```python
import torch

def _softmax(x, axis=-1):
    return torch.softmax(x, dim=axis)

def _gelu(x):
    return torch.nn.functional.gelu(x, approximate='tanh')

def _silu(x):
    return torch.nn.functional.silu(x)

def _sigmoid(x):
    return torch.sigmoid(x)

def _layernorm(x, axis=-1, eps=1e-05):
    m = x.mean(dim=axis, keepdim=True)
    v = x.var(dim=axis, keepdim=True, unbiased=False)
    return (x - m) / torch.sqrt(v + eps)

def _scatter_add(tgt, idx, src, axis=0):
    return tgt.clone().index_add_(axis, idx, src)

def _segment_sum(src, seg, n):
    out = torch.zeros((n,) + src.shape[1:], dtype=src.dtype)
    return out.index_add_(0, seg, src)

def _pad(x, pw):
    flat = tuple((v for pair in reversed(pw) for v in pair))
    return torch.nn.functional.pad(x, flat)
kernel_name = 'gated_mix__memory_aug_recurrent_mem_tr__sliding_local_dilated__prompt'

def setup_inputs():

    _w = lambda a: (lambda t: t.to(torch.bfloat16) if t.is_floating_point() else t)(torch.as_tensor(a))

    def _A_setup():
        B, S, Dm = (1, 2048, 640)
        H, Dh = (32, 192)
        M, seg = (8, 32)
        seg = min(seg, S)
        S = S // seg * seg
        return {'x': _w((lambda *s: torch.randn(*s, dtype=torch.bfloat16) * 0.05)(B, S, Dm)), 'mem0': _w((lambda *s: torch.randn(*s, dtype=torch.bfloat16) * 1.6)(B, M, Dm)), 'Wq': _w((lambda *s: torch.randn(*s, dtype=torch.bfloat16) * 0.8)(Dm, H, Dh) * Dm ** (-0.5)), 'Wk': _w((lambda *s: torch.randn(*s, dtype=torch.bfloat16) * 0.8)(Dm, H, Dh) * Dm ** (-0.5)), 'Wv': _w((lambda *s: torch.randn(*s, dtype=torch.bfloat16) * 1.6)(Dm, H, Dh) * Dm ** (-0.5)), 'Wo': _w((lambda *s: torch.randn(*s, dtype=torch.bfloat16) * 1.6)(H, Dh, Dm) * (H * Dh) ** (-0.5)), 'seg_len': seg}
    _A_in = _A_setup()

    def _B_setup():
        B, S, D = (1, 2048, 640)
        return {'x': _w((lambda *s: torch.randn(*s, dtype=torch.bfloat16) * 0.05)(B, S, D)), 'wqkv': _w((lambda *s: torch.randn(*s, dtype=torch.bfloat16) * 0.8)(D, 3 * D)), 'wo': _w((lambda *s: torch.randn(*s, dtype=torch.bfloat16) * 0.05)(D, D))}
    _B_in = _B_setup()
    return {'A_x': _A_in['x'], 'A_mem0': _A_in['mem0'], 'A_Wq': _A_in['Wq'], 'A_Wk': _A_in['Wk'], 'A_Wv': _A_in['Wv'], 'A_Wo': _A_in['Wo'], 'A_seg_len': _A_in['seg_len'], 'B_x': _B_in['x'], 'B_wqkv': _B_in['wqkv'], 'B_wo': _B_in['wo'], 'gate_w': _w((lambda *s: torch.randn(*s, dtype=torch.bfloat16) * 0.05)(640) * 16.0)}

def reference(A_x, A_mem0, A_Wq, A_Wk, A_Wv, A_Wo, A_seg_len, B_x, B_wqkv, B_wo, gate_w):

    def _A_ref(x, mem0, Wq, Wk, Wv, Wo, seg_len):
        B, S, Dm = x.shape
        H, Dh = (Wq.shape[1], Wq.shape[2])
        M = mem0.shape[1]
        scale = Dh ** (-0.5)
        n_seg = S // seg_len
        L = M + seg_len
        idx = torch.arange(L)
        mask = (idx[:, None] < M) | (idx[:, None] >= idx[None, :])
        mem = mem0
        outs = []
        for s in range(n_seg):
            xs = x[:, s * seg_len:(s + 1) * seg_len, :].clone()
            h = torch.concatenate([mem, xs], axis=1)
            q = torch.einsum('btd,dhe->bhte', h, Wq)
            k = torch.einsum('btd,dhe->bhte', h, Wk)
            v = torch.einsum('btd,dhe->bhte', h, Wv)
            scores = torch.einsum('bhqe,bhke->bhqk', q, k) * scale
            scores = torch.where(mask[None, None], scores, -1000000000.0)
            p = _softmax(scores, axis=-1)
            o = torch.einsum('bhqk,bhke->bhqe', p, v)
            o = torch.einsum('bhte,hed->btd', o, Wo)
            mem = o[:, :M, :].clone()
            outs.append(o[:, M:, :])
        return torch.concatenate(outs, axis=1)

    def _B_ref(x, wqkv, wo):
        B, S, D = x.shape
        H = 32
        Dh = D // H
        W, dil = (8, 2)
        qkv = (lambda x, *d: x.permute(*d))((x @ wqkv).reshape(B, S, 3, H, Dh), 2, 0, 3, 1, 4)
        q, k, v = (qkv[0], qkv[1], qkv[2])
        scale = Dh ** (-0.5)
        pos = torch.arange(S)
        off = torch.arange(W) * dil
        idx = pos[:, None] - off[None, :]
        mask = idx >= 0
        idx_c = torch.where(mask, idx, 0).reshape(-1)
        kg = k[:, :, idx_c, :].reshape(B, H, S, W, Dh)
        vg = v[:, :, idx_c, :].reshape(B, H, S, W, Dh)
        logits = torch.einsum('bhsd,bhswd->bhsw', q, kg) * scale
        logits = torch.where(mask[None, None, :, :], logits, -1000000000.0)
        attn = _softmax(logits, axis=-1)
        o = torch.einsum('bhsw,bhswd->bhsd', attn, vg)
        return (lambda x, *d: x.permute(*d))(o, 0, 2, 1, 3).reshape(B, S, D) @ wo
    x = A_x
    g = _sigmoid((x * gate_w).sum(-1, keepdims=True))
    a = _A_ref(x, A_mem0, A_Wq, A_Wk, A_Wv, A_Wo, A_seg_len)
    b = _B_ref(x, B_wqkv, B_wo)
    return g * a + (1 - g) * b
```

```asm
; @launch kernel=gated_mix__memory_aug_recurrent_mem_tr__sliding_local_dilated__prompt_kernel grid=(256,1,1) block=(256,1,1) lds=163840
.amdgcn_target "amdgcn-amd-amdhsa--gfx950"
.text
.globl gated_mix__memory_aug_recurrent_mem_tr__sliding_local_dilated__prompt_kernel
.p2align 8
.type gated_mix__memory_aug_recurrent_mem_tr__sliding_local_dilated__prompt_kernel,@function
gated_mix__memory_aug_recurrent_mem_tr__sliding_local_dilated__prompt_kernel:
  s_cmp_ge_u32 s2, 256
  s_cbranch_scc1 end0
  s_load_dwordx2 s[4:5], s[0:1], 96
  s_load_dwordx2 s[38:39], s[0:1], 104
  v_lshrrev_b32 v1, 6, v0
  v_and_b32 v2, 15, v0
  v_readfirstlane_b32 s20, v1
  v_and_b32 v1, 63, v0
  v_lshrrev_b32 v3, 4, v1
  s_getreg_b32 s50, hwreg(HW_REG_XCC_ID)
  s_and_b32 s50, s50, 7
  s_waitcnt lgkmcnt(0)
  s_mov_b32 s32, s4
  s_mov_b32 s33, s5
  s_mov_b32 s34, 256
  s_mov_b32 s35, 0x00020000
  v_mov_b32 v21, 0
  s_cmp_lg_u32 s20, 0
  s_cbranch_scc1 rk_1
  s_and_b32 s21, s50, 1
  s_lshl_b32 s21, s21, 7
  s_lshl_b32 s22, s50, 1
  s_and_b32 s22, s22, 12
  s_add_u32 s21, s21, s22
  v_mov_b32 v22, s21
  v_mov_b32 v23, 1
  s_mov_b64 exec, 1
  buffer_atomic_add v23, v22, s[32:35], 0 offen sc0 sc1
  s_waitcnt vmcnt(0)
  v_readfirstlane_b32 s51, v23
  s_lshl_b32 s22, s50, 5
  s_add_u32 s22, s22, s51
  s_cmp_lt_u32 s51, 32
  s_cbranch_scc1 rk_2
  v_mov_b32 v24, 72
  v_mov_b32 v25, 1
  buffer_atomic_add v25, v24, s[32:35], 0 offen sc0 sc1
  s_waitcnt vmcnt(0)
  v_readfirstlane_b32 s23, v25
  s_mov_b32 s101, 0
  s_mov_b64 exec, -1
  v_lshlrev_b32 v24, 2, v1
rk_3:
  s_sleep 8
  buffer_load_dword v25, v24, s[32:35], 0 offen sc1
  s_add_u32 s101, s101, 1
  s_cmp_gt_u32 s101, 131072
  s_cbranch_scc1 end0
  s_waitcnt vmcnt(0)
  v_readlane_b32 s21, v25, 0
  v_readlane_b32 s22, v25, 32
  s_add_u32 s21, s21, s22
  v_readlane_b32 s22, v25, 1
  s_add_u32 s21, s21, s22
  v_readlane_b32 s22, v25, 33
  s_add_u32 s21, s21, s22
  v_readlane_b32 s22, v25, 2
  s_add_u32 s21, s21, s22
  v_readlane_b32 s22, v25, 34
  s_add_u32 s21, s21, s22
  v_readlane_b32 s22, v25, 3
  s_add_u32 s21, s21, s22
  v_readlane_b32 s22, v25, 35
  s_add_u32 s21, s21, s22
  s_cmp_lt_u32 s21, 256
  s_cbranch_scc1 rk_3
  s_mov_b64 exec, 1
  s_mov_b32 s24, 0
rk_5:
  s_and_b32 s21, s24, 1
  s_lshl_b32 s21, s21, 5
  s_lshr_b32 s22, s24, 1
  s_add_u32 s21, s21, s22
  v_readlane_b32 s21, v25, s21
  s_min_u32 s21, s21, 32
  s_sub_u32 s25, 32, s21
  s_cmp_lt_u32 s23, s25
  s_cbranch_scc1 rk_4
  s_sub_u32 s23, s23, s25
  s_add_u32 s24, s24, 1
  s_cmp_lt_u32 s24, 8
  s_cbranch_scc1 rk_5
  s_branch end0
rk_4:
  s_lshl_b32 s22, s24, 5
  s_add_u32 s22, s22, s21
  s_add_u32 s22, s22, s23
  s_or_b32 s22, s22, 0x100
rk_2:
  v_mov_b32 v23, s22
  ds_write_b32 v21, v23
  s_waitcnt lgkmcnt(0)
  s_mov_b64 exec, -1
rk_1:
  s_barrier
  ds_read_b32 v23, v21
  s_waitcnt lgkmcnt(0)
  v_readfirstlane_b32 s22, v23
  s_barrier
  s_mov_b32 s84, 0
  s_mov_b32 s85, -1
  s_lshr_b32 s53, s22, 8
  s_and_b32 s22, s22, 255
  s_cmp_ge_u32 s22, 128
  s_cbranch_scc1 gemm_side
  s_lshr_b32 s50, s22, 4
  s_and_b32 s51, s22, 15
  s_mov_b32 s86, 0x3dd53b95
  s_load_dwordx2 s[4:5], s[0:1], 8
  s_load_dwordx4 s[40:43], s[0:1], 16
  s_load_dwordx4 s[44:47], s[0:1], 32
  s_load_dwordx2 s[48:49], s[0:1], 104
  s_lshr_b32 s55, s51, 2
  s_and_b32 s56, s51, 3
  s_lshl_b32 s57, s50, 2
  s_add_u32 s58, s57, s55
  s_add_u32 s59, s57, s20
  s_lshr_b32 s60, s51, 1
  s_and_b32 s61, s51, 1
  s_mul_i32 s81, s20, 40448
  v_lshlrev_b32 v4, 4, v1
  s_waitcnt lgkmcnt(0)
  s_mov_b32 s12, s44
  s_mov_b32 s13, s45
  s_mov_b32 s14, 7864320
  s_mov_b32 s15, 0x00020000
  s_mov_b32 s16, s46
  s_mov_b32 s17, s47
  s_mov_b32 s18, 7864320
  s_mov_b32 s19, 0x00020000
  s_mov_b32 s24, s40
  s_mov_b32 s25, s41
  s_mov_b32 s26, 7864320
  s_mov_b32 s27, 0x00020000
  s_mov_b32 s28, s42
  s_mov_b32 s29, s43
  s_mov_b32 s30, 7864320
  s_mov_b32 s31, 0x00020000
  s_mov_b32 s36, s4
  s_mov_b32 s37, s5
  s_mov_b32 s38, 10240
  s_mov_b32 s39, 0x00020000
  s_add_u32 s8, s48, 78643200
  s_addc_u32 s9, s49, 0
  s_mov_b32 s10, 491520
  s_mov_b32 s11, 0x00020000
  s_add_u32 s4, s48, 83886079
  s_addc_u32 s5, s49, 0
  s_and_b32 s4, s4, 0xffe00000
  s_mov_b32 s6, 2097152
  s_mov_b32 s7, 0x00020000
  v_add_u32 v66, 0, v1
  v_mul_u32_u24 v67, 2731, v66
  v_lshrrev_b32 v67, 16, v67
  v_mul_u32_u24 v48, 24, v67
  v_sub_u32 v66, v66, v48
  v_mul_u32_u24 v67, 12288, v67
  v_lshl_add_u32 v48, v66, 4, v67
  v_add_u32 v66, 64, v1
  v_mul_u32_u24 v67, 2731, v66
  v_lshrrev_b32 v67, 16, v67
  v_mul_u32_u24 v49, 24, v67
  v_sub_u32 v66, v66, v49
  v_mul_u32_u24 v67, 12288, v67
  v_lshl_add_u32 v49, v66, 4, v67
  v_add_u32 v66, 128, v1
  v_mul_u32_u24 v67, 2731, v66
  v_lshrrev_b32 v67, 16, v67
  v_mul_u32_u24 v50, 24, v67
  v_sub_u32 v66, v66, v50
  v_mul_u32_u24 v67, 12288, v67
  v_lshl_add_u32 v50, v66, 4, v67
  s_mul_i32 s21, s51, 491520
  s_mul_i32 s80, s59, 384
  s_add_u32 s21, s21, s80
  buffer_load_dwordx4 v[248:251], v48, s[12:15], s21 offen
  buffer_load_dwordx4 v[248:251], v49, s[12:15], s21 offen
  buffer_load_dwordx4 v[248:251], v50, s[12:15], s21 offen
  s_add_u32 s21, s21, 98304
  buffer_load_dwordx4 v[248:251], v48, s[12:15], s21 offen
  buffer_load_dwordx4 v[248:251], v49, s[12:15], s21 offen
  buffer_load_dwordx4 v[248:251], v50, s[12:15], s21 offen
  s_add_u32 s21, s21, 98304
  buffer_load_dwordx4 v[248:251], v48, s[12:15], s21 offen
  buffer_load_dwordx4 v[248:251], v49, s[12:15], s21 offen
  buffer_load_dwordx4 v[248:251], v50, s[12:15], s21 offen
  s_add_u32 s21, s21, 98304
  buffer_load_dwordx4 v[248:251], v48, s[12:15], s21 offen
  buffer_load_dwordx4 v[248:251], v49, s[12:15], s21 offen
  buffer_load_dwordx4 v[248:251], v50, s[12:15], s21 offen
  s_add_u32 s21, s21, 98304
  buffer_load_dwordx4 v[248:251], v48, s[12:15], s21 offen
  buffer_load_dwordx4 v[248:251], v49, s[12:15], s21 offen
  buffer_load_dwordx4 v[248:251], v50, s[12:15], s21 offen
  s_add_u32 s21, s21, 98304
  v_add_u32 v66, 0, v1
  v_mul_u32_u24 v67, 10923, v66
  v_lshrrev_b32 v67, 16, v67
  v_mul_u32_u24 v60, 6, v67
  v_sub_u32 v66, v66, v60
  v_mul_u32_u24 v67, 1280, v67
  v_lshl_add_u32 v60, v66, 4, v67
  v_add_u32 v66, 64, v1
  v_mul_u32_u24 v67, 10923, v66
  v_lshrrev_b32 v67, 16, v67
  v_mul_u32_u24 v61, 6, v67
  v_sub_u32 v66, v66, v61
  v_mul_u32_u24 v67, 1280, v67
  v_lshl_add_u32 v61, v66, 4, v67
  v_add_u32 v66, 128, v1
  v_mul_u32_u24 v67, 10923, v66
  v_lshrrev_b32 v67, 16, v67
  v_mul_u32_u24 v62, 6, v67
  v_sub_u32 v66, v66, v62
  v_mul_u32_u24 v67, 1280, v67
  v_lshl_add_u32 v62, v66, 4, v67
  s_mul_i32 s21, s59, 245760
  s_mul_i32 s22, s60, 160
  s_add_u32 s21, s21, s22
  s_lshl_b32 s22, s61, 6
  s_add_u32 s21, s21, s22
  s_add_u32 m0, s81, 0
  s_nop 0
  buffer_load_dwordx4 v60, s[16:19], s21 offen lds
  s_add_u32 m0, s81, 1024
  s_nop 0
  buffer_load_dwordx4 v61, s[16:19], s21 offen lds
  s_add_u32 m0, s81, 2048
  s_nop 0
  buffer_load_dwordx4 v62, s[16:19], s21 offen lds
  s_add_u32 s21, s21, 40960
  s_add_u32 m0, s81, 3072
  s_nop 0
  buffer_load_dwordx4 v60, s[16:19], s21 offen lds
  s_add_u32 m0, s81, 4096
  s_nop 0
  buffer_load_dwordx4 v61, s[16:19], s21 offen lds
  s_add_u32 m0, s81, 5120
  s_nop 0
  buffer_load_dwordx4 v62, s[16:19], s21 offen lds
  s_add_u32 s21, s21, 40960
  s_add_u32 m0, s81, 6144
  s_nop 0
  buffer_load_dwordx4 v60, s[16:19], s21 offen lds
  s_add_u32 m0, s81, 7168
  s_nop 0
  buffer_load_dwordx4 v61, s[16:19], s21 offen lds
  s_add_u32 m0, s81, 8192
  s_nop 0
  buffer_load_dwordx4 v62, s[16:19], s21 offen lds
  s_add_u32 s21, s21, 40960
  s_add_u32 m0, s81, 9216
  s_nop 0
  buffer_load_dwordx4 v60, s[16:19], s21 offen lds
  s_add_u32 m0, s81, 10240
  s_nop 0
  buffer_load_dwordx4 v61, s[16:19], s21 offen lds
  s_add_u32 m0, s81, 11264
  s_nop 0
  buffer_load_dwordx4 v62, s[16:19], s21 offen lds
  s_add_u32 s21, s21, 40960
  s_add_u32 m0, s81, 12288
  s_nop 0
  buffer_load_dwordx4 v60, s[16:19], s21 offen lds
  s_add_u32 m0, s81, 13312
  s_nop 0
  buffer_load_dwordx4 v61, s[16:19], s21 offen lds
  s_add_u32 m0, s81, 14336
  s_nop 0
  buffer_load_dwordx4 v62, s[16:19], s21 offen lds
  s_add_u32 s21, s21, 40960
  s_add_u32 m0, s81, 15360
  s_nop 0
  buffer_load_dwordx4 v60, s[16:19], s21 offen lds
  s_add_u32 m0, s81, 16384
  s_nop 0
  buffer_load_dwordx4 v61, s[16:19], s21 offen lds
  s_add_u32 m0, s81, 17408
  s_nop 0
  buffer_load_dwordx4 v62, s[16:19], s21 offen lds
  s_add_u32 s21, s21, 40960
  v_add_u32 v66, 0, v1
  v_mul_u32_u24 v67, 2731, v66
  v_lshrrev_b32 v67, 16, v67
  v_mul_u32_u24 v48, 24, v67
  v_sub_u32 v66, v66, v48
  v_lshrrev_b32 v48, 2, v67
  v_lshlrev_b32 v48, 1, v48
  v_or_b32 v48, 0, v48
  v_xor_b32 v66, v66, v48
  v_add_u32 v67, 0, v67
  v_mul_u32_u24 v67, 12288, v67
  v_lshl_add_u32 v48, v66, 4, v67
  v_add_u32 v66, 64, v1
  v_mul_u32_u24 v67, 2731, v66
  v_lshrrev_b32 v67, 16, v67
  v_mul_u32_u24 v49, 24, v67
  v_sub_u32 v66, v66, v49
  v_lshrrev_b32 v49, 2, v67
  v_lshlrev_b32 v49, 1, v49
  v_or_b32 v49, 0, v49
  v_xor_b32 v66, v66, v49
  v_add_u32 v67, 0, v67
  v_mul_u32_u24 v67, 12288, v67
  v_lshl_add_u32 v49, v66, 4, v67
  v_add_u32 v66, 128, v1
  v_mul_u32_u24 v67, 2731, v66
  v_lshrrev_b32 v67, 16, v67
  v_mul_u32_u24 v50, 24, v67
  v_sub_u32 v66, v66, v50
  v_lshrrev_b32 v50, 2, v67
  v_lshlrev_b32 v50, 1, v50
  v_or_b32 v50, 0, v50
  v_xor_b32 v66, v66, v50
  v_add_u32 v67, 0, v67
  v_mul_u32_u24 v67, 12288, v67
  v_lshl_add_u32 v50, v66, 4, v67
  v_add_u32 v66, 0, v1
  v_mul_u32_u24 v67, 2731, v66
  v_lshrrev_b32 v67, 16, v67
  v_mul_u32_u24 v51, 24, v67
  v_sub_u32 v66, v66, v51
  v_lshrrev_b32 v51, 2, v67
  v_lshlrev_b32 v51, 1, v51
  v_or_b32 v51, 1, v51
  v_xor_b32 v66, v66, v51
  v_add_u32 v67, 8, v67
  v_mul_u32_u24 v67, 12288, v67
  v_lshl_add_u32 v51, v66, 4, v67
  v_add_u32 v66, 64, v1
  v_mul_u32_u24 v67, 2731, v66
  v_lshrrev_b32 v67, 16, v67
  v_mul_u32_u24 v52, 24, v67
  v_sub_u32 v66, v66, v52
  v_lshrrev_b32 v52, 2, v67
  v_lshlrev_b32 v52, 1, v52
  v_or_b32 v52, 1, v52
  v_xor_b32 v66, v66, v52
  v_add_u32 v67, 8, v67
  v_mul_u32_u24 v67, 12288, v67
  v_lshl_add_u32 v52, v66, 4, v67
  v_add_u32 v66, 128, v1
  v_mul_u32_u24 v67, 2731, v66
  v_lshrrev_b32 v67, 16, v67
  v_mul_u32_u24 v53, 24, v67
  v_sub_u32 v66, v66, v53
  v_lshrrev_b32 v53, 2, v67
  v_lshlrev_b32 v53, 1, v53
  v_or_b32 v53, 1, v53
  v_xor_b32 v66, v66, v53
  v_add_u32 v67, 8, v67
  v_mul_u32_u24 v67, 12288, v67
  v_lshl_add_u32 v53, v66, 4, v67
  v_add_u32 v66, 0, v1
  v_mul_u32_u24 v67, 2731, v66
  v_lshrrev_b32 v67, 16, v67
  v_mul_u32_u24 v54, 24, v67
  v_sub_u32 v66, v66, v54
  v_lshrrev_b32 v54, 2, v67
  v_lshlrev_b32 v54, 1, v54
  v_or_b32 v54, 4, v54
  v_xor_b32 v66, v66, v54
  v_add_u32 v67, 16, v67
  v_mul_u32_u24 v67, 12288, v67
  v_lshl_add_u32 v54, v66, 4, v67
  v_add_u32 v66, 64, v1
  v_mul_u32_u24 v67, 2731, v66
  v_lshrrev_b32 v67, 16, v67
  v_mul_u32_u24 v55, 24, v67
  v_sub_u32 v66, v66, v55
  v_lshrrev_b32 v55, 2, v67
  v_lshlrev_b32 v55, 1, v55
  v_or_b32 v55, 4, v55
  v_xor_b32 v66, v66, v55
  v_add_u32 v67, 16, v67
  v_mul_u32_u24 v67, 12288, v67
  v_lshl_add_u32 v55, v66, 4, v67
  v_add_u32 v66, 128, v1
  v_mul_u32_u24 v67, 2731, v66
  v_lshrrev_b32 v67, 16, v67
  v_mul_u32_u24 v56, 24, v67
  v_sub_u32 v66, v66, v56
  v_lshrrev_b32 v56, 2, v67
  v_lshlrev_b32 v56, 1, v56
  v_or_b32 v56, 4, v56
  v_xor_b32 v66, v66, v56
  v_add_u32 v67, 16, v67
  v_mul_u32_u24 v67, 12288, v67
  v_lshl_add_u32 v56, v66, 4, v67
  v_add_u32 v66, 0, v1
  v_mul_u32_u24 v67, 2731, v66
  v_lshrrev_b32 v67, 16, v67
  v_mul_u32_u24 v57, 24, v67
  v_sub_u32 v66, v66, v57
  v_lshrrev_b32 v57, 2, v67
  v_lshlrev_b32 v57, 1, v57
  v_or_b32 v57, 5, v57
  v_xor_b32 v66, v66, v57
  v_add_u32 v67, 24, v67
  v_mul_u32_u24 v67, 12288, v67
  v_lshl_add_u32 v57, v66, 4, v67
  v_add_u32 v66, 64, v1
  v_mul_u32_u24 v67, 2731, v66
  v_lshrrev_b32 v67, 16, v67
  v_mul_u32_u24 v58, 24, v67
  v_sub_u32 v66, v66, v58
  v_lshrrev_b32 v58, 2, v67
  v_lshlrev_b32 v58, 1, v58
  v_or_b32 v58, 5, v58
  v_xor_b32 v66, v66, v58
  v_add_u32 v67, 24, v67
  v_mul_u32_u24 v67, 12288, v67
  v_lshl_add_u32 v58, v66, 4, v67
  v_add_u32 v66, 128, v1
  v_mul_u32_u24 v67, 2731, v66
  v_lshrrev_b32 v67, 16, v67
  v_mul_u32_u24 v59, 24, v67
  v_sub_u32 v66, v66, v59
  v_lshrrev_b32 v59, 2, v67
  v_lshlrev_b32 v59, 1, v59
  v_or_b32 v59, 5, v59
  v_xor_b32 v66, v66, v59
  v_add_u32 v67, 24, v67
  v_mul_u32_u24 v67, 12288, v67
  v_lshl_add_u32 v59, v66, 4, v67
  s_add_u32 m0, s81, 24576
  s_nop 0
  buffer_load_dwordx4 v48, s[12:15], s80 offen lds
  s_add_u32 m0, s81, 25600
  s_nop 0
  buffer_load_dwordx4 v49, s[12:15], s80 offen lds
  s_add_u32 m0, s81, 26624
  s_nop 0
  buffer_load_dwordx4 v50, s[12:15], s80 offen lds
  s_add_u32 m0, s81, 27648
  s_nop 0
  buffer_load_dwordx4 v51, s[12:15], s80 offen lds
  s_add_u32 m0, s81, 28672
  s_nop 0
  buffer_load_dwordx4 v52, s[12:15], s80 offen lds
  s_add_u32 m0, s81, 29696
  s_nop 0
  buffer_load_dwordx4 v53, s[12:15], s80 offen lds
  s_add_u32 m0, s81, 30720
  s_nop 0
  buffer_load_dwordx4 v54, s[12:15], s80 offen lds
  s_add_u32 m0, s81, 31744
  s_nop 0
  buffer_load_dwordx4 v55, s[12:15], s80 offen lds
  s_add_u32 m0, s81, 32768
  s_nop 0
  buffer_load_dwordx4 v56, s[12:15], s80 offen lds
  s_add_u32 m0, s81, 33792
  s_nop 0
  buffer_load_dwordx4 v57, s[12:15], s80 offen lds
  s_add_u32 m0, s81, 34816
  s_nop 0
  buffer_load_dwordx4 v58, s[12:15], s80 offen lds
  s_add_u32 m0, s81, 35840
  s_nop 0
  buffer_load_dwordx4 v59, s[12:15], s80 offen lds
  s_add_u32 s80, s80, 393216
  v_add_u32 v66, 0, v1
  v_mul_u32_u24 v67, 10923, v66
  v_lshrrev_b32 v67, 16, v67
  v_mul_u32_u24 v63, 6, v67
  v_sub_u32 v66, v66, v63
  v_mul_u32_u24 v67, 12288, v67
  v_lshl_add_u32 v63, v66, 4, v67
  v_add_u32 v66, 64, v1
  v_mul_u32_u24 v67, 10923, v66
  v_lshrrev_b32 v67, 16, v67
  v_mul_u32_u24 v64, 6, v67
  v_sub_u32 v66, v66, v64
  v_mul_u32_u24 v67, 12288, v67
  v_lshl_add_u32 v64, v66, 4, v67
  v_add_u32 v66, 128, v1
  v_mul_u32_u24 v67, 10923, v66
  v_lshrrev_b32 v67, 16, v67
  v_mul_u32_u24 v65, 6, v67
  v_sub_u32 v66, v66, v65
  v_mul_u32_u24 v67, 12288, v67
  v_lshl_add_u32 v65, v66, 4, v67
  s_mul_i32 s79, s58, 384
  s_mul_i32 s22, s56, 96
  s_add_u32 s79, s79, s22
  s_mul_i32 s22, s20, 1966080
  s_add_u32 s79, s79, s22
  v_and_b32 v224, 7, v2
  v_lshrrev_b32 v225, 3, v2
  v_lshlrev_b32 v12, 3, v1
  v_mov_b32 v23, 0
  v_mov_b32 v226, 0x4444
  v_mov_b32 v227, 0xeeee
  v_cmp_eq_u32 vcc, 1, v225
  v_cmp_gt_u32 s[62:63], 8, v2
  v_cmp_le_u32 s[68:69], 8, v2
  v_cndmask_b32 v22, v226, v227, vcc
  v_cmp_gt_u32 vcc, 32, v1
  v_mov_b32 v226, 0x3dd53b95
  v_cmp_gt_u32 s[66:67], 40, v1
  v_cndmask_b32 v24, 1.0, v226, vcc
  v_cndmask_b32 v25, 1.0, v226, vcc
  v_min_u32 v226, 39, v1
  v_and_b32 v227, 31, v1
  v_lshlrev_b32 v227, 2, v227
  v_lshl_add_u32 v5, v226, 7, v227
  v_mul_u32_u24 v226, 192, v3
  v_lshl_add_u32 v226, v2, 3, v226
  s_mul_i32 s21, s20, 768
  s_add_u32 s21, s21, 10240
  v_add_u32 v6, s21, v226
  v_and_b32 v226, 3, v2
  v_mul_u32_u24 v226, 192, v226
  v_lshrrev_b32 v227, 2, v2
  v_lshl_add_u32 v227, v3, 2, v227
  v_lshl_add_u32 v226, v227, 3, v226
  v_add_u32 v7, 10240, v226
  s_mul_i32 s21, s58, 2560
  s_add_u32 s21, s21, 40960
  s_lshr_b32 s22, s56, 1
  s_lshl_b32 s22, s22, 10
  s_and_b32 s23, s56, 1
  s_lshl_b32 s23, s23, 3
  s_add_u32 s22, s22, s23
  s_lshl_b32 s23, s20, 7
  s_add_u32 s22, s22, s23
  s_add_u32 s22, s22, s21
  v_lshlrev_b32 v226, 8, v3
  v_lshl_add_u32 v226, v224, 4, v226
  v_add_u32 v8, s22, v226
  s_lshl_b32 s22, s56, 2
  s_add_u32 s22, s22, s21
  s_add_u32 s22, s22, 2048
  v_and_b32 v226, 0x1ff, v226
  v_add_u32 v226, s22, v226
  s_cmp_eq_u32 s20, 2
  s_cselect_b64 vcc, -1, 0
  v_cmp_le_u32 s[64:65], 32, v1
  v_cndmask_b32 v8, v8, v226, vcc
  s_cselect_b64 s[64:65], s[64:65], -1
  s_and_b64 s[64:65], s[64:65], s[62:63]
  s_mul_i32 s21, s59, 2560
  s_add_u32 s21, s21, 40960
  v_add_u32 v9, s21, v4
  v_and_b32 v226, 0x1ff, v4
  s_add_u32 s21, s21, 2048
  v_add_u32 v10, s21, v226
  v_lshrrev_b32 v226, 2, v2
  v_and_b32 v227, 1, v2
  v_lshl_add_u32 v228, v226, 1, v227
  v_and_b32 v227, 2, v2
  v_cmp_eq_u32 vcc, 0, v227
  s_lshr_b32 s21, s20, 1
  s_lshl_b32 s21, s21, 9
  s_and_b32 s22, s20, 1
  s_lshl_b32 s22, s22, 6
  s_add_u32 s21, s21, s22
  s_add_u32 s21, s21, 12544
  v_lshlrev_b32 v226, 7, v3
  v_lshl_add_u32 v226, v228, 3, v226
  v_add_u32 v226, s21, v226
  v_mov_b32 v227, 13568
  v_cndmask_b32 v11, v227, v226, vcc
  s_lshl_b32 s21, s20, 9
  s_add_u32 s21, s21, 40960
  v_lshlrev_b32 v226, 7, v3
  v_lshl_add_u32 v226, v228, 4, v226
  v_add_u32 v226, s21, v226
  v_mov_b32 v227, 46080
  v_cndmask_b32 v19, v227, v226, vcc
  s_lshl_b32 s21, s20, 11
  s_add_u32 s21, s21, 32768
  v_add_u32 v18, s21, v4
  s_and_b32 s21, s20, 1
  s_mul_i32 s21, s21, 1536
  s_add_u32 s21, s21, 43008
  v_add_u32 v20, s21, v4
  v_lshrrev_b32 v226, 1, v3
  v_lshlrev_b32 v226, 8, v226
  v_lshl_add_u32 v226, v2, 4, v226
  v_and_b32 v227, 1, v3
  v_lshl_add_u32 v226, v227, 3, v226
  s_add_u32 s21, s21, 1024
  v_add_u32 v21, s21, v226
  s_mul_i32 s21, s20, 640
  s_add_u32 s22, s21, 13824
  v_lshlrev_b32 v226, 4, v224
  v_lshl_add_u32 v227, v3, 7, v226
  v_add_u32 v13, s22, v227
  v_lshl_add_u32 v227, v3, 2, v226
  s_add_u32 s22, s22, 512
  v_add_u32 v14, s22, v227
  v_and_b32 v226, 0x1ff, v4
  v_lshrrev_b32 v228, 5, v1
  v_lshl_add_u32 v226, v228, 3, v226
  s_add_u32 s22, s21, 16384
  v_add_u32 v26, s22, v226
  v_lshl_add_u32 v228, v228, 1, v225
  v_mul_u32_u24 v228, 640, v228
  v_and_b32 v226, 1, v3
  v_lshl_add_u32 v228, v226, 6, v228
  v_lshl_add_u32 v228, v224, 3, v228
  v_add_u32 v43, 16896, v228
  s_and_b32 s21, s50, 1
  s_lshl_b32 s21, s21, 4
  s_add_u32 s21, s21, s51
  s_lshl_b32 s22, s20, 5
  s_add_u32 s21, s21, s22
  s_cmp_lt_u32 s21, 80
  s_cselect_b32 s78, 1, 0
  s_cselect_b32 s21, s21, 0
  s_lshl_b32 s22, s21, 7
  v_add_u32 v17, s22, v227
  s_lshr_b32 s22, s21, 3
  s_lshl_b32 s22, s22, 14
  s_and_b32 s21, s21, 7
  s_lshl_b32 s21, s21, 10
  s_add_u32 s21, s21, s22
  v_add_u32 v16, s21, v4
  s_mul_i32 s21, s60, 10
  s_mul_i32 s22, s61, 6
  s_add_u32 s22, s22, s21
  s_add_u32 s21, s21, s61
  s_add_u32 s21, s21, 4
  v_lshrrev_b32 v226, 3, v1
  v_cmp_gt_u32 vcc, 4, v226
  v_add_u32 v226, s22, v226
  v_mov_b32 v227, s21
  v_cndmask_b32 v226, v227, v226, vcc
  v_lshrrev_b32 v227, 3, v226
  v_lshlrev_b32 v227, 14, v227
  v_and_b32 v226, 7, v226
  v_lshl_add_u32 v226, v226, 10, v227
  v_lshl_add_u32 v226, v224, 4, v226
  s_lshl_b32 s21, s50, 7
  v_add_u32 v15, s21, v226
  v_and_b32 v226, 1, v2
  v_lshlrev_b32 v226, 4, v226
  v_mov_b32 v227, 0x3c00
  v_lshlrev_b32 v226, v226, v227
  v_lshrrev_b32 v227, 1, v2
  v_cmp_eq_u32 vcc, 0, v227
  s_nop 1
  v_cndmask_b32 v44, 0, v226, vcc
  v_cmp_eq_u32 vcc, 2, v227
  s_nop 1
  v_cndmask_b32 v45, 0, v226, vcc
  v_cmp_eq_u32 vcc, 4, v227
  s_nop 1
  v_cndmask_b32 v46, 0, v226, vcc
  v_cmp_eq_u32 vcc, 6, v227
  s_nop 1
  v_cndmask_b32 v47, 0, v226, vcc
  v_lshrrev_b32 v226, 5, v1
  v_mul_u32_u24 v226, 40960, v226
  v_bfe_u32 v227, v1, 3, 2
  v_lshl_add_u32 v226, v227, 8, v226
  v_lshl_add_u32 v226, v224, 4, v226
  s_lshl_b32 s21, s61, 7
  v_add_u32 v32, s21, v226
  v_mov_b32 v33, v4
  v_add_u32 v35, 6656, v4
  v_add_u32 v226, 1024, v4
  v_add_u32 v227, 5632, v4
  v_cmp_gt_u32 vcc, 32, v1
  s_mul_i32 s21, s56, 768
  s_nop 0
  v_cndmask_b32 v34, v227, v226, vcc
  v_lshlrev_b32 v226, 4, v224
  v_lshl_add_u32 v227, v3, 7, v226
  v_add_u32 v36, s21, v227
  v_lshrrev_b32 v227, 1, v3
  v_lshl_add_u32 v226, v227, 7, v226
  v_and_b32 v227, 1, v3
  v_lshl_add_u32 v226, v227, 3, v226
  s_add_u32 s21, s21, 512
  v_add_u32 v37, s21, v226
  v_and_b32 v41, 3, v1
  v_lshlrev_b32 v41, 7, v41
  v_add_u32 v226, 0, v1
  v_mul_u32_u24 v227, 1639, v226
  v_lshrrev_b32 v227, 16, v227
  v_mul_u32_u24 v38, 40, v227
  v_sub_u32 v226, v226, v38
  v_mul_u32_u24 v227, 10240, v227
  v_lshl_add_u32 v38, v226, 4, v227
  v_add_u32 v226, 64, v1
  v_mul_u32_u24 v227, 1639, v226
  v_lshrrev_b32 v227, 16, v227
  v_mul_u32_u24 v39, 40, v227
  v_sub_u32 v226, v226, v39
  v_mul_u32_u24 v227, 10240, v227
  v_lshl_add_u32 v39, v226, 4, v227
  v_add_u32 v226, 128, v1
  v_mul_u32_u24 v227, 1639, v226
  v_lshrrev_b32 v227, 16, v227
  v_mul_u32_u24 v40, 40, v227
  v_sub_u32 v226, v226, v40
  v_mul_u32_u24 v227, 10240, v227
  v_lshl_add_u32 v40, v226, 4, v227
  v_mov_b32 v28, -1
  v_mov_b32 v29, -1
  v_mov_b32 v30, -1
  v_mov_b32 v31, -1
  s_lshr_b32 s21, s50, 1
  s_mul_i32 s77, s21, 10240
  s_cmp_eq_u32 s20, 3
  s_cbranch_scc1 ar_8
  s_mov_b64 exec, s[64:65]
  s_cmp_eq_u32 s20, 2
  s_cbranch_scc1 ar_7
  s_mov_b32 s21, 0
  buffer_store_dwordx2 v[28:29], v8, s[8:11], s21 offen
  s_mov_b32 s21, 122880
  buffer_store_dwordx2 v[28:29], v8, s[8:11], s21 offen
  s_mov_b32 s21, 245760
  buffer_store_dwordx2 v[28:29], v8, s[8:11], s21 offen
  s_mov_b32 s21, 368640
  buffer_store_dwordx2 v[28:29], v8, s[8:11], s21 offen
  s_branch ar_9
ar_7:
  s_mov_b32 s21, 0
  buffer_store_dword v28, v8, s[8:11], s21 offen
  buffer_store_dword v28, v8, s[8:11], s21 offen offset:128
  s_mov_b32 s21, 122880
  buffer_store_dword v28, v8, s[8:11], s21 offen
  buffer_store_dword v28, v8, s[8:11], s21 offen offset:128
  s_mov_b32 s21, 245760
  buffer_store_dword v28, v8, s[8:11], s21 offen
  buffer_store_dword v28, v8, s[8:11], s21 offen offset:128
  s_mov_b32 s21, 368640
  buffer_store_dword v28, v8, s[8:11], s21 offen
  buffer_store_dword v28, v8, s[8:11], s21 offen offset:128
ar_9:
  s_cmp_eq_u32 s78, 0
  s_cbranch_scc1 ar_10
  s_mov_b64 exec, s[62:63]
  s_add_u32 s21, s77, 0
  buffer_store_dword v28, v17, s[8:11], s21 offen
  s_add_u32 s21, s77, 122880
  buffer_store_dword v28, v17, s[8:11], s21 offen
  s_add_u32 s21, s77, 245760
  buffer_store_dword v28, v17, s[8:11], s21 offen
  s_add_u32 s21, s77, 368640
  buffer_store_dword v28, v17, s[8:11], s21 offen
  s_branch ar_10
ar_8:
  s_mov_b64 exec, s[66:67]
  s_mov_b32 s21, 0
  buffer_store_dwordx4 v[28:31], v15, s[4:7], s21 offen sc1
  s_mov_b32 s21, 524288
  buffer_store_dwordx4 v[28:31], v15, s[4:7], s21 offen sc1
  s_mov_b32 s21, 8192
  buffer_store_dwordx4 v[28:31], v15, s[4:7], s21 offen sc1
  s_mov_b32 s21, 532480
  buffer_store_dwordx4 v[28:31], v15, s[4:7], s21 offen sc1
ar_10:
  s_mov_b64 exec, -1
  v_lshrrev_b32 v66, 2, v2
  v_lshl_add_u32 v66, v3, 3, v66
  v_mul_u32_u24 v66, 96, v66
  v_add_u32 v66, s81, v66
  v_and_b32 v67, 3, v2
  s_lshl_b32 s21, s61, 5
  v_lshl_add_u32 v68, v67, 4, v66
  v_add_u32 v68, s21, v68
  s_mul_i32 s21, s61, 48
  s_sub_u32 s21, 64, s21
  v_and_b32 v67, 1, v2
  v_lshl_add_u32 v69, v67, 3, v66
  v_add_u32 v69, s21, v69
  v_lshrrev_b32 v226, 3, v2
  v_lshlrev_b32 v226, 4, v226
  v_bfe_u32 v227, v2, 1, 1
  v_lshl_add_u32 v226, v227, 3, v226
  v_and_b32 v227, 5, v2
  v_add_u32 v226, v226, v227
  v_mul_u32_u24 v226, 384, v226
  v_add_u32 v226, s81, v226
  v_lshrrev_b32 v227, 1, v2
  v_xor_b32 v227, v227, v3
  v_lshl_add_u32 v70, v227, 4, v226
  v_xor_b32 v227, 4, v227
  v_lshl_add_u32 v71, v227, 4, v226
  s_waitcnt vmcnt(0)
  ds_read_b64_tr_b16 v[72:73], v68 offset:0
  ds_read_b64_tr_b16 v[74:75], v68 offset:384
  ds_read_b64_tr_b16 v[76:77], v68 offset:8
  ds_read_b64_tr_b16 v[78:79], v68 offset:392
  ds_read_b64_tr_b16 v[80:81], v69 offset:0
  ds_read_b64_tr_b16 v[82:83], v69 offset:384
  ds_read_b64_tr_b16 v[84:85], v68 offset:3072
  ds_read_b64_tr_b16 v[86:87], v68 offset:3456
  ds_read_b64_tr_b16 v[88:89], v68 offset:3080
  ds_read_b64_tr_b16 v[90:91], v68 offset:3464
  ds_read_b64_tr_b16 v[92:93], v69 offset:3072
  ds_read_b64_tr_b16 v[94:95], v69 offset:3456
  ds_read_b64_tr_b16 v[96:97], v68 offset:6144
  ds_read_b64_tr_b16 v[98:99], v68 offset:6528
  ds_read_b64_tr_b16 v[100:101], v68 offset:6152
  ds_read_b64_tr_b16 v[102:103], v68 offset:6536
  ds_read_b64_tr_b16 v[104:105], v69 offset:6144
  ds_read_b64_tr_b16 v[106:107], v69 offset:6528
  ds_read_b64_tr_b16 v[108:109], v68 offset:9216
  ds_read_b64_tr_b16 v[110:111], v68 offset:9600
  ds_read_b64_tr_b16 v[112:113], v68 offset:9224
  ds_read_b64_tr_b16 v[114:115], v68 offset:9608
  ds_read_b64_tr_b16 v[116:117], v69 offset:9216
  ds_read_b64_tr_b16 v[118:119], v69 offset:9600
  ds_read_b64_tr_b16 v[120:121], v68 offset:12288
  ds_read_b64_tr_b16 v[122:123], v68 offset:12672
  ds_read_b64_tr_b16 v[124:125], v68 offset:12296
  ds_read_b64_tr_b16 v[126:127], v68 offset:12680
  ds_read_b64_tr_b16 v[128:129], v69 offset:12288
  ds_read_b64_tr_b16 v[130:131], v69 offset:12672
  ds_read_b64_tr_b16 v[132:133], v68 offset:15360
  ds_read_b64_tr_b16 v[134:135], v68 offset:15744
  ds_read_b64_tr_b16 v[136:137], v68 offset:15368
  ds_read_b64_tr_b16 v[138:139], v68 offset:15752
  ds_read_b64_tr_b16 v[140:141], v69 offset:15360
  ds_read_b64_tr_b16 v[142:143], v69 offset:15744
  s_waitcnt lgkmcnt(0)
  s_barrier
  s_cmp_lg_u32 s20, 0
  s_cbranch_scc1 ic_11
  v_mov_b32 v68, 64
  v_mov_b32 v69, 1
  s_mov_b64 exec, 1
  buffer_atomic_add v69, v68, s[32:35], 0 offen sc1
  s_mov_b64 exec, -1
ic_11:
  s_add_u32 m0, s81, 0
  s_nop 0
  buffer_load_dwordx4 v48, s[12:15], s80 offen lds
  s_add_u32 m0, s81, 1024
  s_nop 0
  buffer_load_dwordx4 v49, s[12:15], s80 offen lds
  s_add_u32 m0, s81, 2048
  s_nop 0
  buffer_load_dwordx4 v50, s[12:15], s80 offen lds
  s_add_u32 m0, s81, 3072
  s_nop 0
  buffer_load_dwordx4 v51, s[12:15], s80 offen lds
  s_add_u32 m0, s81, 4096
  s_nop 0
  buffer_load_dwordx4 v52, s[12:15], s80 offen lds
  s_add_u32 m0, s81, 5120
  s_nop 0
  buffer_load_dwordx4 v53, s[12:15], s80 offen lds
  s_add_u32 m0, s81, 6144
  s_nop 0
  buffer_load_dwordx4 v54, s[12:15], s80 offen lds
  s_add_u32 m0, s81, 7168
  s_nop 0
  buffer_load_dwordx4 v55, s[12:15], s80 offen lds
  s_add_u32 m0, s81, 8192
  s_nop 0
  buffer_load_dwordx4 v56, s[12:15], s80 offen lds
  s_add_u32 m0, s81, 9216
  s_nop 0
  buffer_load_dwordx4 v57, s[12:15], s80 offen lds
  s_add_u32 m0, s81, 10240
  s_nop 0
  buffer_load_dwordx4 v58, s[12:15], s80 offen lds
  s_add_u32 m0, s81, 11264
  s_nop 0
  buffer_load_dwordx4 v59, s[12:15], s80 offen lds
  s_add_u32 s80, s80, 393216
  s_add_u32 s21, s79, 0
  buffer_load_dwordx4 a[160:163], v63, s[24:27], s21 offen
  buffer_load_dwordx4 a[164:167], v64, s[24:27], s21 offen
  buffer_load_dwordx4 a[168:171], v65, s[24:27], s21 offen
  s_add_u32 s21, s79, 393216
  buffer_load_dwordx4 a[172:175], v63, s[24:27], s21 offen
  buffer_load_dwordx4 a[176:179], v64, s[24:27], s21 offen
  buffer_load_dwordx4 a[180:183], v65, s[24:27], s21 offen
  s_add_u32 s21, s79, 786432
  buffer_load_dwordx4 a[184:187], v63, s[24:27], s21 offen
  buffer_load_dwordx4 a[188:191], v64, s[24:27], s21 offen
  buffer_load_dwordx4 a[192:195], v65, s[24:27], s21 offen
  s_add_u32 s21, s79, 1179648
  buffer_load_dwordx4 a[196:199], v63, s[24:27], s21 offen
  buffer_load_dwordx4 a[200:203], v64, s[24:27], s21 offen
  buffer_load_dwordx4 a[204:207], v65, s[24:27], s21 offen
  s_add_u32 s21, s79, 1572864
  buffer_load_dwordx4 a[208:211], v63, s[24:27], s21 offen
  buffer_load_dwordx4 a[212:215], v64, s[24:27], s21 offen
  buffer_load_dwordx4 a[216:219], v65, s[24:27], s21 offen
  s_add_u32 s21, s79, 0
  buffer_load_dwordx4 a[220:223], v63, s[28:31], s21 offen
  buffer_load_dwordx4 a[224:227], v64, s[28:31], s21 offen
  buffer_load_dwordx4 a[228:231], v65, s[28:31], s21 offen
  s_add_u32 s21, s79, 393216
  buffer_load_dwordx4 a[232:235], v63, s[28:31], s21 offen
  buffer_load_dwordx4 a[236:239], v64, s[28:31], s21 offen
  buffer_load_dwordx4 a[240:243], v65, s[28:31], s21 offen
  s_add_u32 s21, s79, 786432
  buffer_load_dwordx4 a[244:247], v63, s[28:31], s21 offen
  buffer_load_dwordx4 a[248:251], v64, s[28:31], s21 offen
  buffer_load_dwordx4 a[252:255], v65, s[28:31], s21 offen
  s_add_u32 s21, s79, 1179648
  buffer_load_dwordx4 v[224:227], v63, s[28:31], s21 offen
  buffer_load_dwordx4 v[228:231], v64, s[28:31], s21 offen
  buffer_load_dwordx4 v[232:235], v65, s[28:31], s21 offen
  s_add_u32 s21, s79, 1572864
  buffer_load_dwordx4 v[236:239], v63, s[28:31], s21 offen
  buffer_load_dwordx4 v[240:243], v64, s[28:31], s21 offen
  buffer_load_dwordx4 v[244:247], v65, s[28:31], s21 offen
  ds_read_b128 v[208:211], v70 offset:24576
  ds_read_b128 v[212:215], v71 offset:24576
  ds_read_b128 v[216:219], v70 offset:24704
  s_waitcnt lgkmcnt(2)
  v_mfma_f32_16x16x32_bf16 v[184:187], v[208:211], v[72:75], 0
  ds_read_b128 v[220:223], v71 offset:24704
  v_mfma_f32_16x16x32_bf16 v[188:191], v[208:211], v[76:79], 0
  s_add_u32 m0, s81, 12288
  s_nop 0
  buffer_load_dwordx4 v48, s[12:15], s80 offen lds
  v_mfma_f32_16x16x32_bf16 v[192:195], v[208:211], v[80:83], 0
  s_waitcnt lgkmcnt(2)
  v_mfma_f32_16x16x32_bf16 v[184:187], v[212:215], v[84:87], v[184:187]
  ds_read_b128 v[208:211], v70 offset:24832
  v_mfma_f32_16x16x32_bf16 v[188:191], v[212:215], v[88:91], v[188:191]
  s_add_u32 m0, s81, 13312
  s_nop 0
  buffer_load_dwordx4 v49, s[12:15], s80 offen lds
  v_mfma_f32_16x16x32_bf16 v[192:195], v[212:215], v[92:95], v[192:195]
  s_waitcnt lgkmcnt(2)
  v_mfma_f32_16x16x32_bf16 v[184:187], v[216:219], v[96:99], v[184:187]
  ds_read_b128 v[212:215], v71 offset:24832
  v_mfma_f32_16x16x32_bf16 v[188:191], v[216:219], v[100:103], v[188:191]
  s_add_u32 m0, s81, 14336
  s_nop 0
  buffer_load_dwordx4 v50, s[12:15], s80 offen lds
  v_mfma_f32_16x16x32_bf16 v[192:195], v[216:219], v[104:107], v[192:195]
  s_waitcnt lgkmcnt(2)
  v_mfma_f32_16x16x32_bf16 v[184:187], v[220:223], v[108:111], v[184:187]
  ds_read_b128 v[216:219], v70 offset:25344
  v_mfma_f32_16x16x32_bf16 v[188:191], v[220:223], v[112:115], v[188:191]
  s_add_u32 m0, s81, 15360
  s_nop 0
  buffer_load_dwordx4 v51, s[12:15], s80 offen lds
  v_mfma_f32_16x16x32_bf16 v[192:195], v[220:223], v[116:119], v[192:195]
  s_waitcnt lgkmcnt(2)
  v_mfma_f32_16x16x32_bf16 v[184:187], v[208:211], v[120:123], v[184:187]
  ds_read_b128 v[220:223], v71 offset:25344
  v_mfma_f32_16x16x32_bf16 v[188:191], v[208:211], v[124:127], v[188:191]
  s_add_u32 m0, s81, 16384
  s_nop 0
  buffer_load_dwordx4 v52, s[12:15], s80 offen lds
  v_mfma_f32_16x16x32_bf16 v[192:195], v[208:211], v[128:131], v[192:195]
  s_waitcnt lgkmcnt(2)
  v_mfma_f32_16x16x32_bf16 v[184:187], v[212:215], v[132:135], v[184:187]
  ds_read_b128 v[208:211], v70 offset:25472
  v_mfma_f32_16x16x32_bf16 v[188:191], v[212:215], v[136:139], v[188:191]
  s_add_u32 m0, s81, 17408
  s_nop 0
  buffer_load_dwordx4 v53, s[12:15], s80 offen lds
  v_mfma_f32_16x16x32_bf16 v[192:195], v[212:215], v[140:143], v[192:195]
  s_waitcnt lgkmcnt(2)
  v_mfma_f32_16x16x32_bf16 v[196:199], v[216:219], v[72:75], 0
  ds_read_b128 v[212:215], v71 offset:25472
  v_mfma_f32_16x16x32_bf16 v[200:203], v[216:219], v[76:79], 0
  s_add_u32 m0, s81, 18432
  s_nop 0
  buffer_load_dwordx4 v54, s[12:15], s80 offen lds
  v_mfma_f32_16x16x32_bf16 v[204:207], v[216:219], v[80:83], 0
  s_waitcnt lgkmcnt(2)
  v_mfma_f32_16x16x32_bf16 v[196:199], v[220:223], v[84:87], v[196:199]
  ds_read_b128 v[216:219], v70 offset:25600
  v_cvt_pk_bf16_f32 v248, v184, v185
  v_mfma_f32_16x16x32_bf16 v[200:203], v[220:223], v[88:91], v[200:203]
  s_add_u32 m0, s81, 19456
  s_nop 0
  buffer_load_dwordx4 v55, s[12:15], s80 offen lds
  v_mfma_f32_16x16x32_bf16 v[204:207], v[220:223], v[92:95], v[204:207]
  v_cvt_pk_bf16_f32 v249, v186, v187
  s_waitcnt lgkmcnt(2)
  v_mfma_f32_16x16x32_bf16 v[196:199], v[208:211], v[96:99], v[196:199]
  ds_read_b128 v[220:223], v71 offset:25600
  v_cvt_pk_bf16_f32 v250, v188, v189
  v_mfma_f32_16x16x32_bf16 v[200:203], v[208:211], v[100:103], v[200:203]
  s_add_u32 m0, s81, 20480
  s_nop 0
  buffer_load_dwordx4 v56, s[12:15], s80 offen lds
  v_mfma_f32_16x16x32_bf16 v[204:207], v[208:211], v[104:107], v[204:207]
  v_cvt_pk_bf16_f32 v251, v190, v191
  s_waitcnt lgkmcnt(2)
  v_mfma_f32_16x16x32_bf16 v[196:199], v[212:215], v[108:111], v[196:199]
  v_accvgpr_write_b32 a0, v248
  v_mfma_f32_16x16x32_bf16 v[200:203], v[212:215], v[112:115], v[200:203]
  s_add_u32 m0, s81, 21504
  s_nop 0
  buffer_load_dwordx4 v57, s[12:15], s80 offen lds
  v_mfma_f32_16x16x32_bf16 v[204:207], v[212:215], v[116:119], v[204:207]
  v_accvgpr_write_b32 a1, v249
  s_waitcnt lgkmcnt(1)
  v_mfma_f32_16x16x32_bf16 v[196:199], v[216:219], v[120:123], v[196:199]
  v_accvgpr_write_b32 a80, v250
  v_mfma_f32_16x16x32_bf16 v[200:203], v[216:219], v[124:127], v[200:203]
  s_add_u32 m0, s81, 22528
  s_nop 0
  buffer_load_dwordx4 v58, s[12:15], s80 offen lds
  v_mfma_f32_16x16x32_bf16 v[204:207], v[216:219], v[128:131], v[204:207]
  v_accvgpr_write_b32 a81, v251
  s_waitcnt lgkmcnt(0)
  v_mfma_f32_16x16x32_bf16 v[196:199], v[220:223], v[132:135], v[196:199]
  v_cvt_pk_bf16_f32 v144, v192, v193
  v_cvt_pk_bf16_f32 v145, v194, v195
  v_mfma_f32_16x16x32_bf16 v[200:203], v[220:223], v[136:139], v[200:203]
  s_add_u32 m0, s81, 23552
  s_nop 0
  buffer_load_dwordx4 v59, s[12:15], s80 offen lds
  s_add_u32 s80, s80, 393216
  v_mfma_f32_16x16x32_bf16 v[204:207], v[220:223], v[140:143], v[204:207]
  s_waitcnt vmcnt(42)
  ds_read_b128 v[208:211], v70 offset:0
  ds_read_b128 v[212:215], v71 offset:0
  ds_read_b128 v[216:219], v70 offset:128
  s_waitcnt lgkmcnt(2)
  v_mfma_f32_16x16x32_bf16 v[184:187], v[208:211], v[72:75], 0
  ds_read_b128 v[220:223], v71 offset:128
  v_mfma_f32_16x16x32_bf16 v[188:191], v[208:211], v[76:79], 0
  s_add_u32 m0, s81, 24576
  s_nop 0
  buffer_load_dwordx4 v48, s[12:15], s80 offen lds
  v_mfma_f32_16x16x32_bf16 v[192:195], v[208:211], v[80:83], 0
  s_waitcnt lgkmcnt(2)
  v_mfma_f32_16x16x32_bf16 v[184:187], v[212:215], v[84:87], v[184:187]
  ds_read_b128 v[208:211], v70 offset:256
  v_cvt_pk_bf16_f32 v248, v196, v197
  v_mfma_f32_16x16x32_bf16 v[188:191], v[212:215], v[88:91], v[188:191]
  s_add_u32 m0, s81, 25600
  s_nop 0
  buffer_load_dwordx4 v49, s[12:15], s80 offen lds
  v_mfma_f32_16x16x32_bf16 v[192:195], v[212:215], v[92:95], v[192:195]
  v_cvt_pk_bf16_f32 v249, v198, v199
  s_waitcnt lgkmcnt(2)
  v_mfma_f32_16x16x32_bf16 v[184:187], v[216:219], v[96:99], v[184:187]
  ds_read_b128 v[212:215], v71 offset:256
  v_cvt_pk_bf16_f32 v250, v200, v201
  v_mfma_f32_16x16x32_bf16 v[188:191], v[216:219], v[100:103], v[188:191]
  s_add_u32 m0, s81, 26624
  s_nop 0
  buffer_load_dwordx4 v50, s[12:15], s80 offen lds
  v_mfma_f32_16x16x32_bf16 v[192:195], v[216:219], v[104:107], v[192:195]
  v_cvt_pk_bf16_f32 v251, v202, v203
  s_waitcnt lgkmcnt(2)
  v_mfma_f32_16x16x32_bf16 v[184:187], v[220:223], v[108:111], v[184:187]
  ds_read_b128 v[216:219], v70 offset:768
  v_accvgpr_write_b32 a2, v248
  v_mfma_f32_16x16x32_bf16 v[188:191], v[220:223], v[112:115], v[188:191]
  s_add_u32 m0, s81, 27648
  s_nop 0
  buffer_load_dwordx4 v51, s[12:15], s80 offen lds
  v_mfma_f32_16x16x32_bf16 v[192:195], v[220:223], v[116:119], v[192:195]
  v_accvgpr_write_b32 a3, v249
  s_waitcnt lgkmcnt(2)
  v_mfma_f32_16x16x32_bf16 v[184:187], v[208:211], v[120:123], v[184:187]
  ds_read_b128 v[220:223], v71 offset:768
  v_accvgpr_write_b32 a82, v250
  v_mfma_f32_16x16x32_bf16 v[188:191], v[208:211], v[124:127], v[188:191]
  s_add_u32 m0, s81, 28672
  s_nop 0
  buffer_load_dwordx4 v52, s[12:15], s80 offen lds
  v_mfma_f32_16x16x32_bf16 v[192:195], v[208:211], v[128:131], v[192:195]
  v_accvgpr_write_b32 a83, v251
  s_waitcnt lgkmcnt(2)
  v_mfma_f32_16x16x32_bf16 v[184:187], v[212:215], v[132:135], v[184:187]
  ds_read_b128 v[208:211], v70 offset:896
  s_mov_b64 exec, s[68:69]
  v_cvt_pk_bf16_f32 v144, v204, v205
  v_cvt_pk_bf16_f32 v145, v206, v207
  s_mov_b64 exec, -1
  v_mfma_f32_16x16x32_bf16 v[188:191], v[212:215], v[136:139], v[188:191]
  s_add_u32 m0, s81, 29696
  s_nop 0
  buffer_load_dwordx4 v53, s[12:15], s80 offen lds
  v_mfma_f32_16x16x32_bf16 v[192:195], v[212:215], v[140:143], v[192:195]
  s_waitcnt lgkmcnt(2)
  v_mfma_f32_16x16x32_bf16 v[196:199], v[216:219], v[72:75], 0
  ds_read_b128 v[212:215], v71 offset:896
  v_mfma_f32_16x16x32_bf16 v[200:203], v[216:219], v[76:79], 0
  s_add_u32 m0, s81, 30720
  s_nop 0
  buffer_load_dwordx4 v54, s[12:15], s80 offen lds
  v_mfma_f32_16x16x32_bf16 v[204:207], v[216:219], v[80:83], 0
  s_waitcnt lgkmcnt(2)
  v_mfma_f32_16x16x32_bf16 v[196:199], v[220:223], v[84:87], v[196:199]
  ds_read_b128 v[216:219], v70 offset:1024
  v_cvt_pk_bf16_f32 v248, v184, v185
  v_mfma_f32_16x16x32_bf16 v[200:203], v[220:223], v[88:91], v[200:203]
  s_add_u32 m0, s81, 31744
  s_nop 0
  buffer_load_dwordx4 v55, s[12:15], s80 offen lds
  v_mfma_f32_16x16x32_bf16 v[204:207], v[220:223], v[92:95], v[204:207]
  v_cvt_pk_bf16_f32 v249, v186, v187
  s_waitcnt lgkmcnt(2)
  v_mfma_f32_16x16x32_bf16 v[196:199], v[208:211], v[96:99], v[196:199]
  ds_read_b128 v[220:223], v71 offset:1024
  v_cvt_pk_bf16_f32 v250, v188, v189
  v_mfma_f32_16x16x32_bf16 v[200:203], v[208:211], v[100:103], v[200:203]
  s_add_u32 m0, s81, 32768
  s_nop 0
  buffer_load_dwordx4 v56, s[12:15], s80 offen lds
  v_mfma_f32_16x16x32_bf16 v[204:207], v[208:211], v[104:107], v[204:207]
  v_cvt_pk_bf16_f32 v251, v190, v191
  s_waitcnt lgkmcnt(2)
  v_mfma_f32_16x16x32_bf16 v[196:199], v[212:215], v[108:111], v[196:199]
  v_accvgpr_write_b32 a4, v248
  v_mfma_f32_16x16x32_bf16 v[200:203], v[212:215], v[112:115], v[200:203]
  s_add_u32 m0, s81, 33792
  s_nop 0
  buffer_load_dwordx4 v57, s[12:15], s80 offen lds
  v_mfma_f32_16x16x32_bf16 v[204:207], v[212:215], v[116:119], v[204:207]
  v_accvgpr_write_b32 a5, v249
  s_waitcnt lgkmcnt(1)
  v_mfma_f32_16x16x32_bf16 v[196:199], v[216:219], v[120:123], v[196:199]
  v_accvgpr_write_b32 a84, v250
  v_mfma_f32_16x16x32_bf16 v[200:203], v[216:219], v[124:127], v[200:203]
  s_add_u32 m0, s81, 34816
  s_nop 0
  buffer_load_dwordx4 v58, s[12:15], s80 offen lds
  v_mfma_f32_16x16x32_bf16 v[204:207], v[216:219], v[128:131], v[204:207]
  v_accvgpr_write_b32 a85, v251
  s_waitcnt lgkmcnt(0)
  v_mfma_f32_16x16x32_bf16 v[196:199], v[220:223], v[132:135], v[196:199]
  v_cvt_pk_bf16_f32 v146, v192, v193
  v_cvt_pk_bf16_f32 v147, v194, v195
  v_mfma_f32_16x16x32_bf16 v[200:203], v[220:223], v[136:139], v[200:203]
  s_add_u32 m0, s81, 35840
  s_nop 0
  buffer_load_dwordx4 v59, s[12:15], s80 offen lds
  s_add_u32 s80, s80, 393216
  v_mfma_f32_16x16x32_bf16 v[204:207], v[220:223], v[140:143], v[204:207]
  s_waitcnt vmcnt(12)
  ds_read_b128 v[208:211], v70 offset:12288
  ds_read_b128 v[212:215], v71 offset:12288
  ds_read_b128 v[216:219], v70 offset:12416
  s_waitcnt lgkmcnt(2)
  v_mfma_f32_16x16x32_bf16 v[184:187], v[208:211], v[72:75], 0
  ds_read_b128 v[220:223], v71 offset:12416
  v_mfma_f32_16x16x32_bf16 v[188:191], v[208:211], v[76:79], 0
  s_add_u32 m0, s81, 0
  s_nop 0
  buffer_load_dwordx4 v48, s[12:15], s80 offen lds
  v_mfma_f32_16x16x32_bf16 v[192:195], v[208:211], v[80:83], 0
  s_waitcnt lgkmcnt(2)
  v_mfma_f32_16x16x32_bf16 v[184:187], v[212:215], v[84:87], v[184:187]
  ds_read_b128 v[208:211], v70 offset:12544
  v_cvt_pk_bf16_f32 v248, v196, v197
  v_mfma_f32_16x16x32_bf16 v[188:191], v[212:215], v[88:91], v[188:191]
  s_add_u32 m0, s81, 1024
  s_nop 0
  buffer_load_dwordx4 v49, s[12:15], s80 offen lds
  v_mfma_f32_16x16x32_bf16 v[192:195], v[212:215], v[92:95], v[192:195]
  v_cvt_pk_bf16_f32 v249, v198, v199
  s_waitcnt lgkmcnt(2)
  v_mfma_f32_16x16x32_bf16 v[184:187], v[216:219], v[96:99], v[184:187]
  ds_read_b128 v[212:215], v71 offset:12544
  v_cvt_pk_bf16_f32 v250, v200, v201
  v_mfma_f32_16x16x32_bf16 v[188:191], v[216:219], v[100:103], v[188:191]
  s_add_u32 m0, s81, 2048
  s_nop 0
  buffer_load_dwordx4 v50, s[12:15], s80 offen lds
  v_mfma_f32_16x16x32_bf16 v[192:195], v[216:219], v[104:107], v[192:195]
  v_cvt_pk_bf16_f32 v251, v202, v203
  s_waitcnt lgkmcnt(2)
  v_mfma_f32_16x16x32_bf16 v[184:187], v[220:223], v[108:111], v[184:187]
  ds_read_b128 v[216:219], v70 offset:13056
  v_accvgpr_write_b32 a6, v248
  v_mfma_f32_16x16x32_bf16 v[188:191], v[220:223], v[112:115], v[188:191]
  s_add_u32 m0, s81, 3072
  s_nop 0
  buffer_load_dwordx4 v51, s[12:15], s80 offen lds
  v_mfma_f32_16x16x32_bf16 v[192:195], v[220:223], v[116:119], v[192:195]
  v_accvgpr_write_b32 a7, v249
  s_waitcnt lgkmcnt(2)
  v_mfma_f32_16x16x32_bf16 v[184:187], v[208:211], v[120:123], v[184:187]
  ds_read_b128 v[220:223], v71 offset:13056
  v_accvgpr_write_b32 a86, v250
  v_mfma_f32_16x16x32_bf16 v[188:191], v[208:211], v[124:127], v[188:191]
  s_add_u32 m0, s81, 4096
  s_nop 0
  buffer_load_dwordx4 v52, s[12:15], s80 offen lds
  v_mfma_f32_16x16x32_bf16 v[192:195], v[208:211], v[128:131], v[192:195]
  v_accvgpr_write_b32 a87, v251
  s_waitcnt lgkmcnt(2)
  v_mfma_f32_16x16x32_bf16 v[184:187], v[212:215], v[132:135], v[184:187]
  ds_read_b128 v[208:211], v70 offset:13184
  s_mov_b64 exec, s[68:69]
  v_cvt_pk_bf16_f32 v146, v204, v205
  v_cvt_pk_bf16_f32 v147, v206, v207
  s_mov_b64 exec, -1
  v_mfma_f32_16x16x32_bf16 v[188:191], v[212:215], v[136:139], v[188:191]
  s_add_u32 m0, s81, 5120
  s_nop 0
  buffer_load_dwordx4 v53, s[12:15], s80 offen lds
  v_mfma_f32_16x16x32_bf16 v[192:195], v[212:215], v[140:143], v[192:195]
  s_waitcnt lgkmcnt(2)
  v_mfma_f32_16x16x32_bf16 v[196:199], v[216:219], v[72:75], 0
  ds_read_b128 v[212:215], v71 offset:13184
  v_mfma_f32_16x16x32_bf16 v[200:203], v[216:219], v[76:79], 0
  s_add_u32 m0, s81, 6144
  s_nop 0
  buffer_load_dwordx4 v54, s[12:15], s80 offen lds
  v_mfma_f32_16x16x32_bf16 v[204:207], v[216:219], v[80:83], 0
  s_waitcnt lgkmcnt(2)
  v_mfma_f32_16x16x32_bf16 v[196:199], v[220:223], v[84:87], v[196:199]
  ds_read_b128 v[216:219], v70 offset:13312
  v_cvt_pk_bf16_f32 v248, v184, v185
  v_mfma_f32_16x16x32_bf16 v[200:203], v[220:223], v[88:91], v[200:203]
  s_add_u32 m0, s81, 7168
  s_nop 0
  buffer_load_dwordx4 v55, s[12:15], s80 offen lds
  v_mfma_f32_16x16x32_bf16 v[204:207], v[220:223], v[92:95], v[204:207]
  v_cvt_pk_bf16_f32 v249, v186, v187
  s_waitcnt lgkmcnt(2)
  v_mfma_f32_16x16x32_bf16 v[196:199], v[208:211], v[96:99], v[196:199]
  ds_read_b128 v[220:223], v71 offset:13312
  v_cvt_pk_bf16_f32 v250, v188, v189
  v_mfma_f32_16x16x32_bf16 v[200:203], v[208:211], v[100:103], v[200:203]
  s_add_u32 m0, s81, 8192
  s_nop 0
  buffer_load_dwordx4 v56, s[12:15], s80 offen lds
  v_mfma_f32_16x16x32_bf16 v[204:207], v[208:211], v[104:107], v[204:207]
  v_cvt_pk_bf16_f32 v251, v190, v191
  s_waitcnt lgkmcnt(2)
  v_mfma_f32_16x16x32_bf16 v[196:199], v[212:215], v[108:111], v[196:199]
  v_accvgpr_write_b32 a8, v248
  v_mfma_f32_16x16x32_bf16 v[200:203], v[212:215], v[112:115], v[200:203]
  s_add_u32 m0, s81, 9216
  s_nop 0
  buffer_load_dwordx4 v57, s[12:15], s80 offen lds
  v_mfma_f32_16x16x32_bf16 v[204:207], v[212:215], v[116:119], v[204:207]
  v_accvgpr_write_b32 a9, v249
  s_waitcnt lgkmcnt(1)
  v_mfma_f32_16x16x32_bf16 v[196:199], v[216:219], v[120:123], v[196:199]
  v_accvgpr_write_b32 a88, v250
  v_mfma_f32_16x16x32_bf16 v[200:203], v[216:219], v[124:127], v[200:203]
  s_add_u32 m0, s81, 10240
  s_nop 0
  buffer_load_dwordx4 v58, s[12:15], s80 offen lds
  v_mfma_f32_16x16x32_bf16 v[204:207], v[216:219], v[128:131], v[204:207]
  v_accvgpr_write_b32 a89, v251
  s_waitcnt lgkmcnt(0)
  v_mfma_f32_16x16x32_bf16 v[196:199], v[220:223], v[132:135], v[196:199]
  v_cvt_pk_bf16_f32 v148, v192, v193
  v_cvt_pk_bf16_f32 v149, v194, v195
  v_mfma_f32_16x16x32_bf16 v[200:203], v[220:223], v[136:139], v[200:203]
  s_add_u32 m0, s81, 11264
  s_nop 0
  buffer_load_dwordx4 v59, s[12:15], s80 offen lds
  s_add_u32 s80, s80, 393216
  v_mfma_f32_16x16x32_bf16 v[204:207], v[220:223], v[140:143], v[204:207]
  s_waitcnt vmcnt(12)
  ds_read_b128 v[208:211], v70 offset:24576
  ds_read_b128 v[212:215], v71 offset:24576
  ds_read_b128 v[216:219], v70 offset:24704
  s_waitcnt lgkmcnt(2)
  v_mfma_f32_16x16x32_bf16 v[184:187], v[208:211], v[72:75], 0
  ds_read_b128 v[220:223], v71 offset:24704
  v_mfma_f32_16x16x32_bf16 v[188:191], v[208:211], v[76:79], 0
  s_add_u32 m0, s81, 12288
  s_nop 0
  buffer_load_dwordx4 v48, s[12:15], s80 offen lds
  v_mfma_f32_16x16x32_bf16 v[192:195], v[208:211], v[80:83], 0
  s_waitcnt lgkmcnt(2)
  v_mfma_f32_16x16x32_bf16 v[184:187], v[212:215], v[84:87], v[184:187]
  ds_read_b128 v[208:211], v70 offset:24832
  v_cvt_pk_bf16_f32 v248, v196, v197
  v_mfma_f32_16x16x32_bf16 v[188:191], v[212:215], v[88:91], v[188:191]
  s_add_u32 m0, s81, 13312
  s_nop 0
  buffer_load_dwordx4 v49, s[12:15], s80 offen lds
  v_mfma_f32_16x16x32_bf16 v[192:195], v[212:215], v[92:95], v[192:195]
  v_cvt_pk_bf16_f32 v249, v198, v199
  s_waitcnt lgkmcnt(2)
  v_mfma_f32_16x16x32_bf16 v[184:187], v[216:219], v[96:99], v[184:187]
  ds_read_b128 v[212:215], v71 offset:24832
  v_cvt_pk_bf16_f32 v250, v200, v201
  v_mfma_f32_16x16x32_bf16 v[188:191], v[216:219], v[100:103], v[188:191]
  s_add_u32 m0, s81, 14336
  s_nop 0
  buffer_load_dwordx4 v50, s[12:15], s80 offen lds
  v_mfma_f32_16x16x32_bf16 v[192:195], v[216:219], v[104:107], v[192:195]
  v_cvt_pk_bf16_f32 v251, v202, v203
  s_waitcnt lgkmcnt(2)
  v_mfma_f32_16x16x32_bf16 v[184:187], v[220:223], v[108:111], v[184:187]
  ds_read_b128 v[216:219], v70 offset:25344
  v_accvgpr_write_b32 a10, v248
  v_mfma_f32_16x16x32_bf16 v[188:191], v[220:223], v[112:115], v[188:191]
  s_add_u32 m0, s81, 15360
  s_nop 0
  buffer_load_dwordx4 v51, s[12:15], s80 offen lds
  v_mfma_f32_16x16x32_bf16 v[192:195], v[220:223], v[116:119], v[192:195]
  v_accvgpr_write_b32 a11, v249
  s_waitcnt lgkmcnt(2)
  v_mfma_f32_16x16x32_bf16 v[184:187], v[208:211], v[120:123], v[184:187]
  ds_read_b128 v[220:223], v71 offset:25344
  v_accvgpr_write_b32 a90, v250
  v_mfma_f32_16x16x32_bf16 v[188:191], v[208:211], v[124:127], v[188:191]
  s_add_u32 m0, s81, 16384
  s_nop 0
  buffer_load_dwordx4 v52, s[12:15], s80 offen lds
  v_mfma_f32_16x16x32_bf16 v[192:195], v[208:211], v[128:131], v[192:195]
  v_accvgpr_write_b32 a91, v251
  s_waitcnt lgkmcnt(2)
  v_mfma_f32_16x16x32_bf16 v[184:187], v[212:215], v[132:135], v[184:187]
  ds_read_b128 v[208:211], v70 offset:25472
  s_mov_b64 exec, s[68:69]
  v_cvt_pk_bf16_f32 v148, v204, v205
  v_cvt_pk_bf16_f32 v149, v206, v207
  s_mov_b64 exec, -1
  v_mfma_f32_16x16x32_bf16 v[188:191], v[212:215], v[136:139], v[188:191]
  s_add_u32 m0, s81, 17408
  s_nop 0
  buffer_load_dwordx4 v53, s[12:15], s80 offen lds
  v_mfma_f32_16x16x32_bf16 v[192:195], v[212:215], v[140:143], v[192:195]
  s_waitcnt lgkmcnt(2)
  v_mfma_f32_16x16x32_bf16 v[196:199], v[216:219], v[72:75], 0
  ds_read_b128 v[212:215], v71 offset:25472
  v_mfma_f32_16x16x32_bf16 v[200:203], v[216:219], v[76:79], 0
  s_add_u32 m0, s81, 18432
  s_nop 0
  buffer_load_dwordx4 v54, s[12:15], s80 offen lds
  v_mfma_f32_16x16x32_bf16 v[204:207], v[216:219], v[80:83], 0
  s_waitcnt lgkmcnt(2)
  v_mfma_f32_16x16x32_bf16 v[196:199], v[220:223], v[84:87], v[196:199]
  ds_read_b128 v[216:219], v70 offset:25600
  v_cvt_pk_bf16_f32 v248, v184, v185
  v_mfma_f32_16x16x32_bf16 v[200:203], v[220:223], v[88:91], v[200:203]
  s_add_u32 m0, s81, 19456
  s_nop 0
  buffer_load_dwordx4 v55, s[12:15], s80 offen lds
  v_mfma_f32_16x16x32_bf16 v[204:207], v[220:223], v[92:95], v[204:207]
  v_cvt_pk_bf16_f32 v249, v186, v187
  s_waitcnt lgkmcnt(2)
  v_mfma_f32_16x16x32_bf16 v[196:199], v[208:211], v[96:99], v[196:199]
  ds_read_b128 v[220:223], v71 offset:25600
  v_cvt_pk_bf16_f32 v250, v188, v189
  v_mfma_f32_16x16x32_bf16 v[200:203], v[208:211], v[100:103], v[200:203]
  s_add_u32 m0, s81, 20480
  s_nop 0
  buffer_load_dwordx4 v56, s[12:15], s80 offen lds
  v_mfma_f32_16x16x32_bf16 v[204:207], v[208:211], v[104:107], v[204:207]
  v_cvt_pk_bf16_f32 v251, v190, v191
  s_waitcnt lgkmcnt(2)
  v_mfma_f32_16x16x32_bf16 v[196:199], v[212:215], v[108:111], v[196:199]
  v_accvgpr_write_b32 a12, v248
  v_mfma_f32_16x16x32_bf16 v[200:203], v[212:215], v[112:115], v[200:203]
  s_add_u32 m0, s81, 21504
  s_nop 0
  buffer_load_dwordx4 v57, s[12:15], s80 offen lds
  v_mfma_f32_16x16x32_bf16 v[204:207], v[212:215], v[116:119], v[204:207]
  v_accvgpr_write_b32 a13, v249
  s_waitcnt lgkmcnt(1)
  v_mfma_f32_16x16x32_bf16 v[196:199], v[216:219], v[120:123], v[196:199]
  v_accvgpr_write_b32 a92, v250
  v_mfma_f32_16x16x32_bf16 v[200:203], v[216:219], v[124:127], v[200:203]
  s_add_u32 m0, s81, 22528
  s_nop 0
  buffer_load_dwordx4 v58, s[12:15], s80 offen lds
  v_mfma_f32_16x16x32_bf16 v[204:207], v[216:219], v[128:131], v[204:207]
  v_accvgpr_write_b32 a93, v251
  s_waitcnt lgkmcnt(0)
  v_mfma_f32_16x16x32_bf16 v[196:199], v[220:223], v[132:135], v[196:199]
  v_cvt_pk_bf16_f32 v150, v192, v193
  v_cvt_pk_bf16_f32 v151, v194, v195
  v_mfma_f32_16x16x32_bf16 v[200:203], v[220:223], v[136:139], v[200:203]
  s_add_u32 m0, s81, 23552
  s_nop 0
  buffer_load_dwordx4 v59, s[12:15], s80 offen lds
  s_add_u32 s80, s80, 393216
  v_mfma_f32_16x16x32_bf16 v[204:207], v[220:223], v[140:143], v[204:207]
  s_waitcnt vmcnt(12)
  ds_read_b128 v[208:211], v70 offset:0
  ds_read_b128 v[212:215], v71 offset:0
  ds_read_b128 v[216:219], v70 offset:128
  s_waitcnt lgkmcnt(2)
  v_mfma_f32_16x16x32_bf16 v[184:187], v[208:211], v[72:75], 0
  ds_read_b128 v[220:223], v71 offset:128
  v_mfma_f32_16x16x32_bf16 v[188:191], v[208:211], v[76:79], 0
  s_add_u32 m0, s81, 24576
  s_nop 0
  buffer_load_dwordx4 v48, s[12:15], s80 offen lds
  v_mfma_f32_16x16x32_bf16 v[192:195], v[208:211], v[80:83], 0
  s_waitcnt lgkmcnt(2)
  v_mfma_f32_16x16x32_bf16 v[184:187], v[212:215], v[84:87], v[184:187]
  ds_read_b128 v[208:211], v70 offset:256
  v_cvt_pk_bf16_f32 v248, v196, v197
  v_mfma_f32_16x16x32_bf16 v[188:191], v[212:215], v[88:91], v[188:191]
  s_add_u32 m0, s81, 25600
  s_nop 0
  buffer_load_dwordx4 v49, s[12:15], s80 offen lds
  v_mfma_f32_16x16x32_bf16 v[192:195], v[212:215], v[92:95], v[192:195]
  v_cvt_pk_bf16_f32 v249, v198, v199
  s_waitcnt lgkmcnt(2)
  v_mfma_f32_16x16x32_bf16 v[184:187], v[216:219], v[96:99], v[184:187]
  ds_read_b128 v[212:215], v71 offset:256
  v_cvt_pk_bf16_f32 v250, v200, v201
  v_mfma_f32_16x16x32_bf16 v[188:191], v[216:219], v[100:103], v[188:191]
  s_add_u32 m0, s81, 26624
  s_nop 0
  buffer_load_dwordx4 v50, s[12:15], s80 offen lds
  v_mfma_f32_16x16x32_bf16 v[192:195], v[216:219], v[104:107], v[192:195]
  v_cvt_pk_bf16_f32 v251, v202, v203
  s_waitcnt lgkmcnt(2)
  v_mfma_f32_16x16x32_bf16 v[184:187], v[220:223], v[108:111], v[184:187]
  ds_read_b128 v[216:219], v70 offset:768
  v_accvgpr_write_b32 a14, v248
  v_mfma_f32_16x16x32_bf16 v[188:191], v[220:223], v[112:115], v[188:191]
  s_add_u32 m0, s81, 27648
  s_nop 0
  buffer_load_dwordx4 v51, s[12:15], s80 offen lds
  v_mfma_f32_16x16x32_bf16 v[192:195], v[220:223], v[116:119], v[192:195]
  v_accvgpr_write_b32 a15, v249
  s_waitcnt lgkmcnt(2)
  v_mfma_f32_16x16x32_bf16 v[184:187], v[208:211], v[120:123], v[184:187]
  ds_read_b128 v[220:223], v71 offset:768
  v_accvgpr_write_b32 a94, v250
  v_mfma_f32_16x16x32_bf16 v[188:191], v[208:211], v[124:127], v[188:191]
  s_add_u32 m0, s81, 28672
  s_nop 0
  buffer_load_dwordx4 v52, s[12:15], s80 offen lds
  v_mfma_f32_16x16x32_bf16 v[192:195], v[208:211], v[128:131], v[192:195]
  v_accvgpr_write_b32 a95, v251
  s_waitcnt lgkmcnt(2)
  v_mfma_f32_16x16x32_bf16 v[184:187], v[212:215], v[132:135], v[184:187]
  ds_read_b128 v[208:211], v70 offset:896
  s_mov_b64 exec, s[68:69]
  v_cvt_pk_bf16_f32 v150, v204, v205
  v_cvt_pk_bf16_f32 v151, v206, v207
  s_mov_b64 exec, -1
  v_mfma_f32_16x16x32_bf16 v[188:191], v[212:215], v[136:139], v[188:191]
  s_add_u32 m0, s81, 29696
  s_nop 0
  buffer_load_dwordx4 v53, s[12:15], s80 offen lds
  v_mfma_f32_16x16x32_bf16 v[192:195], v[212:215], v[140:143], v[192:195]
  s_waitcnt lgkmcnt(2)
  v_mfma_f32_16x16x32_bf16 v[196:199], v[216:219], v[72:75], 0
  ds_read_b128 v[212:215], v71 offset:896
  v_mfma_f32_16x16x32_bf16 v[200:203], v[216:219], v[76:79], 0
  s_add_u32 m0, s81, 30720
  s_nop 0
  buffer_load_dwordx4 v54, s[12:15], s80 offen lds
  v_mfma_f32_16x16x32_bf16 v[204:207], v[216:219], v[80:83], 0
  s_waitcnt lgkmcnt(2)
  v_mfma_f32_16x16x32_bf16 v[196:199], v[220:223], v[84:87], v[196:199]
  ds_read_b128 v[216:219], v70 offset:1024
  v_cvt_pk_bf16_f32 v248, v184, v185
  v_mfma_f32_16x16x32_bf16 v[200:203], v[220:223], v[88:91], v[200:203]
  s_add_u32 m0, s81, 31744
  s_nop 0
  buffer_load_dwordx4 v55, s[12:15], s80 offen lds
  v_mfma_f32_16x16x32_bf16 v[204:207], v[220:223], v[92:95], v[204:207]
  v_cvt_pk_bf16_f32 v249, v186, v187
  s_waitcnt lgkmcnt(2)
  v_mfma_f32_16x16x32_bf16 v[196:199], v[208:211], v[96:99], v[196:199]
  ds_read_b128 v[220:223], v71 offset:1024
  v_cvt_pk_bf16_f32 v250, v188, v189
  v_mfma_f32_16x16x32_bf16 v[200:203], v[208:211], v[100:103], v[200:203]
  s_add_u32 m0, s81, 32768
  s_nop 0
  buffer_load_dwordx4 v56, s[12:15], s80 offen lds
  v_mfma_f32_16x16x32_bf16 v[204:207], v[208:211], v[104:107], v[204:207]
  v_cvt_pk_bf16_f32 v251, v190, v191
  s_waitcnt lgkmcnt(2)
  v_mfma_f32_16x16x32_bf16 v[196:199], v[212:215], v[108:111], v[196:199]
  v_accvgpr_write_b32 a16, v248
  v_mfma_f32_16x16x32_bf16 v[200:203], v[212:215], v[112:115], v[200:203]
  s_add_u32 m0, s81, 33792
  s_nop 0
  buffer_load_dwordx4 v57, s[12:15], s80 offen lds
  v_mfma_f32_16x16x32_bf16 v[204:207], v[212:215], v[116:119], v[204:207]
  v_accvgpr_write_b32 a17, v249
  s_waitcnt lgkmcnt(1)
  v_mfma_f32_16x16x32_bf16 v[196:199], v[216:219], v[120:123], v[196:199]
  v_accvgpr_write_b32 a96, v250
  v_mfma_f32_16x16x32_bf16 v[200:203], v[216:219], v[124:127], v[200:203]
  s_add_u32 m0, s81, 34816
  s_nop 0
  buffer_load_dwordx4 v58, s[12:15], s80 offen lds
  v_mfma_f32_16x16x32_bf16 v[204:207], v[216:219], v[128:131], v[204:207]
  v_accvgpr_write_b32 a97, v251
  s_waitcnt lgkmcnt(0)
  v_mfma_f32_16x16x32_bf16 v[196:199], v[220:223], v[132:135], v[196:199]
  v_cvt_pk_bf16_f32 v152, v192, v193
  v_cvt_pk_bf16_f32 v153, v194, v195
  v_mfma_f32_16x16x32_bf16 v[200:203], v[220:223], v[136:139], v[200:203]
  s_add_u32 m0, s81, 35840
  s_nop 0
  buffer_load_dwordx4 v59, s[12:15], s80 offen lds
  s_add_u32 s80, s80, 393216
  v_mfma_f32_16x16x32_bf16 v[204:207], v[220:223], v[140:143], v[204:207]
  s_waitcnt vmcnt(12)
  ds_read_b128 v[208:211], v70 offset:12288
  ds_read_b128 v[212:215], v71 offset:12288
  ds_read_b128 v[216:219], v70 offset:12416
  s_waitcnt lgkmcnt(2)
  v_mfma_f32_16x16x32_bf16 v[184:187], v[208:211], v[72:75], 0
  ds_read_b128 v[220:223], v71 offset:12416
  v_mfma_f32_16x16x32_bf16 v[188:191], v[208:211], v[76:79], 0
  s_add_u32 m0, s81, 0
  s_nop 0
  buffer_load_dwordx4 v48, s[12:15], s80 offen lds
  v_mfma_f32_16x16x32_bf16 v[192:195], v[208:211], v[80:83], 0
  s_waitcnt lgkmcnt(2)
  v_mfma_f32_16x16x32_bf16 v[184:187], v[212:215], v[84:87], v[184:187]
  ds_read_b128 v[208:211], v70 offset:12544
  v_cvt_pk_bf16_f32 v248, v196, v197
  v_mfma_f32_16x16x32_bf16 v[188:191], v[212:215], v[88:91], v[188:191]
  s_add_u32 m0, s81, 1024
  s_nop 0
  buffer_load_dwordx4 v49, s[12:15], s80 offen lds
  v_mfma_f32_16x16x32_bf16 v[192:195], v[212:215], v[92:95], v[192:195]
  v_cvt_pk_bf16_f32 v249, v198, v199
  s_waitcnt lgkmcnt(2)
  v_mfma_f32_16x16x32_bf16 v[184:187], v[216:219], v[96:99], v[184:187]
  ds_read_b128 v[212:215], v71 offset:12544
  v_cvt_pk_bf16_f32 v250, v200, v201
  v_mfma_f32_16x16x32_bf16 v[188:191], v[216:219], v[100:103], v[188:191]
  s_add_u32 m0, s81, 2048
  s_nop 0
  buffer_load_dwordx4 v50, s[12:15], s80 offen lds
  v_mfma_f32_16x16x32_bf16 v[192:195], v[216:219], v[104:107], v[192:195]
  v_cvt_pk_bf16_f32 v251, v202, v203
  s_waitcnt lgkmcnt(2)
  v_mfma_f32_16x16x32_bf16 v[184:187], v[220:223], v[108:111], v[184:187]
  ds_read_b128 v[216:219], v70 offset:13056
  v_accvgpr_write_b32 a18, v248
  v_mfma_f32_16x16x32_bf16 v[188:191], v[220:223], v[112:115], v[188:191]
  s_add_u32 m0, s81, 3072
  s_nop 0
  buffer_load_dwordx4 v51, s[12:15], s80 offen lds
  v_mfma_f32_16x16x32_bf16 v[192:195], v[220:223], v[116:119], v[192:195]
  v_accvgpr_write_b32 a19, v249
  s_waitcnt lgkmcnt(2)
  v_mfma_f32_16x16x32_bf16 v[184:187], v[208:211], v[120:123], v[184:187]
  ds_read_b128 v[220:223], v71 offset:13056
  v_accvgpr_write_b32 a98, v250
  v_mfma_f32_16x16x32_bf16 v[188:191], v[208:211], v[124:127], v[188:191]
  s_add_u32 m0, s81, 4096
  s_nop 0
  buffer_load_dwordx4 v52, s[12:15], s80 offen lds
  v_mfma_f32_16x16x32_bf16 v[192:195], v[208:211], v[128:131], v[192:195]
  v_accvgpr_write_b32 a99, v251
  s_waitcnt lgkmcnt(2)
  v_mfma_f32_16x16x32_bf16 v[184:187], v[212:215], v[132:135], v[184:187]
  ds_read_b128 v[208:211], v70 offset:13184
  s_mov_b64 exec, s[68:69]
  v_cvt_pk_bf16_f32 v152, v204, v205
  v_cvt_pk_bf16_f32 v153, v206, v207
  s_mov_b64 exec, -1
  v_mfma_f32_16x16x32_bf16 v[188:191], v[212:215], v[136:139], v[188:191]
  s_add_u32 m0, s81, 5120
  s_nop 0
  buffer_load_dwordx4 v53, s[12:15], s80 offen lds
  v_mfma_f32_16x16x32_bf16 v[192:195], v[212:215], v[140:143], v[192:195]
  s_waitcnt lgkmcnt(2)
  v_mfma_f32_16x16x32_bf16 v[196:199], v[216:219], v[72:75], 0
  ds_read_b128 v[212:215], v71 offset:13184
  v_mfma_f32_16x16x32_bf16 v[200:203], v[216:219], v[76:79], 0
  s_add_u32 m0, s81, 6144
  s_nop 0
  buffer_load_dwordx4 v54, s[12:15], s80 offen lds
  v_mfma_f32_16x16x32_bf16 v[204:207], v[216:219], v[80:83], 0
  s_waitcnt lgkmcnt(2)
  v_mfma_f32_16x16x32_bf16 v[196:199], v[220:223], v[84:87], v[196:199]
  ds_read_b128 v[216:219], v70 offset:13312
  v_cvt_pk_bf16_f32 v248, v184, v185
  v_mfma_f32_16x16x32_bf16 v[200:203], v[220:223], v[88:91], v[200:203]
  s_add_u32 m0, s81, 7168
  s_nop 0
  buffer_load_dwordx4 v55, s[12:15], s80 offen lds
  v_mfma_f32_16x16x32_bf16 v[204:207], v[220:223], v[92:95], v[204:207]
  v_cvt_pk_bf16_f32 v249, v186, v187
  s_waitcnt lgkmcnt(2)
  v_mfma_f32_16x16x32_bf16 v[196:199], v[208:211], v[96:99], v[196:199]
  ds_read_b128 v[220:223], v71 offset:13312
  v_cvt_pk_bf16_f32 v250, v188, v189
  v_mfma_f32_16x16x32_bf16 v[200:203], v[208:211], v[100:103], v[200:203]
  s_add_u32 m0, s81, 8192
  s_nop 0
  buffer_load_dwordx4 v56, s[12:15], s80 offen lds
  v_mfma_f32_16x16x32_bf16 v[204:207], v[208:211], v[104:107], v[204:207]
  v_cvt_pk_bf16_f32 v251, v190, v191
  s_waitcnt lgkmcnt(2)
  v_mfma_f32_16x16x32_bf16 v[196:199], v[212:215], v[108:111], v[196:199]
  v_accvgpr_write_b32 a20, v248
  v_mfma_f32_16x16x32_bf16 v[200:203], v[212:215], v[112:115], v[200:203]
  s_add_u32 m0, s81, 9216
  s_nop 0
  buffer_load_dwordx4 v57, s[12:15], s80 offen lds
  v_mfma_f32_16x16x32_bf16 v[204:207], v[212:215], v[116:119], v[204:207]
  v_accvgpr_write_b32 a21, v249
  s_waitcnt lgkmcnt(1)
  v_mfma_f32_16x16x32_bf16 v[196:199], v[216:219], v[120:123], v[196:199]
  v_accvgpr_write_b32 a100, v250
  v_mfma_f32_16x16x32_bf16 v[200:203], v[216:219], v[124:127], v[200:203]
  s_add_u32 m0, s81, 10240
  s_nop 0
  buffer_load_dwordx4 v58, s[12:15], s80 offen lds
  v_mfma_f32_16x16x32_bf16 v[204:207], v[216:219], v[128:131], v[204:207]
  v_accvgpr_write_b32 a101, v251
  s_waitcnt lgkmcnt(0)
  v_mfma_f32_16x16x32_bf16 v[196:199], v[220:223], v[132:135], v[196:199]
  v_cvt_pk_bf16_f32 v154, v192, v193
  v_cvt_pk_bf16_f32 v155, v194, v195
  v_mfma_f32_16x16x32_bf16 v[200:203], v[220:223], v[136:139], v[200:203]
  s_add_u32 m0, s81, 11264
  s_nop 0
  buffer_load_dwordx4 v59, s[12:15], s80 offen lds
  s_add_u32 s80, s80, 393216
  v_mfma_f32_16x16x32_bf16 v[204:207], v[220:223], v[140:143], v[204:207]
  s_waitcnt vmcnt(12)
  ds_read_b128 v[208:211], v70 offset:24576
  ds_read_b128 v[212:215], v71 offset:24576
  ds_read_b128 v[216:219], v70 offset:24704
  s_waitcnt lgkmcnt(2)
  v_mfma_f32_16x16x32_bf16 v[184:187], v[208:211], v[72:75], 0
  ds_read_b128 v[220:223], v71 offset:24704
  v_mfma_f32_16x16x32_bf16 v[188:191], v[208:211], v[76:79], 0
  s_add_u32 m0, s81, 12288
  s_nop 0
  buffer_load_dwordx4 v48, s[12:15], s80 offen lds
  v_mfma_f32_16x16x32_bf16 v[192:195], v[208:211], v[80:83], 0
  s_waitcnt lgkmcnt(2)
  v_mfma_f32_16x16x32_bf16 v[184:187], v[212:215], v[84:87], v[184:187]
  ds_read_b128 v[208:211], v70 offset:24832
  v_cvt_pk_bf16_f32 v248, v196, v197
  v_mfma_f32_16x16x32_bf16 v[188:191], v[212:215], v[88:91], v[188:191]
  s_add_u32 m0, s81, 13312
  s_nop 0
  buffer_load_dwordx4 v49, s[12:15], s80 offen lds
  v_mfma_f32_16x16x32_bf16 v[192:195], v[212:215], v[92:95], v[192:195]
  v_cvt_pk_bf16_f32 v249, v198, v199
  s_waitcnt lgkmcnt(2)
  v_mfma_f32_16x16x32_bf16 v[184:187], v[216:219], v[96:99], v[184:187]
  ds_read_b128 v[212:215], v71 offset:24832
  v_cvt_pk_bf16_f32 v250, v200, v201
  v_mfma_f32_16x16x32_bf16 v[188:191], v[216:219], v[100:103], v[188:191]
  s_add_u32 m0, s81, 14336
  s_nop 0
  buffer_load_dwordx4 v50, s[12:15], s80 offen lds
  v_mfma_f32_16x16x32_bf16 v[192:195], v[216:219], v[104:107], v[192:195]
  v_cvt_pk_bf16_f32 v251, v202, v203
  s_waitcnt lgkmcnt(2)
  v_mfma_f32_16x16x32_bf16 v[184:187], v[220:223], v[108:111], v[184:187]
  ds_read_b128 v[216:219], v70 offset:25344
  v_accvgpr_write_b32 a22, v248
  v_mfma_f32_16x16x32_bf16 v[188:191], v[220:223], v[112:115], v[188:191]
  s_add_u32 m0, s81, 15360
  s_nop 0
  buffer_load_dwordx4 v51, s[12:15], s80 offen lds
  v_mfma_f32_16x16x32_bf16 v[192:195], v[220:223], v[116:119], v[192:195]
  v_accvgpr_write_b32 a23, v249
  s_waitcnt lgkmcnt(2)
  v_mfma_f32_16x16x32_bf16 v[184:187], v[208:211], v[120:123], v[184:187]
  ds_read_b128 v[220:223], v71 offset:25344
  v_accvgpr_write_b32 a102, v250
  v_mfma_f32_16x16x32_bf16 v[188:191], v[208:211], v[124:127], v[188:191]
  s_add_u32 m0, s81, 16384
  s_nop 0
  buffer_load_dwordx4 v52, s[12:15], s80 offen lds
  v_mfma_f32_16x16x32_bf16 v[192:195], v[208:211], v[128:131], v[192:195]
  v_accvgpr_write_b32 a103, v251
  s_waitcnt lgkmcnt(2)
  v_mfma_f32_16x16x32_bf16 v[184:187], v[212:215], v[132:135], v[184:187]
  ds_read_b128 v[208:211], v70 offset:25472
  s_mov_b64 exec, s[68:69]
  v_cvt_pk_bf16_f32 v154, v204, v205
  v_cvt_pk_bf16_f32 v155, v206, v207
  s_mov_b64 exec, -1
  v_mfma_f32_16x16x32_bf16 v[188:191], v[212:215], v[136:139], v[188:191]
  s_add_u32 m0, s81, 17408
  s_nop 0
  buffer_load_dwordx4 v53, s[12:15], s80 offen lds
  v_mfma_f32_16x16x32_bf16 v[192:195], v[212:215], v[140:143], v[192:195]
  s_waitcnt lgkmcnt(2)
  v_mfma_f32_16x16x32_bf16 v[196:199], v[216:219], v[72:75], 0
  ds_read_b128 v[212:215], v71 offset:25472
  v_mfma_f32_16x16x32_bf16 v[200:203], v[216:219], v[76:79], 0
  s_add_u32 m0, s81, 18432
  s_nop 0
  buffer_load_dwordx4 v54, s[12:15], s80 offen lds
  v_mfma_f32_16x16x32_bf16 v[204:207], v[216:219], v[80:83], 0
  s_waitcnt lgkmcnt(2)
  v_mfma_f32_16x16x32_bf16 v[196:199], v[220:223], v[84:87], v[196:199]
  ds_read_b128 v[216:219], v70 offset:25600
  v_cvt_pk_bf16_f32 v248, v184, v185
  v_mfma_f32_16x16x32_bf16 v[200:203], v[220:223], v[88:91], v[200:203]
  s_add_u32 m0, s81, 19456
  s_nop 0
  buffer_load_dwordx4 v55, s[12:15], s80 offen lds
  v_mfma_f32_16x16x32_bf16 v[204:207], v[220:223], v[92:95], v[204:207]
  v_cvt_pk_bf16_f32 v249, v186, v187
  s_waitcnt lgkmcnt(2)
  v_mfma_f32_16x16x32_bf16 v[196:199], v[208:211], v[96:99], v[196:199]
  ds_read_b128 v[220:223], v71 offset:25600
  v_cvt_pk_bf16_f32 v250, v188, v189
  v_mfma_f32_16x16x32_bf16 v[200:203], v[208:211], v[100:103], v[200:203]
  s_add_u32 m0, s81, 20480
  s_nop 0
  buffer_load_dwordx4 v56, s[12:15], s80 offen lds
  v_mfma_f32_16x16x32_bf16 v[204:207], v[208:211], v[104:107], v[204:207]
  v_cvt_pk_bf16_f32 v251, v190, v191
  s_waitcnt lgkmcnt(2)
  v_mfma_f32_16x16x32_bf16 v[196:199], v[212:215], v[108:111], v[196:199]
  v_accvgpr_write_b32 a24, v248
  v_mfma_f32_16x16x32_bf16 v[200:203], v[212:215], v[112:115], v[200:203]
  s_add_u32 m0, s81, 21504
  s_nop 0
  buffer_load_dwordx4 v57, s[12:15], s80 offen lds
  v_mfma_f32_16x16x32_bf16 v[204:207], v[212:215], v[116:119], v[204:207]
  v_accvgpr_write_b32 a25, v249
  s_waitcnt lgkmcnt(1)
  v_mfma_f32_16x16x32_bf16 v[196:199], v[216:219], v[120:123], v[196:199]
  v_accvgpr_write_b32 a104, v250
  v_mfma_f32_16x16x32_bf16 v[200:203], v[216:219], v[124:127], v[200:203]
  s_add_u32 m0, s81, 22528
  s_nop 0
  buffer_load_dwordx4 v58, s[12:15], s80 offen lds
  v_mfma_f32_16x16x32_bf16 v[204:207], v[216:219], v[128:131], v[204:207]
  v_accvgpr_write_b32 a105, v251
  s_waitcnt lgkmcnt(0)
  v_mfma_f32_16x16x32_bf16 v[196:199], v[220:223], v[132:135], v[196:199]
  v_cvt_pk_bf16_f32 v156, v192, v193
  v_cvt_pk_bf16_f32 v157, v194, v195
  v_mfma_f32_16x16x32_bf16 v[200:203], v[220:223], v[136:139], v[200:203]
  s_add_u32 m0, s81, 23552
  s_nop 0
  buffer_load_dwordx4 v59, s[12:15], s80 offen lds
  s_add_u32 s80, s80, 393216
  v_mfma_f32_16x16x32_bf16 v[204:207], v[220:223], v[140:143], v[204:207]
  s_waitcnt vmcnt(12)
  ds_read_b128 v[208:211], v70 offset:0
  ds_read_b128 v[212:215], v71 offset:0
  ds_read_b128 v[216:219], v70 offset:128
  s_waitcnt lgkmcnt(2)
  v_mfma_f32_16x16x32_bf16 v[184:187], v[208:211], v[72:75], 0
  ds_read_b128 v[220:223], v71 offset:128
  v_mfma_f32_16x16x32_bf16 v[188:191], v[208:211], v[76:79], 0
  s_add_u32 m0, s81, 24576
  s_nop 0
  buffer_load_dwordx4 v48, s[12:15], s80 offen lds
  v_mfma_f32_16x16x32_bf16 v[192:195], v[208:211], v[80:83], 0
  s_waitcnt lgkmcnt(2)
  v_mfma_f32_16x16x32_bf16 v[184:187], v[212:215], v[84:87], v[184:187]
  ds_read_b128 v[208:211], v70 offset:256
  v_cvt_pk_bf16_f32 v248, v196, v197
  v_mfma_f32_16x16x32_bf16 v[188:191], v[212:215], v[88:91], v[188:191]
  s_add_u32 m0, s81, 25600
  s_nop 0
  buffer_load_dwordx4 v49, s[12:15], s80 offen lds
  v_mfma_f32_16x16x32_bf16 v[192:195], v[212:215], v[92:95], v[192:195]
  v_cvt_pk_bf16_f32 v249, v198, v199
  s_waitcnt lgkmcnt(2)
  v_mfma_f32_16x16x32_bf16 v[184:187], v[216:219], v[96:99], v[184:187]
  ds_read_b128 v[212:215], v71 offset:256
  v_cvt_pk_bf16_f32 v250, v200, v201
  v_mfma_f32_16x16x32_bf16 v[188:191], v[216:219], v[100:103], v[188:191]
  s_add_u32 m0, s81, 26624
  s_nop 0
  buffer_load_dwordx4 v50, s[12:15], s80 offen lds
  v_mfma_f32_16x16x32_bf16 v[192:195], v[216:219], v[104:107], v[192:195]
  v_cvt_pk_bf16_f32 v251, v202, v203
  s_waitcnt lgkmcnt(2)
  v_mfma_f32_16x16x32_bf16 v[184:187], v[220:223], v[108:111], v[184:187]
  ds_read_b128 v[216:219], v70 offset:768
  v_accvgpr_write_b32 a26, v248
  v_mfma_f32_16x16x32_bf16 v[188:191], v[220:223], v[112:115], v[188:191]
  s_add_u32 m0, s81, 27648
  s_nop 0
  buffer_load_dwordx4 v51, s[12:15], s80 offen lds
  v_mfma_f32_16x16x32_bf16 v[192:195], v[220:223], v[116:119], v[192:195]
  v_accvgpr_write_b32 a27, v249
  s_waitcnt lgkmcnt(2)
  v_mfma_f32_16x16x32_bf16 v[184:187], v[208:211], v[120:123], v[184:187]
  ds_read_b128 v[220:223], v71 offset:768
  v_accvgpr_write_b32 a106, v250
  v_mfma_f32_16x16x32_bf16 v[188:191], v[208:211], v[124:127], v[188:191]
  s_add_u32 m0, s81, 28672
  s_nop 0
  buffer_load_dwordx4 v52, s[12:15], s80 offen lds
  v_mfma_f32_16x16x32_bf16 v[192:195], v[208:211], v[128:131], v[192:195]
  v_accvgpr_write_b32 a107, v251
  s_waitcnt lgkmcnt(2)
  v_mfma_f32_16x16x32_bf16 v[184:187], v[212:215], v[132:135], v[184:187]
  ds_read_b128 v[208:211], v70 offset:896
  s_mov_b64 exec, s[68:69]
  v_cvt_pk_bf16_f32 v156, v204, v205
  v_cvt_pk_bf16_f32 v157, v206, v207
  s_mov_b64 exec, -1
  v_mfma_f32_16x16x32_bf16 v[188:191], v[212:215], v[136:139], v[188:191]
  s_add_u32 m0, s81, 29696
  s_nop 0
  buffer_load_dwordx4 v53, s[12:15], s80 offen lds
  v_mfma_f32_16x16x32_bf16 v[192:195], v[212:215], v[140:143], v[192:195]
  s_waitcnt lgkmcnt(2)
  v_mfma_f32_16x16x32_bf16 v[196:199], v[216:219], v[72:75], 0
  ds_read_b128 v[212:215], v71 offset:896
  v_mfma_f32_16x16x32_bf16 v[200:203], v[216:219], v[76:79], 0
  s_add_u32 m0, s81, 30720
  s_nop 0
  buffer_load_dwordx4 v54, s[12:15], s80 offen lds
  v_mfma_f32_16x16x32_bf16 v[204:207], v[216:219], v[80:83], 0
  s_waitcnt lgkmcnt(2)
  v_mfma_f32_16x16x32_bf16 v[196:199], v[220:223], v[84:87], v[196:199]
  ds_read_b128 v[216:219], v70 offset:1024
  v_cvt_pk_bf16_f32 v248, v184, v185
  v_mfma_f32_16x16x32_bf16 v[200:203], v[220:223], v[88:91], v[200:203]
  s_add_u32 m0, s81, 31744
  s_nop 0
  buffer_load_dwordx4 v55, s[12:15], s80 offen lds
  v_mfma_f32_16x16x32_bf16 v[204:207], v[220:223], v[92:95], v[204:207]
  v_cvt_pk_bf16_f32 v249, v186, v187
  s_waitcnt lgkmcnt(2)
  v_mfma_f32_16x16x32_bf16 v[196:199], v[208:211], v[96:99], v[196:199]
  ds_read_b128 v[220:223], v71 offset:1024
  v_cvt_pk_bf16_f32 v250, v188, v189
  v_mfma_f32_16x16x32_bf16 v[200:203], v[208:211], v[100:103], v[200:203]
  s_add_u32 m0, s81, 32768
  s_nop 0
  buffer_load_dwordx4 v56, s[12:15], s80 offen lds
  v_mfma_f32_16x16x32_bf16 v[204:207], v[208:211], v[104:107], v[204:207]
  v_cvt_pk_bf16_f32 v251, v190, v191
  s_waitcnt lgkmcnt(2)
  v_mfma_f32_16x16x32_bf16 v[196:199], v[212:215], v[108:111], v[196:199]
  v_accvgpr_write_b32 a28, v248
  v_mfma_f32_16x16x32_bf16 v[200:203], v[212:215], v[112:115], v[200:203]
  s_add_u32 m0, s81, 33792
  s_nop 0
  buffer_load_dwordx4 v57, s[12:15], s80 offen lds
  v_mfma_f32_16x16x32_bf16 v[204:207], v[212:215], v[116:119], v[204:207]
  v_accvgpr_write_b32 a29, v249
  s_waitcnt lgkmcnt(1)
  v_mfma_f32_16x16x32_bf16 v[196:199], v[216:219], v[120:123], v[196:199]
  v_accvgpr_write_b32 a108, v250
  v_mfma_f32_16x16x32_bf16 v[200:203], v[216:219], v[124:127], v[200:203]
  s_add_u32 m0, s81, 34816
  s_nop 0
  buffer_load_dwordx4 v58, s[12:15], s80 offen lds
  v_mfma_f32_16x16x32_bf16 v[204:207], v[216:219], v[128:131], v[204:207]
  v_accvgpr_write_b32 a109, v251
  s_waitcnt lgkmcnt(0)
  v_mfma_f32_16x16x32_bf16 v[196:199], v[220:223], v[132:135], v[196:199]
  v_cvt_pk_bf16_f32 v158, v192, v193
  v_cvt_pk_bf16_f32 v159, v194, v195
  v_mfma_f32_16x16x32_bf16 v[200:203], v[220:223], v[136:139], v[200:203]
  s_add_u32 m0, s81, 35840
  s_nop 0
  buffer_load_dwordx4 v59, s[12:15], s80 offen lds
  s_add_u32 s80, s80, 393216
  v_mfma_f32_16x16x32_bf16 v[204:207], v[220:223], v[140:143], v[204:207]
  s_waitcnt vmcnt(12)
  ds_read_b128 v[208:211], v70 offset:12288
  ds_read_b128 v[212:215], v71 offset:12288
  ds_read_b128 v[216:219], v70 offset:12416
  s_waitcnt lgkmcnt(2)
  v_mfma_f32_16x16x32_bf16 v[184:187], v[208:211], v[72:75], 0
  ds_read_b128 v[220:223], v71 offset:12416
  v_mfma_f32_16x16x32_bf16 v[188:191], v[208:211], v[76:79], 0
  s_add_u32 m0, s81, 0
  s_nop 0
  buffer_load_dwordx4 v48, s[12:15], s80 offen lds
  v_mfma_f32_16x16x32_bf16 v[192:195], v[208:211], v[80:83], 0
  s_waitcnt lgkmcnt(2)
  v_mfma_f32_16x16x32_bf16 v[184:187], v[212:215], v[84:87], v[184:187]
  ds_read_b128 v[208:211], v70 offset:12544
  v_cvt_pk_bf16_f32 v248, v196, v197
  v_mfma_f32_16x16x32_bf16 v[188:191], v[212:215], v[88:91], v[188:191]
  s_add_u32 m0, s81, 1024
  s_nop 0
  buffer_load_dwordx4 v49, s[12:15], s80 offen lds
  v_mfma_f32_16x16x32_bf16 v[192:195], v[212:215], v[92:95], v[192:195]
  v_cvt_pk_bf16_f32 v249, v198, v199
  s_waitcnt lgkmcnt(2)
  v_mfma_f32_16x16x32_bf16 v[184:187], v[216:219], v[96:99], v[184:187]
  ds_read_b128 v[212:215], v71 offset:12544
  v_cvt_pk_bf16_f32 v250, v200, v201
  v_mfma_f32_16x16x32_bf16 v[188:191], v[216:219], v[100:103], v[188:191]
  s_add_u32 m0, s81, 2048
  s_nop 0
  buffer_load_dwordx4 v50, s[12:15], s80 offen lds
  v_mfma_f32_16x16x32_bf16 v[192:195], v[216:219], v[104:107], v[192:195]
  v_cvt_pk_bf16_f32 v251, v202, v203
  s_waitcnt lgkmcnt(2)
  v_mfma_f32_16x16x32_bf16 v[184:187], v[220:223], v[108:111], v[184:187]
  ds_read_b128 v[216:219], v70 offset:13056
  v_accvgpr_write_b32 a30, v248
  v_mfma_f32_16x16x32_bf16 v[188:191], v[220:223], v[112:115], v[188:191]
  s_add_u32 m0, s81, 3072
  s_nop 0
  buffer_load_dwordx4 v51, s[12:15], s80 offen lds
  v_mfma_f32_16x16x32_bf16 v[192:195], v[220:223], v[116:119], v[192:195]
  v_accvgpr_write_b32 a31, v249
  s_waitcnt lgkmcnt(2)
  v_mfma_f32_16x16x32_bf16 v[184:187], v[208:211], v[120:123], v[184:187]
  ds_read_b128 v[220:223], v71 offset:13056
  v_accvgpr_write_b32 a110, v250
  v_mfma_f32_16x16x32_bf16 v[188:191], v[208:211], v[124:127], v[188:191]
  s_add_u32 m0, s81, 4096
  s_nop 0
  buffer_load_dwordx4 v52, s[12:15], s80 offen lds
  v_mfma_f32_16x16x32_bf16 v[192:195], v[208:211], v[128:131], v[192:195]
  v_accvgpr_write_b32 a111, v251
  s_waitcnt lgkmcnt(2)
  v_mfma_f32_16x16x32_bf16 v[184:187], v[212:215], v[132:135], v[184:187]
  ds_read_b128 v[208:211], v70 offset:13184
  s_mov_b64 exec, s[68:69]
  v_cvt_pk_bf16_f32 v158, v204, v205
  v_cvt_pk_bf16_f32 v159, v206, v207
  s_mov_b64 exec, -1
  v_mfma_f32_16x16x32_bf16 v[188:191], v[212:215], v[136:139], v[188:191]
  s_add_u32 m0, s81, 5120
  s_nop 0
  buffer_load_dwordx4 v53, s[12:15], s80 offen lds
  v_mfma_f32_16x16x32_bf16 v[192:195], v[212:215], v[140:143], v[192:195]
  s_waitcnt lgkmcnt(2)
  v_mfma_f32_16x16x32_bf16 v[196:199], v[216:219], v[72:75], 0
  ds_read_b128 v[212:215], v71 offset:13184
  v_mfma_f32_16x16x32_bf16 v[200:203], v[216:219], v[76:79], 0
  s_add_u32 m0, s81, 6144
  s_nop 0
  buffer_load_dwordx4 v54, s[12:15], s80 offen lds
  v_mfma_f32_16x16x32_bf16 v[204:207], v[216:219], v[80:83], 0
  s_waitcnt lgkmcnt(2)
  v_mfma_f32_16x16x32_bf16 v[196:199], v[220:223], v[84:87], v[196:199]
  ds_read_b128 v[216:219], v70 offset:13312
  v_cvt_pk_bf16_f32 v248, v184, v185
  v_mfma_f32_16x16x32_bf16 v[200:203], v[220:223], v[88:91], v[200:203]
  s_add_u32 m0, s81, 7168
  s_nop 0
  buffer_load_dwordx4 v55, s[12:15], s80 offen lds
  v_mfma_f32_16x16x32_bf16 v[204:207], v[220:223], v[92:95], v[204:207]
  v_cvt_pk_bf16_f32 v249, v186, v187
  s_waitcnt lgkmcnt(2)
  v_mfma_f32_16x16x32_bf16 v[196:199], v[208:211], v[96:99], v[196:199]
  ds_read_b128 v[220:223], v71 offset:13312
  v_cvt_pk_bf16_f32 v250, v188, v189
  v_mfma_f32_16x16x32_bf16 v[200:203], v[208:211], v[100:103], v[200:203]
  s_add_u32 m0, s81, 8192
  s_nop 0
  buffer_load_dwordx4 v56, s[12:15], s80 offen lds
  v_mfma_f32_16x16x32_bf16 v[204:207], v[208:211], v[104:107], v[204:207]
  v_cvt_pk_bf16_f32 v251, v190, v191
  s_waitcnt lgkmcnt(2)
  v_mfma_f32_16x16x32_bf16 v[196:199], v[212:215], v[108:111], v[196:199]
  v_accvgpr_write_b32 a32, v248
  v_mfma_f32_16x16x32_bf16 v[200:203], v[212:215], v[112:115], v[200:203]
  s_add_u32 m0, s81, 9216
  s_nop 0
  buffer_load_dwordx4 v57, s[12:15], s80 offen lds
  v_mfma_f32_16x16x32_bf16 v[204:207], v[212:215], v[116:119], v[204:207]
  v_accvgpr_write_b32 a33, v249
  s_waitcnt lgkmcnt(1)
  v_mfma_f32_16x16x32_bf16 v[196:199], v[216:219], v[120:123], v[196:199]
  v_accvgpr_write_b32 a112, v250
  v_mfma_f32_16x16x32_bf16 v[200:203], v[216:219], v[124:127], v[200:203]
  s_add_u32 m0, s81, 10240
  s_nop 0
  buffer_load_dwordx4 v58, s[12:15], s80 offen lds
  v_mfma_f32_16x16x32_bf16 v[204:207], v[216:219], v[128:131], v[204:207]
  v_accvgpr_write_b32 a113, v251
  s_waitcnt lgkmcnt(0)
  v_mfma_f32_16x16x32_bf16 v[196:199], v[220:223], v[132:135], v[196:199]
  v_cvt_pk_bf16_f32 v160, v192, v193
  v_cvt_pk_bf16_f32 v161, v194, v195
  v_mfma_f32_16x16x32_bf16 v[200:203], v[220:223], v[136:139], v[200:203]
  s_add_u32 m0, s81, 11264
  s_nop 0
  buffer_load_dwordx4 v59, s[12:15], s80 offen lds
  s_add_u32 s80, s80, 393216
  v_mfma_f32_16x16x32_bf16 v[204:207], v[220:223], v[140:143], v[204:207]
  s_waitcnt vmcnt(12)
  ds_read_b128 v[208:211], v70 offset:24576
  ds_read_b128 v[212:215], v71 offset:24576
  ds_read_b128 v[216:219], v70 offset:24704
  s_waitcnt lgkmcnt(2)
  v_mfma_f32_16x16x32_bf16 v[184:187], v[208:211], v[72:75], 0
  ds_read_b128 v[220:223], v71 offset:24704
  v_mfma_f32_16x16x32_bf16 v[188:191], v[208:211], v[76:79], 0
  s_add_u32 m0, s81, 12288
  s_nop 0
  buffer_load_dwordx4 v48, s[12:15], s80 offen lds
  v_mfma_f32_16x16x32_bf16 v[192:195], v[208:211], v[80:83], 0
  s_waitcnt lgkmcnt(2)
  v_mfma_f32_16x16x32_bf16 v[184:187], v[212:215], v[84:87], v[184:187]
  ds_read_b128 v[208:211], v70 offset:24832
  v_cvt_pk_bf16_f32 v248, v196, v197
  v_mfma_f32_16x16x32_bf16 v[188:191], v[212:215], v[88:91], v[188:191]
  s_add_u32 m0, s81, 13312
  s_nop 0
  buffer_load_dwordx4 v49, s[12:15], s80 offen lds
  v_mfma_f32_16x16x32_bf16 v[192:195], v[212:215], v[92:95], v[192:195]
  v_cvt_pk_bf16_f32 v249, v198, v199
  s_waitcnt lgkmcnt(2)
  v_mfma_f32_16x16x32_bf16 v[184:187], v[216:219], v[96:99], v[184:187]
  ds_read_b128 v[212:215], v71 offset:24832
  v_cvt_pk_bf16_f32 v250, v200, v201
  v_mfma_f32_16x16x32_bf16 v[188:191], v[216:219], v[100:103], v[188:191]
  s_add_u32 m0, s81, 14336
  s_nop 0
  buffer_load_dwordx4 v50, s[12:15], s80 offen lds
  v_mfma_f32_16x16x32_bf16 v[192:195], v[216:219], v[104:107], v[192:195]
  v_cvt_pk_bf16_f32 v251, v202, v203
  s_waitcnt lgkmcnt(2)
  v_mfma_f32_16x16x32_bf16 v[184:187], v[220:223], v[108:111], v[184:187]
  ds_read_b128 v[216:219], v70 offset:25344
  v_accvgpr_write_b32 a34, v248
  v_mfma_f32_16x16x32_bf16 v[188:191], v[220:223], v[112:115], v[188:191]
  s_add_u32 m0, s81, 15360
  s_nop 0
  buffer_load_dwordx4 v51, s[12:15], s80 offen lds
  v_mfma_f32_16x16x32_bf16 v[192:195], v[220:223], v[116:119], v[192:195]
  v_accvgpr_write_b32 a35, v249
  s_waitcnt lgkmcnt(2)
  v_mfma_f32_16x16x32_bf16 v[184:187], v[208:211], v[120:123], v[184:187]
  ds_read_b128 v[220:223], v71 offset:25344
  v_accvgpr_write_b32 a114, v250
  v_mfma_f32_16x16x32_bf16 v[188:191], v[208:211], v[124:127], v[188:191]
  s_add_u32 m0, s81, 16384
  s_nop 0
  buffer_load_dwordx4 v52, s[12:15], s80 offen lds
  v_mfma_f32_16x16x32_bf16 v[192:195], v[208:211], v[128:131], v[192:195]
  v_accvgpr_write_b32 a115, v251
  s_waitcnt lgkmcnt(2)
  v_mfma_f32_16x16x32_bf16 v[184:187], v[212:215], v[132:135], v[184:187]
  ds_read_b128 v[208:211], v70 offset:25472
  s_mov_b64 exec, s[68:69]
  v_cvt_pk_bf16_f32 v160, v204, v205
  v_cvt_pk_bf16_f32 v161, v206, v207
  s_mov_b64 exec, -1
  v_mfma_f32_16x16x32_bf16 v[188:191], v[212:215], v[136:139], v[188:191]
  s_add_u32 m0, s81, 17408
  s_nop 0
  buffer_load_dwordx4 v53, s[12:15], s80 offen lds
  v_mfma_f32_16x16x32_bf16 v[192:195], v[212:215], v[140:143], v[192:195]
  s_waitcnt lgkmcnt(2)
  v_mfma_f32_16x16x32_bf16 v[196:199], v[216:219], v[72:75], 0
  ds_read_b128 v[212:215], v71 offset:25472
  v_mfma_f32_16x16x32_bf16 v[200:203], v[216:219], v[76:79], 0
  s_add_u32 m0, s81, 18432
  s_nop 0
  buffer_load_dwordx4 v54, s[12:15], s80 offen lds
  v_mfma_f32_16x16x32_bf16 v[204:207], v[216:219], v[80:83], 0
  s_waitcnt lgkmcnt(2)
  v_mfma_f32_16x16x32_bf16 v[196:199], v[220:223], v[84:87], v[196:199]
  ds_read_b128 v[216:219], v70 offset:25600
  v_cvt_pk_bf16_f32 v248, v184, v185
  v_mfma_f32_16x16x32_bf16 v[200:203], v[220:223], v[88:91], v[200:203]
  s_add_u32 m0, s81, 19456
  s_nop 0
  buffer_load_dwordx4 v55, s[12:15], s80 offen lds
  v_mfma_f32_16x16x32_bf16 v[204:207], v[220:223], v[92:95], v[204:207]
  v_cvt_pk_bf16_f32 v249, v186, v187
  s_waitcnt lgkmcnt(2)
  v_mfma_f32_16x16x32_bf16 v[196:199], v[208:211], v[96:99], v[196:199]
  ds_read_b128 v[220:223], v71 offset:25600
  v_cvt_pk_bf16_f32 v250, v188, v189
  v_mfma_f32_16x16x32_bf16 v[200:203], v[208:211], v[100:103], v[200:203]
  s_add_u32 m0, s81, 20480
  s_nop 0
  buffer_load_dwordx4 v56, s[12:15], s80 offen lds
  v_mfma_f32_16x16x32_bf16 v[204:207], v[208:211], v[104:107], v[204:207]
  v_cvt_pk_bf16_f32 v251, v190, v191
  s_waitcnt lgkmcnt(2)
  v_mfma_f32_16x16x32_bf16 v[196:199], v[212:215], v[108:111], v[196:199]
  v_accvgpr_write_b32 a36, v248
  v_mfma_f32_16x16x32_bf16 v[200:203], v[212:215], v[112:115], v[200:203]
  s_add_u32 m0, s81, 21504
  s_nop 0
  buffer_load_dwordx4 v57, s[12:15], s80 offen lds
  v_mfma_f32_16x16x32_bf16 v[204:207], v[212:215], v[116:119], v[204:207]
  v_accvgpr_write_b32 a37, v249
  s_waitcnt lgkmcnt(1)
  v_mfma_f32_16x16x32_bf16 v[196:199], v[216:219], v[120:123], v[196:199]
  v_accvgpr_write_b32 a116, v250
  v_mfma_f32_16x16x32_bf16 v[200:203], v[216:219], v[124:127], v[200:203]
  s_add_u32 m0, s81, 22528
  s_nop 0
  buffer_load_dwordx4 v58, s[12:15], s80 offen lds
  v_mfma_f32_16x16x32_bf16 v[204:207], v[216:219], v[128:131], v[204:207]
  v_accvgpr_write_b32 a117, v251
  s_waitcnt lgkmcnt(0)
  v_mfma_f32_16x16x32_bf16 v[196:199], v[220:223], v[132:135], v[196:199]
  v_cvt_pk_bf16_f32 v162, v192, v193
  v_cvt_pk_bf16_f32 v163, v194, v195
  v_mfma_f32_16x16x32_bf16 v[200:203], v[220:223], v[136:139], v[200:203]
  s_add_u32 m0, s81, 23552
  s_nop 0
  buffer_load_dwordx4 v59, s[12:15], s80 offen lds
  s_add_u32 s80, s80, 393216
  v_mfma_f32_16x16x32_bf16 v[204:207], v[220:223], v[140:143], v[204:207]
  s_waitcnt vmcnt(12)
  ds_read_b128 v[208:211], v70 offset:0
  ds_read_b128 v[212:215], v71 offset:0
  ds_read_b128 v[216:219], v70 offset:128
  s_waitcnt lgkmcnt(2)
  v_mfma_f32_16x16x32_bf16 v[184:187], v[208:211], v[72:75], 0
  ds_read_b128 v[220:223], v71 offset:128
  v_mfma_f32_16x16x32_bf16 v[188:191], v[208:211], v[76:79], 0
  s_add_u32 m0, s81, 24576
  s_nop 0
  buffer_load_dwordx4 v48, s[12:15], s80 offen lds
  v_mfma_f32_16x16x32_bf16 v[192:195], v[208:211], v[80:83], 0
  s_waitcnt lgkmcnt(2)
  v_mfma_f32_16x16x32_bf16 v[184:187], v[212:215], v[84:87], v[184:187]
  ds_read_b128 v[208:211], v70 offset:256
  v_cvt_pk_bf16_f32 v248, v196, v197
  v_mfma_f32_16x16x32_bf16 v[188:191], v[212:215], v[88:91], v[188:191]
  s_add_u32 m0, s81, 25600
  s_nop 0
  buffer_load_dwordx4 v49, s[12:15], s80 offen lds
  v_mfma_f32_16x16x32_bf16 v[192:195], v[212:215], v[92:95], v[192:195]
  v_cvt_pk_bf16_f32 v249, v198, v199
  s_waitcnt lgkmcnt(2)
  v_mfma_f32_16x16x32_bf16 v[184:187], v[216:219], v[96:99], v[184:187]
  ds_read_b128 v[212:215], v71 offset:256
  v_cvt_pk_bf16_f32 v250, v200, v201
  v_mfma_f32_16x16x32_bf16 v[188:191], v[216:219], v[100:103], v[188:191]
  s_add_u32 m0, s81, 26624
  s_nop 0
  buffer_load_dwordx4 v50, s[12:15], s80 offen lds
  v_mfma_f32_16x16x32_bf16 v[192:195], v[216:219], v[104:107], v[192:195]
  v_cvt_pk_bf16_f32 v251, v202, v203
  s_waitcnt lgkmcnt(2)
  v_mfma_f32_16x16x32_bf16 v[184:187], v[220:223], v[108:111], v[184:187]
  ds_read_b128 v[216:219], v70 offset:768
  v_accvgpr_write_b32 a38, v248
  v_mfma_f32_16x16x32_bf16 v[188:191], v[220:223], v[112:115], v[188:191]
  s_add_u32 m0, s81, 27648
  s_nop 0
  buffer_load_dwordx4 v51, s[12:15], s80 offen lds
  v_mfma_f32_16x16x32_bf16 v[192:195], v[220:223], v[116:119], v[192:195]
  v_accvgpr_write_b32 a39, v249
  s_waitcnt lgkmcnt(2)
  v_mfma_f32_16x16x32_bf16 v[184:187], v[208:211], v[120:123], v[184:187]
  ds_read_b128 v[220:223], v71 offset:768
  v_accvgpr_write_b32 a118, v250
  v_mfma_f32_16x16x32_bf16 v[188:191], v[208:211], v[124:127], v[188:191]
  s_add_u32 m0, s81, 28672
  s_nop 0
  buffer_load_dwordx4 v52, s[12:15], s80 offen lds
  v_mfma_f32_16x16x32_bf16 v[192:195], v[208:211], v[128:131], v[192:195]
  v_accvgpr_write_b32 a119, v251
  s_waitcnt lgkmcnt(2)
  v_mfma_f32_16x16x32_bf16 v[184:187], v[212:215], v[132:135], v[184:187]
  ds_read_b128 v[208:211], v70 offset:896
  s_mov_b64 exec, s[68:69]
  v_cvt_pk_bf16_f32 v162, v204, v205
  v_cvt_pk_bf16_f32 v163, v206, v207
  s_mov_b64 exec, -1
  v_mfma_f32_16x16x32_bf16 v[188:191], v[212:215], v[136:139], v[188:191]
  s_add_u32 m0, s81, 29696
  s_nop 0
  buffer_load_dwordx4 v53, s[12:15], s80 offen lds
  v_mfma_f32_16x16x32_bf16 v[192:195], v[212:215], v[140:143], v[192:195]
  s_waitcnt lgkmcnt(2)
  v_mfma_f32_16x16x32_bf16 v[196:199], v[216:219], v[72:75], 0
  ds_read_b128 v[212:215], v71 offset:896
  v_mfma_f32_16x16x32_bf16 v[200:203], v[216:219], v[76:79], 0
  s_add_u32 m0, s81, 30720
  s_nop 0
  buffer_load_dwordx4 v54, s[12:15], s80 offen lds
  v_mfma_f32_16x16x32_bf16 v[204:207], v[216:219], v[80:83], 0
  s_waitcnt lgkmcnt(2)
  v_mfma_f32_16x16x32_bf16 v[196:199], v[220:223], v[84:87], v[196:199]
  ds_read_b128 v[216:219], v70 offset:1024
  v_cvt_pk_bf16_f32 v248, v184, v185
  v_mfma_f32_16x16x32_bf16 v[200:203], v[220:223], v[88:91], v[200:203]
  s_add_u32 m0, s81, 31744
  s_nop 0
  buffer_load_dwordx4 v55, s[12:15], s80 offen lds
  v_mfma_f32_16x16x32_bf16 v[204:207], v[220:223], v[92:95], v[204:207]
  v_cvt_pk_bf16_f32 v249, v186, v187
  s_waitcnt lgkmcnt(2)
  v_mfma_f32_16x16x32_bf16 v[196:199], v[208:211], v[96:99], v[196:199]
  ds_read_b128 v[220:223], v71 offset:1024
  v_cvt_pk_bf16_f32 v250, v188, v189
  v_mfma_f32_16x16x32_bf16 v[200:203], v[208:211], v[100:103], v[200:203]
  s_add_u32 m0, s81, 32768
  s_nop 0
  buffer_load_dwordx4 v56, s[12:15], s80 offen lds
  v_mfma_f32_16x16x32_bf16 v[204:207], v[208:211], v[104:107], v[204:207]
  v_cvt_pk_bf16_f32 v251, v190, v191
  s_waitcnt lgkmcnt(2)
  v_mfma_f32_16x16x32_bf16 v[196:199], v[212:215], v[108:111], v[196:199]
  v_accvgpr_write_b32 a40, v248
  v_mfma_f32_16x16x32_bf16 v[200:203], v[212:215], v[112:115], v[200:203]
  s_add_u32 m0, s81, 33792
  s_nop 0
  buffer_load_dwordx4 v57, s[12:15], s80 offen lds
  v_mfma_f32_16x16x32_bf16 v[204:207], v[212:215], v[116:119], v[204:207]
  v_accvgpr_write_b32 a41, v249
  s_waitcnt lgkmcnt(1)
  v_mfma_f32_16x16x32_bf16 v[196:199], v[216:219], v[120:123], v[196:199]
  v_accvgpr_write_b32 a120, v250
  v_mfma_f32_16x16x32_bf16 v[200:203], v[216:219], v[124:127], v[200:203]
  s_add_u32 m0, s81, 34816
  s_nop 0
  buffer_load_dwordx4 v58, s[12:15], s80 offen lds
  v_mfma_f32_16x16x32_bf16 v[204:207], v[216:219], v[128:131], v[204:207]
  v_accvgpr_write_b32 a121, v251
  s_waitcnt lgkmcnt(0)
  v_mfma_f32_16x16x32_bf16 v[196:199], v[220:223], v[132:135], v[196:199]
  v_cvt_pk_bf16_f32 v164, v192, v193
  v_cvt_pk_bf16_f32 v165, v194, v195
  v_mfma_f32_16x16x32_bf16 v[200:203], v[220:223], v[136:139], v[200:203]
  s_add_u32 m0, s81, 35840
  s_nop 0
  buffer_load_dwordx4 v59, s[12:15], s80 offen lds
  s_add_u32 s80, s80, 393216
  v_mfma_f32_16x16x32_bf16 v[204:207], v[220:223], v[140:143], v[204:207]
  s_waitcnt vmcnt(12)
  ds_read_b128 v[208:211], v70 offset:12288
  ds_read_b128 v[212:215], v71 offset:12288
  ds_read_b128 v[216:219], v70 offset:12416
  s_waitcnt lgkmcnt(2)
  v_mfma_f32_16x16x32_bf16 v[184:187], v[208:211], v[72:75], 0
  ds_read_b128 v[220:223], v71 offset:12416
  v_mfma_f32_16x16x32_bf16 v[188:191], v[208:211], v[76:79], 0
  s_add_u32 m0, s81, 0
  s_nop 0
  buffer_load_dwordx4 v48, s[12:15], s80 offen lds
  v_mfma_f32_16x16x32_bf16 v[192:195], v[208:211], v[80:83], 0
  s_waitcnt lgkmcnt(2)
  v_mfma_f32_16x16x32_bf16 v[184:187], v[212:215], v[84:87], v[184:187]
  ds_read_b128 v[208:211], v70 offset:12544
  v_cvt_pk_bf16_f32 v248, v196, v197
  v_mfma_f32_16x16x32_bf16 v[188:191], v[212:215], v[88:91], v[188:191]
  s_add_u32 m0, s81, 1024
  s_nop 0
  buffer_load_dwordx4 v49, s[12:15], s80 offen lds
  v_mfma_f32_16x16x32_bf16 v[192:195], v[212:215], v[92:95], v[192:195]
  v_cvt_pk_bf16_f32 v249, v198, v199
  s_waitcnt lgkmcnt(2)
  v_mfma_f32_16x16x32_bf16 v[184:187], v[216:219], v[96:99], v[184:187]
  ds_read_b128 v[212:215], v71 offset:12544
  v_cvt_pk_bf16_f32 v250, v200, v201
  v_mfma_f32_16x16x32_bf16 v[188:191], v[216:219], v[100:103], v[188:191]
  s_add_u32 m0, s81, 2048
  s_nop 0
  buffer_load_dwordx4 v50, s[12:15], s80 offen lds
  v_mfma_f32_16x16x32_bf16 v[192:195], v[216:219], v[104:107], v[192:195]
  v_cvt_pk_bf16_f32 v251, v202, v203
  s_waitcnt lgkmcnt(2)
  v_mfma_f32_16x16x32_bf16 v[184:187], v[220:223], v[108:111], v[184:187]
  ds_read_b128 v[216:219], v70 offset:13056
  v_accvgpr_write_b32 a42, v248
  v_mfma_f32_16x16x32_bf16 v[188:191], v[220:223], v[112:115], v[188:191]
  s_add_u32 m0, s81, 3072
  s_nop 0
  buffer_load_dwordx4 v51, s[12:15], s80 offen lds
  v_mfma_f32_16x16x32_bf16 v[192:195], v[220:223], v[116:119], v[192:195]
  v_accvgpr_write_b32 a43, v249
  s_waitcnt lgkmcnt(2)
  v_mfma_f32_16x16x32_bf16 v[184:187], v[208:211], v[120:123], v[184:187]
  ds_read_b128 v[220:223], v71 offset:13056
  v_accvgpr_write_b32 a122, v250
  v_mfma_f32_16x16x32_bf16 v[188:191], v[208:211], v[124:127], v[188:191]
  s_add_u32 m0, s81, 4096
  s_nop 0
  buffer_load_dwordx4 v52, s[12:15], s80 offen lds
  v_mfma_f32_16x16x32_bf16 v[192:195], v[208:211], v[128:131], v[192:195]
  v_accvgpr_write_b32 a123, v251
  s_waitcnt lgkmcnt(2)
  v_mfma_f32_16x16x32_bf16 v[184:187], v[212:215], v[132:135], v[184:187]
  ds_read_b128 v[208:211], v70 offset:13184
  s_mov_b64 exec, s[68:69]
  v_cvt_pk_bf16_f32 v164, v204, v205
  v_cvt_pk_bf16_f32 v165, v206, v207
  s_mov_b64 exec, -1
  v_mfma_f32_16x16x32_bf16 v[188:191], v[212:215], v[136:139], v[188:191]
  s_add_u32 m0, s81, 5120
  s_nop 0
  buffer_load_dwordx4 v53, s[12:15], s80 offen lds
  v_mfma_f32_16x16x32_bf16 v[192:195], v[212:215], v[140:143], v[192:195]
  s_waitcnt lgkmcnt(2)
  v_mfma_f32_16x16x32_bf16 v[196:199], v[216:219], v[72:75], 0
  ds_read_b128 v[212:215], v71 offset:13184
  v_mfma_f32_16x16x32_bf16 v[200:203], v[216:219], v[76:79], 0
  s_add_u32 m0, s81, 6144
  s_nop 0
  buffer_load_dwordx4 v54, s[12:15], s80 offen lds
  v_mfma_f32_16x16x32_bf16 v[204:207], v[216:219], v[80:83], 0
  s_waitcnt lgkmcnt(2)
  v_mfma_f32_16x16x32_bf16 v[196:199], v[220:223], v[84:87], v[196:199]
  ds_read_b128 v[216:219], v70 offset:13312
  v_cvt_pk_bf16_f32 v248, v184, v185
  v_mfma_f32_16x16x32_bf16 v[200:203], v[220:223], v[88:91], v[200:203]
  s_add_u32 m0, s81, 7168
  s_nop 0
  buffer_load_dwordx4 v55, s[12:15], s80 offen lds
  v_mfma_f32_16x16x32_bf16 v[204:207], v[220:223], v[92:95], v[204:207]
  v_cvt_pk_bf16_f32 v249, v186, v187
  s_waitcnt lgkmcnt(2)
  v_mfma_f32_16x16x32_bf16 v[196:199], v[208:211], v[96:99], v[196:199]
  ds_read_b128 v[220:223], v71 offset:13312
  v_cvt_pk_bf16_f32 v250, v188, v189
  v_mfma_f32_16x16x32_bf16 v[200:203], v[208:211], v[100:103], v[200:203]
  s_add_u32 m0, s81, 8192
  s_nop 0
  buffer_load_dwordx4 v56, s[12:15], s80 offen lds
  v_mfma_f32_16x16x32_bf16 v[204:207], v[208:211], v[104:107], v[204:207]
  v_cvt_pk_bf16_f32 v251, v190, v191
  s_waitcnt lgkmcnt(2)
  v_mfma_f32_16x16x32_bf16 v[196:199], v[212:215], v[108:111], v[196:199]
  v_accvgpr_write_b32 a44, v248
  v_mfma_f32_16x16x32_bf16 v[200:203], v[212:215], v[112:115], v[200:203]
  s_add_u32 m0, s81, 9216
  s_nop 0
  buffer_load_dwordx4 v57, s[12:15], s80 offen lds
  v_mfma_f32_16x16x32_bf16 v[204:207], v[212:215], v[116:119], v[204:207]
  v_accvgpr_write_b32 a45, v249
  s_waitcnt lgkmcnt(1)
  v_mfma_f32_16x16x32_bf16 v[196:199], v[216:219], v[120:123], v[196:199]
  v_accvgpr_write_b32 a124, v250
  v_mfma_f32_16x16x32_bf16 v[200:203], v[216:219], v[124:127], v[200:203]
  s_add_u32 m0, s81, 10240
  s_nop 0
  buffer_load_dwordx4 v58, s[12:15], s80 offen lds
  v_mfma_f32_16x16x32_bf16 v[204:207], v[216:219], v[128:131], v[204:207]
  v_accvgpr_write_b32 a125, v251
  s_waitcnt lgkmcnt(0)
  v_mfma_f32_16x16x32_bf16 v[196:199], v[220:223], v[132:135], v[196:199]
  v_cvt_pk_bf16_f32 v166, v192, v193
  v_cvt_pk_bf16_f32 v167, v194, v195
  v_mfma_f32_16x16x32_bf16 v[200:203], v[220:223], v[136:139], v[200:203]
  s_add_u32 m0, s81, 11264
  s_nop 0
  buffer_load_dwordx4 v59, s[12:15], s80 offen lds
  s_add_u32 s80, s80, 393216
  v_mfma_f32_16x16x32_bf16 v[204:207], v[220:223], v[140:143], v[204:207]
  s_waitcnt vmcnt(12)
  ds_read_b128 v[208:211], v70 offset:24576
  ds_read_b128 v[212:215], v71 offset:24576
  ds_read_b128 v[216:219], v70 offset:24704
  s_waitcnt lgkmcnt(2)
  v_mfma_f32_16x16x32_bf16 v[184:187], v[208:211], v[72:75], 0
  ds_read_b128 v[220:223], v71 offset:24704
  v_mfma_f32_16x16x32_bf16 v[188:191], v[208:211], v[76:79], 0
  s_add_u32 m0, s81, 12288
  s_nop 0
  buffer_load_dwordx4 v48, s[12:15], s80 offen lds
  v_mfma_f32_16x16x32_bf16 v[192:195], v[208:211], v[80:83], 0
  s_waitcnt lgkmcnt(2)
  v_mfma_f32_16x16x32_bf16 v[184:187], v[212:215], v[84:87], v[184:187]
  ds_read_b128 v[208:211], v70 offset:24832
  v_cvt_pk_bf16_f32 v248, v196, v197
  v_mfma_f32_16x16x32_bf16 v[188:191], v[212:215], v[88:91], v[188:191]
  s_add_u32 m0, s81, 13312
  s_nop 0
  buffer_load_dwordx4 v49, s[12:15], s80 offen lds
  v_mfma_f32_16x16x32_bf16 v[192:195], v[212:215], v[92:95], v[192:195]
  v_cvt_pk_bf16_f32 v249, v198, v199
  s_waitcnt lgkmcnt(2)
  v_mfma_f32_16x16x32_bf16 v[184:187], v[216:219], v[96:99], v[184:187]
  ds_read_b128 v[212:215], v71 offset:24832
  v_cvt_pk_bf16_f32 v250, v200, v201
  v_mfma_f32_16x16x32_bf16 v[188:191], v[216:219], v[100:103], v[188:191]
  s_add_u32 m0, s81, 14336
  s_nop 0
  buffer_load_dwordx4 v50, s[12:15], s80 offen lds
  v_mfma_f32_16x16x32_bf16 v[192:195], v[216:219], v[104:107], v[192:195]
  v_cvt_pk_bf16_f32 v251, v202, v203
  s_waitcnt lgkmcnt(2)
  v_mfma_f32_16x16x32_bf16 v[184:187], v[220:223], v[108:111], v[184:187]
  ds_read_b128 v[216:219], v70 offset:25344
  v_accvgpr_write_b32 a46, v248
  v_mfma_f32_16x16x32_bf16 v[188:191], v[220:223], v[112:115], v[188:191]
  s_add_u32 m0, s81, 15360
  s_nop 0
  buffer_load_dwordx4 v51, s[12:15], s80 offen lds
  v_mfma_f32_16x16x32_bf16 v[192:195], v[220:223], v[116:119], v[192:195]
  v_accvgpr_write_b32 a47, v249
  s_waitcnt lgkmcnt(2)
  v_mfma_f32_16x16x32_bf16 v[184:187], v[208:211], v[120:123], v[184:187]
  ds_read_b128 v[220:223], v71 offset:25344
  v_accvgpr_write_b32 a126, v250
  v_mfma_f32_16x16x32_bf16 v[188:191], v[208:211], v[124:127], v[188:191]
  s_add_u32 m0, s81, 16384
  s_nop 0
  buffer_load_dwordx4 v52, s[12:15], s80 offen lds
  v_mfma_f32_16x16x32_bf16 v[192:195], v[208:211], v[128:131], v[192:195]
  v_accvgpr_write_b32 a127, v251
  s_waitcnt lgkmcnt(2)
  v_mfma_f32_16x16x32_bf16 v[184:187], v[212:215], v[132:135], v[184:187]
  ds_read_b128 v[208:211], v70 offset:25472
  s_mov_b64 exec, s[68:69]
  v_cvt_pk_bf16_f32 v166, v204, v205
  v_cvt_pk_bf16_f32 v167, v206, v207
  s_mov_b64 exec, -1
  v_mfma_f32_16x16x32_bf16 v[188:191], v[212:215], v[136:139], v[188:191]
  s_add_u32 m0, s81, 17408
  s_nop 0
  buffer_load_dwordx4 v53, s[12:15], s80 offen lds
  v_mfma_f32_16x16x32_bf16 v[192:195], v[212:215], v[140:143], v[192:195]
  s_waitcnt lgkmcnt(2)
  v_mfma_f32_16x16x32_bf16 v[196:199], v[216:219], v[72:75], 0
  ds_read_b128 v[212:215], v71 offset:25472
  v_mfma_f32_16x16x32_bf16 v[200:203], v[216:219], v[76:79], 0
  s_add_u32 m0, s81, 18432
  s_nop 0
  buffer_load_dwordx4 v54, s[12:15], s80 offen lds
  v_mfma_f32_16x16x32_bf16 v[204:207], v[216:219], v[80:83], 0
  s_waitcnt lgkmcnt(2)
  v_mfma_f32_16x16x32_bf16 v[196:199], v[220:223], v[84:87], v[196:199]
  ds_read_b128 v[216:219], v70 offset:25600
  v_cvt_pk_bf16_f32 v248, v184, v185
  v_mfma_f32_16x16x32_bf16 v[200:203], v[220:223], v[88:91], v[200:203]
  s_add_u32 m0, s81, 19456
  s_nop 0
  buffer_load_dwordx4 v55, s[12:15], s80 offen lds
  v_mfma_f32_16x16x32_bf16 v[204:207], v[220:223], v[92:95], v[204:207]
  v_cvt_pk_bf16_f32 v249, v186, v187
  s_waitcnt lgkmcnt(2)
  v_mfma_f32_16x16x32_bf16 v[196:199], v[208:211], v[96:99], v[196:199]
  ds_read_b128 v[220:223], v71 offset:25600
  v_cvt_pk_bf16_f32 v250, v188, v189
  v_mfma_f32_16x16x32_bf16 v[200:203], v[208:211], v[100:103], v[200:203]
  s_add_u32 m0, s81, 20480
  s_nop 0
  buffer_load_dwordx4 v56, s[12:15], s80 offen lds
  v_mfma_f32_16x16x32_bf16 v[204:207], v[208:211], v[104:107], v[204:207]
  v_cvt_pk_bf16_f32 v251, v190, v191
  s_waitcnt lgkmcnt(2)
  v_mfma_f32_16x16x32_bf16 v[196:199], v[212:215], v[108:111], v[196:199]
  v_accvgpr_write_b32 a48, v248
  v_mfma_f32_16x16x32_bf16 v[200:203], v[212:215], v[112:115], v[200:203]
  s_add_u32 m0, s81, 21504
  s_nop 0
  buffer_load_dwordx4 v57, s[12:15], s80 offen lds
  v_mfma_f32_16x16x32_bf16 v[204:207], v[212:215], v[116:119], v[204:207]
  v_accvgpr_write_b32 a49, v249
  s_waitcnt lgkmcnt(1)
  v_mfma_f32_16x16x32_bf16 v[196:199], v[216:219], v[120:123], v[196:199]
  v_accvgpr_write_b32 a128, v250
  v_mfma_f32_16x16x32_bf16 v[200:203], v[216:219], v[124:127], v[200:203]
  s_add_u32 m0, s81, 22528
  s_nop 0
  buffer_load_dwordx4 v58, s[12:15], s80 offen lds
  v_mfma_f32_16x16x32_bf16 v[204:207], v[216:219], v[128:131], v[204:207]
  v_accvgpr_write_b32 a129, v251
  s_waitcnt lgkmcnt(0)
  v_mfma_f32_16x16x32_bf16 v[196:199], v[220:223], v[132:135], v[196:199]
  v_cvt_pk_bf16_f32 v168, v192, v193
  v_cvt_pk_bf16_f32 v169, v194, v195
  v_mfma_f32_16x16x32_bf16 v[200:203], v[220:223], v[136:139], v[200:203]
  s_add_u32 m0, s81, 23552
  s_nop 0
  buffer_load_dwordx4 v59, s[12:15], s80 offen lds
  s_add_u32 s80, s80, 393216
  v_mfma_f32_16x16x32_bf16 v[204:207], v[220:223], v[140:143], v[204:207]
  s_waitcnt vmcnt(12)
  ds_read_b128 v[208:211], v70 offset:0
  ds_read_b128 v[212:215], v71 offset:0
  ds_read_b128 v[216:219], v70 offset:128
  s_waitcnt lgkmcnt(2)
  v_mfma_f32_16x16x32_bf16 v[184:187], v[208:211], v[72:75], 0
  ds_read_b128 v[220:223], v71 offset:128
  v_mfma_f32_16x16x32_bf16 v[188:191], v[208:211], v[76:79], 0
  s_add_u32 m0, s81, 24576
  s_nop 0
  buffer_load_dwordx4 v48, s[12:15], s80 offen lds
  v_mfma_f32_16x16x32_bf16 v[192:195], v[208:211], v[80:83], 0
  s_waitcnt lgkmcnt(2)
  v_mfma_f32_16x16x32_bf16 v[184:187], v[212:215], v[84:87], v[184:187]
  ds_read_b128 v[208:211], v70 offset:256
  v_cvt_pk_bf16_f32 v248, v196, v197
  v_mfma_f32_16x16x32_bf16 v[188:191], v[212:215], v[88:91], v[188:191]
  s_add_u32 m0, s81, 25600
  s_nop 0
  buffer_load_dwordx4 v49, s[12:15], s80 offen lds
  v_mfma_f32_16x16x32_bf16 v[192:195], v[212:215], v[92:95], v[192:195]
  v_cvt_pk_bf16_f32 v249, v198, v199
  s_waitcnt lgkmcnt(2)
  v_mfma_f32_16x16x32_bf16 v[184:187], v[216:219], v[96:99], v[184:187]
  ds_read_b128 v[212:215], v71 offset:256
  v_cvt_pk_bf16_f32 v250, v200, v201
  v_mfma_f32_16x16x32_bf16 v[188:191], v[216:219], v[100:103], v[188:191]
  s_add_u32 m0, s81, 26624
  s_nop 0
  buffer_load_dwordx4 v50, s[12:15], s80 offen lds
  v_mfma_f32_16x16x32_bf16 v[192:195], v[216:219], v[104:107], v[192:195]
  v_cvt_pk_bf16_f32 v251, v202, v203
  s_waitcnt lgkmcnt(2)
  v_mfma_f32_16x16x32_bf16 v[184:187], v[220:223], v[108:111], v[184:187]
  ds_read_b128 v[216:219], v70 offset:768
  v_accvgpr_write_b32 a50, v248
  v_mfma_f32_16x16x32_bf16 v[188:191], v[220:223], v[112:115], v[188:191]
  s_add_u32 m0, s81, 27648
  s_nop 0
  buffer_load_dwordx4 v51, s[12:15], s80 offen lds
  v_mfma_f32_16x16x32_bf16 v[192:195], v[220:223], v[116:119], v[192:195]
  v_accvgpr_write_b32 a51, v249
  s_waitcnt lgkmcnt(2)
  v_mfma_f32_16x16x32_bf16 v[184:187], v[208:211], v[120:123], v[184:187]
  ds_read_b128 v[220:223], v71 offset:768
  v_accvgpr_write_b32 a130, v250
  v_mfma_f32_16x16x32_bf16 v[188:191], v[208:211], v[124:127], v[188:191]
  s_add_u32 m0, s81, 28672
  s_nop 0
  buffer_load_dwordx4 v52, s[12:15], s80 offen lds
  v_mfma_f32_16x16x32_bf16 v[192:195], v[208:211], v[128:131], v[192:195]
  v_accvgpr_write_b32 a131, v251
  s_waitcnt lgkmcnt(2)
  v_mfma_f32_16x16x32_bf16 v[184:187], v[212:215], v[132:135], v[184:187]
  ds_read_b128 v[208:211], v70 offset:896
  s_mov_b64 exec, s[68:69]
  v_cvt_pk_bf16_f32 v168, v204, v205
  v_cvt_pk_bf16_f32 v169, v206, v207
  s_mov_b64 exec, -1
  v_mfma_f32_16x16x32_bf16 v[188:191], v[212:215], v[136:139], v[188:191]
  s_add_u32 m0, s81, 29696
  s_nop 0
  buffer_load_dwordx4 v53, s[12:15], s80 offen lds
  v_mfma_f32_16x16x32_bf16 v[192:195], v[212:215], v[140:143], v[192:195]
  s_waitcnt lgkmcnt(2)
  v_mfma_f32_16x16x32_bf16 v[196:199], v[216:219], v[72:75], 0
  ds_read_b128 v[212:215], v71 offset:896
  v_mfma_f32_16x16x32_bf16 v[200:203], v[216:219], v[76:79], 0
  s_add_u32 m0, s81, 30720
  s_nop 0
  buffer_load_dwordx4 v54, s[12:15], s80 offen lds
  v_mfma_f32_16x16x32_bf16 v[204:207], v[216:219], v[80:83], 0
  s_waitcnt lgkmcnt(2)
  v_mfma_f32_16x16x32_bf16 v[196:199], v[220:223], v[84:87], v[196:199]
  ds_read_b128 v[216:219], v70 offset:1024
  v_cvt_pk_bf16_f32 v248, v184, v185
  v_mfma_f32_16x16x32_bf16 v[200:203], v[220:223], v[88:91], v[200:203]
  s_add_u32 m0, s81, 31744
  s_nop 0
  buffer_load_dwordx4 v55, s[12:15], s80 offen lds
  v_mfma_f32_16x16x32_bf16 v[204:207], v[220:223], v[92:95], v[204:207]
  v_cvt_pk_bf16_f32 v249, v186, v187
  s_waitcnt lgkmcnt(2)
  v_mfma_f32_16x16x32_bf16 v[196:199], v[208:211], v[96:99], v[196:199]
  ds_read_b128 v[220:223], v71 offset:1024
  v_cvt_pk_bf16_f32 v250, v188, v189
  v_mfma_f32_16x16x32_bf16 v[200:203], v[208:211], v[100:103], v[200:203]
  s_add_u32 m0, s81, 32768
  s_nop 0
  buffer_load_dwordx4 v56, s[12:15], s80 offen lds
  v_mfma_f32_16x16x32_bf16 v[204:207], v[208:211], v[104:107], v[204:207]
  v_cvt_pk_bf16_f32 v251, v190, v191
  s_waitcnt lgkmcnt(2)
  v_mfma_f32_16x16x32_bf16 v[196:199], v[212:215], v[108:111], v[196:199]
  v_accvgpr_write_b32 a52, v248
  v_mfma_f32_16x16x32_bf16 v[200:203], v[212:215], v[112:115], v[200:203]
  s_add_u32 m0, s81, 33792
  s_nop 0
  buffer_load_dwordx4 v57, s[12:15], s80 offen lds
  v_mfma_f32_16x16x32_bf16 v[204:207], v[212:215], v[116:119], v[204:207]
  v_accvgpr_write_b32 a53, v249
  s_waitcnt lgkmcnt(1)
  v_mfma_f32_16x16x32_bf16 v[196:199], v[216:219], v[120:123], v[196:199]
  v_accvgpr_write_b32 a132, v250
  v_mfma_f32_16x16x32_bf16 v[200:203], v[216:219], v[124:127], v[200:203]
  s_add_u32 m0, s81, 34816
  s_nop 0
  buffer_load_dwordx4 v58, s[12:15], s80 offen lds
  v_mfma_f32_16x16x32_bf16 v[204:207], v[216:219], v[128:131], v[204:207]
  v_accvgpr_write_b32 a133, v251
  s_waitcnt lgkmcnt(0)
  v_mfma_f32_16x16x32_bf16 v[196:199], v[220:223], v[132:135], v[196:199]
  v_cvt_pk_bf16_f32 v170, v192, v193
  v_cvt_pk_bf16_f32 v171, v194, v195
  v_mfma_f32_16x16x32_bf16 v[200:203], v[220:223], v[136:139], v[200:203]
  s_add_u32 m0, s81, 35840
  s_nop 0
  buffer_load_dwordx4 v59, s[12:15], s80 offen lds
  s_add_u32 s80, s80, 393216
  v_mfma_f32_16x16x32_bf16 v[204:207], v[220:223], v[140:143], v[204:207]
  s_waitcnt vmcnt(12)
  ds_read_b128 v[208:211], v70 offset:12288
  ds_read_b128 v[212:215], v71 offset:12288
  ds_read_b128 v[216:219], v70 offset:12416
  s_waitcnt lgkmcnt(2)
  v_mfma_f32_16x16x32_bf16 v[184:187], v[208:211], v[72:75], 0
  ds_read_b128 v[220:223], v71 offset:12416
  v_mfma_f32_16x16x32_bf16 v[188:191], v[208:211], v[76:79], 0
  s_add_u32 m0, s81, 0
  s_nop 0
  buffer_load_dwordx4 v48, s[12:15], s80 offen lds
  v_mfma_f32_16x16x32_bf16 v[192:195], v[208:211], v[80:83], 0
  s_waitcnt lgkmcnt(2)
  v_mfma_f32_16x16x32_bf16 v[184:187], v[212:215], v[84:87], v[184:187]
  ds_read_b128 v[208:211], v70 offset:12544
  v_cvt_pk_bf16_f32 v248, v196, v197
  v_mfma_f32_16x16x32_bf16 v[188:191], v[212:215], v[88:91], v[188:191]
  s_add_u32 m0, s81, 1024
  s_nop 0
  buffer_load_dwordx4 v49, s[12:15], s80 offen lds
  v_mfma_f32_16x16x32_bf16 v[192:195], v[212:215], v[92:95], v[192:195]
  v_cvt_pk_bf16_f32 v249, v198, v199
  s_waitcnt lgkmcnt(2)
  v_mfma_f32_16x16x32_bf16 v[184:187], v[216:219], v[96:99], v[184:187]
  ds_read_b128 v[212:215], v71 offset:12544
  v_cvt_pk_bf16_f32 v250, v200, v201
  v_mfma_f32_16x16x32_bf16 v[188:191], v[216:219], v[100:103], v[188:191]
  s_add_u32 m0, s81, 2048
  s_nop 0
  buffer_load_dwordx4 v50, s[12:15], s80 offen lds
  v_mfma_f32_16x16x32_bf16 v[192:195], v[216:219], v[104:107], v[192:195]
  v_cvt_pk_bf16_f32 v251, v202, v203
  s_waitcnt lgkmcnt(2)
  v_mfma_f32_16x16x32_bf16 v[184:187], v[220:223], v[108:111], v[184:187]
  ds_read_b128 v[216:219], v70 offset:13056
  v_accvgpr_write_b32 a54, v248
  v_mfma_f32_16x16x32_bf16 v[188:191], v[220:223], v[112:115], v[188:191]
  s_add_u32 m0, s81, 3072
  s_nop 0
  buffer_load_dwordx4 v51, s[12:15], s80 offen lds
  v_mfma_f32_16x16x32_bf16 v[192:195], v[220:223], v[116:119], v[192:195]
  v_accvgpr_write_b32 a55, v249
  s_waitcnt lgkmcnt(2)
  v_mfma_f32_16x16x32_bf16 v[184:187], v[208:211], v[120:123], v[184:187]
  ds_read_b128 v[220:223], v71 offset:13056
  v_accvgpr_write_b32 a134, v250
  v_mfma_f32_16x16x32_bf16 v[188:191], v[208:211], v[124:127], v[188:191]
  s_add_u32 m0, s81, 4096
  s_nop 0
  buffer_load_dwordx4 v52, s[12:15], s80 offen lds
  v_mfma_f32_16x16x32_bf16 v[192:195], v[208:211], v[128:131], v[192:195]
  v_accvgpr_write_b32 a135, v251
  s_waitcnt lgkmcnt(2)
  v_mfma_f32_16x16x32_bf16 v[184:187], v[212:215], v[132:135], v[184:187]
  ds_read_b128 v[208:211], v70 offset:13184
  s_mov_b64 exec, s[68:69]
  v_cvt_pk_bf16_f32 v170, v204, v205
  v_cvt_pk_bf16_f32 v171, v206, v207
  s_mov_b64 exec, -1
  v_mfma_f32_16x16x32_bf16 v[188:191], v[212:215], v[136:139], v[188:191]
  s_add_u32 m0, s81, 5120
  s_nop 0
  buffer_load_dwordx4 v53, s[12:15], s80 offen lds
  v_mfma_f32_16x16x32_bf16 v[192:195], v[212:215], v[140:143], v[192:195]
  s_waitcnt lgkmcnt(2)
  v_mfma_f32_16x16x32_bf16 v[196:199], v[216:219], v[72:75], 0
  ds_read_b128 v[212:215], v71 offset:13184
  v_mfma_f32_16x16x32_bf16 v[200:203], v[216:219], v[76:79], 0
  s_add_u32 m0, s81, 6144
  s_nop 0
  buffer_load_dwordx4 v54, s[12:15], s80 offen lds
  v_mfma_f32_16x16x32_bf16 v[204:207], v[216:219], v[80:83], 0
  s_waitcnt lgkmcnt(2)
  v_mfma_f32_16x16x32_bf16 v[196:199], v[220:223], v[84:87], v[196:199]
  ds_read_b128 v[216:219], v70 offset:13312
  v_cvt_pk_bf16_f32 v248, v184, v185
  v_mfma_f32_16x16x32_bf16 v[200:203], v[220:223], v[88:91], v[200:203]
  s_add_u32 m0, s81, 7168
  s_nop 0
  buffer_load_dwordx4 v55, s[12:15], s80 offen lds
  v_mfma_f32_16x16x32_bf16 v[204:207], v[220:223], v[92:95], v[204:207]
  v_cvt_pk_bf16_f32 v249, v186, v187
  s_waitcnt lgkmcnt(2)
  v_mfma_f32_16x16x32_bf16 v[196:199], v[208:211], v[96:99], v[196:199]
  ds_read_b128 v[220:223], v71 offset:13312
  v_cvt_pk_bf16_f32 v250, v188, v189
  v_mfma_f32_16x16x32_bf16 v[200:203], v[208:211], v[100:103], v[200:203]
  s_add_u32 m0, s81, 8192
  s_nop 0
  buffer_load_dwordx4 v56, s[12:15], s80 offen lds
  v_mfma_f32_16x16x32_bf16 v[204:207], v[208:211], v[104:107], v[204:207]
  v_cvt_pk_bf16_f32 v251, v190, v191
  s_waitcnt lgkmcnt(2)
  v_mfma_f32_16x16x32_bf16 v[196:199], v[212:215], v[108:111], v[196:199]
  v_accvgpr_write_b32 a56, v248
  v_mfma_f32_16x16x32_bf16 v[200:203], v[212:215], v[112:115], v[200:203]
  s_add_u32 m0, s81, 9216
  s_nop 0
  buffer_load_dwordx4 v57, s[12:15], s80 offen lds
  v_mfma_f32_16x16x32_bf16 v[204:207], v[212:215], v[116:119], v[204:207]
  v_accvgpr_write_b32 a57, v249
  s_waitcnt lgkmcnt(1)
  v_mfma_f32_16x16x32_bf16 v[196:199], v[216:219], v[120:123], v[196:199]
  v_accvgpr_write_b32 a136, v250
  v_mfma_f32_16x16x32_bf16 v[200:203], v[216:219], v[124:127], v[200:203]
  s_add_u32 m0, s81, 10240
  s_nop 0
  buffer_load_dwordx4 v58, s[12:15], s80 offen lds
  v_mfma_f32_16x16x32_bf16 v[204:207], v[216:219], v[128:131], v[204:207]
  v_accvgpr_write_b32 a137, v251
  s_waitcnt lgkmcnt(0)
  v_mfma_f32_16x16x32_bf16 v[196:199], v[220:223], v[132:135], v[196:199]
  v_cvt_pk_bf16_f32 v172, v192, v193
  v_cvt_pk_bf16_f32 v173, v194, v195
  v_mfma_f32_16x16x32_bf16 v[200:203], v[220:223], v[136:139], v[200:203]
  s_add_u32 m0, s81, 11264
  s_nop 0
  buffer_load_dwordx4 v59, s[12:15], s80 offen lds
  s_add_u32 s80, s80, 393216
  v_mfma_f32_16x16x32_bf16 v[204:207], v[220:223], v[140:143], v[204:207]
  s_waitcnt vmcnt(12)
  ds_read_b128 v[208:211], v70 offset:24576
  ds_read_b128 v[212:215], v71 offset:24576
  ds_read_b128 v[216:219], v70 offset:24704
  s_waitcnt lgkmcnt(2)
  v_mfma_f32_16x16x32_bf16 v[184:187], v[208:211], v[72:75], 0
  ds_read_b128 v[220:223], v71 offset:24704
  v_mfma_f32_16x16x32_bf16 v[188:191], v[208:211], v[76:79], 0
  s_add_u32 m0, s81, 12288
  s_nop 0
  buffer_load_dwordx4 v48, s[12:15], s80 offen lds
  v_mfma_f32_16x16x32_bf16 v[192:195], v[208:211], v[80:83], 0
  s_waitcnt lgkmcnt(2)
  v_mfma_f32_16x16x32_bf16 v[184:187], v[212:215], v[84:87], v[184:187]
  ds_read_b128 v[208:211], v70 offset:24832
  v_cvt_pk_bf16_f32 v248, v196, v197
  v_mfma_f32_16x16x32_bf16 v[188:191], v[212:215], v[88:91], v[188:191]
  s_add_u32 m0, s81, 13312
  s_nop 0
  buffer_load_dwordx4 v49, s[12:15], s80 offen lds
  v_mfma_f32_16x16x32_bf16 v[192:195], v[212:215], v[92:95], v[192:195]
  v_cvt_pk_bf16_f32 v249, v198, v199
  s_waitcnt lgkmcnt(2)
  v_mfma_f32_16x16x32_bf16 v[184:187], v[216:219], v[96:99], v[184:187]
  ds_read_b128 v[212:215], v71 offset:24832
  v_cvt_pk_bf16_f32 v250, v200, v201
  v_mfma_f32_16x16x32_bf16 v[188:191], v[216:219], v[100:103], v[188:191]
  s_add_u32 m0, s81, 14336
  s_nop 0
  buffer_load_dwordx4 v50, s[12:15], s80 offen lds
  v_mfma_f32_16x16x32_bf16 v[192:195], v[216:219], v[104:107], v[192:195]
  v_cvt_pk_bf16_f32 v251, v202, v203
  s_waitcnt lgkmcnt(2)
  v_mfma_f32_16x16x32_bf16 v[184:187], v[220:223], v[108:111], v[184:187]
  ds_read_b128 v[216:219], v70 offset:25344
  v_accvgpr_write_b32 a58, v248
  v_mfma_f32_16x16x32_bf16 v[188:191], v[220:223], v[112:115], v[188:191]
  s_add_u32 m0, s81, 15360
  s_nop 0
  buffer_load_dwordx4 v51, s[12:15], s80 offen lds
  v_mfma_f32_16x16x32_bf16 v[192:195], v[220:223], v[116:119], v[192:195]
  v_accvgpr_write_b32 a59, v249
  s_waitcnt lgkmcnt(2)
  v_mfma_f32_16x16x32_bf16 v[184:187], v[208:211], v[120:123], v[184:187]
  ds_read_b128 v[220:223], v71 offset:25344
  v_accvgpr_write_b32 a138, v250
  v_mfma_f32_16x16x32_bf16 v[188:191], v[208:211], v[124:127], v[188:191]
  s_add_u32 m0, s81, 16384
  s_nop 0
  buffer_load_dwordx4 v52, s[12:15], s80 offen lds
  v_mfma_f32_16x16x32_bf16 v[192:195], v[208:211], v[128:131], v[192:195]
  v_accvgpr_write_b32 a139, v251
  s_waitcnt lgkmcnt(2)
  v_mfma_f32_16x16x32_bf16 v[184:187], v[212:215], v[132:135], v[184:187]
  ds_read_b128 v[208:211], v70 offset:25472
  s_mov_b64 exec, s[68:69]
  v_cvt_pk_bf16_f32 v172, v204, v205
  v_cvt_pk_bf16_f32 v173, v206, v207
  s_mov_b64 exec, -1
  v_mfma_f32_16x16x32_bf16 v[188:191], v[212:215], v[136:139], v[188:191]
  s_add_u32 m0, s81, 17408
  s_nop 0
  buffer_load_dwordx4 v53, s[12:15], s80 offen lds
  v_mfma_f32_16x16x32_bf16 v[192:195], v[212:215], v[140:143], v[192:195]
  s_waitcnt lgkmcnt(2)
  v_mfma_f32_16x16x32_bf16 v[196:199], v[216:219], v[72:75], 0
  ds_read_b128 v[212:215], v71 offset:25472
  v_mfma_f32_16x16x32_bf16 v[200:203], v[216:219], v[76:79], 0
  s_add_u32 m0, s81, 18432
  s_nop 0
  buffer_load_dwordx4 v54, s[12:15], s80 offen lds
  v_mfma_f32_16x16x32_bf16 v[204:207], v[216:219], v[80:83], 0
  s_waitcnt lgkmcnt(2)
  v_mfma_f32_16x16x32_bf16 v[196:199], v[220:223], v[84:87], v[196:199]
  ds_read_b128 v[216:219], v70 offset:25600
  v_cvt_pk_bf16_f32 v248, v184, v185
  v_mfma_f32_16x16x32_bf16 v[200:203], v[220:223], v[88:91], v[200:203]
  s_add_u32 m0, s81, 19456
  s_nop 0
  buffer_load_dwordx4 v55, s[12:15], s80 offen lds
  v_mfma_f32_16x16x32_bf16 v[204:207], v[220:223], v[92:95], v[204:207]
  v_cvt_pk_bf16_f32 v249, v186, v187
  s_waitcnt lgkmcnt(2)
  v_mfma_f32_16x16x32_bf16 v[196:199], v[208:211], v[96:99], v[196:199]
  ds_read_b128 v[220:223], v71 offset:25600
  v_cvt_pk_bf16_f32 v250, v188, v189
  v_mfma_f32_16x16x32_bf16 v[200:203], v[208:211], v[100:103], v[200:203]
  s_add_u32 m0, s81, 20480
  s_nop 0
  buffer_load_dwordx4 v56, s[12:15], s80 offen lds
  v_mfma_f32_16x16x32_bf16 v[204:207], v[208:211], v[104:107], v[204:207]
  v_cvt_pk_bf16_f32 v251, v190, v191
  s_waitcnt lgkmcnt(2)
  v_mfma_f32_16x16x32_bf16 v[196:199], v[212:215], v[108:111], v[196:199]
  v_accvgpr_write_b32 a60, v248
  v_mfma_f32_16x16x32_bf16 v[200:203], v[212:215], v[112:115], v[200:203]
  s_add_u32 m0, s81, 21504
  s_nop 0
  buffer_load_dwordx4 v57, s[12:15], s80 offen lds
  v_mfma_f32_16x16x32_bf16 v[204:207], v[212:215], v[116:119], v[204:207]
  v_accvgpr_write_b32 a61, v249
  s_waitcnt lgkmcnt(1)
  v_mfma_f32_16x16x32_bf16 v[196:199], v[216:219], v[120:123], v[196:199]
  v_accvgpr_write_b32 a140, v250
  v_mfma_f32_16x16x32_bf16 v[200:203], v[216:219], v[124:127], v[200:203]
  s_add_u32 m0, s81, 22528
  s_nop 0
  buffer_load_dwordx4 v58, s[12:15], s80 offen lds
  v_mfma_f32_16x16x32_bf16 v[204:207], v[216:219], v[128:131], v[204:207]
  v_accvgpr_write_b32 a141, v251
  s_waitcnt lgkmcnt(0)
  v_mfma_f32_16x16x32_bf16 v[196:199], v[220:223], v[132:135], v[196:199]
  v_cvt_pk_bf16_f32 v174, v192, v193
  v_cvt_pk_bf16_f32 v175, v194, v195
  v_mfma_f32_16x16x32_bf16 v[200:203], v[220:223], v[136:139], v[200:203]
  s_add_u32 m0, s81, 23552
  s_nop 0
  buffer_load_dwordx4 v59, s[12:15], s80 offen lds
  s_add_u32 s80, s80, 393216
  v_mfma_f32_16x16x32_bf16 v[204:207], v[220:223], v[140:143], v[204:207]
  s_waitcnt vmcnt(12)
  ds_read_b128 v[208:211], v70 offset:0
  ds_read_b128 v[212:215], v71 offset:0
  ds_read_b128 v[216:219], v70 offset:128
  s_waitcnt lgkmcnt(2)
  v_mfma_f32_16x16x32_bf16 v[184:187], v[208:211], v[72:75], 0
  ds_read_b128 v[220:223], v71 offset:128
  v_mfma_f32_16x16x32_bf16 v[188:191], v[208:211], v[76:79], 0
  s_add_u32 m0, s81, 24576
  s_nop 0
  buffer_load_dwordx4 v48, s[12:15], s80 offen lds
  v_mfma_f32_16x16x32_bf16 v[192:195], v[208:211], v[80:83], 0
  s_waitcnt lgkmcnt(2)
  v_mfma_f32_16x16x32_bf16 v[184:187], v[212:215], v[84:87], v[184:187]
  ds_read_b128 v[208:211], v70 offset:256
  v_cvt_pk_bf16_f32 v248, v196, v197
  v_mfma_f32_16x16x32_bf16 v[188:191], v[212:215], v[88:91], v[188:191]
  s_add_u32 m0, s81, 25600
  s_nop 0
  buffer_load_dwordx4 v49, s[12:15], s80 offen lds
  v_mfma_f32_16x16x32_bf16 v[192:195], v[212:215], v[92:95], v[192:195]
  v_cvt_pk_bf16_f32 v249, v198, v199
  s_waitcnt lgkmcnt(2)
  v_mfma_f32_16x16x32_bf16 v[184:187], v[216:219], v[96:99], v[184:187]
  ds_read_b128 v[212:215], v71 offset:256
  v_cvt_pk_bf16_f32 v250, v200, v201
  v_mfma_f32_16x16x32_bf16 v[188:191], v[216:219], v[100:103], v[188:191]
  s_add_u32 m0, s81, 26624
  s_nop 0
  buffer_load_dwordx4 v50, s[12:15], s80 offen lds
  v_mfma_f32_16x16x32_bf16 v[192:195], v[216:219], v[104:107], v[192:195]
  v_cvt_pk_bf16_f32 v251, v202, v203
  s_waitcnt lgkmcnt(2)
  v_mfma_f32_16x16x32_bf16 v[184:187], v[220:223], v[108:111], v[184:187]
  ds_read_b128 v[216:219], v70 offset:768
  v_accvgpr_write_b32 a62, v248
  v_mfma_f32_16x16x32_bf16 v[188:191], v[220:223], v[112:115], v[188:191]
  s_add_u32 m0, s81, 27648
  s_nop 0
  buffer_load_dwordx4 v51, s[12:15], s80 offen lds
  v_mfma_f32_16x16x32_bf16 v[192:195], v[220:223], v[116:119], v[192:195]
  v_accvgpr_write_b32 a63, v249
  s_waitcnt lgkmcnt(2)
  v_mfma_f32_16x16x32_bf16 v[184:187], v[208:211], v[120:123], v[184:187]
  ds_read_b128 v[220:223], v71 offset:768
  v_accvgpr_write_b32 a142, v250
  v_mfma_f32_16x16x32_bf16 v[188:191], v[208:211], v[124:127], v[188:191]
  s_add_u32 m0, s81, 28672
  s_nop 0
  buffer_load_dwordx4 v52, s[12:15], s80 offen lds
  v_mfma_f32_16x16x32_bf16 v[192:195], v[208:211], v[128:131], v[192:195]
  v_accvgpr_write_b32 a143, v251
  s_waitcnt lgkmcnt(2)
  v_mfma_f32_16x16x32_bf16 v[184:187], v[212:215], v[132:135], v[184:187]
  ds_read_b128 v[208:211], v70 offset:896
  s_mov_b64 exec, s[68:69]
  v_cvt_pk_bf16_f32 v174, v204, v205
  v_cvt_pk_bf16_f32 v175, v206, v207
  s_mov_b64 exec, -1
  v_mfma_f32_16x16x32_bf16 v[188:191], v[212:215], v[136:139], v[188:191]
  s_add_u32 m0, s81, 29696
  s_nop 0
  buffer_load_dwordx4 v53, s[12:15], s80 offen lds
  v_mfma_f32_16x16x32_bf16 v[192:195], v[212:215], v[140:143], v[192:195]
  s_waitcnt lgkmcnt(2)
  v_mfma_f32_16x16x32_bf16 v[196:199], v[216:219], v[72:75], 0
  ds_read_b128 v[212:215], v71 offset:896
  v_mfma_f32_16x16x32_bf16 v[200:203], v[216:219], v[76:79], 0
  s_add_u32 m0, s81, 30720
  s_nop 0
  buffer_load_dwordx4 v54, s[12:15], s80 offen lds
  v_mfma_f32_16x16x32_bf16 v[204:207], v[216:219], v[80:83], 0
  s_waitcnt lgkmcnt(2)
  v_mfma_f32_16x16x32_bf16 v[196:199], v[220:223], v[84:87], v[196:199]
  ds_read_b128 v[216:219], v70 offset:1024
  v_cvt_pk_bf16_f32 v248, v184, v185
  v_mfma_f32_16x16x32_bf16 v[200:203], v[220:223], v[88:91], v[200:203]
  s_add_u32 m0, s81, 31744
  s_nop 0
  buffer_load_dwordx4 v55, s[12:15], s80 offen lds
  v_mfma_f32_16x16x32_bf16 v[204:207], v[220:223], v[92:95], v[204:207]
  v_cvt_pk_bf16_f32 v249, v186, v187
  s_waitcnt lgkmcnt(2)
  v_mfma_f32_16x16x32_bf16 v[196:199], v[208:211], v[96:99], v[196:199]
  ds_read_b128 v[220:223], v71 offset:1024
  v_cvt_pk_bf16_f32 v250, v188, v189
  v_mfma_f32_16x16x32_bf16 v[200:203], v[208:211], v[100:103], v[200:203]
  s_add_u32 m0, s81, 32768
  s_nop 0
  buffer_load_dwordx4 v56, s[12:15], s80 offen lds
  v_mfma_f32_16x16x32_bf16 v[204:207], v[208:211], v[104:107], v[204:207]
  v_cvt_pk_bf16_f32 v251, v190, v191
  s_waitcnt lgkmcnt(2)
  v_mfma_f32_16x16x32_bf16 v[196:199], v[212:215], v[108:111], v[196:199]
  v_accvgpr_write_b32 a64, v248
  v_mfma_f32_16x16x32_bf16 v[200:203], v[212:215], v[112:115], v[200:203]
  s_add_u32 m0, s81, 33792
  s_nop 0
  buffer_load_dwordx4 v57, s[12:15], s80 offen lds
  v_mfma_f32_16x16x32_bf16 v[204:207], v[212:215], v[116:119], v[204:207]
  v_accvgpr_write_b32 a65, v249
  s_waitcnt lgkmcnt(1)
  v_mfma_f32_16x16x32_bf16 v[196:199], v[216:219], v[120:123], v[196:199]
  v_accvgpr_write_b32 a144, v250
  v_mfma_f32_16x16x32_bf16 v[200:203], v[216:219], v[124:127], v[200:203]
  s_add_u32 m0, s81, 34816
  s_nop 0
  buffer_load_dwordx4 v58, s[12:15], s80 offen lds
  v_mfma_f32_16x16x32_bf16 v[204:207], v[216:219], v[128:131], v[204:207]
  v_accvgpr_write_b32 a145, v251
  s_waitcnt lgkmcnt(0)
  v_mfma_f32_16x16x32_bf16 v[196:199], v[220:223], v[132:135], v[196:199]
  v_cvt_pk_bf16_f32 v176, v192, v193
  v_cvt_pk_bf16_f32 v177, v194, v195
  v_mfma_f32_16x16x32_bf16 v[200:203], v[220:223], v[136:139], v[200:203]
  s_add_u32 m0, s81, 35840
  s_nop 0
  buffer_load_dwordx4 v59, s[12:15], s80 offen lds
  s_add_u32 s80, s80, 393216
  v_mfma_f32_16x16x32_bf16 v[204:207], v[220:223], v[140:143], v[204:207]
  s_waitcnt vmcnt(12)
  ds_read_b128 v[208:211], v70 offset:12288
  ds_read_b128 v[212:215], v71 offset:12288
  ds_read_b128 v[216:219], v70 offset:12416
  s_waitcnt lgkmcnt(2)
  v_mfma_f32_16x16x32_bf16 v[184:187], v[208:211], v[72:75], 0
  ds_read_b128 v[220:223], v71 offset:12416
  v_mfma_f32_16x16x32_bf16 v[188:191], v[208:211], v[76:79], 0
  s_add_u32 m0, s81, 0
  s_nop 0
  buffer_load_dwordx4 v48, s[12:15], s80 offen lds
  v_mfma_f32_16x16x32_bf16 v[192:195], v[208:211], v[80:83], 0
  s_waitcnt lgkmcnt(2)
  v_mfma_f32_16x16x32_bf16 v[184:187], v[212:215], v[84:87], v[184:187]
  ds_read_b128 v[208:211], v70 offset:12544
  v_cvt_pk_bf16_f32 v248, v196, v197
  v_mfma_f32_16x16x32_bf16 v[188:191], v[212:215], v[88:91], v[188:191]
  s_add_u32 m0, s81, 1024
  s_nop 0
  buffer_load_dwordx4 v49, s[12:15], s80 offen lds
  v_mfma_f32_16x16x32_bf16 v[192:195], v[212:215], v[92:95], v[192:195]
  v_cvt_pk_bf16_f32 v249, v198, v199
  s_waitcnt lgkmcnt(2)
  v_mfma_f32_16x16x32_bf16 v[184:187], v[216:219], v[96:99], v[184:187]
  ds_read_b128 v[212:215], v71 offset:12544
  v_cvt_pk_bf16_f32 v250, v200, v201
  v_mfma_f32_16x16x32_bf16 v[188:191], v[216:219], v[100:103], v[188:191]
  s_add_u32 m0, s81, 2048
  s_nop 0
  buffer_load_dwordx4 v50, s[12:15], s80 offen lds
  v_mfma_f32_16x16x32_bf16 v[192:195], v[216:219], v[104:107], v[192:195]
  v_cvt_pk_bf16_f32 v251, v202, v203
  s_waitcnt lgkmcnt(2)
  v_mfma_f32_16x16x32_bf16 v[184:187], v[220:223], v[108:111], v[184:187]
  ds_read_b128 v[216:219], v70 offset:13056
  v_accvgpr_write_b32 a66, v248
  v_mfma_f32_16x16x32_bf16 v[188:191], v[220:223], v[112:115], v[188:191]
  s_add_u32 m0, s81, 3072
  s_nop 0
  buffer_load_dwordx4 v51, s[12:15], s80 offen lds
  v_mfma_f32_16x16x32_bf16 v[192:195], v[220:223], v[116:119], v[192:195]
  v_accvgpr_write_b32 a67, v249
  s_waitcnt lgkmcnt(2)
  v_mfma_f32_16x16x32_bf16 v[184:187], v[208:211], v[120:123], v[184:187]
  ds_read_b128 v[220:223], v71 offset:13056
  v_accvgpr_write_b32 a146, v250
  v_mfma_f32_16x16x32_bf16 v[188:191], v[208:211], v[124:127], v[188:191]
  s_add_u32 m0, s81, 4096
  s_nop 0
  buffer_load_dwordx4 v52, s[12:15], s80 offen lds
  v_mfma_f32_16x16x32_bf16 v[192:195], v[208:211], v[128:131], v[192:195]
  v_accvgpr_write_b32 a147, v251
  s_waitcnt lgkmcnt(2)
  v_mfma_f32_16x16x32_bf16 v[184:187], v[212:215], v[132:135], v[184:187]
  ds_read_b128 v[208:211], v70 offset:13184
  s_mov_b64 exec, s[68:69]
  v_cvt_pk_bf16_f32 v176, v204, v205
  v_cvt_pk_bf16_f32 v177, v206, v207
  s_mov_b64 exec, -1
  v_mfma_f32_16x16x32_bf16 v[188:191], v[212:215], v[136:139], v[188:191]
  s_add_u32 m0, s81, 5120
  s_nop 0
  buffer_load_dwordx4 v53, s[12:15], s80 offen lds
  v_mfma_f32_16x16x32_bf16 v[192:195], v[212:215], v[140:143], v[192:195]
  s_waitcnt lgkmcnt(2)
  v_mfma_f32_16x16x32_bf16 v[196:199], v[216:219], v[72:75], 0
  ds_read_b128 v[212:215], v71 offset:13184
  v_mfma_f32_16x16x32_bf16 v[200:203], v[216:219], v[76:79], 0
  s_add_u32 m0, s81, 6144
  s_nop 0
  buffer_load_dwordx4 v54, s[12:15], s80 offen lds
  v_mfma_f32_16x16x32_bf16 v[204:207], v[216:219], v[80:83], 0
  s_waitcnt lgkmcnt(2)
  v_mfma_f32_16x16x32_bf16 v[196:199], v[220:223], v[84:87], v[196:199]
  ds_read_b128 v[216:219], v70 offset:13312
  v_cvt_pk_bf16_f32 v248, v184, v185
  v_mfma_f32_16x16x32_bf16 v[200:203], v[220:223], v[88:91], v[200:203]
  s_add_u32 m0, s81, 7168
  s_nop 0
  buffer_load_dwordx4 v55, s[12:15], s80 offen lds
  v_mfma_f32_16x16x32_bf16 v[204:207], v[220:223], v[92:95], v[204:207]
  v_cvt_pk_bf16_f32 v249, v186, v187
  s_waitcnt lgkmcnt(2)
  v_mfma_f32_16x16x32_bf16 v[196:199], v[208:211], v[96:99], v[196:199]
  ds_read_b128 v[220:223], v71 offset:13312
  v_cvt_pk_bf16_f32 v250, v188, v189
  v_mfma_f32_16x16x32_bf16 v[200:203], v[208:211], v[100:103], v[200:203]
  s_add_u32 m0, s81, 8192
  s_nop 0
  buffer_load_dwordx4 v56, s[12:15], s80 offen lds
  v_mfma_f32_16x16x32_bf16 v[204:207], v[208:211], v[104:107], v[204:207]
  v_cvt_pk_bf16_f32 v251, v190, v191
  s_waitcnt lgkmcnt(2)
  v_mfma_f32_16x16x32_bf16 v[196:199], v[212:215], v[108:111], v[196:199]
  v_accvgpr_write_b32 a68, v248
  v_mfma_f32_16x16x32_bf16 v[200:203], v[212:215], v[112:115], v[200:203]
  s_add_u32 m0, s81, 9216
  s_nop 0
  buffer_load_dwordx4 v57, s[12:15], s80 offen lds
  v_mfma_f32_16x16x32_bf16 v[204:207], v[212:215], v[116:119], v[204:207]
  v_accvgpr_write_b32 a69, v249
  s_waitcnt lgkmcnt(1)
  v_mfma_f32_16x16x32_bf16 v[196:199], v[216:219], v[120:123], v[196:199]
  v_accvgpr_write_b32 a148, v250
  v_mfma_f32_16x16x32_bf16 v[200:203], v[216:219], v[124:127], v[200:203]
  s_add_u32 m0, s81, 10240
  s_nop 0
  buffer_load_dwordx4 v58, s[12:15], s80 offen lds
  v_mfma_f32_16x16x32_bf16 v[204:207], v[216:219], v[128:131], v[204:207]
  v_accvgpr_write_b32 a149, v251
  s_waitcnt lgkmcnt(0)
  v_mfma_f32_16x16x32_bf16 v[196:199], v[220:223], v[132:135], v[196:199]
  v_cvt_pk_bf16_f32 v178, v192, v193
  v_cvt_pk_bf16_f32 v179, v194, v195
  v_mfma_f32_16x16x32_bf16 v[200:203], v[220:223], v[136:139], v[200:203]
  s_add_u32 m0, s81, 11264
  s_nop 0
  buffer_load_dwordx4 v59, s[12:15], s80 offen lds
  s_add_u32 s80, s80, 393216
  v_mfma_f32_16x16x32_bf16 v[204:207], v[220:223], v[140:143], v[204:207]
  s_waitcnt vmcnt(12)
  ds_read_b128 v[208:211], v70 offset:24576
  ds_read_b128 v[212:215], v71 offset:24576
  ds_read_b128 v[216:219], v70 offset:24704
  s_waitcnt lgkmcnt(2)
  v_mfma_f32_16x16x32_bf16 v[184:187], v[208:211], v[72:75], 0
  ds_read_b128 v[220:223], v71 offset:24704
  v_mfma_f32_16x16x32_bf16 v[188:191], v[208:211], v[76:79], 0
  v_mfma_f32_16x16x32_bf16 v[192:195], v[208:211], v[80:83], 0
  s_waitcnt lgkmcnt(2)
  v_mfma_f32_16x16x32_bf16 v[184:187], v[212:215], v[84:87], v[184:187]
  ds_read_b128 v[208:211], v70 offset:24832
  v_cvt_pk_bf16_f32 v248, v196, v197
  v_mfma_f32_16x16x32_bf16 v[188:191], v[212:215], v[88:91], v[188:191]
  v_mfma_f32_16x16x32_bf16 v[192:195], v[212:215], v[92:95], v[192:195]
  v_cvt_pk_bf16_f32 v249, v198, v199
  s_waitcnt lgkmcnt(2)
  v_mfma_f32_16x16x32_bf16 v[184:187], v[216:219], v[96:99], v[184:187]
  ds_read_b128 v[212:215], v71 offset:24832
  v_cvt_pk_bf16_f32 v250, v200, v201
  v_mfma_f32_16x16x32_bf16 v[188:191], v[216:219], v[100:103], v[188:191]
  v_mfma_f32_16x16x32_bf16 v[192:195], v[216:219], v[104:107], v[192:195]
  v_cvt_pk_bf16_f32 v251, v202, v203
  s_waitcnt lgkmcnt(2)
  v_mfma_f32_16x16x32_bf16 v[184:187], v[220:223], v[108:111], v[184:187]
  ds_read_b128 v[216:219], v70 offset:25344
  v_accvgpr_write_b32 a70, v248
  v_mfma_f32_16x16x32_bf16 v[188:191], v[220:223], v[112:115], v[188:191]
  v_mfma_f32_16x16x32_bf16 v[192:195], v[220:223], v[116:119], v[192:195]
  v_accvgpr_write_b32 a71, v249
  s_waitcnt lgkmcnt(2)
  v_mfma_f32_16x16x32_bf16 v[184:187], v[208:211], v[120:123], v[184:187]
  ds_read_b128 v[220:223], v71 offset:25344
  v_accvgpr_write_b32 a150, v250
  v_mfma_f32_16x16x32_bf16 v[188:191], v[208:211], v[124:127], v[188:191]
  v_mfma_f32_16x16x32_bf16 v[192:195], v[208:211], v[128:131], v[192:195]
  v_accvgpr_write_b32 a151, v251
  s_waitcnt lgkmcnt(2)
  v_mfma_f32_16x16x32_bf16 v[184:187], v[212:215], v[132:135], v[184:187]
  ds_read_b128 v[208:211], v70 offset:25472
  s_mov_b64 exec, s[68:69]
  v_cvt_pk_bf16_f32 v178, v204, v205
  v_cvt_pk_bf16_f32 v179, v206, v207
  s_mov_b64 exec, -1
  v_mfma_f32_16x16x32_bf16 v[188:191], v[212:215], v[136:139], v[188:191]
  v_mfma_f32_16x16x32_bf16 v[192:195], v[212:215], v[140:143], v[192:195]
  s_waitcnt lgkmcnt(2)
  v_mfma_f32_16x16x32_bf16 v[196:199], v[216:219], v[72:75], 0
  ds_read_b128 v[212:215], v71 offset:25472
  v_mfma_f32_16x16x32_bf16 v[200:203], v[216:219], v[76:79], 0
  v_mfma_f32_16x16x32_bf16 v[204:207], v[216:219], v[80:83], 0
  s_waitcnt lgkmcnt(2)
  v_mfma_f32_16x16x32_bf16 v[196:199], v[220:223], v[84:87], v[196:199]
  ds_read_b128 v[216:219], v70 offset:25600
  v_cvt_pk_bf16_f32 v248, v184, v185
  v_mfma_f32_16x16x32_bf16 v[200:203], v[220:223], v[88:91], v[200:203]
  v_mfma_f32_16x16x32_bf16 v[204:207], v[220:223], v[92:95], v[204:207]
  v_cvt_pk_bf16_f32 v249, v186, v187
  s_waitcnt lgkmcnt(2)
  v_mfma_f32_16x16x32_bf16 v[196:199], v[208:211], v[96:99], v[196:199]
  ds_read_b128 v[220:223], v71 offset:25600
  v_cvt_pk_bf16_f32 v250, v188, v189
  v_mfma_f32_16x16x32_bf16 v[200:203], v[208:211], v[100:103], v[200:203]
  v_mfma_f32_16x16x32_bf16 v[204:207], v[208:211], v[104:107], v[204:207]
  v_cvt_pk_bf16_f32 v251, v190, v191
  s_waitcnt lgkmcnt(2)
  v_mfma_f32_16x16x32_bf16 v[196:199], v[212:215], v[108:111], v[196:199]
  v_accvgpr_write_b32 a72, v248
  v_mfma_f32_16x16x32_bf16 v[200:203], v[212:215], v[112:115], v[200:203]
  v_mfma_f32_16x16x32_bf16 v[204:207], v[212:215], v[116:119], v[204:207]
  v_accvgpr_write_b32 a73, v249
  s_waitcnt lgkmcnt(1)
  v_mfma_f32_16x16x32_bf16 v[196:199], v[216:219], v[120:123], v[196:199]
  v_accvgpr_write_b32 a152, v250
  v_mfma_f32_16x16x32_bf16 v[200:203], v[216:219], v[124:127], v[200:203]
  v_mfma_f32_16x16x32_bf16 v[204:207], v[216:219], v[128:131], v[204:207]
  v_accvgpr_write_b32 a153, v251
  s_waitcnt lgkmcnt(0)
  v_mfma_f32_16x16x32_bf16 v[196:199], v[220:223], v[132:135], v[196:199]
  v_cvt_pk_bf16_f32 v180, v192, v193
  v_cvt_pk_bf16_f32 v181, v194, v195
  v_mfma_f32_16x16x32_bf16 v[200:203], v[220:223], v[136:139], v[200:203]
  v_mfma_f32_16x16x32_bf16 v[204:207], v[220:223], v[140:143], v[204:207]
  s_waitcnt vmcnt(0)
  ds_read_b128 v[208:211], v70 offset:0
  ds_read_b128 v[212:215], v71 offset:0
  ds_read_b128 v[216:219], v70 offset:128
  s_waitcnt lgkmcnt(2)
  v_mfma_f32_16x16x32_bf16 v[184:187], v[208:211], v[72:75], 0
  ds_read_b128 v[220:223], v71 offset:128
  v_mfma_f32_16x16x32_bf16 v[188:191], v[208:211], v[76:79], 0
  v_mfma_f32_16x16x32_bf16 v[192:195], v[208:211], v[80:83], 0
  s_waitcnt lgkmcnt(2)
  v_mfma_f32_16x16x32_bf16 v[184:187], v[212:215], v[84:87], v[184:187]
  ds_read_b128 v[208:211], v70 offset:256
  v_cvt_pk_bf16_f32 v248, v196, v197
  v_mfma_f32_16x16x32_bf16 v[188:191], v[212:215], v[88:91], v[188:191]
  v_mfma_f32_16x16x32_bf16 v[192:195], v[212:215], v[92:95], v[192:195]
  v_cvt_pk_bf16_f32 v249, v198, v199
  s_waitcnt lgkmcnt(2)
  v_mfma_f32_16x16x32_bf16 v[184:187], v[216:219], v[96:99], v[184:187]
  ds_read_b128 v[212:215], v71 offset:256
  v_cvt_pk_bf16_f32 v250, v200, v201
  v_mfma_f32_16x16x32_bf16 v[188:191], v[216:219], v[100:103], v[188:191]
  v_mfma_f32_16x16x32_bf16 v[192:195], v[216:219], v[104:107], v[192:195]
  v_cvt_pk_bf16_f32 v251, v202, v203
  s_waitcnt lgkmcnt(2)
  v_mfma_f32_16x16x32_bf16 v[184:187], v[220:223], v[108:111], v[184:187]
  ds_read_b128 v[216:219], v70 offset:768
  v_accvgpr_write_b32 a74, v248
  v_mfma_f32_16x16x32_bf16 v[188:191], v[220:223], v[112:115], v[188:191]
  v_mfma_f32_16x16x32_bf16 v[192:195], v[220:223], v[116:119], v[192:195]
  v_accvgpr_write_b32 a75, v249
  s_waitcnt lgkmcnt(2)
  v_mfma_f32_16x16x32_bf16 v[184:187], v[208:211], v[120:123], v[184:187]
  ds_read_b128 v[220:223], v71 offset:768
  v_accvgpr_write_b32 a154, v250
  v_mfma_f32_16x16x32_bf16 v[188:191], v[208:211], v[124:127], v[188:191]
  v_mfma_f32_16x16x32_bf16 v[192:195], v[208:211], v[128:131], v[192:195]
  v_accvgpr_write_b32 a155, v251
  s_waitcnt lgkmcnt(2)
  v_mfma_f32_16x16x32_bf16 v[184:187], v[212:215], v[132:135], v[184:187]
  ds_read_b128 v[208:211], v70 offset:896
  s_mov_b64 exec, s[68:69]
  v_cvt_pk_bf16_f32 v180, v204, v205
  v_cvt_pk_bf16_f32 v181, v206, v207
  s_mov_b64 exec, -1
  v_mfma_f32_16x16x32_bf16 v[188:191], v[212:215], v[136:139], v[188:191]
  v_mfma_f32_16x16x32_bf16 v[192:195], v[212:215], v[140:143], v[192:195]
  s_waitcnt lgkmcnt(2)
  v_mfma_f32_16x16x32_bf16 v[196:199], v[216:219], v[72:75], 0
  ds_read_b128 v[212:215], v71 offset:896
  v_mfma_f32_16x16x32_bf16 v[200:203], v[216:219], v[76:79], 0
  v_mfma_f32_16x16x32_bf16 v[204:207], v[216:219], v[80:83], 0
  s_waitcnt lgkmcnt(2)
  v_mfma_f32_16x16x32_bf16 v[196:199], v[220:223], v[84:87], v[196:199]
  ds_read_b128 v[216:219], v70 offset:1024
  v_cvt_pk_bf16_f32 v248, v184, v185
  v_mfma_f32_16x16x32_bf16 v[200:203], v[220:223], v[88:91], v[200:203]
  v_mfma_f32_16x16x32_bf16 v[204:207], v[220:223], v[92:95], v[204:207]
  v_cvt_pk_bf16_f32 v249, v186, v187
  s_waitcnt lgkmcnt(2)
  v_mfma_f32_16x16x32_bf16 v[196:199], v[208:211], v[96:99], v[196:199]
  ds_read_b128 v[220:223], v71 offset:1024
  v_cvt_pk_bf16_f32 v250, v188, v189
  v_mfma_f32_16x16x32_bf16 v[200:203], v[208:211], v[100:103], v[200:203]
  v_mfma_f32_16x16x32_bf16 v[204:207], v[208:211], v[104:107], v[204:207]
  v_cvt_pk_bf16_f32 v251, v190, v191
  s_waitcnt lgkmcnt(2)
  v_mfma_f32_16x16x32_bf16 v[196:199], v[212:215], v[108:111], v[196:199]
  v_accvgpr_write_b32 a76, v248
  v_mfma_f32_16x16x32_bf16 v[200:203], v[212:215], v[112:115], v[200:203]
  v_mfma_f32_16x16x32_bf16 v[204:207], v[212:215], v[116:119], v[204:207]
  v_accvgpr_write_b32 a77, v249
  s_waitcnt lgkmcnt(1)
  v_mfma_f32_16x16x32_bf16 v[196:199], v[216:219], v[120:123], v[196:199]
  v_accvgpr_write_b32 a156, v250
  v_mfma_f32_16x16x32_bf16 v[200:203], v[216:219], v[124:127], v[200:203]
  v_mfma_f32_16x16x32_bf16 v[204:207], v[216:219], v[128:131], v[204:207]
  v_accvgpr_write_b32 a157, v251
  s_waitcnt lgkmcnt(0)
  v_mfma_f32_16x16x32_bf16 v[196:199], v[220:223], v[132:135], v[196:199]
  v_cvt_pk_bf16_f32 v182, v192, v193
  v_cvt_pk_bf16_f32 v183, v194, v195
  v_mfma_f32_16x16x32_bf16 v[200:203], v[220:223], v[136:139], v[200:203]
  v_mfma_f32_16x16x32_bf16 v[204:207], v[220:223], v[140:143], v[204:207]
  s_nop 7
  v_cvt_pk_bf16_f32 v248, v196, v197
  v_cvt_pk_bf16_f32 v249, v198, v199
  v_cvt_pk_bf16_f32 v250, v200, v201
  v_cvt_pk_bf16_f32 v251, v202, v203
  v_accvgpr_write_b32 a78, v248
  v_accvgpr_write_b32 a79, v249
  v_accvgpr_write_b32 a158, v250
  v_accvgpr_write_b32 a159, v251
  s_mov_b64 exec, s[68:69]
  v_cvt_pk_bf16_f32 v182, v204, v205
  v_cvt_pk_bf16_f32 v183, v206, v207
  s_mov_b64 exec, -1
  s_waitcnt vmcnt(0)
  s_barrier
  s_mul_i32 s21, s20, 15360
  v_add_u32 v66, s21, v4
  v_add_u32 v67, 61440, v66
  ds_write_b128 v66, a[160:163] offset:0
  ds_write_b128 v66, a[164:167] offset:1024
  ds_write_b128 v66, a[168:171] offset:2048
  ds_write_b128 v66, a[172:175] offset:3072
  ds_write_b128 v66, a[176:179] offset:4096
  ds_write_b128 v66, a[180:183] offset:5120
  ds_write_b128 v66, a[184:187] offset:6144
  ds_write_b128 v66, a[188:191] offset:7168
  ds_write_b128 v66, a[192:195] offset:8192
  ds_write_b128 v66, a[196:199] offset:9216
  ds_write_b128 v66, a[200:203] offset:10240
  ds_write_b128 v66, a[204:207] offset:11264
  ds_write_b128 v66, a[208:211] offset:12288
  ds_write_b128 v66, a[212:215] offset:13312
  ds_write_b128 v66, a[216:219] offset:14336
  ds_write_b128 v67, a[220:223] offset:0
  ds_write_b128 v67, a[224:227] offset:1024
  ds_write_b128 v67, a[228:231] offset:2048
  ds_write_b128 v67, a[232:235] offset:3072
  ds_write_b128 v67, a[236:239] offset:4096
  ds_write_b128 v67, a[240:243] offset:5120
  ds_write_b128 v67, a[244:247] offset:6144
  ds_write_b128 v67, a[248:251] offset:7168
  ds_write_b128 v67, a[252:255] offset:8192
  ds_write_b128 v67, v[224:227] offset:9216
  ds_write_b128 v67, v[228:231] offset:10240
  ds_write_b128 v67, v[232:235] offset:11264
  ds_write_b128 v67, v[236:239] offset:12288
  ds_write_b128 v67, v[240:243] offset:13312
  ds_write_b128 v67, v[244:247] offset:14336
  s_lshr_b32 s21, s20, 1
  s_mul_i32 s21, s21, 20480
  s_and_b32 s22, s20, 1
  s_lshl_b32 s22, s22, 7
  s_add_u32 s21, s21, s22
  s_add_u32 s21, s21, 122880
  v_and_b32 v68, 7, v2
  v_lshlrev_b32 v68, 4, v68
  v_lshl_add_u32 v68, v3, 8, v68
  v_and_b32 v69, 8, v2
  v_add3_u32 v68, s21, v68, v69
  ds_write_b64 v68, v[144:145] offset:0
  ds_write_b64 v68, v[146:147] offset:1024
  ds_write_b64 v68, v[148:149] offset:2048
  ds_write_b64 v68, v[150:151] offset:3072
  ds_write_b64 v68, v[152:153] offset:4096
  ds_write_b64 v68, v[154:155] offset:5120
  ds_write_b64 v68, v[156:157] offset:6144
  ds_write_b64 v68, v[158:159] offset:7168
  ds_write_b64 v68, v[160:161] offset:8192
  ds_write_b64 v68, v[162:163] offset:9216
  ds_write_b64 v68, v[164:165] offset:10240
  ds_write_b64 v68, v[166:167] offset:11264
  ds_write_b64 v68, v[168:169] offset:12288
  ds_write_b64 v68, v[170:171] offset:13312
  ds_write_b64 v68, v[172:173] offset:14336
  ds_write_b64 v68, v[174:175] offset:15360
  ds_write_b64 v68, v[176:177] offset:16384
  ds_write_b64 v68, v[178:179] offset:17408
  ds_write_b64 v68, v[180:181] offset:18432
  ds_write_b64 v68, v[182:183] offset:19456
  v_lshrrev_b32 v72, 1, v3
  v_lshlrev_b32 v72, 4, v72
  v_and_b32 v73, 8, v2
  v_add_u32 v72, v72, v73
  v_and_b32 v73, 1, v3
  v_lshl_add_u32 v72, v73, 2, v72
  v_bfe_u32 v73, v2, 2, 1
  v_add_u32 v72, v72, v73
  v_mul_u32_u24 v72, 96, v72
  v_and_b32 v73, 3, v2
  s_cmp_lt_u32 s20, 2
  s_cselect_b32 s21, 1, 0
  s_cselect_b32 s22, s20, 8
  v_lshlrev_b32 v73, s21, v73
  v_add_u32 v73, s22, v73
  v_mul_u32_u24 v74, 21846, v73
  v_lshrrev_b32 v74, 16, v74
  v_lshl_add_u32 v72, v74, 3, v72
  v_mul_u32_u24 v74, 3, v74
  v_sub_u32 v73, v73, v74
  v_lshl_add_u32 v72, v73, 5, v72
  v_add_u32 v73, 61440, v72
  v_cndmask_b32 v66, v72, v73, s[68:69]
  v_cndmask_b32 v67, v73, v72, s[68:69]
  v_add_u32 v68, 122880, v4
  s_waitcnt lgkmcnt(0)
  s_barrier
  s_cmp_eq_u32 s20, 3
  s_cbranch_scc1 w3_12
  ds_read_b64_tr_b16 a[160:161], v66 offset:0
  ds_read_b64_tr_b16 a[162:163], v66 offset:192
  ds_read_b64_tr_b16 a[164:165], v66 offset:3072
  ds_read_b64_tr_b16 a[166:167], v66 offset:3264
  ds_read_b64_tr_b16 a[168:169], v66 offset:6144
  ds_read_b64_tr_b16 a[170:171], v66 offset:6336
  ds_read_b64_tr_b16 a[172:173], v66 offset:9216
  ds_read_b64_tr_b16 a[174:175], v66 offset:9408
  ds_read_b64_tr_b16 a[176:177], v66 offset:12288
  ds_read_b64_tr_b16 a[178:179], v66 offset:12480
  ds_read_b64_tr_b16 a[180:181], v66 offset:15360
  ds_read_b64_tr_b16 a[182:183], v66 offset:15552
  ds_read_b64_tr_b16 a[184:185], v66 offset:18432
  ds_read_b64_tr_b16 a[186:187], v66 offset:18624
  ds_read_b64_tr_b16 a[188:189], v66 offset:21504
  ds_read_b64_tr_b16 a[190:191], v66 offset:21696
  ds_read_b64_tr_b16 a[192:193], v66 offset:24576
  ds_read_b64_tr_b16 a[194:195], v66 offset:24768
  ds_read_b64_tr_b16 a[196:197], v66 offset:27648
  ds_read_b64_tr_b16 a[198:199], v66 offset:27840
  ds_read_b64_tr_b16 a[200:201], v66 offset:30720
  ds_read_b64_tr_b16 a[202:203], v66 offset:30912
  ds_read_b64_tr_b16 a[204:205], v66 offset:33792
  ds_read_b64_tr_b16 a[206:207], v66 offset:33984
  ds_read_b64_tr_b16 a[208:209], v66 offset:36864
  ds_read_b64_tr_b16 a[210:211], v66 offset:37056
  ds_read_b64_tr_b16 a[212:213], v66 offset:39936
  ds_read_b64_tr_b16 a[214:215], v66 offset:40128
  ds_read_b64_tr_b16 a[216:217], v66 offset:43008
  ds_read_b64_tr_b16 a[218:219], v66 offset:43200
  ds_read_b64_tr_b16 a[220:221], v66 offset:46080
  ds_read_b64_tr_b16 a[222:223], v66 offset:46272
  ds_read_b64_tr_b16 a[224:225], v66 offset:49152
  ds_read_b64_tr_b16 a[226:227], v66 offset:49344
  ds_read_b64_tr_b16 a[228:229], v66 offset:52224
  ds_read_b64_tr_b16 a[230:231], v66 offset:52416
  ds_read_b64_tr_b16 a[232:233], v66 offset:55296
  ds_read_b64_tr_b16 a[234:235], v66 offset:55488
  ds_read_b64_tr_b16 a[236:237], v66 offset:58368
  ds_read_b64_tr_b16 a[238:239], v66 offset:58560
  ds_read_b64_tr_b16 a[240:241], v67 offset:0
  ds_read_b64_tr_b16 a[242:243], v67 offset:192
  ds_read_b64_tr_b16 a[244:245], v67 offset:3072
  ds_read_b64_tr_b16 a[246:247], v67 offset:3264
  ds_read_b64_tr_b16 a[248:249], v67 offset:6144
  ds_read_b64_tr_b16 a[250:251], v67 offset:6336
  ds_read_b64_tr_b16 a[252:253], v67 offset:9216
  ds_read_b64_tr_b16 a[254:255], v67 offset:9408
  ds_read_b64_tr_b16 v[192:193], v67 offset:12288
  ds_read_b64_tr_b16 v[194:195], v67 offset:12480
  ds_read_b64_tr_b16 v[196:197], v67 offset:15360
  ds_read_b64_tr_b16 v[198:199], v67 offset:15552
  ds_read_b64_tr_b16 v[200:201], v67 offset:18432
  ds_read_b64_tr_b16 v[202:203], v67 offset:18624
  ds_read_b64_tr_b16 v[204:205], v67 offset:21504
  ds_read_b64_tr_b16 v[206:207], v67 offset:21696
  ds_read_b64_tr_b16 v[208:209], v67 offset:24576
  ds_read_b64_tr_b16 v[210:211], v67 offset:24768
  ds_read_b64_tr_b16 v[212:213], v67 offset:27648
  ds_read_b64_tr_b16 v[214:215], v67 offset:27840
  ds_read_b64_tr_b16 v[216:217], v67 offset:30720
  ds_read_b64_tr_b16 v[218:219], v67 offset:30912
  ds_read_b64_tr_b16 v[220:221], v67 offset:33792
  ds_read_b64_tr_b16 v[222:223], v67 offset:33984
  ds_read_b64_tr_b16 v[224:225], v67 offset:36864
  ds_read_b64_tr_b16 v[226:227], v67 offset:37056
  ds_read_b64_tr_b16 v[228:229], v67 offset:39936
  ds_read_b64_tr_b16 v[230:231], v67 offset:40128
  ds_read_b64_tr_b16 v[232:233], v67 offset:43008
  ds_read_b64_tr_b16 v[234:235], v67 offset:43200
  ds_read_b64_tr_b16 v[236:237], v67 offset:46080
  ds_read_b64_tr_b16 v[238:239], v67 offset:46272
  ds_read_b64_tr_b16 v[240:241], v67 offset:49152
  ds_read_b64_tr_b16 v[242:243], v67 offset:49344
  ds_read_b64_tr_b16 v[244:245], v67 offset:52224
  ds_read_b64_tr_b16 v[246:247], v67 offset:52416
  ds_read_b64_tr_b16 v[248:249], v67 offset:55296
  ds_read_b64_tr_b16 v[250:251], v67 offset:55488
  ds_read_b64_tr_b16 v[252:253], v67 offset:58368
  ds_read_b64_tr_b16 v[254:255], v67 offset:58560
  s_branch w3_13
w3_12:
  ds_read_b128 a[160:163], v68 offset:0
  ds_read_b128 a[164:167], v68 offset:1024
  ds_read_b128 a[168:171], v68 offset:2048
  ds_read_b128 a[172:175], v68 offset:3072
  ds_read_b128 a[176:179], v68 offset:4096
  ds_read_b128 a[180:183], v68 offset:5120
  ds_read_b128 a[184:187], v68 offset:6144
  ds_read_b128 a[188:191], v68 offset:7168
  ds_read_b128 a[192:195], v68 offset:8192
  ds_read_b128 a[196:199], v68 offset:9216
  ds_read_b128 a[200:203], v68 offset:10240
  ds_read_b128 a[204:207], v68 offset:11264
  ds_read_b128 a[208:211], v68 offset:12288
  ds_read_b128 a[212:215], v68 offset:13312
  ds_read_b128 a[216:219], v68 offset:14336
  ds_read_b128 a[220:223], v68 offset:15360
  ds_read_b128 a[224:227], v68 offset:16384
  ds_read_b128 a[228:231], v68 offset:17408
  ds_read_b128 a[232:235], v68 offset:18432
  ds_read_b128 a[236:239], v68 offset:19456
  ds_read_b128 a[240:243], v68 offset:20480
  ds_read_b128 a[244:247], v68 offset:21504
  ds_read_b128 a[248:251], v68 offset:22528
  ds_read_b128 a[252:255], v68 offset:23552
  ds_read_b128 v[192:195], v68 offset:24576
  ds_read_b128 v[196:199], v68 offset:25600
  ds_read_b128 v[200:203], v68 offset:26624
  ds_read_b128 v[204:207], v68 offset:27648
  ds_read_b128 v[208:211], v68 offset:28672
  ds_read_b128 v[212:215], v68 offset:29696
  ds_read_b128 v[216:219], v68 offset:30720
  ds_read_b128 v[220:223], v68 offset:31744
  ds_read_b128 v[224:227], v68 offset:32768
  ds_read_b128 v[228:231], v68 offset:33792
  ds_read_b128 v[232:235], v68 offset:34816
  ds_read_b128 v[236:239], v68 offset:35840
  ds_read_b128 v[240:243], v68 offset:36864
  ds_read_b128 v[244:247], v68 offset:37888
  ds_read_b128 v[248:251], v68 offset:38912
  ds_read_b128 v[252:255], v68 offset:39936
w3_13:
  s_waitcnt lgkmcnt(0)
  s_barrier
  v_and_b32 v72, 7, v1
  v_mul_u32_u24 v72, 1280, v72
  v_lshrrev_b32 v73, 3, v1
  v_lshl_add_u32 v72, v73, 4, v72
  s_mul_i32 s21, s20, 3
  s_min_u32 s21, s21, 7
  s_lshl_b32 s22, s21, 7
  s_lshl_b32 s21, s21, 10
  s_add_u32 m0, s21, 0
  s_add_u32 s23, s22, 0
  buffer_load_dwordx4 v72, s[36:39], s23 offen lds
  s_add_u32 m0, s21, 1024
  s_add_u32 s23, s22, 128
  buffer_load_dwordx4 v72, s[36:39], s23 offen lds
  s_add_u32 m0, s21, 2048
  s_add_u32 s23, s22, 256
  buffer_load_dwordx4 v72, s[36:39], s23 offen lds
  v_mov_b32 v76, 0x3f803f80
  v_mov_b32 v77, 0x3f803f80
  v_mov_b32 v78, 0x3f803f80
  v_mov_b32 v79, 0x3f803f80
  v_mov_b32 v80, 0x3f003f00
  v_mov_b32 v81, 0x3f003f00
  ds_write_b128 v23, v[76:79] offset:46080
  ds_write_b128 v23, v[76:79] offset:62464
  ds_write_b64 v23, v[80:81] offset:13568
  s_waitcnt vmcnt(0)
  s_add_u32 s12, s48, 81068032
  s_addc_u32 s13, s49, 0
  s_mov_b32 s14, 115712
  s_mov_b32 s15, 0x00020000
  s_mov_b32 s16, s48
  s_mov_b32 s17, s49
  s_mov_b32 s18, 25165824
  s_mov_b32 s19, 0x00020000
  s_add_u32 s24, s48, 50331648
  s_addc_u32 s25, s49, 0
  s_mov_b32 s26, 6291456
  s_mov_b32 s27, 0x00020000
  s_add_u32 s28, s48, 114294784
  s_addc_u32 s29, s49, 0
  s_mov_b32 s30, 83886080
  s_mov_b32 s31, 0x00020000
  s_add_u32 s36, s48, 93323264
  s_addc_u32 s37, s49, 0
  s_mov_b32 s38, 20971520
  s_mov_b32 s39, 0x00020000
  s_lshl_b32 s76, s50, 9
  s_and_b32 s21, s51, 12
  s_add_u32 s76, s76, s21
  s_add_u32 s76, s76, 94208
  s_cmp_lg_u32 s20, 0
  s_cbranch_scc1 fm_15
  v_lshlrev_b32 v67, 2, v1
  s_bfe_u32 s82, s50, 0x10001
  s_lshl_b32 s82, s82, 5
  s_lshr_b32 s21, s50, 2
  s_add_u32 s82, s82, s21
  s_mov_b32 s101, 0
  s_mov_b32 s83, 0
  s_branch fm_16
fm_14:
  s_sleep 8
fm_16:
  buffer_load_dword v66, v67, s[32:35], 0 offen sc1
  buffer_load_dword v42, v41, s[12:15], s76 offen sc1
  s_add_u32 s101, s101, 1
  s_cmp_gt_u32 s101, 131072
  s_cbranch_scc1 end0
  s_waitcnt vmcnt(0)
  s_mov_b32 s84, s83
  v_readlane_b32 s83, v66, 19
  s_cmp_eq_u32 s83, 0
  s_cbranch_scc1 fm_14
  s_cmp_eq_u32 s84, 0
  s_cbranch_scc1 fm_16
  v_readlane_b32 s22, v66, 0
  v_readlane_b32 s23, v66, 32
  s_add_u32 s22, s22, s23
  v_readlane_b32 s23, v66, 1
  s_add_u32 s22, s22, s23
  v_readlane_b32 s23, v66, 33
  s_add_u32 s22, s22, s23
  v_readlane_b32 s23, v66, 2
  s_add_u32 s22, s22, s23
  v_readlane_b32 s23, v66, 34
  s_add_u32 s22, s22, s23
  v_readlane_b32 s23, v66, 3
  s_add_u32 s22, s22, s23
  v_readlane_b32 s23, v66, 35
  s_add_u32 s22, s22, s23
  v_readlane_b32 s21, v66, 16
  v_readlane_b32 s23, v66, 21
  v_cmp_gt_u32 vcc, 2, v42
  s_cmp_ge_u32 s22, 256
  s_cselect_b32 s23, s23, 0
  s_cmp_ge_u32 s21, 128
  s_cselect_b32 s23, s23, 0
  s_cbranch_vccnz fm_14
  s_cmp_eq_u32 s23, 0
  s_cbranch_scc1 fm_14
  v_readlane_b32 s21, v66, s82
  v_cmp_ne_u32 vcc, 32, v66
  s_cmp_ge_u32 s21, 32
  s_cselect_b32 s84, 1, 0
  s_andn2_b32 s53, s84, s53
  s_and_b32 s21, vcc_lo, 15
  s_and_b32 s22, vcc_hi, 15
  s_or_b32 s21, s21, s22
  v_mov_b32 v76, s23
  v_mov_b32 v77, s53
  v_mov_b32 v78, s21
  ds_write_b96 v23, v[76:78] offset:13824
fm_15:
  s_waitcnt lgkmcnt(0)
  s_barrier
  ds_read_b96 v[76:78], v23 offset:13824
  s_mul_i32 s72, s57, 40960
  s_mul_i32 s21, s60, 5120
  s_add_u32 s72, s72, s21
  s_mul_i32 s79, s61, 3072
  s_add_u32 s79, s79, s72
  s_mul_i32 s73, s58, 12288
  s_mul_i32 s21, s56, 1536
  s_add_u32 s73, s73, s21
  s_mov_b32 s74, 32768
  s_mul_i32 s70, s58, 3072
  s_mul_i32 s71, s57, 10240
  s_mul_i32 s21, s51, 640
  s_add_u32 s71, s71, s21
  s_cmp_lg_u32 s20, 3
  s_cbranch_scc1 pd_18
  s_add_u32 m0, s74, 10240
  s_nop 0
  buffer_load_dwordx4 v33, s[16:19], s73 offen sc1 lds
  s_add_u32 m0, s74, 11264
  s_nop 0
  buffer_load_dwordx4 v34, s[16:19], s73 offen sc1 lds
  s_add_u32 m0, s74, 12288
  s_nop 0
  buffer_load_dwordx4 v35, s[16:19], s73 offen sc1 lds
  s_add_u32 m0, s74, 8192
  s_add_u32 s21, s72, 2048
  buffer_load_dwordx4 v32, s[28:31], s21 offen sc1 lds
  s_add_u32 m0, s74, 9216
  s_add_u32 s21, s72, 83968
  buffer_load_dwordx4 v32, s[28:31], s21 offen sc1 lds
  s_add_u32 m0, s74, 0
  s_add_u32 s21, s79, 0
  buffer_load_dwordx4 v4, s[28:31], s21 offen sc1 lds
  s_add_u32 m0, s74, 1024
  s_add_u32 s21, s79, 1024
  buffer_load_dwordx4 v4, s[28:31], s21 offen sc1 lds
  s_add_u32 m0, s74, 2048
  s_add_u32 s21, s79, 40960
  buffer_load_dwordx4 v4, s[28:31], s21 offen sc1 lds
  s_add_u32 m0, s74, 3072
  s_add_u32 s21, s79, 41984
  buffer_load_dwordx4 v4, s[28:31], s21 offen sc1 lds
  s_add_u32 m0, s74, 4096
  s_add_u32 s21, s79, 81920
  buffer_load_dwordx4 v4, s[28:31], s21 offen sc1 lds
  s_add_u32 m0, s74, 5120
  s_add_u32 s21, s79, 82944
  buffer_load_dwordx4 v4, s[28:31], s21 offen sc1 lds
  s_add_u32 m0, s74, 6144
  s_add_u32 s21, s79, 122880
  buffer_load_dwordx4 v4, s[28:31], s21 offen sc1 lds
  s_add_u32 m0, s74, 7168
  s_add_u32 s21, s79, 123904
  buffer_load_dwordx4 v4, s[28:31], s21 offen sc1 lds
  s_add_u32 s72, s72, 1310720
  s_add_u32 s79, s79, 1310720
  s_add_u32 s73, s73, 393216
  s_xor_b32 s74, s74, 16384
  s_add_u32 m0, s74, 8192
  s_add_u32 s21, s72, 2048
  buffer_load_dwordx4 v32, s[28:31], s21 offen sc1 lds
  s_add_u32 m0, s74, 9216
  s_add_u32 s21, s72, 83968
  buffer_load_dwordx4 v32, s[28:31], s21 offen sc1 lds
  s_add_u32 m0, s74, 0
  s_add_u32 s21, s79, 0
  buffer_load_dwordx4 v4, s[28:31], s21 offen sc1 lds
  s_add_u32 m0, s74, 1024
  s_add_u32 s21, s79, 1024
  buffer_load_dwordx4 v4, s[28:31], s21 offen sc1 lds
  s_add_u32 m0, s74, 2048
  s_add_u32 s21, s79, 40960
  buffer_load_dwordx4 v4, s[28:31], s21 offen sc1 lds
  s_add_u32 m0, s74, 3072
  s_add_u32 s21, s79, 41984
  buffer_load_dwordx4 v4, s[28:31], s21 offen sc1 lds
  s_add_u32 m0, s74, 4096
  s_add_u32 s21, s79, 81920
  buffer_load_dwordx4 v4, s[28:31], s21 offen sc1 lds
  s_add_u32 m0, s74, 5120
  s_add_u32 s21, s79, 82944
  buffer_load_dwordx4 v4, s[28:31], s21 offen sc1 lds
  s_add_u32 m0, s74, 6144
  s_add_u32 s21, s79, 122880
  buffer_load_dwordx4 v4, s[28:31], s21 offen sc1 lds
  s_add_u32 m0, s74, 7168
  s_add_u32 s21, s79, 123904
  buffer_load_dwordx4 v4, s[28:31], s21 offen sc1 lds
  v_mov_b32 v42, 0
  s_branch pd_19
pd_18:
  s_add_u32 s72, s72, 1310720
  s_add_u32 s79, s79, 1310720
  s_add_u32 s73, s73, 393216
  s_xor_b32 s74, s74, 16384
  s_add_u32 s72, s72, 1310720
  s_add_u32 s79, s79, 1310720
  s_add_u32 s73, s73, 393216
  s_xor_b32 s74, s74, 16384
pd_19:
  s_waitcnt lgkmcnt(0)
  v_readfirstlane_b32 s53, v77
  v_readfirstlane_b32 s21, v78
  s_cmp_eq_u32 s21, 0
  s_cbranch_scc1 fm_17
  s_cmp_eq_u32 s20, 3
  s_cbranch_scc1 ar_21
  s_mov_b64 exec, s[64:65]
  s_cmp_eq_u32 s20, 2
  s_cbranch_scc1 ar_20
  s_mov_b32 s21, 0
  buffer_store_dwordx2 v[28:29], v8, s[8:11], s21 offen sc1
  s_mov_b32 s21, 122880
  buffer_store_dwordx2 v[28:29], v8, s[8:11], s21 offen sc1
  s_mov_b32 s21, 245760
  buffer_store_dwordx2 v[28:29], v8, s[8:11], s21 offen sc1
  s_mov_b32 s21, 368640
  buffer_store_dwordx2 v[28:29], v8, s[8:11], s21 offen sc1
  s_branch ar_22
ar_20:
  s_mov_b32 s21, 0
  buffer_store_dword v28, v8, s[8:11], s21 offen sc1
  buffer_store_dword v28, v8, s[8:11], s21 offen offset:128 sc1
  s_mov_b32 s21, 122880
  buffer_store_dword v28, v8, s[8:11], s21 offen sc1
  buffer_store_dword v28, v8, s[8:11], s21 offen offset:128 sc1
  s_mov_b32 s21, 245760
  buffer_store_dword v28, v8, s[8:11], s21 offen sc1
  buffer_store_dword v28, v8, s[8:11], s21 offen offset:128 sc1
  s_mov_b32 s21, 368640
  buffer_store_dword v28, v8, s[8:11], s21 offen sc1
  buffer_store_dword v28, v8, s[8:11], s21 offen offset:128 sc1
ar_22:
  s_cmp_eq_u32 s78, 0
  s_cbranch_scc1 ar_23
  s_mov_b64 exec, s[62:63]
  s_add_u32 s21, s77, 0
  buffer_store_dword v28, v17, s[8:11], s21 offen sc1
  s_add_u32 s21, s77, 122880
  buffer_store_dword v28, v17, s[8:11], s21 offen sc1
  s_add_u32 s21, s77, 245760
  buffer_store_dword v28, v17, s[8:11], s21 offen sc1
  s_add_u32 s21, s77, 368640
  buffer_store_dword v28, v17, s[8:11], s21 offen sc1
  s_branch ar_23
ar_21:
  s_mov_b64 exec, s[66:67]
  s_mov_b32 s21, 0
  buffer_store_dwordx4 v[28:31], v15, s[4:7], s21 offen sc1
  s_mov_b32 s21, 524288
  buffer_store_dwordx4 v[28:31], v15, s[4:7], s21 offen sc1
  s_mov_b32 s21, 8192
  buffer_store_dwordx4 v[28:31], v15, s[4:7], s21 offen sc1
  s_mov_b32 s21, 532480
  buffer_store_dwordx4 v[28:31], v15, s[4:7], s21 offen sc1
ar_23:
  s_mov_b64 exec, -1
  s_waitcnt vmcnt(0)
  s_barrier
  s_mov_b32 s21, 100
  s_cmp_lg_u32 s20, 0
  s_cbranch_scc1 af_24
  v_mov_b32 v80, 0
  v_mov_b32 v81, 1
  s_mov_b64 exec, 1
  buffer_atomic_add v81, v80, s[32:35], s21 offen sc1
  s_mov_b64 exec, -1
  s_nop 1
af_24:
  s_cmp_lg_u32 s20, 0
  s_cbranch_scc1 wf_26
  v_mov_b32 v80, 0
  s_mov_b32 s101, 0
wf_25:
  buffer_load_dword v81, v80, s[32:35], s21 offen sc1
  s_add_u32 s101, s101, 1
  s_cmp_gt_u32 s101, 131072
  s_cbranch_scc1 end0
  s_waitcnt vmcnt(0)
  v_readfirstlane_b32 s100, v81
  s_cmp_ge_u32 s100, 128
  s_cbranch_scc1 wf_26
  s_sleep 8
  s_branch wf_25
wf_26:
  s_barrier
fm_17:
  v_add_u32 v76, -1, v76
  v_lshlrev_b32 v76, 13, v76
  v_add_u32 v15, v15, v76
  v_add_u32 v16, v16, v76
  s_mov_b32 s75, s77
  s_lshl_b32 s77, s58, 7
  s_lshl_b32 s21, s56, 3
  s_add_u32 s77, s77, s21
  s_add_u32 s77, s77, 18432
  s_mov_b32 s80, 0x53800000
  s_mov_b32 s52, 0
  s_mov_b32 s81, 0
  s_waitcnt vmcnt(0)
  s_barrier
  ds_read_b128 v[144:147], v18
  ds_read_b128 v[148:151], v18 offset:1024
  ds_read_b128 v[152:155], v19
  ds_read_b128 v[112:115], v20
  ds_read_b64 v[116:117], v21
  v_xor_b32 v18, 16384, v18
  v_xor_b32 v19, 16384, v19
  v_xor_b32 v20, 16384, v20
  v_xor_b32 v21, 16384, v21
  v_mov_b32 v88, 0
  v_mov_b32 v89, 0
  v_mov_b32 v90, 0
  v_mov_b32 v91, 0
  v_mov_b32 v92, 0
  v_mov_b32 v93, 0
  v_mov_b32 v94, 0
  v_mov_b32 v95, 0
  v_mov_b32 v96, 0
  v_mov_b32 v97, 0
  v_mov_b32 v98, 0
  v_mov_b32 v99, 0
  v_mov_b32 v100, 0
  v_mov_b32 v101, 0
  v_mov_b32 v102, 0
  v_mov_b32 v103, 0
  v_mov_b32 v110, 0
  v_mov_b32 v111, 0
  v_mov_b32 v118, 0
  v_mov_b32 v119, 0
  v_mov_b32 v142, 0
  v_mov_b32 v143, 0
  v_mov_b32 v162, 0
  v_mov_b32 v163, 0
  s_and_b32 s21, s52, 3
  s_mul_i32 s56, s21, 122880
  s_add_u32 s21, s52, 1
  s_and_b32 s21, s21, 3
  s_mul_i32 s55, s21, 122880
  s_add_u32 s55, s55, s75
  s_add_u32 s21, s52, 2
  s_and_b32 s21, s21, 3
  s_mul_i32 s57, s21, 122880
  s_add_u32 s21, s52, 3
  s_and_b32 s21, s21, 3
  s_mul_i32 s59, s21, 122880
  s_add_u32 s59, s59, s75
  s_bfe_u32 s61, s52, 0x10001
  s_and_b32 s21, s52, 1
  s_lshl_b32 s60, s21, 19
  s_mov_b32 s58, s55
  s_waitcnt lgkmcnt(0)
  s_lshl_b32 s21, s53, 2
  s_add_u32 s21, s21, s20
  s_cmp_eq_u32 s21, 0
  s_cbranch_scc1 E_27
  s_cmp_eq_u32 s21, 4
  s_cbranch_scc1 E_28
  s_cmp_eq_u32 s21, 1
  s_cbranch_scc1 E_29
  s_cmp_eq_u32 s21, 5
  s_cbranch_scc1 E_30
  s_cmp_eq_u32 s21, 2
  s_cbranch_scc1 E_31
  s_cmp_eq_u32 s21, 6
  s_cbranch_scc1 E_32
  s_cmp_eq_u32 s21, 3
  s_cbranch_scc1 E_33
  s_cmp_eq_u32 s21, 7
  s_cbranch_scc1 E_34
  s_branch end0
E_28:
  v_add_u32 v190, 0, v4
  ds_read_b128 v[48:51], v4 offset:0
  ds_read_b128 v[52:55], v4 offset:1024
  ds_read_b128 v[56:59], v4 offset:2048
  s_waitcnt lgkmcnt(0)
  s_branch mo_40
  .p2align 3
top_35:
  s_waitcnt vmcnt(2)
  ds_write_b128 v190, v[48:51] offset:0
  v_cmp_eq_u32 s[22:23], -1, v48
  s_waitcnt vmcnt(1)
  ds_write_b128 v190, v[52:55] offset:1024
  v_cmp_eq_u32 s[98:99], -1, v52
  s_waitcnt vmcnt(0)
  ds_write_b128 v190, v[56:59] offset:2048
  v_cmp_eq_u32 s[100:101], -1, v56
  s_or_b64 vcc, s[22:23], s[98:99]
  s_or_b64 vcc, vcc, s[100:101]
  s_cbranch_scc1 mr_36
mo_40:
  s_waitcnt lgkmcnt(0)
  s_barrier
  ds_read_b128 v[60:63], v4 offset:3072
  ds_read_b128 v[64:67], v4 offset:4096
  v_smfmac_f32_16x16x64_bf16 v[92:95], v[48:51], a[240:247], v22
  ds_read_b128 v[68:71], v4 offset:5120
  v_smfmac_f32_16x16x64_bf16 v[88:91], v[48:51], a[160:167], v22
  ds_read_b128 v[72:75], v4 offset:6144
  v_smfmac_f32_16x16x64_bf16 v[92:95], v[52:55], a[248:255], v22
  ds_read_b128 v[76:79], v4 offset:7168
  v_smfmac_f32_16x16x64_bf16 v[88:91], v[52:55], a[168:175], v22
  ds_read_b128 v[80:83], v4 offset:8192
  v_smfmac_f32_16x16x64_bf16 v[92:95], v[56:59], v[192:199], v22
  ds_read_b128 v[84:87], v4 offset:9216
  v_smfmac_f32_16x16x64_bf16 v[88:91], v[56:59], a[176:183], v22
  s_waitcnt lgkmcnt(6)
  v_smfmac_f32_16x16x64_bf16 v[92:95], v[60:63], v[200:207], v22
  v_smfmac_f32_16x16x64_bf16 v[88:91], v[60:63], a[184:191], v22
  s_waitcnt lgkmcnt(5)
  v_smfmac_f32_16x16x64_bf16 v[92:95], v[64:67], v[208:215], v22
  s_waitcnt lgkmcnt(4)
  v_smfmac_f32_16x16x64_bf16 v[92:95], v[68:71], v[216:223], v22
  s_waitcnt lgkmcnt(3)
  v_smfmac_f32_16x16x64_bf16 v[92:95], v[72:75], v[224:231], v22
  s_waitcnt lgkmcnt(2)
  v_smfmac_f32_16x16x64_bf16 v[92:95], v[76:79], v[232:239], v22
  s_waitcnt lgkmcnt(1)
  v_smfmac_f32_16x16x64_bf16 v[92:95], v[80:83], v[240:247], v22
  s_waitcnt lgkmcnt(0)
  v_smfmac_f32_16x16x64_bf16 v[92:95], v[84:87], v[248:255], v22
  v_smfmac_f32_16x16x64_bf16 v[88:91], v[64:67], a[192:199], v22
  v_smfmac_f32_16x16x64_bf16 v[88:91], v[68:71], a[200:207], v22
  v_smfmac_f32_16x16x64_bf16 v[88:91], v[72:75], a[208:215], v22
  v_permlane32_swap_b32 v92, v93
  v_smfmac_f32_16x16x64_bf16 v[88:91], v[76:79], a[216:223], v22
  v_permlane32_swap_b32 v94, v95
  v_smfmac_f32_16x16x64_bf16 v[88:91], v[80:83], a[224:231], v22
  v_permlane32_swap_b32 v93, v92
  v_smfmac_f32_16x16x64_bf16 v[88:91], v[84:87], a[232:239], v22
  v_permlane32_swap_b32 v95, v94
  v_pk_mul_f32 v[120:121], v[92:93], v[24:25] op_sel:[1,0] op_sel_hi:[0,1]
  v_pk_mul_f32 v[122:123], v[94:95], v[24:25] op_sel:[1,0] op_sel_hi:[0,1]
  s_nop 4
  v_pk_fma_f32 v[88:89], v[88:89], v[24:25], v[120:121]
  v_pk_fma_f32 v[90:91], v[90:91], v[24:25], v[122:123]
  v_cvt_pk_bf16_f32 v120, v88, v89
  v_cvt_pk_bf16_f32 v121, v90, v91
  ds_write_b64 v6, v[120:121]
  v_cmp_u_f32 vcc, v88, v89
  v_cmp_u_f32 s[22:23], v90, v91
  s_nop 1
  s_or_b64 vcc, vcc, s[22:23]
  s_cbranch_vccnz mn_37
mk_38:
  s_waitcnt lgkmcnt(0)
  s_barrier
  ds_read_b64_tr_b16 v[104:105], v7 offset:0
  ds_read_b64_tr_b16 v[106:107], v7 offset:768
  ds_read_b64_tr_b16 v[108:109], v7 offset:1536
  ds_read_b64 v[140:141], v11
  s_cmp_eq_u32 s52, 63
  s_cbranch_scc1 last_39
  s_waitcnt lgkmcnt(2)
  v_mfma_f32_16x16x32_bf16 v[120:123], v[112:115], v[104:107], 0
  s_waitcnt lgkmcnt(1)
  v_mfma_f32_16x16x32_bf16 v[120:123], v[116:119], v[108:111], v[120:123]
  s_mov_b64 exec, s[64:65]
  s_nop 6
  v_cvt_pk_f16_f32 v120, v120, v121
  v_cvt_pk_f16_f32 v121, v122, v123
  buffer_store_dwordx2 v[120:121], v8, s[8:11], s56 offen
  s_mov_b64 exec, -1
  s_sleep 3
  s_nop 1
  v_smfmac_f32_16x16x64_bf16 v[96:99], v[48:51], a[0:7], v22
  v_smfmac_f32_16x16x64_bf16 v[100:103], v[48:51], a[80:87], v22
  v_smfmac_f32_16x16x64_bf16 v[96:99], v[52:55], a[8:15], v22
  v_smfmac_f32_16x16x64_bf16 v[100:103], v[52:55], a[88:95], v22
  v_smfmac_f32_16x16x64_bf16 v[96:99], v[56:59], a[16:23], v22
  v_smfmac_f32_16x16x64_bf16 v[100:103], v[56:59], a[96:103], v22
  v_smfmac_f32_16x16x64_bf16 v[96:99], v[60:63], a[24:31], v22
  v_smfmac_f32_16x16x64_bf16 v[96:99], v[64:67], a[32:39], v22
  v_smfmac_f32_16x16x64_bf16 v[96:99], v[68:71], a[40:47], v22
  v_smfmac_f32_16x16x64_bf16 v[96:99], v[72:75], a[48:55], v22
  v_smfmac_f32_16x16x64_bf16 v[96:99], v[76:79], a[56:63], v22
  buffer_load_dwordx4 v[124:127], v9, s[8:11], s56 offen sc1
  v_smfmac_f32_16x16x64_bf16 v[96:99], v[80:83], a[64:71], v22
  buffer_load_dwordx4 v[128:131], v9, s[8:11], s56 offen offset:1024 sc1
  v_smfmac_f32_16x16x64_bf16 v[96:99], v[84:87], a[72:79], v22
  buffer_load_dwordx4 v[132:135], v10, s[8:11], s56 offen sc1
  v_smfmac_f32_16x16x64_bf16 v[100:103], v[60:63], a[104:111], v22
  v_smfmac_f32_16x16x64_bf16 v[100:103], v[64:67], a[112:119], v22
  v_smfmac_f32_16x16x64_bf16 v[100:103], v[68:71], a[120:127], v22
  v_smfmac_f32_16x16x64_bf16 v[100:103], v[72:75], a[128:135], v22
  v_cvt_pk_bf16_f32 v136, v96, v97
  v_smfmac_f32_16x16x64_bf16 v[100:103], v[76:79], a[136:143], v22
  v_cvt_pk_bf16_f32 v137, v98, v99
  v_smfmac_f32_16x16x64_bf16 v[100:103], v[80:83], a[144:151], v22
  v_smfmac_f32_16x16x64_bf16 v[100:103], v[84:87], a[152:159], v22
  s_waitcnt vmcnt(2)
  v_pk_add_f16 v172, v124, v126
  v_pk_add_f16 v173, v125, v127
  s_waitcnt vmcnt(1)
  v_pk_add_f16 v174, v128, v130
  v_pk_add_f16 v175, v129, v131
  v_fma_mix_f32 v166, v172, 1.0, v174 op_sel:[0,0,0] op_sel_hi:[1,0,1]
  v_fma_mix_f32 v168, v173, 1.0, v175 op_sel:[0,0,0] op_sel_hi:[1,0,1]
  s_waitcnt vmcnt(0)
  v_pk_add_f16 v176, v132, v133
  v_pk_add_f16 v177, v134, v135
  v_fma_mix_f32 v170, v176, 1.0, v177 op_sel:[0,0,0] op_sel_hi:[1,0,1]
  v_fma_mix_f32 v167, v172, 1.0, v174 op_sel:[1,0,1] op_sel_hi:[1,0,1]
  v_cmp_u_f32 vcc, v166, v170
  v_fma_mix_f32 v169, v173, 1.0, v175 op_sel:[1,0,1] op_sel_hi:[1,0,1]
  v_fma_mix_f32 v171, v176, 1.0, v177 op_sel:[1,0,1] op_sel_hi:[1,0,1]
  v_cvt_pk_bf16_f32 v138, v100, v101
  s_cbranch_vccnz sr_41
sj_42:
ex_43:
  v_exp_f32 v172, v166
  v_exp_f32 v173, v167
  v_exp_f32 v174, v168
  v_cvt_pk_bf16_f32 v156, v172, v173
  v_exp_f32 v175, v169
  v_exp_f32 v176, v170
  v_cvt_pk_bf16_f32 v157, v174, v175
  v_mov_b32_dpp v158, v156 row_ror:8 row_mask:0xf bank_mask:0xf
  v_exp_f32 v177, v171
  v_mov_b32_dpp v159, v157 row_ror:8 row_mask:0xf bank_mask:0xf
  v_cvt_pk_bf16_f32 v160, v176, v177
  v_cvt_pk_bf16_f32 v139, v102, v103
  v_mfma_f32_16x16x32_bf16 v[178:181], v[152:155], v[156:159], 0
  s_waitcnt lgkmcnt(0)
  v_mov_b32_dpp v161, v160 row_ror:8 row_mask:0xf bank_mask:0xf
  v_mfma_f32_16x16x32_bf16 v[182:185], v[144:147], v[156:159], 0
  s_nop 0
  v_mfma_f32_16x16x32_bf16 v[178:181], v[140:143], v[160:163], v[178:181]
  v_mfma_f32_16x16x32_bf16 v[182:185], v[136:139], v[160:163], v[182:185]
  v_mfma_f32_16x16x32_bf16 v[186:189], v[148:151], v[156:159], 0
  v_mfma_f32_16x16x32_bf16 v[186:189], v[138:141], v[160:163], v[186:189]
  s_mov_b64 exec, s[62:63]
  v_rcp_f32 v164, v180
  s_nop 0
  v_pk_mul_f32 v[178:179], v[178:179], v[164:165] op_sel_hi:[1,0]
  v_pk_mul_f32 v[182:183], v[182:183], v[164:165] op_sel_hi:[1,0]
  v_pk_mul_f32 v[184:185], v[184:185], v[164:165] op_sel_hi:[1,0]
  v_cvt_pk_f16_f32 v64, v178, v179
  v_cvt_pk_f16_f32 v60, v182, v183
  v_pk_mul_f32 v[186:187], v[186:187], v[164:165] op_sel_hi:[1,0]
  v_pk_mul_f32 v[188:189], v[188:189], v[164:165] op_sel_hi:[1,0]
  v_cvt_pk_f16_f32 v61, v184, v185
  v_cvt_pk_f16_f32 v62, v186, v187
  v_cvt_pk_f16_f32 v63, v188, v189
  ds_write_b128 v13, v[60:63]
  ds_write_b32 v14, v64
  v_add_f32 v165, v164, v180
  v_cmp_ngt_f32 vcc, s80, v165
  s_mov_b64 exec, -1
  s_nop 0
  s_cbranch_vccnz fx_44
fk_45:
  s_waitcnt lgkmcnt(0)
  s_barrier
  s_add_u32 m0, s74, 8192
  s_add_u32 s21, s72, 2048
  buffer_load_dwordx4 v32, s[28:31], s21 offen sc1 lds
  s_add_u32 m0, s74, 1024
  s_add_u32 s21, s79, 1024
  buffer_load_dwordx4 v4, s[28:31], s21 offen sc1 lds
  s_add_u32 m0, s74, 4096
  s_add_u32 s21, s79, 81920
  buffer_load_dwordx4 v4, s[28:31], s21 offen sc1 lds
  s_add_u32 m0, s74, 7168
  s_add_u32 s21, s79, 123904
  buffer_load_dwordx4 v4, s[28:31], s21 offen sc1 lds
  s_add_u32 s72, s72, 1310720
  s_add_u32 s79, s79, 1310720
  s_add_u32 s73, s73, 393216
  s_xor_b32 s74, s74, 16384
  s_nop 15
  s_nop 3
  v_permlane32_swap_b32 v96, v100
  v_permlane32_swap_b32 v97, v101
  v_permlane32_swap_b32 v98, v102
  v_permlane32_swap_b32 v99, v103
  v_pk_add_f32 v[96:97], v[96:97], v[100:101]
  v_pk_add_f32 v[98:99], v[98:99], v[102:103]
  v_cvt_pk_bf16_f32 v182, v96, v97
  v_cvt_pk_bf16_f32 v183, v98, v99
  v_min_u32 v182, -2, v182
  ds_write_b64 v26, v[182:183]
  ds_read_b128 v[144:147], v18
  ds_read_b128 v[148:151], v18 offset:1024
  ds_read_b128 v[152:155], v19
  ds_read_b128 v[112:115], v20
  ds_read_b64 v[116:117], v21
  v_xor_b32 v18, 16384, v18
  v_xor_b32 v19, 16384, v19
  v_xor_b32 v20, 16384, v20
  v_xor_b32 v21, 16384, v21
  v_mov_b32 v88, 0
  v_mov_b32 v89, 0
  v_mov_b32 v90, 0
  v_mov_b32 v91, 0
  v_mov_b32 v92, 0
  v_mov_b32 v93, 0
  v_mov_b32 v94, 0
  v_mov_b32 v95, 0
  v_mov_b32 v96, 0
  v_mov_b32 v97, 0
  v_mov_b32 v98, 0
  v_mov_b32 v99, 0
  v_mov_b32 v100, 0
  v_mov_b32 v101, 0
  v_mov_b32 v102, 0
  v_mov_b32 v103, 0
  s_mov_b32 s81, 0
  s_waitcnt lgkmcnt(0)
  s_barrier
  s_mov_b64 exec, s[64:65]
  buffer_store_dwordx2 v[28:29], v8, s[8:11], s57 offen
  s_mov_b64 exec, s[62:63]
  buffer_store_dword v28, v17, s[8:11], s59 offen
  s_mov_b64 exec, -1
  s_sleep 6
  s_nop 3
  buffer_load_dwordx4 v[68:71], v16, s[4:7], s60 offen sc1
  s_sleep 3
  s_nop 1
  buffer_load_dwordx4 v[72:75], v16, s[4:7], s60 offen sc1
  s_mov_b32 s54, 0
pp_47:
  s_waitcnt vmcnt(1)
  v_mfma_f32_16x16x32_f16 v[120:123], v[44:47], v[68:71], 0
  v_bitop3_b32 v27, v68, s61, 1 bitop3:0x28
  v_cmp_ne_u32 vcc, 0, v27
  s_nop 1
  s_cbranch_vccnz p2_49
  s_nop 2
pg_48:
  v_add_f32_dpp v120, v120, v120 row_ror:8 row_mask:0xf bank_mask:0xf
  v_add_f32_dpp v121, v121, v121 row_ror:8 row_mask:0xf bank_mask:0xf
  s_mov_b64 exec, s[62:63]
  v_cvt_pk_bf16_f32 v120, v120, v121
  v_min_u32 v120, -2, v120
  buffer_store_dword v120, v17, s[8:11], s55 offen
  s_mov_b64 exec, -1
nt_46:
  s_barrier
  s_mov_b32 s58, s55
  s_add_u32 s52, s52, 1
  s_and_b32 s21, s52, 3
  s_mul_i32 s56, s21, 122880
  s_add_u32 s21, s52, 1
  s_and_b32 s21, s21, 3
  s_mul_i32 s55, s21, 122880
  s_add_u32 s55, s55, s75
  s_add_u32 s21, s52, 2
  s_and_b32 s21, s21, 3
  s_mul_i32 s57, s21, 122880
  s_add_u32 s21, s52, 3
  s_and_b32 s21, s21, 3
  s_mul_i32 s59, s21, 122880
  s_add_u32 s59, s59, s75
  s_bfe_u32 s61, s52, 0x10001
  s_and_b32 s21, s52, 1
  s_lshl_b32 s60, s21, 19
  s_mov_b32 s54, 0
  s_sleep 3
  s_nop 2
  buffer_load_dwordx4 v[48:51], v190, s[8:11], s58 offen offset:0 sc1
  buffer_load_dwordx4 v[52:55], v190, s[8:11], s58 offen offset:1024 sc1
  buffer_load_dwordx4 v[56:59], v190, s[8:11], s58 offen offset:2048 sc1
  s_branch top_35
mr_36:
  s_mov_b64 exec, s[22:23]
  s_cbranch_execz ms_50
  buffer_load_dwordx4 v[48:51], v190, s[8:11], s58 offen offset:0 sc1
ms_50:
  s_mov_b64 exec, s[98:99]
  s_cbranch_execz ms_51
  buffer_load_dwordx4 v[52:55], v190, s[8:11], s58 offen offset:1024 sc1
ms_51:
  s_mov_b64 exec, s[100:101]
  s_cbranch_execz ms_52
  buffer_load_dwordx4 v[56:59], v190, s[8:11], s58 offen offset:2048 sc1
ms_52:
  s_add_u32 s54, s54, 1
  s_cmp_gt_u32 s54, 131072
  s_cbranch_scc1 end0
  s_waitcnt vmcnt(0)
  s_mov_b64 exec, s[22:23]
  ds_write_b128 v190, v[48:51] offset:0
  v_cmp_eq_u32 s[22:23], -1, v48
  s_mov_b64 exec, s[98:99]
  ds_write_b128 v190, v[52:55] offset:1024
  v_cmp_eq_u32 s[98:99], -1, v52
  s_mov_b64 exec, s[100:101]
  ds_write_b128 v190, v[56:59] offset:2048
  v_cmp_eq_u32 s[100:101], -1, v56
  s_mov_b64 exec, -1
  s_or_b64 vcc, s[22:23], s[98:99]
  s_or_b64 vcc, vcc, s[100:101]
  s_cbranch_scc1 mr_36
  s_branch mo_40
mn_37:
  v_max3_u32 v27, v48, v49, v50
  v_max3_u32 v27, v27, v51, v52
  v_max3_u32 v27, v27, v53, v54
  v_max3_u32 v27, v27, v55, v56
  v_max3_u32 v27, v27, v57, v58
  v_max3_u32 v27, v27, v59, v60
  v_max3_u32 v27, v27, v61, v62
  v_max3_u32 v27, v27, v63, v64
  v_max3_u32 v27, v27, v65, v66
  v_max3_u32 v27, v27, v67, v68
  v_max3_u32 v27, v27, v69, v70
  v_max3_u32 v27, v27, v71, v72
  v_max3_u32 v27, v27, v73, v74
  v_max3_u32 v27, v27, v75, v76
  v_max3_u32 v27, v27, v77, v78
  v_max3_u32 v27, v27, v79, v80
  v_max3_u32 v27, v27, v81, v82
  v_max3_u32 v27, v27, v83, v84
  v_max3_u32 v27, v27, v85, v86
  v_max3_u32 v27, v27, v87, v87
  v_cmp_eq_u32 vcc, -1, v27
  s_cmp_eq_u32 s52, 0
  s_cbranch_scc1 mk_38
  s_cbranch_vccz mk_38
  s_waitcnt lgkmcnt(0)
  s_barrier
  s_nop 7
  v_mov_b32 v88, 0
  v_mov_b32 v89, 0
  v_mov_b32 v90, 0
  v_mov_b32 v91, 0
  v_mov_b32 v92, 0
  v_mov_b32 v93, 0
  v_mov_b32 v94, 0
  v_mov_b32 v95, 0
  v_mov_b32 v96, 0
  v_mov_b32 v97, 0
  v_mov_b32 v98, 0
  v_mov_b32 v99, 0
  v_mov_b32 v100, 0
  v_mov_b32 v101, 0
  v_mov_b32 v102, 0
  v_mov_b32 v103, 0
  s_mov_b64 s[22:23], -1
  s_mov_b64 s[98:99], -1
  s_mov_b64 s[100:101], -1
  s_branch mr_36
sr_41:
  s_mov_b32 s54, 0
sr_53:
  s_mov_b64 exec, vcc
  buffer_load_dwordx4 v[124:127], v9, s[8:11], s56 offen sc1
  buffer_load_dwordx4 v[128:131], v9, s[8:11], s56 offen offset:1024 sc1
  buffer_load_dwordx4 v[132:135], v10, s[8:11], s56 offen sc1
  s_mov_b64 exec, -1
  s_add_u32 s54, s54, 1
  s_cmp_gt_u32 s54, 131072
  s_cbranch_scc1 end0
  s_and_b32 s21, s54, 31
  s_cbranch_scc0 sr_54
  s_waitcnt vmcnt(0)
  v_pk_add_f16 v172, v124, v126
  v_pk_add_f16 v173, v125, v127
  v_pk_add_f16 v174, v128, v130
  v_pk_add_f16 v175, v129, v131
  v_fma_mix_f32 v166, v172, 1.0, v174 op_sel:[0,0,0] op_sel_hi:[1,0,1]
  v_fma_mix_f32 v168, v173, 1.0, v175 op_sel:[0,0,0] op_sel_hi:[1,0,1]
  v_pk_add_f16 v176, v132, v133
  v_pk_add_f16 v177, v134, v135
  v_add_f32 v27, v166, v168
  v_fma_mix_f32 v170, v176, 1.0, v177 op_sel:[0,0,0] op_sel_hi:[1,0,1]
  v_fma_mix_f32 v167, v172, 1.0, v174 op_sel:[1,0,1] op_sel_hi:[1,0,1]
  v_cmp_u_f32 vcc, v27, v170
  v_fma_mix_f32 v169, v173, 1.0, v175 op_sel:[1,0,1] op_sel_hi:[1,0,1]
  v_fma_mix_f32 v171, v176, 1.0, v177 op_sel:[1,0,1] op_sel_hi:[1,0,1]
  s_cbranch_vccnz sr_53
  s_branch sj_42
sr_54:
  s_waitcnt vmcnt(0)
  v_pk_add_f16 v172, v124, v126
  v_pk_add_f16 v173, v125, v127
  v_pk_add_f16 v174, v128, v130
  v_pk_add_f16 v175, v129, v131
  v_fma_mix_f32 v166, v172, 1.0, v174 op_sel:[0,0,0] op_sel_hi:[1,0,1]
  v_fma_mix_f32 v168, v173, 1.0, v175 op_sel:[0,0,0] op_sel_hi:[1,0,1]
  v_pk_add_f16 v176, v132, v133
  v_pk_add_f16 v177, v134, v135
  v_add_f32 v27, v166, v168
  v_fma_mix_f32 v170, v176, 1.0, v177 op_sel:[0,0,0] op_sel_hi:[1,0,1]
  v_fma_mix_f32 v167, v172, 1.0, v174 op_sel:[1,0,1] op_sel_hi:[1,0,1]
  v_cmp_u_f32 vcc, v27, v170
  v_fma_mix_f32 v169, v173, 1.0, v175 op_sel:[1,0,1] op_sel_hi:[1,0,1]
  v_fma_mix_f32 v171, v176, 1.0, v177 op_sel:[1,0,1] op_sel_hi:[1,0,1]
  v_max3_u32 v27, v124, v126, v128
  v_max3_u32 v27, v27, v130, v132
  v_max3_u32 v27, v27, v133, v134
  v_max3_u32 v27, v27, v135, v135
  v_cmp_eq_u32 vcc, -1, v27
  s_nop 1
  s_cbranch_vccnz sr_53
  s_branch sj_42
fx_44:
  s_cmp_eq_u32 s81, 1
  s_cbranch_scc1 fk_45
  s_mov_b32 s81, 1
  v_max3_f32 v164, v166, v167, v168
  v_max3_f32 v165, v169, v170, v171
  v_max_f32 v164, v164, v165
  s_nop 1
  v_max_f32_dpp v164, v164, v164 row_ror:8 row_mask:0xf bank_mask:0xf
  v_mov_b32 v165, v164
  s_nop 1
  v_permlane32_swap_b32 v164, v165
  v_max_f32 v164, v164, v165
  v_mov_b32 v165, v164
  s_nop 1
  v_permlane16_swap_b32 v164, v165
  v_max_f32 v164, v164, v165
  v_sub_f32 v166, v166, v164
  v_sub_f32 v167, v167, v164
  v_sub_f32 v168, v168, v164
  v_sub_f32 v169, v169, v164
  v_sub_f32 v170, v170, v164
  v_sub_f32 v171, v171, v164
  s_branch ex_43
p2_49:
  buffer_load_dwordx4 v[68:71], v16, s[4:7], s60 offen sc1
  s_waitcnt vmcnt(1)
  v_mfma_f32_16x16x32_f16 v[120:123], v[44:47], v[72:75], 0
  v_bitop3_b32 v27, v72, s61, 1 bitop3:0x28
  v_cmp_ne_u32 vcc, 0, v27
  s_nop 1
  s_cbranch_vccz pg_48
  buffer_load_dwordx4 v[72:75], v16, s[4:7], s60 offen sc1
  s_add_u32 s54, s54, 1
  s_cmp_gt_u32 s54, 131072
  s_cbranch_scc1 end0
  s_branch pp_47
last_39:
  v_smfmac_f32_16x16x64_bf16 v[96:99], v[48:51], a[0:7], v22
  v_smfmac_f32_16x16x64_bf16 v[100:103], v[48:51], a[80:87], v22
  v_smfmac_f32_16x16x64_bf16 v[96:99], v[52:55], a[8:15], v22
  v_smfmac_f32_16x16x64_bf16 v[100:103], v[52:55], a[88:95], v22
  v_smfmac_f32_16x16x64_bf16 v[96:99], v[56:59], a[16:23], v22
  v_smfmac_f32_16x16x64_bf16 v[100:103], v[56:59], a[96:103], v22
  v_smfmac_f32_16x16x64_bf16 v[96:99], v[60:63], a[24:31], v22
  v_smfmac_f32_16x16x64_bf16 v[96:99], v[64:67], a[32:39], v22
  v_smfmac_f32_16x16x64_bf16 v[96:99], v[68:71], a[40:47], v22
  v_smfmac_f32_16x16x64_bf16 v[96:99], v[72:75], a[48:55], v22
  v_smfmac_f32_16x16x64_bf16 v[96:99], v[76:79], a[56:63], v22
  v_smfmac_f32_16x16x64_bf16 v[96:99], v[80:83], a[64:71], v22
  v_smfmac_f32_16x16x64_bf16 v[96:99], v[84:87], a[72:79], v22
  v_smfmac_f32_16x16x64_bf16 v[100:103], v[60:63], a[104:111], v22
  v_smfmac_f32_16x16x64_bf16 v[100:103], v[64:67], a[112:119], v22
  v_smfmac_f32_16x16x64_bf16 v[100:103], v[68:71], a[120:127], v22
  v_smfmac_f32_16x16x64_bf16 v[100:103], v[72:75], a[128:135], v22
  v_smfmac_f32_16x16x64_bf16 v[100:103], v[76:79], a[136:143], v22
  v_smfmac_f32_16x16x64_bf16 v[100:103], v[80:83], a[144:151], v22
  v_smfmac_f32_16x16x64_bf16 v[100:103], v[84:87], a[152:159], v22
  s_nop 7
  v_permlane32_swap_b32 v96, v100
  v_permlane32_swap_b32 v97, v101
  v_permlane32_swap_b32 v98, v102
  v_permlane32_swap_b32 v99, v103
  v_pk_add_f32 v[96:97], v[96:97], v[100:101]
  v_pk_add_f32 v[98:99], v[98:99], v[102:103]
  v_cvt_pk_bf16_f32 v182, v96, v97
  v_cvt_pk_bf16_f32 v183, v98, v99
  v_min_u32 v182, -2, v182
  ds_write_b64 v26, v[182:183]
  s_waitcnt lgkmcnt(0)
  s_barrier
  v_mov_b32 v246, 80
  v_mov_b32 v247, 1
  s_mov_b64 exec, 1
  buffer_atomic_add v247, v246, s[32:35], 0 offen sc0 sc1
  s_mov_b64 exec, -1
  s_branch chain_done
E_30:
  v_add_u32 v190, 3072, v4
  ds_read_b128 v[60:63], v4 offset:3072
  ds_read_b128 v[64:67], v4 offset:4096
  ds_read_b128 v[68:71], v4 offset:5120
  s_waitcnt lgkmcnt(0)
  s_branch mo_60
  .p2align 3
top_55:
  s_waitcnt vmcnt(2)
  ds_write_b128 v190, v[60:63] offset:0
  v_cmp_eq_u32 s[22:23], -1, v60
  s_waitcnt vmcnt(1)
  ds_write_b128 v190, v[64:67] offset:1024
  v_cmp_eq_u32 s[98:99], -1, v64
  s_waitcnt vmcnt(0)
  ds_write_b128 v190, v[68:71] offset:2048
  v_cmp_eq_u32 s[100:101], -1, v68
  s_or_b64 vcc, s[22:23], s[98:99]
  s_or_b64 vcc, vcc, s[100:101]
  s_cbranch_scc1 mr_56
mo_60:
  s_waitcnt lgkmcnt(0)
  s_barrier
  ds_read_b128 v[48:51], v4 offset:0
  ds_read_b128 v[52:55], v4 offset:1024
  v_smfmac_f32_16x16x64_bf16 v[92:95], v[60:63], v[200:207], v22
  ds_read_b128 v[56:59], v4 offset:2048
  v_smfmac_f32_16x16x64_bf16 v[88:91], v[60:63], a[184:191], v22
  ds_read_b128 v[72:75], v4 offset:6144
  v_smfmac_f32_16x16x64_bf16 v[92:95], v[64:67], v[208:215], v22
  ds_read_b128 v[76:79], v4 offset:7168
  v_smfmac_f32_16x16x64_bf16 v[88:91], v[64:67], a[192:199], v22
  ds_read_b128 v[80:83], v4 offset:8192
  v_smfmac_f32_16x16x64_bf16 v[92:95], v[68:71], v[216:223], v22
  ds_read_b128 v[84:87], v4 offset:9216
  v_smfmac_f32_16x16x64_bf16 v[88:91], v[68:71], a[200:207], v22
  s_waitcnt lgkmcnt(6)
  v_smfmac_f32_16x16x64_bf16 v[92:95], v[48:51], a[240:247], v22
  v_smfmac_f32_16x16x64_bf16 v[88:91], v[48:51], a[160:167], v22
  s_waitcnt lgkmcnt(5)
  v_smfmac_f32_16x16x64_bf16 v[92:95], v[52:55], a[248:255], v22
  s_waitcnt lgkmcnt(4)
  v_smfmac_f32_16x16x64_bf16 v[92:95], v[56:59], v[192:199], v22
  s_waitcnt lgkmcnt(3)
  v_smfmac_f32_16x16x64_bf16 v[92:95], v[72:75], v[224:231], v22
  s_waitcnt lgkmcnt(2)
  v_smfmac_f32_16x16x64_bf16 v[92:95], v[76:79], v[232:239], v22
  s_waitcnt lgkmcnt(1)
  v_smfmac_f32_16x16x64_bf16 v[92:95], v[80:83], v[240:247], v22
  s_waitcnt lgkmcnt(0)
  v_smfmac_f32_16x16x64_bf16 v[92:95], v[84:87], v[248:255], v22
  v_smfmac_f32_16x16x64_bf16 v[88:91], v[52:55], a[168:175], v22
  v_smfmac_f32_16x16x64_bf16 v[88:91], v[56:59], a[176:183], v22
  v_smfmac_f32_16x16x64_bf16 v[88:91], v[72:75], a[208:215], v22
  v_permlane32_swap_b32 v92, v93
  v_smfmac_f32_16x16x64_bf16 v[88:91], v[76:79], a[216:223], v22
  v_permlane32_swap_b32 v94, v95
  v_smfmac_f32_16x16x64_bf16 v[88:91], v[80:83], a[224:231], v22
  v_permlane32_swap_b32 v93, v92
  v_smfmac_f32_16x16x64_bf16 v[88:91], v[84:87], a[232:239], v22
  v_permlane32_swap_b32 v95, v94
  v_pk_mul_f32 v[120:121], v[92:93], v[24:25] op_sel:[1,0] op_sel_hi:[0,1]
  v_pk_mul_f32 v[122:123], v[94:95], v[24:25] op_sel:[1,0] op_sel_hi:[0,1]
  s_nop 4
  v_pk_fma_f32 v[88:89], v[88:89], v[24:25], v[120:121]
  v_pk_fma_f32 v[90:91], v[90:91], v[24:25], v[122:123]
  v_cvt_pk_bf16_f32 v120, v88, v89
  v_cvt_pk_bf16_f32 v121, v90, v91
  ds_write_b64 v6, v[120:121]
  v_cmp_u_f32 vcc, v88, v89
  v_cmp_u_f32 s[22:23], v90, v91
  s_nop 1
  s_or_b64 vcc, vcc, s[22:23]
  s_cbranch_vccnz mn_57
mk_58:
  s_waitcnt lgkmcnt(0)
  s_barrier
  ds_read_b64_tr_b16 v[104:105], v7 offset:0
  ds_read_b64_tr_b16 v[106:107], v7 offset:768
  ds_read_b64_tr_b16 v[108:109], v7 offset:1536
  ds_read_b64 v[140:141], v11
  s_cmp_eq_u32 s52, 63
  s_cbranch_scc1 last_59
  s_waitcnt lgkmcnt(2)
  v_mfma_f32_16x16x32_bf16 v[120:123], v[112:115], v[104:107], 0
  s_waitcnt lgkmcnt(1)
  v_mfma_f32_16x16x32_bf16 v[120:123], v[116:119], v[108:111], v[120:123]
  s_mov_b64 exec, s[64:65]
  s_nop 6
  v_cvt_pk_f16_f32 v120, v120, v121
  v_cvt_pk_f16_f32 v121, v122, v123
  buffer_store_dwordx2 v[120:121], v8, s[8:11], s56 offen
  s_mov_b64 exec, -1
  s_sleep 3
  s_nop 1
  v_smfmac_f32_16x16x64_bf16 v[96:99], v[48:51], a[0:7], v22
  v_smfmac_f32_16x16x64_bf16 v[100:103], v[48:51], a[80:87], v22
  v_smfmac_f32_16x16x64_bf16 v[96:99], v[52:55], a[8:15], v22
  v_smfmac_f32_16x16x64_bf16 v[100:103], v[52:55], a[88:95], v22
  v_smfmac_f32_16x16x64_bf16 v[96:99], v[56:59], a[16:23], v22
  v_smfmac_f32_16x16x64_bf16 v[100:103], v[56:59], a[96:103], v22
  v_smfmac_f32_16x16x64_bf16 v[96:99], v[60:63], a[24:31], v22
  v_smfmac_f32_16x16x64_bf16 v[96:99], v[64:67], a[32:39], v22
  v_smfmac_f32_16x16x64_bf16 v[96:99], v[68:71], a[40:47], v22
  v_smfmac_f32_16x16x64_bf16 v[96:99], v[72:75], a[48:55], v22
  v_smfmac_f32_16x16x64_bf16 v[96:99], v[76:79], a[56:63], v22
  buffer_load_dwordx4 v[124:127], v9, s[8:11], s56 offen sc1
  v_smfmac_f32_16x16x64_bf16 v[96:99], v[80:83], a[64:71], v22
  buffer_load_dwordx4 v[128:131], v9, s[8:11], s56 offen offset:1024 sc1
  v_smfmac_f32_16x16x64_bf16 v[96:99], v[84:87], a[72:79], v22
  buffer_load_dwordx4 v[132:135], v10, s[8:11], s56 offen sc1
  v_smfmac_f32_16x16x64_bf16 v[100:103], v[60:63], a[104:111], v22
  v_smfmac_f32_16x16x64_bf16 v[100:103], v[64:67], a[112:119], v22
  v_smfmac_f32_16x16x64_bf16 v[100:103], v[68:71], a[120:127], v22
  v_smfmac_f32_16x16x64_bf16 v[100:103], v[72:75], a[128:135], v22
  v_cvt_pk_bf16_f32 v136, v96, v97
  v_smfmac_f32_16x16x64_bf16 v[100:103], v[76:79], a[136:143], v22
  v_cvt_pk_bf16_f32 v137, v98, v99
  v_smfmac_f32_16x16x64_bf16 v[100:103], v[80:83], a[144:151], v22
  v_smfmac_f32_16x16x64_bf16 v[100:103], v[84:87], a[152:159], v22
  s_waitcnt vmcnt(2)
  v_pk_add_f16 v172, v124, v126
  v_pk_add_f16 v173, v125, v127
  s_waitcnt vmcnt(1)
  v_pk_add_f16 v174, v128, v130
  v_pk_add_f16 v175, v129, v131
  v_fma_mix_f32 v166, v172, 1.0, v174 op_sel:[0,0,0] op_sel_hi:[1,0,1]
  v_fma_mix_f32 v168, v173, 1.0, v175 op_sel:[0,0,0] op_sel_hi:[1,0,1]
  s_waitcnt vmcnt(0)
  v_pk_add_f16 v176, v132, v133
  v_pk_add_f16 v177, v134, v135
  v_fma_mix_f32 v170, v176, 1.0, v177 op_sel:[0,0,0] op_sel_hi:[1,0,1]
  v_fma_mix_f32 v167, v172, 1.0, v174 op_sel:[1,0,1] op_sel_hi:[1,0,1]
  v_cmp_u_f32 vcc, v166, v170
  v_fma_mix_f32 v169, v173, 1.0, v175 op_sel:[1,0,1] op_sel_hi:[1,0,1]
  v_fma_mix_f32 v171, v176, 1.0, v177 op_sel:[1,0,1] op_sel_hi:[1,0,1]
  v_cvt_pk_bf16_f32 v138, v100, v101
  s_cbranch_vccnz sr_61
sj_62:
ex_63:
  v_exp_f32 v172, v166
  v_exp_f32 v173, v167
  v_exp_f32 v174, v168
  v_cvt_pk_bf16_f32 v156, v172, v173
  v_exp_f32 v175, v169
  v_exp_f32 v176, v170
  v_cvt_pk_bf16_f32 v157, v174, v175
  v_mov_b32_dpp v158, v156 row_ror:8 row_mask:0xf bank_mask:0xf
  v_exp_f32 v177, v171
  v_mov_b32_dpp v159, v157 row_ror:8 row_mask:0xf bank_mask:0xf
  v_cvt_pk_bf16_f32 v160, v176, v177
  v_cvt_pk_bf16_f32 v139, v102, v103
  v_mfma_f32_16x16x32_bf16 v[178:181], v[152:155], v[156:159], 0
  s_waitcnt lgkmcnt(0)
  v_mov_b32_dpp v161, v160 row_ror:8 row_mask:0xf bank_mask:0xf
  v_mfma_f32_16x16x32_bf16 v[182:185], v[144:147], v[156:159], 0
  s_nop 0
  v_mfma_f32_16x16x32_bf16 v[178:181], v[140:143], v[160:163], v[178:181]
  v_mfma_f32_16x16x32_bf16 v[182:185], v[136:139], v[160:163], v[182:185]
  v_mfma_f32_16x16x32_bf16 v[186:189], v[148:151], v[156:159], 0
  v_mfma_f32_16x16x32_bf16 v[186:189], v[138:141], v[160:163], v[186:189]
  s_mov_b64 exec, s[62:63]
  v_rcp_f32 v164, v180
  s_nop 0
  v_pk_mul_f32 v[178:179], v[178:179], v[164:165] op_sel_hi:[1,0]
  v_pk_mul_f32 v[182:183], v[182:183], v[164:165] op_sel_hi:[1,0]
  v_pk_mul_f32 v[184:185], v[184:185], v[164:165] op_sel_hi:[1,0]
  v_cvt_pk_f16_f32 v64, v178, v179
  v_cvt_pk_f16_f32 v60, v182, v183
  v_pk_mul_f32 v[186:187], v[186:187], v[164:165] op_sel_hi:[1,0]
  v_pk_mul_f32 v[188:189], v[188:189], v[164:165] op_sel_hi:[1,0]
  v_cvt_pk_f16_f32 v61, v184, v185
  v_cvt_pk_f16_f32 v62, v186, v187
  v_cvt_pk_f16_f32 v63, v188, v189
  ds_write_b128 v13, v[60:63]
  ds_write_b32 v14, v64
  v_add_f32 v165, v164, v180
  v_cmp_ngt_f32 vcc, s80, v165
  s_mov_b64 exec, -1
  s_nop 0
  s_cbranch_vccnz fx_64
fk_65:
  s_waitcnt lgkmcnt(0)
  s_barrier
  s_add_u32 m0, s74, 9216
  s_add_u32 s21, s72, 83968
  buffer_load_dwordx4 v32, s[28:31], s21 offen sc1 lds
  s_add_u32 m0, s74, 2048
  s_add_u32 s21, s79, 40960
  buffer_load_dwordx4 v4, s[28:31], s21 offen sc1 lds
  s_add_u32 m0, s74, 5120
  s_add_u32 s21, s79, 82944
  buffer_load_dwordx4 v4, s[28:31], s21 offen sc1 lds
  s_add_u32 s72, s72, 1310720
  s_add_u32 s79, s79, 1310720
  s_add_u32 s73, s73, 393216
  s_xor_b32 s74, s74, 16384
  s_nop 15
  s_nop 3
  v_permlane32_swap_b32 v96, v100
  v_permlane32_swap_b32 v97, v101
  v_permlane32_swap_b32 v98, v102
  v_permlane32_swap_b32 v99, v103
  v_pk_add_f32 v[96:97], v[96:97], v[100:101]
  v_pk_add_f32 v[98:99], v[98:99], v[102:103]
  v_cvt_pk_bf16_f32 v182, v96, v97
  v_cvt_pk_bf16_f32 v183, v98, v99
  v_min_u32 v182, -2, v182
  ds_write_b64 v26, v[182:183]
  ds_read_b128 v[144:147], v18
  ds_read_b128 v[148:151], v18 offset:1024
  ds_read_b128 v[152:155], v19
  ds_read_b128 v[112:115], v20
  ds_read_b64 v[116:117], v21
  v_xor_b32 v18, 16384, v18
  v_xor_b32 v19, 16384, v19
  v_xor_b32 v20, 16384, v20
  v_xor_b32 v21, 16384, v21
  v_mov_b32 v88, 0
  v_mov_b32 v89, 0
  v_mov_b32 v90, 0
  v_mov_b32 v91, 0
  v_mov_b32 v92, 0
  v_mov_b32 v93, 0
  v_mov_b32 v94, 0
  v_mov_b32 v95, 0
  v_mov_b32 v96, 0
  v_mov_b32 v97, 0
  v_mov_b32 v98, 0
  v_mov_b32 v99, 0
  v_mov_b32 v100, 0
  v_mov_b32 v101, 0
  v_mov_b32 v102, 0
  v_mov_b32 v103, 0
  s_mov_b32 s81, 0
  s_waitcnt lgkmcnt(0)
  s_barrier
  s_mov_b64 exec, s[64:65]
  buffer_store_dwordx2 v[28:29], v8, s[8:11], s57 offen
  s_mov_b64 exec, s[62:63]
  buffer_store_dword v28, v17, s[8:11], s59 offen
  s_mov_b64 exec, -1
  s_sleep 6
  s_nop 3
  buffer_load_dwordx4 v[68:71], v16, s[4:7], s60 offen sc1
  s_sleep 3
  s_nop 1
  buffer_load_dwordx4 v[72:75], v16, s[4:7], s60 offen sc1
  s_mov_b32 s54, 0
pp_67:
  s_waitcnt vmcnt(1)
  v_mfma_f32_16x16x32_f16 v[120:123], v[44:47], v[68:71], 0
  v_bitop3_b32 v27, v68, s61, 1 bitop3:0x28
  v_cmp_ne_u32 vcc, 0, v27
  s_nop 1
  s_cbranch_vccnz p2_69
  s_nop 2
pg_68:
  v_add_f32_dpp v120, v120, v120 row_ror:8 row_mask:0xf bank_mask:0xf
  v_add_f32_dpp v121, v121, v121 row_ror:8 row_mask:0xf bank_mask:0xf
  s_mov_b64 exec, s[62:63]
  v_cvt_pk_bf16_f32 v120, v120, v121
  v_min_u32 v120, -2, v120
  buffer_store_dword v120, v17, s[8:11], s55 offen
  s_mov_b64 exec, -1
nt_66:
  s_barrier
  s_mov_b32 s58, s55
  s_add_u32 s52, s52, 1
  s_and_b32 s21, s52, 3
  s_mul_i32 s56, s21, 122880
  s_add_u32 s21, s52, 1
  s_and_b32 s21, s21, 3
  s_mul_i32 s55, s21, 122880
  s_add_u32 s55, s55, s75
  s_add_u32 s21, s52, 2
  s_and_b32 s21, s21, 3
  s_mul_i32 s57, s21, 122880
  s_add_u32 s21, s52, 3
  s_and_b32 s21, s21, 3
  s_mul_i32 s59, s21, 122880
  s_add_u32 s59, s59, s75
  s_bfe_u32 s61, s52, 0x10001
  s_and_b32 s21, s52, 1
  s_lshl_b32 s60, s21, 19
  s_mov_b32 s54, 0
  s_sleep 3
  s_nop 2
  buffer_load_dwordx4 v[60:63], v190, s[8:11], s58 offen offset:0 sc1
  buffer_load_dwordx4 v[64:67], v190, s[8:11], s58 offen offset:1024 sc1
  buffer_load_dwordx4 v[68:71], v190, s[8:11], s58 offen offset:2048 sc1
  s_branch top_55
mr_56:
  s_mov_b64 exec, s[22:23]
  s_cbranch_execz ms_70
  buffer_load_dwordx4 v[60:63], v190, s[8:11], s58 offen offset:0 sc1
ms_70:
  s_mov_b64 exec, s[98:99]
  s_cbranch_execz ms_71
  buffer_load_dwordx4 v[64:67], v190, s[8:11], s58 offen offset:1024 sc1
ms_71:
  s_mov_b64 exec, s[100:101]
  s_cbranch_execz ms_72
  buffer_load_dwordx4 v[68:71], v190, s[8:11], s58 offen offset:2048 sc1
ms_72:
  s_add_u32 s54, s54, 1
  s_cmp_gt_u32 s54, 131072
  s_cbranch_scc1 end0
  s_waitcnt vmcnt(0)
  s_mov_b64 exec, s[22:23]
  ds_write_b128 v190, v[60:63] offset:0
  v_cmp_eq_u32 s[22:23], -1, v60
  s_mov_b64 exec, s[98:99]
  ds_write_b128 v190, v[64:67] offset:1024
  v_cmp_eq_u32 s[98:99], -1, v64
  s_mov_b64 exec, s[100:101]
  ds_write_b128 v190, v[68:71] offset:2048
  v_cmp_eq_u32 s[100:101], -1, v68
  s_mov_b64 exec, -1
  s_or_b64 vcc, s[22:23], s[98:99]
  s_or_b64 vcc, vcc, s[100:101]
  s_cbranch_scc1 mr_56
  s_branch mo_60
mn_57:
  v_max3_u32 v27, v48, v49, v50
  v_max3_u32 v27, v27, v51, v52
  v_max3_u32 v27, v27, v53, v54
  v_max3_u32 v27, v27, v55, v56
  v_max3_u32 v27, v27, v57, v58
  v_max3_u32 v27, v27, v59, v60
  v_max3_u32 v27, v27, v61, v62
  v_max3_u32 v27, v27, v63, v64
  v_max3_u32 v27, v27, v65, v66
  v_max3_u32 v27, v27, v67, v68
  v_max3_u32 v27, v27, v69, v70
  v_max3_u32 v27, v27, v71, v72
  v_max3_u32 v27, v27, v73, v74
  v_max3_u32 v27, v27, v75, v76
  v_max3_u32 v27, v27, v77, v78
  v_max3_u32 v27, v27, v79, v80
  v_max3_u32 v27, v27, v81, v82
  v_max3_u32 v27, v27, v83, v84
  v_max3_u32 v27, v27, v85, v86
  v_max3_u32 v27, v27, v87, v87
  v_cmp_eq_u32 vcc, -1, v27
  s_cmp_eq_u32 s52, 0
  s_cbranch_scc1 mk_58
  s_cbranch_vccz mk_58
  s_waitcnt lgkmcnt(0)
  s_barrier
  s_nop 7
  v_mov_b32 v88, 0
  v_mov_b32 v89, 0
  v_mov_b32 v90, 0
  v_mov_b32 v91, 0
  v_mov_b32 v92, 0
  v_mov_b32 v93, 0
  v_mov_b32 v94, 0
  v_mov_b32 v95, 0
  v_mov_b32 v96, 0
  v_mov_b32 v97, 0
  v_mov_b32 v98, 0
  v_mov_b32 v99, 0
  v_mov_b32 v100, 0
  v_mov_b32 v101, 0
  v_mov_b32 v102, 0
  v_mov_b32 v103, 0
  s_mov_b64 s[22:23], -1
  s_mov_b64 s[98:99], -1
  s_mov_b64 s[100:101], -1
  s_branch mr_56
sr_61:
  s_mov_b32 s54, 0
sr_73:
  s_mov_b64 exec, vcc
  buffer_load_dwordx4 v[124:127], v9, s[8:11], s56 offen sc1
  buffer_load_dwordx4 v[128:131], v9, s[8:11], s56 offen offset:1024 sc1
  buffer_load_dwordx4 v[132:135], v10, s[8:11], s56 offen sc1
  s_mov_b64 exec, -1
  s_add_u32 s54, s54, 1
  s_cmp_gt_u32 s54, 131072
  s_cbranch_scc1 end0
  s_and_b32 s21, s54, 31
  s_cbranch_scc0 sr_74
  s_waitcnt vmcnt(0)
  v_pk_add_f16 v172, v124, v126
  v_pk_add_f16 v173, v125, v127
  v_pk_add_f16 v174, v128, v130
  v_pk_add_f16 v175, v129, v131
  v_fma_mix_f32 v166, v172, 1.0, v174 op_sel:[0,0,0] op_sel_hi:[1,0,1]
  v_fma_mix_f32 v168, v173, 1.0, v175 op_sel:[0,0,0] op_sel_hi:[1,0,1]
  v_pk_add_f16 v176, v132, v133
  v_pk_add_f16 v177, v134, v135
  v_add_f32 v27, v166, v168
  v_fma_mix_f32 v170, v176, 1.0, v177 op_sel:[0,0,0] op_sel_hi:[1,0,1]
  v_fma_mix_f32 v167, v172, 1.0, v174 op_sel:[1,0,1] op_sel_hi:[1,0,1]
  v_cmp_u_f32 vcc, v27, v170
  v_fma_mix_f32 v169, v173, 1.0, v175 op_sel:[1,0,1] op_sel_hi:[1,0,1]
  v_fma_mix_f32 v171, v176, 1.0, v177 op_sel:[1,0,1] op_sel_hi:[1,0,1]
  s_cbranch_vccnz sr_73
  s_branch sj_62
sr_74:
  s_waitcnt vmcnt(0)
  v_pk_add_f16 v172, v124, v126
  v_pk_add_f16 v173, v125, v127
  v_pk_add_f16 v174, v128, v130
  v_pk_add_f16 v175, v129, v131
  v_fma_mix_f32 v166, v172, 1.0, v174 op_sel:[0,0,0] op_sel_hi:[1,0,1]
  v_fma_mix_f32 v168, v173, 1.0, v175 op_sel:[0,0,0] op_sel_hi:[1,0,1]
  v_pk_add_f16 v176, v132, v133
  v_pk_add_f16 v177, v134, v135
  v_add_f32 v27, v166, v168
  v_fma_mix_f32 v170, v176, 1.0, v177 op_sel:[0,0,0] op_sel_hi:[1,0,1]
  v_fma_mix_f32 v167, v172, 1.0, v174 op_sel:[1,0,1] op_sel_hi:[1,0,1]
  v_cmp_u_f32 vcc, v27, v170
  v_fma_mix_f32 v169, v173, 1.0, v175 op_sel:[1,0,1] op_sel_hi:[1,0,1]
  v_fma_mix_f32 v171, v176, 1.0, v177 op_sel:[1,0,1] op_sel_hi:[1,0,1]
  v_max3_u32 v27, v124, v126, v128
  v_max3_u32 v27, v27, v130, v132
  v_max3_u32 v27, v27, v133, v134
  v_max3_u32 v27, v27, v135, v135
  v_cmp_eq_u32 vcc, -1, v27
  s_nop 1
  s_cbranch_vccnz sr_73
  s_branch sj_62
fx_64:
  s_cmp_eq_u32 s81, 1
  s_cbranch_scc1 fk_65
  s_mov_b32 s81, 1
  v_max3_f32 v164, v166, v167, v168
  v_max3_f32 v165, v169, v170, v171
  v_max_f32 v164, v164, v165
  s_nop 1
  v_max_f32_dpp v164, v164, v164 row_ror:8 row_mask:0xf bank_mask:0xf
  v_mov_b32 v165, v164
  s_nop 1
  v_permlane32_swap_b32 v164, v165
  v_max_f32 v164, v164, v165
  v_mov_b32 v165, v164
  s_nop 1
  v_permlane16_swap_b32 v164, v165
  v_max_f32 v164, v164, v165
  v_sub_f32 v166, v166, v164
  v_sub_f32 v167, v167, v164
  v_sub_f32 v168, v168, v164
  v_sub_f32 v169, v169, v164
  v_sub_f32 v170, v170, v164
  v_sub_f32 v171, v171, v164
  s_branch ex_63
p2_69:
  buffer_load_dwordx4 v[68:71], v16, s[4:7], s60 offen sc1
  s_waitcnt vmcnt(1)
  v_mfma_f32_16x16x32_f16 v[120:123], v[44:47], v[72:75], 0
  v_bitop3_b32 v27, v72, s61, 1 bitop3:0x28
  v_cmp_ne_u32 vcc, 0, v27
  s_nop 1
  s_cbranch_vccz pg_68
  buffer_load_dwordx4 v[72:75], v16, s[4:7], s60 offen sc1
  s_add_u32 s54, s54, 1
  s_cmp_gt_u32 s54, 131072
  s_cbranch_scc1 end0
  s_branch pp_67
last_59:
  v_smfmac_f32_16x16x64_bf16 v[96:99], v[48:51], a[0:7], v22
  v_smfmac_f32_16x16x64_bf16 v[100:103], v[48:51], a[80:87], v22
  v_smfmac_f32_16x16x64_bf16 v[96:99], v[52:55], a[8:15], v22
  v_smfmac_f32_16x16x64_bf16 v[100:103], v[52:55], a[88:95], v22
  v_smfmac_f32_16x16x64_bf16 v[96:99], v[56:59], a[16:23], v22
  v_smfmac_f32_16x16x64_bf16 v[100:103], v[56:59], a[96:103], v22
  v_smfmac_f32_16x16x64_bf16 v[96:99], v[60:63], a[24:31], v22
  v_smfmac_f32_16x16x64_bf16 v[96:99], v[64:67], a[32:39], v22
  v_smfmac_f32_16x16x64_bf16 v[96:99], v[68:71], a[40:47], v22
  v_smfmac_f32_16x16x64_bf16 v[96:99], v[72:75], a[48:55], v22
  v_smfmac_f32_16x16x64_bf16 v[96:99], v[76:79], a[56:63], v22
  v_smfmac_f32_16x16x64_bf16 v[96:99], v[80:83], a[64:71], v22
  v_smfmac_f32_16x16x64_bf16 v[96:99], v[84:87], a[72:79], v22
  v_smfmac_f32_16x16x64_bf16 v[100:103], v[60:63], a[104:111], v22
  v_smfmac_f32_16x16x64_bf16 v[100:103], v[64:67], a[112:119], v22
  v_smfmac_f32_16x16x64_bf16 v[100:103], v[68:71], a[120:127], v22
  v_smfmac_f32_16x16x64_bf16 v[100:103], v[72:75], a[128:135], v22
  v_smfmac_f32_16x16x64_bf16 v[100:103], v[76:79], a[136:143], v22
  v_smfmac_f32_16x16x64_bf16 v[100:103], v[80:83], a[144:151], v22
  v_smfmac_f32_16x16x64_bf16 v[100:103], v[84:87], a[152:159], v22
  s_nop 7
  v_permlane32_swap_b32 v96, v100
  v_permlane32_swap_b32 v97, v101
  v_permlane32_swap_b32 v98, v102
  v_permlane32_swap_b32 v99, v103
  v_pk_add_f32 v[96:97], v[96:97], v[100:101]
  v_pk_add_f32 v[98:99], v[98:99], v[102:103]
  v_cvt_pk_bf16_f32 v182, v96, v97
  v_cvt_pk_bf16_f32 v183, v98, v99
  v_min_u32 v182, -2, v182
  ds_write_b64 v26, v[182:183]
  s_waitcnt lgkmcnt(0)
  s_barrier
  s_branch chain_done
E_32:
  v_add_u32 v190, 6144, v4
  ds_read_b128 v[72:75], v4 offset:6144
  ds_read_b128 v[76:79], v4 offset:7168
  ds_read_b128 v[80:83], v4 offset:8192
  s_waitcnt lgkmcnt(0)
  s_branch mo_80
  .p2align 3
top_75:
  s_waitcnt vmcnt(2)
  ds_write_b128 v190, v[72:75] offset:0
  v_cmp_eq_u32 s[22:23], -1, v72
  s_waitcnt vmcnt(1)
  ds_write_b128 v190, v[76:79] offset:1024
  v_cmp_eq_u32 s[98:99], -1, v76
  s_waitcnt vmcnt(0)
  ds_write_b128 v190, v[80:83] offset:2048
  v_cmp_eq_u32 s[100:101], -1, v80
  s_or_b64 vcc, s[22:23], s[98:99]
  s_or_b64 vcc, vcc, s[100:101]
  s_cbranch_scc1 mr_76
mo_80:
  s_waitcnt lgkmcnt(0)
  s_barrier
  ds_read_b128 v[48:51], v4 offset:0
  ds_read_b128 v[52:55], v4 offset:1024
  v_smfmac_f32_16x16x64_bf16 v[92:95], v[72:75], v[224:231], v22
  ds_read_b128 v[56:59], v4 offset:2048
  v_smfmac_f32_16x16x64_bf16 v[88:91], v[72:75], a[208:215], v22
  ds_read_b128 v[60:63], v4 offset:3072
  v_smfmac_f32_16x16x64_bf16 v[92:95], v[76:79], v[232:239], v22
  ds_read_b128 v[64:67], v4 offset:4096
  v_smfmac_f32_16x16x64_bf16 v[88:91], v[76:79], a[216:223], v22
  ds_read_b128 v[68:71], v4 offset:5120
  v_smfmac_f32_16x16x64_bf16 v[92:95], v[80:83], v[240:247], v22
  ds_read_b128 v[84:87], v4 offset:9216
  v_smfmac_f32_16x16x64_bf16 v[88:91], v[80:83], a[224:231], v22
  s_waitcnt lgkmcnt(6)
  v_smfmac_f32_16x16x64_bf16 v[92:95], v[48:51], a[240:247], v22
  v_smfmac_f32_16x16x64_bf16 v[88:91], v[48:51], a[160:167], v22
  s_waitcnt lgkmcnt(5)
  v_smfmac_f32_16x16x64_bf16 v[92:95], v[52:55], a[248:255], v22
  s_waitcnt lgkmcnt(4)
  v_smfmac_f32_16x16x64_bf16 v[92:95], v[56:59], v[192:199], v22
  s_waitcnt lgkmcnt(3)
  v_smfmac_f32_16x16x64_bf16 v[92:95], v[60:63], v[200:207], v22
  s_waitcnt lgkmcnt(2)
  v_smfmac_f32_16x16x64_bf16 v[92:95], v[64:67], v[208:215], v22
  s_waitcnt lgkmcnt(1)
  v_smfmac_f32_16x16x64_bf16 v[92:95], v[68:71], v[216:223], v22
  s_waitcnt lgkmcnt(0)
  v_smfmac_f32_16x16x64_bf16 v[92:95], v[84:87], v[248:255], v22
  v_smfmac_f32_16x16x64_bf16 v[88:91], v[52:55], a[168:175], v22
  v_smfmac_f32_16x16x64_bf16 v[88:91], v[56:59], a[176:183], v22
  v_smfmac_f32_16x16x64_bf16 v[88:91], v[60:63], a[184:191], v22
  v_permlane32_swap_b32 v92, v93
  v_smfmac_f32_16x16x64_bf16 v[88:91], v[64:67], a[192:199], v22
  v_permlane32_swap_b32 v94, v95
  v_smfmac_f32_16x16x64_bf16 v[88:91], v[68:71], a[200:207], v22
  v_permlane32_swap_b32 v93, v92
  v_smfmac_f32_16x16x64_bf16 v[88:91], v[84:87], a[232:239], v22
  v_permlane32_swap_b32 v95, v94
  v_pk_mul_f32 v[120:121], v[92:93], v[24:25] op_sel:[1,0] op_sel_hi:[0,1]
  v_pk_mul_f32 v[122:123], v[94:95], v[24:25] op_sel:[1,0] op_sel_hi:[0,1]
  s_nop 4
  v_pk_fma_f32 v[88:89], v[88:89], v[24:25], v[120:121]
  v_pk_fma_f32 v[90:91], v[90:91], v[24:25], v[122:123]
  v_cvt_pk_bf16_f32 v120, v88, v89
  v_cvt_pk_bf16_f32 v121, v90, v91
  ds_write_b64 v6, v[120:121]
  v_cmp_u_f32 vcc, v88, v89
  v_cmp_u_f32 s[22:23], v90, v91
  s_nop 1
  s_or_b64 vcc, vcc, s[22:23]
  s_cbranch_vccnz mn_77
mk_78:
  s_waitcnt lgkmcnt(0)
  s_barrier
  ds_read_b64_tr_b16 v[104:105], v7 offset:0
  ds_read_b64_tr_b16 v[106:107], v7 offset:768
  ds_read_b64_tr_b16 v[108:109], v7 offset:1536
  ds_read_b64 v[140:141], v11
  s_cmp_eq_u32 s52, 63
  s_cbranch_scc1 last_79
  s_waitcnt lgkmcnt(2)
  v_mfma_f32_16x16x32_bf16 v[120:123], v[104:107], v[104:107], 0
  s_waitcnt lgkmcnt(1)
  v_mfma_f32_16x16x32_bf16 v[120:123], v[108:111], v[108:111], v[120:123]
  s_mov_b64 exec, s[64:65]
  s_nop 6
  v_cvt_pk_f16_f32 v120, v120, v121
  buffer_store_dword v120, v8, s[8:11], s56 offen
  v_cvt_pk_f16_f32 v121, v122, v123
  buffer_store_dword v121, v8, s[8:11], s56 offen offset:128
  s_mov_b64 exec, -1
  s_sleep 3
  s_nop 1
  v_smfmac_f32_16x16x64_bf16 v[96:99], v[48:51], a[0:7], v22
  v_smfmac_f32_16x16x64_bf16 v[100:103], v[48:51], a[80:87], v22
  v_smfmac_f32_16x16x64_bf16 v[96:99], v[52:55], a[8:15], v22
  v_smfmac_f32_16x16x64_bf16 v[100:103], v[52:55], a[88:95], v22
  v_smfmac_f32_16x16x64_bf16 v[96:99], v[56:59], a[16:23], v22
  v_smfmac_f32_16x16x64_bf16 v[100:103], v[56:59], a[96:103], v22
  v_smfmac_f32_16x16x64_bf16 v[96:99], v[60:63], a[24:31], v22
  v_smfmac_f32_16x16x64_bf16 v[96:99], v[64:67], a[32:39], v22
  v_smfmac_f32_16x16x64_bf16 v[96:99], v[68:71], a[40:47], v22
  v_smfmac_f32_16x16x64_bf16 v[96:99], v[72:75], a[48:55], v22
  v_smfmac_f32_16x16x64_bf16 v[96:99], v[76:79], a[56:63], v22
  buffer_load_dwordx4 v[124:127], v9, s[8:11], s56 offen sc1
  v_smfmac_f32_16x16x64_bf16 v[96:99], v[80:83], a[64:71], v22
  buffer_load_dwordx4 v[128:131], v9, s[8:11], s56 offen offset:1024 sc1
  v_smfmac_f32_16x16x64_bf16 v[96:99], v[84:87], a[72:79], v22
  buffer_load_dwordx4 v[132:135], v10, s[8:11], s56 offen sc1
  v_smfmac_f32_16x16x64_bf16 v[100:103], v[60:63], a[104:111], v22
  v_smfmac_f32_16x16x64_bf16 v[100:103], v[64:67], a[112:119], v22
  v_smfmac_f32_16x16x64_bf16 v[100:103], v[68:71], a[120:127], v22
  v_smfmac_f32_16x16x64_bf16 v[100:103], v[72:75], a[128:135], v22
  v_cvt_pk_bf16_f32 v136, v96, v97
  v_smfmac_f32_16x16x64_bf16 v[100:103], v[76:79], a[136:143], v22
  v_cvt_pk_bf16_f32 v137, v98, v99
  v_smfmac_f32_16x16x64_bf16 v[100:103], v[80:83], a[144:151], v22
  v_smfmac_f32_16x16x64_bf16 v[100:103], v[84:87], a[152:159], v22
  s_waitcnt vmcnt(2)
  v_pk_add_f16 v172, v124, v126
  v_pk_add_f16 v173, v125, v127
  s_waitcnt vmcnt(1)
  v_pk_add_f16 v174, v128, v130
  v_pk_add_f16 v175, v129, v131
  v_fma_mix_f32 v166, v172, 1.0, v174 op_sel:[0,0,0] op_sel_hi:[1,0,1]
  v_fma_mix_f32 v168, v173, 1.0, v175 op_sel:[0,0,0] op_sel_hi:[1,0,1]
  s_waitcnt vmcnt(0)
  v_pk_add_f16 v176, v132, v133
  v_pk_add_f16 v177, v134, v135
  v_fma_mix_f32 v170, v176, 1.0, v177 op_sel:[0,0,0] op_sel_hi:[1,0,1]
  v_fma_mix_f32 v167, v172, 1.0, v174 op_sel:[1,0,1] op_sel_hi:[1,0,1]
  v_cmp_u_f32 vcc, v166, v170
  v_fma_mix_f32 v169, v173, 1.0, v175 op_sel:[1,0,1] op_sel_hi:[1,0,1]
  v_fma_mix_f32 v171, v176, 1.0, v177 op_sel:[1,0,1] op_sel_hi:[1,0,1]
  v_cvt_pk_bf16_f32 v138, v100, v101
  s_cbranch_vccnz sr_81
sj_82:
ex_83:
  v_exp_f32 v172, v166
  v_exp_f32 v173, v167
  v_exp_f32 v174, v168
  v_cvt_pk_bf16_f32 v156, v172, v173
  v_exp_f32 v175, v169
  v_exp_f32 v176, v170
  v_cvt_pk_bf16_f32 v157, v174, v175
  v_mov_b32_dpp v158, v156 row_ror:8 row_mask:0xf bank_mask:0xf
  v_exp_f32 v177, v171
  v_mov_b32_dpp v159, v157 row_ror:8 row_mask:0xf bank_mask:0xf
  v_cvt_pk_bf16_f32 v160, v176, v177
  v_cvt_pk_bf16_f32 v139, v102, v103
  v_mfma_f32_16x16x32_bf16 v[178:181], v[152:155], v[156:159], 0
  s_waitcnt lgkmcnt(0)
  v_mov_b32_dpp v161, v160 row_ror:8 row_mask:0xf bank_mask:0xf
  v_mfma_f32_16x16x32_bf16 v[182:185], v[144:147], v[156:159], 0
  s_nop 0
  v_mfma_f32_16x16x32_bf16 v[178:181], v[140:143], v[160:163], v[178:181]
  v_mfma_f32_16x16x32_bf16 v[182:185], v[136:139], v[160:163], v[182:185]
  v_mfma_f32_16x16x32_bf16 v[186:189], v[148:151], v[156:159], 0
  v_mfma_f32_16x16x32_bf16 v[186:189], v[138:141], v[160:163], v[186:189]
  s_mov_b64 exec, s[62:63]
  v_rcp_f32 v164, v180
  s_nop 0
  v_pk_mul_f32 v[178:179], v[178:179], v[164:165] op_sel_hi:[1,0]
  v_pk_mul_f32 v[182:183], v[182:183], v[164:165] op_sel_hi:[1,0]
  v_pk_mul_f32 v[184:185], v[184:185], v[164:165] op_sel_hi:[1,0]
  v_cvt_pk_f16_f32 v64, v178, v179
  v_cvt_pk_f16_f32 v60, v182, v183
  v_pk_mul_f32 v[186:187], v[186:187], v[164:165] op_sel_hi:[1,0]
  v_pk_mul_f32 v[188:189], v[188:189], v[164:165] op_sel_hi:[1,0]
  v_cvt_pk_f16_f32 v61, v184, v185
  v_cvt_pk_f16_f32 v62, v186, v187
  v_cvt_pk_f16_f32 v63, v188, v189
  ds_write_b128 v13, v[60:63]
  ds_write_b32 v14, v64
  v_add_f32 v165, v164, v180
  v_cmp_ngt_f32 vcc, s80, v165
  s_mov_b64 exec, -1
  s_nop 0
  s_cbranch_vccnz fx_84
fk_85:
  s_waitcnt lgkmcnt(0)
  s_barrier
  s_add_u32 m0, s74, 0
  s_add_u32 s21, s79, 0
  buffer_load_dwordx4 v4, s[28:31], s21 offen sc1 lds
  s_add_u32 m0, s74, 3072
  s_add_u32 s21, s79, 41984
  buffer_load_dwordx4 v4, s[28:31], s21 offen sc1 lds
  s_add_u32 m0, s74, 6144
  s_add_u32 s21, s79, 122880
  buffer_load_dwordx4 v4, s[28:31], s21 offen sc1 lds
  s_add_u32 s72, s72, 1310720
  s_add_u32 s79, s79, 1310720
  s_add_u32 s73, s73, 393216
  s_xor_b32 s74, s74, 16384
  s_nop 15
  s_nop 3
  v_permlane32_swap_b32 v96, v100
  v_permlane32_swap_b32 v97, v101
  v_permlane32_swap_b32 v98, v102
  v_permlane32_swap_b32 v99, v103
  v_pk_add_f32 v[96:97], v[96:97], v[100:101]
  v_pk_add_f32 v[98:99], v[98:99], v[102:103]
  v_cvt_pk_bf16_f32 v182, v96, v97
  v_cvt_pk_bf16_f32 v183, v98, v99
  v_min_u32 v182, -2, v182
  ds_write_b64 v26, v[182:183]
  ds_read_b128 v[144:147], v18
  ds_read_b128 v[148:151], v18 offset:1024
  ds_read_b128 v[152:155], v19
  v_xor_b32 v18, 16384, v18
  v_xor_b32 v19, 16384, v19
  v_mov_b32 v88, 0
  v_mov_b32 v89, 0
  v_mov_b32 v90, 0
  v_mov_b32 v91, 0
  v_mov_b32 v92, 0
  v_mov_b32 v93, 0
  v_mov_b32 v94, 0
  v_mov_b32 v95, 0
  v_mov_b32 v96, 0
  v_mov_b32 v97, 0
  v_mov_b32 v98, 0
  v_mov_b32 v99, 0
  v_mov_b32 v100, 0
  v_mov_b32 v101, 0
  v_mov_b32 v102, 0
  v_mov_b32 v103, 0
  s_mov_b32 s81, 0
  s_waitcnt lgkmcnt(0)
  s_barrier
  s_mov_b64 exec, s[64:65]
  buffer_store_dword v28, v8, s[8:11], s57 offen
  buffer_store_dword v28, v8, s[8:11], s57 offen offset:128
  s_mov_b64 exec, -1
  s_cmp_eq_u32 s78, 0
  s_cbranch_scc1 nt_86
  s_mov_b64 exec, s[62:63]
  buffer_store_dword v28, v17, s[8:11], s59 offen
  s_mov_b64 exec, -1
  s_sleep 6
  s_nop 3
  buffer_load_dwordx4 v[68:71], v16, s[4:7], s60 offen sc1
  s_sleep 3
  s_nop 1
  buffer_load_dwordx4 v[72:75], v16, s[4:7], s60 offen sc1
  s_mov_b32 s54, 0
pp_87:
  s_waitcnt vmcnt(1)
  v_mfma_f32_16x16x32_f16 v[120:123], v[44:47], v[68:71], 0
  v_bitop3_b32 v27, v68, s61, 1 bitop3:0x28
  v_cmp_ne_u32 vcc, 0, v27
  s_nop 1
  s_cbranch_vccnz p2_89
  s_nop 2
pg_88:
  v_add_f32_dpp v120, v120, v120 row_ror:8 row_mask:0xf bank_mask:0xf
  v_add_f32_dpp v121, v121, v121 row_ror:8 row_mask:0xf bank_mask:0xf
  s_mov_b64 exec, s[62:63]
  v_cvt_pk_bf16_f32 v120, v120, v121
  v_min_u32 v120, -2, v120
  buffer_store_dword v120, v17, s[8:11], s55 offen
  s_mov_b64 exec, -1
nt_86:
  s_barrier
  s_mov_b32 s58, s55
  s_add_u32 s52, s52, 1
  s_and_b32 s21, s52, 3
  s_mul_i32 s56, s21, 122880
  s_add_u32 s21, s52, 1
  s_and_b32 s21, s21, 3
  s_mul_i32 s55, s21, 122880
  s_add_u32 s55, s55, s75
  s_add_u32 s21, s52, 2
  s_and_b32 s21, s21, 3
  s_mul_i32 s57, s21, 122880
  s_add_u32 s21, s52, 3
  s_and_b32 s21, s21, 3
  s_mul_i32 s59, s21, 122880
  s_add_u32 s59, s59, s75
  s_bfe_u32 s61, s52, 0x10001
  s_and_b32 s21, s52, 1
  s_lshl_b32 s60, s21, 19
  s_mov_b32 s54, 0
  s_sleep 3
  s_nop 2
  buffer_load_dwordx4 v[72:75], v190, s[8:11], s58 offen offset:0 sc1
  buffer_load_dwordx4 v[76:79], v190, s[8:11], s58 offen offset:1024 sc1
  buffer_load_dwordx4 v[80:83], v190, s[8:11], s58 offen offset:2048 sc1
  s_branch top_75
mr_76:
  s_mov_b64 exec, s[22:23]
  s_cbranch_execz ms_90
  buffer_load_dwordx4 v[72:75], v190, s[8:11], s58 offen offset:0 sc1
ms_90:
  s_mov_b64 exec, s[98:99]
  s_cbranch_execz ms_91
  buffer_load_dwordx4 v[76:79], v190, s[8:11], s58 offen offset:1024 sc1
ms_91:
  s_mov_b64 exec, s[100:101]
  s_cbranch_execz ms_92
  buffer_load_dwordx4 v[80:83], v190, s[8:11], s58 offen offset:2048 sc1
ms_92:
  s_add_u32 s54, s54, 1
  s_cmp_gt_u32 s54, 131072
  s_cbranch_scc1 end0
  s_waitcnt vmcnt(0)
  s_mov_b64 exec, s[22:23]
  ds_write_b128 v190, v[72:75] offset:0
  v_cmp_eq_u32 s[22:23], -1, v72
  s_mov_b64 exec, s[98:99]
  ds_write_b128 v190, v[76:79] offset:1024
  v_cmp_eq_u32 s[98:99], -1, v76
  s_mov_b64 exec, s[100:101]
  ds_write_b128 v190, v[80:83] offset:2048
  v_cmp_eq_u32 s[100:101], -1, v80
  s_mov_b64 exec, -1
  s_or_b64 vcc, s[22:23], s[98:99]
  s_or_b64 vcc, vcc, s[100:101]
  s_cbranch_scc1 mr_76
  s_branch mo_80
mn_77:
  v_max3_u32 v27, v48, v49, v50
  v_max3_u32 v27, v27, v51, v52
  v_max3_u32 v27, v27, v53, v54
  v_max3_u32 v27, v27, v55, v56
  v_max3_u32 v27, v27, v57, v58
  v_max3_u32 v27, v27, v59, v60
  v_max3_u32 v27, v27, v61, v62
  v_max3_u32 v27, v27, v63, v64
  v_max3_u32 v27, v27, v65, v66
  v_max3_u32 v27, v27, v67, v68
  v_max3_u32 v27, v27, v69, v70
  v_max3_u32 v27, v27, v71, v72
  v_max3_u32 v27, v27, v73, v74
  v_max3_u32 v27, v27, v75, v76
  v_max3_u32 v27, v27, v77, v78
  v_max3_u32 v27, v27, v79, v80
  v_max3_u32 v27, v27, v81, v82
  v_max3_u32 v27, v27, v83, v84
  v_max3_u32 v27, v27, v85, v86
  v_max3_u32 v27, v27, v87, v87
  v_cmp_eq_u32 vcc, -1, v27
  s_cmp_eq_u32 s52, 0
  s_cbranch_scc1 mk_78
  s_cbranch_vccz mk_78
  s_waitcnt lgkmcnt(0)
  s_barrier
  s_nop 7
  v_mov_b32 v88, 0
  v_mov_b32 v89, 0
  v_mov_b32 v90, 0
  v_mov_b32 v91, 0
  v_mov_b32 v92, 0
  v_mov_b32 v93, 0
  v_mov_b32 v94, 0
  v_mov_b32 v95, 0
  v_mov_b32 v96, 0
  v_mov_b32 v97, 0
  v_mov_b32 v98, 0
  v_mov_b32 v99, 0
  v_mov_b32 v100, 0
  v_mov_b32 v101, 0
  v_mov_b32 v102, 0
  v_mov_b32 v103, 0
  s_mov_b64 s[22:23], -1
  s_mov_b64 s[98:99], -1
  s_mov_b64 s[100:101], -1
  s_branch mr_76
sr_81:
  s_mov_b32 s54, 0
sr_93:
  s_mov_b64 exec, vcc
  buffer_load_dwordx4 v[124:127], v9, s[8:11], s56 offen sc1
  buffer_load_dwordx4 v[128:131], v9, s[8:11], s56 offen offset:1024 sc1
  buffer_load_dwordx4 v[132:135], v10, s[8:11], s56 offen sc1
  s_mov_b64 exec, -1
  s_add_u32 s54, s54, 1
  s_cmp_gt_u32 s54, 131072
  s_cbranch_scc1 end0
  s_and_b32 s21, s54, 31
  s_cbranch_scc0 sr_94
  s_waitcnt vmcnt(0)
  v_pk_add_f16 v172, v124, v126
  v_pk_add_f16 v173, v125, v127
  v_pk_add_f16 v174, v128, v130
  v_pk_add_f16 v175, v129, v131
  v_fma_mix_f32 v166, v172, 1.0, v174 op_sel:[0,0,0] op_sel_hi:[1,0,1]
  v_fma_mix_f32 v168, v173, 1.0, v175 op_sel:[0,0,0] op_sel_hi:[1,0,1]
  v_pk_add_f16 v176, v132, v133
  v_pk_add_f16 v177, v134, v135
  v_add_f32 v27, v166, v168
  v_fma_mix_f32 v170, v176, 1.0, v177 op_sel:[0,0,0] op_sel_hi:[1,0,1]
  v_fma_mix_f32 v167, v172, 1.0, v174 op_sel:[1,0,1] op_sel_hi:[1,0,1]
  v_cmp_u_f32 vcc, v27, v170
  v_fma_mix_f32 v169, v173, 1.0, v175 op_sel:[1,0,1] op_sel_hi:[1,0,1]
  v_fma_mix_f32 v171, v176, 1.0, v177 op_sel:[1,0,1] op_sel_hi:[1,0,1]
  s_cbranch_vccnz sr_93
  s_branch sj_82
sr_94:
  s_waitcnt vmcnt(0)
  v_pk_add_f16 v172, v124, v126
  v_pk_add_f16 v173, v125, v127
  v_pk_add_f16 v174, v128, v130
  v_pk_add_f16 v175, v129, v131
  v_fma_mix_f32 v166, v172, 1.0, v174 op_sel:[0,0,0] op_sel_hi:[1,0,1]
  v_fma_mix_f32 v168, v173, 1.0, v175 op_sel:[0,0,0] op_sel_hi:[1,0,1]
  v_pk_add_f16 v176, v132, v133
  v_pk_add_f16 v177, v134, v135
  v_add_f32 v27, v166, v168
  v_fma_mix_f32 v170, v176, 1.0, v177 op_sel:[0,0,0] op_sel_hi:[1,0,1]
  v_fma_mix_f32 v167, v172, 1.0, v174 op_sel:[1,0,1] op_sel_hi:[1,0,1]
  v_cmp_u_f32 vcc, v27, v170
  v_fma_mix_f32 v169, v173, 1.0, v175 op_sel:[1,0,1] op_sel_hi:[1,0,1]
  v_fma_mix_f32 v171, v176, 1.0, v177 op_sel:[1,0,1] op_sel_hi:[1,0,1]
  v_max3_u32 v27, v124, v126, v128
  v_max3_u32 v27, v27, v130, v132
  v_max3_u32 v27, v27, v133, v134
  v_max3_u32 v27, v27, v135, v135
  v_cmp_eq_u32 vcc, -1, v27
  s_nop 1
  s_cbranch_vccnz sr_93
  s_branch sj_82
fx_84:
  s_cmp_eq_u32 s81, 1
  s_cbranch_scc1 fk_85
  s_mov_b32 s81, 1
  v_max3_f32 v164, v166, v167, v168
  v_max3_f32 v165, v169, v170, v171
  v_max_f32 v164, v164, v165
  s_nop 1
  v_max_f32_dpp v164, v164, v164 row_ror:8 row_mask:0xf bank_mask:0xf
  v_mov_b32 v165, v164
  s_nop 1
  v_permlane32_swap_b32 v164, v165
  v_max_f32 v164, v164, v165
  v_mov_b32 v165, v164
  s_nop 1
  v_permlane16_swap_b32 v164, v165
  v_max_f32 v164, v164, v165
  v_sub_f32 v166, v166, v164
  v_sub_f32 v167, v167, v164
  v_sub_f32 v168, v168, v164
  v_sub_f32 v169, v169, v164
  v_sub_f32 v170, v170, v164
  v_sub_f32 v171, v171, v164
  s_branch ex_83
p2_89:
  buffer_load_dwordx4 v[68:71], v16, s[4:7], s60 offen sc1
  s_waitcnt vmcnt(1)
  v_mfma_f32_16x16x32_f16 v[120:123], v[44:47], v[72:75], 0
  v_bitop3_b32 v27, v72, s61, 1 bitop3:0x28
  v_cmp_ne_u32 vcc, 0, v27
  s_nop 1
  s_cbranch_vccz pg_88
  buffer_load_dwordx4 v[72:75], v16, s[4:7], s60 offen sc1
  s_add_u32 s54, s54, 1
  s_cmp_gt_u32 s54, 131072
  s_cbranch_scc1 end0
  s_branch pp_87
last_79:
  v_smfmac_f32_16x16x64_bf16 v[96:99], v[48:51], a[0:7], v22
  v_smfmac_f32_16x16x64_bf16 v[100:103], v[48:51], a[80:87], v22
  v_smfmac_f32_16x16x64_bf16 v[96:99], v[52:55], a[8:15], v22
  v_smfmac_f32_16x16x64_bf16 v[100:103], v[52:55], a[88:95], v22
  v_smfmac_f32_16x16x64_bf16 v[96:99], v[56:59], a[16:23], v22
  v_smfmac_f32_16x16x64_bf16 v[100:103], v[56:59], a[96:103], v22
  v_smfmac_f32_16x16x64_bf16 v[96:99], v[60:63], a[24:31], v22
  v_smfmac_f32_16x16x64_bf16 v[96:99], v[64:67], a[32:39], v22
  v_smfmac_f32_16x16x64_bf16 v[96:99], v[68:71], a[40:47], v22
  v_smfmac_f32_16x16x64_bf16 v[96:99], v[72:75], a[48:55], v22
  v_smfmac_f32_16x16x64_bf16 v[96:99], v[76:79], a[56:63], v22
  v_smfmac_f32_16x16x64_bf16 v[96:99], v[80:83], a[64:71], v22
  v_smfmac_f32_16x16x64_bf16 v[96:99], v[84:87], a[72:79], v22
  v_smfmac_f32_16x16x64_bf16 v[100:103], v[60:63], a[104:111], v22
  v_smfmac_f32_16x16x64_bf16 v[100:103], v[64:67], a[112:119], v22
  v_smfmac_f32_16x16x64_bf16 v[100:103], v[68:71], a[120:127], v22
  v_smfmac_f32_16x16x64_bf16 v[100:103], v[72:75], a[128:135], v22
  v_smfmac_f32_16x16x64_bf16 v[100:103], v[76:79], a[136:143], v22
  v_smfmac_f32_16x16x64_bf16 v[100:103], v[80:83], a[144:151], v22
  v_smfmac_f32_16x16x64_bf16 v[100:103], v[84:87], a[152:159], v22
  s_nop 7
  v_permlane32_swap_b32 v96, v100
  v_permlane32_swap_b32 v97, v101
  v_permlane32_swap_b32 v98, v102
  v_permlane32_swap_b32 v99, v103
  v_pk_add_f32 v[96:97], v[96:97], v[100:101]
  v_pk_add_f32 v[98:99], v[98:99], v[102:103]
  v_cvt_pk_bf16_f32 v182, v96, v97
  v_cvt_pk_bf16_f32 v183, v98, v99
  v_min_u32 v182, -2, v182
  ds_write_b64 v26, v[182:183]
  s_waitcnt lgkmcnt(0)
  s_barrier
  s_branch chain_done
E_34:
  v_add_u32 v190, 9216, v4
  ds_read_b128 v[84:87], v4 offset:9216
  s_waitcnt lgkmcnt(0)
  s_branch mo_100
  .p2align 3
top_95:
  s_waitcnt vmcnt(0)
  ds_write_b128 v190, v[84:87] offset:0
  v_cmp_eq_u32 s[22:23], -1, v84
  s_or_b64 vcc, s[22:23], s[22:23]
  s_cbranch_scc1 mr_96
mo_100:
  s_waitcnt lgkmcnt(0)
  s_barrier
  ds_read_b128 v[48:51], v4 offset:0
  ds_read_b128 v[52:55], v4 offset:1024
  v_smfmac_f32_16x16x64_bf16 v[92:95], v[84:87], v[248:255], v22
  ds_read_b128 v[56:59], v4 offset:2048
  v_smfmac_f32_16x16x64_bf16 v[88:91], v[84:87], a[232:239], v22
  s_waitcnt lgkmcnt(2)
  ds_read_b128 v[60:63], v4 offset:3072
  v_smfmac_f32_16x16x64_bf16 v[92:95], v[48:51], a[240:247], v22
  ds_read_b128 v[64:67], v4 offset:4096
  v_smfmac_f32_16x16x64_bf16 v[88:91], v[48:51], a[160:167], v22
  s_waitcnt lgkmcnt(3)
  ds_read_b128 v[68:71], v4 offset:5120
  v_smfmac_f32_16x16x64_bf16 v[92:95], v[52:55], a[248:255], v22
  ds_read_b128 v[72:75], v4 offset:6144
  v_smfmac_f32_16x16x64_bf16 v[88:91], v[52:55], a[168:175], v22
  s_waitcnt lgkmcnt(4)
  ds_read_b128 v[76:79], v4 offset:7168
  v_smfmac_f32_16x16x64_bf16 v[92:95], v[56:59], v[192:199], v22
  ds_read_b128 v[80:83], v4 offset:8192
  v_smfmac_f32_16x16x64_bf16 v[88:91], v[56:59], a[176:183], v22
  s_waitcnt lgkmcnt(5)
  s_add_u32 m0, s74, 10240
  s_nop 0
  buffer_load_dwordx4 v33, s[16:19], s73 offen sc1 lds
  v_smfmac_f32_16x16x64_bf16 v[92:95], v[60:63], v[200:207], v22
  s_waitcnt lgkmcnt(4)
  s_add_u32 m0, s74, 11264
  s_nop 0
  buffer_load_dwordx4 v34, s[16:19], s73 offen sc1 lds
  v_smfmac_f32_16x16x64_bf16 v[92:95], v[64:67], v[208:215], v22
  s_waitcnt lgkmcnt(3)
  s_add_u32 m0, s74, 12288
  s_nop 0
  buffer_load_dwordx4 v35, s[16:19], s73 offen sc1 lds
  v_smfmac_f32_16x16x64_bf16 v[92:95], v[68:71], v[216:223], v22
  s_waitcnt lgkmcnt(2)
  v_smfmac_f32_16x16x64_bf16 v[92:95], v[72:75], v[224:231], v22
  s_waitcnt lgkmcnt(1)
  v_smfmac_f32_16x16x64_bf16 v[92:95], v[76:79], v[232:239], v22
  s_waitcnt lgkmcnt(0)
  v_smfmac_f32_16x16x64_bf16 v[92:95], v[80:83], v[240:247], v22
  v_smfmac_f32_16x16x64_bf16 v[88:91], v[60:63], a[184:191], v22
  v_smfmac_f32_16x16x64_bf16 v[88:91], v[64:67], a[192:199], v22
  v_smfmac_f32_16x16x64_bf16 v[88:91], v[68:71], a[200:207], v22
  v_cvt_pk_bf16_f32 v122, v92, v93
  v_smfmac_f32_16x16x64_bf16 v[88:91], v[72:75], a[208:215], v22
  v_cvt_pk_bf16_f32 v123, v94, v95
  v_smfmac_f32_16x16x64_bf16 v[88:91], v[76:79], a[216:223], v22
  ds_write_b64 v12, v[122:123] offset:13056
  v_smfmac_f32_16x16x64_bf16 v[88:91], v[80:83], a[224:231], v22
  v_smfmac_f32_16x16x64_bf16 v[96:99], v[48:51], a[0:7], v22
  v_smfmac_f32_16x16x64_bf16 v[100:103], v[48:51], a[80:87], v22
  v_smfmac_f32_16x16x64_bf16 v[96:99], v[52:55], a[8:15], v22
  v_cvt_pk_bf16_f32 v120, v88, v89
  v_cvt_pk_bf16_f32 v121, v90, v91
  ds_write_b64 v12, v[120:121] offset:12544
  v_smfmac_f32_16x16x64_bf16 v[100:103], v[52:55], a[88:95], v22
  v_cmp_u_f32 vcc, v88, v89
  v_smfmac_f32_16x16x64_bf16 v[96:99], v[56:59], a[16:23], v22
  v_cmp_u_f32 s[22:23], v90, v91
  s_nop 0
  s_or_b64 vcc, vcc, s[22:23]
  s_cbranch_vccnz mn_97
mk_98:
  s_waitcnt lgkmcnt(0)
  s_barrier
  ds_read_b64_tr_b16 v[104:105], v7 offset:0
  ds_read_b64_tr_b16 v[106:107], v7 offset:768
  ds_read_b64_tr_b16 v[108:109], v7 offset:1536
  ds_read_b64 v[140:141], v11
  s_cmp_eq_u32 s52, 63
  s_cbranch_scc1 last_99
  s_add_u32 s22, s52, 3
  s_min_u32 s22, s22, 64
  v_cmp_gt_u32 vcc, s22, v42
  s_nop 1
  s_cbranch_vccnz kw_101
kv_102:
  v_smfmac_f32_16x16x64_bf16 v[100:103], v[56:59], a[96:103], v22
  v_smfmac_f32_16x16x64_bf16 v[96:99], v[60:63], a[24:31], v22
  v_smfmac_f32_16x16x64_bf16 v[96:99], v[64:67], a[32:39], v22
  v_smfmac_f32_16x16x64_bf16 v[96:99], v[68:71], a[40:47], v22
  v_smfmac_f32_16x16x64_bf16 v[96:99], v[72:75], a[48:55], v22
  v_smfmac_f32_16x16x64_bf16 v[96:99], v[76:79], a[56:63], v22
  v_smfmac_f32_16x16x64_bf16 v[96:99], v[80:83], a[64:71], v22
  v_smfmac_f32_16x16x64_bf16 v[96:99], v[84:87], a[72:79], v22
  v_smfmac_f32_16x16x64_bf16 v[100:103], v[60:63], a[104:111], v22
  v_smfmac_f32_16x16x64_bf16 v[100:103], v[64:67], a[112:119], v22
  v_smfmac_f32_16x16x64_bf16 v[100:103], v[68:71], a[120:127], v22
  v_smfmac_f32_16x16x64_bf16 v[100:103], v[72:75], a[128:135], v22
  v_cvt_pk_bf16_f32 v136, v96, v97
  v_smfmac_f32_16x16x64_bf16 v[100:103], v[76:79], a[136:143], v22
  v_cvt_pk_bf16_f32 v137, v98, v99
  v_smfmac_f32_16x16x64_bf16 v[100:103], v[80:83], a[144:151], v22
  v_smfmac_f32_16x16x64_bf16 v[100:103], v[84:87], a[152:159], v22
  s_sleep 3
  s_nop 3
  buffer_load_dwordx4 v[124:127], v9, s[8:11], s56 offen sc1
  buffer_load_dwordx4 v[128:131], v9, s[8:11], s56 offen offset:1024 sc1
  s_nop 5
  buffer_load_dwordx4 v[132:135], v10, s[8:11], s56 offen sc1
  s_waitcnt vmcnt(2)
  v_pk_add_f16 v172, v124, v126
  v_pk_add_f16 v173, v125, v127
  s_waitcnt vmcnt(1)
  v_pk_add_f16 v174, v128, v130
  v_pk_add_f16 v175, v129, v131
  v_fma_mix_f32 v166, v172, 1.0, v174 op_sel:[0,0,0] op_sel_hi:[1,0,1]
  v_fma_mix_f32 v168, v173, 1.0, v175 op_sel:[0,0,0] op_sel_hi:[1,0,1]
  s_waitcnt vmcnt(0)
  v_pk_add_f16 v176, v132, v133
  v_pk_add_f16 v177, v134, v135
  v_fma_mix_f32 v170, v176, 1.0, v177 op_sel:[0,0,0] op_sel_hi:[1,0,1]
  v_fma_mix_f32 v167, v172, 1.0, v174 op_sel:[1,0,1] op_sel_hi:[1,0,1]
  v_cmp_u_f32 vcc, v166, v170
  v_fma_mix_f32 v169, v173, 1.0, v175 op_sel:[1,0,1] op_sel_hi:[1,0,1]
  v_fma_mix_f32 v171, v176, 1.0, v177 op_sel:[1,0,1] op_sel_hi:[1,0,1]
  v_cvt_pk_bf16_f32 v138, v100, v101
  s_cbranch_vccnz sr_103
sj_104:
ex_105:
  v_exp_f32 v172, v166
  v_exp_f32 v173, v167
  v_exp_f32 v174, v168
  v_cvt_pk_bf16_f32 v156, v172, v173
  v_exp_f32 v175, v169
  v_exp_f32 v176, v170
  v_cvt_pk_bf16_f32 v157, v174, v175
  v_mov_b32_dpp v158, v156 row_ror:8 row_mask:0xf bank_mask:0xf
  v_exp_f32 v177, v171
  v_mov_b32_dpp v159, v157 row_ror:8 row_mask:0xf bank_mask:0xf
  v_cvt_pk_bf16_f32 v160, v176, v177
  v_cvt_pk_bf16_f32 v139, v102, v103
  v_mfma_f32_16x16x32_bf16 v[178:181], v[152:155], v[156:159], 0
  s_waitcnt lgkmcnt(0)
  v_mov_b32_dpp v161, v160 row_ror:8 row_mask:0xf bank_mask:0xf
  v_mfma_f32_16x16x32_bf16 v[182:185], v[144:147], v[156:159], 0
  s_nop 0
  v_mfma_f32_16x16x32_bf16 v[178:181], v[140:143], v[160:163], v[178:181]
  v_mfma_f32_16x16x32_bf16 v[182:185], v[136:139], v[160:163], v[182:185]
  v_mfma_f32_16x16x32_bf16 v[186:189], v[148:151], v[156:159], 0
  v_mfma_f32_16x16x32_bf16 v[186:189], v[138:141], v[160:163], v[186:189]
  s_mov_b64 exec, s[62:63]
  v_rcp_f32 v164, v180
  s_nop 0
  v_pk_mul_f32 v[178:179], v[178:179], v[164:165] op_sel_hi:[1,0]
  v_pk_mul_f32 v[182:183], v[182:183], v[164:165] op_sel_hi:[1,0]
  v_pk_mul_f32 v[184:185], v[184:185], v[164:165] op_sel_hi:[1,0]
  v_cvt_pk_f16_f32 v64, v178, v179
  v_cvt_pk_f16_f32 v60, v182, v183
  v_pk_mul_f32 v[186:187], v[186:187], v[164:165] op_sel_hi:[1,0]
  v_pk_mul_f32 v[188:189], v[188:189], v[164:165] op_sel_hi:[1,0]
  v_cvt_pk_f16_f32 v61, v184, v185
  v_cvt_pk_f16_f32 v62, v186, v187
  v_cvt_pk_f16_f32 v63, v188, v189
  ds_write_b128 v13, v[60:63]
  ds_write_b32 v14, v64
  v_add_f32 v165, v164, v180
  v_cmp_ngt_f32 vcc, s80, v165
  s_mov_b64 exec, -1
  s_nop 0
  s_cbranch_vccnz fx_106
fk_107:
  s_waitcnt lgkmcnt(0)
  s_barrier
  ds_read_b128 v[166:169], v4 offset:13824
  ds_read_b128 v[170:173], v4 offset:14464
  ds_read_b128 v[174:177], v4 offset:15104
  ds_read_b128 v[178:181], v4 offset:15744
  s_mov_b64 exec, s[66:67]
  s_waitcnt lgkmcnt(2)
  v_pk_add_f16 v166, v166, v170
  v_pk_add_f16 v167, v167, v171
  v_pk_add_f16 v168, v168, v172
  v_pk_add_f16 v169, v169, v173
  s_waitcnt lgkmcnt(1)
  v_pk_add_f16 v166, v166, v174
  v_pk_add_f16 v167, v167, v175
  v_pk_add_f16 v168, v168, v176
  v_pk_add_f16 v169, v169, v177
  s_waitcnt lgkmcnt(0)
  v_pk_add_f16 v166, v166, v178
  v_pk_add_f16 v167, v167, v179
  v_pk_add_f16 v168, v168, v180
  v_pk_add_f16 v169, v169, v181
  v_and_or_b32 v166, v166, -2, s61
  buffer_store_dwordx4 v[166:169], v15, s[4:7], s60 offen sc1
  s_mov_b64 exec, -1
  v_permlane32_swap_b32 v96, v100
  v_permlane32_swap_b32 v97, v101
  v_permlane32_swap_b32 v98, v102
  v_permlane32_swap_b32 v99, v103
  v_pk_add_f32 v[96:97], v[96:97], v[100:101]
  v_pk_add_f32 v[98:99], v[98:99], v[102:103]
  v_cvt_pk_bf16_f32 v182, v96, v97
  v_cvt_pk_bf16_f32 v183, v98, v99
  v_min_u32 v182, -2, v182
  ds_write_b64 v26, v[182:183]
  v_permlane32_swap_b32 v88, v92
  v_permlane32_swap_b32 v89, v93
  v_permlane32_swap_b32 v90, v94
  v_permlane32_swap_b32 v91, v95
  v_pk_add_f32 v[88:89], v[88:89], v[92:93]
  v_pk_add_f32 v[90:91], v[90:91], v[94:95]
  v_cvt_pk_bf16_f32 v184, v88, v89
  v_cvt_pk_bf16_f32 v185, v90, v91
  v_min_u32 v184, -2, v184
  ds_write_b64 v43, v[184:185]
  ds_read_b128 v[144:147], v18
  ds_read_b128 v[148:151], v18 offset:1024
  ds_read_b128 v[152:155], v19
  v_xor_b32 v18, 16384, v18
  v_xor_b32 v19, 16384, v19
  v_mov_b32 v88, 0
  v_mov_b32 v89, 0
  v_mov_b32 v90, 0
  v_mov_b32 v91, 0
  v_mov_b32 v92, 0
  v_mov_b32 v93, 0
  v_mov_b32 v94, 0
  v_mov_b32 v95, 0
  v_mov_b32 v96, 0
  v_mov_b32 v97, 0
  v_mov_b32 v98, 0
  v_mov_b32 v99, 0
  v_mov_b32 v100, 0
  v_mov_b32 v101, 0
  v_mov_b32 v102, 0
  v_mov_b32 v103, 0
  s_mov_b32 s81, 0
  s_waitcnt lgkmcnt(0)
  s_barrier
  s_add_u32 s72, s72, 1310720
  s_add_u32 s79, s79, 1310720
  s_add_u32 s73, s73, 393216
  s_xor_b32 s74, s74, 16384
  v_mov_b32 v28, s61
  v_mov_b32 v166, s52
  s_mov_b64 exec, 1
  buffer_store_dword v166, v23, s[12:15], s77 offen sc1
  s_mov_b64 exec, -1
  ds_read_b128 v[170:173], v4 offset:16384
  ds_read_b128 v[174:177], v4 offset:17408
  ds_read_b128 v[178:181], v4 offset:18432
  v_min_u32 v104, -2, v104
  v_min_u32 v106, -2, v106
  v_min_u32 v108, -2, v108
  s_mov_b64 exec, s[68:69]
  buffer_store_dwordx4 v[104:107], v36, s[24:27], s70 offen sc1
  buffer_store_dwordx2 v[108:109], v37, s[24:27], s70 offen sc1
  s_mov_b64 exec, -1
  s_waitcnt lgkmcnt(0)
  buffer_store_dwordx4 v[170:173], v38, s[36:39], s71 offen sc1
  buffer_store_dwordx4 v[174:177], v39, s[36:39], s71 offen sc1
  s_mov_b64 exec, 0xffffffff
  buffer_store_dwordx4 v[178:181], v40, s[36:39], s71 offen sc1
  s_mov_b64 exec, -1
  s_add_u32 s70, s70, 98304
  s_add_u32 s71, s71, 327680
  buffer_load_dword v42, v41, s[12:15], s76 offen sc1
nt_108:
  s_barrier
  s_mov_b32 s58, s55
  s_add_u32 s52, s52, 1
  s_and_b32 s21, s52, 3
  s_mul_i32 s56, s21, 122880
  s_add_u32 s21, s52, 1
  s_and_b32 s21, s21, 3
  s_mul_i32 s55, s21, 122880
  s_add_u32 s55, s55, s75
  s_add_u32 s21, s52, 2
  s_and_b32 s21, s21, 3
  s_mul_i32 s57, s21, 122880
  s_add_u32 s21, s52, 3
  s_and_b32 s21, s21, 3
  s_mul_i32 s59, s21, 122880
  s_add_u32 s59, s59, s75
  s_bfe_u32 s61, s52, 0x10001
  s_and_b32 s21, s52, 1
  s_lshl_b32 s60, s21, 19
  s_mov_b32 s54, 0
  s_sleep 3
  s_nop 2
  buffer_load_dwordx4 v[84:87], v190, s[8:11], s58 offen offset:0 sc1
  s_branch top_95
mr_96:
  s_mov_b64 exec, s[22:23]
  s_cbranch_execz ms_109
  buffer_load_dwordx4 v[84:87], v190, s[8:11], s58 offen offset:0 sc1
ms_109:
  s_add_u32 s54, s54, 1
  s_cmp_gt_u32 s54, 131072
  s_cbranch_scc1 end0
  s_waitcnt vmcnt(0)
  s_mov_b64 exec, s[22:23]
  ds_write_b128 v190, v[84:87] offset:0
  v_cmp_eq_u32 s[22:23], -1, v84
  s_mov_b64 exec, -1
  s_or_b64 vcc, s[22:23], s[22:23]
  s_cbranch_scc1 mr_96
  s_branch mo_100
mn_97:
  v_max3_u32 v27, v48, v49, v50
  v_max3_u32 v27, v27, v51, v52
  v_max3_u32 v27, v27, v53, v54
  v_max3_u32 v27, v27, v55, v56
  v_max3_u32 v27, v27, v57, v58
  v_max3_u32 v27, v27, v59, v60
  v_max3_u32 v27, v27, v61, v62
  v_max3_u32 v27, v27, v63, v64
  v_max3_u32 v27, v27, v65, v66
  v_max3_u32 v27, v27, v67, v68
  v_max3_u32 v27, v27, v69, v70
  v_max3_u32 v27, v27, v71, v72
  v_max3_u32 v27, v27, v73, v74
  v_max3_u32 v27, v27, v75, v76
  v_max3_u32 v27, v27, v77, v78
  v_max3_u32 v27, v27, v79, v80
  v_max3_u32 v27, v27, v81, v82
  v_max3_u32 v27, v27, v83, v84
  v_max3_u32 v27, v27, v85, v86
  v_max3_u32 v27, v27, v87, v87
  v_cmp_eq_u32 vcc, -1, v27
  s_cmp_eq_u32 s52, 0
  s_cbranch_scc1 mk_98
  s_cbranch_vccz mk_98
  s_waitcnt lgkmcnt(0)
  s_barrier
  s_nop 7
  v_mov_b32 v88, 0
  v_mov_b32 v89, 0
  v_mov_b32 v90, 0
  v_mov_b32 v91, 0
  v_mov_b32 v92, 0
  v_mov_b32 v93, 0
  v_mov_b32 v94, 0
  v_mov_b32 v95, 0
  v_mov_b32 v96, 0
  v_mov_b32 v97, 0
  v_mov_b32 v98, 0
  v_mov_b32 v99, 0
  v_mov_b32 v100, 0
  v_mov_b32 v101, 0
  v_mov_b32 v102, 0
  v_mov_b32 v103, 0
  s_mov_b64 s[22:23], -1
  s_branch mr_96
kw_101:
  s_mov_b32 s101, 0
wm_110:
  buffer_load_dword v42, v41, s[12:15], s76 offen sc1
  s_add_u32 s101, s101, 1
  s_cmp_gt_u32 s101, 131072
  s_cbranch_scc1 end0
  s_waitcnt vmcnt(0)
  v_cmp_gt_u32 vcc, s22, v42
  v_readfirstlane_b32 s100, v42
  s_nop 0
  s_cbranch_vccz wm_111
  s_sleep 1
  s_branch wm_110
wm_111:
  s_branch kv_102
sr_103:
  s_mov_b32 s54, 0
sr_112:
  s_mov_b64 exec, vcc
  buffer_load_dwordx4 v[124:127], v9, s[8:11], s56 offen sc1
  buffer_load_dwordx4 v[128:131], v9, s[8:11], s56 offen offset:1024 sc1
  buffer_load_dwordx4 v[132:135], v10, s[8:11], s56 offen sc1
  s_mov_b64 exec, -1
  s_add_u32 s54, s54, 1
  s_cmp_gt_u32 s54, 131072
  s_cbranch_scc1 end0
  s_and_b32 s21, s54, 31
  s_cbranch_scc0 sr_113
  s_waitcnt vmcnt(0)
  v_pk_add_f16 v172, v124, v126
  v_pk_add_f16 v173, v125, v127
  v_pk_add_f16 v174, v128, v130
  v_pk_add_f16 v175, v129, v131
  v_fma_mix_f32 v166, v172, 1.0, v174 op_sel:[0,0,0] op_sel_hi:[1,0,1]
  v_fma_mix_f32 v168, v173, 1.0, v175 op_sel:[0,0,0] op_sel_hi:[1,0,1]
  v_pk_add_f16 v176, v132, v133
  v_pk_add_f16 v177, v134, v135
  v_add_f32 v27, v166, v168
  v_fma_mix_f32 v170, v176, 1.0, v177 op_sel:[0,0,0] op_sel_hi:[1,0,1]
  v_fma_mix_f32 v167, v172, 1.0, v174 op_sel:[1,0,1] op_sel_hi:[1,0,1]
  v_cmp_u_f32 vcc, v27, v170
  v_fma_mix_f32 v169, v173, 1.0, v175 op_sel:[1,0,1] op_sel_hi:[1,0,1]
  v_fma_mix_f32 v171, v176, 1.0, v177 op_sel:[1,0,1] op_sel_hi:[1,0,1]
  s_cbranch_vccnz sr_112
  s_branch sj_104
sr_113:
  s_waitcnt vmcnt(0)
  v_pk_add_f16 v172, v124, v126
  v_pk_add_f16 v173, v125, v127
  v_pk_add_f16 v174, v128, v130
  v_pk_add_f16 v175, v129, v131
  v_fma_mix_f32 v166, v172, 1.0, v174 op_sel:[0,0,0] op_sel_hi:[1,0,1]
  v_fma_mix_f32 v168, v173, 1.0, v175 op_sel:[0,0,0] op_sel_hi:[1,0,1]
  v_pk_add_f16 v176, v132, v133
  v_pk_add_f16 v177, v134, v135
  v_add_f32 v27, v166, v168
  v_fma_mix_f32 v170, v176, 1.0, v177 op_sel:[0,0,0] op_sel_hi:[1,0,1]
  v_fma_mix_f32 v167, v172, 1.0, v174 op_sel:[1,0,1] op_sel_hi:[1,0,1]
  v_cmp_u_f32 vcc, v27, v170
  v_fma_mix_f32 v169, v173, 1.0, v175 op_sel:[1,0,1] op_sel_hi:[1,0,1]
  v_fma_mix_f32 v171, v176, 1.0, v177 op_sel:[1,0,1] op_sel_hi:[1,0,1]
  v_max3_u32 v27, v124, v126, v128
  v_max3_u32 v27, v27, v130, v132
  v_max3_u32 v27, v27, v133, v134
  v_max3_u32 v27, v27, v135, v135
  v_cmp_eq_u32 vcc, -1, v27
  s_nop 1
  s_cbranch_vccnz sr_112
  s_branch sj_104
fx_106:
  s_cmp_eq_u32 s81, 1
  s_cbranch_scc1 fk_107
  s_mov_b32 s81, 1
  v_max3_f32 v164, v166, v167, v168
  v_max3_f32 v165, v169, v170, v171
  v_max_f32 v164, v164, v165
  s_nop 1
  v_max_f32_dpp v164, v164, v164 row_ror:8 row_mask:0xf bank_mask:0xf
  v_mov_b32 v165, v164
  s_nop 1
  v_permlane32_swap_b32 v164, v165
  v_max_f32 v164, v164, v165
  v_mov_b32 v165, v164
  s_nop 1
  v_permlane16_swap_b32 v164, v165
  v_max_f32 v164, v164, v165
  v_sub_f32 v166, v166, v164
  v_sub_f32 v167, v167, v164
  v_sub_f32 v168, v168, v164
  v_sub_f32 v169, v169, v164
  v_sub_f32 v170, v170, v164
  v_sub_f32 v171, v171, v164
  s_branch ex_105
last_99:
  v_smfmac_f32_16x16x64_bf16 v[100:103], v[56:59], a[96:103], v22
  v_smfmac_f32_16x16x64_bf16 v[96:99], v[60:63], a[24:31], v22
  v_smfmac_f32_16x16x64_bf16 v[96:99], v[64:67], a[32:39], v22
  v_smfmac_f32_16x16x64_bf16 v[96:99], v[68:71], a[40:47], v22
  v_smfmac_f32_16x16x64_bf16 v[96:99], v[72:75], a[48:55], v22
  v_smfmac_f32_16x16x64_bf16 v[96:99], v[76:79], a[56:63], v22
  v_smfmac_f32_16x16x64_bf16 v[96:99], v[80:83], a[64:71], v22
  v_smfmac_f32_16x16x64_bf16 v[96:99], v[84:87], a[72:79], v22
  v_smfmac_f32_16x16x64_bf16 v[100:103], v[60:63], a[104:111], v22
  v_smfmac_f32_16x16x64_bf16 v[100:103], v[64:67], a[112:119], v22
  v_smfmac_f32_16x16x64_bf16 v[100:103], v[68:71], a[120:127], v22
  v_smfmac_f32_16x16x64_bf16 v[100:103], v[72:75], a[128:135], v22
  v_smfmac_f32_16x16x64_bf16 v[100:103], v[76:79], a[136:143], v22
  v_smfmac_f32_16x16x64_bf16 v[100:103], v[80:83], a[144:151], v22
  v_smfmac_f32_16x16x64_bf16 v[100:103], v[84:87], a[152:159], v22
  s_nop 7
  v_permlane32_swap_b32 v96, v100
  v_permlane32_swap_b32 v97, v101
  v_permlane32_swap_b32 v98, v102
  v_permlane32_swap_b32 v99, v103
  v_pk_add_f32 v[96:97], v[96:97], v[100:101]
  v_pk_add_f32 v[98:99], v[98:99], v[102:103]
  v_cvt_pk_bf16_f32 v182, v96, v97
  v_cvt_pk_bf16_f32 v183, v98, v99
  v_min_u32 v182, -2, v182
  ds_write_b64 v26, v[182:183]
  v_permlane32_swap_b32 v88, v92
  v_permlane32_swap_b32 v89, v93
  v_permlane32_swap_b32 v90, v94
  v_permlane32_swap_b32 v91, v95
  v_pk_add_f32 v[88:89], v[88:89], v[92:93]
  v_pk_add_f32 v[90:91], v[90:91], v[94:95]
  v_cvt_pk_bf16_f32 v184, v88, v89
  v_cvt_pk_bf16_f32 v185, v90, v91
  v_min_u32 v184, -2, v184
  ds_write_b64 v43, v[184:185]
  s_waitcnt lgkmcnt(0)
  s_barrier
  ds_read_b128 v[170:173], v4 offset:16384
  ds_read_b128 v[174:177], v4 offset:17408
  ds_read_b128 v[178:181], v4 offset:18432
  v_min_u32 v104, -2, v104
  v_min_u32 v106, -2, v106
  v_min_u32 v108, -2, v108
  s_mov_b64 exec, s[68:69]
  buffer_store_dwordx4 v[104:107], v36, s[24:27], s70 offen sc1
  buffer_store_dwordx2 v[108:109], v37, s[24:27], s70 offen sc1
  s_mov_b64 exec, -1
  s_waitcnt lgkmcnt(0)
  buffer_store_dwordx4 v[170:173], v38, s[36:39], s71 offen sc1
  buffer_store_dwordx4 v[174:177], v39, s[36:39], s71 offen sc1
  s_mov_b64 exec, 0xffffffff
  buffer_store_dwordx4 v[178:181], v40, s[36:39], s71 offen sc1
  s_mov_b64 exec, -1
  s_add_u32 s70, s70, 98304
  s_add_u32 s71, s71, 327680
  s_waitcnt vmcnt(0)
  v_mov_b32 v166, 64
  s_mov_b64 exec, 1
  buffer_store_dword v166, v23, s[12:15], s77 offen sc1
  s_mov_b64 exec, -1
  s_branch chain_done
E_27:
  v_add_u32 v190, 0, v4
  ds_read_b128 v[48:51], v4 offset:0
  ds_read_b128 v[52:55], v4 offset:1024
  ds_read_b128 v[56:59], v4 offset:2048
  s_waitcnt lgkmcnt(0)
  s_branch mo_119
  .p2align 3
top_114:
  s_waitcnt vmcnt(2)
  ds_write_b128 v190, v[48:51] offset:0
  v_cmp_eq_u32 s[22:23], -1, v48
  s_waitcnt vmcnt(1)
  ds_write_b128 v190, v[52:55] offset:1024
  v_cmp_eq_u32 s[98:99], -1, v52
  s_waitcnt vmcnt(0)
  ds_write_b128 v190, v[56:59] offset:2048
  v_cmp_eq_u32 s[100:101], -1, v56
  s_or_b64 vcc, s[22:23], s[98:99]
  s_or_b64 vcc, vcc, s[100:101]
  s_cbranch_scc1 mr_115
mo_119:
  s_waitcnt lgkmcnt(0)
  s_barrier
  ds_read_b128 v[60:63], v4 offset:3072
  ds_read_b128 v[64:67], v4 offset:4096
  v_smfmac_f32_16x16x64_bf16 v[92:95], v[48:51], a[240:247], v22
  ds_read_b128 v[68:71], v4 offset:5120
  v_smfmac_f32_16x16x64_bf16 v[88:91], v[48:51], a[160:167], v22
  ds_read_b128 v[72:75], v4 offset:6144
  v_smfmac_f32_16x16x64_bf16 v[92:95], v[52:55], a[248:255], v22
  ds_read_b128 v[76:79], v4 offset:7168
  v_smfmac_f32_16x16x64_bf16 v[88:91], v[52:55], a[168:175], v22
  ds_read_b128 v[80:83], v4 offset:8192
  v_smfmac_f32_16x16x64_bf16 v[92:95], v[56:59], v[192:199], v22
  ds_read_b128 v[84:87], v4 offset:9216
  v_smfmac_f32_16x16x64_bf16 v[88:91], v[56:59], a[176:183], v22
  s_waitcnt lgkmcnt(6)
  v_smfmac_f32_16x16x64_bf16 v[92:95], v[60:63], v[200:207], v22
  v_smfmac_f32_16x16x64_bf16 v[88:91], v[60:63], a[184:191], v22
  s_waitcnt lgkmcnt(5)
  v_smfmac_f32_16x16x64_bf16 v[92:95], v[64:67], v[208:215], v22
  s_waitcnt lgkmcnt(4)
  v_smfmac_f32_16x16x64_bf16 v[92:95], v[68:71], v[216:223], v22
  s_waitcnt lgkmcnt(3)
  v_smfmac_f32_16x16x64_bf16 v[92:95], v[72:75], v[224:231], v22
  s_waitcnt lgkmcnt(2)
  v_smfmac_f32_16x16x64_bf16 v[92:95], v[76:79], v[232:239], v22
  s_waitcnt lgkmcnt(1)
  v_smfmac_f32_16x16x64_bf16 v[92:95], v[80:83], v[240:247], v22
  s_waitcnt lgkmcnt(0)
  v_smfmac_f32_16x16x64_bf16 v[92:95], v[84:87], v[248:255], v22
  v_smfmac_f32_16x16x64_bf16 v[88:91], v[64:67], a[192:199], v22
  v_smfmac_f32_16x16x64_bf16 v[88:91], v[68:71], a[200:207], v22
  v_smfmac_f32_16x16x64_bf16 v[88:91], v[72:75], a[208:215], v22
  v_permlane32_swap_b32 v92, v93
  v_smfmac_f32_16x16x64_bf16 v[88:91], v[76:79], a[216:223], v22
  v_permlane32_swap_b32 v94, v95
  v_smfmac_f32_16x16x64_bf16 v[88:91], v[80:83], a[224:231], v22
  v_permlane32_swap_b32 v93, v92
  v_smfmac_f32_16x16x64_bf16 v[88:91], v[84:87], a[232:239], v22
  v_permlane32_swap_b32 v95, v94
  v_pk_mul_f32 v[120:121], v[92:93], v[24:25] op_sel:[1,0] op_sel_hi:[0,1]
  v_pk_mul_f32 v[122:123], v[94:95], v[24:25] op_sel:[1,0] op_sel_hi:[0,1]
  s_nop 4
  v_pk_fma_f32 v[88:89], v[88:89], v[24:25], v[120:121]
  v_pk_fma_f32 v[90:91], v[90:91], v[24:25], v[122:123]
  v_cvt_pk_bf16_f32 v120, v88, v89
  v_cvt_pk_bf16_f32 v121, v90, v91
  ds_write_b64 v6, v[120:121]
  v_cmp_u_f32 vcc, v88, v89
  v_cmp_u_f32 s[22:23], v90, v91
  s_nop 1
  s_or_b64 vcc, vcc, s[22:23]
  s_cbranch_vccnz mn_116
mk_117:
  s_waitcnt lgkmcnt(0)
  s_barrier
  ds_read_b64_tr_b16 v[104:105], v7 offset:0
  ds_read_b64_tr_b16 v[106:107], v7 offset:768
  ds_read_b64_tr_b16 v[108:109], v7 offset:1536
  ds_read_b64 v[140:141], v11
  s_cmp_eq_u32 s52, 63
  s_cbranch_scc1 last_118
  s_waitcnt lgkmcnt(2)
  v_mfma_f32_16x16x32_bf16 v[120:123], v[112:115], v[104:107], 0
  s_waitcnt lgkmcnt(1)
  v_mfma_f32_16x16x32_bf16 v[120:123], v[116:119], v[108:111], v[120:123]
  s_mov_b64 exec, s[64:65]
  s_nop 6
  v_cvt_pk_f16_f32 v120, v120, v121
  v_cvt_pk_f16_f32 v121, v122, v123
  buffer_store_dwordx2 v[120:121], v8, s[8:11], s56 offen sc1
  s_mov_b64 exec, -1
  s_sleep 3
  s_nop 1
  v_smfmac_f32_16x16x64_bf16 v[96:99], v[48:51], a[0:7], v22
  v_smfmac_f32_16x16x64_bf16 v[100:103], v[48:51], a[80:87], v22
  v_smfmac_f32_16x16x64_bf16 v[96:99], v[52:55], a[8:15], v22
  v_smfmac_f32_16x16x64_bf16 v[100:103], v[52:55], a[88:95], v22
  v_smfmac_f32_16x16x64_bf16 v[96:99], v[56:59], a[16:23], v22
  v_smfmac_f32_16x16x64_bf16 v[100:103], v[56:59], a[96:103], v22
  v_smfmac_f32_16x16x64_bf16 v[96:99], v[60:63], a[24:31], v22
  v_smfmac_f32_16x16x64_bf16 v[96:99], v[64:67], a[32:39], v22
  v_smfmac_f32_16x16x64_bf16 v[96:99], v[68:71], a[40:47], v22
  v_smfmac_f32_16x16x64_bf16 v[96:99], v[72:75], a[48:55], v22
  v_smfmac_f32_16x16x64_bf16 v[96:99], v[76:79], a[56:63], v22
  buffer_load_dwordx4 v[124:127], v9, s[8:11], s56 offen sc1
  v_smfmac_f32_16x16x64_bf16 v[96:99], v[80:83], a[64:71], v22
  buffer_load_dwordx4 v[128:131], v9, s[8:11], s56 offen offset:1024 sc1
  v_smfmac_f32_16x16x64_bf16 v[96:99], v[84:87], a[72:79], v22
  buffer_load_dwordx4 v[132:135], v10, s[8:11], s56 offen sc1
  v_smfmac_f32_16x16x64_bf16 v[100:103], v[60:63], a[104:111], v22
  v_smfmac_f32_16x16x64_bf16 v[100:103], v[64:67], a[112:119], v22
  v_smfmac_f32_16x16x64_bf16 v[100:103], v[68:71], a[120:127], v22
  v_smfmac_f32_16x16x64_bf16 v[100:103], v[72:75], a[128:135], v22
  v_cvt_pk_bf16_f32 v136, v96, v97
  v_smfmac_f32_16x16x64_bf16 v[100:103], v[76:79], a[136:143], v22
  v_cvt_pk_bf16_f32 v137, v98, v99
  v_smfmac_f32_16x16x64_bf16 v[100:103], v[80:83], a[144:151], v22
  v_smfmac_f32_16x16x64_bf16 v[100:103], v[84:87], a[152:159], v22
  s_waitcnt vmcnt(2)
  v_pk_add_f16 v172, v124, v126
  v_pk_add_f16 v173, v125, v127
  s_waitcnt vmcnt(1)
  v_pk_add_f16 v174, v128, v130
  v_pk_add_f16 v175, v129, v131
  v_fma_mix_f32 v166, v172, 1.0, v174 op_sel:[0,0,0] op_sel_hi:[1,0,1]
  v_fma_mix_f32 v168, v173, 1.0, v175 op_sel:[0,0,0] op_sel_hi:[1,0,1]
  s_waitcnt vmcnt(0)
  v_pk_add_f16 v176, v132, v133
  v_pk_add_f16 v177, v134, v135
  v_fma_mix_f32 v170, v176, 1.0, v177 op_sel:[0,0,0] op_sel_hi:[1,0,1]
  v_fma_mix_f32 v167, v172, 1.0, v174 op_sel:[1,0,1] op_sel_hi:[1,0,1]
  v_cmp_u_f32 vcc, v166, v170
  v_fma_mix_f32 v169, v173, 1.0, v175 op_sel:[1,0,1] op_sel_hi:[1,0,1]
  v_fma_mix_f32 v171, v176, 1.0, v177 op_sel:[1,0,1] op_sel_hi:[1,0,1]
  v_cvt_pk_bf16_f32 v138, v100, v101
  s_cbranch_vccnz sr_120
sj_121:
ex_122:
  v_exp_f32 v172, v166
  v_exp_f32 v173, v167
  v_exp_f32 v174, v168
  v_cvt_pk_bf16_f32 v156, v172, v173
  v_exp_f32 v175, v169
  v_exp_f32 v176, v170
  v_cvt_pk_bf16_f32 v157, v174, v175
  v_mov_b32_dpp v158, v156 row_ror:8 row_mask:0xf bank_mask:0xf
  v_exp_f32 v177, v171
  v_mov_b32_dpp v159, v157 row_ror:8 row_mask:0xf bank_mask:0xf
  v_cvt_pk_bf16_f32 v160, v176, v177
  v_cvt_pk_bf16_f32 v139, v102, v103
  v_mfma_f32_16x16x32_bf16 v[178:181], v[152:155], v[156:159], 0
  s_waitcnt lgkmcnt(0)
  v_mov_b32_dpp v161, v160 row_ror:8 row_mask:0xf bank_mask:0xf
  v_mfma_f32_16x16x32_bf16 v[182:185], v[144:147], v[156:159], 0
  s_nop 0
  v_mfma_f32_16x16x32_bf16 v[178:181], v[140:143], v[160:163], v[178:181]
  v_mfma_f32_16x16x32_bf16 v[182:185], v[136:139], v[160:163], v[182:185]
  v_mfma_f32_16x16x32_bf16 v[186:189], v[148:151], v[156:159], 0
  v_mfma_f32_16x16x32_bf16 v[186:189], v[138:141], v[160:163], v[186:189]
  s_mov_b64 exec, s[62:63]
  v_rcp_f32 v164, v180
  s_nop 0
  v_pk_mul_f32 v[178:179], v[178:179], v[164:165] op_sel_hi:[1,0]
  v_pk_mul_f32 v[182:183], v[182:183], v[164:165] op_sel_hi:[1,0]
  v_pk_mul_f32 v[184:185], v[184:185], v[164:165] op_sel_hi:[1,0]
  v_cvt_pk_f16_f32 v64, v178, v179
  v_cvt_pk_f16_f32 v60, v182, v183
  v_pk_mul_f32 v[186:187], v[186:187], v[164:165] op_sel_hi:[1,0]
  v_pk_mul_f32 v[188:189], v[188:189], v[164:165] op_sel_hi:[1,0]
  v_cvt_pk_f16_f32 v61, v184, v185
  v_cvt_pk_f16_f32 v62, v186, v187
  v_cvt_pk_f16_f32 v63, v188, v189
  ds_write_b128 v13, v[60:63]
  ds_write_b32 v14, v64
  v_add_f32 v165, v164, v180
  v_cmp_ngt_f32 vcc, s80, v165
  s_mov_b64 exec, -1
  s_nop 0
  s_cbranch_vccnz fx_123
fk_124:
  s_waitcnt lgkmcnt(0)
  s_barrier
  s_add_u32 m0, s74, 8192
  s_add_u32 s21, s72, 2048
  buffer_load_dwordx4 v32, s[28:31], s21 offen sc1 lds
  s_add_u32 m0, s74, 1024
  s_add_u32 s21, s79, 1024
  buffer_load_dwordx4 v4, s[28:31], s21 offen sc1 lds
  s_add_u32 m0, s74, 4096
  s_add_u32 s21, s79, 81920
  buffer_load_dwordx4 v4, s[28:31], s21 offen sc1 lds
  s_add_u32 m0, s74, 7168
  s_add_u32 s21, s79, 123904
  buffer_load_dwordx4 v4, s[28:31], s21 offen sc1 lds
  s_add_u32 s72, s72, 1310720
  s_add_u32 s79, s79, 1310720
  s_add_u32 s73, s73, 393216
  s_xor_b32 s74, s74, 16384
  s_nop 15
  s_nop 3
  v_permlane32_swap_b32 v96, v100
  v_permlane32_swap_b32 v97, v101
  v_permlane32_swap_b32 v98, v102
  v_permlane32_swap_b32 v99, v103
  v_pk_add_f32 v[96:97], v[96:97], v[100:101]
  v_pk_add_f32 v[98:99], v[98:99], v[102:103]
  v_cvt_pk_bf16_f32 v182, v96, v97
  v_cvt_pk_bf16_f32 v183, v98, v99
  v_min_u32 v182, -2, v182
  ds_write_b64 v26, v[182:183]
  ds_read_b128 v[144:147], v18
  ds_read_b128 v[148:151], v18 offset:1024
  ds_read_b128 v[152:155], v19
  ds_read_b128 v[112:115], v20
  ds_read_b64 v[116:117], v21
  v_xor_b32 v18, 16384, v18
  v_xor_b32 v19, 16384, v19
  v_xor_b32 v20, 16384, v20
  v_xor_b32 v21, 16384, v21
  v_mov_b32 v88, 0
  v_mov_b32 v89, 0
  v_mov_b32 v90, 0
  v_mov_b32 v91, 0
  v_mov_b32 v92, 0
  v_mov_b32 v93, 0
  v_mov_b32 v94, 0
  v_mov_b32 v95, 0
  v_mov_b32 v96, 0
  v_mov_b32 v97, 0
  v_mov_b32 v98, 0
  v_mov_b32 v99, 0
  v_mov_b32 v100, 0
  v_mov_b32 v101, 0
  v_mov_b32 v102, 0
  v_mov_b32 v103, 0
  s_mov_b32 s81, 0
  s_waitcnt lgkmcnt(0)
  s_barrier
  s_mov_b64 exec, s[64:65]
  buffer_store_dwordx2 v[28:29], v8, s[8:11], s57 offen sc1
  s_mov_b64 exec, s[62:63]
  buffer_store_dword v28, v17, s[8:11], s59 offen sc1
  s_mov_b64 exec, -1
  s_sleep 6
  s_nop 3
  buffer_load_dwordx4 v[68:71], v16, s[4:7], s60 offen sc1
  s_sleep 3
  s_nop 1
  buffer_load_dwordx4 v[72:75], v16, s[4:7], s60 offen sc1
  s_mov_b32 s54, 0
pp_126:
  s_waitcnt vmcnt(1)
  v_mfma_f32_16x16x32_f16 v[120:123], v[44:47], v[68:71], 0
  v_bitop3_b32 v27, v68, s61, 1 bitop3:0x28
  v_cmp_ne_u32 vcc, 0, v27
  s_nop 1
  s_cbranch_vccnz p2_128
  s_nop 2
pg_127:
  v_add_f32_dpp v120, v120, v120 row_ror:8 row_mask:0xf bank_mask:0xf
  v_add_f32_dpp v121, v121, v121 row_ror:8 row_mask:0xf bank_mask:0xf
  s_mov_b64 exec, s[62:63]
  v_cvt_pk_bf16_f32 v120, v120, v121
  v_min_u32 v120, -2, v120
  buffer_store_dword v120, v17, s[8:11], s55 offen sc1
  s_mov_b64 exec, -1
nt_125:
  s_barrier
  s_mov_b32 s58, s55
  s_add_u32 s52, s52, 1
  s_and_b32 s21, s52, 3
  s_mul_i32 s56, s21, 122880
  s_add_u32 s21, s52, 1
  s_and_b32 s21, s21, 3
  s_mul_i32 s55, s21, 122880
  s_add_u32 s55, s55, s75
  s_add_u32 s21, s52, 2
  s_and_b32 s21, s21, 3
  s_mul_i32 s57, s21, 122880
  s_add_u32 s21, s52, 3
  s_and_b32 s21, s21, 3
  s_mul_i32 s59, s21, 122880
  s_add_u32 s59, s59, s75
  s_bfe_u32 s61, s52, 0x10001
  s_and_b32 s21, s52, 1
  s_lshl_b32 s60, s21, 19
  s_mov_b32 s54, 0
  s_sleep 3
  s_nop 2
  buffer_load_dwordx4 v[48:51], v190, s[8:11], s58 offen offset:0 sc1
  buffer_load_dwordx4 v[52:55], v190, s[8:11], s58 offen offset:1024 sc1
  buffer_load_dwordx4 v[56:59], v190, s[8:11], s58 offen offset:2048 sc1
  s_branch top_114
mr_115:
  s_mov_b64 exec, s[22:23]
  s_cbranch_execz ms_129
  buffer_load_dwordx4 v[48:51], v190, s[8:11], s58 offen offset:0 sc1
ms_129:
  s_mov_b64 exec, s[98:99]
  s_cbranch_execz ms_130
  buffer_load_dwordx4 v[52:55], v190, s[8:11], s58 offen offset:1024 sc1
ms_130:
  s_mov_b64 exec, s[100:101]
  s_cbranch_execz ms_131
  buffer_load_dwordx4 v[56:59], v190, s[8:11], s58 offen offset:2048 sc1
ms_131:
  s_add_u32 s54, s54, 1
  s_cmp_gt_u32 s54, 131072
  s_cbranch_scc1 end0
  s_waitcnt vmcnt(0)
  s_mov_b64 exec, s[22:23]
  ds_write_b128 v190, v[48:51] offset:0
  v_cmp_eq_u32 s[22:23], -1, v48
  s_mov_b64 exec, s[98:99]
  ds_write_b128 v190, v[52:55] offset:1024
  v_cmp_eq_u32 s[98:99], -1, v52
  s_mov_b64 exec, s[100:101]
  ds_write_b128 v190, v[56:59] offset:2048
  v_cmp_eq_u32 s[100:101], -1, v56
  s_mov_b64 exec, -1
  s_or_b64 vcc, s[22:23], s[98:99]
  s_or_b64 vcc, vcc, s[100:101]
  s_cbranch_scc1 mr_115
  s_branch mo_119
mn_116:
  v_max3_u32 v27, v48, v49, v50
  v_max3_u32 v27, v27, v51, v52
  v_max3_u32 v27, v27, v53, v54
  v_max3_u32 v27, v27, v55, v56
  v_max3_u32 v27, v27, v57, v58
  v_max3_u32 v27, v27, v59, v60
  v_max3_u32 v27, v27, v61, v62
  v_max3_u32 v27, v27, v63, v64
  v_max3_u32 v27, v27, v65, v66
  v_max3_u32 v27, v27, v67, v68
  v_max3_u32 v27, v27, v69, v70
  v_max3_u32 v27, v27, v71, v72
  v_max3_u32 v27, v27, v73, v74
  v_max3_u32 v27, v27, v75, v76
  v_max3_u32 v27, v27, v77, v78
  v_max3_u32 v27, v27, v79, v80
  v_max3_u32 v27, v27, v81, v82
  v_max3_u32 v27, v27, v83, v84
  v_max3_u32 v27, v27, v85, v86
  v_max3_u32 v27, v27, v87, v87
  v_cmp_eq_u32 vcc, -1, v27
  s_cmp_eq_u32 s52, 0
  s_cbranch_scc1 mk_117
  s_cbranch_vccz mk_117
  s_waitcnt lgkmcnt(0)
  s_barrier
  s_nop 7
  v_mov_b32 v88, 0
  v_mov_b32 v89, 0
  v_mov_b32 v90, 0
  v_mov_b32 v91, 0
  v_mov_b32 v92, 0
  v_mov_b32 v93, 0
  v_mov_b32 v94, 0
  v_mov_b32 v95, 0
  v_mov_b32 v96, 0
  v_mov_b32 v97, 0
  v_mov_b32 v98, 0
  v_mov_b32 v99, 0
  v_mov_b32 v100, 0
  v_mov_b32 v101, 0
  v_mov_b32 v102, 0
  v_mov_b32 v103, 0
  s_mov_b64 s[22:23], -1
  s_mov_b64 s[98:99], -1
  s_mov_b64 s[100:101], -1
  s_branch mr_115
sr_120:
  s_mov_b32 s54, 0
sr_132:
  s_mov_b64 exec, vcc
  buffer_load_dwordx4 v[124:127], v9, s[8:11], s56 offen sc1
  buffer_load_dwordx4 v[128:131], v9, s[8:11], s56 offen offset:1024 sc1
  buffer_load_dwordx4 v[132:135], v10, s[8:11], s56 offen sc1
  s_mov_b64 exec, -1
  s_add_u32 s54, s54, 1
  s_cmp_gt_u32 s54, 131072
  s_cbranch_scc1 end0
  s_and_b32 s21, s54, 31
  s_cbranch_scc0 sr_133
  s_waitcnt vmcnt(0)
  v_pk_add_f16 v172, v124, v126
  v_pk_add_f16 v173, v125, v127
  v_pk_add_f16 v174, v128, v130
  v_pk_add_f16 v175, v129, v131
  v_fma_mix_f32 v166, v172, 1.0, v174 op_sel:[0,0,0] op_sel_hi:[1,0,1]
  v_fma_mix_f32 v168, v173, 1.0, v175 op_sel:[0,0,0] op_sel_hi:[1,0,1]
  v_pk_add_f16 v176, v132, v133
  v_pk_add_f16 v177, v134, v135
  v_add_f32 v27, v166, v168
  v_fma_mix_f32 v170, v176, 1.0, v177 op_sel:[0,0,0] op_sel_hi:[1,0,1]
  v_fma_mix_f32 v167, v172, 1.0, v174 op_sel:[1,0,1] op_sel_hi:[1,0,1]
  v_cmp_u_f32 vcc, v27, v170
  v_fma_mix_f32 v169, v173, 1.0, v175 op_sel:[1,0,1] op_sel_hi:[1,0,1]
  v_fma_mix_f32 v171, v176, 1.0, v177 op_sel:[1,0,1] op_sel_hi:[1,0,1]
  s_cbranch_vccnz sr_132
  s_branch sj_121
sr_133:
  s_waitcnt vmcnt(0)
  v_pk_add_f16 v172, v124, v126
  v_pk_add_f16 v173, v125, v127
  v_pk_add_f16 v174, v128, v130
  v_pk_add_f16 v175, v129, v131
  v_fma_mix_f32 v166, v172, 1.0, v174 op_sel:[0,0,0] op_sel_hi:[1,0,1]
  v_fma_mix_f32 v168, v173, 1.0, v175 op_sel:[0,0,0] op_sel_hi:[1,0,1]
  v_pk_add_f16 v176, v132, v133
  v_pk_add_f16 v177, v134, v135
  v_add_f32 v27, v166, v168
  v_fma_mix_f32 v170, v176, 1.0, v177 op_sel:[0,0,0] op_sel_hi:[1,0,1]
  v_fma_mix_f32 v167, v172, 1.0, v174 op_sel:[1,0,1] op_sel_hi:[1,0,1]
  v_cmp_u_f32 vcc, v27, v170
  v_fma_mix_f32 v169, v173, 1.0, v175 op_sel:[1,0,1] op_sel_hi:[1,0,1]
  v_fma_mix_f32 v171, v176, 1.0, v177 op_sel:[1,0,1] op_sel_hi:[1,0,1]
  v_max3_u32 v27, v124, v126, v128
  v_max3_u32 v27, v27, v130, v132
  v_max3_u32 v27, v27, v133, v134
  v_max3_u32 v27, v27, v135, v135
  v_cmp_eq_u32 vcc, -1, v27
  s_nop 1
  s_cbranch_vccnz sr_132
  s_branch sj_121
fx_123:
  s_cmp_eq_u32 s81, 1
  s_cbranch_scc1 fk_124
  s_mov_b32 s81, 1
  v_max3_f32 v164, v166, v167, v168
  v_max3_f32 v165, v169, v170, v171
  v_max_f32 v164, v164, v165
  s_nop 1
  v_max_f32_dpp v164, v164, v164 row_ror:8 row_mask:0xf bank_mask:0xf
  v_mov_b32 v165, v164
  s_nop 1
  v_permlane32_swap_b32 v164, v165
  v_max_f32 v164, v164, v165
  v_mov_b32 v165, v164
  s_nop 1
  v_permlane16_swap_b32 v164, v165
  v_max_f32 v164, v164, v165
  v_sub_f32 v166, v166, v164
  v_sub_f32 v167, v167, v164
  v_sub_f32 v168, v168, v164
  v_sub_f32 v169, v169, v164
  v_sub_f32 v170, v170, v164
  v_sub_f32 v171, v171, v164
  s_branch ex_122
p2_128:
  buffer_load_dwordx4 v[68:71], v16, s[4:7], s60 offen sc1
  s_waitcnt vmcnt(1)
  v_mfma_f32_16x16x32_f16 v[120:123], v[44:47], v[72:75], 0
  v_bitop3_b32 v27, v72, s61, 1 bitop3:0x28
  v_cmp_ne_u32 vcc, 0, v27
  s_nop 1
  s_cbranch_vccz pg_127
  buffer_load_dwordx4 v[72:75], v16, s[4:7], s60 offen sc1
  s_add_u32 s54, s54, 1
  s_cmp_gt_u32 s54, 131072
  s_cbranch_scc1 end0
  s_branch pp_126
last_118:
  v_smfmac_f32_16x16x64_bf16 v[96:99], v[48:51], a[0:7], v22
  v_smfmac_f32_16x16x64_bf16 v[100:103], v[48:51], a[80:87], v22
  v_smfmac_f32_16x16x64_bf16 v[96:99], v[52:55], a[8:15], v22
  v_smfmac_f32_16x16x64_bf16 v[100:103], v[52:55], a[88:95], v22
  v_smfmac_f32_16x16x64_bf16 v[96:99], v[56:59], a[16:23], v22
  v_smfmac_f32_16x16x64_bf16 v[100:103], v[56:59], a[96:103], v22
  v_smfmac_f32_16x16x64_bf16 v[96:99], v[60:63], a[24:31], v22
  v_smfmac_f32_16x16x64_bf16 v[96:99], v[64:67], a[32:39], v22
  v_smfmac_f32_16x16x64_bf16 v[96:99], v[68:71], a[40:47], v22
  v_smfmac_f32_16x16x64_bf16 v[96:99], v[72:75], a[48:55], v22
  v_smfmac_f32_16x16x64_bf16 v[96:99], v[76:79], a[56:63], v22
  v_smfmac_f32_16x16x64_bf16 v[96:99], v[80:83], a[64:71], v22
  v_smfmac_f32_16x16x64_bf16 v[96:99], v[84:87], a[72:79], v22
  v_smfmac_f32_16x16x64_bf16 v[100:103], v[60:63], a[104:111], v22
  v_smfmac_f32_16x16x64_bf16 v[100:103], v[64:67], a[112:119], v22
  v_smfmac_f32_16x16x64_bf16 v[100:103], v[68:71], a[120:127], v22
  v_smfmac_f32_16x16x64_bf16 v[100:103], v[72:75], a[128:135], v22
  v_smfmac_f32_16x16x64_bf16 v[100:103], v[76:79], a[136:143], v22
  v_smfmac_f32_16x16x64_bf16 v[100:103], v[80:83], a[144:151], v22
  v_smfmac_f32_16x16x64_bf16 v[100:103], v[84:87], a[152:159], v22
  s_nop 7
  v_permlane32_swap_b32 v96, v100
  v_permlane32_swap_b32 v97, v101
  v_permlane32_swap_b32 v98, v102
  v_permlane32_swap_b32 v99, v103
  v_pk_add_f32 v[96:97], v[96:97], v[100:101]
  v_pk_add_f32 v[98:99], v[98:99], v[102:103]
  v_cvt_pk_bf16_f32 v182, v96, v97
  v_cvt_pk_bf16_f32 v183, v98, v99
  v_min_u32 v182, -2, v182
  ds_write_b64 v26, v[182:183]
  s_waitcnt lgkmcnt(0)
  s_barrier
  v_mov_b32 v246, 80
  v_mov_b32 v247, 1
  s_mov_b64 exec, 1
  buffer_atomic_add v247, v246, s[32:35], 0 offen sc0 sc1
  s_mov_b64 exec, -1
  s_branch chain_done
E_29:
  v_add_u32 v190, 3072, v4
  ds_read_b128 v[60:63], v4 offset:3072
  ds_read_b128 v[64:67], v4 offset:4096
  ds_read_b128 v[68:71], v4 offset:5120
  s_waitcnt lgkmcnt(0)
  s_branch mo_139
  .p2align 3
top_134:
  s_waitcnt vmcnt(2)
  ds_write_b128 v190, v[60:63] offset:0
  v_cmp_eq_u32 s[22:23], -1, v60
  s_waitcnt vmcnt(1)
  ds_write_b128 v190, v[64:67] offset:1024
  v_cmp_eq_u32 s[98:99], -1, v64
  s_waitcnt vmcnt(0)
  ds_write_b128 v190, v[68:71] offset:2048
  v_cmp_eq_u32 s[100:101], -1, v68
  s_or_b64 vcc, s[22:23], s[98:99]
  s_or_b64 vcc, vcc, s[100:101]
  s_cbranch_scc1 mr_135
mo_139:
  s_waitcnt lgkmcnt(0)
  s_barrier
  ds_read_b128 v[48:51], v4 offset:0
  ds_read_b128 v[52:55], v4 offset:1024
  v_smfmac_f32_16x16x64_bf16 v[92:95], v[60:63], v[200:207], v22
  ds_read_b128 v[56:59], v4 offset:2048
  v_smfmac_f32_16x16x64_bf16 v[88:91], v[60:63], a[184:191], v22
  ds_read_b128 v[72:75], v4 offset:6144
  v_smfmac_f32_16x16x64_bf16 v[92:95], v[64:67], v[208:215], v22
  ds_read_b128 v[76:79], v4 offset:7168
  v_smfmac_f32_16x16x64_bf16 v[88:91], v[64:67], a[192:199], v22
  ds_read_b128 v[80:83], v4 offset:8192
  v_smfmac_f32_16x16x64_bf16 v[92:95], v[68:71], v[216:223], v22
  ds_read_b128 v[84:87], v4 offset:9216
  v_smfmac_f32_16x16x64_bf16 v[88:91], v[68:71], a[200:207], v22
  s_waitcnt lgkmcnt(6)
  v_smfmac_f32_16x16x64_bf16 v[92:95], v[48:51], a[240:247], v22
  v_smfmac_f32_16x16x64_bf16 v[88:91], v[48:51], a[160:167], v22
  s_waitcnt lgkmcnt(5)
  v_smfmac_f32_16x16x64_bf16 v[92:95], v[52:55], a[248:255], v22
  s_waitcnt lgkmcnt(4)
  v_smfmac_f32_16x16x64_bf16 v[92:95], v[56:59], v[192:199], v22
  s_waitcnt lgkmcnt(3)
  v_smfmac_f32_16x16x64_bf16 v[92:95], v[72:75], v[224:231], v22
  s_waitcnt lgkmcnt(2)
  v_smfmac_f32_16x16x64_bf16 v[92:95], v[76:79], v[232:239], v22
  s_waitcnt lgkmcnt(1)
  v_smfmac_f32_16x16x64_bf16 v[92:95], v[80:83], v[240:247], v22
  s_waitcnt lgkmcnt(0)
  v_smfmac_f32_16x16x64_bf16 v[92:95], v[84:87], v[248:255], v22
  v_smfmac_f32_16x16x64_bf16 v[88:91], v[52:55], a[168:175], v22
  v_smfmac_f32_16x16x64_bf16 v[88:91], v[56:59], a[176:183], v22
  v_smfmac_f32_16x16x64_bf16 v[88:91], v[72:75], a[208:215], v22
  v_permlane32_swap_b32 v92, v93
  v_smfmac_f32_16x16x64_bf16 v[88:91], v[76:79], a[216:223], v22
  v_permlane32_swap_b32 v94, v95
  v_smfmac_f32_16x16x64_bf16 v[88:91], v[80:83], a[224:231], v22
  v_permlane32_swap_b32 v93, v92
  v_smfmac_f32_16x16x64_bf16 v[88:91], v[84:87], a[232:239], v22
  v_permlane32_swap_b32 v95, v94
  v_pk_mul_f32 v[120:121], v[92:93], v[24:25] op_sel:[1,0] op_sel_hi:[0,1]
  v_pk_mul_f32 v[122:123], v[94:95], v[24:25] op_sel:[1,0] op_sel_hi:[0,1]
  s_nop 4
  v_pk_fma_f32 v[88:89], v[88:89], v[24:25], v[120:121]
  v_pk_fma_f32 v[90:91], v[90:91], v[24:25], v[122:123]
  v_cvt_pk_bf16_f32 v120, v88, v89
  v_cvt_pk_bf16_f32 v121, v90, v91
  ds_write_b64 v6, v[120:121]
  v_cmp_u_f32 vcc, v88, v89
  v_cmp_u_f32 s[22:23], v90, v91
  s_nop 1
  s_or_b64 vcc, vcc, s[22:23]
  s_cbranch_vccnz mn_136
mk_137:
  s_waitcnt lgkmcnt(0)
  s_barrier
  ds_read_b64_tr_b16 v[104:105], v7 offset:0
  ds_read_b64_tr_b16 v[106:107], v7 offset:768
  ds_read_b64_tr_b16 v[108:109], v7 offset:1536
  ds_read_b64 v[140:141], v11
  s_cmp_eq_u32 s52, 63
  s_cbranch_scc1 last_138
  s_waitcnt lgkmcnt(2)
  v_mfma_f32_16x16x32_bf16 v[120:123], v[112:115], v[104:107], 0
  s_waitcnt lgkmcnt(1)
  v_mfma_f32_16x16x32_bf16 v[120:123], v[116:119], v[108:111], v[120:123]
  s_mov_b64 exec, s[64:65]
  s_nop 6
  v_cvt_pk_f16_f32 v120, v120, v121
  v_cvt_pk_f16_f32 v121, v122, v123
  buffer_store_dwordx2 v[120:121], v8, s[8:11], s56 offen sc1
  s_mov_b64 exec, -1
  s_sleep 3
  s_nop 1
  v_smfmac_f32_16x16x64_bf16 v[96:99], v[48:51], a[0:7], v22
  v_smfmac_f32_16x16x64_bf16 v[100:103], v[48:51], a[80:87], v22
  v_smfmac_f32_16x16x64_bf16 v[96:99], v[52:55], a[8:15], v22
  v_smfmac_f32_16x16x64_bf16 v[100:103], v[52:55], a[88:95], v22
  v_smfmac_f32_16x16x64_bf16 v[96:99], v[56:59], a[16:23], v22
  v_smfmac_f32_16x16x64_bf16 v[100:103], v[56:59], a[96:103], v22
  v_smfmac_f32_16x16x64_bf16 v[96:99], v[60:63], a[24:31], v22
  v_smfmac_f32_16x16x64_bf16 v[96:99], v[64:67], a[32:39], v22
  v_smfmac_f32_16x16x64_bf16 v[96:99], v[68:71], a[40:47], v22
  v_smfmac_f32_16x16x64_bf16 v[96:99], v[72:75], a[48:55], v22
  v_smfmac_f32_16x16x64_bf16 v[96:99], v[76:79], a[56:63], v22
  buffer_load_dwordx4 v[124:127], v9, s[8:11], s56 offen sc1
  v_smfmac_f32_16x16x64_bf16 v[96:99], v[80:83], a[64:71], v22
  buffer_load_dwordx4 v[128:131], v9, s[8:11], s56 offen offset:1024 sc1
  v_smfmac_f32_16x16x64_bf16 v[96:99], v[84:87], a[72:79], v22
  buffer_load_dwordx4 v[132:135], v10, s[8:11], s56 offen sc1
  v_smfmac_f32_16x16x64_bf16 v[100:103], v[60:63], a[104:111], v22
  v_smfmac_f32_16x16x64_bf16 v[100:103], v[64:67], a[112:119], v22
  v_smfmac_f32_16x16x64_bf16 v[100:103], v[68:71], a[120:127], v22
  v_smfmac_f32_16x16x64_bf16 v[100:103], v[72:75], a[128:135], v22
  v_cvt_pk_bf16_f32 v136, v96, v97
  v_smfmac_f32_16x16x64_bf16 v[100:103], v[76:79], a[136:143], v22
  v_cvt_pk_bf16_f32 v137, v98, v99
  v_smfmac_f32_16x16x64_bf16 v[100:103], v[80:83], a[144:151], v22
  v_smfmac_f32_16x16x64_bf16 v[100:103], v[84:87], a[152:159], v22
  s_waitcnt vmcnt(2)
  v_pk_add_f16 v172, v124, v126
  v_pk_add_f16 v173, v125, v127
  s_waitcnt vmcnt(1)
  v_pk_add_f16 v174, v128, v130
  v_pk_add_f16 v175, v129, v131
  v_fma_mix_f32 v166, v172, 1.0, v174 op_sel:[0,0,0] op_sel_hi:[1,0,1]
  v_fma_mix_f32 v168, v173, 1.0, v175 op_sel:[0,0,0] op_sel_hi:[1,0,1]
  s_waitcnt vmcnt(0)
  v_pk_add_f16 v176, v132, v133
  v_pk_add_f16 v177, v134, v135
  v_fma_mix_f32 v170, v176, 1.0, v177 op_sel:[0,0,0] op_sel_hi:[1,0,1]
  v_fma_mix_f32 v167, v172, 1.0, v174 op_sel:[1,0,1] op_sel_hi:[1,0,1]
  v_cmp_u_f32 vcc, v166, v170
  v_fma_mix_f32 v169, v173, 1.0, v175 op_sel:[1,0,1] op_sel_hi:[1,0,1]
  v_fma_mix_f32 v171, v176, 1.0, v177 op_sel:[1,0,1] op_sel_hi:[1,0,1]
  v_cvt_pk_bf16_f32 v138, v100, v101
  s_cbranch_vccnz sr_140
sj_141:
ex_142:
  v_exp_f32 v172, v166
  v_exp_f32 v173, v167
  v_exp_f32 v174, v168
  v_cvt_pk_bf16_f32 v156, v172, v173
  v_exp_f32 v175, v169
  v_exp_f32 v176, v170
  v_cvt_pk_bf16_f32 v157, v174, v175
  v_mov_b32_dpp v158, v156 row_ror:8 row_mask:0xf bank_mask:0xf
  v_exp_f32 v177, v171
  v_mov_b32_dpp v159, v157 row_ror:8 row_mask:0xf bank_mask:0xf
  v_cvt_pk_bf16_f32 v160, v176, v177
  v_cvt_pk_bf16_f32 v139, v102, v103
  v_mfma_f32_16x16x32_bf16 v[178:181], v[152:155], v[156:159], 0
  s_waitcnt lgkmcnt(0)
  v_mov_b32_dpp v161, v160 row_ror:8 row_mask:0xf bank_mask:0xf
  v_mfma_f32_16x16x32_bf16 v[182:185], v[144:147], v[156:159], 0
  s_nop 0
  v_mfma_f32_16x16x32_bf16 v[178:181], v[140:143], v[160:163], v[178:181]
  v_mfma_f32_16x16x32_bf16 v[182:185], v[136:139], v[160:163], v[182:185]
  v_mfma_f32_16x16x32_bf16 v[186:189], v[148:151], v[156:159], 0
  v_mfma_f32_16x16x32_bf16 v[186:189], v[138:141], v[160:163], v[186:189]
  s_mov_b64 exec, s[62:63]
  v_rcp_f32 v164, v180
  s_nop 0
  v_pk_mul_f32 v[178:179], v[178:179], v[164:165] op_sel_hi:[1,0]
  v_pk_mul_f32 v[182:183], v[182:183], v[164:165] op_sel_hi:[1,0]
  v_pk_mul_f32 v[184:185], v[184:185], v[164:165] op_sel_hi:[1,0]
  v_cvt_pk_f16_f32 v64, v178, v179
  v_cvt_pk_f16_f32 v60, v182, v183
  v_pk_mul_f32 v[186:187], v[186:187], v[164:165] op_sel_hi:[1,0]
  v_pk_mul_f32 v[188:189], v[188:189], v[164:165] op_sel_hi:[1,0]
  v_cvt_pk_f16_f32 v61, v184, v185
  v_cvt_pk_f16_f32 v62, v186, v187
  v_cvt_pk_f16_f32 v63, v188, v189
  ds_write_b128 v13, v[60:63]
  ds_write_b32 v14, v64
  v_add_f32 v165, v164, v180
  v_cmp_ngt_f32 vcc, s80, v165
  s_mov_b64 exec, -1
  s_nop 0
  s_cbranch_vccnz fx_143
fk_144:
  s_waitcnt lgkmcnt(0)
  s_barrier
  s_add_u32 m0, s74, 9216
  s_add_u32 s21, s72, 83968
  buffer_load_dwordx4 v32, s[28:31], s21 offen sc1 lds
  s_add_u32 m0, s74, 2048
  s_add_u32 s21, s79, 40960
  buffer_load_dwordx4 v4, s[28:31], s21 offen sc1 lds
  s_add_u32 m0, s74, 5120
  s_add_u32 s21, s79, 82944
  buffer_load_dwordx4 v4, s[28:31], s21 offen sc1 lds
  s_add_u32 s72, s72, 1310720
  s_add_u32 s79, s79, 1310720
  s_add_u32 s73, s73, 393216
  s_xor_b32 s74, s74, 16384
  s_nop 15
  s_nop 3
  v_permlane32_swap_b32 v96, v100
  v_permlane32_swap_b32 v97, v101
  v_permlane32_swap_b32 v98, v102
  v_permlane32_swap_b32 v99, v103
  v_pk_add_f32 v[96:97], v[96:97], v[100:101]
  v_pk_add_f32 v[98:99], v[98:99], v[102:103]
  v_cvt_pk_bf16_f32 v182, v96, v97
  v_cvt_pk_bf16_f32 v183, v98, v99
  v_min_u32 v182, -2, v182
  ds_write_b64 v26, v[182:183]
  ds_read_b128 v[144:147], v18
  ds_read_b128 v[148:151], v18 offset:1024
  ds_read_b128 v[152:155], v19
  ds_read_b128 v[112:115], v20
  ds_read_b64 v[116:117], v21
  v_xor_b32 v18, 16384, v18
  v_xor_b32 v19, 16384, v19
  v_xor_b32 v20, 16384, v20
  v_xor_b32 v21, 16384, v21
  v_mov_b32 v88, 0
  v_mov_b32 v89, 0
  v_mov_b32 v90, 0
  v_mov_b32 v91, 0
  v_mov_b32 v92, 0
  v_mov_b32 v93, 0
  v_mov_b32 v94, 0
  v_mov_b32 v95, 0
  v_mov_b32 v96, 0
  v_mov_b32 v97, 0
  v_mov_b32 v98, 0
  v_mov_b32 v99, 0
  v_mov_b32 v100, 0
  v_mov_b32 v101, 0
  v_mov_b32 v102, 0
  v_mov_b32 v103, 0
  s_mov_b32 s81, 0
  s_waitcnt lgkmcnt(0)
  s_barrier
  s_mov_b64 exec, s[64:65]
  buffer_store_dwordx2 v[28:29], v8, s[8:11], s57 offen sc1
  s_mov_b64 exec, s[62:63]
  buffer_store_dword v28, v17, s[8:11], s59 offen sc1
  s_mov_b64 exec, -1
  s_sleep 6
  s_nop 3
  buffer_load_dwordx4 v[68:71], v16, s[4:7], s60 offen sc1
  s_sleep 3
  s_nop 1
  buffer_load_dwordx4 v[72:75], v16, s[4:7], s60 offen sc1
  s_mov_b32 s54, 0
pp_146:
  s_waitcnt vmcnt(1)
  v_mfma_f32_16x16x32_f16 v[120:123], v[44:47], v[68:71], 0
  v_bitop3_b32 v27, v68, s61, 1 bitop3:0x28
  v_cmp_ne_u32 vcc, 0, v27
  s_nop 1
  s_cbranch_vccnz p2_148
  s_nop 2
pg_147:
  v_add_f32_dpp v120, v120, v120 row_ror:8 row_mask:0xf bank_mask:0xf
  v_add_f32_dpp v121, v121, v121 row_ror:8 row_mask:0xf bank_mask:0xf
  s_mov_b64 exec, s[62:63]
  v_cvt_pk_bf16_f32 v120, v120, v121
  v_min_u32 v120, -2, v120
  buffer_store_dword v120, v17, s[8:11], s55 offen sc1
  s_mov_b64 exec, -1
nt_145:
  s_barrier
  s_mov_b32 s58, s55
  s_add_u32 s52, s52, 1
  s_and_b32 s21, s52, 3
  s_mul_i32 s56, s21, 122880
  s_add_u32 s21, s52, 1
  s_and_b32 s21, s21, 3
  s_mul_i32 s55, s21, 122880
  s_add_u32 s55, s55, s75
  s_add_u32 s21, s52, 2
  s_and_b32 s21, s21, 3
  s_mul_i32 s57, s21, 122880
  s_add_u32 s21, s52, 3
  s_and_b32 s21, s21, 3
  s_mul_i32 s59, s21, 122880
  s_add_u32 s59, s59, s75
  s_bfe_u32 s61, s52, 0x10001
  s_and_b32 s21, s52, 1
  s_lshl_b32 s60, s21, 19
  s_mov_b32 s54, 0
  s_sleep 3
  s_nop 2
  buffer_load_dwordx4 v[60:63], v190, s[8:11], s58 offen offset:0 sc1
  buffer_load_dwordx4 v[64:67], v190, s[8:11], s58 offen offset:1024 sc1
  buffer_load_dwordx4 v[68:71], v190, s[8:11], s58 offen offset:2048 sc1
  s_branch top_134
mr_135:
  s_mov_b64 exec, s[22:23]
  s_cbranch_execz ms_149
  buffer_load_dwordx4 v[60:63], v190, s[8:11], s58 offen offset:0 sc1
ms_149:
  s_mov_b64 exec, s[98:99]
  s_cbranch_execz ms_150
  buffer_load_dwordx4 v[64:67], v190, s[8:11], s58 offen offset:1024 sc1
ms_150:
  s_mov_b64 exec, s[100:101]
  s_cbranch_execz ms_151
  buffer_load_dwordx4 v[68:71], v190, s[8:11], s58 offen offset:2048 sc1
ms_151:
  s_add_u32 s54, s54, 1
  s_cmp_gt_u32 s54, 131072
  s_cbranch_scc1 end0
  s_waitcnt vmcnt(0)
  s_mov_b64 exec, s[22:23]
  ds_write_b128 v190, v[60:63] offset:0
  v_cmp_eq_u32 s[22:23], -1, v60
  s_mov_b64 exec, s[98:99]
  ds_write_b128 v190, v[64:67] offset:1024
  v_cmp_eq_u32 s[98:99], -1, v64
  s_mov_b64 exec, s[100:101]
  ds_write_b128 v190, v[68:71] offset:2048
  v_cmp_eq_u32 s[100:101], -1, v68
  s_mov_b64 exec, -1
  s_or_b64 vcc, s[22:23], s[98:99]
  s_or_b64 vcc, vcc, s[100:101]
  s_cbranch_scc1 mr_135
  s_branch mo_139
mn_136:
  v_max3_u32 v27, v48, v49, v50
  v_max3_u32 v27, v27, v51, v52
  v_max3_u32 v27, v27, v53, v54
  v_max3_u32 v27, v27, v55, v56
  v_max3_u32 v27, v27, v57, v58
  v_max3_u32 v27, v27, v59, v60
  v_max3_u32 v27, v27, v61, v62
  v_max3_u32 v27, v27, v63, v64
  v_max3_u32 v27, v27, v65, v66
  v_max3_u32 v27, v27, v67, v68
  v_max3_u32 v27, v27, v69, v70
  v_max3_u32 v27, v27, v71, v72
  v_max3_u32 v27, v27, v73, v74
  v_max3_u32 v27, v27, v75, v76
  v_max3_u32 v27, v27, v77, v78
  v_max3_u32 v27, v27, v79, v80
  v_max3_u32 v27, v27, v81, v82
  v_max3_u32 v27, v27, v83, v84
  v_max3_u32 v27, v27, v85, v86
  v_max3_u32 v27, v27, v87, v87
  v_cmp_eq_u32 vcc, -1, v27
  s_cmp_eq_u32 s52, 0
  s_cbranch_scc1 mk_137
  s_cbranch_vccz mk_137
  s_waitcnt lgkmcnt(0)
  s_barrier
  s_nop 7
  v_mov_b32 v88, 0
  v_mov_b32 v89, 0
  v_mov_b32 v90, 0
  v_mov_b32 v91, 0
  v_mov_b32 v92, 0
  v_mov_b32 v93, 0
  v_mov_b32 v94, 0
  v_mov_b32 v95, 0
  v_mov_b32 v96, 0
  v_mov_b32 v97, 0
  v_mov_b32 v98, 0
  v_mov_b32 v99, 0
  v_mov_b32 v100, 0
  v_mov_b32 v101, 0
  v_mov_b32 v102, 0
  v_mov_b32 v103, 0
  s_mov_b64 s[22:23], -1
  s_mov_b64 s[98:99], -1
  s_mov_b64 s[100:101], -1
  s_branch mr_135
sr_140:
  s_mov_b32 s54, 0
sr_152:
  s_mov_b64 exec, vcc
  buffer_load_dwordx4 v[124:127], v9, s[8:11], s56 offen sc1
  buffer_load_dwordx4 v[128:131], v9, s[8:11], s56 offen offset:1024 sc1
  buffer_load_dwordx4 v[132:135], v10, s[8:11], s56 offen sc1
  s_mov_b64 exec, -1
  s_add_u32 s54, s54, 1
  s_cmp_gt_u32 s54, 131072
  s_cbranch_scc1 end0
  s_and_b32 s21, s54, 31
  s_cbranch_scc0 sr_153
  s_waitcnt vmcnt(0)
  v_pk_add_f16 v172, v124, v126
  v_pk_add_f16 v173, v125, v127
  v_pk_add_f16 v174, v128, v130
  v_pk_add_f16 v175, v129, v131
  v_fma_mix_f32 v166, v172, 1.0, v174 op_sel:[0,0,0] op_sel_hi:[1,0,1]
  v_fma_mix_f32 v168, v173, 1.0, v175 op_sel:[0,0,0] op_sel_hi:[1,0,1]
  v_pk_add_f16 v176, v132, v133
  v_pk_add_f16 v177, v134, v135
  v_add_f32 v27, v166, v168
  v_fma_mix_f32 v170, v176, 1.0, v177 op_sel:[0,0,0] op_sel_hi:[1,0,1]
  v_fma_mix_f32 v167, v172, 1.0, v174 op_sel:[1,0,1] op_sel_hi:[1,0,1]
  v_cmp_u_f32 vcc, v27, v170
  v_fma_mix_f32 v169, v173, 1.0, v175 op_sel:[1,0,1] op_sel_hi:[1,0,1]
  v_fma_mix_f32 v171, v176, 1.0, v177 op_sel:[1,0,1] op_sel_hi:[1,0,1]
  s_cbranch_vccnz sr_152
  s_branch sj_141
sr_153:
  s_waitcnt vmcnt(0)
  v_pk_add_f16 v172, v124, v126
  v_pk_add_f16 v173, v125, v127
  v_pk_add_f16 v174, v128, v130
  v_pk_add_f16 v175, v129, v131
  v_fma_mix_f32 v166, v172, 1.0, v174 op_sel:[0,0,0] op_sel_hi:[1,0,1]
  v_fma_mix_f32 v168, v173, 1.0, v175 op_sel:[0,0,0] op_sel_hi:[1,0,1]
  v_pk_add_f16 v176, v132, v133
  v_pk_add_f16 v177, v134, v135
  v_add_f32 v27, v166, v168
  v_fma_mix_f32 v170, v176, 1.0, v177 op_sel:[0,0,0] op_sel_hi:[1,0,1]
  v_fma_mix_f32 v167, v172, 1.0, v174 op_sel:[1,0,1] op_sel_hi:[1,0,1]
  v_cmp_u_f32 vcc, v27, v170
  v_fma_mix_f32 v169, v173, 1.0, v175 op_sel:[1,0,1] op_sel_hi:[1,0,1]
  v_fma_mix_f32 v171, v176, 1.0, v177 op_sel:[1,0,1] op_sel_hi:[1,0,1]
  v_max3_u32 v27, v124, v126, v128
  v_max3_u32 v27, v27, v130, v132
  v_max3_u32 v27, v27, v133, v134
  v_max3_u32 v27, v27, v135, v135
  v_cmp_eq_u32 vcc, -1, v27
  s_nop 1
  s_cbranch_vccnz sr_152
  s_branch sj_141
fx_143:
  s_cmp_eq_u32 s81, 1
  s_cbranch_scc1 fk_144
  s_mov_b32 s81, 1
  v_max3_f32 v164, v166, v167, v168
  v_max3_f32 v165, v169, v170, v171
  v_max_f32 v164, v164, v165
  s_nop 1
  v_max_f32_dpp v164, v164, v164 row_ror:8 row_mask:0xf bank_mask:0xf
  v_mov_b32 v165, v164
  s_nop 1
  v_permlane32_swap_b32 v164, v165
  v_max_f32 v164, v164, v165
  v_mov_b32 v165, v164
  s_nop 1
  v_permlane16_swap_b32 v164, v165
  v_max_f32 v164, v164, v165
  v_sub_f32 v166, v166, v164
  v_sub_f32 v167, v167, v164
  v_sub_f32 v168, v168, v164
  v_sub_f32 v169, v169, v164
  v_sub_f32 v170, v170, v164
  v_sub_f32 v171, v171, v164
  s_branch ex_142
p2_148:
  buffer_load_dwordx4 v[68:71], v16, s[4:7], s60 offen sc1
  s_waitcnt vmcnt(1)
  v_mfma_f32_16x16x32_f16 v[120:123], v[44:47], v[72:75], 0
  v_bitop3_b32 v27, v72, s61, 1 bitop3:0x28
  v_cmp_ne_u32 vcc, 0, v27
  s_nop 1
  s_cbranch_vccz pg_147
  buffer_load_dwordx4 v[72:75], v16, s[4:7], s60 offen sc1
  s_add_u32 s54, s54, 1
  s_cmp_gt_u32 s54, 131072
  s_cbranch_scc1 end0
  s_branch pp_146
last_138:
  v_smfmac_f32_16x16x64_bf16 v[96:99], v[48:51], a[0:7], v22
  v_smfmac_f32_16x16x64_bf16 v[100:103], v[48:51], a[80:87], v22
  v_smfmac_f32_16x16x64_bf16 v[96:99], v[52:55], a[8:15], v22
  v_smfmac_f32_16x16x64_bf16 v[100:103], v[52:55], a[88:95], v22
  v_smfmac_f32_16x16x64_bf16 v[96:99], v[56:59], a[16:23], v22
  v_smfmac_f32_16x16x64_bf16 v[100:103], v[56:59], a[96:103], v22
  v_smfmac_f32_16x16x64_bf16 v[96:99], v[60:63], a[24:31], v22
  v_smfmac_f32_16x16x64_bf16 v[96:99], v[64:67], a[32:39], v22
  v_smfmac_f32_16x16x64_bf16 v[96:99], v[68:71], a[40:47], v22
  v_smfmac_f32_16x16x64_bf16 v[96:99], v[72:75], a[48:55], v22
  v_smfmac_f32_16x16x64_bf16 v[96:99], v[76:79], a[56:63], v22
  v_smfmac_f32_16x16x64_bf16 v[96:99], v[80:83], a[64:71], v22
  v_smfmac_f32_16x16x64_bf16 v[96:99], v[84:87], a[72:79], v22
  v_smfmac_f32_16x16x64_bf16 v[100:103], v[60:63], a[104:111], v22
  v_smfmac_f32_16x16x64_bf16 v[100:103], v[64:67], a[112:119], v22
  v_smfmac_f32_16x16x64_bf16 v[100:103], v[68:71], a[120:127], v22
  v_smfmac_f32_16x16x64_bf16 v[100:103], v[72:75], a[128:135], v22
  v_smfmac_f32_16x16x64_bf16 v[100:103], v[76:79], a[136:143], v22
  v_smfmac_f32_16x16x64_bf16 v[100:103], v[80:83], a[144:151], v22
  v_smfmac_f32_16x16x64_bf16 v[100:103], v[84:87], a[152:159], v22
  s_nop 7
  v_permlane32_swap_b32 v96, v100
  v_permlane32_swap_b32 v97, v101
  v_permlane32_swap_b32 v98, v102
  v_permlane32_swap_b32 v99, v103
  v_pk_add_f32 v[96:97], v[96:97], v[100:101]
  v_pk_add_f32 v[98:99], v[98:99], v[102:103]
  v_cvt_pk_bf16_f32 v182, v96, v97
  v_cvt_pk_bf16_f32 v183, v98, v99
  v_min_u32 v182, -2, v182
  ds_write_b64 v26, v[182:183]
  s_waitcnt lgkmcnt(0)
  s_barrier
  s_branch chain_done
E_31:
  v_add_u32 v190, 6144, v4
  ds_read_b128 v[72:75], v4 offset:6144
  ds_read_b128 v[76:79], v4 offset:7168
  ds_read_b128 v[80:83], v4 offset:8192
  s_waitcnt lgkmcnt(0)
  s_branch mo_159
  .p2align 3
top_154:
  s_waitcnt vmcnt(2)
  ds_write_b128 v190, v[72:75] offset:0
  v_cmp_eq_u32 s[22:23], -1, v72
  s_waitcnt vmcnt(1)
  ds_write_b128 v190, v[76:79] offset:1024
  v_cmp_eq_u32 s[98:99], -1, v76
  s_waitcnt vmcnt(0)
  ds_write_b128 v190, v[80:83] offset:2048
  v_cmp_eq_u32 s[100:101], -1, v80
  s_or_b64 vcc, s[22:23], s[98:99]
  s_or_b64 vcc, vcc, s[100:101]
  s_cbranch_scc1 mr_155
mo_159:
  s_waitcnt lgkmcnt(0)
  s_barrier
  ds_read_b128 v[48:51], v4 offset:0
  ds_read_b128 v[52:55], v4 offset:1024
  v_smfmac_f32_16x16x64_bf16 v[92:95], v[72:75], v[224:231], v22
  ds_read_b128 v[56:59], v4 offset:2048
  v_smfmac_f32_16x16x64_bf16 v[88:91], v[72:75], a[208:215], v22
  ds_read_b128 v[60:63], v4 offset:3072
  v_smfmac_f32_16x16x64_bf16 v[92:95], v[76:79], v[232:239], v22
  ds_read_b128 v[64:67], v4 offset:4096
  v_smfmac_f32_16x16x64_bf16 v[88:91], v[76:79], a[216:223], v22
  ds_read_b128 v[68:71], v4 offset:5120
  v_smfmac_f32_16x16x64_bf16 v[92:95], v[80:83], v[240:247], v22
  ds_read_b128 v[84:87], v4 offset:9216
  v_smfmac_f32_16x16x64_bf16 v[88:91], v[80:83], a[224:231], v22
  s_waitcnt lgkmcnt(6)
  v_smfmac_f32_16x16x64_bf16 v[92:95], v[48:51], a[240:247], v22
  v_smfmac_f32_16x16x64_bf16 v[88:91], v[48:51], a[160:167], v22
  s_waitcnt lgkmcnt(5)
  v_smfmac_f32_16x16x64_bf16 v[92:95], v[52:55], a[248:255], v22
  s_waitcnt lgkmcnt(4)
  v_smfmac_f32_16x16x64_bf16 v[92:95], v[56:59], v[192:199], v22
  s_waitcnt lgkmcnt(3)
  v_smfmac_f32_16x16x64_bf16 v[92:95], v[60:63], v[200:207], v22
  s_waitcnt lgkmcnt(2)
  v_smfmac_f32_16x16x64_bf16 v[92:95], v[64:67], v[208:215], v22
  s_waitcnt lgkmcnt(1)
  v_smfmac_f32_16x16x64_bf16 v[92:95], v[68:71], v[216:223], v22
  s_waitcnt lgkmcnt(0)
  v_smfmac_f32_16x16x64_bf16 v[92:95], v[84:87], v[248:255], v22
  v_smfmac_f32_16x16x64_bf16 v[88:91], v[52:55], a[168:175], v22
  v_smfmac_f32_16x16x64_bf16 v[88:91], v[56:59], a[176:183], v22
  v_smfmac_f32_16x16x64_bf16 v[88:91], v[60:63], a[184:191], v22
  v_permlane32_swap_b32 v92, v93
  v_smfmac_f32_16x16x64_bf16 v[88:91], v[64:67], a[192:199], v22
  v_permlane32_swap_b32 v94, v95
  v_smfmac_f32_16x16x64_bf16 v[88:91], v[68:71], a[200:207], v22
  v_permlane32_swap_b32 v93, v92
  v_smfmac_f32_16x16x64_bf16 v[88:91], v[84:87], a[232:239], v22
  v_permlane32_swap_b32 v95, v94
  v_pk_mul_f32 v[120:121], v[92:93], v[24:25] op_sel:[1,0] op_sel_hi:[0,1]
  v_pk_mul_f32 v[122:123], v[94:95], v[24:25] op_sel:[1,0] op_sel_hi:[0,1]
  s_nop 4
  v_pk_fma_f32 v[88:89], v[88:89], v[24:25], v[120:121]
  v_pk_fma_f32 v[90:91], v[90:91], v[24:25], v[122:123]
  v_cvt_pk_bf16_f32 v120, v88, v89
  v_cvt_pk_bf16_f32 v121, v90, v91
  ds_write_b64 v6, v[120:121]
  v_cmp_u_f32 vcc, v88, v89
  v_cmp_u_f32 s[22:23], v90, v91
  s_nop 1
  s_or_b64 vcc, vcc, s[22:23]
  s_cbranch_vccnz mn_156
mk_157:
  s_waitcnt lgkmcnt(0)
  s_barrier
  ds_read_b64_tr_b16 v[104:105], v7 offset:0
  ds_read_b64_tr_b16 v[106:107], v7 offset:768
  ds_read_b64_tr_b16 v[108:109], v7 offset:1536
  ds_read_b64 v[140:141], v11
  s_cmp_eq_u32 s52, 63
  s_cbranch_scc1 last_158
  s_waitcnt lgkmcnt(2)
  v_mfma_f32_16x16x32_bf16 v[120:123], v[104:107], v[104:107], 0
  s_waitcnt lgkmcnt(1)
  v_mfma_f32_16x16x32_bf16 v[120:123], v[108:111], v[108:111], v[120:123]
  s_mov_b64 exec, s[64:65]
  s_nop 6
  v_cvt_pk_f16_f32 v120, v120, v121
  buffer_store_dword v120, v8, s[8:11], s56 offen sc1
  v_cvt_pk_f16_f32 v121, v122, v123
  buffer_store_dword v121, v8, s[8:11], s56 offen offset:128 sc1
  s_mov_b64 exec, -1
  s_sleep 3
  s_nop 1
  v_smfmac_f32_16x16x64_bf16 v[96:99], v[48:51], a[0:7], v22
  v_smfmac_f32_16x16x64_bf16 v[100:103], v[48:51], a[80:87], v22
  v_smfmac_f32_16x16x64_bf16 v[96:99], v[52:55], a[8:15], v22
  v_smfmac_f32_16x16x64_bf16 v[100:103], v[52:55], a[88:95], v22
  v_smfmac_f32_16x16x64_bf16 v[96:99], v[56:59], a[16:23], v22
  v_smfmac_f32_16x16x64_bf16 v[100:103], v[56:59], a[96:103], v22
  v_smfmac_f32_16x16x64_bf16 v[96:99], v[60:63], a[24:31], v22
  v_smfmac_f32_16x16x64_bf16 v[96:99], v[64:67], a[32:39], v22
  v_smfmac_f32_16x16x64_bf16 v[96:99], v[68:71], a[40:47], v22
  v_smfmac_f32_16x16x64_bf16 v[96:99], v[72:75], a[48:55], v22
  v_smfmac_f32_16x16x64_bf16 v[96:99], v[76:79], a[56:63], v22
  buffer_load_dwordx4 v[124:127], v9, s[8:11], s56 offen sc1
  v_smfmac_f32_16x16x64_bf16 v[96:99], v[80:83], a[64:71], v22
  buffer_load_dwordx4 v[128:131], v9, s[8:11], s56 offen offset:1024 sc1
  v_smfmac_f32_16x16x64_bf16 v[96:99], v[84:87], a[72:79], v22
  buffer_load_dwordx4 v[132:135], v10, s[8:11], s56 offen sc1
  v_smfmac_f32_16x16x64_bf16 v[100:103], v[60:63], a[104:111], v22
  v_smfmac_f32_16x16x64_bf16 v[100:103], v[64:67], a[112:119], v22
  v_smfmac_f32_16x16x64_bf16 v[100:103], v[68:71], a[120:127], v22
  v_smfmac_f32_16x16x64_bf16 v[100:103], v[72:75], a[128:135], v22
  v_cvt_pk_bf16_f32 v136, v96, v97
  v_smfmac_f32_16x16x64_bf16 v[100:103], v[76:79], a[136:143], v22
  v_cvt_pk_bf16_f32 v137, v98, v99
  v_smfmac_f32_16x16x64_bf16 v[100:103], v[80:83], a[144:151], v22
  v_smfmac_f32_16x16x64_bf16 v[100:103], v[84:87], a[152:159], v22
  s_waitcnt vmcnt(2)
  v_pk_add_f16 v172, v124, v126
  v_pk_add_f16 v173, v125, v127
  s_waitcnt vmcnt(1)
  v_pk_add_f16 v174, v128, v130
  v_pk_add_f16 v175, v129, v131
  v_fma_mix_f32 v166, v172, 1.0, v174 op_sel:[0,0,0] op_sel_hi:[1,0,1]
  v_fma_mix_f32 v168, v173, 1.0, v175 op_sel:[0,0,0] op_sel_hi:[1,0,1]
  s_waitcnt vmcnt(0)
  v_pk_add_f16 v176, v132, v133
  v_pk_add_f16 v177, v134, v135
  v_fma_mix_f32 v170, v176, 1.0, v177 op_sel:[0,0,0] op_sel_hi:[1,0,1]
  v_fma_mix_f32 v167, v172, 1.0, v174 op_sel:[1,0,1] op_sel_hi:[1,0,1]
  v_cmp_u_f32 vcc, v166, v170
  v_fma_mix_f32 v169, v173, 1.0, v175 op_sel:[1,0,1] op_sel_hi:[1,0,1]
  v_fma_mix_f32 v171, v176, 1.0, v177 op_sel:[1,0,1] op_sel_hi:[1,0,1]
  v_cvt_pk_bf16_f32 v138, v100, v101
  s_cbranch_vccnz sr_160
sj_161:
ex_162:
  v_exp_f32 v172, v166
  v_exp_f32 v173, v167
  v_exp_f32 v174, v168
  v_cvt_pk_bf16_f32 v156, v172, v173
  v_exp_f32 v175, v169
  v_exp_f32 v176, v170
  v_cvt_pk_bf16_f32 v157, v174, v175
  v_mov_b32_dpp v158, v156 row_ror:8 row_mask:0xf bank_mask:0xf
  v_exp_f32 v177, v171
  v_mov_b32_dpp v159, v157 row_ror:8 row_mask:0xf bank_mask:0xf
  v_cvt_pk_bf16_f32 v160, v176, v177
  v_cvt_pk_bf16_f32 v139, v102, v103
  v_mfma_f32_16x16x32_bf16 v[178:181], v[152:155], v[156:159], 0
  s_waitcnt lgkmcnt(0)
  v_mov_b32_dpp v161, v160 row_ror:8 row_mask:0xf bank_mask:0xf
  v_mfma_f32_16x16x32_bf16 v[182:185], v[144:147], v[156:159], 0
  s_nop 0
  v_mfma_f32_16x16x32_bf16 v[178:181], v[140:143], v[160:163], v[178:181]
  v_mfma_f32_16x16x32_bf16 v[182:185], v[136:139], v[160:163], v[182:185]
  v_mfma_f32_16x16x32_bf16 v[186:189], v[148:151], v[156:159], 0
  v_mfma_f32_16x16x32_bf16 v[186:189], v[138:141], v[160:163], v[186:189]
  s_mov_b64 exec, s[62:63]
  v_rcp_f32 v164, v180
  s_nop 0
  v_pk_mul_f32 v[178:179], v[178:179], v[164:165] op_sel_hi:[1,0]
  v_pk_mul_f32 v[182:183], v[182:183], v[164:165] op_sel_hi:[1,0]
  v_pk_mul_f32 v[184:185], v[184:185], v[164:165] op_sel_hi:[1,0]
  v_cvt_pk_f16_f32 v64, v178, v179
  v_cvt_pk_f16_f32 v60, v182, v183
  v_pk_mul_f32 v[186:187], v[186:187], v[164:165] op_sel_hi:[1,0]
  v_pk_mul_f32 v[188:189], v[188:189], v[164:165] op_sel_hi:[1,0]
  v_cvt_pk_f16_f32 v61, v184, v185
  v_cvt_pk_f16_f32 v62, v186, v187
  v_cvt_pk_f16_f32 v63, v188, v189
  ds_write_b128 v13, v[60:63]
  ds_write_b32 v14, v64
  v_add_f32 v165, v164, v180
  v_cmp_ngt_f32 vcc, s80, v165
  s_mov_b64 exec, -1
  s_nop 0
  s_cbranch_vccnz fx_163
fk_164:
  s_waitcnt lgkmcnt(0)
  s_barrier
  s_add_u32 m0, s74, 0
  s_add_u32 s21, s79, 0
  buffer_load_dwordx4 v4, s[28:31], s21 offen sc1 lds
  s_add_u32 m0, s74, 3072
  s_add_u32 s21, s79, 41984
  buffer_load_dwordx4 v4, s[28:31], s21 offen sc1 lds
  s_add_u32 m0, s74, 6144
  s_add_u32 s21, s79, 122880
  buffer_load_dwordx4 v4, s[28:31], s21 offen sc1 lds
  s_add_u32 s72, s72, 1310720
  s_add_u32 s79, s79, 1310720
  s_add_u32 s73, s73, 393216
  s_xor_b32 s74, s74, 16384
  s_nop 15
  s_nop 3
  v_permlane32_swap_b32 v96, v100
  v_permlane32_swap_b32 v97, v101
  v_permlane32_swap_b32 v98, v102
  v_permlane32_swap_b32 v99, v103
  v_pk_add_f32 v[96:97], v[96:97], v[100:101]
  v_pk_add_f32 v[98:99], v[98:99], v[102:103]
  v_cvt_pk_bf16_f32 v182, v96, v97
  v_cvt_pk_bf16_f32 v183, v98, v99
  v_min_u32 v182, -2, v182
  ds_write_b64 v26, v[182:183]
  ds_read_b128 v[144:147], v18
  ds_read_b128 v[148:151], v18 offset:1024
  ds_read_b128 v[152:155], v19
  v_xor_b32 v18, 16384, v18
  v_xor_b32 v19, 16384, v19
  v_mov_b32 v88, 0
  v_mov_b32 v89, 0
  v_mov_b32 v90, 0
  v_mov_b32 v91, 0
  v_mov_b32 v92, 0
  v_mov_b32 v93, 0
  v_mov_b32 v94, 0
  v_mov_b32 v95, 0
  v_mov_b32 v96, 0
  v_mov_b32 v97, 0
  v_mov_b32 v98, 0
  v_mov_b32 v99, 0
  v_mov_b32 v100, 0
  v_mov_b32 v101, 0
  v_mov_b32 v102, 0
  v_mov_b32 v103, 0
  s_mov_b32 s81, 0
  s_waitcnt lgkmcnt(0)
  s_barrier
  s_mov_b64 exec, s[64:65]
  buffer_store_dword v28, v8, s[8:11], s57 offen sc1
  buffer_store_dword v28, v8, s[8:11], s57 offen offset:128 sc1
  s_mov_b64 exec, -1
  s_cmp_eq_u32 s78, 0
  s_cbranch_scc1 nt_165
  s_mov_b64 exec, s[62:63]
  buffer_store_dword v28, v17, s[8:11], s59 offen sc1
  s_mov_b64 exec, -1
  s_sleep 6
  s_nop 3
  buffer_load_dwordx4 v[68:71], v16, s[4:7], s60 offen sc1
  s_sleep 3
  s_nop 1
  buffer_load_dwordx4 v[72:75], v16, s[4:7], s60 offen sc1
  s_mov_b32 s54, 0
pp_166:
  s_waitcnt vmcnt(1)
  v_mfma_f32_16x16x32_f16 v[120:123], v[44:47], v[68:71], 0
  v_bitop3_b32 v27, v68, s61, 1 bitop3:0x28
  v_cmp_ne_u32 vcc, 0, v27
  s_nop 1
  s_cbranch_vccnz p2_168
  s_nop 2
pg_167:
  v_add_f32_dpp v120, v120, v120 row_ror:8 row_mask:0xf bank_mask:0xf
  v_add_f32_dpp v121, v121, v121 row_ror:8 row_mask:0xf bank_mask:0xf
  s_mov_b64 exec, s[62:63]
  v_cvt_pk_bf16_f32 v120, v120, v121
  v_min_u32 v120, -2, v120
  buffer_store_dword v120, v17, s[8:11], s55 offen sc1
  s_mov_b64 exec, -1
nt_165:
  s_barrier
  s_mov_b32 s58, s55
  s_add_u32 s52, s52, 1
  s_and_b32 s21, s52, 3
  s_mul_i32 s56, s21, 122880
  s_add_u32 s21, s52, 1
  s_and_b32 s21, s21, 3
  s_mul_i32 s55, s21, 122880
  s_add_u32 s55, s55, s75
  s_add_u32 s21, s52, 2
  s_and_b32 s21, s21, 3
  s_mul_i32 s57, s21, 122880
  s_add_u32 s21, s52, 3
  s_and_b32 s21, s21, 3
  s_mul_i32 s59, s21, 122880
  s_add_u32 s59, s59, s75
  s_bfe_u32 s61, s52, 0x10001
  s_and_b32 s21, s52, 1
  s_lshl_b32 s60, s21, 19
  s_mov_b32 s54, 0
  s_sleep 3
  s_nop 2
  buffer_load_dwordx4 v[72:75], v190, s[8:11], s58 offen offset:0 sc1
  buffer_load_dwordx4 v[76:79], v190, s[8:11], s58 offen offset:1024 sc1
  buffer_load_dwordx4 v[80:83], v190, s[8:11], s58 offen offset:2048 sc1
  s_branch top_154
mr_155:
  s_mov_b64 exec, s[22:23]
  s_cbranch_execz ms_169
  buffer_load_dwordx4 v[72:75], v190, s[8:11], s58 offen offset:0 sc1
ms_169:
  s_mov_b64 exec, s[98:99]
  s_cbranch_execz ms_170
  buffer_load_dwordx4 v[76:79], v190, s[8:11], s58 offen offset:1024 sc1
ms_170:
  s_mov_b64 exec, s[100:101]
  s_cbranch_execz ms_171
  buffer_load_dwordx4 v[80:83], v190, s[8:11], s58 offen offset:2048 sc1
ms_171:
  s_add_u32 s54, s54, 1
  s_cmp_gt_u32 s54, 131072
  s_cbranch_scc1 end0
  s_waitcnt vmcnt(0)
  s_mov_b64 exec, s[22:23]
  ds_write_b128 v190, v[72:75] offset:0
  v_cmp_eq_u32 s[22:23], -1, v72
  s_mov_b64 exec, s[98:99]
  ds_write_b128 v190, v[76:79] offset:1024
  v_cmp_eq_u32 s[98:99], -1, v76
  s_mov_b64 exec, s[100:101]
  ds_write_b128 v190, v[80:83] offset:2048
  v_cmp_eq_u32 s[100:101], -1, v80
  s_mov_b64 exec, -1
  s_or_b64 vcc, s[22:23], s[98:99]
  s_or_b64 vcc, vcc, s[100:101]
  s_cbranch_scc1 mr_155
  s_branch mo_159
mn_156:
  v_max3_u32 v27, v48, v49, v50
  v_max3_u32 v27, v27, v51, v52
  v_max3_u32 v27, v27, v53, v54
  v_max3_u32 v27, v27, v55, v56
  v_max3_u32 v27, v27, v57, v58
  v_max3_u32 v27, v27, v59, v60
  v_max3_u32 v27, v27, v61, v62
  v_max3_u32 v27, v27, v63, v64
  v_max3_u32 v27, v27, v65, v66
  v_max3_u32 v27, v27, v67, v68
  v_max3_u32 v27, v27, v69, v70
  v_max3_u32 v27, v27, v71, v72
  v_max3_u32 v27, v27, v73, v74
  v_max3_u32 v27, v27, v75, v76
  v_max3_u32 v27, v27, v77, v78
  v_max3_u32 v27, v27, v79, v80
  v_max3_u32 v27, v27, v81, v82
  v_max3_u32 v27, v27, v83, v84
  v_max3_u32 v27, v27, v85, v86
  v_max3_u32 v27, v27, v87, v87
  v_cmp_eq_u32 vcc, -1, v27
  s_cmp_eq_u32 s52, 0
  s_cbranch_scc1 mk_157
  s_cbranch_vccz mk_157
  s_waitcnt lgkmcnt(0)
  s_barrier
  s_nop 7
  v_mov_b32 v88, 0
  v_mov_b32 v89, 0
  v_mov_b32 v90, 0
  v_mov_b32 v91, 0
  v_mov_b32 v92, 0
  v_mov_b32 v93, 0
  v_mov_b32 v94, 0
  v_mov_b32 v95, 0
  v_mov_b32 v96, 0
  v_mov_b32 v97, 0
  v_mov_b32 v98, 0
  v_mov_b32 v99, 0
  v_mov_b32 v100, 0
  v_mov_b32 v101, 0
  v_mov_b32 v102, 0
  v_mov_b32 v103, 0
  s_mov_b64 s[22:23], -1
  s_mov_b64 s[98:99], -1
  s_mov_b64 s[100:101], -1
  s_branch mr_155
sr_160:
  s_mov_b32 s54, 0
sr_172:
  s_mov_b64 exec, vcc
  buffer_load_dwordx4 v[124:127], v9, s[8:11], s56 offen sc1
  buffer_load_dwordx4 v[128:131], v9, s[8:11], s56 offen offset:1024 sc1
  buffer_load_dwordx4 v[132:135], v10, s[8:11], s56 offen sc1
  s_mov_b64 exec, -1
  s_add_u32 s54, s54, 1
  s_cmp_gt_u32 s54, 131072
  s_cbranch_scc1 end0
  s_and_b32 s21, s54, 31
  s_cbranch_scc0 sr_173
  s_waitcnt vmcnt(0)
  v_pk_add_f16 v172, v124, v126
  v_pk_add_f16 v173, v125, v127
  v_pk_add_f16 v174, v128, v130
  v_pk_add_f16 v175, v129, v131
  v_fma_mix_f32 v166, v172, 1.0, v174 op_sel:[0,0,0] op_sel_hi:[1,0,1]
  v_fma_mix_f32 v168, v173, 1.0, v175 op_sel:[0,0,0] op_sel_hi:[1,0,1]
  v_pk_add_f16 v176, v132, v133
  v_pk_add_f16 v177, v134, v135
  v_add_f32 v27, v166, v168
  v_fma_mix_f32 v170, v176, 1.0, v177 op_sel:[0,0,0] op_sel_hi:[1,0,1]
  v_fma_mix_f32 v167, v172, 1.0, v174 op_sel:[1,0,1] op_sel_hi:[1,0,1]
  v_cmp_u_f32 vcc, v27, v170
  v_fma_mix_f32 v169, v173, 1.0, v175 op_sel:[1,0,1] op_sel_hi:[1,0,1]
  v_fma_mix_f32 v171, v176, 1.0, v177 op_sel:[1,0,1] op_sel_hi:[1,0,1]
  s_cbranch_vccnz sr_172
  s_branch sj_161
sr_173:
  s_waitcnt vmcnt(0)
  v_pk_add_f16 v172, v124, v126
  v_pk_add_f16 v173, v125, v127
  v_pk_add_f16 v174, v128, v130
  v_pk_add_f16 v175, v129, v131
  v_fma_mix_f32 v166, v172, 1.0, v174 op_sel:[0,0,0] op_sel_hi:[1,0,1]
  v_fma_mix_f32 v168, v173, 1.0, v175 op_sel:[0,0,0] op_sel_hi:[1,0,1]
  v_pk_add_f16 v176, v132, v133
  v_pk_add_f16 v177, v134, v135
  v_add_f32 v27, v166, v168
  v_fma_mix_f32 v170, v176, 1.0, v177 op_sel:[0,0,0] op_sel_hi:[1,0,1]
  v_fma_mix_f32 v167, v172, 1.0, v174 op_sel:[1,0,1] op_sel_hi:[1,0,1]
  v_cmp_u_f32 vcc, v27, v170
  v_fma_mix_f32 v169, v173, 1.0, v175 op_sel:[1,0,1] op_sel_hi:[1,0,1]
  v_fma_mix_f32 v171, v176, 1.0, v177 op_sel:[1,0,1] op_sel_hi:[1,0,1]
  v_max3_u32 v27, v124, v126, v128
  v_max3_u32 v27, v27, v130, v132
  v_max3_u32 v27, v27, v133, v134
  v_max3_u32 v27, v27, v135, v135
  v_cmp_eq_u32 vcc, -1, v27
  s_nop 1
  s_cbranch_vccnz sr_172
  s_branch sj_161
fx_163:
  s_cmp_eq_u32 s81, 1
  s_cbranch_scc1 fk_164
  s_mov_b32 s81, 1
  v_max3_f32 v164, v166, v167, v168
  v_max3_f32 v165, v169, v170, v171
  v_max_f32 v164, v164, v165
  s_nop 1
  v_max_f32_dpp v164, v164, v164 row_ror:8 row_mask:0xf bank_mask:0xf
  v_mov_b32 v165, v164
  s_nop 1
  v_permlane32_swap_b32 v164, v165
  v_max_f32 v164, v164, v165
  v_mov_b32 v165, v164
  s_nop 1
  v_permlane16_swap_b32 v164, v165
  v_max_f32 v164, v164, v165
  v_sub_f32 v166, v166, v164
  v_sub_f32 v167, v167, v164
  v_sub_f32 v168, v168, v164
  v_sub_f32 v169, v169, v164
  v_sub_f32 v170, v170, v164
  v_sub_f32 v171, v171, v164
  s_branch ex_162
p2_168:
  buffer_load_dwordx4 v[68:71], v16, s[4:7], s60 offen sc1
  s_waitcnt vmcnt(1)
  v_mfma_f32_16x16x32_f16 v[120:123], v[44:47], v[72:75], 0
  v_bitop3_b32 v27, v72, s61, 1 bitop3:0x28
  v_cmp_ne_u32 vcc, 0, v27
  s_nop 1
  s_cbranch_vccz pg_167
  buffer_load_dwordx4 v[72:75], v16, s[4:7], s60 offen sc1
  s_add_u32 s54, s54, 1
  s_cmp_gt_u32 s54, 131072
  s_cbranch_scc1 end0
  s_branch pp_166
last_158:
  v_smfmac_f32_16x16x64_bf16 v[96:99], v[48:51], a[0:7], v22
  v_smfmac_f32_16x16x64_bf16 v[100:103], v[48:51], a[80:87], v22
  v_smfmac_f32_16x16x64_bf16 v[96:99], v[52:55], a[8:15], v22
  v_smfmac_f32_16x16x64_bf16 v[100:103], v[52:55], a[88:95], v22
  v_smfmac_f32_16x16x64_bf16 v[96:99], v[56:59], a[16:23], v22
  v_smfmac_f32_16x16x64_bf16 v[100:103], v[56:59], a[96:103], v22
  v_smfmac_f32_16x16x64_bf16 v[96:99], v[60:63], a[24:31], v22
  v_smfmac_f32_16x16x64_bf16 v[96:99], v[64:67], a[32:39], v22
  v_smfmac_f32_16x16x64_bf16 v[96:99], v[68:71], a[40:47], v22
  v_smfmac_f32_16x16x64_bf16 v[96:99], v[72:75], a[48:55], v22
  v_smfmac_f32_16x16x64_bf16 v[96:99], v[76:79], a[56:63], v22
  v_smfmac_f32_16x16x64_bf16 v[96:99], v[80:83], a[64:71], v22
  v_smfmac_f32_16x16x64_bf16 v[96:99], v[84:87], a[72:79], v22
  v_smfmac_f32_16x16x64_bf16 v[100:103], v[60:63], a[104:111], v22
  v_smfmac_f32_16x16x64_bf16 v[100:103], v[64:67], a[112:119], v22
  v_smfmac_f32_16x16x64_bf16 v[100:103], v[68:71], a[120:127], v22
  v_smfmac_f32_16x16x64_bf16 v[100:103], v[72:75], a[128:135], v22
  v_smfmac_f32_16x16x64_bf16 v[100:103], v[76:79], a[136:143], v22
  v_smfmac_f32_16x16x64_bf16 v[100:103], v[80:83], a[144:151], v22
  v_smfmac_f32_16x16x64_bf16 v[100:103], v[84:87], a[152:159], v22
  s_nop 7
  v_permlane32_swap_b32 v96, v100
  v_permlane32_swap_b32 v97, v101
  v_permlane32_swap_b32 v98, v102
  v_permlane32_swap_b32 v99, v103
  v_pk_add_f32 v[96:97], v[96:97], v[100:101]
  v_pk_add_f32 v[98:99], v[98:99], v[102:103]
  v_cvt_pk_bf16_f32 v182, v96, v97
  v_cvt_pk_bf16_f32 v183, v98, v99
  v_min_u32 v182, -2, v182
  ds_write_b64 v26, v[182:183]
  s_waitcnt lgkmcnt(0)
  s_barrier
  s_branch chain_done
E_33:
  v_add_u32 v190, 9216, v4
  ds_read_b128 v[84:87], v4 offset:9216
  s_waitcnt lgkmcnt(0)
  s_branch mo_179
  .p2align 3
top_174:
  s_waitcnt vmcnt(0)
  ds_write_b128 v190, v[84:87] offset:0
  v_cmp_eq_u32 s[22:23], -1, v84
  s_or_b64 vcc, s[22:23], s[22:23]
  s_cbranch_scc1 mr_175
mo_179:
  s_waitcnt lgkmcnt(0)
  s_barrier
  ds_read_b128 v[48:51], v4 offset:0
  ds_read_b128 v[52:55], v4 offset:1024
  v_smfmac_f32_16x16x64_bf16 v[92:95], v[84:87], v[248:255], v22
  ds_read_b128 v[56:59], v4 offset:2048
  v_smfmac_f32_16x16x64_bf16 v[88:91], v[84:87], a[232:239], v22
  s_waitcnt lgkmcnt(2)
  ds_read_b128 v[60:63], v4 offset:3072
  v_smfmac_f32_16x16x64_bf16 v[92:95], v[48:51], a[240:247], v22
  ds_read_b128 v[64:67], v4 offset:4096
  v_smfmac_f32_16x16x64_bf16 v[88:91], v[48:51], a[160:167], v22
  s_waitcnt lgkmcnt(3)
  ds_read_b128 v[68:71], v4 offset:5120
  v_smfmac_f32_16x16x64_bf16 v[92:95], v[52:55], a[248:255], v22
  ds_read_b128 v[72:75], v4 offset:6144
  v_smfmac_f32_16x16x64_bf16 v[88:91], v[52:55], a[168:175], v22
  s_waitcnt lgkmcnt(4)
  ds_read_b128 v[76:79], v4 offset:7168
  v_smfmac_f32_16x16x64_bf16 v[92:95], v[56:59], v[192:199], v22
  ds_read_b128 v[80:83], v4 offset:8192
  v_smfmac_f32_16x16x64_bf16 v[88:91], v[56:59], a[176:183], v22
  s_waitcnt lgkmcnt(5)
  s_add_u32 m0, s74, 10240
  s_nop 0
  buffer_load_dwordx4 v33, s[16:19], s73 offen sc1 lds
  v_smfmac_f32_16x16x64_bf16 v[92:95], v[60:63], v[200:207], v22
  s_waitcnt lgkmcnt(4)
  s_add_u32 m0, s74, 11264
  s_nop 0
  buffer_load_dwordx4 v34, s[16:19], s73 offen sc1 lds
  v_smfmac_f32_16x16x64_bf16 v[92:95], v[64:67], v[208:215], v22
  s_waitcnt lgkmcnt(3)
  s_add_u32 m0, s74, 12288
  s_nop 0
  buffer_load_dwordx4 v35, s[16:19], s73 offen sc1 lds
  v_smfmac_f32_16x16x64_bf16 v[92:95], v[68:71], v[216:223], v22
  s_waitcnt lgkmcnt(2)
  v_smfmac_f32_16x16x64_bf16 v[92:95], v[72:75], v[224:231], v22
  s_waitcnt lgkmcnt(1)
  v_smfmac_f32_16x16x64_bf16 v[92:95], v[76:79], v[232:239], v22
  s_waitcnt lgkmcnt(0)
  v_smfmac_f32_16x16x64_bf16 v[92:95], v[80:83], v[240:247], v22
  v_smfmac_f32_16x16x64_bf16 v[88:91], v[60:63], a[184:191], v22
  v_smfmac_f32_16x16x64_bf16 v[88:91], v[64:67], a[192:199], v22
  v_smfmac_f32_16x16x64_bf16 v[88:91], v[68:71], a[200:207], v22
  v_cvt_pk_bf16_f32 v122, v92, v93
  v_smfmac_f32_16x16x64_bf16 v[88:91], v[72:75], a[208:215], v22
  v_cvt_pk_bf16_f32 v123, v94, v95
  v_smfmac_f32_16x16x64_bf16 v[88:91], v[76:79], a[216:223], v22
  ds_write_b64 v12, v[122:123] offset:13056
  v_smfmac_f32_16x16x64_bf16 v[88:91], v[80:83], a[224:231], v22
  v_smfmac_f32_16x16x64_bf16 v[96:99], v[48:51], a[0:7], v22
  v_smfmac_f32_16x16x64_bf16 v[100:103], v[48:51], a[80:87], v22
  v_smfmac_f32_16x16x64_bf16 v[96:99], v[52:55], a[8:15], v22
  v_cvt_pk_bf16_f32 v120, v88, v89
  v_cvt_pk_bf16_f32 v121, v90, v91
  ds_write_b64 v12, v[120:121] offset:12544
  v_smfmac_f32_16x16x64_bf16 v[100:103], v[52:55], a[88:95], v22
  v_cmp_u_f32 vcc, v88, v89
  v_smfmac_f32_16x16x64_bf16 v[96:99], v[56:59], a[16:23], v22
  v_cmp_u_f32 s[22:23], v90, v91
  s_nop 0
  s_or_b64 vcc, vcc, s[22:23]
  s_cbranch_vccnz mn_176
mk_177:
  s_waitcnt lgkmcnt(0)
  s_barrier
  ds_read_b64_tr_b16 v[104:105], v7 offset:0
  ds_read_b64_tr_b16 v[106:107], v7 offset:768
  ds_read_b64_tr_b16 v[108:109], v7 offset:1536
  ds_read_b64 v[140:141], v11
  s_cmp_eq_u32 s52, 63
  s_cbranch_scc1 last_178
  s_add_u32 s22, s52, 3
  s_min_u32 s22, s22, 64
  v_cmp_gt_u32 vcc, s22, v42
  s_nop 1
  s_cbranch_vccnz kw_180
kv_181:
  v_smfmac_f32_16x16x64_bf16 v[100:103], v[56:59], a[96:103], v22
  v_smfmac_f32_16x16x64_bf16 v[96:99], v[60:63], a[24:31], v22
  v_smfmac_f32_16x16x64_bf16 v[96:99], v[64:67], a[32:39], v22
  v_smfmac_f32_16x16x64_bf16 v[96:99], v[68:71], a[40:47], v22
  v_smfmac_f32_16x16x64_bf16 v[96:99], v[72:75], a[48:55], v22
  v_smfmac_f32_16x16x64_bf16 v[96:99], v[76:79], a[56:63], v22
  v_smfmac_f32_16x16x64_bf16 v[96:99], v[80:83], a[64:71], v22
  v_smfmac_f32_16x16x64_bf16 v[96:99], v[84:87], a[72:79], v22
  v_smfmac_f32_16x16x64_bf16 v[100:103], v[60:63], a[104:111], v22
  v_smfmac_f32_16x16x64_bf16 v[100:103], v[64:67], a[112:119], v22
  v_smfmac_f32_16x16x64_bf16 v[100:103], v[68:71], a[120:127], v22
  v_smfmac_f32_16x16x64_bf16 v[100:103], v[72:75], a[128:135], v22
  v_cvt_pk_bf16_f32 v136, v96, v97
  v_smfmac_f32_16x16x64_bf16 v[100:103], v[76:79], a[136:143], v22
  v_cvt_pk_bf16_f32 v137, v98, v99
  v_smfmac_f32_16x16x64_bf16 v[100:103], v[80:83], a[144:151], v22
  v_smfmac_f32_16x16x64_bf16 v[100:103], v[84:87], a[152:159], v22
  s_sleep 3
  s_nop 3
  buffer_load_dwordx4 v[124:127], v9, s[8:11], s56 offen sc1
  buffer_load_dwordx4 v[128:131], v9, s[8:11], s56 offen offset:1024 sc1
  s_nop 5
  buffer_load_dwordx4 v[132:135], v10, s[8:11], s56 offen sc1
  s_waitcnt vmcnt(2)
  v_pk_add_f16 v172, v124, v126
  v_pk_add_f16 v173, v125, v127
  s_waitcnt vmcnt(1)
  v_pk_add_f16 v174, v128, v130
  v_pk_add_f16 v175, v129, v131
  v_fma_mix_f32 v166, v172, 1.0, v174 op_sel:[0,0,0] op_sel_hi:[1,0,1]
  v_fma_mix_f32 v168, v173, 1.0, v175 op_sel:[0,0,0] op_sel_hi:[1,0,1]
  s_waitcnt vmcnt(0)
  v_pk_add_f16 v176, v132, v133
  v_pk_add_f16 v177, v134, v135
  v_fma_mix_f32 v170, v176, 1.0, v177 op_sel:[0,0,0] op_sel_hi:[1,0,1]
  v_fma_mix_f32 v167, v172, 1.0, v174 op_sel:[1,0,1] op_sel_hi:[1,0,1]
  v_cmp_u_f32 vcc, v166, v170
  v_fma_mix_f32 v169, v173, 1.0, v175 op_sel:[1,0,1] op_sel_hi:[1,0,1]
  v_fma_mix_f32 v171, v176, 1.0, v177 op_sel:[1,0,1] op_sel_hi:[1,0,1]
  v_cvt_pk_bf16_f32 v138, v100, v101
  s_cbranch_vccnz sr_182
sj_183:
ex_184:
  v_exp_f32 v172, v166
  v_exp_f32 v173, v167
  v_exp_f32 v174, v168
  v_cvt_pk_bf16_f32 v156, v172, v173
  v_exp_f32 v175, v169
  v_exp_f32 v176, v170
  v_cvt_pk_bf16_f32 v157, v174, v175
  v_mov_b32_dpp v158, v156 row_ror:8 row_mask:0xf bank_mask:0xf
  v_exp_f32 v177, v171
  v_mov_b32_dpp v159, v157 row_ror:8 row_mask:0xf bank_mask:0xf
  v_cvt_pk_bf16_f32 v160, v176, v177
  v_cvt_pk_bf16_f32 v139, v102, v103
  v_mfma_f32_16x16x32_bf16 v[178:181], v[152:155], v[156:159], 0
  s_waitcnt lgkmcnt(0)
  v_mov_b32_dpp v161, v160 row_ror:8 row_mask:0xf bank_mask:0xf
  v_mfma_f32_16x16x32_bf16 v[182:185], v[144:147], v[156:159], 0
  s_nop 0
  v_mfma_f32_16x16x32_bf16 v[178:181], v[140:143], v[160:163], v[178:181]
  v_mfma_f32_16x16x32_bf16 v[182:185], v[136:139], v[160:163], v[182:185]
  v_mfma_f32_16x16x32_bf16 v[186:189], v[148:151], v[156:159], 0
  v_mfma_f32_16x16x32_bf16 v[186:189], v[138:141], v[160:163], v[186:189]
  s_mov_b64 exec, s[62:63]
  v_rcp_f32 v164, v180
  s_nop 0
  v_pk_mul_f32 v[178:179], v[178:179], v[164:165] op_sel_hi:[1,0]
  v_pk_mul_f32 v[182:183], v[182:183], v[164:165] op_sel_hi:[1,0]
  v_pk_mul_f32 v[184:185], v[184:185], v[164:165] op_sel_hi:[1,0]
  v_cvt_pk_f16_f32 v64, v178, v179
  v_cvt_pk_f16_f32 v60, v182, v183
  v_pk_mul_f32 v[186:187], v[186:187], v[164:165] op_sel_hi:[1,0]
  v_pk_mul_f32 v[188:189], v[188:189], v[164:165] op_sel_hi:[1,0]
  v_cvt_pk_f16_f32 v61, v184, v185
  v_cvt_pk_f16_f32 v62, v186, v187
  v_cvt_pk_f16_f32 v63, v188, v189
  ds_write_b128 v13, v[60:63]
  ds_write_b32 v14, v64
  v_add_f32 v165, v164, v180
  v_cmp_ngt_f32 vcc, s80, v165
  s_mov_b64 exec, -1
  s_nop 0
  s_cbranch_vccnz fx_185
fk_186:
  s_waitcnt lgkmcnt(0)
  s_barrier
  ds_read_b128 v[166:169], v4 offset:13824
  ds_read_b128 v[170:173], v4 offset:14464
  ds_read_b128 v[174:177], v4 offset:15104
  ds_read_b128 v[178:181], v4 offset:15744
  s_mov_b64 exec, s[66:67]
  s_waitcnt lgkmcnt(2)
  v_pk_add_f16 v166, v166, v170
  v_pk_add_f16 v167, v167, v171
  v_pk_add_f16 v168, v168, v172
  v_pk_add_f16 v169, v169, v173
  s_waitcnt lgkmcnt(1)
  v_pk_add_f16 v166, v166, v174
  v_pk_add_f16 v167, v167, v175
  v_pk_add_f16 v168, v168, v176
  v_pk_add_f16 v169, v169, v177
  s_waitcnt lgkmcnt(0)
  v_pk_add_f16 v166, v166, v178
  v_pk_add_f16 v167, v167, v179
  v_pk_add_f16 v168, v168, v180
  v_pk_add_f16 v169, v169, v181
  v_and_or_b32 v166, v166, -2, s61
  buffer_store_dwordx4 v[166:169], v15, s[4:7], s60 offen sc1
  s_mov_b64 exec, -1
  v_permlane32_swap_b32 v96, v100
  v_permlane32_swap_b32 v97, v101
  v_permlane32_swap_b32 v98, v102
  v_permlane32_swap_b32 v99, v103
  v_pk_add_f32 v[96:97], v[96:97], v[100:101]
  v_pk_add_f32 v[98:99], v[98:99], v[102:103]
  v_cvt_pk_bf16_f32 v182, v96, v97
  v_cvt_pk_bf16_f32 v183, v98, v99
  v_min_u32 v182, -2, v182
  ds_write_b64 v26, v[182:183]
  v_permlane32_swap_b32 v88, v92
  v_permlane32_swap_b32 v89, v93
  v_permlane32_swap_b32 v90, v94
  v_permlane32_swap_b32 v91, v95
  v_pk_add_f32 v[88:89], v[88:89], v[92:93]
  v_pk_add_f32 v[90:91], v[90:91], v[94:95]
  v_cvt_pk_bf16_f32 v184, v88, v89
  v_cvt_pk_bf16_f32 v185, v90, v91
  v_min_u32 v184, -2, v184
  ds_write_b64 v43, v[184:185]
  ds_read_b128 v[144:147], v18
  ds_read_b128 v[148:151], v18 offset:1024
  ds_read_b128 v[152:155], v19
  v_xor_b32 v18, 16384, v18
  v_xor_b32 v19, 16384, v19
  v_mov_b32 v88, 0
  v_mov_b32 v89, 0
  v_mov_b32 v90, 0
  v_mov_b32 v91, 0
  v_mov_b32 v92, 0
  v_mov_b32 v93, 0
  v_mov_b32 v94, 0
  v_mov_b32 v95, 0
  v_mov_b32 v96, 0
  v_mov_b32 v97, 0
  v_mov_b32 v98, 0
  v_mov_b32 v99, 0
  v_mov_b32 v100, 0
  v_mov_b32 v101, 0
  v_mov_b32 v102, 0
  v_mov_b32 v103, 0
  s_mov_b32 s81, 0
  s_waitcnt lgkmcnt(0)
  s_barrier
  s_add_u32 s72, s72, 1310720
  s_add_u32 s79, s79, 1310720
  s_add_u32 s73, s73, 393216
  s_xor_b32 s74, s74, 16384
  v_mov_b32 v28, s61
  v_mov_b32 v166, s52
  s_mov_b64 exec, 1
  buffer_store_dword v166, v23, s[12:15], s77 offen sc1
  s_mov_b64 exec, -1
  ds_read_b128 v[170:173], v4 offset:16384
  ds_read_b128 v[174:177], v4 offset:17408
  ds_read_b128 v[178:181], v4 offset:18432
  v_min_u32 v104, -2, v104
  v_min_u32 v106, -2, v106
  v_min_u32 v108, -2, v108
  s_mov_b64 exec, s[68:69]
  buffer_store_dwordx4 v[104:107], v36, s[24:27], s70 offen sc1
  buffer_store_dwordx2 v[108:109], v37, s[24:27], s70 offen sc1
  s_mov_b64 exec, -1
  s_waitcnt lgkmcnt(0)
  buffer_store_dwordx4 v[170:173], v38, s[36:39], s71 offen sc1
  buffer_store_dwordx4 v[174:177], v39, s[36:39], s71 offen sc1
  s_mov_b64 exec, 0xffffffff
  buffer_store_dwordx4 v[178:181], v40, s[36:39], s71 offen sc1
  s_mov_b64 exec, -1
  s_add_u32 s70, s70, 98304
  s_add_u32 s71, s71, 327680
  buffer_load_dword v42, v41, s[12:15], s76 offen sc1
nt_187:
  s_barrier
  s_mov_b32 s58, s55
  s_add_u32 s52, s52, 1
  s_and_b32 s21, s52, 3
  s_mul_i32 s56, s21, 122880
  s_add_u32 s21, s52, 1
  s_and_b32 s21, s21, 3
  s_mul_i32 s55, s21, 122880
  s_add_u32 s55, s55, s75
  s_add_u32 s21, s52, 2
  s_and_b32 s21, s21, 3
  s_mul_i32 s57, s21, 122880
  s_add_u32 s21, s52, 3
  s_and_b32 s21, s21, 3
  s_mul_i32 s59, s21, 122880
  s_add_u32 s59, s59, s75
  s_bfe_u32 s61, s52, 0x10001
  s_and_b32 s21, s52, 1
  s_lshl_b32 s60, s21, 19
  s_mov_b32 s54, 0
  s_sleep 3
  s_nop 2
  buffer_load_dwordx4 v[84:87], v190, s[8:11], s58 offen offset:0 sc1
  s_branch top_174
mr_175:
  s_mov_b64 exec, s[22:23]
  s_cbranch_execz ms_188
  buffer_load_dwordx4 v[84:87], v190, s[8:11], s58 offen offset:0 sc1
ms_188:
  s_add_u32 s54, s54, 1
  s_cmp_gt_u32 s54, 131072
  s_cbranch_scc1 end0
  s_waitcnt vmcnt(0)
  s_mov_b64 exec, s[22:23]
  ds_write_b128 v190, v[84:87] offset:0
  v_cmp_eq_u32 s[22:23], -1, v84
  s_mov_b64 exec, -1
  s_or_b64 vcc, s[22:23], s[22:23]
  s_cbranch_scc1 mr_175
  s_branch mo_179
mn_176:
  v_max3_u32 v27, v48, v49, v50
  v_max3_u32 v27, v27, v51, v52
  v_max3_u32 v27, v27, v53, v54
  v_max3_u32 v27, v27, v55, v56
  v_max3_u32 v27, v27, v57, v58
  v_max3_u32 v27, v27, v59, v60
  v_max3_u32 v27, v27, v61, v62
  v_max3_u32 v27, v27, v63, v64
  v_max3_u32 v27, v27, v65, v66
  v_max3_u32 v27, v27, v67, v68
  v_max3_u32 v27, v27, v69, v70
  v_max3_u32 v27, v27, v71, v72
  v_max3_u32 v27, v27, v73, v74
  v_max3_u32 v27, v27, v75, v76
  v_max3_u32 v27, v27, v77, v78
  v_max3_u32 v27, v27, v79, v80
  v_max3_u32 v27, v27, v81, v82
  v_max3_u32 v27, v27, v83, v84
  v_max3_u32 v27, v27, v85, v86
  v_max3_u32 v27, v27, v87, v87
  v_cmp_eq_u32 vcc, -1, v27
  s_cmp_eq_u32 s52, 0
  s_cbranch_scc1 mk_177
  s_cbranch_vccz mk_177
  s_waitcnt lgkmcnt(0)
  s_barrier
  s_nop 7
  v_mov_b32 v88, 0
  v_mov_b32 v89, 0
  v_mov_b32 v90, 0
  v_mov_b32 v91, 0
  v_mov_b32 v92, 0
  v_mov_b32 v93, 0
  v_mov_b32 v94, 0
  v_mov_b32 v95, 0
  v_mov_b32 v96, 0
  v_mov_b32 v97, 0
  v_mov_b32 v98, 0
  v_mov_b32 v99, 0
  v_mov_b32 v100, 0
  v_mov_b32 v101, 0
  v_mov_b32 v102, 0
  v_mov_b32 v103, 0
  s_mov_b64 s[22:23], -1
  s_branch mr_175
kw_180:
  s_mov_b32 s101, 0
wm_189:
  buffer_load_dword v42, v41, s[12:15], s76 offen sc1
  s_add_u32 s101, s101, 1
  s_cmp_gt_u32 s101, 131072
  s_cbranch_scc1 end0
  s_waitcnt vmcnt(0)
  v_cmp_gt_u32 vcc, s22, v42
  v_readfirstlane_b32 s100, v42
  s_nop 0
  s_cbranch_vccz wm_190
  s_sleep 1
  s_branch wm_189
wm_190:
  s_branch kv_181
sr_182:
  s_mov_b32 s54, 0
sr_191:
  s_mov_b64 exec, vcc
  buffer_load_dwordx4 v[124:127], v9, s[8:11], s56 offen sc1
  buffer_load_dwordx4 v[128:131], v9, s[8:11], s56 offen offset:1024 sc1
  buffer_load_dwordx4 v[132:135], v10, s[8:11], s56 offen sc1
  s_mov_b64 exec, -1
  s_add_u32 s54, s54, 1
  s_cmp_gt_u32 s54, 131072
  s_cbranch_scc1 end0
  s_and_b32 s21, s54, 31
  s_cbranch_scc0 sr_192
  s_waitcnt vmcnt(0)
  v_pk_add_f16 v172, v124, v126
  v_pk_add_f16 v173, v125, v127
  v_pk_add_f16 v174, v128, v130
  v_pk_add_f16 v175, v129, v131
  v_fma_mix_f32 v166, v172, 1.0, v174 op_sel:[0,0,0] op_sel_hi:[1,0,1]
  v_fma_mix_f32 v168, v173, 1.0, v175 op_sel:[0,0,0] op_sel_hi:[1,0,1]
  v_pk_add_f16 v176, v132, v133
  v_pk_add_f16 v177, v134, v135
  v_add_f32 v27, v166, v168
  v_fma_mix_f32 v170, v176, 1.0, v177 op_sel:[0,0,0] op_sel_hi:[1,0,1]
  v_fma_mix_f32 v167, v172, 1.0, v174 op_sel:[1,0,1] op_sel_hi:[1,0,1]
  v_cmp_u_f32 vcc, v27, v170
  v_fma_mix_f32 v169, v173, 1.0, v175 op_sel:[1,0,1] op_sel_hi:[1,0,1]
  v_fma_mix_f32 v171, v176, 1.0, v177 op_sel:[1,0,1] op_sel_hi:[1,0,1]
  s_cbranch_vccnz sr_191
  s_branch sj_183
sr_192:
  s_waitcnt vmcnt(0)
  v_pk_add_f16 v172, v124, v126
  v_pk_add_f16 v173, v125, v127
  v_pk_add_f16 v174, v128, v130
  v_pk_add_f16 v175, v129, v131
  v_fma_mix_f32 v166, v172, 1.0, v174 op_sel:[0,0,0] op_sel_hi:[1,0,1]
  v_fma_mix_f32 v168, v173, 1.0, v175 op_sel:[0,0,0] op_sel_hi:[1,0,1]
  v_pk_add_f16 v176, v132, v133
  v_pk_add_f16 v177, v134, v135
  v_add_f32 v27, v166, v168
  v_fma_mix_f32 v170, v176, 1.0, v177 op_sel:[0,0,0] op_sel_hi:[1,0,1]
  v_fma_mix_f32 v167, v172, 1.0, v174 op_sel:[1,0,1] op_sel_hi:[1,0,1]
  v_cmp_u_f32 vcc, v27, v170
  v_fma_mix_f32 v169, v173, 1.0, v175 op_sel:[1,0,1] op_sel_hi:[1,0,1]
  v_fma_mix_f32 v171, v176, 1.0, v177 op_sel:[1,0,1] op_sel_hi:[1,0,1]
  v_max3_u32 v27, v124, v126, v128
  v_max3_u32 v27, v27, v130, v132
  v_max3_u32 v27, v27, v133, v134
  v_max3_u32 v27, v27, v135, v135
  v_cmp_eq_u32 vcc, -1, v27
  s_nop 1
  s_cbranch_vccnz sr_191
  s_branch sj_183
fx_185:
  s_cmp_eq_u32 s81, 1
  s_cbranch_scc1 fk_186
  s_mov_b32 s81, 1
  v_max3_f32 v164, v166, v167, v168
  v_max3_f32 v165, v169, v170, v171
  v_max_f32 v164, v164, v165
  s_nop 1
  v_max_f32_dpp v164, v164, v164 row_ror:8 row_mask:0xf bank_mask:0xf
  v_mov_b32 v165, v164
  s_nop 1
  v_permlane32_swap_b32 v164, v165
  v_max_f32 v164, v164, v165
  v_mov_b32 v165, v164
  s_nop 1
  v_permlane16_swap_b32 v164, v165
  v_max_f32 v164, v164, v165
  v_sub_f32 v166, v166, v164
  v_sub_f32 v167, v167, v164
  v_sub_f32 v168, v168, v164
  v_sub_f32 v169, v169, v164
  v_sub_f32 v170, v170, v164
  v_sub_f32 v171, v171, v164
  s_branch ex_184
last_178:
  v_smfmac_f32_16x16x64_bf16 v[100:103], v[56:59], a[96:103], v22
  v_smfmac_f32_16x16x64_bf16 v[96:99], v[60:63], a[24:31], v22
  v_smfmac_f32_16x16x64_bf16 v[96:99], v[64:67], a[32:39], v22
  v_smfmac_f32_16x16x64_bf16 v[96:99], v[68:71], a[40:47], v22
  v_smfmac_f32_16x16x64_bf16 v[96:99], v[72:75], a[48:55], v22
  v_smfmac_f32_16x16x64_bf16 v[96:99], v[76:79], a[56:63], v22
  v_smfmac_f32_16x16x64_bf16 v[96:99], v[80:83], a[64:71], v22
  v_smfmac_f32_16x16x64_bf16 v[96:99], v[84:87], a[72:79], v22
  v_smfmac_f32_16x16x64_bf16 v[100:103], v[60:63], a[104:111], v22
  v_smfmac_f32_16x16x64_bf16 v[100:103], v[64:67], a[112:119], v22
  v_smfmac_f32_16x16x64_bf16 v[100:103], v[68:71], a[120:127], v22
  v_smfmac_f32_16x16x64_bf16 v[100:103], v[72:75], a[128:135], v22
  v_smfmac_f32_16x16x64_bf16 v[100:103], v[76:79], a[136:143], v22
  v_smfmac_f32_16x16x64_bf16 v[100:103], v[80:83], a[144:151], v22
  v_smfmac_f32_16x16x64_bf16 v[100:103], v[84:87], a[152:159], v22
  s_nop 7
  v_permlane32_swap_b32 v96, v100
  v_permlane32_swap_b32 v97, v101
  v_permlane32_swap_b32 v98, v102
  v_permlane32_swap_b32 v99, v103
  v_pk_add_f32 v[96:97], v[96:97], v[100:101]
  v_pk_add_f32 v[98:99], v[98:99], v[102:103]
  v_cvt_pk_bf16_f32 v182, v96, v97
  v_cvt_pk_bf16_f32 v183, v98, v99
  v_min_u32 v182, -2, v182
  ds_write_b64 v26, v[182:183]
  v_permlane32_swap_b32 v88, v92
  v_permlane32_swap_b32 v89, v93
  v_permlane32_swap_b32 v90, v94
  v_permlane32_swap_b32 v91, v95
  v_pk_add_f32 v[88:89], v[88:89], v[92:93]
  v_pk_add_f32 v[90:91], v[90:91], v[94:95]
  v_cvt_pk_bf16_f32 v184, v88, v89
  v_cvt_pk_bf16_f32 v185, v90, v91
  v_min_u32 v184, -2, v184
  ds_write_b64 v43, v[184:185]
  s_waitcnt lgkmcnt(0)
  s_barrier
  ds_read_b128 v[170:173], v4 offset:16384
  ds_read_b128 v[174:177], v4 offset:17408
  ds_read_b128 v[178:181], v4 offset:18432
  v_min_u32 v104, -2, v104
  v_min_u32 v106, -2, v106
  v_min_u32 v108, -2, v108
  s_mov_b64 exec, s[68:69]
  buffer_store_dwordx4 v[104:107], v36, s[24:27], s70 offen sc1
  buffer_store_dwordx2 v[108:109], v37, s[24:27], s70 offen sc1
  s_mov_b64 exec, -1
  s_waitcnt lgkmcnt(0)
  buffer_store_dwordx4 v[170:173], v38, s[36:39], s71 offen sc1
  buffer_store_dwordx4 v[174:177], v39, s[36:39], s71 offen sc1
  s_mov_b64 exec, 0xffffffff
  buffer_store_dwordx4 v[178:181], v40, s[36:39], s71 offen sc1
  s_mov_b64 exec, -1
  s_add_u32 s70, s70, 98304
  s_add_u32 s71, s71, 327680
  s_waitcnt vmcnt(0)
  v_mov_b32 v166, 64
  s_mov_b64 exec, 1
  buffer_store_dword v166, v23, s[12:15], s77 offen sc1
  s_mov_b64 exec, -1
  s_branch chain_done
chain_done:
  s_waitcnt vmcnt(0) lgkmcnt(0)
  s_barrier
  s_mov_b32 s84, 0
  s_mov_b32 s85, -1
  s_mov_b32 s86, 0
  v_mov_b32 v21, 0
  v_mov_b32 v23, v247
  s_cmp_lg_u32 s20, 0
  s_cbranch_scc1 queue_b
  s_mov_b64 exec, 1
  s_branch queue_a
end0:
  s_endpgm
gemm_side:
  s_bfe_u32 s23, s22, 0x20005
  s_add_u32 s22, s22, 31
  s_and_b32 s22, s22, 31
  s_lshl_b32 s21, s23, 3
  s_add_u32 s2, s21, s22
  s_add_u32 s3, s2, 72
  s_add_u32 s24, s2, 48
  s_add_u32 s2, s2, s21
  s_cmp_lt_u32 s22, 24
  s_cselect_b32 s3, s24, s3
  s_cmp_lt_u32 s22, 16
  s_cselect_b32 s3, s2, s3
  s_mov_b32 s2, s3
  s_cmp_ge_u32 s3, 64
  s_cbranch_scc1 not_kv
  s_load_dwordx2 s[4:5], s[0:1], 0
  s_load_dwordx2 s[6:7], s[0:1], 24
  s_load_dwordx2 s[36:37], s[0:1], 32
  s_load_dwordx2 s[38:39], s[0:1], 104
  s_and_b32 s43, s3, 1
  s_bfe_u32 s42, s3, 0x50001
  s_lshr_b32 s40, s42, 2
  s_waitcnt lgkmcnt(0)
  s_cmp_eq_u32 s43, 1
  s_cselect_b32 s6, s36, s6
  s_cselect_b32 s7, s37, s7
  s_mov_b32 s8, s4
  s_mov_b32 s9, s5
  s_mov_b32 s10, 2621440
  s_mov_b32 s11, 0x00020000
  s_mov_b32 s12, s6
  s_mov_b32 s13, s7
  s_mov_b32 s14, 7864320
  s_mov_b32 s15, 0x00020000
  s_mov_b32 s16, s38
  s_mov_b32 s17, s39
  s_mov_b32 s18, 50331648
  s_mov_b32 s19, 0x00020000
  s_mul_i32 s44, s42, 384
  s_mov_b32 s24, 0
  s_mov_b32 s25, 81920
  s_mov_b32 s64, s32
  s_mov_b32 s65, s33
  s_mov_b32 s66, s34
  s_mov_b32 s67, s35
  s_load_dwordx2 s[72:73], s[0:1], 104
  s_waitcnt lgkmcnt(0)
  s_add_u32 s72, s72, 81068032
  s_addc_u32 s73, s73, 0
  s_mov_b32 s74, 115712
  s_mov_b32 s75, 0x00020000
  v_mov_b32 v9, 2731
  v_add_u32 v8, 0, v1
  v_mul_u32_u24 v7, v8, v9
  v_lshrrev_b32 v7, 16, v7
  v_mul_u32_u24 v4, 24, v7
  v_sub_u32 v8, v8, v4
  s_mov_b32 s21, 12288
  v_mul_lo_u32 v7, v7, s21
  v_lshl_add_u32 v4, v8, 4, v7
  v_add_u32 v8, 64, v1
  v_mul_u32_u24 v7, v8, v9
  v_lshrrev_b32 v7, 16, v7
  v_mul_u32_u24 v5, 24, v7
  v_sub_u32 v8, v8, v5
  s_mov_b32 s21, 12288
  v_mul_lo_u32 v7, v7, s21
  v_lshl_add_u32 v5, v8, 4, v7
  v_add_u32 v8, 128, v1
  v_mul_u32_u24 v7, v8, v9
  v_lshrrev_b32 v7, 16, v7
  v_mul_u32_u24 v6, 24, v7
  v_sub_u32 v8, v8, v6
  s_mov_b32 s21, 12288
  v_mul_lo_u32 v7, v7, s21
  v_lshl_add_u32 v6, v8, 4, v7
  v_lshrrev_b32 v7, 2, v2
  v_lshl_add_u32 v7, v3, 3, v7
  v_mul_u32_u24 v7, 384, v7
  v_and_b32 v8, 3, v2
  v_lshlrev_b32 v8, 3, v8
  s_mul_i32 s21, s20, 96
  v_add3_u32 v7, v7, v8, s21
  v_add_u32 v8, 49152, v7
  s_mul_i32 s21, s20, 393216
  s_add_u32 s21, s21, 0
  s_add_u32 s21, s21, s44
  s_mul_i32 s22, s20, 12288
  s_add_u32 s22, s22, 0
  s_add_u32 m0, s22, 0
  s_nop 0
  buffer_load_dwordx4 v4, s[12:15], s21 offen lds
  s_add_u32 m0, s22, 1024
  s_nop 0
  buffer_load_dwordx4 v5, s[12:15], s21 offen lds
  s_add_u32 m0, s22, 2048
  s_nop 0
  buffer_load_dwordx4 v6, s[12:15], s21 offen lds
  s_mul_i32 s21, s20, 393216
  s_add_u32 s21, s21, 98304
  s_add_u32 s21, s21, s44
  s_mul_i32 s22, s20, 12288
  s_add_u32 s22, s22, 3072
  s_add_u32 m0, s22, 0
  s_nop 0
  buffer_load_dwordx4 v4, s[12:15], s21 offen lds
  s_add_u32 m0, s22, 1024
  s_nop 0
  buffer_load_dwordx4 v5, s[12:15], s21 offen lds
  s_add_u32 m0, s22, 2048
  s_nop 0
  buffer_load_dwordx4 v6, s[12:15], s21 offen lds
  s_mul_i32 s21, s20, 393216
  s_add_u32 s21, s21, 196608
  s_add_u32 s21, s21, s44
  s_mul_i32 s22, s20, 12288
  s_add_u32 s22, s22, 6144
  s_add_u32 m0, s22, 0
  s_nop 0
  buffer_load_dwordx4 v4, s[12:15], s21 offen lds
  s_add_u32 m0, s22, 1024
  s_nop 0
  buffer_load_dwordx4 v5, s[12:15], s21 offen lds
  s_add_u32 m0, s22, 2048
  s_nop 0
  buffer_load_dwordx4 v6, s[12:15], s21 offen lds
  s_mul_i32 s21, s20, 393216
  s_add_u32 s21, s21, 294912
  s_add_u32 s21, s21, s44
  s_mul_i32 s22, s20, 12288
  s_add_u32 s22, s22, 9216
  s_add_u32 m0, s22, 0
  s_nop 0
  buffer_load_dwordx4 v4, s[12:15], s21 offen lds
  s_add_u32 m0, s22, 1024
  s_nop 0
  buffer_load_dwordx4 v5, s[12:15], s21 offen lds
  s_add_u32 m0, s22, 2048
  s_nop 0
  buffer_load_dwordx4 v6, s[12:15], s21 offen lds
  v_lshrrev_b32 v11, 3, v1
  v_and_b32 v12, 7, v1
  v_xor_b32 v12, v12, v11
  v_mul_u32_u24 v11, 1280, v11
  v_lshl_add_u32 v10, v12, 4, v11
  s_mov_b32 s30, s24
  s_mov_b32 s31, 0
  s_mov_b32 s32, 98304
  s_mul_i32 s46, s20, 20480
  s_add_u32 s46, s46, s30
  s_lshl_b32 s47, s20, 11
  s_add_u32 s47, s47, s32
  s_add_u32 m0, s47, 0
  s_nop 0
  buffer_load_dwordx4 v10, s[8:11], s46 offen lds
  s_add_u32 s46, s46, 10240
  s_add_u32 m0, s47, 1024
  s_nop 0
  buffer_load_dwordx4 v10, s[8:11], s46 offen lds
  s_add_u32 s30, s30, 128
  s_add_u32 s31, s31, 1
  s_cmp_lt_u32 s31, 10
  s_cbranch_scc1 kvm_193
  s_mov_b32 s31, 0
  s_add_u32 s30, s30, s25
  s_sub_u32 s30, s30, 1280
kvm_193:
  s_add_u32 s32, s32, 8192
  s_cmp_lt_u32 s32, 155648
  s_cselect_b32 s32, s32, 98304
  s_mul_i32 s46, s20, 20480
  s_add_u32 s46, s46, s30
  s_lshl_b32 s47, s20, 11
  s_add_u32 s47, s47, s32
  s_add_u32 m0, s47, 0
  s_nop 0
  buffer_load_dwordx4 v10, s[8:11], s46 offen lds
  s_add_u32 s46, s46, 10240
  s_add_u32 m0, s47, 1024
  s_nop 0
  buffer_load_dwordx4 v10, s[8:11], s46 offen lds
  s_add_u32 s30, s30, 128
  s_add_u32 s31, s31, 1
  s_cmp_lt_u32 s31, 10
  s_cbranch_scc1 kvm_194
  s_mov_b32 s31, 0
  s_add_u32 s30, s30, s25
  s_sub_u32 s30, s30, 1280
kvm_194:
  s_add_u32 s32, s32, 8192
  s_cmp_lt_u32 s32, 155648
  s_cselect_b32 s32, s32, 98304
  s_mul_i32 s46, s20, 20480
  s_add_u32 s46, s46, s30
  s_lshl_b32 s47, s20, 11
  s_add_u32 s47, s47, s32
  s_add_u32 m0, s47, 0
  s_nop 0
  buffer_load_dwordx4 v10, s[8:11], s46 offen lds
  s_add_u32 s46, s46, 10240
  s_add_u32 m0, s47, 1024
  s_nop 0
  buffer_load_dwordx4 v10, s[8:11], s46 offen lds
  s_add_u32 s30, s30, 128
  s_add_u32 s31, s31, 1
  s_cmp_lt_u32 s31, 10
  s_cbranch_scc1 kvm_195
  s_mov_b32 s31, 0
  s_add_u32 s30, s30, s25
  s_sub_u32 s30, s30, 1280
kvm_195:
  s_add_u32 s32, s32, 8192
  s_cmp_lt_u32 s32, 155648
  s_cselect_b32 s32, s32, 98304
  s_mul_i32 s46, s20, 20480
  s_add_u32 s46, s46, s30
  s_lshl_b32 s47, s20, 11
  s_add_u32 s47, s47, s32
  s_add_u32 m0, s47, 0
  s_nop 0
  buffer_load_dwordx4 v10, s[8:11], s46 offen lds
  s_add_u32 s46, s46, 10240
  s_add_u32 m0, s47, 1024
  s_nop 0
  buffer_load_dwordx4 v10, s[8:11], s46 offen lds
  s_add_u32 s30, s30, 128
  s_add_u32 s31, s31, 1
  s_cmp_lt_u32 s31, 10
  s_cbranch_scc1 kvm_196
  s_mov_b32 s31, 0
  s_add_u32 s30, s30, s25
  s_sub_u32 s30, s30, 1280
kvm_196:
  s_add_u32 s32, s32, 8192
  s_cmp_lt_u32 s32, 155648
  s_cselect_b32 s32, s32, 98304
  s_mul_i32 s46, s20, 20480
  s_add_u32 s46, s46, s30
  s_lshl_b32 s47, s20, 11
  s_add_u32 s47, s47, s32
  s_add_u32 m0, s47, 0
  s_nop 0
  buffer_load_dwordx4 v10, s[8:11], s46 offen lds
  s_add_u32 s46, s46, 10240
  s_add_u32 m0, s47, 1024
  s_nop 0
  buffer_load_dwordx4 v10, s[8:11], s46 offen lds
  s_add_u32 s30, s30, 128
  s_add_u32 s31, s31, 1
  s_cmp_lt_u32 s31, 10
  s_cbranch_scc1 kvm_197
  s_mov_b32 s31, 0
  s_add_u32 s30, s30, s25
  s_sub_u32 s30, s30, 1280
kvm_197:
  s_add_u32 s32, s32, 8192
  s_cmp_lt_u32 s32, 155648
  s_cselect_b32 s32, s32, 98304
  s_mul_i32 s21, s20, 393216
  s_add_u32 s21, s21, 1572864
  s_add_u32 s21, s21, s44
  s_mul_i32 s22, s20, 12288
  s_add_u32 s22, s22, 49152
  s_add_u32 m0, s22, 0
  s_nop 0
  buffer_load_dwordx4 v4, s[12:15], s21 offen lds
  s_add_u32 m0, s22, 1024
  s_nop 0
  buffer_load_dwordx4 v5, s[12:15], s21 offen lds
  s_add_u32 m0, s22, 2048
  s_nop 0
  buffer_load_dwordx4 v6, s[12:15], s21 offen lds
  s_mul_i32 s21, s20, 393216
  s_add_u32 s21, s21, 1671168
  s_add_u32 s21, s21, s44
  s_mul_i32 s22, s20, 12288
  s_add_u32 s22, s22, 52224
  s_add_u32 m0, s22, 0
  s_nop 0
  buffer_load_dwordx4 v4, s[12:15], s21 offen lds
  s_add_u32 m0, s22, 1024
  s_nop 0
  buffer_load_dwordx4 v5, s[12:15], s21 offen lds
  s_add_u32 m0, s22, 2048
  s_nop 0
  buffer_load_dwordx4 v6, s[12:15], s21 offen lds
  s_mul_i32 s21, s20, 393216
  s_add_u32 s21, s21, 1769472
  s_add_u32 s21, s21, s44
  s_mul_i32 s22, s20, 12288
  s_add_u32 s22, s22, 55296
  s_add_u32 m0, s22, 0
  s_nop 0
  buffer_load_dwordx4 v4, s[12:15], s21 offen lds
  s_add_u32 m0, s22, 1024
  s_nop 0
  buffer_load_dwordx4 v5, s[12:15], s21 offen lds
  s_add_u32 m0, s22, 2048
  s_nop 0
  buffer_load_dwordx4 v6, s[12:15], s21 offen lds
  s_mul_i32 s21, s20, 393216
  s_add_u32 s21, s21, 1867776
  s_add_u32 s21, s21, s44
  s_mul_i32 s22, s20, 12288
  s_add_u32 s22, s22, 58368
  s_add_u32 m0, s22, 0
  s_nop 0
  buffer_load_dwordx4 v4, s[12:15], s21 offen lds
  s_add_u32 m0, s22, 1024
  s_nop 0
  buffer_load_dwordx4 v5, s[12:15], s21 offen lds
  s_add_u32 m0, s22, 2048
  s_nop 0
  buffer_load_dwordx4 v6, s[12:15], s21 offen lds
  s_waitcnt vmcnt(12)
  s_barrier
  ds_read_b64_tr_b16 a[0:1], v7 offset:0
  ds_read_b64_tr_b16 a[2:3], v7 offset:1536
  ds_read_b64_tr_b16 a[4:5], v7 offset:32
  ds_read_b64_tr_b16 a[6:7], v7 offset:1568
  ds_read_b64_tr_b16 a[8:9], v7 offset:64
  ds_read_b64_tr_b16 a[10:11], v7 offset:1600
  ds_read_b64_tr_b16 a[12:13], v7 offset:12288
  ds_read_b64_tr_b16 a[14:15], v7 offset:13824
  ds_read_b64_tr_b16 a[16:17], v7 offset:12320
  ds_read_b64_tr_b16 a[18:19], v7 offset:13856
  ds_read_b64_tr_b16 a[20:21], v7 offset:12352
  ds_read_b64_tr_b16 a[22:23], v7 offset:13888
  ds_read_b64_tr_b16 a[24:25], v7 offset:24576
  ds_read_b64_tr_b16 a[26:27], v7 offset:26112
  ds_read_b64_tr_b16 a[28:29], v7 offset:24608
  ds_read_b64_tr_b16 a[30:31], v7 offset:26144
  ds_read_b64_tr_b16 a[32:33], v7 offset:24640
  ds_read_b64_tr_b16 a[34:35], v7 offset:26176
  ds_read_b64_tr_b16 a[36:37], v7 offset:36864
  ds_read_b64_tr_b16 a[38:39], v7 offset:38400
  ds_read_b64_tr_b16 a[40:41], v7 offset:36896
  ds_read_b64_tr_b16 a[42:43], v7 offset:38432
  ds_read_b64_tr_b16 a[44:45], v7 offset:36928
  ds_read_b64_tr_b16 a[46:47], v7 offset:38464
  s_waitcnt lgkmcnt(0)
  s_barrier
  s_mul_i32 s21, s20, 393216
  s_add_u32 s21, s21, 3145728
  s_add_u32 s21, s21, s44
  s_mul_i32 s22, s20, 12288
  s_add_u32 s22, s22, 0
  s_add_u32 m0, s22, 0
  s_nop 0
  buffer_load_dwordx4 v4, s[12:15], s21 offen lds
  s_add_u32 m0, s22, 1024
  s_nop 0
  buffer_load_dwordx4 v5, s[12:15], s21 offen lds
  s_add_u32 m0, s22, 2048
  s_nop 0
  buffer_load_dwordx4 v6, s[12:15], s21 offen lds
  s_mul_i32 s21, s20, 393216
  s_add_u32 s21, s21, 3244032
  s_add_u32 s21, s21, s44
  s_mul_i32 s22, s20, 12288
  s_add_u32 s22, s22, 3072
  s_add_u32 m0, s22, 0
  s_nop 0
  buffer_load_dwordx4 v4, s[12:15], s21 offen lds
  s_add_u32 m0, s22, 1024
  s_nop 0
  buffer_load_dwordx4 v5, s[12:15], s21 offen lds
  s_add_u32 m0, s22, 2048
  s_nop 0
  buffer_load_dwordx4 v6, s[12:15], s21 offen lds
  s_mul_i32 s21, s20, 393216
  s_add_u32 s21, s21, 3342336
  s_add_u32 s21, s21, s44
  s_mul_i32 s22, s20, 12288
  s_add_u32 s22, s22, 6144
  s_add_u32 m0, s22, 0
  s_nop 0
  buffer_load_dwordx4 v4, s[12:15], s21 offen lds
  s_add_u32 m0, s22, 1024
  s_nop 0
  buffer_load_dwordx4 v5, s[12:15], s21 offen lds
  s_add_u32 m0, s22, 2048
  s_nop 0
  buffer_load_dwordx4 v6, s[12:15], s21 offen lds
  s_mul_i32 s21, s20, 393216
  s_add_u32 s21, s21, 3440640
  s_add_u32 s21, s21, s44
  s_mul_i32 s22, s20, 12288
  s_add_u32 s22, s22, 9216
  s_add_u32 m0, s22, 0
  s_nop 0
  buffer_load_dwordx4 v4, s[12:15], s21 offen lds
  s_add_u32 m0, s22, 1024
  s_nop 0
  buffer_load_dwordx4 v5, s[12:15], s21 offen lds
  s_add_u32 m0, s22, 2048
  s_nop 0
  buffer_load_dwordx4 v6, s[12:15], s21 offen lds
  s_waitcnt vmcnt(12)
  s_barrier
  ds_read_b64_tr_b16 a[48:49], v8 offset:0
  ds_read_b64_tr_b16 a[50:51], v8 offset:1536
  ds_read_b64_tr_b16 a[52:53], v8 offset:32
  ds_read_b64_tr_b16 a[54:55], v8 offset:1568
  ds_read_b64_tr_b16 a[56:57], v8 offset:64
  ds_read_b64_tr_b16 a[58:59], v8 offset:1600
  ds_read_b64_tr_b16 a[60:61], v8 offset:12288
  ds_read_b64_tr_b16 a[62:63], v8 offset:13824
  ds_read_b64_tr_b16 a[64:65], v8 offset:12320
  ds_read_b64_tr_b16 a[66:67], v8 offset:13856
  ds_read_b64_tr_b16 a[68:69], v8 offset:12352
  ds_read_b64_tr_b16 a[70:71], v8 offset:13888
  ds_read_b64_tr_b16 a[72:73], v8 offset:24576
  ds_read_b64_tr_b16 a[74:75], v8 offset:26112
  ds_read_b64_tr_b16 a[76:77], v8 offset:24608
  ds_read_b64_tr_b16 a[78:79], v8 offset:26144
  ds_read_b64_tr_b16 a[80:81], v8 offset:24640
  ds_read_b64_tr_b16 a[82:83], v8 offset:26176
  ds_read_b64_tr_b16 a[84:85], v8 offset:36864
  ds_read_b64_tr_b16 a[86:87], v8 offset:38400
  ds_read_b64_tr_b16 a[88:89], v8 offset:36896
  ds_read_b64_tr_b16 a[90:91], v8 offset:38432
  ds_read_b64_tr_b16 a[92:93], v8 offset:36928
  ds_read_b64_tr_b16 a[94:95], v8 offset:38464
  s_waitcnt lgkmcnt(0)
  s_barrier
  s_mul_i32 s21, s20, 393216
  s_add_u32 s21, s21, 4718592
  s_add_u32 s21, s21, s44
  s_mul_i32 s22, s20, 12288
  s_add_u32 s22, s22, 49152
  s_add_u32 m0, s22, 0
  s_nop 0
  buffer_load_dwordx4 v4, s[12:15], s21 offen lds
  s_add_u32 m0, s22, 1024
  s_nop 0
  buffer_load_dwordx4 v5, s[12:15], s21 offen lds
  s_add_u32 m0, s22, 2048
  s_nop 0
  buffer_load_dwordx4 v6, s[12:15], s21 offen lds
  s_mul_i32 s21, s20, 393216
  s_add_u32 s21, s21, 4816896
  s_add_u32 s21, s21, s44
  s_mul_i32 s22, s20, 12288
  s_add_u32 s22, s22, 52224
  s_add_u32 m0, s22, 0
  s_nop 0
  buffer_load_dwordx4 v4, s[12:15], s21 offen lds
  s_add_u32 m0, s22, 1024
  s_nop 0
  buffer_load_dwordx4 v5, s[12:15], s21 offen lds
  s_add_u32 m0, s22, 2048
  s_nop 0
  buffer_load_dwordx4 v6, s[12:15], s21 offen lds
  s_mul_i32 s21, s20, 393216
  s_add_u32 s21, s21, 4915200
  s_add_u32 s21, s21, s44
  s_mul_i32 s22, s20, 12288
  s_add_u32 s22, s22, 55296
  s_add_u32 m0, s22, 0
  s_nop 0
  buffer_load_dwordx4 v4, s[12:15], s21 offen lds
  s_add_u32 m0, s22, 1024
  s_nop 0
  buffer_load_dwordx4 v5, s[12:15], s21 offen lds
  s_add_u32 m0, s22, 2048
  s_nop 0
  buffer_load_dwordx4 v6, s[12:15], s21 offen lds
  s_mul_i32 s21, s20, 393216
  s_add_u32 s21, s21, 5013504
  s_add_u32 s21, s21, s44
  s_mul_i32 s22, s20, 12288
  s_add_u32 s22, s22, 58368
  s_add_u32 m0, s22, 0
  s_nop 0
  buffer_load_dwordx4 v4, s[12:15], s21 offen lds
  s_add_u32 m0, s22, 1024
  s_nop 0
  buffer_load_dwordx4 v5, s[12:15], s21 offen lds
  s_add_u32 m0, s22, 2048
  s_nop 0
  buffer_load_dwordx4 v6, s[12:15], s21 offen lds
  v_mov_b32 v29, 76
  buffer_load_dword v29, v29, s[64:67], 0 offen sc1
  s_waitcnt vmcnt(12)
  s_barrier
  ds_read_b64_tr_b16 a[96:97], v7 offset:0
  ds_read_b64_tr_b16 a[98:99], v7 offset:1536
  ds_read_b64_tr_b16 a[100:101], v7 offset:32
  ds_read_b64_tr_b16 a[102:103], v7 offset:1568
  ds_read_b64_tr_b16 a[104:105], v7 offset:64
  ds_read_b64_tr_b16 a[106:107], v7 offset:1600
  ds_read_b64_tr_b16 a[108:109], v7 offset:12288
  ds_read_b64_tr_b16 a[110:111], v7 offset:13824
  ds_read_b64_tr_b16 a[112:113], v7 offset:12320
  ds_read_b64_tr_b16 a[114:115], v7 offset:13856
  ds_read_b64_tr_b16 a[116:117], v7 offset:12352
  ds_read_b64_tr_b16 a[118:119], v7 offset:13888
  ds_read_b64_tr_b16 a[120:121], v7 offset:24576
  ds_read_b64_tr_b16 a[122:123], v7 offset:26112
  ds_read_b64_tr_b16 a[124:125], v7 offset:24608
  ds_read_b64_tr_b16 a[126:127], v7 offset:26144
  ds_read_b64_tr_b16 a[128:129], v7 offset:24640
  ds_read_b64_tr_b16 a[130:131], v7 offset:26176
  ds_read_b64_tr_b16 a[132:133], v7 offset:36864
  ds_read_b64_tr_b16 a[134:135], v7 offset:38400
  ds_read_b64_tr_b16 a[136:137], v7 offset:36896
  ds_read_b64_tr_b16 a[138:139], v7 offset:38432
  ds_read_b64_tr_b16 a[140:141], v7 offset:36928
  ds_read_b64_tr_b16 a[142:143], v7 offset:38464
  s_waitcnt lgkmcnt(0)
  s_barrier
  s_mul_i32 s21, s20, 393216
  s_add_u32 s21, s21, 6291456
  s_add_u32 s21, s21, s44
  s_mul_i32 s22, s20, 12288
  s_add_u32 s22, s22, 0
  s_add_u32 m0, s22, 0
  s_nop 0
  buffer_load_dwordx4 v4, s[12:15], s21 offen lds
  s_add_u32 m0, s22, 1024
  s_nop 0
  buffer_load_dwordx4 v5, s[12:15], s21 offen lds
  s_add_u32 m0, s22, 2048
  s_nop 0
  buffer_load_dwordx4 v6, s[12:15], s21 offen lds
  s_mul_i32 s21, s20, 393216
  s_add_u32 s21, s21, 6389760
  s_add_u32 s21, s21, s44
  s_mul_i32 s22, s20, 12288
  s_add_u32 s22, s22, 3072
  s_add_u32 m0, s22, 0
  s_nop 0
  buffer_load_dwordx4 v4, s[12:15], s21 offen lds
  s_add_u32 m0, s22, 1024
  s_nop 0
  buffer_load_dwordx4 v5, s[12:15], s21 offen lds
  s_add_u32 m0, s22, 2048
  s_nop 0
  buffer_load_dwordx4 v6, s[12:15], s21 offen lds
  s_mul_i32 s21, s20, 393216
  s_add_u32 s21, s21, 6488064
  s_add_u32 s21, s21, s44
  s_mul_i32 s22, s20, 12288
  s_add_u32 s22, s22, 6144
  s_add_u32 m0, s22, 0
  s_nop 0
  buffer_load_dwordx4 v4, s[12:15], s21 offen lds
  s_add_u32 m0, s22, 1024
  s_nop 0
  buffer_load_dwordx4 v5, s[12:15], s21 offen lds
  s_add_u32 m0, s22, 2048
  s_nop 0
  buffer_load_dwordx4 v6, s[12:15], s21 offen lds
  s_mul_i32 s21, s20, 393216
  s_add_u32 s21, s21, 6586368
  s_add_u32 s21, s21, s44
  s_mul_i32 s22, s20, 12288
  s_add_u32 s22, s22, 9216
  s_add_u32 m0, s22, 0
  s_nop 0
  buffer_load_dwordx4 v4, s[12:15], s21 offen lds
  s_add_u32 m0, s22, 1024
  s_nop 0
  buffer_load_dwordx4 v5, s[12:15], s21 offen lds
  s_add_u32 m0, s22, 2048
  s_nop 0
  buffer_load_dwordx4 v6, s[12:15], s21 offen lds
  s_waitcnt vmcnt(12)
  s_barrier
  ds_read_b64_tr_b16 a[144:145], v8 offset:0
  ds_read_b64_tr_b16 a[146:147], v8 offset:1536
  ds_read_b64_tr_b16 a[148:149], v8 offset:32
  ds_read_b64_tr_b16 a[150:151], v8 offset:1568
  ds_read_b64_tr_b16 a[152:153], v8 offset:64
  ds_read_b64_tr_b16 a[154:155], v8 offset:1600
  ds_read_b64_tr_b16 a[156:157], v8 offset:12288
  ds_read_b64_tr_b16 a[158:159], v8 offset:13824
  ds_read_b64_tr_b16 a[160:161], v8 offset:12320
  ds_read_b64_tr_b16 a[162:163], v8 offset:13856
  ds_read_b64_tr_b16 a[164:165], v8 offset:12352
  ds_read_b64_tr_b16 a[166:167], v8 offset:13888
  ds_read_b64_tr_b16 a[168:169], v8 offset:24576
  ds_read_b64_tr_b16 a[170:171], v8 offset:26112
  ds_read_b64_tr_b16 a[172:173], v8 offset:24608
  ds_read_b64_tr_b16 a[174:175], v8 offset:26144
  ds_read_b64_tr_b16 a[176:177], v8 offset:24640
  ds_read_b64_tr_b16 a[178:179], v8 offset:26176
  ds_read_b64_tr_b16 a[180:181], v8 offset:36864
  ds_read_b64_tr_b16 a[182:183], v8 offset:38400
  ds_read_b64_tr_b16 a[184:185], v8 offset:36896
  ds_read_b64_tr_b16 a[186:187], v8 offset:38432
  ds_read_b64_tr_b16 a[188:189], v8 offset:36928
  ds_read_b64_tr_b16 a[190:191], v8 offset:38464
  s_waitcnt lgkmcnt(0)
  s_barrier
  s_waitcnt vmcnt(0)
  s_barrier
  ds_read_b64_tr_b16 a[192:193], v7 offset:0
  ds_read_b64_tr_b16 a[194:195], v7 offset:1536
  ds_read_b64_tr_b16 a[196:197], v7 offset:32
  ds_read_b64_tr_b16 a[198:199], v7 offset:1568
  ds_read_b64_tr_b16 a[200:201], v7 offset:64
  ds_read_b64_tr_b16 a[202:203], v7 offset:1600
  ds_read_b64_tr_b16 a[204:205], v7 offset:12288
  ds_read_b64_tr_b16 a[206:207], v7 offset:13824
  ds_read_b64_tr_b16 a[208:209], v7 offset:12320
  ds_read_b64_tr_b16 a[210:211], v7 offset:13856
  ds_read_b64_tr_b16 a[212:213], v7 offset:12352
  ds_read_b64_tr_b16 a[214:215], v7 offset:13888
  ds_read_b64_tr_b16 a[216:217], v7 offset:24576
  ds_read_b64_tr_b16 a[218:219], v7 offset:26112
  ds_read_b64_tr_b16 a[220:221], v7 offset:24608
  ds_read_b64_tr_b16 a[222:223], v7 offset:26144
  ds_read_b64_tr_b16 a[224:225], v7 offset:24640
  ds_read_b64_tr_b16 a[226:227], v7 offset:26176
  ds_read_b64_tr_b16 a[228:229], v7 offset:36864
  ds_read_b64_tr_b16 a[230:231], v7 offset:38400
  ds_read_b64_tr_b16 a[232:233], v7 offset:36896
  ds_read_b64_tr_b16 a[234:235], v7 offset:38432
  ds_read_b64_tr_b16 a[236:237], v7 offset:36928
  ds_read_b64_tr_b16 a[238:239], v7 offset:38464
  s_waitcnt lgkmcnt(0)
  s_barrier
  s_mov_b32 s26, 4
  s_mul_i32 s27, s42, 12288
  s_mul_i32 s21, s43, 25165824
  s_add_u32 s27, s27, s21
  s_mov_b32 s28, 786432
  v_readfirstlane_b32 s21, v29
  s_cmp_lg_u32 s21, 0
  s_cbranch_scc1 kvz_198
  s_mov_b32 s21, 76
  v_mov_b32 v4, 0
  s_mov_b32 s101, 0
wf_199:
  buffer_load_dword v5, v4, s[64:67], s21 offen sc1
  s_add_u32 s101, s101, 1
  s_cmp_gt_u32 s101, 131072
  s_cbranch_scc1 main_end
  s_waitcnt vmcnt(0)
  v_readfirstlane_b32 s100, v5
  s_cmp_ge_u32 s100, 1
  s_cbranch_scc1 wf_200
  s_sleep 8
  s_branch wf_199
wf_200:
kvz_198:
  s_lshl_b32 s60, s40, 7
  s_add_u32 s60, s60, 0
  s_mov_b32 s61, 0
  v_and_b32 v6, 7, v2
  v_add_u32 v4, 0, v3
  v_xor_b32 v4, v4, v6
  v_lshlrev_b32 v4, 4, v4
  v_lshl_add_u32 v14, v2, 7, v4
  v_add_u32 v4, 4, v3
  v_xor_b32 v4, v4, v6
  v_lshlrev_b32 v4, 4, v4
  v_lshl_add_u32 v15, v2, 7, v4
  v_mul_u32_u24 v22, 400, v2
  v_mul_u32_u24 v4, 24, v3
  s_mul_i32 s21, s20, 96
  s_add_u32 s21, s21, 0
  v_add3_u32 v22, v22, v4, s21
  v_mov_b32 v9, 2731
  s_mul_i32 s21, s20, 6400
  s_add_u32 s21, s21, 0
  v_mul_u32_u24 v4, 400, v2
  v_lshlrev_b32 v5, 4, v3
  v_add3_u32 v23, v4, v5, s21
  v_lshlrev_b32 v26, 4, v1
  s_mov_b32 s33, 98304
  s_mov_b32 s48, 0x80000000
  s_mul_i32 s46, s20, 20480
  s_add_u32 s46, s46, s30
  s_lshl_b32 s47, s20, 11
  s_add_u32 s47, s47, s32
  s_add_u32 m0, s47, 0
  s_nop 0
  buffer_load_dwordx4 v10, s[8:11], s46 offen lds
  s_waitcnt vmcnt(9)
  s_barrier
  v_add_u32 v18, s33, v14
  v_add_u32 v19, s33, v15
  s_add_u32 s33, s33, 8192
  s_cmp_lt_u32 s33, 155648
  s_cselect_b32 s33, s33, 98304
  ds_read_b128 v[160:163], v18 offset:0
  ds_read_b128 v[164:167], v18 offset:2048
  ds_read_b128 v[168:171], v18 offset:4096
  ds_read_b128 v[172:175], v18 offset:6144
kvm_blk_201:
  ds_read_b128 v[192:195], v19 offset:0
  s_waitcnt lgkmcnt(4)
  v_mfma_f32_16x16x32_bf16 v[64:67], a[0:3], v[160:163], 0
  v_mfma_f32_16x16x32_bf16 v[68:71], a[4:7], v[160:163], 0
  v_mfma_f32_16x16x32_bf16 v[72:75], a[8:11], v[160:163], 0
  ds_read_b128 v[196:199], v19 offset:2048
  s_waitcnt lgkmcnt(4)
  v_mfma_f32_16x16x32_bf16 v[76:79], a[0:3], v[164:167], 0
  v_mfma_f32_16x16x32_bf16 v[80:83], a[4:7], v[164:167], 0
  v_mfma_f32_16x16x32_bf16 v[84:87], a[8:11], v[164:167], 0
  s_add_u32 s46, s46, 10240
  s_add_u32 m0, s47, 1024
  s_nop 0
  buffer_load_dwordx4 v10, s[8:11], s46 offen lds
  ds_read_b128 v[200:203], v19 offset:4096
  s_waitcnt lgkmcnt(4)
  v_mfma_f32_16x16x32_bf16 v[88:91], a[0:3], v[168:171], 0
  v_mfma_f32_16x16x32_bf16 v[92:95], a[4:7], v[168:171], 0
  v_mfma_f32_16x16x32_bf16 v[96:99], a[8:11], v[168:171], 0
  ds_read_b128 v[204:207], v19 offset:6144
  s_waitcnt lgkmcnt(4)
  v_mfma_f32_16x16x32_bf16 v[100:103], a[0:3], v[172:175], 0
  v_mfma_f32_16x16x32_bf16 v[104:107], a[4:7], v[172:175], 0
  v_mfma_f32_16x16x32_bf16 v[108:111], a[8:11], v[172:175], 0
  s_waitcnt vmcnt(8)
  s_barrier
  s_add_u32 s30, s30, 128
  s_add_u32 s31, s31, 1
  s_cmp_lt_u32 s31, 10
  s_cbranch_scc1 kvm_202
  s_mov_b32 s31, 0
  s_add_u32 s30, s30, s25
  s_sub_u32 s30, s30, 1280
kvm_202:
  s_add_u32 s32, s32, 8192
  s_cmp_lt_u32 s32, 155648
  s_cselect_b32 s32, s32, 98304
  s_mul_i32 s46, s20, 20480
  s_add_u32 s46, s46, s30
  s_lshl_b32 s47, s20, 11
  s_add_u32 s47, s47, s32
  v_add_u32 v18, s33, v14
  v_add_u32 v19, s33, v15
  s_add_u32 s33, s33, 8192
  s_cmp_lt_u32 s33, 155648
  s_cselect_b32 s33, s33, 98304
  ds_read_b128 v[160:163], v18 offset:0
  s_waitcnt lgkmcnt(4)
  v_mfma_f32_16x16x32_bf16 v[64:67], a[12:15], v[192:195], v[64:67]
  v_mfma_f32_16x16x32_bf16 v[68:71], a[16:19], v[192:195], v[68:71]
  v_mfma_f32_16x16x32_bf16 v[72:75], a[20:23], v[192:195], v[72:75]
  ds_read_b128 v[224:227], v23 offset:0
  ds_read_b128 v[164:167], v18 offset:2048
  s_waitcnt lgkmcnt(4)
  v_mfma_f32_16x16x32_bf16 v[76:79], a[12:15], v[196:199], v[76:79]
  v_mfma_f32_16x16x32_bf16 v[80:83], a[16:19], v[196:199], v[80:83]
  v_mfma_f32_16x16x32_bf16 v[84:87], a[20:23], v[196:199], v[84:87]
  s_add_u32 m0, s47, 0
  s_nop 0
  buffer_load_dwordx4 v10, s[8:11], s46 offen lds
  ds_read_b128 v[228:231], v23 offset:64
  ds_read_b128 v[168:171], v18 offset:4096
  s_waitcnt lgkmcnt(4)
  v_mfma_f32_16x16x32_bf16 v[88:91], a[12:15], v[200:203], v[88:91]
  v_mfma_f32_16x16x32_bf16 v[92:95], a[16:19], v[200:203], v[92:95]
  v_mfma_f32_16x16x32_bf16 v[96:99], a[20:23], v[200:203], v[96:99]
  ds_read_b128 v[172:175], v18 offset:6144
  s_waitcnt lgkmcnt(4)
  v_mfma_f32_16x16x32_bf16 v[100:103], a[12:15], v[204:207], v[100:103]
  v_mfma_f32_16x16x32_bf16 v[104:107], a[16:19], v[204:207], v[104:107]
  v_mfma_f32_16x16x32_bf16 v[108:111], a[20:23], v[204:207], v[108:111]
  ds_read_b128 v[192:195], v19 offset:0
  s_waitcnt lgkmcnt(4)
  v_mfma_f32_16x16x32_bf16 v[64:67], a[24:27], v[160:163], v[64:67]
  v_mfma_f32_16x16x32_bf16 v[68:71], a[28:31], v[160:163], v[68:71]
  v_mfma_f32_16x16x32_bf16 v[72:75], a[32:35], v[160:163], v[72:75]
  ds_read_b128 v[232:235], v23 offset:128
  ds_read_b128 v[196:199], v19 offset:2048
  s_waitcnt lgkmcnt(4)
  v_mfma_f32_16x16x32_bf16 v[76:79], a[24:27], v[164:167], v[76:79]
  v_mfma_f32_16x16x32_bf16 v[80:83], a[28:31], v[164:167], v[80:83]
  v_mfma_f32_16x16x32_bf16 v[84:87], a[32:35], v[164:167], v[84:87]
  s_add_u32 s46, s46, 10240
  s_add_u32 m0, s47, 1024
  s_nop 0
  buffer_load_dwordx4 v10, s[8:11], s46 offen lds
  ds_read_b128 v[236:239], v23 offset:192
  ds_read_b128 v[200:203], v19 offset:4096
  s_waitcnt lgkmcnt(4)
  v_mfma_f32_16x16x32_bf16 v[88:91], a[24:27], v[168:171], v[88:91]
  v_mfma_f32_16x16x32_bf16 v[92:95], a[28:31], v[168:171], v[92:95]
  v_mfma_f32_16x16x32_bf16 v[96:99], a[32:35], v[168:171], v[96:99]
  s_add_u32 s21, s48, 0
  buffer_store_dwordx4 v[224:227], v26, s[16:19], s21 offen offset:0 sc1
  ds_read_b128 v[204:207], v19 offset:6144
  s_waitcnt lgkmcnt(4)
  v_mfma_f32_16x16x32_bf16 v[100:103], a[24:27], v[172:175], v[100:103]
  v_mfma_f32_16x16x32_bf16 v[104:107], a[28:31], v[172:175], v[104:107]
  v_mfma_f32_16x16x32_bf16 v[108:111], a[32:35], v[172:175], v[108:111]
  s_add_u32 s21, s48, 0
  buffer_store_dwordx4 v[228:231], v26, s[16:19], s21 offen offset:1024 sc1
  s_waitcnt vmcnt(10)
  s_barrier
  s_add_u32 s30, s30, 128
  s_add_u32 s31, s31, 1
  s_cmp_lt_u32 s31, 10
  s_cbranch_scc1 kvm_203
  s_mov_b32 s31, 0
  s_add_u32 s30, s30, s25
  s_sub_u32 s30, s30, 1280
kvm_203:
  s_add_u32 s32, s32, 8192
  s_cmp_lt_u32 s32, 155648
  s_cselect_b32 s32, s32, 98304
  s_mul_i32 s46, s20, 20480
  s_add_u32 s46, s46, s30
  s_lshl_b32 s47, s20, 11
  s_add_u32 s47, s47, s32
  v_add_u32 v18, s33, v14
  v_add_u32 v19, s33, v15
  s_add_u32 s33, s33, 8192
  s_cmp_lt_u32 s33, 155648
  s_cselect_b32 s33, s33, 98304
  ds_read_b128 v[160:163], v18 offset:0
  s_waitcnt lgkmcnt(4)
  v_mfma_f32_16x16x32_bf16 v[64:67], a[36:39], v[192:195], v[64:67]
  v_mfma_f32_16x16x32_bf16 v[68:71], a[40:43], v[192:195], v[68:71]
  v_mfma_f32_16x16x32_bf16 v[72:75], a[44:47], v[192:195], v[72:75]
  ds_read_b128 v[240:243], v23 offset:256
  ds_read_b128 v[164:167], v18 offset:2048
  s_waitcnt lgkmcnt(4)
  v_mfma_f32_16x16x32_bf16 v[76:79], a[36:39], v[196:199], v[76:79]
  v_mfma_f32_16x16x32_bf16 v[80:83], a[40:43], v[196:199], v[80:83]
  v_mfma_f32_16x16x32_bf16 v[84:87], a[44:47], v[196:199], v[84:87]
  s_add_u32 m0, s47, 0
  s_nop 0
  buffer_load_dwordx4 v10, s[8:11], s46 offen lds
  ds_read_b128 v[244:247], v23 offset:320
  ds_read_b128 v[168:171], v18 offset:4096
  s_waitcnt lgkmcnt(4)
  v_mfma_f32_16x16x32_bf16 v[88:91], a[36:39], v[200:203], v[88:91]
  v_mfma_f32_16x16x32_bf16 v[92:95], a[40:43], v[200:203], v[92:95]
  v_mfma_f32_16x16x32_bf16 v[96:99], a[44:47], v[200:203], v[96:99]
  s_add_u32 s21, s48, 0
  buffer_store_dwordx4 v[232:235], v26, s[16:19], s21 offen offset:2048 sc1
  ds_read_b128 v[172:175], v18 offset:6144
  s_waitcnt lgkmcnt(4)
  v_mfma_f32_16x16x32_bf16 v[100:103], a[36:39], v[204:207], v[100:103]
  v_mfma_f32_16x16x32_bf16 v[104:107], a[40:43], v[204:207], v[104:107]
  v_mfma_f32_16x16x32_bf16 v[108:111], a[44:47], v[204:207], v[108:111]
  s_add_u32 s21, s48, 0
  buffer_store_dwordx4 v[236:239], v26, s[16:19], s21 offen offset:3072 sc1
  ds_read_b128 v[192:195], v19 offset:0
  s_waitcnt lgkmcnt(4)
  v_mfma_f32_16x16x32_bf16 v[64:67], a[48:51], v[160:163], v[64:67]
  v_mfma_f32_16x16x32_bf16 v[68:71], a[52:55], v[160:163], v[68:71]
  v_mfma_f32_16x16x32_bf16 v[72:75], a[56:59], v[160:163], v[72:75]
  ds_read_b128 v[196:199], v19 offset:2048
  s_waitcnt lgkmcnt(4)
  v_mfma_f32_16x16x32_bf16 v[76:79], a[48:51], v[164:167], v[76:79]
  v_mfma_f32_16x16x32_bf16 v[80:83], a[52:55], v[164:167], v[80:83]
  v_mfma_f32_16x16x32_bf16 v[84:87], a[56:59], v[164:167], v[84:87]
  s_add_u32 s46, s46, 10240
  s_add_u32 m0, s47, 1024
  s_nop 0
  buffer_load_dwordx4 v10, s[8:11], s46 offen lds
  ds_read_b128 v[200:203], v19 offset:4096
  s_waitcnt lgkmcnt(4)
  v_mfma_f32_16x16x32_bf16 v[88:91], a[48:51], v[168:171], v[88:91]
  v_mfma_f32_16x16x32_bf16 v[92:95], a[52:55], v[168:171], v[92:95]
  v_mfma_f32_16x16x32_bf16 v[96:99], a[56:59], v[168:171], v[96:99]
  s_add_u32 s21, s48, 4096
  buffer_store_dwordx4 v[240:243], v26, s[16:19], s21 offen offset:0 sc1
  ds_read_b128 v[204:207], v19 offset:6144
  s_waitcnt lgkmcnt(4)
  v_mfma_f32_16x16x32_bf16 v[100:103], a[48:51], v[172:175], v[100:103]
  v_mfma_f32_16x16x32_bf16 v[104:107], a[52:55], v[172:175], v[104:107]
  v_mfma_f32_16x16x32_bf16 v[108:111], a[56:59], v[172:175], v[108:111]
  s_add_u32 s21, s48, 4096
  buffer_store_dwordx4 v[244:247], v26, s[16:19], s21 offen offset:1024 sc1
  s_waitcnt vmcnt(14)
  s_barrier
  s_add_u32 s30, s30, 128
  s_add_u32 s31, s31, 1
  s_cmp_lt_u32 s31, 10
  s_cbranch_scc1 kvm_204
  s_mov_b32 s31, 0
  s_add_u32 s30, s30, s25
  s_sub_u32 s30, s30, 1280
kvm_204:
  s_add_u32 s32, s32, 8192
  s_cmp_lt_u32 s32, 155648
  s_cselect_b32 s32, s32, 98304
  s_mul_i32 s46, s20, 20480
  s_add_u32 s46, s46, s30
  s_lshl_b32 s47, s20, 11
  s_add_u32 s47, s47, s32
  v_add_u32 v18, s33, v14
  v_add_u32 v19, s33, v15
  s_add_u32 s33, s33, 8192
  s_cmp_lt_u32 s33, 155648
  s_cselect_b32 s33, s33, 98304
  ds_read_b128 v[160:163], v18 offset:0
  s_waitcnt lgkmcnt(4)
  v_mfma_f32_16x16x32_bf16 v[64:67], a[60:63], v[192:195], v[64:67]
  v_mfma_f32_16x16x32_bf16 v[68:71], a[64:67], v[192:195], v[68:71]
  v_mfma_f32_16x16x32_bf16 v[72:75], a[68:71], v[192:195], v[72:75]
  ds_read_b128 v[164:167], v18 offset:2048
  s_waitcnt lgkmcnt(4)
  v_mfma_f32_16x16x32_bf16 v[76:79], a[60:63], v[196:199], v[76:79]
  v_mfma_f32_16x16x32_bf16 v[80:83], a[64:67], v[196:199], v[80:83]
  v_mfma_f32_16x16x32_bf16 v[84:87], a[68:71], v[196:199], v[84:87]
  s_add_u32 m0, s47, 0
  s_nop 0
  buffer_load_dwordx4 v10, s[8:11], s46 offen lds
  ds_read_b128 v[168:171], v18 offset:4096
  s_waitcnt lgkmcnt(4)
  v_mfma_f32_16x16x32_bf16 v[88:91], a[60:63], v[200:203], v[88:91]
  v_mfma_f32_16x16x32_bf16 v[92:95], a[64:67], v[200:203], v[92:95]
  v_mfma_f32_16x16x32_bf16 v[96:99], a[68:71], v[200:203], v[96:99]
  ds_read_b128 v[172:175], v18 offset:6144
  s_waitcnt lgkmcnt(4)
  v_mfma_f32_16x16x32_bf16 v[100:103], a[60:63], v[204:207], v[100:103]
  v_mfma_f32_16x16x32_bf16 v[104:107], a[64:67], v[204:207], v[104:107]
  v_mfma_f32_16x16x32_bf16 v[108:111], a[68:71], v[204:207], v[108:111]
  ds_read_b128 v[192:195], v19 offset:0
  s_waitcnt lgkmcnt(4)
  v_mfma_f32_16x16x32_bf16 v[64:67], a[72:75], v[160:163], v[64:67]
  v_mfma_f32_16x16x32_bf16 v[68:71], a[76:79], v[160:163], v[68:71]
  v_mfma_f32_16x16x32_bf16 v[72:75], a[80:83], v[160:163], v[72:75]
  ds_read_b128 v[196:199], v19 offset:2048
  s_waitcnt lgkmcnt(4)
  v_mfma_f32_16x16x32_bf16 v[76:79], a[72:75], v[164:167], v[76:79]
  v_mfma_f32_16x16x32_bf16 v[80:83], a[76:79], v[164:167], v[80:83]
  v_mfma_f32_16x16x32_bf16 v[84:87], a[80:83], v[164:167], v[84:87]
  s_add_u32 s46, s46, 10240
  s_add_u32 m0, s47, 1024
  s_nop 0
  buffer_load_dwordx4 v10, s[8:11], s46 offen lds
  ds_read_b128 v[200:203], v19 offset:4096
  s_waitcnt lgkmcnt(4)
  v_mfma_f32_16x16x32_bf16 v[88:91], a[72:75], v[168:171], v[88:91]
  v_mfma_f32_16x16x32_bf16 v[92:95], a[76:79], v[168:171], v[92:95]
  v_mfma_f32_16x16x32_bf16 v[96:99], a[80:83], v[168:171], v[96:99]
  ds_read_b128 v[204:207], v19 offset:6144
  s_waitcnt lgkmcnt(4)
  v_mfma_f32_16x16x32_bf16 v[100:103], a[72:75], v[172:175], v[100:103]
  v_mfma_f32_16x16x32_bf16 v[104:107], a[76:79], v[172:175], v[104:107]
  v_mfma_f32_16x16x32_bf16 v[108:111], a[80:83], v[172:175], v[108:111]
  s_waitcnt vmcnt(14)
  s_barrier
  s_add_u32 s30, s30, 128
  s_add_u32 s31, s31, 1
  s_cmp_lt_u32 s31, 10
  s_cbranch_scc1 kvm_205
  s_mov_b32 s31, 0
  s_add_u32 s30, s30, s25
  s_sub_u32 s30, s30, 1280
kvm_205:
  s_add_u32 s32, s32, 8192
  s_cmp_lt_u32 s32, 155648
  s_cselect_b32 s32, s32, 98304
  s_mul_i32 s46, s20, 20480
  s_add_u32 s46, s46, s30
  s_lshl_b32 s47, s20, 11
  s_add_u32 s47, s47, s32
  v_add_u32 v18, s33, v14
  v_add_u32 v19, s33, v15
  s_add_u32 s33, s33, 8192
  s_cmp_lt_u32 s33, 155648
  s_cselect_b32 s33, s33, 98304
  ds_read_b128 v[160:163], v18 offset:0
  s_waitcnt lgkmcnt(4)
  v_mfma_f32_16x16x32_bf16 v[64:67], a[84:87], v[192:195], v[64:67]
  v_mfma_f32_16x16x32_bf16 v[68:71], a[88:91], v[192:195], v[68:71]
  v_mfma_f32_16x16x32_bf16 v[72:75], a[92:95], v[192:195], v[72:75]
  ds_read_b128 v[164:167], v18 offset:2048
  s_waitcnt lgkmcnt(4)
  v_mfma_f32_16x16x32_bf16 v[76:79], a[84:87], v[196:199], v[76:79]
  v_mfma_f32_16x16x32_bf16 v[80:83], a[88:91], v[196:199], v[80:83]
  v_mfma_f32_16x16x32_bf16 v[84:87], a[92:95], v[196:199], v[84:87]
  s_add_u32 m0, s47, 0
  s_nop 0
  buffer_load_dwordx4 v10, s[8:11], s46 offen lds
  ds_read_b128 v[168:171], v18 offset:4096
  s_waitcnt lgkmcnt(4)
  v_mfma_f32_16x16x32_bf16 v[88:91], a[84:87], v[200:203], v[88:91]
  v_mfma_f32_16x16x32_bf16 v[92:95], a[88:91], v[200:203], v[92:95]
  v_mfma_f32_16x16x32_bf16 v[96:99], a[92:95], v[200:203], v[96:99]
  ds_read_b128 v[172:175], v18 offset:6144
  s_waitcnt lgkmcnt(4)
  v_mfma_f32_16x16x32_bf16 v[100:103], a[84:87], v[204:207], v[100:103]
  v_mfma_f32_16x16x32_bf16 v[104:107], a[88:91], v[204:207], v[104:107]
  v_mfma_f32_16x16x32_bf16 v[108:111], a[92:95], v[204:207], v[108:111]
  ds_read_b128 v[192:195], v19 offset:0
  s_waitcnt lgkmcnt(4)
  v_mfma_f32_16x16x32_bf16 v[64:67], a[96:99], v[160:163], v[64:67]
  v_mfma_f32_16x16x32_bf16 v[68:71], a[100:103], v[160:163], v[68:71]
  v_mfma_f32_16x16x32_bf16 v[72:75], a[104:107], v[160:163], v[72:75]
  ds_read_b128 v[196:199], v19 offset:2048
  s_waitcnt lgkmcnt(4)
  v_mfma_f32_16x16x32_bf16 v[76:79], a[96:99], v[164:167], v[76:79]
  v_mfma_f32_16x16x32_bf16 v[80:83], a[100:103], v[164:167], v[80:83]
  v_mfma_f32_16x16x32_bf16 v[84:87], a[104:107], v[164:167], v[84:87]
  s_add_u32 s46, s46, 10240
  s_add_u32 m0, s47, 1024
  s_nop 0
  buffer_load_dwordx4 v10, s[8:11], s46 offen lds
  ds_read_b128 v[200:203], v19 offset:4096
  s_waitcnt lgkmcnt(4)
  v_mfma_f32_16x16x32_bf16 v[88:91], a[96:99], v[168:171], v[88:91]
  v_mfma_f32_16x16x32_bf16 v[92:95], a[100:103], v[168:171], v[92:95]
  v_mfma_f32_16x16x32_bf16 v[96:99], a[104:107], v[168:171], v[96:99]
  ds_read_b128 v[204:207], v19 offset:6144
  s_waitcnt lgkmcnt(4)
  v_mfma_f32_16x16x32_bf16 v[100:103], a[96:99], v[172:175], v[100:103]
  v_mfma_f32_16x16x32_bf16 v[104:107], a[100:103], v[172:175], v[104:107]
  v_mfma_f32_16x16x32_bf16 v[108:111], a[104:107], v[172:175], v[108:111]
  s_waitcnt vmcnt(4)
  s_barrier
  s_cmp_eq_u32 s48, 0x80000000
  s_cbranch_scc1 kvm_206
  s_cmp_lg_u32 s20, 0
  s_cbranch_scc1 af_207
  v_mov_b32 v4, 0
  v_mov_b32 v5, 1
  s_mov_b64 exec, 1
  buffer_atomic_add v5, v4, s[72:75], s61 offen sc1
  s_mov_b64 exec, -1
  s_nop 1
af_207:
kvm_206:
  s_add_u32 s30, s30, 128
  s_add_u32 s31, s31, 1
  s_cmp_lt_u32 s31, 10
  s_cbranch_scc1 kvm_208
  s_mov_b32 s31, 0
  s_add_u32 s30, s30, s25
  s_sub_u32 s30, s30, 1280
kvm_208:
  s_add_u32 s32, s32, 8192
  s_cmp_lt_u32 s32, 155648
  s_cselect_b32 s32, s32, 98304
  s_mul_i32 s46, s20, 20480
  s_add_u32 s46, s46, s30
  s_lshl_b32 s47, s20, 11
  s_add_u32 s47, s47, s32
  v_add_u32 v18, s33, v14
  v_add_u32 v19, s33, v15
  s_add_u32 s33, s33, 8192
  s_cmp_lt_u32 s33, 155648
  s_cselect_b32 s33, s33, 98304
  ds_read_b128 v[160:163], v18 offset:0
  s_waitcnt lgkmcnt(4)
  v_mfma_f32_16x16x32_bf16 v[64:67], a[108:111], v[192:195], v[64:67]
  v_mfma_f32_16x16x32_bf16 v[68:71], a[112:115], v[192:195], v[68:71]
  v_mfma_f32_16x16x32_bf16 v[72:75], a[116:119], v[192:195], v[72:75]
  ds_read_b128 v[164:167], v18 offset:2048
  s_waitcnt lgkmcnt(4)
  v_mfma_f32_16x16x32_bf16 v[76:79], a[108:111], v[196:199], v[76:79]
  v_mfma_f32_16x16x32_bf16 v[80:83], a[112:115], v[196:199], v[80:83]
  v_mfma_f32_16x16x32_bf16 v[84:87], a[116:119], v[196:199], v[84:87]
  s_add_u32 m0, s47, 0
  s_nop 0
  buffer_load_dwordx4 v10, s[8:11], s46 offen lds
  ds_read_b128 v[168:171], v18 offset:4096
  s_waitcnt lgkmcnt(4)
  v_mfma_f32_16x16x32_bf16 v[88:91], a[108:111], v[200:203], v[88:91]
  v_mfma_f32_16x16x32_bf16 v[92:95], a[112:115], v[200:203], v[92:95]
  v_mfma_f32_16x16x32_bf16 v[96:99], a[116:119], v[200:203], v[96:99]
  ds_read_b128 v[172:175], v18 offset:6144
  s_waitcnt lgkmcnt(4)
  v_mfma_f32_16x16x32_bf16 v[100:103], a[108:111], v[204:207], v[100:103]
  v_mfma_f32_16x16x32_bf16 v[104:107], a[112:115], v[204:207], v[104:107]
  v_mfma_f32_16x16x32_bf16 v[108:111], a[116:119], v[204:207], v[108:111]
  ds_read_b128 v[192:195], v19 offset:0
  s_waitcnt lgkmcnt(4)
  v_mfma_f32_16x16x32_bf16 v[64:67], a[120:123], v[160:163], v[64:67]
  v_mfma_f32_16x16x32_bf16 v[68:71], a[124:127], v[160:163], v[68:71]
  v_mfma_f32_16x16x32_bf16 v[72:75], a[128:131], v[160:163], v[72:75]
  ds_read_b128 v[196:199], v19 offset:2048
  s_waitcnt lgkmcnt(4)
  v_mfma_f32_16x16x32_bf16 v[76:79], a[120:123], v[164:167], v[76:79]
  v_mfma_f32_16x16x32_bf16 v[80:83], a[124:127], v[164:167], v[80:83]
  v_mfma_f32_16x16x32_bf16 v[84:87], a[128:131], v[164:167], v[84:87]
  s_add_u32 s46, s46, 10240
  s_add_u32 m0, s47, 1024
  s_nop 0
  buffer_load_dwordx4 v10, s[8:11], s46 offen lds
  ds_read_b128 v[200:203], v19 offset:4096
  s_waitcnt lgkmcnt(4)
  v_mfma_f32_16x16x32_bf16 v[88:91], a[120:123], v[168:171], v[88:91]
  v_mfma_f32_16x16x32_bf16 v[92:95], a[124:127], v[168:171], v[92:95]
  v_mfma_f32_16x16x32_bf16 v[96:99], a[128:131], v[168:171], v[96:99]
  ds_read_b128 v[204:207], v19 offset:6144
  s_waitcnt lgkmcnt(4)
  v_mfma_f32_16x16x32_bf16 v[100:103], a[120:123], v[172:175], v[100:103]
  v_mfma_f32_16x16x32_bf16 v[104:107], a[124:127], v[172:175], v[104:107]
  v_mfma_f32_16x16x32_bf16 v[108:111], a[128:131], v[172:175], v[108:111]
  s_waitcnt vmcnt(14)
  s_barrier
  s_add_u32 s30, s30, 128
  s_add_u32 s31, s31, 1
  s_cmp_lt_u32 s31, 10
  s_cbranch_scc1 kvm_209
  s_mov_b32 s31, 0
  s_add_u32 s30, s30, s25
  s_sub_u32 s30, s30, 1280
kvm_209:
  s_add_u32 s32, s32, 8192
  s_cmp_lt_u32 s32, 155648
  s_cselect_b32 s32, s32, 98304
  s_mul_i32 s46, s20, 20480
  s_add_u32 s46, s46, s30
  s_lshl_b32 s47, s20, 11
  s_add_u32 s47, s47, s32
  v_add_u32 v18, s33, v14
  v_add_u32 v19, s33, v15
  s_add_u32 s33, s33, 8192
  s_cmp_lt_u32 s33, 155648
  s_cselect_b32 s33, s33, 98304
  ds_read_b128 v[160:163], v18 offset:0
  s_waitcnt lgkmcnt(4)
  v_mfma_f32_16x16x32_bf16 v[64:67], a[132:135], v[192:195], v[64:67]
  v_mfma_f32_16x16x32_bf16 v[68:71], a[136:139], v[192:195], v[68:71]
  v_mfma_f32_16x16x32_bf16 v[72:75], a[140:143], v[192:195], v[72:75]
  ds_read_b128 v[164:167], v18 offset:2048
  s_waitcnt lgkmcnt(4)
  v_mfma_f32_16x16x32_bf16 v[76:79], a[132:135], v[196:199], v[76:79]
  v_mfma_f32_16x16x32_bf16 v[80:83], a[136:139], v[196:199], v[80:83]
  v_mfma_f32_16x16x32_bf16 v[84:87], a[140:143], v[196:199], v[84:87]
  s_add_u32 m0, s47, 0
  s_nop 0
  buffer_load_dwordx4 v10, s[8:11], s46 offen lds
  ds_read_b128 v[168:171], v18 offset:4096
  s_waitcnt lgkmcnt(4)
  v_mfma_f32_16x16x32_bf16 v[88:91], a[132:135], v[200:203], v[88:91]
  v_mfma_f32_16x16x32_bf16 v[92:95], a[136:139], v[200:203], v[92:95]
  v_mfma_f32_16x16x32_bf16 v[96:99], a[140:143], v[200:203], v[96:99]
  ds_read_b128 v[172:175], v18 offset:6144
  s_waitcnt lgkmcnt(4)
  v_mfma_f32_16x16x32_bf16 v[100:103], a[132:135], v[204:207], v[100:103]
  v_mfma_f32_16x16x32_bf16 v[104:107], a[136:139], v[204:207], v[104:107]
  v_mfma_f32_16x16x32_bf16 v[108:111], a[140:143], v[204:207], v[108:111]
  ds_read_b128 v[192:195], v19 offset:0
  s_waitcnt lgkmcnt(4)
  v_mfma_f32_16x16x32_bf16 v[64:67], a[144:147], v[160:163], v[64:67]
  v_mfma_f32_16x16x32_bf16 v[68:71], a[148:151], v[160:163], v[68:71]
  v_mfma_f32_16x16x32_bf16 v[72:75], a[152:155], v[160:163], v[72:75]
  ds_read_b128 v[196:199], v19 offset:2048
  s_waitcnt lgkmcnt(4)
  v_mfma_f32_16x16x32_bf16 v[76:79], a[144:147], v[164:167], v[76:79]
  v_mfma_f32_16x16x32_bf16 v[80:83], a[148:151], v[164:167], v[80:83]
  v_mfma_f32_16x16x32_bf16 v[84:87], a[152:155], v[164:167], v[84:87]
  s_add_u32 s46, s46, 10240
  s_add_u32 m0, s47, 1024
  s_nop 0
  buffer_load_dwordx4 v10, s[8:11], s46 offen lds
  ds_read_b128 v[200:203], v19 offset:4096
  s_waitcnt lgkmcnt(4)
  v_mfma_f32_16x16x32_bf16 v[88:91], a[144:147], v[168:171], v[88:91]
  v_mfma_f32_16x16x32_bf16 v[92:95], a[148:151], v[168:171], v[92:95]
  v_mfma_f32_16x16x32_bf16 v[96:99], a[152:155], v[168:171], v[96:99]
  ds_read_b128 v[204:207], v19 offset:6144
  s_waitcnt lgkmcnt(4)
  v_mfma_f32_16x16x32_bf16 v[100:103], a[144:147], v[172:175], v[100:103]
  v_mfma_f32_16x16x32_bf16 v[104:107], a[148:151], v[172:175], v[104:107]
  v_mfma_f32_16x16x32_bf16 v[108:111], a[152:155], v[172:175], v[108:111]
  s_waitcnt vmcnt(10)
  s_barrier
  s_add_u32 s30, s30, 128
  s_add_u32 s31, s31, 1
  s_cmp_lt_u32 s31, 10
  s_cbranch_scc1 kvm_210
  s_mov_b32 s31, 0
  s_add_u32 s30, s30, s25
  s_sub_u32 s30, s30, 1280
kvm_210:
  s_add_u32 s32, s32, 8192
  s_cmp_lt_u32 s32, 155648
  s_cselect_b32 s32, s32, 98304
  s_mul_i32 s46, s20, 20480
  s_add_u32 s46, s46, s30
  s_lshl_b32 s47, s20, 11
  s_add_u32 s47, s47, s32
  v_add_u32 v18, s33, v14
  v_add_u32 v19, s33, v15
  s_add_u32 s33, s33, 8192
  s_cmp_lt_u32 s33, 155648
  s_cselect_b32 s33, s33, 98304
  ds_read_b128 v[160:163], v18 offset:0
  s_waitcnt lgkmcnt(4)
  v_mfma_f32_16x16x32_bf16 v[64:67], a[156:159], v[192:195], v[64:67]
  v_mfma_f32_16x16x32_bf16 v[68:71], a[160:163], v[192:195], v[68:71]
  v_mfma_f32_16x16x32_bf16 v[72:75], a[164:167], v[192:195], v[72:75]
  ds_read_b128 v[164:167], v18 offset:2048
  s_waitcnt lgkmcnt(4)
  v_mfma_f32_16x16x32_bf16 v[76:79], a[156:159], v[196:199], v[76:79]
  v_mfma_f32_16x16x32_bf16 v[80:83], a[160:163], v[196:199], v[80:83]
  v_mfma_f32_16x16x32_bf16 v[84:87], a[164:167], v[196:199], v[84:87]
  s_add_u32 m0, s47, 0
  s_nop 0
  buffer_load_dwordx4 v10, s[8:11], s46 offen lds
  ds_read_b128 v[168:171], v18 offset:4096
  s_waitcnt lgkmcnt(4)
  v_mfma_f32_16x16x32_bf16 v[88:91], a[156:159], v[200:203], v[88:91]
  v_mfma_f32_16x16x32_bf16 v[92:95], a[160:163], v[200:203], v[92:95]
  v_mfma_f32_16x16x32_bf16 v[96:99], a[164:167], v[200:203], v[96:99]
  ds_read_b128 v[172:175], v18 offset:6144
  s_waitcnt lgkmcnt(4)
  v_mfma_f32_16x16x32_bf16 v[100:103], a[156:159], v[204:207], v[100:103]
  v_mfma_f32_16x16x32_bf16 v[104:107], a[160:163], v[204:207], v[104:107]
  v_mfma_f32_16x16x32_bf16 v[108:111], a[164:167], v[204:207], v[108:111]
  ds_read_b128 v[192:195], v19 offset:0
  s_waitcnt lgkmcnt(4)
  v_mfma_f32_16x16x32_bf16 v[64:67], a[168:171], v[160:163], v[64:67]
  v_mfma_f32_16x16x32_bf16 v[68:71], a[172:175], v[160:163], v[68:71]
  v_mfma_f32_16x16x32_bf16 v[72:75], a[176:179], v[160:163], v[72:75]
  ds_read_b128 v[196:199], v19 offset:2048
  s_waitcnt lgkmcnt(4)
  v_mfma_f32_16x16x32_bf16 v[76:79], a[168:171], v[164:167], v[76:79]
  v_mfma_f32_16x16x32_bf16 v[80:83], a[172:175], v[164:167], v[80:83]
  v_mfma_f32_16x16x32_bf16 v[84:87], a[176:179], v[164:167], v[84:87]
  s_add_u32 s46, s46, 10240
  s_add_u32 m0, s47, 1024
  s_nop 0
  buffer_load_dwordx4 v10, s[8:11], s46 offen lds
  ds_read_b128 v[200:203], v19 offset:4096
  s_waitcnt lgkmcnt(4)
  v_mfma_f32_16x16x32_bf16 v[88:91], a[168:171], v[168:171], v[88:91]
  v_mfma_f32_16x16x32_bf16 v[92:95], a[172:175], v[168:171], v[92:95]
  v_mfma_f32_16x16x32_bf16 v[96:99], a[176:179], v[168:171], v[96:99]
  ds_read_b128 v[204:207], v19 offset:6144
  s_waitcnt lgkmcnt(4)
  v_mfma_f32_16x16x32_bf16 v[100:103], a[168:171], v[172:175], v[100:103]
  v_mfma_f32_16x16x32_bf16 v[104:107], a[172:175], v[172:175], v[104:107]
  v_mfma_f32_16x16x32_bf16 v[108:111], a[176:179], v[172:175], v[108:111]
  s_waitcnt vmcnt(8)
  s_barrier
  s_add_u32 s30, s30, 128
  s_add_u32 s31, s31, 1
  s_cmp_lt_u32 s31, 10
  s_cbranch_scc1 kvm_211
  s_mov_b32 s31, 0
  s_add_u32 s30, s30, s25
  s_sub_u32 s30, s30, 1280
kvm_211:
  s_add_u32 s32, s32, 8192
  s_cmp_lt_u32 s32, 155648
  s_cselect_b32 s32, s32, 98304
  s_mul_i32 s46, s20, 20480
  s_add_u32 s46, s46, s30
  s_lshl_b32 s47, s20, 11
  s_add_u32 s47, s47, s32
  v_add_u32 v18, s33, v14
  v_add_u32 v19, s33, v15
  s_add_u32 s33, s33, 8192
  s_cmp_lt_u32 s33, 155648
  s_cselect_b32 s33, s33, 98304
  ds_read_b128 v[160:163], v18 offset:0
  s_waitcnt lgkmcnt(4)
  v_mfma_f32_16x16x32_bf16 v[64:67], a[180:183], v[192:195], v[64:67]
  v_mfma_f32_16x16x32_bf16 v[68:71], a[184:187], v[192:195], v[68:71]
  v_mfma_f32_16x16x32_bf16 v[72:75], a[188:191], v[192:195], v[72:75]
  ds_read_b128 v[164:167], v18 offset:2048
  s_waitcnt lgkmcnt(4)
  v_mfma_f32_16x16x32_bf16 v[76:79], a[180:183], v[196:199], v[76:79]
  v_mfma_f32_16x16x32_bf16 v[80:83], a[184:187], v[196:199], v[80:83]
  v_mfma_f32_16x16x32_bf16 v[84:87], a[188:191], v[196:199], v[84:87]
  s_add_u32 m0, s47, 0
  s_nop 0
  buffer_load_dwordx4 v10, s[8:11], s46 offen lds
  ds_read_b128 v[168:171], v18 offset:4096
  s_waitcnt lgkmcnt(4)
  v_mfma_f32_16x16x32_bf16 v[88:91], a[180:183], v[200:203], v[88:91]
  v_mfma_f32_16x16x32_bf16 v[92:95], a[184:187], v[200:203], v[92:95]
  v_mfma_f32_16x16x32_bf16 v[96:99], a[188:191], v[200:203], v[96:99]
  ds_read_b128 v[172:175], v18 offset:6144
  s_waitcnt lgkmcnt(4)
  v_mfma_f32_16x16x32_bf16 v[100:103], a[180:183], v[204:207], v[100:103]
  v_mfma_f32_16x16x32_bf16 v[104:107], a[184:187], v[204:207], v[104:107]
  v_mfma_f32_16x16x32_bf16 v[108:111], a[188:191], v[204:207], v[108:111]
  ds_read_b128 v[192:195], v19 offset:0
  s_waitcnt lgkmcnt(4)
  v_mfma_f32_16x16x32_bf16 v[64:67], a[192:195], v[160:163], v[64:67]
  v_mfma_f32_16x16x32_bf16 v[68:71], a[196:199], v[160:163], v[68:71]
  v_mfma_f32_16x16x32_bf16 v[72:75], a[200:203], v[160:163], v[72:75]
  ds_read_b128 v[196:199], v19 offset:2048
  s_waitcnt lgkmcnt(4)
  v_mfma_f32_16x16x32_bf16 v[76:79], a[192:195], v[164:167], v[76:79]
  v_mfma_f32_16x16x32_bf16 v[80:83], a[196:199], v[164:167], v[80:83]
  v_mfma_f32_16x16x32_bf16 v[84:87], a[200:203], v[164:167], v[84:87]
  s_add_u32 s46, s46, 10240
  s_add_u32 m0, s47, 1024
  s_nop 0
  buffer_load_dwordx4 v10, s[8:11], s46 offen lds
  ds_read_b128 v[200:203], v19 offset:4096
  s_waitcnt lgkmcnt(4)
  v_mfma_f32_16x16x32_bf16 v[88:91], a[192:195], v[168:171], v[88:91]
  v_mfma_f32_16x16x32_bf16 v[92:95], a[196:199], v[168:171], v[92:95]
  v_mfma_f32_16x16x32_bf16 v[96:99], a[200:203], v[168:171], v[96:99]
  ds_read_b128 v[204:207], v19 offset:6144
  s_waitcnt lgkmcnt(4)
  v_mfma_f32_16x16x32_bf16 v[100:103], a[192:195], v[172:175], v[100:103]
  v_mfma_f32_16x16x32_bf16 v[104:107], a[196:199], v[172:175], v[104:107]
  v_mfma_f32_16x16x32_bf16 v[108:111], a[200:203], v[172:175], v[108:111]
  s_waitcnt vmcnt(8)
  s_barrier
  s_add_u32 s30, s30, 128
  s_add_u32 s31, s31, 1
  s_cmp_lt_u32 s31, 10
  s_cbranch_scc1 kvm_212
  s_mov_b32 s31, 0
  s_add_u32 s30, s30, s25
  s_sub_u32 s30, s30, 1280
kvm_212:
  s_add_u32 s32, s32, 8192
  s_cmp_lt_u32 s32, 155648
  s_cselect_b32 s32, s32, 98304
  s_mul_i32 s46, s20, 20480
  s_add_u32 s46, s46, s30
  s_lshl_b32 s47, s20, 11
  s_add_u32 s47, s47, s32
  v_add_u32 v18, s33, v14
  v_add_u32 v19, s33, v15
  s_add_u32 s33, s33, 8192
  s_cmp_lt_u32 s33, 155648
  s_cselect_b32 s33, s33, 98304
  ds_read_b128 v[160:163], v18 offset:0
  s_waitcnt lgkmcnt(4)
  v_mfma_f32_16x16x32_bf16 v[64:67], a[204:207], v[192:195], v[64:67]
  v_mfma_f32_16x16x32_bf16 v[68:71], a[208:211], v[192:195], v[68:71]
  v_mfma_f32_16x16x32_bf16 v[72:75], a[212:215], v[192:195], v[72:75]
  ds_read_b128 v[164:167], v18 offset:2048
  s_waitcnt lgkmcnt(4)
  v_mfma_f32_16x16x32_bf16 v[76:79], a[204:207], v[196:199], v[76:79]
  v_mfma_f32_16x16x32_bf16 v[80:83], a[208:211], v[196:199], v[80:83]
  v_mfma_f32_16x16x32_bf16 v[84:87], a[212:215], v[196:199], v[84:87]
  s_add_u32 m0, s47, 0
  s_nop 0
  buffer_load_dwordx4 v10, s[8:11], s46 offen lds
  ds_read_b128 v[168:171], v18 offset:4096
  s_waitcnt lgkmcnt(4)
  v_mfma_f32_16x16x32_bf16 v[88:91], a[204:207], v[200:203], v[88:91]
  v_mfma_f32_16x16x32_bf16 v[92:95], a[208:211], v[200:203], v[92:95]
  v_mfma_f32_16x16x32_bf16 v[96:99], a[212:215], v[200:203], v[96:99]
  ds_read_b128 v[172:175], v18 offset:6144
  s_waitcnt lgkmcnt(4)
  v_mfma_f32_16x16x32_bf16 v[100:103], a[204:207], v[204:207], v[100:103]
  v_mfma_f32_16x16x32_bf16 v[104:107], a[208:211], v[204:207], v[104:107]
  v_mfma_f32_16x16x32_bf16 v[108:111], a[212:215], v[204:207], v[108:111]
  ds_read_b128 v[192:195], v19 offset:0
  s_waitcnt lgkmcnt(4)
  v_mfma_f32_16x16x32_bf16 v[64:67], a[216:219], v[160:163], v[64:67]
  v_mfma_f32_16x16x32_bf16 v[68:71], a[220:223], v[160:163], v[68:71]
  v_mfma_f32_16x16x32_bf16 v[72:75], a[224:227], v[160:163], v[72:75]
  ds_read_b128 v[196:199], v19 offset:2048
  s_waitcnt lgkmcnt(4)
  v_mfma_f32_16x16x32_bf16 v[76:79], a[216:219], v[164:167], v[76:79]
  v_mfma_f32_16x16x32_bf16 v[80:83], a[220:223], v[164:167], v[80:83]
  v_mfma_f32_16x16x32_bf16 v[84:87], a[224:227], v[164:167], v[84:87]
  s_add_u32 s46, s46, 10240
  s_add_u32 m0, s47, 1024
  s_nop 0
  buffer_load_dwordx4 v10, s[8:11], s46 offen lds
  ds_read_b128 v[200:203], v19 offset:4096
  s_waitcnt lgkmcnt(4)
  v_mfma_f32_16x16x32_bf16 v[88:91], a[216:219], v[168:171], v[88:91]
  v_mfma_f32_16x16x32_bf16 v[92:95], a[220:223], v[168:171], v[92:95]
  v_mfma_f32_16x16x32_bf16 v[96:99], a[224:227], v[168:171], v[96:99]
  ds_read_b128 v[204:207], v19 offset:6144
  s_waitcnt lgkmcnt(4)
  v_mfma_f32_16x16x32_bf16 v[100:103], a[216:219], v[172:175], v[100:103]
  v_mfma_f32_16x16x32_bf16 v[104:107], a[220:223], v[172:175], v[104:107]
  v_mfma_f32_16x16x32_bf16 v[108:111], a[224:227], v[172:175], v[108:111]
  s_waitcnt vmcnt(8)
  s_barrier
  s_add_u32 s30, s30, 128
  s_add_u32 s31, s31, 1
  s_cmp_lt_u32 s31, 10
  s_cbranch_scc1 kvm_213
  s_mov_b32 s31, 0
  s_add_u32 s30, s30, s25
  s_sub_u32 s30, s30, 1280
kvm_213:
  s_add_u32 s32, s32, 8192
  s_cmp_lt_u32 s32, 155648
  s_cselect_b32 s32, s32, 98304
  s_mul_i32 s46, s20, 20480
  s_add_u32 s46, s46, s30
  s_lshl_b32 s47, s20, 11
  s_add_u32 s47, s47, s32
  v_add_u32 v18, s33, v14
  v_add_u32 v19, s33, v15
  s_add_u32 s33, s33, 8192
  s_cmp_lt_u32 s33, 155648
  s_cselect_b32 s33, s33, 98304
  ds_read_b128 v[160:163], v18 offset:0
  s_waitcnt lgkmcnt(4)
  v_mfma_f32_16x16x32_bf16 v[64:67], a[228:231], v[192:195], v[64:67]
  v_mfma_f32_16x16x32_bf16 v[68:71], a[232:235], v[192:195], v[68:71]
  v_mfma_f32_16x16x32_bf16 v[72:75], a[236:239], v[192:195], v[72:75]
  ds_read_b128 v[164:167], v18 offset:2048
  s_waitcnt lgkmcnt(4)
  v_mfma_f32_16x16x32_bf16 v[76:79], a[228:231], v[196:199], v[76:79]
  v_mfma_f32_16x16x32_bf16 v[80:83], a[232:235], v[196:199], v[80:83]
  v_mfma_f32_16x16x32_bf16 v[84:87], a[236:239], v[196:199], v[84:87]
  s_add_u32 m0, s47, 0
  s_nop 0
  buffer_load_dwordx4 v10, s[8:11], s46 offen lds
  ds_read_b128 v[168:171], v18 offset:4096
  s_waitcnt lgkmcnt(4)
  v_mfma_f32_16x16x32_bf16 v[88:91], a[228:231], v[200:203], v[88:91]
  v_mfma_f32_16x16x32_bf16 v[92:95], a[232:235], v[200:203], v[92:95]
  v_mfma_f32_16x16x32_bf16 v[96:99], a[236:239], v[200:203], v[96:99]
  ds_read_b128 v[172:175], v18 offset:6144
  s_waitcnt lgkmcnt(4)
  v_mfma_f32_16x16x32_bf16 v[100:103], a[228:231], v[204:207], v[100:103]
  v_mfma_f32_16x16x32_bf16 v[104:107], a[232:235], v[204:207], v[104:107]
  v_mfma_f32_16x16x32_bf16 v[108:111], a[236:239], v[204:207], v[108:111]
  v_cvt_pk_bf16_f32 v224, v64, v65
  v_cvt_pk_bf16_f32 v225, v66, v67
  v_cvt_pk_bf16_f32 v226, v68, v69
  v_cvt_pk_bf16_f32 v227, v70, v71
  v_cvt_pk_bf16_f32 v228, v72, v73
  v_cvt_pk_bf16_f32 v229, v74, v75
  ds_write_b64 v22, v[224:225] offset:0
  ds_write_b64 v22, v[226:227] offset:8
  ds_write_b64 v22, v[228:229] offset:16
  s_nop 4
  v_cvt_pk_bf16_f32 v230, v76, v77
  v_cvt_pk_bf16_f32 v231, v78, v79
  v_cvt_pk_bf16_f32 v232, v80, v81
  v_cvt_pk_bf16_f32 v233, v82, v83
  v_cvt_pk_bf16_f32 v234, v84, v85
  v_cvt_pk_bf16_f32 v235, v86, v87
  ds_write_b64 v22, v[230:231] offset:6400
  ds_write_b64 v22, v[232:233] offset:6408
  ds_write_b64 v22, v[234:235] offset:6416
  v_cvt_pk_bf16_f32 v224, v88, v89
  v_cvt_pk_bf16_f32 v225, v90, v91
  v_cvt_pk_bf16_f32 v226, v92, v93
  v_cvt_pk_bf16_f32 v227, v94, v95
  v_cvt_pk_bf16_f32 v228, v96, v97
  v_cvt_pk_bf16_f32 v229, v98, v99
  ds_write_b64 v22, v[224:225] offset:12800
  ds_write_b64 v22, v[226:227] offset:12808
  ds_write_b64 v22, v[228:229] offset:12816
  v_cvt_pk_bf16_f32 v230, v100, v101
  v_cvt_pk_bf16_f32 v231, v102, v103
  v_cvt_pk_bf16_f32 v232, v104, v105
  v_cvt_pk_bf16_f32 v233, v106, v107
  v_cvt_pk_bf16_f32 v234, v108, v109
  v_cvt_pk_bf16_f32 v235, v110, v111
  ds_write_b64 v22, v[230:231] offset:19200
  ds_write_b64 v22, v[232:233] offset:19208
  ds_write_b64 v22, v[234:235] offset:19216
  s_mov_b32 s61, s60
  s_add_u32 s60, s60, 1024
  s_lshr_b32 s48, s20, 1
  s_mul_i32 s48, s48, 393216
  s_and_b32 s21, s20, 1
  s_mul_i32 s21, s21, 6144
  s_add_u32 s48, s48, s21
  s_add_u32 s48, s48, s27
  s_add_u32 s27, s27, s28
  s_sub_u32 s26, s26, 1
  s_cmp_gt_u32 s26, 0
  s_cbranch_scc1 kvm_blk_201
  s_waitcnt vmcnt(0) lgkmcnt(0)
  s_barrier
  ds_read_b128 v[224:227], v23 offset:0
  ds_read_b128 v[228:231], v23 offset:64
  ds_read_b128 v[232:235], v23 offset:128
  ds_read_b128 v[236:239], v23 offset:192
  ds_read_b128 v[240:243], v23 offset:256
  ds_read_b128 v[244:247], v23 offset:320
  s_waitcnt lgkmcnt(0)
  s_add_u32 s21, s48, 0
  buffer_store_dwordx4 v[224:227], v26, s[16:19], s21 offen offset:0 sc1
  s_add_u32 s21, s48, 0
  buffer_store_dwordx4 v[228:231], v26, s[16:19], s21 offen offset:1024 sc1
  s_add_u32 s21, s48, 0
  buffer_store_dwordx4 v[232:235], v26, s[16:19], s21 offen offset:2048 sc1
  s_add_u32 s21, s48, 0
  buffer_store_dwordx4 v[236:239], v26, s[16:19], s21 offen offset:3072 sc1
  s_add_u32 s21, s48, 4096
  buffer_store_dwordx4 v[240:243], v26, s[16:19], s21 offen offset:0 sc1
  s_add_u32 s21, s48, 4096
  buffer_store_dwordx4 v[244:247], v26, s[16:19], s21 offen offset:1024 sc1
  s_nop 1
  s_mov_b32 s24, 327680
  s_mov_b32 s25, 163840
  v_lshrrev_b32 v11, 3, v1
  v_and_b32 v12, 7, v1
  v_xor_b32 v12, v12, v11
  v_mul_u32_u24 v11, 1280, v11
  v_lshl_add_u32 v10, v12, 4, v11
  s_mov_b32 s30, s24
  s_mov_b32 s31, 0
  s_mov_b32 s32, 32768
  s_mul_i32 s46, s20, 40960
  s_add_u32 s46, s46, s30
  s_lshl_b32 s47, s20, 12
  s_add_u32 s47, s47, s32
  s_add_u32 m0, s47, 0
  s_nop 0
  buffer_load_dwordx4 v10, s[8:11], s46 offen lds
  s_add_u32 s46, s46, 10240
  s_add_u32 m0, s47, 1024
  s_nop 0
  buffer_load_dwordx4 v10, s[8:11], s46 offen lds
  s_add_u32 s46, s46, 10240
  s_add_u32 m0, s47, 2048
  s_nop 0
  buffer_load_dwordx4 v10, s[8:11], s46 offen lds
  s_add_u32 s46, s46, 10240
  s_add_u32 m0, s47, 3072
  s_nop 0
  buffer_load_dwordx4 v10, s[8:11], s46 offen lds
  s_add_u32 s30, s30, 128
  s_add_u32 s31, s31, 1
  s_cmp_lt_u32 s31, 10
  s_cbranch_scc1 kv_214
  s_mov_b32 s31, 0
  s_add_u32 s30, s30, s25
  s_sub_u32 s30, s30, 1280
kv_214:
  s_add_u32 s32, s32, 16384
  s_cmp_lt_u32 s32, 98304
  s_cselect_b32 s32, s32, 0
  s_mul_i32 s46, s20, 40960
  s_add_u32 s46, s46, s30
  s_lshl_b32 s47, s20, 12
  s_add_u32 s47, s47, s32
  s_add_u32 m0, s47, 0
  s_nop 0
  buffer_load_dwordx4 v10, s[8:11], s46 offen lds
  s_add_u32 s46, s46, 10240
  s_add_u32 m0, s47, 1024
  s_nop 0
  buffer_load_dwordx4 v10, s[8:11], s46 offen lds
  s_add_u32 s46, s46, 10240
  s_add_u32 m0, s47, 2048
  s_nop 0
  buffer_load_dwordx4 v10, s[8:11], s46 offen lds
  s_add_u32 s46, s46, 10240
  s_add_u32 m0, s47, 3072
  s_nop 0
  buffer_load_dwordx4 v10, s[8:11], s46 offen lds
  s_add_u32 s30, s30, 128
  s_add_u32 s31, s31, 1
  s_cmp_lt_u32 s31, 10
  s_cbranch_scc1 kv_215
  s_mov_b32 s31, 0
  s_add_u32 s30, s30, s25
  s_sub_u32 s30, s30, 1280
kv_215:
  s_add_u32 s32, s32, 16384
  s_cmp_lt_u32 s32, 98304
  s_cselect_b32 s32, s32, 0
  s_mul_i32 s46, s20, 40960
  s_add_u32 s46, s46, s30
  s_lshl_b32 s47, s20, 12
  s_add_u32 s47, s47, s32
  s_add_u32 m0, s47, 0
  s_nop 0
  buffer_load_dwordx4 v10, s[8:11], s46 offen lds
  s_add_u32 s46, s46, 10240
  s_add_u32 m0, s47, 1024
  s_nop 0
  buffer_load_dwordx4 v10, s[8:11], s46 offen lds
  s_add_u32 s46, s46, 10240
  s_add_u32 m0, s47, 2048
  s_nop 0
  buffer_load_dwordx4 v10, s[8:11], s46 offen lds
  s_add_u32 s46, s46, 10240
  s_add_u32 m0, s47, 3072
  s_nop 0
  buffer_load_dwordx4 v10, s[8:11], s46 offen lds
  s_add_u32 s30, s30, 128
  s_add_u32 s31, s31, 1
  s_cmp_lt_u32 s31, 10
  s_cbranch_scc1 kv_216
  s_mov_b32 s31, 0
  s_add_u32 s30, s30, s25
  s_sub_u32 s30, s30, 1280
kv_216:
  s_add_u32 s32, s32, 16384
  s_cmp_lt_u32 s32, 98304
  s_cselect_b32 s32, s32, 0
  s_mul_i32 s46, s20, 40960
  s_add_u32 s46, s46, s30
  s_lshl_b32 s47, s20, 12
  s_add_u32 s47, s47, s32
  s_add_u32 m0, s47, 0
  s_nop 0
  buffer_load_dwordx4 v10, s[8:11], s46 offen lds
  s_add_u32 s46, s46, 10240
  s_add_u32 m0, s47, 1024
  s_nop 0
  buffer_load_dwordx4 v10, s[8:11], s46 offen lds
  s_add_u32 s46, s46, 10240
  s_add_u32 m0, s47, 2048
  s_nop 0
  buffer_load_dwordx4 v10, s[8:11], s46 offen lds
  s_add_u32 s46, s46, 10240
  s_add_u32 m0, s47, 3072
  s_nop 0
  buffer_load_dwordx4 v10, s[8:11], s46 offen lds
  s_add_u32 s30, s30, 128
  s_add_u32 s31, s31, 1
  s_cmp_lt_u32 s31, 10
  s_cbranch_scc1 kv_217
  s_mov_b32 s31, 0
  s_add_u32 s30, s30, s25
  s_sub_u32 s30, s30, 1280
kv_217:
  s_add_u32 s32, s32, 16384
  s_cmp_lt_u32 s32, 98304
  s_cselect_b32 s32, s32, 0
  s_waitcnt vmcnt(16)
  s_barrier
  s_cmp_lg_u32 s20, 0
  s_cbranch_scc1 af_218
  v_mov_b32 v4, 0
  v_mov_b32 v5, 1
  s_mov_b64 exec, 1
  buffer_atomic_add v5, v4, s[72:75], s61 offen sc1
  s_mov_b64 exec, -1
  s_nop 1
af_218:
  s_mov_b32 s26, 14
  s_mov_b32 s28, 1572864
  v_and_b32 v6, 7, v2
  v_add_u32 v4, 0, v3
  v_xor_b32 v4, v4, v6
  v_lshlrev_b32 v4, 4, v4
  v_lshl_add_u32 v14, v2, 7, v4
  v_add_u32 v4, 4, v3
  v_xor_b32 v4, v4, v6
  v_lshlrev_b32 v4, 4, v4
  v_lshl_add_u32 v15, v2, 7, v4
  v_mul_u32_u24 v22, 400, v2
  v_mul_u32_u24 v4, 24, v3
  s_mul_i32 s21, s20, 96
  s_add_u32 s21, s21, 98304
  v_add3_u32 v22, v22, v4, s21
  v_mov_b32 v9, 2731
  s_mul_i32 s21, s20, 12800
  s_add_u32 s21, s21, 98304
  v_mul_u32_u24 v4, 400, v2
  v_lshlrev_b32 v5, 4, v3
  v_add3_u32 v23, v4, v5, s21
  v_lshlrev_b32 v26, 4, v1
  s_mov_b32 s33, 32768
  s_mov_b32 s48, 0x80000000
  s_mul_i32 s46, s20, 40960
  s_add_u32 s46, s46, s30
  s_lshl_b32 s47, s20, 12
  s_add_u32 s47, s47, s32
  s_add_u32 m0, s47, 0
  s_nop 0
  buffer_load_dwordx4 v10, s[8:11], s46 offen lds
  s_add_u32 s46, s46, 10240
  s_add_u32 m0, s47, 1024
  s_nop 0
  buffer_load_dwordx4 v10, s[8:11], s46 offen lds
  s_waitcnt vmcnt(14)
  s_barrier
  v_add_u32 v18, s33, v14
  v_add_u32 v19, s33, v15
  s_add_u32 s33, s33, 16384
  s_cmp_lt_u32 s33, 98304
  s_cselect_b32 s33, s33, 0
  ds_read_b128 v[160:163], v18 offset:0
  ds_read_b128 v[164:167], v18 offset:2048
  ds_read_b128 v[168:171], v18 offset:4096
  ds_read_b128 v[172:175], v18 offset:6144
  ds_read_b128 v[176:179], v18 offset:8192
  ds_read_b128 v[180:183], v18 offset:10240
  ds_read_b128 v[184:187], v18 offset:12288
  ds_read_b128 v[188:191], v18 offset:14336
kv_blk_219:
  ds_read_b128 v[192:195], v19 offset:0
  s_waitcnt lgkmcnt(8)
  v_mfma_f32_16x16x32_bf16 v[64:67], a[0:3], v[160:163], 0
  v_mfma_f32_16x16x32_bf16 v[68:71], a[4:7], v[160:163], 0
  v_mfma_f32_16x16x32_bf16 v[72:75], a[8:11], v[160:163], 0
  ds_read_b128 v[196:199], v19 offset:2048
  s_waitcnt lgkmcnt(8)
  v_mfma_f32_16x16x32_bf16 v[76:79], a[0:3], v[164:167], 0
  v_mfma_f32_16x16x32_bf16 v[80:83], a[4:7], v[164:167], 0
  v_mfma_f32_16x16x32_bf16 v[84:87], a[8:11], v[164:167], 0
  s_add_u32 s46, s46, 10240
  s_add_u32 m0, s47, 2048
  s_nop 0
  buffer_load_dwordx4 v10, s[8:11], s46 offen lds
  ds_read_b128 v[200:203], v19 offset:4096
  s_waitcnt lgkmcnt(8)
  v_mfma_f32_16x16x32_bf16 v[88:91], a[0:3], v[168:171], 0
  v_mfma_f32_16x16x32_bf16 v[92:95], a[4:7], v[168:171], 0
  v_mfma_f32_16x16x32_bf16 v[96:99], a[8:11], v[168:171], 0
  ds_read_b128 v[204:207], v19 offset:6144
  s_waitcnt lgkmcnt(8)
  v_mfma_f32_16x16x32_bf16 v[100:103], a[0:3], v[172:175], 0
  v_mfma_f32_16x16x32_bf16 v[104:107], a[4:7], v[172:175], 0
  v_mfma_f32_16x16x32_bf16 v[108:111], a[8:11], v[172:175], 0
  ds_read_b128 v[208:211], v19 offset:8192
  s_waitcnt lgkmcnt(8)
  v_mfma_f32_16x16x32_bf16 v[112:115], a[0:3], v[176:179], 0
  v_mfma_f32_16x16x32_bf16 v[116:119], a[4:7], v[176:179], 0
  v_mfma_f32_16x16x32_bf16 v[120:123], a[8:11], v[176:179], 0
  ds_read_b128 v[212:215], v19 offset:10240
  s_waitcnt lgkmcnt(8)
  v_mfma_f32_16x16x32_bf16 v[124:127], a[0:3], v[180:183], 0
  v_mfma_f32_16x16x32_bf16 v[128:131], a[4:7], v[180:183], 0
  v_mfma_f32_16x16x32_bf16 v[132:135], a[8:11], v[180:183], 0
  s_add_u32 s46, s46, 10240
  s_add_u32 m0, s47, 3072
  s_nop 0
  buffer_load_dwordx4 v10, s[8:11], s46 offen lds
  ds_read_b128 v[216:219], v19 offset:12288
  s_waitcnt lgkmcnt(8)
  v_mfma_f32_16x16x32_bf16 v[136:139], a[0:3], v[184:187], 0
  v_mfma_f32_16x16x32_bf16 v[140:143], a[4:7], v[184:187], 0
  v_mfma_f32_16x16x32_bf16 v[144:147], a[8:11], v[184:187], 0
  ds_read_b128 v[220:223], v19 offset:14336
  s_waitcnt lgkmcnt(8)
  v_mfma_f32_16x16x32_bf16 v[148:151], a[0:3], v[188:191], 0
  v_mfma_f32_16x16x32_bf16 v[152:155], a[4:7], v[188:191], 0
  v_mfma_f32_16x16x32_bf16 v[156:159], a[8:11], v[188:191], 0
  s_waitcnt vmcnt(12)
  s_barrier
  s_add_u32 s30, s30, 128
  s_add_u32 s31, s31, 1
  s_cmp_lt_u32 s31, 10
  s_cbranch_scc1 kv_220
  s_mov_b32 s31, 0
  s_add_u32 s30, s30, s25
  s_sub_u32 s30, s30, 1280
kv_220:
  s_add_u32 s32, s32, 16384
  s_cmp_lt_u32 s32, 98304
  s_cselect_b32 s32, s32, 0
  s_mul_i32 s46, s20, 40960
  s_add_u32 s46, s46, s30
  s_lshl_b32 s47, s20, 12
  s_add_u32 s47, s47, s32
  v_add_u32 v18, s33, v14
  v_add_u32 v19, s33, v15
  s_add_u32 s33, s33, 16384
  s_cmp_lt_u32 s33, 98304
  s_cselect_b32 s33, s33, 0
  ds_read_b128 v[160:163], v18 offset:0
  s_waitcnt lgkmcnt(8)
  v_mfma_f32_16x16x32_bf16 v[64:67], a[12:15], v[192:195], v[64:67]
  v_mfma_f32_16x16x32_bf16 v[68:71], a[16:19], v[192:195], v[68:71]
  v_mfma_f32_16x16x32_bf16 v[72:75], a[20:23], v[192:195], v[72:75]
  ds_read_b128 v[224:227], v23 offset:0
  ds_read_b128 v[164:167], v18 offset:2048
  s_waitcnt lgkmcnt(8)
  v_mfma_f32_16x16x32_bf16 v[76:79], a[12:15], v[196:199], v[76:79]
  v_mfma_f32_16x16x32_bf16 v[80:83], a[16:19], v[196:199], v[80:83]
  v_mfma_f32_16x16x32_bf16 v[84:87], a[20:23], v[196:199], v[84:87]
  s_add_u32 m0, s47, 0
  s_nop 0
  buffer_load_dwordx4 v10, s[8:11], s46 offen lds
  ds_read_b128 v[168:171], v18 offset:4096
  s_waitcnt lgkmcnt(8)
  v_mfma_f32_16x16x32_bf16 v[88:91], a[12:15], v[200:203], v[88:91]
  v_mfma_f32_16x16x32_bf16 v[92:95], a[16:19], v[200:203], v[92:95]
  v_mfma_f32_16x16x32_bf16 v[96:99], a[20:23], v[200:203], v[96:99]
  ds_read_b128 v[172:175], v18 offset:6144
  s_waitcnt lgkmcnt(8)
  v_mfma_f32_16x16x32_bf16 v[100:103], a[12:15], v[204:207], v[100:103]
  v_mfma_f32_16x16x32_bf16 v[104:107], a[16:19], v[204:207], v[104:107]
  v_mfma_f32_16x16x32_bf16 v[108:111], a[20:23], v[204:207], v[108:111]
  ds_read_b128 v[176:179], v18 offset:8192
  s_waitcnt lgkmcnt(8)
  v_mfma_f32_16x16x32_bf16 v[112:115], a[12:15], v[208:211], v[112:115]
  v_mfma_f32_16x16x32_bf16 v[116:119], a[16:19], v[208:211], v[116:119]
  v_mfma_f32_16x16x32_bf16 v[120:123], a[20:23], v[208:211], v[120:123]
  ds_read_b128 v[228:231], v23 offset:64
  ds_read_b128 v[180:183], v18 offset:10240
  s_waitcnt lgkmcnt(8)
  v_mfma_f32_16x16x32_bf16 v[124:127], a[12:15], v[212:215], v[124:127]
  v_mfma_f32_16x16x32_bf16 v[128:131], a[16:19], v[212:215], v[128:131]
  v_mfma_f32_16x16x32_bf16 v[132:135], a[20:23], v[212:215], v[132:135]
  s_add_u32 s46, s46, 10240
  s_add_u32 m0, s47, 1024
  s_nop 0
  buffer_load_dwordx4 v10, s[8:11], s46 offen lds
  ds_read_b128 v[184:187], v18 offset:12288
  s_waitcnt lgkmcnt(8)
  v_mfma_f32_16x16x32_bf16 v[136:139], a[12:15], v[216:219], v[136:139]
  v_mfma_f32_16x16x32_bf16 v[140:143], a[16:19], v[216:219], v[140:143]
  v_mfma_f32_16x16x32_bf16 v[144:147], a[20:23], v[216:219], v[144:147]
  ds_read_b128 v[188:191], v18 offset:14336
  s_waitcnt lgkmcnt(8)
  v_mfma_f32_16x16x32_bf16 v[148:151], a[12:15], v[220:223], v[148:151]
  v_mfma_f32_16x16x32_bf16 v[152:155], a[16:19], v[220:223], v[152:155]
  v_mfma_f32_16x16x32_bf16 v[156:159], a[20:23], v[220:223], v[156:159]
  ds_read_b128 v[192:195], v19 offset:0
  s_waitcnt lgkmcnt(8)
  v_mfma_f32_16x16x32_bf16 v[64:67], a[24:27], v[160:163], v[64:67]
  v_mfma_f32_16x16x32_bf16 v[68:71], a[28:31], v[160:163], v[68:71]
  v_mfma_f32_16x16x32_bf16 v[72:75], a[32:35], v[160:163], v[72:75]
  ds_read_b128 v[232:235], v23 offset:128
  ds_read_b128 v[196:199], v19 offset:2048
  s_waitcnt lgkmcnt(8)
  v_mfma_f32_16x16x32_bf16 v[76:79], a[24:27], v[164:167], v[76:79]
  v_mfma_f32_16x16x32_bf16 v[80:83], a[28:31], v[164:167], v[80:83]
  v_mfma_f32_16x16x32_bf16 v[84:87], a[32:35], v[164:167], v[84:87]
  s_add_u32 s46, s46, 10240
  s_add_u32 m0, s47, 2048
  s_nop 0
  buffer_load_dwordx4 v10, s[8:11], s46 offen lds
  ds_read_b128 v[200:203], v19 offset:4096
  s_waitcnt lgkmcnt(8)
  v_mfma_f32_16x16x32_bf16 v[88:91], a[24:27], v[168:171], v[88:91]
  v_mfma_f32_16x16x32_bf16 v[92:95], a[28:31], v[168:171], v[92:95]
  v_mfma_f32_16x16x32_bf16 v[96:99], a[32:35], v[168:171], v[96:99]
  ds_read_b128 v[204:207], v19 offset:6144
  s_waitcnt lgkmcnt(8)
  v_mfma_f32_16x16x32_bf16 v[100:103], a[24:27], v[172:175], v[100:103]
  v_mfma_f32_16x16x32_bf16 v[104:107], a[28:31], v[172:175], v[104:107]
  v_mfma_f32_16x16x32_bf16 v[108:111], a[32:35], v[172:175], v[108:111]
  s_add_u32 s21, s48, 0
  buffer_store_dwordx4 v[224:227], v26, s[16:19], s21 offen offset:0 sc1
  ds_read_b128 v[208:211], v19 offset:8192
  s_waitcnt lgkmcnt(8)
  v_mfma_f32_16x16x32_bf16 v[112:115], a[24:27], v[176:179], v[112:115]
  v_mfma_f32_16x16x32_bf16 v[116:119], a[28:31], v[176:179], v[116:119]
  v_mfma_f32_16x16x32_bf16 v[120:123], a[32:35], v[176:179], v[120:123]
  ds_read_b128 v[236:239], v23 offset:192
  ds_read_b128 v[212:215], v19 offset:10240
  s_waitcnt lgkmcnt(8)
  v_mfma_f32_16x16x32_bf16 v[124:127], a[24:27], v[180:183], v[124:127]
  v_mfma_f32_16x16x32_bf16 v[128:131], a[28:31], v[180:183], v[128:131]
  v_mfma_f32_16x16x32_bf16 v[132:135], a[32:35], v[180:183], v[132:135]
  s_add_u32 s46, s46, 10240
  s_add_u32 m0, s47, 3072
  s_nop 0
  buffer_load_dwordx4 v10, s[8:11], s46 offen lds
  ds_read_b128 v[216:219], v19 offset:12288
  s_waitcnt lgkmcnt(8)
  v_mfma_f32_16x16x32_bf16 v[136:139], a[24:27], v[184:187], v[136:139]
  v_mfma_f32_16x16x32_bf16 v[140:143], a[28:31], v[184:187], v[140:143]
  v_mfma_f32_16x16x32_bf16 v[144:147], a[32:35], v[184:187], v[144:147]
  s_add_u32 s21, s48, 0
  buffer_store_dwordx4 v[228:231], v26, s[16:19], s21 offen offset:1024 sc1
  ds_read_b128 v[220:223], v19 offset:14336
  s_waitcnt lgkmcnt(8)
  v_mfma_f32_16x16x32_bf16 v[148:151], a[24:27], v[188:191], v[148:151]
  v_mfma_f32_16x16x32_bf16 v[152:155], a[28:31], v[188:191], v[152:155]
  v_mfma_f32_16x16x32_bf16 v[156:159], a[32:35], v[188:191], v[156:159]
  s_waitcnt vmcnt(14)
  s_barrier
  s_add_u32 s30, s30, 128
  s_add_u32 s31, s31, 1
  s_cmp_lt_u32 s31, 10
  s_cbranch_scc1 kv_221
  s_mov_b32 s31, 0
  s_add_u32 s30, s30, s25
  s_sub_u32 s30, s30, 1280
kv_221:
  s_add_u32 s32, s32, 16384
  s_cmp_lt_u32 s32, 98304
  s_cselect_b32 s32, s32, 0
  s_mul_i32 s46, s20, 40960
  s_add_u32 s46, s46, s30
  s_lshl_b32 s47, s20, 12
  s_add_u32 s47, s47, s32
  v_add_u32 v18, s33, v14
  v_add_u32 v19, s33, v15
  s_add_u32 s33, s33, 16384
  s_cmp_lt_u32 s33, 98304
  s_cselect_b32 s33, s33, 0
  ds_read_b128 v[160:163], v18 offset:0
  s_waitcnt lgkmcnt(8)
  v_mfma_f32_16x16x32_bf16 v[64:67], a[36:39], v[192:195], v[64:67]
  v_mfma_f32_16x16x32_bf16 v[68:71], a[40:43], v[192:195], v[68:71]
  v_mfma_f32_16x16x32_bf16 v[72:75], a[44:47], v[192:195], v[72:75]
  ds_read_b128 v[240:243], v23 offset:256
  ds_read_b128 v[164:167], v18 offset:2048
  s_waitcnt lgkmcnt(8)
  v_mfma_f32_16x16x32_bf16 v[76:79], a[36:39], v[196:199], v[76:79]
  v_mfma_f32_16x16x32_bf16 v[80:83], a[40:43], v[196:199], v[80:83]
  v_mfma_f32_16x16x32_bf16 v[84:87], a[44:47], v[196:199], v[84:87]
  s_add_u32 m0, s47, 0
  s_nop 0
  buffer_load_dwordx4 v10, s[8:11], s46 offen lds
  ds_read_b128 v[168:171], v18 offset:4096
  s_waitcnt lgkmcnt(8)
  v_mfma_f32_16x16x32_bf16 v[88:91], a[36:39], v[200:203], v[88:91]
  v_mfma_f32_16x16x32_bf16 v[92:95], a[40:43], v[200:203], v[92:95]
  v_mfma_f32_16x16x32_bf16 v[96:99], a[44:47], v[200:203], v[96:99]
  ds_read_b128 v[172:175], v18 offset:6144
  s_waitcnt lgkmcnt(8)
  v_mfma_f32_16x16x32_bf16 v[100:103], a[36:39], v[204:207], v[100:103]
  v_mfma_f32_16x16x32_bf16 v[104:107], a[40:43], v[204:207], v[104:107]
  v_mfma_f32_16x16x32_bf16 v[108:111], a[44:47], v[204:207], v[108:111]
  s_add_u32 s21, s48, 0
  buffer_store_dwordx4 v[232:235], v26, s[16:19], s21 offen offset:2048 sc1
  ds_read_b128 v[176:179], v18 offset:8192
  s_waitcnt lgkmcnt(8)
  v_mfma_f32_16x16x32_bf16 v[112:115], a[36:39], v[208:211], v[112:115]
  v_mfma_f32_16x16x32_bf16 v[116:119], a[40:43], v[208:211], v[116:119]
  v_mfma_f32_16x16x32_bf16 v[120:123], a[44:47], v[208:211], v[120:123]
  ds_read_b128 v[244:247], v23 offset:320
  ds_read_b128 v[180:183], v18 offset:10240
  s_waitcnt lgkmcnt(8)
  v_mfma_f32_16x16x32_bf16 v[124:127], a[36:39], v[212:215], v[124:127]
  v_mfma_f32_16x16x32_bf16 v[128:131], a[40:43], v[212:215], v[128:131]
  v_mfma_f32_16x16x32_bf16 v[132:135], a[44:47], v[212:215], v[132:135]
  s_add_u32 s46, s46, 10240
  s_add_u32 m0, s47, 1024
  s_nop 0
  buffer_load_dwordx4 v10, s[8:11], s46 offen lds
  ds_read_b128 v[184:187], v18 offset:12288
  s_waitcnt lgkmcnt(8)
  v_mfma_f32_16x16x32_bf16 v[136:139], a[36:39], v[216:219], v[136:139]
  v_mfma_f32_16x16x32_bf16 v[140:143], a[40:43], v[216:219], v[140:143]
  v_mfma_f32_16x16x32_bf16 v[144:147], a[44:47], v[216:219], v[144:147]
  s_add_u32 s21, s48, 0
  buffer_store_dwordx4 v[236:239], v26, s[16:19], s21 offen offset:3072 sc1
  ds_read_b128 v[188:191], v18 offset:14336
  s_waitcnt lgkmcnt(8)
  v_mfma_f32_16x16x32_bf16 v[148:151], a[36:39], v[220:223], v[148:151]
  v_mfma_f32_16x16x32_bf16 v[152:155], a[40:43], v[220:223], v[152:155]
  v_mfma_f32_16x16x32_bf16 v[156:159], a[44:47], v[220:223], v[156:159]
  ds_read_b128 v[192:195], v19 offset:0
  s_waitcnt lgkmcnt(8)
  v_mfma_f32_16x16x32_bf16 v[64:67], a[48:51], v[160:163], v[64:67]
  v_mfma_f32_16x16x32_bf16 v[68:71], a[52:55], v[160:163], v[68:71]
  v_mfma_f32_16x16x32_bf16 v[72:75], a[56:59], v[160:163], v[72:75]
  ds_read_b128 v[224:227], v23 offset:6400
  ds_read_b128 v[196:199], v19 offset:2048
  s_waitcnt lgkmcnt(8)
  v_mfma_f32_16x16x32_bf16 v[76:79], a[48:51], v[164:167], v[76:79]
  v_mfma_f32_16x16x32_bf16 v[80:83], a[52:55], v[164:167], v[80:83]
  v_mfma_f32_16x16x32_bf16 v[84:87], a[56:59], v[164:167], v[84:87]
  s_add_u32 s46, s46, 10240
  s_add_u32 m0, s47, 2048
  s_nop 0
  buffer_load_dwordx4 v10, s[8:11], s46 offen lds
  ds_read_b128 v[200:203], v19 offset:4096
  s_waitcnt lgkmcnt(8)
  v_mfma_f32_16x16x32_bf16 v[88:91], a[48:51], v[168:171], v[88:91]
  v_mfma_f32_16x16x32_bf16 v[92:95], a[52:55], v[168:171], v[92:95]
  v_mfma_f32_16x16x32_bf16 v[96:99], a[56:59], v[168:171], v[96:99]
  ds_read_b128 v[204:207], v19 offset:6144
  s_waitcnt lgkmcnt(8)
  v_mfma_f32_16x16x32_bf16 v[100:103], a[48:51], v[172:175], v[100:103]
  v_mfma_f32_16x16x32_bf16 v[104:107], a[52:55], v[172:175], v[104:107]
  v_mfma_f32_16x16x32_bf16 v[108:111], a[56:59], v[172:175], v[108:111]
  s_add_u32 s21, s48, 4096
  buffer_store_dwordx4 v[240:243], v26, s[16:19], s21 offen offset:0 sc1
  ds_read_b128 v[208:211], v19 offset:8192
  s_waitcnt lgkmcnt(8)
  v_mfma_f32_16x16x32_bf16 v[112:115], a[48:51], v[176:179], v[112:115]
  v_mfma_f32_16x16x32_bf16 v[116:119], a[52:55], v[176:179], v[116:119]
  v_mfma_f32_16x16x32_bf16 v[120:123], a[56:59], v[176:179], v[120:123]
  ds_read_b128 v[228:231], v23 offset:6464
  ds_read_b128 v[212:215], v19 offset:10240
  s_waitcnt lgkmcnt(8)
  v_mfma_f32_16x16x32_bf16 v[124:127], a[48:51], v[180:183], v[124:127]
  v_mfma_f32_16x16x32_bf16 v[128:131], a[52:55], v[180:183], v[128:131]
  v_mfma_f32_16x16x32_bf16 v[132:135], a[56:59], v[180:183], v[132:135]
  s_add_u32 s46, s46, 10240
  s_add_u32 m0, s47, 3072
  s_nop 0
  buffer_load_dwordx4 v10, s[8:11], s46 offen lds
  ds_read_b128 v[216:219], v19 offset:12288
  s_waitcnt lgkmcnt(8)
  v_mfma_f32_16x16x32_bf16 v[136:139], a[48:51], v[184:187], v[136:139]
  v_mfma_f32_16x16x32_bf16 v[140:143], a[52:55], v[184:187], v[140:143]
  v_mfma_f32_16x16x32_bf16 v[144:147], a[56:59], v[184:187], v[144:147]
  s_add_u32 s21, s48, 4096
  buffer_store_dwordx4 v[244:247], v26, s[16:19], s21 offen offset:1024 sc1
  ds_read_b128 v[220:223], v19 offset:14336
  s_waitcnt lgkmcnt(8)
  v_mfma_f32_16x16x32_bf16 v[148:151], a[48:51], v[188:191], v[148:151]
  v_mfma_f32_16x16x32_bf16 v[152:155], a[52:55], v[188:191], v[152:155]
  v_mfma_f32_16x16x32_bf16 v[156:159], a[56:59], v[188:191], v[156:159]
  s_waitcnt vmcnt(18)
  s_barrier
  s_add_u32 s30, s30, 128
  s_add_u32 s31, s31, 1
  s_cmp_lt_u32 s31, 10
  s_cbranch_scc1 kv_222
  s_mov_b32 s31, 0
  s_add_u32 s30, s30, s25
  s_sub_u32 s30, s30, 1280
kv_222:
  s_add_u32 s32, s32, 16384
  s_cmp_lt_u32 s32, 98304
  s_cselect_b32 s32, s32, 0
  s_mul_i32 s46, s20, 40960
  s_add_u32 s46, s46, s30
  s_lshl_b32 s47, s20, 12
  s_add_u32 s47, s47, s32
  v_add_u32 v18, s33, v14
  v_add_u32 v19, s33, v15
  s_add_u32 s33, s33, 16384
  s_cmp_lt_u32 s33, 98304
  s_cselect_b32 s33, s33, 0
  ds_read_b128 v[160:163], v18 offset:0
  s_waitcnt lgkmcnt(8)
  v_mfma_f32_16x16x32_bf16 v[64:67], a[60:63], v[192:195], v[64:67]
  v_mfma_f32_16x16x32_bf16 v[68:71], a[64:67], v[192:195], v[68:71]
  v_mfma_f32_16x16x32_bf16 v[72:75], a[68:71], v[192:195], v[72:75]
  ds_read_b128 v[232:235], v23 offset:6528
  ds_read_b128 v[164:167], v18 offset:2048
  s_waitcnt lgkmcnt(8)
  v_mfma_f32_16x16x32_bf16 v[76:79], a[60:63], v[196:199], v[76:79]
  v_mfma_f32_16x16x32_bf16 v[80:83], a[64:67], v[196:199], v[80:83]
  v_mfma_f32_16x16x32_bf16 v[84:87], a[68:71], v[196:199], v[84:87]
  s_add_u32 m0, s47, 0
  s_nop 0
  buffer_load_dwordx4 v10, s[8:11], s46 offen lds
  ds_read_b128 v[168:171], v18 offset:4096
  s_waitcnt lgkmcnt(8)
  v_mfma_f32_16x16x32_bf16 v[88:91], a[60:63], v[200:203], v[88:91]
  v_mfma_f32_16x16x32_bf16 v[92:95], a[64:67], v[200:203], v[92:95]
  v_mfma_f32_16x16x32_bf16 v[96:99], a[68:71], v[200:203], v[96:99]
  ds_read_b128 v[172:175], v18 offset:6144
  s_waitcnt lgkmcnt(8)
  v_mfma_f32_16x16x32_bf16 v[100:103], a[60:63], v[204:207], v[100:103]
  v_mfma_f32_16x16x32_bf16 v[104:107], a[64:67], v[204:207], v[104:107]
  v_mfma_f32_16x16x32_bf16 v[108:111], a[68:71], v[204:207], v[108:111]
  s_add_u32 s21, s48, 4096
  buffer_store_dwordx4 v[224:227], v26, s[16:19], s21 offen offset:2048 sc1
  ds_read_b128 v[176:179], v18 offset:8192
  s_waitcnt lgkmcnt(8)
  v_mfma_f32_16x16x32_bf16 v[112:115], a[60:63], v[208:211], v[112:115]
  v_mfma_f32_16x16x32_bf16 v[116:119], a[64:67], v[208:211], v[116:119]
  v_mfma_f32_16x16x32_bf16 v[120:123], a[68:71], v[208:211], v[120:123]
  ds_read_b128 v[236:239], v23 offset:6592
  ds_read_b128 v[180:183], v18 offset:10240
  s_waitcnt lgkmcnt(8)
  v_mfma_f32_16x16x32_bf16 v[124:127], a[60:63], v[212:215], v[124:127]
  v_mfma_f32_16x16x32_bf16 v[128:131], a[64:67], v[212:215], v[128:131]
  v_mfma_f32_16x16x32_bf16 v[132:135], a[68:71], v[212:215], v[132:135]
  s_add_u32 s46, s46, 10240
  s_add_u32 m0, s47, 1024
  s_nop 0
  buffer_load_dwordx4 v10, s[8:11], s46 offen lds
  ds_read_b128 v[184:187], v18 offset:12288
  s_waitcnt lgkmcnt(8)
  v_mfma_f32_16x16x32_bf16 v[136:139], a[60:63], v[216:219], v[136:139]
  v_mfma_f32_16x16x32_bf16 v[140:143], a[64:67], v[216:219], v[140:143]
  v_mfma_f32_16x16x32_bf16 v[144:147], a[68:71], v[216:219], v[144:147]
  s_add_u32 s21, s48, 4096
  buffer_store_dwordx4 v[228:231], v26, s[16:19], s21 offen offset:3072 sc1
  ds_read_b128 v[188:191], v18 offset:14336
  s_waitcnt lgkmcnt(8)
  v_mfma_f32_16x16x32_bf16 v[148:151], a[60:63], v[220:223], v[148:151]
  v_mfma_f32_16x16x32_bf16 v[152:155], a[64:67], v[220:223], v[152:155]
  v_mfma_f32_16x16x32_bf16 v[156:159], a[68:71], v[220:223], v[156:159]
  ds_read_b128 v[192:195], v19 offset:0
  s_waitcnt lgkmcnt(8)
  v_mfma_f32_16x16x32_bf16 v[64:67], a[72:75], v[160:163], v[64:67]
  v_mfma_f32_16x16x32_bf16 v[68:71], a[76:79], v[160:163], v[68:71]
  v_mfma_f32_16x16x32_bf16 v[72:75], a[80:83], v[160:163], v[72:75]
  ds_read_b128 v[240:243], v23 offset:6656
  ds_read_b128 v[196:199], v19 offset:2048
  s_waitcnt lgkmcnt(8)
  v_mfma_f32_16x16x32_bf16 v[76:79], a[72:75], v[164:167], v[76:79]
  v_mfma_f32_16x16x32_bf16 v[80:83], a[76:79], v[164:167], v[80:83]
  v_mfma_f32_16x16x32_bf16 v[84:87], a[80:83], v[164:167], v[84:87]
  s_add_u32 s46, s46, 10240
  s_add_u32 m0, s47, 2048
  s_nop 0
  buffer_load_dwordx4 v10, s[8:11], s46 offen lds
  ds_read_b128 v[200:203], v19 offset:4096
  s_waitcnt lgkmcnt(8)
  v_mfma_f32_16x16x32_bf16 v[88:91], a[72:75], v[168:171], v[88:91]
  v_mfma_f32_16x16x32_bf16 v[92:95], a[76:79], v[168:171], v[92:95]
  v_mfma_f32_16x16x32_bf16 v[96:99], a[80:83], v[168:171], v[96:99]
  ds_read_b128 v[204:207], v19 offset:6144
  s_waitcnt lgkmcnt(8)
  v_mfma_f32_16x16x32_bf16 v[100:103], a[72:75], v[172:175], v[100:103]
  v_mfma_f32_16x16x32_bf16 v[104:107], a[76:79], v[172:175], v[104:107]
  v_mfma_f32_16x16x32_bf16 v[108:111], a[80:83], v[172:175], v[108:111]
  s_add_u32 s21, s48, 8192
  buffer_store_dwordx4 v[232:235], v26, s[16:19], s21 offen offset:0 sc1
  ds_read_b128 v[208:211], v19 offset:8192
  s_waitcnt lgkmcnt(8)
  v_mfma_f32_16x16x32_bf16 v[112:115], a[72:75], v[176:179], v[112:115]
  v_mfma_f32_16x16x32_bf16 v[116:119], a[76:79], v[176:179], v[116:119]
  v_mfma_f32_16x16x32_bf16 v[120:123], a[80:83], v[176:179], v[120:123]
  ds_read_b128 v[244:247], v23 offset:6720
  ds_read_b128 v[212:215], v19 offset:10240
  s_waitcnt lgkmcnt(8)
  v_mfma_f32_16x16x32_bf16 v[124:127], a[72:75], v[180:183], v[124:127]
  v_mfma_f32_16x16x32_bf16 v[128:131], a[76:79], v[180:183], v[128:131]
  v_mfma_f32_16x16x32_bf16 v[132:135], a[80:83], v[180:183], v[132:135]
  s_add_u32 s46, s46, 10240
  s_add_u32 m0, s47, 3072
  s_nop 0
  buffer_load_dwordx4 v10, s[8:11], s46 offen lds
  ds_read_b128 v[216:219], v19 offset:12288
  s_waitcnt lgkmcnt(8)
  v_mfma_f32_16x16x32_bf16 v[136:139], a[72:75], v[184:187], v[136:139]
  v_mfma_f32_16x16x32_bf16 v[140:143], a[76:79], v[184:187], v[140:143]
  v_mfma_f32_16x16x32_bf16 v[144:147], a[80:83], v[184:187], v[144:147]
  s_add_u32 s21, s48, 8192
  buffer_store_dwordx4 v[236:239], v26, s[16:19], s21 offen offset:1024 sc1
  ds_read_b128 v[220:223], v19 offset:14336
  s_waitcnt lgkmcnt(8)
  v_mfma_f32_16x16x32_bf16 v[148:151], a[72:75], v[188:191], v[148:151]
  v_mfma_f32_16x16x32_bf16 v[152:155], a[76:79], v[188:191], v[152:155]
  v_mfma_f32_16x16x32_bf16 v[156:159], a[80:83], v[188:191], v[156:159]
  s_waitcnt vmcnt(22)
  s_barrier
  s_add_u32 s30, s30, 128
  s_add_u32 s31, s31, 1
  s_cmp_lt_u32 s31, 10
  s_cbranch_scc1 kv_223
  s_mov_b32 s31, 0
  s_add_u32 s30, s30, s25
  s_sub_u32 s30, s30, 1280
kv_223:
  s_add_u32 s32, s32, 16384
  s_cmp_lt_u32 s32, 98304
  s_cselect_b32 s32, s32, 0
  s_mul_i32 s46, s20, 40960
  s_add_u32 s46, s46, s30
  s_lshl_b32 s47, s20, 12
  s_add_u32 s47, s47, s32
  v_add_u32 v18, s33, v14
  v_add_u32 v19, s33, v15
  s_add_u32 s33, s33, 16384
  s_cmp_lt_u32 s33, 98304
  s_cselect_b32 s33, s33, 0
  ds_read_b128 v[160:163], v18 offset:0
  s_waitcnt lgkmcnt(8)
  v_mfma_f32_16x16x32_bf16 v[64:67], a[84:87], v[192:195], v[64:67]
  v_mfma_f32_16x16x32_bf16 v[68:71], a[88:91], v[192:195], v[68:71]
  v_mfma_f32_16x16x32_bf16 v[72:75], a[92:95], v[192:195], v[72:75]
  ds_read_b128 v[164:167], v18 offset:2048
  s_waitcnt lgkmcnt(8)
  v_mfma_f32_16x16x32_bf16 v[76:79], a[84:87], v[196:199], v[76:79]
  v_mfma_f32_16x16x32_bf16 v[80:83], a[88:91], v[196:199], v[80:83]
  v_mfma_f32_16x16x32_bf16 v[84:87], a[92:95], v[196:199], v[84:87]
  s_add_u32 m0, s47, 0
  s_nop 0
  buffer_load_dwordx4 v10, s[8:11], s46 offen lds
  ds_read_b128 v[168:171], v18 offset:4096
  s_waitcnt lgkmcnt(8)
  v_mfma_f32_16x16x32_bf16 v[88:91], a[84:87], v[200:203], v[88:91]
  v_mfma_f32_16x16x32_bf16 v[92:95], a[88:91], v[200:203], v[92:95]
  v_mfma_f32_16x16x32_bf16 v[96:99], a[92:95], v[200:203], v[96:99]
  ds_read_b128 v[172:175], v18 offset:6144
  s_waitcnt lgkmcnt(8)
  v_mfma_f32_16x16x32_bf16 v[100:103], a[84:87], v[204:207], v[100:103]
  v_mfma_f32_16x16x32_bf16 v[104:107], a[88:91], v[204:207], v[104:107]
  v_mfma_f32_16x16x32_bf16 v[108:111], a[92:95], v[204:207], v[108:111]
  s_add_u32 s21, s48, 8192
  buffer_store_dwordx4 v[240:243], v26, s[16:19], s21 offen offset:2048 sc1
  ds_read_b128 v[176:179], v18 offset:8192
  s_waitcnt lgkmcnt(8)
  v_mfma_f32_16x16x32_bf16 v[112:115], a[84:87], v[208:211], v[112:115]
  v_mfma_f32_16x16x32_bf16 v[116:119], a[88:91], v[208:211], v[116:119]
  v_mfma_f32_16x16x32_bf16 v[120:123], a[92:95], v[208:211], v[120:123]
  ds_read_b128 v[180:183], v18 offset:10240
  s_waitcnt lgkmcnt(8)
  v_mfma_f32_16x16x32_bf16 v[124:127], a[84:87], v[212:215], v[124:127]
  v_mfma_f32_16x16x32_bf16 v[128:131], a[88:91], v[212:215], v[128:131]
  v_mfma_f32_16x16x32_bf16 v[132:135], a[92:95], v[212:215], v[132:135]
  s_add_u32 s46, s46, 10240
  s_add_u32 m0, s47, 1024
  s_nop 0
  buffer_load_dwordx4 v10, s[8:11], s46 offen lds
  ds_read_b128 v[184:187], v18 offset:12288
  s_waitcnt lgkmcnt(8)
  v_mfma_f32_16x16x32_bf16 v[136:139], a[84:87], v[216:219], v[136:139]
  v_mfma_f32_16x16x32_bf16 v[140:143], a[88:91], v[216:219], v[140:143]
  v_mfma_f32_16x16x32_bf16 v[144:147], a[92:95], v[216:219], v[144:147]
  s_add_u32 s21, s48, 8192
  buffer_store_dwordx4 v[244:247], v26, s[16:19], s21 offen offset:3072 sc1
  ds_read_b128 v[188:191], v18 offset:14336
  s_waitcnt lgkmcnt(8)
  v_mfma_f32_16x16x32_bf16 v[148:151], a[84:87], v[220:223], v[148:151]
  v_mfma_f32_16x16x32_bf16 v[152:155], a[88:91], v[220:223], v[152:155]
  v_mfma_f32_16x16x32_bf16 v[156:159], a[92:95], v[220:223], v[156:159]
  ds_read_b128 v[192:195], v19 offset:0
  s_waitcnt lgkmcnt(8)
  v_mfma_f32_16x16x32_bf16 v[64:67], a[96:99], v[160:163], v[64:67]
  v_mfma_f32_16x16x32_bf16 v[68:71], a[100:103], v[160:163], v[68:71]
  v_mfma_f32_16x16x32_bf16 v[72:75], a[104:107], v[160:163], v[72:75]
  ds_read_b128 v[196:199], v19 offset:2048
  s_waitcnt lgkmcnt(8)
  v_mfma_f32_16x16x32_bf16 v[76:79], a[96:99], v[164:167], v[76:79]
  v_mfma_f32_16x16x32_bf16 v[80:83], a[100:103], v[164:167], v[80:83]
  v_mfma_f32_16x16x32_bf16 v[84:87], a[104:107], v[164:167], v[84:87]
  s_add_u32 s46, s46, 10240
  s_add_u32 m0, s47, 2048
  s_nop 0
  buffer_load_dwordx4 v10, s[8:11], s46 offen lds
  ds_read_b128 v[200:203], v19 offset:4096
  s_waitcnt lgkmcnt(8)
  v_mfma_f32_16x16x32_bf16 v[88:91], a[96:99], v[168:171], v[88:91]
  v_mfma_f32_16x16x32_bf16 v[92:95], a[100:103], v[168:171], v[92:95]
  v_mfma_f32_16x16x32_bf16 v[96:99], a[104:107], v[168:171], v[96:99]
  ds_read_b128 v[204:207], v19 offset:6144
  s_waitcnt lgkmcnt(8)
  v_mfma_f32_16x16x32_bf16 v[100:103], a[96:99], v[172:175], v[100:103]
  v_mfma_f32_16x16x32_bf16 v[104:107], a[100:103], v[172:175], v[104:107]
  v_mfma_f32_16x16x32_bf16 v[108:111], a[104:107], v[172:175], v[108:111]
  ds_read_b128 v[208:211], v19 offset:8192
  s_waitcnt lgkmcnt(8)
  v_mfma_f32_16x16x32_bf16 v[112:115], a[96:99], v[176:179], v[112:115]
  v_mfma_f32_16x16x32_bf16 v[116:119], a[100:103], v[176:179], v[116:119]
  v_mfma_f32_16x16x32_bf16 v[120:123], a[104:107], v[176:179], v[120:123]
  ds_read_b128 v[212:215], v19 offset:10240
  s_waitcnt lgkmcnt(8)
  v_mfma_f32_16x16x32_bf16 v[124:127], a[96:99], v[180:183], v[124:127]
  v_mfma_f32_16x16x32_bf16 v[128:131], a[100:103], v[180:183], v[128:131]
  v_mfma_f32_16x16x32_bf16 v[132:135], a[104:107], v[180:183], v[132:135]
  s_add_u32 s46, s46, 10240
  s_add_u32 m0, s47, 3072
  s_nop 0
  buffer_load_dwordx4 v10, s[8:11], s46 offen lds
  ds_read_b128 v[216:219], v19 offset:12288
  s_waitcnt lgkmcnt(8)
  v_mfma_f32_16x16x32_bf16 v[136:139], a[96:99], v[184:187], v[136:139]
  v_mfma_f32_16x16x32_bf16 v[140:143], a[100:103], v[184:187], v[140:143]
  v_mfma_f32_16x16x32_bf16 v[144:147], a[104:107], v[184:187], v[144:147]
  ds_read_b128 v[220:223], v19 offset:14336
  s_waitcnt lgkmcnt(8)
  v_mfma_f32_16x16x32_bf16 v[148:151], a[96:99], v[188:191], v[148:151]
  v_mfma_f32_16x16x32_bf16 v[152:155], a[100:103], v[188:191], v[152:155]
  v_mfma_f32_16x16x32_bf16 v[156:159], a[104:107], v[188:191], v[156:159]
  s_waitcnt vmcnt(23)
  s_barrier
  s_add_u32 s30, s30, 128
  s_add_u32 s31, s31, 1
  s_cmp_lt_u32 s31, 10
  s_cbranch_scc1 kv_224
  s_mov_b32 s31, 0
  s_add_u32 s30, s30, s25
  s_sub_u32 s30, s30, 1280
kv_224:
  s_add_u32 s32, s32, 16384
  s_cmp_lt_u32 s32, 98304
  s_cselect_b32 s32, s32, 0
  s_mul_i32 s46, s20, 40960
  s_add_u32 s46, s46, s30
  s_lshl_b32 s47, s20, 12
  s_add_u32 s47, s47, s32
  v_add_u32 v18, s33, v14
  v_add_u32 v19, s33, v15
  s_add_u32 s33, s33, 16384
  s_cmp_lt_u32 s33, 98304
  s_cselect_b32 s33, s33, 0
  ds_read_b128 v[160:163], v18 offset:0
  s_waitcnt lgkmcnt(8)
  v_mfma_f32_16x16x32_bf16 v[64:67], a[108:111], v[192:195], v[64:67]
  v_mfma_f32_16x16x32_bf16 v[68:71], a[112:115], v[192:195], v[68:71]
  v_mfma_f32_16x16x32_bf16 v[72:75], a[116:119], v[192:195], v[72:75]
  ds_read_b128 v[164:167], v18 offset:2048
  s_waitcnt lgkmcnt(8)
  v_mfma_f32_16x16x32_bf16 v[76:79], a[108:111], v[196:199], v[76:79]
  v_mfma_f32_16x16x32_bf16 v[80:83], a[112:115], v[196:199], v[80:83]
  v_mfma_f32_16x16x32_bf16 v[84:87], a[116:119], v[196:199], v[84:87]
  s_add_u32 m0, s47, 0
  s_nop 0
  buffer_load_dwordx4 v10, s[8:11], s46 offen lds
  ds_read_b128 v[168:171], v18 offset:4096
  s_waitcnt lgkmcnt(8)
  v_mfma_f32_16x16x32_bf16 v[88:91], a[108:111], v[200:203], v[88:91]
  v_mfma_f32_16x16x32_bf16 v[92:95], a[112:115], v[200:203], v[92:95]
  v_mfma_f32_16x16x32_bf16 v[96:99], a[116:119], v[200:203], v[96:99]
  ds_read_b128 v[172:175], v18 offset:6144
  s_waitcnt lgkmcnt(8)
  v_mfma_f32_16x16x32_bf16 v[100:103], a[108:111], v[204:207], v[100:103]
  v_mfma_f32_16x16x32_bf16 v[104:107], a[112:115], v[204:207], v[104:107]
  v_mfma_f32_16x16x32_bf16 v[108:111], a[116:119], v[204:207], v[108:111]
  ds_read_b128 v[176:179], v18 offset:8192
  s_waitcnt lgkmcnt(8)
  v_mfma_f32_16x16x32_bf16 v[112:115], a[108:111], v[208:211], v[112:115]
  v_mfma_f32_16x16x32_bf16 v[116:119], a[112:115], v[208:211], v[116:119]
  v_mfma_f32_16x16x32_bf16 v[120:123], a[116:119], v[208:211], v[120:123]
  ds_read_b128 v[180:183], v18 offset:10240
  s_waitcnt lgkmcnt(8)
  v_mfma_f32_16x16x32_bf16 v[124:127], a[108:111], v[212:215], v[124:127]
  v_mfma_f32_16x16x32_bf16 v[128:131], a[112:115], v[212:215], v[128:131]
  v_mfma_f32_16x16x32_bf16 v[132:135], a[116:119], v[212:215], v[132:135]
  s_add_u32 s46, s46, 10240
  s_add_u32 m0, s47, 1024
  s_nop 0
  buffer_load_dwordx4 v10, s[8:11], s46 offen lds
  ds_read_b128 v[184:187], v18 offset:12288
  s_waitcnt lgkmcnt(8)
  v_mfma_f32_16x16x32_bf16 v[136:139], a[108:111], v[216:219], v[136:139]
  v_mfma_f32_16x16x32_bf16 v[140:143], a[112:115], v[216:219], v[140:143]
  v_mfma_f32_16x16x32_bf16 v[144:147], a[116:119], v[216:219], v[144:147]
  ds_read_b128 v[188:191], v18 offset:14336
  s_waitcnt lgkmcnt(8)
  v_mfma_f32_16x16x32_bf16 v[148:151], a[108:111], v[220:223], v[148:151]
  v_mfma_f32_16x16x32_bf16 v[152:155], a[112:115], v[220:223], v[152:155]
  v_mfma_f32_16x16x32_bf16 v[156:159], a[116:119], v[220:223], v[156:159]
  ds_read_b128 v[192:195], v19 offset:0
  s_waitcnt lgkmcnt(8)
  v_mfma_f32_16x16x32_bf16 v[64:67], a[120:123], v[160:163], v[64:67]
  v_mfma_f32_16x16x32_bf16 v[68:71], a[124:127], v[160:163], v[68:71]
  v_mfma_f32_16x16x32_bf16 v[72:75], a[128:131], v[160:163], v[72:75]
  ds_read_b128 v[196:199], v19 offset:2048
  s_waitcnt lgkmcnt(8)
  v_mfma_f32_16x16x32_bf16 v[76:79], a[120:123], v[164:167], v[76:79]
  v_mfma_f32_16x16x32_bf16 v[80:83], a[124:127], v[164:167], v[80:83]
  v_mfma_f32_16x16x32_bf16 v[84:87], a[128:131], v[164:167], v[84:87]
  s_add_u32 s46, s46, 10240
  s_add_u32 m0, s47, 2048
  s_nop 0
  buffer_load_dwordx4 v10, s[8:11], s46 offen lds
  ds_read_b128 v[200:203], v19 offset:4096
  s_waitcnt lgkmcnt(8)
  v_mfma_f32_16x16x32_bf16 v[88:91], a[120:123], v[168:171], v[88:91]
  v_mfma_f32_16x16x32_bf16 v[92:95], a[124:127], v[168:171], v[92:95]
  v_mfma_f32_16x16x32_bf16 v[96:99], a[128:131], v[168:171], v[96:99]
  ds_read_b128 v[204:207], v19 offset:6144
  s_waitcnt lgkmcnt(8)
  v_mfma_f32_16x16x32_bf16 v[100:103], a[120:123], v[172:175], v[100:103]
  v_mfma_f32_16x16x32_bf16 v[104:107], a[124:127], v[172:175], v[104:107]
  v_mfma_f32_16x16x32_bf16 v[108:111], a[128:131], v[172:175], v[108:111]
  ds_read_b128 v[208:211], v19 offset:8192
  s_waitcnt lgkmcnt(8)
  v_mfma_f32_16x16x32_bf16 v[112:115], a[120:123], v[176:179], v[112:115]
  v_mfma_f32_16x16x32_bf16 v[116:119], a[124:127], v[176:179], v[116:119]
  v_mfma_f32_16x16x32_bf16 v[120:123], a[128:131], v[176:179], v[120:123]
  ds_read_b128 v[212:215], v19 offset:10240
  s_waitcnt lgkmcnt(8)
  v_mfma_f32_16x16x32_bf16 v[124:127], a[120:123], v[180:183], v[124:127]
  v_mfma_f32_16x16x32_bf16 v[128:131], a[124:127], v[180:183], v[128:131]
  v_mfma_f32_16x16x32_bf16 v[132:135], a[128:131], v[180:183], v[132:135]
  s_add_u32 s46, s46, 10240
  s_add_u32 m0, s47, 3072
  s_nop 0
  buffer_load_dwordx4 v10, s[8:11], s46 offen lds
  ds_read_b128 v[216:219], v19 offset:12288
  s_waitcnt lgkmcnt(8)
  v_mfma_f32_16x16x32_bf16 v[136:139], a[120:123], v[184:187], v[136:139]
  v_mfma_f32_16x16x32_bf16 v[140:143], a[124:127], v[184:187], v[140:143]
  v_mfma_f32_16x16x32_bf16 v[144:147], a[128:131], v[184:187], v[144:147]
  ds_read_b128 v[220:223], v19 offset:14336
  s_waitcnt lgkmcnt(8)
  v_mfma_f32_16x16x32_bf16 v[148:151], a[120:123], v[188:191], v[148:151]
  v_mfma_f32_16x16x32_bf16 v[152:155], a[124:127], v[188:191], v[152:155]
  v_mfma_f32_16x16x32_bf16 v[156:159], a[128:131], v[188:191], v[156:159]
  s_waitcnt vmcnt(6)
  s_barrier
  s_cmp_eq_u32 s48, 0x80000000
  s_cbranch_scc1 kv_225
  s_cmp_lg_u32 s20, 0
  s_cbranch_scc1 af_226
  v_mov_b32 v4, 0
  v_mov_b32 v5, 1
  s_mov_b64 exec, 1
  buffer_atomic_add v5, v4, s[72:75], s61 offen sc1
  s_mov_b64 exec, -1
  s_nop 1
af_226:
kv_225:
  s_add_u32 s30, s30, 128
  s_add_u32 s31, s31, 1
  s_cmp_lt_u32 s31, 10
  s_cbranch_scc1 kv_227
  s_mov_b32 s31, 0
  s_add_u32 s30, s30, s25
  s_sub_u32 s30, s30, 1280
kv_227:
  s_add_u32 s32, s32, 16384
  s_cmp_lt_u32 s32, 98304
  s_cselect_b32 s32, s32, 0
  s_mul_i32 s46, s20, 40960
  s_add_u32 s46, s46, s30
  s_lshl_b32 s47, s20, 12
  s_add_u32 s47, s47, s32
  v_add_u32 v18, s33, v14
  v_add_u32 v19, s33, v15
  s_add_u32 s33, s33, 16384
  s_cmp_lt_u32 s33, 98304
  s_cselect_b32 s33, s33, 0
  ds_read_b128 v[160:163], v18 offset:0
  s_waitcnt lgkmcnt(8)
  v_mfma_f32_16x16x32_bf16 v[64:67], a[132:135], v[192:195], v[64:67]
  v_mfma_f32_16x16x32_bf16 v[68:71], a[136:139], v[192:195], v[68:71]
  v_mfma_f32_16x16x32_bf16 v[72:75], a[140:143], v[192:195], v[72:75]
  ds_read_b128 v[164:167], v18 offset:2048
  s_waitcnt lgkmcnt(8)
  v_mfma_f32_16x16x32_bf16 v[76:79], a[132:135], v[196:199], v[76:79]
  v_mfma_f32_16x16x32_bf16 v[80:83], a[136:139], v[196:199], v[80:83]
  v_mfma_f32_16x16x32_bf16 v[84:87], a[140:143], v[196:199], v[84:87]
  s_add_u32 m0, s47, 0
  s_nop 0
  buffer_load_dwordx4 v10, s[8:11], s46 offen lds
  ds_read_b128 v[168:171], v18 offset:4096
  s_waitcnt lgkmcnt(8)
  v_mfma_f32_16x16x32_bf16 v[88:91], a[132:135], v[200:203], v[88:91]
  v_mfma_f32_16x16x32_bf16 v[92:95], a[136:139], v[200:203], v[92:95]
  v_mfma_f32_16x16x32_bf16 v[96:99], a[140:143], v[200:203], v[96:99]
  ds_read_b128 v[172:175], v18 offset:6144
  s_waitcnt lgkmcnt(8)
  v_mfma_f32_16x16x32_bf16 v[100:103], a[132:135], v[204:207], v[100:103]
  v_mfma_f32_16x16x32_bf16 v[104:107], a[136:139], v[204:207], v[104:107]
  v_mfma_f32_16x16x32_bf16 v[108:111], a[140:143], v[204:207], v[108:111]
  ds_read_b128 v[176:179], v18 offset:8192
  s_waitcnt lgkmcnt(8)
  v_mfma_f32_16x16x32_bf16 v[112:115], a[132:135], v[208:211], v[112:115]
  v_mfma_f32_16x16x32_bf16 v[116:119], a[136:139], v[208:211], v[116:119]
  v_mfma_f32_16x16x32_bf16 v[120:123], a[140:143], v[208:211], v[120:123]
  ds_read_b128 v[180:183], v18 offset:10240
  s_waitcnt lgkmcnt(8)
  v_mfma_f32_16x16x32_bf16 v[124:127], a[132:135], v[212:215], v[124:127]
  v_mfma_f32_16x16x32_bf16 v[128:131], a[136:139], v[212:215], v[128:131]
  v_mfma_f32_16x16x32_bf16 v[132:135], a[140:143], v[212:215], v[132:135]
  s_add_u32 s46, s46, 10240
  s_add_u32 m0, s47, 1024
  s_nop 0
  buffer_load_dwordx4 v10, s[8:11], s46 offen lds
  ds_read_b128 v[184:187], v18 offset:12288
  s_waitcnt lgkmcnt(8)
  v_mfma_f32_16x16x32_bf16 v[136:139], a[132:135], v[216:219], v[136:139]
  v_mfma_f32_16x16x32_bf16 v[140:143], a[136:139], v[216:219], v[140:143]
  v_mfma_f32_16x16x32_bf16 v[144:147], a[140:143], v[216:219], v[144:147]
  ds_read_b128 v[188:191], v18 offset:14336
  s_waitcnt lgkmcnt(8)
  v_mfma_f32_16x16x32_bf16 v[148:151], a[132:135], v[220:223], v[148:151]
  v_mfma_f32_16x16x32_bf16 v[152:155], a[136:139], v[220:223], v[152:155]
  v_mfma_f32_16x16x32_bf16 v[156:159], a[140:143], v[220:223], v[156:159]
  ds_read_b128 v[192:195], v19 offset:0
  s_waitcnt lgkmcnt(8)
  v_mfma_f32_16x16x32_bf16 v[64:67], a[144:147], v[160:163], v[64:67]
  v_mfma_f32_16x16x32_bf16 v[68:71], a[148:151], v[160:163], v[68:71]
  v_mfma_f32_16x16x32_bf16 v[72:75], a[152:155], v[160:163], v[72:75]
  ds_read_b128 v[196:199], v19 offset:2048
  s_waitcnt lgkmcnt(8)
  v_mfma_f32_16x16x32_bf16 v[76:79], a[144:147], v[164:167], v[76:79]
  v_mfma_f32_16x16x32_bf16 v[80:83], a[148:151], v[164:167], v[80:83]
  v_mfma_f32_16x16x32_bf16 v[84:87], a[152:155], v[164:167], v[84:87]
  s_add_u32 s46, s46, 10240
  s_add_u32 m0, s47, 2048
  s_nop 0
  buffer_load_dwordx4 v10, s[8:11], s46 offen lds
  ds_read_b128 v[200:203], v19 offset:4096
  s_waitcnt lgkmcnt(8)
  v_mfma_f32_16x16x32_bf16 v[88:91], a[144:147], v[168:171], v[88:91]
  v_mfma_f32_16x16x32_bf16 v[92:95], a[148:151], v[168:171], v[92:95]
  v_mfma_f32_16x16x32_bf16 v[96:99], a[152:155], v[168:171], v[96:99]
  ds_read_b128 v[204:207], v19 offset:6144
  s_waitcnt lgkmcnt(8)
  v_mfma_f32_16x16x32_bf16 v[100:103], a[144:147], v[172:175], v[100:103]
  v_mfma_f32_16x16x32_bf16 v[104:107], a[148:151], v[172:175], v[104:107]
  v_mfma_f32_16x16x32_bf16 v[108:111], a[152:155], v[172:175], v[108:111]
  ds_read_b128 v[208:211], v19 offset:8192
  s_waitcnt lgkmcnt(8)
  v_mfma_f32_16x16x32_bf16 v[112:115], a[144:147], v[176:179], v[112:115]
  v_mfma_f32_16x16x32_bf16 v[116:119], a[148:151], v[176:179], v[116:119]
  v_mfma_f32_16x16x32_bf16 v[120:123], a[152:155], v[176:179], v[120:123]
  ds_read_b128 v[212:215], v19 offset:10240
  s_waitcnt lgkmcnt(8)
  v_mfma_f32_16x16x32_bf16 v[124:127], a[144:147], v[180:183], v[124:127]
  v_mfma_f32_16x16x32_bf16 v[128:131], a[148:151], v[180:183], v[128:131]
  v_mfma_f32_16x16x32_bf16 v[132:135], a[152:155], v[180:183], v[132:135]
  s_add_u32 s46, s46, 10240
  s_add_u32 m0, s47, 3072
  s_nop 0
  buffer_load_dwordx4 v10, s[8:11], s46 offen lds
  ds_read_b128 v[216:219], v19 offset:12288
  s_waitcnt lgkmcnt(8)
  v_mfma_f32_16x16x32_bf16 v[136:139], a[144:147], v[184:187], v[136:139]
  v_mfma_f32_16x16x32_bf16 v[140:143], a[148:151], v[184:187], v[140:143]
  v_mfma_f32_16x16x32_bf16 v[144:147], a[152:155], v[184:187], v[144:147]
  ds_read_b128 v[220:223], v19 offset:14336
  s_waitcnt lgkmcnt(8)
  v_mfma_f32_16x16x32_bf16 v[148:151], a[144:147], v[188:191], v[148:151]
  v_mfma_f32_16x16x32_bf16 v[152:155], a[148:151], v[188:191], v[152:155]
  v_mfma_f32_16x16x32_bf16 v[156:159], a[152:155], v[188:191], v[156:159]
  s_waitcnt vmcnt(15)
  s_barrier
  s_add_u32 s30, s30, 128
  s_add_u32 s31, s31, 1
  s_cmp_lt_u32 s31, 10
  s_cbranch_scc1 kv_228
  s_mov_b32 s31, 0
  s_add_u32 s30, s30, s25
  s_sub_u32 s30, s30, 1280
kv_228:
  s_add_u32 s32, s32, 16384
  s_cmp_lt_u32 s32, 98304
  s_cselect_b32 s32, s32, 0
  s_mul_i32 s46, s20, 40960
  s_add_u32 s46, s46, s30
  s_lshl_b32 s47, s20, 12
  s_add_u32 s47, s47, s32
  v_add_u32 v18, s33, v14
  v_add_u32 v19, s33, v15
  s_add_u32 s33, s33, 16384
  s_cmp_lt_u32 s33, 98304
  s_cselect_b32 s33, s33, 0
  ds_read_b128 v[160:163], v18 offset:0
  s_waitcnt lgkmcnt(8)
  v_mfma_f32_16x16x32_bf16 v[64:67], a[156:159], v[192:195], v[64:67]
  v_mfma_f32_16x16x32_bf16 v[68:71], a[160:163], v[192:195], v[68:71]
  v_mfma_f32_16x16x32_bf16 v[72:75], a[164:167], v[192:195], v[72:75]
  ds_read_b128 v[164:167], v18 offset:2048
  s_waitcnt lgkmcnt(8)
  v_mfma_f32_16x16x32_bf16 v[76:79], a[156:159], v[196:199], v[76:79]
  v_mfma_f32_16x16x32_bf16 v[80:83], a[160:163], v[196:199], v[80:83]
  v_mfma_f32_16x16x32_bf16 v[84:87], a[164:167], v[196:199], v[84:87]
  s_add_u32 m0, s47, 0
  s_nop 0
  buffer_load_dwordx4 v10, s[8:11], s46 offen lds
  ds_read_b128 v[168:171], v18 offset:4096
  s_waitcnt lgkmcnt(8)
  v_mfma_f32_16x16x32_bf16 v[88:91], a[156:159], v[200:203], v[88:91]
  v_mfma_f32_16x16x32_bf16 v[92:95], a[160:163], v[200:203], v[92:95]
  v_mfma_f32_16x16x32_bf16 v[96:99], a[164:167], v[200:203], v[96:99]
  ds_read_b128 v[172:175], v18 offset:6144
  s_waitcnt lgkmcnt(8)
  v_mfma_f32_16x16x32_bf16 v[100:103], a[156:159], v[204:207], v[100:103]
  v_mfma_f32_16x16x32_bf16 v[104:107], a[160:163], v[204:207], v[104:107]
  v_mfma_f32_16x16x32_bf16 v[108:111], a[164:167], v[204:207], v[108:111]
  ds_read_b128 v[176:179], v18 offset:8192
  s_waitcnt lgkmcnt(8)
  v_mfma_f32_16x16x32_bf16 v[112:115], a[156:159], v[208:211], v[112:115]
  v_mfma_f32_16x16x32_bf16 v[116:119], a[160:163], v[208:211], v[116:119]
  v_mfma_f32_16x16x32_bf16 v[120:123], a[164:167], v[208:211], v[120:123]
  ds_read_b128 v[180:183], v18 offset:10240
  s_waitcnt lgkmcnt(8)
  v_mfma_f32_16x16x32_bf16 v[124:127], a[156:159], v[212:215], v[124:127]
  v_mfma_f32_16x16x32_bf16 v[128:131], a[160:163], v[212:215], v[128:131]
  v_mfma_f32_16x16x32_bf16 v[132:135], a[164:167], v[212:215], v[132:135]
  s_add_u32 s46, s46, 10240
  s_add_u32 m0, s47, 1024
  s_nop 0
  buffer_load_dwordx4 v10, s[8:11], s46 offen lds
  ds_read_b128 v[184:187], v18 offset:12288
  s_waitcnt lgkmcnt(8)
  v_mfma_f32_16x16x32_bf16 v[136:139], a[156:159], v[216:219], v[136:139]
  v_mfma_f32_16x16x32_bf16 v[140:143], a[160:163], v[216:219], v[140:143]
  v_mfma_f32_16x16x32_bf16 v[144:147], a[164:167], v[216:219], v[144:147]
  ds_read_b128 v[188:191], v18 offset:14336
  s_waitcnt lgkmcnt(8)
  v_mfma_f32_16x16x32_bf16 v[148:151], a[156:159], v[220:223], v[148:151]
  v_mfma_f32_16x16x32_bf16 v[152:155], a[160:163], v[220:223], v[152:155]
  v_mfma_f32_16x16x32_bf16 v[156:159], a[164:167], v[220:223], v[156:159]
  ds_read_b128 v[192:195], v19 offset:0
  s_waitcnt lgkmcnt(8)
  v_mfma_f32_16x16x32_bf16 v[64:67], a[168:171], v[160:163], v[64:67]
  v_mfma_f32_16x16x32_bf16 v[68:71], a[172:175], v[160:163], v[68:71]
  v_mfma_f32_16x16x32_bf16 v[72:75], a[176:179], v[160:163], v[72:75]
  ds_read_b128 v[196:199], v19 offset:2048
  s_waitcnt lgkmcnt(8)
  v_mfma_f32_16x16x32_bf16 v[76:79], a[168:171], v[164:167], v[76:79]
  v_mfma_f32_16x16x32_bf16 v[80:83], a[172:175], v[164:167], v[80:83]
  v_mfma_f32_16x16x32_bf16 v[84:87], a[176:179], v[164:167], v[84:87]
  s_add_u32 s46, s46, 10240
  s_add_u32 m0, s47, 2048
  s_nop 0
  buffer_load_dwordx4 v10, s[8:11], s46 offen lds
  ds_read_b128 v[200:203], v19 offset:4096
  s_waitcnt lgkmcnt(8)
  v_mfma_f32_16x16x32_bf16 v[88:91], a[168:171], v[168:171], v[88:91]
  v_mfma_f32_16x16x32_bf16 v[92:95], a[172:175], v[168:171], v[92:95]
  v_mfma_f32_16x16x32_bf16 v[96:99], a[176:179], v[168:171], v[96:99]
  ds_read_b128 v[204:207], v19 offset:6144
  s_waitcnt lgkmcnt(8)
  v_mfma_f32_16x16x32_bf16 v[100:103], a[168:171], v[172:175], v[100:103]
  v_mfma_f32_16x16x32_bf16 v[104:107], a[172:175], v[172:175], v[104:107]
  v_mfma_f32_16x16x32_bf16 v[108:111], a[176:179], v[172:175], v[108:111]
  ds_read_b128 v[208:211], v19 offset:8192
  s_waitcnt lgkmcnt(8)
  v_mfma_f32_16x16x32_bf16 v[112:115], a[168:171], v[176:179], v[112:115]
  v_mfma_f32_16x16x32_bf16 v[116:119], a[172:175], v[176:179], v[116:119]
  v_mfma_f32_16x16x32_bf16 v[120:123], a[176:179], v[176:179], v[120:123]
  ds_read_b128 v[212:215], v19 offset:10240
  s_waitcnt lgkmcnt(8)
  v_mfma_f32_16x16x32_bf16 v[124:127], a[168:171], v[180:183], v[124:127]
  v_mfma_f32_16x16x32_bf16 v[128:131], a[172:175], v[180:183], v[128:131]
  v_mfma_f32_16x16x32_bf16 v[132:135], a[176:179], v[180:183], v[132:135]
  s_add_u32 s46, s46, 10240
  s_add_u32 m0, s47, 3072
  s_nop 0
  buffer_load_dwordx4 v10, s[8:11], s46 offen lds
  ds_read_b128 v[216:219], v19 offset:12288
  s_waitcnt lgkmcnt(8)
  v_mfma_f32_16x16x32_bf16 v[136:139], a[168:171], v[184:187], v[136:139]
  v_mfma_f32_16x16x32_bf16 v[140:143], a[172:175], v[184:187], v[140:143]
  v_mfma_f32_16x16x32_bf16 v[144:147], a[176:179], v[184:187], v[144:147]
  ds_read_b128 v[220:223], v19 offset:14336
  s_waitcnt lgkmcnt(8)
  v_mfma_f32_16x16x32_bf16 v[148:151], a[168:171], v[188:191], v[148:151]
  v_mfma_f32_16x16x32_bf16 v[152:155], a[172:175], v[188:191], v[152:155]
  v_mfma_f32_16x16x32_bf16 v[156:159], a[176:179], v[188:191], v[156:159]
  s_waitcnt vmcnt(12)
  s_barrier
  s_add_u32 s30, s30, 128
  s_add_u32 s31, s31, 1
  s_cmp_lt_u32 s31, 10
  s_cbranch_scc1 kv_229
  s_mov_b32 s31, 0
  s_add_u32 s30, s30, s25
  s_sub_u32 s30, s30, 1280
kv_229:
  s_add_u32 s32, s32, 16384
  s_cmp_lt_u32 s32, 98304
  s_cselect_b32 s32, s32, 0
  s_mul_i32 s46, s20, 40960
  s_add_u32 s46, s46, s30
  s_lshl_b32 s47, s20, 12
  s_add_u32 s47, s47, s32
  v_add_u32 v18, s33, v14
  v_add_u32 v19, s33, v15
  s_add_u32 s33, s33, 16384
  s_cmp_lt_u32 s33, 98304
  s_cselect_b32 s33, s33, 0
  ds_read_b128 v[160:163], v18 offset:0
  s_waitcnt lgkmcnt(8)
  v_mfma_f32_16x16x32_bf16 v[64:67], a[180:183], v[192:195], v[64:67]
  v_mfma_f32_16x16x32_bf16 v[68:71], a[184:187], v[192:195], v[68:71]
  v_mfma_f32_16x16x32_bf16 v[72:75], a[188:191], v[192:195], v[72:75]
  ds_read_b128 v[164:167], v18 offset:2048
  s_waitcnt lgkmcnt(8)
  v_mfma_f32_16x16x32_bf16 v[76:79], a[180:183], v[196:199], v[76:79]
  v_mfma_f32_16x16x32_bf16 v[80:83], a[184:187], v[196:199], v[80:83]
  v_mfma_f32_16x16x32_bf16 v[84:87], a[188:191], v[196:199], v[84:87]
  s_add_u32 m0, s47, 0
  s_nop 0
  buffer_load_dwordx4 v10, s[8:11], s46 offen lds
  ds_read_b128 v[168:171], v18 offset:4096
  s_waitcnt lgkmcnt(8)
  v_mfma_f32_16x16x32_bf16 v[88:91], a[180:183], v[200:203], v[88:91]
  v_mfma_f32_16x16x32_bf16 v[92:95], a[184:187], v[200:203], v[92:95]
  v_mfma_f32_16x16x32_bf16 v[96:99], a[188:191], v[200:203], v[96:99]
  ds_read_b128 v[172:175], v18 offset:6144
  s_waitcnt lgkmcnt(8)
  v_mfma_f32_16x16x32_bf16 v[100:103], a[180:183], v[204:207], v[100:103]
  v_mfma_f32_16x16x32_bf16 v[104:107], a[184:187], v[204:207], v[104:107]
  v_mfma_f32_16x16x32_bf16 v[108:111], a[188:191], v[204:207], v[108:111]
  ds_read_b128 v[176:179], v18 offset:8192
  s_waitcnt lgkmcnt(8)
  v_mfma_f32_16x16x32_bf16 v[112:115], a[180:183], v[208:211], v[112:115]
  v_mfma_f32_16x16x32_bf16 v[116:119], a[184:187], v[208:211], v[116:119]
  v_mfma_f32_16x16x32_bf16 v[120:123], a[188:191], v[208:211], v[120:123]
  ds_read_b128 v[180:183], v18 offset:10240
  s_waitcnt lgkmcnt(8)
  v_mfma_f32_16x16x32_bf16 v[124:127], a[180:183], v[212:215], v[124:127]
  v_mfma_f32_16x16x32_bf16 v[128:131], a[184:187], v[212:215], v[128:131]
  v_mfma_f32_16x16x32_bf16 v[132:135], a[188:191], v[212:215], v[132:135]
  s_add_u32 s46, s46, 10240
  s_add_u32 m0, s47, 1024
  s_nop 0
  buffer_load_dwordx4 v10, s[8:11], s46 offen lds
  ds_read_b128 v[184:187], v18 offset:12288
  s_waitcnt lgkmcnt(8)
  v_mfma_f32_16x16x32_bf16 v[136:139], a[180:183], v[216:219], v[136:139]
  v_mfma_f32_16x16x32_bf16 v[140:143], a[184:187], v[216:219], v[140:143]
  v_mfma_f32_16x16x32_bf16 v[144:147], a[188:191], v[216:219], v[144:147]
  ds_read_b128 v[188:191], v18 offset:14336
  s_waitcnt lgkmcnt(8)
  v_mfma_f32_16x16x32_bf16 v[148:151], a[180:183], v[220:223], v[148:151]
  v_mfma_f32_16x16x32_bf16 v[152:155], a[184:187], v[220:223], v[152:155]
  v_mfma_f32_16x16x32_bf16 v[156:159], a[188:191], v[220:223], v[156:159]
  ds_read_b128 v[192:195], v19 offset:0
  s_waitcnt lgkmcnt(8)
  v_mfma_f32_16x16x32_bf16 v[64:67], a[192:195], v[160:163], v[64:67]
  v_mfma_f32_16x16x32_bf16 v[68:71], a[196:199], v[160:163], v[68:71]
  v_mfma_f32_16x16x32_bf16 v[72:75], a[200:203], v[160:163], v[72:75]
  ds_read_b128 v[196:199], v19 offset:2048
  s_waitcnt lgkmcnt(8)
  v_mfma_f32_16x16x32_bf16 v[76:79], a[192:195], v[164:167], v[76:79]
  v_mfma_f32_16x16x32_bf16 v[80:83], a[196:199], v[164:167], v[80:83]
  v_mfma_f32_16x16x32_bf16 v[84:87], a[200:203], v[164:167], v[84:87]
  s_add_u32 s46, s46, 10240
  s_add_u32 m0, s47, 2048
  s_nop 0
  buffer_load_dwordx4 v10, s[8:11], s46 offen lds
  ds_read_b128 v[200:203], v19 offset:4096
  s_waitcnt lgkmcnt(8)
  v_mfma_f32_16x16x32_bf16 v[88:91], a[192:195], v[168:171], v[88:91]
  v_mfma_f32_16x16x32_bf16 v[92:95], a[196:199], v[168:171], v[92:95]
  v_mfma_f32_16x16x32_bf16 v[96:99], a[200:203], v[168:171], v[96:99]
  ds_read_b128 v[204:207], v19 offset:6144
  s_waitcnt lgkmcnt(8)
  v_mfma_f32_16x16x32_bf16 v[100:103], a[192:195], v[172:175], v[100:103]
  v_mfma_f32_16x16x32_bf16 v[104:107], a[196:199], v[172:175], v[104:107]
  v_mfma_f32_16x16x32_bf16 v[108:111], a[200:203], v[172:175], v[108:111]
  ds_read_b128 v[208:211], v19 offset:8192
  s_waitcnt lgkmcnt(8)
  v_mfma_f32_16x16x32_bf16 v[112:115], a[192:195], v[176:179], v[112:115]
  v_mfma_f32_16x16x32_bf16 v[116:119], a[196:199], v[176:179], v[116:119]
  v_mfma_f32_16x16x32_bf16 v[120:123], a[200:203], v[176:179], v[120:123]
  ds_read_b128 v[212:215], v19 offset:10240
  s_waitcnt lgkmcnt(8)
  v_mfma_f32_16x16x32_bf16 v[124:127], a[192:195], v[180:183], v[124:127]
  v_mfma_f32_16x16x32_bf16 v[128:131], a[196:199], v[180:183], v[128:131]
  v_mfma_f32_16x16x32_bf16 v[132:135], a[200:203], v[180:183], v[132:135]
  s_add_u32 s46, s46, 10240
  s_add_u32 m0, s47, 3072
  s_nop 0
  buffer_load_dwordx4 v10, s[8:11], s46 offen lds
  ds_read_b128 v[216:219], v19 offset:12288
  s_waitcnt lgkmcnt(8)
  v_mfma_f32_16x16x32_bf16 v[136:139], a[192:195], v[184:187], v[136:139]
  v_mfma_f32_16x16x32_bf16 v[140:143], a[196:199], v[184:187], v[140:143]
  v_mfma_f32_16x16x32_bf16 v[144:147], a[200:203], v[184:187], v[144:147]
  ds_read_b128 v[220:223], v19 offset:14336
  s_waitcnt lgkmcnt(8)
  v_mfma_f32_16x16x32_bf16 v[148:151], a[192:195], v[188:191], v[148:151]
  v_mfma_f32_16x16x32_bf16 v[152:155], a[196:199], v[188:191], v[152:155]
  v_mfma_f32_16x16x32_bf16 v[156:159], a[200:203], v[188:191], v[156:159]
  s_waitcnt vmcnt(12)
  s_barrier
  s_add_u32 s30, s30, 128
  s_add_u32 s31, s31, 1
  s_cmp_lt_u32 s31, 10
  s_cbranch_scc1 kv_230
  s_mov_b32 s31, 0
  s_add_u32 s30, s30, s25
  s_sub_u32 s30, s30, 1280
kv_230:
  s_add_u32 s32, s32, 16384
  s_cmp_lt_u32 s32, 98304
  s_cselect_b32 s32, s32, 0
  s_mul_i32 s46, s20, 40960
  s_add_u32 s46, s46, s30
  s_lshl_b32 s47, s20, 12
  s_add_u32 s47, s47, s32
  v_add_u32 v18, s33, v14
  v_add_u32 v19, s33, v15
  s_add_u32 s33, s33, 16384
  s_cmp_lt_u32 s33, 98304
  s_cselect_b32 s33, s33, 0
  ds_read_b128 v[160:163], v18 offset:0
  s_waitcnt lgkmcnt(8)
  v_mfma_f32_16x16x32_bf16 v[64:67], a[204:207], v[192:195], v[64:67]
  v_mfma_f32_16x16x32_bf16 v[68:71], a[208:211], v[192:195], v[68:71]
  v_mfma_f32_16x16x32_bf16 v[72:75], a[212:215], v[192:195], v[72:75]
  ds_read_b128 v[164:167], v18 offset:2048
  s_waitcnt lgkmcnt(8)
  v_mfma_f32_16x16x32_bf16 v[76:79], a[204:207], v[196:199], v[76:79]
  v_mfma_f32_16x16x32_bf16 v[80:83], a[208:211], v[196:199], v[80:83]
  v_mfma_f32_16x16x32_bf16 v[84:87], a[212:215], v[196:199], v[84:87]
  s_add_u32 m0, s47, 0
  s_nop 0
  buffer_load_dwordx4 v10, s[8:11], s46 offen lds
  ds_read_b128 v[168:171], v18 offset:4096
  s_waitcnt lgkmcnt(8)
  v_mfma_f32_16x16x32_bf16 v[88:91], a[204:207], v[200:203], v[88:91]
  v_mfma_f32_16x16x32_bf16 v[92:95], a[208:211], v[200:203], v[92:95]
  v_mfma_f32_16x16x32_bf16 v[96:99], a[212:215], v[200:203], v[96:99]
  ds_read_b128 v[172:175], v18 offset:6144
  s_waitcnt lgkmcnt(8)
  v_mfma_f32_16x16x32_bf16 v[100:103], a[204:207], v[204:207], v[100:103]
  v_mfma_f32_16x16x32_bf16 v[104:107], a[208:211], v[204:207], v[104:107]
  v_mfma_f32_16x16x32_bf16 v[108:111], a[212:215], v[204:207], v[108:111]
  ds_read_b128 v[176:179], v18 offset:8192
  s_waitcnt lgkmcnt(8)
  v_mfma_f32_16x16x32_bf16 v[112:115], a[204:207], v[208:211], v[112:115]
  v_mfma_f32_16x16x32_bf16 v[116:119], a[208:211], v[208:211], v[116:119]
  v_mfma_f32_16x16x32_bf16 v[120:123], a[212:215], v[208:211], v[120:123]
  ds_read_b128 v[180:183], v18 offset:10240
  s_waitcnt lgkmcnt(8)
  v_mfma_f32_16x16x32_bf16 v[124:127], a[204:207], v[212:215], v[124:127]
  v_mfma_f32_16x16x32_bf16 v[128:131], a[208:211], v[212:215], v[128:131]
  v_mfma_f32_16x16x32_bf16 v[132:135], a[212:215], v[212:215], v[132:135]
  s_add_u32 s46, s46, 10240
  s_add_u32 m0, s47, 1024
  s_nop 0
  buffer_load_dwordx4 v10, s[8:11], s46 offen lds
  ds_read_b128 v[184:187], v18 offset:12288
  s_waitcnt lgkmcnt(8)
  v_mfma_f32_16x16x32_bf16 v[136:139], a[204:207], v[216:219], v[136:139]
  v_mfma_f32_16x16x32_bf16 v[140:143], a[208:211], v[216:219], v[140:143]
  v_mfma_f32_16x16x32_bf16 v[144:147], a[212:215], v[216:219], v[144:147]
  ds_read_b128 v[188:191], v18 offset:14336
  s_waitcnt lgkmcnt(8)
  v_mfma_f32_16x16x32_bf16 v[148:151], a[204:207], v[220:223], v[148:151]
  v_mfma_f32_16x16x32_bf16 v[152:155], a[208:211], v[220:223], v[152:155]
  v_mfma_f32_16x16x32_bf16 v[156:159], a[212:215], v[220:223], v[156:159]
  ds_read_b128 v[192:195], v19 offset:0
  s_waitcnt lgkmcnt(8)
  v_mfma_f32_16x16x32_bf16 v[64:67], a[216:219], v[160:163], v[64:67]
  v_mfma_f32_16x16x32_bf16 v[68:71], a[220:223], v[160:163], v[68:71]
  v_mfma_f32_16x16x32_bf16 v[72:75], a[224:227], v[160:163], v[72:75]
  ds_read_b128 v[196:199], v19 offset:2048
  s_waitcnt lgkmcnt(8)
  v_mfma_f32_16x16x32_bf16 v[76:79], a[216:219], v[164:167], v[76:79]
  v_mfma_f32_16x16x32_bf16 v[80:83], a[220:223], v[164:167], v[80:83]
  v_mfma_f32_16x16x32_bf16 v[84:87], a[224:227], v[164:167], v[84:87]
  s_add_u32 s46, s46, 10240
  s_add_u32 m0, s47, 2048
  s_nop 0
  buffer_load_dwordx4 v10, s[8:11], s46 offen lds
  ds_read_b128 v[200:203], v19 offset:4096
  s_waitcnt lgkmcnt(8)
  v_mfma_f32_16x16x32_bf16 v[88:91], a[216:219], v[168:171], v[88:91]
  v_mfma_f32_16x16x32_bf16 v[92:95], a[220:223], v[168:171], v[92:95]
  v_mfma_f32_16x16x32_bf16 v[96:99], a[224:227], v[168:171], v[96:99]
  ds_read_b128 v[204:207], v19 offset:6144
  s_waitcnt lgkmcnt(8)
  v_mfma_f32_16x16x32_bf16 v[100:103], a[216:219], v[172:175], v[100:103]
  v_mfma_f32_16x16x32_bf16 v[104:107], a[220:223], v[172:175], v[104:107]
  v_mfma_f32_16x16x32_bf16 v[108:111], a[224:227], v[172:175], v[108:111]
  ds_read_b128 v[208:211], v19 offset:8192
  s_waitcnt lgkmcnt(8)
  v_mfma_f32_16x16x32_bf16 v[112:115], a[216:219], v[176:179], v[112:115]
  v_mfma_f32_16x16x32_bf16 v[116:119], a[220:223], v[176:179], v[116:119]
  v_mfma_f32_16x16x32_bf16 v[120:123], a[224:227], v[176:179], v[120:123]
  ds_read_b128 v[212:215], v19 offset:10240
  s_waitcnt lgkmcnt(8)
  v_mfma_f32_16x16x32_bf16 v[124:127], a[216:219], v[180:183], v[124:127]
  v_mfma_f32_16x16x32_bf16 v[128:131], a[220:223], v[180:183], v[128:131]
  v_mfma_f32_16x16x32_bf16 v[132:135], a[224:227], v[180:183], v[132:135]
  s_add_u32 s46, s46, 10240
  s_add_u32 m0, s47, 3072
  s_nop 0
  buffer_load_dwordx4 v10, s[8:11], s46 offen lds
  ds_read_b128 v[216:219], v19 offset:12288
  s_waitcnt lgkmcnt(8)
  v_mfma_f32_16x16x32_bf16 v[136:139], a[216:219], v[184:187], v[136:139]
  v_mfma_f32_16x16x32_bf16 v[140:143], a[220:223], v[184:187], v[140:143]
  v_mfma_f32_16x16x32_bf16 v[144:147], a[224:227], v[184:187], v[144:147]
  ds_read_b128 v[220:223], v19 offset:14336
  s_waitcnt lgkmcnt(8)
  v_mfma_f32_16x16x32_bf16 v[148:151], a[216:219], v[188:191], v[148:151]
  v_mfma_f32_16x16x32_bf16 v[152:155], a[220:223], v[188:191], v[152:155]
  v_mfma_f32_16x16x32_bf16 v[156:159], a[224:227], v[188:191], v[156:159]
  s_waitcnt vmcnt(12)
  s_barrier
  s_add_u32 s30, s30, 128
  s_add_u32 s31, s31, 1
  s_cmp_lt_u32 s31, 10
  s_cbranch_scc1 kv_231
  s_mov_b32 s31, 0
  s_add_u32 s30, s30, s25
  s_sub_u32 s30, s30, 1280
kv_231:
  s_add_u32 s32, s32, 16384
  s_cmp_lt_u32 s32, 98304
  s_cselect_b32 s32, s32, 0
  s_mul_i32 s46, s20, 40960
  s_add_u32 s46, s46, s30
  s_lshl_b32 s47, s20, 12
  s_add_u32 s47, s47, s32
  v_add_u32 v18, s33, v14
  v_add_u32 v19, s33, v15
  s_add_u32 s33, s33, 16384
  s_cmp_lt_u32 s33, 98304
  s_cselect_b32 s33, s33, 0
  ds_read_b128 v[160:163], v18 offset:0
  s_waitcnt lgkmcnt(8)
  v_mfma_f32_16x16x32_bf16 v[64:67], a[228:231], v[192:195], v[64:67]
  v_mfma_f32_16x16x32_bf16 v[68:71], a[232:235], v[192:195], v[68:71]
  v_mfma_f32_16x16x32_bf16 v[72:75], a[236:239], v[192:195], v[72:75]
  ds_read_b128 v[164:167], v18 offset:2048
  s_waitcnt lgkmcnt(8)
  v_mfma_f32_16x16x32_bf16 v[76:79], a[228:231], v[196:199], v[76:79]
  v_mfma_f32_16x16x32_bf16 v[80:83], a[232:235], v[196:199], v[80:83]
  v_mfma_f32_16x16x32_bf16 v[84:87], a[236:239], v[196:199], v[84:87]
  s_add_u32 m0, s47, 0
  s_nop 0
  buffer_load_dwordx4 v10, s[8:11], s46 offen lds
  ds_read_b128 v[168:171], v18 offset:4096
  s_waitcnt lgkmcnt(8)
  v_mfma_f32_16x16x32_bf16 v[88:91], a[228:231], v[200:203], v[88:91]
  v_mfma_f32_16x16x32_bf16 v[92:95], a[232:235], v[200:203], v[92:95]
  v_mfma_f32_16x16x32_bf16 v[96:99], a[236:239], v[200:203], v[96:99]
  ds_read_b128 v[172:175], v18 offset:6144
  s_waitcnt lgkmcnt(8)
  v_mfma_f32_16x16x32_bf16 v[100:103], a[228:231], v[204:207], v[100:103]
  v_mfma_f32_16x16x32_bf16 v[104:107], a[232:235], v[204:207], v[104:107]
  v_mfma_f32_16x16x32_bf16 v[108:111], a[236:239], v[204:207], v[108:111]
  v_cvt_pk_bf16_f32 v224, v64, v65
  v_cvt_pk_bf16_f32 v225, v66, v67
  v_cvt_pk_bf16_f32 v226, v68, v69
  v_cvt_pk_bf16_f32 v227, v70, v71
  v_cvt_pk_bf16_f32 v228, v72, v73
  v_cvt_pk_bf16_f32 v229, v74, v75
  ds_write_b64 v22, v[224:225] offset:0
  ds_write_b64 v22, v[226:227] offset:8
  ds_write_b64 v22, v[228:229] offset:16
  ds_read_b128 v[176:179], v18 offset:8192
  s_waitcnt lgkmcnt(8)
  v_mfma_f32_16x16x32_bf16 v[112:115], a[228:231], v[208:211], v[112:115]
  v_mfma_f32_16x16x32_bf16 v[116:119], a[232:235], v[208:211], v[116:119]
  v_mfma_f32_16x16x32_bf16 v[120:123], a[236:239], v[208:211], v[120:123]
  v_cvt_pk_bf16_f32 v230, v76, v77
  v_cvt_pk_bf16_f32 v231, v78, v79
  v_cvt_pk_bf16_f32 v232, v80, v81
  v_cvt_pk_bf16_f32 v233, v82, v83
  v_cvt_pk_bf16_f32 v234, v84, v85
  v_cvt_pk_bf16_f32 v235, v86, v87
  ds_write_b64 v22, v[230:231] offset:6400
  ds_write_b64 v22, v[232:233] offset:6408
  ds_write_b64 v22, v[234:235] offset:6416
  ds_read_b128 v[180:183], v18 offset:10240
  s_waitcnt lgkmcnt(8)
  v_mfma_f32_16x16x32_bf16 v[124:127], a[228:231], v[212:215], v[124:127]
  v_mfma_f32_16x16x32_bf16 v[128:131], a[232:235], v[212:215], v[128:131]
  v_mfma_f32_16x16x32_bf16 v[132:135], a[236:239], v[212:215], v[132:135]
  s_add_u32 s46, s46, 10240
  s_add_u32 m0, s47, 1024
  s_nop 0
  buffer_load_dwordx4 v10, s[8:11], s46 offen lds
  v_cvt_pk_bf16_f32 v224, v88, v89
  v_cvt_pk_bf16_f32 v225, v90, v91
  v_cvt_pk_bf16_f32 v226, v92, v93
  v_cvt_pk_bf16_f32 v227, v94, v95
  v_cvt_pk_bf16_f32 v228, v96, v97
  v_cvt_pk_bf16_f32 v229, v98, v99
  ds_write_b64 v22, v[224:225] offset:12800
  ds_write_b64 v22, v[226:227] offset:12808
  ds_write_b64 v22, v[228:229] offset:12816
  ds_read_b128 v[184:187], v18 offset:12288
  s_waitcnt lgkmcnt(8)
  v_mfma_f32_16x16x32_bf16 v[136:139], a[228:231], v[216:219], v[136:139]
  v_mfma_f32_16x16x32_bf16 v[140:143], a[232:235], v[216:219], v[140:143]
  v_mfma_f32_16x16x32_bf16 v[144:147], a[236:239], v[216:219], v[144:147]
  v_cvt_pk_bf16_f32 v230, v100, v101
  v_cvt_pk_bf16_f32 v231, v102, v103
  v_cvt_pk_bf16_f32 v232, v104, v105
  v_cvt_pk_bf16_f32 v233, v106, v107
  v_cvt_pk_bf16_f32 v234, v108, v109
  v_cvt_pk_bf16_f32 v235, v110, v111
  ds_write_b64 v22, v[230:231] offset:19200
  ds_write_b64 v22, v[232:233] offset:19208
  ds_write_b64 v22, v[234:235] offset:19216
  ds_read_b128 v[188:191], v18 offset:14336
  s_waitcnt lgkmcnt(8)
  v_mfma_f32_16x16x32_bf16 v[148:151], a[228:231], v[220:223], v[148:151]
  v_mfma_f32_16x16x32_bf16 v[152:155], a[232:235], v[220:223], v[152:155]
  v_mfma_f32_16x16x32_bf16 v[156:159], a[236:239], v[220:223], v[156:159]
  v_cvt_pk_bf16_f32 v224, v112, v113
  v_cvt_pk_bf16_f32 v225, v114, v115
  v_cvt_pk_bf16_f32 v226, v116, v117
  v_cvt_pk_bf16_f32 v227, v118, v119
  v_cvt_pk_bf16_f32 v228, v120, v121
  v_cvt_pk_bf16_f32 v229, v122, v123
  ds_write_b64 v22, v[224:225] offset:25600
  ds_write_b64 v22, v[226:227] offset:25608
  ds_write_b64 v22, v[228:229] offset:25616
  v_cvt_pk_bf16_f32 v230, v124, v125
  v_cvt_pk_bf16_f32 v231, v126, v127
  v_cvt_pk_bf16_f32 v232, v128, v129
  v_cvt_pk_bf16_f32 v233, v130, v131
  v_cvt_pk_bf16_f32 v234, v132, v133
  v_cvt_pk_bf16_f32 v235, v134, v135
  ds_write_b64 v22, v[230:231] offset:32000
  ds_write_b64 v22, v[232:233] offset:32008
  ds_write_b64 v22, v[234:235] offset:32016
  v_cvt_pk_bf16_f32 v224, v136, v137
  v_cvt_pk_bf16_f32 v225, v138, v139
  v_cvt_pk_bf16_f32 v226, v140, v141
  v_cvt_pk_bf16_f32 v227, v142, v143
  v_cvt_pk_bf16_f32 v228, v144, v145
  v_cvt_pk_bf16_f32 v229, v146, v147
  ds_write_b64 v22, v[224:225] offset:38400
  ds_write_b64 v22, v[226:227] offset:38408
  ds_write_b64 v22, v[228:229] offset:38416
  v_cvt_pk_bf16_f32 v230, v148, v149
  v_cvt_pk_bf16_f32 v231, v150, v151
  v_cvt_pk_bf16_f32 v232, v152, v153
  v_cvt_pk_bf16_f32 v233, v154, v155
  v_cvt_pk_bf16_f32 v234, v156, v157
  v_cvt_pk_bf16_f32 v235, v158, v159
  ds_write_b64 v22, v[230:231] offset:44800
  ds_write_b64 v22, v[232:233] offset:44808
  ds_write_b64 v22, v[234:235] offset:44816
  s_mov_b32 s61, s60
  s_add_u32 s60, s60, 1024
  s_mul_i32 s48, s20, 393216
  s_add_u32 s48, s48, s27
  s_add_u32 s27, s27, s28
  s_sub_u32 s26, s26, 1
  s_cmp_gt_u32 s26, 0
  s_cbranch_scc1 kv_blk_219
  s_waitcnt vmcnt(0) lgkmcnt(0)
  s_barrier
  ds_read_b128 v[224:227], v23 offset:0
  ds_read_b128 v[228:231], v23 offset:64
  ds_read_b128 v[232:235], v23 offset:128
  ds_read_b128 v[236:239], v23 offset:192
  ds_read_b128 v[240:243], v23 offset:256
  ds_read_b128 v[244:247], v23 offset:320
  s_waitcnt lgkmcnt(0)
  s_add_u32 s21, s48, 0
  buffer_store_dwordx4 v[224:227], v26, s[16:19], s21 offen offset:0 sc1
  s_add_u32 s21, s48, 0
  buffer_store_dwordx4 v[228:231], v26, s[16:19], s21 offen offset:1024 sc1
  s_add_u32 s21, s48, 0
  buffer_store_dwordx4 v[232:235], v26, s[16:19], s21 offen offset:2048 sc1
  s_add_u32 s21, s48, 0
  buffer_store_dwordx4 v[236:239], v26, s[16:19], s21 offen offset:3072 sc1
  s_add_u32 s21, s48, 4096
  buffer_store_dwordx4 v[240:243], v26, s[16:19], s21 offen offset:0 sc1
  s_add_u32 s21, s48, 4096
  buffer_store_dwordx4 v[244:247], v26, s[16:19], s21 offen offset:1024 sc1
  s_nop 1
  ds_read_b128 v[224:227], v23 offset:6400
  ds_read_b128 v[228:231], v23 offset:6464
  ds_read_b128 v[232:235], v23 offset:6528
  ds_read_b128 v[236:239], v23 offset:6592
  ds_read_b128 v[240:243], v23 offset:6656
  ds_read_b128 v[244:247], v23 offset:6720
  s_waitcnt lgkmcnt(0)
  s_add_u32 s21, s48, 4096
  buffer_store_dwordx4 v[224:227], v26, s[16:19], s21 offen offset:2048 sc1
  s_add_u32 s21, s48, 4096
  buffer_store_dwordx4 v[228:231], v26, s[16:19], s21 offen offset:3072 sc1
  s_add_u32 s21, s48, 8192
  buffer_store_dwordx4 v[232:235], v26, s[16:19], s21 offen offset:0 sc1
  s_add_u32 s21, s48, 8192
  buffer_store_dwordx4 v[236:239], v26, s[16:19], s21 offen offset:1024 sc1
  s_add_u32 s21, s48, 8192
  buffer_store_dwordx4 v[240:243], v26, s[16:19], s21 offen offset:2048 sc1
  s_add_u32 s21, s48, 8192
  buffer_store_dwordx4 v[244:247], v26, s[16:19], s21 offen offset:3072 sc1
  s_nop 1
  s_waitcnt vmcnt(0)
  s_barrier
  s_cmp_lg_u32 s20, 0
  s_cbranch_scc1 af_232
  v_mov_b32 v4, 0
  v_mov_b32 v5, 1
  s_mov_b64 exec, 1
  buffer_atomic_add v5, v4, s[72:75], s61 offen sc1
  s_mov_b64 exec, -1
  s_nop 1
af_232:
  s_branch queue
not_kv:
  s_cmp_ge_u32 s3, 96
  s_cbranch_scc1 not_vw
  s_sub_u32 s2, s3, 64
  s_load_dwordx2 s[6:7], s[0:1], 40
  s_load_dwordx2 s[38:39], s[0:1], 104
  s_waitcnt lgkmcnt(0)
  s_mov_b32 s12, s6
  s_mov_b32 s13, s7
  s_mov_b32 s14, 7864320
  s_mov_b32 s15, 0x00020000
  s_mov_b32 s16, s38
  s_mov_b32 s17, s39
  s_mov_b32 s18, 50331648
  s_mov_b32 s19, 0x00020000
  s_add_u32 s24, s38, 114294784
  s_addc_u32 s25, s39, 0
  s_mov_b32 s26, 83886080
  s_mov_b32 s27, 0x00020000
  s_load_dwordx2 s[72:73], s[0:1], 104
  s_waitcnt lgkmcnt(0)
  s_add_u32 s72, s72, 81068032
  s_addc_u32 s73, s73, 0
  s_mov_b32 s74, 115712
  s_mov_b32 s75, 0x00020000
  v_mov_b32 v29, 52429
  s_mul_i32 s21, s20, 960
  s_add_u32 s21, s21, 0
  v_add_u32 v21, s21, v1
  v_mul_u32_u24 v22, v21, v29
  v_lshrrev_b32 v22, 22, v22
  v_mul_u32_u24 v23, 80, v22
  v_sub_u32 v21, v21, v23
  v_mul_u32_u24 v26, 5462, v22
  v_lshrrev_b32 v26, 16, v26
  v_mul_u32_u24 v27, 12, v26
  v_sub_u32 v22, v22, v27
  v_lshrrev_b32 v27, 2, v22
  v_and_b32 v22, 3, v22
  v_lshlrev_b32 v25, 4, v27
  v_lshl_add_u32 v25, v26, 2, v25
  v_add_u32 v25, v25, v22
  v_mul_u32_u24 v25, 1280, v25
  v_lshl_add_u32 v64, v21, 4, v25
  s_mul_i32 s21, s20, 960
  s_add_u32 s21, s21, 64
  v_add_u32 v21, s21, v1
  v_mul_u32_u24 v22, v21, v29
  v_lshrrev_b32 v22, 22, v22
  v_mul_u32_u24 v23, 80, v22
  v_sub_u32 v21, v21, v23
  v_mul_u32_u24 v26, 5462, v22
  v_lshrrev_b32 v26, 16, v26
  v_mul_u32_u24 v27, 12, v26
  v_sub_u32 v22, v22, v27
  v_lshrrev_b32 v27, 2, v22
  v_and_b32 v22, 3, v22
  v_lshlrev_b32 v25, 4, v27
  v_lshl_add_u32 v25, v26, 2, v25
  v_add_u32 v25, v25, v22
  v_mul_u32_u24 v25, 1280, v25
  v_lshl_add_u32 v65, v21, 4, v25
  s_mul_i32 s21, s20, 960
  s_add_u32 s21, s21, 128
  v_add_u32 v21, s21, v1
  v_mul_u32_u24 v22, v21, v29
  v_lshrrev_b32 v22, 22, v22
  v_mul_u32_u24 v23, 80, v22
  v_sub_u32 v21, v21, v23
  v_mul_u32_u24 v26, 5462, v22
  v_lshrrev_b32 v26, 16, v26
  v_mul_u32_u24 v27, 12, v26
  v_sub_u32 v22, v22, v27
  v_lshrrev_b32 v27, 2, v22
  v_and_b32 v22, 3, v22
  v_lshlrev_b32 v25, 4, v27
  v_lshl_add_u32 v25, v26, 2, v25
  v_add_u32 v25, v25, v22
  v_mul_u32_u24 v25, 1280, v25
  v_lshl_add_u32 v66, v21, 4, v25
  s_mul_i32 s21, s20, 960
  s_add_u32 s21, s21, 192
  v_add_u32 v21, s21, v1
  v_mul_u32_u24 v22, v21, v29
  v_lshrrev_b32 v22, 22, v22
  v_mul_u32_u24 v23, 80, v22
  v_sub_u32 v21, v21, v23
  v_mul_u32_u24 v26, 5462, v22
  v_lshrrev_b32 v26, 16, v26
  v_mul_u32_u24 v27, 12, v26
  v_sub_u32 v22, v22, v27
  v_lshrrev_b32 v27, 2, v22
  v_and_b32 v22, 3, v22
  v_lshlrev_b32 v25, 4, v27
  v_lshl_add_u32 v25, v26, 2, v25
  v_add_u32 v25, v25, v22
  v_mul_u32_u24 v25, 1280, v25
  v_lshl_add_u32 v67, v21, 4, v25
  s_mul_i32 s21, s20, 960
  s_add_u32 s21, s21, 256
  v_add_u32 v21, s21, v1
  v_mul_u32_u24 v22, v21, v29
  v_lshrrev_b32 v22, 22, v22
  v_mul_u32_u24 v23, 80, v22
  v_sub_u32 v21, v21, v23
  v_mul_u32_u24 v26, 5462, v22
  v_lshrrev_b32 v26, 16, v26
  v_mul_u32_u24 v27, 12, v26
  v_sub_u32 v22, v22, v27
  v_lshrrev_b32 v27, 2, v22
  v_and_b32 v22, 3, v22
  v_lshlrev_b32 v25, 4, v27
  v_lshl_add_u32 v25, v26, 2, v25
  v_add_u32 v25, v25, v22
  v_mul_u32_u24 v25, 1280, v25
  v_lshl_add_u32 v68, v21, 4, v25
  s_mul_i32 s21, s20, 960
  s_add_u32 s21, s21, 320
  v_add_u32 v21, s21, v1
  v_mul_u32_u24 v22, v21, v29
  v_lshrrev_b32 v22, 22, v22
  v_mul_u32_u24 v23, 80, v22
  v_sub_u32 v21, v21, v23
  v_mul_u32_u24 v26, 5462, v22
  v_lshrrev_b32 v26, 16, v26
  v_mul_u32_u24 v27, 12, v26
  v_sub_u32 v22, v22, v27
  v_lshrrev_b32 v27, 2, v22
  v_and_b32 v22, 3, v22
  v_lshlrev_b32 v25, 4, v27
  v_lshl_add_u32 v25, v26, 2, v25
  v_add_u32 v25, v25, v22
  v_mul_u32_u24 v25, 1280, v25
  v_lshl_add_u32 v69, v21, 4, v25
  s_mul_i32 s21, s20, 960
  s_add_u32 s21, s21, 384
  v_add_u32 v21, s21, v1
  v_mul_u32_u24 v22, v21, v29
  v_lshrrev_b32 v22, 22, v22
  v_mul_u32_u24 v23, 80, v22
  v_sub_u32 v21, v21, v23
  v_mul_u32_u24 v26, 5462, v22
  v_lshrrev_b32 v26, 16, v26
  v_mul_u32_u24 v27, 12, v26
  v_sub_u32 v22, v22, v27
  v_lshrrev_b32 v27, 2, v22
  v_and_b32 v22, 3, v22
  v_lshlrev_b32 v25, 4, v27
  v_lshl_add_u32 v25, v26, 2, v25
  v_add_u32 v25, v25, v22
  v_mul_u32_u24 v25, 1280, v25
  v_lshl_add_u32 v70, v21, 4, v25
  s_mul_i32 s21, s20, 960
  s_add_u32 s21, s21, 448
  v_add_u32 v21, s21, v1
  v_mul_u32_u24 v22, v21, v29
  v_lshrrev_b32 v22, 22, v22
  v_mul_u32_u24 v23, 80, v22
  v_sub_u32 v21, v21, v23
  v_mul_u32_u24 v26, 5462, v22
  v_lshrrev_b32 v26, 16, v26
  v_mul_u32_u24 v27, 12, v26
  v_sub_u32 v22, v22, v27
  v_lshrrev_b32 v27, 2, v22
  v_and_b32 v22, 3, v22
  v_lshlrev_b32 v25, 4, v27
  v_lshl_add_u32 v25, v26, 2, v25
  v_add_u32 v25, v25, v22
  v_mul_u32_u24 v25, 1280, v25
  v_lshl_add_u32 v71, v21, 4, v25
  s_mul_i32 s21, s20, 960
  s_add_u32 s21, s21, 512
  v_add_u32 v21, s21, v1
  v_mul_u32_u24 v22, v21, v29
  v_lshrrev_b32 v22, 22, v22
  v_mul_u32_u24 v23, 80, v22
  v_sub_u32 v21, v21, v23
  v_mul_u32_u24 v26, 5462, v22
  v_lshrrev_b32 v26, 16, v26
  v_mul_u32_u24 v27, 12, v26
  v_sub_u32 v22, v22, v27
  v_lshrrev_b32 v27, 2, v22
  v_and_b32 v22, 3, v22
  v_lshlrev_b32 v25, 4, v27
  v_lshl_add_u32 v25, v26, 2, v25
  v_add_u32 v25, v25, v22
  v_mul_u32_u24 v25, 1280, v25
  v_lshl_add_u32 v72, v21, 4, v25
  s_mul_i32 s21, s20, 960
  s_add_u32 s21, s21, 576
  v_add_u32 v21, s21, v1
  v_mul_u32_u24 v22, v21, v29
  v_lshrrev_b32 v22, 22, v22
  v_mul_u32_u24 v23, 80, v22
  v_sub_u32 v21, v21, v23
  v_mul_u32_u24 v26, 5462, v22
  v_lshrrev_b32 v26, 16, v26
  v_mul_u32_u24 v27, 12, v26
  v_sub_u32 v22, v22, v27
  v_lshrrev_b32 v27, 2, v22
  v_and_b32 v22, 3, v22
  v_lshlrev_b32 v25, 4, v27
  v_lshl_add_u32 v25, v26, 2, v25
  v_add_u32 v25, v25, v22
  v_mul_u32_u24 v25, 1280, v25
  v_lshl_add_u32 v73, v21, 4, v25
  s_mul_i32 s21, s20, 960
  s_add_u32 s21, s21, 640
  v_add_u32 v21, s21, v1
  v_mul_u32_u24 v22, v21, v29
  v_lshrrev_b32 v22, 22, v22
  v_mul_u32_u24 v23, 80, v22
  v_sub_u32 v21, v21, v23
  v_mul_u32_u24 v26, 5462, v22
  v_lshrrev_b32 v26, 16, v26
  v_mul_u32_u24 v27, 12, v26
  v_sub_u32 v22, v22, v27
  v_lshrrev_b32 v27, 2, v22
  v_and_b32 v22, 3, v22
  v_lshlrev_b32 v25, 4, v27
  v_lshl_add_u32 v25, v26, 2, v25
  v_add_u32 v25, v25, v22
  v_mul_u32_u24 v25, 1280, v25
  v_lshl_add_u32 v74, v21, 4, v25
  s_mul_i32 s21, s20, 960
  s_add_u32 s21, s21, 704
  v_add_u32 v21, s21, v1
  v_mul_u32_u24 v22, v21, v29
  v_lshrrev_b32 v22, 22, v22
  v_mul_u32_u24 v23, 80, v22
  v_sub_u32 v21, v21, v23
  v_mul_u32_u24 v26, 5462, v22
  v_lshrrev_b32 v26, 16, v26
  v_mul_u32_u24 v27, 12, v26
  v_sub_u32 v22, v22, v27
  v_lshrrev_b32 v27, 2, v22
  v_and_b32 v22, 3, v22
  v_lshlrev_b32 v25, 4, v27
  v_lshl_add_u32 v25, v26, 2, v25
  v_add_u32 v25, v25, v22
  v_mul_u32_u24 v25, 1280, v25
  v_lshl_add_u32 v75, v21, 4, v25
  s_mul_i32 s21, s20, 960
  s_add_u32 s21, s21, 768
  v_add_u32 v21, s21, v1
  v_mul_u32_u24 v22, v21, v29
  v_lshrrev_b32 v22, 22, v22
  v_mul_u32_u24 v23, 80, v22
  v_sub_u32 v21, v21, v23
  v_mul_u32_u24 v26, 5462, v22
  v_lshrrev_b32 v26, 16, v26
  v_mul_u32_u24 v27, 12, v26
  v_sub_u32 v22, v22, v27
  v_lshrrev_b32 v27, 2, v22
  v_and_b32 v22, 3, v22
  v_lshlrev_b32 v25, 4, v27
  v_lshl_add_u32 v25, v26, 2, v25
  v_add_u32 v25, v25, v22
  v_mul_u32_u24 v25, 1280, v25
  v_lshl_add_u32 v76, v21, 4, v25
  s_mul_i32 s21, s20, 960
  s_add_u32 s21, s21, 832
  v_add_u32 v21, s21, v1
  v_mul_u32_u24 v22, v21, v29
  v_lshrrev_b32 v22, 22, v22
  v_mul_u32_u24 v23, 80, v22
  v_sub_u32 v21, v21, v23
  v_mul_u32_u24 v26, 5462, v22
  v_lshrrev_b32 v26, 16, v26
  v_mul_u32_u24 v27, 12, v26
  v_sub_u32 v22, v22, v27
  v_lshrrev_b32 v27, 2, v22
  v_and_b32 v22, 3, v22
  v_lshlrev_b32 v25, 4, v27
  v_lshl_add_u32 v25, v26, 2, v25
  v_add_u32 v25, v25, v22
  v_mul_u32_u24 v25, 1280, v25
  v_lshl_add_u32 v77, v21, 4, v25
  s_mul_i32 s21, s20, 960
  s_add_u32 s21, s21, 896
  v_add_u32 v21, s21, v1
  v_mul_u32_u24 v22, v21, v29
  v_lshrrev_b32 v22, 22, v22
  v_mul_u32_u24 v23, 80, v22
  v_sub_u32 v21, v21, v23
  v_mul_u32_u24 v26, 5462, v22
  v_lshrrev_b32 v26, 16, v26
  v_mul_u32_u24 v27, 12, v26
  v_sub_u32 v22, v22, v27
  v_lshrrev_b32 v27, 2, v22
  v_and_b32 v22, 3, v22
  v_lshlrev_b32 v25, 4, v27
  v_lshl_add_u32 v25, v26, 2, v25
  v_add_u32 v25, v25, v22
  v_mul_u32_u24 v25, 1280, v25
  v_lshl_add_u32 v78, v21, 4, v25
  v_lshrrev_b32 v6, 2, v2
  v_lshl_add_u32 v6, v3, 3, v6
  v_mul_u32_u24 v6, 1280, v6
  v_and_b32 v7, 3, v2
  v_lshlrev_b32 v7, 3, v7
  s_mul_i32 s21, s20, 320
  v_add3_u32 v6, v6, v7, s21
  v_add_u32 v12, v6, v7
  v_add_u32 v7, 40960, v6
  v_add_u32 v8, 81920, v6
  v_add_u32 v13, 40960, v12
  v_add_u32 v14, 81920, v12
  s_mul_i32 s40, s2, 245760
  s_add_u32 s21, s40, 0
  s_mul_i32 s22, s20, 15360
  s_add_u32 s22, s22, 0
  s_add_u32 m0, s22, 0
  s_nop 0
  buffer_load_dwordx4 v64, s[12:15], s21 offen lds
  s_add_u32 m0, s22, 1024
  s_nop 0
  buffer_load_dwordx4 v65, s[12:15], s21 offen lds
  s_add_u32 m0, s22, 2048
  s_nop 0
  buffer_load_dwordx4 v66, s[12:15], s21 offen lds
  s_add_u32 m0, s22, 3072
  s_nop 0
  buffer_load_dwordx4 v67, s[12:15], s21 offen lds
  s_add_u32 m0, s22, 4096
  s_nop 0
  buffer_load_dwordx4 v68, s[12:15], s21 offen lds
  s_add_u32 m0, s22, 5120
  s_nop 0
  buffer_load_dwordx4 v69, s[12:15], s21 offen lds
  s_add_u32 m0, s22, 6144
  s_nop 0
  buffer_load_dwordx4 v70, s[12:15], s21 offen lds
  s_add_u32 m0, s22, 7168
  s_nop 0
  buffer_load_dwordx4 v71, s[12:15], s21 offen lds
  s_add_u32 m0, s22, 8192
  s_nop 0
  buffer_load_dwordx4 v72, s[12:15], s21 offen lds
  s_add_u32 m0, s22, 9216
  s_nop 0
  buffer_load_dwordx4 v73, s[12:15], s21 offen lds
  s_add_u32 m0, s22, 10240
  s_nop 0
  buffer_load_dwordx4 v74, s[12:15], s21 offen lds
  s_add_u32 m0, s22, 11264
  s_nop 0
  buffer_load_dwordx4 v75, s[12:15], s21 offen lds
  s_add_u32 m0, s22, 12288
  s_nop 0
  buffer_load_dwordx4 v76, s[12:15], s21 offen lds
  s_add_u32 m0, s22, 13312
  s_nop 0
  buffer_load_dwordx4 v77, s[12:15], s21 offen lds
  s_add_u32 m0, s22, 14336
  s_nop 0
  buffer_load_dwordx4 v78, s[12:15], s21 offen lds
  s_add_u32 s21, s40, 61440
  s_mul_i32 s22, s20, 15360
  s_add_u32 s22, s22, 61440
  s_add_u32 m0, s22, 0
  s_nop 0
  buffer_load_dwordx4 v64, s[12:15], s21 offen lds
  s_add_u32 m0, s22, 1024
  s_nop 0
  buffer_load_dwordx4 v65, s[12:15], s21 offen lds
  s_add_u32 m0, s22, 2048
  s_nop 0
  buffer_load_dwordx4 v66, s[12:15], s21 offen lds
  s_add_u32 m0, s22, 3072
  s_nop 0
  buffer_load_dwordx4 v67, s[12:15], s21 offen lds
  s_add_u32 m0, s22, 4096
  s_nop 0
  buffer_load_dwordx4 v68, s[12:15], s21 offen lds
  s_add_u32 m0, s22, 5120
  s_nop 0
  buffer_load_dwordx4 v69, s[12:15], s21 offen lds
  s_add_u32 m0, s22, 6144
  s_nop 0
  buffer_load_dwordx4 v70, s[12:15], s21 offen lds
  s_add_u32 m0, s22, 7168
  s_nop 0
  buffer_load_dwordx4 v71, s[12:15], s21 offen lds
  s_add_u32 m0, s22, 8192
  s_nop 0
  buffer_load_dwordx4 v72, s[12:15], s21 offen lds
  s_add_u32 m0, s22, 9216
  s_nop 0
  buffer_load_dwordx4 v73, s[12:15], s21 offen lds
  s_add_u32 m0, s22, 10240
  s_nop 0
  buffer_load_dwordx4 v74, s[12:15], s21 offen lds
  s_add_u32 m0, s22, 11264
  s_nop 0
  buffer_load_dwordx4 v75, s[12:15], s21 offen lds
  s_add_u32 m0, s22, 12288
  s_nop 0
  buffer_load_dwordx4 v76, s[12:15], s21 offen lds
  s_add_u32 m0, s22, 13312
  s_nop 0
  buffer_load_dwordx4 v77, s[12:15], s21 offen lds
  s_add_u32 m0, s22, 14336
  s_nop 0
  buffer_load_dwordx4 v78, s[12:15], s21 offen lds
  s_waitcnt vmcnt(0)
  s_barrier
  ds_read_b64_tr_b16 a[0:1], v12 offset:0
  ds_read_b64_tr_b16 a[2:3], v12 offset:5120
  ds_read_b64_tr_b16 a[24:25], v12 offset:8
  ds_read_b64_tr_b16 a[26:27], v12 offset:5128
  ds_read_b64_tr_b16 a[48:49], v6 offset:64
  ds_read_b64_tr_b16 a[50:51], v6 offset:5184
  ds_read_b64_tr_b16 a[72:73], v12 offset:96
  ds_read_b64_tr_b16 a[74:75], v12 offset:5216
  ds_read_b64_tr_b16 a[96:97], v12 offset:104
  ds_read_b64_tr_b16 a[98:99], v12 offset:5224
  ds_read_b64_tr_b16 a[120:121], v12 offset:160
  ds_read_b64_tr_b16 a[122:123], v12 offset:5280
  ds_read_b64_tr_b16 a[144:145], v12 offset:168
  ds_read_b64_tr_b16 a[146:147], v12 offset:5288
  ds_read_b64_tr_b16 a[168:169], v6 offset:224
  ds_read_b64_tr_b16 a[170:171], v6 offset:5344
  ds_read_b64_tr_b16 a[192:193], v12 offset:256
  ds_read_b64_tr_b16 a[194:195], v12 offset:5376
  ds_read_b64_tr_b16 a[216:217], v12 offset:264
  ds_read_b64_tr_b16 a[218:219], v12 offset:5384
  ds_read_b64_tr_b16 a[4:5], v13 offset:0
  ds_read_b64_tr_b16 a[6:7], v13 offset:5120
  ds_read_b64_tr_b16 a[28:29], v13 offset:8
  ds_read_b64_tr_b16 a[30:31], v13 offset:5128
  ds_read_b64_tr_b16 a[52:53], v7 offset:64
  ds_read_b64_tr_b16 a[54:55], v7 offset:5184
  ds_read_b64_tr_b16 a[76:77], v13 offset:96
  ds_read_b64_tr_b16 a[78:79], v13 offset:5216
  ds_read_b64_tr_b16 a[100:101], v13 offset:104
  ds_read_b64_tr_b16 a[102:103], v13 offset:5224
  ds_read_b64_tr_b16 a[124:125], v13 offset:160
  ds_read_b64_tr_b16 a[126:127], v13 offset:5280
  ds_read_b64_tr_b16 a[148:149], v13 offset:168
  ds_read_b64_tr_b16 a[150:151], v13 offset:5288
  ds_read_b64_tr_b16 a[172:173], v7 offset:224
  ds_read_b64_tr_b16 a[174:175], v7 offset:5344
  ds_read_b64_tr_b16 a[196:197], v13 offset:256
  ds_read_b64_tr_b16 a[198:199], v13 offset:5376
  ds_read_b64_tr_b16 a[220:221], v13 offset:264
  ds_read_b64_tr_b16 a[222:223], v13 offset:5384
  ds_read_b64_tr_b16 a[8:9], v14 offset:0
  ds_read_b64_tr_b16 a[10:11], v14 offset:5120
  ds_read_b64_tr_b16 a[32:33], v14 offset:8
  ds_read_b64_tr_b16 a[34:35], v14 offset:5128
  ds_read_b64_tr_b16 a[56:57], v8 offset:64
  ds_read_b64_tr_b16 a[58:59], v8 offset:5184
  ds_read_b64_tr_b16 a[80:81], v14 offset:96
  ds_read_b64_tr_b16 a[82:83], v14 offset:5216
  ds_read_b64_tr_b16 a[104:105], v14 offset:104
  ds_read_b64_tr_b16 a[106:107], v14 offset:5224
  ds_read_b64_tr_b16 a[128:129], v14 offset:160
  ds_read_b64_tr_b16 a[130:131], v14 offset:5280
  ds_read_b64_tr_b16 a[152:153], v14 offset:168
  ds_read_b64_tr_b16 a[154:155], v14 offset:5288
  ds_read_b64_tr_b16 a[176:177], v8 offset:224
  ds_read_b64_tr_b16 a[178:179], v8 offset:5344
  ds_read_b64_tr_b16 a[200:201], v14 offset:256
  ds_read_b64_tr_b16 a[202:203], v14 offset:5376
  ds_read_b64_tr_b16 a[224:225], v14 offset:264
  ds_read_b64_tr_b16 a[226:227], v14 offset:5384
  s_waitcnt lgkmcnt(0)
  s_barrier
  s_add_u32 s21, s40, 122880
  s_mul_i32 s22, s20, 15360
  s_add_u32 s22, s22, 0
  s_add_u32 m0, s22, 0
  s_nop 0
  buffer_load_dwordx4 v64, s[12:15], s21 offen lds
  s_add_u32 m0, s22, 1024
  s_nop 0
  buffer_load_dwordx4 v65, s[12:15], s21 offen lds
  s_add_u32 m0, s22, 2048
  s_nop 0
  buffer_load_dwordx4 v66, s[12:15], s21 offen lds
  s_add_u32 m0, s22, 3072
  s_nop 0
  buffer_load_dwordx4 v67, s[12:15], s21 offen lds
  s_add_u32 m0, s22, 4096
  s_nop 0
  buffer_load_dwordx4 v68, s[12:15], s21 offen lds
  s_add_u32 m0, s22, 5120
  s_nop 0
  buffer_load_dwordx4 v69, s[12:15], s21 offen lds
  s_add_u32 m0, s22, 6144
  s_nop 0
  buffer_load_dwordx4 v70, s[12:15], s21 offen lds
  s_add_u32 m0, s22, 7168
  s_nop 0
  buffer_load_dwordx4 v71, s[12:15], s21 offen lds
  s_add_u32 m0, s22, 8192
  s_nop 0
  buffer_load_dwordx4 v72, s[12:15], s21 offen lds
  s_add_u32 m0, s22, 9216
  s_nop 0
  buffer_load_dwordx4 v73, s[12:15], s21 offen lds
  s_add_u32 m0, s22, 10240
  s_nop 0
  buffer_load_dwordx4 v74, s[12:15], s21 offen lds
  s_add_u32 m0, s22, 11264
  s_nop 0
  buffer_load_dwordx4 v75, s[12:15], s21 offen lds
  s_add_u32 m0, s22, 12288
  s_nop 0
  buffer_load_dwordx4 v76, s[12:15], s21 offen lds
  s_add_u32 m0, s22, 13312
  s_nop 0
  buffer_load_dwordx4 v77, s[12:15], s21 offen lds
  s_add_u32 m0, s22, 14336
  s_nop 0
  buffer_load_dwordx4 v78, s[12:15], s21 offen lds
  s_add_u32 s21, s40, 184320
  s_mul_i32 s22, s20, 15360
  s_add_u32 s22, s22, 61440
  s_add_u32 m0, s22, 0
  s_nop 0
  buffer_load_dwordx4 v64, s[12:15], s21 offen lds
  s_add_u32 m0, s22, 1024
  s_nop 0
  buffer_load_dwordx4 v65, s[12:15], s21 offen lds
  s_add_u32 m0, s22, 2048
  s_nop 0
  buffer_load_dwordx4 v66, s[12:15], s21 offen lds
  s_add_u32 m0, s22, 3072
  s_nop 0
  buffer_load_dwordx4 v67, s[12:15], s21 offen lds
  s_add_u32 m0, s22, 4096
  s_nop 0
  buffer_load_dwordx4 v68, s[12:15], s21 offen lds
  s_add_u32 m0, s22, 5120
  s_nop 0
  buffer_load_dwordx4 v69, s[12:15], s21 offen lds
  s_add_u32 m0, s22, 6144
  s_nop 0
  buffer_load_dwordx4 v70, s[12:15], s21 offen lds
  s_add_u32 m0, s22, 7168
  s_nop 0
  buffer_load_dwordx4 v71, s[12:15], s21 offen lds
  s_add_u32 m0, s22, 8192
  s_nop 0
  buffer_load_dwordx4 v72, s[12:15], s21 offen lds
  s_add_u32 m0, s22, 9216
  s_nop 0
  buffer_load_dwordx4 v73, s[12:15], s21 offen lds
  s_add_u32 m0, s22, 10240
  s_nop 0
  buffer_load_dwordx4 v74, s[12:15], s21 offen lds
  s_add_u32 m0, s22, 11264
  s_nop 0
  buffer_load_dwordx4 v75, s[12:15], s21 offen lds
  s_add_u32 m0, s22, 12288
  s_nop 0
  buffer_load_dwordx4 v76, s[12:15], s21 offen lds
  s_add_u32 m0, s22, 13312
  s_nop 0
  buffer_load_dwordx4 v77, s[12:15], s21 offen lds
  s_add_u32 m0, s22, 14336
  s_nop 0
  buffer_load_dwordx4 v78, s[12:15], s21 offen lds
  s_waitcnt vmcnt(0)
  s_barrier
  ds_read_b64_tr_b16 a[12:13], v12 offset:0
  ds_read_b64_tr_b16 a[14:15], v12 offset:5120
  ds_read_b64_tr_b16 a[36:37], v12 offset:8
  ds_read_b64_tr_b16 a[38:39], v12 offset:5128
  ds_read_b64_tr_b16 a[60:61], v6 offset:64
  ds_read_b64_tr_b16 a[62:63], v6 offset:5184
  ds_read_b64_tr_b16 a[84:85], v12 offset:96
  ds_read_b64_tr_b16 a[86:87], v12 offset:5216
  ds_read_b64_tr_b16 a[108:109], v12 offset:104
  ds_read_b64_tr_b16 a[110:111], v12 offset:5224
  ds_read_b64_tr_b16 a[132:133], v12 offset:160
  ds_read_b64_tr_b16 a[134:135], v12 offset:5280
  ds_read_b64_tr_b16 a[156:157], v12 offset:168
  ds_read_b64_tr_b16 a[158:159], v12 offset:5288
  ds_read_b64_tr_b16 a[180:181], v6 offset:224
  ds_read_b64_tr_b16 a[182:183], v6 offset:5344
  ds_read_b64_tr_b16 a[204:205], v12 offset:256
  ds_read_b64_tr_b16 a[206:207], v12 offset:5376
  ds_read_b64_tr_b16 a[228:229], v12 offset:264
  ds_read_b64_tr_b16 a[230:231], v12 offset:5384
  ds_read_b64_tr_b16 a[16:17], v13 offset:0
  ds_read_b64_tr_b16 a[18:19], v13 offset:5120
  ds_read_b64_tr_b16 a[40:41], v13 offset:8
  ds_read_b64_tr_b16 a[42:43], v13 offset:5128
  ds_read_b64_tr_b16 a[64:65], v7 offset:64
  ds_read_b64_tr_b16 a[66:67], v7 offset:5184
  ds_read_b64_tr_b16 a[88:89], v13 offset:96
  ds_read_b64_tr_b16 a[90:91], v13 offset:5216
  ds_read_b64_tr_b16 a[112:113], v13 offset:104
  ds_read_b64_tr_b16 a[114:115], v13 offset:5224
  ds_read_b64_tr_b16 a[136:137], v13 offset:160
  ds_read_b64_tr_b16 a[138:139], v13 offset:5280
  ds_read_b64_tr_b16 a[160:161], v13 offset:168
  ds_read_b64_tr_b16 a[162:163], v13 offset:5288
  ds_read_b64_tr_b16 a[184:185], v7 offset:224
  ds_read_b64_tr_b16 a[186:187], v7 offset:5344
  ds_read_b64_tr_b16 a[208:209], v13 offset:256
  ds_read_b64_tr_b16 a[210:211], v13 offset:5376
  ds_read_b64_tr_b16 a[232:233], v13 offset:264
  ds_read_b64_tr_b16 a[234:235], v13 offset:5384
  ds_read_b64_tr_b16 a[20:21], v14 offset:0
  ds_read_b64_tr_b16 a[22:23], v14 offset:5120
  ds_read_b64_tr_b16 a[44:45], v14 offset:8
  ds_read_b64_tr_b16 a[46:47], v14 offset:5128
  ds_read_b64_tr_b16 a[68:69], v8 offset:64
  ds_read_b64_tr_b16 a[70:71], v8 offset:5184
  ds_read_b64_tr_b16 a[92:93], v14 offset:96
  ds_read_b64_tr_b16 a[94:95], v14 offset:5216
  ds_read_b64_tr_b16 a[116:117], v14 offset:104
  ds_read_b64_tr_b16 a[118:119], v14 offset:5224
  ds_read_b64_tr_b16 a[140:141], v14 offset:160
  ds_read_b64_tr_b16 a[142:143], v14 offset:5280
  ds_read_b64_tr_b16 a[164:165], v14 offset:168
  ds_read_b64_tr_b16 a[166:167], v14 offset:5288
  ds_read_b64_tr_b16 a[188:189], v8 offset:224
  ds_read_b64_tr_b16 a[190:191], v8 offset:5344
  ds_read_b64_tr_b16 a[212:213], v14 offset:256
  ds_read_b64_tr_b16 a[214:215], v14 offset:5376
  ds_read_b64_tr_b16 a[236:237], v14 offset:264
  ds_read_b64_tr_b16 a[238:239], v14 offset:5384
  s_waitcnt lgkmcnt(0)
  s_barrier
  s_load_dwordx2 s[32:33], s[0:1], 96
  s_waitcnt lgkmcnt(0)
  s_mov_b32 s32, s32
  s_mov_b32 s33, s33
  s_mov_b32 s34, 256
  s_mov_b32 s35, 0x00020000
  s_mov_b32 s21, 76
  s_cmp_lg_u32 s20, 0
  s_cbranch_scc1 wf_234
  v_mov_b32 v4, 0
  s_mov_b32 s101, 0
wf_233:
  buffer_load_dword v5, v4, s[32:35], s21 offen sc1
  s_add_u32 s101, s101, 1
  s_cmp_gt_u32 s101, 131072
  s_cbranch_scc1 main_end
  s_waitcnt vmcnt(0)
  v_readfirstlane_b32 s100, v5
  s_cmp_ge_u32 s100, 1
  s_cbranch_scc1 wf_234
  s_sleep 8
  s_branch wf_233
wf_234:
  s_barrier
  s_mul_i32 s41, s2, 12288
  s_add_u32 s41, s41, 25165824
  s_mul_i32 s42, s2, 40960
  s_mul_i32 s21, s20, 10240
  s_add_u32 s42, s42, s21
  s_lshr_b32 s43, s2, 2
  s_lshl_b32 s43, s43, 7
  s_add_u32 s43, s43, 0
  s_lshl_b32 s44, s2, 7
  s_lshl_b32 s21, s20, 2
  s_add_u32 s44, s44, s21
  s_add_u32 s44, s44, 94208
  s_mov_b32 s45, 0
  s_mov_b32 s50, 0
  v_mov_b32 v10, 0
  v_lshlrev_b32 v4, 4, v1
  v_lshlrev_b32 v21, 3, v1
  s_add_u32 s84, s38, 50331648
  s_addc_u32 s85, s39, 0
  s_mov_b32 s86, 6291456
  s_mov_b32 s87, 0x00020000
  s_add_u32 s80, s38, 93323264
  s_addc_u32 s81, s39, 0
  s_mov_b32 s82, 20971520
  s_mov_b32 s83, 0x00020000
  s_add_u32 s88, s38, 85983232
  s_addc_u32 s89, s39, 0
  s_mov_b32 s90, 5242880
  s_mov_b32 s91, 0x00020000
  v_mov_b32 v244, -1
  v_mov_b32 v245, -1
  v_mov_b32 v246, -1
  v_mov_b32 v247, -1
  s_cmp_lg_u32 s20, 0
  s_cbranch_scc1 wf_236
  v_mov_b32 v8, 0
  s_mov_b32 s101, 0
wf_235:
  buffer_load_dword v9, v8, s[72:75], s43 offen sc1
  s_add_u32 s101, s101, 1
  s_cmp_gt_u32 s101, 131072
  s_cbranch_scc1 main_end
  s_waitcnt vmcnt(0)
  v_readfirstlane_b32 s100, v9
  s_cmp_ge_u32 s100, 8
  s_cbranch_scc1 wf_236
  s_sleep 6
  s_branch wf_235
wf_236:
  s_barrier
  v_lshlrev_b32 v21, 3, v1
  s_add_u32 s21, s41, 0
  buffer_load_dwordx4 v[144:147], v4, s[16:19], s21 offen offset:0 sc1
  buffer_load_dwordx4 v[148:151], v4, s[16:19], s21 offen offset:1024 sc1
  buffer_load_dwordx4 v[152:155], v4, s[16:19], s21 offen offset:2048 sc1
  buffer_load_dwordx4 v[156:159], v4, s[16:19], s21 offen offset:3072 sc1
  s_add_u32 s21, s41, 4096
  buffer_load_dwordx4 v[160:163], v4, s[16:19], s21 offen offset:0 sc1
  buffer_load_dwordx4 v[164:167], v4, s[16:19], s21 offen offset:1024 sc1
  buffer_load_dwordx4 v[168:171], v4, s[16:19], s21 offen offset:2048 sc1
  buffer_load_dwordx4 v[172:175], v4, s[16:19], s21 offen offset:3072 sc1
  s_add_u32 s21, s41, 8192
  buffer_load_dwordx4 v[176:179], v4, s[16:19], s21 offen offset:0 sc1
  buffer_load_dwordx4 v[180:183], v4, s[16:19], s21 offen offset:1024 sc1
  buffer_load_dwordx4 v[184:187], v4, s[16:19], s21 offen offset:2048 sc1
  buffer_load_dwordx4 v[188:191], v4, s[16:19], s21 offen offset:3072 sc1
  s_add_u32 s41, s41, 393216
  v_mov_b32 v9, 0
  s_waitcnt vmcnt(0)
vwl_237:
  s_add_u32 s46, s45, 1
  s_cmp_ge_u32 s46, 64
  s_cbranch_scc1 vwn_239
  s_cmp_lt_u32 s46, 8
  s_cselect_b32 s21, 1, 3
  s_and_b32 s21, s46, s21
  s_cmp_lg_u32 s21, 0
  s_cbranch_scc1 vwn_238
  s_add_u32 s43, s43, 1024
  v_readfirstlane_b32 s21, v9
  v_mov_b32 v9, 0
  s_cmp_lt_u32 s21, 8
  s_cselect_b32 s50, 1, 0
  s_cbranch_scc1 vwn_239
vwn_238:
  s_add_u32 s21, s41, 0
  buffer_load_dwordx4 v[192:195], v4, s[16:19], s21 offen offset:0 sc1
  buffer_load_dwordx4 v[196:199], v4, s[16:19], s21 offen offset:1024 sc1
  buffer_load_dwordx4 v[200:203], v4, s[16:19], s21 offen offset:2048 sc1
  buffer_load_dwordx4 v[204:207], v4, s[16:19], s21 offen offset:3072 sc1
  s_add_u32 s21, s41, 4096
  buffer_load_dwordx4 v[208:211], v4, s[16:19], s21 offen offset:0 sc1
  buffer_load_dwordx4 v[212:215], v4, s[16:19], s21 offen offset:1024 sc1
  buffer_load_dwordx4 v[216:219], v4, s[16:19], s21 offen offset:2048 sc1
  buffer_load_dwordx4 v[220:223], v4, s[16:19], s21 offen offset:3072 sc1
  s_add_u32 s21, s41, 8192
  buffer_load_dwordx4 v[224:227], v4, s[16:19], s21 offen offset:0 sc1
  buffer_load_dwordx4 v[228:231], v4, s[16:19], s21 offen offset:1024 sc1
  buffer_load_dwordx4 v[232:235], v4, s[16:19], s21 offen offset:2048 sc1
  buffer_load_dwordx4 v[236:239], v4, s[16:19], s21 offen offset:3072 sc1
  s_add_u32 s41, s41, 393216
vwn_239:
  s_cmp_lg_u32 s45, 24
  s_cbranch_scc1 arm_240
  s_mul_i32 s21, s2, 10240
  s_mul_i32 s22, s20, 2560
  s_add_u32 s21, s21, s22
  s_add_u32 s21, s21, 18350080
  buffer_store_dwordx4 v[244:247], v4, s[80:83], s21 offen sc1
  buffer_store_dwordx4 v[244:247], v4, s[80:83], s21 offen offset:1024 sc1
  buffer_store_dwordx2 v[244:245], v21, s[80:83], s21 offen offset:2048 sc1
  s_add_u32 s21, s21, 327680
  buffer_store_dwordx4 v[244:247], v4, s[80:83], s21 offen sc1
  buffer_store_dwordx4 v[244:247], v4, s[80:83], s21 offen offset:1024 sc1
  buffer_store_dwordx2 v[244:245], v21, s[80:83], s21 offen offset:2048 sc1
  s_add_u32 s21, s21, 327680
  buffer_store_dwordx4 v[244:247], v4, s[80:83], s21 offen sc1
  buffer_store_dwordx4 v[244:247], v4, s[80:83], s21 offen offset:1024 sc1
  buffer_store_dwordx2 v[244:245], v21, s[80:83], s21 offen offset:2048 sc1
  s_add_u32 s21, s21, 327680
  buffer_store_dwordx4 v[244:247], v4, s[80:83], s21 offen sc1
  buffer_store_dwordx4 v[244:247], v4, s[80:83], s21 offen offset:1024 sc1
  buffer_store_dwordx2 v[244:245], v21, s[80:83], s21 offen offset:2048 sc1
  s_add_u32 s21, s21, 327680
  buffer_store_dwordx4 v[244:247], v4, s[80:83], s21 offen sc1
  buffer_store_dwordx4 v[244:247], v4, s[80:83], s21 offen offset:1024 sc1
  buffer_store_dwordx2 v[244:245], v21, s[80:83], s21 offen offset:2048 sc1
  s_add_u32 s21, s21, 327680
  buffer_store_dwordx4 v[244:247], v4, s[80:83], s21 offen sc1
  buffer_store_dwordx4 v[244:247], v4, s[80:83], s21 offen offset:1024 sc1
  buffer_store_dwordx2 v[244:245], v21, s[80:83], s21 offen offset:2048 sc1
  s_add_u32 s21, s21, 327680
  buffer_store_dwordx4 v[244:247], v4, s[80:83], s21 offen sc1
  buffer_store_dwordx4 v[244:247], v4, s[80:83], s21 offen offset:1024 sc1
  buffer_store_dwordx2 v[244:245], v21, s[80:83], s21 offen offset:2048 sc1
  s_add_u32 s21, s21, 327680
  buffer_store_dwordx4 v[244:247], v4, s[80:83], s21 offen sc1
  buffer_store_dwordx4 v[244:247], v4, s[80:83], s21 offen offset:1024 sc1
  buffer_store_dwordx2 v[244:245], v21, s[80:83], s21 offen offset:2048 sc1
  s_add_u32 s21, s21, 327680
  s_and_b32 s21, s2, 3
  s_cmp_lg_u32 s21, s20
  s_cbranch_scc1 arm_240
  s_waitcnt vmcnt(12)
  s_mul_i32 s21, s2, 2560
  s_add_u32 s21, s21, 4587520
  buffer_store_dwordx4 v[244:247], v4, s[88:91], s21 offen sc1
  buffer_store_dwordx4 v[244:247], v4, s[88:91], s21 offen offset:1024 sc1
  buffer_store_dwordx2 v[244:245], v21, s[88:91], s21 offen offset:2048 sc1
  s_add_u32 s21, s21, 81920
  buffer_store_dwordx4 v[244:247], v4, s[88:91], s21 offen sc1
  buffer_store_dwordx4 v[244:247], v4, s[88:91], s21 offen offset:1024 sc1
  buffer_store_dwordx2 v[244:245], v21, s[88:91], s21 offen offset:2048 sc1
  s_add_u32 s21, s21, 81920
  buffer_store_dwordx4 v[244:247], v4, s[88:91], s21 offen sc1
  buffer_store_dwordx4 v[244:247], v4, s[88:91], s21 offen offset:1024 sc1
  buffer_store_dwordx2 v[244:245], v21, s[88:91], s21 offen offset:2048 sc1
  s_add_u32 s21, s21, 81920
  buffer_store_dwordx4 v[244:247], v4, s[88:91], s21 offen sc1
  buffer_store_dwordx4 v[244:247], v4, s[88:91], s21 offen offset:1024 sc1
  buffer_store_dwordx2 v[244:245], v21, s[88:91], s21 offen offset:2048 sc1
  s_add_u32 s21, s21, 81920
  buffer_store_dwordx4 v[244:247], v4, s[88:91], s21 offen sc1
  buffer_store_dwordx4 v[244:247], v4, s[88:91], s21 offen offset:1024 sc1
  buffer_store_dwordx2 v[244:245], v21, s[88:91], s21 offen offset:2048 sc1
  s_add_u32 s21, s21, 81920
  buffer_store_dwordx4 v[244:247], v4, s[88:91], s21 offen sc1
  buffer_store_dwordx4 v[244:247], v4, s[88:91], s21 offen offset:1024 sc1
  buffer_store_dwordx2 v[244:245], v21, s[88:91], s21 offen offset:2048 sc1
  s_add_u32 s21, s21, 81920
  buffer_store_dwordx4 v[244:247], v4, s[88:91], s21 offen sc1
  buffer_store_dwordx4 v[244:247], v4, s[88:91], s21 offen offset:1024 sc1
  buffer_store_dwordx2 v[244:245], v21, s[88:91], s21 offen offset:2048 sc1
  s_add_u32 s21, s21, 81920
  buffer_store_dwordx4 v[244:247], v4, s[88:91], s21 offen sc1
  buffer_store_dwordx4 v[244:247], v4, s[88:91], s21 offen offset:1024 sc1
  buffer_store_dwordx2 v[244:245], v21, s[88:91], s21 offen offset:2048 sc1
  s_add_u32 s21, s21, 81920
  s_mul_i32 s21, s2, 3072
  s_add_u32 s21, s21, 5898240
  buffer_store_dwordx4 v[244:247], v4, s[84:87], s21 offen offset:0 sc1
  buffer_store_dwordx4 v[244:247], v4, s[84:87], s21 offen offset:1024 sc1
  buffer_store_dwordx4 v[244:247], v4, s[84:87], s21 offen offset:2048 sc1
  s_add_u32 s21, s21, 98304
  buffer_store_dwordx4 v[244:247], v4, s[84:87], s21 offen offset:0 sc1
  buffer_store_dwordx4 v[244:247], v4, s[84:87], s21 offen offset:1024 sc1
  buffer_store_dwordx4 v[244:247], v4, s[84:87], s21 offen offset:2048 sc1
  s_add_u32 s21, s21, 98304
  buffer_store_dwordx4 v[244:247], v4, s[84:87], s21 offen offset:0 sc1
  buffer_store_dwordx4 v[244:247], v4, s[84:87], s21 offen offset:1024 sc1
  buffer_store_dwordx4 v[244:247], v4, s[84:87], s21 offen offset:2048 sc1
  s_add_u32 s21, s21, 98304
  buffer_store_dwordx4 v[244:247], v4, s[84:87], s21 offen offset:0 sc1
  buffer_store_dwordx4 v[244:247], v4, s[84:87], s21 offen offset:1024 sc1
  buffer_store_dwordx4 v[244:247], v4, s[84:87], s21 offen offset:2048 sc1
  s_add_u32 s21, s21, 98304
arm_240:
  v_mfma_f32_16x16x32_bf16 v[64:67], v[144:147], a[0:3], 0
  v_mfma_f32_16x16x32_bf16 v[72:75], v[144:147], a[24:27], 0
  v_mfma_f32_16x16x32_bf16 v[80:83], v[144:147], a[48:51], 0
  v_mfma_f32_16x16x32_bf16 v[88:91], v[144:147], a[72:75], 0
  v_mfma_f32_16x16x32_bf16 v[96:99], v[144:147], a[96:99], 0
  v_mfma_f32_16x16x32_bf16 v[104:107], v[144:147], a[120:123], 0
  v_mfma_f32_16x16x32_bf16 v[112:115], v[144:147], a[144:147], 0
  v_mfma_f32_16x16x32_bf16 v[120:123], v[144:147], a[168:171], 0
  v_mfma_f32_16x16x32_bf16 v[128:131], v[144:147], a[192:195], 0
  v_mfma_f32_16x16x32_bf16 v[136:139], v[144:147], a[216:219], 0
  v_mfma_f32_16x16x32_bf16 v[68:71], v[168:171], a[0:3], 0
  v_mfma_f32_16x16x32_bf16 v[76:79], v[168:171], a[24:27], 0
  v_mfma_f32_16x16x32_bf16 v[84:87], v[168:171], a[48:51], 0
  v_mfma_f32_16x16x32_bf16 v[92:95], v[168:171], a[72:75], 0
  v_mfma_f32_16x16x32_bf16 v[100:103], v[168:171], a[96:99], 0
  v_mfma_f32_16x16x32_bf16 v[108:111], v[168:171], a[120:123], 0
  v_mfma_f32_16x16x32_bf16 v[116:119], v[168:171], a[144:147], 0
  v_mfma_f32_16x16x32_bf16 v[124:127], v[168:171], a[168:171], 0
  v_mfma_f32_16x16x32_bf16 v[132:135], v[168:171], a[192:195], 0
  v_mfma_f32_16x16x32_bf16 v[140:143], v[168:171], a[216:219], 0
  v_mfma_f32_16x16x32_bf16 v[64:67], v[148:151], a[4:7], v[64:67]
  v_mfma_f32_16x16x32_bf16 v[72:75], v[148:151], a[28:31], v[72:75]
  v_mfma_f32_16x16x32_bf16 v[80:83], v[148:151], a[52:55], v[80:83]
  v_mfma_f32_16x16x32_bf16 v[88:91], v[148:151], a[76:79], v[88:91]
  v_mfma_f32_16x16x32_bf16 v[96:99], v[148:151], a[100:103], v[96:99]
  v_mfma_f32_16x16x32_bf16 v[104:107], v[148:151], a[124:127], v[104:107]
  v_mfma_f32_16x16x32_bf16 v[112:115], v[148:151], a[148:151], v[112:115]
  v_mfma_f32_16x16x32_bf16 v[120:123], v[148:151], a[172:175], v[120:123]
  v_mfma_f32_16x16x32_bf16 v[128:131], v[148:151], a[196:199], v[128:131]
  v_mfma_f32_16x16x32_bf16 v[136:139], v[148:151], a[220:223], v[136:139]
  v_mfma_f32_16x16x32_bf16 v[68:71], v[172:175], a[4:7], v[68:71]
  v_mfma_f32_16x16x32_bf16 v[76:79], v[172:175], a[28:31], v[76:79]
  v_mfma_f32_16x16x32_bf16 v[84:87], v[172:175], a[52:55], v[84:87]
  v_mfma_f32_16x16x32_bf16 v[92:95], v[172:175], a[76:79], v[92:95]
  v_mfma_f32_16x16x32_bf16 v[100:103], v[172:175], a[100:103], v[100:103]
  v_mfma_f32_16x16x32_bf16 v[108:111], v[172:175], a[124:127], v[108:111]
  v_mfma_f32_16x16x32_bf16 v[116:119], v[172:175], a[148:151], v[116:119]
  v_mfma_f32_16x16x32_bf16 v[124:127], v[172:175], a[172:175], v[124:127]
  v_mfma_f32_16x16x32_bf16 v[132:135], v[172:175], a[196:199], v[132:135]
  v_mfma_f32_16x16x32_bf16 v[140:143], v[172:175], a[220:223], v[140:143]
  v_mfma_f32_16x16x32_bf16 v[64:67], v[152:155], a[8:11], v[64:67]
  v_mfma_f32_16x16x32_bf16 v[72:75], v[152:155], a[32:35], v[72:75]
  v_mfma_f32_16x16x32_bf16 v[80:83], v[152:155], a[56:59], v[80:83]
  v_mfma_f32_16x16x32_bf16 v[88:91], v[152:155], a[80:83], v[88:91]
  v_mfma_f32_16x16x32_bf16 v[96:99], v[152:155], a[104:107], v[96:99]
  v_mfma_f32_16x16x32_bf16 v[104:107], v[152:155], a[128:131], v[104:107]
  v_mfma_f32_16x16x32_bf16 v[112:115], v[152:155], a[152:155], v[112:115]
  v_mfma_f32_16x16x32_bf16 v[120:123], v[152:155], a[176:179], v[120:123]
  v_mfma_f32_16x16x32_bf16 v[128:131], v[152:155], a[200:203], v[128:131]
  v_mfma_f32_16x16x32_bf16 v[136:139], v[152:155], a[224:227], v[136:139]
  v_mfma_f32_16x16x32_bf16 v[68:71], v[176:179], a[8:11], v[68:71]
  v_mfma_f32_16x16x32_bf16 v[76:79], v[176:179], a[32:35], v[76:79]
  v_mfma_f32_16x16x32_bf16 v[84:87], v[176:179], a[56:59], v[84:87]
  v_mfma_f32_16x16x32_bf16 v[92:95], v[176:179], a[80:83], v[92:95]
  v_mfma_f32_16x16x32_bf16 v[100:103], v[176:179], a[104:107], v[100:103]
  v_mfma_f32_16x16x32_bf16 v[108:111], v[176:179], a[128:131], v[108:111]
  v_mfma_f32_16x16x32_bf16 v[116:119], v[176:179], a[152:155], v[116:119]
  v_mfma_f32_16x16x32_bf16 v[124:127], v[176:179], a[176:179], v[124:127]
  v_mfma_f32_16x16x32_bf16 v[132:135], v[176:179], a[200:203], v[132:135]
  v_mfma_f32_16x16x32_bf16 v[140:143], v[176:179], a[224:227], v[140:143]
  s_add_u32 s21, s43, 1024
  buffer_load_dword v9, v10, s[72:75], s21 offen sc1
  v_mfma_f32_16x16x32_bf16 v[64:67], v[156:159], a[12:15], v[64:67]
  v_mfma_f32_16x16x32_bf16 v[72:75], v[156:159], a[36:39], v[72:75]
  v_mfma_f32_16x16x32_bf16 v[80:83], v[156:159], a[60:63], v[80:83]
  v_mfma_f32_16x16x32_bf16 v[88:91], v[156:159], a[84:87], v[88:91]
  v_mfma_f32_16x16x32_bf16 v[96:99], v[156:159], a[108:111], v[96:99]
  v_mfma_f32_16x16x32_bf16 v[104:107], v[156:159], a[132:135], v[104:107]
  v_mfma_f32_16x16x32_bf16 v[112:115], v[156:159], a[156:159], v[112:115]
  v_mfma_f32_16x16x32_bf16 v[120:123], v[156:159], a[180:183], v[120:123]
  v_mfma_f32_16x16x32_bf16 v[128:131], v[156:159], a[204:207], v[128:131]
  v_mfma_f32_16x16x32_bf16 v[136:139], v[156:159], a[228:231], v[136:139]
  v_mfma_f32_16x16x32_bf16 v[68:71], v[180:183], a[12:15], v[68:71]
  v_mfma_f32_16x16x32_bf16 v[76:79], v[180:183], a[36:39], v[76:79]
  v_mfma_f32_16x16x32_bf16 v[84:87], v[180:183], a[60:63], v[84:87]
  v_mfma_f32_16x16x32_bf16 v[92:95], v[180:183], a[84:87], v[92:95]
  v_mfma_f32_16x16x32_bf16 v[100:103], v[180:183], a[108:111], v[100:103]
  v_mfma_f32_16x16x32_bf16 v[108:111], v[180:183], a[132:135], v[108:111]
  v_mfma_f32_16x16x32_bf16 v[116:119], v[180:183], a[156:159], v[116:119]
  v_mfma_f32_16x16x32_bf16 v[124:127], v[180:183], a[180:183], v[124:127]
  v_mfma_f32_16x16x32_bf16 v[132:135], v[180:183], a[204:207], v[132:135]
  v_mfma_f32_16x16x32_bf16 v[140:143], v[180:183], a[228:231], v[140:143]
  v_mfma_f32_16x16x32_bf16 v[64:67], v[160:163], a[16:19], v[64:67]
  v_mfma_f32_16x16x32_bf16 v[72:75], v[160:163], a[40:43], v[72:75]
  v_mfma_f32_16x16x32_bf16 v[80:83], v[160:163], a[64:67], v[80:83]
  v_mfma_f32_16x16x32_bf16 v[88:91], v[160:163], a[88:91], v[88:91]
  v_mfma_f32_16x16x32_bf16 v[96:99], v[160:163], a[112:115], v[96:99]
  v_mfma_f32_16x16x32_bf16 v[104:107], v[160:163], a[136:139], v[104:107]
  v_mfma_f32_16x16x32_bf16 v[112:115], v[160:163], a[160:163], v[112:115]
  v_mfma_f32_16x16x32_bf16 v[120:123], v[160:163], a[184:187], v[120:123]
  v_mfma_f32_16x16x32_bf16 v[128:131], v[160:163], a[208:211], v[128:131]
  v_mfma_f32_16x16x32_bf16 v[136:139], v[160:163], a[232:235], v[136:139]
  v_mfma_f32_16x16x32_bf16 v[68:71], v[184:187], a[16:19], v[68:71]
  v_mfma_f32_16x16x32_bf16 v[76:79], v[184:187], a[40:43], v[76:79]
  v_mfma_f32_16x16x32_bf16 v[84:87], v[184:187], a[64:67], v[84:87]
  v_mfma_f32_16x16x32_bf16 v[92:95], v[184:187], a[88:91], v[92:95]
  v_mfma_f32_16x16x32_bf16 v[100:103], v[184:187], a[112:115], v[100:103]
  v_mfma_f32_16x16x32_bf16 v[108:111], v[184:187], a[136:139], v[108:111]
  v_mfma_f32_16x16x32_bf16 v[116:119], v[184:187], a[160:163], v[116:119]
  v_mfma_f32_16x16x32_bf16 v[124:127], v[184:187], a[184:187], v[124:127]
  v_mfma_f32_16x16x32_bf16 v[132:135], v[184:187], a[208:211], v[132:135]
  v_mfma_f32_16x16x32_bf16 v[140:143], v[184:187], a[232:235], v[140:143]
  v_mfma_f32_16x16x32_bf16 v[64:67], v[164:167], a[20:23], v[64:67]
  v_mfma_f32_16x16x32_bf16 v[72:75], v[164:167], a[44:47], v[72:75]
  v_mfma_f32_16x16x32_bf16 v[80:83], v[164:167], a[68:71], v[80:83]
  v_mfma_f32_16x16x32_bf16 v[88:91], v[164:167], a[92:95], v[88:91]
  v_mfma_f32_16x16x32_bf16 v[96:99], v[164:167], a[116:119], v[96:99]
  v_mfma_f32_16x16x32_bf16 v[104:107], v[164:167], a[140:143], v[104:107]
  v_mfma_f32_16x16x32_bf16 v[112:115], v[164:167], a[164:167], v[112:115]
  v_mfma_f32_16x16x32_bf16 v[120:123], v[164:167], a[188:191], v[120:123]
  v_mfma_f32_16x16x32_bf16 v[128:131], v[164:167], a[212:215], v[128:131]
  v_mfma_f32_16x16x32_bf16 v[136:139], v[164:167], a[236:239], v[136:139]
  v_mfma_f32_16x16x32_bf16 v[68:71], v[188:191], a[20:23], v[68:71]
  v_mfma_f32_16x16x32_bf16 v[76:79], v[188:191], a[44:47], v[76:79]
  v_mfma_f32_16x16x32_bf16 v[84:87], v[188:191], a[68:71], v[84:87]
  v_mfma_f32_16x16x32_bf16 v[92:95], v[188:191], a[92:95], v[92:95]
  v_mfma_f32_16x16x32_bf16 v[100:103], v[188:191], a[116:119], v[100:103]
  v_mfma_f32_16x16x32_bf16 v[108:111], v[188:191], a[140:143], v[108:111]
  v_mfma_f32_16x16x32_bf16 v[116:119], v[188:191], a[164:167], v[116:119]
  v_mfma_f32_16x16x32_bf16 v[124:127], v[188:191], a[188:191], v[124:127]
  v_mfma_f32_16x16x32_bf16 v[132:135], v[188:191], a[212:215], v[132:135]
  v_mfma_f32_16x16x32_bf16 v[140:143], v[188:191], a[236:239], v[140:143]
  s_waitcnt vmcnt(0)
  s_mov_b64 exec, 1
  v_mov_b32 v20, s45
  buffer_store_dword v20, v10, s[72:75], s44 offen sc1
  s_mov_b64 exec, -1
  v_cvt_pk_bf16_f32 v24, v64, v65
  v_cvt_pk_bf16_f32 v25, v66, v67
  v_cvt_pk_bf16_f32 v26, v68, v69
  v_cvt_pk_bf16_f32 v27, v70, v71
  s_add_u32 s21, s42, 0
  buffer_store_dwordx4 v[24:27], v4, s[24:27], s21 offen offset:0 sc1
  v_cvt_pk_bf16_f32 v28, v72, v73
  v_cvt_pk_bf16_f32 v29, v74, v75
  v_cvt_pk_bf16_f32 v30, v76, v77
  v_cvt_pk_bf16_f32 v31, v78, v79
  buffer_store_dwordx4 v[28:31], v4, s[24:27], s21 offen offset:1024 sc1
  v_cvt_pk_bf16_f32 v32, v80, v81
  v_cvt_pk_bf16_f32 v33, v82, v83
  v_cvt_pk_bf16_f32 v34, v84, v85
  v_cvt_pk_bf16_f32 v35, v86, v87
  buffer_store_dwordx4 v[32:35], v4, s[24:27], s21 offen offset:2048 sc1
  v_cvt_pk_bf16_f32 v36, v88, v89
  v_cvt_pk_bf16_f32 v37, v90, v91
  v_cvt_pk_bf16_f32 v38, v92, v93
  v_cvt_pk_bf16_f32 v39, v94, v95
  buffer_store_dwordx4 v[36:39], v4, s[24:27], s21 offen offset:3072 sc1
  v_cvt_pk_bf16_f32 v40, v96, v97
  v_cvt_pk_bf16_f32 v41, v98, v99
  v_cvt_pk_bf16_f32 v42, v100, v101
  v_cvt_pk_bf16_f32 v43, v102, v103
  s_add_u32 s21, s42, 4096
  buffer_store_dwordx4 v[40:43], v4, s[24:27], s21 offen offset:0 sc1
  v_cvt_pk_bf16_f32 v44, v104, v105
  v_cvt_pk_bf16_f32 v45, v106, v107
  v_cvt_pk_bf16_f32 v46, v108, v109
  v_cvt_pk_bf16_f32 v47, v110, v111
  buffer_store_dwordx4 v[44:47], v4, s[24:27], s21 offen offset:1024 sc1
  v_cvt_pk_bf16_f32 v48, v112, v113
  v_cvt_pk_bf16_f32 v49, v114, v115
  v_cvt_pk_bf16_f32 v50, v116, v117
  v_cvt_pk_bf16_f32 v51, v118, v119
  buffer_store_dwordx4 v[48:51], v4, s[24:27], s21 offen offset:2048 sc1
  v_cvt_pk_bf16_f32 v52, v120, v121
  v_cvt_pk_bf16_f32 v53, v122, v123
  v_cvt_pk_bf16_f32 v54, v124, v125
  v_cvt_pk_bf16_f32 v55, v126, v127
  buffer_store_dwordx4 v[52:55], v4, s[24:27], s21 offen offset:3072 sc1
  v_cvt_pk_bf16_f32 v56, v128, v129
  v_cvt_pk_bf16_f32 v57, v130, v131
  v_cvt_pk_bf16_f32 v58, v132, v133
  v_cvt_pk_bf16_f32 v59, v134, v135
  s_add_u32 s21, s42, 8192
  buffer_store_dwordx4 v[56:59], v4, s[24:27], s21 offen offset:0 sc1
  v_cvt_pk_bf16_f32 v60, v136, v137
  v_cvt_pk_bf16_f32 v61, v138, v139
  v_cvt_pk_bf16_f32 v62, v140, v141
  v_cvt_pk_bf16_f32 v63, v142, v143
  buffer_store_dwordx4 v[60:63], v4, s[24:27], s21 offen offset:1024 sc1
  s_add_u32 s45, s45, 1
  s_add_u32 s42, s42, 1310720
  s_cmp_eq_u32 s50, 0
  s_cbranch_scc1 vwt_241
  s_waitcnt vmcnt(0)
  s_mov_b64 exec, 1
  v_mov_b32 v20, s45
  buffer_store_dword v20, v10, s[72:75], s44 offen sc1
  s_mov_b64 exec, -1
  s_mov_b32 s50, 0
  v_mov_b32 v7, 0
  s_mov_b32 s101, 0
wf_242:
  buffer_load_dword v8, v7, s[72:75], s43 offen sc1
  s_add_u32 s101, s101, 1
  s_cmp_gt_u32 s101, 131072
  s_cbranch_scc1 main_end
  s_waitcnt vmcnt(0)
  v_readfirstlane_b32 s100, v8
  s_cmp_ge_u32 s100, 8
  s_cbranch_scc1 wf_243
  s_sleep 4
  s_branch wf_242
wf_243:
  s_add_u32 s21, s41, 0
  buffer_load_dwordx4 v[192:195], v4, s[16:19], s21 offen offset:0 sc1
  buffer_load_dwordx4 v[196:199], v4, s[16:19], s21 offen offset:1024 sc1
  buffer_load_dwordx4 v[200:203], v4, s[16:19], s21 offen offset:2048 sc1
  buffer_load_dwordx4 v[204:207], v4, s[16:19], s21 offen offset:3072 sc1
  s_add_u32 s21, s41, 4096
  buffer_load_dwordx4 v[208:211], v4, s[16:19], s21 offen offset:0 sc1
  buffer_load_dwordx4 v[212:215], v4, s[16:19], s21 offen offset:1024 sc1
  buffer_load_dwordx4 v[216:219], v4, s[16:19], s21 offen offset:2048 sc1
  buffer_load_dwordx4 v[220:223], v4, s[16:19], s21 offen offset:3072 sc1
  s_add_u32 s21, s41, 8192
  buffer_load_dwordx4 v[224:227], v4, s[16:19], s21 offen offset:0 sc1
  buffer_load_dwordx4 v[228:231], v4, s[16:19], s21 offen offset:1024 sc1
  buffer_load_dwordx4 v[232:235], v4, s[16:19], s21 offen offset:2048 sc1
  buffer_load_dwordx4 v[236:239], v4, s[16:19], s21 offen offset:3072 sc1
  s_add_u32 s41, s41, 393216
  s_waitcnt vmcnt(0)
vwt_241:
  s_add_u32 s46, s45, 1
  s_cmp_ge_u32 s46, 64
  s_cbranch_scc1 vwn_245
  s_cmp_lt_u32 s46, 8
  s_cselect_b32 s21, 1, 3
  s_and_b32 s21, s46, s21
  s_cmp_lg_u32 s21, 0
  s_cbranch_scc1 vwn_244
  s_add_u32 s43, s43, 1024
  v_readfirstlane_b32 s21, v9
  v_mov_b32 v9, 0
  s_cmp_lt_u32 s21, 8
  s_cselect_b32 s50, 1, 0
  s_cbranch_scc1 vwn_245
vwn_244:
  s_add_u32 s21, s41, 0
  buffer_load_dwordx4 v[144:147], v4, s[16:19], s21 offen offset:0 sc1
  buffer_load_dwordx4 v[148:151], v4, s[16:19], s21 offen offset:1024 sc1
  buffer_load_dwordx4 v[152:155], v4, s[16:19], s21 offen offset:2048 sc1
  buffer_load_dwordx4 v[156:159], v4, s[16:19], s21 offen offset:3072 sc1
  s_add_u32 s21, s41, 4096
  buffer_load_dwordx4 v[160:163], v4, s[16:19], s21 offen offset:0 sc1
  buffer_load_dwordx4 v[164:167], v4, s[16:19], s21 offen offset:1024 sc1
  buffer_load_dwordx4 v[168:171], v4, s[16:19], s21 offen offset:2048 sc1
  buffer_load_dwordx4 v[172:175], v4, s[16:19], s21 offen offset:3072 sc1
  s_add_u32 s21, s41, 8192
  buffer_load_dwordx4 v[176:179], v4, s[16:19], s21 offen offset:0 sc1
  buffer_load_dwordx4 v[180:183], v4, s[16:19], s21 offen offset:1024 sc1
  buffer_load_dwordx4 v[184:187], v4, s[16:19], s21 offen offset:2048 sc1
  buffer_load_dwordx4 v[188:191], v4, s[16:19], s21 offen offset:3072 sc1
  s_add_u32 s41, s41, 393216
vwn_245:
  v_mfma_f32_16x16x32_bf16 v[64:67], v[192:195], a[0:3], 0
  v_mfma_f32_16x16x32_bf16 v[72:75], v[192:195], a[24:27], 0
  v_mfma_f32_16x16x32_bf16 v[80:83], v[192:195], a[48:51], 0
  v_mfma_f32_16x16x32_bf16 v[88:91], v[192:195], a[72:75], 0
  v_mfma_f32_16x16x32_bf16 v[96:99], v[192:195], a[96:99], 0
  v_mfma_f32_16x16x32_bf16 v[104:107], v[192:195], a[120:123], 0
  v_mfma_f32_16x16x32_bf16 v[112:115], v[192:195], a[144:147], 0
  v_mfma_f32_16x16x32_bf16 v[120:123], v[192:195], a[168:171], 0
  v_mfma_f32_16x16x32_bf16 v[128:131], v[192:195], a[192:195], 0
  v_mfma_f32_16x16x32_bf16 v[136:139], v[192:195], a[216:219], 0
  v_mfma_f32_16x16x32_bf16 v[68:71], v[216:219], a[0:3], 0
  v_mfma_f32_16x16x32_bf16 v[76:79], v[216:219], a[24:27], 0
  v_mfma_f32_16x16x32_bf16 v[84:87], v[216:219], a[48:51], 0
  v_mfma_f32_16x16x32_bf16 v[92:95], v[216:219], a[72:75], 0
  v_mfma_f32_16x16x32_bf16 v[100:103], v[216:219], a[96:99], 0
  v_mfma_f32_16x16x32_bf16 v[108:111], v[216:219], a[120:123], 0
  v_mfma_f32_16x16x32_bf16 v[116:119], v[216:219], a[144:147], 0
  v_mfma_f32_16x16x32_bf16 v[124:127], v[216:219], a[168:171], 0
  v_mfma_f32_16x16x32_bf16 v[132:135], v[216:219], a[192:195], 0
  v_mfma_f32_16x16x32_bf16 v[140:143], v[216:219], a[216:219], 0
  v_mfma_f32_16x16x32_bf16 v[64:67], v[196:199], a[4:7], v[64:67]
  v_mfma_f32_16x16x32_bf16 v[72:75], v[196:199], a[28:31], v[72:75]
  v_mfma_f32_16x16x32_bf16 v[80:83], v[196:199], a[52:55], v[80:83]
  v_mfma_f32_16x16x32_bf16 v[88:91], v[196:199], a[76:79], v[88:91]
  v_mfma_f32_16x16x32_bf16 v[96:99], v[196:199], a[100:103], v[96:99]
  v_mfma_f32_16x16x32_bf16 v[104:107], v[196:199], a[124:127], v[104:107]
  v_mfma_f32_16x16x32_bf16 v[112:115], v[196:199], a[148:151], v[112:115]
  v_mfma_f32_16x16x32_bf16 v[120:123], v[196:199], a[172:175], v[120:123]
  v_mfma_f32_16x16x32_bf16 v[128:131], v[196:199], a[196:199], v[128:131]
  v_mfma_f32_16x16x32_bf16 v[136:139], v[196:199], a[220:223], v[136:139]
  v_mfma_f32_16x16x32_bf16 v[68:71], v[220:223], a[4:7], v[68:71]
  v_mfma_f32_16x16x32_bf16 v[76:79], v[220:223], a[28:31], v[76:79]
  v_mfma_f32_16x16x32_bf16 v[84:87], v[220:223], a[52:55], v[84:87]
  v_mfma_f32_16x16x32_bf16 v[92:95], v[220:223], a[76:79], v[92:95]
  v_mfma_f32_16x16x32_bf16 v[100:103], v[220:223], a[100:103], v[100:103]
  v_mfma_f32_16x16x32_bf16 v[108:111], v[220:223], a[124:127], v[108:111]
  v_mfma_f32_16x16x32_bf16 v[116:119], v[220:223], a[148:151], v[116:119]
  v_mfma_f32_16x16x32_bf16 v[124:127], v[220:223], a[172:175], v[124:127]
  v_mfma_f32_16x16x32_bf16 v[132:135], v[220:223], a[196:199], v[132:135]
  v_mfma_f32_16x16x32_bf16 v[140:143], v[220:223], a[220:223], v[140:143]
  v_mfma_f32_16x16x32_bf16 v[64:67], v[200:203], a[8:11], v[64:67]
  v_mfma_f32_16x16x32_bf16 v[72:75], v[200:203], a[32:35], v[72:75]
  v_mfma_f32_16x16x32_bf16 v[80:83], v[200:203], a[56:59], v[80:83]
  v_mfma_f32_16x16x32_bf16 v[88:91], v[200:203], a[80:83], v[88:91]
  v_mfma_f32_16x16x32_bf16 v[96:99], v[200:203], a[104:107], v[96:99]
  v_mfma_f32_16x16x32_bf16 v[104:107], v[200:203], a[128:131], v[104:107]
  v_mfma_f32_16x16x32_bf16 v[112:115], v[200:203], a[152:155], v[112:115]
  v_mfma_f32_16x16x32_bf16 v[120:123], v[200:203], a[176:179], v[120:123]
  v_mfma_f32_16x16x32_bf16 v[128:131], v[200:203], a[200:203], v[128:131]
  v_mfma_f32_16x16x32_bf16 v[136:139], v[200:203], a[224:227], v[136:139]
  v_mfma_f32_16x16x32_bf16 v[68:71], v[224:227], a[8:11], v[68:71]
  v_mfma_f32_16x16x32_bf16 v[76:79], v[224:227], a[32:35], v[76:79]
  v_mfma_f32_16x16x32_bf16 v[84:87], v[224:227], a[56:59], v[84:87]
  v_mfma_f32_16x16x32_bf16 v[92:95], v[224:227], a[80:83], v[92:95]
  v_mfma_f32_16x16x32_bf16 v[100:103], v[224:227], a[104:107], v[100:103]
  v_mfma_f32_16x16x32_bf16 v[108:111], v[224:227], a[128:131], v[108:111]
  v_mfma_f32_16x16x32_bf16 v[116:119], v[224:227], a[152:155], v[116:119]
  v_mfma_f32_16x16x32_bf16 v[124:127], v[224:227], a[176:179], v[124:127]
  v_mfma_f32_16x16x32_bf16 v[132:135], v[224:227], a[200:203], v[132:135]
  v_mfma_f32_16x16x32_bf16 v[140:143], v[224:227], a[224:227], v[140:143]
  s_add_u32 s21, s43, 1024
  buffer_load_dword v9, v10, s[72:75], s21 offen sc1
  v_mfma_f32_16x16x32_bf16 v[64:67], v[204:207], a[12:15], v[64:67]
  v_mfma_f32_16x16x32_bf16 v[72:75], v[204:207], a[36:39], v[72:75]
  v_mfma_f32_16x16x32_bf16 v[80:83], v[204:207], a[60:63], v[80:83]
  v_mfma_f32_16x16x32_bf16 v[88:91], v[204:207], a[84:87], v[88:91]
  v_mfma_f32_16x16x32_bf16 v[96:99], v[204:207], a[108:111], v[96:99]
  v_mfma_f32_16x16x32_bf16 v[104:107], v[204:207], a[132:135], v[104:107]
  v_mfma_f32_16x16x32_bf16 v[112:115], v[204:207], a[156:159], v[112:115]
  v_mfma_f32_16x16x32_bf16 v[120:123], v[204:207], a[180:183], v[120:123]
  v_mfma_f32_16x16x32_bf16 v[128:131], v[204:207], a[204:207], v[128:131]
  v_mfma_f32_16x16x32_bf16 v[136:139], v[204:207], a[228:231], v[136:139]
  v_mfma_f32_16x16x32_bf16 v[68:71], v[228:231], a[12:15], v[68:71]
  v_mfma_f32_16x16x32_bf16 v[76:79], v[228:231], a[36:39], v[76:79]
  v_mfma_f32_16x16x32_bf16 v[84:87], v[228:231], a[60:63], v[84:87]
  v_mfma_f32_16x16x32_bf16 v[92:95], v[228:231], a[84:87], v[92:95]
  v_mfma_f32_16x16x32_bf16 v[100:103], v[228:231], a[108:111], v[100:103]
  v_mfma_f32_16x16x32_bf16 v[108:111], v[228:231], a[132:135], v[108:111]
  v_mfma_f32_16x16x32_bf16 v[116:119], v[228:231], a[156:159], v[116:119]
  v_mfma_f32_16x16x32_bf16 v[124:127], v[228:231], a[180:183], v[124:127]
  v_mfma_f32_16x16x32_bf16 v[132:135], v[228:231], a[204:207], v[132:135]
  v_mfma_f32_16x16x32_bf16 v[140:143], v[228:231], a[228:231], v[140:143]
  v_mfma_f32_16x16x32_bf16 v[64:67], v[208:211], a[16:19], v[64:67]
  v_mfma_f32_16x16x32_bf16 v[72:75], v[208:211], a[40:43], v[72:75]
  v_mfma_f32_16x16x32_bf16 v[80:83], v[208:211], a[64:67], v[80:83]
  v_mfma_f32_16x16x32_bf16 v[88:91], v[208:211], a[88:91], v[88:91]
  v_mfma_f32_16x16x32_bf16 v[96:99], v[208:211], a[112:115], v[96:99]
  v_mfma_f32_16x16x32_bf16 v[104:107], v[208:211], a[136:139], v[104:107]
  v_mfma_f32_16x16x32_bf16 v[112:115], v[208:211], a[160:163], v[112:115]
  v_mfma_f32_16x16x32_bf16 v[120:123], v[208:211], a[184:187], v[120:123]
  v_mfma_f32_16x16x32_bf16 v[128:131], v[208:211], a[208:211], v[128:131]
  v_mfma_f32_16x16x32_bf16 v[136:139], v[208:211], a[232:235], v[136:139]
  v_mfma_f32_16x16x32_bf16 v[68:71], v[232:235], a[16:19], v[68:71]
  v_mfma_f32_16x16x32_bf16 v[76:79], v[232:235], a[40:43], v[76:79]
  v_mfma_f32_16x16x32_bf16 v[84:87], v[232:235], a[64:67], v[84:87]
  v_mfma_f32_16x16x32_bf16 v[92:95], v[232:235], a[88:91], v[92:95]
  v_mfma_f32_16x16x32_bf16 v[100:103], v[232:235], a[112:115], v[100:103]
  v_mfma_f32_16x16x32_bf16 v[108:111], v[232:235], a[136:139], v[108:111]
  v_mfma_f32_16x16x32_bf16 v[116:119], v[232:235], a[160:163], v[116:119]
  v_mfma_f32_16x16x32_bf16 v[124:127], v[232:235], a[184:187], v[124:127]
  v_mfma_f32_16x16x32_bf16 v[132:135], v[232:235], a[208:211], v[132:135]
  v_mfma_f32_16x16x32_bf16 v[140:143], v[232:235], a[232:235], v[140:143]
  v_mfma_f32_16x16x32_bf16 v[64:67], v[212:215], a[20:23], v[64:67]
  v_mfma_f32_16x16x32_bf16 v[72:75], v[212:215], a[44:47], v[72:75]
  v_mfma_f32_16x16x32_bf16 v[80:83], v[212:215], a[68:71], v[80:83]
  v_mfma_f32_16x16x32_bf16 v[88:91], v[212:215], a[92:95], v[88:91]
  v_mfma_f32_16x16x32_bf16 v[96:99], v[212:215], a[116:119], v[96:99]
  v_mfma_f32_16x16x32_bf16 v[104:107], v[212:215], a[140:143], v[104:107]
  v_mfma_f32_16x16x32_bf16 v[112:115], v[212:215], a[164:167], v[112:115]
  v_mfma_f32_16x16x32_bf16 v[120:123], v[212:215], a[188:191], v[120:123]
  v_mfma_f32_16x16x32_bf16 v[128:131], v[212:215], a[212:215], v[128:131]
  v_mfma_f32_16x16x32_bf16 v[136:139], v[212:215], a[236:239], v[136:139]
  v_mfma_f32_16x16x32_bf16 v[68:71], v[236:239], a[20:23], v[68:71]
  v_mfma_f32_16x16x32_bf16 v[76:79], v[236:239], a[44:47], v[76:79]
  v_mfma_f32_16x16x32_bf16 v[84:87], v[236:239], a[68:71], v[84:87]
  v_mfma_f32_16x16x32_bf16 v[92:95], v[236:239], a[92:95], v[92:95]
  v_mfma_f32_16x16x32_bf16 v[100:103], v[236:239], a[116:119], v[100:103]
  v_mfma_f32_16x16x32_bf16 v[108:111], v[236:239], a[140:143], v[108:111]
  v_mfma_f32_16x16x32_bf16 v[116:119], v[236:239], a[164:167], v[116:119]
  v_mfma_f32_16x16x32_bf16 v[124:127], v[236:239], a[188:191], v[124:127]
  v_mfma_f32_16x16x32_bf16 v[132:135], v[236:239], a[212:215], v[132:135]
  v_mfma_f32_16x16x32_bf16 v[140:143], v[236:239], a[236:239], v[140:143]
  s_waitcnt vmcnt(0)
  s_mov_b64 exec, 1
  v_mov_b32 v20, s45
  buffer_store_dword v20, v10, s[72:75], s44 offen sc1
  s_mov_b64 exec, -1
  v_cvt_pk_bf16_f32 v24, v64, v65
  v_cvt_pk_bf16_f32 v25, v66, v67
  v_cvt_pk_bf16_f32 v26, v68, v69
  v_cvt_pk_bf16_f32 v27, v70, v71
  s_add_u32 s21, s42, 0
  buffer_store_dwordx4 v[24:27], v4, s[24:27], s21 offen offset:0 sc1
  v_cvt_pk_bf16_f32 v28, v72, v73
  v_cvt_pk_bf16_f32 v29, v74, v75
  v_cvt_pk_bf16_f32 v30, v76, v77
  v_cvt_pk_bf16_f32 v31, v78, v79
  buffer_store_dwordx4 v[28:31], v4, s[24:27], s21 offen offset:1024 sc1
  v_cvt_pk_bf16_f32 v32, v80, v81
  v_cvt_pk_bf16_f32 v33, v82, v83
  v_cvt_pk_bf16_f32 v34, v84, v85
  v_cvt_pk_bf16_f32 v35, v86, v87
  buffer_store_dwordx4 v[32:35], v4, s[24:27], s21 offen offset:2048 sc1
  v_cvt_pk_bf16_f32 v36, v88, v89
  v_cvt_pk_bf16_f32 v37, v90, v91
  v_cvt_pk_bf16_f32 v38, v92, v93
  v_cvt_pk_bf16_f32 v39, v94, v95
  buffer_store_dwordx4 v[36:39], v4, s[24:27], s21 offen offset:3072 sc1
  v_cvt_pk_bf16_f32 v40, v96, v97
  v_cvt_pk_bf16_f32 v41, v98, v99
  v_cvt_pk_bf16_f32 v42, v100, v101
  v_cvt_pk_bf16_f32 v43, v102, v103
  s_add_u32 s21, s42, 4096
  buffer_store_dwordx4 v[40:43], v4, s[24:27], s21 offen offset:0 sc1
  v_cvt_pk_bf16_f32 v44, v104, v105
  v_cvt_pk_bf16_f32 v45, v106, v107
  v_cvt_pk_bf16_f32 v46, v108, v109
  v_cvt_pk_bf16_f32 v47, v110, v111
  buffer_store_dwordx4 v[44:47], v4, s[24:27], s21 offen offset:1024 sc1
  v_cvt_pk_bf16_f32 v48, v112, v113
  v_cvt_pk_bf16_f32 v49, v114, v115
  v_cvt_pk_bf16_f32 v50, v116, v117
  v_cvt_pk_bf16_f32 v51, v118, v119
  buffer_store_dwordx4 v[48:51], v4, s[24:27], s21 offen offset:2048 sc1
  v_cvt_pk_bf16_f32 v52, v120, v121
  v_cvt_pk_bf16_f32 v53, v122, v123
  v_cvt_pk_bf16_f32 v54, v124, v125
  v_cvt_pk_bf16_f32 v55, v126, v127
  buffer_store_dwordx4 v[52:55], v4, s[24:27], s21 offen offset:3072 sc1
  v_cvt_pk_bf16_f32 v56, v128, v129
  v_cvt_pk_bf16_f32 v57, v130, v131
  v_cvt_pk_bf16_f32 v58, v132, v133
  v_cvt_pk_bf16_f32 v59, v134, v135
  s_add_u32 s21, s42, 8192
  buffer_store_dwordx4 v[56:59], v4, s[24:27], s21 offen offset:0 sc1
  v_cvt_pk_bf16_f32 v60, v136, v137
  v_cvt_pk_bf16_f32 v61, v138, v139
  v_cvt_pk_bf16_f32 v62, v140, v141
  v_cvt_pk_bf16_f32 v63, v142, v143
  buffer_store_dwordx4 v[60:63], v4, s[24:27], s21 offen offset:1024 sc1
  s_add_u32 s45, s45, 1
  s_add_u32 s42, s42, 1310720
  s_cmp_eq_u32 s50, 0
  s_cbranch_scc1 vwt_246
  s_waitcnt vmcnt(0)
  s_mov_b64 exec, 1
  v_mov_b32 v20, s45
  buffer_store_dword v20, v10, s[72:75], s44 offen sc1
  s_mov_b64 exec, -1
  s_mov_b32 s50, 0
  v_mov_b32 v7, 0
  s_mov_b32 s101, 0
wf_247:
  buffer_load_dword v8, v7, s[72:75], s43 offen sc1
  s_add_u32 s101, s101, 1
  s_cmp_gt_u32 s101, 131072
  s_cbranch_scc1 main_end
  s_waitcnt vmcnt(0)
  v_readfirstlane_b32 s100, v8
  s_cmp_ge_u32 s100, 8
  s_cbranch_scc1 wf_248
  s_sleep 4
  s_branch wf_247
wf_248:
  s_add_u32 s21, s41, 0
  buffer_load_dwordx4 v[144:147], v4, s[16:19], s21 offen offset:0 sc1
  buffer_load_dwordx4 v[148:151], v4, s[16:19], s21 offen offset:1024 sc1
  buffer_load_dwordx4 v[152:155], v4, s[16:19], s21 offen offset:2048 sc1
  buffer_load_dwordx4 v[156:159], v4, s[16:19], s21 offen offset:3072 sc1
  s_add_u32 s21, s41, 4096
  buffer_load_dwordx4 v[160:163], v4, s[16:19], s21 offen offset:0 sc1
  buffer_load_dwordx4 v[164:167], v4, s[16:19], s21 offen offset:1024 sc1
  buffer_load_dwordx4 v[168:171], v4, s[16:19], s21 offen offset:2048 sc1
  buffer_load_dwordx4 v[172:175], v4, s[16:19], s21 offen offset:3072 sc1
  s_add_u32 s21, s41, 8192
  buffer_load_dwordx4 v[176:179], v4, s[16:19], s21 offen offset:0 sc1
  buffer_load_dwordx4 v[180:183], v4, s[16:19], s21 offen offset:1024 sc1
  buffer_load_dwordx4 v[184:187], v4, s[16:19], s21 offen offset:2048 sc1
  buffer_load_dwordx4 v[188:191], v4, s[16:19], s21 offen offset:3072 sc1
  s_add_u32 s41, s41, 393216
  s_waitcnt vmcnt(0)
vwt_246:
  s_cmp_lt_u32 s45, 64
  s_cbranch_scc1 vwl_237
  s_waitcnt vmcnt(0)
  s_mov_b64 exec, 1
  v_mov_b32 v20, s45
  buffer_store_dword v20, v10, s[72:75], s44 offen sc1
  s_mov_b64 exec, -1
  s_mov_b32 s84, 0
  s_mov_b32 s85, -1
  s_mov_b32 s86, 0
  s_branch queue
not_vw:
  s_sub_u32 s2, s3, 96
  s_cmp_lg_u32 s2, 31
  s_cbranch_scc1 not_cal
  s_load_dwordx2 s[72:73], s[0:1], 104
  s_waitcnt lgkmcnt(0)
  s_add_u32 s72, s72, 81068032
  s_addc_u32 s73, s73, 0
  s_mov_b32 s74, 115712
  s_mov_b32 s75, 0x00020000
  v_lshlrev_b32 v8, 4, v0
  v_mov_b32 v4, 0
  v_mov_b32 v5, 0
  v_mov_b32 v6, 0
  v_mov_b32 v7, 0
  s_mov_b32 s21, 0
  buffer_store_dwordx4 v[4:7], v8, s[72:75], s21 offen sc1
  s_mov_b32 s21, 4096
  buffer_store_dwordx4 v[4:7], v8, s[72:75], s21 offen sc1
  s_mov_b32 s21, 8192
  buffer_store_dwordx4 v[4:7], v8, s[72:75], s21 offen sc1
  s_mov_b32 s21, 12288
  buffer_store_dwordx4 v[4:7], v8, s[72:75], s21 offen sc1
  s_mov_b32 s21, 16384
  buffer_store_dwordx4 v[4:7], v8, s[72:75], s21 offen sc1
  s_mov_b32 s21, 20480
  buffer_store_dwordx4 v[4:7], v8, s[72:75], s21 offen sc1
  s_mov_b32 s21, 24576
  buffer_store_dwordx4 v[4:7], v8, s[72:75], s21 offen sc1
  s_mov_b32 s21, 28672
  buffer_store_dwordx4 v[4:7], v8, s[72:75], s21 offen sc1
  s_mov_b32 s21, 32768
  buffer_store_dwordx4 v[4:7], v8, s[72:75], s21 offen sc1
  s_mov_b32 s21, 36864
  buffer_store_dwordx4 v[4:7], v8, s[72:75], s21 offen sc1
  s_mov_b32 s21, 40960
  buffer_store_dwordx4 v[4:7], v8, s[72:75], s21 offen sc1
  s_mov_b32 s21, 45056
  buffer_store_dwordx4 v[4:7], v8, s[72:75], s21 offen sc1
  s_mov_b32 s21, 49152
  buffer_store_dwordx4 v[4:7], v8, s[72:75], s21 offen sc1
  s_mov_b32 s21, 53248
  buffer_store_dwordx4 v[4:7], v8, s[72:75], s21 offen sc1
  s_mov_b32 s21, 57344
  buffer_store_dwordx4 v[4:7], v8, s[72:75], s21 offen sc1
  s_mov_b32 s21, 61440
  buffer_store_dwordx4 v[4:7], v8, s[72:75], s21 offen sc1
  s_mov_b32 s21, 65536
  buffer_store_dwordx4 v[4:7], v8, s[72:75], s21 offen sc1
  s_mov_b32 s21, 69632
  buffer_store_dwordx4 v[4:7], v8, s[72:75], s21 offen sc1
  s_mov_b32 s21, 73728
  buffer_store_dwordx4 v[4:7], v8, s[72:75], s21 offen sc1
  s_mov_b32 s21, 77824
  buffer_store_dwordx4 v[4:7], v8, s[72:75], s21 offen sc1
  s_mov_b32 s21, 81920
  buffer_store_dwordx4 v[4:7], v8, s[72:75], s21 offen sc1
  s_mov_b32 s21, 86016
  buffer_store_dwordx4 v[4:7], v8, s[72:75], s21 offen sc1
  s_mov_b32 s21, 90112
  buffer_store_dwordx4 v[4:7], v8, s[72:75], s21 offen sc1
  s_mov_b32 s21, 94208
  buffer_store_dwordx4 v[4:7], v8, s[72:75], s21 offen sc1
  s_mov_b32 s21, 98304
  buffer_store_dwordx4 v[4:7], v8, s[72:75], s21 offen sc1
  s_mov_b32 s21, 102400
  buffer_store_dwordx4 v[4:7], v8, s[72:75], s21 offen sc1
  s_mov_b32 s21, 106496
  buffer_store_dwordx4 v[4:7], v8, s[72:75], s21 offen sc1
  s_mov_b32 s21, 110592
  buffer_store_dwordx4 v[4:7], v8, s[72:75], s21 offen sc1
  s_mov_b32 s21, 114688
  buffer_store_dwordx4 v[4:7], v8, s[72:75], s21 offen sc1
  s_waitcnt vmcnt(0)
  s_barrier
  s_cmp_lg_u32 s20, 0
  s_cbranch_scc1 cal_249
  s_mov_b64 exec, 1
  v_mov_b32 v4, 76
  v_mov_b32 v5, 1
  buffer_store_dword v5, v4, s[32:35], 0 offen sc1
  s_add_u32 s8, s38, 83886079
  s_addc_u32 s9, s39, 0
  s_and_b32 s8, s8, 0xffe00000
  s_mov_b32 s10, 2097152
  s_mov_b32 s11, 0x00020000
  v_mov_b32 v4, 0
  s_mov_b32 s40, -1
  s_mov_b32 s41, -1
  s_mov_b32 s42, 1048576
  s_mov_b32 s43, 0
  s_waitcnt vmcnt(0)
cal_250:
  s_add_u32 s21, s42, 0
  s_memtime s[98:99]
  s_waitcnt lgkmcnt(0)
  buffer_load_dword v5, v4, s[8:11], s21 offen sc1
  s_waitcnt vmcnt(0)
  s_memtime s[100:101]
  s_waitcnt lgkmcnt(0)
  s_sub_u32 s21, s100, s98
  s_min_u32 s40, s40, s21
  s_add_u32 s21, s42, 8192
  s_memtime s[98:99]
  s_waitcnt lgkmcnt(0)
  buffer_load_dword v5, v4, s[8:11], s21 offen sc1
  s_waitcnt vmcnt(0)
  s_memtime s[100:101]
  s_waitcnt lgkmcnt(0)
  s_sub_u32 s21, s100, s98
  s_min_u32 s41, s41, s21
  s_add_u32 s42, s42, 16640
  s_add_u32 s43, s43, 1
  s_cmp_lt_u32 s43, 8
  s_cbranch_scc1 cal_250
  s_cmp_lt_u32 s41, s40
  s_cselect_b32 s21, 1, 2
  v_mov_b32 v4, s21
  v_mov_b32 v5, s40
  v_mov_b32 v6, s41
  v_mov_b32 v8, 84
  buffer_store_dwordx3 v[4:6], v8, s[32:35], 0 offen sc1
  s_waitcnt vmcnt(0)
  s_mov_b64 exec, -1
cal_249:
not_cal:
  s_sleep 127
  s_sleep 127
  s_load_dwordx2 s[32:33], s[0:1], 96
  s_waitcnt lgkmcnt(0)
  s_mov_b32 s32, s32
  s_mov_b32 s33, s33
  s_mov_b32 s34, 256
  s_mov_b32 s35, 0x00020000
  s_mov_b32 s21, 76
  s_cmp_lg_u32 s20, 0
  s_cbranch_scc1 wf_252
  v_mov_b32 v4, 0
  s_mov_b32 s101, 0
wf_251:
  buffer_load_dword v5, v4, s[32:35], s21 offen sc1
  s_add_u32 s101, s101, 1
  s_cmp_gt_u32 s101, 131072
  s_cbranch_scc1 main_end
  s_waitcnt vmcnt(0)
  v_readfirstlane_b32 s100, v5
  s_cmp_ge_u32 s100, 1
  s_cbranch_scc1 wf_252
  s_sleep 8
  s_branch wf_251
wf_252:
  s_barrier
  s_load_dwordx2 s[72:73], s[0:1], 104
  s_waitcnt lgkmcnt(0)
  s_add_u32 s72, s72, 81068032
  s_addc_u32 s73, s73, 0
  s_mov_b32 s74, 115712
  s_mov_b32 s75, 0x00020000
  s_cmp_ge_u32 s2, 30
  s_cbranch_scc1 skip_qb
  s_mul_hi_u32 s42, s2, 0x1999999a
  s_mul_i32 s21, s42, 10
  s_sub_u32 s41, s2, s21
  s_sub_u32 s26, 17, s42
  s_mul_hi_u32 s26, s26, 0x55555556
  s_mov_b32 s63, 3
  s_mov_b32 s64, 0
qkvb_entry:
  s_load_dwordx2 s[4:5], s[0:1], 0
  s_load_dwordx2 s[6:7], s[0:1], 64
  s_load_dwordx2 s[38:39], s[0:1], 104
  s_waitcnt lgkmcnt(0)
  s_mov_b32 s8, s4
  s_mov_b32 s9, s5
  s_mov_b32 s10, 2621440
  s_mov_b32 s11, 0x00020000
  s_mov_b32 s12, s6
  s_mov_b32 s13, s7
  s_mov_b32 s14, 2457600
  s_mov_b32 s15, 0x00020000
  s_add_u32 s16, s38, 62914560
  s_addc_u32 s17, s39, 0
  s_mov_b32 s18, 7864320
  s_mov_b32 s19, 0x00020000
  s_mul_i32 s44, s41, 384
  v_mov_b32 v9, 2731
  v_add_u32 v8, 0, v1
  v_mul_u32_u24 v7, v8, v9
  v_lshrrev_b32 v7, 16, v7
  v_mul_u32_u24 v4, 24, v7
  v_sub_u32 v8, v8, v4
  s_mov_b32 s21, 3840
  v_mul_lo_u32 v7, v7, s21
  v_lshl_add_u32 v4, v8, 4, v7
  v_add_u32 v8, 64, v1
  v_mul_u32_u24 v7, v8, v9
  v_lshrrev_b32 v7, 16, v7
  v_mul_u32_u24 v5, 24, v7
  v_sub_u32 v8, v8, v5
  s_mov_b32 s21, 3840
  v_mul_lo_u32 v7, v7, s21
  v_lshl_add_u32 v5, v8, 4, v7
  v_add_u32 v8, 128, v1
  v_mul_u32_u24 v7, v8, v9
  v_lshrrev_b32 v7, 16, v7
  v_mul_u32_u24 v6, 24, v7
  v_sub_u32 v8, v8, v6
  s_mov_b32 s21, 3840
  v_mul_lo_u32 v7, v7, s21
  v_lshl_add_u32 v6, v8, 4, v7
  v_lshrrev_b32 v7, 2, v2
  v_lshl_add_u32 v7, v3, 3, v7
  v_mul_u32_u24 v7, 384, v7
  v_and_b32 v8, 3, v2
  v_lshlrev_b32 v8, 3, v8
  s_mul_i32 s21, s20, 96
  v_add3_u32 v7, v7, v8, s21
  v_add_u32 v8, 61440, v7
  s_mul_i32 s21, s20, 153600
  s_add_u32 s21, s21, 0
  s_add_u32 s21, s21, s44
  s_mul_i32 s22, s20, 15360
  s_add_u32 s22, s22, 0
  s_add_u32 m0, s22, 0
  s_nop 0
  buffer_load_dwordx4 v4, s[12:15], s21 offen lds
  s_add_u32 m0, s22, 1024
  s_nop 0
  buffer_load_dwordx4 v5, s[12:15], s21 offen lds
  s_add_u32 m0, s22, 2048
  s_nop 0
  buffer_load_dwordx4 v6, s[12:15], s21 offen lds
  s_mul_i32 s21, s20, 153600
  s_add_u32 s21, s21, 30720
  s_add_u32 s21, s21, s44
  s_mul_i32 s22, s20, 15360
  s_add_u32 s22, s22, 3072
  s_add_u32 m0, s22, 0
  s_nop 0
  buffer_load_dwordx4 v4, s[12:15], s21 offen lds
  s_add_u32 m0, s22, 1024
  s_nop 0
  buffer_load_dwordx4 v5, s[12:15], s21 offen lds
  s_add_u32 m0, s22, 2048
  s_nop 0
  buffer_load_dwordx4 v6, s[12:15], s21 offen lds
  s_mul_i32 s21, s20, 153600
  s_add_u32 s21, s21, 61440
  s_add_u32 s21, s21, s44
  s_mul_i32 s22, s20, 15360
  s_add_u32 s22, s22, 6144
  s_add_u32 m0, s22, 0
  s_nop 0
  buffer_load_dwordx4 v4, s[12:15], s21 offen lds
  s_add_u32 m0, s22, 1024
  s_nop 0
  buffer_load_dwordx4 v5, s[12:15], s21 offen lds
  s_add_u32 m0, s22, 2048
  s_nop 0
  buffer_load_dwordx4 v6, s[12:15], s21 offen lds
  s_mul_i32 s21, s20, 153600
  s_add_u32 s21, s21, 92160
  s_add_u32 s21, s21, s44
  s_mul_i32 s22, s20, 15360
  s_add_u32 s22, s22, 9216
  s_add_u32 m0, s22, 0
  s_nop 0
  buffer_load_dwordx4 v4, s[12:15], s21 offen lds
  s_add_u32 m0, s22, 1024
  s_nop 0
  buffer_load_dwordx4 v5, s[12:15], s21 offen lds
  s_add_u32 m0, s22, 2048
  s_nop 0
  buffer_load_dwordx4 v6, s[12:15], s21 offen lds
  s_mul_i32 s21, s20, 153600
  s_add_u32 s21, s21, 122880
  s_add_u32 s21, s21, s44
  s_mul_i32 s22, s20, 15360
  s_add_u32 s22, s22, 12288
  s_add_u32 m0, s22, 0
  s_nop 0
  buffer_load_dwordx4 v4, s[12:15], s21 offen lds
  s_add_u32 m0, s22, 1024
  s_nop 0
  buffer_load_dwordx4 v5, s[12:15], s21 offen lds
  s_add_u32 m0, s22, 2048
  s_nop 0
  buffer_load_dwordx4 v6, s[12:15], s21 offen lds
  s_mul_i32 s21, s20, 153600
  s_add_u32 s21, s21, 614400
  s_add_u32 s21, s21, s44
  s_mul_i32 s22, s20, 15360
  s_add_u32 s22, s22, 61440
  s_add_u32 m0, s22, 0
  s_nop 0
  buffer_load_dwordx4 v4, s[12:15], s21 offen lds
  s_add_u32 m0, s22, 1024
  s_nop 0
  buffer_load_dwordx4 v5, s[12:15], s21 offen lds
  s_add_u32 m0, s22, 2048
  s_nop 0
  buffer_load_dwordx4 v6, s[12:15], s21 offen lds
  s_mul_i32 s21, s20, 153600
  s_add_u32 s21, s21, 645120
  s_add_u32 s21, s21, s44
  s_mul_i32 s22, s20, 15360
  s_add_u32 s22, s22, 64512
  s_add_u32 m0, s22, 0
  s_nop 0
  buffer_load_dwordx4 v4, s[12:15], s21 offen lds
  s_add_u32 m0, s22, 1024
  s_nop 0
  buffer_load_dwordx4 v5, s[12:15], s21 offen lds
  s_add_u32 m0, s22, 2048
  s_nop 0
  buffer_load_dwordx4 v6, s[12:15], s21 offen lds
  s_mul_i32 s21, s20, 153600
  s_add_u32 s21, s21, 675840
  s_add_u32 s21, s21, s44
  s_mul_i32 s22, s20, 15360
  s_add_u32 s22, s22, 67584
  s_add_u32 m0, s22, 0
  s_nop 0
  buffer_load_dwordx4 v4, s[12:15], s21 offen lds
  s_add_u32 m0, s22, 1024
  s_nop 0
  buffer_load_dwordx4 v5, s[12:15], s21 offen lds
  s_add_u32 m0, s22, 2048
  s_nop 0
  buffer_load_dwordx4 v6, s[12:15], s21 offen lds
  s_mul_i32 s21, s20, 153600
  s_add_u32 s21, s21, 706560
  s_add_u32 s21, s21, s44
  s_mul_i32 s22, s20, 15360
  s_add_u32 s22, s22, 70656
  s_add_u32 m0, s22, 0
  s_nop 0
  buffer_load_dwordx4 v4, s[12:15], s21 offen lds
  s_add_u32 m0, s22, 1024
  s_nop 0
  buffer_load_dwordx4 v5, s[12:15], s21 offen lds
  s_add_u32 m0, s22, 2048
  s_nop 0
  buffer_load_dwordx4 v6, s[12:15], s21 offen lds
  s_mul_i32 s21, s20, 153600
  s_add_u32 s21, s21, 737280
  s_add_u32 s21, s21, s44
  s_mul_i32 s22, s20, 15360
  s_add_u32 s22, s22, 73728
  s_add_u32 m0, s22, 0
  s_nop 0
  buffer_load_dwordx4 v4, s[12:15], s21 offen lds
  s_add_u32 m0, s22, 1024
  s_nop 0
  buffer_load_dwordx4 v5, s[12:15], s21 offen lds
  s_add_u32 m0, s22, 2048
  s_nop 0
  buffer_load_dwordx4 v6, s[12:15], s21 offen lds
  s_mul_i32 s21, s20, 153600
  s_add_u32 s21, s21, 1228800
  s_add_u32 s21, s21, s44
  buffer_load_dwordx4 v[64:67], v4, s[12:15], s21 offen
  buffer_load_dwordx4 v[68:71], v5, s[12:15], s21 offen
  buffer_load_dwordx4 v[72:75], v6, s[12:15], s21 offen
  s_mul_i32 s21, s20, 153600
  s_add_u32 s21, s21, 1259520
  s_add_u32 s21, s21, s44
  buffer_load_dwordx4 v[76:79], v4, s[12:15], s21 offen
  buffer_load_dwordx4 v[80:83], v5, s[12:15], s21 offen
  buffer_load_dwordx4 v[84:87], v6, s[12:15], s21 offen
  s_mul_i32 s21, s20, 153600
  s_add_u32 s21, s21, 1290240
  s_add_u32 s21, s21, s44
  buffer_load_dwordx4 v[88:91], v4, s[12:15], s21 offen
  buffer_load_dwordx4 v[92:95], v5, s[12:15], s21 offen
  buffer_load_dwordx4 v[96:99], v6, s[12:15], s21 offen
  s_mul_i32 s21, s20, 153600
  s_add_u32 s21, s21, 1320960
  s_add_u32 s21, s21, s44
  buffer_load_dwordx4 v[100:103], v4, s[12:15], s21 offen
  buffer_load_dwordx4 v[104:107], v5, s[12:15], s21 offen
  buffer_load_dwordx4 v[108:111], v6, s[12:15], s21 offen
  s_mul_i32 s21, s20, 153600
  s_add_u32 s21, s21, 1351680
  s_add_u32 s21, s21, s44
  buffer_load_dwordx4 v[112:115], v4, s[12:15], s21 offen
  buffer_load_dwordx4 v[116:119], v5, s[12:15], s21 offen
  buffer_load_dwordx4 v[120:123], v6, s[12:15], s21 offen
  s_mul_i32 s21, s20, 153600
  s_add_u32 s21, s21, 1843200
  s_add_u32 s21, s21, s44
  buffer_load_dwordx4 v[124:127], v4, s[12:15], s21 offen
  buffer_load_dwordx4 v[128:131], v5, s[12:15], s21 offen
  buffer_load_dwordx4 v[132:135], v6, s[12:15], s21 offen
  s_mul_i32 s21, s20, 153600
  s_add_u32 s21, s21, 1873920
  s_add_u32 s21, s21, s44
  buffer_load_dwordx4 v[136:139], v4, s[12:15], s21 offen
  buffer_load_dwordx4 v[140:143], v5, s[12:15], s21 offen
  buffer_load_dwordx4 v[144:147], v6, s[12:15], s21 offen
  s_mul_i32 s21, s20, 153600
  s_add_u32 s21, s21, 1904640
  s_add_u32 s21, s21, s44
  buffer_load_dwordx4 v[148:151], v4, s[12:15], s21 offen
  buffer_load_dwordx4 v[152:155], v5, s[12:15], s21 offen
  buffer_load_dwordx4 v[156:159], v6, s[12:15], s21 offen
  s_mul_i32 s21, s20, 153600
  s_add_u32 s21, s21, 1935360
  s_add_u32 s21, s21, s44
  buffer_load_dwordx4 v[160:163], v4, s[12:15], s21 offen
  buffer_load_dwordx4 v[164:167], v5, s[12:15], s21 offen
  buffer_load_dwordx4 v[168:171], v6, s[12:15], s21 offen
  s_mul_i32 s21, s20, 153600
  s_add_u32 s21, s21, 1966080
  s_add_u32 s21, s21, s44
  buffer_load_dwordx4 v[172:175], v4, s[12:15], s21 offen
  buffer_load_dwordx4 v[176:179], v5, s[12:15], s21 offen
  buffer_load_dwordx4 v[180:183], v6, s[12:15], s21 offen
  s_mul_i32 s22, s20, 15360
  v_lshl_add_u32 v30, v1, 4, s22
  v_add_u32 v31, 61440, v30
  s_waitcnt vmcnt(45)
  s_barrier
  ds_read_b64_tr_b16 a[0:1], v7 offset:0
  ds_read_b64_tr_b16 a[2:3], v7 offset:1536
  ds_read_b64_tr_b16 a[4:5], v7 offset:32
  ds_read_b64_tr_b16 a[6:7], v7 offset:1568
  ds_read_b64_tr_b16 a[8:9], v7 offset:64
  ds_read_b64_tr_b16 a[10:11], v7 offset:1600
  ds_read_b64_tr_b16 a[12:13], v7 offset:12288
  ds_read_b64_tr_b16 a[14:15], v7 offset:13824
  ds_read_b64_tr_b16 a[16:17], v7 offset:12320
  ds_read_b64_tr_b16 a[18:19], v7 offset:13856
  ds_read_b64_tr_b16 a[20:21], v7 offset:12352
  ds_read_b64_tr_b16 a[22:23], v7 offset:13888
  ds_read_b64_tr_b16 a[24:25], v7 offset:24576
  ds_read_b64_tr_b16 a[26:27], v7 offset:26112
  ds_read_b64_tr_b16 a[28:29], v7 offset:24608
  ds_read_b64_tr_b16 a[30:31], v7 offset:26144
  ds_read_b64_tr_b16 a[32:33], v7 offset:24640
  ds_read_b64_tr_b16 a[34:35], v7 offset:26176
  ds_read_b64_tr_b16 a[36:37], v7 offset:36864
  ds_read_b64_tr_b16 a[38:39], v7 offset:38400
  ds_read_b64_tr_b16 a[40:41], v7 offset:36896
  ds_read_b64_tr_b16 a[42:43], v7 offset:38432
  ds_read_b64_tr_b16 a[44:45], v7 offset:36928
  ds_read_b64_tr_b16 a[46:47], v7 offset:38464
  ds_read_b64_tr_b16 a[48:49], v7 offset:49152
  ds_read_b64_tr_b16 a[50:51], v7 offset:50688
  ds_read_b64_tr_b16 a[52:53], v7 offset:49184
  ds_read_b64_tr_b16 a[54:55], v7 offset:50720
  ds_read_b64_tr_b16 a[56:57], v7 offset:49216
  ds_read_b64_tr_b16 a[58:59], v7 offset:50752
  s_waitcnt lgkmcnt(0)
  s_barrier
  s_waitcnt vmcnt(30)
  s_barrier
  ds_read_b64_tr_b16 a[60:61], v8 offset:0
  ds_read_b64_tr_b16 a[62:63], v8 offset:1536
  ds_read_b64_tr_b16 a[64:65], v8 offset:32
  ds_read_b64_tr_b16 a[66:67], v8 offset:1568
  ds_read_b64_tr_b16 a[68:69], v8 offset:64
  ds_read_b64_tr_b16 a[70:71], v8 offset:1600
  ds_read_b64_tr_b16 a[72:73], v8 offset:12288
  ds_read_b64_tr_b16 a[74:75], v8 offset:13824
  ds_read_b64_tr_b16 a[76:77], v8 offset:12320
  ds_read_b64_tr_b16 a[78:79], v8 offset:13856
  ds_read_b64_tr_b16 a[80:81], v8 offset:12352
  ds_read_b64_tr_b16 a[82:83], v8 offset:13888
  ds_read_b64_tr_b16 a[84:85], v8 offset:24576
  ds_read_b64_tr_b16 a[86:87], v8 offset:26112
  ds_read_b64_tr_b16 a[88:89], v8 offset:24608
  ds_read_b64_tr_b16 a[90:91], v8 offset:26144
  ds_read_b64_tr_b16 a[92:93], v8 offset:24640
  ds_read_b64_tr_b16 a[94:95], v8 offset:26176
  ds_read_b64_tr_b16 a[96:97], v8 offset:36864
  ds_read_b64_tr_b16 a[98:99], v8 offset:38400
  ds_read_b64_tr_b16 a[100:101], v8 offset:36896
  ds_read_b64_tr_b16 a[102:103], v8 offset:38432
  ds_read_b64_tr_b16 a[104:105], v8 offset:36928
  ds_read_b64_tr_b16 a[106:107], v8 offset:38464
  ds_read_b64_tr_b16 a[108:109], v8 offset:49152
  ds_read_b64_tr_b16 a[110:111], v8 offset:50688
  ds_read_b64_tr_b16 a[112:113], v8 offset:49184
  ds_read_b64_tr_b16 a[114:115], v8 offset:50720
  ds_read_b64_tr_b16 a[116:117], v8 offset:49216
  ds_read_b64_tr_b16 a[118:119], v8 offset:50752
  s_waitcnt lgkmcnt(0)
  s_barrier
  s_waitcnt vmcnt(15)
  ds_write_b128 v30, v[64:67] offset:0
  ds_write_b128 v30, v[68:71] offset:1024
  ds_write_b128 v30, v[72:75] offset:2048
  ds_write_b128 v30, v[76:79] offset:3072
  ds_write_b128 v30, v[80:83] offset:4096
  ds_write_b128 v30, v[84:87] offset:5120
  ds_write_b128 v30, v[88:91] offset:6144
  ds_write_b128 v30, v[92:95] offset:7168
  ds_write_b128 v30, v[96:99] offset:8192
  ds_write_b128 v30, v[100:103] offset:9216
  ds_write_b128 v30, v[104:107] offset:10240
  ds_write_b128 v30, v[108:111] offset:11264
  ds_write_b128 v30, v[112:115] offset:12288
  ds_write_b128 v30, v[116:119] offset:13312
  ds_write_b128 v30, v[120:123] offset:14336
  s_waitcnt lgkmcnt(0)
  s_barrier
  ds_read_b64_tr_b16 a[120:121], v7 offset:0
  ds_read_b64_tr_b16 a[122:123], v7 offset:1536
  ds_read_b64_tr_b16 a[124:125], v7 offset:32
  ds_read_b64_tr_b16 a[126:127], v7 offset:1568
  ds_read_b64_tr_b16 a[128:129], v7 offset:64
  ds_read_b64_tr_b16 a[130:131], v7 offset:1600
  ds_read_b64_tr_b16 a[132:133], v7 offset:12288
  ds_read_b64_tr_b16 a[134:135], v7 offset:13824
  ds_read_b64_tr_b16 a[136:137], v7 offset:12320
  ds_read_b64_tr_b16 a[138:139], v7 offset:13856
  ds_read_b64_tr_b16 a[140:141], v7 offset:12352
  ds_read_b64_tr_b16 a[142:143], v7 offset:13888
  ds_read_b64_tr_b16 a[144:145], v7 offset:24576
  ds_read_b64_tr_b16 a[146:147], v7 offset:26112
  ds_read_b64_tr_b16 a[148:149], v7 offset:24608
  ds_read_b64_tr_b16 a[150:151], v7 offset:26144
  ds_read_b64_tr_b16 a[152:153], v7 offset:24640
  ds_read_b64_tr_b16 a[154:155], v7 offset:26176
  ds_read_b64_tr_b16 a[156:157], v7 offset:36864
  ds_read_b64_tr_b16 a[158:159], v7 offset:38400
  ds_read_b64_tr_b16 a[160:161], v7 offset:36896
  ds_read_b64_tr_b16 a[162:163], v7 offset:38432
  ds_read_b64_tr_b16 a[164:165], v7 offset:36928
  ds_read_b64_tr_b16 a[166:167], v7 offset:38464
  ds_read_b64_tr_b16 a[168:169], v7 offset:49152
  ds_read_b64_tr_b16 a[170:171], v7 offset:50688
  ds_read_b64_tr_b16 a[172:173], v7 offset:49184
  ds_read_b64_tr_b16 a[174:175], v7 offset:50720
  ds_read_b64_tr_b16 a[176:177], v7 offset:49216
  ds_read_b64_tr_b16 a[178:179], v7 offset:50752
  s_waitcnt lgkmcnt(0)
  s_barrier
  s_waitcnt vmcnt(0)
  ds_write_b128 v31, v[124:127] offset:0
  ds_write_b128 v31, v[128:131] offset:1024
  ds_write_b128 v31, v[132:135] offset:2048
  ds_write_b128 v31, v[136:139] offset:3072
  ds_write_b128 v31, v[140:143] offset:4096
  ds_write_b128 v31, v[144:147] offset:5120
  ds_write_b128 v31, v[148:151] offset:6144
  ds_write_b128 v31, v[152:155] offset:7168
  ds_write_b128 v31, v[156:159] offset:8192
  ds_write_b128 v31, v[160:163] offset:9216
  ds_write_b128 v31, v[164:167] offset:10240
  ds_write_b128 v31, v[168:171] offset:11264
  ds_write_b128 v31, v[172:175] offset:12288
  ds_write_b128 v31, v[176:179] offset:13312
  ds_write_b128 v31, v[180:183] offset:14336
  s_waitcnt lgkmcnt(0)
  s_barrier
  ds_read_b64_tr_b16 a[180:181], v8 offset:0
  ds_read_b64_tr_b16 a[182:183], v8 offset:1536
  ds_read_b64_tr_b16 a[184:185], v8 offset:32
  ds_read_b64_tr_b16 a[186:187], v8 offset:1568
  ds_read_b64_tr_b16 a[188:189], v8 offset:64
  ds_read_b64_tr_b16 a[190:191], v8 offset:1600
  ds_read_b64_tr_b16 a[192:193], v8 offset:12288
  ds_read_b64_tr_b16 a[194:195], v8 offset:13824
  ds_read_b64_tr_b16 a[196:197], v8 offset:12320
  ds_read_b64_tr_b16 a[198:199], v8 offset:13856
  ds_read_b64_tr_b16 a[200:201], v8 offset:12352
  ds_read_b64_tr_b16 a[202:203], v8 offset:13888
  ds_read_b64_tr_b16 a[204:205], v8 offset:24576
  ds_read_b64_tr_b16 a[206:207], v8 offset:26112
  ds_read_b64_tr_b16 a[208:209], v8 offset:24608
  ds_read_b64_tr_b16 a[210:211], v8 offset:26144
  ds_read_b64_tr_b16 a[212:213], v8 offset:24640
  ds_read_b64_tr_b16 a[214:215], v8 offset:26176
  ds_read_b64_tr_b16 a[216:217], v8 offset:36864
  ds_read_b64_tr_b16 a[218:219], v8 offset:38400
  ds_read_b64_tr_b16 a[220:221], v8 offset:36896
  ds_read_b64_tr_b16 a[222:223], v8 offset:38432
  ds_read_b64_tr_b16 a[224:225], v8 offset:36928
  ds_read_b64_tr_b16 a[226:227], v8 offset:38464
  ds_read_b64_tr_b16 a[228:229], v8 offset:49152
  ds_read_b64_tr_b16 a[230:231], v8 offset:50688
  ds_read_b64_tr_b16 a[232:233], v8 offset:49184
  ds_read_b64_tr_b16 a[234:235], v8 offset:50720
  ds_read_b64_tr_b16 a[236:237], v8 offset:49216
  ds_read_b64_tr_b16 a[238:239], v8 offset:50752
  s_waitcnt lgkmcnt(0)
  s_barrier
  s_mul_i32 s24, s42, 163840
  s_mul_i32 s25, s63, 163840
  s_mul_i32 s27, s42, 491520
  s_add_u32 s27, s27, s44
  s_mul_i32 s28, s63, 491520
  s_lshl_b32 s63, s63, 7
  s_load_dwordx2 s[72:73], s[0:1], 104
  s_waitcnt lgkmcnt(0)
  s_add_u32 s72, s72, 81068032
  s_addc_u32 s73, s73, 0
  s_mov_b32 s74, 115712
  s_mov_b32 s75, 0x00020000
  s_lshl_b32 s60, s42, 7
  s_add_u32 s60, s60, 88064
  s_mov_b32 s61, 0
  v_lshrrev_b32 v11, 3, v1
  v_and_b32 v12, 7, v1
  v_xor_b32 v12, v12, v11
  v_mul_u32_u24 v11, 1280, v11
  v_lshl_add_u32 v10, v12, 4, v11
  s_mov_b32 s30, s24
  s_mov_b32 s31, 0
  s_mov_b32 s32, 0
  s_mul_i32 s46, s20, 40960
  s_add_u32 s46, s46, s30
  s_lshl_b32 s47, s20, 12
  s_add_u32 s47, s47, s32
  s_add_u32 m0, s47, 0
  s_nop 0
  buffer_load_dwordx4 v10, s[8:11], s46 offen lds
  s_add_u32 s46, s46, 10240
  s_add_u32 m0, s47, 1024
  s_nop 0
  buffer_load_dwordx4 v10, s[8:11], s46 offen lds
  s_add_u32 s46, s46, 10240
  s_add_u32 m0, s47, 2048
  s_nop 0
  buffer_load_dwordx4 v10, s[8:11], s46 offen lds
  s_add_u32 s46, s46, 10240
  s_add_u32 m0, s47, 3072
  s_nop 0
  buffer_load_dwordx4 v10, s[8:11], s46 offen lds
  s_add_u32 s30, s30, 128
  s_add_u32 s31, s31, 1
  s_cmp_lt_u32 s31, 10
  s_cbranch_scc1 qb_253
  s_mov_b32 s31, 0
  s_add_u32 s30, s30, s25
  s_sub_u32 s30, s30, 1280
qb_253:
  s_add_u32 s32, s32, 16384
  s_cmp_lt_u32 s32, 98304
  s_cselect_b32 s32, s32, 0
  s_mul_i32 s46, s20, 40960
  s_add_u32 s46, s46, s30
  s_lshl_b32 s47, s20, 12
  s_add_u32 s47, s47, s32
  s_add_u32 m0, s47, 0
  s_nop 0
  buffer_load_dwordx4 v10, s[8:11], s46 offen lds
  s_add_u32 s46, s46, 10240
  s_add_u32 m0, s47, 1024
  s_nop 0
  buffer_load_dwordx4 v10, s[8:11], s46 offen lds
  s_add_u32 s46, s46, 10240
  s_add_u32 m0, s47, 2048
  s_nop 0
  buffer_load_dwordx4 v10, s[8:11], s46 offen lds
  s_add_u32 s46, s46, 10240
  s_add_u32 m0, s47, 3072
  s_nop 0
  buffer_load_dwordx4 v10, s[8:11], s46 offen lds
  s_add_u32 s30, s30, 128
  s_add_u32 s31, s31, 1
  s_cmp_lt_u32 s31, 10
  s_cbranch_scc1 qb_254
  s_mov_b32 s31, 0
  s_add_u32 s30, s30, s25
  s_sub_u32 s30, s30, 1280
qb_254:
  s_add_u32 s32, s32, 16384
  s_cmp_lt_u32 s32, 98304
  s_cselect_b32 s32, s32, 0
  s_mul_i32 s46, s20, 40960
  s_add_u32 s46, s46, s30
  s_lshl_b32 s47, s20, 12
  s_add_u32 s47, s47, s32
  s_add_u32 m0, s47, 0
  s_nop 0
  buffer_load_dwordx4 v10, s[8:11], s46 offen lds
  s_add_u32 s46, s46, 10240
  s_add_u32 m0, s47, 1024
  s_nop 0
  buffer_load_dwordx4 v10, s[8:11], s46 offen lds
  s_add_u32 s46, s46, 10240
  s_add_u32 m0, s47, 2048
  s_nop 0
  buffer_load_dwordx4 v10, s[8:11], s46 offen lds
  s_add_u32 s46, s46, 10240
  s_add_u32 m0, s47, 3072
  s_nop 0
  buffer_load_dwordx4 v10, s[8:11], s46 offen lds
  s_add_u32 s30, s30, 128
  s_add_u32 s31, s31, 1
  s_cmp_lt_u32 s31, 10
  s_cbranch_scc1 qb_255
  s_mov_b32 s31, 0
  s_add_u32 s30, s30, s25
  s_sub_u32 s30, s30, 1280
qb_255:
  s_add_u32 s32, s32, 16384
  s_cmp_lt_u32 s32, 98304
  s_cselect_b32 s32, s32, 0
  s_mul_i32 s46, s20, 40960
  s_add_u32 s46, s46, s30
  s_lshl_b32 s47, s20, 12
  s_add_u32 s47, s47, s32
  s_add_u32 m0, s47, 0
  s_nop 0
  buffer_load_dwordx4 v10, s[8:11], s46 offen lds
  s_add_u32 s46, s46, 10240
  s_add_u32 m0, s47, 1024
  s_nop 0
  buffer_load_dwordx4 v10, s[8:11], s46 offen lds
  s_add_u32 s46, s46, 10240
  s_add_u32 m0, s47, 2048
  s_nop 0
  buffer_load_dwordx4 v10, s[8:11], s46 offen lds
  s_add_u32 s46, s46, 10240
  s_add_u32 m0, s47, 3072
  s_nop 0
  buffer_load_dwordx4 v10, s[8:11], s46 offen lds
  s_add_u32 s30, s30, 128
  s_add_u32 s31, s31, 1
  s_cmp_lt_u32 s31, 10
  s_cbranch_scc1 qb_256
  s_mov_b32 s31, 0
  s_add_u32 s30, s30, s25
  s_sub_u32 s30, s30, 1280
qb_256:
  s_add_u32 s32, s32, 16384
  s_cmp_lt_u32 s32, 98304
  s_cselect_b32 s32, s32, 0
  v_and_b32 v6, 7, v2
  v_add_u32 v4, 0, v3
  v_xor_b32 v4, v4, v6
  v_lshlrev_b32 v4, 4, v4
  v_lshl_add_u32 v14, v2, 7, v4
  v_add_u32 v4, 4, v3
  v_xor_b32 v4, v4, v6
  v_lshlrev_b32 v4, 4, v4
  v_lshl_add_u32 v15, v2, 7, v4
  v_mul_u32_u24 v22, 400, v2
  v_mul_u32_u24 v4, 8, v3
  s_mul_i32 s21, s20, 96
  s_add_u32 s21, s21, 98304
  v_add3_u32 v22, v22, v4, s21
  v_mov_b32 v9, 2731
  v_add_u32 v8, 0, v1
  v_mul_u32_u24 v7, v8, v9
  v_lshrrev_b32 v7, 16, v7
  v_mul_u32_u24 v4, 24, v7
  v_sub_u32 v8, v8, v4
  v_lshlrev_b32 v8, 4, v8
  s_mov_b32 s21, 3840
  v_mul_lo_u32 v4, v7, s21
  v_add_u32 v26, v4, v8
  v_mul_u32_u24 v4, 400, v7
  s_mul_i32 s21, s20, 12800
  s_add_u32 s21, s21, 98304
  v_add3_u32 v23, v4, v8, s21
  v_add_u32 v8, 64, v1
  v_mul_u32_u24 v7, v8, v9
  v_lshrrev_b32 v7, 16, v7
  v_mul_u32_u24 v4, 24, v7
  v_sub_u32 v8, v8, v4
  v_lshlrev_b32 v8, 4, v8
  s_mov_b32 s21, 3840
  v_mul_lo_u32 v4, v7, s21
  v_add_u32 v27, v4, v8
  v_mul_u32_u24 v4, 400, v7
  s_mul_i32 s21, s20, 12800
  s_add_u32 s21, s21, 98304
  v_add3_u32 v24, v4, v8, s21
  v_add_u32 v8, 128, v1
  v_mul_u32_u24 v7, v8, v9
  v_lshrrev_b32 v7, 16, v7
  v_mul_u32_u24 v4, 24, v7
  v_sub_u32 v8, v8, v4
  v_lshlrev_b32 v8, 4, v8
  s_mov_b32 s21, 3840
  v_mul_lo_u32 v4, v7, s21
  v_add_u32 v28, v4, v8
  v_mul_u32_u24 v4, 400, v7
  s_mul_i32 s21, s20, 12800
  s_add_u32 s21, s21, 98304
  v_add3_u32 v25, v4, v8, s21
  s_mov_b32 s33, 0
  s_mov_b32 s48, 0x80000000
  s_mul_i32 s46, s20, 40960
  s_add_u32 s46, s46, s30
  s_lshl_b32 s47, s20, 12
  s_add_u32 s47, s47, s32
  s_add_u32 m0, s47, 0
  s_nop 0
  buffer_load_dwordx4 v10, s[8:11], s46 offen lds
  s_add_u32 s46, s46, 10240
  s_add_u32 m0, s47, 1024
  s_nop 0
  buffer_load_dwordx4 v10, s[8:11], s46 offen lds
  s_waitcnt vmcnt(14)
  s_barrier
  v_add_u32 v18, s33, v14
  v_add_u32 v19, s33, v15
  s_add_u32 s33, s33, 16384
  s_cmp_lt_u32 s33, 98304
  s_cselect_b32 s33, s33, 0
  ds_read_b128 v[160:163], v18 offset:0
  ds_read_b128 v[164:167], v18 offset:2048
  ds_read_b128 v[168:171], v18 offset:4096
  ds_read_b128 v[172:175], v18 offset:6144
  ds_read_b128 v[176:179], v18 offset:8192
  ds_read_b128 v[180:183], v18 offset:10240
  ds_read_b128 v[184:187], v18 offset:12288
  ds_read_b128 v[188:191], v18 offset:14336
qb_blk_257:
  ds_read_b128 v[192:195], v19 offset:0
  s_waitcnt lgkmcnt(8)
  v_mfma_f32_16x16x32_bf16 v[64:67], a[0:3], v[160:163], 0
  v_mfma_f32_16x16x32_bf16 v[68:71], a[4:7], v[160:163], 0
  v_mfma_f32_16x16x32_bf16 v[72:75], a[8:11], v[160:163], 0
  ds_read_b128 v[196:199], v19 offset:2048
  s_waitcnt lgkmcnt(8)
  v_mfma_f32_16x16x32_bf16 v[76:79], a[0:3], v[164:167], 0
  v_mfma_f32_16x16x32_bf16 v[80:83], a[4:7], v[164:167], 0
  v_mfma_f32_16x16x32_bf16 v[84:87], a[8:11], v[164:167], 0
  s_add_u32 s46, s46, 10240
  s_add_u32 m0, s47, 2048
  s_nop 0
  buffer_load_dwordx4 v10, s[8:11], s46 offen lds
  ds_read_b128 v[200:203], v19 offset:4096
  s_waitcnt lgkmcnt(8)
  v_mfma_f32_16x16x32_bf16 v[88:91], a[0:3], v[168:171], 0
  v_mfma_f32_16x16x32_bf16 v[92:95], a[4:7], v[168:171], 0
  v_mfma_f32_16x16x32_bf16 v[96:99], a[8:11], v[168:171], 0
  ds_read_b128 v[204:207], v19 offset:6144
  s_waitcnt lgkmcnt(8)
  v_mfma_f32_16x16x32_bf16 v[100:103], a[0:3], v[172:175], 0
  v_mfma_f32_16x16x32_bf16 v[104:107], a[4:7], v[172:175], 0
  v_mfma_f32_16x16x32_bf16 v[108:111], a[8:11], v[172:175], 0
  ds_read_b128 v[208:211], v19 offset:8192
  s_waitcnt lgkmcnt(8)
  v_mfma_f32_16x16x32_bf16 v[112:115], a[0:3], v[176:179], 0
  v_mfma_f32_16x16x32_bf16 v[116:119], a[4:7], v[176:179], 0
  v_mfma_f32_16x16x32_bf16 v[120:123], a[8:11], v[176:179], 0
  ds_read_b128 v[212:215], v19 offset:10240
  s_waitcnt lgkmcnt(8)
  v_mfma_f32_16x16x32_bf16 v[124:127], a[0:3], v[180:183], 0
  v_mfma_f32_16x16x32_bf16 v[128:131], a[4:7], v[180:183], 0
  v_mfma_f32_16x16x32_bf16 v[132:135], a[8:11], v[180:183], 0
  s_add_u32 s46, s46, 10240
  s_add_u32 m0, s47, 3072
  s_nop 0
  buffer_load_dwordx4 v10, s[8:11], s46 offen lds
  ds_read_b128 v[216:219], v19 offset:12288
  s_waitcnt lgkmcnt(8)
  v_mfma_f32_16x16x32_bf16 v[136:139], a[0:3], v[184:187], 0
  v_mfma_f32_16x16x32_bf16 v[140:143], a[4:7], v[184:187], 0
  v_mfma_f32_16x16x32_bf16 v[144:147], a[8:11], v[184:187], 0
  ds_read_b128 v[220:223], v19 offset:14336
  s_waitcnt lgkmcnt(8)
  v_mfma_f32_16x16x32_bf16 v[148:151], a[0:3], v[188:191], 0
  v_mfma_f32_16x16x32_bf16 v[152:155], a[4:7], v[188:191], 0
  v_mfma_f32_16x16x32_bf16 v[156:159], a[8:11], v[188:191], 0
  s_waitcnt vmcnt(12)
  s_barrier
  s_add_u32 s30, s30, 128
  s_add_u32 s31, s31, 1
  s_cmp_lt_u32 s31, 10
  s_cbranch_scc1 qb_258
  s_mov_b32 s31, 0
  s_add_u32 s30, s30, s25
  s_sub_u32 s30, s30, 1280
qb_258:
  s_add_u32 s32, s32, 16384
  s_cmp_lt_u32 s32, 98304
  s_cselect_b32 s32, s32, 0
  s_mul_i32 s46, s20, 40960
  s_add_u32 s46, s46, s30
  s_lshl_b32 s47, s20, 12
  s_add_u32 s47, s47, s32
  v_add_u32 v18, s33, v14
  v_add_u32 v19, s33, v15
  s_add_u32 s33, s33, 16384
  s_cmp_lt_u32 s33, 98304
  s_cselect_b32 s33, s33, 0
  ds_read_b128 v[160:163], v18 offset:0
  s_waitcnt lgkmcnt(8)
  v_mfma_f32_16x16x32_bf16 v[64:67], a[12:15], v[192:195], v[64:67]
  v_mfma_f32_16x16x32_bf16 v[68:71], a[16:19], v[192:195], v[68:71]
  v_mfma_f32_16x16x32_bf16 v[72:75], a[20:23], v[192:195], v[72:75]
  ds_read_b128 v[224:227], v23 offset:0
  ds_read_b128 v[164:167], v18 offset:2048
  s_waitcnt lgkmcnt(8)
  v_mfma_f32_16x16x32_bf16 v[76:79], a[12:15], v[196:199], v[76:79]
  v_mfma_f32_16x16x32_bf16 v[80:83], a[16:19], v[196:199], v[80:83]
  v_mfma_f32_16x16x32_bf16 v[84:87], a[20:23], v[196:199], v[84:87]
  s_add_u32 m0, s47, 0
  s_nop 0
  buffer_load_dwordx4 v10, s[8:11], s46 offen lds
  ds_read_b128 v[168:171], v18 offset:4096
  s_waitcnt lgkmcnt(8)
  v_mfma_f32_16x16x32_bf16 v[88:91], a[12:15], v[200:203], v[88:91]
  v_mfma_f32_16x16x32_bf16 v[92:95], a[16:19], v[200:203], v[92:95]
  v_mfma_f32_16x16x32_bf16 v[96:99], a[20:23], v[200:203], v[96:99]
  ds_read_b128 v[172:175], v18 offset:6144
  s_waitcnt lgkmcnt(8)
  v_mfma_f32_16x16x32_bf16 v[100:103], a[12:15], v[204:207], v[100:103]
  v_mfma_f32_16x16x32_bf16 v[104:107], a[16:19], v[204:207], v[104:107]
  v_mfma_f32_16x16x32_bf16 v[108:111], a[20:23], v[204:207], v[108:111]
  ds_read_b128 v[176:179], v18 offset:8192
  s_waitcnt lgkmcnt(8)
  v_mfma_f32_16x16x32_bf16 v[112:115], a[12:15], v[208:211], v[112:115]
  v_mfma_f32_16x16x32_bf16 v[116:119], a[16:19], v[208:211], v[116:119]
  v_mfma_f32_16x16x32_bf16 v[120:123], a[20:23], v[208:211], v[120:123]
  ds_read_b128 v[228:231], v24 offset:0
  ds_read_b128 v[180:183], v18 offset:10240
  s_waitcnt lgkmcnt(8)
  v_mfma_f32_16x16x32_bf16 v[124:127], a[12:15], v[212:215], v[124:127]
  v_mfma_f32_16x16x32_bf16 v[128:131], a[16:19], v[212:215], v[128:131]
  v_mfma_f32_16x16x32_bf16 v[132:135], a[20:23], v[212:215], v[132:135]
  s_add_u32 s46, s46, 10240
  s_add_u32 m0, s47, 1024
  s_nop 0
  buffer_load_dwordx4 v10, s[8:11], s46 offen lds
  ds_read_b128 v[184:187], v18 offset:12288
  s_waitcnt lgkmcnt(8)
  v_mfma_f32_16x16x32_bf16 v[136:139], a[12:15], v[216:219], v[136:139]
  v_mfma_f32_16x16x32_bf16 v[140:143], a[16:19], v[216:219], v[140:143]
  v_mfma_f32_16x16x32_bf16 v[144:147], a[20:23], v[216:219], v[144:147]
  ds_read_b128 v[188:191], v18 offset:14336
  s_waitcnt lgkmcnt(8)
  v_mfma_f32_16x16x32_bf16 v[148:151], a[12:15], v[220:223], v[148:151]
  v_mfma_f32_16x16x32_bf16 v[152:155], a[16:19], v[220:223], v[152:155]
  v_mfma_f32_16x16x32_bf16 v[156:159], a[20:23], v[220:223], v[156:159]
  ds_read_b128 v[192:195], v19 offset:0
  s_waitcnt lgkmcnt(8)
  v_mfma_f32_16x16x32_bf16 v[64:67], a[24:27], v[160:163], v[64:67]
  v_mfma_f32_16x16x32_bf16 v[68:71], a[28:31], v[160:163], v[68:71]
  v_mfma_f32_16x16x32_bf16 v[72:75], a[32:35], v[160:163], v[72:75]
  ds_read_b128 v[232:235], v25 offset:0
  ds_read_b128 v[196:199], v19 offset:2048
  s_waitcnt lgkmcnt(8)
  v_mfma_f32_16x16x32_bf16 v[76:79], a[24:27], v[164:167], v[76:79]
  v_mfma_f32_16x16x32_bf16 v[80:83], a[28:31], v[164:167], v[80:83]
  v_mfma_f32_16x16x32_bf16 v[84:87], a[32:35], v[164:167], v[84:87]
  s_add_u32 s46, s46, 10240
  s_add_u32 m0, s47, 2048
  s_nop 0
  buffer_load_dwordx4 v10, s[8:11], s46 offen lds
  ds_read_b128 v[200:203], v19 offset:4096
  s_waitcnt lgkmcnt(8)
  v_mfma_f32_16x16x32_bf16 v[88:91], a[24:27], v[168:171], v[88:91]
  v_mfma_f32_16x16x32_bf16 v[92:95], a[28:31], v[168:171], v[92:95]
  v_mfma_f32_16x16x32_bf16 v[96:99], a[32:35], v[168:171], v[96:99]
  ds_read_b128 v[204:207], v19 offset:6144
  s_waitcnt lgkmcnt(8)
  v_mfma_f32_16x16x32_bf16 v[100:103], a[24:27], v[172:175], v[100:103]
  v_mfma_f32_16x16x32_bf16 v[104:107], a[28:31], v[172:175], v[104:107]
  v_mfma_f32_16x16x32_bf16 v[108:111], a[32:35], v[172:175], v[108:111]
  s_add_u32 s21, s48, 0
  buffer_store_dwordx4 v[224:227], v26, s[16:19], s21 offen sc1
  ds_read_b128 v[208:211], v19 offset:8192
  s_waitcnt lgkmcnt(8)
  v_mfma_f32_16x16x32_bf16 v[112:115], a[24:27], v[176:179], v[112:115]
  v_mfma_f32_16x16x32_bf16 v[116:119], a[28:31], v[176:179], v[116:119]
  v_mfma_f32_16x16x32_bf16 v[120:123], a[32:35], v[176:179], v[120:123]
  ds_read_b128 v[236:239], v23 offset:3200
  ds_read_b128 v[212:215], v19 offset:10240
  s_waitcnt lgkmcnt(8)
  v_mfma_f32_16x16x32_bf16 v[124:127], a[24:27], v[180:183], v[124:127]
  v_mfma_f32_16x16x32_bf16 v[128:131], a[28:31], v[180:183], v[128:131]
  v_mfma_f32_16x16x32_bf16 v[132:135], a[32:35], v[180:183], v[132:135]
  s_add_u32 s46, s46, 10240
  s_add_u32 m0, s47, 3072
  s_nop 0
  buffer_load_dwordx4 v10, s[8:11], s46 offen lds
  ds_read_b128 v[216:219], v19 offset:12288
  s_waitcnt lgkmcnt(8)
  v_mfma_f32_16x16x32_bf16 v[136:139], a[24:27], v[184:187], v[136:139]
  v_mfma_f32_16x16x32_bf16 v[140:143], a[28:31], v[184:187], v[140:143]
  v_mfma_f32_16x16x32_bf16 v[144:147], a[32:35], v[184:187], v[144:147]
  s_add_u32 s21, s48, 0
  buffer_store_dwordx4 v[228:231], v27, s[16:19], s21 offen sc1
  ds_read_b128 v[220:223], v19 offset:14336
  s_waitcnt lgkmcnt(8)
  v_mfma_f32_16x16x32_bf16 v[148:151], a[24:27], v[188:191], v[148:151]
  v_mfma_f32_16x16x32_bf16 v[152:155], a[28:31], v[188:191], v[152:155]
  v_mfma_f32_16x16x32_bf16 v[156:159], a[32:35], v[188:191], v[156:159]
  s_waitcnt vmcnt(14)
  s_barrier
  s_add_u32 s30, s30, 128
  s_add_u32 s31, s31, 1
  s_cmp_lt_u32 s31, 10
  s_cbranch_scc1 qb_259
  s_mov_b32 s31, 0
  s_add_u32 s30, s30, s25
  s_sub_u32 s30, s30, 1280
qb_259:
  s_add_u32 s32, s32, 16384
  s_cmp_lt_u32 s32, 98304
  s_cselect_b32 s32, s32, 0
  s_mul_i32 s46, s20, 40960
  s_add_u32 s46, s46, s30
  s_lshl_b32 s47, s20, 12
  s_add_u32 s47, s47, s32
  v_add_u32 v18, s33, v14
  v_add_u32 v19, s33, v15
  s_add_u32 s33, s33, 16384
  s_cmp_lt_u32 s33, 98304
  s_cselect_b32 s33, s33, 0
  ds_read_b128 v[160:163], v18 offset:0
  s_waitcnt lgkmcnt(8)
  v_mfma_f32_16x16x32_bf16 v[64:67], a[36:39], v[192:195], v[64:67]
  v_mfma_f32_16x16x32_bf16 v[68:71], a[40:43], v[192:195], v[68:71]
  v_mfma_f32_16x16x32_bf16 v[72:75], a[44:47], v[192:195], v[72:75]
  ds_read_b128 v[240:243], v24 offset:3200
  ds_read_b128 v[164:167], v18 offset:2048
  s_waitcnt lgkmcnt(8)
  v_mfma_f32_16x16x32_bf16 v[76:79], a[36:39], v[196:199], v[76:79]
  v_mfma_f32_16x16x32_bf16 v[80:83], a[40:43], v[196:199], v[80:83]
  v_mfma_f32_16x16x32_bf16 v[84:87], a[44:47], v[196:199], v[84:87]
  s_add_u32 m0, s47, 0
  s_nop 0
  buffer_load_dwordx4 v10, s[8:11], s46 offen lds
  ds_read_b128 v[168:171], v18 offset:4096
  s_waitcnt lgkmcnt(8)
  v_mfma_f32_16x16x32_bf16 v[88:91], a[36:39], v[200:203], v[88:91]
  v_mfma_f32_16x16x32_bf16 v[92:95], a[40:43], v[200:203], v[92:95]
  v_mfma_f32_16x16x32_bf16 v[96:99], a[44:47], v[200:203], v[96:99]
  ds_read_b128 v[172:175], v18 offset:6144
  s_waitcnt lgkmcnt(8)
  v_mfma_f32_16x16x32_bf16 v[100:103], a[36:39], v[204:207], v[100:103]
  v_mfma_f32_16x16x32_bf16 v[104:107], a[40:43], v[204:207], v[104:107]
  v_mfma_f32_16x16x32_bf16 v[108:111], a[44:47], v[204:207], v[108:111]
  s_add_u32 s21, s48, 0
  buffer_store_dwordx4 v[232:235], v28, s[16:19], s21 offen sc1
  ds_read_b128 v[176:179], v18 offset:8192
  s_waitcnt lgkmcnt(8)
  v_mfma_f32_16x16x32_bf16 v[112:115], a[36:39], v[208:211], v[112:115]
  v_mfma_f32_16x16x32_bf16 v[116:119], a[40:43], v[208:211], v[116:119]
  v_mfma_f32_16x16x32_bf16 v[120:123], a[44:47], v[208:211], v[120:123]
  ds_read_b128 v[244:247], v25 offset:3200
  ds_read_b128 v[180:183], v18 offset:10240
  s_waitcnt lgkmcnt(8)
  v_mfma_f32_16x16x32_bf16 v[124:127], a[36:39], v[212:215], v[124:127]
  v_mfma_f32_16x16x32_bf16 v[128:131], a[40:43], v[212:215], v[128:131]
  v_mfma_f32_16x16x32_bf16 v[132:135], a[44:47], v[212:215], v[132:135]
  s_add_u32 s46, s46, 10240
  s_add_u32 m0, s47, 1024
  s_nop 0
  buffer_load_dwordx4 v10, s[8:11], s46 offen lds
  ds_read_b128 v[184:187], v18 offset:12288
  s_waitcnt lgkmcnt(8)
  v_mfma_f32_16x16x32_bf16 v[136:139], a[36:39], v[216:219], v[136:139]
  v_mfma_f32_16x16x32_bf16 v[140:143], a[40:43], v[216:219], v[140:143]
  v_mfma_f32_16x16x32_bf16 v[144:147], a[44:47], v[216:219], v[144:147]
  s_add_u32 s21, s48, 30720
  buffer_store_dwordx4 v[236:239], v26, s[16:19], s21 offen sc1
  ds_read_b128 v[188:191], v18 offset:14336
  s_waitcnt lgkmcnt(8)
  v_mfma_f32_16x16x32_bf16 v[148:151], a[36:39], v[220:223], v[148:151]
  v_mfma_f32_16x16x32_bf16 v[152:155], a[40:43], v[220:223], v[152:155]
  v_mfma_f32_16x16x32_bf16 v[156:159], a[44:47], v[220:223], v[156:159]
  ds_read_b128 v[192:195], v19 offset:0
  s_waitcnt lgkmcnt(8)
  v_mfma_f32_16x16x32_bf16 v[64:67], a[48:51], v[160:163], v[64:67]
  v_mfma_f32_16x16x32_bf16 v[68:71], a[52:55], v[160:163], v[68:71]
  v_mfma_f32_16x16x32_bf16 v[72:75], a[56:59], v[160:163], v[72:75]
  ds_read_b128 v[224:227], v23 offset:6400
  ds_read_b128 v[196:199], v19 offset:2048
  s_waitcnt lgkmcnt(8)
  v_mfma_f32_16x16x32_bf16 v[76:79], a[48:51], v[164:167], v[76:79]
  v_mfma_f32_16x16x32_bf16 v[80:83], a[52:55], v[164:167], v[80:83]
  v_mfma_f32_16x16x32_bf16 v[84:87], a[56:59], v[164:167], v[84:87]
  s_add_u32 s46, s46, 10240
  s_add_u32 m0, s47, 2048
  s_nop 0
  buffer_load_dwordx4 v10, s[8:11], s46 offen lds
  ds_read_b128 v[200:203], v19 offset:4096
  s_waitcnt lgkmcnt(8)
  v_mfma_f32_16x16x32_bf16 v[88:91], a[48:51], v[168:171], v[88:91]
  v_mfma_f32_16x16x32_bf16 v[92:95], a[52:55], v[168:171], v[92:95]
  v_mfma_f32_16x16x32_bf16 v[96:99], a[56:59], v[168:171], v[96:99]
  ds_read_b128 v[204:207], v19 offset:6144
  s_waitcnt lgkmcnt(8)
  v_mfma_f32_16x16x32_bf16 v[100:103], a[48:51], v[172:175], v[100:103]
  v_mfma_f32_16x16x32_bf16 v[104:107], a[52:55], v[172:175], v[104:107]
  v_mfma_f32_16x16x32_bf16 v[108:111], a[56:59], v[172:175], v[108:111]
  s_add_u32 s21, s48, 30720
  buffer_store_dwordx4 v[240:243], v27, s[16:19], s21 offen sc1
  ds_read_b128 v[208:211], v19 offset:8192
  s_waitcnt lgkmcnt(8)
  v_mfma_f32_16x16x32_bf16 v[112:115], a[48:51], v[176:179], v[112:115]
  v_mfma_f32_16x16x32_bf16 v[116:119], a[52:55], v[176:179], v[116:119]
  v_mfma_f32_16x16x32_bf16 v[120:123], a[56:59], v[176:179], v[120:123]
  ds_read_b128 v[228:231], v24 offset:6400
  ds_read_b128 v[212:215], v19 offset:10240
  s_waitcnt lgkmcnt(8)
  v_mfma_f32_16x16x32_bf16 v[124:127], a[48:51], v[180:183], v[124:127]
  v_mfma_f32_16x16x32_bf16 v[128:131], a[52:55], v[180:183], v[128:131]
  v_mfma_f32_16x16x32_bf16 v[132:135], a[56:59], v[180:183], v[132:135]
  s_add_u32 s46, s46, 10240
  s_add_u32 m0, s47, 3072
  s_nop 0
  buffer_load_dwordx4 v10, s[8:11], s46 offen lds
  ds_read_b128 v[216:219], v19 offset:12288
  s_waitcnt lgkmcnt(8)
  v_mfma_f32_16x16x32_bf16 v[136:139], a[48:51], v[184:187], v[136:139]
  v_mfma_f32_16x16x32_bf16 v[140:143], a[52:55], v[184:187], v[140:143]
  v_mfma_f32_16x16x32_bf16 v[144:147], a[56:59], v[184:187], v[144:147]
  s_add_u32 s21, s48, 30720
  buffer_store_dwordx4 v[244:247], v28, s[16:19], s21 offen sc1
  ds_read_b128 v[220:223], v19 offset:14336
  s_waitcnt lgkmcnt(8)
  v_mfma_f32_16x16x32_bf16 v[148:151], a[48:51], v[188:191], v[148:151]
  v_mfma_f32_16x16x32_bf16 v[152:155], a[52:55], v[188:191], v[152:155]
  v_mfma_f32_16x16x32_bf16 v[156:159], a[56:59], v[188:191], v[156:159]
  s_waitcnt vmcnt(18)
  s_barrier
  s_add_u32 s30, s30, 128
  s_add_u32 s31, s31, 1
  s_cmp_lt_u32 s31, 10
  s_cbranch_scc1 qb_260
  s_mov_b32 s31, 0
  s_add_u32 s30, s30, s25
  s_sub_u32 s30, s30, 1280
qb_260:
  s_add_u32 s32, s32, 16384
  s_cmp_lt_u32 s32, 98304
  s_cselect_b32 s32, s32, 0
  s_mul_i32 s46, s20, 40960
  s_add_u32 s46, s46, s30
  s_lshl_b32 s47, s20, 12
  s_add_u32 s47, s47, s32
  v_add_u32 v18, s33, v14
  v_add_u32 v19, s33, v15
  s_add_u32 s33, s33, 16384
  s_cmp_lt_u32 s33, 98304
  s_cselect_b32 s33, s33, 0
  ds_read_b128 v[160:163], v18 offset:0
  s_waitcnt lgkmcnt(8)
  v_mfma_f32_16x16x32_bf16 v[64:67], a[60:63], v[192:195], v[64:67]
  v_mfma_f32_16x16x32_bf16 v[68:71], a[64:67], v[192:195], v[68:71]
  v_mfma_f32_16x16x32_bf16 v[72:75], a[68:71], v[192:195], v[72:75]
  ds_read_b128 v[232:235], v25 offset:6400
  ds_read_b128 v[164:167], v18 offset:2048
  s_waitcnt lgkmcnt(8)
  v_mfma_f32_16x16x32_bf16 v[76:79], a[60:63], v[196:199], v[76:79]
  v_mfma_f32_16x16x32_bf16 v[80:83], a[64:67], v[196:199], v[80:83]
  v_mfma_f32_16x16x32_bf16 v[84:87], a[68:71], v[196:199], v[84:87]
  s_add_u32 m0, s47, 0
  s_nop 0
  buffer_load_dwordx4 v10, s[8:11], s46 offen lds
  ds_read_b128 v[168:171], v18 offset:4096
  s_waitcnt lgkmcnt(8)
  v_mfma_f32_16x16x32_bf16 v[88:91], a[60:63], v[200:203], v[88:91]
  v_mfma_f32_16x16x32_bf16 v[92:95], a[64:67], v[200:203], v[92:95]
  v_mfma_f32_16x16x32_bf16 v[96:99], a[68:71], v[200:203], v[96:99]
  ds_read_b128 v[172:175], v18 offset:6144
  s_waitcnt lgkmcnt(8)
  v_mfma_f32_16x16x32_bf16 v[100:103], a[60:63], v[204:207], v[100:103]
  v_mfma_f32_16x16x32_bf16 v[104:107], a[64:67], v[204:207], v[104:107]
  v_mfma_f32_16x16x32_bf16 v[108:111], a[68:71], v[204:207], v[108:111]
  s_add_u32 s21, s48, 61440
  buffer_store_dwordx4 v[224:227], v26, s[16:19], s21 offen sc1
  ds_read_b128 v[176:179], v18 offset:8192
  s_waitcnt lgkmcnt(8)
  v_mfma_f32_16x16x32_bf16 v[112:115], a[60:63], v[208:211], v[112:115]
  v_mfma_f32_16x16x32_bf16 v[116:119], a[64:67], v[208:211], v[116:119]
  v_mfma_f32_16x16x32_bf16 v[120:123], a[68:71], v[208:211], v[120:123]
  ds_read_b128 v[236:239], v23 offset:9600
  ds_read_b128 v[180:183], v18 offset:10240
  s_waitcnt lgkmcnt(8)
  v_mfma_f32_16x16x32_bf16 v[124:127], a[60:63], v[212:215], v[124:127]
  v_mfma_f32_16x16x32_bf16 v[128:131], a[64:67], v[212:215], v[128:131]
  v_mfma_f32_16x16x32_bf16 v[132:135], a[68:71], v[212:215], v[132:135]
  s_add_u32 s46, s46, 10240
  s_add_u32 m0, s47, 1024
  s_nop 0
  buffer_load_dwordx4 v10, s[8:11], s46 offen lds
  ds_read_b128 v[184:187], v18 offset:12288
  s_waitcnt lgkmcnt(8)
  v_mfma_f32_16x16x32_bf16 v[136:139], a[60:63], v[216:219], v[136:139]
  v_mfma_f32_16x16x32_bf16 v[140:143], a[64:67], v[216:219], v[140:143]
  v_mfma_f32_16x16x32_bf16 v[144:147], a[68:71], v[216:219], v[144:147]
  s_add_u32 s21, s48, 61440
  buffer_store_dwordx4 v[228:231], v27, s[16:19], s21 offen sc1
  ds_read_b128 v[188:191], v18 offset:14336
  s_waitcnt lgkmcnt(8)
  v_mfma_f32_16x16x32_bf16 v[148:151], a[60:63], v[220:223], v[148:151]
  v_mfma_f32_16x16x32_bf16 v[152:155], a[64:67], v[220:223], v[152:155]
  v_mfma_f32_16x16x32_bf16 v[156:159], a[68:71], v[220:223], v[156:159]
  ds_read_b128 v[192:195], v19 offset:0
  s_waitcnt lgkmcnt(8)
  v_mfma_f32_16x16x32_bf16 v[64:67], a[72:75], v[160:163], v[64:67]
  v_mfma_f32_16x16x32_bf16 v[68:71], a[76:79], v[160:163], v[68:71]
  v_mfma_f32_16x16x32_bf16 v[72:75], a[80:83], v[160:163], v[72:75]
  ds_read_b128 v[240:243], v24 offset:9600
  ds_read_b128 v[196:199], v19 offset:2048
  s_waitcnt lgkmcnt(8)
  v_mfma_f32_16x16x32_bf16 v[76:79], a[72:75], v[164:167], v[76:79]
  v_mfma_f32_16x16x32_bf16 v[80:83], a[76:79], v[164:167], v[80:83]
  v_mfma_f32_16x16x32_bf16 v[84:87], a[80:83], v[164:167], v[84:87]
  s_add_u32 s46, s46, 10240
  s_add_u32 m0, s47, 2048
  s_nop 0
  buffer_load_dwordx4 v10, s[8:11], s46 offen lds
  ds_read_b128 v[200:203], v19 offset:4096
  s_waitcnt lgkmcnt(8)
  v_mfma_f32_16x16x32_bf16 v[88:91], a[72:75], v[168:171], v[88:91]
  v_mfma_f32_16x16x32_bf16 v[92:95], a[76:79], v[168:171], v[92:95]
  v_mfma_f32_16x16x32_bf16 v[96:99], a[80:83], v[168:171], v[96:99]
  ds_read_b128 v[204:207], v19 offset:6144
  s_waitcnt lgkmcnt(8)
  v_mfma_f32_16x16x32_bf16 v[100:103], a[72:75], v[172:175], v[100:103]
  v_mfma_f32_16x16x32_bf16 v[104:107], a[76:79], v[172:175], v[104:107]
  v_mfma_f32_16x16x32_bf16 v[108:111], a[80:83], v[172:175], v[108:111]
  s_add_u32 s21, s48, 61440
  buffer_store_dwordx4 v[232:235], v28, s[16:19], s21 offen sc1
  ds_read_b128 v[208:211], v19 offset:8192
  s_waitcnt lgkmcnt(8)
  v_mfma_f32_16x16x32_bf16 v[112:115], a[72:75], v[176:179], v[112:115]
  v_mfma_f32_16x16x32_bf16 v[116:119], a[76:79], v[176:179], v[116:119]
  v_mfma_f32_16x16x32_bf16 v[120:123], a[80:83], v[176:179], v[120:123]
  ds_read_b128 v[244:247], v25 offset:9600
  ds_read_b128 v[212:215], v19 offset:10240
  s_waitcnt lgkmcnt(8)
  v_mfma_f32_16x16x32_bf16 v[124:127], a[72:75], v[180:183], v[124:127]
  v_mfma_f32_16x16x32_bf16 v[128:131], a[76:79], v[180:183], v[128:131]
  v_mfma_f32_16x16x32_bf16 v[132:135], a[80:83], v[180:183], v[132:135]
  s_add_u32 s46, s46, 10240
  s_add_u32 m0, s47, 3072
  s_nop 0
  buffer_load_dwordx4 v10, s[8:11], s46 offen lds
  ds_read_b128 v[216:219], v19 offset:12288
  s_waitcnt lgkmcnt(8)
  v_mfma_f32_16x16x32_bf16 v[136:139], a[72:75], v[184:187], v[136:139]
  v_mfma_f32_16x16x32_bf16 v[140:143], a[76:79], v[184:187], v[140:143]
  v_mfma_f32_16x16x32_bf16 v[144:147], a[80:83], v[184:187], v[144:147]
  s_add_u32 s21, s48, 92160
  buffer_store_dwordx4 v[236:239], v26, s[16:19], s21 offen sc1
  ds_read_b128 v[220:223], v19 offset:14336
  s_waitcnt lgkmcnt(8)
  v_mfma_f32_16x16x32_bf16 v[148:151], a[72:75], v[188:191], v[148:151]
  v_mfma_f32_16x16x32_bf16 v[152:155], a[76:79], v[188:191], v[152:155]
  v_mfma_f32_16x16x32_bf16 v[156:159], a[80:83], v[188:191], v[156:159]
  s_waitcnt vmcnt(22)
  s_barrier
  s_add_u32 s30, s30, 128
  s_add_u32 s31, s31, 1
  s_cmp_lt_u32 s31, 10
  s_cbranch_scc1 qb_261
  s_mov_b32 s31, 0
  s_add_u32 s30, s30, s25
  s_sub_u32 s30, s30, 1280
qb_261:
  s_add_u32 s32, s32, 16384
  s_cmp_lt_u32 s32, 98304
  s_cselect_b32 s32, s32, 0
  s_mul_i32 s46, s20, 40960
  s_add_u32 s46, s46, s30
  s_lshl_b32 s47, s20, 12
  s_add_u32 s47, s47, s32
  v_add_u32 v18, s33, v14
  v_add_u32 v19, s33, v15
  s_add_u32 s33, s33, 16384
  s_cmp_lt_u32 s33, 98304
  s_cselect_b32 s33, s33, 0
  ds_read_b128 v[160:163], v18 offset:0
  s_waitcnt lgkmcnt(8)
  v_mfma_f32_16x16x32_bf16 v[64:67], a[84:87], v[192:195], v[64:67]
  v_mfma_f32_16x16x32_bf16 v[68:71], a[88:91], v[192:195], v[68:71]
  v_mfma_f32_16x16x32_bf16 v[72:75], a[92:95], v[192:195], v[72:75]
  ds_read_b128 v[164:167], v18 offset:2048
  s_waitcnt lgkmcnt(8)
  v_mfma_f32_16x16x32_bf16 v[76:79], a[84:87], v[196:199], v[76:79]
  v_mfma_f32_16x16x32_bf16 v[80:83], a[88:91], v[196:199], v[80:83]
  v_mfma_f32_16x16x32_bf16 v[84:87], a[92:95], v[196:199], v[84:87]
  s_add_u32 m0, s47, 0
  s_nop 0
  buffer_load_dwordx4 v10, s[8:11], s46 offen lds
  ds_read_b128 v[168:171], v18 offset:4096
  s_waitcnt lgkmcnt(8)
  v_mfma_f32_16x16x32_bf16 v[88:91], a[84:87], v[200:203], v[88:91]
  v_mfma_f32_16x16x32_bf16 v[92:95], a[88:91], v[200:203], v[92:95]
  v_mfma_f32_16x16x32_bf16 v[96:99], a[92:95], v[200:203], v[96:99]
  ds_read_b128 v[172:175], v18 offset:6144
  s_waitcnt lgkmcnt(8)
  v_mfma_f32_16x16x32_bf16 v[100:103], a[84:87], v[204:207], v[100:103]
  v_mfma_f32_16x16x32_bf16 v[104:107], a[88:91], v[204:207], v[104:107]
  v_mfma_f32_16x16x32_bf16 v[108:111], a[92:95], v[204:207], v[108:111]
  s_add_u32 s21, s48, 92160
  buffer_store_dwordx4 v[240:243], v27, s[16:19], s21 offen sc1
  ds_read_b128 v[176:179], v18 offset:8192
  s_waitcnt lgkmcnt(8)
  v_mfma_f32_16x16x32_bf16 v[112:115], a[84:87], v[208:211], v[112:115]
  v_mfma_f32_16x16x32_bf16 v[116:119], a[88:91], v[208:211], v[116:119]
  v_mfma_f32_16x16x32_bf16 v[120:123], a[92:95], v[208:211], v[120:123]
  ds_read_b128 v[180:183], v18 offset:10240
  s_waitcnt lgkmcnt(8)
  v_mfma_f32_16x16x32_bf16 v[124:127], a[84:87], v[212:215], v[124:127]
  v_mfma_f32_16x16x32_bf16 v[128:131], a[88:91], v[212:215], v[128:131]
  v_mfma_f32_16x16x32_bf16 v[132:135], a[92:95], v[212:215], v[132:135]
  s_add_u32 s46, s46, 10240
  s_add_u32 m0, s47, 1024
  s_nop 0
  buffer_load_dwordx4 v10, s[8:11], s46 offen lds
  ds_read_b128 v[184:187], v18 offset:12288
  s_waitcnt lgkmcnt(8)
  v_mfma_f32_16x16x32_bf16 v[136:139], a[84:87], v[216:219], v[136:139]
  v_mfma_f32_16x16x32_bf16 v[140:143], a[88:91], v[216:219], v[140:143]
  v_mfma_f32_16x16x32_bf16 v[144:147], a[92:95], v[216:219], v[144:147]
  s_add_u32 s21, s48, 92160
  buffer_store_dwordx4 v[244:247], v28, s[16:19], s21 offen sc1
  ds_read_b128 v[188:191], v18 offset:14336
  s_waitcnt lgkmcnt(8)
  v_mfma_f32_16x16x32_bf16 v[148:151], a[84:87], v[220:223], v[148:151]
  v_mfma_f32_16x16x32_bf16 v[152:155], a[88:91], v[220:223], v[152:155]
  v_mfma_f32_16x16x32_bf16 v[156:159], a[92:95], v[220:223], v[156:159]
  ds_read_b128 v[192:195], v19 offset:0
  s_waitcnt lgkmcnt(8)
  v_mfma_f32_16x16x32_bf16 v[64:67], a[96:99], v[160:163], v[64:67]
  v_mfma_f32_16x16x32_bf16 v[68:71], a[100:103], v[160:163], v[68:71]
  v_mfma_f32_16x16x32_bf16 v[72:75], a[104:107], v[160:163], v[72:75]
  ds_read_b128 v[196:199], v19 offset:2048
  s_waitcnt lgkmcnt(8)
  v_mfma_f32_16x16x32_bf16 v[76:79], a[96:99], v[164:167], v[76:79]
  v_mfma_f32_16x16x32_bf16 v[80:83], a[100:103], v[164:167], v[80:83]
  v_mfma_f32_16x16x32_bf16 v[84:87], a[104:107], v[164:167], v[84:87]
  s_add_u32 s46, s46, 10240
  s_add_u32 m0, s47, 2048
  s_nop 0
  buffer_load_dwordx4 v10, s[8:11], s46 offen lds
  ds_read_b128 v[200:203], v19 offset:4096
  s_waitcnt lgkmcnt(8)
  v_mfma_f32_16x16x32_bf16 v[88:91], a[96:99], v[168:171], v[88:91]
  v_mfma_f32_16x16x32_bf16 v[92:95], a[100:103], v[168:171], v[92:95]
  v_mfma_f32_16x16x32_bf16 v[96:99], a[104:107], v[168:171], v[96:99]
  ds_read_b128 v[204:207], v19 offset:6144
  s_waitcnt lgkmcnt(8)
  v_mfma_f32_16x16x32_bf16 v[100:103], a[96:99], v[172:175], v[100:103]
  v_mfma_f32_16x16x32_bf16 v[104:107], a[100:103], v[172:175], v[104:107]
  v_mfma_f32_16x16x32_bf16 v[108:111], a[104:107], v[172:175], v[108:111]
  ds_read_b128 v[208:211], v19 offset:8192
  s_waitcnt lgkmcnt(8)
  v_mfma_f32_16x16x32_bf16 v[112:115], a[96:99], v[176:179], v[112:115]
  v_mfma_f32_16x16x32_bf16 v[116:119], a[100:103], v[176:179], v[116:119]
  v_mfma_f32_16x16x32_bf16 v[120:123], a[104:107], v[176:179], v[120:123]
  ds_read_b128 v[212:215], v19 offset:10240
  s_waitcnt lgkmcnt(8)
  v_mfma_f32_16x16x32_bf16 v[124:127], a[96:99], v[180:183], v[124:127]
  v_mfma_f32_16x16x32_bf16 v[128:131], a[100:103], v[180:183], v[128:131]
  v_mfma_f32_16x16x32_bf16 v[132:135], a[104:107], v[180:183], v[132:135]
  s_add_u32 s46, s46, 10240
  s_add_u32 m0, s47, 3072
  s_nop 0
  buffer_load_dwordx4 v10, s[8:11], s46 offen lds
  ds_read_b128 v[216:219], v19 offset:12288
  s_waitcnt lgkmcnt(8)
  v_mfma_f32_16x16x32_bf16 v[136:139], a[96:99], v[184:187], v[136:139]
  v_mfma_f32_16x16x32_bf16 v[140:143], a[100:103], v[184:187], v[140:143]
  v_mfma_f32_16x16x32_bf16 v[144:147], a[104:107], v[184:187], v[144:147]
  ds_read_b128 v[220:223], v19 offset:14336
  s_waitcnt lgkmcnt(8)
  v_mfma_f32_16x16x32_bf16 v[148:151], a[96:99], v[188:191], v[148:151]
  v_mfma_f32_16x16x32_bf16 v[152:155], a[100:103], v[188:191], v[152:155]
  v_mfma_f32_16x16x32_bf16 v[156:159], a[104:107], v[188:191], v[156:159]
  s_waitcnt vmcnt(23)
  s_barrier
  s_add_u32 s30, s30, 128
  s_add_u32 s31, s31, 1
  s_cmp_lt_u32 s31, 10
  s_cbranch_scc1 qb_262
  s_mov_b32 s31, 0
  s_add_u32 s30, s30, s25
  s_sub_u32 s30, s30, 1280
qb_262:
  s_add_u32 s32, s32, 16384
  s_cmp_lt_u32 s32, 98304
  s_cselect_b32 s32, s32, 0
  s_mul_i32 s46, s20, 40960
  s_add_u32 s46, s46, s30
  s_lshl_b32 s47, s20, 12
  s_add_u32 s47, s47, s32
  v_add_u32 v18, s33, v14
  v_add_u32 v19, s33, v15
  s_add_u32 s33, s33, 16384
  s_cmp_lt_u32 s33, 98304
  s_cselect_b32 s33, s33, 0
  ds_read_b128 v[160:163], v18 offset:0
  s_waitcnt lgkmcnt(8)
  v_mfma_f32_16x16x32_bf16 v[64:67], a[108:111], v[192:195], v[64:67]
  v_mfma_f32_16x16x32_bf16 v[68:71], a[112:115], v[192:195], v[68:71]
  v_mfma_f32_16x16x32_bf16 v[72:75], a[116:119], v[192:195], v[72:75]
  ds_read_b128 v[164:167], v18 offset:2048
  s_waitcnt lgkmcnt(8)
  v_mfma_f32_16x16x32_bf16 v[76:79], a[108:111], v[196:199], v[76:79]
  v_mfma_f32_16x16x32_bf16 v[80:83], a[112:115], v[196:199], v[80:83]
  v_mfma_f32_16x16x32_bf16 v[84:87], a[116:119], v[196:199], v[84:87]
  s_add_u32 m0, s47, 0
  s_nop 0
  buffer_load_dwordx4 v10, s[8:11], s46 offen lds
  ds_read_b128 v[168:171], v18 offset:4096
  s_waitcnt lgkmcnt(8)
  v_mfma_f32_16x16x32_bf16 v[88:91], a[108:111], v[200:203], v[88:91]
  v_mfma_f32_16x16x32_bf16 v[92:95], a[112:115], v[200:203], v[92:95]
  v_mfma_f32_16x16x32_bf16 v[96:99], a[116:119], v[200:203], v[96:99]
  ds_read_b128 v[172:175], v18 offset:6144
  s_waitcnt lgkmcnt(8)
  v_mfma_f32_16x16x32_bf16 v[100:103], a[108:111], v[204:207], v[100:103]
  v_mfma_f32_16x16x32_bf16 v[104:107], a[112:115], v[204:207], v[104:107]
  v_mfma_f32_16x16x32_bf16 v[108:111], a[116:119], v[204:207], v[108:111]
  ds_read_b128 v[176:179], v18 offset:8192
  s_waitcnt lgkmcnt(8)
  v_mfma_f32_16x16x32_bf16 v[112:115], a[108:111], v[208:211], v[112:115]
  v_mfma_f32_16x16x32_bf16 v[116:119], a[112:115], v[208:211], v[116:119]
  v_mfma_f32_16x16x32_bf16 v[120:123], a[116:119], v[208:211], v[120:123]
  ds_read_b128 v[180:183], v18 offset:10240
  s_waitcnt lgkmcnt(8)
  v_mfma_f32_16x16x32_bf16 v[124:127], a[108:111], v[212:215], v[124:127]
  v_mfma_f32_16x16x32_bf16 v[128:131], a[112:115], v[212:215], v[128:131]
  v_mfma_f32_16x16x32_bf16 v[132:135], a[116:119], v[212:215], v[132:135]
  s_add_u32 s46, s46, 10240
  s_add_u32 m0, s47, 1024
  s_nop 0
  buffer_load_dwordx4 v10, s[8:11], s46 offen lds
  ds_read_b128 v[184:187], v18 offset:12288
  s_waitcnt lgkmcnt(8)
  v_mfma_f32_16x16x32_bf16 v[136:139], a[108:111], v[216:219], v[136:139]
  v_mfma_f32_16x16x32_bf16 v[140:143], a[112:115], v[216:219], v[140:143]
  v_mfma_f32_16x16x32_bf16 v[144:147], a[116:119], v[216:219], v[144:147]
  ds_read_b128 v[188:191], v18 offset:14336
  s_waitcnt lgkmcnt(8)
  v_mfma_f32_16x16x32_bf16 v[148:151], a[108:111], v[220:223], v[148:151]
  v_mfma_f32_16x16x32_bf16 v[152:155], a[112:115], v[220:223], v[152:155]
  v_mfma_f32_16x16x32_bf16 v[156:159], a[116:119], v[220:223], v[156:159]
  ds_read_b128 v[192:195], v19 offset:0
  s_waitcnt lgkmcnt(8)
  v_mfma_f32_16x16x32_bf16 v[64:67], a[120:123], v[160:163], v[64:67]
  v_mfma_f32_16x16x32_bf16 v[68:71], a[124:127], v[160:163], v[68:71]
  v_mfma_f32_16x16x32_bf16 v[72:75], a[128:131], v[160:163], v[72:75]
  ds_read_b128 v[196:199], v19 offset:2048
  s_waitcnt lgkmcnt(8)
  v_mfma_f32_16x16x32_bf16 v[76:79], a[120:123], v[164:167], v[76:79]
  v_mfma_f32_16x16x32_bf16 v[80:83], a[124:127], v[164:167], v[80:83]
  v_mfma_f32_16x16x32_bf16 v[84:87], a[128:131], v[164:167], v[84:87]
  s_add_u32 s46, s46, 10240
  s_add_u32 m0, s47, 2048
  s_nop 0
  buffer_load_dwordx4 v10, s[8:11], s46 offen lds
  ds_read_b128 v[200:203], v19 offset:4096
  s_waitcnt lgkmcnt(8)
  v_mfma_f32_16x16x32_bf16 v[88:91], a[120:123], v[168:171], v[88:91]
  v_mfma_f32_16x16x32_bf16 v[92:95], a[124:127], v[168:171], v[92:95]
  v_mfma_f32_16x16x32_bf16 v[96:99], a[128:131], v[168:171], v[96:99]
  ds_read_b128 v[204:207], v19 offset:6144
  s_waitcnt lgkmcnt(8)
  v_mfma_f32_16x16x32_bf16 v[100:103], a[120:123], v[172:175], v[100:103]
  v_mfma_f32_16x16x32_bf16 v[104:107], a[124:127], v[172:175], v[104:107]
  v_mfma_f32_16x16x32_bf16 v[108:111], a[128:131], v[172:175], v[108:111]
  ds_read_b128 v[208:211], v19 offset:8192
  s_waitcnt lgkmcnt(8)
  v_mfma_f32_16x16x32_bf16 v[112:115], a[120:123], v[176:179], v[112:115]
  v_mfma_f32_16x16x32_bf16 v[116:119], a[124:127], v[176:179], v[116:119]
  v_mfma_f32_16x16x32_bf16 v[120:123], a[128:131], v[176:179], v[120:123]
  ds_read_b128 v[212:215], v19 offset:10240
  s_waitcnt lgkmcnt(8)
  v_mfma_f32_16x16x32_bf16 v[124:127], a[120:123], v[180:183], v[124:127]
  v_mfma_f32_16x16x32_bf16 v[128:131], a[124:127], v[180:183], v[128:131]
  v_mfma_f32_16x16x32_bf16 v[132:135], a[128:131], v[180:183], v[132:135]
  s_add_u32 s46, s46, 10240
  s_add_u32 m0, s47, 3072
  s_nop 0
  buffer_load_dwordx4 v10, s[8:11], s46 offen lds
  ds_read_b128 v[216:219], v19 offset:12288
  s_waitcnt lgkmcnt(8)
  v_mfma_f32_16x16x32_bf16 v[136:139], a[120:123], v[184:187], v[136:139]
  v_mfma_f32_16x16x32_bf16 v[140:143], a[124:127], v[184:187], v[140:143]
  v_mfma_f32_16x16x32_bf16 v[144:147], a[128:131], v[184:187], v[144:147]
  ds_read_b128 v[220:223], v19 offset:14336
  s_waitcnt lgkmcnt(8)
  v_mfma_f32_16x16x32_bf16 v[148:151], a[120:123], v[188:191], v[148:151]
  v_mfma_f32_16x16x32_bf16 v[152:155], a[124:127], v[188:191], v[152:155]
  v_mfma_f32_16x16x32_bf16 v[156:159], a[128:131], v[188:191], v[156:159]
  s_waitcnt vmcnt(6)
  s_barrier
  s_cmp_eq_u32 s48, 0x80000000
  s_cbranch_scc1 qb_263
  s_cmp_lg_u32 s20, 0
  s_cbranch_scc1 af_264
  v_mov_b32 v4, 0
  v_mov_b32 v5, 1
  s_mov_b64 exec, 1
  buffer_atomic_add v5, v4, s[72:75], s61 offen sc1
  s_mov_b64 exec, -1
  s_nop 1
af_264:
qb_263:
  s_add_u32 s30, s30, 128
  s_add_u32 s31, s31, 1
  s_cmp_lt_u32 s31, 10
  s_cbranch_scc1 qb_265
  s_mov_b32 s31, 0
  s_add_u32 s30, s30, s25
  s_sub_u32 s30, s30, 1280
qb_265:
  s_add_u32 s32, s32, 16384
  s_cmp_lt_u32 s32, 98304
  s_cselect_b32 s32, s32, 0
  s_mul_i32 s46, s20, 40960
  s_add_u32 s46, s46, s30
  s_lshl_b32 s47, s20, 12
  s_add_u32 s47, s47, s32
  v_add_u32 v18, s33, v14
  v_add_u32 v19, s33, v15
  s_add_u32 s33, s33, 16384
  s_cmp_lt_u32 s33, 98304
  s_cselect_b32 s33, s33, 0
  ds_read_b128 v[160:163], v18 offset:0
  s_waitcnt lgkmcnt(8)
  v_mfma_f32_16x16x32_bf16 v[64:67], a[132:135], v[192:195], v[64:67]
  v_mfma_f32_16x16x32_bf16 v[68:71], a[136:139], v[192:195], v[68:71]
  v_mfma_f32_16x16x32_bf16 v[72:75], a[140:143], v[192:195], v[72:75]
  ds_read_b128 v[164:167], v18 offset:2048
  s_waitcnt lgkmcnt(8)
  v_mfma_f32_16x16x32_bf16 v[76:79], a[132:135], v[196:199], v[76:79]
  v_mfma_f32_16x16x32_bf16 v[80:83], a[136:139], v[196:199], v[80:83]
  v_mfma_f32_16x16x32_bf16 v[84:87], a[140:143], v[196:199], v[84:87]
  s_add_u32 m0, s47, 0
  s_nop 0
  buffer_load_dwordx4 v10, s[8:11], s46 offen lds
  ds_read_b128 v[168:171], v18 offset:4096
  s_waitcnt lgkmcnt(8)
  v_mfma_f32_16x16x32_bf16 v[88:91], a[132:135], v[200:203], v[88:91]
  v_mfma_f32_16x16x32_bf16 v[92:95], a[136:139], v[200:203], v[92:95]
  v_mfma_f32_16x16x32_bf16 v[96:99], a[140:143], v[200:203], v[96:99]
  ds_read_b128 v[172:175], v18 offset:6144
  s_waitcnt lgkmcnt(8)
  v_mfma_f32_16x16x32_bf16 v[100:103], a[132:135], v[204:207], v[100:103]
  v_mfma_f32_16x16x32_bf16 v[104:107], a[136:139], v[204:207], v[104:107]
  v_mfma_f32_16x16x32_bf16 v[108:111], a[140:143], v[204:207], v[108:111]
  ds_read_b128 v[176:179], v18 offset:8192
  s_waitcnt lgkmcnt(8)
  v_mfma_f32_16x16x32_bf16 v[112:115], a[132:135], v[208:211], v[112:115]
  v_mfma_f32_16x16x32_bf16 v[116:119], a[136:139], v[208:211], v[116:119]
  v_mfma_f32_16x16x32_bf16 v[120:123], a[140:143], v[208:211], v[120:123]
  ds_read_b128 v[180:183], v18 offset:10240
  s_waitcnt lgkmcnt(8)
  v_mfma_f32_16x16x32_bf16 v[124:127], a[132:135], v[212:215], v[124:127]
  v_mfma_f32_16x16x32_bf16 v[128:131], a[136:139], v[212:215], v[128:131]
  v_mfma_f32_16x16x32_bf16 v[132:135], a[140:143], v[212:215], v[132:135]
  s_add_u32 s46, s46, 10240
  s_add_u32 m0, s47, 1024
  s_nop 0
  buffer_load_dwordx4 v10, s[8:11], s46 offen lds
  ds_read_b128 v[184:187], v18 offset:12288
  s_waitcnt lgkmcnt(8)
  v_mfma_f32_16x16x32_bf16 v[136:139], a[132:135], v[216:219], v[136:139]
  v_mfma_f32_16x16x32_bf16 v[140:143], a[136:139], v[216:219], v[140:143]
  v_mfma_f32_16x16x32_bf16 v[144:147], a[140:143], v[216:219], v[144:147]
  ds_read_b128 v[188:191], v18 offset:14336
  s_waitcnt lgkmcnt(8)
  v_mfma_f32_16x16x32_bf16 v[148:151], a[132:135], v[220:223], v[148:151]
  v_mfma_f32_16x16x32_bf16 v[152:155], a[136:139], v[220:223], v[152:155]
  v_mfma_f32_16x16x32_bf16 v[156:159], a[140:143], v[220:223], v[156:159]
  ds_read_b128 v[192:195], v19 offset:0
  s_waitcnt lgkmcnt(8)
  v_mfma_f32_16x16x32_bf16 v[64:67], a[144:147], v[160:163], v[64:67]
  v_mfma_f32_16x16x32_bf16 v[68:71], a[148:151], v[160:163], v[68:71]
  v_mfma_f32_16x16x32_bf16 v[72:75], a[152:155], v[160:163], v[72:75]
  ds_read_b128 v[196:199], v19 offset:2048
  s_waitcnt lgkmcnt(8)
  v_mfma_f32_16x16x32_bf16 v[76:79], a[144:147], v[164:167], v[76:79]
  v_mfma_f32_16x16x32_bf16 v[80:83], a[148:151], v[164:167], v[80:83]
  v_mfma_f32_16x16x32_bf16 v[84:87], a[152:155], v[164:167], v[84:87]
  s_add_u32 s46, s46, 10240
  s_add_u32 m0, s47, 2048
  s_nop 0
  buffer_load_dwordx4 v10, s[8:11], s46 offen lds
  ds_read_b128 v[200:203], v19 offset:4096
  s_waitcnt lgkmcnt(8)
  v_mfma_f32_16x16x32_bf16 v[88:91], a[144:147], v[168:171], v[88:91]
  v_mfma_f32_16x16x32_bf16 v[92:95], a[148:151], v[168:171], v[92:95]
  v_mfma_f32_16x16x32_bf16 v[96:99], a[152:155], v[168:171], v[96:99]
  ds_read_b128 v[204:207], v19 offset:6144
  s_waitcnt lgkmcnt(8)
  v_mfma_f32_16x16x32_bf16 v[100:103], a[144:147], v[172:175], v[100:103]
  v_mfma_f32_16x16x32_bf16 v[104:107], a[148:151], v[172:175], v[104:107]
  v_mfma_f32_16x16x32_bf16 v[108:111], a[152:155], v[172:175], v[108:111]
  ds_read_b128 v[208:211], v19 offset:8192
  s_waitcnt lgkmcnt(8)
  v_mfma_f32_16x16x32_bf16 v[112:115], a[144:147], v[176:179], v[112:115]
  v_mfma_f32_16x16x32_bf16 v[116:119], a[148:151], v[176:179], v[116:119]
  v_mfma_f32_16x16x32_bf16 v[120:123], a[152:155], v[176:179], v[120:123]
  ds_read_b128 v[212:215], v19 offset:10240
  s_waitcnt lgkmcnt(8)
  v_mfma_f32_16x16x32_bf16 v[124:127], a[144:147], v[180:183], v[124:127]
  v_mfma_f32_16x16x32_bf16 v[128:131], a[148:151], v[180:183], v[128:131]
  v_mfma_f32_16x16x32_bf16 v[132:135], a[152:155], v[180:183], v[132:135]
  s_add_u32 s46, s46, 10240
  s_add_u32 m0, s47, 3072
  s_nop 0
  buffer_load_dwordx4 v10, s[8:11], s46 offen lds
  ds_read_b128 v[216:219], v19 offset:12288
  s_waitcnt lgkmcnt(8)
  v_mfma_f32_16x16x32_bf16 v[136:139], a[144:147], v[184:187], v[136:139]
  v_mfma_f32_16x16x32_bf16 v[140:143], a[148:151], v[184:187], v[140:143]
  v_mfma_f32_16x16x32_bf16 v[144:147], a[152:155], v[184:187], v[144:147]
  ds_read_b128 v[220:223], v19 offset:14336
  s_waitcnt lgkmcnt(8)
  v_mfma_f32_16x16x32_bf16 v[148:151], a[144:147], v[188:191], v[148:151]
  v_mfma_f32_16x16x32_bf16 v[152:155], a[148:151], v[188:191], v[152:155]
  v_mfma_f32_16x16x32_bf16 v[156:159], a[152:155], v[188:191], v[156:159]
  s_waitcnt vmcnt(15)
  s_barrier
  s_add_u32 s30, s30, 128
  s_add_u32 s31, s31, 1
  s_cmp_lt_u32 s31, 10
  s_cbranch_scc1 qb_266
  s_mov_b32 s31, 0
  s_add_u32 s30, s30, s25
  s_sub_u32 s30, s30, 1280
qb_266:
  s_add_u32 s32, s32, 16384
  s_cmp_lt_u32 s32, 98304
  s_cselect_b32 s32, s32, 0
  s_mul_i32 s46, s20, 40960
  s_add_u32 s46, s46, s30
  s_lshl_b32 s47, s20, 12
  s_add_u32 s47, s47, s32
  v_add_u32 v18, s33, v14
  v_add_u32 v19, s33, v15
  s_add_u32 s33, s33, 16384
  s_cmp_lt_u32 s33, 98304
  s_cselect_b32 s33, s33, 0
  ds_read_b128 v[160:163], v18 offset:0
  s_waitcnt lgkmcnt(8)
  v_mfma_f32_16x16x32_bf16 v[64:67], a[156:159], v[192:195], v[64:67]
  v_mfma_f32_16x16x32_bf16 v[68:71], a[160:163], v[192:195], v[68:71]
  v_mfma_f32_16x16x32_bf16 v[72:75], a[164:167], v[192:195], v[72:75]
  ds_read_b128 v[164:167], v18 offset:2048
  s_waitcnt lgkmcnt(8)
  v_mfma_f32_16x16x32_bf16 v[76:79], a[156:159], v[196:199], v[76:79]
  v_mfma_f32_16x16x32_bf16 v[80:83], a[160:163], v[196:199], v[80:83]
  v_mfma_f32_16x16x32_bf16 v[84:87], a[164:167], v[196:199], v[84:87]
  s_add_u32 m0, s47, 0
  s_nop 0
  buffer_load_dwordx4 v10, s[8:11], s46 offen lds
  ds_read_b128 v[168:171], v18 offset:4096
  s_waitcnt lgkmcnt(8)
  v_mfma_f32_16x16x32_bf16 v[88:91], a[156:159], v[200:203], v[88:91]
  v_mfma_f32_16x16x32_bf16 v[92:95], a[160:163], v[200:203], v[92:95]
  v_mfma_f32_16x16x32_bf16 v[96:99], a[164:167], v[200:203], v[96:99]
  ds_read_b128 v[172:175], v18 offset:6144
  s_waitcnt lgkmcnt(8)
  v_mfma_f32_16x16x32_bf16 v[100:103], a[156:159], v[204:207], v[100:103]
  v_mfma_f32_16x16x32_bf16 v[104:107], a[160:163], v[204:207], v[104:107]
  v_mfma_f32_16x16x32_bf16 v[108:111], a[164:167], v[204:207], v[108:111]
  ds_read_b128 v[176:179], v18 offset:8192
  s_waitcnt lgkmcnt(8)
  v_mfma_f32_16x16x32_bf16 v[112:115], a[156:159], v[208:211], v[112:115]
  v_mfma_f32_16x16x32_bf16 v[116:119], a[160:163], v[208:211], v[116:119]
  v_mfma_f32_16x16x32_bf16 v[120:123], a[164:167], v[208:211], v[120:123]
  ds_read_b128 v[180:183], v18 offset:10240
  s_waitcnt lgkmcnt(8)
  v_mfma_f32_16x16x32_bf16 v[124:127], a[156:159], v[212:215], v[124:127]
  v_mfma_f32_16x16x32_bf16 v[128:131], a[160:163], v[212:215], v[128:131]
  v_mfma_f32_16x16x32_bf16 v[132:135], a[164:167], v[212:215], v[132:135]
  s_add_u32 s46, s46, 10240
  s_add_u32 m0, s47, 1024
  s_nop 0
  buffer_load_dwordx4 v10, s[8:11], s46 offen lds
  ds_read_b128 v[184:187], v18 offset:12288
  s_waitcnt lgkmcnt(8)
  v_mfma_f32_16x16x32_bf16 v[136:139], a[156:159], v[216:219], v[136:139]
  v_mfma_f32_16x16x32_bf16 v[140:143], a[160:163], v[216:219], v[140:143]
  v_mfma_f32_16x16x32_bf16 v[144:147], a[164:167], v[216:219], v[144:147]
  ds_read_b128 v[188:191], v18 offset:14336
  s_waitcnt lgkmcnt(8)
  v_mfma_f32_16x16x32_bf16 v[148:151], a[156:159], v[220:223], v[148:151]
  v_mfma_f32_16x16x32_bf16 v[152:155], a[160:163], v[220:223], v[152:155]
  v_mfma_f32_16x16x32_bf16 v[156:159], a[164:167], v[220:223], v[156:159]
  ds_read_b128 v[192:195], v19 offset:0
  s_waitcnt lgkmcnt(8)
  v_mfma_f32_16x16x32_bf16 v[64:67], a[168:171], v[160:163], v[64:67]
  v_mfma_f32_16x16x32_bf16 v[68:71], a[172:175], v[160:163], v[68:71]
  v_mfma_f32_16x16x32_bf16 v[72:75], a[176:179], v[160:163], v[72:75]
  ds_read_b128 v[196:199], v19 offset:2048
  s_waitcnt lgkmcnt(8)
  v_mfma_f32_16x16x32_bf16 v[76:79], a[168:171], v[164:167], v[76:79]
  v_mfma_f32_16x16x32_bf16 v[80:83], a[172:175], v[164:167], v[80:83]
  v_mfma_f32_16x16x32_bf16 v[84:87], a[176:179], v[164:167], v[84:87]
  s_add_u32 s46, s46, 10240
  s_add_u32 m0, s47, 2048
  s_nop 0
  buffer_load_dwordx4 v10, s[8:11], s46 offen lds
  ds_read_b128 v[200:203], v19 offset:4096
  s_waitcnt lgkmcnt(8)
  v_mfma_f32_16x16x32_bf16 v[88:91], a[168:171], v[168:171], v[88:91]
  v_mfma_f32_16x16x32_bf16 v[92:95], a[172:175], v[168:171], v[92:95]
  v_mfma_f32_16x16x32_bf16 v[96:99], a[176:179], v[168:171], v[96:99]
  ds_read_b128 v[204:207], v19 offset:6144
  s_waitcnt lgkmcnt(8)
  v_mfma_f32_16x16x32_bf16 v[100:103], a[168:171], v[172:175], v[100:103]
  v_mfma_f32_16x16x32_bf16 v[104:107], a[172:175], v[172:175], v[104:107]
  v_mfma_f32_16x16x32_bf16 v[108:111], a[176:179], v[172:175], v[108:111]
  ds_read_b128 v[208:211], v19 offset:8192
  s_waitcnt lgkmcnt(8)
  v_mfma_f32_16x16x32_bf16 v[112:115], a[168:171], v[176:179], v[112:115]
  v_mfma_f32_16x16x32_bf16 v[116:119], a[172:175], v[176:179], v[116:119]
  v_mfma_f32_16x16x32_bf16 v[120:123], a[176:179], v[176:179], v[120:123]
  ds_read_b128 v[212:215], v19 offset:10240
  s_waitcnt lgkmcnt(8)
  v_mfma_f32_16x16x32_bf16 v[124:127], a[168:171], v[180:183], v[124:127]
  v_mfma_f32_16x16x32_bf16 v[128:131], a[172:175], v[180:183], v[128:131]
  v_mfma_f32_16x16x32_bf16 v[132:135], a[176:179], v[180:183], v[132:135]
  s_add_u32 s46, s46, 10240
  s_add_u32 m0, s47, 3072
  s_nop 0
  buffer_load_dwordx4 v10, s[8:11], s46 offen lds
  ds_read_b128 v[216:219], v19 offset:12288
  s_waitcnt lgkmcnt(8)
  v_mfma_f32_16x16x32_bf16 v[136:139], a[168:171], v[184:187], v[136:139]
  v_mfma_f32_16x16x32_bf16 v[140:143], a[172:175], v[184:187], v[140:143]
  v_mfma_f32_16x16x32_bf16 v[144:147], a[176:179], v[184:187], v[144:147]
  ds_read_b128 v[220:223], v19 offset:14336
  s_waitcnt lgkmcnt(8)
  v_mfma_f32_16x16x32_bf16 v[148:151], a[168:171], v[188:191], v[148:151]
  v_mfma_f32_16x16x32_bf16 v[152:155], a[172:175], v[188:191], v[152:155]
  v_mfma_f32_16x16x32_bf16 v[156:159], a[176:179], v[188:191], v[156:159]
  s_waitcnt vmcnt(12)
  s_barrier
  s_add_u32 s30, s30, 128
  s_add_u32 s31, s31, 1
  s_cmp_lt_u32 s31, 10
  s_cbranch_scc1 qb_267
  s_mov_b32 s31, 0
  s_add_u32 s30, s30, s25
  s_sub_u32 s30, s30, 1280
qb_267:
  s_add_u32 s32, s32, 16384
  s_cmp_lt_u32 s32, 98304
  s_cselect_b32 s32, s32, 0
  s_mul_i32 s46, s20, 40960
  s_add_u32 s46, s46, s30
  s_lshl_b32 s47, s20, 12
  s_add_u32 s47, s47, s32
  v_add_u32 v18, s33, v14
  v_add_u32 v19, s33, v15
  s_add_u32 s33, s33, 16384
  s_cmp_lt_u32 s33, 98304
  s_cselect_b32 s33, s33, 0
  ds_read_b128 v[160:163], v18 offset:0
  s_waitcnt lgkmcnt(8)
  v_mfma_f32_16x16x32_bf16 v[64:67], a[180:183], v[192:195], v[64:67]
  v_mfma_f32_16x16x32_bf16 v[68:71], a[184:187], v[192:195], v[68:71]
  v_mfma_f32_16x16x32_bf16 v[72:75], a[188:191], v[192:195], v[72:75]
  ds_read_b128 v[164:167], v18 offset:2048
  s_waitcnt lgkmcnt(8)
  v_mfma_f32_16x16x32_bf16 v[76:79], a[180:183], v[196:199], v[76:79]
  v_mfma_f32_16x16x32_bf16 v[80:83], a[184:187], v[196:199], v[80:83]
  v_mfma_f32_16x16x32_bf16 v[84:87], a[188:191], v[196:199], v[84:87]
  s_add_u32 m0, s47, 0
  s_nop 0
  buffer_load_dwordx4 v10, s[8:11], s46 offen lds
  ds_read_b128 v[168:171], v18 offset:4096
  s_waitcnt lgkmcnt(8)
  v_mfma_f32_16x16x32_bf16 v[88:91], a[180:183], v[200:203], v[88:91]
  v_mfma_f32_16x16x32_bf16 v[92:95], a[184:187], v[200:203], v[92:95]
  v_mfma_f32_16x16x32_bf16 v[96:99], a[188:191], v[200:203], v[96:99]
  ds_read_b128 v[172:175], v18 offset:6144
  s_waitcnt lgkmcnt(8)
  v_mfma_f32_16x16x32_bf16 v[100:103], a[180:183], v[204:207], v[100:103]
  v_mfma_f32_16x16x32_bf16 v[104:107], a[184:187], v[204:207], v[104:107]
  v_mfma_f32_16x16x32_bf16 v[108:111], a[188:191], v[204:207], v[108:111]
  ds_read_b128 v[176:179], v18 offset:8192
  s_waitcnt lgkmcnt(8)
  v_mfma_f32_16x16x32_bf16 v[112:115], a[180:183], v[208:211], v[112:115]
  v_mfma_f32_16x16x32_bf16 v[116:119], a[184:187], v[208:211], v[116:119]
  v_mfma_f32_16x16x32_bf16 v[120:123], a[188:191], v[208:211], v[120:123]
  ds_read_b128 v[180:183], v18 offset:10240
  s_waitcnt lgkmcnt(8)
  v_mfma_f32_16x16x32_bf16 v[124:127], a[180:183], v[212:215], v[124:127]
  v_mfma_f32_16x16x32_bf16 v[128:131], a[184:187], v[212:215], v[128:131]
  v_mfma_f32_16x16x32_bf16 v[132:135], a[188:191], v[212:215], v[132:135]
  s_add_u32 s46, s46, 10240
  s_add_u32 m0, s47, 1024
  s_nop 0
  buffer_load_dwordx4 v10, s[8:11], s46 offen lds
  ds_read_b128 v[184:187], v18 offset:12288
  s_waitcnt lgkmcnt(8)
  v_mfma_f32_16x16x32_bf16 v[136:139], a[180:183], v[216:219], v[136:139]
  v_mfma_f32_16x16x32_bf16 v[140:143], a[184:187], v[216:219], v[140:143]
  v_mfma_f32_16x16x32_bf16 v[144:147], a[188:191], v[216:219], v[144:147]
  ds_read_b128 v[188:191], v18 offset:14336
  s_waitcnt lgkmcnt(8)
  v_mfma_f32_16x16x32_bf16 v[148:151], a[180:183], v[220:223], v[148:151]
  v_mfma_f32_16x16x32_bf16 v[152:155], a[184:187], v[220:223], v[152:155]
  v_mfma_f32_16x16x32_bf16 v[156:159], a[188:191], v[220:223], v[156:159]
  ds_read_b128 v[192:195], v19 offset:0
  s_waitcnt lgkmcnt(8)
  v_mfma_f32_16x16x32_bf16 v[64:67], a[192:195], v[160:163], v[64:67]
  v_mfma_f32_16x16x32_bf16 v[68:71], a[196:199], v[160:163], v[68:71]
  v_mfma_f32_16x16x32_bf16 v[72:75], a[200:203], v[160:163], v[72:75]
  ds_read_b128 v[196:199], v19 offset:2048
  s_waitcnt lgkmcnt(8)
  v_mfma_f32_16x16x32_bf16 v[76:79], a[192:195], v[164:167], v[76:79]
  v_mfma_f32_16x16x32_bf16 v[80:83], a[196:199], v[164:167], v[80:83]
  v_mfma_f32_16x16x32_bf16 v[84:87], a[200:203], v[164:167], v[84:87]
  s_add_u32 s46, s46, 10240
  s_add_u32 m0, s47, 2048
  s_nop 0
  buffer_load_dwordx4 v10, s[8:11], s46 offen lds
  ds_read_b128 v[200:203], v19 offset:4096
  s_waitcnt lgkmcnt(8)
  v_mfma_f32_16x16x32_bf16 v[88:91], a[192:195], v[168:171], v[88:91]
  v_mfma_f32_16x16x32_bf16 v[92:95], a[196:199], v[168:171], v[92:95]
  v_mfma_f32_16x16x32_bf16 v[96:99], a[200:203], v[168:171], v[96:99]
  ds_read_b128 v[204:207], v19 offset:6144
  s_waitcnt lgkmcnt(8)
  v_mfma_f32_16x16x32_bf16 v[100:103], a[192:195], v[172:175], v[100:103]
  v_mfma_f32_16x16x32_bf16 v[104:107], a[196:199], v[172:175], v[104:107]
  v_mfma_f32_16x16x32_bf16 v[108:111], a[200:203], v[172:175], v[108:111]
  ds_read_b128 v[208:211], v19 offset:8192
  s_waitcnt lgkmcnt(8)
  v_mfma_f32_16x16x32_bf16 v[112:115], a[192:195], v[176:179], v[112:115]
  v_mfma_f32_16x16x32_bf16 v[116:119], a[196:199], v[176:179], v[116:119]
  v_mfma_f32_16x16x32_bf16 v[120:123], a[200:203], v[176:179], v[120:123]
  ds_read_b128 v[212:215], v19 offset:10240
  s_waitcnt lgkmcnt(8)
  v_mfma_f32_16x16x32_bf16 v[124:127], a[192:195], v[180:183], v[124:127]
  v_mfma_f32_16x16x32_bf16 v[128:131], a[196:199], v[180:183], v[128:131]
  v_mfma_f32_16x16x32_bf16 v[132:135], a[200:203], v[180:183], v[132:135]
  s_add_u32 s46, s46, 10240
  s_add_u32 m0, s47, 3072
  s_nop 0
  buffer_load_dwordx4 v10, s[8:11], s46 offen lds
  ds_read_b128 v[216:219], v19 offset:12288
  s_waitcnt lgkmcnt(8)
  v_mfma_f32_16x16x32_bf16 v[136:139], a[192:195], v[184:187], v[136:139]
  v_mfma_f32_16x16x32_bf16 v[140:143], a[196:199], v[184:187], v[140:143]
  v_mfma_f32_16x16x32_bf16 v[144:147], a[200:203], v[184:187], v[144:147]
  ds_read_b128 v[220:223], v19 offset:14336
  s_waitcnt lgkmcnt(8)
  v_mfma_f32_16x16x32_bf16 v[148:151], a[192:195], v[188:191], v[148:151]
  v_mfma_f32_16x16x32_bf16 v[152:155], a[196:199], v[188:191], v[152:155]
  v_mfma_f32_16x16x32_bf16 v[156:159], a[200:203], v[188:191], v[156:159]
  s_waitcnt vmcnt(12)
  s_barrier
  s_add_u32 s30, s30, 128
  s_add_u32 s31, s31, 1
  s_cmp_lt_u32 s31, 10
  s_cbranch_scc1 qb_268
  s_mov_b32 s31, 0
  s_add_u32 s30, s30, s25
  s_sub_u32 s30, s30, 1280
qb_268:
  s_add_u32 s32, s32, 16384
  s_cmp_lt_u32 s32, 98304
  s_cselect_b32 s32, s32, 0
  s_mul_i32 s46, s20, 40960
  s_add_u32 s46, s46, s30
  s_lshl_b32 s47, s20, 12
  s_add_u32 s47, s47, s32
  v_add_u32 v18, s33, v14
  v_add_u32 v19, s33, v15
  s_add_u32 s33, s33, 16384
  s_cmp_lt_u32 s33, 98304
  s_cselect_b32 s33, s33, 0
  ds_read_b128 v[160:163], v18 offset:0
  s_waitcnt lgkmcnt(8)
  v_mfma_f32_16x16x32_bf16 v[64:67], a[204:207], v[192:195], v[64:67]
  v_mfma_f32_16x16x32_bf16 v[68:71], a[208:211], v[192:195], v[68:71]
  v_mfma_f32_16x16x32_bf16 v[72:75], a[212:215], v[192:195], v[72:75]
  ds_read_b128 v[164:167], v18 offset:2048
  s_waitcnt lgkmcnt(8)
  v_mfma_f32_16x16x32_bf16 v[76:79], a[204:207], v[196:199], v[76:79]
  v_mfma_f32_16x16x32_bf16 v[80:83], a[208:211], v[196:199], v[80:83]
  v_mfma_f32_16x16x32_bf16 v[84:87], a[212:215], v[196:199], v[84:87]
  s_add_u32 m0, s47, 0
  s_nop 0
  buffer_load_dwordx4 v10, s[8:11], s46 offen lds
  ds_read_b128 v[168:171], v18 offset:4096
  s_waitcnt lgkmcnt(8)
  v_mfma_f32_16x16x32_bf16 v[88:91], a[204:207], v[200:203], v[88:91]
  v_mfma_f32_16x16x32_bf16 v[92:95], a[208:211], v[200:203], v[92:95]
  v_mfma_f32_16x16x32_bf16 v[96:99], a[212:215], v[200:203], v[96:99]
  ds_read_b128 v[172:175], v18 offset:6144
  s_waitcnt lgkmcnt(8)
  v_mfma_f32_16x16x32_bf16 v[100:103], a[204:207], v[204:207], v[100:103]
  v_mfma_f32_16x16x32_bf16 v[104:107], a[208:211], v[204:207], v[104:107]
  v_mfma_f32_16x16x32_bf16 v[108:111], a[212:215], v[204:207], v[108:111]
  ds_read_b128 v[176:179], v18 offset:8192
  s_waitcnt lgkmcnt(8)
  v_mfma_f32_16x16x32_bf16 v[112:115], a[204:207], v[208:211], v[112:115]
  v_mfma_f32_16x16x32_bf16 v[116:119], a[208:211], v[208:211], v[116:119]
  v_mfma_f32_16x16x32_bf16 v[120:123], a[212:215], v[208:211], v[120:123]
  ds_read_b128 v[180:183], v18 offset:10240
  s_waitcnt lgkmcnt(8)
  v_mfma_f32_16x16x32_bf16 v[124:127], a[204:207], v[212:215], v[124:127]
  v_mfma_f32_16x16x32_bf16 v[128:131], a[208:211], v[212:215], v[128:131]
  v_mfma_f32_16x16x32_bf16 v[132:135], a[212:215], v[212:215], v[132:135]
  s_add_u32 s46, s46, 10240
  s_add_u32 m0, s47, 1024
  s_nop 0
  buffer_load_dwordx4 v10, s[8:11], s46 offen lds
  ds_read_b128 v[184:187], v18 offset:12288
  s_waitcnt lgkmcnt(8)
  v_mfma_f32_16x16x32_bf16 v[136:139], a[204:207], v[216:219], v[136:139]
  v_mfma_f32_16x16x32_bf16 v[140:143], a[208:211], v[216:219], v[140:143]
  v_mfma_f32_16x16x32_bf16 v[144:147], a[212:215], v[216:219], v[144:147]
  ds_read_b128 v[188:191], v18 offset:14336
  s_waitcnt lgkmcnt(8)
  v_mfma_f32_16x16x32_bf16 v[148:151], a[204:207], v[220:223], v[148:151]
  v_mfma_f32_16x16x32_bf16 v[152:155], a[208:211], v[220:223], v[152:155]
  v_mfma_f32_16x16x32_bf16 v[156:159], a[212:215], v[220:223], v[156:159]
  ds_read_b128 v[192:195], v19 offset:0
  s_waitcnt lgkmcnt(8)
  v_mfma_f32_16x16x32_bf16 v[64:67], a[216:219], v[160:163], v[64:67]
  v_mfma_f32_16x16x32_bf16 v[68:71], a[220:223], v[160:163], v[68:71]
  v_mfma_f32_16x16x32_bf16 v[72:75], a[224:227], v[160:163], v[72:75]
  ds_read_b128 v[196:199], v19 offset:2048
  s_waitcnt lgkmcnt(8)
  v_mfma_f32_16x16x32_bf16 v[76:79], a[216:219], v[164:167], v[76:79]
  v_mfma_f32_16x16x32_bf16 v[80:83], a[220:223], v[164:167], v[80:83]
  v_mfma_f32_16x16x32_bf16 v[84:87], a[224:227], v[164:167], v[84:87]
  s_add_u32 s46, s46, 10240
  s_add_u32 m0, s47, 2048
  s_nop 0
  buffer_load_dwordx4 v10, s[8:11], s46 offen lds
  ds_read_b128 v[200:203], v19 offset:4096
  s_waitcnt lgkmcnt(8)
  v_mfma_f32_16x16x32_bf16 v[88:91], a[216:219], v[168:171], v[88:91]
  v_mfma_f32_16x16x32_bf16 v[92:95], a[220:223], v[168:171], v[92:95]
  v_mfma_f32_16x16x32_bf16 v[96:99], a[224:227], v[168:171], v[96:99]
  ds_read_b128 v[204:207], v19 offset:6144
  s_waitcnt lgkmcnt(8)
  v_mfma_f32_16x16x32_bf16 v[100:103], a[216:219], v[172:175], v[100:103]
  v_mfma_f32_16x16x32_bf16 v[104:107], a[220:223], v[172:175], v[104:107]
  v_mfma_f32_16x16x32_bf16 v[108:111], a[224:227], v[172:175], v[108:111]
  ds_read_b128 v[208:211], v19 offset:8192
  s_waitcnt lgkmcnt(8)
  v_mfma_f32_16x16x32_bf16 v[112:115], a[216:219], v[176:179], v[112:115]
  v_mfma_f32_16x16x32_bf16 v[116:119], a[220:223], v[176:179], v[116:119]
  v_mfma_f32_16x16x32_bf16 v[120:123], a[224:227], v[176:179], v[120:123]
  ds_read_b128 v[212:215], v19 offset:10240
  s_waitcnt lgkmcnt(8)
  v_mfma_f32_16x16x32_bf16 v[124:127], a[216:219], v[180:183], v[124:127]
  v_mfma_f32_16x16x32_bf16 v[128:131], a[220:223], v[180:183], v[128:131]
  v_mfma_f32_16x16x32_bf16 v[132:135], a[224:227], v[180:183], v[132:135]
  s_add_u32 s46, s46, 10240
  s_add_u32 m0, s47, 3072
  s_nop 0
  buffer_load_dwordx4 v10, s[8:11], s46 offen lds
  ds_read_b128 v[216:219], v19 offset:12288
  s_waitcnt lgkmcnt(8)
  v_mfma_f32_16x16x32_bf16 v[136:139], a[216:219], v[184:187], v[136:139]
  v_mfma_f32_16x16x32_bf16 v[140:143], a[220:223], v[184:187], v[140:143]
  v_mfma_f32_16x16x32_bf16 v[144:147], a[224:227], v[184:187], v[144:147]
  ds_read_b128 v[220:223], v19 offset:14336
  s_waitcnt lgkmcnt(8)
  v_mfma_f32_16x16x32_bf16 v[148:151], a[216:219], v[188:191], v[148:151]
  v_mfma_f32_16x16x32_bf16 v[152:155], a[220:223], v[188:191], v[152:155]
  v_mfma_f32_16x16x32_bf16 v[156:159], a[224:227], v[188:191], v[156:159]
  s_waitcnt vmcnt(12)
  s_barrier
  s_add_u32 s30, s30, 128
  s_add_u32 s31, s31, 1
  s_cmp_lt_u32 s31, 10
  s_cbranch_scc1 qb_269
  s_mov_b32 s31, 0
  s_add_u32 s30, s30, s25
  s_sub_u32 s30, s30, 1280
qb_269:
  s_add_u32 s32, s32, 16384
  s_cmp_lt_u32 s32, 98304
  s_cselect_b32 s32, s32, 0
  s_mul_i32 s46, s20, 40960
  s_add_u32 s46, s46, s30
  s_lshl_b32 s47, s20, 12
  s_add_u32 s47, s47, s32
  v_add_u32 v18, s33, v14
  v_add_u32 v19, s33, v15
  s_add_u32 s33, s33, 16384
  s_cmp_lt_u32 s33, 98304
  s_cselect_b32 s33, s33, 0
  ds_read_b128 v[160:163], v18 offset:0
  s_waitcnt lgkmcnt(8)
  v_mfma_f32_16x16x32_bf16 v[64:67], a[228:231], v[192:195], v[64:67]
  v_mfma_f32_16x16x32_bf16 v[68:71], a[232:235], v[192:195], v[68:71]
  v_mfma_f32_16x16x32_bf16 v[72:75], a[236:239], v[192:195], v[72:75]
  ds_read_b128 v[164:167], v18 offset:2048
  s_waitcnt lgkmcnt(8)
  v_mfma_f32_16x16x32_bf16 v[76:79], a[228:231], v[196:199], v[76:79]
  v_mfma_f32_16x16x32_bf16 v[80:83], a[232:235], v[196:199], v[80:83]
  v_mfma_f32_16x16x32_bf16 v[84:87], a[236:239], v[196:199], v[84:87]
  s_add_u32 m0, s47, 0
  s_nop 0
  buffer_load_dwordx4 v10, s[8:11], s46 offen lds
  ds_read_b128 v[168:171], v18 offset:4096
  s_waitcnt lgkmcnt(8)
  v_mfma_f32_16x16x32_bf16 v[88:91], a[228:231], v[200:203], v[88:91]
  v_mfma_f32_16x16x32_bf16 v[92:95], a[232:235], v[200:203], v[92:95]
  v_mfma_f32_16x16x32_bf16 v[96:99], a[236:239], v[200:203], v[96:99]
  ds_read_b128 v[172:175], v18 offset:6144
  s_waitcnt lgkmcnt(8)
  v_mfma_f32_16x16x32_bf16 v[100:103], a[228:231], v[204:207], v[100:103]
  v_mfma_f32_16x16x32_bf16 v[104:107], a[232:235], v[204:207], v[104:107]
  v_mfma_f32_16x16x32_bf16 v[108:111], a[236:239], v[204:207], v[108:111]
  v_cvt_pk_bf16_f32 v224, v64, v65
  v_cvt_pk_bf16_f32 v225, v66, v67
  v_cvt_pk_bf16_f32 v226, v68, v69
  v_cvt_pk_bf16_f32 v227, v70, v71
  v_cvt_pk_bf16_f32 v228, v72, v73
  v_cvt_pk_bf16_f32 v229, v74, v75
  ds_write_b64 v22, v[224:225] offset:0
  ds_write_b64 v22, v[226:227] offset:32
  ds_write_b64 v22, v[228:229] offset:64
  ds_read_b128 v[176:179], v18 offset:8192
  s_waitcnt lgkmcnt(8)
  v_mfma_f32_16x16x32_bf16 v[112:115], a[228:231], v[208:211], v[112:115]
  v_mfma_f32_16x16x32_bf16 v[116:119], a[232:235], v[208:211], v[116:119]
  v_mfma_f32_16x16x32_bf16 v[120:123], a[236:239], v[208:211], v[120:123]
  v_cvt_pk_bf16_f32 v230, v76, v77
  v_cvt_pk_bf16_f32 v231, v78, v79
  v_cvt_pk_bf16_f32 v232, v80, v81
  v_cvt_pk_bf16_f32 v233, v82, v83
  v_cvt_pk_bf16_f32 v234, v84, v85
  v_cvt_pk_bf16_f32 v235, v86, v87
  ds_write_b64 v22, v[230:231] offset:6400
  ds_write_b64 v22, v[232:233] offset:6432
  ds_write_b64 v22, v[234:235] offset:6464
  ds_read_b128 v[180:183], v18 offset:10240
  s_waitcnt lgkmcnt(8)
  v_mfma_f32_16x16x32_bf16 v[124:127], a[228:231], v[212:215], v[124:127]
  v_mfma_f32_16x16x32_bf16 v[128:131], a[232:235], v[212:215], v[128:131]
  v_mfma_f32_16x16x32_bf16 v[132:135], a[236:239], v[212:215], v[132:135]
  s_add_u32 s46, s46, 10240
  s_add_u32 m0, s47, 1024
  s_nop 0
  buffer_load_dwordx4 v10, s[8:11], s46 offen lds
  v_cvt_pk_bf16_f32 v224, v88, v89
  v_cvt_pk_bf16_f32 v225, v90, v91
  v_cvt_pk_bf16_f32 v226, v92, v93
  v_cvt_pk_bf16_f32 v227, v94, v95
  v_cvt_pk_bf16_f32 v228, v96, v97
  v_cvt_pk_bf16_f32 v229, v98, v99
  ds_write_b64 v22, v[224:225] offset:12800
  ds_write_b64 v22, v[226:227] offset:12832
  ds_write_b64 v22, v[228:229] offset:12864
  ds_read_b128 v[184:187], v18 offset:12288
  s_waitcnt lgkmcnt(8)
  v_mfma_f32_16x16x32_bf16 v[136:139], a[228:231], v[216:219], v[136:139]
  v_mfma_f32_16x16x32_bf16 v[140:143], a[232:235], v[216:219], v[140:143]
  v_mfma_f32_16x16x32_bf16 v[144:147], a[236:239], v[216:219], v[144:147]
  v_cvt_pk_bf16_f32 v230, v100, v101
  v_cvt_pk_bf16_f32 v231, v102, v103
  v_cvt_pk_bf16_f32 v232, v104, v105
  v_cvt_pk_bf16_f32 v233, v106, v107
  v_cvt_pk_bf16_f32 v234, v108, v109
  v_cvt_pk_bf16_f32 v235, v110, v111
  ds_write_b64 v22, v[230:231] offset:19200
  ds_write_b64 v22, v[232:233] offset:19232
  ds_write_b64 v22, v[234:235] offset:19264
  ds_read_b128 v[188:191], v18 offset:14336
  s_waitcnt lgkmcnt(8)
  v_mfma_f32_16x16x32_bf16 v[148:151], a[228:231], v[220:223], v[148:151]
  v_mfma_f32_16x16x32_bf16 v[152:155], a[232:235], v[220:223], v[152:155]
  v_mfma_f32_16x16x32_bf16 v[156:159], a[236:239], v[220:223], v[156:159]
  v_cvt_pk_bf16_f32 v224, v112, v113
  v_cvt_pk_bf16_f32 v225, v114, v115
  v_cvt_pk_bf16_f32 v226, v116, v117
  v_cvt_pk_bf16_f32 v227, v118, v119
  v_cvt_pk_bf16_f32 v228, v120, v121
  v_cvt_pk_bf16_f32 v229, v122, v123
  ds_write_b64 v22, v[224:225] offset:25600
  ds_write_b64 v22, v[226:227] offset:25632
  ds_write_b64 v22, v[228:229] offset:25664
  v_cvt_pk_bf16_f32 v230, v124, v125
  v_cvt_pk_bf16_f32 v231, v126, v127
  v_cvt_pk_bf16_f32 v232, v128, v129
  v_cvt_pk_bf16_f32 v233, v130, v131
  v_cvt_pk_bf16_f32 v234, v132, v133
  v_cvt_pk_bf16_f32 v235, v134, v135
  ds_write_b64 v22, v[230:231] offset:32000
  ds_write_b64 v22, v[232:233] offset:32032
  ds_write_b64 v22, v[234:235] offset:32064
  v_cvt_pk_bf16_f32 v224, v136, v137
  v_cvt_pk_bf16_f32 v225, v138, v139
  v_cvt_pk_bf16_f32 v226, v140, v141
  v_cvt_pk_bf16_f32 v227, v142, v143
  v_cvt_pk_bf16_f32 v228, v144, v145
  v_cvt_pk_bf16_f32 v229, v146, v147
  ds_write_b64 v22, v[224:225] offset:38400
  ds_write_b64 v22, v[226:227] offset:38432
  ds_write_b64 v22, v[228:229] offset:38464
  v_cvt_pk_bf16_f32 v230, v148, v149
  v_cvt_pk_bf16_f32 v231, v150, v151
  v_cvt_pk_bf16_f32 v232, v152, v153
  v_cvt_pk_bf16_f32 v233, v154, v155
  v_cvt_pk_bf16_f32 v234, v156, v157
  v_cvt_pk_bf16_f32 v235, v158, v159
  ds_write_b64 v22, v[230:231] offset:44800
  ds_write_b64 v22, v[232:233] offset:44832
  ds_write_b64 v22, v[234:235] offset:44864
  s_mov_b32 s61, s60
  s_add_u32 s60, s60, s63
  s_mul_i32 s48, s20, 122880
  s_add_u32 s48, s48, s27
  s_add_u32 s27, s27, s28
  s_sub_u32 s26, s26, 1
  s_cmp_gt_u32 s26, 0
  s_cbranch_scc1 qb_blk_257
  s_waitcnt vmcnt(0) lgkmcnt(0)
  s_barrier
  ds_read_b128 v[224:227], v23 offset:0
  ds_read_b128 v[228:231], v24 offset:0
  ds_read_b128 v[232:235], v25 offset:0
  ds_read_b128 v[236:239], v23 offset:3200
  ds_read_b128 v[240:243], v24 offset:3200
  ds_read_b128 v[244:247], v25 offset:3200
  s_waitcnt lgkmcnt(0)
  s_add_u32 s21, s48, 0
  buffer_store_dwordx4 v[224:227], v26, s[16:19], s21 offen sc1
  s_add_u32 s21, s48, 0
  buffer_store_dwordx4 v[228:231], v27, s[16:19], s21 offen sc1
  s_add_u32 s21, s48, 0
  buffer_store_dwordx4 v[232:235], v28, s[16:19], s21 offen sc1
  s_add_u32 s21, s48, 30720
  buffer_store_dwordx4 v[236:239], v26, s[16:19], s21 offen sc1
  s_add_u32 s21, s48, 30720
  buffer_store_dwordx4 v[240:243], v27, s[16:19], s21 offen sc1
  s_add_u32 s21, s48, 30720
  buffer_store_dwordx4 v[244:247], v28, s[16:19], s21 offen sc1
  s_nop 1
  ds_read_b128 v[224:227], v23 offset:6400
  ds_read_b128 v[228:231], v24 offset:6400
  ds_read_b128 v[232:235], v25 offset:6400
  ds_read_b128 v[236:239], v23 offset:9600
  ds_read_b128 v[240:243], v24 offset:9600
  ds_read_b128 v[244:247], v25 offset:9600
  s_waitcnt lgkmcnt(0)
  s_add_u32 s21, s48, 61440
  buffer_store_dwordx4 v[224:227], v26, s[16:19], s21 offen sc1
  s_add_u32 s21, s48, 61440
  buffer_store_dwordx4 v[228:231], v27, s[16:19], s21 offen sc1
  s_add_u32 s21, s48, 61440
  buffer_store_dwordx4 v[232:235], v28, s[16:19], s21 offen sc1
  s_add_u32 s21, s48, 92160
  buffer_store_dwordx4 v[236:239], v26, s[16:19], s21 offen sc1
  s_add_u32 s21, s48, 92160
  buffer_store_dwordx4 v[240:243], v27, s[16:19], s21 offen sc1
  s_add_u32 s21, s48, 92160
  buffer_store_dwordx4 v[244:247], v28, s[16:19], s21 offen sc1
  s_nop 1
  s_waitcnt vmcnt(0)
  s_barrier
  s_cmp_lg_u32 s20, 0
  s_cbranch_scc1 af_270
  v_mov_b32 v4, 0
  v_mov_b32 v5, 1
  s_mov_b64 exec, 1
  buffer_atomic_add v5, v4, s[72:75], s61 offen sc1
  s_mov_b64 exec, -1
  s_nop 1
af_270:
  s_barrier
  s_cmp_eq_u32 s64, 1
  s_cbranch_scc1 queue
skip_qb:
  s_sub_u32 s2, s3, 96
  s_load_dwordx2 s[4:5], s[0:1], 0
  s_load_dwordx2 s[6:7], s[0:1], 16
  s_load_dwordx2 s[38:39], s[0:1], 104
  s_mov_b32 s42, s2
  s_mov_b32 s41, 0
  s_waitcnt lgkmcnt(0)
  s_mov_b32 s8, s4
  s_mov_b32 s9, s5
  s_mov_b32 s10, 2621440
  s_mov_b32 s11, 0x00020000
  s_mov_b32 s12, s6
  s_mov_b32 s13, s7
  s_mov_b32 s14, 7864320
  s_mov_b32 s15, 0x00020000
  s_mov_b32 s16, s38
  s_mov_b32 s17, s39
  s_mov_b32 s18, 50331648
  s_mov_b32 s19, 0x00020000
  s_add_u32 s52, s38, 50331648
  s_addc_u32 s53, s39, 0
  s_mov_b32 s54, 6291456
  s_mov_b32 s55, 0x00020000
  s_add_u32 s56, s38, 85983232
  s_addc_u32 s57, s39, 0
  s_mov_b32 s58, 6815744
  s_mov_b32 s59, 0x00020000
  s_load_dwordx2 s[72:73], s[0:1], 104
  s_waitcnt lgkmcnt(0)
  s_add_u32 s72, s72, 81068032
  s_addc_u32 s73, s73, 0
  s_mov_b32 s74, 115712
  s_mov_b32 s75, 0x00020000
  s_mul_i32 s44, s42, 384
  v_mov_b32 v9, 2731
  v_add_u32 v8, 0, v1
  v_mul_u32_u24 v7, v8, v9
  v_lshrrev_b32 v7, 16, v7
  v_mul_u32_u24 v4, 24, v7
  v_sub_u32 v8, v8, v4
  s_mov_b32 s21, 12288
  v_mul_lo_u32 v7, v7, s21
  v_lshl_add_u32 v4, v8, 4, v7
  v_add_u32 v8, 64, v1
  v_mul_u32_u24 v7, v8, v9
  v_lshrrev_b32 v7, 16, v7
  v_mul_u32_u24 v5, 24, v7
  v_sub_u32 v8, v8, v5
  s_mov_b32 s21, 12288
  v_mul_lo_u32 v7, v7, s21
  v_lshl_add_u32 v5, v8, 4, v7
  v_add_u32 v8, 128, v1
  v_mul_u32_u24 v7, v8, v9
  v_lshrrev_b32 v7, 16, v7
  v_mul_u32_u24 v6, 24, v7
  v_sub_u32 v8, v8, v6
  s_mov_b32 s21, 12288
  v_mul_lo_u32 v7, v7, s21
  v_lshl_add_u32 v6, v8, 4, v7
  v_lshrrev_b32 v7, 2, v2
  v_lshl_add_u32 v7, v3, 3, v7
  v_mul_u32_u24 v7, 384, v7
  v_and_b32 v8, 3, v2
  v_lshlrev_b32 v8, 3, v8
  s_mul_i32 s21, s20, 96
  v_add3_u32 v7, v7, v8, s21
  v_add_u32 v8, 61440, v7
  s_mul_i32 s21, s20, 491520
  s_add_u32 s21, s21, 0
  s_add_u32 s21, s21, s44
  s_mul_i32 s22, s20, 15360
  s_add_u32 s22, s22, 0
  s_add_u32 m0, s22, 0
  s_nop 0
  buffer_load_dwordx4 v4, s[12:15], s21 offen lds
  s_add_u32 m0, s22, 1024
  s_nop 0
  buffer_load_dwordx4 v5, s[12:15], s21 offen lds
  s_add_u32 m0, s22, 2048
  s_nop 0
  buffer_load_dwordx4 v6, s[12:15], s21 offen lds
  s_mul_i32 s21, s20, 491520
  s_add_u32 s21, s21, 98304
  s_add_u32 s21, s21, s44
  s_mul_i32 s22, s20, 15360
  s_add_u32 s22, s22, 3072
  s_add_u32 m0, s22, 0
  s_nop 0
  buffer_load_dwordx4 v4, s[12:15], s21 offen lds
  s_add_u32 m0, s22, 1024
  s_nop 0
  buffer_load_dwordx4 v5, s[12:15], s21 offen lds
  s_add_u32 m0, s22, 2048
  s_nop 0
  buffer_load_dwordx4 v6, s[12:15], s21 offen lds
  s_mul_i32 s21, s20, 491520
  s_add_u32 s21, s21, 196608
  s_add_u32 s21, s21, s44
  s_mul_i32 s22, s20, 15360
  s_add_u32 s22, s22, 6144
  s_add_u32 m0, s22, 0
  s_nop 0
  buffer_load_dwordx4 v4, s[12:15], s21 offen lds
  s_add_u32 m0, s22, 1024
  s_nop 0
  buffer_load_dwordx4 v5, s[12:15], s21 offen lds
  s_add_u32 m0, s22, 2048
  s_nop 0
  buffer_load_dwordx4 v6, s[12:15], s21 offen lds
  s_mul_i32 s21, s20, 491520
  s_add_u32 s21, s21, 294912
  s_add_u32 s21, s21, s44
  s_mul_i32 s22, s20, 15360
  s_add_u32 s22, s22, 9216
  s_add_u32 m0, s22, 0
  s_nop 0
  buffer_load_dwordx4 v4, s[12:15], s21 offen lds
  s_add_u32 m0, s22, 1024
  s_nop 0
  buffer_load_dwordx4 v5, s[12:15], s21 offen lds
  s_add_u32 m0, s22, 2048
  s_nop 0
  buffer_load_dwordx4 v6, s[12:15], s21 offen lds
  s_mul_i32 s21, s20, 491520
  s_add_u32 s21, s21, 393216
  s_add_u32 s21, s21, s44
  s_mul_i32 s22, s20, 15360
  s_add_u32 s22, s22, 12288
  s_add_u32 m0, s22, 0
  s_nop 0
  buffer_load_dwordx4 v4, s[12:15], s21 offen lds
  s_add_u32 m0, s22, 1024
  s_nop 0
  buffer_load_dwordx4 v5, s[12:15], s21 offen lds
  s_add_u32 m0, s22, 2048
  s_nop 0
  buffer_load_dwordx4 v6, s[12:15], s21 offen lds
  s_mul_i32 s21, s20, 491520
  s_add_u32 s21, s21, 1966080
  s_add_u32 s21, s21, s44
  s_mul_i32 s22, s20, 15360
  s_add_u32 s22, s22, 61440
  s_add_u32 m0, s22, 0
  s_nop 0
  buffer_load_dwordx4 v4, s[12:15], s21 offen lds
  s_add_u32 m0, s22, 1024
  s_nop 0
  buffer_load_dwordx4 v5, s[12:15], s21 offen lds
  s_add_u32 m0, s22, 2048
  s_nop 0
  buffer_load_dwordx4 v6, s[12:15], s21 offen lds
  s_mul_i32 s21, s20, 491520
  s_add_u32 s21, s21, 2064384
  s_add_u32 s21, s21, s44
  s_mul_i32 s22, s20, 15360
  s_add_u32 s22, s22, 64512
  s_add_u32 m0, s22, 0
  s_nop 0
  buffer_load_dwordx4 v4, s[12:15], s21 offen lds
  s_add_u32 m0, s22, 1024
  s_nop 0
  buffer_load_dwordx4 v5, s[12:15], s21 offen lds
  s_add_u32 m0, s22, 2048
  s_nop 0
  buffer_load_dwordx4 v6, s[12:15], s21 offen lds
  s_mul_i32 s21, s20, 491520
  s_add_u32 s21, s21, 2162688
  s_add_u32 s21, s21, s44
  s_mul_i32 s22, s20, 15360
  s_add_u32 s22, s22, 67584
  s_add_u32 m0, s22, 0
  s_nop 0
  buffer_load_dwordx4 v4, s[12:15], s21 offen lds
  s_add_u32 m0, s22, 1024
  s_nop 0
  buffer_load_dwordx4 v5, s[12:15], s21 offen lds
  s_add_u32 m0, s22, 2048
  s_nop 0
  buffer_load_dwordx4 v6, s[12:15], s21 offen lds
  s_mul_i32 s21, s20, 491520
  s_add_u32 s21, s21, 2260992
  s_add_u32 s21, s21, s44
  s_mul_i32 s22, s20, 15360
  s_add_u32 s22, s22, 70656
  s_add_u32 m0, s22, 0
  s_nop 0
  buffer_load_dwordx4 v4, s[12:15], s21 offen lds
  s_add_u32 m0, s22, 1024
  s_nop 0
  buffer_load_dwordx4 v5, s[12:15], s21 offen lds
  s_add_u32 m0, s22, 2048
  s_nop 0
  buffer_load_dwordx4 v6, s[12:15], s21 offen lds
  s_mul_i32 s21, s20, 491520
  s_add_u32 s21, s21, 2359296
  s_add_u32 s21, s21, s44
  s_mul_i32 s22, s20, 15360
  s_add_u32 s22, s22, 73728
  s_add_u32 m0, s22, 0
  s_nop 0
  buffer_load_dwordx4 v4, s[12:15], s21 offen lds
  s_add_u32 m0, s22, 1024
  s_nop 0
  buffer_load_dwordx4 v5, s[12:15], s21 offen lds
  s_add_u32 m0, s22, 2048
  s_nop 0
  buffer_load_dwordx4 v6, s[12:15], s21 offen lds
  s_mul_i32 s21, s20, 491520
  s_add_u32 s21, s21, 3932160
  s_add_u32 s21, s21, s44
  buffer_load_dwordx4 v[64:67], v4, s[12:15], s21 offen
  buffer_load_dwordx4 v[68:71], v5, s[12:15], s21 offen
  buffer_load_dwordx4 v[72:75], v6, s[12:15], s21 offen
  s_mul_i32 s21, s20, 491520
  s_add_u32 s21, s21, 4030464
  s_add_u32 s21, s21, s44
  buffer_load_dwordx4 v[76:79], v4, s[12:15], s21 offen
  buffer_load_dwordx4 v[80:83], v5, s[12:15], s21 offen
  buffer_load_dwordx4 v[84:87], v6, s[12:15], s21 offen
  s_mul_i32 s21, s20, 491520
  s_add_u32 s21, s21, 4128768
  s_add_u32 s21, s21, s44
  buffer_load_dwordx4 v[88:91], v4, s[12:15], s21 offen
  buffer_load_dwordx4 v[92:95], v5, s[12:15], s21 offen
  buffer_load_dwordx4 v[96:99], v6, s[12:15], s21 offen
  s_mul_i32 s21, s20, 491520
  s_add_u32 s21, s21, 4227072
  s_add_u32 s21, s21, s44
  buffer_load_dwordx4 v[100:103], v4, s[12:15], s21 offen
  buffer_load_dwordx4 v[104:107], v5, s[12:15], s21 offen
  buffer_load_dwordx4 v[108:111], v6, s[12:15], s21 offen
  s_mul_i32 s21, s20, 491520
  s_add_u32 s21, s21, 4325376
  s_add_u32 s21, s21, s44
  buffer_load_dwordx4 v[112:115], v4, s[12:15], s21 offen
  buffer_load_dwordx4 v[116:119], v5, s[12:15], s21 offen
  buffer_load_dwordx4 v[120:123], v6, s[12:15], s21 offen
  s_mul_i32 s21, s20, 491520
  s_add_u32 s21, s21, 5898240
  s_add_u32 s21, s21, s44
  buffer_load_dwordx4 v[124:127], v4, s[12:15], s21 offen
  buffer_load_dwordx4 v[128:131], v5, s[12:15], s21 offen
  buffer_load_dwordx4 v[132:135], v6, s[12:15], s21 offen
  s_mul_i32 s21, s20, 491520
  s_add_u32 s21, s21, 5996544
  s_add_u32 s21, s21, s44
  buffer_load_dwordx4 v[136:139], v4, s[12:15], s21 offen
  buffer_load_dwordx4 v[140:143], v5, s[12:15], s21 offen
  buffer_load_dwordx4 v[144:147], v6, s[12:15], s21 offen
  s_mul_i32 s21, s20, 491520
  s_add_u32 s21, s21, 6094848
  s_add_u32 s21, s21, s44
  buffer_load_dwordx4 v[148:151], v4, s[12:15], s21 offen
  buffer_load_dwordx4 v[152:155], v5, s[12:15], s21 offen
  buffer_load_dwordx4 v[156:159], v6, s[12:15], s21 offen
  s_mul_i32 s21, s20, 491520
  s_add_u32 s21, s21, 6193152
  s_add_u32 s21, s21, s44
  buffer_load_dwordx4 v[160:163], v4, s[12:15], s21 offen
  buffer_load_dwordx4 v[164:167], v5, s[12:15], s21 offen
  buffer_load_dwordx4 v[168:171], v6, s[12:15], s21 offen
  s_mul_i32 s21, s20, 491520
  s_add_u32 s21, s21, 6291456
  s_add_u32 s21, s21, s44
  buffer_load_dwordx4 v[172:175], v4, s[12:15], s21 offen
  buffer_load_dwordx4 v[176:179], v5, s[12:15], s21 offen
  buffer_load_dwordx4 v[180:183], v6, s[12:15], s21 offen
  s_mul_i32 s22, s20, 15360
  v_lshl_add_u32 v30, v1, 4, s22
  v_add_u32 v31, 61440, v30
  s_waitcnt vmcnt(45)
  s_barrier
  ds_read_b64_tr_b16 a[0:1], v7 offset:0
  ds_read_b64_tr_b16 a[2:3], v7 offset:1536
  ds_read_b64_tr_b16 a[4:5], v7 offset:32
  ds_read_b64_tr_b16 a[6:7], v7 offset:1568
  ds_read_b64_tr_b16 a[8:9], v7 offset:64
  ds_read_b64_tr_b16 a[10:11], v7 offset:1600
  ds_read_b64_tr_b16 a[12:13], v7 offset:12288
  ds_read_b64_tr_b16 a[14:15], v7 offset:13824
  ds_read_b64_tr_b16 a[16:17], v7 offset:12320
  ds_read_b64_tr_b16 a[18:19], v7 offset:13856
  ds_read_b64_tr_b16 a[20:21], v7 offset:12352
  ds_read_b64_tr_b16 a[22:23], v7 offset:13888
  ds_read_b64_tr_b16 a[24:25], v7 offset:24576
  ds_read_b64_tr_b16 a[26:27], v7 offset:26112
  ds_read_b64_tr_b16 a[28:29], v7 offset:24608
  ds_read_b64_tr_b16 a[30:31], v7 offset:26144
  ds_read_b64_tr_b16 a[32:33], v7 offset:24640
  ds_read_b64_tr_b16 a[34:35], v7 offset:26176
  ds_read_b64_tr_b16 a[36:37], v7 offset:36864
  ds_read_b64_tr_b16 a[38:39], v7 offset:38400
  ds_read_b64_tr_b16 a[40:41], v7 offset:36896
  ds_read_b64_tr_b16 a[42:43], v7 offset:38432
  ds_read_b64_tr_b16 a[44:45], v7 offset:36928
  ds_read_b64_tr_b16 a[46:47], v7 offset:38464
  ds_read_b64_tr_b16 a[48:49], v7 offset:49152
  ds_read_b64_tr_b16 a[50:51], v7 offset:50688
  ds_read_b64_tr_b16 a[52:53], v7 offset:49184
  ds_read_b64_tr_b16 a[54:55], v7 offset:50720
  ds_read_b64_tr_b16 a[56:57], v7 offset:49216
  ds_read_b64_tr_b16 a[58:59], v7 offset:50752
  s_waitcnt lgkmcnt(0)
  s_barrier
  s_waitcnt vmcnt(30)
  s_barrier
  ds_read_b64_tr_b16 a[60:61], v8 offset:0
  ds_read_b64_tr_b16 a[62:63], v8 offset:1536
  ds_read_b64_tr_b16 a[64:65], v8 offset:32
  ds_read_b64_tr_b16 a[66:67], v8 offset:1568
  ds_read_b64_tr_b16 a[68:69], v8 offset:64
  ds_read_b64_tr_b16 a[70:71], v8 offset:1600
  ds_read_b64_tr_b16 a[72:73], v8 offset:12288
  ds_read_b64_tr_b16 a[74:75], v8 offset:13824
  ds_read_b64_tr_b16 a[76:77], v8 offset:12320
  ds_read_b64_tr_b16 a[78:79], v8 offset:13856
  ds_read_b64_tr_b16 a[80:81], v8 offset:12352
  ds_read_b64_tr_b16 a[82:83], v8 offset:13888
  ds_read_b64_tr_b16 a[84:85], v8 offset:24576
  ds_read_b64_tr_b16 a[86:87], v8 offset:26112
  ds_read_b64_tr_b16 a[88:89], v8 offset:24608
  ds_read_b64_tr_b16 a[90:91], v8 offset:26144
  ds_read_b64_tr_b16 a[92:93], v8 offset:24640
  ds_read_b64_tr_b16 a[94:95], v8 offset:26176
  ds_read_b64_tr_b16 a[96:97], v8 offset:36864
  ds_read_b64_tr_b16 a[98:99], v8 offset:38400
  ds_read_b64_tr_b16 a[100:101], v8 offset:36896
  ds_read_b64_tr_b16 a[102:103], v8 offset:38432
  ds_read_b64_tr_b16 a[104:105], v8 offset:36928
  ds_read_b64_tr_b16 a[106:107], v8 offset:38464
  ds_read_b64_tr_b16 a[108:109], v8 offset:49152
  ds_read_b64_tr_b16 a[110:111], v8 offset:50688
  ds_read_b64_tr_b16 a[112:113], v8 offset:49184
  ds_read_b64_tr_b16 a[114:115], v8 offset:50720
  ds_read_b64_tr_b16 a[116:117], v8 offset:49216
  ds_read_b64_tr_b16 a[118:119], v8 offset:50752
  s_waitcnt lgkmcnt(0)
  s_barrier
  s_waitcnt vmcnt(15)
  ds_write_b128 v30, v[64:67] offset:0
  ds_write_b128 v30, v[68:71] offset:1024
  ds_write_b128 v30, v[72:75] offset:2048
  ds_write_b128 v30, v[76:79] offset:3072
  ds_write_b128 v30, v[80:83] offset:4096
  ds_write_b128 v30, v[84:87] offset:5120
  ds_write_b128 v30, v[88:91] offset:6144
  ds_write_b128 v30, v[92:95] offset:7168
  ds_write_b128 v30, v[96:99] offset:8192
  ds_write_b128 v30, v[100:103] offset:9216
  ds_write_b128 v30, v[104:107] offset:10240
  ds_write_b128 v30, v[108:111] offset:11264
  ds_write_b128 v30, v[112:115] offset:12288
  ds_write_b128 v30, v[116:119] offset:13312
  ds_write_b128 v30, v[120:123] offset:14336
  s_waitcnt lgkmcnt(0)
  s_barrier
  ds_read_b64_tr_b16 a[120:121], v7 offset:0
  ds_read_b64_tr_b16 a[122:123], v7 offset:1536
  ds_read_b64_tr_b16 a[124:125], v7 offset:32
  ds_read_b64_tr_b16 a[126:127], v7 offset:1568
  ds_read_b64_tr_b16 a[128:129], v7 offset:64
  ds_read_b64_tr_b16 a[130:131], v7 offset:1600
  ds_read_b64_tr_b16 a[132:133], v7 offset:12288
  ds_read_b64_tr_b16 a[134:135], v7 offset:13824
  ds_read_b64_tr_b16 a[136:137], v7 offset:12320
  ds_read_b64_tr_b16 a[138:139], v7 offset:13856
  ds_read_b64_tr_b16 a[140:141], v7 offset:12352
  ds_read_b64_tr_b16 a[142:143], v7 offset:13888
  ds_read_b64_tr_b16 a[144:145], v7 offset:24576
  ds_read_b64_tr_b16 a[146:147], v7 offset:26112
  ds_read_b64_tr_b16 a[148:149], v7 offset:24608
  ds_read_b64_tr_b16 a[150:151], v7 offset:26144
  ds_read_b64_tr_b16 a[152:153], v7 offset:24640
  ds_read_b64_tr_b16 a[154:155], v7 offset:26176
  ds_read_b64_tr_b16 a[156:157], v7 offset:36864
  ds_read_b64_tr_b16 a[158:159], v7 offset:38400
  ds_read_b64_tr_b16 a[160:161], v7 offset:36896
  ds_read_b64_tr_b16 a[162:163], v7 offset:38432
  ds_read_b64_tr_b16 a[164:165], v7 offset:36928
  ds_read_b64_tr_b16 a[166:167], v7 offset:38464
  ds_read_b64_tr_b16 a[168:169], v7 offset:49152
  ds_read_b64_tr_b16 a[170:171], v7 offset:50688
  ds_read_b64_tr_b16 a[172:173], v7 offset:49184
  ds_read_b64_tr_b16 a[174:175], v7 offset:50720
  ds_read_b64_tr_b16 a[176:177], v7 offset:49216
  ds_read_b64_tr_b16 a[178:179], v7 offset:50752
  s_waitcnt lgkmcnt(0)
  s_barrier
  s_waitcnt vmcnt(0)
  ds_write_b128 v31, v[124:127] offset:0
  ds_write_b128 v31, v[128:131] offset:1024
  ds_write_b128 v31, v[132:135] offset:2048
  ds_write_b128 v31, v[136:139] offset:3072
  ds_write_b128 v31, v[140:143] offset:4096
  ds_write_b128 v31, v[144:147] offset:5120
  ds_write_b128 v31, v[148:151] offset:6144
  ds_write_b128 v31, v[152:155] offset:7168
  ds_write_b128 v31, v[156:159] offset:8192
  ds_write_b128 v31, v[160:163] offset:9216
  ds_write_b128 v31, v[164:167] offset:10240
  ds_write_b128 v31, v[168:171] offset:11264
  ds_write_b128 v31, v[172:175] offset:12288
  ds_write_b128 v31, v[176:179] offset:13312
  ds_write_b128 v31, v[180:183] offset:14336
  s_waitcnt lgkmcnt(0)
  s_barrier
  ds_read_b64_tr_b16 a[180:181], v8 offset:0
  ds_read_b64_tr_b16 a[182:183], v8 offset:1536
  ds_read_b64_tr_b16 a[184:185], v8 offset:32
  ds_read_b64_tr_b16 a[186:187], v8 offset:1568
  ds_read_b64_tr_b16 a[188:189], v8 offset:64
  ds_read_b64_tr_b16 a[190:191], v8 offset:1600
  ds_read_b64_tr_b16 a[192:193], v8 offset:12288
  ds_read_b64_tr_b16 a[194:195], v8 offset:13824
  ds_read_b64_tr_b16 a[196:197], v8 offset:12320
  ds_read_b64_tr_b16 a[198:199], v8 offset:13856
  ds_read_b64_tr_b16 a[200:201], v8 offset:12352
  ds_read_b64_tr_b16 a[202:203], v8 offset:13888
  ds_read_b64_tr_b16 a[204:205], v8 offset:24576
  ds_read_b64_tr_b16 a[206:207], v8 offset:26112
  ds_read_b64_tr_b16 a[208:209], v8 offset:24608
  ds_read_b64_tr_b16 a[210:211], v8 offset:26144
  ds_read_b64_tr_b16 a[212:213], v8 offset:24640
  ds_read_b64_tr_b16 a[214:215], v8 offset:26176
  ds_read_b64_tr_b16 a[216:217], v8 offset:36864
  ds_read_b64_tr_b16 a[218:219], v8 offset:38400
  ds_read_b64_tr_b16 a[220:221], v8 offset:36896
  ds_read_b64_tr_b16 a[222:223], v8 offset:38432
  ds_read_b64_tr_b16 a[224:225], v8 offset:36928
  ds_read_b64_tr_b16 a[226:227], v8 offset:38464
  ds_read_b64_tr_b16 a[228:229], v8 offset:49152
  ds_read_b64_tr_b16 a[230:231], v8 offset:50688
  ds_read_b64_tr_b16 a[232:233], v8 offset:49184
  ds_read_b64_tr_b16 a[234:235], v8 offset:50720
  ds_read_b64_tr_b16 a[236:237], v8 offset:49216
  ds_read_b64_tr_b16 a[238:239], v8 offset:50752
  s_waitcnt lgkmcnt(0)
  s_barrier
  s_mul_i32 s21, s20, 12800
  s_add_u32 s21, s21, 98304
  v_mul_u32_u24 v4, 400, v2
  v_lshlrev_b32 v5, 4, v3
  v_add3_u32 v29, v4, v5, s21
  v_lshlrev_b32 v30, 4, v1
  v_and_b32 v4, 7, v2
  v_lshlrev_b32 v4, 4, v4
  v_lshl_add_u32 v31, v3, 7, v4
  v_lshlrev_b32 v32, 3, v1
  v_and_b32 v4, 3, v1
  v_lshlrev_b32 v33, 3, v4
  v_mov_b32 v34, 0xf149f2ca
  v_lshlrev_b32 v4, 2, v3
  v_sub_u32 v35, v2, v4
  v_cmp_gt_u32 s[60:61], 2, v3
  s_mov_b32 s62, 0x3d93cd3a
  s_mov_b32 s63, 0x3fb8aa3b
  s_mov_b32 s83, 0x3dd53b95
  v_cmp_le_i32 s[64:65], 0, v35
  v_cmp_le_i32 s[66:67], 1, v35
  v_cmp_le_i32 s[68:69], 2, v35
  v_cmp_le_i32 s[70:71], 3, v35
  s_mov_b32 s24, 2457600
  s_mov_b32 s25, 4292509696
  s_mov_b32 s26, 16
  s_lshl_b32 s49, s41, 2
  s_add_u32 s49, s49, s20
  s_mov_b32 s29, 4
  s_mov_b32 s78, 0
  s_mov_b32 s81, 0x80000000
  s_mov_b32 s82, 0
  v_lshrrev_b32 v11, 3, v1
  v_and_b32 v12, 7, v1
  v_xor_b32 v12, v12, v11
  v_mul_u32_u24 v11, 1280, v11
  v_lshl_add_u32 v10, v12, 4, v11
  s_mov_b32 s30, s24
  s_mov_b32 s31, 0
  s_mov_b32 s32, 0
  s_mul_i32 s46, s20, 40960
  s_add_u32 s46, s46, s30
  s_lshl_b32 s47, s20, 12
  s_add_u32 s47, s47, s32
  s_add_u32 m0, s47, 0
  s_nop 0
  buffer_load_dwordx4 v10, s[8:11], s46 offen lds
  s_add_u32 s46, s46, 10240
  s_add_u32 m0, s47, 1024
  s_nop 0
  buffer_load_dwordx4 v10, s[8:11], s46 offen lds
  s_add_u32 s46, s46, 10240
  s_add_u32 m0, s47, 2048
  s_nop 0
  buffer_load_dwordx4 v10, s[8:11], s46 offen lds
  s_add_u32 s46, s46, 10240
  s_add_u32 m0, s47, 3072
  s_nop 0
  buffer_load_dwordx4 v10, s[8:11], s46 offen lds
  s_add_u32 s30, s30, 128
  s_add_u32 s31, s31, 1
  s_cmp_lt_u32 s31, 10
  s_cbranch_scc1 qa_271
  s_mov_b32 s31, 0
  s_add_u32 s30, s30, s25
  s_sub_u32 s30, s30, 1280
  s_mov_b32 s25, 163840
qa_271:
  s_add_u32 s32, s32, 16384
  s_cmp_lt_u32 s32, 98304
  s_cselect_b32 s32, s32, 0
  s_mul_i32 s46, s20, 40960
  s_add_u32 s46, s46, s30
  s_lshl_b32 s47, s20, 12
  s_add_u32 s47, s47, s32
  s_add_u32 m0, s47, 0
  s_nop 0
  buffer_load_dwordx4 v10, s[8:11], s46 offen lds
  s_add_u32 s46, s46, 10240
  s_add_u32 m0, s47, 1024
  s_nop 0
  buffer_load_dwordx4 v10, s[8:11], s46 offen lds
  s_add_u32 s46, s46, 10240
  s_add_u32 m0, s47, 2048
  s_nop 0
  buffer_load_dwordx4 v10, s[8:11], s46 offen lds
  s_add_u32 s46, s46, 10240
  s_add_u32 m0, s47, 3072
  s_nop 0
  buffer_load_dwordx4 v10, s[8:11], s46 offen lds
  s_add_u32 s30, s30, 128
  s_add_u32 s31, s31, 1
  s_cmp_lt_u32 s31, 10
  s_cbranch_scc1 qa_272
  s_mov_b32 s31, 0
  s_add_u32 s30, s30, s25
  s_sub_u32 s30, s30, 1280
  s_mov_b32 s25, 163840
qa_272:
  s_add_u32 s32, s32, 16384
  s_cmp_lt_u32 s32, 98304
  s_cselect_b32 s32, s32, 0
  s_mul_i32 s46, s20, 40960
  s_add_u32 s46, s46, s30
  s_lshl_b32 s47, s20, 12
  s_add_u32 s47, s47, s32
  s_add_u32 m0, s47, 0
  s_nop 0
  buffer_load_dwordx4 v10, s[8:11], s46 offen lds
  s_add_u32 s46, s46, 10240
  s_add_u32 m0, s47, 1024
  s_nop 0
  buffer_load_dwordx4 v10, s[8:11], s46 offen lds
  s_add_u32 s46, s46, 10240
  s_add_u32 m0, s47, 2048
  s_nop 0
  buffer_load_dwordx4 v10, s[8:11], s46 offen lds
  s_add_u32 s46, s46, 10240
  s_add_u32 m0, s47, 3072
  s_nop 0
  buffer_load_dwordx4 v10, s[8:11], s46 offen lds
  s_add_u32 s30, s30, 128
  s_add_u32 s31, s31, 1
  s_cmp_lt_u32 s31, 10
  s_cbranch_scc1 qa_273
  s_mov_b32 s31, 0
  s_add_u32 s30, s30, s25
  s_sub_u32 s30, s30, 1280
  s_mov_b32 s25, 163840
qa_273:
  s_add_u32 s32, s32, 16384
  s_cmp_lt_u32 s32, 98304
  s_cselect_b32 s32, s32, 0
  s_mul_i32 s46, s20, 40960
  s_add_u32 s46, s46, s30
  s_lshl_b32 s47, s20, 12
  s_add_u32 s47, s47, s32
  s_add_u32 m0, s47, 0
  s_nop 0
  buffer_load_dwordx4 v10, s[8:11], s46 offen lds
  s_add_u32 s46, s46, 10240
  s_add_u32 m0, s47, 1024
  s_nop 0
  buffer_load_dwordx4 v10, s[8:11], s46 offen lds
  s_add_u32 s46, s46, 10240
  s_add_u32 m0, s47, 2048
  s_nop 0
  buffer_load_dwordx4 v10, s[8:11], s46 offen lds
  s_add_u32 s46, s46, 10240
  s_add_u32 m0, s47, 3072
  s_nop 0
  buffer_load_dwordx4 v10, s[8:11], s46 offen lds
  s_add_u32 s30, s30, 128
  s_add_u32 s31, s31, 1
  s_cmp_lt_u32 s31, 10
  s_cbranch_scc1 qa_274
  s_mov_b32 s31, 0
  s_add_u32 s30, s30, s25
  s_sub_u32 s30, s30, 1280
  s_mov_b32 s25, 163840
qa_274:
  s_add_u32 s32, s32, 16384
  s_cmp_lt_u32 s32, 98304
  s_cselect_b32 s32, s32, 0
  v_and_b32 v6, 7, v2
  v_add_u32 v4, 0, v3
  v_xor_b32 v4, v4, v6
  v_lshlrev_b32 v4, 4, v4
  v_lshl_add_u32 v14, v2, 7, v4
  v_add_u32 v4, 4, v3
  v_xor_b32 v4, v4, v6
  v_lshlrev_b32 v4, 4, v4
  v_lshl_add_u32 v15, v2, 7, v4
  v_mul_u32_u24 v22, 400, v2
  v_mul_u32_u24 v4, 24, v3
  s_mul_i32 s21, s20, 96
  s_add_u32 s21, s21, 98304
  v_add3_u32 v22, v22, v4, s21
  v_mov_b32 v9, 2731
  s_mov_b32 s33, 0
  s_mov_b32 s48, 0x80000000
  s_mul_i32 s46, s20, 40960
  s_add_u32 s46, s46, s30
  s_lshl_b32 s47, s20, 12
  s_add_u32 s47, s47, s32
  s_add_u32 m0, s47, 0
  s_nop 0
  buffer_load_dwordx4 v10, s[8:11], s46 offen lds
  s_add_u32 s46, s46, 10240
  s_add_u32 m0, s47, 1024
  s_nop 0
  buffer_load_dwordx4 v10, s[8:11], s46 offen lds
  s_waitcnt vmcnt(14)
  s_barrier
  v_add_u32 v18, s33, v14
  v_add_u32 v19, s33, v15
  s_add_u32 s33, s33, 16384
  s_cmp_lt_u32 s33, 98304
  s_cselect_b32 s33, s33, 0
  ds_read_b128 v[160:163], v18 offset:0
  ds_read_b128 v[164:167], v18 offset:2048
  ds_read_b128 v[168:171], v18 offset:4096
  ds_read_b128 v[172:175], v18 offset:6144
  ds_read_b128 v[176:179], v18 offset:8192
  ds_read_b128 v[180:183], v18 offset:10240
  ds_read_b128 v[184:187], v18 offset:12288
  ds_read_b128 v[188:191], v18 offset:14336
qa_blk_275:
  ds_read_b128 v[192:195], v19 offset:0
  s_waitcnt lgkmcnt(8)
  v_mfma_f32_16x16x32_bf16 v[64:67], a[0:3], v[160:163], 0
  v_mfma_f32_16x16x32_bf16 v[68:71], a[4:7], v[160:163], 0
  v_mfma_f32_16x16x32_bf16 v[72:75], a[8:11], v[160:163], 0
  ds_read_b128 v[196:199], v19 offset:2048
  s_waitcnt lgkmcnt(8)
  v_mfma_f32_16x16x32_bf16 v[76:79], a[0:3], v[164:167], 0
  v_mfma_f32_16x16x32_bf16 v[80:83], a[4:7], v[164:167], 0
  v_mfma_f32_16x16x32_bf16 v[84:87], a[8:11], v[164:167], 0
  s_add_u32 s46, s46, 10240
  s_add_u32 m0, s47, 2048
  s_nop 0
  buffer_load_dwordx4 v10, s[8:11], s46 offen lds
  ds_read_b128 v[200:203], v19 offset:4096
  s_waitcnt lgkmcnt(8)
  v_mfma_f32_16x16x32_bf16 v[88:91], a[0:3], v[168:171], 0
  v_mfma_f32_16x16x32_bf16 v[92:95], a[4:7], v[168:171], 0
  v_mfma_f32_16x16x32_bf16 v[96:99], a[8:11], v[168:171], 0
  ds_read_b128 v[204:207], v19 offset:6144
  s_waitcnt lgkmcnt(8)
  v_mfma_f32_16x16x32_bf16 v[100:103], a[0:3], v[172:175], 0
  v_mfma_f32_16x16x32_bf16 v[104:107], a[4:7], v[172:175], 0
  v_mfma_f32_16x16x32_bf16 v[108:111], a[8:11], v[172:175], 0
  ds_read_b128 v[208:211], v19 offset:8192
  s_waitcnt lgkmcnt(8)
  v_mfma_f32_16x16x32_bf16 v[112:115], a[0:3], v[176:179], 0
  v_mfma_f32_16x16x32_bf16 v[116:119], a[4:7], v[176:179], 0
  v_mfma_f32_16x16x32_bf16 v[120:123], a[8:11], v[176:179], 0
  ds_read_b128 v[212:215], v19 offset:10240
  s_waitcnt lgkmcnt(8)
  v_mfma_f32_16x16x32_bf16 v[124:127], a[0:3], v[180:183], 0
  v_mfma_f32_16x16x32_bf16 v[128:131], a[4:7], v[180:183], 0
  v_mfma_f32_16x16x32_bf16 v[132:135], a[8:11], v[180:183], 0
  s_add_u32 s46, s46, 10240
  s_add_u32 m0, s47, 3072
  s_nop 0
  buffer_load_dwordx4 v10, s[8:11], s46 offen lds
  ds_read_b128 v[216:219], v19 offset:12288
  s_waitcnt lgkmcnt(8)
  v_mfma_f32_16x16x32_bf16 v[136:139], a[0:3], v[184:187], 0
  v_mfma_f32_16x16x32_bf16 v[140:143], a[4:7], v[184:187], 0
  v_mfma_f32_16x16x32_bf16 v[144:147], a[8:11], v[184:187], 0
  ds_read_b128 v[220:223], v19 offset:14336
  s_waitcnt lgkmcnt(8)
  v_mfma_f32_16x16x32_bf16 v[148:151], a[0:3], v[188:191], 0
  v_mfma_f32_16x16x32_bf16 v[152:155], a[4:7], v[188:191], 0
  v_mfma_f32_16x16x32_bf16 v[156:159], a[8:11], v[188:191], 0
  s_waitcnt vmcnt(12)
  s_barrier
  s_add_u32 s30, s30, 128
  s_add_u32 s31, s31, 1
  s_cmp_lt_u32 s31, 10
  s_cbranch_scc1 qa_276
  s_mov_b32 s31, 0
  s_add_u32 s30, s30, s25
  s_sub_u32 s30, s30, 1280
  s_mov_b32 s25, 163840
qa_276:
  s_add_u32 s32, s32, 16384
  s_cmp_lt_u32 s32, 98304
  s_cselect_b32 s32, s32, 0
  s_mul_i32 s46, s20, 40960
  s_add_u32 s46, s46, s30
  s_lshl_b32 s47, s20, 12
  s_add_u32 s47, s47, s32
  v_add_u32 v18, s33, v14
  v_add_u32 v19, s33, v15
  s_add_u32 s33, s33, 16384
  s_cmp_lt_u32 s33, 98304
  s_cselect_b32 s33, s33, 0
  ds_read_b128 v[160:163], v18 offset:0
  s_waitcnt lgkmcnt(8)
  v_mfma_f32_16x16x32_bf16 v[64:67], a[12:15], v[192:195], v[64:67]
  v_mfma_f32_16x16x32_bf16 v[68:71], a[16:19], v[192:195], v[68:71]
  v_mfma_f32_16x16x32_bf16 v[72:75], a[20:23], v[192:195], v[72:75]
  ds_read_b128 v[164:167], v18 offset:2048
  s_waitcnt lgkmcnt(8)
  v_mfma_f32_16x16x32_bf16 v[76:79], a[12:15], v[196:199], v[76:79]
  v_mfma_f32_16x16x32_bf16 v[80:83], a[16:19], v[196:199], v[80:83]
  v_mfma_f32_16x16x32_bf16 v[84:87], a[20:23], v[196:199], v[84:87]
  s_add_u32 m0, s47, 0
  s_nop 0
  buffer_load_dwordx4 v10, s[8:11], s46 offen lds
  ds_read_b128 v[168:171], v18 offset:4096
  s_waitcnt lgkmcnt(8)
  v_mfma_f32_16x16x32_bf16 v[88:91], a[12:15], v[200:203], v[88:91]
  v_mfma_f32_16x16x32_bf16 v[92:95], a[16:19], v[200:203], v[92:95]
  v_mfma_f32_16x16x32_bf16 v[96:99], a[20:23], v[200:203], v[96:99]
  ds_read_b128 v[172:175], v18 offset:6144
  s_waitcnt lgkmcnt(8)
  v_mfma_f32_16x16x32_bf16 v[100:103], a[12:15], v[204:207], v[100:103]
  v_mfma_f32_16x16x32_bf16 v[104:107], a[16:19], v[204:207], v[104:107]
  v_mfma_f32_16x16x32_bf16 v[108:111], a[20:23], v[204:207], v[108:111]
  ds_read_b128 v[176:179], v18 offset:8192
  s_waitcnt lgkmcnt(8)
  v_mfma_f32_16x16x32_bf16 v[112:115], a[12:15], v[208:211], v[112:115]
  v_mfma_f32_16x16x32_bf16 v[116:119], a[16:19], v[208:211], v[116:119]
  v_mfma_f32_16x16x32_bf16 v[120:123], a[20:23], v[208:211], v[120:123]
  ds_read_b128 v[180:183], v18 offset:10240
  s_waitcnt lgkmcnt(8)
  v_mfma_f32_16x16x32_bf16 v[124:127], a[12:15], v[212:215], v[124:127]
  v_mfma_f32_16x16x32_bf16 v[128:131], a[16:19], v[212:215], v[128:131]
  v_mfma_f32_16x16x32_bf16 v[132:135], a[20:23], v[212:215], v[132:135]
  s_add_u32 s46, s46, 10240
  s_add_u32 m0, s47, 1024
  s_nop 0
  buffer_load_dwordx4 v10, s[8:11], s46 offen lds
  ds_read_b128 v[184:187], v18 offset:12288
  s_waitcnt lgkmcnt(8)
  v_mfma_f32_16x16x32_bf16 v[136:139], a[12:15], v[216:219], v[136:139]
  v_mfma_f32_16x16x32_bf16 v[140:143], a[16:19], v[216:219], v[140:143]
  v_mfma_f32_16x16x32_bf16 v[144:147], a[20:23], v[216:219], v[144:147]
  ds_read_b128 v[188:191], v18 offset:14336
  s_waitcnt lgkmcnt(8)
  v_mfma_f32_16x16x32_bf16 v[148:151], a[12:15], v[220:223], v[148:151]
  v_mfma_f32_16x16x32_bf16 v[152:155], a[16:19], v[220:223], v[152:155]
  v_mfma_f32_16x16x32_bf16 v[156:159], a[20:23], v[220:223], v[156:159]
  ds_read_b128 v[192:195], v19 offset:0
  s_waitcnt lgkmcnt(8)
  v_mfma_f32_16x16x32_bf16 v[64:67], a[24:27], v[160:163], v[64:67]
  v_mfma_f32_16x16x32_bf16 v[68:71], a[28:31], v[160:163], v[68:71]
  v_mfma_f32_16x16x32_bf16 v[72:75], a[32:35], v[160:163], v[72:75]
  ds_read_b128 v[196:199], v19 offset:2048
  s_waitcnt lgkmcnt(8)
  v_mfma_f32_16x16x32_bf16 v[76:79], a[24:27], v[164:167], v[76:79]
  v_mfma_f32_16x16x32_bf16 v[80:83], a[28:31], v[164:167], v[80:83]
  v_mfma_f32_16x16x32_bf16 v[84:87], a[32:35], v[164:167], v[84:87]
  s_add_u32 s46, s46, 10240
  s_add_u32 m0, s47, 2048
  s_nop 0
  buffer_load_dwordx4 v10, s[8:11], s46 offen lds
  ds_read_b128 v[200:203], v19 offset:4096
  s_waitcnt lgkmcnt(8)
  v_mfma_f32_16x16x32_bf16 v[88:91], a[24:27], v[168:171], v[88:91]
  v_mfma_f32_16x16x32_bf16 v[92:95], a[28:31], v[168:171], v[92:95]
  v_mfma_f32_16x16x32_bf16 v[96:99], a[32:35], v[168:171], v[96:99]
  ds_read_b128 v[204:207], v19 offset:6144
  s_waitcnt lgkmcnt(8)
  v_mfma_f32_16x16x32_bf16 v[100:103], a[24:27], v[172:175], v[100:103]
  v_mfma_f32_16x16x32_bf16 v[104:107], a[28:31], v[172:175], v[104:107]
  v_mfma_f32_16x16x32_bf16 v[108:111], a[32:35], v[172:175], v[108:111]
  ds_read_b128 v[208:211], v19 offset:8192
  s_waitcnt lgkmcnt(8)
  v_mfma_f32_16x16x32_bf16 v[112:115], a[24:27], v[176:179], v[112:115]
  v_mfma_f32_16x16x32_bf16 v[116:119], a[28:31], v[176:179], v[116:119]
  v_mfma_f32_16x16x32_bf16 v[120:123], a[32:35], v[176:179], v[120:123]
  ds_read_b128 v[212:215], v19 offset:10240
  s_waitcnt lgkmcnt(8)
  v_mfma_f32_16x16x32_bf16 v[124:127], a[24:27], v[180:183], v[124:127]
  v_mfma_f32_16x16x32_bf16 v[128:131], a[28:31], v[180:183], v[128:131]
  v_mfma_f32_16x16x32_bf16 v[132:135], a[32:35], v[180:183], v[132:135]
  s_add_u32 s46, s46, 10240
  s_add_u32 m0, s47, 3072
  s_nop 0
  buffer_load_dwordx4 v10, s[8:11], s46 offen lds
  ds_read_b128 v[216:219], v19 offset:12288
  s_waitcnt lgkmcnt(8)
  v_mfma_f32_16x16x32_bf16 v[136:139], a[24:27], v[184:187], v[136:139]
  v_mfma_f32_16x16x32_bf16 v[140:143], a[28:31], v[184:187], v[140:143]
  v_mfma_f32_16x16x32_bf16 v[144:147], a[32:35], v[184:187], v[144:147]
  ds_read_b128 v[220:223], v19 offset:14336
  s_waitcnt lgkmcnt(8)
  v_mfma_f32_16x16x32_bf16 v[148:151], a[24:27], v[188:191], v[148:151]
  v_mfma_f32_16x16x32_bf16 v[152:155], a[28:31], v[188:191], v[152:155]
  v_mfma_f32_16x16x32_bf16 v[156:159], a[32:35], v[188:191], v[156:159]
  s_waitcnt vmcnt(12)
  s_barrier
  s_add_u32 s30, s30, 128
  s_add_u32 s31, s31, 1
  s_cmp_lt_u32 s31, 10
  s_cbranch_scc1 qa_277
  s_mov_b32 s31, 0
  s_add_u32 s30, s30, s25
  s_sub_u32 s30, s30, 1280
  s_mov_b32 s25, 163840
qa_277:
  s_add_u32 s32, s32, 16384
  s_cmp_lt_u32 s32, 98304
  s_cselect_b32 s32, s32, 0
  s_mul_i32 s46, s20, 40960
  s_add_u32 s46, s46, s30
  s_lshl_b32 s47, s20, 12
  s_add_u32 s47, s47, s32
  v_add_u32 v18, s33, v14
  v_add_u32 v19, s33, v15
  s_add_u32 s33, s33, 16384
  s_cmp_lt_u32 s33, 98304
  s_cselect_b32 s33, s33, 0
  ds_read_b128 v[160:163], v18 offset:0
  s_waitcnt lgkmcnt(8)
  v_mfma_f32_16x16x32_bf16 v[64:67], a[36:39], v[192:195], v[64:67]
  v_mfma_f32_16x16x32_bf16 v[68:71], a[40:43], v[192:195], v[68:71]
  v_mfma_f32_16x16x32_bf16 v[72:75], a[44:47], v[192:195], v[72:75]
  ds_read_b128 v[164:167], v18 offset:2048
  s_waitcnt lgkmcnt(8)
  v_mfma_f32_16x16x32_bf16 v[76:79], a[36:39], v[196:199], v[76:79]
  v_mfma_f32_16x16x32_bf16 v[80:83], a[40:43], v[196:199], v[80:83]
  v_mfma_f32_16x16x32_bf16 v[84:87], a[44:47], v[196:199], v[84:87]
  s_add_u32 m0, s47, 0
  s_nop 0
  buffer_load_dwordx4 v10, s[8:11], s46 offen lds
  ds_read_b128 v[168:171], v18 offset:4096
  s_waitcnt lgkmcnt(8)
  v_mfma_f32_16x16x32_bf16 v[88:91], a[36:39], v[200:203], v[88:91]
  v_mfma_f32_16x16x32_bf16 v[92:95], a[40:43], v[200:203], v[92:95]
  v_mfma_f32_16x16x32_bf16 v[96:99], a[44:47], v[200:203], v[96:99]
  ds_read_b128 v[172:175], v18 offset:6144
  s_waitcnt lgkmcnt(8)
  v_mfma_f32_16x16x32_bf16 v[100:103], a[36:39], v[204:207], v[100:103]
  v_mfma_f32_16x16x32_bf16 v[104:107], a[40:43], v[204:207], v[104:107]
  v_mfma_f32_16x16x32_bf16 v[108:111], a[44:47], v[204:207], v[108:111]
  ds_read_b128 v[176:179], v18 offset:8192
  s_waitcnt lgkmcnt(8)
  v_mfma_f32_16x16x32_bf16 v[112:115], a[36:39], v[208:211], v[112:115]
  v_mfma_f32_16x16x32_bf16 v[116:119], a[40:43], v[208:211], v[116:119]
  v_mfma_f32_16x16x32_bf16 v[120:123], a[44:47], v[208:211], v[120:123]
  ds_read_b128 v[180:183], v18 offset:10240
  s_waitcnt lgkmcnt(8)
  v_mfma_f32_16x16x32_bf16 v[124:127], a[36:39], v[212:215], v[124:127]
  v_mfma_f32_16x16x32_bf16 v[128:131], a[40:43], v[212:215], v[128:131]
  v_mfma_f32_16x16x32_bf16 v[132:135], a[44:47], v[212:215], v[132:135]
  s_add_u32 s46, s46, 10240
  s_add_u32 m0, s47, 1024
  s_nop 0
  buffer_load_dwordx4 v10, s[8:11], s46 offen lds
  ds_read_b128 v[184:187], v18 offset:12288
  s_waitcnt lgkmcnt(8)
  v_mfma_f32_16x16x32_bf16 v[136:139], a[36:39], v[216:219], v[136:139]
  v_mfma_f32_16x16x32_bf16 v[140:143], a[40:43], v[216:219], v[140:143]
  v_mfma_f32_16x16x32_bf16 v[144:147], a[44:47], v[216:219], v[144:147]
  ds_read_b128 v[188:191], v18 offset:14336
  s_waitcnt lgkmcnt(8)
  v_mfma_f32_16x16x32_bf16 v[148:151], a[36:39], v[220:223], v[148:151]
  v_mfma_f32_16x16x32_bf16 v[152:155], a[40:43], v[220:223], v[152:155]
  v_mfma_f32_16x16x32_bf16 v[156:159], a[44:47], v[220:223], v[156:159]
  ds_read_b128 v[192:195], v19 offset:0
  s_waitcnt lgkmcnt(8)
  v_mfma_f32_16x16x32_bf16 v[64:67], a[48:51], v[160:163], v[64:67]
  v_mfma_f32_16x16x32_bf16 v[68:71], a[52:55], v[160:163], v[68:71]
  v_mfma_f32_16x16x32_bf16 v[72:75], a[56:59], v[160:163], v[72:75]
  ds_read_b128 v[196:199], v19 offset:2048
  s_waitcnt lgkmcnt(8)
  v_mfma_f32_16x16x32_bf16 v[76:79], a[48:51], v[164:167], v[76:79]
  v_mfma_f32_16x16x32_bf16 v[80:83], a[52:55], v[164:167], v[80:83]
  v_mfma_f32_16x16x32_bf16 v[84:87], a[56:59], v[164:167], v[84:87]
  s_add_u32 s46, s46, 10240
  s_add_u32 m0, s47, 2048
  s_nop 0
  buffer_load_dwordx4 v10, s[8:11], s46 offen lds
  ds_read_b128 v[200:203], v19 offset:4096
  s_waitcnt lgkmcnt(8)
  v_mfma_f32_16x16x32_bf16 v[88:91], a[48:51], v[168:171], v[88:91]
  v_mfma_f32_16x16x32_bf16 v[92:95], a[52:55], v[168:171], v[92:95]
  v_mfma_f32_16x16x32_bf16 v[96:99], a[56:59], v[168:171], v[96:99]
  ds_read_b128 v[204:207], v19 offset:6144
  s_waitcnt lgkmcnt(8)
  v_mfma_f32_16x16x32_bf16 v[100:103], a[48:51], v[172:175], v[100:103]
  v_mfma_f32_16x16x32_bf16 v[104:107], a[52:55], v[172:175], v[104:107]
  v_mfma_f32_16x16x32_bf16 v[108:111], a[56:59], v[172:175], v[108:111]
  ds_read_b128 v[208:211], v19 offset:8192
  s_waitcnt lgkmcnt(8)
  v_mfma_f32_16x16x32_bf16 v[112:115], a[48:51], v[176:179], v[112:115]
  v_mfma_f32_16x16x32_bf16 v[116:119], a[52:55], v[176:179], v[116:119]
  v_mfma_f32_16x16x32_bf16 v[120:123], a[56:59], v[176:179], v[120:123]
  ds_read_b128 v[212:215], v19 offset:10240
  s_waitcnt lgkmcnt(8)
  v_mfma_f32_16x16x32_bf16 v[124:127], a[48:51], v[180:183], v[124:127]
  v_mfma_f32_16x16x32_bf16 v[128:131], a[52:55], v[180:183], v[128:131]
  v_mfma_f32_16x16x32_bf16 v[132:135], a[56:59], v[180:183], v[132:135]
  s_add_u32 s46, s46, 10240
  s_add_u32 m0, s47, 3072
  s_nop 0
  buffer_load_dwordx4 v10, s[8:11], s46 offen lds
  ds_read_b128 v[216:219], v19 offset:12288
  s_waitcnt lgkmcnt(8)
  v_mfma_f32_16x16x32_bf16 v[136:139], a[48:51], v[184:187], v[136:139]
  v_mfma_f32_16x16x32_bf16 v[140:143], a[52:55], v[184:187], v[140:143]
  v_mfma_f32_16x16x32_bf16 v[144:147], a[56:59], v[184:187], v[144:147]
  ds_read_b128 v[220:223], v19 offset:14336
  s_waitcnt lgkmcnt(8)
  v_mfma_f32_16x16x32_bf16 v[148:151], a[48:51], v[188:191], v[148:151]
  v_mfma_f32_16x16x32_bf16 v[152:155], a[52:55], v[188:191], v[152:155]
  v_mfma_f32_16x16x32_bf16 v[156:159], a[56:59], v[188:191], v[156:159]
  s_waitcnt vmcnt(12)
  s_barrier
  s_waitcnt vmcnt(10)
  s_cmp_eq_u32 s78, 0
  s_cbranch_scc1 pf_278
  v_mov_b32 v4, 0
  v_mov_b32 v5, 1
  s_mov_b64 exec, 1
  buffer_atomic_add v5, v4, s[72:75], s78 offen sc1
  s_mov_b64 exec, -1
  s_mov_b32 s78, 0
pf_278:
  s_mul_i32 s21, s49, 393216
  s_mul_i32 s22, s42, 12288
  s_add_u32 s50, s21, s22
  s_mul_i32 s21, s49, 98304
  s_mul_i32 s22, s42, 3072
  s_add_u32 s51, s21, s22
  s_lshr_b32 s22, s49, 1
  s_lshr_b32 s21, s49, 2
  s_add_u32 s21, s21, 2
  s_cmp_lt_u32 s49, 8
  s_cselect_b32 s21, s22, s21
  s_lshl_b32 s21, s21, 3
  s_lshr_b32 s22, s42, 2
  s_add_u32 s21, s21, s22
  s_lshl_b32 s21, s21, 7
  s_add_u32 s76, s21, 0
  s_lshl_b32 s77, s42, 7
  s_add_u32 s77, s77, 18432
  v_mov_b32 v4, 0
  buffer_load_dword v20, v4, s[72:75], s76 offen sc1
  s_add_u32 s30, s30, 128
  s_add_u32 s31, s31, 1
  s_cmp_lt_u32 s31, 10
  s_cbranch_scc1 qa_279
  s_mov_b32 s31, 0
  s_add_u32 s30, s30, s25
  s_sub_u32 s30, s30, 1280
  s_mov_b32 s25, 163840
qa_279:
  s_add_u32 s32, s32, 16384
  s_cmp_lt_u32 s32, 98304
  s_cselect_b32 s32, s32, 0
  s_mul_i32 s46, s20, 40960
  s_add_u32 s46, s46, s30
  s_lshl_b32 s47, s20, 12
  s_add_u32 s47, s47, s32
  v_add_u32 v18, s33, v14
  v_add_u32 v19, s33, v15
  s_add_u32 s33, s33, 16384
  s_cmp_lt_u32 s33, 98304
  s_cselect_b32 s33, s33, 0
  ds_read_b128 v[160:163], v18 offset:0
  s_waitcnt lgkmcnt(8)
  v_mfma_f32_16x16x32_bf16 v[64:67], a[60:63], v[192:195], v[64:67]
  v_mfma_f32_16x16x32_bf16 v[68:71], a[64:67], v[192:195], v[68:71]
  v_mfma_f32_16x16x32_bf16 v[72:75], a[68:71], v[192:195], v[72:75]
  ds_read_b128 v[164:167], v18 offset:2048
  s_waitcnt lgkmcnt(8)
  v_mfma_f32_16x16x32_bf16 v[76:79], a[60:63], v[196:199], v[76:79]
  v_mfma_f32_16x16x32_bf16 v[80:83], a[64:67], v[196:199], v[80:83]
  v_mfma_f32_16x16x32_bf16 v[84:87], a[68:71], v[196:199], v[84:87]
  s_add_u32 m0, s47, 0
  s_nop 0
  buffer_load_dwordx4 v10, s[8:11], s46 offen lds
  ds_read_b128 v[168:171], v18 offset:4096
  s_waitcnt lgkmcnt(8)
  v_mfma_f32_16x16x32_bf16 v[88:91], a[60:63], v[200:203], v[88:91]
  v_mfma_f32_16x16x32_bf16 v[92:95], a[64:67], v[200:203], v[92:95]
  v_mfma_f32_16x16x32_bf16 v[96:99], a[68:71], v[200:203], v[96:99]
  ds_read_b128 v[172:175], v18 offset:6144
  s_waitcnt lgkmcnt(8)
  v_mfma_f32_16x16x32_bf16 v[100:103], a[60:63], v[204:207], v[100:103]
  v_mfma_f32_16x16x32_bf16 v[104:107], a[64:67], v[204:207], v[104:107]
  v_mfma_f32_16x16x32_bf16 v[108:111], a[68:71], v[204:207], v[108:111]
  ds_read_b128 v[176:179], v18 offset:8192
  s_waitcnt lgkmcnt(8)
  v_mfma_f32_16x16x32_bf16 v[112:115], a[60:63], v[208:211], v[112:115]
  v_mfma_f32_16x16x32_bf16 v[116:119], a[64:67], v[208:211], v[116:119]
  v_mfma_f32_16x16x32_bf16 v[120:123], a[68:71], v[208:211], v[120:123]
  ds_read_b128 v[180:183], v18 offset:10240
  s_waitcnt lgkmcnt(8)
  v_mfma_f32_16x16x32_bf16 v[124:127], a[60:63], v[212:215], v[124:127]
  v_mfma_f32_16x16x32_bf16 v[128:131], a[64:67], v[212:215], v[128:131]
  v_mfma_f32_16x16x32_bf16 v[132:135], a[68:71], v[212:215], v[132:135]
  s_add_u32 s46, s46, 10240
  s_add_u32 m0, s47, 1024
  s_nop 0
  buffer_load_dwordx4 v10, s[8:11], s46 offen lds
  ds_read_b128 v[184:187], v18 offset:12288
  s_waitcnt lgkmcnt(8)
  v_mfma_f32_16x16x32_bf16 v[136:139], a[60:63], v[216:219], v[136:139]
  v_mfma_f32_16x16x32_bf16 v[140:143], a[64:67], v[216:219], v[140:143]
  v_mfma_f32_16x16x32_bf16 v[144:147], a[68:71], v[216:219], v[144:147]
  ds_read_b128 v[188:191], v18 offset:14336
  s_waitcnt lgkmcnt(8)
  v_mfma_f32_16x16x32_bf16 v[148:151], a[60:63], v[220:223], v[148:151]
  v_mfma_f32_16x16x32_bf16 v[152:155], a[64:67], v[220:223], v[152:155]
  v_mfma_f32_16x16x32_bf16 v[156:159], a[68:71], v[220:223], v[156:159]
  ds_read_b128 v[192:195], v19 offset:0
  s_waitcnt lgkmcnt(8)
  v_mfma_f32_16x16x32_bf16 v[64:67], a[72:75], v[160:163], v[64:67]
  v_mfma_f32_16x16x32_bf16 v[68:71], a[76:79], v[160:163], v[68:71]
  v_mfma_f32_16x16x32_bf16 v[72:75], a[80:83], v[160:163], v[72:75]
  ds_read_b128 v[196:199], v19 offset:2048
  s_waitcnt lgkmcnt(8)
  v_mfma_f32_16x16x32_bf16 v[76:79], a[72:75], v[164:167], v[76:79]
  v_mfma_f32_16x16x32_bf16 v[80:83], a[76:79], v[164:167], v[80:83]
  v_mfma_f32_16x16x32_bf16 v[84:87], a[80:83], v[164:167], v[84:87]
  s_add_u32 s46, s46, 10240
  s_add_u32 m0, s47, 2048
  s_nop 0
  buffer_load_dwordx4 v10, s[8:11], s46 offen lds
  ds_read_b128 v[200:203], v19 offset:4096
  s_waitcnt lgkmcnt(8)
  v_mfma_f32_16x16x32_bf16 v[88:91], a[72:75], v[168:171], v[88:91]
  v_mfma_f32_16x16x32_bf16 v[92:95], a[76:79], v[168:171], v[92:95]
  v_mfma_f32_16x16x32_bf16 v[96:99], a[80:83], v[168:171], v[96:99]
  ds_read_b128 v[204:207], v19 offset:6144
  s_waitcnt lgkmcnt(8)
  v_mfma_f32_16x16x32_bf16 v[100:103], a[72:75], v[172:175], v[100:103]
  v_mfma_f32_16x16x32_bf16 v[104:107], a[76:79], v[172:175], v[104:107]
  v_mfma_f32_16x16x32_bf16 v[108:111], a[80:83], v[172:175], v[108:111]
  ds_read_b128 v[208:211], v19 offset:8192
  s_waitcnt lgkmcnt(8)
  v_mfma_f32_16x16x32_bf16 v[112:115], a[72:75], v[176:179], v[112:115]
  v_mfma_f32_16x16x32_bf16 v[116:119], a[76:79], v[176:179], v[116:119]
  v_mfma_f32_16x16x32_bf16 v[120:123], a[80:83], v[176:179], v[120:123]
  ds_read_b128 v[212:215], v19 offset:10240
  s_waitcnt lgkmcnt(8)
  v_mfma_f32_16x16x32_bf16 v[124:127], a[72:75], v[180:183], v[124:127]
  v_mfma_f32_16x16x32_bf16 v[128:131], a[76:79], v[180:183], v[128:131]
  v_mfma_f32_16x16x32_bf16 v[132:135], a[80:83], v[180:183], v[132:135]
  s_add_u32 s46, s46, 10240
  s_add_u32 m0, s47, 3072
  s_nop 0
  buffer_load_dwordx4 v10, s[8:11], s46 offen lds
  ds_read_b128 v[216:219], v19 offset:12288
  s_waitcnt lgkmcnt(8)
  v_mfma_f32_16x16x32_bf16 v[136:139], a[72:75], v[184:187], v[136:139]
  v_mfma_f32_16x16x32_bf16 v[140:143], a[76:79], v[184:187], v[140:143]
  v_mfma_f32_16x16x32_bf16 v[144:147], a[80:83], v[184:187], v[144:147]
  ds_read_b128 v[220:223], v19 offset:14336
  s_waitcnt lgkmcnt(8)
  v_mfma_f32_16x16x32_bf16 v[148:151], a[72:75], v[188:191], v[148:151]
  v_mfma_f32_16x16x32_bf16 v[152:155], a[76:79], v[188:191], v[152:155]
  v_mfma_f32_16x16x32_bf16 v[156:159], a[80:83], v[188:191], v[156:159]
  s_waitcnt vmcnt(13)
  s_barrier
  s_add_u32 s30, s30, 128
  s_add_u32 s31, s31, 1
  s_cmp_lt_u32 s31, 10
  s_cbranch_scc1 qa_280
  s_mov_b32 s31, 0
  s_add_u32 s30, s30, s25
  s_sub_u32 s30, s30, 1280
  s_mov_b32 s25, 163840
qa_280:
  s_add_u32 s32, s32, 16384
  s_cmp_lt_u32 s32, 98304
  s_cselect_b32 s32, s32, 0
  s_mul_i32 s46, s20, 40960
  s_add_u32 s46, s46, s30
  s_lshl_b32 s47, s20, 12
  s_add_u32 s47, s47, s32
  v_add_u32 v18, s33, v14
  v_add_u32 v19, s33, v15
  s_add_u32 s33, s33, 16384
  s_cmp_lt_u32 s33, 98304
  s_cselect_b32 s33, s33, 0
  ds_read_b128 v[160:163], v18 offset:0
  s_waitcnt lgkmcnt(8)
  v_mfma_f32_16x16x32_bf16 v[64:67], a[84:87], v[192:195], v[64:67]
  v_mfma_f32_16x16x32_bf16 v[68:71], a[88:91], v[192:195], v[68:71]
  v_mfma_f32_16x16x32_bf16 v[72:75], a[92:95], v[192:195], v[72:75]
  ds_read_b128 v[164:167], v18 offset:2048
  s_waitcnt lgkmcnt(8)
  v_mfma_f32_16x16x32_bf16 v[76:79], a[84:87], v[196:199], v[76:79]
  v_mfma_f32_16x16x32_bf16 v[80:83], a[88:91], v[196:199], v[80:83]
  v_mfma_f32_16x16x32_bf16 v[84:87], a[92:95], v[196:199], v[84:87]
  s_add_u32 m0, s47, 0
  s_nop 0
  buffer_load_dwordx4 v10, s[8:11], s46 offen lds
  ds_read_b128 v[168:171], v18 offset:4096
  s_waitcnt lgkmcnt(8)
  v_mfma_f32_16x16x32_bf16 v[88:91], a[84:87], v[200:203], v[88:91]
  v_mfma_f32_16x16x32_bf16 v[92:95], a[88:91], v[200:203], v[92:95]
  v_mfma_f32_16x16x32_bf16 v[96:99], a[92:95], v[200:203], v[96:99]
  ds_read_b128 v[172:175], v18 offset:6144
  s_waitcnt lgkmcnt(8)
  v_mfma_f32_16x16x32_bf16 v[100:103], a[84:87], v[204:207], v[100:103]
  v_mfma_f32_16x16x32_bf16 v[104:107], a[88:91], v[204:207], v[104:107]
  v_mfma_f32_16x16x32_bf16 v[108:111], a[92:95], v[204:207], v[108:111]
  ds_read_b128 v[176:179], v18 offset:8192
  s_waitcnt lgkmcnt(8)
  v_mfma_f32_16x16x32_bf16 v[112:115], a[84:87], v[208:211], v[112:115]
  v_mfma_f32_16x16x32_bf16 v[116:119], a[88:91], v[208:211], v[116:119]
  v_mfma_f32_16x16x32_bf16 v[120:123], a[92:95], v[208:211], v[120:123]
  ds_read_b128 v[180:183], v18 offset:10240
  s_waitcnt lgkmcnt(8)
  v_mfma_f32_16x16x32_bf16 v[124:127], a[84:87], v[212:215], v[124:127]
  v_mfma_f32_16x16x32_bf16 v[128:131], a[88:91], v[212:215], v[128:131]
  v_mfma_f32_16x16x32_bf16 v[132:135], a[92:95], v[212:215], v[132:135]
  s_add_u32 s46, s46, 10240
  s_add_u32 m0, s47, 1024
  s_nop 0
  buffer_load_dwordx4 v10, s[8:11], s46 offen lds
  ds_read_b128 v[184:187], v18 offset:12288
  s_waitcnt lgkmcnt(8)
  v_mfma_f32_16x16x32_bf16 v[136:139], a[84:87], v[216:219], v[136:139]
  v_mfma_f32_16x16x32_bf16 v[140:143], a[88:91], v[216:219], v[140:143]
  v_mfma_f32_16x16x32_bf16 v[144:147], a[92:95], v[216:219], v[144:147]
  ds_read_b128 v[188:191], v18 offset:14336
  s_waitcnt lgkmcnt(8)
  v_mfma_f32_16x16x32_bf16 v[148:151], a[84:87], v[220:223], v[148:151]
  v_mfma_f32_16x16x32_bf16 v[152:155], a[88:91], v[220:223], v[152:155]
  v_mfma_f32_16x16x32_bf16 v[156:159], a[92:95], v[220:223], v[156:159]
  ds_read_b128 v[192:195], v19 offset:0
  s_waitcnt lgkmcnt(8)
  v_mfma_f32_16x16x32_bf16 v[64:67], a[96:99], v[160:163], v[64:67]
  v_mfma_f32_16x16x32_bf16 v[68:71], a[100:103], v[160:163], v[68:71]
  v_mfma_f32_16x16x32_bf16 v[72:75], a[104:107], v[160:163], v[72:75]
  ds_read_b128 v[196:199], v19 offset:2048
  s_waitcnt lgkmcnt(8)
  v_mfma_f32_16x16x32_bf16 v[76:79], a[96:99], v[164:167], v[76:79]
  v_mfma_f32_16x16x32_bf16 v[80:83], a[100:103], v[164:167], v[80:83]
  v_mfma_f32_16x16x32_bf16 v[84:87], a[104:107], v[164:167], v[84:87]
  s_add_u32 s46, s46, 10240
  s_add_u32 m0, s47, 2048
  s_nop 0
  buffer_load_dwordx4 v10, s[8:11], s46 offen lds
  ds_read_b128 v[200:203], v19 offset:4096
  s_waitcnt lgkmcnt(8)
  v_mfma_f32_16x16x32_bf16 v[88:91], a[96:99], v[168:171], v[88:91]
  v_mfma_f32_16x16x32_bf16 v[92:95], a[100:103], v[168:171], v[92:95]
  v_mfma_f32_16x16x32_bf16 v[96:99], a[104:107], v[168:171], v[96:99]
  ds_read_b128 v[204:207], v19 offset:6144
  s_waitcnt lgkmcnt(8)
  v_mfma_f32_16x16x32_bf16 v[100:103], a[96:99], v[172:175], v[100:103]
  v_mfma_f32_16x16x32_bf16 v[104:107], a[100:103], v[172:175], v[104:107]
  v_mfma_f32_16x16x32_bf16 v[108:111], a[104:107], v[172:175], v[108:111]
  ds_read_b128 v[208:211], v19 offset:8192
  s_waitcnt lgkmcnt(8)
  v_mfma_f32_16x16x32_bf16 v[112:115], a[96:99], v[176:179], v[112:115]
  v_mfma_f32_16x16x32_bf16 v[116:119], a[100:103], v[176:179], v[116:119]
  v_mfma_f32_16x16x32_bf16 v[120:123], a[104:107], v[176:179], v[120:123]
  ds_read_b128 v[212:215], v19 offset:10240
  s_waitcnt lgkmcnt(8)
  v_mfma_f32_16x16x32_bf16 v[124:127], a[96:99], v[180:183], v[124:127]
  v_mfma_f32_16x16x32_bf16 v[128:131], a[100:103], v[180:183], v[128:131]
  v_mfma_f32_16x16x32_bf16 v[132:135], a[104:107], v[180:183], v[132:135]
  s_add_u32 s46, s46, 10240
  s_add_u32 m0, s47, 3072
  s_nop 0
  buffer_load_dwordx4 v10, s[8:11], s46 offen lds
  ds_read_b128 v[216:219], v19 offset:12288
  s_waitcnt lgkmcnt(8)
  v_mfma_f32_16x16x32_bf16 v[136:139], a[96:99], v[184:187], v[136:139]
  v_mfma_f32_16x16x32_bf16 v[140:143], a[100:103], v[184:187], v[140:143]
  v_mfma_f32_16x16x32_bf16 v[144:147], a[104:107], v[184:187], v[144:147]
  ds_read_b128 v[220:223], v19 offset:14336
  s_waitcnt lgkmcnt(8)
  v_mfma_f32_16x16x32_bf16 v[148:151], a[96:99], v[188:191], v[148:151]
  v_mfma_f32_16x16x32_bf16 v[152:155], a[100:103], v[188:191], v[152:155]
  v_mfma_f32_16x16x32_bf16 v[156:159], a[104:107], v[188:191], v[156:159]
  s_waitcnt vmcnt(13)
  s_barrier
  s_add_u32 s30, s30, 128
  s_add_u32 s31, s31, 1
  s_cmp_lt_u32 s31, 10
  s_cbranch_scc1 qa_281
  s_mov_b32 s31, 0
  s_add_u32 s30, s30, s25
  s_sub_u32 s30, s30, 1280
  s_mov_b32 s25, 163840
qa_281:
  s_add_u32 s32, s32, 16384
  s_cmp_lt_u32 s32, 98304
  s_cselect_b32 s32, s32, 0
  s_mul_i32 s46, s20, 40960
  s_add_u32 s46, s46, s30
  s_lshl_b32 s47, s20, 12
  s_add_u32 s47, s47, s32
  v_add_u32 v18, s33, v14
  v_add_u32 v19, s33, v15
  s_add_u32 s33, s33, 16384
  s_cmp_lt_u32 s33, 98304
  s_cselect_b32 s33, s33, 0
  ds_read_b128 v[160:163], v18 offset:0
  s_waitcnt lgkmcnt(8)
  v_mfma_f32_16x16x32_bf16 v[64:67], a[108:111], v[192:195], v[64:67]
  v_mfma_f32_16x16x32_bf16 v[68:71], a[112:115], v[192:195], v[68:71]
  v_mfma_f32_16x16x32_bf16 v[72:75], a[116:119], v[192:195], v[72:75]
  ds_read_b128 v[164:167], v18 offset:2048
  s_waitcnt lgkmcnt(8)
  v_mfma_f32_16x16x32_bf16 v[76:79], a[108:111], v[196:199], v[76:79]
  v_mfma_f32_16x16x32_bf16 v[80:83], a[112:115], v[196:199], v[80:83]
  v_mfma_f32_16x16x32_bf16 v[84:87], a[116:119], v[196:199], v[84:87]
  s_add_u32 m0, s47, 0
  s_nop 0
  buffer_load_dwordx4 v10, s[8:11], s46 offen lds
  ds_read_b128 v[168:171], v18 offset:4096
  s_waitcnt lgkmcnt(8)
  v_mfma_f32_16x16x32_bf16 v[88:91], a[108:111], v[200:203], v[88:91]
  v_mfma_f32_16x16x32_bf16 v[92:95], a[112:115], v[200:203], v[92:95]
  v_mfma_f32_16x16x32_bf16 v[96:99], a[116:119], v[200:203], v[96:99]
  ds_read_b128 v[172:175], v18 offset:6144
  s_waitcnt lgkmcnt(8)
  v_mfma_f32_16x16x32_bf16 v[100:103], a[108:111], v[204:207], v[100:103]
  v_mfma_f32_16x16x32_bf16 v[104:107], a[112:115], v[204:207], v[104:107]
  v_mfma_f32_16x16x32_bf16 v[108:111], a[116:119], v[204:207], v[108:111]
  ds_read_b128 v[176:179], v18 offset:8192
  s_waitcnt lgkmcnt(8)
  v_mfma_f32_16x16x32_bf16 v[112:115], a[108:111], v[208:211], v[112:115]
  v_mfma_f32_16x16x32_bf16 v[116:119], a[112:115], v[208:211], v[116:119]
  v_mfma_f32_16x16x32_bf16 v[120:123], a[116:119], v[208:211], v[120:123]
  ds_read_b128 v[180:183], v18 offset:10240
  s_waitcnt lgkmcnt(8)
  v_mfma_f32_16x16x32_bf16 v[124:127], a[108:111], v[212:215], v[124:127]
  v_mfma_f32_16x16x32_bf16 v[128:131], a[112:115], v[212:215], v[128:131]
  v_mfma_f32_16x16x32_bf16 v[132:135], a[116:119], v[212:215], v[132:135]
  s_add_u32 s46, s46, 10240
  s_add_u32 m0, s47, 1024
  s_nop 0
  buffer_load_dwordx4 v10, s[8:11], s46 offen lds
  ds_read_b128 v[184:187], v18 offset:12288
  s_waitcnt lgkmcnt(8)
  v_mfma_f32_16x16x32_bf16 v[136:139], a[108:111], v[216:219], v[136:139]
  v_mfma_f32_16x16x32_bf16 v[140:143], a[112:115], v[216:219], v[140:143]
  v_mfma_f32_16x16x32_bf16 v[144:147], a[116:119], v[216:219], v[144:147]
  ds_read_b128 v[188:191], v18 offset:14336
  s_waitcnt lgkmcnt(8)
  v_mfma_f32_16x16x32_bf16 v[148:151], a[108:111], v[220:223], v[148:151]
  v_mfma_f32_16x16x32_bf16 v[152:155], a[112:115], v[220:223], v[152:155]
  v_mfma_f32_16x16x32_bf16 v[156:159], a[116:119], v[220:223], v[156:159]
  ds_read_b128 v[192:195], v19 offset:0
  s_waitcnt lgkmcnt(8)
  v_mfma_f32_16x16x32_bf16 v[64:67], a[120:123], v[160:163], v[64:67]
  v_mfma_f32_16x16x32_bf16 v[68:71], a[124:127], v[160:163], v[68:71]
  v_mfma_f32_16x16x32_bf16 v[72:75], a[128:131], v[160:163], v[72:75]
  ds_read_b128 v[196:199], v19 offset:2048
  s_waitcnt lgkmcnt(8)
  v_mfma_f32_16x16x32_bf16 v[76:79], a[120:123], v[164:167], v[76:79]
  v_mfma_f32_16x16x32_bf16 v[80:83], a[124:127], v[164:167], v[80:83]
  v_mfma_f32_16x16x32_bf16 v[84:87], a[128:131], v[164:167], v[84:87]
  s_add_u32 s46, s46, 10240
  s_add_u32 m0, s47, 2048
  s_nop 0
  buffer_load_dwordx4 v10, s[8:11], s46 offen lds
  ds_read_b128 v[200:203], v19 offset:4096
  s_waitcnt lgkmcnt(8)
  v_mfma_f32_16x16x32_bf16 v[88:91], a[120:123], v[168:171], v[88:91]
  v_mfma_f32_16x16x32_bf16 v[92:95], a[124:127], v[168:171], v[92:95]
  v_mfma_f32_16x16x32_bf16 v[96:99], a[128:131], v[168:171], v[96:99]
  ds_read_b128 v[204:207], v19 offset:6144
  s_waitcnt lgkmcnt(8)
  v_mfma_f32_16x16x32_bf16 v[100:103], a[120:123], v[172:175], v[100:103]
  v_mfma_f32_16x16x32_bf16 v[104:107], a[124:127], v[172:175], v[104:107]
  v_mfma_f32_16x16x32_bf16 v[108:111], a[128:131], v[172:175], v[108:111]
  ds_read_b128 v[208:211], v19 offset:8192
  s_waitcnt lgkmcnt(8)
  v_mfma_f32_16x16x32_bf16 v[112:115], a[120:123], v[176:179], v[112:115]
  v_mfma_f32_16x16x32_bf16 v[116:119], a[124:127], v[176:179], v[116:119]
  v_mfma_f32_16x16x32_bf16 v[120:123], a[128:131], v[176:179], v[120:123]
  ds_read_b128 v[212:215], v19 offset:10240
  s_waitcnt lgkmcnt(8)
  v_mfma_f32_16x16x32_bf16 v[124:127], a[120:123], v[180:183], v[124:127]
  v_mfma_f32_16x16x32_bf16 v[128:131], a[124:127], v[180:183], v[128:131]
  v_mfma_f32_16x16x32_bf16 v[132:135], a[128:131], v[180:183], v[132:135]
  s_add_u32 s46, s46, 10240
  s_add_u32 m0, s47, 3072
  s_nop 0
  buffer_load_dwordx4 v10, s[8:11], s46 offen lds
  ds_read_b128 v[216:219], v19 offset:12288
  s_waitcnt lgkmcnt(8)
  v_mfma_f32_16x16x32_bf16 v[136:139], a[120:123], v[184:187], v[136:139]
  v_mfma_f32_16x16x32_bf16 v[140:143], a[124:127], v[184:187], v[140:143]
  v_mfma_f32_16x16x32_bf16 v[144:147], a[128:131], v[184:187], v[144:147]
  ds_read_b128 v[220:223], v19 offset:14336
  s_waitcnt lgkmcnt(8)
  v_mfma_f32_16x16x32_bf16 v[148:151], a[120:123], v[188:191], v[148:151]
  v_mfma_f32_16x16x32_bf16 v[152:155], a[124:127], v[188:191], v[152:155]
  v_mfma_f32_16x16x32_bf16 v[156:159], a[128:131], v[188:191], v[156:159]
  s_waitcnt vmcnt(13)
  s_barrier
  s_add_u32 s30, s30, 128
  s_add_u32 s31, s31, 1
  s_cmp_lt_u32 s31, 10
  s_cbranch_scc1 qa_282
  s_mov_b32 s31, 0
  s_add_u32 s30, s30, s25
  s_sub_u32 s30, s30, 1280
  s_mov_b32 s25, 163840
qa_282:
  s_add_u32 s32, s32, 16384
  s_cmp_lt_u32 s32, 98304
  s_cselect_b32 s32, s32, 0
  s_mul_i32 s46, s20, 40960
  s_add_u32 s46, s46, s30
  s_lshl_b32 s47, s20, 12
  s_add_u32 s47, s47, s32
  v_add_u32 v18, s33, v14
  v_add_u32 v19, s33, v15
  s_add_u32 s33, s33, 16384
  s_cmp_lt_u32 s33, 98304
  s_cselect_b32 s33, s33, 0
  ds_read_b128 v[160:163], v18 offset:0
  s_waitcnt lgkmcnt(8)
  v_mfma_f32_16x16x32_bf16 v[64:67], a[132:135], v[192:195], v[64:67]
  v_mfma_f32_16x16x32_bf16 v[68:71], a[136:139], v[192:195], v[68:71]
  v_mfma_f32_16x16x32_bf16 v[72:75], a[140:143], v[192:195], v[72:75]
  ds_read_b128 v[164:167], v18 offset:2048
  s_waitcnt lgkmcnt(8)
  v_mfma_f32_16x16x32_bf16 v[76:79], a[132:135], v[196:199], v[76:79]
  v_mfma_f32_16x16x32_bf16 v[80:83], a[136:139], v[196:199], v[80:83]
  v_mfma_f32_16x16x32_bf16 v[84:87], a[140:143], v[196:199], v[84:87]
  s_add_u32 m0, s47, 0
  s_nop 0
  buffer_load_dwordx4 v10, s[8:11], s46 offen lds
  ds_read_b128 v[168:171], v18 offset:4096
  s_waitcnt lgkmcnt(8)
  v_mfma_f32_16x16x32_bf16 v[88:91], a[132:135], v[200:203], v[88:91]
  v_mfma_f32_16x16x32_bf16 v[92:95], a[136:139], v[200:203], v[92:95]
  v_mfma_f32_16x16x32_bf16 v[96:99], a[140:143], v[200:203], v[96:99]
  ds_read_b128 v[172:175], v18 offset:6144
  s_waitcnt lgkmcnt(8)
  v_mfma_f32_16x16x32_bf16 v[100:103], a[132:135], v[204:207], v[100:103]
  v_mfma_f32_16x16x32_bf16 v[104:107], a[136:139], v[204:207], v[104:107]
  v_mfma_f32_16x16x32_bf16 v[108:111], a[140:143], v[204:207], v[108:111]
  ds_read_b128 v[176:179], v18 offset:8192
  s_waitcnt lgkmcnt(8)
  v_mfma_f32_16x16x32_bf16 v[112:115], a[132:135], v[208:211], v[112:115]
  v_mfma_f32_16x16x32_bf16 v[116:119], a[136:139], v[208:211], v[116:119]
  v_mfma_f32_16x16x32_bf16 v[120:123], a[140:143], v[208:211], v[120:123]
  ds_read_b128 v[180:183], v18 offset:10240
  s_waitcnt lgkmcnt(8)
  v_mfma_f32_16x16x32_bf16 v[124:127], a[132:135], v[212:215], v[124:127]
  v_mfma_f32_16x16x32_bf16 v[128:131], a[136:139], v[212:215], v[128:131]
  v_mfma_f32_16x16x32_bf16 v[132:135], a[140:143], v[212:215], v[132:135]
  s_add_u32 s46, s46, 10240
  s_add_u32 m0, s47, 1024
  s_nop 0
  buffer_load_dwordx4 v10, s[8:11], s46 offen lds
  ds_read_b128 v[184:187], v18 offset:12288
  s_waitcnt lgkmcnt(8)
  v_mfma_f32_16x16x32_bf16 v[136:139], a[132:135], v[216:219], v[136:139]
  v_mfma_f32_16x16x32_bf16 v[140:143], a[136:139], v[216:219], v[140:143]
  v_mfma_f32_16x16x32_bf16 v[144:147], a[140:143], v[216:219], v[144:147]
  ds_read_b128 v[188:191], v18 offset:14336
  s_waitcnt lgkmcnt(8)
  v_mfma_f32_16x16x32_bf16 v[148:151], a[132:135], v[220:223], v[148:151]
  v_mfma_f32_16x16x32_bf16 v[152:155], a[136:139], v[220:223], v[152:155]
  v_mfma_f32_16x16x32_bf16 v[156:159], a[140:143], v[220:223], v[156:159]
  ds_read_b128 v[192:195], v19 offset:0
  s_waitcnt lgkmcnt(8)
  v_mfma_f32_16x16x32_bf16 v[64:67], a[144:147], v[160:163], v[64:67]
  v_mfma_f32_16x16x32_bf16 v[68:71], a[148:151], v[160:163], v[68:71]
  v_mfma_f32_16x16x32_bf16 v[72:75], a[152:155], v[160:163], v[72:75]
  ds_read_b128 v[196:199], v19 offset:2048
  s_waitcnt lgkmcnt(8)
  v_mfma_f32_16x16x32_bf16 v[76:79], a[144:147], v[164:167], v[76:79]
  v_mfma_f32_16x16x32_bf16 v[80:83], a[148:151], v[164:167], v[80:83]
  v_mfma_f32_16x16x32_bf16 v[84:87], a[152:155], v[164:167], v[84:87]
  s_add_u32 s46, s46, 10240
  s_add_u32 m0, s47, 2048
  s_nop 0
  buffer_load_dwordx4 v10, s[8:11], s46 offen lds
  ds_read_b128 v[200:203], v19 offset:4096
  s_waitcnt lgkmcnt(8)
  v_mfma_f32_16x16x32_bf16 v[88:91], a[144:147], v[168:171], v[88:91]
  v_mfma_f32_16x16x32_bf16 v[92:95], a[148:151], v[168:171], v[92:95]
  v_mfma_f32_16x16x32_bf16 v[96:99], a[152:155], v[168:171], v[96:99]
  ds_read_b128 v[204:207], v19 offset:6144
  s_waitcnt lgkmcnt(8)
  v_mfma_f32_16x16x32_bf16 v[100:103], a[144:147], v[172:175], v[100:103]
  v_mfma_f32_16x16x32_bf16 v[104:107], a[148:151], v[172:175], v[104:107]
  v_mfma_f32_16x16x32_bf16 v[108:111], a[152:155], v[172:175], v[108:111]
  ds_read_b128 v[208:211], v19 offset:8192
  s_waitcnt lgkmcnt(8)
  v_mfma_f32_16x16x32_bf16 v[112:115], a[144:147], v[176:179], v[112:115]
  v_mfma_f32_16x16x32_bf16 v[116:119], a[148:151], v[176:179], v[116:119]
  v_mfma_f32_16x16x32_bf16 v[120:123], a[152:155], v[176:179], v[120:123]
  ds_read_b128 v[212:215], v19 offset:10240
  s_waitcnt lgkmcnt(8)
  v_mfma_f32_16x16x32_bf16 v[124:127], a[144:147], v[180:183], v[124:127]
  v_mfma_f32_16x16x32_bf16 v[128:131], a[148:151], v[180:183], v[128:131]
  v_mfma_f32_16x16x32_bf16 v[132:135], a[152:155], v[180:183], v[132:135]
  s_add_u32 s46, s46, 10240
  s_add_u32 m0, s47, 3072
  s_nop 0
  buffer_load_dwordx4 v10, s[8:11], s46 offen lds
  ds_read_b128 v[216:219], v19 offset:12288
  s_waitcnt lgkmcnt(8)
  v_mfma_f32_16x16x32_bf16 v[136:139], a[144:147], v[184:187], v[136:139]
  v_mfma_f32_16x16x32_bf16 v[140:143], a[148:151], v[184:187], v[140:143]
  v_mfma_f32_16x16x32_bf16 v[144:147], a[152:155], v[184:187], v[144:147]
  ds_read_b128 v[220:223], v19 offset:14336
  s_waitcnt lgkmcnt(8)
  v_mfma_f32_16x16x32_bf16 v[148:151], a[144:147], v[188:191], v[148:151]
  v_mfma_f32_16x16x32_bf16 v[152:155], a[148:151], v[188:191], v[152:155]
  v_mfma_f32_16x16x32_bf16 v[156:159], a[152:155], v[188:191], v[156:159]
  s_waitcnt vmcnt(12)
  s_barrier
  v_readfirstlane_b32 s79, v20
  buffer_load_dword v21, v33, s[72:75], s77 offen sc1
  s_add_u32 s21, s50, 0
  buffer_load_dwordx4 v[36:39], v30, s[16:19], s21 offen offset:0 sc1
  buffer_load_dwordx4 v[40:43], v30, s[16:19], s21 offen offset:1024 sc1
  buffer_load_dwordx4 v[44:47], v30, s[16:19], s21 offen offset:2048 sc1
  buffer_load_dwordx4 v[48:51], v30, s[16:19], s21 offen offset:3072 sc1
  s_add_u32 s21, s50, 4096
  buffer_load_dwordx4 v[52:55], v30, s[16:19], s21 offen offset:0 sc1
  buffer_load_dwordx4 v[56:59], v30, s[16:19], s21 offen offset:1024 sc1
  buffer_load_dwordx4 v[60:63], v30, s[16:19], s21 offen offset:2048 sc1
  buffer_load_dwordx4 v[236:239], v30, s[16:19], s21 offen offset:3072 sc1
  s_add_u32 s21, s50, 8192
  buffer_load_dwordx4 v[240:243], v30, s[16:19], s21 offen offset:0 sc1
  buffer_load_dwordx4 v[244:247], v30, s[16:19], s21 offen offset:1024 sc1
  buffer_load_dwordx4 v[248:251], v30, s[16:19], s21 offen offset:2048 sc1
  buffer_load_dwordx4 v[252:255], v30, s[16:19], s21 offen offset:3072 sc1
  s_add_u32 s30, s30, 128
  s_add_u32 s31, s31, 1
  s_cmp_lt_u32 s31, 10
  s_cbranch_scc1 qa_283
  s_mov_b32 s31, 0
  s_add_u32 s30, s30, s25
  s_sub_u32 s30, s30, 1280
  s_mov_b32 s25, 163840
qa_283:
  s_add_u32 s32, s32, 16384
  s_cmp_lt_u32 s32, 98304
  s_cselect_b32 s32, s32, 0
  s_mul_i32 s46, s20, 40960
  s_add_u32 s46, s46, s30
  s_lshl_b32 s47, s20, 12
  s_add_u32 s47, s47, s32
  v_add_u32 v18, s33, v14
  v_add_u32 v19, s33, v15
  s_add_u32 s33, s33, 16384
  s_cmp_lt_u32 s33, 98304
  s_cselect_b32 s33, s33, 0
  ds_read_b128 v[160:163], v18 offset:0
  s_waitcnt lgkmcnt(8)
  v_mfma_f32_16x16x32_bf16 v[64:67], a[156:159], v[192:195], v[64:67]
  v_mfma_f32_16x16x32_bf16 v[68:71], a[160:163], v[192:195], v[68:71]
  v_mfma_f32_16x16x32_bf16 v[72:75], a[164:167], v[192:195], v[72:75]
  ds_read_b128 v[164:167], v18 offset:2048
  s_waitcnt lgkmcnt(8)
  v_mfma_f32_16x16x32_bf16 v[76:79], a[156:159], v[196:199], v[76:79]
  v_mfma_f32_16x16x32_bf16 v[80:83], a[160:163], v[196:199], v[80:83]
  v_mfma_f32_16x16x32_bf16 v[84:87], a[164:167], v[196:199], v[84:87]
  s_add_u32 m0, s47, 0
  s_nop 0
  buffer_load_dwordx4 v10, s[8:11], s46 offen lds
  ds_read_b128 v[168:171], v18 offset:4096
  s_waitcnt lgkmcnt(8)
  v_mfma_f32_16x16x32_bf16 v[88:91], a[156:159], v[200:203], v[88:91]
  v_mfma_f32_16x16x32_bf16 v[92:95], a[160:163], v[200:203], v[92:95]
  v_mfma_f32_16x16x32_bf16 v[96:99], a[164:167], v[200:203], v[96:99]
  ds_read_b128 v[172:175], v18 offset:6144
  s_waitcnt lgkmcnt(8)
  v_mfma_f32_16x16x32_bf16 v[100:103], a[156:159], v[204:207], v[100:103]
  v_mfma_f32_16x16x32_bf16 v[104:107], a[160:163], v[204:207], v[104:107]
  v_mfma_f32_16x16x32_bf16 v[108:111], a[164:167], v[204:207], v[108:111]
  ds_read_b128 v[176:179], v18 offset:8192
  s_waitcnt lgkmcnt(8)
  v_mfma_f32_16x16x32_bf16 v[112:115], a[156:159], v[208:211], v[112:115]
  v_mfma_f32_16x16x32_bf16 v[116:119], a[160:163], v[208:211], v[116:119]
  v_mfma_f32_16x16x32_bf16 v[120:123], a[164:167], v[208:211], v[120:123]
  ds_read_b128 v[180:183], v18 offset:10240
  s_waitcnt lgkmcnt(8)
  v_mfma_f32_16x16x32_bf16 v[124:127], a[156:159], v[212:215], v[124:127]
  v_mfma_f32_16x16x32_bf16 v[128:131], a[160:163], v[212:215], v[128:131]
  v_mfma_f32_16x16x32_bf16 v[132:135], a[164:167], v[212:215], v[132:135]
  s_add_u32 s46, s46, 10240
  s_add_u32 m0, s47, 1024
  s_nop 0
  buffer_load_dwordx4 v10, s[8:11], s46 offen lds
  ds_read_b128 v[184:187], v18 offset:12288
  s_waitcnt lgkmcnt(8)
  v_mfma_f32_16x16x32_bf16 v[136:139], a[156:159], v[216:219], v[136:139]
  v_mfma_f32_16x16x32_bf16 v[140:143], a[160:163], v[216:219], v[140:143]
  v_mfma_f32_16x16x32_bf16 v[144:147], a[164:167], v[216:219], v[144:147]
  ds_read_b128 v[188:191], v18 offset:14336
  s_waitcnt lgkmcnt(8)
  v_mfma_f32_16x16x32_bf16 v[148:151], a[156:159], v[220:223], v[148:151]
  v_mfma_f32_16x16x32_bf16 v[152:155], a[160:163], v[220:223], v[152:155]
  v_mfma_f32_16x16x32_bf16 v[156:159], a[164:167], v[220:223], v[156:159]
  ds_read_b128 v[192:195], v19 offset:0
  s_waitcnt lgkmcnt(8)
  v_mfma_f32_16x16x32_bf16 v[64:67], a[168:171], v[160:163], v[64:67]
  v_mfma_f32_16x16x32_bf16 v[68:71], a[172:175], v[160:163], v[68:71]
  v_mfma_f32_16x16x32_bf16 v[72:75], a[176:179], v[160:163], v[72:75]
  ds_read_b128 v[196:199], v19 offset:2048
  s_waitcnt lgkmcnt(8)
  v_mfma_f32_16x16x32_bf16 v[76:79], a[168:171], v[164:167], v[76:79]
  v_mfma_f32_16x16x32_bf16 v[80:83], a[172:175], v[164:167], v[80:83]
  v_mfma_f32_16x16x32_bf16 v[84:87], a[176:179], v[164:167], v[84:87]
  s_add_u32 s46, s46, 10240
  s_add_u32 m0, s47, 2048
  s_nop 0
  buffer_load_dwordx4 v10, s[8:11], s46 offen lds
  ds_read_b128 v[200:203], v19 offset:4096
  s_waitcnt lgkmcnt(8)
  v_mfma_f32_16x16x32_bf16 v[88:91], a[168:171], v[168:171], v[88:91]
  v_mfma_f32_16x16x32_bf16 v[92:95], a[172:175], v[168:171], v[92:95]
  v_mfma_f32_16x16x32_bf16 v[96:99], a[176:179], v[168:171], v[96:99]
  ds_read_b128 v[204:207], v19 offset:6144
  s_waitcnt lgkmcnt(8)
  v_mfma_f32_16x16x32_bf16 v[100:103], a[168:171], v[172:175], v[100:103]
  v_mfma_f32_16x16x32_bf16 v[104:107], a[172:175], v[172:175], v[104:107]
  v_mfma_f32_16x16x32_bf16 v[108:111], a[176:179], v[172:175], v[108:111]
  ds_read_b128 v[208:211], v19 offset:8192
  s_waitcnt lgkmcnt(8)
  v_mfma_f32_16x16x32_bf16 v[112:115], a[168:171], v[176:179], v[112:115]
  v_mfma_f32_16x16x32_bf16 v[116:119], a[172:175], v[176:179], v[116:119]
  v_mfma_f32_16x16x32_bf16 v[120:123], a[176:179], v[176:179], v[120:123]
  ds_read_b128 v[212:215], v19 offset:10240
  s_waitcnt lgkmcnt(8)
  v_mfma_f32_16x16x32_bf16 v[124:127], a[168:171], v[180:183], v[124:127]
  v_mfma_f32_16x16x32_bf16 v[128:131], a[172:175], v[180:183], v[128:131]
  v_mfma_f32_16x16x32_bf16 v[132:135], a[176:179], v[180:183], v[132:135]
  s_add_u32 s46, s46, 10240
  s_add_u32 m0, s47, 3072
  s_nop 0
  buffer_load_dwordx4 v10, s[8:11], s46 offen lds
  ds_read_b128 v[216:219], v19 offset:12288
  s_waitcnt lgkmcnt(8)
  v_mfma_f32_16x16x32_bf16 v[136:139], a[168:171], v[184:187], v[136:139]
  v_mfma_f32_16x16x32_bf16 v[140:143], a[172:175], v[184:187], v[140:143]
  v_mfma_f32_16x16x32_bf16 v[144:147], a[176:179], v[184:187], v[144:147]
  ds_read_b128 v[220:223], v19 offset:14336
  s_waitcnt lgkmcnt(8)
  v_mfma_f32_16x16x32_bf16 v[148:151], a[168:171], v[188:191], v[148:151]
  v_mfma_f32_16x16x32_bf16 v[152:155], a[172:175], v[188:191], v[152:155]
  v_mfma_f32_16x16x32_bf16 v[156:159], a[176:179], v[188:191], v[156:159]
  s_waitcnt vmcnt(25)
  s_barrier
  s_add_u32 s30, s30, 128
  s_add_u32 s31, s31, 1
  s_cmp_lt_u32 s31, 10
  s_cbranch_scc1 qa_284
  s_mov_b32 s31, 0
  s_add_u32 s30, s30, s25
  s_sub_u32 s30, s30, 1280
  s_mov_b32 s25, 163840
qa_284:
  s_add_u32 s32, s32, 16384
  s_cmp_lt_u32 s32, 98304
  s_cselect_b32 s32, s32, 0
  s_mul_i32 s46, s20, 40960
  s_add_u32 s46, s46, s30
  s_lshl_b32 s47, s20, 12
  s_add_u32 s47, s47, s32
  v_add_u32 v18, s33, v14
  v_add_u32 v19, s33, v15
  s_add_u32 s33, s33, 16384
  s_cmp_lt_u32 s33, 98304
  s_cselect_b32 s33, s33, 0
  ds_read_b128 v[160:163], v18 offset:0
  s_waitcnt lgkmcnt(8)
  v_mfma_f32_16x16x32_bf16 v[64:67], a[180:183], v[192:195], v[64:67]
  v_mfma_f32_16x16x32_bf16 v[68:71], a[184:187], v[192:195], v[68:71]
  v_mfma_f32_16x16x32_bf16 v[72:75], a[188:191], v[192:195], v[72:75]
  ds_read_b128 v[164:167], v18 offset:2048
  s_waitcnt lgkmcnt(8)
  v_mfma_f32_16x16x32_bf16 v[76:79], a[180:183], v[196:199], v[76:79]
  v_mfma_f32_16x16x32_bf16 v[80:83], a[184:187], v[196:199], v[80:83]
  v_mfma_f32_16x16x32_bf16 v[84:87], a[188:191], v[196:199], v[84:87]
  s_add_u32 m0, s47, 0
  s_nop 0
  buffer_load_dwordx4 v10, s[8:11], s46 offen lds
  ds_read_b128 v[168:171], v18 offset:4096
  s_waitcnt lgkmcnt(8)
  v_mfma_f32_16x16x32_bf16 v[88:91], a[180:183], v[200:203], v[88:91]
  v_mfma_f32_16x16x32_bf16 v[92:95], a[184:187], v[200:203], v[92:95]
  v_mfma_f32_16x16x32_bf16 v[96:99], a[188:191], v[200:203], v[96:99]
  ds_read_b128 v[172:175], v18 offset:6144
  s_waitcnt lgkmcnt(8)
  v_mfma_f32_16x16x32_bf16 v[100:103], a[180:183], v[204:207], v[100:103]
  v_mfma_f32_16x16x32_bf16 v[104:107], a[184:187], v[204:207], v[104:107]
  v_mfma_f32_16x16x32_bf16 v[108:111], a[188:191], v[204:207], v[108:111]
  ds_read_b128 v[176:179], v18 offset:8192
  s_waitcnt lgkmcnt(8)
  v_mfma_f32_16x16x32_bf16 v[112:115], a[180:183], v[208:211], v[112:115]
  v_mfma_f32_16x16x32_bf16 v[116:119], a[184:187], v[208:211], v[116:119]
  v_mfma_f32_16x16x32_bf16 v[120:123], a[188:191], v[208:211], v[120:123]
  ds_read_b128 v[180:183], v18 offset:10240
  s_waitcnt lgkmcnt(8)
  v_mfma_f32_16x16x32_bf16 v[124:127], a[180:183], v[212:215], v[124:127]
  v_mfma_f32_16x16x32_bf16 v[128:131], a[184:187], v[212:215], v[128:131]
  v_mfma_f32_16x16x32_bf16 v[132:135], a[188:191], v[212:215], v[132:135]
  s_add_u32 s46, s46, 10240
  s_add_u32 m0, s47, 1024
  s_nop 0
  buffer_load_dwordx4 v10, s[8:11], s46 offen lds
  ds_read_b128 v[184:187], v18 offset:12288
  s_waitcnt lgkmcnt(8)
  v_mfma_f32_16x16x32_bf16 v[136:139], a[180:183], v[216:219], v[136:139]
  v_mfma_f32_16x16x32_bf16 v[140:143], a[184:187], v[216:219], v[140:143]
  v_mfma_f32_16x16x32_bf16 v[144:147], a[188:191], v[216:219], v[144:147]
  ds_read_b128 v[188:191], v18 offset:14336
  s_waitcnt lgkmcnt(8)
  v_mfma_f32_16x16x32_bf16 v[148:151], a[180:183], v[220:223], v[148:151]
  v_mfma_f32_16x16x32_bf16 v[152:155], a[184:187], v[220:223], v[152:155]
  v_mfma_f32_16x16x32_bf16 v[156:159], a[188:191], v[220:223], v[156:159]
  ds_read_b128 v[192:195], v19 offset:0
  s_waitcnt lgkmcnt(8)
  v_mfma_f32_16x16x32_bf16 v[64:67], a[192:195], v[160:163], v[64:67]
  v_mfma_f32_16x16x32_bf16 v[68:71], a[196:199], v[160:163], v[68:71]
  v_mfma_f32_16x16x32_bf16 v[72:75], a[200:203], v[160:163], v[72:75]
  ds_read_b128 v[196:199], v19 offset:2048
  s_waitcnt lgkmcnt(8)
  v_mfma_f32_16x16x32_bf16 v[76:79], a[192:195], v[164:167], v[76:79]
  v_mfma_f32_16x16x32_bf16 v[80:83], a[196:199], v[164:167], v[80:83]
  v_mfma_f32_16x16x32_bf16 v[84:87], a[200:203], v[164:167], v[84:87]
  s_add_u32 s46, s46, 10240
  s_add_u32 m0, s47, 2048
  s_nop 0
  buffer_load_dwordx4 v10, s[8:11], s46 offen lds
  ds_read_b128 v[200:203], v19 offset:4096
  s_waitcnt lgkmcnt(8)
  v_mfma_f32_16x16x32_bf16 v[88:91], a[192:195], v[168:171], v[88:91]
  v_mfma_f32_16x16x32_bf16 v[92:95], a[196:199], v[168:171], v[92:95]
  v_mfma_f32_16x16x32_bf16 v[96:99], a[200:203], v[168:171], v[96:99]
  ds_read_b128 v[204:207], v19 offset:6144
  s_waitcnt lgkmcnt(8)
  v_mfma_f32_16x16x32_bf16 v[100:103], a[192:195], v[172:175], v[100:103]
  v_mfma_f32_16x16x32_bf16 v[104:107], a[196:199], v[172:175], v[104:107]
  v_mfma_f32_16x16x32_bf16 v[108:111], a[200:203], v[172:175], v[108:111]
  ds_read_b128 v[208:211], v19 offset:8192
  s_waitcnt lgkmcnt(8)
  v_mfma_f32_16x16x32_bf16 v[112:115], a[192:195], v[176:179], v[112:115]
  v_mfma_f32_16x16x32_bf16 v[116:119], a[196:199], v[176:179], v[116:119]
  v_mfma_f32_16x16x32_bf16 v[120:123], a[200:203], v[176:179], v[120:123]
  ds_read_b128 v[212:215], v19 offset:10240
  s_waitcnt lgkmcnt(8)
  v_mfma_f32_16x16x32_bf16 v[124:127], a[192:195], v[180:183], v[124:127]
  v_mfma_f32_16x16x32_bf16 v[128:131], a[196:199], v[180:183], v[128:131]
  v_mfma_f32_16x16x32_bf16 v[132:135], a[200:203], v[180:183], v[132:135]
  s_add_u32 s46, s46, 10240
  s_add_u32 m0, s47, 3072
  s_nop 0
  buffer_load_dwordx4 v10, s[8:11], s46 offen lds
  ds_read_b128 v[216:219], v19 offset:12288
  s_waitcnt lgkmcnt(8)
  v_mfma_f32_16x16x32_bf16 v[136:139], a[192:195], v[184:187], v[136:139]
  v_mfma_f32_16x16x32_bf16 v[140:143], a[196:199], v[184:187], v[140:143]
  v_mfma_f32_16x16x32_bf16 v[144:147], a[200:203], v[184:187], v[144:147]
  ds_read_b128 v[220:223], v19 offset:14336
  s_waitcnt lgkmcnt(8)
  v_mfma_f32_16x16x32_bf16 v[148:151], a[192:195], v[188:191], v[148:151]
  v_mfma_f32_16x16x32_bf16 v[152:155], a[196:199], v[188:191], v[152:155]
  v_mfma_f32_16x16x32_bf16 v[156:159], a[200:203], v[188:191], v[156:159]
  s_waitcnt vmcnt(25)
  s_barrier
  s_add_u32 s30, s30, 128
  s_add_u32 s31, s31, 1
  s_cmp_lt_u32 s31, 10
  s_cbranch_scc1 qa_285
  s_mov_b32 s31, 0
  s_add_u32 s30, s30, s25
  s_sub_u32 s30, s30, 1280
  s_mov_b32 s25, 163840
qa_285:
  s_add_u32 s32, s32, 16384
  s_cmp_lt_u32 s32, 98304
  s_cselect_b32 s32, s32, 0
  s_mul_i32 s46, s20, 40960
  s_add_u32 s46, s46, s30
  s_lshl_b32 s47, s20, 12
  s_add_u32 s47, s47, s32
  v_add_u32 v18, s33, v14
  v_add_u32 v19, s33, v15
  s_add_u32 s33, s33, 16384
  s_cmp_lt_u32 s33, 98304
  s_cselect_b32 s33, s33, 0
  ds_read_b128 v[160:163], v18 offset:0
  s_waitcnt lgkmcnt(8)
  v_mfma_f32_16x16x32_bf16 v[64:67], a[204:207], v[192:195], v[64:67]
  v_mfma_f32_16x16x32_bf16 v[68:71], a[208:211], v[192:195], v[68:71]
  v_mfma_f32_16x16x32_bf16 v[72:75], a[212:215], v[192:195], v[72:75]
  ds_read_b128 v[164:167], v18 offset:2048
  s_waitcnt lgkmcnt(8)
  v_mfma_f32_16x16x32_bf16 v[76:79], a[204:207], v[196:199], v[76:79]
  v_mfma_f32_16x16x32_bf16 v[80:83], a[208:211], v[196:199], v[80:83]
  v_mfma_f32_16x16x32_bf16 v[84:87], a[212:215], v[196:199], v[84:87]
  s_add_u32 m0, s47, 0
  s_nop 0
  buffer_load_dwordx4 v10, s[8:11], s46 offen lds
  ds_read_b128 v[168:171], v18 offset:4096
  s_waitcnt lgkmcnt(8)
  v_mfma_f32_16x16x32_bf16 v[88:91], a[204:207], v[200:203], v[88:91]
  v_mfma_f32_16x16x32_bf16 v[92:95], a[208:211], v[200:203], v[92:95]
  v_mfma_f32_16x16x32_bf16 v[96:99], a[212:215], v[200:203], v[96:99]
  ds_read_b128 v[172:175], v18 offset:6144
  s_waitcnt lgkmcnt(8)
  v_mfma_f32_16x16x32_bf16 v[100:103], a[204:207], v[204:207], v[100:103]
  v_mfma_f32_16x16x32_bf16 v[104:107], a[208:211], v[204:207], v[104:107]
  v_mfma_f32_16x16x32_bf16 v[108:111], a[212:215], v[204:207], v[108:111]
  ds_read_b128 v[176:179], v18 offset:8192
  s_waitcnt lgkmcnt(8)
  v_mfma_f32_16x16x32_bf16 v[112:115], a[204:207], v[208:211], v[112:115]
  v_mfma_f32_16x16x32_bf16 v[116:119], a[208:211], v[208:211], v[116:119]
  v_mfma_f32_16x16x32_bf16 v[120:123], a[212:215], v[208:211], v[120:123]
  ds_read_b128 v[180:183], v18 offset:10240
  s_waitcnt lgkmcnt(8)
  v_mfma_f32_16x16x32_bf16 v[124:127], a[204:207], v[212:215], v[124:127]
  v_mfma_f32_16x16x32_bf16 v[128:131], a[208:211], v[212:215], v[128:131]
  v_mfma_f32_16x16x32_bf16 v[132:135], a[212:215], v[212:215], v[132:135]
  s_add_u32 s46, s46, 10240
  s_add_u32 m0, s47, 1024
  s_nop 0
  buffer_load_dwordx4 v10, s[8:11], s46 offen lds
  ds_read_b128 v[184:187], v18 offset:12288
  s_waitcnt lgkmcnt(8)
  v_mfma_f32_16x16x32_bf16 v[136:139], a[204:207], v[216:219], v[136:139]
  v_mfma_f32_16x16x32_bf16 v[140:143], a[208:211], v[216:219], v[140:143]
  v_mfma_f32_16x16x32_bf16 v[144:147], a[212:215], v[216:219], v[144:147]
  ds_read_b128 v[188:191], v18 offset:14336
  s_waitcnt lgkmcnt(8)
  v_mfma_f32_16x16x32_bf16 v[148:151], a[204:207], v[220:223], v[148:151]
  v_mfma_f32_16x16x32_bf16 v[152:155], a[208:211], v[220:223], v[152:155]
  v_mfma_f32_16x16x32_bf16 v[156:159], a[212:215], v[220:223], v[156:159]
  ds_read_b128 v[192:195], v19 offset:0
  s_waitcnt lgkmcnt(8)
  v_mfma_f32_16x16x32_bf16 v[64:67], a[216:219], v[160:163], v[64:67]
  v_mfma_f32_16x16x32_bf16 v[68:71], a[220:223], v[160:163], v[68:71]
  v_mfma_f32_16x16x32_bf16 v[72:75], a[224:227], v[160:163], v[72:75]
  ds_read_b128 v[196:199], v19 offset:2048
  s_waitcnt lgkmcnt(8)
  v_mfma_f32_16x16x32_bf16 v[76:79], a[216:219], v[164:167], v[76:79]
  v_mfma_f32_16x16x32_bf16 v[80:83], a[220:223], v[164:167], v[80:83]
  v_mfma_f32_16x16x32_bf16 v[84:87], a[224:227], v[164:167], v[84:87]
  s_add_u32 s46, s46, 10240
  s_add_u32 m0, s47, 2048
  s_nop 0
  buffer_load_dwordx4 v10, s[8:11], s46 offen lds
  ds_read_b128 v[200:203], v19 offset:4096
  s_waitcnt lgkmcnt(8)
  v_mfma_f32_16x16x32_bf16 v[88:91], a[216:219], v[168:171], v[88:91]
  v_mfma_f32_16x16x32_bf16 v[92:95], a[220:223], v[168:171], v[92:95]
  v_mfma_f32_16x16x32_bf16 v[96:99], a[224:227], v[168:171], v[96:99]
  ds_read_b128 v[204:207], v19 offset:6144
  s_waitcnt lgkmcnt(8)
  v_mfma_f32_16x16x32_bf16 v[100:103], a[216:219], v[172:175], v[100:103]
  v_mfma_f32_16x16x32_bf16 v[104:107], a[220:223], v[172:175], v[104:107]
  v_mfma_f32_16x16x32_bf16 v[108:111], a[224:227], v[172:175], v[108:111]
  ds_read_b128 v[208:211], v19 offset:8192
  s_waitcnt lgkmcnt(8)
  v_mfma_f32_16x16x32_bf16 v[112:115], a[216:219], v[176:179], v[112:115]
  v_mfma_f32_16x16x32_bf16 v[116:119], a[220:223], v[176:179], v[116:119]
  v_mfma_f32_16x16x32_bf16 v[120:123], a[224:227], v[176:179], v[120:123]
  ds_read_b128 v[212:215], v19 offset:10240
  s_waitcnt lgkmcnt(8)
  v_mfma_f32_16x16x32_bf16 v[124:127], a[216:219], v[180:183], v[124:127]
  v_mfma_f32_16x16x32_bf16 v[128:131], a[220:223], v[180:183], v[128:131]
  v_mfma_f32_16x16x32_bf16 v[132:135], a[224:227], v[180:183], v[132:135]
  s_add_u32 s46, s46, 10240
  s_add_u32 m0, s47, 3072
  s_nop 0
  buffer_load_dwordx4 v10, s[8:11], s46 offen lds
  ds_read_b128 v[216:219], v19 offset:12288
  s_waitcnt lgkmcnt(8)
  v_mfma_f32_16x16x32_bf16 v[136:139], a[216:219], v[184:187], v[136:139]
  v_mfma_f32_16x16x32_bf16 v[140:143], a[220:223], v[184:187], v[140:143]
  v_mfma_f32_16x16x32_bf16 v[144:147], a[224:227], v[184:187], v[144:147]
  ds_read_b128 v[220:223], v19 offset:14336
  s_waitcnt lgkmcnt(8)
  v_mfma_f32_16x16x32_bf16 v[148:151], a[216:219], v[188:191], v[148:151]
  v_mfma_f32_16x16x32_bf16 v[152:155], a[220:223], v[188:191], v[152:155]
  v_mfma_f32_16x16x32_bf16 v[156:159], a[224:227], v[188:191], v[156:159]
  s_waitcnt vmcnt(25)
  s_barrier
  s_add_u32 s30, s30, 128
  s_add_u32 s31, s31, 1
  s_cmp_lt_u32 s31, 10
  s_cbranch_scc1 qa_286
  s_mov_b32 s31, 0
  s_add_u32 s30, s30, s25
  s_sub_u32 s30, s30, 1280
  s_mov_b32 s25, 163840
qa_286:
  s_add_u32 s32, s32, 16384
  s_cmp_lt_u32 s32, 98304
  s_cselect_b32 s32, s32, 0
  s_mul_i32 s46, s20, 40960
  s_add_u32 s46, s46, s30
  s_lshl_b32 s47, s20, 12
  s_add_u32 s47, s47, s32
  v_add_u32 v18, s33, v14
  v_add_u32 v19, s33, v15
  s_add_u32 s33, s33, 16384
  s_cmp_lt_u32 s33, 98304
  s_cselect_b32 s33, s33, 0
  ds_read_b128 v[160:163], v18 offset:0
  s_waitcnt lgkmcnt(8)
  v_mfma_f32_16x16x32_bf16 v[64:67], a[228:231], v[192:195], v[64:67]
  v_mfma_f32_16x16x32_bf16 v[68:71], a[232:235], v[192:195], v[68:71]
  v_mfma_f32_16x16x32_bf16 v[72:75], a[236:239], v[192:195], v[72:75]
  ds_read_b128 v[164:167], v18 offset:2048
  s_waitcnt lgkmcnt(8)
  v_mfma_f32_16x16x32_bf16 v[76:79], a[228:231], v[196:199], v[76:79]
  v_mfma_f32_16x16x32_bf16 v[80:83], a[232:235], v[196:199], v[80:83]
  v_mfma_f32_16x16x32_bf16 v[84:87], a[236:239], v[196:199], v[84:87]
  s_add_u32 m0, s47, 0
  s_nop 0
  buffer_load_dwordx4 v10, s[8:11], s46 offen lds
  ds_read_b128 v[168:171], v18 offset:4096
  s_waitcnt lgkmcnt(8)
  v_mfma_f32_16x16x32_bf16 v[88:91], a[228:231], v[200:203], v[88:91]
  v_mfma_f32_16x16x32_bf16 v[92:95], a[232:235], v[200:203], v[92:95]
  v_mfma_f32_16x16x32_bf16 v[96:99], a[236:239], v[200:203], v[96:99]
  ds_read_b128 v[172:175], v18 offset:6144
  s_waitcnt lgkmcnt(8)
  v_mfma_f32_16x16x32_bf16 v[100:103], a[228:231], v[204:207], v[100:103]
  v_mfma_f32_16x16x32_bf16 v[104:107], a[232:235], v[204:207], v[104:107]
  v_mfma_f32_16x16x32_bf16 v[108:111], a[236:239], v[204:207], v[108:111]
  v_cvt_pk_bf16_f32 v224, v64, v65
  v_cvt_pk_bf16_f32 v225, v66, v67
  v_cvt_pk_bf16_f32 v226, v68, v69
  v_cvt_pk_bf16_f32 v227, v70, v71
  v_cvt_pk_bf16_f32 v228, v72, v73
  v_cvt_pk_bf16_f32 v229, v74, v75
  ds_write_b64 v22, v[224:225] offset:0
  ds_write_b64 v22, v[226:227] offset:8
  ds_write_b64 v22, v[228:229] offset:16
  ds_read_b128 v[176:179], v18 offset:8192
  s_waitcnt lgkmcnt(8)
  v_mfma_f32_16x16x32_bf16 v[112:115], a[228:231], v[208:211], v[112:115]
  v_mfma_f32_16x16x32_bf16 v[116:119], a[232:235], v[208:211], v[116:119]
  v_mfma_f32_16x16x32_bf16 v[120:123], a[236:239], v[208:211], v[120:123]
  v_cvt_pk_bf16_f32 v230, v76, v77
  v_cvt_pk_bf16_f32 v231, v78, v79
  v_cvt_pk_bf16_f32 v232, v80, v81
  v_cvt_pk_bf16_f32 v233, v82, v83
  v_cvt_pk_bf16_f32 v234, v84, v85
  v_cvt_pk_bf16_f32 v235, v86, v87
  ds_write_b64 v22, v[230:231] offset:6400
  ds_write_b64 v22, v[232:233] offset:6408
  ds_write_b64 v22, v[234:235] offset:6416
  ds_read_b128 v[180:183], v18 offset:10240
  s_waitcnt lgkmcnt(8)
  v_mfma_f32_16x16x32_bf16 v[124:127], a[228:231], v[212:215], v[124:127]
  v_mfma_f32_16x16x32_bf16 v[128:131], a[232:235], v[212:215], v[128:131]
  v_mfma_f32_16x16x32_bf16 v[132:135], a[236:239], v[212:215], v[132:135]
  s_add_u32 s46, s46, 10240
  s_add_u32 m0, s47, 1024
  s_nop 0
  buffer_load_dwordx4 v10, s[8:11], s46 offen lds
  v_cvt_pk_bf16_f32 v224, v88, v89
  v_cvt_pk_bf16_f32 v225, v90, v91
  v_cvt_pk_bf16_f32 v226, v92, v93
  v_cvt_pk_bf16_f32 v227, v94, v95
  v_cvt_pk_bf16_f32 v228, v96, v97
  v_cvt_pk_bf16_f32 v229, v98, v99
  ds_write_b64 v22, v[224:225] offset:12800
  ds_write_b64 v22, v[226:227] offset:12808
  ds_write_b64 v22, v[228:229] offset:12816
  ds_read_b128 v[184:187], v18 offset:12288
  s_waitcnt lgkmcnt(8)
  v_mfma_f32_16x16x32_bf16 v[136:139], a[228:231], v[216:219], v[136:139]
  v_mfma_f32_16x16x32_bf16 v[140:143], a[232:235], v[216:219], v[140:143]
  v_mfma_f32_16x16x32_bf16 v[144:147], a[236:239], v[216:219], v[144:147]
  v_cvt_pk_bf16_f32 v230, v100, v101
  v_cvt_pk_bf16_f32 v231, v102, v103
  v_cvt_pk_bf16_f32 v232, v104, v105
  v_cvt_pk_bf16_f32 v233, v106, v107
  v_cvt_pk_bf16_f32 v234, v108, v109
  v_cvt_pk_bf16_f32 v235, v110, v111
  ds_write_b64 v22, v[230:231] offset:19200
  ds_write_b64 v22, v[232:233] offset:19208
  ds_write_b64 v22, v[234:235] offset:19216
  ds_read_b128 v[188:191], v18 offset:14336
  s_waitcnt lgkmcnt(8)
  v_mfma_f32_16x16x32_bf16 v[148:151], a[228:231], v[220:223], v[148:151]
  v_mfma_f32_16x16x32_bf16 v[152:155], a[232:235], v[220:223], v[152:155]
  v_mfma_f32_16x16x32_bf16 v[156:159], a[236:239], v[220:223], v[156:159]
  v_cvt_pk_bf16_f32 v224, v112, v113
  v_cvt_pk_bf16_f32 v225, v114, v115
  v_cvt_pk_bf16_f32 v226, v116, v117
  v_cvt_pk_bf16_f32 v227, v118, v119
  v_cvt_pk_bf16_f32 v228, v120, v121
  v_cvt_pk_bf16_f32 v229, v122, v123
  ds_write_b64 v22, v[224:225] offset:25600
  ds_write_b64 v22, v[226:227] offset:25608
  ds_write_b64 v22, v[228:229] offset:25616
  v_cvt_pk_bf16_f32 v230, v124, v125
  v_cvt_pk_bf16_f32 v231, v126, v127
  v_cvt_pk_bf16_f32 v232, v128, v129
  v_cvt_pk_bf16_f32 v233, v130, v131
  v_cvt_pk_bf16_f32 v234, v132, v133
  v_cvt_pk_bf16_f32 v235, v134, v135
  ds_write_b64 v22, v[230:231] offset:32000
  ds_write_b64 v22, v[232:233] offset:32008
  ds_write_b64 v22, v[234:235] offset:32016
  v_cvt_pk_bf16_f32 v224, v136, v137
  v_cvt_pk_bf16_f32 v225, v138, v139
  v_cvt_pk_bf16_f32 v226, v140, v141
  v_cvt_pk_bf16_f32 v227, v142, v143
  v_cvt_pk_bf16_f32 v228, v144, v145
  v_cvt_pk_bf16_f32 v229, v146, v147
  ds_write_b64 v22, v[224:225] offset:38400
  ds_write_b64 v22, v[226:227] offset:38408
  ds_write_b64 v22, v[228:229] offset:38416
  v_cvt_pk_bf16_f32 v230, v148, v149
  v_cvt_pk_bf16_f32 v231, v150, v151
  v_cvt_pk_bf16_f32 v232, v152, v153
  v_cvt_pk_bf16_f32 v233, v154, v155
  v_cvt_pk_bf16_f32 v234, v156, v157
  v_cvt_pk_bf16_f32 v235, v158, v159
  ds_write_b64 v22, v[230:231] offset:44800
  ds_write_b64 v22, v[232:233] offset:44808
  ds_write_b64 v22, v[234:235] offset:44816
  s_lshl_b32 s43, s42, 2
  s_add_u32 s43, s43, s20
  s_mul_i32 s43, s43, 12288
  s_add_u32 s43, s43, 5242880
  s_cmp_lg_u32 s26, 16
  s_cbranch_scc1 qbs_288
  s_waitcnt lgkmcnt(0)
  s_barrier
  ds_read_b128 v[64:67], v29 offset:0
  ds_read_b128 v[68:71], v29 offset:64
  ds_read_b128 v[72:75], v29 offset:128
  ds_read_b128 v[76:79], v29 offset:192
  ds_read_b128 v[80:83], v29 offset:256
  ds_read_b128 v[84:87], v29 offset:320
  ds_read_b128 v[88:91], v29 offset:6400
  ds_read_b128 v[92:95], v29 offset:6464
  ds_read_b128 v[96:99], v29 offset:6528
  ds_read_b128 v[100:103], v29 offset:6592
  ds_read_b128 v[104:107], v29 offset:6656
  ds_read_b128 v[108:111], v29 offset:6720
  s_waitcnt lgkmcnt(0)
  s_add_u32 s21, s43, 0
  buffer_store_dwordx4 v[64:67], v30, s[56:59], s21 offen offset:0 sc1
  buffer_store_dwordx4 v[68:71], v30, s[56:59], s21 offen offset:1024 sc1
  buffer_store_dwordx4 v[72:75], v30, s[56:59], s21 offen offset:2048 sc1
  buffer_store_dwordx4 v[76:79], v30, s[56:59], s21 offen offset:3072 sc1
  s_add_u32 s21, s43, 4096
  buffer_store_dwordx4 v[80:83], v30, s[56:59], s21 offen offset:0 sc1
  buffer_store_dwordx4 v[84:87], v30, s[56:59], s21 offen offset:1024 sc1
  buffer_store_dwordx4 v[88:91], v30, s[56:59], s21 offen offset:2048 sc1
  buffer_store_dwordx4 v[92:95], v30, s[56:59], s21 offen offset:3072 sc1
  s_add_u32 s21, s43, 8192
  buffer_store_dwordx4 v[96:99], v30, s[56:59], s21 offen offset:0 sc1
  buffer_store_dwordx4 v[100:103], v30, s[56:59], s21 offen offset:1024 sc1
  buffer_store_dwordx4 v[104:107], v30, s[56:59], s21 offen offset:2048 sc1
  buffer_store_dwordx4 v[108:111], v30, s[56:59], s21 offen offset:3072 sc1
  s_waitcnt vmcnt(0)
  s_barrier
  s_lshl_b32 s21, s42, 7
  s_add_u32 s21, s21, 111616
  s_cmp_lg_u32 s20, 0
  s_cbranch_scc1 af_289
  v_mov_b32 v4, 0
  v_mov_b32 v5, 1
  s_mov_b64 exec, 1
  buffer_atomic_add v5, v4, s[72:75], s21 offen sc1
  s_mov_b64 exec, -1
  s_nop 1
af_289:
  s_branch qbe_287
qbs_288:
  s_add_u32 s23, s49, 1
  s_waitcnt vmcnt(12)
  v_cmp_gt_u32 vcc, s23, v21
  s_mov_b32 s80, 0
  s_nop 0
  s_cbranch_vccnz qk_291
  s_mov_b32 s80, 1
  buffer_load_dwordx4 v[132:135], v31, s[52:55], s51 offen offset:0 sc1
  buffer_load_dwordx4 v[136:139], v31, s[52:55], s51 offen offset:512 sc1
  buffer_load_dwordx4 v[140:143], v31, s[52:55], s51 offen offset:1024 sc1
  buffer_load_dwordx4 v[144:147], v31, s[52:55], s51 offen offset:1536 sc1
  buffer_load_dwordx4 v[148:151], v31, s[52:55], s51 offen offset:2048 sc1
  buffer_load_dwordx4 v[152:155], v31, s[52:55], s51 offen offset:2560 sc1
qk_291:
  s_cmp_ge_u32 s79, 8
  s_cbranch_scc1 qk_290
  v_mov_b32 v156, 0
  s_mov_b32 s101, 0
wf_292:
  buffer_load_dword v157, v156, s[72:75], s76 offen sc1
  s_add_u32 s101, s101, 1
  s_cmp_gt_u32 s101, 131072
  s_cbranch_scc1 main_end
  s_waitcnt vmcnt(0)
  v_readfirstlane_b32 s100, v157
  s_cmp_ge_u32 s100, 8
  s_cbranch_scc1 wf_293
  s_sleep 2
  s_branch wf_292
wf_293:
  s_add_u32 s21, s50, 0
  buffer_load_dwordx4 v[36:39], v30, s[16:19], s21 offen offset:0 sc1
  buffer_load_dwordx4 v[40:43], v30, s[16:19], s21 offen offset:1024 sc1
  buffer_load_dwordx4 v[44:47], v30, s[16:19], s21 offen offset:2048 sc1
  buffer_load_dwordx4 v[48:51], v30, s[16:19], s21 offen offset:3072 sc1
  s_add_u32 s21, s50, 4096
  buffer_load_dwordx4 v[52:55], v30, s[16:19], s21 offen offset:0 sc1
  buffer_load_dwordx4 v[56:59], v30, s[16:19], s21 offen offset:1024 sc1
  buffer_load_dwordx4 v[60:63], v30, s[16:19], s21 offen offset:2048 sc1
  buffer_load_dwordx4 v[236:239], v30, s[16:19], s21 offen offset:3072 sc1
  s_add_u32 s21, s50, 8192
  buffer_load_dwordx4 v[240:243], v30, s[16:19], s21 offen offset:0 sc1
  buffer_load_dwordx4 v[244:247], v30, s[16:19], s21 offen offset:1024 sc1
  buffer_load_dwordx4 v[248:251], v30, s[16:19], s21 offen offset:2048 sc1
  buffer_load_dwordx4 v[252:255], v30, s[16:19], s21 offen offset:3072 sc1
qk_290:
  s_waitcnt lgkmcnt(0)
  s_barrier
  ds_read_b128 v[64:67], v29 offset:0
  ds_read_b128 v[68:71], v29 offset:64
  ds_read_b128 v[72:75], v29 offset:128
  ds_read_b128 v[76:79], v29 offset:192
  ds_read_b128 v[80:83], v29 offset:256
  ds_read_b128 v[84:87], v29 offset:320
  ds_read_b128 v[88:91], v29 offset:6400
  ds_read_b128 v[92:95], v29 offset:6464
  ds_read_b128 v[96:99], v29 offset:6528
  ds_read_b128 v[100:103], v29 offset:6592
  ds_read_b128 v[104:107], v29 offset:6656
  ds_read_b128 v[108:111], v29 offset:6720
  s_waitcnt lgkmcnt(0) vmcnt(6)
  s_cmp_eq_u32 s80, 1
  s_cselect_b32 s21, s79, 0
  s_cmp_ge_u32 s21, 8
  s_cbranch_scc1 qw_294
  s_waitcnt vmcnt(0)
qw_294:
  v_mfma_f32_16x16x32_bf16 v[112:115], v[36:39], v[64:67], 0
  v_mfma_f32_16x16x32_bf16 v[120:123], v[36:39], v[88:91], 0
  v_mfma_f32_16x16x32_bf16 v[124:127], v[60:63], v[88:91], 0
  v_mfma_f32_16x16x32_bf16 v[112:115], v[40:43], v[68:71], v[112:115]
  v_mfma_f32_16x16x32_bf16 v[120:123], v[40:43], v[92:95], v[120:123]
  v_mfma_f32_16x16x32_bf16 v[124:127], v[236:239], v[92:95], v[124:127]
  v_mfma_f32_16x16x32_bf16 v[112:115], v[44:47], v[72:75], v[112:115]
  v_mfma_f32_16x16x32_bf16 v[120:123], v[44:47], v[96:99], v[120:123]
  v_mfma_f32_16x16x32_bf16 v[124:127], v[240:243], v[96:99], v[124:127]
  v_mfma_f32_16x16x32_bf16 v[112:115], v[48:51], v[76:79], v[112:115]
  v_mfma_f32_16x16x32_bf16 v[120:123], v[48:51], v[100:103], v[120:123]
  v_mfma_f32_16x16x32_bf16 v[124:127], v[244:247], v[100:103], v[124:127]
  v_mfma_f32_16x16x32_bf16 v[112:115], v[52:55], v[80:83], v[112:115]
  v_mfma_f32_16x16x32_bf16 v[120:123], v[52:55], v[104:107], v[120:123]
  v_mfma_f32_16x16x32_bf16 v[124:127], v[248:251], v[104:107], v[124:127]
  v_mfma_f32_16x16x32_bf16 v[112:115], v[56:59], v[84:87], v[112:115]
  v_mfma_f32_16x16x32_bf16 v[120:123], v[56:59], v[108:111], v[120:123]
  v_mfma_f32_16x16x32_bf16 v[124:127], v[252:255], v[108:111], v[124:127]
  s_cmp_eq_u32 s80, 1
  s_cbranch_scc1 qm_295
  s_add_u32 s23, s49, 1
  s_mov_b32 s101, 0
wm_296:
  buffer_load_dword v156, v33, s[72:75], s77 offen sc1
  s_add_u32 s101, s101, 1
  s_cmp_gt_u32 s101, 131072
  s_cbranch_scc1 main_end
  s_waitcnt vmcnt(0)
  v_cmp_gt_u32 vcc, s23, v156
  v_readfirstlane_b32 s100, v156
  s_nop 0
  s_cbranch_vccz wm_297
  s_sleep 4
  s_add_u32 s100, s100, 2
  s_cmp_ge_u32 s100, s23
  s_cbranch_scc1 wm_296
  s_sleep 90
  s_branch wm_296
wm_297:
  buffer_load_dwordx4 v[132:135], v31, s[52:55], s51 offen offset:0 sc1
  buffer_load_dwordx4 v[136:139], v31, s[52:55], s51 offen offset:512 sc1
  buffer_load_dwordx4 v[140:143], v31, s[52:55], s51 offen offset:1024 sc1
  buffer_load_dwordx4 v[144:147], v31, s[52:55], s51 offen offset:1536 sc1
  buffer_load_dwordx4 v[148:151], v31, s[52:55], s51 offen offset:2048 sc1
  buffer_load_dwordx4 v[152:155], v31, s[52:55], s51 offen offset:2560 sc1
qm_295:
  s_waitcnt vmcnt(0)
  v_mfma_f32_16x16x32_bf16 v[116:119], v[132:135], v[64:67], 0
  v_mfma_f32_16x16x32_bf16 v[128:131], v[132:135], v[88:91], 0
  v_mfma_f32_16x16x32_bf16 v[116:119], v[136:139], v[68:71], v[116:119]
  v_mfma_f32_16x16x32_bf16 v[128:131], v[136:139], v[92:95], v[128:131]
  v_mfma_f32_16x16x32_bf16 v[116:119], v[140:143], v[72:75], v[116:119]
  v_mfma_f32_16x16x32_bf16 v[128:131], v[140:143], v[96:99], v[128:131]
  v_mfma_f32_16x16x32_bf16 v[116:119], v[144:147], v[76:79], v[116:119]
  v_mfma_f32_16x16x32_bf16 v[128:131], v[144:147], v[100:103], v[128:131]
  v_mfma_f32_16x16x32_bf16 v[116:119], v[148:151], v[80:83], v[116:119]
  v_mfma_f32_16x16x32_bf16 v[128:131], v[148:151], v[104:107], v[128:131]
  v_mfma_f32_16x16x32_bf16 v[116:119], v[152:155], v[84:87], v[116:119]
  v_mfma_f32_16x16x32_bf16 v[128:131], v[152:155], v[108:111], v[128:131]
  s_lshl_b32 s21, s49, 5
  s_add_u32 s21, s21, s42
  s_mul_i32 s81, s21, 2560
  s_lshl_b32 s82, s49, 3
  s_and_b32 s21, s42, 7
  s_add_u32 s82, s82, s21
  s_lshl_b32 s82, s82, 7
  s_add_u32 s82, s82, 22528
  v_cndmask_b32 v112, v34, v112, s[64:65]
  v_cndmask_b32 v124, v34, v124, s[64:65]
  v_cndmask_b32 v113, v34, v113, s[66:67]
  v_cndmask_b32 v125, v34, v125, s[66:67]
  v_cndmask_b32 v114, v34, v114, s[68:69]
  v_cndmask_b32 v126, v34, v126, s[68:69]
  v_cndmask_b32 v115, v34, v115, s[70:71]
  v_cndmask_b32 v127, v34, v127, s[70:71]
  v_max3_f32 v156, v112, v113, v114
  v_max3_f32 v156, v156, v115, v116
  v_max3_f32 v156, v156, v117, v118
  v_max_f32 v156, v156, v119
  v_mov_b32 v157, v156
  s_nop 1
  v_permlane32_swap_b32 v156, v157
  v_max_f32 v156, v156, v157
  v_mov_b32 v157, v156
  s_nop 1
  v_permlane16_swap_b32 v156, v157
  v_max_f32 v156, v156, v157
  v_mul_f32 v156, s83, v156
  v_fma_f32 v112, v112, s83, -v156
  v_fma_f32 v113, v113, s83, -v156
  v_fma_f32 v114, v114, s83, -v156
  v_fma_f32 v115, v115, s83, -v156
  v_fma_f32 v116, v116, s83, -v156
  v_fma_f32 v117, v117, s83, -v156
  v_fma_f32 v118, v118, s83, -v156
  v_fma_f32 v119, v119, s83, -v156
  v_exp_f32 v112, v112
  v_exp_f32 v113, v113
  v_exp_f32 v114, v114
  v_exp_f32 v115, v115
  v_exp_f32 v116, v116
  v_exp_f32 v117, v117
  v_exp_f32 v118, v118
  v_exp_f32 v119, v119
  s_nop 0
  v_add_f32 v156, v116, v117
  v_add_f32 v156, v156, v118
  v_add_f32 v156, v156, v119
  v_cndmask_b32 v156, 0, v156, s[60:61]
  v_add_f32 v156, v156, v112
  v_add_f32 v156, v156, v113
  v_add_f32 v156, v156, v114
  v_add_f32 v156, v156, v115
  v_mov_b32 v157, v156
  s_nop 1
  v_permlane32_swap_b32 v156, v157
  v_add_f32 v156, v156, v157
  v_mov_b32 v157, v156
  s_nop 1
  v_permlane16_swap_b32 v156, v157
  v_add_f32 v156, v156, v157
  v_rcp_f32 v156, v156
  s_nop 0
  v_mul_f32 v112, v112, v156
  v_mul_f32 v113, v113, v156
  v_mul_f32 v114, v114, v156
  v_mul_f32 v115, v115, v156
  v_mul_f32 v116, v116, v156
  v_mul_f32 v117, v117, v156
  v_mul_f32 v118, v118, v156
  v_mul_f32 v119, v119, v156
  v_max3_f32 v156, v120, v121, v122
  v_max3_f32 v156, v156, v123, v124
  v_max3_f32 v156, v156, v125, v126
  v_max3_f32 v156, v156, v127, v128
  v_max3_f32 v156, v156, v129, v130
  v_max_f32 v156, v156, v131
  v_mov_b32 v157, v156
  s_nop 1
  v_permlane32_swap_b32 v156, v157
  v_max_f32 v156, v156, v157
  v_mov_b32 v157, v156
  s_nop 1
  v_permlane16_swap_b32 v156, v157
  v_max_f32 v156, v156, v157
  v_mul_f32 v156, s83, v156
  v_fma_f32 v120, v120, s83, -v156
  v_fma_f32 v121, v121, s83, -v156
  v_fma_f32 v122, v122, s83, -v156
  v_fma_f32 v123, v123, s83, -v156
  v_fma_f32 v124, v124, s83, -v156
  v_fma_f32 v125, v125, s83, -v156
  v_fma_f32 v126, v126, s83, -v156
  v_fma_f32 v127, v127, s83, -v156
  v_fma_f32 v128, v128, s83, -v156
  v_fma_f32 v129, v129, s83, -v156
  v_fma_f32 v130, v130, s83, -v156
  v_fma_f32 v131, v131, s83, -v156
  v_exp_f32 v120, v120
  v_exp_f32 v121, v121
  v_exp_f32 v122, v122
  v_exp_f32 v123, v123
  v_exp_f32 v124, v124
  v_exp_f32 v125, v125
  v_exp_f32 v126, v126
  v_exp_f32 v127, v127
  v_exp_f32 v128, v128
  v_exp_f32 v129, v129
  v_exp_f32 v130, v130
  v_exp_f32 v131, v131
  s_nop 0
  v_add_f32 v156, v128, v129
  v_add_f32 v156, v156, v130
  v_add_f32 v156, v156, v131
  v_cndmask_b32 v156, 0, v156, s[60:61]
  v_add_f32 v156, v156, v120
  v_add_f32 v156, v156, v121
  v_add_f32 v156, v156, v122
  v_add_f32 v156, v156, v123
  v_add_f32 v156, v156, v124
  v_add_f32 v156, v156, v125
  v_add_f32 v156, v156, v126
  v_add_f32 v156, v156, v127
  v_mov_b32 v157, v156
  s_nop 1
  v_permlane32_swap_b32 v156, v157
  v_add_f32 v156, v156, v157
  v_mov_b32 v157, v156
  s_nop 1
  v_permlane16_swap_b32 v156, v157
  v_add_f32 v156, v156, v157
  v_rcp_f32 v156, v156
  s_nop 0
  v_mul_f32 v120, v120, v156
  v_mul_f32 v121, v121, v156
  v_mul_f32 v122, v122, v156
  v_mul_f32 v123, v123, v156
  v_mul_f32 v124, v124, v156
  v_mul_f32 v125, v125, v156
  v_mul_f32 v126, v126, v156
  v_mul_f32 v127, v127, v156
  v_mul_f32 v128, v128, v156
  v_mul_f32 v129, v129, v156
  v_mul_f32 v130, v130, v156
  v_mul_f32 v131, v131, v156
  v_cvt_pk_bf16_f32 v192, v120, v121
  v_cvt_pk_bf16_f32 v193, v122, v123
  v_cvt_pk_bf16_f32 v194, v124, v125
  v_cvt_pk_bf16_f32 v195, v126, v127
  v_cvt_pk_bf16_f32 v196, v116, v117
  v_cvt_pk_bf16_f32 v197, v118, v119
  v_cvt_pk_bf16_f32 v198, v128, v129
  v_cvt_pk_bf16_f32 v199, v130, v131
  v_cvt_pk_bf16_f32 v200, v112, v113
  v_cvt_pk_bf16_f32 v201, v114, v115
  buffer_store_dwordx4 v[192:195], v30, s[56:59], s81 offen sc1
  buffer_store_dwordx4 v[196:199], v30, s[56:59], s81 offen offset:1024 sc1
  buffer_store_dwordx2 v[200:201], v32, s[56:59], s81 offen offset:2048 sc1
  s_mov_b32 s78, s82
  s_mov_b32 s81, 0x80000000
  s_mov_b32 s82, 0
  s_cmp_eq_u32 s80, 1
  s_cbranch_scc1 qd_298
  s_waitcnt vmcnt(0)
  s_cmp_eq_u32 s78, 0
  s_cbranch_scc1 pf_299
  v_mov_b32 v4, 0
  v_mov_b32 v5, 1
  s_mov_b64 exec, 1
  buffer_atomic_add v5, v4, s[72:75], s78 offen sc1
  s_mov_b64 exec, -1
  s_mov_b32 s78, 0
pf_299:
qd_298:
  s_add_u32 s49, s49, s29
qbe_287:
  s_sub_u32 s26, s26, 1
  s_cmp_gt_u32 s26, 0
  s_cbranch_scc1 qa_blk_275
  s_waitcnt vmcnt(0) lgkmcnt(0)
  s_lshl_b32 s21, s42, 7
  s_add_u32 s21, s21, 18432
  v_mov_b32 v25, 0
  buffer_load_dword v27, v25, s[72:75], s21 offen sc1
  s_waitcnt vmcnt(0)
  s_cmp_eq_u32 s78, 0
  s_cbranch_scc1 pf_300
  v_mov_b32 v4, 0
  v_mov_b32 v5, 1
  s_mov_b64 exec, 1
  buffer_atomic_add v5, v4, s[72:75], s78 offen sc1
  s_mov_b64 exec, -1
  s_mov_b32 s78, 0
pf_300:
  s_add_u32 s84, s42, 1
  v_mov_b32 v26, 32768
  s_waitcnt lgkmcnt(0)
  s_barrier
  s_cmp_lg_u32 s20, 0
  s_cbranch_scc1 a0_301
  ds_write_b32 v26, v27
a0_301:
  s_waitcnt lgkmcnt(0)
  s_barrier
  ds_read_b32 v27, v26
  s_waitcnt lgkmcnt(0)
  v_readfirstlane_b32 s64, v27
  s_barrier
  s_cmp_ge_u32 s64, 59
  s_cbranch_scc1 own_afin
queue:
  s_load_dwordx2 s[4:5], s[0:1], 96
  s_waitcnt lgkmcnt(0)
  s_mov_b32 s32, s4
  s_mov_b32 s33, s5
  s_mov_b32 s34, 256
  s_mov_b32 s35, 0x00020000
  s_waitcnt vmcnt(0) lgkmcnt(0)
  s_barrier
  s_mov_b32 s2, s85
  s_mov_b32 s85, -1
  s_cmp_lg_u32 s2, -1
  s_cbranch_scc1 queue_c
  v_mov_b32 v21, 0
  s_cmp_lg_u32 s20, 0
  s_cbranch_scc1 q_302
  v_mov_b32 v22, 80
  v_mov_b32 v23, 1
  s_mov_b64 exec, 1
  buffer_atomic_add v23, v22, s[32:35], 0 offen sc0 sc1
  s_waitcnt vmcnt(0)
queue_a:
  ds_write_b32 v21, v23
  s_waitcnt lgkmcnt(0)
  s_mov_b64 exec, -1
q_302:
queue_b:
  s_barrier
  ds_read_b32 v23, v21
  s_waitcnt lgkmcnt(0)
  v_readfirstlane_b32 s2, v23
  s_barrier
queue_c:
  s_cmp_eq_u32 s84, 0
  s_cbranch_scc1 od_303
  s_cmp_lt_u32 s2, 618
  s_cbranch_scc1 od_303
  s_mov_b32 s85, s2
  s_branch own_afin
od_303:
  s_add_u32 s21, s2, 0
  s_cmp_lt_u32 s2, 10
  s_cbranch_scc1 do_qbl
  s_sub_u32 s2, s2, 10
  s_add_u32 s21, s2, 0
  s_cmp_lt_u32 s2, 54
  s_cbranch_scc1 do_bat
  s_sub_u32 s2, s2, 54
  s_add_u32 s21, s2, 0
  s_cmp_lt_u32 s2, 56
  s_cbranch_scc1 do_opb
  s_sub_u32 s2, s2, 56
  s_add_u32 s21, s2, 54
  s_cmp_lt_u32 s2, 10
  s_cbranch_scc1 do_bat
  s_sub_u32 s2, s2, 10
  s_add_u32 s21, s2, 0
  s_cmp_lt_u32 s2, 48
  s_cbranch_scc1 do_pv
  s_sub_u32 s2, s2, 48
  s_add_u32 s21, s2, 56
  s_cmp_lt_u32 s2, 8
  s_cbranch_scc1 do_opb
  s_sub_u32 s2, s2, 8
  s_add_u32 s21, s2, 48
  s_cmp_lt_u32 s2, 384
  s_cbranch_scc1 do_pv
  s_sub_u32 s2, s2, 384
  s_add_u32 s21, s2, 432
  s_cmp_lt_u32 s2, 80
  s_cbranch_scc1 do_pv
  s_sub_u32 s2, s2, 80
  s_branch main_fin
do_qbl:
  s_mul_hi_u32 s42, s21, 0x1999999a
  s_mul_i32 s22, s42, 10
  s_sub_u32 s41, s21, s22
  s_add_u32 s42, s42, 15
  s_mov_b32 s26, 1
  s_mov_b32 s63, 1
  s_mov_b32 s64, 1
  s_branch qkvb_entry
do_opb:
  s_mov_b32 s2, s21
  s_lshr_b32 s40, s2, 2
  s_and_b32 s42, s2, 3
  s_mov_b32 s43, 4
  s_load_dwordx2 s[4:5], s[0:1], 40
  s_load_dwordx2 s[6:7], s[0:1], 72
  s_load_dwordx2 s[38:39], s[0:1], 104
  s_waitcnt lgkmcnt(0)
  s_cmp_eq_u32 s43, 4
  s_cselect_b32 s4, s6, s4
  s_cselect_b32 s5, s7, s5
  s_mov_b32 s10, 7864320
  s_cselect_b32 s10, 819200, s10
  s_cselect_b32 s44, 10, 24
  s_mov_b32 s45, 196608
  s_cselect_b32 s45, 20480, s45
  s_mov_b32 s46, 93323264
  s_cselect_b32 s46, 70778880, s46
  s_cselect_b32 s47, 1, 0
  s_mov_b32 s8, s4
  s_mov_b32 s9, s5
  s_mov_b32 s11, 0x00020000
  s_mov_b32 s12, s38
  s_mov_b32 s13, s39
  s_mov_b32 s14, 73400320
  s_mov_b32 s15, 0x00020000
  s_add_u32 s16, s38, 73400320
  s_addc_u32 s17, s39, 0
  s_mov_b32 s18, 5242880
  s_mov_b32 s19, 0x00020000
  s_lshl_b32 s21, s40, 3
  s_lshl_b32 s22, s20, 1
  s_add_u32 s21, s21, s22
  s_mul_i32 s21, s21, s45
  s_add_u32 s48, s46, s21
  s_and_b32 s22, s43, 3
  s_mul_i32 s22, s22, 49152
  s_cmp_eq_u32 s47, 1
  s_cselect_b32 s22, 0, s22
  s_add_u32 s48, s48, s22
  v_lshlrev_b32 v4, 4, v1
  s_and_b32 s22, s43, 3
  s_mul_i32 s49, s22, 1966080
  s_cmp_eq_u32 s47, 1
  s_cselect_b32 s49, 0, s49
  s_mul_i32 s22, s42, 320
  s_add_u32 s49, s49, s22
  v_mov_b32 v29, 3277
  s_mul_i32 s21, s20, 320
  s_add_u32 s21, s21, 0
  v_add_u32 v21, s21, v1
  v_mul_u32_u24 v22, v21, v29
  v_lshrrev_b32 v22, 16, v22
  v_mul_u32_u24 v23, 20, v22
  v_sub_u32 v21, v21, v23
  v_add_u32 v22, 0, v22
  v_mov_b32 v25, v22
  s_cmp_eq_u32 s47, 1
  s_cbranch_scc1 id_304
  v_and_b32 v23, 0xe3, v22
  v_bfe_u32 v24, v22, 2, 1
  v_lshl_add_u32 v23, v24, 4, v23
  v_bfe_u32 v24, v22, 3, 2
  v_lshl_add_u32 v22, v24, 2, v23
  v_mul_u32_u24 v23, 1366, v22
  v_lshrrev_b32 v23, 16, v23
  v_mul_u32_u24 v25, 48, v23
  v_sub_u32 v22, v22, v25
  v_mul_u32_u24 v26, 5462, v22
  v_lshrrev_b32 v26, 16, v26
  v_mul_u32_u24 v27, 12, v26
  v_sub_u32 v22, v22, v27
  v_lshrrev_b32 v27, 2, v22
  v_and_b32 v22, 3, v22
  v_lshl_add_u32 v25, v27, 4, v25
  v_lshl_add_u32 v25, v26, 2, v25
  v_add_u32 v25, v25, v22
id_304:
  v_mul_u32_u24 v25, 1280, v25
  v_lshl_add_u32 v64, v21, 4, v25
  s_mul_i32 s21, s20, 320
  s_add_u32 s21, s21, 64
  v_add_u32 v21, s21, v1
  v_mul_u32_u24 v22, v21, v29
  v_lshrrev_b32 v22, 16, v22
  v_mul_u32_u24 v23, 20, v22
  v_sub_u32 v21, v21, v23
  v_add_u32 v22, 0, v22
  v_mov_b32 v25, v22
  s_cmp_eq_u32 s47, 1
  s_cbranch_scc1 id_305
  v_and_b32 v23, 0xe3, v22
  v_bfe_u32 v24, v22, 2, 1
  v_lshl_add_u32 v23, v24, 4, v23
  v_bfe_u32 v24, v22, 3, 2
  v_lshl_add_u32 v22, v24, 2, v23
  v_mul_u32_u24 v23, 1366, v22
  v_lshrrev_b32 v23, 16, v23
  v_mul_u32_u24 v25, 48, v23
  v_sub_u32 v22, v22, v25
  v_mul_u32_u24 v26, 5462, v22
  v_lshrrev_b32 v26, 16, v26
  v_mul_u32_u24 v27, 12, v26
  v_sub_u32 v22, v22, v27
  v_lshrrev_b32 v27, 2, v22
  v_and_b32 v22, 3, v22
  v_lshl_add_u32 v25, v27, 4, v25
  v_lshl_add_u32 v25, v26, 2, v25
  v_add_u32 v25, v25, v22
id_305:
  v_mul_u32_u24 v25, 1280, v25
  v_lshl_add_u32 v65, v21, 4, v25
  s_mul_i32 s21, s20, 320
  s_add_u32 s21, s21, 128
  v_add_u32 v21, s21, v1
  v_mul_u32_u24 v22, v21, v29
  v_lshrrev_b32 v22, 16, v22
  v_mul_u32_u24 v23, 20, v22
  v_sub_u32 v21, v21, v23
  v_add_u32 v22, 0, v22
  v_mov_b32 v25, v22
  s_cmp_eq_u32 s47, 1
  s_cbranch_scc1 id_306
  v_and_b32 v23, 0xe3, v22
  v_bfe_u32 v24, v22, 2, 1
  v_lshl_add_u32 v23, v24, 4, v23
  v_bfe_u32 v24, v22, 3, 2
  v_lshl_add_u32 v22, v24, 2, v23
  v_mul_u32_u24 v23, 1366, v22
  v_lshrrev_b32 v23, 16, v23
  v_mul_u32_u24 v25, 48, v23
  v_sub_u32 v22, v22, v25
  v_mul_u32_u24 v26, 5462, v22
  v_lshrrev_b32 v26, 16, v26
  v_mul_u32_u24 v27, 12, v26
  v_sub_u32 v22, v22, v27
  v_lshrrev_b32 v27, 2, v22
  v_and_b32 v22, 3, v22
  v_lshl_add_u32 v25, v27, 4, v25
  v_lshl_add_u32 v25, v26, 2, v25
  v_add_u32 v25, v25, v22
id_306:
  v_mul_u32_u24 v25, 1280, v25
  v_lshl_add_u32 v66, v21, 4, v25
  s_mul_i32 s21, s20, 320
  s_add_u32 s21, s21, 192
  v_add_u32 v21, s21, v1
  v_mul_u32_u24 v22, v21, v29
  v_lshrrev_b32 v22, 16, v22
  v_mul_u32_u24 v23, 20, v22
  v_sub_u32 v21, v21, v23
  v_add_u32 v22, 0, v22
  v_mov_b32 v25, v22
  s_cmp_eq_u32 s47, 1
  s_cbranch_scc1 id_307
  v_and_b32 v23, 0xe3, v22
  v_bfe_u32 v24, v22, 2, 1
  v_lshl_add_u32 v23, v24, 4, v23
  v_bfe_u32 v24, v22, 3, 2
  v_lshl_add_u32 v22, v24, 2, v23
  v_mul_u32_u24 v23, 1366, v22
  v_lshrrev_b32 v23, 16, v23
  v_mul_u32_u24 v25, 48, v23
  v_sub_u32 v22, v22, v25
  v_mul_u32_u24 v26, 5462, v22
  v_lshrrev_b32 v26, 16, v26
  v_mul_u32_u24 v27, 12, v26
  v_sub_u32 v22, v22, v27
  v_lshrrev_b32 v27, 2, v22
  v_and_b32 v22, 3, v22
  v_lshl_add_u32 v25, v27, 4, v25
  v_lshl_add_u32 v25, v26, 2, v25
  v_add_u32 v25, v25, v22
id_307:
  v_mul_u32_u24 v25, 1280, v25
  v_lshl_add_u32 v67, v21, 4, v25
  s_mul_i32 s21, s20, 320
  s_add_u32 s21, s21, 256
  v_add_u32 v21, s21, v1
  v_mul_u32_u24 v22, v21, v29
  v_lshrrev_b32 v22, 16, v22
  v_mul_u32_u24 v23, 20, v22
  v_sub_u32 v21, v21, v23
  v_add_u32 v22, 0, v22
  v_mov_b32 v25, v22
  s_cmp_eq_u32 s47, 1
  s_cbranch_scc1 id_308
  v_and_b32 v23, 0xe3, v22
  v_bfe_u32 v24, v22, 2, 1
  v_lshl_add_u32 v23, v24, 4, v23
  v_bfe_u32 v24, v22, 3, 2
  v_lshl_add_u32 v22, v24, 2, v23
  v_mul_u32_u24 v23, 1366, v22
  v_lshrrev_b32 v23, 16, v23
  v_mul_u32_u24 v25, 48, v23
  v_sub_u32 v22, v22, v25
  v_mul_u32_u24 v26, 5462, v22
  v_lshrrev_b32 v26, 16, v26
  v_mul_u32_u24 v27, 12, v26
  v_sub_u32 v22, v22, v27
  v_lshrrev_b32 v27, 2, v22
  v_and_b32 v22, 3, v22
  v_lshl_add_u32 v25, v27, 4, v25
  v_lshl_add_u32 v25, v26, 2, v25
  v_add_u32 v25, v25, v22
id_308:
  v_mul_u32_u24 v25, 1280, v25
  v_lshl_add_u32 v68, v21, 4, v25
  s_mul_i32 s21, s20, 320
  s_add_u32 s21, s21, 0
  v_add_u32 v21, s21, v1
  v_mul_u32_u24 v22, v21, v29
  v_lshrrev_b32 v22, 16, v22
  v_mul_u32_u24 v23, 20, v22
  v_sub_u32 v21, v21, v23
  v_add_u32 v22, 64, v22
  v_mov_b32 v25, v22
  s_cmp_eq_u32 s47, 1
  s_cbranch_scc1 id_309
  v_and_b32 v23, 0xe3, v22
  v_bfe_u32 v24, v22, 2, 1
  v_lshl_add_u32 v23, v24, 4, v23
  v_bfe_u32 v24, v22, 3, 2
  v_lshl_add_u32 v22, v24, 2, v23
  v_mul_u32_u24 v23, 1366, v22
  v_lshrrev_b32 v23, 16, v23
  v_mul_u32_u24 v25, 48, v23
  v_sub_u32 v22, v22, v25
  v_mul_u32_u24 v26, 5462, v22
  v_lshrrev_b32 v26, 16, v26
  v_mul_u32_u24 v27, 12, v26
  v_sub_u32 v22, v22, v27
  v_lshrrev_b32 v27, 2, v22
  v_and_b32 v22, 3, v22
  v_lshl_add_u32 v25, v27, 4, v25
  v_lshl_add_u32 v25, v26, 2, v25
  v_add_u32 v25, v25, v22
id_309:
  v_mul_u32_u24 v25, 1280, v25
  v_lshl_add_u32 v69, v21, 4, v25
  s_mul_i32 s21, s20, 320
  s_add_u32 s21, s21, 64
  v_add_u32 v21, s21, v1
  v_mul_u32_u24 v22, v21, v29
  v_lshrrev_b32 v22, 16, v22
  v_mul_u32_u24 v23, 20, v22
  v_sub_u32 v21, v21, v23
  v_add_u32 v22, 64, v22
  v_mov_b32 v25, v22
  s_cmp_eq_u32 s47, 1
  s_cbranch_scc1 id_310
  v_and_b32 v23, 0xe3, v22
  v_bfe_u32 v24, v22, 2, 1
  v_lshl_add_u32 v23, v24, 4, v23
  v_bfe_u32 v24, v22, 3, 2
  v_lshl_add_u32 v22, v24, 2, v23
  v_mul_u32_u24 v23, 1366, v22
  v_lshrrev_b32 v23, 16, v23
  v_mul_u32_u24 v25, 48, v23
  v_sub_u32 v22, v22, v25
  v_mul_u32_u24 v26, 5462, v22
  v_lshrrev_b32 v26, 16, v26
  v_mul_u32_u24 v27, 12, v26
  v_sub_u32 v22, v22, v27
  v_lshrrev_b32 v27, 2, v22
  v_and_b32 v22, 3, v22
  v_lshl_add_u32 v25, v27, 4, v25
  v_lshl_add_u32 v25, v26, 2, v25
  v_add_u32 v25, v25, v22
id_310:
  v_mul_u32_u24 v25, 1280, v25
  v_lshl_add_u32 v70, v21, 4, v25
  s_mul_i32 s21, s20, 320
  s_add_u32 s21, s21, 128
  v_add_u32 v21, s21, v1
  v_mul_u32_u24 v22, v21, v29
  v_lshrrev_b32 v22, 16, v22
  v_mul_u32_u24 v23, 20, v22
  v_sub_u32 v21, v21, v23
  v_add_u32 v22, 64, v22
  v_mov_b32 v25, v22
  s_cmp_eq_u32 s47, 1
  s_cbranch_scc1 id_311
  v_and_b32 v23, 0xe3, v22
  v_bfe_u32 v24, v22, 2, 1
  v_lshl_add_u32 v23, v24, 4, v23
  v_bfe_u32 v24, v22, 3, 2
  v_lshl_add_u32 v22, v24, 2, v23
  v_mul_u32_u24 v23, 1366, v22
  v_lshrrev_b32 v23, 16, v23
  v_mul_u32_u24 v25, 48, v23
  v_sub_u32 v22, v22, v25
  v_mul_u32_u24 v26, 5462, v22
  v_lshrrev_b32 v26, 16, v26
  v_mul_u32_u24 v27, 12, v26
  v_sub_u32 v22, v22, v27
  v_lshrrev_b32 v27, 2, v22
  v_and_b32 v22, 3, v22
  v_lshl_add_u32 v25, v27, 4, v25
  v_lshl_add_u32 v25, v26, 2, v25
  v_add_u32 v25, v25, v22
id_311:
  v_mul_u32_u24 v25, 1280, v25
  v_lshl_add_u32 v71, v21, 4, v25
  s_mul_i32 s21, s20, 320
  s_add_u32 s21, s21, 192
  v_add_u32 v21, s21, v1
  v_mul_u32_u24 v22, v21, v29
  v_lshrrev_b32 v22, 16, v22
  v_mul_u32_u24 v23, 20, v22
  v_sub_u32 v21, v21, v23
  v_add_u32 v22, 64, v22
  v_mov_b32 v25, v22
  s_cmp_eq_u32 s47, 1
  s_cbranch_scc1 id_312
  v_and_b32 v23, 0xe3, v22
  v_bfe_u32 v24, v22, 2, 1
  v_lshl_add_u32 v23, v24, 4, v23
  v_bfe_u32 v24, v22, 3, 2
  v_lshl_add_u32 v22, v24, 2, v23
  v_mul_u32_u24 v23, 1366, v22
  v_lshrrev_b32 v23, 16, v23
  v_mul_u32_u24 v25, 48, v23
  v_sub_u32 v22, v22, v25
  v_mul_u32_u24 v26, 5462, v22
  v_lshrrev_b32 v26, 16, v26
  v_mul_u32_u24 v27, 12, v26
  v_sub_u32 v22, v22, v27
  v_lshrrev_b32 v27, 2, v22
  v_and_b32 v22, 3, v22
  v_lshl_add_u32 v25, v27, 4, v25
  v_lshl_add_u32 v25, v26, 2, v25
  v_add_u32 v25, v25, v22
id_312:
  v_mul_u32_u24 v25, 1280, v25
  v_lshl_add_u32 v72, v21, 4, v25
  s_mul_i32 s21, s20, 320
  s_add_u32 s21, s21, 256
  v_add_u32 v21, s21, v1
  v_mul_u32_u24 v22, v21, v29
  v_lshrrev_b32 v22, 16, v22
  v_mul_u32_u24 v23, 20, v22
  v_sub_u32 v21, v21, v23
  v_add_u32 v22, 64, v22
  v_mov_b32 v25, v22
  s_cmp_eq_u32 s47, 1
  s_cbranch_scc1 id_313
  v_and_b32 v23, 0xe3, v22
  v_bfe_u32 v24, v22, 2, 1
  v_lshl_add_u32 v23, v24, 4, v23
  v_bfe_u32 v24, v22, 3, 2
  v_lshl_add_u32 v22, v24, 2, v23
  v_mul_u32_u24 v23, 1366, v22
  v_lshrrev_b32 v23, 16, v23
  v_mul_u32_u24 v25, 48, v23
  v_sub_u32 v22, v22, v25
  v_mul_u32_u24 v26, 5462, v22
  v_lshrrev_b32 v26, 16, v26
  v_mul_u32_u24 v27, 12, v26
  v_sub_u32 v22, v22, v27
  v_lshrrev_b32 v27, 2, v22
  v_and_b32 v22, 3, v22
  v_lshl_add_u32 v25, v27, 4, v25
  v_lshl_add_u32 v25, v26, 2, v25
  v_add_u32 v25, v25, v22
id_313:
  v_mul_u32_u24 v25, 1280, v25
  v_lshl_add_u32 v73, v21, 4, v25
  s_mul_i32 s21, s20, 320
  s_add_u32 s21, s21, 0
  v_add_u32 v21, s21, v1
  v_mul_u32_u24 v22, v21, v29
  v_lshrrev_b32 v22, 16, v22
  v_mul_u32_u24 v23, 20, v22
  v_sub_u32 v21, v21, v23
  v_add_u32 v22, 128, v22
  v_mov_b32 v25, v22
  s_cmp_eq_u32 s47, 1
  s_cbranch_scc1 id_314
  v_and_b32 v23, 0xe3, v22
  v_bfe_u32 v24, v22, 2, 1
  v_lshl_add_u32 v23, v24, 4, v23
  v_bfe_u32 v24, v22, 3, 2
  v_lshl_add_u32 v22, v24, 2, v23
  v_mul_u32_u24 v23, 1366, v22
  v_lshrrev_b32 v23, 16, v23
  v_mul_u32_u24 v25, 48, v23
  v_sub_u32 v22, v22, v25
  v_mul_u32_u24 v26, 5462, v22
  v_lshrrev_b32 v26, 16, v26
  v_mul_u32_u24 v27, 12, v26
  v_sub_u32 v22, v22, v27
  v_lshrrev_b32 v27, 2, v22
  v_and_b32 v22, 3, v22
  v_lshl_add_u32 v25, v27, 4, v25
  v_lshl_add_u32 v25, v26, 2, v25
  v_add_u32 v25, v25, v22
id_314:
  v_mul_u32_u24 v25, 1280, v25
  v_lshl_add_u32 v74, v21, 4, v25
  s_mul_i32 s21, s20, 320
  s_add_u32 s21, s21, 64
  v_add_u32 v21, s21, v1
  v_mul_u32_u24 v22, v21, v29
  v_lshrrev_b32 v22, 16, v22
  v_mul_u32_u24 v23, 20, v22
  v_sub_u32 v21, v21, v23
  v_add_u32 v22, 128, v22
  v_mov_b32 v25, v22
  s_cmp_eq_u32 s47, 1
  s_cbranch_scc1 id_315
  v_and_b32 v23, 0xe3, v22
  v_bfe_u32 v24, v22, 2, 1
  v_lshl_add_u32 v23, v24, 4, v23
  v_bfe_u32 v24, v22, 3, 2
  v_lshl_add_u32 v22, v24, 2, v23
  v_mul_u32_u24 v23, 1366, v22
  v_lshrrev_b32 v23, 16, v23
  v_mul_u32_u24 v25, 48, v23
  v_sub_u32 v22, v22, v25
  v_mul_u32_u24 v26, 5462, v22
  v_lshrrev_b32 v26, 16, v26
  v_mul_u32_u24 v27, 12, v26
  v_sub_u32 v22, v22, v27
  v_lshrrev_b32 v27, 2, v22
  v_and_b32 v22, 3, v22
  v_lshl_add_u32 v25, v27, 4, v25
  v_lshl_add_u32 v25, v26, 2, v25
  v_add_u32 v25, v25, v22
id_315:
  v_mul_u32_u24 v25, 1280, v25
  v_lshl_add_u32 v75, v21, 4, v25
  s_mul_i32 s21, s20, 320
  s_add_u32 s21, s21, 128
  v_add_u32 v21, s21, v1
  v_mul_u32_u24 v22, v21, v29
  v_lshrrev_b32 v22, 16, v22
  v_mul_u32_u24 v23, 20, v22
  v_sub_u32 v21, v21, v23
  v_add_u32 v22, 128, v22
  v_mov_b32 v25, v22
  s_cmp_eq_u32 s47, 1
  s_cbranch_scc1 id_316
  v_and_b32 v23, 0xe3, v22
  v_bfe_u32 v24, v22, 2, 1
  v_lshl_add_u32 v23, v24, 4, v23
  v_bfe_u32 v24, v22, 3, 2
  v_lshl_add_u32 v22, v24, 2, v23
  v_mul_u32_u24 v23, 1366, v22
  v_lshrrev_b32 v23, 16, v23
  v_mul_u32_u24 v25, 48, v23
  v_sub_u32 v22, v22, v25
  v_mul_u32_u24 v26, 5462, v22
  v_lshrrev_b32 v26, 16, v26
  v_mul_u32_u24 v27, 12, v26
  v_sub_u32 v22, v22, v27
  v_lshrrev_b32 v27, 2, v22
  v_and_b32 v22, 3, v22
  v_lshl_add_u32 v25, v27, 4, v25
  v_lshl_add_u32 v25, v26, 2, v25
  v_add_u32 v25, v25, v22
id_316:
  v_mul_u32_u24 v25, 1280, v25
  v_lshl_add_u32 v76, v21, 4, v25
  s_mul_i32 s21, s20, 320
  s_add_u32 s21, s21, 192
  v_add_u32 v21, s21, v1
  v_mul_u32_u24 v22, v21, v29
  v_lshrrev_b32 v22, 16, v22
  v_mul_u32_u24 v23, 20, v22
  v_sub_u32 v21, v21, v23
  v_add_u32 v22, 128, v22
  v_mov_b32 v25, v22
  s_cmp_eq_u32 s47, 1
  s_cbranch_scc1 id_317
  v_and_b32 v23, 0xe3, v22
  v_bfe_u32 v24, v22, 2, 1
  v_lshl_add_u32 v23, v24, 4, v23
  v_bfe_u32 v24, v22, 3, 2
  v_lshl_add_u32 v22, v24, 2, v23
  v_mul_u32_u24 v23, 1366, v22
  v_lshrrev_b32 v23, 16, v23
  v_mul_u32_u24 v25, 48, v23
  v_sub_u32 v22, v22, v25
  v_mul_u32_u24 v26, 5462, v22
  v_lshrrev_b32 v26, 16, v26
  v_mul_u32_u24 v27, 12, v26
  v_sub_u32 v22, v22, v27
  v_lshrrev_b32 v27, 2, v22
  v_and_b32 v22, 3, v22
  v_lshl_add_u32 v25, v27, 4, v25
  v_lshl_add_u32 v25, v26, 2, v25
  v_add_u32 v25, v25, v22
id_317:
  v_mul_u32_u24 v25, 1280, v25
  v_lshl_add_u32 v77, v21, 4, v25
  s_mul_i32 s21, s20, 320
  s_add_u32 s21, s21, 256
  v_add_u32 v21, s21, v1
  v_mul_u32_u24 v22, v21, v29
  v_lshrrev_b32 v22, 16, v22
  v_mul_u32_u24 v23, 20, v22
  v_sub_u32 v21, v21, v23
  v_add_u32 v22, 128, v22
  v_mov_b32 v25, v22
  s_cmp_eq_u32 s47, 1
  s_cbranch_scc1 id_318
  v_and_b32 v23, 0xe3, v22
  v_bfe_u32 v24, v22, 2, 1
  v_lshl_add_u32 v23, v24, 4, v23
  v_bfe_u32 v24, v22, 3, 2
  v_lshl_add_u32 v22, v24, 2, v23
  v_mul_u32_u24 v23, 1366, v22
  v_lshrrev_b32 v23, 16, v23
  v_mul_u32_u24 v25, 48, v23
  v_sub_u32 v22, v22, v25
  v_mul_u32_u24 v26, 5462, v22
  v_lshrrev_b32 v26, 16, v26
  v_mul_u32_u24 v27, 12, v26
  v_sub_u32 v22, v22, v27
  v_lshrrev_b32 v27, 2, v22
  v_and_b32 v22, 3, v22
  v_lshl_add_u32 v25, v27, 4, v25
  v_lshl_add_u32 v25, v26, 2, v25
  v_add_u32 v25, v25, v22
id_318:
  v_mul_u32_u24 v25, 1280, v25
  v_lshl_add_u32 v78, v21, 4, v25
  s_lshr_b32 s21, s20, 1
  s_lshl_b32 s21, s21, 13
  v_add_u32 v5, s21, v4
  v_lshrrev_b32 v6, 2, v2
  v_lshl_add_u32 v6, v3, 3, v6
  v_mul_u32_u24 v6, 320, v6
  v_and_b32 v7, 3, v2
  v_lshlrev_b32 v7, 3, v7
  s_and_b32 s21, s20, 1
  s_mul_i32 s21, s21, 160
  s_add_u32 s21, s21, 16384
  v_add3_u32 v6, v6, v7, s21
  s_mov_b32 s50, 0
  s_mov_b32 s51, 0
  v_mov_b32 v80, 0
  v_mov_b32 v81, 0
  v_mov_b32 v82, 0
  v_mov_b32 v83, 0
  v_mov_b32 v84, 0
  v_mov_b32 v85, 0
  v_mov_b32 v86, 0
  v_mov_b32 v87, 0
  v_mov_b32 v88, 0
  v_mov_b32 v89, 0
  v_mov_b32 v90, 0
  v_mov_b32 v91, 0
  v_mov_b32 v92, 0
  v_mov_b32 v93, 0
  v_mov_b32 v94, 0
  v_mov_b32 v95, 0
  v_mov_b32 v96, 0
  v_mov_b32 v97, 0
  v_mov_b32 v98, 0
  v_mov_b32 v99, 0
  v_mov_b32 v100, 0
  v_mov_b32 v101, 0
  v_mov_b32 v102, 0
  v_mov_b32 v103, 0
  v_mov_b32 v104, 0
  v_mov_b32 v105, 0
  v_mov_b32 v106, 0
  v_mov_b32 v107, 0
  v_mov_b32 v108, 0
  v_mov_b32 v109, 0
  v_mov_b32 v110, 0
  v_mov_b32 v111, 0
  v_mov_b32 v112, 0
  v_mov_b32 v113, 0
  v_mov_b32 v114, 0
  v_mov_b32 v115, 0
  v_mov_b32 v116, 0
  v_mov_b32 v117, 0
  v_mov_b32 v118, 0
  v_mov_b32 v119, 0
  v_mov_b32 v120, 0
  v_mov_b32 v121, 0
  v_mov_b32 v122, 0
  v_mov_b32 v123, 0
  v_mov_b32 v124, 0
  v_mov_b32 v125, 0
  v_mov_b32 v126, 0
  v_mov_b32 v127, 0
  v_mov_b32 v128, 0
  v_mov_b32 v129, 0
  v_mov_b32 v130, 0
  v_mov_b32 v131, 0
  v_mov_b32 v132, 0
  v_mov_b32 v133, 0
  v_mov_b32 v134, 0
  v_mov_b32 v135, 0
  v_mov_b32 v136, 0
  v_mov_b32 v137, 0
  v_mov_b32 v138, 0
  v_mov_b32 v139, 0
  v_mov_b32 v140, 0
  v_mov_b32 v141, 0
  v_mov_b32 v142, 0
  v_mov_b32 v143, 0
  v_mov_b32 v144, 0
  v_mov_b32 v145, 0
  v_mov_b32 v146, 0
  v_mov_b32 v147, 0
  v_mov_b32 v148, 0
  v_mov_b32 v149, 0
  v_mov_b32 v150, 0
  v_mov_b32 v151, 0
  v_mov_b32 v152, 0
  v_mov_b32 v153, 0
  v_mov_b32 v154, 0
  v_mov_b32 v155, 0
  v_mov_b32 v156, 0
  v_mov_b32 v157, 0
  v_mov_b32 v158, 0
  v_mov_b32 v159, 0
  s_lshl_b32 s53, s44, 11
  s_add_u32 s53, s53, s48
  s_sub_u32 s53, s53, 2048
  s_load_dwordx2 s[72:73], s[0:1], 104
  s_waitcnt lgkmcnt(0)
  s_add_u32 s72, s72, 81068032
  s_addc_u32 s73, s73, 0
  s_mov_b32 s74, 115712
  s_mov_b32 s75, 0x00020000
  s_lshl_b32 s21, s40, 7
  s_add_u32 s21, s21, 90112
  s_mov_b32 s23, 4
  s_cmp_lg_u32 s20, 0
  s_cbranch_scc1 wf_320
  v_mov_b32 v10, 0
  s_mov_b32 s101, 0
wf_319:
  buffer_load_dword v11, v10, s[72:75], s21 offen sc1
  s_add_u32 s101, s101, 1
  s_cmp_gt_u32 s101, 131072
  s_cbranch_scc1 main_end
  s_waitcnt vmcnt(0)
  v_readfirstlane_b32 s100, v11
  s_cmp_ge_u32 s100, s23
  s_cbranch_scc1 wf_320
  s_sleep 8
  s_add_u32 s100, s100, 8
  s_cmp_ge_u32 s100, s23
  s_cbranch_scc1 wf_319
  s_sleep 60
  s_branch wf_319
wf_320:
  s_barrier
  s_lshl_b32 s22, s20, 12
  s_add_u32 s22, s22, s50
  s_add_u32 s23, s48, s45
  s_add_u32 m0, s22, 0
  s_nop 0
  buffer_load_dwordx4 v4, s[12:15], s48 offen offset:0 sc1 lds
  s_add_u32 m0, s22, 0
  s_nop 0
  buffer_load_dwordx4 v4, s[12:15], s48 offen offset:1024 sc1 lds
  s_add_u32 m0, s22, 2048
  s_nop 0
  buffer_load_dwordx4 v4, s[12:15], s23 offen offset:0 sc1 lds
  s_add_u32 m0, s22, 2048
  s_nop 0
  buffer_load_dwordx4 v4, s[12:15], s23 offen offset:1024 sc1 lds
  s_mul_i32 s22, s20, 5120
  s_add_u32 s22, s22, s50
  s_add_u32 s22, s22, 16384
  s_add_u32 m0, s22, 0
  s_nop 0
  buffer_load_dwordx4 v64, s[8:11], s49 offen lds
  s_add_u32 m0, s22, 1024
  s_nop 0
  buffer_load_dwordx4 v65, s[8:11], s49 offen lds
  s_add_u32 m0, s22, 2048
  s_nop 0
  buffer_load_dwordx4 v66, s[8:11], s49 offen lds
  s_add_u32 m0, s22, 3072
  s_nop 0
  buffer_load_dwordx4 v67, s[8:11], s49 offen lds
  s_add_u32 m0, s22, 4096
  s_nop 0
  buffer_load_dwordx4 v68, s[8:11], s49 offen lds
  s_add_u32 s48, s48, 2048
  s_min_u32 s48, s48, s53
  s_add_u32 s50, s50, 36864
  s_cmp_lt_u32 s50, 147456
  s_cselect_b32 s50, s50, 0
  s_lshl_b32 s22, s20, 12
  s_add_u32 s22, s22, s50
  s_add_u32 s23, s48, s45
  s_add_u32 m0, s22, 0
  s_nop 0
  buffer_load_dwordx4 v4, s[12:15], s48 offen offset:0 sc1 lds
  s_add_u32 m0, s22, 0
  s_nop 0
  buffer_load_dwordx4 v4, s[12:15], s48 offen offset:1024 sc1 lds
  s_add_u32 m0, s22, 2048
  s_nop 0
  buffer_load_dwordx4 v4, s[12:15], s23 offen offset:0 sc1 lds
  s_add_u32 m0, s22, 2048
  s_nop 0
  buffer_load_dwordx4 v4, s[12:15], s23 offen offset:1024 sc1 lds
  s_mul_i32 s22, s20, 5120
  s_add_u32 s22, s22, s50
  s_add_u32 s22, s22, 16384
  s_add_u32 m0, s22, 0
  s_nop 0
  buffer_load_dwordx4 v69, s[8:11], s49 offen lds
  s_add_u32 m0, s22, 1024
  s_nop 0
  buffer_load_dwordx4 v70, s[8:11], s49 offen lds
  s_add_u32 m0, s22, 2048
  s_nop 0
  buffer_load_dwordx4 v71, s[8:11], s49 offen lds
  s_add_u32 m0, s22, 3072
  s_nop 0
  buffer_load_dwordx4 v72, s[8:11], s49 offen lds
  s_add_u32 m0, s22, 4096
  s_nop 0
  buffer_load_dwordx4 v73, s[8:11], s49 offen lds
  s_add_u32 s48, s48, 2048
  s_min_u32 s48, s48, s53
  s_add_u32 s50, s50, 36864
  s_cmp_lt_u32 s50, 147456
  s_cselect_b32 s50, s50, 0
  s_lshl_b32 s22, s20, 12
  s_add_u32 s22, s22, s50
  s_add_u32 s23, s48, s45
  s_add_u32 m0, s22, 0
  s_nop 0
  buffer_load_dwordx4 v4, s[12:15], s48 offen offset:0 sc1 lds
  s_add_u32 m0, s22, 0
  s_nop 0
  buffer_load_dwordx4 v4, s[12:15], s48 offen offset:1024 sc1 lds
  s_add_u32 m0, s22, 2048
  s_nop 0
  buffer_load_dwordx4 v4, s[12:15], s23 offen offset:0 sc1 lds
  s_add_u32 m0, s22, 2048
  s_nop 0
  buffer_load_dwordx4 v4, s[12:15], s23 offen offset:1024 sc1 lds
  s_mul_i32 s22, s20, 5120
  s_add_u32 s22, s22, s50
  s_add_u32 s22, s22, 16384
  s_add_u32 m0, s22, 0
  s_nop 0
  buffer_load_dwordx4 v74, s[8:11], s49 offen lds
  s_add_u32 m0, s22, 1024
  s_nop 0
  buffer_load_dwordx4 v75, s[8:11], s49 offen lds
  s_add_u32 m0, s22, 2048
  s_nop 0
  buffer_load_dwordx4 v76, s[8:11], s49 offen lds
  s_add_u32 m0, s22, 3072
  s_nop 0
  buffer_load_dwordx4 v77, s[8:11], s49 offen lds
  s_add_u32 m0, s22, 4096
  s_nop 0
  buffer_load_dwordx4 v78, s[8:11], s49 offen lds
  s_add_u32 s48, s48, 2048
  s_min_u32 s48, s48, s53
  s_add_u32 s49, s49, 245760
  s_add_u32 s50, s50, 36864
  s_cmp_lt_u32 s50, 147456
  s_cselect_b32 s50, s50, 0
  s_mov_b32 s52, 0
op_321:
  s_waitcnt vmcnt(18)
  s_barrier
  v_add_u32 v8, s51, v5
  v_add_u32 v9, s51, v6
  s_add_u32 s51, s51, 36864
  s_cmp_lt_u32 s51, 147456
  s_cselect_b32 s51, s51, 0
  ds_read_b128 v[160:163], v8 offset:0
  ds_read_b128 v[164:167], v8 offset:2048
  ds_read_b128 v[168:171], v8 offset:4096
  ds_read_b128 v[172:175], v8 offset:6144
  ds_read_b64_tr_b16 v[176:177], v9 offset:0
  ds_read_b64_tr_b16 v[178:179], v9 offset:1280
  ds_read_b64_tr_b16 v[180:181], v9 offset:32
  ds_read_b64_tr_b16 v[182:183], v9 offset:1312
  ds_read_b64_tr_b16 v[184:185], v9 offset:64
  ds_read_b64_tr_b16 v[186:187], v9 offset:1344
  ds_read_b64_tr_b16 v[188:189], v9 offset:96
  ds_read_b64_tr_b16 v[190:191], v9 offset:1376
  ds_read_b64_tr_b16 v[192:193], v9 offset:128
  ds_read_b64_tr_b16 v[194:195], v9 offset:1408
  s_lshl_b32 s22, s20, 12
  s_add_u32 s22, s22, s50
  s_add_u32 s23, s48, s45
  s_add_u32 m0, s22, 0
  s_nop 0
  buffer_load_dwordx4 v4, s[12:15], s48 offen offset:0 sc1 lds
  s_add_u32 m0, s22, 0
  s_nop 0
  buffer_load_dwordx4 v4, s[12:15], s48 offen offset:1024 sc1 lds
  s_add_u32 m0, s22, 2048
  s_nop 0
  buffer_load_dwordx4 v4, s[12:15], s23 offen offset:0 sc1 lds
  s_add_u32 m0, s22, 2048
  s_nop 0
  buffer_load_dwordx4 v4, s[12:15], s23 offen offset:1024 sc1 lds
  ds_read_b128 v[196:199], v8 offset:1024
  ds_read_b128 v[200:203], v8 offset:3072
  ds_read_b128 v[204:207], v8 offset:5120
  ds_read_b128 v[208:211], v8 offset:7168
  ds_read_b64_tr_b16 v[212:213], v9 offset:10240
  ds_read_b64_tr_b16 v[214:215], v9 offset:11520
  ds_read_b64_tr_b16 v[216:217], v9 offset:10272
  ds_read_b64_tr_b16 v[218:219], v9 offset:11552
  ds_read_b64_tr_b16 v[220:221], v9 offset:10304
  ds_read_b64_tr_b16 v[222:223], v9 offset:11584
  ds_read_b64_tr_b16 v[224:225], v9 offset:10336
  ds_read_b64_tr_b16 v[226:227], v9 offset:11616
  ds_read_b64_tr_b16 v[228:229], v9 offset:10368
  ds_read_b64_tr_b16 v[230:231], v9 offset:11648
  s_waitcnt lgkmcnt(14)
  v_mfma_f32_16x16x32_bf16 v[80:83], v[176:179], v[160:163], v[80:83]
  v_mfma_f32_16x16x32_bf16 v[84:87], v[180:183], v[160:163], v[84:87]
  v_mfma_f32_16x16x32_bf16 v[88:91], v[184:187], v[160:163], v[88:91]
  v_mfma_f32_16x16x32_bf16 v[92:95], v[188:191], v[160:163], v[92:95]
  v_mfma_f32_16x16x32_bf16 v[96:99], v[192:195], v[160:163], v[96:99]
  v_mfma_f32_16x16x32_bf16 v[100:103], v[176:179], v[164:167], v[100:103]
  v_mfma_f32_16x16x32_bf16 v[104:107], v[180:183], v[164:167], v[104:107]
  v_mfma_f32_16x16x32_bf16 v[108:111], v[184:187], v[164:167], v[108:111]
  v_mfma_f32_16x16x32_bf16 v[112:115], v[188:191], v[164:167], v[112:115]
  v_mfma_f32_16x16x32_bf16 v[116:119], v[192:195], v[164:167], v[116:119]
  v_mfma_f32_16x16x32_bf16 v[120:123], v[176:179], v[168:171], v[120:123]
  v_mfma_f32_16x16x32_bf16 v[124:127], v[180:183], v[168:171], v[124:127]
  v_mfma_f32_16x16x32_bf16 v[128:131], v[184:187], v[168:171], v[128:131]
  v_mfma_f32_16x16x32_bf16 v[132:135], v[188:191], v[168:171], v[132:135]
  v_mfma_f32_16x16x32_bf16 v[136:139], v[192:195], v[168:171], v[136:139]
  v_mfma_f32_16x16x32_bf16 v[140:143], v[176:179], v[172:175], v[140:143]
  v_mfma_f32_16x16x32_bf16 v[144:147], v[180:183], v[172:175], v[144:147]
  v_mfma_f32_16x16x32_bf16 v[148:151], v[184:187], v[172:175], v[148:151]
  v_mfma_f32_16x16x32_bf16 v[152:155], v[188:191], v[172:175], v[152:155]
  v_mfma_f32_16x16x32_bf16 v[156:159], v[192:195], v[172:175], v[156:159]
  s_mul_i32 s22, s20, 5120
  s_add_u32 s22, s22, s50
  s_add_u32 s22, s22, 16384
  s_add_u32 m0, s22, 0
  s_nop 0
  buffer_load_dwordx4 v64, s[8:11], s49 offen lds
  s_add_u32 m0, s22, 1024
  s_nop 0
  buffer_load_dwordx4 v65, s[8:11], s49 offen lds
  s_add_u32 m0, s22, 2048
  s_nop 0
  buffer_load_dwordx4 v66, s[8:11], s49 offen lds
  s_add_u32 m0, s22, 3072
  s_nop 0
  buffer_load_dwordx4 v67, s[8:11], s49 offen lds
  s_add_u32 m0, s22, 4096
  s_nop 0
  buffer_load_dwordx4 v68, s[8:11], s49 offen lds
  s_add_u32 s48, s48, 2048
  s_min_u32 s48, s48, s53
  s_add_u32 s50, s50, 36864
  s_cmp_lt_u32 s50, 147456
  s_cselect_b32 s50, s50, 0
  s_waitcnt lgkmcnt(0)
  v_mfma_f32_16x16x32_bf16 v[80:83], v[212:215], v[196:199], v[80:83]
  v_mfma_f32_16x16x32_bf16 v[84:87], v[216:219], v[196:199], v[84:87]
  v_mfma_f32_16x16x32_bf16 v[88:91], v[220:223], v[196:199], v[88:91]
  v_mfma_f32_16x16x32_bf16 v[92:95], v[224:227], v[196:199], v[92:95]
  v_mfma_f32_16x16x32_bf16 v[96:99], v[228:231], v[196:199], v[96:99]
  v_mfma_f32_16x16x32_bf16 v[100:103], v[212:215], v[200:203], v[100:103]
  v_mfma_f32_16x16x32_bf16 v[104:107], v[216:219], v[200:203], v[104:107]
  v_mfma_f32_16x16x32_bf16 v[108:111], v[220:223], v[200:203], v[108:111]
  v_mfma_f32_16x16x32_bf16 v[112:115], v[224:227], v[200:203], v[112:115]
  v_mfma_f32_16x16x32_bf16 v[116:119], v[228:231], v[200:203], v[116:119]
  v_mfma_f32_16x16x32_bf16 v[120:123], v[212:215], v[204:207], v[120:123]
  v_mfma_f32_16x16x32_bf16 v[124:127], v[216:219], v[204:207], v[124:127]
  v_mfma_f32_16x16x32_bf16 v[128:131], v[220:223], v[204:207], v[128:131]
  v_mfma_f32_16x16x32_bf16 v[132:135], v[224:227], v[204:207], v[132:135]
  v_mfma_f32_16x16x32_bf16 v[136:139], v[228:231], v[204:207], v[136:139]
  v_mfma_f32_16x16x32_bf16 v[140:143], v[212:215], v[208:211], v[140:143]
  v_mfma_f32_16x16x32_bf16 v[144:147], v[216:219], v[208:211], v[144:147]
  v_mfma_f32_16x16x32_bf16 v[148:151], v[220:223], v[208:211], v[148:151]
  v_mfma_f32_16x16x32_bf16 v[152:155], v[224:227], v[208:211], v[152:155]
  v_mfma_f32_16x16x32_bf16 v[156:159], v[228:231], v[208:211], v[156:159]
  s_add_u32 s52, s52, 1
  s_cmp_ge_u32 s52, s44
  s_cbranch_scc1 opd_322
  s_waitcnt vmcnt(18)
  s_barrier
  v_add_u32 v8, s51, v5
  v_add_u32 v9, s51, v6
  s_add_u32 s51, s51, 36864
  s_cmp_lt_u32 s51, 147456
  s_cselect_b32 s51, s51, 0
  ds_read_b128 v[160:163], v8 offset:0
  ds_read_b128 v[164:167], v8 offset:2048
  ds_read_b128 v[168:171], v8 offset:4096
  ds_read_b128 v[172:175], v8 offset:6144
  ds_read_b64_tr_b16 v[176:177], v9 offset:0
  ds_read_b64_tr_b16 v[178:179], v9 offset:1280
  ds_read_b64_tr_b16 v[180:181], v9 offset:32
  ds_read_b64_tr_b16 v[182:183], v9 offset:1312
  ds_read_b64_tr_b16 v[184:185], v9 offset:64
  ds_read_b64_tr_b16 v[186:187], v9 offset:1344
  ds_read_b64_tr_b16 v[188:189], v9 offset:96
  ds_read_b64_tr_b16 v[190:191], v9 offset:1376
  ds_read_b64_tr_b16 v[192:193], v9 offset:128
  ds_read_b64_tr_b16 v[194:195], v9 offset:1408
  s_lshl_b32 s22, s20, 12
  s_add_u32 s22, s22, s50
  s_add_u32 s23, s48, s45
  s_add_u32 m0, s22, 0
  s_nop 0
  buffer_load_dwordx4 v4, s[12:15], s48 offen offset:0 sc1 lds
  s_add_u32 m0, s22, 0
  s_nop 0
  buffer_load_dwordx4 v4, s[12:15], s48 offen offset:1024 sc1 lds
  s_add_u32 m0, s22, 2048
  s_nop 0
  buffer_load_dwordx4 v4, s[12:15], s23 offen offset:0 sc1 lds
  s_add_u32 m0, s22, 2048
  s_nop 0
  buffer_load_dwordx4 v4, s[12:15], s23 offen offset:1024 sc1 lds
  ds_read_b128 v[196:199], v8 offset:1024
  ds_read_b128 v[200:203], v8 offset:3072
  ds_read_b128 v[204:207], v8 offset:5120
  ds_read_b128 v[208:211], v8 offset:7168
  ds_read_b64_tr_b16 v[212:213], v9 offset:10240
  ds_read_b64_tr_b16 v[214:215], v9 offset:11520
  ds_read_b64_tr_b16 v[216:217], v9 offset:10272
  ds_read_b64_tr_b16 v[218:219], v9 offset:11552
  ds_read_b64_tr_b16 v[220:221], v9 offset:10304
  ds_read_b64_tr_b16 v[222:223], v9 offset:11584
  ds_read_b64_tr_b16 v[224:225], v9 offset:10336
  ds_read_b64_tr_b16 v[226:227], v9 offset:11616
  ds_read_b64_tr_b16 v[228:229], v9 offset:10368
  ds_read_b64_tr_b16 v[230:231], v9 offset:11648
  s_waitcnt lgkmcnt(14)
  v_mfma_f32_16x16x32_bf16 v[80:83], v[176:179], v[160:163], v[80:83]
  v_mfma_f32_16x16x32_bf16 v[84:87], v[180:183], v[160:163], v[84:87]
  v_mfma_f32_16x16x32_bf16 v[88:91], v[184:187], v[160:163], v[88:91]
  v_mfma_f32_16x16x32_bf16 v[92:95], v[188:191], v[160:163], v[92:95]
  v_mfma_f32_16x16x32_bf16 v[96:99], v[192:195], v[160:163], v[96:99]
  v_mfma_f32_16x16x32_bf16 v[100:103], v[176:179], v[164:167], v[100:103]
  v_mfma_f32_16x16x32_bf16 v[104:107], v[180:183], v[164:167], v[104:107]
  v_mfma_f32_16x16x32_bf16 v[108:111], v[184:187], v[164:167], v[108:111]
  v_mfma_f32_16x16x32_bf16 v[112:115], v[188:191], v[164:167], v[112:115]
  v_mfma_f32_16x16x32_bf16 v[116:119], v[192:195], v[164:167], v[116:119]
  v_mfma_f32_16x16x32_bf16 v[120:123], v[176:179], v[168:171], v[120:123]
  v_mfma_f32_16x16x32_bf16 v[124:127], v[180:183], v[168:171], v[124:127]
  v_mfma_f32_16x16x32_bf16 v[128:131], v[184:187], v[168:171], v[128:131]
  v_mfma_f32_16x16x32_bf16 v[132:135], v[188:191], v[168:171], v[132:135]
  v_mfma_f32_16x16x32_bf16 v[136:139], v[192:195], v[168:171], v[136:139]
  v_mfma_f32_16x16x32_bf16 v[140:143], v[176:179], v[172:175], v[140:143]
  v_mfma_f32_16x16x32_bf16 v[144:147], v[180:183], v[172:175], v[144:147]
  v_mfma_f32_16x16x32_bf16 v[148:151], v[184:187], v[172:175], v[148:151]
  v_mfma_f32_16x16x32_bf16 v[152:155], v[188:191], v[172:175], v[152:155]
  v_mfma_f32_16x16x32_bf16 v[156:159], v[192:195], v[172:175], v[156:159]
  s_mul_i32 s22, s20, 5120
  s_add_u32 s22, s22, s50
  s_add_u32 s22, s22, 16384
  s_add_u32 m0, s22, 0
  s_nop 0
  buffer_load_dwordx4 v69, s[8:11], s49 offen lds
  s_add_u32 m0, s22, 1024
  s_nop 0
  buffer_load_dwordx4 v70, s[8:11], s49 offen lds
  s_add_u32 m0, s22, 2048
  s_nop 0
  buffer_load_dwordx4 v71, s[8:11], s49 offen lds
  s_add_u32 m0, s22, 3072
  s_nop 0
  buffer_load_dwordx4 v72, s[8:11], s49 offen lds
  s_add_u32 m0, s22, 4096
  s_nop 0
  buffer_load_dwordx4 v73, s[8:11], s49 offen lds
  s_add_u32 s48, s48, 2048
  s_min_u32 s48, s48, s53
  s_add_u32 s50, s50, 36864
  s_cmp_lt_u32 s50, 147456
  s_cselect_b32 s50, s50, 0
  s_waitcnt lgkmcnt(0)
  v_mfma_f32_16x16x32_bf16 v[80:83], v[212:215], v[196:199], v[80:83]
  v_mfma_f32_16x16x32_bf16 v[84:87], v[216:219], v[196:199], v[84:87]
  v_mfma_f32_16x16x32_bf16 v[88:91], v[220:223], v[196:199], v[88:91]
  v_mfma_f32_16x16x32_bf16 v[92:95], v[224:227], v[196:199], v[92:95]
  v_mfma_f32_16x16x32_bf16 v[96:99], v[228:231], v[196:199], v[96:99]
  v_mfma_f32_16x16x32_bf16 v[100:103], v[212:215], v[200:203], v[100:103]
  v_mfma_f32_16x16x32_bf16 v[104:107], v[216:219], v[200:203], v[104:107]
  v_mfma_f32_16x16x32_bf16 v[108:111], v[220:223], v[200:203], v[108:111]
  v_mfma_f32_16x16x32_bf16 v[112:115], v[224:227], v[200:203], v[112:115]
  v_mfma_f32_16x16x32_bf16 v[116:119], v[228:231], v[200:203], v[116:119]
  v_mfma_f32_16x16x32_bf16 v[120:123], v[212:215], v[204:207], v[120:123]
  v_mfma_f32_16x16x32_bf16 v[124:127], v[216:219], v[204:207], v[124:127]
  v_mfma_f32_16x16x32_bf16 v[128:131], v[220:223], v[204:207], v[128:131]
  v_mfma_f32_16x16x32_bf16 v[132:135], v[224:227], v[204:207], v[132:135]
  v_mfma_f32_16x16x32_bf16 v[136:139], v[228:231], v[204:207], v[136:139]
  v_mfma_f32_16x16x32_bf16 v[140:143], v[212:215], v[208:211], v[140:143]
  v_mfma_f32_16x16x32_bf16 v[144:147], v[216:219], v[208:211], v[144:147]
  v_mfma_f32_16x16x32_bf16 v[148:151], v[220:223], v[208:211], v[148:151]
  v_mfma_f32_16x16x32_bf16 v[152:155], v[224:227], v[208:211], v[152:155]
  v_mfma_f32_16x16x32_bf16 v[156:159], v[228:231], v[208:211], v[156:159]
  s_add_u32 s52, s52, 1
  s_cmp_ge_u32 s52, s44
  s_cbranch_scc1 opd_322
  s_waitcnt vmcnt(18)
  s_barrier
  v_add_u32 v8, s51, v5
  v_add_u32 v9, s51, v6
  s_add_u32 s51, s51, 36864
  s_cmp_lt_u32 s51, 147456
  s_cselect_b32 s51, s51, 0
  ds_read_b128 v[160:163], v8 offset:0
  ds_read_b128 v[164:167], v8 offset:2048
  ds_read_b128 v[168:171], v8 offset:4096
  ds_read_b128 v[172:175], v8 offset:6144
  ds_read_b64_tr_b16 v[176:177], v9 offset:0
  ds_read_b64_tr_b16 v[178:179], v9 offset:1280
  ds_read_b64_tr_b16 v[180:181], v9 offset:32
  ds_read_b64_tr_b16 v[182:183], v9 offset:1312
  ds_read_b64_tr_b16 v[184:185], v9 offset:64
  ds_read_b64_tr_b16 v[186:187], v9 offset:1344
  ds_read_b64_tr_b16 v[188:189], v9 offset:96
  ds_read_b64_tr_b16 v[190:191], v9 offset:1376
  ds_read_b64_tr_b16 v[192:193], v9 offset:128
  ds_read_b64_tr_b16 v[194:195], v9 offset:1408
  s_lshl_b32 s22, s20, 12
  s_add_u32 s22, s22, s50
  s_add_u32 s23, s48, s45
  s_add_u32 m0, s22, 0
  s_nop 0
  buffer_load_dwordx4 v4, s[12:15], s48 offen offset:0 sc1 lds
  s_add_u32 m0, s22, 0
  s_nop 0
  buffer_load_dwordx4 v4, s[12:15], s48 offen offset:1024 sc1 lds
  s_add_u32 m0, s22, 2048
  s_nop 0
  buffer_load_dwordx4 v4, s[12:15], s23 offen offset:0 sc1 lds
  s_add_u32 m0, s22, 2048
  s_nop 0
  buffer_load_dwordx4 v4, s[12:15], s23 offen offset:1024 sc1 lds
  ds_read_b128 v[196:199], v8 offset:1024
  ds_read_b128 v[200:203], v8 offset:3072
  ds_read_b128 v[204:207], v8 offset:5120
  ds_read_b128 v[208:211], v8 offset:7168
  ds_read_b64_tr_b16 v[212:213], v9 offset:10240
  ds_read_b64_tr_b16 v[214:215], v9 offset:11520
  ds_read_b64_tr_b16 v[216:217], v9 offset:10272
  ds_read_b64_tr_b16 v[218:219], v9 offset:11552
  ds_read_b64_tr_b16 v[220:221], v9 offset:10304
  ds_read_b64_tr_b16 v[222:223], v9 offset:11584
  ds_read_b64_tr_b16 v[224:225], v9 offset:10336
  ds_read_b64_tr_b16 v[226:227], v9 offset:11616
  ds_read_b64_tr_b16 v[228:229], v9 offset:10368
  ds_read_b64_tr_b16 v[230:231], v9 offset:11648
  s_waitcnt lgkmcnt(14)
  v_mfma_f32_16x16x32_bf16 v[80:83], v[176:179], v[160:163], v[80:83]
  v_mfma_f32_16x16x32_bf16 v[84:87], v[180:183], v[160:163], v[84:87]
  v_mfma_f32_16x16x32_bf16 v[88:91], v[184:187], v[160:163], v[88:91]
  v_mfma_f32_16x16x32_bf16 v[92:95], v[188:191], v[160:163], v[92:95]
  v_mfma_f32_16x16x32_bf16 v[96:99], v[192:195], v[160:163], v[96:99]
  v_mfma_f32_16x16x32_bf16 v[100:103], v[176:179], v[164:167], v[100:103]
  v_mfma_f32_16x16x32_bf16 v[104:107], v[180:183], v[164:167], v[104:107]
  v_mfma_f32_16x16x32_bf16 v[108:111], v[184:187], v[164:167], v[108:111]
  v_mfma_f32_16x16x32_bf16 v[112:115], v[188:191], v[164:167], v[112:115]
  v_mfma_f32_16x16x32_bf16 v[116:119], v[192:195], v[164:167], v[116:119]
  v_mfma_f32_16x16x32_bf16 v[120:123], v[176:179], v[168:171], v[120:123]
  v_mfma_f32_16x16x32_bf16 v[124:127], v[180:183], v[168:171], v[124:127]
  v_mfma_f32_16x16x32_bf16 v[128:131], v[184:187], v[168:171], v[128:131]
  v_mfma_f32_16x16x32_bf16 v[132:135], v[188:191], v[168:171], v[132:135]
  v_mfma_f32_16x16x32_bf16 v[136:139], v[192:195], v[168:171], v[136:139]
  v_mfma_f32_16x16x32_bf16 v[140:143], v[176:179], v[172:175], v[140:143]
  v_mfma_f32_16x16x32_bf16 v[144:147], v[180:183], v[172:175], v[144:147]
  v_mfma_f32_16x16x32_bf16 v[148:151], v[184:187], v[172:175], v[148:151]
  v_mfma_f32_16x16x32_bf16 v[152:155], v[188:191], v[172:175], v[152:155]
  v_mfma_f32_16x16x32_bf16 v[156:159], v[192:195], v[172:175], v[156:159]
  s_mul_i32 s22, s20, 5120
  s_add_u32 s22, s22, s50
  s_add_u32 s22, s22, 16384
  s_add_u32 m0, s22, 0
  s_nop 0
  buffer_load_dwordx4 v74, s[8:11], s49 offen lds
  s_add_u32 m0, s22, 1024
  s_nop 0
  buffer_load_dwordx4 v75, s[8:11], s49 offen lds
  s_add_u32 m0, s22, 2048
  s_nop 0
  buffer_load_dwordx4 v76, s[8:11], s49 offen lds
  s_add_u32 m0, s22, 3072
  s_nop 0
  buffer_load_dwordx4 v77, s[8:11], s49 offen lds
  s_add_u32 m0, s22, 4096
  s_nop 0
  buffer_load_dwordx4 v78, s[8:11], s49 offen lds
  s_add_u32 s48, s48, 2048
  s_min_u32 s48, s48, s53
  s_add_u32 s49, s49, 245760
  s_add_u32 s50, s50, 36864
  s_cmp_lt_u32 s50, 147456
  s_cselect_b32 s50, s50, 0
  s_waitcnt lgkmcnt(0)
  v_mfma_f32_16x16x32_bf16 v[80:83], v[212:215], v[196:199], v[80:83]
  v_mfma_f32_16x16x32_bf16 v[84:87], v[216:219], v[196:199], v[84:87]
  v_mfma_f32_16x16x32_bf16 v[88:91], v[220:223], v[196:199], v[88:91]
  v_mfma_f32_16x16x32_bf16 v[92:95], v[224:227], v[196:199], v[92:95]
  v_mfma_f32_16x16x32_bf16 v[96:99], v[228:231], v[196:199], v[96:99]
  v_mfma_f32_16x16x32_bf16 v[100:103], v[212:215], v[200:203], v[100:103]
  v_mfma_f32_16x16x32_bf16 v[104:107], v[216:219], v[200:203], v[104:107]
  v_mfma_f32_16x16x32_bf16 v[108:111], v[220:223], v[200:203], v[108:111]
  v_mfma_f32_16x16x32_bf16 v[112:115], v[224:227], v[200:203], v[112:115]
  v_mfma_f32_16x16x32_bf16 v[116:119], v[228:231], v[200:203], v[116:119]
  v_mfma_f32_16x16x32_bf16 v[120:123], v[212:215], v[204:207], v[120:123]
  v_mfma_f32_16x16x32_bf16 v[124:127], v[216:219], v[204:207], v[124:127]
  v_mfma_f32_16x16x32_bf16 v[128:131], v[220:223], v[204:207], v[128:131]
  v_mfma_f32_16x16x32_bf16 v[132:135], v[224:227], v[204:207], v[132:135]
  v_mfma_f32_16x16x32_bf16 v[136:139], v[228:231], v[204:207], v[136:139]
  v_mfma_f32_16x16x32_bf16 v[140:143], v[212:215], v[208:211], v[140:143]
  v_mfma_f32_16x16x32_bf16 v[144:147], v[216:219], v[208:211], v[144:147]
  v_mfma_f32_16x16x32_bf16 v[148:151], v[220:223], v[208:211], v[148:151]
  v_mfma_f32_16x16x32_bf16 v[152:155], v[224:227], v[208:211], v[152:155]
  v_mfma_f32_16x16x32_bf16 v[156:159], v[228:231], v[208:211], v[156:159]
  s_add_u32 s52, s52, 1
  s_cmp_ge_u32 s52, s44
  s_cbranch_scc1 opd_322
  s_branch op_321
opd_322:
  s_nop 7
  s_lshl_b32 s21, s40, 3
  s_lshr_b32 s22, s20, 1
  s_lshl_b32 s22, s22, 2
  s_add_u32 s21, s21, s22
  s_mul_i32 s21, s21, 40960
  s_mul_i32 s22, s42, 10
  s_and_b32 s23, s20, 1
  s_mul_i32 s23, s23, 5
  s_add_u32 s22, s22, s23
  s_lshl_b32 s22, s22, 10
  s_add_u32 s21, s21, s22
  buffer_store_dwordx4 v[80:83], v4, s[16:19], s21 offen offset:0 sc1
  buffer_store_dwordx4 v[84:87], v4, s[16:19], s21 offen offset:1024 sc1
  buffer_store_dwordx4 v[88:91], v4, s[16:19], s21 offen offset:2048 sc1
  buffer_store_dwordx4 v[92:95], v4, s[16:19], s21 offen offset:3072 sc1
  s_add_u32 s22, s21, 4096
  buffer_store_dwordx4 v[96:99], v4, s[16:19], s22 offen offset:0 sc1
  s_add_u32 s21, s21, 40960
  buffer_store_dwordx4 v[100:103], v4, s[16:19], s21 offen offset:0 sc1
  buffer_store_dwordx4 v[104:107], v4, s[16:19], s21 offen offset:1024 sc1
  buffer_store_dwordx4 v[108:111], v4, s[16:19], s21 offen offset:2048 sc1
  buffer_store_dwordx4 v[112:115], v4, s[16:19], s21 offen offset:3072 sc1
  s_add_u32 s22, s21, 4096
  buffer_store_dwordx4 v[116:119], v4, s[16:19], s22 offen offset:0 sc1
  s_add_u32 s21, s21, 40960
  buffer_store_dwordx4 v[120:123], v4, s[16:19], s21 offen offset:0 sc1
  buffer_store_dwordx4 v[124:127], v4, s[16:19], s21 offen offset:1024 sc1
  buffer_store_dwordx4 v[128:131], v4, s[16:19], s21 offen offset:2048 sc1
  buffer_store_dwordx4 v[132:135], v4, s[16:19], s21 offen offset:3072 sc1
  s_add_u32 s22, s21, 4096
  buffer_store_dwordx4 v[136:139], v4, s[16:19], s22 offen offset:0 sc1
  s_add_u32 s21, s21, 40960
  buffer_store_dwordx4 v[140:143], v4, s[16:19], s21 offen offset:0 sc1
  buffer_store_dwordx4 v[144:147], v4, s[16:19], s21 offen offset:1024 sc1
  buffer_store_dwordx4 v[148:151], v4, s[16:19], s21 offen offset:2048 sc1
  buffer_store_dwordx4 v[152:155], v4, s[16:19], s21 offen offset:3072 sc1
  s_add_u32 s22, s21, 4096
  buffer_store_dwordx4 v[156:159], v4, s[16:19], s22 offen offset:0 sc1
  s_add_u32 s21, s21, 40960
  s_waitcnt vmcnt(0)
  s_barrier
  s_lshl_b32 s21, s40, 7
  s_add_u32 s21, s21, 92160
  s_cmp_lg_u32 s20, 0
  s_cbranch_scc1 af_323
  v_mov_b32 v10, 0
  v_mov_b32 v11, 1
  s_mov_b64 exec, 1
  buffer_atomic_add v11, v10, s[72:75], s21 offen sc1
  s_mov_b64 exec, -1
  s_nop 1
af_323:
  s_branch queue
do_pv:
  s_mov_b32 s2, s21
  s_load_dwordx2 s[4:5], s[0:1], 88
  s_load_dwordx2 s[38:39], s[0:1], 104
  s_waitcnt lgkmcnt(0)
  s_mov_b32 s8, s4
  s_mov_b32 s9, s5
  s_mov_b32 s10, 2621440
  s_mov_b32 s11, 0x00020000
  s_add_u32 s12, s38, 114294784
  s_addc_u32 s13, s39, 0
  s_mov_b32 s14, 83886080
  s_mov_b32 s15, 0x00020000
  s_add_u32 s16, s38, 85983232
  s_addc_u32 s17, s39, 0
  s_mov_b32 s18, 28311552
  s_mov_b32 s19, 0x00020000
  s_add_u32 s24, s38, 73400320
  s_addc_u32 s25, s39, 0
  s_mov_b32 s26, 5242880
  s_mov_b32 s27, 0x00020000
  s_add_u32 s28, s38, 81002496
  s_addc_u32 s29, s39, 0
  s_mov_b32 s30, 8192
  s_mov_b32 s31, 0x00020000
  s_add_u32 s72, s38, 81068032
  s_addc_u32 s73, s39, 0
  s_mov_b32 s74, 115712
  s_mov_b32 s75, 0x00020000
  v_lshlrev_b32 v4, 4, v1
  v_lshlrev_b32 v5, 3, v1
  v_lshlrev_b32 v6, 2, v2
  v_and_b32 v7, 7, v1
  v_lshlrev_b32 v7, 7, v7
  v_bfe_u32 v31, v1, 3, 2
  v_lshl_add_u32 v31, v31, 2, v7
  s_lshl_b32 s21, s20, 10
  s_add_u32 s21, s21, 94208
  buffer_load_dword v8, v31, s[72:75], s21 offen sc1
  v_lshlrev_b32 v25, 7, v2
  s_mov_b32 s21, 92160
  buffer_load_dword v26, v25, s[72:75], s21 offen sc1
  s_mov_b32 s63, 1
  v_mul_u32_u24 v9, 1280, v2
  v_lshl_add_u32 v13, v3, 3, v9
  v_lshl_add_u32 v9, v3, 4, v9
  s_mul_i32 s21, s20, 10240
  v_add_u32 v10, s21, v4
  s_and_b32 s43, s20, 1
  s_lshr_b32 s44, s20, 1
  s_mul_i32 s21, s44, 6
  s_add_u32 s21, s21, s43
  s_lshl_b32 s21, s21, 10
  v_add_u32 v11, s21, v4
  s_add_u32 s21, s43, 4
  s_lshl_b32 s21, s21, 10
  v_add_u32 v12, s21, v4
  v_lshrrev_b32 v20, 5, v1
  v_mul_u32_u24 v21, 2560, v20
  v_add_u32 v21, v21, v4
  v_and_b32 v22, 31, v1
  v_lshlrev_b32 v22, 4, v22
  v_mul_u32_u24 v14, 10240, v20
  v_add_u32 v22, v22, v14
  v_and_b32 v15, 1, v3
  v_lshl_add_u32 v14, v15, 6, v14
  v_lshrrev_b32 v16, 3, v2
  v_mul_u32_u24 v16, 576, v16
  v_lshl_add_u32 v16, v2, 3, v16
  v_add_u32 v14, v14, v16
  v_lshlrev_b32 v16, 10, v20
  v_lshl_add_u32 v16, v15, 9, v16
  v_lshl_add_u32 v15, v2, 4, v16
  v_lshlrev_b32 v17, 2, v7
  v_bfe_u32 v16, v1, 3, 1
  v_lshl_add_u32 v17, v16, 3, v17
  v_cmp_gt_u32 s[66:67], 16, v1
  v_mov_b32 v28, 80
  v_mov_b32 v30, 40960
  s_mov_b32 s50, 0
  s_mov_b32 s51, 0
  v_mov_b32 v70, 0
  v_mov_b32 v71, 0
  v_mov_b32 v78, 0
  v_mov_b32 v79, 0
  v_mov_b32 v86, 0
  v_mov_b32 v87, 0
  v_mov_b32 v94, 0
  v_mov_b32 v95, 0
  v_mov_b32 v102, 0
  v_mov_b32 v103, 0
  v_mov_b32 v110, 0
  v_mov_b32 v111, 0
  v_mov_b32 v118, 0
  v_mov_b32 v119, 0
  v_mov_b32 v126, 0
  v_mov_b32 v127, 0
  s_mov_b32 s21, s2
pv_loop:
  s_mov_b32 s2, s21
  s_lshr_b32 s40, s2, 3
  s_and_b32 s41, s2, 7
  s_lshr_b32 s52, s41, 1
  s_lshl_b32 s52, s52, 7
  s_and_b32 s21, s41, 1
  s_lshl_b32 s21, s21, 4
  s_add_u32 s52, s52, s21
  s_add_u32 s52, s52, 18432
  s_lshl_b32 s21, s40, 10
  s_add_u32 s21, s21, 22528
  v_add_u32 v18, s21, v7
  v_add_u32 v19, s52, v17
  v_cndmask_b32 v18, v19, v18, s[66:67]
  s_add_u32 s21, s40, 1
  v_mov_b32 v19, s21
  v_cndmask_b32 v19, v19, 4, s[66:67]
  buffer_load_dword v27, v18, s[72:75], 0 offen sc1
  s_cmp_lg_u32 s20, 0
  s_cbranch_scc1 pv_324
  v_mov_b32 v29, 1
  s_mov_b64 exec, 1
  buffer_atomic_add v29, v28, s[32:35], 0 offen sc0 sc1
  s_mov_b64 exec, -1
pv_324:
  s_lshl_b32 s42, s40, 5
  s_lshl_b32 s21, s20, 3
  s_add_u32 s42, s42, s21
  s_mul_i32 s53, s42, 40960
  s_mul_i32 s22, s41, 5120
  s_add_u32 s53, s53, s22
  s_lshl_b32 s21, s40, 1
  s_add_u32 s21, s21, s43
  s_lshl_b32 s45, s21, 6
  s_mul_i32 s46, s21, 20480
  s_mul_i32 s21, s21, 40960
  s_add_u32 s55, s21, s22
  s_mul_i32 s21, s44, 3072
  s_add_u32 s54, s55, s21
  s_mul_i32 s22, s41, 160
  s_add_u32 s49, s46, s22
  s_mul_i32 s21, s44, 96
  s_add_u32 s46, s49, s21
  s_mul_i32 s47, s42, 2560
  s_mul_i32 s48, s42, 10240
  s_mul_i32 s22, s41, 1280
  s_add_u32 s48, s48, s22
  s_add_u32 s48, s48, 7340032
  s_add_u32 s23, s40, 1
  s_cmp_ge_u32 s50, s23
  s_cbranch_scc1 pv_325
  s_cmp_eq_u32 s63, 0
  s_cbranch_scc1 pv_328
  s_mov_b32 s63, 0
  s_waitcnt vmcnt(1)
  v_cmp_le_u32 vcc, 4, v26
  s_mov_b32 s51, vcc_lo
  v_cmp_gt_u32 vcc, s23, v8
  s_nop 1
  s_cbranch_vccz pv_329
pv_328:
  s_lshl_b32 s21, s20, 10
  s_add_u32 s21, s21, 94208
  s_mov_b32 s101, 0
wm_332:
  buffer_load_dword v8, v31, s[72:75], s21 offen sc1
  s_add_u32 s101, s101, 1
  s_cmp_gt_u32 s101, 131072
  s_cbranch_scc1 main_end
  s_waitcnt vmcnt(0)
  v_cmp_gt_u32 vcc, s23, v8
  v_readfirstlane_b32 s100, v8
  s_nop 0
  s_cbranch_vccz wm_333
  s_sleep 8
  s_add_u32 s100, s100, 2
  s_cmp_ge_u32 s100, s23
  s_cbranch_scc1 wm_332
  s_sleep 60
  s_branch wm_332
wm_333:
pv_329:
  v_readlane_b32 s50, v8, 0
  v_readlane_b32 s21, v8, 1
  s_min_u32 s50, s50, s21
  v_readlane_b32 s21, v8, 2
  s_min_u32 s50, s50, s21
  v_readlane_b32 s21, v8, 3
  s_min_u32 s50, s50, s21
  v_readlane_b32 s21, v8, 4
  s_min_u32 s50, s50, s21
  v_readlane_b32 s21, v8, 5
  s_min_u32 s50, s50, s21
  v_readlane_b32 s21, v8, 6
  s_min_u32 s50, s50, s21
  v_readlane_b32 s21, v8, 7
  s_min_u32 s50, s50, s21
  v_readlane_b32 s21, v8, 8
  s_min_u32 s50, s50, s21
  v_readlane_b32 s21, v8, 9
  s_min_u32 s50, s50, s21
  v_readlane_b32 s21, v8, 10
  s_min_u32 s50, s50, s21
  v_readlane_b32 s21, v8, 11
  s_min_u32 s50, s50, s21
  v_readlane_b32 s21, v8, 12
  s_min_u32 s50, s50, s21
  v_readlane_b32 s21, v8, 13
  s_min_u32 s50, s50, s21
  v_readlane_b32 s21, v8, 14
  s_min_u32 s50, s50, s21
  v_readlane_b32 s21, v8, 15
  s_min_u32 s50, s50, s21
  v_readlane_b32 s21, v8, 16
  s_min_u32 s50, s50, s21
  v_readlane_b32 s21, v8, 17
  s_min_u32 s50, s50, s21
  v_readlane_b32 s21, v8, 18
  s_min_u32 s50, s50, s21
  v_readlane_b32 s21, v8, 19
  s_min_u32 s50, s50, s21
  v_readlane_b32 s21, v8, 20
  s_min_u32 s50, s50, s21
  v_readlane_b32 s21, v8, 21
  s_min_u32 s50, s50, s21
  v_readlane_b32 s21, v8, 22
  s_min_u32 s50, s50, s21
  v_readlane_b32 s21, v8, 23
  s_min_u32 s50, s50, s21
  v_readlane_b32 s21, v8, 24
  s_min_u32 s50, s50, s21
  v_readlane_b32 s21, v8, 25
  s_min_u32 s50, s50, s21
  v_readlane_b32 s21, v8, 26
  s_min_u32 s50, s50, s21
  v_readlane_b32 s21, v8, 27
  s_min_u32 s50, s50, s21
  v_readlane_b32 s21, v8, 28
  s_min_u32 s50, s50, s21
  v_readlane_b32 s21, v8, 29
  s_min_u32 s50, s50, s21
  v_readlane_b32 s21, v8, 30
  s_min_u32 s50, s50, s21
  v_readlane_b32 s21, v8, 31
  s_min_u32 s50, s50, s21
pv_325:
  s_lshr_b32 s22, s40, 2
  s_bitcmp1_b32 s51, s22
  s_cbranch_scc1 pv_326
  s_mov_b32 s21, 92160
  v_lshlrev_b32 v25, 7, v2
  s_mov_b32 s101, 0
pv_327:
  buffer_load_dword v26, v25, s[72:75], s21 offen sc1
  s_add_u32 s101, s101, 1
  s_cmp_gt_u32 s101, 131072
  s_cbranch_scc1 main_end
  s_waitcnt vmcnt(0)
  v_cmp_le_u32 vcc, 4, v26
  s_mov_b32 s51, vcc_lo
  s_bitcmp1_b32 s51, s22
  s_cbranch_scc1 pv_326
  s_sleep 8
  s_branch pv_327
pv_326:
  buffer_load_dwordx4 a[0:3], v4, s[12:15], s53 offen offset:0 sc1
  buffer_load_dwordx4 a[4:7], v4, s[12:15], s53 offen offset:1024 sc1
  buffer_load_dwordx4 a[8:11], v4, s[12:15], s53 offen offset:2048 sc1
  buffer_load_dwordx4 a[12:15], v4, s[12:15], s53 offen offset:3072 sc1
  s_add_u32 s21, s53, 4096
  buffer_load_dwordx4 a[16:19], v4, s[12:15], s21 offen offset:0 sc1
  s_add_u32 s53, s53, 40960
  buffer_load_dwordx4 a[20:23], v4, s[12:15], s53 offen offset:0 sc1
  buffer_load_dwordx4 a[24:27], v4, s[12:15], s53 offen offset:1024 sc1
  buffer_load_dwordx4 a[28:31], v4, s[12:15], s53 offen offset:2048 sc1
  buffer_load_dwordx4 a[32:35], v4, s[12:15], s53 offen offset:3072 sc1
  s_add_u32 s21, s53, 4096
  buffer_load_dwordx4 a[36:39], v4, s[12:15], s21 offen offset:0 sc1
  s_add_u32 s53, s53, 40960
  buffer_load_dwordx4 a[40:43], v4, s[12:15], s53 offen offset:0 sc1
  buffer_load_dwordx4 a[44:47], v4, s[12:15], s53 offen offset:1024 sc1
  buffer_load_dwordx4 a[48:51], v4, s[12:15], s53 offen offset:2048 sc1
  buffer_load_dwordx4 a[52:55], v4, s[12:15], s53 offen offset:3072 sc1
  s_add_u32 s21, s53, 4096
  buffer_load_dwordx4 a[56:59], v4, s[12:15], s21 offen offset:0 sc1
  s_add_u32 s53, s53, 40960
  buffer_load_dwordx4 a[60:63], v4, s[12:15], s53 offen offset:0 sc1
  buffer_load_dwordx4 a[64:67], v4, s[12:15], s53 offen offset:1024 sc1
  buffer_load_dwordx4 a[68:71], v4, s[12:15], s53 offen offset:2048 sc1
  buffer_load_dwordx4 a[72:75], v4, s[12:15], s53 offen offset:3072 sc1
  s_add_u32 s21, s53, 4096
  buffer_load_dwordx4 a[76:79], v4, s[12:15], s21 offen offset:0 sc1
  s_add_u32 s53, s53, 40960
  buffer_load_dwordx4 a[80:83], v4, s[12:15], s53 offen offset:0 sc1
  buffer_load_dwordx4 a[84:87], v4, s[12:15], s53 offen offset:1024 sc1
  buffer_load_dwordx4 a[88:91], v4, s[12:15], s53 offen offset:2048 sc1
  buffer_load_dwordx4 a[92:95], v4, s[12:15], s53 offen offset:3072 sc1
  s_add_u32 s21, s53, 4096
  buffer_load_dwordx4 a[96:99], v4, s[12:15], s21 offen offset:0 sc1
  s_add_u32 s53, s53, 40960
  buffer_load_dwordx4 a[100:103], v4, s[12:15], s53 offen offset:0 sc1
  buffer_load_dwordx4 a[104:107], v4, s[12:15], s53 offen offset:1024 sc1
  buffer_load_dwordx4 a[108:111], v4, s[12:15], s53 offen offset:2048 sc1
  buffer_load_dwordx4 a[112:115], v4, s[12:15], s53 offen offset:3072 sc1
  s_add_u32 s21, s53, 4096
  buffer_load_dwordx4 a[116:119], v4, s[12:15], s21 offen offset:0 sc1
  s_add_u32 s53, s53, 40960
  buffer_load_dwordx4 a[120:123], v4, s[12:15], s53 offen offset:0 sc1
  buffer_load_dwordx4 a[124:127], v4, s[12:15], s53 offen offset:1024 sc1
  buffer_load_dwordx4 a[128:131], v4, s[12:15], s53 offen offset:2048 sc1
  buffer_load_dwordx4 a[132:135], v4, s[12:15], s53 offen offset:3072 sc1
  s_add_u32 s21, s53, 4096
  buffer_load_dwordx4 a[136:139], v4, s[12:15], s21 offen offset:0 sc1
  s_add_u32 s53, s53, 40960
  buffer_load_dwordx4 a[140:143], v4, s[12:15], s53 offen offset:0 sc1
  buffer_load_dwordx4 a[144:147], v4, s[12:15], s53 offen offset:1024 sc1
  buffer_load_dwordx4 a[148:151], v4, s[12:15], s53 offen offset:2048 sc1
  buffer_load_dwordx4 a[152:155], v4, s[12:15], s53 offen offset:3072 sc1
  s_add_u32 s21, s53, 4096
  buffer_load_dwordx4 a[156:159], v4, s[12:15], s21 offen offset:0 sc1
  s_add_u32 s53, s53, 40960
  buffer_load_dwordx4 v[240:243], v15, s[24:27], s54 offen sc1
  buffer_load_dwordx4 v[244:247], v15, s[24:27], s54 offen offset:256 sc1
  buffer_load_dwordx4 v[248:251], v4, s[24:27], s55 offen offset:2048 sc1
  buffer_load_dword v24, v6, s[28:31], s45 offen sc1
  s_waitcnt vmcnt(44)
  v_cmp_gt_u32 vcc, v19, v27
  s_nop 1
  s_cbranch_vccnz pvw_330
  buffer_load_dwordx4 v[64:67], v4, s[16:19], s47 offen sc1
  buffer_load_dwordx2 v[68:69], v5, s[16:19], s47 offen offset:2048 sc1
  buffer_load_dwordx4 v[128:131], v21, s[16:19], s47 offen offset:1024 sc1
  s_add_u32 s47, s47, 2560
  buffer_load_dwordx4 v[72:75], v4, s[16:19], s47 offen sc1
  buffer_load_dwordx2 v[76:77], v5, s[16:19], s47 offen offset:2048 sc1
  s_add_u32 s47, s47, 2560
  buffer_load_dwordx4 v[80:83], v4, s[16:19], s47 offen sc1
  buffer_load_dwordx2 v[84:85], v5, s[16:19], s47 offen offset:2048 sc1
  buffer_load_dwordx4 v[132:135], v21, s[16:19], s47 offen offset:1024 sc1
  s_add_u32 s47, s47, 2560
  buffer_load_dwordx4 v[88:91], v4, s[16:19], s47 offen sc1
  buffer_load_dwordx2 v[92:93], v5, s[16:19], s47 offen offset:2048 sc1
  s_add_u32 s47, s47, 2560
  buffer_load_dwordx4 v[32:35], v22, s[16:19], s48 offen offset:0 sc1
  buffer_load_dwordx4 v[40:43], v22, s[16:19], s48 offen offset:640 sc1
  buffer_load_dwordx2 v[184:185], v14, s[16:19], s48 offen offset:512 sc1
  s_add_u32 s48, s48, 20480
  buffer_load_dwordx4 v[36:39], v22, s[16:19], s48 offen offset:0 sc1
  buffer_load_dwordx4 v[44:47], v22, s[16:19], s48 offen offset:640 sc1
  buffer_load_dwordx2 v[186:187], v14, s[16:19], s48 offen offset:512 sc1
  s_add_u32 s48, s48, 20480
  s_waitcnt vmcnt(40)
  buffer_load_dwordx4 v[96:99], v4, s[16:19], s47 offen sc1
  buffer_load_dwordx2 v[100:101], v5, s[16:19], s47 offen offset:2048 sc1
  buffer_load_dwordx4 v[136:139], v21, s[16:19], s47 offen offset:1024 sc1
  s_add_u32 s47, s47, 2560
  buffer_load_dwordx4 v[104:107], v4, s[16:19], s47 offen sc1
  buffer_load_dwordx2 v[108:109], v5, s[16:19], s47 offen offset:2048 sc1
  s_add_u32 s47, s47, 2560
  buffer_load_dwordx4 v[112:115], v4, s[16:19], s47 offen sc1
  buffer_load_dwordx2 v[116:117], v5, s[16:19], s47 offen offset:2048 sc1
  buffer_load_dwordx4 v[140:143], v21, s[16:19], s47 offen offset:1024 sc1
  s_add_u32 s47, s47, 2560
  buffer_load_dwordx4 v[120:123], v4, s[16:19], s47 offen sc1
  buffer_load_dwordx2 v[124:125], v5, s[16:19], s47 offen offset:2048 sc1
  s_add_u32 s47, s47, 2560
  buffer_load_dwordx4 v[48:51], v22, s[16:19], s48 offen offset:0 sc1
  buffer_load_dwordx4 v[56:59], v22, s[16:19], s48 offen offset:640 sc1
  buffer_load_dwordx2 v[188:189], v14, s[16:19], s48 offen offset:512 sc1
  s_add_u32 s48, s48, 20480
  buffer_load_dwordx4 v[52:55], v22, s[16:19], s48 offen offset:0 sc1
  buffer_load_dwordx4 v[60:63], v22, s[16:19], s48 offen offset:640 sc1
  buffer_load_dwordx2 v[190:191], v14, s[16:19], s48 offen offset:512 sc1
  s_add_u32 s48, s48, 20480
  s_barrier
  s_waitcnt vmcnt(32)
  v_sub_f32 v25, 1.0, v24
  v_cvt_pk_bf16_f32 v26, v25, v25
  v_lshlrev_b32 v25, 16, v26
  v_cvt_pk_bf16_f32 v26, v240, v240
  v_lshlrev_b32 v240, 16, v26
  v_cvt_pk_bf16_f32 v26, v241, v241
  v_lshlrev_b32 v241, 16, v26
  v_cvt_pk_bf16_f32 v26, v242, v242
  v_lshlrev_b32 v242, 16, v26
  v_cvt_pk_bf16_f32 v26, v243, v243
  v_lshlrev_b32 v243, 16, v26
  v_cvt_pk_bf16_f32 v26, v244, v244
  v_lshlrev_b32 v244, 16, v26
  v_cvt_pk_bf16_f32 v26, v245, v245
  v_lshlrev_b32 v245, 16, v26
  v_cvt_pk_bf16_f32 v26, v246, v246
  v_lshlrev_b32 v246, 16, v26
  v_cvt_pk_bf16_f32 v26, v247, v247
  v_lshlrev_b32 v247, 16, v26
  v_cvt_pk_bf16_f32 v26, v248, v248
  v_lshlrev_b32 v248, 16, v26
  v_cvt_pk_bf16_f32 v26, v249, v249
  v_lshlrev_b32 v249, 16, v26
  v_cvt_pk_bf16_f32 v26, v250, v250
  v_lshlrev_b32 v250, 16, v26
  v_cvt_pk_bf16_f32 v26, v251, v251
  v_lshlrev_b32 v251, 16, v26
  v_mul_f32 v240, v240, v25
  v_cvt_pk_bf16_f32 v26, v240, v240
  v_lshlrev_b32 v240, 16, v26
  v_mul_f32 v241, v241, v25
  v_cvt_pk_bf16_f32 v26, v241, v241
  v_lshlrev_b32 v241, 16, v26
  v_mul_f32 v242, v242, v25
  v_cvt_pk_bf16_f32 v26, v242, v242
  v_lshlrev_b32 v242, 16, v26
  v_mul_f32 v243, v243, v25
  v_cvt_pk_bf16_f32 v26, v243, v243
  v_lshlrev_b32 v243, 16, v26
  v_mul_f32 v244, v244, v25
  v_cvt_pk_bf16_f32 v26, v244, v244
  v_lshlrev_b32 v244, 16, v26
  v_mul_f32 v245, v245, v25
  v_cvt_pk_bf16_f32 v26, v245, v245
  v_lshlrev_b32 v245, 16, v26
  v_mul_f32 v246, v246, v25
  v_cvt_pk_bf16_f32 v26, v246, v246
  v_lshlrev_b32 v246, 16, v26
  v_mul_f32 v247, v247, v25
  v_cvt_pk_bf16_f32 v26, v247, v247
  v_lshlrev_b32 v247, 16, v26
  v_mul_f32 v248, v248, v25
  v_cvt_pk_bf16_f32 v26, v248, v248
  v_lshlrev_b32 v248, 16, v26
  v_mul_f32 v249, v249, v25
  v_cvt_pk_bf16_f32 v26, v249, v249
  v_lshlrev_b32 v249, 16, v26
  v_mul_f32 v250, v250, v25
  v_cvt_pk_bf16_f32 v26, v250, v250
  v_lshlrev_b32 v250, 16, v26
  v_mul_f32 v251, v251, v25
  v_cvt_pk_bf16_f32 v26, v251, v251
  v_lshlrev_b32 v251, 16, v26
  s_branch pvg_334
pvw_330:
  s_waitcnt vmcnt(0)
  v_sub_f32 v25, 1.0, v24
  v_cvt_pk_bf16_f32 v26, v25, v25
  v_lshlrev_b32 v25, 16, v26
  v_cvt_pk_bf16_f32 v26, v240, v240
  v_lshlrev_b32 v240, 16, v26
  v_cvt_pk_bf16_f32 v26, v241, v241
  v_lshlrev_b32 v241, 16, v26
  v_cvt_pk_bf16_f32 v26, v242, v242
  v_lshlrev_b32 v242, 16, v26
  v_cvt_pk_bf16_f32 v26, v243, v243
  v_lshlrev_b32 v243, 16, v26
  v_cvt_pk_bf16_f32 v26, v244, v244
  v_lshlrev_b32 v244, 16, v26
  v_cvt_pk_bf16_f32 v26, v245, v245
  v_lshlrev_b32 v245, 16, v26
  v_cvt_pk_bf16_f32 v26, v246, v246
  v_lshlrev_b32 v246, 16, v26
  v_cvt_pk_bf16_f32 v26, v247, v247
  v_lshlrev_b32 v247, 16, v26
  v_cvt_pk_bf16_f32 v26, v248, v248
  v_lshlrev_b32 v248, 16, v26
  v_cvt_pk_bf16_f32 v26, v249, v249
  v_lshlrev_b32 v249, 16, v26
  v_cvt_pk_bf16_f32 v26, v250, v250
  v_lshlrev_b32 v250, 16, v26
  v_cvt_pk_bf16_f32 v26, v251, v251
  v_lshlrev_b32 v251, 16, v26
  v_mul_f32 v240, v240, v25
  v_cvt_pk_bf16_f32 v26, v240, v240
  v_lshlrev_b32 v240, 16, v26
  v_mul_f32 v241, v241, v25
  v_cvt_pk_bf16_f32 v26, v241, v241
  v_lshlrev_b32 v241, 16, v26
  v_mul_f32 v242, v242, v25
  v_cvt_pk_bf16_f32 v26, v242, v242
  v_lshlrev_b32 v242, 16, v26
  v_mul_f32 v243, v243, v25
  v_cvt_pk_bf16_f32 v26, v243, v243
  v_lshlrev_b32 v243, 16, v26
  v_mul_f32 v244, v244, v25
  v_cvt_pk_bf16_f32 v26, v244, v244
  v_lshlrev_b32 v244, 16, v26
  v_mul_f32 v245, v245, v25
  v_cvt_pk_bf16_f32 v26, v245, v245
  v_lshlrev_b32 v245, 16, v26
  v_mul_f32 v246, v246, v25
  v_cvt_pk_bf16_f32 v26, v246, v246
  v_lshlrev_b32 v246, 16, v26
  v_mul_f32 v247, v247, v25
  v_cvt_pk_bf16_f32 v26, v247, v247
  v_lshlrev_b32 v247, 16, v26
  v_mul_f32 v248, v248, v25
  v_cvt_pk_bf16_f32 v26, v248, v248
  v_lshlrev_b32 v248, 16, v26
  v_mul_f32 v249, v249, v25
  v_cvt_pk_bf16_f32 v26, v249, v249
  v_lshlrev_b32 v249, 16, v26
  v_mul_f32 v250, v250, v25
  v_cvt_pk_bf16_f32 v26, v250, v250
  v_lshlrev_b32 v250, 16, v26
  v_mul_f32 v251, v251, v25
  v_cvt_pk_bf16_f32 v26, v251, v251
  v_lshlrev_b32 v251, 16, v26
  s_cmp_ge_u32 s40, 56
  s_cbranch_scc1 pvt_335
  s_cmp_lg_u32 s20, 0
  s_cbranch_scc1 wr_337
  s_mov_b32 s101, 0
wr_336:
  buffer_load_dword v26, v18, s[72:75], 0 offen sc1
  s_add_u32 s101, s101, 1
  s_cmp_gt_u32 s101, 131072
  s_cbranch_scc1 main_end
  s_waitcnt vmcnt(0)
  v_cmp_gt_u32 vcc, v19, v26
  v_readfirstlane_b32 s100, v26
  s_nop 0
  s_cbranch_vccz wr_337
  s_sleep 2
  s_cmp_lg_u32 s100, 0
  s_cbranch_scc1 wr_336
  s_sleep 24
  s_branch wr_336
wr_337:
  s_barrier
  buffer_load_dwordx4 v[64:67], v4, s[16:19], s47 offen sc1
  buffer_load_dwordx2 v[68:69], v5, s[16:19], s47 offen offset:2048 sc1
  buffer_load_dwordx4 v[128:131], v21, s[16:19], s47 offen offset:1024 sc1
  s_add_u32 s47, s47, 2560
  buffer_load_dwordx4 v[72:75], v4, s[16:19], s47 offen sc1
  buffer_load_dwordx2 v[76:77], v5, s[16:19], s47 offen offset:2048 sc1
  s_add_u32 s47, s47, 2560
  buffer_load_dwordx4 v[80:83], v4, s[16:19], s47 offen sc1
  buffer_load_dwordx2 v[84:85], v5, s[16:19], s47 offen offset:2048 sc1
  buffer_load_dwordx4 v[132:135], v21, s[16:19], s47 offen offset:1024 sc1
  s_add_u32 s47, s47, 2560
  buffer_load_dwordx4 v[88:91], v4, s[16:19], s47 offen sc1
  buffer_load_dwordx2 v[92:93], v5, s[16:19], s47 offen offset:2048 sc1
  s_add_u32 s47, s47, 2560
  buffer_load_dwordx4 v[32:35], v22, s[16:19], s48 offen offset:0 sc1
  buffer_load_dwordx4 v[40:43], v22, s[16:19], s48 offen offset:640 sc1
  buffer_load_dwordx2 v[184:185], v14, s[16:19], s48 offen offset:512 sc1
  s_add_u32 s48, s48, 20480
  buffer_load_dwordx4 v[36:39], v22, s[16:19], s48 offen offset:0 sc1
  buffer_load_dwordx4 v[44:47], v22, s[16:19], s48 offen offset:640 sc1
  buffer_load_dwordx2 v[186:187], v14, s[16:19], s48 offen offset:512 sc1
  s_add_u32 s48, s48, 20480
  s_waitcnt vmcnt(40)
  buffer_load_dwordx4 v[96:99], v4, s[16:19], s47 offen sc1
  buffer_load_dwordx2 v[100:101], v5, s[16:19], s47 offen offset:2048 sc1
  buffer_load_dwordx4 v[136:139], v21, s[16:19], s47 offen offset:1024 sc1
  s_add_u32 s47, s47, 2560
  buffer_load_dwordx4 v[104:107], v4, s[16:19], s47 offen sc1
  buffer_load_dwordx2 v[108:109], v5, s[16:19], s47 offen offset:2048 sc1
  s_add_u32 s47, s47, 2560
  buffer_load_dwordx4 v[112:115], v4, s[16:19], s47 offen sc1
  buffer_load_dwordx2 v[116:117], v5, s[16:19], s47 offen offset:2048 sc1
  buffer_load_dwordx4 v[140:143], v21, s[16:19], s47 offen offset:1024 sc1
  s_add_u32 s47, s47, 2560
  buffer_load_dwordx4 v[120:123], v4, s[16:19], s47 offen sc1
  buffer_load_dwordx2 v[124:125], v5, s[16:19], s47 offen offset:2048 sc1
  s_add_u32 s47, s47, 2560
  buffer_load_dwordx4 v[48:51], v22, s[16:19], s48 offen offset:0 sc1
  buffer_load_dwordx4 v[56:59], v22, s[16:19], s48 offen offset:640 sc1
  buffer_load_dwordx2 v[188:189], v14, s[16:19], s48 offen offset:512 sc1
  s_add_u32 s48, s48, 20480
  buffer_load_dwordx4 v[52:55], v22, s[16:19], s48 offen offset:0 sc1
  buffer_load_dwordx4 v[60:63], v22, s[16:19], s48 offen offset:640 sc1
  buffer_load_dwordx2 v[190:191], v14, s[16:19], s48 offen offset:512 sc1
  s_add_u32 s48, s48, 20480
pvg_334:
  s_waitcnt vmcnt(30)
  v_mfma_f32_16x16x32_bf16 v[148:151], a[0:3], v[64:67], 0
  v_mfma_f32_16x16x32_bf16 v[144:147], a[0:3], v[68:71], 0
  v_mfma_f32_16x16x32_bf16 v[156:159], a[4:7], v[64:67], 0
  v_mfma_f32_16x16x32_bf16 v[152:155], a[4:7], v[68:71], 0
  v_mfma_f32_16x16x32_bf16 v[164:167], a[8:11], v[64:67], 0
  v_mfma_f32_16x16x32_bf16 v[160:163], a[8:11], v[68:71], 0
  v_mfma_f32_16x16x32_bf16 v[172:175], a[12:15], v[64:67], 0
  v_mfma_f32_16x16x32_bf16 v[168:171], a[12:15], v[68:71], 0
  v_mfma_f32_16x16x32_bf16 v[180:183], a[16:19], v[64:67], 0
  v_mfma_f32_16x16x32_bf16 v[176:179], a[16:19], v[68:71], 0
  s_waitcnt vmcnt(27)
  v_mfma_f32_16x16x32_bf16 v[148:151], a[20:23], v[72:75], v[148:151]
  v_mfma_f32_16x16x32_bf16 v[144:147], a[20:23], v[76:79], v[144:147]
  v_mfma_f32_16x16x32_bf16 v[156:159], a[24:27], v[72:75], v[156:159]
  v_mfma_f32_16x16x32_bf16 v[152:155], a[24:27], v[76:79], v[152:155]
  v_mfma_f32_16x16x32_bf16 v[164:167], a[28:31], v[72:75], v[164:167]
  v_mfma_f32_16x16x32_bf16 v[160:163], a[28:31], v[76:79], v[160:163]
  v_mfma_f32_16x16x32_bf16 v[172:175], a[32:35], v[72:75], v[172:175]
  v_mfma_f32_16x16x32_bf16 v[168:171], a[32:35], v[76:79], v[168:171]
  v_mfma_f32_16x16x32_bf16 v[180:183], a[36:39], v[72:75], v[180:183]
  v_mfma_f32_16x16x32_bf16 v[176:179], a[36:39], v[76:79], v[176:179]
  s_waitcnt vmcnt(25)
  v_mfma_f32_16x16x32_bf16 v[148:151], a[40:43], v[80:83], v[148:151]
  v_mfma_f32_16x16x32_bf16 v[144:147], a[40:43], v[84:87], v[144:147]
  v_mfma_f32_16x16x32_bf16 v[156:159], a[44:47], v[80:83], v[156:159]
  v_mfma_f32_16x16x32_bf16 v[152:155], a[44:47], v[84:87], v[152:155]
  v_mfma_f32_16x16x32_bf16 v[164:167], a[48:51], v[80:83], v[164:167]
  v_mfma_f32_16x16x32_bf16 v[160:163], a[48:51], v[84:87], v[160:163]
  v_mfma_f32_16x16x32_bf16 v[172:175], a[52:55], v[80:83], v[172:175]
  v_mfma_f32_16x16x32_bf16 v[168:171], a[52:55], v[84:87], v[168:171]
  v_mfma_f32_16x16x32_bf16 v[180:183], a[56:59], v[80:83], v[180:183]
  v_mfma_f32_16x16x32_bf16 v[176:179], a[56:59], v[84:87], v[176:179]
  s_waitcnt vmcnt(22)
  v_mfma_f32_16x16x32_bf16 v[148:151], a[60:63], v[88:91], v[148:151]
  v_mfma_f32_16x16x32_bf16 v[144:147], a[60:63], v[92:95], v[144:147]
  v_mfma_f32_16x16x32_bf16 v[156:159], a[64:67], v[88:91], v[156:159]
  v_mfma_f32_16x16x32_bf16 v[152:155], a[64:67], v[92:95], v[152:155]
  v_mfma_f32_16x16x32_bf16 v[164:167], a[68:71], v[88:91], v[164:167]
  v_mfma_f32_16x16x32_bf16 v[160:163], a[68:71], v[92:95], v[160:163]
  v_mfma_f32_16x16x32_bf16 v[172:175], a[72:75], v[88:91], v[172:175]
  v_mfma_f32_16x16x32_bf16 v[168:171], a[72:75], v[92:95], v[168:171]
  v_mfma_f32_16x16x32_bf16 v[180:183], a[76:79], v[88:91], v[180:183]
  v_mfma_f32_16x16x32_bf16 v[176:179], a[76:79], v[92:95], v[176:179]
  s_waitcnt vmcnt(16)
  v_swap_b32 v130, v132
  v_swap_b32 v131, v133
  v_swap_b32 v34, v36
  v_swap_b32 v35, v37
  v_swap_b32 v42, v44
  v_swap_b32 v43, v45
  s_nop 1
  v_mfma_f32_16x16x32_bf16 v[144:147], v[32:35], v[128:131], v[144:147]
  v_mfma_f32_16x16x32_bf16 v[148:151], v[32:35], v[132:135], v[148:151]
  v_mfma_f32_16x16x32_bf16 v[152:155], v[36:39], v[128:131], v[152:155]
  v_mfma_f32_16x16x32_bf16 v[156:159], v[36:39], v[132:135], v[156:159]
  v_mfma_f32_16x16x32_bf16 v[160:163], v[184:187], v[128:131], v[160:163]
  v_mfma_f32_16x16x32_bf16 v[164:167], v[184:187], v[132:135], v[164:167]
  v_mfma_f32_16x16x32_bf16 v[168:171], v[40:43], v[128:131], v[168:171]
  v_mfma_f32_16x16x32_bf16 v[172:175], v[40:43], v[132:135], v[172:175]
  v_mfma_f32_16x16x32_bf16 v[176:179], v[44:47], v[128:131], v[176:179]
  v_mfma_f32_16x16x32_bf16 v[180:183], v[44:47], v[132:135], v[180:183]
  s_waitcnt vmcnt(14)
  v_mfma_f32_16x16x32_bf16 v[148:151], a[80:83], v[96:99], v[148:151]
  v_mfma_f32_16x16x32_bf16 v[144:147], a[80:83], v[100:103], v[144:147]
  v_mfma_f32_16x16x32_bf16 v[156:159], a[84:87], v[96:99], v[156:159]
  v_mfma_f32_16x16x32_bf16 v[152:155], a[84:87], v[100:103], v[152:155]
  v_mfma_f32_16x16x32_bf16 v[164:167], a[88:91], v[96:99], v[164:167]
  v_mfma_f32_16x16x32_bf16 v[160:163], a[88:91], v[100:103], v[160:163]
  v_mfma_f32_16x16x32_bf16 v[172:175], a[92:95], v[96:99], v[172:175]
  v_mfma_f32_16x16x32_bf16 v[168:171], a[92:95], v[100:103], v[168:171]
  v_mfma_f32_16x16x32_bf16 v[180:183], a[96:99], v[96:99], v[180:183]
  v_mfma_f32_16x16x32_bf16 v[176:179], a[96:99], v[100:103], v[176:179]
  s_waitcnt vmcnt(11)
  v_mfma_f32_16x16x32_bf16 v[148:151], a[100:103], v[104:107], v[148:151]
  v_mfma_f32_16x16x32_bf16 v[144:147], a[100:103], v[108:111], v[144:147]
  v_mfma_f32_16x16x32_bf16 v[156:159], a[104:107], v[104:107], v[156:159]
  v_mfma_f32_16x16x32_bf16 v[152:155], a[104:107], v[108:111], v[152:155]
  v_mfma_f32_16x16x32_bf16 v[164:167], a[108:111], v[104:107], v[164:167]
  v_mfma_f32_16x16x32_bf16 v[160:163], a[108:111], v[108:111], v[160:163]
  v_mfma_f32_16x16x32_bf16 v[172:175], a[112:115], v[104:107], v[172:175]
  v_mfma_f32_16x16x32_bf16 v[168:171], a[112:115], v[108:111], v[168:171]
  v_mfma_f32_16x16x32_bf16 v[180:183], a[116:119], v[104:107], v[180:183]
  v_mfma_f32_16x16x32_bf16 v[176:179], a[116:119], v[108:111], v[176:179]
  s_waitcnt vmcnt(9)
  v_mfma_f32_16x16x32_bf16 v[148:151], a[120:123], v[112:115], v[148:151]
  v_mfma_f32_16x16x32_bf16 v[144:147], a[120:123], v[116:119], v[144:147]
  v_mfma_f32_16x16x32_bf16 v[156:159], a[124:127], v[112:115], v[156:159]
  v_mfma_f32_16x16x32_bf16 v[152:155], a[124:127], v[116:119], v[152:155]
  v_mfma_f32_16x16x32_bf16 v[164:167], a[128:131], v[112:115], v[164:167]
  v_mfma_f32_16x16x32_bf16 v[160:163], a[128:131], v[116:119], v[160:163]
  v_mfma_f32_16x16x32_bf16 v[172:175], a[132:135], v[112:115], v[172:175]
  v_mfma_f32_16x16x32_bf16 v[168:171], a[132:135], v[116:119], v[168:171]
  v_mfma_f32_16x16x32_bf16 v[180:183], a[136:139], v[112:115], v[180:183]
  v_mfma_f32_16x16x32_bf16 v[176:179], a[136:139], v[116:119], v[176:179]
  s_waitcnt vmcnt(6)
  v_mfma_f32_16x16x32_bf16 v[148:151], a[140:143], v[120:123], v[148:151]
  v_mfma_f32_16x16x32_bf16 v[144:147], a[140:143], v[124:127], v[144:147]
  v_mfma_f32_16x16x32_bf16 v[156:159], a[144:147], v[120:123], v[156:159]
  v_mfma_f32_16x16x32_bf16 v[152:155], a[144:147], v[124:127], v[152:155]
  v_mfma_f32_16x16x32_bf16 v[164:167], a[148:151], v[120:123], v[164:167]
  v_mfma_f32_16x16x32_bf16 v[160:163], a[148:151], v[124:127], v[160:163]
  v_mfma_f32_16x16x32_bf16 v[172:175], a[152:155], v[120:123], v[172:175]
  v_mfma_f32_16x16x32_bf16 v[168:171], a[152:155], v[124:127], v[168:171]
  v_mfma_f32_16x16x32_bf16 v[180:183], a[156:159], v[120:123], v[180:183]
  v_mfma_f32_16x16x32_bf16 v[176:179], a[156:159], v[124:127], v[176:179]
  s_waitcnt vmcnt(0)
  v_swap_b32 v138, v140
  v_swap_b32 v139, v141
  v_swap_b32 v50, v52
  v_swap_b32 v51, v53
  v_swap_b32 v58, v60
  v_swap_b32 v59, v61
  s_nop 1
  v_mfma_f32_16x16x32_bf16 v[144:147], v[48:51], v[136:139], v[144:147]
  v_mfma_f32_16x16x32_bf16 v[148:151], v[48:51], v[140:143], v[148:151]
  v_mfma_f32_16x16x32_bf16 v[152:155], v[52:55], v[136:139], v[152:155]
  v_mfma_f32_16x16x32_bf16 v[156:159], v[52:55], v[140:143], v[156:159]
  v_mfma_f32_16x16x32_bf16 v[160:163], v[188:191], v[136:139], v[160:163]
  v_mfma_f32_16x16x32_bf16 v[164:167], v[188:191], v[140:143], v[164:167]
  v_mfma_f32_16x16x32_bf16 v[168:171], v[56:59], v[136:139], v[168:171]
  v_mfma_f32_16x16x32_bf16 v[172:175], v[56:59], v[140:143], v[172:175]
  v_mfma_f32_16x16x32_bf16 v[176:179], v[60:63], v[136:139], v[176:179]
  v_mfma_f32_16x16x32_bf16 v[180:183], v[60:63], v[140:143], v[180:183]
  s_branch pve_331
pvt_335:
  s_sub_u32 s56, s40, 1
  s_lshl_b32 s21, s56, 10
  s_add_u32 s21, s21, 22528
  v_add_u32 v18, s21, v7
  v_add_u32 v19, s52, v17
  v_cndmask_b32 v18, v19, v18, s[66:67]
  s_add_u32 s21, s56, 1
  v_mov_b32 v19, s21
  v_cndmask_b32 v19, v19, 4, s[66:67]
  v_add_u32 v26, -1, v19
  v_cndmask_b32 v19, v26, v19, s[66:67]
  s_cmp_lg_u32 s20, 0
  s_cbranch_scc1 wr_339
  s_mov_b32 s101, 0
wr_338:
  buffer_load_dword v26, v18, s[72:75], 0 offen sc1
  s_add_u32 s101, s101, 1
  s_cmp_gt_u32 s101, 131072
  s_cbranch_scc1 main_end
  s_waitcnt vmcnt(0)
  v_cmp_gt_u32 vcc, v19, v26
  v_readfirstlane_b32 s100, v26
  s_nop 0
  s_cbranch_vccz wr_339
  s_sleep 4
  s_cmp_lg_u32 s100, 0
  s_cbranch_scc1 wr_338
  s_sleep 24
  s_branch wr_338
wr_339:
  s_barrier
  s_mov_b32 s56, s47
  s_mov_b32 s57, s48
  buffer_load_dwordx4 v[64:67], v4, s[16:19], s56 offen sc1
  buffer_load_dwordx2 v[68:69], v5, s[16:19], s56 offen offset:2048 sc1
  buffer_load_dwordx4 v[128:131], v21, s[16:19], s56 offen offset:1024 sc1
  s_add_u32 s56, s56, 2560
  buffer_load_dwordx4 v[72:75], v4, s[16:19], s56 offen sc1
  buffer_load_dwordx2 v[76:77], v5, s[16:19], s56 offen offset:2048 sc1
  s_add_u32 s56, s56, 2560
  buffer_load_dwordx4 v[80:83], v4, s[16:19], s56 offen sc1
  buffer_load_dwordx2 v[84:85], v5, s[16:19], s56 offen offset:2048 sc1
  buffer_load_dwordx4 v[132:135], v21, s[16:19], s56 offen offset:1024 sc1
  s_add_u32 s56, s56, 2560
  buffer_load_dwordx4 v[88:91], v4, s[16:19], s56 offen sc1
  buffer_load_dwordx2 v[92:93], v5, s[16:19], s56 offen offset:2048 sc1
  s_add_u32 s56, s56, 2560
  buffer_load_dwordx4 v[32:35], v22, s[16:19], s57 offen offset:0 sc1
  buffer_load_dwordx4 v[40:43], v22, s[16:19], s57 offen offset:640 sc1
  buffer_load_dwordx2 v[184:185], v14, s[16:19], s57 offen offset:512 sc1
  s_add_u32 s57, s57, 20480
  buffer_load_dwordx4 v[36:39], v22, s[16:19], s57 offen offset:0 sc1
  buffer_load_dwordx4 v[44:47], v22, s[16:19], s57 offen offset:640 sc1
  buffer_load_dwordx2 v[186:187], v14, s[16:19], s57 offen offset:512 sc1
  s_add_u32 s57, s57, 20480
  buffer_load_dwordx4 v[96:99], v4, s[16:19], s56 offen sc1
  buffer_load_dwordx2 v[100:101], v5, s[16:19], s56 offen offset:2048 sc1
  buffer_load_dwordx4 v[136:139], v21, s[16:19], s56 offen offset:1024 sc1
  s_add_u32 s56, s56, 2560
  buffer_load_dwordx4 v[104:107], v4, s[16:19], s56 offen sc1
  buffer_load_dwordx2 v[108:109], v5, s[16:19], s56 offen offset:2048 sc1
  s_add_u32 s56, s56, 2560
  buffer_load_dwordx4 v[112:115], v4, s[16:19], s56 offen sc1
  buffer_load_dwordx2 v[116:117], v5, s[16:19], s56 offen offset:2048 sc1
  buffer_load_dwordx4 v[140:143], v21, s[16:19], s56 offen offset:1024 sc1
  s_add_u32 s56, s56, 2560
  buffer_load_dwordx4 v[120:123], v4, s[16:19], s56 offen sc1
  buffer_load_dwordx2 v[124:125], v5, s[16:19], s56 offen offset:2048 sc1
  s_add_u32 s56, s56, 2560
  buffer_load_dwordx4 v[48:51], v22, s[16:19], s57 offen offset:0 sc1
  buffer_load_dwordx4 v[56:59], v22, s[16:19], s57 offen offset:640 sc1
  buffer_load_dwordx2 v[188:189], v14, s[16:19], s57 offen offset:512 sc1
  s_add_u32 s57, s57, 20480
  buffer_load_dwordx4 v[52:55], v22, s[16:19], s57 offen offset:0 sc1
  buffer_load_dwordx4 v[60:63], v22, s[16:19], s57 offen offset:640 sc1
  buffer_load_dwordx2 v[190:191], v14, s[16:19], s57 offen offset:512 sc1
  s_add_u32 s57, s57, 20480
  s_mov_b32 s101, 0
  s_waitcnt vmcnt(16)
  s_branch pvr_341
pvr_340:
  s_sleep 2
  s_add_u32 s56, s47, 0
  s_add_u32 s57, s48, 0
  buffer_load_dwordx4 v[64:67], v4, s[16:19], s56 offen sc1
  buffer_load_dwordx2 v[68:69], v5, s[16:19], s56 offen offset:2048 sc1
  buffer_load_dwordx4 v[128:131], v21, s[16:19], s56 offen offset:1024 sc1
  s_add_u32 s56, s56, 2560
  buffer_load_dwordx4 v[72:75], v4, s[16:19], s56 offen sc1
  buffer_load_dwordx2 v[76:77], v5, s[16:19], s56 offen offset:2048 sc1
  s_add_u32 s56, s56, 2560
  buffer_load_dwordx4 v[80:83], v4, s[16:19], s56 offen sc1
  buffer_load_dwordx2 v[84:85], v5, s[16:19], s56 offen offset:2048 sc1
  buffer_load_dwordx4 v[132:135], v21, s[16:19], s56 offen offset:1024 sc1
  s_add_u32 s56, s56, 2560
  buffer_load_dwordx4 v[88:91], v4, s[16:19], s56 offen sc1
  buffer_load_dwordx2 v[92:93], v5, s[16:19], s56 offen offset:2048 sc1
  s_add_u32 s56, s56, 2560
  buffer_load_dwordx4 v[32:35], v22, s[16:19], s57 offen offset:0 sc1
  buffer_load_dwordx4 v[40:43], v22, s[16:19], s57 offen offset:640 sc1
  buffer_load_dwordx2 v[184:185], v14, s[16:19], s57 offen offset:512 sc1
  s_add_u32 s57, s57, 20480
  buffer_load_dwordx4 v[36:39], v22, s[16:19], s57 offen offset:0 sc1
  buffer_load_dwordx4 v[44:47], v22, s[16:19], s57 offen offset:640 sc1
  buffer_load_dwordx2 v[186:187], v14, s[16:19], s57 offen offset:512 sc1
  s_add_u32 s57, s57, 20480
  s_add_u32 s101, s101, 1
  s_cmp_gt_u32 s101, 131072
  s_cbranch_scc1 main_end
  s_waitcnt vmcnt(0)
pvr_341:
  v_max3_u32 v26, v64, v68, v72
  v_max3_u32 v26, v26, v76, v80
  v_max3_u32 v26, v26, v84, v88
  v_max3_u32 v26, v26, v92, v128
  v_max3_u32 v26, v26, v132, v32
  v_max3_u32 v26, v26, v36, v40
  v_max3_u32 v26, v26, v44, v184
  v_max3_u32 v26, v26, v186, v186
  v_cmp_eq_u32 vcc, -1, v26
  s_nop 1
  s_cbranch_vccnz pvr_340
  v_mfma_f32_16x16x32_bf16 v[148:151], a[0:3], v[64:67], 0
  v_mfma_f32_16x16x32_bf16 v[144:147], a[0:3], v[68:71], 0
  v_mfma_f32_16x16x32_bf16 v[156:159], a[4:7], v[64:67], 0
  v_mfma_f32_16x16x32_bf16 v[152:155], a[4:7], v[68:71], 0
  v_mfma_f32_16x16x32_bf16 v[164:167], a[8:11], v[64:67], 0
  v_mfma_f32_16x16x32_bf16 v[160:163], a[8:11], v[68:71], 0
  v_mfma_f32_16x16x32_bf16 v[172:175], a[12:15], v[64:67], 0
  v_mfma_f32_16x16x32_bf16 v[168:171], a[12:15], v[68:71], 0
  v_mfma_f32_16x16x32_bf16 v[180:183], a[16:19], v[64:67], 0
  v_mfma_f32_16x16x32_bf16 v[176:179], a[16:19], v[68:71], 0
  v_mfma_f32_16x16x32_bf16 v[148:151], a[20:23], v[72:75], v[148:151]
  v_mfma_f32_16x16x32_bf16 v[144:147], a[20:23], v[76:79], v[144:147]
  v_mfma_f32_16x16x32_bf16 v[156:159], a[24:27], v[72:75], v[156:159]
  v_mfma_f32_16x16x32_bf16 v[152:155], a[24:27], v[76:79], v[152:155]
  v_mfma_f32_16x16x32_bf16 v[164:167], a[28:31], v[72:75], v[164:167]
  v_mfma_f32_16x16x32_bf16 v[160:163], a[28:31], v[76:79], v[160:163]
  v_mfma_f32_16x16x32_bf16 v[172:175], a[32:35], v[72:75], v[172:175]
  v_mfma_f32_16x16x32_bf16 v[168:171], a[32:35], v[76:79], v[168:171]
  v_mfma_f32_16x16x32_bf16 v[180:183], a[36:39], v[72:75], v[180:183]
  v_mfma_f32_16x16x32_bf16 v[176:179], a[36:39], v[76:79], v[176:179]
  v_mfma_f32_16x16x32_bf16 v[148:151], a[40:43], v[80:83], v[148:151]
  v_mfma_f32_16x16x32_bf16 v[144:147], a[40:43], v[84:87], v[144:147]
  v_mfma_f32_16x16x32_bf16 v[156:159], a[44:47], v[80:83], v[156:159]
  v_mfma_f32_16x16x32_bf16 v[152:155], a[44:47], v[84:87], v[152:155]
  v_mfma_f32_16x16x32_bf16 v[164:167], a[48:51], v[80:83], v[164:167]
  v_mfma_f32_16x16x32_bf16 v[160:163], a[48:51], v[84:87], v[160:163]
  v_mfma_f32_16x16x32_bf16 v[172:175], a[52:55], v[80:83], v[172:175]
  v_mfma_f32_16x16x32_bf16 v[168:171], a[52:55], v[84:87], v[168:171]
  v_mfma_f32_16x16x32_bf16 v[180:183], a[56:59], v[80:83], v[180:183]
  v_mfma_f32_16x16x32_bf16 v[176:179], a[56:59], v[84:87], v[176:179]
  v_mfma_f32_16x16x32_bf16 v[148:151], a[60:63], v[88:91], v[148:151]
  v_mfma_f32_16x16x32_bf16 v[144:147], a[60:63], v[92:95], v[144:147]
  v_mfma_f32_16x16x32_bf16 v[156:159], a[64:67], v[88:91], v[156:159]
  v_mfma_f32_16x16x32_bf16 v[152:155], a[64:67], v[92:95], v[152:155]
  v_mfma_f32_16x16x32_bf16 v[164:167], a[68:71], v[88:91], v[164:167]
  v_mfma_f32_16x16x32_bf16 v[160:163], a[68:71], v[92:95], v[160:163]
  v_mfma_f32_16x16x32_bf16 v[172:175], a[72:75], v[88:91], v[172:175]
  v_mfma_f32_16x16x32_bf16 v[168:171], a[72:75], v[92:95], v[168:171]
  v_mfma_f32_16x16x32_bf16 v[180:183], a[76:79], v[88:91], v[180:183]
  v_mfma_f32_16x16x32_bf16 v[176:179], a[76:79], v[92:95], v[176:179]
  v_swap_b32 v130, v132
  v_swap_b32 v131, v133
  v_swap_b32 v34, v36
  v_swap_b32 v35, v37
  v_swap_b32 v42, v44
  v_swap_b32 v43, v45
  s_nop 1
  v_mfma_f32_16x16x32_bf16 v[144:147], v[32:35], v[128:131], v[144:147]
  v_mfma_f32_16x16x32_bf16 v[148:151], v[32:35], v[132:135], v[148:151]
  v_mfma_f32_16x16x32_bf16 v[152:155], v[36:39], v[128:131], v[152:155]
  v_mfma_f32_16x16x32_bf16 v[156:159], v[36:39], v[132:135], v[156:159]
  v_mfma_f32_16x16x32_bf16 v[160:163], v[184:187], v[128:131], v[160:163]
  v_mfma_f32_16x16x32_bf16 v[164:167], v[184:187], v[132:135], v[164:167]
  v_mfma_f32_16x16x32_bf16 v[168:171], v[40:43], v[128:131], v[168:171]
  v_mfma_f32_16x16x32_bf16 v[172:175], v[40:43], v[132:135], v[172:175]
  v_mfma_f32_16x16x32_bf16 v[176:179], v[44:47], v[128:131], v[176:179]
  v_mfma_f32_16x16x32_bf16 v[180:183], v[44:47], v[132:135], v[180:183]
  s_mov_b32 s101, 0
  s_waitcnt vmcnt(0)
  s_branch pvr_343
pvr_342:
  s_sleep 2
  s_add_u32 s56, s47, 10240
  s_add_u32 s57, s48, 40960
  buffer_load_dwordx4 v[96:99], v4, s[16:19], s56 offen sc1
  buffer_load_dwordx2 v[100:101], v5, s[16:19], s56 offen offset:2048 sc1
  buffer_load_dwordx4 v[136:139], v21, s[16:19], s56 offen offset:1024 sc1
  s_add_u32 s56, s56, 2560
  buffer_load_dwordx4 v[104:107], v4, s[16:19], s56 offen sc1
  buffer_load_dwordx2 v[108:109], v5, s[16:19], s56 offen offset:2048 sc1
  s_add_u32 s56, s56, 2560
  buffer_load_dwordx4 v[112:115], v4, s[16:19], s56 offen sc1
  buffer_load_dwordx2 v[116:117], v5, s[16:19], s56 offen offset:2048 sc1
  buffer_load_dwordx4 v[140:143], v21, s[16:19], s56 offen offset:1024 sc1
  s_add_u32 s56, s56, 2560
  buffer_load_dwordx4 v[120:123], v4, s[16:19], s56 offen sc1
  buffer_load_dwordx2 v[124:125], v5, s[16:19], s56 offen offset:2048 sc1
  s_add_u32 s56, s56, 2560
  buffer_load_dwordx4 v[48:51], v22, s[16:19], s57 offen offset:0 sc1
  buffer_load_dwordx4 v[56:59], v22, s[16:19], s57 offen offset:640 sc1
  buffer_load_dwordx2 v[188:189], v14, s[16:19], s57 offen offset:512 sc1
  s_add_u32 s57, s57, 20480
  buffer_load_dwordx4 v[52:55], v22, s[16:19], s57 offen offset:0 sc1
  buffer_load_dwordx4 v[60:63], v22, s[16:19], s57 offen offset:640 sc1
  buffer_load_dwordx2 v[190:191], v14, s[16:19], s57 offen offset:512 sc1
  s_add_u32 s57, s57, 20480
  s_add_u32 s101, s101, 1
  s_cmp_gt_u32 s101, 131072
  s_cbranch_scc1 main_end
  s_waitcnt vmcnt(0)
pvr_343:
  v_max3_u32 v26, v96, v100, v104
  v_max3_u32 v26, v26, v108, v112
  v_max3_u32 v26, v26, v116, v120
  v_max3_u32 v26, v26, v124, v136
  v_max3_u32 v26, v26, v140, v48
  v_max3_u32 v26, v26, v52, v56
  v_max3_u32 v26, v26, v60, v188
  v_max3_u32 v26, v26, v190, v190
  v_cmp_eq_u32 vcc, -1, v26
  s_nop 1
  s_cbranch_vccnz pvr_342
  v_mfma_f32_16x16x32_bf16 v[148:151], a[80:83], v[96:99], v[148:151]
  v_mfma_f32_16x16x32_bf16 v[144:147], a[80:83], v[100:103], v[144:147]
  v_mfma_f32_16x16x32_bf16 v[156:159], a[84:87], v[96:99], v[156:159]
  v_mfma_f32_16x16x32_bf16 v[152:155], a[84:87], v[100:103], v[152:155]
  v_mfma_f32_16x16x32_bf16 v[164:167], a[88:91], v[96:99], v[164:167]
  v_mfma_f32_16x16x32_bf16 v[160:163], a[88:91], v[100:103], v[160:163]
  v_mfma_f32_16x16x32_bf16 v[172:175], a[92:95], v[96:99], v[172:175]
  v_mfma_f32_16x16x32_bf16 v[168:171], a[92:95], v[100:103], v[168:171]
  v_mfma_f32_16x16x32_bf16 v[180:183], a[96:99], v[96:99], v[180:183]
  v_mfma_f32_16x16x32_bf16 v[176:179], a[96:99], v[100:103], v[176:179]
  v_mfma_f32_16x16x32_bf16 v[148:151], a[100:103], v[104:107], v[148:151]
  v_mfma_f32_16x16x32_bf16 v[144:147], a[100:103], v[108:111], v[144:147]
  v_mfma_f32_16x16x32_bf16 v[156:159], a[104:107], v[104:107], v[156:159]
  v_mfma_f32_16x16x32_bf16 v[152:155], a[104:107], v[108:111], v[152:155]
  v_mfma_f32_16x16x32_bf16 v[164:167], a[108:111], v[104:107], v[164:167]
  v_mfma_f32_16x16x32_bf16 v[160:163], a[108:111], v[108:111], v[160:163]
  v_mfma_f32_16x16x32_bf16 v[172:175], a[112:115], v[104:107], v[172:175]
  v_mfma_f32_16x16x32_bf16 v[168:171], a[112:115], v[108:111], v[168:171]
  v_mfma_f32_16x16x32_bf16 v[180:183], a[116:119], v[104:107], v[180:183]
  v_mfma_f32_16x16x32_bf16 v[176:179], a[116:119], v[108:111], v[176:179]
  v_mfma_f32_16x16x32_bf16 v[148:151], a[120:123], v[112:115], v[148:151]
  v_mfma_f32_16x16x32_bf16 v[144:147], a[120:123], v[116:119], v[144:147]
  v_mfma_f32_16x16x32_bf16 v[156:159], a[124:127], v[112:115], v[156:159]
  v_mfma_f32_16x16x32_bf16 v[152:155], a[124:127], v[116:119], v[152:155]
  v_mfma_f32_16x16x32_bf16 v[164:167], a[128:131], v[112:115], v[164:167]
  v_mfma_f32_16x16x32_bf16 v[160:163], a[128:131], v[116:119], v[160:163]
  v_mfma_f32_16x16x32_bf16 v[172:175], a[132:135], v[112:115], v[172:175]
  v_mfma_f32_16x16x32_bf16 v[168:171], a[132:135], v[116:119], v[168:171]
  v_mfma_f32_16x16x32_bf16 v[180:183], a[136:139], v[112:115], v[180:183]
  v_mfma_f32_16x16x32_bf16 v[176:179], a[136:139], v[116:119], v[176:179]
  v_mfma_f32_16x16x32_bf16 v[148:151], a[140:143], v[120:123], v[148:151]
  v_mfma_f32_16x16x32_bf16 v[144:147], a[140:143], v[124:127], v[144:147]
  v_mfma_f32_16x16x32_bf16 v[156:159], a[144:147], v[120:123], v[156:159]
  v_mfma_f32_16x16x32_bf16 v[152:155], a[144:147], v[124:127], v[152:155]
  v_mfma_f32_16x16x32_bf16 v[164:167], a[148:151], v[120:123], v[164:167]
  v_mfma_f32_16x16x32_bf16 v[160:163], a[148:151], v[124:127], v[160:163]
  v_mfma_f32_16x16x32_bf16 v[172:175], a[152:155], v[120:123], v[172:175]
  v_mfma_f32_16x16x32_bf16 v[168:171], a[152:155], v[124:127], v[168:171]
  v_mfma_f32_16x16x32_bf16 v[180:183], a[156:159], v[120:123], v[180:183]
  v_mfma_f32_16x16x32_bf16 v[176:179], a[156:159], v[124:127], v[176:179]
  v_swap_b32 v138, v140
  v_swap_b32 v139, v141
  v_swap_b32 v50, v52
  v_swap_b32 v51, v53
  v_swap_b32 v58, v60
  v_swap_b32 v59, v61
  s_nop 1
  v_mfma_f32_16x16x32_bf16 v[144:147], v[48:51], v[136:139], v[144:147]
  v_mfma_f32_16x16x32_bf16 v[148:151], v[48:51], v[140:143], v[148:151]
  v_mfma_f32_16x16x32_bf16 v[152:155], v[52:55], v[136:139], v[152:155]
  v_mfma_f32_16x16x32_bf16 v[156:159], v[52:55], v[140:143], v[156:159]
  v_mfma_f32_16x16x32_bf16 v[160:163], v[188:191], v[136:139], v[160:163]
  v_mfma_f32_16x16x32_bf16 v[164:167], v[188:191], v[140:143], v[164:167]
  v_mfma_f32_16x16x32_bf16 v[168:171], v[56:59], v[136:139], v[168:171]
  v_mfma_f32_16x16x32_bf16 v[172:175], v[56:59], v[140:143], v[172:175]
  v_mfma_f32_16x16x32_bf16 v[176:179], v[60:63], v[136:139], v[176:179]
  v_mfma_f32_16x16x32_bf16 v[180:183], v[60:63], v[140:143], v[180:183]
pve_331:
  s_nop 0
  s_cmp_eq_u32 s84, 0
  s_cbranch_scc1 ps_344
  s_lshl_b32 s21, s84, 7
  s_add_u32 s21, s21, 18304
  v_mov_b32 v25, 0
  buffer_load_dword v27, v25, s[72:75], s21 offen sc1
ps_344:
  ds_write_b128 v10, v[144:147] offset:0
  ds_write_b128 v10, v[148:151] offset:1024
  ds_write_b128 v10, v[152:155] offset:2048
  ds_write_b128 v10, v[156:159] offset:3072
  ds_write_b128 v10, v[160:163] offset:4096
  ds_write_b128 v10, v[164:167] offset:5120
  ds_write_b128 v10, v[168:171] offset:6144
  ds_write_b128 v10, v[172:175] offset:7168
  s_nop 1
  ds_write_b128 v10, v[176:179] offset:8192
  ds_write_b128 v10, v[180:183] offset:9216
  s_cmp_lg_u32 s20, 0
  s_cbranch_scc1 pvq_345
  s_mov_b64 exec, 1
  ds_write_b32 v30, v29
  s_mov_b64 exec, -1
pvq_345:
  s_waitcnt lgkmcnt(0)
  s_barrier
  ds_read_b32 v23, v30
  ds_read_b128 v[192:195], v11 offset:0
  ds_read_b128 v[196:199], v11 offset:10240
  ds_read_b128 v[200:203], v11 offset:20480
  ds_read_b128 v[204:207], v11 offset:30720
  ds_read_b128 v[208:211], v11 offset:2048
  ds_read_b128 v[212:215], v11 offset:12288
  ds_read_b128 v[216:219], v11 offset:22528
  ds_read_b128 v[220:223], v11 offset:32768
  ds_read_b128 v[224:227], v12 offset:0
  ds_read_b128 v[228:231], v12 offset:10240
  ds_read_b128 v[232:235], v12 offset:20480
  ds_read_b128 v[236:239], v12 offset:30720
  s_waitcnt lgkmcnt(8)
  v_pk_add_f32 v[192:193], v[192:193], v[196:197]
  v_pk_add_f32 v[200:201], v[200:201], v[204:205]
  v_pk_add_f32 v[194:195], v[194:195], v[198:199]
  v_pk_add_f32 v[202:203], v[202:203], v[206:207]
  v_pk_add_f32 v[192:193], v[192:193], v[200:201]
  v_pk_add_f32 v[194:195], v[194:195], v[202:203]
  v_cvt_pk_bf16_f32 v26, v192, v193
  v_lshlrev_b32 v192, 16, v26
  v_and_b32 v193, 0xffff0000, v26
  v_mul_f32 v192, v192, v24
  v_mul_f32 v193, v193, v24
  v_cvt_pk_bf16_f32 v26, v192, v193
  v_lshlrev_b32 v192, 16, v26
  v_and_b32 v193, 0xffff0000, v26
  v_add_f32 v192, v192, v240
  v_add_f32 v193, v193, v241
  v_cvt_pk_bf16_f32 v196, v192, v193
  v_cvt_pk_bf16_f32 v26, v194, v195
  v_lshlrev_b32 v194, 16, v26
  v_and_b32 v195, 0xffff0000, v26
  v_mul_f32 v194, v194, v24
  v_mul_f32 v195, v195, v24
  v_cvt_pk_bf16_f32 v26, v194, v195
  v_lshlrev_b32 v194, 16, v26
  v_and_b32 v195, 0xffff0000, v26
  v_add_f32 v194, v194, v242
  v_add_f32 v195, v195, v243
  v_cvt_pk_bf16_f32 v197, v194, v195
  s_waitcnt lgkmcnt(4)
  v_pk_add_f32 v[208:209], v[208:209], v[212:213]
  v_pk_add_f32 v[216:217], v[216:217], v[220:221]
  v_pk_add_f32 v[210:211], v[210:211], v[214:215]
  v_pk_add_f32 v[218:219], v[218:219], v[222:223]
  v_pk_add_f32 v[208:209], v[208:209], v[216:217]
  v_pk_add_f32 v[210:211], v[210:211], v[218:219]
  v_cvt_pk_bf16_f32 v26, v208, v209
  v_lshlrev_b32 v208, 16, v26
  v_and_b32 v209, 0xffff0000, v26
  v_mul_f32 v208, v208, v24
  v_mul_f32 v209, v209, v24
  v_cvt_pk_bf16_f32 v26, v208, v209
  v_lshlrev_b32 v208, 16, v26
  v_and_b32 v209, 0xffff0000, v26
  v_add_f32 v208, v208, v244
  v_add_f32 v209, v209, v245
  v_cvt_pk_bf16_f32 v198, v208, v209
  v_cvt_pk_bf16_f32 v26, v210, v211
  v_lshlrev_b32 v210, 16, v26
  v_and_b32 v211, 0xffff0000, v26
  v_mul_f32 v210, v210, v24
  v_mul_f32 v211, v211, v24
  v_cvt_pk_bf16_f32 v26, v210, v211
  v_lshlrev_b32 v210, 16, v26
  v_and_b32 v211, 0xffff0000, v26
  v_add_f32 v210, v210, v246
  v_add_f32 v211, v211, v247
  v_cvt_pk_bf16_f32 v199, v210, v211
  buffer_store_dwordx4 v[196:199], v9, s[8:11], s46 offen
  s_cmp_ge_u32 s20, 2
  s_cbranch_scc1 pvm_346
  s_waitcnt lgkmcnt(0)
  v_pk_add_f32 v[224:225], v[224:225], v[228:229]
  v_pk_add_f32 v[232:233], v[232:233], v[236:237]
  v_pk_add_f32 v[226:227], v[226:227], v[230:231]
  v_pk_add_f32 v[234:235], v[234:235], v[238:239]
  v_pk_add_f32 v[224:225], v[224:225], v[232:233]
  v_pk_add_f32 v[226:227], v[226:227], v[234:235]
  v_cvt_pk_bf16_f32 v26, v224, v225
  v_lshlrev_b32 v224, 16, v26
  v_and_b32 v225, 0xffff0000, v26
  v_mul_f32 v224, v224, v24
  v_mul_f32 v225, v225, v24
  v_cvt_pk_bf16_f32 v26, v224, v225
  v_lshlrev_b32 v224, 16, v26
  v_and_b32 v225, 0xffff0000, v26
  v_add_f32 v224, v224, v248
  v_add_f32 v225, v225, v249
  v_cvt_pk_bf16_f32 v228, v224, v225
  v_cvt_pk_bf16_f32 v26, v226, v227
  v_lshlrev_b32 v226, 16, v26
  v_and_b32 v227, 0xffff0000, v26
  v_mul_f32 v226, v226, v24
  v_mul_f32 v227, v227, v24
  v_cvt_pk_bf16_f32 v26, v226, v227
  v_lshlrev_b32 v226, 16, v26
  v_and_b32 v227, 0xffff0000, v26
  v_add_f32 v226, v226, v250
  v_add_f32 v227, v227, v251
  v_cvt_pk_bf16_f32 v229, v226, v227
  buffer_store_dwordx2 v[228:229], v13, s[8:11], s49 offen offset:64
pvm_346:
  s_cmp_eq_u32 s84, 0
  s_cbranch_scc1 pz_347
  s_waitcnt vmcnt(2)
  s_cmp_lg_u32 s20, 0
  s_cbranch_scc1 pz_347x
  ds_write_b32 v30, v27 offset:4
pz_347x:
  s_waitcnt lgkmcnt(0)
  s_barrier
  ds_read_b32 v27, v30 offset:4
  s_waitcnt lgkmcnt(0)
  v_readfirstlane_b32 s64, v27
pz_347:
  s_waitcnt lgkmcnt(0)
  v_readfirstlane_b32 s2, v23
  s_barrier
  s_cmp_eq_u32 s84, 0
  s_cbranch_scc1 oa_348
  s_cmp_lt_u32 s64, 61
  s_cbranch_scc1 oa_348
  s_mov_b32 s85, s2
  s_branch own_afin
oa_348:
  s_cmp_eq_u32 s84, 0
  s_cbranch_scc1 od_349
  s_cmp_lt_u32 s2, 618
  s_cbranch_scc1 od_349
  s_mov_b32 s85, s2
  s_branch own_afin
od_349:
  s_add_u32 s21, s2, 0
  s_cmp_lt_u32 s2, 10
  s_cbranch_scc1 do_qbl
  s_sub_u32 s2, s2, 10
  s_add_u32 s21, s2, 0
  s_cmp_lt_u32 s2, 54
  s_cbranch_scc1 do_bat
  s_sub_u32 s2, s2, 54
  s_add_u32 s21, s2, 0
  s_cmp_lt_u32 s2, 56
  s_cbranch_scc1 do_opb
  s_sub_u32 s2, s2, 56
  s_add_u32 s21, s2, 54
  s_cmp_lt_u32 s2, 10
  s_cbranch_scc1 do_bat
  s_sub_u32 s2, s2, 10
  s_add_u32 s21, s2, 0
  s_cmp_lt_u32 s2, 48
  s_cbranch_scc1 pv_loop
  s_sub_u32 s2, s2, 48
  s_add_u32 s21, s2, 56
  s_cmp_lt_u32 s2, 8
  s_cbranch_scc1 do_opb
  s_sub_u32 s2, s2, 8
  s_add_u32 s21, s2, 48
  s_cmp_lt_u32 s2, 384
  s_cbranch_scc1 pv_loop
  s_sub_u32 s2, s2, 384
  s_add_u32 s21, s2, 432
  s_cmp_lt_u32 s2, 80
  s_cbranch_scc1 pv_loop
  s_sub_u32 s2, s2, 80
  s_branch main_fin
own_afin:
  s_sub_u32 s21, s84, 1
  s_mov_b32 s84, 0
do_afin:
  s_mov_b32 s2, s21
  s_load_dwordx2 s[38:39], s[0:1], 104
  s_mov_b32 s42, s2
  s_waitcnt lgkmcnt(0)
  s_mov_b32 s16, s38
  s_mov_b32 s17, s39
  s_mov_b32 s18, 50331648
  s_mov_b32 s19, 0x00020000
  s_add_u32 s52, s38, 50331648
  s_addc_u32 s53, s39, 0
  s_mov_b32 s54, 6291456
  s_mov_b32 s55, 0x00020000
  s_add_u32 s56, s38, 85983232
  s_addc_u32 s57, s39, 0
  s_mov_b32 s58, 6815744
  s_mov_b32 s59, 0x00020000
  s_add_u32 s72, s38, 81068032
  s_addc_u32 s73, s39, 0
  s_mov_b32 s74, 115712
  s_mov_b32 s75, 0x00020000
  s_mul_i32 s21, s20, 12800
  s_add_u32 s21, s21, 98304
  v_mul_u32_u24 v4, 400, v2
  v_lshlrev_b32 v5, 4, v3
  v_add3_u32 v29, v4, v5, s21
  v_lshlrev_b32 v30, 4, v1
  v_and_b32 v4, 7, v2
  v_lshlrev_b32 v4, 4, v4
  v_lshl_add_u32 v31, v3, 7, v4
  v_lshlrev_b32 v32, 3, v1
  v_and_b32 v4, 3, v1
  v_lshlrev_b32 v33, 3, v4
  v_mov_b32 v34, 0xf149f2ca
  v_lshlrev_b32 v4, 2, v3
  v_sub_u32 v35, v2, v4
  v_cmp_gt_u32 s[60:61], 2, v3
  s_mov_b32 s62, 0x3d93cd3a
  s_mov_b32 s63, 0x3fb8aa3b
  s_mov_b32 s83, 0x3dd53b95
  v_cmp_le_i32 s[64:65], 0, v35
  v_cmp_le_i32 s[66:67], 1, v35
  v_cmp_le_i32 s[68:69], 2, v35
  v_cmp_le_i32 s[70:71], 3, v35
  s_add_u32 s49, s20, 60
  s_mov_b32 s29, 4
  s_mov_b32 s78, 0
  s_lshl_b32 s21, s42, 7
  s_add_u32 s21, s21, 111616
  s_lshl_b32 s43, s42, 2
  s_add_u32 s43, s43, s20
  s_mul_i32 s43, s43, 12288
  s_add_u32 s43, s43, 5242880
  s_waitcnt vmcnt(0)
  s_cmp_eq_u32 s78, 0
  s_cbranch_scc1 pf_351
  v_mov_b32 v4, 0
  v_mov_b32 v5, 1
  s_mov_b64 exec, 1
  buffer_atomic_add v5, v4, s[72:75], s78 offen sc1
  s_mov_b64 exec, -1
  s_mov_b32 s78, 0
pf_351:
  s_mul_i32 s21, s49, 393216
  s_mul_i32 s22, s42, 12288
  s_add_u32 s50, s21, s22
  s_mul_i32 s21, s49, 98304
  s_mul_i32 s22, s42, 3072
  s_add_u32 s51, s21, s22
  s_lshr_b32 s22, s49, 1
  s_lshr_b32 s21, s49, 2
  s_add_u32 s21, s21, 2
  s_cmp_lt_u32 s49, 8
  s_cselect_b32 s21, s22, s21
  s_lshl_b32 s21, s21, 3
  s_lshr_b32 s22, s42, 2
  s_add_u32 s21, s21, s22
  s_lshl_b32 s21, s21, 7
  s_add_u32 s76, s21, 0
  s_lshl_b32 s77, s42, 7
  s_add_u32 s77, s77, 18432
  v_mov_b32 v156, 0
  s_mov_b32 s101, 0
wf_352:
  buffer_load_dword v157, v156, s[72:75], s76 offen sc1
  s_add_u32 s101, s101, 1
  s_cmp_gt_u32 s101, 131072
  s_cbranch_scc1 main_end
  s_waitcnt vmcnt(0)
  v_readfirstlane_b32 s100, v157
  s_cmp_ge_u32 s100, 8
  s_cbranch_scc1 wf_353
  s_sleep 2
  s_branch wf_352
wf_353:
  s_add_u32 s21, s50, 0
  buffer_load_dwordx4 v[36:39], v30, s[16:19], s21 offen offset:0 sc1
  buffer_load_dwordx4 v[40:43], v30, s[16:19], s21 offen offset:1024 sc1
  buffer_load_dwordx4 v[44:47], v30, s[16:19], s21 offen offset:2048 sc1
  buffer_load_dwordx4 v[48:51], v30, s[16:19], s21 offen offset:3072 sc1
  s_add_u32 s21, s50, 4096
  buffer_load_dwordx4 v[52:55], v30, s[16:19], s21 offen offset:0 sc1
  buffer_load_dwordx4 v[56:59], v30, s[16:19], s21 offen offset:1024 sc1
  buffer_load_dwordx4 v[60:63], v30, s[16:19], s21 offen offset:2048 sc1
  buffer_load_dwordx4 v[236:239], v30, s[16:19], s21 offen offset:3072 sc1
  s_add_u32 s21, s50, 8192
  buffer_load_dwordx4 v[240:243], v30, s[16:19], s21 offen offset:0 sc1
  buffer_load_dwordx4 v[244:247], v30, s[16:19], s21 offen offset:1024 sc1
  buffer_load_dwordx4 v[248:251], v30, s[16:19], s21 offen offset:2048 sc1
  buffer_load_dwordx4 v[252:255], v30, s[16:19], s21 offen offset:3072 sc1
  s_add_u32 s21, s43, 0
  buffer_load_dwordx4 v[64:67], v30, s[56:59], s21 offen offset:0 sc1
  buffer_load_dwordx4 v[68:71], v30, s[56:59], s21 offen offset:1024 sc1
  buffer_load_dwordx4 v[72:75], v30, s[56:59], s21 offen offset:2048 sc1
  buffer_load_dwordx4 v[76:79], v30, s[56:59], s21 offen offset:3072 sc1
  s_add_u32 s21, s43, 4096
  buffer_load_dwordx4 v[80:83], v30, s[56:59], s21 offen offset:0 sc1
  buffer_load_dwordx4 v[84:87], v30, s[56:59], s21 offen offset:1024 sc1
  buffer_load_dwordx4 v[88:91], v30, s[56:59], s21 offen offset:2048 sc1
  buffer_load_dwordx4 v[92:95], v30, s[56:59], s21 offen offset:3072 sc1
  s_add_u32 s21, s43, 8192
  buffer_load_dwordx4 v[96:99], v30, s[56:59], s21 offen offset:0 sc1
  buffer_load_dwordx4 v[100:103], v30, s[56:59], s21 offen offset:1024 sc1
  buffer_load_dwordx4 v[104:107], v30, s[56:59], s21 offen offset:2048 sc1
  buffer_load_dwordx4 v[108:111], v30, s[56:59], s21 offen offset:3072 sc1
  s_mov_b32 s80, 0
  s_waitcnt vmcnt(0)
  v_mfma_f32_16x16x32_bf16 v[112:115], v[36:39], v[64:67], 0
  v_mfma_f32_16x16x32_bf16 v[120:123], v[36:39], v[88:91], 0
  v_mfma_f32_16x16x32_bf16 v[124:127], v[60:63], v[88:91], 0
  v_mfma_f32_16x16x32_bf16 v[112:115], v[40:43], v[68:71], v[112:115]
  v_mfma_f32_16x16x32_bf16 v[120:123], v[40:43], v[92:95], v[120:123]
  v_mfma_f32_16x16x32_bf16 v[124:127], v[236:239], v[92:95], v[124:127]
  v_mfma_f32_16x16x32_bf16 v[112:115], v[44:47], v[72:75], v[112:115]
  v_mfma_f32_16x16x32_bf16 v[120:123], v[44:47], v[96:99], v[120:123]
  v_mfma_f32_16x16x32_bf16 v[124:127], v[240:243], v[96:99], v[124:127]
  v_mfma_f32_16x16x32_bf16 v[112:115], v[48:51], v[76:79], v[112:115]
  v_mfma_f32_16x16x32_bf16 v[120:123], v[48:51], v[100:103], v[120:123]
  v_mfma_f32_16x16x32_bf16 v[124:127], v[244:247], v[100:103], v[124:127]
  v_mfma_f32_16x16x32_bf16 v[112:115], v[52:55], v[80:83], v[112:115]
  v_mfma_f32_16x16x32_bf16 v[120:123], v[52:55], v[104:107], v[120:123]
  v_mfma_f32_16x16x32_bf16 v[124:127], v[248:251], v[104:107], v[124:127]
  v_mfma_f32_16x16x32_bf16 v[112:115], v[56:59], v[84:87], v[112:115]
  v_mfma_f32_16x16x32_bf16 v[120:123], v[56:59], v[108:111], v[120:123]
  v_mfma_f32_16x16x32_bf16 v[124:127], v[252:255], v[108:111], v[124:127]
  s_cmp_eq_u32 s80, 1
  s_cbranch_scc1 qm_354
  s_add_u32 s23, s49, 1
  s_min_u32 s23, s49, 62
  s_mov_b32 s101, 0
wm_355:
  buffer_load_dword v156, v33, s[72:75], s77 offen sc1
  s_add_u32 s101, s101, 1
  s_cmp_gt_u32 s101, 131072
  s_cbranch_scc1 main_end
  s_waitcnt vmcnt(0)
  v_cmp_gt_u32 vcc, s23, v156
  v_readfirstlane_b32 s100, v156
  s_nop 0
  s_cbranch_vccz wm_356
  s_sleep 4
  s_add_u32 s100, s100, 2
  s_cmp_ge_u32 s100, s23
  s_cbranch_scc1 wm_355
  s_sleep 90
  s_branch wm_355
wm_356:
  s_mov_b32 s101, 0
  s_branch qtp_358
qtp_357:
  s_sleep 3
qtp_358:
  buffer_load_dwordx4 v[132:135], v31, s[52:55], s51 offen offset:0 sc1
  buffer_load_dwordx4 v[136:139], v31, s[52:55], s51 offen offset:512 sc1
  buffer_load_dwordx4 v[140:143], v31, s[52:55], s51 offen offset:1024 sc1
  buffer_load_dwordx4 v[144:147], v31, s[52:55], s51 offen offset:1536 sc1
  buffer_load_dwordx4 v[148:151], v31, s[52:55], s51 offen offset:2048 sc1
  buffer_load_dwordx4 v[152:155], v31, s[52:55], s51 offen offset:2560 sc1
  s_add_u32 s101, s101, 1
  s_cmp_gt_u32 s101, 131072
  s_cbranch_scc1 main_end
  s_waitcnt vmcnt(0)
  v_max3_u32 v156, v132, v134, v136
  v_max3_u32 v156, v156, v138, v140
  v_max3_u32 v156, v156, v142, v144
  v_max3_u32 v156, v156, v146, v148
  v_max3_u32 v156, v156, v150, v152
  v_max3_u32 v156, v156, v154, v154
  v_cmp_eq_u32 vcc, -1, v156
  s_nop 1
  s_cbranch_vccnz qtp_357
qm_354:
  s_waitcnt vmcnt(0)
  v_mfma_f32_16x16x32_bf16 v[116:119], v[132:135], v[64:67], 0
  v_mfma_f32_16x16x32_bf16 v[128:131], v[132:135], v[88:91], 0
  v_mfma_f32_16x16x32_bf16 v[116:119], v[136:139], v[68:71], v[116:119]
  v_mfma_f32_16x16x32_bf16 v[128:131], v[136:139], v[92:95], v[128:131]
  v_mfma_f32_16x16x32_bf16 v[116:119], v[140:143], v[72:75], v[116:119]
  v_mfma_f32_16x16x32_bf16 v[128:131], v[140:143], v[96:99], v[128:131]
  v_mfma_f32_16x16x32_bf16 v[116:119], v[144:147], v[76:79], v[116:119]
  v_mfma_f32_16x16x32_bf16 v[128:131], v[144:147], v[100:103], v[128:131]
  v_mfma_f32_16x16x32_bf16 v[116:119], v[148:151], v[80:83], v[116:119]
  v_mfma_f32_16x16x32_bf16 v[128:131], v[148:151], v[104:107], v[128:131]
  v_mfma_f32_16x16x32_bf16 v[116:119], v[152:155], v[84:87], v[116:119]
  v_mfma_f32_16x16x32_bf16 v[128:131], v[152:155], v[108:111], v[128:131]
  s_lshl_b32 s21, s49, 5
  s_add_u32 s21, s21, s42
  s_mul_i32 s81, s21, 2560
  s_lshl_b32 s82, s49, 3
  s_and_b32 s21, s42, 7
  s_add_u32 s82, s82, s21
  s_lshl_b32 s82, s82, 7
  s_add_u32 s82, s82, 22528
  v_cndmask_b32 v112, v34, v112, s[64:65]
  v_cndmask_b32 v124, v34, v124, s[64:65]
  v_cndmask_b32 v113, v34, v113, s[66:67]
  v_cndmask_b32 v125, v34, v125, s[66:67]
  v_cndmask_b32 v114, v34, v114, s[68:69]
  v_cndmask_b32 v126, v34, v126, s[68:69]
  v_cndmask_b32 v115, v34, v115, s[70:71]
  v_cndmask_b32 v127, v34, v127, s[70:71]
  v_max3_f32 v156, v112, v113, v114
  v_max3_f32 v156, v156, v115, v116
  v_max3_f32 v156, v156, v117, v118
  v_max_f32 v156, v156, v119
  v_mov_b32 v157, v156
  s_nop 1
  v_permlane32_swap_b32 v156, v157
  v_max_f32 v156, v156, v157
  v_mov_b32 v157, v156
  s_nop 1
  v_permlane16_swap_b32 v156, v157
  v_max_f32 v156, v156, v157
  v_mul_f32 v156, s83, v156
  v_fma_f32 v112, v112, s83, -v156
  v_fma_f32 v113, v113, s83, -v156
  v_fma_f32 v114, v114, s83, -v156
  v_fma_f32 v115, v115, s83, -v156
  v_fma_f32 v116, v116, s83, -v156
  v_fma_f32 v117, v117, s83, -v156
  v_fma_f32 v118, v118, s83, -v156
  v_fma_f32 v119, v119, s83, -v156
  v_exp_f32 v112, v112
  v_exp_f32 v113, v113
  v_exp_f32 v114, v114
  v_exp_f32 v115, v115
  v_exp_f32 v116, v116
  v_exp_f32 v117, v117
  v_exp_f32 v118, v118
  v_exp_f32 v119, v119
  s_nop 0
  v_add_f32 v156, v116, v117
  v_add_f32 v156, v156, v118
  v_add_f32 v156, v156, v119
  v_cndmask_b32 v156, 0, v156, s[60:61]
  v_add_f32 v156, v156, v112
  v_add_f32 v156, v156, v113
  v_add_f32 v156, v156, v114
  v_add_f32 v156, v156, v115
  v_mov_b32 v157, v156
  s_nop 1
  v_permlane32_swap_b32 v156, v157
  v_add_f32 v156, v156, v157
  v_mov_b32 v157, v156
  s_nop 1
  v_permlane16_swap_b32 v156, v157
  v_add_f32 v156, v156, v157
  v_rcp_f32 v156, v156
  s_nop 0
  v_mul_f32 v112, v112, v156
  v_mul_f32 v113, v113, v156
  v_mul_f32 v114, v114, v156
  v_mul_f32 v115, v115, v156
  v_mul_f32 v116, v116, v156
  v_mul_f32 v117, v117, v156
  v_mul_f32 v118, v118, v156
  v_mul_f32 v119, v119, v156
  v_max3_f32 v156, v120, v121, v122
  v_max3_f32 v156, v156, v123, v124
  v_max3_f32 v156, v156, v125, v126
  v_max3_f32 v156, v156, v127, v128
  v_max3_f32 v156, v156, v129, v130
  v_max_f32 v156, v156, v131
  v_mov_b32 v157, v156
  s_nop 1
  v_permlane32_swap_b32 v156, v157
  v_max_f32 v156, v156, v157
  v_mov_b32 v157, v156
  s_nop 1
  v_permlane16_swap_b32 v156, v157
  v_max_f32 v156, v156, v157
  v_mul_f32 v156, s83, v156
  v_fma_f32 v120, v120, s83, -v156
  v_fma_f32 v121, v121, s83, -v156
  v_fma_f32 v122, v122, s83, -v156
  v_fma_f32 v123, v123, s83, -v156
  v_fma_f32 v124, v124, s83, -v156
  v_fma_f32 v125, v125, s83, -v156
  v_fma_f32 v126, v126, s83, -v156
  v_fma_f32 v127, v127, s83, -v156
  v_fma_f32 v128, v128, s83, -v156
  v_fma_f32 v129, v129, s83, -v156
  v_fma_f32 v130, v130, s83, -v156
  v_fma_f32 v131, v131, s83, -v156
  v_exp_f32 v120, v120
  v_exp_f32 v121, v121
  v_exp_f32 v122, v122
  v_exp_f32 v123, v123
  v_exp_f32 v124, v124
  v_exp_f32 v125, v125
  v_exp_f32 v126, v126
  v_exp_f32 v127, v127
  v_exp_f32 v128, v128
  v_exp_f32 v129, v129
  v_exp_f32 v130, v130
  v_exp_f32 v131, v131
  s_nop 0
  v_add_f32 v156, v128, v129
  v_add_f32 v156, v156, v130
  v_add_f32 v156, v156, v131
  v_cndmask_b32 v156, 0, v156, s[60:61]
  v_add_f32 v156, v156, v120
  v_add_f32 v156, v156, v121
  v_add_f32 v156, v156, v122
  v_add_f32 v156, v156, v123
  v_add_f32 v156, v156, v124
  v_add_f32 v156, v156, v125
  v_add_f32 v156, v156, v126
  v_add_f32 v156, v156, v127
  v_mov_b32 v157, v156
  s_nop 1
  v_permlane32_swap_b32 v156, v157
  v_add_f32 v156, v156, v157
  v_mov_b32 v157, v156
  s_nop 1
  v_permlane16_swap_b32 v156, v157
  v_add_f32 v156, v156, v157
  v_rcp_f32 v156, v156
  s_nop 0
  v_mul_f32 v120, v120, v156
  v_mul_f32 v121, v121, v156
  v_mul_f32 v122, v122, v156
  v_mul_f32 v123, v123, v156
  v_mul_f32 v124, v124, v156
  v_mul_f32 v125, v125, v156
  v_mul_f32 v126, v126, v156
  v_mul_f32 v127, v127, v156
  v_mul_f32 v128, v128, v156
  v_mul_f32 v129, v129, v156
  v_mul_f32 v130, v130, v156
  v_mul_f32 v131, v131, v156
  v_cvt_pk_bf16_f32 v192, v120, v121
  v_cvt_pk_bf16_f32 v193, v122, v123
  v_cvt_pk_bf16_f32 v194, v124, v125
  v_cvt_pk_bf16_f32 v195, v126, v127
  v_cvt_pk_bf16_f32 v196, v116, v117
  v_cvt_pk_bf16_f32 v197, v118, v119
  v_cvt_pk_bf16_f32 v198, v128, v129
  v_cvt_pk_bf16_f32 v199, v130, v131
  v_cvt_pk_bf16_f32 v200, v112, v113
  v_cvt_pk_bf16_f32 v201, v114, v115
  buffer_store_dwordx4 v[192:195], v30, s[56:59], s81 offen sc1
  buffer_store_dwordx4 v[196:199], v30, s[56:59], s81 offen offset:1024 sc1
  buffer_store_dwordx2 v[200:201], v32, s[56:59], s81 offen offset:2048 sc1
  s_mov_b32 s78, s82
  s_mov_b32 s81, 0x80000000
  s_mov_b32 s82, 0
  s_cmp_eq_u32 s80, 1
  s_cbranch_scc1 qd_359
  s_waitcnt vmcnt(0)
  s_cmp_eq_u32 s78, 0
  s_cbranch_scc1 pf_360
  v_mov_b32 v4, 0
  v_mov_b32 v5, 1
  s_mov_b64 exec, 1
  buffer_atomic_add v5, v4, s[72:75], s78 offen sc1
  s_mov_b64 exec, -1
  s_mov_b32 s78, 0
pf_360:
qd_359:
  s_add_u32 s49, s49, s29
qbe_350:
  s_branch queue
do_bat:
  s_mov_b32 s2, s21
  s_load_dwordx2 s[4:5], s[0:1], 0
  s_load_dwordx2 s[6:7], s[0:1], 80
  s_load_dwordx2 s[38:39], s[0:1], 104
  s_waitcnt lgkmcnt(0)
  s_mov_b32 s8, s4
  s_mov_b32 s9, s5
  s_mov_b32 s10, 2621440
  s_mov_b32 s11, 0x00020000
  s_mov_b32 s12, s6
  s_mov_b32 s13, s7
  s_mov_b32 s14, 1280
  s_mov_b32 s15, 0x00020000
  s_add_u32 s16, s38, 62914560
  s_addc_u32 s17, s39, 0
  s_mov_b32 s18, 7864320
  s_mov_b32 s19, 0x00020000
  s_add_u32 s24, s38, 70778880
  s_addc_u32 s25, s39, 0
  s_mov_b32 s26, 2621440
  s_mov_b32 s27, 0x00020000
  s_add_u32 s28, s38, 81002496
  s_addc_u32 s29, s39, 0
  s_mov_b32 s30, 8192
  s_mov_b32 s31, 0x00020000
  s_add_u32 s72, s38, 81068032
  s_addc_u32 s73, s39, 0
  s_mov_b32 s74, 115712
  s_mov_b32 s75, 0x00020000
  v_mov_b32 v7, 52429
  v_add_u32 v5, 0, v1
  v_mul_u32_u24 v6, v5, v7
  v_lshrrev_b32 v18, 23, v6
  v_mul_u32_u24 v19, 1280, v18
  v_lshl_add_u32 v8, v5, 4, v19
  v_add_u32 v8, 1280, v8
  v_lshrrev_b32 v18, 22, v6
  v_mul_u32_u24 v19, 2560, v18
  v_lshl_add_u32 v13, v5, 4, v19
  v_add_u32 v5, 64, v1
  v_mul_u32_u24 v6, v5, v7
  v_lshrrev_b32 v18, 23, v6
  v_mul_u32_u24 v19, 1280, v18
  v_lshl_add_u32 v9, v5, 4, v19
  v_add_u32 v9, 1280, v9
  v_lshrrev_b32 v18, 22, v6
  v_mul_u32_u24 v19, 2560, v18
  v_lshl_add_u32 v14, v5, 4, v19
  v_add_u32 v5, 128, v1
  v_mul_u32_u24 v6, v5, v7
  v_lshrrev_b32 v18, 23, v6
  v_mul_u32_u24 v19, 1280, v18
  v_lshl_add_u32 v10, v5, 4, v19
  v_add_u32 v10, 1280, v10
  v_lshrrev_b32 v18, 22, v6
  v_mul_u32_u24 v19, 2560, v18
  v_lshl_add_u32 v15, v5, 4, v19
  v_add_u32 v5, 192, v1
  v_mul_u32_u24 v6, v5, v7
  v_lshrrev_b32 v18, 23, v6
  v_mul_u32_u24 v19, 1280, v18
  v_lshl_add_u32 v11, v5, 4, v19
  v_add_u32 v11, 1280, v11
  v_lshrrev_b32 v18, 22, v6
  v_mul_u32_u24 v19, 2560, v18
  v_lshl_add_u32 v16, v5, 4, v19
  v_add_u32 v5, 256, v1
  v_mul_u32_u24 v6, v5, v7
  v_lshrrev_b32 v18, 23, v6
  v_mul_u32_u24 v19, 1280, v18
  v_lshl_add_u32 v12, v5, 4, v19
  v_add_u32 v12, 1280, v12
  v_lshrrev_b32 v18, 22, v6
  v_mul_u32_u24 v19, 2560, v18
  v_lshl_add_u32 v17, v5, 4, v19
  s_lshr_b32 s21, s2, 2
  s_lshl_b32 s21, s21, 7
  s_add_u32 s21, s21, 88064
  s_cmp_lg_u32 s20, 0
  s_cbranch_scc1 wf_362
  v_mov_b32 v18, 0
  s_mov_b32 s101, 0
wf_361:
  buffer_load_dword v19, v18, s[72:75], s21 offen sc1
  s_add_u32 s101, s101, 1
  s_cmp_gt_u32 s101, 131072
  s_cbranch_scc1 main_end
  s_waitcnt vmcnt(0)
  v_readfirstlane_b32 s100, v19
  s_cmp_ge_u32 s100, 10
  s_cbranch_scc1 wf_362
  s_sleep 16
  s_branch wf_361
wf_362:
  s_barrier
  s_max_u32 s21, s2, 1
  s_sub_u32 s21, s21, 1
  s_lshr_b32 s21, s21, 2
  s_lshl_b32 s21, s21, 7
  s_add_u32 s21, s21, 88064
  s_cmp_lg_u32 s20, 0
  s_cbranch_scc1 wf_364
  v_mov_b32 v18, 0
  s_mov_b32 s101, 0
wf_363:
  buffer_load_dword v19, v18, s[72:75], s21 offen sc1
  s_add_u32 s101, s101, 1
  s_cmp_gt_u32 s101, 131072
  s_cbranch_scc1 main_end
  s_waitcnt vmcnt(0)
  v_readfirstlane_b32 s100, v19
  s_cmp_ge_u32 s100, 10
  s_cbranch_scc1 wf_364
  s_sleep 16
  s_branch wf_363
wf_364:
  s_barrier
  s_lshl_b32 s58, s2, 5
  s_add_u32 s22, s20, 0
  s_cmp_ge_u32 s22, 23
  s_cbranch_scc1 bd_365
  s_lshl_b32 s23, s22, 1
  s_add_u32 s23, s23, s58
  s_sub_i32 s23, s23, 14
  s_max_i32 s23, s23, 0
  s_mul_i32 s23, s23, 3840
  s_mul_i32 s22, s22, 5120
  s_add_u32 m0, s22, 0
  s_nop 0
  buffer_load_dwordx4 v8, s[16:19], s23 offen sc1 lds
  s_add_u32 m0, s22, 1024
  s_nop 0
  buffer_load_dwordx4 v9, s[16:19], s23 offen sc1 lds
  s_add_u32 m0, s22, 2048
  s_nop 0
  buffer_load_dwordx4 v10, s[16:19], s23 offen sc1 lds
  s_add_u32 m0, s22, 3072
  s_nop 0
  buffer_load_dwordx4 v11, s[16:19], s23 offen sc1 lds
  s_add_u32 m0, s22, 4096
  s_nop 0
  buffer_load_dwordx4 v12, s[16:19], s23 offen sc1 lds
bd_365:
  s_add_u32 s22, s20, 4
  s_cmp_ge_u32 s22, 23
  s_cbranch_scc1 bd_366
  s_lshl_b32 s23, s22, 1
  s_add_u32 s23, s23, s58
  s_sub_i32 s23, s23, 14
  s_max_i32 s23, s23, 0
  s_mul_i32 s23, s23, 3840
  s_mul_i32 s22, s22, 5120
  s_add_u32 m0, s22, 0
  s_nop 0
  buffer_load_dwordx4 v8, s[16:19], s23 offen sc1 lds
  s_add_u32 m0, s22, 1024
  s_nop 0
  buffer_load_dwordx4 v9, s[16:19], s23 offen sc1 lds
  s_add_u32 m0, s22, 2048
  s_nop 0
  buffer_load_dwordx4 v10, s[16:19], s23 offen sc1 lds
  s_add_u32 m0, s22, 3072
  s_nop 0
  buffer_load_dwordx4 v11, s[16:19], s23 offen sc1 lds
  s_add_u32 m0, s22, 4096
  s_nop 0
  buffer_load_dwordx4 v12, s[16:19], s23 offen sc1 lds
bd_366:
  s_add_u32 s22, s20, 8
  s_cmp_ge_u32 s22, 23
  s_cbranch_scc1 bd_367
  s_lshl_b32 s23, s22, 1
  s_add_u32 s23, s23, s58
  s_sub_i32 s23, s23, 14
  s_max_i32 s23, s23, 0
  s_mul_i32 s23, s23, 3840
  s_mul_i32 s22, s22, 5120
  s_add_u32 m0, s22, 0
  s_nop 0
  buffer_load_dwordx4 v8, s[16:19], s23 offen sc1 lds
  s_add_u32 m0, s22, 1024
  s_nop 0
  buffer_load_dwordx4 v9, s[16:19], s23 offen sc1 lds
  s_add_u32 m0, s22, 2048
  s_nop 0
  buffer_load_dwordx4 v10, s[16:19], s23 offen sc1 lds
  s_add_u32 m0, s22, 3072
  s_nop 0
  buffer_load_dwordx4 v11, s[16:19], s23 offen sc1 lds
  s_add_u32 m0, s22, 4096
  s_nop 0
  buffer_load_dwordx4 v12, s[16:19], s23 offen sc1 lds
bd_367:
  s_add_u32 s22, s20, 12
  s_cmp_ge_u32 s22, 23
  s_cbranch_scc1 bd_368
  s_lshl_b32 s23, s22, 1
  s_add_u32 s23, s23, s58
  s_sub_i32 s23, s23, 14
  s_max_i32 s23, s23, 0
  s_mul_i32 s23, s23, 3840
  s_mul_i32 s22, s22, 5120
  s_add_u32 m0, s22, 0
  s_nop 0
  buffer_load_dwordx4 v8, s[16:19], s23 offen sc1 lds
  s_add_u32 m0, s22, 1024
  s_nop 0
  buffer_load_dwordx4 v9, s[16:19], s23 offen sc1 lds
  s_add_u32 m0, s22, 2048
  s_nop 0
  buffer_load_dwordx4 v10, s[16:19], s23 offen sc1 lds
  s_add_u32 m0, s22, 3072
  s_nop 0
  buffer_load_dwordx4 v11, s[16:19], s23 offen sc1 lds
  s_add_u32 m0, s22, 4096
  s_nop 0
  buffer_load_dwordx4 v12, s[16:19], s23 offen sc1 lds
bd_368:
  s_add_u32 s22, s20, 16
  s_cmp_ge_u32 s22, 23
  s_cbranch_scc1 bd_369
  s_lshl_b32 s23, s22, 1
  s_add_u32 s23, s23, s58
  s_sub_i32 s23, s23, 14
  s_max_i32 s23, s23, 0
  s_mul_i32 s23, s23, 3840
  s_mul_i32 s22, s22, 5120
  s_add_u32 m0, s22, 0
  s_nop 0
  buffer_load_dwordx4 v8, s[16:19], s23 offen sc1 lds
  s_add_u32 m0, s22, 1024
  s_nop 0
  buffer_load_dwordx4 v9, s[16:19], s23 offen sc1 lds
  s_add_u32 m0, s22, 2048
  s_nop 0
  buffer_load_dwordx4 v10, s[16:19], s23 offen sc1 lds
  s_add_u32 m0, s22, 3072
  s_nop 0
  buffer_load_dwordx4 v11, s[16:19], s23 offen sc1 lds
  s_add_u32 m0, s22, 4096
  s_nop 0
  buffer_load_dwordx4 v12, s[16:19], s23 offen sc1 lds
bd_369:
  s_add_u32 s22, s20, 20
  s_cmp_ge_u32 s22, 23
  s_cbranch_scc1 bd_370
  s_lshl_b32 s23, s22, 1
  s_add_u32 s23, s23, s58
  s_sub_i32 s23, s23, 14
  s_max_i32 s23, s23, 0
  s_mul_i32 s23, s23, 3840
  s_mul_i32 s22, s22, 5120
  s_add_u32 m0, s22, 0
  s_nop 0
  buffer_load_dwordx4 v8, s[16:19], s23 offen sc1 lds
  s_add_u32 m0, s22, 1024
  s_nop 0
  buffer_load_dwordx4 v9, s[16:19], s23 offen sc1 lds
  s_add_u32 m0, s22, 2048
  s_nop 0
  buffer_load_dwordx4 v10, s[16:19], s23 offen sc1 lds
  s_add_u32 m0, s22, 3072
  s_nop 0
  buffer_load_dwordx4 v11, s[16:19], s23 offen sc1 lds
  s_add_u32 m0, s22, 4096
  s_nop 0
  buffer_load_dwordx4 v12, s[16:19], s23 offen sc1 lds
bd_370:
  s_add_u32 s22, s20, 0
  s_lshl_b32 s23, s22, 2
  s_add_u32 s23, s23, s58
  s_mul_i32 s23, s23, 3840
  s_mul_i32 s22, s22, 5120
  s_add_u32 s22, s22, 117760
  s_add_u32 m0, s22, 0
  s_nop 0
  buffer_load_dwordx4 v13, s[16:19], s23 offen sc1 lds
  s_add_u32 m0, s22, 1024
  s_nop 0
  buffer_load_dwordx4 v14, s[16:19], s23 offen sc1 lds
  s_add_u32 m0, s22, 2048
  s_nop 0
  buffer_load_dwordx4 v15, s[16:19], s23 offen sc1 lds
  s_add_u32 m0, s22, 3072
  s_nop 0
  buffer_load_dwordx4 v16, s[16:19], s23 offen sc1 lds
  s_add_u32 m0, s22, 4096
  s_nop 0
  buffer_load_dwordx4 v17, s[16:19], s23 offen sc1 lds
  s_add_u32 s22, s20, 4
  s_lshl_b32 s23, s22, 2
  s_add_u32 s23, s23, s58
  s_mul_i32 s23, s23, 3840
  s_mul_i32 s22, s22, 5120
  s_add_u32 s22, s22, 117760
  s_add_u32 m0, s22, 0
  s_nop 0
  buffer_load_dwordx4 v13, s[16:19], s23 offen sc1 lds
  s_add_u32 m0, s22, 1024
  s_nop 0
  buffer_load_dwordx4 v14, s[16:19], s23 offen sc1 lds
  s_add_u32 m0, s22, 2048
  s_nop 0
  buffer_load_dwordx4 v15, s[16:19], s23 offen sc1 lds
  s_add_u32 m0, s22, 3072
  s_nop 0
  buffer_load_dwordx4 v16, s[16:19], s23 offen sc1 lds
  s_add_u32 m0, s22, 4096
  s_nop 0
  buffer_load_dwordx4 v17, s[16:19], s23 offen sc1 lds
  s_lshl_b32 s21, s20, 3
  s_add_u32 s59, s58, s21
  v_lshlrev_b32 v4, 2, v1
  buffer_load_dword v16, v4, s[12:15], 0 offen offset:0
  buffer_load_dword v17, v4, s[12:15], 0 offen offset:256
  buffer_load_dword v18, v4, s[12:15], 0 offen offset:512
  buffer_load_dword v19, v4, s[12:15], 0 offen offset:768
  buffer_load_dword v20, v4, s[12:15], 0 offen offset:1024
  s_mul_i32 s22, s59, 1280
  buffer_load_dword v32, v4, s[8:11], s22 offen offset:0
  buffer_load_dword v33, v4, s[8:11], s22 offen offset:256
  buffer_load_dword v34, v4, s[8:11], s22 offen offset:512
  buffer_load_dword v35, v4, s[8:11], s22 offen offset:768
  buffer_load_dword v36, v4, s[8:11], s22 offen offset:1024
  s_add_u32 s22, s22, 1280
  buffer_load_dword v37, v4, s[8:11], s22 offen offset:0
  buffer_load_dword v38, v4, s[8:11], s22 offen offset:256
  buffer_load_dword v39, v4, s[8:11], s22 offen offset:512
  buffer_load_dword v40, v4, s[8:11], s22 offen offset:768
  buffer_load_dword v41, v4, s[8:11], s22 offen offset:1024
  s_add_u32 s22, s22, 1280
  buffer_load_dword v42, v4, s[8:11], s22 offen offset:0
  buffer_load_dword v43, v4, s[8:11], s22 offen offset:256
  buffer_load_dword v44, v4, s[8:11], s22 offen offset:512
  buffer_load_dword v45, v4, s[8:11], s22 offen offset:768
  buffer_load_dword v46, v4, s[8:11], s22 offen offset:1024
  s_add_u32 s22, s22, 1280
  buffer_load_dword v47, v4, s[8:11], s22 offen offset:0
  buffer_load_dword v48, v4, s[8:11], s22 offen offset:256
  buffer_load_dword v49, v4, s[8:11], s22 offen offset:512
  buffer_load_dword v50, v4, s[8:11], s22 offen offset:768
  buffer_load_dword v51, v4, s[8:11], s22 offen offset:1024
  s_add_u32 s22, s22, 1280
  buffer_load_dword v52, v4, s[8:11], s22 offen offset:0
  buffer_load_dword v53, v4, s[8:11], s22 offen offset:256
  buffer_load_dword v54, v4, s[8:11], s22 offen offset:512
  buffer_load_dword v55, v4, s[8:11], s22 offen offset:768
  buffer_load_dword v56, v4, s[8:11], s22 offen offset:1024
  s_add_u32 s22, s22, 1280
  buffer_load_dword v57, v4, s[8:11], s22 offen offset:0
  buffer_load_dword v58, v4, s[8:11], s22 offen offset:256
  buffer_load_dword v59, v4, s[8:11], s22 offen offset:512
  buffer_load_dword v60, v4, s[8:11], s22 offen offset:768
  buffer_load_dword v61, v4, s[8:11], s22 offen offset:1024
  s_add_u32 s22, s22, 1280
  buffer_load_dword v62, v4, s[8:11], s22 offen offset:0
  buffer_load_dword v63, v4, s[8:11], s22 offen offset:256
  buffer_load_dword v64, v4, s[8:11], s22 offen offset:512
  buffer_load_dword v65, v4, s[8:11], s22 offen offset:768
  buffer_load_dword v66, v4, s[8:11], s22 offen offset:1024
  s_add_u32 s22, s22, 1280
  buffer_load_dword v67, v4, s[8:11], s22 offen offset:0
  buffer_load_dword v68, v4, s[8:11], s22 offen offset:256
  buffer_load_dword v69, v4, s[8:11], s22 offen offset:512
  buffer_load_dword v70, v4, s[8:11], s22 offen offset:768
  buffer_load_dword v71, v4, s[8:11], s22 offen offset:1024
  s_add_u32 s22, s22, 1280
  s_waitcnt vmcnt(40)
  v_lshlrev_b32 v8, 16, v16
  v_and_b32 v16, 0xffff0000, v16
  v_lshlrev_b32 v9, 16, v17
  v_and_b32 v17, 0xffff0000, v17
  v_lshlrev_b32 v10, 16, v18
  v_and_b32 v18, 0xffff0000, v18
  v_lshlrev_b32 v11, 16, v19
  v_and_b32 v19, 0xffff0000, v19
  v_lshlrev_b32 v12, 16, v20
  v_and_b32 v20, 0xffff0000, v20
  s_waitcnt vmcnt(35)
  v_mov_b32 v80, 0
  v_lshlrev_b32 v25, 16, v32
  v_and_b32 v26, 0xffff0000, v32
  v_mul_f32 v25, v25, v8
  v_mul_f32 v26, v26, v16
  v_cvt_pk_bf16_f32 v25, v25, v26
  v_lshlrev_b32 v26, 16, v25
  v_and_b32 v25, 0xffff0000, v25
  v_add_f32 v80, v80, v26
  v_add_f32 v80, v80, v25
  v_lshlrev_b32 v25, 16, v33
  v_and_b32 v26, 0xffff0000, v33
  v_mul_f32 v25, v25, v9
  v_mul_f32 v26, v26, v17
  v_cvt_pk_bf16_f32 v25, v25, v26
  v_lshlrev_b32 v26, 16, v25
  v_and_b32 v25, 0xffff0000, v25
  v_add_f32 v80, v80, v26
  v_add_f32 v80, v80, v25
  v_lshlrev_b32 v25, 16, v34
  v_and_b32 v26, 0xffff0000, v34
  v_mul_f32 v25, v25, v10
  v_mul_f32 v26, v26, v18
  v_cvt_pk_bf16_f32 v25, v25, v26
  v_lshlrev_b32 v26, 16, v25
  v_and_b32 v25, 0xffff0000, v25
  v_add_f32 v80, v80, v26
  v_add_f32 v80, v80, v25
  v_lshlrev_b32 v25, 16, v35
  v_and_b32 v26, 0xffff0000, v35
  v_mul_f32 v25, v25, v11
  v_mul_f32 v26, v26, v19
  v_cvt_pk_bf16_f32 v25, v25, v26
  v_lshlrev_b32 v26, 16, v25
  v_and_b32 v25, 0xffff0000, v25
  v_add_f32 v80, v80, v26
  v_add_f32 v80, v80, v25
  v_lshlrev_b32 v25, 16, v36
  v_and_b32 v26, 0xffff0000, v36
  v_mul_f32 v25, v25, v12
  v_mul_f32 v26, v26, v20
  v_cvt_pk_bf16_f32 v25, v25, v26
  v_lshlrev_b32 v26, 16, v25
  v_and_b32 v25, 0xffff0000, v25
  v_add_f32 v80, v80, v26
  v_add_f32 v80, v80, v25
  s_waitcnt vmcnt(30)
  v_mov_b32 v81, 0
  v_lshlrev_b32 v25, 16, v37
  v_and_b32 v26, 0xffff0000, v37
  v_mul_f32 v25, v25, v8
  v_mul_f32 v26, v26, v16
  v_cvt_pk_bf16_f32 v25, v25, v26
  v_lshlrev_b32 v26, 16, v25
  v_and_b32 v25, 0xffff0000, v25
  v_add_f32 v81, v81, v26
  v_add_f32 v81, v81, v25
  v_lshlrev_b32 v25, 16, v38
  v_and_b32 v26, 0xffff0000, v38
  v_mul_f32 v25, v25, v9
  v_mul_f32 v26, v26, v17
  v_cvt_pk_bf16_f32 v25, v25, v26
  v_lshlrev_b32 v26, 16, v25
  v_and_b32 v25, 0xffff0000, v25
  v_add_f32 v81, v81, v26
  v_add_f32 v81, v81, v25
  v_lshlrev_b32 v25, 16, v39
  v_and_b32 v26, 0xffff0000, v39
  v_mul_f32 v25, v25, v10
  v_mul_f32 v26, v26, v18
  v_cvt_pk_bf16_f32 v25, v25, v26
  v_lshlrev_b32 v26, 16, v25
  v_and_b32 v25, 0xffff0000, v25
  v_add_f32 v81, v81, v26
  v_add_f32 v81, v81, v25
  v_lshlrev_b32 v25, 16, v40
  v_and_b32 v26, 0xffff0000, v40
  v_mul_f32 v25, v25, v11
  v_mul_f32 v26, v26, v19
  v_cvt_pk_bf16_f32 v25, v25, v26
  v_lshlrev_b32 v26, 16, v25
  v_and_b32 v25, 0xffff0000, v25
  v_add_f32 v81, v81, v26
  v_add_f32 v81, v81, v25
  v_lshlrev_b32 v25, 16, v41
  v_and_b32 v26, 0xffff0000, v41
  v_mul_f32 v25, v25, v12
  v_mul_f32 v26, v26, v20
  v_cvt_pk_bf16_f32 v25, v25, v26
  v_lshlrev_b32 v26, 16, v25
  v_and_b32 v25, 0xffff0000, v25
  v_add_f32 v81, v81, v26
  v_add_f32 v81, v81, v25
  s_waitcnt vmcnt(25)
  v_mov_b32 v82, 0
  v_lshlrev_b32 v25, 16, v42
  v_and_b32 v26, 0xffff0000, v42
  v_mul_f32 v25, v25, v8
  v_mul_f32 v26, v26, v16
  v_cvt_pk_bf16_f32 v25, v25, v26
  v_lshlrev_b32 v26, 16, v25
  v_and_b32 v25, 0xffff0000, v25
  v_add_f32 v82, v82, v26
  v_add_f32 v82, v82, v25
  v_lshlrev_b32 v25, 16, v43
  v_and_b32 v26, 0xffff0000, v43
  v_mul_f32 v25, v25, v9
  v_mul_f32 v26, v26, v17
  v_cvt_pk_bf16_f32 v25, v25, v26
  v_lshlrev_b32 v26, 16, v25
  v_and_b32 v25, 0xffff0000, v25
  v_add_f32 v82, v82, v26
  v_add_f32 v82, v82, v25
  v_lshlrev_b32 v25, 16, v44
  v_and_b32 v26, 0xffff0000, v44
  v_mul_f32 v25, v25, v10
  v_mul_f32 v26, v26, v18
  v_cvt_pk_bf16_f32 v25, v25, v26
  v_lshlrev_b32 v26, 16, v25
  v_and_b32 v25, 0xffff0000, v25
  v_add_f32 v82, v82, v26
  v_add_f32 v82, v82, v25
  v_lshlrev_b32 v25, 16, v45
  v_and_b32 v26, 0xffff0000, v45
  v_mul_f32 v25, v25, v11
  v_mul_f32 v26, v26, v19
  v_cvt_pk_bf16_f32 v25, v25, v26
  v_lshlrev_b32 v26, 16, v25
  v_and_b32 v25, 0xffff0000, v25
  v_add_f32 v82, v82, v26
  v_add_f32 v82, v82, v25
  v_lshlrev_b32 v25, 16, v46
  v_and_b32 v26, 0xffff0000, v46
  v_mul_f32 v25, v25, v12
  v_mul_f32 v26, v26, v20
  v_cvt_pk_bf16_f32 v25, v25, v26
  v_lshlrev_b32 v26, 16, v25
  v_and_b32 v25, 0xffff0000, v25
  v_add_f32 v82, v82, v26
  v_add_f32 v82, v82, v25
  s_waitcnt vmcnt(20)
  v_mov_b32 v83, 0
  v_lshlrev_b32 v25, 16, v47
  v_and_b32 v26, 0xffff0000, v47
  v_mul_f32 v25, v25, v8
  v_mul_f32 v26, v26, v16
  v_cvt_pk_bf16_f32 v25, v25, v26
  v_lshlrev_b32 v26, 16, v25
  v_and_b32 v25, 0xffff0000, v25
  v_add_f32 v83, v83, v26
  v_add_f32 v83, v83, v25
  v_lshlrev_b32 v25, 16, v48
  v_and_b32 v26, 0xffff0000, v48
  v_mul_f32 v25, v25, v9
  v_mul_f32 v26, v26, v17
  v_cvt_pk_bf16_f32 v25, v25, v26
  v_lshlrev_b32 v26, 16, v25
  v_and_b32 v25, 0xffff0000, v25
  v_add_f32 v83, v83, v26
  v_add_f32 v83, v83, v25
  v_lshlrev_b32 v25, 16, v49
  v_and_b32 v26, 0xffff0000, v49
  v_mul_f32 v25, v25, v10
  v_mul_f32 v26, v26, v18
  v_cvt_pk_bf16_f32 v25, v25, v26
  v_lshlrev_b32 v26, 16, v25
  v_and_b32 v25, 0xffff0000, v25
  v_add_f32 v83, v83, v26
  v_add_f32 v83, v83, v25
  v_lshlrev_b32 v25, 16, v50
  v_and_b32 v26, 0xffff0000, v50
  v_mul_f32 v25, v25, v11
  v_mul_f32 v26, v26, v19
  v_cvt_pk_bf16_f32 v25, v25, v26
  v_lshlrev_b32 v26, 16, v25
  v_and_b32 v25, 0xffff0000, v25
  v_add_f32 v83, v83, v26
  v_add_f32 v83, v83, v25
  v_lshlrev_b32 v25, 16, v51
  v_and_b32 v26, 0xffff0000, v51
  v_mul_f32 v25, v25, v12
  v_mul_f32 v26, v26, v20
  v_cvt_pk_bf16_f32 v25, v25, v26
  v_lshlrev_b32 v26, 16, v25
  v_and_b32 v25, 0xffff0000, v25
  v_add_f32 v83, v83, v26
  v_add_f32 v83, v83, v25
  s_waitcnt vmcnt(15)
  v_mov_b32 v84, 0
  v_lshlrev_b32 v25, 16, v52
  v_and_b32 v26, 0xffff0000, v52
  v_mul_f32 v25, v25, v8
  v_mul_f32 v26, v26, v16
  v_cvt_pk_bf16_f32 v25, v25, v26
  v_lshlrev_b32 v26, 16, v25
  v_and_b32 v25, 0xffff0000, v25
  v_add_f32 v84, v84, v26
  v_add_f32 v84, v84, v25
  v_lshlrev_b32 v25, 16, v53
  v_and_b32 v26, 0xffff0000, v53
  v_mul_f32 v25, v25, v9
  v_mul_f32 v26, v26, v17
  v_cvt_pk_bf16_f32 v25, v25, v26
  v_lshlrev_b32 v26, 16, v25
  v_and_b32 v25, 0xffff0000, v25
  v_add_f32 v84, v84, v26
  v_add_f32 v84, v84, v25
  v_lshlrev_b32 v25, 16, v54
  v_and_b32 v26, 0xffff0000, v54
  v_mul_f32 v25, v25, v10
  v_mul_f32 v26, v26, v18
  v_cvt_pk_bf16_f32 v25, v25, v26
  v_lshlrev_b32 v26, 16, v25
  v_and_b32 v25, 0xffff0000, v25
  v_add_f32 v84, v84, v26
  v_add_f32 v84, v84, v25
  v_lshlrev_b32 v25, 16, v55
  v_and_b32 v26, 0xffff0000, v55
  v_mul_f32 v25, v25, v11
  v_mul_f32 v26, v26, v19
  v_cvt_pk_bf16_f32 v25, v25, v26
  v_lshlrev_b32 v26, 16, v25
  v_and_b32 v25, 0xffff0000, v25
  v_add_f32 v84, v84, v26
  v_add_f32 v84, v84, v25
  v_lshlrev_b32 v25, 16, v56
  v_and_b32 v26, 0xffff0000, v56
  v_mul_f32 v25, v25, v12
  v_mul_f32 v26, v26, v20
  v_cvt_pk_bf16_f32 v25, v25, v26
  v_lshlrev_b32 v26, 16, v25
  v_and_b32 v25, 0xffff0000, v25
  v_add_f32 v84, v84, v26
  v_add_f32 v84, v84, v25
  s_waitcnt vmcnt(10)
  v_mov_b32 v85, 0
  v_lshlrev_b32 v25, 16, v57
  v_and_b32 v26, 0xffff0000, v57
  v_mul_f32 v25, v25, v8
  v_mul_f32 v26, v26, v16
  v_cvt_pk_bf16_f32 v25, v25, v26
  v_lshlrev_b32 v26, 16, v25
  v_and_b32 v25, 0xffff0000, v25
  v_add_f32 v85, v85, v26
  v_add_f32 v85, v85, v25
  v_lshlrev_b32 v25, 16, v58
  v_and_b32 v26, 0xffff0000, v58
  v_mul_f32 v25, v25, v9
  v_mul_f32 v26, v26, v17
  v_cvt_pk_bf16_f32 v25, v25, v26
  v_lshlrev_b32 v26, 16, v25
  v_and_b32 v25, 0xffff0000, v25
  v_add_f32 v85, v85, v26
  v_add_f32 v85, v85, v25
  v_lshlrev_b32 v25, 16, v59
  v_and_b32 v26, 0xffff0000, v59
  v_mul_f32 v25, v25, v10
  v_mul_f32 v26, v26, v18
  v_cvt_pk_bf16_f32 v25, v25, v26
  v_lshlrev_b32 v26, 16, v25
  v_and_b32 v25, 0xffff0000, v25
  v_add_f32 v85, v85, v26
  v_add_f32 v85, v85, v25
  v_lshlrev_b32 v25, 16, v60
  v_and_b32 v26, 0xffff0000, v60
  v_mul_f32 v25, v25, v11
  v_mul_f32 v26, v26, v19
  v_cvt_pk_bf16_f32 v25, v25, v26
  v_lshlrev_b32 v26, 16, v25
  v_and_b32 v25, 0xffff0000, v25
  v_add_f32 v85, v85, v26
  v_add_f32 v85, v85, v25
  v_lshlrev_b32 v25, 16, v61
  v_and_b32 v26, 0xffff0000, v61
  v_mul_f32 v25, v25, v12
  v_mul_f32 v26, v26, v20
  v_cvt_pk_bf16_f32 v25, v25, v26
  v_lshlrev_b32 v26, 16, v25
  v_and_b32 v25, 0xffff0000, v25
  v_add_f32 v85, v85, v26
  v_add_f32 v85, v85, v25
  s_waitcnt vmcnt(5)
  v_mov_b32 v86, 0
  v_lshlrev_b32 v25, 16, v62
  v_and_b32 v26, 0xffff0000, v62
  v_mul_f32 v25, v25, v8
  v_mul_f32 v26, v26, v16
  v_cvt_pk_bf16_f32 v25, v25, v26
  v_lshlrev_b32 v26, 16, v25
  v_and_b32 v25, 0xffff0000, v25
  v_add_f32 v86, v86, v26
  v_add_f32 v86, v86, v25
  v_lshlrev_b32 v25, 16, v63
  v_and_b32 v26, 0xffff0000, v63
  v_mul_f32 v25, v25, v9
  v_mul_f32 v26, v26, v17
  v_cvt_pk_bf16_f32 v25, v25, v26
  v_lshlrev_b32 v26, 16, v25
  v_and_b32 v25, 0xffff0000, v25
  v_add_f32 v86, v86, v26
  v_add_f32 v86, v86, v25
  v_lshlrev_b32 v25, 16, v64
  v_and_b32 v26, 0xffff0000, v64
  v_mul_f32 v25, v25, v10
  v_mul_f32 v26, v26, v18
  v_cvt_pk_bf16_f32 v25, v25, v26
  v_lshlrev_b32 v26, 16, v25
  v_and_b32 v25, 0xffff0000, v25
  v_add_f32 v86, v86, v26
  v_add_f32 v86, v86, v25
  v_lshlrev_b32 v25, 16, v65
  v_and_b32 v26, 0xffff0000, v65
  v_mul_f32 v25, v25, v11
  v_mul_f32 v26, v26, v19
  v_cvt_pk_bf16_f32 v25, v25, v26
  v_lshlrev_b32 v26, 16, v25
  v_and_b32 v25, 0xffff0000, v25
  v_add_f32 v86, v86, v26
  v_add_f32 v86, v86, v25
  v_lshlrev_b32 v25, 16, v66
  v_and_b32 v26, 0xffff0000, v66
  v_mul_f32 v25, v25, v12
  v_mul_f32 v26, v26, v20
  v_cvt_pk_bf16_f32 v25, v25, v26
  v_lshlrev_b32 v26, 16, v25
  v_and_b32 v25, 0xffff0000, v25
  v_add_f32 v86, v86, v26
  v_add_f32 v86, v86, v25
  s_waitcnt vmcnt(0)
  v_mov_b32 v87, 0
  v_lshlrev_b32 v25, 16, v67
  v_and_b32 v26, 0xffff0000, v67
  v_mul_f32 v25, v25, v8
  v_mul_f32 v26, v26, v16
  v_cvt_pk_bf16_f32 v25, v25, v26
  v_lshlrev_b32 v26, 16, v25
  v_and_b32 v25, 0xffff0000, v25
  v_add_f32 v87, v87, v26
  v_add_f32 v87, v87, v25
  v_lshlrev_b32 v25, 16, v68
  v_and_b32 v26, 0xffff0000, v68
  v_mul_f32 v25, v25, v9
  v_mul_f32 v26, v26, v17
  v_cvt_pk_bf16_f32 v25, v25, v26
  v_lshlrev_b32 v26, 16, v25
  v_and_b32 v25, 0xffff0000, v25
  v_add_f32 v87, v87, v26
  v_add_f32 v87, v87, v25
  v_lshlrev_b32 v25, 16, v69
  v_and_b32 v26, 0xffff0000, v69
  v_mul_f32 v25, v25, v10
  v_mul_f32 v26, v26, v18
  v_cvt_pk_bf16_f32 v25, v25, v26
  v_lshlrev_b32 v26, 16, v25
  v_and_b32 v25, 0xffff0000, v25
  v_add_f32 v87, v87, v26
  v_add_f32 v87, v87, v25
  v_lshlrev_b32 v25, 16, v70
  v_and_b32 v26, 0xffff0000, v70
  v_mul_f32 v25, v25, v11
  v_mul_f32 v26, v26, v19
  v_cvt_pk_bf16_f32 v25, v25, v26
  v_lshlrev_b32 v26, 16, v25
  v_and_b32 v25, 0xffff0000, v25
  v_add_f32 v87, v87, v26
  v_add_f32 v87, v87, v25
  v_lshlrev_b32 v25, 16, v71
  v_and_b32 v26, 0xffff0000, v71
  v_mul_f32 v25, v25, v12
  v_mul_f32 v26, v26, v20
  v_cvt_pk_bf16_f32 v25, v25, v26
  v_lshlrev_b32 v26, 16, v25
  v_and_b32 v25, 0xffff0000, v25
  v_add_f32 v87, v87, v26
  v_add_f32 v87, v87, v25
  v_add_f32_dpp v80, v80, v80 row_ror:8 row_mask:0xf bank_mask:0xf
  v_add_f32_dpp v81, v81, v81 row_ror:8 row_mask:0xf bank_mask:0xf
  v_add_f32_dpp v82, v82, v82 row_ror:8 row_mask:0xf bank_mask:0xf
  v_add_f32_dpp v83, v83, v83 row_ror:8 row_mask:0xf bank_mask:0xf
  v_add_f32_dpp v84, v84, v84 row_ror:8 row_mask:0xf bank_mask:0xf
  v_add_f32_dpp v85, v85, v85 row_ror:8 row_mask:0xf bank_mask:0xf
  v_add_f32_dpp v86, v86, v86 row_ror:8 row_mask:0xf bank_mask:0xf
  v_add_f32_dpp v87, v87, v87 row_ror:8 row_mask:0xf bank_mask:0xf
  v_add_f32_dpp v80, v80, v80 row_ror:4 row_mask:0xf bank_mask:0xf
  v_add_f32_dpp v81, v81, v81 row_ror:4 row_mask:0xf bank_mask:0xf
  v_add_f32_dpp v82, v82, v82 row_ror:4 row_mask:0xf bank_mask:0xf
  v_add_f32_dpp v83, v83, v83 row_ror:4 row_mask:0xf bank_mask:0xf
  v_add_f32_dpp v84, v84, v84 row_ror:4 row_mask:0xf bank_mask:0xf
  v_add_f32_dpp v85, v85, v85 row_ror:4 row_mask:0xf bank_mask:0xf
  v_add_f32_dpp v86, v86, v86 row_ror:4 row_mask:0xf bank_mask:0xf
  v_add_f32_dpp v87, v87, v87 row_ror:4 row_mask:0xf bank_mask:0xf
  v_add_f32_dpp v80, v80, v80 row_ror:2 row_mask:0xf bank_mask:0xf
  v_add_f32_dpp v81, v81, v81 row_ror:2 row_mask:0xf bank_mask:0xf
  v_add_f32_dpp v82, v82, v82 row_ror:2 row_mask:0xf bank_mask:0xf
  v_add_f32_dpp v83, v83, v83 row_ror:2 row_mask:0xf bank_mask:0xf
  v_add_f32_dpp v84, v84, v84 row_ror:2 row_mask:0xf bank_mask:0xf
  v_add_f32_dpp v85, v85, v85 row_ror:2 row_mask:0xf bank_mask:0xf
  v_add_f32_dpp v86, v86, v86 row_ror:2 row_mask:0xf bank_mask:0xf
  v_add_f32_dpp v87, v87, v87 row_ror:2 row_mask:0xf bank_mask:0xf
  v_add_f32_dpp v80, v80, v80 row_ror:1 row_mask:0xf bank_mask:0xf
  v_add_f32_dpp v81, v81, v81 row_ror:1 row_mask:0xf bank_mask:0xf
  v_add_f32_dpp v82, v82, v82 row_ror:1 row_mask:0xf bank_mask:0xf
  v_add_f32_dpp v83, v83, v83 row_ror:1 row_mask:0xf bank_mask:0xf
  v_add_f32_dpp v84, v84, v84 row_ror:1 row_mask:0xf bank_mask:0xf
  v_add_f32_dpp v85, v85, v85 row_ror:1 row_mask:0xf bank_mask:0xf
  v_add_f32_dpp v86, v86, v86 row_ror:1 row_mask:0xf bank_mask:0xf
  v_add_f32_dpp v87, v87, v87 row_ror:1 row_mask:0xf bank_mask:0xf
  v_mov_b32 v88, v80
  v_mov_b32 v89, v81
  v_mov_b32 v90, v82
  v_mov_b32 v91, v83
  v_mov_b32 v92, v84
  v_mov_b32 v93, v85
  v_mov_b32 v94, v86
  v_mov_b32 v95, v87
  v_permlane32_swap_b32 v80, v88
  v_permlane32_swap_b32 v81, v89
  v_permlane32_swap_b32 v82, v90
  v_permlane32_swap_b32 v83, v91
  v_permlane32_swap_b32 v84, v92
  v_permlane32_swap_b32 v85, v93
  v_permlane32_swap_b32 v86, v94
  v_permlane32_swap_b32 v87, v95
  v_add_f32 v80, v80, v88
  v_add_f32 v81, v81, v89
  v_add_f32 v82, v82, v90
  v_add_f32 v83, v83, v91
  v_add_f32 v84, v84, v92
  v_add_f32 v85, v85, v93
  v_add_f32 v86, v86, v94
  v_add_f32 v87, v87, v95
  v_mov_b32 v88, v80
  v_mov_b32 v89, v81
  v_mov_b32 v90, v82
  v_mov_b32 v91, v83
  v_mov_b32 v92, v84
  v_mov_b32 v93, v85
  v_mov_b32 v94, v86
  v_mov_b32 v95, v87
  v_permlane16_swap_b32 v80, v88
  v_permlane16_swap_b32 v81, v89
  v_permlane16_swap_b32 v82, v90
  v_permlane16_swap_b32 v83, v91
  v_permlane16_swap_b32 v84, v92
  v_permlane16_swap_b32 v85, v93
  v_permlane16_swap_b32 v86, v94
  v_permlane16_swap_b32 v87, v95
  v_add_f32 v80, v80, v88
  v_add_f32 v81, v81, v89
  v_add_f32 v82, v82, v90
  v_add_f32 v83, v83, v91
  v_add_f32 v84, v84, v92
  v_add_f32 v85, v85, v93
  v_add_f32 v86, v86, v94
  v_add_f32 v87, v87, v95
  v_mov_b32 v24, v80
  v_cmp_eq_u32 vcc, 1, v1
  s_nop 1
  v_cndmask_b32 v24, v24, v81, vcc
  v_cmp_eq_u32 vcc, 2, v1
  s_nop 1
  v_cndmask_b32 v24, v24, v82, vcc
  v_cmp_eq_u32 vcc, 3, v1
  s_nop 1
  v_cndmask_b32 v24, v24, v83, vcc
  v_cmp_eq_u32 vcc, 4, v1
  s_nop 1
  v_cndmask_b32 v24, v24, v84, vcc
  v_cmp_eq_u32 vcc, 5, v1
  s_nop 1
  v_cndmask_b32 v24, v24, v85, vcc
  v_cmp_eq_u32 vcc, 6, v1
  s_nop 1
  v_cndmask_b32 v24, v24, v86, vcc
  v_cmp_eq_u32 vcc, 7, v1
  s_nop 1
  v_cndmask_b32 v24, v24, v87, vcc
  v_cvt_pk_bf16_f32 v25, v24, v24
  v_lshlrev_b32 v24, 16, v25
  v_mul_f32 v24, 0xbfb8aa3b, v24
  v_exp_f32 v24, v24
  s_nop 0
  v_add_f32 v24, 1.0, v24
  v_rcp_f32 v24, v24
  s_nop 0
  v_cvt_pk_bf16_f32 v25, v24, v24
  v_lshlrev_b32 v24, 16, v25
  s_lshl_b32 s21, s59, 2
  s_mov_b64 exec, 0xff
  buffer_store_dword v24, v4, s[28:31], s21 offen sc1
  s_mov_b64 exec, -1
  s_barrier
  v_and_b32 v4, 31, v1
  v_lshrrev_b32 v5, 5, v1
  s_lshl_b32 s22, s20, 1
  v_add_u32 v5, s22, v5
  v_mul_u32_u24 v6, 40, v4
  v_mul_u32_u24 v7, 2560, v5
  v_add_u32 v7, v7, v6
  v_mul_u32_u24 v8, 1280, v5
  s_mov_b32 s22, 117760
  v_add3_u32 v8, v8, v6, s22
  v_add_u32 v5, s58, v5
  s_mov_b32 s59, 0
  s_mov_b32 s60, 0x3e64f92e
  s_mov_b32 s61, 0x3fb8aa3b
  s_mov_b32 s62, 0x05040100
  s_mov_b32 s63, 0x07060302
  v_mov_b32 v9, 0xf149f2ca
ba_371:
  ds_read_b64 v[16:17], v8 offset:0
  ds_read_b64 v[18:19], v8 offset:8
  ds_read_b64 v[20:21], v8 offset:16
  ds_read_b64 v[22:23], v8 offset:24
  ds_read_b64 v[24:25], v8 offset:32
  ds_read_b64 v[32:33], v7 offset:35840
  ds_read_b64 v[34:35], v7 offset:35848
  ds_read_b64 v[36:37], v7 offset:35856
  ds_read_b64 v[38:39], v7 offset:35864
  ds_read_b64 v[40:41], v7 offset:35872
  ds_read_b64 v[42:43], v7 offset:30720
  ds_read_b64 v[44:45], v7 offset:30728
  ds_read_b64 v[46:47], v7 offset:30736
  ds_read_b64 v[48:49], v7 offset:30744
  ds_read_b64 v[50:51], v7 offset:30752
  ds_read_b64 v[52:53], v7 offset:25600
  ds_read_b64 v[54:55], v7 offset:25608
  ds_read_b64 v[56:57], v7 offset:25616
  ds_read_b64 v[58:59], v7 offset:25624
  ds_read_b64 v[60:61], v7 offset:25632
  ds_read_b64 v[62:63], v7 offset:20480
  ds_read_b64 v[64:65], v7 offset:20488
  ds_read_b64 v[66:67], v7 offset:20496
  ds_read_b64 v[68:69], v7 offset:20504
  ds_read_b64 v[70:71], v7 offset:20512
  ds_read_b64 v[72:73], v7 offset:15360
  ds_read_b64 v[74:75], v7 offset:15368
  ds_read_b64 v[76:77], v7 offset:15376
  ds_read_b64 v[78:79], v7 offset:15384
  ds_read_b64 v[80:81], v7 offset:15392
  ds_read_b64 v[82:83], v7 offset:10240
  ds_read_b64 v[84:85], v7 offset:10248
  ds_read_b64 v[86:87], v7 offset:10256
  ds_read_b64 v[88:89], v7 offset:10264
  ds_read_b64 v[90:91], v7 offset:10272
  ds_read_b64 v[92:93], v7 offset:5120
  ds_read_b64 v[94:95], v7 offset:5128
  ds_read_b64 v[96:97], v7 offset:5136
  ds_read_b64 v[98:99], v7 offset:5144
  ds_read_b64 v[100:101], v7 offset:5152
  ds_read_b64 v[102:103], v7 offset:0
  ds_read_b64 v[104:105], v7 offset:8
  ds_read_b64 v[106:107], v7 offset:16
  ds_read_b64 v[108:109], v7 offset:24
  ds_read_b64 v[110:111], v7 offset:32
  v_cmp_le_u32 s[40:41], 0, v5
  v_mov_b32 v224, 0
  v_cmp_le_u32 s[42:43], 2, v5
  v_mov_b32 v225, 0
  v_cmp_le_u32 s[44:45], 4, v5
  v_mov_b32 v226, 0
  v_cmp_le_u32 s[46:47], 6, v5
  v_mov_b32 v227, 0
  v_cmp_le_u32 s[48:49], 8, v5
  v_mov_b32 v228, 0
  v_cmp_le_u32 s[50:51], 10, v5
  v_mov_b32 v229, 0
  v_cmp_le_u32 s[52:53], 12, v5
  v_mov_b32 v230, 0
  v_cmp_le_u32 s[54:55], 14, v5
  v_mov_b32 v231, 0
  v_mov_b32 v200, 0
  v_mov_b32 v201, 0
  v_mov_b32 v202, 0
  v_mov_b32 v203, 0
  v_mov_b32 v204, 0
  v_mov_b32 v205, 0
  v_mov_b32 v206, 0
  v_mov_b32 v207, 0
  v_mov_b32 v208, 0
  v_mov_b32 v209, 0
  v_mov_b32 v210, 0
  v_mov_b32 v211, 0
  v_mov_b32 v212, 0
  v_mov_b32 v213, 0
  v_mov_b32 v214, 0
  v_mov_b32 v215, 0
  v_mov_b32 v216, 0
  v_mov_b32 v217, 0
  v_mov_b32 v218, 0
  v_mov_b32 v219, 0
  s_waitcnt lgkmcnt(15)
  v_dot2c_f32_bf16 v224, v32, v16
  v_dot2c_f32_bf16 v225, v42, v16
  v_dot2c_f32_bf16 v226, v52, v16
  v_dot2c_f32_bf16 v227, v62, v16
  v_dot2c_f32_bf16 v228, v72, v16
  v_dot2c_f32_bf16 v224, v33, v17
  v_dot2c_f32_bf16 v225, v43, v17
  v_dot2c_f32_bf16 v226, v53, v17
  v_dot2c_f32_bf16 v227, v63, v17
  v_dot2c_f32_bf16 v228, v73, v17
  v_dot2c_f32_bf16 v224, v34, v18
  v_dot2c_f32_bf16 v225, v44, v18
  v_dot2c_f32_bf16 v226, v54, v18
  v_dot2c_f32_bf16 v227, v64, v18
  v_dot2c_f32_bf16 v228, v74, v18
  v_dot2c_f32_bf16 v224, v35, v19
  v_dot2c_f32_bf16 v225, v45, v19
  v_dot2c_f32_bf16 v226, v55, v19
  v_dot2c_f32_bf16 v227, v65, v19
  v_dot2c_f32_bf16 v228, v75, v19
  v_dot2c_f32_bf16 v224, v36, v20
  v_dot2c_f32_bf16 v225, v46, v20
  v_dot2c_f32_bf16 v226, v56, v20
  v_dot2c_f32_bf16 v227, v66, v20
  v_dot2c_f32_bf16 v228, v76, v20
  v_dot2c_f32_bf16 v224, v37, v21
  v_dot2c_f32_bf16 v225, v47, v21
  v_dot2c_f32_bf16 v226, v57, v21
  v_dot2c_f32_bf16 v227, v67, v21
  v_dot2c_f32_bf16 v228, v77, v21
  v_dot2c_f32_bf16 v224, v38, v22
  v_dot2c_f32_bf16 v225, v48, v22
  v_dot2c_f32_bf16 v226, v58, v22
  v_dot2c_f32_bf16 v227, v68, v22
  v_dot2c_f32_bf16 v228, v78, v22
  v_dot2c_f32_bf16 v224, v39, v23
  v_dot2c_f32_bf16 v225, v49, v23
  v_dot2c_f32_bf16 v226, v59, v23
  v_dot2c_f32_bf16 v227, v69, v23
  v_dot2c_f32_bf16 v228, v79, v23
  v_dot2c_f32_bf16 v224, v40, v24
  v_dot2c_f32_bf16 v225, v50, v24
  v_dot2c_f32_bf16 v226, v60, v24
  v_dot2c_f32_bf16 v227, v70, v24
  v_dot2c_f32_bf16 v228, v80, v24
  v_dot2c_f32_bf16 v224, v41, v25
  v_dot2c_f32_bf16 v225, v51, v25
  v_dot2c_f32_bf16 v226, v61, v25
  v_dot2c_f32_bf16 v227, v71, v25
  v_dot2c_f32_bf16 v228, v81, v25
  s_waitcnt lgkmcnt(0)
  v_dot2c_f32_bf16 v229, v82, v16
  v_dot2c_f32_bf16 v230, v92, v16
  v_dot2c_f32_bf16 v231, v102, v16
  v_dot2c_f32_bf16 v229, v83, v17
  v_dot2c_f32_bf16 v230, v93, v17
  v_dot2c_f32_bf16 v231, v103, v17
  v_dot2c_f32_bf16 v229, v84, v18
  v_dot2c_f32_bf16 v230, v94, v18
  v_dot2c_f32_bf16 v231, v104, v18
  v_dot2c_f32_bf16 v229, v85, v19
  v_dot2c_f32_bf16 v230, v95, v19
  v_dot2c_f32_bf16 v231, v105, v19
  v_dot2c_f32_bf16 v229, v86, v20
  v_dot2c_f32_bf16 v230, v96, v20
  v_dot2c_f32_bf16 v231, v106, v20
  v_dot2c_f32_bf16 v229, v87, v21
  v_dot2c_f32_bf16 v230, v97, v21
  v_dot2c_f32_bf16 v231, v107, v21
  v_dot2c_f32_bf16 v229, v88, v22
  v_dot2c_f32_bf16 v230, v98, v22
  v_dot2c_f32_bf16 v231, v108, v22
  v_dot2c_f32_bf16 v229, v89, v23
  v_dot2c_f32_bf16 v230, v99, v23
  v_dot2c_f32_bf16 v231, v109, v23
  v_dot2c_f32_bf16 v229, v90, v24
  v_dot2c_f32_bf16 v230, v100, v24
  v_dot2c_f32_bf16 v231, v110, v24
  v_dot2c_f32_bf16 v229, v91, v25
  v_dot2c_f32_bf16 v230, v101, v25
  v_dot2c_f32_bf16 v231, v111, v25
  ds_read_b64 v[112:113], v7 offset:37120
  ds_read_b64 v[114:115], v7 offset:37128
  ds_read_b64 v[116:117], v7 offset:37136
  ds_read_b64 v[118:119], v7 offset:37144
  ds_read_b64 v[120:121], v7 offset:37152
  ds_read_b64 v[122:123], v7 offset:32000
  ds_read_b64 v[124:125], v7 offset:32008
  ds_read_b64 v[126:127], v7 offset:32016
  ds_read_b64 v[128:129], v7 offset:32024
  ds_read_b64 v[130:131], v7 offset:32032
  ds_read_b64 v[132:133], v7 offset:26880
  ds_read_b64 v[134:135], v7 offset:26888
  ds_read_b64 v[136:137], v7 offset:26896
  ds_read_b64 v[138:139], v7 offset:26904
  ds_read_b64 v[140:141], v7 offset:26912
  ds_read_b64 v[142:143], v7 offset:21760
  ds_read_b64 v[144:145], v7 offset:21768
  ds_read_b64 v[146:147], v7 offset:21776
  ds_read_b64 v[148:149], v7 offset:21784
  ds_read_b64 v[150:151], v7 offset:21792
  ds_read_b64 v[152:153], v7 offset:16640
  ds_read_b64 v[154:155], v7 offset:16648
  ds_read_b64 v[156:157], v7 offset:16656
  ds_read_b64 v[158:159], v7 offset:16664
  ds_read_b64 v[160:161], v7 offset:16672
  ds_read_b64 v[162:163], v7 offset:11520
  ds_read_b64 v[164:165], v7 offset:11528
  ds_read_b64 v[166:167], v7 offset:11536
  ds_read_b64 v[168:169], v7 offset:11544
  ds_read_b64 v[170:171], v7 offset:11552
  ds_read_b64 v[172:173], v7 offset:6400
  ds_read_b64 v[174:175], v7 offset:6408
  ds_read_b64 v[176:177], v7 offset:6416
  ds_read_b64 v[178:179], v7 offset:6424
  ds_read_b64 v[180:181], v7 offset:6432
  ds_read_b64 v[182:183], v7 offset:1280
  ds_read_b64 v[184:185], v7 offset:1288
  ds_read_b64 v[186:187], v7 offset:1296
  ds_read_b64 v[188:189], v7 offset:1304
  ds_read_b64 v[190:191], v7 offset:1312
  v_cvt_pk_bf16_f32 v10, v224, v225
  v_lshlrev_b32 v224, 16, v10
  v_and_b32 v225, 0xffff0000, v10
  v_mul_f32 v224, s60, v224
  v_mul_f32 v225, s60, v225
  v_cvt_pk_bf16_f32 v10, v224, v225
  v_lshlrev_b32 v224, 16, v10
  v_and_b32 v225, 0xffff0000, v10
  v_cndmask_b32 v224, v9, v224, s[40:41]
  v_cndmask_b32 v225, v9, v225, s[42:43]
  v_cvt_pk_bf16_f32 v10, v226, v227
  v_lshlrev_b32 v226, 16, v10
  v_and_b32 v227, 0xffff0000, v10
  v_mul_f32 v226, s60, v226
  v_mul_f32 v227, s60, v227
  v_cvt_pk_bf16_f32 v10, v226, v227
  v_lshlrev_b32 v226, 16, v10
  v_and_b32 v227, 0xffff0000, v10
  v_cndmask_b32 v226, v9, v226, s[44:45]
  v_cndmask_b32 v227, v9, v227, s[46:47]
  v_cvt_pk_bf16_f32 v10, v228, v229
  v_lshlrev_b32 v228, 16, v10
  v_and_b32 v229, 0xffff0000, v10
  v_mul_f32 v228, s60, v228
  v_mul_f32 v229, s60, v229
  v_cvt_pk_bf16_f32 v10, v228, v229
  v_lshlrev_b32 v228, 16, v10
  v_and_b32 v229, 0xffff0000, v10
  v_cndmask_b32 v228, v9, v228, s[48:49]
  v_cndmask_b32 v229, v9, v229, s[50:51]
  v_cvt_pk_bf16_f32 v10, v230, v231
  v_lshlrev_b32 v230, 16, v10
  v_and_b32 v231, 0xffff0000, v10
  v_mul_f32 v230, s60, v230
  v_mul_f32 v231, s60, v231
  v_cvt_pk_bf16_f32 v10, v230, v231
  v_lshlrev_b32 v230, 16, v10
  v_and_b32 v231, 0xffff0000, v10
  v_cndmask_b32 v230, v9, v230, s[52:53]
  v_cndmask_b32 v231, v9, v231, s[54:55]
  v_max3_f32 v12, v224, v225, v226
  v_max3_f32 v12, v12, v227, v228
  v_max3_f32 v12, v12, v229, v230
  v_max_f32 v12, v12, v231
  v_sub_f32 v224, v224, v12
  v_mul_f32 v224, s61, v224
  v_exp_f32 v224, v224
  v_sub_f32 v225, v225, v12
  v_mul_f32 v225, s61, v225
  v_exp_f32 v225, v225
  v_sub_f32 v226, v226, v12
  v_mul_f32 v226, s61, v226
  v_exp_f32 v226, v226
  v_sub_f32 v227, v227, v12
  v_mul_f32 v227, s61, v227
  v_exp_f32 v227, v227
  v_sub_f32 v228, v228, v12
  v_mul_f32 v228, s61, v228
  v_exp_f32 v228, v228
  v_sub_f32 v229, v229, v12
  v_mul_f32 v229, s61, v229
  v_exp_f32 v229, v229
  v_sub_f32 v230, v230, v12
  v_mul_f32 v230, s61, v230
  v_exp_f32 v230, v230
  v_sub_f32 v231, v231, v12
  v_mul_f32 v231, s61, v231
  v_exp_f32 v231, v231
  s_nop 0
  v_add_f32 v12, v224, v225
  v_add_f32 v12, v12, v226
  v_add_f32 v12, v12, v227
  v_add_f32 v12, v12, v228
  v_add_f32 v12, v12, v229
  v_add_f32 v12, v12, v230
  v_add_f32 v12, v12, v231
  v_rcp_f32 v12, v12
  s_nop 0
  v_mul_f32 v224, v224, v12
  v_mul_f32 v225, v225, v12
  v_mul_f32 v226, v226, v12
  v_mul_f32 v227, v227, v12
  v_mul_f32 v228, v228, v12
  v_mul_f32 v229, v229, v12
  v_mul_f32 v230, v230, v12
  v_mul_f32 v231, v231, v12
  v_cvt_pk_bf16_f32 v232, v224, v225
  v_cvt_pk_bf16_f32 v233, v226, v227
  v_cvt_pk_bf16_f32 v234, v228, v229
  v_cvt_pk_bf16_f32 v235, v230, v231
  s_waitcnt lgkmcnt(15)
  v_perm_b32 v236, v122, v112, s62
  v_perm_b32 v237, v122, v112, s63
  v_dot2c_f32_bf16 v200, v236, v232
  v_dot2c_f32_bf16 v201, v237, v232
  v_perm_b32 v238, v123, v113, s62
  v_perm_b32 v239, v123, v113, s63
  v_dot2c_f32_bf16 v202, v238, v232
  v_dot2c_f32_bf16 v203, v239, v232
  v_perm_b32 v240, v124, v114, s62
  v_perm_b32 v241, v124, v114, s63
  v_dot2c_f32_bf16 v204, v240, v232
  v_dot2c_f32_bf16 v205, v241, v232
  v_perm_b32 v242, v125, v115, s62
  v_perm_b32 v243, v125, v115, s63
  v_dot2c_f32_bf16 v206, v242, v232
  v_dot2c_f32_bf16 v207, v243, v232
  v_perm_b32 v236, v126, v116, s62
  v_perm_b32 v237, v126, v116, s63
  v_dot2c_f32_bf16 v208, v236, v232
  v_dot2c_f32_bf16 v209, v237, v232
  v_perm_b32 v238, v127, v117, s62
  v_perm_b32 v239, v127, v117, s63
  v_dot2c_f32_bf16 v210, v238, v232
  v_dot2c_f32_bf16 v211, v239, v232
  v_perm_b32 v240, v128, v118, s62
  v_perm_b32 v241, v128, v118, s63
  v_dot2c_f32_bf16 v212, v240, v232
  v_dot2c_f32_bf16 v213, v241, v232
  v_perm_b32 v242, v129, v119, s62
  v_perm_b32 v243, v129, v119, s63
  v_dot2c_f32_bf16 v214, v242, v232
  v_dot2c_f32_bf16 v215, v243, v232
  v_perm_b32 v236, v130, v120, s62
  v_perm_b32 v237, v130, v120, s63
  v_dot2c_f32_bf16 v216, v236, v232
  v_dot2c_f32_bf16 v217, v237, v232
  v_perm_b32 v238, v131, v121, s62
  v_perm_b32 v239, v131, v121, s63
  v_dot2c_f32_bf16 v218, v238, v232
  v_dot2c_f32_bf16 v219, v239, v232
  s_waitcnt lgkmcnt(15)
  v_perm_b32 v236, v142, v132, s62
  v_perm_b32 v237, v142, v132, s63
  v_dot2c_f32_bf16 v200, v236, v233
  v_dot2c_f32_bf16 v201, v237, v233
  v_perm_b32 v238, v143, v133, s62
  v_perm_b32 v239, v143, v133, s63
  v_dot2c_f32_bf16 v202, v238, v233
  v_dot2c_f32_bf16 v203, v239, v233
  v_perm_b32 v240, v144, v134, s62
  v_perm_b32 v241, v144, v134, s63
  v_dot2c_f32_bf16 v204, v240, v233
  v_dot2c_f32_bf16 v205, v241, v233
  v_perm_b32 v242, v145, v135, s62
  v_perm_b32 v243, v145, v135, s63
  v_dot2c_f32_bf16 v206, v242, v233
  v_dot2c_f32_bf16 v207, v243, v233
  v_perm_b32 v236, v146, v136, s62
  v_perm_b32 v237, v146, v136, s63
  v_dot2c_f32_bf16 v208, v236, v233
  v_dot2c_f32_bf16 v209, v237, v233
  v_perm_b32 v238, v147, v137, s62
  v_perm_b32 v239, v147, v137, s63
  v_dot2c_f32_bf16 v210, v238, v233
  v_dot2c_f32_bf16 v211, v239, v233
  v_perm_b32 v240, v148, v138, s62
  v_perm_b32 v241, v148, v138, s63
  v_dot2c_f32_bf16 v212, v240, v233
  v_dot2c_f32_bf16 v213, v241, v233
  v_perm_b32 v242, v149, v139, s62
  v_perm_b32 v243, v149, v139, s63
  v_dot2c_f32_bf16 v214, v242, v233
  v_dot2c_f32_bf16 v215, v243, v233
  v_perm_b32 v236, v150, v140, s62
  v_perm_b32 v237, v150, v140, s63
  v_dot2c_f32_bf16 v216, v236, v233
  v_dot2c_f32_bf16 v217, v237, v233
  v_perm_b32 v238, v151, v141, s62
  v_perm_b32 v239, v151, v141, s63
  v_dot2c_f32_bf16 v218, v238, v233
  v_dot2c_f32_bf16 v219, v239, v233
  s_waitcnt lgkmcnt(10)
  v_perm_b32 v236, v162, v152, s62
  v_perm_b32 v237, v162, v152, s63
  v_dot2c_f32_bf16 v200, v236, v234
  v_dot2c_f32_bf16 v201, v237, v234
  v_perm_b32 v238, v163, v153, s62
  v_perm_b32 v239, v163, v153, s63
  v_dot2c_f32_bf16 v202, v238, v234
  v_dot2c_f32_bf16 v203, v239, v234
  v_perm_b32 v240, v164, v154, s62
  v_perm_b32 v241, v164, v154, s63
  v_dot2c_f32_bf16 v204, v240, v234
  v_dot2c_f32_bf16 v205, v241, v234
  v_perm_b32 v242, v165, v155, s62
  v_perm_b32 v243, v165, v155, s63
  v_dot2c_f32_bf16 v206, v242, v234
  v_dot2c_f32_bf16 v207, v243, v234
  v_perm_b32 v236, v166, v156, s62
  v_perm_b32 v237, v166, v156, s63
  v_dot2c_f32_bf16 v208, v236, v234
  v_dot2c_f32_bf16 v209, v237, v234
  v_perm_b32 v238, v167, v157, s62
  v_perm_b32 v239, v167, v157, s63
  v_dot2c_f32_bf16 v210, v238, v234
  v_dot2c_f32_bf16 v211, v239, v234
  v_perm_b32 v240, v168, v158, s62
  v_perm_b32 v241, v168, v158, s63
  v_dot2c_f32_bf16 v212, v240, v234
  v_dot2c_f32_bf16 v213, v241, v234
  v_perm_b32 v242, v169, v159, s62
  v_perm_b32 v243, v169, v159, s63
  v_dot2c_f32_bf16 v214, v242, v234
  v_dot2c_f32_bf16 v215, v243, v234
  v_perm_b32 v236, v170, v160, s62
  v_perm_b32 v237, v170, v160, s63
  v_dot2c_f32_bf16 v216, v236, v234
  v_dot2c_f32_bf16 v217, v237, v234
  v_perm_b32 v238, v171, v161, s62
  v_perm_b32 v239, v171, v161, s63
  v_dot2c_f32_bf16 v218, v238, v234
  v_dot2c_f32_bf16 v219, v239, v234
  s_waitcnt lgkmcnt(0)
  v_perm_b32 v236, v182, v172, s62
  v_perm_b32 v237, v182, v172, s63
  v_dot2c_f32_bf16 v200, v236, v235
  v_dot2c_f32_bf16 v201, v237, v235
  v_perm_b32 v238, v183, v173, s62
  v_perm_b32 v239, v183, v173, s63
  v_dot2c_f32_bf16 v202, v238, v235
  v_dot2c_f32_bf16 v203, v239, v235
  v_perm_b32 v240, v184, v174, s62
  v_perm_b32 v241, v184, v174, s63
  v_dot2c_f32_bf16 v204, v240, v235
  v_dot2c_f32_bf16 v205, v241, v235
  v_perm_b32 v242, v185, v175, s62
  v_perm_b32 v243, v185, v175, s63
  v_dot2c_f32_bf16 v206, v242, v235
  v_dot2c_f32_bf16 v207, v243, v235
  v_perm_b32 v236, v186, v176, s62
  v_perm_b32 v237, v186, v176, s63
  v_dot2c_f32_bf16 v208, v236, v235
  v_dot2c_f32_bf16 v209, v237, v235
  v_perm_b32 v238, v187, v177, s62
  v_perm_b32 v239, v187, v177, s63
  v_dot2c_f32_bf16 v210, v238, v235
  v_dot2c_f32_bf16 v211, v239, v235
  v_perm_b32 v240, v188, v178, s62
  v_perm_b32 v241, v188, v178, s63
  v_dot2c_f32_bf16 v212, v240, v235
  v_dot2c_f32_bf16 v213, v241, v235
  v_perm_b32 v242, v189, v179, s62
  v_perm_b32 v243, v189, v179, s63
  v_dot2c_f32_bf16 v214, v242, v235
  v_dot2c_f32_bf16 v215, v243, v235
  v_perm_b32 v236, v190, v180, s62
  v_perm_b32 v237, v190, v180, s63
  v_dot2c_f32_bf16 v216, v236, v235
  v_dot2c_f32_bf16 v217, v237, v235
  v_perm_b32 v238, v191, v181, s62
  v_perm_b32 v239, v191, v181, s63
  v_dot2c_f32_bf16 v218, v238, v235
  v_dot2c_f32_bf16 v219, v239, v235
  v_cvt_pk_bf16_f32 v244, v200, v201
  v_cvt_pk_bf16_f32 v245, v202, v203
  v_cvt_pk_bf16_f32 v246, v204, v205
  v_cvt_pk_bf16_f32 v247, v206, v207
  v_cvt_pk_bf16_f32 v248, v208, v209
  v_cvt_pk_bf16_f32 v249, v210, v211
  v_cvt_pk_bf16_f32 v250, v212, v213
  v_cvt_pk_bf16_f32 v251, v214, v215
  v_cvt_pk_bf16_f32 v252, v216, v217
  v_cvt_pk_bf16_f32 v253, v218, v219
  v_lshrrev_b32 v10, 4, v5
  v_mul_u32_u24 v10, 20480, v10
  v_and_b32 v11, 15, v5
  v_lshl_add_u32 v10, v11, 4, v10
  v_mul_u32_u24 v11, 5, v4
  v_add_u32 v12, 0, v11
  v_lshrrev_b32 v13, 1, v12
  v_and_b32 v12, 1, v12
  v_lshl_add_u32 v13, v13, 8, v10
  v_lshl_add_u32 v13, v12, 3, v13
  buffer_store_dwordx2 v[244:245], v13, s[24:27], 0 offen sc1
  v_add_u32 v12, 1, v11
  v_lshrrev_b32 v13, 1, v12
  v_and_b32 v12, 1, v12
  v_lshl_add_u32 v13, v13, 8, v10
  v_lshl_add_u32 v13, v12, 3, v13
  buffer_store_dwordx2 v[246:247], v13, s[24:27], 0 offen sc1
  v_add_u32 v12, 2, v11
  v_lshrrev_b32 v13, 1, v12
  v_and_b32 v12, 1, v12
  v_lshl_add_u32 v13, v13, 8, v10
  v_lshl_add_u32 v13, v12, 3, v13
  buffer_store_dwordx2 v[248:249], v13, s[24:27], 0 offen sc1
  v_add_u32 v12, 3, v11
  v_lshrrev_b32 v13, 1, v12
  v_and_b32 v12, 1, v12
  v_lshl_add_u32 v13, v13, 8, v10
  v_lshl_add_u32 v13, v12, 3, v13
  buffer_store_dwordx2 v[250:251], v13, s[24:27], 0 offen sc1
  v_add_u32 v12, 4, v11
  v_lshrrev_b32 v13, 1, v12
  v_and_b32 v12, 1, v12
  v_lshl_add_u32 v13, v13, 8, v10
  v_lshl_add_u32 v13, v12, 3, v13
  buffer_store_dwordx2 v[252:253], v13, s[24:27], 0 offen sc1
  v_add_u32 v5, 8, v5
  v_add_u32 v7, 20480, v7
  v_add_u32 v8, 10240, v8
  s_add_u32 s59, s59, 1
  s_cmp_lt_u32 s59, 4
  s_cbranch_scc1 ba_371
  s_waitcnt vmcnt(0)
  s_barrier
  s_lshr_b32 s21, s2, 2
  s_lshl_b32 s21, s21, 7
  s_add_u32 s21, s21, 90112
  s_cmp_lg_u32 s20, 0
  s_cbranch_scc1 af_372
  v_mov_b32 v8, 0
  v_mov_b32 v9, 1
  s_mov_b64 exec, 1
  buffer_atomic_add v9, v8, s[72:75], s21 offen sc1
  s_mov_b64 exec, -1
  s_nop 1
af_372:
  s_branch queue
main_fin:
  s_waitcnt vmcnt(0)
main_end:
  s_endpgm
.section .rodata,"a"
.p2align 6
.amdhsa_kernel gated_mix__memory_aug_recurrent_mem_tr__sliding_local_dilated__prompt_kernel
  .amdhsa_next_free_vgpr 512
  .amdhsa_next_free_sgpr 102
  .amdhsa_accum_offset 256
  .amdhsa_group_segment_fixed_size 0
  .amdhsa_kernarg_size 112
  .amdhsa_user_sgpr_count 2
  .amdhsa_user_sgpr_kernarg_segment_ptr 1
  .amdhsa_system_sgpr_workgroup_id_x 1
.end_amdhsa_kernel
.text
```

```asm
; @launch kernel=gated_mix__memory_aug_recurrent_mem_tr__sliding_local_dilated__prompt_kernel grid=(256,1,1) block=(256,1,1) lds=163840
.amdgcn_target "amdgcn-amd-amdhsa--gfx950"
.text
.globl gated_mix__memory_aug_recurrent_mem_tr__sliding_local_dilated__prompt_kernel
.p2align 8
.type gated_mix__memory_aug_recurrent_mem_tr__sliding_local_dilated__prompt_kernel,@function
gated_mix__memory_aug_recurrent_mem_tr__sliding_local_dilated__prompt_kernel:
  s_cmp_ge_u32 s2, 256
  s_cbranch_scc1 end0
  s_load_dwordx2 s[4:5], s[0:1], 96
  s_load_dwordx2 s[38:39], s[0:1], 104
  v_lshrrev_b32 v1, 6, v0
  v_and_b32 v2, 15, v0
  v_readfirstlane_b32 s20, v1
  v_and_b32 v1, 63, v0
  v_lshrrev_b32 v3, 4, v1
  s_getreg_b32 s50, hwreg(HW_REG_XCC_ID)
  s_and_b32 s50, s50, 7
  s_waitcnt lgkmcnt(0)
  s_mov_b32 s32, s4
  s_mov_b32 s33, s5
  s_mov_b32 s34, 256
  s_mov_b32 s35, 0x00020000
  v_mov_b32 v21, 0
  s_cmp_lg_u32 s20, 0
  s_cbranch_scc1 rk_1
  s_and_b32 s21, s50, 1
  s_lshl_b32 s21, s21, 7
  s_lshl_b32 s22, s50, 1
  s_and_b32 s22, s22, 12
  s_add_u32 s21, s21, s22
  v_mov_b32 v22, s21
  v_mov_b32 v23, 1
  s_mov_b64 exec, 1
  buffer_atomic_add v23, v22, s[32:35], 0 offen sc0 sc1
  s_waitcnt vmcnt(0)
  v_readfirstlane_b32 s51, v23
  s_lshl_b32 s22, s50, 5
  s_add_u32 s22, s22, s51
  s_cmp_lt_u32 s51, 32
  s_cbranch_scc1 rk_2
  v_mov_b32 v24, 72
  v_mov_b32 v25, 1
  buffer_atomic_add v25, v24, s[32:35], 0 offen sc0 sc1
  s_waitcnt vmcnt(0)
  v_readfirstlane_b32 s23, v25
  s_mov_b32 s101, 0
  s_mov_b64 exec, -1
  v_lshlrev_b32 v24, 2, v1
rk_3:
  s_sleep 8
  buffer_load_dword v25, v24, s[32:35], 0 offen sc1
  s_add_u32 s101, s101, 1
  s_cmp_gt_u32 s101, 131072
  s_cbranch_scc1 end0
  s_waitcnt vmcnt(0)
  v_readlane_b32 s21, v25, 0
  v_readlane_b32 s22, v25, 32
  s_add_u32 s21, s21, s22
  v_readlane_b32 s22, v25, 1
  s_add_u32 s21, s21, s22
  v_readlane_b32 s22, v25, 33
  s_add_u32 s21, s21, s22
  v_readlane_b32 s22, v25, 2
  s_add_u32 s21, s21, s22
  v_readlane_b32 s22, v25, 34
  s_add_u32 s21, s21, s22
  v_readlane_b32 s22, v25, 3
  s_add_u32 s21, s21, s22
  v_readlane_b32 s22, v25, 35
  s_add_u32 s21, s21, s22
  s_cmp_lt_u32 s21, 256
  s_cbranch_scc1 rk_3
  s_mov_b64 exec, 1
  s_mov_b32 s24, 0
rk_5:
  s_and_b32 s21, s24, 1
  s_lshl_b32 s21, s21, 5
  s_lshr_b32 s22, s24, 1
  s_add_u32 s21, s21, s22
  v_readlane_b32 s21, v25, s21
  s_min_u32 s21, s21, 32
  s_sub_u32 s25, 32, s21
  s_cmp_lt_u32 s23, s25
  s_cbranch_scc1 rk_4
  s_sub_u32 s23, s23, s25
  s_add_u32 s24, s24, 1
  s_cmp_lt_u32 s24, 8
  s_cbranch_scc1 rk_5
  s_branch end0
rk_4:
  s_lshl_b32 s22, s24, 5
  s_add_u32 s22, s22, s21
  s_add_u32 s22, s22, s23
  s_or_b32 s22, s22, 0x100
rk_2:
  v_mov_b32 v23, s22
  ds_write_b32 v21, v23
  s_waitcnt lgkmcnt(0)
  s_mov_b64 exec, -1
rk_1:
  s_barrier
  ds_read_b32 v23, v21
  s_waitcnt lgkmcnt(0)
  v_readfirstlane_b32 s22, v23
  s_barrier
  s_mov_b32 s84, 0
  s_mov_b32 s85, -1
  s_lshr_b32 s53, s22, 8
  s_and_b32 s22, s22, 255
  s_cmp_ge_u32 s22, 128
  s_cbranch_scc1 gemm_side
  s_lshr_b32 s50, s22, 4
  s_and_b32 s51, s22, 15
  s_mov_b32 s86, 0x3dd53b95
  s_load_dwordx2 s[4:5], s[0:1], 8
  s_load_dwordx4 s[40:43], s[0:1], 16
  s_load_dwordx4 s[44:47], s[0:1], 32
  s_load_dwordx2 s[48:49], s[0:1], 104
  s_lshr_b32 s55, s51, 2
  s_and_b32 s56, s51, 3
  s_lshl_b32 s57, s50, 2
  s_add_u32 s58, s57, s55
  s_add_u32 s59, s57, s20
  s_lshr_b32 s60, s51, 1
  s_and_b32 s61, s51, 1
  s_mul_i32 s81, s20, 40448
  v_lshlrev_b32 v4, 4, v1
  s_waitcnt lgkmcnt(0)
  s_mov_b32 s12, s44
  s_mov_b32 s13, s45
  s_mov_b32 s14, 7864320
  s_mov_b32 s15, 0x00020000
  s_mov_b32 s16, s46
  s_mov_b32 s17, s47
  s_mov_b32 s18, 7864320
  s_mov_b32 s19, 0x00020000
  s_mov_b32 s24, s40
  s_mov_b32 s25, s41
  s_mov_b32 s26, 7864320
  s_mov_b32 s27, 0x00020000
  s_mov_b32 s28, s42
  s_mov_b32 s29, s43
  s_mov_b32 s30, 7864320
  s_mov_b32 s31, 0x00020000
  s_mov_b32 s36, s4
  s_mov_b32 s37, s5
  s_mov_b32 s38, 10240
  s_mov_b32 s39, 0x00020000
  s_add_u32 s8, s48, 78643200
  s_addc_u32 s9, s49, 0
  s_mov_b32 s10, 491520
  s_mov_b32 s11, 0x00020000
  s_add_u32 s4, s48, 83886079
  s_addc_u32 s5, s49, 0
  s_and_b32 s4, s4, 0xffe00000
  s_mov_b32 s6, 2097152
  s_mov_b32 s7, 0x00020000
  v_add_u32 v66, 0, v1
  v_mul_u32_u24 v67, 2731, v66
  v_lshrrev_b32 v67, 16, v67
  v_mul_u32_u24 v48, 24, v67
  v_sub_u32 v66, v66, v48
  v_mul_u32_u24 v67, 12288, v67
  v_lshl_add_u32 v48, v66, 4, v67
  v_add_u32 v66, 64, v1
  v_mul_u32_u24 v67, 2731, v66
  v_lshrrev_b32 v67, 16, v67
  v_mul_u32_u24 v49, 24, v67
  v_sub_u32 v66, v66, v49
  v_mul_u32_u24 v67, 12288, v67
  v_lshl_add_u32 v49, v66, 4, v67
  v_add_u32 v66, 128, v1
  v_mul_u32_u24 v67, 2731, v66
  v_lshrrev_b32 v67, 16, v67
  v_mul_u32_u24 v50, 24, v67
  v_sub_u32 v66, v66, v50
  v_mul_u32_u24 v67, 12288, v67
  v_lshl_add_u32 v50, v66, 4, v67
  s_mul_i32 s21, s51, 491520
  s_mul_i32 s80, s59, 384
  s_add_u32 s21, s21, s80
  buffer_load_dwordx4 v[248:251], v48, s[12:15], s21 offen
  buffer_load_dwordx4 v[248:251], v49, s[12:15], s21 offen
  buffer_load_dwordx4 v[248:251], v50, s[12:15], s21 offen
  s_add_u32 s21, s21, 98304
  buffer_load_dwordx4 v[248:251], v48, s[12:15], s21 offen
  buffer_load_dwordx4 v[248:251], v49, s[12:15], s21 offen
  buffer_load_dwordx4 v[248:251], v50, s[12:15], s21 offen
  s_add_u32 s21, s21, 98304
  buffer_load_dwordx4 v[248:251], v48, s[12:15], s21 offen
  buffer_load_dwordx4 v[248:251], v49, s[12:15], s21 offen
  buffer_load_dwordx4 v[248:251], v50, s[12:15], s21 offen
  s_add_u32 s21, s21, 98304
  buffer_load_dwordx4 v[248:251], v48, s[12:15], s21 offen
  buffer_load_dwordx4 v[248:251], v49, s[12:15], s21 offen
  buffer_load_dwordx4 v[248:251], v50, s[12:15], s21 offen
  s_add_u32 s21, s21, 98304
  buffer_load_dwordx4 v[248:251], v48, s[12:15], s21 offen
  buffer_load_dwordx4 v[248:251], v49, s[12:15], s21 offen
  buffer_load_dwordx4 v[248:251], v50, s[12:15], s21 offen
  s_add_u32 s21, s21, 98304
  v_add_u32 v66, 0, v1
  v_mul_u32_u24 v67, 10923, v66
  v_lshrrev_b32 v67, 16, v67
  v_mul_u32_u24 v60, 6, v67
  v_sub_u32 v66, v66, v60
  v_mul_u32_u24 v67, 1280, v67
  v_lshl_add_u32 v60, v66, 4, v67
  v_add_u32 v66, 64, v1
  v_mul_u32_u24 v67, 10923, v66
  v_lshrrev_b32 v67, 16, v67
  v_mul_u32_u24 v61, 6, v67
  v_sub_u32 v66, v66, v61
  v_mul_u32_u24 v67, 1280, v67
  v_lshl_add_u32 v61, v66, 4, v67
  v_add_u32 v66, 128, v1
  v_mul_u32_u24 v67, 10923, v66
  v_lshrrev_b32 v67, 16, v67
  v_mul_u32_u24 v62, 6, v67
  v_sub_u32 v66, v66, v62
  v_mul_u32_u24 v67, 1280, v67
  v_lshl_add_u32 v62, v66, 4, v67
  s_mul_i32 s21, s59, 245760
  s_mul_i32 s22, s60, 160
  s_add_u32 s21, s21, s22
  s_lshl_b32 s22, s61, 6
  s_add_u32 s21, s21, s22
  s_add_u32 m0, s81, 0
  s_nop 0
  buffer_load_dwordx4 v60, s[16:19], s21 offen lds
  s_add_u32 m0, s81, 1024
  s_nop 0
  buffer_load_dwordx4 v61, s[16:19], s21 offen lds
  s_add_u32 m0, s81, 2048
  s_nop 0
  buffer_load_dwordx4 v62, s[16:19], s21 offen lds
  s_add_u32 s21, s21, 40960
  s_add_u32 m0, s81, 3072
  s_nop 0
  buffer_load_dwordx4 v60, s[16:19], s21 offen lds
  s_add_u32 m0, s81, 4096
  s_nop 0
  buffer_load_dwordx4 v61, s[16:19], s21 offen lds
  s_add_u32 m0, s81, 5120
  s_nop 0
  buffer_load_dwordx4 v62, s[16:19], s21 offen lds
  s_add_u32 s21, s21, 40960
  s_add_u32 m0, s81, 6144
  s_nop 0
  buffer_load_dwordx4 v60, s[16:19], s21 offen lds
  s_add_u32 m0, s81, 7168
  s_nop 0
  buffer_load_dwordx4 v61, s[16:19], s21 offen lds
  s_add_u32 m0, s81, 8192
  s_nop 0
  buffer_load_dwordx4 v62, s[16:19], s21 offen lds
  s_add_u32 s21, s21, 40960
  s_add_u32 m0, s81, 9216
  s_nop 0
  buffer_load_dwordx4 v60, s[16:19], s21 offen lds
  s_add_u32 m0, s81, 10240
  s_nop 0
  buffer_load_dwordx4 v61, s[16:19], s21 offen lds
  s_add_u32 m0, s81, 11264
  s_nop 0
  buffer_load_dwordx4 v62, s[16:19], s21 offen lds
  s_add_u32 s21, s21, 40960
  s_add_u32 m0, s81, 12288
  s_nop 0
  buffer_load_dwordx4 v60, s[16:19], s21 offen lds
  s_add_u32 m0, s81, 13312
  s_nop 0
  buffer_load_dwordx4 v61, s[16:19], s21 offen lds
  s_add_u32 m0, s81, 14336
  s_nop 0
  buffer_load_dwordx4 v62, s[16:19], s21 offen lds
  s_add_u32 s21, s21, 40960
  s_add_u32 m0, s81, 15360
  s_nop 0
  buffer_load_dwordx4 v60, s[16:19], s21 offen lds
  s_add_u32 m0, s81, 16384
  s_nop 0
  buffer_load_dwordx4 v61, s[16:19], s21 offen lds
  s_add_u32 m0, s81, 17408
  s_nop 0
  buffer_load_dwordx4 v62, s[16:19], s21 offen lds
  s_add_u32 s21, s21, 40960
  v_add_u32 v66, 0, v1
  v_mul_u32_u24 v67, 2731, v66
  v_lshrrev_b32 v67, 16, v67
  v_mul_u32_u24 v48, 24, v67
  v_sub_u32 v66, v66, v48
  v_lshrrev_b32 v48, 2, v67
  v_lshlrev_b32 v48, 1, v48
  v_or_b32 v48, 0, v48
  v_xor_b32 v66, v66, v48
  v_add_u32 v67, 0, v67
  v_mul_u32_u24 v67, 12288, v67
  v_lshl_add_u32 v48, v66, 4, v67
  v_add_u32 v66, 64, v1
  v_mul_u32_u24 v67, 2731, v66
  v_lshrrev_b32 v67, 16, v67
  v_mul_u32_u24 v49, 24, v67
  v_sub_u32 v66, v66, v49
  v_lshrrev_b32 v49, 2, v67
  v_lshlrev_b32 v49, 1, v49
  v_or_b32 v49, 0, v49
  v_xor_b32 v66, v66, v49
  v_add_u32 v67, 0, v67
  v_mul_u32_u24 v67, 12288, v67
  v_lshl_add_u32 v49, v66, 4, v67
  v_add_u32 v66, 128, v1
  v_mul_u32_u24 v67, 2731, v66
  v_lshrrev_b32 v67, 16, v67
  v_mul_u32_u24 v50, 24, v67
  v_sub_u32 v66, v66, v50
  v_lshrrev_b32 v50, 2, v67
  v_lshlrev_b32 v50, 1, v50
  v_or_b32 v50, 0, v50
  v_xor_b32 v66, v66, v50
  v_add_u32 v67, 0, v67
  v_mul_u32_u24 v67, 12288, v67
  v_lshl_add_u32 v50, v66, 4, v67
  v_add_u32 v66, 0, v1
  v_mul_u32_u24 v67, 2731, v66
  v_lshrrev_b32 v67, 16, v67
  v_mul_u32_u24 v51, 24, v67
  v_sub_u32 v66, v66, v51
  v_lshrrev_b32 v51, 2, v67
  v_lshlrev_b32 v51, 1, v51
  v_or_b32 v51, 1, v51
  v_xor_b32 v66, v66, v51
  v_add_u32 v67, 8, v67
  v_mul_u32_u24 v67, 12288, v67
  v_lshl_add_u32 v51, v66, 4, v67
  v_add_u32 v66, 64, v1
  v_mul_u32_u24 v67, 2731, v66
  v_lshrrev_b32 v67, 16, v67
  v_mul_u32_u24 v52, 24, v67
  v_sub_u32 v66, v66, v52
  v_lshrrev_b32 v52, 2, v67
  v_lshlrev_b32 v52, 1, v52
  v_or_b32 v52, 1, v52
  v_xor_b32 v66, v66, v52
  v_add_u32 v67, 8, v67
  v_mul_u32_u24 v67, 12288, v67
  v_lshl_add_u32 v52, v66, 4, v67
  v_add_u32 v66, 128, v1
  v_mul_u32_u24 v67, 2731, v66
  v_lshrrev_b32 v67, 16, v67
  v_mul_u32_u24 v53, 24, v67
  v_sub_u32 v66, v66, v53
  v_lshrrev_b32 v53, 2, v67
  v_lshlrev_b32 v53, 1, v53
  v_or_b32 v53, 1, v53
  v_xor_b32 v66, v66, v53
  v_add_u32 v67, 8, v67
  v_mul_u32_u24 v67, 12288, v67
  v_lshl_add_u32 v53, v66, 4, v67
  v_add_u32 v66, 0, v1
  v_mul_u32_u24 v67, 2731, v66
  v_lshrrev_b32 v67, 16, v67
  v_mul_u32_u24 v54, 24, v67
  v_sub_u32 v66, v66, v54
  v_lshrrev_b32 v54, 2, v67
  v_lshlrev_b32 v54, 1, v54
  v_or_b32 v54, 4, v54
  v_xor_b32 v66, v66, v54
  v_add_u32 v67, 16, v67
  v_mul_u32_u24 v67, 12288, v67
  v_lshl_add_u32 v54, v66, 4, v67
  v_add_u32 v66, 64, v1
  v_mul_u32_u24 v67, 2731, v66
  v_lshrrev_b32 v67, 16, v67
  v_mul_u32_u24 v55, 24, v67
  v_sub_u32 v66, v66, v55
  v_lshrrev_b32 v55, 2, v67
  v_lshlrev_b32 v55, 1, v55
  v_or_b32 v55, 4, v55
  v_xor_b32 v66, v66, v55
  v_add_u32 v67, 16, v67
  v_mul_u32_u24 v67, 12288, v67
  v_lshl_add_u32 v55, v66, 4, v67
  v_add_u32 v66, 128, v1
  v_mul_u32_u24 v67, 2731, v66
  v_lshrrev_b32 v67, 16, v67
  v_mul_u32_u24 v56, 24, v67
  v_sub_u32 v66, v66, v56
  v_lshrrev_b32 v56, 2, v67
  v_lshlrev_b32 v56, 1, v56
  v_or_b32 v56, 4, v56
  v_xor_b32 v66, v66, v56
  v_add_u32 v67, 16, v67
  v_mul_u32_u24 v67, 12288, v67
  v_lshl_add_u32 v56, v66, 4, v67
  v_add_u32 v66, 0, v1
  v_mul_u32_u24 v67, 2731, v66
  v_lshrrev_b32 v67, 16, v67
  v_mul_u32_u24 v57, 24, v67
  v_sub_u32 v66, v66, v57
  v_lshrrev_b32 v57, 2, v67
  v_lshlrev_b32 v57, 1, v57
  v_or_b32 v57, 5, v57
  v_xor_b32 v66, v66, v57
  v_add_u32 v67, 24, v67
  v_mul_u32_u24 v67, 12288, v67
  v_lshl_add_u32 v57, v66, 4, v67
  v_add_u32 v66, 64, v1
  v_mul_u32_u24 v67, 2731, v66
  v_lshrrev_b32 v67, 16, v67
  v_mul_u32_u24 v58, 24, v67
  v_sub_u32 v66, v66, v58
  v_lshrrev_b32 v58, 2, v67
  v_lshlrev_b32 v58, 1, v58
  v_or_b32 v58, 5, v58
  v_xor_b32 v66, v66, v58
  v_add_u32 v67, 24, v67
  v_mul_u32_u24 v67, 12288, v67
  v_lshl_add_u32 v58, v66, 4, v67
  v_add_u32 v66, 128, v1
  v_mul_u32_u24 v67, 2731, v66
  v_lshrrev_b32 v67, 16, v67
  v_mul_u32_u24 v59, 24, v67
  v_sub_u32 v66, v66, v59
  v_lshrrev_b32 v59, 2, v67
  v_lshlrev_b32 v59, 1, v59
  v_or_b32 v59, 5, v59
  v_xor_b32 v66, v66, v59
  v_add_u32 v67, 24, v67
  v_mul_u32_u24 v67, 12288, v67
  v_lshl_add_u32 v59, v66, 4, v67
  s_add_u32 m0, s81, 24576
  s_nop 0
  buffer_load_dwordx4 v48, s[12:15], s80 offen lds
  s_add_u32 m0, s81, 25600
  s_nop 0
  buffer_load_dwordx4 v49, s[12:15], s80 offen lds
  s_add_u32 m0, s81, 26624
  s_nop 0
  buffer_load_dwordx4 v50, s[12:15], s80 offen lds
  s_add_u32 m0, s81, 27648
  s_nop 0
  buffer_load_dwordx4 v51, s[12:15], s80 offen lds
  s_add_u32 m0, s81, 28672
  s_nop 0
  buffer_load_dwordx4 v52, s[12:15], s80 offen lds
  s_add_u32 m0, s81, 29696
  s_nop 0
  buffer_load_dwordx4 v53, s[12:15], s80 offen lds
  s_add_u32 m0, s81, 30720
  s_nop 0
  buffer_load_dwordx4 v54, s[12:15], s80 offen lds
  s_add_u32 m0, s81, 31744
  s_nop 0
  buffer_load_dwordx4 v55, s[12:15], s80 offen lds
  s_add_u32 m0, s81, 32768
  s_nop 0
  buffer_load_dwordx4 v56, s[12:15], s80 offen lds
  s_add_u32 m0, s81, 33792
  s_nop 0
  buffer_load_dwordx4 v57, s[12:15], s80 offen lds
  s_add_u32 m0, s81, 34816
  s_nop 0
  buffer_load_dwordx4 v58, s[12:15], s80 offen lds
  s_add_u32 m0, s81, 35840
  s_nop 0
  buffer_load_dwordx4 v59, s[12:15], s80 offen lds
  s_add_u32 s80, s80, 393216
  v_add_u32 v66, 0, v1
  v_mul_u32_u24 v67, 10923, v66
  v_lshrrev_b32 v67, 16, v67
  v_mul_u32_u24 v63, 6, v67
  v_sub_u32 v66, v66, v63
  v_mul_u32_u24 v67, 12288, v67
  v_lshl_add_u32 v63, v66, 4, v67
  v_add_u32 v66, 64, v1
  v_mul_u32_u24 v67, 10923, v66
  v_lshrrev_b32 v67, 16, v67
  v_mul_u32_u24 v64, 6, v67
  v_sub_u32 v66, v66, v64
  v_mul_u32_u24 v67, 12288, v67
  v_lshl_add_u32 v64, v66, 4, v67
  v_add_u32 v66, 128, v1
  v_mul_u32_u24 v67, 10923, v66
  v_lshrrev_b32 v67, 16, v67
  v_mul_u32_u24 v65, 6, v67
  v_sub_u32 v66, v66, v65
  v_mul_u32_u24 v67, 12288, v67
  v_lshl_add_u32 v65, v66, 4, v67
  s_mul_i32 s79, s58, 384
  s_mul_i32 s22, s56, 96
  s_add_u32 s79, s79, s22
  s_mul_i32 s22, s20, 1966080
  s_add_u32 s79, s79, s22
  v_and_b32 v224, 7, v2
  v_lshrrev_b32 v225, 3, v2
  v_lshlrev_b32 v12, 3, v1
  v_mov_b32 v23, 0
  v_mov_b32 v226, 0x4444
  v_mov_b32 v227, 0xeeee
  v_cmp_eq_u32 vcc, 1, v225
  v_cmp_gt_u32 s[62:63], 8, v2
  v_cmp_le_u32 s[68:69], 8, v2
  v_cndmask_b32 v22, v226, v227, vcc
  v_cmp_gt_u32 vcc, 32, v1
  v_mov_b32 v226, 0x3dd53b95
  v_cmp_gt_u32 s[66:67], 40, v1
  v_cndmask_b32 v24, 1.0, v226, vcc
  v_cndmask_b32 v25, 1.0, v226, vcc
  v_min_u32 v226, 39, v1
  v_and_b32 v227, 31, v1
  v_lshlrev_b32 v227, 2, v227
  v_lshl_add_u32 v5, v226, 7, v227
  v_mul_u32_u24 v226, 192, v3
  v_lshl_add_u32 v226, v2, 3, v226
  s_mul_i32 s21, s20, 768
  s_add_u32 s21, s21, 10240
  v_add_u32 v6, s21, v226
  v_and_b32 v226, 3, v2
  v_mul_u32_u24 v226, 192, v226
  v_lshrrev_b32 v227, 2, v2
  v_lshl_add_u32 v227, v3, 2, v227
  v_lshl_add_u32 v226, v227, 3, v226
  v_add_u32 v7, 10240, v226
  s_mul_i32 s21, s58, 2560
  s_add_u32 s21, s21, 40960
  s_lshr_b32 s22, s56, 1
  s_lshl_b32 s22, s22, 10
  s_and_b32 s23, s56, 1
  s_lshl_b32 s23, s23, 3
  s_add_u32 s22, s22, s23
  s_lshl_b32 s23, s20, 7
  s_add_u32 s22, s22, s23
  s_add_u32 s22, s22, s21
  v_lshlrev_b32 v226, 8, v3
  v_lshl_add_u32 v226, v224, 4, v226
  v_add_u32 v8, s22, v226
  s_lshl_b32 s22, s56, 2
  s_add_u32 s22, s22, s21
  s_add_u32 s22, s22, 2048
  v_and_b32 v226, 0x1ff, v226
  v_add_u32 v226, s22, v226
  s_cmp_eq_u32 s20, 2
  s_cselect_b64 vcc, -1, 0
  v_cmp_le_u32 s[64:65], 32, v1
  v_cndmask_b32 v8, v8, v226, vcc
  s_cselect_b64 s[64:65], s[64:65], -1
  s_and_b64 s[64:65], s[64:65], s[62:63]
  s_mul_i32 s21, s59, 2560
  s_add_u32 s21, s21, 40960
  v_add_u32 v9, s21, v4
  v_and_b32 v226, 0x1ff, v4
  s_add_u32 s21, s21, 2048
  v_add_u32 v10, s21, v226
  v_lshrrev_b32 v226, 2, v2
  v_and_b32 v227, 1, v2
  v_lshl_add_u32 v228, v226, 1, v227
  v_and_b32 v227, 2, v2
  v_cmp_eq_u32 vcc, 0, v227
  s_lshr_b32 s21, s20, 1
  s_lshl_b32 s21, s21, 9
  s_and_b32 s22, s20, 1
  s_lshl_b32 s22, s22, 6
  s_add_u32 s21, s21, s22
  s_add_u32 s21, s21, 12544
  v_lshlrev_b32 v226, 7, v3
  v_lshl_add_u32 v226, v228, 3, v226
  v_add_u32 v226, s21, v226
  v_mov_b32 v227, 13568
  v_cndmask_b32 v11, v227, v226, vcc
  s_lshl_b32 s21, s20, 9
  s_add_u32 s21, s21, 40960
  v_lshlrev_b32 v226, 7, v3
  v_lshl_add_u32 v226, v228, 4, v226
  v_add_u32 v226, s21, v226
  v_mov_b32 v227, 46080
  v_cndmask_b32 v19, v227, v226, vcc
  s_lshl_b32 s21, s20, 11
  s_add_u32 s21, s21, 32768
  v_add_u32 v18, s21, v4
  s_and_b32 s21, s20, 1
  s_lshl_b32 s22, s21, 10
  s_add_u32 s22, s22, 43008
  v_add_u32 v20, s22, v4
  s_lshl_b32 s22, s21, 3
  s_add_u32 s22, s22, 45056
  v_add_u32 v21, s22, v4
  s_mul_i32 s21, s20, 640
  s_add_u32 s22, s21, 13824
  v_lshlrev_b32 v226, 4, v224
  v_lshl_add_u32 v227, v3, 7, v226
  v_add_u32 v13, s22, v227
  v_lshl_add_u32 v227, v3, 2, v226
  s_add_u32 s22, s22, 512
  v_add_u32 v14, s22, v227
  v_and_b32 v226, 0x1ff, v4
  v_lshrrev_b32 v228, 5, v1
  v_lshl_add_u32 v226, v228, 3, v226
  s_add_u32 s22, s21, 16384
  v_add_u32 v26, s22, v226
  v_lshl_add_u32 v228, v228, 1, v225
  v_mul_u32_u24 v228, 640, v228
  v_and_b32 v226, 1, v3
  v_lshl_add_u32 v228, v226, 6, v228
  v_lshl_add_u32 v228, v224, 3, v228
  v_add_u32 v43, 16896, v228
  s_and_b32 s21, s50, 1
  s_lshl_b32 s21, s21, 4
  s_add_u32 s21, s21, s51
  s_lshl_b32 s22, s20, 5
  s_add_u32 s21, s21, s22
  s_cmp_lt_u32 s21, 80
  s_cselect_b32 s78, 1, 0
  s_cselect_b32 s21, s21, 0
  s_lshl_b32 s22, s21, 7
  v_add_u32 v17, s22, v227
  s_lshr_b32 s22, s21, 3
  s_lshl_b32 s22, s22, 14
  s_and_b32 s21, s21, 7
  s_lshl_b32 s21, s21, 10
  s_add_u32 s21, s21, s22
  v_add_u32 v16, s21, v4
  s_mul_i32 s21, s60, 10
  s_mul_i32 s22, s61, 6
  s_add_u32 s22, s22, s21
  s_add_u32 s21, s21, s61
  s_add_u32 s21, s21, 4
  v_lshrrev_b32 v226, 3, v1
  v_cmp_gt_u32 vcc, 4, v226
  v_add_u32 v226, s22, v226
  v_mov_b32 v227, s21
  v_cndmask_b32 v226, v227, v226, vcc
  v_lshrrev_b32 v227, 3, v226
  v_lshlrev_b32 v227, 14, v227
  v_and_b32 v226, 7, v226
  v_lshl_add_u32 v226, v226, 10, v227
  v_lshl_add_u32 v226, v224, 4, v226
  s_lshl_b32 s21, s50, 7
  v_add_u32 v15, s21, v226
  v_and_b32 v226, 1, v2
  v_lshlrev_b32 v226, 4, v226
  v_mov_b32 v227, 0x3c00
  v_lshlrev_b32 v226, v226, v227
  v_lshrrev_b32 v227, 1, v2
  v_cmp_eq_u32 vcc, 0, v227
  s_nop 1
  v_cndmask_b32 v44, 0, v226, vcc
  v_cmp_eq_u32 vcc, 2, v227
  s_nop 1
  v_cndmask_b32 v45, 0, v226, vcc
  v_cmp_eq_u32 vcc, 4, v227
  s_nop 1
  v_cndmask_b32 v46, 0, v226, vcc
  v_cmp_eq_u32 vcc, 6, v227
  s_nop 1
  v_cndmask_b32 v47, 0, v226, vcc
  v_lshrrev_b32 v226, 5, v1
  v_mul_u32_u24 v226, 40960, v226
  v_bfe_u32 v227, v1, 3, 2
  v_lshl_add_u32 v226, v227, 8, v226
  v_lshl_add_u32 v226, v224, 4, v226
  s_lshl_b32 s21, s61, 7
  v_add_u32 v32, s21, v226
  s_mul_i32 s21, s56, 768
  v_lshlrev_b32 v226, 4, v224
  v_lshl_add_u32 v227, v3, 7, v226
  v_add_u32 v36, s21, v227
  v_lshrrev_b32 v227, 1, v227
  s_add_u32 s21, s21, 512
  v_add_u32 v37, s21, v227
  v_and_b32 v41, 3, v1
  v_lshlrev_b32 v41, 7, v41
  v_add_u32 v226, 0, v1
  v_mul_u32_u24 v227, 1639, v226
  v_lshrrev_b32 v227, 16, v227
  v_mul_u32_u24 v38, 40, v227
  v_sub_u32 v226, v226, v38
  v_mul_u32_u24 v227, 10240, v227
  v_lshl_add_u32 v38, v226, 4, v227
  v_add_u32 v226, 64, v1
  v_mul_u32_u24 v227, 1639, v226
  v_lshrrev_b32 v227, 16, v227
  v_mul_u32_u24 v39, 40, v227
  v_sub_u32 v226, v226, v39
  v_mul_u32_u24 v227, 10240, v227
  v_lshl_add_u32 v39, v226, 4, v227
  v_add_u32 v226, 128, v1
  v_mul_u32_u24 v227, 1639, v226
  v_lshrrev_b32 v227, 16, v227
  v_mul_u32_u24 v40, 40, v227
  v_sub_u32 v226, v226, v40
  v_mul_u32_u24 v227, 10240, v227
  v_lshl_add_u32 v40, v226, 4, v227
  v_mov_b32 v28, -1
  v_mov_b32 v29, -1
  v_mov_b32 v30, -1
  v_mov_b32 v31, -1
  s_lshr_b32 s21, s50, 1
  s_mul_i32 s77, s21, 10240
  s_cmp_eq_u32 s20, 3
  s_cbranch_scc1 ar_8
  s_mov_b64 exec, s[64:65]
  s_cmp_eq_u32 s20, 2
  s_cbranch_scc1 ar_7
  s_mov_b32 s21, 0
  buffer_store_dwordx2 v[28:29], v8, s[8:11], s21 offen
  s_mov_b32 s21, 122880
  buffer_store_dwordx2 v[28:29], v8, s[8:11], s21 offen
  s_mov_b32 s21, 245760
  buffer_store_dwordx2 v[28:29], v8, s[8:11], s21 offen
  s_mov_b32 s21, 368640
  buffer_store_dwordx2 v[28:29], v8, s[8:11], s21 offen
  s_branch ar_9
ar_7:
  s_mov_b32 s21, 0
  buffer_store_dword v28, v8, s[8:11], s21 offen
  buffer_store_dword v28, v8, s[8:11], s21 offen offset:128
  s_mov_b32 s21, 122880
  buffer_store_dword v28, v8, s[8:11], s21 offen
  buffer_store_dword v28, v8, s[8:11], s21 offen offset:128
  s_mov_b32 s21, 245760
  buffer_store_dword v28, v8, s[8:11], s21 offen
  buffer_store_dword v28, v8, s[8:11], s21 offen offset:128
  s_mov_b32 s21, 368640
  buffer_store_dword v28, v8, s[8:11], s21 offen
  buffer_store_dword v28, v8, s[8:11], s21 offen offset:128
ar_9:
  s_cmp_eq_u32 s78, 0
  s_cbranch_scc1 ar_10
  s_mov_b64 exec, s[62:63]
  s_add_u32 s21, s77, 0
  buffer_store_dword v28, v17, s[8:11], s21 offen
  s_add_u32 s21, s77, 122880
  buffer_store_dword v28, v17, s[8:11], s21 offen
  s_add_u32 s21, s77, 245760
  buffer_store_dword v28, v17, s[8:11], s21 offen
  s_add_u32 s21, s77, 368640
  buffer_store_dword v28, v17, s[8:11], s21 offen
  s_branch ar_10
ar_8:
  s_mov_b64 exec, s[66:67]
  s_mov_b32 s21, 0
  buffer_store_dwordx4 v[28:31], v15, s[4:7], s21 offen sc1
  s_mov_b32 s21, 524288
  buffer_store_dwordx4 v[28:31], v15, s[4:7], s21 offen sc1
  s_mov_b32 s21, 8192
  buffer_store_dwordx4 v[28:31], v15, s[4:7], s21 offen sc1
  s_mov_b32 s21, 532480
  buffer_store_dwordx4 v[28:31], v15, s[4:7], s21 offen sc1
ar_10:
  s_mov_b64 exec, -1
  v_lshrrev_b32 v66, 2, v2
  v_lshl_add_u32 v66, v3, 3, v66
  v_mul_u32_u24 v66, 96, v66
  v_add_u32 v66, s81, v66
  v_and_b32 v67, 3, v2
  s_lshl_b32 s21, s61, 5
  v_lshl_add_u32 v68, v67, 4, v66
  v_add_u32 v68, s21, v68
  s_mul_i32 s21, s61, 48
  s_sub_u32 s21, 64, s21
  v_and_b32 v67, 1, v2
  v_lshl_add_u32 v69, v67, 3, v66
  v_add_u32 v69, s21, v69
  v_lshrrev_b32 v226, 3, v2
  v_lshlrev_b32 v226, 4, v226
  v_bfe_u32 v227, v2, 1, 1
  v_lshl_add_u32 v226, v227, 3, v226
  v_and_b32 v227, 5, v2
  v_add_u32 v226, v226, v227
  v_mul_u32_u24 v226, 384, v226
  v_add_u32 v226, s81, v226
  v_lshrrev_b32 v227, 1, v2
  v_xor_b32 v227, v227, v3
  v_lshl_add_u32 v70, v227, 4, v226
  v_xor_b32 v227, 4, v227
  v_lshl_add_u32 v71, v227, 4, v226
  s_waitcnt vmcnt(0)
  ds_read_b64_tr_b16 v[72:73], v68 offset:0
  ds_read_b64_tr_b16 v[74:75], v68 offset:384
  ds_read_b64_tr_b16 v[76:77], v68 offset:8
  ds_read_b64_tr_b16 v[78:79], v68 offset:392
  ds_read_b64_tr_b16 v[80:81], v69 offset:0
  ds_read_b64_tr_b16 v[82:83], v69 offset:384
  ds_read_b64_tr_b16 v[84:85], v68 offset:3072
  ds_read_b64_tr_b16 v[86:87], v68 offset:3456
  ds_read_b64_tr_b16 v[88:89], v68 offset:3080
  ds_read_b64_tr_b16 v[90:91], v68 offset:3464
  ds_read_b64_tr_b16 v[92:93], v69 offset:3072
  ds_read_b64_tr_b16 v[94:95], v69 offset:3456
  ds_read_b64_tr_b16 v[96:97], v68 offset:6144
  ds_read_b64_tr_b16 v[98:99], v68 offset:6528
  ds_read_b64_tr_b16 v[100:101], v68 offset:6152
  ds_read_b64_tr_b16 v[102:103], v68 offset:6536
  ds_read_b64_tr_b16 v[104:105], v69 offset:6144
  ds_read_b64_tr_b16 v[106:107], v69 offset:6528
  ds_read_b64_tr_b16 v[108:109], v68 offset:9216
  ds_read_b64_tr_b16 v[110:111], v68 offset:9600
  ds_read_b64_tr_b16 v[112:113], v68 offset:9224
  ds_read_b64_tr_b16 v[114:115], v68 offset:9608
  ds_read_b64_tr_b16 v[116:117], v69 offset:9216
  ds_read_b64_tr_b16 v[118:119], v69 offset:9600
  ds_read_b64_tr_b16 v[120:121], v68 offset:12288
  ds_read_b64_tr_b16 v[122:123], v68 offset:12672
  ds_read_b64_tr_b16 v[124:125], v68 offset:12296
  ds_read_b64_tr_b16 v[126:127], v68 offset:12680
  ds_read_b64_tr_b16 v[128:129], v69 offset:12288
  ds_read_b64_tr_b16 v[130:131], v69 offset:12672
  ds_read_b64_tr_b16 v[132:133], v68 offset:15360
  ds_read_b64_tr_b16 v[134:135], v68 offset:15744
  ds_read_b64_tr_b16 v[136:137], v68 offset:15368
  ds_read_b64_tr_b16 v[138:139], v68 offset:15752
  ds_read_b64_tr_b16 v[140:141], v69 offset:15360
  ds_read_b64_tr_b16 v[142:143], v69 offset:15744
  s_waitcnt lgkmcnt(0)
  s_barrier
  s_cmp_lg_u32 s20, 0
  s_cbranch_scc1 ic_11
  v_mov_b32 v68, 64
  v_mov_b32 v69, 1
  s_mov_b64 exec, 1
  buffer_atomic_add v69, v68, s[32:35], 0 offen sc1
  s_mov_b64 exec, -1
ic_11:
  s_add_u32 m0, s81, 0
  s_nop 0
  buffer_load_dwordx4 v48, s[12:15], s80 offen lds
  s_add_u32 m0, s81, 1024
  s_nop 0
  buffer_load_dwordx4 v49, s[12:15], s80 offen lds
  s_add_u32 m0, s81, 2048
  s_nop 0
  buffer_load_dwordx4 v50, s[12:15], s80 offen lds
  s_add_u32 m0, s81, 3072
  s_nop 0
  buffer_load_dwordx4 v51, s[12:15], s80 offen lds
  s_add_u32 m0, s81, 4096
  s_nop 0
  buffer_load_dwordx4 v52, s[12:15], s80 offen lds
  s_add_u32 m0, s81, 5120
  s_nop 0
  buffer_load_dwordx4 v53, s[12:15], s80 offen lds
  s_add_u32 m0, s81, 6144
  s_nop 0
  buffer_load_dwordx4 v54, s[12:15], s80 offen lds
  s_add_u32 m0, s81, 7168
  s_nop 0
  buffer_load_dwordx4 v55, s[12:15], s80 offen lds
  s_add_u32 m0, s81, 8192
  s_nop 0
  buffer_load_dwordx4 v56, s[12:15], s80 offen lds
  s_add_u32 m0, s81, 9216
  s_nop 0
  buffer_load_dwordx4 v57, s[12:15], s80 offen lds
  s_add_u32 m0, s81, 10240
  s_nop 0
  buffer_load_dwordx4 v58, s[12:15], s80 offen lds
  s_add_u32 m0, s81, 11264
  s_nop 0
  buffer_load_dwordx4 v59, s[12:15], s80 offen lds
  s_add_u32 s80, s80, 393216
  s_add_u32 s21, s79, 0
  buffer_load_dwordx4 a[160:163], v63, s[24:27], s21 offen
  buffer_load_dwordx4 a[164:167], v64, s[24:27], s21 offen
  buffer_load_dwordx4 a[168:171], v65, s[24:27], s21 offen
  s_add_u32 s21, s79, 393216
  buffer_load_dwordx4 a[172:175], v63, s[24:27], s21 offen
  buffer_load_dwordx4 a[176:179], v64, s[24:27], s21 offen
  buffer_load_dwordx4 a[180:183], v65, s[24:27], s21 offen
  s_add_u32 s21, s79, 786432
  buffer_load_dwordx4 a[184:187], v63, s[24:27], s21 offen
  buffer_load_dwordx4 a[188:191], v64, s[24:27], s21 offen
  buffer_load_dwordx4 a[192:195], v65, s[24:27], s21 offen
  s_add_u32 s21, s79, 1179648
  buffer_load_dwordx4 a[196:199], v63, s[24:27], s21 offen
  buffer_load_dwordx4 a[200:203], v64, s[24:27], s21 offen
  buffer_load_dwordx4 a[204:207], v65, s[24:27], s21 offen
  s_add_u32 s21, s79, 1572864
  buffer_load_dwordx4 a[208:211], v63, s[24:27], s21 offen
  buffer_load_dwordx4 a[212:215], v64, s[24:27], s21 offen
  buffer_load_dwordx4 a[216:219], v65, s[24:27], s21 offen
  s_add_u32 s21, s79, 0
  buffer_load_dwordx4 a[220:223], v63, s[28:31], s21 offen
  buffer_load_dwordx4 a[224:227], v64, s[28:31], s21 offen
  buffer_load_dwordx4 a[228:231], v65, s[28:31], s21 offen
  s_add_u32 s21, s79, 393216
  buffer_load_dwordx4 a[232:235], v63, s[28:31], s21 offen
  buffer_load_dwordx4 a[236:239], v64, s[28:31], s21 offen
  buffer_load_dwordx4 a[240:243], v65, s[28:31], s21 offen
  s_add_u32 s21, s79, 786432
  buffer_load_dwordx4 a[244:247], v63, s[28:31], s21 offen
  buffer_load_dwordx4 a[248:251], v64, s[28:31], s21 offen
  buffer_load_dwordx4 a[252:255], v65, s[28:31], s21 offen
  s_add_u32 s21, s79, 1179648
  buffer_load_dwordx4 v[224:227], v63, s[28:31], s21 offen
  buffer_load_dwordx4 v[228:231], v64, s[28:31], s21 offen
  buffer_load_dwordx4 v[232:235], v65, s[28:31], s21 offen
  s_add_u32 s21, s79, 1572864
  buffer_load_dwordx4 v[236:239], v63, s[28:31], s21 offen
  buffer_load_dwordx4 v[240:243], v64, s[28:31], s21 offen
  buffer_load_dwordx4 v[244:247], v65, s[28:31], s21 offen
  ds_read_b128 v[208:211], v70 offset:24576
  ds_read_b128 v[212:215], v71 offset:24576
  ds_read_b128 v[216:219], v70 offset:24704
  s_waitcnt lgkmcnt(2)
  v_mfma_f32_16x16x32_bf16 v[184:187], v[208:211], v[72:75], 0
  ds_read_b128 v[220:223], v71 offset:24704
  v_mfma_f32_16x16x32_bf16 v[188:191], v[208:211], v[76:79], 0
  s_add_u32 m0, s81, 12288
  s_nop 0
  buffer_load_dwordx4 v48, s[12:15], s80 offen lds
  v_mfma_f32_16x16x32_bf16 v[192:195], v[208:211], v[80:83], 0
  s_waitcnt lgkmcnt(2)
  v_mfma_f32_16x16x32_bf16 v[184:187], v[212:215], v[84:87], v[184:187]
  ds_read_b128 v[208:211], v70 offset:24832
  v_mfma_f32_16x16x32_bf16 v[188:191], v[212:215], v[88:91], v[188:191]
  s_add_u32 m0, s81, 13312
  s_nop 0
  buffer_load_dwordx4 v49, s[12:15], s80 offen lds
  v_mfma_f32_16x16x32_bf16 v[192:195], v[212:215], v[92:95], v[192:195]
  s_waitcnt lgkmcnt(2)
  v_mfma_f32_16x16x32_bf16 v[184:187], v[216:219], v[96:99], v[184:187]
  ds_read_b128 v[212:215], v71 offset:24832
  v_mfma_f32_16x16x32_bf16 v[188:191], v[216:219], v[100:103], v[188:191]
  s_add_u32 m0, s81, 14336
  s_nop 0
  buffer_load_dwordx4 v50, s[12:15], s80 offen lds
  v_mfma_f32_16x16x32_bf16 v[192:195], v[216:219], v[104:107], v[192:195]
  s_waitcnt lgkmcnt(2)
  v_mfma_f32_16x16x32_bf16 v[184:187], v[220:223], v[108:111], v[184:187]
  ds_read_b128 v[216:219], v70 offset:25344
  v_mfma_f32_16x16x32_bf16 v[188:191], v[220:223], v[112:115], v[188:191]
  s_add_u32 m0, s81, 15360
  s_nop 0
  buffer_load_dwordx4 v51, s[12:15], s80 offen lds
  v_mfma_f32_16x16x32_bf16 v[192:195], v[220:223], v[116:119], v[192:195]
  s_waitcnt lgkmcnt(2)
  v_mfma_f32_16x16x32_bf16 v[184:187], v[208:211], v[120:123], v[184:187]
  ds_read_b128 v[220:223], v71 offset:25344
  v_mfma_f32_16x16x32_bf16 v[188:191], v[208:211], v[124:127], v[188:191]
  s_add_u32 m0, s81, 16384
  s_nop 0
  buffer_load_dwordx4 v52, s[12:15], s80 offen lds
  v_mfma_f32_16x16x32_bf16 v[192:195], v[208:211], v[128:131], v[192:195]
  s_waitcnt lgkmcnt(2)
  v_mfma_f32_16x16x32_bf16 v[184:187], v[212:215], v[132:135], v[184:187]
  ds_read_b128 v[208:211], v70 offset:25472
  v_mfma_f32_16x16x32_bf16 v[188:191], v[212:215], v[136:139], v[188:191]
  s_add_u32 m0, s81, 17408
  s_nop 0
  buffer_load_dwordx4 v53, s[12:15], s80 offen lds
  v_mfma_f32_16x16x32_bf16 v[192:195], v[212:215], v[140:143], v[192:195]
  s_waitcnt lgkmcnt(2)
  v_mfma_f32_16x16x32_bf16 v[196:199], v[216:219], v[72:75], 0
  ds_read_b128 v[212:215], v71 offset:25472
  v_mfma_f32_16x16x32_bf16 v[200:203], v[216:219], v[76:79], 0
  s_add_u32 m0, s81, 18432
  s_nop 0
  buffer_load_dwordx4 v54, s[12:15], s80 offen lds
  v_mfma_f32_16x16x32_bf16 v[204:207], v[216:219], v[80:83], 0
  s_waitcnt lgkmcnt(2)
  v_mfma_f32_16x16x32_bf16 v[196:199], v[220:223], v[84:87], v[196:199]
  ds_read_b128 v[216:219], v70 offset:25600
  v_cvt_pk_bf16_f32 v248, v184, v185
  v_mfma_f32_16x16x32_bf16 v[200:203], v[220:223], v[88:91], v[200:203]
  s_add_u32 m0, s81, 19456
  s_nop 0
  buffer_load_dwordx4 v55, s[12:15], s80 offen lds
  v_mfma_f32_16x16x32_bf16 v[204:207], v[220:223], v[92:95], v[204:207]
  v_cvt_pk_bf16_f32 v249, v186, v187
  s_waitcnt lgkmcnt(2)
  v_mfma_f32_16x16x32_bf16 v[196:199], v[208:211], v[96:99], v[196:199]
  ds_read_b128 v[220:223], v71 offset:25600
  v_cvt_pk_bf16_f32 v250, v188, v189
  v_mfma_f32_16x16x32_bf16 v[200:203], v[208:211], v[100:103], v[200:203]
  s_add_u32 m0, s81, 20480
  s_nop 0
  buffer_load_dwordx4 v56, s[12:15], s80 offen lds
  v_mfma_f32_16x16x32_bf16 v[204:207], v[208:211], v[104:107], v[204:207]
  v_cvt_pk_bf16_f32 v251, v190, v191
  s_waitcnt lgkmcnt(2)
  v_mfma_f32_16x16x32_bf16 v[196:199], v[212:215], v[108:111], v[196:199]
  v_accvgpr_write_b32 a0, v248
  v_mfma_f32_16x16x32_bf16 v[200:203], v[212:215], v[112:115], v[200:203]
  s_add_u32 m0, s81, 21504
  s_nop 0
  buffer_load_dwordx4 v57, s[12:15], s80 offen lds
  v_mfma_f32_16x16x32_bf16 v[204:207], v[212:215], v[116:119], v[204:207]
  v_accvgpr_write_b32 a1, v249
  s_waitcnt lgkmcnt(1)
  v_mfma_f32_16x16x32_bf16 v[196:199], v[216:219], v[120:123], v[196:199]
  v_accvgpr_write_b32 a80, v250
  v_mfma_f32_16x16x32_bf16 v[200:203], v[216:219], v[124:127], v[200:203]
  s_add_u32 m0, s81, 22528
  s_nop 0
  buffer_load_dwordx4 v58, s[12:15], s80 offen lds
  v_mfma_f32_16x16x32_bf16 v[204:207], v[216:219], v[128:131], v[204:207]
  v_accvgpr_write_b32 a81, v251
  s_waitcnt lgkmcnt(0)
  v_mfma_f32_16x16x32_bf16 v[196:199], v[220:223], v[132:135], v[196:199]
  v_cvt_pk_bf16_f32 v144, v192, v193
  v_cvt_pk_bf16_f32 v145, v194, v195
  v_mfma_f32_16x16x32_bf16 v[200:203], v[220:223], v[136:139], v[200:203]
  s_add_u32 m0, s81, 23552
  s_nop 0
  buffer_load_dwordx4 v59, s[12:15], s80 offen lds
  s_add_u32 s80, s80, 393216
  v_mfma_f32_16x16x32_bf16 v[204:207], v[220:223], v[140:143], v[204:207]
  s_waitcnt vmcnt(42)
  ds_read_b128 v[208:211], v70 offset:0
  ds_read_b128 v[212:215], v71 offset:0
  ds_read_b128 v[216:219], v70 offset:128
  s_waitcnt lgkmcnt(2)
  v_mfma_f32_16x16x32_bf16 v[184:187], v[208:211], v[72:75], 0
  ds_read_b128 v[220:223], v71 offset:128
  v_mfma_f32_16x16x32_bf16 v[188:191], v[208:211], v[76:79], 0
  s_add_u32 m0, s81, 24576
  s_nop 0
  buffer_load_dwordx4 v48, s[12:15], s80 offen lds
  v_mfma_f32_16x16x32_bf16 v[192:195], v[208:211], v[80:83], 0
  s_waitcnt lgkmcnt(2)
  v_mfma_f32_16x16x32_bf16 v[184:187], v[212:215], v[84:87], v[184:187]
  ds_read_b128 v[208:211], v70 offset:256
  v_cvt_pk_bf16_f32 v248, v196, v197
  v_mfma_f32_16x16x32_bf16 v[188:191], v[212:215], v[88:91], v[188:191]
  s_add_u32 m0, s81, 25600
  s_nop 0
  buffer_load_dwordx4 v49, s[12:15], s80 offen lds
  v_mfma_f32_16x16x32_bf16 v[192:195], v[212:215], v[92:95], v[192:195]
  v_cvt_pk_bf16_f32 v249, v198, v199
  s_waitcnt lgkmcnt(2)
  v_mfma_f32_16x16x32_bf16 v[184:187], v[216:219], v[96:99], v[184:187]
  ds_read_b128 v[212:215], v71 offset:256
  v_cvt_pk_bf16_f32 v250, v200, v201
  v_mfma_f32_16x16x32_bf16 v[188:191], v[216:219], v[100:103], v[188:191]
  s_add_u32 m0, s81, 26624
  s_nop 0
  buffer_load_dwordx4 v50, s[12:15], s80 offen lds
  v_mfma_f32_16x16x32_bf16 v[192:195], v[216:219], v[104:107], v[192:195]
  v_cvt_pk_bf16_f32 v251, v202, v203
  s_waitcnt lgkmcnt(2)
  v_mfma_f32_16x16x32_bf16 v[184:187], v[220:223], v[108:111], v[184:187]
  ds_read_b128 v[216:219], v70 offset:768
  v_accvgpr_write_b32 a2, v248
  v_mfma_f32_16x16x32_bf16 v[188:191], v[220:223], v[112:115], v[188:191]
  s_add_u32 m0, s81, 27648
  s_nop 0
  buffer_load_dwordx4 v51, s[12:15], s80 offen lds
  v_mfma_f32_16x16x32_bf16 v[192:195], v[220:223], v[116:119], v[192:195]
  v_accvgpr_write_b32 a3, v249
  s_waitcnt lgkmcnt(2)
  v_mfma_f32_16x16x32_bf16 v[184:187], v[208:211], v[120:123], v[184:187]
  ds_read_b128 v[220:223], v71 offset:768
  v_accvgpr_write_b32 a82, v250
  v_mfma_f32_16x16x32_bf16 v[188:191], v[208:211], v[124:127], v[188:191]
  s_add_u32 m0, s81, 28672
  s_nop 0
  buffer_load_dwordx4 v52, s[12:15], s80 offen lds
  v_mfma_f32_16x16x32_bf16 v[192:195], v[208:211], v[128:131], v[192:195]
  v_accvgpr_write_b32 a83, v251
  s_waitcnt lgkmcnt(2)
  v_mfma_f32_16x16x32_bf16 v[184:187], v[212:215], v[132:135], v[184:187]
  ds_read_b128 v[208:211], v70 offset:896
  s_mov_b64 exec, s[68:69]
  v_cvt_pk_bf16_f32 v144, v204, v205
  v_cvt_pk_bf16_f32 v145, v206, v207
  s_mov_b64 exec, -1
  v_mfma_f32_16x16x32_bf16 v[188:191], v[212:215], v[136:139], v[188:191]
  s_add_u32 m0, s81, 29696
  s_nop 0
  buffer_load_dwordx4 v53, s[12:15], s80 offen lds
  v_mfma_f32_16x16x32_bf16 v[192:195], v[212:215], v[140:143], v[192:195]
  s_waitcnt lgkmcnt(2)
  v_mfma_f32_16x16x32_bf16 v[196:199], v[216:219], v[72:75], 0
  ds_read_b128 v[212:215], v71 offset:896
  v_mfma_f32_16x16x32_bf16 v[200:203], v[216:219], v[76:79], 0
  s_add_u32 m0, s81, 30720
  s_nop 0
  buffer_load_dwordx4 v54, s[12:15], s80 offen lds
  v_mfma_f32_16x16x32_bf16 v[204:207], v[216:219], v[80:83], 0
  s_waitcnt lgkmcnt(2)
  v_mfma_f32_16x16x32_bf16 v[196:199], v[220:223], v[84:87], v[196:199]
  ds_read_b128 v[216:219], v70 offset:1024
  v_cvt_pk_bf16_f32 v248, v184, v185
  v_mfma_f32_16x16x32_bf16 v[200:203], v[220:223], v[88:91], v[200:203]
  s_add_u32 m0, s81, 31744
  s_nop 0
  buffer_load_dwordx4 v55, s[12:15], s80 offen lds
  v_mfma_f32_16x16x32_bf16 v[204:207], v[220:223], v[92:95], v[204:207]
  v_cvt_pk_bf16_f32 v249, v186, v187
  s_waitcnt lgkmcnt(2)
  v_mfma_f32_16x16x32_bf16 v[196:199], v[208:211], v[96:99], v[196:199]
  ds_read_b128 v[220:223], v71 offset:1024
  v_cvt_pk_bf16_f32 v250, v188, v189
  v_mfma_f32_16x16x32_bf16 v[200:203], v[208:211], v[100:103], v[200:203]
  s_add_u32 m0, s81, 32768
  s_nop 0
  buffer_load_dwordx4 v56, s[12:15], s80 offen lds
  v_mfma_f32_16x16x32_bf16 v[204:207], v[208:211], v[104:107], v[204:207]
  v_cvt_pk_bf16_f32 v251, v190, v191
  s_waitcnt lgkmcnt(2)
  v_mfma_f32_16x16x32_bf16 v[196:199], v[212:215], v[108:111], v[196:199]
  v_accvgpr_write_b32 a4, v248
  v_mfma_f32_16x16x32_bf16 v[200:203], v[212:215], v[112:115], v[200:203]
  s_add_u32 m0, s81, 33792
  s_nop 0
  buffer_load_dwordx4 v57, s[12:15], s80 offen lds
  v_mfma_f32_16x16x32_bf16 v[204:207], v[212:215], v[116:119], v[204:207]
  v_accvgpr_write_b32 a5, v249
  s_waitcnt lgkmcnt(1)
  v_mfma_f32_16x16x32_bf16 v[196:199], v[216:219], v[120:123], v[196:199]
  v_accvgpr_write_b32 a84, v250
  v_mfma_f32_16x16x32_bf16 v[200:203], v[216:219], v[124:127], v[200:203]
  s_add_u32 m0, s81, 34816
  s_nop 0
  buffer_load_dwordx4 v58, s[12:15], s80 offen lds
  v_mfma_f32_16x16x32_bf16 v[204:207], v[216:219], v[128:131], v[204:207]
  v_accvgpr_write_b32 a85, v251
  s_waitcnt lgkmcnt(0)
  v_mfma_f32_16x16x32_bf16 v[196:199], v[220:223], v[132:135], v[196:199]
  v_cvt_pk_bf16_f32 v146, v192, v193
  v_cvt_pk_bf16_f32 v147, v194, v195
  v_mfma_f32_16x16x32_bf16 v[200:203], v[220:223], v[136:139], v[200:203]
  s_add_u32 m0, s81, 35840
  s_nop 0
  buffer_load_dwordx4 v59, s[12:15], s80 offen lds
  s_add_u32 s80, s80, 393216
  v_mfma_f32_16x16x32_bf16 v[204:207], v[220:223], v[140:143], v[204:207]
  s_waitcnt vmcnt(12)
  ds_read_b128 v[208:211], v70 offset:12288
  ds_read_b128 v[212:215], v71 offset:12288
  ds_read_b128 v[216:219], v70 offset:12416
  s_waitcnt lgkmcnt(2)
  v_mfma_f32_16x16x32_bf16 v[184:187], v[208:211], v[72:75], 0
  ds_read_b128 v[220:223], v71 offset:12416
  v_mfma_f32_16x16x32_bf16 v[188:191], v[208:211], v[76:79], 0
  s_add_u32 m0, s81, 0
  s_nop 0
  buffer_load_dwordx4 v48, s[12:15], s80 offen lds
  v_mfma_f32_16x16x32_bf16 v[192:195], v[208:211], v[80:83], 0
  s_waitcnt lgkmcnt(2)
  v_mfma_f32_16x16x32_bf16 v[184:187], v[212:215], v[84:87], v[184:187]
  ds_read_b128 v[208:211], v70 offset:12544
  v_cvt_pk_bf16_f32 v248, v196, v197
  v_mfma_f32_16x16x32_bf16 v[188:191], v[212:215], v[88:91], v[188:191]
  s_add_u32 m0, s81, 1024
  s_nop 0
  buffer_load_dwordx4 v49, s[12:15], s80 offen lds
  v_mfma_f32_16x16x32_bf16 v[192:195], v[212:215], v[92:95], v[192:195]
  v_cvt_pk_bf16_f32 v249, v198, v199
  s_waitcnt lgkmcnt(2)
  v_mfma_f32_16x16x32_bf16 v[184:187], v[216:219], v[96:99], v[184:187]
  ds_read_b128 v[212:215], v71 offset:12544
  v_cvt_pk_bf16_f32 v250, v200, v201
  v_mfma_f32_16x16x32_bf16 v[188:191], v[216:219], v[100:103], v[188:191]
  s_add_u32 m0, s81, 2048
  s_nop 0
  buffer_load_dwordx4 v50, s[12:15], s80 offen lds
  v_mfma_f32_16x16x32_bf16 v[192:195], v[216:219], v[104:107], v[192:195]
  v_cvt_pk_bf16_f32 v251, v202, v203
  s_waitcnt lgkmcnt(2)
  v_mfma_f32_16x16x32_bf16 v[184:187], v[220:223], v[108:111], v[184:187]
  ds_read_b128 v[216:219], v70 offset:13056
  v_accvgpr_write_b32 a6, v248
  v_mfma_f32_16x16x32_bf16 v[188:191], v[220:223], v[112:115], v[188:191]
  s_add_u32 m0, s81, 3072
  s_nop 0
  buffer_load_dwordx4 v51, s[12:15], s80 offen lds
  v_mfma_f32_16x16x32_bf16 v[192:195], v[220:223], v[116:119], v[192:195]
  v_accvgpr_write_b32 a7, v249
  s_waitcnt lgkmcnt(2)
  v_mfma_f32_16x16x32_bf16 v[184:187], v[208:211], v[120:123], v[184:187]
  ds_read_b128 v[220:223], v71 offset:13056
  v_accvgpr_write_b32 a86, v250
  v_mfma_f32_16x16x32_bf16 v[188:191], v[208:211], v[124:127], v[188:191]
  s_add_u32 m0, s81, 4096
  s_nop 0
  buffer_load_dwordx4 v52, s[12:15], s80 offen lds
  v_mfma_f32_16x16x32_bf16 v[192:195], v[208:211], v[128:131], v[192:195]
  v_accvgpr_write_b32 a87, v251
  s_waitcnt lgkmcnt(2)
  v_mfma_f32_16x16x32_bf16 v[184:187], v[212:215], v[132:135], v[184:187]
  ds_read_b128 v[208:211], v70 offset:13184
  s_mov_b64 exec, s[68:69]
  v_cvt_pk_bf16_f32 v146, v204, v205
  v_cvt_pk_bf16_f32 v147, v206, v207
  s_mov_b64 exec, -1
  v_mfma_f32_16x16x32_bf16 v[188:191], v[212:215], v[136:139], v[188:191]
  s_add_u32 m0, s81, 5120
  s_nop 0
  buffer_load_dwordx4 v53, s[12:15], s80 offen lds
  v_mfma_f32_16x16x32_bf16 v[192:195], v[212:215], v[140:143], v[192:195]
  s_waitcnt lgkmcnt(2)
  v_mfma_f32_16x16x32_bf16 v[196:199], v[216:219], v[72:75], 0
  ds_read_b128 v[212:215], v71 offset:13184
  v_mfma_f32_16x16x32_bf16 v[200:203], v[216:219], v[76:79], 0
  s_add_u32 m0, s81, 6144
  s_nop 0
  buffer_load_dwordx4 v54, s[12:15], s80 offen lds
  v_mfma_f32_16x16x32_bf16 v[204:207], v[216:219], v[80:83], 0
  s_waitcnt lgkmcnt(2)
  v_mfma_f32_16x16x32_bf16 v[196:199], v[220:223], v[84:87], v[196:199]
  ds_read_b128 v[216:219], v70 offset:13312
  v_cvt_pk_bf16_f32 v248, v184, v185
  v_mfma_f32_16x16x32_bf16 v[200:203], v[220:223], v[88:91], v[200:203]
  s_add_u32 m0, s81, 7168
  s_nop 0
  buffer_load_dwordx4 v55, s[12:15], s80 offen lds
  v_mfma_f32_16x16x32_bf16 v[204:207], v[220:223], v[92:95], v[204:207]
  v_cvt_pk_bf16_f32 v249, v186, v187
  s_waitcnt lgkmcnt(2)
  v_mfma_f32_16x16x32_bf16 v[196:199], v[208:211], v[96:99], v[196:199]
  ds_read_b128 v[220:223], v71 offset:13312
  v_cvt_pk_bf16_f32 v250, v188, v189
  v_mfma_f32_16x16x32_bf16 v[200:203], v[208:211], v[100:103], v[200:203]
  s_add_u32 m0, s81, 8192
  s_nop 0
  buffer_load_dwordx4 v56, s[12:15], s80 offen lds
  v_mfma_f32_16x16x32_bf16 v[204:207], v[208:211], v[104:107], v[204:207]
  v_cvt_pk_bf16_f32 v251, v190, v191
  s_waitcnt lgkmcnt(2)
  v_mfma_f32_16x16x32_bf16 v[196:199], v[212:215], v[108:111], v[196:199]
  v_accvgpr_write_b32 a8, v248
  v_mfma_f32_16x16x32_bf16 v[200:203], v[212:215], v[112:115], v[200:203]
  s_add_u32 m0, s81, 9216
  s_nop 0
  buffer_load_dwordx4 v57, s[12:15], s80 offen lds
  v_mfma_f32_16x16x32_bf16 v[204:207], v[212:215], v[116:119], v[204:207]
  v_accvgpr_write_b32 a9, v249
  s_waitcnt lgkmcnt(1)
  v_mfma_f32_16x16x32_bf16 v[196:199], v[216:219], v[120:123], v[196:199]
  v_accvgpr_write_b32 a88, v250
  v_mfma_f32_16x16x32_bf16 v[200:203], v[216:219], v[124:127], v[200:203]
  s_add_u32 m0, s81, 10240
  s_nop 0
  buffer_load_dwordx4 v58, s[12:15], s80 offen lds
  v_mfma_f32_16x16x32_bf16 v[204:207], v[216:219], v[128:131], v[204:207]
  v_accvgpr_write_b32 a89, v251
  s_waitcnt lgkmcnt(0)
  v_mfma_f32_16x16x32_bf16 v[196:199], v[220:223], v[132:135], v[196:199]
  v_cvt_pk_bf16_f32 v148, v192, v193
  v_cvt_pk_bf16_f32 v149, v194, v195
  v_mfma_f32_16x16x32_bf16 v[200:203], v[220:223], v[136:139], v[200:203]
  s_add_u32 m0, s81, 11264
  s_nop 0
  buffer_load_dwordx4 v59, s[12:15], s80 offen lds
  s_add_u32 s80, s80, 393216
  v_mfma_f32_16x16x32_bf16 v[204:207], v[220:223], v[140:143], v[204:207]
  s_waitcnt vmcnt(12)
  ds_read_b128 v[208:211], v70 offset:24576
  ds_read_b128 v[212:215], v71 offset:24576
  ds_read_b128 v[216:219], v70 offset:24704
  s_waitcnt lgkmcnt(2)
  v_mfma_f32_16x16x32_bf16 v[184:187], v[208:211], v[72:75], 0
  ds_read_b128 v[220:223], v71 offset:24704
  v_mfma_f32_16x16x32_bf16 v[188:191], v[208:211], v[76:79], 0
  s_add_u32 m0, s81, 12288
  s_nop 0
  buffer_load_dwordx4 v48, s[12:15], s80 offen lds
  v_mfma_f32_16x16x32_bf16 v[192:195], v[208:211], v[80:83], 0
  s_waitcnt lgkmcnt(2)
  v_mfma_f32_16x16x32_bf16 v[184:187], v[212:215], v[84:87], v[184:187]
  ds_read_b128 v[208:211], v70 offset:24832
  v_cvt_pk_bf16_f32 v248, v196, v197
  v_mfma_f32_16x16x32_bf16 v[188:191], v[212:215], v[88:91], v[188:191]
  s_add_u32 m0, s81, 13312
  s_nop 0
  buffer_load_dwordx4 v49, s[12:15], s80 offen lds
  v_mfma_f32_16x16x32_bf16 v[192:195], v[212:215], v[92:95], v[192:195]
  v_cvt_pk_bf16_f32 v249, v198, v199
  s_waitcnt lgkmcnt(2)
  v_mfma_f32_16x16x32_bf16 v[184:187], v[216:219], v[96:99], v[184:187]
  ds_read_b128 v[212:215], v71 offset:24832
  v_cvt_pk_bf16_f32 v250, v200, v201
  v_mfma_f32_16x16x32_bf16 v[188:191], v[216:219], v[100:103], v[188:191]
  s_add_u32 m0, s81, 14336
  s_nop 0
  buffer_load_dwordx4 v50, s[12:15], s80 offen lds
  v_mfma_f32_16x16x32_bf16 v[192:195], v[216:219], v[104:107], v[192:195]
  v_cvt_pk_bf16_f32 v251, v202, v203
  s_waitcnt lgkmcnt(2)
  v_mfma_f32_16x16x32_bf16 v[184:187], v[220:223], v[108:111], v[184:187]
  ds_read_b128 v[216:219], v70 offset:25344
  v_accvgpr_write_b32 a10, v248
  v_mfma_f32_16x16x32_bf16 v[188:191], v[220:223], v[112:115], v[188:191]
  s_add_u32 m0, s81, 15360
  s_nop 0
  buffer_load_dwordx4 v51, s[12:15], s80 offen lds
  v_mfma_f32_16x16x32_bf16 v[192:195], v[220:223], v[116:119], v[192:195]
  v_accvgpr_write_b32 a11, v249
  s_waitcnt lgkmcnt(2)
  v_mfma_f32_16x16x32_bf16 v[184:187], v[208:211], v[120:123], v[184:187]
  ds_read_b128 v[220:223], v71 offset:25344
  v_accvgpr_write_b32 a90, v250
  v_mfma_f32_16x16x32_bf16 v[188:191], v[208:211], v[124:127], v[188:191]
  s_add_u32 m0, s81, 16384
  s_nop 0
  buffer_load_dwordx4 v52, s[12:15], s80 offen lds
  v_mfma_f32_16x16x32_bf16 v[192:195], v[208:211], v[128:131], v[192:195]
  v_accvgpr_write_b32 a91, v251
  s_waitcnt lgkmcnt(2)
  v_mfma_f32_16x16x32_bf16 v[184:187], v[212:215], v[132:135], v[184:187]
  ds_read_b128 v[208:211], v70 offset:25472
  s_mov_b64 exec, s[68:69]
  v_cvt_pk_bf16_f32 v148, v204, v205
  v_cvt_pk_bf16_f32 v149, v206, v207
  s_mov_b64 exec, -1
  v_mfma_f32_16x16x32_bf16 v[188:191], v[212:215], v[136:139], v[188:191]
  s_add_u32 m0, s81, 17408
  s_nop 0
  buffer_load_dwordx4 v53, s[12:15], s80 offen lds
  v_mfma_f32_16x16x32_bf16 v[192:195], v[212:215], v[140:143], v[192:195]
  s_waitcnt lgkmcnt(2)
  v_mfma_f32_16x16x32_bf16 v[196:199], v[216:219], v[72:75], 0
  ds_read_b128 v[212:215], v71 offset:25472
  v_mfma_f32_16x16x32_bf16 v[200:203], v[216:219], v[76:79], 0
  s_add_u32 m0, s81, 18432
  s_nop 0
  buffer_load_dwordx4 v54, s[12:15], s80 offen lds
  v_mfma_f32_16x16x32_bf16 v[204:207], v[216:219], v[80:83], 0
  s_waitcnt lgkmcnt(2)
  v_mfma_f32_16x16x32_bf16 v[196:199], v[220:223], v[84:87], v[196:199]
  ds_read_b128 v[216:219], v70 offset:25600
  v_cvt_pk_bf16_f32 v248, v184, v185
  v_mfma_f32_16x16x32_bf16 v[200:203], v[220:223], v[88:91], v[200:203]
  s_add_u32 m0, s81, 19456
  s_nop 0
  buffer_load_dwordx4 v55, s[12:15], s80 offen lds
  v_mfma_f32_16x16x32_bf16 v[204:207], v[220:223], v[92:95], v[204:207]
  v_cvt_pk_bf16_f32 v249, v186, v187
  s_waitcnt lgkmcnt(2)
  v_mfma_f32_16x16x32_bf16 v[196:199], v[208:211], v[96:99], v[196:199]
  ds_read_b128 v[220:223], v71 offset:25600
  v_cvt_pk_bf16_f32 v250, v188, v189
  v_mfma_f32_16x16x32_bf16 v[200:203], v[208:211], v[100:103], v[200:203]
  s_add_u32 m0, s81, 20480
  s_nop 0
  buffer_load_dwordx4 v56, s[12:15], s80 offen lds
  v_mfma_f32_16x16x32_bf16 v[204:207], v[208:211], v[104:107], v[204:207]
  v_cvt_pk_bf16_f32 v251, v190, v191
  s_waitcnt lgkmcnt(2)
  v_mfma_f32_16x16x32_bf16 v[196:199], v[212:215], v[108:111], v[196:199]
  v_accvgpr_write_b32 a12, v248
  v_mfma_f32_16x16x32_bf16 v[200:203], v[212:215], v[112:115], v[200:203]
  s_add_u32 m0, s81, 21504
  s_nop 0
  buffer_load_dwordx4 v57, s[12:15], s80 offen lds
  v_mfma_f32_16x16x32_bf16 v[204:207], v[212:215], v[116:119], v[204:207]
  v_accvgpr_write_b32 a13, v249
  s_waitcnt lgkmcnt(1)
  v_mfma_f32_16x16x32_bf16 v[196:199], v[216:219], v[120:123], v[196:199]
  v_accvgpr_write_b32 a92, v250
  v_mfma_f32_16x16x32_bf16 v[200:203], v[216:219], v[124:127], v[200:203]
  s_add_u32 m0, s81, 22528
  s_nop 0
  buffer_load_dwordx4 v58, s[12:15], s80 offen lds
  v_mfma_f32_16x16x32_bf16 v[204:207], v[216:219], v[128:131], v[204:207]
  v_accvgpr_write_b32 a93, v251
  s_waitcnt lgkmcnt(0)
  v_mfma_f32_16x16x32_bf16 v[196:199], v[220:223], v[132:135], v[196:199]
  v_cvt_pk_bf16_f32 v150, v192, v193
  v_cvt_pk_bf16_f32 v151, v194, v195
  v_mfma_f32_16x16x32_bf16 v[200:203], v[220:223], v[136:139], v[200:203]
  s_add_u32 m0, s81, 23552
  s_nop 0
  buffer_load_dwordx4 v59, s[12:15], s80 offen lds
  s_add_u32 s80, s80, 393216
  v_mfma_f32_16x16x32_bf16 v[204:207], v[220:223], v[140:143], v[204:207]
  s_waitcnt vmcnt(12)
  ds_read_b128 v[208:211], v70 offset:0
  ds_read_b128 v[212:215], v71 offset:0
  ds_read_b128 v[216:219], v70 offset:128
  s_waitcnt lgkmcnt(2)
  v_mfma_f32_16x16x32_bf16 v[184:187], v[208:211], v[72:75], 0
  ds_read_b128 v[220:223], v71 offset:128
  v_mfma_f32_16x16x32_bf16 v[188:191], v[208:211], v[76:79], 0
  s_add_u32 m0, s81, 24576
  s_nop 0
  buffer_load_dwordx4 v48, s[12:15], s80 offen lds
  v_mfma_f32_16x16x32_bf16 v[192:195], v[208:211], v[80:83], 0
  s_waitcnt lgkmcnt(2)
  v_mfma_f32_16x16x32_bf16 v[184:187], v[212:215], v[84:87], v[184:187]
  ds_read_b128 v[208:211], v70 offset:256
  v_cvt_pk_bf16_f32 v248, v196, v197
  v_mfma_f32_16x16x32_bf16 v[188:191], v[212:215], v[88:91], v[188:191]
  s_add_u32 m0, s81, 25600
  s_nop 0
  buffer_load_dwordx4 v49, s[12:15], s80 offen lds
  v_mfma_f32_16x16x32_bf16 v[192:195], v[212:215], v[92:95], v[192:195]
  v_cvt_pk_bf16_f32 v249, v198, v199
  s_waitcnt lgkmcnt(2)
  v_mfma_f32_16x16x32_bf16 v[184:187], v[216:219], v[96:99], v[184:187]
  ds_read_b128 v[212:215], v71 offset:256
  v_cvt_pk_bf16_f32 v250, v200, v201
  v_mfma_f32_16x16x32_bf16 v[188:191], v[216:219], v[100:103], v[188:191]
  s_add_u32 m0, s81, 26624
  s_nop 0
  buffer_load_dwordx4 v50, s[12:15], s80 offen lds
  v_mfma_f32_16x16x32_bf16 v[192:195], v[216:219], v[104:107], v[192:195]
  v_cvt_pk_bf16_f32 v251, v202, v203
  s_waitcnt lgkmcnt(2)
  v_mfma_f32_16x16x32_bf16 v[184:187], v[220:223], v[108:111], v[184:187]
  ds_read_b128 v[216:219], v70 offset:768
  v_accvgpr_write_b32 a14, v248
  v_mfma_f32_16x16x32_bf16 v[188:191], v[220:223], v[112:115], v[188:191]
  s_add_u32 m0, s81, 27648
  s_nop 0
  buffer_load_dwordx4 v51, s[12:15], s80 offen lds
  v_mfma_f32_16x16x32_bf16 v[192:195], v[220:223], v[116:119], v[192:195]
  v_accvgpr_write_b32 a15, v249
  s_waitcnt lgkmcnt(2)
  v_mfma_f32_16x16x32_bf16 v[184:187], v[208:211], v[120:123], v[184:187]
  ds_read_b128 v[220:223], v71 offset:768
  v_accvgpr_write_b32 a94, v250
  v_mfma_f32_16x16x32_bf16 v[188:191], v[208:211], v[124:127], v[188:191]
  s_add_u32 m0, s81, 28672
  s_nop 0
  buffer_load_dwordx4 v52, s[12:15], s80 offen lds
  v_mfma_f32_16x16x32_bf16 v[192:195], v[208:211], v[128:131], v[192:195]
  v_accvgpr_write_b32 a95, v251
  s_waitcnt lgkmcnt(2)
  v_mfma_f32_16x16x32_bf16 v[184:187], v[212:215], v[132:135], v[184:187]
  ds_read_b128 v[208:211], v70 offset:896
  s_mov_b64 exec, s[68:69]
  v_cvt_pk_bf16_f32 v150, v204, v205
  v_cvt_pk_bf16_f32 v151, v206, v207
  s_mov_b64 exec, -1
  v_mfma_f32_16x16x32_bf16 v[188:191], v[212:215], v[136:139], v[188:191]
  s_add_u32 m0, s81, 29696
  s_nop 0
  buffer_load_dwordx4 v53, s[12:15], s80 offen lds
  v_mfma_f32_16x16x32_bf16 v[192:195], v[212:215], v[140:143], v[192:195]
  s_waitcnt lgkmcnt(2)
  v_mfma_f32_16x16x32_bf16 v[196:199], v[216:219], v[72:75], 0
  ds_read_b128 v[212:215], v71 offset:896
  v_mfma_f32_16x16x32_bf16 v[200:203], v[216:219], v[76:79], 0
  s_add_u32 m0, s81, 30720
  s_nop 0
  buffer_load_dwordx4 v54, s[12:15], s80 offen lds
  v_mfma_f32_16x16x32_bf16 v[204:207], v[216:219], v[80:83], 0
  s_waitcnt lgkmcnt(2)
  v_mfma_f32_16x16x32_bf16 v[196:199], v[220:223], v[84:87], v[196:199]
  ds_read_b128 v[216:219], v70 offset:1024
  v_cvt_pk_bf16_f32 v248, v184, v185
  v_mfma_f32_16x16x32_bf16 v[200:203], v[220:223], v[88:91], v[200:203]
  s_add_u32 m0, s81, 31744
  s_nop 0
  buffer_load_dwordx4 v55, s[12:15], s80 offen lds
  v_mfma_f32_16x16x32_bf16 v[204:207], v[220:223], v[92:95], v[204:207]
  v_cvt_pk_bf16_f32 v249, v186, v187
  s_waitcnt lgkmcnt(2)
  v_mfma_f32_16x16x32_bf16 v[196:199], v[208:211], v[96:99], v[196:199]
  ds_read_b128 v[220:223], v71 offset:1024
  v_cvt_pk_bf16_f32 v250, v188, v189
  v_mfma_f32_16x16x32_bf16 v[200:203], v[208:211], v[100:103], v[200:203]
  s_add_u32 m0, s81, 32768
  s_nop 0
  buffer_load_dwordx4 v56, s[12:15], s80 offen lds
  v_mfma_f32_16x16x32_bf16 v[204:207], v[208:211], v[104:107], v[204:207]
  v_cvt_pk_bf16_f32 v251, v190, v191
  s_waitcnt lgkmcnt(2)
  v_mfma_f32_16x16x32_bf16 v[196:199], v[212:215], v[108:111], v[196:199]
  v_accvgpr_write_b32 a16, v248
  v_mfma_f32_16x16x32_bf16 v[200:203], v[212:215], v[112:115], v[200:203]
  s_add_u32 m0, s81, 33792
  s_nop 0
  buffer_load_dwordx4 v57, s[12:15], s80 offen lds
  v_mfma_f32_16x16x32_bf16 v[204:207], v[212:215], v[116:119], v[204:207]
  v_accvgpr_write_b32 a17, v249
  s_waitcnt lgkmcnt(1)
  v_mfma_f32_16x16x32_bf16 v[196:199], v[216:219], v[120:123], v[196:199]
  v_accvgpr_write_b32 a96, v250
  v_mfma_f32_16x16x32_bf16 v[200:203], v[216:219], v[124:127], v[200:203]
  s_add_u32 m0, s81, 34816
  s_nop 0
  buffer_load_dwordx4 v58, s[12:15], s80 offen lds
  v_mfma_f32_16x16x32_bf16 v[204:207], v[216:219], v[128:131], v[204:207]
  v_accvgpr_write_b32 a97, v251
  s_waitcnt lgkmcnt(0)
  v_mfma_f32_16x16x32_bf16 v[196:199], v[220:223], v[132:135], v[196:199]
  v_cvt_pk_bf16_f32 v152, v192, v193
  v_cvt_pk_bf16_f32 v153, v194, v195
  v_mfma_f32_16x16x32_bf16 v[200:203], v[220:223], v[136:139], v[200:203]
  s_add_u32 m0, s81, 35840
  s_nop 0
  buffer_load_dwordx4 v59, s[12:15], s80 offen lds
  s_add_u32 s80, s80, 393216
  v_mfma_f32_16x16x32_bf16 v[204:207], v[220:223], v[140:143], v[204:207]
  s_waitcnt vmcnt(12)
  ds_read_b128 v[208:211], v70 offset:12288
  ds_read_b128 v[212:215], v71 offset:12288
  ds_read_b128 v[216:219], v70 offset:12416
  s_waitcnt lgkmcnt(2)
  v_mfma_f32_16x16x32_bf16 v[184:187], v[208:211], v[72:75], 0
  ds_read_b128 v[220:223], v71 offset:12416
  v_mfma_f32_16x16x32_bf16 v[188:191], v[208:211], v[76:79], 0
  s_add_u32 m0, s81, 0
  s_nop 0
  buffer_load_dwordx4 v48, s[12:15], s80 offen lds
  v_mfma_f32_16x16x32_bf16 v[192:195], v[208:211], v[80:83], 0
  s_waitcnt lgkmcnt(2)
  v_mfma_f32_16x16x32_bf16 v[184:187], v[212:215], v[84:87], v[184:187]
  ds_read_b128 v[208:211], v70 offset:12544
  v_cvt_pk_bf16_f32 v248, v196, v197
  v_mfma_f32_16x16x32_bf16 v[188:191], v[212:215], v[88:91], v[188:191]
  s_add_u32 m0, s81, 1024
  s_nop 0
  buffer_load_dwordx4 v49, s[12:15], s80 offen lds
  v_mfma_f32_16x16x32_bf16 v[192:195], v[212:215], v[92:95], v[192:195]
  v_cvt_pk_bf16_f32 v249, v198, v199
  s_waitcnt lgkmcnt(2)
  v_mfma_f32_16x16x32_bf16 v[184:187], v[216:219], v[96:99], v[184:187]
  ds_read_b128 v[212:215], v71 offset:12544
  v_cvt_pk_bf16_f32 v250, v200, v201
  v_mfma_f32_16x16x32_bf16 v[188:191], v[216:219], v[100:103], v[188:191]
  s_add_u32 m0, s81, 2048
  s_nop 0
  buffer_load_dwordx4 v50, s[12:15], s80 offen lds
  v_mfma_f32_16x16x32_bf16 v[192:195], v[216:219], v[104:107], v[192:195]
  v_cvt_pk_bf16_f32 v251, v202, v203
  s_waitcnt lgkmcnt(2)
  v_mfma_f32_16x16x32_bf16 v[184:187], v[220:223], v[108:111], v[184:187]
  ds_read_b128 v[216:219], v70 offset:13056
  v_accvgpr_write_b32 a18, v248
  v_mfma_f32_16x16x32_bf16 v[188:191], v[220:223], v[112:115], v[188:191]
  s_add_u32 m0, s81, 3072
  s_nop 0
  buffer_load_dwordx4 v51, s[12:15], s80 offen lds
  v_mfma_f32_16x16x32_bf16 v[192:195], v[220:223], v[116:119], v[192:195]
  v_accvgpr_write_b32 a19, v249
  s_waitcnt lgkmcnt(2)
  v_mfma_f32_16x16x32_bf16 v[184:187], v[208:211], v[120:123], v[184:187]
  ds_read_b128 v[220:223], v71 offset:13056
  v_accvgpr_write_b32 a98, v250
  v_mfma_f32_16x16x32_bf16 v[188:191], v[208:211], v[124:127], v[188:191]
  s_add_u32 m0, s81, 4096
  s_nop 0
  buffer_load_dwordx4 v52, s[12:15], s80 offen lds
  v_mfma_f32_16x16x32_bf16 v[192:195], v[208:211], v[128:131], v[192:195]
  v_accvgpr_write_b32 a99, v251
  s_waitcnt lgkmcnt(2)
  v_mfma_f32_16x16x32_bf16 v[184:187], v[212:215], v[132:135], v[184:187]
  ds_read_b128 v[208:211], v70 offset:13184
  s_mov_b64 exec, s[68:69]
  v_cvt_pk_bf16_f32 v152, v204, v205
  v_cvt_pk_bf16_f32 v153, v206, v207
  s_mov_b64 exec, -1
  v_mfma_f32_16x16x32_bf16 v[188:191], v[212:215], v[136:139], v[188:191]
  s_add_u32 m0, s81, 5120
  s_nop 0
  buffer_load_dwordx4 v53, s[12:15], s80 offen lds
  v_mfma_f32_16x16x32_bf16 v[192:195], v[212:215], v[140:143], v[192:195]
  s_waitcnt lgkmcnt(2)
  v_mfma_f32_16x16x32_bf16 v[196:199], v[216:219], v[72:75], 0
  ds_read_b128 v[212:215], v71 offset:13184
  v_mfma_f32_16x16x32_bf16 v[200:203], v[216:219], v[76:79], 0
  s_add_u32 m0, s81, 6144
  s_nop 0
  buffer_load_dwordx4 v54, s[12:15], s80 offen lds
  v_mfma_f32_16x16x32_bf16 v[204:207], v[216:219], v[80:83], 0
  s_waitcnt lgkmcnt(2)
  v_mfma_f32_16x16x32_bf16 v[196:199], v[220:223], v[84:87], v[196:199]
  ds_read_b128 v[216:219], v70 offset:13312
  v_cvt_pk_bf16_f32 v248, v184, v185
  v_mfma_f32_16x16x32_bf16 v[200:203], v[220:223], v[88:91], v[200:203]
  s_add_u32 m0, s81, 7168
  s_nop 0
  buffer_load_dwordx4 v55, s[12:15], s80 offen lds
  v_mfma_f32_16x16x32_bf16 v[204:207], v[220:223], v[92:95], v[204:207]
  v_cvt_pk_bf16_f32 v249, v186, v187
  s_waitcnt lgkmcnt(2)
  v_mfma_f32_16x16x32_bf16 v[196:199], v[208:211], v[96:99], v[196:199]
  ds_read_b128 v[220:223], v71 offset:13312
  v_cvt_pk_bf16_f32 v250, v188, v189
  v_mfma_f32_16x16x32_bf16 v[200:203], v[208:211], v[100:103], v[200:203]
  s_add_u32 m0, s81, 8192
  s_nop 0
  buffer_load_dwordx4 v56, s[12:15], s80 offen lds
  v_mfma_f32_16x16x32_bf16 v[204:207], v[208:211], v[104:107], v[204:207]
  v_cvt_pk_bf16_f32 v251, v190, v191
  s_waitcnt lgkmcnt(2)
  v_mfma_f32_16x16x32_bf16 v[196:199], v[212:215], v[108:111], v[196:199]
  v_accvgpr_write_b32 a20, v248
  v_mfma_f32_16x16x32_bf16 v[200:203], v[212:215], v[112:115], v[200:203]
  s_add_u32 m0, s81, 9216
  s_nop 0
  buffer_load_dwordx4 v57, s[12:15], s80 offen lds
  v_mfma_f32_16x16x32_bf16 v[204:207], v[212:215], v[116:119], v[204:207]
  v_accvgpr_write_b32 a21, v249
  s_waitcnt lgkmcnt(1)
  v_mfma_f32_16x16x32_bf16 v[196:199], v[216:219], v[120:123], v[196:199]
  v_accvgpr_write_b32 a100, v250
  v_mfma_f32_16x16x32_bf16 v[200:203], v[216:219], v[124:127], v[200:203]
  s_add_u32 m0, s81, 10240
  s_nop 0
  buffer_load_dwordx4 v58, s[12:15], s80 offen lds
  v_mfma_f32_16x16x32_bf16 v[204:207], v[216:219], v[128:131], v[204:207]
  v_accvgpr_write_b32 a101, v251
  s_waitcnt lgkmcnt(0)
  v_mfma_f32_16x16x32_bf16 v[196:199], v[220:223], v[132:135], v[196:199]
  v_cvt_pk_bf16_f32 v154, v192, v193
  v_cvt_pk_bf16_f32 v155, v194, v195
  v_mfma_f32_16x16x32_bf16 v[200:203], v[220:223], v[136:139], v[200:203]
  s_add_u32 m0, s81, 11264
  s_nop 0
  buffer_load_dwordx4 v59, s[12:15], s80 offen lds
  s_add_u32 s80, s80, 393216
  v_mfma_f32_16x16x32_bf16 v[204:207], v[220:223], v[140:143], v[204:207]
  s_waitcnt vmcnt(12)
  ds_read_b128 v[208:211], v70 offset:24576
  ds_read_b128 v[212:215], v71 offset:24576
  ds_read_b128 v[216:219], v70 offset:24704
  s_waitcnt lgkmcnt(2)
  v_mfma_f32_16x16x32_bf16 v[184:187], v[208:211], v[72:75], 0
  ds_read_b128 v[220:223], v71 offset:24704
  v_mfma_f32_16x16x32_bf16 v[188:191], v[208:211], v[76:79], 0
  s_add_u32 m0, s81, 12288
  s_nop 0
  buffer_load_dwordx4 v48, s[12:15], s80 offen lds
  v_mfma_f32_16x16x32_bf16 v[192:195], v[208:211], v[80:83], 0
  s_waitcnt lgkmcnt(2)
  v_mfma_f32_16x16x32_bf16 v[184:187], v[212:215], v[84:87], v[184:187]
  ds_read_b128 v[208:211], v70 offset:24832
  v_cvt_pk_bf16_f32 v248, v196, v197
  v_mfma_f32_16x16x32_bf16 v[188:191], v[212:215], v[88:91], v[188:191]
  s_add_u32 m0, s81, 13312
  s_nop 0
  buffer_load_dwordx4 v49, s[12:15], s80 offen lds
  v_mfma_f32_16x16x32_bf16 v[192:195], v[212:215], v[92:95], v[192:195]
  v_cvt_pk_bf16_f32 v249, v198, v199
  s_waitcnt lgkmcnt(2)
  v_mfma_f32_16x16x32_bf16 v[184:187], v[216:219], v[96:99], v[184:187]
  ds_read_b128 v[212:215], v71 offset:24832
  v_cvt_pk_bf16_f32 v250, v200, v201
  v_mfma_f32_16x16x32_bf16 v[188:191], v[216:219], v[100:103], v[188:191]
  s_add_u32 m0, s81, 14336
  s_nop 0
  buffer_load_dwordx4 v50, s[12:15], s80 offen lds
  v_mfma_f32_16x16x32_bf16 v[192:195], v[216:219], v[104:107], v[192:195]
  v_cvt_pk_bf16_f32 v251, v202, v203
  s_waitcnt lgkmcnt(2)
  v_mfma_f32_16x16x32_bf16 v[184:187], v[220:223], v[108:111], v[184:187]
  ds_read_b128 v[216:219], v70 offset:25344
  v_accvgpr_write_b32 a22, v248
  v_mfma_f32_16x16x32_bf16 v[188:191], v[220:223], v[112:115], v[188:191]
  s_add_u32 m0, s81, 15360
  s_nop 0
  buffer_load_dwordx4 v51, s[12:15], s80 offen lds
  v_mfma_f32_16x16x32_bf16 v[192:195], v[220:223], v[116:119], v[192:195]
  v_accvgpr_write_b32 a23, v249
  s_waitcnt lgkmcnt(2)
  v_mfma_f32_16x16x32_bf16 v[184:187], v[208:211], v[120:123], v[184:187]
  ds_read_b128 v[220:223], v71 offset:25344
  v_accvgpr_write_b32 a102, v250
  v_mfma_f32_16x16x32_bf16 v[188:191], v[208:211], v[124:127], v[188:191]
  s_add_u32 m0, s81, 16384
  s_nop 0
  buffer_load_dwordx4 v52, s[12:15], s80 offen lds
  v_mfma_f32_16x16x32_bf16 v[192:195], v[208:211], v[128:131], v[192:195]
  v_accvgpr_write_b32 a103, v251
  s_waitcnt lgkmcnt(2)
  v_mfma_f32_16x16x32_bf16 v[184:187], v[212:215], v[132:135], v[184:187]
  ds_read_b128 v[208:211], v70 offset:25472
  s_mov_b64 exec, s[68:69]
  v_cvt_pk_bf16_f32 v154, v204, v205
  v_cvt_pk_bf16_f32 v155, v206, v207
  s_mov_b64 exec, -1
  v_mfma_f32_16x16x32_bf16 v[188:191], v[212:215], v[136:139], v[188:191]
  s_add_u32 m0, s81, 17408
  s_nop 0
  buffer_load_dwordx4 v53, s[12:15], s80 offen lds
  v_mfma_f32_16x16x32_bf16 v[192:195], v[212:215], v[140:143], v[192:195]
  s_waitcnt lgkmcnt(2)
  v_mfma_f32_16x16x32_bf16 v[196:199], v[216:219], v[72:75], 0
  ds_read_b128 v[212:215], v71 offset:25472
  v_mfma_f32_16x16x32_bf16 v[200:203], v[216:219], v[76:79], 0
  s_add_u32 m0, s81, 18432
  s_nop 0
  buffer_load_dwordx4 v54, s[12:15], s80 offen lds
  v_mfma_f32_16x16x32_bf16 v[204:207], v[216:219], v[80:83], 0
  s_waitcnt lgkmcnt(2)
  v_mfma_f32_16x16x32_bf16 v[196:199], v[220:223], v[84:87], v[196:199]
  ds_read_b128 v[216:219], v70 offset:25600
  v_cvt_pk_bf16_f32 v248, v184, v185
  v_mfma_f32_16x16x32_bf16 v[200:203], v[220:223], v[88:91], v[200:203]
  s_add_u32 m0, s81, 19456
  s_nop 0
  buffer_load_dwordx4 v55, s[12:15], s80 offen lds
  v_mfma_f32_16x16x32_bf16 v[204:207], v[220:223], v[92:95], v[204:207]
  v_cvt_pk_bf16_f32 v249, v186, v187
  s_waitcnt lgkmcnt(2)
  v_mfma_f32_16x16x32_bf16 v[196:199], v[208:211], v[96:99], v[196:199]
  ds_read_b128 v[220:223], v71 offset:25600
  v_cvt_pk_bf16_f32 v250, v188, v189
  v_mfma_f32_16x16x32_bf16 v[200:203], v[208:211], v[100:103], v[200:203]
  s_add_u32 m0, s81, 20480
  s_nop 0
  buffer_load_dwordx4 v56, s[12:15], s80 offen lds
  v_mfma_f32_16x16x32_bf16 v[204:207], v[208:211], v[104:107], v[204:207]
  v_cvt_pk_bf16_f32 v251, v190, v191
  s_waitcnt lgkmcnt(2)
  v_mfma_f32_16x16x32_bf16 v[196:199], v[212:215], v[108:111], v[196:199]
  v_accvgpr_write_b32 a24, v248
  v_mfma_f32_16x16x32_bf16 v[200:203], v[212:215], v[112:115], v[200:203]
  s_add_u32 m0, s81, 21504
  s_nop 0
  buffer_load_dwordx4 v57, s[12:15], s80 offen lds
  v_mfma_f32_16x16x32_bf16 v[204:207], v[212:215], v[116:119], v[204:207]
  v_accvgpr_write_b32 a25, v249
  s_waitcnt lgkmcnt(1)
  v_mfma_f32_16x16x32_bf16 v[196:199], v[216:219], v[120:123], v[196:199]
  v_accvgpr_write_b32 a104, v250
  v_mfma_f32_16x16x32_bf16 v[200:203], v[216:219], v[124:127], v[200:203]
  s_add_u32 m0, s81, 22528
  s_nop 0
  buffer_load_dwordx4 v58, s[12:15], s80 offen lds
  v_mfma_f32_16x16x32_bf16 v[204:207], v[216:219], v[128:131], v[204:207]
  v_accvgpr_write_b32 a105, v251
  s_waitcnt lgkmcnt(0)
  v_mfma_f32_16x16x32_bf16 v[196:199], v[220:223], v[132:135], v[196:199]
  v_cvt_pk_bf16_f32 v156, v192, v193
  v_cvt_pk_bf16_f32 v157, v194, v195
  v_mfma_f32_16x16x32_bf16 v[200:203], v[220:223], v[136:139], v[200:203]
  s_add_u32 m0, s81, 23552
  s_nop 0
  buffer_load_dwordx4 v59, s[12:15], s80 offen lds
  s_add_u32 s80, s80, 393216
  v_mfma_f32_16x16x32_bf16 v[204:207], v[220:223], v[140:143], v[204:207]
  s_waitcnt vmcnt(12)
  ds_read_b128 v[208:211], v70 offset:0
  ds_read_b128 v[212:215], v71 offset:0
  ds_read_b128 v[216:219], v70 offset:128
  s_waitcnt lgkmcnt(2)
  v_mfma_f32_16x16x32_bf16 v[184:187], v[208:211], v[72:75], 0
  ds_read_b128 v[220:223], v71 offset:128
  v_mfma_f32_16x16x32_bf16 v[188:191], v[208:211], v[76:79], 0
  s_add_u32 m0, s81, 24576
  s_nop 0
  buffer_load_dwordx4 v48, s[12:15], s80 offen lds
  v_mfma_f32_16x16x32_bf16 v[192:195], v[208:211], v[80:83], 0
  s_waitcnt lgkmcnt(2)
  v_mfma_f32_16x16x32_bf16 v[184:187], v[212:215], v[84:87], v[184:187]
  ds_read_b128 v[208:211], v70 offset:256
  v_cvt_pk_bf16_f32 v248, v196, v197
  v_mfma_f32_16x16x32_bf16 v[188:191], v[212:215], v[88:91], v[188:191]
  s_add_u32 m0, s81, 25600
  s_nop 0
  buffer_load_dwordx4 v49, s[12:15], s80 offen lds
  v_mfma_f32_16x16x32_bf16 v[192:195], v[212:215], v[92:95], v[192:195]
  v_cvt_pk_bf16_f32 v249, v198, v199
  s_waitcnt lgkmcnt(2)
  v_mfma_f32_16x16x32_bf16 v[184:187], v[216:219], v[96:99], v[184:187]
  ds_read_b128 v[212:215], v71 offset:256
  v_cvt_pk_bf16_f32 v250, v200, v201
  v_mfma_f32_16x16x32_bf16 v[188:191], v[216:219], v[100:103], v[188:191]
  s_add_u32 m0, s81, 26624
  s_nop 0
  buffer_load_dwordx4 v50, s[12:15], s80 offen lds
  v_mfma_f32_16x16x32_bf16 v[192:195], v[216:219], v[104:107], v[192:195]
  v_cvt_pk_bf16_f32 v251, v202, v203
  s_waitcnt lgkmcnt(2)
  v_mfma_f32_16x16x32_bf16 v[184:187], v[220:223], v[108:111], v[184:187]
  ds_read_b128 v[216:219], v70 offset:768
  v_accvgpr_write_b32 a26, v248
  v_mfma_f32_16x16x32_bf16 v[188:191], v[220:223], v[112:115], v[188:191]
  s_add_u32 m0, s81, 27648
  s_nop 0
  buffer_load_dwordx4 v51, s[12:15], s80 offen lds
  v_mfma_f32_16x16x32_bf16 v[192:195], v[220:223], v[116:119], v[192:195]
  v_accvgpr_write_b32 a27, v249
  s_waitcnt lgkmcnt(2)
  v_mfma_f32_16x16x32_bf16 v[184:187], v[208:211], v[120:123], v[184:187]
  ds_read_b128 v[220:223], v71 offset:768
  v_accvgpr_write_b32 a106, v250
  v_mfma_f32_16x16x32_bf16 v[188:191], v[208:211], v[124:127], v[188:191]
  s_add_u32 m0, s81, 28672
  s_nop 0
  buffer_load_dwordx4 v52, s[12:15], s80 offen lds
  v_mfma_f32_16x16x32_bf16 v[192:195], v[208:211], v[128:131], v[192:195]
  v_accvgpr_write_b32 a107, v251
  s_waitcnt lgkmcnt(2)
  v_mfma_f32_16x16x32_bf16 v[184:187], v[212:215], v[132:135], v[184:187]
  ds_read_b128 v[208:211], v70 offset:896
  s_mov_b64 exec, s[68:69]
  v_cvt_pk_bf16_f32 v156, v204, v205
  v_cvt_pk_bf16_f32 v157, v206, v207
  s_mov_b64 exec, -1
  v_mfma_f32_16x16x32_bf16 v[188:191], v[212:215], v[136:139], v[188:191]
  s_add_u32 m0, s81, 29696
  s_nop 0
  buffer_load_dwordx4 v53, s[12:15], s80 offen lds
  v_mfma_f32_16x16x32_bf16 v[192:195], v[212:215], v[140:143], v[192:195]
  s_waitcnt lgkmcnt(2)
  v_mfma_f32_16x16x32_bf16 v[196:199], v[216:219], v[72:75], 0
  ds_read_b128 v[212:215], v71 offset:896
  v_mfma_f32_16x16x32_bf16 v[200:203], v[216:219], v[76:79], 0
  s_add_u32 m0, s81, 30720
  s_nop 0
  buffer_load_dwordx4 v54, s[12:15], s80 offen lds
  v_mfma_f32_16x16x32_bf16 v[204:207], v[216:219], v[80:83], 0
  s_waitcnt lgkmcnt(2)
  v_mfma_f32_16x16x32_bf16 v[196:199], v[220:223], v[84:87], v[196:199]
  ds_read_b128 v[216:219], v70 offset:1024
  v_cvt_pk_bf16_f32 v248, v184, v185
  v_mfma_f32_16x16x32_bf16 v[200:203], v[220:223], v[88:91], v[200:203]
  s_add_u32 m0, s81, 31744
  s_nop 0
  buffer_load_dwordx4 v55, s[12:15], s80 offen lds
  v_mfma_f32_16x16x32_bf16 v[204:207], v[220:223], v[92:95], v[204:207]
  v_cvt_pk_bf16_f32 v249, v186, v187
  s_waitcnt lgkmcnt(2)
  v_mfma_f32_16x16x32_bf16 v[196:199], v[208:211], v[96:99], v[196:199]
  ds_read_b128 v[220:223], v71 offset:1024
  v_cvt_pk_bf16_f32 v250, v188, v189
  v_mfma_f32_16x16x32_bf16 v[200:203], v[208:211], v[100:103], v[200:203]
  s_add_u32 m0, s81, 32768
  s_nop 0
  buffer_load_dwordx4 v56, s[12:15], s80 offen lds
  v_mfma_f32_16x16x32_bf16 v[204:207], v[208:211], v[104:107], v[204:207]
  v_cvt_pk_bf16_f32 v251, v190, v191
  s_waitcnt lgkmcnt(2)
  v_mfma_f32_16x16x32_bf16 v[196:199], v[212:215], v[108:111], v[196:199]
  v_accvgpr_write_b32 a28, v248
  v_mfma_f32_16x16x32_bf16 v[200:203], v[212:215], v[112:115], v[200:203]
  s_add_u32 m0, s81, 33792
  s_nop 0
  buffer_load_dwordx4 v57, s[12:15], s80 offen lds
  v_mfma_f32_16x16x32_bf16 v[204:207], v[212:215], v[116:119], v[204:207]
  v_accvgpr_write_b32 a29, v249
  s_waitcnt lgkmcnt(1)
  v_mfma_f32_16x16x32_bf16 v[196:199], v[216:219], v[120:123], v[196:199]
  v_accvgpr_write_b32 a108, v250
  v_mfma_f32_16x16x32_bf16 v[200:203], v[216:219], v[124:127], v[200:203]
  s_add_u32 m0, s81, 34816
  s_nop 0
  buffer_load_dwordx4 v58, s[12:15], s80 offen lds
  v_mfma_f32_16x16x32_bf16 v[204:207], v[216:219], v[128:131], v[204:207]
  v_accvgpr_write_b32 a109, v251
  s_waitcnt lgkmcnt(0)
  v_mfma_f32_16x16x32_bf16 v[196:199], v[220:223], v[132:135], v[196:199]
  v_cvt_pk_bf16_f32 v158, v192, v193
  v_cvt_pk_bf16_f32 v159, v194, v195
  v_mfma_f32_16x16x32_bf16 v[200:203], v[220:223], v[136:139], v[200:203]
  s_add_u32 m0, s81, 35840
  s_nop 0
  buffer_load_dwordx4 v59, s[12:15], s80 offen lds
  s_add_u32 s80, s80, 393216
  v_mfma_f32_16x16x32_bf16 v[204:207], v[220:223], v[140:143], v[204:207]
  s_waitcnt vmcnt(12)
  ds_read_b128 v[208:211], v70 offset:12288
  ds_read_b128 v[212:215], v71 offset:12288
  ds_read_b128 v[216:219], v70 offset:12416
  s_waitcnt lgkmcnt(2)
  v_mfma_f32_16x16x32_bf16 v[184:187], v[208:211], v[72:75], 0
  ds_read_b128 v[220:223], v71 offset:12416
  v_mfma_f32_16x16x32_bf16 v[188:191], v[208:211], v[76:79], 0
  s_add_u32 m0, s81, 0
  s_nop 0
  buffer_load_dwordx4 v48, s[12:15], s80 offen lds
  v_mfma_f32_16x16x32_bf16 v[192:195], v[208:211], v[80:83], 0
  s_waitcnt lgkmcnt(2)
  v_mfma_f32_16x16x32_bf16 v[184:187], v[212:215], v[84:87], v[184:187]
  ds_read_b128 v[208:211], v70 offset:12544
  v_cvt_pk_bf16_f32 v248, v196, v197
  v_mfma_f32_16x16x32_bf16 v[188:191], v[212:215], v[88:91], v[188:191]
  s_add_u32 m0, s81, 1024
  s_nop 0
  buffer_load_dwordx4 v49, s[12:15], s80 offen lds
  v_mfma_f32_16x16x32_bf16 v[192:195], v[212:215], v[92:95], v[192:195]
  v_cvt_pk_bf16_f32 v249, v198, v199
  s_waitcnt lgkmcnt(2)
  v_mfma_f32_16x16x32_bf16 v[184:187], v[216:219], v[96:99], v[184:187]
  ds_read_b128 v[212:215], v71 offset:12544
  v_cvt_pk_bf16_f32 v250, v200, v201
  v_mfma_f32_16x16x32_bf16 v[188:191], v[216:219], v[100:103], v[188:191]
  s_add_u32 m0, s81, 2048
  s_nop 0
  buffer_load_dwordx4 v50, s[12:15], s80 offen lds
  v_mfma_f32_16x16x32_bf16 v[192:195], v[216:219], v[104:107], v[192:195]
  v_cvt_pk_bf16_f32 v251, v202, v203
  s_waitcnt lgkmcnt(2)
  v_mfma_f32_16x16x32_bf16 v[184:187], v[220:223], v[108:111], v[184:187]
  ds_read_b128 v[216:219], v70 offset:13056
  v_accvgpr_write_b32 a30, v248
  v_mfma_f32_16x16x32_bf16 v[188:191], v[220:223], v[112:115], v[188:191]
  s_add_u32 m0, s81, 3072
  s_nop 0
  buffer_load_dwordx4 v51, s[12:15], s80 offen lds
  v_mfma_f32_16x16x32_bf16 v[192:195], v[220:223], v[116:119], v[192:195]
  v_accvgpr_write_b32 a31, v249
  s_waitcnt lgkmcnt(2)
  v_mfma_f32_16x16x32_bf16 v[184:187], v[208:211], v[120:123], v[184:187]
  ds_read_b128 v[220:223], v71 offset:13056
  v_accvgpr_write_b32 a110, v250
  v_mfma_f32_16x16x32_bf16 v[188:191], v[208:211], v[124:127], v[188:191]
  s_add_u32 m0, s81, 4096
  s_nop 0
  buffer_load_dwordx4 v52, s[12:15], s80 offen lds
  v_mfma_f32_16x16x32_bf16 v[192:195], v[208:211], v[128:131], v[192:195]
  v_accvgpr_write_b32 a111, v251
  s_waitcnt lgkmcnt(2)
  v_mfma_f32_16x16x32_bf16 v[184:187], v[212:215], v[132:135], v[184:187]
  ds_read_b128 v[208:211], v70 offset:13184
  s_mov_b64 exec, s[68:69]
  v_cvt_pk_bf16_f32 v158, v204, v205
  v_cvt_pk_bf16_f32 v159, v206, v207
  s_mov_b64 exec, -1
  v_mfma_f32_16x16x32_bf16 v[188:191], v[212:215], v[136:139], v[188:191]
  s_add_u32 m0, s81, 5120
  s_nop 0
  buffer_load_dwordx4 v53, s[12:15], s80 offen lds
  v_mfma_f32_16x16x32_bf16 v[192:195], v[212:215], v[140:143], v[192:195]
  s_waitcnt lgkmcnt(2)
  v_mfma_f32_16x16x32_bf16 v[196:199], v[216:219], v[72:75], 0
  ds_read_b128 v[212:215], v71 offset:13184
  v_mfma_f32_16x16x32_bf16 v[200:203], v[216:219], v[76:79], 0
  s_add_u32 m0, s81, 6144
  s_nop 0
  buffer_load_dwordx4 v54, s[12:15], s80 offen lds
  v_mfma_f32_16x16x32_bf16 v[204:207], v[216:219], v[80:83], 0
  s_waitcnt lgkmcnt(2)
  v_mfma_f32_16x16x32_bf16 v[196:199], v[220:223], v[84:87], v[196:199]
  ds_read_b128 v[216:219], v70 offset:13312
  v_cvt_pk_bf16_f32 v248, v184, v185
  v_mfma_f32_16x16x32_bf16 v[200:203], v[220:223], v[88:91], v[200:203]
  s_add_u32 m0, s81, 7168
  s_nop 0
  buffer_load_dwordx4 v55, s[12:15], s80 offen lds
  v_mfma_f32_16x16x32_bf16 v[204:207], v[220:223], v[92:95], v[204:207]
  v_cvt_pk_bf16_f32 v249, v186, v187
  s_waitcnt lgkmcnt(2)
  v_mfma_f32_16x16x32_bf16 v[196:199], v[208:211], v[96:99], v[196:199]
  ds_read_b128 v[220:223], v71 offset:13312
  v_cvt_pk_bf16_f32 v250, v188, v189
  v_mfma_f32_16x16x32_bf16 v[200:203], v[208:211], v[100:103], v[200:203]
  s_add_u32 m0, s81, 8192
  s_nop 0
  buffer_load_dwordx4 v56, s[12:15], s80 offen lds
  v_mfma_f32_16x16x32_bf16 v[204:207], v[208:211], v[104:107], v[204:207]
  v_cvt_pk_bf16_f32 v251, v190, v191
  s_waitcnt lgkmcnt(2)
  v_mfma_f32_16x16x32_bf16 v[196:199], v[212:215], v[108:111], v[196:199]
  v_accvgpr_write_b32 a32, v248
  v_mfma_f32_16x16x32_bf16 v[200:203], v[212:215], v[112:115], v[200:203]
  s_add_u32 m0, s81, 9216
  s_nop 0
  buffer_load_dwordx4 v57, s[12:15], s80 offen lds
  v_mfma_f32_16x16x32_bf16 v[204:207], v[212:215], v[116:119], v[204:207]
  v_accvgpr_write_b32 a33, v249
  s_waitcnt lgkmcnt(1)
  v_mfma_f32_16x16x32_bf16 v[196:199], v[216:219], v[120:123], v[196:199]
  v_accvgpr_write_b32 a112, v250
  v_mfma_f32_16x16x32_bf16 v[200:203], v[216:219], v[124:127], v[200:203]
  s_add_u32 m0, s81, 10240
  s_nop 0
  buffer_load_dwordx4 v58, s[12:15], s80 offen lds
  v_mfma_f32_16x16x32_bf16 v[204:207], v[216:219], v[128:131], v[204:207]
  v_accvgpr_write_b32 a113, v251
  s_waitcnt lgkmcnt(0)
  v_mfma_f32_16x16x32_bf16 v[196:199], v[220:223], v[132:135], v[196:199]
  v_cvt_pk_bf16_f32 v160, v192, v193
  v_cvt_pk_bf16_f32 v161, v194, v195
  v_mfma_f32_16x16x32_bf16 v[200:203], v[220:223], v[136:139], v[200:203]
  s_add_u32 m0, s81, 11264
  s_nop 0
  buffer_load_dwordx4 v59, s[12:15], s80 offen lds
  s_add_u32 s80, s80, 393216
  v_mfma_f32_16x16x32_bf16 v[204:207], v[220:223], v[140:143], v[204:207]
  s_waitcnt vmcnt(12)
  ds_read_b128 v[208:211], v70 offset:24576
  ds_read_b128 v[212:215], v71 offset:24576
  ds_read_b128 v[216:219], v70 offset:24704
  s_waitcnt lgkmcnt(2)
  v_mfma_f32_16x16x32_bf16 v[184:187], v[208:211], v[72:75], 0
  ds_read_b128 v[220:223], v71 offset:24704
  v_mfma_f32_16x16x32_bf16 v[188:191], v[208:211], v[76:79], 0
  s_add_u32 m0, s81, 12288
  s_nop 0
  buffer_load_dwordx4 v48, s[12:15], s80 offen lds
  v_mfma_f32_16x16x32_bf16 v[192:195], v[208:211], v[80:83], 0
  s_waitcnt lgkmcnt(2)
  v_mfma_f32_16x16x32_bf16 v[184:187], v[212:215], v[84:87], v[184:187]
  ds_read_b128 v[208:211], v70 offset:24832
  v_cvt_pk_bf16_f32 v248, v196, v197
  v_mfma_f32_16x16x32_bf16 v[188:191], v[212:215], v[88:91], v[188:191]
  s_add_u32 m0, s81, 13312
  s_nop 0
  buffer_load_dwordx4 v49, s[12:15], s80 offen lds
  v_mfma_f32_16x16x32_bf16 v[192:195], v[212:215], v[92:95], v[192:195]
  v_cvt_pk_bf16_f32 v249, v198, v199
  s_waitcnt lgkmcnt(2)
  v_mfma_f32_16x16x32_bf16 v[184:187], v[216:219], v[96:99], v[184:187]
  ds_read_b128 v[212:215], v71 offset:24832
  v_cvt_pk_bf16_f32 v250, v200, v201
  v_mfma_f32_16x16x32_bf16 v[188:191], v[216:219], v[100:103], v[188:191]
  s_add_u32 m0, s81, 14336
  s_nop 0
  buffer_load_dwordx4 v50, s[12:15], s80 offen lds
  v_mfma_f32_16x16x32_bf16 v[192:195], v[216:219], v[104:107], v[192:195]
  v_cvt_pk_bf16_f32 v251, v202, v203
  s_waitcnt lgkmcnt(2)
  v_mfma_f32_16x16x32_bf16 v[184:187], v[220:223], v[108:111], v[184:187]
  ds_read_b128 v[216:219], v70 offset:25344
  v_accvgpr_write_b32 a34, v248
  v_mfma_f32_16x16x32_bf16 v[188:191], v[220:223], v[112:115], v[188:191]
  s_add_u32 m0, s81, 15360
  s_nop 0
  buffer_load_dwordx4 v51, s[12:15], s80 offen lds
  v_mfma_f32_16x16x32_bf16 v[192:195], v[220:223], v[116:119], v[192:195]
  v_accvgpr_write_b32 a35, v249
  s_waitcnt lgkmcnt(2)
  v_mfma_f32_16x16x32_bf16 v[184:187], v[208:211], v[120:123], v[184:187]
  ds_read_b128 v[220:223], v71 offset:25344
  v_accvgpr_write_b32 a114, v250
  v_mfma_f32_16x16x32_bf16 v[188:191], v[208:211], v[124:127], v[188:191]
  s_add_u32 m0, s81, 16384
  s_nop 0
  buffer_load_dwordx4 v52, s[12:15], s80 offen lds
  v_mfma_f32_16x16x32_bf16 v[192:195], v[208:211], v[128:131], v[192:195]
  v_accvgpr_write_b32 a115, v251
  s_waitcnt lgkmcnt(2)
  v_mfma_f32_16x16x32_bf16 v[184:187], v[212:215], v[132:135], v[184:187]
  ds_read_b128 v[208:211], v70 offset:25472
  s_mov_b64 exec, s[68:69]
  v_cvt_pk_bf16_f32 v160, v204, v205
  v_cvt_pk_bf16_f32 v161, v206, v207
  s_mov_b64 exec, -1
  v_mfma_f32_16x16x32_bf16 v[188:191], v[212:215], v[136:139], v[188:191]
  s_add_u32 m0, s81, 17408
  s_nop 0
  buffer_load_dwordx4 v53, s[12:15], s80 offen lds
  v_mfma_f32_16x16x32_bf16 v[192:195], v[212:215], v[140:143], v[192:195]
  s_waitcnt lgkmcnt(2)
  v_mfma_f32_16x16x32_bf16 v[196:199], v[216:219], v[72:75], 0
  ds_read_b128 v[212:215], v71 offset:25472
  v_mfma_f32_16x16x32_bf16 v[200:203], v[216:219], v[76:79], 0
  s_add_u32 m0, s81, 18432
  s_nop 0
  buffer_load_dwordx4 v54, s[12:15], s80 offen lds
  v_mfma_f32_16x16x32_bf16 v[204:207], v[216:219], v[80:83], 0
  s_waitcnt lgkmcnt(2)
  v_mfma_f32_16x16x32_bf16 v[196:199], v[220:223], v[84:87], v[196:199]
  ds_read_b128 v[216:219], v70 offset:25600
  v_cvt_pk_bf16_f32 v248, v184, v185
  v_mfma_f32_16x16x32_bf16 v[200:203], v[220:223], v[88:91], v[200:203]
  s_add_u32 m0, s81, 19456
  s_nop 0
  buffer_load_dwordx4 v55, s[12:15], s80 offen lds
  v_mfma_f32_16x16x32_bf16 v[204:207], v[220:223], v[92:95], v[204:207]
  v_cvt_pk_bf16_f32 v249, v186, v187
  s_waitcnt lgkmcnt(2)
  v_mfma_f32_16x16x32_bf16 v[196:199], v[208:211], v[96:99], v[196:199]
  ds_read_b128 v[220:223], v71 offset:25600
  v_cvt_pk_bf16_f32 v250, v188, v189
  v_mfma_f32_16x16x32_bf16 v[200:203], v[208:211], v[100:103], v[200:203]
  s_add_u32 m0, s81, 20480
  s_nop 0
  buffer_load_dwordx4 v56, s[12:15], s80 offen lds
  v_mfma_f32_16x16x32_bf16 v[204:207], v[208:211], v[104:107], v[204:207]
  v_cvt_pk_bf16_f32 v251, v190, v191
  s_waitcnt lgkmcnt(2)
  v_mfma_f32_16x16x32_bf16 v[196:199], v[212:215], v[108:111], v[196:199]
  v_accvgpr_write_b32 a36, v248
  v_mfma_f32_16x16x32_bf16 v[200:203], v[212:215], v[112:115], v[200:203]
  s_add_u32 m0, s81, 21504
  s_nop 0
  buffer_load_dwordx4 v57, s[12:15], s80 offen lds
  v_mfma_f32_16x16x32_bf16 v[204:207], v[212:215], v[116:119], v[204:207]
  v_accvgpr_write_b32 a37, v249
  s_waitcnt lgkmcnt(1)
  v_mfma_f32_16x16x32_bf16 v[196:199], v[216:219], v[120:123], v[196:199]
  v_accvgpr_write_b32 a116, v250
  v_mfma_f32_16x16x32_bf16 v[200:203], v[216:219], v[124:127], v[200:203]
  s_add_u32 m0, s81, 22528
  s_nop 0
  buffer_load_dwordx4 v58, s[12:15], s80 offen lds
  v_mfma_f32_16x16x32_bf16 v[204:207], v[216:219], v[128:131], v[204:207]
  v_accvgpr_write_b32 a117, v251
  s_waitcnt lgkmcnt(0)
  v_mfma_f32_16x16x32_bf16 v[196:199], v[220:223], v[132:135], v[196:199]
  v_cvt_pk_bf16_f32 v162, v192, v193
  v_cvt_pk_bf16_f32 v163, v194, v195
  v_mfma_f32_16x16x32_bf16 v[200:203], v[220:223], v[136:139], v[200:203]
  s_add_u32 m0, s81, 23552
  s_nop 0
  buffer_load_dwordx4 v59, s[12:15], s80 offen lds
  s_add_u32 s80, s80, 393216
  v_mfma_f32_16x16x32_bf16 v[204:207], v[220:223], v[140:143], v[204:207]
  s_waitcnt vmcnt(12)
  ds_read_b128 v[208:211], v70 offset:0
  ds_read_b128 v[212:215], v71 offset:0
  ds_read_b128 v[216:219], v70 offset:128
  s_waitcnt lgkmcnt(2)
  v_mfma_f32_16x16x32_bf16 v[184:187], v[208:211], v[72:75], 0
  ds_read_b128 v[220:223], v71 offset:128
  v_mfma_f32_16x16x32_bf16 v[188:191], v[208:211], v[76:79], 0
  s_add_u32 m0, s81, 24576
  s_nop 0
  buffer_load_dwordx4 v48, s[12:15], s80 offen lds
  v_mfma_f32_16x16x32_bf16 v[192:195], v[208:211], v[80:83], 0
  s_waitcnt lgkmcnt(2)
  v_mfma_f32_16x16x32_bf16 v[184:187], v[212:215], v[84:87], v[184:187]
  ds_read_b128 v[208:211], v70 offset:256
  v_cvt_pk_bf16_f32 v248, v196, v197
  v_mfma_f32_16x16x32_bf16 v[188:191], v[212:215], v[88:91], v[188:191]
  s_add_u32 m0, s81, 25600
  s_nop 0
  buffer_load_dwordx4 v49, s[12:15], s80 offen lds
  v_mfma_f32_16x16x32_bf16 v[192:195], v[212:215], v[92:95], v[192:195]
  v_cvt_pk_bf16_f32 v249, v198, v199
  s_waitcnt lgkmcnt(2)
  v_mfma_f32_16x16x32_bf16 v[184:187], v[216:219], v[96:99], v[184:187]
  ds_read_b128 v[212:215], v71 offset:256
  v_cvt_pk_bf16_f32 v250, v200, v201
  v_mfma_f32_16x16x32_bf16 v[188:191], v[216:219], v[100:103], v[188:191]
  s_add_u32 m0, s81, 26624
  s_nop 0
  buffer_load_dwordx4 v50, s[12:15], s80 offen lds
  v_mfma_f32_16x16x32_bf16 v[192:195], v[216:219], v[104:107], v[192:195]
  v_cvt_pk_bf16_f32 v251, v202, v203
  s_waitcnt lgkmcnt(2)
  v_mfma_f32_16x16x32_bf16 v[184:187], v[220:223], v[108:111], v[184:187]
  ds_read_b128 v[216:219], v70 offset:768
  v_accvgpr_write_b32 a38, v248
  v_mfma_f32_16x16x32_bf16 v[188:191], v[220:223], v[112:115], v[188:191]
  s_add_u32 m0, s81, 27648
  s_nop 0
  buffer_load_dwordx4 v51, s[12:15], s80 offen lds
  v_mfma_f32_16x16x32_bf16 v[192:195], v[220:223], v[116:119], v[192:195]
  v_accvgpr_write_b32 a39, v249
  s_waitcnt lgkmcnt(2)
  v_mfma_f32_16x16x32_bf16 v[184:187], v[208:211], v[120:123], v[184:187]
  ds_read_b128 v[220:223], v71 offset:768
  v_accvgpr_write_b32 a118, v250
  v_mfma_f32_16x16x32_bf16 v[188:191], v[208:211], v[124:127], v[188:191]
  s_add_u32 m0, s81, 28672
  s_nop 0
  buffer_load_dwordx4 v52, s[12:15], s80 offen lds
  v_mfma_f32_16x16x32_bf16 v[192:195], v[208:211], v[128:131], v[192:195]
  v_accvgpr_write_b32 a119, v251
  s_waitcnt lgkmcnt(2)
  v_mfma_f32_16x16x32_bf16 v[184:187], v[212:215], v[132:135], v[184:187]
  ds_read_b128 v[208:211], v70 offset:896
  s_mov_b64 exec, s[68:69]
  v_cvt_pk_bf16_f32 v162, v204, v205
  v_cvt_pk_bf16_f32 v163, v206, v207
  s_mov_b64 exec, -1
  v_mfma_f32_16x16x32_bf16 v[188:191], v[212:215], v[136:139], v[188:191]
  s_add_u32 m0, s81, 29696
  s_nop 0
  buffer_load_dwordx4 v53, s[12:15], s80 offen lds
  v_mfma_f32_16x16x32_bf16 v[192:195], v[212:215], v[140:143], v[192:195]
  s_waitcnt lgkmcnt(2)
  v_mfma_f32_16x16x32_bf16 v[196:199], v[216:219], v[72:75], 0
  ds_read_b128 v[212:215], v71 offset:896
  v_mfma_f32_16x16x32_bf16 v[200:203], v[216:219], v[76:79], 0
  s_add_u32 m0, s81, 30720
  s_nop 0
  buffer_load_dwordx4 v54, s[12:15], s80 offen lds
  v_mfma_f32_16x16x32_bf16 v[204:207], v[216:219], v[80:83], 0
  s_waitcnt lgkmcnt(2)
  v_mfma_f32_16x16x32_bf16 v[196:199], v[220:223], v[84:87], v[196:199]
  ds_read_b128 v[216:219], v70 offset:1024
  v_cvt_pk_bf16_f32 v248, v184, v185
  v_mfma_f32_16x16x32_bf16 v[200:203], v[220:223], v[88:91], v[200:203]
  s_add_u32 m0, s81, 31744
  s_nop 0
  buffer_load_dwordx4 v55, s[12:15], s80 offen lds
  v_mfma_f32_16x16x32_bf16 v[204:207], v[220:223], v[92:95], v[204:207]
  v_cvt_pk_bf16_f32 v249, v186, v187
  s_waitcnt lgkmcnt(2)
  v_mfma_f32_16x16x32_bf16 v[196:199], v[208:211], v[96:99], v[196:199]
  ds_read_b128 v[220:223], v71 offset:1024
  v_cvt_pk_bf16_f32 v250, v188, v189
  v_mfma_f32_16x16x32_bf16 v[200:203], v[208:211], v[100:103], v[200:203]
  s_add_u32 m0, s81, 32768
  s_nop 0
  buffer_load_dwordx4 v56, s[12:15], s80 offen lds
  v_mfma_f32_16x16x32_bf16 v[204:207], v[208:211], v[104:107], v[204:207]
  v_cvt_pk_bf16_f32 v251, v190, v191
  s_waitcnt lgkmcnt(2)
  v_mfma_f32_16x16x32_bf16 v[196:199], v[212:215], v[108:111], v[196:199]
  v_accvgpr_write_b32 a40, v248
  v_mfma_f32_16x16x32_bf16 v[200:203], v[212:215], v[112:115], v[200:203]
  s_add_u32 m0, s81, 33792
  s_nop 0
  buffer_load_dwordx4 v57, s[12:15], s80 offen lds
  v_mfma_f32_16x16x32_bf16 v[204:207], v[212:215], v[116:119], v[204:207]
  v_accvgpr_write_b32 a41, v249
  s_waitcnt lgkmcnt(1)
  v_mfma_f32_16x16x32_bf16 v[196:199], v[216:219], v[120:123], v[196:199]
  v_accvgpr_write_b32 a120, v250
  v_mfma_f32_16x16x32_bf16 v[200:203], v[216:219], v[124:127], v[200:203]
  s_add_u32 m0, s81, 34816
  s_nop 0
  buffer_load_dwordx4 v58, s[12:15], s80 offen lds
  v_mfma_f32_16x16x32_bf16 v[204:207], v[216:219], v[128:131], v[204:207]
  v_accvgpr_write_b32 a121, v251
  s_waitcnt lgkmcnt(0)
  v_mfma_f32_16x16x32_bf16 v[196:199], v[220:223], v[132:135], v[196:199]
  v_cvt_pk_bf16_f32 v164, v192, v193
  v_cvt_pk_bf16_f32 v165, v194, v195
  v_mfma_f32_16x16x32_bf16 v[200:203], v[220:223], v[136:139], v[200:203]
  s_add_u32 m0, s81, 35840
  s_nop 0
  buffer_load_dwordx4 v59, s[12:15], s80 offen lds
  s_add_u32 s80, s80, 393216
  v_mfma_f32_16x16x32_bf16 v[204:207], v[220:223], v[140:143], v[204:207]
  s_waitcnt vmcnt(12)
  ds_read_b128 v[208:211], v70 offset:12288
  ds_read_b128 v[212:215], v71 offset:12288
  ds_read_b128 v[216:219], v70 offset:12416
  s_waitcnt lgkmcnt(2)
  v_mfma_f32_16x16x32_bf16 v[184:187], v[208:211], v[72:75], 0
  ds_read_b128 v[220:223], v71 offset:12416
  v_mfma_f32_16x16x32_bf16 v[188:191], v[208:211], v[76:79], 0
  s_add_u32 m0, s81, 0
  s_nop 0
  buffer_load_dwordx4 v48, s[12:15], s80 offen lds
  v_mfma_f32_16x16x32_bf16 v[192:195], v[208:211], v[80:83], 0
  s_waitcnt lgkmcnt(2)
  v_mfma_f32_16x16x32_bf16 v[184:187], v[212:215], v[84:87], v[184:187]
  ds_read_b128 v[208:211], v70 offset:12544
  v_cvt_pk_bf16_f32 v248, v196, v197
  v_mfma_f32_16x16x32_bf16 v[188:191], v[212:215], v[88:91], v[188:191]
  s_add_u32 m0, s81, 1024
  s_nop 0
  buffer_load_dwordx4 v49, s[12:15], s80 offen lds
  v_mfma_f32_16x16x32_bf16 v[192:195], v[212:215], v[92:95], v[192:195]
  v_cvt_pk_bf16_f32 v249, v198, v199
  s_waitcnt lgkmcnt(2)
  v_mfma_f32_16x16x32_bf16 v[184:187], v[216:219], v[96:99], v[184:187]
  ds_read_b128 v[212:215], v71 offset:12544
  v_cvt_pk_bf16_f32 v250, v200, v201
  v_mfma_f32_16x16x32_bf16 v[188:191], v[216:219], v[100:103], v[188:191]
  s_add_u32 m0, s81, 2048
  s_nop 0
  buffer_load_dwordx4 v50, s[12:15], s80 offen lds
  v_mfma_f32_16x16x32_bf16 v[192:195], v[216:219], v[104:107], v[192:195]
  v_cvt_pk_bf16_f32 v251, v202, v203
  s_waitcnt lgkmcnt(2)
  v_mfma_f32_16x16x32_bf16 v[184:187], v[220:223], v[108:111], v[184:187]
  ds_read_b128 v[216:219], v70 offset:13056
  v_accvgpr_write_b32 a42, v248
  v_mfma_f32_16x16x32_bf16 v[188:191], v[220:223], v[112:115], v[188:191]
  s_add_u32 m0, s81, 3072
  s_nop 0
  buffer_load_dwordx4 v51, s[12:15], s80 offen lds
  v_mfma_f32_16x16x32_bf16 v[192:195], v[220:223], v[116:119], v[192:195]
  v_accvgpr_write_b32 a43, v249
  s_waitcnt lgkmcnt(2)
  v_mfma_f32_16x16x32_bf16 v[184:187], v[208:211], v[120:123], v[184:187]
  ds_read_b128 v[220:223], v71 offset:13056
  v_accvgpr_write_b32 a122, v250
  v_mfma_f32_16x16x32_bf16 v[188:191], v[208:211], v[124:127], v[188:191]
  s_add_u32 m0, s81, 4096
  s_nop 0
  buffer_load_dwordx4 v52, s[12:15], s80 offen lds
  v_mfma_f32_16x16x32_bf16 v[192:195], v[208:211], v[128:131], v[192:195]
  v_accvgpr_write_b32 a123, v251
  s_waitcnt lgkmcnt(2)
  v_mfma_f32_16x16x32_bf16 v[184:187], v[212:215], v[132:135], v[184:187]
  ds_read_b128 v[208:211], v70 offset:13184
  s_mov_b64 exec, s[68:69]
  v_cvt_pk_bf16_f32 v164, v204, v205
  v_cvt_pk_bf16_f32 v165, v206, v207
  s_mov_b64 exec, -1
  v_mfma_f32_16x16x32_bf16 v[188:191], v[212:215], v[136:139], v[188:191]
  s_add_u32 m0, s81, 5120
  s_nop 0
  buffer_load_dwordx4 v53, s[12:15], s80 offen lds
  v_mfma_f32_16x16x32_bf16 v[192:195], v[212:215], v[140:143], v[192:195]
  s_waitcnt lgkmcnt(2)
  v_mfma_f32_16x16x32_bf16 v[196:199], v[216:219], v[72:75], 0
  ds_read_b128 v[212:215], v71 offset:13184
  v_mfma_f32_16x16x32_bf16 v[200:203], v[216:219], v[76:79], 0
  s_add_u32 m0, s81, 6144
  s_nop 0
  buffer_load_dwordx4 v54, s[12:15], s80 offen lds
  v_mfma_f32_16x16x32_bf16 v[204:207], v[216:219], v[80:83], 0
  s_waitcnt lgkmcnt(2)
  v_mfma_f32_16x16x32_bf16 v[196:199], v[220:223], v[84:87], v[196:199]
  ds_read_b128 v[216:219], v70 offset:13312
  v_cvt_pk_bf16_f32 v248, v184, v185
  v_mfma_f32_16x16x32_bf16 v[200:203], v[220:223], v[88:91], v[200:203]
  s_add_u32 m0, s81, 7168
  s_nop 0
  buffer_load_dwordx4 v55, s[12:15], s80 offen lds
  v_mfma_f32_16x16x32_bf16 v[204:207], v[220:223], v[92:95], v[204:207]
  v_cvt_pk_bf16_f32 v249, v186, v187
  s_waitcnt lgkmcnt(2)
  v_mfma_f32_16x16x32_bf16 v[196:199], v[208:211], v[96:99], v[196:199]
  ds_read_b128 v[220:223], v71 offset:13312
  v_cvt_pk_bf16_f32 v250, v188, v189
  v_mfma_f32_16x16x32_bf16 v[200:203], v[208:211], v[100:103], v[200:203]
  s_add_u32 m0, s81, 8192
  s_nop 0
  buffer_load_dwordx4 v56, s[12:15], s80 offen lds
  v_mfma_f32_16x16x32_bf16 v[204:207], v[208:211], v[104:107], v[204:207]
  v_cvt_pk_bf16_f32 v251, v190, v191
  s_waitcnt lgkmcnt(2)
  v_mfma_f32_16x16x32_bf16 v[196:199], v[212:215], v[108:111], v[196:199]
  v_accvgpr_write_b32 a44, v248
  v_mfma_f32_16x16x32_bf16 v[200:203], v[212:215], v[112:115], v[200:203]
  s_add_u32 m0, s81, 9216
  s_nop 0
  buffer_load_dwordx4 v57, s[12:15], s80 offen lds
  v_mfma_f32_16x16x32_bf16 v[204:207], v[212:215], v[116:119], v[204:207]
  v_accvgpr_write_b32 a45, v249
  s_waitcnt lgkmcnt(1)
  v_mfma_f32_16x16x32_bf16 v[196:199], v[216:219], v[120:123], v[196:199]
  v_accvgpr_write_b32 a124, v250
  v_mfma_f32_16x16x32_bf16 v[200:203], v[216:219], v[124:127], v[200:203]
  s_add_u32 m0, s81, 10240
  s_nop 0
  buffer_load_dwordx4 v58, s[12:15], s80 offen lds
  v_mfma_f32_16x16x32_bf16 v[204:207], v[216:219], v[128:131], v[204:207]
  v_accvgpr_write_b32 a125, v251
  s_waitcnt lgkmcnt(0)
  v_mfma_f32_16x16x32_bf16 v[196:199], v[220:223], v[132:135], v[196:199]
  v_cvt_pk_bf16_f32 v166, v192, v193
  v_cvt_pk_bf16_f32 v167, v194, v195
  v_mfma_f32_16x16x32_bf16 v[200:203], v[220:223], v[136:139], v[200:203]
  s_add_u32 m0, s81, 11264
  s_nop 0
  buffer_load_dwordx4 v59, s[12:15], s80 offen lds
  s_add_u32 s80, s80, 393216
  v_mfma_f32_16x16x32_bf16 v[204:207], v[220:223], v[140:143], v[204:207]
  s_waitcnt vmcnt(12)
  ds_read_b128 v[208:211], v70 offset:24576
  ds_read_b128 v[212:215], v71 offset:24576
  ds_read_b128 v[216:219], v70 offset:24704
  s_waitcnt lgkmcnt(2)
  v_mfma_f32_16x16x32_bf16 v[184:187], v[208:211], v[72:75], 0
  ds_read_b128 v[220:223], v71 offset:24704
  v_mfma_f32_16x16x32_bf16 v[188:191], v[208:211], v[76:79], 0
  s_add_u32 m0, s81, 12288
  s_nop 0
  buffer_load_dwordx4 v48, s[12:15], s80 offen lds
  v_mfma_f32_16x16x32_bf16 v[192:195], v[208:211], v[80:83], 0
  s_waitcnt lgkmcnt(2)
  v_mfma_f32_16x16x32_bf16 v[184:187], v[212:215], v[84:87], v[184:187]
  ds_read_b128 v[208:211], v70 offset:24832
  v_cvt_pk_bf16_f32 v248, v196, v197
  v_mfma_f32_16x16x32_bf16 v[188:191], v[212:215], v[88:91], v[188:191]
  s_add_u32 m0, s81, 13312
  s_nop 0
  buffer_load_dwordx4 v49, s[12:15], s80 offen lds
  v_mfma_f32_16x16x32_bf16 v[192:195], v[212:215], v[92:95], v[192:195]
  v_cvt_pk_bf16_f32 v249, v198, v199
  s_waitcnt lgkmcnt(2)
  v_mfma_f32_16x16x32_bf16 v[184:187], v[216:219], v[96:99], v[184:187]
  ds_read_b128 v[212:215], v71 offset:24832
  v_cvt_pk_bf16_f32 v250, v200, v201
  v_mfma_f32_16x16x32_bf16 v[188:191], v[216:219], v[100:103], v[188:191]
  s_add_u32 m0, s81, 14336
  s_nop 0
  buffer_load_dwordx4 v50, s[12:15], s80 offen lds
  v_mfma_f32_16x16x32_bf16 v[192:195], v[216:219], v[104:107], v[192:195]
  v_cvt_pk_bf16_f32 v251, v202, v203
  s_waitcnt lgkmcnt(2)
  v_mfma_f32_16x16x32_bf16 v[184:187], v[220:223], v[108:111], v[184:187]
  ds_read_b128 v[216:219], v70 offset:25344
  v_accvgpr_write_b32 a46, v248
  v_mfma_f32_16x16x32_bf16 v[188:191], v[220:223], v[112:115], v[188:191]
  s_add_u32 m0, s81, 15360
  s_nop 0
  buffer_load_dwordx4 v51, s[12:15], s80 offen lds
  v_mfma_f32_16x16x32_bf16 v[192:195], v[220:223], v[116:119], v[192:195]
  v_accvgpr_write_b32 a47, v249
  s_waitcnt lgkmcnt(2)
  v_mfma_f32_16x16x32_bf16 v[184:187], v[208:211], v[120:123], v[184:187]
  ds_read_b128 v[220:223], v71 offset:25344
  v_accvgpr_write_b32 a126, v250
  v_mfma_f32_16x16x32_bf16 v[188:191], v[208:211], v[124:127], v[188:191]
  s_add_u32 m0, s81, 16384
  s_nop 0
  buffer_load_dwordx4 v52, s[12:15], s80 offen lds
  v_mfma_f32_16x16x32_bf16 v[192:195], v[208:211], v[128:131], v[192:195]
  v_accvgpr_write_b32 a127, v251
  s_waitcnt lgkmcnt(2)
  v_mfma_f32_16x16x32_bf16 v[184:187], v[212:215], v[132:135], v[184:187]
  ds_read_b128 v[208:211], v70 offset:25472
  s_mov_b64 exec, s[68:69]
  v_cvt_pk_bf16_f32 v166, v204, v205
  v_cvt_pk_bf16_f32 v167, v206, v207
  s_mov_b64 exec, -1
  v_mfma_f32_16x16x32_bf16 v[188:191], v[212:215], v[136:139], v[188:191]
  s_add_u32 m0, s81, 17408
  s_nop 0
  buffer_load_dwordx4 v53, s[12:15], s80 offen lds
  v_mfma_f32_16x16x32_bf16 v[192:195], v[212:215], v[140:143], v[192:195]
  s_waitcnt lgkmcnt(2)
  v_mfma_f32_16x16x32_bf16 v[196:199], v[216:219], v[72:75], 0
  ds_read_b128 v[212:215], v71 offset:25472
  v_mfma_f32_16x16x32_bf16 v[200:203], v[216:219], v[76:79], 0
  s_add_u32 m0, s81, 18432
  s_nop 0
  buffer_load_dwordx4 v54, s[12:15], s80 offen lds
  v_mfma_f32_16x16x32_bf16 v[204:207], v[216:219], v[80:83], 0
  s_waitcnt lgkmcnt(2)
  v_mfma_f32_16x16x32_bf16 v[196:199], v[220:223], v[84:87], v[196:199]
  ds_read_b128 v[216:219], v70 offset:25600
  v_cvt_pk_bf16_f32 v248, v184, v185
  v_mfma_f32_16x16x32_bf16 v[200:203], v[220:223], v[88:91], v[200:203]
  s_add_u32 m0, s81, 19456
  s_nop 0
  buffer_load_dwordx4 v55, s[12:15], s80 offen lds
  v_mfma_f32_16x16x32_bf16 v[204:207], v[220:223], v[92:95], v[204:207]
  v_cvt_pk_bf16_f32 v249, v186, v187
  s_waitcnt lgkmcnt(2)
  v_mfma_f32_16x16x32_bf16 v[196:199], v[208:211], v[96:99], v[196:199]
  ds_read_b128 v[220:223], v71 offset:25600
  v_cvt_pk_bf16_f32 v250, v188, v189
  v_mfma_f32_16x16x32_bf16 v[200:203], v[208:211], v[100:103], v[200:203]
  s_add_u32 m0, s81, 20480
  s_nop 0
  buffer_load_dwordx4 v56, s[12:15], s80 offen lds
  v_mfma_f32_16x16x32_bf16 v[204:207], v[208:211], v[104:107], v[204:207]
  v_cvt_pk_bf16_f32 v251, v190, v191
  s_waitcnt lgkmcnt(2)
  v_mfma_f32_16x16x32_bf16 v[196:199], v[212:215], v[108:111], v[196:199]
  v_accvgpr_write_b32 a48, v248
  v_mfma_f32_16x16x32_bf16 v[200:203], v[212:215], v[112:115], v[200:203]
  s_add_u32 m0, s81, 21504
  s_nop 0
  buffer_load_dwordx4 v57, s[12:15], s80 offen lds
  v_mfma_f32_16x16x32_bf16 v[204:207], v[212:215], v[116:119], v[204:207]
  v_accvgpr_write_b32 a49, v249
  s_waitcnt lgkmcnt(1)
  v_mfma_f32_16x16x32_bf16 v[196:199], v[216:219], v[120:123], v[196:199]
  v_accvgpr_write_b32 a128, v250
  v_mfma_f32_16x16x32_bf16 v[200:203], v[216:219], v[124:127], v[200:203]
  s_add_u32 m0, s81, 22528
  s_nop 0
  buffer_load_dwordx4 v58, s[12:15], s80 offen lds
  v_mfma_f32_16x16x32_bf16 v[204:207], v[216:219], v[128:131], v[204:207]
  v_accvgpr_write_b32 a129, v251
  s_waitcnt lgkmcnt(0)
  v_mfma_f32_16x16x32_bf16 v[196:199], v[220:223], v[132:135], v[196:199]
  v_cvt_pk_bf16_f32 v168, v192, v193
  v_cvt_pk_bf16_f32 v169, v194, v195
  v_mfma_f32_16x16x32_bf16 v[200:203], v[220:223], v[136:139], v[200:203]
  s_add_u32 m0, s81, 23552
  s_nop 0
  buffer_load_dwordx4 v59, s[12:15], s80 offen lds
  s_add_u32 s80, s80, 393216
  v_mfma_f32_16x16x32_bf16 v[204:207], v[220:223], v[140:143], v[204:207]
  s_waitcnt vmcnt(12)
  ds_read_b128 v[208:211], v70 offset:0
  ds_read_b128 v[212:215], v71 offset:0
  ds_read_b128 v[216:219], v70 offset:128
  s_waitcnt lgkmcnt(2)
  v_mfma_f32_16x16x32_bf16 v[184:187], v[208:211], v[72:75], 0
  ds_read_b128 v[220:223], v71 offset:128
  v_mfma_f32_16x16x32_bf16 v[188:191], v[208:211], v[76:79], 0
  s_add_u32 m0, s81, 24576
  s_nop 0
  buffer_load_dwordx4 v48, s[12:15], s80 offen lds
  v_mfma_f32_16x16x32_bf16 v[192:195], v[208:211], v[80:83], 0
  s_waitcnt lgkmcnt(2)
  v_mfma_f32_16x16x32_bf16 v[184:187], v[212:215], v[84:87], v[184:187]
  ds_read_b128 v[208:211], v70 offset:256
  v_cvt_pk_bf16_f32 v248, v196, v197
  v_mfma_f32_16x16x32_bf16 v[188:191], v[212:215], v[88:91], v[188:191]
  s_add_u32 m0, s81, 25600
  s_nop 0
  buffer_load_dwordx4 v49, s[12:15], s80 offen lds
  v_mfma_f32_16x16x32_bf16 v[192:195], v[212:215], v[92:95], v[192:195]
  v_cvt_pk_bf16_f32 v249, v198, v199
  s_waitcnt lgkmcnt(2)
  v_mfma_f32_16x16x32_bf16 v[184:187], v[216:219], v[96:99], v[184:187]
  ds_read_b128 v[212:215], v71 offset:256
  v_cvt_pk_bf16_f32 v250, v200, v201
  v_mfma_f32_16x16x32_bf16 v[188:191], v[216:219], v[100:103], v[188:191]
  s_add_u32 m0, s81, 26624
  s_nop 0
  buffer_load_dwordx4 v50, s[12:15], s80 offen lds
  v_mfma_f32_16x16x32_bf16 v[192:195], v[216:219], v[104:107], v[192:195]
  v_cvt_pk_bf16_f32 v251, v202, v203
  s_waitcnt lgkmcnt(2)
  v_mfma_f32_16x16x32_bf16 v[184:187], v[220:223], v[108:111], v[184:187]
  ds_read_b128 v[216:219], v70 offset:768
  v_accvgpr_write_b32 a50, v248
  v_mfma_f32_16x16x32_bf16 v[188:191], v[220:223], v[112:115], v[188:191]
  s_add_u32 m0, s81, 27648
  s_nop 0
  buffer_load_dwordx4 v51, s[12:15], s80 offen lds
  v_mfma_f32_16x16x32_bf16 v[192:195], v[220:223], v[116:119], v[192:195]
  v_accvgpr_write_b32 a51, v249
  s_waitcnt lgkmcnt(2)
  v_mfma_f32_16x16x32_bf16 v[184:187], v[208:211], v[120:123], v[184:187]
  ds_read_b128 v[220:223], v71 offset:768
  v_accvgpr_write_b32 a130, v250
  v_mfma_f32_16x16x32_bf16 v[188:191], v[208:211], v[124:127], v[188:191]
  s_add_u32 m0, s81, 28672
  s_nop 0
  buffer_load_dwordx4 v52, s[12:15], s80 offen lds
  v_mfma_f32_16x16x32_bf16 v[192:195], v[208:211], v[128:131], v[192:195]
  v_accvgpr_write_b32 a131, v251
  s_waitcnt lgkmcnt(2)
  v_mfma_f32_16x16x32_bf16 v[184:187], v[212:215], v[132:135], v[184:187]
  ds_read_b128 v[208:211], v70 offset:896
  s_mov_b64 exec, s[68:69]
  v_cvt_pk_bf16_f32 v168, v204, v205
  v_cvt_pk_bf16_f32 v169, v206, v207
  s_mov_b64 exec, -1
  v_mfma_f32_16x16x32_bf16 v[188:191], v[212:215], v[136:139], v[188:191]
  s_add_u32 m0, s81, 29696
  s_nop 0
  buffer_load_dwordx4 v53, s[12:15], s80 offen lds
  v_mfma_f32_16x16x32_bf16 v[192:195], v[212:215], v[140:143], v[192:195]
  s_waitcnt lgkmcnt(2)
  v_mfma_f32_16x16x32_bf16 v[196:199], v[216:219], v[72:75], 0
  ds_read_b128 v[212:215], v71 offset:896
  v_mfma_f32_16x16x32_bf16 v[200:203], v[216:219], v[76:79], 0
  s_add_u32 m0, s81, 30720
  s_nop 0
  buffer_load_dwordx4 v54, s[12:15], s80 offen lds
  v_mfma_f32_16x16x32_bf16 v[204:207], v[216:219], v[80:83], 0
  s_waitcnt lgkmcnt(2)
  v_mfma_f32_16x16x32_bf16 v[196:199], v[220:223], v[84:87], v[196:199]
  ds_read_b128 v[216:219], v70 offset:1024
  v_cvt_pk_bf16_f32 v248, v184, v185
  v_mfma_f32_16x16x32_bf16 v[200:203], v[220:223], v[88:91], v[200:203]
  s_add_u32 m0, s81, 31744
  s_nop 0
  buffer_load_dwordx4 v55, s[12:15], s80 offen lds
  v_mfma_f32_16x16x32_bf16 v[204:207], v[220:223], v[92:95], v[204:207]
  v_cvt_pk_bf16_f32 v249, v186, v187
  s_waitcnt lgkmcnt(2)
  v_mfma_f32_16x16x32_bf16 v[196:199], v[208:211], v[96:99], v[196:199]
  ds_read_b128 v[220:223], v71 offset:1024
  v_cvt_pk_bf16_f32 v250, v188, v189
  v_mfma_f32_16x16x32_bf16 v[200:203], v[208:211], v[100:103], v[200:203]
  s_add_u32 m0, s81, 32768
  s_nop 0
  buffer_load_dwordx4 v56, s[12:15], s80 offen lds
  v_mfma_f32_16x16x32_bf16 v[204:207], v[208:211], v[104:107], v[204:207]
  v_cvt_pk_bf16_f32 v251, v190, v191
  s_waitcnt lgkmcnt(2)
  v_mfma_f32_16x16x32_bf16 v[196:199], v[212:215], v[108:111], v[196:199]
  v_accvgpr_write_b32 a52, v248
  v_mfma_f32_16x16x32_bf16 v[200:203], v[212:215], v[112:115], v[200:203]
  s_add_u32 m0, s81, 33792
  s_nop 0
  buffer_load_dwordx4 v57, s[12:15], s80 offen lds
  v_mfma_f32_16x16x32_bf16 v[204:207], v[212:215], v[116:119], v[204:207]
  v_accvgpr_write_b32 a53, v249
  s_waitcnt lgkmcnt(1)
  v_mfma_f32_16x16x32_bf16 v[196:199], v[216:219], v[120:123], v[196:199]
  v_accvgpr_write_b32 a132, v250
  v_mfma_f32_16x16x32_bf16 v[200:203], v[216:219], v[124:127], v[200:203]
  s_add_u32 m0, s81, 34816
  s_nop 0
  buffer_load_dwordx4 v58, s[12:15], s80 offen lds
  v_mfma_f32_16x16x32_bf16 v[204:207], v[216:219], v[128:131], v[204:207]
  v_accvgpr_write_b32 a133, v251
  s_waitcnt lgkmcnt(0)
  v_mfma_f32_16x16x32_bf16 v[196:199], v[220:223], v[132:135], v[196:199]
  v_cvt_pk_bf16_f32 v170, v192, v193
  v_cvt_pk_bf16_f32 v171, v194, v195
  v_mfma_f32_16x16x32_bf16 v[200:203], v[220:223], v[136:139], v[200:203]
  s_add_u32 m0, s81, 35840
  s_nop 0
  buffer_load_dwordx4 v59, s[12:15], s80 offen lds
  s_add_u32 s80, s80, 393216
  v_mfma_f32_16x16x32_bf16 v[204:207], v[220:223], v[140:143], v[204:207]
  s_waitcnt vmcnt(12)
  ds_read_b128 v[208:211], v70 offset:12288
  ds_read_b128 v[212:215], v71 offset:12288
  ds_read_b128 v[216:219], v70 offset:12416
  s_waitcnt lgkmcnt(2)
  v_mfma_f32_16x16x32_bf16 v[184:187], v[208:211], v[72:75], 0
  ds_read_b128 v[220:223], v71 offset:12416
  v_mfma_f32_16x16x32_bf16 v[188:191], v[208:211], v[76:79], 0
  s_add_u32 m0, s81, 0
  s_nop 0
  buffer_load_dwordx4 v48, s[12:15], s80 offen lds
  v_mfma_f32_16x16x32_bf16 v[192:195], v[208:211], v[80:83], 0
  s_waitcnt lgkmcnt(2)
  v_mfma_f32_16x16x32_bf16 v[184:187], v[212:215], v[84:87], v[184:187]
  ds_read_b128 v[208:211], v70 offset:12544
  v_cvt_pk_bf16_f32 v248, v196, v197
  v_mfma_f32_16x16x32_bf16 v[188:191], v[212:215], v[88:91], v[188:191]
  s_add_u32 m0, s81, 1024
  s_nop 0
  buffer_load_dwordx4 v49, s[12:15], s80 offen lds
  v_mfma_f32_16x16x32_bf16 v[192:195], v[212:215], v[92:95], v[192:195]
  v_cvt_pk_bf16_f32 v249, v198, v199
  s_waitcnt lgkmcnt(2)
  v_mfma_f32_16x16x32_bf16 v[184:187], v[216:219], v[96:99], v[184:187]
  ds_read_b128 v[212:215], v71 offset:12544
  v_cvt_pk_bf16_f32 v250, v200, v201
  v_mfma_f32_16x16x32_bf16 v[188:191], v[216:219], v[100:103], v[188:191]
  s_add_u32 m0, s81, 2048
  s_nop 0
  buffer_load_dwordx4 v50, s[12:15], s80 offen lds
  v_mfma_f32_16x16x32_bf16 v[192:195], v[216:219], v[104:107], v[192:195]
  v_cvt_pk_bf16_f32 v251, v202, v203
  s_waitcnt lgkmcnt(2)
  v_mfma_f32_16x16x32_bf16 v[184:187], v[220:223], v[108:111], v[184:187]
  ds_read_b128 v[216:219], v70 offset:13056
  v_accvgpr_write_b32 a54, v248
  v_mfma_f32_16x16x32_bf16 v[188:191], v[220:223], v[112:115], v[188:191]
  s_add_u32 m0, s81, 3072
  s_nop 0
  buffer_load_dwordx4 v51, s[12:15], s80 offen lds
  v_mfma_f32_16x16x32_bf16 v[192:195], v[220:223], v[116:119], v[192:195]
  v_accvgpr_write_b32 a55, v249
  s_waitcnt lgkmcnt(2)
  v_mfma_f32_16x16x32_bf16 v[184:187], v[208:211], v[120:123], v[184:187]
  ds_read_b128 v[220:223], v71 offset:13056
  v_accvgpr_write_b32 a134, v250
  v_mfma_f32_16x16x32_bf16 v[188:191], v[208:211], v[124:127], v[188:191]
  s_add_u32 m0, s81, 4096
  s_nop 0
  buffer_load_dwordx4 v52, s[12:15], s80 offen lds
  v_mfma_f32_16x16x32_bf16 v[192:195], v[208:211], v[128:131], v[192:195]
  v_accvgpr_write_b32 a135, v251
  s_waitcnt lgkmcnt(2)
  v_mfma_f32_16x16x32_bf16 v[184:187], v[212:215], v[132:135], v[184:187]
  ds_read_b128 v[208:211], v70 offset:13184
  s_mov_b64 exec, s[68:69]
  v_cvt_pk_bf16_f32 v170, v204, v205
  v_cvt_pk_bf16_f32 v171, v206, v207
  s_mov_b64 exec, -1
  v_mfma_f32_16x16x32_bf16 v[188:191], v[212:215], v[136:139], v[188:191]
  s_add_u32 m0, s81, 5120
  s_nop 0
  buffer_load_dwordx4 v53, s[12:15], s80 offen lds
  v_mfma_f32_16x16x32_bf16 v[192:195], v[212:215], v[140:143], v[192:195]
  s_waitcnt lgkmcnt(2)
  v_mfma_f32_16x16x32_bf16 v[196:199], v[216:219], v[72:75], 0
  ds_read_b128 v[212:215], v71 offset:13184
  v_mfma_f32_16x16x32_bf16 v[200:203], v[216:219], v[76:79], 0
  s_add_u32 m0, s81, 6144
  s_nop 0
  buffer_load_dwordx4 v54, s[12:15], s80 offen lds
  v_mfma_f32_16x16x32_bf16 v[204:207], v[216:219], v[80:83], 0
  s_waitcnt lgkmcnt(2)
  v_mfma_f32_16x16x32_bf16 v[196:199], v[220:223], v[84:87], v[196:199]
  ds_read_b128 v[216:219], v70 offset:13312
  v_cvt_pk_bf16_f32 v248, v184, v185
  v_mfma_f32_16x16x32_bf16 v[200:203], v[220:223], v[88:91], v[200:203]
  s_add_u32 m0, s81, 7168
  s_nop 0
  buffer_load_dwordx4 v55, s[12:15], s80 offen lds
  v_mfma_f32_16x16x32_bf16 v[204:207], v[220:223], v[92:95], v[204:207]
  v_cvt_pk_bf16_f32 v249, v186, v187
  s_waitcnt lgkmcnt(2)
  v_mfma_f32_16x16x32_bf16 v[196:199], v[208:211], v[96:99], v[196:199]
  ds_read_b128 v[220:223], v71 offset:13312
  v_cvt_pk_bf16_f32 v250, v188, v189
  v_mfma_f32_16x16x32_bf16 v[200:203], v[208:211], v[100:103], v[200:203]
  s_add_u32 m0, s81, 8192
  s_nop 0
  buffer_load_dwordx4 v56, s[12:15], s80 offen lds
  v_mfma_f32_16x16x32_bf16 v[204:207], v[208:211], v[104:107], v[204:207]
  v_cvt_pk_bf16_f32 v251, v190, v191
  s_waitcnt lgkmcnt(2)
  v_mfma_f32_16x16x32_bf16 v[196:199], v[212:215], v[108:111], v[196:199]
  v_accvgpr_write_b32 a56, v248
  v_mfma_f32_16x16x32_bf16 v[200:203], v[212:215], v[112:115], v[200:203]
  s_add_u32 m0, s81, 9216
  s_nop 0
  buffer_load_dwordx4 v57, s[12:15], s80 offen lds
  v_mfma_f32_16x16x32_bf16 v[204:207], v[212:215], v[116:119], v[204:207]
  v_accvgpr_write_b32 a57, v249
  s_waitcnt lgkmcnt(1)
  v_mfma_f32_16x16x32_bf16 v[196:199], v[216:219], v[120:123], v[196:199]
  v_accvgpr_write_b32 a136, v250
  v_mfma_f32_16x16x32_bf16 v[200:203], v[216:219], v[124:127], v[200:203]
  s_add_u32 m0, s81, 10240
  s_nop 0
  buffer_load_dwordx4 v58, s[12:15], s80 offen lds
  v_mfma_f32_16x16x32_bf16 v[204:207], v[216:219], v[128:131], v[204:207]
  v_accvgpr_write_b32 a137, v251
  s_waitcnt lgkmcnt(0)
  v_mfma_f32_16x16x32_bf16 v[196:199], v[220:223], v[132:135], v[196:199]
  v_cvt_pk_bf16_f32 v172, v192, v193
  v_cvt_pk_bf16_f32 v173, v194, v195
  v_mfma_f32_16x16x32_bf16 v[200:203], v[220:223], v[136:139], v[200:203]
  s_add_u32 m0, s81, 11264
  s_nop 0
  buffer_load_dwordx4 v59, s[12:15], s80 offen lds
  s_add_u32 s80, s80, 393216
  v_mfma_f32_16x16x32_bf16 v[204:207], v[220:223], v[140:143], v[204:207]
  s_waitcnt vmcnt(12)
  ds_read_b128 v[208:211], v70 offset:24576
  ds_read_b128 v[212:215], v71 offset:24576
  ds_read_b128 v[216:219], v70 offset:24704
  s_waitcnt lgkmcnt(2)
  v_mfma_f32_16x16x32_bf16 v[184:187], v[208:211], v[72:75], 0
  ds_read_b128 v[220:223], v71 offset:24704
  v_mfma_f32_16x16x32_bf16 v[188:191], v[208:211], v[76:79], 0
  s_add_u32 m0, s81, 12288
  s_nop 0
  buffer_load_dwordx4 v48, s[12:15], s80 offen lds
  v_mfma_f32_16x16x32_bf16 v[192:195], v[208:211], v[80:83], 0
  s_waitcnt lgkmcnt(2)
  v_mfma_f32_16x16x32_bf16 v[184:187], v[212:215], v[84:87], v[184:187]
  ds_read_b128 v[208:211], v70 offset:24832
  v_cvt_pk_bf16_f32 v248, v196, v197
  v_mfma_f32_16x16x32_bf16 v[188:191], v[212:215], v[88:91], v[188:191]
  s_add_u32 m0, s81, 13312
  s_nop 0
  buffer_load_dwordx4 v49, s[12:15], s80 offen lds
  v_mfma_f32_16x16x32_bf16 v[192:195], v[212:215], v[92:95], v[192:195]
  v_cvt_pk_bf16_f32 v249, v198, v199
  s_waitcnt lgkmcnt(2)
  v_mfma_f32_16x16x32_bf16 v[184:187], v[216:219], v[96:99], v[184:187]
  ds_read_b128 v[212:215], v71 offset:24832
  v_cvt_pk_bf16_f32 v250, v200, v201
  v_mfma_f32_16x16x32_bf16 v[188:191], v[216:219], v[100:103], v[188:191]
  s_add_u32 m0, s81, 14336
  s_nop 0
  buffer_load_dwordx4 v50, s[12:15], s80 offen lds
  v_mfma_f32_16x16x32_bf16 v[192:195], v[216:219], v[104:107], v[192:195]
  v_cvt_pk_bf16_f32 v251, v202, v203
  s_waitcnt lgkmcnt(2)
  v_mfma_f32_16x16x32_bf16 v[184:187], v[220:223], v[108:111], v[184:187]
  ds_read_b128 v[216:219], v70 offset:25344
  v_accvgpr_write_b32 a58, v248
  v_mfma_f32_16x16x32_bf16 v[188:191], v[220:223], v[112:115], v[188:191]
  s_add_u32 m0, s81, 15360
  s_nop 0
  buffer_load_dwordx4 v51, s[12:15], s80 offen lds
  v_mfma_f32_16x16x32_bf16 v[192:195], v[220:223], v[116:119], v[192:195]
  v_accvgpr_write_b32 a59, v249
  s_waitcnt lgkmcnt(2)
  v_mfma_f32_16x16x32_bf16 v[184:187], v[208:211], v[120:123], v[184:187]
  ds_read_b128 v[220:223], v71 offset:25344
  v_accvgpr_write_b32 a138, v250
  v_mfma_f32_16x16x32_bf16 v[188:191], v[208:211], v[124:127], v[188:191]
  s_add_u32 m0, s81, 16384
  s_nop 0
  buffer_load_dwordx4 v52, s[12:15], s80 offen lds
  v_mfma_f32_16x16x32_bf16 v[192:195], v[208:211], v[128:131], v[192:195]
  v_accvgpr_write_b32 a139, v251
  s_waitcnt lgkmcnt(2)
  v_mfma_f32_16x16x32_bf16 v[184:187], v[212:215], v[132:135], v[184:187]
  ds_read_b128 v[208:211], v70 offset:25472
  s_mov_b64 exec, s[68:69]
  v_cvt_pk_bf16_f32 v172, v204, v205
  v_cvt_pk_bf16_f32 v173, v206, v207
  s_mov_b64 exec, -1
  v_mfma_f32_16x16x32_bf16 v[188:191], v[212:215], v[136:139], v[188:191]
  s_add_u32 m0, s81, 17408
  s_nop 0
  buffer_load_dwordx4 v53, s[12:15], s80 offen lds
  v_mfma_f32_16x16x32_bf16 v[192:195], v[212:215], v[140:143], v[192:195]
  s_waitcnt lgkmcnt(2)
  v_mfma_f32_16x16x32_bf16 v[196:199], v[216:219], v[72:75], 0
  ds_read_b128 v[212:215], v71 offset:25472
  v_mfma_f32_16x16x32_bf16 v[200:203], v[216:219], v[76:79], 0
  s_add_u32 m0, s81, 18432
  s_nop 0
  buffer_load_dwordx4 v54, s[12:15], s80 offen lds
  v_mfma_f32_16x16x32_bf16 v[204:207], v[216:219], v[80:83], 0
  s_waitcnt lgkmcnt(2)
  v_mfma_f32_16x16x32_bf16 v[196:199], v[220:223], v[84:87], v[196:199]
  ds_read_b128 v[216:219], v70 offset:25600
  v_cvt_pk_bf16_f32 v248, v184, v185
  v_mfma_f32_16x16x32_bf16 v[200:203], v[220:223], v[88:91], v[200:203]
  s_add_u32 m0, s81, 19456
  s_nop 0
  buffer_load_dwordx4 v55, s[12:15], s80 offen lds
  v_mfma_f32_16x16x32_bf16 v[204:207], v[220:223], v[92:95], v[204:207]
  v_cvt_pk_bf16_f32 v249, v186, v187
  s_waitcnt lgkmcnt(2)
  v_mfma_f32_16x16x32_bf16 v[196:199], v[208:211], v[96:99], v[196:199]
  ds_read_b128 v[220:223], v71 offset:25600
  v_cvt_pk_bf16_f32 v250, v188, v189
  v_mfma_f32_16x16x32_bf16 v[200:203], v[208:211], v[100:103], v[200:203]
  s_add_u32 m0, s81, 20480
  s_nop 0
  buffer_load_dwordx4 v56, s[12:15], s80 offen lds
  v_mfma_f32_16x16x32_bf16 v[204:207], v[208:211], v[104:107], v[204:207]
  v_cvt_pk_bf16_f32 v251, v190, v191
  s_waitcnt lgkmcnt(2)
  v_mfma_f32_16x16x32_bf16 v[196:199], v[212:215], v[108:111], v[196:199]
  v_accvgpr_write_b32 a60, v248
  v_mfma_f32_16x16x32_bf16 v[200:203], v[212:215], v[112:115], v[200:203]
  s_add_u32 m0, s81, 21504
  s_nop 0
  buffer_load_dwordx4 v57, s[12:15], s80 offen lds
  v_mfma_f32_16x16x32_bf16 v[204:207], v[212:215], v[116:119], v[204:207]
  v_accvgpr_write_b32 a61, v249
  s_waitcnt lgkmcnt(1)
  v_mfma_f32_16x16x32_bf16 v[196:199], v[216:219], v[120:123], v[196:199]
  v_accvgpr_write_b32 a140, v250
  v_mfma_f32_16x16x32_bf16 v[200:203], v[216:219], v[124:127], v[200:203]
  s_add_u32 m0, s81, 22528
  s_nop 0
  buffer_load_dwordx4 v58, s[12:15], s80 offen lds
  v_mfma_f32_16x16x32_bf16 v[204:207], v[216:219], v[128:131], v[204:207]
  v_accvgpr_write_b32 a141, v251
  s_waitcnt lgkmcnt(0)
  v_mfma_f32_16x16x32_bf16 v[196:199], v[220:223], v[132:135], v[196:199]
  v_cvt_pk_bf16_f32 v174, v192, v193
  v_cvt_pk_bf16_f32 v175, v194, v195
  v_mfma_f32_16x16x32_bf16 v[200:203], v[220:223], v[136:139], v[200:203]
  s_add_u32 m0, s81, 23552
  s_nop 0
  buffer_load_dwordx4 v59, s[12:15], s80 offen lds
  s_add_u32 s80, s80, 393216
  v_mfma_f32_16x16x32_bf16 v[204:207], v[220:223], v[140:143], v[204:207]
  s_waitcnt vmcnt(12)
  ds_read_b128 v[208:211], v70 offset:0
  ds_read_b128 v[212:215], v71 offset:0
  ds_read_b128 v[216:219], v70 offset:128
  s_waitcnt lgkmcnt(2)
  v_mfma_f32_16x16x32_bf16 v[184:187], v[208:211], v[72:75], 0
  ds_read_b128 v[220:223], v71 offset:128
  v_mfma_f32_16x16x32_bf16 v[188:191], v[208:211], v[76:79], 0
  s_add_u32 m0, s81, 24576
  s_nop 0
  buffer_load_dwordx4 v48, s[12:15], s80 offen lds
  v_mfma_f32_16x16x32_bf16 v[192:195], v[208:211], v[80:83], 0
  s_waitcnt lgkmcnt(2)
  v_mfma_f32_16x16x32_bf16 v[184:187], v[212:215], v[84:87], v[184:187]
  ds_read_b128 v[208:211], v70 offset:256
  v_cvt_pk_bf16_f32 v248, v196, v197
  v_mfma_f32_16x16x32_bf16 v[188:191], v[212:215], v[88:91], v[188:191]
  s_add_u32 m0, s81, 25600
  s_nop 0
  buffer_load_dwordx4 v49, s[12:15], s80 offen lds
  v_mfma_f32_16x16x32_bf16 v[192:195], v[212:215], v[92:95], v[192:195]
  v_cvt_pk_bf16_f32 v249, v198, v199
  s_waitcnt lgkmcnt(2)
  v_mfma_f32_16x16x32_bf16 v[184:187], v[216:219], v[96:99], v[184:187]
  ds_read_b128 v[212:215], v71 offset:256
  v_cvt_pk_bf16_f32 v250, v200, v201
  v_mfma_f32_16x16x32_bf16 v[188:191], v[216:219], v[100:103], v[188:191]
  s_add_u32 m0, s81, 26624
  s_nop 0
  buffer_load_dwordx4 v50, s[12:15], s80 offen lds
  v_mfma_f32_16x16x32_bf16 v[192:195], v[216:219], v[104:107], v[192:195]
  v_cvt_pk_bf16_f32 v251, v202, v203
  s_waitcnt lgkmcnt(2)
  v_mfma_f32_16x16x32_bf16 v[184:187], v[220:223], v[108:111], v[184:187]
  ds_read_b128 v[216:219], v70 offset:768
  v_accvgpr_write_b32 a62, v248
  v_mfma_f32_16x16x32_bf16 v[188:191], v[220:223], v[112:115], v[188:191]
  s_add_u32 m0, s81, 27648
  s_nop 0
  buffer_load_dwordx4 v51, s[12:15], s80 offen lds
  v_mfma_f32_16x16x32_bf16 v[192:195], v[220:223], v[116:119], v[192:195]
  v_accvgpr_write_b32 a63, v249
  s_waitcnt lgkmcnt(2)
  v_mfma_f32_16x16x32_bf16 v[184:187], v[208:211], v[120:123], v[184:187]
  ds_read_b128 v[220:223], v71 offset:768
  v_accvgpr_write_b32 a142, v250
  v_mfma_f32_16x16x32_bf16 v[188:191], v[208:211], v[124:127], v[188:191]
  s_add_u32 m0, s81, 28672
  s_nop 0
  buffer_load_dwordx4 v52, s[12:15], s80 offen lds
  v_mfma_f32_16x16x32_bf16 v[192:195], v[208:211], v[128:131], v[192:195]
  v_accvgpr_write_b32 a143, v251
  s_waitcnt lgkmcnt(2)
  v_mfma_f32_16x16x32_bf16 v[184:187], v[212:215], v[132:135], v[184:187]
  ds_read_b128 v[208:211], v70 offset:896
  s_mov_b64 exec, s[68:69]
  v_cvt_pk_bf16_f32 v174, v204, v205
  v_cvt_pk_bf16_f32 v175, v206, v207
  s_mov_b64 exec, -1
  v_mfma_f32_16x16x32_bf16 v[188:191], v[212:215], v[136:139], v[188:191]
  s_add_u32 m0, s81, 29696
  s_nop 0
  buffer_load_dwordx4 v53, s[12:15], s80 offen lds
  v_mfma_f32_16x16x32_bf16 v[192:195], v[212:215], v[140:143], v[192:195]
  s_waitcnt lgkmcnt(2)
  v_mfma_f32_16x16x32_bf16 v[196:199], v[216:219], v[72:75], 0
  ds_read_b128 v[212:215], v71 offset:896
  v_mfma_f32_16x16x32_bf16 v[200:203], v[216:219], v[76:79], 0
  s_add_u32 m0, s81, 30720
  s_nop 0
  buffer_load_dwordx4 v54, s[12:15], s80 offen lds
  v_mfma_f32_16x16x32_bf16 v[204:207], v[216:219], v[80:83], 0
  s_waitcnt lgkmcnt(2)
  v_mfma_f32_16x16x32_bf16 v[196:199], v[220:223], v[84:87], v[196:199]
  ds_read_b128 v[216:219], v70 offset:1024
  v_cvt_pk_bf16_f32 v248, v184, v185
  v_mfma_f32_16x16x32_bf16 v[200:203], v[220:223], v[88:91], v[200:203]
  s_add_u32 m0, s81, 31744
  s_nop 0
  buffer_load_dwordx4 v55, s[12:15], s80 offen lds
  v_mfma_f32_16x16x32_bf16 v[204:207], v[220:223], v[92:95], v[204:207]
  v_cvt_pk_bf16_f32 v249, v186, v187
  s_waitcnt lgkmcnt(2)
  v_mfma_f32_16x16x32_bf16 v[196:199], v[208:211], v[96:99], v[196:199]
  ds_read_b128 v[220:223], v71 offset:1024
  v_cvt_pk_bf16_f32 v250, v188, v189
  v_mfma_f32_16x16x32_bf16 v[200:203], v[208:211], v[100:103], v[200:203]
  s_add_u32 m0, s81, 32768
  s_nop 0
  buffer_load_dwordx4 v56, s[12:15], s80 offen lds
  v_mfma_f32_16x16x32_bf16 v[204:207], v[208:211], v[104:107], v[204:207]
  v_cvt_pk_bf16_f32 v251, v190, v191
  s_waitcnt lgkmcnt(2)
  v_mfma_f32_16x16x32_bf16 v[196:199], v[212:215], v[108:111], v[196:199]
  v_accvgpr_write_b32 a64, v248
  v_mfma_f32_16x16x32_bf16 v[200:203], v[212:215], v[112:115], v[200:203]
  s_add_u32 m0, s81, 33792
  s_nop 0
  buffer_load_dwordx4 v57, s[12:15], s80 offen lds
  v_mfma_f32_16x16x32_bf16 v[204:207], v[212:215], v[116:119], v[204:207]
  v_accvgpr_write_b32 a65, v249
  s_waitcnt lgkmcnt(1)
  v_mfma_f32_16x16x32_bf16 v[196:199], v[216:219], v[120:123], v[196:199]
  v_accvgpr_write_b32 a144, v250
  v_mfma_f32_16x16x32_bf16 v[200:203], v[216:219], v[124:127], v[200:203]
  s_add_u32 m0, s81, 34816
  s_nop 0
  buffer_load_dwordx4 v58, s[12:15], s80 offen lds
  v_mfma_f32_16x16x32_bf16 v[204:207], v[216:219], v[128:131], v[204:207]
  v_accvgpr_write_b32 a145, v251
  s_waitcnt lgkmcnt(0)
  v_mfma_f32_16x16x32_bf16 v[196:199], v[220:223], v[132:135], v[196:199]
  v_cvt_pk_bf16_f32 v176, v192, v193
  v_cvt_pk_bf16_f32 v177, v194, v195
  v_mfma_f32_16x16x32_bf16 v[200:203], v[220:223], v[136:139], v[200:203]
  s_add_u32 m0, s81, 35840
  s_nop 0
  buffer_load_dwordx4 v59, s[12:15], s80 offen lds
  s_add_u32 s80, s80, 393216
  v_mfma_f32_16x16x32_bf16 v[204:207], v[220:223], v[140:143], v[204:207]
  s_waitcnt vmcnt(12)
  ds_read_b128 v[208:211], v70 offset:12288
  ds_read_b128 v[212:215], v71 offset:12288
  ds_read_b128 v[216:219], v70 offset:12416
  s_waitcnt lgkmcnt(2)
  v_mfma_f32_16x16x32_bf16 v[184:187], v[208:211], v[72:75], 0
  ds_read_b128 v[220:223], v71 offset:12416
  v_mfma_f32_16x16x32_bf16 v[188:191], v[208:211], v[76:79], 0
  s_add_u32 m0, s81, 0
  s_nop 0
  buffer_load_dwordx4 v48, s[12:15], s80 offen lds
  v_mfma_f32_16x16x32_bf16 v[192:195], v[208:211], v[80:83], 0
  s_waitcnt lgkmcnt(2)
  v_mfma_f32_16x16x32_bf16 v[184:187], v[212:215], v[84:87], v[184:187]
  ds_read_b128 v[208:211], v70 offset:12544
  v_cvt_pk_bf16_f32 v248, v196, v197
  v_mfma_f32_16x16x32_bf16 v[188:191], v[212:215], v[88:91], v[188:191]
  s_add_u32 m0, s81, 1024
  s_nop 0
  buffer_load_dwordx4 v49, s[12:15], s80 offen lds
  v_mfma_f32_16x16x32_bf16 v[192:195], v[212:215], v[92:95], v[192:195]
  v_cvt_pk_bf16_f32 v249, v198, v199
  s_waitcnt lgkmcnt(2)
  v_mfma_f32_16x16x32_bf16 v[184:187], v[216:219], v[96:99], v[184:187]
  ds_read_b128 v[212:215], v71 offset:12544
  v_cvt_pk_bf16_f32 v250, v200, v201
  v_mfma_f32_16x16x32_bf16 v[188:191], v[216:219], v[100:103], v[188:191]
  s_add_u32 m0, s81, 2048
  s_nop 0
  buffer_load_dwordx4 v50, s[12:15], s80 offen lds
  v_mfma_f32_16x16x32_bf16 v[192:195], v[216:219], v[104:107], v[192:195]
  v_cvt_pk_bf16_f32 v251, v202, v203
  s_waitcnt lgkmcnt(2)
  v_mfma_f32_16x16x32_bf16 v[184:187], v[220:223], v[108:111], v[184:187]
  ds_read_b128 v[216:219], v70 offset:13056
  v_accvgpr_write_b32 a66, v248
  v_mfma_f32_16x16x32_bf16 v[188:191], v[220:223], v[112:115], v[188:191]
  s_add_u32 m0, s81, 3072
  s_nop 0
  buffer_load_dwordx4 v51, s[12:15], s80 offen lds
  v_mfma_f32_16x16x32_bf16 v[192:195], v[220:223], v[116:119], v[192:195]
  v_accvgpr_write_b32 a67, v249
  s_waitcnt lgkmcnt(2)
  v_mfma_f32_16x16x32_bf16 v[184:187], v[208:211], v[120:123], v[184:187]
  ds_read_b128 v[220:223], v71 offset:13056
  v_accvgpr_write_b32 a146, v250
  v_mfma_f32_16x16x32_bf16 v[188:191], v[208:211], v[124:127], v[188:191]
  s_add_u32 m0, s81, 4096
  s_nop 0
  buffer_load_dwordx4 v52, s[12:15], s80 offen lds
  v_mfma_f32_16x16x32_bf16 v[192:195], v[208:211], v[128:131], v[192:195]
  v_accvgpr_write_b32 a147, v251
  s_waitcnt lgkmcnt(2)
  v_mfma_f32_16x16x32_bf16 v[184:187], v[212:215], v[132:135], v[184:187]
  ds_read_b128 v[208:211], v70 offset:13184
  s_mov_b64 exec, s[68:69]
  v_cvt_pk_bf16_f32 v176, v204, v205
  v_cvt_pk_bf16_f32 v177, v206, v207
  s_mov_b64 exec, -1
  v_mfma_f32_16x16x32_bf16 v[188:191], v[212:215], v[136:139], v[188:191]
  s_add_u32 m0, s81, 5120
  s_nop 0
  buffer_load_dwordx4 v53, s[12:15], s80 offen lds
  v_mfma_f32_16x16x32_bf16 v[192:195], v[212:215], v[140:143], v[192:195]
  s_waitcnt lgkmcnt(2)
  v_mfma_f32_16x16x32_bf16 v[196:199], v[216:219], v[72:75], 0
  ds_read_b128 v[212:215], v71 offset:13184
  v_mfma_f32_16x16x32_bf16 v[200:203], v[216:219], v[76:79], 0
  s_add_u32 m0, s81, 6144
  s_nop 0
  buffer_load_dwordx4 v54, s[12:15], s80 offen lds
  v_mfma_f32_16x16x32_bf16 v[204:207], v[216:219], v[80:83], 0
  s_waitcnt lgkmcnt(2)
  v_mfma_f32_16x16x32_bf16 v[196:199], v[220:223], v[84:87], v[196:199]
  ds_read_b128 v[216:219], v70 offset:13312
  v_cvt_pk_bf16_f32 v248, v184, v185
  v_mfma_f32_16x16x32_bf16 v[200:203], v[220:223], v[88:91], v[200:203]
  s_add_u32 m0, s81, 7168
  s_nop 0
  buffer_load_dwordx4 v55, s[12:15], s80 offen lds
  v_mfma_f32_16x16x32_bf16 v[204:207], v[220:223], v[92:95], v[204:207]
  v_cvt_pk_bf16_f32 v249, v186, v187
  s_waitcnt lgkmcnt(2)
  v_mfma_f32_16x16x32_bf16 v[196:199], v[208:211], v[96:99], v[196:199]
  ds_read_b128 v[220:223], v71 offset:13312
  v_cvt_pk_bf16_f32 v250, v188, v189
  v_mfma_f32_16x16x32_bf16 v[200:203], v[208:211], v[100:103], v[200:203]
  s_add_u32 m0, s81, 8192
  s_nop 0
  buffer_load_dwordx4 v56, s[12:15], s80 offen lds
  v_mfma_f32_16x16x32_bf16 v[204:207], v[208:211], v[104:107], v[204:207]
  v_cvt_pk_bf16_f32 v251, v190, v191
  s_waitcnt lgkmcnt(2)
  v_mfma_f32_16x16x32_bf16 v[196:199], v[212:215], v[108:111], v[196:199]
  v_accvgpr_write_b32 a68, v248
  v_mfma_f32_16x16x32_bf16 v[200:203], v[212:215], v[112:115], v[200:203]
  s_add_u32 m0, s81, 9216
  s_nop 0
  buffer_load_dwordx4 v57, s[12:15], s80 offen lds
  v_mfma_f32_16x16x32_bf16 v[204:207], v[212:215], v[116:119], v[204:207]
  v_accvgpr_write_b32 a69, v249
  s_waitcnt lgkmcnt(1)
  v_mfma_f32_16x16x32_bf16 v[196:199], v[216:219], v[120:123], v[196:199]
  v_accvgpr_write_b32 a148, v250
  v_mfma_f32_16x16x32_bf16 v[200:203], v[216:219], v[124:127], v[200:203]
  s_add_u32 m0, s81, 10240
  s_nop 0
  buffer_load_dwordx4 v58, s[12:15], s80 offen lds
  v_mfma_f32_16x16x32_bf16 v[204:207], v[216:219], v[128:131], v[204:207]
  v_accvgpr_write_b32 a149, v251
  s_waitcnt lgkmcnt(0)
  v_mfma_f32_16x16x32_bf16 v[196:199], v[220:223], v[132:135], v[196:199]
  v_cvt_pk_bf16_f32 v178, v192, v193
  v_cvt_pk_bf16_f32 v179, v194, v195
  v_mfma_f32_16x16x32_bf16 v[200:203], v[220:223], v[136:139], v[200:203]
  s_add_u32 m0, s81, 11264
  s_nop 0
  buffer_load_dwordx4 v59, s[12:15], s80 offen lds
  s_add_u32 s80, s80, 393216
  v_mfma_f32_16x16x32_bf16 v[204:207], v[220:223], v[140:143], v[204:207]
  s_waitcnt vmcnt(12)
  ds_read_b128 v[208:211], v70 offset:24576
  ds_read_b128 v[212:215], v71 offset:24576
  ds_read_b128 v[216:219], v70 offset:24704
  s_waitcnt lgkmcnt(2)
  v_mfma_f32_16x16x32_bf16 v[184:187], v[208:211], v[72:75], 0
  ds_read_b128 v[220:223], v71 offset:24704
  v_mfma_f32_16x16x32_bf16 v[188:191], v[208:211], v[76:79], 0
  v_mfma_f32_16x16x32_bf16 v[192:195], v[208:211], v[80:83], 0
  s_waitcnt lgkmcnt(2)
  v_mfma_f32_16x16x32_bf16 v[184:187], v[212:215], v[84:87], v[184:187]
  ds_read_b128 v[208:211], v70 offset:24832
  v_cvt_pk_bf16_f32 v248, v196, v197
  v_mfma_f32_16x16x32_bf16 v[188:191], v[212:215], v[88:91], v[188:191]
  v_mfma_f32_16x16x32_bf16 v[192:195], v[212:215], v[92:95], v[192:195]
  v_cvt_pk_bf16_f32 v249, v198, v199
  s_waitcnt lgkmcnt(2)
  v_mfma_f32_16x16x32_bf16 v[184:187], v[216:219], v[96:99], v[184:187]
  ds_read_b128 v[212:215], v71 offset:24832
  v_cvt_pk_bf16_f32 v250, v200, v201
  v_mfma_f32_16x16x32_bf16 v[188:191], v[216:219], v[100:103], v[188:191]
  v_mfma_f32_16x16x32_bf16 v[192:195], v[216:219], v[104:107], v[192:195]
  v_cvt_pk_bf16_f32 v251, v202, v203
  s_waitcnt lgkmcnt(2)
  v_mfma_f32_16x16x32_bf16 v[184:187], v[220:223], v[108:111], v[184:187]
  ds_read_b128 v[216:219], v70 offset:25344
  v_accvgpr_write_b32 a70, v248
  v_mfma_f32_16x16x32_bf16 v[188:191], v[220:223], v[112:115], v[188:191]
  v_mfma_f32_16x16x32_bf16 v[192:195], v[220:223], v[116:119], v[192:195]
  v_accvgpr_write_b32 a71, v249
  s_waitcnt lgkmcnt(2)
  v_mfma_f32_16x16x32_bf16 v[184:187], v[208:211], v[120:123], v[184:187]
  ds_read_b128 v[220:223], v71 offset:25344
  v_accvgpr_write_b32 a150, v250
  v_mfma_f32_16x16x32_bf16 v[188:191], v[208:211], v[124:127], v[188:191]
  v_mfma_f32_16x16x32_bf16 v[192:195], v[208:211], v[128:131], v[192:195]
  v_accvgpr_write_b32 a151, v251
  s_waitcnt lgkmcnt(2)
  v_mfma_f32_16x16x32_bf16 v[184:187], v[212:215], v[132:135], v[184:187]
  ds_read_b128 v[208:211], v70 offset:25472
  s_mov_b64 exec, s[68:69]
  v_cvt_pk_bf16_f32 v178, v204, v205
  v_cvt_pk_bf16_f32 v179, v206, v207
  s_mov_b64 exec, -1
  v_mfma_f32_16x16x32_bf16 v[188:191], v[212:215], v[136:139], v[188:191]
  v_mfma_f32_16x16x32_bf16 v[192:195], v[212:215], v[140:143], v[192:195]
  s_waitcnt lgkmcnt(2)
  v_mfma_f32_16x16x32_bf16 v[196:199], v[216:219], v[72:75], 0
  ds_read_b128 v[212:215], v71 offset:25472
  v_mfma_f32_16x16x32_bf16 v[200:203], v[216:219], v[76:79], 0
  v_mfma_f32_16x16x32_bf16 v[204:207], v[216:219], v[80:83], 0
  s_waitcnt lgkmcnt(2)
  v_mfma_f32_16x16x32_bf16 v[196:199], v[220:223], v[84:87], v[196:199]
  ds_read_b128 v[216:219], v70 offset:25600
  v_cvt_pk_bf16_f32 v248, v184, v185
  v_mfma_f32_16x16x32_bf16 v[200:203], v[220:223], v[88:91], v[200:203]
  v_mfma_f32_16x16x32_bf16 v[204:207], v[220:223], v[92:95], v[204:207]
  v_cvt_pk_bf16_f32 v249, v186, v187
  s_waitcnt lgkmcnt(2)
  v_mfma_f32_16x16x32_bf16 v[196:199], v[208:211], v[96:99], v[196:199]
  ds_read_b128 v[220:223], v71 offset:25600
  v_cvt_pk_bf16_f32 v250, v188, v189
  v_mfma_f32_16x16x32_bf16 v[200:203], v[208:211], v[100:103], v[200:203]
  v_mfma_f32_16x16x32_bf16 v[204:207], v[208:211], v[104:107], v[204:207]
  v_cvt_pk_bf16_f32 v251, v190, v191
  s_waitcnt lgkmcnt(2)
  v_mfma_f32_16x16x32_bf16 v[196:199], v[212:215], v[108:111], v[196:199]
  v_accvgpr_write_b32 a72, v248
  v_mfma_f32_16x16x32_bf16 v[200:203], v[212:215], v[112:115], v[200:203]
  v_mfma_f32_16x16x32_bf16 v[204:207], v[212:215], v[116:119], v[204:207]
  v_accvgpr_write_b32 a73, v249
  s_waitcnt lgkmcnt(1)
  v_mfma_f32_16x16x32_bf16 v[196:199], v[216:219], v[120:123], v[196:199]
  v_accvgpr_write_b32 a152, v250
  v_mfma_f32_16x16x32_bf16 v[200:203], v[216:219], v[124:127], v[200:203]
  v_mfma_f32_16x16x32_bf16 v[204:207], v[216:219], v[128:131], v[204:207]
  v_accvgpr_write_b32 a153, v251
  s_waitcnt lgkmcnt(0)
  v_mfma_f32_16x16x32_bf16 v[196:199], v[220:223], v[132:135], v[196:199]
  v_cvt_pk_bf16_f32 v180, v192, v193
  v_cvt_pk_bf16_f32 v181, v194, v195
  v_mfma_f32_16x16x32_bf16 v[200:203], v[220:223], v[136:139], v[200:203]
  v_mfma_f32_16x16x32_bf16 v[204:207], v[220:223], v[140:143], v[204:207]
  s_waitcnt vmcnt(0)
  ds_read_b128 v[208:211], v70 offset:0
  ds_read_b128 v[212:215], v71 offset:0
  ds_read_b128 v[216:219], v70 offset:128
  s_waitcnt lgkmcnt(2)
  v_mfma_f32_16x16x32_bf16 v[184:187], v[208:211], v[72:75], 0
  ds_read_b128 v[220:223], v71 offset:128
  v_mfma_f32_16x16x32_bf16 v[188:191], v[208:211], v[76:79], 0
  v_mfma_f32_16x16x32_bf16 v[192:195], v[208:211], v[80:83], 0
  s_waitcnt lgkmcnt(2)
  v_mfma_f32_16x16x32_bf16 v[184:187], v[212:215], v[84:87], v[184:187]
  ds_read_b128 v[208:211], v70 offset:256
  v_cvt_pk_bf16_f32 v248, v196, v197
  v_mfma_f32_16x16x32_bf16 v[188:191], v[212:215], v[88:91], v[188:191]
  v_mfma_f32_16x16x32_bf16 v[192:195], v[212:215], v[92:95], v[192:195]
  v_cvt_pk_bf16_f32 v249, v198, v199
  s_waitcnt lgkmcnt(2)
  v_mfma_f32_16x16x32_bf16 v[184:187], v[216:219], v[96:99], v[184:187]
  ds_read_b128 v[212:215], v71 offset:256
  v_cvt_pk_bf16_f32 v250, v200, v201
  v_mfma_f32_16x16x32_bf16 v[188:191], v[216:219], v[100:103], v[188:191]
  v_mfma_f32_16x16x32_bf16 v[192:195], v[216:219], v[104:107], v[192:195]
  v_cvt_pk_bf16_f32 v251, v202, v203
  s_waitcnt lgkmcnt(2)
  v_mfma_f32_16x16x32_bf16 v[184:187], v[220:223], v[108:111], v[184:187]
  ds_read_b128 v[216:219], v70 offset:768
  v_accvgpr_write_b32 a74, v248
  v_mfma_f32_16x16x32_bf16 v[188:191], v[220:223], v[112:115], v[188:191]
  v_mfma_f32_16x16x32_bf16 v[192:195], v[220:223], v[116:119], v[192:195]
  v_accvgpr_write_b32 a75, v249
  s_waitcnt lgkmcnt(2)
  v_mfma_f32_16x16x32_bf16 v[184:187], v[208:211], v[120:123], v[184:187]
  ds_read_b128 v[220:223], v71 offset:768
  v_accvgpr_write_b32 a154, v250
  v_mfma_f32_16x16x32_bf16 v[188:191], v[208:211], v[124:127], v[188:191]
  v_mfma_f32_16x16x32_bf16 v[192:195], v[208:211], v[128:131], v[192:195]
  v_accvgpr_write_b32 a155, v251
  s_waitcnt lgkmcnt(2)
  v_mfma_f32_16x16x32_bf16 v[184:187], v[212:215], v[132:135], v[184:187]
  ds_read_b128 v[208:211], v70 offset:896
  s_mov_b64 exec, s[68:69]
  v_cvt_pk_bf16_f32 v180, v204, v205
  v_cvt_pk_bf16_f32 v181, v206, v207
  s_mov_b64 exec, -1
  v_mfma_f32_16x16x32_bf16 v[188:191], v[212:215], v[136:139], v[188:191]
  v_mfma_f32_16x16x32_bf16 v[192:195], v[212:215], v[140:143], v[192:195]
  s_waitcnt lgkmcnt(2)
  v_mfma_f32_16x16x32_bf16 v[196:199], v[216:219], v[72:75], 0
  ds_read_b128 v[212:215], v71 offset:896
  v_mfma_f32_16x16x32_bf16 v[200:203], v[216:219], v[76:79], 0
  v_mfma_f32_16x16x32_bf16 v[204:207], v[216:219], v[80:83], 0
  s_waitcnt lgkmcnt(2)
  v_mfma_f32_16x16x32_bf16 v[196:199], v[220:223], v[84:87], v[196:199]
  ds_read_b128 v[216:219], v70 offset:1024
  v_cvt_pk_bf16_f32 v248, v184, v185
  v_mfma_f32_16x16x32_bf16 v[200:203], v[220:223], v[88:91], v[200:203]
  v_mfma_f32_16x16x32_bf16 v[204:207], v[220:223], v[92:95], v[204:207]
  v_cvt_pk_bf16_f32 v249, v186, v187
  s_waitcnt lgkmcnt(2)
  v_mfma_f32_16x16x32_bf16 v[196:199], v[208:211], v[96:99], v[196:199]
  ds_read_b128 v[220:223], v71 offset:1024
  v_cvt_pk_bf16_f32 v250, v188, v189
  v_mfma_f32_16x16x32_bf16 v[200:203], v[208:211], v[100:103], v[200:203]
  v_mfma_f32_16x16x32_bf16 v[204:207], v[208:211], v[104:107], v[204:207]
  v_cvt_pk_bf16_f32 v251, v190, v191
  s_waitcnt lgkmcnt(2)
  v_mfma_f32_16x16x32_bf16 v[196:199], v[212:215], v[108:111], v[196:199]
  v_accvgpr_write_b32 a76, v248
  v_mfma_f32_16x16x32_bf16 v[200:203], v[212:215], v[112:115], v[200:203]
  v_mfma_f32_16x16x32_bf16 v[204:207], v[212:215], v[116:119], v[204:207]
  v_accvgpr_write_b32 a77, v249
  s_waitcnt lgkmcnt(1)
  v_mfma_f32_16x16x32_bf16 v[196:199], v[216:219], v[120:123], v[196:199]
  v_accvgpr_write_b32 a156, v250
  v_mfma_f32_16x16x32_bf16 v[200:203], v[216:219], v[124:127], v[200:203]
  v_mfma_f32_16x16x32_bf16 v[204:207], v[216:219], v[128:131], v[204:207]
  v_accvgpr_write_b32 a157, v251
  s_waitcnt lgkmcnt(0)
  v_mfma_f32_16x16x32_bf16 v[196:199], v[220:223], v[132:135], v[196:199]
  v_cvt_pk_bf16_f32 v182, v192, v193
  v_cvt_pk_bf16_f32 v183, v194, v195
  v_mfma_f32_16x16x32_bf16 v[200:203], v[220:223], v[136:139], v[200:203]
  v_mfma_f32_16x16x32_bf16 v[204:207], v[220:223], v[140:143], v[204:207]
  s_nop 7
  v_cvt_pk_bf16_f32 v248, v196, v197
  v_cvt_pk_bf16_f32 v249, v198, v199
  v_cvt_pk_bf16_f32 v250, v200, v201
  v_cvt_pk_bf16_f32 v251, v202, v203
  v_accvgpr_write_b32 a78, v248
  v_accvgpr_write_b32 a79, v249
  v_accvgpr_write_b32 a158, v250
  v_accvgpr_write_b32 a159, v251
  s_mov_b64 exec, s[68:69]
  v_cvt_pk_bf16_f32 v182, v204, v205
  v_cvt_pk_bf16_f32 v183, v206, v207
  s_mov_b64 exec, -1
  s_waitcnt vmcnt(0)
  s_barrier
  s_mul_i32 s21, s20, 15360
  v_add_u32 v66, s21, v4
  v_add_u32 v67, 61440, v66
  ds_write_b128 v66, a[160:163] offset:0
  ds_write_b128 v66, a[164:167] offset:1024
  ds_write_b128 v66, a[168:171] offset:2048
  ds_write_b128 v66, a[172:175] offset:3072
  ds_write_b128 v66, a[176:179] offset:4096
  ds_write_b128 v66, a[180:183] offset:5120
  ds_write_b128 v66, a[184:187] offset:6144
  ds_write_b128 v66, a[188:191] offset:7168
  ds_write_b128 v66, a[192:195] offset:8192
  ds_write_b128 v66, a[196:199] offset:9216
  ds_write_b128 v66, a[200:203] offset:10240
  ds_write_b128 v66, a[204:207] offset:11264
  ds_write_b128 v66, a[208:211] offset:12288
  ds_write_b128 v66, a[212:215] offset:13312
  ds_write_b128 v66, a[216:219] offset:14336
  ds_write_b128 v67, a[220:223] offset:0
  ds_write_b128 v67, a[224:227] offset:1024
  ds_write_b128 v67, a[228:231] offset:2048
  ds_write_b128 v67, a[232:235] offset:3072
  ds_write_b128 v67, a[236:239] offset:4096
  ds_write_b128 v67, a[240:243] offset:5120
  ds_write_b128 v67, a[244:247] offset:6144
  ds_write_b128 v67, a[248:251] offset:7168
  ds_write_b128 v67, a[252:255] offset:8192
  ds_write_b128 v67, v[224:227] offset:9216
  ds_write_b128 v67, v[228:231] offset:10240
  ds_write_b128 v67, v[232:235] offset:11264
  ds_write_b128 v67, v[236:239] offset:12288
  ds_write_b128 v67, v[240:243] offset:13312
  ds_write_b128 v67, v[244:247] offset:14336
  s_lshr_b32 s21, s20, 1
  s_mul_i32 s21, s21, 20480
  s_and_b32 s22, s20, 1
  s_lshl_b32 s22, s22, 7
  s_add_u32 s21, s21, s22
  s_add_u32 s21, s21, 122880
  v_and_b32 v68, 7, v2
  v_lshlrev_b32 v68, 4, v68
  v_lshl_add_u32 v68, v3, 8, v68
  v_and_b32 v69, 8, v2
  v_add3_u32 v68, s21, v68, v69
  ds_write_b64 v68, v[144:145] offset:0
  ds_write_b64 v68, v[146:147] offset:1024
  ds_write_b64 v68, v[148:149] offset:2048
  ds_write_b64 v68, v[150:151] offset:3072
  ds_write_b64 v68, v[152:153] offset:4096
  ds_write_b64 v68, v[154:155] offset:5120
  ds_write_b64 v68, v[156:157] offset:6144
  ds_write_b64 v68, v[158:159] offset:7168
  ds_write_b64 v68, v[160:161] offset:8192
  ds_write_b64 v68, v[162:163] offset:9216
  ds_write_b64 v68, v[164:165] offset:10240
  ds_write_b64 v68, v[166:167] offset:11264
  ds_write_b64 v68, v[168:169] offset:12288
  ds_write_b64 v68, v[170:171] offset:13312
  ds_write_b64 v68, v[172:173] offset:14336
  ds_write_b64 v68, v[174:175] offset:15360
  ds_write_b64 v68, v[176:177] offset:16384
  ds_write_b64 v68, v[178:179] offset:17408
  ds_write_b64 v68, v[180:181] offset:18432
  ds_write_b64 v68, v[182:183] offset:19456
  v_lshrrev_b32 v72, 1, v3
  v_lshlrev_b32 v72, 4, v72
  v_and_b32 v73, 8, v2
  v_add_u32 v72, v72, v73
  v_and_b32 v73, 1, v3
  v_lshl_add_u32 v72, v73, 2, v72
  v_bfe_u32 v73, v2, 2, 1
  v_add_u32 v72, v72, v73
  v_mul_u32_u24 v72, 96, v72
  v_and_b32 v73, 3, v2
  v_lshl_add_u32 v72, v73, 3, v72
  s_lshl_b32 s21, s20, 5
  v_add_u32 v72, s21, v72
  v_add_u32 v73, 61440, v72
  v_cndmask_b32 v66, v72, v73, s[68:69]
  v_cndmask_b32 v67, v73, v72, s[68:69]
  v_add_u32 v68, 122880, v4
  s_waitcnt lgkmcnt(0)
  s_barrier
  s_cmp_eq_u32 s20, 3
  s_cbranch_scc1 w3_12
  ds_read_b64_tr_b16 a[160:161], v66 offset:0
  ds_read_b64_tr_b16 a[162:163], v66 offset:192
  ds_read_b64_tr_b16 a[164:165], v66 offset:3072
  ds_read_b64_tr_b16 a[166:167], v66 offset:3264
  ds_read_b64_tr_b16 a[168:169], v66 offset:6144
  ds_read_b64_tr_b16 a[170:171], v66 offset:6336
  ds_read_b64_tr_b16 a[172:173], v66 offset:9216
  ds_read_b64_tr_b16 a[174:175], v66 offset:9408
  ds_read_b64_tr_b16 a[176:177], v66 offset:12288
  ds_read_b64_tr_b16 a[178:179], v66 offset:12480
  ds_read_b64_tr_b16 a[180:181], v66 offset:15360
  ds_read_b64_tr_b16 a[182:183], v66 offset:15552
  ds_read_b64_tr_b16 a[184:185], v66 offset:18432
  ds_read_b64_tr_b16 a[186:187], v66 offset:18624
  ds_read_b64_tr_b16 a[188:189], v66 offset:21504
  ds_read_b64_tr_b16 a[190:191], v66 offset:21696
  ds_read_b64_tr_b16 a[192:193], v66 offset:24576
  ds_read_b64_tr_b16 a[194:195], v66 offset:24768
  ds_read_b64_tr_b16 a[196:197], v66 offset:27648
  ds_read_b64_tr_b16 a[198:199], v66 offset:27840
  ds_read_b64_tr_b16 a[200:201], v66 offset:30720
  ds_read_b64_tr_b16 a[202:203], v66 offset:30912
  ds_read_b64_tr_b16 a[204:205], v66 offset:33792
  ds_read_b64_tr_b16 a[206:207], v66 offset:33984
  ds_read_b64_tr_b16 a[208:209], v66 offset:36864
  ds_read_b64_tr_b16 a[210:211], v66 offset:37056
  ds_read_b64_tr_b16 a[212:213], v66 offset:39936
  ds_read_b64_tr_b16 a[214:215], v66 offset:40128
  ds_read_b64_tr_b16 a[216:217], v66 offset:43008
  ds_read_b64_tr_b16 a[218:219], v66 offset:43200
  ds_read_b64_tr_b16 a[220:221], v66 offset:46080
  ds_read_b64_tr_b16 a[222:223], v66 offset:46272
  ds_read_b64_tr_b16 a[224:225], v66 offset:49152
  ds_read_b64_tr_b16 a[226:227], v66 offset:49344
  ds_read_b64_tr_b16 a[228:229], v66 offset:52224
  ds_read_b64_tr_b16 a[230:231], v66 offset:52416
  ds_read_b64_tr_b16 a[232:233], v66 offset:55296
  ds_read_b64_tr_b16 a[234:235], v66 offset:55488
  ds_read_b64_tr_b16 a[236:237], v66 offset:58368
  ds_read_b64_tr_b16 a[238:239], v66 offset:58560
  ds_read_b64_tr_b16 a[240:241], v67 offset:0
  ds_read_b64_tr_b16 a[242:243], v67 offset:192
  ds_read_b64_tr_b16 a[244:245], v67 offset:3072
  ds_read_b64_tr_b16 a[246:247], v67 offset:3264
  ds_read_b64_tr_b16 a[248:249], v67 offset:6144
  ds_read_b64_tr_b16 a[250:251], v67 offset:6336
  ds_read_b64_tr_b16 a[252:253], v67 offset:9216
  ds_read_b64_tr_b16 a[254:255], v67 offset:9408
  ds_read_b64_tr_b16 v[192:193], v67 offset:12288
  ds_read_b64_tr_b16 v[194:195], v67 offset:12480
  ds_read_b64_tr_b16 v[196:197], v67 offset:15360
  ds_read_b64_tr_b16 v[198:199], v67 offset:15552
  ds_read_b64_tr_b16 v[200:201], v67 offset:18432
  ds_read_b64_tr_b16 v[202:203], v67 offset:18624
  ds_read_b64_tr_b16 v[204:205], v67 offset:21504
  ds_read_b64_tr_b16 v[206:207], v67 offset:21696
  ds_read_b64_tr_b16 v[208:209], v67 offset:24576
  ds_read_b64_tr_b16 v[210:211], v67 offset:24768
  ds_read_b64_tr_b16 v[212:213], v67 offset:27648
  ds_read_b64_tr_b16 v[214:215], v67 offset:27840
  ds_read_b64_tr_b16 v[216:217], v67 offset:30720
  ds_read_b64_tr_b16 v[218:219], v67 offset:30912
  ds_read_b64_tr_b16 v[220:221], v67 offset:33792
  ds_read_b64_tr_b16 v[222:223], v67 offset:33984
  ds_read_b64_tr_b16 v[224:225], v67 offset:36864
  ds_read_b64_tr_b16 v[226:227], v67 offset:37056
  ds_read_b64_tr_b16 v[228:229], v67 offset:39936
  ds_read_b64_tr_b16 v[230:231], v67 offset:40128
  ds_read_b64_tr_b16 v[232:233], v67 offset:43008
  ds_read_b64_tr_b16 v[234:235], v67 offset:43200
  ds_read_b64_tr_b16 v[236:237], v67 offset:46080
  ds_read_b64_tr_b16 v[238:239], v67 offset:46272
  ds_read_b64_tr_b16 v[240:241], v67 offset:49152
  ds_read_b64_tr_b16 v[242:243], v67 offset:49344
  ds_read_b64_tr_b16 v[244:245], v67 offset:52224
  ds_read_b64_tr_b16 v[246:247], v67 offset:52416
  ds_read_b64_tr_b16 v[248:249], v67 offset:55296
  ds_read_b64_tr_b16 v[250:251], v67 offset:55488
  ds_read_b64_tr_b16 v[252:253], v67 offset:58368
  ds_read_b64_tr_b16 v[254:255], v67 offset:58560
  s_branch w3_13
w3_12:
  ds_read_b128 a[160:163], v68 offset:0
  ds_read_b128 a[164:167], v68 offset:1024
  ds_read_b128 a[168:171], v68 offset:2048
  ds_read_b128 a[172:175], v68 offset:3072
  ds_read_b128 a[176:179], v68 offset:4096
  ds_read_b128 a[180:183], v68 offset:5120
  ds_read_b128 a[184:187], v68 offset:6144
  ds_read_b128 a[188:191], v68 offset:7168
  ds_read_b128 a[192:195], v68 offset:8192
  ds_read_b128 a[196:199], v68 offset:9216
  ds_read_b128 a[200:203], v68 offset:10240
  ds_read_b128 a[204:207], v68 offset:11264
  ds_read_b128 a[208:211], v68 offset:12288
  ds_read_b128 a[212:215], v68 offset:13312
  ds_read_b128 a[216:219], v68 offset:14336
  ds_read_b128 a[220:223], v68 offset:15360
  ds_read_b128 a[224:227], v68 offset:16384
  ds_read_b128 a[228:231], v68 offset:17408
  ds_read_b128 a[232:235], v68 offset:18432
  ds_read_b128 a[236:239], v68 offset:19456
  ds_read_b128 a[240:243], v68 offset:20480
  ds_read_b128 a[244:247], v68 offset:21504
  ds_read_b128 a[248:251], v68 offset:22528
  ds_read_b128 a[252:255], v68 offset:23552
  ds_read_b128 v[192:195], v68 offset:24576
  ds_read_b128 v[196:199], v68 offset:25600
  ds_read_b128 v[200:203], v68 offset:26624
  ds_read_b128 v[204:207], v68 offset:27648
  ds_read_b128 v[208:211], v68 offset:28672
  ds_read_b128 v[212:215], v68 offset:29696
  ds_read_b128 v[216:219], v68 offset:30720
  ds_read_b128 v[220:223], v68 offset:31744
  ds_read_b128 v[224:227], v68 offset:32768
  ds_read_b128 v[228:231], v68 offset:33792
  ds_read_b128 v[232:235], v68 offset:34816
  ds_read_b128 v[236:239], v68 offset:35840
  ds_read_b128 v[240:243], v68 offset:36864
  ds_read_b128 v[244:247], v68 offset:37888
  ds_read_b128 v[248:251], v68 offset:38912
  ds_read_b128 v[252:255], v68 offset:39936
w3_13:
  s_waitcnt lgkmcnt(0)
  s_barrier
  v_and_b32 v72, 7, v1
  v_mul_u32_u24 v72, 1280, v72
  v_lshrrev_b32 v73, 3, v1
  v_lshl_add_u32 v72, v73, 4, v72
  s_mul_i32 s21, s20, 3
  s_min_u32 s21, s21, 7
  s_lshl_b32 s22, s21, 7
  s_lshl_b32 s21, s21, 10
  s_add_u32 m0, s21, 0
  s_add_u32 s23, s22, 0
  buffer_load_dwordx4 v72, s[36:39], s23 offen lds
  s_add_u32 m0, s21, 1024
  s_add_u32 s23, s22, 128
  buffer_load_dwordx4 v72, s[36:39], s23 offen lds
  s_add_u32 m0, s21, 2048
  s_add_u32 s23, s22, 256
  buffer_load_dwordx4 v72, s[36:39], s23 offen lds
  v_mov_b32 v76, 0x3f803f80
  v_mov_b32 v77, 0x3f803f80
  v_mov_b32 v78, 0x3f803f80
  v_mov_b32 v79, 0x3f803f80
  v_mov_b32 v80, 0x3f003f00
  v_mov_b32 v81, 0x3f003f00
  ds_write_b128 v23, v[76:79] offset:46080
  ds_write_b128 v23, v[76:79] offset:62464
  ds_write_b64 v23, v[80:81] offset:13568
  s_waitcnt vmcnt(0)
  s_add_u32 s12, s48, 81068032
  s_addc_u32 s13, s49, 0
  s_mov_b32 s14, 115712
  s_mov_b32 s15, 0x00020000
  s_mov_b32 s16, s48
  s_mov_b32 s17, s49
  s_mov_b32 s18, 25165824
  s_mov_b32 s19, 0x00020000
  s_add_u32 s24, s48, 50331648
  s_addc_u32 s25, s49, 0
  s_mov_b32 s26, 6291456
  s_mov_b32 s27, 0x00020000
  s_add_u32 s28, s48, 114294784
  s_addc_u32 s29, s49, 0
  s_mov_b32 s30, 83886080
  s_mov_b32 s31, 0x00020000
  s_add_u32 s36, s48, 93323264
  s_addc_u32 s37, s49, 0
  s_mov_b32 s38, 20971520
  s_mov_b32 s39, 0x00020000
  s_lshl_b32 s76, s50, 9
  s_and_b32 s21, s51, 12
  s_add_u32 s76, s76, s21
  s_add_u32 s76, s76, 94208
  s_cmp_lg_u32 s20, 0
  s_cbranch_scc1 fm_15
  v_lshlrev_b32 v67, 2, v1
  s_bfe_u32 s82, s50, 0x10001
  s_lshl_b32 s82, s82, 5
  s_lshr_b32 s21, s50, 2
  s_add_u32 s82, s82, s21
  s_mov_b32 s101, 0
  s_mov_b32 s83, 0
  s_branch fm_16
fm_14:
  s_sleep 8
fm_16:
  buffer_load_dword v66, v67, s[32:35], 0 offen sc1
  buffer_load_dword v42, v41, s[12:15], s76 offen sc1
  s_add_u32 s101, s101, 1
  s_cmp_gt_u32 s101, 131072
  s_cbranch_scc1 end0
  s_waitcnt vmcnt(0)
  s_mov_b32 s84, s83
  v_readlane_b32 s83, v66, 19
  s_cmp_eq_u32 s83, 0
  s_cbranch_scc1 fm_14
  s_cmp_eq_u32 s84, 0
  s_cbranch_scc1 fm_16
  v_readlane_b32 s22, v66, 0
  v_readlane_b32 s23, v66, 32
  s_add_u32 s22, s22, s23
  v_readlane_b32 s23, v66, 1
  s_add_u32 s22, s22, s23
  v_readlane_b32 s23, v66, 33
  s_add_u32 s22, s22, s23
  v_readlane_b32 s23, v66, 2
  s_add_u32 s22, s22, s23
  v_readlane_b32 s23, v66, 34
  s_add_u32 s22, s22, s23
  v_readlane_b32 s23, v66, 3
  s_add_u32 s22, s22, s23
  v_readlane_b32 s23, v66, 35
  s_add_u32 s22, s22, s23
  v_readlane_b32 s21, v66, 16
  v_readlane_b32 s23, v66, 21
  v_cmp_gt_u32 vcc, 2, v42
  s_cmp_ge_u32 s22, 256
  s_cselect_b32 s23, s23, 0
  s_cmp_ge_u32 s21, 128
  s_cselect_b32 s23, s23, 0
  s_cbranch_vccnz fm_14
  s_cmp_eq_u32 s23, 0
  s_cbranch_scc1 fm_14
  v_readlane_b32 s21, v66, s82
  v_cmp_ne_u32 vcc, 32, v66
  s_cmp_ge_u32 s21, 32
  s_cselect_b32 s84, 1, 0
  s_andn2_b32 s53, s84, s53
  s_and_b32 s21, vcc_lo, 15
  s_and_b32 s22, vcc_hi, 15
  s_or_b32 s21, s21, s22
  v_mov_b32 v76, s23
  v_mov_b32 v77, s53
  v_mov_b32 v78, s21
  ds_write_b96 v23, v[76:78] offset:13824
fm_15:
  s_waitcnt lgkmcnt(0)
  s_barrier
  ds_read_b96 v[76:78], v23 offset:13824
  s_mul_i32 s72, s57, 40960
  s_mul_i32 s21, s60, 5120
  s_add_u32 s72, s72, s21
  s_mul_i32 s79, s61, 3072
  s_add_u32 s79, s79, s72
  s_mul_i32 s73, s58, 12288
  s_mul_i32 s21, s56, 3072
  s_add_u32 s73, s73, s21
  s_mov_b32 s74, 32768
  s_mul_i32 s70, s58, 3072
  s_mul_i32 s71, s57, 10240
  s_mul_i32 s21, s51, 640
  s_add_u32 s71, s71, s21
  s_cmp_lg_u32 s20, 3
  s_cbranch_scc1 pd_18
  s_add_u32 m0, s74, 10240
  s_nop 0
  buffer_load_dwordx4 v4, s[16:19], s73 offen offset:0 sc1 lds
  s_add_u32 m0, s74, 10240
  s_nop 0
  buffer_load_dwordx4 v4, s[16:19], s73 offen offset:1024 sc1 lds
  s_add_u32 m0, s74, 10240
  s_nop 0
  buffer_load_dwordx4 v4, s[16:19], s73 offen offset:2048 sc1 lds
  s_add_u32 m0, s74, 8192
  s_add_u32 s21, s72, 2048
  buffer_load_dwordx4 v32, s[28:31], s21 offen sc1 lds
  s_add_u32 m0, s74, 9216
  s_add_u32 s21, s72, 83968
  buffer_load_dwordx4 v32, s[28:31], s21 offen sc1 lds
  s_add_u32 m0, s74, 0
  s_add_u32 s21, s79, 0
  buffer_load_dwordx4 v4, s[28:31], s21 offen sc1 lds
  s_add_u32 m0, s74, 1024
  s_add_u32 s21, s79, 1024
  buffer_load_dwordx4 v4, s[28:31], s21 offen sc1 lds
  s_add_u32 m0, s74, 2048
  s_add_u32 s21, s79, 40960
  buffer_load_dwordx4 v4, s[28:31], s21 offen sc1 lds
  s_add_u32 m0, s74, 3072
  s_add_u32 s21, s79, 41984
  buffer_load_dwordx4 v4, s[28:31], s21 offen sc1 lds
  s_add_u32 m0, s74, 4096
  s_add_u32 s21, s79, 81920
  buffer_load_dwordx4 v4, s[28:31], s21 offen sc1 lds
  s_add_u32 m0, s74, 5120
  s_add_u32 s21, s79, 82944
  buffer_load_dwordx4 v4, s[28:31], s21 offen sc1 lds
  s_add_u32 m0, s74, 6144
  s_add_u32 s21, s79, 122880
  buffer_load_dwordx4 v4, s[28:31], s21 offen sc1 lds
  s_add_u32 m0, s74, 7168
  s_add_u32 s21, s79, 123904
  buffer_load_dwordx4 v4, s[28:31], s21 offen sc1 lds
  s_add_u32 s72, s72, 1310720
  s_add_u32 s79, s79, 1310720
  s_add_u32 s73, s73, 393216
  s_xor_b32 s74, s74, 16384
  s_add_u32 m0, s74, 8192
  s_add_u32 s21, s72, 2048
  buffer_load_dwordx4 v32, s[28:31], s21 offen sc1 lds
  s_add_u32 m0, s74, 9216
  s_add_u32 s21, s72, 83968
  buffer_load_dwordx4 v32, s[28:31], s21 offen sc1 lds
  s_add_u32 m0, s74, 0
  s_add_u32 s21, s79, 0
  buffer_load_dwordx4 v4, s[28:31], s21 offen sc1 lds
  s_add_u32 m0, s74, 1024
  s_add_u32 s21, s79, 1024
  buffer_load_dwordx4 v4, s[28:31], s21 offen sc1 lds
  s_add_u32 m0, s74, 2048
  s_add_u32 s21, s79, 40960
  buffer_load_dwordx4 v4, s[28:31], s21 offen sc1 lds
  s_add_u32 m0, s74, 3072
  s_add_u32 s21, s79, 41984
  buffer_load_dwordx4 v4, s[28:31], s21 offen sc1 lds
  s_add_u32 m0, s74, 4096
  s_add_u32 s21, s79, 81920
  buffer_load_dwordx4 v4, s[28:31], s21 offen sc1 lds
  s_add_u32 m0, s74, 5120
  s_add_u32 s21, s79, 82944
  buffer_load_dwordx4 v4, s[28:31], s21 offen sc1 lds
  s_add_u32 m0, s74, 6144
  s_add_u32 s21, s79, 122880
  buffer_load_dwordx4 v4, s[28:31], s21 offen sc1 lds
  s_add_u32 m0, s74, 7168
  s_add_u32 s21, s79, 123904
  buffer_load_dwordx4 v4, s[28:31], s21 offen sc1 lds
  v_mov_b32 v42, 0
  s_branch pd_19
pd_18:
  s_add_u32 s72, s72, 1310720
  s_add_u32 s79, s79, 1310720
  s_add_u32 s73, s73, 393216
  s_xor_b32 s74, s74, 16384
  s_add_u32 s72, s72, 1310720
  s_add_u32 s79, s79, 1310720
  s_add_u32 s73, s73, 393216
  s_xor_b32 s74, s74, 16384
pd_19:
  s_waitcnt lgkmcnt(0)
  v_readfirstlane_b32 s53, v77
  v_readfirstlane_b32 s21, v78
  s_cmp_eq_u32 s21, 0
  s_cbranch_scc1 fm_17
  s_cmp_eq_u32 s20, 3
  s_cbranch_scc1 ar_21
  s_mov_b64 exec, s[64:65]
  s_cmp_eq_u32 s20, 2
  s_cbranch_scc1 ar_20
  s_mov_b32 s21, 0
  buffer_store_dwordx2 v[28:29], v8, s[8:11], s21 offen sc1
  s_mov_b32 s21, 122880
  buffer_store_dwordx2 v[28:29], v8, s[8:11], s21 offen sc1
  s_mov_b32 s21, 245760
  buffer_store_dwordx2 v[28:29], v8, s[8:11], s21 offen sc1
  s_mov_b32 s21, 368640
  buffer_store_dwordx2 v[28:29], v8, s[8:11], s21 offen sc1
  s_branch ar_22
ar_20:
  s_mov_b32 s21, 0
  buffer_store_dword v28, v8, s[8:11], s21 offen sc1
  buffer_store_dword v28, v8, s[8:11], s21 offen offset:128 sc1
  s_mov_b32 s21, 122880
  buffer_store_dword v28, v8, s[8:11], s21 offen sc1
  buffer_store_dword v28, v8, s[8:11], s21 offen offset:128 sc1
  s_mov_b32 s21, 245760
  buffer_store_dword v28, v8, s[8:11], s21 offen sc1
  buffer_store_dword v28, v8, s[8:11], s21 offen offset:128 sc1
  s_mov_b32 s21, 368640
  buffer_store_dword v28, v8, s[8:11], s21 offen sc1
  buffer_store_dword v28, v8, s[8:11], s21 offen offset:128 sc1
ar_22:
  s_cmp_eq_u32 s78, 0
  s_cbranch_scc1 ar_23
  s_mov_b64 exec, s[62:63]
  s_add_u32 s21, s77, 0
  buffer_store_dword v28, v17, s[8:11], s21 offen sc1
  s_add_u32 s21, s77, 122880
  buffer_store_dword v28, v17, s[8:11], s21 offen sc1
  s_add_u32 s21, s77, 245760
  buffer_store_dword v28, v17, s[8:11], s21 offen sc1
  s_add_u32 s21, s77, 368640
  buffer_store_dword v28, v17, s[8:11], s21 offen sc1
  s_branch ar_23
ar_21:
  s_mov_b64 exec, s[66:67]
  s_mov_b32 s21, 0
  buffer_store_dwordx4 v[28:31], v15, s[4:7], s21 offen sc1
  s_mov_b32 s21, 524288
  buffer_store_dwordx4 v[28:31], v15, s[4:7], s21 offen sc1
  s_mov_b32 s21, 8192
  buffer_store_dwordx4 v[28:31], v15, s[4:7], s21 offen sc1
  s_mov_b32 s21, 532480
  buffer_store_dwordx4 v[28:31], v15, s[4:7], s21 offen sc1
ar_23:
  s_mov_b64 exec, -1
  s_waitcnt vmcnt(0)
  s_barrier
  s_mov_b32 s21, 100
  s_cmp_lg_u32 s20, 0
  s_cbranch_scc1 af_24
  v_mov_b32 v80, 0
  v_mov_b32 v81, 1
  s_mov_b64 exec, 1
  buffer_atomic_add v81, v80, s[32:35], s21 offen sc1
  s_mov_b64 exec, -1
  s_nop 1
af_24:
  s_cmp_lg_u32 s20, 0
  s_cbranch_scc1 wf_26
  v_mov_b32 v80, 0
  s_mov_b32 s101, 0
wf_25:
  buffer_load_dword v81, v80, s[32:35], s21 offen sc1
  s_add_u32 s101, s101, 1
  s_cmp_gt_u32 s101, 131072
  s_cbranch_scc1 end0
  s_waitcnt vmcnt(0)
  v_readfirstlane_b32 s100, v81
  s_cmp_ge_u32 s100, 128
  s_cbranch_scc1 wf_26
  s_sleep 8
  s_branch wf_25
wf_26:
  s_barrier
fm_17:
  v_add_u32 v76, -1, v76
  v_lshlrev_b32 v76, 13, v76
  v_add_u32 v15, v15, v76
  v_add_u32 v16, v16, v76
  s_mov_b32 s75, s77
  s_lshl_b32 s77, s58, 7
  s_lshl_b32 s21, s56, 3
  s_add_u32 s77, s77, s21
  s_add_u32 s77, s77, 18432
  s_mov_b32 s80, 0x53800000
  s_mov_b32 s52, 0
  s_mov_b32 s81, 0
  s_waitcnt vmcnt(0)
  s_barrier
  ds_read_b128 v[144:147], v18
  ds_read_b128 v[148:151], v18 offset:1024
  ds_read_b128 v[152:155], v19
  ds_read_b128 v[112:115], v20
  ds_read_b64 v[116:117], v21
  v_xor_b32 v18, 16384, v18
  v_xor_b32 v19, 16384, v19
  v_xor_b32 v20, 16384, v20
  v_xor_b32 v21, 16384, v21
  v_mov_b32 v88, 0
  v_mov_b32 v89, 0
  v_mov_b32 v90, 0
  v_mov_b32 v91, 0
  v_mov_b32 v92, 0
  v_mov_b32 v93, 0
  v_mov_b32 v94, 0
  v_mov_b32 v95, 0
  v_mov_b32 v96, 0
  v_mov_b32 v97, 0
  v_mov_b32 v98, 0
  v_mov_b32 v99, 0
  v_mov_b32 v100, 0
  v_mov_b32 v101, 0
  v_mov_b32 v102, 0
  v_mov_b32 v103, 0
  v_mov_b32 v110, 0
  v_mov_b32 v111, 0
  v_mov_b32 v118, 0
  v_mov_b32 v119, 0
  v_mov_b32 v142, 0
  v_mov_b32 v143, 0
  v_mov_b32 v162, 0
  v_mov_b32 v163, 0
  s_and_b32 s21, s52, 3
  s_mul_i32 s56, s21, 122880
  s_add_u32 s21, s52, 1
  s_and_b32 s21, s21, 3
  s_mul_i32 s55, s21, 122880
  s_add_u32 s55, s55, s75
  s_add_u32 s21, s52, 2
  s_and_b32 s21, s21, 3
  s_mul_i32 s57, s21, 122880
  s_add_u32 s21, s52, 3
  s_and_b32 s21, s21, 3
  s_mul_i32 s59, s21, 122880
  s_add_u32 s59, s59, s75
  s_bfe_u32 s61, s52, 0x10001
  s_and_b32 s21, s52, 1
  s_lshl_b32 s60, s21, 19
  s_mov_b32 s58, s55
  s_waitcnt lgkmcnt(0)
  s_lshl_b32 s21, s53, 2
  s_add_u32 s21, s21, s20
  s_cmp_eq_u32 s21, 0
  s_cbranch_scc1 E_27
  s_cmp_eq_u32 s21, 4
  s_cbranch_scc1 E_28
  s_cmp_eq_u32 s21, 1
  s_cbranch_scc1 E_29
  s_cmp_eq_u32 s21, 5
  s_cbranch_scc1 E_30
  s_cmp_eq_u32 s21, 2
  s_cbranch_scc1 E_31
  s_cmp_eq_u32 s21, 6
  s_cbranch_scc1 E_32
  s_cmp_eq_u32 s21, 3
  s_cbranch_scc1 E_33
  s_cmp_eq_u32 s21, 7
  s_cbranch_scc1 E_34
  s_branch end0
E_28:
  v_add_u32 v190, 0, v4
  ds_read_b128 v[48:51], v4 offset:0
  ds_read_b128 v[52:55], v4 offset:1024
  ds_read_b128 v[56:59], v4 offset:2048
  s_waitcnt lgkmcnt(0)
  s_branch mo_40
  .p2align 3
top_35:
  s_waitcnt vmcnt(2)
  ds_write_b128 v190, v[48:51] offset:0
  v_cmp_eq_u32 s[22:23], -1, v48
  s_waitcnt vmcnt(1)
  ds_write_b128 v190, v[52:55] offset:1024
  v_cmp_eq_u32 s[98:99], -1, v52
  s_waitcnt vmcnt(0)
  ds_write_b128 v190, v[56:59] offset:2048
  v_cmp_eq_u32 s[100:101], -1, v56
  s_or_b64 vcc, s[22:23], s[98:99]
  s_or_b64 vcc, vcc, s[100:101]
  s_cbranch_scc1 mr_36
mo_40:
  s_waitcnt lgkmcnt(0)
  s_barrier
  ds_read_b128 v[60:63], v4 offset:3072
  ds_read_b128 v[64:67], v4 offset:4096
  v_smfmac_f32_16x16x64_bf16 v[92:95], v[48:51], a[240:247], v22
  ds_read_b128 v[68:71], v4 offset:5120
  v_smfmac_f32_16x16x64_bf16 v[88:91], v[48:51], a[160:167], v22
  ds_read_b128 v[72:75], v4 offset:6144
  v_smfmac_f32_16x16x64_bf16 v[92:95], v[52:55], a[248:255], v22
  ds_read_b128 v[76:79], v4 offset:7168
  v_smfmac_f32_16x16x64_bf16 v[88:91], v[52:55], a[168:175], v22
  ds_read_b128 v[80:83], v4 offset:8192
  v_smfmac_f32_16x16x64_bf16 v[92:95], v[56:59], v[192:199], v22
  ds_read_b128 v[84:87], v4 offset:9216
  v_smfmac_f32_16x16x64_bf16 v[88:91], v[56:59], a[176:183], v22
  s_waitcnt lgkmcnt(6)
  v_smfmac_f32_16x16x64_bf16 v[92:95], v[60:63], v[200:207], v22
  v_smfmac_f32_16x16x64_bf16 v[88:91], v[60:63], a[184:191], v22
  s_waitcnt lgkmcnt(5)
  v_smfmac_f32_16x16x64_bf16 v[92:95], v[64:67], v[208:215], v22
  s_waitcnt lgkmcnt(4)
  v_smfmac_f32_16x16x64_bf16 v[92:95], v[68:71], v[216:223], v22
  s_waitcnt lgkmcnt(3)
  v_smfmac_f32_16x16x64_bf16 v[92:95], v[72:75], v[224:231], v22
  s_waitcnt lgkmcnt(2)
  v_smfmac_f32_16x16x64_bf16 v[92:95], v[76:79], v[232:239], v22
  s_waitcnt lgkmcnt(1)
  v_smfmac_f32_16x16x64_bf16 v[92:95], v[80:83], v[240:247], v22
  s_waitcnt lgkmcnt(0)
  v_smfmac_f32_16x16x64_bf16 v[92:95], v[84:87], v[248:255], v22
  v_smfmac_f32_16x16x64_bf16 v[88:91], v[64:67], a[192:199], v22
  v_smfmac_f32_16x16x64_bf16 v[88:91], v[68:71], a[200:207], v22
  v_smfmac_f32_16x16x64_bf16 v[88:91], v[72:75], a[208:215], v22
  v_permlane32_swap_b32 v92, v93
  v_smfmac_f32_16x16x64_bf16 v[88:91], v[76:79], a[216:223], v22
  v_permlane32_swap_b32 v94, v95
  v_smfmac_f32_16x16x64_bf16 v[88:91], v[80:83], a[224:231], v22
  v_permlane32_swap_b32 v93, v92
  v_smfmac_f32_16x16x64_bf16 v[88:91], v[84:87], a[232:239], v22
  v_permlane32_swap_b32 v95, v94
  v_pk_mul_f32 v[120:121], v[92:93], v[24:25] op_sel:[1,0] op_sel_hi:[0,1]
  v_pk_mul_f32 v[122:123], v[94:95], v[24:25] op_sel:[1,0] op_sel_hi:[0,1]
  s_nop 4
  v_pk_fma_f32 v[88:89], v[88:89], v[24:25], v[120:121]
  v_pk_fma_f32 v[90:91], v[90:91], v[24:25], v[122:123]
  v_cvt_pk_bf16_f32 v120, v88, v89
  v_cvt_pk_bf16_f32 v121, v90, v91
  ds_write_b64 v6, v[120:121]
  v_cmp_u_f32 vcc, v88, v89
  v_cmp_u_f32 s[22:23], v90, v91
  s_nop 1
  s_or_b64 vcc, vcc, s[22:23]
  s_cbranch_vccnz mn_37
mk_38:
  s_waitcnt lgkmcnt(0)
  s_barrier
  ds_read_b64_tr_b16 v[104:105], v7 offset:0
  ds_read_b64_tr_b16 v[106:107], v7 offset:768
  ds_read_b64_tr_b16 v[108:109], v7 offset:1536
  ds_read_b64 v[140:141], v11
  s_cmp_eq_u32 s52, 63
  s_cbranch_scc1 last_39
  s_waitcnt lgkmcnt(2)
  v_mfma_f32_16x16x32_bf16 v[120:123], v[112:115], v[104:107], 0
  s_waitcnt lgkmcnt(1)
  v_mfma_f32_16x16x32_bf16 v[120:123], v[116:119], v[108:111], v[120:123]
  s_mov_b64 exec, s[64:65]
  s_nop 6
  v_cvt_pk_f16_f32 v120, v120, v121
  v_cvt_pk_f16_f32 v121, v122, v123
  buffer_store_dwordx2 v[120:121], v8, s[8:11], s56 offen
  s_mov_b64 exec, -1
  s_sleep 3
  s_nop 1
  v_smfmac_f32_16x16x64_bf16 v[96:99], v[48:51], a[0:7], v22
  v_smfmac_f32_16x16x64_bf16 v[100:103], v[48:51], a[80:87], v22
  v_smfmac_f32_16x16x64_bf16 v[96:99], v[52:55], a[8:15], v22
  v_smfmac_f32_16x16x64_bf16 v[100:103], v[52:55], a[88:95], v22
  v_smfmac_f32_16x16x64_bf16 v[96:99], v[56:59], a[16:23], v22
  v_smfmac_f32_16x16x64_bf16 v[100:103], v[56:59], a[96:103], v22
  v_smfmac_f32_16x16x64_bf16 v[96:99], v[60:63], a[24:31], v22
  v_smfmac_f32_16x16x64_bf16 v[96:99], v[64:67], a[32:39], v22
  v_smfmac_f32_16x16x64_bf16 v[96:99], v[68:71], a[40:47], v22
  v_smfmac_f32_16x16x64_bf16 v[96:99], v[72:75], a[48:55], v22
  v_smfmac_f32_16x16x64_bf16 v[96:99], v[76:79], a[56:63], v22
  buffer_load_dwordx4 v[124:127], v9, s[8:11], s56 offen sc1
  v_smfmac_f32_16x16x64_bf16 v[96:99], v[80:83], a[64:71], v22
  buffer_load_dwordx4 v[128:131], v9, s[8:11], s56 offen offset:1024 sc1
  v_smfmac_f32_16x16x64_bf16 v[96:99], v[84:87], a[72:79], v22
  buffer_load_dwordx4 v[132:135], v10, s[8:11], s56 offen sc1
  v_smfmac_f32_16x16x64_bf16 v[100:103], v[60:63], a[104:111], v22
  v_smfmac_f32_16x16x64_bf16 v[100:103], v[64:67], a[112:119], v22
  v_smfmac_f32_16x16x64_bf16 v[100:103], v[68:71], a[120:127], v22
  v_smfmac_f32_16x16x64_bf16 v[100:103], v[72:75], a[128:135], v22
  v_cvt_pk_bf16_f32 v136, v96, v97
  v_smfmac_f32_16x16x64_bf16 v[100:103], v[76:79], a[136:143], v22
  v_cvt_pk_bf16_f32 v137, v98, v99
  v_smfmac_f32_16x16x64_bf16 v[100:103], v[80:83], a[144:151], v22
  v_smfmac_f32_16x16x64_bf16 v[100:103], v[84:87], a[152:159], v22
  s_waitcnt vmcnt(2)
  v_pk_add_f16 v172, v124, v126
  v_pk_add_f16 v173, v125, v127
  s_waitcnt vmcnt(1)
  v_pk_add_f16 v174, v128, v130
  v_pk_add_f16 v175, v129, v131
  v_fma_mix_f32 v166, v172, 1.0, v174 op_sel:[0,0,0] op_sel_hi:[1,0,1]
  v_fma_mix_f32 v168, v173, 1.0, v175 op_sel:[0,0,0] op_sel_hi:[1,0,1]
  s_waitcnt vmcnt(0)
  v_pk_add_f16 v176, v132, v133
  v_pk_add_f16 v177, v134, v135
  v_fma_mix_f32 v170, v176, 1.0, v177 op_sel:[0,0,0] op_sel_hi:[1,0,1]
  v_fma_mix_f32 v167, v172, 1.0, v174 op_sel:[1,0,1] op_sel_hi:[1,0,1]
  v_cmp_u_f32 vcc, v166, v170
  v_fma_mix_f32 v169, v173, 1.0, v175 op_sel:[1,0,1] op_sel_hi:[1,0,1]
  v_fma_mix_f32 v171, v176, 1.0, v177 op_sel:[1,0,1] op_sel_hi:[1,0,1]
  v_cvt_pk_bf16_f32 v138, v100, v101
  s_cbranch_vccnz sr_41
sj_42:
ex_43:
  v_exp_f32 v172, v166
  v_exp_f32 v173, v167
  v_exp_f32 v174, v168
  v_cvt_pk_bf16_f32 v156, v172, v173
  v_exp_f32 v175, v169
  v_exp_f32 v176, v170
  v_cvt_pk_bf16_f32 v157, v174, v175
  v_mov_b32_dpp v158, v156 row_ror:8 row_mask:0xf bank_mask:0xf
  v_exp_f32 v177, v171
  v_mov_b32_dpp v159, v157 row_ror:8 row_mask:0xf bank_mask:0xf
  v_cvt_pk_bf16_f32 v160, v176, v177
  v_cvt_pk_bf16_f32 v139, v102, v103
  v_mfma_f32_16x16x32_bf16 v[178:181], v[152:155], v[156:159], 0
  s_waitcnt lgkmcnt(0)
  v_mov_b32_dpp v161, v160 row_ror:8 row_mask:0xf bank_mask:0xf
  v_mfma_f32_16x16x32_bf16 v[182:185], v[144:147], v[156:159], 0
  s_nop 0
  v_mfma_f32_16x16x32_bf16 v[178:181], v[140:143], v[160:163], v[178:181]
  v_mfma_f32_16x16x32_bf16 v[182:185], v[136:139], v[160:163], v[182:185]
  v_mfma_f32_16x16x32_bf16 v[186:189], v[148:151], v[156:159], 0
  v_mfma_f32_16x16x32_bf16 v[186:189], v[138:141], v[160:163], v[186:189]
  s_mov_b64 exec, s[62:63]
  v_rcp_f32 v164, v180
  s_nop 0
  v_pk_mul_f32 v[178:179], v[178:179], v[164:165] op_sel_hi:[1,0]
  v_pk_mul_f32 v[182:183], v[182:183], v[164:165] op_sel_hi:[1,0]
  v_pk_mul_f32 v[184:185], v[184:185], v[164:165] op_sel_hi:[1,0]
  v_cvt_pk_f16_f32 v64, v178, v179
  v_cvt_pk_f16_f32 v60, v182, v183
  v_pk_mul_f32 v[186:187], v[186:187], v[164:165] op_sel_hi:[1,0]
  v_pk_mul_f32 v[188:189], v[188:189], v[164:165] op_sel_hi:[1,0]
  v_cvt_pk_f16_f32 v61, v184, v185
  v_cvt_pk_f16_f32 v62, v186, v187
  v_cvt_pk_f16_f32 v63, v188, v189
  ds_write_b128 v13, v[60:63]
  ds_write_b32 v14, v64
  v_add_f32 v165, v164, v180
  v_cmp_ngt_f32 vcc, s80, v165
  s_mov_b64 exec, -1
  s_nop 0
  s_cbranch_vccnz fx_44
fk_45:
  s_waitcnt lgkmcnt(0)
  s_barrier
  s_add_u32 m0, s74, 8192
  s_add_u32 s21, s72, 2048
  buffer_load_dwordx4 v32, s[28:31], s21 offen sc1 lds
  s_add_u32 m0, s74, 1024
  s_add_u32 s21, s79, 1024
  buffer_load_dwordx4 v4, s[28:31], s21 offen sc1 lds
  s_add_u32 m0, s74, 4096
  s_add_u32 s21, s79, 81920
  buffer_load_dwordx4 v4, s[28:31], s21 offen sc1 lds
  s_add_u32 m0, s74, 7168
  s_add_u32 s21, s79, 123904
  buffer_load_dwordx4 v4, s[28:31], s21 offen sc1 lds
  s_add_u32 s72, s72, 1310720
  s_add_u32 s79, s79, 1310720
  s_add_u32 s73, s73, 393216
  s_xor_b32 s74, s74, 16384
  s_nop 15
  s_nop 3
  v_permlane32_swap_b32 v96, v100
  v_permlane32_swap_b32 v97, v101
  v_permlane32_swap_b32 v98, v102
  v_permlane32_swap_b32 v99, v103
  v_pk_add_f32 v[96:97], v[96:97], v[100:101]
  v_pk_add_f32 v[98:99], v[98:99], v[102:103]
  v_cvt_pk_bf16_f32 v182, v96, v97
  v_cvt_pk_bf16_f32 v183, v98, v99
  v_min_u32 v182, -2, v182
  ds_write_b64 v26, v[182:183]
  ds_read_b128 v[144:147], v18
  ds_read_b128 v[148:151], v18 offset:1024
  ds_read_b128 v[152:155], v19
  ds_read_b128 v[112:115], v20
  ds_read_b64 v[116:117], v21
  v_xor_b32 v18, 16384, v18
  v_xor_b32 v19, 16384, v19
  v_xor_b32 v20, 16384, v20
  v_xor_b32 v21, 16384, v21
  v_mov_b32 v88, 0
  v_mov_b32 v89, 0
  v_mov_b32 v90, 0
  v_mov_b32 v91, 0
  v_mov_b32 v92, 0
  v_mov_b32 v93, 0
  v_mov_b32 v94, 0
  v_mov_b32 v95, 0
  v_mov_b32 v96, 0
  v_mov_b32 v97, 0
  v_mov_b32 v98, 0
  v_mov_b32 v99, 0
  v_mov_b32 v100, 0
  v_mov_b32 v101, 0
  v_mov_b32 v102, 0
  v_mov_b32 v103, 0
  s_mov_b32 s81, 0
  s_waitcnt lgkmcnt(0)
  s_barrier
  s_mov_b64 exec, s[64:65]
  buffer_store_dwordx2 v[28:29], v8, s[8:11], s57 offen
  s_mov_b64 exec, s[62:63]
  buffer_store_dword v28, v17, s[8:11], s59 offen
  s_mov_b64 exec, -1
  s_sleep 6
  s_nop 3
  buffer_load_dwordx4 v[68:71], v16, s[4:7], s60 offen sc1
  s_sleep 3
  s_nop 1
  buffer_load_dwordx4 v[72:75], v16, s[4:7], s60 offen sc1
  s_mov_b32 s54, 0
pp_47:
  s_waitcnt vmcnt(1)
  v_mfma_f32_16x16x32_f16 v[120:123], v[44:47], v[68:71], 0
  v_bitop3_b32 v27, v68, s61, 1 bitop3:0x28
  v_cmp_ne_u32 vcc, 0, v27
  s_nop 1
  s_cbranch_vccnz p2_49
  s_nop 2
pg_48:
  v_add_f32_dpp v120, v120, v120 row_ror:8 row_mask:0xf bank_mask:0xf
  v_add_f32_dpp v121, v121, v121 row_ror:8 row_mask:0xf bank_mask:0xf
  s_mov_b64 exec, s[62:63]
  v_cvt_pk_bf16_f32 v120, v120, v121
  v_min_u32 v120, -2, v120
  buffer_store_dword v120, v17, s[8:11], s55 offen
  s_mov_b64 exec, -1
nt_46:
  s_barrier
  s_mov_b32 s58, s55
  s_add_u32 s52, s52, 1
  s_and_b32 s21, s52, 3
  s_mul_i32 s56, s21, 122880
  s_add_u32 s21, s52, 1
  s_and_b32 s21, s21, 3
  s_mul_i32 s55, s21, 122880
  s_add_u32 s55, s55, s75
  s_add_u32 s21, s52, 2
  s_and_b32 s21, s21, 3
  s_mul_i32 s57, s21, 122880
  s_add_u32 s21, s52, 3
  s_and_b32 s21, s21, 3
  s_mul_i32 s59, s21, 122880
  s_add_u32 s59, s59, s75
  s_bfe_u32 s61, s52, 0x10001
  s_and_b32 s21, s52, 1
  s_lshl_b32 s60, s21, 19
  s_mov_b32 s54, 0
  s_sleep 3
  s_nop 2
  buffer_load_dwordx4 v[48:51], v190, s[8:11], s58 offen offset:0 sc1
  buffer_load_dwordx4 v[52:55], v190, s[8:11], s58 offen offset:1024 sc1
  buffer_load_dwordx4 v[56:59], v190, s[8:11], s58 offen offset:2048 sc1
  s_branch top_35
mr_36:
  s_mov_b64 exec, s[22:23]
  s_cbranch_execz ms_50
  buffer_load_dwordx4 v[48:51], v190, s[8:11], s58 offen offset:0 sc1
ms_50:
  s_mov_b64 exec, s[98:99]
  s_cbranch_execz ms_51
  buffer_load_dwordx4 v[52:55], v190, s[8:11], s58 offen offset:1024 sc1
ms_51:
  s_mov_b64 exec, s[100:101]
  s_cbranch_execz ms_52
  buffer_load_dwordx4 v[56:59], v190, s[8:11], s58 offen offset:2048 sc1
ms_52:
  s_add_u32 s54, s54, 1
  s_cmp_gt_u32 s54, 131072
  s_cbranch_scc1 end0
  s_waitcnt vmcnt(0)
  s_mov_b64 exec, s[22:23]
  ds_write_b128 v190, v[48:51] offset:0
  v_cmp_eq_u32 s[22:23], -1, v48
  s_mov_b64 exec, s[98:99]
  ds_write_b128 v190, v[52:55] offset:1024
  v_cmp_eq_u32 s[98:99], -1, v52
  s_mov_b64 exec, s[100:101]
  ds_write_b128 v190, v[56:59] offset:2048
  v_cmp_eq_u32 s[100:101], -1, v56
  s_mov_b64 exec, -1
  s_or_b64 vcc, s[22:23], s[98:99]
  s_or_b64 vcc, vcc, s[100:101]
  s_cbranch_scc1 mr_36
  s_branch mo_40
mn_37:
  v_max3_u32 v27, v48, v49, v50
  v_max3_u32 v27, v27, v51, v52
  v_max3_u32 v27, v27, v53, v54
  v_max3_u32 v27, v27, v55, v56
  v_max3_u32 v27, v27, v57, v58
  v_max3_u32 v27, v27, v59, v60
  v_max3_u32 v27, v27, v61, v62
  v_max3_u32 v27, v27, v63, v64
  v_max3_u32 v27, v27, v65, v66
  v_max3_u32 v27, v27, v67, v68
  v_max3_u32 v27, v27, v69, v70
  v_max3_u32 v27, v27, v71, v72
  v_max3_u32 v27, v27, v73, v74
  v_max3_u32 v27, v27, v75, v76
  v_max3_u32 v27, v27, v77, v78
  v_max3_u32 v27, v27, v79, v80
  v_max3_u32 v27, v27, v81, v82
  v_max3_u32 v27, v27, v83, v84
  v_max3_u32 v27, v27, v85, v86
  v_max3_u32 v27, v27, v87, v87
  v_cmp_eq_u32 vcc, -1, v27
  s_cmp_eq_u32 s52, 0
  s_cbranch_scc1 mk_38
  s_cbranch_vccz mk_38
  s_waitcnt lgkmcnt(0)
  s_barrier
  s_nop 7
  v_mov_b32 v88, 0
  v_mov_b32 v89, 0
  v_mov_b32 v90, 0
  v_mov_b32 v91, 0
  v_mov_b32 v92, 0
  v_mov_b32 v93, 0
  v_mov_b32 v94, 0
  v_mov_b32 v95, 0
  v_mov_b32 v96, 0
  v_mov_b32 v97, 0
  v_mov_b32 v98, 0
  v_mov_b32 v99, 0
  v_mov_b32 v100, 0
  v_mov_b32 v101, 0
  v_mov_b32 v102, 0
  v_mov_b32 v103, 0
  s_mov_b64 s[22:23], -1
  s_mov_b64 s[98:99], -1
  s_mov_b64 s[100:101], -1
  s_branch mr_36
sr_41:
  s_mov_b32 s54, 0
sr_53:
  s_mov_b64 exec, vcc
  buffer_load_dwordx4 v[124:127], v9, s[8:11], s56 offen sc1
  buffer_load_dwordx4 v[128:131], v9, s[8:11], s56 offen offset:1024 sc1
  buffer_load_dwordx4 v[132:135], v10, s[8:11], s56 offen sc1
  s_mov_b64 exec, -1
  s_add_u32 s54, s54, 1
  s_cmp_gt_u32 s54, 131072
  s_cbranch_scc1 end0
  s_and_b32 s21, s54, 31
  s_cbranch_scc0 sr_54
  s_waitcnt vmcnt(0)
  v_pk_add_f16 v172, v124, v126
  v_pk_add_f16 v173, v125, v127
  v_pk_add_f16 v174, v128, v130
  v_pk_add_f16 v175, v129, v131
  v_fma_mix_f32 v166, v172, 1.0, v174 op_sel:[0,0,0] op_sel_hi:[1,0,1]
  v_fma_mix_f32 v168, v173, 1.0, v175 op_sel:[0,0,0] op_sel_hi:[1,0,1]
  v_pk_add_f16 v176, v132, v133
  v_pk_add_f16 v177, v134, v135
  v_add_f32 v27, v166, v168
  v_fma_mix_f32 v170, v176, 1.0, v177 op_sel:[0,0,0] op_sel_hi:[1,0,1]
  v_fma_mix_f32 v167, v172, 1.0, v174 op_sel:[1,0,1] op_sel_hi:[1,0,1]
  v_cmp_u_f32 vcc, v27, v170
  v_fma_mix_f32 v169, v173, 1.0, v175 op_sel:[1,0,1] op_sel_hi:[1,0,1]
  v_fma_mix_f32 v171, v176, 1.0, v177 op_sel:[1,0,1] op_sel_hi:[1,0,1]
  s_cbranch_vccnz sr_53
  s_branch sj_42
sr_54:
  s_waitcnt vmcnt(0)
  v_pk_add_f16 v172, v124, v126
  v_pk_add_f16 v173, v125, v127
  v_pk_add_f16 v174, v128, v130
  v_pk_add_f16 v175, v129, v131
  v_fma_mix_f32 v166, v172, 1.0, v174 op_sel:[0,0,0] op_sel_hi:[1,0,1]
  v_fma_mix_f32 v168, v173, 1.0, v175 op_sel:[0,0,0] op_sel_hi:[1,0,1]
  v_pk_add_f16 v176, v132, v133
  v_pk_add_f16 v177, v134, v135
  v_add_f32 v27, v166, v168
  v_fma_mix_f32 v170, v176, 1.0, v177 op_sel:[0,0,0] op_sel_hi:[1,0,1]
  v_fma_mix_f32 v167, v172, 1.0, v174 op_sel:[1,0,1] op_sel_hi:[1,0,1]
  v_cmp_u_f32 vcc, v27, v170
  v_fma_mix_f32 v169, v173, 1.0, v175 op_sel:[1,0,1] op_sel_hi:[1,0,1]
  v_fma_mix_f32 v171, v176, 1.0, v177 op_sel:[1,0,1] op_sel_hi:[1,0,1]
  v_max3_u32 v27, v124, v126, v128
  v_max3_u32 v27, v27, v130, v132
  v_max3_u32 v27, v27, v133, v134
  v_max3_u32 v27, v27, v135, v135
  v_cmp_eq_u32 vcc, -1, v27
  s_nop 1
  s_cbranch_vccnz sr_53
  s_branch sj_42
fx_44:
  s_cmp_eq_u32 s81, 1
  s_cbranch_scc1 fk_45
  s_mov_b32 s81, 1
  v_max3_f32 v164, v166, v167, v168
  v_max3_f32 v165, v169, v170, v171
  v_max_f32 v164, v164, v165
  s_nop 1
  v_max_f32_dpp v164, v164, v164 row_ror:8 row_mask:0xf bank_mask:0xf
  v_mov_b32 v165, v164
  s_nop 1
  v_permlane32_swap_b32 v164, v165
  v_max_f32 v164, v164, v165
  v_mov_b32 v165, v164
  s_nop 1
  v_permlane16_swap_b32 v164, v165
  v_max_f32 v164, v164, v165
  v_sub_f32 v166, v166, v164
  v_sub_f32 v167, v167, v164
  v_sub_f32 v168, v168, v164
  v_sub_f32 v169, v169, v164
  v_sub_f32 v170, v170, v164
  v_sub_f32 v171, v171, v164
  s_branch ex_43
p2_49:
  buffer_load_dwordx4 v[68:71], v16, s[4:7], s60 offen sc1
  s_waitcnt vmcnt(1)
  v_mfma_f32_16x16x32_f16 v[120:123], v[44:47], v[72:75], 0
  v_bitop3_b32 v27, v72, s61, 1 bitop3:0x28
  v_cmp_ne_u32 vcc, 0, v27
  s_nop 1
  s_cbranch_vccz pg_48
  buffer_load_dwordx4 v[72:75], v16, s[4:7], s60 offen sc1
  s_add_u32 s54, s54, 1
  s_cmp_gt_u32 s54, 131072
  s_cbranch_scc1 end0
  s_branch pp_47
last_39:
  v_smfmac_f32_16x16x64_bf16 v[96:99], v[48:51], a[0:7], v22
  v_smfmac_f32_16x16x64_bf16 v[100:103], v[48:51], a[80:87], v22
  v_smfmac_f32_16x16x64_bf16 v[96:99], v[52:55], a[8:15], v22
  v_smfmac_f32_16x16x64_bf16 v[100:103], v[52:55], a[88:95], v22
  v_smfmac_f32_16x16x64_bf16 v[96:99], v[56:59], a[16:23], v22
  v_smfmac_f32_16x16x64_bf16 v[100:103], v[56:59], a[96:103], v22
  v_smfmac_f32_16x16x64_bf16 v[96:99], v[60:63], a[24:31], v22
  v_smfmac_f32_16x16x64_bf16 v[96:99], v[64:67], a[32:39], v22
  v_smfmac_f32_16x16x64_bf16 v[96:99], v[68:71], a[40:47], v22
  v_smfmac_f32_16x16x64_bf16 v[96:99], v[72:75], a[48:55], v22
  v_smfmac_f32_16x16x64_bf16 v[96:99], v[76:79], a[56:63], v22
  v_smfmac_f32_16x16x64_bf16 v[96:99], v[80:83], a[64:71], v22
  v_smfmac_f32_16x16x64_bf16 v[96:99], v[84:87], a[72:79], v22
  v_smfmac_f32_16x16x64_bf16 v[100:103], v[60:63], a[104:111], v22
  v_smfmac_f32_16x16x64_bf16 v[100:103], v[64:67], a[112:119], v22
  v_smfmac_f32_16x16x64_bf16 v[100:103], v[68:71], a[120:127], v22
  v_smfmac_f32_16x16x64_bf16 v[100:103], v[72:75], a[128:135], v22
  v_smfmac_f32_16x16x64_bf16 v[100:103], v[76:79], a[136:143], v22
  v_smfmac_f32_16x16x64_bf16 v[100:103], v[80:83], a[144:151], v22
  v_smfmac_f32_16x16x64_bf16 v[100:103], v[84:87], a[152:159], v22
  s_nop 7
  v_permlane32_swap_b32 v96, v100
  v_permlane32_swap_b32 v97, v101
  v_permlane32_swap_b32 v98, v102
  v_permlane32_swap_b32 v99, v103
  v_pk_add_f32 v[96:97], v[96:97], v[100:101]
  v_pk_add_f32 v[98:99], v[98:99], v[102:103]
  v_cvt_pk_bf16_f32 v182, v96, v97
  v_cvt_pk_bf16_f32 v183, v98, v99
  v_min_u32 v182, -2, v182
  ds_write_b64 v26, v[182:183]
  s_waitcnt lgkmcnt(0)
  s_barrier
  v_mov_b32 v246, 80
  v_mov_b32 v247, 1
  s_mov_b64 exec, 1
  buffer_atomic_add v247, v246, s[32:35], 0 offen sc0 sc1
  s_mov_b64 exec, -1
  s_branch chain_done
E_30:
  v_add_u32 v190, 3072, v4
  ds_read_b128 v[60:63], v4 offset:3072
  ds_read_b128 v[64:67], v4 offset:4096
  ds_read_b128 v[68:71], v4 offset:5120
  s_waitcnt lgkmcnt(0)
  s_branch mo_60
  .p2align 3
top_55:
  s_waitcnt vmcnt(2)
  ds_write_b128 v190, v[60:63] offset:0
  v_cmp_eq_u32 s[22:23], -1, v60
  s_waitcnt vmcnt(1)
  ds_write_b128 v190, v[64:67] offset:1024
  v_cmp_eq_u32 s[98:99], -1, v64
  s_waitcnt vmcnt(0)
  ds_write_b128 v190, v[68:71] offset:2048
  v_cmp_eq_u32 s[100:101], -1, v68
  s_or_b64 vcc, s[22:23], s[98:99]
  s_or_b64 vcc, vcc, s[100:101]
  s_cbranch_scc1 mr_56
mo_60:
  s_waitcnt lgkmcnt(0)
  s_barrier
  ds_read_b128 v[48:51], v4 offset:0
  ds_read_b128 v[52:55], v4 offset:1024
  v_smfmac_f32_16x16x64_bf16 v[92:95], v[60:63], v[200:207], v22
  ds_read_b128 v[56:59], v4 offset:2048
  v_smfmac_f32_16x16x64_bf16 v[88:91], v[60:63], a[184:191], v22
  ds_read_b128 v[72:75], v4 offset:6144
  v_smfmac_f32_16x16x64_bf16 v[92:95], v[64:67], v[208:215], v22
  ds_read_b128 v[76:79], v4 offset:7168
  v_smfmac_f32_16x16x64_bf16 v[88:91], v[64:67], a[192:199], v22
  ds_read_b128 v[80:83], v4 offset:8192
  v_smfmac_f32_16x16x64_bf16 v[92:95], v[68:71], v[216:223], v22
  ds_read_b128 v[84:87], v4 offset:9216
  v_smfmac_f32_16x16x64_bf16 v[88:91], v[68:71], a[200:207], v22
  s_waitcnt lgkmcnt(6)
  v_smfmac_f32_16x16x64_bf16 v[92:95], v[48:51], a[240:247], v22
  v_smfmac_f32_16x16x64_bf16 v[88:91], v[48:51], a[160:167], v22
  s_waitcnt lgkmcnt(5)
  v_smfmac_f32_16x16x64_bf16 v[92:95], v[52:55], a[248:255], v22
  s_waitcnt lgkmcnt(4)
  v_smfmac_f32_16x16x64_bf16 v[92:95], v[56:59], v[192:199], v22
  s_waitcnt lgkmcnt(3)
  v_smfmac_f32_16x16x64_bf16 v[92:95], v[72:75], v[224:231], v22
  s_waitcnt lgkmcnt(2)
  v_smfmac_f32_16x16x64_bf16 v[92:95], v[76:79], v[232:239], v22
  s_waitcnt lgkmcnt(1)
  v_smfmac_f32_16x16x64_bf16 v[92:95], v[80:83], v[240:247], v22
  s_waitcnt lgkmcnt(0)
  v_smfmac_f32_16x16x64_bf16 v[92:95], v[84:87], v[248:255], v22
  v_smfmac_f32_16x16x64_bf16 v[88:91], v[52:55], a[168:175], v22
  v_smfmac_f32_16x16x64_bf16 v[88:91], v[56:59], a[176:183], v22
  v_smfmac_f32_16x16x64_bf16 v[88:91], v[72:75], a[208:215], v22
  v_permlane32_swap_b32 v92, v93
  v_smfmac_f32_16x16x64_bf16 v[88:91], v[76:79], a[216:223], v22
  v_permlane32_swap_b32 v94, v95
  v_smfmac_f32_16x16x64_bf16 v[88:91], v[80:83], a[224:231], v22
  v_permlane32_swap_b32 v93, v92
  v_smfmac_f32_16x16x64_bf16 v[88:91], v[84:87], a[232:239], v22
  v_permlane32_swap_b32 v95, v94
  v_pk_mul_f32 v[120:121], v[92:93], v[24:25] op_sel:[1,0] op_sel_hi:[0,1]
  v_pk_mul_f32 v[122:123], v[94:95], v[24:25] op_sel:[1,0] op_sel_hi:[0,1]
  s_nop 4
  v_pk_fma_f32 v[88:89], v[88:89], v[24:25], v[120:121]
  v_pk_fma_f32 v[90:91], v[90:91], v[24:25], v[122:123]
  v_cvt_pk_bf16_f32 v120, v88, v89
  v_cvt_pk_bf16_f32 v121, v90, v91
  ds_write_b64 v6, v[120:121]
  v_cmp_u_f32 vcc, v88, v89
  v_cmp_u_f32 s[22:23], v90, v91
  s_nop 1
  s_or_b64 vcc, vcc, s[22:23]
  s_cbranch_vccnz mn_57
mk_58:
  s_waitcnt lgkmcnt(0)
  s_barrier
  ds_read_b64_tr_b16 v[104:105], v7 offset:0
  ds_read_b64_tr_b16 v[106:107], v7 offset:768
  ds_read_b64_tr_b16 v[108:109], v7 offset:1536
  ds_read_b64 v[140:141], v11
  s_cmp_eq_u32 s52, 63
  s_cbranch_scc1 last_59
  s_waitcnt lgkmcnt(2)
  v_mfma_f32_16x16x32_bf16 v[120:123], v[112:115], v[104:107], 0
  s_waitcnt lgkmcnt(1)
  v_mfma_f32_16x16x32_bf16 v[120:123], v[116:119], v[108:111], v[120:123]
  s_mov_b64 exec, s[64:65]
  s_nop 6
  v_cvt_pk_f16_f32 v120, v120, v121
  v_cvt_pk_f16_f32 v121, v122, v123
  buffer_store_dwordx2 v[120:121], v8, s[8:11], s56 offen
  s_mov_b64 exec, -1
  s_sleep 3
  s_nop 1
  v_smfmac_f32_16x16x64_bf16 v[96:99], v[48:51], a[0:7], v22
  v_smfmac_f32_16x16x64_bf16 v[100:103], v[48:51], a[80:87], v22
  v_smfmac_f32_16x16x64_bf16 v[96:99], v[52:55], a[8:15], v22
  v_smfmac_f32_16x16x64_bf16 v[100:103], v[52:55], a[88:95], v22
  v_smfmac_f32_16x16x64_bf16 v[96:99], v[56:59], a[16:23], v22
  v_smfmac_f32_16x16x64_bf16 v[100:103], v[56:59], a[96:103], v22
  v_smfmac_f32_16x16x64_bf16 v[96:99], v[60:63], a[24:31], v22
  v_smfmac_f32_16x16x64_bf16 v[96:99], v[64:67], a[32:39], v22
  v_smfmac_f32_16x16x64_bf16 v[96:99], v[68:71], a[40:47], v22
  v_smfmac_f32_16x16x64_bf16 v[96:99], v[72:75], a[48:55], v22
  v_smfmac_f32_16x16x64_bf16 v[96:99], v[76:79], a[56:63], v22
  buffer_load_dwordx4 v[124:127], v9, s[8:11], s56 offen sc1
  v_smfmac_f32_16x16x64_bf16 v[96:99], v[80:83], a[64:71], v22
  buffer_load_dwordx4 v[128:131], v9, s[8:11], s56 offen offset:1024 sc1
  v_smfmac_f32_16x16x64_bf16 v[96:99], v[84:87], a[72:79], v22
  buffer_load_dwordx4 v[132:135], v10, s[8:11], s56 offen sc1
  v_smfmac_f32_16x16x64_bf16 v[100:103], v[60:63], a[104:111], v22
  v_smfmac_f32_16x16x64_bf16 v[100:103], v[64:67], a[112:119], v22
  v_smfmac_f32_16x16x64_bf16 v[100:103], v[68:71], a[120:127], v22
  v_smfmac_f32_16x16x64_bf16 v[100:103], v[72:75], a[128:135], v22
  v_cvt_pk_bf16_f32 v136, v96, v97
  v_smfmac_f32_16x16x64_bf16 v[100:103], v[76:79], a[136:143], v22
  v_cvt_pk_bf16_f32 v137, v98, v99
  v_smfmac_f32_16x16x64_bf16 v[100:103], v[80:83], a[144:151], v22
  v_smfmac_f32_16x16x64_bf16 v[100:103], v[84:87], a[152:159], v22
  s_waitcnt vmcnt(2)
  v_pk_add_f16 v172, v124, v126
  v_pk_add_f16 v173, v125, v127
  s_waitcnt vmcnt(1)
  v_pk_add_f16 v174, v128, v130
  v_pk_add_f16 v175, v129, v131
  v_fma_mix_f32 v166, v172, 1.0, v174 op_sel:[0,0,0] op_sel_hi:[1,0,1]
  v_fma_mix_f32 v168, v173, 1.0, v175 op_sel:[0,0,0] op_sel_hi:[1,0,1]
  s_waitcnt vmcnt(0)
  v_pk_add_f16 v176, v132, v133
  v_pk_add_f16 v177, v134, v135
  v_fma_mix_f32 v170, v176, 1.0, v177 op_sel:[0,0,0] op_sel_hi:[1,0,1]
  v_fma_mix_f32 v167, v172, 1.0, v174 op_sel:[1,0,1] op_sel_hi:[1,0,1]
  v_cmp_u_f32 vcc, v166, v170
  v_fma_mix_f32 v169, v173, 1.0, v175 op_sel:[1,0,1] op_sel_hi:[1,0,1]
  v_fma_mix_f32 v171, v176, 1.0, v177 op_sel:[1,0,1] op_sel_hi:[1,0,1]
  v_cvt_pk_bf16_f32 v138, v100, v101
  s_cbranch_vccnz sr_61
sj_62:
ex_63:
  v_exp_f32 v172, v166
  v_exp_f32 v173, v167
  v_exp_f32 v174, v168
  v_cvt_pk_bf16_f32 v156, v172, v173
  v_exp_f32 v175, v169
  v_exp_f32 v176, v170
  v_cvt_pk_bf16_f32 v157, v174, v175
  v_mov_b32_dpp v158, v156 row_ror:8 row_mask:0xf bank_mask:0xf
  v_exp_f32 v177, v171
  v_mov_b32_dpp v159, v157 row_ror:8 row_mask:0xf bank_mask:0xf
  v_cvt_pk_bf16_f32 v160, v176, v177
  v_cvt_pk_bf16_f32 v139, v102, v103
  v_mfma_f32_16x16x32_bf16 v[178:181], v[152:155], v[156:159], 0
  s_waitcnt lgkmcnt(0)
  v_mov_b32_dpp v161, v160 row_ror:8 row_mask:0xf bank_mask:0xf
  v_mfma_f32_16x16x32_bf16 v[182:185], v[144:147], v[156:159], 0
  s_nop 0
  v_mfma_f32_16x16x32_bf16 v[178:181], v[140:143], v[160:163], v[178:181]
  v_mfma_f32_16x16x32_bf16 v[182:185], v[136:139], v[160:163], v[182:185]
  v_mfma_f32_16x16x32_bf16 v[186:189], v[148:151], v[156:159], 0
  v_mfma_f32_16x16x32_bf16 v[186:189], v[138:141], v[160:163], v[186:189]
  s_mov_b64 exec, s[62:63]
  v_rcp_f32 v164, v180
  s_nop 0
  v_pk_mul_f32 v[178:179], v[178:179], v[164:165] op_sel_hi:[1,0]
  v_pk_mul_f32 v[182:183], v[182:183], v[164:165] op_sel_hi:[1,0]
  v_pk_mul_f32 v[184:185], v[184:185], v[164:165] op_sel_hi:[1,0]
  v_cvt_pk_f16_f32 v64, v178, v179
  v_cvt_pk_f16_f32 v60, v182, v183
  v_pk_mul_f32 v[186:187], v[186:187], v[164:165] op_sel_hi:[1,0]
  v_pk_mul_f32 v[188:189], v[188:189], v[164:165] op_sel_hi:[1,0]
  v_cvt_pk_f16_f32 v61, v184, v185
  v_cvt_pk_f16_f32 v62, v186, v187
  v_cvt_pk_f16_f32 v63, v188, v189
  ds_write_b128 v13, v[60:63]
  ds_write_b32 v14, v64
  v_add_f32 v165, v164, v180
  v_cmp_ngt_f32 vcc, s80, v165
  s_mov_b64 exec, -1
  s_nop 0
  s_cbranch_vccnz fx_64
fk_65:
  s_waitcnt lgkmcnt(0)
  s_barrier
  s_add_u32 m0, s74, 9216
  s_add_u32 s21, s72, 83968
  buffer_load_dwordx4 v32, s[28:31], s21 offen sc1 lds
  s_add_u32 m0, s74, 2048
  s_add_u32 s21, s79, 40960
  buffer_load_dwordx4 v4, s[28:31], s21 offen sc1 lds
  s_add_u32 m0, s74, 5120
  s_add_u32 s21, s79, 82944
  buffer_load_dwordx4 v4, s[28:31], s21 offen sc1 lds
  s_add_u32 s72, s72, 1310720
  s_add_u32 s79, s79, 1310720
  s_add_u32 s73, s73, 393216
  s_xor_b32 s74, s74, 16384
  s_nop 15
  s_nop 3
  v_permlane32_swap_b32 v96, v100
  v_permlane32_swap_b32 v97, v101
  v_permlane32_swap_b32 v98, v102
  v_permlane32_swap_b32 v99, v103
  v_pk_add_f32 v[96:97], v[96:97], v[100:101]
  v_pk_add_f32 v[98:99], v[98:99], v[102:103]
  v_cvt_pk_bf16_f32 v182, v96, v97
  v_cvt_pk_bf16_f32 v183, v98, v99
  v_min_u32 v182, -2, v182
  ds_write_b64 v26, v[182:183]
  ds_read_b128 v[144:147], v18
  ds_read_b128 v[148:151], v18 offset:1024
  ds_read_b128 v[152:155], v19
  ds_read_b128 v[112:115], v20
  ds_read_b64 v[116:117], v21
  v_xor_b32 v18, 16384, v18
  v_xor_b32 v19, 16384, v19
  v_xor_b32 v20, 16384, v20
  v_xor_b32 v21, 16384, v21
  v_mov_b32 v88, 0
  v_mov_b32 v89, 0
  v_mov_b32 v90, 0
  v_mov_b32 v91, 0
  v_mov_b32 v92, 0
  v_mov_b32 v93, 0
  v_mov_b32 v94, 0
  v_mov_b32 v95, 0
  v_mov_b32 v96, 0
  v_mov_b32 v97, 0
  v_mov_b32 v98, 0
  v_mov_b32 v99, 0
  v_mov_b32 v100, 0
  v_mov_b32 v101, 0
  v_mov_b32 v102, 0
  v_mov_b32 v103, 0
  s_mov_b32 s81, 0
  s_waitcnt lgkmcnt(0)
  s_barrier
  s_mov_b64 exec, s[64:65]
  buffer_store_dwordx2 v[28:29], v8, s[8:11], s57 offen
  s_mov_b64 exec, s[62:63]
  buffer_store_dword v28, v17, s[8:11], s59 offen
  s_mov_b64 exec, -1
  s_sleep 6
  s_nop 3
  buffer_load_dwordx4 v[68:71], v16, s[4:7], s60 offen sc1
  s_sleep 3
  s_nop 1
  buffer_load_dwordx4 v[72:75], v16, s[4:7], s60 offen sc1
  s_mov_b32 s54, 0
pp_67:
  s_waitcnt vmcnt(1)
  v_mfma_f32_16x16x32_f16 v[120:123], v[44:47], v[68:71], 0
  v_bitop3_b32 v27, v68, s61, 1 bitop3:0x28
  v_cmp_ne_u32 vcc, 0, v27
  s_nop 1
  s_cbranch_vccnz p2_69
  s_nop 2
pg_68:
  v_add_f32_dpp v120, v120, v120 row_ror:8 row_mask:0xf bank_mask:0xf
  v_add_f32_dpp v121, v121, v121 row_ror:8 row_mask:0xf bank_mask:0xf
  s_mov_b64 exec, s[62:63]
  v_cvt_pk_bf16_f32 v120, v120, v121
  v_min_u32 v120, -2, v120
  buffer_store_dword v120, v17, s[8:11], s55 offen
  s_mov_b64 exec, -1
nt_66:
  s_barrier
  s_mov_b32 s58, s55
  s_add_u32 s52, s52, 1
  s_and_b32 s21, s52, 3
  s_mul_i32 s56, s21, 122880
  s_add_u32 s21, s52, 1
  s_and_b32 s21, s21, 3
  s_mul_i32 s55, s21, 122880
  s_add_u32 s55, s55, s75
  s_add_u32 s21, s52, 2
  s_and_b32 s21, s21, 3
  s_mul_i32 s57, s21, 122880
  s_add_u32 s21, s52, 3
  s_and_b32 s21, s21, 3
  s_mul_i32 s59, s21, 122880
  s_add_u32 s59, s59, s75
  s_bfe_u32 s61, s52, 0x10001
  s_and_b32 s21, s52, 1
  s_lshl_b32 s60, s21, 19
  s_mov_b32 s54, 0
  s_sleep 3
  s_nop 2
  buffer_load_dwordx4 v[60:63], v190, s[8:11], s58 offen offset:0 sc1
  buffer_load_dwordx4 v[64:67], v190, s[8:11], s58 offen offset:1024 sc1
  buffer_load_dwordx4 v[68:71], v190, s[8:11], s58 offen offset:2048 sc1
  s_branch top_55
mr_56:
  s_mov_b64 exec, s[22:23]
  s_cbranch_execz ms_70
  buffer_load_dwordx4 v[60:63], v190, s[8:11], s58 offen offset:0 sc1
ms_70:
  s_mov_b64 exec, s[98:99]
  s_cbranch_execz ms_71
  buffer_load_dwordx4 v[64:67], v190, s[8:11], s58 offen offset:1024 sc1
ms_71:
  s_mov_b64 exec, s[100:101]
  s_cbranch_execz ms_72
  buffer_load_dwordx4 v[68:71], v190, s[8:11], s58 offen offset:2048 sc1
ms_72:
  s_add_u32 s54, s54, 1
  s_cmp_gt_u32 s54, 131072
  s_cbranch_scc1 end0
  s_waitcnt vmcnt(0)
  s_mov_b64 exec, s[22:23]
  ds_write_b128 v190, v[60:63] offset:0
  v_cmp_eq_u32 s[22:23], -1, v60
  s_mov_b64 exec, s[98:99]
  ds_write_b128 v190, v[64:67] offset:1024
  v_cmp_eq_u32 s[98:99], -1, v64
  s_mov_b64 exec, s[100:101]
  ds_write_b128 v190, v[68:71] offset:2048
  v_cmp_eq_u32 s[100:101], -1, v68
  s_mov_b64 exec, -1
  s_or_b64 vcc, s[22:23], s[98:99]
  s_or_b64 vcc, vcc, s[100:101]
  s_cbranch_scc1 mr_56
  s_branch mo_60
mn_57:
  v_max3_u32 v27, v48, v49, v50
  v_max3_u32 v27, v27, v51, v52
  v_max3_u32 v27, v27, v53, v54
  v_max3_u32 v27, v27, v55, v56
  v_max3_u32 v27, v27, v57, v58
  v_max3_u32 v27, v27, v59, v60
  v_max3_u32 v27, v27, v61, v62
  v_max3_u32 v27, v27, v63, v64
  v_max3_u32 v27, v27, v65, v66
  v_max3_u32 v27, v27, v67, v68
  v_max3_u32 v27, v27, v69, v70
  v_max3_u32 v27, v27, v71, v72
  v_max3_u32 v27, v27, v73, v74
  v_max3_u32 v27, v27, v75, v76
  v_max3_u32 v27, v27, v77, v78
  v_max3_u32 v27, v27, v79, v80
  v_max3_u32 v27, v27, v81, v82
  v_max3_u32 v27, v27, v83, v84
  v_max3_u32 v27, v27, v85, v86
  v_max3_u32 v27, v27, v87, v87
  v_cmp_eq_u32 vcc, -1, v27
  s_cmp_eq_u32 s52, 0
  s_cbranch_scc1 mk_58
  s_cbranch_vccz mk_58
  s_waitcnt lgkmcnt(0)
  s_barrier
  s_nop 7
  v_mov_b32 v88, 0
  v_mov_b32 v89, 0
  v_mov_b32 v90, 0
  v_mov_b32 v91, 0
  v_mov_b32 v92, 0
  v_mov_b32 v93, 0
  v_mov_b32 v94, 0
  v_mov_b32 v95, 0
  v_mov_b32 v96, 0
  v_mov_b32 v97, 0
  v_mov_b32 v98, 0
  v_mov_b32 v99, 0
  v_mov_b32 v100, 0
  v_mov_b32 v101, 0
  v_mov_b32 v102, 0
  v_mov_b32 v103, 0
  s_mov_b64 s[22:23], -1
  s_mov_b64 s[98:99], -1
  s_mov_b64 s[100:101], -1
  s_branch mr_56
sr_61:
  s_mov_b32 s54, 0
sr_73:
  s_mov_b64 exec, vcc
  buffer_load_dwordx4 v[124:127], v9, s[8:11], s56 offen sc1
  buffer_load_dwordx4 v[128:131], v9, s[8:11], s56 offen offset:1024 sc1
  buffer_load_dwordx4 v[132:135], v10, s[8:11], s56 offen sc1
  s_mov_b64 exec, -1
  s_add_u32 s54, s54, 1
  s_cmp_gt_u32 s54, 131072
  s_cbranch_scc1 end0
  s_and_b32 s21, s54, 31
  s_cbranch_scc0 sr_74
  s_waitcnt vmcnt(0)
  v_pk_add_f16 v172, v124, v126
  v_pk_add_f16 v173, v125, v127
  v_pk_add_f16 v174, v128, v130
  v_pk_add_f16 v175, v129, v131
  v_fma_mix_f32 v166, v172, 1.0, v174 op_sel:[0,0,0] op_sel_hi:[1,0,1]
  v_fma_mix_f32 v168, v173, 1.0, v175 op_sel:[0,0,0] op_sel_hi:[1,0,1]
  v_pk_add_f16 v176, v132, v133
  v_pk_add_f16 v177, v134, v135
  v_add_f32 v27, v166, v168
  v_fma_mix_f32 v170, v176, 1.0, v177 op_sel:[0,0,0] op_sel_hi:[1,0,1]
  v_fma_mix_f32 v167, v172, 1.0, v174 op_sel:[1,0,1] op_sel_hi:[1,0,1]
  v_cmp_u_f32 vcc, v27, v170
  v_fma_mix_f32 v169, v173, 1.0, v175 op_sel:[1,0,1] op_sel_hi:[1,0,1]
  v_fma_mix_f32 v171, v176, 1.0, v177 op_sel:[1,0,1] op_sel_hi:[1,0,1]
  s_cbranch_vccnz sr_73
  s_branch sj_62
sr_74:
  s_waitcnt vmcnt(0)
  v_pk_add_f16 v172, v124, v126
  v_pk_add_f16 v173, v125, v127
  v_pk_add_f16 v174, v128, v130
  v_pk_add_f16 v175, v129, v131
  v_fma_mix_f32 v166, v172, 1.0, v174 op_sel:[0,0,0] op_sel_hi:[1,0,1]
  v_fma_mix_f32 v168, v173, 1.0, v175 op_sel:[0,0,0] op_sel_hi:[1,0,1]
  v_pk_add_f16 v176, v132, v133
  v_pk_add_f16 v177, v134, v135
  v_add_f32 v27, v166, v168
  v_fma_mix_f32 v170, v176, 1.0, v177 op_sel:[0,0,0] op_sel_hi:[1,0,1]
  v_fma_mix_f32 v167, v172, 1.0, v174 op_sel:[1,0,1] op_sel_hi:[1,0,1]
  v_cmp_u_f32 vcc, v27, v170
  v_fma_mix_f32 v169, v173, 1.0, v175 op_sel:[1,0,1] op_sel_hi:[1,0,1]
  v_fma_mix_f32 v171, v176, 1.0, v177 op_sel:[1,0,1] op_sel_hi:[1,0,1]
  v_max3_u32 v27, v124, v126, v128
  v_max3_u32 v27, v27, v130, v132
  v_max3_u32 v27, v27, v133, v134
  v_max3_u32 v27, v27, v135, v135
  v_cmp_eq_u32 vcc, -1, v27
  s_nop 1
  s_cbranch_vccnz sr_73
  s_branch sj_62
fx_64:
  s_cmp_eq_u32 s81, 1
  s_cbranch_scc1 fk_65
  s_mov_b32 s81, 1
  v_max3_f32 v164, v166, v167, v168
  v_max3_f32 v165, v169, v170, v171
  v_max_f32 v164, v164, v165
  s_nop 1
  v_max_f32_dpp v164, v164, v164 row_ror:8 row_mask:0xf bank_mask:0xf
  v_mov_b32 v165, v164
  s_nop 1
  v_permlane32_swap_b32 v164, v165
  v_max_f32 v164, v164, v165
  v_mov_b32 v165, v164
  s_nop 1
  v_permlane16_swap_b32 v164, v165
  v_max_f32 v164, v164, v165
  v_sub_f32 v166, v166, v164
  v_sub_f32 v167, v167, v164
  v_sub_f32 v168, v168, v164
  v_sub_f32 v169, v169, v164
  v_sub_f32 v170, v170, v164
  v_sub_f32 v171, v171, v164
  s_branch ex_63
p2_69:
  buffer_load_dwordx4 v[68:71], v16, s[4:7], s60 offen sc1
  s_waitcnt vmcnt(1)
  v_mfma_f32_16x16x32_f16 v[120:123], v[44:47], v[72:75], 0
  v_bitop3_b32 v27, v72, s61, 1 bitop3:0x28
  v_cmp_ne_u32 vcc, 0, v27
  s_nop 1
  s_cbranch_vccz pg_68
  buffer_load_dwordx4 v[72:75], v16, s[4:7], s60 offen sc1
  s_add_u32 s54, s54, 1
  s_cmp_gt_u32 s54, 131072
  s_cbranch_scc1 end0
  s_branch pp_67
last_59:
  v_smfmac_f32_16x16x64_bf16 v[96:99], v[48:51], a[0:7], v22
  v_smfmac_f32_16x16x64_bf16 v[100:103], v[48:51], a[80:87], v22
  v_smfmac_f32_16x16x64_bf16 v[96:99], v[52:55], a[8:15], v22
  v_smfmac_f32_16x16x64_bf16 v[100:103], v[52:55], a[88:95], v22
  v_smfmac_f32_16x16x64_bf16 v[96:99], v[56:59], a[16:23], v22
  v_smfmac_f32_16x16x64_bf16 v[100:103], v[56:59], a[96:103], v22
  v_smfmac_f32_16x16x64_bf16 v[96:99], v[60:63], a[24:31], v22
  v_smfmac_f32_16x16x64_bf16 v[96:99], v[64:67], a[32:39], v22
  v_smfmac_f32_16x16x64_bf16 v[96:99], v[68:71], a[40:47], v22
  v_smfmac_f32_16x16x64_bf16 v[96:99], v[72:75], a[48:55], v22
  v_smfmac_f32_16x16x64_bf16 v[96:99], v[76:79], a[56:63], v22
  v_smfmac_f32_16x16x64_bf16 v[96:99], v[80:83], a[64:71], v22
  v_smfmac_f32_16x16x64_bf16 v[96:99], v[84:87], a[72:79], v22
  v_smfmac_f32_16x16x64_bf16 v[100:103], v[60:63], a[104:111], v22
  v_smfmac_f32_16x16x64_bf16 v[100:103], v[64:67], a[112:119], v22
  v_smfmac_f32_16x16x64_bf16 v[100:103], v[68:71], a[120:127], v22
  v_smfmac_f32_16x16x64_bf16 v[100:103], v[72:75], a[128:135], v22
  v_smfmac_f32_16x16x64_bf16 v[100:103], v[76:79], a[136:143], v22
  v_smfmac_f32_16x16x64_bf16 v[100:103], v[80:83], a[144:151], v22
  v_smfmac_f32_16x16x64_bf16 v[100:103], v[84:87], a[152:159], v22
  s_nop 7
  v_permlane32_swap_b32 v96, v100
  v_permlane32_swap_b32 v97, v101
  v_permlane32_swap_b32 v98, v102
  v_permlane32_swap_b32 v99, v103
  v_pk_add_f32 v[96:97], v[96:97], v[100:101]
  v_pk_add_f32 v[98:99], v[98:99], v[102:103]
  v_cvt_pk_bf16_f32 v182, v96, v97
  v_cvt_pk_bf16_f32 v183, v98, v99
  v_min_u32 v182, -2, v182
  ds_write_b64 v26, v[182:183]
  s_waitcnt lgkmcnt(0)
  s_barrier
  s_branch chain_done
E_32:
  v_add_u32 v190, 6144, v4
  ds_read_b128 v[72:75], v4 offset:6144
  ds_read_b128 v[76:79], v4 offset:7168
  ds_read_b128 v[80:83], v4 offset:8192
  s_waitcnt lgkmcnt(0)
  s_branch mo_80
  .p2align 3
top_75:
  s_waitcnt vmcnt(2)
  ds_write_b128 v190, v[72:75] offset:0
  v_cmp_eq_u32 s[22:23], -1, v72
  s_waitcnt vmcnt(1)
  ds_write_b128 v190, v[76:79] offset:1024
  v_cmp_eq_u32 s[98:99], -1, v76
  s_waitcnt vmcnt(0)
  ds_write_b128 v190, v[80:83] offset:2048
  v_cmp_eq_u32 s[100:101], -1, v80
  s_or_b64 vcc, s[22:23], s[98:99]
  s_or_b64 vcc, vcc, s[100:101]
  s_cbranch_scc1 mr_76
mo_80:
  s_waitcnt lgkmcnt(0)
  s_barrier
  ds_read_b128 v[48:51], v4 offset:0
  ds_read_b128 v[52:55], v4 offset:1024
  v_smfmac_f32_16x16x64_bf16 v[92:95], v[72:75], v[224:231], v22
  ds_read_b128 v[56:59], v4 offset:2048
  v_smfmac_f32_16x16x64_bf16 v[88:91], v[72:75], a[208:215], v22
  ds_read_b128 v[60:63], v4 offset:3072
  v_smfmac_f32_16x16x64_bf16 v[92:95], v[76:79], v[232:239], v22
  ds_read_b128 v[64:67], v4 offset:4096
  v_smfmac_f32_16x16x64_bf16 v[88:91], v[76:79], a[216:223], v22
  ds_read_b128 v[68:71], v4 offset:5120
  v_smfmac_f32_16x16x64_bf16 v[92:95], v[80:83], v[240:247], v22
  ds_read_b128 v[84:87], v4 offset:9216
  v_smfmac_f32_16x16x64_bf16 v[88:91], v[80:83], a[224:231], v22
  s_waitcnt lgkmcnt(6)
  v_smfmac_f32_16x16x64_bf16 v[92:95], v[48:51], a[240:247], v22
  v_smfmac_f32_16x16x64_bf16 v[88:91], v[48:51], a[160:167], v22
  s_waitcnt lgkmcnt(5)
  v_smfmac_f32_16x16x64_bf16 v[92:95], v[52:55], a[248:255], v22
  s_waitcnt lgkmcnt(4)
  v_smfmac_f32_16x16x64_bf16 v[92:95], v[56:59], v[192:199], v22
  s_waitcnt lgkmcnt(3)
  v_smfmac_f32_16x16x64_bf16 v[92:95], v[60:63], v[200:207], v22
  s_waitcnt lgkmcnt(2)
  v_smfmac_f32_16x16x64_bf16 v[92:95], v[64:67], v[208:215], v22
  s_waitcnt lgkmcnt(1)
  v_smfmac_f32_16x16x64_bf16 v[92:95], v[68:71], v[216:223], v22
  s_waitcnt lgkmcnt(0)
  v_smfmac_f32_16x16x64_bf16 v[92:95], v[84:87], v[248:255], v22
  v_smfmac_f32_16x16x64_bf16 v[88:91], v[52:55], a[168:175], v22
  v_smfmac_f32_16x16x64_bf16 v[88:91], v[56:59], a[176:183], v22
  v_smfmac_f32_16x16x64_bf16 v[88:91], v[60:63], a[184:191], v22
  v_permlane32_swap_b32 v92, v93
  v_smfmac_f32_16x16x64_bf16 v[88:91], v[64:67], a[192:199], v22
  v_permlane32_swap_b32 v94, v95
  v_smfmac_f32_16x16x64_bf16 v[88:91], v[68:71], a[200:207], v22
  v_permlane32_swap_b32 v93, v92
  v_smfmac_f32_16x16x64_bf16 v[88:91], v[84:87], a[232:239], v22
  v_permlane32_swap_b32 v95, v94
  v_pk_mul_f32 v[120:121], v[92:93], v[24:25] op_sel:[1,0] op_sel_hi:[0,1]
  v_pk_mul_f32 v[122:123], v[94:95], v[24:25] op_sel:[1,0] op_sel_hi:[0,1]
  s_nop 4
  v_pk_fma_f32 v[88:89], v[88:89], v[24:25], v[120:121]
  v_pk_fma_f32 v[90:91], v[90:91], v[24:25], v[122:123]
  v_cvt_pk_bf16_f32 v120, v88, v89
  v_cvt_pk_bf16_f32 v121, v90, v91
  ds_write_b64 v6, v[120:121]
  v_cmp_u_f32 vcc, v88, v89
  v_cmp_u_f32 s[22:23], v90, v91
  s_nop 1
  s_or_b64 vcc, vcc, s[22:23]
  s_cbranch_vccnz mn_77
mk_78:
  s_waitcnt lgkmcnt(0)
  s_barrier
  ds_read_b64_tr_b16 v[104:105], v7 offset:0
  ds_read_b64_tr_b16 v[106:107], v7 offset:768
  ds_read_b64_tr_b16 v[108:109], v7 offset:1536
  ds_read_b64 v[140:141], v11
  s_cmp_eq_u32 s52, 63
  s_cbranch_scc1 last_79
  s_waitcnt lgkmcnt(2)
  v_mfma_f32_16x16x32_bf16 v[120:123], v[104:107], v[104:107], 0
  s_waitcnt lgkmcnt(1)
  v_mfma_f32_16x16x32_bf16 v[120:123], v[108:111], v[108:111], v[120:123]
  s_mov_b64 exec, s[64:65]
  s_nop 6
  v_cvt_pk_f16_f32 v120, v120, v121
  buffer_store_dword v120, v8, s[8:11], s56 offen
  v_cvt_pk_f16_f32 v121, v122, v123
  buffer_store_dword v121, v8, s[8:11], s56 offen offset:128
  s_mov_b64 exec, -1
  s_sleep 3
  s_nop 1
  v_smfmac_f32_16x16x64_bf16 v[96:99], v[48:51], a[0:7], v22
  v_smfmac_f32_16x16x64_bf16 v[100:103], v[48:51], a[80:87], v22
  v_smfmac_f32_16x16x64_bf16 v[96:99], v[52:55], a[8:15], v22
  v_smfmac_f32_16x16x64_bf16 v[100:103], v[52:55], a[88:95], v22
  v_smfmac_f32_16x16x64_bf16 v[96:99], v[56:59], a[16:23], v22
  v_smfmac_f32_16x16x64_bf16 v[100:103], v[56:59], a[96:103], v22
  v_smfmac_f32_16x16x64_bf16 v[96:99], v[60:63], a[24:31], v22
  v_smfmac_f32_16x16x64_bf16 v[96:99], v[64:67], a[32:39], v22
  v_smfmac_f32_16x16x64_bf16 v[96:99], v[68:71], a[40:47], v22
  v_smfmac_f32_16x16x64_bf16 v[96:99], v[72:75], a[48:55], v22
  v_smfmac_f32_16x16x64_bf16 v[96:99], v[76:79], a[56:63], v22
  buffer_load_dwordx4 v[124:127], v9, s[8:11], s56 offen sc1
  v_smfmac_f32_16x16x64_bf16 v[96:99], v[80:83], a[64:71], v22
  buffer_load_dwordx4 v[128:131], v9, s[8:11], s56 offen offset:1024 sc1
  v_smfmac_f32_16x16x64_bf16 v[96:99], v[84:87], a[72:79], v22
  buffer_load_dwordx4 v[132:135], v10, s[8:11], s56 offen sc1
  v_smfmac_f32_16x16x64_bf16 v[100:103], v[60:63], a[104:111], v22
  v_smfmac_f32_16x16x64_bf16 v[100:103], v[64:67], a[112:119], v22
  v_smfmac_f32_16x16x64_bf16 v[100:103], v[68:71], a[120:127], v22
  v_smfmac_f32_16x16x64_bf16 v[100:103], v[72:75], a[128:135], v22
  v_cvt_pk_bf16_f32 v136, v96, v97
  v_smfmac_f32_16x16x64_bf16 v[100:103], v[76:79], a[136:143], v22
  v_cvt_pk_bf16_f32 v137, v98, v99
  v_smfmac_f32_16x16x64_bf16 v[100:103], v[80:83], a[144:151], v22
  v_smfmac_f32_16x16x64_bf16 v[100:103], v[84:87], a[152:159], v22
  s_waitcnt vmcnt(2)
  v_pk_add_f16 v172, v124, v126
  v_pk_add_f16 v173, v125, v127
  s_waitcnt vmcnt(1)
  v_pk_add_f16 v174, v128, v130
  v_pk_add_f16 v175, v129, v131
  v_fma_mix_f32 v166, v172, 1.0, v174 op_sel:[0,0,0] op_sel_hi:[1,0,1]
  v_fma_mix_f32 v168, v173, 1.0, v175 op_sel:[0,0,0] op_sel_hi:[1,0,1]
  s_waitcnt vmcnt(0)
  v_pk_add_f16 v176, v132, v133
  v_pk_add_f16 v177, v134, v135
  v_fma_mix_f32 v170, v176, 1.0, v177 op_sel:[0,0,0] op_sel_hi:[1,0,1]
  v_fma_mix_f32 v167, v172, 1.0, v174 op_sel:[1,0,1] op_sel_hi:[1,0,1]
  v_cmp_u_f32 vcc, v166, v170
  v_fma_mix_f32 v169, v173, 1.0, v175 op_sel:[1,0,1] op_sel_hi:[1,0,1]
  v_fma_mix_f32 v171, v176, 1.0, v177 op_sel:[1,0,1] op_sel_hi:[1,0,1]
  v_cvt_pk_bf16_f32 v138, v100, v101
  s_cbranch_vccnz sr_81
sj_82:
ex_83:
  v_exp_f32 v172, v166
  v_exp_f32 v173, v167
  v_exp_f32 v174, v168
  v_cvt_pk_bf16_f32 v156, v172, v173
  v_exp_f32 v175, v169
  v_exp_f32 v176, v170
  v_cvt_pk_bf16_f32 v157, v174, v175
  v_mov_b32_dpp v158, v156 row_ror:8 row_mask:0xf bank_mask:0xf
  v_exp_f32 v177, v171
  v_mov_b32_dpp v159, v157 row_ror:8 row_mask:0xf bank_mask:0xf
  v_cvt_pk_bf16_f32 v160, v176, v177
  v_cvt_pk_bf16_f32 v139, v102, v103
  v_mfma_f32_16x16x32_bf16 v[178:181], v[152:155], v[156:159], 0
  s_waitcnt lgkmcnt(0)
  v_mov_b32_dpp v161, v160 row_ror:8 row_mask:0xf bank_mask:0xf
  v_mfma_f32_16x16x32_bf16 v[182:185], v[144:147], v[156:159], 0
  s_nop 0
  v_mfma_f32_16x16x32_bf16 v[178:181], v[140:143], v[160:163], v[178:181]
  v_mfma_f32_16x16x32_bf16 v[182:185], v[136:139], v[160:163], v[182:185]
  v_mfma_f32_16x16x32_bf16 v[186:189], v[148:151], v[156:159], 0
  v_mfma_f32_16x16x32_bf16 v[186:189], v[138:141], v[160:163], v[186:189]
  s_mov_b64 exec, s[62:63]
  v_rcp_f32 v164, v180
  s_nop 0
  v_pk_mul_f32 v[178:179], v[178:179], v[164:165] op_sel_hi:[1,0]
  v_pk_mul_f32 v[182:183], v[182:183], v[164:165] op_sel_hi:[1,0]
  v_pk_mul_f32 v[184:185], v[184:185], v[164:165] op_sel_hi:[1,0]
  v_cvt_pk_f16_f32 v64, v178, v179
  v_cvt_pk_f16_f32 v60, v182, v183
  v_pk_mul_f32 v[186:187], v[186:187], v[164:165] op_sel_hi:[1,0]
  v_pk_mul_f32 v[188:189], v[188:189], v[164:165] op_sel_hi:[1,0]
  v_cvt_pk_f16_f32 v61, v184, v185
  v_cvt_pk_f16_f32 v62, v186, v187
  v_cvt_pk_f16_f32 v63, v188, v189
  ds_write_b128 v13, v[60:63]
  ds_write_b32 v14, v64
  v_add_f32 v165, v164, v180
  v_cmp_ngt_f32 vcc, s80, v165
  s_mov_b64 exec, -1
  s_nop 0
  s_cbranch_vccnz fx_84
fk_85:
  s_waitcnt lgkmcnt(0)
  s_barrier
  s_add_u32 m0, s74, 0
  s_add_u32 s21, s79, 0
  buffer_load_dwordx4 v4, s[28:31], s21 offen sc1 lds
  s_add_u32 m0, s74, 3072
  s_add_u32 s21, s79, 41984
  buffer_load_dwordx4 v4, s[28:31], s21 offen sc1 lds
  s_add_u32 m0, s74, 6144
  s_add_u32 s21, s79, 122880
  buffer_load_dwordx4 v4, s[28:31], s21 offen sc1 lds
  s_add_u32 s72, s72, 1310720
  s_add_u32 s79, s79, 1310720
  s_add_u32 s73, s73, 393216
  s_xor_b32 s74, s74, 16384
  s_nop 15
  s_nop 3
  v_permlane32_swap_b32 v96, v100
  v_permlane32_swap_b32 v97, v101
  v_permlane32_swap_b32 v98, v102
  v_permlane32_swap_b32 v99, v103
  v_pk_add_f32 v[96:97], v[96:97], v[100:101]
  v_pk_add_f32 v[98:99], v[98:99], v[102:103]
  v_cvt_pk_bf16_f32 v182, v96, v97
  v_cvt_pk_bf16_f32 v183, v98, v99
  v_min_u32 v182, -2, v182
  ds_write_b64 v26, v[182:183]
  ds_read_b128 v[144:147], v18
  ds_read_b128 v[148:151], v18 offset:1024
  ds_read_b128 v[152:155], v19
  v_xor_b32 v18, 16384, v18
  v_xor_b32 v19, 16384, v19
  v_mov_b32 v88, 0
  v_mov_b32 v89, 0
  v_mov_b32 v90, 0
  v_mov_b32 v91, 0
  v_mov_b32 v92, 0
  v_mov_b32 v93, 0
  v_mov_b32 v94, 0
  v_mov_b32 v95, 0
  v_mov_b32 v96, 0
  v_mov_b32 v97, 0
  v_mov_b32 v98, 0
  v_mov_b32 v99, 0
  v_mov_b32 v100, 0
  v_mov_b32 v101, 0
  v_mov_b32 v102, 0
  v_mov_b32 v103, 0
  s_mov_b32 s81, 0
  s_waitcnt lgkmcnt(0)
  s_barrier
  s_mov_b64 exec, s[64:65]
  buffer_store_dword v28, v8, s[8:11], s57 offen
  buffer_store_dword v28, v8, s[8:11], s57 offen offset:128
  s_mov_b64 exec, -1
  s_cmp_eq_u32 s78, 0
  s_cbranch_scc1 nt_86
  s_mov_b64 exec, s[62:63]
  buffer_store_dword v28, v17, s[8:11], s59 offen
  s_mov_b64 exec, -1
  s_sleep 6
  s_nop 3
  buffer_load_dwordx4 v[68:71], v16, s[4:7], s60 offen sc1
  s_sleep 3
  s_nop 1
  buffer_load_dwordx4 v[72:75], v16, s[4:7], s60 offen sc1
  s_mov_b32 s54, 0
pp_87:
  s_waitcnt vmcnt(1)
  v_mfma_f32_16x16x32_f16 v[120:123], v[44:47], v[68:71], 0
  v_bitop3_b32 v27, v68, s61, 1 bitop3:0x28
  v_cmp_ne_u32 vcc, 0, v27
  s_nop 1
  s_cbranch_vccnz p2_89
  s_nop 2
pg_88:
  v_add_f32_dpp v120, v120, v120 row_ror:8 row_mask:0xf bank_mask:0xf
  v_add_f32_dpp v121, v121, v121 row_ror:8 row_mask:0xf bank_mask:0xf
  s_mov_b64 exec, s[62:63]
  v_cvt_pk_bf16_f32 v120, v120, v121
  v_min_u32 v120, -2, v120
  buffer_store_dword v120, v17, s[8:11], s55 offen
  s_mov_b64 exec, -1
nt_86:
  s_barrier
  s_mov_b32 s58, s55
  s_add_u32 s52, s52, 1
  s_and_b32 s21, s52, 3
  s_mul_i32 s56, s21, 122880
  s_add_u32 s21, s52, 1
  s_and_b32 s21, s21, 3
  s_mul_i32 s55, s21, 122880
  s_add_u32 s55, s55, s75
  s_add_u32 s21, s52, 2
  s_and_b32 s21, s21, 3
  s_mul_i32 s57, s21, 122880
  s_add_u32 s21, s52, 3
  s_and_b32 s21, s21, 3
  s_mul_i32 s59, s21, 122880
  s_add_u32 s59, s59, s75
  s_bfe_u32 s61, s52, 0x10001
  s_and_b32 s21, s52, 1
  s_lshl_b32 s60, s21, 19
  s_mov_b32 s54, 0
  s_sleep 3
  s_nop 2
  buffer_load_dwordx4 v[72:75], v190, s[8:11], s58 offen offset:0 sc1
  buffer_load_dwordx4 v[76:79], v190, s[8:11], s58 offen offset:1024 sc1
  buffer_load_dwordx4 v[80:83], v190, s[8:11], s58 offen offset:2048 sc1
  s_branch top_75
mr_76:
  s_mov_b64 exec, s[22:23]
  s_cbranch_execz ms_90
  buffer_load_dwordx4 v[72:75], v190, s[8:11], s58 offen offset:0 sc1
ms_90:
  s_mov_b64 exec, s[98:99]
  s_cbranch_execz ms_91
  buffer_load_dwordx4 v[76:79], v190, s[8:11], s58 offen offset:1024 sc1
ms_91:
  s_mov_b64 exec, s[100:101]
  s_cbranch_execz ms_92
  buffer_load_dwordx4 v[80:83], v190, s[8:11], s58 offen offset:2048 sc1
ms_92:
  s_add_u32 s54, s54, 1
  s_cmp_gt_u32 s54, 131072
  s_cbranch_scc1 end0
  s_waitcnt vmcnt(0)
  s_mov_b64 exec, s[22:23]
  ds_write_b128 v190, v[72:75] offset:0
  v_cmp_eq_u32 s[22:23], -1, v72
  s_mov_b64 exec, s[98:99]
  ds_write_b128 v190, v[76:79] offset:1024
  v_cmp_eq_u32 s[98:99], -1, v76
  s_mov_b64 exec, s[100:101]
  ds_write_b128 v190, v[80:83] offset:2048
  v_cmp_eq_u32 s[100:101], -1, v80
  s_mov_b64 exec, -1
  s_or_b64 vcc, s[22:23], s[98:99]
  s_or_b64 vcc, vcc, s[100:101]
  s_cbranch_scc1 mr_76
  s_branch mo_80
mn_77:
  v_max3_u32 v27, v48, v49, v50
  v_max3_u32 v27, v27, v51, v52
  v_max3_u32 v27, v27, v53, v54
  v_max3_u32 v27, v27, v55, v56
  v_max3_u32 v27, v27, v57, v58
  v_max3_u32 v27, v27, v59, v60
  v_max3_u32 v27, v27, v61, v62
  v_max3_u32 v27, v27, v63, v64
  v_max3_u32 v27, v27, v65, v66
  v_max3_u32 v27, v27, v67, v68
  v_max3_u32 v27, v27, v69, v70
  v_max3_u32 v27, v27, v71, v72
  v_max3_u32 v27, v27, v73, v74
  v_max3_u32 v27, v27, v75, v76
  v_max3_u32 v27, v27, v77, v78
  v_max3_u32 v27, v27, v79, v80
  v_max3_u32 v27, v27, v81, v82
  v_max3_u32 v27, v27, v83, v84
  v_max3_u32 v27, v27, v85, v86
  v_max3_u32 v27, v27, v87, v87
  v_cmp_eq_u32 vcc, -1, v27
  s_cmp_eq_u32 s52, 0
  s_cbranch_scc1 mk_78
  s_cbranch_vccz mk_78
  s_waitcnt lgkmcnt(0)
  s_barrier
  s_nop 7
  v_mov_b32 v88, 0
  v_mov_b32 v89, 0
  v_mov_b32 v90, 0
  v_mov_b32 v91, 0
  v_mov_b32 v92, 0
  v_mov_b32 v93, 0
  v_mov_b32 v94, 0
  v_mov_b32 v95, 0
  v_mov_b32 v96, 0
  v_mov_b32 v97, 0
  v_mov_b32 v98, 0
  v_mov_b32 v99, 0
  v_mov_b32 v100, 0
  v_mov_b32 v101, 0
  v_mov_b32 v102, 0
  v_mov_b32 v103, 0
  s_mov_b64 s[22:23], -1
  s_mov_b64 s[98:99], -1
  s_mov_b64 s[100:101], -1
  s_branch mr_76
sr_81:
  s_mov_b32 s54, 0
sr_93:
  s_mov_b64 exec, vcc
  buffer_load_dwordx4 v[124:127], v9, s[8:11], s56 offen sc1
  buffer_load_dwordx4 v[128:131], v9, s[8:11], s56 offen offset:1024 sc1
  buffer_load_dwordx4 v[132:135], v10, s[8:11], s56 offen sc1
  s_mov_b64 exec, -1
  s_add_u32 s54, s54, 1
  s_cmp_gt_u32 s54, 131072
  s_cbranch_scc1 end0
  s_and_b32 s21, s54, 31
  s_cbranch_scc0 sr_94
  s_waitcnt vmcnt(0)
  v_pk_add_f16 v172, v124, v126
  v_pk_add_f16 v173, v125, v127
  v_pk_add_f16 v174, v128, v130
  v_pk_add_f16 v175, v129, v131
  v_fma_mix_f32 v166, v172, 1.0, v174 op_sel:[0,0,0] op_sel_hi:[1,0,1]
  v_fma_mix_f32 v168, v173, 1.0, v175 op_sel:[0,0,0] op_sel_hi:[1,0,1]
  v_pk_add_f16 v176, v132, v133
  v_pk_add_f16 v177, v134, v135
  v_add_f32 v27, v166, v168
  v_fma_mix_f32 v170, v176, 1.0, v177 op_sel:[0,0,0] op_sel_hi:[1,0,1]
  v_fma_mix_f32 v167, v172, 1.0, v174 op_sel:[1,0,1] op_sel_hi:[1,0,1]
  v_cmp_u_f32 vcc, v27, v170
  v_fma_mix_f32 v169, v173, 1.0, v175 op_sel:[1,0,1] op_sel_hi:[1,0,1]
  v_fma_mix_f32 v171, v176, 1.0, v177 op_sel:[1,0,1] op_sel_hi:[1,0,1]
  s_cbranch_vccnz sr_93
  s_branch sj_82
sr_94:
  s_waitcnt vmcnt(0)
  v_pk_add_f16 v172, v124, v126
  v_pk_add_f16 v173, v125, v127
  v_pk_add_f16 v174, v128, v130
  v_pk_add_f16 v175, v129, v131
  v_fma_mix_f32 v166, v172, 1.0, v174 op_sel:[0,0,0] op_sel_hi:[1,0,1]
  v_fma_mix_f32 v168, v173, 1.0, v175 op_sel:[0,0,0] op_sel_hi:[1,0,1]
  v_pk_add_f16 v176, v132, v133
  v_pk_add_f16 v177, v134, v135
  v_add_f32 v27, v166, v168
  v_fma_mix_f32 v170, v176, 1.0, v177 op_sel:[0,0,0] op_sel_hi:[1,0,1]
  v_fma_mix_f32 v167, v172, 1.0, v174 op_sel:[1,0,1] op_sel_hi:[1,0,1]
  v_cmp_u_f32 vcc, v27, v170
  v_fma_mix_f32 v169, v173, 1.0, v175 op_sel:[1,0,1] op_sel_hi:[1,0,1]
  v_fma_mix_f32 v171, v176, 1.0, v177 op_sel:[1,0,1] op_sel_hi:[1,0,1]
  v_max3_u32 v27, v124, v126, v128
  v_max3_u32 v27, v27, v130, v132
  v_max3_u32 v27, v27, v133, v134
  v_max3_u32 v27, v27, v135, v135
  v_cmp_eq_u32 vcc, -1, v27
  s_nop 1
  s_cbranch_vccnz sr_93
  s_branch sj_82
fx_84:
  s_cmp_eq_u32 s81, 1
  s_cbranch_scc1 fk_85
  s_mov_b32 s81, 1
  v_max3_f32 v164, v166, v167, v168
  v_max3_f32 v165, v169, v170, v171
  v_max_f32 v164, v164, v165
  s_nop 1
  v_max_f32_dpp v164, v164, v164 row_ror:8 row_mask:0xf bank_mask:0xf
  v_mov_b32 v165, v164
  s_nop 1
  v_permlane32_swap_b32 v164, v165
  v_max_f32 v164, v164, v165
  v_mov_b32 v165, v164
  s_nop 1
  v_permlane16_swap_b32 v164, v165
  v_max_f32 v164, v164, v165
  v_sub_f32 v166, v166, v164
  v_sub_f32 v167, v167, v164
  v_sub_f32 v168, v168, v164
  v_sub_f32 v169, v169, v164
  v_sub_f32 v170, v170, v164
  v_sub_f32 v171, v171, v164
  s_branch ex_83
p2_89:
  buffer_load_dwordx4 v[68:71], v16, s[4:7], s60 offen sc1
  s_waitcnt vmcnt(1)
  v_mfma_f32_16x16x32_f16 v[120:123], v[44:47], v[72:75], 0
  v_bitop3_b32 v27, v72, s61, 1 bitop3:0x28
  v_cmp_ne_u32 vcc, 0, v27
  s_nop 1
  s_cbranch_vccz pg_88
  buffer_load_dwordx4 v[72:75], v16, s[4:7], s60 offen sc1
  s_add_u32 s54, s54, 1
  s_cmp_gt_u32 s54, 131072
  s_cbranch_scc1 end0
  s_branch pp_87
last_79:
  v_smfmac_f32_16x16x64_bf16 v[96:99], v[48:51], a[0:7], v22
  v_smfmac_f32_16x16x64_bf16 v[100:103], v[48:51], a[80:87], v22
  v_smfmac_f32_16x16x64_bf16 v[96:99], v[52:55], a[8:15], v22
  v_smfmac_f32_16x16x64_bf16 v[100:103], v[52:55], a[88:95], v22
  v_smfmac_f32_16x16x64_bf16 v[96:99], v[56:59], a[16:23], v22
  v_smfmac_f32_16x16x64_bf16 v[100:103], v[56:59], a[96:103], v22
  v_smfmac_f32_16x16x64_bf16 v[96:99], v[60:63], a[24:31], v22
  v_smfmac_f32_16x16x64_bf16 v[96:99], v[64:67], a[32:39], v22
  v_smfmac_f32_16x16x64_bf16 v[96:99], v[68:71], a[40:47], v22
  v_smfmac_f32_16x16x64_bf16 v[96:99], v[72:75], a[48:55], v22
  v_smfmac_f32_16x16x64_bf16 v[96:99], v[76:79], a[56:63], v22
  v_smfmac_f32_16x16x64_bf16 v[96:99], v[80:83], a[64:71], v22
  v_smfmac_f32_16x16x64_bf16 v[96:99], v[84:87], a[72:79], v22
  v_smfmac_f32_16x16x64_bf16 v[100:103], v[60:63], a[104:111], v22
  v_smfmac_f32_16x16x64_bf16 v[100:103], v[64:67], a[112:119], v22
  v_smfmac_f32_16x16x64_bf16 v[100:103], v[68:71], a[120:127], v22
  v_smfmac_f32_16x16x64_bf16 v[100:103], v[72:75], a[128:135], v22
  v_smfmac_f32_16x16x64_bf16 v[100:103], v[76:79], a[136:143], v22
  v_smfmac_f32_16x16x64_bf16 v[100:103], v[80:83], a[144:151], v22
  v_smfmac_f32_16x16x64_bf16 v[100:103], v[84:87], a[152:159], v22
  s_nop 7
  v_permlane32_swap_b32 v96, v100
  v_permlane32_swap_b32 v97, v101
  v_permlane32_swap_b32 v98, v102
  v_permlane32_swap_b32 v99, v103
  v_pk_add_f32 v[96:97], v[96:97], v[100:101]
  v_pk_add_f32 v[98:99], v[98:99], v[102:103]
  v_cvt_pk_bf16_f32 v182, v96, v97
  v_cvt_pk_bf16_f32 v183, v98, v99
  v_min_u32 v182, -2, v182
  ds_write_b64 v26, v[182:183]
  s_waitcnt lgkmcnt(0)
  s_barrier
  s_branch chain_done
E_34:
  v_add_u32 v190, 9216, v4
  ds_read_b128 v[84:87], v4 offset:9216
  s_waitcnt lgkmcnt(0)
  s_branch mo_100
  .p2align 3
top_95:
  s_waitcnt vmcnt(0)
  ds_write_b128 v190, v[84:87] offset:0
  v_cmp_eq_u32 s[22:23], -1, v84
  s_or_b64 vcc, s[22:23], s[22:23]
  s_cbranch_scc1 mr_96
mo_100:
  s_waitcnt lgkmcnt(0)
  s_barrier
  ds_read_b128 v[48:51], v4 offset:0
  ds_read_b128 v[52:55], v4 offset:1024
  v_smfmac_f32_16x16x64_bf16 v[92:95], v[84:87], v[248:255], v22
  ds_read_b128 v[56:59], v4 offset:2048
  v_smfmac_f32_16x16x64_bf16 v[88:91], v[84:87], a[232:239], v22
  s_waitcnt lgkmcnt(2)
  ds_read_b128 v[60:63], v4 offset:3072
  v_smfmac_f32_16x16x64_bf16 v[92:95], v[48:51], a[240:247], v22
  ds_read_b128 v[64:67], v4 offset:4096
  v_smfmac_f32_16x16x64_bf16 v[88:91], v[48:51], a[160:167], v22
  s_waitcnt lgkmcnt(3)
  ds_read_b128 v[68:71], v4 offset:5120
  v_smfmac_f32_16x16x64_bf16 v[92:95], v[52:55], a[248:255], v22
  ds_read_b128 v[72:75], v4 offset:6144
  v_smfmac_f32_16x16x64_bf16 v[88:91], v[52:55], a[168:175], v22
  s_waitcnt lgkmcnt(4)
  ds_read_b128 v[76:79], v4 offset:7168
  v_smfmac_f32_16x16x64_bf16 v[92:95], v[56:59], v[192:199], v22
  ds_read_b128 v[80:83], v4 offset:8192
  v_smfmac_f32_16x16x64_bf16 v[88:91], v[56:59], a[176:183], v22
  s_waitcnt lgkmcnt(5)
  s_add_u32 m0, s74, 10240
  s_nop 0
  buffer_load_dwordx4 v4, s[16:19], s73 offen offset:0 sc1 lds
  v_smfmac_f32_16x16x64_bf16 v[92:95], v[60:63], v[200:207], v22
  s_waitcnt lgkmcnt(4)
  s_add_u32 m0, s74, 10240
  s_nop 0
  buffer_load_dwordx4 v4, s[16:19], s73 offen offset:1024 sc1 lds
  v_smfmac_f32_16x16x64_bf16 v[92:95], v[64:67], v[208:215], v22
  s_waitcnt lgkmcnt(3)
  s_add_u32 m0, s74, 10240
  s_nop 0
  buffer_load_dwordx4 v4, s[16:19], s73 offen offset:2048 sc1 lds
  v_smfmac_f32_16x16x64_bf16 v[92:95], v[68:71], v[216:223], v22
  s_waitcnt lgkmcnt(2)
  v_smfmac_f32_16x16x64_bf16 v[92:95], v[72:75], v[224:231], v22
  s_waitcnt lgkmcnt(1)
  v_smfmac_f32_16x16x64_bf16 v[92:95], v[76:79], v[232:239], v22
  s_waitcnt lgkmcnt(0)
  v_smfmac_f32_16x16x64_bf16 v[92:95], v[80:83], v[240:247], v22
  v_smfmac_f32_16x16x64_bf16 v[88:91], v[60:63], a[184:191], v22
  v_smfmac_f32_16x16x64_bf16 v[88:91], v[64:67], a[192:199], v22
  v_smfmac_f32_16x16x64_bf16 v[88:91], v[68:71], a[200:207], v22
  v_cvt_pk_bf16_f32 v122, v92, v93
  v_smfmac_f32_16x16x64_bf16 v[88:91], v[72:75], a[208:215], v22
  v_cvt_pk_bf16_f32 v123, v94, v95
  v_smfmac_f32_16x16x64_bf16 v[88:91], v[76:79], a[216:223], v22
  ds_write_b64 v12, v[122:123] offset:13056
  v_smfmac_f32_16x16x64_bf16 v[88:91], v[80:83], a[224:231], v22
  v_smfmac_f32_16x16x64_bf16 v[96:99], v[48:51], a[0:7], v22
  v_smfmac_f32_16x16x64_bf16 v[100:103], v[48:51], a[80:87], v22
  v_smfmac_f32_16x16x64_bf16 v[96:99], v[52:55], a[8:15], v22
  v_cvt_pk_bf16_f32 v120, v88, v89
  v_cvt_pk_bf16_f32 v121, v90, v91
  ds_write_b64 v12, v[120:121] offset:12544
  v_smfmac_f32_16x16x64_bf16 v[100:103], v[52:55], a[88:95], v22
  v_cmp_u_f32 vcc, v88, v89
  v_smfmac_f32_16x16x64_bf16 v[96:99], v[56:59], a[16:23], v22
  v_cmp_u_f32 s[22:23], v90, v91
  s_nop 0
  s_or_b64 vcc, vcc, s[22:23]
  s_cbranch_vccnz mn_97
mk_98:
  s_waitcnt lgkmcnt(0)
  s_barrier
  ds_read_b64_tr_b16 v[104:105], v7 offset:0
  ds_read_b64_tr_b16 v[106:107], v7 offset:768
  ds_read_b64_tr_b16 v[108:109], v7 offset:1536
  ds_read_b64 v[140:141], v11
  s_cmp_eq_u32 s52, 63
  s_cbranch_scc1 last_99
  s_add_u32 s22, s52, 3
  s_min_u32 s22, s22, 64
  v_cmp_gt_u32 vcc, s22, v42
  s_nop 1
  s_cbranch_vccnz kw_101
kv_102:
  v_smfmac_f32_16x16x64_bf16 v[100:103], v[56:59], a[96:103], v22
  v_smfmac_f32_16x16x64_bf16 v[96:99], v[60:63], a[24:31], v22
  v_smfmac_f32_16x16x64_bf16 v[96:99], v[64:67], a[32:39], v22
  v_smfmac_f32_16x16x64_bf16 v[96:99], v[68:71], a[40:47], v22
  v_smfmac_f32_16x16x64_bf16 v[96:99], v[72:75], a[48:55], v22
  v_smfmac_f32_16x16x64_bf16 v[96:99], v[76:79], a[56:63], v22
  v_smfmac_f32_16x16x64_bf16 v[96:99], v[80:83], a[64:71], v22
  v_smfmac_f32_16x16x64_bf16 v[96:99], v[84:87], a[72:79], v22
  v_smfmac_f32_16x16x64_bf16 v[100:103], v[60:63], a[104:111], v22
  v_smfmac_f32_16x16x64_bf16 v[100:103], v[64:67], a[112:119], v22
  v_smfmac_f32_16x16x64_bf16 v[100:103], v[68:71], a[120:127], v22
  v_smfmac_f32_16x16x64_bf16 v[100:103], v[72:75], a[128:135], v22
  v_cvt_pk_bf16_f32 v136, v96, v97
  v_smfmac_f32_16x16x64_bf16 v[100:103], v[76:79], a[136:143], v22
  v_cvt_pk_bf16_f32 v137, v98, v99
  v_smfmac_f32_16x16x64_bf16 v[100:103], v[80:83], a[144:151], v22
  v_smfmac_f32_16x16x64_bf16 v[100:103], v[84:87], a[152:159], v22
  s_sleep 3
  s_nop 3
  buffer_load_dwordx4 v[124:127], v9, s[8:11], s56 offen sc1
  buffer_load_dwordx4 v[128:131], v9, s[8:11], s56 offen offset:1024 sc1
  s_nop 5
  buffer_load_dwordx4 v[132:135], v10, s[8:11], s56 offen sc1
  s_waitcnt vmcnt(2)
  v_pk_add_f16 v172, v124, v126
  v_pk_add_f16 v173, v125, v127
  s_waitcnt vmcnt(1)
  v_pk_add_f16 v174, v128, v130
  v_pk_add_f16 v175, v129, v131
  v_fma_mix_f32 v166, v172, 1.0, v174 op_sel:[0,0,0] op_sel_hi:[1,0,1]
  v_fma_mix_f32 v168, v173, 1.0, v175 op_sel:[0,0,0] op_sel_hi:[1,0,1]
  s_waitcnt vmcnt(0)
  v_pk_add_f16 v176, v132, v133
  v_pk_add_f16 v177, v134, v135
  v_fma_mix_f32 v170, v176, 1.0, v177 op_sel:[0,0,0] op_sel_hi:[1,0,1]
  v_fma_mix_f32 v167, v172, 1.0, v174 op_sel:[1,0,1] op_sel_hi:[1,0,1]
  v_cmp_u_f32 vcc, v166, v170
  v_fma_mix_f32 v169, v173, 1.0, v175 op_sel:[1,0,1] op_sel_hi:[1,0,1]
  v_fma_mix_f32 v171, v176, 1.0, v177 op_sel:[1,0,1] op_sel_hi:[1,0,1]
  v_cvt_pk_bf16_f32 v138, v100, v101
  s_cbranch_vccnz sr_103
sj_104:
ex_105:
  v_exp_f32 v172, v166
  v_exp_f32 v173, v167
  v_exp_f32 v174, v168
  v_cvt_pk_bf16_f32 v156, v172, v173
  v_exp_f32 v175, v169
  v_exp_f32 v176, v170
  v_cvt_pk_bf16_f32 v157, v174, v175
  v_mov_b32_dpp v158, v156 row_ror:8 row_mask:0xf bank_mask:0xf
  v_exp_f32 v177, v171
  v_mov_b32_dpp v159, v157 row_ror:8 row_mask:0xf bank_mask:0xf
  v_cvt_pk_bf16_f32 v160, v176, v177
  v_cvt_pk_bf16_f32 v139, v102, v103
  v_mfma_f32_16x16x32_bf16 v[178:181], v[152:155], v[156:159], 0
  s_waitcnt lgkmcnt(0)
  v_mov_b32_dpp v161, v160 row_ror:8 row_mask:0xf bank_mask:0xf
  v_mfma_f32_16x16x32_bf16 v[182:185], v[144:147], v[156:159], 0
  s_nop 0
  v_mfma_f32_16x16x32_bf16 v[178:181], v[140:143], v[160:163], v[178:181]
  v_mfma_f32_16x16x32_bf16 v[182:185], v[136:139], v[160:163], v[182:185]
  v_mfma_f32_16x16x32_bf16 v[186:189], v[148:151], v[156:159], 0
  v_mfma_f32_16x16x32_bf16 v[186:189], v[138:141], v[160:163], v[186:189]
  s_mov_b64 exec, s[62:63]
  v_rcp_f32 v164, v180
  s_nop 0
  v_pk_mul_f32 v[178:179], v[178:179], v[164:165] op_sel_hi:[1,0]
  v_pk_mul_f32 v[182:183], v[182:183], v[164:165] op_sel_hi:[1,0]
  v_pk_mul_f32 v[184:185], v[184:185], v[164:165] op_sel_hi:[1,0]
  v_cvt_pk_f16_f32 v64, v178, v179
  v_cvt_pk_f16_f32 v60, v182, v183
  v_pk_mul_f32 v[186:187], v[186:187], v[164:165] op_sel_hi:[1,0]
  v_pk_mul_f32 v[188:189], v[188:189], v[164:165] op_sel_hi:[1,0]
  v_cvt_pk_f16_f32 v61, v184, v185
  v_cvt_pk_f16_f32 v62, v186, v187
  v_cvt_pk_f16_f32 v63, v188, v189
  ds_write_b128 v13, v[60:63]
  ds_write_b32 v14, v64
  v_add_f32 v165, v164, v180
  v_cmp_ngt_f32 vcc, s80, v165
  s_mov_b64 exec, -1
  s_nop 0
  s_cbranch_vccnz fx_106
fk_107:
  s_waitcnt lgkmcnt(0)
  s_barrier
  ds_read_b128 v[166:169], v4 offset:13824
  ds_read_b128 v[170:173], v4 offset:14464
  ds_read_b128 v[174:177], v4 offset:15104
  ds_read_b128 v[178:181], v4 offset:15744
  s_mov_b64 exec, s[66:67]
  s_waitcnt lgkmcnt(2)
  v_pk_add_f16 v166, v166, v170
  v_pk_add_f16 v167, v167, v171
  v_pk_add_f16 v168, v168, v172
  v_pk_add_f16 v169, v169, v173
  s_waitcnt lgkmcnt(1)
  v_pk_add_f16 v166, v166, v174
  v_pk_add_f16 v167, v167, v175
  v_pk_add_f16 v168, v168, v176
  v_pk_add_f16 v169, v169, v177
  s_waitcnt lgkmcnt(0)
  v_pk_add_f16 v166, v166, v178
  v_pk_add_f16 v167, v167, v179
  v_pk_add_f16 v168, v168, v180
  v_pk_add_f16 v169, v169, v181
  v_and_or_b32 v166, v166, -2, s61
  buffer_store_dwordx4 v[166:169], v15, s[4:7], s60 offen sc1
  s_mov_b64 exec, -1
  v_permlane32_swap_b32 v96, v100
  v_permlane32_swap_b32 v97, v101
  v_permlane32_swap_b32 v98, v102
  v_permlane32_swap_b32 v99, v103
  v_pk_add_f32 v[96:97], v[96:97], v[100:101]
  v_pk_add_f32 v[98:99], v[98:99], v[102:103]
  v_cvt_pk_bf16_f32 v182, v96, v97
  v_cvt_pk_bf16_f32 v183, v98, v99
  v_min_u32 v182, -2, v182
  ds_write_b64 v26, v[182:183]
  v_permlane32_swap_b32 v88, v92
  v_permlane32_swap_b32 v89, v93
  v_permlane32_swap_b32 v90, v94
  v_permlane32_swap_b32 v91, v95
  v_pk_add_f32 v[88:89], v[88:89], v[92:93]
  v_pk_add_f32 v[90:91], v[90:91], v[94:95]
  v_cvt_pk_bf16_f32 v184, v88, v89
  v_cvt_pk_bf16_f32 v185, v90, v91
  v_min_u32 v184, -2, v184
  ds_write_b64 v43, v[184:185]
  ds_read_b128 v[144:147], v18
  ds_read_b128 v[148:151], v18 offset:1024
  ds_read_b128 v[152:155], v19
  v_xor_b32 v18, 16384, v18
  v_xor_b32 v19, 16384, v19
  v_mov_b32 v88, 0
  v_mov_b32 v89, 0
  v_mov_b32 v90, 0
  v_mov_b32 v91, 0
  v_mov_b32 v92, 0
  v_mov_b32 v93, 0
  v_mov_b32 v94, 0
  v_mov_b32 v95, 0
  v_mov_b32 v96, 0
  v_mov_b32 v97, 0
  v_mov_b32 v98, 0
  v_mov_b32 v99, 0
  v_mov_b32 v100, 0
  v_mov_b32 v101, 0
  v_mov_b32 v102, 0
  v_mov_b32 v103, 0
  s_mov_b32 s81, 0
  s_waitcnt lgkmcnt(0)
  s_barrier
  s_add_u32 s72, s72, 1310720
  s_add_u32 s79, s79, 1310720
  s_add_u32 s73, s73, 393216
  s_xor_b32 s74, s74, 16384
  v_mov_b32 v28, s61
  v_mov_b32 v166, s52
  s_mov_b64 exec, 1
  buffer_store_dword v166, v23, s[12:15], s77 offen sc1
  s_mov_b64 exec, -1
  ds_read_b128 v[170:173], v4 offset:16384
  ds_read_b128 v[174:177], v4 offset:17408
  ds_read_b128 v[178:181], v4 offset:18432
  v_min_u32 v104, -2, v104
  v_min_u32 v106, -2, v106
  v_min_u32 v108, -2, v108
  s_mov_b64 exec, s[68:69]
  buffer_store_dwordx4 v[104:107], v36, s[24:27], s70 offen sc1
  buffer_store_dwordx2 v[108:109], v37, s[24:27], s70 offen sc1
  s_mov_b64 exec, -1
  s_waitcnt lgkmcnt(0)
  buffer_store_dwordx4 v[170:173], v38, s[36:39], s71 offen sc1
  buffer_store_dwordx4 v[174:177], v39, s[36:39], s71 offen sc1
  s_mov_b64 exec, 0xffffffff
  buffer_store_dwordx4 v[178:181], v40, s[36:39], s71 offen sc1
  s_mov_b64 exec, -1
  s_add_u32 s70, s70, 98304
  s_add_u32 s71, s71, 327680
  buffer_load_dword v42, v41, s[12:15], s76 offen sc1
nt_108:
  s_barrier
  s_mov_b32 s58, s55
  s_add_u32 s52, s52, 1
  s_and_b32 s21, s52, 3
  s_mul_i32 s56, s21, 122880
  s_add_u32 s21, s52, 1
  s_and_b32 s21, s21, 3
  s_mul_i32 s55, s21, 122880
  s_add_u32 s55, s55, s75
  s_add_u32 s21, s52, 2
  s_and_b32 s21, s21, 3
  s_mul_i32 s57, s21, 122880
  s_add_u32 s21, s52, 3
  s_and_b32 s21, s21, 3
  s_mul_i32 s59, s21, 122880
  s_add_u32 s59, s59, s75
  s_bfe_u32 s61, s52, 0x10001
  s_and_b32 s21, s52, 1
  s_lshl_b32 s60, s21, 19
  s_mov_b32 s54, 0
  s_sleep 3
  s_nop 2
  buffer_load_dwordx4 v[84:87], v190, s[8:11], s58 offen offset:0 sc1
  s_branch top_95
mr_96:
  s_mov_b64 exec, s[22:23]
  s_cbranch_execz ms_109
  buffer_load_dwordx4 v[84:87], v190, s[8:11], s58 offen offset:0 sc1
ms_109:
  s_add_u32 s54, s54, 1
  s_cmp_gt_u32 s54, 131072
  s_cbranch_scc1 end0
  s_waitcnt vmcnt(0)
  s_mov_b64 exec, s[22:23]
  ds_write_b128 v190, v[84:87] offset:0
  v_cmp_eq_u32 s[22:23], -1, v84
  s_mov_b64 exec, -1
  s_or_b64 vcc, s[22:23], s[22:23]
  s_cbranch_scc1 mr_96
  s_branch mo_100
mn_97:
  v_max3_u32 v27, v48, v49, v50
  v_max3_u32 v27, v27, v51, v52
  v_max3_u32 v27, v27, v53, v54
  v_max3_u32 v27, v27, v55, v56
  v_max3_u32 v27, v27, v57, v58
  v_max3_u32 v27, v27, v59, v60
  v_max3_u32 v27, v27, v61, v62
  v_max3_u32 v27, v27, v63, v64
  v_max3_u32 v27, v27, v65, v66
  v_max3_u32 v27, v27, v67, v68
  v_max3_u32 v27, v27, v69, v70
  v_max3_u32 v27, v27, v71, v72
  v_max3_u32 v27, v27, v73, v74
  v_max3_u32 v27, v27, v75, v76
  v_max3_u32 v27, v27, v77, v78
  v_max3_u32 v27, v27, v79, v80
  v_max3_u32 v27, v27, v81, v82
  v_max3_u32 v27, v27, v83, v84
  v_max3_u32 v27, v27, v85, v86
  v_max3_u32 v27, v27, v87, v87
  v_cmp_eq_u32 vcc, -1, v27
  s_cmp_eq_u32 s52, 0
  s_cbranch_scc1 mk_98
  s_cbranch_vccz mk_98
  s_waitcnt lgkmcnt(0)
  s_barrier
  s_nop 7
  v_mov_b32 v88, 0
  v_mov_b32 v89, 0
  v_mov_b32 v90, 0
  v_mov_b32 v91, 0
  v_mov_b32 v92, 0
  v_mov_b32 v93, 0
  v_mov_b32 v94, 0
  v_mov_b32 v95, 0
  v_mov_b32 v96, 0
  v_mov_b32 v97, 0
  v_mov_b32 v98, 0
  v_mov_b32 v99, 0
  v_mov_b32 v100, 0
  v_mov_b32 v101, 0
  v_mov_b32 v102, 0
  v_mov_b32 v103, 0
  s_mov_b64 s[22:23], -1
  s_branch mr_96
kw_101:
  s_mov_b32 s101, 0
wm_110:
  buffer_load_dword v42, v41, s[12:15], s76 offen sc1
  s_add_u32 s101, s101, 1
  s_cmp_gt_u32 s101, 131072
  s_cbranch_scc1 end0
  s_waitcnt vmcnt(0)
  v_cmp_gt_u32 vcc, s22, v42
  v_readfirstlane_b32 s100, v42
  s_nop 0
  s_cbranch_vccz wm_111
  s_sleep 1
  s_branch wm_110
wm_111:
  s_branch kv_102
sr_103:
  s_mov_b32 s54, 0
sr_112:
  s_mov_b64 exec, vcc
  buffer_load_dwordx4 v[124:127], v9, s[8:11], s56 offen sc1
  buffer_load_dwordx4 v[128:131], v9, s[8:11], s56 offen offset:1024 sc1
  buffer_load_dwordx4 v[132:135], v10, s[8:11], s56 offen sc1
  s_mov_b64 exec, -1
  s_add_u32 s54, s54, 1
  s_cmp_gt_u32 s54, 131072
  s_cbranch_scc1 end0
  s_and_b32 s21, s54, 31
  s_cbranch_scc0 sr_113
  s_waitcnt vmcnt(0)
  v_pk_add_f16 v172, v124, v126
  v_pk_add_f16 v173, v125, v127
  v_pk_add_f16 v174, v128, v130
  v_pk_add_f16 v175, v129, v131
  v_fma_mix_f32 v166, v172, 1.0, v174 op_sel:[0,0,0] op_sel_hi:[1,0,1]
  v_fma_mix_f32 v168, v173, 1.0, v175 op_sel:[0,0,0] op_sel_hi:[1,0,1]
  v_pk_add_f16 v176, v132, v133
  v_pk_add_f16 v177, v134, v135
  v_add_f32 v27, v166, v168
  v_fma_mix_f32 v170, v176, 1.0, v177 op_sel:[0,0,0] op_sel_hi:[1,0,1]
  v_fma_mix_f32 v167, v172, 1.0, v174 op_sel:[1,0,1] op_sel_hi:[1,0,1]
  v_cmp_u_f32 vcc, v27, v170
  v_fma_mix_f32 v169, v173, 1.0, v175 op_sel:[1,0,1] op_sel_hi:[1,0,1]
  v_fma_mix_f32 v171, v176, 1.0, v177 op_sel:[1,0,1] op_sel_hi:[1,0,1]
  s_cbranch_vccnz sr_112
  s_branch sj_104
sr_113:
  s_waitcnt vmcnt(0)
  v_pk_add_f16 v172, v124, v126
  v_pk_add_f16 v173, v125, v127
  v_pk_add_f16 v174, v128, v130
  v_pk_add_f16 v175, v129, v131
  v_fma_mix_f32 v166, v172, 1.0, v174 op_sel:[0,0,0] op_sel_hi:[1,0,1]
  v_fma_mix_f32 v168, v173, 1.0, v175 op_sel:[0,0,0] op_sel_hi:[1,0,1]
  v_pk_add_f16 v176, v132, v133
  v_pk_add_f16 v177, v134, v135
  v_add_f32 v27, v166, v168
  v_fma_mix_f32 v170, v176, 1.0, v177 op_sel:[0,0,0] op_sel_hi:[1,0,1]
  v_fma_mix_f32 v167, v172, 1.0, v174 op_sel:[1,0,1] op_sel_hi:[1,0,1]
  v_cmp_u_f32 vcc, v27, v170
  v_fma_mix_f32 v169, v173, 1.0, v175 op_sel:[1,0,1] op_sel_hi:[1,0,1]
  v_fma_mix_f32 v171, v176, 1.0, v177 op_sel:[1,0,1] op_sel_hi:[1,0,1]
  v_max3_u32 v27, v124, v126, v128
  v_max3_u32 v27, v27, v130, v132
  v_max3_u32 v27, v27, v133, v134
  v_max3_u32 v27, v27, v135, v135
  v_cmp_eq_u32 vcc, -1, v27
  s_nop 1
  s_cbranch_vccnz sr_112
  s_branch sj_104
fx_106:
  s_cmp_eq_u32 s81, 1
  s_cbranch_scc1 fk_107
  s_mov_b32 s81, 1
  v_max3_f32 v164, v166, v167, v168
  v_max3_f32 v165, v169, v170, v171
  v_max_f32 v164, v164, v165
  s_nop 1
  v_max_f32_dpp v164, v164, v164 row_ror:8 row_mask:0xf bank_mask:0xf
  v_mov_b32 v165, v164
  s_nop 1
  v_permlane32_swap_b32 v164, v165
  v_max_f32 v164, v164, v165
  v_mov_b32 v165, v164
  s_nop 1
  v_permlane16_swap_b32 v164, v165
  v_max_f32 v164, v164, v165
  v_sub_f32 v166, v166, v164
  v_sub_f32 v167, v167, v164
  v_sub_f32 v168, v168, v164
  v_sub_f32 v169, v169, v164
  v_sub_f32 v170, v170, v164
  v_sub_f32 v171, v171, v164
  s_branch ex_105
last_99:
  v_smfmac_f32_16x16x64_bf16 v[100:103], v[56:59], a[96:103], v22
  v_smfmac_f32_16x16x64_bf16 v[96:99], v[60:63], a[24:31], v22
  v_smfmac_f32_16x16x64_bf16 v[96:99], v[64:67], a[32:39], v22
  v_smfmac_f32_16x16x64_bf16 v[96:99], v[68:71], a[40:47], v22
  v_smfmac_f32_16x16x64_bf16 v[96:99], v[72:75], a[48:55], v22
  v_smfmac_f32_16x16x64_bf16 v[96:99], v[76:79], a[56:63], v22
  v_smfmac_f32_16x16x64_bf16 v[96:99], v[80:83], a[64:71], v22
  v_smfmac_f32_16x16x64_bf16 v[96:99], v[84:87], a[72:79], v22
  v_smfmac_f32_16x16x64_bf16 v[100:103], v[60:63], a[104:111], v22
  v_smfmac_f32_16x16x64_bf16 v[100:103], v[64:67], a[112:119], v22
  v_smfmac_f32_16x16x64_bf16 v[100:103], v[68:71], a[120:127], v22
  v_smfmac_f32_16x16x64_bf16 v[100:103], v[72:75], a[128:135], v22
  v_smfmac_f32_16x16x64_bf16 v[100:103], v[76:79], a[136:143], v22
  v_smfmac_f32_16x16x64_bf16 v[100:103], v[80:83], a[144:151], v22
  v_smfmac_f32_16x16x64_bf16 v[100:103], v[84:87], a[152:159], v22
  s_nop 7
  v_permlane32_swap_b32 v96, v100
  v_permlane32_swap_b32 v97, v101
  v_permlane32_swap_b32 v98, v102
  v_permlane32_swap_b32 v99, v103
  v_pk_add_f32 v[96:97], v[96:97], v[100:101]
  v_pk_add_f32 v[98:99], v[98:99], v[102:103]
  v_cvt_pk_bf16_f32 v182, v96, v97
  v_cvt_pk_bf16_f32 v183, v98, v99
  v_min_u32 v182, -2, v182
  ds_write_b64 v26, v[182:183]
  v_permlane32_swap_b32 v88, v92
  v_permlane32_swap_b32 v89, v93
  v_permlane32_swap_b32 v90, v94
  v_permlane32_swap_b32 v91, v95
  v_pk_add_f32 v[88:89], v[88:89], v[92:93]
  v_pk_add_f32 v[90:91], v[90:91], v[94:95]
  v_cvt_pk_bf16_f32 v184, v88, v89
  v_cvt_pk_bf16_f32 v185, v90, v91
  v_min_u32 v184, -2, v184
  ds_write_b64 v43, v[184:185]
  s_waitcnt lgkmcnt(0)
  s_barrier
  ds_read_b128 v[170:173], v4 offset:16384
  ds_read_b128 v[174:177], v4 offset:17408
  ds_read_b128 v[178:181], v4 offset:18432
  v_min_u32 v104, -2, v104
  v_min_u32 v106, -2, v106
  v_min_u32 v108, -2, v108
  s_mov_b64 exec, s[68:69]
  buffer_store_dwordx4 v[104:107], v36, s[24:27], s70 offen sc1
  buffer_store_dwordx2 v[108:109], v37, s[24:27], s70 offen sc1
  s_mov_b64 exec, -1
  s_waitcnt lgkmcnt(0)
  buffer_store_dwordx4 v[170:173], v38, s[36:39], s71 offen sc1
  buffer_store_dwordx4 v[174:177], v39, s[36:39], s71 offen sc1
  s_mov_b64 exec, 0xffffffff
  buffer_store_dwordx4 v[178:181], v40, s[36:39], s71 offen sc1
  s_mov_b64 exec, -1
  s_add_u32 s70, s70, 98304
  s_add_u32 s71, s71, 327680
  s_waitcnt vmcnt(0)
  v_mov_b32 v166, 64
  s_mov_b64 exec, 1
  buffer_store_dword v166, v23, s[12:15], s77 offen sc1
  s_mov_b64 exec, -1
  s_branch chain_done
E_27:
  v_add_u32 v190, 0, v4
  ds_read_b128 v[48:51], v4 offset:0
  ds_read_b128 v[52:55], v4 offset:1024
  ds_read_b128 v[56:59], v4 offset:2048
  s_waitcnt lgkmcnt(0)
  s_branch mo_119
  .p2align 3
top_114:
  s_waitcnt vmcnt(2)
  ds_write_b128 v190, v[48:51] offset:0
  v_cmp_eq_u32 s[22:23], -1, v48
  s_waitcnt vmcnt(1)
  ds_write_b128 v190, v[52:55] offset:1024
  v_cmp_eq_u32 s[98:99], -1, v52
  s_waitcnt vmcnt(0)
  ds_write_b128 v190, v[56:59] offset:2048
  v_cmp_eq_u32 s[100:101], -1, v56
  s_or_b64 vcc, s[22:23], s[98:99]
  s_or_b64 vcc, vcc, s[100:101]
  s_cbranch_scc1 mr_115
mo_119:
  s_waitcnt lgkmcnt(0)
  s_barrier
  ds_read_b128 v[60:63], v4 offset:3072
  ds_read_b128 v[64:67], v4 offset:4096
  v_smfmac_f32_16x16x64_bf16 v[92:95], v[48:51], a[240:247], v22
  ds_read_b128 v[68:71], v4 offset:5120
  v_smfmac_f32_16x16x64_bf16 v[88:91], v[48:51], a[160:167], v22
  ds_read_b128 v[72:75], v4 offset:6144
  v_smfmac_f32_16x16x64_bf16 v[92:95], v[52:55], a[248:255], v22
  ds_read_b128 v[76:79], v4 offset:7168
  v_smfmac_f32_16x16x64_bf16 v[88:91], v[52:55], a[168:175], v22
  ds_read_b128 v[80:83], v4 offset:8192
  v_smfmac_f32_16x16x64_bf16 v[92:95], v[56:59], v[192:199], v22
  ds_read_b128 v[84:87], v4 offset:9216
  v_smfmac_f32_16x16x64_bf16 v[88:91], v[56:59], a[176:183], v22
  s_waitcnt lgkmcnt(6)
  v_smfmac_f32_16x16x64_bf16 v[92:95], v[60:63], v[200:207], v22
  v_smfmac_f32_16x16x64_bf16 v[88:91], v[60:63], a[184:191], v22
  s_waitcnt lgkmcnt(5)
  v_smfmac_f32_16x16x64_bf16 v[92:95], v[64:67], v[208:215], v22
  s_waitcnt lgkmcnt(4)
  v_smfmac_f32_16x16x64_bf16 v[92:95], v[68:71], v[216:223], v22
  s_waitcnt lgkmcnt(3)
  v_smfmac_f32_16x16x64_bf16 v[92:95], v[72:75], v[224:231], v22
  s_waitcnt lgkmcnt(2)
  v_smfmac_f32_16x16x64_bf16 v[92:95], v[76:79], v[232:239], v22
  s_waitcnt lgkmcnt(1)
  v_smfmac_f32_16x16x64_bf16 v[92:95], v[80:83], v[240:247], v22
  s_waitcnt lgkmcnt(0)
  v_smfmac_f32_16x16x64_bf16 v[92:95], v[84:87], v[248:255], v22
  v_smfmac_f32_16x16x64_bf16 v[88:91], v[64:67], a[192:199], v22
  v_smfmac_f32_16x16x64_bf16 v[88:91], v[68:71], a[200:207], v22
  v_smfmac_f32_16x16x64_bf16 v[88:91], v[72:75], a[208:215], v22
  v_permlane32_swap_b32 v92, v93
  v_smfmac_f32_16x16x64_bf16 v[88:91], v[76:79], a[216:223], v22
  v_permlane32_swap_b32 v94, v95
  v_smfmac_f32_16x16x64_bf16 v[88:91], v[80:83], a[224:231], v22
  v_permlane32_swap_b32 v93, v92
  v_smfmac_f32_16x16x64_bf16 v[88:91], v[84:87], a[232:239], v22
  v_permlane32_swap_b32 v95, v94
  v_pk_mul_f32 v[120:121], v[92:93], v[24:25] op_sel:[1,0] op_sel_hi:[0,1]
  v_pk_mul_f32 v[122:123], v[94:95], v[24:25] op_sel:[1,0] op_sel_hi:[0,1]
  s_nop 4
  v_pk_fma_f32 v[88:89], v[88:89], v[24:25], v[120:121]
  v_pk_fma_f32 v[90:91], v[90:91], v[24:25], v[122:123]
  v_cvt_pk_bf16_f32 v120, v88, v89
  v_cvt_pk_bf16_f32 v121, v90, v91
  ds_write_b64 v6, v[120:121]
  v_cmp_u_f32 vcc, v88, v89
  v_cmp_u_f32 s[22:23], v90, v91
  s_nop 1
  s_or_b64 vcc, vcc, s[22:23]
  s_cbranch_vccnz mn_116
mk_117:
  s_waitcnt lgkmcnt(0)
  s_barrier
  ds_read_b64_tr_b16 v[104:105], v7 offset:0
  ds_read_b64_tr_b16 v[106:107], v7 offset:768
  ds_read_b64_tr_b16 v[108:109], v7 offset:1536
  ds_read_b64 v[140:141], v11
  s_cmp_eq_u32 s52, 63
  s_cbranch_scc1 last_118
  s_waitcnt lgkmcnt(2)
  v_mfma_f32_16x16x32_bf16 v[120:123], v[112:115], v[104:107], 0
  s_waitcnt lgkmcnt(1)
  v_mfma_f32_16x16x32_bf16 v[120:123], v[116:119], v[108:111], v[120:123]
  s_mov_b64 exec, s[64:65]
  s_nop 6
  v_cvt_pk_f16_f32 v120, v120, v121
  v_cvt_pk_f16_f32 v121, v122, v123
  buffer_store_dwordx2 v[120:121], v8, s[8:11], s56 offen sc1
  s_mov_b64 exec, -1
  s_sleep 3
  s_nop 1
  v_smfmac_f32_16x16x64_bf16 v[96:99], v[48:51], a[0:7], v22
  v_smfmac_f32_16x16x64_bf16 v[100:103], v[48:51], a[80:87], v22
  v_smfmac_f32_16x16x64_bf16 v[96:99], v[52:55], a[8:15], v22
  v_smfmac_f32_16x16x64_bf16 v[100:103], v[52:55], a[88:95], v22
  v_smfmac_f32_16x16x64_bf16 v[96:99], v[56:59], a[16:23], v22
  v_smfmac_f32_16x16x64_bf16 v[100:103], v[56:59], a[96:103], v22
  v_smfmac_f32_16x16x64_bf16 v[96:99], v[60:63], a[24:31], v22
  v_smfmac_f32_16x16x64_bf16 v[96:99], v[64:67], a[32:39], v22
  v_smfmac_f32_16x16x64_bf16 v[96:99], v[68:71], a[40:47], v22
  v_smfmac_f32_16x16x64_bf16 v[96:99], v[72:75], a[48:55], v22
  v_smfmac_f32_16x16x64_bf16 v[96:99], v[76:79], a[56:63], v22
  buffer_load_dwordx4 v[124:127], v9, s[8:11], s56 offen sc1
  v_smfmac_f32_16x16x64_bf16 v[96:99], v[80:83], a[64:71], v22
  buffer_load_dwordx4 v[128:131], v9, s[8:11], s56 offen offset:1024 sc1
  v_smfmac_f32_16x16x64_bf16 v[96:99], v[84:87], a[72:79], v22
  buffer_load_dwordx4 v[132:135], v10, s[8:11], s56 offen sc1
  v_smfmac_f32_16x16x64_bf16 v[100:103], v[60:63], a[104:111], v22
  v_smfmac_f32_16x16x64_bf16 v[100:103], v[64:67], a[112:119], v22
  v_smfmac_f32_16x16x64_bf16 v[100:103], v[68:71], a[120:127], v22
  v_smfmac_f32_16x16x64_bf16 v[100:103], v[72:75], a[128:135], v22
  v_cvt_pk_bf16_f32 v136, v96, v97
  v_smfmac_f32_16x16x64_bf16 v[100:103], v[76:79], a[136:143], v22
  v_cvt_pk_bf16_f32 v137, v98, v99
  v_smfmac_f32_16x16x64_bf16 v[100:103], v[80:83], a[144:151], v22
  v_smfmac_f32_16x16x64_bf16 v[100:103], v[84:87], a[152:159], v22
  s_waitcnt vmcnt(2)
  v_pk_add_f16 v172, v124, v126
  v_pk_add_f16 v173, v125, v127
  s_waitcnt vmcnt(1)
  v_pk_add_f16 v174, v128, v130
  v_pk_add_f16 v175, v129, v131
  v_fma_mix_f32 v166, v172, 1.0, v174 op_sel:[0,0,0] op_sel_hi:[1,0,1]
  v_fma_mix_f32 v168, v173, 1.0, v175 op_sel:[0,0,0] op_sel_hi:[1,0,1]
  s_waitcnt vmcnt(0)
  v_pk_add_f16 v176, v132, v133
  v_pk_add_f16 v177, v134, v135
  v_fma_mix_f32 v170, v176, 1.0, v177 op_sel:[0,0,0] op_sel_hi:[1,0,1]
  v_fma_mix_f32 v167, v172, 1.0, v174 op_sel:[1,0,1] op_sel_hi:[1,0,1]
  v_cmp_u_f32 vcc, v166, v170
  v_fma_mix_f32 v169, v173, 1.0, v175 op_sel:[1,0,1] op_sel_hi:[1,0,1]
  v_fma_mix_f32 v171, v176, 1.0, v177 op_sel:[1,0,1] op_sel_hi:[1,0,1]
  v_cvt_pk_bf16_f32 v138, v100, v101
  s_cbranch_vccnz sr_120
sj_121:
ex_122:
  v_exp_f32 v172, v166
  v_exp_f32 v173, v167
  v_exp_f32 v174, v168
  v_cvt_pk_bf16_f32 v156, v172, v173
  v_exp_f32 v175, v169
  v_exp_f32 v176, v170
  v_cvt_pk_bf16_f32 v157, v174, v175
  v_mov_b32_dpp v158, v156 row_ror:8 row_mask:0xf bank_mask:0xf
  v_exp_f32 v177, v171
  v_mov_b32_dpp v159, v157 row_ror:8 row_mask:0xf bank_mask:0xf
  v_cvt_pk_bf16_f32 v160, v176, v177
  v_cvt_pk_bf16_f32 v139, v102, v103
  v_mfma_f32_16x16x32_bf16 v[178:181], v[152:155], v[156:159], 0
  s_waitcnt lgkmcnt(0)
  v_mov_b32_dpp v161, v160 row_ror:8 row_mask:0xf bank_mask:0xf
  v_mfma_f32_16x16x32_bf16 v[182:185], v[144:147], v[156:159], 0
  s_nop 0
  v_mfma_f32_16x16x32_bf16 v[178:181], v[140:143], v[160:163], v[178:181]
  v_mfma_f32_16x16x32_bf16 v[182:185], v[136:139], v[160:163], v[182:185]
  v_mfma_f32_16x16x32_bf16 v[186:189], v[148:151], v[156:159], 0
  v_mfma_f32_16x16x32_bf16 v[186:189], v[138:141], v[160:163], v[186:189]
  s_mov_b64 exec, s[62:63]
  v_rcp_f32 v164, v180
  s_nop 0
  v_pk_mul_f32 v[178:179], v[178:179], v[164:165] op_sel_hi:[1,0]
  v_pk_mul_f32 v[182:183], v[182:183], v[164:165] op_sel_hi:[1,0]
  v_pk_mul_f32 v[184:185], v[184:185], v[164:165] op_sel_hi:[1,0]
  v_cvt_pk_f16_f32 v64, v178, v179
  v_cvt_pk_f16_f32 v60, v182, v183
  v_pk_mul_f32 v[186:187], v[186:187], v[164:165] op_sel_hi:[1,0]
  v_pk_mul_f32 v[188:189], v[188:189], v[164:165] op_sel_hi:[1,0]
  v_cvt_pk_f16_f32 v61, v184, v185
  v_cvt_pk_f16_f32 v62, v186, v187
  v_cvt_pk_f16_f32 v63, v188, v189
  ds_write_b128 v13, v[60:63]
  ds_write_b32 v14, v64
  v_add_f32 v165, v164, v180
  v_cmp_ngt_f32 vcc, s80, v165
  s_mov_b64 exec, -1
  s_nop 0
  s_cbranch_vccnz fx_123
fk_124:
  s_waitcnt lgkmcnt(0)
  s_barrier
  s_add_u32 m0, s74, 8192
  s_add_u32 s21, s72, 2048
  buffer_load_dwordx4 v32, s[28:31], s21 offen sc1 lds
  s_add_u32 m0, s74, 1024
  s_add_u32 s21, s79, 1024
  buffer_load_dwordx4 v4, s[28:31], s21 offen sc1 lds
  s_add_u32 m0, s74, 4096
  s_add_u32 s21, s79, 81920
  buffer_load_dwordx4 v4, s[28:31], s21 offen sc1 lds
  s_add_u32 m0, s74, 7168
  s_add_u32 s21, s79, 123904
  buffer_load_dwordx4 v4, s[28:31], s21 offen sc1 lds
  s_add_u32 s72, s72, 1310720
  s_add_u32 s79, s79, 1310720
  s_add_u32 s73, s73, 393216
  s_xor_b32 s74, s74, 16384
  s_nop 15
  s_nop 3
  v_permlane32_swap_b32 v96, v100
  v_permlane32_swap_b32 v97, v101
  v_permlane32_swap_b32 v98, v102
  v_permlane32_swap_b32 v99, v103
  v_pk_add_f32 v[96:97], v[96:97], v[100:101]
  v_pk_add_f32 v[98:99], v[98:99], v[102:103]
  v_cvt_pk_bf16_f32 v182, v96, v97
  v_cvt_pk_bf16_f32 v183, v98, v99
  v_min_u32 v182, -2, v182
  ds_write_b64 v26, v[182:183]
  ds_read_b128 v[144:147], v18
  ds_read_b128 v[148:151], v18 offset:1024
  ds_read_b128 v[152:155], v19
  ds_read_b128 v[112:115], v20
  ds_read_b64 v[116:117], v21
  v_xor_b32 v18, 16384, v18
  v_xor_b32 v19, 16384, v19
  v_xor_b32 v20, 16384, v20
  v_xor_b32 v21, 16384, v21
  v_mov_b32 v88, 0
  v_mov_b32 v89, 0
  v_mov_b32 v90, 0
  v_mov_b32 v91, 0
  v_mov_b32 v92, 0
  v_mov_b32 v93, 0
  v_mov_b32 v94, 0
  v_mov_b32 v95, 0
  v_mov_b32 v96, 0
  v_mov_b32 v97, 0
  v_mov_b32 v98, 0
  v_mov_b32 v99, 0
  v_mov_b32 v100, 0
  v_mov_b32 v101, 0
  v_mov_b32 v102, 0
  v_mov_b32 v103, 0
  s_mov_b32 s81, 0
  s_waitcnt lgkmcnt(0)
  s_barrier
  s_mov_b64 exec, s[64:65]
  buffer_store_dwordx2 v[28:29], v8, s[8:11], s57 offen sc1
  s_mov_b64 exec, s[62:63]
  buffer_store_dword v28, v17, s[8:11], s59 offen sc1
  s_mov_b64 exec, -1
  s_sleep 6
  s_nop 3
  buffer_load_dwordx4 v[68:71], v16, s[4:7], s60 offen sc1
  s_sleep 3
  s_nop 1
  buffer_load_dwordx4 v[72:75], v16, s[4:7], s60 offen sc1
  s_mov_b32 s54, 0
pp_126:
  s_waitcnt vmcnt(1)
  v_mfma_f32_16x16x32_f16 v[120:123], v[44:47], v[68:71], 0
  v_bitop3_b32 v27, v68, s61, 1 bitop3:0x28
  v_cmp_ne_u32 vcc, 0, v27
  s_nop 1
  s_cbranch_vccnz p2_128
  s_nop 2
pg_127:
  v_add_f32_dpp v120, v120, v120 row_ror:8 row_mask:0xf bank_mask:0xf
  v_add_f32_dpp v121, v121, v121 row_ror:8 row_mask:0xf bank_mask:0xf
  s_mov_b64 exec, s[62:63]
  v_cvt_pk_bf16_f32 v120, v120, v121
  v_min_u32 v120, -2, v120
  buffer_store_dword v120, v17, s[8:11], s55 offen sc1
  s_mov_b64 exec, -1
nt_125:
  s_barrier
  s_mov_b32 s58, s55
  s_add_u32 s52, s52, 1
  s_and_b32 s21, s52, 3
  s_mul_i32 s56, s21, 122880
  s_add_u32 s21, s52, 1
  s_and_b32 s21, s21, 3
  s_mul_i32 s55, s21, 122880
  s_add_u32 s55, s55, s75
  s_add_u32 s21, s52, 2
  s_and_b32 s21, s21, 3
  s_mul_i32 s57, s21, 122880
  s_add_u32 s21, s52, 3
  s_and_b32 s21, s21, 3
  s_mul_i32 s59, s21, 122880
  s_add_u32 s59, s59, s75
  s_bfe_u32 s61, s52, 0x10001
  s_and_b32 s21, s52, 1
  s_lshl_b32 s60, s21, 19
  s_mov_b32 s54, 0
  s_sleep 3
  s_nop 2
  buffer_load_dwordx4 v[48:51], v190, s[8:11], s58 offen offset:0 sc1
  buffer_load_dwordx4 v[52:55], v190, s[8:11], s58 offen offset:1024 sc1
  buffer_load_dwordx4 v[56:59], v190, s[8:11], s58 offen offset:2048 sc1
  s_branch top_114
mr_115:
  s_mov_b64 exec, s[22:23]
  s_cbranch_execz ms_129
  buffer_load_dwordx4 v[48:51], v190, s[8:11], s58 offen offset:0 sc1
ms_129:
  s_mov_b64 exec, s[98:99]
  s_cbranch_execz ms_130
  buffer_load_dwordx4 v[52:55], v190, s[8:11], s58 offen offset:1024 sc1
ms_130:
  s_mov_b64 exec, s[100:101]
  s_cbranch_execz ms_131
  buffer_load_dwordx4 v[56:59], v190, s[8:11], s58 offen offset:2048 sc1
ms_131:
  s_add_u32 s54, s54, 1
  s_cmp_gt_u32 s54, 131072
  s_cbranch_scc1 end0
  s_waitcnt vmcnt(0)
  s_mov_b64 exec, s[22:23]
  ds_write_b128 v190, v[48:51] offset:0
  v_cmp_eq_u32 s[22:23], -1, v48
  s_mov_b64 exec, s[98:99]
  ds_write_b128 v190, v[52:55] offset:1024
  v_cmp_eq_u32 s[98:99], -1, v52
  s_mov_b64 exec, s[100:101]
  ds_write_b128 v190, v[56:59] offset:2048
  v_cmp_eq_u32 s[100:101], -1, v56
  s_mov_b64 exec, -1
  s_or_b64 vcc, s[22:23], s[98:99]
  s_or_b64 vcc, vcc, s[100:101]
  s_cbranch_scc1 mr_115
  s_branch mo_119
mn_116:
  v_max3_u32 v27, v48, v49, v50
  v_max3_u32 v27, v27, v51, v52
  v_max3_u32 v27, v27, v53, v54
  v_max3_u32 v27, v27, v55, v56
  v_max3_u32 v27, v27, v57, v58
  v_max3_u32 v27, v27, v59, v60
  v_max3_u32 v27, v27, v61, v62
  v_max3_u32 v27, v27, v63, v64
  v_max3_u32 v27, v27, v65, v66
  v_max3_u32 v27, v27, v67, v68
  v_max3_u32 v27, v27, v69, v70
  v_max3_u32 v27, v27, v71, v72
  v_max3_u32 v27, v27, v73, v74
  v_max3_u32 v27, v27, v75, v76
  v_max3_u32 v27, v27, v77, v78
  v_max3_u32 v27, v27, v79, v80
  v_max3_u32 v27, v27, v81, v82
  v_max3_u32 v27, v27, v83, v84
  v_max3_u32 v27, v27, v85, v86
  v_max3_u32 v27, v27, v87, v87
  v_cmp_eq_u32 vcc, -1, v27
  s_cmp_eq_u32 s52, 0
  s_cbranch_scc1 mk_117
  s_cbranch_vccz mk_117
  s_waitcnt lgkmcnt(0)
  s_barrier
  s_nop 7
  v_mov_b32 v88, 0
  v_mov_b32 v89, 0
  v_mov_b32 v90, 0
  v_mov_b32 v91, 0
  v_mov_b32 v92, 0
  v_mov_b32 v93, 0
  v_mov_b32 v94, 0
  v_mov_b32 v95, 0
  v_mov_b32 v96, 0
  v_mov_b32 v97, 0
  v_mov_b32 v98, 0
  v_mov_b32 v99, 0
  v_mov_b32 v100, 0
  v_mov_b32 v101, 0
  v_mov_b32 v102, 0
  v_mov_b32 v103, 0
  s_mov_b64 s[22:23], -1
  s_mov_b64 s[98:99], -1
  s_mov_b64 s[100:101], -1
  s_branch mr_115
sr_120:
  s_mov_b32 s54, 0
sr_132:
  s_mov_b64 exec, vcc
  buffer_load_dwordx4 v[124:127], v9, s[8:11], s56 offen sc1
  buffer_load_dwordx4 v[128:131], v9, s[8:11], s56 offen offset:1024 sc1
  buffer_load_dwordx4 v[132:135], v10, s[8:11], s56 offen sc1
  s_mov_b64 exec, -1
  s_add_u32 s54, s54, 1
  s_cmp_gt_u32 s54, 131072
  s_cbranch_scc1 end0
  s_and_b32 s21, s54, 31
  s_cbranch_scc0 sr_133
  s_waitcnt vmcnt(0)
  v_pk_add_f16 v172, v124, v126
  v_pk_add_f16 v173, v125, v127
  v_pk_add_f16 v174, v128, v130
  v_pk_add_f16 v175, v129, v131
  v_fma_mix_f32 v166, v172, 1.0, v174 op_sel:[0,0,0] op_sel_hi:[1,0,1]
  v_fma_mix_f32 v168, v173, 1.0, v175 op_sel:[0,0,0] op_sel_hi:[1,0,1]
  v_pk_add_f16 v176, v132, v133
  v_pk_add_f16 v177, v134, v135
  v_add_f32 v27, v166, v168
  v_fma_mix_f32 v170, v176, 1.0, v177 op_sel:[0,0,0] op_sel_hi:[1,0,1]
  v_fma_mix_f32 v167, v172, 1.0, v174 op_sel:[1,0,1] op_sel_hi:[1,0,1]
  v_cmp_u_f32 vcc, v27, v170
  v_fma_mix_f32 v169, v173, 1.0, v175 op_sel:[1,0,1] op_sel_hi:[1,0,1]
  v_fma_mix_f32 v171, v176, 1.0, v177 op_sel:[1,0,1] op_sel_hi:[1,0,1]
  s_cbranch_vccnz sr_132
  s_branch sj_121
sr_133:
  s_waitcnt vmcnt(0)
  v_pk_add_f16 v172, v124, v126
  v_pk_add_f16 v173, v125, v127
  v_pk_add_f16 v174, v128, v130
  v_pk_add_f16 v175, v129, v131
  v_fma_mix_f32 v166, v172, 1.0, v174 op_sel:[0,0,0] op_sel_hi:[1,0,1]
  v_fma_mix_f32 v168, v173, 1.0, v175 op_sel:[0,0,0] op_sel_hi:[1,0,1]
  v_pk_add_f16 v176, v132, v133
  v_pk_add_f16 v177, v134, v135
  v_add_f32 v27, v166, v168
  v_fma_mix_f32 v170, v176, 1.0, v177 op_sel:[0,0,0] op_sel_hi:[1,0,1]
  v_fma_mix_f32 v167, v172, 1.0, v174 op_sel:[1,0,1] op_sel_hi:[1,0,1]
  v_cmp_u_f32 vcc, v27, v170
  v_fma_mix_f32 v169, v173, 1.0, v175 op_sel:[1,0,1] op_sel_hi:[1,0,1]
  v_fma_mix_f32 v171, v176, 1.0, v177 op_sel:[1,0,1] op_sel_hi:[1,0,1]
  v_max3_u32 v27, v124, v126, v128
  v_max3_u32 v27, v27, v130, v132
  v_max3_u32 v27, v27, v133, v134
  v_max3_u32 v27, v27, v135, v135
  v_cmp_eq_u32 vcc, -1, v27
  s_nop 1
  s_cbranch_vccnz sr_132
  s_branch sj_121
fx_123:
  s_cmp_eq_u32 s81, 1
  s_cbranch_scc1 fk_124
  s_mov_b32 s81, 1
  v_max3_f32 v164, v166, v167, v168
  v_max3_f32 v165, v169, v170, v171
  v_max_f32 v164, v164, v165
  s_nop 1
  v_max_f32_dpp v164, v164, v164 row_ror:8 row_mask:0xf bank_mask:0xf
  v_mov_b32 v165, v164
  s_nop 1
  v_permlane32_swap_b32 v164, v165
  v_max_f32 v164, v164, v165
  v_mov_b32 v165, v164
  s_nop 1
  v_permlane16_swap_b32 v164, v165
  v_max_f32 v164, v164, v165
  v_sub_f32 v166, v166, v164
  v_sub_f32 v167, v167, v164
  v_sub_f32 v168, v168, v164
  v_sub_f32 v169, v169, v164
  v_sub_f32 v170, v170, v164
  v_sub_f32 v171, v171, v164
  s_branch ex_122
p2_128:
  buffer_load_dwordx4 v[68:71], v16, s[4:7], s60 offen sc1
  s_waitcnt vmcnt(1)
  v_mfma_f32_16x16x32_f16 v[120:123], v[44:47], v[72:75], 0
  v_bitop3_b32 v27, v72, s61, 1 bitop3:0x28
  v_cmp_ne_u32 vcc, 0, v27
  s_nop 1
  s_cbranch_vccz pg_127
  buffer_load_dwordx4 v[72:75], v16, s[4:7], s60 offen sc1
  s_add_u32 s54, s54, 1
  s_cmp_gt_u32 s54, 131072
  s_cbranch_scc1 end0
  s_branch pp_126
last_118:
  v_smfmac_f32_16x16x64_bf16 v[96:99], v[48:51], a[0:7], v22
  v_smfmac_f32_16x16x64_bf16 v[100:103], v[48:51], a[80:87], v22
  v_smfmac_f32_16x16x64_bf16 v[96:99], v[52:55], a[8:15], v22
  v_smfmac_f32_16x16x64_bf16 v[100:103], v[52:55], a[88:95], v22
  v_smfmac_f32_16x16x64_bf16 v[96:99], v[56:59], a[16:23], v22
  v_smfmac_f32_16x16x64_bf16 v[100:103], v[56:59], a[96:103], v22
  v_smfmac_f32_16x16x64_bf16 v[96:99], v[60:63], a[24:31], v22
  v_smfmac_f32_16x16x64_bf16 v[96:99], v[64:67], a[32:39], v22
  v_smfmac_f32_16x16x64_bf16 v[96:99], v[68:71], a[40:47], v22
  v_smfmac_f32_16x16x64_bf16 v[96:99], v[72:75], a[48:55], v22
  v_smfmac_f32_16x16x64_bf16 v[96:99], v[76:79], a[56:63], v22
  v_smfmac_f32_16x16x64_bf16 v[96:99], v[80:83], a[64:71], v22
  v_smfmac_f32_16x16x64_bf16 v[96:99], v[84:87], a[72:79], v22
  v_smfmac_f32_16x16x64_bf16 v[100:103], v[60:63], a[104:111], v22
  v_smfmac_f32_16x16x64_bf16 v[100:103], v[64:67], a[112:119], v22
  v_smfmac_f32_16x16x64_bf16 v[100:103], v[68:71], a[120:127], v22
  v_smfmac_f32_16x16x64_bf16 v[100:103], v[72:75], a[128:135], v22
  v_smfmac_f32_16x16x64_bf16 v[100:103], v[76:79], a[136:143], v22
  v_smfmac_f32_16x16x64_bf16 v[100:103], v[80:83], a[144:151], v22
  v_smfmac_f32_16x16x64_bf16 v[100:103], v[84:87], a[152:159], v22
  s_nop 7
  v_permlane32_swap_b32 v96, v100
  v_permlane32_swap_b32 v97, v101
  v_permlane32_swap_b32 v98, v102
  v_permlane32_swap_b32 v99, v103
  v_pk_add_f32 v[96:97], v[96:97], v[100:101]
  v_pk_add_f32 v[98:99], v[98:99], v[102:103]
  v_cvt_pk_bf16_f32 v182, v96, v97
  v_cvt_pk_bf16_f32 v183, v98, v99
  v_min_u32 v182, -2, v182
  ds_write_b64 v26, v[182:183]
  s_waitcnt lgkmcnt(0)
  s_barrier
  v_mov_b32 v246, 80
  v_mov_b32 v247, 1
  s_mov_b64 exec, 1
  buffer_atomic_add v247, v246, s[32:35], 0 offen sc0 sc1
  s_mov_b64 exec, -1
  s_branch chain_done
E_29:
  v_add_u32 v190, 3072, v4
  ds_read_b128 v[60:63], v4 offset:3072
  ds_read_b128 v[64:67], v4 offset:4096
  ds_read_b128 v[68:71], v4 offset:5120
  s_waitcnt lgkmcnt(0)
  s_branch mo_139
  .p2align 3
top_134:
  s_waitcnt vmcnt(2)
  ds_write_b128 v190, v[60:63] offset:0
  v_cmp_eq_u32 s[22:23], -1, v60
  s_waitcnt vmcnt(1)
  ds_write_b128 v190, v[64:67] offset:1024
  v_cmp_eq_u32 s[98:99], -1, v64
  s_waitcnt vmcnt(0)
  ds_write_b128 v190, v[68:71] offset:2048
  v_cmp_eq_u32 s[100:101], -1, v68
  s_or_b64 vcc, s[22:23], s[98:99]
  s_or_b64 vcc, vcc, s[100:101]
  s_cbranch_scc1 mr_135
mo_139:
  s_waitcnt lgkmcnt(0)
  s_barrier
  ds_read_b128 v[48:51], v4 offset:0
  ds_read_b128 v[52:55], v4 offset:1024
  v_smfmac_f32_16x16x64_bf16 v[92:95], v[60:63], v[200:207], v22
  ds_read_b128 v[56:59], v4 offset:2048
  v_smfmac_f32_16x16x64_bf16 v[88:91], v[60:63], a[184:191], v22
  ds_read_b128 v[72:75], v4 offset:6144
  v_smfmac_f32_16x16x64_bf16 v[92:95], v[64:67], v[208:215], v22
  ds_read_b128 v[76:79], v4 offset:7168
  v_smfmac_f32_16x16x64_bf16 v[88:91], v[64:67], a[192:199], v22
  ds_read_b128 v[80:83], v4 offset:8192
  v_smfmac_f32_16x16x64_bf16 v[92:95], v[68:71], v[216:223], v22
  ds_read_b128 v[84:87], v4 offset:9216
  v_smfmac_f32_16x16x64_bf16 v[88:91], v[68:71], a[200:207], v22
  s_waitcnt lgkmcnt(6)
  v_smfmac_f32_16x16x64_bf16 v[92:95], v[48:51], a[240:247], v22
  v_smfmac_f32_16x16x64_bf16 v[88:91], v[48:51], a[160:167], v22
  s_waitcnt lgkmcnt(5)
  v_smfmac_f32_16x16x64_bf16 v[92:95], v[52:55], a[248:255], v22
  s_waitcnt lgkmcnt(4)
  v_smfmac_f32_16x16x64_bf16 v[92:95], v[56:59], v[192:199], v22
  s_waitcnt lgkmcnt(3)
  v_smfmac_f32_16x16x64_bf16 v[92:95], v[72:75], v[224:231], v22
  s_waitcnt lgkmcnt(2)
  v_smfmac_f32_16x16x64_bf16 v[92:95], v[76:79], v[232:239], v22
  s_waitcnt lgkmcnt(1)
  v_smfmac_f32_16x16x64_bf16 v[92:95], v[80:83], v[240:247], v22
  s_waitcnt lgkmcnt(0)
  v_smfmac_f32_16x16x64_bf16 v[92:95], v[84:87], v[248:255], v22
  v_smfmac_f32_16x16x64_bf16 v[88:91], v[52:55], a[168:175], v22
  v_smfmac_f32_16x16x64_bf16 v[88:91], v[56:59], a[176:183], v22
  v_smfmac_f32_16x16x64_bf16 v[88:91], v[72:75], a[208:215], v22
  v_permlane32_swap_b32 v92, v93
  v_smfmac_f32_16x16x64_bf16 v[88:91], v[76:79], a[216:223], v22
  v_permlane32_swap_b32 v94, v95
  v_smfmac_f32_16x16x64_bf16 v[88:91], v[80:83], a[224:231], v22
  v_permlane32_swap_b32 v93, v92
  v_smfmac_f32_16x16x64_bf16 v[88:91], v[84:87], a[232:239], v22
  v_permlane32_swap_b32 v95, v94
  v_pk_mul_f32 v[120:121], v[92:93], v[24:25] op_sel:[1,0] op_sel_hi:[0,1]
  v_pk_mul_f32 v[122:123], v[94:95], v[24:25] op_sel:[1,0] op_sel_hi:[0,1]
  s_nop 4
  v_pk_fma_f32 v[88:89], v[88:89], v[24:25], v[120:121]
  v_pk_fma_f32 v[90:91], v[90:91], v[24:25], v[122:123]
  v_cvt_pk_bf16_f32 v120, v88, v89
  v_cvt_pk_bf16_f32 v121, v90, v91
  ds_write_b64 v6, v[120:121]
  v_cmp_u_f32 vcc, v88, v89
  v_cmp_u_f32 s[22:23], v90, v91
  s_nop 1
  s_or_b64 vcc, vcc, s[22:23]
  s_cbranch_vccnz mn_136
mk_137:
  s_waitcnt lgkmcnt(0)
  s_barrier
  ds_read_b64_tr_b16 v[104:105], v7 offset:0
  ds_read_b64_tr_b16 v[106:107], v7 offset:768
  ds_read_b64_tr_b16 v[108:109], v7 offset:1536
  ds_read_b64 v[140:141], v11
  s_cmp_eq_u32 s52, 63
  s_cbranch_scc1 last_138
  s_waitcnt lgkmcnt(2)
  v_mfma_f32_16x16x32_bf16 v[120:123], v[112:115], v[104:107], 0
  s_waitcnt lgkmcnt(1)
  v_mfma_f32_16x16x32_bf16 v[120:123], v[116:119], v[108:111], v[120:123]
  s_mov_b64 exec, s[64:65]
  s_nop 6
  v_cvt_pk_f16_f32 v120, v120, v121
  v_cvt_pk_f16_f32 v121, v122, v123
  buffer_store_dwordx2 v[120:121], v8, s[8:11], s56 offen sc1
  s_mov_b64 exec, -1
  s_sleep 3
  s_nop 1
  v_smfmac_f32_16x16x64_bf16 v[96:99], v[48:51], a[0:7], v22
  v_smfmac_f32_16x16x64_bf16 v[100:103], v[48:51], a[80:87], v22
  v_smfmac_f32_16x16x64_bf16 v[96:99], v[52:55], a[8:15], v22
  v_smfmac_f32_16x16x64_bf16 v[100:103], v[52:55], a[88:95], v22
  v_smfmac_f32_16x16x64_bf16 v[96:99], v[56:59], a[16:23], v22
  v_smfmac_f32_16x16x64_bf16 v[100:103], v[56:59], a[96:103], v22
  v_smfmac_f32_16x16x64_bf16 v[96:99], v[60:63], a[24:31], v22
  v_smfmac_f32_16x16x64_bf16 v[96:99], v[64:67], a[32:39], v22
  v_smfmac_f32_16x16x64_bf16 v[96:99], v[68:71], a[40:47], v22
  v_smfmac_f32_16x16x64_bf16 v[96:99], v[72:75], a[48:55], v22
  v_smfmac_f32_16x16x64_bf16 v[96:99], v[76:79], a[56:63], v22
  buffer_load_dwordx4 v[124:127], v9, s[8:11], s56 offen sc1
  v_smfmac_f32_16x16x64_bf16 v[96:99], v[80:83], a[64:71], v22
  buffer_load_dwordx4 v[128:131], v9, s[8:11], s56 offen offset:1024 sc1
  v_smfmac_f32_16x16x64_bf16 v[96:99], v[84:87], a[72:79], v22
  buffer_load_dwordx4 v[132:135], v10, s[8:11], s56 offen sc1
  v_smfmac_f32_16x16x64_bf16 v[100:103], v[60:63], a[104:111], v22
  v_smfmac_f32_16x16x64_bf16 v[100:103], v[64:67], a[112:119], v22
  v_smfmac_f32_16x16x64_bf16 v[100:103], v[68:71], a[120:127], v22
  v_smfmac_f32_16x16x64_bf16 v[100:103], v[72:75], a[128:135], v22
  v_cvt_pk_bf16_f32 v136, v96, v97
  v_smfmac_f32_16x16x64_bf16 v[100:103], v[76:79], a[136:143], v22
  v_cvt_pk_bf16_f32 v137, v98, v99
  v_smfmac_f32_16x16x64_bf16 v[100:103], v[80:83], a[144:151], v22
  v_smfmac_f32_16x16x64_bf16 v[100:103], v[84:87], a[152:159], v22
  s_waitcnt vmcnt(2)
  v_pk_add_f16 v172, v124, v126
  v_pk_add_f16 v173, v125, v127
  s_waitcnt vmcnt(1)
  v_pk_add_f16 v174, v128, v130
  v_pk_add_f16 v175, v129, v131
  v_fma_mix_f32 v166, v172, 1.0, v174 op_sel:[0,0,0] op_sel_hi:[1,0,1]
  v_fma_mix_f32 v168, v173, 1.0, v175 op_sel:[0,0,0] op_sel_hi:[1,0,1]
  s_waitcnt vmcnt(0)
  v_pk_add_f16 v176, v132, v133
  v_pk_add_f16 v177, v134, v135
  v_fma_mix_f32 v170, v176, 1.0, v177 op_sel:[0,0,0] op_sel_hi:[1,0,1]
  v_fma_mix_f32 v167, v172, 1.0, v174 op_sel:[1,0,1] op_sel_hi:[1,0,1]
  v_cmp_u_f32 vcc, v166, v170
  v_fma_mix_f32 v169, v173, 1.0, v175 op_sel:[1,0,1] op_sel_hi:[1,0,1]
  v_fma_mix_f32 v171, v176, 1.0, v177 op_sel:[1,0,1] op_sel_hi:[1,0,1]
  v_cvt_pk_bf16_f32 v138, v100, v101
  s_cbranch_vccnz sr_140
sj_141:
ex_142:
  v_exp_f32 v172, v166
  v_exp_f32 v173, v167
  v_exp_f32 v174, v168
  v_cvt_pk_bf16_f32 v156, v172, v173
  v_exp_f32 v175, v169
  v_exp_f32 v176, v170
  v_cvt_pk_bf16_f32 v157, v174, v175
  v_mov_b32_dpp v158, v156 row_ror:8 row_mask:0xf bank_mask:0xf
  v_exp_f32 v177, v171
  v_mov_b32_dpp v159, v157 row_ror:8 row_mask:0xf bank_mask:0xf
  v_cvt_pk_bf16_f32 v160, v176, v177
  v_cvt_pk_bf16_f32 v139, v102, v103
  v_mfma_f32_16x16x32_bf16 v[178:181], v[152:155], v[156:159], 0
  s_waitcnt lgkmcnt(0)
  v_mov_b32_dpp v161, v160 row_ror:8 row_mask:0xf bank_mask:0xf
  v_mfma_f32_16x16x32_bf16 v[182:185], v[144:147], v[156:159], 0
  s_nop 0
  v_mfma_f32_16x16x32_bf16 v[178:181], v[140:143], v[160:163], v[178:181]
  v_mfma_f32_16x16x32_bf16 v[182:185], v[136:139], v[160:163], v[182:185]
  v_mfma_f32_16x16x32_bf16 v[186:189], v[148:151], v[156:159], 0
  v_mfma_f32_16x16x32_bf16 v[186:189], v[138:141], v[160:163], v[186:189]
  s_mov_b64 exec, s[62:63]
  v_rcp_f32 v164, v180
  s_nop 0
  v_pk_mul_f32 v[178:179], v[178:179], v[164:165] op_sel_hi:[1,0]
  v_pk_mul_f32 v[182:183], v[182:183], v[164:165] op_sel_hi:[1,0]
  v_pk_mul_f32 v[184:185], v[184:185], v[164:165] op_sel_hi:[1,0]
  v_cvt_pk_f16_f32 v64, v178, v179
  v_cvt_pk_f16_f32 v60, v182, v183
  v_pk_mul_f32 v[186:187], v[186:187], v[164:165] op_sel_hi:[1,0]
  v_pk_mul_f32 v[188:189], v[188:189], v[164:165] op_sel_hi:[1,0]
  v_cvt_pk_f16_f32 v61, v184, v185
  v_cvt_pk_f16_f32 v62, v186, v187
  v_cvt_pk_f16_f32 v63, v188, v189
  ds_write_b128 v13, v[60:63]
  ds_write_b32 v14, v64
  v_add_f32 v165, v164, v180
  v_cmp_ngt_f32 vcc, s80, v165
  s_mov_b64 exec, -1
  s_nop 0
  s_cbranch_vccnz fx_143
fk_144:
  s_waitcnt lgkmcnt(0)
  s_barrier
  s_add_u32 m0, s74, 9216
  s_add_u32 s21, s72, 83968
  buffer_load_dwordx4 v32, s[28:31], s21 offen sc1 lds
  s_add_u32 m0, s74, 2048
  s_add_u32 s21, s79, 40960
  buffer_load_dwordx4 v4, s[28:31], s21 offen sc1 lds
  s_add_u32 m0, s74, 5120
  s_add_u32 s21, s79, 82944
  buffer_load_dwordx4 v4, s[28:31], s21 offen sc1 lds
  s_add_u32 s72, s72, 1310720
  s_add_u32 s79, s79, 1310720
  s_add_u32 s73, s73, 393216
  s_xor_b32 s74, s74, 16384
  s_nop 15
  s_nop 3
  v_permlane32_swap_b32 v96, v100
  v_permlane32_swap_b32 v97, v101
  v_permlane32_swap_b32 v98, v102
  v_permlane32_swap_b32 v99, v103
  v_pk_add_f32 v[96:97], v[96:97], v[100:101]
  v_pk_add_f32 v[98:99], v[98:99], v[102:103]
  v_cvt_pk_bf16_f32 v182, v96, v97
  v_cvt_pk_bf16_f32 v183, v98, v99
  v_min_u32 v182, -2, v182
  ds_write_b64 v26, v[182:183]
  ds_read_b128 v[144:147], v18
  ds_read_b128 v[148:151], v18 offset:1024
  ds_read_b128 v[152:155], v19
  ds_read_b128 v[112:115], v20
  ds_read_b64 v[116:117], v21
  v_xor_b32 v18, 16384, v18
  v_xor_b32 v19, 16384, v19
  v_xor_b32 v20, 16384, v20
  v_xor_b32 v21, 16384, v21
  v_mov_b32 v88, 0
  v_mov_b32 v89, 0
  v_mov_b32 v90, 0
  v_mov_b32 v91, 0
  v_mov_b32 v92, 0
  v_mov_b32 v93, 0
  v_mov_b32 v94, 0
  v_mov_b32 v95, 0
  v_mov_b32 v96, 0
  v_mov_b32 v97, 0
  v_mov_b32 v98, 0
  v_mov_b32 v99, 0
  v_mov_b32 v100, 0
  v_mov_b32 v101, 0
  v_mov_b32 v102, 0
  v_mov_b32 v103, 0
  s_mov_b32 s81, 0
  s_waitcnt lgkmcnt(0)
  s_barrier
  s_mov_b64 exec, s[64:65]
  buffer_store_dwordx2 v[28:29], v8, s[8:11], s57 offen sc1
  s_mov_b64 exec, s[62:63]
  buffer_store_dword v28, v17, s[8:11], s59 offen sc1
  s_mov_b64 exec, -1
  s_sleep 6
  s_nop 3
  buffer_load_dwordx4 v[68:71], v16, s[4:7], s60 offen sc1
  s_sleep 3
  s_nop 1
  buffer_load_dwordx4 v[72:75], v16, s[4:7], s60 offen sc1
  s_mov_b32 s54, 0
pp_146:
  s_waitcnt vmcnt(1)
  v_mfma_f32_16x16x32_f16 v[120:123], v[44:47], v[68:71], 0
  v_bitop3_b32 v27, v68, s61, 1 bitop3:0x28
  v_cmp_ne_u32 vcc, 0, v27
  s_nop 1
  s_cbranch_vccnz p2_148
  s_nop 2
pg_147:
  v_add_f32_dpp v120, v120, v120 row_ror:8 row_mask:0xf bank_mask:0xf
  v_add_f32_dpp v121, v121, v121 row_ror:8 row_mask:0xf bank_mask:0xf
  s_mov_b64 exec, s[62:63]
  v_cvt_pk_bf16_f32 v120, v120, v121
  v_min_u32 v120, -2, v120
  buffer_store_dword v120, v17, s[8:11], s55 offen sc1
  s_mov_b64 exec, -1
nt_145:
  s_barrier
  s_mov_b32 s58, s55
  s_add_u32 s52, s52, 1
  s_and_b32 s21, s52, 3
  s_mul_i32 s56, s21, 122880
  s_add_u32 s21, s52, 1
  s_and_b32 s21, s21, 3
  s_mul_i32 s55, s21, 122880
  s_add_u32 s55, s55, s75
  s_add_u32 s21, s52, 2
  s_and_b32 s21, s21, 3
  s_mul_i32 s57, s21, 122880
  s_add_u32 s21, s52, 3
  s_and_b32 s21, s21, 3
  s_mul_i32 s59, s21, 122880
  s_add_u32 s59, s59, s75
  s_bfe_u32 s61, s52, 0x10001
  s_and_b32 s21, s52, 1
  s_lshl_b32 s60, s21, 19
  s_mov_b32 s54, 0
  s_sleep 3
  s_nop 2
  buffer_load_dwordx4 v[60:63], v190, s[8:11], s58 offen offset:0 sc1
  buffer_load_dwordx4 v[64:67], v190, s[8:11], s58 offen offset:1024 sc1
  buffer_load_dwordx4 v[68:71], v190, s[8:11], s58 offen offset:2048 sc1
  s_branch top_134
mr_135:
  s_mov_b64 exec, s[22:23]
  s_cbranch_execz ms_149
  buffer_load_dwordx4 v[60:63], v190, s[8:11], s58 offen offset:0 sc1
ms_149:
  s_mov_b64 exec, s[98:99]
  s_cbranch_execz ms_150
  buffer_load_dwordx4 v[64:67], v190, s[8:11], s58 offen offset:1024 sc1
ms_150:
  s_mov_b64 exec, s[100:101]
  s_cbranch_execz ms_151
  buffer_load_dwordx4 v[68:71], v190, s[8:11], s58 offen offset:2048 sc1
ms_151:
  s_add_u32 s54, s54, 1
  s_cmp_gt_u32 s54, 131072
  s_cbranch_scc1 end0
  s_waitcnt vmcnt(0)
  s_mov_b64 exec, s[22:23]
  ds_write_b128 v190, v[60:63] offset:0
  v_cmp_eq_u32 s[22:23], -1, v60
  s_mov_b64 exec, s[98:99]
  ds_write_b128 v190, v[64:67] offset:1024
  v_cmp_eq_u32 s[98:99], -1, v64
  s_mov_b64 exec, s[100:101]
  ds_write_b128 v190, v[68:71] offset:2048
  v_cmp_eq_u32 s[100:101], -1, v68
  s_mov_b64 exec, -1
  s_or_b64 vcc, s[22:23], s[98:99]
  s_or_b64 vcc, vcc, s[100:101]
  s_cbranch_scc1 mr_135
  s_branch mo_139
mn_136:
  v_max3_u32 v27, v48, v49, v50
  v_max3_u32 v27, v27, v51, v52
  v_max3_u32 v27, v27, v53, v54
  v_max3_u32 v27, v27, v55, v56
  v_max3_u32 v27, v27, v57, v58
  v_max3_u32 v27, v27, v59, v60
  v_max3_u32 v27, v27, v61, v62
  v_max3_u32 v27, v27, v63, v64
  v_max3_u32 v27, v27, v65, v66
  v_max3_u32 v27, v27, v67, v68
  v_max3_u32 v27, v27, v69, v70
  v_max3_u32 v27, v27, v71, v72
  v_max3_u32 v27, v27, v73, v74
  v_max3_u32 v27, v27, v75, v76
  v_max3_u32 v27, v27, v77, v78
  v_max3_u32 v27, v27, v79, v80
  v_max3_u32 v27, v27, v81, v82
  v_max3_u32 v27, v27, v83, v84
  v_max3_u32 v27, v27, v85, v86
  v_max3_u32 v27, v27, v87, v87
  v_cmp_eq_u32 vcc, -1, v27
  s_cmp_eq_u32 s52, 0
  s_cbranch_scc1 mk_137
  s_cbranch_vccz mk_137
  s_waitcnt lgkmcnt(0)
  s_barrier
  s_nop 7
  v_mov_b32 v88, 0
  v_mov_b32 v89, 0
  v_mov_b32 v90, 0
  v_mov_b32 v91, 0
  v_mov_b32 v92, 0
  v_mov_b32 v93, 0
  v_mov_b32 v94, 0
  v_mov_b32 v95, 0
  v_mov_b32 v96, 0
  v_mov_b32 v97, 0
  v_mov_b32 v98, 0
  v_mov_b32 v99, 0
  v_mov_b32 v100, 0
  v_mov_b32 v101, 0
  v_mov_b32 v102, 0
  v_mov_b32 v103, 0
  s_mov_b64 s[22:23], -1
  s_mov_b64 s[98:99], -1
  s_mov_b64 s[100:101], -1
  s_branch mr_135
sr_140:
  s_mov_b32 s54, 0
sr_152:
  s_mov_b64 exec, vcc
  buffer_load_dwordx4 v[124:127], v9, s[8:11], s56 offen sc1
  buffer_load_dwordx4 v[128:131], v9, s[8:11], s56 offen offset:1024 sc1
  buffer_load_dwordx4 v[132:135], v10, s[8:11], s56 offen sc1
  s_mov_b64 exec, -1
  s_add_u32 s54, s54, 1
  s_cmp_gt_u32 s54, 131072
  s_cbranch_scc1 end0
  s_and_b32 s21, s54, 31
  s_cbranch_scc0 sr_153
  s_waitcnt vmcnt(0)
  v_pk_add_f16 v172, v124, v126
  v_pk_add_f16 v173, v125, v127
  v_pk_add_f16 v174, v128, v130
  v_pk_add_f16 v175, v129, v131
  v_fma_mix_f32 v166, v172, 1.0, v174 op_sel:[0,0,0] op_sel_hi:[1,0,1]
  v_fma_mix_f32 v168, v173, 1.0, v175 op_sel:[0,0,0] op_sel_hi:[1,0,1]
  v_pk_add_f16 v176, v132, v133
  v_pk_add_f16 v177, v134, v135
  v_add_f32 v27, v166, v168
  v_fma_mix_f32 v170, v176, 1.0, v177 op_sel:[0,0,0] op_sel_hi:[1,0,1]
  v_fma_mix_f32 v167, v172, 1.0, v174 op_sel:[1,0,1] op_sel_hi:[1,0,1]
  v_cmp_u_f32 vcc, v27, v170
  v_fma_mix_f32 v169, v173, 1.0, v175 op_sel:[1,0,1] op_sel_hi:[1,0,1]
  v_fma_mix_f32 v171, v176, 1.0, v177 op_sel:[1,0,1] op_sel_hi:[1,0,1]
  s_cbranch_vccnz sr_152
  s_branch sj_141
sr_153:
  s_waitcnt vmcnt(0)
  v_pk_add_f16 v172, v124, v126
  v_pk_add_f16 v173, v125, v127
  v_pk_add_f16 v174, v128, v130
  v_pk_add_f16 v175, v129, v131
  v_fma_mix_f32 v166, v172, 1.0, v174 op_sel:[0,0,0] op_sel_hi:[1,0,1]
  v_fma_mix_f32 v168, v173, 1.0, v175 op_sel:[0,0,0] op_sel_hi:[1,0,1]
  v_pk_add_f16 v176, v132, v133
  v_pk_add_f16 v177, v134, v135
  v_add_f32 v27, v166, v168
  v_fma_mix_f32 v170, v176, 1.0, v177 op_sel:[0,0,0] op_sel_hi:[1,0,1]
  v_fma_mix_f32 v167, v172, 1.0, v174 op_sel:[1,0,1] op_sel_hi:[1,0,1]
  v_cmp_u_f32 vcc, v27, v170
  v_fma_mix_f32 v169, v173, 1.0, v175 op_sel:[1,0,1] op_sel_hi:[1,0,1]
  v_fma_mix_f32 v171, v176, 1.0, v177 op_sel:[1,0,1] op_sel_hi:[1,0,1]
  v_max3_u32 v27, v124, v126, v128
  v_max3_u32 v27, v27, v130, v132
  v_max3_u32 v27, v27, v133, v134
  v_max3_u32 v27, v27, v135, v135
  v_cmp_eq_u32 vcc, -1, v27
  s_nop 1
  s_cbranch_vccnz sr_152
  s_branch sj_141
fx_143:
  s_cmp_eq_u32 s81, 1
  s_cbranch_scc1 fk_144
  s_mov_b32 s81, 1
  v_max3_f32 v164, v166, v167, v168
  v_max3_f32 v165, v169, v170, v171
  v_max_f32 v164, v164, v165
  s_nop 1
  v_max_f32_dpp v164, v164, v164 row_ror:8 row_mask:0xf bank_mask:0xf
  v_mov_b32 v165, v164
  s_nop 1
  v_permlane32_swap_b32 v164, v165
  v_max_f32 v164, v164, v165
  v_mov_b32 v165, v164
  s_nop 1
  v_permlane16_swap_b32 v164, v165
  v_max_f32 v164, v164, v165
  v_sub_f32 v166, v166, v164
  v_sub_f32 v167, v167, v164
  v_sub_f32 v168, v168, v164
  v_sub_f32 v169, v169, v164
  v_sub_f32 v170, v170, v164
  v_sub_f32 v171, v171, v164
  s_branch ex_142
p2_148:
  buffer_load_dwordx4 v[68:71], v16, s[4:7], s60 offen sc1
  s_waitcnt vmcnt(1)
  v_mfma_f32_16x16x32_f16 v[120:123], v[44:47], v[72:75], 0
  v_bitop3_b32 v27, v72, s61, 1 bitop3:0x28
  v_cmp_ne_u32 vcc, 0, v27
  s_nop 1
  s_cbranch_vccz pg_147
  buffer_load_dwordx4 v[72:75], v16, s[4:7], s60 offen sc1
  s_add_u32 s54, s54, 1
  s_cmp_gt_u32 s54, 131072
  s_cbranch_scc1 end0
  s_branch pp_146
last_138:
  v_smfmac_f32_16x16x64_bf16 v[96:99], v[48:51], a[0:7], v22
  v_smfmac_f32_16x16x64_bf16 v[100:103], v[48:51], a[80:87], v22
  v_smfmac_f32_16x16x64_bf16 v[96:99], v[52:55], a[8:15], v22
  v_smfmac_f32_16x16x64_bf16 v[100:103], v[52:55], a[88:95], v22
  v_smfmac_f32_16x16x64_bf16 v[96:99], v[56:59], a[16:23], v22
  v_smfmac_f32_16x16x64_bf16 v[100:103], v[56:59], a[96:103], v22
  v_smfmac_f32_16x16x64_bf16 v[96:99], v[60:63], a[24:31], v22
  v_smfmac_f32_16x16x64_bf16 v[96:99], v[64:67], a[32:39], v22
  v_smfmac_f32_16x16x64_bf16 v[96:99], v[68:71], a[40:47], v22
  v_smfmac_f32_16x16x64_bf16 v[96:99], v[72:75], a[48:55], v22
  v_smfmac_f32_16x16x64_bf16 v[96:99], v[76:79], a[56:63], v22
  v_smfmac_f32_16x16x64_bf16 v[96:99], v[80:83], a[64:71], v22
  v_smfmac_f32_16x16x64_bf16 v[96:99], v[84:87], a[72:79], v22
  v_smfmac_f32_16x16x64_bf16 v[100:103], v[60:63], a[104:111], v22
  v_smfmac_f32_16x16x64_bf16 v[100:103], v[64:67], a[112:119], v22
  v_smfmac_f32_16x16x64_bf16 v[100:103], v[68:71], a[120:127], v22
  v_smfmac_f32_16x16x64_bf16 v[100:103], v[72:75], a[128:135], v22
  v_smfmac_f32_16x16x64_bf16 v[100:103], v[76:79], a[136:143], v22
  v_smfmac_f32_16x16x64_bf16 v[100:103], v[80:83], a[144:151], v22
  v_smfmac_f32_16x16x64_bf16 v[100:103], v[84:87], a[152:159], v22
  s_nop 7
  v_permlane32_swap_b32 v96, v100
  v_permlane32_swap_b32 v97, v101
  v_permlane32_swap_b32 v98, v102
  v_permlane32_swap_b32 v99, v103
  v_pk_add_f32 v[96:97], v[96:97], v[100:101]
  v_pk_add_f32 v[98:99], v[98:99], v[102:103]
  v_cvt_pk_bf16_f32 v182, v96, v97
  v_cvt_pk_bf16_f32 v183, v98, v99
  v_min_u32 v182, -2, v182
  ds_write_b64 v26, v[182:183]
  s_waitcnt lgkmcnt(0)
  s_barrier
  s_branch chain_done
E_31:
  v_add_u32 v190, 6144, v4
  ds_read_b128 v[72:75], v4 offset:6144
  ds_read_b128 v[76:79], v4 offset:7168
  ds_read_b128 v[80:83], v4 offset:8192
  s_waitcnt lgkmcnt(0)
  s_branch mo_159
  .p2align 3
top_154:
  s_waitcnt vmcnt(2)
  ds_write_b128 v190, v[72:75] offset:0
  v_cmp_eq_u32 s[22:23], -1, v72
  s_waitcnt vmcnt(1)
  ds_write_b128 v190, v[76:79] offset:1024
  v_cmp_eq_u32 s[98:99], -1, v76
  s_waitcnt vmcnt(0)
  ds_write_b128 v190, v[80:83] offset:2048
  v_cmp_eq_u32 s[100:101], -1, v80
  s_or_b64 vcc, s[22:23], s[98:99]
  s_or_b64 vcc, vcc, s[100:101]
  s_cbranch_scc1 mr_155
mo_159:
  s_waitcnt lgkmcnt(0)
  s_barrier
  ds_read_b128 v[48:51], v4 offset:0
  ds_read_b128 v[52:55], v4 offset:1024
  v_smfmac_f32_16x16x64_bf16 v[92:95], v[72:75], v[224:231], v22
  ds_read_b128 v[56:59], v4 offset:2048
  v_smfmac_f32_16x16x64_bf16 v[88:91], v[72:75], a[208:215], v22
  ds_read_b128 v[60:63], v4 offset:3072
  v_smfmac_f32_16x16x64_bf16 v[92:95], v[76:79], v[232:239], v22
  ds_read_b128 v[64:67], v4 offset:4096
  v_smfmac_f32_16x16x64_bf16 v[88:91], v[76:79], a[216:223], v22
  ds_read_b128 v[68:71], v4 offset:5120
  v_smfmac_f32_16x16x64_bf16 v[92:95], v[80:83], v[240:247], v22
  ds_read_b128 v[84:87], v4 offset:9216
  v_smfmac_f32_16x16x64_bf16 v[88:91], v[80:83], a[224:231], v22
  s_waitcnt lgkmcnt(6)
  v_smfmac_f32_16x16x64_bf16 v[92:95], v[48:51], a[240:247], v22
  v_smfmac_f32_16x16x64_bf16 v[88:91], v[48:51], a[160:167], v22
  s_waitcnt lgkmcnt(5)
  v_smfmac_f32_16x16x64_bf16 v[92:95], v[52:55], a[248:255], v22
  s_waitcnt lgkmcnt(4)
  v_smfmac_f32_16x16x64_bf16 v[92:95], v[56:59], v[192:199], v22
  s_waitcnt lgkmcnt(3)
  v_smfmac_f32_16x16x64_bf16 v[92:95], v[60:63], v[200:207], v22
  s_waitcnt lgkmcnt(2)
  v_smfmac_f32_16x16x64_bf16 v[92:95], v[64:67], v[208:215], v22
  s_waitcnt lgkmcnt(1)
  v_smfmac_f32_16x16x64_bf16 v[92:95], v[68:71], v[216:223], v22
  s_waitcnt lgkmcnt(0)
  v_smfmac_f32_16x16x64_bf16 v[92:95], v[84:87], v[248:255], v22
  v_smfmac_f32_16x16x64_bf16 v[88:91], v[52:55], a[168:175], v22
  v_smfmac_f32_16x16x64_bf16 v[88:91], v[56:59], a[176:183], v22
  v_smfmac_f32_16x16x64_bf16 v[88:91], v[60:63], a[184:191], v22
  v_permlane32_swap_b32 v92, v93
  v_smfmac_f32_16x16x64_bf16 v[88:91], v[64:67], a[192:199], v22
  v_permlane32_swap_b32 v94, v95
  v_smfmac_f32_16x16x64_bf16 v[88:91], v[68:71], a[200:207], v22
  v_permlane32_swap_b32 v93, v92
  v_smfmac_f32_16x16x64_bf16 v[88:91], v[84:87], a[232:239], v22
  v_permlane32_swap_b32 v95, v94
  v_pk_mul_f32 v[120:121], v[92:93], v[24:25] op_sel:[1,0] op_sel_hi:[0,1]
  v_pk_mul_f32 v[122:123], v[94:95], v[24:25] op_sel:[1,0] op_sel_hi:[0,1]
  s_nop 4
  v_pk_fma_f32 v[88:89], v[88:89], v[24:25], v[120:121]
  v_pk_fma_f32 v[90:91], v[90:91], v[24:25], v[122:123]
  v_cvt_pk_bf16_f32 v120, v88, v89
  v_cvt_pk_bf16_f32 v121, v90, v91
  ds_write_b64 v6, v[120:121]
  v_cmp_u_f32 vcc, v88, v89
  v_cmp_u_f32 s[22:23], v90, v91
  s_nop 1
  s_or_b64 vcc, vcc, s[22:23]
  s_cbranch_vccnz mn_156
mk_157:
  s_waitcnt lgkmcnt(0)
  s_barrier
  ds_read_b64_tr_b16 v[104:105], v7 offset:0
  ds_read_b64_tr_b16 v[106:107], v7 offset:768
  ds_read_b64_tr_b16 v[108:109], v7 offset:1536
  ds_read_b64 v[140:141], v11
  s_cmp_eq_u32 s52, 63
  s_cbranch_scc1 last_158
  s_waitcnt lgkmcnt(2)
  v_mfma_f32_16x16x32_bf16 v[120:123], v[104:107], v[104:107], 0
  s_waitcnt lgkmcnt(1)
  v_mfma_f32_16x16x32_bf16 v[120:123], v[108:111], v[108:111], v[120:123]
  s_mov_b64 exec, s[64:65]
  s_nop 6
  v_cvt_pk_f16_f32 v120, v120, v121
  buffer_store_dword v120, v8, s[8:11], s56 offen sc1
  v_cvt_pk_f16_f32 v121, v122, v123
  buffer_store_dword v121, v8, s[8:11], s56 offen offset:128 sc1
  s_mov_b64 exec, -1
  s_sleep 3
  s_nop 1
  v_smfmac_f32_16x16x64_bf16 v[96:99], v[48:51], a[0:7], v22
  v_smfmac_f32_16x16x64_bf16 v[100:103], v[48:51], a[80:87], v22
  v_smfmac_f32_16x16x64_bf16 v[96:99], v[52:55], a[8:15], v22
  v_smfmac_f32_16x16x64_bf16 v[100:103], v[52:55], a[88:95], v22
  v_smfmac_f32_16x16x64_bf16 v[96:99], v[56:59], a[16:23], v22
  v_smfmac_f32_16x16x64_bf16 v[100:103], v[56:59], a[96:103], v22
  v_smfmac_f32_16x16x64_bf16 v[96:99], v[60:63], a[24:31], v22
  v_smfmac_f32_16x16x64_bf16 v[96:99], v[64:67], a[32:39], v22
  v_smfmac_f32_16x16x64_bf16 v[96:99], v[68:71], a[40:47], v22
  v_smfmac_f32_16x16x64_bf16 v[96:99], v[72:75], a[48:55], v22
  v_smfmac_f32_16x16x64_bf16 v[96:99], v[76:79], a[56:63], v22
  buffer_load_dwordx4 v[124:127], v9, s[8:11], s56 offen sc1
  v_smfmac_f32_16x16x64_bf16 v[96:99], v[80:83], a[64:71], v22
  buffer_load_dwordx4 v[128:131], v9, s[8:11], s56 offen offset:1024 sc1
  v_smfmac_f32_16x16x64_bf16 v[96:99], v[84:87], a[72:79], v22
  buffer_load_dwordx4 v[132:135], v10, s[8:11], s56 offen sc1
  v_smfmac_f32_16x16x64_bf16 v[100:103], v[60:63], a[104:111], v22
  v_smfmac_f32_16x16x64_bf16 v[100:103], v[64:67], a[112:119], v22
  v_smfmac_f32_16x16x64_bf16 v[100:103], v[68:71], a[120:127], v22
  v_smfmac_f32_16x16x64_bf16 v[100:103], v[72:75], a[128:135], v22
  v_cvt_pk_bf16_f32 v136, v96, v97
  v_smfmac_f32_16x16x64_bf16 v[100:103], v[76:79], a[136:143], v22
  v_cvt_pk_bf16_f32 v137, v98, v99
  v_smfmac_f32_16x16x64_bf16 v[100:103], v[80:83], a[144:151], v22
  v_smfmac_f32_16x16x64_bf16 v[100:103], v[84:87], a[152:159], v22
  s_waitcnt vmcnt(2)
  v_pk_add_f16 v172, v124, v126
  v_pk_add_f16 v173, v125, v127
  s_waitcnt vmcnt(1)
  v_pk_add_f16 v174, v128, v130
  v_pk_add_f16 v175, v129, v131
  v_fma_mix_f32 v166, v172, 1.0, v174 op_sel:[0,0,0] op_sel_hi:[1,0,1]
  v_fma_mix_f32 v168, v173, 1.0, v175 op_sel:[0,0,0] op_sel_hi:[1,0,1]
  s_waitcnt vmcnt(0)
  v_pk_add_f16 v176, v132, v133
  v_pk_add_f16 v177, v134, v135
  v_fma_mix_f32 v170, v176, 1.0, v177 op_sel:[0,0,0] op_sel_hi:[1,0,1]
  v_fma_mix_f32 v167, v172, 1.0, v174 op_sel:[1,0,1] op_sel_hi:[1,0,1]
  v_cmp_u_f32 vcc, v166, v170
  v_fma_mix_f32 v169, v173, 1.0, v175 op_sel:[1,0,1] op_sel_hi:[1,0,1]
  v_fma_mix_f32 v171, v176, 1.0, v177 op_sel:[1,0,1] op_sel_hi:[1,0,1]
  v_cvt_pk_bf16_f32 v138, v100, v101
  s_cbranch_vccnz sr_160
sj_161:
ex_162:
  v_exp_f32 v172, v166
  v_exp_f32 v173, v167
  v_exp_f32 v174, v168
  v_cvt_pk_bf16_f32 v156, v172, v173
  v_exp_f32 v175, v169
  v_exp_f32 v176, v170
  v_cvt_pk_bf16_f32 v157, v174, v175
  v_mov_b32_dpp v158, v156 row_ror:8 row_mask:0xf bank_mask:0xf
  v_exp_f32 v177, v171
  v_mov_b32_dpp v159, v157 row_ror:8 row_mask:0xf bank_mask:0xf
  v_cvt_pk_bf16_f32 v160, v176, v177
  v_cvt_pk_bf16_f32 v139, v102, v103
  v_mfma_f32_16x16x32_bf16 v[178:181], v[152:155], v[156:159], 0
  s_waitcnt lgkmcnt(0)
  v_mov_b32_dpp v161, v160 row_ror:8 row_mask:0xf bank_mask:0xf
  v_mfma_f32_16x16x32_bf16 v[182:185], v[144:147], v[156:159], 0
  s_nop 0
  v_mfma_f32_16x16x32_bf16 v[178:181], v[140:143], v[160:163], v[178:181]
  v_mfma_f32_16x16x32_bf16 v[182:185], v[136:139], v[160:163], v[182:185]
  v_mfma_f32_16x16x32_bf16 v[186:189], v[148:151], v[156:159], 0
  v_mfma_f32_16x16x32_bf16 v[186:189], v[138:141], v[160:163], v[186:189]
  s_mov_b64 exec, s[62:63]
  v_rcp_f32 v164, v180
  s_nop 0
  v_pk_mul_f32 v[178:179], v[178:179], v[164:165] op_sel_hi:[1,0]
  v_pk_mul_f32 v[182:183], v[182:183], v[164:165] op_sel_hi:[1,0]
  v_pk_mul_f32 v[184:185], v[184:185], v[164:165] op_sel_hi:[1,0]
  v_cvt_pk_f16_f32 v64, v178, v179
  v_cvt_pk_f16_f32 v60, v182, v183
  v_pk_mul_f32 v[186:187], v[186:187], v[164:165] op_sel_hi:[1,0]
  v_pk_mul_f32 v[188:189], v[188:189], v[164:165] op_sel_hi:[1,0]
  v_cvt_pk_f16_f32 v61, v184, v185
  v_cvt_pk_f16_f32 v62, v186, v187
  v_cvt_pk_f16_f32 v63, v188, v189
  ds_write_b128 v13, v[60:63]
  ds_write_b32 v14, v64
  v_add_f32 v165, v164, v180
  v_cmp_ngt_f32 vcc, s80, v165
  s_mov_b64 exec, -1
  s_nop 0
  s_cbranch_vccnz fx_163
fk_164:
  s_waitcnt lgkmcnt(0)
  s_barrier
  s_add_u32 m0, s74, 0
  s_add_u32 s21, s79, 0
  buffer_load_dwordx4 v4, s[28:31], s21 offen sc1 lds
  s_add_u32 m0, s74, 3072
  s_add_u32 s21, s79, 41984
  buffer_load_dwordx4 v4, s[28:31], s21 offen sc1 lds
  s_add_u32 m0, s74, 6144
  s_add_u32 s21, s79, 122880
  buffer_load_dwordx4 v4, s[28:31], s21 offen sc1 lds
  s_add_u32 s72, s72, 1310720
  s_add_u32 s79, s79, 1310720
  s_add_u32 s73, s73, 393216
  s_xor_b32 s74, s74, 16384
  s_nop 15
  s_nop 3
  v_permlane32_swap_b32 v96, v100
  v_permlane32_swap_b32 v97, v101
  v_permlane32_swap_b32 v98, v102
  v_permlane32_swap_b32 v99, v103
  v_pk_add_f32 v[96:97], v[96:97], v[100:101]
  v_pk_add_f32 v[98:99], v[98:99], v[102:103]
  v_cvt_pk_bf16_f32 v182, v96, v97
  v_cvt_pk_bf16_f32 v183, v98, v99
  v_min_u32 v182, -2, v182
  ds_write_b64 v26, v[182:183]
  ds_read_b128 v[144:147], v18
  ds_read_b128 v[148:151], v18 offset:1024
  ds_read_b128 v[152:155], v19
  v_xor_b32 v18, 16384, v18
  v_xor_b32 v19, 16384, v19
  v_mov_b32 v88, 0
  v_mov_b32 v89, 0
  v_mov_b32 v90, 0
  v_mov_b32 v91, 0
  v_mov_b32 v92, 0
  v_mov_b32 v93, 0
  v_mov_b32 v94, 0
  v_mov_b32 v95, 0
  v_mov_b32 v96, 0
  v_mov_b32 v97, 0
  v_mov_b32 v98, 0
  v_mov_b32 v99, 0
  v_mov_b32 v100, 0
  v_mov_b32 v101, 0
  v_mov_b32 v102, 0
  v_mov_b32 v103, 0
  s_mov_b32 s81, 0
  s_waitcnt lgkmcnt(0)
  s_barrier
  s_mov_b64 exec, s[64:65]
  buffer_store_dword v28, v8, s[8:11], s57 offen sc1
  buffer_store_dword v28, v8, s[8:11], s57 offen offset:128 sc1
  s_mov_b64 exec, -1
  s_cmp_eq_u32 s78, 0
  s_cbranch_scc1 nt_165
  s_mov_b64 exec, s[62:63]
  buffer_store_dword v28, v17, s[8:11], s59 offen sc1
  s_mov_b64 exec, -1
  s_sleep 6
  s_nop 3
  buffer_load_dwordx4 v[68:71], v16, s[4:7], s60 offen sc1
  s_sleep 3
  s_nop 1
  buffer_load_dwordx4 v[72:75], v16, s[4:7], s60 offen sc1
  s_mov_b32 s54, 0
pp_166:
  s_waitcnt vmcnt(1)
  v_mfma_f32_16x16x32_f16 v[120:123], v[44:47], v[68:71], 0
  v_bitop3_b32 v27, v68, s61, 1 bitop3:0x28
  v_cmp_ne_u32 vcc, 0, v27
  s_nop 1
  s_cbranch_vccnz p2_168
  s_nop 2
pg_167:
  v_add_f32_dpp v120, v120, v120 row_ror:8 row_mask:0xf bank_mask:0xf
  v_add_f32_dpp v121, v121, v121 row_ror:8 row_mask:0xf bank_mask:0xf
  s_mov_b64 exec, s[62:63]
  v_cvt_pk_bf16_f32 v120, v120, v121
  v_min_u32 v120, -2, v120
  buffer_store_dword v120, v17, s[8:11], s55 offen sc1
  s_mov_b64 exec, -1
nt_165:
  s_barrier
  s_mov_b32 s58, s55
  s_add_u32 s52, s52, 1
  s_and_b32 s21, s52, 3
  s_mul_i32 s56, s21, 122880
  s_add_u32 s21, s52, 1
  s_and_b32 s21, s21, 3
  s_mul_i32 s55, s21, 122880
  s_add_u32 s55, s55, s75
  s_add_u32 s21, s52, 2
  s_and_b32 s21, s21, 3
  s_mul_i32 s57, s21, 122880
  s_add_u32 s21, s52, 3
  s_and_b32 s21, s21, 3
  s_mul_i32 s59, s21, 122880
  s_add_u32 s59, s59, s75
  s_bfe_u32 s61, s52, 0x10001
  s_and_b32 s21, s52, 1
  s_lshl_b32 s60, s21, 19
  s_mov_b32 s54, 0
  s_sleep 3
  s_nop 2
  buffer_load_dwordx4 v[72:75], v190, s[8:11], s58 offen offset:0 sc1
  buffer_load_dwordx4 v[76:79], v190, s[8:11], s58 offen offset:1024 sc1
  buffer_load_dwordx4 v[80:83], v190, s[8:11], s58 offen offset:2048 sc1
  s_branch top_154
mr_155:
  s_mov_b64 exec, s[22:23]
  s_cbranch_execz ms_169
  buffer_load_dwordx4 v[72:75], v190, s[8:11], s58 offen offset:0 sc1
ms_169:
  s_mov_b64 exec, s[98:99]
  s_cbranch_execz ms_170
  buffer_load_dwordx4 v[76:79], v190, s[8:11], s58 offen offset:1024 sc1
ms_170:
  s_mov_b64 exec, s[100:101]
  s_cbranch_execz ms_171
  buffer_load_dwordx4 v[80:83], v190, s[8:11], s58 offen offset:2048 sc1
ms_171:
  s_add_u32 s54, s54, 1
  s_cmp_gt_u32 s54, 131072
  s_cbranch_scc1 end0
  s_waitcnt vmcnt(0)
  s_mov_b64 exec, s[22:23]
  ds_write_b128 v190, v[72:75] offset:0
  v_cmp_eq_u32 s[22:23], -1, v72
  s_mov_b64 exec, s[98:99]
  ds_write_b128 v190, v[76:79] offset:1024
  v_cmp_eq_u32 s[98:99], -1, v76
  s_mov_b64 exec, s[100:101]
  ds_write_b128 v190, v[80:83] offset:2048
  v_cmp_eq_u32 s[100:101], -1, v80
  s_mov_b64 exec, -1
  s_or_b64 vcc, s[22:23], s[98:99]
  s_or_b64 vcc, vcc, s[100:101]
  s_cbranch_scc1 mr_155
  s_branch mo_159
mn_156:
  v_max3_u32 v27, v48, v49, v50
  v_max3_u32 v27, v27, v51, v52
  v_max3_u32 v27, v27, v53, v54
  v_max3_u32 v27, v27, v55, v56
  v_max3_u32 v27, v27, v57, v58
  v_max3_u32 v27, v27, v59, v60
  v_max3_u32 v27, v27, v61, v62
  v_max3_u32 v27, v27, v63, v64
  v_max3_u32 v27, v27, v65, v66
  v_max3_u32 v27, v27, v67, v68
  v_max3_u32 v27, v27, v69, v70
  v_max3_u32 v27, v27, v71, v72
  v_max3_u32 v27, v27, v73, v74
  v_max3_u32 v27, v27, v75, v76
  v_max3_u32 v27, v27, v77, v78
  v_max3_u32 v27, v27, v79, v80
  v_max3_u32 v27, v27, v81, v82
  v_max3_u32 v27, v27, v83, v84
  v_max3_u32 v27, v27, v85, v86
  v_max3_u32 v27, v27, v87, v87
  v_cmp_eq_u32 vcc, -1, v27
  s_cmp_eq_u32 s52, 0
  s_cbranch_scc1 mk_157
  s_cbranch_vccz mk_157
  s_waitcnt lgkmcnt(0)
  s_barrier
  s_nop 7
  v_mov_b32 v88, 0
  v_mov_b32 v89, 0
  v_mov_b32 v90, 0
  v_mov_b32 v91, 0
  v_mov_b32 v92, 0
  v_mov_b32 v93, 0
  v_mov_b32 v94, 0
  v_mov_b32 v95, 0
  v_mov_b32 v96, 0
  v_mov_b32 v97, 0
  v_mov_b32 v98, 0
  v_mov_b32 v99, 0
  v_mov_b32 v100, 0
  v_mov_b32 v101, 0
  v_mov_b32 v102, 0
  v_mov_b32 v103, 0
  s_mov_b64 s[22:23], -1
  s_mov_b64 s[98:99], -1
  s_mov_b64 s[100:101], -1
  s_branch mr_155
sr_160:
  s_mov_b32 s54, 0
sr_172:
  s_mov_b64 exec, vcc
  buffer_load_dwordx4 v[124:127], v9, s[8:11], s56 offen sc1
  buffer_load_dwordx4 v[128:131], v9, s[8:11], s56 offen offset:1024 sc1
  buffer_load_dwordx4 v[132:135], v10, s[8:11], s56 offen sc1
  s_mov_b64 exec, -1
  s_add_u32 s54, s54, 1
  s_cmp_gt_u32 s54, 131072
  s_cbranch_scc1 end0
  s_and_b32 s21, s54, 31
  s_cbranch_scc0 sr_173
  s_waitcnt vmcnt(0)
  v_pk_add_f16 v172, v124, v126
  v_pk_add_f16 v173, v125, v127
  v_pk_add_f16 v174, v128, v130
  v_pk_add_f16 v175, v129, v131
  v_fma_mix_f32 v166, v172, 1.0, v174 op_sel:[0,0,0] op_sel_hi:[1,0,1]
  v_fma_mix_f32 v168, v173, 1.0, v175 op_sel:[0,0,0] op_sel_hi:[1,0,1]
  v_pk_add_f16 v176, v132, v133
  v_pk_add_f16 v177, v134, v135
  v_add_f32 v27, v166, v168
  v_fma_mix_f32 v170, v176, 1.0, v177 op_sel:[0,0,0] op_sel_hi:[1,0,1]
  v_fma_mix_f32 v167, v172, 1.0, v174 op_sel:[1,0,1] op_sel_hi:[1,0,1]
  v_cmp_u_f32 vcc, v27, v170
  v_fma_mix_f32 v169, v173, 1.0, v175 op_sel:[1,0,1] op_sel_hi:[1,0,1]
  v_fma_mix_f32 v171, v176, 1.0, v177 op_sel:[1,0,1] op_sel_hi:[1,0,1]
  s_cbranch_vccnz sr_172
  s_branch sj_161
sr_173:
  s_waitcnt vmcnt(0)
  v_pk_add_f16 v172, v124, v126
  v_pk_add_f16 v173, v125, v127
  v_pk_add_f16 v174, v128, v130
  v_pk_add_f16 v175, v129, v131
  v_fma_mix_f32 v166, v172, 1.0, v174 op_sel:[0,0,0] op_sel_hi:[1,0,1]
  v_fma_mix_f32 v168, v173, 1.0, v175 op_sel:[0,0,0] op_sel_hi:[1,0,1]
  v_pk_add_f16 v176, v132, v133
  v_pk_add_f16 v177, v134, v135
  v_add_f32 v27, v166, v168
  v_fma_mix_f32 v170, v176, 1.0, v177 op_sel:[0,0,0] op_sel_hi:[1,0,1]
  v_fma_mix_f32 v167, v172, 1.0, v174 op_sel:[1,0,1] op_sel_hi:[1,0,1]
  v_cmp_u_f32 vcc, v27, v170
  v_fma_mix_f32 v169, v173, 1.0, v175 op_sel:[1,0,1] op_sel_hi:[1,0,1]
  v_fma_mix_f32 v171, v176, 1.0, v177 op_sel:[1,0,1] op_sel_hi:[1,0,1]
  v_max3_u32 v27, v124, v126, v128
  v_max3_u32 v27, v27, v130, v132
  v_max3_u32 v27, v27, v133, v134
  v_max3_u32 v27, v27, v135, v135
  v_cmp_eq_u32 vcc, -1, v27
  s_nop 1
  s_cbranch_vccnz sr_172
  s_branch sj_161
fx_163:
  s_cmp_eq_u32 s81, 1
  s_cbranch_scc1 fk_164
  s_mov_b32 s81, 1
  v_max3_f32 v164, v166, v167, v168
  v_max3_f32 v165, v169, v170, v171
  v_max_f32 v164, v164, v165
  s_nop 1
  v_max_f32_dpp v164, v164, v164 row_ror:8 row_mask:0xf bank_mask:0xf
  v_mov_b32 v165, v164
  s_nop 1
  v_permlane32_swap_b32 v164, v165
  v_max_f32 v164, v164, v165
  v_mov_b32 v165, v164
  s_nop 1
  v_permlane16_swap_b32 v164, v165
  v_max_f32 v164, v164, v165
  v_sub_f32 v166, v166, v164
  v_sub_f32 v167, v167, v164
  v_sub_f32 v168, v168, v164
  v_sub_f32 v169, v169, v164
  v_sub_f32 v170, v170, v164
  v_sub_f32 v171, v171, v164
  s_branch ex_162
p2_168:
  buffer_load_dwordx4 v[68:71], v16, s[4:7], s60 offen sc1
  s_waitcnt vmcnt(1)
  v_mfma_f32_16x16x32_f16 v[120:123], v[44:47], v[72:75], 0
  v_bitop3_b32 v27, v72, s61, 1 bitop3:0x28
  v_cmp_ne_u32 vcc, 0, v27
  s_nop 1
  s_cbranch_vccz pg_167
  buffer_load_dwordx4 v[72:75], v16, s[4:7], s60 offen sc1
  s_add_u32 s54, s54, 1
  s_cmp_gt_u32 s54, 131072
  s_cbranch_scc1 end0
  s_branch pp_166
last_158:
  v_smfmac_f32_16x16x64_bf16 v[96:99], v[48:51], a[0:7], v22
  v_smfmac_f32_16x16x64_bf16 v[100:103], v[48:51], a[80:87], v22
  v_smfmac_f32_16x16x64_bf16 v[96:99], v[52:55], a[8:15], v22
  v_smfmac_f32_16x16x64_bf16 v[100:103], v[52:55], a[88:95], v22
  v_smfmac_f32_16x16x64_bf16 v[96:99], v[56:59], a[16:23], v22
  v_smfmac_f32_16x16x64_bf16 v[100:103], v[56:59], a[96:103], v22
  v_smfmac_f32_16x16x64_bf16 v[96:99], v[60:63], a[24:31], v22
  v_smfmac_f32_16x16x64_bf16 v[96:99], v[64:67], a[32:39], v22
  v_smfmac_f32_16x16x64_bf16 v[96:99], v[68:71], a[40:47], v22
  v_smfmac_f32_16x16x64_bf16 v[96:99], v[72:75], a[48:55], v22
  v_smfmac_f32_16x16x64_bf16 v[96:99], v[76:79], a[56:63], v22
  v_smfmac_f32_16x16x64_bf16 v[96:99], v[80:83], a[64:71], v22
  v_smfmac_f32_16x16x64_bf16 v[96:99], v[84:87], a[72:79], v22
  v_smfmac_f32_16x16x64_bf16 v[100:103], v[60:63], a[104:111], v22
  v_smfmac_f32_16x16x64_bf16 v[100:103], v[64:67], a[112:119], v22
  v_smfmac_f32_16x16x64_bf16 v[100:103], v[68:71], a[120:127], v22
  v_smfmac_f32_16x16x64_bf16 v[100:103], v[72:75], a[128:135], v22
  v_smfmac_f32_16x16x64_bf16 v[100:103], v[76:79], a[136:143], v22
  v_smfmac_f32_16x16x64_bf16 v[100:103], v[80:83], a[144:151], v22
  v_smfmac_f32_16x16x64_bf16 v[100:103], v[84:87], a[152:159], v22
  s_nop 7
  v_permlane32_swap_b32 v96, v100
  v_permlane32_swap_b32 v97, v101
  v_permlane32_swap_b32 v98, v102
  v_permlane32_swap_b32 v99, v103
  v_pk_add_f32 v[96:97], v[96:97], v[100:101]
  v_pk_add_f32 v[98:99], v[98:99], v[102:103]
  v_cvt_pk_bf16_f32 v182, v96, v97
  v_cvt_pk_bf16_f32 v183, v98, v99
  v_min_u32 v182, -2, v182
  ds_write_b64 v26, v[182:183]
  s_waitcnt lgkmcnt(0)
  s_barrier
  s_branch chain_done
E_33:
  v_add_u32 v190, 9216, v4
  ds_read_b128 v[84:87], v4 offset:9216
  s_waitcnt lgkmcnt(0)
  s_branch mo_179
  .p2align 3
top_174:
  s_waitcnt vmcnt(0)
  ds_write_b128 v190, v[84:87] offset:0
  v_cmp_eq_u32 s[22:23], -1, v84
  s_or_b64 vcc, s[22:23], s[22:23]
  s_cbranch_scc1 mr_175
mo_179:
  s_waitcnt lgkmcnt(0)
  s_barrier
  ds_read_b128 v[48:51], v4 offset:0
  ds_read_b128 v[52:55], v4 offset:1024
  v_smfmac_f32_16x16x64_bf16 v[92:95], v[84:87], v[248:255], v22
  ds_read_b128 v[56:59], v4 offset:2048
  v_smfmac_f32_16x16x64_bf16 v[88:91], v[84:87], a[232:239], v22
  s_waitcnt lgkmcnt(2)
  ds_read_b128 v[60:63], v4 offset:3072
  v_smfmac_f32_16x16x64_bf16 v[92:95], v[48:51], a[240:247], v22
  ds_read_b128 v[64:67], v4 offset:4096
  v_smfmac_f32_16x16x64_bf16 v[88:91], v[48:51], a[160:167], v22
  s_waitcnt lgkmcnt(3)
  ds_read_b128 v[68:71], v4 offset:5120
  v_smfmac_f32_16x16x64_bf16 v[92:95], v[52:55], a[248:255], v22
  ds_read_b128 v[72:75], v4 offset:6144
  v_smfmac_f32_16x16x64_bf16 v[88:91], v[52:55], a[168:175], v22
  s_waitcnt lgkmcnt(4)
  ds_read_b128 v[76:79], v4 offset:7168
  v_smfmac_f32_16x16x64_bf16 v[92:95], v[56:59], v[192:199], v22
  ds_read_b128 v[80:83], v4 offset:8192
  v_smfmac_f32_16x16x64_bf16 v[88:91], v[56:59], a[176:183], v22
  s_waitcnt lgkmcnt(5)
  s_add_u32 m0, s74, 10240
  s_nop 0
  buffer_load_dwordx4 v4, s[16:19], s73 offen offset:0 sc1 lds
  v_smfmac_f32_16x16x64_bf16 v[92:95], v[60:63], v[200:207], v22
  s_waitcnt lgkmcnt(4)
  s_add_u32 m0, s74, 10240
  s_nop 0
  buffer_load_dwordx4 v4, s[16:19], s73 offen offset:1024 sc1 lds
  v_smfmac_f32_16x16x64_bf16 v[92:95], v[64:67], v[208:215], v22
  s_waitcnt lgkmcnt(3)
  s_add_u32 m0, s74, 10240
  s_nop 0
  buffer_load_dwordx4 v4, s[16:19], s73 offen offset:2048 sc1 lds
  v_smfmac_f32_16x16x64_bf16 v[92:95], v[68:71], v[216:223], v22
  s_waitcnt lgkmcnt(2)
  v_smfmac_f32_16x16x64_bf16 v[92:95], v[72:75], v[224:231], v22
  s_waitcnt lgkmcnt(1)
  v_smfmac_f32_16x16x64_bf16 v[92:95], v[76:79], v[232:239], v22
  s_waitcnt lgkmcnt(0)
  v_smfmac_f32_16x16x64_bf16 v[92:95], v[80:83], v[240:247], v22
  v_smfmac_f32_16x16x64_bf16 v[88:91], v[60:63], a[184:191], v22
  v_smfmac_f32_16x16x64_bf16 v[88:91], v[64:67], a[192:199], v22
  v_smfmac_f32_16x16x64_bf16 v[88:91], v[68:71], a[200:207], v22
  v_cvt_pk_bf16_f32 v122, v92, v93
  v_smfmac_f32_16x16x64_bf16 v[88:91], v[72:75], a[208:215], v22
  v_cvt_pk_bf16_f32 v123, v94, v95
  v_smfmac_f32_16x16x64_bf16 v[88:91], v[76:79], a[216:223], v22
  ds_write_b64 v12, v[122:123] offset:13056
  v_smfmac_f32_16x16x64_bf16 v[88:91], v[80:83], a[224:231], v22
  v_smfmac_f32_16x16x64_bf16 v[96:99], v[48:51], a[0:7], v22
  v_smfmac_f32_16x16x64_bf16 v[100:103], v[48:51], a[80:87], v22
  v_smfmac_f32_16x16x64_bf16 v[96:99], v[52:55], a[8:15], v22
  v_cvt_pk_bf16_f32 v120, v88, v89
  v_cvt_pk_bf16_f32 v121, v90, v91
  ds_write_b64 v12, v[120:121] offset:12544
  v_smfmac_f32_16x16x64_bf16 v[100:103], v[52:55], a[88:95], v22
  v_cmp_u_f32 vcc, v88, v89
  v_smfmac_f32_16x16x64_bf16 v[96:99], v[56:59], a[16:23], v22
  v_cmp_u_f32 s[22:23], v90, v91
  s_nop 0
  s_or_b64 vcc, vcc, s[22:23]
  s_cbranch_vccnz mn_176
mk_177:
  s_waitcnt lgkmcnt(0)
  s_barrier
  ds_read_b64_tr_b16 v[104:105], v7 offset:0
  ds_read_b64_tr_b16 v[106:107], v7 offset:768
  ds_read_b64_tr_b16 v[108:109], v7 offset:1536
  ds_read_b64 v[140:141], v11
  s_cmp_eq_u32 s52, 63
  s_cbranch_scc1 last_178
  s_add_u32 s22, s52, 3
  s_min_u32 s22, s22, 64
  v_cmp_gt_u32 vcc, s22, v42
  s_nop 1
  s_cbranch_vccnz kw_180
kv_181:
  v_smfmac_f32_16x16x64_bf16 v[100:103], v[56:59], a[96:103], v22
  v_smfmac_f32_16x16x64_bf16 v[96:99], v[60:63], a[24:31], v22
  v_smfmac_f32_16x16x64_bf16 v[96:99], v[64:67], a[32:39], v22
  v_smfmac_f32_16x16x64_bf16 v[96:99], v[68:71], a[40:47], v22
  v_smfmac_f32_16x16x64_bf16 v[96:99], v[72:75], a[48:55], v22
  v_smfmac_f32_16x16x64_bf16 v[96:99], v[76:79], a[56:63], v22
  v_smfmac_f32_16x16x64_bf16 v[96:99], v[80:83], a[64:71], v22
  v_smfmac_f32_16x16x64_bf16 v[96:99], v[84:87], a[72:79], v22
  v_smfmac_f32_16x16x64_bf16 v[100:103], v[60:63], a[104:111], v22
  v_smfmac_f32_16x16x64_bf16 v[100:103], v[64:67], a[112:119], v22
  v_smfmac_f32_16x16x64_bf16 v[100:103], v[68:71], a[120:127], v22
  v_smfmac_f32_16x16x64_bf16 v[100:103], v[72:75], a[128:135], v22
  v_cvt_pk_bf16_f32 v136, v96, v97
  v_smfmac_f32_16x16x64_bf16 v[100:103], v[76:79], a[136:143], v22
  v_cvt_pk_bf16_f32 v137, v98, v99
  v_smfmac_f32_16x16x64_bf16 v[100:103], v[80:83], a[144:151], v22
  v_smfmac_f32_16x16x64_bf16 v[100:103], v[84:87], a[152:159], v22
  s_sleep 3
  s_nop 3
  buffer_load_dwordx4 v[124:127], v9, s[8:11], s56 offen sc1
  buffer_load_dwordx4 v[128:131], v9, s[8:11], s56 offen offset:1024 sc1
  s_nop 5
  buffer_load_dwordx4 v[132:135], v10, s[8:11], s56 offen sc1
  s_waitcnt vmcnt(2)
  v_pk_add_f16 v172, v124, v126
  v_pk_add_f16 v173, v125, v127
  s_waitcnt vmcnt(1)
  v_pk_add_f16 v174, v128, v130
  v_pk_add_f16 v175, v129, v131
  v_fma_mix_f32 v166, v172, 1.0, v174 op_sel:[0,0,0] op_sel_hi:[1,0,1]
  v_fma_mix_f32 v168, v173, 1.0, v175 op_sel:[0,0,0] op_sel_hi:[1,0,1]
  s_waitcnt vmcnt(0)
  v_pk_add_f16 v176, v132, v133
  v_pk_add_f16 v177, v134, v135
  v_fma_mix_f32 v170, v176, 1.0, v177 op_sel:[0,0,0] op_sel_hi:[1,0,1]
  v_fma_mix_f32 v167, v172, 1.0, v174 op_sel:[1,0,1] op_sel_hi:[1,0,1]
  v_cmp_u_f32 vcc, v166, v170
  v_fma_mix_f32 v169, v173, 1.0, v175 op_sel:[1,0,1] op_sel_hi:[1,0,1]
  v_fma_mix_f32 v171, v176, 1.0, v177 op_sel:[1,0,1] op_sel_hi:[1,0,1]
  v_cvt_pk_bf16_f32 v138, v100, v101
  s_cbranch_vccnz sr_182
sj_183:
ex_184:
  v_exp_f32 v172, v166
  v_exp_f32 v173, v167
  v_exp_f32 v174, v168
  v_cvt_pk_bf16_f32 v156, v172, v173
  v_exp_f32 v175, v169
  v_exp_f32 v176, v170
  v_cvt_pk_bf16_f32 v157, v174, v175
  v_mov_b32_dpp v158, v156 row_ror:8 row_mask:0xf bank_mask:0xf
  v_exp_f32 v177, v171
  v_mov_b32_dpp v159, v157 row_ror:8 row_mask:0xf bank_mask:0xf
  v_cvt_pk_bf16_f32 v160, v176, v177
  v_cvt_pk_bf16_f32 v139, v102, v103
  v_mfma_f32_16x16x32_bf16 v[178:181], v[152:155], v[156:159], 0
  s_waitcnt lgkmcnt(0)
  v_mov_b32_dpp v161, v160 row_ror:8 row_mask:0xf bank_mask:0xf
  v_mfma_f32_16x16x32_bf16 v[182:185], v[144:147], v[156:159], 0
  s_nop 0
  v_mfma_f32_16x16x32_bf16 v[178:181], v[140:143], v[160:163], v[178:181]
  v_mfma_f32_16x16x32_bf16 v[182:185], v[136:139], v[160:163], v[182:185]
  v_mfma_f32_16x16x32_bf16 v[186:189], v[148:151], v[156:159], 0
  v_mfma_f32_16x16x32_bf16 v[186:189], v[138:141], v[160:163], v[186:189]
  s_mov_b64 exec, s[62:63]
  v_rcp_f32 v164, v180
  s_nop 0
  v_pk_mul_f32 v[178:179], v[178:179], v[164:165] op_sel_hi:[1,0]
  v_pk_mul_f32 v[182:183], v[182:183], v[164:165] op_sel_hi:[1,0]
  v_pk_mul_f32 v[184:185], v[184:185], v[164:165] op_sel_hi:[1,0]
  v_cvt_pk_f16_f32 v64, v178, v179
  v_cvt_pk_f16_f32 v60, v182, v183
  v_pk_mul_f32 v[186:187], v[186:187], v[164:165] op_sel_hi:[1,0]
  v_pk_mul_f32 v[188:189], v[188:189], v[164:165] op_sel_hi:[1,0]
  v_cvt_pk_f16_f32 v61, v184, v185
  v_cvt_pk_f16_f32 v62, v186, v187
  v_cvt_pk_f16_f32 v63, v188, v189
  ds_write_b128 v13, v[60:63]
  ds_write_b32 v14, v64
  v_add_f32 v165, v164, v180
  v_cmp_ngt_f32 vcc, s80, v165
  s_mov_b64 exec, -1
  s_nop 0
  s_cbranch_vccnz fx_185
fk_186:
  s_waitcnt lgkmcnt(0)
  s_barrier
  ds_read_b128 v[166:169], v4 offset:13824
  ds_read_b128 v[170:173], v4 offset:14464
  ds_read_b128 v[174:177], v4 offset:15104
  ds_read_b128 v[178:181], v4 offset:15744
  s_mov_b64 exec, s[66:67]
  s_waitcnt lgkmcnt(2)
  v_pk_add_f16 v166, v166, v170
  v_pk_add_f16 v167, v167, v171
  v_pk_add_f16 v168, v168, v172
  v_pk_add_f16 v169, v169, v173
  s_waitcnt lgkmcnt(1)
  v_pk_add_f16 v166, v166, v174
  v_pk_add_f16 v167, v167, v175
  v_pk_add_f16 v168, v168, v176
  v_pk_add_f16 v169, v169, v177
  s_waitcnt lgkmcnt(0)
  v_pk_add_f16 v166, v166, v178
  v_pk_add_f16 v167, v167, v179
  v_pk_add_f16 v168, v168, v180
  v_pk_add_f16 v169, v169, v181
  v_and_or_b32 v166, v166, -2, s61
  buffer_store_dwordx4 v[166:169], v15, s[4:7], s60 offen sc1
  s_mov_b64 exec, -1
  v_permlane32_swap_b32 v96, v100
  v_permlane32_swap_b32 v97, v101
  v_permlane32_swap_b32 v98, v102
  v_permlane32_swap_b32 v99, v103
  v_pk_add_f32 v[96:97], v[96:97], v[100:101]
  v_pk_add_f32 v[98:99], v[98:99], v[102:103]
  v_cvt_pk_bf16_f32 v182, v96, v97
  v_cvt_pk_bf16_f32 v183, v98, v99
  v_min_u32 v182, -2, v182
  ds_write_b64 v26, v[182:183]
  v_permlane32_swap_b32 v88, v92
  v_permlane32_swap_b32 v89, v93
  v_permlane32_swap_b32 v90, v94
  v_permlane32_swap_b32 v91, v95
  v_pk_add_f32 v[88:89], v[88:89], v[92:93]
  v_pk_add_f32 v[90:91], v[90:91], v[94:95]
  v_cvt_pk_bf16_f32 v184, v88, v89
  v_cvt_pk_bf16_f32 v185, v90, v91
  v_min_u32 v184, -2, v184
  ds_write_b64 v43, v[184:185]
  ds_read_b128 v[144:147], v18
  ds_read_b128 v[148:151], v18 offset:1024
  ds_read_b128 v[152:155], v19
  v_xor_b32 v18, 16384, v18
  v_xor_b32 v19, 16384, v19
  v_mov_b32 v88, 0
  v_mov_b32 v89, 0
  v_mov_b32 v90, 0
  v_mov_b32 v91, 0
  v_mov_b32 v92, 0
  v_mov_b32 v93, 0
  v_mov_b32 v94, 0
  v_mov_b32 v95, 0
  v_mov_b32 v96, 0
  v_mov_b32 v97, 0
  v_mov_b32 v98, 0
  v_mov_b32 v99, 0
  v_mov_b32 v100, 0
  v_mov_b32 v101, 0
  v_mov_b32 v102, 0
  v_mov_b32 v103, 0
  s_mov_b32 s81, 0
  s_waitcnt lgkmcnt(0)
  s_barrier
  s_add_u32 s72, s72, 1310720
  s_add_u32 s79, s79, 1310720
  s_add_u32 s73, s73, 393216
  s_xor_b32 s74, s74, 16384
  v_mov_b32 v28, s61
  v_mov_b32 v166, s52
  s_mov_b64 exec, 1
  buffer_store_dword v166, v23, s[12:15], s77 offen sc1
  s_mov_b64 exec, -1
  ds_read_b128 v[170:173], v4 offset:16384
  ds_read_b128 v[174:177], v4 offset:17408
  ds_read_b128 v[178:181], v4 offset:18432
  v_min_u32 v104, -2, v104
  v_min_u32 v106, -2, v106
  v_min_u32 v108, -2, v108
  s_mov_b64 exec, s[68:69]
  buffer_store_dwordx4 v[104:107], v36, s[24:27], s70 offen sc1
  buffer_store_dwordx2 v[108:109], v37, s[24:27], s70 offen sc1
  s_mov_b64 exec, -1
  s_waitcnt lgkmcnt(0)
  buffer_store_dwordx4 v[170:173], v38, s[36:39], s71 offen sc1
  buffer_store_dwordx4 v[174:177], v39, s[36:39], s71 offen sc1
  s_mov_b64 exec, 0xffffffff
  buffer_store_dwordx4 v[178:181], v40, s[36:39], s71 offen sc1
  s_mov_b64 exec, -1
  s_add_u32 s70, s70, 98304
  s_add_u32 s71, s71, 327680
  buffer_load_dword v42, v41, s[12:15], s76 offen sc1
nt_187:
  s_barrier
  s_mov_b32 s58, s55
  s_add_u32 s52, s52, 1
  s_and_b32 s21, s52, 3
  s_mul_i32 s56, s21, 122880
  s_add_u32 s21, s52, 1
  s_and_b32 s21, s21, 3
  s_mul_i32 s55, s21, 122880
  s_add_u32 s55, s55, s75
  s_add_u32 s21, s52, 2
  s_and_b32 s21, s21, 3
  s_mul_i32 s57, s21, 122880
  s_add_u32 s21, s52, 3
  s_and_b32 s21, s21, 3
  s_mul_i32 s59, s21, 122880
  s_add_u32 s59, s59, s75
  s_bfe_u32 s61, s52, 0x10001
  s_and_b32 s21, s52, 1
  s_lshl_b32 s60, s21, 19
  s_mov_b32 s54, 0
  s_sleep 3
  s_nop 2
  buffer_load_dwordx4 v[84:87], v190, s[8:11], s58 offen offset:0 sc1
  s_branch top_174
mr_175:
  s_mov_b64 exec, s[22:23]
  s_cbranch_execz ms_188
  buffer_load_dwordx4 v[84:87], v190, s[8:11], s58 offen offset:0 sc1
ms_188:
  s_add_u32 s54, s54, 1
  s_cmp_gt_u32 s54, 131072
  s_cbranch_scc1 end0
  s_waitcnt vmcnt(0)
  s_mov_b64 exec, s[22:23]
  ds_write_b128 v190, v[84:87] offset:0
  v_cmp_eq_u32 s[22:23], -1, v84
  s_mov_b64 exec, -1
  s_or_b64 vcc, s[22:23], s[22:23]
  s_cbranch_scc1 mr_175
  s_branch mo_179
mn_176:
  v_max3_u32 v27, v48, v49, v50
  v_max3_u32 v27, v27, v51, v52
  v_max3_u32 v27, v27, v53, v54
  v_max3_u32 v27, v27, v55, v56
  v_max3_u32 v27, v27, v57, v58
  v_max3_u32 v27, v27, v59, v60
  v_max3_u32 v27, v27, v61, v62
  v_max3_u32 v27, v27, v63, v64
  v_max3_u32 v27, v27, v65, v66
  v_max3_u32 v27, v27, v67, v68
  v_max3_u32 v27, v27, v69, v70
  v_max3_u32 v27, v27, v71, v72
  v_max3_u32 v27, v27, v73, v74
  v_max3_u32 v27, v27, v75, v76
  v_max3_u32 v27, v27, v77, v78
  v_max3_u32 v27, v27, v79, v80
  v_max3_u32 v27, v27, v81, v82
  v_max3_u32 v27, v27, v83, v84
  v_max3_u32 v27, v27, v85, v86
  v_max3_u32 v27, v27, v87, v87
  v_cmp_eq_u32 vcc, -1, v27
  s_cmp_eq_u32 s52, 0
  s_cbranch_scc1 mk_177
  s_cbranch_vccz mk_177
  s_waitcnt lgkmcnt(0)
  s_barrier
  s_nop 7
  v_mov_b32 v88, 0
  v_mov_b32 v89, 0
  v_mov_b32 v90, 0
  v_mov_b32 v91, 0
  v_mov_b32 v92, 0
  v_mov_b32 v93, 0
  v_mov_b32 v94, 0
  v_mov_b32 v95, 0
  v_mov_b32 v96, 0
  v_mov_b32 v97, 0
  v_mov_b32 v98, 0
  v_mov_b32 v99, 0
  v_mov_b32 v100, 0
  v_mov_b32 v101, 0
  v_mov_b32 v102, 0
  v_mov_b32 v103, 0
  s_mov_b64 s[22:23], -1
  s_branch mr_175
kw_180:
  s_mov_b32 s101, 0
wm_189:
  buffer_load_dword v42, v41, s[12:15], s76 offen sc1
  s_add_u32 s101, s101, 1
  s_cmp_gt_u32 s101, 131072
  s_cbranch_scc1 end0
  s_waitcnt vmcnt(0)
  v_cmp_gt_u32 vcc, s22, v42
  v_readfirstlane_b32 s100, v42
  s_nop 0
  s_cbranch_vccz wm_190
  s_sleep 1
  s_branch wm_189
wm_190:
  s_branch kv_181
sr_182:
  s_mov_b32 s54, 0
sr_191:
  s_mov_b64 exec, vcc
  buffer_load_dwordx4 v[124:127], v9, s[8:11], s56 offen sc1
  buffer_load_dwordx4 v[128:131], v9, s[8:11], s56 offen offset:1024 sc1
  buffer_load_dwordx4 v[132:135], v10, s[8:11], s56 offen sc1
  s_mov_b64 exec, -1
  s_add_u32 s54, s54, 1
  s_cmp_gt_u32 s54, 131072
  s_cbranch_scc1 end0
  s_and_b32 s21, s54, 31
  s_cbranch_scc0 sr_192
  s_waitcnt vmcnt(0)
  v_pk_add_f16 v172, v124, v126
  v_pk_add_f16 v173, v125, v127
  v_pk_add_f16 v174, v128, v130
  v_pk_add_f16 v175, v129, v131
  v_fma_mix_f32 v166, v172, 1.0, v174 op_sel:[0,0,0] op_sel_hi:[1,0,1]
  v_fma_mix_f32 v168, v173, 1.0, v175 op_sel:[0,0,0] op_sel_hi:[1,0,1]
  v_pk_add_f16 v176, v132, v133
  v_pk_add_f16 v177, v134, v135
  v_add_f32 v27, v166, v168
  v_fma_mix_f32 v170, v176, 1.0, v177 op_sel:[0,0,0] op_sel_hi:[1,0,1]
  v_fma_mix_f32 v167, v172, 1.0, v174 op_sel:[1,0,1] op_sel_hi:[1,0,1]
  v_cmp_u_f32 vcc, v27, v170
  v_fma_mix_f32 v169, v173, 1.0, v175 op_sel:[1,0,1] op_sel_hi:[1,0,1]
  v_fma_mix_f32 v171, v176, 1.0, v177 op_sel:[1,0,1] op_sel_hi:[1,0,1]
  s_cbranch_vccnz sr_191
  s_branch sj_183
sr_192:
  s_waitcnt vmcnt(0)
  v_pk_add_f16 v172, v124, v126
  v_pk_add_f16 v173, v125, v127
  v_pk_add_f16 v174, v128, v130
  v_pk_add_f16 v175, v129, v131
  v_fma_mix_f32 v166, v172, 1.0, v174 op_sel:[0,0,0] op_sel_hi:[1,0,1]
  v_fma_mix_f32 v168, v173, 1.0, v175 op_sel:[0,0,0] op_sel_hi:[1,0,1]
  v_pk_add_f16 v176, v132, v133
  v_pk_add_f16 v177, v134, v135
  v_add_f32 v27, v166, v168
  v_fma_mix_f32 v170, v176, 1.0, v177 op_sel:[0,0,0] op_sel_hi:[1,0,1]
  v_fma_mix_f32 v167, v172, 1.0, v174 op_sel:[1,0,1] op_sel_hi:[1,0,1]
  v_cmp_u_f32 vcc, v27, v170
  v_fma_mix_f32 v169, v173, 1.0, v175 op_sel:[1,0,1] op_sel_hi:[1,0,1]
  v_fma_mix_f32 v171, v176, 1.0, v177 op_sel:[1,0,1] op_sel_hi:[1,0,1]
  v_max3_u32 v27, v124, v126, v128
  v_max3_u32 v27, v27, v130, v132
  v_max3_u32 v27, v27, v133, v134
  v_max3_u32 v27, v27, v135, v135
  v_cmp_eq_u32 vcc, -1, v27
  s_nop 1
  s_cbranch_vccnz sr_191
  s_branch sj_183
fx_185:
  s_cmp_eq_u32 s81, 1
  s_cbranch_scc1 fk_186
  s_mov_b32 s81, 1
  v_max3_f32 v164, v166, v167, v168
  v_max3_f32 v165, v169, v170, v171
  v_max_f32 v164, v164, v165
  s_nop 1
  v_max_f32_dpp v164, v164, v164 row_ror:8 row_mask:0xf bank_mask:0xf
  v_mov_b32 v165, v164
  s_nop 1
  v_permlane32_swap_b32 v164, v165
  v_max_f32 v164, v164, v165
  v_mov_b32 v165, v164
  s_nop 1
  v_permlane16_swap_b32 v164, v165
  v_max_f32 v164, v164, v165
  v_sub_f32 v166, v166, v164
  v_sub_f32 v167, v167, v164
  v_sub_f32 v168, v168, v164
  v_sub_f32 v169, v169, v164
  v_sub_f32 v170, v170, v164
  v_sub_f32 v171, v171, v164
  s_branch ex_184
last_178:
  v_smfmac_f32_16x16x64_bf16 v[100:103], v[56:59], a[96:103], v22
  v_smfmac_f32_16x16x64_bf16 v[96:99], v[60:63], a[24:31], v22
  v_smfmac_f32_16x16x64_bf16 v[96:99], v[64:67], a[32:39], v22
  v_smfmac_f32_16x16x64_bf16 v[96:99], v[68:71], a[40:47], v22
  v_smfmac_f32_16x16x64_bf16 v[96:99], v[72:75], a[48:55], v22
  v_smfmac_f32_16x16x64_bf16 v[96:99], v[76:79], a[56:63], v22
  v_smfmac_f32_16x16x64_bf16 v[96:99], v[80:83], a[64:71], v22
  v_smfmac_f32_16x16x64_bf16 v[96:99], v[84:87], a[72:79], v22
  v_smfmac_f32_16x16x64_bf16 v[100:103], v[60:63], a[104:111], v22
  v_smfmac_f32_16x16x64_bf16 v[100:103], v[64:67], a[112:119], v22
  v_smfmac_f32_16x16x64_bf16 v[100:103], v[68:71], a[120:127], v22
  v_smfmac_f32_16x16x64_bf16 v[100:103], v[72:75], a[128:135], v22
  v_smfmac_f32_16x16x64_bf16 v[100:103], v[76:79], a[136:143], v22
  v_smfmac_f32_16x16x64_bf16 v[100:103], v[80:83], a[144:151], v22
  v_smfmac_f32_16x16x64_bf16 v[100:103], v[84:87], a[152:159], v22
  s_nop 7
  v_permlane32_swap_b32 v96, v100
  v_permlane32_swap_b32 v97, v101
  v_permlane32_swap_b32 v98, v102
  v_permlane32_swap_b32 v99, v103
  v_pk_add_f32 v[96:97], v[96:97], v[100:101]
  v_pk_add_f32 v[98:99], v[98:99], v[102:103]
  v_cvt_pk_bf16_f32 v182, v96, v97
  v_cvt_pk_bf16_f32 v183, v98, v99
  v_min_u32 v182, -2, v182
  ds_write_b64 v26, v[182:183]
  v_permlane32_swap_b32 v88, v92
  v_permlane32_swap_b32 v89, v93
  v_permlane32_swap_b32 v90, v94
  v_permlane32_swap_b32 v91, v95
  v_pk_add_f32 v[88:89], v[88:89], v[92:93]
  v_pk_add_f32 v[90:91], v[90:91], v[94:95]
  v_cvt_pk_bf16_f32 v184, v88, v89
  v_cvt_pk_bf16_f32 v185, v90, v91
  v_min_u32 v184, -2, v184
  ds_write_b64 v43, v[184:185]
  s_waitcnt lgkmcnt(0)
  s_barrier
  ds_read_b128 v[170:173], v4 offset:16384
  ds_read_b128 v[174:177], v4 offset:17408
  ds_read_b128 v[178:181], v4 offset:18432
  v_min_u32 v104, -2, v104
  v_min_u32 v106, -2, v106
  v_min_u32 v108, -2, v108
  s_mov_b64 exec, s[68:69]
  buffer_store_dwordx4 v[104:107], v36, s[24:27], s70 offen sc1
  buffer_store_dwordx2 v[108:109], v37, s[24:27], s70 offen sc1
  s_mov_b64 exec, -1
  s_waitcnt lgkmcnt(0)
  buffer_store_dwordx4 v[170:173], v38, s[36:39], s71 offen sc1
  buffer_store_dwordx4 v[174:177], v39, s[36:39], s71 offen sc1
  s_mov_b64 exec, 0xffffffff
  buffer_store_dwordx4 v[178:181], v40, s[36:39], s71 offen sc1
  s_mov_b64 exec, -1
  s_add_u32 s70, s70, 98304
  s_add_u32 s71, s71, 327680
  s_waitcnt vmcnt(0)
  v_mov_b32 v166, 64
  s_mov_b64 exec, 1
  buffer_store_dword v166, v23, s[12:15], s77 offen sc1
  s_mov_b64 exec, -1
  s_branch chain_done
chain_done:
  s_waitcnt vmcnt(0) lgkmcnt(0)
  s_barrier
  s_mov_b32 s84, 0
  s_mov_b32 s85, -1
  s_mov_b32 s86, 0
  v_mov_b32 v21, 0
  v_mov_b32 v23, v247
  s_cmp_lg_u32 s20, 0
  s_cbranch_scc1 queue_b
  s_mov_b64 exec, 1
  s_branch queue_a
end0:
  s_endpgm
gemm_side:
  s_bfe_u32 s23, s22, 0x20005
  s_add_u32 s22, s22, 31
  s_and_b32 s22, s22, 31
  s_lshl_b32 s21, s23, 3
  s_add_u32 s2, s21, s22
  s_add_u32 s3, s2, 72
  s_add_u32 s24, s2, 48
  s_add_u32 s2, s2, s21
  s_cmp_lt_u32 s22, 24
  s_cselect_b32 s3, s24, s3
  s_cmp_lt_u32 s22, 16
  s_cselect_b32 s3, s2, s3
  s_mov_b32 s2, s3
  s_cmp_ge_u32 s3, 64
  s_cbranch_scc1 not_kv
  s_load_dwordx2 s[4:5], s[0:1], 0
  s_load_dwordx2 s[6:7], s[0:1], 24
  s_load_dwordx2 s[36:37], s[0:1], 32
  s_load_dwordx2 s[38:39], s[0:1], 104
  s_and_b32 s43, s3, 1
  s_bfe_u32 s42, s3, 0x50001
  s_lshr_b32 s40, s42, 2
  s_waitcnt lgkmcnt(0)
  s_cmp_eq_u32 s43, 1
  s_cselect_b32 s6, s36, s6
  s_cselect_b32 s7, s37, s7
  s_mov_b32 s8, s4
  s_mov_b32 s9, s5
  s_mov_b32 s10, 2621440
  s_mov_b32 s11, 0x00020000
  s_mov_b32 s12, s6
  s_mov_b32 s13, s7
  s_mov_b32 s14, 7864320
  s_mov_b32 s15, 0x00020000
  s_mov_b32 s16, s38
  s_mov_b32 s17, s39
  s_mov_b32 s18, 50331648
  s_mov_b32 s19, 0x00020000
  s_add_u32 s72, s38, 81068032
  s_addc_u32 s73, s39, 0
  s_mov_b32 s74, 115712
  s_mov_b32 s75, 0x00020000
  s_mul_i32 s44, s42, 384
  s_mov_b32 s30, 0
  s_mov_b32 s25, 80768
  v_lshrrev_b32 v4, 3, v1
  v_and_b32 v5, 7, v1
  v_xor_b32 v5, v5, v4
  s_mul_i32 s21, s20, 16
  v_add_u32 v4, s21, v4
  v_mul_u32_u24 v4, 1280, v4
  v_lshl_add_u32 v10, v5, 4, v4
  s_mul_i32 s31, s20, 2048
  v_add_u32 v11, 10240, v10
  v_mov_b32 v9, 2731
  v_add_u32 v8, 0, v1
  v_mul_u32_u24 v7, v8, v9
  v_lshrrev_b32 v7, 16, v7
  v_mul_u32_u24 v4, 24, v7
  v_sub_u32 v8, v8, v4
  s_mov_b32 s21, 12288
  v_mul_lo_u32 v7, v7, s21
  v_lshl_add_u32 v4, v8, 4, v7
  v_add_u32 v8, 64, v1
  v_mul_u32_u24 v7, v8, v9
  v_lshrrev_b32 v7, 16, v7
  v_mul_u32_u24 v5, 24, v7
  v_sub_u32 v8, v8, v5
  s_mov_b32 s21, 12288
  v_mul_lo_u32 v7, v7, s21
  v_lshl_add_u32 v5, v8, 4, v7
  v_add_u32 v8, 128, v1
  v_mul_u32_u24 v7, v8, v9
  v_lshrrev_b32 v7, 16, v7
  v_mul_u32_u24 v6, 24, v7
  v_sub_u32 v8, v8, v6
  s_mov_b32 s21, 12288
  v_mul_lo_u32 v7, v7, s21
  v_lshl_add_u32 v6, v8, 4, v7
  v_lshrrev_b32 v7, 2, v2
  v_lshl_add_u32 v7, v3, 3, v7
  v_mul_u32_u24 v7, 384, v7
  v_and_b32 v8, 3, v2
  v_lshlrev_b32 v8, 3, v8
  s_mul_i32 s21, s20, 96
  v_add3_u32 v7, v7, v8, s21
  v_add_u32 v8, 49152, v7
  s_mul_i32 s21, s20, 393216
  s_add_u32 s21, s21, 0
  s_add_u32 s21, s21, s44
  s_mul_i32 s22, s20, 12288
  s_add_u32 s22, s22, 0
  s_add_u32 m0, s22, 0
  s_nop 0
  buffer_load_dwordx4 v4, s[12:15], s21 offen lds
  s_add_u32 m0, s22, 1024
  s_nop 0
  buffer_load_dwordx4 v5, s[12:15], s21 offen lds
  s_add_u32 m0, s22, 2048
  s_nop 0
  buffer_load_dwordx4 v6, s[12:15], s21 offen lds
  s_mul_i32 s21, s20, 393216
  s_add_u32 s21, s21, 98304
  s_add_u32 s21, s21, s44
  s_mul_i32 s22, s20, 12288
  s_add_u32 s22, s22, 3072
  s_add_u32 m0, s22, 0
  s_nop 0
  buffer_load_dwordx4 v4, s[12:15], s21 offen lds
  s_add_u32 m0, s22, 1024
  s_nop 0
  buffer_load_dwordx4 v5, s[12:15], s21 offen lds
  s_add_u32 m0, s22, 2048
  s_nop 0
  buffer_load_dwordx4 v6, s[12:15], s21 offen lds
  s_mul_i32 s21, s20, 393216
  s_add_u32 s21, s21, 196608
  s_add_u32 s21, s21, s44
  s_mul_i32 s22, s20, 12288
  s_add_u32 s22, s22, 6144
  s_add_u32 m0, s22, 0
  s_nop 0
  buffer_load_dwordx4 v4, s[12:15], s21 offen lds
  s_add_u32 m0, s22, 1024
  s_nop 0
  buffer_load_dwordx4 v5, s[12:15], s21 offen lds
  s_add_u32 m0, s22, 2048
  s_nop 0
  buffer_load_dwordx4 v6, s[12:15], s21 offen lds
  s_mul_i32 s21, s20, 393216
  s_add_u32 s21, s21, 294912
  s_add_u32 s21, s21, s44
  s_mul_i32 s22, s20, 12288
  s_add_u32 s22, s22, 9216
  s_add_u32 m0, s22, 0
  s_nop 0
  buffer_load_dwordx4 v4, s[12:15], s21 offen lds
  s_add_u32 m0, s22, 1024
  s_nop 0
  buffer_load_dwordx4 v5, s[12:15], s21 offen lds
  s_add_u32 m0, s22, 2048
  s_nop 0
  buffer_load_dwordx4 v6, s[12:15], s21 offen lds
  s_add_u32 m0, s31, 98304
  s_nop 0
  buffer_load_dwordx4 v10, s[8:11], s30 offen lds
  s_add_u32 m0, s31, 99328
  s_nop 0
  buffer_load_dwordx4 v11, s[8:11], s30 offen lds
  s_add_u32 s30, s30, 128
  s_add_u32 m0, s31, 106496
  s_nop 0
  buffer_load_dwordx4 v10, s[8:11], s30 offen lds
  s_add_u32 m0, s31, 107520
  s_nop 0
  buffer_load_dwordx4 v11, s[8:11], s30 offen lds
  s_add_u32 s30, s30, 128
  s_add_u32 m0, s31, 114688
  s_nop 0
  buffer_load_dwordx4 v10, s[8:11], s30 offen lds
  s_add_u32 m0, s31, 115712
  s_nop 0
  buffer_load_dwordx4 v11, s[8:11], s30 offen lds
  s_add_u32 s30, s30, 128
  s_mul_i32 s21, s20, 393216
  s_add_u32 s21, s21, 1572864
  s_add_u32 s21, s21, s44
  s_mul_i32 s22, s20, 12288
  s_add_u32 s22, s22, 49152
  s_add_u32 m0, s22, 0
  s_nop 0
  buffer_load_dwordx4 v4, s[12:15], s21 offen lds
  s_add_u32 m0, s22, 1024
  s_nop 0
  buffer_load_dwordx4 v5, s[12:15], s21 offen lds
  s_add_u32 m0, s22, 2048
  s_nop 0
  buffer_load_dwordx4 v6, s[12:15], s21 offen lds
  s_mul_i32 s21, s20, 393216
  s_add_u32 s21, s21, 1671168
  s_add_u32 s21, s21, s44
  s_mul_i32 s22, s20, 12288
  s_add_u32 s22, s22, 52224
  s_add_u32 m0, s22, 0
  s_nop 0
  buffer_load_dwordx4 v4, s[12:15], s21 offen lds
  s_add_u32 m0, s22, 1024
  s_nop 0
  buffer_load_dwordx4 v5, s[12:15], s21 offen lds
  s_add_u32 m0, s22, 2048
  s_nop 0
  buffer_load_dwordx4 v6, s[12:15], s21 offen lds
  s_mul_i32 s21, s20, 393216
  s_add_u32 s21, s21, 1769472
  s_add_u32 s21, s21, s44
  s_mul_i32 s22, s20, 12288
  s_add_u32 s22, s22, 55296
  s_add_u32 m0, s22, 0
  s_nop 0
  buffer_load_dwordx4 v4, s[12:15], s21 offen lds
  s_add_u32 m0, s22, 1024
  s_nop 0
  buffer_load_dwordx4 v5, s[12:15], s21 offen lds
  s_add_u32 m0, s22, 2048
  s_nop 0
  buffer_load_dwordx4 v6, s[12:15], s21 offen lds
  s_mul_i32 s21, s20, 393216
  s_add_u32 s21, s21, 1867776
  s_add_u32 s21, s21, s44
  s_mul_i32 s22, s20, 12288
  s_add_u32 s22, s22, 58368
  s_add_u32 m0, s22, 0
  s_nop 0
  buffer_load_dwordx4 v4, s[12:15], s21 offen lds
  s_add_u32 m0, s22, 1024
  s_nop 0
  buffer_load_dwordx4 v5, s[12:15], s21 offen lds
  s_add_u32 m0, s22, 2048
  s_nop 0
  buffer_load_dwordx4 v6, s[12:15], s21 offen lds
  s_waitcnt vmcnt(12)
  s_barrier
  ds_read_b64_tr_b16 a[0:1], v7 offset:0
  ds_read_b64_tr_b16 a[2:3], v7 offset:1536
  ds_read_b64_tr_b16 a[4:5], v7 offset:32
  ds_read_b64_tr_b16 a[6:7], v7 offset:1568
  ds_read_b64_tr_b16 a[8:9], v7 offset:64
  ds_read_b64_tr_b16 a[10:11], v7 offset:1600
  ds_read_b64_tr_b16 a[12:13], v7 offset:12288
  ds_read_b64_tr_b16 a[14:15], v7 offset:13824
  ds_read_b64_tr_b16 a[16:17], v7 offset:12320
  ds_read_b64_tr_b16 a[18:19], v7 offset:13856
  ds_read_b64_tr_b16 a[20:21], v7 offset:12352
  ds_read_b64_tr_b16 a[22:23], v7 offset:13888
  ds_read_b64_tr_b16 a[24:25], v7 offset:24576
  ds_read_b64_tr_b16 a[26:27], v7 offset:26112
  ds_read_b64_tr_b16 a[28:29], v7 offset:24608
  ds_read_b64_tr_b16 a[30:31], v7 offset:26144
  ds_read_b64_tr_b16 a[32:33], v7 offset:24640
  ds_read_b64_tr_b16 a[34:35], v7 offset:26176
  ds_read_b64_tr_b16 a[36:37], v7 offset:36864
  ds_read_b64_tr_b16 a[38:39], v7 offset:38400
  ds_read_b64_tr_b16 a[40:41], v7 offset:36896
  ds_read_b64_tr_b16 a[42:43], v7 offset:38432
  ds_read_b64_tr_b16 a[44:45], v7 offset:36928
  ds_read_b64_tr_b16 a[46:47], v7 offset:38464
  s_waitcnt lgkmcnt(0)
  s_barrier
  s_mul_i32 s21, s20, 393216
  s_add_u32 s21, s21, 3145728
  s_add_u32 s21, s21, s44
  s_mul_i32 s22, s20, 12288
  s_add_u32 s22, s22, 0
  s_add_u32 m0, s22, 0
  s_nop 0
  buffer_load_dwordx4 v4, s[12:15], s21 offen lds
  s_add_u32 m0, s22, 1024
  s_nop 0
  buffer_load_dwordx4 v5, s[12:15], s21 offen lds
  s_add_u32 m0, s22, 2048
  s_nop 0
  buffer_load_dwordx4 v6, s[12:15], s21 offen lds
  s_mul_i32 s21, s20, 393216
  s_add_u32 s21, s21, 3244032
  s_add_u32 s21, s21, s44
  s_mul_i32 s22, s20, 12288
  s_add_u32 s22, s22, 3072
  s_add_u32 m0, s22, 0
  s_nop 0
  buffer_load_dwordx4 v4, s[12:15], s21 offen lds
  s_add_u32 m0, s22, 1024
  s_nop 0
  buffer_load_dwordx4 v5, s[12:15], s21 offen lds
  s_add_u32 m0, s22, 2048
  s_nop 0
  buffer_load_dwordx4 v6, s[12:15], s21 offen lds
  s_mul_i32 s21, s20, 393216
  s_add_u32 s21, s21, 3342336
  s_add_u32 s21, s21, s44
  s_mul_i32 s22, s20, 12288
  s_add_u32 s22, s22, 6144
  s_add_u32 m0, s22, 0
  s_nop 0
  buffer_load_dwordx4 v4, s[12:15], s21 offen lds
  s_add_u32 m0, s22, 1024
  s_nop 0
  buffer_load_dwordx4 v5, s[12:15], s21 offen lds
  s_add_u32 m0, s22, 2048
  s_nop 0
  buffer_load_dwordx4 v6, s[12:15], s21 offen lds
  s_mul_i32 s21, s20, 393216
  s_add_u32 s21, s21, 3440640
  s_add_u32 s21, s21, s44
  s_mul_i32 s22, s20, 12288
  s_add_u32 s22, s22, 9216
  s_add_u32 m0, s22, 0
  s_nop 0
  buffer_load_dwordx4 v4, s[12:15], s21 offen lds
  s_add_u32 m0, s22, 1024
  s_nop 0
  buffer_load_dwordx4 v5, s[12:15], s21 offen lds
  s_add_u32 m0, s22, 2048
  s_nop 0
  buffer_load_dwordx4 v6, s[12:15], s21 offen lds
  s_waitcnt vmcnt(12)
  s_barrier
  ds_read_b64_tr_b16 a[48:49], v8 offset:0
  ds_read_b64_tr_b16 a[50:51], v8 offset:1536
  ds_read_b64_tr_b16 a[52:53], v8 offset:32
  ds_read_b64_tr_b16 a[54:55], v8 offset:1568
  ds_read_b64_tr_b16 a[56:57], v8 offset:64
  ds_read_b64_tr_b16 a[58:59], v8 offset:1600
  ds_read_b64_tr_b16 a[60:61], v8 offset:12288
  ds_read_b64_tr_b16 a[62:63], v8 offset:13824
  ds_read_b64_tr_b16 a[64:65], v8 offset:12320
  ds_read_b64_tr_b16 a[66:67], v8 offset:13856
  ds_read_b64_tr_b16 a[68:69], v8 offset:12352
  ds_read_b64_tr_b16 a[70:71], v8 offset:13888
  ds_read_b64_tr_b16 a[72:73], v8 offset:24576
  ds_read_b64_tr_b16 a[74:75], v8 offset:26112
  ds_read_b64_tr_b16 a[76:77], v8 offset:24608
  ds_read_b64_tr_b16 a[78:79], v8 offset:26144
  ds_read_b64_tr_b16 a[80:81], v8 offset:24640
  ds_read_b64_tr_b16 a[82:83], v8 offset:26176
  ds_read_b64_tr_b16 a[84:85], v8 offset:36864
  ds_read_b64_tr_b16 a[86:87], v8 offset:38400
  ds_read_b64_tr_b16 a[88:89], v8 offset:36896
  ds_read_b64_tr_b16 a[90:91], v8 offset:38432
  ds_read_b64_tr_b16 a[92:93], v8 offset:36928
  ds_read_b64_tr_b16 a[94:95], v8 offset:38464
  s_waitcnt lgkmcnt(0)
  s_barrier
  s_mul_i32 s21, s20, 393216
  s_add_u32 s21, s21, 4718592
  s_add_u32 s21, s21, s44
  s_mul_i32 s22, s20, 12288
  s_add_u32 s22, s22, 49152
  s_add_u32 m0, s22, 0
  s_nop 0
  buffer_load_dwordx4 v4, s[12:15], s21 offen lds
  s_add_u32 m0, s22, 1024
  s_nop 0
  buffer_load_dwordx4 v5, s[12:15], s21 offen lds
  s_add_u32 m0, s22, 2048
  s_nop 0
  buffer_load_dwordx4 v6, s[12:15], s21 offen lds
  s_mul_i32 s21, s20, 393216
  s_add_u32 s21, s21, 4816896
  s_add_u32 s21, s21, s44
  s_mul_i32 s22, s20, 12288
  s_add_u32 s22, s22, 52224
  s_add_u32 m0, s22, 0
  s_nop 0
  buffer_load_dwordx4 v4, s[12:15], s21 offen lds
  s_add_u32 m0, s22, 1024
  s_nop 0
  buffer_load_dwordx4 v5, s[12:15], s21 offen lds
  s_add_u32 m0, s22, 2048
  s_nop 0
  buffer_load_dwordx4 v6, s[12:15], s21 offen lds
  s_mul_i32 s21, s20, 393216
  s_add_u32 s21, s21, 4915200
  s_add_u32 s21, s21, s44
  s_mul_i32 s22, s20, 12288
  s_add_u32 s22, s22, 55296
  s_add_u32 m0, s22, 0
  s_nop 0
  buffer_load_dwordx4 v4, s[12:15], s21 offen lds
  s_add_u32 m0, s22, 1024
  s_nop 0
  buffer_load_dwordx4 v5, s[12:15], s21 offen lds
  s_add_u32 m0, s22, 2048
  s_nop 0
  buffer_load_dwordx4 v6, s[12:15], s21 offen lds
  s_mul_i32 s21, s20, 393216
  s_add_u32 s21, s21, 5013504
  s_add_u32 s21, s21, s44
  s_mul_i32 s22, s20, 12288
  s_add_u32 s22, s22, 58368
  s_add_u32 m0, s22, 0
  s_nop 0
  buffer_load_dwordx4 v4, s[12:15], s21 offen lds
  s_add_u32 m0, s22, 1024
  s_nop 0
  buffer_load_dwordx4 v5, s[12:15], s21 offen lds
  s_add_u32 m0, s22, 2048
  s_nop 0
  buffer_load_dwordx4 v6, s[12:15], s21 offen lds
  v_mov_b32 v29, 76
  buffer_load_dword v29, v29, s[32:35], 0 offen sc1
  s_waitcnt vmcnt(12)
  s_barrier
  ds_read_b64_tr_b16 a[96:97], v7 offset:0
  ds_read_b64_tr_b16 a[98:99], v7 offset:1536
  ds_read_b64_tr_b16 a[100:101], v7 offset:32
  ds_read_b64_tr_b16 a[102:103], v7 offset:1568
  ds_read_b64_tr_b16 a[104:105], v7 offset:64
  ds_read_b64_tr_b16 a[106:107], v7 offset:1600
  ds_read_b64_tr_b16 a[108:109], v7 offset:12288
  ds_read_b64_tr_b16 a[110:111], v7 offset:13824
  ds_read_b64_tr_b16 a[112:113], v7 offset:12320
  ds_read_b64_tr_b16 a[114:115], v7 offset:13856
  ds_read_b64_tr_b16 a[116:117], v7 offset:12352
  ds_read_b64_tr_b16 a[118:119], v7 offset:13888
  ds_read_b64_tr_b16 a[120:121], v7 offset:24576
  ds_read_b64_tr_b16 a[122:123], v7 offset:26112
  ds_read_b64_tr_b16 a[124:125], v7 offset:24608
  ds_read_b64_tr_b16 a[126:127], v7 offset:26144
  ds_read_b64_tr_b16 a[128:129], v7 offset:24640
  ds_read_b64_tr_b16 a[130:131], v7 offset:26176
  ds_read_b64_tr_b16 a[132:133], v7 offset:36864
  ds_read_b64_tr_b16 a[134:135], v7 offset:38400
  ds_read_b64_tr_b16 a[136:137], v7 offset:36896
  ds_read_b64_tr_b16 a[138:139], v7 offset:38432
  ds_read_b64_tr_b16 a[140:141], v7 offset:36928
  ds_read_b64_tr_b16 a[142:143], v7 offset:38464
  s_waitcnt lgkmcnt(0)
  s_barrier
  s_mul_i32 s21, s20, 393216
  s_add_u32 s21, s21, 6291456
  s_add_u32 s21, s21, s44
  s_mul_i32 s22, s20, 12288
  s_add_u32 s22, s22, 0
  s_add_u32 m0, s22, 0
  s_nop 0
  buffer_load_dwordx4 v4, s[12:15], s21 offen lds
  s_add_u32 m0, s22, 1024
  s_nop 0
  buffer_load_dwordx4 v5, s[12:15], s21 offen lds
  s_add_u32 m0, s22, 2048
  s_nop 0
  buffer_load_dwordx4 v6, s[12:15], s21 offen lds
  s_mul_i32 s21, s20, 393216
  s_add_u32 s21, s21, 6389760
  s_add_u32 s21, s21, s44
  s_mul_i32 s22, s20, 12288
  s_add_u32 s22, s22, 3072
  s_add_u32 m0, s22, 0
  s_nop 0
  buffer_load_dwordx4 v4, s[12:15], s21 offen lds
  s_add_u32 m0, s22, 1024
  s_nop 0
  buffer_load_dwordx4 v5, s[12:15], s21 offen lds
  s_add_u32 m0, s22, 2048
  s_nop 0
  buffer_load_dwordx4 v6, s[12:15], s21 offen lds
  s_mul_i32 s21, s20, 393216
  s_add_u32 s21, s21, 6488064
  s_add_u32 s21, s21, s44
  s_mul_i32 s22, s20, 12288
  s_add_u32 s22, s22, 6144
  s_add_u32 m0, s22, 0
  s_nop 0
  buffer_load_dwordx4 v4, s[12:15], s21 offen lds
  s_add_u32 m0, s22, 1024
  s_nop 0
  buffer_load_dwordx4 v5, s[12:15], s21 offen lds
  s_add_u32 m0, s22, 2048
  s_nop 0
  buffer_load_dwordx4 v6, s[12:15], s21 offen lds
  s_mul_i32 s21, s20, 393216
  s_add_u32 s21, s21, 6586368
  s_add_u32 s21, s21, s44
  s_mul_i32 s22, s20, 12288
  s_add_u32 s22, s22, 9216
  s_add_u32 m0, s22, 0
  s_nop 0
  buffer_load_dwordx4 v4, s[12:15], s21 offen lds
  s_add_u32 m0, s22, 1024
  s_nop 0
  buffer_load_dwordx4 v5, s[12:15], s21 offen lds
  s_add_u32 m0, s22, 2048
  s_nop 0
  buffer_load_dwordx4 v6, s[12:15], s21 offen lds
  s_waitcnt vmcnt(12)
  s_barrier
  ds_read_b64_tr_b16 a[144:145], v8 offset:0
  ds_read_b64_tr_b16 a[146:147], v8 offset:1536
  ds_read_b64_tr_b16 a[148:149], v8 offset:32
  ds_read_b64_tr_b16 a[150:151], v8 offset:1568
  ds_read_b64_tr_b16 a[152:153], v8 offset:64
  ds_read_b64_tr_b16 a[154:155], v8 offset:1600
  ds_read_b64_tr_b16 a[156:157], v8 offset:12288
  ds_read_b64_tr_b16 a[158:159], v8 offset:13824
  ds_read_b64_tr_b16 a[160:161], v8 offset:12320
  ds_read_b64_tr_b16 a[162:163], v8 offset:13856
  ds_read_b64_tr_b16 a[164:165], v8 offset:12352
  ds_read_b64_tr_b16 a[166:167], v8 offset:13888
  ds_read_b64_tr_b16 a[168:169], v8 offset:24576
  ds_read_b64_tr_b16 a[170:171], v8 offset:26112
  ds_read_b64_tr_b16 a[172:173], v8 offset:24608
  ds_read_b64_tr_b16 a[174:175], v8 offset:26144
  ds_read_b64_tr_b16 a[176:177], v8 offset:24640
  ds_read_b64_tr_b16 a[178:179], v8 offset:26176
  ds_read_b64_tr_b16 a[180:181], v8 offset:36864
  ds_read_b64_tr_b16 a[182:183], v8 offset:38400
  ds_read_b64_tr_b16 a[184:185], v8 offset:36896
  ds_read_b64_tr_b16 a[186:187], v8 offset:38432
  ds_read_b64_tr_b16 a[188:189], v8 offset:36928
  ds_read_b64_tr_b16 a[190:191], v8 offset:38464
  s_waitcnt lgkmcnt(0)
  s_barrier
  s_waitcnt vmcnt(0)
  s_barrier
  ds_read_b64_tr_b16 a[192:193], v7 offset:0
  ds_read_b64_tr_b16 a[194:195], v7 offset:1536
  ds_read_b64_tr_b16 a[196:197], v7 offset:32
  ds_read_b64_tr_b16 a[198:199], v7 offset:1568
  ds_read_b64_tr_b16 a[200:201], v7 offset:64
  ds_read_b64_tr_b16 a[202:203], v7 offset:1600
  ds_read_b64_tr_b16 a[204:205], v7 offset:12288
  ds_read_b64_tr_b16 a[206:207], v7 offset:13824
  ds_read_b64_tr_b16 a[208:209], v7 offset:12320
  ds_read_b64_tr_b16 a[210:211], v7 offset:13856
  ds_read_b64_tr_b16 a[212:213], v7 offset:12352
  ds_read_b64_tr_b16 a[214:215], v7 offset:13888
  ds_read_b64_tr_b16 a[216:217], v7 offset:24576
  ds_read_b64_tr_b16 a[218:219], v7 offset:26112
  ds_read_b64_tr_b16 a[220:221], v7 offset:24608
  ds_read_b64_tr_b16 a[222:223], v7 offset:26144
  ds_read_b64_tr_b16 a[224:225], v7 offset:24640
  ds_read_b64_tr_b16 a[226:227], v7 offset:26176
  ds_read_b64_tr_b16 a[228:229], v7 offset:36864
  ds_read_b64_tr_b16 a[230:231], v7 offset:38400
  ds_read_b64_tr_b16 a[232:233], v7 offset:36896
  ds_read_b64_tr_b16 a[234:235], v7 offset:38432
  ds_read_b64_tr_b16 a[236:237], v7 offset:36928
  ds_read_b64_tr_b16 a[238:239], v7 offset:38464
  s_waitcnt lgkmcnt(0)
  s_barrier
  v_and_b32 v6, 7, v2
  v_add_u32 v4, 0, v3
  v_xor_b32 v4, v4, v6
  v_lshlrev_b32 v4, 4, v4
  v_lshl_add_u32 v14, v2, 7, v4
  v_add_u32 v16, 65536, v14
  v_add_u32 v18, 131072, v14
  v_add_u32 v4, 4, v3
  v_xor_b32 v4, v4, v6
  v_lshlrev_b32 v4, 4, v4
  v_lshl_add_u32 v15, v2, 7, v4
  v_add_u32 v17, 65536, v15
  v_add_u32 v19, 131072, v15
  v_lshlrev_b32 v26, 4, v1
  v_mov_b32 v28, 1
  v_mov_b32 v4, 0x40000000
  v_cmp_eq_u32 vcc, 0, v0
  s_nop 1
  v_cndmask_b32 v27, v4, 0, vcc
  s_mov_b32 s26, 4
  s_mul_i32 s27, s42, 12288
  s_mul_i32 s21, s43, 25165824
  s_add_u32 s27, s27, s21
  s_mul_i32 s21, s20, 3072
  s_add_u32 s27, s27, s21
  s_mov_b32 s28, 786432
  v_readfirstlane_b32 s21, v29
  s_cmp_lg_u32 s21, 0
  s_cbranch_scc1 kvz_193
  s_mov_b32 s21, 76
  v_mov_b32 v4, 0
  s_mov_b32 s101, 0
wf_194:
  buffer_load_dword v5, v4, s[32:35], s21 offen sc1
  s_add_u32 s101, s101, 1
  s_cmp_gt_u32 s101, 131072
  s_cbranch_scc1 main_end
  s_waitcnt vmcnt(0)
  v_readfirstlane_b32 s100, v5
  s_cmp_ge_u32 s100, 1
  s_cbranch_scc1 wf_195
  s_sleep 8
  s_branch wf_194
wf_195:
kvz_193:
  s_lshl_b32 s60, s40, 7
  s_add_u32 s60, s60, 0
  s_mov_b32 s48, 0x40000000
  s_mov_b32 s61, 0x40000000
  s_waitcnt vmcnt(4)
  s_barrier
  ds_read_b128 v[160:163], v16 offset:32768
  ds_read_b128 v[164:167], v16 offset:34816
  ds_read_b128 v[168:171], v16 offset:36864
  ds_read_b128 v[172:175], v16 offset:38912
  s_waitcnt lgkmcnt(3)
  .p2align 3
kvm_196:
  v_mfma_f32_16x16x32_bf16 v[64:67], a[0:3], v[160:163], 0
  s_add_u32 s29, s48, 0
  ds_read_b128 v[176:179], v17 offset:32768
  v_cvt_pk_bf16_f32 v204, v88, v89
  v_mfma_f32_16x16x32_bf16 v[68:71], a[4:7], v[160:163], 0
  v_cvt_pk_bf16_f32 v205, v90, v91
  v_cvt_pk_bf16_f32 v206, v92, v93
  v_mfma_f32_16x16x32_bf16 v[72:75], a[8:11], v[160:163], 0
  s_waitcnt lgkmcnt(3)
  v_cvt_pk_bf16_f32 v207, v94, v95
  v_cvt_pk_bf16_f32 v212, v96, v97
  v_mfma_f32_16x16x32_bf16 v[76:79], a[0:3], v[164:167], 0
  ds_read_b128 v[180:183], v17 offset:34816
  v_cvt_pk_bf16_f32 v213, v98, v99
  v_mfma_f32_16x16x32_bf16 v[80:83], a[4:7], v[164:167], 0
  v_cvt_pk_bf16_f32 v208, v100, v101
  v_cvt_pk_bf16_f32 v209, v102, v103
  v_mfma_f32_16x16x32_bf16 v[84:87], a[8:11], v[164:167], 0
  s_waitcnt lgkmcnt(3)
  v_cvt_pk_bf16_f32 v210, v104, v105
  v_cvt_pk_bf16_f32 v211, v106, v107
  v_mfma_f32_16x16x32_bf16 v[88:91], a[0:3], v[168:171], 0
  ds_read_b128 v[184:187], v17 offset:36864
  v_cvt_pk_bf16_f32 v214, v108, v109
  v_mfma_f32_16x16x32_bf16 v[92:95], a[4:7], v[168:171], 0
  s_add_u32 m0, s31, 122880
  v_cvt_pk_bf16_f32 v215, v110, v111
  buffer_store_dwordx4 v[192:195], v26, s[16:19], s29 offen offset:0 sc1
  v_mfma_f32_16x16x32_bf16 v[96:99], a[8:11], v[168:171], 0
  s_waitcnt lgkmcnt(3)
  buffer_load_dwordx4 v10, s[8:11], s30 offen lds
  v_mfma_f32_16x16x32_bf16 v[100:103], a[0:3], v[172:175], 0
  ds_read_b128 v[188:191], v17 offset:38912
  v_mfma_f32_16x16x32_bf16 v[104:107], a[4:7], v[172:175], 0
  v_mfma_f32_16x16x32_bf16 v[108:111], a[8:11], v[172:175], 0
  s_waitcnt lgkmcnt(3)
  v_mfma_f32_16x16x32_bf16 v[64:67], a[12:15], v[176:179], v[64:67]
  s_waitcnt vmcnt(4)
  s_barrier
  ds_read_b128 v[160:163], v16 offset:40960
  v_mfma_f32_16x16x32_bf16 v[68:71], a[16:19], v[176:179], v[68:71]
  s_add_u32 m0, s31, 123904
  v_mfma_f32_16x16x32_bf16 v[72:75], a[20:23], v[176:179], v[72:75]
  s_waitcnt lgkmcnt(3)
  buffer_load_dwordx4 v11, s[8:11], s30 offen lds
  buffer_store_dwordx4 v[196:199], v26, s[16:19], s29 offen offset:1024 sc1
  v_mfma_f32_16x16x32_bf16 v[76:79], a[12:15], v[180:183], v[76:79]
  s_add_u32 s30, s30, 128
  ds_read_b128 v[164:167], v16 offset:43008
  v_mfma_f32_16x16x32_bf16 v[80:83], a[16:19], v[180:183], v[80:83]
  v_mfma_f32_16x16x32_bf16 v[84:87], a[20:23], v[180:183], v[84:87]
  s_waitcnt lgkmcnt(3)
  v_mfma_f32_16x16x32_bf16 v[88:91], a[12:15], v[184:187], v[88:91]
  ds_read_b128 v[168:171], v16 offset:45056
  v_mfma_f32_16x16x32_bf16 v[92:95], a[16:19], v[184:187], v[92:95]
  v_mfma_f32_16x16x32_bf16 v[96:99], a[20:23], v[184:187], v[96:99]
  s_waitcnt lgkmcnt(3)
  v_mfma_f32_16x16x32_bf16 v[100:103], a[12:15], v[188:191], v[100:103]
  ds_read_b128 v[172:175], v16 offset:47104
  buffer_store_dwordx4 v[200:203], v26, s[16:19], s29 offen offset:2048 sc1
  v_mfma_f32_16x16x32_bf16 v[104:107], a[16:19], v[188:191], v[104:107]
  v_mfma_f32_16x16x32_bf16 v[108:111], a[20:23], v[188:191], v[108:111]
  s_waitcnt lgkmcnt(3)
  v_mfma_f32_16x16x32_bf16 v[64:67], a[24:27], v[160:163], v[64:67]
  ds_read_b128 v[176:179], v17 offset:40960
  v_mfma_f32_16x16x32_bf16 v[68:71], a[28:31], v[160:163], v[68:71]
  s_add_u32 m0, s31, 131072
  v_mfma_f32_16x16x32_bf16 v[72:75], a[32:35], v[160:163], v[72:75]
  s_waitcnt lgkmcnt(3)
  buffer_load_dwordx4 v10, s[8:11], s30 offen lds
  v_mfma_f32_16x16x32_bf16 v[76:79], a[24:27], v[164:167], v[76:79]
  s_add_u32 s29, s48, 393216
  ds_read_b128 v[180:183], v17 offset:43008
  v_mfma_f32_16x16x32_bf16 v[80:83], a[28:31], v[164:167], v[80:83]
  buffer_store_dwordx4 v[204:207], v26, s[16:19], s29 offen offset:0 sc1
  v_mfma_f32_16x16x32_bf16 v[84:87], a[32:35], v[164:167], v[84:87]
  s_waitcnt lgkmcnt(3)
  v_mfma_f32_16x16x32_bf16 v[88:91], a[24:27], v[168:171], v[88:91]
  ds_read_b128 v[184:187], v17 offset:45056
  v_mfma_f32_16x16x32_bf16 v[92:95], a[28:31], v[168:171], v[92:95]
  s_add_u32 m0, s31, 132096
  v_mfma_f32_16x16x32_bf16 v[96:99], a[32:35], v[168:171], v[96:99]
  s_waitcnt lgkmcnt(3)
  buffer_load_dwordx4 v11, s[8:11], s30 offen lds
  v_mfma_f32_16x16x32_bf16 v[100:103], a[24:27], v[172:175], v[100:103]
  s_add_u32 s30, s30, 128
  ds_read_b128 v[188:191], v17 offset:47104
  v_mfma_f32_16x16x32_bf16 v[104:107], a[28:31], v[172:175], v[104:107]
  v_mfma_f32_16x16x32_bf16 v[108:111], a[32:35], v[172:175], v[108:111]
  s_waitcnt lgkmcnt(3)
  buffer_store_dwordx4 v[208:211], v26, s[16:19], s29 offen offset:1024 sc1
  v_mfma_f32_16x16x32_bf16 v[64:67], a[36:39], v[176:179], v[64:67]
  s_waitcnt vmcnt(9)
  s_barrier
  ds_read_b128 v[160:163], v16 offset:49152
  v_mfma_f32_16x16x32_bf16 v[68:71], a[40:43], v[176:179], v[68:71]
  v_mfma_f32_16x16x32_bf16 v[72:75], a[44:47], v[176:179], v[72:75]
  s_waitcnt lgkmcnt(3)
  v_mfma_f32_16x16x32_bf16 v[76:79], a[36:39], v[180:183], v[76:79]
  ds_read_b128 v[164:167], v16 offset:51200
  v_mfma_f32_16x16x32_bf16 v[80:83], a[40:43], v[180:183], v[80:83]
  v_mfma_f32_16x16x32_bf16 v[84:87], a[44:47], v[180:183], v[84:87]
  s_waitcnt lgkmcnt(3)
  v_mfma_f32_16x16x32_bf16 v[88:91], a[36:39], v[184:187], v[88:91]
  ds_read_b128 v[168:171], v16 offset:53248
  buffer_store_dwordx4 v[212:215], v26, s[16:19], s29 offen offset:2048 sc1
  v_mfma_f32_16x16x32_bf16 v[92:95], a[40:43], v[184:187], v[92:95]
  v_mfma_f32_16x16x32_bf16 v[96:99], a[44:47], v[184:187], v[96:99]
  s_waitcnt lgkmcnt(3)
  v_mfma_f32_16x16x32_bf16 v[100:103], a[36:39], v[188:191], v[100:103]
  ds_read_b128 v[172:175], v16 offset:55296
  v_mfma_f32_16x16x32_bf16 v[104:107], a[40:43], v[188:191], v[104:107]
  v_mfma_f32_16x16x32_bf16 v[108:111], a[44:47], v[188:191], v[108:111]
  s_waitcnt lgkmcnt(3)
  v_mfma_f32_16x16x32_bf16 v[64:67], a[48:51], v[160:163], v[64:67]
  ds_read_b128 v[176:179], v17 offset:49152
  v_mfma_f32_16x16x32_bf16 v[68:71], a[52:55], v[160:163], v[68:71]
  s_add_u32 m0, s31, 98304
  v_mfma_f32_16x16x32_bf16 v[72:75], a[56:59], v[160:163], v[72:75]
  s_waitcnt lgkmcnt(3)
  buffer_load_dwordx4 v10, s[8:11], s30 offen lds
  v_mfma_f32_16x16x32_bf16 v[76:79], a[48:51], v[164:167], v[76:79]
  ds_read_b128 v[180:183], v17 offset:51200
  v_mfma_f32_16x16x32_bf16 v[80:83], a[52:55], v[164:167], v[80:83]
  v_mfma_f32_16x16x32_bf16 v[84:87], a[56:59], v[164:167], v[84:87]
  s_waitcnt lgkmcnt(3)
  v_mfma_f32_16x16x32_bf16 v[88:91], a[48:51], v[168:171], v[88:91]
  ds_read_b128 v[184:187], v17 offset:53248
  v_mfma_f32_16x16x32_bf16 v[92:95], a[52:55], v[168:171], v[92:95]
  s_add_u32 m0, s31, 99328
  v_mfma_f32_16x16x32_bf16 v[96:99], a[56:59], v[168:171], v[96:99]
  s_waitcnt lgkmcnt(3)
  buffer_load_dwordx4 v11, s[8:11], s30 offen lds
  v_mfma_f32_16x16x32_bf16 v[100:103], a[48:51], v[172:175], v[100:103]
  s_add_u32 s30, s30, 128
  ds_read_b128 v[188:191], v17 offset:55296
  v_mfma_f32_16x16x32_bf16 v[104:107], a[52:55], v[172:175], v[104:107]
  v_mfma_f32_16x16x32_bf16 v[108:111], a[56:59], v[172:175], v[108:111]
  s_waitcnt lgkmcnt(3)
  v_mfma_f32_16x16x32_bf16 v[64:67], a[60:63], v[176:179], v[64:67]
  s_waitcnt vmcnt(9)
  s_barrier
  ds_read_b128 v[160:163], v16 offset:57344
  v_mfma_f32_16x16x32_bf16 v[68:71], a[64:67], v[176:179], v[68:71]
  v_mfma_f32_16x16x32_bf16 v[72:75], a[68:71], v[176:179], v[72:75]
  s_waitcnt lgkmcnt(3)
  v_mfma_f32_16x16x32_bf16 v[76:79], a[60:63], v[180:183], v[76:79]
  ds_read_b128 v[164:167], v16 offset:59392
  v_mfma_f32_16x16x32_bf16 v[80:83], a[64:67], v[180:183], v[80:83]
  v_mfma_f32_16x16x32_bf16 v[84:87], a[68:71], v[180:183], v[84:87]
  s_waitcnt lgkmcnt(3)
  v_mfma_f32_16x16x32_bf16 v[88:91], a[60:63], v[184:187], v[88:91]
  ds_read_b128 v[168:171], v16 offset:61440
  v_mfma_f32_16x16x32_bf16 v[92:95], a[64:67], v[184:187], v[92:95]
  v_mfma_f32_16x16x32_bf16 v[96:99], a[68:71], v[184:187], v[96:99]
  s_waitcnt lgkmcnt(3)
  v_mfma_f32_16x16x32_bf16 v[100:103], a[60:63], v[188:191], v[100:103]
  ds_read_b128 v[172:175], v16 offset:63488
  v_mfma_f32_16x16x32_bf16 v[104:107], a[64:67], v[188:191], v[104:107]
  v_mfma_f32_16x16x32_bf16 v[108:111], a[68:71], v[188:191], v[108:111]
  s_waitcnt lgkmcnt(3)
  v_mfma_f32_16x16x32_bf16 v[64:67], a[72:75], v[160:163], v[64:67]
  ds_read_b128 v[176:179], v17 offset:57344
  v_mfma_f32_16x16x32_bf16 v[68:71], a[76:79], v[160:163], v[68:71]
  s_add_u32 m0, s31, 106496
  v_mfma_f32_16x16x32_bf16 v[72:75], a[80:83], v[160:163], v[72:75]
  s_waitcnt lgkmcnt(3)
  buffer_load_dwordx4 v10, s[8:11], s30 offen lds
  v_mfma_f32_16x16x32_bf16 v[76:79], a[72:75], v[164:167], v[76:79]
  ds_read_b128 v[180:183], v17 offset:59392
  v_mfma_f32_16x16x32_bf16 v[80:83], a[76:79], v[164:167], v[80:83]
  v_mfma_f32_16x16x32_bf16 v[84:87], a[80:83], v[164:167], v[84:87]
  s_waitcnt lgkmcnt(3)
  v_mfma_f32_16x16x32_bf16 v[88:91], a[72:75], v[168:171], v[88:91]
  ds_read_b128 v[184:187], v17 offset:61440
  v_mfma_f32_16x16x32_bf16 v[92:95], a[76:79], v[168:171], v[92:95]
  s_add_u32 m0, s31, 107520
  v_mfma_f32_16x16x32_bf16 v[96:99], a[80:83], v[168:171], v[96:99]
  s_waitcnt lgkmcnt(3)
  buffer_load_dwordx4 v11, s[8:11], s30 offen lds
  v_mfma_f32_16x16x32_bf16 v[100:103], a[72:75], v[172:175], v[100:103]
  s_add_u32 s30, s30, 128
  ds_read_b128 v[188:191], v17 offset:63488
  v_mfma_f32_16x16x32_bf16 v[104:107], a[76:79], v[172:175], v[104:107]
  v_mfma_f32_16x16x32_bf16 v[108:111], a[80:83], v[172:175], v[108:111]
  s_waitcnt lgkmcnt(3)
  v_mfma_f32_16x16x32_bf16 v[64:67], a[84:87], v[176:179], v[64:67]
  s_waitcnt vmcnt(4)
  s_barrier
  ds_read_b128 v[160:163], v18 offset:0
  v_mfma_f32_16x16x32_bf16 v[68:71], a[88:91], v[176:179], v[68:71]
  buffer_atomic_add v28, v27, s[72:75], s61 offen sc1
  v_mfma_f32_16x16x32_bf16 v[72:75], a[92:95], v[176:179], v[72:75]
  s_waitcnt lgkmcnt(3)
  s_mov_b32 s48, s27
  s_add_u32 s27, s27, s28
  v_mfma_f32_16x16x32_bf16 v[76:79], a[84:87], v[180:183], v[76:79]
  ds_read_b128 v[164:167], v18 offset:2048
  s_mov_b32 s61, s60
  v_mfma_f32_16x16x32_bf16 v[80:83], a[88:91], v[180:183], v[80:83]
  s_add_u32 s60, s60, 1024
  v_mfma_f32_16x16x32_bf16 v[84:87], a[92:95], v[180:183], v[84:87]
  s_waitcnt lgkmcnt(3)
  v_mfma_f32_16x16x32_bf16 v[88:91], a[84:87], v[184:187], v[88:91]
  ds_read_b128 v[168:171], v18 offset:4096
  v_mfma_f32_16x16x32_bf16 v[92:95], a[88:91], v[184:187], v[92:95]
  v_mfma_f32_16x16x32_bf16 v[96:99], a[92:95], v[184:187], v[96:99]
  s_waitcnt lgkmcnt(3)
  v_mfma_f32_16x16x32_bf16 v[100:103], a[84:87], v[188:191], v[100:103]
  ds_read_b128 v[172:175], v18 offset:6144
  v_mfma_f32_16x16x32_bf16 v[104:107], a[88:91], v[188:191], v[104:107]
  v_mfma_f32_16x16x32_bf16 v[108:111], a[92:95], v[188:191], v[108:111]
  s_waitcnt lgkmcnt(3)
  v_mfma_f32_16x16x32_bf16 v[64:67], a[96:99], v[160:163], v[64:67]
  ds_read_b128 v[176:179], v19 offset:0
  v_mfma_f32_16x16x32_bf16 v[68:71], a[100:103], v[160:163], v[68:71]
  s_add_u32 m0, s31, 114688
  v_mfma_f32_16x16x32_bf16 v[72:75], a[104:107], v[160:163], v[72:75]
  s_waitcnt lgkmcnt(3)
  buffer_load_dwordx4 v10, s[8:11], s30 offen lds
  v_mfma_f32_16x16x32_bf16 v[76:79], a[96:99], v[164:167], v[76:79]
  ds_read_b128 v[180:183], v19 offset:2048
  v_mfma_f32_16x16x32_bf16 v[80:83], a[100:103], v[164:167], v[80:83]
  v_mfma_f32_16x16x32_bf16 v[84:87], a[104:107], v[164:167], v[84:87]
  s_waitcnt lgkmcnt(3)
  v_mfma_f32_16x16x32_bf16 v[88:91], a[96:99], v[168:171], v[88:91]
  ds_read_b128 v[184:187], v19 offset:4096
  v_mfma_f32_16x16x32_bf16 v[92:95], a[100:103], v[168:171], v[92:95]
  s_add_u32 m0, s31, 115712
  v_mfma_f32_16x16x32_bf16 v[96:99], a[104:107], v[168:171], v[96:99]
  s_waitcnt lgkmcnt(3)
  buffer_load_dwordx4 v11, s[8:11], s30 offen lds
  v_mfma_f32_16x16x32_bf16 v[100:103], a[96:99], v[172:175], v[100:103]
  s_add_u32 s30, s30, 128
  ds_read_b128 v[188:191], v19 offset:6144
  v_mfma_f32_16x16x32_bf16 v[104:107], a[100:103], v[172:175], v[104:107]
  v_mfma_f32_16x16x32_bf16 v[108:111], a[104:107], v[172:175], v[108:111]
  s_waitcnt lgkmcnt(3)
  v_mfma_f32_16x16x32_bf16 v[64:67], a[108:111], v[176:179], v[64:67]
  s_waitcnt vmcnt(5)
  s_barrier
  ds_read_b128 v[160:163], v16 offset:32768
  v_mfma_f32_16x16x32_bf16 v[68:71], a[112:115], v[176:179], v[68:71]
  v_mfma_f32_16x16x32_bf16 v[72:75], a[116:119], v[176:179], v[72:75]
  s_waitcnt lgkmcnt(3)
  v_mfma_f32_16x16x32_bf16 v[76:79], a[108:111], v[180:183], v[76:79]
  ds_read_b128 v[164:167], v16 offset:34816
  v_mfma_f32_16x16x32_bf16 v[80:83], a[112:115], v[180:183], v[80:83]
  v_mfma_f32_16x16x32_bf16 v[84:87], a[116:119], v[180:183], v[84:87]
  s_waitcnt lgkmcnt(3)
  v_mfma_f32_16x16x32_bf16 v[88:91], a[108:111], v[184:187], v[88:91]
  ds_read_b128 v[168:171], v16 offset:36864
  v_mfma_f32_16x16x32_bf16 v[92:95], a[112:115], v[184:187], v[92:95]
  v_mfma_f32_16x16x32_bf16 v[96:99], a[116:119], v[184:187], v[96:99]
  s_waitcnt lgkmcnt(3)
  v_mfma_f32_16x16x32_bf16 v[100:103], a[108:111], v[188:191], v[100:103]
  ds_read_b128 v[172:175], v16 offset:38912
  v_mfma_f32_16x16x32_bf16 v[104:107], a[112:115], v[188:191], v[104:107]
  v_mfma_f32_16x16x32_bf16 v[108:111], a[116:119], v[188:191], v[108:111]
  s_waitcnt lgkmcnt(3)
  v_mfma_f32_16x16x32_bf16 v[64:67], a[120:123], v[160:163], v[64:67]
  ds_read_b128 v[176:179], v17 offset:32768
  v_mfma_f32_16x16x32_bf16 v[68:71], a[124:127], v[160:163], v[68:71]
  s_add_u32 m0, s31, 122880
  v_mfma_f32_16x16x32_bf16 v[72:75], a[128:131], v[160:163], v[72:75]
  s_waitcnt lgkmcnt(3)
  buffer_load_dwordx4 v10, s[8:11], s30 offen lds
  v_mfma_f32_16x16x32_bf16 v[76:79], a[120:123], v[164:167], v[76:79]
  ds_read_b128 v[180:183], v17 offset:34816
  v_mfma_f32_16x16x32_bf16 v[80:83], a[124:127], v[164:167], v[80:83]
  v_mfma_f32_16x16x32_bf16 v[84:87], a[128:131], v[164:167], v[84:87]
  s_waitcnt lgkmcnt(3)
  v_mfma_f32_16x16x32_bf16 v[88:91], a[120:123], v[168:171], v[88:91]
  ds_read_b128 v[184:187], v17 offset:36864
  v_mfma_f32_16x16x32_bf16 v[92:95], a[124:127], v[168:171], v[92:95]
  s_add_u32 m0, s31, 123904
  v_mfma_f32_16x16x32_bf16 v[96:99], a[128:131], v[168:171], v[96:99]
  s_waitcnt lgkmcnt(3)
  buffer_load_dwordx4 v11, s[8:11], s30 offen lds
  v_mfma_f32_16x16x32_bf16 v[100:103], a[120:123], v[172:175], v[100:103]
  s_add_u32 s30, s30, 128
  ds_read_b128 v[188:191], v17 offset:38912
  v_mfma_f32_16x16x32_bf16 v[104:107], a[124:127], v[172:175], v[104:107]
  v_mfma_f32_16x16x32_bf16 v[108:111], a[128:131], v[172:175], v[108:111]
  s_waitcnt lgkmcnt(3)
  v_mfma_f32_16x16x32_bf16 v[64:67], a[132:135], v[176:179], v[64:67]
  s_waitcnt vmcnt(5)
  s_barrier
  ds_read_b128 v[160:163], v16 offset:40960
  v_mfma_f32_16x16x32_bf16 v[68:71], a[136:139], v[176:179], v[68:71]
  v_mfma_f32_16x16x32_bf16 v[72:75], a[140:143], v[176:179], v[72:75]
  s_waitcnt lgkmcnt(3)
  v_mfma_f32_16x16x32_bf16 v[76:79], a[132:135], v[180:183], v[76:79]
  ds_read_b128 v[164:167], v16 offset:43008
  v_mfma_f32_16x16x32_bf16 v[80:83], a[136:139], v[180:183], v[80:83]
  v_mfma_f32_16x16x32_bf16 v[84:87], a[140:143], v[180:183], v[84:87]
  s_waitcnt lgkmcnt(3)
  v_mfma_f32_16x16x32_bf16 v[88:91], a[132:135], v[184:187], v[88:91]
  ds_read_b128 v[168:171], v16 offset:45056
  v_mfma_f32_16x16x32_bf16 v[92:95], a[136:139], v[184:187], v[92:95]
  v_mfma_f32_16x16x32_bf16 v[96:99], a[140:143], v[184:187], v[96:99]
  s_waitcnt lgkmcnt(3)
  v_mfma_f32_16x16x32_bf16 v[100:103], a[132:135], v[188:191], v[100:103]
  ds_read_b128 v[172:175], v16 offset:47104
  v_mfma_f32_16x16x32_bf16 v[104:107], a[136:139], v[188:191], v[104:107]
  v_mfma_f32_16x16x32_bf16 v[108:111], a[140:143], v[188:191], v[108:111]
  s_waitcnt lgkmcnt(3)
  v_mfma_f32_16x16x32_bf16 v[64:67], a[144:147], v[160:163], v[64:67]
  ds_read_b128 v[176:179], v17 offset:40960
  v_mfma_f32_16x16x32_bf16 v[68:71], a[148:151], v[160:163], v[68:71]
  s_add_u32 m0, s31, 131072
  v_mfma_f32_16x16x32_bf16 v[72:75], a[152:155], v[160:163], v[72:75]
  s_waitcnt lgkmcnt(3)
  buffer_load_dwordx4 v10, s[8:11], s30 offen lds
  v_mfma_f32_16x16x32_bf16 v[76:79], a[144:147], v[164:167], v[76:79]
  ds_read_b128 v[180:183], v17 offset:43008
  v_mfma_f32_16x16x32_bf16 v[80:83], a[148:151], v[164:167], v[80:83]
  v_mfma_f32_16x16x32_bf16 v[84:87], a[152:155], v[164:167], v[84:87]
  s_waitcnt lgkmcnt(3)
  v_mfma_f32_16x16x32_bf16 v[88:91], a[144:147], v[168:171], v[88:91]
  ds_read_b128 v[184:187], v17 offset:45056
  v_mfma_f32_16x16x32_bf16 v[92:95], a[148:151], v[168:171], v[92:95]
  s_add_u32 m0, s31, 132096
  v_mfma_f32_16x16x32_bf16 v[96:99], a[152:155], v[168:171], v[96:99]
  s_waitcnt lgkmcnt(3)
  buffer_load_dwordx4 v11, s[8:11], s30 offen lds
  v_mfma_f32_16x16x32_bf16 v[100:103], a[144:147], v[172:175], v[100:103]
  s_add_u32 s30, s30, s25
  ds_read_b128 v[188:191], v17 offset:47104
  v_mfma_f32_16x16x32_bf16 v[104:107], a[148:151], v[172:175], v[104:107]
  v_mfma_f32_16x16x32_bf16 v[108:111], a[152:155], v[172:175], v[108:111]
  s_waitcnt lgkmcnt(3)
  v_mfma_f32_16x16x32_bf16 v[64:67], a[156:159], v[176:179], v[64:67]
  s_waitcnt vmcnt(4)
  s_barrier
  ds_read_b128 v[160:163], v16 offset:49152
  v_mfma_f32_16x16x32_bf16 v[68:71], a[160:163], v[176:179], v[68:71]
  v_mfma_f32_16x16x32_bf16 v[72:75], a[164:167], v[176:179], v[72:75]
  s_waitcnt lgkmcnt(3)
  v_mfma_f32_16x16x32_bf16 v[76:79], a[156:159], v[180:183], v[76:79]
  ds_read_b128 v[164:167], v16 offset:51200
  v_mfma_f32_16x16x32_bf16 v[80:83], a[160:163], v[180:183], v[80:83]
  v_mfma_f32_16x16x32_bf16 v[84:87], a[164:167], v[180:183], v[84:87]
  s_waitcnt lgkmcnt(3)
  v_mfma_f32_16x16x32_bf16 v[88:91], a[156:159], v[184:187], v[88:91]
  ds_read_b128 v[168:171], v16 offset:53248
  v_mfma_f32_16x16x32_bf16 v[92:95], a[160:163], v[184:187], v[92:95]
  v_mfma_f32_16x16x32_bf16 v[96:99], a[164:167], v[184:187], v[96:99]
  s_waitcnt lgkmcnt(3)
  v_mfma_f32_16x16x32_bf16 v[100:103], a[156:159], v[188:191], v[100:103]
  ds_read_b128 v[172:175], v16 offset:55296
  v_mfma_f32_16x16x32_bf16 v[104:107], a[160:163], v[188:191], v[104:107]
  v_mfma_f32_16x16x32_bf16 v[108:111], a[164:167], v[188:191], v[108:111]
  s_waitcnt lgkmcnt(3)
  v_mfma_f32_16x16x32_bf16 v[64:67], a[168:171], v[160:163], v[64:67]
  ds_read_b128 v[176:179], v17 offset:49152
  v_mfma_f32_16x16x32_bf16 v[68:71], a[172:175], v[160:163], v[68:71]
  s_add_u32 m0, s31, 98304
  v_mfma_f32_16x16x32_bf16 v[72:75], a[176:179], v[160:163], v[72:75]
  s_waitcnt lgkmcnt(3)
  buffer_load_dwordx4 v10, s[8:11], s30 offen lds
  v_mfma_f32_16x16x32_bf16 v[76:79], a[168:171], v[164:167], v[76:79]
  ds_read_b128 v[180:183], v17 offset:51200
  v_mfma_f32_16x16x32_bf16 v[80:83], a[172:175], v[164:167], v[80:83]
  v_mfma_f32_16x16x32_bf16 v[84:87], a[176:179], v[164:167], v[84:87]
  s_waitcnt lgkmcnt(3)
  v_mfma_f32_16x16x32_bf16 v[88:91], a[168:171], v[168:171], v[88:91]
  ds_read_b128 v[184:187], v17 offset:53248
  v_mfma_f32_16x16x32_bf16 v[92:95], a[172:175], v[168:171], v[92:95]
  s_add_u32 m0, s31, 99328
  v_mfma_f32_16x16x32_bf16 v[96:99], a[176:179], v[168:171], v[96:99]
  s_waitcnt lgkmcnt(3)
  buffer_load_dwordx4 v11, s[8:11], s30 offen lds
  v_mfma_f32_16x16x32_bf16 v[100:103], a[168:171], v[172:175], v[100:103]
  s_add_u32 s30, s30, 128
  ds_read_b128 v[188:191], v17 offset:55296
  v_mfma_f32_16x16x32_bf16 v[104:107], a[172:175], v[172:175], v[104:107]
  v_mfma_f32_16x16x32_bf16 v[108:111], a[176:179], v[172:175], v[108:111]
  s_waitcnt lgkmcnt(3)
  v_mfma_f32_16x16x32_bf16 v[64:67], a[180:183], v[176:179], v[64:67]
  s_waitcnt vmcnt(4)
  s_barrier
  ds_read_b128 v[160:163], v16 offset:57344
  v_mfma_f32_16x16x32_bf16 v[68:71], a[184:187], v[176:179], v[68:71]
  v_mfma_f32_16x16x32_bf16 v[72:75], a[188:191], v[176:179], v[72:75]
  s_waitcnt lgkmcnt(3)
  v_mfma_f32_16x16x32_bf16 v[76:79], a[180:183], v[180:183], v[76:79]
  ds_read_b128 v[164:167], v16 offset:59392
  v_mfma_f32_16x16x32_bf16 v[80:83], a[184:187], v[180:183], v[80:83]
  v_mfma_f32_16x16x32_bf16 v[84:87], a[188:191], v[180:183], v[84:87]
  s_waitcnt lgkmcnt(3)
  v_mfma_f32_16x16x32_bf16 v[88:91], a[180:183], v[184:187], v[88:91]
  ds_read_b128 v[168:171], v16 offset:61440
  v_mfma_f32_16x16x32_bf16 v[92:95], a[184:187], v[184:187], v[92:95]
  v_mfma_f32_16x16x32_bf16 v[96:99], a[188:191], v[184:187], v[96:99]
  s_waitcnt lgkmcnt(3)
  v_mfma_f32_16x16x32_bf16 v[100:103], a[180:183], v[188:191], v[100:103]
  ds_read_b128 v[172:175], v16 offset:63488
  v_mfma_f32_16x16x32_bf16 v[104:107], a[184:187], v[188:191], v[104:107]
  v_mfma_f32_16x16x32_bf16 v[108:111], a[188:191], v[188:191], v[108:111]
  s_waitcnt lgkmcnt(3)
  v_mfma_f32_16x16x32_bf16 v[64:67], a[192:195], v[160:163], v[64:67]
  ds_read_b128 v[176:179], v17 offset:57344
  v_mfma_f32_16x16x32_bf16 v[68:71], a[196:199], v[160:163], v[68:71]
  s_add_u32 m0, s31, 106496
  v_mfma_f32_16x16x32_bf16 v[72:75], a[200:203], v[160:163], v[72:75]
  s_waitcnt lgkmcnt(3)
  buffer_load_dwordx4 v10, s[8:11], s30 offen lds
  v_mfma_f32_16x16x32_bf16 v[76:79], a[192:195], v[164:167], v[76:79]
  ds_read_b128 v[180:183], v17 offset:59392
  v_mfma_f32_16x16x32_bf16 v[80:83], a[196:199], v[164:167], v[80:83]
  v_mfma_f32_16x16x32_bf16 v[84:87], a[200:203], v[164:167], v[84:87]
  s_waitcnt lgkmcnt(3)
  v_mfma_f32_16x16x32_bf16 v[88:91], a[192:195], v[168:171], v[88:91]
  ds_read_b128 v[184:187], v17 offset:61440
  v_mfma_f32_16x16x32_bf16 v[92:95], a[196:199], v[168:171], v[92:95]
  s_add_u32 m0, s31, 107520
  v_mfma_f32_16x16x32_bf16 v[96:99], a[200:203], v[168:171], v[96:99]
  s_waitcnt lgkmcnt(3)
  buffer_load_dwordx4 v11, s[8:11], s30 offen lds
  v_mfma_f32_16x16x32_bf16 v[100:103], a[192:195], v[172:175], v[100:103]
  s_add_u32 s30, s30, 128
  ds_read_b128 v[188:191], v17 offset:63488
  v_mfma_f32_16x16x32_bf16 v[104:107], a[196:199], v[172:175], v[104:107]
  v_mfma_f32_16x16x32_bf16 v[108:111], a[200:203], v[172:175], v[108:111]
  s_waitcnt lgkmcnt(3)
  v_mfma_f32_16x16x32_bf16 v[64:67], a[204:207], v[176:179], v[64:67]
  s_waitcnt vmcnt(4)
  s_barrier
  ds_read_b128 v[160:163], v18 offset:0
  v_mfma_f32_16x16x32_bf16 v[68:71], a[208:211], v[176:179], v[68:71]
  v_mfma_f32_16x16x32_bf16 v[72:75], a[212:215], v[176:179], v[72:75]
  s_waitcnt lgkmcnt(3)
  v_mfma_f32_16x16x32_bf16 v[76:79], a[204:207], v[180:183], v[76:79]
  ds_read_b128 v[164:167], v18 offset:2048
  v_mfma_f32_16x16x32_bf16 v[80:83], a[208:211], v[180:183], v[80:83]
  v_mfma_f32_16x16x32_bf16 v[84:87], a[212:215], v[180:183], v[84:87]
  s_waitcnt lgkmcnt(3)
  v_mfma_f32_16x16x32_bf16 v[88:91], a[204:207], v[184:187], v[88:91]
  ds_read_b128 v[168:171], v18 offset:4096
  v_mfma_f32_16x16x32_bf16 v[92:95], a[208:211], v[184:187], v[92:95]
  v_mfma_f32_16x16x32_bf16 v[96:99], a[212:215], v[184:187], v[96:99]
  s_waitcnt lgkmcnt(3)
  v_mfma_f32_16x16x32_bf16 v[100:103], a[204:207], v[188:191], v[100:103]
  ds_read_b128 v[172:175], v18 offset:6144
  v_mfma_f32_16x16x32_bf16 v[104:107], a[208:211], v[188:191], v[104:107]
  v_mfma_f32_16x16x32_bf16 v[108:111], a[212:215], v[188:191], v[108:111]
  s_waitcnt lgkmcnt(3)
  v_mfma_f32_16x16x32_bf16 v[64:67], a[216:219], v[160:163], v[64:67]
  ds_read_b128 v[176:179], v19 offset:0
  v_mfma_f32_16x16x32_bf16 v[68:71], a[220:223], v[160:163], v[68:71]
  s_add_u32 m0, s31, 114688
  v_mfma_f32_16x16x32_bf16 v[72:75], a[224:227], v[160:163], v[72:75]
  s_waitcnt lgkmcnt(3)
  buffer_load_dwordx4 v10, s[8:11], s30 offen lds
  v_mfma_f32_16x16x32_bf16 v[76:79], a[216:219], v[164:167], v[76:79]
  ds_read_b128 v[180:183], v19 offset:2048
  v_mfma_f32_16x16x32_bf16 v[80:83], a[220:223], v[164:167], v[80:83]
  v_mfma_f32_16x16x32_bf16 v[84:87], a[224:227], v[164:167], v[84:87]
  s_waitcnt lgkmcnt(3)
  v_mfma_f32_16x16x32_bf16 v[88:91], a[216:219], v[168:171], v[88:91]
  ds_read_b128 v[184:187], v19 offset:4096
  v_mfma_f32_16x16x32_bf16 v[92:95], a[220:223], v[168:171], v[92:95]
  s_add_u32 m0, s31, 115712
  v_mfma_f32_16x16x32_bf16 v[96:99], a[224:227], v[168:171], v[96:99]
  s_waitcnt lgkmcnt(3)
  buffer_load_dwordx4 v11, s[8:11], s30 offen lds
  v_mfma_f32_16x16x32_bf16 v[100:103], a[216:219], v[172:175], v[100:103]
  s_add_u32 s30, s30, 128
  ds_read_b128 v[188:191], v19 offset:6144
  v_mfma_f32_16x16x32_bf16 v[104:107], a[220:223], v[172:175], v[104:107]
  v_mfma_f32_16x16x32_bf16 v[108:111], a[224:227], v[172:175], v[108:111]
  s_waitcnt lgkmcnt(3)
  v_mfma_f32_16x16x32_bf16 v[64:67], a[228:231], v[176:179], v[64:67]
  s_waitcnt vmcnt(4)
  s_barrier
  ds_read_b128 v[160:163], v16 offset:32768
  v_mfma_f32_16x16x32_bf16 v[68:71], a[232:235], v[176:179], v[68:71]
  v_mfma_f32_16x16x32_bf16 v[72:75], a[236:239], v[176:179], v[72:75]
  s_waitcnt lgkmcnt(3)
  v_mfma_f32_16x16x32_bf16 v[76:79], a[228:231], v[180:183], v[76:79]
  ds_read_b128 v[164:167], v16 offset:34816
  v_cvt_pk_bf16_f32 v192, v64, v65
  v_mfma_f32_16x16x32_bf16 v[80:83], a[232:235], v[180:183], v[80:83]
  v_cvt_pk_bf16_f32 v193, v66, v67
  v_cvt_pk_bf16_f32 v194, v68, v69
  v_mfma_f32_16x16x32_bf16 v[84:87], a[236:239], v[180:183], v[84:87]
  s_waitcnt lgkmcnt(3)
  v_cvt_pk_bf16_f32 v195, v70, v71
  v_cvt_pk_bf16_f32 v200, v72, v73
  v_mfma_f32_16x16x32_bf16 v[88:91], a[228:231], v[184:187], v[88:91]
  ds_read_b128 v[168:171], v16 offset:36864
  v_cvt_pk_bf16_f32 v201, v74, v75
  v_mfma_f32_16x16x32_bf16 v[92:95], a[232:235], v[184:187], v[92:95]
  v_cvt_pk_bf16_f32 v196, v76, v77
  v_cvt_pk_bf16_f32 v197, v78, v79
  v_mfma_f32_16x16x32_bf16 v[96:99], a[236:239], v[184:187], v[96:99]
  s_waitcnt lgkmcnt(3)
  v_cvt_pk_bf16_f32 v198, v80, v81
  v_cvt_pk_bf16_f32 v199, v82, v83
  v_mfma_f32_16x16x32_bf16 v[100:103], a[228:231], v[188:191], v[100:103]
  ds_read_b128 v[172:175], v16 offset:38912
  v_cvt_pk_bf16_f32 v202, v84, v85
  v_mfma_f32_16x16x32_bf16 v[104:107], a[232:235], v[188:191], v[104:107]
  s_sub_u32 s26, s26, 1
  s_cmp_gt_u32 s26, 0
  v_cvt_pk_bf16_f32 v203, v86, v87
  v_mfma_f32_16x16x32_bf16 v[108:111], a[236:239], v[188:191], v[108:111]
  s_waitcnt lgkmcnt(3)
  s_cbranch_scc1 kvm_196
  s_nop 7
  v_cvt_pk_bf16_f32 v204, v88, v89
  v_cvt_pk_bf16_f32 v205, v90, v91
  v_cvt_pk_bf16_f32 v206, v92, v93
  v_cvt_pk_bf16_f32 v207, v94, v95
  v_cvt_pk_bf16_f32 v212, v96, v97
  v_cvt_pk_bf16_f32 v213, v98, v99
  v_cvt_pk_bf16_f32 v208, v100, v101
  v_cvt_pk_bf16_f32 v209, v102, v103
  v_cvt_pk_bf16_f32 v210, v104, v105
  v_cvt_pk_bf16_f32 v211, v106, v107
  v_cvt_pk_bf16_f32 v214, v108, v109
  v_cvt_pk_bf16_f32 v215, v110, v111
  s_add_u32 s29, s48, 0
  buffer_store_dwordx4 v[192:195], v26, s[16:19], s29 offen offset:0 sc1
  buffer_store_dwordx4 v[196:199], v26, s[16:19], s29 offen offset:1024 sc1
  buffer_store_dwordx4 v[200:203], v26, s[16:19], s29 offen offset:2048 sc1
  s_add_u32 s29, s48, 393216
  buffer_store_dwordx4 v[204:207], v26, s[16:19], s29 offen offset:0 sc1
  buffer_store_dwordx4 v[208:211], v26, s[16:19], s29 offen offset:1024 sc1
  buffer_store_dwordx4 v[212:215], v26, s[16:19], s29 offen offset:2048 sc1
  s_mov_b32 s30, 327680
  s_mov_b32 s25, 162688
  v_lshrrev_b32 v4, 3, v1
  v_and_b32 v5, 7, v1
  v_xor_b32 v5, v5, v4
  s_mul_i32 s21, s20, 32
  v_add_u32 v4, s21, v4
  v_mul_u32_u24 v4, 1280, v4
  v_lshl_add_u32 v10, v5, 4, v4
  s_mul_i32 s31, s20, 4096
  v_add_u32 v11, 10240, v10
  v_add_u32 v12, 20480, v10
  v_add_u32 v13, 30720, v10
  s_add_u32 m0, s31, 0
  s_nop 0
  buffer_load_dwordx4 v10, s[8:11], s30 offen lds
  s_add_u32 m0, s31, 1024
  s_nop 0
  buffer_load_dwordx4 v11, s[8:11], s30 offen lds
  s_add_u32 m0, s31, 2048
  s_nop 0
  buffer_load_dwordx4 v12, s[8:11], s30 offen lds
  s_add_u32 m0, s31, 3072
  s_nop 0
  buffer_load_dwordx4 v13, s[8:11], s30 offen lds
  s_add_u32 s30, s30, 128
  s_add_u32 m0, s31, 16384
  s_nop 0
  buffer_load_dwordx4 v10, s[8:11], s30 offen lds
  s_add_u32 m0, s31, 17408
  s_nop 0
  buffer_load_dwordx4 v11, s[8:11], s30 offen lds
  s_add_u32 m0, s31, 18432
  s_nop 0
  buffer_load_dwordx4 v12, s[8:11], s30 offen lds
  s_add_u32 m0, s31, 19456
  s_nop 0
  buffer_load_dwordx4 v13, s[8:11], s30 offen lds
  s_add_u32 s30, s30, 128
  s_add_u32 m0, s31, 32768
  s_nop 0
  buffer_load_dwordx4 v10, s[8:11], s30 offen lds
  s_add_u32 m0, s31, 33792
  s_nop 0
  buffer_load_dwordx4 v11, s[8:11], s30 offen lds
  s_add_u32 m0, s31, 34816
  s_nop 0
  buffer_load_dwordx4 v12, s[8:11], s30 offen lds
  s_add_u32 m0, s31, 35840
  s_nop 0
  buffer_load_dwordx4 v13, s[8:11], s30 offen lds
  s_add_u32 s30, s30, 128
  s_add_u32 m0, s31, 49152
  s_nop 0
  buffer_load_dwordx4 v10, s[8:11], s30 offen lds
  s_add_u32 m0, s31, 50176
  s_nop 0
  buffer_load_dwordx4 v11, s[8:11], s30 offen lds
  s_add_u32 m0, s31, 51200
  s_nop 0
  buffer_load_dwordx4 v12, s[8:11], s30 offen lds
  s_add_u32 m0, s31, 52224
  s_nop 0
  buffer_load_dwordx4 v13, s[8:11], s30 offen lds
  s_add_u32 s30, s30, 128
  s_add_u32 m0, s31, 65536
  s_nop 0
  buffer_load_dwordx4 v10, s[8:11], s30 offen lds
  s_add_u32 m0, s31, 66560
  s_nop 0
  buffer_load_dwordx4 v11, s[8:11], s30 offen lds
  s_add_u32 m0, s31, 67584
  s_nop 0
  buffer_load_dwordx4 v12, s[8:11], s30 offen lds
  s_add_u32 m0, s31, 68608
  s_nop 0
  buffer_load_dwordx4 v13, s[8:11], s30 offen lds
  s_add_u32 s30, s30, 128
  s_add_u32 m0, s31, 81920
  s_nop 0
  buffer_load_dwordx4 v10, s[8:11], s30 offen lds
  s_add_u32 m0, s31, 82944
  s_nop 0
  buffer_load_dwordx4 v11, s[8:11], s30 offen lds
  s_add_u32 m0, s31, 83968
  s_nop 0
  buffer_load_dwordx4 v12, s[8:11], s30 offen lds
  s_add_u32 m0, s31, 84992
  s_nop 0
  buffer_load_dwordx4 v13, s[8:11], s30 offen lds
  s_add_u32 s30, s30, 128
  s_waitcnt vmcnt(24) lgkmcnt(0)
  s_barrier
  buffer_atomic_add v28, v27, s[72:75], s61 offen sc1
  s_add_u32 m0, s31, 98304
  s_nop 0
  buffer_load_dwordx4 v10, s[8:11], s30 offen lds
  s_add_u32 m0, s31, 99328
  s_nop 0
  buffer_load_dwordx4 v11, s[8:11], s30 offen lds
  s_add_u32 m0, s31, 100352
  s_nop 0
  buffer_load_dwordx4 v12, s[8:11], s30 offen lds
  s_add_u32 m0, s31, 101376
  s_nop 0
  buffer_load_dwordx4 v13, s[8:11], s30 offen lds
  s_add_u32 s30, s30, 128
  s_add_u32 m0, s31, 114688
  s_nop 0
  buffer_load_dwordx4 v10, s[8:11], s30 offen lds
  s_add_u32 m0, s31, 115712
  s_nop 0
  buffer_load_dwordx4 v11, s[8:11], s30 offen lds
  s_add_u32 m0, s31, 116736
  s_nop 0
  buffer_load_dwordx4 v12, s[8:11], s30 offen lds
  s_add_u32 m0, s31, 117760
  s_nop 0
  buffer_load_dwordx4 v13, s[8:11], s30 offen lds
  s_add_u32 s30, s30, 128
  s_mov_b32 s26, 14
  s_mov_b32 s28, 1572864
  s_mov_b32 s48, 0x40000000
  s_mov_b32 s61, 0x40000000
  s_waitcnt vmcnt(28)
  s_barrier
  ds_read_b128 v[160:163], v14 offset:0
  ds_read_b128 v[164:167], v14 offset:2048
  ds_read_b128 v[168:171], v14 offset:4096
  ds_read_b128 v[172:175], v14 offset:6144
  s_waitcnt lgkmcnt(3)
  .p2align 3
kvs_197:
  v_mfma_f32_16x16x32_bf16 v[64:67], a[0:3], v[160:163], 0
  s_add_u32 s29, s48, 0
  ds_read_b128 v[176:179], v14 offset:8192
  v_cvt_pk_bf16_f32 v221, v126, v127
  v_mfma_f32_16x16x32_bf16 v[68:71], a[4:7], v[160:163], 0
  v_cvt_pk_bf16_f32 v222, v128, v129
  v_cvt_pk_bf16_f32 v223, v130, v131
  v_mfma_f32_16x16x32_bf16 v[72:75], a[8:11], v[160:163], 0
  s_waitcnt lgkmcnt(3)
  v_cvt_pk_bf16_f32 v226, v132, v133
  v_cvt_pk_bf16_f32 v227, v134, v135
  v_mfma_f32_16x16x32_bf16 v[76:79], a[0:3], v[164:167], 0
  ds_read_b128 v[180:183], v14 offset:10240
  v_cvt_pk_bf16_f32 v228, v136, v137
  v_mfma_f32_16x16x32_bf16 v[80:83], a[4:7], v[164:167], 0
  v_cvt_pk_bf16_f32 v229, v138, v139
  v_cvt_pk_bf16_f32 v230, v140, v141
  v_mfma_f32_16x16x32_bf16 v[84:87], a[8:11], v[164:167], 0
  s_waitcnt lgkmcnt(3)
  v_cvt_pk_bf16_f32 v231, v142, v143
  v_cvt_pk_bf16_f32 v236, v144, v145
  v_mfma_f32_16x16x32_bf16 v[88:91], a[0:3], v[168:171], 0
  ds_read_b128 v[184:187], v14 offset:12288
  v_cvt_pk_bf16_f32 v237, v146, v147
  v_mfma_f32_16x16x32_bf16 v[92:95], a[4:7], v[168:171], 0
  v_cvt_pk_bf16_f32 v232, v148, v149
  v_cvt_pk_bf16_f32 v233, v150, v151
  v_mfma_f32_16x16x32_bf16 v[96:99], a[8:11], v[168:171], 0
  s_waitcnt lgkmcnt(3)
  v_cvt_pk_bf16_f32 v234, v152, v153
  v_cvt_pk_bf16_f32 v235, v154, v155
  v_mfma_f32_16x16x32_bf16 v[100:103], a[0:3], v[172:175], 0
  ds_read_b128 v[188:191], v14 offset:14336
  v_cvt_pk_bf16_f32 v238, v156, v157
  v_mfma_f32_16x16x32_bf16 v[104:107], a[4:7], v[172:175], 0
  v_cvt_pk_bf16_f32 v239, v158, v159
  buffer_store_dwordx4 v[192:195], v26, s[16:19], s29 offen offset:0 sc1
  v_mfma_f32_16x16x32_bf16 v[108:111], a[8:11], v[172:175], 0
  s_waitcnt lgkmcnt(3)
  v_mfma_f32_16x16x32_bf16 v[112:115], a[0:3], v[176:179], 0
  ds_read_b128 v[160:163], v15 offset:0
  v_mfma_f32_16x16x32_bf16 v[116:119], a[4:7], v[176:179], 0
  s_add_u32 m0, s31, 131072
  v_mfma_f32_16x16x32_bf16 v[120:123], a[8:11], v[176:179], 0
  s_waitcnt lgkmcnt(3)
  buffer_load_dwordx4 v10, s[8:11], s30 offen lds
  v_mfma_f32_16x16x32_bf16 v[124:127], a[0:3], v[180:183], 0
  ds_read_b128 v[164:167], v15 offset:2048
  v_mfma_f32_16x16x32_bf16 v[128:131], a[4:7], v[180:183], 0
  v_mfma_f32_16x16x32_bf16 v[132:135], a[8:11], v[180:183], 0
  s_waitcnt lgkmcnt(3)
  buffer_store_dwordx4 v[196:199], v26, s[16:19], s29 offen offset:1024 sc1
  v_mfma_f32_16x16x32_bf16 v[136:139], a[0:3], v[184:187], 0
  ds_read_b128 v[168:171], v15 offset:4096
  v_mfma_f32_16x16x32_bf16 v[140:143], a[4:7], v[184:187], 0
  s_add_u32 m0, s31, 132096
  v_mfma_f32_16x16x32_bf16 v[144:147], a[8:11], v[184:187], 0
  s_waitcnt lgkmcnt(3)
  buffer_load_dwordx4 v11, s[8:11], s30 offen lds
  v_mfma_f32_16x16x32_bf16 v[148:151], a[0:3], v[188:191], 0
  ds_read_b128 v[172:175], v15 offset:6144
  v_mfma_f32_16x16x32_bf16 v[152:155], a[4:7], v[188:191], 0
  v_mfma_f32_16x16x32_bf16 v[156:159], a[8:11], v[188:191], 0
  s_waitcnt lgkmcnt(3)
  v_mfma_f32_16x16x32_bf16 v[64:67], a[12:15], v[160:163], v[64:67]
  ds_read_b128 v[176:179], v15 offset:8192
  buffer_store_dwordx4 v[200:203], v26, s[16:19], s29 offen offset:2048 sc1
  v_mfma_f32_16x16x32_bf16 v[68:71], a[16:19], v[160:163], v[68:71]
  s_add_u32 m0, s31, 133120
  v_mfma_f32_16x16x32_bf16 v[72:75], a[20:23], v[160:163], v[72:75]
  s_waitcnt lgkmcnt(3)
  buffer_load_dwordx4 v12, s[8:11], s30 offen lds
  v_mfma_f32_16x16x32_bf16 v[76:79], a[12:15], v[164:167], v[76:79]
  ds_read_b128 v[180:183], v15 offset:10240
  v_mfma_f32_16x16x32_bf16 v[80:83], a[16:19], v[164:167], v[80:83]
  v_mfma_f32_16x16x32_bf16 v[84:87], a[20:23], v[164:167], v[84:87]
  s_waitcnt lgkmcnt(3)
  v_mfma_f32_16x16x32_bf16 v[88:91], a[12:15], v[168:171], v[88:91]
  s_add_u32 s29, s48, 393216
  ds_read_b128 v[184:187], v15 offset:12288
  v_mfma_f32_16x16x32_bf16 v[92:95], a[16:19], v[168:171], v[92:95]
  s_add_u32 m0, s31, 134144
  buffer_store_dwordx4 v[204:207], v26, s[16:19], s29 offen offset:0 sc1
  v_mfma_f32_16x16x32_bf16 v[96:99], a[20:23], v[168:171], v[96:99]
  s_waitcnt lgkmcnt(3)
  buffer_load_dwordx4 v13, s[8:11], s30 offen lds
  v_mfma_f32_16x16x32_bf16 v[100:103], a[12:15], v[172:175], v[100:103]
  s_add_u32 s30, s30, 128
  ds_read_b128 v[188:191], v15 offset:14336
  v_mfma_f32_16x16x32_bf16 v[104:107], a[16:19], v[172:175], v[104:107]
  v_mfma_f32_16x16x32_bf16 v[108:111], a[20:23], v[172:175], v[108:111]
  s_waitcnt lgkmcnt(3)
  v_mfma_f32_16x16x32_bf16 v[112:115], a[12:15], v[176:179], v[112:115]
  s_waitcnt vmcnt(32)
  s_barrier
  ds_read_b128 v[160:163], v14 offset:16384
  v_mfma_f32_16x16x32_bf16 v[116:119], a[16:19], v[176:179], v[116:119]
  v_mfma_f32_16x16x32_bf16 v[120:123], a[20:23], v[176:179], v[120:123]
  s_waitcnt lgkmcnt(3)
  buffer_store_dwordx4 v[208:211], v26, s[16:19], s29 offen offset:1024 sc1
  v_mfma_f32_16x16x32_bf16 v[124:127], a[12:15], v[180:183], v[124:127]
  ds_read_b128 v[164:167], v14 offset:18432
  v_mfma_f32_16x16x32_bf16 v[128:131], a[16:19], v[180:183], v[128:131]
  v_mfma_f32_16x16x32_bf16 v[132:135], a[20:23], v[180:183], v[132:135]
  s_waitcnt lgkmcnt(3)
  v_mfma_f32_16x16x32_bf16 v[136:139], a[12:15], v[184:187], v[136:139]
  ds_read_b128 v[168:171], v14 offset:20480
  v_mfma_f32_16x16x32_bf16 v[140:143], a[16:19], v[184:187], v[140:143]
  v_mfma_f32_16x16x32_bf16 v[144:147], a[20:23], v[184:187], v[144:147]
  s_waitcnt lgkmcnt(3)
  v_mfma_f32_16x16x32_bf16 v[148:151], a[12:15], v[188:191], v[148:151]
  ds_read_b128 v[172:175], v14 offset:22528
  buffer_store_dwordx4 v[212:215], v26, s[16:19], s29 offen offset:2048 sc1
  v_mfma_f32_16x16x32_bf16 v[152:155], a[16:19], v[188:191], v[152:155]
  v_mfma_f32_16x16x32_bf16 v[156:159], a[20:23], v[188:191], v[156:159]
  s_waitcnt lgkmcnt(3)
  v_mfma_f32_16x16x32_bf16 v[64:67], a[24:27], v[160:163], v[64:67]
  ds_read_b128 v[176:179], v14 offset:24576
  v_mfma_f32_16x16x32_bf16 v[68:71], a[28:31], v[160:163], v[68:71]
  s_add_u32 m0, s31, 147456
  v_mfma_f32_16x16x32_bf16 v[72:75], a[32:35], v[160:163], v[72:75]
  s_waitcnt lgkmcnt(3)
  buffer_load_dwordx4 v10, s[8:11], s30 offen lds
  v_mfma_f32_16x16x32_bf16 v[76:79], a[24:27], v[164:167], v[76:79]
  s_add_u32 s29, s48, 786432
  ds_read_b128 v[180:183], v14 offset:26624
  v_mfma_f32_16x16x32_bf16 v[80:83], a[28:31], v[164:167], v[80:83]
  buffer_store_dwordx4 v[216:219], v26, s[16:19], s29 offen offset:0 sc1
  v_mfma_f32_16x16x32_bf16 v[84:87], a[32:35], v[164:167], v[84:87]
  s_waitcnt lgkmcnt(3)
  v_mfma_f32_16x16x32_bf16 v[88:91], a[24:27], v[168:171], v[88:91]
  ds_read_b128 v[184:187], v14 offset:28672
  v_mfma_f32_16x16x32_bf16 v[92:95], a[28:31], v[168:171], v[92:95]
  s_add_u32 m0, s31, 148480
  v_mfma_f32_16x16x32_bf16 v[96:99], a[32:35], v[168:171], v[96:99]
  s_waitcnt lgkmcnt(3)
  buffer_load_dwordx4 v11, s[8:11], s30 offen lds
  v_mfma_f32_16x16x32_bf16 v[100:103], a[24:27], v[172:175], v[100:103]
  ds_read_b128 v[188:191], v14 offset:30720
  v_mfma_f32_16x16x32_bf16 v[104:107], a[28:31], v[172:175], v[104:107]
  v_mfma_f32_16x16x32_bf16 v[108:111], a[32:35], v[172:175], v[108:111]
  s_waitcnt lgkmcnt(3)
  buffer_store_dwordx4 v[220:223], v26, s[16:19], s29 offen offset:1024 sc1
  v_mfma_f32_16x16x32_bf16 v[112:115], a[24:27], v[176:179], v[112:115]
  ds_read_b128 v[160:163], v15 offset:16384
  v_mfma_f32_16x16x32_bf16 v[116:119], a[28:31], v[176:179], v[116:119]
  s_add_u32 m0, s31, 149504
  v_mfma_f32_16x16x32_bf16 v[120:123], a[32:35], v[176:179], v[120:123]
  s_waitcnt lgkmcnt(3)
  buffer_load_dwordx4 v12, s[8:11], s30 offen lds
  v_mfma_f32_16x16x32_bf16 v[124:127], a[24:27], v[180:183], v[124:127]
  ds_read_b128 v[164:167], v15 offset:18432
  v_mfma_f32_16x16x32_bf16 v[128:131], a[28:31], v[180:183], v[128:131]
  v_mfma_f32_16x16x32_bf16 v[132:135], a[32:35], v[180:183], v[132:135]
  s_waitcnt lgkmcnt(3)
  v_mfma_f32_16x16x32_bf16 v[136:139], a[24:27], v[184:187], v[136:139]
  ds_read_b128 v[168:171], v15 offset:20480
  buffer_store_dwordx4 v[224:227], v26, s[16:19], s29 offen offset:2048 sc1
  v_mfma_f32_16x16x32_bf16 v[140:143], a[28:31], v[184:187], v[140:143]
  s_add_u32 m0, s31, 150528
  v_mfma_f32_16x16x32_bf16 v[144:147], a[32:35], v[184:187], v[144:147]
  s_waitcnt lgkmcnt(3)
  buffer_load_dwordx4 v13, s[8:11], s30 offen lds
  v_mfma_f32_16x16x32_bf16 v[148:151], a[24:27], v[188:191], v[148:151]
  s_add_u32 s30, s30, s25
  ds_read_b128 v[172:175], v15 offset:22528
  v_mfma_f32_16x16x32_bf16 v[152:155], a[28:31], v[188:191], v[152:155]
  v_mfma_f32_16x16x32_bf16 v[156:159], a[32:35], v[188:191], v[156:159]
  s_waitcnt lgkmcnt(3)
  v_mfma_f32_16x16x32_bf16 v[64:67], a[36:39], v[160:163], v[64:67]
  s_add_u32 s29, s48, 1179648
  ds_read_b128 v[176:179], v15 offset:24576
  v_mfma_f32_16x16x32_bf16 v[68:71], a[40:43], v[160:163], v[68:71]
  buffer_store_dwordx4 v[228:231], v26, s[16:19], s29 offen offset:0 sc1
  v_mfma_f32_16x16x32_bf16 v[72:75], a[44:47], v[160:163], v[72:75]
  s_waitcnt lgkmcnt(3)
  v_mfma_f32_16x16x32_bf16 v[76:79], a[36:39], v[164:167], v[76:79]
  ds_read_b128 v[180:183], v15 offset:26624
  v_mfma_f32_16x16x32_bf16 v[80:83], a[40:43], v[164:167], v[80:83]
  v_mfma_f32_16x16x32_bf16 v[84:87], a[44:47], v[164:167], v[84:87]
  s_waitcnt lgkmcnt(3)
  v_mfma_f32_16x16x32_bf16 v[88:91], a[36:39], v[168:171], v[88:91]
  ds_read_b128 v[184:187], v15 offset:28672
  v_mfma_f32_16x16x32_bf16 v[92:95], a[40:43], v[168:171], v[92:95]
  v_mfma_f32_16x16x32_bf16 v[96:99], a[44:47], v[168:171], v[96:99]
  s_waitcnt lgkmcnt(3)
  buffer_store_dwordx4 v[232:235], v26, s[16:19], s29 offen offset:1024 sc1
  v_mfma_f32_16x16x32_bf16 v[100:103], a[36:39], v[172:175], v[100:103]
  ds_read_b128 v[188:191], v15 offset:30720
  v_mfma_f32_16x16x32_bf16 v[104:107], a[40:43], v[172:175], v[104:107]
  v_mfma_f32_16x16x32_bf16 v[108:111], a[44:47], v[172:175], v[108:111]
  s_waitcnt lgkmcnt(3)
  v_mfma_f32_16x16x32_bf16 v[112:115], a[36:39], v[176:179], v[112:115]
  s_waitcnt vmcnt(39)
  s_barrier
  ds_read_b128 v[160:163], v14 offset:32768
  v_mfma_f32_16x16x32_bf16 v[116:119], a[40:43], v[176:179], v[116:119]
  v_mfma_f32_16x16x32_bf16 v[120:123], a[44:47], v[176:179], v[120:123]
  s_waitcnt lgkmcnt(3)
  v_mfma_f32_16x16x32_bf16 v[124:127], a[36:39], v[180:183], v[124:127]
  ds_read_b128 v[164:167], v14 offset:34816
  buffer_store_dwordx4 v[236:239], v26, s[16:19], s29 offen offset:2048 sc1
  v_mfma_f32_16x16x32_bf16 v[128:131], a[40:43], v[180:183], v[128:131]
  v_mfma_f32_16x16x32_bf16 v[132:135], a[44:47], v[180:183], v[132:135]
  s_waitcnt lgkmcnt(3)
  v_mfma_f32_16x16x32_bf16 v[136:139], a[36:39], v[184:187], v[136:139]
  ds_read_b128 v[168:171], v14 offset:36864
  v_mfma_f32_16x16x32_bf16 v[140:143], a[40:43], v[184:187], v[140:143]
  v_mfma_f32_16x16x32_bf16 v[144:147], a[44:47], v[184:187], v[144:147]
  s_waitcnt lgkmcnt(3)
  v_mfma_f32_16x16x32_bf16 v[148:151], a[36:39], v[188:191], v[148:151]
  ds_read_b128 v[172:175], v14 offset:38912
  v_mfma_f32_16x16x32_bf16 v[152:155], a[40:43], v[188:191], v[152:155]
  v_mfma_f32_16x16x32_bf16 v[156:159], a[44:47], v[188:191], v[156:159]
  s_waitcnt lgkmcnt(3)
  v_mfma_f32_16x16x32_bf16 v[64:67], a[48:51], v[160:163], v[64:67]
  ds_read_b128 v[176:179], v14 offset:40960
  v_mfma_f32_16x16x32_bf16 v[68:71], a[52:55], v[160:163], v[68:71]
  s_add_u32 m0, s31, 0
  v_mfma_f32_16x16x32_bf16 v[72:75], a[56:59], v[160:163], v[72:75]
  s_waitcnt lgkmcnt(3)
  buffer_load_dwordx4 v10, s[8:11], s30 offen lds
  v_mfma_f32_16x16x32_bf16 v[76:79], a[48:51], v[164:167], v[76:79]
  ds_read_b128 v[180:183], v14 offset:43008
  v_mfma_f32_16x16x32_bf16 v[80:83], a[52:55], v[164:167], v[80:83]
  v_mfma_f32_16x16x32_bf16 v[84:87], a[56:59], v[164:167], v[84:87]
  s_waitcnt lgkmcnt(3)
  v_mfma_f32_16x16x32_bf16 v[88:91], a[48:51], v[168:171], v[88:91]
  ds_read_b128 v[184:187], v14 offset:45056
  v_mfma_f32_16x16x32_bf16 v[92:95], a[52:55], v[168:171], v[92:95]
  s_add_u32 m0, s31, 1024
  v_mfma_f32_16x16x32_bf16 v[96:99], a[56:59], v[168:171], v[96:99]
  s_waitcnt lgkmcnt(3)
  buffer_load_dwordx4 v11, s[8:11], s30 offen lds
  v_mfma_f32_16x16x32_bf16 v[100:103], a[48:51], v[172:175], v[100:103]
  ds_read_b128 v[188:191], v14 offset:47104
  v_mfma_f32_16x16x32_bf16 v[104:107], a[52:55], v[172:175], v[104:107]
  v_mfma_f32_16x16x32_bf16 v[108:111], a[56:59], v[172:175], v[108:111]
  s_waitcnt lgkmcnt(3)
  v_mfma_f32_16x16x32_bf16 v[112:115], a[48:51], v[176:179], v[112:115]
  ds_read_b128 v[160:163], v15 offset:32768
  v_mfma_f32_16x16x32_bf16 v[116:119], a[52:55], v[176:179], v[116:119]
  s_add_u32 m0, s31, 2048
  v_mfma_f32_16x16x32_bf16 v[120:123], a[56:59], v[176:179], v[120:123]
  s_waitcnt lgkmcnt(3)
  buffer_load_dwordx4 v12, s[8:11], s30 offen lds
  v_mfma_f32_16x16x32_bf16 v[124:127], a[48:51], v[180:183], v[124:127]
  ds_read_b128 v[164:167], v15 offset:34816
  v_mfma_f32_16x16x32_bf16 v[128:131], a[52:55], v[180:183], v[128:131]
  v_mfma_f32_16x16x32_bf16 v[132:135], a[56:59], v[180:183], v[132:135]
  s_waitcnt lgkmcnt(3)
  v_mfma_f32_16x16x32_bf16 v[136:139], a[48:51], v[184:187], v[136:139]
  ds_read_b128 v[168:171], v15 offset:36864
  v_mfma_f32_16x16x32_bf16 v[140:143], a[52:55], v[184:187], v[140:143]
  s_add_u32 m0, s31, 3072
  v_mfma_f32_16x16x32_bf16 v[144:147], a[56:59], v[184:187], v[144:147]
  s_waitcnt lgkmcnt(3)
  buffer_load_dwordx4 v13, s[8:11], s30 offen lds
  v_mfma_f32_16x16x32_bf16 v[148:151], a[48:51], v[188:191], v[148:151]
  s_add_u32 s30, s30, 128
  ds_read_b128 v[172:175], v15 offset:38912
  v_mfma_f32_16x16x32_bf16 v[152:155], a[52:55], v[188:191], v[152:155]
  v_mfma_f32_16x16x32_bf16 v[156:159], a[56:59], v[188:191], v[156:159]
  s_waitcnt lgkmcnt(3)
  v_mfma_f32_16x16x32_bf16 v[64:67], a[60:63], v[160:163], v[64:67]
  ds_read_b128 v[176:179], v15 offset:40960
  v_mfma_f32_16x16x32_bf16 v[68:71], a[64:67], v[160:163], v[68:71]
  v_mfma_f32_16x16x32_bf16 v[72:75], a[68:71], v[160:163], v[72:75]
  s_waitcnt lgkmcnt(3)
  v_mfma_f32_16x16x32_bf16 v[76:79], a[60:63], v[164:167], v[76:79]
  ds_read_b128 v[180:183], v15 offset:43008
  v_mfma_f32_16x16x32_bf16 v[80:83], a[64:67], v[164:167], v[80:83]
  v_mfma_f32_16x16x32_bf16 v[84:87], a[68:71], v[164:167], v[84:87]
  s_waitcnt lgkmcnt(3)
  v_mfma_f32_16x16x32_bf16 v[88:91], a[60:63], v[168:171], v[88:91]
  ds_read_b128 v[184:187], v15 offset:45056
  v_mfma_f32_16x16x32_bf16 v[92:95], a[64:67], v[168:171], v[92:95]
  v_mfma_f32_16x16x32_bf16 v[96:99], a[68:71], v[168:171], v[96:99]
  s_waitcnt lgkmcnt(3)
  v_mfma_f32_16x16x32_bf16 v[100:103], a[60:63], v[172:175], v[100:103]
  ds_read_b128 v[188:191], v15 offset:47104
  v_mfma_f32_16x16x32_bf16 v[104:107], a[64:67], v[172:175], v[104:107]
  v_mfma_f32_16x16x32_bf16 v[108:111], a[68:71], v[172:175], v[108:111]
  s_waitcnt lgkmcnt(3)
  v_mfma_f32_16x16x32_bf16 v[112:115], a[60:63], v[176:179], v[112:115]
  s_waitcnt vmcnt(40)
  s_barrier
  ds_read_b128 v[160:163], v14 offset:49152
  v_mfma_f32_16x16x32_bf16 v[116:119], a[64:67], v[176:179], v[116:119]
  v_mfma_f32_16x16x32_bf16 v[120:123], a[68:71], v[176:179], v[120:123]
  s_waitcnt lgkmcnt(3)
  v_mfma_f32_16x16x32_bf16 v[124:127], a[60:63], v[180:183], v[124:127]
  ds_read_b128 v[164:167], v14 offset:51200
  v_mfma_f32_16x16x32_bf16 v[128:131], a[64:67], v[180:183], v[128:131]
  v_mfma_f32_16x16x32_bf16 v[132:135], a[68:71], v[180:183], v[132:135]
  s_waitcnt lgkmcnt(3)
  v_mfma_f32_16x16x32_bf16 v[136:139], a[60:63], v[184:187], v[136:139]
  ds_read_b128 v[168:171], v14 offset:53248
  v_mfma_f32_16x16x32_bf16 v[140:143], a[64:67], v[184:187], v[140:143]
  v_mfma_f32_16x16x32_bf16 v[144:147], a[68:71], v[184:187], v[144:147]
  s_waitcnt lgkmcnt(3)
  v_mfma_f32_16x16x32_bf16 v[148:151], a[60:63], v[188:191], v[148:151]
  ds_read_b128 v[172:175], v14 offset:55296
  v_mfma_f32_16x16x32_bf16 v[152:155], a[64:67], v[188:191], v[152:155]
  v_mfma_f32_16x16x32_bf16 v[156:159], a[68:71], v[188:191], v[156:159]
  s_waitcnt lgkmcnt(3)
  v_mfma_f32_16x16x32_bf16 v[64:67], a[72:75], v[160:163], v[64:67]
  ds_read_b128 v[176:179], v14 offset:57344
  v_mfma_f32_16x16x32_bf16 v[68:71], a[76:79], v[160:163], v[68:71]
  s_add_u32 m0, s31, 16384
  v_mfma_f32_16x16x32_bf16 v[72:75], a[80:83], v[160:163], v[72:75]
  s_waitcnt lgkmcnt(3)
  buffer_load_dwordx4 v10, s[8:11], s30 offen lds
  v_mfma_f32_16x16x32_bf16 v[76:79], a[72:75], v[164:167], v[76:79]
  ds_read_b128 v[180:183], v14 offset:59392
  v_mfma_f32_16x16x32_bf16 v[80:83], a[76:79], v[164:167], v[80:83]
  v_mfma_f32_16x16x32_bf16 v[84:87], a[80:83], v[164:167], v[84:87]
  s_waitcnt lgkmcnt(3)
  v_mfma_f32_16x16x32_bf16 v[88:91], a[72:75], v[168:171], v[88:91]
  ds_read_b128 v[184:187], v14 offset:61440
  v_mfma_f32_16x16x32_bf16 v[92:95], a[76:79], v[168:171], v[92:95]
  s_add_u32 m0, s31, 17408
  v_mfma_f32_16x16x32_bf16 v[96:99], a[80:83], v[168:171], v[96:99]
  s_waitcnt lgkmcnt(3)
  buffer_load_dwordx4 v11, s[8:11], s30 offen lds
  v_mfma_f32_16x16x32_bf16 v[100:103], a[72:75], v[172:175], v[100:103]
  ds_read_b128 v[188:191], v14 offset:63488
  v_mfma_f32_16x16x32_bf16 v[104:107], a[76:79], v[172:175], v[104:107]
  v_mfma_f32_16x16x32_bf16 v[108:111], a[80:83], v[172:175], v[108:111]
  s_waitcnt lgkmcnt(3)
  v_mfma_f32_16x16x32_bf16 v[112:115], a[72:75], v[176:179], v[112:115]
  ds_read_b128 v[160:163], v15 offset:49152
  v_mfma_f32_16x16x32_bf16 v[116:119], a[76:79], v[176:179], v[116:119]
  s_add_u32 m0, s31, 18432
  v_mfma_f32_16x16x32_bf16 v[120:123], a[80:83], v[176:179], v[120:123]
  s_waitcnt lgkmcnt(3)
  buffer_load_dwordx4 v12, s[8:11], s30 offen lds
  v_mfma_f32_16x16x32_bf16 v[124:127], a[72:75], v[180:183], v[124:127]
  ds_read_b128 v[164:167], v15 offset:51200
  v_mfma_f32_16x16x32_bf16 v[128:131], a[76:79], v[180:183], v[128:131]
  v_mfma_f32_16x16x32_bf16 v[132:135], a[80:83], v[180:183], v[132:135]
  s_waitcnt lgkmcnt(3)
  v_mfma_f32_16x16x32_bf16 v[136:139], a[72:75], v[184:187], v[136:139]
  ds_read_b128 v[168:171], v15 offset:53248
  v_mfma_f32_16x16x32_bf16 v[140:143], a[76:79], v[184:187], v[140:143]
  s_add_u32 m0, s31, 19456
  v_mfma_f32_16x16x32_bf16 v[144:147], a[80:83], v[184:187], v[144:147]
  s_waitcnt lgkmcnt(3)
  buffer_load_dwordx4 v13, s[8:11], s30 offen lds
  v_mfma_f32_16x16x32_bf16 v[148:151], a[72:75], v[188:191], v[148:151]
  s_add_u32 s30, s30, 128
  ds_read_b128 v[172:175], v15 offset:55296
  v_mfma_f32_16x16x32_bf16 v[152:155], a[76:79], v[188:191], v[152:155]
  v_mfma_f32_16x16x32_bf16 v[156:159], a[80:83], v[188:191], v[156:159]
  s_waitcnt lgkmcnt(3)
  v_mfma_f32_16x16x32_bf16 v[64:67], a[84:87], v[160:163], v[64:67]
  ds_read_b128 v[176:179], v15 offset:57344
  v_mfma_f32_16x16x32_bf16 v[68:71], a[88:91], v[160:163], v[68:71]
  v_mfma_f32_16x16x32_bf16 v[72:75], a[92:95], v[160:163], v[72:75]
  s_waitcnt lgkmcnt(3)
  v_mfma_f32_16x16x32_bf16 v[76:79], a[84:87], v[164:167], v[76:79]
  ds_read_b128 v[180:183], v15 offset:59392
  v_mfma_f32_16x16x32_bf16 v[80:83], a[88:91], v[164:167], v[80:83]
  v_mfma_f32_16x16x32_bf16 v[84:87], a[92:95], v[164:167], v[84:87]
  s_waitcnt lgkmcnt(3)
  v_mfma_f32_16x16x32_bf16 v[88:91], a[84:87], v[168:171], v[88:91]
  ds_read_b128 v[184:187], v15 offset:61440
  v_mfma_f32_16x16x32_bf16 v[92:95], a[88:91], v[168:171], v[92:95]
  v_mfma_f32_16x16x32_bf16 v[96:99], a[92:95], v[168:171], v[96:99]
  s_waitcnt lgkmcnt(3)
  v_mfma_f32_16x16x32_bf16 v[100:103], a[84:87], v[172:175], v[100:103]
  ds_read_b128 v[188:191], v15 offset:63488
  v_mfma_f32_16x16x32_bf16 v[104:107], a[88:91], v[172:175], v[104:107]
  v_mfma_f32_16x16x32_bf16 v[108:111], a[92:95], v[172:175], v[108:111]
  s_waitcnt lgkmcnt(3)
  v_mfma_f32_16x16x32_bf16 v[112:115], a[84:87], v[176:179], v[112:115]
  s_waitcnt vmcnt(40)
  s_barrier
  ds_read_b128 v[160:163], v16 offset:0
  v_mfma_f32_16x16x32_bf16 v[116:119], a[88:91], v[176:179], v[116:119]
  v_mfma_f32_16x16x32_bf16 v[120:123], a[92:95], v[176:179], v[120:123]
  s_waitcnt lgkmcnt(3)
  v_mfma_f32_16x16x32_bf16 v[124:127], a[84:87], v[180:183], v[124:127]
  ds_read_b128 v[164:167], v16 offset:2048
  v_mfma_f32_16x16x32_bf16 v[128:131], a[88:91], v[180:183], v[128:131]
  v_mfma_f32_16x16x32_bf16 v[132:135], a[92:95], v[180:183], v[132:135]
  s_waitcnt lgkmcnt(3)
  v_mfma_f32_16x16x32_bf16 v[136:139], a[84:87], v[184:187], v[136:139]
  ds_read_b128 v[168:171], v16 offset:4096
  v_mfma_f32_16x16x32_bf16 v[140:143], a[88:91], v[184:187], v[140:143]
  v_mfma_f32_16x16x32_bf16 v[144:147], a[92:95], v[184:187], v[144:147]
  s_waitcnt lgkmcnt(3)
  v_mfma_f32_16x16x32_bf16 v[148:151], a[84:87], v[188:191], v[148:151]
  ds_read_b128 v[172:175], v16 offset:6144
  v_mfma_f32_16x16x32_bf16 v[152:155], a[88:91], v[188:191], v[152:155]
  v_mfma_f32_16x16x32_bf16 v[156:159], a[92:95], v[188:191], v[156:159]
  s_waitcnt lgkmcnt(3)
  v_mfma_f32_16x16x32_bf16 v[64:67], a[96:99], v[160:163], v[64:67]
  ds_read_b128 v[176:179], v16 offset:8192
  v_mfma_f32_16x16x32_bf16 v[68:71], a[100:103], v[160:163], v[68:71]
  s_add_u32 m0, s31, 32768
  v_mfma_f32_16x16x32_bf16 v[72:75], a[104:107], v[160:163], v[72:75]
  s_waitcnt lgkmcnt(3)
  buffer_load_dwordx4 v10, s[8:11], s30 offen lds
  v_mfma_f32_16x16x32_bf16 v[76:79], a[96:99], v[164:167], v[76:79]
  ds_read_b128 v[180:183], v16 offset:10240
  v_mfma_f32_16x16x32_bf16 v[80:83], a[100:103], v[164:167], v[80:83]
  v_mfma_f32_16x16x32_bf16 v[84:87], a[104:107], v[164:167], v[84:87]
  s_waitcnt lgkmcnt(3)
  v_mfma_f32_16x16x32_bf16 v[88:91], a[96:99], v[168:171], v[88:91]
  ds_read_b128 v[184:187], v16 offset:12288
  v_mfma_f32_16x16x32_bf16 v[92:95], a[100:103], v[168:171], v[92:95]
  s_add_u32 m0, s31, 33792
  v_mfma_f32_16x16x32_bf16 v[96:99], a[104:107], v[168:171], v[96:99]
  s_waitcnt lgkmcnt(3)
  buffer_load_dwordx4 v11, s[8:11], s30 offen lds
  v_mfma_f32_16x16x32_bf16 v[100:103], a[96:99], v[172:175], v[100:103]
  ds_read_b128 v[188:191], v16 offset:14336
  v_mfma_f32_16x16x32_bf16 v[104:107], a[100:103], v[172:175], v[104:107]
  v_mfma_f32_16x16x32_bf16 v[108:111], a[104:107], v[172:175], v[108:111]
  s_waitcnt lgkmcnt(3)
  v_mfma_f32_16x16x32_bf16 v[112:115], a[96:99], v[176:179], v[112:115]
  ds_read_b128 v[160:163], v17 offset:0
  v_mfma_f32_16x16x32_bf16 v[116:119], a[100:103], v[176:179], v[116:119]
  s_add_u32 m0, s31, 34816
  v_mfma_f32_16x16x32_bf16 v[120:123], a[104:107], v[176:179], v[120:123]
  s_waitcnt lgkmcnt(3)
  buffer_load_dwordx4 v12, s[8:11], s30 offen lds
  v_mfma_f32_16x16x32_bf16 v[124:127], a[96:99], v[180:183], v[124:127]
  ds_read_b128 v[164:167], v17 offset:2048
  v_mfma_f32_16x16x32_bf16 v[128:131], a[100:103], v[180:183], v[128:131]
  v_mfma_f32_16x16x32_bf16 v[132:135], a[104:107], v[180:183], v[132:135]
  s_waitcnt lgkmcnt(3)
  v_mfma_f32_16x16x32_bf16 v[136:139], a[96:99], v[184:187], v[136:139]
  ds_read_b128 v[168:171], v17 offset:4096
  v_mfma_f32_16x16x32_bf16 v[140:143], a[100:103], v[184:187], v[140:143]
  s_add_u32 m0, s31, 35840
  v_mfma_f32_16x16x32_bf16 v[144:147], a[104:107], v[184:187], v[144:147]
  s_waitcnt lgkmcnt(3)
  buffer_load_dwordx4 v13, s[8:11], s30 offen lds
  v_mfma_f32_16x16x32_bf16 v[148:151], a[96:99], v[188:191], v[148:151]
  s_add_u32 s30, s30, 128
  ds_read_b128 v[172:175], v17 offset:6144
  v_mfma_f32_16x16x32_bf16 v[152:155], a[100:103], v[188:191], v[152:155]
  v_mfma_f32_16x16x32_bf16 v[156:159], a[104:107], v[188:191], v[156:159]
  s_waitcnt lgkmcnt(3)
  v_mfma_f32_16x16x32_bf16 v[64:67], a[108:111], v[160:163], v[64:67]
  ds_read_b128 v[176:179], v17 offset:8192
  v_mfma_f32_16x16x32_bf16 v[68:71], a[112:115], v[160:163], v[68:71]
  v_mfma_f32_16x16x32_bf16 v[72:75], a[116:119], v[160:163], v[72:75]
  s_waitcnt lgkmcnt(3)
  v_mfma_f32_16x16x32_bf16 v[76:79], a[108:111], v[164:167], v[76:79]
  ds_read_b128 v[180:183], v17 offset:10240
  v_mfma_f32_16x16x32_bf16 v[80:83], a[112:115], v[164:167], v[80:83]
  v_mfma_f32_16x16x32_bf16 v[84:87], a[116:119], v[164:167], v[84:87]
  s_waitcnt lgkmcnt(3)
  v_mfma_f32_16x16x32_bf16 v[88:91], a[108:111], v[168:171], v[88:91]
  ds_read_b128 v[184:187], v17 offset:12288
  v_mfma_f32_16x16x32_bf16 v[92:95], a[112:115], v[168:171], v[92:95]
  v_mfma_f32_16x16x32_bf16 v[96:99], a[116:119], v[168:171], v[96:99]
  s_waitcnt lgkmcnt(3)
  v_mfma_f32_16x16x32_bf16 v[100:103], a[108:111], v[172:175], v[100:103]
  ds_read_b128 v[188:191], v17 offset:14336
  v_mfma_f32_16x16x32_bf16 v[104:107], a[112:115], v[172:175], v[104:107]
  v_mfma_f32_16x16x32_bf16 v[108:111], a[116:119], v[172:175], v[108:111]
  s_waitcnt lgkmcnt(3)
  v_mfma_f32_16x16x32_bf16 v[112:115], a[108:111], v[176:179], v[112:115]
  s_waitcnt vmcnt(12)
  s_barrier
  ds_read_b128 v[160:163], v16 offset:16384
  v_mfma_f32_16x16x32_bf16 v[116:119], a[112:115], v[176:179], v[116:119]
  buffer_atomic_add v28, v27, s[72:75], s61 offen sc1
  v_mfma_f32_16x16x32_bf16 v[120:123], a[116:119], v[176:179], v[120:123]
  s_waitcnt lgkmcnt(3)
  s_mov_b32 s48, s27
  s_add_u32 s27, s27, s28
  v_mfma_f32_16x16x32_bf16 v[124:127], a[108:111], v[180:183], v[124:127]
  ds_read_b128 v[164:167], v16 offset:18432
  s_mov_b32 s61, s60
  v_mfma_f32_16x16x32_bf16 v[128:131], a[112:115], v[180:183], v[128:131]
  s_add_u32 s60, s60, 1024
  v_mfma_f32_16x16x32_bf16 v[132:135], a[116:119], v[180:183], v[132:135]
  s_waitcnt lgkmcnt(3)
  v_mfma_f32_16x16x32_bf16 v[136:139], a[108:111], v[184:187], v[136:139]
  ds_read_b128 v[168:171], v16 offset:20480
  v_mfma_f32_16x16x32_bf16 v[140:143], a[112:115], v[184:187], v[140:143]
  v_mfma_f32_16x16x32_bf16 v[144:147], a[116:119], v[184:187], v[144:147]
  s_waitcnt lgkmcnt(3)
  v_mfma_f32_16x16x32_bf16 v[148:151], a[108:111], v[188:191], v[148:151]
  ds_read_b128 v[172:175], v16 offset:22528
  v_mfma_f32_16x16x32_bf16 v[152:155], a[112:115], v[188:191], v[152:155]
  v_mfma_f32_16x16x32_bf16 v[156:159], a[116:119], v[188:191], v[156:159]
  s_waitcnt lgkmcnt(3)
  v_mfma_f32_16x16x32_bf16 v[64:67], a[120:123], v[160:163], v[64:67]
  ds_read_b128 v[176:179], v16 offset:24576
  v_mfma_f32_16x16x32_bf16 v[68:71], a[124:127], v[160:163], v[68:71]
  s_add_u32 m0, s31, 49152
  v_mfma_f32_16x16x32_bf16 v[72:75], a[128:131], v[160:163], v[72:75]
  s_waitcnt lgkmcnt(3)
  buffer_load_dwordx4 v10, s[8:11], s30 offen lds
  v_mfma_f32_16x16x32_bf16 v[76:79], a[120:123], v[164:167], v[76:79]
  ds_read_b128 v[180:183], v16 offset:26624
  v_mfma_f32_16x16x32_bf16 v[80:83], a[124:127], v[164:167], v[80:83]
  v_mfma_f32_16x16x32_bf16 v[84:87], a[128:131], v[164:167], v[84:87]
  s_waitcnt lgkmcnt(3)
  v_mfma_f32_16x16x32_bf16 v[88:91], a[120:123], v[168:171], v[88:91]
  ds_read_b128 v[184:187], v16 offset:28672
  v_mfma_f32_16x16x32_bf16 v[92:95], a[124:127], v[168:171], v[92:95]
  s_add_u32 m0, s31, 50176
  v_mfma_f32_16x16x32_bf16 v[96:99], a[128:131], v[168:171], v[96:99]
  s_waitcnt lgkmcnt(3)
  buffer_load_dwordx4 v11, s[8:11], s30 offen lds
  v_mfma_f32_16x16x32_bf16 v[100:103], a[120:123], v[172:175], v[100:103]
  ds_read_b128 v[188:191], v16 offset:30720
  v_mfma_f32_16x16x32_bf16 v[104:107], a[124:127], v[172:175], v[104:107]
  v_mfma_f32_16x16x32_bf16 v[108:111], a[128:131], v[172:175], v[108:111]
  s_waitcnt lgkmcnt(3)
  v_mfma_f32_16x16x32_bf16 v[112:115], a[120:123], v[176:179], v[112:115]
  ds_read_b128 v[160:163], v17 offset:16384
  v_mfma_f32_16x16x32_bf16 v[116:119], a[124:127], v[176:179], v[116:119]
  s_add_u32 m0, s31, 51200
  v_mfma_f32_16x16x32_bf16 v[120:123], a[128:131], v[176:179], v[120:123]
  s_waitcnt lgkmcnt(3)
  buffer_load_dwordx4 v12, s[8:11], s30 offen lds
  v_mfma_f32_16x16x32_bf16 v[124:127], a[120:123], v[180:183], v[124:127]
  ds_read_b128 v[164:167], v17 offset:18432
  v_mfma_f32_16x16x32_bf16 v[128:131], a[124:127], v[180:183], v[128:131]
  v_mfma_f32_16x16x32_bf16 v[132:135], a[128:131], v[180:183], v[132:135]
  s_waitcnt lgkmcnt(3)
  v_mfma_f32_16x16x32_bf16 v[136:139], a[120:123], v[184:187], v[136:139]
  ds_read_b128 v[168:171], v17 offset:20480
  v_mfma_f32_16x16x32_bf16 v[140:143], a[124:127], v[184:187], v[140:143]
  s_add_u32 m0, s31, 52224
  v_mfma_f32_16x16x32_bf16 v[144:147], a[128:131], v[184:187], v[144:147]
  s_waitcnt lgkmcnt(3)
  buffer_load_dwordx4 v13, s[8:11], s30 offen lds
  v_mfma_f32_16x16x32_bf16 v[148:151], a[120:123], v[188:191], v[148:151]
  s_add_u32 s30, s30, 128
  ds_read_b128 v[172:175], v17 offset:22528
  v_mfma_f32_16x16x32_bf16 v[152:155], a[124:127], v[188:191], v[152:155]
  v_mfma_f32_16x16x32_bf16 v[156:159], a[128:131], v[188:191], v[156:159]
  s_waitcnt lgkmcnt(3)
  v_mfma_f32_16x16x32_bf16 v[64:67], a[132:135], v[160:163], v[64:67]
  ds_read_b128 v[176:179], v17 offset:24576
  v_mfma_f32_16x16x32_bf16 v[68:71], a[136:139], v[160:163], v[68:71]
  v_mfma_f32_16x16x32_bf16 v[72:75], a[140:143], v[160:163], v[72:75]
  s_waitcnt lgkmcnt(3)
  v_mfma_f32_16x16x32_bf16 v[76:79], a[132:135], v[164:167], v[76:79]
  ds_read_b128 v[180:183], v17 offset:26624
  v_mfma_f32_16x16x32_bf16 v[80:83], a[136:139], v[164:167], v[80:83]
  v_mfma_f32_16x16x32_bf16 v[84:87], a[140:143], v[164:167], v[84:87]
  s_waitcnt lgkmcnt(3)
  v_mfma_f32_16x16x32_bf16 v[88:91], a[132:135], v[168:171], v[88:91]
  ds_read_b128 v[184:187], v17 offset:28672
  v_mfma_f32_16x16x32_bf16 v[92:95], a[136:139], v[168:171], v[92:95]
  v_mfma_f32_16x16x32_bf16 v[96:99], a[140:143], v[168:171], v[96:99]
  s_waitcnt lgkmcnt(3)
  v_mfma_f32_16x16x32_bf16 v[100:103], a[132:135], v[172:175], v[100:103]
  ds_read_b128 v[188:191], v17 offset:30720
  v_mfma_f32_16x16x32_bf16 v[104:107], a[136:139], v[172:175], v[104:107]
  v_mfma_f32_16x16x32_bf16 v[108:111], a[140:143], v[172:175], v[108:111]
  s_waitcnt lgkmcnt(3)
  v_mfma_f32_16x16x32_bf16 v[112:115], a[132:135], v[176:179], v[112:115]
  s_waitcnt vmcnt(41)
  s_barrier
  ds_read_b128 v[160:163], v16 offset:32768
  v_mfma_f32_16x16x32_bf16 v[116:119], a[136:139], v[176:179], v[116:119]
  v_mfma_f32_16x16x32_bf16 v[120:123], a[140:143], v[176:179], v[120:123]
  s_waitcnt lgkmcnt(3)
  v_mfma_f32_16x16x32_bf16 v[124:127], a[132:135], v[180:183], v[124:127]
  ds_read_b128 v[164:167], v16 offset:34816
  v_mfma_f32_16x16x32_bf16 v[128:131], a[136:139], v[180:183], v[128:131]
  v_mfma_f32_16x16x32_bf16 v[132:135], a[140:143], v[180:183], v[132:135]
  s_waitcnt lgkmcnt(3)
  v_mfma_f32_16x16x32_bf16 v[136:139], a[132:135], v[184:187], v[136:139]
  ds_read_b128 v[168:171], v16 offset:36864
  v_mfma_f32_16x16x32_bf16 v[140:143], a[136:139], v[184:187], v[140:143]
  v_mfma_f32_16x16x32_bf16 v[144:147], a[140:143], v[184:187], v[144:147]
  s_waitcnt lgkmcnt(3)
  v_mfma_f32_16x16x32_bf16 v[148:151], a[132:135], v[188:191], v[148:151]
  ds_read_b128 v[172:175], v16 offset:38912
  v_mfma_f32_16x16x32_bf16 v[152:155], a[136:139], v[188:191], v[152:155]
  v_mfma_f32_16x16x32_bf16 v[156:159], a[140:143], v[188:191], v[156:159]
  s_waitcnt lgkmcnt(3)
  v_mfma_f32_16x16x32_bf16 v[64:67], a[144:147], v[160:163], v[64:67]
  ds_read_b128 v[176:179], v16 offset:40960
  v_mfma_f32_16x16x32_bf16 v[68:71], a[148:151], v[160:163], v[68:71]
  s_add_u32 m0, s31, 65536
  v_mfma_f32_16x16x32_bf16 v[72:75], a[152:155], v[160:163], v[72:75]
  s_waitcnt lgkmcnt(3)
  buffer_load_dwordx4 v10, s[8:11], s30 offen lds
  v_mfma_f32_16x16x32_bf16 v[76:79], a[144:147], v[164:167], v[76:79]
  ds_read_b128 v[180:183], v16 offset:43008
  v_mfma_f32_16x16x32_bf16 v[80:83], a[148:151], v[164:167], v[80:83]
  v_mfma_f32_16x16x32_bf16 v[84:87], a[152:155], v[164:167], v[84:87]
  s_waitcnt lgkmcnt(3)
  v_mfma_f32_16x16x32_bf16 v[88:91], a[144:147], v[168:171], v[88:91]
  ds_read_b128 v[184:187], v16 offset:45056
  v_mfma_f32_16x16x32_bf16 v[92:95], a[148:151], v[168:171], v[92:95]
  s_add_u32 m0, s31, 66560
  v_mfma_f32_16x16x32_bf16 v[96:99], a[152:155], v[168:171], v[96:99]
  s_waitcnt lgkmcnt(3)
  buffer_load_dwordx4 v11, s[8:11], s30 offen lds
  v_mfma_f32_16x16x32_bf16 v[100:103], a[144:147], v[172:175], v[100:103]
  ds_read_b128 v[188:191], v16 offset:47104
  v_mfma_f32_16x16x32_bf16 v[104:107], a[148:151], v[172:175], v[104:107]
  v_mfma_f32_16x16x32_bf16 v[108:111], a[152:155], v[172:175], v[108:111]
  s_waitcnt lgkmcnt(3)
  v_mfma_f32_16x16x32_bf16 v[112:115], a[144:147], v[176:179], v[112:115]
  ds_read_b128 v[160:163], v17 offset:32768
  v_mfma_f32_16x16x32_bf16 v[116:119], a[148:151], v[176:179], v[116:119]
  s_add_u32 m0, s31, 67584
  v_mfma_f32_16x16x32_bf16 v[120:123], a[152:155], v[176:179], v[120:123]
  s_waitcnt lgkmcnt(3)
  buffer_load_dwordx4 v12, s[8:11], s30 offen lds
  v_mfma_f32_16x16x32_bf16 v[124:127], a[144:147], v[180:183], v[124:127]
  ds_read_b128 v[164:167], v17 offset:34816
  v_mfma_f32_16x16x32_bf16 v[128:131], a[148:151], v[180:183], v[128:131]
  v_mfma_f32_16x16x32_bf16 v[132:135], a[152:155], v[180:183], v[132:135]
  s_waitcnt lgkmcnt(3)
  v_mfma_f32_16x16x32_bf16 v[136:139], a[144:147], v[184:187], v[136:139]
  ds_read_b128 v[168:171], v17 offset:36864
  v_mfma_f32_16x16x32_bf16 v[140:143], a[148:151], v[184:187], v[140:143]
  s_add_u32 m0, s31, 68608
  v_mfma_f32_16x16x32_bf16 v[144:147], a[152:155], v[184:187], v[144:147]
  s_waitcnt lgkmcnt(3)
  buffer_load_dwordx4 v13, s[8:11], s30 offen lds
  v_mfma_f32_16x16x32_bf16 v[148:151], a[144:147], v[188:191], v[148:151]
  s_add_u32 s30, s30, 128
  ds_read_b128 v[172:175], v17 offset:38912
  v_mfma_f32_16x16x32_bf16 v[152:155], a[148:151], v[188:191], v[152:155]
  v_mfma_f32_16x16x32_bf16 v[156:159], a[152:155], v[188:191], v[156:159]
  s_waitcnt lgkmcnt(3)
  v_mfma_f32_16x16x32_bf16 v[64:67], a[156:159], v[160:163], v[64:67]
  ds_read_b128 v[176:179], v17 offset:40960
  v_mfma_f32_16x16x32_bf16 v[68:71], a[160:163], v[160:163], v[68:71]
  v_mfma_f32_16x16x32_bf16 v[72:75], a[164:167], v[160:163], v[72:75]
  s_waitcnt lgkmcnt(3)
  v_mfma_f32_16x16x32_bf16 v[76:79], a[156:159], v[164:167], v[76:79]
  ds_read_b128 v[180:183], v17 offset:43008
  v_mfma_f32_16x16x32_bf16 v[80:83], a[160:163], v[164:167], v[80:83]
  v_mfma_f32_16x16x32_bf16 v[84:87], a[164:167], v[164:167], v[84:87]
  s_waitcnt lgkmcnt(3)
  v_mfma_f32_16x16x32_bf16 v[88:91], a[156:159], v[168:171], v[88:91]
  ds_read_b128 v[184:187], v17 offset:45056
  v_mfma_f32_16x16x32_bf16 v[92:95], a[160:163], v[168:171], v[92:95]
  v_mfma_f32_16x16x32_bf16 v[96:99], a[164:167], v[168:171], v[96:99]
  s_waitcnt lgkmcnt(3)
  v_mfma_f32_16x16x32_bf16 v[100:103], a[156:159], v[172:175], v[100:103]
  ds_read_b128 v[188:191], v17 offset:47104
  v_mfma_f32_16x16x32_bf16 v[104:107], a[160:163], v[172:175], v[104:107]
  v_mfma_f32_16x16x32_bf16 v[108:111], a[164:167], v[172:175], v[108:111]
  s_waitcnt lgkmcnt(3)
  v_mfma_f32_16x16x32_bf16 v[112:115], a[156:159], v[176:179], v[112:115]
  s_waitcnt vmcnt(41)
  s_barrier
  ds_read_b128 v[160:163], v16 offset:49152
  v_mfma_f32_16x16x32_bf16 v[116:119], a[160:163], v[176:179], v[116:119]
  v_mfma_f32_16x16x32_bf16 v[120:123], a[164:167], v[176:179], v[120:123]
  s_waitcnt lgkmcnt(3)
  v_mfma_f32_16x16x32_bf16 v[124:127], a[156:159], v[180:183], v[124:127]
  ds_read_b128 v[164:167], v16 offset:51200
  v_mfma_f32_16x16x32_bf16 v[128:131], a[160:163], v[180:183], v[128:131]
  v_mfma_f32_16x16x32_bf16 v[132:135], a[164:167], v[180:183], v[132:135]
  s_waitcnt lgkmcnt(3)
  v_mfma_f32_16x16x32_bf16 v[136:139], a[156:159], v[184:187], v[136:139]
  ds_read_b128 v[168:171], v16 offset:53248
  v_mfma_f32_16x16x32_bf16 v[140:143], a[160:163], v[184:187], v[140:143]
  v_mfma_f32_16x16x32_bf16 v[144:147], a[164:167], v[184:187], v[144:147]
  s_waitcnt lgkmcnt(3)
  v_mfma_f32_16x16x32_bf16 v[148:151], a[156:159], v[188:191], v[148:151]
  ds_read_b128 v[172:175], v16 offset:55296
  v_mfma_f32_16x16x32_bf16 v[152:155], a[160:163], v[188:191], v[152:155]
  v_mfma_f32_16x16x32_bf16 v[156:159], a[164:167], v[188:191], v[156:159]
  s_waitcnt lgkmcnt(3)
  v_mfma_f32_16x16x32_bf16 v[64:67], a[168:171], v[160:163], v[64:67]
  ds_read_b128 v[176:179], v16 offset:57344
  v_mfma_f32_16x16x32_bf16 v[68:71], a[172:175], v[160:163], v[68:71]
  s_add_u32 m0, s31, 81920
  v_mfma_f32_16x16x32_bf16 v[72:75], a[176:179], v[160:163], v[72:75]
  s_waitcnt lgkmcnt(3)
  buffer_load_dwordx4 v10, s[8:11], s30 offen lds
  v_mfma_f32_16x16x32_bf16 v[76:79], a[168:171], v[164:167], v[76:79]
  ds_read_b128 v[180:183], v16 offset:59392
  v_mfma_f32_16x16x32_bf16 v[80:83], a[172:175], v[164:167], v[80:83]
  v_mfma_f32_16x16x32_bf16 v[84:87], a[176:179], v[164:167], v[84:87]
  s_waitcnt lgkmcnt(3)
  v_mfma_f32_16x16x32_bf16 v[88:91], a[168:171], v[168:171], v[88:91]
  ds_read_b128 v[184:187], v16 offset:61440
  v_mfma_f32_16x16x32_bf16 v[92:95], a[172:175], v[168:171], v[92:95]
  s_add_u32 m0, s31, 82944
  v_mfma_f32_16x16x32_bf16 v[96:99], a[176:179], v[168:171], v[96:99]
  s_waitcnt lgkmcnt(3)
  buffer_load_dwordx4 v11, s[8:11], s30 offen lds
  v_mfma_f32_16x16x32_bf16 v[100:103], a[168:171], v[172:175], v[100:103]
  ds_read_b128 v[188:191], v16 offset:63488
  v_mfma_f32_16x16x32_bf16 v[104:107], a[172:175], v[172:175], v[104:107]
  v_mfma_f32_16x16x32_bf16 v[108:111], a[176:179], v[172:175], v[108:111]
  s_waitcnt lgkmcnt(3)
  v_mfma_f32_16x16x32_bf16 v[112:115], a[168:171], v[176:179], v[112:115]
  ds_read_b128 v[160:163], v17 offset:49152
  v_mfma_f32_16x16x32_bf16 v[116:119], a[172:175], v[176:179], v[116:119]
  s_add_u32 m0, s31, 83968
  v_mfma_f32_16x16x32_bf16 v[120:123], a[176:179], v[176:179], v[120:123]
  s_waitcnt lgkmcnt(3)
  buffer_load_dwordx4 v12, s[8:11], s30 offen lds
  v_mfma_f32_16x16x32_bf16 v[124:127], a[168:171], v[180:183], v[124:127]
  ds_read_b128 v[164:167], v17 offset:51200
  v_mfma_f32_16x16x32_bf16 v[128:131], a[172:175], v[180:183], v[128:131]
  v_mfma_f32_16x16x32_bf16 v[132:135], a[176:179], v[180:183], v[132:135]
  s_waitcnt lgkmcnt(3)
  v_mfma_f32_16x16x32_bf16 v[136:139], a[168:171], v[184:187], v[136:139]
  ds_read_b128 v[168:171], v17 offset:53248
  v_mfma_f32_16x16x32_bf16 v[140:143], a[172:175], v[184:187], v[140:143]
  s_add_u32 m0, s31, 84992
  v_mfma_f32_16x16x32_bf16 v[144:147], a[176:179], v[184:187], v[144:147]
  s_waitcnt lgkmcnt(3)
  buffer_load_dwordx4 v13, s[8:11], s30 offen lds
  v_mfma_f32_16x16x32_bf16 v[148:151], a[168:171], v[188:191], v[148:151]
  s_add_u32 s30, s30, 128
  ds_read_b128 v[172:175], v17 offset:55296
  v_mfma_f32_16x16x32_bf16 v[152:155], a[172:175], v[188:191], v[152:155]
  v_mfma_f32_16x16x32_bf16 v[156:159], a[176:179], v[188:191], v[156:159]
  s_waitcnt lgkmcnt(3)
  v_mfma_f32_16x16x32_bf16 v[64:67], a[180:183], v[160:163], v[64:67]
  ds_read_b128 v[176:179], v17 offset:57344
  v_mfma_f32_16x16x32_bf16 v[68:71], a[184:187], v[160:163], v[68:71]
  v_mfma_f32_16x16x32_bf16 v[72:75], a[188:191], v[160:163], v[72:75]
  s_waitcnt lgkmcnt(3)
  v_mfma_f32_16x16x32_bf16 v[76:79], a[180:183], v[164:167], v[76:79]
  ds_read_b128 v[180:183], v17 offset:59392
  v_mfma_f32_16x16x32_bf16 v[80:83], a[184:187], v[164:167], v[80:83]
  v_mfma_f32_16x16x32_bf16 v[84:87], a[188:191], v[164:167], v[84:87]
  s_waitcnt lgkmcnt(3)
  v_mfma_f32_16x16x32_bf16 v[88:91], a[180:183], v[168:171], v[88:91]
  ds_read_b128 v[184:187], v17 offset:61440
  v_mfma_f32_16x16x32_bf16 v[92:95], a[184:187], v[168:171], v[92:95]
  v_mfma_f32_16x16x32_bf16 v[96:99], a[188:191], v[168:171], v[96:99]
  s_waitcnt lgkmcnt(3)
  v_mfma_f32_16x16x32_bf16 v[100:103], a[180:183], v[172:175], v[100:103]
  ds_read_b128 v[188:191], v17 offset:63488
  v_mfma_f32_16x16x32_bf16 v[104:107], a[184:187], v[172:175], v[104:107]
  v_mfma_f32_16x16x32_bf16 v[108:111], a[188:191], v[172:175], v[108:111]
  s_waitcnt lgkmcnt(3)
  v_mfma_f32_16x16x32_bf16 v[112:115], a[180:183], v[176:179], v[112:115]
  s_waitcnt vmcnt(37)
  s_barrier
  ds_read_b128 v[160:163], v18 offset:0
  v_mfma_f32_16x16x32_bf16 v[116:119], a[184:187], v[176:179], v[116:119]
  v_mfma_f32_16x16x32_bf16 v[120:123], a[188:191], v[176:179], v[120:123]
  s_waitcnt lgkmcnt(3)
  v_mfma_f32_16x16x32_bf16 v[124:127], a[180:183], v[180:183], v[124:127]
  ds_read_b128 v[164:167], v18 offset:2048
  v_mfma_f32_16x16x32_bf16 v[128:131], a[184:187], v[180:183], v[128:131]
  v_mfma_f32_16x16x32_bf16 v[132:135], a[188:191], v[180:183], v[132:135]
  s_waitcnt lgkmcnt(3)
  v_mfma_f32_16x16x32_bf16 v[136:139], a[180:183], v[184:187], v[136:139]
  ds_read_b128 v[168:171], v18 offset:4096
  v_mfma_f32_16x16x32_bf16 v[140:143], a[184:187], v[184:187], v[140:143]
  v_mfma_f32_16x16x32_bf16 v[144:147], a[188:191], v[184:187], v[144:147]
  s_waitcnt lgkmcnt(3)
  v_mfma_f32_16x16x32_bf16 v[148:151], a[180:183], v[188:191], v[148:151]
  ds_read_b128 v[172:175], v18 offset:6144
  v_mfma_f32_16x16x32_bf16 v[152:155], a[184:187], v[188:191], v[152:155]
  v_mfma_f32_16x16x32_bf16 v[156:159], a[188:191], v[188:191], v[156:159]
  s_waitcnt lgkmcnt(3)
  v_mfma_f32_16x16x32_bf16 v[64:67], a[192:195], v[160:163], v[64:67]
  ds_read_b128 v[176:179], v18 offset:8192
  v_mfma_f32_16x16x32_bf16 v[68:71], a[196:199], v[160:163], v[68:71]
  s_add_u32 m0, s31, 98304
  v_mfma_f32_16x16x32_bf16 v[72:75], a[200:203], v[160:163], v[72:75]
  s_waitcnt lgkmcnt(3)
  buffer_load_dwordx4 v10, s[8:11], s30 offen lds
  v_mfma_f32_16x16x32_bf16 v[76:79], a[192:195], v[164:167], v[76:79]
  ds_read_b128 v[180:183], v18 offset:10240
  v_mfma_f32_16x16x32_bf16 v[80:83], a[196:199], v[164:167], v[80:83]
  v_mfma_f32_16x16x32_bf16 v[84:87], a[200:203], v[164:167], v[84:87]
  s_waitcnt lgkmcnt(3)
  v_mfma_f32_16x16x32_bf16 v[88:91], a[192:195], v[168:171], v[88:91]
  ds_read_b128 v[184:187], v18 offset:12288
  v_mfma_f32_16x16x32_bf16 v[92:95], a[196:199], v[168:171], v[92:95]
  s_add_u32 m0, s31, 99328
  v_mfma_f32_16x16x32_bf16 v[96:99], a[200:203], v[168:171], v[96:99]
  s_waitcnt lgkmcnt(3)
  buffer_load_dwordx4 v11, s[8:11], s30 offen lds
  v_mfma_f32_16x16x32_bf16 v[100:103], a[192:195], v[172:175], v[100:103]
  ds_read_b128 v[188:191], v18 offset:14336
  v_mfma_f32_16x16x32_bf16 v[104:107], a[196:199], v[172:175], v[104:107]
  v_mfma_f32_16x16x32_bf16 v[108:111], a[200:203], v[172:175], v[108:111]
  s_waitcnt lgkmcnt(3)
  v_mfma_f32_16x16x32_bf16 v[112:115], a[192:195], v[176:179], v[112:115]
  ds_read_b128 v[160:163], v19 offset:0
  v_mfma_f32_16x16x32_bf16 v[116:119], a[196:199], v[176:179], v[116:119]
  s_add_u32 m0, s31, 100352
  v_mfma_f32_16x16x32_bf16 v[120:123], a[200:203], v[176:179], v[120:123]
  s_waitcnt lgkmcnt(3)
  buffer_load_dwordx4 v12, s[8:11], s30 offen lds
  v_mfma_f32_16x16x32_bf16 v[124:127], a[192:195], v[180:183], v[124:127]
  ds_read_b128 v[164:167], v19 offset:2048
  v_mfma_f32_16x16x32_bf16 v[128:131], a[196:199], v[180:183], v[128:131]
  v_mfma_f32_16x16x32_bf16 v[132:135], a[200:203], v[180:183], v[132:135]
  s_waitcnt lgkmcnt(3)
  v_mfma_f32_16x16x32_bf16 v[136:139], a[192:195], v[184:187], v[136:139]
  ds_read_b128 v[168:171], v19 offset:4096
  v_mfma_f32_16x16x32_bf16 v[140:143], a[196:199], v[184:187], v[140:143]
  s_add_u32 m0, s31, 101376
  v_mfma_f32_16x16x32_bf16 v[144:147], a[200:203], v[184:187], v[144:147]
  s_waitcnt lgkmcnt(3)
  buffer_load_dwordx4 v13, s[8:11], s30 offen lds
  v_mfma_f32_16x16x32_bf16 v[148:151], a[192:195], v[188:191], v[148:151]
  s_add_u32 s30, s30, 128
  ds_read_b128 v[172:175], v19 offset:6144
  v_mfma_f32_16x16x32_bf16 v[152:155], a[196:199], v[188:191], v[152:155]
  v_mfma_f32_16x16x32_bf16 v[156:159], a[200:203], v[188:191], v[156:159]
  s_waitcnt lgkmcnt(3)
  v_mfma_f32_16x16x32_bf16 v[64:67], a[204:207], v[160:163], v[64:67]
  ds_read_b128 v[176:179], v19 offset:8192
  v_mfma_f32_16x16x32_bf16 v[68:71], a[208:211], v[160:163], v[68:71]
  v_mfma_f32_16x16x32_bf16 v[72:75], a[212:215], v[160:163], v[72:75]
  s_waitcnt lgkmcnt(3)
  v_mfma_f32_16x16x32_bf16 v[76:79], a[204:207], v[164:167], v[76:79]
  ds_read_b128 v[180:183], v19 offset:10240
  v_mfma_f32_16x16x32_bf16 v[80:83], a[208:211], v[164:167], v[80:83]
  v_mfma_f32_16x16x32_bf16 v[84:87], a[212:215], v[164:167], v[84:87]
  s_waitcnt lgkmcnt(3)
  v_mfma_f32_16x16x32_bf16 v[88:91], a[204:207], v[168:171], v[88:91]
  ds_read_b128 v[184:187], v19 offset:12288
  v_mfma_f32_16x16x32_bf16 v[92:95], a[208:211], v[168:171], v[92:95]
  v_mfma_f32_16x16x32_bf16 v[96:99], a[212:215], v[168:171], v[96:99]
  s_waitcnt lgkmcnt(3)
  v_mfma_f32_16x16x32_bf16 v[100:103], a[204:207], v[172:175], v[100:103]
  ds_read_b128 v[188:191], v19 offset:14336
  v_mfma_f32_16x16x32_bf16 v[104:107], a[208:211], v[172:175], v[104:107]
  v_mfma_f32_16x16x32_bf16 v[108:111], a[212:215], v[172:175], v[108:111]
  s_waitcnt lgkmcnt(3)
  v_mfma_f32_16x16x32_bf16 v[112:115], a[204:207], v[176:179], v[112:115]
  s_waitcnt vmcnt(32)
  s_barrier
  ds_read_b128 v[160:163], v18 offset:16384
  v_mfma_f32_16x16x32_bf16 v[116:119], a[208:211], v[176:179], v[116:119]
  v_mfma_f32_16x16x32_bf16 v[120:123], a[212:215], v[176:179], v[120:123]
  s_waitcnt lgkmcnt(3)
  v_mfma_f32_16x16x32_bf16 v[124:127], a[204:207], v[180:183], v[124:127]
  ds_read_b128 v[164:167], v18 offset:18432
  v_mfma_f32_16x16x32_bf16 v[128:131], a[208:211], v[180:183], v[128:131]
  v_mfma_f32_16x16x32_bf16 v[132:135], a[212:215], v[180:183], v[132:135]
  s_waitcnt lgkmcnt(3)
  v_mfma_f32_16x16x32_bf16 v[136:139], a[204:207], v[184:187], v[136:139]
  ds_read_b128 v[168:171], v18 offset:20480
  v_mfma_f32_16x16x32_bf16 v[140:143], a[208:211], v[184:187], v[140:143]
  v_mfma_f32_16x16x32_bf16 v[144:147], a[212:215], v[184:187], v[144:147]
  s_waitcnt lgkmcnt(3)
  v_mfma_f32_16x16x32_bf16 v[148:151], a[204:207], v[188:191], v[148:151]
  ds_read_b128 v[172:175], v18 offset:22528
  v_mfma_f32_16x16x32_bf16 v[152:155], a[208:211], v[188:191], v[152:155]
  v_mfma_f32_16x16x32_bf16 v[156:159], a[212:215], v[188:191], v[156:159]
  s_waitcnt lgkmcnt(3)
  v_mfma_f32_16x16x32_bf16 v[64:67], a[216:219], v[160:163], v[64:67]
  ds_read_b128 v[176:179], v18 offset:24576
  v_mfma_f32_16x16x32_bf16 v[68:71], a[220:223], v[160:163], v[68:71]
  s_add_u32 m0, s31, 114688
  v_mfma_f32_16x16x32_bf16 v[72:75], a[224:227], v[160:163], v[72:75]
  s_waitcnt lgkmcnt(3)
  buffer_load_dwordx4 v10, s[8:11], s30 offen lds
  v_mfma_f32_16x16x32_bf16 v[76:79], a[216:219], v[164:167], v[76:79]
  ds_read_b128 v[180:183], v18 offset:26624
  v_mfma_f32_16x16x32_bf16 v[80:83], a[220:223], v[164:167], v[80:83]
  v_mfma_f32_16x16x32_bf16 v[84:87], a[224:227], v[164:167], v[84:87]
  s_waitcnt lgkmcnt(3)
  v_mfma_f32_16x16x32_bf16 v[88:91], a[216:219], v[168:171], v[88:91]
  ds_read_b128 v[184:187], v18 offset:28672
  v_mfma_f32_16x16x32_bf16 v[92:95], a[220:223], v[168:171], v[92:95]
  s_add_u32 m0, s31, 115712
  v_mfma_f32_16x16x32_bf16 v[96:99], a[224:227], v[168:171], v[96:99]
  s_waitcnt lgkmcnt(3)
  buffer_load_dwordx4 v11, s[8:11], s30 offen lds
  v_mfma_f32_16x16x32_bf16 v[100:103], a[216:219], v[172:175], v[100:103]
  ds_read_b128 v[188:191], v18 offset:30720
  v_mfma_f32_16x16x32_bf16 v[104:107], a[220:223], v[172:175], v[104:107]
  v_mfma_f32_16x16x32_bf16 v[108:111], a[224:227], v[172:175], v[108:111]
  s_waitcnt lgkmcnt(3)
  v_mfma_f32_16x16x32_bf16 v[112:115], a[216:219], v[176:179], v[112:115]
  ds_read_b128 v[160:163], v19 offset:16384
  v_mfma_f32_16x16x32_bf16 v[116:119], a[220:223], v[176:179], v[116:119]
  s_add_u32 m0, s31, 116736
  v_mfma_f32_16x16x32_bf16 v[120:123], a[224:227], v[176:179], v[120:123]
  s_waitcnt lgkmcnt(3)
  buffer_load_dwordx4 v12, s[8:11], s30 offen lds
  v_mfma_f32_16x16x32_bf16 v[124:127], a[216:219], v[180:183], v[124:127]
  ds_read_b128 v[164:167], v19 offset:18432
  v_mfma_f32_16x16x32_bf16 v[128:131], a[220:223], v[180:183], v[128:131]
  v_mfma_f32_16x16x32_bf16 v[132:135], a[224:227], v[180:183], v[132:135]
  s_waitcnt lgkmcnt(3)
  v_mfma_f32_16x16x32_bf16 v[136:139], a[216:219], v[184:187], v[136:139]
  ds_read_b128 v[168:171], v19 offset:20480
  v_mfma_f32_16x16x32_bf16 v[140:143], a[220:223], v[184:187], v[140:143]
  s_add_u32 m0, s31, 117760
  v_mfma_f32_16x16x32_bf16 v[144:147], a[224:227], v[184:187], v[144:147]
  s_waitcnt lgkmcnt(3)
  buffer_load_dwordx4 v13, s[8:11], s30 offen lds
  v_mfma_f32_16x16x32_bf16 v[148:151], a[216:219], v[188:191], v[148:151]
  s_add_u32 s30, s30, 128
  ds_read_b128 v[172:175], v19 offset:22528
  v_mfma_f32_16x16x32_bf16 v[152:155], a[220:223], v[188:191], v[152:155]
  v_mfma_f32_16x16x32_bf16 v[156:159], a[224:227], v[188:191], v[156:159]
  s_waitcnt lgkmcnt(3)
  v_mfma_f32_16x16x32_bf16 v[64:67], a[228:231], v[160:163], v[64:67]
  ds_read_b128 v[176:179], v19 offset:24576
  v_mfma_f32_16x16x32_bf16 v[68:71], a[232:235], v[160:163], v[68:71]
  v_mfma_f32_16x16x32_bf16 v[72:75], a[236:239], v[160:163], v[72:75]
  s_waitcnt lgkmcnt(3)
  v_mfma_f32_16x16x32_bf16 v[76:79], a[228:231], v[164:167], v[76:79]
  ds_read_b128 v[180:183], v19 offset:26624
  v_cvt_pk_bf16_f32 v192, v64, v65
  v_mfma_f32_16x16x32_bf16 v[80:83], a[232:235], v[164:167], v[80:83]
  v_cvt_pk_bf16_f32 v193, v66, v67
  v_cvt_pk_bf16_f32 v194, v68, v69
  v_mfma_f32_16x16x32_bf16 v[84:87], a[236:239], v[164:167], v[84:87]
  s_waitcnt lgkmcnt(3)
  v_cvt_pk_bf16_f32 v195, v70, v71
  v_cvt_pk_bf16_f32 v200, v72, v73
  v_mfma_f32_16x16x32_bf16 v[88:91], a[228:231], v[168:171], v[88:91]
  ds_read_b128 v[184:187], v19 offset:28672
  v_cvt_pk_bf16_f32 v201, v74, v75
  v_mfma_f32_16x16x32_bf16 v[92:95], a[232:235], v[168:171], v[92:95]
  v_cvt_pk_bf16_f32 v196, v76, v77
  v_cvt_pk_bf16_f32 v197, v78, v79
  v_mfma_f32_16x16x32_bf16 v[96:99], a[236:239], v[168:171], v[96:99]
  s_waitcnt lgkmcnt(3)
  v_cvt_pk_bf16_f32 v198, v80, v81
  v_cvt_pk_bf16_f32 v199, v82, v83
  v_mfma_f32_16x16x32_bf16 v[100:103], a[228:231], v[172:175], v[100:103]
  ds_read_b128 v[188:191], v19 offset:30720
  v_cvt_pk_bf16_f32 v202, v84, v85
  v_mfma_f32_16x16x32_bf16 v[104:107], a[232:235], v[172:175], v[104:107]
  v_cvt_pk_bf16_f32 v203, v86, v87
  v_cvt_pk_bf16_f32 v204, v88, v89
  v_mfma_f32_16x16x32_bf16 v[108:111], a[236:239], v[172:175], v[108:111]
  s_waitcnt lgkmcnt(3)
  v_cvt_pk_bf16_f32 v205, v90, v91
  v_cvt_pk_bf16_f32 v206, v92, v93
  v_mfma_f32_16x16x32_bf16 v[112:115], a[228:231], v[176:179], v[112:115]
  s_waitcnt vmcnt(29)
  s_barrier
  ds_read_b128 v[160:163], v14 offset:0
  v_mfma_f32_16x16x32_bf16 v[116:119], a[232:235], v[176:179], v[116:119]
  v_cvt_pk_bf16_f32 v207, v94, v95
  v_cvt_pk_bf16_f32 v212, v96, v97
  v_mfma_f32_16x16x32_bf16 v[120:123], a[236:239], v[176:179], v[120:123]
  s_waitcnt lgkmcnt(3)
  v_cvt_pk_bf16_f32 v213, v98, v99
  v_cvt_pk_bf16_f32 v208, v100, v101
  v_mfma_f32_16x16x32_bf16 v[124:127], a[228:231], v[180:183], v[124:127]
  ds_read_b128 v[164:167], v14 offset:2048
  v_cvt_pk_bf16_f32 v209, v102, v103
  v_mfma_f32_16x16x32_bf16 v[128:131], a[232:235], v[180:183], v[128:131]
  v_cvt_pk_bf16_f32 v210, v104, v105
  v_cvt_pk_bf16_f32 v211, v106, v107
  v_mfma_f32_16x16x32_bf16 v[132:135], a[236:239], v[180:183], v[132:135]
  s_waitcnt lgkmcnt(3)
  v_cvt_pk_bf16_f32 v214, v108, v109
  v_cvt_pk_bf16_f32 v215, v110, v111
  v_mfma_f32_16x16x32_bf16 v[136:139], a[228:231], v[184:187], v[136:139]
  ds_read_b128 v[168:171], v14 offset:4096
  v_cvt_pk_bf16_f32 v216, v112, v113
  v_mfma_f32_16x16x32_bf16 v[140:143], a[232:235], v[184:187], v[140:143]
  v_cvt_pk_bf16_f32 v217, v114, v115
  v_cvt_pk_bf16_f32 v218, v116, v117
  v_mfma_f32_16x16x32_bf16 v[144:147], a[236:239], v[184:187], v[144:147]
  s_waitcnt lgkmcnt(3)
  v_cvt_pk_bf16_f32 v219, v118, v119
  v_cvt_pk_bf16_f32 v224, v120, v121
  v_mfma_f32_16x16x32_bf16 v[148:151], a[228:231], v[188:191], v[148:151]
  ds_read_b128 v[172:175], v14 offset:6144
  v_cvt_pk_bf16_f32 v225, v122, v123
  v_mfma_f32_16x16x32_bf16 v[152:155], a[232:235], v[188:191], v[152:155]
  s_sub_u32 s26, s26, 1
  s_cmp_gt_u32 s26, 0
  v_cvt_pk_bf16_f32 v220, v124, v125
  v_mfma_f32_16x16x32_bf16 v[156:159], a[236:239], v[188:191], v[156:159]
  s_waitcnt lgkmcnt(3)
  s_cbranch_scc1 kvs_197
  s_nop 7
  v_cvt_pk_bf16_f32 v221, v126, v127
  v_cvt_pk_bf16_f32 v222, v128, v129
  v_cvt_pk_bf16_f32 v223, v130, v131
  v_cvt_pk_bf16_f32 v226, v132, v133
  v_cvt_pk_bf16_f32 v227, v134, v135
  v_cvt_pk_bf16_f32 v228, v136, v137
  v_cvt_pk_bf16_f32 v229, v138, v139
  v_cvt_pk_bf16_f32 v230, v140, v141
  v_cvt_pk_bf16_f32 v231, v142, v143
  v_cvt_pk_bf16_f32 v236, v144, v145
  v_cvt_pk_bf16_f32 v237, v146, v147
  v_cvt_pk_bf16_f32 v232, v148, v149
  v_cvt_pk_bf16_f32 v233, v150, v151
  v_cvt_pk_bf16_f32 v234, v152, v153
  v_cvt_pk_bf16_f32 v235, v154, v155
  v_cvt_pk_bf16_f32 v238, v156, v157
  v_cvt_pk_bf16_f32 v239, v158, v159
  s_add_u32 s29, s48, 0
  buffer_store_dwordx4 v[192:195], v26, s[16:19], s29 offen offset:0 sc1
  buffer_store_dwordx4 v[196:199], v26, s[16:19], s29 offen offset:1024 sc1
  buffer_store_dwordx4 v[200:203], v26, s[16:19], s29 offen offset:2048 sc1
  s_add_u32 s29, s48, 393216
  buffer_store_dwordx4 v[204:207], v26, s[16:19], s29 offen offset:0 sc1
  buffer_store_dwordx4 v[208:211], v26, s[16:19], s29 offen offset:1024 sc1
  buffer_store_dwordx4 v[212:215], v26, s[16:19], s29 offen offset:2048 sc1
  s_add_u32 s29, s48, 786432
  buffer_store_dwordx4 v[216:219], v26, s[16:19], s29 offen offset:0 sc1
  buffer_store_dwordx4 v[220:223], v26, s[16:19], s29 offen offset:1024 sc1
  buffer_store_dwordx4 v[224:227], v26, s[16:19], s29 offen offset:2048 sc1
  s_add_u32 s29, s48, 1179648
  buffer_store_dwordx4 v[228:231], v26, s[16:19], s29 offen offset:0 sc1
  buffer_store_dwordx4 v[232:235], v26, s[16:19], s29 offen offset:1024 sc1
  buffer_store_dwordx4 v[236:239], v26, s[16:19], s29 offen offset:2048 sc1
  s_waitcnt vmcnt(0) lgkmcnt(0)
  s_barrier
  buffer_atomic_add v28, v27, s[72:75], s61 offen sc1
  s_branch queue
not_kv:
  s_cmp_ge_u32 s3, 96
  s_cbranch_scc1 not_vw
  s_sub_u32 s2, s3, 64
  s_load_dwordx2 s[6:7], s[0:1], 40
  s_load_dwordx2 s[38:39], s[0:1], 104
  v_lshlrev_b32 v4, 4, v1
  s_waitcnt lgkmcnt(0)
  s_mov_b32 s12, s6
  s_mov_b32 s13, s7
  s_mov_b32 s14, 7864320
  s_mov_b32 s15, 0x00020000
  s_add_u32 s16, s38, 25165824
  s_addc_u32 s17, s39, 0
  s_mov_b32 s18, 25165824
  s_mov_b32 s19, 0x00020000
  s_add_u32 s24, s38, 114294784
  s_addc_u32 s25, s39, 0
  s_mov_b32 s26, 83886080
  s_mov_b32 s27, 0x00020000
  s_add_u32 s72, s38, 81068032
  s_addc_u32 s73, s39, 0
  s_mov_b32 s74, 115712
  s_mov_b32 s75, 0x00020000
  s_mul_i32 s40, s2, 245760
  s_mul_i32 s22, s20, 30720
  s_add_u32 s40, s40, s22
  s_add_u32 m0, s22, 0
  s_add_u32 s21, s40, 0
  buffer_load_dwordx4 v4, s[12:15], s21 offen offset:0 lds
  buffer_load_dwordx4 v4, s[12:15], s21 offen offset:1024 lds
  buffer_load_dwordx4 v4, s[12:15], s21 offen offset:2048 lds
  buffer_load_dwordx4 v4, s[12:15], s21 offen offset:3072 lds
  s_add_u32 m0, s22, 4096
  s_add_u32 s21, s40, 4096
  buffer_load_dwordx4 v4, s[12:15], s21 offen offset:0 lds
  buffer_load_dwordx4 v4, s[12:15], s21 offen offset:1024 lds
  buffer_load_dwordx4 v4, s[12:15], s21 offen offset:2048 lds
  buffer_load_dwordx4 v4, s[12:15], s21 offen offset:3072 lds
  s_add_u32 m0, s22, 8192
  s_add_u32 s21, s40, 8192
  buffer_load_dwordx4 v4, s[12:15], s21 offen offset:0 lds
  buffer_load_dwordx4 v4, s[12:15], s21 offen offset:1024 lds
  buffer_load_dwordx4 v4, s[12:15], s21 offen offset:2048 lds
  buffer_load_dwordx4 v4, s[12:15], s21 offen offset:3072 lds
  s_add_u32 m0, s22, 12288
  s_add_u32 s21, s40, 12288
  buffer_load_dwordx4 v4, s[12:15], s21 offen offset:0 lds
  buffer_load_dwordx4 v4, s[12:15], s21 offen offset:1024 lds
  buffer_load_dwordx4 v4, s[12:15], s21 offen offset:2048 lds
  buffer_load_dwordx4 v4, s[12:15], s21 offen offset:3072 lds
  s_add_u32 m0, s22, 16384
  s_add_u32 s21, s40, 16384
  buffer_load_dwordx4 v4, s[12:15], s21 offen offset:0 lds
  buffer_load_dwordx4 v4, s[12:15], s21 offen offset:1024 lds
  buffer_load_dwordx4 v4, s[12:15], s21 offen offset:2048 lds
  buffer_load_dwordx4 v4, s[12:15], s21 offen offset:3072 lds
  s_add_u32 m0, s22, 20480
  s_add_u32 s21, s40, 20480
  buffer_load_dwordx4 v4, s[12:15], s21 offen offset:0 lds
  buffer_load_dwordx4 v4, s[12:15], s21 offen offset:1024 lds
  buffer_load_dwordx4 v4, s[12:15], s21 offen offset:2048 lds
  buffer_load_dwordx4 v4, s[12:15], s21 offen offset:3072 lds
  s_add_u32 m0, s22, 24576
  s_add_u32 s21, s40, 24576
  buffer_load_dwordx4 v4, s[12:15], s21 offen offset:0 lds
  buffer_load_dwordx4 v4, s[12:15], s21 offen offset:1024 lds
  buffer_load_dwordx4 v4, s[12:15], s21 offen offset:2048 lds
  buffer_load_dwordx4 v4, s[12:15], s21 offen offset:3072 lds
  s_add_u32 m0, s22, 28672
  s_add_u32 s21, s40, 28672
  buffer_load_dwordx4 v4, s[12:15], s21 offen offset:0 lds
  buffer_load_dwordx4 v4, s[12:15], s21 offen offset:1024 lds
  s_add_u32 s21, s40, 122880
  buffer_load_dwordx4 v[64:67], v4, s[12:15], s21 offen offset:0
  buffer_load_dwordx4 v[68:71], v4, s[12:15], s21 offen offset:1024
  buffer_load_dwordx4 v[72:75], v4, s[12:15], s21 offen offset:2048
  buffer_load_dwordx4 v[76:79], v4, s[12:15], s21 offen offset:3072
  s_add_u32 s21, s40, 126976
  buffer_load_dwordx4 v[80:83], v4, s[12:15], s21 offen offset:0
  buffer_load_dwordx4 v[84:87], v4, s[12:15], s21 offen offset:1024
  buffer_load_dwordx4 v[88:91], v4, s[12:15], s21 offen offset:2048
  buffer_load_dwordx4 v[92:95], v4, s[12:15], s21 offen offset:3072
  s_add_u32 s21, s40, 131072
  buffer_load_dwordx4 v[96:99], v4, s[12:15], s21 offen offset:0
  buffer_load_dwordx4 v[100:103], v4, s[12:15], s21 offen offset:1024
  buffer_load_dwordx4 v[104:107], v4, s[12:15], s21 offen offset:2048
  buffer_load_dwordx4 v[108:111], v4, s[12:15], s21 offen offset:3072
  s_add_u32 s21, s40, 135168
  buffer_load_dwordx4 v[112:115], v4, s[12:15], s21 offen offset:0
  buffer_load_dwordx4 v[116:119], v4, s[12:15], s21 offen offset:1024
  buffer_load_dwordx4 v[120:123], v4, s[12:15], s21 offen offset:2048
  buffer_load_dwordx4 v[124:127], v4, s[12:15], s21 offen offset:3072
  s_add_u32 s21, s40, 139264
  buffer_load_dwordx4 v[128:131], v4, s[12:15], s21 offen offset:0
  buffer_load_dwordx4 v[132:135], v4, s[12:15], s21 offen offset:1024
  buffer_load_dwordx4 v[136:139], v4, s[12:15], s21 offen offset:2048
  buffer_load_dwordx4 v[140:143], v4, s[12:15], s21 offen offset:3072
  s_add_u32 s21, s40, 143360
  buffer_load_dwordx4 v[144:147], v4, s[12:15], s21 offen offset:0
  buffer_load_dwordx4 v[148:151], v4, s[12:15], s21 offen offset:1024
  buffer_load_dwordx4 v[152:155], v4, s[12:15], s21 offen offset:2048
  buffer_load_dwordx4 v[156:159], v4, s[12:15], s21 offen offset:3072
  s_add_u32 s21, s40, 147456
  buffer_load_dwordx4 v[160:163], v4, s[12:15], s21 offen offset:0
  buffer_load_dwordx4 v[164:167], v4, s[12:15], s21 offen offset:1024
  buffer_load_dwordx4 v[168:171], v4, s[12:15], s21 offen offset:2048
  buffer_load_dwordx4 v[172:175], v4, s[12:15], s21 offen offset:3072
  s_add_u32 s21, s40, 151552
  buffer_load_dwordx4 v[176:179], v4, s[12:15], s21 offen offset:0
  buffer_load_dwordx4 v[180:183], v4, s[12:15], s21 offen offset:1024
  v_lshrrev_b32 v6, 2, v2
  v_lshl_add_u32 v6, v3, 2, v6
  v_mul_u32_u24 v6, 1280, v6
  v_and_b32 v7, 3, v2
  v_lshlrev_b32 v7, 3, v7
  s_mul_i32 s21, s20, 320
  v_add3_u32 v6, v6, v7, s21
  v_add_u32 v8, v6, v7
  v_add_u32 v7, 61440, v6
  v_add_u32 v9, 61440, v8
  v_add_u32 v5, s22, v4
  s_waitcnt vmcnt(30)
  s_barrier
  ds_read_b64_tr_b16 a[0:1], v8 offset:0
  ds_read_b64_tr_b16 a[2:3], v8 offset:20480
  ds_read_b64_tr_b16 a[24:25], v8 offset:8
  ds_read_b64_tr_b16 a[26:27], v8 offset:20488
  ds_read_b64_tr_b16 a[48:49], v6 offset:64
  ds_read_b64_tr_b16 a[50:51], v6 offset:20544
  ds_read_b64_tr_b16 a[72:73], v8 offset:96
  ds_read_b64_tr_b16 a[74:75], v8 offset:20576
  ds_read_b64_tr_b16 a[96:97], v8 offset:104
  ds_read_b64_tr_b16 a[98:99], v8 offset:20584
  ds_read_b64_tr_b16 a[120:121], v8 offset:160
  ds_read_b64_tr_b16 a[122:123], v8 offset:20640
  ds_read_b64_tr_b16 a[144:145], v8 offset:168
  ds_read_b64_tr_b16 a[146:147], v8 offset:20648
  ds_read_b64_tr_b16 a[168:169], v6 offset:224
  ds_read_b64_tr_b16 a[170:171], v6 offset:20704
  ds_read_b64_tr_b16 a[192:193], v8 offset:256
  ds_read_b64_tr_b16 a[194:195], v8 offset:20736
  ds_read_b64_tr_b16 a[216:217], v8 offset:264
  ds_read_b64_tr_b16 a[218:219], v8 offset:20744
  ds_read_b64_tr_b16 a[4:5], v9 offset:0
  ds_read_b64_tr_b16 a[6:7], v9 offset:20480
  ds_read_b64_tr_b16 a[28:29], v9 offset:8
  ds_read_b64_tr_b16 a[30:31], v9 offset:20488
  ds_read_b64_tr_b16 a[52:53], v7 offset:64
  ds_read_b64_tr_b16 a[54:55], v7 offset:20544
  ds_read_b64_tr_b16 a[76:77], v9 offset:96
  ds_read_b64_tr_b16 a[78:79], v9 offset:20576
  ds_read_b64_tr_b16 a[100:101], v9 offset:104
  ds_read_b64_tr_b16 a[102:103], v9 offset:20584
  ds_read_b64_tr_b16 a[124:125], v9 offset:160
  ds_read_b64_tr_b16 a[126:127], v9 offset:20640
  ds_read_b64_tr_b16 a[148:149], v9 offset:168
  ds_read_b64_tr_b16 a[150:151], v9 offset:20648
  ds_read_b64_tr_b16 a[172:173], v7 offset:224
  ds_read_b64_tr_b16 a[174:175], v7 offset:20704
  ds_read_b64_tr_b16 a[196:197], v9 offset:256
  ds_read_b64_tr_b16 a[198:199], v9 offset:20736
  ds_read_b64_tr_b16 a[220:221], v9 offset:264
  ds_read_b64_tr_b16 a[222:223], v9 offset:20744
  ds_read_b64_tr_b16 a[8:9], v8 offset:40960
  ds_read_b64_tr_b16 a[10:11], v9 offset:40960
  ds_read_b64_tr_b16 a[32:33], v8 offset:40968
  ds_read_b64_tr_b16 a[34:35], v9 offset:40968
  ds_read_b64_tr_b16 a[56:57], v6 offset:41024
  ds_read_b64_tr_b16 a[58:59], v7 offset:41024
  ds_read_b64_tr_b16 a[80:81], v8 offset:41056
  ds_read_b64_tr_b16 a[82:83], v9 offset:41056
  ds_read_b64_tr_b16 a[104:105], v8 offset:41064
  ds_read_b64_tr_b16 a[106:107], v9 offset:41064
  ds_read_b64_tr_b16 a[128:129], v8 offset:41120
  ds_read_b64_tr_b16 a[130:131], v9 offset:41120
  ds_read_b64_tr_b16 a[152:153], v8 offset:41128
  ds_read_b64_tr_b16 a[154:155], v9 offset:41128
  ds_read_b64_tr_b16 a[176:177], v6 offset:41184
  ds_read_b64_tr_b16 a[178:179], v7 offset:41184
  ds_read_b64_tr_b16 a[200:201], v8 offset:41216
  ds_read_b64_tr_b16 a[202:203], v9 offset:41216
  ds_read_b64_tr_b16 a[224:225], v8 offset:41224
  ds_read_b64_tr_b16 a[226:227], v9 offset:41224
  s_waitcnt lgkmcnt(0)
  s_barrier
  s_waitcnt vmcnt(0)
  ds_write_b128 v5, v[64:67] offset:0
  ds_write_b128 v5, v[68:71] offset:1024
  ds_write_b128 v5, v[72:75] offset:2048
  ds_write_b128 v5, v[76:79] offset:3072
  ds_write_b128 v5, v[80:83] offset:4096
  ds_write_b128 v5, v[84:87] offset:5120
  ds_write_b128 v5, v[88:91] offset:6144
  ds_write_b128 v5, v[92:95] offset:7168
  ds_write_b128 v5, v[96:99] offset:8192
  ds_write_b128 v5, v[100:103] offset:9216
  ds_write_b128 v5, v[104:107] offset:10240
  ds_write_b128 v5, v[108:111] offset:11264
  ds_write_b128 v5, v[112:115] offset:12288
  ds_write_b128 v5, v[116:119] offset:13312
  ds_write_b128 v5, v[120:123] offset:14336
  ds_write_b128 v5, v[124:127] offset:15360
  ds_write_b128 v5, v[128:131] offset:16384
  ds_write_b128 v5, v[132:135] offset:17408
  ds_write_b128 v5, v[136:139] offset:18432
  ds_write_b128 v5, v[140:143] offset:19456
  ds_write_b128 v5, v[144:147] offset:20480
  ds_write_b128 v5, v[148:151] offset:21504
  ds_write_b128 v5, v[152:155] offset:22528
  ds_write_b128 v5, v[156:159] offset:23552
  ds_write_b128 v5, v[160:163] offset:24576
  ds_write_b128 v5, v[164:167] offset:25600
  ds_write_b128 v5, v[168:171] offset:26624
  ds_write_b128 v5, v[172:175] offset:27648
  ds_write_b128 v5, v[176:179] offset:28672
  ds_write_b128 v5, v[180:183] offset:29696
  s_waitcnt lgkmcnt(0)
  s_barrier
  ds_read_b64_tr_b16 a[12:13], v8 offset:0
  ds_read_b64_tr_b16 a[14:15], v8 offset:20480
  ds_read_b64_tr_b16 a[36:37], v8 offset:8
  ds_read_b64_tr_b16 a[38:39], v8 offset:20488
  ds_read_b64_tr_b16 a[60:61], v6 offset:64
  ds_read_b64_tr_b16 a[62:63], v6 offset:20544
  ds_read_b64_tr_b16 a[84:85], v8 offset:96
  ds_read_b64_tr_b16 a[86:87], v8 offset:20576
  ds_read_b64_tr_b16 a[108:109], v8 offset:104
  ds_read_b64_tr_b16 a[110:111], v8 offset:20584
  ds_read_b64_tr_b16 a[132:133], v8 offset:160
  ds_read_b64_tr_b16 a[134:135], v8 offset:20640
  ds_read_b64_tr_b16 a[156:157], v8 offset:168
  ds_read_b64_tr_b16 a[158:159], v8 offset:20648
  ds_read_b64_tr_b16 a[180:181], v6 offset:224
  ds_read_b64_tr_b16 a[182:183], v6 offset:20704
  ds_read_b64_tr_b16 a[204:205], v8 offset:256
  ds_read_b64_tr_b16 a[206:207], v8 offset:20736
  ds_read_b64_tr_b16 a[228:229], v8 offset:264
  ds_read_b64_tr_b16 a[230:231], v8 offset:20744
  ds_read_b64_tr_b16 a[16:17], v9 offset:0
  ds_read_b64_tr_b16 a[18:19], v9 offset:20480
  ds_read_b64_tr_b16 a[40:41], v9 offset:8
  ds_read_b64_tr_b16 a[42:43], v9 offset:20488
  ds_read_b64_tr_b16 a[64:65], v7 offset:64
  ds_read_b64_tr_b16 a[66:67], v7 offset:20544
  ds_read_b64_tr_b16 a[88:89], v9 offset:96
  ds_read_b64_tr_b16 a[90:91], v9 offset:20576
  ds_read_b64_tr_b16 a[112:113], v9 offset:104
  ds_read_b64_tr_b16 a[114:115], v9 offset:20584
  ds_read_b64_tr_b16 a[136:137], v9 offset:160
  ds_read_b64_tr_b16 a[138:139], v9 offset:20640
  ds_read_b64_tr_b16 a[160:161], v9 offset:168
  ds_read_b64_tr_b16 a[162:163], v9 offset:20648
  ds_read_b64_tr_b16 a[184:185], v7 offset:224
  ds_read_b64_tr_b16 a[186:187], v7 offset:20704
  ds_read_b64_tr_b16 a[208:209], v9 offset:256
  ds_read_b64_tr_b16 a[210:211], v9 offset:20736
  ds_read_b64_tr_b16 a[232:233], v9 offset:264
  ds_read_b64_tr_b16 a[234:235], v9 offset:20744
  ds_read_b64_tr_b16 a[20:21], v8 offset:40960
  ds_read_b64_tr_b16 a[22:23], v9 offset:40960
  ds_read_b64_tr_b16 a[44:45], v8 offset:40968
  ds_read_b64_tr_b16 a[46:47], v9 offset:40968
  ds_read_b64_tr_b16 a[68:69], v6 offset:41024
  ds_read_b64_tr_b16 a[70:71], v7 offset:41024
  ds_read_b64_tr_b16 a[92:93], v8 offset:41056
  ds_read_b64_tr_b16 a[94:95], v9 offset:41056
  ds_read_b64_tr_b16 a[116:117], v8 offset:41064
  ds_read_b64_tr_b16 a[118:119], v9 offset:41064
  ds_read_b64_tr_b16 a[140:141], v8 offset:41120
  ds_read_b64_tr_b16 a[142:143], v9 offset:41120
  ds_read_b64_tr_b16 a[164:165], v8 offset:41128
  ds_read_b64_tr_b16 a[166:167], v9 offset:41128
  ds_read_b64_tr_b16 a[188:189], v6 offset:41184
  ds_read_b64_tr_b16 a[190:191], v7 offset:41184
  ds_read_b64_tr_b16 a[212:213], v8 offset:41216
  ds_read_b64_tr_b16 a[214:215], v9 offset:41216
  ds_read_b64_tr_b16 a[236:237], v8 offset:41224
  ds_read_b64_tr_b16 a[238:239], v9 offset:41224
  s_waitcnt lgkmcnt(0)
  s_barrier
  s_load_dwordx2 s[32:33], s[0:1], 96
  s_waitcnt lgkmcnt(0)
  s_mov_b32 s32, s32
  s_mov_b32 s33, s33
  s_mov_b32 s34, 256
  s_mov_b32 s35, 0x00020000
  s_mov_b32 s21, 76
  s_cmp_lg_u32 s20, 0
  s_cbranch_scc1 wf_199
  v_mov_b32 v4, 0
  s_mov_b32 s101, 0
wf_198:
  buffer_load_dword v5, v4, s[32:35], s21 offen sc1
  s_add_u32 s101, s101, 1
  s_cmp_gt_u32 s101, 131072
  s_cbranch_scc1 main_end
  s_waitcnt vmcnt(0)
  v_readfirstlane_b32 s100, v5
  s_cmp_ge_u32 s100, 1
  s_cbranch_scc1 wf_199
  s_sleep 8
  s_branch wf_198
wf_199:
  s_barrier
  s_mul_i32 s40, s2, 12288
  s_mul_i32 s47, s20, 3072
  s_add_u32 s40, s40, s47
  s_lshr_b32 s43, s2, 2
  s_lshl_b32 s43, s43, 7
  s_add_u32 s43, s43, 0
  s_lshl_b32 s44, s2, 7
  s_lshl_b32 s21, s20, 2
  s_add_u32 s44, s44, s21
  s_add_u32 s44, s44, 94208
  s_lshl_b32 s49, s20, 8
  s_add_u32 s49, s49, 12288
  s_mov_b32 s45, 0
  v_lshlrev_b32 v4, 4, v1
  v_min_u32 v14, 17, v1
  v_lshlrev_b32 v14, 10, v14
  v_mov_b32 v17, 1073741824
  v_cmp_eq_u32 vcc, 0, v1
  s_nop 1
  v_cndmask_b32 v17, v17, 0, vcc
vwr_200:
  s_cmp_lg_u32 s20, 0
  s_cbranch_scc1 vwr_202
  s_mov_b32 s101, 0
vwr_201:
  s_sleep 4
  buffer_load_dword v15, v14, s[72:75], s43 offen sc1
  s_add_u32 s101, s101, 1
  s_cmp_gt_u32 s101, 131072
  s_cbranch_scc1 main_end
  s_waitcnt vmcnt(0)
  v_cmp_le_u32 vcc, 8, v15
  s_nop 1
  s_ff0_i32_b32 s21, vcc_lo
  s_min_u32 s21, s21, 18
  s_lshl_b32 s22, s21, 1
  s_lshl_b32 s21, s21, 2
  s_sub_i32 s21, s21, 8
  s_max_i32 s46, s21, s22
  s_cmp_le_u32 s46, s45
  s_cbranch_scc1 vwr_201
  v_mov_b32 v15, s46
  v_mov_b32 v16, 65536
  ds_write_b32 v16, v15
  s_waitcnt lgkmcnt(0)
vwr_202:
  s_barrier
  v_mov_b32 v16, 65536
  ds_read_b32 v15, v16
  s_and_b32 s50, s45, 2
  s_lshl_b32 s50, s50, 14
  v_add_u32 v10, s50, v4
  v_add_u32 v11, 2048, v10
  v_add_u32 v12, 2056, v10
  v_lshl_add_u32 v13, v1, 2, s50
  s_mul_i32 s41, s45, 393216
  s_add_u32 s41, s41, s40
  s_mov_b32 s48, s45
  s_mul_i32 s42, s45, 1310720
  s_mul_i32 s21, s2, 40960
  s_add_u32 s42, s42, s21
  s_mul_i32 s21, s20, 10240
  s_add_u32 s42, s42, s21
  s_mov_b32 s51, 1073741824
  s_waitcnt lgkmcnt(0)
  v_readfirstlane_b32 s46, v15
  s_mov_b32 s52, s50
  s_cmp_lt_u32 s48, s46
  s_cselect_b32 s53, s41, 1073741824
  s_add_u32 s54, s52, 0
  s_add_u32 m0, s54, s47
  s_nop 0
  buffer_load_dwordx4 v4, s[16:19], s53 offen offset:0 sc1 lds
  buffer_load_dwordx4 v4, s[16:19], s53 offen offset:1024 sc1 lds
  buffer_load_dwordx4 v4, s[16:19], s53 offen offset:2048 sc1 lds
  s_nop 0
  s_add_u32 m0, s54, s49
  s_nop 0
  buffer_load_dword v14, s[72:75], s43 offen sc1 lds
  s_add_u32 s41, s41, 393216
  s_add_u32 s48, s48, 1
  s_cmp_lt_u32 s48, s46
  s_cselect_b32 s53, s41, 1073741824
  s_add_u32 s54, s52, 16384
  s_add_u32 m0, s54, s47
  s_nop 0
  buffer_load_dwordx4 v4, s[16:19], s53 offen offset:0 sc1 lds
  buffer_load_dwordx4 v4, s[16:19], s53 offen offset:1024 sc1 lds
  buffer_load_dwordx4 v4, s[16:19], s53 offen offset:2048 sc1 lds
  s_nop 0
  s_add_u32 m0, s54, s49
  s_nop 0
  buffer_load_dword v14, s[72:75], s43 offen sc1 lds
  s_add_u32 s41, s41, 393216
  s_add_u32 s48, s48, 1
  s_xor_b32 s52, s52, 32768
  s_cmp_lt_u32 s48, s46
  s_cselect_b32 s53, s41, 1073741824
  s_add_u32 s54, s52, 0
  s_add_u32 m0, s54, s47
  s_nop 0
  buffer_load_dwordx4 v4, s[16:19], s53 offen offset:0 sc1 lds
  buffer_load_dwordx4 v4, s[16:19], s53 offen offset:1024 sc1 lds
  buffer_load_dwordx4 v4, s[16:19], s53 offen offset:2048 sc1 lds
  s_nop 0
  s_add_u32 m0, s54, s49
  s_nop 0
  buffer_load_dword v14, s[72:75], s43 offen sc1 lds
  s_add_u32 s41, s41, 393216
  s_add_u32 s48, s48, 1
  s_waitcnt vmcnt(0)
  s_barrier
  ds_read_b128 v[64:67], v10 offset:0
  ds_read_b128 v[88:91], v10 offset:1024
  ds_read_b128 v[68:71], v10 offset:3072
  ds_read_b128 v[92:95], v10 offset:4096
  ds_read2st64_b64 v[72:75], v11 offset0:0 offset1:6
  ds_read2st64_b64 v[96:99], v12 offset0:0 offset1:6
  ds_read_b128 v[76:79], v10 offset:6144
  ds_read_b128 v[100:103], v10 offset:7168
  ds_read_b128 v[80:83], v10 offset:9216
  ds_read_b128 v[104:107], v10 offset:10240
  ds_read2st64_b64 v[84:87], v11 offset0:12 offset1:18
  ds_read2st64_b64 v[108:111], v12 offset0:12 offset1:18
  s_waitcnt lgkmcnt(0)
  .p2align 3
vwl_203:
  v_mfma_f32_16x16x32_bf16 v[160:163], v[64:67], a[0:3], 0
  v_mfma_f32_16x16x32_bf16 v[164:167], v[88:91], a[0:3], 0
  v_mfma_f32_16x16x32_bf16 v[160:163], v[68:71], a[4:7], v[160:163]
  v_cvt_pk_bf16_f32 v204, v184, v185
  v_cvt_pk_bf16_f32 v205, v186, v187
  v_mfma_f32_16x16x32_bf16 v[164:167], v[92:95], a[4:7], v[164:167]
  v_cvt_pk_bf16_f32 v206, v188, v189
  v_cvt_pk_bf16_f32 v207, v190, v191
  v_mfma_f32_16x16x32_bf16 v[160:163], v[72:75], a[8:11], v[160:163]
  buffer_store_dwordx4 v[204:207], v4, s[24:27], s51 offen offset:1024 sc1
  v_mfma_f32_16x16x32_bf16 v[164:167], v[96:99], a[8:11], v[164:167]
  v_mfma_f32_16x16x32_bf16 v[160:163], v[76:79], a[12:15], v[160:163]
  v_mfma_f32_16x16x32_bf16 v[164:167], v[100:103], a[12:15], v[164:167]
  s_waitcnt vmcnt(23)
  s_barrier
  ds_read_b32 v15, v13 offset:28672
  v_mfma_f32_16x16x32_bf16 v[160:163], v[80:83], a[16:19], v[160:163]
  ds_read_b128 v[112:115], v10 offset:16384
  v_mfma_f32_16x16x32_bf16 v[164:167], v[104:107], a[16:19], v[164:167]
  v_mfma_f32_16x16x32_bf16 v[160:163], v[84:87], a[20:23], v[160:163]
  ds_read_b128 v[136:139], v10 offset:17408
  v_mfma_f32_16x16x32_bf16 v[164:167], v[108:111], a[20:23], v[164:167]
  v_mfma_f32_16x16x32_bf16 v[168:171], v[64:67], a[24:27], 0
  ds_read_b128 v[116:119], v10 offset:19456
  v_mfma_f32_16x16x32_bf16 v[172:175], v[88:91], a[24:27], 0
  v_mfma_f32_16x16x32_bf16 v[168:171], v[68:71], a[28:31], v[168:171]
  v_cvt_pk_bf16_f32 v192, v160, v161
  v_cvt_pk_bf16_f32 v193, v162, v163
  v_mfma_f32_16x16x32_bf16 v[172:175], v[92:95], a[28:31], v[172:175]
  v_cvt_pk_bf16_f32 v194, v164, v165
  v_cvt_pk_bf16_f32 v195, v166, v167
  v_mfma_f32_16x16x32_bf16 v[168:171], v[72:75], a[32:35], v[168:171]
  s_add_u32 s55, s42, 0
  buffer_store_dwordx4 v[192:195], v4, s[24:27], s55 offen offset:0 sc1
  ds_read_b128 v[140:143], v10 offset:20480
  v_mfma_f32_16x16x32_bf16 v[172:175], v[96:99], a[32:35], v[172:175]
  v_mfma_f32_16x16x32_bf16 v[168:171], v[76:79], a[36:39], v[168:171]
  ds_read2st64_b64 v[120:123], v11 offset0:32 offset1:38
  v_mfma_f32_16x16x32_bf16 v[172:175], v[100:103], a[36:39], v[172:175]
  v_mfma_f32_16x16x32_bf16 v[168:171], v[80:83], a[40:43], v[168:171]
  ds_read2st64_b64 v[144:147], v12 offset0:32 offset1:38
  v_mfma_f32_16x16x32_bf16 v[172:175], v[104:107], a[40:43], v[172:175]
  v_mfma_f32_16x16x32_bf16 v[168:171], v[84:87], a[44:47], v[168:171]
  ds_read_b128 v[124:127], v10 offset:22528
  v_mfma_f32_16x16x32_bf16 v[172:175], v[108:111], a[44:47], v[172:175]
  v_mfma_f32_16x16x32_bf16 v[176:179], v[64:67], a[48:51], 0
  ds_read_b128 v[148:151], v10 offset:23552
  v_mfma_f32_16x16x32_bf16 v[180:183], v[88:91], a[48:51], 0
  v_mfma_f32_16x16x32_bf16 v[176:179], v[68:71], a[52:55], v[176:179]
  v_cvt_pk_bf16_f32 v196, v168, v169
  v_cvt_pk_bf16_f32 v197, v170, v171
  v_mfma_f32_16x16x32_bf16 v[180:183], v[92:95], a[52:55], v[180:183]
  v_cvt_pk_bf16_f32 v198, v172, v173
  v_cvt_pk_bf16_f32 v199, v174, v175
  v_mfma_f32_16x16x32_bf16 v[176:179], v[72:75], a[56:59], v[176:179]
  buffer_store_dwordx4 v[196:199], v4, s[24:27], s55 offen offset:1024 sc1
  ds_read_b128 v[128:131], v10 offset:25600
  v_mfma_f32_16x16x32_bf16 v[180:183], v[96:99], a[56:59], v[180:183]
  v_mfma_f32_16x16x32_bf16 v[176:179], v[76:79], a[60:63], v[176:179]
  ds_read_b128 v[152:155], v10 offset:26624
  v_mfma_f32_16x16x32_bf16 v[180:183], v[100:103], a[60:63], v[180:183]
  v_mfma_f32_16x16x32_bf16 v[176:179], v[80:83], a[64:67], v[176:179]
  ds_read2st64_b64 v[132:135], v11 offset0:44 offset1:50
  v_mfma_f32_16x16x32_bf16 v[180:183], v[104:107], a[64:67], v[180:183]
  v_mfma_f32_16x16x32_bf16 v[176:179], v[84:87], a[68:71], v[176:179]
  ds_read2st64_b64 v[156:159], v12 offset0:44 offset1:50
  v_mfma_f32_16x16x32_bf16 v[180:183], v[108:111], a[68:71], v[180:183]
  v_mfma_f32_16x16x32_bf16 v[184:187], v[64:67], a[72:75], 0
  v_mfma_f32_16x16x32_bf16 v[188:191], v[88:91], a[72:75], 0
  s_waitcnt lgkmcnt(12)
  v_cmp_le_u32 vcc, 8, v15
  v_mfma_f32_16x16x32_bf16 v[184:187], v[68:71], a[76:79], v[184:187]
  v_cvt_pk_bf16_f32 v200, v176, v177
  v_cvt_pk_bf16_f32 v201, v178, v179
  v_mfma_f32_16x16x32_bf16 v[188:191], v[92:95], a[76:79], v[188:191]
  v_cvt_pk_bf16_f32 v202, v180, v181
  v_cvt_pk_bf16_f32 v203, v182, v183
  v_mfma_f32_16x16x32_bf16 v[184:187], v[72:75], a[80:83], v[184:187]
  buffer_store_dwordx4 v[200:203], v4, s[24:27], s55 offen offset:2048 sc1
  s_ff0_i32_b32 s21, vcc_lo
  v_mfma_f32_16x16x32_bf16 v[188:191], v[96:99], a[80:83], v[188:191]
  s_min_u32 s21, s21, 18
  s_lshl_b32 s22, s21, 1
  s_lshl_b32 s21, s21, 2
  v_mfma_f32_16x16x32_bf16 v[184:187], v[76:79], a[84:87], v[184:187]
  s_sub_i32 s21, s21, 8
  s_max_i32 s21, s21, s22
  s_max_u32 s21, s21, s46
  v_mfma_f32_16x16x32_bf16 v[188:191], v[100:103], a[84:87], v[188:191]
  s_cmp_ge_u32 s46, s48
  s_cselect_b32 s46, s21, s46
  v_mfma_f32_16x16x32_bf16 v[184:187], v[80:83], a[88:91], v[184:187]
  s_cmp_lt_u32 s48, s46
  s_cselect_b32 s53, s41, 1073741824
  s_add_u32 s54, s52, 16384
  v_mfma_f32_16x16x32_bf16 v[188:191], v[104:107], a[88:91], v[188:191]
  s_add_u32 m0, s54, s47
  v_mfma_f32_16x16x32_bf16 v[184:187], v[84:87], a[92:95], v[184:187]
  buffer_load_dwordx4 v4, s[16:19], s53 offen offset:0 sc1 lds
  buffer_load_dwordx4 v4, s[16:19], s53 offen offset:1024 sc1 lds
  v_mfma_f32_16x16x32_bf16 v[188:191], v[108:111], a[92:95], v[188:191]
  buffer_load_dwordx4 v4, s[16:19], s53 offen offset:2048 sc1 lds
  v_mfma_f32_16x16x32_bf16 v[160:163], v[64:67], a[96:99], 0
  s_add_u32 m0, s54, s49
  v_mfma_f32_16x16x32_bf16 v[164:167], v[88:91], a[96:99], 0
  buffer_load_dword v14, s[72:75], s43 offen sc1 lds
  s_add_u32 s41, s41, 393216
  v_mfma_f32_16x16x32_bf16 v[160:163], v[68:71], a[100:103], v[160:163]
  v_cvt_pk_bf16_f32 v204, v184, v185
  v_cvt_pk_bf16_f32 v205, v186, v187
  v_mfma_f32_16x16x32_bf16 v[164:167], v[92:95], a[100:103], v[164:167]
  v_cvt_pk_bf16_f32 v206, v188, v189
  v_cvt_pk_bf16_f32 v207, v190, v191
  v_mfma_f32_16x16x32_bf16 v[160:163], v[72:75], a[104:107], v[160:163]
  buffer_store_dwordx4 v[204:207], v4, s[24:27], s55 offen offset:3072 sc1
  s_add_u32 s48, s48, 1
  v_mfma_f32_16x16x32_bf16 v[164:167], v[96:99], a[104:107], v[164:167]
  v_mfma_f32_16x16x32_bf16 v[160:163], v[76:79], a[108:111], v[160:163]
  v_mfma_f32_16x16x32_bf16 v[164:167], v[100:103], a[108:111], v[164:167]
  v_mfma_f32_16x16x32_bf16 v[160:163], v[80:83], a[112:115], v[160:163]
  v_mfma_f32_16x16x32_bf16 v[164:167], v[104:107], a[112:115], v[164:167]
  v_mfma_f32_16x16x32_bf16 v[160:163], v[84:87], a[116:119], v[160:163]
  v_mfma_f32_16x16x32_bf16 v[164:167], v[108:111], a[116:119], v[164:167]
  v_mfma_f32_16x16x32_bf16 v[168:171], v[64:67], a[120:123], 0
  v_mfma_f32_16x16x32_bf16 v[172:175], v[88:91], a[120:123], 0
  v_mfma_f32_16x16x32_bf16 v[168:171], v[68:71], a[124:127], v[168:171]
  v_cvt_pk_bf16_f32 v192, v160, v161
  v_cvt_pk_bf16_f32 v193, v162, v163
  v_mfma_f32_16x16x32_bf16 v[172:175], v[92:95], a[124:127], v[172:175]
  v_cvt_pk_bf16_f32 v194, v164, v165
  v_cvt_pk_bf16_f32 v195, v166, v167
  v_mfma_f32_16x16x32_bf16 v[168:171], v[72:75], a[128:131], v[168:171]
  s_add_u32 s55, s42, 4096
  buffer_store_dwordx4 v[192:195], v4, s[24:27], s55 offen offset:0 sc1
  v_mfma_f32_16x16x32_bf16 v[172:175], v[96:99], a[128:131], v[172:175]
  v_mfma_f32_16x16x32_bf16 v[168:171], v[76:79], a[132:135], v[168:171]
  v_mfma_f32_16x16x32_bf16 v[172:175], v[100:103], a[132:135], v[172:175]
  v_mfma_f32_16x16x32_bf16 v[168:171], v[80:83], a[136:139], v[168:171]
  v_mfma_f32_16x16x32_bf16 v[172:175], v[104:107], a[136:139], v[172:175]
  v_mfma_f32_16x16x32_bf16 v[168:171], v[84:87], a[140:143], v[168:171]
  v_mfma_f32_16x16x32_bf16 v[172:175], v[108:111], a[140:143], v[172:175]
  v_mfma_f32_16x16x32_bf16 v[176:179], v[64:67], a[144:147], 0
  v_mfma_f32_16x16x32_bf16 v[180:183], v[88:91], a[144:147], 0
  v_mfma_f32_16x16x32_bf16 v[176:179], v[68:71], a[148:151], v[176:179]
  v_cvt_pk_bf16_f32 v196, v168, v169
  v_cvt_pk_bf16_f32 v197, v170, v171
  v_mfma_f32_16x16x32_bf16 v[180:183], v[92:95], a[148:151], v[180:183]
  v_cvt_pk_bf16_f32 v198, v172, v173
  v_cvt_pk_bf16_f32 v199, v174, v175
  v_mfma_f32_16x16x32_bf16 v[176:179], v[72:75], a[152:155], v[176:179]
  buffer_store_dwordx4 v[196:199], v4, s[24:27], s55 offen offset:1024 sc1
  v_mfma_f32_16x16x32_bf16 v[180:183], v[96:99], a[152:155], v[180:183]
  v_mfma_f32_16x16x32_bf16 v[176:179], v[76:79], a[156:159], v[176:179]
  v_mfma_f32_16x16x32_bf16 v[180:183], v[100:103], a[156:159], v[180:183]
  v_mfma_f32_16x16x32_bf16 v[176:179], v[80:83], a[160:163], v[176:179]
  v_mfma_f32_16x16x32_bf16 v[180:183], v[104:107], a[160:163], v[180:183]
  v_mfma_f32_16x16x32_bf16 v[176:179], v[84:87], a[164:167], v[176:179]
  v_mfma_f32_16x16x32_bf16 v[180:183], v[108:111], a[164:167], v[180:183]
  v_mfma_f32_16x16x32_bf16 v[184:187], v[64:67], a[168:171], 0
  v_mfma_f32_16x16x32_bf16 v[188:191], v[88:91], a[168:171], 0
  v_mfma_f32_16x16x32_bf16 v[184:187], v[68:71], a[172:175], v[184:187]
  v_cvt_pk_bf16_f32 v200, v176, v177
  v_cvt_pk_bf16_f32 v201, v178, v179
  v_mfma_f32_16x16x32_bf16 v[188:191], v[92:95], a[172:175], v[188:191]
  v_cvt_pk_bf16_f32 v202, v180, v181
  v_cvt_pk_bf16_f32 v203, v182, v183
  v_mfma_f32_16x16x32_bf16 v[184:187], v[72:75], a[176:179], v[184:187]
  buffer_store_dwordx4 v[200:203], v4, s[24:27], s55 offen offset:2048 sc1
  v_mfma_f32_16x16x32_bf16 v[188:191], v[96:99], a[176:179], v[188:191]
  v_mfma_f32_16x16x32_bf16 v[184:187], v[76:79], a[180:183], v[184:187]
  v_mfma_f32_16x16x32_bf16 v[188:191], v[100:103], a[180:183], v[188:191]
  v_mfma_f32_16x16x32_bf16 v[184:187], v[80:83], a[184:187], v[184:187]
  v_mfma_f32_16x16x32_bf16 v[188:191], v[104:107], a[184:187], v[188:191]
  v_mfma_f32_16x16x32_bf16 v[184:187], v[84:87], a[188:191], v[184:187]
  v_mfma_f32_16x16x32_bf16 v[188:191], v[108:111], a[188:191], v[188:191]
  v_mfma_f32_16x16x32_bf16 v[160:163], v[64:67], a[192:195], 0
  s_min_u32 s21, s45, 52
  v_mov_b32 v16, s21
  s_waitcnt vmcnt(11)
  v_mfma_f32_16x16x32_bf16 v[164:167], v[88:91], a[192:195], 0
  buffer_store_dword v16, v17, s[72:75], s44 offen sc1
  v_mfma_f32_16x16x32_bf16 v[160:163], v[68:71], a[196:199], v[160:163]
  v_cvt_pk_bf16_f32 v204, v184, v185
  v_cvt_pk_bf16_f32 v205, v186, v187
  v_mfma_f32_16x16x32_bf16 v[164:167], v[92:95], a[196:199], v[164:167]
  v_cvt_pk_bf16_f32 v206, v188, v189
  v_cvt_pk_bf16_f32 v207, v190, v191
  v_mfma_f32_16x16x32_bf16 v[160:163], v[72:75], a[200:203], v[160:163]
  buffer_store_dwordx4 v[204:207], v4, s[24:27], s55 offen offset:3072 sc1
  v_mfma_f32_16x16x32_bf16 v[164:167], v[96:99], a[200:203], v[164:167]
  v_mfma_f32_16x16x32_bf16 v[160:163], v[76:79], a[204:207], v[160:163]
  v_mfma_f32_16x16x32_bf16 v[164:167], v[100:103], a[204:207], v[164:167]
  v_mfma_f32_16x16x32_bf16 v[160:163], v[80:83], a[208:211], v[160:163]
  v_mfma_f32_16x16x32_bf16 v[164:167], v[104:107], a[208:211], v[164:167]
  v_mfma_f32_16x16x32_bf16 v[160:163], v[84:87], a[212:215], v[160:163]
  v_mfma_f32_16x16x32_bf16 v[164:167], v[108:111], a[212:215], v[164:167]
  v_mfma_f32_16x16x32_bf16 v[168:171], v[64:67], a[216:219], 0
  v_mfma_f32_16x16x32_bf16 v[172:175], v[88:91], a[216:219], 0
  v_mfma_f32_16x16x32_bf16 v[168:171], v[68:71], a[220:223], v[168:171]
  v_cvt_pk_bf16_f32 v192, v160, v161
  v_cvt_pk_bf16_f32 v193, v162, v163
  v_mfma_f32_16x16x32_bf16 v[172:175], v[92:95], a[220:223], v[172:175]
  v_cvt_pk_bf16_f32 v194, v164, v165
  v_cvt_pk_bf16_f32 v195, v166, v167
  v_mfma_f32_16x16x32_bf16 v[168:171], v[72:75], a[224:227], v[168:171]
  s_add_u32 s55, s42, 8192
  buffer_store_dwordx4 v[192:195], v4, s[24:27], s55 offen offset:0 sc1
  v_mfma_f32_16x16x32_bf16 v[172:175], v[96:99], a[224:227], v[172:175]
  v_mfma_f32_16x16x32_bf16 v[168:171], v[76:79], a[228:231], v[168:171]
  s_add_u32 s51, s42, 8192
  s_add_u32 s42, s42, 1310720
  s_add_u32 s45, s45, 1
  v_mfma_f32_16x16x32_bf16 v[172:175], v[100:103], a[228:231], v[172:175]
  v_mfma_f32_16x16x32_bf16 v[168:171], v[80:83], a[232:235], v[168:171]
  v_mfma_f32_16x16x32_bf16 v[172:175], v[104:107], a[232:235], v[172:175]
  v_mfma_f32_16x16x32_bf16 v[168:171], v[84:87], a[236:239], v[168:171]
  v_mfma_f32_16x16x32_bf16 v[172:175], v[108:111], a[236:239], v[172:175]
  s_waitcnt lgkmcnt(0)
  v_mfma_f32_16x16x32_bf16 v[176:179], v[112:115], a[0:3], 0
  v_mfma_f32_16x16x32_bf16 v[180:183], v[136:139], a[0:3], 0
  v_mfma_f32_16x16x32_bf16 v[176:179], v[116:119], a[4:7], v[176:179]
  v_cvt_pk_bf16_f32 v196, v168, v169
  v_cvt_pk_bf16_f32 v197, v170, v171
  v_mfma_f32_16x16x32_bf16 v[180:183], v[140:143], a[4:7], v[180:183]
  v_cvt_pk_bf16_f32 v198, v172, v173
  v_cvt_pk_bf16_f32 v199, v174, v175
  v_mfma_f32_16x16x32_bf16 v[176:179], v[120:123], a[8:11], v[176:179]
  buffer_store_dwordx4 v[196:199], v4, s[24:27], s51 offen offset:1024 sc1
  v_mfma_f32_16x16x32_bf16 v[180:183], v[144:147], a[8:11], v[180:183]
  v_mfma_f32_16x16x32_bf16 v[176:179], v[124:127], a[12:15], v[176:179]
  v_mfma_f32_16x16x32_bf16 v[180:183], v[148:151], a[12:15], v[180:183]
  s_waitcnt vmcnt(22)
  s_barrier
  v_xor_b32 v10, 32768, v10
  v_mfma_f32_16x16x32_bf16 v[176:179], v[128:131], a[16:19], v[176:179]
  v_xor_b32 v11, 32768, v11
  v_xor_b32 v12, 32768, v12
  v_mfma_f32_16x16x32_bf16 v[180:183], v[152:155], a[16:19], v[180:183]
  v_xor_b32 v13, 32768, v13
  ds_read_b32 v15, v13 offset:12288
  v_mfma_f32_16x16x32_bf16 v[176:179], v[132:135], a[20:23], v[176:179]
  ds_read_b128 v[64:67], v10 offset:0
  v_mfma_f32_16x16x32_bf16 v[180:183], v[156:159], a[20:23], v[180:183]
  v_mfma_f32_16x16x32_bf16 v[184:187], v[112:115], a[24:27], 0
  ds_read_b128 v[88:91], v10 offset:1024
  v_mfma_f32_16x16x32_bf16 v[188:191], v[136:139], a[24:27], 0
  v_mfma_f32_16x16x32_bf16 v[184:187], v[116:119], a[28:31], v[184:187]
  v_cvt_pk_bf16_f32 v200, v176, v177
  v_cvt_pk_bf16_f32 v201, v178, v179
  v_mfma_f32_16x16x32_bf16 v[188:191], v[140:143], a[28:31], v[188:191]
  v_cvt_pk_bf16_f32 v202, v180, v181
  v_cvt_pk_bf16_f32 v203, v182, v183
  v_mfma_f32_16x16x32_bf16 v[184:187], v[120:123], a[32:35], v[184:187]
  s_add_u32 s55, s42, 0
  buffer_store_dwordx4 v[200:203], v4, s[24:27], s55 offen offset:0 sc1
  ds_read_b128 v[68:71], v10 offset:3072
  v_mfma_f32_16x16x32_bf16 v[188:191], v[144:147], a[32:35], v[188:191]
  v_mfma_f32_16x16x32_bf16 v[184:187], v[124:127], a[36:39], v[184:187]
  ds_read_b128 v[92:95], v10 offset:4096
  v_mfma_f32_16x16x32_bf16 v[188:191], v[148:151], a[36:39], v[188:191]
  v_mfma_f32_16x16x32_bf16 v[184:187], v[128:131], a[40:43], v[184:187]
  ds_read2st64_b64 v[72:75], v11 offset0:0 offset1:6
  v_mfma_f32_16x16x32_bf16 v[188:191], v[152:155], a[40:43], v[188:191]
  v_mfma_f32_16x16x32_bf16 v[184:187], v[132:135], a[44:47], v[184:187]
  ds_read2st64_b64 v[96:99], v12 offset0:0 offset1:6
  v_mfma_f32_16x16x32_bf16 v[188:191], v[156:159], a[44:47], v[188:191]
  v_mfma_f32_16x16x32_bf16 v[160:163], v[112:115], a[48:51], 0
  ds_read_b128 v[76:79], v10 offset:6144
  v_mfma_f32_16x16x32_bf16 v[164:167], v[136:139], a[48:51], 0
  v_mfma_f32_16x16x32_bf16 v[160:163], v[116:119], a[52:55], v[160:163]
  v_cvt_pk_bf16_f32 v204, v184, v185
  v_cvt_pk_bf16_f32 v205, v186, v187
  v_mfma_f32_16x16x32_bf16 v[164:167], v[140:143], a[52:55], v[164:167]
  v_cvt_pk_bf16_f32 v206, v188, v189
  v_cvt_pk_bf16_f32 v207, v190, v191
  v_mfma_f32_16x16x32_bf16 v[160:163], v[120:123], a[56:59], v[160:163]
  buffer_store_dwordx4 v[204:207], v4, s[24:27], s55 offen offset:1024 sc1
  ds_read_b128 v[100:103], v10 offset:7168
  v_mfma_f32_16x16x32_bf16 v[164:167], v[144:147], a[56:59], v[164:167]
  v_mfma_f32_16x16x32_bf16 v[160:163], v[124:127], a[60:63], v[160:163]
  ds_read_b128 v[80:83], v10 offset:9216
  v_mfma_f32_16x16x32_bf16 v[164:167], v[148:151], a[60:63], v[164:167]
  v_mfma_f32_16x16x32_bf16 v[160:163], v[128:131], a[64:67], v[160:163]
  ds_read_b128 v[104:107], v10 offset:10240
  v_mfma_f32_16x16x32_bf16 v[164:167], v[152:155], a[64:67], v[164:167]
  v_mfma_f32_16x16x32_bf16 v[160:163], v[132:135], a[68:71], v[160:163]
  ds_read2st64_b64 v[84:87], v11 offset0:12 offset1:18
  v_mfma_f32_16x16x32_bf16 v[164:167], v[156:159], a[68:71], v[164:167]
  v_mfma_f32_16x16x32_bf16 v[168:171], v[112:115], a[72:75], 0
  ds_read2st64_b64 v[108:111], v12 offset0:12 offset1:18
  v_mfma_f32_16x16x32_bf16 v[172:175], v[136:139], a[72:75], 0
  v_mfma_f32_16x16x32_bf16 v[168:171], v[116:119], a[76:79], v[168:171]
  v_cvt_pk_bf16_f32 v192, v160, v161
  v_cvt_pk_bf16_f32 v193, v162, v163
  v_mfma_f32_16x16x32_bf16 v[172:175], v[140:143], a[76:79], v[172:175]
  v_cvt_pk_bf16_f32 v194, v164, v165
  v_cvt_pk_bf16_f32 v195, v166, v167
  v_mfma_f32_16x16x32_bf16 v[168:171], v[120:123], a[80:83], v[168:171]
  buffer_store_dwordx4 v[192:195], v4, s[24:27], s55 offen offset:2048 sc1
  s_waitcnt lgkmcnt(12)
  v_mfma_f32_16x16x32_bf16 v[172:175], v[144:147], a[80:83], v[172:175]
  v_cmp_le_u32 vcc, 8, v15
  v_mfma_f32_16x16x32_bf16 v[168:171], v[124:127], a[84:87], v[168:171]
  s_ff0_i32_b32 s21, vcc_lo
  s_min_u32 s21, s21, 18
  s_lshl_b32 s22, s21, 1
  v_mfma_f32_16x16x32_bf16 v[172:175], v[148:151], a[84:87], v[172:175]
  s_lshl_b32 s21, s21, 2
  s_sub_i32 s21, s21, 8
  s_max_i32 s21, s21, s22
  v_mfma_f32_16x16x32_bf16 v[168:171], v[128:131], a[88:91], v[168:171]
  s_max_u32 s21, s21, s46
  s_cmp_ge_u32 s46, s48
  s_cselect_b32 s46, s21, s46
  v_mfma_f32_16x16x32_bf16 v[172:175], v[152:155], a[88:91], v[172:175]
  s_xor_b32 s52, s52, 32768
  s_cmp_lt_u32 s48, s46
  s_cselect_b32 s53, s41, 1073741824
  v_mfma_f32_16x16x32_bf16 v[168:171], v[132:135], a[92:95], v[168:171]
  s_add_u32 s54, s52, 0
  s_add_u32 m0, s54, s47
  v_mfma_f32_16x16x32_bf16 v[172:175], v[156:159], a[92:95], v[172:175]
  buffer_load_dwordx4 v4, s[16:19], s53 offen offset:0 sc1 lds
  buffer_load_dwordx4 v4, s[16:19], s53 offen offset:1024 sc1 lds
  v_mfma_f32_16x16x32_bf16 v[176:179], v[112:115], a[96:99], 0
  buffer_load_dwordx4 v4, s[16:19], s53 offen offset:2048 sc1 lds
  v_mfma_f32_16x16x32_bf16 v[180:183], v[136:139], a[96:99], 0
  s_add_u32 m0, s54, s49
  v_mfma_f32_16x16x32_bf16 v[176:179], v[116:119], a[100:103], v[176:179]
  v_cvt_pk_bf16_f32 v196, v168, v169
  v_cvt_pk_bf16_f32 v197, v170, v171
  v_mfma_f32_16x16x32_bf16 v[180:183], v[140:143], a[100:103], v[180:183]
  v_cvt_pk_bf16_f32 v198, v172, v173
  v_cvt_pk_bf16_f32 v199, v174, v175
  v_mfma_f32_16x16x32_bf16 v[176:179], v[120:123], a[104:107], v[176:179]
  buffer_store_dwordx4 v[196:199], v4, s[24:27], s55 offen offset:3072 sc1
  buffer_load_dword v14, s[72:75], s43 offen sc1 lds
  v_mfma_f32_16x16x32_bf16 v[180:183], v[144:147], a[104:107], v[180:183]
  s_add_u32 s41, s41, 393216
  s_add_u32 s48, s48, 1
  v_mfma_f32_16x16x32_bf16 v[176:179], v[124:127], a[108:111], v[176:179]
  v_mfma_f32_16x16x32_bf16 v[180:183], v[148:151], a[108:111], v[180:183]
  v_mfma_f32_16x16x32_bf16 v[176:179], v[128:131], a[112:115], v[176:179]
  v_mfma_f32_16x16x32_bf16 v[180:183], v[152:155], a[112:115], v[180:183]
  v_mfma_f32_16x16x32_bf16 v[176:179], v[132:135], a[116:119], v[176:179]
  v_mfma_f32_16x16x32_bf16 v[180:183], v[156:159], a[116:119], v[180:183]
  v_mfma_f32_16x16x32_bf16 v[184:187], v[112:115], a[120:123], 0
  v_mfma_f32_16x16x32_bf16 v[188:191], v[136:139], a[120:123], 0
  v_mfma_f32_16x16x32_bf16 v[184:187], v[116:119], a[124:127], v[184:187]
  v_cvt_pk_bf16_f32 v200, v176, v177
  v_cvt_pk_bf16_f32 v201, v178, v179
  v_mfma_f32_16x16x32_bf16 v[188:191], v[140:143], a[124:127], v[188:191]
  v_cvt_pk_bf16_f32 v202, v180, v181
  v_cvt_pk_bf16_f32 v203, v182, v183
  v_mfma_f32_16x16x32_bf16 v[184:187], v[120:123], a[128:131], v[184:187]
  s_add_u32 s55, s42, 4096
  buffer_store_dwordx4 v[200:203], v4, s[24:27], s55 offen offset:0 sc1
  v_mfma_f32_16x16x32_bf16 v[188:191], v[144:147], a[128:131], v[188:191]
  v_mfma_f32_16x16x32_bf16 v[184:187], v[124:127], a[132:135], v[184:187]
  v_mfma_f32_16x16x32_bf16 v[188:191], v[148:151], a[132:135], v[188:191]
  v_mfma_f32_16x16x32_bf16 v[184:187], v[128:131], a[136:139], v[184:187]
  v_mfma_f32_16x16x32_bf16 v[188:191], v[152:155], a[136:139], v[188:191]
  v_mfma_f32_16x16x32_bf16 v[184:187], v[132:135], a[140:143], v[184:187]
  v_mfma_f32_16x16x32_bf16 v[188:191], v[156:159], a[140:143], v[188:191]
  v_mfma_f32_16x16x32_bf16 v[160:163], v[112:115], a[144:147], 0
  v_mfma_f32_16x16x32_bf16 v[164:167], v[136:139], a[144:147], 0
  v_mfma_f32_16x16x32_bf16 v[160:163], v[116:119], a[148:151], v[160:163]
  v_cvt_pk_bf16_f32 v204, v184, v185
  v_cvt_pk_bf16_f32 v205, v186, v187
  v_mfma_f32_16x16x32_bf16 v[164:167], v[140:143], a[148:151], v[164:167]
  v_cvt_pk_bf16_f32 v206, v188, v189
  v_cvt_pk_bf16_f32 v207, v190, v191
  v_mfma_f32_16x16x32_bf16 v[160:163], v[120:123], a[152:155], v[160:163]
  buffer_store_dwordx4 v[204:207], v4, s[24:27], s55 offen offset:1024 sc1
  v_mfma_f32_16x16x32_bf16 v[164:167], v[144:147], a[152:155], v[164:167]
  v_mfma_f32_16x16x32_bf16 v[160:163], v[124:127], a[156:159], v[160:163]
  v_mfma_f32_16x16x32_bf16 v[164:167], v[148:151], a[156:159], v[164:167]
  v_mfma_f32_16x16x32_bf16 v[160:163], v[128:131], a[160:163], v[160:163]
  v_mfma_f32_16x16x32_bf16 v[164:167], v[152:155], a[160:163], v[164:167]
  v_mfma_f32_16x16x32_bf16 v[160:163], v[132:135], a[164:167], v[160:163]
  v_mfma_f32_16x16x32_bf16 v[164:167], v[156:159], a[164:167], v[164:167]
  v_mfma_f32_16x16x32_bf16 v[168:171], v[112:115], a[168:171], 0
  v_mfma_f32_16x16x32_bf16 v[172:175], v[136:139], a[168:171], 0
  v_mfma_f32_16x16x32_bf16 v[168:171], v[116:119], a[172:175], v[168:171]
  v_cvt_pk_bf16_f32 v192, v160, v161
  v_cvt_pk_bf16_f32 v193, v162, v163
  v_mfma_f32_16x16x32_bf16 v[172:175], v[140:143], a[172:175], v[172:175]
  v_cvt_pk_bf16_f32 v194, v164, v165
  v_cvt_pk_bf16_f32 v195, v166, v167
  v_mfma_f32_16x16x32_bf16 v[168:171], v[120:123], a[176:179], v[168:171]
  buffer_store_dwordx4 v[192:195], v4, s[24:27], s55 offen offset:2048 sc1
  v_mfma_f32_16x16x32_bf16 v[172:175], v[144:147], a[176:179], v[172:175]
  v_mfma_f32_16x16x32_bf16 v[168:171], v[124:127], a[180:183], v[168:171]
  v_mfma_f32_16x16x32_bf16 v[172:175], v[148:151], a[180:183], v[172:175]
  v_mfma_f32_16x16x32_bf16 v[168:171], v[128:131], a[184:187], v[168:171]
  v_mfma_f32_16x16x32_bf16 v[172:175], v[152:155], a[184:187], v[172:175]
  v_mfma_f32_16x16x32_bf16 v[168:171], v[132:135], a[188:191], v[168:171]
  v_mfma_f32_16x16x32_bf16 v[172:175], v[156:159], a[188:191], v[172:175]
  v_mfma_f32_16x16x32_bf16 v[176:179], v[112:115], a[192:195], 0
  s_min_u32 s21, s45, 52
  v_mov_b32 v16, s21
  s_waitcnt vmcnt(11)
  v_mfma_f32_16x16x32_bf16 v[180:183], v[136:139], a[192:195], 0
  buffer_store_dword v16, v17, s[72:75], s44 offen sc1
  v_mfma_f32_16x16x32_bf16 v[176:179], v[116:119], a[196:199], v[176:179]
  v_cvt_pk_bf16_f32 v196, v168, v169
  v_cvt_pk_bf16_f32 v197, v170, v171
  v_mfma_f32_16x16x32_bf16 v[180:183], v[140:143], a[196:199], v[180:183]
  v_cvt_pk_bf16_f32 v198, v172, v173
  v_cvt_pk_bf16_f32 v199, v174, v175
  v_mfma_f32_16x16x32_bf16 v[176:179], v[120:123], a[200:203], v[176:179]
  buffer_store_dwordx4 v[196:199], v4, s[24:27], s55 offen offset:3072 sc1
  v_mfma_f32_16x16x32_bf16 v[180:183], v[144:147], a[200:203], v[180:183]
  v_mfma_f32_16x16x32_bf16 v[176:179], v[124:127], a[204:207], v[176:179]
  v_mfma_f32_16x16x32_bf16 v[180:183], v[148:151], a[204:207], v[180:183]
  v_mfma_f32_16x16x32_bf16 v[176:179], v[128:131], a[208:211], v[176:179]
  v_mfma_f32_16x16x32_bf16 v[180:183], v[152:155], a[208:211], v[180:183]
  v_mfma_f32_16x16x32_bf16 v[176:179], v[132:135], a[212:215], v[176:179]
  v_mfma_f32_16x16x32_bf16 v[180:183], v[156:159], a[212:215], v[180:183]
  v_mfma_f32_16x16x32_bf16 v[184:187], v[112:115], a[216:219], 0
  v_mfma_f32_16x16x32_bf16 v[188:191], v[136:139], a[216:219], 0
  v_mfma_f32_16x16x32_bf16 v[184:187], v[116:119], a[220:223], v[184:187]
  v_cvt_pk_bf16_f32 v200, v176, v177
  v_cvt_pk_bf16_f32 v201, v178, v179
  v_mfma_f32_16x16x32_bf16 v[188:191], v[140:143], a[220:223], v[188:191]
  v_cvt_pk_bf16_f32 v202, v180, v181
  v_cvt_pk_bf16_f32 v203, v182, v183
  v_mfma_f32_16x16x32_bf16 v[184:187], v[120:123], a[224:227], v[184:187]
  s_add_u32 s55, s42, 8192
  buffer_store_dwordx4 v[200:203], v4, s[24:27], s55 offen offset:0 sc1
  v_mfma_f32_16x16x32_bf16 v[188:191], v[144:147], a[224:227], v[188:191]
  v_mfma_f32_16x16x32_bf16 v[184:187], v[124:127], a[228:231], v[184:187]
  s_add_u32 s51, s42, 8192
  s_add_u32 s42, s42, 1310720
  s_add_u32 s45, s45, 1
  v_mfma_f32_16x16x32_bf16 v[188:191], v[148:151], a[228:231], v[188:191]
  v_mfma_f32_16x16x32_bf16 v[184:187], v[128:131], a[232:235], v[184:187]
  v_mfma_f32_16x16x32_bf16 v[188:191], v[152:155], a[232:235], v[188:191]
  v_mfma_f32_16x16x32_bf16 v[184:187], v[132:135], a[236:239], v[184:187]
  s_cmp_lt_u32 s45, s46
  v_mfma_f32_16x16x32_bf16 v[188:191], v[156:159], a[236:239], v[188:191]
  s_waitcnt lgkmcnt(0)
  s_cbranch_scc1 vwl_203
  s_nop 7
  v_cvt_pk_bf16_f32 v204, v184, v185
  v_cvt_pk_bf16_f32 v205, v186, v187
  v_cvt_pk_bf16_f32 v206, v188, v189
  v_cvt_pk_bf16_f32 v207, v190, v191
  buffer_store_dwordx4 v[204:207], v4, s[24:27], s51 offen offset:1024 sc1
  s_min_u32 s21, s45, 52
  v_mov_b32 v16, s21
  s_waitcnt vmcnt(0)
  buffer_store_dword v16, v17, s[72:75], s44 offen sc1
  s_cmp_lt_u32 s45, 64
  s_cbranch_scc1 vwr_200
  s_add_u32 s84, s38, 50331648
  s_addc_u32 s85, s39, 0
  s_mov_b32 s86, 6291456
  s_mov_b32 s87, 0x00020000
  s_add_u32 s80, s38, 93323264
  s_addc_u32 s81, s39, 0
  s_mov_b32 s82, 20971520
  s_mov_b32 s83, 0x00020000
  s_add_u32 s88, s38, 85983232
  s_addc_u32 s89, s39, 0
  s_mov_b32 s90, 5242880
  s_mov_b32 s91, 0x00020000
  v_mov_b32 v244, -1
  v_mov_b32 v245, -1
  v_mov_b32 v246, -1
  v_mov_b32 v247, -1
  v_lshlrev_b32 v21, 3, v1
  s_mul_i32 s21, s2, 10240
  s_mul_i32 s22, s20, 2560
  s_add_u32 s21, s21, s22
  s_add_u32 s21, s21, 18350080
  buffer_store_dwordx4 v[244:247], v4, s[80:83], s21 offen sc1
  buffer_store_dwordx4 v[244:247], v4, s[80:83], s21 offen offset:1024 sc1
  buffer_store_dwordx2 v[244:245], v21, s[80:83], s21 offen offset:2048 sc1
  s_add_u32 s21, s21, 327680
  buffer_store_dwordx4 v[244:247], v4, s[80:83], s21 offen sc1
  buffer_store_dwordx4 v[244:247], v4, s[80:83], s21 offen offset:1024 sc1
  buffer_store_dwordx2 v[244:245], v21, s[80:83], s21 offen offset:2048 sc1
  s_add_u32 s21, s21, 327680
  buffer_store_dwordx4 v[244:247], v4, s[80:83], s21 offen sc1
  buffer_store_dwordx4 v[244:247], v4, s[80:83], s21 offen offset:1024 sc1
  buffer_store_dwordx2 v[244:245], v21, s[80:83], s21 offen offset:2048 sc1
  s_add_u32 s21, s21, 327680
  buffer_store_dwordx4 v[244:247], v4, s[80:83], s21 offen sc1
  buffer_store_dwordx4 v[244:247], v4, s[80:83], s21 offen offset:1024 sc1
  buffer_store_dwordx2 v[244:245], v21, s[80:83], s21 offen offset:2048 sc1
  s_add_u32 s21, s21, 327680
  buffer_store_dwordx4 v[244:247], v4, s[80:83], s21 offen sc1
  buffer_store_dwordx4 v[244:247], v4, s[80:83], s21 offen offset:1024 sc1
  buffer_store_dwordx2 v[244:245], v21, s[80:83], s21 offen offset:2048 sc1
  s_add_u32 s21, s21, 327680
  buffer_store_dwordx4 v[244:247], v4, s[80:83], s21 offen sc1
  buffer_store_dwordx4 v[244:247], v4, s[80:83], s21 offen offset:1024 sc1
  buffer_store_dwordx2 v[244:245], v21, s[80:83], s21 offen offset:2048 sc1
  s_add_u32 s21, s21, 327680
  buffer_store_dwordx4 v[244:247], v4, s[80:83], s21 offen sc1
  buffer_store_dwordx4 v[244:247], v4, s[80:83], s21 offen offset:1024 sc1
  buffer_store_dwordx2 v[244:245], v21, s[80:83], s21 offen offset:2048 sc1
  s_add_u32 s21, s21, 327680
  buffer_store_dwordx4 v[244:247], v4, s[80:83], s21 offen sc1
  buffer_store_dwordx4 v[244:247], v4, s[80:83], s21 offen offset:1024 sc1
  buffer_store_dwordx2 v[244:245], v21, s[80:83], s21 offen offset:2048 sc1
  s_add_u32 s21, s21, 327680
  s_and_b32 s21, s2, 3
  s_cmp_lg_u32 s21, s20
  s_cbranch_scc1 arm_204
  s_waitcnt vmcnt(12)
  s_mul_i32 s21, s2, 2560
  s_add_u32 s21, s21, 4587520
  buffer_store_dwordx4 v[244:247], v4, s[88:91], s21 offen sc1
  buffer_store_dwordx4 v[244:247], v4, s[88:91], s21 offen offset:1024 sc1
  buffer_store_dwordx2 v[244:245], v21, s[88:91], s21 offen offset:2048 sc1
  s_add_u32 s21, s21, 81920
  buffer_store_dwordx4 v[244:247], v4, s[88:91], s21 offen sc1
  buffer_store_dwordx4 v[244:247], v4, s[88:91], s21 offen offset:1024 sc1
  buffer_store_dwordx2 v[244:245], v21, s[88:91], s21 offen offset:2048 sc1
  s_add_u32 s21, s21, 81920
  buffer_store_dwordx4 v[244:247], v4, s[88:91], s21 offen sc1
  buffer_store_dwordx4 v[244:247], v4, s[88:91], s21 offen offset:1024 sc1
  buffer_store_dwordx2 v[244:245], v21, s[88:91], s21 offen offset:2048 sc1
  s_add_u32 s21, s21, 81920
  buffer_store_dwordx4 v[244:247], v4, s[88:91], s21 offen sc1
  buffer_store_dwordx4 v[244:247], v4, s[88:91], s21 offen offset:1024 sc1
  buffer_store_dwordx2 v[244:245], v21, s[88:91], s21 offen offset:2048 sc1
  s_add_u32 s21, s21, 81920
  buffer_store_dwordx4 v[244:247], v4, s[88:91], s21 offen sc1
  buffer_store_dwordx4 v[244:247], v4, s[88:91], s21 offen offset:1024 sc1
  buffer_store_dwordx2 v[244:245], v21, s[88:91], s21 offen offset:2048 sc1
  s_add_u32 s21, s21, 81920
  buffer_store_dwordx4 v[244:247], v4, s[88:91], s21 offen sc1
  buffer_store_dwordx4 v[244:247], v4, s[88:91], s21 offen offset:1024 sc1
  buffer_store_dwordx2 v[244:245], v21, s[88:91], s21 offen offset:2048 sc1
  s_add_u32 s21, s21, 81920
  buffer_store_dwordx4 v[244:247], v4, s[88:91], s21 offen sc1
  buffer_store_dwordx4 v[244:247], v4, s[88:91], s21 offen offset:1024 sc1
  buffer_store_dwordx2 v[244:245], v21, s[88:91], s21 offen offset:2048 sc1
  s_add_u32 s21, s21, 81920
  buffer_store_dwordx4 v[244:247], v4, s[88:91], s21 offen sc1
  buffer_store_dwordx4 v[244:247], v4, s[88:91], s21 offen offset:1024 sc1
  buffer_store_dwordx2 v[244:245], v21, s[88:91], s21 offen offset:2048 sc1
  s_add_u32 s21, s21, 81920
  s_mul_i32 s21, s2, 3072
  s_add_u32 s21, s21, 5898240
  buffer_store_dwordx4 v[244:247], v4, s[84:87], s21 offen offset:0 sc1
  buffer_store_dwordx4 v[244:247], v4, s[84:87], s21 offen offset:1024 sc1
  buffer_store_dwordx4 v[244:247], v4, s[84:87], s21 offen offset:2048 sc1
  s_add_u32 s21, s21, 98304
  buffer_store_dwordx4 v[244:247], v4, s[84:87], s21 offen offset:0 sc1
  buffer_store_dwordx4 v[244:247], v4, s[84:87], s21 offen offset:1024 sc1
  buffer_store_dwordx4 v[244:247], v4, s[84:87], s21 offen offset:2048 sc1
  s_add_u32 s21, s21, 98304
  buffer_store_dwordx4 v[244:247], v4, s[84:87], s21 offen offset:0 sc1
  buffer_store_dwordx4 v[244:247], v4, s[84:87], s21 offen offset:1024 sc1
  buffer_store_dwordx4 v[244:247], v4, s[84:87], s21 offen offset:2048 sc1
  s_add_u32 s21, s21, 98304
  buffer_store_dwordx4 v[244:247], v4, s[84:87], s21 offen offset:0 sc1
  buffer_store_dwordx4 v[244:247], v4, s[84:87], s21 offen offset:1024 sc1
  buffer_store_dwordx4 v[244:247], v4, s[84:87], s21 offen offset:2048 sc1
  s_add_u32 s21, s21, 98304
arm_204:
  v_mov_b32 v16, 64
  s_waitcnt vmcnt(0)
  buffer_store_dword v16, v17, s[72:75], s44 offen sc1
  s_mov_b32 s84, 0
  s_mov_b32 s85, -1
  s_mov_b32 s86, 0
  s_branch queue
not_vw:
  s_sub_u32 s2, s3, 96
  s_cmp_lg_u32 s2, 31
  s_cbranch_scc1 not_cal
  s_load_dwordx2 s[72:73], s[0:1], 104
  s_waitcnt lgkmcnt(0)
  s_add_u32 s72, s72, 81068032
  s_addc_u32 s73, s73, 0
  s_mov_b32 s74, 115712
  s_mov_b32 s75, 0x00020000
  v_lshlrev_b32 v8, 4, v0
  v_mov_b32 v4, 0
  v_mov_b32 v5, 0
  v_mov_b32 v6, 0
  v_mov_b32 v7, 0
  s_mov_b32 s21, 0
  buffer_store_dwordx4 v[4:7], v8, s[72:75], s21 offen sc1
  s_mov_b32 s21, 4096
  buffer_store_dwordx4 v[4:7], v8, s[72:75], s21 offen sc1
  s_mov_b32 s21, 8192
  buffer_store_dwordx4 v[4:7], v8, s[72:75], s21 offen sc1
  s_mov_b32 s21, 12288
  buffer_store_dwordx4 v[4:7], v8, s[72:75], s21 offen sc1
  s_mov_b32 s21, 16384
  buffer_store_dwordx4 v[4:7], v8, s[72:75], s21 offen sc1
  s_mov_b32 s21, 20480
  buffer_store_dwordx4 v[4:7], v8, s[72:75], s21 offen sc1
  s_mov_b32 s21, 24576
  buffer_store_dwordx4 v[4:7], v8, s[72:75], s21 offen sc1
  s_mov_b32 s21, 28672
  buffer_store_dwordx4 v[4:7], v8, s[72:75], s21 offen sc1
  s_mov_b32 s21, 32768
  buffer_store_dwordx4 v[4:7], v8, s[72:75], s21 offen sc1
  s_mov_b32 s21, 36864
  buffer_store_dwordx4 v[4:7], v8, s[72:75], s21 offen sc1
  s_mov_b32 s21, 40960
  buffer_store_dwordx4 v[4:7], v8, s[72:75], s21 offen sc1
  s_mov_b32 s21, 45056
  buffer_store_dwordx4 v[4:7], v8, s[72:75], s21 offen sc1
  s_mov_b32 s21, 49152
  buffer_store_dwordx4 v[4:7], v8, s[72:75], s21 offen sc1
  s_mov_b32 s21, 53248
  buffer_store_dwordx4 v[4:7], v8, s[72:75], s21 offen sc1
  s_mov_b32 s21, 57344
  buffer_store_dwordx4 v[4:7], v8, s[72:75], s21 offen sc1
  s_mov_b32 s21, 61440
  buffer_store_dwordx4 v[4:7], v8, s[72:75], s21 offen sc1
  s_mov_b32 s21, 65536
  buffer_store_dwordx4 v[4:7], v8, s[72:75], s21 offen sc1
  s_mov_b32 s21, 69632
  buffer_store_dwordx4 v[4:7], v8, s[72:75], s21 offen sc1
  s_mov_b32 s21, 73728
  buffer_store_dwordx4 v[4:7], v8, s[72:75], s21 offen sc1
  s_mov_b32 s21, 77824
  buffer_store_dwordx4 v[4:7], v8, s[72:75], s21 offen sc1
  s_mov_b32 s21, 81920
  buffer_store_dwordx4 v[4:7], v8, s[72:75], s21 offen sc1
  s_mov_b32 s21, 86016
  buffer_store_dwordx4 v[4:7], v8, s[72:75], s21 offen sc1
  s_mov_b32 s21, 90112
  buffer_store_dwordx4 v[4:7], v8, s[72:75], s21 offen sc1
  s_mov_b32 s21, 94208
  buffer_store_dwordx4 v[4:7], v8, s[72:75], s21 offen sc1
  s_mov_b32 s21, 98304
  buffer_store_dwordx4 v[4:7], v8, s[72:75], s21 offen sc1
  s_mov_b32 s21, 102400
  buffer_store_dwordx4 v[4:7], v8, s[72:75], s21 offen sc1
  s_mov_b32 s21, 106496
  buffer_store_dwordx4 v[4:7], v8, s[72:75], s21 offen sc1
  s_mov_b32 s21, 110592
  buffer_store_dwordx4 v[4:7], v8, s[72:75], s21 offen sc1
  s_mov_b32 s21, 114688
  buffer_store_dwordx4 v[4:7], v8, s[72:75], s21 offen sc1
  s_waitcnt vmcnt(0)
  s_barrier
  s_cmp_lg_u32 s20, 0
  s_cbranch_scc1 cal_205
  s_mov_b64 exec, 1
  v_mov_b32 v4, 76
  v_mov_b32 v5, 1
  buffer_store_dword v5, v4, s[32:35], 0 offen sc1
  s_add_u32 s8, s38, 83886079
  s_addc_u32 s9, s39, 0
  s_and_b32 s8, s8, 0xffe00000
  s_mov_b32 s10, 2097152
  s_mov_b32 s11, 0x00020000
  v_mov_b32 v4, 0
  s_mov_b32 s40, -1
  s_mov_b32 s41, -1
  s_mov_b32 s42, 1048576
  s_mov_b32 s43, 0
  s_waitcnt vmcnt(0)
cal_206:
  s_add_u32 s21, s42, 0
  s_memtime s[98:99]
  s_waitcnt lgkmcnt(0)
  buffer_load_dword v5, v4, s[8:11], s21 offen sc1
  s_waitcnt vmcnt(0)
  s_memtime s[100:101]
  s_waitcnt lgkmcnt(0)
  s_sub_u32 s21, s100, s98
  s_min_u32 s40, s40, s21
  s_add_u32 s21, s42, 8192
  s_memtime s[98:99]
  s_waitcnt lgkmcnt(0)
  buffer_load_dword v5, v4, s[8:11], s21 offen sc1
  s_waitcnt vmcnt(0)
  s_memtime s[100:101]
  s_waitcnt lgkmcnt(0)
  s_sub_u32 s21, s100, s98
  s_min_u32 s41, s41, s21
  s_add_u32 s42, s42, 16640
  s_add_u32 s43, s43, 1
  s_cmp_lt_u32 s43, 8
  s_cbranch_scc1 cal_206
  s_cmp_lt_u32 s41, s40
  s_cselect_b32 s21, 1, 2
  v_mov_b32 v4, s21
  v_mov_b32 v5, s40
  v_mov_b32 v6, s41
  v_mov_b32 v8, 84
  buffer_store_dwordx3 v[4:6], v8, s[32:35], 0 offen sc1
  s_waitcnt vmcnt(0)
  s_mov_b64 exec, -1
cal_205:
not_cal:
  s_sleep 127
  s_sleep 127
  s_load_dwordx2 s[32:33], s[0:1], 96
  s_waitcnt lgkmcnt(0)
  s_mov_b32 s32, s32
  s_mov_b32 s33, s33
  s_mov_b32 s34, 256
  s_mov_b32 s35, 0x00020000
  s_mov_b32 s21, 76
  s_cmp_lg_u32 s20, 0
  s_cbranch_scc1 wf_208
  v_mov_b32 v4, 0
  s_mov_b32 s101, 0
wf_207:
  buffer_load_dword v5, v4, s[32:35], s21 offen sc1
  s_add_u32 s101, s101, 1
  s_cmp_gt_u32 s101, 131072
  s_cbranch_scc1 main_end
  s_waitcnt vmcnt(0)
  v_readfirstlane_b32 s100, v5
  s_cmp_ge_u32 s100, 1
  s_cbranch_scc1 wf_208
  s_sleep 8
  s_branch wf_207
wf_208:
  s_barrier
  s_load_dwordx2 s[72:73], s[0:1], 104
  s_waitcnt lgkmcnt(0)
  s_add_u32 s72, s72, 81068032
  s_addc_u32 s73, s73, 0
  s_mov_b32 s74, 115712
  s_mov_b32 s75, 0x00020000
  s_cmp_ge_u32 s2, 30
  s_cbranch_scc1 skip_qb
  s_mul_hi_u32 s42, s2, 0x1999999a
  s_mul_i32 s21, s42, 10
  s_sub_u32 s41, s2, s21
  s_sub_u32 s26, 17, s42
  s_mul_hi_u32 s26, s26, 0x55555556
  s_mov_b32 s63, 3
  s_mov_b32 s64, 0
qkvb_entry:
  s_load_dwordx2 s[4:5], s[0:1], 0
  s_load_dwordx2 s[6:7], s[0:1], 64
  s_load_dwordx2 s[38:39], s[0:1], 104
  s_waitcnt lgkmcnt(0)
  s_mov_b32 s8, s4
  s_mov_b32 s9, s5
  s_mov_b32 s10, 2621440
  s_mov_b32 s11, 0x00020000
  s_mov_b32 s12, s6
  s_mov_b32 s13, s7
  s_mov_b32 s14, 2457600
  s_mov_b32 s15, 0x00020000
  s_add_u32 s16, s38, 62914560
  s_addc_u32 s17, s39, 0
  s_mov_b32 s18, 7864320
  s_mov_b32 s19, 0x00020000
  s_mul_i32 s44, s41, 384
  v_mov_b32 v9, 2731
  v_add_u32 v8, 0, v1
  v_mul_u32_u24 v7, v8, v9
  v_lshrrev_b32 v7, 16, v7
  v_mul_u32_u24 v4, 24, v7
  v_sub_u32 v8, v8, v4
  s_mov_b32 s21, 3840
  v_mul_lo_u32 v7, v7, s21
  v_lshl_add_u32 v4, v8, 4, v7
  v_add_u32 v8, 64, v1
  v_mul_u32_u24 v7, v8, v9
  v_lshrrev_b32 v7, 16, v7
  v_mul_u32_u24 v5, 24, v7
  v_sub_u32 v8, v8, v5
  s_mov_b32 s21, 3840
  v_mul_lo_u32 v7, v7, s21
  v_lshl_add_u32 v5, v8, 4, v7
  v_add_u32 v8, 128, v1
  v_mul_u32_u24 v7, v8, v9
  v_lshrrev_b32 v7, 16, v7
  v_mul_u32_u24 v6, 24, v7
  v_sub_u32 v8, v8, v6
  s_mov_b32 s21, 3840
  v_mul_lo_u32 v7, v7, s21
  v_lshl_add_u32 v6, v8, 4, v7
  v_lshrrev_b32 v7, 2, v2
  v_lshl_add_u32 v7, v3, 3, v7
  v_mul_u32_u24 v7, 384, v7
  v_and_b32 v8, 3, v2
  v_lshlrev_b32 v8, 3, v8
  s_mul_i32 s21, s20, 96
  v_add3_u32 v7, v7, v8, s21
  v_add_u32 v8, 61440, v7
  s_mul_i32 s21, s20, 153600
  s_add_u32 s21, s21, 0
  s_add_u32 s21, s21, s44
  s_mul_i32 s22, s20, 15360
  s_add_u32 s22, s22, 0
  s_add_u32 m0, s22, 0
  s_nop 0
  buffer_load_dwordx4 v4, s[12:15], s21 offen lds
  s_add_u32 m0, s22, 1024
  s_nop 0
  buffer_load_dwordx4 v5, s[12:15], s21 offen lds
  s_add_u32 m0, s22, 2048
  s_nop 0
  buffer_load_dwordx4 v6, s[12:15], s21 offen lds
  s_mul_i32 s21, s20, 153600
  s_add_u32 s21, s21, 30720
  s_add_u32 s21, s21, s44
  s_mul_i32 s22, s20, 15360
  s_add_u32 s22, s22, 3072
  s_add_u32 m0, s22, 0
  s_nop 0
  buffer_load_dwordx4 v4, s[12:15], s21 offen lds
  s_add_u32 m0, s22, 1024
  s_nop 0
  buffer_load_dwordx4 v5, s[12:15], s21 offen lds
  s_add_u32 m0, s22, 2048
  s_nop 0
  buffer_load_dwordx4 v6, s[12:15], s21 offen lds
  s_mul_i32 s21, s20, 153600
  s_add_u32 s21, s21, 61440
  s_add_u32 s21, s21, s44
  s_mul_i32 s22, s20, 15360
  s_add_u32 s22, s22, 6144
  s_add_u32 m0, s22, 0
  s_nop 0
  buffer_load_dwordx4 v4, s[12:15], s21 offen lds
  s_add_u32 m0, s22, 1024
  s_nop 0
  buffer_load_dwordx4 v5, s[12:15], s21 offen lds
  s_add_u32 m0, s22, 2048
  s_nop 0
  buffer_load_dwordx4 v6, s[12:15], s21 offen lds
  s_mul_i32 s21, s20, 153600
  s_add_u32 s21, s21, 92160
  s_add_u32 s21, s21, s44
  s_mul_i32 s22, s20, 15360
  s_add_u32 s22, s22, 9216
  s_add_u32 m0, s22, 0
  s_nop 0
  buffer_load_dwordx4 v4, s[12:15], s21 offen lds
  s_add_u32 m0, s22, 1024
  s_nop 0
  buffer_load_dwordx4 v5, s[12:15], s21 offen lds
  s_add_u32 m0, s22, 2048
  s_nop 0
  buffer_load_dwordx4 v6, s[12:15], s21 offen lds
  s_mul_i32 s21, s20, 153600
  s_add_u32 s21, s21, 122880
  s_add_u32 s21, s21, s44
  s_mul_i32 s22, s20, 15360
  s_add_u32 s22, s22, 12288
  s_add_u32 m0, s22, 0
  s_nop 0
  buffer_load_dwordx4 v4, s[12:15], s21 offen lds
  s_add_u32 m0, s22, 1024
  s_nop 0
  buffer_load_dwordx4 v5, s[12:15], s21 offen lds
  s_add_u32 m0, s22, 2048
  s_nop 0
  buffer_load_dwordx4 v6, s[12:15], s21 offen lds
  s_mul_i32 s21, s20, 153600
  s_add_u32 s21, s21, 614400
  s_add_u32 s21, s21, s44
  s_mul_i32 s22, s20, 15360
  s_add_u32 s22, s22, 61440
  s_add_u32 m0, s22, 0
  s_nop 0
  buffer_load_dwordx4 v4, s[12:15], s21 offen lds
  s_add_u32 m0, s22, 1024
  s_nop 0
  buffer_load_dwordx4 v5, s[12:15], s21 offen lds
  s_add_u32 m0, s22, 2048
  s_nop 0
  buffer_load_dwordx4 v6, s[12:15], s21 offen lds
  s_mul_i32 s21, s20, 153600
  s_add_u32 s21, s21, 645120
  s_add_u32 s21, s21, s44
  s_mul_i32 s22, s20, 15360
  s_add_u32 s22, s22, 64512
  s_add_u32 m0, s22, 0
  s_nop 0
  buffer_load_dwordx4 v4, s[12:15], s21 offen lds
  s_add_u32 m0, s22, 1024
  s_nop 0
  buffer_load_dwordx4 v5, s[12:15], s21 offen lds
  s_add_u32 m0, s22, 2048
  s_nop 0
  buffer_load_dwordx4 v6, s[12:15], s21 offen lds
  s_mul_i32 s21, s20, 153600
  s_add_u32 s21, s21, 675840
  s_add_u32 s21, s21, s44
  s_mul_i32 s22, s20, 15360
  s_add_u32 s22, s22, 67584
  s_add_u32 m0, s22, 0
  s_nop 0
  buffer_load_dwordx4 v4, s[12:15], s21 offen lds
  s_add_u32 m0, s22, 1024
  s_nop 0
  buffer_load_dwordx4 v5, s[12:15], s21 offen lds
  s_add_u32 m0, s22, 2048
  s_nop 0
  buffer_load_dwordx4 v6, s[12:15], s21 offen lds
  s_mul_i32 s21, s20, 153600
  s_add_u32 s21, s21, 706560
  s_add_u32 s21, s21, s44
  s_mul_i32 s22, s20, 15360
  s_add_u32 s22, s22, 70656
  s_add_u32 m0, s22, 0
  s_nop 0
  buffer_load_dwordx4 v4, s[12:15], s21 offen lds
  s_add_u32 m0, s22, 1024
  s_nop 0
  buffer_load_dwordx4 v5, s[12:15], s21 offen lds
  s_add_u32 m0, s22, 2048
  s_nop 0
  buffer_load_dwordx4 v6, s[12:15], s21 offen lds
  s_mul_i32 s21, s20, 153600
  s_add_u32 s21, s21, 737280
  s_add_u32 s21, s21, s44
  s_mul_i32 s22, s20, 15360
  s_add_u32 s22, s22, 73728
  s_add_u32 m0, s22, 0
  s_nop 0
  buffer_load_dwordx4 v4, s[12:15], s21 offen lds
  s_add_u32 m0, s22, 1024
  s_nop 0
  buffer_load_dwordx4 v5, s[12:15], s21 offen lds
  s_add_u32 m0, s22, 2048
  s_nop 0
  buffer_load_dwordx4 v6, s[12:15], s21 offen lds
  s_mul_i32 s21, s20, 153600
  s_add_u32 s21, s21, 1228800
  s_add_u32 s21, s21, s44
  buffer_load_dwordx4 v[64:67], v4, s[12:15], s21 offen
  buffer_load_dwordx4 v[68:71], v5, s[12:15], s21 offen
  buffer_load_dwordx4 v[72:75], v6, s[12:15], s21 offen
  s_mul_i32 s21, s20, 153600
  s_add_u32 s21, s21, 1259520
  s_add_u32 s21, s21, s44
  buffer_load_dwordx4 v[76:79], v4, s[12:15], s21 offen
  buffer_load_dwordx4 v[80:83], v5, s[12:15], s21 offen
  buffer_load_dwordx4 v[84:87], v6, s[12:15], s21 offen
  s_mul_i32 s21, s20, 153600
  s_add_u32 s21, s21, 1290240
  s_add_u32 s21, s21, s44
  buffer_load_dwordx4 v[88:91], v4, s[12:15], s21 offen
  buffer_load_dwordx4 v[92:95], v5, s[12:15], s21 offen
  buffer_load_dwordx4 v[96:99], v6, s[12:15], s21 offen
  s_mul_i32 s21, s20, 153600
  s_add_u32 s21, s21, 1320960
  s_add_u32 s21, s21, s44
  buffer_load_dwordx4 v[100:103], v4, s[12:15], s21 offen
  buffer_load_dwordx4 v[104:107], v5, s[12:15], s21 offen
  buffer_load_dwordx4 v[108:111], v6, s[12:15], s21 offen
  s_mul_i32 s21, s20, 153600
  s_add_u32 s21, s21, 1351680
  s_add_u32 s21, s21, s44
  buffer_load_dwordx4 v[112:115], v4, s[12:15], s21 offen
  buffer_load_dwordx4 v[116:119], v5, s[12:15], s21 offen
  buffer_load_dwordx4 v[120:123], v6, s[12:15], s21 offen
  s_mul_i32 s21, s20, 153600
  s_add_u32 s21, s21, 1843200
  s_add_u32 s21, s21, s44
  buffer_load_dwordx4 v[124:127], v4, s[12:15], s21 offen
  buffer_load_dwordx4 v[128:131], v5, s[12:15], s21 offen
  buffer_load_dwordx4 v[132:135], v6, s[12:15], s21 offen
  s_mul_i32 s21, s20, 153600
  s_add_u32 s21, s21, 1873920
  s_add_u32 s21, s21, s44
  buffer_load_dwordx4 v[136:139], v4, s[12:15], s21 offen
  buffer_load_dwordx4 v[140:143], v5, s[12:15], s21 offen
  buffer_load_dwordx4 v[144:147], v6, s[12:15], s21 offen
  s_mul_i32 s21, s20, 153600
  s_add_u32 s21, s21, 1904640
  s_add_u32 s21, s21, s44
  buffer_load_dwordx4 v[148:151], v4, s[12:15], s21 offen
  buffer_load_dwordx4 v[152:155], v5, s[12:15], s21 offen
  buffer_load_dwordx4 v[156:159], v6, s[12:15], s21 offen
  s_mul_i32 s21, s20, 153600
  s_add_u32 s21, s21, 1935360
  s_add_u32 s21, s21, s44
  buffer_load_dwordx4 v[160:163], v4, s[12:15], s21 offen
  buffer_load_dwordx4 v[164:167], v5, s[12:15], s21 offen
  buffer_load_dwordx4 v[168:171], v6, s[12:15], s21 offen
  s_mul_i32 s21, s20, 153600
  s_add_u32 s21, s21, 1966080
  s_add_u32 s21, s21, s44
  buffer_load_dwordx4 v[172:175], v4, s[12:15], s21 offen
  buffer_load_dwordx4 v[176:179], v5, s[12:15], s21 offen
  buffer_load_dwordx4 v[180:183], v6, s[12:15], s21 offen
  s_mul_i32 s22, s20, 15360
  v_lshl_add_u32 v30, v1, 4, s22
  v_add_u32 v31, 61440, v30
  s_waitcnt vmcnt(45)
  s_barrier
  ds_read_b64_tr_b16 a[0:1], v7 offset:0
  ds_read_b64_tr_b16 a[2:3], v7 offset:1536
  ds_read_b64_tr_b16 a[4:5], v7 offset:32
  ds_read_b64_tr_b16 a[6:7], v7 offset:1568
  ds_read_b64_tr_b16 a[8:9], v7 offset:64
  ds_read_b64_tr_b16 a[10:11], v7 offset:1600
  ds_read_b64_tr_b16 a[12:13], v7 offset:12288
  ds_read_b64_tr_b16 a[14:15], v7 offset:13824
  ds_read_b64_tr_b16 a[16:17], v7 offset:12320
  ds_read_b64_tr_b16 a[18:19], v7 offset:13856
  ds_read_b64_tr_b16 a[20:21], v7 offset:12352
  ds_read_b64_tr_b16 a[22:23], v7 offset:13888
  ds_read_b64_tr_b16 a[24:25], v7 offset:24576
  ds_read_b64_tr_b16 a[26:27], v7 offset:26112
  ds_read_b64_tr_b16 a[28:29], v7 offset:24608
  ds_read_b64_tr_b16 a[30:31], v7 offset:26144
  ds_read_b64_tr_b16 a[32:33], v7 offset:24640
  ds_read_b64_tr_b16 a[34:35], v7 offset:26176
  ds_read_b64_tr_b16 a[36:37], v7 offset:36864
  ds_read_b64_tr_b16 a[38:39], v7 offset:38400
  ds_read_b64_tr_b16 a[40:41], v7 offset:36896
  ds_read_b64_tr_b16 a[42:43], v7 offset:38432
  ds_read_b64_tr_b16 a[44:45], v7 offset:36928
  ds_read_b64_tr_b16 a[46:47], v7 offset:38464
  ds_read_b64_tr_b16 a[48:49], v7 offset:49152
  ds_read_b64_tr_b16 a[50:51], v7 offset:50688
  ds_read_b64_tr_b16 a[52:53], v7 offset:49184
  ds_read_b64_tr_b16 a[54:55], v7 offset:50720
  ds_read_b64_tr_b16 a[56:57], v7 offset:49216
  ds_read_b64_tr_b16 a[58:59], v7 offset:50752
  s_waitcnt lgkmcnt(0)
  s_barrier
  s_waitcnt vmcnt(30)
  s_barrier
  ds_read_b64_tr_b16 a[60:61], v8 offset:0
  ds_read_b64_tr_b16 a[62:63], v8 offset:1536
  ds_read_b64_tr_b16 a[64:65], v8 offset:32
  ds_read_b64_tr_b16 a[66:67], v8 offset:1568
  ds_read_b64_tr_b16 a[68:69], v8 offset:64
  ds_read_b64_tr_b16 a[70:71], v8 offset:1600
  ds_read_b64_tr_b16 a[72:73], v8 offset:12288
  ds_read_b64_tr_b16 a[74:75], v8 offset:13824
  ds_read_b64_tr_b16 a[76:77], v8 offset:12320
  ds_read_b64_tr_b16 a[78:79], v8 offset:13856
  ds_read_b64_tr_b16 a[80:81], v8 offset:12352
  ds_read_b64_tr_b16 a[82:83], v8 offset:13888
  ds_read_b64_tr_b16 a[84:85], v8 offset:24576
  ds_read_b64_tr_b16 a[86:87], v8 offset:26112
  ds_read_b64_tr_b16 a[88:89], v8 offset:24608
  ds_read_b64_tr_b16 a[90:91], v8 offset:26144
  ds_read_b64_tr_b16 a[92:93], v8 offset:24640
  ds_read_b64_tr_b16 a[94:95], v8 offset:26176
  ds_read_b64_tr_b16 a[96:97], v8 offset:36864
  ds_read_b64_tr_b16 a[98:99], v8 offset:38400
  ds_read_b64_tr_b16 a[100:101], v8 offset:36896
  ds_read_b64_tr_b16 a[102:103], v8 offset:38432
  ds_read_b64_tr_b16 a[104:105], v8 offset:36928
  ds_read_b64_tr_b16 a[106:107], v8 offset:38464
  ds_read_b64_tr_b16 a[108:109], v8 offset:49152
  ds_read_b64_tr_b16 a[110:111], v8 offset:50688
  ds_read_b64_tr_b16 a[112:113], v8 offset:49184
  ds_read_b64_tr_b16 a[114:115], v8 offset:50720
  ds_read_b64_tr_b16 a[116:117], v8 offset:49216
  ds_read_b64_tr_b16 a[118:119], v8 offset:50752
  s_waitcnt lgkmcnt(0)
  s_barrier
  s_waitcnt vmcnt(15)
  ds_write_b128 v30, v[64:67] offset:0
  ds_write_b128 v30, v[68:71] offset:1024
  ds_write_b128 v30, v[72:75] offset:2048
  ds_write_b128 v30, v[76:79] offset:3072
  ds_write_b128 v30, v[80:83] offset:4096
  ds_write_b128 v30, v[84:87] offset:5120
  ds_write_b128 v30, v[88:91] offset:6144
  ds_write_b128 v30, v[92:95] offset:7168
  ds_write_b128 v30, v[96:99] offset:8192
  ds_write_b128 v30, v[100:103] offset:9216
  ds_write_b128 v30, v[104:107] offset:10240
  ds_write_b128 v30, v[108:111] offset:11264
  ds_write_b128 v30, v[112:115] offset:12288
  ds_write_b128 v30, v[116:119] offset:13312
  ds_write_b128 v30, v[120:123] offset:14336
  s_waitcnt lgkmcnt(0)
  s_barrier
  ds_read_b64_tr_b16 a[120:121], v7 offset:0
  ds_read_b64_tr_b16 a[122:123], v7 offset:1536
  ds_read_b64_tr_b16 a[124:125], v7 offset:32
  ds_read_b64_tr_b16 a[126:127], v7 offset:1568
  ds_read_b64_tr_b16 a[128:129], v7 offset:64
  ds_read_b64_tr_b16 a[130:131], v7 offset:1600
  ds_read_b64_tr_b16 a[132:133], v7 offset:12288
  ds_read_b64_tr_b16 a[134:135], v7 offset:13824
  ds_read_b64_tr_b16 a[136:137], v7 offset:12320
  ds_read_b64_tr_b16 a[138:139], v7 offset:13856
  ds_read_b64_tr_b16 a[140:141], v7 offset:12352
  ds_read_b64_tr_b16 a[142:143], v7 offset:13888
  ds_read_b64_tr_b16 a[144:145], v7 offset:24576
  ds_read_b64_tr_b16 a[146:147], v7 offset:26112
  ds_read_b64_tr_b16 a[148:149], v7 offset:24608
  ds_read_b64_tr_b16 a[150:151], v7 offset:26144
  ds_read_b64_tr_b16 a[152:153], v7 offset:24640
  ds_read_b64_tr_b16 a[154:155], v7 offset:26176
  ds_read_b64_tr_b16 a[156:157], v7 offset:36864
  ds_read_b64_tr_b16 a[158:159], v7 offset:38400
  ds_read_b64_tr_b16 a[160:161], v7 offset:36896
  ds_read_b64_tr_b16 a[162:163], v7 offset:38432
  ds_read_b64_tr_b16 a[164:165], v7 offset:36928
  ds_read_b64_tr_b16 a[166:167], v7 offset:38464
  ds_read_b64_tr_b16 a[168:169], v7 offset:49152
  ds_read_b64_tr_b16 a[170:171], v7 offset:50688
  ds_read_b64_tr_b16 a[172:173], v7 offset:49184
  ds_read_b64_tr_b16 a[174:175], v7 offset:50720
  ds_read_b64_tr_b16 a[176:177], v7 offset:49216
  ds_read_b64_tr_b16 a[178:179], v7 offset:50752
  s_waitcnt lgkmcnt(0)
  s_barrier
  s_waitcnt vmcnt(0)
  ds_write_b128 v31, v[124:127] offset:0
  ds_write_b128 v31, v[128:131] offset:1024
  ds_write_b128 v31, v[132:135] offset:2048
  ds_write_b128 v31, v[136:139] offset:3072
  ds_write_b128 v31, v[140:143] offset:4096
  ds_write_b128 v31, v[144:147] offset:5120
  ds_write_b128 v31, v[148:151] offset:6144
  ds_write_b128 v31, v[152:155] offset:7168
  ds_write_b128 v31, v[156:159] offset:8192
  ds_write_b128 v31, v[160:163] offset:9216
  ds_write_b128 v31, v[164:167] offset:10240
  ds_write_b128 v31, v[168:171] offset:11264
  ds_write_b128 v31, v[172:175] offset:12288
  ds_write_b128 v31, v[176:179] offset:13312
  ds_write_b128 v31, v[180:183] offset:14336
  s_waitcnt lgkmcnt(0)
  s_barrier
  ds_read_b64_tr_b16 a[180:181], v8 offset:0
  ds_read_b64_tr_b16 a[182:183], v8 offset:1536
  ds_read_b64_tr_b16 a[184:185], v8 offset:32
  ds_read_b64_tr_b16 a[186:187], v8 offset:1568
  ds_read_b64_tr_b16 a[188:189], v8 offset:64
  ds_read_b64_tr_b16 a[190:191], v8 offset:1600
  ds_read_b64_tr_b16 a[192:193], v8 offset:12288
  ds_read_b64_tr_b16 a[194:195], v8 offset:13824
  ds_read_b64_tr_b16 a[196:197], v8 offset:12320
  ds_read_b64_tr_b16 a[198:199], v8 offset:13856
  ds_read_b64_tr_b16 a[200:201], v8 offset:12352
  ds_read_b64_tr_b16 a[202:203], v8 offset:13888
  ds_read_b64_tr_b16 a[204:205], v8 offset:24576
  ds_read_b64_tr_b16 a[206:207], v8 offset:26112
  ds_read_b64_tr_b16 a[208:209], v8 offset:24608
  ds_read_b64_tr_b16 a[210:211], v8 offset:26144
  ds_read_b64_tr_b16 a[212:213], v8 offset:24640
  ds_read_b64_tr_b16 a[214:215], v8 offset:26176
  ds_read_b64_tr_b16 a[216:217], v8 offset:36864
  ds_read_b64_tr_b16 a[218:219], v8 offset:38400
  ds_read_b64_tr_b16 a[220:221], v8 offset:36896
  ds_read_b64_tr_b16 a[222:223], v8 offset:38432
  ds_read_b64_tr_b16 a[224:225], v8 offset:36928
  ds_read_b64_tr_b16 a[226:227], v8 offset:38464
  ds_read_b64_tr_b16 a[228:229], v8 offset:49152
  ds_read_b64_tr_b16 a[230:231], v8 offset:50688
  ds_read_b64_tr_b16 a[232:233], v8 offset:49184
  ds_read_b64_tr_b16 a[234:235], v8 offset:50720
  ds_read_b64_tr_b16 a[236:237], v8 offset:49216
  ds_read_b64_tr_b16 a[238:239], v8 offset:50752
  s_waitcnt lgkmcnt(0)
  s_barrier
  s_mul_i32 s24, s42, 163840
  s_mul_i32 s25, s63, 163840
  s_mul_i32 s27, s42, 491520
  s_add_u32 s27, s27, s44
  s_mul_i32 s28, s63, 491520
  s_lshl_b32 s63, s63, 7
  s_load_dwordx2 s[72:73], s[0:1], 104
  s_waitcnt lgkmcnt(0)
  s_add_u32 s72, s72, 81068032
  s_addc_u32 s73, s73, 0
  s_mov_b32 s74, 115712
  s_mov_b32 s75, 0x00020000
  s_lshl_b32 s60, s42, 7
  s_add_u32 s60, s60, 88064
  s_mov_b32 s61, 0
  v_lshrrev_b32 v11, 3, v1
  v_and_b32 v12, 7, v1
  v_xor_b32 v12, v12, v11
  v_mul_u32_u24 v11, 1280, v11
  v_lshl_add_u32 v10, v12, 4, v11
  s_mov_b32 s30, s24
  s_mov_b32 s31, 0
  s_mov_b32 s32, 0
  s_mul_i32 s46, s20, 40960
  s_add_u32 s46, s46, s30
  s_lshl_b32 s47, s20, 12
  s_add_u32 s47, s47, s32
  s_add_u32 m0, s47, 0
  s_nop 0
  buffer_load_dwordx4 v10, s[8:11], s46 offen lds
  s_add_u32 s46, s46, 10240
  s_add_u32 m0, s47, 1024
  s_nop 0
  buffer_load_dwordx4 v10, s[8:11], s46 offen lds
  s_add_u32 s46, s46, 10240
  s_add_u32 m0, s47, 2048
  s_nop 0
  buffer_load_dwordx4 v10, s[8:11], s46 offen lds
  s_add_u32 s46, s46, 10240
  s_add_u32 m0, s47, 3072
  s_nop 0
  buffer_load_dwordx4 v10, s[8:11], s46 offen lds
  s_add_u32 s30, s30, 128
  s_add_u32 s31, s31, 1
  s_cmp_lt_u32 s31, 10
  s_cbranch_scc1 qb_209
  s_mov_b32 s31, 0
  s_add_u32 s30, s30, s25
  s_sub_u32 s30, s30, 1280
qb_209:
  s_add_u32 s32, s32, 16384
  s_cmp_lt_u32 s32, 98304
  s_cselect_b32 s32, s32, 0
  s_mul_i32 s46, s20, 40960
  s_add_u32 s46, s46, s30
  s_lshl_b32 s47, s20, 12
  s_add_u32 s47, s47, s32
  s_add_u32 m0, s47, 0
  s_nop 0
  buffer_load_dwordx4 v10, s[8:11], s46 offen lds
  s_add_u32 s46, s46, 10240
  s_add_u32 m0, s47, 1024
  s_nop 0
  buffer_load_dwordx4 v10, s[8:11], s46 offen lds
  s_add_u32 s46, s46, 10240
  s_add_u32 m0, s47, 2048
  s_nop 0
  buffer_load_dwordx4 v10, s[8:11], s46 offen lds
  s_add_u32 s46, s46, 10240
  s_add_u32 m0, s47, 3072
  s_nop 0
  buffer_load_dwordx4 v10, s[8:11], s46 offen lds
  s_add_u32 s30, s30, 128
  s_add_u32 s31, s31, 1
  s_cmp_lt_u32 s31, 10
  s_cbranch_scc1 qb_210
  s_mov_b32 s31, 0
  s_add_u32 s30, s30, s25
  s_sub_u32 s30, s30, 1280
qb_210:
  s_add_u32 s32, s32, 16384
  s_cmp_lt_u32 s32, 98304
  s_cselect_b32 s32, s32, 0
  s_mul_i32 s46, s20, 40960
  s_add_u32 s46, s46, s30
  s_lshl_b32 s47, s20, 12
  s_add_u32 s47, s47, s32
  s_add_u32 m0, s47, 0
  s_nop 0
  buffer_load_dwordx4 v10, s[8:11], s46 offen lds
  s_add_u32 s46, s46, 10240
  s_add_u32 m0, s47, 1024
  s_nop 0
  buffer_load_dwordx4 v10, s[8:11], s46 offen lds
  s_add_u32 s46, s46, 10240
  s_add_u32 m0, s47, 2048
  s_nop 0
  buffer_load_dwordx4 v10, s[8:11], s46 offen lds
  s_add_u32 s46, s46, 10240
  s_add_u32 m0, s47, 3072
  s_nop 0
  buffer_load_dwordx4 v10, s[8:11], s46 offen lds
  s_add_u32 s30, s30, 128
  s_add_u32 s31, s31, 1
  s_cmp_lt_u32 s31, 10
  s_cbranch_scc1 qb_211
  s_mov_b32 s31, 0
  s_add_u32 s30, s30, s25
  s_sub_u32 s30, s30, 1280
qb_211:
  s_add_u32 s32, s32, 16384
  s_cmp_lt_u32 s32, 98304
  s_cselect_b32 s32, s32, 0
  s_mul_i32 s46, s20, 40960
  s_add_u32 s46, s46, s30
  s_lshl_b32 s47, s20, 12
  s_add_u32 s47, s47, s32
  s_add_u32 m0, s47, 0
  s_nop 0
  buffer_load_dwordx4 v10, s[8:11], s46 offen lds
  s_add_u32 s46, s46, 10240
  s_add_u32 m0, s47, 1024
  s_nop 0
  buffer_load_dwordx4 v10, s[8:11], s46 offen lds
  s_add_u32 s46, s46, 10240
  s_add_u32 m0, s47, 2048
  s_nop 0
  buffer_load_dwordx4 v10, s[8:11], s46 offen lds
  s_add_u32 s46, s46, 10240
  s_add_u32 m0, s47, 3072
  s_nop 0
  buffer_load_dwordx4 v10, s[8:11], s46 offen lds
  s_add_u32 s30, s30, 128
  s_add_u32 s31, s31, 1
  s_cmp_lt_u32 s31, 10
  s_cbranch_scc1 qb_212
  s_mov_b32 s31, 0
  s_add_u32 s30, s30, s25
  s_sub_u32 s30, s30, 1280
qb_212:
  s_add_u32 s32, s32, 16384
  s_cmp_lt_u32 s32, 98304
  s_cselect_b32 s32, s32, 0
  v_and_b32 v6, 7, v2
  v_add_u32 v4, 0, v3
  v_xor_b32 v4, v4, v6
  v_lshlrev_b32 v4, 4, v4
  v_lshl_add_u32 v14, v2, 7, v4
  v_add_u32 v4, 4, v3
  v_xor_b32 v4, v4, v6
  v_lshlrev_b32 v4, 4, v4
  v_lshl_add_u32 v15, v2, 7, v4
  v_mul_u32_u24 v22, 400, v2
  v_mul_u32_u24 v4, 8, v3
  s_mul_i32 s21, s20, 96
  s_add_u32 s21, s21, 98304
  v_add3_u32 v22, v22, v4, s21
  v_mov_b32 v9, 2731
  v_add_u32 v8, 0, v1
  v_mul_u32_u24 v7, v8, v9
  v_lshrrev_b32 v7, 16, v7
  v_mul_u32_u24 v4, 24, v7
  v_sub_u32 v8, v8, v4
  v_lshlrev_b32 v8, 4, v8
  s_mov_b32 s21, 3840
  v_mul_lo_u32 v4, v7, s21
  v_add_u32 v26, v4, v8
  v_mul_u32_u24 v4, 400, v7
  s_mul_i32 s21, s20, 12800
  s_add_u32 s21, s21, 98304
  v_add3_u32 v23, v4, v8, s21
  v_add_u32 v8, 64, v1
  v_mul_u32_u24 v7, v8, v9
  v_lshrrev_b32 v7, 16, v7
  v_mul_u32_u24 v4, 24, v7
  v_sub_u32 v8, v8, v4
  v_lshlrev_b32 v8, 4, v8
  s_mov_b32 s21, 3840
  v_mul_lo_u32 v4, v7, s21
  v_add_u32 v27, v4, v8
  v_mul_u32_u24 v4, 400, v7
  s_mul_i32 s21, s20, 12800
  s_add_u32 s21, s21, 98304
  v_add3_u32 v24, v4, v8, s21
  v_add_u32 v8, 128, v1
  v_mul_u32_u24 v7, v8, v9
  v_lshrrev_b32 v7, 16, v7
  v_mul_u32_u24 v4, 24, v7
  v_sub_u32 v8, v8, v4
  v_lshlrev_b32 v8, 4, v8
  s_mov_b32 s21, 3840
  v_mul_lo_u32 v4, v7, s21
  v_add_u32 v28, v4, v8
  v_mul_u32_u24 v4, 400, v7
  s_mul_i32 s21, s20, 12800
  s_add_u32 s21, s21, 98304
  v_add3_u32 v25, v4, v8, s21
  s_mov_b32 s33, 0
  s_mov_b32 s48, 0x80000000
  s_mul_i32 s46, s20, 40960
  s_add_u32 s46, s46, s30
  s_lshl_b32 s47, s20, 12
  s_add_u32 s47, s47, s32
  s_add_u32 m0, s47, 0
  s_nop 0
  buffer_load_dwordx4 v10, s[8:11], s46 offen lds
  s_add_u32 s46, s46, 10240
  s_add_u32 m0, s47, 1024
  s_nop 0
  buffer_load_dwordx4 v10, s[8:11], s46 offen lds
  s_waitcnt vmcnt(14)
  s_barrier
  v_add_u32 v18, s33, v14
  v_add_u32 v19, s33, v15
  s_add_u32 s33, s33, 16384
  s_cmp_lt_u32 s33, 98304
  s_cselect_b32 s33, s33, 0
  ds_read_b128 v[160:163], v18 offset:0
  ds_read_b128 v[164:167], v18 offset:2048
  ds_read_b128 v[168:171], v18 offset:4096
  ds_read_b128 v[172:175], v18 offset:6144
  ds_read_b128 v[176:179], v18 offset:8192
  ds_read_b128 v[180:183], v18 offset:10240
  ds_read_b128 v[184:187], v18 offset:12288
  ds_read_b128 v[188:191], v18 offset:14336
qb_blk_213:
  ds_read_b128 v[192:195], v19 offset:0
  s_waitcnt lgkmcnt(8)
  v_mfma_f32_16x16x32_bf16 v[64:67], a[0:3], v[160:163], 0
  v_mfma_f32_16x16x32_bf16 v[68:71], a[4:7], v[160:163], 0
  v_mfma_f32_16x16x32_bf16 v[72:75], a[8:11], v[160:163], 0
  ds_read_b128 v[196:199], v19 offset:2048
  s_waitcnt lgkmcnt(8)
  v_mfma_f32_16x16x32_bf16 v[76:79], a[0:3], v[164:167], 0
  v_mfma_f32_16x16x32_bf16 v[80:83], a[4:7], v[164:167], 0
  v_mfma_f32_16x16x32_bf16 v[84:87], a[8:11], v[164:167], 0
  s_add_u32 s46, s46, 10240
  s_add_u32 m0, s47, 2048
  s_nop 0
  buffer_load_dwordx4 v10, s[8:11], s46 offen lds
  ds_read_b128 v[200:203], v19 offset:4096
  s_waitcnt lgkmcnt(8)
  v_mfma_f32_16x16x32_bf16 v[88:91], a[0:3], v[168:171], 0
  v_mfma_f32_16x16x32_bf16 v[92:95], a[4:7], v[168:171], 0
  v_mfma_f32_16x16x32_bf16 v[96:99], a[8:11], v[168:171], 0
  ds_read_b128 v[204:207], v19 offset:6144
  s_waitcnt lgkmcnt(8)
  v_mfma_f32_16x16x32_bf16 v[100:103], a[0:3], v[172:175], 0
  v_mfma_f32_16x16x32_bf16 v[104:107], a[4:7], v[172:175], 0
  v_mfma_f32_16x16x32_bf16 v[108:111], a[8:11], v[172:175], 0
  ds_read_b128 v[208:211], v19 offset:8192
  s_waitcnt lgkmcnt(8)
  v_mfma_f32_16x16x32_bf16 v[112:115], a[0:3], v[176:179], 0
  v_mfma_f32_16x16x32_bf16 v[116:119], a[4:7], v[176:179], 0
  v_mfma_f32_16x16x32_bf16 v[120:123], a[8:11], v[176:179], 0
  ds_read_b128 v[212:215], v19 offset:10240
  s_waitcnt lgkmcnt(8)
  v_mfma_f32_16x16x32_bf16 v[124:127], a[0:3], v[180:183], 0
  v_mfma_f32_16x16x32_bf16 v[128:131], a[4:7], v[180:183], 0
  v_mfma_f32_16x16x32_bf16 v[132:135], a[8:11], v[180:183], 0
  s_add_u32 s46, s46, 10240
  s_add_u32 m0, s47, 3072
  s_nop 0
  buffer_load_dwordx4 v10, s[8:11], s46 offen lds
  ds_read_b128 v[216:219], v19 offset:12288
  s_waitcnt lgkmcnt(8)
  v_mfma_f32_16x16x32_bf16 v[136:139], a[0:3], v[184:187], 0
  v_mfma_f32_16x16x32_bf16 v[140:143], a[4:7], v[184:187], 0
  v_mfma_f32_16x16x32_bf16 v[144:147], a[8:11], v[184:187], 0
  ds_read_b128 v[220:223], v19 offset:14336
  s_waitcnt lgkmcnt(8)
  v_mfma_f32_16x16x32_bf16 v[148:151], a[0:3], v[188:191], 0
  v_mfma_f32_16x16x32_bf16 v[152:155], a[4:7], v[188:191], 0
  v_mfma_f32_16x16x32_bf16 v[156:159], a[8:11], v[188:191], 0
  s_waitcnt vmcnt(12)
  s_barrier
  s_add_u32 s30, s30, 128
  s_add_u32 s31, s31, 1
  s_cmp_lt_u32 s31, 10
  s_cbranch_scc1 qb_214
  s_mov_b32 s31, 0
  s_add_u32 s30, s30, s25
  s_sub_u32 s30, s30, 1280
qb_214:
  s_add_u32 s32, s32, 16384
  s_cmp_lt_u32 s32, 98304
  s_cselect_b32 s32, s32, 0
  s_mul_i32 s46, s20, 40960
  s_add_u32 s46, s46, s30
  s_lshl_b32 s47, s20, 12
  s_add_u32 s47, s47, s32
  v_add_u32 v18, s33, v14
  v_add_u32 v19, s33, v15
  s_add_u32 s33, s33, 16384
  s_cmp_lt_u32 s33, 98304
  s_cselect_b32 s33, s33, 0
  ds_read_b128 v[160:163], v18 offset:0
  s_waitcnt lgkmcnt(8)
  v_mfma_f32_16x16x32_bf16 v[64:67], a[12:15], v[192:195], v[64:67]
  v_mfma_f32_16x16x32_bf16 v[68:71], a[16:19], v[192:195], v[68:71]
  v_mfma_f32_16x16x32_bf16 v[72:75], a[20:23], v[192:195], v[72:75]
  ds_read_b128 v[224:227], v23 offset:0
  ds_read_b128 v[164:167], v18 offset:2048
  s_waitcnt lgkmcnt(8)
  v_mfma_f32_16x16x32_bf16 v[76:79], a[12:15], v[196:199], v[76:79]
  v_mfma_f32_16x16x32_bf16 v[80:83], a[16:19], v[196:199], v[80:83]
  v_mfma_f32_16x16x32_bf16 v[84:87], a[20:23], v[196:199], v[84:87]
  s_add_u32 m0, s47, 0
  s_nop 0
  buffer_load_dwordx4 v10, s[8:11], s46 offen lds
  ds_read_b128 v[168:171], v18 offset:4096
  s_waitcnt lgkmcnt(8)
  v_mfma_f32_16x16x32_bf16 v[88:91], a[12:15], v[200:203], v[88:91]
  v_mfma_f32_16x16x32_bf16 v[92:95], a[16:19], v[200:203], v[92:95]
  v_mfma_f32_16x16x32_bf16 v[96:99], a[20:23], v[200:203], v[96:99]
  ds_read_b128 v[172:175], v18 offset:6144
  s_waitcnt lgkmcnt(8)
  v_mfma_f32_16x16x32_bf16 v[100:103], a[12:15], v[204:207], v[100:103]
  v_mfma_f32_16x16x32_bf16 v[104:107], a[16:19], v[204:207], v[104:107]
  v_mfma_f32_16x16x32_bf16 v[108:111], a[20:23], v[204:207], v[108:111]
  ds_read_b128 v[176:179], v18 offset:8192
  s_waitcnt lgkmcnt(8)
  v_mfma_f32_16x16x32_bf16 v[112:115], a[12:15], v[208:211], v[112:115]
  v_mfma_f32_16x16x32_bf16 v[116:119], a[16:19], v[208:211], v[116:119]
  v_mfma_f32_16x16x32_bf16 v[120:123], a[20:23], v[208:211], v[120:123]
  ds_read_b128 v[228:231], v24 offset:0
  ds_read_b128 v[180:183], v18 offset:10240
  s_waitcnt lgkmcnt(8)
  v_mfma_f32_16x16x32_bf16 v[124:127], a[12:15], v[212:215], v[124:127]
  v_mfma_f32_16x16x32_bf16 v[128:131], a[16:19], v[212:215], v[128:131]
  v_mfma_f32_16x16x32_bf16 v[132:135], a[20:23], v[212:215], v[132:135]
  s_add_u32 s46, s46, 10240
  s_add_u32 m0, s47, 1024
  s_nop 0
  buffer_load_dwordx4 v10, s[8:11], s46 offen lds
  ds_read_b128 v[184:187], v18 offset:12288
  s_waitcnt lgkmcnt(8)
  v_mfma_f32_16x16x32_bf16 v[136:139], a[12:15], v[216:219], v[136:139]
  v_mfma_f32_16x16x32_bf16 v[140:143], a[16:19], v[216:219], v[140:143]
  v_mfma_f32_16x16x32_bf16 v[144:147], a[20:23], v[216:219], v[144:147]
  ds_read_b128 v[188:191], v18 offset:14336
  s_waitcnt lgkmcnt(8)
  v_mfma_f32_16x16x32_bf16 v[148:151], a[12:15], v[220:223], v[148:151]
  v_mfma_f32_16x16x32_bf16 v[152:155], a[16:19], v[220:223], v[152:155]
  v_mfma_f32_16x16x32_bf16 v[156:159], a[20:23], v[220:223], v[156:159]
  ds_read_b128 v[192:195], v19 offset:0
  s_waitcnt lgkmcnt(8)
  v_mfma_f32_16x16x32_bf16 v[64:67], a[24:27], v[160:163], v[64:67]
  v_mfma_f32_16x16x32_bf16 v[68:71], a[28:31], v[160:163], v[68:71]
  v_mfma_f32_16x16x32_bf16 v[72:75], a[32:35], v[160:163], v[72:75]
  ds_read_b128 v[232:235], v25 offset:0
  ds_read_b128 v[196:199], v19 offset:2048
  s_waitcnt lgkmcnt(8)
  v_mfma_f32_16x16x32_bf16 v[76:79], a[24:27], v[164:167], v[76:79]
  v_mfma_f32_16x16x32_bf16 v[80:83], a[28:31], v[164:167], v[80:83]
  v_mfma_f32_16x16x32_bf16 v[84:87], a[32:35], v[164:167], v[84:87]
  s_add_u32 s46, s46, 10240
  s_add_u32 m0, s47, 2048
  s_nop 0
  buffer_load_dwordx4 v10, s[8:11], s46 offen lds
  ds_read_b128 v[200:203], v19 offset:4096
  s_waitcnt lgkmcnt(8)
  v_mfma_f32_16x16x32_bf16 v[88:91], a[24:27], v[168:171], v[88:91]
  v_mfma_f32_16x16x32_bf16 v[92:95], a[28:31], v[168:171], v[92:95]
  v_mfma_f32_16x16x32_bf16 v[96:99], a[32:35], v[168:171], v[96:99]
  ds_read_b128 v[204:207], v19 offset:6144
  s_waitcnt lgkmcnt(8)
  v_mfma_f32_16x16x32_bf16 v[100:103], a[24:27], v[172:175], v[100:103]
  v_mfma_f32_16x16x32_bf16 v[104:107], a[28:31], v[172:175], v[104:107]
  v_mfma_f32_16x16x32_bf16 v[108:111], a[32:35], v[172:175], v[108:111]
  s_add_u32 s21, s48, 0
  buffer_store_dwordx4 v[224:227], v26, s[16:19], s21 offen sc1
  ds_read_b128 v[208:211], v19 offset:8192
  s_waitcnt lgkmcnt(8)
  v_mfma_f32_16x16x32_bf16 v[112:115], a[24:27], v[176:179], v[112:115]
  v_mfma_f32_16x16x32_bf16 v[116:119], a[28:31], v[176:179], v[116:119]
  v_mfma_f32_16x16x32_bf16 v[120:123], a[32:35], v[176:179], v[120:123]
  ds_read_b128 v[236:239], v23 offset:3200
  ds_read_b128 v[212:215], v19 offset:10240
  s_waitcnt lgkmcnt(8)
  v_mfma_f32_16x16x32_bf16 v[124:127], a[24:27], v[180:183], v[124:127]
  v_mfma_f32_16x16x32_bf16 v[128:131], a[28:31], v[180:183], v[128:131]
  v_mfma_f32_16x16x32_bf16 v[132:135], a[32:35], v[180:183], v[132:135]
  s_add_u32 s46, s46, 10240
  s_add_u32 m0, s47, 3072
  s_nop 0
  buffer_load_dwordx4 v10, s[8:11], s46 offen lds
  ds_read_b128 v[216:219], v19 offset:12288
  s_waitcnt lgkmcnt(8)
  v_mfma_f32_16x16x32_bf16 v[136:139], a[24:27], v[184:187], v[136:139]
  v_mfma_f32_16x16x32_bf16 v[140:143], a[28:31], v[184:187], v[140:143]
  v_mfma_f32_16x16x32_bf16 v[144:147], a[32:35], v[184:187], v[144:147]
  s_add_u32 s21, s48, 0
  buffer_store_dwordx4 v[228:231], v27, s[16:19], s21 offen sc1
  ds_read_b128 v[220:223], v19 offset:14336
  s_waitcnt lgkmcnt(8)
  v_mfma_f32_16x16x32_bf16 v[148:151], a[24:27], v[188:191], v[148:151]
  v_mfma_f32_16x16x32_bf16 v[152:155], a[28:31], v[188:191], v[152:155]
  v_mfma_f32_16x16x32_bf16 v[156:159], a[32:35], v[188:191], v[156:159]
  s_waitcnt vmcnt(14)
  s_barrier
  s_add_u32 s30, s30, 128
  s_add_u32 s31, s31, 1
  s_cmp_lt_u32 s31, 10
  s_cbranch_scc1 qb_215
  s_mov_b32 s31, 0
  s_add_u32 s30, s30, s25
  s_sub_u32 s30, s30, 1280
qb_215:
  s_add_u32 s32, s32, 16384
  s_cmp_lt_u32 s32, 98304
  s_cselect_b32 s32, s32, 0
  s_mul_i32 s46, s20, 40960
  s_add_u32 s46, s46, s30
  s_lshl_b32 s47, s20, 12
  s_add_u32 s47, s47, s32
  v_add_u32 v18, s33, v14
  v_add_u32 v19, s33, v15
  s_add_u32 s33, s33, 16384
  s_cmp_lt_u32 s33, 98304
  s_cselect_b32 s33, s33, 0
  ds_read_b128 v[160:163], v18 offset:0
  s_waitcnt lgkmcnt(8)
  v_mfma_f32_16x16x32_bf16 v[64:67], a[36:39], v[192:195], v[64:67]
  v_mfma_f32_16x16x32_bf16 v[68:71], a[40:43], v[192:195], v[68:71]
  v_mfma_f32_16x16x32_bf16 v[72:75], a[44:47], v[192:195], v[72:75]
  ds_read_b128 v[240:243], v24 offset:3200
  ds_read_b128 v[164:167], v18 offset:2048
  s_waitcnt lgkmcnt(8)
  v_mfma_f32_16x16x32_bf16 v[76:79], a[36:39], v[196:199], v[76:79]
  v_mfma_f32_16x16x32_bf16 v[80:83], a[40:43], v[196:199], v[80:83]
  v_mfma_f32_16x16x32_bf16 v[84:87], a[44:47], v[196:199], v[84:87]
  s_add_u32 m0, s47, 0
  s_nop 0
  buffer_load_dwordx4 v10, s[8:11], s46 offen lds
  ds_read_b128 v[168:171], v18 offset:4096
  s_waitcnt lgkmcnt(8)
  v_mfma_f32_16x16x32_bf16 v[88:91], a[36:39], v[200:203], v[88:91]
  v_mfma_f32_16x16x32_bf16 v[92:95], a[40:43], v[200:203], v[92:95]
  v_mfma_f32_16x16x32_bf16 v[96:99], a[44:47], v[200:203], v[96:99]
  ds_read_b128 v[172:175], v18 offset:6144
  s_waitcnt lgkmcnt(8)
  v_mfma_f32_16x16x32_bf16 v[100:103], a[36:39], v[204:207], v[100:103]
  v_mfma_f32_16x16x32_bf16 v[104:107], a[40:43], v[204:207], v[104:107]
  v_mfma_f32_16x16x32_bf16 v[108:111], a[44:47], v[204:207], v[108:111]
  s_add_u32 s21, s48, 0
  buffer_store_dwordx4 v[232:235], v28, s[16:19], s21 offen sc1
  ds_read_b128 v[176:179], v18 offset:8192
  s_waitcnt lgkmcnt(8)
  v_mfma_f32_16x16x32_bf16 v[112:115], a[36:39], v[208:211], v[112:115]
  v_mfma_f32_16x16x32_bf16 v[116:119], a[40:43], v[208:211], v[116:119]
  v_mfma_f32_16x16x32_bf16 v[120:123], a[44:47], v[208:211], v[120:123]
  ds_read_b128 v[244:247], v25 offset:3200
  ds_read_b128 v[180:183], v18 offset:10240
  s_waitcnt lgkmcnt(8)
  v_mfma_f32_16x16x32_bf16 v[124:127], a[36:39], v[212:215], v[124:127]
  v_mfma_f32_16x16x32_bf16 v[128:131], a[40:43], v[212:215], v[128:131]
  v_mfma_f32_16x16x32_bf16 v[132:135], a[44:47], v[212:215], v[132:135]
  s_add_u32 s46, s46, 10240
  s_add_u32 m0, s47, 1024
  s_nop 0
  buffer_load_dwordx4 v10, s[8:11], s46 offen lds
  ds_read_b128 v[184:187], v18 offset:12288
  s_waitcnt lgkmcnt(8)
  v_mfma_f32_16x16x32_bf16 v[136:139], a[36:39], v[216:219], v[136:139]
  v_mfma_f32_16x16x32_bf16 v[140:143], a[40:43], v[216:219], v[140:143]
  v_mfma_f32_16x16x32_bf16 v[144:147], a[44:47], v[216:219], v[144:147]
  s_add_u32 s21, s48, 30720
  buffer_store_dwordx4 v[236:239], v26, s[16:19], s21 offen sc1
  ds_read_b128 v[188:191], v18 offset:14336
  s_waitcnt lgkmcnt(8)
  v_mfma_f32_16x16x32_bf16 v[148:151], a[36:39], v[220:223], v[148:151]
  v_mfma_f32_16x16x32_bf16 v[152:155], a[40:43], v[220:223], v[152:155]
  v_mfma_f32_16x16x32_bf16 v[156:159], a[44:47], v[220:223], v[156:159]
  ds_read_b128 v[192:195], v19 offset:0
  s_waitcnt lgkmcnt(8)
  v_mfma_f32_16x16x32_bf16 v[64:67], a[48:51], v[160:163], v[64:67]
  v_mfma_f32_16x16x32_bf16 v[68:71], a[52:55], v[160:163], v[68:71]
  v_mfma_f32_16x16x32_bf16 v[72:75], a[56:59], v[160:163], v[72:75]
  ds_read_b128 v[224:227], v23 offset:6400
  ds_read_b128 v[196:199], v19 offset:2048
  s_waitcnt lgkmcnt(8)
  v_mfma_f32_16x16x32_bf16 v[76:79], a[48:51], v[164:167], v[76:79]
  v_mfma_f32_16x16x32_bf16 v[80:83], a[52:55], v[164:167], v[80:83]
  v_mfma_f32_16x16x32_bf16 v[84:87], a[56:59], v[164:167], v[84:87]
  s_add_u32 s46, s46, 10240
  s_add_u32 m0, s47, 2048
  s_nop 0
  buffer_load_dwordx4 v10, s[8:11], s46 offen lds
  ds_read_b128 v[200:203], v19 offset:4096
  s_waitcnt lgkmcnt(8)
  v_mfma_f32_16x16x32_bf16 v[88:91], a[48:51], v[168:171], v[88:91]
  v_mfma_f32_16x16x32_bf16 v[92:95], a[52:55], v[168:171], v[92:95]
  v_mfma_f32_16x16x32_bf16 v[96:99], a[56:59], v[168:171], v[96:99]
  ds_read_b128 v[204:207], v19 offset:6144
  s_waitcnt lgkmcnt(8)
  v_mfma_f32_16x16x32_bf16 v[100:103], a[48:51], v[172:175], v[100:103]
  v_mfma_f32_16x16x32_bf16 v[104:107], a[52:55], v[172:175], v[104:107]
  v_mfma_f32_16x16x32_bf16 v[108:111], a[56:59], v[172:175], v[108:111]
  s_add_u32 s21, s48, 30720
  buffer_store_dwordx4 v[240:243], v27, s[16:19], s21 offen sc1
  ds_read_b128 v[208:211], v19 offset:8192
  s_waitcnt lgkmcnt(8)
  v_mfma_f32_16x16x32_bf16 v[112:115], a[48:51], v[176:179], v[112:115]
  v_mfma_f32_16x16x32_bf16 v[116:119], a[52:55], v[176:179], v[116:119]
  v_mfma_f32_16x16x32_bf16 v[120:123], a[56:59], v[176:179], v[120:123]
  ds_read_b128 v[228:231], v24 offset:6400
  ds_read_b128 v[212:215], v19 offset:10240
  s_waitcnt lgkmcnt(8)
  v_mfma_f32_16x16x32_bf16 v[124:127], a[48:51], v[180:183], v[124:127]
  v_mfma_f32_16x16x32_bf16 v[128:131], a[52:55], v[180:183], v[128:131]
  v_mfma_f32_16x16x32_bf16 v[132:135], a[56:59], v[180:183], v[132:135]
  s_add_u32 s46, s46, 10240
  s_add_u32 m0, s47, 3072
  s_nop 0
  buffer_load_dwordx4 v10, s[8:11], s46 offen lds
  ds_read_b128 v[216:219], v19 offset:12288
  s_waitcnt lgkmcnt(8)
  v_mfma_f32_16x16x32_bf16 v[136:139], a[48:51], v[184:187], v[136:139]
  v_mfma_f32_16x16x32_bf16 v[140:143], a[52:55], v[184:187], v[140:143]
  v_mfma_f32_16x16x32_bf16 v[144:147], a[56:59], v[184:187], v[144:147]
  s_add_u32 s21, s48, 30720
  buffer_store_dwordx4 v[244:247], v28, s[16:19], s21 offen sc1
  ds_read_b128 v[220:223], v19 offset:14336
  s_waitcnt lgkmcnt(8)
  v_mfma_f32_16x16x32_bf16 v[148:151], a[48:51], v[188:191], v[148:151]
  v_mfma_f32_16x16x32_bf16 v[152:155], a[52:55], v[188:191], v[152:155]
  v_mfma_f32_16x16x32_bf16 v[156:159], a[56:59], v[188:191], v[156:159]
  s_waitcnt vmcnt(18)
  s_barrier
  s_add_u32 s30, s30, 128
  s_add_u32 s31, s31, 1
  s_cmp_lt_u32 s31, 10
  s_cbranch_scc1 qb_216
  s_mov_b32 s31, 0
  s_add_u32 s30, s30, s25
  s_sub_u32 s30, s30, 1280
qb_216:
  s_add_u32 s32, s32, 16384
  s_cmp_lt_u32 s32, 98304
  s_cselect_b32 s32, s32, 0
  s_mul_i32 s46, s20, 40960
  s_add_u32 s46, s46, s30
  s_lshl_b32 s47, s20, 12
  s_add_u32 s47, s47, s32
  v_add_u32 v18, s33, v14
  v_add_u32 v19, s33, v15
  s_add_u32 s33, s33, 16384
  s_cmp_lt_u32 s33, 98304
  s_cselect_b32 s33, s33, 0
  ds_read_b128 v[160:163], v18 offset:0
  s_waitcnt lgkmcnt(8)
  v_mfma_f32_16x16x32_bf16 v[64:67], a[60:63], v[192:195], v[64:67]
  v_mfma_f32_16x16x32_bf16 v[68:71], a[64:67], v[192:195], v[68:71]
  v_mfma_f32_16x16x32_bf16 v[72:75], a[68:71], v[192:195], v[72:75]
  ds_read_b128 v[232:235], v25 offset:6400
  ds_read_b128 v[164:167], v18 offset:2048
  s_waitcnt lgkmcnt(8)
  v_mfma_f32_16x16x32_bf16 v[76:79], a[60:63], v[196:199], v[76:79]
  v_mfma_f32_16x16x32_bf16 v[80:83], a[64:67], v[196:199], v[80:83]
  v_mfma_f32_16x16x32_bf16 v[84:87], a[68:71], v[196:199], v[84:87]
  s_add_u32 m0, s47, 0
  s_nop 0
  buffer_load_dwordx4 v10, s[8:11], s46 offen lds
  ds_read_b128 v[168:171], v18 offset:4096
  s_waitcnt lgkmcnt(8)
  v_mfma_f32_16x16x32_bf16 v[88:91], a[60:63], v[200:203], v[88:91]
  v_mfma_f32_16x16x32_bf16 v[92:95], a[64:67], v[200:203], v[92:95]
  v_mfma_f32_16x16x32_bf16 v[96:99], a[68:71], v[200:203], v[96:99]
  ds_read_b128 v[172:175], v18 offset:6144
  s_waitcnt lgkmcnt(8)
  v_mfma_f32_16x16x32_bf16 v[100:103], a[60:63], v[204:207], v[100:103]
  v_mfma_f32_16x16x32_bf16 v[104:107], a[64:67], v[204:207], v[104:107]
  v_mfma_f32_16x16x32_bf16 v[108:111], a[68:71], v[204:207], v[108:111]
  s_add_u32 s21, s48, 61440
  buffer_store_dwordx4 v[224:227], v26, s[16:19], s21 offen sc1
  ds_read_b128 v[176:179], v18 offset:8192
  s_waitcnt lgkmcnt(8)
  v_mfma_f32_16x16x32_bf16 v[112:115], a[60:63], v[208:211], v[112:115]
  v_mfma_f32_16x16x32_bf16 v[116:119], a[64:67], v[208:211], v[116:119]
  v_mfma_f32_16x16x32_bf16 v[120:123], a[68:71], v[208:211], v[120:123]
  ds_read_b128 v[236:239], v23 offset:9600
  ds_read_b128 v[180:183], v18 offset:10240
  s_waitcnt lgkmcnt(8)
  v_mfma_f32_16x16x32_bf16 v[124:127], a[60:63], v[212:215], v[124:127]
  v_mfma_f32_16x16x32_bf16 v[128:131], a[64:67], v[212:215], v[128:131]
  v_mfma_f32_16x16x32_bf16 v[132:135], a[68:71], v[212:215], v[132:135]
  s_add_u32 s46, s46, 10240
  s_add_u32 m0, s47, 1024
  s_nop 0
  buffer_load_dwordx4 v10, s[8:11], s46 offen lds
  ds_read_b128 v[184:187], v18 offset:12288
  s_waitcnt lgkmcnt(8)
  v_mfma_f32_16x16x32_bf16 v[136:139], a[60:63], v[216:219], v[136:139]
  v_mfma_f32_16x16x32_bf16 v[140:143], a[64:67], v[216:219], v[140:143]
  v_mfma_f32_16x16x32_bf16 v[144:147], a[68:71], v[216:219], v[144:147]
  s_add_u32 s21, s48, 61440
  buffer_store_dwordx4 v[228:231], v27, s[16:19], s21 offen sc1
  ds_read_b128 v[188:191], v18 offset:14336
  s_waitcnt lgkmcnt(8)
  v_mfma_f32_16x16x32_bf16 v[148:151], a[60:63], v[220:223], v[148:151]
  v_mfma_f32_16x16x32_bf16 v[152:155], a[64:67], v[220:223], v[152:155]
  v_mfma_f32_16x16x32_bf16 v[156:159], a[68:71], v[220:223], v[156:159]
  ds_read_b128 v[192:195], v19 offset:0
  s_waitcnt lgkmcnt(8)
  v_mfma_f32_16x16x32_bf16 v[64:67], a[72:75], v[160:163], v[64:67]
  v_mfma_f32_16x16x32_bf16 v[68:71], a[76:79], v[160:163], v[68:71]
  v_mfma_f32_16x16x32_bf16 v[72:75], a[80:83], v[160:163], v[72:75]
  ds_read_b128 v[240:243], v24 offset:9600
  ds_read_b128 v[196:199], v19 offset:2048
  s_waitcnt lgkmcnt(8)
  v_mfma_f32_16x16x32_bf16 v[76:79], a[72:75], v[164:167], v[76:79]
  v_mfma_f32_16x16x32_bf16 v[80:83], a[76:79], v[164:167], v[80:83]
  v_mfma_f32_16x16x32_bf16 v[84:87], a[80:83], v[164:167], v[84:87]
  s_add_u32 s46, s46, 10240
  s_add_u32 m0, s47, 2048
  s_nop 0
  buffer_load_dwordx4 v10, s[8:11], s46 offen lds
  ds_read_b128 v[200:203], v19 offset:4096
  s_waitcnt lgkmcnt(8)
  v_mfma_f32_16x16x32_bf16 v[88:91], a[72:75], v[168:171], v[88:91]
  v_mfma_f32_16x16x32_bf16 v[92:95], a[76:79], v[168:171], v[92:95]
  v_mfma_f32_16x16x32_bf16 v[96:99], a[80:83], v[168:171], v[96:99]
  ds_read_b128 v[204:207], v19 offset:6144
  s_waitcnt lgkmcnt(8)
  v_mfma_f32_16x16x32_bf16 v[100:103], a[72:75], v[172:175], v[100:103]
  v_mfma_f32_16x16x32_bf16 v[104:107], a[76:79], v[172:175], v[104:107]
  v_mfma_f32_16x16x32_bf16 v[108:111], a[80:83], v[172:175], v[108:111]
  s_add_u32 s21, s48, 61440
  buffer_store_dwordx4 v[232:235], v28, s[16:19], s21 offen sc1
  ds_read_b128 v[208:211], v19 offset:8192
  s_waitcnt lgkmcnt(8)
  v_mfma_f32_16x16x32_bf16 v[112:115], a[72:75], v[176:179], v[112:115]
  v_mfma_f32_16x16x32_bf16 v[116:119], a[76:79], v[176:179], v[116:119]
  v_mfma_f32_16x16x32_bf16 v[120:123], a[80:83], v[176:179], v[120:123]
  ds_read_b128 v[244:247], v25 offset:9600
  ds_read_b128 v[212:215], v19 offset:10240
  s_waitcnt lgkmcnt(8)
  v_mfma_f32_16x16x32_bf16 v[124:127], a[72:75], v[180:183], v[124:127]
  v_mfma_f32_16x16x32_bf16 v[128:131], a[76:79], v[180:183], v[128:131]
  v_mfma_f32_16x16x32_bf16 v[132:135], a[80:83], v[180:183], v[132:135]
  s_add_u32 s46, s46, 10240
  s_add_u32 m0, s47, 3072
  s_nop 0
  buffer_load_dwordx4 v10, s[8:11], s46 offen lds
  ds_read_b128 v[216:219], v19 offset:12288
  s_waitcnt lgkmcnt(8)
  v_mfma_f32_16x16x32_bf16 v[136:139], a[72:75], v[184:187], v[136:139]
  v_mfma_f32_16x16x32_bf16 v[140:143], a[76:79], v[184:187], v[140:143]
  v_mfma_f32_16x16x32_bf16 v[144:147], a[80:83], v[184:187], v[144:147]
  s_add_u32 s21, s48, 92160
  buffer_store_dwordx4 v[236:239], v26, s[16:19], s21 offen sc1
  ds_read_b128 v[220:223], v19 offset:14336
  s_waitcnt lgkmcnt(8)
  v_mfma_f32_16x16x32_bf16 v[148:151], a[72:75], v[188:191], v[148:151]
  v_mfma_f32_16x16x32_bf16 v[152:155], a[76:79], v[188:191], v[152:155]
  v_mfma_f32_16x16x32_bf16 v[156:159], a[80:83], v[188:191], v[156:159]
  s_waitcnt vmcnt(22)
  s_barrier
  s_add_u32 s30, s30, 128
  s_add_u32 s31, s31, 1
  s_cmp_lt_u32 s31, 10
  s_cbranch_scc1 qb_217
  s_mov_b32 s31, 0
  s_add_u32 s30, s30, s25
  s_sub_u32 s30, s30, 1280
qb_217:
  s_add_u32 s32, s32, 16384
  s_cmp_lt_u32 s32, 98304
  s_cselect_b32 s32, s32, 0
  s_mul_i32 s46, s20, 40960
  s_add_u32 s46, s46, s30
  s_lshl_b32 s47, s20, 12
  s_add_u32 s47, s47, s32
  v_add_u32 v18, s33, v14
  v_add_u32 v19, s33, v15
  s_add_u32 s33, s33, 16384
  s_cmp_lt_u32 s33, 98304
  s_cselect_b32 s33, s33, 0
  ds_read_b128 v[160:163], v18 offset:0
  s_waitcnt lgkmcnt(8)
  v_mfma_f32_16x16x32_bf16 v[64:67], a[84:87], v[192:195], v[64:67]
  v_mfma_f32_16x16x32_bf16 v[68:71], a[88:91], v[192:195], v[68:71]
  v_mfma_f32_16x16x32_bf16 v[72:75], a[92:95], v[192:195], v[72:75]
  ds_read_b128 v[164:167], v18 offset:2048
  s_waitcnt lgkmcnt(8)
  v_mfma_f32_16x16x32_bf16 v[76:79], a[84:87], v[196:199], v[76:79]
  v_mfma_f32_16x16x32_bf16 v[80:83], a[88:91], v[196:199], v[80:83]
  v_mfma_f32_16x16x32_bf16 v[84:87], a[92:95], v[196:199], v[84:87]
  s_add_u32 m0, s47, 0
  s_nop 0
  buffer_load_dwordx4 v10, s[8:11], s46 offen lds
  ds_read_b128 v[168:171], v18 offset:4096
  s_waitcnt lgkmcnt(8)
  v_mfma_f32_16x16x32_bf16 v[88:91], a[84:87], v[200:203], v[88:91]
  v_mfma_f32_16x16x32_bf16 v[92:95], a[88:91], v[200:203], v[92:95]
  v_mfma_f32_16x16x32_bf16 v[96:99], a[92:95], v[200:203], v[96:99]
  ds_read_b128 v[172:175], v18 offset:6144
  s_waitcnt lgkmcnt(8)
  v_mfma_f32_16x16x32_bf16 v[100:103], a[84:87], v[204:207], v[100:103]
  v_mfma_f32_16x16x32_bf16 v[104:107], a[88:91], v[204:207], v[104:107]
  v_mfma_f32_16x16x32_bf16 v[108:111], a[92:95], v[204:207], v[108:111]
  s_add_u32 s21, s48, 92160
  buffer_store_dwordx4 v[240:243], v27, s[16:19], s21 offen sc1
  ds_read_b128 v[176:179], v18 offset:8192
  s_waitcnt lgkmcnt(8)
  v_mfma_f32_16x16x32_bf16 v[112:115], a[84:87], v[208:211], v[112:115]
  v_mfma_f32_16x16x32_bf16 v[116:119], a[88:91], v[208:211], v[116:119]
  v_mfma_f32_16x16x32_bf16 v[120:123], a[92:95], v[208:211], v[120:123]
  ds_read_b128 v[180:183], v18 offset:10240
  s_waitcnt lgkmcnt(8)
  v_mfma_f32_16x16x32_bf16 v[124:127], a[84:87], v[212:215], v[124:127]
  v_mfma_f32_16x16x32_bf16 v[128:131], a[88:91], v[212:215], v[128:131]
  v_mfma_f32_16x16x32_bf16 v[132:135], a[92:95], v[212:215], v[132:135]
  s_add_u32 s46, s46, 10240
  s_add_u32 m0, s47, 1024
  s_nop 0
  buffer_load_dwordx4 v10, s[8:11], s46 offen lds
  ds_read_b128 v[184:187], v18 offset:12288
  s_waitcnt lgkmcnt(8)
  v_mfma_f32_16x16x32_bf16 v[136:139], a[84:87], v[216:219], v[136:139]
  v_mfma_f32_16x16x32_bf16 v[140:143], a[88:91], v[216:219], v[140:143]
  v_mfma_f32_16x16x32_bf16 v[144:147], a[92:95], v[216:219], v[144:147]
  s_add_u32 s21, s48, 92160
  buffer_store_dwordx4 v[244:247], v28, s[16:19], s21 offen sc1
  ds_read_b128 v[188:191], v18 offset:14336
  s_waitcnt lgkmcnt(8)
  v_mfma_f32_16x16x32_bf16 v[148:151], a[84:87], v[220:223], v[148:151]
  v_mfma_f32_16x16x32_bf16 v[152:155], a[88:91], v[220:223], v[152:155]
  v_mfma_f32_16x16x32_bf16 v[156:159], a[92:95], v[220:223], v[156:159]
  ds_read_b128 v[192:195], v19 offset:0
  s_waitcnt lgkmcnt(8)
  v_mfma_f32_16x16x32_bf16 v[64:67], a[96:99], v[160:163], v[64:67]
  v_mfma_f32_16x16x32_bf16 v[68:71], a[100:103], v[160:163], v[68:71]
  v_mfma_f32_16x16x32_bf16 v[72:75], a[104:107], v[160:163], v[72:75]
  ds_read_b128 v[196:199], v19 offset:2048
  s_waitcnt lgkmcnt(8)
  v_mfma_f32_16x16x32_bf16 v[76:79], a[96:99], v[164:167], v[76:79]
  v_mfma_f32_16x16x32_bf16 v[80:83], a[100:103], v[164:167], v[80:83]
  v_mfma_f32_16x16x32_bf16 v[84:87], a[104:107], v[164:167], v[84:87]
  s_add_u32 s46, s46, 10240
  s_add_u32 m0, s47, 2048
  s_nop 0
  buffer_load_dwordx4 v10, s[8:11], s46 offen lds
  ds_read_b128 v[200:203], v19 offset:4096
  s_waitcnt lgkmcnt(8)
  v_mfma_f32_16x16x32_bf16 v[88:91], a[96:99], v[168:171], v[88:91]
  v_mfma_f32_16x16x32_bf16 v[92:95], a[100:103], v[168:171], v[92:95]
  v_mfma_f32_16x16x32_bf16 v[96:99], a[104:107], v[168:171], v[96:99]
  ds_read_b128 v[204:207], v19 offset:6144
  s_waitcnt lgkmcnt(8)
  v_mfma_f32_16x16x32_bf16 v[100:103], a[96:99], v[172:175], v[100:103]
  v_mfma_f32_16x16x32_bf16 v[104:107], a[100:103], v[172:175], v[104:107]
  v_mfma_f32_16x16x32_bf16 v[108:111], a[104:107], v[172:175], v[108:111]
  ds_read_b128 v[208:211], v19 offset:8192
  s_waitcnt lgkmcnt(8)
  v_mfma_f32_16x16x32_bf16 v[112:115], a[96:99], v[176:179], v[112:115]
  v_mfma_f32_16x16x32_bf16 v[116:119], a[100:103], v[176:179], v[116:119]
  v_mfma_f32_16x16x32_bf16 v[120:123], a[104:107], v[176:179], v[120:123]
  ds_read_b128 v[212:215], v19 offset:10240
  s_waitcnt lgkmcnt(8)
  v_mfma_f32_16x16x32_bf16 v[124:127], a[96:99], v[180:183], v[124:127]
  v_mfma_f32_16x16x32_bf16 v[128:131], a[100:103], v[180:183], v[128:131]
  v_mfma_f32_16x16x32_bf16 v[132:135], a[104:107], v[180:183], v[132:135]
  s_add_u32 s46, s46, 10240
  s_add_u32 m0, s47, 3072
  s_nop 0
  buffer_load_dwordx4 v10, s[8:11], s46 offen lds
  ds_read_b128 v[216:219], v19 offset:12288
  s_waitcnt lgkmcnt(8)
  v_mfma_f32_16x16x32_bf16 v[136:139], a[96:99], v[184:187], v[136:139]
  v_mfma_f32_16x16x32_bf16 v[140:143], a[100:103], v[184:187], v[140:143]
  v_mfma_f32_16x16x32_bf16 v[144:147], a[104:107], v[184:187], v[144:147]
  ds_read_b128 v[220:223], v19 offset:14336
  s_waitcnt lgkmcnt(8)
  v_mfma_f32_16x16x32_bf16 v[148:151], a[96:99], v[188:191], v[148:151]
  v_mfma_f32_16x16x32_bf16 v[152:155], a[100:103], v[188:191], v[152:155]
  v_mfma_f32_16x16x32_bf16 v[156:159], a[104:107], v[188:191], v[156:159]
  s_waitcnt vmcnt(23)
  s_barrier
  s_add_u32 s30, s30, 128
  s_add_u32 s31, s31, 1
  s_cmp_lt_u32 s31, 10
  s_cbranch_scc1 qb_218
  s_mov_b32 s31, 0
  s_add_u32 s30, s30, s25
  s_sub_u32 s30, s30, 1280
qb_218:
  s_add_u32 s32, s32, 16384
  s_cmp_lt_u32 s32, 98304
  s_cselect_b32 s32, s32, 0
  s_mul_i32 s46, s20, 40960
  s_add_u32 s46, s46, s30
  s_lshl_b32 s47, s20, 12
  s_add_u32 s47, s47, s32
  v_add_u32 v18, s33, v14
  v_add_u32 v19, s33, v15
  s_add_u32 s33, s33, 16384
  s_cmp_lt_u32 s33, 98304
  s_cselect_b32 s33, s33, 0
  ds_read_b128 v[160:163], v18 offset:0
  s_waitcnt lgkmcnt(8)
  v_mfma_f32_16x16x32_bf16 v[64:67], a[108:111], v[192:195], v[64:67]
  v_mfma_f32_16x16x32_bf16 v[68:71], a[112:115], v[192:195], v[68:71]
  v_mfma_f32_16x16x32_bf16 v[72:75], a[116:119], v[192:195], v[72:75]
  ds_read_b128 v[164:167], v18 offset:2048
  s_waitcnt lgkmcnt(8)
  v_mfma_f32_16x16x32_bf16 v[76:79], a[108:111], v[196:199], v[76:79]
  v_mfma_f32_16x16x32_bf16 v[80:83], a[112:115], v[196:199], v[80:83]
  v_mfma_f32_16x16x32_bf16 v[84:87], a[116:119], v[196:199], v[84:87]
  s_add_u32 m0, s47, 0
  s_nop 0
  buffer_load_dwordx4 v10, s[8:11], s46 offen lds
  ds_read_b128 v[168:171], v18 offset:4096
  s_waitcnt lgkmcnt(8)
  v_mfma_f32_16x16x32_bf16 v[88:91], a[108:111], v[200:203], v[88:91]
  v_mfma_f32_16x16x32_bf16 v[92:95], a[112:115], v[200:203], v[92:95]
  v_mfma_f32_16x16x32_bf16 v[96:99], a[116:119], v[200:203], v[96:99]
  ds_read_b128 v[172:175], v18 offset:6144
  s_waitcnt lgkmcnt(8)
  v_mfma_f32_16x16x32_bf16 v[100:103], a[108:111], v[204:207], v[100:103]
  v_mfma_f32_16x16x32_bf16 v[104:107], a[112:115], v[204:207], v[104:107]
  v_mfma_f32_16x16x32_bf16 v[108:111], a[116:119], v[204:207], v[108:111]
  ds_read_b128 v[176:179], v18 offset:8192
  s_waitcnt lgkmcnt(8)
  v_mfma_f32_16x16x32_bf16 v[112:115], a[108:111], v[208:211], v[112:115]
  v_mfma_f32_16x16x32_bf16 v[116:119], a[112:115], v[208:211], v[116:119]
  v_mfma_f32_16x16x32_bf16 v[120:123], a[116:119], v[208:211], v[120:123]
  ds_read_b128 v[180:183], v18 offset:10240
  s_waitcnt lgkmcnt(8)
  v_mfma_f32_16x16x32_bf16 v[124:127], a[108:111], v[212:215], v[124:127]
  v_mfma_f32_16x16x32_bf16 v[128:131], a[112:115], v[212:215], v[128:131]
  v_mfma_f32_16x16x32_bf16 v[132:135], a[116:119], v[212:215], v[132:135]
  s_add_u32 s46, s46, 10240
  s_add_u32 m0, s47, 1024
  s_nop 0
  buffer_load_dwordx4 v10, s[8:11], s46 offen lds
  ds_read_b128 v[184:187], v18 offset:12288
  s_waitcnt lgkmcnt(8)
  v_mfma_f32_16x16x32_bf16 v[136:139], a[108:111], v[216:219], v[136:139]
  v_mfma_f32_16x16x32_bf16 v[140:143], a[112:115], v[216:219], v[140:143]
  v_mfma_f32_16x16x32_bf16 v[144:147], a[116:119], v[216:219], v[144:147]
  ds_read_b128 v[188:191], v18 offset:14336
  s_waitcnt lgkmcnt(8)
  v_mfma_f32_16x16x32_bf16 v[148:151], a[108:111], v[220:223], v[148:151]
  v_mfma_f32_16x16x32_bf16 v[152:155], a[112:115], v[220:223], v[152:155]
  v_mfma_f32_16x16x32_bf16 v[156:159], a[116:119], v[220:223], v[156:159]
  ds_read_b128 v[192:195], v19 offset:0
  s_waitcnt lgkmcnt(8)
  v_mfma_f32_16x16x32_bf16 v[64:67], a[120:123], v[160:163], v[64:67]
  v_mfma_f32_16x16x32_bf16 v[68:71], a[124:127], v[160:163], v[68:71]
  v_mfma_f32_16x16x32_bf16 v[72:75], a[128:131], v[160:163], v[72:75]
  ds_read_b128 v[196:199], v19 offset:2048
  s_waitcnt lgkmcnt(8)
  v_mfma_f32_16x16x32_bf16 v[76:79], a[120:123], v[164:167], v[76:79]
  v_mfma_f32_16x16x32_bf16 v[80:83], a[124:127], v[164:167], v[80:83]
  v_mfma_f32_16x16x32_bf16 v[84:87], a[128:131], v[164:167], v[84:87]
  s_add_u32 s46, s46, 10240
  s_add_u32 m0, s47, 2048
  s_nop 0
  buffer_load_dwordx4 v10, s[8:11], s46 offen lds
  ds_read_b128 v[200:203], v19 offset:4096
  s_waitcnt lgkmcnt(8)
  v_mfma_f32_16x16x32_bf16 v[88:91], a[120:123], v[168:171], v[88:91]
  v_mfma_f32_16x16x32_bf16 v[92:95], a[124:127], v[168:171], v[92:95]
  v_mfma_f32_16x16x32_bf16 v[96:99], a[128:131], v[168:171], v[96:99]
  ds_read_b128 v[204:207], v19 offset:6144
  s_waitcnt lgkmcnt(8)
  v_mfma_f32_16x16x32_bf16 v[100:103], a[120:123], v[172:175], v[100:103]
  v_mfma_f32_16x16x32_bf16 v[104:107], a[124:127], v[172:175], v[104:107]
  v_mfma_f32_16x16x32_bf16 v[108:111], a[128:131], v[172:175], v[108:111]
  ds_read_b128 v[208:211], v19 offset:8192
  s_waitcnt lgkmcnt(8)
  v_mfma_f32_16x16x32_bf16 v[112:115], a[120:123], v[176:179], v[112:115]
  v_mfma_f32_16x16x32_bf16 v[116:119], a[124:127], v[176:179], v[116:119]
  v_mfma_f32_16x16x32_bf16 v[120:123], a[128:131], v[176:179], v[120:123]
  ds_read_b128 v[212:215], v19 offset:10240
  s_waitcnt lgkmcnt(8)
  v_mfma_f32_16x16x32_bf16 v[124:127], a[120:123], v[180:183], v[124:127]
  v_mfma_f32_16x16x32_bf16 v[128:131], a[124:127], v[180:183], v[128:131]
  v_mfma_f32_16x16x32_bf16 v[132:135], a[128:131], v[180:183], v[132:135]
  s_add_u32 s46, s46, 10240
  s_add_u32 m0, s47, 3072
  s_nop 0
  buffer_load_dwordx4 v10, s[8:11], s46 offen lds
  ds_read_b128 v[216:219], v19 offset:12288
  s_waitcnt lgkmcnt(8)
  v_mfma_f32_16x16x32_bf16 v[136:139], a[120:123], v[184:187], v[136:139]
  v_mfma_f32_16x16x32_bf16 v[140:143], a[124:127], v[184:187], v[140:143]
  v_mfma_f32_16x16x32_bf16 v[144:147], a[128:131], v[184:187], v[144:147]
  ds_read_b128 v[220:223], v19 offset:14336
  s_waitcnt lgkmcnt(8)
  v_mfma_f32_16x16x32_bf16 v[148:151], a[120:123], v[188:191], v[148:151]
  v_mfma_f32_16x16x32_bf16 v[152:155], a[124:127], v[188:191], v[152:155]
  v_mfma_f32_16x16x32_bf16 v[156:159], a[128:131], v[188:191], v[156:159]
  s_waitcnt vmcnt(6)
  s_barrier
  s_cmp_eq_u32 s48, 0x80000000
  s_cbranch_scc1 qb_219
  s_cmp_lg_u32 s20, 0
  s_cbranch_scc1 af_220
  v_mov_b32 v4, 0
  v_mov_b32 v5, 1
  s_mov_b64 exec, 1
  buffer_atomic_add v5, v4, s[72:75], s61 offen sc1
  s_mov_b64 exec, -1
  s_nop 1
af_220:
qb_219:
  s_add_u32 s30, s30, 128
  s_add_u32 s31, s31, 1
  s_cmp_lt_u32 s31, 10
  s_cbranch_scc1 qb_221
  s_mov_b32 s31, 0
  s_add_u32 s30, s30, s25
  s_sub_u32 s30, s30, 1280
qb_221:
  s_add_u32 s32, s32, 16384
  s_cmp_lt_u32 s32, 98304
  s_cselect_b32 s32, s32, 0
  s_mul_i32 s46, s20, 40960
  s_add_u32 s46, s46, s30
  s_lshl_b32 s47, s20, 12
  s_add_u32 s47, s47, s32
  v_add_u32 v18, s33, v14
  v_add_u32 v19, s33, v15
  s_add_u32 s33, s33, 16384
  s_cmp_lt_u32 s33, 98304
  s_cselect_b32 s33, s33, 0
  ds_read_b128 v[160:163], v18 offset:0
  s_waitcnt lgkmcnt(8)
  v_mfma_f32_16x16x32_bf16 v[64:67], a[132:135], v[192:195], v[64:67]
  v_mfma_f32_16x16x32_bf16 v[68:71], a[136:139], v[192:195], v[68:71]
  v_mfma_f32_16x16x32_bf16 v[72:75], a[140:143], v[192:195], v[72:75]
  ds_read_b128 v[164:167], v18 offset:2048
  s_waitcnt lgkmcnt(8)
  v_mfma_f32_16x16x32_bf16 v[76:79], a[132:135], v[196:199], v[76:79]
  v_mfma_f32_16x16x32_bf16 v[80:83], a[136:139], v[196:199], v[80:83]
  v_mfma_f32_16x16x32_bf16 v[84:87], a[140:143], v[196:199], v[84:87]
  s_add_u32 m0, s47, 0
  s_nop 0
  buffer_load_dwordx4 v10, s[8:11], s46 offen lds
  ds_read_b128 v[168:171], v18 offset:4096
  s_waitcnt lgkmcnt(8)
  v_mfma_f32_16x16x32_bf16 v[88:91], a[132:135], v[200:203], v[88:91]
  v_mfma_f32_16x16x32_bf16 v[92:95], a[136:139], v[200:203], v[92:95]
  v_mfma_f32_16x16x32_bf16 v[96:99], a[140:143], v[200:203], v[96:99]
  ds_read_b128 v[172:175], v18 offset:6144
  s_waitcnt lgkmcnt(8)
  v_mfma_f32_16x16x32_bf16 v[100:103], a[132:135], v[204:207], v[100:103]
  v_mfma_f32_16x16x32_bf16 v[104:107], a[136:139], v[204:207], v[104:107]
  v_mfma_f32_16x16x32_bf16 v[108:111], a[140:143], v[204:207], v[108:111]
  ds_read_b128 v[176:179], v18 offset:8192
  s_waitcnt lgkmcnt(8)
  v_mfma_f32_16x16x32_bf16 v[112:115], a[132:135], v[208:211], v[112:115]
  v_mfma_f32_16x16x32_bf16 v[116:119], a[136:139], v[208:211], v[116:119]
  v_mfma_f32_16x16x32_bf16 v[120:123], a[140:143], v[208:211], v[120:123]
  ds_read_b128 v[180:183], v18 offset:10240
  s_waitcnt lgkmcnt(8)
  v_mfma_f32_16x16x32_bf16 v[124:127], a[132:135], v[212:215], v[124:127]
  v_mfma_f32_16x16x32_bf16 v[128:131], a[136:139], v[212:215], v[128:131]
  v_mfma_f32_16x16x32_bf16 v[132:135], a[140:143], v[212:215], v[132:135]
  s_add_u32 s46, s46, 10240
  s_add_u32 m0, s47, 1024
  s_nop 0
  buffer_load_dwordx4 v10, s[8:11], s46 offen lds
  ds_read_b128 v[184:187], v18 offset:12288
  s_waitcnt lgkmcnt(8)
  v_mfma_f32_16x16x32_bf16 v[136:139], a[132:135], v[216:219], v[136:139]
  v_mfma_f32_16x16x32_bf16 v[140:143], a[136:139], v[216:219], v[140:143]
  v_mfma_f32_16x16x32_bf16 v[144:147], a[140:143], v[216:219], v[144:147]
  ds_read_b128 v[188:191], v18 offset:14336
  s_waitcnt lgkmcnt(8)
  v_mfma_f32_16x16x32_bf16 v[148:151], a[132:135], v[220:223], v[148:151]
  v_mfma_f32_16x16x32_bf16 v[152:155], a[136:139], v[220:223], v[152:155]
  v_mfma_f32_16x16x32_bf16 v[156:159], a[140:143], v[220:223], v[156:159]
  ds_read_b128 v[192:195], v19 offset:0
  s_waitcnt lgkmcnt(8)
  v_mfma_f32_16x16x32_bf16 v[64:67], a[144:147], v[160:163], v[64:67]
  v_mfma_f32_16x16x32_bf16 v[68:71], a[148:151], v[160:163], v[68:71]
  v_mfma_f32_16x16x32_bf16 v[72:75], a[152:155], v[160:163], v[72:75]
  ds_read_b128 v[196:199], v19 offset:2048
  s_waitcnt lgkmcnt(8)
  v_mfma_f32_16x16x32_bf16 v[76:79], a[144:147], v[164:167], v[76:79]
  v_mfma_f32_16x16x32_bf16 v[80:83], a[148:151], v[164:167], v[80:83]
  v_mfma_f32_16x16x32_bf16 v[84:87], a[152:155], v[164:167], v[84:87]
  s_add_u32 s46, s46, 10240
  s_add_u32 m0, s47, 2048
  s_nop 0
  buffer_load_dwordx4 v10, s[8:11], s46 offen lds
  ds_read_b128 v[200:203], v19 offset:4096
  s_waitcnt lgkmcnt(8)
  v_mfma_f32_16x16x32_bf16 v[88:91], a[144:147], v[168:171], v[88:91]
  v_mfma_f32_16x16x32_bf16 v[92:95], a[148:151], v[168:171], v[92:95]
  v_mfma_f32_16x16x32_bf16 v[96:99], a[152:155], v[168:171], v[96:99]
  ds_read_b128 v[204:207], v19 offset:6144
  s_waitcnt lgkmcnt(8)
  v_mfma_f32_16x16x32_bf16 v[100:103], a[144:147], v[172:175], v[100:103]
  v_mfma_f32_16x16x32_bf16 v[104:107], a[148:151], v[172:175], v[104:107]
  v_mfma_f32_16x16x32_bf16 v[108:111], a[152:155], v[172:175], v[108:111]
  ds_read_b128 v[208:211], v19 offset:8192
  s_waitcnt lgkmcnt(8)
  v_mfma_f32_16x16x32_bf16 v[112:115], a[144:147], v[176:179], v[112:115]
  v_mfma_f32_16x16x32_bf16 v[116:119], a[148:151], v[176:179], v[116:119]
  v_mfma_f32_16x16x32_bf16 v[120:123], a[152:155], v[176:179], v[120:123]
  ds_read_b128 v[212:215], v19 offset:10240
  s_waitcnt lgkmcnt(8)
  v_mfma_f32_16x16x32_bf16 v[124:127], a[144:147], v[180:183], v[124:127]
  v_mfma_f32_16x16x32_bf16 v[128:131], a[148:151], v[180:183], v[128:131]
  v_mfma_f32_16x16x32_bf16 v[132:135], a[152:155], v[180:183], v[132:135]
  s_add_u32 s46, s46, 10240
  s_add_u32 m0, s47, 3072
  s_nop 0
  buffer_load_dwordx4 v10, s[8:11], s46 offen lds
  ds_read_b128 v[216:219], v19 offset:12288
  s_waitcnt lgkmcnt(8)
  v_mfma_f32_16x16x32_bf16 v[136:139], a[144:147], v[184:187], v[136:139]
  v_mfma_f32_16x16x32_bf16 v[140:143], a[148:151], v[184:187], v[140:143]
  v_mfma_f32_16x16x32_bf16 v[144:147], a[152:155], v[184:187], v[144:147]
  ds_read_b128 v[220:223], v19 offset:14336
  s_waitcnt lgkmcnt(8)
  v_mfma_f32_16x16x32_bf16 v[148:151], a[144:147], v[188:191], v[148:151]
  v_mfma_f32_16x16x32_bf16 v[152:155], a[148:151], v[188:191], v[152:155]
  v_mfma_f32_16x16x32_bf16 v[156:159], a[152:155], v[188:191], v[156:159]
  s_waitcnt vmcnt(15)
  s_barrier
  s_add_u32 s30, s30, 128
  s_add_u32 s31, s31, 1
  s_cmp_lt_u32 s31, 10
  s_cbranch_scc1 qb_222
  s_mov_b32 s31, 0
  s_add_u32 s30, s30, s25
  s_sub_u32 s30, s30, 1280
qb_222:
  s_add_u32 s32, s32, 16384
  s_cmp_lt_u32 s32, 98304
  s_cselect_b32 s32, s32, 0
  s_mul_i32 s46, s20, 40960
  s_add_u32 s46, s46, s30
  s_lshl_b32 s47, s20, 12
  s_add_u32 s47, s47, s32
  v_add_u32 v18, s33, v14
  v_add_u32 v19, s33, v15
  s_add_u32 s33, s33, 16384
  s_cmp_lt_u32 s33, 98304
  s_cselect_b32 s33, s33, 0
  ds_read_b128 v[160:163], v18 offset:0
  s_waitcnt lgkmcnt(8)
  v_mfma_f32_16x16x32_bf16 v[64:67], a[156:159], v[192:195], v[64:67]
  v_mfma_f32_16x16x32_bf16 v[68:71], a[160:163], v[192:195], v[68:71]
  v_mfma_f32_16x16x32_bf16 v[72:75], a[164:167], v[192:195], v[72:75]
  ds_read_b128 v[164:167], v18 offset:2048
  s_waitcnt lgkmcnt(8)
  v_mfma_f32_16x16x32_bf16 v[76:79], a[156:159], v[196:199], v[76:79]
  v_mfma_f32_16x16x32_bf16 v[80:83], a[160:163], v[196:199], v[80:83]
  v_mfma_f32_16x16x32_bf16 v[84:87], a[164:167], v[196:199], v[84:87]
  s_add_u32 m0, s47, 0
  s_nop 0
  buffer_load_dwordx4 v10, s[8:11], s46 offen lds
  ds_read_b128 v[168:171], v18 offset:4096
  s_waitcnt lgkmcnt(8)
  v_mfma_f32_16x16x32_bf16 v[88:91], a[156:159], v[200:203], v[88:91]
  v_mfma_f32_16x16x32_bf16 v[92:95], a[160:163], v[200:203], v[92:95]
  v_mfma_f32_16x16x32_bf16 v[96:99], a[164:167], v[200:203], v[96:99]
  ds_read_b128 v[172:175], v18 offset:6144
  s_waitcnt lgkmcnt(8)
  v_mfma_f32_16x16x32_bf16 v[100:103], a[156:159], v[204:207], v[100:103]
  v_mfma_f32_16x16x32_bf16 v[104:107], a[160:163], v[204:207], v[104:107]
  v_mfma_f32_16x16x32_bf16 v[108:111], a[164:167], v[204:207], v[108:111]
  ds_read_b128 v[176:179], v18 offset:8192
  s_waitcnt lgkmcnt(8)
  v_mfma_f32_16x16x32_bf16 v[112:115], a[156:159], v[208:211], v[112:115]
  v_mfma_f32_16x16x32_bf16 v[116:119], a[160:163], v[208:211], v[116:119]
  v_mfma_f32_16x16x32_bf16 v[120:123], a[164:167], v[208:211], v[120:123]
  ds_read_b128 v[180:183], v18 offset:10240
  s_waitcnt lgkmcnt(8)
  v_mfma_f32_16x16x32_bf16 v[124:127], a[156:159], v[212:215], v[124:127]
  v_mfma_f32_16x16x32_bf16 v[128:131], a[160:163], v[212:215], v[128:131]
  v_mfma_f32_16x16x32_bf16 v[132:135], a[164:167], v[212:215], v[132:135]
  s_add_u32 s46, s46, 10240
  s_add_u32 m0, s47, 1024
  s_nop 0
  buffer_load_dwordx4 v10, s[8:11], s46 offen lds
  ds_read_b128 v[184:187], v18 offset:12288
  s_waitcnt lgkmcnt(8)
  v_mfma_f32_16x16x32_bf16 v[136:139], a[156:159], v[216:219], v[136:139]
  v_mfma_f32_16x16x32_bf16 v[140:143], a[160:163], v[216:219], v[140:143]
  v_mfma_f32_16x16x32_bf16 v[144:147], a[164:167], v[216:219], v[144:147]
  ds_read_b128 v[188:191], v18 offset:14336
  s_waitcnt lgkmcnt(8)
  v_mfma_f32_16x16x32_bf16 v[148:151], a[156:159], v[220:223], v[148:151]
  v_mfma_f32_16x16x32_bf16 v[152:155], a[160:163], v[220:223], v[152:155]
  v_mfma_f32_16x16x32_bf16 v[156:159], a[164:167], v[220:223], v[156:159]
  ds_read_b128 v[192:195], v19 offset:0
  s_waitcnt lgkmcnt(8)
  v_mfma_f32_16x16x32_bf16 v[64:67], a[168:171], v[160:163], v[64:67]
  v_mfma_f32_16x16x32_bf16 v[68:71], a[172:175], v[160:163], v[68:71]
  v_mfma_f32_16x16x32_bf16 v[72:75], a[176:179], v[160:163], v[72:75]
  ds_read_b128 v[196:199], v19 offset:2048
  s_waitcnt lgkmcnt(8)
  v_mfma_f32_16x16x32_bf16 v[76:79], a[168:171], v[164:167], v[76:79]
  v_mfma_f32_16x16x32_bf16 v[80:83], a[172:175], v[164:167], v[80:83]
  v_mfma_f32_16x16x32_bf16 v[84:87], a[176:179], v[164:167], v[84:87]
  s_add_u32 s46, s46, 10240
  s_add_u32 m0, s47, 2048
  s_nop 0
  buffer_load_dwordx4 v10, s[8:11], s46 offen lds
  ds_read_b128 v[200:203], v19 offset:4096
  s_waitcnt lgkmcnt(8)
  v_mfma_f32_16x16x32_bf16 v[88:91], a[168:171], v[168:171], v[88:91]
  v_mfma_f32_16x16x32_bf16 v[92:95], a[172:175], v[168:171], v[92:95]
  v_mfma_f32_16x16x32_bf16 v[96:99], a[176:179], v[168:171], v[96:99]
  ds_read_b128 v[204:207], v19 offset:6144
  s_waitcnt lgkmcnt(8)
  v_mfma_f32_16x16x32_bf16 v[100:103], a[168:171], v[172:175], v[100:103]
  v_mfma_f32_16x16x32_bf16 v[104:107], a[172:175], v[172:175], v[104:107]
  v_mfma_f32_16x16x32_bf16 v[108:111], a[176:179], v[172:175], v[108:111]
  ds_read_b128 v[208:211], v19 offset:8192
  s_waitcnt lgkmcnt(8)
  v_mfma_f32_16x16x32_bf16 v[112:115], a[168:171], v[176:179], v[112:115]
  v_mfma_f32_16x16x32_bf16 v[116:119], a[172:175], v[176:179], v[116:119]
  v_mfma_f32_16x16x32_bf16 v[120:123], a[176:179], v[176:179], v[120:123]
  ds_read_b128 v[212:215], v19 offset:10240
  s_waitcnt lgkmcnt(8)
  v_mfma_f32_16x16x32_bf16 v[124:127], a[168:171], v[180:183], v[124:127]
  v_mfma_f32_16x16x32_bf16 v[128:131], a[172:175], v[180:183], v[128:131]
  v_mfma_f32_16x16x32_bf16 v[132:135], a[176:179], v[180:183], v[132:135]
  s_add_u32 s46, s46, 10240
  s_add_u32 m0, s47, 3072
  s_nop 0
  buffer_load_dwordx4 v10, s[8:11], s46 offen lds
  ds_read_b128 v[216:219], v19 offset:12288
  s_waitcnt lgkmcnt(8)
  v_mfma_f32_16x16x32_bf16 v[136:139], a[168:171], v[184:187], v[136:139]
  v_mfma_f32_16x16x32_bf16 v[140:143], a[172:175], v[184:187], v[140:143]
  v_mfma_f32_16x16x32_bf16 v[144:147], a[176:179], v[184:187], v[144:147]
  ds_read_b128 v[220:223], v19 offset:14336
  s_waitcnt lgkmcnt(8)
  v_mfma_f32_16x16x32_bf16 v[148:151], a[168:171], v[188:191], v[148:151]
  v_mfma_f32_16x16x32_bf16 v[152:155], a[172:175], v[188:191], v[152:155]
  v_mfma_f32_16x16x32_bf16 v[156:159], a[176:179], v[188:191], v[156:159]
  s_waitcnt vmcnt(12)
  s_barrier
  s_add_u32 s30, s30, 128
  s_add_u32 s31, s31, 1
  s_cmp_lt_u32 s31, 10
  s_cbranch_scc1 qb_223
  s_mov_b32 s31, 0
  s_add_u32 s30, s30, s25
  s_sub_u32 s30, s30, 1280
qb_223:
  s_add_u32 s32, s32, 16384
  s_cmp_lt_u32 s32, 98304
  s_cselect_b32 s32, s32, 0
  s_mul_i32 s46, s20, 40960
  s_add_u32 s46, s46, s30
  s_lshl_b32 s47, s20, 12
  s_add_u32 s47, s47, s32
  v_add_u32 v18, s33, v14
  v_add_u32 v19, s33, v15
  s_add_u32 s33, s33, 16384
  s_cmp_lt_u32 s33, 98304
  s_cselect_b32 s33, s33, 0
  ds_read_b128 v[160:163], v18 offset:0
  s_waitcnt lgkmcnt(8)
  v_mfma_f32_16x16x32_bf16 v[64:67], a[180:183], v[192:195], v[64:67]
  v_mfma_f32_16x16x32_bf16 v[68:71], a[184:187], v[192:195], v[68:71]
  v_mfma_f32_16x16x32_bf16 v[72:75], a[188:191], v[192:195], v[72:75]
  ds_read_b128 v[164:167], v18 offset:2048
  s_waitcnt lgkmcnt(8)
  v_mfma_f32_16x16x32_bf16 v[76:79], a[180:183], v[196:199], v[76:79]
  v_mfma_f32_16x16x32_bf16 v[80:83], a[184:187], v[196:199], v[80:83]
  v_mfma_f32_16x16x32_bf16 v[84:87], a[188:191], v[196:199], v[84:87]
  s_add_u32 m0, s47, 0
  s_nop 0
  buffer_load_dwordx4 v10, s[8:11], s46 offen lds
  ds_read_b128 v[168:171], v18 offset:4096
  s_waitcnt lgkmcnt(8)
  v_mfma_f32_16x16x32_bf16 v[88:91], a[180:183], v[200:203], v[88:91]
  v_mfma_f32_16x16x32_bf16 v[92:95], a[184:187], v[200:203], v[92:95]
  v_mfma_f32_16x16x32_bf16 v[96:99], a[188:191], v[200:203], v[96:99]
  ds_read_b128 v[172:175], v18 offset:6144
  s_waitcnt lgkmcnt(8)
  v_mfma_f32_16x16x32_bf16 v[100:103], a[180:183], v[204:207], v[100:103]
  v_mfma_f32_16x16x32_bf16 v[104:107], a[184:187], v[204:207], v[104:107]
  v_mfma_f32_16x16x32_bf16 v[108:111], a[188:191], v[204:207], v[108:111]
  ds_read_b128 v[176:179], v18 offset:8192
  s_waitcnt lgkmcnt(8)
  v_mfma_f32_16x16x32_bf16 v[112:115], a[180:183], v[208:211], v[112:115]
  v_mfma_f32_16x16x32_bf16 v[116:119], a[184:187], v[208:211], v[116:119]
  v_mfma_f32_16x16x32_bf16 v[120:123], a[188:191], v[208:211], v[120:123]
  ds_read_b128 v[180:183], v18 offset:10240
  s_waitcnt lgkmcnt(8)
  v_mfma_f32_16x16x32_bf16 v[124:127], a[180:183], v[212:215], v[124:127]
  v_mfma_f32_16x16x32_bf16 v[128:131], a[184:187], v[212:215], v[128:131]
  v_mfma_f32_16x16x32_bf16 v[132:135], a[188:191], v[212:215], v[132:135]
  s_add_u32 s46, s46, 10240
  s_add_u32 m0, s47, 1024
  s_nop 0
  buffer_load_dwordx4 v10, s[8:11], s46 offen lds
  ds_read_b128 v[184:187], v18 offset:12288
  s_waitcnt lgkmcnt(8)
  v_mfma_f32_16x16x32_bf16 v[136:139], a[180:183], v[216:219], v[136:139]
  v_mfma_f32_16x16x32_bf16 v[140:143], a[184:187], v[216:219], v[140:143]
  v_mfma_f32_16x16x32_bf16 v[144:147], a[188:191], v[216:219], v[144:147]
  ds_read_b128 v[188:191], v18 offset:14336
  s_waitcnt lgkmcnt(8)
  v_mfma_f32_16x16x32_bf16 v[148:151], a[180:183], v[220:223], v[148:151]
  v_mfma_f32_16x16x32_bf16 v[152:155], a[184:187], v[220:223], v[152:155]
  v_mfma_f32_16x16x32_bf16 v[156:159], a[188:191], v[220:223], v[156:159]
  ds_read_b128 v[192:195], v19 offset:0
  s_waitcnt lgkmcnt(8)
  v_mfma_f32_16x16x32_bf16 v[64:67], a[192:195], v[160:163], v[64:67]
  v_mfma_f32_16x16x32_bf16 v[68:71], a[196:199], v[160:163], v[68:71]
  v_mfma_f32_16x16x32_bf16 v[72:75], a[200:203], v[160:163], v[72:75]
  ds_read_b128 v[196:199], v19 offset:2048
  s_waitcnt lgkmcnt(8)
  v_mfma_f32_16x16x32_bf16 v[76:79], a[192:195], v[164:167], v[76:79]
  v_mfma_f32_16x16x32_bf16 v[80:83], a[196:199], v[164:167], v[80:83]
  v_mfma_f32_16x16x32_bf16 v[84:87], a[200:203], v[164:167], v[84:87]
  s_add_u32 s46, s46, 10240
  s_add_u32 m0, s47, 2048
  s_nop 0
  buffer_load_dwordx4 v10, s[8:11], s46 offen lds
  ds_read_b128 v[200:203], v19 offset:4096
  s_waitcnt lgkmcnt(8)
  v_mfma_f32_16x16x32_bf16 v[88:91], a[192:195], v[168:171], v[88:91]
  v_mfma_f32_16x16x32_bf16 v[92:95], a[196:199], v[168:171], v[92:95]
  v_mfma_f32_16x16x32_bf16 v[96:99], a[200:203], v[168:171], v[96:99]
  ds_read_b128 v[204:207], v19 offset:6144
  s_waitcnt lgkmcnt(8)
  v_mfma_f32_16x16x32_bf16 v[100:103], a[192:195], v[172:175], v[100:103]
  v_mfma_f32_16x16x32_bf16 v[104:107], a[196:199], v[172:175], v[104:107]
  v_mfma_f32_16x16x32_bf16 v[108:111], a[200:203], v[172:175], v[108:111]
  ds_read_b128 v[208:211], v19 offset:8192
  s_waitcnt lgkmcnt(8)
  v_mfma_f32_16x16x32_bf16 v[112:115], a[192:195], v[176:179], v[112:115]
  v_mfma_f32_16x16x32_bf16 v[116:119], a[196:199], v[176:179], v[116:119]
  v_mfma_f32_16x16x32_bf16 v[120:123], a[200:203], v[176:179], v[120:123]
  ds_read_b128 v[212:215], v19 offset:10240
  s_waitcnt lgkmcnt(8)
  v_mfma_f32_16x16x32_bf16 v[124:127], a[192:195], v[180:183], v[124:127]
  v_mfma_f32_16x16x32_bf16 v[128:131], a[196:199], v[180:183], v[128:131]
  v_mfma_f32_16x16x32_bf16 v[132:135], a[200:203], v[180:183], v[132:135]
  s_add_u32 s46, s46, 10240
  s_add_u32 m0, s47, 3072
  s_nop 0
  buffer_load_dwordx4 v10, s[8:11], s46 offen lds
  ds_read_b128 v[216:219], v19 offset:12288
  s_waitcnt lgkmcnt(8)
  v_mfma_f32_16x16x32_bf16 v[136:139], a[192:195], v[184:187], v[136:139]
  v_mfma_f32_16x16x32_bf16 v[140:143], a[196:199], v[184:187], v[140:143]
  v_mfma_f32_16x16x32_bf16 v[144:147], a[200:203], v[184:187], v[144:147]
  ds_read_b128 v[220:223], v19 offset:14336
  s_waitcnt lgkmcnt(8)
  v_mfma_f32_16x16x32_bf16 v[148:151], a[192:195], v[188:191], v[148:151]
  v_mfma_f32_16x16x32_bf16 v[152:155], a[196:199], v[188:191], v[152:155]
  v_mfma_f32_16x16x32_bf16 v[156:159], a[200:203], v[188:191], v[156:159]
  s_waitcnt vmcnt(12)
  s_barrier
  s_add_u32 s30, s30, 128
  s_add_u32 s31, s31, 1
  s_cmp_lt_u32 s31, 10
  s_cbranch_scc1 qb_224
  s_mov_b32 s31, 0
  s_add_u32 s30, s30, s25
  s_sub_u32 s30, s30, 1280
qb_224:
  s_add_u32 s32, s32, 16384
  s_cmp_lt_u32 s32, 98304
  s_cselect_b32 s32, s32, 0
  s_mul_i32 s46, s20, 40960
  s_add_u32 s46, s46, s30
  s_lshl_b32 s47, s20, 12
  s_add_u32 s47, s47, s32
  v_add_u32 v18, s33, v14
  v_add_u32 v19, s33, v15
  s_add_u32 s33, s33, 16384
  s_cmp_lt_u32 s33, 98304
  s_cselect_b32 s33, s33, 0
  ds_read_b128 v[160:163], v18 offset:0
  s_waitcnt lgkmcnt(8)
  v_mfma_f32_16x16x32_bf16 v[64:67], a[204:207], v[192:195], v[64:67]
  v_mfma_f32_16x16x32_bf16 v[68:71], a[208:211], v[192:195], v[68:71]
  v_mfma_f32_16x16x32_bf16 v[72:75], a[212:215], v[192:195], v[72:75]
  ds_read_b128 v[164:167], v18 offset:2048
  s_waitcnt lgkmcnt(8)
  v_mfma_f32_16x16x32_bf16 v[76:79], a[204:207], v[196:199], v[76:79]
  v_mfma_f32_16x16x32_bf16 v[80:83], a[208:211], v[196:199], v[80:83]
  v_mfma_f32_16x16x32_bf16 v[84:87], a[212:215], v[196:199], v[84:87]
  s_add_u32 m0, s47, 0
  s_nop 0
  buffer_load_dwordx4 v10, s[8:11], s46 offen lds
  ds_read_b128 v[168:171], v18 offset:4096
  s_waitcnt lgkmcnt(8)
  v_mfma_f32_16x16x32_bf16 v[88:91], a[204:207], v[200:203], v[88:91]
  v_mfma_f32_16x16x32_bf16 v[92:95], a[208:211], v[200:203], v[92:95]
  v_mfma_f32_16x16x32_bf16 v[96:99], a[212:215], v[200:203], v[96:99]
  ds_read_b128 v[172:175], v18 offset:6144
  s_waitcnt lgkmcnt(8)
  v_mfma_f32_16x16x32_bf16 v[100:103], a[204:207], v[204:207], v[100:103]
  v_mfma_f32_16x16x32_bf16 v[104:107], a[208:211], v[204:207], v[104:107]
  v_mfma_f32_16x16x32_bf16 v[108:111], a[212:215], v[204:207], v[108:111]
  ds_read_b128 v[176:179], v18 offset:8192
  s_waitcnt lgkmcnt(8)
  v_mfma_f32_16x16x32_bf16 v[112:115], a[204:207], v[208:211], v[112:115]
  v_mfma_f32_16x16x32_bf16 v[116:119], a[208:211], v[208:211], v[116:119]
  v_mfma_f32_16x16x32_bf16 v[120:123], a[212:215], v[208:211], v[120:123]
  ds_read_b128 v[180:183], v18 offset:10240
  s_waitcnt lgkmcnt(8)
  v_mfma_f32_16x16x32_bf16 v[124:127], a[204:207], v[212:215], v[124:127]
  v_mfma_f32_16x16x32_bf16 v[128:131], a[208:211], v[212:215], v[128:131]
  v_mfma_f32_16x16x32_bf16 v[132:135], a[212:215], v[212:215], v[132:135]
  s_add_u32 s46, s46, 10240
  s_add_u32 m0, s47, 1024
  s_nop 0
  buffer_load_dwordx4 v10, s[8:11], s46 offen lds
  ds_read_b128 v[184:187], v18 offset:12288
  s_waitcnt lgkmcnt(8)
  v_mfma_f32_16x16x32_bf16 v[136:139], a[204:207], v[216:219], v[136:139]
  v_mfma_f32_16x16x32_bf16 v[140:143], a[208:211], v[216:219], v[140:143]
  v_mfma_f32_16x16x32_bf16 v[144:147], a[212:215], v[216:219], v[144:147]
  ds_read_b128 v[188:191], v18 offset:14336
  s_waitcnt lgkmcnt(8)
  v_mfma_f32_16x16x32_bf16 v[148:151], a[204:207], v[220:223], v[148:151]
  v_mfma_f32_16x16x32_bf16 v[152:155], a[208:211], v[220:223], v[152:155]
  v_mfma_f32_16x16x32_bf16 v[156:159], a[212:215], v[220:223], v[156:159]
  ds_read_b128 v[192:195], v19 offset:0
  s_waitcnt lgkmcnt(8)
  v_mfma_f32_16x16x32_bf16 v[64:67], a[216:219], v[160:163], v[64:67]
  v_mfma_f32_16x16x32_bf16 v[68:71], a[220:223], v[160:163], v[68:71]
  v_mfma_f32_16x16x32_bf16 v[72:75], a[224:227], v[160:163], v[72:75]
  ds_read_b128 v[196:199], v19 offset:2048
  s_waitcnt lgkmcnt(8)
  v_mfma_f32_16x16x32_bf16 v[76:79], a[216:219], v[164:167], v[76:79]
  v_mfma_f32_16x16x32_bf16 v[80:83], a[220:223], v[164:167], v[80:83]
  v_mfma_f32_16x16x32_bf16 v[84:87], a[224:227], v[164:167], v[84:87]
  s_add_u32 s46, s46, 10240
  s_add_u32 m0, s47, 2048
  s_nop 0
  buffer_load_dwordx4 v10, s[8:11], s46 offen lds
  ds_read_b128 v[200:203], v19 offset:4096
  s_waitcnt lgkmcnt(8)
  v_mfma_f32_16x16x32_bf16 v[88:91], a[216:219], v[168:171], v[88:91]
  v_mfma_f32_16x16x32_bf16 v[92:95], a[220:223], v[168:171], v[92:95]
  v_mfma_f32_16x16x32_bf16 v[96:99], a[224:227], v[168:171], v[96:99]
  ds_read_b128 v[204:207], v19 offset:6144
  s_waitcnt lgkmcnt(8)
  v_mfma_f32_16x16x32_bf16 v[100:103], a[216:219], v[172:175], v[100:103]
  v_mfma_f32_16x16x32_bf16 v[104:107], a[220:223], v[172:175], v[104:107]
  v_mfma_f32_16x16x32_bf16 v[108:111], a[224:227], v[172:175], v[108:111]
  ds_read_b128 v[208:211], v19 offset:8192
  s_waitcnt lgkmcnt(8)
  v_mfma_f32_16x16x32_bf16 v[112:115], a[216:219], v[176:179], v[112:115]
  v_mfma_f32_16x16x32_bf16 v[116:119], a[220:223], v[176:179], v[116:119]
  v_mfma_f32_16x16x32_bf16 v[120:123], a[224:227], v[176:179], v[120:123]
  ds_read_b128 v[212:215], v19 offset:10240
  s_waitcnt lgkmcnt(8)
  v_mfma_f32_16x16x32_bf16 v[124:127], a[216:219], v[180:183], v[124:127]
  v_mfma_f32_16x16x32_bf16 v[128:131], a[220:223], v[180:183], v[128:131]
  v_mfma_f32_16x16x32_bf16 v[132:135], a[224:227], v[180:183], v[132:135]
  s_add_u32 s46, s46, 10240
  s_add_u32 m0, s47, 3072
  s_nop 0
  buffer_load_dwordx4 v10, s[8:11], s46 offen lds
  ds_read_b128 v[216:219], v19 offset:12288
  s_waitcnt lgkmcnt(8)
  v_mfma_f32_16x16x32_bf16 v[136:139], a[216:219], v[184:187], v[136:139]
  v_mfma_f32_16x16x32_bf16 v[140:143], a[220:223], v[184:187], v[140:143]
  v_mfma_f32_16x16x32_bf16 v[144:147], a[224:227], v[184:187], v[144:147]
  ds_read_b128 v[220:223], v19 offset:14336
  s_waitcnt lgkmcnt(8)
  v_mfma_f32_16x16x32_bf16 v[148:151], a[216:219], v[188:191], v[148:151]
  v_mfma_f32_16x16x32_bf16 v[152:155], a[220:223], v[188:191], v[152:155]
  v_mfma_f32_16x16x32_bf16 v[156:159], a[224:227], v[188:191], v[156:159]
  s_waitcnt vmcnt(12)
  s_barrier
  s_add_u32 s30, s30, 128
  s_add_u32 s31, s31, 1
  s_cmp_lt_u32 s31, 10
  s_cbranch_scc1 qb_225
  s_mov_b32 s31, 0
  s_add_u32 s30, s30, s25
  s_sub_u32 s30, s30, 1280
qb_225:
  s_add_u32 s32, s32, 16384
  s_cmp_lt_u32 s32, 98304
  s_cselect_b32 s32, s32, 0
  s_mul_i32 s46, s20, 40960
  s_add_u32 s46, s46, s30
  s_lshl_b32 s47, s20, 12
  s_add_u32 s47, s47, s32
  v_add_u32 v18, s33, v14
  v_add_u32 v19, s33, v15
  s_add_u32 s33, s33, 16384
  s_cmp_lt_u32 s33, 98304
  s_cselect_b32 s33, s33, 0
  ds_read_b128 v[160:163], v18 offset:0
  s_waitcnt lgkmcnt(8)
  v_mfma_f32_16x16x32_bf16 v[64:67], a[228:231], v[192:195], v[64:67]
  v_mfma_f32_16x16x32_bf16 v[68:71], a[232:235], v[192:195], v[68:71]
  v_mfma_f32_16x16x32_bf16 v[72:75], a[236:239], v[192:195], v[72:75]
  ds_read_b128 v[164:167], v18 offset:2048
  s_waitcnt lgkmcnt(8)
  v_mfma_f32_16x16x32_bf16 v[76:79], a[228:231], v[196:199], v[76:79]
  v_mfma_f32_16x16x32_bf16 v[80:83], a[232:235], v[196:199], v[80:83]
  v_mfma_f32_16x16x32_bf16 v[84:87], a[236:239], v[196:199], v[84:87]
  s_add_u32 m0, s47, 0
  s_nop 0
  buffer_load_dwordx4 v10, s[8:11], s46 offen lds
  ds_read_b128 v[168:171], v18 offset:4096
  s_waitcnt lgkmcnt(8)
  v_mfma_f32_16x16x32_bf16 v[88:91], a[228:231], v[200:203], v[88:91]
  v_mfma_f32_16x16x32_bf16 v[92:95], a[232:235], v[200:203], v[92:95]
  v_mfma_f32_16x16x32_bf16 v[96:99], a[236:239], v[200:203], v[96:99]
  ds_read_b128 v[172:175], v18 offset:6144
  s_waitcnt lgkmcnt(8)
  v_mfma_f32_16x16x32_bf16 v[100:103], a[228:231], v[204:207], v[100:103]
  v_mfma_f32_16x16x32_bf16 v[104:107], a[232:235], v[204:207], v[104:107]
  v_mfma_f32_16x16x32_bf16 v[108:111], a[236:239], v[204:207], v[108:111]
  v_cvt_pk_bf16_f32 v224, v64, v65
  v_cvt_pk_bf16_f32 v225, v66, v67
  v_cvt_pk_bf16_f32 v226, v68, v69
  v_cvt_pk_bf16_f32 v227, v70, v71
  v_cvt_pk_bf16_f32 v228, v72, v73
  v_cvt_pk_bf16_f32 v229, v74, v75
  ds_write_b64 v22, v[224:225] offset:0
  ds_write_b64 v22, v[226:227] offset:32
  ds_write_b64 v22, v[228:229] offset:64
  ds_read_b128 v[176:179], v18 offset:8192
  s_waitcnt lgkmcnt(8)
  v_mfma_f32_16x16x32_bf16 v[112:115], a[228:231], v[208:211], v[112:115]
  v_mfma_f32_16x16x32_bf16 v[116:119], a[232:235], v[208:211], v[116:119]
  v_mfma_f32_16x16x32_bf16 v[120:123], a[236:239], v[208:211], v[120:123]
  v_cvt_pk_bf16_f32 v230, v76, v77
  v_cvt_pk_bf16_f32 v231, v78, v79
  v_cvt_pk_bf16_f32 v232, v80, v81
  v_cvt_pk_bf16_f32 v233, v82, v83
  v_cvt_pk_bf16_f32 v234, v84, v85
  v_cvt_pk_bf16_f32 v235, v86, v87
  ds_write_b64 v22, v[230:231] offset:6400
  ds_write_b64 v22, v[232:233] offset:6432
  ds_write_b64 v22, v[234:235] offset:6464
  ds_read_b128 v[180:183], v18 offset:10240
  s_waitcnt lgkmcnt(8)
  v_mfma_f32_16x16x32_bf16 v[124:127], a[228:231], v[212:215], v[124:127]
  v_mfma_f32_16x16x32_bf16 v[128:131], a[232:235], v[212:215], v[128:131]
  v_mfma_f32_16x16x32_bf16 v[132:135], a[236:239], v[212:215], v[132:135]
  s_add_u32 s46, s46, 10240
  s_add_u32 m0, s47, 1024
  s_nop 0
  buffer_load_dwordx4 v10, s[8:11], s46 offen lds
  v_cvt_pk_bf16_f32 v224, v88, v89
  v_cvt_pk_bf16_f32 v225, v90, v91
  v_cvt_pk_bf16_f32 v226, v92, v93
  v_cvt_pk_bf16_f32 v227, v94, v95
  v_cvt_pk_bf16_f32 v228, v96, v97
  v_cvt_pk_bf16_f32 v229, v98, v99
  ds_write_b64 v22, v[224:225] offset:12800
  ds_write_b64 v22, v[226:227] offset:12832
  ds_write_b64 v22, v[228:229] offset:12864
  ds_read_b128 v[184:187], v18 offset:12288
  s_waitcnt lgkmcnt(8)
  v_mfma_f32_16x16x32_bf16 v[136:139], a[228:231], v[216:219], v[136:139]
  v_mfma_f32_16x16x32_bf16 v[140:143], a[232:235], v[216:219], v[140:143]
  v_mfma_f32_16x16x32_bf16 v[144:147], a[236:239], v[216:219], v[144:147]
  v_cvt_pk_bf16_f32 v230, v100, v101
  v_cvt_pk_bf16_f32 v231, v102, v103
  v_cvt_pk_bf16_f32 v232, v104, v105
  v_cvt_pk_bf16_f32 v233, v106, v107
  v_cvt_pk_bf16_f32 v234, v108, v109
  v_cvt_pk_bf16_f32 v235, v110, v111
  ds_write_b64 v22, v[230:231] offset:19200
  ds_write_b64 v22, v[232:233] offset:19232
  ds_write_b64 v22, v[234:235] offset:19264
  ds_read_b128 v[188:191], v18 offset:14336
  s_waitcnt lgkmcnt(8)
  v_mfma_f32_16x16x32_bf16 v[148:151], a[228:231], v[220:223], v[148:151]
  v_mfma_f32_16x16x32_bf16 v[152:155], a[232:235], v[220:223], v[152:155]
  v_mfma_f32_16x16x32_bf16 v[156:159], a[236:239], v[220:223], v[156:159]
  v_cvt_pk_bf16_f32 v224, v112, v113
  v_cvt_pk_bf16_f32 v225, v114, v115
  v_cvt_pk_bf16_f32 v226, v116, v117
  v_cvt_pk_bf16_f32 v227, v118, v119
  v_cvt_pk_bf16_f32 v228, v120, v121
  v_cvt_pk_bf16_f32 v229, v122, v123
  ds_write_b64 v22, v[224:225] offset:25600
  ds_write_b64 v22, v[226:227] offset:25632
  ds_write_b64 v22, v[228:229] offset:25664
  v_cvt_pk_bf16_f32 v230, v124, v125
  v_cvt_pk_bf16_f32 v231, v126, v127
  v_cvt_pk_bf16_f32 v232, v128, v129
  v_cvt_pk_bf16_f32 v233, v130, v131
  v_cvt_pk_bf16_f32 v234, v132, v133
  v_cvt_pk_bf16_f32 v235, v134, v135
  ds_write_b64 v22, v[230:231] offset:32000
  ds_write_b64 v22, v[232:233] offset:32032
  ds_write_b64 v22, v[234:235] offset:32064
  v_cvt_pk_bf16_f32 v224, v136, v137
  v_cvt_pk_bf16_f32 v225, v138, v139
  v_cvt_pk_bf16_f32 v226, v140, v141
  v_cvt_pk_bf16_f32 v227, v142, v143
  v_cvt_pk_bf16_f32 v228, v144, v145
  v_cvt_pk_bf16_f32 v229, v146, v147
  ds_write_b64 v22, v[224:225] offset:38400
  ds_write_b64 v22, v[226:227] offset:38432
  ds_write_b64 v22, v[228:229] offset:38464
  v_cvt_pk_bf16_f32 v230, v148, v149
  v_cvt_pk_bf16_f32 v231, v150, v151
  v_cvt_pk_bf16_f32 v232, v152, v153
  v_cvt_pk_bf16_f32 v233, v154, v155
  v_cvt_pk_bf16_f32 v234, v156, v157
  v_cvt_pk_bf16_f32 v235, v158, v159
  ds_write_b64 v22, v[230:231] offset:44800
  ds_write_b64 v22, v[232:233] offset:44832
  ds_write_b64 v22, v[234:235] offset:44864
  s_mov_b32 s61, s60
  s_add_u32 s60, s60, s63
  s_mul_i32 s48, s20, 122880
  s_add_u32 s48, s48, s27
  s_add_u32 s27, s27, s28
  s_sub_u32 s26, s26, 1
  s_cmp_gt_u32 s26, 0
  s_cbranch_scc1 qb_blk_213
  s_waitcnt vmcnt(0) lgkmcnt(0)
  s_barrier
  ds_read_b128 v[224:227], v23 offset:0
  ds_read_b128 v[228:231], v24 offset:0
  ds_read_b128 v[232:235], v25 offset:0
  ds_read_b128 v[236:239], v23 offset:3200
  ds_read_b128 v[240:243], v24 offset:3200
  ds_read_b128 v[244:247], v25 offset:3200
  s_waitcnt lgkmcnt(0)
  s_add_u32 s21, s48, 0
  buffer_store_dwordx4 v[224:227], v26, s[16:19], s21 offen sc1
  s_add_u32 s21, s48, 0
  buffer_store_dwordx4 v[228:231], v27, s[16:19], s21 offen sc1
  s_add_u32 s21, s48, 0
  buffer_store_dwordx4 v[232:235], v28, s[16:19], s21 offen sc1
  s_add_u32 s21, s48, 30720
  buffer_store_dwordx4 v[236:239], v26, s[16:19], s21 offen sc1
  s_add_u32 s21, s48, 30720
  buffer_store_dwordx4 v[240:243], v27, s[16:19], s21 offen sc1
  s_add_u32 s21, s48, 30720
  buffer_store_dwordx4 v[244:247], v28, s[16:19], s21 offen sc1
  s_nop 1
  ds_read_b128 v[224:227], v23 offset:6400
  ds_read_b128 v[228:231], v24 offset:6400
  ds_read_b128 v[232:235], v25 offset:6400
  ds_read_b128 v[236:239], v23 offset:9600
  ds_read_b128 v[240:243], v24 offset:9600
  ds_read_b128 v[244:247], v25 offset:9600
  s_waitcnt lgkmcnt(0)
  s_add_u32 s21, s48, 61440
  buffer_store_dwordx4 v[224:227], v26, s[16:19], s21 offen sc1
  s_add_u32 s21, s48, 61440
  buffer_store_dwordx4 v[228:231], v27, s[16:19], s21 offen sc1
  s_add_u32 s21, s48, 61440
  buffer_store_dwordx4 v[232:235], v28, s[16:19], s21 offen sc1
  s_add_u32 s21, s48, 92160
  buffer_store_dwordx4 v[236:239], v26, s[16:19], s21 offen sc1
  s_add_u32 s21, s48, 92160
  buffer_store_dwordx4 v[240:243], v27, s[16:19], s21 offen sc1
  s_add_u32 s21, s48, 92160
  buffer_store_dwordx4 v[244:247], v28, s[16:19], s21 offen sc1
  s_nop 1
  s_waitcnt vmcnt(0)
  s_barrier
  s_cmp_lg_u32 s20, 0
  s_cbranch_scc1 af_226
  v_mov_b32 v4, 0
  v_mov_b32 v5, 1
  s_mov_b64 exec, 1
  buffer_atomic_add v5, v4, s[72:75], s61 offen sc1
  s_mov_b64 exec, -1
  s_nop 1
af_226:
  s_barrier
  s_cmp_eq_u32 s64, 1
  s_cbranch_scc1 queue
skip_qb:
  s_sub_u32 s2, s3, 96
  s_load_dwordx2 s[4:5], s[0:1], 0
  s_load_dwordx2 s[6:7], s[0:1], 16
  s_load_dwordx2 s[38:39], s[0:1], 104
  s_mov_b32 s42, s2
  s_waitcnt lgkmcnt(0)
  s_mov_b32 s8, s4
  s_mov_b32 s9, s5
  s_mov_b32 s10, 2621440
  s_mov_b32 s11, 0x00020000
  s_mov_b32 s12, s6
  s_mov_b32 s13, s7
  s_mov_b32 s14, 7864320
  s_mov_b32 s15, 0x00020000
  s_mov_b32 s16, s38
  s_mov_b32 s17, s39
  s_mov_b32 s18, 25165824
  s_mov_b32 s19, 0x00020000
  s_add_u32 s52, s38, 50331648
  s_addc_u32 s53, s39, 0
  s_mov_b32 s54, 6291456
  s_mov_b32 s55, 0x00020000
  s_add_u32 s56, s38, 85983232
  s_addc_u32 s57, s39, 0
  s_mov_b32 s58, 5242880
  s_mov_b32 s59, 0x00020000
  s_add_u32 s72, s38, 81068032
  s_addc_u32 s73, s39, 0
  s_mov_b32 s74, 115712
  s_mov_b32 s75, 0x00020000
  s_mul_i32 s44, s42, 384
  v_mov_b32 v9, 2731
  v_add_u32 v8, 0, v1
  v_mul_u32_u24 v7, v8, v9
  v_lshrrev_b32 v7, 16, v7
  v_mul_u32_u24 v4, 24, v7
  v_sub_u32 v8, v8, v4
  s_mov_b32 s21, 12288
  v_mul_lo_u32 v7, v7, s21
  v_lshl_add_u32 v4, v8, 4, v7
  v_add_u32 v8, 64, v1
  v_mul_u32_u24 v7, v8, v9
  v_lshrrev_b32 v7, 16, v7
  v_mul_u32_u24 v5, 24, v7
  v_sub_u32 v8, v8, v5
  s_mov_b32 s21, 12288
  v_mul_lo_u32 v7, v7, s21
  v_lshl_add_u32 v5, v8, 4, v7
  v_add_u32 v8, 128, v1
  v_mul_u32_u24 v7, v8, v9
  v_lshrrev_b32 v7, 16, v7
  v_mul_u32_u24 v6, 24, v7
  v_sub_u32 v8, v8, v6
  s_mov_b32 s21, 12288
  v_mul_lo_u32 v7, v7, s21
  v_lshl_add_u32 v6, v8, 4, v7
  v_lshrrev_b32 v7, 2, v2
  v_lshl_add_u32 v7, v3, 3, v7
  v_mul_u32_u24 v7, 384, v7
  v_and_b32 v8, 3, v2
  v_lshlrev_b32 v8, 3, v8
  s_mul_i32 s21, s20, 96
  v_add3_u32 v7, v7, v8, s21
  v_add_u32 v8, 61440, v7
  s_mul_i32 s21, s20, 491520
  s_add_u32 s21, s21, 0
  s_add_u32 s21, s21, s44
  s_mul_i32 s22, s20, 15360
  s_add_u32 s22, s22, 0
  s_add_u32 m0, s22, 0
  s_nop 0
  buffer_load_dwordx4 v4, s[12:15], s21 offen lds
  s_add_u32 m0, s22, 1024
  s_nop 0
  buffer_load_dwordx4 v5, s[12:15], s21 offen lds
  s_add_u32 m0, s22, 2048
  s_nop 0
  buffer_load_dwordx4 v6, s[12:15], s21 offen lds
  s_mul_i32 s21, s20, 491520
  s_add_u32 s21, s21, 98304
  s_add_u32 s21, s21, s44
  s_mul_i32 s22, s20, 15360
  s_add_u32 s22, s22, 3072
  s_add_u32 m0, s22, 0
  s_nop 0
  buffer_load_dwordx4 v4, s[12:15], s21 offen lds
  s_add_u32 m0, s22, 1024
  s_nop 0
  buffer_load_dwordx4 v5, s[12:15], s21 offen lds
  s_add_u32 m0, s22, 2048
  s_nop 0
  buffer_load_dwordx4 v6, s[12:15], s21 offen lds
  s_mul_i32 s21, s20, 491520
  s_add_u32 s21, s21, 196608
  s_add_u32 s21, s21, s44
  s_mul_i32 s22, s20, 15360
  s_add_u32 s22, s22, 6144
  s_add_u32 m0, s22, 0
  s_nop 0
  buffer_load_dwordx4 v4, s[12:15], s21 offen lds
  s_add_u32 m0, s22, 1024
  s_nop 0
  buffer_load_dwordx4 v5, s[12:15], s21 offen lds
  s_add_u32 m0, s22, 2048
  s_nop 0
  buffer_load_dwordx4 v6, s[12:15], s21 offen lds
  s_mul_i32 s21, s20, 491520
  s_add_u32 s21, s21, 294912
  s_add_u32 s21, s21, s44
  s_mul_i32 s22, s20, 15360
  s_add_u32 s22, s22, 9216
  s_add_u32 m0, s22, 0
  s_nop 0
  buffer_load_dwordx4 v4, s[12:15], s21 offen lds
  s_add_u32 m0, s22, 1024
  s_nop 0
  buffer_load_dwordx4 v5, s[12:15], s21 offen lds
  s_add_u32 m0, s22, 2048
  s_nop 0
  buffer_load_dwordx4 v6, s[12:15], s21 offen lds
  s_mul_i32 s21, s20, 491520
  s_add_u32 s21, s21, 393216
  s_add_u32 s21, s21, s44
  s_mul_i32 s22, s20, 15360
  s_add_u32 s22, s22, 12288
  s_add_u32 m0, s22, 0
  s_nop 0
  buffer_load_dwordx4 v4, s[12:15], s21 offen lds
  s_add_u32 m0, s22, 1024
  s_nop 0
  buffer_load_dwordx4 v5, s[12:15], s21 offen lds
  s_add_u32 m0, s22, 2048
  s_nop 0
  buffer_load_dwordx4 v6, s[12:15], s21 offen lds
  s_mul_i32 s21, s20, 491520
  s_add_u32 s21, s21, 1966080
  s_add_u32 s21, s21, s44
  s_mul_i32 s22, s20, 15360
  s_add_u32 s22, s22, 61440
  s_add_u32 m0, s22, 0
  s_nop 0
  buffer_load_dwordx4 v4, s[12:15], s21 offen lds
  s_add_u32 m0, s22, 1024
  s_nop 0
  buffer_load_dwordx4 v5, s[12:15], s21 offen lds
  s_add_u32 m0, s22, 2048
  s_nop 0
  buffer_load_dwordx4 v6, s[12:15], s21 offen lds
  s_mul_i32 s21, s20, 491520
  s_add_u32 s21, s21, 2064384
  s_add_u32 s21, s21, s44
  s_mul_i32 s22, s20, 15360
  s_add_u32 s22, s22, 64512
  s_add_u32 m0, s22, 0
  s_nop 0
  buffer_load_dwordx4 v4, s[12:15], s21 offen lds
  s_add_u32 m0, s22, 1024
  s_nop 0
  buffer_load_dwordx4 v5, s[12:15], s21 offen lds
  s_add_u32 m0, s22, 2048
  s_nop 0
  buffer_load_dwordx4 v6, s[12:15], s21 offen lds
  s_mul_i32 s21, s20, 491520
  s_add_u32 s21, s21, 2162688
  s_add_u32 s21, s21, s44
  s_mul_i32 s22, s20, 15360
  s_add_u32 s22, s22, 67584
  s_add_u32 m0, s22, 0
  s_nop 0
  buffer_load_dwordx4 v4, s[12:15], s21 offen lds
  s_add_u32 m0, s22, 1024
  s_nop 0
  buffer_load_dwordx4 v5, s[12:15], s21 offen lds
  s_add_u32 m0, s22, 2048
  s_nop 0
  buffer_load_dwordx4 v6, s[12:15], s21 offen lds
  s_mul_i32 s21, s20, 491520
  s_add_u32 s21, s21, 2260992
  s_add_u32 s21, s21, s44
  s_mul_i32 s22, s20, 15360
  s_add_u32 s22, s22, 70656
  s_add_u32 m0, s22, 0
  s_nop 0
  buffer_load_dwordx4 v4, s[12:15], s21 offen lds
  s_add_u32 m0, s22, 1024
  s_nop 0
  buffer_load_dwordx4 v5, s[12:15], s21 offen lds
  s_add_u32 m0, s22, 2048
  s_nop 0
  buffer_load_dwordx4 v6, s[12:15], s21 offen lds
  s_mul_i32 s21, s20, 491520
  s_add_u32 s21, s21, 2359296
  s_add_u32 s21, s21, s44
  s_mul_i32 s22, s20, 15360
  s_add_u32 s22, s22, 73728
  s_add_u32 m0, s22, 0
  s_nop 0
  buffer_load_dwordx4 v4, s[12:15], s21 offen lds
  s_add_u32 m0, s22, 1024
  s_nop 0
  buffer_load_dwordx4 v5, s[12:15], s21 offen lds
  s_add_u32 m0, s22, 2048
  s_nop 0
  buffer_load_dwordx4 v6, s[12:15], s21 offen lds
  s_mul_i32 s21, s20, 491520
  s_add_u32 s21, s21, 3932160
  s_add_u32 s21, s21, s44
  buffer_load_dwordx4 v[64:67], v4, s[12:15], s21 offen
  buffer_load_dwordx4 v[68:71], v5, s[12:15], s21 offen
  buffer_load_dwordx4 v[72:75], v6, s[12:15], s21 offen
  s_mul_i32 s21, s20, 491520
  s_add_u32 s21, s21, 4030464
  s_add_u32 s21, s21, s44
  buffer_load_dwordx4 v[76:79], v4, s[12:15], s21 offen
  buffer_load_dwordx4 v[80:83], v5, s[12:15], s21 offen
  buffer_load_dwordx4 v[84:87], v6, s[12:15], s21 offen
  s_mul_i32 s21, s20, 491520
  s_add_u32 s21, s21, 4128768
  s_add_u32 s21, s21, s44
  buffer_load_dwordx4 v[88:91], v4, s[12:15], s21 offen
  buffer_load_dwordx4 v[92:95], v5, s[12:15], s21 offen
  buffer_load_dwordx4 v[96:99], v6, s[12:15], s21 offen
  s_mul_i32 s21, s20, 491520
  s_add_u32 s21, s21, 4227072
  s_add_u32 s21, s21, s44
  buffer_load_dwordx4 v[100:103], v4, s[12:15], s21 offen
  buffer_load_dwordx4 v[104:107], v5, s[12:15], s21 offen
  buffer_load_dwordx4 v[108:111], v6, s[12:15], s21 offen
  s_mul_i32 s21, s20, 491520
  s_add_u32 s21, s21, 4325376
  s_add_u32 s21, s21, s44
  buffer_load_dwordx4 v[112:115], v4, s[12:15], s21 offen
  buffer_load_dwordx4 v[116:119], v5, s[12:15], s21 offen
  buffer_load_dwordx4 v[120:123], v6, s[12:15], s21 offen
  s_mul_i32 s21, s20, 491520
  s_add_u32 s21, s21, 5898240
  s_add_u32 s21, s21, s44
  buffer_load_dwordx4 v[124:127], v4, s[12:15], s21 offen
  buffer_load_dwordx4 v[128:131], v5, s[12:15], s21 offen
  buffer_load_dwordx4 v[132:135], v6, s[12:15], s21 offen
  s_mul_i32 s21, s20, 491520
  s_add_u32 s21, s21, 5996544
  s_add_u32 s21, s21, s44
  buffer_load_dwordx4 v[136:139], v4, s[12:15], s21 offen
  buffer_load_dwordx4 v[140:143], v5, s[12:15], s21 offen
  buffer_load_dwordx4 v[144:147], v6, s[12:15], s21 offen
  s_mul_i32 s21, s20, 491520
  s_add_u32 s21, s21, 6094848
  s_add_u32 s21, s21, s44
  buffer_load_dwordx4 v[148:151], v4, s[12:15], s21 offen
  buffer_load_dwordx4 v[152:155], v5, s[12:15], s21 offen
  buffer_load_dwordx4 v[156:159], v6, s[12:15], s21 offen
  s_mul_i32 s21, s20, 491520
  s_add_u32 s21, s21, 6193152
  s_add_u32 s21, s21, s44
  buffer_load_dwordx4 v[160:163], v4, s[12:15], s21 offen
  buffer_load_dwordx4 v[164:167], v5, s[12:15], s21 offen
  buffer_load_dwordx4 v[168:171], v6, s[12:15], s21 offen
  s_mul_i32 s21, s20, 491520
  s_add_u32 s21, s21, 6291456
  s_add_u32 s21, s21, s44
  buffer_load_dwordx4 v[172:175], v4, s[12:15], s21 offen
  buffer_load_dwordx4 v[176:179], v5, s[12:15], s21 offen
  buffer_load_dwordx4 v[180:183], v6, s[12:15], s21 offen
  s_mul_i32 s22, s20, 15360
  v_lshl_add_u32 v30, v1, 4, s22
  v_add_u32 v31, 61440, v30
  s_waitcnt vmcnt(45)
  s_barrier
  ds_read_b64_tr_b16 a[0:1], v7 offset:0
  ds_read_b64_tr_b16 a[2:3], v7 offset:1536
  ds_read_b64_tr_b16 a[4:5], v7 offset:32
  ds_read_b64_tr_b16 a[6:7], v7 offset:1568
  ds_read_b64_tr_b16 a[8:9], v7 offset:64
  ds_read_b64_tr_b16 a[10:11], v7 offset:1600
  ds_read_b64_tr_b16 a[12:13], v7 offset:12288
  ds_read_b64_tr_b16 a[14:15], v7 offset:13824
  ds_read_b64_tr_b16 a[16:17], v7 offset:12320
  ds_read_b64_tr_b16 a[18:19], v7 offset:13856
  ds_read_b64_tr_b16 a[20:21], v7 offset:12352
  ds_read_b64_tr_b16 a[22:23], v7 offset:13888
  ds_read_b64_tr_b16 a[24:25], v7 offset:24576
  ds_read_b64_tr_b16 a[26:27], v7 offset:26112
  ds_read_b64_tr_b16 a[28:29], v7 offset:24608
  ds_read_b64_tr_b16 a[30:31], v7 offset:26144
  ds_read_b64_tr_b16 a[32:33], v7 offset:24640
  ds_read_b64_tr_b16 a[34:35], v7 offset:26176
  ds_read_b64_tr_b16 a[36:37], v7 offset:36864
  ds_read_b64_tr_b16 a[38:39], v7 offset:38400
  ds_read_b64_tr_b16 a[40:41], v7 offset:36896
  ds_read_b64_tr_b16 a[42:43], v7 offset:38432
  ds_read_b64_tr_b16 a[44:45], v7 offset:36928
  ds_read_b64_tr_b16 a[46:47], v7 offset:38464
  ds_read_b64_tr_b16 a[48:49], v7 offset:49152
  ds_read_b64_tr_b16 a[50:51], v7 offset:50688
  ds_read_b64_tr_b16 a[52:53], v7 offset:49184
  ds_read_b64_tr_b16 a[54:55], v7 offset:50720
  ds_read_b64_tr_b16 a[56:57], v7 offset:49216
  ds_read_b64_tr_b16 a[58:59], v7 offset:50752
  s_waitcnt lgkmcnt(0)
  s_barrier
  s_waitcnt vmcnt(30)
  s_barrier
  ds_read_b64_tr_b16 a[60:61], v8 offset:0
  ds_read_b64_tr_b16 a[62:63], v8 offset:1536
  ds_read_b64_tr_b16 a[64:65], v8 offset:32
  ds_read_b64_tr_b16 a[66:67], v8 offset:1568
  ds_read_b64_tr_b16 a[68:69], v8 offset:64
  ds_read_b64_tr_b16 a[70:71], v8 offset:1600
  ds_read_b64_tr_b16 a[72:73], v8 offset:12288
  ds_read_b64_tr_b16 a[74:75], v8 offset:13824
  ds_read_b64_tr_b16 a[76:77], v8 offset:12320
  ds_read_b64_tr_b16 a[78:79], v8 offset:13856
  ds_read_b64_tr_b16 a[80:81], v8 offset:12352
  ds_read_b64_tr_b16 a[82:83], v8 offset:13888
  ds_read_b64_tr_b16 a[84:85], v8 offset:24576
  ds_read_b64_tr_b16 a[86:87], v8 offset:26112
  ds_read_b64_tr_b16 a[88:89], v8 offset:24608
  ds_read_b64_tr_b16 a[90:91], v8 offset:26144
  ds_read_b64_tr_b16 a[92:93], v8 offset:24640
  ds_read_b64_tr_b16 a[94:95], v8 offset:26176
  ds_read_b64_tr_b16 a[96:97], v8 offset:36864
  ds_read_b64_tr_b16 a[98:99], v8 offset:38400
  ds_read_b64_tr_b16 a[100:101], v8 offset:36896
  ds_read_b64_tr_b16 a[102:103], v8 offset:38432
  ds_read_b64_tr_b16 a[104:105], v8 offset:36928
  ds_read_b64_tr_b16 a[106:107], v8 offset:38464
  ds_read_b64_tr_b16 a[108:109], v8 offset:49152
  ds_read_b64_tr_b16 a[110:111], v8 offset:50688
  ds_read_b64_tr_b16 a[112:113], v8 offset:49184
  ds_read_b64_tr_b16 a[114:115], v8 offset:50720
  ds_read_b64_tr_b16 a[116:117], v8 offset:49216
  ds_read_b64_tr_b16 a[118:119], v8 offset:50752
  s_waitcnt lgkmcnt(0)
  s_barrier
  s_waitcnt vmcnt(15)
  ds_write_b128 v30, v[64:67] offset:0
  ds_write_b128 v30, v[68:71] offset:1024
  ds_write_b128 v30, v[72:75] offset:2048
  ds_write_b128 v30, v[76:79] offset:3072
  ds_write_b128 v30, v[80:83] offset:4096
  ds_write_b128 v30, v[84:87] offset:5120
  ds_write_b128 v30, v[88:91] offset:6144
  ds_write_b128 v30, v[92:95] offset:7168
  ds_write_b128 v30, v[96:99] offset:8192
  ds_write_b128 v30, v[100:103] offset:9216
  ds_write_b128 v30, v[104:107] offset:10240
  ds_write_b128 v30, v[108:111] offset:11264
  ds_write_b128 v30, v[112:115] offset:12288
  ds_write_b128 v30, v[116:119] offset:13312
  ds_write_b128 v30, v[120:123] offset:14336
  s_waitcnt lgkmcnt(0)
  s_barrier
  ds_read_b64_tr_b16 a[120:121], v7 offset:0
  ds_read_b64_tr_b16 a[122:123], v7 offset:1536
  ds_read_b64_tr_b16 a[124:125], v7 offset:32
  ds_read_b64_tr_b16 a[126:127], v7 offset:1568
  ds_read_b64_tr_b16 a[128:129], v7 offset:64
  ds_read_b64_tr_b16 a[130:131], v7 offset:1600
  ds_read_b64_tr_b16 a[132:133], v7 offset:12288
  ds_read_b64_tr_b16 a[134:135], v7 offset:13824
  ds_read_b64_tr_b16 a[136:137], v7 offset:12320
  ds_read_b64_tr_b16 a[138:139], v7 offset:13856
  ds_read_b64_tr_b16 a[140:141], v7 offset:12352
  ds_read_b64_tr_b16 a[142:143], v7 offset:13888
  ds_read_b64_tr_b16 a[144:145], v7 offset:24576
  ds_read_b64_tr_b16 a[146:147], v7 offset:26112
  ds_read_b64_tr_b16 a[148:149], v7 offset:24608
  ds_read_b64_tr_b16 a[150:151], v7 offset:26144
  ds_read_b64_tr_b16 a[152:153], v7 offset:24640
  ds_read_b64_tr_b16 a[154:155], v7 offset:26176
  ds_read_b64_tr_b16 a[156:157], v7 offset:36864
  ds_read_b64_tr_b16 a[158:159], v7 offset:38400
  ds_read_b64_tr_b16 a[160:161], v7 offset:36896
  ds_read_b64_tr_b16 a[162:163], v7 offset:38432
  ds_read_b64_tr_b16 a[164:165], v7 offset:36928
  ds_read_b64_tr_b16 a[166:167], v7 offset:38464
  ds_read_b64_tr_b16 a[168:169], v7 offset:49152
  ds_read_b64_tr_b16 a[170:171], v7 offset:50688
  ds_read_b64_tr_b16 a[172:173], v7 offset:49184
  ds_read_b64_tr_b16 a[174:175], v7 offset:50720
  ds_read_b64_tr_b16 a[176:177], v7 offset:49216
  ds_read_b64_tr_b16 a[178:179], v7 offset:50752
  s_waitcnt lgkmcnt(0)
  s_barrier
  s_waitcnt vmcnt(0)
  ds_write_b128 v31, v[124:127] offset:0
  ds_write_b128 v31, v[128:131] offset:1024
  ds_write_b128 v31, v[132:135] offset:2048
  ds_write_b128 v31, v[136:139] offset:3072
  ds_write_b128 v31, v[140:143] offset:4096
  ds_write_b128 v31, v[144:147] offset:5120
  ds_write_b128 v31, v[148:151] offset:6144
  ds_write_b128 v31, v[152:155] offset:7168
  ds_write_b128 v31, v[156:159] offset:8192
  ds_write_b128 v31, v[160:163] offset:9216
  ds_write_b128 v31, v[164:167] offset:10240
  ds_write_b128 v31, v[168:171] offset:11264
  ds_write_b128 v31, v[172:175] offset:12288
  ds_write_b128 v31, v[176:179] offset:13312
  ds_write_b128 v31, v[180:183] offset:14336
  s_waitcnt lgkmcnt(0)
  s_barrier
  ds_read_b64_tr_b16 a[180:181], v8 offset:0
  ds_read_b64_tr_b16 a[182:183], v8 offset:1536
  ds_read_b64_tr_b16 a[184:185], v8 offset:32
  ds_read_b64_tr_b16 a[186:187], v8 offset:1568
  ds_read_b64_tr_b16 a[188:189], v8 offset:64
  ds_read_b64_tr_b16 a[190:191], v8 offset:1600
  ds_read_b64_tr_b16 a[192:193], v8 offset:12288
  ds_read_b64_tr_b16 a[194:195], v8 offset:13824
  ds_read_b64_tr_b16 a[196:197], v8 offset:12320
  ds_read_b64_tr_b16 a[198:199], v8 offset:13856
  ds_read_b64_tr_b16 a[200:201], v8 offset:12352
  ds_read_b64_tr_b16 a[202:203], v8 offset:13888
  ds_read_b64_tr_b16 a[204:205], v8 offset:24576
  ds_read_b64_tr_b16 a[206:207], v8 offset:26112
  ds_read_b64_tr_b16 a[208:209], v8 offset:24608
  ds_read_b64_tr_b16 a[210:211], v8 offset:26144
  ds_read_b64_tr_b16 a[212:213], v8 offset:24640
  ds_read_b64_tr_b16 a[214:215], v8 offset:26176
  ds_read_b64_tr_b16 a[216:217], v8 offset:36864
  ds_read_b64_tr_b16 a[218:219], v8 offset:38400
  ds_read_b64_tr_b16 a[220:221], v8 offset:36896
  ds_read_b64_tr_b16 a[222:223], v8 offset:38432
  ds_read_b64_tr_b16 a[224:225], v8 offset:36928
  ds_read_b64_tr_b16 a[226:227], v8 offset:38464
  ds_read_b64_tr_b16 a[228:229], v8 offset:49152
  ds_read_b64_tr_b16 a[230:231], v8 offset:50688
  ds_read_b64_tr_b16 a[232:233], v8 offset:49184
  ds_read_b64_tr_b16 a[234:235], v8 offset:50720
  ds_read_b64_tr_b16 a[236:237], v8 offset:49216
  ds_read_b64_tr_b16 a[238:239], v8 offset:50752
  s_waitcnt lgkmcnt(0)
  s_barrier
  s_mov_b32 s30, 0
  s_mov_b32 s25, 162688
  s_mov_b32 s26, 16
  v_lshrrev_b32 v4, 3, v1
  v_and_b32 v5, 7, v1
  v_xor_b32 v5, v5, v4
  s_mul_i32 s21, s20, 32
  v_add_u32 v4, s21, v4
  v_mul_u32_u24 v4, 1280, v4
  v_lshl_add_u32 v10, v5, 4, v4
  s_mul_i32 s31, s20, 4096
  v_add_u32 v11, 10240, v10
  v_add_u32 v12, 20480, v10
  v_add_u32 v13, 30720, v10
  s_add_u32 m0, s31, 0
  s_nop 0
  buffer_load_dwordx4 v10, s[8:11], s30 offen lds
  s_add_u32 m0, s31, 1024
  s_nop 0
  buffer_load_dwordx4 v11, s[8:11], s30 offen lds
  s_add_u32 m0, s31, 2048
  s_nop 0
  buffer_load_dwordx4 v12, s[8:11], s30 offen lds
  s_add_u32 m0, s31, 3072
  s_nop 0
  buffer_load_dwordx4 v13, s[8:11], s30 offen lds
  s_add_u32 s30, s30, 128
  s_add_u32 m0, s31, 16384
  s_nop 0
  buffer_load_dwordx4 v10, s[8:11], s30 offen lds
  s_add_u32 m0, s31, 17408
  s_nop 0
  buffer_load_dwordx4 v11, s[8:11], s30 offen lds
  s_add_u32 m0, s31, 18432
  s_nop 0
  buffer_load_dwordx4 v12, s[8:11], s30 offen lds
  s_add_u32 m0, s31, 19456
  s_nop 0
  buffer_load_dwordx4 v13, s[8:11], s30 offen lds
  s_add_u32 s30, s30, 128
  s_add_u32 m0, s31, 32768
  s_nop 0
  buffer_load_dwordx4 v10, s[8:11], s30 offen lds
  s_add_u32 m0, s31, 33792
  s_nop 0
  buffer_load_dwordx4 v11, s[8:11], s30 offen lds
  s_add_u32 m0, s31, 34816
  s_nop 0
  buffer_load_dwordx4 v12, s[8:11], s30 offen lds
  s_add_u32 m0, s31, 35840
  s_nop 0
  buffer_load_dwordx4 v13, s[8:11], s30 offen lds
  s_add_u32 s30, s30, 128
  v_and_b32 v6, 7, v2
  v_add_u32 v4, 0, v3
  v_xor_b32 v4, v4, v6
  v_lshlrev_b32 v4, 4, v4
  v_lshl_add_u32 v14, v2, 7, v4
  v_add_u32 v16, 65536, v14
  v_add_u32 v18, 131072, v14
  v_add_u32 v4, 4, v3
  v_xor_b32 v4, v4, v6
  v_lshlrev_b32 v4, 4, v4
  v_lshl_add_u32 v15, v2, 7, v4
  v_add_u32 v17, 65536, v15
  v_add_u32 v19, 131072, v15
  v_lshlrev_b32 v26, 4, v1
  v_mov_b32 v28, 1
  v_mov_b32 v4, 0x40000000
  v_cmp_eq_u32 vcc, 0, v0
  s_nop 1
  v_cndmask_b32 v27, v4, 0, vcc
  s_mul_i32 s21, s20, 3072
  s_add_u32 s21, s21, 81920
  v_add_u32 v20, s21, v26
  s_mul_i32 s21, s20, 12288
  s_add_u32 s21, s21, 81920
  v_add_u32 v21, s21, v26
  v_add_u32 v22, 2048, v21
  v_add_u32 v23, 2056, v21
  v_and_b32 v4, 7, v2
  v_lshlrev_b32 v4, 4, v4
  v_lshl_add_u32 v24, v3, 7, v4
  v_lshrrev_b32 v25, 1, v24
  v_lshlrev_b32 v29, 3, v1
  v_and_b32 v4, 3, v1
  v_lshlrev_b32 v30, 3, v4
  v_mov_b32 v31, 0xf149f2ca
  v_mov_b32 v32, 0
  v_mov_b32 v4, 1073741824
  v_cmp_eq_u32 vcc, 0, v1
  v_lshlrev_b32 v5, 2, v3
  v_sub_u32 v5, v2, v5
  v_cndmask_b32 v33, v4, 0, vcc
  v_cmp_gt_u32 s[62:63], 2, v3
  s_mov_b32 s83, 0x3dd53b95
  s_lshl_b32 s77, s42, 7
  s_add_u32 s77, s77, 18432
  s_lshl_b32 s21, s20, 5
  s_add_u32 s21, s21, s42
  s_mul_i32 s45, s21, 12288
  s_mul_i32 s46, s21, 3072
  s_mul_i32 s47, s21, 2560
  s_lshl_b32 s48, s20, 3
  s_and_b32 s21, s42, 7
  s_add_u32 s48, s48, s21
  s_lshl_b32 s48, s48, 7
  s_add_u32 s48, s48, 22528
  s_add_u32 s43, s20, 1
  s_mov_b32 s49, 0
  s_mov_b32 s50, 1073741824
  s_mov_b32 s51, 1073741824
  s_mov_b32 s81, 1073741824
  s_mov_b32 s82, 1073741824
  v_cmp_le_i32 s[64:65], 0, v5
  v_cmp_le_i32 s[66:67], 1, v5
  v_cmp_le_i32 s[68:69], 2, v5
  v_cmp_le_i32 s[70:71], 3, v5
  s_waitcnt vmcnt(8)
  s_barrier
  ds_read_b128 v[160:163], v14 offset:0
  ds_read_b128 v[164:167], v14 offset:2048
  ds_read_b128 v[168:171], v14 offset:4096
  ds_read_b128 v[172:175], v14 offset:6144
  s_waitcnt lgkmcnt(3)
  .p2align 3
qa_227:
  v_mfma_f32_16x16x32_bf16 v[64:67], a[0:3], v[160:163], 0
  ds_read_b128 v[176:179], v14 offset:8192
  v_cvt_pk_bf16_f32 v221, v126, v127
  v_mfma_f32_16x16x32_bf16 v[68:71], a[4:7], v[160:163], 0
  v_cvt_pk_bf16_f32 v222, v128, v129
  v_cvt_pk_bf16_f32 v223, v130, v131
  v_mfma_f32_16x16x32_bf16 v[72:75], a[8:11], v[160:163], 0
  s_waitcnt lgkmcnt(3)
  v_cvt_pk_bf16_f32 v226, v132, v133
  v_cvt_pk_bf16_f32 v227, v134, v135
  v_mfma_f32_16x16x32_bf16 v[76:79], a[0:3], v[164:167], 0
  ds_read_b128 v[180:183], v14 offset:10240
  v_cvt_pk_bf16_f32 v228, v136, v137
  v_mfma_f32_16x16x32_bf16 v[80:83], a[4:7], v[164:167], 0
  v_cvt_pk_bf16_f32 v229, v138, v139
  v_cvt_pk_bf16_f32 v230, v140, v141
  v_mfma_f32_16x16x32_bf16 v[84:87], a[8:11], v[164:167], 0
  s_waitcnt lgkmcnt(3)
  v_cvt_pk_bf16_f32 v231, v142, v143
  v_cvt_pk_bf16_f32 v236, v144, v145
  v_mfma_f32_16x16x32_bf16 v[88:91], a[0:3], v[168:171], 0
  ds_read_b128 v[184:187], v14 offset:12288
  v_cvt_pk_bf16_f32 v237, v146, v147
  v_mfma_f32_16x16x32_bf16 v[92:95], a[4:7], v[168:171], 0
  v_cvt_pk_bf16_f32 v232, v148, v149
  v_cvt_pk_bf16_f32 v233, v150, v151
  v_mfma_f32_16x16x32_bf16 v[96:99], a[8:11], v[168:171], 0
  s_waitcnt lgkmcnt(3)
  v_cvt_pk_bf16_f32 v234, v152, v153
  v_cvt_pk_bf16_f32 v235, v154, v155
  v_mfma_f32_16x16x32_bf16 v[100:103], a[0:3], v[172:175], 0
  ds_read_b128 v[188:191], v14 offset:14336
  v_cvt_pk_bf16_f32 v238, v156, v157
  v_mfma_f32_16x16x32_bf16 v[104:107], a[4:7], v[172:175], 0
  v_cvt_pk_bf16_f32 v239, v158, v159
  ds_write_b128 v20, v[192:195] offset:0
  v_mfma_f32_16x16x32_bf16 v[108:111], a[8:11], v[172:175], 0
  s_waitcnt lgkmcnt(4)
  v_mfma_f32_16x16x32_bf16 v[112:115], a[0:3], v[176:179], 0
  ds_read_b128 v[160:163], v15 offset:0
  ds_write_b128 v20, v[196:199] offset:1024
  v_mfma_f32_16x16x32_bf16 v[116:119], a[4:7], v[176:179], 0
  s_add_u32 m0, s31, 49152
  v_mfma_f32_16x16x32_bf16 v[120:123], a[8:11], v[176:179], 0
  s_waitcnt lgkmcnt(5)
  buffer_load_dwordx4 v10, s[8:11], s30 offen lds
  ds_write_b128 v20, v[200:203] offset:2048
  v_mfma_f32_16x16x32_bf16 v[124:127], a[0:3], v[180:183], 0
  ds_read_b128 v[164:167], v15 offset:2048
  v_mfma_f32_16x16x32_bf16 v[128:131], a[4:7], v[180:183], 0
  ds_write_b128 v20, v[204:207] offset:12288
  v_mfma_f32_16x16x32_bf16 v[132:135], a[8:11], v[180:183], 0
  s_waitcnt lgkmcnt(7)
  v_mfma_f32_16x16x32_bf16 v[136:139], a[0:3], v[184:187], 0
  ds_read_b128 v[168:171], v15 offset:4096
  ds_write_b128 v20, v[208:211] offset:13312
  v_mfma_f32_16x16x32_bf16 v[140:143], a[4:7], v[184:187], 0
  s_add_u32 m0, s31, 50176
  v_mfma_f32_16x16x32_bf16 v[144:147], a[8:11], v[184:187], 0
  s_waitcnt lgkmcnt(8)
  buffer_load_dwordx4 v11, s[8:11], s30 offen lds
  ds_write_b128 v20, v[212:215] offset:14336
  v_mfma_f32_16x16x32_bf16 v[148:151], a[0:3], v[188:191], 0
  ds_read_b128 v[172:175], v15 offset:6144
  v_mfma_f32_16x16x32_bf16 v[152:155], a[4:7], v[188:191], 0
  ds_write_b128 v20, v[216:219] offset:24576
  v_mfma_f32_16x16x32_bf16 v[156:159], a[8:11], v[188:191], 0
  s_waitcnt lgkmcnt(9)
  v_mfma_f32_16x16x32_bf16 v[64:67], a[12:15], v[160:163], v[64:67]
  ds_read_b128 v[176:179], v15 offset:8192
  ds_write_b128 v20, v[220:223] offset:25600
  v_mfma_f32_16x16x32_bf16 v[68:71], a[16:19], v[160:163], v[68:71]
  s_add_u32 m0, s31, 51200
  v_mfma_f32_16x16x32_bf16 v[72:75], a[20:23], v[160:163], v[72:75]
  s_waitcnt lgkmcnt(8)
  buffer_load_dwordx4 v12, s[8:11], s30 offen lds
  ds_write_b128 v20, v[224:227] offset:26624
  v_mfma_f32_16x16x32_bf16 v[76:79], a[12:15], v[164:167], v[76:79]
  ds_read_b128 v[180:183], v15 offset:10240
  v_mfma_f32_16x16x32_bf16 v[80:83], a[16:19], v[164:167], v[80:83]
  ds_write_b128 v20, v[228:231] offset:36864
  v_mfma_f32_16x16x32_bf16 v[84:87], a[20:23], v[164:167], v[84:87]
  s_waitcnt lgkmcnt(9)
  v_mfma_f32_16x16x32_bf16 v[88:91], a[12:15], v[168:171], v[88:91]
  ds_read_b128 v[184:187], v15 offset:12288
  ds_write_b128 v20, v[232:235] offset:37888
  v_mfma_f32_16x16x32_bf16 v[92:95], a[16:19], v[168:171], v[92:95]
  s_add_u32 m0, s31, 52224
  v_mfma_f32_16x16x32_bf16 v[96:99], a[20:23], v[168:171], v[96:99]
  s_waitcnt lgkmcnt(8)
  buffer_load_dwordx4 v13, s[8:11], s30 offen lds
  ds_write_b128 v20, v[236:239] offset:38912
  v_mfma_f32_16x16x32_bf16 v[100:103], a[12:15], v[172:175], v[100:103]
  s_add_u32 s30, s30, 128
  ds_read_b128 v[188:191], v15 offset:14336
  s_waitcnt vmcnt(8)
  v_mfma_f32_16x16x32_bf16 v[104:107], a[16:19], v[172:175], v[104:107]
  v_cmp_gt_u32 vcc, s49, v32
  v_mfma_f32_16x16x32_bf16 v[108:111], a[20:23], v[172:175], v[108:111]
  s_waitcnt lgkmcnt(8)
  s_cbranch_vccnz qw_228
qj_229:
  s_waitcnt lgkmcnt(1)
  v_mfma_f32_16x16x32_bf16 v[112:115], a[12:15], v[176:179], v[112:115]
  s_waitcnt vmcnt(8)
  s_barrier
  ds_read_b128 v[160:163], v14 offset:16384
  v_mfma_f32_16x16x32_bf16 v[116:119], a[16:19], v[176:179], v[116:119]
  s_add_u32 s29, s50, 0
  buffer_load_dwordx4 v[192:195], v26, s[16:19], s29 offen offset:0 sc1
  v_mfma_f32_16x16x32_bf16 v[120:123], a[20:23], v[176:179], v[120:123]
  s_waitcnt lgkmcnt(6)
  v_mfma_f32_16x16x32_bf16 v[124:127], a[12:15], v[180:183], v[124:127]
  ds_read_b128 v[164:167], v14 offset:18432
  buffer_load_dwordx4 v[196:199], v26, s[16:19], s29 offen offset:1024 sc1
  v_mfma_f32_16x16x32_bf16 v[128:131], a[16:19], v[180:183], v[128:131]
  v_mfma_f32_16x16x32_bf16 v[132:135], a[20:23], v[180:183], v[132:135]
  s_waitcnt lgkmcnt(5)
  buffer_load_dwordx4 v[224:227], v26, s[16:19], s29 offen offset:2048 sc1
  v_mfma_f32_16x16x32_bf16 v[136:139], a[12:15], v[184:187], v[136:139]
  ds_read_b128 v[168:171], v14 offset:20480
  v_mfma_f32_16x16x32_bf16 v[140:143], a[16:19], v[184:187], v[140:143]
  s_add_u32 s29, s50, 3072
  buffer_load_dwordx4 v[200:203], v26, s[16:19], s29 offen offset:0 sc1
  v_mfma_f32_16x16x32_bf16 v[144:147], a[20:23], v[184:187], v[144:147]
  s_waitcnt lgkmcnt(3)
  v_mfma_f32_16x16x32_bf16 v[148:151], a[12:15], v[188:191], v[148:151]
  ds_read_b128 v[172:175], v14 offset:22528
  buffer_load_dwordx4 v[204:207], v26, s[16:19], s29 offen offset:1024 sc1
  v_mfma_f32_16x16x32_bf16 v[152:155], a[16:19], v[188:191], v[152:155]
  v_mfma_f32_16x16x32_bf16 v[156:159], a[20:23], v[188:191], v[156:159]
  s_waitcnt lgkmcnt(3)
  buffer_load_dwordx4 v[228:231], v26, s[16:19], s29 offen offset:2048 sc1
  v_mfma_f32_16x16x32_bf16 v[64:67], a[24:27], v[160:163], v[64:67]
  ds_read_b128 v[176:179], v14 offset:24576
  v_mfma_f32_16x16x32_bf16 v[68:71], a[28:31], v[160:163], v[68:71]
  s_add_u32 m0, s31, 65536
  s_add_u32 s29, s50, 6144
  buffer_load_dwordx4 v[208:211], v26, s[16:19], s29 offen offset:0 sc1
  v_mfma_f32_16x16x32_bf16 v[72:75], a[32:35], v[160:163], v[72:75]
  s_waitcnt lgkmcnt(3)
  buffer_load_dwordx4 v10, s[8:11], s30 offen lds
  v_mfma_f32_16x16x32_bf16 v[76:79], a[24:27], v[164:167], v[76:79]
  ds_read_b128 v[180:183], v14 offset:26624
  buffer_load_dwordx4 v[212:215], v26, s[16:19], s29 offen offset:1024 sc1
  v_mfma_f32_16x16x32_bf16 v[80:83], a[28:31], v[164:167], v[80:83]
  v_mfma_f32_16x16x32_bf16 v[84:87], a[32:35], v[164:167], v[84:87]
  s_waitcnt lgkmcnt(3)
  buffer_load_dwordx4 v[232:235], v26, s[16:19], s29 offen offset:2048 sc1
  v_mfma_f32_16x16x32_bf16 v[88:91], a[24:27], v[168:171], v[88:91]
  ds_read_b128 v[184:187], v14 offset:28672
  v_mfma_f32_16x16x32_bf16 v[92:95], a[28:31], v[168:171], v[92:95]
  s_add_u32 m0, s31, 66560
  s_add_u32 s29, s50, 9216
  buffer_load_dwordx4 v[216:219], v26, s[16:19], s29 offen offset:0 sc1
  v_mfma_f32_16x16x32_bf16 v[96:99], a[32:35], v[168:171], v[96:99]
  s_waitcnt lgkmcnt(3)
  buffer_load_dwordx4 v11, s[8:11], s30 offen lds
  v_mfma_f32_16x16x32_bf16 v[100:103], a[24:27], v[172:175], v[100:103]
  ds_read_b128 v[188:191], v14 offset:30720
  buffer_load_dwordx4 v[220:223], v26, s[16:19], s29 offen offset:1024 sc1
  v_mfma_f32_16x16x32_bf16 v[104:107], a[28:31], v[172:175], v[104:107]
  v_mfma_f32_16x16x32_bf16 v[108:111], a[32:35], v[172:175], v[108:111]
  s_waitcnt lgkmcnt(3)
  buffer_load_dwordx4 v[236:239], v26, s[16:19], s29 offen offset:2048 sc1
  v_mfma_f32_16x16x32_bf16 v[112:115], a[24:27], v[176:179], v[112:115]
  ds_read_b128 v[160:163], v15 offset:16384
  v_mfma_f32_16x16x32_bf16 v[116:119], a[28:31], v[176:179], v[116:119]
  s_add_u32 m0, s31, 67584
  buffer_load_dwordx4 a[240:243], v24, s[52:55], s51 offen offset:0 sc1
  v_mfma_f32_16x16x32_bf16 v[120:123], a[32:35], v[176:179], v[120:123]
  s_waitcnt lgkmcnt(3)
  buffer_load_dwordx4 v12, s[8:11], s30 offen lds
  v_mfma_f32_16x16x32_bf16 v[124:127], a[24:27], v[180:183], v[124:127]
  ds_read_b128 v[164:167], v15 offset:18432
  buffer_load_dwordx2 v[240:241], v25, s[52:55], s51 offen offset:512 sc1
  v_mfma_f32_16x16x32_bf16 v[128:131], a[28:31], v[180:183], v[128:131]
  v_mfma_f32_16x16x32_bf16 v[132:135], a[32:35], v[180:183], v[132:135]
  s_waitcnt lgkmcnt(3)
  buffer_load_dwordx4 a[244:247], v24, s[52:55], s51 offen offset:768 sc1
  v_mfma_f32_16x16x32_bf16 v[136:139], a[24:27], v[184:187], v[136:139]
  ds_read_b128 v[168:171], v15 offset:20480
  v_mfma_f32_16x16x32_bf16 v[140:143], a[28:31], v[184:187], v[140:143]
  s_add_u32 m0, s31, 68608
  buffer_load_dwordx2 v[242:243], v25, s[52:55], s51 offen offset:1280 sc1
  v_mfma_f32_16x16x32_bf16 v[144:147], a[32:35], v[184:187], v[144:147]
  s_waitcnt lgkmcnt(3)
  buffer_load_dwordx4 v13, s[8:11], s30 offen lds
  v_mfma_f32_16x16x32_bf16 v[148:151], a[24:27], v[188:191], v[148:151]
  s_add_u32 s30, s30, 128
  ds_read_b128 v[172:175], v15 offset:22528
  buffer_load_dwordx4 a[248:251], v24, s[52:55], s51 offen offset:1536 sc1
  v_mfma_f32_16x16x32_bf16 v[152:155], a[28:31], v[188:191], v[152:155]
  v_mfma_f32_16x16x32_bf16 v[156:159], a[32:35], v[188:191], v[156:159]
  s_waitcnt lgkmcnt(3)
  buffer_load_dwordx2 v[244:245], v25, s[52:55], s51 offen offset:2048 sc1
  v_mfma_f32_16x16x32_bf16 v[64:67], a[36:39], v[160:163], v[64:67]
  ds_read_b128 v[176:179], v15 offset:24576
  v_mfma_f32_16x16x32_bf16 v[68:71], a[40:43], v[160:163], v[68:71]
  buffer_load_dwordx4 a[252:255], v24, s[52:55], s51 offen offset:2304 sc1
  v_mfma_f32_16x16x32_bf16 v[72:75], a[44:47], v[160:163], v[72:75]
  s_waitcnt lgkmcnt(3)
  v_mfma_f32_16x16x32_bf16 v[76:79], a[36:39], v[164:167], v[76:79]
  ds_read_b128 v[180:183], v15 offset:26624
  buffer_load_dwordx2 v[246:247], v25, s[52:55], s51 offen offset:2816 sc1
  v_mfma_f32_16x16x32_bf16 v[80:83], a[40:43], v[164:167], v[80:83]
  v_mfma_f32_16x16x32_bf16 v[84:87], a[44:47], v[164:167], v[84:87]
  s_waitcnt lgkmcnt(3)
  v_mfma_f32_16x16x32_bf16 v[88:91], a[36:39], v[168:171], v[88:91]
  ds_read_b128 v[184:187], v15 offset:28672
  v_mfma_f32_16x16x32_bf16 v[92:95], a[40:43], v[168:171], v[92:95]
  v_mfma_f32_16x16x32_bf16 v[96:99], a[44:47], v[168:171], v[96:99]
  s_waitcnt lgkmcnt(3)
  v_mfma_f32_16x16x32_bf16 v[100:103], a[36:39], v[172:175], v[100:103]
  ds_read_b128 v[188:191], v15 offset:30720
  v_mfma_f32_16x16x32_bf16 v[104:107], a[40:43], v[172:175], v[104:107]
  v_mfma_f32_16x16x32_bf16 v[108:111], a[44:47], v[172:175], v[108:111]
  s_waitcnt lgkmcnt(3)
  v_mfma_f32_16x16x32_bf16 v[112:115], a[36:39], v[176:179], v[112:115]
  s_waitcnt vmcnt(28)
  s_barrier
  ds_read_b128 v[160:163], v14 offset:32768
  v_mfma_f32_16x16x32_bf16 v[116:119], a[40:43], v[176:179], v[116:119]
  v_mfma_f32_16x16x32_bf16 v[120:123], a[44:47], v[176:179], v[120:123]
  s_waitcnt lgkmcnt(3)
  v_mfma_f32_16x16x32_bf16 v[124:127], a[36:39], v[180:183], v[124:127]
  ds_read_b128 v[164:167], v14 offset:34816
  v_mfma_f32_16x16x32_bf16 v[128:131], a[40:43], v[180:183], v[128:131]
  v_mfma_f32_16x16x32_bf16 v[132:135], a[44:47], v[180:183], v[132:135]
  s_waitcnt lgkmcnt(3)
  v_mfma_f32_16x16x32_bf16 v[136:139], a[36:39], v[184:187], v[136:139]
  ds_read_b128 v[168:171], v14 offset:36864
  v_mfma_f32_16x16x32_bf16 v[140:143], a[40:43], v[184:187], v[140:143]
  v_mfma_f32_16x16x32_bf16 v[144:147], a[44:47], v[184:187], v[144:147]
  s_waitcnt lgkmcnt(3)
  v_mfma_f32_16x16x32_bf16 v[148:151], a[36:39], v[188:191], v[148:151]
  ds_read_b128 v[172:175], v14 offset:38912
  v_mfma_f32_16x16x32_bf16 v[152:155], a[40:43], v[188:191], v[152:155]
  v_mfma_f32_16x16x32_bf16 v[156:159], a[44:47], v[188:191], v[156:159]
  s_waitcnt lgkmcnt(3)
  v_mfma_f32_16x16x32_bf16 v[64:67], a[48:51], v[160:163], v[64:67]
  ds_read_b128 v[176:179], v14 offset:40960
  v_mfma_f32_16x16x32_bf16 v[68:71], a[52:55], v[160:163], v[68:71]
  s_add_u32 m0, s31, 0
  v_mfma_f32_16x16x32_bf16 v[72:75], a[56:59], v[160:163], v[72:75]
  s_waitcnt lgkmcnt(3)
  buffer_load_dwordx4 v10, s[8:11], s30 offen lds
  v_mfma_f32_16x16x32_bf16 v[76:79], a[48:51], v[164:167], v[76:79]
  ds_read_b128 v[180:183], v14 offset:43008
  v_mfma_f32_16x16x32_bf16 v[80:83], a[52:55], v[164:167], v[80:83]
  v_mfma_f32_16x16x32_bf16 v[84:87], a[56:59], v[164:167], v[84:87]
  s_waitcnt lgkmcnt(3)
  v_mfma_f32_16x16x32_bf16 v[88:91], a[48:51], v[168:171], v[88:91]
  ds_read_b128 v[184:187], v14 offset:45056
  v_mfma_f32_16x16x32_bf16 v[92:95], a[52:55], v[168:171], v[92:95]
  s_add_u32 m0, s31, 1024
  v_mfma_f32_16x16x32_bf16 v[96:99], a[56:59], v[168:171], v[96:99]
  s_waitcnt lgkmcnt(3)
  buffer_load_dwordx4 v11, s[8:11], s30 offen lds
  v_mfma_f32_16x16x32_bf16 v[100:103], a[48:51], v[172:175], v[100:103]
  ds_read_b128 v[188:191], v14 offset:47104
  v_mfma_f32_16x16x32_bf16 v[104:107], a[52:55], v[172:175], v[104:107]
  v_mfma_f32_16x16x32_bf16 v[108:111], a[56:59], v[172:175], v[108:111]
  s_waitcnt lgkmcnt(3)
  v_mfma_f32_16x16x32_bf16 v[112:115], a[48:51], v[176:179], v[112:115]
  ds_read_b128 v[160:163], v15 offset:32768
  v_mfma_f32_16x16x32_bf16 v[116:119], a[52:55], v[176:179], v[116:119]
  s_add_u32 m0, s31, 2048
  v_mfma_f32_16x16x32_bf16 v[120:123], a[56:59], v[176:179], v[120:123]
  s_waitcnt lgkmcnt(3)
  buffer_load_dwordx4 v12, s[8:11], s30 offen lds
  v_mfma_f32_16x16x32_bf16 v[124:127], a[48:51], v[180:183], v[124:127]
  ds_read_b128 v[164:167], v15 offset:34816
  v_mfma_f32_16x16x32_bf16 v[128:131], a[52:55], v[180:183], v[128:131]
  v_mfma_f32_16x16x32_bf16 v[132:135], a[56:59], v[180:183], v[132:135]
  s_waitcnt lgkmcnt(3)
  v_mfma_f32_16x16x32_bf16 v[136:139], a[48:51], v[184:187], v[136:139]
  ds_read_b128 v[168:171], v15 offset:36864
  v_mfma_f32_16x16x32_bf16 v[140:143], a[52:55], v[184:187], v[140:143]
  s_add_u32 m0, s31, 3072
  v_mfma_f32_16x16x32_bf16 v[144:147], a[56:59], v[184:187], v[144:147]
  s_waitcnt lgkmcnt(3)
  buffer_load_dwordx4 v13, s[8:11], s30 offen lds
  v_mfma_f32_16x16x32_bf16 v[148:151], a[48:51], v[188:191], v[148:151]
  s_add_u32 s30, s30, 128
  ds_read_b128 v[172:175], v15 offset:38912
  v_mfma_f32_16x16x32_bf16 v[152:155], a[52:55], v[188:191], v[152:155]
  v_mfma_f32_16x16x32_bf16 v[156:159], a[56:59], v[188:191], v[156:159]
  s_waitcnt lgkmcnt(3)
  v_mfma_f32_16x16x32_bf16 v[64:67], a[60:63], v[160:163], v[64:67]
  ds_read_b128 v[176:179], v15 offset:40960
  v_mfma_f32_16x16x32_bf16 v[68:71], a[64:67], v[160:163], v[68:71]
  v_mfma_f32_16x16x32_bf16 v[72:75], a[68:71], v[160:163], v[72:75]
  s_waitcnt lgkmcnt(3)
  v_mfma_f32_16x16x32_bf16 v[76:79], a[60:63], v[164:167], v[76:79]
  ds_read_b128 v[180:183], v15 offset:43008
  v_mfma_f32_16x16x32_bf16 v[80:83], a[64:67], v[164:167], v[80:83]
  v_mfma_f32_16x16x32_bf16 v[84:87], a[68:71], v[164:167], v[84:87]
  s_waitcnt lgkmcnt(3)
  v_mfma_f32_16x16x32_bf16 v[88:91], a[60:63], v[168:171], v[88:91]
  ds_read_b128 v[184:187], v15 offset:45056
  v_mfma_f32_16x16x32_bf16 v[92:95], a[64:67], v[168:171], v[92:95]
  v_mfma_f32_16x16x32_bf16 v[96:99], a[68:71], v[168:171], v[96:99]
  s_waitcnt lgkmcnt(3)
  v_mfma_f32_16x16x32_bf16 v[100:103], a[60:63], v[172:175], v[100:103]
  ds_read_b128 v[188:191], v15 offset:47104
  v_mfma_f32_16x16x32_bf16 v[104:107], a[64:67], v[172:175], v[104:107]
  v_mfma_f32_16x16x32_bf16 v[108:111], a[68:71], v[172:175], v[108:111]
  s_waitcnt lgkmcnt(3)
  v_mfma_f32_16x16x32_bf16 v[112:115], a[60:63], v[176:179], v[112:115]
  s_waitcnt vmcnt(28)
  s_barrier
  ds_read_b128 v[160:163], v14 offset:49152
  v_mfma_f32_16x16x32_bf16 v[116:119], a[64:67], v[176:179], v[116:119]
  v_mfma_f32_16x16x32_bf16 v[120:123], a[68:71], v[176:179], v[120:123]
  s_waitcnt lgkmcnt(3)
  v_mfma_f32_16x16x32_bf16 v[124:127], a[60:63], v[180:183], v[124:127]
  ds_read_b128 v[164:167], v14 offset:51200
  v_mfma_f32_16x16x32_bf16 v[128:131], a[64:67], v[180:183], v[128:131]
  v_mfma_f32_16x16x32_bf16 v[132:135], a[68:71], v[180:183], v[132:135]
  s_waitcnt lgkmcnt(3)
  v_mfma_f32_16x16x32_bf16 v[136:139], a[60:63], v[184:187], v[136:139]
  ds_read_b128 v[168:171], v14 offset:53248
  v_mfma_f32_16x16x32_bf16 v[140:143], a[64:67], v[184:187], v[140:143]
  v_mfma_f32_16x16x32_bf16 v[144:147], a[68:71], v[184:187], v[144:147]
  s_waitcnt lgkmcnt(3)
  v_mfma_f32_16x16x32_bf16 v[148:151], a[60:63], v[188:191], v[148:151]
  ds_read_b128 v[172:175], v14 offset:55296
  v_mfma_f32_16x16x32_bf16 v[152:155], a[64:67], v[188:191], v[152:155]
  v_mfma_f32_16x16x32_bf16 v[156:159], a[68:71], v[188:191], v[156:159]
  s_waitcnt lgkmcnt(3)
  v_mfma_f32_16x16x32_bf16 v[64:67], a[72:75], v[160:163], v[64:67]
  ds_read_b128 v[176:179], v14 offset:57344
  v_mfma_f32_16x16x32_bf16 v[68:71], a[76:79], v[160:163], v[68:71]
  s_add_u32 m0, s31, 16384
  v_mfma_f32_16x16x32_bf16 v[72:75], a[80:83], v[160:163], v[72:75]
  s_waitcnt lgkmcnt(3)
  buffer_load_dwordx4 v10, s[8:11], s30 offen lds
  v_mfma_f32_16x16x32_bf16 v[76:79], a[72:75], v[164:167], v[76:79]
  ds_read_b128 v[180:183], v14 offset:59392
  v_mfma_f32_16x16x32_bf16 v[80:83], a[76:79], v[164:167], v[80:83]
  v_mfma_f32_16x16x32_bf16 v[84:87], a[80:83], v[164:167], v[84:87]
  s_waitcnt lgkmcnt(3)
  v_mfma_f32_16x16x32_bf16 v[88:91], a[72:75], v[168:171], v[88:91]
  ds_read_b128 v[184:187], v14 offset:61440
  v_mfma_f32_16x16x32_bf16 v[92:95], a[76:79], v[168:171], v[92:95]
  s_add_u32 m0, s31, 17408
  v_mfma_f32_16x16x32_bf16 v[96:99], a[80:83], v[168:171], v[96:99]
  s_waitcnt lgkmcnt(3)
  buffer_load_dwordx4 v11, s[8:11], s30 offen lds
  v_mfma_f32_16x16x32_bf16 v[100:103], a[72:75], v[172:175], v[100:103]
  ds_read_b128 v[188:191], v14 offset:63488
  v_mfma_f32_16x16x32_bf16 v[104:107], a[76:79], v[172:175], v[104:107]
  v_mfma_f32_16x16x32_bf16 v[108:111], a[80:83], v[172:175], v[108:111]
  s_waitcnt lgkmcnt(3)
  v_mfma_f32_16x16x32_bf16 v[112:115], a[72:75], v[176:179], v[112:115]
  ds_read_b128 v[160:163], v15 offset:49152
  v_mfma_f32_16x16x32_bf16 v[116:119], a[76:79], v[176:179], v[116:119]
  s_add_u32 m0, s31, 18432
  v_mfma_f32_16x16x32_bf16 v[120:123], a[80:83], v[176:179], v[120:123]
  s_waitcnt lgkmcnt(3)
  buffer_load_dwordx4 v12, s[8:11], s30 offen lds
  v_mfma_f32_16x16x32_bf16 v[124:127], a[72:75], v[180:183], v[124:127]
  ds_read_b128 v[164:167], v15 offset:51200
  v_mfma_f32_16x16x32_bf16 v[128:131], a[76:79], v[180:183], v[128:131]
  v_mfma_f32_16x16x32_bf16 v[132:135], a[80:83], v[180:183], v[132:135]
  s_waitcnt lgkmcnt(3)
  v_mfma_f32_16x16x32_bf16 v[136:139], a[72:75], v[184:187], v[136:139]
  ds_read_b128 v[168:171], v15 offset:53248
  v_mfma_f32_16x16x32_bf16 v[140:143], a[76:79], v[184:187], v[140:143]
  s_add_u32 m0, s31, 19456
  v_mfma_f32_16x16x32_bf16 v[144:147], a[80:83], v[184:187], v[144:147]
  s_waitcnt lgkmcnt(3)
  buffer_load_dwordx4 v13, s[8:11], s30 offen lds
  v_mfma_f32_16x16x32_bf16 v[148:151], a[72:75], v[188:191], v[148:151]
  s_add_u32 s30, s30, 128
  ds_read_b128 v[172:175], v15 offset:55296
  v_mfma_f32_16x16x32_bf16 v[152:155], a[76:79], v[188:191], v[152:155]
  v_mfma_f32_16x16x32_bf16 v[156:159], a[80:83], v[188:191], v[156:159]
  s_waitcnt lgkmcnt(3)
  v_mfma_f32_16x16x32_bf16 v[64:67], a[84:87], v[160:163], v[64:67]
  ds_read_b128 v[176:179], v15 offset:57344
  v_mfma_f32_16x16x32_bf16 v[68:71], a[88:91], v[160:163], v[68:71]
  v_mfma_f32_16x16x32_bf16 v[72:75], a[92:95], v[160:163], v[72:75]
  s_waitcnt lgkmcnt(3)
  v_mfma_f32_16x16x32_bf16 v[76:79], a[84:87], v[164:167], v[76:79]
  ds_read_b128 v[180:183], v15 offset:59392
  v_mfma_f32_16x16x32_bf16 v[80:83], a[88:91], v[164:167], v[80:83]
  v_mfma_f32_16x16x32_bf16 v[84:87], a[92:95], v[164:167], v[84:87]
  s_waitcnt lgkmcnt(3)
  v_mfma_f32_16x16x32_bf16 v[88:91], a[84:87], v[168:171], v[88:91]
  ds_read_b128 v[184:187], v15 offset:61440
  v_mfma_f32_16x16x32_bf16 v[92:95], a[88:91], v[168:171], v[92:95]
  v_mfma_f32_16x16x32_bf16 v[96:99], a[92:95], v[168:171], v[96:99]
  s_waitcnt lgkmcnt(3)
  v_mfma_f32_16x16x32_bf16 v[100:103], a[84:87], v[172:175], v[100:103]
  ds_read_b128 v[188:191], v15 offset:63488
  v_mfma_f32_16x16x32_bf16 v[104:107], a[88:91], v[172:175], v[104:107]
  v_mfma_f32_16x16x32_bf16 v[108:111], a[92:95], v[172:175], v[108:111]
  s_waitcnt lgkmcnt(3)
  v_mfma_f32_16x16x32_bf16 v[112:115], a[84:87], v[176:179], v[112:115]
  s_waitcnt vmcnt(12)
  s_barrier
  ds_read_b128 v[160:163], v16 offset:0
  v_mfma_f32_16x16x32_bf16 v[116:119], a[88:91], v[176:179], v[116:119]
  v_mfma_f32_16x16x32_bf16 v[120:123], a[92:95], v[176:179], v[120:123]
  s_waitcnt lgkmcnt(3)
  v_mfma_f32_16x16x32_bf16 v[124:127], a[84:87], v[180:183], v[124:127]
  ds_read_b128 v[164:167], v16 offset:2048
  v_mfma_f32_16x16x32_bf16 v[128:131], a[88:91], v[180:183], v[128:131]
  v_mfma_f32_16x16x32_bf16 v[132:135], a[92:95], v[180:183], v[132:135]
  s_waitcnt lgkmcnt(3)
  v_mfma_f32_16x16x32_bf16 v[136:139], a[84:87], v[184:187], v[136:139]
  ds_read_b128 v[168:171], v16 offset:4096
  v_mfma_f32_16x16x32_bf16 v[140:143], a[88:91], v[184:187], v[140:143]
  v_mfma_f32_16x16x32_bf16 v[144:147], a[92:95], v[184:187], v[144:147]
  s_waitcnt lgkmcnt(3)
  v_mfma_f32_16x16x32_bf16 v[148:151], a[84:87], v[188:191], v[148:151]
  ds_read_b128 v[172:175], v16 offset:6144
  s_waitcnt vmcnt(8)
  v_mfma_f32_16x16x32_bf16 v[152:155], a[88:91], v[188:191], v[152:155]
  v_swap_b32 v226, v228
  v_swap_b32 v227, v229
  v_mfma_f32_16x16x32_bf16 v[156:159], a[92:95], v[188:191], v[156:159]
  s_waitcnt lgkmcnt(3)
  v_swap_b32 v234, v236
  v_swap_b32 v235, v237
  v_mfma_f32_16x16x32_bf16 v[64:67], a[96:99], v[160:163], v[64:67]
  ds_read_b128 v[176:179], v16 offset:8192
  v_mfma_f32_16x16x32_bf16 v[68:71], a[100:103], v[160:163], v[68:71]
  s_add_u32 m0, s31, 32768
  ds_read_b128 v[56:59], v21 offset:0
  ds_read_b128 v[60:63], v21 offset:1024
  v_mfma_f32_16x16x32_bf16 v[72:75], a[104:107], v[160:163], v[72:75]
  s_waitcnt lgkmcnt(5)
  buffer_load_dwordx4 v10, s[8:11], s30 offen lds
  v_mfma_f32_16x16x32_bf16 v[76:79], a[96:99], v[164:167], v[76:79]
  ds_read_b128 v[180:183], v16 offset:10240
  v_mfma_f32_16x16x32_bf16 v[80:83], a[100:103], v[164:167], v[80:83]
  v_mfma_f32_16x16x32_bf16 v[84:87], a[104:107], v[164:167], v[84:87]
  s_waitcnt lgkmcnt(5)
  v_mfma_f32_16x16x32_bf16 v[88:91], a[96:99], v[168:171], v[88:91]
  ds_read_b128 v[184:187], v16 offset:12288
  v_mfma_f32_16x16x32_bf16 v[92:95], a[100:103], v[168:171], v[92:95]
  s_add_u32 m0, s31, 33792
  ds_read_b128 v[248:251], v21 offset:3072
  ds_read_b128 v[252:255], v21 offset:4096
  v_mfma_f32_16x16x32_bf16 v[96:99], a[104:107], v[168:171], v[96:99]
  s_waitcnt lgkmcnt(4)
  buffer_load_dwordx4 v11, s[8:11], s30 offen lds
  v_mfma_f32_16x16x32_bf16 v[36:39], v[192:195], v[56:59], 0
  v_mfma_f32_16x16x32_bf16 v[44:47], v[192:195], v[60:63], 0
  v_mfma_f32_16x16x32_bf16 v[48:51], v[196:199], v[60:63], 0
  v_mfma_f32_16x16x32_bf16 v[40:43], a[240:243], v[56:59], 0
  v_mfma_f32_16x16x32_bf16 v[52:55], a[240:243], v[60:63], 0
  s_waitcnt lgkmcnt(7)
  ds_read2st64_b64 v[56:59], v22 offset0:0 offset1:6
  ds_read2st64_b64 v[60:63], v23 offset0:0 offset1:6
  v_mfma_f32_16x16x32_bf16 v[100:103], a[96:99], v[172:175], v[100:103]
  ds_read_b128 v[188:191], v16 offset:14336
  v_mfma_f32_16x16x32_bf16 v[104:107], a[100:103], v[172:175], v[104:107]
  v_mfma_f32_16x16x32_bf16 v[108:111], a[104:107], v[172:175], v[108:111]
  s_waitcnt lgkmcnt(9)
  v_mfma_f32_16x16x32_bf16 v[112:115], a[96:99], v[176:179], v[112:115]
  ds_read_b128 v[160:163], v17 offset:0
  v_mfma_f32_16x16x32_bf16 v[116:119], a[100:103], v[176:179], v[116:119]
  s_add_u32 m0, s31, 34816
  v_mfma_f32_16x16x32_bf16 v[120:123], a[104:107], v[176:179], v[120:123]
  s_waitcnt lgkmcnt(4)
  buffer_load_dwordx4 v12, s[8:11], s30 offen lds
  v_mfma_f32_16x16x32_bf16 v[36:39], v[200:203], v[248:251], v[36:39]
  v_mfma_f32_16x16x32_bf16 v[44:47], v[200:203], v[252:255], v[44:47]
  v_mfma_f32_16x16x32_bf16 v[48:51], v[204:207], v[252:255], v[48:51]
  v_mfma_f32_16x16x32_bf16 v[40:43], a[244:247], v[248:251], v[40:43]
  v_mfma_f32_16x16x32_bf16 v[52:55], a[244:247], v[252:255], v[52:55]
  s_waitcnt lgkmcnt(7)
  ds_read_b128 v[248:251], v21 offset:6144
  ds_read_b128 v[252:255], v21 offset:7168
  v_mfma_f32_16x16x32_bf16 v[124:127], a[96:99], v[180:183], v[124:127]
  ds_read_b128 v[164:167], v17 offset:2048
  v_mfma_f32_16x16x32_bf16 v[128:131], a[100:103], v[180:183], v[128:131]
  v_mfma_f32_16x16x32_bf16 v[132:135], a[104:107], v[180:183], v[132:135]
  s_waitcnt lgkmcnt(9)
  v_mfma_f32_16x16x32_bf16 v[136:139], a[96:99], v[184:187], v[136:139]
  ds_read_b128 v[168:171], v17 offset:4096
  v_mfma_f32_16x16x32_bf16 v[140:143], a[100:103], v[184:187], v[140:143]
  s_add_u32 m0, s31, 35840
  v_mfma_f32_16x16x32_bf16 v[144:147], a[104:107], v[184:187], v[144:147]
  s_waitcnt lgkmcnt(6)
  buffer_load_dwordx4 v13, s[8:11], s30 offen lds
  v_mfma_f32_16x16x32_bf16 v[36:39], v[224:227], v[56:59], v[36:39]
  s_add_u32 s30, s30, 128
  v_mfma_f32_16x16x32_bf16 v[44:47], v[224:227], v[60:63], v[44:47]
  v_mfma_f32_16x16x32_bf16 v[48:51], v[228:231], v[60:63], v[48:51]
  v_mfma_f32_16x16x32_bf16 v[40:43], v[240:243], v[56:59], v[40:43]
  v_mfma_f32_16x16x32_bf16 v[52:55], v[240:243], v[60:63], v[52:55]
  s_waitcnt lgkmcnt(5)
  ds_read_b128 v[56:59], v21 offset:9216
  ds_read_b128 v[60:63], v21 offset:10240
  v_mfma_f32_16x16x32_bf16 v[148:151], a[96:99], v[188:191], v[148:151]
  ds_read_b128 v[172:175], v17 offset:6144
  v_mfma_f32_16x16x32_bf16 v[152:155], a[100:103], v[188:191], v[152:155]
  v_mfma_f32_16x16x32_bf16 v[156:159], a[104:107], v[188:191], v[156:159]
  s_waitcnt lgkmcnt(7)
  v_mfma_f32_16x16x32_bf16 v[64:67], a[108:111], v[160:163], v[64:67]
  ds_read_b128 v[176:179], v17 offset:8192
  v_mfma_f32_16x16x32_bf16 v[68:71], a[112:115], v[160:163], v[68:71]
  v_mfma_f32_16x16x32_bf16 v[72:75], a[116:119], v[160:163], v[72:75]
  s_waitcnt lgkmcnt(6)
  v_mfma_f32_16x16x32_bf16 v[36:39], v[208:211], v[248:251], v[36:39]
  v_mfma_f32_16x16x32_bf16 v[44:47], v[208:211], v[252:255], v[44:47]
  v_mfma_f32_16x16x32_bf16 v[48:51], v[212:215], v[252:255], v[48:51]
  v_mfma_f32_16x16x32_bf16 v[40:43], a[248:251], v[248:251], v[40:43]
  v_mfma_f32_16x16x32_bf16 v[52:55], a[248:251], v[252:255], v[52:55]
  s_waitcnt lgkmcnt(5)
  ds_read2st64_b64 v[248:251], v22 offset0:12 offset1:18
  ds_read2st64_b64 v[252:255], v23 offset0:12 offset1:18
  v_mfma_f32_16x16x32_bf16 v[76:79], a[108:111], v[164:167], v[76:79]
  ds_read_b128 v[180:183], v17 offset:10240
  v_mfma_f32_16x16x32_bf16 v[80:83], a[112:115], v[164:167], v[80:83]
  v_mfma_f32_16x16x32_bf16 v[84:87], a[116:119], v[164:167], v[84:87]
  s_waitcnt lgkmcnt(7)
  v_mfma_f32_16x16x32_bf16 v[88:91], a[108:111], v[168:171], v[88:91]
  ds_read_b128 v[184:187], v17 offset:12288
  v_mfma_f32_16x16x32_bf16 v[92:95], a[112:115], v[168:171], v[92:95]
  v_mfma_f32_16x16x32_bf16 v[96:99], a[116:119], v[168:171], v[96:99]
  s_waitcnt lgkmcnt(6)
  v_mfma_f32_16x16x32_bf16 v[36:39], v[216:219], v[56:59], v[36:39]
  v_mfma_f32_16x16x32_bf16 v[44:47], v[216:219], v[60:63], v[44:47]
  v_mfma_f32_16x16x32_bf16 v[48:51], v[220:223], v[60:63], v[48:51]
  v_mfma_f32_16x16x32_bf16 v[40:43], a[252:255], v[56:59], v[40:43]
  v_mfma_f32_16x16x32_bf16 v[52:55], a[252:255], v[60:63], v[52:55]
  s_waitcnt lgkmcnt(5)
  v_mfma_f32_16x16x32_bf16 v[100:103], a[108:111], v[172:175], v[100:103]
  ds_read_b128 v[188:191], v17 offset:14336
  v_mfma_f32_16x16x32_bf16 v[104:107], a[112:115], v[172:175], v[104:107]
  v_mfma_f32_16x16x32_bf16 v[108:111], a[116:119], v[172:175], v[108:111]
  s_waitcnt lgkmcnt(5)
  v_mfma_f32_16x16x32_bf16 v[112:115], a[108:111], v[176:179], v[112:115]
  s_waitcnt vmcnt(8)
  s_barrier
  ds_read_b128 v[160:163], v14 offset:0
  v_mfma_f32_16x16x32_bf16 v[116:119], a[112:115], v[176:179], v[116:119]
  v_mfma_f32_16x16x32_bf16 v[120:123], a[116:119], v[176:179], v[120:123]
  s_waitcnt lgkmcnt(4)
  v_mfma_f32_16x16x32_bf16 v[36:39], v[232:235], v[248:251], v[36:39]
  v_mfma_f32_16x16x32_bf16 v[44:47], v[232:235], v[252:255], v[44:47]
  v_mfma_f32_16x16x32_bf16 v[48:51], v[236:239], v[252:255], v[48:51]
  v_mfma_f32_16x16x32_bf16 v[40:43], v[244:247], v[248:251], v[40:43]
  v_mfma_f32_16x16x32_bf16 v[52:55], v[244:247], v[252:255], v[52:55]
  s_waitcnt lgkmcnt(3)
  v_mfma_f32_16x16x32_bf16 v[124:127], a[108:111], v[180:183], v[124:127]
  ds_read_b128 v[164:167], v14 offset:2048
  v_mfma_f32_16x16x32_bf16 v[128:131], a[112:115], v[180:183], v[128:131]
  v_mfma_f32_16x16x32_bf16 v[132:135], a[116:119], v[180:183], v[132:135]
  s_waitcnt lgkmcnt(3)
  v_cndmask_b32 v36, v31, v36, s[64:65]
  v_cndmask_b32 v48, v31, v48, s[64:65]
  v_mfma_f32_16x16x32_bf16 v[136:139], a[108:111], v[184:187], v[136:139]
  ds_read_b128 v[168:171], v14 offset:4096
  v_cndmask_b32 v37, v31, v37, s[66:67]
  v_mfma_f32_16x16x32_bf16 v[140:143], a[112:115], v[184:187], v[140:143]
  v_cndmask_b32 v49, v31, v49, s[66:67]
  v_cndmask_b32 v38, v31, v38, s[68:69]
  v_mfma_f32_16x16x32_bf16 v[144:147], a[116:119], v[184:187], v[144:147]
  s_waitcnt lgkmcnt(3)
  v_cndmask_b32 v50, v31, v50, s[68:69]
  v_cndmask_b32 v39, v31, v39, s[70:71]
  v_mfma_f32_16x16x32_bf16 v[148:151], a[108:111], v[188:191], v[148:151]
  ds_read_b128 v[172:175], v14 offset:6144
  v_cndmask_b32 v51, v31, v51, s[70:71]
  v_mfma_f32_16x16x32_bf16 v[152:155], a[112:115], v[188:191], v[152:155]
  v_max3_f32 v34, v36, v37, v38
  v_max3_f32 v34, v34, v39, v40
  v_mfma_f32_16x16x32_bf16 v[156:159], a[116:119], v[188:191], v[156:159]
  s_waitcnt lgkmcnt(3)
  v_max3_f32 v34, v34, v41, v42
  v_max_f32 v34, v34, v43
  v_mfma_f32_16x16x32_bf16 v[64:67], a[120:123], v[160:163], v[64:67]
  ds_read_b128 v[176:179], v14 offset:8192
  v_mov_b32 v35, v34
  v_mfma_f32_16x16x32_bf16 v[68:71], a[124:127], v[160:163], v[68:71]
  s_add_u32 m0, s31, 49152
  v_permlane32_swap_b32 v34, v35
  v_max_f32 v34, v34, v35
  v_mfma_f32_16x16x32_bf16 v[72:75], a[128:131], v[160:163], v[72:75]
  s_waitcnt lgkmcnt(3)
  buffer_load_dwordx4 v10, s[8:11], s30 offen lds
  v_mov_b32 v35, v34
  v_mfma_f32_16x16x32_bf16 v[76:79], a[120:123], v[164:167], v[76:79]
  ds_read_b128 v[180:183], v14 offset:10240
  v_permlane16_swap_b32 v34, v35
  v_mfma_f32_16x16x32_bf16 v[80:83], a[124:127], v[164:167], v[80:83]
  v_max_f32 v34, v34, v35
  v_mul_f32 v34, s83, v34
  v_mfma_f32_16x16x32_bf16 v[84:87], a[128:131], v[164:167], v[84:87]
  s_waitcnt lgkmcnt(3)
  v_fma_f32 v36, v36, s83, -v34
  v_fma_f32 v37, v37, s83, -v34
  v_mfma_f32_16x16x32_bf16 v[88:91], a[120:123], v[168:171], v[88:91]
  ds_read_b128 v[184:187], v14 offset:12288
  v_fma_f32 v38, v38, s83, -v34
  v_mfma_f32_16x16x32_bf16 v[92:95], a[124:127], v[168:171], v[92:95]
  s_add_u32 m0, s31, 50176
  v_fma_f32 v39, v39, s83, -v34
  v_fma_f32 v40, v40, s83, -v34
  v_mfma_f32_16x16x32_bf16 v[96:99], a[128:131], v[168:171], v[96:99]
  s_waitcnt lgkmcnt(3)
  buffer_load_dwordx4 v11, s[8:11], s30 offen lds
  v_fma_f32 v41, v41, s83, -v34
  v_mfma_f32_16x16x32_bf16 v[100:103], a[120:123], v[172:175], v[100:103]
  ds_read_b128 v[188:191], v14 offset:14336
  v_fma_f32 v42, v42, s83, -v34
  v_mfma_f32_16x16x32_bf16 v[104:107], a[124:127], v[172:175], v[104:107]
  v_fma_f32 v43, v43, s83, -v34
  v_mfma_f32_16x16x32_bf16 v[108:111], a[128:131], v[172:175], v[108:111]
  s_waitcnt lgkmcnt(3)
  v_exp_f32 v36, v36
  v_mfma_f32_16x16x32_bf16 v[112:115], a[120:123], v[176:179], v[112:115]
  ds_read_b128 v[160:163], v15 offset:0
  v_mfma_f32_16x16x32_bf16 v[116:119], a[124:127], v[176:179], v[116:119]
  s_add_u32 m0, s31, 51200
  v_exp_f32 v37, v37
  v_mfma_f32_16x16x32_bf16 v[120:123], a[128:131], v[176:179], v[120:123]
  s_waitcnt lgkmcnt(3)
  buffer_load_dwordx4 v12, s[8:11], s30 offen lds
  v_mfma_f32_16x16x32_bf16 v[124:127], a[120:123], v[180:183], v[124:127]
  ds_read_b128 v[164:167], v15 offset:2048
  v_mfma_f32_16x16x32_bf16 v[128:131], a[124:127], v[180:183], v[128:131]
  v_exp_f32 v38, v38
  v_mfma_f32_16x16x32_bf16 v[132:135], a[128:131], v[180:183], v[132:135]
  s_waitcnt lgkmcnt(3)
  v_exp_f32 v39, v39
  v_mfma_f32_16x16x32_bf16 v[136:139], a[120:123], v[184:187], v[136:139]
  ds_read_b128 v[168:171], v15 offset:4096
  v_mfma_f32_16x16x32_bf16 v[140:143], a[124:127], v[184:187], v[140:143]
  s_add_u32 m0, s31, 52224
  v_exp_f32 v40, v40
  v_mfma_f32_16x16x32_bf16 v[144:147], a[128:131], v[184:187], v[144:147]
  s_waitcnt lgkmcnt(3)
  buffer_load_dwordx4 v13, s[8:11], s30 offen lds
  v_mfma_f32_16x16x32_bf16 v[148:151], a[120:123], v[188:191], v[148:151]
  s_add_u32 s30, s30, 128
  ds_read_b128 v[172:175], v15 offset:6144
  v_mfma_f32_16x16x32_bf16 v[152:155], a[124:127], v[188:191], v[152:155]
  v_exp_f32 v41, v41
  v_mfma_f32_16x16x32_bf16 v[156:159], a[128:131], v[188:191], v[156:159]
  s_waitcnt lgkmcnt(3)
  v_exp_f32 v42, v42
  v_mfma_f32_16x16x32_bf16 v[64:67], a[132:135], v[160:163], v[64:67]
  ds_read_b128 v[176:179], v15 offset:8192
  v_mfma_f32_16x16x32_bf16 v[68:71], a[136:139], v[160:163], v[68:71]
  v_exp_f32 v43, v43
  v_mfma_f32_16x16x32_bf16 v[72:75], a[140:143], v[160:163], v[72:75]
  s_waitcnt lgkmcnt(3)
  v_add_f32 v34, v40, v41
  v_add_f32 v34, v34, v42
  v_mfma_f32_16x16x32_bf16 v[76:79], a[132:135], v[164:167], v[76:79]
  ds_read_b128 v[180:183], v15 offset:10240
  v_add_f32 v34, v34, v43
  v_mfma_f32_16x16x32_bf16 v[80:83], a[136:139], v[164:167], v[80:83]
  v_cndmask_b32 v34, 0, v34, s[62:63]
  v_add_f32 v34, v34, v36
  v_mfma_f32_16x16x32_bf16 v[84:87], a[140:143], v[164:167], v[84:87]
  s_waitcnt lgkmcnt(3)
  v_add_f32 v34, v34, v37
  v_add_f32 v34, v34, v38
  v_mfma_f32_16x16x32_bf16 v[88:91], a[132:135], v[168:171], v[88:91]
  ds_read_b128 v[184:187], v15 offset:12288
  v_add_f32 v34, v34, v39
  v_mfma_f32_16x16x32_bf16 v[92:95], a[136:139], v[168:171], v[92:95]
  v_mov_b32 v35, v34
  v_mfma_f32_16x16x32_bf16 v[96:99], a[140:143], v[168:171], v[96:99]
  s_waitcnt lgkmcnt(3)
  v_permlane32_swap_b32 v34, v35
  v_add_f32 v34, v34, v35
  v_mfma_f32_16x16x32_bf16 v[100:103], a[132:135], v[172:175], v[100:103]
  ds_read_b128 v[188:191], v15 offset:14336
  v_mov_b32 v35, v34
  v_mfma_f32_16x16x32_bf16 v[104:107], a[136:139], v[172:175], v[104:107]
  v_permlane16_swap_b32 v34, v35
  v_add_f32 v34, v34, v35
  v_mfma_f32_16x16x32_bf16 v[108:111], a[140:143], v[172:175], v[108:111]
  s_waitcnt lgkmcnt(3)
  v_rcp_f32 v34, v34
  v_mfma_f32_16x16x32_bf16 v[112:115], a[132:135], v[176:179], v[112:115]
  s_waitcnt vmcnt(8)
  s_barrier
  ds_read_b128 v[160:163], v14 offset:16384
  v_mfma_f32_16x16x32_bf16 v[116:119], a[136:139], v[176:179], v[116:119]
  v_mul_f32 v36, v36, v34
  v_mul_f32 v37, v37, v34
  v_mfma_f32_16x16x32_bf16 v[120:123], a[140:143], v[176:179], v[120:123]
  s_waitcnt lgkmcnt(3)
  v_mul_f32 v38, v38, v34
  v_mul_f32 v39, v39, v34
  v_mfma_f32_16x16x32_bf16 v[124:127], a[132:135], v[180:183], v[124:127]
  ds_read_b128 v[164:167], v14 offset:18432
  v_mul_f32 v40, v40, v34
  v_mfma_f32_16x16x32_bf16 v[128:131], a[136:139], v[180:183], v[128:131]
  v_mul_f32 v41, v41, v34
  v_mul_f32 v42, v42, v34
  v_mfma_f32_16x16x32_bf16 v[132:135], a[140:143], v[180:183], v[132:135]
  s_waitcnt lgkmcnt(3)
  v_mul_f32 v43, v43, v34
  v_max3_f32 v34, v44, v45, v46
  v_mfma_f32_16x16x32_bf16 v[136:139], a[132:135], v[184:187], v[136:139]
  ds_read_b128 v[168:171], v14 offset:20480
  v_max3_f32 v34, v34, v47, v48
  v_mfma_f32_16x16x32_bf16 v[140:143], a[136:139], v[184:187], v[140:143]
  v_max3_f32 v34, v34, v49, v50
  v_max3_f32 v34, v34, v51, v52
  v_mfma_f32_16x16x32_bf16 v[144:147], a[140:143], v[184:187], v[144:147]
  s_waitcnt lgkmcnt(3)
  v_max3_f32 v34, v34, v53, v54
  v_max_f32 v34, v34, v55
  v_mfma_f32_16x16x32_bf16 v[148:151], a[132:135], v[188:191], v[148:151]
  ds_read_b128 v[172:175], v14 offset:22528
  v_mov_b32 v35, v34
  v_mfma_f32_16x16x32_bf16 v[152:155], a[136:139], v[188:191], v[152:155]
  v_permlane32_swap_b32 v34, v35
  v_max_f32 v34, v34, v35
  v_mfma_f32_16x16x32_bf16 v[156:159], a[140:143], v[188:191], v[156:159]
  s_waitcnt lgkmcnt(3)
  v_mov_b32 v35, v34
  v_mfma_f32_16x16x32_bf16 v[64:67], a[144:147], v[160:163], v[64:67]
  ds_read_b128 v[176:179], v14 offset:24576
  v_permlane16_swap_b32 v34, v35
  v_mfma_f32_16x16x32_bf16 v[68:71], a[148:151], v[160:163], v[68:71]
  s_add_u32 m0, s31, 65536
  v_max_f32 v34, v34, v35
  v_mul_f32 v34, s83, v34
  v_mfma_f32_16x16x32_bf16 v[72:75], a[152:155], v[160:163], v[72:75]
  s_waitcnt lgkmcnt(3)
  buffer_load_dwordx4 v10, s[8:11], s30 offen lds
  v_fma_f32 v44, v44, s83, -v34
  v_mfma_f32_16x16x32_bf16 v[76:79], a[144:147], v[164:167], v[76:79]
  ds_read_b128 v[180:183], v14 offset:26624
  v_fma_f32 v45, v45, s83, -v34
  v_mfma_f32_16x16x32_bf16 v[80:83], a[148:151], v[164:167], v[80:83]
  v_fma_f32 v46, v46, s83, -v34
  v_fma_f32 v47, v47, s83, -v34
  v_mfma_f32_16x16x32_bf16 v[84:87], a[152:155], v[164:167], v[84:87]
  s_waitcnt lgkmcnt(3)
  v_fma_f32 v48, v48, s83, -v34
  v_fma_f32 v49, v49, s83, -v34
  v_mfma_f32_16x16x32_bf16 v[88:91], a[144:147], v[168:171], v[88:91]
  ds_read_b128 v[184:187], v14 offset:28672
  v_fma_f32 v50, v50, s83, -v34
  v_mfma_f32_16x16x32_bf16 v[92:95], a[148:151], v[168:171], v[92:95]
  s_add_u32 m0, s31, 66560
  v_fma_f32 v51, v51, s83, -v34
  v_fma_f32 v52, v52, s83, -v34
  v_mfma_f32_16x16x32_bf16 v[96:99], a[152:155], v[168:171], v[96:99]
  s_waitcnt lgkmcnt(3)
  buffer_load_dwordx4 v11, s[8:11], s30 offen lds
  v_fma_f32 v53, v53, s83, -v34
  v_mfma_f32_16x16x32_bf16 v[100:103], a[144:147], v[172:175], v[100:103]
  ds_read_b128 v[188:191], v14 offset:30720
  v_fma_f32 v54, v54, s83, -v34
  v_mfma_f32_16x16x32_bf16 v[104:107], a[148:151], v[172:175], v[104:107]
  v_fma_f32 v55, v55, s83, -v34
  v_mfma_f32_16x16x32_bf16 v[108:111], a[152:155], v[172:175], v[108:111]
  s_waitcnt lgkmcnt(3)
  v_exp_f32 v44, v44
  v_mfma_f32_16x16x32_bf16 v[112:115], a[144:147], v[176:179], v[112:115]
  ds_read_b128 v[160:163], v15 offset:16384
  v_mfma_f32_16x16x32_bf16 v[116:119], a[148:151], v[176:179], v[116:119]
  s_add_u32 m0, s31, 67584
  v_exp_f32 v45, v45
  v_mfma_f32_16x16x32_bf16 v[120:123], a[152:155], v[176:179], v[120:123]
  s_waitcnt lgkmcnt(3)
  buffer_load_dwordx4 v12, s[8:11], s30 offen lds
  v_mfma_f32_16x16x32_bf16 v[124:127], a[144:147], v[180:183], v[124:127]
  ds_read_b128 v[164:167], v15 offset:18432
  v_mfma_f32_16x16x32_bf16 v[128:131], a[148:151], v[180:183], v[128:131]
  v_exp_f32 v46, v46
  v_mfma_f32_16x16x32_bf16 v[132:135], a[152:155], v[180:183], v[132:135]
  s_waitcnt lgkmcnt(3)
  v_exp_f32 v47, v47
  v_mfma_f32_16x16x32_bf16 v[136:139], a[144:147], v[184:187], v[136:139]
  ds_read_b128 v[168:171], v15 offset:20480
  v_mfma_f32_16x16x32_bf16 v[140:143], a[148:151], v[184:187], v[140:143]
  s_add_u32 m0, s31, 68608
  v_exp_f32 v48, v48
  v_mfma_f32_16x16x32_bf16 v[144:147], a[152:155], v[184:187], v[144:147]
  s_waitcnt lgkmcnt(3)
  buffer_load_dwordx4 v13, s[8:11], s30 offen lds
  v_mfma_f32_16x16x32_bf16 v[148:151], a[144:147], v[188:191], v[148:151]
  s_add_u32 s30, s30, s25
  ds_read_b128 v[172:175], v15 offset:22528
  v_mfma_f32_16x16x32_bf16 v[152:155], a[148:151], v[188:191], v[152:155]
  v_exp_f32 v49, v49
  v_mfma_f32_16x16x32_bf16 v[156:159], a[152:155], v[188:191], v[156:159]
  s_waitcnt lgkmcnt(3)
  v_exp_f32 v50, v50
  v_mfma_f32_16x16x32_bf16 v[64:67], a[156:159], v[160:163], v[64:67]
  ds_read_b128 v[176:179], v15 offset:24576
  v_mfma_f32_16x16x32_bf16 v[68:71], a[160:163], v[160:163], v[68:71]
  v_exp_f32 v51, v51
  v_mfma_f32_16x16x32_bf16 v[72:75], a[164:167], v[160:163], v[72:75]
  s_waitcnt lgkmcnt(3)
  v_exp_f32 v52, v52
  v_mfma_f32_16x16x32_bf16 v[76:79], a[156:159], v[164:167], v[76:79]
  ds_read_b128 v[180:183], v15 offset:26624
  v_mfma_f32_16x16x32_bf16 v[80:83], a[160:163], v[164:167], v[80:83]
  v_exp_f32 v53, v53
  v_mfma_f32_16x16x32_bf16 v[84:87], a[164:167], v[164:167], v[84:87]
  s_waitcnt lgkmcnt(3)
  v_exp_f32 v54, v54
  v_mfma_f32_16x16x32_bf16 v[88:91], a[156:159], v[168:171], v[88:91]
  ds_read_b128 v[184:187], v15 offset:28672
  v_mfma_f32_16x16x32_bf16 v[92:95], a[160:163], v[168:171], v[92:95]
  v_exp_f32 v55, v55
  v_mfma_f32_16x16x32_bf16 v[96:99], a[164:167], v[168:171], v[96:99]
  s_waitcnt lgkmcnt(3)
  v_add_f32 v34, v52, v53
  v_add_f32 v34, v34, v54
  v_mfma_f32_16x16x32_bf16 v[100:103], a[156:159], v[172:175], v[100:103]
  ds_read_b128 v[188:191], v15 offset:30720
  v_add_f32 v34, v34, v55
  v_mfma_f32_16x16x32_bf16 v[104:107], a[160:163], v[172:175], v[104:107]
  v_cndmask_b32 v34, 0, v34, s[62:63]
  v_add_f32 v34, v34, v44
  v_mfma_f32_16x16x32_bf16 v[108:111], a[164:167], v[172:175], v[108:111]
  s_waitcnt lgkmcnt(3)
  v_add_f32 v34, v34, v45
  v_add_f32 v34, v34, v46
  v_mfma_f32_16x16x32_bf16 v[112:115], a[156:159], v[176:179], v[112:115]
  s_waitcnt vmcnt(8)
  s_barrier
  ds_read_b128 v[160:163], v14 offset:32768
  v_mfma_f32_16x16x32_bf16 v[116:119], a[160:163], v[176:179], v[116:119]
  v_add_f32 v34, v34, v47
  v_add_f32 v34, v34, v48
  v_mfma_f32_16x16x32_bf16 v[120:123], a[164:167], v[176:179], v[120:123]
  s_waitcnt lgkmcnt(3)
  v_add_f32 v34, v34, v49
  v_add_f32 v34, v34, v50
  v_mfma_f32_16x16x32_bf16 v[124:127], a[156:159], v[180:183], v[124:127]
  ds_read_b128 v[164:167], v14 offset:34816
  v_add_f32 v34, v34, v51
  v_mfma_f32_16x16x32_bf16 v[128:131], a[160:163], v[180:183], v[128:131]
  v_mov_b32 v35, v34
  v_mfma_f32_16x16x32_bf16 v[132:135], a[164:167], v[180:183], v[132:135]
  s_waitcnt lgkmcnt(3)
  v_permlane32_swap_b32 v34, v35
  v_add_f32 v34, v34, v35
  v_mfma_f32_16x16x32_bf16 v[136:139], a[156:159], v[184:187], v[136:139]
  ds_read_b128 v[168:171], v14 offset:36864
  v_mov_b32 v35, v34
  v_mfma_f32_16x16x32_bf16 v[140:143], a[160:163], v[184:187], v[140:143]
  v_permlane16_swap_b32 v34, v35
  v_add_f32 v34, v34, v35
  v_mfma_f32_16x16x32_bf16 v[144:147], a[164:167], v[184:187], v[144:147]
  s_waitcnt lgkmcnt(3)
  v_rcp_f32 v34, v34
  v_mfma_f32_16x16x32_bf16 v[148:151], a[156:159], v[188:191], v[148:151]
  ds_read_b128 v[172:175], v14 offset:38912
  v_mul_f32 v44, v44, v34
  v_mfma_f32_16x16x32_bf16 v[152:155], a[160:163], v[188:191], v[152:155]
  v_mul_f32 v45, v45, v34
  v_mul_f32 v46, v46, v34
  v_mfma_f32_16x16x32_bf16 v[156:159], a[164:167], v[188:191], v[156:159]
  s_waitcnt lgkmcnt(3)
  v_mul_f32 v47, v47, v34
  v_mul_f32 v48, v48, v34
  v_mfma_f32_16x16x32_bf16 v[64:67], a[168:171], v[160:163], v[64:67]
  ds_read_b128 v[176:179], v14 offset:40960
  v_mul_f32 v49, v49, v34
  v_mfma_f32_16x16x32_bf16 v[68:71], a[172:175], v[160:163], v[68:71]
  s_add_u32 m0, s31, 0
  v_mul_f32 v50, v50, v34
  v_mul_f32 v51, v51, v34
  v_mfma_f32_16x16x32_bf16 v[72:75], a[176:179], v[160:163], v[72:75]
  s_waitcnt lgkmcnt(3)
  buffer_load_dwordx4 v10, s[8:11], s30 offen lds
  v_mul_f32 v52, v52, v34
  v_mfma_f32_16x16x32_bf16 v[76:79], a[168:171], v[164:167], v[76:79]
  ds_read_b128 v[180:183], v14 offset:43008
  v_mul_f32 v53, v53, v34
  v_mfma_f32_16x16x32_bf16 v[80:83], a[172:175], v[164:167], v[80:83]
  v_mul_f32 v54, v54, v34
  v_mul_f32 v55, v55, v34
  v_mfma_f32_16x16x32_bf16 v[84:87], a[176:179], v[164:167], v[84:87]
  s_waitcnt lgkmcnt(3)
  v_cvt_pk_bf16_f32 v56, v44, v45
  v_cvt_pk_bf16_f32 v57, v46, v47
  v_mfma_f32_16x16x32_bf16 v[88:91], a[168:171], v[168:171], v[88:91]
  ds_read_b128 v[184:187], v14 offset:45056
  v_cvt_pk_bf16_f32 v58, v48, v49
  v_mfma_f32_16x16x32_bf16 v[92:95], a[172:175], v[168:171], v[92:95]
  s_add_u32 m0, s31, 1024
  v_cvt_pk_bf16_f32 v59, v50, v51
  v_cvt_pk_bf16_f32 v60, v40, v41
  v_mfma_f32_16x16x32_bf16 v[96:99], a[176:179], v[168:171], v[96:99]
  s_waitcnt lgkmcnt(3)
  buffer_load_dwordx4 v11, s[8:11], s30 offen lds
  v_cvt_pk_bf16_f32 v61, v42, v43
  v_mfma_f32_16x16x32_bf16 v[100:103], a[168:171], v[172:175], v[100:103]
  ds_read_b128 v[188:191], v14 offset:47104
  v_cvt_pk_bf16_f32 v62, v52, v53
  v_mfma_f32_16x16x32_bf16 v[104:107], a[172:175], v[172:175], v[104:107]
  v_cvt_pk_bf16_f32 v63, v54, v55
  v_cvt_pk_bf16_f32 v248, v36, v37
  v_mfma_f32_16x16x32_bf16 v[108:111], a[176:179], v[172:175], v[108:111]
  s_waitcnt lgkmcnt(3)
  v_cvt_pk_bf16_f32 v249, v38, v39
  buffer_store_dwordx4 v[56:59], v26, s[56:59], s81 offen sc1
  v_mfma_f32_16x16x32_bf16 v[112:115], a[168:171], v[176:179], v[112:115]
  ds_read_b128 v[160:163], v15 offset:32768
  buffer_store_dwordx4 v[60:63], v26, s[56:59], s81 offen offset:1024 sc1
  v_mfma_f32_16x16x32_bf16 v[116:119], a[172:175], v[176:179], v[116:119]
  s_add_u32 m0, s31, 2048
  buffer_store_dwordx2 v[248:249], v29, s[56:59], s81 offen offset:2048 sc1
  v_mfma_f32_16x16x32_bf16 v[120:123], a[176:179], v[176:179], v[120:123]
  s_waitcnt lgkmcnt(3)
  buffer_load_dwordx4 v12, s[8:11], s30 offen lds
  v_mfma_f32_16x16x32_bf16 v[124:127], a[168:171], v[180:183], v[124:127]
  ds_read_b128 v[164:167], v15 offset:34816
  v_mfma_f32_16x16x32_bf16 v[128:131], a[172:175], v[180:183], v[128:131]
  v_mfma_f32_16x16x32_bf16 v[132:135], a[176:179], v[180:183], v[132:135]
  s_waitcnt lgkmcnt(3)
  v_mfma_f32_16x16x32_bf16 v[136:139], a[168:171], v[184:187], v[136:139]
  ds_read_b128 v[168:171], v15 offset:36864
  v_mfma_f32_16x16x32_bf16 v[140:143], a[172:175], v[184:187], v[140:143]
  s_add_u32 m0, s31, 3072
  v_mfma_f32_16x16x32_bf16 v[144:147], a[176:179], v[184:187], v[144:147]
  s_waitcnt lgkmcnt(3)
  buffer_load_dwordx4 v13, s[8:11], s30 offen lds
  v_mfma_f32_16x16x32_bf16 v[148:151], a[168:171], v[188:191], v[148:151]
  s_add_u32 s30, s30, 128
  ds_read_b128 v[172:175], v15 offset:38912
  v_mfma_f32_16x16x32_bf16 v[152:155], a[172:175], v[188:191], v[152:155]
  v_mfma_f32_16x16x32_bf16 v[156:159], a[176:179], v[188:191], v[156:159]
  s_waitcnt lgkmcnt(3)
  v_mfma_f32_16x16x32_bf16 v[64:67], a[180:183], v[160:163], v[64:67]
  ds_read_b128 v[176:179], v15 offset:40960
  v_mfma_f32_16x16x32_bf16 v[68:71], a[184:187], v[160:163], v[68:71]
  v_mfma_f32_16x16x32_bf16 v[72:75], a[188:191], v[160:163], v[72:75]
  s_waitcnt lgkmcnt(3)
  v_mfma_f32_16x16x32_bf16 v[76:79], a[180:183], v[164:167], v[76:79]
  ds_read_b128 v[180:183], v15 offset:43008
  v_mfma_f32_16x16x32_bf16 v[80:83], a[184:187], v[164:167], v[80:83]
  v_mfma_f32_16x16x32_bf16 v[84:87], a[188:191], v[164:167], v[84:87]
  s_waitcnt lgkmcnt(3)
  v_mfma_f32_16x16x32_bf16 v[88:91], a[180:183], v[168:171], v[88:91]
  ds_read_b128 v[184:187], v15 offset:45056
  v_mfma_f32_16x16x32_bf16 v[92:95], a[184:187], v[168:171], v[92:95]
  v_mfma_f32_16x16x32_bf16 v[96:99], a[188:191], v[168:171], v[96:99]
  s_waitcnt lgkmcnt(3)
  v_mfma_f32_16x16x32_bf16 v[100:103], a[180:183], v[172:175], v[100:103]
  ds_read_b128 v[188:191], v15 offset:47104
  v_mfma_f32_16x16x32_bf16 v[104:107], a[184:187], v[172:175], v[104:107]
  v_mfma_f32_16x16x32_bf16 v[108:111], a[188:191], v[172:175], v[108:111]
  s_waitcnt lgkmcnt(3)
  v_mfma_f32_16x16x32_bf16 v[112:115], a[180:183], v[176:179], v[112:115]
  s_waitcnt vmcnt(11)
  s_barrier
  ds_read_b128 v[160:163], v14 offset:49152
  v_mfma_f32_16x16x32_bf16 v[116:119], a[184:187], v[176:179], v[116:119]
  v_mfma_f32_16x16x32_bf16 v[120:123], a[188:191], v[176:179], v[120:123]
  s_waitcnt lgkmcnt(3)
  v_mfma_f32_16x16x32_bf16 v[124:127], a[180:183], v[180:183], v[124:127]
  ds_read_b128 v[164:167], v14 offset:51200
  v_mfma_f32_16x16x32_bf16 v[128:131], a[184:187], v[180:183], v[128:131]
  v_mfma_f32_16x16x32_bf16 v[132:135], a[188:191], v[180:183], v[132:135]
  s_waitcnt lgkmcnt(3)
  v_mfma_f32_16x16x32_bf16 v[136:139], a[180:183], v[184:187], v[136:139]
  ds_read_b128 v[168:171], v14 offset:53248
  v_mfma_f32_16x16x32_bf16 v[140:143], a[184:187], v[184:187], v[140:143]
  v_mfma_f32_16x16x32_bf16 v[144:147], a[188:191], v[184:187], v[144:147]
  s_waitcnt lgkmcnt(3)
  v_mfma_f32_16x16x32_bf16 v[148:151], a[180:183], v[188:191], v[148:151]
  ds_read_b128 v[172:175], v14 offset:55296
  v_mfma_f32_16x16x32_bf16 v[152:155], a[184:187], v[188:191], v[152:155]
  v_mfma_f32_16x16x32_bf16 v[156:159], a[188:191], v[188:191], v[156:159]
  s_waitcnt lgkmcnt(3)
  v_mfma_f32_16x16x32_bf16 v[64:67], a[192:195], v[160:163], v[64:67]
  ds_read_b128 v[176:179], v14 offset:57344
  v_mfma_f32_16x16x32_bf16 v[68:71], a[196:199], v[160:163], v[68:71]
  s_add_u32 m0, s31, 16384
  v_mfma_f32_16x16x32_bf16 v[72:75], a[200:203], v[160:163], v[72:75]
  s_waitcnt lgkmcnt(3)
  buffer_load_dwordx4 v10, s[8:11], s30 offen lds
  v_mfma_f32_16x16x32_bf16 v[76:79], a[192:195], v[164:167], v[76:79]
  ds_read_b128 v[180:183], v14 offset:59392
  v_mfma_f32_16x16x32_bf16 v[80:83], a[196:199], v[164:167], v[80:83]
  v_mfma_f32_16x16x32_bf16 v[84:87], a[200:203], v[164:167], v[84:87]
  s_waitcnt lgkmcnt(3)
  v_mfma_f32_16x16x32_bf16 v[88:91], a[192:195], v[168:171], v[88:91]
  ds_read_b128 v[184:187], v14 offset:61440
  v_mfma_f32_16x16x32_bf16 v[92:95], a[196:199], v[168:171], v[92:95]
  s_add_u32 m0, s31, 17408
  v_mfma_f32_16x16x32_bf16 v[96:99], a[200:203], v[168:171], v[96:99]
  s_waitcnt lgkmcnt(3)
  buffer_load_dwordx4 v11, s[8:11], s30 offen lds
  v_mfma_f32_16x16x32_bf16 v[100:103], a[192:195], v[172:175], v[100:103]
  ds_read_b128 v[188:191], v14 offset:63488
  v_mfma_f32_16x16x32_bf16 v[104:107], a[196:199], v[172:175], v[104:107]
  v_mfma_f32_16x16x32_bf16 v[108:111], a[200:203], v[172:175], v[108:111]
  s_waitcnt lgkmcnt(3)
  v_mfma_f32_16x16x32_bf16 v[112:115], a[192:195], v[176:179], v[112:115]
  ds_read_b128 v[160:163], v15 offset:49152
  v_mfma_f32_16x16x32_bf16 v[116:119], a[196:199], v[176:179], v[116:119]
  s_add_u32 m0, s31, 18432
  v_mfma_f32_16x16x32_bf16 v[120:123], a[200:203], v[176:179], v[120:123]
  s_waitcnt lgkmcnt(3)
  buffer_load_dwordx4 v12, s[8:11], s30 offen lds
  v_mfma_f32_16x16x32_bf16 v[124:127], a[192:195], v[180:183], v[124:127]
  ds_read_b128 v[164:167], v15 offset:51200
  v_mfma_f32_16x16x32_bf16 v[128:131], a[196:199], v[180:183], v[128:131]
  v_mfma_f32_16x16x32_bf16 v[132:135], a[200:203], v[180:183], v[132:135]
  s_waitcnt lgkmcnt(3)
  v_mfma_f32_16x16x32_bf16 v[136:139], a[192:195], v[184:187], v[136:139]
  ds_read_b128 v[168:171], v15 offset:53248
  v_mfma_f32_16x16x32_bf16 v[140:143], a[196:199], v[184:187], v[140:143]
  s_add_u32 m0, s31, 19456
  v_mfma_f32_16x16x32_bf16 v[144:147], a[200:203], v[184:187], v[144:147]
  s_waitcnt lgkmcnt(3)
  buffer_load_dwordx4 v13, s[8:11], s30 offen lds
  v_mfma_f32_16x16x32_bf16 v[148:151], a[192:195], v[188:191], v[148:151]
  s_add_u32 s30, s30, 128
  ds_read_b128 v[172:175], v15 offset:55296
  v_mfma_f32_16x16x32_bf16 v[152:155], a[196:199], v[188:191], v[152:155]
  v_mfma_f32_16x16x32_bf16 v[156:159], a[200:203], v[188:191], v[156:159]
  s_waitcnt lgkmcnt(3)
  v_mfma_f32_16x16x32_bf16 v[64:67], a[204:207], v[160:163], v[64:67]
  ds_read_b128 v[176:179], v15 offset:57344
  v_mfma_f32_16x16x32_bf16 v[68:71], a[208:211], v[160:163], v[68:71]
  v_mfma_f32_16x16x32_bf16 v[72:75], a[212:215], v[160:163], v[72:75]
  s_waitcnt lgkmcnt(3)
  v_mfma_f32_16x16x32_bf16 v[76:79], a[204:207], v[164:167], v[76:79]
  ds_read_b128 v[180:183], v15 offset:59392
  v_mfma_f32_16x16x32_bf16 v[80:83], a[208:211], v[164:167], v[80:83]
  v_mfma_f32_16x16x32_bf16 v[84:87], a[212:215], v[164:167], v[84:87]
  s_waitcnt lgkmcnt(3)
  v_mfma_f32_16x16x32_bf16 v[88:91], a[204:207], v[168:171], v[88:91]
  ds_read_b128 v[184:187], v15 offset:61440
  v_mfma_f32_16x16x32_bf16 v[92:95], a[208:211], v[168:171], v[92:95]
  v_mfma_f32_16x16x32_bf16 v[96:99], a[212:215], v[168:171], v[96:99]
  s_waitcnt lgkmcnt(3)
  v_mfma_f32_16x16x32_bf16 v[100:103], a[204:207], v[172:175], v[100:103]
  ds_read_b128 v[188:191], v15 offset:63488
  v_mfma_f32_16x16x32_bf16 v[104:107], a[208:211], v[172:175], v[104:107]
  v_mfma_f32_16x16x32_bf16 v[108:111], a[212:215], v[172:175], v[108:111]
  s_waitcnt lgkmcnt(3)
  v_mfma_f32_16x16x32_bf16 v[112:115], a[204:207], v[176:179], v[112:115]
  s_waitcnt vmcnt(11)
  s_barrier
  ds_read_b128 v[160:163], v16 offset:0
  v_mfma_f32_16x16x32_bf16 v[116:119], a[208:211], v[176:179], v[116:119]
  v_mfma_f32_16x16x32_bf16 v[120:123], a[212:215], v[176:179], v[120:123]
  s_waitcnt lgkmcnt(3)
  v_mfma_f32_16x16x32_bf16 v[124:127], a[204:207], v[180:183], v[124:127]
  ds_read_b128 v[164:167], v16 offset:2048
  v_mfma_f32_16x16x32_bf16 v[128:131], a[208:211], v[180:183], v[128:131]
  v_mfma_f32_16x16x32_bf16 v[132:135], a[212:215], v[180:183], v[132:135]
  s_waitcnt lgkmcnt(3)
  v_mfma_f32_16x16x32_bf16 v[136:139], a[204:207], v[184:187], v[136:139]
  ds_read_b128 v[168:171], v16 offset:4096
  v_mfma_f32_16x16x32_bf16 v[140:143], a[208:211], v[184:187], v[140:143]
  v_mfma_f32_16x16x32_bf16 v[144:147], a[212:215], v[184:187], v[144:147]
  s_waitcnt lgkmcnt(3)
  v_mfma_f32_16x16x32_bf16 v[148:151], a[204:207], v[188:191], v[148:151]
  ds_read_b128 v[172:175], v16 offset:6144
  v_mfma_f32_16x16x32_bf16 v[152:155], a[208:211], v[188:191], v[152:155]
  v_mfma_f32_16x16x32_bf16 v[156:159], a[212:215], v[188:191], v[156:159]
  s_waitcnt lgkmcnt(3)
  v_mfma_f32_16x16x32_bf16 v[64:67], a[216:219], v[160:163], v[64:67]
  ds_read_b128 v[176:179], v16 offset:8192
  v_mfma_f32_16x16x32_bf16 v[68:71], a[220:223], v[160:163], v[68:71]
  s_add_u32 m0, s31, 32768
  v_mfma_f32_16x16x32_bf16 v[72:75], a[224:227], v[160:163], v[72:75]
  s_waitcnt lgkmcnt(3)
  buffer_load_dwordx4 v10, s[8:11], s30 offen lds
  v_mfma_f32_16x16x32_bf16 v[76:79], a[216:219], v[164:167], v[76:79]
  ds_read_b128 v[180:183], v16 offset:10240
  v_mfma_f32_16x16x32_bf16 v[80:83], a[220:223], v[164:167], v[80:83]
  v_mfma_f32_16x16x32_bf16 v[84:87], a[224:227], v[164:167], v[84:87]
  s_waitcnt lgkmcnt(3)
  v_mfma_f32_16x16x32_bf16 v[88:91], a[216:219], v[168:171], v[88:91]
  ds_read_b128 v[184:187], v16 offset:12288
  buffer_load_dword v32, v30, s[72:75], s77 offen sc1
  v_mfma_f32_16x16x32_bf16 v[92:95], a[220:223], v[168:171], v[92:95]
  s_add_u32 m0, s31, 33792
  s_waitcnt vmcnt(8)
  buffer_atomic_add v28, v33, s[72:75], s82 offen sc1
  v_mfma_f32_16x16x32_bf16 v[96:99], a[224:227], v[168:171], v[96:99]
  s_waitcnt lgkmcnt(3)
  buffer_load_dwordx4 v11, s[8:11], s30 offen lds
  s_mov_b32 s49, s43
  v_mfma_f32_16x16x32_bf16 v[100:103], a[216:219], v[172:175], v[100:103]
  ds_read_b128 v[188:191], v16 offset:14336
  s_add_u32 s43, s43, 4
  v_mfma_f32_16x16x32_bf16 v[104:107], a[220:223], v[172:175], v[104:107]
  s_mov_b32 s50, s45
  s_add_u32 s45, s45, 1572864
  s_mov_b32 s51, s46
  v_mfma_f32_16x16x32_bf16 v[108:111], a[224:227], v[172:175], v[108:111]
  s_waitcnt lgkmcnt(3)
  s_add_u32 s46, s46, 393216
  s_mov_b32 s81, s47
  v_mfma_f32_16x16x32_bf16 v[112:115], a[216:219], v[176:179], v[112:115]
  ds_read_b128 v[160:163], v17 offset:0
  s_add_u32 s47, s47, 327680
  v_mfma_f32_16x16x32_bf16 v[116:119], a[220:223], v[176:179], v[116:119]
  s_add_u32 m0, s31, 34816
  s_mov_b32 s82, s48
  s_add_u32 s48, s48, 4096
  v_mfma_f32_16x16x32_bf16 v[120:123], a[224:227], v[176:179], v[120:123]
  s_waitcnt lgkmcnt(3)
  buffer_load_dwordx4 v12, s[8:11], s30 offen lds
  v_mfma_f32_16x16x32_bf16 v[124:127], a[216:219], v[180:183], v[124:127]
  ds_read_b128 v[164:167], v17 offset:2048
  v_mfma_f32_16x16x32_bf16 v[128:131], a[220:223], v[180:183], v[128:131]
  v_mfma_f32_16x16x32_bf16 v[132:135], a[224:227], v[180:183], v[132:135]
  s_waitcnt lgkmcnt(3)
  v_mfma_f32_16x16x32_bf16 v[136:139], a[216:219], v[184:187], v[136:139]
  ds_read_b128 v[168:171], v17 offset:4096
  v_mfma_f32_16x16x32_bf16 v[140:143], a[220:223], v[184:187], v[140:143]
  s_add_u32 m0, s31, 35840
  v_mfma_f32_16x16x32_bf16 v[144:147], a[224:227], v[184:187], v[144:147]
  s_waitcnt lgkmcnt(3)
  buffer_load_dwordx4 v13, s[8:11], s30 offen lds
  v_mfma_f32_16x16x32_bf16 v[148:151], a[216:219], v[188:191], v[148:151]
  s_add_u32 s30, s30, 128
  ds_read_b128 v[172:175], v17 offset:6144
  v_mfma_f32_16x16x32_bf16 v[152:155], a[220:223], v[188:191], v[152:155]
  v_mfma_f32_16x16x32_bf16 v[156:159], a[224:227], v[188:191], v[156:159]
  s_waitcnt lgkmcnt(3)
  v_mfma_f32_16x16x32_bf16 v[64:67], a[228:231], v[160:163], v[64:67]
  ds_read_b128 v[176:179], v17 offset:8192
  v_mfma_f32_16x16x32_bf16 v[68:71], a[232:235], v[160:163], v[68:71]
  v_mfma_f32_16x16x32_bf16 v[72:75], a[236:239], v[160:163], v[72:75]
  s_waitcnt lgkmcnt(3)
  v_mfma_f32_16x16x32_bf16 v[76:79], a[228:231], v[164:167], v[76:79]
  ds_read_b128 v[180:183], v17 offset:10240
  v_cvt_pk_bf16_f32 v192, v64, v65
  v_mfma_f32_16x16x32_bf16 v[80:83], a[232:235], v[164:167], v[80:83]
  v_cvt_pk_bf16_f32 v193, v66, v67
  v_cvt_pk_bf16_f32 v194, v68, v69
  v_mfma_f32_16x16x32_bf16 v[84:87], a[236:239], v[164:167], v[84:87]
  s_waitcnt lgkmcnt(3)
  v_cvt_pk_bf16_f32 v195, v70, v71
  v_cvt_pk_bf16_f32 v200, v72, v73
  v_mfma_f32_16x16x32_bf16 v[88:91], a[228:231], v[168:171], v[88:91]
  ds_read_b128 v[184:187], v17 offset:12288
  v_cvt_pk_bf16_f32 v201, v74, v75
  v_mfma_f32_16x16x32_bf16 v[92:95], a[232:235], v[168:171], v[92:95]
  v_cvt_pk_bf16_f32 v196, v76, v77
  v_cvt_pk_bf16_f32 v197, v78, v79
  v_mfma_f32_16x16x32_bf16 v[96:99], a[236:239], v[168:171], v[96:99]
  s_waitcnt lgkmcnt(3)
  v_cvt_pk_bf16_f32 v198, v80, v81
  v_cvt_pk_bf16_f32 v199, v82, v83
  v_mfma_f32_16x16x32_bf16 v[100:103], a[228:231], v[172:175], v[100:103]
  ds_read_b128 v[188:191], v17 offset:14336
  v_cvt_pk_bf16_f32 v202, v84, v85
  v_mfma_f32_16x16x32_bf16 v[104:107], a[232:235], v[172:175], v[104:107]
  v_cvt_pk_bf16_f32 v203, v86, v87
  v_cvt_pk_bf16_f32 v204, v88, v89
  v_mfma_f32_16x16x32_bf16 v[108:111], a[236:239], v[172:175], v[108:111]
  s_waitcnt lgkmcnt(3)
  v_cvt_pk_bf16_f32 v205, v90, v91
  v_cvt_pk_bf16_f32 v206, v92, v93
  v_mfma_f32_16x16x32_bf16 v[112:115], a[228:231], v[176:179], v[112:115]
  s_waitcnt vmcnt(10)
  s_barrier
  ds_read_b128 v[160:163], v14 offset:0
  v_mfma_f32_16x16x32_bf16 v[116:119], a[232:235], v[176:179], v[116:119]
  v_cvt_pk_bf16_f32 v207, v94, v95
  v_cvt_pk_bf16_f32 v212, v96, v97
  v_mfma_f32_16x16x32_bf16 v[120:123], a[236:239], v[176:179], v[120:123]
  s_waitcnt lgkmcnt(3)
  v_cvt_pk_bf16_f32 v213, v98, v99
  v_cvt_pk_bf16_f32 v208, v100, v101
  v_mfma_f32_16x16x32_bf16 v[124:127], a[228:231], v[180:183], v[124:127]
  ds_read_b128 v[164:167], v14 offset:2048
  v_cvt_pk_bf16_f32 v209, v102, v103
  v_mfma_f32_16x16x32_bf16 v[128:131], a[232:235], v[180:183], v[128:131]
  v_cvt_pk_bf16_f32 v210, v104, v105
  v_cvt_pk_bf16_f32 v211, v106, v107
  v_mfma_f32_16x16x32_bf16 v[132:135], a[236:239], v[180:183], v[132:135]
  s_waitcnt lgkmcnt(3)
  v_cvt_pk_bf16_f32 v214, v108, v109
  v_cvt_pk_bf16_f32 v215, v110, v111
  v_mfma_f32_16x16x32_bf16 v[136:139], a[228:231], v[184:187], v[136:139]
  ds_read_b128 v[168:171], v14 offset:4096
  v_cvt_pk_bf16_f32 v216, v112, v113
  v_mfma_f32_16x16x32_bf16 v[140:143], a[232:235], v[184:187], v[140:143]
  v_cvt_pk_bf16_f32 v217, v114, v115
  v_cvt_pk_bf16_f32 v218, v116, v117
  v_mfma_f32_16x16x32_bf16 v[144:147], a[236:239], v[184:187], v[144:147]
  s_waitcnt lgkmcnt(3)
  v_cvt_pk_bf16_f32 v219, v118, v119
  v_cvt_pk_bf16_f32 v224, v120, v121
  v_mfma_f32_16x16x32_bf16 v[148:151], a[228:231], v[188:191], v[148:151]
  ds_read_b128 v[172:175], v14 offset:6144
  v_cvt_pk_bf16_f32 v225, v122, v123
  v_mfma_f32_16x16x32_bf16 v[152:155], a[232:235], v[188:191], v[152:155]
  s_sub_u32 s26, s26, 1
  s_cmp_gt_u32 s26, 0
  v_cvt_pk_bf16_f32 v220, v124, v125
  v_mfma_f32_16x16x32_bf16 v[156:159], a[236:239], v[188:191], v[156:159]
  s_waitcnt lgkmcnt(3)
  s_cbranch_scc1 qa_227
  s_nop 7
  v_cvt_pk_bf16_f32 v221, v126, v127
  v_cvt_pk_bf16_f32 v222, v128, v129
  v_cvt_pk_bf16_f32 v223, v130, v131
  v_cvt_pk_bf16_f32 v226, v132, v133
  v_cvt_pk_bf16_f32 v227, v134, v135
  v_cvt_pk_bf16_f32 v228, v136, v137
  v_cvt_pk_bf16_f32 v229, v138, v139
  v_cvt_pk_bf16_f32 v230, v140, v141
  v_cvt_pk_bf16_f32 v231, v142, v143
  v_cvt_pk_bf16_f32 v236, v144, v145
  v_cvt_pk_bf16_f32 v237, v146, v147
  v_cvt_pk_bf16_f32 v232, v148, v149
  v_cvt_pk_bf16_f32 v233, v150, v151
  v_cvt_pk_bf16_f32 v234, v152, v153
  v_cvt_pk_bf16_f32 v235, v154, v155
  v_cvt_pk_bf16_f32 v238, v156, v157
  v_cvt_pk_bf16_f32 v239, v158, v159
  ds_write_b128 v20, v[192:195] offset:0
  ds_write_b128 v20, v[196:199] offset:1024
  ds_write_b128 v20, v[200:203] offset:2048
  ds_write_b128 v20, v[204:207] offset:12288
  ds_write_b128 v20, v[208:211] offset:13312
  ds_write_b128 v20, v[212:215] offset:14336
  ds_write_b128 v20, v[216:219] offset:24576
  ds_write_b128 v20, v[220:223] offset:25600
  ds_write_b128 v20, v[224:227] offset:26624
  ds_write_b128 v20, v[228:231] offset:36864
  ds_write_b128 v20, v[232:235] offset:37888
  ds_write_b128 v20, v[236:239] offset:38912
  s_waitcnt lgkmcnt(0)
  s_barrier
  s_add_u32 s29, s50, 0
  buffer_load_dwordx4 v[192:195], v26, s[16:19], s29 offen offset:0 sc1
  buffer_load_dwordx4 v[196:199], v26, s[16:19], s29 offen offset:1024 sc1
  buffer_load_dwordx4 v[224:227], v26, s[16:19], s29 offen offset:2048 sc1
  s_add_u32 s29, s50, 3072
  buffer_load_dwordx4 v[200:203], v26, s[16:19], s29 offen offset:0 sc1
  buffer_load_dwordx4 v[204:207], v26, s[16:19], s29 offen offset:1024 sc1
  buffer_load_dwordx4 v[228:231], v26, s[16:19], s29 offen offset:2048 sc1
  s_add_u32 s29, s50, 6144
  buffer_load_dwordx4 v[208:211], v26, s[16:19], s29 offen offset:0 sc1
  buffer_load_dwordx4 v[212:215], v26, s[16:19], s29 offen offset:1024 sc1
  buffer_load_dwordx4 v[232:235], v26, s[16:19], s29 offen offset:2048 sc1
  s_add_u32 s29, s50, 9216
  buffer_load_dwordx4 v[216:219], v26, s[16:19], s29 offen offset:0 sc1
  buffer_load_dwordx4 v[220:223], v26, s[16:19], s29 offen offset:1024 sc1
  buffer_load_dwordx4 v[236:239], v26, s[16:19], s29 offen offset:2048 sc1
  ds_read_b128 v[64:67], v21 offset:0
  ds_read_b128 v[68:71], v21 offset:1024
  ds_read_b128 v[72:75], v21 offset:3072
  ds_read_b128 v[76:79], v21 offset:4096
  ds_read2st64_b64 v[80:83], v22 offset0:0 offset1:6
  ds_read2st64_b64 v[84:87], v23 offset0:0 offset1:6
  ds_read_b128 v[88:91], v21 offset:6144
  ds_read_b128 v[92:95], v21 offset:7168
  ds_read_b128 v[96:99], v21 offset:9216
  ds_read_b128 v[100:103], v21 offset:10240
  ds_read2st64_b64 v[104:107], v22 offset0:12 offset1:18
  ds_read2st64_b64 v[108:111], v23 offset0:12 offset1:18
  s_waitcnt vmcnt(0) lgkmcnt(0)
  v_swap_b32 v226, v228
  v_swap_b32 v227, v229
  v_swap_b32 v234, v236
  v_swap_b32 v235, v237
  s_nop 1
  v_mfma_f32_16x16x32_bf16 v[36:39], v[192:195], v[64:67], 0
  v_mfma_f32_16x16x32_bf16 v[44:47], v[192:195], v[68:71], 0
  v_mfma_f32_16x16x32_bf16 v[48:51], v[196:199], v[68:71], 0
  v_mfma_f32_16x16x32_bf16 v[36:39], v[200:203], v[72:75], v[36:39]
  v_mfma_f32_16x16x32_bf16 v[44:47], v[200:203], v[76:79], v[44:47]
  v_mfma_f32_16x16x32_bf16 v[48:51], v[204:207], v[76:79], v[48:51]
  v_mfma_f32_16x16x32_bf16 v[36:39], v[224:227], v[80:83], v[36:39]
  v_mfma_f32_16x16x32_bf16 v[44:47], v[224:227], v[84:87], v[44:47]
  v_mfma_f32_16x16x32_bf16 v[48:51], v[228:231], v[84:87], v[48:51]
  v_mfma_f32_16x16x32_bf16 v[36:39], v[208:211], v[88:91], v[36:39]
  v_mfma_f32_16x16x32_bf16 v[44:47], v[208:211], v[92:95], v[44:47]
  v_mfma_f32_16x16x32_bf16 v[48:51], v[212:215], v[92:95], v[48:51]
  v_mfma_f32_16x16x32_bf16 v[36:39], v[216:219], v[96:99], v[36:39]
  v_mfma_f32_16x16x32_bf16 v[44:47], v[216:219], v[100:103], v[44:47]
  v_mfma_f32_16x16x32_bf16 v[48:51], v[220:223], v[100:103], v[48:51]
  v_mfma_f32_16x16x32_bf16 v[36:39], v[232:235], v[104:107], v[36:39]
  v_mfma_f32_16x16x32_bf16 v[44:47], v[232:235], v[108:111], v[44:47]
  v_mfma_f32_16x16x32_bf16 v[48:51], v[236:239], v[108:111], v[48:51]
  s_sub_u32 s23, s49, 1
  s_min_u32 s23, s23, 62
  s_mov_b32 s101, 0
wm_230:
  buffer_load_dword v34, v30, s[72:75], s77 offen sc1
  s_add_u32 s101, s101, 1
  s_cmp_gt_u32 s101, 131072
  s_cbranch_scc1 main_end
  s_waitcnt vmcnt(0)
  v_cmp_gt_u32 vcc, s23, v34
  v_readfirstlane_b32 s100, v34
  s_nop 0
  s_cbranch_vccz wm_231
  s_sleep 4
  s_add_u32 s100, s100, 2
  s_cmp_ge_u32 s100, s23
  s_cbranch_scc1 wm_230
  s_sleep 60
  s_branch wm_230
wm_231:
  s_mov_b32 s101, 0
  s_branch qtp_233
qtp_232:
  s_sleep 3
qtp_233:
  buffer_load_dwordx4 v[112:115], v24, s[52:55], s51 offen offset:0 sc1
  buffer_load_dwordx2 v[240:241], v25, s[52:55], s51 offen offset:512 sc1
  buffer_load_dwordx4 v[116:119], v24, s[52:55], s51 offen offset:768 sc1
  buffer_load_dwordx2 v[242:243], v25, s[52:55], s51 offen offset:1280 sc1
  buffer_load_dwordx4 v[120:123], v24, s[52:55], s51 offen offset:1536 sc1
  buffer_load_dwordx2 v[244:245], v25, s[52:55], s51 offen offset:2048 sc1
  buffer_load_dwordx4 v[124:127], v24, s[52:55], s51 offen offset:2304 sc1
  buffer_load_dwordx2 v[246:247], v25, s[52:55], s51 offen offset:2816 sc1
  s_add_u32 s101, s101, 1
  s_cmp_gt_u32 s101, 131072
  s_cbranch_scc1 main_end
  s_waitcnt vmcnt(0)
  v_max3_u32 v34, v112, v116, v120
  v_max3_u32 v34, v34, v124, v240
  v_max3_u32 v34, v34, v242, v244
  v_max_u32 v34, v34, v246
  v_cmp_eq_u32 vcc, -1, v34
  s_nop 1
  s_cbranch_vccnz qtp_232
  v_mfma_f32_16x16x32_bf16 v[40:43], v[112:115], v[64:67], 0
  v_mfma_f32_16x16x32_bf16 v[52:55], v[112:115], v[68:71], 0
  v_mfma_f32_16x16x32_bf16 v[40:43], v[116:119], v[72:75], v[40:43]
  v_mfma_f32_16x16x32_bf16 v[52:55], v[116:119], v[76:79], v[52:55]
  v_mfma_f32_16x16x32_bf16 v[40:43], v[240:243], v[80:83], v[40:43]
  v_mfma_f32_16x16x32_bf16 v[52:55], v[240:243], v[84:87], v[52:55]
  v_mfma_f32_16x16x32_bf16 v[40:43], v[120:123], v[88:91], v[40:43]
  v_mfma_f32_16x16x32_bf16 v[52:55], v[120:123], v[92:95], v[52:55]
  v_mfma_f32_16x16x32_bf16 v[40:43], v[124:127], v[96:99], v[40:43]
  v_mfma_f32_16x16x32_bf16 v[52:55], v[124:127], v[100:103], v[52:55]
  v_mfma_f32_16x16x32_bf16 v[40:43], v[244:247], v[104:107], v[40:43]
  v_mfma_f32_16x16x32_bf16 v[52:55], v[244:247], v[108:111], v[52:55]
  s_nop 4
  v_cndmask_b32 v36, v31, v36, s[64:65]
  v_cndmask_b32 v48, v31, v48, s[64:65]
  v_cndmask_b32 v37, v31, v37, s[66:67]
  v_cndmask_b32 v49, v31, v49, s[66:67]
  v_cndmask_b32 v38, v31, v38, s[68:69]
  v_cndmask_b32 v50, v31, v50, s[68:69]
  v_cndmask_b32 v39, v31, v39, s[70:71]
  v_cndmask_b32 v51, v31, v51, s[70:71]
  v_max3_f32 v34, v36, v37, v38
  v_max3_f32 v34, v34, v39, v40
  v_max3_f32 v34, v34, v41, v42
  v_max_f32 v34, v34, v43
  v_mov_b32 v35, v34
  s_nop 1
  v_permlane32_swap_b32 v34, v35
  v_max_f32 v34, v34, v35
  v_mov_b32 v35, v34
  s_nop 1
  v_permlane16_swap_b32 v34, v35
  v_max_f32 v34, v34, v35
  v_mul_f32 v34, s83, v34
  v_fma_f32 v36, v36, s83, -v34
  v_fma_f32 v37, v37, s83, -v34
  v_fma_f32 v38, v38, s83, -v34
  v_fma_f32 v39, v39, s83, -v34
  v_fma_f32 v40, v40, s83, -v34
  v_fma_f32 v41, v41, s83, -v34
  v_fma_f32 v42, v42, s83, -v34
  v_fma_f32 v43, v43, s83, -v34
  v_exp_f32 v36, v36
  v_exp_f32 v37, v37
  v_exp_f32 v38, v38
  v_exp_f32 v39, v39
  v_exp_f32 v40, v40
  v_exp_f32 v41, v41
  v_exp_f32 v42, v42
  v_exp_f32 v43, v43
  s_nop 0
  v_add_f32 v34, v40, v41
  v_add_f32 v34, v34, v42
  v_add_f32 v34, v34, v43
  v_cndmask_b32 v34, 0, v34, s[62:63]
  v_add_f32 v34, v34, v36
  v_add_f32 v34, v34, v37
  v_add_f32 v34, v34, v38
  v_add_f32 v34, v34, v39
  v_mov_b32 v35, v34
  s_nop 1
  v_permlane32_swap_b32 v34, v35
  v_add_f32 v34, v34, v35
  v_mov_b32 v35, v34
  s_nop 1
  v_permlane16_swap_b32 v34, v35
  v_add_f32 v34, v34, v35
  v_rcp_f32 v34, v34
  s_nop 0
  v_mul_f32 v36, v36, v34
  v_mul_f32 v37, v37, v34
  v_mul_f32 v38, v38, v34
  v_mul_f32 v39, v39, v34
  v_mul_f32 v40, v40, v34
  v_mul_f32 v41, v41, v34
  v_mul_f32 v42, v42, v34
  v_mul_f32 v43, v43, v34
  v_max3_f32 v34, v44, v45, v46
  v_max3_f32 v34, v34, v47, v48
  v_max3_f32 v34, v34, v49, v50
  v_max3_f32 v34, v34, v51, v52
  v_max3_f32 v34, v34, v53, v54
  v_max_f32 v34, v34, v55
  v_mov_b32 v35, v34
  s_nop 1
  v_permlane32_swap_b32 v34, v35
  v_max_f32 v34, v34, v35
  v_mov_b32 v35, v34
  s_nop 1
  v_permlane16_swap_b32 v34, v35
  v_max_f32 v34, v34, v35
  v_mul_f32 v34, s83, v34
  v_fma_f32 v44, v44, s83, -v34
  v_fma_f32 v45, v45, s83, -v34
  v_fma_f32 v46, v46, s83, -v34
  v_fma_f32 v47, v47, s83, -v34
  v_fma_f32 v48, v48, s83, -v34
  v_fma_f32 v49, v49, s83, -v34
  v_fma_f32 v50, v50, s83, -v34
  v_fma_f32 v51, v51, s83, -v34
  v_fma_f32 v52, v52, s83, -v34
  v_fma_f32 v53, v53, s83, -v34
  v_fma_f32 v54, v54, s83, -v34
  v_fma_f32 v55, v55, s83, -v34
  v_exp_f32 v44, v44
  v_exp_f32 v45, v45
  v_exp_f32 v46, v46
  v_exp_f32 v47, v47
  v_exp_f32 v48, v48
  v_exp_f32 v49, v49
  v_exp_f32 v50, v50
  v_exp_f32 v51, v51
  v_exp_f32 v52, v52
  v_exp_f32 v53, v53
  v_exp_f32 v54, v54
  v_exp_f32 v55, v55
  s_nop 0
  v_add_f32 v34, v52, v53
  v_add_f32 v34, v34, v54
  v_add_f32 v34, v34, v55
  v_cndmask_b32 v34, 0, v34, s[62:63]
  v_add_f32 v34, v34, v44
  v_add_f32 v34, v34, v45
  v_add_f32 v34, v34, v46
  v_add_f32 v34, v34, v47
  v_add_f32 v34, v34, v48
  v_add_f32 v34, v34, v49
  v_add_f32 v34, v34, v50
  v_add_f32 v34, v34, v51
  v_mov_b32 v35, v34
  s_nop 1
  v_permlane32_swap_b32 v34, v35
  v_add_f32 v34, v34, v35
  v_mov_b32 v35, v34
  s_nop 1
  v_permlane16_swap_b32 v34, v35
  v_add_f32 v34, v34, v35
  v_rcp_f32 v34, v34
  s_nop 0
  v_mul_f32 v44, v44, v34
  v_mul_f32 v45, v45, v34
  v_mul_f32 v46, v46, v34
  v_mul_f32 v47, v47, v34
  v_mul_f32 v48, v48, v34
  v_mul_f32 v49, v49, v34
  v_mul_f32 v50, v50, v34
  v_mul_f32 v51, v51, v34
  v_mul_f32 v52, v52, v34
  v_mul_f32 v53, v53, v34
  v_mul_f32 v54, v54, v34
  v_mul_f32 v55, v55, v34
  v_cvt_pk_bf16_f32 v56, v44, v45
  v_cvt_pk_bf16_f32 v57, v46, v47
  v_cvt_pk_bf16_f32 v58, v48, v49
  v_cvt_pk_bf16_f32 v59, v50, v51
  v_cvt_pk_bf16_f32 v60, v40, v41
  v_cvt_pk_bf16_f32 v61, v42, v43
  v_cvt_pk_bf16_f32 v62, v52, v53
  v_cvt_pk_bf16_f32 v63, v54, v55
  v_cvt_pk_bf16_f32 v248, v36, v37
  v_cvt_pk_bf16_f32 v249, v38, v39
  buffer_store_dwordx4 v[56:59], v26, s[56:59], s81 offen sc1
  buffer_store_dwordx4 v[60:63], v26, s[56:59], s81 offen offset:1024 sc1
  buffer_store_dwordx2 v[248:249], v29, s[56:59], s81 offen offset:2048 sc1
  s_waitcnt vmcnt(0)
  buffer_atomic_add v28, v33, s[72:75], s82 offen sc1
  s_branch qe_234
qw_228:
  s_mov_b32 s101, 0
wm_235:
  buffer_load_dword v32, v30, s[72:75], s77 offen sc1
  s_add_u32 s101, s101, 1
  s_cmp_gt_u32 s101, 131072
  s_cbranch_scc1 main_end
  s_waitcnt vmcnt(0)
  v_cmp_gt_u32 vcc, s49, v32
  v_readfirstlane_b32 s100, v32
  s_nop 0
  s_cbranch_vccz wm_236
  s_sleep 4
  s_add_u32 s100, s100, 2
  s_cmp_ge_u32 s100, s49
  s_cbranch_scc1 wm_235
  s_sleep 60
  s_branch wm_235
wm_236:
  s_branch qj_229
qe_234:
queue:
  s_load_dwordx2 s[4:5], s[0:1], 96
  s_waitcnt lgkmcnt(0)
  s_mov_b32 s32, s4
  s_mov_b32 s33, s5
  s_mov_b32 s34, 256
  s_mov_b32 s35, 0x00020000
  s_waitcnt vmcnt(0) lgkmcnt(0)
  s_barrier
  s_mov_b32 s2, s85
  s_mov_b32 s85, -1
  s_cmp_lg_u32 s2, -1
  s_cbranch_scc1 queue_c
  v_mov_b32 v21, 0
  s_cmp_lg_u32 s20, 0
  s_cbranch_scc1 q_237
  v_mov_b32 v22, 80
  v_mov_b32 v23, 1
  s_mov_b64 exec, 1
  buffer_atomic_add v23, v22, s[32:35], 0 offen sc0 sc1
  s_waitcnt vmcnt(0)
queue_a:
  ds_write_b32 v21, v23
  s_waitcnt lgkmcnt(0)
  s_mov_b64 exec, -1
q_237:
queue_b:
  s_barrier
  ds_read_b32 v23, v21
  s_waitcnt lgkmcnt(0)
  v_readfirstlane_b32 s2, v23
  s_barrier
queue_c:
  s_add_u32 s21, s2, 0
  s_cmp_lt_u32 s2, 10
  s_cbranch_scc1 do_qbl
  s_sub_u32 s2, s2, 10
  s_add_u32 s21, s2, 0
  s_cmp_lt_u32 s2, 54
  s_cbranch_scc1 do_bat
  s_sub_u32 s2, s2, 54
  s_add_u32 s21, s2, 0
  s_cmp_lt_u32 s2, 56
  s_cbranch_scc1 do_opb
  s_sub_u32 s2, s2, 56
  s_add_u32 s21, s2, 54
  s_cmp_lt_u32 s2, 10
  s_cbranch_scc1 do_bat
  s_sub_u32 s2, s2, 10
  s_add_u32 s21, s2, 0
  s_cmp_lt_u32 s2, 48
  s_cbranch_scc1 do_pv
  s_sub_u32 s2, s2, 48
  s_add_u32 s21, s2, 56
  s_cmp_lt_u32 s2, 8
  s_cbranch_scc1 do_opb
  s_sub_u32 s2, s2, 8
  s_add_u32 s21, s2, 48
  s_cmp_lt_u32 s2, 464
  s_cbranch_scc1 do_pv
  s_sub_u32 s2, s2, 464
  s_branch main_fin
do_qbl:
  s_mul_hi_u32 s42, s21, 0x1999999a
  s_mul_i32 s22, s42, 10
  s_sub_u32 s41, s21, s22
  s_add_u32 s42, s42, 15
  s_mov_b32 s26, 1
  s_mov_b32 s63, 1
  s_mov_b32 s64, 1
  s_branch qkvb_entry
do_opb:
  s_mov_b32 s2, s21
  s_lshr_b32 s40, s2, 2
  s_and_b32 s42, s2, 3
  s_mov_b32 s43, 4
  s_load_dwordx2 s[4:5], s[0:1], 40
  s_load_dwordx2 s[6:7], s[0:1], 72
  s_load_dwordx2 s[38:39], s[0:1], 104
  s_waitcnt lgkmcnt(0)
  s_cmp_eq_u32 s43, 4
  s_cselect_b32 s4, s6, s4
  s_cselect_b32 s5, s7, s5
  s_mov_b32 s10, 7864320
  s_cselect_b32 s10, 819200, s10
  s_cselect_b32 s44, 10, 24
  s_mov_b32 s45, 196608
  s_cselect_b32 s45, 20480, s45
  s_mov_b32 s46, 93323264
  s_cselect_b32 s46, 70778880, s46
  s_cselect_b32 s47, 1, 0
  s_mov_b32 s8, s4
  s_mov_b32 s9, s5
  s_mov_b32 s11, 0x00020000
  s_mov_b32 s12, s38
  s_mov_b32 s13, s39
  s_mov_b32 s14, 73400320
  s_mov_b32 s15, 0x00020000
  s_add_u32 s16, s38, 73400320
  s_addc_u32 s17, s39, 0
  s_mov_b32 s18, 5242880
  s_mov_b32 s19, 0x00020000
  s_lshl_b32 s21, s40, 3
  s_lshl_b32 s22, s20, 1
  s_add_u32 s21, s21, s22
  s_mul_i32 s21, s21, s45
  s_add_u32 s48, s46, s21
  s_and_b32 s22, s43, 3
  s_mul_i32 s22, s22, 49152
  s_cmp_eq_u32 s47, 1
  s_cselect_b32 s22, 0, s22
  s_add_u32 s48, s48, s22
  v_lshlrev_b32 v4, 4, v1
  s_and_b32 s22, s43, 3
  s_mul_i32 s49, s22, 1966080
  s_cmp_eq_u32 s47, 1
  s_cselect_b32 s49, 0, s49
  s_mul_i32 s22, s42, 320
  s_add_u32 s49, s49, s22
  v_mov_b32 v29, 3277
  s_mul_i32 s21, s20, 320
  s_add_u32 s21, s21, 0
  v_add_u32 v21, s21, v1
  v_mul_u32_u24 v22, v21, v29
  v_lshrrev_b32 v22, 16, v22
  v_mul_u32_u24 v23, 20, v22
  v_sub_u32 v21, v21, v23
  v_add_u32 v22, 0, v22
  v_mov_b32 v25, v22
  s_cmp_eq_u32 s47, 1
  s_cbranch_scc1 id_238
  v_and_b32 v23, 0xe3, v22
  v_bfe_u32 v24, v22, 2, 1
  v_lshl_add_u32 v23, v24, 4, v23
  v_bfe_u32 v24, v22, 3, 2
  v_lshl_add_u32 v22, v24, 2, v23
  v_mul_u32_u24 v23, 1366, v22
  v_lshrrev_b32 v23, 16, v23
  v_mul_u32_u24 v25, 48, v23
  v_sub_u32 v22, v22, v25
  v_mul_u32_u24 v26, 5462, v22
  v_lshrrev_b32 v26, 16, v26
  v_mul_u32_u24 v27, 12, v26
  v_sub_u32 v22, v22, v27
  v_lshrrev_b32 v27, 2, v22
  v_and_b32 v22, 3, v22
  v_lshl_add_u32 v25, v27, 4, v25
  v_lshl_add_u32 v25, v26, 2, v25
  v_add_u32 v25, v25, v22
id_238:
  v_mul_u32_u24 v25, 1280, v25
  v_lshl_add_u32 v64, v21, 4, v25
  s_mul_i32 s21, s20, 320
  s_add_u32 s21, s21, 64
  v_add_u32 v21, s21, v1
  v_mul_u32_u24 v22, v21, v29
  v_lshrrev_b32 v22, 16, v22
  v_mul_u32_u24 v23, 20, v22
  v_sub_u32 v21, v21, v23
  v_add_u32 v22, 0, v22
  v_mov_b32 v25, v22
  s_cmp_eq_u32 s47, 1
  s_cbranch_scc1 id_239
  v_and_b32 v23, 0xe3, v22
  v_bfe_u32 v24, v22, 2, 1
  v_lshl_add_u32 v23, v24, 4, v23
  v_bfe_u32 v24, v22, 3, 2
  v_lshl_add_u32 v22, v24, 2, v23
  v_mul_u32_u24 v23, 1366, v22
  v_lshrrev_b32 v23, 16, v23
  v_mul_u32_u24 v25, 48, v23
  v_sub_u32 v22, v22, v25
  v_mul_u32_u24 v26, 5462, v22
  v_lshrrev_b32 v26, 16, v26
  v_mul_u32_u24 v27, 12, v26
  v_sub_u32 v22, v22, v27
  v_lshrrev_b32 v27, 2, v22
  v_and_b32 v22, 3, v22
  v_lshl_add_u32 v25, v27, 4, v25
  v_lshl_add_u32 v25, v26, 2, v25
  v_add_u32 v25, v25, v22
id_239:
  v_mul_u32_u24 v25, 1280, v25
  v_lshl_add_u32 v65, v21, 4, v25
  s_mul_i32 s21, s20, 320
  s_add_u32 s21, s21, 128
  v_add_u32 v21, s21, v1
  v_mul_u32_u24 v22, v21, v29
  v_lshrrev_b32 v22, 16, v22
  v_mul_u32_u24 v23, 20, v22
  v_sub_u32 v21, v21, v23
  v_add_u32 v22, 0, v22
  v_mov_b32 v25, v22
  s_cmp_eq_u32 s47, 1
  s_cbranch_scc1 id_240
  v_and_b32 v23, 0xe3, v22
  v_bfe_u32 v24, v22, 2, 1
  v_lshl_add_u32 v23, v24, 4, v23
  v_bfe_u32 v24, v22, 3, 2
  v_lshl_add_u32 v22, v24, 2, v23
  v_mul_u32_u24 v23, 1366, v22
  v_lshrrev_b32 v23, 16, v23
  v_mul_u32_u24 v25, 48, v23
  v_sub_u32 v22, v22, v25
  v_mul_u32_u24 v26, 5462, v22
  v_lshrrev_b32 v26, 16, v26
  v_mul_u32_u24 v27, 12, v26
  v_sub_u32 v22, v22, v27
  v_lshrrev_b32 v27, 2, v22
  v_and_b32 v22, 3, v22
  v_lshl_add_u32 v25, v27, 4, v25
  v_lshl_add_u32 v25, v26, 2, v25
  v_add_u32 v25, v25, v22
id_240:
  v_mul_u32_u24 v25, 1280, v25
  v_lshl_add_u32 v66, v21, 4, v25
  s_mul_i32 s21, s20, 320
  s_add_u32 s21, s21, 192
  v_add_u32 v21, s21, v1
  v_mul_u32_u24 v22, v21, v29
  v_lshrrev_b32 v22, 16, v22
  v_mul_u32_u24 v23, 20, v22
  v_sub_u32 v21, v21, v23
  v_add_u32 v22, 0, v22
  v_mov_b32 v25, v22
  s_cmp_eq_u32 s47, 1
  s_cbranch_scc1 id_241
  v_and_b32 v23, 0xe3, v22
  v_bfe_u32 v24, v22, 2, 1
  v_lshl_add_u32 v23, v24, 4, v23
  v_bfe_u32 v24, v22, 3, 2
  v_lshl_add_u32 v22, v24, 2, v23
  v_mul_u32_u24 v23, 1366, v22
  v_lshrrev_b32 v23, 16, v23
  v_mul_u32_u24 v25, 48, v23
  v_sub_u32 v22, v22, v25
  v_mul_u32_u24 v26, 5462, v22
  v_lshrrev_b32 v26, 16, v26
  v_mul_u32_u24 v27, 12, v26
  v_sub_u32 v22, v22, v27
  v_lshrrev_b32 v27, 2, v22
  v_and_b32 v22, 3, v22
  v_lshl_add_u32 v25, v27, 4, v25
  v_lshl_add_u32 v25, v26, 2, v25
  v_add_u32 v25, v25, v22
id_241:
  v_mul_u32_u24 v25, 1280, v25
  v_lshl_add_u32 v67, v21, 4, v25
  s_mul_i32 s21, s20, 320
  s_add_u32 s21, s21, 256
  v_add_u32 v21, s21, v1
  v_mul_u32_u24 v22, v21, v29
  v_lshrrev_b32 v22, 16, v22
  v_mul_u32_u24 v23, 20, v22
  v_sub_u32 v21, v21, v23
  v_add_u32 v22, 0, v22
  v_mov_b32 v25, v22
  s_cmp_eq_u32 s47, 1
  s_cbranch_scc1 id_242
  v_and_b32 v23, 0xe3, v22
  v_bfe_u32 v24, v22, 2, 1
  v_lshl_add_u32 v23, v24, 4, v23
  v_bfe_u32 v24, v22, 3, 2
  v_lshl_add_u32 v22, v24, 2, v23
  v_mul_u32_u24 v23, 1366, v22
  v_lshrrev_b32 v23, 16, v23
  v_mul_u32_u24 v25, 48, v23
  v_sub_u32 v22, v22, v25
  v_mul_u32_u24 v26, 5462, v22
  v_lshrrev_b32 v26, 16, v26
  v_mul_u32_u24 v27, 12, v26
  v_sub_u32 v22, v22, v27
  v_lshrrev_b32 v27, 2, v22
  v_and_b32 v22, 3, v22
  v_lshl_add_u32 v25, v27, 4, v25
  v_lshl_add_u32 v25, v26, 2, v25
  v_add_u32 v25, v25, v22
id_242:
  v_mul_u32_u24 v25, 1280, v25
  v_lshl_add_u32 v68, v21, 4, v25
  s_mul_i32 s21, s20, 320
  s_add_u32 s21, s21, 0
  v_add_u32 v21, s21, v1
  v_mul_u32_u24 v22, v21, v29
  v_lshrrev_b32 v22, 16, v22
  v_mul_u32_u24 v23, 20, v22
  v_sub_u32 v21, v21, v23
  v_add_u32 v22, 64, v22
  v_mov_b32 v25, v22
  s_cmp_eq_u32 s47, 1
  s_cbranch_scc1 id_243
  v_and_b32 v23, 0xe3, v22
  v_bfe_u32 v24, v22, 2, 1
  v_lshl_add_u32 v23, v24, 4, v23
  v_bfe_u32 v24, v22, 3, 2
  v_lshl_add_u32 v22, v24, 2, v23
  v_mul_u32_u24 v23, 1366, v22
  v_lshrrev_b32 v23, 16, v23
  v_mul_u32_u24 v25, 48, v23
  v_sub_u32 v22, v22, v25
  v_mul_u32_u24 v26, 5462, v22
  v_lshrrev_b32 v26, 16, v26
  v_mul_u32_u24 v27, 12, v26
  v_sub_u32 v22, v22, v27
  v_lshrrev_b32 v27, 2, v22
  v_and_b32 v22, 3, v22
  v_lshl_add_u32 v25, v27, 4, v25
  v_lshl_add_u32 v25, v26, 2, v25
  v_add_u32 v25, v25, v22
id_243:
  v_mul_u32_u24 v25, 1280, v25
  v_lshl_add_u32 v69, v21, 4, v25
  s_mul_i32 s21, s20, 320
  s_add_u32 s21, s21, 64
  v_add_u32 v21, s21, v1
  v_mul_u32_u24 v22, v21, v29
  v_lshrrev_b32 v22, 16, v22
  v_mul_u32_u24 v23, 20, v22
  v_sub_u32 v21, v21, v23
  v_add_u32 v22, 64, v22
  v_mov_b32 v25, v22
  s_cmp_eq_u32 s47, 1
  s_cbranch_scc1 id_244
  v_and_b32 v23, 0xe3, v22
  v_bfe_u32 v24, v22, 2, 1
  v_lshl_add_u32 v23, v24, 4, v23
  v_bfe_u32 v24, v22, 3, 2
  v_lshl_add_u32 v22, v24, 2, v23
  v_mul_u32_u24 v23, 1366, v22
  v_lshrrev_b32 v23, 16, v23
  v_mul_u32_u24 v25, 48, v23
  v_sub_u32 v22, v22, v25
  v_mul_u32_u24 v26, 5462, v22
  v_lshrrev_b32 v26, 16, v26
  v_mul_u32_u24 v27, 12, v26
  v_sub_u32 v22, v22, v27
  v_lshrrev_b32 v27, 2, v22
  v_and_b32 v22, 3, v22
  v_lshl_add_u32 v25, v27, 4, v25
  v_lshl_add_u32 v25, v26, 2, v25
  v_add_u32 v25, v25, v22
id_244:
  v_mul_u32_u24 v25, 1280, v25
  v_lshl_add_u32 v70, v21, 4, v25
  s_mul_i32 s21, s20, 320
  s_add_u32 s21, s21, 128
  v_add_u32 v21, s21, v1
  v_mul_u32_u24 v22, v21, v29
  v_lshrrev_b32 v22, 16, v22
  v_mul_u32_u24 v23, 20, v22
  v_sub_u32 v21, v21, v23
  v_add_u32 v22, 64, v22
  v_mov_b32 v25, v22
  s_cmp_eq_u32 s47, 1
  s_cbranch_scc1 id_245
  v_and_b32 v23, 0xe3, v22
  v_bfe_u32 v24, v22, 2, 1
  v_lshl_add_u32 v23, v24, 4, v23
  v_bfe_u32 v24, v22, 3, 2
  v_lshl_add_u32 v22, v24, 2, v23
  v_mul_u32_u24 v23, 1366, v22
  v_lshrrev_b32 v23, 16, v23
  v_mul_u32_u24 v25, 48, v23
  v_sub_u32 v22, v22, v25
  v_mul_u32_u24 v26, 5462, v22
  v_lshrrev_b32 v26, 16, v26
  v_mul_u32_u24 v27, 12, v26
  v_sub_u32 v22, v22, v27
  v_lshrrev_b32 v27, 2, v22
  v_and_b32 v22, 3, v22
  v_lshl_add_u32 v25, v27, 4, v25
  v_lshl_add_u32 v25, v26, 2, v25
  v_add_u32 v25, v25, v22
id_245:
  v_mul_u32_u24 v25, 1280, v25
  v_lshl_add_u32 v71, v21, 4, v25
  s_mul_i32 s21, s20, 320
  s_add_u32 s21, s21, 192
  v_add_u32 v21, s21, v1
  v_mul_u32_u24 v22, v21, v29
  v_lshrrev_b32 v22, 16, v22
  v_mul_u32_u24 v23, 20, v22
  v_sub_u32 v21, v21, v23
  v_add_u32 v22, 64, v22
  v_mov_b32 v25, v22
  s_cmp_eq_u32 s47, 1
  s_cbranch_scc1 id_246
  v_and_b32 v23, 0xe3, v22
  v_bfe_u32 v24, v22, 2, 1
  v_lshl_add_u32 v23, v24, 4, v23
  v_bfe_u32 v24, v22, 3, 2
  v_lshl_add_u32 v22, v24, 2, v23
  v_mul_u32_u24 v23, 1366, v22
  v_lshrrev_b32 v23, 16, v23
  v_mul_u32_u24 v25, 48, v23
  v_sub_u32 v22, v22, v25
  v_mul_u32_u24 v26, 5462, v22
  v_lshrrev_b32 v26, 16, v26
  v_mul_u32_u24 v27, 12, v26
  v_sub_u32 v22, v22, v27
  v_lshrrev_b32 v27, 2, v22
  v_and_b32 v22, 3, v22
  v_lshl_add_u32 v25, v27, 4, v25
  v_lshl_add_u32 v25, v26, 2, v25
  v_add_u32 v25, v25, v22
id_246:
  v_mul_u32_u24 v25, 1280, v25
  v_lshl_add_u32 v72, v21, 4, v25
  s_mul_i32 s21, s20, 320
  s_add_u32 s21, s21, 256
  v_add_u32 v21, s21, v1
  v_mul_u32_u24 v22, v21, v29
  v_lshrrev_b32 v22, 16, v22
  v_mul_u32_u24 v23, 20, v22
  v_sub_u32 v21, v21, v23
  v_add_u32 v22, 64, v22
  v_mov_b32 v25, v22
  s_cmp_eq_u32 s47, 1
  s_cbranch_scc1 id_247
  v_and_b32 v23, 0xe3, v22
  v_bfe_u32 v24, v22, 2, 1
  v_lshl_add_u32 v23, v24, 4, v23
  v_bfe_u32 v24, v22, 3, 2
  v_lshl_add_u32 v22, v24, 2, v23
  v_mul_u32_u24 v23, 1366, v22
  v_lshrrev_b32 v23, 16, v23
  v_mul_u32_u24 v25, 48, v23
  v_sub_u32 v22, v22, v25
  v_mul_u32_u24 v26, 5462, v22
  v_lshrrev_b32 v26, 16, v26
  v_mul_u32_u24 v27, 12, v26
  v_sub_u32 v22, v22, v27
  v_lshrrev_b32 v27, 2, v22
  v_and_b32 v22, 3, v22
  v_lshl_add_u32 v25, v27, 4, v25
  v_lshl_add_u32 v25, v26, 2, v25
  v_add_u32 v25, v25, v22
id_247:
  v_mul_u32_u24 v25, 1280, v25
  v_lshl_add_u32 v73, v21, 4, v25
  s_mul_i32 s21, s20, 320
  s_add_u32 s21, s21, 0
  v_add_u32 v21, s21, v1
  v_mul_u32_u24 v22, v21, v29
  v_lshrrev_b32 v22, 16, v22
  v_mul_u32_u24 v23, 20, v22
  v_sub_u32 v21, v21, v23
  v_add_u32 v22, 128, v22
  v_mov_b32 v25, v22
  s_cmp_eq_u32 s47, 1
  s_cbranch_scc1 id_248
  v_and_b32 v23, 0xe3, v22
  v_bfe_u32 v24, v22, 2, 1
  v_lshl_add_u32 v23, v24, 4, v23
  v_bfe_u32 v24, v22, 3, 2
  v_lshl_add_u32 v22, v24, 2, v23
  v_mul_u32_u24 v23, 1366, v22
  v_lshrrev_b32 v23, 16, v23
  v_mul_u32_u24 v25, 48, v23
  v_sub_u32 v22, v22, v25
  v_mul_u32_u24 v26, 5462, v22
  v_lshrrev_b32 v26, 16, v26
  v_mul_u32_u24 v27, 12, v26
  v_sub_u32 v22, v22, v27
  v_lshrrev_b32 v27, 2, v22
  v_and_b32 v22, 3, v22
  v_lshl_add_u32 v25, v27, 4, v25
  v_lshl_add_u32 v25, v26, 2, v25
  v_add_u32 v25, v25, v22
id_248:
  v_mul_u32_u24 v25, 1280, v25
  v_lshl_add_u32 v74, v21, 4, v25
  s_mul_i32 s21, s20, 320
  s_add_u32 s21, s21, 64
  v_add_u32 v21, s21, v1
  v_mul_u32_u24 v22, v21, v29
  v_lshrrev_b32 v22, 16, v22
  v_mul_u32_u24 v23, 20, v22
  v_sub_u32 v21, v21, v23
  v_add_u32 v22, 128, v22
  v_mov_b32 v25, v22
  s_cmp_eq_u32 s47, 1
  s_cbranch_scc1 id_249
  v_and_b32 v23, 0xe3, v22
  v_bfe_u32 v24, v22, 2, 1
  v_lshl_add_u32 v23, v24, 4, v23
  v_bfe_u32 v24, v22, 3, 2
  v_lshl_add_u32 v22, v24, 2, v23
  v_mul_u32_u24 v23, 1366, v22
  v_lshrrev_b32 v23, 16, v23
  v_mul_u32_u24 v25, 48, v23
  v_sub_u32 v22, v22, v25
  v_mul_u32_u24 v26, 5462, v22
  v_lshrrev_b32 v26, 16, v26
  v_mul_u32_u24 v27, 12, v26
  v_sub_u32 v22, v22, v27
  v_lshrrev_b32 v27, 2, v22
  v_and_b32 v22, 3, v22
  v_lshl_add_u32 v25, v27, 4, v25
  v_lshl_add_u32 v25, v26, 2, v25
  v_add_u32 v25, v25, v22
id_249:
  v_mul_u32_u24 v25, 1280, v25
  v_lshl_add_u32 v75, v21, 4, v25
  s_mul_i32 s21, s20, 320
  s_add_u32 s21, s21, 128
  v_add_u32 v21, s21, v1
  v_mul_u32_u24 v22, v21, v29
  v_lshrrev_b32 v22, 16, v22
  v_mul_u32_u24 v23, 20, v22
  v_sub_u32 v21, v21, v23
  v_add_u32 v22, 128, v22
  v_mov_b32 v25, v22
  s_cmp_eq_u32 s47, 1
  s_cbranch_scc1 id_250
  v_and_b32 v23, 0xe3, v22
  v_bfe_u32 v24, v22, 2, 1
  v_lshl_add_u32 v23, v24, 4, v23
  v_bfe_u32 v24, v22, 3, 2
  v_lshl_add_u32 v22, v24, 2, v23
  v_mul_u32_u24 v23, 1366, v22
  v_lshrrev_b32 v23, 16, v23
  v_mul_u32_u24 v25, 48, v23
  v_sub_u32 v22, v22, v25
  v_mul_u32_u24 v26, 5462, v22
  v_lshrrev_b32 v26, 16, v26
  v_mul_u32_u24 v27, 12, v26
  v_sub_u32 v22, v22, v27
  v_lshrrev_b32 v27, 2, v22
  v_and_b32 v22, 3, v22
  v_lshl_add_u32 v25, v27, 4, v25
  v_lshl_add_u32 v25, v26, 2, v25
  v_add_u32 v25, v25, v22
id_250:
  v_mul_u32_u24 v25, 1280, v25
  v_lshl_add_u32 v76, v21, 4, v25
  s_mul_i32 s21, s20, 320
  s_add_u32 s21, s21, 192
  v_add_u32 v21, s21, v1
  v_mul_u32_u24 v22, v21, v29
  v_lshrrev_b32 v22, 16, v22
  v_mul_u32_u24 v23, 20, v22
  v_sub_u32 v21, v21, v23
  v_add_u32 v22, 128, v22
  v_mov_b32 v25, v22
  s_cmp_eq_u32 s47, 1
  s_cbranch_scc1 id_251
  v_and_b32 v23, 0xe3, v22
  v_bfe_u32 v24, v22, 2, 1
  v_lshl_add_u32 v23, v24, 4, v23
  v_bfe_u32 v24, v22, 3, 2
  v_lshl_add_u32 v22, v24, 2, v23
  v_mul_u32_u24 v23, 1366, v22
  v_lshrrev_b32 v23, 16, v23
  v_mul_u32_u24 v25, 48, v23
  v_sub_u32 v22, v22, v25
  v_mul_u32_u24 v26, 5462, v22
  v_lshrrev_b32 v26, 16, v26
  v_mul_u32_u24 v27, 12, v26
  v_sub_u32 v22, v22, v27
  v_lshrrev_b32 v27, 2, v22
  v_and_b32 v22, 3, v22
  v_lshl_add_u32 v25, v27, 4, v25
  v_lshl_add_u32 v25, v26, 2, v25
  v_add_u32 v25, v25, v22
id_251:
  v_mul_u32_u24 v25, 1280, v25
  v_lshl_add_u32 v77, v21, 4, v25
  s_mul_i32 s21, s20, 320
  s_add_u32 s21, s21, 256
  v_add_u32 v21, s21, v1
  v_mul_u32_u24 v22, v21, v29
  v_lshrrev_b32 v22, 16, v22
  v_mul_u32_u24 v23, 20, v22
  v_sub_u32 v21, v21, v23
  v_add_u32 v22, 128, v22
  v_mov_b32 v25, v22
  s_cmp_eq_u32 s47, 1
  s_cbranch_scc1 id_252
  v_and_b32 v23, 0xe3, v22
  v_bfe_u32 v24, v22, 2, 1
  v_lshl_add_u32 v23, v24, 4, v23
  v_bfe_u32 v24, v22, 3, 2
  v_lshl_add_u32 v22, v24, 2, v23
  v_mul_u32_u24 v23, 1366, v22
  v_lshrrev_b32 v23, 16, v23
  v_mul_u32_u24 v25, 48, v23
  v_sub_u32 v22, v22, v25
  v_mul_u32_u24 v26, 5462, v22
  v_lshrrev_b32 v26, 16, v26
  v_mul_u32_u24 v27, 12, v26
  v_sub_u32 v22, v22, v27
  v_lshrrev_b32 v27, 2, v22
  v_and_b32 v22, 3, v22
  v_lshl_add_u32 v25, v27, 4, v25
  v_lshl_add_u32 v25, v26, 2, v25
  v_add_u32 v25, v25, v22
id_252:
  v_mul_u32_u24 v25, 1280, v25
  v_lshl_add_u32 v78, v21, 4, v25
  s_lshr_b32 s21, s20, 1
  s_lshl_b32 s21, s21, 13
  v_add_u32 v5, s21, v4
  v_lshrrev_b32 v6, 2, v2
  v_lshl_add_u32 v6, v3, 3, v6
  v_mul_u32_u24 v6, 320, v6
  v_and_b32 v7, 3, v2
  v_lshlrev_b32 v7, 3, v7
  s_and_b32 s21, s20, 1
  s_mul_i32 s21, s21, 160
  s_add_u32 s21, s21, 16384
  v_add3_u32 v6, v6, v7, s21
  s_mov_b32 s50, 0
  s_mov_b32 s51, 0
  v_mov_b32 v80, 0
  v_mov_b32 v81, 0
  v_mov_b32 v82, 0
  v_mov_b32 v83, 0
  v_mov_b32 v84, 0
  v_mov_b32 v85, 0
  v_mov_b32 v86, 0
  v_mov_b32 v87, 0
  v_mov_b32 v88, 0
  v_mov_b32 v89, 0
  v_mov_b32 v90, 0
  v_mov_b32 v91, 0
  v_mov_b32 v92, 0
  v_mov_b32 v93, 0
  v_mov_b32 v94, 0
  v_mov_b32 v95, 0
  v_mov_b32 v96, 0
  v_mov_b32 v97, 0
  v_mov_b32 v98, 0
  v_mov_b32 v99, 0
  v_mov_b32 v100, 0
  v_mov_b32 v101, 0
  v_mov_b32 v102, 0
  v_mov_b32 v103, 0
  v_mov_b32 v104, 0
  v_mov_b32 v105, 0
  v_mov_b32 v106, 0
  v_mov_b32 v107, 0
  v_mov_b32 v108, 0
  v_mov_b32 v109, 0
  v_mov_b32 v110, 0
  v_mov_b32 v111, 0
  v_mov_b32 v112, 0
  v_mov_b32 v113, 0
  v_mov_b32 v114, 0
  v_mov_b32 v115, 0
  v_mov_b32 v116, 0
  v_mov_b32 v117, 0
  v_mov_b32 v118, 0
  v_mov_b32 v119, 0
  v_mov_b32 v120, 0
  v_mov_b32 v121, 0
  v_mov_b32 v122, 0
  v_mov_b32 v123, 0
  v_mov_b32 v124, 0
  v_mov_b32 v125, 0
  v_mov_b32 v126, 0
  v_mov_b32 v127, 0
  v_mov_b32 v128, 0
  v_mov_b32 v129, 0
  v_mov_b32 v130, 0
  v_mov_b32 v131, 0
  v_mov_b32 v132, 0
  v_mov_b32 v133, 0
  v_mov_b32 v134, 0
  v_mov_b32 v135, 0
  v_mov_b32 v136, 0
  v_mov_b32 v137, 0
  v_mov_b32 v138, 0
  v_mov_b32 v139, 0
  v_mov_b32 v140, 0
  v_mov_b32 v141, 0
  v_mov_b32 v142, 0
  v_mov_b32 v143, 0
  v_mov_b32 v144, 0
  v_mov_b32 v145, 0
  v_mov_b32 v146, 0
  v_mov_b32 v147, 0
  v_mov_b32 v148, 0
  v_mov_b32 v149, 0
  v_mov_b32 v150, 0
  v_mov_b32 v151, 0
  v_mov_b32 v152, 0
  v_mov_b32 v153, 0
  v_mov_b32 v154, 0
  v_mov_b32 v155, 0
  v_mov_b32 v156, 0
  v_mov_b32 v157, 0
  v_mov_b32 v158, 0
  v_mov_b32 v159, 0
  s_lshl_b32 s53, s44, 11
  s_add_u32 s53, s53, s48
  s_sub_u32 s53, s53, 2048
  s_load_dwordx2 s[72:73], s[0:1], 104
  s_waitcnt lgkmcnt(0)
  s_add_u32 s72, s72, 81068032
  s_addc_u32 s73, s73, 0
  s_mov_b32 s74, 115712
  s_mov_b32 s75, 0x00020000
  s_lshl_b32 s21, s40, 7
  s_add_u32 s21, s21, 90112
  s_mov_b32 s23, 4
  s_cmp_lg_u32 s20, 0
  s_cbranch_scc1 wf_254
  v_mov_b32 v10, 0
  s_mov_b32 s101, 0
wf_253:
  buffer_load_dword v11, v10, s[72:75], s21 offen sc1
  s_add_u32 s101, s101, 1
  s_cmp_gt_u32 s101, 131072
  s_cbranch_scc1 main_end
  s_waitcnt vmcnt(0)
  v_readfirstlane_b32 s100, v11
  s_cmp_ge_u32 s100, s23
  s_cbranch_scc1 wf_254
  s_sleep 8
  s_add_u32 s100, s100, 8
  s_cmp_ge_u32 s100, s23
  s_cbranch_scc1 wf_253
  s_sleep 60
  s_branch wf_253
wf_254:
  s_barrier
  s_lshl_b32 s22, s20, 12
  s_add_u32 s22, s22, s50
  s_add_u32 s23, s48, s45
  s_add_u32 m0, s22, 0
  s_nop 0
  buffer_load_dwordx4 v4, s[12:15], s48 offen offset:0 sc1 lds
  s_add_u32 m0, s22, 0
  s_nop 0
  buffer_load_dwordx4 v4, s[12:15], s48 offen offset:1024 sc1 lds
  s_add_u32 m0, s22, 2048
  s_nop 0
  buffer_load_dwordx4 v4, s[12:15], s23 offen offset:0 sc1 lds
  s_add_u32 m0, s22, 2048
  s_nop 0
  buffer_load_dwordx4 v4, s[12:15], s23 offen offset:1024 sc1 lds
  s_mul_i32 s22, s20, 5120
  s_add_u32 s22, s22, s50
  s_add_u32 s22, s22, 16384
  s_add_u32 m0, s22, 0
  s_nop 0
  buffer_load_dwordx4 v64, s[8:11], s49 offen lds
  s_add_u32 m0, s22, 1024
  s_nop 0
  buffer_load_dwordx4 v65, s[8:11], s49 offen lds
  s_add_u32 m0, s22, 2048
  s_nop 0
  buffer_load_dwordx4 v66, s[8:11], s49 offen lds
  s_add_u32 m0, s22, 3072
  s_nop 0
  buffer_load_dwordx4 v67, s[8:11], s49 offen lds
  s_add_u32 m0, s22, 4096
  s_nop 0
  buffer_load_dwordx4 v68, s[8:11], s49 offen lds
  s_add_u32 s48, s48, 2048
  s_min_u32 s48, s48, s53
  s_add_u32 s50, s50, 36864
  s_cmp_lt_u32 s50, 147456
  s_cselect_b32 s50, s50, 0
  s_lshl_b32 s22, s20, 12
  s_add_u32 s22, s22, s50
  s_add_u32 s23, s48, s45
  s_add_u32 m0, s22, 0
  s_nop 0
  buffer_load_dwordx4 v4, s[12:15], s48 offen offset:0 sc1 lds
  s_add_u32 m0, s22, 0
  s_nop 0
  buffer_load_dwordx4 v4, s[12:15], s48 offen offset:1024 sc1 lds
  s_add_u32 m0, s22, 2048
  s_nop 0
  buffer_load_dwordx4 v4, s[12:15], s23 offen offset:0 sc1 lds
  s_add_u32 m0, s22, 2048
  s_nop 0
  buffer_load_dwordx4 v4, s[12:15], s23 offen offset:1024 sc1 lds
  s_mul_i32 s22, s20, 5120
  s_add_u32 s22, s22, s50
  s_add_u32 s22, s22, 16384
  s_add_u32 m0, s22, 0
  s_nop 0
  buffer_load_dwordx4 v69, s[8:11], s49 offen lds
  s_add_u32 m0, s22, 1024
  s_nop 0
  buffer_load_dwordx4 v70, s[8:11], s49 offen lds
  s_add_u32 m0, s22, 2048
  s_nop 0
  buffer_load_dwordx4 v71, s[8:11], s49 offen lds
  s_add_u32 m0, s22, 3072
  s_nop 0
  buffer_load_dwordx4 v72, s[8:11], s49 offen lds
  s_add_u32 m0, s22, 4096
  s_nop 0
  buffer_load_dwordx4 v73, s[8:11], s49 offen lds
  s_add_u32 s48, s48, 2048
  s_min_u32 s48, s48, s53
  s_add_u32 s50, s50, 36864
  s_cmp_lt_u32 s50, 147456
  s_cselect_b32 s50, s50, 0
  s_lshl_b32 s22, s20, 12
  s_add_u32 s22, s22, s50
  s_add_u32 s23, s48, s45
  s_add_u32 m0, s22, 0
  s_nop 0
  buffer_load_dwordx4 v4, s[12:15], s48 offen offset:0 sc1 lds
  s_add_u32 m0, s22, 0
  s_nop 0
  buffer_load_dwordx4 v4, s[12:15], s48 offen offset:1024 sc1 lds
  s_add_u32 m0, s22, 2048
  s_nop 0
  buffer_load_dwordx4 v4, s[12:15], s23 offen offset:0 sc1 lds
  s_add_u32 m0, s22, 2048
  s_nop 0
  buffer_load_dwordx4 v4, s[12:15], s23 offen offset:1024 sc1 lds
  s_mul_i32 s22, s20, 5120
  s_add_u32 s22, s22, s50
  s_add_u32 s22, s22, 16384
  s_add_u32 m0, s22, 0
  s_nop 0
  buffer_load_dwordx4 v74, s[8:11], s49 offen lds
  s_add_u32 m0, s22, 1024
  s_nop 0
  buffer_load_dwordx4 v75, s[8:11], s49 offen lds
  s_add_u32 m0, s22, 2048
  s_nop 0
  buffer_load_dwordx4 v76, s[8:11], s49 offen lds
  s_add_u32 m0, s22, 3072
  s_nop 0
  buffer_load_dwordx4 v77, s[8:11], s49 offen lds
  s_add_u32 m0, s22, 4096
  s_nop 0
  buffer_load_dwordx4 v78, s[8:11], s49 offen lds
  s_add_u32 s48, s48, 2048
  s_min_u32 s48, s48, s53
  s_add_u32 s49, s49, 245760
  s_add_u32 s50, s50, 36864
  s_cmp_lt_u32 s50, 147456
  s_cselect_b32 s50, s50, 0
  s_mov_b32 s52, 0
op_255:
  s_waitcnt vmcnt(18)
  s_barrier
  v_add_u32 v8, s51, v5
  v_add_u32 v9, s51, v6
  s_add_u32 s51, s51, 36864
  s_cmp_lt_u32 s51, 147456
  s_cselect_b32 s51, s51, 0
  ds_read_b128 v[160:163], v8 offset:0
  ds_read_b128 v[164:167], v8 offset:2048
  ds_read_b128 v[168:171], v8 offset:4096
  ds_read_b128 v[172:175], v8 offset:6144
  ds_read_b64_tr_b16 v[176:177], v9 offset:0
  ds_read_b64_tr_b16 v[178:179], v9 offset:1280
  ds_read_b64_tr_b16 v[180:181], v9 offset:32
  ds_read_b64_tr_b16 v[182:183], v9 offset:1312
  ds_read_b64_tr_b16 v[184:185], v9 offset:64
  ds_read_b64_tr_b16 v[186:187], v9 offset:1344
  ds_read_b64_tr_b16 v[188:189], v9 offset:96
  ds_read_b64_tr_b16 v[190:191], v9 offset:1376
  ds_read_b64_tr_b16 v[192:193], v9 offset:128
  ds_read_b64_tr_b16 v[194:195], v9 offset:1408
  s_lshl_b32 s22, s20, 12
  s_add_u32 s22, s22, s50
  s_add_u32 s23, s48, s45
  s_add_u32 m0, s22, 0
  s_nop 0
  buffer_load_dwordx4 v4, s[12:15], s48 offen offset:0 sc1 lds
  s_add_u32 m0, s22, 0
  s_nop 0
  buffer_load_dwordx4 v4, s[12:15], s48 offen offset:1024 sc1 lds
  s_add_u32 m0, s22, 2048
  s_nop 0
  buffer_load_dwordx4 v4, s[12:15], s23 offen offset:0 sc1 lds
  s_add_u32 m0, s22, 2048
  s_nop 0
  buffer_load_dwordx4 v4, s[12:15], s23 offen offset:1024 sc1 lds
  ds_read_b128 v[196:199], v8 offset:1024
  ds_read_b128 v[200:203], v8 offset:3072
  ds_read_b128 v[204:207], v8 offset:5120
  ds_read_b128 v[208:211], v8 offset:7168
  ds_read_b64_tr_b16 v[212:213], v9 offset:10240
  ds_read_b64_tr_b16 v[214:215], v9 offset:11520
  ds_read_b64_tr_b16 v[216:217], v9 offset:10272
  ds_read_b64_tr_b16 v[218:219], v9 offset:11552
  ds_read_b64_tr_b16 v[220:221], v9 offset:10304
  ds_read_b64_tr_b16 v[222:223], v9 offset:11584
  ds_read_b64_tr_b16 v[224:225], v9 offset:10336
  ds_read_b64_tr_b16 v[226:227], v9 offset:11616
  ds_read_b64_tr_b16 v[228:229], v9 offset:10368
  ds_read_b64_tr_b16 v[230:231], v9 offset:11648
  s_waitcnt lgkmcnt(14)
  v_mfma_f32_16x16x32_bf16 v[80:83], v[176:179], v[160:163], v[80:83]
  v_mfma_f32_16x16x32_bf16 v[84:87], v[180:183], v[160:163], v[84:87]
  v_mfma_f32_16x16x32_bf16 v[88:91], v[184:187], v[160:163], v[88:91]
  v_mfma_f32_16x16x32_bf16 v[92:95], v[188:191], v[160:163], v[92:95]
  v_mfma_f32_16x16x32_bf16 v[96:99], v[192:195], v[160:163], v[96:99]
  v_mfma_f32_16x16x32_bf16 v[100:103], v[176:179], v[164:167], v[100:103]
  v_mfma_f32_16x16x32_bf16 v[104:107], v[180:183], v[164:167], v[104:107]
  v_mfma_f32_16x16x32_bf16 v[108:111], v[184:187], v[164:167], v[108:111]
  v_mfma_f32_16x16x32_bf16 v[112:115], v[188:191], v[164:167], v[112:115]
  v_mfma_f32_16x16x32_bf16 v[116:119], v[192:195], v[164:167], v[116:119]
  v_mfma_f32_16x16x32_bf16 v[120:123], v[176:179], v[168:171], v[120:123]
  v_mfma_f32_16x16x32_bf16 v[124:127], v[180:183], v[168:171], v[124:127]
  v_mfma_f32_16x16x32_bf16 v[128:131], v[184:187], v[168:171], v[128:131]
  v_mfma_f32_16x16x32_bf16 v[132:135], v[188:191], v[168:171], v[132:135]
  v_mfma_f32_16x16x32_bf16 v[136:139], v[192:195], v[168:171], v[136:139]
  v_mfma_f32_16x16x32_bf16 v[140:143], v[176:179], v[172:175], v[140:143]
  v_mfma_f32_16x16x32_bf16 v[144:147], v[180:183], v[172:175], v[144:147]
  v_mfma_f32_16x16x32_bf16 v[148:151], v[184:187], v[172:175], v[148:151]
  v_mfma_f32_16x16x32_bf16 v[152:155], v[188:191], v[172:175], v[152:155]
  v_mfma_f32_16x16x32_bf16 v[156:159], v[192:195], v[172:175], v[156:159]
  s_mul_i32 s22, s20, 5120
  s_add_u32 s22, s22, s50
  s_add_u32 s22, s22, 16384
  s_add_u32 m0, s22, 0
  s_nop 0
  buffer_load_dwordx4 v64, s[8:11], s49 offen lds
  s_add_u32 m0, s22, 1024
  s_nop 0
  buffer_load_dwordx4 v65, s[8:11], s49 offen lds
  s_add_u32 m0, s22, 2048
  s_nop 0
  buffer_load_dwordx4 v66, s[8:11], s49 offen lds
  s_add_u32 m0, s22, 3072
  s_nop 0
  buffer_load_dwordx4 v67, s[8:11], s49 offen lds
  s_add_u32 m0, s22, 4096
  s_nop 0
  buffer_load_dwordx4 v68, s[8:11], s49 offen lds
  s_add_u32 s48, s48, 2048
  s_min_u32 s48, s48, s53
  s_add_u32 s50, s50, 36864
  s_cmp_lt_u32 s50, 147456
  s_cselect_b32 s50, s50, 0
  s_waitcnt lgkmcnt(0)
  v_mfma_f32_16x16x32_bf16 v[80:83], v[212:215], v[196:199], v[80:83]
  v_mfma_f32_16x16x32_bf16 v[84:87], v[216:219], v[196:199], v[84:87]
  v_mfma_f32_16x16x32_bf16 v[88:91], v[220:223], v[196:199], v[88:91]
  v_mfma_f32_16x16x32_bf16 v[92:95], v[224:227], v[196:199], v[92:95]
  v_mfma_f32_16x16x32_bf16 v[96:99], v[228:231], v[196:199], v[96:99]
  v_mfma_f32_16x16x32_bf16 v[100:103], v[212:215], v[200:203], v[100:103]
  v_mfma_f32_16x16x32_bf16 v[104:107], v[216:219], v[200:203], v[104:107]
  v_mfma_f32_16x16x32_bf16 v[108:111], v[220:223], v[200:203], v[108:111]
  v_mfma_f32_16x16x32_bf16 v[112:115], v[224:227], v[200:203], v[112:115]
  v_mfma_f32_16x16x32_bf16 v[116:119], v[228:231], v[200:203], v[116:119]
  v_mfma_f32_16x16x32_bf16 v[120:123], v[212:215], v[204:207], v[120:123]
  v_mfma_f32_16x16x32_bf16 v[124:127], v[216:219], v[204:207], v[124:127]
  v_mfma_f32_16x16x32_bf16 v[128:131], v[220:223], v[204:207], v[128:131]
  v_mfma_f32_16x16x32_bf16 v[132:135], v[224:227], v[204:207], v[132:135]
  v_mfma_f32_16x16x32_bf16 v[136:139], v[228:231], v[204:207], v[136:139]
  v_mfma_f32_16x16x32_bf16 v[140:143], v[212:215], v[208:211], v[140:143]
  v_mfma_f32_16x16x32_bf16 v[144:147], v[216:219], v[208:211], v[144:147]
  v_mfma_f32_16x16x32_bf16 v[148:151], v[220:223], v[208:211], v[148:151]
  v_mfma_f32_16x16x32_bf16 v[152:155], v[224:227], v[208:211], v[152:155]
  v_mfma_f32_16x16x32_bf16 v[156:159], v[228:231], v[208:211], v[156:159]
  s_add_u32 s52, s52, 1
  s_cmp_ge_u32 s52, s44
  s_cbranch_scc1 opd_256
  s_waitcnt vmcnt(18)
  s_barrier
  v_add_u32 v8, s51, v5
  v_add_u32 v9, s51, v6
  s_add_u32 s51, s51, 36864
  s_cmp_lt_u32 s51, 147456
  s_cselect_b32 s51, s51, 0
  ds_read_b128 v[160:163], v8 offset:0
  ds_read_b128 v[164:167], v8 offset:2048
  ds_read_b128 v[168:171], v8 offset:4096
  ds_read_b128 v[172:175], v8 offset:6144
  ds_read_b64_tr_b16 v[176:177], v9 offset:0
  ds_read_b64_tr_b16 v[178:179], v9 offset:1280
  ds_read_b64_tr_b16 v[180:181], v9 offset:32
  ds_read_b64_tr_b16 v[182:183], v9 offset:1312
  ds_read_b64_tr_b16 v[184:185], v9 offset:64
  ds_read_b64_tr_b16 v[186:187], v9 offset:1344
  ds_read_b64_tr_b16 v[188:189], v9 offset:96
  ds_read_b64_tr_b16 v[190:191], v9 offset:1376
  ds_read_b64_tr_b16 v[192:193], v9 offset:128
  ds_read_b64_tr_b16 v[194:195], v9 offset:1408
  s_lshl_b32 s22, s20, 12
  s_add_u32 s22, s22, s50
  s_add_u32 s23, s48, s45
  s_add_u32 m0, s22, 0
  s_nop 0
  buffer_load_dwordx4 v4, s[12:15], s48 offen offset:0 sc1 lds
  s_add_u32 m0, s22, 0
  s_nop 0
  buffer_load_dwordx4 v4, s[12:15], s48 offen offset:1024 sc1 lds
  s_add_u32 m0, s22, 2048
  s_nop 0
  buffer_load_dwordx4 v4, s[12:15], s23 offen offset:0 sc1 lds
  s_add_u32 m0, s22, 2048
  s_nop 0
  buffer_load_dwordx4 v4, s[12:15], s23 offen offset:1024 sc1 lds
  ds_read_b128 v[196:199], v8 offset:1024
  ds_read_b128 v[200:203], v8 offset:3072
  ds_read_b128 v[204:207], v8 offset:5120
  ds_read_b128 v[208:211], v8 offset:7168
  ds_read_b64_tr_b16 v[212:213], v9 offset:10240
  ds_read_b64_tr_b16 v[214:215], v9 offset:11520
  ds_read_b64_tr_b16 v[216:217], v9 offset:10272
  ds_read_b64_tr_b16 v[218:219], v9 offset:11552
  ds_read_b64_tr_b16 v[220:221], v9 offset:10304
  ds_read_b64_tr_b16 v[222:223], v9 offset:11584
  ds_read_b64_tr_b16 v[224:225], v9 offset:10336
  ds_read_b64_tr_b16 v[226:227], v9 offset:11616
  ds_read_b64_tr_b16 v[228:229], v9 offset:10368
  ds_read_b64_tr_b16 v[230:231], v9 offset:11648
  s_waitcnt lgkmcnt(14)
  v_mfma_f32_16x16x32_bf16 v[80:83], v[176:179], v[160:163], v[80:83]
  v_mfma_f32_16x16x32_bf16 v[84:87], v[180:183], v[160:163], v[84:87]
  v_mfma_f32_16x16x32_bf16 v[88:91], v[184:187], v[160:163], v[88:91]
  v_mfma_f32_16x16x32_bf16 v[92:95], v[188:191], v[160:163], v[92:95]
  v_mfma_f32_16x16x32_bf16 v[96:99], v[192:195], v[160:163], v[96:99]
  v_mfma_f32_16x16x32_bf16 v[100:103], v[176:179], v[164:167], v[100:103]
  v_mfma_f32_16x16x32_bf16 v[104:107], v[180:183], v[164:167], v[104:107]
  v_mfma_f32_16x16x32_bf16 v[108:111], v[184:187], v[164:167], v[108:111]
  v_mfma_f32_16x16x32_bf16 v[112:115], v[188:191], v[164:167], v[112:115]
  v_mfma_f32_16x16x32_bf16 v[116:119], v[192:195], v[164:167], v[116:119]
  v_mfma_f32_16x16x32_bf16 v[120:123], v[176:179], v[168:171], v[120:123]
  v_mfma_f32_16x16x32_bf16 v[124:127], v[180:183], v[168:171], v[124:127]
  v_mfma_f32_16x16x32_bf16 v[128:131], v[184:187], v[168:171], v[128:131]
  v_mfma_f32_16x16x32_bf16 v[132:135], v[188:191], v[168:171], v[132:135]
  v_mfma_f32_16x16x32_bf16 v[136:139], v[192:195], v[168:171], v[136:139]
  v_mfma_f32_16x16x32_bf16 v[140:143], v[176:179], v[172:175], v[140:143]
  v_mfma_f32_16x16x32_bf16 v[144:147], v[180:183], v[172:175], v[144:147]
  v_mfma_f32_16x16x32_bf16 v[148:151], v[184:187], v[172:175], v[148:151]
  v_mfma_f32_16x16x32_bf16 v[152:155], v[188:191], v[172:175], v[152:155]
  v_mfma_f32_16x16x32_bf16 v[156:159], v[192:195], v[172:175], v[156:159]
  s_mul_i32 s22, s20, 5120
  s_add_u32 s22, s22, s50
  s_add_u32 s22, s22, 16384
  s_add_u32 m0, s22, 0
  s_nop 0
  buffer_load_dwordx4 v69, s[8:11], s49 offen lds
  s_add_u32 m0, s22, 1024
  s_nop 0
  buffer_load_dwordx4 v70, s[8:11], s49 offen lds
  s_add_u32 m0, s22, 2048
  s_nop 0
  buffer_load_dwordx4 v71, s[8:11], s49 offen lds
  s_add_u32 m0, s22, 3072
  s_nop 0
  buffer_load_dwordx4 v72, s[8:11], s49 offen lds
  s_add_u32 m0, s22, 4096
  s_nop 0
  buffer_load_dwordx4 v73, s[8:11], s49 offen lds
  s_add_u32 s48, s48, 2048
  s_min_u32 s48, s48, s53
  s_add_u32 s50, s50, 36864
  s_cmp_lt_u32 s50, 147456
  s_cselect_b32 s50, s50, 0
  s_waitcnt lgkmcnt(0)
  v_mfma_f32_16x16x32_bf16 v[80:83], v[212:215], v[196:199], v[80:83]
  v_mfma_f32_16x16x32_bf16 v[84:87], v[216:219], v[196:199], v[84:87]
  v_mfma_f32_16x16x32_bf16 v[88:91], v[220:223], v[196:199], v[88:91]
  v_mfma_f32_16x16x32_bf16 v[92:95], v[224:227], v[196:199], v[92:95]
  v_mfma_f32_16x16x32_bf16 v[96:99], v[228:231], v[196:199], v[96:99]
  v_mfma_f32_16x16x32_bf16 v[100:103], v[212:215], v[200:203], v[100:103]
  v_mfma_f32_16x16x32_bf16 v[104:107], v[216:219], v[200:203], v[104:107]
  v_mfma_f32_16x16x32_bf16 v[108:111], v[220:223], v[200:203], v[108:111]
  v_mfma_f32_16x16x32_bf16 v[112:115], v[224:227], v[200:203], v[112:115]
  v_mfma_f32_16x16x32_bf16 v[116:119], v[228:231], v[200:203], v[116:119]
  v_mfma_f32_16x16x32_bf16 v[120:123], v[212:215], v[204:207], v[120:123]
  v_mfma_f32_16x16x32_bf16 v[124:127], v[216:219], v[204:207], v[124:127]
  v_mfma_f32_16x16x32_bf16 v[128:131], v[220:223], v[204:207], v[128:131]
  v_mfma_f32_16x16x32_bf16 v[132:135], v[224:227], v[204:207], v[132:135]
  v_mfma_f32_16x16x32_bf16 v[136:139], v[228:231], v[204:207], v[136:139]
  v_mfma_f32_16x16x32_bf16 v[140:143], v[212:215], v[208:211], v[140:143]
  v_mfma_f32_16x16x32_bf16 v[144:147], v[216:219], v[208:211], v[144:147]
  v_mfma_f32_16x16x32_bf16 v[148:151], v[220:223], v[208:211], v[148:151]
  v_mfma_f32_16x16x32_bf16 v[152:155], v[224:227], v[208:211], v[152:155]
  v_mfma_f32_16x16x32_bf16 v[156:159], v[228:231], v[208:211], v[156:159]
  s_add_u32 s52, s52, 1
  s_cmp_ge_u32 s52, s44
  s_cbranch_scc1 opd_256
  s_waitcnt vmcnt(18)
  s_barrier
  v_add_u32 v8, s51, v5
  v_add_u32 v9, s51, v6
  s_add_u32 s51, s51, 36864
  s_cmp_lt_u32 s51, 147456
  s_cselect_b32 s51, s51, 0
  ds_read_b128 v[160:163], v8 offset:0
  ds_read_b128 v[164:167], v8 offset:2048
  ds_read_b128 v[168:171], v8 offset:4096
  ds_read_b128 v[172:175], v8 offset:6144
  ds_read_b64_tr_b16 v[176:177], v9 offset:0
  ds_read_b64_tr_b16 v[178:179], v9 offset:1280
  ds_read_b64_tr_b16 v[180:181], v9 offset:32
  ds_read_b64_tr_b16 v[182:183], v9 offset:1312
  ds_read_b64_tr_b16 v[184:185], v9 offset:64
  ds_read_b64_tr_b16 v[186:187], v9 offset:1344
  ds_read_b64_tr_b16 v[188:189], v9 offset:96
  ds_read_b64_tr_b16 v[190:191], v9 offset:1376
  ds_read_b64_tr_b16 v[192:193], v9 offset:128
  ds_read_b64_tr_b16 v[194:195], v9 offset:1408
  s_lshl_b32 s22, s20, 12
  s_add_u32 s22, s22, s50
  s_add_u32 s23, s48, s45
  s_add_u32 m0, s22, 0
  s_nop 0
  buffer_load_dwordx4 v4, s[12:15], s48 offen offset:0 sc1 lds
  s_add_u32 m0, s22, 0
  s_nop 0
  buffer_load_dwordx4 v4, s[12:15], s48 offen offset:1024 sc1 lds
  s_add_u32 m0, s22, 2048
  s_nop 0
  buffer_load_dwordx4 v4, s[12:15], s23 offen offset:0 sc1 lds
  s_add_u32 m0, s22, 2048
  s_nop 0
  buffer_load_dwordx4 v4, s[12:15], s23 offen offset:1024 sc1 lds
  ds_read_b128 v[196:199], v8 offset:1024
  ds_read_b128 v[200:203], v8 offset:3072
  ds_read_b128 v[204:207], v8 offset:5120
  ds_read_b128 v[208:211], v8 offset:7168
  ds_read_b64_tr_b16 v[212:213], v9 offset:10240
  ds_read_b64_tr_b16 v[214:215], v9 offset:11520
  ds_read_b64_tr_b16 v[216:217], v9 offset:10272
  ds_read_b64_tr_b16 v[218:219], v9 offset:11552
  ds_read_b64_tr_b16 v[220:221], v9 offset:10304
  ds_read_b64_tr_b16 v[222:223], v9 offset:11584
  ds_read_b64_tr_b16 v[224:225], v9 offset:10336
  ds_read_b64_tr_b16 v[226:227], v9 offset:11616
  ds_read_b64_tr_b16 v[228:229], v9 offset:10368
  ds_read_b64_tr_b16 v[230:231], v9 offset:11648
  s_waitcnt lgkmcnt(14)
  v_mfma_f32_16x16x32_bf16 v[80:83], v[176:179], v[160:163], v[80:83]
  v_mfma_f32_16x16x32_bf16 v[84:87], v[180:183], v[160:163], v[84:87]
  v_mfma_f32_16x16x32_bf16 v[88:91], v[184:187], v[160:163], v[88:91]
  v_mfma_f32_16x16x32_bf16 v[92:95], v[188:191], v[160:163], v[92:95]
  v_mfma_f32_16x16x32_bf16 v[96:99], v[192:195], v[160:163], v[96:99]
  v_mfma_f32_16x16x32_bf16 v[100:103], v[176:179], v[164:167], v[100:103]
  v_mfma_f32_16x16x32_bf16 v[104:107], v[180:183], v[164:167], v[104:107]
  v_mfma_f32_16x16x32_bf16 v[108:111], v[184:187], v[164:167], v[108:111]
  v_mfma_f32_16x16x32_bf16 v[112:115], v[188:191], v[164:167], v[112:115]
  v_mfma_f32_16x16x32_bf16 v[116:119], v[192:195], v[164:167], v[116:119]
  v_mfma_f32_16x16x32_bf16 v[120:123], v[176:179], v[168:171], v[120:123]
  v_mfma_f32_16x16x32_bf16 v[124:127], v[180:183], v[168:171], v[124:127]
  v_mfma_f32_16x16x32_bf16 v[128:131], v[184:187], v[168:171], v[128:131]
  v_mfma_f32_16x16x32_bf16 v[132:135], v[188:191], v[168:171], v[132:135]
  v_mfma_f32_16x16x32_bf16 v[136:139], v[192:195], v[168:171], v[136:139]
  v_mfma_f32_16x16x32_bf16 v[140:143], v[176:179], v[172:175], v[140:143]
  v_mfma_f32_16x16x32_bf16 v[144:147], v[180:183], v[172:175], v[144:147]
  v_mfma_f32_16x16x32_bf16 v[148:151], v[184:187], v[172:175], v[148:151]
  v_mfma_f32_16x16x32_bf16 v[152:155], v[188:191], v[172:175], v[152:155]
  v_mfma_f32_16x16x32_bf16 v[156:159], v[192:195], v[172:175], v[156:159]
  s_mul_i32 s22, s20, 5120
  s_add_u32 s22, s22, s50
  s_add_u32 s22, s22, 16384
  s_add_u32 m0, s22, 0
  s_nop 0
  buffer_load_dwordx4 v74, s[8:11], s49 offen lds
  s_add_u32 m0, s22, 1024
  s_nop 0
  buffer_load_dwordx4 v75, s[8:11], s49 offen lds
  s_add_u32 m0, s22, 2048
  s_nop 0
  buffer_load_dwordx4 v76, s[8:11], s49 offen lds
  s_add_u32 m0, s22, 3072
  s_nop 0
  buffer_load_dwordx4 v77, s[8:11], s49 offen lds
  s_add_u32 m0, s22, 4096
  s_nop 0
  buffer_load_dwordx4 v78, s[8:11], s49 offen lds
  s_add_u32 s48, s48, 2048
  s_min_u32 s48, s48, s53
  s_add_u32 s49, s49, 245760
  s_add_u32 s50, s50, 36864
  s_cmp_lt_u32 s50, 147456
  s_cselect_b32 s50, s50, 0
  s_waitcnt lgkmcnt(0)
  v_mfma_f32_16x16x32_bf16 v[80:83], v[212:215], v[196:199], v[80:83]
  v_mfma_f32_16x16x32_bf16 v[84:87], v[216:219], v[196:199], v[84:87]
  v_mfma_f32_16x16x32_bf16 v[88:91], v[220:223], v[196:199], v[88:91]
  v_mfma_f32_16x16x32_bf16 v[92:95], v[224:227], v[196:199], v[92:95]
  v_mfma_f32_16x16x32_bf16 v[96:99], v[228:231], v[196:199], v[96:99]
  v_mfma_f32_16x16x32_bf16 v[100:103], v[212:215], v[200:203], v[100:103]
  v_mfma_f32_16x16x32_bf16 v[104:107], v[216:219], v[200:203], v[104:107]
  v_mfma_f32_16x16x32_bf16 v[108:111], v[220:223], v[200:203], v[108:111]
  v_mfma_f32_16x16x32_bf16 v[112:115], v[224:227], v[200:203], v[112:115]
  v_mfma_f32_16x16x32_bf16 v[116:119], v[228:231], v[200:203], v[116:119]
  v_mfma_f32_16x16x32_bf16 v[120:123], v[212:215], v[204:207], v[120:123]
  v_mfma_f32_16x16x32_bf16 v[124:127], v[216:219], v[204:207], v[124:127]
  v_mfma_f32_16x16x32_bf16 v[128:131], v[220:223], v[204:207], v[128:131]
  v_mfma_f32_16x16x32_bf16 v[132:135], v[224:227], v[204:207], v[132:135]
  v_mfma_f32_16x16x32_bf16 v[136:139], v[228:231], v[204:207], v[136:139]
  v_mfma_f32_16x16x32_bf16 v[140:143], v[212:215], v[208:211], v[140:143]
  v_mfma_f32_16x16x32_bf16 v[144:147], v[216:219], v[208:211], v[144:147]
  v_mfma_f32_16x16x32_bf16 v[148:151], v[220:223], v[208:211], v[148:151]
  v_mfma_f32_16x16x32_bf16 v[152:155], v[224:227], v[208:211], v[152:155]
  v_mfma_f32_16x16x32_bf16 v[156:159], v[228:231], v[208:211], v[156:159]
  s_add_u32 s52, s52, 1
  s_cmp_ge_u32 s52, s44
  s_cbranch_scc1 opd_256
  s_branch op_255
opd_256:
  s_nop 7
  s_lshl_b32 s21, s40, 3
  s_lshr_b32 s22, s20, 1
  s_lshl_b32 s22, s22, 2
  s_add_u32 s21, s21, s22
  s_mul_i32 s21, s21, 40960
  s_mul_i32 s22, s42, 10
  s_and_b32 s23, s20, 1
  s_mul_i32 s23, s23, 5
  s_add_u32 s22, s22, s23
  s_lshl_b32 s22, s22, 10
  s_add_u32 s21, s21, s22
  buffer_store_dwordx4 v[80:83], v4, s[16:19], s21 offen offset:0 sc1
  buffer_store_dwordx4 v[84:87], v4, s[16:19], s21 offen offset:1024 sc1
  buffer_store_dwordx4 v[88:91], v4, s[16:19], s21 offen offset:2048 sc1
  buffer_store_dwordx4 v[92:95], v4, s[16:19], s21 offen offset:3072 sc1
  s_add_u32 s22, s21, 4096
  buffer_store_dwordx4 v[96:99], v4, s[16:19], s22 offen offset:0 sc1
  s_add_u32 s21, s21, 40960
  buffer_store_dwordx4 v[100:103], v4, s[16:19], s21 offen offset:0 sc1
  buffer_store_dwordx4 v[104:107], v4, s[16:19], s21 offen offset:1024 sc1
  buffer_store_dwordx4 v[108:111], v4, s[16:19], s21 offen offset:2048 sc1
  buffer_store_dwordx4 v[112:115], v4, s[16:19], s21 offen offset:3072 sc1
  s_add_u32 s22, s21, 4096
  buffer_store_dwordx4 v[116:119], v4, s[16:19], s22 offen offset:0 sc1
  s_add_u32 s21, s21, 40960
  buffer_store_dwordx4 v[120:123], v4, s[16:19], s21 offen offset:0 sc1
  buffer_store_dwordx4 v[124:127], v4, s[16:19], s21 offen offset:1024 sc1
  buffer_store_dwordx4 v[128:131], v4, s[16:19], s21 offen offset:2048 sc1
  buffer_store_dwordx4 v[132:135], v4, s[16:19], s21 offen offset:3072 sc1
  s_add_u32 s22, s21, 4096
  buffer_store_dwordx4 v[136:139], v4, s[16:19], s22 offen offset:0 sc1
  s_add_u32 s21, s21, 40960
  buffer_store_dwordx4 v[140:143], v4, s[16:19], s21 offen offset:0 sc1
  buffer_store_dwordx4 v[144:147], v4, s[16:19], s21 offen offset:1024 sc1
  buffer_store_dwordx4 v[148:151], v4, s[16:19], s21 offen offset:2048 sc1
  buffer_store_dwordx4 v[152:155], v4, s[16:19], s21 offen offset:3072 sc1
  s_add_u32 s22, s21, 4096
  buffer_store_dwordx4 v[156:159], v4, s[16:19], s22 offen offset:0 sc1
  s_add_u32 s21, s21, 40960
  s_waitcnt vmcnt(0)
  s_barrier
  s_lshl_b32 s21, s40, 7
  s_add_u32 s21, s21, 92160
  s_cmp_lg_u32 s20, 0
  s_cbranch_scc1 af_257
  v_mov_b32 v10, 0
  v_mov_b32 v11, 1
  s_mov_b64 exec, 1
  buffer_atomic_add v11, v10, s[72:75], s21 offen sc1
  s_mov_b64 exec, -1
  s_nop 1
af_257:
  s_branch queue
do_pv:
  s_mov_b32 s2, s21
  s_load_dwordx2 s[4:5], s[0:1], 88
  s_load_dwordx2 s[38:39], s[0:1], 104
  s_waitcnt lgkmcnt(0)
  s_mov_b32 s8, s4
  s_mov_b32 s9, s5
  s_mov_b32 s10, 2621440
  s_mov_b32 s11, 0x00020000
  s_add_u32 s12, s38, 114294784
  s_addc_u32 s13, s39, 0
  s_mov_b32 s14, 83886080
  s_mov_b32 s15, 0x00020000
  s_add_u32 s16, s38, 85983232
  s_addc_u32 s17, s39, 0
  s_mov_b32 s18, 28311552
  s_mov_b32 s19, 0x00020000
  s_add_u32 s24, s38, 73400320
  s_addc_u32 s25, s39, 0
  s_mov_b32 s26, 5242880
  s_mov_b32 s27, 0x00020000
  s_add_u32 s28, s38, 81002496
  s_addc_u32 s29, s39, 0
  s_mov_b32 s30, 8192
  s_mov_b32 s31, 0x00020000
  s_add_u32 s72, s38, 81068032
  s_addc_u32 s73, s39, 0
  s_mov_b32 s74, 115712
  s_mov_b32 s75, 0x00020000
  v_lshlrev_b32 v4, 4, v1
  v_lshlrev_b32 v5, 3, v1
  v_lshlrev_b32 v6, 2, v2
  v_and_b32 v7, 7, v1
  v_lshlrev_b32 v7, 7, v7
  v_bfe_u32 v31, v1, 3, 2
  v_lshl_add_u32 v31, v31, 2, v7
  s_lshl_b32 s21, s20, 10
  s_add_u32 s21, s21, 94208
  buffer_load_dword v8, v31, s[72:75], s21 offen sc1
  v_lshlrev_b32 v25, 7, v2
  s_mov_b32 s21, 92160
  buffer_load_dword v26, v25, s[72:75], s21 offen sc1
  s_mov_b32 s63, 1
  v_mul_u32_u24 v9, 1280, v2
  v_lshl_add_u32 v13, v3, 3, v9
  v_lshl_add_u32 v9, v3, 4, v9
  s_mul_i32 s21, s20, 10240
  v_add_u32 v10, s21, v4
  s_and_b32 s43, s20, 1
  s_lshr_b32 s44, s20, 1
  s_mul_i32 s21, s44, 6
  s_add_u32 s21, s21, s43
  s_lshl_b32 s21, s21, 10
  v_add_u32 v11, s21, v4
  s_add_u32 s21, s43, 4
  s_lshl_b32 s21, s21, 10
  v_add_u32 v12, s21, v4
  v_lshrrev_b32 v20, 5, v1
  v_mul_u32_u24 v21, 2560, v20
  v_add_u32 v21, v21, v4
  v_and_b32 v22, 31, v1
  v_lshlrev_b32 v22, 4, v22
  v_mul_u32_u24 v14, 10240, v20
  v_add_u32 v22, v22, v14
  v_and_b32 v15, 1, v3
  v_lshl_add_u32 v14, v15, 6, v14
  v_lshrrev_b32 v16, 3, v2
  v_mul_u32_u24 v16, 576, v16
  v_lshl_add_u32 v16, v2, 3, v16
  v_add_u32 v14, v14, v16
  v_lshlrev_b32 v16, 10, v20
  v_lshl_add_u32 v16, v15, 9, v16
  v_lshl_add_u32 v15, v2, 4, v16
  v_lshlrev_b32 v17, 2, v7
  v_bfe_u32 v16, v1, 3, 1
  v_lshl_add_u32 v17, v16, 3, v17
  v_cmp_gt_u32 s[66:67], 16, v1
  v_mov_b32 v28, 80
  v_mov_b32 v30, 40960
  s_mov_b32 s50, 0
  s_mov_b32 s51, 0
  v_mov_b32 v70, 0
  v_mov_b32 v71, 0
  v_mov_b32 v78, 0
  v_mov_b32 v79, 0
  v_mov_b32 v86, 0
  v_mov_b32 v87, 0
  v_mov_b32 v94, 0
  v_mov_b32 v95, 0
  v_mov_b32 v102, 0
  v_mov_b32 v103, 0
  v_mov_b32 v110, 0
  v_mov_b32 v111, 0
  v_mov_b32 v118, 0
  v_mov_b32 v119, 0
  v_mov_b32 v126, 0
  v_mov_b32 v127, 0
  s_mov_b32 s21, s2
pv_loop:
  s_mov_b32 s2, s21
  s_lshr_b32 s40, s2, 3
  s_and_b32 s41, s2, 7
  s_lshr_b32 s52, s41, 1
  s_lshl_b32 s52, s52, 7
  s_and_b32 s21, s41, 1
  s_lshl_b32 s21, s21, 4
  s_add_u32 s52, s52, s21
  s_add_u32 s52, s52, 18432
  s_lshl_b32 s21, s40, 10
  s_add_u32 s21, s21, 22528
  v_add_u32 v18, s21, v7
  v_add_u32 v19, s52, v17
  v_cndmask_b32 v18, v19, v18, s[66:67]
  s_add_u32 s21, s40, 1
  v_mov_b32 v19, s21
  v_cndmask_b32 v19, v19, 4, s[66:67]
  buffer_load_dword v27, v18, s[72:75], 0 offen sc1
  s_cmp_lg_u32 s20, 0
  s_cbranch_scc1 pv_258
  v_mov_b32 v29, 1
  s_mov_b64 exec, 1
  buffer_atomic_add v29, v28, s[32:35], 0 offen sc0 sc1
  s_mov_b64 exec, -1
pv_258:
  s_lshl_b32 s42, s40, 5
  s_lshl_b32 s21, s20, 3
  s_add_u32 s42, s42, s21
  s_mul_i32 s53, s42, 40960
  s_mul_i32 s22, s41, 5120
  s_add_u32 s53, s53, s22
  s_lshl_b32 s21, s40, 1
  s_add_u32 s21, s21, s43
  s_lshl_b32 s45, s21, 6
  s_mul_i32 s46, s21, 20480
  s_mul_i32 s21, s21, 40960
  s_add_u32 s55, s21, s22
  s_mul_i32 s21, s44, 3072
  s_add_u32 s54, s55, s21
  s_mul_i32 s22, s41, 160
  s_add_u32 s49, s46, s22
  s_mul_i32 s21, s44, 96
  s_add_u32 s46, s49, s21
  s_mul_i32 s47, s42, 2560
  s_mul_i32 s48, s42, 10240
  s_mul_i32 s22, s41, 1280
  s_add_u32 s48, s48, s22
  s_add_u32 s48, s48, 7340032
  s_add_u32 s23, s40, 1
  s_cmp_ge_u32 s50, s23
  s_cbranch_scc1 pv_259
  s_cmp_eq_u32 s63, 0
  s_cbranch_scc1 pv_262
  s_mov_b32 s63, 0
  s_waitcnt vmcnt(1)
  v_cmp_le_u32 vcc, 4, v26
  s_mov_b32 s51, vcc_lo
  v_cmp_gt_u32 vcc, s23, v8
  s_nop 1
  s_cbranch_vccz pv_263
pv_262:
  s_lshl_b32 s21, s20, 10
  s_add_u32 s21, s21, 94208
  s_mov_b32 s101, 0
wm_266:
  buffer_load_dword v8, v31, s[72:75], s21 offen sc1
  s_add_u32 s101, s101, 1
  s_cmp_gt_u32 s101, 131072
  s_cbranch_scc1 main_end
  s_waitcnt vmcnt(0)
  v_cmp_gt_u32 vcc, s23, v8
  v_readfirstlane_b32 s100, v8
  s_nop 0
  s_cbranch_vccz wm_267
  s_sleep 8
  s_add_u32 s100, s100, 2
  s_cmp_ge_u32 s100, s23
  s_cbranch_scc1 wm_266
  s_sleep 60
  s_branch wm_266
wm_267:
pv_263:
  v_readlane_b32 s50, v8, 0
  v_readlane_b32 s21, v8, 1
  s_min_u32 s50, s50, s21
  v_readlane_b32 s21, v8, 2
  s_min_u32 s50, s50, s21
  v_readlane_b32 s21, v8, 3
  s_min_u32 s50, s50, s21
  v_readlane_b32 s21, v8, 4
  s_min_u32 s50, s50, s21
  v_readlane_b32 s21, v8, 5
  s_min_u32 s50, s50, s21
  v_readlane_b32 s21, v8, 6
  s_min_u32 s50, s50, s21
  v_readlane_b32 s21, v8, 7
  s_min_u32 s50, s50, s21
  v_readlane_b32 s21, v8, 8
  s_min_u32 s50, s50, s21
  v_readlane_b32 s21, v8, 9
  s_min_u32 s50, s50, s21
  v_readlane_b32 s21, v8, 10
  s_min_u32 s50, s50, s21
  v_readlane_b32 s21, v8, 11
  s_min_u32 s50, s50, s21
  v_readlane_b32 s21, v8, 12
  s_min_u32 s50, s50, s21
  v_readlane_b32 s21, v8, 13
  s_min_u32 s50, s50, s21
  v_readlane_b32 s21, v8, 14
  s_min_u32 s50, s50, s21
  v_readlane_b32 s21, v8, 15
  s_min_u32 s50, s50, s21
  v_readlane_b32 s21, v8, 16
  s_min_u32 s50, s50, s21
  v_readlane_b32 s21, v8, 17
  s_min_u32 s50, s50, s21
  v_readlane_b32 s21, v8, 18
  s_min_u32 s50, s50, s21
  v_readlane_b32 s21, v8, 19
  s_min_u32 s50, s50, s21
  v_readlane_b32 s21, v8, 20
  s_min_u32 s50, s50, s21
  v_readlane_b32 s21, v8, 21
  s_min_u32 s50, s50, s21
  v_readlane_b32 s21, v8, 22
  s_min_u32 s50, s50, s21
  v_readlane_b32 s21, v8, 23
  s_min_u32 s50, s50, s21
  v_readlane_b32 s21, v8, 24
  s_min_u32 s50, s50, s21
  v_readlane_b32 s21, v8, 25
  s_min_u32 s50, s50, s21
  v_readlane_b32 s21, v8, 26
  s_min_u32 s50, s50, s21
  v_readlane_b32 s21, v8, 27
  s_min_u32 s50, s50, s21
  v_readlane_b32 s21, v8, 28
  s_min_u32 s50, s50, s21
  v_readlane_b32 s21, v8, 29
  s_min_u32 s50, s50, s21
  v_readlane_b32 s21, v8, 30
  s_min_u32 s50, s50, s21
  v_readlane_b32 s21, v8, 31
  s_min_u32 s50, s50, s21
pv_259:
  s_lshr_b32 s22, s40, 2
  s_bitcmp1_b32 s51, s22
  s_cbranch_scc1 pv_260
  s_mov_b32 s21, 92160
  v_lshlrev_b32 v25, 7, v2
  s_mov_b32 s101, 0
pv_261:
  buffer_load_dword v26, v25, s[72:75], s21 offen sc1
  s_add_u32 s101, s101, 1
  s_cmp_gt_u32 s101, 131072
  s_cbranch_scc1 main_end
  s_waitcnt vmcnt(0)
  v_cmp_le_u32 vcc, 4, v26
  s_mov_b32 s51, vcc_lo
  s_bitcmp1_b32 s51, s22
  s_cbranch_scc1 pv_260
  s_sleep 8
  s_branch pv_261
pv_260:
  buffer_load_dwordx4 a[0:3], v4, s[12:15], s53 offen offset:0 sc1
  buffer_load_dwordx4 a[4:7], v4, s[12:15], s53 offen offset:1024 sc1
  buffer_load_dwordx4 a[8:11], v4, s[12:15], s53 offen offset:2048 sc1
  buffer_load_dwordx4 a[12:15], v4, s[12:15], s53 offen offset:3072 sc1
  s_add_u32 s21, s53, 4096
  buffer_load_dwordx4 a[16:19], v4, s[12:15], s21 offen offset:0 sc1
  s_add_u32 s53, s53, 40960
  buffer_load_dwordx4 a[20:23], v4, s[12:15], s53 offen offset:0 sc1
  buffer_load_dwordx4 a[24:27], v4, s[12:15], s53 offen offset:1024 sc1
  buffer_load_dwordx4 a[28:31], v4, s[12:15], s53 offen offset:2048 sc1
  buffer_load_dwordx4 a[32:35], v4, s[12:15], s53 offen offset:3072 sc1
  s_add_u32 s21, s53, 4096
  buffer_load_dwordx4 a[36:39], v4, s[12:15], s21 offen offset:0 sc1
  s_add_u32 s53, s53, 40960
  buffer_load_dwordx4 a[40:43], v4, s[12:15], s53 offen offset:0 sc1
  buffer_load_dwordx4 a[44:47], v4, s[12:15], s53 offen offset:1024 sc1
  buffer_load_dwordx4 a[48:51], v4, s[12:15], s53 offen offset:2048 sc1
  buffer_load_dwordx4 a[52:55], v4, s[12:15], s53 offen offset:3072 sc1
  s_add_u32 s21, s53, 4096
  buffer_load_dwordx4 a[56:59], v4, s[12:15], s21 offen offset:0 sc1
  s_add_u32 s53, s53, 40960
  buffer_load_dwordx4 a[60:63], v4, s[12:15], s53 offen offset:0 sc1
  buffer_load_dwordx4 a[64:67], v4, s[12:15], s53 offen offset:1024 sc1
  buffer_load_dwordx4 a[68:71], v4, s[12:15], s53 offen offset:2048 sc1
  buffer_load_dwordx4 a[72:75], v4, s[12:15], s53 offen offset:3072 sc1
  s_add_u32 s21, s53, 4096
  buffer_load_dwordx4 a[76:79], v4, s[12:15], s21 offen offset:0 sc1
  s_add_u32 s53, s53, 40960
  buffer_load_dwordx4 a[80:83], v4, s[12:15], s53 offen offset:0 sc1
  buffer_load_dwordx4 a[84:87], v4, s[12:15], s53 offen offset:1024 sc1
  buffer_load_dwordx4 a[88:91], v4, s[12:15], s53 offen offset:2048 sc1
  buffer_load_dwordx4 a[92:95], v4, s[12:15], s53 offen offset:3072 sc1
  s_add_u32 s21, s53, 4096
  buffer_load_dwordx4 a[96:99], v4, s[12:15], s21 offen offset:0 sc1
  s_add_u32 s53, s53, 40960
  buffer_load_dwordx4 a[100:103], v4, s[12:15], s53 offen offset:0 sc1
  buffer_load_dwordx4 a[104:107], v4, s[12:15], s53 offen offset:1024 sc1
  buffer_load_dwordx4 a[108:111], v4, s[12:15], s53 offen offset:2048 sc1
  buffer_load_dwordx4 a[112:115], v4, s[12:15], s53 offen offset:3072 sc1
  s_add_u32 s21, s53, 4096
  buffer_load_dwordx4 a[116:119], v4, s[12:15], s21 offen offset:0 sc1
  s_add_u32 s53, s53, 40960
  buffer_load_dwordx4 a[120:123], v4, s[12:15], s53 offen offset:0 sc1
  buffer_load_dwordx4 a[124:127], v4, s[12:15], s53 offen offset:1024 sc1
  buffer_load_dwordx4 a[128:131], v4, s[12:15], s53 offen offset:2048 sc1
  buffer_load_dwordx4 a[132:135], v4, s[12:15], s53 offen offset:3072 sc1
  s_add_u32 s21, s53, 4096
  buffer_load_dwordx4 a[136:139], v4, s[12:15], s21 offen offset:0 sc1
  s_add_u32 s53, s53, 40960
  buffer_load_dwordx4 a[140:143], v4, s[12:15], s53 offen offset:0 sc1
  buffer_load_dwordx4 a[144:147], v4, s[12:15], s53 offen offset:1024 sc1
  buffer_load_dwordx4 a[148:151], v4, s[12:15], s53 offen offset:2048 sc1
  buffer_load_dwordx4 a[152:155], v4, s[12:15], s53 offen offset:3072 sc1
  s_add_u32 s21, s53, 4096
  buffer_load_dwordx4 a[156:159], v4, s[12:15], s21 offen offset:0 sc1
  s_add_u32 s53, s53, 40960
  buffer_load_dwordx4 v[240:243], v15, s[24:27], s54 offen sc1
  buffer_load_dwordx4 v[244:247], v15, s[24:27], s54 offen offset:256 sc1
  buffer_load_dwordx4 v[248:251], v4, s[24:27], s55 offen offset:2048 sc1
  buffer_load_dword v24, v6, s[28:31], s45 offen sc1
  s_waitcnt vmcnt(44)
  v_cmp_gt_u32 vcc, v19, v27
  s_nop 1
  s_cbranch_vccnz pvw_264
  buffer_load_dwordx4 v[64:67], v4, s[16:19], s47 offen sc1
  buffer_load_dwordx2 v[68:69], v5, s[16:19], s47 offen offset:2048 sc1
  buffer_load_dwordx4 v[128:131], v21, s[16:19], s47 offen offset:1024 sc1
  s_add_u32 s47, s47, 2560
  buffer_load_dwordx4 v[72:75], v4, s[16:19], s47 offen sc1
  buffer_load_dwordx2 v[76:77], v5, s[16:19], s47 offen offset:2048 sc1
  s_add_u32 s47, s47, 2560
  buffer_load_dwordx4 v[80:83], v4, s[16:19], s47 offen sc1
  buffer_load_dwordx2 v[84:85], v5, s[16:19], s47 offen offset:2048 sc1
  buffer_load_dwordx4 v[132:135], v21, s[16:19], s47 offen offset:1024 sc1
  s_add_u32 s47, s47, 2560
  buffer_load_dwordx4 v[88:91], v4, s[16:19], s47 offen sc1
  buffer_load_dwordx2 v[92:93], v5, s[16:19], s47 offen offset:2048 sc1
  s_add_u32 s47, s47, 2560
  buffer_load_dwordx4 v[32:35], v22, s[16:19], s48 offen offset:0 sc1
  buffer_load_dwordx4 v[40:43], v22, s[16:19], s48 offen offset:640 sc1
  buffer_load_dwordx2 v[184:185], v14, s[16:19], s48 offen offset:512 sc1
  s_add_u32 s48, s48, 20480
  buffer_load_dwordx4 v[36:39], v22, s[16:19], s48 offen offset:0 sc1
  buffer_load_dwordx4 v[44:47], v22, s[16:19], s48 offen offset:640 sc1
  buffer_load_dwordx2 v[186:187], v14, s[16:19], s48 offen offset:512 sc1
  s_add_u32 s48, s48, 20480
  s_waitcnt vmcnt(40)
  buffer_load_dwordx4 v[96:99], v4, s[16:19], s47 offen sc1
  buffer_load_dwordx2 v[100:101], v5, s[16:19], s47 offen offset:2048 sc1
  buffer_load_dwordx4 v[136:139], v21, s[16:19], s47 offen offset:1024 sc1
  s_add_u32 s47, s47, 2560
  buffer_load_dwordx4 v[104:107], v4, s[16:19], s47 offen sc1
  buffer_load_dwordx2 v[108:109], v5, s[16:19], s47 offen offset:2048 sc1
  s_add_u32 s47, s47, 2560
  buffer_load_dwordx4 v[112:115], v4, s[16:19], s47 offen sc1
  buffer_load_dwordx2 v[116:117], v5, s[16:19], s47 offen offset:2048 sc1
  buffer_load_dwordx4 v[140:143], v21, s[16:19], s47 offen offset:1024 sc1
  s_add_u32 s47, s47, 2560
  buffer_load_dwordx4 v[120:123], v4, s[16:19], s47 offen sc1
  buffer_load_dwordx2 v[124:125], v5, s[16:19], s47 offen offset:2048 sc1
  s_add_u32 s47, s47, 2560
  buffer_load_dwordx4 v[48:51], v22, s[16:19], s48 offen offset:0 sc1
  buffer_load_dwordx4 v[56:59], v22, s[16:19], s48 offen offset:640 sc1
  buffer_load_dwordx2 v[188:189], v14, s[16:19], s48 offen offset:512 sc1
  s_add_u32 s48, s48, 20480
  buffer_load_dwordx4 v[52:55], v22, s[16:19], s48 offen offset:0 sc1
  buffer_load_dwordx4 v[60:63], v22, s[16:19], s48 offen offset:640 sc1
  buffer_load_dwordx2 v[190:191], v14, s[16:19], s48 offen offset:512 sc1
  s_add_u32 s48, s48, 20480
  s_barrier
  s_waitcnt vmcnt(32)
  v_sub_f32 v25, 1.0, v24
  v_cvt_pk_bf16_f32 v26, v25, v25
  v_lshlrev_b32 v25, 16, v26
  v_cvt_pk_bf16_f32 v26, v240, v240
  v_lshlrev_b32 v240, 16, v26
  v_cvt_pk_bf16_f32 v26, v241, v241
  v_lshlrev_b32 v241, 16, v26
  v_cvt_pk_bf16_f32 v26, v242, v242
  v_lshlrev_b32 v242, 16, v26
  v_cvt_pk_bf16_f32 v26, v243, v243
  v_lshlrev_b32 v243, 16, v26
  v_cvt_pk_bf16_f32 v26, v244, v244
  v_lshlrev_b32 v244, 16, v26
  v_cvt_pk_bf16_f32 v26, v245, v245
  v_lshlrev_b32 v245, 16, v26
  v_cvt_pk_bf16_f32 v26, v246, v246
  v_lshlrev_b32 v246, 16, v26
  v_cvt_pk_bf16_f32 v26, v247, v247
  v_lshlrev_b32 v247, 16, v26
  v_cvt_pk_bf16_f32 v26, v248, v248
  v_lshlrev_b32 v248, 16, v26
  v_cvt_pk_bf16_f32 v26, v249, v249
  v_lshlrev_b32 v249, 16, v26
  v_cvt_pk_bf16_f32 v26, v250, v250
  v_lshlrev_b32 v250, 16, v26
  v_cvt_pk_bf16_f32 v26, v251, v251
  v_lshlrev_b32 v251, 16, v26
  v_mul_f32 v240, v240, v25
  v_cvt_pk_bf16_f32 v26, v240, v240
  v_lshlrev_b32 v240, 16, v26
  v_mul_f32 v241, v241, v25
  v_cvt_pk_bf16_f32 v26, v241, v241
  v_lshlrev_b32 v241, 16, v26
  v_mul_f32 v242, v242, v25
  v_cvt_pk_bf16_f32 v26, v242, v242
  v_lshlrev_b32 v242, 16, v26
  v_mul_f32 v243, v243, v25
  v_cvt_pk_bf16_f32 v26, v243, v243
  v_lshlrev_b32 v243, 16, v26
  v_mul_f32 v244, v244, v25
  v_cvt_pk_bf16_f32 v26, v244, v244
  v_lshlrev_b32 v244, 16, v26
  v_mul_f32 v245, v245, v25
  v_cvt_pk_bf16_f32 v26, v245, v245
  v_lshlrev_b32 v245, 16, v26
  v_mul_f32 v246, v246, v25
  v_cvt_pk_bf16_f32 v26, v246, v246
  v_lshlrev_b32 v246, 16, v26
  v_mul_f32 v247, v247, v25
  v_cvt_pk_bf16_f32 v26, v247, v247
  v_lshlrev_b32 v247, 16, v26
  v_mul_f32 v248, v248, v25
  v_cvt_pk_bf16_f32 v26, v248, v248
  v_lshlrev_b32 v248, 16, v26
  v_mul_f32 v249, v249, v25
  v_cvt_pk_bf16_f32 v26, v249, v249
  v_lshlrev_b32 v249, 16, v26
  v_mul_f32 v250, v250, v25
  v_cvt_pk_bf16_f32 v26, v250, v250
  v_lshlrev_b32 v250, 16, v26
  v_mul_f32 v251, v251, v25
  v_cvt_pk_bf16_f32 v26, v251, v251
  v_lshlrev_b32 v251, 16, v26
  s_branch pvg_268
pvw_264:
  s_waitcnt vmcnt(0)
  v_sub_f32 v25, 1.0, v24
  v_cvt_pk_bf16_f32 v26, v25, v25
  v_lshlrev_b32 v25, 16, v26
  v_cvt_pk_bf16_f32 v26, v240, v240
  v_lshlrev_b32 v240, 16, v26
  v_cvt_pk_bf16_f32 v26, v241, v241
  v_lshlrev_b32 v241, 16, v26
  v_cvt_pk_bf16_f32 v26, v242, v242
  v_lshlrev_b32 v242, 16, v26
  v_cvt_pk_bf16_f32 v26, v243, v243
  v_lshlrev_b32 v243, 16, v26
  v_cvt_pk_bf16_f32 v26, v244, v244
  v_lshlrev_b32 v244, 16, v26
  v_cvt_pk_bf16_f32 v26, v245, v245
  v_lshlrev_b32 v245, 16, v26
  v_cvt_pk_bf16_f32 v26, v246, v246
  v_lshlrev_b32 v246, 16, v26
  v_cvt_pk_bf16_f32 v26, v247, v247
  v_lshlrev_b32 v247, 16, v26
  v_cvt_pk_bf16_f32 v26, v248, v248
  v_lshlrev_b32 v248, 16, v26
  v_cvt_pk_bf16_f32 v26, v249, v249
  v_lshlrev_b32 v249, 16, v26
  v_cvt_pk_bf16_f32 v26, v250, v250
  v_lshlrev_b32 v250, 16, v26
  v_cvt_pk_bf16_f32 v26, v251, v251
  v_lshlrev_b32 v251, 16, v26
  v_mul_f32 v240, v240, v25
  v_cvt_pk_bf16_f32 v26, v240, v240
  v_lshlrev_b32 v240, 16, v26
  v_mul_f32 v241, v241, v25
  v_cvt_pk_bf16_f32 v26, v241, v241
  v_lshlrev_b32 v241, 16, v26
  v_mul_f32 v242, v242, v25
  v_cvt_pk_bf16_f32 v26, v242, v242
  v_lshlrev_b32 v242, 16, v26
  v_mul_f32 v243, v243, v25
  v_cvt_pk_bf16_f32 v26, v243, v243
  v_lshlrev_b32 v243, 16, v26
  v_mul_f32 v244, v244, v25
  v_cvt_pk_bf16_f32 v26, v244, v244
  v_lshlrev_b32 v244, 16, v26
  v_mul_f32 v245, v245, v25
  v_cvt_pk_bf16_f32 v26, v245, v245
  v_lshlrev_b32 v245, 16, v26
  v_mul_f32 v246, v246, v25
  v_cvt_pk_bf16_f32 v26, v246, v246
  v_lshlrev_b32 v246, 16, v26
  v_mul_f32 v247, v247, v25
  v_cvt_pk_bf16_f32 v26, v247, v247
  v_lshlrev_b32 v247, 16, v26
  v_mul_f32 v248, v248, v25
  v_cvt_pk_bf16_f32 v26, v248, v248
  v_lshlrev_b32 v248, 16, v26
  v_mul_f32 v249, v249, v25
  v_cvt_pk_bf16_f32 v26, v249, v249
  v_lshlrev_b32 v249, 16, v26
  v_mul_f32 v250, v250, v25
  v_cvt_pk_bf16_f32 v26, v250, v250
  v_lshlrev_b32 v250, 16, v26
  v_mul_f32 v251, v251, v25
  v_cvt_pk_bf16_f32 v26, v251, v251
  v_lshlrev_b32 v251, 16, v26
  s_cmp_ge_u32 s40, 56
  s_cbranch_scc1 pvt_269
  s_cmp_lg_u32 s20, 0
  s_cbranch_scc1 wr_271
  s_mov_b32 s101, 0
wr_270:
  buffer_load_dword v26, v18, s[72:75], 0 offen sc1
  s_add_u32 s101, s101, 1
  s_cmp_gt_u32 s101, 131072
  s_cbranch_scc1 main_end
  s_waitcnt vmcnt(0)
  v_cmp_gt_u32 vcc, v19, v26
  v_readfirstlane_b32 s100, v26
  s_nop 0
  s_cbranch_vccz wr_271
  s_sleep 2
  s_cmp_lg_u32 s100, 0
  s_cbranch_scc1 wr_270
  s_sleep 24
  s_branch wr_270
wr_271:
  s_barrier
  buffer_load_dwordx4 v[64:67], v4, s[16:19], s47 offen sc1
  buffer_load_dwordx2 v[68:69], v5, s[16:19], s47 offen offset:2048 sc1
  buffer_load_dwordx4 v[128:131], v21, s[16:19], s47 offen offset:1024 sc1
  s_add_u32 s47, s47, 2560
  buffer_load_dwordx4 v[72:75], v4, s[16:19], s47 offen sc1
  buffer_load_dwordx2 v[76:77], v5, s[16:19], s47 offen offset:2048 sc1
  s_add_u32 s47, s47, 2560
  buffer_load_dwordx4 v[80:83], v4, s[16:19], s47 offen sc1
  buffer_load_dwordx2 v[84:85], v5, s[16:19], s47 offen offset:2048 sc1
  buffer_load_dwordx4 v[132:135], v21, s[16:19], s47 offen offset:1024 sc1
  s_add_u32 s47, s47, 2560
  buffer_load_dwordx4 v[88:91], v4, s[16:19], s47 offen sc1
  buffer_load_dwordx2 v[92:93], v5, s[16:19], s47 offen offset:2048 sc1
  s_add_u32 s47, s47, 2560
  buffer_load_dwordx4 v[32:35], v22, s[16:19], s48 offen offset:0 sc1
  buffer_load_dwordx4 v[40:43], v22, s[16:19], s48 offen offset:640 sc1
  buffer_load_dwordx2 v[184:185], v14, s[16:19], s48 offen offset:512 sc1
  s_add_u32 s48, s48, 20480
  buffer_load_dwordx4 v[36:39], v22, s[16:19], s48 offen offset:0 sc1
  buffer_load_dwordx4 v[44:47], v22, s[16:19], s48 offen offset:640 sc1
  buffer_load_dwordx2 v[186:187], v14, s[16:19], s48 offen offset:512 sc1
  s_add_u32 s48, s48, 20480
  s_waitcnt vmcnt(40)
  buffer_load_dwordx4 v[96:99], v4, s[16:19], s47 offen sc1
  buffer_load_dwordx2 v[100:101], v5, s[16:19], s47 offen offset:2048 sc1
  buffer_load_dwordx4 v[136:139], v21, s[16:19], s47 offen offset:1024 sc1
  s_add_u32 s47, s47, 2560
  buffer_load_dwordx4 v[104:107], v4, s[16:19], s47 offen sc1
  buffer_load_dwordx2 v[108:109], v5, s[16:19], s47 offen offset:2048 sc1
  s_add_u32 s47, s47, 2560
  buffer_load_dwordx4 v[112:115], v4, s[16:19], s47 offen sc1
  buffer_load_dwordx2 v[116:117], v5, s[16:19], s47 offen offset:2048 sc1
  buffer_load_dwordx4 v[140:143], v21, s[16:19], s47 offen offset:1024 sc1
  s_add_u32 s47, s47, 2560
  buffer_load_dwordx4 v[120:123], v4, s[16:19], s47 offen sc1
  buffer_load_dwordx2 v[124:125], v5, s[16:19], s47 offen offset:2048 sc1
  s_add_u32 s47, s47, 2560
  buffer_load_dwordx4 v[48:51], v22, s[16:19], s48 offen offset:0 sc1
  buffer_load_dwordx4 v[56:59], v22, s[16:19], s48 offen offset:640 sc1
  buffer_load_dwordx2 v[188:189], v14, s[16:19], s48 offen offset:512 sc1
  s_add_u32 s48, s48, 20480
  buffer_load_dwordx4 v[52:55], v22, s[16:19], s48 offen offset:0 sc1
  buffer_load_dwordx4 v[60:63], v22, s[16:19], s48 offen offset:640 sc1
  buffer_load_dwordx2 v[190:191], v14, s[16:19], s48 offen offset:512 sc1
  s_add_u32 s48, s48, 20480
pvg_268:
  s_waitcnt vmcnt(30)
  v_mfma_f32_16x16x32_bf16 v[148:151], a[0:3], v[64:67], 0
  v_mfma_f32_16x16x32_bf16 v[144:147], a[0:3], v[68:71], 0
  v_mfma_f32_16x16x32_bf16 v[156:159], a[4:7], v[64:67], 0
  v_mfma_f32_16x16x32_bf16 v[152:155], a[4:7], v[68:71], 0
  v_mfma_f32_16x16x32_bf16 v[164:167], a[8:11], v[64:67], 0
  v_mfma_f32_16x16x32_bf16 v[160:163], a[8:11], v[68:71], 0
  v_mfma_f32_16x16x32_bf16 v[172:175], a[12:15], v[64:67], 0
  v_mfma_f32_16x16x32_bf16 v[168:171], a[12:15], v[68:71], 0
  v_mfma_f32_16x16x32_bf16 v[180:183], a[16:19], v[64:67], 0
  v_mfma_f32_16x16x32_bf16 v[176:179], a[16:19], v[68:71], 0
  s_waitcnt vmcnt(27)
  v_mfma_f32_16x16x32_bf16 v[148:151], a[20:23], v[72:75], v[148:151]
  v_mfma_f32_16x16x32_bf16 v[144:147], a[20:23], v[76:79], v[144:147]
  v_mfma_f32_16x16x32_bf16 v[156:159], a[24:27], v[72:75], v[156:159]
  v_mfma_f32_16x16x32_bf16 v[152:155], a[24:27], v[76:79], v[152:155]
  v_mfma_f32_16x16x32_bf16 v[164:167], a[28:31], v[72:75], v[164:167]
  v_mfma_f32_16x16x32_bf16 v[160:163], a[28:31], v[76:79], v[160:163]
  v_mfma_f32_16x16x32_bf16 v[172:175], a[32:35], v[72:75], v[172:175]
  v_mfma_f32_16x16x32_bf16 v[168:171], a[32:35], v[76:79], v[168:171]
  v_mfma_f32_16x16x32_bf16 v[180:183], a[36:39], v[72:75], v[180:183]
  v_mfma_f32_16x16x32_bf16 v[176:179], a[36:39], v[76:79], v[176:179]
  s_waitcnt vmcnt(25)
  v_mfma_f32_16x16x32_bf16 v[148:151], a[40:43], v[80:83], v[148:151]
  v_mfma_f32_16x16x32_bf16 v[144:147], a[40:43], v[84:87], v[144:147]
  v_mfma_f32_16x16x32_bf16 v[156:159], a[44:47], v[80:83], v[156:159]
  v_mfma_f32_16x16x32_bf16 v[152:155], a[44:47], v[84:87], v[152:155]
  v_mfma_f32_16x16x32_bf16 v[164:167], a[48:51], v[80:83], v[164:167]
  v_mfma_f32_16x16x32_bf16 v[160:163], a[48:51], v[84:87], v[160:163]
  v_mfma_f32_16x16x32_bf16 v[172:175], a[52:55], v[80:83], v[172:175]
  v_mfma_f32_16x16x32_bf16 v[168:171], a[52:55], v[84:87], v[168:171]
  v_mfma_f32_16x16x32_bf16 v[180:183], a[56:59], v[80:83], v[180:183]
  v_mfma_f32_16x16x32_bf16 v[176:179], a[56:59], v[84:87], v[176:179]
  s_waitcnt vmcnt(22)
  v_mfma_f32_16x16x32_bf16 v[148:151], a[60:63], v[88:91], v[148:151]
  v_mfma_f32_16x16x32_bf16 v[144:147], a[60:63], v[92:95], v[144:147]
  v_mfma_f32_16x16x32_bf16 v[156:159], a[64:67], v[88:91], v[156:159]
  v_mfma_f32_16x16x32_bf16 v[152:155], a[64:67], v[92:95], v[152:155]
  v_mfma_f32_16x16x32_bf16 v[164:167], a[68:71], v[88:91], v[164:167]
  v_mfma_f32_16x16x32_bf16 v[160:163], a[68:71], v[92:95], v[160:163]
  v_mfma_f32_16x16x32_bf16 v[172:175], a[72:75], v[88:91], v[172:175]
  v_mfma_f32_16x16x32_bf16 v[168:171], a[72:75], v[92:95], v[168:171]
  v_mfma_f32_16x16x32_bf16 v[180:183], a[76:79], v[88:91], v[180:183]
  v_mfma_f32_16x16x32_bf16 v[176:179], a[76:79], v[92:95], v[176:179]
  s_waitcnt vmcnt(16)
  v_swap_b32 v130, v132
  v_swap_b32 v131, v133
  v_swap_b32 v34, v36
  v_swap_b32 v35, v37
  v_swap_b32 v42, v44
  v_swap_b32 v43, v45
  s_nop 1
  v_mfma_f32_16x16x32_bf16 v[144:147], v[32:35], v[128:131], v[144:147]
  v_mfma_f32_16x16x32_bf16 v[148:151], v[32:35], v[132:135], v[148:151]
  v_mfma_f32_16x16x32_bf16 v[152:155], v[36:39], v[128:131], v[152:155]
  v_mfma_f32_16x16x32_bf16 v[156:159], v[36:39], v[132:135], v[156:159]
  v_mfma_f32_16x16x32_bf16 v[160:163], v[184:187], v[128:131], v[160:163]
  v_mfma_f32_16x16x32_bf16 v[164:167], v[184:187], v[132:135], v[164:167]
  v_mfma_f32_16x16x32_bf16 v[168:171], v[40:43], v[128:131], v[168:171]
  v_mfma_f32_16x16x32_bf16 v[172:175], v[40:43], v[132:135], v[172:175]
  v_mfma_f32_16x16x32_bf16 v[176:179], v[44:47], v[128:131], v[176:179]
  v_mfma_f32_16x16x32_bf16 v[180:183], v[44:47], v[132:135], v[180:183]
  s_waitcnt vmcnt(14)
  v_mfma_f32_16x16x32_bf16 v[148:151], a[80:83], v[96:99], v[148:151]
  v_mfma_f32_16x16x32_bf16 v[144:147], a[80:83], v[100:103], v[144:147]
  v_mfma_f32_16x16x32_bf16 v[156:159], a[84:87], v[96:99], v[156:159]
  v_mfma_f32_16x16x32_bf16 v[152:155], a[84:87], v[100:103], v[152:155]
  v_mfma_f32_16x16x32_bf16 v[164:167], a[88:91], v[96:99], v[164:167]
  v_mfma_f32_16x16x32_bf16 v[160:163], a[88:91], v[100:103], v[160:163]
  v_mfma_f32_16x16x32_bf16 v[172:175], a[92:95], v[96:99], v[172:175]
  v_mfma_f32_16x16x32_bf16 v[168:171], a[92:95], v[100:103], v[168:171]
  v_mfma_f32_16x16x32_bf16 v[180:183], a[96:99], v[96:99], v[180:183]
  v_mfma_f32_16x16x32_bf16 v[176:179], a[96:99], v[100:103], v[176:179]
  s_waitcnt vmcnt(11)
  v_mfma_f32_16x16x32_bf16 v[148:151], a[100:103], v[104:107], v[148:151]
  v_mfma_f32_16x16x32_bf16 v[144:147], a[100:103], v[108:111], v[144:147]
  v_mfma_f32_16x16x32_bf16 v[156:159], a[104:107], v[104:107], v[156:159]
  v_mfma_f32_16x16x32_bf16 v[152:155], a[104:107], v[108:111], v[152:155]
  v_mfma_f32_16x16x32_bf16 v[164:167], a[108:111], v[104:107], v[164:167]
  v_mfma_f32_16x16x32_bf16 v[160:163], a[108:111], v[108:111], v[160:163]
  v_mfma_f32_16x16x32_bf16 v[172:175], a[112:115], v[104:107], v[172:175]
  v_mfma_f32_16x16x32_bf16 v[168:171], a[112:115], v[108:111], v[168:171]
  v_mfma_f32_16x16x32_bf16 v[180:183], a[116:119], v[104:107], v[180:183]
  v_mfma_f32_16x16x32_bf16 v[176:179], a[116:119], v[108:111], v[176:179]
  s_waitcnt vmcnt(9)
  v_mfma_f32_16x16x32_bf16 v[148:151], a[120:123], v[112:115], v[148:151]
  v_mfma_f32_16x16x32_bf16 v[144:147], a[120:123], v[116:119], v[144:147]
  v_mfma_f32_16x16x32_bf16 v[156:159], a[124:127], v[112:115], v[156:159]
  v_mfma_f32_16x16x32_bf16 v[152:155], a[124:127], v[116:119], v[152:155]
  v_mfma_f32_16x16x32_bf16 v[164:167], a[128:131], v[112:115], v[164:167]
  v_mfma_f32_16x16x32_bf16 v[160:163], a[128:131], v[116:119], v[160:163]
  v_mfma_f32_16x16x32_bf16 v[172:175], a[132:135], v[112:115], v[172:175]
  v_mfma_f32_16x16x32_bf16 v[168:171], a[132:135], v[116:119], v[168:171]
  v_mfma_f32_16x16x32_bf16 v[180:183], a[136:139], v[112:115], v[180:183]
  v_mfma_f32_16x16x32_bf16 v[176:179], a[136:139], v[116:119], v[176:179]
  s_waitcnt vmcnt(6)
  v_mfma_f32_16x16x32_bf16 v[148:151], a[140:143], v[120:123], v[148:151]
  v_mfma_f32_16x16x32_bf16 v[144:147], a[140:143], v[124:127], v[144:147]
  v_mfma_f32_16x16x32_bf16 v[156:159], a[144:147], v[120:123], v[156:159]
  v_mfma_f32_16x16x32_bf16 v[152:155], a[144:147], v[124:127], v[152:155]
  v_mfma_f32_16x16x32_bf16 v[164:167], a[148:151], v[120:123], v[164:167]
  v_mfma_f32_16x16x32_bf16 v[160:163], a[148:151], v[124:127], v[160:163]
  v_mfma_f32_16x16x32_bf16 v[172:175], a[152:155], v[120:123], v[172:175]
  v_mfma_f32_16x16x32_bf16 v[168:171], a[152:155], v[124:127], v[168:171]
  v_mfma_f32_16x16x32_bf16 v[180:183], a[156:159], v[120:123], v[180:183]
  v_mfma_f32_16x16x32_bf16 v[176:179], a[156:159], v[124:127], v[176:179]
  s_waitcnt vmcnt(0)
  v_swap_b32 v138, v140
  v_swap_b32 v139, v141
  v_swap_b32 v50, v52
  v_swap_b32 v51, v53
  v_swap_b32 v58, v60
  v_swap_b32 v59, v61
  s_nop 1
  v_mfma_f32_16x16x32_bf16 v[144:147], v[48:51], v[136:139], v[144:147]
  v_mfma_f32_16x16x32_bf16 v[148:151], v[48:51], v[140:143], v[148:151]
  v_mfma_f32_16x16x32_bf16 v[152:155], v[52:55], v[136:139], v[152:155]
  v_mfma_f32_16x16x32_bf16 v[156:159], v[52:55], v[140:143], v[156:159]
  v_mfma_f32_16x16x32_bf16 v[160:163], v[188:191], v[136:139], v[160:163]
  v_mfma_f32_16x16x32_bf16 v[164:167], v[188:191], v[140:143], v[164:167]
  v_mfma_f32_16x16x32_bf16 v[168:171], v[56:59], v[136:139], v[168:171]
  v_mfma_f32_16x16x32_bf16 v[172:175], v[56:59], v[140:143], v[172:175]
  v_mfma_f32_16x16x32_bf16 v[176:179], v[60:63], v[136:139], v[176:179]
  v_mfma_f32_16x16x32_bf16 v[180:183], v[60:63], v[140:143], v[180:183]
  s_branch pve_265
pvt_269:
  s_sub_u32 s56, s40, 1
  s_lshl_b32 s21, s56, 10
  s_add_u32 s21, s21, 22528
  v_add_u32 v18, s21, v7
  v_add_u32 v19, s52, v17
  v_cndmask_b32 v18, v19, v18, s[66:67]
  s_add_u32 s21, s56, 1
  v_mov_b32 v19, s21
  v_cndmask_b32 v19, v19, 4, s[66:67]
  v_add_u32 v26, -1, v19
  v_cndmask_b32 v19, v26, v19, s[66:67]
  s_cmp_lg_u32 s20, 0
  s_cbranch_scc1 wr_273
  s_mov_b32 s101, 0
wr_272:
  buffer_load_dword v26, v18, s[72:75], 0 offen sc1
  s_add_u32 s101, s101, 1
  s_cmp_gt_u32 s101, 131072
  s_cbranch_scc1 main_end
  s_waitcnt vmcnt(0)
  v_cmp_gt_u32 vcc, v19, v26
  v_readfirstlane_b32 s100, v26
  s_nop 0
  s_cbranch_vccz wr_273
  s_sleep 4
  s_cmp_lg_u32 s100, 0
  s_cbranch_scc1 wr_272
  s_sleep 24
  s_branch wr_272
wr_273:
  s_barrier
  s_mov_b32 s56, s47
  s_mov_b32 s57, s48
  buffer_load_dwordx4 v[64:67], v4, s[16:19], s56 offen sc1
  buffer_load_dwordx2 v[68:69], v5, s[16:19], s56 offen offset:2048 sc1
  buffer_load_dwordx4 v[128:131], v21, s[16:19], s56 offen offset:1024 sc1
  s_add_u32 s56, s56, 2560
  buffer_load_dwordx4 v[72:75], v4, s[16:19], s56 offen sc1
  buffer_load_dwordx2 v[76:77], v5, s[16:19], s56 offen offset:2048 sc1
  s_add_u32 s56, s56, 2560
  buffer_load_dwordx4 v[80:83], v4, s[16:19], s56 offen sc1
  buffer_load_dwordx2 v[84:85], v5, s[16:19], s56 offen offset:2048 sc1
  buffer_load_dwordx4 v[132:135], v21, s[16:19], s56 offen offset:1024 sc1
  s_add_u32 s56, s56, 2560
  buffer_load_dwordx4 v[88:91], v4, s[16:19], s56 offen sc1
  buffer_load_dwordx2 v[92:93], v5, s[16:19], s56 offen offset:2048 sc1
  s_add_u32 s56, s56, 2560
  buffer_load_dwordx4 v[32:35], v22, s[16:19], s57 offen offset:0 sc1
  buffer_load_dwordx4 v[40:43], v22, s[16:19], s57 offen offset:640 sc1
  buffer_load_dwordx2 v[184:185], v14, s[16:19], s57 offen offset:512 sc1
  s_add_u32 s57, s57, 20480
  buffer_load_dwordx4 v[36:39], v22, s[16:19], s57 offen offset:0 sc1
  buffer_load_dwordx4 v[44:47], v22, s[16:19], s57 offen offset:640 sc1
  buffer_load_dwordx2 v[186:187], v14, s[16:19], s57 offen offset:512 sc1
  s_add_u32 s57, s57, 20480
  buffer_load_dwordx4 v[96:99], v4, s[16:19], s56 offen sc1
  buffer_load_dwordx2 v[100:101], v5, s[16:19], s56 offen offset:2048 sc1
  buffer_load_dwordx4 v[136:139], v21, s[16:19], s56 offen offset:1024 sc1
  s_add_u32 s56, s56, 2560
  buffer_load_dwordx4 v[104:107], v4, s[16:19], s56 offen sc1
  buffer_load_dwordx2 v[108:109], v5, s[16:19], s56 offen offset:2048 sc1
  s_add_u32 s56, s56, 2560
  buffer_load_dwordx4 v[112:115], v4, s[16:19], s56 offen sc1
  buffer_load_dwordx2 v[116:117], v5, s[16:19], s56 offen offset:2048 sc1
  buffer_load_dwordx4 v[140:143], v21, s[16:19], s56 offen offset:1024 sc1
  s_add_u32 s56, s56, 2560
  buffer_load_dwordx4 v[120:123], v4, s[16:19], s56 offen sc1
  buffer_load_dwordx2 v[124:125], v5, s[16:19], s56 offen offset:2048 sc1
  s_add_u32 s56, s56, 2560
  buffer_load_dwordx4 v[48:51], v22, s[16:19], s57 offen offset:0 sc1
  buffer_load_dwordx4 v[56:59], v22, s[16:19], s57 offen offset:640 sc1
  buffer_load_dwordx2 v[188:189], v14, s[16:19], s57 offen offset:512 sc1
  s_add_u32 s57, s57, 20480
  buffer_load_dwordx4 v[52:55], v22, s[16:19], s57 offen offset:0 sc1
  buffer_load_dwordx4 v[60:63], v22, s[16:19], s57 offen offset:640 sc1
  buffer_load_dwordx2 v[190:191], v14, s[16:19], s57 offen offset:512 sc1
  s_add_u32 s57, s57, 20480
  s_mov_b32 s101, 0
  s_waitcnt vmcnt(16)
  s_branch pvr_275
pvr_274:
  s_sleep 2
  s_add_u32 s56, s47, 0
  s_add_u32 s57, s48, 0
  buffer_load_dwordx4 v[64:67], v4, s[16:19], s56 offen sc1
  buffer_load_dwordx2 v[68:69], v5, s[16:19], s56 offen offset:2048 sc1
  buffer_load_dwordx4 v[128:131], v21, s[16:19], s56 offen offset:1024 sc1
  s_add_u32 s56, s56, 2560
  buffer_load_dwordx4 v[72:75], v4, s[16:19], s56 offen sc1
  buffer_load_dwordx2 v[76:77], v5, s[16:19], s56 offen offset:2048 sc1
  s_add_u32 s56, s56, 2560
  buffer_load_dwordx4 v[80:83], v4, s[16:19], s56 offen sc1
  buffer_load_dwordx2 v[84:85], v5, s[16:19], s56 offen offset:2048 sc1
  buffer_load_dwordx4 v[132:135], v21, s[16:19], s56 offen offset:1024 sc1
  s_add_u32 s56, s56, 2560
  buffer_load_dwordx4 v[88:91], v4, s[16:19], s56 offen sc1
  buffer_load_dwordx2 v[92:93], v5, s[16:19], s56 offen offset:2048 sc1
  s_add_u32 s56, s56, 2560
  buffer_load_dwordx4 v[32:35], v22, s[16:19], s57 offen offset:0 sc1
  buffer_load_dwordx4 v[40:43], v22, s[16:19], s57 offen offset:640 sc1
  buffer_load_dwordx2 v[184:185], v14, s[16:19], s57 offen offset:512 sc1
  s_add_u32 s57, s57, 20480
  buffer_load_dwordx4 v[36:39], v22, s[16:19], s57 offen offset:0 sc1
  buffer_load_dwordx4 v[44:47], v22, s[16:19], s57 offen offset:640 sc1
  buffer_load_dwordx2 v[186:187], v14, s[16:19], s57 offen offset:512 sc1
  s_add_u32 s57, s57, 20480
  s_add_u32 s101, s101, 1
  s_cmp_gt_u32 s101, 131072
  s_cbranch_scc1 main_end
  s_waitcnt vmcnt(0)
pvr_275:
  v_max3_u32 v26, v64, v68, v72
  v_max3_u32 v26, v26, v76, v80
  v_max3_u32 v26, v26, v84, v88
  v_max3_u32 v26, v26, v92, v128
  v_max3_u32 v26, v26, v132, v32
  v_max3_u32 v26, v26, v36, v40
  v_max3_u32 v26, v26, v44, v184
  v_max3_u32 v26, v26, v186, v186
  v_cmp_eq_u32 vcc, -1, v26
  s_nop 1
  s_cbranch_vccnz pvr_274
  v_mfma_f32_16x16x32_bf16 v[148:151], a[0:3], v[64:67], 0
  v_mfma_f32_16x16x32_bf16 v[144:147], a[0:3], v[68:71], 0
  v_mfma_f32_16x16x32_bf16 v[156:159], a[4:7], v[64:67], 0
  v_mfma_f32_16x16x32_bf16 v[152:155], a[4:7], v[68:71], 0
  v_mfma_f32_16x16x32_bf16 v[164:167], a[8:11], v[64:67], 0
  v_mfma_f32_16x16x32_bf16 v[160:163], a[8:11], v[68:71], 0
  v_mfma_f32_16x16x32_bf16 v[172:175], a[12:15], v[64:67], 0
  v_mfma_f32_16x16x32_bf16 v[168:171], a[12:15], v[68:71], 0
  v_mfma_f32_16x16x32_bf16 v[180:183], a[16:19], v[64:67], 0
  v_mfma_f32_16x16x32_bf16 v[176:179], a[16:19], v[68:71], 0
  v_mfma_f32_16x16x32_bf16 v[148:151], a[20:23], v[72:75], v[148:151]
  v_mfma_f32_16x16x32_bf16 v[144:147], a[20:23], v[76:79], v[144:147]
  v_mfma_f32_16x16x32_bf16 v[156:159], a[24:27], v[72:75], v[156:159]
  v_mfma_f32_16x16x32_bf16 v[152:155], a[24:27], v[76:79], v[152:155]
  v_mfma_f32_16x16x32_bf16 v[164:167], a[28:31], v[72:75], v[164:167]
  v_mfma_f32_16x16x32_bf16 v[160:163], a[28:31], v[76:79], v[160:163]
  v_mfma_f32_16x16x32_bf16 v[172:175], a[32:35], v[72:75], v[172:175]
  v_mfma_f32_16x16x32_bf16 v[168:171], a[32:35], v[76:79], v[168:171]
  v_mfma_f32_16x16x32_bf16 v[180:183], a[36:39], v[72:75], v[180:183]
  v_mfma_f32_16x16x32_bf16 v[176:179], a[36:39], v[76:79], v[176:179]
  v_mfma_f32_16x16x32_bf16 v[148:151], a[40:43], v[80:83], v[148:151]
  v_mfma_f32_16x16x32_bf16 v[144:147], a[40:43], v[84:87], v[144:147]
  v_mfma_f32_16x16x32_bf16 v[156:159], a[44:47], v[80:83], v[156:159]
  v_mfma_f32_16x16x32_bf16 v[152:155], a[44:47], v[84:87], v[152:155]
  v_mfma_f32_16x16x32_bf16 v[164:167], a[48:51], v[80:83], v[164:167]
  v_mfma_f32_16x16x32_bf16 v[160:163], a[48:51], v[84:87], v[160:163]
  v_mfma_f32_16x16x32_bf16 v[172:175], a[52:55], v[80:83], v[172:175]
  v_mfma_f32_16x16x32_bf16 v[168:171], a[52:55], v[84:87], v[168:171]
  v_mfma_f32_16x16x32_bf16 v[180:183], a[56:59], v[80:83], v[180:183]
  v_mfma_f32_16x16x32_bf16 v[176:179], a[56:59], v[84:87], v[176:179]
  v_mfma_f32_16x16x32_bf16 v[148:151], a[60:63], v[88:91], v[148:151]
  v_mfma_f32_16x16x32_bf16 v[144:147], a[60:63], v[92:95], v[144:147]
  v_mfma_f32_16x16x32_bf16 v[156:159], a[64:67], v[88:91], v[156:159]
  v_mfma_f32_16x16x32_bf16 v[152:155], a[64:67], v[92:95], v[152:155]
  v_mfma_f32_16x16x32_bf16 v[164:167], a[68:71], v[88:91], v[164:167]
  v_mfma_f32_16x16x32_bf16 v[160:163], a[68:71], v[92:95], v[160:163]
  v_mfma_f32_16x16x32_bf16 v[172:175], a[72:75], v[88:91], v[172:175]
  v_mfma_f32_16x16x32_bf16 v[168:171], a[72:75], v[92:95], v[168:171]
  v_mfma_f32_16x16x32_bf16 v[180:183], a[76:79], v[88:91], v[180:183]
  v_mfma_f32_16x16x32_bf16 v[176:179], a[76:79], v[92:95], v[176:179]
  v_swap_b32 v130, v132
  v_swap_b32 v131, v133
  v_swap_b32 v34, v36
  v_swap_b32 v35, v37
  v_swap_b32 v42, v44
  v_swap_b32 v43, v45
  s_nop 1
  v_mfma_f32_16x16x32_bf16 v[144:147], v[32:35], v[128:131], v[144:147]
  v_mfma_f32_16x16x32_bf16 v[148:151], v[32:35], v[132:135], v[148:151]
  v_mfma_f32_16x16x32_bf16 v[152:155], v[36:39], v[128:131], v[152:155]
  v_mfma_f32_16x16x32_bf16 v[156:159], v[36:39], v[132:135], v[156:159]
  v_mfma_f32_16x16x32_bf16 v[160:163], v[184:187], v[128:131], v[160:163]
  v_mfma_f32_16x16x32_bf16 v[164:167], v[184:187], v[132:135], v[164:167]
  v_mfma_f32_16x16x32_bf16 v[168:171], v[40:43], v[128:131], v[168:171]
  v_mfma_f32_16x16x32_bf16 v[172:175], v[40:43], v[132:135], v[172:175]
  v_mfma_f32_16x16x32_bf16 v[176:179], v[44:47], v[128:131], v[176:179]
  v_mfma_f32_16x16x32_bf16 v[180:183], v[44:47], v[132:135], v[180:183]
  s_mov_b32 s101, 0
  s_waitcnt vmcnt(0)
  s_branch pvr_277
pvr_276:
  s_sleep 2
  s_add_u32 s56, s47, 10240
  s_add_u32 s57, s48, 40960
  buffer_load_dwordx4 v[96:99], v4, s[16:19], s56 offen sc1
  buffer_load_dwordx2 v[100:101], v5, s[16:19], s56 offen offset:2048 sc1
  buffer_load_dwordx4 v[136:139], v21, s[16:19], s56 offen offset:1024 sc1
  s_add_u32 s56, s56, 2560
  buffer_load_dwordx4 v[104:107], v4, s[16:19], s56 offen sc1
  buffer_load_dwordx2 v[108:109], v5, s[16:19], s56 offen offset:2048 sc1
  s_add_u32 s56, s56, 2560
  buffer_load_dwordx4 v[112:115], v4, s[16:19], s56 offen sc1
  buffer_load_dwordx2 v[116:117], v5, s[16:19], s56 offen offset:2048 sc1
  buffer_load_dwordx4 v[140:143], v21, s[16:19], s56 offen offset:1024 sc1
  s_add_u32 s56, s56, 2560
  buffer_load_dwordx4 v[120:123], v4, s[16:19], s56 offen sc1
  buffer_load_dwordx2 v[124:125], v5, s[16:19], s56 offen offset:2048 sc1
  s_add_u32 s56, s56, 2560
  buffer_load_dwordx4 v[48:51], v22, s[16:19], s57 offen offset:0 sc1
  buffer_load_dwordx4 v[56:59], v22, s[16:19], s57 offen offset:640 sc1
  buffer_load_dwordx2 v[188:189], v14, s[16:19], s57 offen offset:512 sc1
  s_add_u32 s57, s57, 20480
  buffer_load_dwordx4 v[52:55], v22, s[16:19], s57 offen offset:0 sc1
  buffer_load_dwordx4 v[60:63], v22, s[16:19], s57 offen offset:640 sc1
  buffer_load_dwordx2 v[190:191], v14, s[16:19], s57 offen offset:512 sc1
  s_add_u32 s57, s57, 20480
  s_add_u32 s101, s101, 1
  s_cmp_gt_u32 s101, 131072
  s_cbranch_scc1 main_end
  s_waitcnt vmcnt(0)
pvr_277:
  v_max3_u32 v26, v96, v100, v104
  v_max3_u32 v26, v26, v108, v112
  v_max3_u32 v26, v26, v116, v120
  v_max3_u32 v26, v26, v124, v136
  v_max3_u32 v26, v26, v140, v48
  v_max3_u32 v26, v26, v52, v56
  v_max3_u32 v26, v26, v60, v188
  v_max3_u32 v26, v26, v190, v190
  v_cmp_eq_u32 vcc, -1, v26
  s_nop 1
  s_cbranch_vccnz pvr_276
  v_mfma_f32_16x16x32_bf16 v[148:151], a[80:83], v[96:99], v[148:151]
  v_mfma_f32_16x16x32_bf16 v[144:147], a[80:83], v[100:103], v[144:147]
  v_mfma_f32_16x16x32_bf16 v[156:159], a[84:87], v[96:99], v[156:159]
  v_mfma_f32_16x16x32_bf16 v[152:155], a[84:87], v[100:103], v[152:155]
  v_mfma_f32_16x16x32_bf16 v[164:167], a[88:91], v[96:99], v[164:167]
  v_mfma_f32_16x16x32_bf16 v[160:163], a[88:91], v[100:103], v[160:163]
  v_mfma_f32_16x16x32_bf16 v[172:175], a[92:95], v[96:99], v[172:175]
  v_mfma_f32_16x16x32_bf16 v[168:171], a[92:95], v[100:103], v[168:171]
  v_mfma_f32_16x16x32_bf16 v[180:183], a[96:99], v[96:99], v[180:183]
  v_mfma_f32_16x16x32_bf16 v[176:179], a[96:99], v[100:103], v[176:179]
  v_mfma_f32_16x16x32_bf16 v[148:151], a[100:103], v[104:107], v[148:151]
  v_mfma_f32_16x16x32_bf16 v[144:147], a[100:103], v[108:111], v[144:147]
  v_mfma_f32_16x16x32_bf16 v[156:159], a[104:107], v[104:107], v[156:159]
  v_mfma_f32_16x16x32_bf16 v[152:155], a[104:107], v[108:111], v[152:155]
  v_mfma_f32_16x16x32_bf16 v[164:167], a[108:111], v[104:107], v[164:167]
  v_mfma_f32_16x16x32_bf16 v[160:163], a[108:111], v[108:111], v[160:163]
  v_mfma_f32_16x16x32_bf16 v[172:175], a[112:115], v[104:107], v[172:175]
  v_mfma_f32_16x16x32_bf16 v[168:171], a[112:115], v[108:111], v[168:171]
  v_mfma_f32_16x16x32_bf16 v[180:183], a[116:119], v[104:107], v[180:183]
  v_mfma_f32_16x16x32_bf16 v[176:179], a[116:119], v[108:111], v[176:179]
  v_mfma_f32_16x16x32_bf16 v[148:151], a[120:123], v[112:115], v[148:151]
  v_mfma_f32_16x16x32_bf16 v[144:147], a[120:123], v[116:119], v[144:147]
  v_mfma_f32_16x16x32_bf16 v[156:159], a[124:127], v[112:115], v[156:159]
  v_mfma_f32_16x16x32_bf16 v[152:155], a[124:127], v[116:119], v[152:155]
  v_mfma_f32_16x16x32_bf16 v[164:167], a[128:131], v[112:115], v[164:167]
  v_mfma_f32_16x16x32_bf16 v[160:163], a[128:131], v[116:119], v[160:163]
  v_mfma_f32_16x16x32_bf16 v[172:175], a[132:135], v[112:115], v[172:175]
  v_mfma_f32_16x16x32_bf16 v[168:171], a[132:135], v[116:119], v[168:171]
  v_mfma_f32_16x16x32_bf16 v[180:183], a[136:139], v[112:115], v[180:183]
  v_mfma_f32_16x16x32_bf16 v[176:179], a[136:139], v[116:119], v[176:179]
  v_mfma_f32_16x16x32_bf16 v[148:151], a[140:143], v[120:123], v[148:151]
  v_mfma_f32_16x16x32_bf16 v[144:147], a[140:143], v[124:127], v[144:147]
  v_mfma_f32_16x16x32_bf16 v[156:159], a[144:147], v[120:123], v[156:159]
  v_mfma_f32_16x16x32_bf16 v[152:155], a[144:147], v[124:127], v[152:155]
  v_mfma_f32_16x16x32_bf16 v[164:167], a[148:151], v[120:123], v[164:167]
  v_mfma_f32_16x16x32_bf16 v[160:163], a[148:151], v[124:127], v[160:163]
  v_mfma_f32_16x16x32_bf16 v[172:175], a[152:155], v[120:123], v[172:175]
  v_mfma_f32_16x16x32_bf16 v[168:171], a[152:155], v[124:127], v[168:171]
  v_mfma_f32_16x16x32_bf16 v[180:183], a[156:159], v[120:123], v[180:183]
  v_mfma_f32_16x16x32_bf16 v[176:179], a[156:159], v[124:127], v[176:179]
  v_swap_b32 v138, v140
  v_swap_b32 v139, v141
  v_swap_b32 v50, v52
  v_swap_b32 v51, v53
  v_swap_b32 v58, v60
  v_swap_b32 v59, v61
  s_nop 1
  v_mfma_f32_16x16x32_bf16 v[144:147], v[48:51], v[136:139], v[144:147]
  v_mfma_f32_16x16x32_bf16 v[148:151], v[48:51], v[140:143], v[148:151]
  v_mfma_f32_16x16x32_bf16 v[152:155], v[52:55], v[136:139], v[152:155]
  v_mfma_f32_16x16x32_bf16 v[156:159], v[52:55], v[140:143], v[156:159]
  v_mfma_f32_16x16x32_bf16 v[160:163], v[188:191], v[136:139], v[160:163]
  v_mfma_f32_16x16x32_bf16 v[164:167], v[188:191], v[140:143], v[164:167]
  v_mfma_f32_16x16x32_bf16 v[168:171], v[56:59], v[136:139], v[168:171]
  v_mfma_f32_16x16x32_bf16 v[172:175], v[56:59], v[140:143], v[172:175]
  v_mfma_f32_16x16x32_bf16 v[176:179], v[60:63], v[136:139], v[176:179]
  v_mfma_f32_16x16x32_bf16 v[180:183], v[60:63], v[140:143], v[180:183]
pve_265:
  s_nop 0
  ds_write_b128 v10, v[144:147] offset:0
  ds_write_b128 v10, v[148:151] offset:1024
  ds_write_b128 v10, v[152:155] offset:2048
  ds_write_b128 v10, v[156:159] offset:3072
  ds_write_b128 v10, v[160:163] offset:4096
  ds_write_b128 v10, v[164:167] offset:5120
  ds_write_b128 v10, v[168:171] offset:6144
  ds_write_b128 v10, v[172:175] offset:7168
  s_nop 1
  ds_write_b128 v10, v[176:179] offset:8192
  ds_write_b128 v10, v[180:183] offset:9216
  s_cmp_lg_u32 s20, 0
  s_cbranch_scc1 pvq_278
  s_mov_b64 exec, 1
  ds_write_b32 v30, v29
  s_mov_b64 exec, -1
pvq_278:
  s_waitcnt lgkmcnt(0)
  s_barrier
  ds_read_b32 v23, v30
  ds_read_b128 v[192:195], v11 offset:0
  ds_read_b128 v[196:199], v11 offset:10240
  ds_read_b128 v[200:203], v11 offset:20480
  ds_read_b128 v[204:207], v11 offset:30720
  ds_read_b128 v[208:211], v11 offset:2048
  ds_read_b128 v[212:215], v11 offset:12288
  ds_read_b128 v[216:219], v11 offset:22528
  ds_read_b128 v[220:223], v11 offset:32768
  ds_read_b128 v[224:227], v12 offset:0
  ds_read_b128 v[228:231], v12 offset:10240
  ds_read_b128 v[232:235], v12 offset:20480
  ds_read_b128 v[236:239], v12 offset:30720
  s_waitcnt lgkmcnt(8)
  v_pk_add_f32 v[192:193], v[192:193], v[196:197]
  v_pk_add_f32 v[200:201], v[200:201], v[204:205]
  v_pk_add_f32 v[194:195], v[194:195], v[198:199]
  v_pk_add_f32 v[202:203], v[202:203], v[206:207]
  v_pk_add_f32 v[192:193], v[192:193], v[200:201]
  v_pk_add_f32 v[194:195], v[194:195], v[202:203]
  v_cvt_pk_bf16_f32 v26, v192, v193
  v_lshlrev_b32 v192, 16, v26
  v_and_b32 v193, 0xffff0000, v26
  v_mul_f32 v192, v192, v24
  v_mul_f32 v193, v193, v24
  v_cvt_pk_bf16_f32 v26, v192, v193
  v_lshlrev_b32 v192, 16, v26
  v_and_b32 v193, 0xffff0000, v26
  v_add_f32 v192, v192, v240
  v_add_f32 v193, v193, v241
  v_cvt_pk_bf16_f32 v196, v192, v193
  v_cvt_pk_bf16_f32 v26, v194, v195
  v_lshlrev_b32 v194, 16, v26
  v_and_b32 v195, 0xffff0000, v26
  v_mul_f32 v194, v194, v24
  v_mul_f32 v195, v195, v24
  v_cvt_pk_bf16_f32 v26, v194, v195
  v_lshlrev_b32 v194, 16, v26
  v_and_b32 v195, 0xffff0000, v26
  v_add_f32 v194, v194, v242
  v_add_f32 v195, v195, v243
  v_cvt_pk_bf16_f32 v197, v194, v195
  s_waitcnt lgkmcnt(4)
  v_pk_add_f32 v[208:209], v[208:209], v[212:213]
  v_pk_add_f32 v[216:217], v[216:217], v[220:221]
  v_pk_add_f32 v[210:211], v[210:211], v[214:215]
  v_pk_add_f32 v[218:219], v[218:219], v[222:223]
  v_pk_add_f32 v[208:209], v[208:209], v[216:217]
  v_pk_add_f32 v[210:211], v[210:211], v[218:219]
  v_cvt_pk_bf16_f32 v26, v208, v209
  v_lshlrev_b32 v208, 16, v26
  v_and_b32 v209, 0xffff0000, v26
  v_mul_f32 v208, v208, v24
  v_mul_f32 v209, v209, v24
  v_cvt_pk_bf16_f32 v26, v208, v209
  v_lshlrev_b32 v208, 16, v26
  v_and_b32 v209, 0xffff0000, v26
  v_add_f32 v208, v208, v244
  v_add_f32 v209, v209, v245
  v_cvt_pk_bf16_f32 v198, v208, v209
  v_cvt_pk_bf16_f32 v26, v210, v211
  v_lshlrev_b32 v210, 16, v26
  v_and_b32 v211, 0xffff0000, v26
  v_mul_f32 v210, v210, v24
  v_mul_f32 v211, v211, v24
  v_cvt_pk_bf16_f32 v26, v210, v211
  v_lshlrev_b32 v210, 16, v26
  v_and_b32 v211, 0xffff0000, v26
  v_add_f32 v210, v210, v246
  v_add_f32 v211, v211, v247
  v_cvt_pk_bf16_f32 v199, v210, v211
  buffer_store_dwordx4 v[196:199], v9, s[8:11], s46 offen
  s_cmp_ge_u32 s20, 2
  s_cbranch_scc1 pvm_279
  s_waitcnt lgkmcnt(0)
  v_pk_add_f32 v[224:225], v[224:225], v[228:229]
  v_pk_add_f32 v[232:233], v[232:233], v[236:237]
  v_pk_add_f32 v[226:227], v[226:227], v[230:231]
  v_pk_add_f32 v[234:235], v[234:235], v[238:239]
  v_pk_add_f32 v[224:225], v[224:225], v[232:233]
  v_pk_add_f32 v[226:227], v[226:227], v[234:235]
  v_cvt_pk_bf16_f32 v26, v224, v225
  v_lshlrev_b32 v224, 16, v26
  v_and_b32 v225, 0xffff0000, v26
  v_mul_f32 v224, v224, v24
  v_mul_f32 v225, v225, v24
  v_cvt_pk_bf16_f32 v26, v224, v225
  v_lshlrev_b32 v224, 16, v26
  v_and_b32 v225, 0xffff0000, v26
  v_add_f32 v224, v224, v248
  v_add_f32 v225, v225, v249
  v_cvt_pk_bf16_f32 v228, v224, v225
  v_cvt_pk_bf16_f32 v26, v226, v227
  v_lshlrev_b32 v226, 16, v26
  v_and_b32 v227, 0xffff0000, v26
  v_mul_f32 v226, v226, v24
  v_mul_f32 v227, v227, v24
  v_cvt_pk_bf16_f32 v26, v226, v227
  v_lshlrev_b32 v226, 16, v26
  v_and_b32 v227, 0xffff0000, v26
  v_add_f32 v226, v226, v250
  v_add_f32 v227, v227, v251
  v_cvt_pk_bf16_f32 v229, v226, v227
  buffer_store_dwordx2 v[228:229], v13, s[8:11], s49 offen offset:64
pvm_279:
  s_waitcnt lgkmcnt(0)
  v_readfirstlane_b32 s2, v23
  s_barrier
  s_add_u32 s21, s2, 0
  s_cmp_lt_u32 s2, 10
  s_cbranch_scc1 do_qbl
  s_sub_u32 s2, s2, 10
  s_add_u32 s21, s2, 0
  s_cmp_lt_u32 s2, 54
  s_cbranch_scc1 do_bat
  s_sub_u32 s2, s2, 54
  s_add_u32 s21, s2, 0
  s_cmp_lt_u32 s2, 56
  s_cbranch_scc1 do_opb
  s_sub_u32 s2, s2, 56
  s_add_u32 s21, s2, 54
  s_cmp_lt_u32 s2, 10
  s_cbranch_scc1 do_bat
  s_sub_u32 s2, s2, 10
  s_add_u32 s21, s2, 0
  s_cmp_lt_u32 s2, 48
  s_cbranch_scc1 pv_loop
  s_sub_u32 s2, s2, 48
  s_add_u32 s21, s2, 56
  s_cmp_lt_u32 s2, 8
  s_cbranch_scc1 do_opb
  s_sub_u32 s2, s2, 8
  s_add_u32 s21, s2, 48
  s_cmp_lt_u32 s2, 464
  s_cbranch_scc1 pv_loop
  s_sub_u32 s2, s2, 464
  s_branch main_fin
do_bat:
  s_mov_b32 s2, s21
  s_load_dwordx2 s[4:5], s[0:1], 0
  s_load_dwordx2 s[6:7], s[0:1], 80
  s_load_dwordx2 s[38:39], s[0:1], 104
  s_waitcnt lgkmcnt(0)
  s_mov_b32 s8, s4
  s_mov_b32 s9, s5
  s_mov_b32 s10, 2621440
  s_mov_b32 s11, 0x00020000
  s_mov_b32 s12, s6
  s_mov_b32 s13, s7
  s_mov_b32 s14, 1280
  s_mov_b32 s15, 0x00020000
  s_add_u32 s16, s38, 62914560
  s_addc_u32 s17, s39, 0
  s_mov_b32 s18, 7864320
  s_mov_b32 s19, 0x00020000
  s_add_u32 s24, s38, 70778880
  s_addc_u32 s25, s39, 0
  s_mov_b32 s26, 2621440
  s_mov_b32 s27, 0x00020000
  s_add_u32 s28, s38, 81002496
  s_addc_u32 s29, s39, 0
  s_mov_b32 s30, 8192
  s_mov_b32 s31, 0x00020000
  s_add_u32 s72, s38, 81068032
  s_addc_u32 s73, s39, 0
  s_mov_b32 s74, 115712
  s_mov_b32 s75, 0x00020000
  v_mov_b32 v7, 52429
  v_add_u32 v5, 0, v1
  v_mul_u32_u24 v6, v5, v7
  v_lshrrev_b32 v18, 23, v6
  v_mul_u32_u24 v19, 1280, v18
  v_lshl_add_u32 v8, v5, 4, v19
  v_add_u32 v8, 1280, v8
  v_lshrrev_b32 v18, 22, v6
  v_mul_u32_u24 v19, 2560, v18
  v_lshl_add_u32 v13, v5, 4, v19
  v_add_u32 v5, 64, v1
  v_mul_u32_u24 v6, v5, v7
  v_lshrrev_b32 v18, 23, v6
  v_mul_u32_u24 v19, 1280, v18
  v_lshl_add_u32 v9, v5, 4, v19
  v_add_u32 v9, 1280, v9
  v_lshrrev_b32 v18, 22, v6
  v_mul_u32_u24 v19, 2560, v18
  v_lshl_add_u32 v14, v5, 4, v19
  v_add_u32 v5, 128, v1
  v_mul_u32_u24 v6, v5, v7
  v_lshrrev_b32 v18, 23, v6
  v_mul_u32_u24 v19, 1280, v18
  v_lshl_add_u32 v10, v5, 4, v19
  v_add_u32 v10, 1280, v10
  v_lshrrev_b32 v18, 22, v6
  v_mul_u32_u24 v19, 2560, v18
  v_lshl_add_u32 v15, v5, 4, v19
  v_add_u32 v5, 192, v1
  v_mul_u32_u24 v6, v5, v7
  v_lshrrev_b32 v18, 23, v6
  v_mul_u32_u24 v19, 1280, v18
  v_lshl_add_u32 v11, v5, 4, v19
  v_add_u32 v11, 1280, v11
  v_lshrrev_b32 v18, 22, v6
  v_mul_u32_u24 v19, 2560, v18
  v_lshl_add_u32 v16, v5, 4, v19
  v_add_u32 v5, 256, v1
  v_mul_u32_u24 v6, v5, v7
  v_lshrrev_b32 v18, 23, v6
  v_mul_u32_u24 v19, 1280, v18
  v_lshl_add_u32 v12, v5, 4, v19
  v_add_u32 v12, 1280, v12
  v_lshrrev_b32 v18, 22, v6
  v_mul_u32_u24 v19, 2560, v18
  v_lshl_add_u32 v17, v5, 4, v19
  s_lshr_b32 s21, s2, 2
  s_lshl_b32 s21, s21, 7
  s_add_u32 s21, s21, 88064
  s_cmp_lg_u32 s20, 0
  s_cbranch_scc1 wf_281
  v_mov_b32 v18, 0
  s_mov_b32 s101, 0
wf_280:
  buffer_load_dword v19, v18, s[72:75], s21 offen sc1
  s_add_u32 s101, s101, 1
  s_cmp_gt_u32 s101, 131072
  s_cbranch_scc1 main_end
  s_waitcnt vmcnt(0)
  v_readfirstlane_b32 s100, v19
  s_cmp_ge_u32 s100, 10
  s_cbranch_scc1 wf_281
  s_sleep 16
  s_branch wf_280
wf_281:
  s_barrier
  s_max_u32 s21, s2, 1
  s_sub_u32 s21, s21, 1
  s_lshr_b32 s21, s21, 2
  s_lshl_b32 s21, s21, 7
  s_add_u32 s21, s21, 88064
  s_cmp_lg_u32 s20, 0
  s_cbranch_scc1 wf_283
  v_mov_b32 v18, 0
  s_mov_b32 s101, 0
wf_282:
  buffer_load_dword v19, v18, s[72:75], s21 offen sc1
  s_add_u32 s101, s101, 1
  s_cmp_gt_u32 s101, 131072
  s_cbranch_scc1 main_end
  s_waitcnt vmcnt(0)
  v_readfirstlane_b32 s100, v19
  s_cmp_ge_u32 s100, 10
  s_cbranch_scc1 wf_283
  s_sleep 16
  s_branch wf_282
wf_283:
  s_barrier
  s_lshl_b32 s58, s2, 5
  s_add_u32 s22, s20, 0
  s_cmp_ge_u32 s22, 23
  s_cbranch_scc1 bd_284
  s_lshl_b32 s23, s22, 1
  s_add_u32 s23, s23, s58
  s_sub_i32 s23, s23, 14
  s_max_i32 s23, s23, 0
  s_mul_i32 s23, s23, 3840
  s_mul_i32 s22, s22, 5120
  s_add_u32 m0, s22, 0
  s_nop 0
  buffer_load_dwordx4 v8, s[16:19], s23 offen sc1 lds
  s_add_u32 m0, s22, 1024
  s_nop 0
  buffer_load_dwordx4 v9, s[16:19], s23 offen sc1 lds
  s_add_u32 m0, s22, 2048
  s_nop 0
  buffer_load_dwordx4 v10, s[16:19], s23 offen sc1 lds
  s_add_u32 m0, s22, 3072
  s_nop 0
  buffer_load_dwordx4 v11, s[16:19], s23 offen sc1 lds
  s_add_u32 m0, s22, 4096
  s_nop 0
  buffer_load_dwordx4 v12, s[16:19], s23 offen sc1 lds
bd_284:
  s_add_u32 s22, s20, 4
  s_cmp_ge_u32 s22, 23
  s_cbranch_scc1 bd_285
  s_lshl_b32 s23, s22, 1
  s_add_u32 s23, s23, s58
  s_sub_i32 s23, s23, 14
  s_max_i32 s23, s23, 0
  s_mul_i32 s23, s23, 3840
  s_mul_i32 s22, s22, 5120
  s_add_u32 m0, s22, 0
  s_nop 0
  buffer_load_dwordx4 v8, s[16:19], s23 offen sc1 lds
  s_add_u32 m0, s22, 1024
  s_nop 0
  buffer_load_dwordx4 v9, s[16:19], s23 offen sc1 lds
  s_add_u32 m0, s22, 2048
  s_nop 0
  buffer_load_dwordx4 v10, s[16:19], s23 offen sc1 lds
  s_add_u32 m0, s22, 3072
  s_nop 0
  buffer_load_dwordx4 v11, s[16:19], s23 offen sc1 lds
  s_add_u32 m0, s22, 4096
  s_nop 0
  buffer_load_dwordx4 v12, s[16:19], s23 offen sc1 lds
bd_285:
  s_add_u32 s22, s20, 8
  s_cmp_ge_u32 s22, 23
  s_cbranch_scc1 bd_286
  s_lshl_b32 s23, s22, 1
  s_add_u32 s23, s23, s58
  s_sub_i32 s23, s23, 14
  s_max_i32 s23, s23, 0
  s_mul_i32 s23, s23, 3840
  s_mul_i32 s22, s22, 5120
  s_add_u32 m0, s22, 0
  s_nop 0
  buffer_load_dwordx4 v8, s[16:19], s23 offen sc1 lds
  s_add_u32 m0, s22, 1024
  s_nop 0
  buffer_load_dwordx4 v9, s[16:19], s23 offen sc1 lds
  s_add_u32 m0, s22, 2048
  s_nop 0
  buffer_load_dwordx4 v10, s[16:19], s23 offen sc1 lds
  s_add_u32 m0, s22, 3072
  s_nop 0
  buffer_load_dwordx4 v11, s[16:19], s23 offen sc1 lds
  s_add_u32 m0, s22, 4096
  s_nop 0
  buffer_load_dwordx4 v12, s[16:19], s23 offen sc1 lds
bd_286:
  s_add_u32 s22, s20, 12
  s_cmp_ge_u32 s22, 23
  s_cbranch_scc1 bd_287
  s_lshl_b32 s23, s22, 1
  s_add_u32 s23, s23, s58
  s_sub_i32 s23, s23, 14
  s_max_i32 s23, s23, 0
  s_mul_i32 s23, s23, 3840
  s_mul_i32 s22, s22, 5120
  s_add_u32 m0, s22, 0
  s_nop 0
  buffer_load_dwordx4 v8, s[16:19], s23 offen sc1 lds
  s_add_u32 m0, s22, 1024
  s_nop 0
  buffer_load_dwordx4 v9, s[16:19], s23 offen sc1 lds
  s_add_u32 m0, s22, 2048
  s_nop 0
  buffer_load_dwordx4 v10, s[16:19], s23 offen sc1 lds
  s_add_u32 m0, s22, 3072
  s_nop 0
  buffer_load_dwordx4 v11, s[16:19], s23 offen sc1 lds
  s_add_u32 m0, s22, 4096
  s_nop 0
  buffer_load_dwordx4 v12, s[16:19], s23 offen sc1 lds
bd_287:
  s_add_u32 s22, s20, 16
  s_cmp_ge_u32 s22, 23
  s_cbranch_scc1 bd_288
  s_lshl_b32 s23, s22, 1
  s_add_u32 s23, s23, s58
  s_sub_i32 s23, s23, 14
  s_max_i32 s23, s23, 0
  s_mul_i32 s23, s23, 3840
  s_mul_i32 s22, s22, 5120
  s_add_u32 m0, s22, 0
  s_nop 0
  buffer_load_dwordx4 v8, s[16:19], s23 offen sc1 lds
  s_add_u32 m0, s22, 1024
  s_nop 0
  buffer_load_dwordx4 v9, s[16:19], s23 offen sc1 lds
  s_add_u32 m0, s22, 2048
  s_nop 0
  buffer_load_dwordx4 v10, s[16:19], s23 offen sc1 lds
  s_add_u32 m0, s22, 3072
  s_nop 0
  buffer_load_dwordx4 v11, s[16:19], s23 offen sc1 lds
  s_add_u32 m0, s22, 4096
  s_nop 0
  buffer_load_dwordx4 v12, s[16:19], s23 offen sc1 lds
bd_288:
  s_add_u32 s22, s20, 20
  s_cmp_ge_u32 s22, 23
  s_cbranch_scc1 bd_289
  s_lshl_b32 s23, s22, 1
  s_add_u32 s23, s23, s58
  s_sub_i32 s23, s23, 14
  s_max_i32 s23, s23, 0
  s_mul_i32 s23, s23, 3840
  s_mul_i32 s22, s22, 5120
  s_add_u32 m0, s22, 0
  s_nop 0
  buffer_load_dwordx4 v8, s[16:19], s23 offen sc1 lds
  s_add_u32 m0, s22, 1024
  s_nop 0
  buffer_load_dwordx4 v9, s[16:19], s23 offen sc1 lds
  s_add_u32 m0, s22, 2048
  s_nop 0
  buffer_load_dwordx4 v10, s[16:19], s23 offen sc1 lds
  s_add_u32 m0, s22, 3072
  s_nop 0
  buffer_load_dwordx4 v11, s[16:19], s23 offen sc1 lds
  s_add_u32 m0, s22, 4096
  s_nop 0
  buffer_load_dwordx4 v12, s[16:19], s23 offen sc1 lds
bd_289:
  s_add_u32 s22, s20, 0
  s_lshl_b32 s23, s22, 2
  s_add_u32 s23, s23, s58
  s_mul_i32 s23, s23, 3840
  s_mul_i32 s22, s22, 5120
  s_add_u32 s22, s22, 117760
  s_add_u32 m0, s22, 0
  s_nop 0
  buffer_load_dwordx4 v13, s[16:19], s23 offen sc1 lds
  s_add_u32 m0, s22, 1024
  s_nop 0
  buffer_load_dwordx4 v14, s[16:19], s23 offen sc1 lds
  s_add_u32 m0, s22, 2048
  s_nop 0
  buffer_load_dwordx4 v15, s[16:19], s23 offen sc1 lds
  s_add_u32 m0, s22, 3072
  s_nop 0
  buffer_load_dwordx4 v16, s[16:19], s23 offen sc1 lds
  s_add_u32 m0, s22, 4096
  s_nop 0
  buffer_load_dwordx4 v17, s[16:19], s23 offen sc1 lds
  s_add_u32 s22, s20, 4
  s_lshl_b32 s23, s22, 2
  s_add_u32 s23, s23, s58
  s_mul_i32 s23, s23, 3840
  s_mul_i32 s22, s22, 5120
  s_add_u32 s22, s22, 117760
  s_add_u32 m0, s22, 0
  s_nop 0
  buffer_load_dwordx4 v13, s[16:19], s23 offen sc1 lds
  s_add_u32 m0, s22, 1024
  s_nop 0
  buffer_load_dwordx4 v14, s[16:19], s23 offen sc1 lds
  s_add_u32 m0, s22, 2048
  s_nop 0
  buffer_load_dwordx4 v15, s[16:19], s23 offen sc1 lds
  s_add_u32 m0, s22, 3072
  s_nop 0
  buffer_load_dwordx4 v16, s[16:19], s23 offen sc1 lds
  s_add_u32 m0, s22, 4096
  s_nop 0
  buffer_load_dwordx4 v17, s[16:19], s23 offen sc1 lds
  s_lshl_b32 s21, s20, 3
  s_add_u32 s59, s58, s21
  v_lshlrev_b32 v4, 2, v1
  buffer_load_dword v16, v4, s[12:15], 0 offen offset:0
  buffer_load_dword v17, v4, s[12:15], 0 offen offset:256
  buffer_load_dword v18, v4, s[12:15], 0 offen offset:512
  buffer_load_dword v19, v4, s[12:15], 0 offen offset:768
  buffer_load_dword v20, v4, s[12:15], 0 offen offset:1024
  s_mul_i32 s22, s59, 1280
  buffer_load_dword v32, v4, s[8:11], s22 offen offset:0
  buffer_load_dword v33, v4, s[8:11], s22 offen offset:256
  buffer_load_dword v34, v4, s[8:11], s22 offen offset:512
  buffer_load_dword v35, v4, s[8:11], s22 offen offset:768
  buffer_load_dword v36, v4, s[8:11], s22 offen offset:1024
  s_add_u32 s22, s22, 1280
  buffer_load_dword v37, v4, s[8:11], s22 offen offset:0
  buffer_load_dword v38, v4, s[8:11], s22 offen offset:256
  buffer_load_dword v39, v4, s[8:11], s22 offen offset:512
  buffer_load_dword v40, v4, s[8:11], s22 offen offset:768
  buffer_load_dword v41, v4, s[8:11], s22 offen offset:1024
  s_add_u32 s22, s22, 1280
  buffer_load_dword v42, v4, s[8:11], s22 offen offset:0
  buffer_load_dword v43, v4, s[8:11], s22 offen offset:256
  buffer_load_dword v44, v4, s[8:11], s22 offen offset:512
  buffer_load_dword v45, v4, s[8:11], s22 offen offset:768
  buffer_load_dword v46, v4, s[8:11], s22 offen offset:1024
  s_add_u32 s22, s22, 1280
  buffer_load_dword v47, v4, s[8:11], s22 offen offset:0
  buffer_load_dword v48, v4, s[8:11], s22 offen offset:256
  buffer_load_dword v49, v4, s[8:11], s22 offen offset:512
  buffer_load_dword v50, v4, s[8:11], s22 offen offset:768
  buffer_load_dword v51, v4, s[8:11], s22 offen offset:1024
  s_add_u32 s22, s22, 1280
  buffer_load_dword v52, v4, s[8:11], s22 offen offset:0
  buffer_load_dword v53, v4, s[8:11], s22 offen offset:256
  buffer_load_dword v54, v4, s[8:11], s22 offen offset:512
  buffer_load_dword v55, v4, s[8:11], s22 offen offset:768
  buffer_load_dword v56, v4, s[8:11], s22 offen offset:1024
  s_add_u32 s22, s22, 1280
  buffer_load_dword v57, v4, s[8:11], s22 offen offset:0
  buffer_load_dword v58, v4, s[8:11], s22 offen offset:256
  buffer_load_dword v59, v4, s[8:11], s22 offen offset:512
  buffer_load_dword v60, v4, s[8:11], s22 offen offset:768
  buffer_load_dword v61, v4, s[8:11], s22 offen offset:1024
  s_add_u32 s22, s22, 1280
  buffer_load_dword v62, v4, s[8:11], s22 offen offset:0
  buffer_load_dword v63, v4, s[8:11], s22 offen offset:256
  buffer_load_dword v64, v4, s[8:11], s22 offen offset:512
  buffer_load_dword v65, v4, s[8:11], s22 offen offset:768
  buffer_load_dword v66, v4, s[8:11], s22 offen offset:1024
  s_add_u32 s22, s22, 1280
  buffer_load_dword v67, v4, s[8:11], s22 offen offset:0
  buffer_load_dword v68, v4, s[8:11], s22 offen offset:256
  buffer_load_dword v69, v4, s[8:11], s22 offen offset:512
  buffer_load_dword v70, v4, s[8:11], s22 offen offset:768
  buffer_load_dword v71, v4, s[8:11], s22 offen offset:1024
  s_add_u32 s22, s22, 1280
  s_waitcnt vmcnt(40)
  v_lshlrev_b32 v8, 16, v16
  v_and_b32 v16, 0xffff0000, v16
  v_lshlrev_b32 v9, 16, v17
  v_and_b32 v17, 0xffff0000, v17
  v_lshlrev_b32 v10, 16, v18
  v_and_b32 v18, 0xffff0000, v18
  v_lshlrev_b32 v11, 16, v19
  v_and_b32 v19, 0xffff0000, v19
  v_lshlrev_b32 v12, 16, v20
  v_and_b32 v20, 0xffff0000, v20
  s_waitcnt vmcnt(35)
  v_mov_b32 v80, 0
  v_lshlrev_b32 v25, 16, v32
  v_and_b32 v26, 0xffff0000, v32
  v_mul_f32 v25, v25, v8
  v_mul_f32 v26, v26, v16
  v_cvt_pk_bf16_f32 v25, v25, v26
  v_lshlrev_b32 v26, 16, v25
  v_and_b32 v25, 0xffff0000, v25
  v_add_f32 v80, v80, v26
  v_add_f32 v80, v80, v25
  v_lshlrev_b32 v25, 16, v33
  v_and_b32 v26, 0xffff0000, v33
  v_mul_f32 v25, v25, v9
  v_mul_f32 v26, v26, v17
  v_cvt_pk_bf16_f32 v25, v25, v26
  v_lshlrev_b32 v26, 16, v25
  v_and_b32 v25, 0xffff0000, v25
  v_add_f32 v80, v80, v26
  v_add_f32 v80, v80, v25
  v_lshlrev_b32 v25, 16, v34
  v_and_b32 v26, 0xffff0000, v34
  v_mul_f32 v25, v25, v10
  v_mul_f32 v26, v26, v18
  v_cvt_pk_bf16_f32 v25, v25, v26
  v_lshlrev_b32 v26, 16, v25
  v_and_b32 v25, 0xffff0000, v25
  v_add_f32 v80, v80, v26
  v_add_f32 v80, v80, v25
  v_lshlrev_b32 v25, 16, v35
  v_and_b32 v26, 0xffff0000, v35
  v_mul_f32 v25, v25, v11
  v_mul_f32 v26, v26, v19
  v_cvt_pk_bf16_f32 v25, v25, v26
  v_lshlrev_b32 v26, 16, v25
  v_and_b32 v25, 0xffff0000, v25
  v_add_f32 v80, v80, v26
  v_add_f32 v80, v80, v25
  v_lshlrev_b32 v25, 16, v36
  v_and_b32 v26, 0xffff0000, v36
  v_mul_f32 v25, v25, v12
  v_mul_f32 v26, v26, v20
  v_cvt_pk_bf16_f32 v25, v25, v26
  v_lshlrev_b32 v26, 16, v25
  v_and_b32 v25, 0xffff0000, v25
  v_add_f32 v80, v80, v26
  v_add_f32 v80, v80, v25
  s_waitcnt vmcnt(30)
  v_mov_b32 v81, 0
  v_lshlrev_b32 v25, 16, v37
  v_and_b32 v26, 0xffff0000, v37
  v_mul_f32 v25, v25, v8
  v_mul_f32 v26, v26, v16
  v_cvt_pk_bf16_f32 v25, v25, v26
  v_lshlrev_b32 v26, 16, v25
  v_and_b32 v25, 0xffff0000, v25
  v_add_f32 v81, v81, v26
  v_add_f32 v81, v81, v25
  v_lshlrev_b32 v25, 16, v38
  v_and_b32 v26, 0xffff0000, v38
  v_mul_f32 v25, v25, v9
  v_mul_f32 v26, v26, v17
  v_cvt_pk_bf16_f32 v25, v25, v26
  v_lshlrev_b32 v26, 16, v25
  v_and_b32 v25, 0xffff0000, v25
  v_add_f32 v81, v81, v26
  v_add_f32 v81, v81, v25
  v_lshlrev_b32 v25, 16, v39
  v_and_b32 v26, 0xffff0000, v39
  v_mul_f32 v25, v25, v10
  v_mul_f32 v26, v26, v18
  v_cvt_pk_bf16_f32 v25, v25, v26
  v_lshlrev_b32 v26, 16, v25
  v_and_b32 v25, 0xffff0000, v25
  v_add_f32 v81, v81, v26
  v_add_f32 v81, v81, v25
  v_lshlrev_b32 v25, 16, v40
  v_and_b32 v26, 0xffff0000, v40
  v_mul_f32 v25, v25, v11
  v_mul_f32 v26, v26, v19
  v_cvt_pk_bf16_f32 v25, v25, v26
  v_lshlrev_b32 v26, 16, v25
  v_and_b32 v25, 0xffff0000, v25
  v_add_f32 v81, v81, v26
  v_add_f32 v81, v81, v25
  v_lshlrev_b32 v25, 16, v41
  v_and_b32 v26, 0xffff0000, v41
  v_mul_f32 v25, v25, v12
  v_mul_f32 v26, v26, v20
  v_cvt_pk_bf16_f32 v25, v25, v26
  v_lshlrev_b32 v26, 16, v25
  v_and_b32 v25, 0xffff0000, v25
  v_add_f32 v81, v81, v26
  v_add_f32 v81, v81, v25
  s_waitcnt vmcnt(25)
  v_mov_b32 v82, 0
  v_lshlrev_b32 v25, 16, v42
  v_and_b32 v26, 0xffff0000, v42
  v_mul_f32 v25, v25, v8
  v_mul_f32 v26, v26, v16
  v_cvt_pk_bf16_f32 v25, v25, v26
  v_lshlrev_b32 v26, 16, v25
  v_and_b32 v25, 0xffff0000, v25
  v_add_f32 v82, v82, v26
  v_add_f32 v82, v82, v25
  v_lshlrev_b32 v25, 16, v43
  v_and_b32 v26, 0xffff0000, v43
  v_mul_f32 v25, v25, v9
  v_mul_f32 v26, v26, v17
  v_cvt_pk_bf16_f32 v25, v25, v26
  v_lshlrev_b32 v26, 16, v25
  v_and_b32 v25, 0xffff0000, v25
  v_add_f32 v82, v82, v26
  v_add_f32 v82, v82, v25
  v_lshlrev_b32 v25, 16, v44
  v_and_b32 v26, 0xffff0000, v44
  v_mul_f32 v25, v25, v10
  v_mul_f32 v26, v26, v18
  v_cvt_pk_bf16_f32 v25, v25, v26
  v_lshlrev_b32 v26, 16, v25
  v_and_b32 v25, 0xffff0000, v25
  v_add_f32 v82, v82, v26
  v_add_f32 v82, v82, v25
  v_lshlrev_b32 v25, 16, v45
  v_and_b32 v26, 0xffff0000, v45
  v_mul_f32 v25, v25, v11
  v_mul_f32 v26, v26, v19
  v_cvt_pk_bf16_f32 v25, v25, v26
  v_lshlrev_b32 v26, 16, v25
  v_and_b32 v25, 0xffff0000, v25
  v_add_f32 v82, v82, v26
  v_add_f32 v82, v82, v25
  v_lshlrev_b32 v25, 16, v46
  v_and_b32 v26, 0xffff0000, v46
  v_mul_f32 v25, v25, v12
  v_mul_f32 v26, v26, v20
  v_cvt_pk_bf16_f32 v25, v25, v26
  v_lshlrev_b32 v26, 16, v25
  v_and_b32 v25, 0xffff0000, v25
  v_add_f32 v82, v82, v26
  v_add_f32 v82, v82, v25
  s_waitcnt vmcnt(20)
  v_mov_b32 v83, 0
  v_lshlrev_b32 v25, 16, v47
  v_and_b32 v26, 0xffff0000, v47
  v_mul_f32 v25, v25, v8
  v_mul_f32 v26, v26, v16
  v_cvt_pk_bf16_f32 v25, v25, v26
  v_lshlrev_b32 v26, 16, v25
  v_and_b32 v25, 0xffff0000, v25
  v_add_f32 v83, v83, v26
  v_add_f32 v83, v83, v25
  v_lshlrev_b32 v25, 16, v48
  v_and_b32 v26, 0xffff0000, v48
  v_mul_f32 v25, v25, v9
  v_mul_f32 v26, v26, v17
  v_cvt_pk_bf16_f32 v25, v25, v26
  v_lshlrev_b32 v26, 16, v25
  v_and_b32 v25, 0xffff0000, v25
  v_add_f32 v83, v83, v26
  v_add_f32 v83, v83, v25
  v_lshlrev_b32 v25, 16, v49
  v_and_b32 v26, 0xffff0000, v49
  v_mul_f32 v25, v25, v10
  v_mul_f32 v26, v26, v18
  v_cvt_pk_bf16_f32 v25, v25, v26
  v_lshlrev_b32 v26, 16, v25
  v_and_b32 v25, 0xffff0000, v25
  v_add_f32 v83, v83, v26
  v_add_f32 v83, v83, v25
  v_lshlrev_b32 v25, 16, v50
  v_and_b32 v26, 0xffff0000, v50
  v_mul_f32 v25, v25, v11
  v_mul_f32 v26, v26, v19
  v_cvt_pk_bf16_f32 v25, v25, v26
  v_lshlrev_b32 v26, 16, v25
  v_and_b32 v25, 0xffff0000, v25
  v_add_f32 v83, v83, v26
  v_add_f32 v83, v83, v25
  v_lshlrev_b32 v25, 16, v51
  v_and_b32 v26, 0xffff0000, v51
  v_mul_f32 v25, v25, v12
  v_mul_f32 v26, v26, v20
  v_cvt_pk_bf16_f32 v25, v25, v26
  v_lshlrev_b32 v26, 16, v25
  v_and_b32 v25, 0xffff0000, v25
  v_add_f32 v83, v83, v26
  v_add_f32 v83, v83, v25
  s_waitcnt vmcnt(15)
  v_mov_b32 v84, 0
  v_lshlrev_b32 v25, 16, v52
  v_and_b32 v26, 0xffff0000, v52
  v_mul_f32 v25, v25, v8
  v_mul_f32 v26, v26, v16
  v_cvt_pk_bf16_f32 v25, v25, v26
  v_lshlrev_b32 v26, 16, v25
  v_and_b32 v25, 0xffff0000, v25
  v_add_f32 v84, v84, v26
  v_add_f32 v84, v84, v25
  v_lshlrev_b32 v25, 16, v53
  v_and_b32 v26, 0xffff0000, v53
  v_mul_f32 v25, v25, v9
  v_mul_f32 v26, v26, v17
  v_cvt_pk_bf16_f32 v25, v25, v26
  v_lshlrev_b32 v26, 16, v25
  v_and_b32 v25, 0xffff0000, v25
  v_add_f32 v84, v84, v26
  v_add_f32 v84, v84, v25
  v_lshlrev_b32 v25, 16, v54
  v_and_b32 v26, 0xffff0000, v54
  v_mul_f32 v25, v25, v10
  v_mul_f32 v26, v26, v18
  v_cvt_pk_bf16_f32 v25, v25, v26
  v_lshlrev_b32 v26, 16, v25
  v_and_b32 v25, 0xffff0000, v25
  v_add_f32 v84, v84, v26
  v_add_f32 v84, v84, v25
  v_lshlrev_b32 v25, 16, v55
  v_and_b32 v26, 0xffff0000, v55
  v_mul_f32 v25, v25, v11
  v_mul_f32 v26, v26, v19
  v_cvt_pk_bf16_f32 v25, v25, v26
  v_lshlrev_b32 v26, 16, v25
  v_and_b32 v25, 0xffff0000, v25
  v_add_f32 v84, v84, v26
  v_add_f32 v84, v84, v25
  v_lshlrev_b32 v25, 16, v56
  v_and_b32 v26, 0xffff0000, v56
  v_mul_f32 v25, v25, v12
  v_mul_f32 v26, v26, v20
  v_cvt_pk_bf16_f32 v25, v25, v26
  v_lshlrev_b32 v26, 16, v25
  v_and_b32 v25, 0xffff0000, v25
  v_add_f32 v84, v84, v26
  v_add_f32 v84, v84, v25
  s_waitcnt vmcnt(10)
  v_mov_b32 v85, 0
  v_lshlrev_b32 v25, 16, v57
  v_and_b32 v26, 0xffff0000, v57
  v_mul_f32 v25, v25, v8
  v_mul_f32 v26, v26, v16
  v_cvt_pk_bf16_f32 v25, v25, v26
  v_lshlrev_b32 v26, 16, v25
  v_and_b32 v25, 0xffff0000, v25
  v_add_f32 v85, v85, v26
  v_add_f32 v85, v85, v25
  v_lshlrev_b32 v25, 16, v58
  v_and_b32 v26, 0xffff0000, v58
  v_mul_f32 v25, v25, v9
  v_mul_f32 v26, v26, v17
  v_cvt_pk_bf16_f32 v25, v25, v26
  v_lshlrev_b32 v26, 16, v25
  v_and_b32 v25, 0xffff0000, v25
  v_add_f32 v85, v85, v26
  v_add_f32 v85, v85, v25
  v_lshlrev_b32 v25, 16, v59
  v_and_b32 v26, 0xffff0000, v59
  v_mul_f32 v25, v25, v10
  v_mul_f32 v26, v26, v18
  v_cvt_pk_bf16_f32 v25, v25, v26
  v_lshlrev_b32 v26, 16, v25
  v_and_b32 v25, 0xffff0000, v25
  v_add_f32 v85, v85, v26
  v_add_f32 v85, v85, v25
  v_lshlrev_b32 v25, 16, v60
  v_and_b32 v26, 0xffff0000, v60
  v_mul_f32 v25, v25, v11
  v_mul_f32 v26, v26, v19
  v_cvt_pk_bf16_f32 v25, v25, v26
  v_lshlrev_b32 v26, 16, v25
  v_and_b32 v25, 0xffff0000, v25
  v_add_f32 v85, v85, v26
  v_add_f32 v85, v85, v25
  v_lshlrev_b32 v25, 16, v61
  v_and_b32 v26, 0xffff0000, v61
  v_mul_f32 v25, v25, v12
  v_mul_f32 v26, v26, v20
  v_cvt_pk_bf16_f32 v25, v25, v26
  v_lshlrev_b32 v26, 16, v25
  v_and_b32 v25, 0xffff0000, v25
  v_add_f32 v85, v85, v26
  v_add_f32 v85, v85, v25
  s_waitcnt vmcnt(5)
  v_mov_b32 v86, 0
  v_lshlrev_b32 v25, 16, v62
  v_and_b32 v26, 0xffff0000, v62
  v_mul_f32 v25, v25, v8
  v_mul_f32 v26, v26, v16
  v_cvt_pk_bf16_f32 v25, v25, v26
  v_lshlrev_b32 v26, 16, v25
  v_and_b32 v25, 0xffff0000, v25
  v_add_f32 v86, v86, v26
  v_add_f32 v86, v86, v25
  v_lshlrev_b32 v25, 16, v63
  v_and_b32 v26, 0xffff0000, v63
  v_mul_f32 v25, v25, v9
  v_mul_f32 v26, v26, v17
  v_cvt_pk_bf16_f32 v25, v25, v26
  v_lshlrev_b32 v26, 16, v25
  v_and_b32 v25, 0xffff0000, v25
  v_add_f32 v86, v86, v26
  v_add_f32 v86, v86, v25
  v_lshlrev_b32 v25, 16, v64
  v_and_b32 v26, 0xffff0000, v64
  v_mul_f32 v25, v25, v10
  v_mul_f32 v26, v26, v18
  v_cvt_pk_bf16_f32 v25, v25, v26
  v_lshlrev_b32 v26, 16, v25
  v_and_b32 v25, 0xffff0000, v25
  v_add_f32 v86, v86, v26
  v_add_f32 v86, v86, v25
  v_lshlrev_b32 v25, 16, v65
  v_and_b32 v26, 0xffff0000, v65
  v_mul_f32 v25, v25, v11
  v_mul_f32 v26, v26, v19
  v_cvt_pk_bf16_f32 v25, v25, v26
  v_lshlrev_b32 v26, 16, v25
  v_and_b32 v25, 0xffff0000, v25
  v_add_f32 v86, v86, v26
  v_add_f32 v86, v86, v25
  v_lshlrev_b32 v25, 16, v66
  v_and_b32 v26, 0xffff0000, v66
  v_mul_f32 v25, v25, v12
  v_mul_f32 v26, v26, v20
  v_cvt_pk_bf16_f32 v25, v25, v26
  v_lshlrev_b32 v26, 16, v25
  v_and_b32 v25, 0xffff0000, v25
  v_add_f32 v86, v86, v26
  v_add_f32 v86, v86, v25
  s_waitcnt vmcnt(0)
  v_mov_b32 v87, 0
  v_lshlrev_b32 v25, 16, v67
  v_and_b32 v26, 0xffff0000, v67
  v_mul_f32 v25, v25, v8
  v_mul_f32 v26, v26, v16
  v_cvt_pk_bf16_f32 v25, v25, v26
  v_lshlrev_b32 v26, 16, v25
  v_and_b32 v25, 0xffff0000, v25
  v_add_f32 v87, v87, v26
  v_add_f32 v87, v87, v25
  v_lshlrev_b32 v25, 16, v68
  v_and_b32 v26, 0xffff0000, v68
  v_mul_f32 v25, v25, v9
  v_mul_f32 v26, v26, v17
  v_cvt_pk_bf16_f32 v25, v25, v26
  v_lshlrev_b32 v26, 16, v25
  v_and_b32 v25, 0xffff0000, v25
  v_add_f32 v87, v87, v26
  v_add_f32 v87, v87, v25
  v_lshlrev_b32 v25, 16, v69
  v_and_b32 v26, 0xffff0000, v69
  v_mul_f32 v25, v25, v10
  v_mul_f32 v26, v26, v18
  v_cvt_pk_bf16_f32 v25, v25, v26
  v_lshlrev_b32 v26, 16, v25
  v_and_b32 v25, 0xffff0000, v25
  v_add_f32 v87, v87, v26
  v_add_f32 v87, v87, v25
  v_lshlrev_b32 v25, 16, v70
  v_and_b32 v26, 0xffff0000, v70
  v_mul_f32 v25, v25, v11
  v_mul_f32 v26, v26, v19
  v_cvt_pk_bf16_f32 v25, v25, v26
  v_lshlrev_b32 v26, 16, v25
  v_and_b32 v25, 0xffff0000, v25
  v_add_f32 v87, v87, v26
  v_add_f32 v87, v87, v25
  v_lshlrev_b32 v25, 16, v71
  v_and_b32 v26, 0xffff0000, v71
  v_mul_f32 v25, v25, v12
  v_mul_f32 v26, v26, v20
  v_cvt_pk_bf16_f32 v25, v25, v26
  v_lshlrev_b32 v26, 16, v25
  v_and_b32 v25, 0xffff0000, v25
  v_add_f32 v87, v87, v26
  v_add_f32 v87, v87, v25
  v_add_f32_dpp v80, v80, v80 row_ror:8 row_mask:0xf bank_mask:0xf
  v_add_f32_dpp v81, v81, v81 row_ror:8 row_mask:0xf bank_mask:0xf
  v_add_f32_dpp v82, v82, v82 row_ror:8 row_mask:0xf bank_mask:0xf
  v_add_f32_dpp v83, v83, v83 row_ror:8 row_mask:0xf bank_mask:0xf
  v_add_f32_dpp v84, v84, v84 row_ror:8 row_mask:0xf bank_mask:0xf
  v_add_f32_dpp v85, v85, v85 row_ror:8 row_mask:0xf bank_mask:0xf
  v_add_f32_dpp v86, v86, v86 row_ror:8 row_mask:0xf bank_mask:0xf
  v_add_f32_dpp v87, v87, v87 row_ror:8 row_mask:0xf bank_mask:0xf
  v_add_f32_dpp v80, v80, v80 row_ror:4 row_mask:0xf bank_mask:0xf
  v_add_f32_dpp v81, v81, v81 row_ror:4 row_mask:0xf bank_mask:0xf
  v_add_f32_dpp v82, v82, v82 row_ror:4 row_mask:0xf bank_mask:0xf
  v_add_f32_dpp v83, v83, v83 row_ror:4 row_mask:0xf bank_mask:0xf
  v_add_f32_dpp v84, v84, v84 row_ror:4 row_mask:0xf bank_mask:0xf
  v_add_f32_dpp v85, v85, v85 row_ror:4 row_mask:0xf bank_mask:0xf
  v_add_f32_dpp v86, v86, v86 row_ror:4 row_mask:0xf bank_mask:0xf
  v_add_f32_dpp v87, v87, v87 row_ror:4 row_mask:0xf bank_mask:0xf
  v_add_f32_dpp v80, v80, v80 row_ror:2 row_mask:0xf bank_mask:0xf
  v_add_f32_dpp v81, v81, v81 row_ror:2 row_mask:0xf bank_mask:0xf
  v_add_f32_dpp v82, v82, v82 row_ror:2 row_mask:0xf bank_mask:0xf
  v_add_f32_dpp v83, v83, v83 row_ror:2 row_mask:0xf bank_mask:0xf
  v_add_f32_dpp v84, v84, v84 row_ror:2 row_mask:0xf bank_mask:0xf
  v_add_f32_dpp v85, v85, v85 row_ror:2 row_mask:0xf bank_mask:0xf
  v_add_f32_dpp v86, v86, v86 row_ror:2 row_mask:0xf bank_mask:0xf
  v_add_f32_dpp v87, v87, v87 row_ror:2 row_mask:0xf bank_mask:0xf
  v_add_f32_dpp v80, v80, v80 row_ror:1 row_mask:0xf bank_mask:0xf
  v_add_f32_dpp v81, v81, v81 row_ror:1 row_mask:0xf bank_mask:0xf
  v_add_f32_dpp v82, v82, v82 row_ror:1 row_mask:0xf bank_mask:0xf
  v_add_f32_dpp v83, v83, v83 row_ror:1 row_mask:0xf bank_mask:0xf
  v_add_f32_dpp v84, v84, v84 row_ror:1 row_mask:0xf bank_mask:0xf
  v_add_f32_dpp v85, v85, v85 row_ror:1 row_mask:0xf bank_mask:0xf
  v_add_f32_dpp v86, v86, v86 row_ror:1 row_mask:0xf bank_mask:0xf
  v_add_f32_dpp v87, v87, v87 row_ror:1 row_mask:0xf bank_mask:0xf
  v_mov_b32 v88, v80
  v_mov_b32 v89, v81
  v_mov_b32 v90, v82
  v_mov_b32 v91, v83
  v_mov_b32 v92, v84
  v_mov_b32 v93, v85
  v_mov_b32 v94, v86
  v_mov_b32 v95, v87
  v_permlane32_swap_b32 v80, v88
  v_permlane32_swap_b32 v81, v89
  v_permlane32_swap_b32 v82, v90
  v_permlane32_swap_b32 v83, v91
  v_permlane32_swap_b32 v84, v92
  v_permlane32_swap_b32 v85, v93
  v_permlane32_swap_b32 v86, v94
  v_permlane32_swap_b32 v87, v95
  v_add_f32 v80, v80, v88
  v_add_f32 v81, v81, v89
  v_add_f32 v82, v82, v90
  v_add_f32 v83, v83, v91
  v_add_f32 v84, v84, v92
  v_add_f32 v85, v85, v93
  v_add_f32 v86, v86, v94
  v_add_f32 v87, v87, v95
  v_mov_b32 v88, v80
  v_mov_b32 v89, v81
  v_mov_b32 v90, v82
  v_mov_b32 v91, v83
  v_mov_b32 v92, v84
  v_mov_b32 v93, v85
  v_mov_b32 v94, v86
  v_mov_b32 v95, v87
  v_permlane16_swap_b32 v80, v88
  v_permlane16_swap_b32 v81, v89
  v_permlane16_swap_b32 v82, v90
  v_permlane16_swap_b32 v83, v91
  v_permlane16_swap_b32 v84, v92
  v_permlane16_swap_b32 v85, v93
  v_permlane16_swap_b32 v86, v94
  v_permlane16_swap_b32 v87, v95
  v_add_f32 v80, v80, v88
  v_add_f32 v81, v81, v89
  v_add_f32 v82, v82, v90
  v_add_f32 v83, v83, v91
  v_add_f32 v84, v84, v92
  v_add_f32 v85, v85, v93
  v_add_f32 v86, v86, v94
  v_add_f32 v87, v87, v95
  v_mov_b32 v24, v80
  v_cmp_eq_u32 vcc, 1, v1
  s_nop 1
  v_cndmask_b32 v24, v24, v81, vcc
  v_cmp_eq_u32 vcc, 2, v1
  s_nop 1
  v_cndmask_b32 v24, v24, v82, vcc
  v_cmp_eq_u32 vcc, 3, v1
  s_nop 1
  v_cndmask_b32 v24, v24, v83, vcc
  v_cmp_eq_u32 vcc, 4, v1
  s_nop 1
  v_cndmask_b32 v24, v24, v84, vcc
  v_cmp_eq_u32 vcc, 5, v1
  s_nop 1
  v_cndmask_b32 v24, v24, v85, vcc
  v_cmp_eq_u32 vcc, 6, v1
  s_nop 1
  v_cndmask_b32 v24, v24, v86, vcc
  v_cmp_eq_u32 vcc, 7, v1
  s_nop 1
  v_cndmask_b32 v24, v24, v87, vcc
  v_cvt_pk_bf16_f32 v25, v24, v24
  v_lshlrev_b32 v24, 16, v25
  v_mul_f32 v24, 0xbfb8aa3b, v24
  v_exp_f32 v24, v24
  s_nop 0
  v_add_f32 v24, 1.0, v24
  v_rcp_f32 v24, v24
  s_nop 0
  v_cvt_pk_bf16_f32 v25, v24, v24
  v_lshlrev_b32 v24, 16, v25
  s_lshl_b32 s21, s59, 2
  s_mov_b64 exec, 0xff
  buffer_store_dword v24, v4, s[28:31], s21 offen sc1
  s_mov_b64 exec, -1
  s_barrier
  v_and_b32 v4, 31, v1
  v_lshrrev_b32 v5, 5, v1
  s_lshl_b32 s22, s20, 1
  v_add_u32 v5, s22, v5
  v_mul_u32_u24 v6, 40, v4
  v_mul_u32_u24 v7, 2560, v5
  v_add_u32 v7, v7, v6
  v_mul_u32_u24 v8, 1280, v5
  s_mov_b32 s22, 117760
  v_add3_u32 v8, v8, v6, s22
  v_add_u32 v5, s58, v5
  s_mov_b32 s59, 0
  s_mov_b32 s60, 0x3e64f92e
  s_mov_b32 s61, 0x3fb8aa3b
  s_mov_b32 s62, 0x05040100
  s_mov_b32 s63, 0x07060302
  v_mov_b32 v9, 0xf149f2ca
ba_290:
  ds_read_b64 v[16:17], v8 offset:0
  ds_read_b64 v[18:19], v8 offset:8
  ds_read_b64 v[20:21], v8 offset:16
  ds_read_b64 v[22:23], v8 offset:24
  ds_read_b64 v[24:25], v8 offset:32
  ds_read_b64 v[32:33], v7 offset:35840
  ds_read_b64 v[34:35], v7 offset:35848
  ds_read_b64 v[36:37], v7 offset:35856
  ds_read_b64 v[38:39], v7 offset:35864
  ds_read_b64 v[40:41], v7 offset:35872
  ds_read_b64 v[42:43], v7 offset:30720
  ds_read_b64 v[44:45], v7 offset:30728
  ds_read_b64 v[46:47], v7 offset:30736
  ds_read_b64 v[48:49], v7 offset:30744
  ds_read_b64 v[50:51], v7 offset:30752
  ds_read_b64 v[52:53], v7 offset:25600
  ds_read_b64 v[54:55], v7 offset:25608
  ds_read_b64 v[56:57], v7 offset:25616
  ds_read_b64 v[58:59], v7 offset:25624
  ds_read_b64 v[60:61], v7 offset:25632
  ds_read_b64 v[62:63], v7 offset:20480
  ds_read_b64 v[64:65], v7 offset:20488
  ds_read_b64 v[66:67], v7 offset:20496
  ds_read_b64 v[68:69], v7 offset:20504
  ds_read_b64 v[70:71], v7 offset:20512
  ds_read_b64 v[72:73], v7 offset:15360
  ds_read_b64 v[74:75], v7 offset:15368
  ds_read_b64 v[76:77], v7 offset:15376
  ds_read_b64 v[78:79], v7 offset:15384
  ds_read_b64 v[80:81], v7 offset:15392
  ds_read_b64 v[82:83], v7 offset:10240
  ds_read_b64 v[84:85], v7 offset:10248
  ds_read_b64 v[86:87], v7 offset:10256
  ds_read_b64 v[88:89], v7 offset:10264
  ds_read_b64 v[90:91], v7 offset:10272
  ds_read_b64 v[92:93], v7 offset:5120
  ds_read_b64 v[94:95], v7 offset:5128
  ds_read_b64 v[96:97], v7 offset:5136
  ds_read_b64 v[98:99], v7 offset:5144
  ds_read_b64 v[100:101], v7 offset:5152
  ds_read_b64 v[102:103], v7 offset:0
  ds_read_b64 v[104:105], v7 offset:8
  ds_read_b64 v[106:107], v7 offset:16
  ds_read_b64 v[108:109], v7 offset:24
  ds_read_b64 v[110:111], v7 offset:32
  v_cmp_le_u32 s[40:41], 0, v5
  v_mov_b32 v224, 0
  v_cmp_le_u32 s[42:43], 2, v5
  v_mov_b32 v225, 0
  v_cmp_le_u32 s[44:45], 4, v5
  v_mov_b32 v226, 0
  v_cmp_le_u32 s[46:47], 6, v5
  v_mov_b32 v227, 0
  v_cmp_le_u32 s[48:49], 8, v5
  v_mov_b32 v228, 0
  v_cmp_le_u32 s[50:51], 10, v5
  v_mov_b32 v229, 0
  v_cmp_le_u32 s[52:53], 12, v5
  v_mov_b32 v230, 0
  v_cmp_le_u32 s[54:55], 14, v5
  v_mov_b32 v231, 0
  v_mov_b32 v200, 0
  v_mov_b32 v201, 0
  v_mov_b32 v202, 0
  v_mov_b32 v203, 0
  v_mov_b32 v204, 0
  v_mov_b32 v205, 0
  v_mov_b32 v206, 0
  v_mov_b32 v207, 0
  v_mov_b32 v208, 0
  v_mov_b32 v209, 0
  v_mov_b32 v210, 0
  v_mov_b32 v211, 0
  v_mov_b32 v212, 0
  v_mov_b32 v213, 0
  v_mov_b32 v214, 0
  v_mov_b32 v215, 0
  v_mov_b32 v216, 0
  v_mov_b32 v217, 0
  v_mov_b32 v218, 0
  v_mov_b32 v219, 0
  s_waitcnt lgkmcnt(15)
  v_dot2c_f32_bf16 v224, v32, v16
  v_dot2c_f32_bf16 v225, v42, v16
  v_dot2c_f32_bf16 v226, v52, v16
  v_dot2c_f32_bf16 v227, v62, v16
  v_dot2c_f32_bf16 v228, v72, v16
  v_dot2c_f32_bf16 v224, v33, v17
  v_dot2c_f32_bf16 v225, v43, v17
  v_dot2c_f32_bf16 v226, v53, v17
  v_dot2c_f32_bf16 v227, v63, v17
  v_dot2c_f32_bf16 v228, v73, v17
  v_dot2c_f32_bf16 v224, v34, v18
  v_dot2c_f32_bf16 v225, v44, v18
  v_dot2c_f32_bf16 v226, v54, v18
  v_dot2c_f32_bf16 v227, v64, v18
  v_dot2c_f32_bf16 v228, v74, v18
  v_dot2c_f32_bf16 v224, v35, v19
  v_dot2c_f32_bf16 v225, v45, v19
  v_dot2c_f32_bf16 v226, v55, v19
  v_dot2c_f32_bf16 v227, v65, v19
  v_dot2c_f32_bf16 v228, v75, v19
  v_dot2c_f32_bf16 v224, v36, v20
  v_dot2c_f32_bf16 v225, v46, v20
  v_dot2c_f32_bf16 v226, v56, v20
  v_dot2c_f32_bf16 v227, v66, v20
  v_dot2c_f32_bf16 v228, v76, v20
  v_dot2c_f32_bf16 v224, v37, v21
  v_dot2c_f32_bf16 v225, v47, v21
  v_dot2c_f32_bf16 v226, v57, v21
  v_dot2c_f32_bf16 v227, v67, v21
  v_dot2c_f32_bf16 v228, v77, v21
  v_dot2c_f32_bf16 v224, v38, v22
  v_dot2c_f32_bf16 v225, v48, v22
  v_dot2c_f32_bf16 v226, v58, v22
  v_dot2c_f32_bf16 v227, v68, v22
  v_dot2c_f32_bf16 v228, v78, v22
  v_dot2c_f32_bf16 v224, v39, v23
  v_dot2c_f32_bf16 v225, v49, v23
  v_dot2c_f32_bf16 v226, v59, v23
  v_dot2c_f32_bf16 v227, v69, v23
  v_dot2c_f32_bf16 v228, v79, v23
  v_dot2c_f32_bf16 v224, v40, v24
  v_dot2c_f32_bf16 v225, v50, v24
  v_dot2c_f32_bf16 v226, v60, v24
  v_dot2c_f32_bf16 v227, v70, v24
  v_dot2c_f32_bf16 v228, v80, v24
  v_dot2c_f32_bf16 v224, v41, v25
  v_dot2c_f32_bf16 v225, v51, v25
  v_dot2c_f32_bf16 v226, v61, v25
  v_dot2c_f32_bf16 v227, v71, v25
  v_dot2c_f32_bf16 v228, v81, v25
  s_waitcnt lgkmcnt(0)
  v_dot2c_f32_bf16 v229, v82, v16
  v_dot2c_f32_bf16 v230, v92, v16
  v_dot2c_f32_bf16 v231, v102, v16
  v_dot2c_f32_bf16 v229, v83, v17
  v_dot2c_f32_bf16 v230, v93, v17
  v_dot2c_f32_bf16 v231, v103, v17
  v_dot2c_f32_bf16 v229, v84, v18
  v_dot2c_f32_bf16 v230, v94, v18
  v_dot2c_f32_bf16 v231, v104, v18
  v_dot2c_f32_bf16 v229, v85, v19
  v_dot2c_f32_bf16 v230, v95, v19
  v_dot2c_f32_bf16 v231, v105, v19
  v_dot2c_f32_bf16 v229, v86, v20
  v_dot2c_f32_bf16 v230, v96, v20
  v_dot2c_f32_bf16 v231, v106, v20
  v_dot2c_f32_bf16 v229, v87, v21
  v_dot2c_f32_bf16 v230, v97, v21
  v_dot2c_f32_bf16 v231, v107, v21
  v_dot2c_f32_bf16 v229, v88, v22
  v_dot2c_f32_bf16 v230, v98, v22
  v_dot2c_f32_bf16 v231, v108, v22
  v_dot2c_f32_bf16 v229, v89, v23
  v_dot2c_f32_bf16 v230, v99, v23
  v_dot2c_f32_bf16 v231, v109, v23
  v_dot2c_f32_bf16 v229, v90, v24
  v_dot2c_f32_bf16 v230, v100, v24
  v_dot2c_f32_bf16 v231, v110, v24
  v_dot2c_f32_bf16 v229, v91, v25
  v_dot2c_f32_bf16 v230, v101, v25
  v_dot2c_f32_bf16 v231, v111, v25
  ds_read_b64 v[112:113], v7 offset:37120
  ds_read_b64 v[114:115], v7 offset:37128
  ds_read_b64 v[116:117], v7 offset:37136
  ds_read_b64 v[118:119], v7 offset:37144
  ds_read_b64 v[120:121], v7 offset:37152
  ds_read_b64 v[122:123], v7 offset:32000
  ds_read_b64 v[124:125], v7 offset:32008
  ds_read_b64 v[126:127], v7 offset:32016
  ds_read_b64 v[128:129], v7 offset:32024
  ds_read_b64 v[130:131], v7 offset:32032
  ds_read_b64 v[132:133], v7 offset:26880
  ds_read_b64 v[134:135], v7 offset:26888
  ds_read_b64 v[136:137], v7 offset:26896
  ds_read_b64 v[138:139], v7 offset:26904
  ds_read_b64 v[140:141], v7 offset:26912
  ds_read_b64 v[142:143], v7 offset:21760
  ds_read_b64 v[144:145], v7 offset:21768
  ds_read_b64 v[146:147], v7 offset:21776
  ds_read_b64 v[148:149], v7 offset:21784
  ds_read_b64 v[150:151], v7 offset:21792
  ds_read_b64 v[152:153], v7 offset:16640
  ds_read_b64 v[154:155], v7 offset:16648
  ds_read_b64 v[156:157], v7 offset:16656
  ds_read_b64 v[158:159], v7 offset:16664
  ds_read_b64 v[160:161], v7 offset:16672
  ds_read_b64 v[162:163], v7 offset:11520
  ds_read_b64 v[164:165], v7 offset:11528
  ds_read_b64 v[166:167], v7 offset:11536
  ds_read_b64 v[168:169], v7 offset:11544
  ds_read_b64 v[170:171], v7 offset:11552
  ds_read_b64 v[172:173], v7 offset:6400
  ds_read_b64 v[174:175], v7 offset:6408
  ds_read_b64 v[176:177], v7 offset:6416
  ds_read_b64 v[178:179], v7 offset:6424
  ds_read_b64 v[180:181], v7 offset:6432
  ds_read_b64 v[182:183], v7 offset:1280
  ds_read_b64 v[184:185], v7 offset:1288
  ds_read_b64 v[186:187], v7 offset:1296
  ds_read_b64 v[188:189], v7 offset:1304
  ds_read_b64 v[190:191], v7 offset:1312
  v_cvt_pk_bf16_f32 v10, v224, v225
  v_lshlrev_b32 v224, 16, v10
  v_and_b32 v225, 0xffff0000, v10
  v_mul_f32 v224, s60, v224
  v_mul_f32 v225, s60, v225
  v_cvt_pk_bf16_f32 v10, v224, v225
  v_lshlrev_b32 v224, 16, v10
  v_and_b32 v225, 0xffff0000, v10
  v_cndmask_b32 v224, v9, v224, s[40:41]
  v_cndmask_b32 v225, v9, v225, s[42:43]
  v_cvt_pk_bf16_f32 v10, v226, v227
  v_lshlrev_b32 v226, 16, v10
  v_and_b32 v227, 0xffff0000, v10
  v_mul_f32 v226, s60, v226
  v_mul_f32 v227, s60, v227
  v_cvt_pk_bf16_f32 v10, v226, v227
  v_lshlrev_b32 v226, 16, v10
  v_and_b32 v227, 0xffff0000, v10
  v_cndmask_b32 v226, v9, v226, s[44:45]
  v_cndmask_b32 v227, v9, v227, s[46:47]
  v_cvt_pk_bf16_f32 v10, v228, v229
  v_lshlrev_b32 v228, 16, v10
  v_and_b32 v229, 0xffff0000, v10
  v_mul_f32 v228, s60, v228
  v_mul_f32 v229, s60, v229
  v_cvt_pk_bf16_f32 v10, v228, v229
  v_lshlrev_b32 v228, 16, v10
  v_and_b32 v229, 0xffff0000, v10
  v_cndmask_b32 v228, v9, v228, s[48:49]
  v_cndmask_b32 v229, v9, v229, s[50:51]
  v_cvt_pk_bf16_f32 v10, v230, v231
  v_lshlrev_b32 v230, 16, v10
  v_and_b32 v231, 0xffff0000, v10
  v_mul_f32 v230, s60, v230
  v_mul_f32 v231, s60, v231
  v_cvt_pk_bf16_f32 v10, v230, v231
  v_lshlrev_b32 v230, 16, v10
  v_and_b32 v231, 0xffff0000, v10
  v_cndmask_b32 v230, v9, v230, s[52:53]
  v_cndmask_b32 v231, v9, v231, s[54:55]
  v_max3_f32 v12, v224, v225, v226
  v_max3_f32 v12, v12, v227, v228
  v_max3_f32 v12, v12, v229, v230
  v_max_f32 v12, v12, v231
  v_sub_f32 v224, v224, v12
  v_mul_f32 v224, s61, v224
  v_exp_f32 v224, v224
  v_sub_f32 v225, v225, v12
  v_mul_f32 v225, s61, v225
  v_exp_f32 v225, v225
  v_sub_f32 v226, v226, v12
  v_mul_f32 v226, s61, v226
  v_exp_f32 v226, v226
  v_sub_f32 v227, v227, v12
  v_mul_f32 v227, s61, v227
  v_exp_f32 v227, v227
  v_sub_f32 v228, v228, v12
  v_mul_f32 v228, s61, v228
  v_exp_f32 v228, v228
  v_sub_f32 v229, v229, v12
  v_mul_f32 v229, s61, v229
  v_exp_f32 v229, v229
  v_sub_f32 v230, v230, v12
  v_mul_f32 v230, s61, v230
  v_exp_f32 v230, v230
  v_sub_f32 v231, v231, v12
  v_mul_f32 v231, s61, v231
  v_exp_f32 v231, v231
  s_nop 0
  v_add_f32 v12, v224, v225
  v_add_f32 v12, v12, v226
  v_add_f32 v12, v12, v227
  v_add_f32 v12, v12, v228
  v_add_f32 v12, v12, v229
  v_add_f32 v12, v12, v230
  v_add_f32 v12, v12, v231
  v_rcp_f32 v12, v12
  s_nop 0
  v_mul_f32 v224, v224, v12
  v_mul_f32 v225, v225, v12
  v_mul_f32 v226, v226, v12
  v_mul_f32 v227, v227, v12
  v_mul_f32 v228, v228, v12
  v_mul_f32 v229, v229, v12
  v_mul_f32 v230, v230, v12
  v_mul_f32 v231, v231, v12
  v_cvt_pk_bf16_f32 v232, v224, v225
  v_cvt_pk_bf16_f32 v233, v226, v227
  v_cvt_pk_bf16_f32 v234, v228, v229
  v_cvt_pk_bf16_f32 v235, v230, v231
  s_waitcnt lgkmcnt(15)
  v_perm_b32 v236, v122, v112, s62
  v_perm_b32 v237, v122, v112, s63
  v_dot2c_f32_bf16 v200, v236, v232
  v_dot2c_f32_bf16 v201, v237, v232
  v_perm_b32 v238, v123, v113, s62
  v_perm_b32 v239, v123, v113, s63
  v_dot2c_f32_bf16 v202, v238, v232
  v_dot2c_f32_bf16 v203, v239, v232
  v_perm_b32 v240, v124, v114, s62
  v_perm_b32 v241, v124, v114, s63
  v_dot2c_f32_bf16 v204, v240, v232
  v_dot2c_f32_bf16 v205, v241, v232
  v_perm_b32 v242, v125, v115, s62
  v_perm_b32 v243, v125, v115, s63
  v_dot2c_f32_bf16 v206, v242, v232
  v_dot2c_f32_bf16 v207, v243, v232
  v_perm_b32 v236, v126, v116, s62
  v_perm_b32 v237, v126, v116, s63
  v_dot2c_f32_bf16 v208, v236, v232
  v_dot2c_f32_bf16 v209, v237, v232
  v_perm_b32 v238, v127, v117, s62
  v_perm_b32 v239, v127, v117, s63
  v_dot2c_f32_bf16 v210, v238, v232
  v_dot2c_f32_bf16 v211, v239, v232
  v_perm_b32 v240, v128, v118, s62
  v_perm_b32 v241, v128, v118, s63
  v_dot2c_f32_bf16 v212, v240, v232
  v_dot2c_f32_bf16 v213, v241, v232
  v_perm_b32 v242, v129, v119, s62
  v_perm_b32 v243, v129, v119, s63
  v_dot2c_f32_bf16 v214, v242, v232
  v_dot2c_f32_bf16 v215, v243, v232
  v_perm_b32 v236, v130, v120, s62
  v_perm_b32 v237, v130, v120, s63
  v_dot2c_f32_bf16 v216, v236, v232
  v_dot2c_f32_bf16 v217, v237, v232
  v_perm_b32 v238, v131, v121, s62
  v_perm_b32 v239, v131, v121, s63
  v_dot2c_f32_bf16 v218, v238, v232
  v_dot2c_f32_bf16 v219, v239, v232
  s_waitcnt lgkmcnt(15)
  v_perm_b32 v236, v142, v132, s62
  v_perm_b32 v237, v142, v132, s63
  v_dot2c_f32_bf16 v200, v236, v233
  v_dot2c_f32_bf16 v201, v237, v233
  v_perm_b32 v238, v143, v133, s62
  v_perm_b32 v239, v143, v133, s63
  v_dot2c_f32_bf16 v202, v238, v233
  v_dot2c_f32_bf16 v203, v239, v233
  v_perm_b32 v240, v144, v134, s62
  v_perm_b32 v241, v144, v134, s63
  v_dot2c_f32_bf16 v204, v240, v233
  v_dot2c_f32_bf16 v205, v241, v233
  v_perm_b32 v242, v145, v135, s62
  v_perm_b32 v243, v145, v135, s63
  v_dot2c_f32_bf16 v206, v242, v233
  v_dot2c_f32_bf16 v207, v243, v233
  v_perm_b32 v236, v146, v136, s62
  v_perm_b32 v237, v146, v136, s63
  v_dot2c_f32_bf16 v208, v236, v233
  v_dot2c_f32_bf16 v209, v237, v233
  v_perm_b32 v238, v147, v137, s62
  v_perm_b32 v239, v147, v137, s63
  v_dot2c_f32_bf16 v210, v238, v233
  v_dot2c_f32_bf16 v211, v239, v233
  v_perm_b32 v240, v148, v138, s62
  v_perm_b32 v241, v148, v138, s63
  v_dot2c_f32_bf16 v212, v240, v233
  v_dot2c_f32_bf16 v213, v241, v233
  v_perm_b32 v242, v149, v139, s62
  v_perm_b32 v243, v149, v139, s63
  v_dot2c_f32_bf16 v214, v242, v233
  v_dot2c_f32_bf16 v215, v243, v233
  v_perm_b32 v236, v150, v140, s62
  v_perm_b32 v237, v150, v140, s63
  v_dot2c_f32_bf16 v216, v236, v233
  v_dot2c_f32_bf16 v217, v237, v233
  v_perm_b32 v238, v151, v141, s62
  v_perm_b32 v239, v151, v141, s63
  v_dot2c_f32_bf16 v218, v238, v233
  v_dot2c_f32_bf16 v219, v239, v233
  s_waitcnt lgkmcnt(10)
  v_perm_b32 v236, v162, v152, s62
  v_perm_b32 v237, v162, v152, s63
  v_dot2c_f32_bf16 v200, v236, v234
  v_dot2c_f32_bf16 v201, v237, v234
  v_perm_b32 v238, v163, v153, s62
  v_perm_b32 v239, v163, v153, s63
  v_dot2c_f32_bf16 v202, v238, v234
  v_dot2c_f32_bf16 v203, v239, v234
  v_perm_b32 v240, v164, v154, s62
  v_perm_b32 v241, v164, v154, s63
  v_dot2c_f32_bf16 v204, v240, v234
  v_dot2c_f32_bf16 v205, v241, v234
  v_perm_b32 v242, v165, v155, s62
  v_perm_b32 v243, v165, v155, s63
  v_dot2c_f32_bf16 v206, v242, v234
  v_dot2c_f32_bf16 v207, v243, v234
  v_perm_b32 v236, v166, v156, s62
  v_perm_b32 v237, v166, v156, s63
  v_dot2c_f32_bf16 v208, v236, v234
  v_dot2c_f32_bf16 v209, v237, v234
  v_perm_b32 v238, v167, v157, s62
  v_perm_b32 v239, v167, v157, s63
  v_dot2c_f32_bf16 v210, v238, v234
  v_dot2c_f32_bf16 v211, v239, v234
  v_perm_b32 v240, v168, v158, s62
  v_perm_b32 v241, v168, v158, s63
  v_dot2c_f32_bf16 v212, v240, v234
  v_dot2c_f32_bf16 v213, v241, v234
  v_perm_b32 v242, v169, v159, s62
  v_perm_b32 v243, v169, v159, s63
  v_dot2c_f32_bf16 v214, v242, v234
  v_dot2c_f32_bf16 v215, v243, v234
  v_perm_b32 v236, v170, v160, s62
  v_perm_b32 v237, v170, v160, s63
  v_dot2c_f32_bf16 v216, v236, v234
  v_dot2c_f32_bf16 v217, v237, v234
  v_perm_b32 v238, v171, v161, s62
  v_perm_b32 v239, v171, v161, s63
  v_dot2c_f32_bf16 v218, v238, v234
  v_dot2c_f32_bf16 v219, v239, v234
  s_waitcnt lgkmcnt(0)
  v_perm_b32 v236, v182, v172, s62
  v_perm_b32 v237, v182, v172, s63
  v_dot2c_f32_bf16 v200, v236, v235
  v_dot2c_f32_bf16 v201, v237, v235
  v_perm_b32 v238, v183, v173, s62
  v_perm_b32 v239, v183, v173, s63
  v_dot2c_f32_bf16 v202, v238, v235
  v_dot2c_f32_bf16 v203, v239, v235
  v_perm_b32 v240, v184, v174, s62
  v_perm_b32 v241, v184, v174, s63
  v_dot2c_f32_bf16 v204, v240, v235
  v_dot2c_f32_bf16 v205, v241, v235
  v_perm_b32 v242, v185, v175, s62
  v_perm_b32 v243, v185, v175, s63
  v_dot2c_f32_bf16 v206, v242, v235
  v_dot2c_f32_bf16 v207, v243, v235
  v_perm_b32 v236, v186, v176, s62
  v_perm_b32 v237, v186, v176, s63
  v_dot2c_f32_bf16 v208, v236, v235
  v_dot2c_f32_bf16 v209, v237, v235
  v_perm_b32 v238, v187, v177, s62
  v_perm_b32 v239, v187, v177, s63
  v_dot2c_f32_bf16 v210, v238, v235
  v_dot2c_f32_bf16 v211, v239, v235
  v_perm_b32 v240, v188, v178, s62
  v_perm_b32 v241, v188, v178, s63
  v_dot2c_f32_bf16 v212, v240, v235
  v_dot2c_f32_bf16 v213, v241, v235
  v_perm_b32 v242, v189, v179, s62
  v_perm_b32 v243, v189, v179, s63
  v_dot2c_f32_bf16 v214, v242, v235
  v_dot2c_f32_bf16 v215, v243, v235
  v_perm_b32 v236, v190, v180, s62
  v_perm_b32 v237, v190, v180, s63
  v_dot2c_f32_bf16 v216, v236, v235
  v_dot2c_f32_bf16 v217, v237, v235
  v_perm_b32 v238, v191, v181, s62
  v_perm_b32 v239, v191, v181, s63
  v_dot2c_f32_bf16 v218, v238, v235
  v_dot2c_f32_bf16 v219, v239, v235
  v_cvt_pk_bf16_f32 v244, v200, v201
  v_cvt_pk_bf16_f32 v245, v202, v203
  v_cvt_pk_bf16_f32 v246, v204, v205
  v_cvt_pk_bf16_f32 v247, v206, v207
  v_cvt_pk_bf16_f32 v248, v208, v209
  v_cvt_pk_bf16_f32 v249, v210, v211
  v_cvt_pk_bf16_f32 v250, v212, v213
  v_cvt_pk_bf16_f32 v251, v214, v215
  v_cvt_pk_bf16_f32 v252, v216, v217
  v_cvt_pk_bf16_f32 v253, v218, v219
  v_lshrrev_b32 v10, 4, v5
  v_mul_u32_u24 v10, 20480, v10
  v_and_b32 v11, 15, v5
  v_lshl_add_u32 v10, v11, 4, v10
  v_mul_u32_u24 v11, 5, v4
  v_add_u32 v12, 0, v11
  v_lshrrev_b32 v13, 1, v12
  v_and_b32 v12, 1, v12
  v_lshl_add_u32 v13, v13, 8, v10
  v_lshl_add_u32 v13, v12, 3, v13
  buffer_store_dwordx2 v[244:245], v13, s[24:27], 0 offen sc1
  v_add_u32 v12, 1, v11
  v_lshrrev_b32 v13, 1, v12
  v_and_b32 v12, 1, v12
  v_lshl_add_u32 v13, v13, 8, v10
  v_lshl_add_u32 v13, v12, 3, v13
  buffer_store_dwordx2 v[246:247], v13, s[24:27], 0 offen sc1
  v_add_u32 v12, 2, v11
  v_lshrrev_b32 v13, 1, v12
  v_and_b32 v12, 1, v12
  v_lshl_add_u32 v13, v13, 8, v10
  v_lshl_add_u32 v13, v12, 3, v13
  buffer_store_dwordx2 v[248:249], v13, s[24:27], 0 offen sc1
  v_add_u32 v12, 3, v11
  v_lshrrev_b32 v13, 1, v12
  v_and_b32 v12, 1, v12
  v_lshl_add_u32 v13, v13, 8, v10
  v_lshl_add_u32 v13, v12, 3, v13
  buffer_store_dwordx2 v[250:251], v13, s[24:27], 0 offen sc1
  v_add_u32 v12, 4, v11
  v_lshrrev_b32 v13, 1, v12
  v_and_b32 v12, 1, v12
  v_lshl_add_u32 v13, v13, 8, v10
  v_lshl_add_u32 v13, v12, 3, v13
  buffer_store_dwordx2 v[252:253], v13, s[24:27], 0 offen sc1
  v_add_u32 v5, 8, v5
  v_add_u32 v7, 20480, v7
  v_add_u32 v8, 10240, v8
  s_add_u32 s59, s59, 1
  s_cmp_lt_u32 s59, 4
  s_cbranch_scc1 ba_290
  s_waitcnt vmcnt(0)
  s_barrier
  s_lshr_b32 s21, s2, 2
  s_lshl_b32 s21, s21, 7
  s_add_u32 s21, s21, 90112
  s_cmp_lg_u32 s20, 0
  s_cbranch_scc1 af_291
  v_mov_b32 v8, 0
  v_mov_b32 v9, 1
  s_mov_b64 exec, 1
  buffer_atomic_add v9, v8, s[72:75], s21 offen sc1
  s_mov_b64 exec, -1
  s_nop 1
af_291:
  s_branch queue
main_fin:
  s_waitcnt vmcnt(0)
main_end:
  s_endpgm
.section .rodata,"a"
.p2align 6
.amdhsa_kernel gated_mix__memory_aug_recurrent_mem_tr__sliding_local_dilated__prompt_kernel
  .amdhsa_next_free_vgpr 512
  .amdhsa_next_free_sgpr 102
  .amdhsa_accum_offset 256
  .amdhsa_group_segment_fixed_size 0
  .amdhsa_kernarg_size 112
  .amdhsa_user_sgpr_count 2
  .amdhsa_user_sgpr_kernarg_segment_ptr 1
  .amdhsa_system_sgpr_workgroup_id_x 1
.end_amdhsa_kernel
.text
```

```asm
; @launch kernel=gated_mix__memory_aug_recurrent_mem_tr__sliding_local_dilated__prompt_kernel grid=(256,1,1) block=(256,1,1) lds=163840
.amdgcn_target "amdgcn-amd-amdhsa--gfx950"
.text
.globl gated_mix__memory_aug_recurrent_mem_tr__sliding_local_dilated__prompt_kernel
.p2align 8
.type gated_mix__memory_aug_recurrent_mem_tr__sliding_local_dilated__prompt_kernel,@function
gated_mix__memory_aug_recurrent_mem_tr__sliding_local_dilated__prompt_kernel:
  s_cmp_ge_u32 s2, 256
  s_cbranch_scc1 end0
  s_load_dwordx2 s[4:5], s[0:1], 96
  s_load_dwordx2 s[38:39], s[0:1], 104
  v_lshrrev_b32 v1, 6, v0
  v_and_b32 v2, 15, v0
  v_readfirstlane_b32 s20, v1
  v_and_b32 v1, 63, v0
  v_lshrrev_b32 v3, 4, v1
  s_getreg_b32 s50, hwreg(HW_REG_XCC_ID)
  s_and_b32 s50, s50, 7
  s_waitcnt lgkmcnt(0)
  s_mov_b32 s32, s4
  s_mov_b32 s33, s5
  s_mov_b32 s34, 256
  s_mov_b32 s35, 0x00020000
  v_mov_b32 v21, 0
  s_cmp_lg_u32 s20, 0
  s_cbranch_scc1 rk_1
  s_and_b32 s21, s50, 1
  s_lshl_b32 s21, s21, 7
  s_lshl_b32 s22, s50, 1
  s_and_b32 s22, s22, 12
  s_add_u32 s21, s21, s22
  v_mov_b32 v22, s21
  v_mov_b32 v23, 1
  s_mov_b64 exec, 1
  buffer_atomic_add v23, v22, s[32:35], 0 offen sc0 sc1
  s_waitcnt vmcnt(0)
  v_readfirstlane_b32 s51, v23
  s_lshl_b32 s22, s50, 5
  s_add_u32 s22, s22, s51
  s_cmp_lt_u32 s51, 32
  s_cbranch_scc1 rk_2
  v_mov_b32 v24, 72
  v_mov_b32 v25, 1
  buffer_atomic_add v25, v24, s[32:35], 0 offen sc0 sc1
  s_waitcnt vmcnt(0)
  v_readfirstlane_b32 s23, v25
  s_mov_b32 s101, 0
  s_mov_b64 exec, -1
  v_lshlrev_b32 v24, 2, v1
rk_3:
  s_sleep 8
  buffer_load_dword v25, v24, s[32:35], 0 offen sc1
  s_add_u32 s101, s101, 1
  s_cmp_gt_u32 s101, 131072
  s_cbranch_scc1 end0
  s_waitcnt vmcnt(0)
  v_readlane_b32 s21, v25, 0
  v_readlane_b32 s22, v25, 32
  s_add_u32 s21, s21, s22
  v_readlane_b32 s22, v25, 1
  s_add_u32 s21, s21, s22
  v_readlane_b32 s22, v25, 33
  s_add_u32 s21, s21, s22
  v_readlane_b32 s22, v25, 2
  s_add_u32 s21, s21, s22
  v_readlane_b32 s22, v25, 34
  s_add_u32 s21, s21, s22
  v_readlane_b32 s22, v25, 3
  s_add_u32 s21, s21, s22
  v_readlane_b32 s22, v25, 35
  s_add_u32 s21, s21, s22
  s_cmp_lt_u32 s21, 256
  s_cbranch_scc1 rk_3
  s_mov_b64 exec, 1
  s_mov_b32 s24, 0
rk_5:
  s_and_b32 s21, s24, 1
  s_lshl_b32 s21, s21, 5
  s_lshr_b32 s22, s24, 1
  s_add_u32 s21, s21, s22
  v_readlane_b32 s21, v25, s21
  s_min_u32 s21, s21, 32
  s_sub_u32 s25, 32, s21
  s_cmp_lt_u32 s23, s25
  s_cbranch_scc1 rk_4
  s_sub_u32 s23, s23, s25
  s_add_u32 s24, s24, 1
  s_cmp_lt_u32 s24, 8
  s_cbranch_scc1 rk_5
  s_branch end0
rk_4:
  s_lshl_b32 s22, s24, 5
  s_add_u32 s22, s22, s21
  s_add_u32 s22, s22, s23
  s_or_b32 s22, s22, 0x100
rk_2:
  v_mov_b32 v23, s22
  ds_write_b32 v21, v23
  s_waitcnt lgkmcnt(0)
  s_mov_b64 exec, -1
rk_1:
  s_waitcnt vmcnt(0)
  s_barrier
  ds_read_b32 v23, v21
  s_waitcnt lgkmcnt(0)
  v_readfirstlane_b32 s22, v23
  s_barrier
  s_mov_b32 s84, 0
  s_mov_b32 s85, -1
  s_lshr_b32 s53, s22, 8
  s_and_b32 s22, s22, 255
  s_cmp_ge_u32 s22, 128
  s_cbranch_scc1 gemm_side
  s_lshr_b32 s50, s22, 4
  s_and_b32 s51, s22, 15
  s_mov_b32 s86, 0x3dd53b95
  s_load_dwordx2 s[4:5], s[0:1], 8
  s_load_dwordx4 s[40:43], s[0:1], 16
  s_load_dwordx4 s[44:47], s[0:1], 32
  s_load_dwordx2 s[48:49], s[0:1], 104
  s_lshr_b32 s55, s51, 2
  s_and_b32 s56, s51, 3
  s_lshl_b32 s57, s50, 2
  s_add_u32 s58, s57, s55
  s_add_u32 s59, s57, s20
  s_lshr_b32 s60, s51, 1
  s_and_b32 s61, s51, 1
  s_mul_i32 s81, s20, 40448
  v_lshlrev_b32 v4, 4, v1
  s_waitcnt lgkmcnt(0)
  s_mov_b32 s12, s44
  s_mov_b32 s13, s45
  s_mov_b32 s14, 7864320
  s_mov_b32 s15, 0x00020000
  s_mov_b32 s16, s46
  s_mov_b32 s17, s47
  s_mov_b32 s18, 7864320
  s_mov_b32 s19, 0x00020000
  s_mov_b32 s24, s40
  s_mov_b32 s25, s41
  s_mov_b32 s26, 7864320
  s_mov_b32 s27, 0x00020000
  s_mov_b32 s28, s42
  s_mov_b32 s29, s43
  s_mov_b32 s30, 7864320
  s_mov_b32 s31, 0x00020000
  s_mov_b32 s36, s4
  s_mov_b32 s37, s5
  s_mov_b32 s38, 10240
  s_mov_b32 s39, 0x00020000
  s_add_u32 s8, s48, 78643200
  s_addc_u32 s9, s49, 0
  s_mov_b32 s10, 491520
  s_mov_b32 s11, 0x00020000
  s_add_u32 s4, s48, 83886079
  s_addc_u32 s5, s49, 0
  s_and_b32 s4, s4, 0xffe00000
  s_mov_b32 s6, 2097152
  s_mov_b32 s7, 0x00020000
  v_add_u32 v66, 0, v1
  v_mul_u32_u24 v67, 2731, v66
  v_lshrrev_b32 v67, 16, v67
  v_mul_u32_u24 v48, 24, v67
  v_sub_u32 v66, v66, v48
  v_mul_u32_u24 v67, 12288, v67
  v_lshl_add_u32 v48, v66, 4, v67
  v_add_u32 v66, 64, v1
  v_mul_u32_u24 v67, 2731, v66
  v_lshrrev_b32 v67, 16, v67
  v_mul_u32_u24 v49, 24, v67
  v_sub_u32 v66, v66, v49
  v_mul_u32_u24 v67, 12288, v67
  v_lshl_add_u32 v49, v66, 4, v67
  v_add_u32 v66, 128, v1
  v_mul_u32_u24 v67, 2731, v66
  v_lshrrev_b32 v67, 16, v67
  v_mul_u32_u24 v50, 24, v67
  v_sub_u32 v66, v66, v50
  v_mul_u32_u24 v67, 12288, v67
  v_lshl_add_u32 v50, v66, 4, v67
  s_mul_i32 s21, s51, 491520
  s_mul_i32 s80, s59, 384
  s_add_u32 s21, s21, s80
  s_mov_b32 s23, s21
  v_add_u32 v66, 0, v1
  v_mul_u32_u24 v67, 10923, v66
  v_lshrrev_b32 v67, 16, v67
  v_mul_u32_u24 v60, 6, v67
  v_sub_u32 v66, v66, v60
  v_mul_u32_u24 v67, 1280, v67
  v_lshl_add_u32 v60, v66, 4, v67
  v_add_u32 v66, 64, v1
  v_mul_u32_u24 v67, 10923, v66
  v_lshrrev_b32 v67, 16, v67
  v_mul_u32_u24 v61, 6, v67
  v_sub_u32 v66, v66, v61
  v_mul_u32_u24 v67, 1280, v67
  v_lshl_add_u32 v61, v66, 4, v67
  v_add_u32 v66, 128, v1
  v_mul_u32_u24 v67, 10923, v66
  v_lshrrev_b32 v67, 16, v67
  v_mul_u32_u24 v62, 6, v67
  v_sub_u32 v66, v66, v62
  v_mul_u32_u24 v67, 1280, v67
  v_lshl_add_u32 v62, v66, 4, v67
  s_mul_i32 s21, s59, 245760
  s_mul_i32 s22, s60, 160
  s_add_u32 s21, s21, s22
  s_lshl_b32 s22, s61, 6
  s_add_u32 s21, s21, s22
  s_add_u32 m0, s81, 0
  s_nop 0
  buffer_load_dwordx4 v60, s[16:19], s21 offen lds
  s_add_u32 m0, s81, 1024
  s_nop 0
  buffer_load_dwordx4 v61, s[16:19], s21 offen lds
  s_add_u32 m0, s81, 2048
  s_nop 0
  buffer_load_dwordx4 v62, s[16:19], s21 offen lds
  s_add_u32 s21, s21, 40960
  s_add_u32 m0, s81, 3072
  s_nop 0
  buffer_load_dwordx4 v60, s[16:19], s21 offen lds
  s_add_u32 m0, s81, 4096
  s_nop 0
  buffer_load_dwordx4 v61, s[16:19], s21 offen lds
  s_add_u32 m0, s81, 5120
  s_nop 0
  buffer_load_dwordx4 v62, s[16:19], s21 offen lds
  s_add_u32 s21, s21, 40960
  s_add_u32 m0, s81, 6144
  s_nop 0
  buffer_load_dwordx4 v60, s[16:19], s21 offen lds
  s_add_u32 m0, s81, 7168
  s_nop 0
  buffer_load_dwordx4 v61, s[16:19], s21 offen lds
  s_add_u32 m0, s81, 8192
  s_nop 0
  buffer_load_dwordx4 v62, s[16:19], s21 offen lds
  s_add_u32 s21, s21, 40960
  s_add_u32 m0, s81, 9216
  s_nop 0
  buffer_load_dwordx4 v60, s[16:19], s21 offen lds
  s_add_u32 m0, s81, 10240
  s_nop 0
  buffer_load_dwordx4 v61, s[16:19], s21 offen lds
  s_add_u32 m0, s81, 11264
  s_nop 0
  buffer_load_dwordx4 v62, s[16:19], s21 offen lds
  s_add_u32 s21, s21, 40960
  s_add_u32 m0, s81, 12288
  s_nop 0
  buffer_load_dwordx4 v60, s[16:19], s21 offen lds
  s_add_u32 m0, s81, 13312
  s_nop 0
  buffer_load_dwordx4 v61, s[16:19], s21 offen lds
  s_add_u32 m0, s81, 14336
  s_nop 0
  buffer_load_dwordx4 v62, s[16:19], s21 offen lds
  s_add_u32 s21, s21, 40960
  s_add_u32 m0, s81, 15360
  s_nop 0
  buffer_load_dwordx4 v60, s[16:19], s21 offen lds
  s_add_u32 m0, s81, 16384
  s_nop 0
  buffer_load_dwordx4 v61, s[16:19], s21 offen lds
  s_add_u32 m0, s81, 17408
  s_nop 0
  buffer_load_dwordx4 v62, s[16:19], s21 offen lds
  s_add_u32 s21, s21, 40960
  v_add_u32 v66, 0, v1
  v_mul_u32_u24 v67, 2731, v66
  v_lshrrev_b32 v67, 16, v67
  v_mul_u32_u24 v48, 24, v67
  v_sub_u32 v66, v66, v48
  v_lshrrev_b32 v48, 2, v67
  v_lshlrev_b32 v48, 1, v48
  v_or_b32 v48, 0, v48
  v_xor_b32 v66, v66, v48
  v_add_u32 v67, 0, v67
  v_mul_u32_u24 v67, 12288, v67
  v_lshl_add_u32 v48, v66, 4, v67
  v_add_u32 v66, 64, v1
  v_mul_u32_u24 v67, 2731, v66
  v_lshrrev_b32 v67, 16, v67
  v_mul_u32_u24 v49, 24, v67
  v_sub_u32 v66, v66, v49
  v_lshrrev_b32 v49, 2, v67
  v_lshlrev_b32 v49, 1, v49
  v_or_b32 v49, 0, v49
  v_xor_b32 v66, v66, v49
  v_add_u32 v67, 0, v67
  v_mul_u32_u24 v67, 12288, v67
  v_lshl_add_u32 v49, v66, 4, v67
  v_add_u32 v66, 128, v1
  v_mul_u32_u24 v67, 2731, v66
  v_lshrrev_b32 v67, 16, v67
  v_mul_u32_u24 v50, 24, v67
  v_sub_u32 v66, v66, v50
  v_lshrrev_b32 v50, 2, v67
  v_lshlrev_b32 v50, 1, v50
  v_or_b32 v50, 0, v50
  v_xor_b32 v66, v66, v50
  v_add_u32 v67, 0, v67
  v_mul_u32_u24 v67, 12288, v67
  v_lshl_add_u32 v50, v66, 4, v67
  v_add_u32 v66, 0, v1
  v_mul_u32_u24 v67, 2731, v66
  v_lshrrev_b32 v67, 16, v67
  v_mul_u32_u24 v51, 24, v67
  v_sub_u32 v66, v66, v51
  v_lshrrev_b32 v51, 2, v67
  v_lshlrev_b32 v51, 1, v51
  v_or_b32 v51, 1, v51
  v_xor_b32 v66, v66, v51
  v_add_u32 v67, 8, v67
  v_mul_u32_u24 v67, 12288, v67
  v_lshl_add_u32 v51, v66, 4, v67
  v_add_u32 v66, 64, v1
  v_mul_u32_u24 v67, 2731, v66
  v_lshrrev_b32 v67, 16, v67
  v_mul_u32_u24 v52, 24, v67
  v_sub_u32 v66, v66, v52
  v_lshrrev_b32 v52, 2, v67
  v_lshlrev_b32 v52, 1, v52
  v_or_b32 v52, 1, v52
  v_xor_b32 v66, v66, v52
  v_add_u32 v67, 8, v67
  v_mul_u32_u24 v67, 12288, v67
  v_lshl_add_u32 v52, v66, 4, v67
  v_add_u32 v66, 128, v1
  v_mul_u32_u24 v67, 2731, v66
  v_lshrrev_b32 v67, 16, v67
  v_mul_u32_u24 v53, 24, v67
  v_sub_u32 v66, v66, v53
  v_lshrrev_b32 v53, 2, v67
  v_lshlrev_b32 v53, 1, v53
  v_or_b32 v53, 1, v53
  v_xor_b32 v66, v66, v53
  v_add_u32 v67, 8, v67
  v_mul_u32_u24 v67, 12288, v67
  v_lshl_add_u32 v53, v66, 4, v67
  v_add_u32 v66, 0, v1
  v_mul_u32_u24 v67, 2731, v66
  v_lshrrev_b32 v67, 16, v67
  v_mul_u32_u24 v54, 24, v67
  v_sub_u32 v66, v66, v54
  v_lshrrev_b32 v54, 2, v67
  v_lshlrev_b32 v54, 1, v54
  v_or_b32 v54, 4, v54
  v_xor_b32 v66, v66, v54
  v_add_u32 v67, 16, v67
  v_mul_u32_u24 v67, 12288, v67
  v_lshl_add_u32 v54, v66, 4, v67
  v_add_u32 v66, 64, v1
  v_mul_u32_u24 v67, 2731, v66
  v_lshrrev_b32 v67, 16, v67
  v_mul_u32_u24 v55, 24, v67
  v_sub_u32 v66, v66, v55
  v_lshrrev_b32 v55, 2, v67
  v_lshlrev_b32 v55, 1, v55
  v_or_b32 v55, 4, v55
  v_xor_b32 v66, v66, v55
  v_add_u32 v67, 16, v67
  v_mul_u32_u24 v67, 12288, v67
  v_lshl_add_u32 v55, v66, 4, v67
  v_add_u32 v66, 128, v1
  v_mul_u32_u24 v67, 2731, v66
  v_lshrrev_b32 v67, 16, v67
  v_mul_u32_u24 v56, 24, v67
  v_sub_u32 v66, v66, v56
  v_lshrrev_b32 v56, 2, v67
  v_lshlrev_b32 v56, 1, v56
  v_or_b32 v56, 4, v56
  v_xor_b32 v66, v66, v56
  v_add_u32 v67, 16, v67
  v_mul_u32_u24 v67, 12288, v67
  v_lshl_add_u32 v56, v66, 4, v67
  v_add_u32 v66, 0, v1
  v_mul_u32_u24 v67, 2731, v66
  v_lshrrev_b32 v67, 16, v67
  v_mul_u32_u24 v57, 24, v67
  v_sub_u32 v66, v66, v57
  v_lshrrev_b32 v57, 2, v67
  v_lshlrev_b32 v57, 1, v57
  v_or_b32 v57, 5, v57
  v_xor_b32 v66, v66, v57
  v_add_u32 v67, 24, v67
  v_mul_u32_u24 v67, 12288, v67
  v_lshl_add_u32 v57, v66, 4, v67
  v_add_u32 v66, 64, v1
  v_mul_u32_u24 v67, 2731, v66
  v_lshrrev_b32 v67, 16, v67
  v_mul_u32_u24 v58, 24, v67
  v_sub_u32 v66, v66, v58
  v_lshrrev_b32 v58, 2, v67
  v_lshlrev_b32 v58, 1, v58
  v_or_b32 v58, 5, v58
  v_xor_b32 v66, v66, v58
  v_add_u32 v67, 24, v67
  v_mul_u32_u24 v67, 12288, v67
  v_lshl_add_u32 v58, v66, 4, v67
  v_add_u32 v66, 128, v1
  v_mul_u32_u24 v67, 2731, v66
  v_lshrrev_b32 v67, 16, v67
  v_mul_u32_u24 v59, 24, v67
  v_sub_u32 v66, v66, v59
  v_lshrrev_b32 v59, 2, v67
  v_lshlrev_b32 v59, 1, v59
  v_or_b32 v59, 5, v59
  v_xor_b32 v66, v66, v59
  v_add_u32 v67, 24, v67
  v_mul_u32_u24 v67, 12288, v67
  v_lshl_add_u32 v59, v66, 4, v67
  s_add_u32 m0, s81, 24576
  s_nop 0
  buffer_load_dwordx4 v48, s[12:15], s80 offen lds
  s_add_u32 m0, s81, 25600
  s_nop 0
  buffer_load_dwordx4 v49, s[12:15], s80 offen lds
  s_add_u32 m0, s81, 26624
  s_nop 0
  buffer_load_dwordx4 v50, s[12:15], s80 offen lds
  s_add_u32 m0, s81, 27648
  s_nop 0
  buffer_load_dwordx4 v51, s[12:15], s80 offen lds
  s_add_u32 m0, s81, 28672
  s_nop 0
  buffer_load_dwordx4 v52, s[12:15], s80 offen lds
  s_add_u32 m0, s81, 29696
  s_nop 0
  buffer_load_dwordx4 v53, s[12:15], s80 offen lds
  s_add_u32 m0, s81, 30720
  s_nop 0
  buffer_load_dwordx4 v54, s[12:15], s80 offen lds
  s_add_u32 m0, s81, 31744
  s_nop 0
  buffer_load_dwordx4 v55, s[12:15], s80 offen lds
  s_add_u32 m0, s81, 32768
  s_nop 0
  buffer_load_dwordx4 v56, s[12:15], s80 offen lds
  s_add_u32 m0, s81, 33792
  s_nop 0
  buffer_load_dwordx4 v57, s[12:15], s80 offen lds
  s_add_u32 m0, s81, 34816
  s_nop 0
  buffer_load_dwordx4 v58, s[12:15], s80 offen lds
  s_add_u32 m0, s81, 35840
  s_nop 0
  buffer_load_dwordx4 v59, s[12:15], s80 offen lds
  s_add_u32 s80, s80, 393216
  v_add_u32 v66, 0, v1
  v_mul_u32_u24 v67, 10923, v66
  v_lshrrev_b32 v67, 16, v67
  v_mul_u32_u24 v63, 6, v67
  v_sub_u32 v66, v66, v63
  v_mul_u32_u24 v67, 12288, v67
  v_lshl_add_u32 v63, v66, 4, v67
  v_add_u32 v66, 64, v1
  v_mul_u32_u24 v67, 10923, v66
  v_lshrrev_b32 v67, 16, v67
  v_mul_u32_u24 v64, 6, v67
  v_sub_u32 v66, v66, v64
  v_mul_u32_u24 v67, 12288, v67
  v_lshl_add_u32 v64, v66, 4, v67
  v_add_u32 v66, 128, v1
  v_mul_u32_u24 v67, 10923, v66
  v_lshrrev_b32 v67, 16, v67
  v_mul_u32_u24 v65, 6, v67
  v_sub_u32 v66, v66, v65
  v_mul_u32_u24 v67, 12288, v67
  v_lshl_add_u32 v65, v66, 4, v67
  s_mul_i32 s79, s58, 384
  s_mul_i32 s22, s56, 96
  s_add_u32 s79, s79, s22
  s_mul_i32 s22, s20, 1966080
  s_add_u32 s79, s79, s22
  v_and_b32 v224, 7, v2
  v_lshrrev_b32 v225, 3, v2
  v_lshlrev_b32 v12, 3, v1
  v_mov_b32 v23, 0
  v_mov_b32 v226, 0x4444
  v_mov_b32 v227, 0xeeee
  v_cmp_eq_u32 vcc, 1, v225
  v_cmp_gt_u32 s[62:63], 8, v2
  v_cmp_le_u32 s[68:69], 8, v2
  v_cndmask_b32 v22, v226, v227, vcc
  v_cmp_gt_u32 vcc, 32, v1
  v_mov_b32 v226, 0x3dd53b95
  v_cmp_gt_u32 s[66:67], 40, v1
  v_cndmask_b32 v24, 1.0, v226, vcc
  v_cndmask_b32 v25, 1.0, v226, vcc
  v_min_u32 v226, 39, v1
  v_and_b32 v227, 31, v1
  v_lshlrev_b32 v227, 2, v227
  v_lshl_add_u32 v5, v226, 7, v227
  v_mul_u32_u24 v226, 192, v3
  v_lshl_add_u32 v226, v2, 3, v226
  s_mul_i32 s21, s20, 768
  s_add_u32 s21, s21, 10240
  v_add_u32 v6, s21, v226
  v_and_b32 v226, 3, v2
  v_mul_u32_u24 v226, 192, v226
  v_lshrrev_b32 v227, 2, v2
  v_lshl_add_u32 v227, v3, 2, v227
  v_lshl_add_u32 v226, v227, 3, v226
  v_add_u32 v7, 10240, v226
  s_mul_i32 s21, s58, 2560
  s_add_u32 s21, s21, 40960
  s_lshr_b32 s22, s56, 1
  s_lshl_b32 s22, s22, 10
  s_and_b32 s23, s56, 1
  s_lshl_b32 s23, s23, 3
  s_add_u32 s22, s22, s23
  s_lshl_b32 s23, s20, 7
  s_add_u32 s22, s22, s23
  s_add_u32 s22, s22, s21
  v_lshlrev_b32 v226, 8, v3
  v_lshl_add_u32 v226, v224, 4, v226
  v_add_u32 v8, s22, v226
  s_lshl_b32 s22, s56, 2
  s_add_u32 s22, s22, s21
  s_add_u32 s22, s22, 2048
  v_and_b32 v226, 0x1ff, v226
  v_add_u32 v226, s22, v226
  s_cmp_eq_u32 s20, 2
  s_cselect_b64 vcc, -1, 0
  v_cmp_le_u32 s[64:65], 32, v1
  v_cndmask_b32 v8, v8, v226, vcc
  s_cselect_b64 s[64:65], s[64:65], -1
  s_and_b64 s[64:65], s[64:65], s[62:63]
  s_mul_i32 s21, s59, 2560
  s_add_u32 s21, s21, 40960
  v_add_u32 v9, s21, v4
  v_and_b32 v226, 0x1ff, v4
  s_add_u32 s21, s21, 2048
  v_add_u32 v10, s21, v226
  v_lshrrev_b32 v226, 2, v2
  v_and_b32 v227, 1, v2
  v_lshl_add_u32 v228, v226, 1, v227
  v_and_b32 v227, 2, v2
  v_cmp_eq_u32 vcc, 0, v227
  s_lshr_b32 s21, s20, 1
  s_lshl_b32 s21, s21, 9
  s_and_b32 s22, s20, 1
  s_lshl_b32 s22, s22, 6
  s_add_u32 s21, s21, s22
  s_add_u32 s21, s21, 12544
  v_lshlrev_b32 v226, 7, v3
  v_lshl_add_u32 v226, v228, 3, v226
  v_add_u32 v226, s21, v226
  v_mov_b32 v227, 13568
  v_cndmask_b32 v11, v227, v226, vcc
  s_lshl_b32 s21, s20, 9
  s_add_u32 s21, s21, 40960
  v_lshlrev_b32 v226, 7, v3
  v_lshl_add_u32 v226, v228, 4, v226
  v_add_u32 v226, s21, v226
  v_mov_b32 v227, 46080
  v_cndmask_b32 v19, v227, v226, vcc
  s_lshl_b32 s21, s20, 11
  s_add_u32 s21, s21, 32768
  v_add_u32 v18, s21, v4
  s_and_b32 s21, s20, 1
  s_lshl_b32 s22, s21, 10
  s_add_u32 s22, s22, 43008
  v_add_u32 v20, s22, v4
  s_lshl_b32 s22, s21, 3
  s_add_u32 s22, s22, 45056
  v_add_u32 v21, s22, v4
  s_mul_i32 s21, s20, 640
  s_add_u32 s22, s21, 13824
  v_lshlrev_b32 v226, 4, v224
  v_lshl_add_u32 v227, v3, 7, v226
  v_add_u32 v13, s22, v227
  v_lshl_add_u32 v227, v3, 2, v226
  s_add_u32 s22, s22, 512
  v_add_u32 v14, s22, v227
  v_and_b32 v226, 0x1ff, v4
  v_lshrrev_b32 v228, 5, v1
  v_lshl_add_u32 v226, v228, 3, v226
  s_add_u32 s22, s21, 16384
  v_add_u32 v26, s22, v226
  v_lshl_add_u32 v228, v228, 1, v225
  v_mul_u32_u24 v228, 640, v228
  v_and_b32 v226, 1, v3
  v_lshl_add_u32 v228, v226, 6, v228
  v_lshl_add_u32 v228, v224, 3, v228
  v_add_u32 v43, 16896, v228
  s_and_b32 s21, s50, 1
  s_lshl_b32 s21, s21, 4
  s_add_u32 s21, s21, s51
  s_lshl_b32 s22, s20, 5
  s_add_u32 s21, s21, s22
  s_cmp_lt_u32 s21, 80
  s_cselect_b32 s78, 1, 0
  s_cselect_b32 s21, s21, 0
  s_lshl_b32 s22, s21, 7
  v_add_u32 v17, s22, v227
  s_lshr_b32 s22, s21, 3
  s_lshl_b32 s22, s22, 14
  s_and_b32 s21, s21, 7
  s_lshl_b32 s21, s21, 10
  s_add_u32 s21, s21, s22
  v_add_u32 v16, s21, v4
  s_mul_i32 s21, s60, 10
  s_mul_i32 s22, s61, 6
  s_add_u32 s22, s22, s21
  s_add_u32 s21, s21, s61
  s_add_u32 s21, s21, 4
  v_lshrrev_b32 v226, 3, v1
  v_cmp_gt_u32 vcc, 4, v226
  v_add_u32 v226, s22, v226
  v_mov_b32 v227, s21
  v_cndmask_b32 v226, v227, v226, vcc
  v_lshrrev_b32 v227, 3, v226
  v_lshlrev_b32 v227, 14, v227
  v_and_b32 v226, 7, v226
  v_lshl_add_u32 v226, v226, 10, v227
  v_lshl_add_u32 v226, v224, 4, v226
  s_lshl_b32 s21, s50, 7
  v_add_u32 v15, s21, v226
  v_and_b32 v226, 1, v2
  v_lshlrev_b32 v226, 4, v226
  v_mov_b32 v227, 0x3c00
  v_lshlrev_b32 v226, v226, v227
  v_lshrrev_b32 v227, 1, v2
  v_cmp_eq_u32 vcc, 0, v227
  s_nop 1
  v_cndmask_b32 v44, 0, v226, vcc
  v_cmp_eq_u32 vcc, 2, v227
  s_nop 1
  v_cndmask_b32 v45, 0, v226, vcc
  v_cmp_eq_u32 vcc, 4, v227
  s_nop 1
  v_cndmask_b32 v46, 0, v226, vcc
  v_cmp_eq_u32 vcc, 6, v227
  s_nop 1
  v_cndmask_b32 v47, 0, v226, vcc
  v_lshrrev_b32 v226, 5, v1
  v_mul_u32_u24 v226, 40960, v226
  v_bfe_u32 v227, v1, 3, 2
  v_lshl_add_u32 v226, v227, 8, v226
  v_lshl_add_u32 v226, v224, 4, v226
  s_lshl_b32 s21, s61, 7
  v_add_u32 v32, s21, v226
  s_mul_i32 s21, s56, 768
  v_lshlrev_b32 v226, 4, v224
  v_lshl_add_u32 v227, v3, 7, v226
  v_add_u32 v36, s21, v227
  v_lshrrev_b32 v227, 1, v227
  s_add_u32 s21, s21, 512
  v_add_u32 v37, s21, v227
  v_and_b32 v41, 3, v1
  v_lshlrev_b32 v41, 7, v41
  v_add_u32 v226, 0, v1
  v_mul_u32_u24 v227, 1639, v226
  v_lshrrev_b32 v227, 16, v227
  v_mul_u32_u24 v38, 40, v227
  v_sub_u32 v226, v226, v38
  v_mul_u32_u24 v227, 10240, v227
  v_lshl_add_u32 v38, v226, 4, v227
  v_add_u32 v226, 64, v1
  v_mul_u32_u24 v227, 1639, v226
  v_lshrrev_b32 v227, 16, v227
  v_mul_u32_u24 v39, 40, v227
  v_sub_u32 v226, v226, v39
  v_mul_u32_u24 v227, 10240, v227
  v_lshl_add_u32 v39, v226, 4, v227
  v_add_u32 v226, 128, v1
  v_mul_u32_u24 v227, 1639, v226
  v_lshrrev_b32 v227, 16, v227
  v_mul_u32_u24 v40, 40, v227
  v_sub_u32 v226, v226, v40
  v_mul_u32_u24 v227, 10240, v227
  v_lshl_add_u32 v40, v226, 4, v227
  v_mov_b32 v28, -1
  v_mov_b32 v29, -1
  v_mov_b32 v30, -1
  v_mov_b32 v31, -1
  s_lshr_b32 s21, s50, 1
  s_mul_i32 s77, s21, 10240
  s_cmp_eq_u32 s20, 3
  s_cbranch_scc1 ar_8
  s_mov_b64 exec, s[64:65]
  s_cmp_eq_u32 s20, 2
  s_cbranch_scc1 ar_7
  s_mov_b32 s21, 0
  buffer_store_dwordx2 v[28:29], v8, s[8:11], s21 offen
  s_mov_b32 s21, 122880
  buffer_store_dwordx2 v[28:29], v8, s[8:11], s21 offen
  s_mov_b32 s21, 245760
  buffer_store_dwordx2 v[28:29], v8, s[8:11], s21 offen
  s_mov_b32 s21, 368640
  buffer_store_dwordx2 v[28:29], v8, s[8:11], s21 offen
  s_branch ar_9
ar_7:
  s_mov_b32 s21, 0
  buffer_store_dword v28, v8, s[8:11], s21 offen
  buffer_store_dword v28, v8, s[8:11], s21 offen offset:128
  s_mov_b32 s21, 122880
  buffer_store_dword v28, v8, s[8:11], s21 offen
  buffer_store_dword v28, v8, s[8:11], s21 offen offset:128
  s_mov_b32 s21, 245760
  buffer_store_dword v28, v8, s[8:11], s21 offen
  buffer_store_dword v28, v8, s[8:11], s21 offen offset:128
  s_mov_b32 s21, 368640
  buffer_store_dword v28, v8, s[8:11], s21 offen
  buffer_store_dword v28, v8, s[8:11], s21 offen offset:128
ar_9:
  s_cmp_eq_u32 s78, 0
  s_cbranch_scc1 ar_10
  s_mov_b64 exec, s[62:63]
  s_add_u32 s21, s77, 0
  buffer_store_dword v28, v17, s[8:11], s21 offen
  s_add_u32 s21, s77, 122880
  buffer_store_dword v28, v17, s[8:11], s21 offen
  s_add_u32 s21, s77, 245760
  buffer_store_dword v28, v17, s[8:11], s21 offen
  s_add_u32 s21, s77, 368640
  buffer_store_dword v28, v17, s[8:11], s21 offen
  s_branch ar_10
ar_8:
  s_mov_b64 exec, s[66:67]
  s_mov_b32 s21, 0
  buffer_store_dwordx4 v[28:31], v15, s[4:7], s21 offen sc1
  s_mov_b32 s21, 524288
  buffer_store_dwordx4 v[28:31], v15, s[4:7], s21 offen sc1
  s_mov_b32 s21, 8192
  buffer_store_dwordx4 v[28:31], v15, s[4:7], s21 offen sc1
  s_mov_b32 s21, 532480
  buffer_store_dwordx4 v[28:31], v15, s[4:7], s21 offen sc1
ar_10:
  s_mov_b64 exec, -1
  v_lshrrev_b32 v66, 2, v2
  v_lshl_add_u32 v66, v3, 3, v66
  v_mul_u32_u24 v66, 96, v66
  v_add_u32 v66, s81, v66
  v_and_b32 v67, 3, v2
  s_lshl_b32 s21, s61, 5
  v_lshl_add_u32 v68, v67, 4, v66
  v_add_u32 v68, s21, v68
  s_mul_i32 s21, s61, 48
  s_sub_u32 s21, 64, s21
  v_and_b32 v67, 1, v2
  v_lshl_add_u32 v69, v67, 3, v66
  v_add_u32 v69, s21, v69
  v_lshrrev_b32 v226, 3, v2
  v_lshlrev_b32 v226, 4, v226
  v_bfe_u32 v227, v2, 1, 1
  v_lshl_add_u32 v226, v227, 3, v226
  v_and_b32 v227, 5, v2
  v_add_u32 v226, v226, v227
  v_mul_u32_u24 v226, 384, v226
  v_add_u32 v226, s81, v226
  v_lshrrev_b32 v227, 1, v2
  v_xor_b32 v227, v227, v3
  v_lshl_add_u32 v70, v227, 4, v226
  v_xor_b32 v227, 4, v227
  v_lshl_add_u32 v71, v227, 4, v226
  s_waitcnt vmcnt(0)
  ds_read_b64_tr_b16 v[72:73], v68 offset:0
  ds_read_b64_tr_b16 v[74:75], v68 offset:384
  ds_read_b64_tr_b16 v[76:77], v68 offset:8
  ds_read_b64_tr_b16 v[78:79], v68 offset:392
  ds_read_b64_tr_b16 v[80:81], v69 offset:0
  ds_read_b64_tr_b16 v[82:83], v69 offset:384
  ds_read_b64_tr_b16 v[84:85], v68 offset:3072
  ds_read_b64_tr_b16 v[86:87], v68 offset:3456
  ds_read_b64_tr_b16 v[88:89], v68 offset:3080
  ds_read_b64_tr_b16 v[90:91], v68 offset:3464
  ds_read_b64_tr_b16 v[92:93], v69 offset:3072
  ds_read_b64_tr_b16 v[94:95], v69 offset:3456
  ds_read_b64_tr_b16 v[96:97], v68 offset:6144
  ds_read_b64_tr_b16 v[98:99], v68 offset:6528
  ds_read_b64_tr_b16 v[100:101], v68 offset:6152
  ds_read_b64_tr_b16 v[102:103], v68 offset:6536
  ds_read_b64_tr_b16 v[104:105], v69 offset:6144
  ds_read_b64_tr_b16 v[106:107], v69 offset:6528
  ds_read_b64_tr_b16 v[108:109], v68 offset:9216
  ds_read_b64_tr_b16 v[110:111], v68 offset:9600
  ds_read_b64_tr_b16 v[112:113], v68 offset:9224
  ds_read_b64_tr_b16 v[114:115], v68 offset:9608
  ds_read_b64_tr_b16 v[116:117], v69 offset:9216
  ds_read_b64_tr_b16 v[118:119], v69 offset:9600
  ds_read_b64_tr_b16 v[120:121], v68 offset:12288
  ds_read_b64_tr_b16 v[122:123], v68 offset:12672
  ds_read_b64_tr_b16 v[124:125], v68 offset:12296
  ds_read_b64_tr_b16 v[126:127], v68 offset:12680
  ds_read_b64_tr_b16 v[128:129], v69 offset:12288
  ds_read_b64_tr_b16 v[130:131], v69 offset:12672
  ds_read_b64_tr_b16 v[132:133], v68 offset:15360
  ds_read_b64_tr_b16 v[134:135], v68 offset:15744
  ds_read_b64_tr_b16 v[136:137], v68 offset:15368
  ds_read_b64_tr_b16 v[138:139], v68 offset:15752
  ds_read_b64_tr_b16 v[140:141], v69 offset:15360
  ds_read_b64_tr_b16 v[142:143], v69 offset:15744
  s_waitcnt lgkmcnt(0)
  s_barrier
  s_cmp_lg_u32 s20, 0
  s_cbranch_scc1 ic_11
  v_mov_b32 v68, 64
  v_mov_b32 v69, 1
  s_mov_b64 exec, 1
  buffer_atomic_add v69, v68, s[32:35], 0 offen sc1
  s_mov_b64 exec, -1
ic_11:
  s_add_u32 m0, s81, 0
  s_nop 0
  buffer_load_dwordx4 v48, s[12:15], s80 offen lds
  s_add_u32 m0, s81, 1024
  s_nop 0
  buffer_load_dwordx4 v49, s[12:15], s80 offen lds
  s_add_u32 m0, s81, 2048
  s_nop 0
  buffer_load_dwordx4 v50, s[12:15], s80 offen lds
  s_add_u32 m0, s81, 3072
  s_nop 0
  buffer_load_dwordx4 v51, s[12:15], s80 offen lds
  s_add_u32 m0, s81, 4096
  s_nop 0
  buffer_load_dwordx4 v52, s[12:15], s80 offen lds
  s_add_u32 m0, s81, 5120
  s_nop 0
  buffer_load_dwordx4 v53, s[12:15], s80 offen lds
  s_add_u32 m0, s81, 6144
  s_nop 0
  buffer_load_dwordx4 v54, s[12:15], s80 offen lds
  s_add_u32 m0, s81, 7168
  s_nop 0
  buffer_load_dwordx4 v55, s[12:15], s80 offen lds
  s_add_u32 m0, s81, 8192
  s_nop 0
  buffer_load_dwordx4 v56, s[12:15], s80 offen lds
  s_add_u32 m0, s81, 9216
  s_nop 0
  buffer_load_dwordx4 v57, s[12:15], s80 offen lds
  s_add_u32 m0, s81, 10240
  s_nop 0
  buffer_load_dwordx4 v58, s[12:15], s80 offen lds
  s_add_u32 m0, s81, 11264
  s_nop 0
  buffer_load_dwordx4 v59, s[12:15], s80 offen lds
  s_add_u32 s80, s80, 393216
  ds_read_b128 v[208:211], v70 offset:24576
  ds_read_b128 v[212:215], v71 offset:24576
  ds_read_b128 v[216:219], v70 offset:24704
  s_waitcnt lgkmcnt(2)
  v_mfma_f32_16x16x32_bf16 v[184:187], v[208:211], v[72:75], 0
  ds_read_b128 v[220:223], v71 offset:24704
  v_mfma_f32_16x16x32_bf16 v[188:191], v[208:211], v[76:79], 0
  s_add_u32 m0, s81, 12288
  s_nop 0
  buffer_load_dwordx4 v48, s[12:15], s80 offen lds
  v_mfma_f32_16x16x32_bf16 v[192:195], v[208:211], v[80:83], 0
  s_waitcnt lgkmcnt(2)
  v_mfma_f32_16x16x32_bf16 v[184:187], v[212:215], v[84:87], v[184:187]
  ds_read_b128 v[208:211], v70 offset:24832
  v_mfma_f32_16x16x32_bf16 v[188:191], v[212:215], v[88:91], v[188:191]
  s_add_u32 m0, s81, 13312
  s_nop 0
  buffer_load_dwordx4 v49, s[12:15], s80 offen lds
  v_mfma_f32_16x16x32_bf16 v[192:195], v[212:215], v[92:95], v[192:195]
  s_waitcnt lgkmcnt(2)
  v_mfma_f32_16x16x32_bf16 v[184:187], v[216:219], v[96:99], v[184:187]
  ds_read_b128 v[212:215], v71 offset:24832
  v_mfma_f32_16x16x32_bf16 v[188:191], v[216:219], v[100:103], v[188:191]
  s_add_u32 m0, s81, 14336
  s_nop 0
  buffer_load_dwordx4 v50, s[12:15], s80 offen lds
  v_mfma_f32_16x16x32_bf16 v[192:195], v[216:219], v[104:107], v[192:195]
  s_waitcnt lgkmcnt(2)
  v_mfma_f32_16x16x32_bf16 v[184:187], v[220:223], v[108:111], v[184:187]
  ds_read_b128 v[216:219], v70 offset:25344
  v_mfma_f32_16x16x32_bf16 v[188:191], v[220:223], v[112:115], v[188:191]
  s_add_u32 m0, s81, 15360
  s_nop 0
  buffer_load_dwordx4 v51, s[12:15], s80 offen lds
  v_mfma_f32_16x16x32_bf16 v[192:195], v[220:223], v[116:119], v[192:195]
  s_waitcnt lgkmcnt(2)
  v_mfma_f32_16x16x32_bf16 v[184:187], v[208:211], v[120:123], v[184:187]
  ds_read_b128 v[220:223], v71 offset:25344
  v_mfma_f32_16x16x32_bf16 v[188:191], v[208:211], v[124:127], v[188:191]
  s_add_u32 m0, s81, 16384
  s_nop 0
  buffer_load_dwordx4 v52, s[12:15], s80 offen lds
  v_mfma_f32_16x16x32_bf16 v[192:195], v[208:211], v[128:131], v[192:195]
  s_waitcnt lgkmcnt(2)
  v_mfma_f32_16x16x32_bf16 v[184:187], v[212:215], v[132:135], v[184:187]
  ds_read_b128 v[208:211], v70 offset:25472
  v_mfma_f32_16x16x32_bf16 v[188:191], v[212:215], v[136:139], v[188:191]
  s_add_u32 m0, s81, 17408
  s_nop 0
  buffer_load_dwordx4 v53, s[12:15], s80 offen lds
  v_mfma_f32_16x16x32_bf16 v[192:195], v[212:215], v[140:143], v[192:195]
  s_waitcnt lgkmcnt(2)
  v_mfma_f32_16x16x32_bf16 v[196:199], v[216:219], v[72:75], 0
  ds_read_b128 v[212:215], v71 offset:25472
  v_mfma_f32_16x16x32_bf16 v[200:203], v[216:219], v[76:79], 0
  s_add_u32 m0, s81, 18432
  s_nop 0
  buffer_load_dwordx4 v54, s[12:15], s80 offen lds
  v_mfma_f32_16x16x32_bf16 v[204:207], v[216:219], v[80:83], 0
  s_waitcnt lgkmcnt(2)
  v_mfma_f32_16x16x32_bf16 v[196:199], v[220:223], v[84:87], v[196:199]
  ds_read_b128 v[216:219], v70 offset:25600
  v_cvt_pk_bf16_f32 v248, v184, v185
  v_mfma_f32_16x16x32_bf16 v[200:203], v[220:223], v[88:91], v[200:203]
  s_add_u32 m0, s81, 19456
  s_nop 0
  buffer_load_dwordx4 v55, s[12:15], s80 offen lds
  v_mfma_f32_16x16x32_bf16 v[204:207], v[220:223], v[92:95], v[204:207]
  v_cvt_pk_bf16_f32 v249, v186, v187
  s_waitcnt lgkmcnt(2)
  v_mfma_f32_16x16x32_bf16 v[196:199], v[208:211], v[96:99], v[196:199]
  ds_read_b128 v[220:223], v71 offset:25600
  v_cvt_pk_bf16_f32 v250, v188, v189
  v_mfma_f32_16x16x32_bf16 v[200:203], v[208:211], v[100:103], v[200:203]
  s_add_u32 m0, s81, 20480
  s_nop 0
  buffer_load_dwordx4 v56, s[12:15], s80 offen lds
  v_mfma_f32_16x16x32_bf16 v[204:207], v[208:211], v[104:107], v[204:207]
  v_cvt_pk_bf16_f32 v251, v190, v191
  s_waitcnt lgkmcnt(2)
  v_mfma_f32_16x16x32_bf16 v[196:199], v[212:215], v[108:111], v[196:199]
  v_accvgpr_write_b32 a0, v248
  v_mfma_f32_16x16x32_bf16 v[200:203], v[212:215], v[112:115], v[200:203]
  s_add_u32 m0, s81, 21504
  s_nop 0
  buffer_load_dwordx4 v57, s[12:15], s80 offen lds
  v_mfma_f32_16x16x32_bf16 v[204:207], v[212:215], v[116:119], v[204:207]
  v_accvgpr_write_b32 a1, v249
  s_waitcnt lgkmcnt(1)
  v_mfma_f32_16x16x32_bf16 v[196:199], v[216:219], v[120:123], v[196:199]
  v_accvgpr_write_b32 a80, v250
  v_mfma_f32_16x16x32_bf16 v[200:203], v[216:219], v[124:127], v[200:203]
  s_add_u32 m0, s81, 22528
  s_nop 0
  buffer_load_dwordx4 v58, s[12:15], s80 offen lds
  v_mfma_f32_16x16x32_bf16 v[204:207], v[216:219], v[128:131], v[204:207]
  v_accvgpr_write_b32 a81, v251
  s_waitcnt lgkmcnt(0)
  v_mfma_f32_16x16x32_bf16 v[196:199], v[220:223], v[132:135], v[196:199]
  v_cvt_pk_bf16_f32 v144, v192, v193
  v_cvt_pk_bf16_f32 v145, v194, v195
  v_mfma_f32_16x16x32_bf16 v[200:203], v[220:223], v[136:139], v[200:203]
  s_add_u32 m0, s81, 23552
  s_nop 0
  buffer_load_dwordx4 v59, s[12:15], s80 offen lds
  s_add_u32 s80, s80, 393216
  v_mfma_f32_16x16x32_bf16 v[204:207], v[220:223], v[140:143], v[204:207]
  s_add_u32 s21, s79, 0
  buffer_load_dwordx4 a[160:163], v63, s[24:27], s21 offen
  s_add_u32 s21, s79, 0
  buffer_load_dwordx4 a[164:167], v64, s[24:27], s21 offen
  s_waitcnt vmcnt(14)
  ds_read_b128 v[208:211], v70 offset:0
  ds_read_b128 v[212:215], v71 offset:0
  ds_read_b128 v[216:219], v70 offset:128
  s_waitcnt lgkmcnt(2)
  v_mfma_f32_16x16x32_bf16 v[184:187], v[208:211], v[72:75], 0
  ds_read_b128 v[220:223], v71 offset:128
  v_mfma_f32_16x16x32_bf16 v[188:191], v[208:211], v[76:79], 0
  s_add_u32 m0, s81, 24576
  s_nop 0
  buffer_load_dwordx4 v48, s[12:15], s80 offen lds
  v_mfma_f32_16x16x32_bf16 v[192:195], v[208:211], v[80:83], 0
  s_waitcnt lgkmcnt(2)
  v_mfma_f32_16x16x32_bf16 v[184:187], v[212:215], v[84:87], v[184:187]
  ds_read_b128 v[208:211], v70 offset:256
  v_cvt_pk_bf16_f32 v248, v196, v197
  v_mfma_f32_16x16x32_bf16 v[188:191], v[212:215], v[88:91], v[188:191]
  s_add_u32 m0, s81, 25600
  s_nop 0
  buffer_load_dwordx4 v49, s[12:15], s80 offen lds
  v_mfma_f32_16x16x32_bf16 v[192:195], v[212:215], v[92:95], v[192:195]
  v_cvt_pk_bf16_f32 v249, v198, v199
  s_waitcnt lgkmcnt(2)
  v_mfma_f32_16x16x32_bf16 v[184:187], v[216:219], v[96:99], v[184:187]
  ds_read_b128 v[212:215], v71 offset:256
  v_cvt_pk_bf16_f32 v250, v200, v201
  v_mfma_f32_16x16x32_bf16 v[188:191], v[216:219], v[100:103], v[188:191]
  s_add_u32 m0, s81, 26624
  s_nop 0
  buffer_load_dwordx4 v50, s[12:15], s80 offen lds
  v_mfma_f32_16x16x32_bf16 v[192:195], v[216:219], v[104:107], v[192:195]
  v_cvt_pk_bf16_f32 v251, v202, v203
  s_waitcnt lgkmcnt(2)
  v_mfma_f32_16x16x32_bf16 v[184:187], v[220:223], v[108:111], v[184:187]
  ds_read_b128 v[216:219], v70 offset:768
  v_accvgpr_write_b32 a2, v248
  v_mfma_f32_16x16x32_bf16 v[188:191], v[220:223], v[112:115], v[188:191]
  s_add_u32 m0, s81, 27648
  s_nop 0
  buffer_load_dwordx4 v51, s[12:15], s80 offen lds
  v_mfma_f32_16x16x32_bf16 v[192:195], v[220:223], v[116:119], v[192:195]
  v_accvgpr_write_b32 a3, v249
  s_waitcnt lgkmcnt(2)
  v_mfma_f32_16x16x32_bf16 v[184:187], v[208:211], v[120:123], v[184:187]
  ds_read_b128 v[220:223], v71 offset:768
  v_accvgpr_write_b32 a82, v250
  v_mfma_f32_16x16x32_bf16 v[188:191], v[208:211], v[124:127], v[188:191]
  s_add_u32 m0, s81, 28672
  s_nop 0
  buffer_load_dwordx4 v52, s[12:15], s80 offen lds
  v_mfma_f32_16x16x32_bf16 v[192:195], v[208:211], v[128:131], v[192:195]
  v_accvgpr_write_b32 a83, v251
  s_waitcnt lgkmcnt(2)
  v_mfma_f32_16x16x32_bf16 v[184:187], v[212:215], v[132:135], v[184:187]
  ds_read_b128 v[208:211], v70 offset:896
  s_mov_b64 exec, s[68:69]
  v_cvt_pk_bf16_f32 v144, v204, v205
  v_cvt_pk_bf16_f32 v145, v206, v207
  s_mov_b64 exec, -1
  v_mfma_f32_16x16x32_bf16 v[188:191], v[212:215], v[136:139], v[188:191]
  s_add_u32 m0, s81, 29696
  s_nop 0
  buffer_load_dwordx4 v53, s[12:15], s80 offen lds
  v_mfma_f32_16x16x32_bf16 v[192:195], v[212:215], v[140:143], v[192:195]
  s_waitcnt lgkmcnt(2)
  v_mfma_f32_16x16x32_bf16 v[196:199], v[216:219], v[72:75], 0
  ds_read_b128 v[212:215], v71 offset:896
  v_mfma_f32_16x16x32_bf16 v[200:203], v[216:219], v[76:79], 0
  s_add_u32 m0, s81, 30720
  s_nop 0
  buffer_load_dwordx4 v54, s[12:15], s80 offen lds
  v_mfma_f32_16x16x32_bf16 v[204:207], v[216:219], v[80:83], 0
  s_waitcnt lgkmcnt(2)
  v_mfma_f32_16x16x32_bf16 v[196:199], v[220:223], v[84:87], v[196:199]
  ds_read_b128 v[216:219], v70 offset:1024
  v_cvt_pk_bf16_f32 v248, v184, v185
  v_mfma_f32_16x16x32_bf16 v[200:203], v[220:223], v[88:91], v[200:203]
  s_add_u32 m0, s81, 31744
  s_nop 0
  buffer_load_dwordx4 v55, s[12:15], s80 offen lds
  v_mfma_f32_16x16x32_bf16 v[204:207], v[220:223], v[92:95], v[204:207]
  v_cvt_pk_bf16_f32 v249, v186, v187
  s_waitcnt lgkmcnt(2)
  v_mfma_f32_16x16x32_bf16 v[196:199], v[208:211], v[96:99], v[196:199]
  ds_read_b128 v[220:223], v71 offset:1024
  v_cvt_pk_bf16_f32 v250, v188, v189
  v_mfma_f32_16x16x32_bf16 v[200:203], v[208:211], v[100:103], v[200:203]
  s_add_u32 m0, s81, 32768
  s_nop 0
  buffer_load_dwordx4 v56, s[12:15], s80 offen lds
  v_mfma_f32_16x16x32_bf16 v[204:207], v[208:211], v[104:107], v[204:207]
  v_cvt_pk_bf16_f32 v251, v190, v191
  s_waitcnt lgkmcnt(2)
  v_mfma_f32_16x16x32_bf16 v[196:199], v[212:215], v[108:111], v[196:199]
  v_accvgpr_write_b32 a4, v248
  v_mfma_f32_16x16x32_bf16 v[200:203], v[212:215], v[112:115], v[200:203]
  s_add_u32 m0, s81, 33792
  s_nop 0
  buffer_load_dwordx4 v57, s[12:15], s80 offen lds
  v_mfma_f32_16x16x32_bf16 v[204:207], v[212:215], v[116:119], v[204:207]
  v_accvgpr_write_b32 a5, v249
  s_waitcnt lgkmcnt(1)
  v_mfma_f32_16x16x32_bf16 v[196:199], v[216:219], v[120:123], v[196:199]
  v_accvgpr_write_b32 a84, v250
  v_mfma_f32_16x16x32_bf16 v[200:203], v[216:219], v[124:127], v[200:203]
  s_add_u32 m0, s81, 34816
  s_nop 0
  buffer_load_dwordx4 v58, s[12:15], s80 offen lds
  v_mfma_f32_16x16x32_bf16 v[204:207], v[216:219], v[128:131], v[204:207]
  v_accvgpr_write_b32 a85, v251
  s_waitcnt lgkmcnt(0)
  v_mfma_f32_16x16x32_bf16 v[196:199], v[220:223], v[132:135], v[196:199]
  v_cvt_pk_bf16_f32 v146, v192, v193
  v_cvt_pk_bf16_f32 v147, v194, v195
  v_mfma_f32_16x16x32_bf16 v[200:203], v[220:223], v[136:139], v[200:203]
  s_add_u32 m0, s81, 35840
  s_nop 0
  buffer_load_dwordx4 v59, s[12:15], s80 offen lds
  s_add_u32 s80, s80, 393216
  v_mfma_f32_16x16x32_bf16 v[204:207], v[220:223], v[140:143], v[204:207]
  s_add_u32 s21, s79, 0
  buffer_load_dwordx4 a[168:171], v65, s[24:27], s21 offen
  s_add_u32 s21, s79, 393216
  buffer_load_dwordx4 a[172:175], v63, s[24:27], s21 offen
  s_waitcnt vmcnt(16)
  ds_read_b128 v[208:211], v70 offset:12288
  ds_read_b128 v[212:215], v71 offset:12288
  ds_read_b128 v[216:219], v70 offset:12416
  s_waitcnt lgkmcnt(2)
  v_mfma_f32_16x16x32_bf16 v[184:187], v[208:211], v[72:75], 0
  ds_read_b128 v[220:223], v71 offset:12416
  v_mfma_f32_16x16x32_bf16 v[188:191], v[208:211], v[76:79], 0
  s_add_u32 m0, s81, 0
  s_nop 0
  buffer_load_dwordx4 v48, s[12:15], s80 offen lds
  v_mfma_f32_16x16x32_bf16 v[192:195], v[208:211], v[80:83], 0
  s_waitcnt lgkmcnt(2)
  v_mfma_f32_16x16x32_bf16 v[184:187], v[212:215], v[84:87], v[184:187]
  ds_read_b128 v[208:211], v70 offset:12544
  v_cvt_pk_bf16_f32 v248, v196, v197
  v_mfma_f32_16x16x32_bf16 v[188:191], v[212:215], v[88:91], v[188:191]
  s_add_u32 m0, s81, 1024
  s_nop 0
  buffer_load_dwordx4 v49, s[12:15], s80 offen lds
  v_mfma_f32_16x16x32_bf16 v[192:195], v[212:215], v[92:95], v[192:195]
  v_cvt_pk_bf16_f32 v249, v198, v199
  s_waitcnt lgkmcnt(2)
  v_mfma_f32_16x16x32_bf16 v[184:187], v[216:219], v[96:99], v[184:187]
  ds_read_b128 v[212:215], v71 offset:12544
  v_cvt_pk_bf16_f32 v250, v200, v201
  v_mfma_f32_16x16x32_bf16 v[188:191], v[216:219], v[100:103], v[188:191]
  s_add_u32 m0, s81, 2048
  s_nop 0
  buffer_load_dwordx4 v50, s[12:15], s80 offen lds
  v_mfma_f32_16x16x32_bf16 v[192:195], v[216:219], v[104:107], v[192:195]
  v_cvt_pk_bf16_f32 v251, v202, v203
  s_waitcnt lgkmcnt(2)
  v_mfma_f32_16x16x32_bf16 v[184:187], v[220:223], v[108:111], v[184:187]
  ds_read_b128 v[216:219], v70 offset:13056
  v_accvgpr_write_b32 a6, v248
  v_mfma_f32_16x16x32_bf16 v[188:191], v[220:223], v[112:115], v[188:191]
  s_add_u32 m0, s81, 3072
  s_nop 0
  buffer_load_dwordx4 v51, s[12:15], s80 offen lds
  v_mfma_f32_16x16x32_bf16 v[192:195], v[220:223], v[116:119], v[192:195]
  v_accvgpr_write_b32 a7, v249
  s_waitcnt lgkmcnt(2)
  v_mfma_f32_16x16x32_bf16 v[184:187], v[208:211], v[120:123], v[184:187]
  ds_read_b128 v[220:223], v71 offset:13056
  v_accvgpr_write_b32 a86, v250
  v_mfma_f32_16x16x32_bf16 v[188:191], v[208:211], v[124:127], v[188:191]
  s_add_u32 m0, s81, 4096
  s_nop 0
  buffer_load_dwordx4 v52, s[12:15], s80 offen lds
  v_mfma_f32_16x16x32_bf16 v[192:195], v[208:211], v[128:131], v[192:195]
  v_accvgpr_write_b32 a87, v251
  s_waitcnt lgkmcnt(2)
  v_mfma_f32_16x16x32_bf16 v[184:187], v[212:215], v[132:135], v[184:187]
  ds_read_b128 v[208:211], v70 offset:13184
  s_mov_b64 exec, s[68:69]
  v_cvt_pk_bf16_f32 v146, v204, v205
  v_cvt_pk_bf16_f32 v147, v206, v207
  s_mov_b64 exec, -1
  v_mfma_f32_16x16x32_bf16 v[188:191], v[212:215], v[136:139], v[188:191]
  s_add_u32 m0, s81, 5120
  s_nop 0
  buffer_load_dwordx4 v53, s[12:15], s80 offen lds
  v_mfma_f32_16x16x32_bf16 v[192:195], v[212:215], v[140:143], v[192:195]
  s_waitcnt lgkmcnt(2)
  v_mfma_f32_16x16x32_bf16 v[196:199], v[216:219], v[72:75], 0
  ds_read_b128 v[212:215], v71 offset:13184
  v_mfma_f32_16x16x32_bf16 v[200:203], v[216:219], v[76:79], 0
  s_add_u32 m0, s81, 6144
  s_nop 0
  buffer_load_dwordx4 v54, s[12:15], s80 offen lds
  v_mfma_f32_16x16x32_bf16 v[204:207], v[216:219], v[80:83], 0
  s_waitcnt lgkmcnt(2)
  v_mfma_f32_16x16x32_bf16 v[196:199], v[220:223], v[84:87], v[196:199]
  ds_read_b128 v[216:219], v70 offset:13312
  v_cvt_pk_bf16_f32 v248, v184, v185
  v_mfma_f32_16x16x32_bf16 v[200:203], v[220:223], v[88:91], v[200:203]
  s_add_u32 m0, s81, 7168
  s_nop 0
  buffer_load_dwordx4 v55, s[12:15], s80 offen lds
  v_mfma_f32_16x16x32_bf16 v[204:207], v[220:223], v[92:95], v[204:207]
  v_cvt_pk_bf16_f32 v249, v186, v187
  s_waitcnt lgkmcnt(2)
  v_mfma_f32_16x16x32_bf16 v[196:199], v[208:211], v[96:99], v[196:199]
  ds_read_b128 v[220:223], v71 offset:13312
  v_cvt_pk_bf16_f32 v250, v188, v189
  v_mfma_f32_16x16x32_bf16 v[200:203], v[208:211], v[100:103], v[200:203]
  s_add_u32 m0, s81, 8192
  s_nop 0
  buffer_load_dwordx4 v56, s[12:15], s80 offen lds
  v_mfma_f32_16x16x32_bf16 v[204:207], v[208:211], v[104:107], v[204:207]
  v_cvt_pk_bf16_f32 v251, v190, v191
  s_waitcnt lgkmcnt(2)
  v_mfma_f32_16x16x32_bf16 v[196:199], v[212:215], v[108:111], v[196:199]
  v_accvgpr_write_b32 a8, v248
  v_mfma_f32_16x16x32_bf16 v[200:203], v[212:215], v[112:115], v[200:203]
  s_add_u32 m0, s81, 9216
  s_nop 0
  buffer_load_dwordx4 v57, s[12:15], s80 offen lds
  v_mfma_f32_16x16x32_bf16 v[204:207], v[212:215], v[116:119], v[204:207]
  v_accvgpr_write_b32 a9, v249
  s_waitcnt lgkmcnt(1)
  v_mfma_f32_16x16x32_bf16 v[196:199], v[216:219], v[120:123], v[196:199]
  v_accvgpr_write_b32 a88, v250
  v_mfma_f32_16x16x32_bf16 v[200:203], v[216:219], v[124:127], v[200:203]
  s_add_u32 m0, s81, 10240
  s_nop 0
  buffer_load_dwordx4 v58, s[12:15], s80 offen lds
  v_mfma_f32_16x16x32_bf16 v[204:207], v[216:219], v[128:131], v[204:207]
  v_accvgpr_write_b32 a89, v251
  s_waitcnt lgkmcnt(0)
  v_mfma_f32_16x16x32_bf16 v[196:199], v[220:223], v[132:135], v[196:199]
  v_cvt_pk_bf16_f32 v148, v192, v193
  v_cvt_pk_bf16_f32 v149, v194, v195
  v_mfma_f32_16x16x32_bf16 v[200:203], v[220:223], v[136:139], v[200:203]
  s_add_u32 m0, s81, 11264
  s_nop 0
  buffer_load_dwordx4 v59, s[12:15], s80 offen lds
  s_add_u32 s80, s80, 393216
  v_mfma_f32_16x16x32_bf16 v[204:207], v[220:223], v[140:143], v[204:207]
  s_add_u32 s21, s79, 393216
  buffer_load_dwordx4 a[176:179], v64, s[24:27], s21 offen
  s_add_u32 s21, s79, 393216
  buffer_load_dwordx4 a[180:183], v65, s[24:27], s21 offen
  s_waitcnt vmcnt(16)
  ds_read_b128 v[208:211], v70 offset:24576
  ds_read_b128 v[212:215], v71 offset:24576
  ds_read_b128 v[216:219], v70 offset:24704
  s_waitcnt lgkmcnt(2)
  v_mfma_f32_16x16x32_bf16 v[184:187], v[208:211], v[72:75], 0
  ds_read_b128 v[220:223], v71 offset:24704
  v_mfma_f32_16x16x32_bf16 v[188:191], v[208:211], v[76:79], 0
  s_add_u32 m0, s81, 12288
  s_nop 0
  buffer_load_dwordx4 v48, s[12:15], s80 offen lds
  v_mfma_f32_16x16x32_bf16 v[192:195], v[208:211], v[80:83], 0
  s_waitcnt lgkmcnt(2)
  v_mfma_f32_16x16x32_bf16 v[184:187], v[212:215], v[84:87], v[184:187]
  ds_read_b128 v[208:211], v70 offset:24832
  v_cvt_pk_bf16_f32 v248, v196, v197
  v_mfma_f32_16x16x32_bf16 v[188:191], v[212:215], v[88:91], v[188:191]
  s_add_u32 m0, s81, 13312
  s_nop 0
  buffer_load_dwordx4 v49, s[12:15], s80 offen lds
  v_mfma_f32_16x16x32_bf16 v[192:195], v[212:215], v[92:95], v[192:195]
  v_cvt_pk_bf16_f32 v249, v198, v199
  s_waitcnt lgkmcnt(2)
  v_mfma_f32_16x16x32_bf16 v[184:187], v[216:219], v[96:99], v[184:187]
  ds_read_b128 v[212:215], v71 offset:24832
  v_cvt_pk_bf16_f32 v250, v200, v201
  v_mfma_f32_16x16x32_bf16 v[188:191], v[216:219], v[100:103], v[188:191]
  s_add_u32 m0, s81, 14336
  s_nop 0
  buffer_load_dwordx4 v50, s[12:15], s80 offen lds
  v_mfma_f32_16x16x32_bf16 v[192:195], v[216:219], v[104:107], v[192:195]
  v_cvt_pk_bf16_f32 v251, v202, v203
  s_waitcnt lgkmcnt(2)
  v_mfma_f32_16x16x32_bf16 v[184:187], v[220:223], v[108:111], v[184:187]
  ds_read_b128 v[216:219], v70 offset:25344
  v_accvgpr_write_b32 a10, v248
  v_mfma_f32_16x16x32_bf16 v[188:191], v[220:223], v[112:115], v[188:191]
  s_add_u32 m0, s81, 15360
  s_nop 0
  buffer_load_dwordx4 v51, s[12:15], s80 offen lds
  v_mfma_f32_16x16x32_bf16 v[192:195], v[220:223], v[116:119], v[192:195]
  v_accvgpr_write_b32 a11, v249
  s_waitcnt lgkmcnt(2)
  v_mfma_f32_16x16x32_bf16 v[184:187], v[208:211], v[120:123], v[184:187]
  ds_read_b128 v[220:223], v71 offset:25344
  v_accvgpr_write_b32 a90, v250
  v_mfma_f32_16x16x32_bf16 v[188:191], v[208:211], v[124:127], v[188:191]
  s_add_u32 m0, s81, 16384
  s_nop 0
  buffer_load_dwordx4 v52, s[12:15], s80 offen lds
  v_mfma_f32_16x16x32_bf16 v[192:195], v[208:211], v[128:131], v[192:195]
  v_accvgpr_write_b32 a91, v251
  s_waitcnt lgkmcnt(2)
  v_mfma_f32_16x16x32_bf16 v[184:187], v[212:215], v[132:135], v[184:187]
  ds_read_b128 v[208:211], v70 offset:25472
  s_mov_b64 exec, s[68:69]
  v_cvt_pk_bf16_f32 v148, v204, v205
  v_cvt_pk_bf16_f32 v149, v206, v207
  s_mov_b64 exec, -1
  v_mfma_f32_16x16x32_bf16 v[188:191], v[212:215], v[136:139], v[188:191]
  s_add_u32 m0, s81, 17408
  s_nop 0
  buffer_load_dwordx4 v53, s[12:15], s80 offen lds
  v_mfma_f32_16x16x32_bf16 v[192:195], v[212:215], v[140:143], v[192:195]
  s_waitcnt lgkmcnt(2)
  v_mfma_f32_16x16x32_bf16 v[196:199], v[216:219], v[72:75], 0
  ds_read_b128 v[212:215], v71 offset:25472
  v_mfma_f32_16x16x32_bf16 v[200:203], v[216:219], v[76:79], 0
  s_add_u32 m0, s81, 18432
  s_nop 0
  buffer_load_dwordx4 v54, s[12:15], s80 offen lds
  v_mfma_f32_16x16x32_bf16 v[204:207], v[216:219], v[80:83], 0
  s_waitcnt lgkmcnt(2)
  v_mfma_f32_16x16x32_bf16 v[196:199], v[220:223], v[84:87], v[196:199]
  ds_read_b128 v[216:219], v70 offset:25600
  v_cvt_pk_bf16_f32 v248, v184, v185
  v_mfma_f32_16x16x32_bf16 v[200:203], v[220:223], v[88:91], v[200:203]
  s_add_u32 m0, s81, 19456
  s_nop 0
  buffer_load_dwordx4 v55, s[12:15], s80 offen lds
  v_mfma_f32_16x16x32_bf16 v[204:207], v[220:223], v[92:95], v[204:207]
  v_cvt_pk_bf16_f32 v249, v186, v187
  s_waitcnt lgkmcnt(2)
  v_mfma_f32_16x16x32_bf16 v[196:199], v[208:211], v[96:99], v[196:199]
  ds_read_b128 v[220:223], v71 offset:25600
  v_cvt_pk_bf16_f32 v250, v188, v189
  v_mfma_f32_16x16x32_bf16 v[200:203], v[208:211], v[100:103], v[200:203]
  s_add_u32 m0, s81, 20480
  s_nop 0
  buffer_load_dwordx4 v56, s[12:15], s80 offen lds
  v_mfma_f32_16x16x32_bf16 v[204:207], v[208:211], v[104:107], v[204:207]
  v_cvt_pk_bf16_f32 v251, v190, v191
  s_waitcnt lgkmcnt(2)
  v_mfma_f32_16x16x32_bf16 v[196:199], v[212:215], v[108:111], v[196:199]
  v_accvgpr_write_b32 a12, v248
  v_mfma_f32_16x16x32_bf16 v[200:203], v[212:215], v[112:115], v[200:203]
  s_add_u32 m0, s81, 21504
  s_nop 0
  buffer_load_dwordx4 v57, s[12:15], s80 offen lds
  v_mfma_f32_16x16x32_bf16 v[204:207], v[212:215], v[116:119], v[204:207]
  v_accvgpr_write_b32 a13, v249
  s_waitcnt lgkmcnt(1)
  v_mfma_f32_16x16x32_bf16 v[196:199], v[216:219], v[120:123], v[196:199]
  v_accvgpr_write_b32 a92, v250
  v_mfma_f32_16x16x32_bf16 v[200:203], v[216:219], v[124:127], v[200:203]
  s_add_u32 m0, s81, 22528
  s_nop 0
  buffer_load_dwordx4 v58, s[12:15], s80 offen lds
  v_mfma_f32_16x16x32_bf16 v[204:207], v[216:219], v[128:131], v[204:207]
  v_accvgpr_write_b32 a93, v251
  s_waitcnt lgkmcnt(0)
  v_mfma_f32_16x16x32_bf16 v[196:199], v[220:223], v[132:135], v[196:199]
  v_cvt_pk_bf16_f32 v150, v192, v193
  v_cvt_pk_bf16_f32 v151, v194, v195
  v_mfma_f32_16x16x32_bf16 v[200:203], v[220:223], v[136:139], v[200:203]
  s_add_u32 m0, s81, 23552
  s_nop 0
  buffer_load_dwordx4 v59, s[12:15], s80 offen lds
  s_add_u32 s80, s80, 393216
  v_mfma_f32_16x16x32_bf16 v[204:207], v[220:223], v[140:143], v[204:207]
  s_add_u32 s21, s79, 786432
  buffer_load_dwordx4 a[184:187], v63, s[24:27], s21 offen
  s_add_u32 s21, s79, 786432
  buffer_load_dwordx4 a[188:191], v64, s[24:27], s21 offen
  s_waitcnt vmcnt(16)
  ds_read_b128 v[208:211], v70 offset:0
  ds_read_b128 v[212:215], v71 offset:0
  ds_read_b128 v[216:219], v70 offset:128
  s_waitcnt lgkmcnt(2)
  v_mfma_f32_16x16x32_bf16 v[184:187], v[208:211], v[72:75], 0
  ds_read_b128 v[220:223], v71 offset:128
  v_mfma_f32_16x16x32_bf16 v[188:191], v[208:211], v[76:79], 0
  s_add_u32 m0, s81, 24576
  s_nop 0
  buffer_load_dwordx4 v48, s[12:15], s80 offen lds
  v_mfma_f32_16x16x32_bf16 v[192:195], v[208:211], v[80:83], 0
  s_waitcnt lgkmcnt(2)
  v_mfma_f32_16x16x32_bf16 v[184:187], v[212:215], v[84:87], v[184:187]
  ds_read_b128 v[208:211], v70 offset:256
  v_cvt_pk_bf16_f32 v248, v196, v197
  v_mfma_f32_16x16x32_bf16 v[188:191], v[212:215], v[88:91], v[188:191]
  s_add_u32 m0, s81, 25600
  s_nop 0
  buffer_load_dwordx4 v49, s[12:15], s80 offen lds
  v_mfma_f32_16x16x32_bf16 v[192:195], v[212:215], v[92:95], v[192:195]
  v_cvt_pk_bf16_f32 v249, v198, v199
  s_waitcnt lgkmcnt(2)
  v_mfma_f32_16x16x32_bf16 v[184:187], v[216:219], v[96:99], v[184:187]
  ds_read_b128 v[212:215], v71 offset:256
  v_cvt_pk_bf16_f32 v250, v200, v201
  v_mfma_f32_16x16x32_bf16 v[188:191], v[216:219], v[100:103], v[188:191]
  s_add_u32 m0, s81, 26624
  s_nop 0
  buffer_load_dwordx4 v50, s[12:15], s80 offen lds
  v_mfma_f32_16x16x32_bf16 v[192:195], v[216:219], v[104:107], v[192:195]
  v_cvt_pk_bf16_f32 v251, v202, v203
  s_waitcnt lgkmcnt(2)
  v_mfma_f32_16x16x32_bf16 v[184:187], v[220:223], v[108:111], v[184:187]
  ds_read_b128 v[216:219], v70 offset:768
  v_accvgpr_write_b32 a14, v248
  v_mfma_f32_16x16x32_bf16 v[188:191], v[220:223], v[112:115], v[188:191]
  s_add_u32 m0, s81, 27648
  s_nop 0
  buffer_load_dwordx4 v51, s[12:15], s80 offen lds
  v_mfma_f32_16x16x32_bf16 v[192:195], v[220:223], v[116:119], v[192:195]
  v_accvgpr_write_b32 a15, v249
  s_waitcnt lgkmcnt(2)
  v_mfma_f32_16x16x32_bf16 v[184:187], v[208:211], v[120:123], v[184:187]
  ds_read_b128 v[220:223], v71 offset:768
  v_accvgpr_write_b32 a94, v250
  v_mfma_f32_16x16x32_bf16 v[188:191], v[208:211], v[124:127], v[188:191]
  s_add_u32 m0, s81, 28672
  s_nop 0
  buffer_load_dwordx4 v52, s[12:15], s80 offen lds
  v_mfma_f32_16x16x32_bf16 v[192:195], v[208:211], v[128:131], v[192:195]
  v_accvgpr_write_b32 a95, v251
  s_waitcnt lgkmcnt(2)
  v_mfma_f32_16x16x32_bf16 v[184:187], v[212:215], v[132:135], v[184:187]
  ds_read_b128 v[208:211], v70 offset:896
  s_mov_b64 exec, s[68:69]
  v_cvt_pk_bf16_f32 v150, v204, v205
  v_cvt_pk_bf16_f32 v151, v206, v207
  s_mov_b64 exec, -1
  v_mfma_f32_16x16x32_bf16 v[188:191], v[212:215], v[136:139], v[188:191]
  s_add_u32 m0, s81, 29696
  s_nop 0
  buffer_load_dwordx4 v53, s[12:15], s80 offen lds
  v_mfma_f32_16x16x32_bf16 v[192:195], v[212:215], v[140:143], v[192:195]
  s_waitcnt lgkmcnt(2)
  v_mfma_f32_16x16x32_bf16 v[196:199], v[216:219], v[72:75], 0
  ds_read_b128 v[212:215], v71 offset:896
  v_mfma_f32_16x16x32_bf16 v[200:203], v[216:219], v[76:79], 0
  s_add_u32 m0, s81, 30720
  s_nop 0
  buffer_load_dwordx4 v54, s[12:15], s80 offen lds
  v_mfma_f32_16x16x32_bf16 v[204:207], v[216:219], v[80:83], 0
  s_waitcnt lgkmcnt(2)
  v_mfma_f32_16x16x32_bf16 v[196:199], v[220:223], v[84:87], v[196:199]
  ds_read_b128 v[216:219], v70 offset:1024
  v_cvt_pk_bf16_f32 v248, v184, v185
  v_mfma_f32_16x16x32_bf16 v[200:203], v[220:223], v[88:91], v[200:203]
  s_add_u32 m0, s81, 31744
  s_nop 0
  buffer_load_dwordx4 v55, s[12:15], s80 offen lds
  v_mfma_f32_16x16x32_bf16 v[204:207], v[220:223], v[92:95], v[204:207]
  v_cvt_pk_bf16_f32 v249, v186, v187
  s_waitcnt lgkmcnt(2)
  v_mfma_f32_16x16x32_bf16 v[196:199], v[208:211], v[96:99], v[196:199]
  ds_read_b128 v[220:223], v71 offset:1024
  v_cvt_pk_bf16_f32 v250, v188, v189
  v_mfma_f32_16x16x32_bf16 v[200:203], v[208:211], v[100:103], v[200:203]
  s_add_u32 m0, s81, 32768
  s_nop 0
  buffer_load_dwordx4 v56, s[12:15], s80 offen lds
  v_mfma_f32_16x16x32_bf16 v[204:207], v[208:211], v[104:107], v[204:207]
  v_cvt_pk_bf16_f32 v251, v190, v191
  s_waitcnt lgkmcnt(2)
  v_mfma_f32_16x16x32_bf16 v[196:199], v[212:215], v[108:111], v[196:199]
  v_accvgpr_write_b32 a16, v248
  v_mfma_f32_16x16x32_bf16 v[200:203], v[212:215], v[112:115], v[200:203]
  s_add_u32 m0, s81, 33792
  s_nop 0
  buffer_load_dwordx4 v57, s[12:15], s80 offen lds
  v_mfma_f32_16x16x32_bf16 v[204:207], v[212:215], v[116:119], v[204:207]
  v_accvgpr_write_b32 a17, v249
  s_waitcnt lgkmcnt(1)
  v_mfma_f32_16x16x32_bf16 v[196:199], v[216:219], v[120:123], v[196:199]
  v_accvgpr_write_b32 a96, v250
  v_mfma_f32_16x16x32_bf16 v[200:203], v[216:219], v[124:127], v[200:203]
  s_add_u32 m0, s81, 34816
  s_nop 0
  buffer_load_dwordx4 v58, s[12:15], s80 offen lds
  v_mfma_f32_16x16x32_bf16 v[204:207], v[216:219], v[128:131], v[204:207]
  v_accvgpr_write_b32 a97, v251
  s_waitcnt lgkmcnt(0)
  v_mfma_f32_16x16x32_bf16 v[196:199], v[220:223], v[132:135], v[196:199]
  v_cvt_pk_bf16_f32 v152, v192, v193
  v_cvt_pk_bf16_f32 v153, v194, v195
  v_mfma_f32_16x16x32_bf16 v[200:203], v[220:223], v[136:139], v[200:203]
  s_add_u32 m0, s81, 35840
  s_nop 0
  buffer_load_dwordx4 v59, s[12:15], s80 offen lds
  s_add_u32 s80, s80, 393216
  v_mfma_f32_16x16x32_bf16 v[204:207], v[220:223], v[140:143], v[204:207]
  s_add_u32 s21, s79, 786432
  buffer_load_dwordx4 a[192:195], v65, s[24:27], s21 offen
  s_add_u32 s21, s79, 1179648
  buffer_load_dwordx4 a[196:199], v63, s[24:27], s21 offen
  s_waitcnt vmcnt(16)
  ds_read_b128 v[208:211], v70 offset:12288
  ds_read_b128 v[212:215], v71 offset:12288
  ds_read_b128 v[216:219], v70 offset:12416
  s_waitcnt lgkmcnt(2)
  v_mfma_f32_16x16x32_bf16 v[184:187], v[208:211], v[72:75], 0
  ds_read_b128 v[220:223], v71 offset:12416
  v_mfma_f32_16x16x32_bf16 v[188:191], v[208:211], v[76:79], 0
  s_add_u32 m0, s81, 0
  s_nop 0
  buffer_load_dwordx4 v48, s[12:15], s80 offen lds
  v_mfma_f32_16x16x32_bf16 v[192:195], v[208:211], v[80:83], 0
  s_waitcnt lgkmcnt(2)
  v_mfma_f32_16x16x32_bf16 v[184:187], v[212:215], v[84:87], v[184:187]
  ds_read_b128 v[208:211], v70 offset:12544
  v_cvt_pk_bf16_f32 v248, v196, v197
  v_mfma_f32_16x16x32_bf16 v[188:191], v[212:215], v[88:91], v[188:191]
  s_add_u32 m0, s81, 1024
  s_nop 0
  buffer_load_dwordx4 v49, s[12:15], s80 offen lds
  v_mfma_f32_16x16x32_bf16 v[192:195], v[212:215], v[92:95], v[192:195]
  v_cvt_pk_bf16_f32 v249, v198, v199
  s_waitcnt lgkmcnt(2)
  v_mfma_f32_16x16x32_bf16 v[184:187], v[216:219], v[96:99], v[184:187]
  ds_read_b128 v[212:215], v71 offset:12544
  v_cvt_pk_bf16_f32 v250, v200, v201
  v_mfma_f32_16x16x32_bf16 v[188:191], v[216:219], v[100:103], v[188:191]
  s_add_u32 m0, s81, 2048
  s_nop 0
  buffer_load_dwordx4 v50, s[12:15], s80 offen lds
  v_mfma_f32_16x16x32_bf16 v[192:195], v[216:219], v[104:107], v[192:195]
  v_cvt_pk_bf16_f32 v251, v202, v203
  s_waitcnt lgkmcnt(2)
  v_mfma_f32_16x16x32_bf16 v[184:187], v[220:223], v[108:111], v[184:187]
  ds_read_b128 v[216:219], v70 offset:13056
  v_accvgpr_write_b32 a18, v248
  v_mfma_f32_16x16x32_bf16 v[188:191], v[220:223], v[112:115], v[188:191]
  s_add_u32 m0, s81, 3072
  s_nop 0
  buffer_load_dwordx4 v51, s[12:15], s80 offen lds
  v_mfma_f32_16x16x32_bf16 v[192:195], v[220:223], v[116:119], v[192:195]
  v_accvgpr_write_b32 a19, v249
  s_waitcnt lgkmcnt(2)
  v_mfma_f32_16x16x32_bf16 v[184:187], v[208:211], v[120:123], v[184:187]
  ds_read_b128 v[220:223], v71 offset:13056
  v_accvgpr_write_b32 a98, v250
  v_mfma_f32_16x16x32_bf16 v[188:191], v[208:211], v[124:127], v[188:191]
  s_add_u32 m0, s81, 4096
  s_nop 0
  buffer_load_dwordx4 v52, s[12:15], s80 offen lds
  v_mfma_f32_16x16x32_bf16 v[192:195], v[208:211], v[128:131], v[192:195]
  v_accvgpr_write_b32 a99, v251
  s_waitcnt lgkmcnt(2)
  v_mfma_f32_16x16x32_bf16 v[184:187], v[212:215], v[132:135], v[184:187]
  ds_read_b128 v[208:211], v70 offset:13184
  s_mov_b64 exec, s[68:69]
  v_cvt_pk_bf16_f32 v152, v204, v205
  v_cvt_pk_bf16_f32 v153, v206, v207
  s_mov_b64 exec, -1
  v_mfma_f32_16x16x32_bf16 v[188:191], v[212:215], v[136:139], v[188:191]
  s_add_u32 m0, s81, 5120
  s_nop 0
  buffer_load_dwordx4 v53, s[12:15], s80 offen lds
  v_mfma_f32_16x16x32_bf16 v[192:195], v[212:215], v[140:143], v[192:195]
  s_waitcnt lgkmcnt(2)
  v_mfma_f32_16x16x32_bf16 v[196:199], v[216:219], v[72:75], 0
  ds_read_b128 v[212:215], v71 offset:13184
  v_mfma_f32_16x16x32_bf16 v[200:203], v[216:219], v[76:79], 0
  s_add_u32 m0, s81, 6144
  s_nop 0
  buffer_load_dwordx4 v54, s[12:15], s80 offen lds
  v_mfma_f32_16x16x32_bf16 v[204:207], v[216:219], v[80:83], 0
  s_waitcnt lgkmcnt(2)
  v_mfma_f32_16x16x32_bf16 v[196:199], v[220:223], v[84:87], v[196:199]
  ds_read_b128 v[216:219], v70 offset:13312
  v_cvt_pk_bf16_f32 v248, v184, v185
  v_mfma_f32_16x16x32_bf16 v[200:203], v[220:223], v[88:91], v[200:203]
  s_add_u32 m0, s81, 7168
  s_nop 0
  buffer_load_dwordx4 v55, s[12:15], s80 offen lds
  v_mfma_f32_16x16x32_bf16 v[204:207], v[220:223], v[92:95], v[204:207]
  v_cvt_pk_bf16_f32 v249, v186, v187
  s_waitcnt lgkmcnt(2)
  v_mfma_f32_16x16x32_bf16 v[196:199], v[208:211], v[96:99], v[196:199]
  ds_read_b128 v[220:223], v71 offset:13312
  v_cvt_pk_bf16_f32 v250, v188, v189
  v_mfma_f32_16x16x32_bf16 v[200:203], v[208:211], v[100:103], v[200:203]
  s_add_u32 m0, s81, 8192
  s_nop 0
  buffer_load_dwordx4 v56, s[12:15], s80 offen lds
  v_mfma_f32_16x16x32_bf16 v[204:207], v[208:211], v[104:107], v[204:207]
  v_cvt_pk_bf16_f32 v251, v190, v191
  s_waitcnt lgkmcnt(2)
  v_mfma_f32_16x16x32_bf16 v[196:199], v[212:215], v[108:111], v[196:199]
  v_accvgpr_write_b32 a20, v248
  v_mfma_f32_16x16x32_bf16 v[200:203], v[212:215], v[112:115], v[200:203]
  s_add_u32 m0, s81, 9216
  s_nop 0
  buffer_load_dwordx4 v57, s[12:15], s80 offen lds
  v_mfma_f32_16x16x32_bf16 v[204:207], v[212:215], v[116:119], v[204:207]
  v_accvgpr_write_b32 a21, v249
  s_waitcnt lgkmcnt(1)
  v_mfma_f32_16x16x32_bf16 v[196:199], v[216:219], v[120:123], v[196:199]
  v_accvgpr_write_b32 a100, v250
  v_mfma_f32_16x16x32_bf16 v[200:203], v[216:219], v[124:127], v[200:203]
  s_add_u32 m0, s81, 10240
  s_nop 0
  buffer_load_dwordx4 v58, s[12:15], s80 offen lds
  v_mfma_f32_16x16x32_bf16 v[204:207], v[216:219], v[128:131], v[204:207]
  v_accvgpr_write_b32 a101, v251
  s_waitcnt lgkmcnt(0)
  v_mfma_f32_16x16x32_bf16 v[196:199], v[220:223], v[132:135], v[196:199]
  v_cvt_pk_bf16_f32 v154, v192, v193
  v_cvt_pk_bf16_f32 v155, v194, v195
  v_mfma_f32_16x16x32_bf16 v[200:203], v[220:223], v[136:139], v[200:203]
  s_add_u32 m0, s81, 11264
  s_nop 0
  buffer_load_dwordx4 v59, s[12:15], s80 offen lds
  s_add_u32 s80, s80, 393216
  v_mfma_f32_16x16x32_bf16 v[204:207], v[220:223], v[140:143], v[204:207]
  s_add_u32 s21, s79, 1179648
  buffer_load_dwordx4 a[200:203], v64, s[24:27], s21 offen
  s_add_u32 s21, s79, 1179648
  buffer_load_dwordx4 a[204:207], v65, s[24:27], s21 offen
  s_waitcnt vmcnt(16)
  ds_read_b128 v[208:211], v70 offset:24576
  ds_read_b128 v[212:215], v71 offset:24576
  ds_read_b128 v[216:219], v70 offset:24704
  s_waitcnt lgkmcnt(2)
  v_mfma_f32_16x16x32_bf16 v[184:187], v[208:211], v[72:75], 0
  ds_read_b128 v[220:223], v71 offset:24704
  v_mfma_f32_16x16x32_bf16 v[188:191], v[208:211], v[76:79], 0
  s_add_u32 m0, s81, 12288
  s_nop 0
  buffer_load_dwordx4 v48, s[12:15], s80 offen lds
  v_mfma_f32_16x16x32_bf16 v[192:195], v[208:211], v[80:83], 0
  s_waitcnt lgkmcnt(2)
  v_mfma_f32_16x16x32_bf16 v[184:187], v[212:215], v[84:87], v[184:187]
  ds_read_b128 v[208:211], v70 offset:24832
  v_cvt_pk_bf16_f32 v248, v196, v197
  v_mfma_f32_16x16x32_bf16 v[188:191], v[212:215], v[88:91], v[188:191]
  s_add_u32 m0, s81, 13312
  s_nop 0
  buffer_load_dwordx4 v49, s[12:15], s80 offen lds
  v_mfma_f32_16x16x32_bf16 v[192:195], v[212:215], v[92:95], v[192:195]
  v_cvt_pk_bf16_f32 v249, v198, v199
  s_waitcnt lgkmcnt(2)
  v_mfma_f32_16x16x32_bf16 v[184:187], v[216:219], v[96:99], v[184:187]
  ds_read_b128 v[212:215], v71 offset:24832
  v_cvt_pk_bf16_f32 v250, v200, v201
  v_mfma_f32_16x16x32_bf16 v[188:191], v[216:219], v[100:103], v[188:191]
  s_add_u32 m0, s81, 14336
  s_nop 0
  buffer_load_dwordx4 v50, s[12:15], s80 offen lds
  v_mfma_f32_16x16x32_bf16 v[192:195], v[216:219], v[104:107], v[192:195]
  v_cvt_pk_bf16_f32 v251, v202, v203
  s_waitcnt lgkmcnt(2)
  v_mfma_f32_16x16x32_bf16 v[184:187], v[220:223], v[108:111], v[184:187]
  ds_read_b128 v[216:219], v70 offset:25344
  v_accvgpr_write_b32 a22, v248
  v_mfma_f32_16x16x32_bf16 v[188:191], v[220:223], v[112:115], v[188:191]
  s_add_u32 m0, s81, 15360
  s_nop 0
  buffer_load_dwordx4 v51, s[12:15], s80 offen lds
  v_mfma_f32_16x16x32_bf16 v[192:195], v[220:223], v[116:119], v[192:195]
  v_accvgpr_write_b32 a23, v249
  s_waitcnt lgkmcnt(2)
  v_mfma_f32_16x16x32_bf16 v[184:187], v[208:211], v[120:123], v[184:187]
  ds_read_b128 v[220:223], v71 offset:25344
  v_accvgpr_write_b32 a102, v250
  v_mfma_f32_16x16x32_bf16 v[188:191], v[208:211], v[124:127], v[188:191]
  s_add_u32 m0, s81, 16384
  s_nop 0
  buffer_load_dwordx4 v52, s[12:15], s80 offen lds
  v_mfma_f32_16x16x32_bf16 v[192:195], v[208:211], v[128:131], v[192:195]
  v_accvgpr_write_b32 a103, v251
  s_waitcnt lgkmcnt(2)
  v_mfma_f32_16x16x32_bf16 v[184:187], v[212:215], v[132:135], v[184:187]
  ds_read_b128 v[208:211], v70 offset:25472
  s_mov_b64 exec, s[68:69]
  v_cvt_pk_bf16_f32 v154, v204, v205
  v_cvt_pk_bf16_f32 v155, v206, v207
  s_mov_b64 exec, -1
  v_mfma_f32_16x16x32_bf16 v[188:191], v[212:215], v[136:139], v[188:191]
  s_add_u32 m0, s81, 17408
  s_nop 0
  buffer_load_dwordx4 v53, s[12:15], s80 offen lds
  v_mfma_f32_16x16x32_bf16 v[192:195], v[212:215], v[140:143], v[192:195]
  s_waitcnt lgkmcnt(2)
  v_mfma_f32_16x16x32_bf16 v[196:199], v[216:219], v[72:75], 0
  ds_read_b128 v[212:215], v71 offset:25472
  v_mfma_f32_16x16x32_bf16 v[200:203], v[216:219], v[76:79], 0
  s_add_u32 m0, s81, 18432
  s_nop 0
  buffer_load_dwordx4 v54, s[12:15], s80 offen lds
  v_mfma_f32_16x16x32_bf16 v[204:207], v[216:219], v[80:83], 0
  s_waitcnt lgkmcnt(2)
  v_mfma_f32_16x16x32_bf16 v[196:199], v[220:223], v[84:87], v[196:199]
  ds_read_b128 v[216:219], v70 offset:25600
  v_cvt_pk_bf16_f32 v248, v184, v185
  v_mfma_f32_16x16x32_bf16 v[200:203], v[220:223], v[88:91], v[200:203]
  s_add_u32 m0, s81, 19456
  s_nop 0
  buffer_load_dwordx4 v55, s[12:15], s80 offen lds
  v_mfma_f32_16x16x32_bf16 v[204:207], v[220:223], v[92:95], v[204:207]
  v_cvt_pk_bf16_f32 v249, v186, v187
  s_waitcnt lgkmcnt(2)
  v_mfma_f32_16x16x32_bf16 v[196:199], v[208:211], v[96:99], v[196:199]
  ds_read_b128 v[220:223], v71 offset:25600
  v_cvt_pk_bf16_f32 v250, v188, v189
  v_mfma_f32_16x16x32_bf16 v[200:203], v[208:211], v[100:103], v[200:203]
  s_add_u32 m0, s81, 20480
  s_nop 0
  buffer_load_dwordx4 v56, s[12:15], s80 offen lds
  v_mfma_f32_16x16x32_bf16 v[204:207], v[208:211], v[104:107], v[204:207]
  v_cvt_pk_bf16_f32 v251, v190, v191
  s_waitcnt lgkmcnt(2)
  v_mfma_f32_16x16x32_bf16 v[196:199], v[212:215], v[108:111], v[196:199]
  v_accvgpr_write_b32 a24, v248
  v_mfma_f32_16x16x32_bf16 v[200:203], v[212:215], v[112:115], v[200:203]
  s_add_u32 m0, s81, 21504
  s_nop 0
  buffer_load_dwordx4 v57, s[12:15], s80 offen lds
  v_mfma_f32_16x16x32_bf16 v[204:207], v[212:215], v[116:119], v[204:207]
  v_accvgpr_write_b32 a25, v249
  s_waitcnt lgkmcnt(1)
  v_mfma_f32_16x16x32_bf16 v[196:199], v[216:219], v[120:123], v[196:199]
  v_accvgpr_write_b32 a104, v250
  v_mfma_f32_16x16x32_bf16 v[200:203], v[216:219], v[124:127], v[200:203]
  s_add_u32 m0, s81, 22528
  s_nop 0
  buffer_load_dwordx4 v58, s[12:15], s80 offen lds
  v_mfma_f32_16x16x32_bf16 v[204:207], v[216:219], v[128:131], v[204:207]
  v_accvgpr_write_b32 a105, v251
  s_waitcnt lgkmcnt(0)
  v_mfma_f32_16x16x32_bf16 v[196:199], v[220:223], v[132:135], v[196:199]
  v_cvt_pk_bf16_f32 v156, v192, v193
  v_cvt_pk_bf16_f32 v157, v194, v195
  v_mfma_f32_16x16x32_bf16 v[200:203], v[220:223], v[136:139], v[200:203]
  s_add_u32 m0, s81, 23552
  s_nop 0
  buffer_load_dwordx4 v59, s[12:15], s80 offen lds
  s_add_u32 s80, s80, 393216
  v_mfma_f32_16x16x32_bf16 v[204:207], v[220:223], v[140:143], v[204:207]
  s_add_u32 s21, s79, 1572864
  buffer_load_dwordx4 a[208:211], v63, s[24:27], s21 offen
  s_add_u32 s21, s79, 1572864
  buffer_load_dwordx4 a[212:215], v64, s[24:27], s21 offen
  s_waitcnt vmcnt(16)
  ds_read_b128 v[208:211], v70 offset:0
  ds_read_b128 v[212:215], v71 offset:0
  ds_read_b128 v[216:219], v70 offset:128
  s_waitcnt lgkmcnt(2)
  v_mfma_f32_16x16x32_bf16 v[184:187], v[208:211], v[72:75], 0
  ds_read_b128 v[220:223], v71 offset:128
  v_mfma_f32_16x16x32_bf16 v[188:191], v[208:211], v[76:79], 0
  s_add_u32 m0, s81, 24576
  s_nop 0
  buffer_load_dwordx4 v48, s[12:15], s80 offen lds
  v_mfma_f32_16x16x32_bf16 v[192:195], v[208:211], v[80:83], 0
  s_waitcnt lgkmcnt(2)
  v_mfma_f32_16x16x32_bf16 v[184:187], v[212:215], v[84:87], v[184:187]
  ds_read_b128 v[208:211], v70 offset:256
  v_cvt_pk_bf16_f32 v248, v196, v197
  v_mfma_f32_16x16x32_bf16 v[188:191], v[212:215], v[88:91], v[188:191]
  s_add_u32 m0, s81, 25600
  s_nop 0
  buffer_load_dwordx4 v49, s[12:15], s80 offen lds
  v_mfma_f32_16x16x32_bf16 v[192:195], v[212:215], v[92:95], v[192:195]
  v_cvt_pk_bf16_f32 v249, v198, v199
  s_waitcnt lgkmcnt(2)
  v_mfma_f32_16x16x32_bf16 v[184:187], v[216:219], v[96:99], v[184:187]
  ds_read_b128 v[212:215], v71 offset:256
  v_cvt_pk_bf16_f32 v250, v200, v201
  v_mfma_f32_16x16x32_bf16 v[188:191], v[216:219], v[100:103], v[188:191]
  s_add_u32 m0, s81, 26624
  s_nop 0
  buffer_load_dwordx4 v50, s[12:15], s80 offen lds
  v_mfma_f32_16x16x32_bf16 v[192:195], v[216:219], v[104:107], v[192:195]
  v_cvt_pk_bf16_f32 v251, v202, v203
  s_waitcnt lgkmcnt(2)
  v_mfma_f32_16x16x32_bf16 v[184:187], v[220:223], v[108:111], v[184:187]
  ds_read_b128 v[216:219], v70 offset:768
  v_accvgpr_write_b32 a26, v248
  v_mfma_f32_16x16x32_bf16 v[188:191], v[220:223], v[112:115], v[188:191]
  s_add_u32 m0, s81, 27648
  s_nop 0
  buffer_load_dwordx4 v51, s[12:15], s80 offen lds
  v_mfma_f32_16x16x32_bf16 v[192:195], v[220:223], v[116:119], v[192:195]
  v_accvgpr_write_b32 a27, v249
  s_waitcnt lgkmcnt(2)
  v_mfma_f32_16x16x32_bf16 v[184:187], v[208:211], v[120:123], v[184:187]
  ds_read_b128 v[220:223], v71 offset:768
  v_accvgpr_write_b32 a106, v250
  v_mfma_f32_16x16x32_bf16 v[188:191], v[208:211], v[124:127], v[188:191]
  s_add_u32 m0, s81, 28672
  s_nop 0
  buffer_load_dwordx4 v52, s[12:15], s80 offen lds
  v_mfma_f32_16x16x32_bf16 v[192:195], v[208:211], v[128:131], v[192:195]
  v_accvgpr_write_b32 a107, v251
  s_waitcnt lgkmcnt(2)
  v_mfma_f32_16x16x32_bf16 v[184:187], v[212:215], v[132:135], v[184:187]
  ds_read_b128 v[208:211], v70 offset:896
  s_mov_b64 exec, s[68:69]
  v_cvt_pk_bf16_f32 v156, v204, v205
  v_cvt_pk_bf16_f32 v157, v206, v207
  s_mov_b64 exec, -1
  v_mfma_f32_16x16x32_bf16 v[188:191], v[212:215], v[136:139], v[188:191]
  s_add_u32 m0, s81, 29696
  s_nop 0
  buffer_load_dwordx4 v53, s[12:15], s80 offen lds
  v_mfma_f32_16x16x32_bf16 v[192:195], v[212:215], v[140:143], v[192:195]
  s_waitcnt lgkmcnt(2)
  v_mfma_f32_16x16x32_bf16 v[196:199], v[216:219], v[72:75], 0
  ds_read_b128 v[212:215], v71 offset:896
  v_mfma_f32_16x16x32_bf16 v[200:203], v[216:219], v[76:79], 0
  s_add_u32 m0, s81, 30720
  s_nop 0
  buffer_load_dwordx4 v54, s[12:15], s80 offen lds
  v_mfma_f32_16x16x32_bf16 v[204:207], v[216:219], v[80:83], 0
  s_waitcnt lgkmcnt(2)
  v_mfma_f32_16x16x32_bf16 v[196:199], v[220:223], v[84:87], v[196:199]
  ds_read_b128 v[216:219], v70 offset:1024
  v_cvt_pk_bf16_f32 v248, v184, v185
  v_mfma_f32_16x16x32_bf16 v[200:203], v[220:223], v[88:91], v[200:203]
  s_add_u32 m0, s81, 31744
  s_nop 0
  buffer_load_dwordx4 v55, s[12:15], s80 offen lds
  v_mfma_f32_16x16x32_bf16 v[204:207], v[220:223], v[92:95], v[204:207]
  v_cvt_pk_bf16_f32 v249, v186, v187
  s_waitcnt lgkmcnt(2)
  v_mfma_f32_16x16x32_bf16 v[196:199], v[208:211], v[96:99], v[196:199]
  ds_read_b128 v[220:223], v71 offset:1024
  v_cvt_pk_bf16_f32 v250, v188, v189
  v_mfma_f32_16x16x32_bf16 v[200:203], v[208:211], v[100:103], v[200:203]
  s_add_u32 m0, s81, 32768
  s_nop 0
  buffer_load_dwordx4 v56, s[12:15], s80 offen lds
  v_mfma_f32_16x16x32_bf16 v[204:207], v[208:211], v[104:107], v[204:207]
  v_cvt_pk_bf16_f32 v251, v190, v191
  s_waitcnt lgkmcnt(2)
  v_mfma_f32_16x16x32_bf16 v[196:199], v[212:215], v[108:111], v[196:199]
  v_accvgpr_write_b32 a28, v248
  v_mfma_f32_16x16x32_bf16 v[200:203], v[212:215], v[112:115], v[200:203]
  s_add_u32 m0, s81, 33792
  s_nop 0
  buffer_load_dwordx4 v57, s[12:15], s80 offen lds
  v_mfma_f32_16x16x32_bf16 v[204:207], v[212:215], v[116:119], v[204:207]
  v_accvgpr_write_b32 a29, v249
  s_waitcnt lgkmcnt(1)
  v_mfma_f32_16x16x32_bf16 v[196:199], v[216:219], v[120:123], v[196:199]
  v_accvgpr_write_b32 a108, v250
  v_mfma_f32_16x16x32_bf16 v[200:203], v[216:219], v[124:127], v[200:203]
  s_add_u32 m0, s81, 34816
  s_nop 0
  buffer_load_dwordx4 v58, s[12:15], s80 offen lds
  v_mfma_f32_16x16x32_bf16 v[204:207], v[216:219], v[128:131], v[204:207]
  v_accvgpr_write_b32 a109, v251
  s_waitcnt lgkmcnt(0)
  v_mfma_f32_16x16x32_bf16 v[196:199], v[220:223], v[132:135], v[196:199]
  v_cvt_pk_bf16_f32 v158, v192, v193
  v_cvt_pk_bf16_f32 v159, v194, v195
  v_mfma_f32_16x16x32_bf16 v[200:203], v[220:223], v[136:139], v[200:203]
  s_add_u32 m0, s81, 35840
  s_nop 0
  buffer_load_dwordx4 v59, s[12:15], s80 offen lds
  s_add_u32 s80, s80, 393216
  v_mfma_f32_16x16x32_bf16 v[204:207], v[220:223], v[140:143], v[204:207]
  s_add_u32 s21, s79, 1572864
  buffer_load_dwordx4 a[216:219], v65, s[24:27], s21 offen
  s_add_u32 s21, s79, 0
  buffer_load_dwordx4 a[220:223], v63, s[28:31], s21 offen
  s_waitcnt vmcnt(16)
  ds_read_b128 v[208:211], v70 offset:12288
  ds_read_b128 v[212:215], v71 offset:12288
  ds_read_b128 v[216:219], v70 offset:12416
  s_waitcnt lgkmcnt(2)
  v_mfma_f32_16x16x32_bf16 v[184:187], v[208:211], v[72:75], 0
  ds_read_b128 v[220:223], v71 offset:12416
  v_mfma_f32_16x16x32_bf16 v[188:191], v[208:211], v[76:79], 0
  s_add_u32 m0, s81, 0
  s_nop 0
  buffer_load_dwordx4 v48, s[12:15], s80 offen lds
  v_mfma_f32_16x16x32_bf16 v[192:195], v[208:211], v[80:83], 0
  s_waitcnt lgkmcnt(2)
  v_mfma_f32_16x16x32_bf16 v[184:187], v[212:215], v[84:87], v[184:187]
  ds_read_b128 v[208:211], v70 offset:12544
  v_cvt_pk_bf16_f32 v248, v196, v197
  v_mfma_f32_16x16x32_bf16 v[188:191], v[212:215], v[88:91], v[188:191]
  s_add_u32 m0, s81, 1024
  s_nop 0
  buffer_load_dwordx4 v49, s[12:15], s80 offen lds
  v_mfma_f32_16x16x32_bf16 v[192:195], v[212:215], v[92:95], v[192:195]
  v_cvt_pk_bf16_f32 v249, v198, v199
  s_waitcnt lgkmcnt(2)
  v_mfma_f32_16x16x32_bf16 v[184:187], v[216:219], v[96:99], v[184:187]
  ds_read_b128 v[212:215], v71 offset:12544
  v_cvt_pk_bf16_f32 v250, v200, v201
  v_mfma_f32_16x16x32_bf16 v[188:191], v[216:219], v[100:103], v[188:191]
  s_add_u32 m0, s81, 2048
  s_nop 0
  buffer_load_dwordx4 v50, s[12:15], s80 offen lds
  v_mfma_f32_16x16x32_bf16 v[192:195], v[216:219], v[104:107], v[192:195]
  v_cvt_pk_bf16_f32 v251, v202, v203
  s_waitcnt lgkmcnt(2)
  v_mfma_f32_16x16x32_bf16 v[184:187], v[220:223], v[108:111], v[184:187]
  ds_read_b128 v[216:219], v70 offset:13056
  v_accvgpr_write_b32 a30, v248
  v_mfma_f32_16x16x32_bf16 v[188:191], v[220:223], v[112:115], v[188:191]
  s_add_u32 m0, s81, 3072
  s_nop 0
  buffer_load_dwordx4 v51, s[12:15], s80 offen lds
  v_mfma_f32_16x16x32_bf16 v[192:195], v[220:223], v[116:119], v[192:195]
  v_accvgpr_write_b32 a31, v249
  s_waitcnt lgkmcnt(2)
  v_mfma_f32_16x16x32_bf16 v[184:187], v[208:211], v[120:123], v[184:187]
  ds_read_b128 v[220:223], v71 offset:13056
  v_accvgpr_write_b32 a110, v250
  v_mfma_f32_16x16x32_bf16 v[188:191], v[208:211], v[124:127], v[188:191]
  s_add_u32 m0, s81, 4096
  s_nop 0
  buffer_load_dwordx4 v52, s[12:15], s80 offen lds
  v_mfma_f32_16x16x32_bf16 v[192:195], v[208:211], v[128:131], v[192:195]
  v_accvgpr_write_b32 a111, v251
  s_waitcnt lgkmcnt(2)
  v_mfma_f32_16x16x32_bf16 v[184:187], v[212:215], v[132:135], v[184:187]
  ds_read_b128 v[208:211], v70 offset:13184
  s_mov_b64 exec, s[68:69]
  v_cvt_pk_bf16_f32 v158, v204, v205
  v_cvt_pk_bf16_f32 v159, v206, v207
  s_mov_b64 exec, -1
  v_mfma_f32_16x16x32_bf16 v[188:191], v[212:215], v[136:139], v[188:191]
  s_add_u32 m0, s81, 5120
  s_nop 0
  buffer_load_dwordx4 v53, s[12:15], s80 offen lds
  v_mfma_f32_16x16x32_bf16 v[192:195], v[212:215], v[140:143], v[192:195]
  s_waitcnt lgkmcnt(2)
  v_mfma_f32_16x16x32_bf16 v[196:199], v[216:219], v[72:75], 0
  ds_read_b128 v[212:215], v71 offset:13184
  v_mfma_f32_16x16x32_bf16 v[200:203], v[216:219], v[76:79], 0
  s_add_u32 m0, s81, 6144
  s_nop 0
  buffer_load_dwordx4 v54, s[12:15], s80 offen lds
  v_mfma_f32_16x16x32_bf16 v[204:207], v[216:219], v[80:83], 0
  s_waitcnt lgkmcnt(2)
  v_mfma_f32_16x16x32_bf16 v[196:199], v[220:223], v[84:87], v[196:199]
  ds_read_b128 v[216:219], v70 offset:13312
  v_cvt_pk_bf16_f32 v248, v184, v185
  v_mfma_f32_16x16x32_bf16 v[200:203], v[220:223], v[88:91], v[200:203]
  s_add_u32 m0, s81, 7168
  s_nop 0
  buffer_load_dwordx4 v55, s[12:15], s80 offen lds
  v_mfma_f32_16x16x32_bf16 v[204:207], v[220:223], v[92:95], v[204:207]
  v_cvt_pk_bf16_f32 v249, v186, v187
  s_waitcnt lgkmcnt(2)
  v_mfma_f32_16x16x32_bf16 v[196:199], v[208:211], v[96:99], v[196:199]
  ds_read_b128 v[220:223], v71 offset:13312
  v_cvt_pk_bf16_f32 v250, v188, v189
  v_mfma_f32_16x16x32_bf16 v[200:203], v[208:211], v[100:103], v[200:203]
  s_add_u32 m0, s81, 8192
  s_nop 0
  buffer_load_dwordx4 v56, s[12:15], s80 offen lds
  v_mfma_f32_16x16x32_bf16 v[204:207], v[208:211], v[104:107], v[204:207]
  v_cvt_pk_bf16_f32 v251, v190, v191
  s_waitcnt lgkmcnt(2)
  v_mfma_f32_16x16x32_bf16 v[196:199], v[212:215], v[108:111], v[196:199]
  v_accvgpr_write_b32 a32, v248
  v_mfma_f32_16x16x32_bf16 v[200:203], v[212:215], v[112:115], v[200:203]
  s_add_u32 m0, s81, 9216
  s_nop 0
  buffer_load_dwordx4 v57, s[12:15], s80 offen lds
  v_mfma_f32_16x16x32_bf16 v[204:207], v[212:215], v[116:119], v[204:207]
  v_accvgpr_write_b32 a33, v249
  s_waitcnt lgkmcnt(1)
  v_mfma_f32_16x16x32_bf16 v[196:199], v[216:219], v[120:123], v[196:199]
  v_accvgpr_write_b32 a112, v250
  v_mfma_f32_16x16x32_bf16 v[200:203], v[216:219], v[124:127], v[200:203]
  s_add_u32 m0, s81, 10240
  s_nop 0
  buffer_load_dwordx4 v58, s[12:15], s80 offen lds
  v_mfma_f32_16x16x32_bf16 v[204:207], v[216:219], v[128:131], v[204:207]
  v_accvgpr_write_b32 a113, v251
  s_waitcnt lgkmcnt(0)
  v_mfma_f32_16x16x32_bf16 v[196:199], v[220:223], v[132:135], v[196:199]
  v_cvt_pk_bf16_f32 v160, v192, v193
  v_cvt_pk_bf16_f32 v161, v194, v195
  v_mfma_f32_16x16x32_bf16 v[200:203], v[220:223], v[136:139], v[200:203]
  s_add_u32 m0, s81, 11264
  s_nop 0
  buffer_load_dwordx4 v59, s[12:15], s80 offen lds
  s_add_u32 s80, s80, 393216
  v_mfma_f32_16x16x32_bf16 v[204:207], v[220:223], v[140:143], v[204:207]
  s_add_u32 s21, s79, 0
  buffer_load_dwordx4 a[224:227], v64, s[28:31], s21 offen
  s_add_u32 s21, s79, 0
  buffer_load_dwordx4 a[228:231], v65, s[28:31], s21 offen
  s_waitcnt vmcnt(16)
  ds_read_b128 v[208:211], v70 offset:24576
  ds_read_b128 v[212:215], v71 offset:24576
  ds_read_b128 v[216:219], v70 offset:24704
  s_waitcnt lgkmcnt(2)
  v_mfma_f32_16x16x32_bf16 v[184:187], v[208:211], v[72:75], 0
  ds_read_b128 v[220:223], v71 offset:24704
  v_mfma_f32_16x16x32_bf16 v[188:191], v[208:211], v[76:79], 0
  s_add_u32 m0, s81, 12288
  s_nop 0
  buffer_load_dwordx4 v48, s[12:15], s80 offen lds
  v_mfma_f32_16x16x32_bf16 v[192:195], v[208:211], v[80:83], 0
  s_waitcnt lgkmcnt(2)
  v_mfma_f32_16x16x32_bf16 v[184:187], v[212:215], v[84:87], v[184:187]
  ds_read_b128 v[208:211], v70 offset:24832
  v_cvt_pk_bf16_f32 v248, v196, v197
  v_mfma_f32_16x16x32_bf16 v[188:191], v[212:215], v[88:91], v[188:191]
  s_add_u32 m0, s81, 13312
  s_nop 0
  buffer_load_dwordx4 v49, s[12:15], s80 offen lds
  v_mfma_f32_16x16x32_bf16 v[192:195], v[212:215], v[92:95], v[192:195]
  v_cvt_pk_bf16_f32 v249, v198, v199
  s_waitcnt lgkmcnt(2)
  v_mfma_f32_16x16x32_bf16 v[184:187], v[216:219], v[96:99], v[184:187]
  ds_read_b128 v[212:215], v71 offset:24832
  v_cvt_pk_bf16_f32 v250, v200, v201
  v_mfma_f32_16x16x32_bf16 v[188:191], v[216:219], v[100:103], v[188:191]
  s_add_u32 m0, s81, 14336
  s_nop 0
  buffer_load_dwordx4 v50, s[12:15], s80 offen lds
  v_mfma_f32_16x16x32_bf16 v[192:195], v[216:219], v[104:107], v[192:195]
  v_cvt_pk_bf16_f32 v251, v202, v203
  s_waitcnt lgkmcnt(2)
  v_mfma_f32_16x16x32_bf16 v[184:187], v[220:223], v[108:111], v[184:187]
  ds_read_b128 v[216:219], v70 offset:25344
  v_accvgpr_write_b32 a34, v248
  v_mfma_f32_16x16x32_bf16 v[188:191], v[220:223], v[112:115], v[188:191]
  s_add_u32 m0, s81, 15360
  s_nop 0
  buffer_load_dwordx4 v51, s[12:15], s80 offen lds
  v_mfma_f32_16x16x32_bf16 v[192:195], v[220:223], v[116:119], v[192:195]
  v_accvgpr_write_b32 a35, v249
  s_waitcnt lgkmcnt(2)
  v_mfma_f32_16x16x32_bf16 v[184:187], v[208:211], v[120:123], v[184:187]
  ds_read_b128 v[220:223], v71 offset:25344
  v_accvgpr_write_b32 a114, v250
  v_mfma_f32_16x16x32_bf16 v[188:191], v[208:211], v[124:127], v[188:191]
  s_add_u32 m0, s81, 16384
  s_nop 0
  buffer_load_dwordx4 v52, s[12:15], s80 offen lds
  v_mfma_f32_16x16x32_bf16 v[192:195], v[208:211], v[128:131], v[192:195]
  v_accvgpr_write_b32 a115, v251
  s_waitcnt lgkmcnt(2)
  v_mfma_f32_16x16x32_bf16 v[184:187], v[212:215], v[132:135], v[184:187]
  ds_read_b128 v[208:211], v70 offset:25472
  s_mov_b64 exec, s[68:69]
  v_cvt_pk_bf16_f32 v160, v204, v205
  v_cvt_pk_bf16_f32 v161, v206, v207
  s_mov_b64 exec, -1
  v_mfma_f32_16x16x32_bf16 v[188:191], v[212:215], v[136:139], v[188:191]
  s_add_u32 m0, s81, 17408
  s_nop 0
  buffer_load_dwordx4 v53, s[12:15], s80 offen lds
  v_mfma_f32_16x16x32_bf16 v[192:195], v[212:215], v[140:143], v[192:195]
  s_waitcnt lgkmcnt(2)
  v_mfma_f32_16x16x32_bf16 v[196:199], v[216:219], v[72:75], 0
  ds_read_b128 v[212:215], v71 offset:25472
  v_mfma_f32_16x16x32_bf16 v[200:203], v[216:219], v[76:79], 0
  s_add_u32 m0, s81, 18432
  s_nop 0
  buffer_load_dwordx4 v54, s[12:15], s80 offen lds
  v_mfma_f32_16x16x32_bf16 v[204:207], v[216:219], v[80:83], 0
  s_waitcnt lgkmcnt(2)
  v_mfma_f32_16x16x32_bf16 v[196:199], v[220:223], v[84:87], v[196:199]
  ds_read_b128 v[216:219], v70 offset:25600
  v_cvt_pk_bf16_f32 v248, v184, v185
  v_mfma_f32_16x16x32_bf16 v[200:203], v[220:223], v[88:91], v[200:203]
  s_add_u32 m0, s81, 19456
  s_nop 0
  buffer_load_dwordx4 v55, s[12:15], s80 offen lds
  v_mfma_f32_16x16x32_bf16 v[204:207], v[220:223], v[92:95], v[204:207]
  v_cvt_pk_bf16_f32 v249, v186, v187
  s_waitcnt lgkmcnt(2)
  v_mfma_f32_16x16x32_bf16 v[196:199], v[208:211], v[96:99], v[196:199]
  ds_read_b128 v[220:223], v71 offset:25600
  v_cvt_pk_bf16_f32 v250, v188, v189
  v_mfma_f32_16x16x32_bf16 v[200:203], v[208:211], v[100:103], v[200:203]
  s_add_u32 m0, s81, 20480
  s_nop 0
  buffer_load_dwordx4 v56, s[12:15], s80 offen lds
  v_mfma_f32_16x16x32_bf16 v[204:207], v[208:211], v[104:107], v[204:207]
  v_cvt_pk_bf16_f32 v251, v190, v191
  s_waitcnt lgkmcnt(2)
  v_mfma_f32_16x16x32_bf16 v[196:199], v[212:215], v[108:111], v[196:199]
  v_accvgpr_write_b32 a36, v248
  v_mfma_f32_16x16x32_bf16 v[200:203], v[212:215], v[112:115], v[200:203]
  s_add_u32 m0, s81, 21504
  s_nop 0
  buffer_load_dwordx4 v57, s[12:15], s80 offen lds
  v_mfma_f32_16x16x32_bf16 v[204:207], v[212:215], v[116:119], v[204:207]
  v_accvgpr_write_b32 a37, v249
  s_waitcnt lgkmcnt(1)
  v_mfma_f32_16x16x32_bf16 v[196:199], v[216:219], v[120:123], v[196:199]
  v_accvgpr_write_b32 a116, v250
  v_mfma_f32_16x16x32_bf16 v[200:203], v[216:219], v[124:127], v[200:203]
  s_add_u32 m0, s81, 22528
  s_nop 0
  buffer_load_dwordx4 v58, s[12:15], s80 offen lds
  v_mfma_f32_16x16x32_bf16 v[204:207], v[216:219], v[128:131], v[204:207]
  v_accvgpr_write_b32 a117, v251
  s_waitcnt lgkmcnt(0)
  v_mfma_f32_16x16x32_bf16 v[196:199], v[220:223], v[132:135], v[196:199]
  v_cvt_pk_bf16_f32 v162, v192, v193
  v_cvt_pk_bf16_f32 v163, v194, v195
  v_mfma_f32_16x16x32_bf16 v[200:203], v[220:223], v[136:139], v[200:203]
  s_add_u32 m0, s81, 23552
  s_nop 0
  buffer_load_dwordx4 v59, s[12:15], s80 offen lds
  s_add_u32 s80, s80, 393216
  v_mfma_f32_16x16x32_bf16 v[204:207], v[220:223], v[140:143], v[204:207]
  s_add_u32 s21, s79, 393216
  buffer_load_dwordx4 a[232:235], v63, s[28:31], s21 offen
  s_add_u32 s21, s79, 393216
  buffer_load_dwordx4 a[236:239], v64, s[28:31], s21 offen
  s_waitcnt vmcnt(16)
  ds_read_b128 v[208:211], v70 offset:0
  ds_read_b128 v[212:215], v71 offset:0
  ds_read_b128 v[216:219], v70 offset:128
  s_waitcnt lgkmcnt(2)
  v_mfma_f32_16x16x32_bf16 v[184:187], v[208:211], v[72:75], 0
  ds_read_b128 v[220:223], v71 offset:128
  v_mfma_f32_16x16x32_bf16 v[188:191], v[208:211], v[76:79], 0
  s_add_u32 m0, s81, 24576
  s_nop 0
  buffer_load_dwordx4 v48, s[12:15], s80 offen lds
  v_mfma_f32_16x16x32_bf16 v[192:195], v[208:211], v[80:83], 0
  s_waitcnt lgkmcnt(2)
  v_mfma_f32_16x16x32_bf16 v[184:187], v[212:215], v[84:87], v[184:187]
  ds_read_b128 v[208:211], v70 offset:256
  v_cvt_pk_bf16_f32 v248, v196, v197
  v_mfma_f32_16x16x32_bf16 v[188:191], v[212:215], v[88:91], v[188:191]
  s_add_u32 m0, s81, 25600
  s_nop 0
  buffer_load_dwordx4 v49, s[12:15], s80 offen lds
  v_mfma_f32_16x16x32_bf16 v[192:195], v[212:215], v[92:95], v[192:195]
  v_cvt_pk_bf16_f32 v249, v198, v199
  s_waitcnt lgkmcnt(2)
  v_mfma_f32_16x16x32_bf16 v[184:187], v[216:219], v[96:99], v[184:187]
  ds_read_b128 v[212:215], v71 offset:256
  v_cvt_pk_bf16_f32 v250, v200, v201
  v_mfma_f32_16x16x32_bf16 v[188:191], v[216:219], v[100:103], v[188:191]
  s_add_u32 m0, s81, 26624
  s_nop 0
  buffer_load_dwordx4 v50, s[12:15], s80 offen lds
  v_mfma_f32_16x16x32_bf16 v[192:195], v[216:219], v[104:107], v[192:195]
  v_cvt_pk_bf16_f32 v251, v202, v203
  s_waitcnt lgkmcnt(2)
  v_mfma_f32_16x16x32_bf16 v[184:187], v[220:223], v[108:111], v[184:187]
  ds_read_b128 v[216:219], v70 offset:768
  v_accvgpr_write_b32 a38, v248
  v_mfma_f32_16x16x32_bf16 v[188:191], v[220:223], v[112:115], v[188:191]
  s_add_u32 m0, s81, 27648
  s_nop 0
  buffer_load_dwordx4 v51, s[12:15], s80 offen lds
  v_mfma_f32_16x16x32_bf16 v[192:195], v[220:223], v[116:119], v[192:195]
  v_accvgpr_write_b32 a39, v249
  s_waitcnt lgkmcnt(2)
  v_mfma_f32_16x16x32_bf16 v[184:187], v[208:211], v[120:123], v[184:187]
  ds_read_b128 v[220:223], v71 offset:768
  v_accvgpr_write_b32 a118, v250
  v_mfma_f32_16x16x32_bf16 v[188:191], v[208:211], v[124:127], v[188:191]
  s_add_u32 m0, s81, 28672
  s_nop 0
  buffer_load_dwordx4 v52, s[12:15], s80 offen lds
  v_mfma_f32_16x16x32_bf16 v[192:195], v[208:211], v[128:131], v[192:195]
  v_accvgpr_write_b32 a119, v251
  s_waitcnt lgkmcnt(2)
  v_mfma_f32_16x16x32_bf16 v[184:187], v[212:215], v[132:135], v[184:187]
  ds_read_b128 v[208:211], v70 offset:896
  s_mov_b64 exec, s[68:69]
  v_cvt_pk_bf16_f32 v162, v204, v205
  v_cvt_pk_bf16_f32 v163, v206, v207
  s_mov_b64 exec, -1
  v_mfma_f32_16x16x32_bf16 v[188:191], v[212:215], v[136:139], v[188:191]
  s_add_u32 m0, s81, 29696
  s_nop 0
  buffer_load_dwordx4 v53, s[12:15], s80 offen lds
  v_mfma_f32_16x16x32_bf16 v[192:195], v[212:215], v[140:143], v[192:195]
  s_waitcnt lgkmcnt(2)
  v_mfma_f32_16x16x32_bf16 v[196:199], v[216:219], v[72:75], 0
  ds_read_b128 v[212:215], v71 offset:896
  v_mfma_f32_16x16x32_bf16 v[200:203], v[216:219], v[76:79], 0
  s_add_u32 m0, s81, 30720
  s_nop 0
  buffer_load_dwordx4 v54, s[12:15], s80 offen lds
  v_mfma_f32_16x16x32_bf16 v[204:207], v[216:219], v[80:83], 0
  s_waitcnt lgkmcnt(2)
  v_mfma_f32_16x16x32_bf16 v[196:199], v[220:223], v[84:87], v[196:199]
  ds_read_b128 v[216:219], v70 offset:1024
  v_cvt_pk_bf16_f32 v248, v184, v185
  v_mfma_f32_16x16x32_bf16 v[200:203], v[220:223], v[88:91], v[200:203]
  s_add_u32 m0, s81, 31744
  s_nop 0
  buffer_load_dwordx4 v55, s[12:15], s80 offen lds
  v_mfma_f32_16x16x32_bf16 v[204:207], v[220:223], v[92:95], v[204:207]
  v_cvt_pk_bf16_f32 v249, v186, v187
  s_waitcnt lgkmcnt(2)
  v_mfma_f32_16x16x32_bf16 v[196:199], v[208:211], v[96:99], v[196:199]
  ds_read_b128 v[220:223], v71 offset:1024
  v_cvt_pk_bf16_f32 v250, v188, v189
  v_mfma_f32_16x16x32_bf16 v[200:203], v[208:211], v[100:103], v[200:203]
  s_add_u32 m0, s81, 32768
  s_nop 0
  buffer_load_dwordx4 v56, s[12:15], s80 offen lds
  v_mfma_f32_16x16x32_bf16 v[204:207], v[208:211], v[104:107], v[204:207]
  v_cvt_pk_bf16_f32 v251, v190, v191
  s_waitcnt lgkmcnt(2)
  v_mfma_f32_16x16x32_bf16 v[196:199], v[212:215], v[108:111], v[196:199]
  v_accvgpr_write_b32 a40, v248
  v_mfma_f32_16x16x32_bf16 v[200:203], v[212:215], v[112:115], v[200:203]
  s_add_u32 m0, s81, 33792
  s_nop 0
  buffer_load_dwordx4 v57, s[12:15], s80 offen lds
  v_mfma_f32_16x16x32_bf16 v[204:207], v[212:215], v[116:119], v[204:207]
  v_accvgpr_write_b32 a41, v249
  s_waitcnt lgkmcnt(1)
  v_mfma_f32_16x16x32_bf16 v[196:199], v[216:219], v[120:123], v[196:199]
  v_accvgpr_write_b32 a120, v250
  v_mfma_f32_16x16x32_bf16 v[200:203], v[216:219], v[124:127], v[200:203]
  s_add_u32 m0, s81, 34816
  s_nop 0
  buffer_load_dwordx4 v58, s[12:15], s80 offen lds
  v_mfma_f32_16x16x32_bf16 v[204:207], v[216:219], v[128:131], v[204:207]
  v_accvgpr_write_b32 a121, v251
  s_waitcnt lgkmcnt(0)
  v_mfma_f32_16x16x32_bf16 v[196:199], v[220:223], v[132:135], v[196:199]
  v_cvt_pk_bf16_f32 v164, v192, v193
  v_cvt_pk_bf16_f32 v165, v194, v195
  v_mfma_f32_16x16x32_bf16 v[200:203], v[220:223], v[136:139], v[200:203]
  s_add_u32 m0, s81, 35840
  s_nop 0
  buffer_load_dwordx4 v59, s[12:15], s80 offen lds
  s_add_u32 s80, s80, 393216
  v_mfma_f32_16x16x32_bf16 v[204:207], v[220:223], v[140:143], v[204:207]
  s_add_u32 s21, s79, 393216
  buffer_load_dwordx4 a[240:243], v65, s[28:31], s21 offen
  s_add_u32 s21, s79, 786432
  buffer_load_dwordx4 a[244:247], v63, s[28:31], s21 offen
  s_waitcnt vmcnt(16)
  ds_read_b128 v[208:211], v70 offset:12288
  ds_read_b128 v[212:215], v71 offset:12288
  ds_read_b128 v[216:219], v70 offset:12416
  s_waitcnt lgkmcnt(2)
  v_mfma_f32_16x16x32_bf16 v[184:187], v[208:211], v[72:75], 0
  ds_read_b128 v[220:223], v71 offset:12416
  v_mfma_f32_16x16x32_bf16 v[188:191], v[208:211], v[76:79], 0
  s_add_u32 m0, s81, 0
  s_nop 0
  buffer_load_dwordx4 v48, s[12:15], s80 offen lds
  v_mfma_f32_16x16x32_bf16 v[192:195], v[208:211], v[80:83], 0
  s_waitcnt lgkmcnt(2)
  v_mfma_f32_16x16x32_bf16 v[184:187], v[212:215], v[84:87], v[184:187]
  ds_read_b128 v[208:211], v70 offset:12544
  v_cvt_pk_bf16_f32 v248, v196, v197
  v_mfma_f32_16x16x32_bf16 v[188:191], v[212:215], v[88:91], v[188:191]
  s_add_u32 m0, s81, 1024
  s_nop 0
  buffer_load_dwordx4 v49, s[12:15], s80 offen lds
  v_mfma_f32_16x16x32_bf16 v[192:195], v[212:215], v[92:95], v[192:195]
  v_cvt_pk_bf16_f32 v249, v198, v199
  s_waitcnt lgkmcnt(2)
  v_mfma_f32_16x16x32_bf16 v[184:187], v[216:219], v[96:99], v[184:187]
  ds_read_b128 v[212:215], v71 offset:12544
  v_cvt_pk_bf16_f32 v250, v200, v201
  v_mfma_f32_16x16x32_bf16 v[188:191], v[216:219], v[100:103], v[188:191]
  s_add_u32 m0, s81, 2048
  s_nop 0
  buffer_load_dwordx4 v50, s[12:15], s80 offen lds
  v_mfma_f32_16x16x32_bf16 v[192:195], v[216:219], v[104:107], v[192:195]
  v_cvt_pk_bf16_f32 v251, v202, v203
  s_waitcnt lgkmcnt(2)
  v_mfma_f32_16x16x32_bf16 v[184:187], v[220:223], v[108:111], v[184:187]
  ds_read_b128 v[216:219], v70 offset:13056
  v_accvgpr_write_b32 a42, v248
  v_mfma_f32_16x16x32_bf16 v[188:191], v[220:223], v[112:115], v[188:191]
  s_add_u32 m0, s81, 3072
  s_nop 0
  buffer_load_dwordx4 v51, s[12:15], s80 offen lds
  v_mfma_f32_16x16x32_bf16 v[192:195], v[220:223], v[116:119], v[192:195]
  v_accvgpr_write_b32 a43, v249
  s_waitcnt lgkmcnt(2)
  v_mfma_f32_16x16x32_bf16 v[184:187], v[208:211], v[120:123], v[184:187]
  ds_read_b128 v[220:223], v71 offset:13056
  v_accvgpr_write_b32 a122, v250
  v_mfma_f32_16x16x32_bf16 v[188:191], v[208:211], v[124:127], v[188:191]
  s_add_u32 m0, s81, 4096
  s_nop 0
  buffer_load_dwordx4 v52, s[12:15], s80 offen lds
  v_mfma_f32_16x16x32_bf16 v[192:195], v[208:211], v[128:131], v[192:195]
  v_accvgpr_write_b32 a123, v251
  s_waitcnt lgkmcnt(2)
  v_mfma_f32_16x16x32_bf16 v[184:187], v[212:215], v[132:135], v[184:187]
  ds_read_b128 v[208:211], v70 offset:13184
  s_mov_b64 exec, s[68:69]
  v_cvt_pk_bf16_f32 v164, v204, v205
  v_cvt_pk_bf16_f32 v165, v206, v207
  s_mov_b64 exec, -1
  v_mfma_f32_16x16x32_bf16 v[188:191], v[212:215], v[136:139], v[188:191]
  s_add_u32 m0, s81, 5120
  s_nop 0
  buffer_load_dwordx4 v53, s[12:15], s80 offen lds
  v_mfma_f32_16x16x32_bf16 v[192:195], v[212:215], v[140:143], v[192:195]
  s_waitcnt lgkmcnt(2)
  v_mfma_f32_16x16x32_bf16 v[196:199], v[216:219], v[72:75], 0
  ds_read_b128 v[212:215], v71 offset:13184
  v_mfma_f32_16x16x32_bf16 v[200:203], v[216:219], v[76:79], 0
  s_add_u32 m0, s81, 6144
  s_nop 0
  buffer_load_dwordx4 v54, s[12:15], s80 offen lds
  v_mfma_f32_16x16x32_bf16 v[204:207], v[216:219], v[80:83], 0
  s_waitcnt lgkmcnt(2)
  v_mfma_f32_16x16x32_bf16 v[196:199], v[220:223], v[84:87], v[196:199]
  ds_read_b128 v[216:219], v70 offset:13312
  v_cvt_pk_bf16_f32 v248, v184, v185
  v_mfma_f32_16x16x32_bf16 v[200:203], v[220:223], v[88:91], v[200:203]
  s_add_u32 m0, s81, 7168
  s_nop 0
  buffer_load_dwordx4 v55, s[12:15], s80 offen lds
  v_mfma_f32_16x16x32_bf16 v[204:207], v[220:223], v[92:95], v[204:207]
  v_cvt_pk_bf16_f32 v249, v186, v187
  s_waitcnt lgkmcnt(2)
  v_mfma_f32_16x16x32_bf16 v[196:199], v[208:211], v[96:99], v[196:199]
  ds_read_b128 v[220:223], v71 offset:13312
  v_cvt_pk_bf16_f32 v250, v188, v189
  v_mfma_f32_16x16x32_bf16 v[200:203], v[208:211], v[100:103], v[200:203]
  s_add_u32 m0, s81, 8192
  s_nop 0
  buffer_load_dwordx4 v56, s[12:15], s80 offen lds
  v_mfma_f32_16x16x32_bf16 v[204:207], v[208:211], v[104:107], v[204:207]
  v_cvt_pk_bf16_f32 v251, v190, v191
  s_waitcnt lgkmcnt(2)
  v_mfma_f32_16x16x32_bf16 v[196:199], v[212:215], v[108:111], v[196:199]
  v_accvgpr_write_b32 a44, v248
  v_mfma_f32_16x16x32_bf16 v[200:203], v[212:215], v[112:115], v[200:203]
  s_add_u32 m0, s81, 9216
  s_nop 0
  buffer_load_dwordx4 v57, s[12:15], s80 offen lds
  v_mfma_f32_16x16x32_bf16 v[204:207], v[212:215], v[116:119], v[204:207]
  v_accvgpr_write_b32 a45, v249
  s_waitcnt lgkmcnt(1)
  v_mfma_f32_16x16x32_bf16 v[196:199], v[216:219], v[120:123], v[196:199]
  v_accvgpr_write_b32 a124, v250
  v_mfma_f32_16x16x32_bf16 v[200:203], v[216:219], v[124:127], v[200:203]
  s_add_u32 m0, s81, 10240
  s_nop 0
  buffer_load_dwordx4 v58, s[12:15], s80 offen lds
  v_mfma_f32_16x16x32_bf16 v[204:207], v[216:219], v[128:131], v[204:207]
  v_accvgpr_write_b32 a125, v251
  s_waitcnt lgkmcnt(0)
  v_mfma_f32_16x16x32_bf16 v[196:199], v[220:223], v[132:135], v[196:199]
  v_cvt_pk_bf16_f32 v166, v192, v193
  v_cvt_pk_bf16_f32 v167, v194, v195
  v_mfma_f32_16x16x32_bf16 v[200:203], v[220:223], v[136:139], v[200:203]
  s_add_u32 m0, s81, 11264
  s_nop 0
  buffer_load_dwordx4 v59, s[12:15], s80 offen lds
  s_add_u32 s80, s80, 393216
  v_mfma_f32_16x16x32_bf16 v[204:207], v[220:223], v[140:143], v[204:207]
  s_add_u32 s21, s79, 786432
  buffer_load_dwordx4 a[248:251], v64, s[28:31], s21 offen
  s_add_u32 s21, s79, 786432
  buffer_load_dwordx4 a[252:255], v65, s[28:31], s21 offen
  s_waitcnt vmcnt(16)
  ds_read_b128 v[208:211], v70 offset:24576
  ds_read_b128 v[212:215], v71 offset:24576
  ds_read_b128 v[216:219], v70 offset:24704
  s_waitcnt lgkmcnt(2)
  v_mfma_f32_16x16x32_bf16 v[184:187], v[208:211], v[72:75], 0
  ds_read_b128 v[220:223], v71 offset:24704
  v_mfma_f32_16x16x32_bf16 v[188:191], v[208:211], v[76:79], 0
  s_add_u32 m0, s81, 12288
  s_nop 0
  buffer_load_dwordx4 v48, s[12:15], s80 offen lds
  v_mfma_f32_16x16x32_bf16 v[192:195], v[208:211], v[80:83], 0
  s_waitcnt lgkmcnt(2)
  v_mfma_f32_16x16x32_bf16 v[184:187], v[212:215], v[84:87], v[184:187]
  ds_read_b128 v[208:211], v70 offset:24832
  v_cvt_pk_bf16_f32 v248, v196, v197
  v_mfma_f32_16x16x32_bf16 v[188:191], v[212:215], v[88:91], v[188:191]
  s_add_u32 m0, s81, 13312
  s_nop 0
  buffer_load_dwordx4 v49, s[12:15], s80 offen lds
  v_mfma_f32_16x16x32_bf16 v[192:195], v[212:215], v[92:95], v[192:195]
  v_cvt_pk_bf16_f32 v249, v198, v199
  s_waitcnt lgkmcnt(2)
  v_mfma_f32_16x16x32_bf16 v[184:187], v[216:219], v[96:99], v[184:187]
  ds_read_b128 v[212:215], v71 offset:24832
  v_cvt_pk_bf16_f32 v250, v200, v201
  v_mfma_f32_16x16x32_bf16 v[188:191], v[216:219], v[100:103], v[188:191]
  s_add_u32 m0, s81, 14336
  s_nop 0
  buffer_load_dwordx4 v50, s[12:15], s80 offen lds
  v_mfma_f32_16x16x32_bf16 v[192:195], v[216:219], v[104:107], v[192:195]
  v_cvt_pk_bf16_f32 v251, v202, v203
  s_waitcnt lgkmcnt(2)
  v_mfma_f32_16x16x32_bf16 v[184:187], v[220:223], v[108:111], v[184:187]
  ds_read_b128 v[216:219], v70 offset:25344
  v_accvgpr_write_b32 a46, v248
  v_mfma_f32_16x16x32_bf16 v[188:191], v[220:223], v[112:115], v[188:191]
  s_add_u32 m0, s81, 15360
  s_nop 0
  buffer_load_dwordx4 v51, s[12:15], s80 offen lds
  v_mfma_f32_16x16x32_bf16 v[192:195], v[220:223], v[116:119], v[192:195]
  v_accvgpr_write_b32 a47, v249
  s_waitcnt lgkmcnt(2)
  v_mfma_f32_16x16x32_bf16 v[184:187], v[208:211], v[120:123], v[184:187]
  ds_read_b128 v[220:223], v71 offset:25344
  v_accvgpr_write_b32 a126, v250
  v_mfma_f32_16x16x32_bf16 v[188:191], v[208:211], v[124:127], v[188:191]
  s_add_u32 m0, s81, 16384
  s_nop 0
  buffer_load_dwordx4 v52, s[12:15], s80 offen lds
  v_mfma_f32_16x16x32_bf16 v[192:195], v[208:211], v[128:131], v[192:195]
  v_accvgpr_write_b32 a127, v251
  s_waitcnt lgkmcnt(2)
  v_mfma_f32_16x16x32_bf16 v[184:187], v[212:215], v[132:135], v[184:187]
  ds_read_b128 v[208:211], v70 offset:25472
  s_mov_b64 exec, s[68:69]
  v_cvt_pk_bf16_f32 v166, v204, v205
  v_cvt_pk_bf16_f32 v167, v206, v207
  s_mov_b64 exec, -1
  v_mfma_f32_16x16x32_bf16 v[188:191], v[212:215], v[136:139], v[188:191]
  s_add_u32 m0, s81, 17408
  s_nop 0
  buffer_load_dwordx4 v53, s[12:15], s80 offen lds
  v_mfma_f32_16x16x32_bf16 v[192:195], v[212:215], v[140:143], v[192:195]
  s_waitcnt lgkmcnt(2)
  v_mfma_f32_16x16x32_bf16 v[196:199], v[216:219], v[72:75], 0
  ds_read_b128 v[212:215], v71 offset:25472
  v_mfma_f32_16x16x32_bf16 v[200:203], v[216:219], v[76:79], 0
  s_add_u32 m0, s81, 18432
  s_nop 0
  buffer_load_dwordx4 v54, s[12:15], s80 offen lds
  v_mfma_f32_16x16x32_bf16 v[204:207], v[216:219], v[80:83], 0
  s_waitcnt lgkmcnt(2)
  v_mfma_f32_16x16x32_bf16 v[196:199], v[220:223], v[84:87], v[196:199]
  ds_read_b128 v[216:219], v70 offset:25600
  v_cvt_pk_bf16_f32 v248, v184, v185
  v_mfma_f32_16x16x32_bf16 v[200:203], v[220:223], v[88:91], v[200:203]
  s_add_u32 m0, s81, 19456
  s_nop 0
  buffer_load_dwordx4 v55, s[12:15], s80 offen lds
  v_mfma_f32_16x16x32_bf16 v[204:207], v[220:223], v[92:95], v[204:207]
  v_cvt_pk_bf16_f32 v249, v186, v187
  s_waitcnt lgkmcnt(2)
  v_mfma_f32_16x16x32_bf16 v[196:199], v[208:211], v[96:99], v[196:199]
  ds_read_b128 v[220:223], v71 offset:25600
  v_cvt_pk_bf16_f32 v250, v188, v189
  v_mfma_f32_16x16x32_bf16 v[200:203], v[208:211], v[100:103], v[200:203]
  s_add_u32 m0, s81, 20480
  s_nop 0
  buffer_load_dwordx4 v56, s[12:15], s80 offen lds
  v_mfma_f32_16x16x32_bf16 v[204:207], v[208:211], v[104:107], v[204:207]
  v_cvt_pk_bf16_f32 v251, v190, v191
  s_waitcnt lgkmcnt(2)
  v_mfma_f32_16x16x32_bf16 v[196:199], v[212:215], v[108:111], v[196:199]
  v_accvgpr_write_b32 a48, v248
  v_mfma_f32_16x16x32_bf16 v[200:203], v[212:215], v[112:115], v[200:203]
  s_add_u32 m0, s81, 21504
  s_nop 0
  buffer_load_dwordx4 v57, s[12:15], s80 offen lds
  v_mfma_f32_16x16x32_bf16 v[204:207], v[212:215], v[116:119], v[204:207]
  v_accvgpr_write_b32 a49, v249
  s_waitcnt lgkmcnt(1)
  v_mfma_f32_16x16x32_bf16 v[196:199], v[216:219], v[120:123], v[196:199]
  v_accvgpr_write_b32 a128, v250
  v_mfma_f32_16x16x32_bf16 v[200:203], v[216:219], v[124:127], v[200:203]
  s_add_u32 m0, s81, 22528
  s_nop 0
  buffer_load_dwordx4 v58, s[12:15], s80 offen lds
  v_mfma_f32_16x16x32_bf16 v[204:207], v[216:219], v[128:131], v[204:207]
  v_accvgpr_write_b32 a129, v251
  s_waitcnt lgkmcnt(0)
  v_mfma_f32_16x16x32_bf16 v[196:199], v[220:223], v[132:135], v[196:199]
  v_cvt_pk_bf16_f32 v168, v192, v193
  v_cvt_pk_bf16_f32 v169, v194, v195
  v_mfma_f32_16x16x32_bf16 v[200:203], v[220:223], v[136:139], v[200:203]
  s_add_u32 m0, s81, 23552
  s_nop 0
  buffer_load_dwordx4 v59, s[12:15], s80 offen lds
  s_add_u32 s80, s80, 393216
  v_mfma_f32_16x16x32_bf16 v[204:207], v[220:223], v[140:143], v[204:207]
  s_add_u32 s21, s79, 1179648
  buffer_load_dwordx4 v[224:227], v63, s[28:31], s21 offen
  s_add_u32 s21, s79, 1179648
  buffer_load_dwordx4 v[228:231], v64, s[28:31], s21 offen
  s_waitcnt vmcnt(16)
  ds_read_b128 v[208:211], v70 offset:0
  ds_read_b128 v[212:215], v71 offset:0
  ds_read_b128 v[216:219], v70 offset:128
  s_waitcnt lgkmcnt(2)
  v_mfma_f32_16x16x32_bf16 v[184:187], v[208:211], v[72:75], 0
  ds_read_b128 v[220:223], v71 offset:128
  v_mfma_f32_16x16x32_bf16 v[188:191], v[208:211], v[76:79], 0
  s_add_u32 m0, s81, 24576
  s_nop 0
  buffer_load_dwordx4 v48, s[12:15], s80 offen lds
  v_mfma_f32_16x16x32_bf16 v[192:195], v[208:211], v[80:83], 0
  s_waitcnt lgkmcnt(2)
  v_mfma_f32_16x16x32_bf16 v[184:187], v[212:215], v[84:87], v[184:187]
  ds_read_b128 v[208:211], v70 offset:256
  v_cvt_pk_bf16_f32 v248, v196, v197
  v_mfma_f32_16x16x32_bf16 v[188:191], v[212:215], v[88:91], v[188:191]
  s_add_u32 m0, s81, 25600
  s_nop 0
  buffer_load_dwordx4 v49, s[12:15], s80 offen lds
  v_mfma_f32_16x16x32_bf16 v[192:195], v[212:215], v[92:95], v[192:195]
  v_cvt_pk_bf16_f32 v249, v198, v199
  s_waitcnt lgkmcnt(2)
  v_mfma_f32_16x16x32_bf16 v[184:187], v[216:219], v[96:99], v[184:187]
  ds_read_b128 v[212:215], v71 offset:256
  v_cvt_pk_bf16_f32 v250, v200, v201
  v_mfma_f32_16x16x32_bf16 v[188:191], v[216:219], v[100:103], v[188:191]
  s_add_u32 m0, s81, 26624
  s_nop 0
  buffer_load_dwordx4 v50, s[12:15], s80 offen lds
  v_mfma_f32_16x16x32_bf16 v[192:195], v[216:219], v[104:107], v[192:195]
  v_cvt_pk_bf16_f32 v251, v202, v203
  s_waitcnt lgkmcnt(2)
  v_mfma_f32_16x16x32_bf16 v[184:187], v[220:223], v[108:111], v[184:187]
  ds_read_b128 v[216:219], v70 offset:768
  v_accvgpr_write_b32 a50, v248
  v_mfma_f32_16x16x32_bf16 v[188:191], v[220:223], v[112:115], v[188:191]
  s_add_u32 m0, s81, 27648
  s_nop 0
  buffer_load_dwordx4 v51, s[12:15], s80 offen lds
  v_mfma_f32_16x16x32_bf16 v[192:195], v[220:223], v[116:119], v[192:195]
  v_accvgpr_write_b32 a51, v249
  s_waitcnt lgkmcnt(2)
  v_mfma_f32_16x16x32_bf16 v[184:187], v[208:211], v[120:123], v[184:187]
  ds_read_b128 v[220:223], v71 offset:768
  v_accvgpr_write_b32 a130, v250
  v_mfma_f32_16x16x32_bf16 v[188:191], v[208:211], v[124:127], v[188:191]
  s_add_u32 m0, s81, 28672
  s_nop 0
  buffer_load_dwordx4 v52, s[12:15], s80 offen lds
  v_mfma_f32_16x16x32_bf16 v[192:195], v[208:211], v[128:131], v[192:195]
  v_accvgpr_write_b32 a131, v251
  s_waitcnt lgkmcnt(2)
  v_mfma_f32_16x16x32_bf16 v[184:187], v[212:215], v[132:135], v[184:187]
  ds_read_b128 v[208:211], v70 offset:896
  s_mov_b64 exec, s[68:69]
  v_cvt_pk_bf16_f32 v168, v204, v205
  v_cvt_pk_bf16_f32 v169, v206, v207
  s_mov_b64 exec, -1
  v_mfma_f32_16x16x32_bf16 v[188:191], v[212:215], v[136:139], v[188:191]
  s_add_u32 m0, s81, 29696
  s_nop 0
  buffer_load_dwordx4 v53, s[12:15], s80 offen lds
  v_mfma_f32_16x16x32_bf16 v[192:195], v[212:215], v[140:143], v[192:195]
  s_waitcnt lgkmcnt(2)
  v_mfma_f32_16x16x32_bf16 v[196:199], v[216:219], v[72:75], 0
  ds_read_b128 v[212:215], v71 offset:896
  v_mfma_f32_16x16x32_bf16 v[200:203], v[216:219], v[76:79], 0
  s_add_u32 m0, s81, 30720
  s_nop 0
  buffer_load_dwordx4 v54, s[12:15], s80 offen lds
  v_mfma_f32_16x16x32_bf16 v[204:207], v[216:219], v[80:83], 0
  s_waitcnt lgkmcnt(2)
  v_mfma_f32_16x16x32_bf16 v[196:199], v[220:223], v[84:87], v[196:199]
  ds_read_b128 v[216:219], v70 offset:1024
  v_cvt_pk_bf16_f32 v248, v184, v185
  v_mfma_f32_16x16x32_bf16 v[200:203], v[220:223], v[88:91], v[200:203]
  s_add_u32 m0, s81, 31744
  s_nop 0
  buffer_load_dwordx4 v55, s[12:15], s80 offen lds
  v_mfma_f32_16x16x32_bf16 v[204:207], v[220:223], v[92:95], v[204:207]
  v_cvt_pk_bf16_f32 v249, v186, v187
  s_waitcnt lgkmcnt(2)
  v_mfma_f32_16x16x32_bf16 v[196:199], v[208:211], v[96:99], v[196:199]
  ds_read_b128 v[220:223], v71 offset:1024
  v_cvt_pk_bf16_f32 v250, v188, v189
  v_mfma_f32_16x16x32_bf16 v[200:203], v[208:211], v[100:103], v[200:203]
  s_add_u32 m0, s81, 32768
  s_nop 0
  buffer_load_dwordx4 v56, s[12:15], s80 offen lds
  v_mfma_f32_16x16x32_bf16 v[204:207], v[208:211], v[104:107], v[204:207]
  v_cvt_pk_bf16_f32 v251, v190, v191
  s_waitcnt lgkmcnt(2)
  v_mfma_f32_16x16x32_bf16 v[196:199], v[212:215], v[108:111], v[196:199]
  v_accvgpr_write_b32 a52, v248
  v_mfma_f32_16x16x32_bf16 v[200:203], v[212:215], v[112:115], v[200:203]
  s_add_u32 m0, s81, 33792
  s_nop 0
  buffer_load_dwordx4 v57, s[12:15], s80 offen lds
  v_mfma_f32_16x16x32_bf16 v[204:207], v[212:215], v[116:119], v[204:207]
  v_accvgpr_write_b32 a53, v249
  s_waitcnt lgkmcnt(1)
  v_mfma_f32_16x16x32_bf16 v[196:199], v[216:219], v[120:123], v[196:199]
  v_accvgpr_write_b32 a132, v250
  v_mfma_f32_16x16x32_bf16 v[200:203], v[216:219], v[124:127], v[200:203]
  s_add_u32 m0, s81, 34816
  s_nop 0
  buffer_load_dwordx4 v58, s[12:15], s80 offen lds
  v_mfma_f32_16x16x32_bf16 v[204:207], v[216:219], v[128:131], v[204:207]
  v_accvgpr_write_b32 a133, v251
  s_waitcnt lgkmcnt(0)
  v_mfma_f32_16x16x32_bf16 v[196:199], v[220:223], v[132:135], v[196:199]
  v_cvt_pk_bf16_f32 v170, v192, v193
  v_cvt_pk_bf16_f32 v171, v194, v195
  v_mfma_f32_16x16x32_bf16 v[200:203], v[220:223], v[136:139], v[200:203]
  s_add_u32 m0, s81, 35840
  s_nop 0
  buffer_load_dwordx4 v59, s[12:15], s80 offen lds
  s_add_u32 s80, s80, 393216
  v_mfma_f32_16x16x32_bf16 v[204:207], v[220:223], v[140:143], v[204:207]
  s_add_u32 s21, s79, 1179648
  buffer_load_dwordx4 v[232:235], v65, s[28:31], s21 offen
  s_add_u32 s21, s79, 1572864
  buffer_load_dwordx4 v[236:239], v63, s[28:31], s21 offen
  s_waitcnt vmcnt(16)
  ds_read_b128 v[208:211], v70 offset:12288
  ds_read_b128 v[212:215], v71 offset:12288
  ds_read_b128 v[216:219], v70 offset:12416
  s_waitcnt lgkmcnt(2)
  v_mfma_f32_16x16x32_bf16 v[184:187], v[208:211], v[72:75], 0
  ds_read_b128 v[220:223], v71 offset:12416
  v_mfma_f32_16x16x32_bf16 v[188:191], v[208:211], v[76:79], 0
  s_add_u32 m0, s81, 0
  s_nop 0
  buffer_load_dwordx4 v48, s[12:15], s80 offen lds
  v_mfma_f32_16x16x32_bf16 v[192:195], v[208:211], v[80:83], 0
  s_waitcnt lgkmcnt(2)
  v_mfma_f32_16x16x32_bf16 v[184:187], v[212:215], v[84:87], v[184:187]
  ds_read_b128 v[208:211], v70 offset:12544
  v_cvt_pk_bf16_f32 v248, v196, v197
  v_mfma_f32_16x16x32_bf16 v[188:191], v[212:215], v[88:91], v[188:191]
  s_add_u32 m0, s81, 1024
  s_nop 0
  buffer_load_dwordx4 v49, s[12:15], s80 offen lds
  v_mfma_f32_16x16x32_bf16 v[192:195], v[212:215], v[92:95], v[192:195]
  v_cvt_pk_bf16_f32 v249, v198, v199
  s_waitcnt lgkmcnt(2)
  v_mfma_f32_16x16x32_bf16 v[184:187], v[216:219], v[96:99], v[184:187]
  ds_read_b128 v[212:215], v71 offset:12544
  v_cvt_pk_bf16_f32 v250, v200, v201
  v_mfma_f32_16x16x32_bf16 v[188:191], v[216:219], v[100:103], v[188:191]
  s_add_u32 m0, s81, 2048
  s_nop 0
  buffer_load_dwordx4 v50, s[12:15], s80 offen lds
  v_mfma_f32_16x16x32_bf16 v[192:195], v[216:219], v[104:107], v[192:195]
  v_cvt_pk_bf16_f32 v251, v202, v203
  s_waitcnt lgkmcnt(2)
  v_mfma_f32_16x16x32_bf16 v[184:187], v[220:223], v[108:111], v[184:187]
  ds_read_b128 v[216:219], v70 offset:13056
  v_accvgpr_write_b32 a54, v248
  v_mfma_f32_16x16x32_bf16 v[188:191], v[220:223], v[112:115], v[188:191]
  s_add_u32 m0, s81, 3072
  s_nop 0
  buffer_load_dwordx4 v51, s[12:15], s80 offen lds
  v_mfma_f32_16x16x32_bf16 v[192:195], v[220:223], v[116:119], v[192:195]
  v_accvgpr_write_b32 a55, v249
  s_waitcnt lgkmcnt(2)
  v_mfma_f32_16x16x32_bf16 v[184:187], v[208:211], v[120:123], v[184:187]
  ds_read_b128 v[220:223], v71 offset:13056
  v_accvgpr_write_b32 a134, v250
  v_mfma_f32_16x16x32_bf16 v[188:191], v[208:211], v[124:127], v[188:191]
  s_add_u32 m0, s81, 4096
  s_nop 0
  buffer_load_dwordx4 v52, s[12:15], s80 offen lds
  v_mfma_f32_16x16x32_bf16 v[192:195], v[208:211], v[128:131], v[192:195]
  v_accvgpr_write_b32 a135, v251
  s_waitcnt lgkmcnt(2)
  v_mfma_f32_16x16x32_bf16 v[184:187], v[212:215], v[132:135], v[184:187]
  ds_read_b128 v[208:211], v70 offset:13184
  s_mov_b64 exec, s[68:69]
  v_cvt_pk_bf16_f32 v170, v204, v205
  v_cvt_pk_bf16_f32 v171, v206, v207
  s_mov_b64 exec, -1
  v_mfma_f32_16x16x32_bf16 v[188:191], v[212:215], v[136:139], v[188:191]
  s_add_u32 m0, s81, 5120
  s_nop 0
  buffer_load_dwordx4 v53, s[12:15], s80 offen lds
  v_mfma_f32_16x16x32_bf16 v[192:195], v[212:215], v[140:143], v[192:195]
  s_waitcnt lgkmcnt(2)
  v_mfma_f32_16x16x32_bf16 v[196:199], v[216:219], v[72:75], 0
  ds_read_b128 v[212:215], v71 offset:13184
  v_mfma_f32_16x16x32_bf16 v[200:203], v[216:219], v[76:79], 0
  s_add_u32 m0, s81, 6144
  s_nop 0
  buffer_load_dwordx4 v54, s[12:15], s80 offen lds
  v_mfma_f32_16x16x32_bf16 v[204:207], v[216:219], v[80:83], 0
  s_waitcnt lgkmcnt(2)
  v_mfma_f32_16x16x32_bf16 v[196:199], v[220:223], v[84:87], v[196:199]
  ds_read_b128 v[216:219], v70 offset:13312
  v_cvt_pk_bf16_f32 v248, v184, v185
  v_mfma_f32_16x16x32_bf16 v[200:203], v[220:223], v[88:91], v[200:203]
  s_add_u32 m0, s81, 7168
  s_nop 0
  buffer_load_dwordx4 v55, s[12:15], s80 offen lds
  v_mfma_f32_16x16x32_bf16 v[204:207], v[220:223], v[92:95], v[204:207]
  v_cvt_pk_bf16_f32 v249, v186, v187
  s_waitcnt lgkmcnt(2)
  v_mfma_f32_16x16x32_bf16 v[196:199], v[208:211], v[96:99], v[196:199]
  ds_read_b128 v[220:223], v71 offset:13312
  v_cvt_pk_bf16_f32 v250, v188, v189
  v_mfma_f32_16x16x32_bf16 v[200:203], v[208:211], v[100:103], v[200:203]
  s_add_u32 m0, s81, 8192
  s_nop 0
  buffer_load_dwordx4 v56, s[12:15], s80 offen lds
  v_mfma_f32_16x16x32_bf16 v[204:207], v[208:211], v[104:107], v[204:207]
  v_cvt_pk_bf16_f32 v251, v190, v191
  s_waitcnt lgkmcnt(2)
  v_mfma_f32_16x16x32_bf16 v[196:199], v[212:215], v[108:111], v[196:199]
  v_accvgpr_write_b32 a56, v248
  v_mfma_f32_16x16x32_bf16 v[200:203], v[212:215], v[112:115], v[200:203]
  s_add_u32 m0, s81, 9216
  s_nop 0
  buffer_load_dwordx4 v57, s[12:15], s80 offen lds
  v_mfma_f32_16x16x32_bf16 v[204:207], v[212:215], v[116:119], v[204:207]
  v_accvgpr_write_b32 a57, v249
  s_waitcnt lgkmcnt(1)
  v_mfma_f32_16x16x32_bf16 v[196:199], v[216:219], v[120:123], v[196:199]
  v_accvgpr_write_b32 a136, v250
  v_mfma_f32_16x16x32_bf16 v[200:203], v[216:219], v[124:127], v[200:203]
  s_add_u32 m0, s81, 10240
  s_nop 0
  buffer_load_dwordx4 v58, s[12:15], s80 offen lds
  v_mfma_f32_16x16x32_bf16 v[204:207], v[216:219], v[128:131], v[204:207]
  v_accvgpr_write_b32 a137, v251
  s_waitcnt lgkmcnt(0)
  v_mfma_f32_16x16x32_bf16 v[196:199], v[220:223], v[132:135], v[196:199]
  v_cvt_pk_bf16_f32 v172, v192, v193
  v_cvt_pk_bf16_f32 v173, v194, v195
  v_mfma_f32_16x16x32_bf16 v[200:203], v[220:223], v[136:139], v[200:203]
  s_add_u32 m0, s81, 11264
  s_nop 0
  buffer_load_dwordx4 v59, s[12:15], s80 offen lds
  s_add_u32 s80, s80, 393216
  v_mfma_f32_16x16x32_bf16 v[204:207], v[220:223], v[140:143], v[204:207]
  s_add_u32 s21, s79, 1572864
  buffer_load_dwordx4 v[240:243], v64, s[28:31], s21 offen
  s_add_u32 s21, s79, 1572864
  buffer_load_dwordx4 v[244:247], v65, s[28:31], s21 offen
  s_waitcnt vmcnt(16)
  ds_read_b128 v[208:211], v70 offset:24576
  ds_read_b128 v[212:215], v71 offset:24576
  ds_read_b128 v[216:219], v70 offset:24704
  s_waitcnt lgkmcnt(2)
  v_mfma_f32_16x16x32_bf16 v[184:187], v[208:211], v[72:75], 0
  ds_read_b128 v[220:223], v71 offset:24704
  v_mfma_f32_16x16x32_bf16 v[188:191], v[208:211], v[76:79], 0
  s_add_u32 m0, s81, 12288
  s_nop 0
  buffer_load_dwordx4 v48, s[12:15], s80 offen lds
  v_mfma_f32_16x16x32_bf16 v[192:195], v[208:211], v[80:83], 0
  s_waitcnt lgkmcnt(2)
  v_mfma_f32_16x16x32_bf16 v[184:187], v[212:215], v[84:87], v[184:187]
  ds_read_b128 v[208:211], v70 offset:24832
  v_cvt_pk_bf16_f32 v248, v196, v197
  v_mfma_f32_16x16x32_bf16 v[188:191], v[212:215], v[88:91], v[188:191]
  s_add_u32 m0, s81, 13312
  s_nop 0
  buffer_load_dwordx4 v49, s[12:15], s80 offen lds
  v_mfma_f32_16x16x32_bf16 v[192:195], v[212:215], v[92:95], v[192:195]
  v_cvt_pk_bf16_f32 v249, v198, v199
  s_waitcnt lgkmcnt(2)
  v_mfma_f32_16x16x32_bf16 v[184:187], v[216:219], v[96:99], v[184:187]
  ds_read_b128 v[212:215], v71 offset:24832
  v_cvt_pk_bf16_f32 v250, v200, v201
  v_mfma_f32_16x16x32_bf16 v[188:191], v[216:219], v[100:103], v[188:191]
  s_add_u32 m0, s81, 14336
  s_nop 0
  buffer_load_dwordx4 v50, s[12:15], s80 offen lds
  v_mfma_f32_16x16x32_bf16 v[192:195], v[216:219], v[104:107], v[192:195]
  v_cvt_pk_bf16_f32 v251, v202, v203
  s_waitcnt lgkmcnt(2)
  v_mfma_f32_16x16x32_bf16 v[184:187], v[220:223], v[108:111], v[184:187]
  ds_read_b128 v[216:219], v70 offset:25344
  v_accvgpr_write_b32 a58, v248
  v_mfma_f32_16x16x32_bf16 v[188:191], v[220:223], v[112:115], v[188:191]
  s_add_u32 m0, s81, 15360
  s_nop 0
  buffer_load_dwordx4 v51, s[12:15], s80 offen lds
  v_mfma_f32_16x16x32_bf16 v[192:195], v[220:223], v[116:119], v[192:195]
  v_accvgpr_write_b32 a59, v249
  s_waitcnt lgkmcnt(2)
  v_mfma_f32_16x16x32_bf16 v[184:187], v[208:211], v[120:123], v[184:187]
  ds_read_b128 v[220:223], v71 offset:25344
  v_accvgpr_write_b32 a138, v250
  v_mfma_f32_16x16x32_bf16 v[188:191], v[208:211], v[124:127], v[188:191]
  s_add_u32 m0, s81, 16384
  s_nop 0
  buffer_load_dwordx4 v52, s[12:15], s80 offen lds
  v_mfma_f32_16x16x32_bf16 v[192:195], v[208:211], v[128:131], v[192:195]
  v_accvgpr_write_b32 a139, v251
  s_waitcnt lgkmcnt(2)
  v_mfma_f32_16x16x32_bf16 v[184:187], v[212:215], v[132:135], v[184:187]
  ds_read_b128 v[208:211], v70 offset:25472
  s_mov_b64 exec, s[68:69]
  v_cvt_pk_bf16_f32 v172, v204, v205
  v_cvt_pk_bf16_f32 v173, v206, v207
  s_mov_b64 exec, -1
  v_mfma_f32_16x16x32_bf16 v[188:191], v[212:215], v[136:139], v[188:191]
  s_add_u32 m0, s81, 17408
  s_nop 0
  buffer_load_dwordx4 v53, s[12:15], s80 offen lds
  v_mfma_f32_16x16x32_bf16 v[192:195], v[212:215], v[140:143], v[192:195]
  s_waitcnt lgkmcnt(2)
  v_mfma_f32_16x16x32_bf16 v[196:199], v[216:219], v[72:75], 0
  ds_read_b128 v[212:215], v71 offset:25472
  v_mfma_f32_16x16x32_bf16 v[200:203], v[216:219], v[76:79], 0
  s_add_u32 m0, s81, 18432
  s_nop 0
  buffer_load_dwordx4 v54, s[12:15], s80 offen lds
  v_mfma_f32_16x16x32_bf16 v[204:207], v[216:219], v[80:83], 0
  s_waitcnt lgkmcnt(2)
  v_mfma_f32_16x16x32_bf16 v[196:199], v[220:223], v[84:87], v[196:199]
  ds_read_b128 v[216:219], v70 offset:25600
  v_cvt_pk_bf16_f32 v248, v184, v185
  v_mfma_f32_16x16x32_bf16 v[200:203], v[220:223], v[88:91], v[200:203]
  s_add_u32 m0, s81, 19456
  s_nop 0
  buffer_load_dwordx4 v55, s[12:15], s80 offen lds
  v_mfma_f32_16x16x32_bf16 v[204:207], v[220:223], v[92:95], v[204:207]
  v_cvt_pk_bf16_f32 v249, v186, v187
  s_waitcnt lgkmcnt(2)
  v_mfma_f32_16x16x32_bf16 v[196:199], v[208:211], v[96:99], v[196:199]
  ds_read_b128 v[220:223], v71 offset:25600
  v_cvt_pk_bf16_f32 v250, v188, v189
  v_mfma_f32_16x16x32_bf16 v[200:203], v[208:211], v[100:103], v[200:203]
  s_add_u32 m0, s81, 20480
  s_nop 0
  buffer_load_dwordx4 v56, s[12:15], s80 offen lds
  v_mfma_f32_16x16x32_bf16 v[204:207], v[208:211], v[104:107], v[204:207]
  v_cvt_pk_bf16_f32 v251, v190, v191
  s_waitcnt lgkmcnt(2)
  v_mfma_f32_16x16x32_bf16 v[196:199], v[212:215], v[108:111], v[196:199]
  v_accvgpr_write_b32 a60, v248
  v_mfma_f32_16x16x32_bf16 v[200:203], v[212:215], v[112:115], v[200:203]
  s_add_u32 m0, s81, 21504
  s_nop 0
  buffer_load_dwordx4 v57, s[12:15], s80 offen lds
  v_mfma_f32_16x16x32_bf16 v[204:207], v[212:215], v[116:119], v[204:207]
  v_accvgpr_write_b32 a61, v249
  s_waitcnt lgkmcnt(1)
  v_mfma_f32_16x16x32_bf16 v[196:199], v[216:219], v[120:123], v[196:199]
  v_accvgpr_write_b32 a140, v250
  v_mfma_f32_16x16x32_bf16 v[200:203], v[216:219], v[124:127], v[200:203]
  s_add_u32 m0, s81, 22528
  s_nop 0
  buffer_load_dwordx4 v58, s[12:15], s80 offen lds
  v_mfma_f32_16x16x32_bf16 v[204:207], v[216:219], v[128:131], v[204:207]
  v_accvgpr_write_b32 a141, v251
  s_waitcnt lgkmcnt(0)
  v_mfma_f32_16x16x32_bf16 v[196:199], v[220:223], v[132:135], v[196:199]
  v_cvt_pk_bf16_f32 v174, v192, v193
  v_cvt_pk_bf16_f32 v175, v194, v195
  v_mfma_f32_16x16x32_bf16 v[200:203], v[220:223], v[136:139], v[200:203]
  s_add_u32 m0, s81, 23552
  s_nop 0
  buffer_load_dwordx4 v59, s[12:15], s80 offen lds
  s_add_u32 s80, s80, 393216
  v_mfma_f32_16x16x32_bf16 v[204:207], v[220:223], v[140:143], v[204:207]
  s_waitcnt vmcnt(14)
  ds_read_b128 v[208:211], v70 offset:0
  ds_read_b128 v[212:215], v71 offset:0
  ds_read_b128 v[216:219], v70 offset:128
  s_waitcnt lgkmcnt(2)
  v_mfma_f32_16x16x32_bf16 v[184:187], v[208:211], v[72:75], 0
  ds_read_b128 v[220:223], v71 offset:128
  v_mfma_f32_16x16x32_bf16 v[188:191], v[208:211], v[76:79], 0
  s_add_u32 m0, s81, 24576
  s_nop 0
  buffer_load_dwordx4 v48, s[12:15], s80 offen lds
  v_mfma_f32_16x16x32_bf16 v[192:195], v[208:211], v[80:83], 0
  s_waitcnt lgkmcnt(2)
  v_mfma_f32_16x16x32_bf16 v[184:187], v[212:215], v[84:87], v[184:187]
  ds_read_b128 v[208:211], v70 offset:256
  v_cvt_pk_bf16_f32 v248, v196, v197
  v_mfma_f32_16x16x32_bf16 v[188:191], v[212:215], v[88:91], v[188:191]
  s_add_u32 m0, s81, 25600
  s_nop 0
  buffer_load_dwordx4 v49, s[12:15], s80 offen lds
  v_mfma_f32_16x16x32_bf16 v[192:195], v[212:215], v[92:95], v[192:195]
  v_cvt_pk_bf16_f32 v249, v198, v199
  s_waitcnt lgkmcnt(2)
  v_mfma_f32_16x16x32_bf16 v[184:187], v[216:219], v[96:99], v[184:187]
  ds_read_b128 v[212:215], v71 offset:256
  v_cvt_pk_bf16_f32 v250, v200, v201
  v_mfma_f32_16x16x32_bf16 v[188:191], v[216:219], v[100:103], v[188:191]
  s_add_u32 m0, s81, 26624
  s_nop 0
  buffer_load_dwordx4 v50, s[12:15], s80 offen lds
  v_mfma_f32_16x16x32_bf16 v[192:195], v[216:219], v[104:107], v[192:195]
  v_cvt_pk_bf16_f32 v251, v202, v203
  s_waitcnt lgkmcnt(2)
  v_mfma_f32_16x16x32_bf16 v[184:187], v[220:223], v[108:111], v[184:187]
  ds_read_b128 v[216:219], v70 offset:768
  v_accvgpr_write_b32 a62, v248
  v_mfma_f32_16x16x32_bf16 v[188:191], v[220:223], v[112:115], v[188:191]
  s_add_u32 m0, s81, 27648
  s_nop 0
  buffer_load_dwordx4 v51, s[12:15], s80 offen lds
  v_mfma_f32_16x16x32_bf16 v[192:195], v[220:223], v[116:119], v[192:195]
  v_accvgpr_write_b32 a63, v249
  s_waitcnt lgkmcnt(2)
  v_mfma_f32_16x16x32_bf16 v[184:187], v[208:211], v[120:123], v[184:187]
  ds_read_b128 v[220:223], v71 offset:768
  v_accvgpr_write_b32 a142, v250
  v_mfma_f32_16x16x32_bf16 v[188:191], v[208:211], v[124:127], v[188:191]
  s_add_u32 m0, s81, 28672
  s_nop 0
  buffer_load_dwordx4 v52, s[12:15], s80 offen lds
  v_mfma_f32_16x16x32_bf16 v[192:195], v[208:211], v[128:131], v[192:195]
  v_accvgpr_write_b32 a143, v251
  s_waitcnt lgkmcnt(2)
  v_mfma_f32_16x16x32_bf16 v[184:187], v[212:215], v[132:135], v[184:187]
  ds_read_b128 v[208:211], v70 offset:896
  s_mov_b64 exec, s[68:69]
  v_cvt_pk_bf16_f32 v174, v204, v205
  v_cvt_pk_bf16_f32 v175, v206, v207
  s_mov_b64 exec, -1
  v_mfma_f32_16x16x32_bf16 v[188:191], v[212:215], v[136:139], v[188:191]
  s_add_u32 m0, s81, 29696
  s_nop 0
  buffer_load_dwordx4 v53, s[12:15], s80 offen lds
  v_mfma_f32_16x16x32_bf16 v[192:195], v[212:215], v[140:143], v[192:195]
  s_waitcnt lgkmcnt(2)
  v_mfma_f32_16x16x32_bf16 v[196:199], v[216:219], v[72:75], 0
  ds_read_b128 v[212:215], v71 offset:896
  v_mfma_f32_16x16x32_bf16 v[200:203], v[216:219], v[76:79], 0
  s_add_u32 m0, s81, 30720
  s_nop 0
  buffer_load_dwordx4 v54, s[12:15], s80 offen lds
  v_mfma_f32_16x16x32_bf16 v[204:207], v[216:219], v[80:83], 0
  s_waitcnt lgkmcnt(2)
  v_mfma_f32_16x16x32_bf16 v[196:199], v[220:223], v[84:87], v[196:199]
  ds_read_b128 v[216:219], v70 offset:1024
  v_cvt_pk_bf16_f32 v248, v184, v185
  v_mfma_f32_16x16x32_bf16 v[200:203], v[220:223], v[88:91], v[200:203]
  s_add_u32 m0, s81, 31744
  s_nop 0
  buffer_load_dwordx4 v55, s[12:15], s80 offen lds
  v_mfma_f32_16x16x32_bf16 v[204:207], v[220:223], v[92:95], v[204:207]
  v_cvt_pk_bf16_f32 v249, v186, v187
  s_waitcnt lgkmcnt(2)
  v_mfma_f32_16x16x32_bf16 v[196:199], v[208:211], v[96:99], v[196:199]
  ds_read_b128 v[220:223], v71 offset:1024
  v_cvt_pk_bf16_f32 v250, v188, v189
  v_mfma_f32_16x16x32_bf16 v[200:203], v[208:211], v[100:103], v[200:203]
  s_add_u32 m0, s81, 32768
  s_nop 0
  buffer_load_dwordx4 v56, s[12:15], s80 offen lds
  v_mfma_f32_16x16x32_bf16 v[204:207], v[208:211], v[104:107], v[204:207]
  v_cvt_pk_bf16_f32 v251, v190, v191
  s_waitcnt lgkmcnt(2)
  v_mfma_f32_16x16x32_bf16 v[196:199], v[212:215], v[108:111], v[196:199]
  v_accvgpr_write_b32 a64, v248
  v_mfma_f32_16x16x32_bf16 v[200:203], v[212:215], v[112:115], v[200:203]
  s_add_u32 m0, s81, 33792
  s_nop 0
  buffer_load_dwordx4 v57, s[12:15], s80 offen lds
  v_mfma_f32_16x16x32_bf16 v[204:207], v[212:215], v[116:119], v[204:207]
  v_accvgpr_write_b32 a65, v249
  s_waitcnt lgkmcnt(1)
  v_mfma_f32_16x16x32_bf16 v[196:199], v[216:219], v[120:123], v[196:199]
  v_accvgpr_write_b32 a144, v250
  v_mfma_f32_16x16x32_bf16 v[200:203], v[216:219], v[124:127], v[200:203]
  s_add_u32 m0, s81, 34816
  s_nop 0
  buffer_load_dwordx4 v58, s[12:15], s80 offen lds
  v_mfma_f32_16x16x32_bf16 v[204:207], v[216:219], v[128:131], v[204:207]
  v_accvgpr_write_b32 a145, v251
  s_waitcnt lgkmcnt(0)
  v_mfma_f32_16x16x32_bf16 v[196:199], v[220:223], v[132:135], v[196:199]
  v_cvt_pk_bf16_f32 v176, v192, v193
  v_cvt_pk_bf16_f32 v177, v194, v195
  v_mfma_f32_16x16x32_bf16 v[200:203], v[220:223], v[136:139], v[200:203]
  s_add_u32 m0, s81, 35840
  s_nop 0
  buffer_load_dwordx4 v59, s[12:15], s80 offen lds
  s_add_u32 s80, s80, 393216
  v_mfma_f32_16x16x32_bf16 v[204:207], v[220:223], v[140:143], v[204:207]
  s_waitcnt vmcnt(12)
  ds_read_b128 v[208:211], v70 offset:12288
  ds_read_b128 v[212:215], v71 offset:12288
  ds_read_b128 v[216:219], v70 offset:12416
  s_waitcnt lgkmcnt(2)
  v_mfma_f32_16x16x32_bf16 v[184:187], v[208:211], v[72:75], 0
  ds_read_b128 v[220:223], v71 offset:12416
  v_mfma_f32_16x16x32_bf16 v[188:191], v[208:211], v[76:79], 0
  s_add_u32 m0, s81, 0
  s_nop 0
  buffer_load_dwordx4 v48, s[12:15], s80 offen lds
  v_mfma_f32_16x16x32_bf16 v[192:195], v[208:211], v[80:83], 0
  s_waitcnt lgkmcnt(2)
  v_mfma_f32_16x16x32_bf16 v[184:187], v[212:215], v[84:87], v[184:187]
  ds_read_b128 v[208:211], v70 offset:12544
  v_cvt_pk_bf16_f32 v248, v196, v197
  v_mfma_f32_16x16x32_bf16 v[188:191], v[212:215], v[88:91], v[188:191]
  s_add_u32 m0, s81, 1024
  s_nop 0
  buffer_load_dwordx4 v49, s[12:15], s80 offen lds
  v_mfma_f32_16x16x32_bf16 v[192:195], v[212:215], v[92:95], v[192:195]
  v_cvt_pk_bf16_f32 v249, v198, v199
  s_waitcnt lgkmcnt(2)
  v_mfma_f32_16x16x32_bf16 v[184:187], v[216:219], v[96:99], v[184:187]
  ds_read_b128 v[212:215], v71 offset:12544
  v_cvt_pk_bf16_f32 v250, v200, v201
  v_mfma_f32_16x16x32_bf16 v[188:191], v[216:219], v[100:103], v[188:191]
  s_add_u32 m0, s81, 2048
  s_nop 0
  buffer_load_dwordx4 v50, s[12:15], s80 offen lds
  v_mfma_f32_16x16x32_bf16 v[192:195], v[216:219], v[104:107], v[192:195]
  v_cvt_pk_bf16_f32 v251, v202, v203
  s_waitcnt lgkmcnt(2)
  v_mfma_f32_16x16x32_bf16 v[184:187], v[220:223], v[108:111], v[184:187]
  ds_read_b128 v[216:219], v70 offset:13056
  v_accvgpr_write_b32 a66, v248
  v_mfma_f32_16x16x32_bf16 v[188:191], v[220:223], v[112:115], v[188:191]
  s_add_u32 m0, s81, 3072
  s_nop 0
  buffer_load_dwordx4 v51, s[12:15], s80 offen lds
  v_mfma_f32_16x16x32_bf16 v[192:195], v[220:223], v[116:119], v[192:195]
  v_accvgpr_write_b32 a67, v249
  s_waitcnt lgkmcnt(2)
  v_mfma_f32_16x16x32_bf16 v[184:187], v[208:211], v[120:123], v[184:187]
  ds_read_b128 v[220:223], v71 offset:13056
  v_accvgpr_write_b32 a146, v250
  v_mfma_f32_16x16x32_bf16 v[188:191], v[208:211], v[124:127], v[188:191]
  s_add_u32 m0, s81, 4096
  s_nop 0
  buffer_load_dwordx4 v52, s[12:15], s80 offen lds
  v_mfma_f32_16x16x32_bf16 v[192:195], v[208:211], v[128:131], v[192:195]
  v_accvgpr_write_b32 a147, v251
  s_waitcnt lgkmcnt(2)
  v_mfma_f32_16x16x32_bf16 v[184:187], v[212:215], v[132:135], v[184:187]
  ds_read_b128 v[208:211], v70 offset:13184
  s_mov_b64 exec, s[68:69]
  v_cvt_pk_bf16_f32 v176, v204, v205
  v_cvt_pk_bf16_f32 v177, v206, v207
  s_mov_b64 exec, -1
  v_mfma_f32_16x16x32_bf16 v[188:191], v[212:215], v[136:139], v[188:191]
  s_add_u32 m0, s81, 5120
  s_nop 0
  buffer_load_dwordx4 v53, s[12:15], s80 offen lds
  v_mfma_f32_16x16x32_bf16 v[192:195], v[212:215], v[140:143], v[192:195]
  s_waitcnt lgkmcnt(2)
  v_mfma_f32_16x16x32_bf16 v[196:199], v[216:219], v[72:75], 0
  ds_read_b128 v[212:215], v71 offset:13184
  v_mfma_f32_16x16x32_bf16 v[200:203], v[216:219], v[76:79], 0
  s_add_u32 m0, s81, 6144
  s_nop 0
  buffer_load_dwordx4 v54, s[12:15], s80 offen lds
  v_mfma_f32_16x16x32_bf16 v[204:207], v[216:219], v[80:83], 0
  s_waitcnt lgkmcnt(2)
  v_mfma_f32_16x16x32_bf16 v[196:199], v[220:223], v[84:87], v[196:199]
  ds_read_b128 v[216:219], v70 offset:13312
  v_cvt_pk_bf16_f32 v248, v184, v185
  v_mfma_f32_16x16x32_bf16 v[200:203], v[220:223], v[88:91], v[200:203]
  s_add_u32 m0, s81, 7168
  s_nop 0
  buffer_load_dwordx4 v55, s[12:15], s80 offen lds
  v_mfma_f32_16x16x32_bf16 v[204:207], v[220:223], v[92:95], v[204:207]
  v_cvt_pk_bf16_f32 v249, v186, v187
  s_waitcnt lgkmcnt(2)
  v_mfma_f32_16x16x32_bf16 v[196:199], v[208:211], v[96:99], v[196:199]
  ds_read_b128 v[220:223], v71 offset:13312
  v_cvt_pk_bf16_f32 v250, v188, v189
  v_mfma_f32_16x16x32_bf16 v[200:203], v[208:211], v[100:103], v[200:203]
  s_add_u32 m0, s81, 8192
  s_nop 0
  buffer_load_dwordx4 v56, s[12:15], s80 offen lds
  v_mfma_f32_16x16x32_bf16 v[204:207], v[208:211], v[104:107], v[204:207]
  v_cvt_pk_bf16_f32 v251, v190, v191
  s_waitcnt lgkmcnt(2)
  v_mfma_f32_16x16x32_bf16 v[196:199], v[212:215], v[108:111], v[196:199]
  v_accvgpr_write_b32 a68, v248
  v_mfma_f32_16x16x32_bf16 v[200:203], v[212:215], v[112:115], v[200:203]
  s_add_u32 m0, s81, 9216
  s_nop 0
  buffer_load_dwordx4 v57, s[12:15], s80 offen lds
  v_mfma_f32_16x16x32_bf16 v[204:207], v[212:215], v[116:119], v[204:207]
  v_accvgpr_write_b32 a69, v249
  s_waitcnt lgkmcnt(1)
  v_mfma_f32_16x16x32_bf16 v[196:199], v[216:219], v[120:123], v[196:199]
  v_accvgpr_write_b32 a148, v250
  v_mfma_f32_16x16x32_bf16 v[200:203], v[216:219], v[124:127], v[200:203]
  s_add_u32 m0, s81, 10240
  s_nop 0
  buffer_load_dwordx4 v58, s[12:15], s80 offen lds
  v_mfma_f32_16x16x32_bf16 v[204:207], v[216:219], v[128:131], v[204:207]
  v_accvgpr_write_b32 a149, v251
  s_waitcnt lgkmcnt(0)
  v_mfma_f32_16x16x32_bf16 v[196:199], v[220:223], v[132:135], v[196:199]
  v_cvt_pk_bf16_f32 v178, v192, v193
  v_cvt_pk_bf16_f32 v179, v194, v195
  v_mfma_f32_16x16x32_bf16 v[200:203], v[220:223], v[136:139], v[200:203]
  s_add_u32 m0, s81, 11264
  s_nop 0
  buffer_load_dwordx4 v59, s[12:15], s80 offen lds
  s_add_u32 s80, s80, 393216
  v_mfma_f32_16x16x32_bf16 v[204:207], v[220:223], v[140:143], v[204:207]
  s_waitcnt vmcnt(12)
  ds_read_b128 v[208:211], v70 offset:24576
  ds_read_b128 v[212:215], v71 offset:24576
  ds_read_b128 v[216:219], v70 offset:24704
  s_waitcnt lgkmcnt(2)
  v_mfma_f32_16x16x32_bf16 v[184:187], v[208:211], v[72:75], 0
  ds_read_b128 v[220:223], v71 offset:24704
  v_mfma_f32_16x16x32_bf16 v[188:191], v[208:211], v[76:79], 0
  v_mfma_f32_16x16x32_bf16 v[192:195], v[208:211], v[80:83], 0
  s_waitcnt lgkmcnt(2)
  v_mfma_f32_16x16x32_bf16 v[184:187], v[212:215], v[84:87], v[184:187]
  ds_read_b128 v[208:211], v70 offset:24832
  v_cvt_pk_bf16_f32 v248, v196, v197
  v_mfma_f32_16x16x32_bf16 v[188:191], v[212:215], v[88:91], v[188:191]
  v_mfma_f32_16x16x32_bf16 v[192:195], v[212:215], v[92:95], v[192:195]
  v_cvt_pk_bf16_f32 v249, v198, v199
  s_waitcnt lgkmcnt(2)
  v_mfma_f32_16x16x32_bf16 v[184:187], v[216:219], v[96:99], v[184:187]
  ds_read_b128 v[212:215], v71 offset:24832
  v_cvt_pk_bf16_f32 v250, v200, v201
  v_mfma_f32_16x16x32_bf16 v[188:191], v[216:219], v[100:103], v[188:191]
  v_mfma_f32_16x16x32_bf16 v[192:195], v[216:219], v[104:107], v[192:195]
  v_cvt_pk_bf16_f32 v251, v202, v203
  s_waitcnt lgkmcnt(2)
  v_mfma_f32_16x16x32_bf16 v[184:187], v[220:223], v[108:111], v[184:187]
  ds_read_b128 v[216:219], v70 offset:25344
  v_accvgpr_write_b32 a70, v248
  v_mfma_f32_16x16x32_bf16 v[188:191], v[220:223], v[112:115], v[188:191]
  v_mfma_f32_16x16x32_bf16 v[192:195], v[220:223], v[116:119], v[192:195]
  v_accvgpr_write_b32 a71, v249
  s_waitcnt lgkmcnt(2)
  v_mfma_f32_16x16x32_bf16 v[184:187], v[208:211], v[120:123], v[184:187]
  ds_read_b128 v[220:223], v71 offset:25344
  v_accvgpr_write_b32 a150, v250
  v_mfma_f32_16x16x32_bf16 v[188:191], v[208:211], v[124:127], v[188:191]
  v_mfma_f32_16x16x32_bf16 v[192:195], v[208:211], v[128:131], v[192:195]
  v_accvgpr_write_b32 a151, v251
  s_waitcnt lgkmcnt(2)
  v_mfma_f32_16x16x32_bf16 v[184:187], v[212:215], v[132:135], v[184:187]
  ds_read_b128 v[208:211], v70 offset:25472
  s_mov_b64 exec, s[68:69]
  v_cvt_pk_bf16_f32 v178, v204, v205
  v_cvt_pk_bf16_f32 v179, v206, v207
  s_mov_b64 exec, -1
  v_mfma_f32_16x16x32_bf16 v[188:191], v[212:215], v[136:139], v[188:191]
  v_mfma_f32_16x16x32_bf16 v[192:195], v[212:215], v[140:143], v[192:195]
  s_waitcnt lgkmcnt(2)
  v_mfma_f32_16x16x32_bf16 v[196:199], v[216:219], v[72:75], 0
  ds_read_b128 v[212:215], v71 offset:25472
  v_mfma_f32_16x16x32_bf16 v[200:203], v[216:219], v[76:79], 0
  v_mfma_f32_16x16x32_bf16 v[204:207], v[216:219], v[80:83], 0
  s_waitcnt lgkmcnt(2)
  v_mfma_f32_16x16x32_bf16 v[196:199], v[220:223], v[84:87], v[196:199]
  ds_read_b128 v[216:219], v70 offset:25600
  v_cvt_pk_bf16_f32 v248, v184, v185
  v_mfma_f32_16x16x32_bf16 v[200:203], v[220:223], v[88:91], v[200:203]
  v_mfma_f32_16x16x32_bf16 v[204:207], v[220:223], v[92:95], v[204:207]
  v_cvt_pk_bf16_f32 v249, v186, v187
  s_waitcnt lgkmcnt(2)
  v_mfma_f32_16x16x32_bf16 v[196:199], v[208:211], v[96:99], v[196:199]
  ds_read_b128 v[220:223], v71 offset:25600
  v_cvt_pk_bf16_f32 v250, v188, v189
  v_mfma_f32_16x16x32_bf16 v[200:203], v[208:211], v[100:103], v[200:203]
  v_mfma_f32_16x16x32_bf16 v[204:207], v[208:211], v[104:107], v[204:207]
  v_cvt_pk_bf16_f32 v251, v190, v191
  s_waitcnt lgkmcnt(2)
  v_mfma_f32_16x16x32_bf16 v[196:199], v[212:215], v[108:111], v[196:199]
  v_accvgpr_write_b32 a72, v248
  v_mfma_f32_16x16x32_bf16 v[200:203], v[212:215], v[112:115], v[200:203]
  v_mfma_f32_16x16x32_bf16 v[204:207], v[212:215], v[116:119], v[204:207]
  v_accvgpr_write_b32 a73, v249
  s_waitcnt lgkmcnt(1)
  v_mfma_f32_16x16x32_bf16 v[196:199], v[216:219], v[120:123], v[196:199]
  v_accvgpr_write_b32 a152, v250
  v_mfma_f32_16x16x32_bf16 v[200:203], v[216:219], v[124:127], v[200:203]
  v_mfma_f32_16x16x32_bf16 v[204:207], v[216:219], v[128:131], v[204:207]
  v_accvgpr_write_b32 a153, v251
  s_waitcnt lgkmcnt(0)
  v_mfma_f32_16x16x32_bf16 v[196:199], v[220:223], v[132:135], v[196:199]
  v_cvt_pk_bf16_f32 v180, v192, v193
  v_cvt_pk_bf16_f32 v181, v194, v195
  v_mfma_f32_16x16x32_bf16 v[200:203], v[220:223], v[136:139], v[200:203]
  v_mfma_f32_16x16x32_bf16 v[204:207], v[220:223], v[140:143], v[204:207]
  s_waitcnt vmcnt(0)
  ds_read_b128 v[208:211], v70 offset:0
  ds_read_b128 v[212:215], v71 offset:0
  ds_read_b128 v[216:219], v70 offset:128
  s_waitcnt lgkmcnt(2)
  v_mfma_f32_16x16x32_bf16 v[184:187], v[208:211], v[72:75], 0
  ds_read_b128 v[220:223], v71 offset:128
  v_mfma_f32_16x16x32_bf16 v[188:191], v[208:211], v[76:79], 0
  v_mfma_f32_16x16x32_bf16 v[192:195], v[208:211], v[80:83], 0
  s_waitcnt lgkmcnt(2)
  v_mfma_f32_16x16x32_bf16 v[184:187], v[212:215], v[84:87], v[184:187]
  ds_read_b128 v[208:211], v70 offset:256
  v_cvt_pk_bf16_f32 v248, v196, v197
  v_mfma_f32_16x16x32_bf16 v[188:191], v[212:215], v[88:91], v[188:191]
  v_mfma_f32_16x16x32_bf16 v[192:195], v[212:215], v[92:95], v[192:195]
  v_cvt_pk_bf16_f32 v249, v198, v199
  s_waitcnt lgkmcnt(2)
  v_mfma_f32_16x16x32_bf16 v[184:187], v[216:219], v[96:99], v[184:187]
  ds_read_b128 v[212:215], v71 offset:256
  v_cvt_pk_bf16_f32 v250, v200, v201
  v_mfma_f32_16x16x32_bf16 v[188:191], v[216:219], v[100:103], v[188:191]
  v_mfma_f32_16x16x32_bf16 v[192:195], v[216:219], v[104:107], v[192:195]
  v_cvt_pk_bf16_f32 v251, v202, v203
  s_waitcnt lgkmcnt(2)
  v_mfma_f32_16x16x32_bf16 v[184:187], v[220:223], v[108:111], v[184:187]
  ds_read_b128 v[216:219], v70 offset:768
  v_accvgpr_write_b32 a74, v248
  v_mfma_f32_16x16x32_bf16 v[188:191], v[220:223], v[112:115], v[188:191]
  v_mfma_f32_16x16x32_bf16 v[192:195], v[220:223], v[116:119], v[192:195]
  v_accvgpr_write_b32 a75, v249
  s_waitcnt lgkmcnt(2)
  v_mfma_f32_16x16x32_bf16 v[184:187], v[208:211], v[120:123], v[184:187]
  ds_read_b128 v[220:223], v71 offset:768
  v_accvgpr_write_b32 a154, v250
  v_mfma_f32_16x16x32_bf16 v[188:191], v[208:211], v[124:127], v[188:191]
  v_mfma_f32_16x16x32_bf16 v[192:195], v[208:211], v[128:131], v[192:195]
  v_accvgpr_write_b32 a155, v251
  s_waitcnt lgkmcnt(2)
  v_mfma_f32_16x16x32_bf16 v[184:187], v[212:215], v[132:135], v[184:187]
  ds_read_b128 v[208:211], v70 offset:896
  s_mov_b64 exec, s[68:69]
  v_cvt_pk_bf16_f32 v180, v204, v205
  v_cvt_pk_bf16_f32 v181, v206, v207
  s_mov_b64 exec, -1
  v_mfma_f32_16x16x32_bf16 v[188:191], v[212:215], v[136:139], v[188:191]
  v_mfma_f32_16x16x32_bf16 v[192:195], v[212:215], v[140:143], v[192:195]
  s_waitcnt lgkmcnt(2)
  v_mfma_f32_16x16x32_bf16 v[196:199], v[216:219], v[72:75], 0
  ds_read_b128 v[212:215], v71 offset:896
  v_mfma_f32_16x16x32_bf16 v[200:203], v[216:219], v[76:79], 0
  v_mfma_f32_16x16x32_bf16 v[204:207], v[216:219], v[80:83], 0
  s_waitcnt lgkmcnt(2)
  v_mfma_f32_16x16x32_bf16 v[196:199], v[220:223], v[84:87], v[196:199]
  ds_read_b128 v[216:219], v70 offset:1024
  v_cvt_pk_bf16_f32 v248, v184, v185
  v_mfma_f32_16x16x32_bf16 v[200:203], v[220:223], v[88:91], v[200:203]
  v_mfma_f32_16x16x32_bf16 v[204:207], v[220:223], v[92:95], v[204:207]
  v_cvt_pk_bf16_f32 v249, v186, v187
  s_waitcnt lgkmcnt(2)
  v_mfma_f32_16x16x32_bf16 v[196:199], v[208:211], v[96:99], v[196:199]
  ds_read_b128 v[220:223], v71 offset:1024
  v_cvt_pk_bf16_f32 v250, v188, v189
  v_mfma_f32_16x16x32_bf16 v[200:203], v[208:211], v[100:103], v[200:203]
  v_mfma_f32_16x16x32_bf16 v[204:207], v[208:211], v[104:107], v[204:207]
  v_cvt_pk_bf16_f32 v251, v190, v191
  s_waitcnt lgkmcnt(2)
  v_mfma_f32_16x16x32_bf16 v[196:199], v[212:215], v[108:111], v[196:199]
  v_accvgpr_write_b32 a76, v248
  v_mfma_f32_16x16x32_bf16 v[200:203], v[212:215], v[112:115], v[200:203]
  v_mfma_f32_16x16x32_bf16 v[204:207], v[212:215], v[116:119], v[204:207]
  v_accvgpr_write_b32 a77, v249
  s_waitcnt lgkmcnt(1)
  v_mfma_f32_16x16x32_bf16 v[196:199], v[216:219], v[120:123], v[196:199]
  v_accvgpr_write_b32 a156, v250
  v_mfma_f32_16x16x32_bf16 v[200:203], v[216:219], v[124:127], v[200:203]
  v_mfma_f32_16x16x32_bf16 v[204:207], v[216:219], v[128:131], v[204:207]
  v_accvgpr_write_b32 a157, v251
  s_waitcnt lgkmcnt(0)
  v_mfma_f32_16x16x32_bf16 v[196:199], v[220:223], v[132:135], v[196:199]
  v_cvt_pk_bf16_f32 v182, v192, v193
  v_cvt_pk_bf16_f32 v183, v194, v195
  v_mfma_f32_16x16x32_bf16 v[200:203], v[220:223], v[136:139], v[200:203]
  v_mfma_f32_16x16x32_bf16 v[204:207], v[220:223], v[140:143], v[204:207]
  s_nop 7
  v_cvt_pk_bf16_f32 v248, v196, v197
  v_cvt_pk_bf16_f32 v249, v198, v199
  v_cvt_pk_bf16_f32 v250, v200, v201
  v_cvt_pk_bf16_f32 v251, v202, v203
  v_accvgpr_write_b32 a78, v248
  v_accvgpr_write_b32 a79, v249
  v_accvgpr_write_b32 a158, v250
  v_accvgpr_write_b32 a159, v251
  s_mov_b64 exec, s[68:69]
  v_cvt_pk_bf16_f32 v182, v204, v205
  v_cvt_pk_bf16_f32 v183, v206, v207
  s_mov_b64 exec, -1
  s_waitcnt vmcnt(0)
  s_barrier
  s_mul_i32 s21, s20, 15360
  v_add_u32 v66, s21, v4
  v_add_u32 v67, 61440, v66
  ds_write_b128 v66, a[160:163] offset:0
  ds_write_b128 v66, a[164:167] offset:1024
  ds_write_b128 v66, a[168:171] offset:2048
  ds_write_b128 v66, a[172:175] offset:3072
  ds_write_b128 v66, a[176:179] offset:4096
  ds_write_b128 v66, a[180:183] offset:5120
  ds_write_b128 v66, a[184:187] offset:6144
  ds_write_b128 v66, a[188:191] offset:7168
  ds_write_b128 v66, a[192:195] offset:8192
  ds_write_b128 v66, a[196:199] offset:9216
  ds_write_b128 v66, a[200:203] offset:10240
  ds_write_b128 v66, a[204:207] offset:11264
  ds_write_b128 v66, a[208:211] offset:12288
  ds_write_b128 v66, a[212:215] offset:13312
  ds_write_b128 v66, a[216:219] offset:14336
  ds_write_b128 v67, a[220:223] offset:0
  ds_write_b128 v67, a[224:227] offset:1024
  ds_write_b128 v67, a[228:231] offset:2048
  ds_write_b128 v67, a[232:235] offset:3072
  ds_write_b128 v67, a[236:239] offset:4096
  ds_write_b128 v67, a[240:243] offset:5120
  ds_write_b128 v67, a[244:247] offset:6144
  ds_write_b128 v67, a[248:251] offset:7168
  ds_write_b128 v67, a[252:255] offset:8192
  ds_write_b128 v67, v[224:227] offset:9216
  ds_write_b128 v67, v[228:231] offset:10240
  ds_write_b128 v67, v[232:235] offset:11264
  ds_write_b128 v67, v[236:239] offset:12288
  ds_write_b128 v67, v[240:243] offset:13312
  ds_write_b128 v67, v[244:247] offset:14336
  s_lshr_b32 s21, s20, 1
  s_mul_i32 s21, s21, 20480
  s_and_b32 s22, s20, 1
  s_lshl_b32 s22, s22, 7
  s_add_u32 s21, s21, s22
  s_add_u32 s21, s21, 122880
  v_and_b32 v68, 7, v2
  v_lshlrev_b32 v68, 4, v68
  v_lshl_add_u32 v68, v3, 8, v68
  v_and_b32 v69, 8, v2
  v_add3_u32 v68, s21, v68, v69
  ds_write_b64 v68, v[144:145] offset:0
  ds_write_b64 v68, v[146:147] offset:1024
  ds_write_b64 v68, v[148:149] offset:2048
  ds_write_b64 v68, v[150:151] offset:3072
  ds_write_b64 v68, v[152:153] offset:4096
  ds_write_b64 v68, v[154:155] offset:5120
  ds_write_b64 v68, v[156:157] offset:6144
  ds_write_b64 v68, v[158:159] offset:7168
  ds_write_b64 v68, v[160:161] offset:8192
  ds_write_b64 v68, v[162:163] offset:9216
  ds_write_b64 v68, v[164:165] offset:10240
  ds_write_b64 v68, v[166:167] offset:11264
  ds_write_b64 v68, v[168:169] offset:12288
  ds_write_b64 v68, v[170:171] offset:13312
  ds_write_b64 v68, v[172:173] offset:14336
  ds_write_b64 v68, v[174:175] offset:15360
  ds_write_b64 v68, v[176:177] offset:16384
  ds_write_b64 v68, v[178:179] offset:17408
  ds_write_b64 v68, v[180:181] offset:18432
  ds_write_b64 v68, v[182:183] offset:19456
  v_lshrrev_b32 v72, 1, v3
  v_lshlrev_b32 v72, 4, v72
  v_and_b32 v73, 8, v2
  v_add_u32 v72, v72, v73
  v_and_b32 v73, 1, v3
  v_lshl_add_u32 v72, v73, 2, v72
  v_bfe_u32 v73, v2, 2, 1
  v_add_u32 v72, v72, v73
  v_mul_u32_u24 v72, 96, v72
  v_and_b32 v73, 3, v2
  v_lshl_add_u32 v72, v73, 3, v72
  s_lshl_b32 s21, s20, 5
  v_add_u32 v72, s21, v72
  v_add_u32 v73, 61440, v72
  v_cndmask_b32 v66, v72, v73, s[68:69]
  v_cndmask_b32 v67, v73, v72, s[68:69]
  v_add_u32 v68, 122880, v4
  s_waitcnt lgkmcnt(0)
  s_barrier
  s_cmp_eq_u32 s20, 3
  s_cbranch_scc1 w3_12
  ds_read_b64_tr_b16 a[160:161], v66 offset:0
  ds_read_b64_tr_b16 a[162:163], v66 offset:192
  ds_read_b64_tr_b16 a[164:165], v66 offset:3072
  ds_read_b64_tr_b16 a[166:167], v66 offset:3264
  ds_read_b64_tr_b16 a[168:169], v66 offset:6144
  ds_read_b64_tr_b16 a[170:171], v66 offset:6336
  ds_read_b64_tr_b16 a[172:173], v66 offset:9216
  ds_read_b64_tr_b16 a[174:175], v66 offset:9408
  ds_read_b64_tr_b16 a[176:177], v66 offset:12288
  ds_read_b64_tr_b16 a[178:179], v66 offset:12480
  ds_read_b64_tr_b16 a[180:181], v66 offset:15360
  ds_read_b64_tr_b16 a[182:183], v66 offset:15552
  ds_read_b64_tr_b16 a[184:185], v66 offset:18432
  ds_read_b64_tr_b16 a[186:187], v66 offset:18624
  ds_read_b64_tr_b16 a[188:189], v66 offset:21504
  ds_read_b64_tr_b16 a[190:191], v66 offset:21696
  ds_read_b64_tr_b16 a[192:193], v66 offset:24576
  ds_read_b64_tr_b16 a[194:195], v66 offset:24768
  ds_read_b64_tr_b16 a[196:197], v66 offset:27648
  ds_read_b64_tr_b16 a[198:199], v66 offset:27840
  ds_read_b64_tr_b16 a[200:201], v66 offset:30720
  ds_read_b64_tr_b16 a[202:203], v66 offset:30912
  ds_read_b64_tr_b16 a[204:205], v66 offset:33792
  ds_read_b64_tr_b16 a[206:207], v66 offset:33984
  ds_read_b64_tr_b16 a[208:209], v66 offset:36864
  ds_read_b64_tr_b16 a[210:211], v66 offset:37056
  ds_read_b64_tr_b16 a[212:213], v66 offset:39936
  ds_read_b64_tr_b16 a[214:215], v66 offset:40128
  ds_read_b64_tr_b16 a[216:217], v66 offset:43008
  ds_read_b64_tr_b16 a[218:219], v66 offset:43200
  ds_read_b64_tr_b16 a[220:221], v66 offset:46080
  ds_read_b64_tr_b16 a[222:223], v66 offset:46272
  ds_read_b64_tr_b16 a[224:225], v66 offset:49152
  ds_read_b64_tr_b16 a[226:227], v66 offset:49344
  ds_read_b64_tr_b16 a[228:229], v66 offset:52224
  ds_read_b64_tr_b16 a[230:231], v66 offset:52416
  ds_read_b64_tr_b16 a[232:233], v66 offset:55296
  ds_read_b64_tr_b16 a[234:235], v66 offset:55488
  ds_read_b64_tr_b16 a[236:237], v66 offset:58368
  ds_read_b64_tr_b16 a[238:239], v66 offset:58560
  ds_read_b64_tr_b16 a[240:241], v67 offset:0
  ds_read_b64_tr_b16 a[242:243], v67 offset:192
  ds_read_b64_tr_b16 a[244:245], v67 offset:3072
  ds_read_b64_tr_b16 a[246:247], v67 offset:3264
  ds_read_b64_tr_b16 a[248:249], v67 offset:6144
  ds_read_b64_tr_b16 a[250:251], v67 offset:6336
  ds_read_b64_tr_b16 a[252:253], v67 offset:9216
  ds_read_b64_tr_b16 a[254:255], v67 offset:9408
  ds_read_b64_tr_b16 v[192:193], v67 offset:12288
  ds_read_b64_tr_b16 v[194:195], v67 offset:12480
  ds_read_b64_tr_b16 v[196:197], v67 offset:15360
  ds_read_b64_tr_b16 v[198:199], v67 offset:15552
  ds_read_b64_tr_b16 v[200:201], v67 offset:18432
  ds_read_b64_tr_b16 v[202:203], v67 offset:18624
  ds_read_b64_tr_b16 v[204:205], v67 offset:21504
  ds_read_b64_tr_b16 v[206:207], v67 offset:21696
  ds_read_b64_tr_b16 v[208:209], v67 offset:24576
  ds_read_b64_tr_b16 v[210:211], v67 offset:24768
  ds_read_b64_tr_b16 v[212:213], v67 offset:27648
  ds_read_b64_tr_b16 v[214:215], v67 offset:27840
  ds_read_b64_tr_b16 v[216:217], v67 offset:30720
  ds_read_b64_tr_b16 v[218:219], v67 offset:30912
  ds_read_b64_tr_b16 v[220:221], v67 offset:33792
  ds_read_b64_tr_b16 v[222:223], v67 offset:33984
  ds_read_b64_tr_b16 v[224:225], v67 offset:36864
  ds_read_b64_tr_b16 v[226:227], v67 offset:37056
  ds_read_b64_tr_b16 v[228:229], v67 offset:39936
  ds_read_b64_tr_b16 v[230:231], v67 offset:40128
  ds_read_b64_tr_b16 v[232:233], v67 offset:43008
  ds_read_b64_tr_b16 v[234:235], v67 offset:43200
  ds_read_b64_tr_b16 v[236:237], v67 offset:46080
  ds_read_b64_tr_b16 v[238:239], v67 offset:46272
  ds_read_b64_tr_b16 v[240:241], v67 offset:49152
  ds_read_b64_tr_b16 v[242:243], v67 offset:49344
  ds_read_b64_tr_b16 v[244:245], v67 offset:52224
  ds_read_b64_tr_b16 v[246:247], v67 offset:52416
  ds_read_b64_tr_b16 v[248:249], v67 offset:55296
  ds_read_b64_tr_b16 v[250:251], v67 offset:55488
  ds_read_b64_tr_b16 v[252:253], v67 offset:58368
  ds_read_b64_tr_b16 v[254:255], v67 offset:58560
  s_branch w3_13
w3_12:
  ds_read_b128 a[160:163], v68 offset:0
  ds_read_b128 a[164:167], v68 offset:1024
  ds_read_b128 a[168:171], v68 offset:2048
  ds_read_b128 a[172:175], v68 offset:3072
  ds_read_b128 a[176:179], v68 offset:4096
  ds_read_b128 a[180:183], v68 offset:5120
  ds_read_b128 a[184:187], v68 offset:6144
  ds_read_b128 a[188:191], v68 offset:7168
  ds_read_b128 a[192:195], v68 offset:8192
  ds_read_b128 a[196:199], v68 offset:9216
  ds_read_b128 a[200:203], v68 offset:10240
  ds_read_b128 a[204:207], v68 offset:11264
  ds_read_b128 a[208:211], v68 offset:12288
  ds_read_b128 a[212:215], v68 offset:13312
  ds_read_b128 a[216:219], v68 offset:14336
  ds_read_b128 a[220:223], v68 offset:15360
  ds_read_b128 a[224:227], v68 offset:16384
  ds_read_b128 a[228:231], v68 offset:17408
  ds_read_b128 a[232:235], v68 offset:18432
  ds_read_b128 a[236:239], v68 offset:19456
  ds_read_b128 a[240:243], v68 offset:20480
  ds_read_b128 a[244:247], v68 offset:21504
  ds_read_b128 a[248:251], v68 offset:22528
  ds_read_b128 a[252:255], v68 offset:23552
  ds_read_b128 v[192:195], v68 offset:24576
  ds_read_b128 v[196:199], v68 offset:25600
  ds_read_b128 v[200:203], v68 offset:26624
  ds_read_b128 v[204:207], v68 offset:27648
  ds_read_b128 v[208:211], v68 offset:28672
  ds_read_b128 v[212:215], v68 offset:29696
  ds_read_b128 v[216:219], v68 offset:30720
  ds_read_b128 v[220:223], v68 offset:31744
  ds_read_b128 v[224:227], v68 offset:32768
  ds_read_b128 v[228:231], v68 offset:33792
  ds_read_b128 v[232:235], v68 offset:34816
  ds_read_b128 v[236:239], v68 offset:35840
  ds_read_b128 v[240:243], v68 offset:36864
  ds_read_b128 v[244:247], v68 offset:37888
  ds_read_b128 v[248:251], v68 offset:38912
  ds_read_b128 v[252:255], v68 offset:39936
w3_13:
  s_waitcnt lgkmcnt(0)
  s_barrier
  v_and_b32 v72, 7, v1
  v_mul_u32_u24 v72, 1280, v72
  v_lshrrev_b32 v73, 3, v1
  v_lshl_add_u32 v72, v73, 4, v72
  s_mul_i32 s21, s20, 3
  s_min_u32 s21, s21, 7
  s_lshl_b32 s22, s21, 7
  s_lshl_b32 s21, s21, 10
  s_add_u32 m0, s21, 0
  s_add_u32 s23, s22, 0
  buffer_load_dwordx4 v72, s[36:39], s23 offen lds
  s_add_u32 m0, s21, 1024
  s_add_u32 s23, s22, 128
  buffer_load_dwordx4 v72, s[36:39], s23 offen lds
  s_add_u32 m0, s21, 2048
  s_add_u32 s23, s22, 256
  buffer_load_dwordx4 v72, s[36:39], s23 offen lds
  v_mov_b32 v76, 0x3f803f80
  v_mov_b32 v77, 0x3f803f80
  v_mov_b32 v78, 0x3f803f80
  v_mov_b32 v79, 0x3f803f80
  v_mov_b32 v80, 0x3f003f00
  v_mov_b32 v81, 0x3f003f00
  ds_write_b128 v23, v[76:79] offset:46080
  ds_write_b128 v23, v[76:79] offset:62464
  ds_write_b64 v23, v[80:81] offset:13568
  s_waitcnt vmcnt(0)
  s_add_u32 s12, s48, 81068032
  s_addc_u32 s13, s49, 0
  s_mov_b32 s14, 96768
  s_mov_b32 s15, 0x00020000
  s_mov_b32 s16, s48
  s_mov_b32 s17, s49
  s_mov_b32 s18, 25165824
  s_mov_b32 s19, 0x00020000
  s_add_u32 s24, s48, 50331648
  s_addc_u32 s25, s49, 0
  s_mov_b32 s26, 6291456
  s_mov_b32 s27, 0x00020000
  s_add_u32 s28, s48, 114294784
  s_addc_u32 s29, s49, 0
  s_mov_b32 s30, 83886080
  s_mov_b32 s31, 0x00020000
  s_add_u32 s36, s48, 93323264
  s_addc_u32 s37, s49, 0
  s_mov_b32 s38, 20971520
  s_mov_b32 s39, 0x00020000
  s_lshl_b32 s76, s50, 9
  s_and_b32 s21, s51, 12
  s_add_u32 s76, s76, s21
  s_add_u32 s76, s76, 88576
  s_cmp_lg_u32 s20, 0
  s_cbranch_scc1 fm_15
  v_lshlrev_b32 v67, 2, v1
  s_bfe_u32 s82, s50, 0x10001
  s_lshl_b32 s82, s82, 5
  s_lshr_b32 s21, s50, 2
  s_add_u32 s82, s82, s21
  s_mov_b32 s101, 0
  s_mov_b32 s83, 0
  s_branch fm_16
fm_14:
  s_sleep 8
fm_16:
  buffer_load_dword v66, v67, s[32:35], 0 offen sc1
  buffer_load_dword v42, v41, s[12:15], s76 offen sc1
  s_add_u32 s101, s101, 1
  s_cmp_gt_u32 s101, 131072
  s_cbranch_scc1 end0
  s_waitcnt vmcnt(0)
  s_mov_b32 s84, s83
  v_readlane_b32 s83, v66, 19
  s_cmp_eq_u32 s83, 0
  s_cbranch_scc1 fm_14
  s_cmp_eq_u32 s84, 0
  s_cbranch_scc1 fm_16
  v_readlane_b32 s22, v66, 0
  v_readlane_b32 s23, v66, 32
  s_add_u32 s22, s22, s23
  v_readlane_b32 s23, v66, 1
  s_add_u32 s22, s22, s23
  v_readlane_b32 s23, v66, 33
  s_add_u32 s22, s22, s23
  v_readlane_b32 s23, v66, 2
  s_add_u32 s22, s22, s23
  v_readlane_b32 s23, v66, 34
  s_add_u32 s22, s22, s23
  v_readlane_b32 s23, v66, 3
  s_add_u32 s22, s22, s23
  v_readlane_b32 s23, v66, 35
  s_add_u32 s22, s22, s23
  v_readlane_b32 s21, v66, 16
  v_readlane_b32 s23, v66, 21
  v_cmp_gt_u32 vcc, 2, v42
  s_cmp_ge_u32 s22, 256
  s_cselect_b32 s23, s23, 0
  s_cmp_ge_u32 s21, 128
  s_cselect_b32 s23, s23, 0
  s_cbranch_vccnz fm_14
  s_cmp_eq_u32 s23, 0
  s_cbranch_scc1 fm_14
  v_readlane_b32 s21, v66, s82
  v_cmp_ne_u32 vcc, 32, v66
  s_cmp_ge_u32 s21, 32
  s_cselect_b32 s84, 1, 0
  s_andn2_b32 s53, s84, s53
  s_and_b32 s21, vcc_lo, 15
  s_and_b32 s22, vcc_hi, 15
  s_or_b32 s21, s21, s22
  v_mov_b32 v76, s23
  v_mov_b32 v77, s53
  v_mov_b32 v78, s21
  ds_write_b96 v23, v[76:78] offset:13824
fm_15:
  s_waitcnt lgkmcnt(0)
  s_barrier
  ds_read_b96 v[76:78], v23 offset:13824
  s_mul_i32 s72, s57, 40960
  s_mul_i32 s21, s60, 5120
  s_add_u32 s72, s72, s21
  s_mul_i32 s79, s61, 3072
  s_add_u32 s79, s79, s72
  s_mul_i32 s73, s58, 12288
  s_mul_i32 s21, s56, 3072
  s_add_u32 s73, s73, s21
  s_mov_b32 s74, 32768
  s_mul_i32 s70, s58, 3072
  s_mul_i32 s71, s57, 10240
  s_mul_i32 s21, s51, 640
  s_add_u32 s71, s71, s21
  s_cmp_lg_u32 s20, 3
  s_cbranch_scc1 pd_18
  s_add_u32 m0, s74, 10240
  s_nop 0
  buffer_load_dwordx4 v4, s[16:19], s73 offen offset:0 sc1 lds
  s_add_u32 m0, s74, 10240
  s_nop 0
  buffer_load_dwordx4 v4, s[16:19], s73 offen offset:1024 sc1 lds
  s_add_u32 m0, s74, 10240
  s_nop 0
  buffer_load_dwordx4 v4, s[16:19], s73 offen offset:2048 sc1 lds
  s_add_u32 m0, s74, 8192
  s_add_u32 s21, s72, 2048
  buffer_load_dwordx4 v32, s[28:31], s21 offen sc1 lds
  s_add_u32 m0, s74, 9216
  s_add_u32 s21, s72, 83968
  buffer_load_dwordx4 v32, s[28:31], s21 offen sc1 lds
  s_add_u32 m0, s74, 0
  s_add_u32 s21, s79, 0
  buffer_load_dwordx4 v4, s[28:31], s21 offen sc1 lds
  s_add_u32 m0, s74, 1024
  s_add_u32 s21, s79, 1024
  buffer_load_dwordx4 v4, s[28:31], s21 offen sc1 lds
  s_add_u32 m0, s74, 2048
  s_add_u32 s21, s79, 40960
  buffer_load_dwordx4 v4, s[28:31], s21 offen sc1 lds
  s_add_u32 m0, s74, 3072
  s_add_u32 s21, s79, 41984
  buffer_load_dwordx4 v4, s[28:31], s21 offen sc1 lds
  s_add_u32 m0, s74, 4096
  s_add_u32 s21, s79, 81920
  buffer_load_dwordx4 v4, s[28:31], s21 offen sc1 lds
  s_add_u32 m0, s74, 5120
  s_add_u32 s21, s79, 82944
  buffer_load_dwordx4 v4, s[28:31], s21 offen sc1 lds
  s_add_u32 m0, s74, 6144
  s_add_u32 s21, s79, 122880
  buffer_load_dwordx4 v4, s[28:31], s21 offen sc1 lds
  s_add_u32 m0, s74, 7168
  s_add_u32 s21, s79, 123904
  buffer_load_dwordx4 v4, s[28:31], s21 offen sc1 lds
  s_add_u32 s72, s72, 1310720
  s_add_u32 s79, s79, 1310720
  s_add_u32 s73, s73, 393216
  s_xor_b32 s74, s74, 16384
  s_add_u32 m0, s74, 8192
  s_add_u32 s21, s72, 2048
  buffer_load_dwordx4 v32, s[28:31], s21 offen sc1 lds
  s_add_u32 m0, s74, 9216
  s_add_u32 s21, s72, 83968
  buffer_load_dwordx4 v32, s[28:31], s21 offen sc1 lds
  s_add_u32 m0, s74, 0
  s_add_u32 s21, s79, 0
  buffer_load_dwordx4 v4, s[28:31], s21 offen sc1 lds
  s_add_u32 m0, s74, 1024
  s_add_u32 s21, s79, 1024
  buffer_load_dwordx4 v4, s[28:31], s21 offen sc1 lds
  s_add_u32 m0, s74, 2048
  s_add_u32 s21, s79, 40960
  buffer_load_dwordx4 v4, s[28:31], s21 offen sc1 lds
  s_add_u32 m0, s74, 3072
  s_add_u32 s21, s79, 41984
  buffer_load_dwordx4 v4, s[28:31], s21 offen sc1 lds
  s_add_u32 m0, s74, 4096
  s_add_u32 s21, s79, 81920
  buffer_load_dwordx4 v4, s[28:31], s21 offen sc1 lds
  s_add_u32 m0, s74, 5120
  s_add_u32 s21, s79, 82944
  buffer_load_dwordx4 v4, s[28:31], s21 offen sc1 lds
  s_add_u32 m0, s74, 6144
  s_add_u32 s21, s79, 122880
  buffer_load_dwordx4 v4, s[28:31], s21 offen sc1 lds
  s_add_u32 m0, s74, 7168
  s_add_u32 s21, s79, 123904
  buffer_load_dwordx4 v4, s[28:31], s21 offen sc1 lds
  v_mov_b32 v42, 0
  s_branch pd_19
pd_18:
  s_add_u32 s72, s72, 1310720
  s_add_u32 s79, s79, 1310720
  s_add_u32 s73, s73, 393216
  s_xor_b32 s74, s74, 16384
  s_add_u32 s72, s72, 1310720
  s_add_u32 s79, s79, 1310720
  s_add_u32 s73, s73, 393216
  s_xor_b32 s74, s74, 16384
pd_19:
  s_waitcnt lgkmcnt(0)
  v_readfirstlane_b32 s53, v77
  v_readfirstlane_b32 s21, v78
  s_cmp_eq_u32 s21, 0
  s_cbranch_scc1 fm_17
  s_cmp_eq_u32 s20, 3
  s_cbranch_scc1 ar_21
  s_mov_b64 exec, s[64:65]
  s_cmp_eq_u32 s20, 2
  s_cbranch_scc1 ar_20
  s_mov_b32 s21, 0
  buffer_store_dwordx2 v[28:29], v8, s[8:11], s21 offen sc1
  s_mov_b32 s21, 122880
  buffer_store_dwordx2 v[28:29], v8, s[8:11], s21 offen sc1
  s_mov_b32 s21, 245760
  buffer_store_dwordx2 v[28:29], v8, s[8:11], s21 offen sc1
  s_mov_b32 s21, 368640
  buffer_store_dwordx2 v[28:29], v8, s[8:11], s21 offen sc1
  s_branch ar_22
ar_20:
  s_mov_b32 s21, 0
  buffer_store_dword v28, v8, s[8:11], s21 offen sc1
  buffer_store_dword v28, v8, s[8:11], s21 offen offset:128 sc1
  s_mov_b32 s21, 122880
  buffer_store_dword v28, v8, s[8:11], s21 offen sc1
  buffer_store_dword v28, v8, s[8:11], s21 offen offset:128 sc1
  s_mov_b32 s21, 245760
  buffer_store_dword v28, v8, s[8:11], s21 offen sc1
  buffer_store_dword v28, v8, s[8:11], s21 offen offset:128 sc1
  s_mov_b32 s21, 368640
  buffer_store_dword v28, v8, s[8:11], s21 offen sc1
  buffer_store_dword v28, v8, s[8:11], s21 offen offset:128 sc1
ar_22:
  s_cmp_eq_u32 s78, 0
  s_cbranch_scc1 ar_23
  s_mov_b64 exec, s[62:63]
  s_add_u32 s21, s77, 0
  buffer_store_dword v28, v17, s[8:11], s21 offen sc1
  s_add_u32 s21, s77, 122880
  buffer_store_dword v28, v17, s[8:11], s21 offen sc1
  s_add_u32 s21, s77, 245760
  buffer_store_dword v28, v17, s[8:11], s21 offen sc1
  s_add_u32 s21, s77, 368640
  buffer_store_dword v28, v17, s[8:11], s21 offen sc1
  s_branch ar_23
ar_21:
  s_mov_b64 exec, s[66:67]
  s_mov_b32 s21, 0
  buffer_store_dwordx4 v[28:31], v15, s[4:7], s21 offen sc1
  s_mov_b32 s21, 524288
  buffer_store_dwordx4 v[28:31], v15, s[4:7], s21 offen sc1
  s_mov_b32 s21, 8192
  buffer_store_dwordx4 v[28:31], v15, s[4:7], s21 offen sc1
  s_mov_b32 s21, 532480
  buffer_store_dwordx4 v[28:31], v15, s[4:7], s21 offen sc1
ar_23:
  s_mov_b64 exec, -1
  s_waitcnt vmcnt(0)
  s_barrier
  s_mov_b32 s21, 100
  s_cmp_lg_u32 s20, 0
  s_cbranch_scc1 af_24
  v_mov_b32 v80, 0
  v_mov_b32 v81, 1
  s_mov_b64 exec, 1
  buffer_atomic_add v81, v80, s[32:35], s21 offen sc1
  s_mov_b64 exec, -1
  s_nop 1
af_24:
  s_cmp_lg_u32 s20, 0
  s_cbranch_scc1 wf_26
  v_mov_b32 v80, 0
  s_mov_b32 s101, 0
wf_25:
  buffer_load_dword v81, v80, s[32:35], s21 offen sc1
  s_add_u32 s101, s101, 1
  s_cmp_gt_u32 s101, 131072
  s_cbranch_scc1 end0
  s_waitcnt vmcnt(0)
  v_readfirstlane_b32 s100, v81
  s_cmp_ge_u32 s100, 128
  s_cbranch_scc1 wf_26
  s_sleep 8
  s_branch wf_25
wf_26:
  s_barrier
fm_17:
  v_add_u32 v76, -1, v76
  v_lshlrev_b32 v76, 13, v76
  v_add_u32 v15, v15, v76
  v_add_u32 v16, v16, v76
  s_mov_b32 s75, s77
  s_lshl_b32 s77, s58, 7
  s_lshl_b32 s21, s56, 3
  s_add_u32 s77, s77, s21
  s_add_u32 s77, s77, 18432
  s_mov_b32 s80, 0x53800000
  s_mov_b32 s52, 0
  s_mov_b32 s81, 0
  s_waitcnt vmcnt(0)
  s_barrier
  ds_read_b128 v[144:147], v18
  ds_read_b128 v[148:151], v18 offset:1024
  ds_read_b128 v[152:155], v19
  ds_read_b128 v[112:115], v20
  ds_read_b64 v[116:117], v21
  v_xor_b32 v18, 16384, v18
  v_xor_b32 v19, 16384, v19
  v_xor_b32 v20, 16384, v20
  v_xor_b32 v21, 16384, v21
  v_mov_b32 v88, 0
  v_mov_b32 v89, 0
  v_mov_b32 v90, 0
  v_mov_b32 v91, 0
  v_mov_b32 v92, 0
  v_mov_b32 v93, 0
  v_mov_b32 v94, 0
  v_mov_b32 v95, 0
  v_mov_b32 v96, 0
  v_mov_b32 v97, 0
  v_mov_b32 v98, 0
  v_mov_b32 v99, 0
  v_mov_b32 v100, 0
  v_mov_b32 v101, 0
  v_mov_b32 v102, 0
  v_mov_b32 v103, 0
  v_mov_b32 v110, 0
  v_mov_b32 v111, 0
  v_mov_b32 v118, 0
  v_mov_b32 v119, 0
  v_mov_b32 v142, 0
  v_mov_b32 v143, 0
  v_mov_b32 v162, 0
  v_mov_b32 v163, 0
  s_and_b32 s21, s52, 3
  s_mul_i32 s56, s21, 122880
  s_add_u32 s21, s52, 1
  s_and_b32 s21, s21, 3
  s_mul_i32 s55, s21, 122880
  s_add_u32 s55, s55, s75
  s_add_u32 s21, s52, 2
  s_and_b32 s21, s21, 3
  s_mul_i32 s57, s21, 122880
  s_add_u32 s21, s52, 3
  s_and_b32 s21, s21, 3
  s_mul_i32 s59, s21, 122880
  s_add_u32 s59, s59, s75
  s_bfe_u32 s61, s52, 0x10001
  s_and_b32 s21, s52, 1
  s_lshl_b32 s60, s21, 19
  s_mov_b32 s58, s55
  s_waitcnt lgkmcnt(0)
  s_lshl_b32 s21, s53, 2
  s_add_u32 s21, s21, s20
  s_cmp_eq_u32 s21, 0
  s_cbranch_scc1 E_27
  s_cmp_eq_u32 s21, 4
  s_cbranch_scc1 E_28
  s_cmp_eq_u32 s21, 1
  s_cbranch_scc1 E_29
  s_cmp_eq_u32 s21, 5
  s_cbranch_scc1 E_30
  s_cmp_eq_u32 s21, 2
  s_cbranch_scc1 E_31
  s_cmp_eq_u32 s21, 6
  s_cbranch_scc1 E_32
  s_cmp_eq_u32 s21, 3
  s_cbranch_scc1 E_33
  s_cmp_eq_u32 s21, 7
  s_cbranch_scc1 E_34
  s_branch end0
E_28:
  v_add_u32 v190, 0, v4
  ds_read_b128 v[48:51], v4 offset:0
  ds_read_b128 v[52:55], v4 offset:1024
  ds_read_b128 v[56:59], v4 offset:2048
  s_waitcnt lgkmcnt(0)
  s_branch mo_40
  .p2align 3
top_35:
  s_waitcnt vmcnt(2)
  ds_write_b128 v190, v[48:51] offset:0
  v_cmp_eq_u32 s[22:23], -1, v48
  s_waitcnt vmcnt(1)
  ds_write_b128 v190, v[52:55] offset:1024
  v_cmp_eq_u32 s[98:99], -1, v52
  s_waitcnt vmcnt(0)
  ds_write_b128 v190, v[56:59] offset:2048
  v_cmp_eq_u32 s[100:101], -1, v56
  s_or_b64 vcc, s[22:23], s[98:99]
  s_or_b64 vcc, vcc, s[100:101]
  s_cbranch_scc1 mr_36
mo_40:
  s_waitcnt lgkmcnt(0)
  s_barrier
  ds_read_b128 v[60:63], v4 offset:3072
  ds_read_b128 v[64:67], v4 offset:4096
  v_smfmac_f32_16x16x64_bf16 v[92:95], v[48:51], a[240:247], v22
  ds_read_b128 v[68:71], v4 offset:5120
  v_smfmac_f32_16x16x64_bf16 v[88:91], v[48:51], a[160:167], v22
  ds_read_b128 v[72:75], v4 offset:6144
  v_smfmac_f32_16x16x64_bf16 v[92:95], v[52:55], a[248:255], v22
  ds_read_b128 v[76:79], v4 offset:7168
  v_smfmac_f32_16x16x64_bf16 v[88:91], v[52:55], a[168:175], v22
  ds_read_b128 v[80:83], v4 offset:8192
  v_smfmac_f32_16x16x64_bf16 v[92:95], v[56:59], v[192:199], v22
  ds_read_b128 v[84:87], v4 offset:9216
  v_smfmac_f32_16x16x64_bf16 v[88:91], v[56:59], a[176:183], v22
  s_waitcnt lgkmcnt(6)
  v_smfmac_f32_16x16x64_bf16 v[92:95], v[60:63], v[200:207], v22
  v_smfmac_f32_16x16x64_bf16 v[88:91], v[60:63], a[184:191], v22
  s_waitcnt lgkmcnt(5)
  v_smfmac_f32_16x16x64_bf16 v[92:95], v[64:67], v[208:215], v22
  s_waitcnt lgkmcnt(4)
  v_smfmac_f32_16x16x64_bf16 v[92:95], v[68:71], v[216:223], v22
  s_waitcnt lgkmcnt(3)
  v_smfmac_f32_16x16x64_bf16 v[92:95], v[72:75], v[224:231], v22
  s_waitcnt lgkmcnt(2)
  v_smfmac_f32_16x16x64_bf16 v[92:95], v[76:79], v[232:239], v22
  s_waitcnt lgkmcnt(1)
  v_smfmac_f32_16x16x64_bf16 v[92:95], v[80:83], v[240:247], v22
  s_waitcnt lgkmcnt(0)
  v_smfmac_f32_16x16x64_bf16 v[92:95], v[84:87], v[248:255], v22
  v_smfmac_f32_16x16x64_bf16 v[88:91], v[64:67], a[192:199], v22
  v_smfmac_f32_16x16x64_bf16 v[88:91], v[68:71], a[200:207], v22
  v_smfmac_f32_16x16x64_bf16 v[88:91], v[72:75], a[208:215], v22
  v_permlane32_swap_b32 v92, v93
  v_smfmac_f32_16x16x64_bf16 v[88:91], v[76:79], a[216:223], v22
  v_permlane32_swap_b32 v94, v95
  v_smfmac_f32_16x16x64_bf16 v[88:91], v[80:83], a[224:231], v22
  v_permlane32_swap_b32 v93, v92
  v_smfmac_f32_16x16x64_bf16 v[88:91], v[84:87], a[232:239], v22
  v_permlane32_swap_b32 v95, v94
  v_pk_mul_f32 v[120:121], v[92:93], v[24:25] op_sel:[1,0] op_sel_hi:[0,1]
  v_pk_mul_f32 v[122:123], v[94:95], v[24:25] op_sel:[1,0] op_sel_hi:[0,1]
  s_nop 4
  v_pk_fma_f32 v[88:89], v[88:89], v[24:25], v[120:121]
  v_pk_fma_f32 v[90:91], v[90:91], v[24:25], v[122:123]
  v_cvt_pk_bf16_f32 v120, v88, v89
  v_cvt_pk_bf16_f32 v121, v90, v91
  ds_write_b64 v6, v[120:121]
  v_cmp_u_f32 vcc, v88, v89
  v_cmp_u_f32 s[22:23], v90, v91
  s_nop 1
  s_or_b64 vcc, vcc, s[22:23]
  s_cbranch_vccnz mn_37
mk_38:
  s_waitcnt lgkmcnt(0)
  s_barrier
  ds_read_b64_tr_b16 v[104:105], v7 offset:0
  ds_read_b64_tr_b16 v[106:107], v7 offset:768
  ds_read_b64_tr_b16 v[108:109], v7 offset:1536
  ds_read_b64 v[140:141], v11
  s_cmp_eq_u32 s52, 63
  s_cbranch_scc1 last_39
  s_waitcnt lgkmcnt(2)
  v_mfma_f32_16x16x32_bf16 v[120:123], v[112:115], v[104:107], 0
  s_waitcnt lgkmcnt(1)
  v_mfma_f32_16x16x32_bf16 v[120:123], v[116:119], v[108:111], v[120:123]
  s_mov_b64 exec, s[64:65]
  s_nop 6
  v_cvt_pk_f16_f32 v120, v120, v121
  v_cvt_pk_f16_f32 v121, v122, v123
  buffer_store_dwordx2 v[120:121], v8, s[8:11], s56 offen
  s_mov_b64 exec, -1
  s_sleep 3
  s_nop 1
  v_smfmac_f32_16x16x64_bf16 v[96:99], v[48:51], a[0:7], v22
  v_smfmac_f32_16x16x64_bf16 v[100:103], v[48:51], a[80:87], v22
  v_smfmac_f32_16x16x64_bf16 v[96:99], v[52:55], a[8:15], v22
  v_smfmac_f32_16x16x64_bf16 v[100:103], v[52:55], a[88:95], v22
  v_smfmac_f32_16x16x64_bf16 v[96:99], v[56:59], a[16:23], v22
  v_smfmac_f32_16x16x64_bf16 v[100:103], v[56:59], a[96:103], v22
  v_smfmac_f32_16x16x64_bf16 v[96:99], v[60:63], a[24:31], v22
  v_smfmac_f32_16x16x64_bf16 v[96:99], v[64:67], a[32:39], v22
  v_smfmac_f32_16x16x64_bf16 v[96:99], v[68:71], a[40:47], v22
  v_smfmac_f32_16x16x64_bf16 v[96:99], v[72:75], a[48:55], v22
  v_smfmac_f32_16x16x64_bf16 v[96:99], v[76:79], a[56:63], v22
  buffer_load_dwordx4 v[124:127], v9, s[8:11], s56 offen sc1
  v_smfmac_f32_16x16x64_bf16 v[96:99], v[80:83], a[64:71], v22
  buffer_load_dwordx4 v[128:131], v9, s[8:11], s56 offen offset:1024 sc1
  v_smfmac_f32_16x16x64_bf16 v[96:99], v[84:87], a[72:79], v22
  buffer_load_dwordx4 v[132:135], v10, s[8:11], s56 offen sc1
  v_smfmac_f32_16x16x64_bf16 v[100:103], v[60:63], a[104:111], v22
  v_smfmac_f32_16x16x64_bf16 v[100:103], v[64:67], a[112:119], v22
  v_smfmac_f32_16x16x64_bf16 v[100:103], v[68:71], a[120:127], v22
  v_smfmac_f32_16x16x64_bf16 v[100:103], v[72:75], a[128:135], v22
  v_cvt_pk_bf16_f32 v136, v96, v97
  v_smfmac_f32_16x16x64_bf16 v[100:103], v[76:79], a[136:143], v22
  v_cvt_pk_bf16_f32 v137, v98, v99
  v_smfmac_f32_16x16x64_bf16 v[100:103], v[80:83], a[144:151], v22
  v_smfmac_f32_16x16x64_bf16 v[100:103], v[84:87], a[152:159], v22
  s_waitcnt vmcnt(2)
  v_pk_add_f16 v172, v124, v126
  v_pk_add_f16 v173, v125, v127
  s_waitcnt vmcnt(1)
  v_pk_add_f16 v174, v128, v130
  v_pk_add_f16 v175, v129, v131
  v_fma_mix_f32 v166, v172, 1.0, v174 op_sel:[0,0,0] op_sel_hi:[1,0,1]
  v_fma_mix_f32 v168, v173, 1.0, v175 op_sel:[0,0,0] op_sel_hi:[1,0,1]
  s_waitcnt vmcnt(0)
  v_pk_add_f16 v176, v132, v133
  v_pk_add_f16 v177, v134, v135
  v_fma_mix_f32 v170, v176, 1.0, v177 op_sel:[0,0,0] op_sel_hi:[1,0,1]
  v_fma_mix_f32 v167, v172, 1.0, v174 op_sel:[1,0,1] op_sel_hi:[1,0,1]
  v_cmp_u_f32 vcc, v166, v170
  v_fma_mix_f32 v169, v173, 1.0, v175 op_sel:[1,0,1] op_sel_hi:[1,0,1]
  v_fma_mix_f32 v171, v176, 1.0, v177 op_sel:[1,0,1] op_sel_hi:[1,0,1]
  v_cvt_pk_bf16_f32 v138, v100, v101
  s_cbranch_vccnz sr_41
sj_42:
ex_43:
  v_exp_f32 v172, v166
  v_exp_f32 v173, v167
  v_exp_f32 v174, v168
  v_cvt_pk_bf16_f32 v156, v172, v173
  v_exp_f32 v175, v169
  v_exp_f32 v176, v170
  v_cvt_pk_bf16_f32 v157, v174, v175
  v_mov_b32_dpp v158, v156 row_ror:8 row_mask:0xf bank_mask:0xf
  v_exp_f32 v177, v171
  v_mov_b32_dpp v159, v157 row_ror:8 row_mask:0xf bank_mask:0xf
  v_cvt_pk_bf16_f32 v160, v176, v177
  v_cvt_pk_bf16_f32 v139, v102, v103
  v_mfma_f32_16x16x32_bf16 v[178:181], v[152:155], v[156:159], 0
  s_waitcnt lgkmcnt(0)
  v_mov_b32_dpp v161, v160 row_ror:8 row_mask:0xf bank_mask:0xf
  v_mfma_f32_16x16x32_bf16 v[182:185], v[144:147], v[156:159], 0
  s_nop 0
  v_mfma_f32_16x16x32_bf16 v[178:181], v[140:143], v[160:163], v[178:181]
  v_mfma_f32_16x16x32_bf16 v[182:185], v[136:139], v[160:163], v[182:185]
  v_mfma_f32_16x16x32_bf16 v[186:189], v[148:151], v[156:159], 0
  v_mfma_f32_16x16x32_bf16 v[186:189], v[138:141], v[160:163], v[186:189]
  s_mov_b64 exec, s[62:63]
  v_rcp_f32 v164, v180
  s_nop 0
  v_pk_mul_f32 v[178:179], v[178:179], v[164:165] op_sel_hi:[1,0]
  v_pk_mul_f32 v[182:183], v[182:183], v[164:165] op_sel_hi:[1,0]
  v_pk_mul_f32 v[184:185], v[184:185], v[164:165] op_sel_hi:[1,0]
  v_cvt_pk_f16_f32 v64, v178, v179
  v_cvt_pk_f16_f32 v60, v182, v183
  v_pk_mul_f32 v[186:187], v[186:187], v[164:165] op_sel_hi:[1,0]
  v_pk_mul_f32 v[188:189], v[188:189], v[164:165] op_sel_hi:[1,0]
  v_cvt_pk_f16_f32 v61, v184, v185
  v_cvt_pk_f16_f32 v62, v186, v187
  v_cvt_pk_f16_f32 v63, v188, v189
  ds_write_b128 v13, v[60:63]
  ds_write_b32 v14, v64
  v_add_f32 v165, v164, v180
  v_cmp_ngt_f32 vcc, s80, v165
  s_mov_b64 exec, -1
  s_nop 0
  s_cbranch_vccnz fx_44
fk_45:
  s_waitcnt lgkmcnt(0)
  s_barrier
  s_add_u32 m0, s74, 8192
  s_add_u32 s21, s72, 2048
  buffer_load_dwordx4 v32, s[28:31], s21 offen sc1 lds
  s_add_u32 m0, s74, 1024
  s_add_u32 s21, s79, 1024
  buffer_load_dwordx4 v4, s[28:31], s21 offen sc1 lds
  s_add_u32 m0, s74, 4096
  s_add_u32 s21, s79, 81920
  buffer_load_dwordx4 v4, s[28:31], s21 offen sc1 lds
  s_add_u32 m0, s74, 7168
  s_add_u32 s21, s79, 123904
  buffer_load_dwordx4 v4, s[28:31], s21 offen sc1 lds
  s_add_u32 s72, s72, 1310720
  s_add_u32 s79, s79, 1310720
  s_add_u32 s73, s73, 393216
  s_xor_b32 s74, s74, 16384
  s_nop 15
  s_nop 3
  v_permlane32_swap_b32 v96, v100
  v_permlane32_swap_b32 v97, v101
  v_permlane32_swap_b32 v98, v102
  v_permlane32_swap_b32 v99, v103
  v_pk_add_f32 v[96:97], v[96:97], v[100:101]
  v_pk_add_f32 v[98:99], v[98:99], v[102:103]
  v_cvt_pk_bf16_f32 v182, v96, v97
  v_cvt_pk_bf16_f32 v183, v98, v99
  v_min_u32 v182, -2, v182
  ds_write_b64 v26, v[182:183]
  ds_read_b128 v[144:147], v18
  ds_read_b128 v[148:151], v18 offset:1024
  ds_read_b128 v[152:155], v19
  ds_read_b128 v[112:115], v20
  ds_read_b64 v[116:117], v21
  v_xor_b32 v18, 16384, v18
  v_xor_b32 v19, 16384, v19
  v_xor_b32 v20, 16384, v20
  v_xor_b32 v21, 16384, v21
  v_mov_b32 v88, 0
  v_mov_b32 v89, 0
  v_mov_b32 v90, 0
  v_mov_b32 v91, 0
  v_mov_b32 v92, 0
  v_mov_b32 v93, 0
  v_mov_b32 v94, 0
  v_mov_b32 v95, 0
  v_mov_b32 v96, 0
  v_mov_b32 v97, 0
  v_mov_b32 v98, 0
  v_mov_b32 v99, 0
  v_mov_b32 v100, 0
  v_mov_b32 v101, 0
  v_mov_b32 v102, 0
  v_mov_b32 v103, 0
  s_mov_b32 s81, 0
  s_waitcnt lgkmcnt(0)
  s_barrier
  s_mov_b64 exec, s[64:65]
  buffer_store_dwordx2 v[28:29], v8, s[8:11], s57 offen
  s_mov_b64 exec, s[62:63]
  buffer_store_dword v28, v17, s[8:11], s59 offen
  s_mov_b64 exec, -1
  s_sleep 6
  s_nop 3
  buffer_load_dwordx4 v[68:71], v16, s[4:7], s60 offen sc1
  s_sleep 3
  s_nop 1
  buffer_load_dwordx4 v[72:75], v16, s[4:7], s60 offen sc1
  s_mov_b32 s54, 0
pp_47:
  s_waitcnt vmcnt(1)
  v_mfma_f32_16x16x32_f16 v[120:123], v[44:47], v[68:71], 0
  v_bitop3_b32 v27, v68, s61, 1 bitop3:0x28
  v_cmp_ne_u32 vcc, 0, v27
  s_nop 1
  s_cbranch_vccnz p2_49
  s_nop 2
pg_48:
  v_add_f32_dpp v120, v120, v120 row_ror:8 row_mask:0xf bank_mask:0xf
  v_add_f32_dpp v121, v121, v121 row_ror:8 row_mask:0xf bank_mask:0xf
  s_mov_b64 exec, s[62:63]
  v_cvt_pk_bf16_f32 v120, v120, v121
  v_min_u32 v120, -2, v120
  buffer_store_dword v120, v17, s[8:11], s55 offen
  s_mov_b64 exec, -1
nt_46:
  s_barrier
  s_mov_b32 s58, s55
  s_add_u32 s52, s52, 1
  s_and_b32 s21, s52, 3
  s_mul_i32 s56, s21, 122880
  s_add_u32 s21, s52, 1
  s_and_b32 s21, s21, 3
  s_mul_i32 s55, s21, 122880
  s_add_u32 s55, s55, s75
  s_add_u32 s21, s52, 2
  s_and_b32 s21, s21, 3
  s_mul_i32 s57, s21, 122880
  s_add_u32 s21, s52, 3
  s_and_b32 s21, s21, 3
  s_mul_i32 s59, s21, 122880
  s_add_u32 s59, s59, s75
  s_bfe_u32 s61, s52, 0x10001
  s_and_b32 s21, s52, 1
  s_lshl_b32 s60, s21, 19
  s_mov_b32 s54, 0
  s_sleep 3
  s_nop 2
  buffer_load_dwordx4 v[48:51], v190, s[8:11], s58 offen offset:0 sc1
  buffer_load_dwordx4 v[52:55], v190, s[8:11], s58 offen offset:1024 sc1
  buffer_load_dwordx4 v[56:59], v190, s[8:11], s58 offen offset:2048 sc1
  s_branch top_35
mr_36:
  s_mov_b64 exec, s[22:23]
  s_cbranch_execz ms_50
  buffer_load_dwordx4 v[48:51], v190, s[8:11], s58 offen offset:0 sc1
ms_50:
  s_mov_b64 exec, s[98:99]
  s_cbranch_execz ms_51
  buffer_load_dwordx4 v[52:55], v190, s[8:11], s58 offen offset:1024 sc1
ms_51:
  s_mov_b64 exec, s[100:101]
  s_cbranch_execz ms_52
  buffer_load_dwordx4 v[56:59], v190, s[8:11], s58 offen offset:2048 sc1
ms_52:
  s_add_u32 s54, s54, 1
  s_cmp_gt_u32 s54, 131072
  s_cbranch_scc1 end0
  s_waitcnt vmcnt(0)
  s_mov_b64 exec, s[22:23]
  ds_write_b128 v190, v[48:51] offset:0
  v_cmp_eq_u32 s[22:23], -1, v48
  s_mov_b64 exec, s[98:99]
  ds_write_b128 v190, v[52:55] offset:1024
  v_cmp_eq_u32 s[98:99], -1, v52
  s_mov_b64 exec, s[100:101]
  ds_write_b128 v190, v[56:59] offset:2048
  v_cmp_eq_u32 s[100:101], -1, v56
  s_mov_b64 exec, -1
  s_or_b64 vcc, s[22:23], s[98:99]
  s_or_b64 vcc, vcc, s[100:101]
  s_cbranch_scc1 mr_36
  s_branch mo_40
mn_37:
  v_max3_u32 v27, v48, v49, v50
  v_max3_u32 v27, v27, v51, v52
  v_max3_u32 v27, v27, v53, v54
  v_max3_u32 v27, v27, v55, v56
  v_max3_u32 v27, v27, v57, v58
  v_max3_u32 v27, v27, v59, v60
  v_max3_u32 v27, v27, v61, v62
  v_max3_u32 v27, v27, v63, v64
  v_max3_u32 v27, v27, v65, v66
  v_max3_u32 v27, v27, v67, v68
  v_max3_u32 v27, v27, v69, v70
  v_max3_u32 v27, v27, v71, v72
  v_max3_u32 v27, v27, v73, v74
  v_max3_u32 v27, v27, v75, v76
  v_max3_u32 v27, v27, v77, v78
  v_max3_u32 v27, v27, v79, v80
  v_max3_u32 v27, v27, v81, v82
  v_max3_u32 v27, v27, v83, v84
  v_max3_u32 v27, v27, v85, v86
  v_max3_u32 v27, v27, v87, v87
  v_cmp_eq_u32 vcc, -1, v27
  s_cmp_eq_u32 s52, 0
  s_cbranch_scc1 mk_38
  s_cbranch_vccz mk_38
  s_waitcnt lgkmcnt(0)
  s_barrier
  s_nop 7
  v_mov_b32 v88, 0
  v_mov_b32 v89, 0
  v_mov_b32 v90, 0
  v_mov_b32 v91, 0
  v_mov_b32 v92, 0
  v_mov_b32 v93, 0
  v_mov_b32 v94, 0
  v_mov_b32 v95, 0
  v_mov_b32 v96, 0
  v_mov_b32 v97, 0
  v_mov_b32 v98, 0
  v_mov_b32 v99, 0
  v_mov_b32 v100, 0
  v_mov_b32 v101, 0
  v_mov_b32 v102, 0
  v_mov_b32 v103, 0
  s_mov_b64 s[22:23], -1
  s_mov_b64 s[98:99], -1
  s_mov_b64 s[100:101], -1
  s_branch mr_36
sr_41:
  s_mov_b32 s54, 0
sr_53:
  s_mov_b64 exec, vcc
  buffer_load_dwordx4 v[124:127], v9, s[8:11], s56 offen sc1
  buffer_load_dwordx4 v[128:131], v9, s[8:11], s56 offen offset:1024 sc1
  buffer_load_dwordx4 v[132:135], v10, s[8:11], s56 offen sc1
  s_mov_b64 exec, -1
  s_add_u32 s54, s54, 1
  s_cmp_gt_u32 s54, 131072
  s_cbranch_scc1 end0
  s_and_b32 s21, s54, 31
  s_cbranch_scc0 sr_54
  s_waitcnt vmcnt(0)
  v_pk_add_f16 v172, v124, v126
  v_pk_add_f16 v173, v125, v127
  v_pk_add_f16 v174, v128, v130
  v_pk_add_f16 v175, v129, v131
  v_fma_mix_f32 v166, v172, 1.0, v174 op_sel:[0,0,0] op_sel_hi:[1,0,1]
  v_fma_mix_f32 v168, v173, 1.0, v175 op_sel:[0,0,0] op_sel_hi:[1,0,1]
  v_pk_add_f16 v176, v132, v133
  v_pk_add_f16 v177, v134, v135
  v_add_f32 v27, v166, v168
  v_fma_mix_f32 v170, v176, 1.0, v177 op_sel:[0,0,0] op_sel_hi:[1,0,1]
  v_fma_mix_f32 v167, v172, 1.0, v174 op_sel:[1,0,1] op_sel_hi:[1,0,1]
  v_cmp_u_f32 vcc, v27, v170
  v_fma_mix_f32 v169, v173, 1.0, v175 op_sel:[1,0,1] op_sel_hi:[1,0,1]
  v_fma_mix_f32 v171, v176, 1.0, v177 op_sel:[1,0,1] op_sel_hi:[1,0,1]
  s_cbranch_vccnz sr_53
  s_branch sj_42
sr_54:
  s_waitcnt vmcnt(0)
  v_pk_add_f16 v172, v124, v126
  v_pk_add_f16 v173, v125, v127
  v_pk_add_f16 v174, v128, v130
  v_pk_add_f16 v175, v129, v131
  v_fma_mix_f32 v166, v172, 1.0, v174 op_sel:[0,0,0] op_sel_hi:[1,0,1]
  v_fma_mix_f32 v168, v173, 1.0, v175 op_sel:[0,0,0] op_sel_hi:[1,0,1]
  v_pk_add_f16 v176, v132, v133
  v_pk_add_f16 v177, v134, v135
  v_add_f32 v27, v166, v168
  v_fma_mix_f32 v170, v176, 1.0, v177 op_sel:[0,0,0] op_sel_hi:[1,0,1]
  v_fma_mix_f32 v167, v172, 1.0, v174 op_sel:[1,0,1] op_sel_hi:[1,0,1]
  v_cmp_u_f32 vcc, v27, v170
  v_fma_mix_f32 v169, v173, 1.0, v175 op_sel:[1,0,1] op_sel_hi:[1,0,1]
  v_fma_mix_f32 v171, v176, 1.0, v177 op_sel:[1,0,1] op_sel_hi:[1,0,1]
  v_max3_u32 v27, v124, v126, v128
  v_max3_u32 v27, v27, v130, v132
  v_max3_u32 v27, v27, v133, v134
  v_max3_u32 v27, v27, v135, v135
  v_cmp_eq_u32 vcc, -1, v27
  s_nop 1
  s_cbranch_vccnz sr_53
  s_branch sj_42
fx_44:
  s_cmp_eq_u32 s81, 1
  s_cbranch_scc1 fk_45
  s_mov_b32 s81, 1
  v_max3_f32 v164, v166, v167, v168
  v_max3_f32 v165, v169, v170, v171
  v_max_f32 v164, v164, v165
  s_nop 1
  v_max_f32_dpp v164, v164, v164 row_ror:8 row_mask:0xf bank_mask:0xf
  v_mov_b32 v165, v164
  s_nop 1
  v_permlane32_swap_b32 v164, v165
  v_max_f32 v164, v164, v165
  v_mov_b32 v165, v164
  s_nop 1
  v_permlane16_swap_b32 v164, v165
  v_max_f32 v164, v164, v165
  v_sub_f32 v166, v166, v164
  v_sub_f32 v167, v167, v164
  v_sub_f32 v168, v168, v164
  v_sub_f32 v169, v169, v164
  v_sub_f32 v170, v170, v164
  v_sub_f32 v171, v171, v164
  s_branch ex_43
p2_49:
  buffer_load_dwordx4 v[68:71], v16, s[4:7], s60 offen sc1
  s_waitcnt vmcnt(1)
  v_mfma_f32_16x16x32_f16 v[120:123], v[44:47], v[72:75], 0
  v_bitop3_b32 v27, v72, s61, 1 bitop3:0x28
  v_cmp_ne_u32 vcc, 0, v27
  s_nop 1
  s_cbranch_vccz pg_48
  buffer_load_dwordx4 v[72:75], v16, s[4:7], s60 offen sc1
  s_add_u32 s54, s54, 1
  s_cmp_gt_u32 s54, 131072
  s_cbranch_scc1 end0
  s_branch pp_47
last_39:
  v_smfmac_f32_16x16x64_bf16 v[96:99], v[48:51], a[0:7], v22
  v_smfmac_f32_16x16x64_bf16 v[100:103], v[48:51], a[80:87], v22
  v_smfmac_f32_16x16x64_bf16 v[96:99], v[52:55], a[8:15], v22
  v_smfmac_f32_16x16x64_bf16 v[100:103], v[52:55], a[88:95], v22
  v_smfmac_f32_16x16x64_bf16 v[96:99], v[56:59], a[16:23], v22
  v_smfmac_f32_16x16x64_bf16 v[100:103], v[56:59], a[96:103], v22
  v_smfmac_f32_16x16x64_bf16 v[96:99], v[60:63], a[24:31], v22
  v_smfmac_f32_16x16x64_bf16 v[96:99], v[64:67], a[32:39], v22
  v_smfmac_f32_16x16x64_bf16 v[96:99], v[68:71], a[40:47], v22
  v_smfmac_f32_16x16x64_bf16 v[96:99], v[72:75], a[48:55], v22
  v_smfmac_f32_16x16x64_bf16 v[96:99], v[76:79], a[56:63], v22
  v_smfmac_f32_16x16x64_bf16 v[96:99], v[80:83], a[64:71], v22
  v_smfmac_f32_16x16x64_bf16 v[96:99], v[84:87], a[72:79], v22
  v_smfmac_f32_16x16x64_bf16 v[100:103], v[60:63], a[104:111], v22
  v_smfmac_f32_16x16x64_bf16 v[100:103], v[64:67], a[112:119], v22
  v_smfmac_f32_16x16x64_bf16 v[100:103], v[68:71], a[120:127], v22
  v_smfmac_f32_16x16x64_bf16 v[100:103], v[72:75], a[128:135], v22
  v_smfmac_f32_16x16x64_bf16 v[100:103], v[76:79], a[136:143], v22
  v_smfmac_f32_16x16x64_bf16 v[100:103], v[80:83], a[144:151], v22
  v_smfmac_f32_16x16x64_bf16 v[100:103], v[84:87], a[152:159], v22
  s_nop 7
  v_permlane32_swap_b32 v96, v100
  v_permlane32_swap_b32 v97, v101
  v_permlane32_swap_b32 v98, v102
  v_permlane32_swap_b32 v99, v103
  v_pk_add_f32 v[96:97], v[96:97], v[100:101]
  v_pk_add_f32 v[98:99], v[98:99], v[102:103]
  v_cvt_pk_bf16_f32 v182, v96, v97
  v_cvt_pk_bf16_f32 v183, v98, v99
  v_min_u32 v182, -2, v182
  ds_write_b64 v26, v[182:183]
  s_waitcnt lgkmcnt(0)
  s_barrier
  s_branch chain_done
E_30:
  v_add_u32 v190, 3072, v4
  ds_read_b128 v[60:63], v4 offset:3072
  ds_read_b128 v[64:67], v4 offset:4096
  ds_read_b128 v[68:71], v4 offset:5120
  s_waitcnt lgkmcnt(0)
  s_branch mo_60
  .p2align 3
top_55:
  s_waitcnt vmcnt(2)
  ds_write_b128 v190, v[60:63] offset:0
  v_cmp_eq_u32 s[22:23], -1, v60
  s_waitcnt vmcnt(1)
  ds_write_b128 v190, v[64:67] offset:1024
  v_cmp_eq_u32 s[98:99], -1, v64
  s_waitcnt vmcnt(0)
  ds_write_b128 v190, v[68:71] offset:2048
  v_cmp_eq_u32 s[100:101], -1, v68
  s_or_b64 vcc, s[22:23], s[98:99]
  s_or_b64 vcc, vcc, s[100:101]
  s_cbranch_scc1 mr_56
mo_60:
  s_waitcnt lgkmcnt(0)
  s_barrier
  ds_read_b128 v[48:51], v4 offset:0
  ds_read_b128 v[52:55], v4 offset:1024
  v_smfmac_f32_16x16x64_bf16 v[92:95], v[60:63], v[200:207], v22
  ds_read_b128 v[56:59], v4 offset:2048
  v_smfmac_f32_16x16x64_bf16 v[88:91], v[60:63], a[184:191], v22
  ds_read_b128 v[72:75], v4 offset:6144
  v_smfmac_f32_16x16x64_bf16 v[92:95], v[64:67], v[208:215], v22
  ds_read_b128 v[76:79], v4 offset:7168
  v_smfmac_f32_16x16x64_bf16 v[88:91], v[64:67], a[192:199], v22
  ds_read_b128 v[80:83], v4 offset:8192
  v_smfmac_f32_16x16x64_bf16 v[92:95], v[68:71], v[216:223], v22
  ds_read_b128 v[84:87], v4 offset:9216
  v_smfmac_f32_16x16x64_bf16 v[88:91], v[68:71], a[200:207], v22
  s_waitcnt lgkmcnt(6)
  v_smfmac_f32_16x16x64_bf16 v[92:95], v[48:51], a[240:247], v22
  v_smfmac_f32_16x16x64_bf16 v[88:91], v[48:51], a[160:167], v22
  s_waitcnt lgkmcnt(5)
  v_smfmac_f32_16x16x64_bf16 v[92:95], v[52:55], a[248:255], v22
  s_waitcnt lgkmcnt(4)
  v_smfmac_f32_16x16x64_bf16 v[92:95], v[56:59], v[192:199], v22
  s_waitcnt lgkmcnt(3)
  v_smfmac_f32_16x16x64_bf16 v[92:95], v[72:75], v[224:231], v22
  s_waitcnt lgkmcnt(2)
  v_smfmac_f32_16x16x64_bf16 v[92:95], v[76:79], v[232:239], v22
  s_waitcnt lgkmcnt(1)
  v_smfmac_f32_16x16x64_bf16 v[92:95], v[80:83], v[240:247], v22
  s_waitcnt lgkmcnt(0)
  v_smfmac_f32_16x16x64_bf16 v[92:95], v[84:87], v[248:255], v22
  v_smfmac_f32_16x16x64_bf16 v[88:91], v[52:55], a[168:175], v22
  v_smfmac_f32_16x16x64_bf16 v[88:91], v[56:59], a[176:183], v22
  v_smfmac_f32_16x16x64_bf16 v[88:91], v[72:75], a[208:215], v22
  v_permlane32_swap_b32 v92, v93
  v_smfmac_f32_16x16x64_bf16 v[88:91], v[76:79], a[216:223], v22
  v_permlane32_swap_b32 v94, v95
  v_smfmac_f32_16x16x64_bf16 v[88:91], v[80:83], a[224:231], v22
  v_permlane32_swap_b32 v93, v92
  v_smfmac_f32_16x16x64_bf16 v[88:91], v[84:87], a[232:239], v22
  v_permlane32_swap_b32 v95, v94
  v_pk_mul_f32 v[120:121], v[92:93], v[24:25] op_sel:[1,0] op_sel_hi:[0,1]
  v_pk_mul_f32 v[122:123], v[94:95], v[24:25] op_sel:[1,0] op_sel_hi:[0,1]
  s_nop 4
  v_pk_fma_f32 v[88:89], v[88:89], v[24:25], v[120:121]
  v_pk_fma_f32 v[90:91], v[90:91], v[24:25], v[122:123]
  v_cvt_pk_bf16_f32 v120, v88, v89
  v_cvt_pk_bf16_f32 v121, v90, v91
  ds_write_b64 v6, v[120:121]
  v_cmp_u_f32 vcc, v88, v89
  v_cmp_u_f32 s[22:23], v90, v91
  s_nop 1
  s_or_b64 vcc, vcc, s[22:23]
  s_cbranch_vccnz mn_57
mk_58:
  s_waitcnt lgkmcnt(0)
  s_barrier
  ds_read_b64_tr_b16 v[104:105], v7 offset:0
  ds_read_b64_tr_b16 v[106:107], v7 offset:768
  ds_read_b64_tr_b16 v[108:109], v7 offset:1536
  ds_read_b64 v[140:141], v11
  s_cmp_eq_u32 s52, 63
  s_cbranch_scc1 last_59
  s_waitcnt lgkmcnt(2)
  v_mfma_f32_16x16x32_bf16 v[120:123], v[112:115], v[104:107], 0
  s_waitcnt lgkmcnt(1)
  v_mfma_f32_16x16x32_bf16 v[120:123], v[116:119], v[108:111], v[120:123]
  s_mov_b64 exec, s[64:65]
  s_nop 6
  v_cvt_pk_f16_f32 v120, v120, v121
  v_cvt_pk_f16_f32 v121, v122, v123
  buffer_store_dwordx2 v[120:121], v8, s[8:11], s56 offen
  s_mov_b64 exec, -1
  s_sleep 3
  s_nop 1
  v_smfmac_f32_16x16x64_bf16 v[96:99], v[48:51], a[0:7], v22
  v_smfmac_f32_16x16x64_bf16 v[100:103], v[48:51], a[80:87], v22
  v_smfmac_f32_16x16x64_bf16 v[96:99], v[52:55], a[8:15], v22
  v_smfmac_f32_16x16x64_bf16 v[100:103], v[52:55], a[88:95], v22
  v_smfmac_f32_16x16x64_bf16 v[96:99], v[56:59], a[16:23], v22
  v_smfmac_f32_16x16x64_bf16 v[100:103], v[56:59], a[96:103], v22
  v_smfmac_f32_16x16x64_bf16 v[96:99], v[60:63], a[24:31], v22
  v_smfmac_f32_16x16x64_bf16 v[96:99], v[64:67], a[32:39], v22
  v_smfmac_f32_16x16x64_bf16 v[96:99], v[68:71], a[40:47], v22
  v_smfmac_f32_16x16x64_bf16 v[96:99], v[72:75], a[48:55], v22
  v_smfmac_f32_16x16x64_bf16 v[96:99], v[76:79], a[56:63], v22
  buffer_load_dwordx4 v[124:127], v9, s[8:11], s56 offen sc1
  v_smfmac_f32_16x16x64_bf16 v[96:99], v[80:83], a[64:71], v22
  buffer_load_dwordx4 v[128:131], v9, s[8:11], s56 offen offset:1024 sc1
  v_smfmac_f32_16x16x64_bf16 v[96:99], v[84:87], a[72:79], v22
  buffer_load_dwordx4 v[132:135], v10, s[8:11], s56 offen sc1
  v_smfmac_f32_16x16x64_bf16 v[100:103], v[60:63], a[104:111], v22
  v_smfmac_f32_16x16x64_bf16 v[100:103], v[64:67], a[112:119], v22
  v_smfmac_f32_16x16x64_bf16 v[100:103], v[68:71], a[120:127], v22
  v_smfmac_f32_16x16x64_bf16 v[100:103], v[72:75], a[128:135], v22
  v_cvt_pk_bf16_f32 v136, v96, v97
  v_smfmac_f32_16x16x64_bf16 v[100:103], v[76:79], a[136:143], v22
  v_cvt_pk_bf16_f32 v137, v98, v99
  v_smfmac_f32_16x16x64_bf16 v[100:103], v[80:83], a[144:151], v22
  v_smfmac_f32_16x16x64_bf16 v[100:103], v[84:87], a[152:159], v22
  s_waitcnt vmcnt(2)
  v_pk_add_f16 v172, v124, v126
  v_pk_add_f16 v173, v125, v127
  s_waitcnt vmcnt(1)
  v_pk_add_f16 v174, v128, v130
  v_pk_add_f16 v175, v129, v131
  v_fma_mix_f32 v166, v172, 1.0, v174 op_sel:[0,0,0] op_sel_hi:[1,0,1]
  v_fma_mix_f32 v168, v173, 1.0, v175 op_sel:[0,0,0] op_sel_hi:[1,0,1]
  s_waitcnt vmcnt(0)
  v_pk_add_f16 v176, v132, v133
  v_pk_add_f16 v177, v134, v135
  v_fma_mix_f32 v170, v176, 1.0, v177 op_sel:[0,0,0] op_sel_hi:[1,0,1]
  v_fma_mix_f32 v167, v172, 1.0, v174 op_sel:[1,0,1] op_sel_hi:[1,0,1]
  v_cmp_u_f32 vcc, v166, v170
  v_fma_mix_f32 v169, v173, 1.0, v175 op_sel:[1,0,1] op_sel_hi:[1,0,1]
  v_fma_mix_f32 v171, v176, 1.0, v177 op_sel:[1,0,1] op_sel_hi:[1,0,1]
  v_cvt_pk_bf16_f32 v138, v100, v101
  s_cbranch_vccnz sr_61
sj_62:
ex_63:
  v_exp_f32 v172, v166
  v_exp_f32 v173, v167
  v_exp_f32 v174, v168
  v_cvt_pk_bf16_f32 v156, v172, v173
  v_exp_f32 v175, v169
  v_exp_f32 v176, v170
  v_cvt_pk_bf16_f32 v157, v174, v175
  v_mov_b32_dpp v158, v156 row_ror:8 row_mask:0xf bank_mask:0xf
  v_exp_f32 v177, v171
  v_mov_b32_dpp v159, v157 row_ror:8 row_mask:0xf bank_mask:0xf
  v_cvt_pk_bf16_f32 v160, v176, v177
  v_cvt_pk_bf16_f32 v139, v102, v103
  v_mfma_f32_16x16x32_bf16 v[178:181], v[152:155], v[156:159], 0
  s_waitcnt lgkmcnt(0)
  v_mov_b32_dpp v161, v160 row_ror:8 row_mask:0xf bank_mask:0xf
  v_mfma_f32_16x16x32_bf16 v[182:185], v[144:147], v[156:159], 0
  s_nop 0
  v_mfma_f32_16x16x32_bf16 v[178:181], v[140:143], v[160:163], v[178:181]
  v_mfma_f32_16x16x32_bf16 v[182:185], v[136:139], v[160:163], v[182:185]
  v_mfma_f32_16x16x32_bf16 v[186:189], v[148:151], v[156:159], 0
  v_mfma_f32_16x16x32_bf16 v[186:189], v[138:141], v[160:163], v[186:189]
  s_mov_b64 exec, s[62:63]
  v_rcp_f32 v164, v180
  s_nop 0
  v_pk_mul_f32 v[178:179], v[178:179], v[164:165] op_sel_hi:[1,0]
  v_pk_mul_f32 v[182:183], v[182:183], v[164:165] op_sel_hi:[1,0]
  v_pk_mul_f32 v[184:185], v[184:185], v[164:165] op_sel_hi:[1,0]
  v_cvt_pk_f16_f32 v64, v178, v179
  v_cvt_pk_f16_f32 v60, v182, v183
  v_pk_mul_f32 v[186:187], v[186:187], v[164:165] op_sel_hi:[1,0]
  v_pk_mul_f32 v[188:189], v[188:189], v[164:165] op_sel_hi:[1,0]
  v_cvt_pk_f16_f32 v61, v184, v185
  v_cvt_pk_f16_f32 v62, v186, v187
  v_cvt_pk_f16_f32 v63, v188, v189
  ds_write_b128 v13, v[60:63]
  ds_write_b32 v14, v64
  v_add_f32 v165, v164, v180
  v_cmp_ngt_f32 vcc, s80, v165
  s_mov_b64 exec, -1
  s_nop 0
  s_cbranch_vccnz fx_64
fk_65:
  s_waitcnt lgkmcnt(0)
  s_barrier
  s_add_u32 m0, s74, 9216
  s_add_u32 s21, s72, 83968
  buffer_load_dwordx4 v32, s[28:31], s21 offen sc1 lds
  s_add_u32 m0, s74, 2048
  s_add_u32 s21, s79, 40960
  buffer_load_dwordx4 v4, s[28:31], s21 offen sc1 lds
  s_add_u32 m0, s74, 5120
  s_add_u32 s21, s79, 82944
  buffer_load_dwordx4 v4, s[28:31], s21 offen sc1 lds
  s_add_u32 s72, s72, 1310720
  s_add_u32 s79, s79, 1310720
  s_add_u32 s73, s73, 393216
  s_xor_b32 s74, s74, 16384
  s_nop 15
  s_nop 3
  v_permlane32_swap_b32 v96, v100
  v_permlane32_swap_b32 v97, v101
  v_permlane32_swap_b32 v98, v102
  v_permlane32_swap_b32 v99, v103
  v_pk_add_f32 v[96:97], v[96:97], v[100:101]
  v_pk_add_f32 v[98:99], v[98:99], v[102:103]
  v_cvt_pk_bf16_f32 v182, v96, v97
  v_cvt_pk_bf16_f32 v183, v98, v99
  v_min_u32 v182, -2, v182
  ds_write_b64 v26, v[182:183]
  ds_read_b128 v[144:147], v18
  ds_read_b128 v[148:151], v18 offset:1024
  ds_read_b128 v[152:155], v19
  ds_read_b128 v[112:115], v20
  ds_read_b64 v[116:117], v21
  v_xor_b32 v18, 16384, v18
  v_xor_b32 v19, 16384, v19
  v_xor_b32 v20, 16384, v20
  v_xor_b32 v21, 16384, v21
  v_mov_b32 v88, 0
  v_mov_b32 v89, 0
  v_mov_b32 v90, 0
  v_mov_b32 v91, 0
  v_mov_b32 v92, 0
  v_mov_b32 v93, 0
  v_mov_b32 v94, 0
  v_mov_b32 v95, 0
  v_mov_b32 v96, 0
  v_mov_b32 v97, 0
  v_mov_b32 v98, 0
  v_mov_b32 v99, 0
  v_mov_b32 v100, 0
  v_mov_b32 v101, 0
  v_mov_b32 v102, 0
  v_mov_b32 v103, 0
  s_mov_b32 s81, 0
  s_waitcnt lgkmcnt(0)
  s_barrier
  s_mov_b64 exec, s[64:65]
  buffer_store_dwordx2 v[28:29], v8, s[8:11], s57 offen
  s_mov_b64 exec, s[62:63]
  buffer_store_dword v28, v17, s[8:11], s59 offen
  s_mov_b64 exec, -1
  s_sleep 6
  s_nop 3
  buffer_load_dwordx4 v[68:71], v16, s[4:7], s60 offen sc1
  s_sleep 3
  s_nop 1
  buffer_load_dwordx4 v[72:75], v16, s[4:7], s60 offen sc1
  s_mov_b32 s54, 0
pp_67:
  s_waitcnt vmcnt(1)
  v_mfma_f32_16x16x32_f16 v[120:123], v[44:47], v[68:71], 0
  v_bitop3_b32 v27, v68, s61, 1 bitop3:0x28
  v_cmp_ne_u32 vcc, 0, v27
  s_nop 1
  s_cbranch_vccnz p2_69
  s_nop 2
pg_68:
  v_add_f32_dpp v120, v120, v120 row_ror:8 row_mask:0xf bank_mask:0xf
  v_add_f32_dpp v121, v121, v121 row_ror:8 row_mask:0xf bank_mask:0xf
  s_mov_b64 exec, s[62:63]
  v_cvt_pk_bf16_f32 v120, v120, v121
  v_min_u32 v120, -2, v120
  buffer_store_dword v120, v17, s[8:11], s55 offen
  s_mov_b64 exec, -1
nt_66:
  s_barrier
  s_mov_b32 s58, s55
  s_add_u32 s52, s52, 1
  s_and_b32 s21, s52, 3
  s_mul_i32 s56, s21, 122880
  s_add_u32 s21, s52, 1
  s_and_b32 s21, s21, 3
  s_mul_i32 s55, s21, 122880
  s_add_u32 s55, s55, s75
  s_add_u32 s21, s52, 2
  s_and_b32 s21, s21, 3
  s_mul_i32 s57, s21, 122880
  s_add_u32 s21, s52, 3
  s_and_b32 s21, s21, 3
  s_mul_i32 s59, s21, 122880
  s_add_u32 s59, s59, s75
  s_bfe_u32 s61, s52, 0x10001
  s_and_b32 s21, s52, 1
  s_lshl_b32 s60, s21, 19
  s_mov_b32 s54, 0
  s_sleep 3
  s_nop 2
  buffer_load_dwordx4 v[60:63], v190, s[8:11], s58 offen offset:0 sc1
  buffer_load_dwordx4 v[64:67], v190, s[8:11], s58 offen offset:1024 sc1
  buffer_load_dwordx4 v[68:71], v190, s[8:11], s58 offen offset:2048 sc1
  s_branch top_55
mr_56:
  s_mov_b64 exec, s[22:23]
  s_cbranch_execz ms_70
  buffer_load_dwordx4 v[60:63], v190, s[8:11], s58 offen offset:0 sc1
ms_70:
  s_mov_b64 exec, s[98:99]
  s_cbranch_execz ms_71
  buffer_load_dwordx4 v[64:67], v190, s[8:11], s58 offen offset:1024 sc1
ms_71:
  s_mov_b64 exec, s[100:101]
  s_cbranch_execz ms_72
  buffer_load_dwordx4 v[68:71], v190, s[8:11], s58 offen offset:2048 sc1
ms_72:
  s_add_u32 s54, s54, 1
  s_cmp_gt_u32 s54, 131072
  s_cbranch_scc1 end0
  s_waitcnt vmcnt(0)
  s_mov_b64 exec, s[22:23]
  ds_write_b128 v190, v[60:63] offset:0
  v_cmp_eq_u32 s[22:23], -1, v60
  s_mov_b64 exec, s[98:99]
  ds_write_b128 v190, v[64:67] offset:1024
  v_cmp_eq_u32 s[98:99], -1, v64
  s_mov_b64 exec, s[100:101]
  ds_write_b128 v190, v[68:71] offset:2048
  v_cmp_eq_u32 s[100:101], -1, v68
  s_mov_b64 exec, -1
  s_or_b64 vcc, s[22:23], s[98:99]
  s_or_b64 vcc, vcc, s[100:101]
  s_cbranch_scc1 mr_56
  s_branch mo_60
mn_57:
  v_max3_u32 v27, v48, v49, v50
  v_max3_u32 v27, v27, v51, v52
  v_max3_u32 v27, v27, v53, v54
  v_max3_u32 v27, v27, v55, v56
  v_max3_u32 v27, v27, v57, v58
  v_max3_u32 v27, v27, v59, v60
  v_max3_u32 v27, v27, v61, v62
  v_max3_u32 v27, v27, v63, v64
  v_max3_u32 v27, v27, v65, v66
  v_max3_u32 v27, v27, v67, v68
  v_max3_u32 v27, v27, v69, v70
  v_max3_u32 v27, v27, v71, v72
  v_max3_u32 v27, v27, v73, v74
  v_max3_u32 v27, v27, v75, v76
  v_max3_u32 v27, v27, v77, v78
  v_max3_u32 v27, v27, v79, v80
  v_max3_u32 v27, v27, v81, v82
  v_max3_u32 v27, v27, v83, v84
  v_max3_u32 v27, v27, v85, v86
  v_max3_u32 v27, v27, v87, v87
  v_cmp_eq_u32 vcc, -1, v27
  s_cmp_eq_u32 s52, 0
  s_cbranch_scc1 mk_58
  s_cbranch_vccz mk_58
  s_waitcnt lgkmcnt(0)
  s_barrier
  s_nop 7
  v_mov_b32 v88, 0
  v_mov_b32 v89, 0
  v_mov_b32 v90, 0
  v_mov_b32 v91, 0
  v_mov_b32 v92, 0
  v_mov_b32 v93, 0
  v_mov_b32 v94, 0
  v_mov_b32 v95, 0
  v_mov_b32 v96, 0
  v_mov_b32 v97, 0
  v_mov_b32 v98, 0
  v_mov_b32 v99, 0
  v_mov_b32 v100, 0
  v_mov_b32 v101, 0
  v_mov_b32 v102, 0
  v_mov_b32 v103, 0
  s_mov_b64 s[22:23], -1
  s_mov_b64 s[98:99], -1
  s_mov_b64 s[100:101], -1
  s_branch mr_56
sr_61:
  s_mov_b32 s54, 0
sr_73:
  s_mov_b64 exec, vcc
  buffer_load_dwordx4 v[124:127], v9, s[8:11], s56 offen sc1
  buffer_load_dwordx4 v[128:131], v9, s[8:11], s56 offen offset:1024 sc1
  buffer_load_dwordx4 v[132:135], v10, s[8:11], s56 offen sc1
  s_mov_b64 exec, -1
  s_add_u32 s54, s54, 1
  s_cmp_gt_u32 s54, 131072
  s_cbranch_scc1 end0
  s_and_b32 s21, s54, 31
  s_cbranch_scc0 sr_74
  s_waitcnt vmcnt(0)
  v_pk_add_f16 v172, v124, v126
  v_pk_add_f16 v173, v125, v127
  v_pk_add_f16 v174, v128, v130
  v_pk_add_f16 v175, v129, v131
  v_fma_mix_f32 v166, v172, 1.0, v174 op_sel:[0,0,0] op_sel_hi:[1,0,1]
  v_fma_mix_f32 v168, v173, 1.0, v175 op_sel:[0,0,0] op_sel_hi:[1,0,1]
  v_pk_add_f16 v176, v132, v133
  v_pk_add_f16 v177, v134, v135
  v_add_f32 v27, v166, v168
  v_fma_mix_f32 v170, v176, 1.0, v177 op_sel:[0,0,0] op_sel_hi:[1,0,1]
  v_fma_mix_f32 v167, v172, 1.0, v174 op_sel:[1,0,1] op_sel_hi:[1,0,1]
  v_cmp_u_f32 vcc, v27, v170
  v_fma_mix_f32 v169, v173, 1.0, v175 op_sel:[1,0,1] op_sel_hi:[1,0,1]
  v_fma_mix_f32 v171, v176, 1.0, v177 op_sel:[1,0,1] op_sel_hi:[1,0,1]
  s_cbranch_vccnz sr_73
  s_branch sj_62
sr_74:
  s_waitcnt vmcnt(0)
  v_pk_add_f16 v172, v124, v126
  v_pk_add_f16 v173, v125, v127
  v_pk_add_f16 v174, v128, v130
  v_pk_add_f16 v175, v129, v131
  v_fma_mix_f32 v166, v172, 1.0, v174 op_sel:[0,0,0] op_sel_hi:[1,0,1]
  v_fma_mix_f32 v168, v173, 1.0, v175 op_sel:[0,0,0] op_sel_hi:[1,0,1]
  v_pk_add_f16 v176, v132, v133
  v_pk_add_f16 v177, v134, v135
  v_add_f32 v27, v166, v168
  v_fma_mix_f32 v170, v176, 1.0, v177 op_sel:[0,0,0] op_sel_hi:[1,0,1]
  v_fma_mix_f32 v167, v172, 1.0, v174 op_sel:[1,0,1] op_sel_hi:[1,0,1]
  v_cmp_u_f32 vcc, v27, v170
  v_fma_mix_f32 v169, v173, 1.0, v175 op_sel:[1,0,1] op_sel_hi:[1,0,1]
  v_fma_mix_f32 v171, v176, 1.0, v177 op_sel:[1,0,1] op_sel_hi:[1,0,1]
  v_max3_u32 v27, v124, v126, v128
  v_max3_u32 v27, v27, v130, v132
  v_max3_u32 v27, v27, v133, v134
  v_max3_u32 v27, v27, v135, v135
  v_cmp_eq_u32 vcc, -1, v27
  s_nop 1
  s_cbranch_vccnz sr_73
  s_branch sj_62
fx_64:
  s_cmp_eq_u32 s81, 1
  s_cbranch_scc1 fk_65
  s_mov_b32 s81, 1
  v_max3_f32 v164, v166, v167, v168
  v_max3_f32 v165, v169, v170, v171
  v_max_f32 v164, v164, v165
  s_nop 1
  v_max_f32_dpp v164, v164, v164 row_ror:8 row_mask:0xf bank_mask:0xf
  v_mov_b32 v165, v164
  s_nop 1
  v_permlane32_swap_b32 v164, v165
  v_max_f32 v164, v164, v165
  v_mov_b32 v165, v164
  s_nop 1
  v_permlane16_swap_b32 v164, v165
  v_max_f32 v164, v164, v165
  v_sub_f32 v166, v166, v164
  v_sub_f32 v167, v167, v164
  v_sub_f32 v168, v168, v164
  v_sub_f32 v169, v169, v164
  v_sub_f32 v170, v170, v164
  v_sub_f32 v171, v171, v164
  s_branch ex_63
p2_69:
  buffer_load_dwordx4 v[68:71], v16, s[4:7], s60 offen sc1
  s_waitcnt vmcnt(1)
  v_mfma_f32_16x16x32_f16 v[120:123], v[44:47], v[72:75], 0
  v_bitop3_b32 v27, v72, s61, 1 bitop3:0x28
  v_cmp_ne_u32 vcc, 0, v27
  s_nop 1
  s_cbranch_vccz pg_68
  buffer_load_dwordx4 v[72:75], v16, s[4:7], s60 offen sc1
  s_add_u32 s54, s54, 1
  s_cmp_gt_u32 s54, 131072
  s_cbranch_scc1 end0
  s_branch pp_67
last_59:
  v_smfmac_f32_16x16x64_bf16 v[96:99], v[48:51], a[0:7], v22
  v_smfmac_f32_16x16x64_bf16 v[100:103], v[48:51], a[80:87], v22
  v_smfmac_f32_16x16x64_bf16 v[96:99], v[52:55], a[8:15], v22
  v_smfmac_f32_16x16x64_bf16 v[100:103], v[52:55], a[88:95], v22
  v_smfmac_f32_16x16x64_bf16 v[96:99], v[56:59], a[16:23], v22
  v_smfmac_f32_16x16x64_bf16 v[100:103], v[56:59], a[96:103], v22
  v_smfmac_f32_16x16x64_bf16 v[96:99], v[60:63], a[24:31], v22
  v_smfmac_f32_16x16x64_bf16 v[96:99], v[64:67], a[32:39], v22
  v_smfmac_f32_16x16x64_bf16 v[96:99], v[68:71], a[40:47], v22
  v_smfmac_f32_16x16x64_bf16 v[96:99], v[72:75], a[48:55], v22
  v_smfmac_f32_16x16x64_bf16 v[96:99], v[76:79], a[56:63], v22
  v_smfmac_f32_16x16x64_bf16 v[96:99], v[80:83], a[64:71], v22
  v_smfmac_f32_16x16x64_bf16 v[96:99], v[84:87], a[72:79], v22
  v_smfmac_f32_16x16x64_bf16 v[100:103], v[60:63], a[104:111], v22
  v_smfmac_f32_16x16x64_bf16 v[100:103], v[64:67], a[112:119], v22
  v_smfmac_f32_16x16x64_bf16 v[100:103], v[68:71], a[120:127], v22
  v_smfmac_f32_16x16x64_bf16 v[100:103], v[72:75], a[128:135], v22
  v_smfmac_f32_16x16x64_bf16 v[100:103], v[76:79], a[136:143], v22
  v_smfmac_f32_16x16x64_bf16 v[100:103], v[80:83], a[144:151], v22
  v_smfmac_f32_16x16x64_bf16 v[100:103], v[84:87], a[152:159], v22
  s_nop 7
  v_permlane32_swap_b32 v96, v100
  v_permlane32_swap_b32 v97, v101
  v_permlane32_swap_b32 v98, v102
  v_permlane32_swap_b32 v99, v103
  v_pk_add_f32 v[96:97], v[96:97], v[100:101]
  v_pk_add_f32 v[98:99], v[98:99], v[102:103]
  v_cvt_pk_bf16_f32 v182, v96, v97
  v_cvt_pk_bf16_f32 v183, v98, v99
  v_min_u32 v182, -2, v182
  ds_write_b64 v26, v[182:183]
  s_waitcnt lgkmcnt(0)
  s_barrier
  s_branch chain_done
E_32:
  v_add_u32 v190, 6144, v4
  ds_read_b128 v[72:75], v4 offset:6144
  ds_read_b128 v[76:79], v4 offset:7168
  ds_read_b128 v[80:83], v4 offset:8192
  s_waitcnt lgkmcnt(0)
  s_branch mo_80
  .p2align 3
top_75:
  s_waitcnt vmcnt(2)
  ds_write_b128 v190, v[72:75] offset:0
  v_cmp_eq_u32 s[22:23], -1, v72
  s_waitcnt vmcnt(1)
  ds_write_b128 v190, v[76:79] offset:1024
  v_cmp_eq_u32 s[98:99], -1, v76
  s_waitcnt vmcnt(0)
  ds_write_b128 v190, v[80:83] offset:2048
  v_cmp_eq_u32 s[100:101], -1, v80
  s_or_b64 vcc, s[22:23], s[98:99]
  s_or_b64 vcc, vcc, s[100:101]
  s_cbranch_scc1 mr_76
mo_80:
  s_waitcnt lgkmcnt(0)
  s_barrier
  ds_read_b128 v[48:51], v4 offset:0
  ds_read_b128 v[52:55], v4 offset:1024
  v_smfmac_f32_16x16x64_bf16 v[92:95], v[72:75], v[224:231], v22
  ds_read_b128 v[56:59], v4 offset:2048
  v_smfmac_f32_16x16x64_bf16 v[88:91], v[72:75], a[208:215], v22
  ds_read_b128 v[60:63], v4 offset:3072
  v_smfmac_f32_16x16x64_bf16 v[92:95], v[76:79], v[232:239], v22
  ds_read_b128 v[64:67], v4 offset:4096
  v_smfmac_f32_16x16x64_bf16 v[88:91], v[76:79], a[216:223], v22
  ds_read_b128 v[68:71], v4 offset:5120
  v_smfmac_f32_16x16x64_bf16 v[92:95], v[80:83], v[240:247], v22
  ds_read_b128 v[84:87], v4 offset:9216
  v_smfmac_f32_16x16x64_bf16 v[88:91], v[80:83], a[224:231], v22
  s_waitcnt lgkmcnt(6)
  v_smfmac_f32_16x16x64_bf16 v[92:95], v[48:51], a[240:247], v22
  v_smfmac_f32_16x16x64_bf16 v[88:91], v[48:51], a[160:167], v22
  s_waitcnt lgkmcnt(5)
  v_smfmac_f32_16x16x64_bf16 v[92:95], v[52:55], a[248:255], v22
  s_waitcnt lgkmcnt(4)
  v_smfmac_f32_16x16x64_bf16 v[92:95], v[56:59], v[192:199], v22
  s_waitcnt lgkmcnt(3)
  v_smfmac_f32_16x16x64_bf16 v[92:95], v[60:63], v[200:207], v22
  s_waitcnt lgkmcnt(2)
  v_smfmac_f32_16x16x64_bf16 v[92:95], v[64:67], v[208:215], v22
  s_waitcnt lgkmcnt(1)
  v_smfmac_f32_16x16x64_bf16 v[92:95], v[68:71], v[216:223], v22
  s_waitcnt lgkmcnt(0)
  v_smfmac_f32_16x16x64_bf16 v[92:95], v[84:87], v[248:255], v22
  v_smfmac_f32_16x16x64_bf16 v[88:91], v[52:55], a[168:175], v22
  v_smfmac_f32_16x16x64_bf16 v[88:91], v[56:59], a[176:183], v22
  v_smfmac_f32_16x16x64_bf16 v[88:91], v[60:63], a[184:191], v22
  v_permlane32_swap_b32 v92, v93
  v_smfmac_f32_16x16x64_bf16 v[88:91], v[64:67], a[192:199], v22
  v_permlane32_swap_b32 v94, v95
  v_smfmac_f32_16x16x64_bf16 v[88:91], v[68:71], a[200:207], v22
  v_permlane32_swap_b32 v93, v92
  v_smfmac_f32_16x16x64_bf16 v[88:91], v[84:87], a[232:239], v22
  v_permlane32_swap_b32 v95, v94
  v_pk_mul_f32 v[120:121], v[92:93], v[24:25] op_sel:[1,0] op_sel_hi:[0,1]
  v_pk_mul_f32 v[122:123], v[94:95], v[24:25] op_sel:[1,0] op_sel_hi:[0,1]
  s_nop 4
  v_pk_fma_f32 v[88:89], v[88:89], v[24:25], v[120:121]
  v_pk_fma_f32 v[90:91], v[90:91], v[24:25], v[122:123]
  v_cvt_pk_bf16_f32 v120, v88, v89
  v_cvt_pk_bf16_f32 v121, v90, v91
  ds_write_b64 v6, v[120:121]
  v_cmp_u_f32 vcc, v88, v89
  v_cmp_u_f32 s[22:23], v90, v91
  s_nop 1
  s_or_b64 vcc, vcc, s[22:23]
  s_cbranch_vccnz mn_77
mk_78:
  s_waitcnt lgkmcnt(0)
  s_barrier
  ds_read_b64_tr_b16 v[104:105], v7 offset:0
  ds_read_b64_tr_b16 v[106:107], v7 offset:768
  ds_read_b64_tr_b16 v[108:109], v7 offset:1536
  ds_read_b64 v[140:141], v11
  s_cmp_eq_u32 s52, 63
  s_cbranch_scc1 last_79
  s_waitcnt lgkmcnt(2)
  v_mfma_f32_16x16x32_bf16 v[120:123], v[104:107], v[104:107], 0
  s_waitcnt lgkmcnt(1)
  v_mfma_f32_16x16x32_bf16 v[120:123], v[108:111], v[108:111], v[120:123]
  s_mov_b64 exec, s[64:65]
  s_nop 6
  v_cvt_pk_f16_f32 v120, v120, v121
  buffer_store_dword v120, v8, s[8:11], s56 offen
  v_cvt_pk_f16_f32 v121, v122, v123
  buffer_store_dword v121, v8, s[8:11], s56 offen offset:128
  s_mov_b64 exec, -1
  s_sleep 3
  s_nop 1
  v_smfmac_f32_16x16x64_bf16 v[96:99], v[48:51], a[0:7], v22
  v_smfmac_f32_16x16x64_bf16 v[100:103], v[48:51], a[80:87], v22
  v_smfmac_f32_16x16x64_bf16 v[96:99], v[52:55], a[8:15], v22
  v_smfmac_f32_16x16x64_bf16 v[100:103], v[52:55], a[88:95], v22
  v_smfmac_f32_16x16x64_bf16 v[96:99], v[56:59], a[16:23], v22
  v_smfmac_f32_16x16x64_bf16 v[100:103], v[56:59], a[96:103], v22
  v_smfmac_f32_16x16x64_bf16 v[96:99], v[60:63], a[24:31], v22
  v_smfmac_f32_16x16x64_bf16 v[96:99], v[64:67], a[32:39], v22
  v_smfmac_f32_16x16x64_bf16 v[96:99], v[68:71], a[40:47], v22
  v_smfmac_f32_16x16x64_bf16 v[96:99], v[72:75], a[48:55], v22
  v_smfmac_f32_16x16x64_bf16 v[96:99], v[76:79], a[56:63], v22
  buffer_load_dwordx4 v[124:127], v9, s[8:11], s56 offen sc1
  v_smfmac_f32_16x16x64_bf16 v[96:99], v[80:83], a[64:71], v22
  buffer_load_dwordx4 v[128:131], v9, s[8:11], s56 offen offset:1024 sc1
  v_smfmac_f32_16x16x64_bf16 v[96:99], v[84:87], a[72:79], v22
  buffer_load_dwordx4 v[132:135], v10, s[8:11], s56 offen sc1
  v_smfmac_f32_16x16x64_bf16 v[100:103], v[60:63], a[104:111], v22
  v_smfmac_f32_16x16x64_bf16 v[100:103], v[64:67], a[112:119], v22
  v_smfmac_f32_16x16x64_bf16 v[100:103], v[68:71], a[120:127], v22
  v_smfmac_f32_16x16x64_bf16 v[100:103], v[72:75], a[128:135], v22
  v_cvt_pk_bf16_f32 v136, v96, v97
  v_smfmac_f32_16x16x64_bf16 v[100:103], v[76:79], a[136:143], v22
  v_cvt_pk_bf16_f32 v137, v98, v99
  v_smfmac_f32_16x16x64_bf16 v[100:103], v[80:83], a[144:151], v22
  v_smfmac_f32_16x16x64_bf16 v[100:103], v[84:87], a[152:159], v22
  s_waitcnt vmcnt(2)
  v_pk_add_f16 v172, v124, v126
  v_pk_add_f16 v173, v125, v127
  s_waitcnt vmcnt(1)
  v_pk_add_f16 v174, v128, v130
  v_pk_add_f16 v175, v129, v131
  v_fma_mix_f32 v166, v172, 1.0, v174 op_sel:[0,0,0] op_sel_hi:[1,0,1]
  v_fma_mix_f32 v168, v173, 1.0, v175 op_sel:[0,0,0] op_sel_hi:[1,0,1]
  s_waitcnt vmcnt(0)
  v_pk_add_f16 v176, v132, v133
  v_pk_add_f16 v177, v134, v135
  v_fma_mix_f32 v170, v176, 1.0, v177 op_sel:[0,0,0] op_sel_hi:[1,0,1]
  v_fma_mix_f32 v167, v172, 1.0, v174 op_sel:[1,0,1] op_sel_hi:[1,0,1]
  v_cmp_u_f32 vcc, v166, v170
  v_fma_mix_f32 v169, v173, 1.0, v175 op_sel:[1,0,1] op_sel_hi:[1,0,1]
  v_fma_mix_f32 v171, v176, 1.0, v177 op_sel:[1,0,1] op_sel_hi:[1,0,1]
  v_cvt_pk_bf16_f32 v138, v100, v101
  s_cbranch_vccnz sr_81
sj_82:
ex_83:
  v_exp_f32 v172, v166
  v_exp_f32 v173, v167
  v_exp_f32 v174, v168
  v_cvt_pk_bf16_f32 v156, v172, v173
  v_exp_f32 v175, v169
  v_exp_f32 v176, v170
  v_cvt_pk_bf16_f32 v157, v174, v175
  v_mov_b32_dpp v158, v156 row_ror:8 row_mask:0xf bank_mask:0xf
  v_exp_f32 v177, v171
  v_mov_b32_dpp v159, v157 row_ror:8 row_mask:0xf bank_mask:0xf
  v_cvt_pk_bf16_f32 v160, v176, v177
  v_cvt_pk_bf16_f32 v139, v102, v103
  v_mfma_f32_16x16x32_bf16 v[178:181], v[152:155], v[156:159], 0
  s_waitcnt lgkmcnt(0)
  v_mov_b32_dpp v161, v160 row_ror:8 row_mask:0xf bank_mask:0xf
  v_mfma_f32_16x16x32_bf16 v[182:185], v[144:147], v[156:159], 0
  s_nop 0
  v_mfma_f32_16x16x32_bf16 v[178:181], v[140:143], v[160:163], v[178:181]
  v_mfma_f32_16x16x32_bf16 v[182:185], v[136:139], v[160:163], v[182:185]
  v_mfma_f32_16x16x32_bf16 v[186:189], v[148:151], v[156:159], 0
  v_mfma_f32_16x16x32_bf16 v[186:189], v[138:141], v[160:163], v[186:189]
  s_mov_b64 exec, s[62:63]
  v_rcp_f32 v164, v180
  s_nop 0
  v_pk_mul_f32 v[178:179], v[178:179], v[164:165] op_sel_hi:[1,0]
  v_pk_mul_f32 v[182:183], v[182:183], v[164:165] op_sel_hi:[1,0]
  v_pk_mul_f32 v[184:185], v[184:185], v[164:165] op_sel_hi:[1,0]
  v_cvt_pk_f16_f32 v64, v178, v179
  v_cvt_pk_f16_f32 v60, v182, v183
  v_pk_mul_f32 v[186:187], v[186:187], v[164:165] op_sel_hi:[1,0]
  v_pk_mul_f32 v[188:189], v[188:189], v[164:165] op_sel_hi:[1,0]
  v_cvt_pk_f16_f32 v61, v184, v185
  v_cvt_pk_f16_f32 v62, v186, v187
  v_cvt_pk_f16_f32 v63, v188, v189
  ds_write_b128 v13, v[60:63]
  ds_write_b32 v14, v64
  v_add_f32 v165, v164, v180
  v_cmp_ngt_f32 vcc, s80, v165
  s_mov_b64 exec, -1
  s_nop 0
  s_cbranch_vccnz fx_84
fk_85:
  s_waitcnt lgkmcnt(0)
  s_barrier
  s_add_u32 m0, s74, 0
  s_add_u32 s21, s79, 0
  buffer_load_dwordx4 v4, s[28:31], s21 offen sc1 lds
  s_add_u32 m0, s74, 3072
  s_add_u32 s21, s79, 41984
  buffer_load_dwordx4 v4, s[28:31], s21 offen sc1 lds
  s_add_u32 m0, s74, 6144
  s_add_u32 s21, s79, 122880
  buffer_load_dwordx4 v4, s[28:31], s21 offen sc1 lds
  s_add_u32 s72, s72, 1310720
  s_add_u32 s79, s79, 1310720
  s_add_u32 s73, s73, 393216
  s_xor_b32 s74, s74, 16384
  s_nop 15
  s_nop 3
  v_permlane32_swap_b32 v96, v100
  v_permlane32_swap_b32 v97, v101
  v_permlane32_swap_b32 v98, v102
  v_permlane32_swap_b32 v99, v103
  v_pk_add_f32 v[96:97], v[96:97], v[100:101]
  v_pk_add_f32 v[98:99], v[98:99], v[102:103]
  v_cvt_pk_bf16_f32 v182, v96, v97
  v_cvt_pk_bf16_f32 v183, v98, v99
  v_min_u32 v182, -2, v182
  ds_write_b64 v26, v[182:183]
  ds_read_b128 v[144:147], v18
  ds_read_b128 v[148:151], v18 offset:1024
  ds_read_b128 v[152:155], v19
  v_xor_b32 v18, 16384, v18
  v_xor_b32 v19, 16384, v19
  v_mov_b32 v88, 0
  v_mov_b32 v89, 0
  v_mov_b32 v90, 0
  v_mov_b32 v91, 0
  v_mov_b32 v92, 0
  v_mov_b32 v93, 0
  v_mov_b32 v94, 0
  v_mov_b32 v95, 0
  v_mov_b32 v96, 0
  v_mov_b32 v97, 0
  v_mov_b32 v98, 0
  v_mov_b32 v99, 0
  v_mov_b32 v100, 0
  v_mov_b32 v101, 0
  v_mov_b32 v102, 0
  v_mov_b32 v103, 0
  s_mov_b32 s81, 0
  s_waitcnt lgkmcnt(0)
  s_barrier
  s_mov_b64 exec, s[64:65]
  buffer_store_dword v28, v8, s[8:11], s57 offen
  buffer_store_dword v28, v8, s[8:11], s57 offen offset:128
  s_mov_b64 exec, -1
  s_cmp_eq_u32 s78, 0
  s_cbranch_scc1 nt_86
  s_mov_b64 exec, s[62:63]
  buffer_store_dword v28, v17, s[8:11], s59 offen
  s_mov_b64 exec, -1
  s_sleep 6
  s_nop 3
  buffer_load_dwordx4 v[68:71], v16, s[4:7], s60 offen sc1
  s_sleep 3
  s_nop 1
  buffer_load_dwordx4 v[72:75], v16, s[4:7], s60 offen sc1
  s_mov_b32 s54, 0
pp_87:
  s_waitcnt vmcnt(1)
  v_mfma_f32_16x16x32_f16 v[120:123], v[44:47], v[68:71], 0
  v_bitop3_b32 v27, v68, s61, 1 bitop3:0x28
  v_cmp_ne_u32 vcc, 0, v27
  s_nop 1
  s_cbranch_vccnz p2_89
  s_nop 2
pg_88:
  v_add_f32_dpp v120, v120, v120 row_ror:8 row_mask:0xf bank_mask:0xf
  v_add_f32_dpp v121, v121, v121 row_ror:8 row_mask:0xf bank_mask:0xf
  s_mov_b64 exec, s[62:63]
  v_cvt_pk_bf16_f32 v120, v120, v121
  v_min_u32 v120, -2, v120
  buffer_store_dword v120, v17, s[8:11], s55 offen
  s_mov_b64 exec, -1
nt_86:
  s_barrier
  s_mov_b32 s58, s55
  s_add_u32 s52, s52, 1
  s_and_b32 s21, s52, 3
  s_mul_i32 s56, s21, 122880
  s_add_u32 s21, s52, 1
  s_and_b32 s21, s21, 3
  s_mul_i32 s55, s21, 122880
  s_add_u32 s55, s55, s75
  s_add_u32 s21, s52, 2
  s_and_b32 s21, s21, 3
  s_mul_i32 s57, s21, 122880
  s_add_u32 s21, s52, 3
  s_and_b32 s21, s21, 3
  s_mul_i32 s59, s21, 122880
  s_add_u32 s59, s59, s75
  s_bfe_u32 s61, s52, 0x10001
  s_and_b32 s21, s52, 1
  s_lshl_b32 s60, s21, 19
  s_mov_b32 s54, 0
  s_sleep 3
  s_nop 2
  buffer_load_dwordx4 v[72:75], v190, s[8:11], s58 offen offset:0 sc1
  buffer_load_dwordx4 v[76:79], v190, s[8:11], s58 offen offset:1024 sc1
  buffer_load_dwordx4 v[80:83], v190, s[8:11], s58 offen offset:2048 sc1
  s_branch top_75
mr_76:
  s_mov_b64 exec, s[22:23]
  s_cbranch_execz ms_90
  buffer_load_dwordx4 v[72:75], v190, s[8:11], s58 offen offset:0 sc1
ms_90:
  s_mov_b64 exec, s[98:99]
  s_cbranch_execz ms_91
  buffer_load_dwordx4 v[76:79], v190, s[8:11], s58 offen offset:1024 sc1
ms_91:
  s_mov_b64 exec, s[100:101]
  s_cbranch_execz ms_92
  buffer_load_dwordx4 v[80:83], v190, s[8:11], s58 offen offset:2048 sc1
ms_92:
  s_add_u32 s54, s54, 1
  s_cmp_gt_u32 s54, 131072
  s_cbranch_scc1 end0
  s_waitcnt vmcnt(0)
  s_mov_b64 exec, s[22:23]
  ds_write_b128 v190, v[72:75] offset:0
  v_cmp_eq_u32 s[22:23], -1, v72
  s_mov_b64 exec, s[98:99]
  ds_write_b128 v190, v[76:79] offset:1024
  v_cmp_eq_u32 s[98:99], -1, v76
  s_mov_b64 exec, s[100:101]
  ds_write_b128 v190, v[80:83] offset:2048
  v_cmp_eq_u32 s[100:101], -1, v80
  s_mov_b64 exec, -1
  s_or_b64 vcc, s[22:23], s[98:99]
  s_or_b64 vcc, vcc, s[100:101]
  s_cbranch_scc1 mr_76
  s_branch mo_80
mn_77:
  v_max3_u32 v27, v48, v49, v50
  v_max3_u32 v27, v27, v51, v52
  v_max3_u32 v27, v27, v53, v54
  v_max3_u32 v27, v27, v55, v56
  v_max3_u32 v27, v27, v57, v58
  v_max3_u32 v27, v27, v59, v60
  v_max3_u32 v27, v27, v61, v62
  v_max3_u32 v27, v27, v63, v64
  v_max3_u32 v27, v27, v65, v66
  v_max3_u32 v27, v27, v67, v68
  v_max3_u32 v27, v27, v69, v70
  v_max3_u32 v27, v27, v71, v72
  v_max3_u32 v27, v27, v73, v74
  v_max3_u32 v27, v27, v75, v76
  v_max3_u32 v27, v27, v77, v78
  v_max3_u32 v27, v27, v79, v80
  v_max3_u32 v27, v27, v81, v82
  v_max3_u32 v27, v27, v83, v84
  v_max3_u32 v27, v27, v85, v86
  v_max3_u32 v27, v27, v87, v87
  v_cmp_eq_u32 vcc, -1, v27
  s_cmp_eq_u32 s52, 0
  s_cbranch_scc1 mk_78
  s_cbranch_vccz mk_78
  s_waitcnt lgkmcnt(0)
  s_barrier
  s_nop 7
  v_mov_b32 v88, 0
  v_mov_b32 v89, 0
  v_mov_b32 v90, 0
  v_mov_b32 v91, 0
  v_mov_b32 v92, 0
  v_mov_b32 v93, 0
  v_mov_b32 v94, 0
  v_mov_b32 v95, 0
  v_mov_b32 v96, 0
  v_mov_b32 v97, 0
  v_mov_b32 v98, 0
  v_mov_b32 v99, 0
  v_mov_b32 v100, 0
  v_mov_b32 v101, 0
  v_mov_b32 v102, 0
  v_mov_b32 v103, 0
  s_mov_b64 s[22:23], -1
  s_mov_b64 s[98:99], -1
  s_mov_b64 s[100:101], -1
  s_branch mr_76
sr_81:
  s_mov_b32 s54, 0
sr_93:
  s_mov_b64 exec, vcc
  buffer_load_dwordx4 v[124:127], v9, s[8:11], s56 offen sc1
  buffer_load_dwordx4 v[128:131], v9, s[8:11], s56 offen offset:1024 sc1
  buffer_load_dwordx4 v[132:135], v10, s[8:11], s56 offen sc1
  s_mov_b64 exec, -1
  s_add_u32 s54, s54, 1
  s_cmp_gt_u32 s54, 131072
  s_cbranch_scc1 end0
  s_and_b32 s21, s54, 31
  s_cbranch_scc0 sr_94
  s_waitcnt vmcnt(0)
  v_pk_add_f16 v172, v124, v126
  v_pk_add_f16 v173, v125, v127
  v_pk_add_f16 v174, v128, v130
  v_pk_add_f16 v175, v129, v131
  v_fma_mix_f32 v166, v172, 1.0, v174 op_sel:[0,0,0] op_sel_hi:[1,0,1]
  v_fma_mix_f32 v168, v173, 1.0, v175 op_sel:[0,0,0] op_sel_hi:[1,0,1]
  v_pk_add_f16 v176, v132, v133
  v_pk_add_f16 v177, v134, v135
  v_add_f32 v27, v166, v168
  v_fma_mix_f32 v170, v176, 1.0, v177 op_sel:[0,0,0] op_sel_hi:[1,0,1]
  v_fma_mix_f32 v167, v172, 1.0, v174 op_sel:[1,0,1] op_sel_hi:[1,0,1]
  v_cmp_u_f32 vcc, v27, v170
  v_fma_mix_f32 v169, v173, 1.0, v175 op_sel:[1,0,1] op_sel_hi:[1,0,1]
  v_fma_mix_f32 v171, v176, 1.0, v177 op_sel:[1,0,1] op_sel_hi:[1,0,1]
  s_cbranch_vccnz sr_93
  s_branch sj_82
sr_94:
  s_waitcnt vmcnt(0)
  v_pk_add_f16 v172, v124, v126
  v_pk_add_f16 v173, v125, v127
  v_pk_add_f16 v174, v128, v130
  v_pk_add_f16 v175, v129, v131
  v_fma_mix_f32 v166, v172, 1.0, v174 op_sel:[0,0,0] op_sel_hi:[1,0,1]
  v_fma_mix_f32 v168, v173, 1.0, v175 op_sel:[0,0,0] op_sel_hi:[1,0,1]
  v_pk_add_f16 v176, v132, v133
  v_pk_add_f16 v177, v134, v135
  v_add_f32 v27, v166, v168
  v_fma_mix_f32 v170, v176, 1.0, v177 op_sel:[0,0,0] op_sel_hi:[1,0,1]
  v_fma_mix_f32 v167, v172, 1.0, v174 op_sel:[1,0,1] op_sel_hi:[1,0,1]
  v_cmp_u_f32 vcc, v27, v170
  v_fma_mix_f32 v169, v173, 1.0, v175 op_sel:[1,0,1] op_sel_hi:[1,0,1]
  v_fma_mix_f32 v171, v176, 1.0, v177 op_sel:[1,0,1] op_sel_hi:[1,0,1]
  v_max3_u32 v27, v124, v126, v128
  v_max3_u32 v27, v27, v130, v132
  v_max3_u32 v27, v27, v133, v134
  v_max3_u32 v27, v27, v135, v135
  v_cmp_eq_u32 vcc, -1, v27
  s_nop 1
  s_cbranch_vccnz sr_93
  s_branch sj_82
fx_84:
  s_cmp_eq_u32 s81, 1
  s_cbranch_scc1 fk_85
  s_mov_b32 s81, 1
  v_max3_f32 v164, v166, v167, v168
  v_max3_f32 v165, v169, v170, v171
  v_max_f32 v164, v164, v165
  s_nop 1
  v_max_f32_dpp v164, v164, v164 row_ror:8 row_mask:0xf bank_mask:0xf
  v_mov_b32 v165, v164
  s_nop 1
  v_permlane32_swap_b32 v164, v165
  v_max_f32 v164, v164, v165
  v_mov_b32 v165, v164
  s_nop 1
  v_permlane16_swap_b32 v164, v165
  v_max_f32 v164, v164, v165
  v_sub_f32 v166, v166, v164
  v_sub_f32 v167, v167, v164
  v_sub_f32 v168, v168, v164
  v_sub_f32 v169, v169, v164
  v_sub_f32 v170, v170, v164
  v_sub_f32 v171, v171, v164
  s_branch ex_83
p2_89:
  buffer_load_dwordx4 v[68:71], v16, s[4:7], s60 offen sc1
  s_waitcnt vmcnt(1)
  v_mfma_f32_16x16x32_f16 v[120:123], v[44:47], v[72:75], 0
  v_bitop3_b32 v27, v72, s61, 1 bitop3:0x28
  v_cmp_ne_u32 vcc, 0, v27
  s_nop 1
  s_cbranch_vccz pg_88
  buffer_load_dwordx4 v[72:75], v16, s[4:7], s60 offen sc1
  s_add_u32 s54, s54, 1
  s_cmp_gt_u32 s54, 131072
  s_cbranch_scc1 end0
  s_branch pp_87
last_79:
  v_smfmac_f32_16x16x64_bf16 v[96:99], v[48:51], a[0:7], v22
  v_smfmac_f32_16x16x64_bf16 v[100:103], v[48:51], a[80:87], v22
  v_smfmac_f32_16x16x64_bf16 v[96:99], v[52:55], a[8:15], v22
  v_smfmac_f32_16x16x64_bf16 v[100:103], v[52:55], a[88:95], v22
  v_smfmac_f32_16x16x64_bf16 v[96:99], v[56:59], a[16:23], v22
  v_smfmac_f32_16x16x64_bf16 v[100:103], v[56:59], a[96:103], v22
  v_smfmac_f32_16x16x64_bf16 v[96:99], v[60:63], a[24:31], v22
  v_smfmac_f32_16x16x64_bf16 v[96:99], v[64:67], a[32:39], v22
  v_smfmac_f32_16x16x64_bf16 v[96:99], v[68:71], a[40:47], v22
  v_smfmac_f32_16x16x64_bf16 v[96:99], v[72:75], a[48:55], v22
  v_smfmac_f32_16x16x64_bf16 v[96:99], v[76:79], a[56:63], v22
  v_smfmac_f32_16x16x64_bf16 v[96:99], v[80:83], a[64:71], v22
  v_smfmac_f32_16x16x64_bf16 v[96:99], v[84:87], a[72:79], v22
  v_smfmac_f32_16x16x64_bf16 v[100:103], v[60:63], a[104:111], v22
  v_smfmac_f32_16x16x64_bf16 v[100:103], v[64:67], a[112:119], v22
  v_smfmac_f32_16x16x64_bf16 v[100:103], v[68:71], a[120:127], v22
  v_smfmac_f32_16x16x64_bf16 v[100:103], v[72:75], a[128:135], v22
  v_smfmac_f32_16x16x64_bf16 v[100:103], v[76:79], a[136:143], v22
  v_smfmac_f32_16x16x64_bf16 v[100:103], v[80:83], a[144:151], v22
  v_smfmac_f32_16x16x64_bf16 v[100:103], v[84:87], a[152:159], v22
  s_nop 7
  v_permlane32_swap_b32 v96, v100
  v_permlane32_swap_b32 v97, v101
  v_permlane32_swap_b32 v98, v102
  v_permlane32_swap_b32 v99, v103
  v_pk_add_f32 v[96:97], v[96:97], v[100:101]
  v_pk_add_f32 v[98:99], v[98:99], v[102:103]
  v_cvt_pk_bf16_f32 v182, v96, v97
  v_cvt_pk_bf16_f32 v183, v98, v99
  v_min_u32 v182, -2, v182
  ds_write_b64 v26, v[182:183]
  s_waitcnt lgkmcnt(0)
  s_barrier
  s_branch chain_done
E_34:
  v_add_u32 v190, 9216, v4
  ds_read_b128 v[84:87], v4 offset:9216
  s_waitcnt lgkmcnt(0)
  s_branch mo_100
  .p2align 3
top_95:
  s_waitcnt vmcnt(0)
  ds_write_b128 v190, v[84:87] offset:0
  v_cmp_eq_u32 s[22:23], -1, v84
  s_or_b64 vcc, s[22:23], s[22:23]
  s_cbranch_scc1 mr_96
mo_100:
  s_waitcnt lgkmcnt(0)
  s_barrier
  ds_read_b128 v[48:51], v4 offset:0
  ds_read_b128 v[52:55], v4 offset:1024
  v_smfmac_f32_16x16x64_bf16 v[92:95], v[84:87], v[248:255], v22
  ds_read_b128 v[56:59], v4 offset:2048
  v_smfmac_f32_16x16x64_bf16 v[88:91], v[84:87], a[232:239], v22
  s_waitcnt lgkmcnt(2)
  ds_read_b128 v[60:63], v4 offset:3072
  v_smfmac_f32_16x16x64_bf16 v[92:95], v[48:51], a[240:247], v22
  ds_read_b128 v[64:67], v4 offset:4096
  v_smfmac_f32_16x16x64_bf16 v[88:91], v[48:51], a[160:167], v22
  s_waitcnt lgkmcnt(3)
  ds_read_b128 v[68:71], v4 offset:5120
  v_smfmac_f32_16x16x64_bf16 v[92:95], v[52:55], a[248:255], v22
  ds_read_b128 v[72:75], v4 offset:6144
  v_smfmac_f32_16x16x64_bf16 v[88:91], v[52:55], a[168:175], v22
  s_waitcnt lgkmcnt(4)
  ds_read_b128 v[76:79], v4 offset:7168
  v_smfmac_f32_16x16x64_bf16 v[92:95], v[56:59], v[192:199], v22
  ds_read_b128 v[80:83], v4 offset:8192
  v_smfmac_f32_16x16x64_bf16 v[88:91], v[56:59], a[176:183], v22
  s_waitcnt lgkmcnt(5)
  s_add_u32 m0, s74, 10240
  s_nop 0
  buffer_load_dwordx4 v4, s[16:19], s73 offen offset:0 sc1 lds
  v_smfmac_f32_16x16x64_bf16 v[92:95], v[60:63], v[200:207], v22
  s_waitcnt lgkmcnt(4)
  s_add_u32 m0, s74, 10240
  s_nop 0
  buffer_load_dwordx4 v4, s[16:19], s73 offen offset:1024 sc1 lds
  v_smfmac_f32_16x16x64_bf16 v[92:95], v[64:67], v[208:215], v22
  s_waitcnt lgkmcnt(3)
  s_add_u32 m0, s74, 10240
  s_nop 0
  buffer_load_dwordx4 v4, s[16:19], s73 offen offset:2048 sc1 lds
  v_smfmac_f32_16x16x64_bf16 v[92:95], v[68:71], v[216:223], v22
  s_waitcnt lgkmcnt(2)
  v_smfmac_f32_16x16x64_bf16 v[92:95], v[72:75], v[224:231], v22
  s_waitcnt lgkmcnt(1)
  v_smfmac_f32_16x16x64_bf16 v[92:95], v[76:79], v[232:239], v22
  s_waitcnt lgkmcnt(0)
  v_smfmac_f32_16x16x64_bf16 v[92:95], v[80:83], v[240:247], v22
  v_smfmac_f32_16x16x64_bf16 v[88:91], v[60:63], a[184:191], v22
  v_smfmac_f32_16x16x64_bf16 v[88:91], v[64:67], a[192:199], v22
  v_smfmac_f32_16x16x64_bf16 v[88:91], v[68:71], a[200:207], v22
  v_cvt_pk_bf16_f32 v122, v92, v93
  v_smfmac_f32_16x16x64_bf16 v[88:91], v[72:75], a[208:215], v22
  v_cvt_pk_bf16_f32 v123, v94, v95
  v_smfmac_f32_16x16x64_bf16 v[88:91], v[76:79], a[216:223], v22
  ds_write_b64 v12, v[122:123] offset:13056
  v_smfmac_f32_16x16x64_bf16 v[88:91], v[80:83], a[224:231], v22
  v_smfmac_f32_16x16x64_bf16 v[96:99], v[48:51], a[0:7], v22
  v_smfmac_f32_16x16x64_bf16 v[100:103], v[48:51], a[80:87], v22
  v_smfmac_f32_16x16x64_bf16 v[96:99], v[52:55], a[8:15], v22
  v_cvt_pk_bf16_f32 v120, v88, v89
  v_cvt_pk_bf16_f32 v121, v90, v91
  ds_write_b64 v12, v[120:121] offset:12544
  v_smfmac_f32_16x16x64_bf16 v[100:103], v[52:55], a[88:95], v22
  v_cmp_u_f32 vcc, v88, v89
  v_smfmac_f32_16x16x64_bf16 v[96:99], v[56:59], a[16:23], v22
  v_cmp_u_f32 s[22:23], v90, v91
  s_nop 0
  s_or_b64 vcc, vcc, s[22:23]
  s_cbranch_vccnz mn_97
mk_98:
  s_waitcnt lgkmcnt(0)
  s_barrier
  ds_read_b64_tr_b16 v[104:105], v7 offset:0
  ds_read_b64_tr_b16 v[106:107], v7 offset:768
  ds_read_b64_tr_b16 v[108:109], v7 offset:1536
  ds_read_b64 v[140:141], v11
  s_cmp_eq_u32 s52, 63
  s_cbranch_scc1 last_99
  s_add_u32 s22, s52, 3
  s_min_u32 s22, s22, 64
  v_cmp_gt_u32 vcc, s22, v42
  s_nop 1
  s_cbranch_vccnz kw_101
kv_102:
  v_smfmac_f32_16x16x64_bf16 v[100:103], v[56:59], a[96:103], v22
  v_smfmac_f32_16x16x64_bf16 v[96:99], v[60:63], a[24:31], v22
  v_smfmac_f32_16x16x64_bf16 v[96:99], v[64:67], a[32:39], v22
  v_smfmac_f32_16x16x64_bf16 v[96:99], v[68:71], a[40:47], v22
  v_smfmac_f32_16x16x64_bf16 v[96:99], v[72:75], a[48:55], v22
  v_smfmac_f32_16x16x64_bf16 v[96:99], v[76:79], a[56:63], v22
  v_smfmac_f32_16x16x64_bf16 v[96:99], v[80:83], a[64:71], v22
  v_smfmac_f32_16x16x64_bf16 v[96:99], v[84:87], a[72:79], v22
  v_smfmac_f32_16x16x64_bf16 v[100:103], v[60:63], a[104:111], v22
  v_smfmac_f32_16x16x64_bf16 v[100:103], v[64:67], a[112:119], v22
  v_smfmac_f32_16x16x64_bf16 v[100:103], v[68:71], a[120:127], v22
  v_smfmac_f32_16x16x64_bf16 v[100:103], v[72:75], a[128:135], v22
  v_cvt_pk_bf16_f32 v136, v96, v97
  v_smfmac_f32_16x16x64_bf16 v[100:103], v[76:79], a[136:143], v22
  v_cvt_pk_bf16_f32 v137, v98, v99
  v_smfmac_f32_16x16x64_bf16 v[100:103], v[80:83], a[144:151], v22
  v_smfmac_f32_16x16x64_bf16 v[100:103], v[84:87], a[152:159], v22
  s_sleep 3
  s_nop 3
  buffer_load_dwordx4 v[124:127], v9, s[8:11], s56 offen sc1
  buffer_load_dwordx4 v[128:131], v9, s[8:11], s56 offen offset:1024 sc1
  s_nop 5
  buffer_load_dwordx4 v[132:135], v10, s[8:11], s56 offen sc1
  s_waitcnt vmcnt(2)
  v_pk_add_f16 v172, v124, v126
  v_pk_add_f16 v173, v125, v127
  s_waitcnt vmcnt(1)
  v_pk_add_f16 v174, v128, v130
  v_pk_add_f16 v175, v129, v131
  v_fma_mix_f32 v166, v172, 1.0, v174 op_sel:[0,0,0] op_sel_hi:[1,0,1]
  v_fma_mix_f32 v168, v173, 1.0, v175 op_sel:[0,0,0] op_sel_hi:[1,0,1]
  s_waitcnt vmcnt(0)
  v_pk_add_f16 v176, v132, v133
  v_pk_add_f16 v177, v134, v135
  v_fma_mix_f32 v170, v176, 1.0, v177 op_sel:[0,0,0] op_sel_hi:[1,0,1]
  v_fma_mix_f32 v167, v172, 1.0, v174 op_sel:[1,0,1] op_sel_hi:[1,0,1]
  v_cmp_u_f32 vcc, v166, v170
  v_fma_mix_f32 v169, v173, 1.0, v175 op_sel:[1,0,1] op_sel_hi:[1,0,1]
  v_fma_mix_f32 v171, v176, 1.0, v177 op_sel:[1,0,1] op_sel_hi:[1,0,1]
  v_cvt_pk_bf16_f32 v138, v100, v101
  s_cbranch_vccnz sr_103
sj_104:
ex_105:
  v_exp_f32 v172, v166
  v_exp_f32 v173, v167
  v_exp_f32 v174, v168
  v_cvt_pk_bf16_f32 v156, v172, v173
  v_exp_f32 v175, v169
  v_exp_f32 v176, v170
  v_cvt_pk_bf16_f32 v157, v174, v175
  v_mov_b32_dpp v158, v156 row_ror:8 row_mask:0xf bank_mask:0xf
  v_exp_f32 v177, v171
  v_mov_b32_dpp v159, v157 row_ror:8 row_mask:0xf bank_mask:0xf
  v_cvt_pk_bf16_f32 v160, v176, v177
  v_cvt_pk_bf16_f32 v139, v102, v103
  v_mfma_f32_16x16x32_bf16 v[178:181], v[152:155], v[156:159], 0
  s_waitcnt lgkmcnt(0)
  v_mov_b32_dpp v161, v160 row_ror:8 row_mask:0xf bank_mask:0xf
  v_mfma_f32_16x16x32_bf16 v[182:185], v[144:147], v[156:159], 0
  s_nop 0
  v_mfma_f32_16x16x32_bf16 v[178:181], v[140:143], v[160:163], v[178:181]
  v_mfma_f32_16x16x32_bf16 v[182:185], v[136:139], v[160:163], v[182:185]
  v_mfma_f32_16x16x32_bf16 v[186:189], v[148:151], v[156:159], 0
  v_mfma_f32_16x16x32_bf16 v[186:189], v[138:141], v[160:163], v[186:189]
  s_mov_b64 exec, s[62:63]
  v_rcp_f32 v164, v180
  s_nop 0
  v_pk_mul_f32 v[178:179], v[178:179], v[164:165] op_sel_hi:[1,0]
  v_pk_mul_f32 v[182:183], v[182:183], v[164:165] op_sel_hi:[1,0]
  v_pk_mul_f32 v[184:185], v[184:185], v[164:165] op_sel_hi:[1,0]
  v_cvt_pk_f16_f32 v64, v178, v179
  v_cvt_pk_f16_f32 v60, v182, v183
  v_pk_mul_f32 v[186:187], v[186:187], v[164:165] op_sel_hi:[1,0]
  v_pk_mul_f32 v[188:189], v[188:189], v[164:165] op_sel_hi:[1,0]
  v_cvt_pk_f16_f32 v61, v184, v185
  v_cvt_pk_f16_f32 v62, v186, v187
  v_cvt_pk_f16_f32 v63, v188, v189
  ds_write_b128 v13, v[60:63]
  ds_write_b32 v14, v64
  v_add_f32 v165, v164, v180
  v_cmp_ngt_f32 vcc, s80, v165
  s_mov_b64 exec, -1
  s_nop 0
  s_cbranch_vccnz fx_106
fk_107:
  s_waitcnt lgkmcnt(0)
  s_barrier
  ds_read_b128 v[166:169], v4 offset:13824
  ds_read_b128 v[170:173], v4 offset:14464
  ds_read_b128 v[174:177], v4 offset:15104
  ds_read_b128 v[178:181], v4 offset:15744
  s_mov_b64 exec, s[66:67]
  s_waitcnt lgkmcnt(2)
  v_pk_add_f16 v166, v166, v170
  v_pk_add_f16 v167, v167, v171
  v_pk_add_f16 v168, v168, v172
  v_pk_add_f16 v169, v169, v173
  s_waitcnt lgkmcnt(1)
  v_pk_add_f16 v166, v166, v174
  v_pk_add_f16 v167, v167, v175
  v_pk_add_f16 v168, v168, v176
  v_pk_add_f16 v169, v169, v177
  s_waitcnt lgkmcnt(0)
  v_pk_add_f16 v166, v166, v178
  v_pk_add_f16 v167, v167, v179
  v_pk_add_f16 v168, v168, v180
  v_pk_add_f16 v169, v169, v181
  v_and_or_b32 v166, v166, -2, s61
  buffer_store_dwordx4 v[166:169], v15, s[4:7], s60 offen sc1
  s_mov_b64 exec, -1
  v_permlane32_swap_b32 v96, v100
  v_permlane32_swap_b32 v97, v101
  v_permlane32_swap_b32 v98, v102
  v_permlane32_swap_b32 v99, v103
  v_pk_add_f32 v[96:97], v[96:97], v[100:101]
  v_pk_add_f32 v[98:99], v[98:99], v[102:103]
  v_cvt_pk_bf16_f32 v182, v96, v97
  v_cvt_pk_bf16_f32 v183, v98, v99
  v_min_u32 v182, -2, v182
  ds_write_b64 v26, v[182:183]
  v_permlane32_swap_b32 v88, v92
  v_permlane32_swap_b32 v89, v93
  v_permlane32_swap_b32 v90, v94
  v_permlane32_swap_b32 v91, v95
  v_pk_add_f32 v[88:89], v[88:89], v[92:93]
  v_pk_add_f32 v[90:91], v[90:91], v[94:95]
  v_cvt_pk_bf16_f32 v184, v88, v89
  v_cvt_pk_bf16_f32 v185, v90, v91
  v_min_u32 v184, -2, v184
  ds_write_b64 v43, v[184:185]
  ds_read_b128 v[144:147], v18
  ds_read_b128 v[148:151], v18 offset:1024
  ds_read_b128 v[152:155], v19
  v_xor_b32 v18, 16384, v18
  v_xor_b32 v19, 16384, v19
  v_mov_b32 v88, 0
  v_mov_b32 v89, 0
  v_mov_b32 v90, 0
  v_mov_b32 v91, 0
  v_mov_b32 v92, 0
  v_mov_b32 v93, 0
  v_mov_b32 v94, 0
  v_mov_b32 v95, 0
  v_mov_b32 v96, 0
  v_mov_b32 v97, 0
  v_mov_b32 v98, 0
  v_mov_b32 v99, 0
  v_mov_b32 v100, 0
  v_mov_b32 v101, 0
  v_mov_b32 v102, 0
  v_mov_b32 v103, 0
  s_mov_b32 s81, 0
  s_waitcnt lgkmcnt(0)
  s_barrier
  s_add_u32 s72, s72, 1310720
  s_add_u32 s79, s79, 1310720
  s_add_u32 s73, s73, 393216
  s_xor_b32 s74, s74, 16384
  v_mov_b32 v28, s61
  v_mov_b32 v166, s52
  s_mov_b64 exec, 1
  buffer_store_dword v166, v23, s[12:15], s77 offen sc1
  s_mov_b64 exec, -1
  ds_read_b128 v[170:173], v4 offset:16384
  ds_read_b128 v[174:177], v4 offset:17408
  ds_read_b128 v[178:181], v4 offset:18432
  v_min_u32 v104, -2, v104
  v_min_u32 v106, -2, v106
  v_min_u32 v108, -2, v108
  s_mov_b64 exec, s[68:69]
  buffer_store_dwordx4 v[104:107], v36, s[24:27], s70 offen sc1
  buffer_store_dwordx2 v[108:109], v37, s[24:27], s70 offen sc1
  s_mov_b64 exec, -1
  s_waitcnt lgkmcnt(0)
  buffer_store_dwordx4 v[170:173], v38, s[36:39], s71 offen sc1
  buffer_store_dwordx4 v[174:177], v39, s[36:39], s71 offen sc1
  s_mov_b64 exec, 0xffffffff
  buffer_store_dwordx4 v[178:181], v40, s[36:39], s71 offen sc1
  s_mov_b64 exec, -1
  s_add_u32 s70, s70, 98304
  s_add_u32 s71, s71, 327680
  buffer_load_dword v42, v41, s[12:15], s76 offen sc1
nt_108:
  s_barrier
  s_mov_b32 s58, s55
  s_add_u32 s52, s52, 1
  s_and_b32 s21, s52, 3
  s_mul_i32 s56, s21, 122880
  s_add_u32 s21, s52, 1
  s_and_b32 s21, s21, 3
  s_mul_i32 s55, s21, 122880
  s_add_u32 s55, s55, s75
  s_add_u32 s21, s52, 2
  s_and_b32 s21, s21, 3
  s_mul_i32 s57, s21, 122880
  s_add_u32 s21, s52, 3
  s_and_b32 s21, s21, 3
  s_mul_i32 s59, s21, 122880
  s_add_u32 s59, s59, s75
  s_bfe_u32 s61, s52, 0x10001
  s_and_b32 s21, s52, 1
  s_lshl_b32 s60, s21, 19
  s_mov_b32 s54, 0
  s_sleep 3
  s_nop 2
  buffer_load_dwordx4 v[84:87], v190, s[8:11], s58 offen offset:0 sc1
  s_branch top_95
mr_96:
  s_mov_b64 exec, s[22:23]
  s_cbranch_execz ms_109
  buffer_load_dwordx4 v[84:87], v190, s[8:11], s58 offen offset:0 sc1
ms_109:
  s_add_u32 s54, s54, 1
  s_cmp_gt_u32 s54, 131072
  s_cbranch_scc1 end0
  s_waitcnt vmcnt(0)
  s_mov_b64 exec, s[22:23]
  ds_write_b128 v190, v[84:87] offset:0
  v_cmp_eq_u32 s[22:23], -1, v84
  s_mov_b64 exec, -1
  s_or_b64 vcc, s[22:23], s[22:23]
  s_cbranch_scc1 mr_96
  s_branch mo_100
mn_97:
  v_max3_u32 v27, v48, v49, v50
  v_max3_u32 v27, v27, v51, v52
  v_max3_u32 v27, v27, v53, v54
  v_max3_u32 v27, v27, v55, v56
  v_max3_u32 v27, v27, v57, v58
  v_max3_u32 v27, v27, v59, v60
  v_max3_u32 v27, v27, v61, v62
  v_max3_u32 v27, v27, v63, v64
  v_max3_u32 v27, v27, v65, v66
  v_max3_u32 v27, v27, v67, v68
  v_max3_u32 v27, v27, v69, v70
  v_max3_u32 v27, v27, v71, v72
  v_max3_u32 v27, v27, v73, v74
  v_max3_u32 v27, v27, v75, v76
  v_max3_u32 v27, v27, v77, v78
  v_max3_u32 v27, v27, v79, v80
  v_max3_u32 v27, v27, v81, v82
  v_max3_u32 v27, v27, v83, v84
  v_max3_u32 v27, v27, v85, v86
  v_max3_u32 v27, v27, v87, v87
  v_cmp_eq_u32 vcc, -1, v27
  s_cmp_eq_u32 s52, 0
  s_cbranch_scc1 mk_98
  s_cbranch_vccz mk_98
  s_waitcnt lgkmcnt(0)
  s_barrier
  s_nop 7
  v_mov_b32 v88, 0
  v_mov_b32 v89, 0
  v_mov_b32 v90, 0
  v_mov_b32 v91, 0
  v_mov_b32 v92, 0
  v_mov_b32 v93, 0
  v_mov_b32 v94, 0
  v_mov_b32 v95, 0
  v_mov_b32 v96, 0
  v_mov_b32 v97, 0
  v_mov_b32 v98, 0
  v_mov_b32 v99, 0
  v_mov_b32 v100, 0
  v_mov_b32 v101, 0
  v_mov_b32 v102, 0
  v_mov_b32 v103, 0
  s_mov_b64 s[22:23], -1
  s_branch mr_96
kw_101:
  s_mov_b32 s101, 0
wm_110:
  buffer_load_dword v42, v41, s[12:15], s76 offen sc1
  s_add_u32 s101, s101, 1
  s_cmp_gt_u32 s101, 131072
  s_cbranch_scc1 end0
  s_waitcnt vmcnt(0)
  v_cmp_gt_u32 vcc, s22, v42
  v_readfirstlane_b32 s100, v42
  s_nop 0
  s_cbranch_vccz wm_111
  s_sleep 1
  s_branch wm_110
wm_111:
  s_branch kv_102
sr_103:
  s_mov_b32 s54, 0
sr_112:
  s_mov_b64 exec, vcc
  buffer_load_dwordx4 v[124:127], v9, s[8:11], s56 offen sc1
  buffer_load_dwordx4 v[128:131], v9, s[8:11], s56 offen offset:1024 sc1
  buffer_load_dwordx4 v[132:135], v10, s[8:11], s56 offen sc1
  s_mov_b64 exec, -1
  s_add_u32 s54, s54, 1
  s_cmp_gt_u32 s54, 131072
  s_cbranch_scc1 end0
  s_and_b32 s21, s54, 31
  s_cbranch_scc0 sr_113
  s_waitcnt vmcnt(0)
  v_pk_add_f16 v172, v124, v126
  v_pk_add_f16 v173, v125, v127
  v_pk_add_f16 v174, v128, v130
  v_pk_add_f16 v175, v129, v131
  v_fma_mix_f32 v166, v172, 1.0, v174 op_sel:[0,0,0] op_sel_hi:[1,0,1]
  v_fma_mix_f32 v168, v173, 1.0, v175 op_sel:[0,0,0] op_sel_hi:[1,0,1]
  v_pk_add_f16 v176, v132, v133
  v_pk_add_f16 v177, v134, v135
  v_add_f32 v27, v166, v168
  v_fma_mix_f32 v170, v176, 1.0, v177 op_sel:[0,0,0] op_sel_hi:[1,0,1]
  v_fma_mix_f32 v167, v172, 1.0, v174 op_sel:[1,0,1] op_sel_hi:[1,0,1]
  v_cmp_u_f32 vcc, v27, v170
  v_fma_mix_f32 v169, v173, 1.0, v175 op_sel:[1,0,1] op_sel_hi:[1,0,1]
  v_fma_mix_f32 v171, v176, 1.0, v177 op_sel:[1,0,1] op_sel_hi:[1,0,1]
  s_cbranch_vccnz sr_112
  s_branch sj_104
sr_113:
  s_waitcnt vmcnt(0)
  v_pk_add_f16 v172, v124, v126
  v_pk_add_f16 v173, v125, v127
  v_pk_add_f16 v174, v128, v130
  v_pk_add_f16 v175, v129, v131
  v_fma_mix_f32 v166, v172, 1.0, v174 op_sel:[0,0,0] op_sel_hi:[1,0,1]
  v_fma_mix_f32 v168, v173, 1.0, v175 op_sel:[0,0,0] op_sel_hi:[1,0,1]
  v_pk_add_f16 v176, v132, v133
  v_pk_add_f16 v177, v134, v135
  v_add_f32 v27, v166, v168
  v_fma_mix_f32 v170, v176, 1.0, v177 op_sel:[0,0,0] op_sel_hi:[1,0,1]
  v_fma_mix_f32 v167, v172, 1.0, v174 op_sel:[1,0,1] op_sel_hi:[1,0,1]
  v_cmp_u_f32 vcc, v27, v170
  v_fma_mix_f32 v169, v173, 1.0, v175 op_sel:[1,0,1] op_sel_hi:[1,0,1]
  v_fma_mix_f32 v171, v176, 1.0, v177 op_sel:[1,0,1] op_sel_hi:[1,0,1]
  v_max3_u32 v27, v124, v126, v128
  v_max3_u32 v27, v27, v130, v132
  v_max3_u32 v27, v27, v133, v134
  v_max3_u32 v27, v27, v135, v135
  v_cmp_eq_u32 vcc, -1, v27
  s_nop 1
  s_cbranch_vccnz sr_112
  s_branch sj_104
fx_106:
  s_cmp_eq_u32 s81, 1
  s_cbranch_scc1 fk_107
  s_mov_b32 s81, 1
  v_max3_f32 v164, v166, v167, v168
  v_max3_f32 v165, v169, v170, v171
  v_max_f32 v164, v164, v165
  s_nop 1
  v_max_f32_dpp v164, v164, v164 row_ror:8 row_mask:0xf bank_mask:0xf
  v_mov_b32 v165, v164
  s_nop 1
  v_permlane32_swap_b32 v164, v165
  v_max_f32 v164, v164, v165
  v_mov_b32 v165, v164
  s_nop 1
  v_permlane16_swap_b32 v164, v165
  v_max_f32 v164, v164, v165
  v_sub_f32 v166, v166, v164
  v_sub_f32 v167, v167, v164
  v_sub_f32 v168, v168, v164
  v_sub_f32 v169, v169, v164
  v_sub_f32 v170, v170, v164
  v_sub_f32 v171, v171, v164
  s_branch ex_105
last_99:
  v_smfmac_f32_16x16x64_bf16 v[100:103], v[56:59], a[96:103], v22
  v_smfmac_f32_16x16x64_bf16 v[96:99], v[60:63], a[24:31], v22
  v_smfmac_f32_16x16x64_bf16 v[96:99], v[64:67], a[32:39], v22
  v_smfmac_f32_16x16x64_bf16 v[96:99], v[68:71], a[40:47], v22
  v_smfmac_f32_16x16x64_bf16 v[96:99], v[72:75], a[48:55], v22
  v_smfmac_f32_16x16x64_bf16 v[96:99], v[76:79], a[56:63], v22
  v_smfmac_f32_16x16x64_bf16 v[96:99], v[80:83], a[64:71], v22
  v_smfmac_f32_16x16x64_bf16 v[96:99], v[84:87], a[72:79], v22
  v_smfmac_f32_16x16x64_bf16 v[100:103], v[60:63], a[104:111], v22
  v_smfmac_f32_16x16x64_bf16 v[100:103], v[64:67], a[112:119], v22
  v_smfmac_f32_16x16x64_bf16 v[100:103], v[68:71], a[120:127], v22
  v_smfmac_f32_16x16x64_bf16 v[100:103], v[72:75], a[128:135], v22
  v_smfmac_f32_16x16x64_bf16 v[100:103], v[76:79], a[136:143], v22
  v_smfmac_f32_16x16x64_bf16 v[100:103], v[80:83], a[144:151], v22
  v_smfmac_f32_16x16x64_bf16 v[100:103], v[84:87], a[152:159], v22
  s_nop 7
  v_permlane32_swap_b32 v96, v100
  v_permlane32_swap_b32 v97, v101
  v_permlane32_swap_b32 v98, v102
  v_permlane32_swap_b32 v99, v103
  v_pk_add_f32 v[96:97], v[96:97], v[100:101]
  v_pk_add_f32 v[98:99], v[98:99], v[102:103]
  v_cvt_pk_bf16_f32 v182, v96, v97
  v_cvt_pk_bf16_f32 v183, v98, v99
  v_min_u32 v182, -2, v182
  ds_write_b64 v26, v[182:183]
  v_permlane32_swap_b32 v88, v92
  v_permlane32_swap_b32 v89, v93
  v_permlane32_swap_b32 v90, v94
  v_permlane32_swap_b32 v91, v95
  v_pk_add_f32 v[88:89], v[88:89], v[92:93]
  v_pk_add_f32 v[90:91], v[90:91], v[94:95]
  v_cvt_pk_bf16_f32 v184, v88, v89
  v_cvt_pk_bf16_f32 v185, v90, v91
  v_min_u32 v184, -2, v184
  ds_write_b64 v43, v[184:185]
  s_waitcnt lgkmcnt(0)
  s_barrier
  ds_read_b128 v[170:173], v4 offset:16384
  ds_read_b128 v[174:177], v4 offset:17408
  ds_read_b128 v[178:181], v4 offset:18432
  v_min_u32 v104, -2, v104
  v_min_u32 v106, -2, v106
  v_min_u32 v108, -2, v108
  s_mov_b64 exec, s[68:69]
  buffer_store_dwordx4 v[104:107], v36, s[24:27], s70 offen sc1
  buffer_store_dwordx2 v[108:109], v37, s[24:27], s70 offen sc1
  s_mov_b64 exec, -1
  s_waitcnt lgkmcnt(0)
  buffer_store_dwordx4 v[170:173], v38, s[36:39], s71 offen sc1
  buffer_store_dwordx4 v[174:177], v39, s[36:39], s71 offen sc1
  s_mov_b64 exec, 0xffffffff
  buffer_store_dwordx4 v[178:181], v40, s[36:39], s71 offen sc1
  s_mov_b64 exec, -1
  s_add_u32 s70, s70, 98304
  s_add_u32 s71, s71, 327680
  s_waitcnt vmcnt(0)
  v_mov_b32 v166, 64
  s_mov_b64 exec, 1
  buffer_store_dword v166, v23, s[12:15], s77 offen sc1
  s_mov_b64 exec, -1
  s_branch chain_done
E_27:
  v_add_u32 v190, 0, v4
  ds_read_b128 v[48:51], v4 offset:0
  ds_read_b128 v[52:55], v4 offset:1024
  ds_read_b128 v[56:59], v4 offset:2048
  s_waitcnt lgkmcnt(0)
  s_branch mo_119
  .p2align 3
top_114:
  s_waitcnt vmcnt(2)
  ds_write_b128 v190, v[48:51] offset:0
  v_cmp_eq_u32 s[22:23], -1, v48
  s_waitcnt vmcnt(1)
  ds_write_b128 v190, v[52:55] offset:1024
  v_cmp_eq_u32 s[98:99], -1, v52
  s_waitcnt vmcnt(0)
  ds_write_b128 v190, v[56:59] offset:2048
  v_cmp_eq_u32 s[100:101], -1, v56
  s_or_b64 vcc, s[22:23], s[98:99]
  s_or_b64 vcc, vcc, s[100:101]
  s_cbranch_scc1 mr_115
mo_119:
  s_waitcnt lgkmcnt(0)
  s_barrier
  ds_read_b128 v[60:63], v4 offset:3072
  ds_read_b128 v[64:67], v4 offset:4096
  v_smfmac_f32_16x16x64_bf16 v[92:95], v[48:51], a[240:247], v22
  ds_read_b128 v[68:71], v4 offset:5120
  v_smfmac_f32_16x16x64_bf16 v[88:91], v[48:51], a[160:167], v22
  ds_read_b128 v[72:75], v4 offset:6144
  v_smfmac_f32_16x16x64_bf16 v[92:95], v[52:55], a[248:255], v22
  ds_read_b128 v[76:79], v4 offset:7168
  v_smfmac_f32_16x16x64_bf16 v[88:91], v[52:55], a[168:175], v22
  ds_read_b128 v[80:83], v4 offset:8192
  v_smfmac_f32_16x16x64_bf16 v[92:95], v[56:59], v[192:199], v22
  ds_read_b128 v[84:87], v4 offset:9216
  v_smfmac_f32_16x16x64_bf16 v[88:91], v[56:59], a[176:183], v22
  s_waitcnt lgkmcnt(6)
  v_smfmac_f32_16x16x64_bf16 v[92:95], v[60:63], v[200:207], v22
  v_smfmac_f32_16x16x64_bf16 v[88:91], v[60:63], a[184:191], v22
  s_waitcnt lgkmcnt(5)
  v_smfmac_f32_16x16x64_bf16 v[92:95], v[64:67], v[208:215], v22
  s_waitcnt lgkmcnt(4)
  v_smfmac_f32_16x16x64_bf16 v[92:95], v[68:71], v[216:223], v22
  s_waitcnt lgkmcnt(3)
  v_smfmac_f32_16x16x64_bf16 v[92:95], v[72:75], v[224:231], v22
  s_waitcnt lgkmcnt(2)
  v_smfmac_f32_16x16x64_bf16 v[92:95], v[76:79], v[232:239], v22
  s_waitcnt lgkmcnt(1)
  v_smfmac_f32_16x16x64_bf16 v[92:95], v[80:83], v[240:247], v22
  s_waitcnt lgkmcnt(0)
  v_smfmac_f32_16x16x64_bf16 v[92:95], v[84:87], v[248:255], v22
  v_smfmac_f32_16x16x64_bf16 v[88:91], v[64:67], a[192:199], v22
  v_smfmac_f32_16x16x64_bf16 v[88:91], v[68:71], a[200:207], v22
  v_smfmac_f32_16x16x64_bf16 v[88:91], v[72:75], a[208:215], v22
  v_permlane32_swap_b32 v92, v93
  v_smfmac_f32_16x16x64_bf16 v[88:91], v[76:79], a[216:223], v22
  v_permlane32_swap_b32 v94, v95
  v_smfmac_f32_16x16x64_bf16 v[88:91], v[80:83], a[224:231], v22
  v_permlane32_swap_b32 v93, v92
  v_smfmac_f32_16x16x64_bf16 v[88:91], v[84:87], a[232:239], v22
  v_permlane32_swap_b32 v95, v94
  v_pk_mul_f32 v[120:121], v[92:93], v[24:25] op_sel:[1,0] op_sel_hi:[0,1]
  v_pk_mul_f32 v[122:123], v[94:95], v[24:25] op_sel:[1,0] op_sel_hi:[0,1]
  s_nop 4
  v_pk_fma_f32 v[88:89], v[88:89], v[24:25], v[120:121]
  v_pk_fma_f32 v[90:91], v[90:91], v[24:25], v[122:123]
  v_cvt_pk_bf16_f32 v120, v88, v89
  v_cvt_pk_bf16_f32 v121, v90, v91
  ds_write_b64 v6, v[120:121]
  v_cmp_u_f32 vcc, v88, v89
  v_cmp_u_f32 s[22:23], v90, v91
  s_nop 1
  s_or_b64 vcc, vcc, s[22:23]
  s_cbranch_vccnz mn_116
mk_117:
  s_waitcnt lgkmcnt(0)
  s_barrier
  ds_read_b64_tr_b16 v[104:105], v7 offset:0
  ds_read_b64_tr_b16 v[106:107], v7 offset:768
  ds_read_b64_tr_b16 v[108:109], v7 offset:1536
  ds_read_b64 v[140:141], v11
  s_cmp_eq_u32 s52, 63
  s_cbranch_scc1 last_118
  s_waitcnt lgkmcnt(2)
  v_mfma_f32_16x16x32_bf16 v[120:123], v[112:115], v[104:107], 0
  s_waitcnt lgkmcnt(1)
  v_mfma_f32_16x16x32_bf16 v[120:123], v[116:119], v[108:111], v[120:123]
  s_mov_b64 exec, s[64:65]
  s_nop 6
  v_cvt_pk_f16_f32 v120, v120, v121
  v_cvt_pk_f16_f32 v121, v122, v123
  buffer_store_dwordx2 v[120:121], v8, s[8:11], s56 offen sc1
  s_mov_b64 exec, -1
  s_sleep 3
  s_nop 1
  v_smfmac_f32_16x16x64_bf16 v[96:99], v[48:51], a[0:7], v22
  v_smfmac_f32_16x16x64_bf16 v[100:103], v[48:51], a[80:87], v22
  v_smfmac_f32_16x16x64_bf16 v[96:99], v[52:55], a[8:15], v22
  v_smfmac_f32_16x16x64_bf16 v[100:103], v[52:55], a[88:95], v22
  v_smfmac_f32_16x16x64_bf16 v[96:99], v[56:59], a[16:23], v22
  v_smfmac_f32_16x16x64_bf16 v[100:103], v[56:59], a[96:103], v22
  v_smfmac_f32_16x16x64_bf16 v[96:99], v[60:63], a[24:31], v22
  v_smfmac_f32_16x16x64_bf16 v[96:99], v[64:67], a[32:39], v22
  v_smfmac_f32_16x16x64_bf16 v[96:99], v[68:71], a[40:47], v22
  v_smfmac_f32_16x16x64_bf16 v[96:99], v[72:75], a[48:55], v22
  v_smfmac_f32_16x16x64_bf16 v[96:99], v[76:79], a[56:63], v22
  buffer_load_dwordx4 v[124:127], v9, s[8:11], s56 offen sc1
  v_smfmac_f32_16x16x64_bf16 v[96:99], v[80:83], a[64:71], v22
  buffer_load_dwordx4 v[128:131], v9, s[8:11], s56 offen offset:1024 sc1
  v_smfmac_f32_16x16x64_bf16 v[96:99], v[84:87], a[72:79], v22
  buffer_load_dwordx4 v[132:135], v10, s[8:11], s56 offen sc1
  v_smfmac_f32_16x16x64_bf16 v[100:103], v[60:63], a[104:111], v22
  v_smfmac_f32_16x16x64_bf16 v[100:103], v[64:67], a[112:119], v22
  v_smfmac_f32_16x16x64_bf16 v[100:103], v[68:71], a[120:127], v22
  v_smfmac_f32_16x16x64_bf16 v[100:103], v[72:75], a[128:135], v22
  v_cvt_pk_bf16_f32 v136, v96, v97
  v_smfmac_f32_16x16x64_bf16 v[100:103], v[76:79], a[136:143], v22
  v_cvt_pk_bf16_f32 v137, v98, v99
  v_smfmac_f32_16x16x64_bf16 v[100:103], v[80:83], a[144:151], v22
  v_smfmac_f32_16x16x64_bf16 v[100:103], v[84:87], a[152:159], v22
  s_waitcnt vmcnt(2)
  v_pk_add_f16 v172, v124, v126
  v_pk_add_f16 v173, v125, v127
  s_waitcnt vmcnt(1)
  v_pk_add_f16 v174, v128, v130
  v_pk_add_f16 v175, v129, v131
  v_fma_mix_f32 v166, v172, 1.0, v174 op_sel:[0,0,0] op_sel_hi:[1,0,1]
  v_fma_mix_f32 v168, v173, 1.0, v175 op_sel:[0,0,0] op_sel_hi:[1,0,1]
  s_waitcnt vmcnt(0)
  v_pk_add_f16 v176, v132, v133
  v_pk_add_f16 v177, v134, v135
  v_fma_mix_f32 v170, v176, 1.0, v177 op_sel:[0,0,0] op_sel_hi:[1,0,1]
  v_fma_mix_f32 v167, v172, 1.0, v174 op_sel:[1,0,1] op_sel_hi:[1,0,1]
  v_cmp_u_f32 vcc, v166, v170
  v_fma_mix_f32 v169, v173, 1.0, v175 op_sel:[1,0,1] op_sel_hi:[1,0,1]
  v_fma_mix_f32 v171, v176, 1.0, v177 op_sel:[1,0,1] op_sel_hi:[1,0,1]
  v_cvt_pk_bf16_f32 v138, v100, v101
  s_cbranch_vccnz sr_120
sj_121:
ex_122:
  v_exp_f32 v172, v166
  v_exp_f32 v173, v167
  v_exp_f32 v174, v168
  v_cvt_pk_bf16_f32 v156, v172, v173
  v_exp_f32 v175, v169
  v_exp_f32 v176, v170
  v_cvt_pk_bf16_f32 v157, v174, v175
  v_mov_b32_dpp v158, v156 row_ror:8 row_mask:0xf bank_mask:0xf
  v_exp_f32 v177, v171
  v_mov_b32_dpp v159, v157 row_ror:8 row_mask:0xf bank_mask:0xf
  v_cvt_pk_bf16_f32 v160, v176, v177
  v_cvt_pk_bf16_f32 v139, v102, v103
  v_mfma_f32_16x16x32_bf16 v[178:181], v[152:155], v[156:159], 0
  s_waitcnt lgkmcnt(0)
  v_mov_b32_dpp v161, v160 row_ror:8 row_mask:0xf bank_mask:0xf
  v_mfma_f32_16x16x32_bf16 v[182:185], v[144:147], v[156:159], 0
  s_nop 0
  v_mfma_f32_16x16x32_bf16 v[178:181], v[140:143], v[160:163], v[178:181]
  v_mfma_f32_16x16x32_bf16 v[182:185], v[136:139], v[160:163], v[182:185]
  v_mfma_f32_16x16x32_bf16 v[186:189], v[148:151], v[156:159], 0
  v_mfma_f32_16x16x32_bf16 v[186:189], v[138:141], v[160:163], v[186:189]
  s_mov_b64 exec, s[62:63]
  v_rcp_f32 v164, v180
  s_nop 0
  v_pk_mul_f32 v[178:179], v[178:179], v[164:165] op_sel_hi:[1,0]
  v_pk_mul_f32 v[182:183], v[182:183], v[164:165] op_sel_hi:[1,0]
  v_pk_mul_f32 v[184:185], v[184:185], v[164:165] op_sel_hi:[1,0]
  v_cvt_pk_f16_f32 v64, v178, v179
  v_cvt_pk_f16_f32 v60, v182, v183
  v_pk_mul_f32 v[186:187], v[186:187], v[164:165] op_sel_hi:[1,0]
  v_pk_mul_f32 v[188:189], v[188:189], v[164:165] op_sel_hi:[1,0]
  v_cvt_pk_f16_f32 v61, v184, v185
  v_cvt_pk_f16_f32 v62, v186, v187
  v_cvt_pk_f16_f32 v63, v188, v189
  ds_write_b128 v13, v[60:63]
  ds_write_b32 v14, v64
  v_add_f32 v165, v164, v180
  v_cmp_ngt_f32 vcc, s80, v165
  s_mov_b64 exec, -1
  s_nop 0
  s_cbranch_vccnz fx_123
fk_124:
  s_waitcnt lgkmcnt(0)
  s_barrier
  s_add_u32 m0, s74, 8192
  s_add_u32 s21, s72, 2048
  buffer_load_dwordx4 v32, s[28:31], s21 offen sc1 lds
  s_add_u32 m0, s74, 1024
  s_add_u32 s21, s79, 1024
  buffer_load_dwordx4 v4, s[28:31], s21 offen sc1 lds
  s_add_u32 m0, s74, 4096
  s_add_u32 s21, s79, 81920
  buffer_load_dwordx4 v4, s[28:31], s21 offen sc1 lds
  s_add_u32 m0, s74, 7168
  s_add_u32 s21, s79, 123904
  buffer_load_dwordx4 v4, s[28:31], s21 offen sc1 lds
  s_add_u32 s72, s72, 1310720
  s_add_u32 s79, s79, 1310720
  s_add_u32 s73, s73, 393216
  s_xor_b32 s74, s74, 16384
  s_nop 15
  s_nop 3
  v_permlane32_swap_b32 v96, v100
  v_permlane32_swap_b32 v97, v101
  v_permlane32_swap_b32 v98, v102
  v_permlane32_swap_b32 v99, v103
  v_pk_add_f32 v[96:97], v[96:97], v[100:101]
  v_pk_add_f32 v[98:99], v[98:99], v[102:103]
  v_cvt_pk_bf16_f32 v182, v96, v97
  v_cvt_pk_bf16_f32 v183, v98, v99
  v_min_u32 v182, -2, v182
  ds_write_b64 v26, v[182:183]
  ds_read_b128 v[144:147], v18
  ds_read_b128 v[148:151], v18 offset:1024
  ds_read_b128 v[152:155], v19
  ds_read_b128 v[112:115], v20
  ds_read_b64 v[116:117], v21
  v_xor_b32 v18, 16384, v18
  v_xor_b32 v19, 16384, v19
  v_xor_b32 v20, 16384, v20
  v_xor_b32 v21, 16384, v21
  v_mov_b32 v88, 0
  v_mov_b32 v89, 0
  v_mov_b32 v90, 0
  v_mov_b32 v91, 0
  v_mov_b32 v92, 0
  v_mov_b32 v93, 0
  v_mov_b32 v94, 0
  v_mov_b32 v95, 0
  v_mov_b32 v96, 0
  v_mov_b32 v97, 0
  v_mov_b32 v98, 0
  v_mov_b32 v99, 0
  v_mov_b32 v100, 0
  v_mov_b32 v101, 0
  v_mov_b32 v102, 0
  v_mov_b32 v103, 0
  s_mov_b32 s81, 0
  s_waitcnt lgkmcnt(0)
  s_barrier
  s_mov_b64 exec, s[64:65]
  buffer_store_dwordx2 v[28:29], v8, s[8:11], s57 offen sc1
  s_mov_b64 exec, s[62:63]
  buffer_store_dword v28, v17, s[8:11], s59 offen sc1
  s_mov_b64 exec, -1
  s_sleep 6
  s_nop 3
  buffer_load_dwordx4 v[68:71], v16, s[4:7], s60 offen sc1
  s_sleep 3
  s_nop 1
  buffer_load_dwordx4 v[72:75], v16, s[4:7], s60 offen sc1
  s_mov_b32 s54, 0
pp_126:
  s_waitcnt vmcnt(1)
  v_mfma_f32_16x16x32_f16 v[120:123], v[44:47], v[68:71], 0
  v_bitop3_b32 v27, v68, s61, 1 bitop3:0x28
  v_cmp_ne_u32 vcc, 0, v27
  s_nop 1
  s_cbranch_vccnz p2_128
  s_nop 2
pg_127:
  v_add_f32_dpp v120, v120, v120 row_ror:8 row_mask:0xf bank_mask:0xf
  v_add_f32_dpp v121, v121, v121 row_ror:8 row_mask:0xf bank_mask:0xf
  s_mov_b64 exec, s[62:63]
  v_cvt_pk_bf16_f32 v120, v120, v121
  v_min_u32 v120, -2, v120
  buffer_store_dword v120, v17, s[8:11], s55 offen sc1
  s_mov_b64 exec, -1
nt_125:
  s_barrier
  s_mov_b32 s58, s55
  s_add_u32 s52, s52, 1
  s_and_b32 s21, s52, 3
  s_mul_i32 s56, s21, 122880
  s_add_u32 s21, s52, 1
  s_and_b32 s21, s21, 3
  s_mul_i32 s55, s21, 122880
  s_add_u32 s55, s55, s75
  s_add_u32 s21, s52, 2
  s_and_b32 s21, s21, 3
  s_mul_i32 s57, s21, 122880
  s_add_u32 s21, s52, 3
  s_and_b32 s21, s21, 3
  s_mul_i32 s59, s21, 122880
  s_add_u32 s59, s59, s75
  s_bfe_u32 s61, s52, 0x10001
  s_and_b32 s21, s52, 1
  s_lshl_b32 s60, s21, 19
  s_mov_b32 s54, 0
  s_sleep 3
  s_nop 2
  buffer_load_dwordx4 v[48:51], v190, s[8:11], s58 offen offset:0 sc1
  buffer_load_dwordx4 v[52:55], v190, s[8:11], s58 offen offset:1024 sc1
  buffer_load_dwordx4 v[56:59], v190, s[8:11], s58 offen offset:2048 sc1
  s_branch top_114
mr_115:
  s_mov_b64 exec, s[22:23]
  s_cbranch_execz ms_129
  buffer_load_dwordx4 v[48:51], v190, s[8:11], s58 offen offset:0 sc1
ms_129:
  s_mov_b64 exec, s[98:99]
  s_cbranch_execz ms_130
  buffer_load_dwordx4 v[52:55], v190, s[8:11], s58 offen offset:1024 sc1
ms_130:
  s_mov_b64 exec, s[100:101]
  s_cbranch_execz ms_131
  buffer_load_dwordx4 v[56:59], v190, s[8:11], s58 offen offset:2048 sc1
ms_131:
  s_add_u32 s54, s54, 1
  s_cmp_gt_u32 s54, 131072
  s_cbranch_scc1 end0
  s_waitcnt vmcnt(0)
  s_mov_b64 exec, s[22:23]
  ds_write_b128 v190, v[48:51] offset:0
  v_cmp_eq_u32 s[22:23], -1, v48
  s_mov_b64 exec, s[98:99]
  ds_write_b128 v190, v[52:55] offset:1024
  v_cmp_eq_u32 s[98:99], -1, v52
  s_mov_b64 exec, s[100:101]
  ds_write_b128 v190, v[56:59] offset:2048
  v_cmp_eq_u32 s[100:101], -1, v56
  s_mov_b64 exec, -1
  s_or_b64 vcc, s[22:23], s[98:99]
  s_or_b64 vcc, vcc, s[100:101]
  s_cbranch_scc1 mr_115
  s_branch mo_119
mn_116:
  v_max3_u32 v27, v48, v49, v50
  v_max3_u32 v27, v27, v51, v52
  v_max3_u32 v27, v27, v53, v54
  v_max3_u32 v27, v27, v55, v56
  v_max3_u32 v27, v27, v57, v58
  v_max3_u32 v27, v27, v59, v60
  v_max3_u32 v27, v27, v61, v62
  v_max3_u32 v27, v27, v63, v64
  v_max3_u32 v27, v27, v65, v66
  v_max3_u32 v27, v27, v67, v68
  v_max3_u32 v27, v27, v69, v70
  v_max3_u32 v27, v27, v71, v72
  v_max3_u32 v27, v27, v73, v74
  v_max3_u32 v27, v27, v75, v76
  v_max3_u32 v27, v27, v77, v78
  v_max3_u32 v27, v27, v79, v80
  v_max3_u32 v27, v27, v81, v82
  v_max3_u32 v27, v27, v83, v84
  v_max3_u32 v27, v27, v85, v86
  v_max3_u32 v27, v27, v87, v87
  v_cmp_eq_u32 vcc, -1, v27
  s_cmp_eq_u32 s52, 0
  s_cbranch_scc1 mk_117
  s_cbranch_vccz mk_117
  s_waitcnt lgkmcnt(0)
  s_barrier
  s_nop 7
  v_mov_b32 v88, 0
  v_mov_b32 v89, 0
  v_mov_b32 v90, 0
  v_mov_b32 v91, 0
  v_mov_b32 v92, 0
  v_mov_b32 v93, 0
  v_mov_b32 v94, 0
  v_mov_b32 v95, 0
  v_mov_b32 v96, 0
  v_mov_b32 v97, 0
  v_mov_b32 v98, 0
  v_mov_b32 v99, 0
  v_mov_b32 v100, 0
  v_mov_b32 v101, 0
  v_mov_b32 v102, 0
  v_mov_b32 v103, 0
  s_mov_b64 s[22:23], -1
  s_mov_b64 s[98:99], -1
  s_mov_b64 s[100:101], -1
  s_branch mr_115
sr_120:
  s_mov_b32 s54, 0
sr_132:
  s_mov_b64 exec, vcc
  buffer_load_dwordx4 v[124:127], v9, s[8:11], s56 offen sc1
  buffer_load_dwordx4 v[128:131], v9, s[8:11], s56 offen offset:1024 sc1
  buffer_load_dwordx4 v[132:135], v10, s[8:11], s56 offen sc1
  s_mov_b64 exec, -1
  s_add_u32 s54, s54, 1
  s_cmp_gt_u32 s54, 131072
  s_cbranch_scc1 end0
  s_and_b32 s21, s54, 31
  s_cbranch_scc0 sr_133
  s_waitcnt vmcnt(0)
  v_pk_add_f16 v172, v124, v126
  v_pk_add_f16 v173, v125, v127
  v_pk_add_f16 v174, v128, v130
  v_pk_add_f16 v175, v129, v131
  v_fma_mix_f32 v166, v172, 1.0, v174 op_sel:[0,0,0] op_sel_hi:[1,0,1]
  v_fma_mix_f32 v168, v173, 1.0, v175 op_sel:[0,0,0] op_sel_hi:[1,0,1]
  v_pk_add_f16 v176, v132, v133
  v_pk_add_f16 v177, v134, v135
  v_add_f32 v27, v166, v168
  v_fma_mix_f32 v170, v176, 1.0, v177 op_sel:[0,0,0] op_sel_hi:[1,0,1]
  v_fma_mix_f32 v167, v172, 1.0, v174 op_sel:[1,0,1] op_sel_hi:[1,0,1]
  v_cmp_u_f32 vcc, v27, v170
  v_fma_mix_f32 v169, v173, 1.0, v175 op_sel:[1,0,1] op_sel_hi:[1,0,1]
  v_fma_mix_f32 v171, v176, 1.0, v177 op_sel:[1,0,1] op_sel_hi:[1,0,1]
  s_cbranch_vccnz sr_132
  s_branch sj_121
sr_133:
  s_waitcnt vmcnt(0)
  v_pk_add_f16 v172, v124, v126
  v_pk_add_f16 v173, v125, v127
  v_pk_add_f16 v174, v128, v130
  v_pk_add_f16 v175, v129, v131
  v_fma_mix_f32 v166, v172, 1.0, v174 op_sel:[0,0,0] op_sel_hi:[1,0,1]
  v_fma_mix_f32 v168, v173, 1.0, v175 op_sel:[0,0,0] op_sel_hi:[1,0,1]
  v_pk_add_f16 v176, v132, v133
  v_pk_add_f16 v177, v134, v135
  v_add_f32 v27, v166, v168
  v_fma_mix_f32 v170, v176, 1.0, v177 op_sel:[0,0,0] op_sel_hi:[1,0,1]
  v_fma_mix_f32 v167, v172, 1.0, v174 op_sel:[1,0,1] op_sel_hi:[1,0,1]
  v_cmp_u_f32 vcc, v27, v170
  v_fma_mix_f32 v169, v173, 1.0, v175 op_sel:[1,0,1] op_sel_hi:[1,0,1]
  v_fma_mix_f32 v171, v176, 1.0, v177 op_sel:[1,0,1] op_sel_hi:[1,0,1]
  v_max3_u32 v27, v124, v126, v128
  v_max3_u32 v27, v27, v130, v132
  v_max3_u32 v27, v27, v133, v134
  v_max3_u32 v27, v27, v135, v135
  v_cmp_eq_u32 vcc, -1, v27
  s_nop 1
  s_cbranch_vccnz sr_132
  s_branch sj_121
fx_123:
  s_cmp_eq_u32 s81, 1
  s_cbranch_scc1 fk_124
  s_mov_b32 s81, 1
  v_max3_f32 v164, v166, v167, v168
  v_max3_f32 v165, v169, v170, v171
  v_max_f32 v164, v164, v165
  s_nop 1
  v_max_f32_dpp v164, v164, v164 row_ror:8 row_mask:0xf bank_mask:0xf
  v_mov_b32 v165, v164
  s_nop 1
  v_permlane32_swap_b32 v164, v165
  v_max_f32 v164, v164, v165
  v_mov_b32 v165, v164
  s_nop 1
  v_permlane16_swap_b32 v164, v165
  v_max_f32 v164, v164, v165
  v_sub_f32 v166, v166, v164
  v_sub_f32 v167, v167, v164
  v_sub_f32 v168, v168, v164
  v_sub_f32 v169, v169, v164
  v_sub_f32 v170, v170, v164
  v_sub_f32 v171, v171, v164
  s_branch ex_122
p2_128:
  buffer_load_dwordx4 v[68:71], v16, s[4:7], s60 offen sc1
  s_waitcnt vmcnt(1)
  v_mfma_f32_16x16x32_f16 v[120:123], v[44:47], v[72:75], 0
  v_bitop3_b32 v27, v72, s61, 1 bitop3:0x28
  v_cmp_ne_u32 vcc, 0, v27
  s_nop 1
  s_cbranch_vccz pg_127
  buffer_load_dwordx4 v[72:75], v16, s[4:7], s60 offen sc1
  s_add_u32 s54, s54, 1
  s_cmp_gt_u32 s54, 131072
  s_cbranch_scc1 end0
  s_branch pp_126
last_118:
  v_smfmac_f32_16x16x64_bf16 v[96:99], v[48:51], a[0:7], v22
  v_smfmac_f32_16x16x64_bf16 v[100:103], v[48:51], a[80:87], v22
  v_smfmac_f32_16x16x64_bf16 v[96:99], v[52:55], a[8:15], v22
  v_smfmac_f32_16x16x64_bf16 v[100:103], v[52:55], a[88:95], v22
  v_smfmac_f32_16x16x64_bf16 v[96:99], v[56:59], a[16:23], v22
  v_smfmac_f32_16x16x64_bf16 v[100:103], v[56:59], a[96:103], v22
  v_smfmac_f32_16x16x64_bf16 v[96:99], v[60:63], a[24:31], v22
  v_smfmac_f32_16x16x64_bf16 v[96:99], v[64:67], a[32:39], v22
  v_smfmac_f32_16x16x64_bf16 v[96:99], v[68:71], a[40:47], v22
  v_smfmac_f32_16x16x64_bf16 v[96:99], v[72:75], a[48:55], v22
  v_smfmac_f32_16x16x64_bf16 v[96:99], v[76:79], a[56:63], v22
  v_smfmac_f32_16x16x64_bf16 v[96:99], v[80:83], a[64:71], v22
  v_smfmac_f32_16x16x64_bf16 v[96:99], v[84:87], a[72:79], v22
  v_smfmac_f32_16x16x64_bf16 v[100:103], v[60:63], a[104:111], v22
  v_smfmac_f32_16x16x64_bf16 v[100:103], v[64:67], a[112:119], v22
  v_smfmac_f32_16x16x64_bf16 v[100:103], v[68:71], a[120:127], v22
  v_smfmac_f32_16x16x64_bf16 v[100:103], v[72:75], a[128:135], v22
  v_smfmac_f32_16x16x64_bf16 v[100:103], v[76:79], a[136:143], v22
  v_smfmac_f32_16x16x64_bf16 v[100:103], v[80:83], a[144:151], v22
  v_smfmac_f32_16x16x64_bf16 v[100:103], v[84:87], a[152:159], v22
  s_nop 7
  v_permlane32_swap_b32 v96, v100
  v_permlane32_swap_b32 v97, v101
  v_permlane32_swap_b32 v98, v102
  v_permlane32_swap_b32 v99, v103
  v_pk_add_f32 v[96:97], v[96:97], v[100:101]
  v_pk_add_f32 v[98:99], v[98:99], v[102:103]
  v_cvt_pk_bf16_f32 v182, v96, v97
  v_cvt_pk_bf16_f32 v183, v98, v99
  v_min_u32 v182, -2, v182
  ds_write_b64 v26, v[182:183]
  s_waitcnt lgkmcnt(0)
  s_barrier
  s_branch chain_done
E_29:
  v_add_u32 v190, 3072, v4
  ds_read_b128 v[60:63], v4 offset:3072
  ds_read_b128 v[64:67], v4 offset:4096
  ds_read_b128 v[68:71], v4 offset:5120
  s_waitcnt lgkmcnt(0)
  s_branch mo_139
  .p2align 3
top_134:
  s_waitcnt vmcnt(2)
  ds_write_b128 v190, v[60:63] offset:0
  v_cmp_eq_u32 s[22:23], -1, v60
  s_waitcnt vmcnt(1)
  ds_write_b128 v190, v[64:67] offset:1024
  v_cmp_eq_u32 s[98:99], -1, v64
  s_waitcnt vmcnt(0)
  ds_write_b128 v190, v[68:71] offset:2048
  v_cmp_eq_u32 s[100:101], -1, v68
  s_or_b64 vcc, s[22:23], s[98:99]
  s_or_b64 vcc, vcc, s[100:101]
  s_cbranch_scc1 mr_135
mo_139:
  s_waitcnt lgkmcnt(0)
  s_barrier
  ds_read_b128 v[48:51], v4 offset:0
  ds_read_b128 v[52:55], v4 offset:1024
  v_smfmac_f32_16x16x64_bf16 v[92:95], v[60:63], v[200:207], v22
  ds_read_b128 v[56:59], v4 offset:2048
  v_smfmac_f32_16x16x64_bf16 v[88:91], v[60:63], a[184:191], v22
  ds_read_b128 v[72:75], v4 offset:6144
  v_smfmac_f32_16x16x64_bf16 v[92:95], v[64:67], v[208:215], v22
  ds_read_b128 v[76:79], v4 offset:7168
  v_smfmac_f32_16x16x64_bf16 v[88:91], v[64:67], a[192:199], v22
  ds_read_b128 v[80:83], v4 offset:8192
  v_smfmac_f32_16x16x64_bf16 v[92:95], v[68:71], v[216:223], v22
  ds_read_b128 v[84:87], v4 offset:9216
  v_smfmac_f32_16x16x64_bf16 v[88:91], v[68:71], a[200:207], v22
  s_waitcnt lgkmcnt(6)
  v_smfmac_f32_16x16x64_bf16 v[92:95], v[48:51], a[240:247], v22
  v_smfmac_f32_16x16x64_bf16 v[88:91], v[48:51], a[160:167], v22
  s_waitcnt lgkmcnt(5)
  v_smfmac_f32_16x16x64_bf16 v[92:95], v[52:55], a[248:255], v22
  s_waitcnt lgkmcnt(4)
  v_smfmac_f32_16x16x64_bf16 v[92:95], v[56:59], v[192:199], v22
  s_waitcnt lgkmcnt(3)
  v_smfmac_f32_16x16x64_bf16 v[92:95], v[72:75], v[224:231], v22
  s_waitcnt lgkmcnt(2)
  v_smfmac_f32_16x16x64_bf16 v[92:95], v[76:79], v[232:239], v22
  s_waitcnt lgkmcnt(1)
  v_smfmac_f32_16x16x64_bf16 v[92:95], v[80:83], v[240:247], v22
  s_waitcnt lgkmcnt(0)
  v_smfmac_f32_16x16x64_bf16 v[92:95], v[84:87], v[248:255], v22
  v_smfmac_f32_16x16x64_bf16 v[88:91], v[52:55], a[168:175], v22
  v_smfmac_f32_16x16x64_bf16 v[88:91], v[56:59], a[176:183], v22
  v_smfmac_f32_16x16x64_bf16 v[88:91], v[72:75], a[208:215], v22
  v_permlane32_swap_b32 v92, v93
  v_smfmac_f32_16x16x64_bf16 v[88:91], v[76:79], a[216:223], v22
  v_permlane32_swap_b32 v94, v95
  v_smfmac_f32_16x16x64_bf16 v[88:91], v[80:83], a[224:231], v22
  v_permlane32_swap_b32 v93, v92
  v_smfmac_f32_16x16x64_bf16 v[88:91], v[84:87], a[232:239], v22
  v_permlane32_swap_b32 v95, v94
  v_pk_mul_f32 v[120:121], v[92:93], v[24:25] op_sel:[1,0] op_sel_hi:[0,1]
  v_pk_mul_f32 v[122:123], v[94:95], v[24:25] op_sel:[1,0] op_sel_hi:[0,1]
  s_nop 4
  v_pk_fma_f32 v[88:89], v[88:89], v[24:25], v[120:121]
  v_pk_fma_f32 v[90:91], v[90:91], v[24:25], v[122:123]
  v_cvt_pk_bf16_f32 v120, v88, v89
  v_cvt_pk_bf16_f32 v121, v90, v91
  ds_write_b64 v6, v[120:121]
  v_cmp_u_f32 vcc, v88, v89
  v_cmp_u_f32 s[22:23], v90, v91
  s_nop 1
  s_or_b64 vcc, vcc, s[22:23]
  s_cbranch_vccnz mn_136
mk_137:
  s_waitcnt lgkmcnt(0)
  s_barrier
  ds_read_b64_tr_b16 v[104:105], v7 offset:0
  ds_read_b64_tr_b16 v[106:107], v7 offset:768
  ds_read_b64_tr_b16 v[108:109], v7 offset:1536
  ds_read_b64 v[140:141], v11
  s_cmp_eq_u32 s52, 63
  s_cbranch_scc1 last_138
  s_waitcnt lgkmcnt(2)
  v_mfma_f32_16x16x32_bf16 v[120:123], v[112:115], v[104:107], 0
  s_waitcnt lgkmcnt(1)
  v_mfma_f32_16x16x32_bf16 v[120:123], v[116:119], v[108:111], v[120:123]
  s_mov_b64 exec, s[64:65]
  s_nop 6
  v_cvt_pk_f16_f32 v120, v120, v121
  v_cvt_pk_f16_f32 v121, v122, v123
  buffer_store_dwordx2 v[120:121], v8, s[8:11], s56 offen sc1
  s_mov_b64 exec, -1
  s_sleep 3
  s_nop 1
  v_smfmac_f32_16x16x64_bf16 v[96:99], v[48:51], a[0:7], v22
  v_smfmac_f32_16x16x64_bf16 v[100:103], v[48:51], a[80:87], v22
  v_smfmac_f32_16x16x64_bf16 v[96:99], v[52:55], a[8:15], v22
  v_smfmac_f32_16x16x64_bf16 v[100:103], v[52:55], a[88:95], v22
  v_smfmac_f32_16x16x64_bf16 v[96:99], v[56:59], a[16:23], v22
  v_smfmac_f32_16x16x64_bf16 v[100:103], v[56:59], a[96:103], v22
  v_smfmac_f32_16x16x64_bf16 v[96:99], v[60:63], a[24:31], v22
  v_smfmac_f32_16x16x64_bf16 v[96:99], v[64:67], a[32:39], v22
  v_smfmac_f32_16x16x64_bf16 v[96:99], v[68:71], a[40:47], v22
  v_smfmac_f32_16x16x64_bf16 v[96:99], v[72:75], a[48:55], v22
  v_smfmac_f32_16x16x64_bf16 v[96:99], v[76:79], a[56:63], v22
  buffer_load_dwordx4 v[124:127], v9, s[8:11], s56 offen sc1
  v_smfmac_f32_16x16x64_bf16 v[96:99], v[80:83], a[64:71], v22
  buffer_load_dwordx4 v[128:131], v9, s[8:11], s56 offen offset:1024 sc1
  v_smfmac_f32_16x16x64_bf16 v[96:99], v[84:87], a[72:79], v22
  buffer_load_dwordx4 v[132:135], v10, s[8:11], s56 offen sc1
  v_smfmac_f32_16x16x64_bf16 v[100:103], v[60:63], a[104:111], v22
  v_smfmac_f32_16x16x64_bf16 v[100:103], v[64:67], a[112:119], v22
  v_smfmac_f32_16x16x64_bf16 v[100:103], v[68:71], a[120:127], v22
  v_smfmac_f32_16x16x64_bf16 v[100:103], v[72:75], a[128:135], v22
  v_cvt_pk_bf16_f32 v136, v96, v97
  v_smfmac_f32_16x16x64_bf16 v[100:103], v[76:79], a[136:143], v22
  v_cvt_pk_bf16_f32 v137, v98, v99
  v_smfmac_f32_16x16x64_bf16 v[100:103], v[80:83], a[144:151], v22
  v_smfmac_f32_16x16x64_bf16 v[100:103], v[84:87], a[152:159], v22
  s_waitcnt vmcnt(2)
  v_pk_add_f16 v172, v124, v126
  v_pk_add_f16 v173, v125, v127
  s_waitcnt vmcnt(1)
  v_pk_add_f16 v174, v128, v130
  v_pk_add_f16 v175, v129, v131
  v_fma_mix_f32 v166, v172, 1.0, v174 op_sel:[0,0,0] op_sel_hi:[1,0,1]
  v_fma_mix_f32 v168, v173, 1.0, v175 op_sel:[0,0,0] op_sel_hi:[1,0,1]
  s_waitcnt vmcnt(0)
  v_pk_add_f16 v176, v132, v133
  v_pk_add_f16 v177, v134, v135
  v_fma_mix_f32 v170, v176, 1.0, v177 op_sel:[0,0,0] op_sel_hi:[1,0,1]
  v_fma_mix_f32 v167, v172, 1.0, v174 op_sel:[1,0,1] op_sel_hi:[1,0,1]
  v_cmp_u_f32 vcc, v166, v170
  v_fma_mix_f32 v169, v173, 1.0, v175 op_sel:[1,0,1] op_sel_hi:[1,0,1]
  v_fma_mix_f32 v171, v176, 1.0, v177 op_sel:[1,0,1] op_sel_hi:[1,0,1]
  v_cvt_pk_bf16_f32 v138, v100, v101
  s_cbranch_vccnz sr_140
sj_141:
ex_142:
  v_exp_f32 v172, v166
  v_exp_f32 v173, v167
  v_exp_f32 v174, v168
  v_cvt_pk_bf16_f32 v156, v172, v173
  v_exp_f32 v175, v169
  v_exp_f32 v176, v170
  v_cvt_pk_bf16_f32 v157, v174, v175
  v_mov_b32_dpp v158, v156 row_ror:8 row_mask:0xf bank_mask:0xf
  v_exp_f32 v177, v171
  v_mov_b32_dpp v159, v157 row_ror:8 row_mask:0xf bank_mask:0xf
  v_cvt_pk_bf16_f32 v160, v176, v177
  v_cvt_pk_bf16_f32 v139, v102, v103
  v_mfma_f32_16x16x32_bf16 v[178:181], v[152:155], v[156:159], 0
  s_waitcnt lgkmcnt(0)
  v_mov_b32_dpp v161, v160 row_ror:8 row_mask:0xf bank_mask:0xf
  v_mfma_f32_16x16x32_bf16 v[182:185], v[144:147], v[156:159], 0
  s_nop 0
  v_mfma_f32_16x16x32_bf16 v[178:181], v[140:143], v[160:163], v[178:181]
  v_mfma_f32_16x16x32_bf16 v[182:185], v[136:139], v[160:163], v[182:185]
  v_mfma_f32_16x16x32_bf16 v[186:189], v[148:151], v[156:159], 0
  v_mfma_f32_16x16x32_bf16 v[186:189], v[138:141], v[160:163], v[186:189]
  s_mov_b64 exec, s[62:63]
  v_rcp_f32 v164, v180
  s_nop 0
  v_pk_mul_f32 v[178:179], v[178:179], v[164:165] op_sel_hi:[1,0]
  v_pk_mul_f32 v[182:183], v[182:183], v[164:165] op_sel_hi:[1,0]
  v_pk_mul_f32 v[184:185], v[184:185], v[164:165] op_sel_hi:[1,0]
  v_cvt_pk_f16_f32 v64, v178, v179
  v_cvt_pk_f16_f32 v60, v182, v183
  v_pk_mul_f32 v[186:187], v[186:187], v[164:165] op_sel_hi:[1,0]
  v_pk_mul_f32 v[188:189], v[188:189], v[164:165] op_sel_hi:[1,0]
  v_cvt_pk_f16_f32 v61, v184, v185
  v_cvt_pk_f16_f32 v62, v186, v187
  v_cvt_pk_f16_f32 v63, v188, v189
  ds_write_b128 v13, v[60:63]
  ds_write_b32 v14, v64
  v_add_f32 v165, v164, v180
  v_cmp_ngt_f32 vcc, s80, v165
  s_mov_b64 exec, -1
  s_nop 0
  s_cbranch_vccnz fx_143
fk_144:
  s_waitcnt lgkmcnt(0)
  s_barrier
  s_add_u32 m0, s74, 9216
  s_add_u32 s21, s72, 83968
  buffer_load_dwordx4 v32, s[28:31], s21 offen sc1 lds
  s_add_u32 m0, s74, 2048
  s_add_u32 s21, s79, 40960
  buffer_load_dwordx4 v4, s[28:31], s21 offen sc1 lds
  s_add_u32 m0, s74, 5120
  s_add_u32 s21, s79, 82944
  buffer_load_dwordx4 v4, s[28:31], s21 offen sc1 lds
  s_add_u32 s72, s72, 1310720
  s_add_u32 s79, s79, 1310720
  s_add_u32 s73, s73, 393216
  s_xor_b32 s74, s74, 16384
  s_nop 15
  s_nop 3
  v_permlane32_swap_b32 v96, v100
  v_permlane32_swap_b32 v97, v101
  v_permlane32_swap_b32 v98, v102
  v_permlane32_swap_b32 v99, v103
  v_pk_add_f32 v[96:97], v[96:97], v[100:101]
  v_pk_add_f32 v[98:99], v[98:99], v[102:103]
  v_cvt_pk_bf16_f32 v182, v96, v97
  v_cvt_pk_bf16_f32 v183, v98, v99
  v_min_u32 v182, -2, v182
  ds_write_b64 v26, v[182:183]
  ds_read_b128 v[144:147], v18
  ds_read_b128 v[148:151], v18 offset:1024
  ds_read_b128 v[152:155], v19
  ds_read_b128 v[112:115], v20
  ds_read_b64 v[116:117], v21
  v_xor_b32 v18, 16384, v18
  v_xor_b32 v19, 16384, v19
  v_xor_b32 v20, 16384, v20
  v_xor_b32 v21, 16384, v21
  v_mov_b32 v88, 0
  v_mov_b32 v89, 0
  v_mov_b32 v90, 0
  v_mov_b32 v91, 0
  v_mov_b32 v92, 0
  v_mov_b32 v93, 0
  v_mov_b32 v94, 0
  v_mov_b32 v95, 0
  v_mov_b32 v96, 0
  v_mov_b32 v97, 0
  v_mov_b32 v98, 0
  v_mov_b32 v99, 0
  v_mov_b32 v100, 0
  v_mov_b32 v101, 0
  v_mov_b32 v102, 0
  v_mov_b32 v103, 0
  s_mov_b32 s81, 0
  s_waitcnt lgkmcnt(0)
  s_barrier
  s_mov_b64 exec, s[64:65]
  buffer_store_dwordx2 v[28:29], v8, s[8:11], s57 offen sc1
  s_mov_b64 exec, s[62:63]
  buffer_store_dword v28, v17, s[8:11], s59 offen sc1
  s_mov_b64 exec, -1
  s_sleep 6
  s_nop 3
  buffer_load_dwordx4 v[68:71], v16, s[4:7], s60 offen sc1
  s_sleep 3
  s_nop 1
  buffer_load_dwordx4 v[72:75], v16, s[4:7], s60 offen sc1
  s_mov_b32 s54, 0
pp_146:
  s_waitcnt vmcnt(1)
  v_mfma_f32_16x16x32_f16 v[120:123], v[44:47], v[68:71], 0
  v_bitop3_b32 v27, v68, s61, 1 bitop3:0x28
  v_cmp_ne_u32 vcc, 0, v27
  s_nop 1
  s_cbranch_vccnz p2_148
  s_nop 2
pg_147:
  v_add_f32_dpp v120, v120, v120 row_ror:8 row_mask:0xf bank_mask:0xf
  v_add_f32_dpp v121, v121, v121 row_ror:8 row_mask:0xf bank_mask:0xf
  s_mov_b64 exec, s[62:63]
  v_cvt_pk_bf16_f32 v120, v120, v121
  v_min_u32 v120, -2, v120
  buffer_store_dword v120, v17, s[8:11], s55 offen sc1
  s_mov_b64 exec, -1
nt_145:
  s_barrier
  s_mov_b32 s58, s55
  s_add_u32 s52, s52, 1
  s_and_b32 s21, s52, 3
  s_mul_i32 s56, s21, 122880
  s_add_u32 s21, s52, 1
  s_and_b32 s21, s21, 3
  s_mul_i32 s55, s21, 122880
  s_add_u32 s55, s55, s75
  s_add_u32 s21, s52, 2
  s_and_b32 s21, s21, 3
  s_mul_i32 s57, s21, 122880
  s_add_u32 s21, s52, 3
  s_and_b32 s21, s21, 3
  s_mul_i32 s59, s21, 122880
  s_add_u32 s59, s59, s75
  s_bfe_u32 s61, s52, 0x10001
  s_and_b32 s21, s52, 1
  s_lshl_b32 s60, s21, 19
  s_mov_b32 s54, 0
  s_sleep 3
  s_nop 2
  buffer_load_dwordx4 v[60:63], v190, s[8:11], s58 offen offset:0 sc1
  buffer_load_dwordx4 v[64:67], v190, s[8:11], s58 offen offset:1024 sc1
  buffer_load_dwordx4 v[68:71], v190, s[8:11], s58 offen offset:2048 sc1
  s_branch top_134
mr_135:
  s_mov_b64 exec, s[22:23]
  s_cbranch_execz ms_149
  buffer_load_dwordx4 v[60:63], v190, s[8:11], s58 offen offset:0 sc1
ms_149:
  s_mov_b64 exec, s[98:99]
  s_cbranch_execz ms_150
  buffer_load_dwordx4 v[64:67], v190, s[8:11], s58 offen offset:1024 sc1
ms_150:
  s_mov_b64 exec, s[100:101]
  s_cbranch_execz ms_151
  buffer_load_dwordx4 v[68:71], v190, s[8:11], s58 offen offset:2048 sc1
ms_151:
  s_add_u32 s54, s54, 1
  s_cmp_gt_u32 s54, 131072
  s_cbranch_scc1 end0
  s_waitcnt vmcnt(0)
  s_mov_b64 exec, s[22:23]
  ds_write_b128 v190, v[60:63] offset:0
  v_cmp_eq_u32 s[22:23], -1, v60
  s_mov_b64 exec, s[98:99]
  ds_write_b128 v190, v[64:67] offset:1024
  v_cmp_eq_u32 s[98:99], -1, v64
  s_mov_b64 exec, s[100:101]
  ds_write_b128 v190, v[68:71] offset:2048
  v_cmp_eq_u32 s[100:101], -1, v68
  s_mov_b64 exec, -1
  s_or_b64 vcc, s[22:23], s[98:99]
  s_or_b64 vcc, vcc, s[100:101]
  s_cbranch_scc1 mr_135
  s_branch mo_139
mn_136:
  v_max3_u32 v27, v48, v49, v50
  v_max3_u32 v27, v27, v51, v52
  v_max3_u32 v27, v27, v53, v54
  v_max3_u32 v27, v27, v55, v56
  v_max3_u32 v27, v27, v57, v58
  v_max3_u32 v27, v27, v59, v60
  v_max3_u32 v27, v27, v61, v62
  v_max3_u32 v27, v27, v63, v64
  v_max3_u32 v27, v27, v65, v66
  v_max3_u32 v27, v27, v67, v68
  v_max3_u32 v27, v27, v69, v70
  v_max3_u32 v27, v27, v71, v72
  v_max3_u32 v27, v27, v73, v74
  v_max3_u32 v27, v27, v75, v76
  v_max3_u32 v27, v27, v77, v78
  v_max3_u32 v27, v27, v79, v80
  v_max3_u32 v27, v27, v81, v82
  v_max3_u32 v27, v27, v83, v84
  v_max3_u32 v27, v27, v85, v86
  v_max3_u32 v27, v27, v87, v87
  v_cmp_eq_u32 vcc, -1, v27
  s_cmp_eq_u32 s52, 0
  s_cbranch_scc1 mk_137
  s_cbranch_vccz mk_137
  s_waitcnt lgkmcnt(0)
  s_barrier
  s_nop 7
  v_mov_b32 v88, 0
  v_mov_b32 v89, 0
  v_mov_b32 v90, 0
  v_mov_b32 v91, 0
  v_mov_b32 v92, 0
  v_mov_b32 v93, 0
  v_mov_b32 v94, 0
  v_mov_b32 v95, 0
  v_mov_b32 v96, 0
  v_mov_b32 v97, 0
  v_mov_b32 v98, 0
  v_mov_b32 v99, 0
  v_mov_b32 v100, 0
  v_mov_b32 v101, 0
  v_mov_b32 v102, 0
  v_mov_b32 v103, 0
  s_mov_b64 s[22:23], -1
  s_mov_b64 s[98:99], -1
  s_mov_b64 s[100:101], -1
  s_branch mr_135
sr_140:
  s_mov_b32 s54, 0
sr_152:
  s_mov_b64 exec, vcc
  buffer_load_dwordx4 v[124:127], v9, s[8:11], s56 offen sc1
  buffer_load_dwordx4 v[128:131], v9, s[8:11], s56 offen offset:1024 sc1
  buffer_load_dwordx4 v[132:135], v10, s[8:11], s56 offen sc1
  s_mov_b64 exec, -1
  s_add_u32 s54, s54, 1
  s_cmp_gt_u32 s54, 131072
  s_cbranch_scc1 end0
  s_and_b32 s21, s54, 31
  s_cbranch_scc0 sr_153
  s_waitcnt vmcnt(0)
  v_pk_add_f16 v172, v124, v126
  v_pk_add_f16 v173, v125, v127
  v_pk_add_f16 v174, v128, v130
  v_pk_add_f16 v175, v129, v131
  v_fma_mix_f32 v166, v172, 1.0, v174 op_sel:[0,0,0] op_sel_hi:[1,0,1]
  v_fma_mix_f32 v168, v173, 1.0, v175 op_sel:[0,0,0] op_sel_hi:[1,0,1]
  v_pk_add_f16 v176, v132, v133
  v_pk_add_f16 v177, v134, v135
  v_add_f32 v27, v166, v168
  v_fma_mix_f32 v170, v176, 1.0, v177 op_sel:[0,0,0] op_sel_hi:[1,0,1]
  v_fma_mix_f32 v167, v172, 1.0, v174 op_sel:[1,0,1] op_sel_hi:[1,0,1]
  v_cmp_u_f32 vcc, v27, v170
  v_fma_mix_f32 v169, v173, 1.0, v175 op_sel:[1,0,1] op_sel_hi:[1,0,1]
  v_fma_mix_f32 v171, v176, 1.0, v177 op_sel:[1,0,1] op_sel_hi:[1,0,1]
  s_cbranch_vccnz sr_152
  s_branch sj_141
sr_153:
  s_waitcnt vmcnt(0)
  v_pk_add_f16 v172, v124, v126
  v_pk_add_f16 v173, v125, v127
  v_pk_add_f16 v174, v128, v130
  v_pk_add_f16 v175, v129, v131
  v_fma_mix_f32 v166, v172, 1.0, v174 op_sel:[0,0,0] op_sel_hi:[1,0,1]
  v_fma_mix_f32 v168, v173, 1.0, v175 op_sel:[0,0,0] op_sel_hi:[1,0,1]
  v_pk_add_f16 v176, v132, v133
  v_pk_add_f16 v177, v134, v135
  v_add_f32 v27, v166, v168
  v_fma_mix_f32 v170, v176, 1.0, v177 op_sel:[0,0,0] op_sel_hi:[1,0,1]
  v_fma_mix_f32 v167, v172, 1.0, v174 op_sel:[1,0,1] op_sel_hi:[1,0,1]
  v_cmp_u_f32 vcc, v27, v170
  v_fma_mix_f32 v169, v173, 1.0, v175 op_sel:[1,0,1] op_sel_hi:[1,0,1]
  v_fma_mix_f32 v171, v176, 1.0, v177 op_sel:[1,0,1] op_sel_hi:[1,0,1]
  v_max3_u32 v27, v124, v126, v128
  v_max3_u32 v27, v27, v130, v132
  v_max3_u32 v27, v27, v133, v134
  v_max3_u32 v27, v27, v135, v135
  v_cmp_eq_u32 vcc, -1, v27
  s_nop 1
  s_cbranch_vccnz sr_152
  s_branch sj_141
fx_143:
  s_cmp_eq_u32 s81, 1
  s_cbranch_scc1 fk_144
  s_mov_b32 s81, 1
  v_max3_f32 v164, v166, v167, v168
  v_max3_f32 v165, v169, v170, v171
  v_max_f32 v164, v164, v165
  s_nop 1
  v_max_f32_dpp v164, v164, v164 row_ror:8 row_mask:0xf bank_mask:0xf
  v_mov_b32 v165, v164
  s_nop 1
  v_permlane32_swap_b32 v164, v165
  v_max_f32 v164, v164, v165
  v_mov_b32 v165, v164
  s_nop 1
  v_permlane16_swap_b32 v164, v165
  v_max_f32 v164, v164, v165
  v_sub_f32 v166, v166, v164
  v_sub_f32 v167, v167, v164
  v_sub_f32 v168, v168, v164
  v_sub_f32 v169, v169, v164
  v_sub_f32 v170, v170, v164
  v_sub_f32 v171, v171, v164
  s_branch ex_142
p2_148:
  buffer_load_dwordx4 v[68:71], v16, s[4:7], s60 offen sc1
  s_waitcnt vmcnt(1)
  v_mfma_f32_16x16x32_f16 v[120:123], v[44:47], v[72:75], 0
  v_bitop3_b32 v27, v72, s61, 1 bitop3:0x28
  v_cmp_ne_u32 vcc, 0, v27
  s_nop 1
  s_cbranch_vccz pg_147
  buffer_load_dwordx4 v[72:75], v16, s[4:7], s60 offen sc1
  s_add_u32 s54, s54, 1
  s_cmp_gt_u32 s54, 131072
  s_cbranch_scc1 end0
  s_branch pp_146
last_138:
  v_smfmac_f32_16x16x64_bf16 v[96:99], v[48:51], a[0:7], v22
  v_smfmac_f32_16x16x64_bf16 v[100:103], v[48:51], a[80:87], v22
  v_smfmac_f32_16x16x64_bf16 v[96:99], v[52:55], a[8:15], v22
  v_smfmac_f32_16x16x64_bf16 v[100:103], v[52:55], a[88:95], v22
  v_smfmac_f32_16x16x64_bf16 v[96:99], v[56:59], a[16:23], v22
  v_smfmac_f32_16x16x64_bf16 v[100:103], v[56:59], a[96:103], v22
  v_smfmac_f32_16x16x64_bf16 v[96:99], v[60:63], a[24:31], v22
  v_smfmac_f32_16x16x64_bf16 v[96:99], v[64:67], a[32:39], v22
  v_smfmac_f32_16x16x64_bf16 v[96:99], v[68:71], a[40:47], v22
  v_smfmac_f32_16x16x64_bf16 v[96:99], v[72:75], a[48:55], v22
  v_smfmac_f32_16x16x64_bf16 v[96:99], v[76:79], a[56:63], v22
  v_smfmac_f32_16x16x64_bf16 v[96:99], v[80:83], a[64:71], v22
  v_smfmac_f32_16x16x64_bf16 v[96:99], v[84:87], a[72:79], v22
  v_smfmac_f32_16x16x64_bf16 v[100:103], v[60:63], a[104:111], v22
  v_smfmac_f32_16x16x64_bf16 v[100:103], v[64:67], a[112:119], v22
  v_smfmac_f32_16x16x64_bf16 v[100:103], v[68:71], a[120:127], v22
  v_smfmac_f32_16x16x64_bf16 v[100:103], v[72:75], a[128:135], v22
  v_smfmac_f32_16x16x64_bf16 v[100:103], v[76:79], a[136:143], v22
  v_smfmac_f32_16x16x64_bf16 v[100:103], v[80:83], a[144:151], v22
  v_smfmac_f32_16x16x64_bf16 v[100:103], v[84:87], a[152:159], v22
  s_nop 7
  v_permlane32_swap_b32 v96, v100
  v_permlane32_swap_b32 v97, v101
  v_permlane32_swap_b32 v98, v102
  v_permlane32_swap_b32 v99, v103
  v_pk_add_f32 v[96:97], v[96:97], v[100:101]
  v_pk_add_f32 v[98:99], v[98:99], v[102:103]
  v_cvt_pk_bf16_f32 v182, v96, v97
  v_cvt_pk_bf16_f32 v183, v98, v99
  v_min_u32 v182, -2, v182
  ds_write_b64 v26, v[182:183]
  s_waitcnt lgkmcnt(0)
  s_barrier
  s_branch chain_done
E_31:
  v_add_u32 v190, 6144, v4
  ds_read_b128 v[72:75], v4 offset:6144
  ds_read_b128 v[76:79], v4 offset:7168
  ds_read_b128 v[80:83], v4 offset:8192
  s_waitcnt lgkmcnt(0)
  s_branch mo_159
  .p2align 3
top_154:
  s_waitcnt vmcnt(2)
  ds_write_b128 v190, v[72:75] offset:0
  v_cmp_eq_u32 s[22:23], -1, v72
  s_waitcnt vmcnt(1)
  ds_write_b128 v190, v[76:79] offset:1024
  v_cmp_eq_u32 s[98:99], -1, v76
  s_waitcnt vmcnt(0)
  ds_write_b128 v190, v[80:83] offset:2048
  v_cmp_eq_u32 s[100:101], -1, v80
  s_or_b64 vcc, s[22:23], s[98:99]
  s_or_b64 vcc, vcc, s[100:101]
  s_cbranch_scc1 mr_155
mo_159:
  s_waitcnt lgkmcnt(0)
  s_barrier
  ds_read_b128 v[48:51], v4 offset:0
  ds_read_b128 v[52:55], v4 offset:1024
  v_smfmac_f32_16x16x64_bf16 v[92:95], v[72:75], v[224:231], v22
  ds_read_b128 v[56:59], v4 offset:2048
  v_smfmac_f32_16x16x64_bf16 v[88:91], v[72:75], a[208:215], v22
  ds_read_b128 v[60:63], v4 offset:3072
  v_smfmac_f32_16x16x64_bf16 v[92:95], v[76:79], v[232:239], v22
  ds_read_b128 v[64:67], v4 offset:4096
  v_smfmac_f32_16x16x64_bf16 v[88:91], v[76:79], a[216:223], v22
  ds_read_b128 v[68:71], v4 offset:5120
  v_smfmac_f32_16x16x64_bf16 v[92:95], v[80:83], v[240:247], v22
  ds_read_b128 v[84:87], v4 offset:9216
  v_smfmac_f32_16x16x64_bf16 v[88:91], v[80:83], a[224:231], v22
  s_waitcnt lgkmcnt(6)
  v_smfmac_f32_16x16x64_bf16 v[92:95], v[48:51], a[240:247], v22
  v_smfmac_f32_16x16x64_bf16 v[88:91], v[48:51], a[160:167], v22
  s_waitcnt lgkmcnt(5)
  v_smfmac_f32_16x16x64_bf16 v[92:95], v[52:55], a[248:255], v22
  s_waitcnt lgkmcnt(4)
  v_smfmac_f32_16x16x64_bf16 v[92:95], v[56:59], v[192:199], v22
  s_waitcnt lgkmcnt(3)
  v_smfmac_f32_16x16x64_bf16 v[92:95], v[60:63], v[200:207], v22
  s_waitcnt lgkmcnt(2)
  v_smfmac_f32_16x16x64_bf16 v[92:95], v[64:67], v[208:215], v22
  s_waitcnt lgkmcnt(1)
  v_smfmac_f32_16x16x64_bf16 v[92:95], v[68:71], v[216:223], v22
  s_waitcnt lgkmcnt(0)
  v_smfmac_f32_16x16x64_bf16 v[92:95], v[84:87], v[248:255], v22
  v_smfmac_f32_16x16x64_bf16 v[88:91], v[52:55], a[168:175], v22
  v_smfmac_f32_16x16x64_bf16 v[88:91], v[56:59], a[176:183], v22
  v_smfmac_f32_16x16x64_bf16 v[88:91], v[60:63], a[184:191], v22
  v_permlane32_swap_b32 v92, v93
  v_smfmac_f32_16x16x64_bf16 v[88:91], v[64:67], a[192:199], v22
  v_permlane32_swap_b32 v94, v95
  v_smfmac_f32_16x16x64_bf16 v[88:91], v[68:71], a[200:207], v22
  v_permlane32_swap_b32 v93, v92
  v_smfmac_f32_16x16x64_bf16 v[88:91], v[84:87], a[232:239], v22
  v_permlane32_swap_b32 v95, v94
  v_pk_mul_f32 v[120:121], v[92:93], v[24:25] op_sel:[1,0] op_sel_hi:[0,1]
  v_pk_mul_f32 v[122:123], v[94:95], v[24:25] op_sel:[1,0] op_sel_hi:[0,1]
  s_nop 4
  v_pk_fma_f32 v[88:89], v[88:89], v[24:25], v[120:121]
  v_pk_fma_f32 v[90:91], v[90:91], v[24:25], v[122:123]
  v_cvt_pk_bf16_f32 v120, v88, v89
  v_cvt_pk_bf16_f32 v121, v90, v91
  ds_write_b64 v6, v[120:121]
  v_cmp_u_f32 vcc, v88, v89
  v_cmp_u_f32 s[22:23], v90, v91
  s_nop 1
  s_or_b64 vcc, vcc, s[22:23]
  s_cbranch_vccnz mn_156
mk_157:
  s_waitcnt lgkmcnt(0)
  s_barrier
  ds_read_b64_tr_b16 v[104:105], v7 offset:0
  ds_read_b64_tr_b16 v[106:107], v7 offset:768
  ds_read_b64_tr_b16 v[108:109], v7 offset:1536
  ds_read_b64 v[140:141], v11
  s_cmp_eq_u32 s52, 63
  s_cbranch_scc1 last_158
  s_waitcnt lgkmcnt(2)
  v_mfma_f32_16x16x32_bf16 v[120:123], v[104:107], v[104:107], 0
  s_waitcnt lgkmcnt(1)
  v_mfma_f32_16x16x32_bf16 v[120:123], v[108:111], v[108:111], v[120:123]
  s_mov_b64 exec, s[64:65]
  s_nop 6
  v_cvt_pk_f16_f32 v120, v120, v121
  buffer_store_dword v120, v8, s[8:11], s56 offen sc1
  v_cvt_pk_f16_f32 v121, v122, v123
  buffer_store_dword v121, v8, s[8:11], s56 offen offset:128 sc1
  s_mov_b64 exec, -1
  s_sleep 3
  s_nop 1
  v_smfmac_f32_16x16x64_bf16 v[96:99], v[48:51], a[0:7], v22
  v_smfmac_f32_16x16x64_bf16 v[100:103], v[48:51], a[80:87], v22
  v_smfmac_f32_16x16x64_bf16 v[96:99], v[52:55], a[8:15], v22
  v_smfmac_f32_16x16x64_bf16 v[100:103], v[52:55], a[88:95], v22
  v_smfmac_f32_16x16x64_bf16 v[96:99], v[56:59], a[16:23], v22
  v_smfmac_f32_16x16x64_bf16 v[100:103], v[56:59], a[96:103], v22
  v_smfmac_f32_16x16x64_bf16 v[96:99], v[60:63], a[24:31], v22
  v_smfmac_f32_16x16x64_bf16 v[96:99], v[64:67], a[32:39], v22
  v_smfmac_f32_16x16x64_bf16 v[96:99], v[68:71], a[40:47], v22
  v_smfmac_f32_16x16x64_bf16 v[96:99], v[72:75], a[48:55], v22
  v_smfmac_f32_16x16x64_bf16 v[96:99], v[76:79], a[56:63], v22
  buffer_load_dwordx4 v[124:127], v9, s[8:11], s56 offen sc1
  v_smfmac_f32_16x16x64_bf16 v[96:99], v[80:83], a[64:71], v22
  buffer_load_dwordx4 v[128:131], v9, s[8:11], s56 offen offset:1024 sc1
  v_smfmac_f32_16x16x64_bf16 v[96:99], v[84:87], a[72:79], v22
  buffer_load_dwordx4 v[132:135], v10, s[8:11], s56 offen sc1
  v_smfmac_f32_16x16x64_bf16 v[100:103], v[60:63], a[104:111], v22
  v_smfmac_f32_16x16x64_bf16 v[100:103], v[64:67], a[112:119], v22
  v_smfmac_f32_16x16x64_bf16 v[100:103], v[68:71], a[120:127], v22
  v_smfmac_f32_16x16x64_bf16 v[100:103], v[72:75], a[128:135], v22
  v_cvt_pk_bf16_f32 v136, v96, v97
  v_smfmac_f32_16x16x64_bf16 v[100:103], v[76:79], a[136:143], v22
  v_cvt_pk_bf16_f32 v137, v98, v99
  v_smfmac_f32_16x16x64_bf16 v[100:103], v[80:83], a[144:151], v22
  v_smfmac_f32_16x16x64_bf16 v[100:103], v[84:87], a[152:159], v22
  s_waitcnt vmcnt(2)
  v_pk_add_f16 v172, v124, v126
  v_pk_add_f16 v173, v125, v127
  s_waitcnt vmcnt(1)
  v_pk_add_f16 v174, v128, v130
  v_pk_add_f16 v175, v129, v131
  v_fma_mix_f32 v166, v172, 1.0, v174 op_sel:[0,0,0] op_sel_hi:[1,0,1]
  v_fma_mix_f32 v168, v173, 1.0, v175 op_sel:[0,0,0] op_sel_hi:[1,0,1]
  s_waitcnt vmcnt(0)
  v_pk_add_f16 v176, v132, v133
  v_pk_add_f16 v177, v134, v135
  v_fma_mix_f32 v170, v176, 1.0, v177 op_sel:[0,0,0] op_sel_hi:[1,0,1]
  v_fma_mix_f32 v167, v172, 1.0, v174 op_sel:[1,0,1] op_sel_hi:[1,0,1]
  v_cmp_u_f32 vcc, v166, v170
  v_fma_mix_f32 v169, v173, 1.0, v175 op_sel:[1,0,1] op_sel_hi:[1,0,1]
  v_fma_mix_f32 v171, v176, 1.0, v177 op_sel:[1,0,1] op_sel_hi:[1,0,1]
  v_cvt_pk_bf16_f32 v138, v100, v101
  s_cbranch_vccnz sr_160
sj_161:
ex_162:
  v_exp_f32 v172, v166
  v_exp_f32 v173, v167
  v_exp_f32 v174, v168
  v_cvt_pk_bf16_f32 v156, v172, v173
  v_exp_f32 v175, v169
  v_exp_f32 v176, v170
  v_cvt_pk_bf16_f32 v157, v174, v175
  v_mov_b32_dpp v158, v156 row_ror:8 row_mask:0xf bank_mask:0xf
  v_exp_f32 v177, v171
  v_mov_b32_dpp v159, v157 row_ror:8 row_mask:0xf bank_mask:0xf
  v_cvt_pk_bf16_f32 v160, v176, v177
  v_cvt_pk_bf16_f32 v139, v102, v103
  v_mfma_f32_16x16x32_bf16 v[178:181], v[152:155], v[156:159], 0
  s_waitcnt lgkmcnt(0)
  v_mov_b32_dpp v161, v160 row_ror:8 row_mask:0xf bank_mask:0xf
  v_mfma_f32_16x16x32_bf16 v[182:185], v[144:147], v[156:159], 0
  s_nop 0
  v_mfma_f32_16x16x32_bf16 v[178:181], v[140:143], v[160:163], v[178:181]
  v_mfma_f32_16x16x32_bf16 v[182:185], v[136:139], v[160:163], v[182:185]
  v_mfma_f32_16x16x32_bf16 v[186:189], v[148:151], v[156:159], 0
  v_mfma_f32_16x16x32_bf16 v[186:189], v[138:141], v[160:163], v[186:189]
  s_mov_b64 exec, s[62:63]
  v_rcp_f32 v164, v180
  s_nop 0
  v_pk_mul_f32 v[178:179], v[178:179], v[164:165] op_sel_hi:[1,0]
  v_pk_mul_f32 v[182:183], v[182:183], v[164:165] op_sel_hi:[1,0]
  v_pk_mul_f32 v[184:185], v[184:185], v[164:165] op_sel_hi:[1,0]
  v_cvt_pk_f16_f32 v64, v178, v179
  v_cvt_pk_f16_f32 v60, v182, v183
  v_pk_mul_f32 v[186:187], v[186:187], v[164:165] op_sel_hi:[1,0]
  v_pk_mul_f32 v[188:189], v[188:189], v[164:165] op_sel_hi:[1,0]
  v_cvt_pk_f16_f32 v61, v184, v185
  v_cvt_pk_f16_f32 v62, v186, v187
  v_cvt_pk_f16_f32 v63, v188, v189
  ds_write_b128 v13, v[60:63]
  ds_write_b32 v14, v64
  v_add_f32 v165, v164, v180
  v_cmp_ngt_f32 vcc, s80, v165
  s_mov_b64 exec, -1
  s_nop 0
  s_cbranch_vccnz fx_163
fk_164:
  s_waitcnt lgkmcnt(0)
  s_barrier
  s_add_u32 m0, s74, 0
  s_add_u32 s21, s79, 0
  buffer_load_dwordx4 v4, s[28:31], s21 offen sc1 lds
  s_add_u32 m0, s74, 3072
  s_add_u32 s21, s79, 41984
  buffer_load_dwordx4 v4, s[28:31], s21 offen sc1 lds
  s_add_u32 m0, s74, 6144
  s_add_u32 s21, s79, 122880
  buffer_load_dwordx4 v4, s[28:31], s21 offen sc1 lds
  s_add_u32 s72, s72, 1310720
  s_add_u32 s79, s79, 1310720
  s_add_u32 s73, s73, 393216
  s_xor_b32 s74, s74, 16384
  s_nop 15
  s_nop 3
  v_permlane32_swap_b32 v96, v100
  v_permlane32_swap_b32 v97, v101
  v_permlane32_swap_b32 v98, v102
  v_permlane32_swap_b32 v99, v103
  v_pk_add_f32 v[96:97], v[96:97], v[100:101]
  v_pk_add_f32 v[98:99], v[98:99], v[102:103]
  v_cvt_pk_bf16_f32 v182, v96, v97
  v_cvt_pk_bf16_f32 v183, v98, v99
  v_min_u32 v182, -2, v182
  ds_write_b64 v26, v[182:183]
  ds_read_b128 v[144:147], v18
  ds_read_b128 v[148:151], v18 offset:1024
  ds_read_b128 v[152:155], v19
  v_xor_b32 v18, 16384, v18
  v_xor_b32 v19, 16384, v19
  v_mov_b32 v88, 0
  v_mov_b32 v89, 0
  v_mov_b32 v90, 0
  v_mov_b32 v91, 0
  v_mov_b32 v92, 0
  v_mov_b32 v93, 0
  v_mov_b32 v94, 0
  v_mov_b32 v95, 0
  v_mov_b32 v96, 0
  v_mov_b32 v97, 0
  v_mov_b32 v98, 0
  v_mov_b32 v99, 0
  v_mov_b32 v100, 0
  v_mov_b32 v101, 0
  v_mov_b32 v102, 0
  v_mov_b32 v103, 0
  s_mov_b32 s81, 0
  s_waitcnt lgkmcnt(0)
  s_barrier
  s_mov_b64 exec, s[64:65]
  buffer_store_dword v28, v8, s[8:11], s57 offen sc1
  buffer_store_dword v28, v8, s[8:11], s57 offen offset:128 sc1
  s_mov_b64 exec, -1
  s_cmp_eq_u32 s78, 0
  s_cbranch_scc1 nt_165
  s_mov_b64 exec, s[62:63]
  buffer_store_dword v28, v17, s[8:11], s59 offen sc1
  s_mov_b64 exec, -1
  s_sleep 6
  s_nop 3
  buffer_load_dwordx4 v[68:71], v16, s[4:7], s60 offen sc1
  s_sleep 3
  s_nop 1
  buffer_load_dwordx4 v[72:75], v16, s[4:7], s60 offen sc1
  s_mov_b32 s54, 0
pp_166:
  s_waitcnt vmcnt(1)
  v_mfma_f32_16x16x32_f16 v[120:123], v[44:47], v[68:71], 0
  v_bitop3_b32 v27, v68, s61, 1 bitop3:0x28
  v_cmp_ne_u32 vcc, 0, v27
  s_nop 1
  s_cbranch_vccnz p2_168
  s_nop 2
pg_167:
  v_add_f32_dpp v120, v120, v120 row_ror:8 row_mask:0xf bank_mask:0xf
  v_add_f32_dpp v121, v121, v121 row_ror:8 row_mask:0xf bank_mask:0xf
  s_mov_b64 exec, s[62:63]
  v_cvt_pk_bf16_f32 v120, v120, v121
  v_min_u32 v120, -2, v120
  buffer_store_dword v120, v17, s[8:11], s55 offen sc1
  s_mov_b64 exec, -1
nt_165:
  s_barrier
  s_mov_b32 s58, s55
  s_add_u32 s52, s52, 1
  s_and_b32 s21, s52, 3
  s_mul_i32 s56, s21, 122880
  s_add_u32 s21, s52, 1
  s_and_b32 s21, s21, 3
  s_mul_i32 s55, s21, 122880
  s_add_u32 s55, s55, s75
  s_add_u32 s21, s52, 2
  s_and_b32 s21, s21, 3
  s_mul_i32 s57, s21, 122880
  s_add_u32 s21, s52, 3
  s_and_b32 s21, s21, 3
  s_mul_i32 s59, s21, 122880
  s_add_u32 s59, s59, s75
  s_bfe_u32 s61, s52, 0x10001
  s_and_b32 s21, s52, 1
  s_lshl_b32 s60, s21, 19
  s_mov_b32 s54, 0
  s_sleep 3
  s_nop 2
  buffer_load_dwordx4 v[72:75], v190, s[8:11], s58 offen offset:0 sc1
  buffer_load_dwordx4 v[76:79], v190, s[8:11], s58 offen offset:1024 sc1
  buffer_load_dwordx4 v[80:83], v190, s[8:11], s58 offen offset:2048 sc1
  s_branch top_154
mr_155:
  s_mov_b64 exec, s[22:23]
  s_cbranch_execz ms_169
  buffer_load_dwordx4 v[72:75], v190, s[8:11], s58 offen offset:0 sc1
ms_169:
  s_mov_b64 exec, s[98:99]
  s_cbranch_execz ms_170
  buffer_load_dwordx4 v[76:79], v190, s[8:11], s58 offen offset:1024 sc1
ms_170:
  s_mov_b64 exec, s[100:101]
  s_cbranch_execz ms_171
  buffer_load_dwordx4 v[80:83], v190, s[8:11], s58 offen offset:2048 sc1
ms_171:
  s_add_u32 s54, s54, 1
  s_cmp_gt_u32 s54, 131072
  s_cbranch_scc1 end0
  s_waitcnt vmcnt(0)
  s_mov_b64 exec, s[22:23]
  ds_write_b128 v190, v[72:75] offset:0
  v_cmp_eq_u32 s[22:23], -1, v72
  s_mov_b64 exec, s[98:99]
  ds_write_b128 v190, v[76:79] offset:1024
  v_cmp_eq_u32 s[98:99], -1, v76
  s_mov_b64 exec, s[100:101]
  ds_write_b128 v190, v[80:83] offset:2048
  v_cmp_eq_u32 s[100:101], -1, v80
  s_mov_b64 exec, -1
  s_or_b64 vcc, s[22:23], s[98:99]
  s_or_b64 vcc, vcc, s[100:101]
  s_cbranch_scc1 mr_155
  s_branch mo_159
mn_156:
  v_max3_u32 v27, v48, v49, v50
  v_max3_u32 v27, v27, v51, v52
  v_max3_u32 v27, v27, v53, v54
  v_max3_u32 v27, v27, v55, v56
  v_max3_u32 v27, v27, v57, v58
  v_max3_u32 v27, v27, v59, v60
  v_max3_u32 v27, v27, v61, v62
  v_max3_u32 v27, v27, v63, v64
  v_max3_u32 v27, v27, v65, v66
  v_max3_u32 v27, v27, v67, v68
  v_max3_u32 v27, v27, v69, v70
  v_max3_u32 v27, v27, v71, v72
  v_max3_u32 v27, v27, v73, v74
  v_max3_u32 v27, v27, v75, v76
  v_max3_u32 v27, v27, v77, v78
  v_max3_u32 v27, v27, v79, v80
  v_max3_u32 v27, v27, v81, v82
  v_max3_u32 v27, v27, v83, v84
  v_max3_u32 v27, v27, v85, v86
  v_max3_u32 v27, v27, v87, v87
  v_cmp_eq_u32 vcc, -1, v27
  s_cmp_eq_u32 s52, 0
  s_cbranch_scc1 mk_157
  s_cbranch_vccz mk_157
  s_waitcnt lgkmcnt(0)
  s_barrier
  s_nop 7
  v_mov_b32 v88, 0
  v_mov_b32 v89, 0
  v_mov_b32 v90, 0
  v_mov_b32 v91, 0
  v_mov_b32 v92, 0
  v_mov_b32 v93, 0
  v_mov_b32 v94, 0
  v_mov_b32 v95, 0
  v_mov_b32 v96, 0
  v_mov_b32 v97, 0
  v_mov_b32 v98, 0
  v_mov_b32 v99, 0
  v_mov_b32 v100, 0
  v_mov_b32 v101, 0
  v_mov_b32 v102, 0
  v_mov_b32 v103, 0
  s_mov_b64 s[22:23], -1
  s_mov_b64 s[98:99], -1
  s_mov_b64 s[100:101], -1
  s_branch mr_155
sr_160:
  s_mov_b32 s54, 0
sr_172:
  s_mov_b64 exec, vcc
  buffer_load_dwordx4 v[124:127], v9, s[8:11], s56 offen sc1
  buffer_load_dwordx4 v[128:131], v9, s[8:11], s56 offen offset:1024 sc1
  buffer_load_dwordx4 v[132:135], v10, s[8:11], s56 offen sc1
  s_mov_b64 exec, -1
  s_add_u32 s54, s54, 1
  s_cmp_gt_u32 s54, 131072
  s_cbranch_scc1 end0
  s_and_b32 s21, s54, 31
  s_cbranch_scc0 sr_173
  s_waitcnt vmcnt(0)
  v_pk_add_f16 v172, v124, v126
  v_pk_add_f16 v173, v125, v127
  v_pk_add_f16 v174, v128, v130
  v_pk_add_f16 v175, v129, v131
  v_fma_mix_f32 v166, v172, 1.0, v174 op_sel:[0,0,0] op_sel_hi:[1,0,1]
  v_fma_mix_f32 v168, v173, 1.0, v175 op_sel:[0,0,0] op_sel_hi:[1,0,1]
  v_pk_add_f16 v176, v132, v133
  v_pk_add_f16 v177, v134, v135
  v_add_f32 v27, v166, v168
  v_fma_mix_f32 v170, v176, 1.0, v177 op_sel:[0,0,0] op_sel_hi:[1,0,1]
  v_fma_mix_f32 v167, v172, 1.0, v174 op_sel:[1,0,1] op_sel_hi:[1,0,1]
  v_cmp_u_f32 vcc, v27, v170
  v_fma_mix_f32 v169, v173, 1.0, v175 op_sel:[1,0,1] op_sel_hi:[1,0,1]
  v_fma_mix_f32 v171, v176, 1.0, v177 op_sel:[1,0,1] op_sel_hi:[1,0,1]
  s_cbranch_vccnz sr_172
  s_branch sj_161
sr_173:
  s_waitcnt vmcnt(0)
  v_pk_add_f16 v172, v124, v126
  v_pk_add_f16 v173, v125, v127
  v_pk_add_f16 v174, v128, v130
  v_pk_add_f16 v175, v129, v131
  v_fma_mix_f32 v166, v172, 1.0, v174 op_sel:[0,0,0] op_sel_hi:[1,0,1]
  v_fma_mix_f32 v168, v173, 1.0, v175 op_sel:[0,0,0] op_sel_hi:[1,0,1]
  v_pk_add_f16 v176, v132, v133
  v_pk_add_f16 v177, v134, v135
  v_add_f32 v27, v166, v168
  v_fma_mix_f32 v170, v176, 1.0, v177 op_sel:[0,0,0] op_sel_hi:[1,0,1]
  v_fma_mix_f32 v167, v172, 1.0, v174 op_sel:[1,0,1] op_sel_hi:[1,0,1]
  v_cmp_u_f32 vcc, v27, v170
  v_fma_mix_f32 v169, v173, 1.0, v175 op_sel:[1,0,1] op_sel_hi:[1,0,1]
  v_fma_mix_f32 v171, v176, 1.0, v177 op_sel:[1,0,1] op_sel_hi:[1,0,1]
  v_max3_u32 v27, v124, v126, v128
  v_max3_u32 v27, v27, v130, v132
  v_max3_u32 v27, v27, v133, v134
  v_max3_u32 v27, v27, v135, v135
  v_cmp_eq_u32 vcc, -1, v27
  s_nop 1
  s_cbranch_vccnz sr_172
  s_branch sj_161
fx_163:
  s_cmp_eq_u32 s81, 1
  s_cbranch_scc1 fk_164
  s_mov_b32 s81, 1
  v_max3_f32 v164, v166, v167, v168
  v_max3_f32 v165, v169, v170, v171
  v_max_f32 v164, v164, v165
  s_nop 1
  v_max_f32_dpp v164, v164, v164 row_ror:8 row_mask:0xf bank_mask:0xf
  v_mov_b32 v165, v164
  s_nop 1
  v_permlane32_swap_b32 v164, v165
  v_max_f32 v164, v164, v165
  v_mov_b32 v165, v164
  s_nop 1
  v_permlane16_swap_b32 v164, v165
  v_max_f32 v164, v164, v165
  v_sub_f32 v166, v166, v164
  v_sub_f32 v167, v167, v164
  v_sub_f32 v168, v168, v164
  v_sub_f32 v169, v169, v164
  v_sub_f32 v170, v170, v164
  v_sub_f32 v171, v171, v164
  s_branch ex_162
p2_168:
  buffer_load_dwordx4 v[68:71], v16, s[4:7], s60 offen sc1
  s_waitcnt vmcnt(1)
  v_mfma_f32_16x16x32_f16 v[120:123], v[44:47], v[72:75], 0
  v_bitop3_b32 v27, v72, s61, 1 bitop3:0x28
  v_cmp_ne_u32 vcc, 0, v27
  s_nop 1
  s_cbranch_vccz pg_167
  buffer_load_dwordx4 v[72:75], v16, s[4:7], s60 offen sc1
  s_add_u32 s54, s54, 1
  s_cmp_gt_u32 s54, 131072
  s_cbranch_scc1 end0
  s_branch pp_166
last_158:
  v_smfmac_f32_16x16x64_bf16 v[96:99], v[48:51], a[0:7], v22
  v_smfmac_f32_16x16x64_bf16 v[100:103], v[48:51], a[80:87], v22
  v_smfmac_f32_16x16x64_bf16 v[96:99], v[52:55], a[8:15], v22
  v_smfmac_f32_16x16x64_bf16 v[100:103], v[52:55], a[88:95], v22
  v_smfmac_f32_16x16x64_bf16 v[96:99], v[56:59], a[16:23], v22
  v_smfmac_f32_16x16x64_bf16 v[100:103], v[56:59], a[96:103], v22
  v_smfmac_f32_16x16x64_bf16 v[96:99], v[60:63], a[24:31], v22
  v_smfmac_f32_16x16x64_bf16 v[96:99], v[64:67], a[32:39], v22
  v_smfmac_f32_16x16x64_bf16 v[96:99], v[68:71], a[40:47], v22
  v_smfmac_f32_16x16x64_bf16 v[96:99], v[72:75], a[48:55], v22
  v_smfmac_f32_16x16x64_bf16 v[96:99], v[76:79], a[56:63], v22
  v_smfmac_f32_16x16x64_bf16 v[96:99], v[80:83], a[64:71], v22
  v_smfmac_f32_16x16x64_bf16 v[96:99], v[84:87], a[72:79], v22
  v_smfmac_f32_16x16x64_bf16 v[100:103], v[60:63], a[104:111], v22
  v_smfmac_f32_16x16x64_bf16 v[100:103], v[64:67], a[112:119], v22
  v_smfmac_f32_16x16x64_bf16 v[100:103], v[68:71], a[120:127], v22
  v_smfmac_f32_16x16x64_bf16 v[100:103], v[72:75], a[128:135], v22
  v_smfmac_f32_16x16x64_bf16 v[100:103], v[76:79], a[136:143], v22
  v_smfmac_f32_16x16x64_bf16 v[100:103], v[80:83], a[144:151], v22
  v_smfmac_f32_16x16x64_bf16 v[100:103], v[84:87], a[152:159], v22
  s_nop 7
  v_permlane32_swap_b32 v96, v100
  v_permlane32_swap_b32 v97, v101
  v_permlane32_swap_b32 v98, v102
  v_permlane32_swap_b32 v99, v103
  v_pk_add_f32 v[96:97], v[96:97], v[100:101]
  v_pk_add_f32 v[98:99], v[98:99], v[102:103]
  v_cvt_pk_bf16_f32 v182, v96, v97
  v_cvt_pk_bf16_f32 v183, v98, v99
  v_min_u32 v182, -2, v182
  ds_write_b64 v26, v[182:183]
  s_waitcnt lgkmcnt(0)
  s_barrier
  s_branch chain_done
E_33:
  v_add_u32 v190, 9216, v4
  ds_read_b128 v[84:87], v4 offset:9216
  s_waitcnt lgkmcnt(0)
  s_branch mo_179
  .p2align 3
top_174:
  s_waitcnt vmcnt(0)
  ds_write_b128 v190, v[84:87] offset:0
  v_cmp_eq_u32 s[22:23], -1, v84
  s_or_b64 vcc, s[22:23], s[22:23]
  s_cbranch_scc1 mr_175
mo_179:
  s_waitcnt lgkmcnt(0)
  s_barrier
  ds_read_b128 v[48:51], v4 offset:0
  ds_read_b128 v[52:55], v4 offset:1024
  v_smfmac_f32_16x16x64_bf16 v[92:95], v[84:87], v[248:255], v22
  ds_read_b128 v[56:59], v4 offset:2048
  v_smfmac_f32_16x16x64_bf16 v[88:91], v[84:87], a[232:239], v22
  s_waitcnt lgkmcnt(2)
  ds_read_b128 v[60:63], v4 offset:3072
  v_smfmac_f32_16x16x64_bf16 v[92:95], v[48:51], a[240:247], v22
  ds_read_b128 v[64:67], v4 offset:4096
  v_smfmac_f32_16x16x64_bf16 v[88:91], v[48:51], a[160:167], v22
  s_waitcnt lgkmcnt(3)
  ds_read_b128 v[68:71], v4 offset:5120
  v_smfmac_f32_16x16x64_bf16 v[92:95], v[52:55], a[248:255], v22
  ds_read_b128 v[72:75], v4 offset:6144
  v_smfmac_f32_16x16x64_bf16 v[88:91], v[52:55], a[168:175], v22
  s_waitcnt lgkmcnt(4)
  ds_read_b128 v[76:79], v4 offset:7168
  v_smfmac_f32_16x16x64_bf16 v[92:95], v[56:59], v[192:199], v22
  ds_read_b128 v[80:83], v4 offset:8192
  v_smfmac_f32_16x16x64_bf16 v[88:91], v[56:59], a[176:183], v22
  s_waitcnt lgkmcnt(5)
  s_add_u32 m0, s74, 10240
  s_nop 0
  buffer_load_dwordx4 v4, s[16:19], s73 offen offset:0 sc1 lds
  v_smfmac_f32_16x16x64_bf16 v[92:95], v[60:63], v[200:207], v22
  s_waitcnt lgkmcnt(4)
  s_add_u32 m0, s74, 10240
  s_nop 0
  buffer_load_dwordx4 v4, s[16:19], s73 offen offset:1024 sc1 lds
  v_smfmac_f32_16x16x64_bf16 v[92:95], v[64:67], v[208:215], v22
  s_waitcnt lgkmcnt(3)
  s_add_u32 m0, s74, 10240
  s_nop 0
  buffer_load_dwordx4 v4, s[16:19], s73 offen offset:2048 sc1 lds
  v_smfmac_f32_16x16x64_bf16 v[92:95], v[68:71], v[216:223], v22
  s_waitcnt lgkmcnt(2)
  v_smfmac_f32_16x16x64_bf16 v[92:95], v[72:75], v[224:231], v22
  s_waitcnt lgkmcnt(1)
  v_smfmac_f32_16x16x64_bf16 v[92:95], v[76:79], v[232:239], v22
  s_waitcnt lgkmcnt(0)
  v_smfmac_f32_16x16x64_bf16 v[92:95], v[80:83], v[240:247], v22
  v_smfmac_f32_16x16x64_bf16 v[88:91], v[60:63], a[184:191], v22
  v_smfmac_f32_16x16x64_bf16 v[88:91], v[64:67], a[192:199], v22
  v_smfmac_f32_16x16x64_bf16 v[88:91], v[68:71], a[200:207], v22
  v_cvt_pk_bf16_f32 v122, v92, v93
  v_smfmac_f32_16x16x64_bf16 v[88:91], v[72:75], a[208:215], v22
  v_cvt_pk_bf16_f32 v123, v94, v95
  v_smfmac_f32_16x16x64_bf16 v[88:91], v[76:79], a[216:223], v22
  ds_write_b64 v12, v[122:123] offset:13056
  v_smfmac_f32_16x16x64_bf16 v[88:91], v[80:83], a[224:231], v22
  v_smfmac_f32_16x16x64_bf16 v[96:99], v[48:51], a[0:7], v22
  v_smfmac_f32_16x16x64_bf16 v[100:103], v[48:51], a[80:87], v22
  v_smfmac_f32_16x16x64_bf16 v[96:99], v[52:55], a[8:15], v22
  v_cvt_pk_bf16_f32 v120, v88, v89
  v_cvt_pk_bf16_f32 v121, v90, v91
  ds_write_b64 v12, v[120:121] offset:12544
  v_smfmac_f32_16x16x64_bf16 v[100:103], v[52:55], a[88:95], v22
  v_cmp_u_f32 vcc, v88, v89
  v_smfmac_f32_16x16x64_bf16 v[96:99], v[56:59], a[16:23], v22
  v_cmp_u_f32 s[22:23], v90, v91
  s_nop 0
  s_or_b64 vcc, vcc, s[22:23]
  s_cbranch_vccnz mn_176
mk_177:
  s_waitcnt lgkmcnt(0)
  s_barrier
  ds_read_b64_tr_b16 v[104:105], v7 offset:0
  ds_read_b64_tr_b16 v[106:107], v7 offset:768
  ds_read_b64_tr_b16 v[108:109], v7 offset:1536
  ds_read_b64 v[140:141], v11
  s_cmp_eq_u32 s52, 63
  s_cbranch_scc1 last_178
  s_add_u32 s22, s52, 3
  s_min_u32 s22, s22, 64
  v_cmp_gt_u32 vcc, s22, v42
  s_nop 1
  s_cbranch_vccnz kw_180
kv_181:
  v_smfmac_f32_16x16x64_bf16 v[100:103], v[56:59], a[96:103], v22
  v_smfmac_f32_16x16x64_bf16 v[96:99], v[60:63], a[24:31], v22
  v_smfmac_f32_16x16x64_bf16 v[96:99], v[64:67], a[32:39], v22
  v_smfmac_f32_16x16x64_bf16 v[96:99], v[68:71], a[40:47], v22
  v_smfmac_f32_16x16x64_bf16 v[96:99], v[72:75], a[48:55], v22
  v_smfmac_f32_16x16x64_bf16 v[96:99], v[76:79], a[56:63], v22
  v_smfmac_f32_16x16x64_bf16 v[96:99], v[80:83], a[64:71], v22
  v_smfmac_f32_16x16x64_bf16 v[96:99], v[84:87], a[72:79], v22
  v_smfmac_f32_16x16x64_bf16 v[100:103], v[60:63], a[104:111], v22
  v_smfmac_f32_16x16x64_bf16 v[100:103], v[64:67], a[112:119], v22
  v_smfmac_f32_16x16x64_bf16 v[100:103], v[68:71], a[120:127], v22
  v_smfmac_f32_16x16x64_bf16 v[100:103], v[72:75], a[128:135], v22
  v_cvt_pk_bf16_f32 v136, v96, v97
  v_smfmac_f32_16x16x64_bf16 v[100:103], v[76:79], a[136:143], v22
  v_cvt_pk_bf16_f32 v137, v98, v99
  v_smfmac_f32_16x16x64_bf16 v[100:103], v[80:83], a[144:151], v22
  v_smfmac_f32_16x16x64_bf16 v[100:103], v[84:87], a[152:159], v22
  s_sleep 3
  s_nop 3
  buffer_load_dwordx4 v[124:127], v9, s[8:11], s56 offen sc1
  buffer_load_dwordx4 v[128:131], v9, s[8:11], s56 offen offset:1024 sc1
  s_nop 5
  buffer_load_dwordx4 v[132:135], v10, s[8:11], s56 offen sc1
  s_waitcnt vmcnt(2)
  v_pk_add_f16 v172, v124, v126
  v_pk_add_f16 v173, v125, v127
  s_waitcnt vmcnt(1)
  v_pk_add_f16 v174, v128, v130
  v_pk_add_f16 v175, v129, v131
  v_fma_mix_f32 v166, v172, 1.0, v174 op_sel:[0,0,0] op_sel_hi:[1,0,1]
  v_fma_mix_f32 v168, v173, 1.0, v175 op_sel:[0,0,0] op_sel_hi:[1,0,1]
  s_waitcnt vmcnt(0)
  v_pk_add_f16 v176, v132, v133
  v_pk_add_f16 v177, v134, v135
  v_fma_mix_f32 v170, v176, 1.0, v177 op_sel:[0,0,0] op_sel_hi:[1,0,1]
  v_fma_mix_f32 v167, v172, 1.0, v174 op_sel:[1,0,1] op_sel_hi:[1,0,1]
  v_cmp_u_f32 vcc, v166, v170
  v_fma_mix_f32 v169, v173, 1.0, v175 op_sel:[1,0,1] op_sel_hi:[1,0,1]
  v_fma_mix_f32 v171, v176, 1.0, v177 op_sel:[1,0,1] op_sel_hi:[1,0,1]
  v_cvt_pk_bf16_f32 v138, v100, v101
  s_cbranch_vccnz sr_182
sj_183:
ex_184:
  v_exp_f32 v172, v166
  v_exp_f32 v173, v167
  v_exp_f32 v174, v168
  v_cvt_pk_bf16_f32 v156, v172, v173
  v_exp_f32 v175, v169
  v_exp_f32 v176, v170
  v_cvt_pk_bf16_f32 v157, v174, v175
  v_mov_b32_dpp v158, v156 row_ror:8 row_mask:0xf bank_mask:0xf
  v_exp_f32 v177, v171
  v_mov_b32_dpp v159, v157 row_ror:8 row_mask:0xf bank_mask:0xf
  v_cvt_pk_bf16_f32 v160, v176, v177
  v_cvt_pk_bf16_f32 v139, v102, v103
  v_mfma_f32_16x16x32_bf16 v[178:181], v[152:155], v[156:159], 0
  s_waitcnt lgkmcnt(0)
  v_mov_b32_dpp v161, v160 row_ror:8 row_mask:0xf bank_mask:0xf
  v_mfma_f32_16x16x32_bf16 v[182:185], v[144:147], v[156:159], 0
  s_nop 0
  v_mfma_f32_16x16x32_bf16 v[178:181], v[140:143], v[160:163], v[178:181]
  v_mfma_f32_16x16x32_bf16 v[182:185], v[136:139], v[160:163], v[182:185]
  v_mfma_f32_16x16x32_bf16 v[186:189], v[148:151], v[156:159], 0
  v_mfma_f32_16x16x32_bf16 v[186:189], v[138:141], v[160:163], v[186:189]
  s_mov_b64 exec, s[62:63]
  v_rcp_f32 v164, v180
  s_nop 0
  v_pk_mul_f32 v[178:179], v[178:179], v[164:165] op_sel_hi:[1,0]
  v_pk_mul_f32 v[182:183], v[182:183], v[164:165] op_sel_hi:[1,0]
  v_pk_mul_f32 v[184:185], v[184:185], v[164:165] op_sel_hi:[1,0]
  v_cvt_pk_f16_f32 v64, v178, v179
  v_cvt_pk_f16_f32 v60, v182, v183
  v_pk_mul_f32 v[186:187], v[186:187], v[164:165] op_sel_hi:[1,0]
  v_pk_mul_f32 v[188:189], v[188:189], v[164:165] op_sel_hi:[1,0]
  v_cvt_pk_f16_f32 v61, v184, v185
  v_cvt_pk_f16_f32 v62, v186, v187
  v_cvt_pk_f16_f32 v63, v188, v189
  ds_write_b128 v13, v[60:63]
  ds_write_b32 v14, v64
  v_add_f32 v165, v164, v180
  v_cmp_ngt_f32 vcc, s80, v165
  s_mov_b64 exec, -1
  s_nop 0
  s_cbranch_vccnz fx_185
fk_186:
  s_waitcnt lgkmcnt(0)
  s_barrier
  ds_read_b128 v[166:169], v4 offset:13824
  ds_read_b128 v[170:173], v4 offset:14464
  ds_read_b128 v[174:177], v4 offset:15104
  ds_read_b128 v[178:181], v4 offset:15744
  s_mov_b64 exec, s[66:67]
  s_waitcnt lgkmcnt(2)
  v_pk_add_f16 v166, v166, v170
  v_pk_add_f16 v167, v167, v171
  v_pk_add_f16 v168, v168, v172
  v_pk_add_f16 v169, v169, v173
  s_waitcnt lgkmcnt(1)
  v_pk_add_f16 v166, v166, v174
  v_pk_add_f16 v167, v167, v175
  v_pk_add_f16 v168, v168, v176
  v_pk_add_f16 v169, v169, v177
  s_waitcnt lgkmcnt(0)
  v_pk_add_f16 v166, v166, v178
  v_pk_add_f16 v167, v167, v179
  v_pk_add_f16 v168, v168, v180
  v_pk_add_f16 v169, v169, v181
  v_and_or_b32 v166, v166, -2, s61
  buffer_store_dwordx4 v[166:169], v15, s[4:7], s60 offen sc1
  s_mov_b64 exec, -1
  v_permlane32_swap_b32 v96, v100
  v_permlane32_swap_b32 v97, v101
  v_permlane32_swap_b32 v98, v102
  v_permlane32_swap_b32 v99, v103
  v_pk_add_f32 v[96:97], v[96:97], v[100:101]
  v_pk_add_f32 v[98:99], v[98:99], v[102:103]
  v_cvt_pk_bf16_f32 v182, v96, v97
  v_cvt_pk_bf16_f32 v183, v98, v99
  v_min_u32 v182, -2, v182
  ds_write_b64 v26, v[182:183]
  v_permlane32_swap_b32 v88, v92
  v_permlane32_swap_b32 v89, v93
  v_permlane32_swap_b32 v90, v94
  v_permlane32_swap_b32 v91, v95
  v_pk_add_f32 v[88:89], v[88:89], v[92:93]
  v_pk_add_f32 v[90:91], v[90:91], v[94:95]
  v_cvt_pk_bf16_f32 v184, v88, v89
  v_cvt_pk_bf16_f32 v185, v90, v91
  v_min_u32 v184, -2, v184
  ds_write_b64 v43, v[184:185]
  ds_read_b128 v[144:147], v18
  ds_read_b128 v[148:151], v18 offset:1024
  ds_read_b128 v[152:155], v19
  v_xor_b32 v18, 16384, v18
  v_xor_b32 v19, 16384, v19
  v_mov_b32 v88, 0
  v_mov_b32 v89, 0
  v_mov_b32 v90, 0
  v_mov_b32 v91, 0
  v_mov_b32 v92, 0
  v_mov_b32 v93, 0
  v_mov_b32 v94, 0
  v_mov_b32 v95, 0
  v_mov_b32 v96, 0
  v_mov_b32 v97, 0
  v_mov_b32 v98, 0
  v_mov_b32 v99, 0
  v_mov_b32 v100, 0
  v_mov_b32 v101, 0
  v_mov_b32 v102, 0
  v_mov_b32 v103, 0
  s_mov_b32 s81, 0
  s_waitcnt lgkmcnt(0)
  s_barrier
  s_add_u32 s72, s72, 1310720
  s_add_u32 s79, s79, 1310720
  s_add_u32 s73, s73, 393216
  s_xor_b32 s74, s74, 16384
  v_mov_b32 v28, s61
  v_mov_b32 v166, s52
  s_mov_b64 exec, 1
  buffer_store_dword v166, v23, s[12:15], s77 offen sc1
  s_mov_b64 exec, -1
  ds_read_b128 v[170:173], v4 offset:16384
  ds_read_b128 v[174:177], v4 offset:17408
  ds_read_b128 v[178:181], v4 offset:18432
  v_min_u32 v104, -2, v104
  v_min_u32 v106, -2, v106
  v_min_u32 v108, -2, v108
  s_mov_b64 exec, s[68:69]
  buffer_store_dwordx4 v[104:107], v36, s[24:27], s70 offen sc1
  buffer_store_dwordx2 v[108:109], v37, s[24:27], s70 offen sc1
  s_mov_b64 exec, -1
  s_waitcnt lgkmcnt(0)
  buffer_store_dwordx4 v[170:173], v38, s[36:39], s71 offen sc1
  buffer_store_dwordx4 v[174:177], v39, s[36:39], s71 offen sc1
  s_mov_b64 exec, 0xffffffff
  buffer_store_dwordx4 v[178:181], v40, s[36:39], s71 offen sc1
  s_mov_b64 exec, -1
  s_add_u32 s70, s70, 98304
  s_add_u32 s71, s71, 327680
  buffer_load_dword v42, v41, s[12:15], s76 offen sc1
nt_187:
  s_barrier
  s_mov_b32 s58, s55
  s_add_u32 s52, s52, 1
  s_and_b32 s21, s52, 3
  s_mul_i32 s56, s21, 122880
  s_add_u32 s21, s52, 1
  s_and_b32 s21, s21, 3
  s_mul_i32 s55, s21, 122880
  s_add_u32 s55, s55, s75
  s_add_u32 s21, s52, 2
  s_and_b32 s21, s21, 3
  s_mul_i32 s57, s21, 122880
  s_add_u32 s21, s52, 3
  s_and_b32 s21, s21, 3
  s_mul_i32 s59, s21, 122880
  s_add_u32 s59, s59, s75
  s_bfe_u32 s61, s52, 0x10001
  s_and_b32 s21, s52, 1
  s_lshl_b32 s60, s21, 19
  s_mov_b32 s54, 0
  s_sleep 3
  s_nop 2
  buffer_load_dwordx4 v[84:87], v190, s[8:11], s58 offen offset:0 sc1
  s_branch top_174
mr_175:
  s_mov_b64 exec, s[22:23]
  s_cbranch_execz ms_188
  buffer_load_dwordx4 v[84:87], v190, s[8:11], s58 offen offset:0 sc1
ms_188:
  s_add_u32 s54, s54, 1
  s_cmp_gt_u32 s54, 131072
  s_cbranch_scc1 end0
  s_waitcnt vmcnt(0)
  s_mov_b64 exec, s[22:23]
  ds_write_b128 v190, v[84:87] offset:0
  v_cmp_eq_u32 s[22:23], -1, v84
  s_mov_b64 exec, -1
  s_or_b64 vcc, s[22:23], s[22:23]
  s_cbranch_scc1 mr_175
  s_branch mo_179
mn_176:
  v_max3_u32 v27, v48, v49, v50
  v_max3_u32 v27, v27, v51, v52
  v_max3_u32 v27, v27, v53, v54
  v_max3_u32 v27, v27, v55, v56
  v_max3_u32 v27, v27, v57, v58
  v_max3_u32 v27, v27, v59, v60
  v_max3_u32 v27, v27, v61, v62
  v_max3_u32 v27, v27, v63, v64
  v_max3_u32 v27, v27, v65, v66
  v_max3_u32 v27, v27, v67, v68
  v_max3_u32 v27, v27, v69, v70
  v_max3_u32 v27, v27, v71, v72
  v_max3_u32 v27, v27, v73, v74
  v_max3_u32 v27, v27, v75, v76
  v_max3_u32 v27, v27, v77, v78
  v_max3_u32 v27, v27, v79, v80
  v_max3_u32 v27, v27, v81, v82
  v_max3_u32 v27, v27, v83, v84
  v_max3_u32 v27, v27, v85, v86
  v_max3_u32 v27, v27, v87, v87
  v_cmp_eq_u32 vcc, -1, v27
  s_cmp_eq_u32 s52, 0
  s_cbranch_scc1 mk_177
  s_cbranch_vccz mk_177
  s_waitcnt lgkmcnt(0)
  s_barrier
  s_nop 7
  v_mov_b32 v88, 0
  v_mov_b32 v89, 0
  v_mov_b32 v90, 0
  v_mov_b32 v91, 0
  v_mov_b32 v92, 0
  v_mov_b32 v93, 0
  v_mov_b32 v94, 0
  v_mov_b32 v95, 0
  v_mov_b32 v96, 0
  v_mov_b32 v97, 0
  v_mov_b32 v98, 0
  v_mov_b32 v99, 0
  v_mov_b32 v100, 0
  v_mov_b32 v101, 0
  v_mov_b32 v102, 0
  v_mov_b32 v103, 0
  s_mov_b64 s[22:23], -1
  s_branch mr_175
kw_180:
  s_mov_b32 s101, 0
wm_189:
  buffer_load_dword v42, v41, s[12:15], s76 offen sc1
  s_add_u32 s101, s101, 1
  s_cmp_gt_u32 s101, 131072
  s_cbranch_scc1 end0
  s_waitcnt vmcnt(0)
  v_cmp_gt_u32 vcc, s22, v42
  v_readfirstlane_b32 s100, v42
  s_nop 0
  s_cbranch_vccz wm_190
  s_sleep 1
  s_branch wm_189
wm_190:
  s_branch kv_181
sr_182:
  s_mov_b32 s54, 0
sr_191:
  s_mov_b64 exec, vcc
  buffer_load_dwordx4 v[124:127], v9, s[8:11], s56 offen sc1
  buffer_load_dwordx4 v[128:131], v9, s[8:11], s56 offen offset:1024 sc1
  buffer_load_dwordx4 v[132:135], v10, s[8:11], s56 offen sc1
  s_mov_b64 exec, -1
  s_add_u32 s54, s54, 1
  s_cmp_gt_u32 s54, 131072
  s_cbranch_scc1 end0
  s_and_b32 s21, s54, 31
  s_cbranch_scc0 sr_192
  s_waitcnt vmcnt(0)
  v_pk_add_f16 v172, v124, v126
  v_pk_add_f16 v173, v125, v127
  v_pk_add_f16 v174, v128, v130
  v_pk_add_f16 v175, v129, v131
  v_fma_mix_f32 v166, v172, 1.0, v174 op_sel:[0,0,0] op_sel_hi:[1,0,1]
  v_fma_mix_f32 v168, v173, 1.0, v175 op_sel:[0,0,0] op_sel_hi:[1,0,1]
  v_pk_add_f16 v176, v132, v133
  v_pk_add_f16 v177, v134, v135
  v_add_f32 v27, v166, v168
  v_fma_mix_f32 v170, v176, 1.0, v177 op_sel:[0,0,0] op_sel_hi:[1,0,1]
  v_fma_mix_f32 v167, v172, 1.0, v174 op_sel:[1,0,1] op_sel_hi:[1,0,1]
  v_cmp_u_f32 vcc, v27, v170
  v_fma_mix_f32 v169, v173, 1.0, v175 op_sel:[1,0,1] op_sel_hi:[1,0,1]
  v_fma_mix_f32 v171, v176, 1.0, v177 op_sel:[1,0,1] op_sel_hi:[1,0,1]
  s_cbranch_vccnz sr_191
  s_branch sj_183
sr_192:
  s_waitcnt vmcnt(0)
  v_pk_add_f16 v172, v124, v126
  v_pk_add_f16 v173, v125, v127
  v_pk_add_f16 v174, v128, v130
  v_pk_add_f16 v175, v129, v131
  v_fma_mix_f32 v166, v172, 1.0, v174 op_sel:[0,0,0] op_sel_hi:[1,0,1]
  v_fma_mix_f32 v168, v173, 1.0, v175 op_sel:[0,0,0] op_sel_hi:[1,0,1]
  v_pk_add_f16 v176, v132, v133
  v_pk_add_f16 v177, v134, v135
  v_add_f32 v27, v166, v168
  v_fma_mix_f32 v170, v176, 1.0, v177 op_sel:[0,0,0] op_sel_hi:[1,0,1]
  v_fma_mix_f32 v167, v172, 1.0, v174 op_sel:[1,0,1] op_sel_hi:[1,0,1]
  v_cmp_u_f32 vcc, v27, v170
  v_fma_mix_f32 v169, v173, 1.0, v175 op_sel:[1,0,1] op_sel_hi:[1,0,1]
  v_fma_mix_f32 v171, v176, 1.0, v177 op_sel:[1,0,1] op_sel_hi:[1,0,1]
  v_max3_u32 v27, v124, v126, v128
  v_max3_u32 v27, v27, v130, v132
  v_max3_u32 v27, v27, v133, v134
  v_max3_u32 v27, v27, v135, v135
  v_cmp_eq_u32 vcc, -1, v27
  s_nop 1
  s_cbranch_vccnz sr_191
  s_branch sj_183
fx_185:
  s_cmp_eq_u32 s81, 1
  s_cbranch_scc1 fk_186
  s_mov_b32 s81, 1
  v_max3_f32 v164, v166, v167, v168
  v_max3_f32 v165, v169, v170, v171
  v_max_f32 v164, v164, v165
  s_nop 1
  v_max_f32_dpp v164, v164, v164 row_ror:8 row_mask:0xf bank_mask:0xf
  v_mov_b32 v165, v164
  s_nop 1
  v_permlane32_swap_b32 v164, v165
  v_max_f32 v164, v164, v165
  v_mov_b32 v165, v164
  s_nop 1
  v_permlane16_swap_b32 v164, v165
  v_max_f32 v164, v164, v165
  v_sub_f32 v166, v166, v164
  v_sub_f32 v167, v167, v164
  v_sub_f32 v168, v168, v164
  v_sub_f32 v169, v169, v164
  v_sub_f32 v170, v170, v164
  v_sub_f32 v171, v171, v164
  s_branch ex_184
last_178:
  v_smfmac_f32_16x16x64_bf16 v[100:103], v[56:59], a[96:103], v22
  v_smfmac_f32_16x16x64_bf16 v[96:99], v[60:63], a[24:31], v22
  v_smfmac_f32_16x16x64_bf16 v[96:99], v[64:67], a[32:39], v22
  v_smfmac_f32_16x16x64_bf16 v[96:99], v[68:71], a[40:47], v22
  v_smfmac_f32_16x16x64_bf16 v[96:99], v[72:75], a[48:55], v22
  v_smfmac_f32_16x16x64_bf16 v[96:99], v[76:79], a[56:63], v22
  v_smfmac_f32_16x16x64_bf16 v[96:99], v[80:83], a[64:71], v22
  v_smfmac_f32_16x16x64_bf16 v[96:99], v[84:87], a[72:79], v22
  v_smfmac_f32_16x16x64_bf16 v[100:103], v[60:63], a[104:111], v22
  v_smfmac_f32_16x16x64_bf16 v[100:103], v[64:67], a[112:119], v22
  v_smfmac_f32_16x16x64_bf16 v[100:103], v[68:71], a[120:127], v22
  v_smfmac_f32_16x16x64_bf16 v[100:103], v[72:75], a[128:135], v22
  v_smfmac_f32_16x16x64_bf16 v[100:103], v[76:79], a[136:143], v22
  v_smfmac_f32_16x16x64_bf16 v[100:103], v[80:83], a[144:151], v22
  v_smfmac_f32_16x16x64_bf16 v[100:103], v[84:87], a[152:159], v22
  s_nop 7
  v_permlane32_swap_b32 v96, v100
  v_permlane32_swap_b32 v97, v101
  v_permlane32_swap_b32 v98, v102
  v_permlane32_swap_b32 v99, v103
  v_pk_add_f32 v[96:97], v[96:97], v[100:101]
  v_pk_add_f32 v[98:99], v[98:99], v[102:103]
  v_cvt_pk_bf16_f32 v182, v96, v97
  v_cvt_pk_bf16_f32 v183, v98, v99
  v_min_u32 v182, -2, v182
  ds_write_b64 v26, v[182:183]
  v_permlane32_swap_b32 v88, v92
  v_permlane32_swap_b32 v89, v93
  v_permlane32_swap_b32 v90, v94
  v_permlane32_swap_b32 v91, v95
  v_pk_add_f32 v[88:89], v[88:89], v[92:93]
  v_pk_add_f32 v[90:91], v[90:91], v[94:95]
  v_cvt_pk_bf16_f32 v184, v88, v89
  v_cvt_pk_bf16_f32 v185, v90, v91
  v_min_u32 v184, -2, v184
  ds_write_b64 v43, v[184:185]
  s_waitcnt lgkmcnt(0)
  s_barrier
  ds_read_b128 v[170:173], v4 offset:16384
  ds_read_b128 v[174:177], v4 offset:17408
  ds_read_b128 v[178:181], v4 offset:18432
  v_min_u32 v104, -2, v104
  v_min_u32 v106, -2, v106
  v_min_u32 v108, -2, v108
  s_mov_b64 exec, s[68:69]
  buffer_store_dwordx4 v[104:107], v36, s[24:27], s70 offen sc1
  buffer_store_dwordx2 v[108:109], v37, s[24:27], s70 offen sc1
  s_mov_b64 exec, -1
  s_waitcnt lgkmcnt(0)
  buffer_store_dwordx4 v[170:173], v38, s[36:39], s71 offen sc1
  buffer_store_dwordx4 v[174:177], v39, s[36:39], s71 offen sc1
  s_mov_b64 exec, 0xffffffff
  buffer_store_dwordx4 v[178:181], v40, s[36:39], s71 offen sc1
  s_mov_b64 exec, -1
  s_add_u32 s70, s70, 98304
  s_add_u32 s71, s71, 327680
  s_waitcnt vmcnt(0)
  v_mov_b32 v166, 64
  s_mov_b64 exec, 1
  buffer_store_dword v166, v23, s[12:15], s77 offen sc1
  s_mov_b64 exec, -1
  s_branch chain_done
chain_done:
end0:
  s_endpgm
gemm_side:
  s_bfe_u32 s23, s22, 0x20005
  s_add_u32 s22, s22, 31
  s_and_b32 s22, s22, 31
  s_lshl_b32 s21, s23, 3
  s_add_u32 s2, s21, s22
  s_add_u32 s3, s2, 72
  s_add_u32 s24, s2, 48
  s_add_u32 s2, s2, s21
  s_cmp_lt_u32 s22, 24
  s_cselect_b32 s3, s24, s3
  s_cmp_lt_u32 s22, 16
  s_cselect_b32 s3, s2, s3
  s_mov_b32 s2, s3
  s_cmp_ge_u32 s3, 64
  s_cbranch_scc1 not_kv
  s_load_dwordx2 s[4:5], s[0:1], 0
  s_load_dwordx2 s[6:7], s[0:1], 24
  s_load_dwordx2 s[36:37], s[0:1], 32
  s_load_dwordx2 s[38:39], s[0:1], 104
  s_and_b32 s43, s3, 1
  s_bfe_u32 s42, s3, 0x50001
  s_lshr_b32 s40, s42, 2
  s_waitcnt lgkmcnt(0)
  s_cmp_eq_u32 s43, 1
  s_cselect_b32 s6, s36, s6
  s_cselect_b32 s7, s37, s7
  s_mov_b32 s8, s4
  s_mov_b32 s9, s5
  s_mov_b32 s10, 2621440
  s_mov_b32 s11, 0x00020000
  s_mov_b32 s12, s6
  s_mov_b32 s13, s7
  s_mov_b32 s14, 7864320
  s_mov_b32 s15, 0x00020000
  s_mov_b32 s16, s38
  s_mov_b32 s17, s39
  s_mov_b32 s18, 50331648
  s_mov_b32 s19, 0x00020000
  s_add_u32 s72, s38, 81068032
  s_addc_u32 s73, s39, 0
  s_mov_b32 s74, 96768
  s_mov_b32 s75, 0x00020000
  s_mul_i32 s44, s42, 384
  s_mov_b32 s30, 0
  s_mov_b32 s25, 80768
  v_lshrrev_b32 v4, 3, v1
  v_and_b32 v5, 7, v1
  v_xor_b32 v5, v5, v4
  s_mul_i32 s21, s20, 16
  v_add_u32 v4, s21, v4
  v_mul_u32_u24 v4, 1280, v4
  v_lshl_add_u32 v10, v5, 4, v4
  s_mul_i32 s31, s20, 2048
  v_add_u32 v11, 10240, v10
  v_mov_b32 v9, 2731
  v_add_u32 v8, 0, v1
  v_mul_u32_u24 v7, v8, v9
  v_lshrrev_b32 v7, 16, v7
  v_mul_u32_u24 v4, 24, v7
  v_sub_u32 v8, v8, v4
  s_mov_b32 s21, 12288
  v_mul_lo_u32 v7, v7, s21
  v_lshl_add_u32 v4, v8, 4, v7
  v_add_u32 v8, 64, v1
  v_mul_u32_u24 v7, v8, v9
  v_lshrrev_b32 v7, 16, v7
  v_mul_u32_u24 v5, 24, v7
  v_sub_u32 v8, v8, v5
  s_mov_b32 s21, 12288
  v_mul_lo_u32 v7, v7, s21
  v_lshl_add_u32 v5, v8, 4, v7
  v_add_u32 v8, 128, v1
  v_mul_u32_u24 v7, v8, v9
  v_lshrrev_b32 v7, 16, v7
  v_mul_u32_u24 v6, 24, v7
  v_sub_u32 v8, v8, v6
  s_mov_b32 s21, 12288
  v_mul_lo_u32 v7, v7, s21
  v_lshl_add_u32 v6, v8, 4, v7
  v_lshrrev_b32 v7, 2, v2
  v_lshl_add_u32 v7, v3, 3, v7
  v_mul_u32_u24 v7, 384, v7
  v_and_b32 v8, 3, v2
  v_lshlrev_b32 v8, 3, v8
  s_mul_i32 s21, s20, 96
  v_add3_u32 v7, v7, v8, s21
  v_add_u32 v8, 49152, v7
  s_mul_i32 s21, s20, 393216
  s_add_u32 s21, s21, 0
  s_add_u32 s21, s21, s44
  s_mul_i32 s22, s20, 12288
  s_add_u32 s22, s22, 0
  s_add_u32 m0, s22, 0
  s_nop 0
  buffer_load_dwordx4 v4, s[12:15], s21 offen lds
  s_add_u32 m0, s22, 1024
  s_nop 0
  buffer_load_dwordx4 v5, s[12:15], s21 offen lds
  s_add_u32 m0, s22, 2048
  s_nop 0
  buffer_load_dwordx4 v6, s[12:15], s21 offen lds
  s_mul_i32 s21, s20, 393216
  s_add_u32 s21, s21, 98304
  s_add_u32 s21, s21, s44
  s_mul_i32 s22, s20, 12288
  s_add_u32 s22, s22, 3072
  s_add_u32 m0, s22, 0
  s_nop 0
  buffer_load_dwordx4 v4, s[12:15], s21 offen lds
  s_add_u32 m0, s22, 1024
  s_nop 0
  buffer_load_dwordx4 v5, s[12:15], s21 offen lds
  s_add_u32 m0, s22, 2048
  s_nop 0
  buffer_load_dwordx4 v6, s[12:15], s21 offen lds
  s_mul_i32 s21, s20, 393216
  s_add_u32 s21, s21, 196608
  s_add_u32 s21, s21, s44
  s_mul_i32 s22, s20, 12288
  s_add_u32 s22, s22, 6144
  s_add_u32 m0, s22, 0
  s_nop 0
  buffer_load_dwordx4 v4, s[12:15], s21 offen lds
  s_add_u32 m0, s22, 1024
  s_nop 0
  buffer_load_dwordx4 v5, s[12:15], s21 offen lds
  s_add_u32 m0, s22, 2048
  s_nop 0
  buffer_load_dwordx4 v6, s[12:15], s21 offen lds
  s_mul_i32 s21, s20, 393216
  s_add_u32 s21, s21, 294912
  s_add_u32 s21, s21, s44
  s_mul_i32 s22, s20, 12288
  s_add_u32 s22, s22, 9216
  s_add_u32 m0, s22, 0
  s_nop 0
  buffer_load_dwordx4 v4, s[12:15], s21 offen lds
  s_add_u32 m0, s22, 1024
  s_nop 0
  buffer_load_dwordx4 v5, s[12:15], s21 offen lds
  s_add_u32 m0, s22, 2048
  s_nop 0
  buffer_load_dwordx4 v6, s[12:15], s21 offen lds
  s_add_u32 m0, s31, 98304
  s_nop 0
  buffer_load_dwordx4 v10, s[8:11], s30 offen lds
  s_add_u32 m0, s31, 99328
  s_nop 0
  buffer_load_dwordx4 v11, s[8:11], s30 offen lds
  s_add_u32 s30, s30, 128
  s_add_u32 m0, s31, 106496
  s_nop 0
  buffer_load_dwordx4 v10, s[8:11], s30 offen lds
  s_add_u32 m0, s31, 107520
  s_nop 0
  buffer_load_dwordx4 v11, s[8:11], s30 offen lds
  s_add_u32 s30, s30, 128
  s_add_u32 m0, s31, 114688
  s_nop 0
  buffer_load_dwordx4 v10, s[8:11], s30 offen lds
  s_add_u32 m0, s31, 115712
  s_nop 0
  buffer_load_dwordx4 v11, s[8:11], s30 offen lds
  s_add_u32 s30, s30, 128
  s_mul_i32 s21, s20, 393216
  s_add_u32 s21, s21, 1572864
  s_add_u32 s21, s21, s44
  s_mul_i32 s22, s20, 12288
  s_add_u32 s22, s22, 49152
  s_add_u32 m0, s22, 0
  s_nop 0
  buffer_load_dwordx4 v4, s[12:15], s21 offen lds
  s_add_u32 m0, s22, 1024
  s_nop 0
  buffer_load_dwordx4 v5, s[12:15], s21 offen lds
  s_add_u32 m0, s22, 2048
  s_nop 0
  buffer_load_dwordx4 v6, s[12:15], s21 offen lds
  s_mul_i32 s21, s20, 393216
  s_add_u32 s21, s21, 1671168
  s_add_u32 s21, s21, s44
  s_mul_i32 s22, s20, 12288
  s_add_u32 s22, s22, 52224
  s_add_u32 m0, s22, 0
  s_nop 0
  buffer_load_dwordx4 v4, s[12:15], s21 offen lds
  s_add_u32 m0, s22, 1024
  s_nop 0
  buffer_load_dwordx4 v5, s[12:15], s21 offen lds
  s_add_u32 m0, s22, 2048
  s_nop 0
  buffer_load_dwordx4 v6, s[12:15], s21 offen lds
  s_mul_i32 s21, s20, 393216
  s_add_u32 s21, s21, 1769472
  s_add_u32 s21, s21, s44
  s_mul_i32 s22, s20, 12288
  s_add_u32 s22, s22, 55296
  s_add_u32 m0, s22, 0
  s_nop 0
  buffer_load_dwordx4 v4, s[12:15], s21 offen lds
  s_add_u32 m0, s22, 1024
  s_nop 0
  buffer_load_dwordx4 v5, s[12:15], s21 offen lds
  s_add_u32 m0, s22, 2048
  s_nop 0
  buffer_load_dwordx4 v6, s[12:15], s21 offen lds
  s_mul_i32 s21, s20, 393216
  s_add_u32 s21, s21, 1867776
  s_add_u32 s21, s21, s44
  s_mul_i32 s22, s20, 12288
  s_add_u32 s22, s22, 58368
  s_add_u32 m0, s22, 0
  s_nop 0
  buffer_load_dwordx4 v4, s[12:15], s21 offen lds
  s_add_u32 m0, s22, 1024
  s_nop 0
  buffer_load_dwordx4 v5, s[12:15], s21 offen lds
  s_add_u32 m0, s22, 2048
  s_nop 0
  buffer_load_dwordx4 v6, s[12:15], s21 offen lds
  s_waitcnt vmcnt(12)
  s_barrier
  ds_read_b64_tr_b16 a[0:1], v7 offset:0
  ds_read_b64_tr_b16 a[2:3], v7 offset:1536
  ds_read_b64_tr_b16 a[4:5], v7 offset:32
  ds_read_b64_tr_b16 a[6:7], v7 offset:1568
  ds_read_b64_tr_b16 a[8:9], v7 offset:64
  ds_read_b64_tr_b16 a[10:11], v7 offset:1600
  ds_read_b64_tr_b16 a[12:13], v7 offset:12288
  ds_read_b64_tr_b16 a[14:15], v7 offset:13824
  ds_read_b64_tr_b16 a[16:17], v7 offset:12320
  ds_read_b64_tr_b16 a[18:19], v7 offset:13856
  ds_read_b64_tr_b16 a[20:21], v7 offset:12352
  ds_read_b64_tr_b16 a[22:23], v7 offset:13888
  ds_read_b64_tr_b16 a[24:25], v7 offset:24576
  ds_read_b64_tr_b16 a[26:27], v7 offset:26112
  ds_read_b64_tr_b16 a[28:29], v7 offset:24608
  ds_read_b64_tr_b16 a[30:31], v7 offset:26144
  ds_read_b64_tr_b16 a[32:33], v7 offset:24640
  ds_read_b64_tr_b16 a[34:35], v7 offset:26176
  ds_read_b64_tr_b16 a[36:37], v7 offset:36864
  ds_read_b64_tr_b16 a[38:39], v7 offset:38400
  ds_read_b64_tr_b16 a[40:41], v7 offset:36896
  ds_read_b64_tr_b16 a[42:43], v7 offset:38432
  ds_read_b64_tr_b16 a[44:45], v7 offset:36928
  ds_read_b64_tr_b16 a[46:47], v7 offset:38464
  s_waitcnt lgkmcnt(0)
  s_barrier
  s_mul_i32 s21, s20, 393216
  s_add_u32 s21, s21, 3145728
  s_add_u32 s21, s21, s44
  s_mul_i32 s22, s20, 12288
  s_add_u32 s22, s22, 0
  s_add_u32 m0, s22, 0
  s_nop 0
  buffer_load_dwordx4 v4, s[12:15], s21 offen lds
  s_add_u32 m0, s22, 1024
  s_nop 0
  buffer_load_dwordx4 v5, s[12:15], s21 offen lds
  s_add_u32 m0, s22, 2048
  s_nop 0
  buffer_load_dwordx4 v6, s[12:15], s21 offen lds
  s_mul_i32 s21, s20, 393216
  s_add_u32 s21, s21, 3244032
  s_add_u32 s21, s21, s44
  s_mul_i32 s22, s20, 12288
  s_add_u32 s22, s22, 3072
  s_add_u32 m0, s22, 0
  s_nop 0
  buffer_load_dwordx4 v4, s[12:15], s21 offen lds
  s_add_u32 m0, s22, 1024
  s_nop 0
  buffer_load_dwordx4 v5, s[12:15], s21 offen lds
  s_add_u32 m0, s22, 2048
  s_nop 0
  buffer_load_dwordx4 v6, s[12:15], s21 offen lds
  s_mul_i32 s21, s20, 393216
  s_add_u32 s21, s21, 3342336
  s_add_u32 s21, s21, s44
  s_mul_i32 s22, s20, 12288
  s_add_u32 s22, s22, 6144
  s_add_u32 m0, s22, 0
  s_nop 0
  buffer_load_dwordx4 v4, s[12:15], s21 offen lds
  s_add_u32 m0, s22, 1024
  s_nop 0
  buffer_load_dwordx4 v5, s[12:15], s21 offen lds
  s_add_u32 m0, s22, 2048
  s_nop 0
  buffer_load_dwordx4 v6, s[12:15], s21 offen lds
  s_mul_i32 s21, s20, 393216
  s_add_u32 s21, s21, 3440640
  s_add_u32 s21, s21, s44
  s_mul_i32 s22, s20, 12288
  s_add_u32 s22, s22, 9216
  s_add_u32 m0, s22, 0
  s_nop 0
  buffer_load_dwordx4 v4, s[12:15], s21 offen lds
  s_add_u32 m0, s22, 1024
  s_nop 0
  buffer_load_dwordx4 v5, s[12:15], s21 offen lds
  s_add_u32 m0, s22, 2048
  s_nop 0
  buffer_load_dwordx4 v6, s[12:15], s21 offen lds
  s_waitcnt vmcnt(12)
  s_barrier
  ds_read_b64_tr_b16 a[48:49], v8 offset:0
  ds_read_b64_tr_b16 a[50:51], v8 offset:1536
  ds_read_b64_tr_b16 a[52:53], v8 offset:32
  ds_read_b64_tr_b16 a[54:55], v8 offset:1568
  ds_read_b64_tr_b16 a[56:57], v8 offset:64
  ds_read_b64_tr_b16 a[58:59], v8 offset:1600
  ds_read_b64_tr_b16 a[60:61], v8 offset:12288
  ds_read_b64_tr_b16 a[62:63], v8 offset:13824
  ds_read_b64_tr_b16 a[64:65], v8 offset:12320
  ds_read_b64_tr_b16 a[66:67], v8 offset:13856
  ds_read_b64_tr_b16 a[68:69], v8 offset:12352
  ds_read_b64_tr_b16 a[70:71], v8 offset:13888
  ds_read_b64_tr_b16 a[72:73], v8 offset:24576
  ds_read_b64_tr_b16 a[74:75], v8 offset:26112
  ds_read_b64_tr_b16 a[76:77], v8 offset:24608
  ds_read_b64_tr_b16 a[78:79], v8 offset:26144
  ds_read_b64_tr_b16 a[80:81], v8 offset:24640
  ds_read_b64_tr_b16 a[82:83], v8 offset:26176
  ds_read_b64_tr_b16 a[84:85], v8 offset:36864
  ds_read_b64_tr_b16 a[86:87], v8 offset:38400
  ds_read_b64_tr_b16 a[88:89], v8 offset:36896
  ds_read_b64_tr_b16 a[90:91], v8 offset:38432
  ds_read_b64_tr_b16 a[92:93], v8 offset:36928
  ds_read_b64_tr_b16 a[94:95], v8 offset:38464
  s_waitcnt lgkmcnt(0)
  s_barrier
  s_mul_i32 s21, s20, 393216
  s_add_u32 s21, s21, 4718592
  s_add_u32 s21, s21, s44
  s_mul_i32 s22, s20, 12288
  s_add_u32 s22, s22, 49152
  s_add_u32 m0, s22, 0
  s_nop 0
  buffer_load_dwordx4 v4, s[12:15], s21 offen lds
  s_add_u32 m0, s22, 1024
  s_nop 0
  buffer_load_dwordx4 v5, s[12:15], s21 offen lds
  s_add_u32 m0, s22, 2048
  s_nop 0
  buffer_load_dwordx4 v6, s[12:15], s21 offen lds
  s_mul_i32 s21, s20, 393216
  s_add_u32 s21, s21, 4816896
  s_add_u32 s21, s21, s44
  s_mul_i32 s22, s20, 12288
  s_add_u32 s22, s22, 52224
  s_add_u32 m0, s22, 0
  s_nop 0
  buffer_load_dwordx4 v4, s[12:15], s21 offen lds
  s_add_u32 m0, s22, 1024
  s_nop 0
  buffer_load_dwordx4 v5, s[12:15], s21 offen lds
  s_add_u32 m0, s22, 2048
  s_nop 0
  buffer_load_dwordx4 v6, s[12:15], s21 offen lds
  s_mul_i32 s21, s20, 393216
  s_add_u32 s21, s21, 4915200
  s_add_u32 s21, s21, s44
  s_mul_i32 s22, s20, 12288
  s_add_u32 s22, s22, 55296
  s_add_u32 m0, s22, 0
  s_nop 0
  buffer_load_dwordx4 v4, s[12:15], s21 offen lds
  s_add_u32 m0, s22, 1024
  s_nop 0
  buffer_load_dwordx4 v5, s[12:15], s21 offen lds
  s_add_u32 m0, s22, 2048
  s_nop 0
  buffer_load_dwordx4 v6, s[12:15], s21 offen lds
  s_mul_i32 s21, s20, 393216
  s_add_u32 s21, s21, 5013504
  s_add_u32 s21, s21, s44
  s_mul_i32 s22, s20, 12288
  s_add_u32 s22, s22, 58368
  s_add_u32 m0, s22, 0
  s_nop 0
  buffer_load_dwordx4 v4, s[12:15], s21 offen lds
  s_add_u32 m0, s22, 1024
  s_nop 0
  buffer_load_dwordx4 v5, s[12:15], s21 offen lds
  s_add_u32 m0, s22, 2048
  s_nop 0
  buffer_load_dwordx4 v6, s[12:15], s21 offen lds
  v_mov_b32 v29, 76
  buffer_load_dword v29, v29, s[32:35], 0 offen sc1
  s_waitcnt vmcnt(12)
  s_barrier
  ds_read_b64_tr_b16 a[96:97], v7 offset:0
  ds_read_b64_tr_b16 a[98:99], v7 offset:1536
  ds_read_b64_tr_b16 a[100:101], v7 offset:32
  ds_read_b64_tr_b16 a[102:103], v7 offset:1568
  ds_read_b64_tr_b16 a[104:105], v7 offset:64
  ds_read_b64_tr_b16 a[106:107], v7 offset:1600
  ds_read_b64_tr_b16 a[108:109], v7 offset:12288
  ds_read_b64_tr_b16 a[110:111], v7 offset:13824
  ds_read_b64_tr_b16 a[112:113], v7 offset:12320
  ds_read_b64_tr_b16 a[114:115], v7 offset:13856
  ds_read_b64_tr_b16 a[116:117], v7 offset:12352
  ds_read_b64_tr_b16 a[118:119], v7 offset:13888
  ds_read_b64_tr_b16 a[120:121], v7 offset:24576
  ds_read_b64_tr_b16 a[122:123], v7 offset:26112
  ds_read_b64_tr_b16 a[124:125], v7 offset:24608
  ds_read_b64_tr_b16 a[126:127], v7 offset:26144
  ds_read_b64_tr_b16 a[128:129], v7 offset:24640
  ds_read_b64_tr_b16 a[130:131], v7 offset:26176
  ds_read_b64_tr_b16 a[132:133], v7 offset:36864
  ds_read_b64_tr_b16 a[134:135], v7 offset:38400
  ds_read_b64_tr_b16 a[136:137], v7 offset:36896
  ds_read_b64_tr_b16 a[138:139], v7 offset:38432
  ds_read_b64_tr_b16 a[140:141], v7 offset:36928
  ds_read_b64_tr_b16 a[142:143], v7 offset:38464
  s_waitcnt lgkmcnt(0)
  s_barrier
  s_mul_i32 s21, s20, 393216
  s_add_u32 s21, s21, 6291456
  s_add_u32 s21, s21, s44
  s_mul_i32 s22, s20, 12288
  s_add_u32 s22, s22, 0
  s_add_u32 m0, s22, 0
  s_nop 0
  buffer_load_dwordx4 v4, s[12:15], s21 offen lds
  s_add_u32 m0, s22, 1024
  s_nop 0
  buffer_load_dwordx4 v5, s[12:15], s21 offen lds
  s_add_u32 m0, s22, 2048
  s_nop 0
  buffer_load_dwordx4 v6, s[12:15], s21 offen lds
  s_mul_i32 s21, s20, 393216
  s_add_u32 s21, s21, 6389760
  s_add_u32 s21, s21, s44
  s_mul_i32 s22, s20, 12288
  s_add_u32 s22, s22, 3072
  s_add_u32 m0, s22, 0
  s_nop 0
  buffer_load_dwordx4 v4, s[12:15], s21 offen lds
  s_add_u32 m0, s22, 1024
  s_nop 0
  buffer_load_dwordx4 v5, s[12:15], s21 offen lds
  s_add_u32 m0, s22, 2048
  s_nop 0
  buffer_load_dwordx4 v6, s[12:15], s21 offen lds
  s_mul_i32 s21, s20, 393216
  s_add_u32 s21, s21, 6488064
  s_add_u32 s21, s21, s44
  s_mul_i32 s22, s20, 12288
  s_add_u32 s22, s22, 6144
  s_add_u32 m0, s22, 0
  s_nop 0
  buffer_load_dwordx4 v4, s[12:15], s21 offen lds
  s_add_u32 m0, s22, 1024
  s_nop 0
  buffer_load_dwordx4 v5, s[12:15], s21 offen lds
  s_add_u32 m0, s22, 2048
  s_nop 0
  buffer_load_dwordx4 v6, s[12:15], s21 offen lds
  s_mul_i32 s21, s20, 393216
  s_add_u32 s21, s21, 6586368
  s_add_u32 s21, s21, s44
  s_mul_i32 s22, s20, 12288
  s_add_u32 s22, s22, 9216
  s_add_u32 m0, s22, 0
  s_nop 0
  buffer_load_dwordx4 v4, s[12:15], s21 offen lds
  s_add_u32 m0, s22, 1024
  s_nop 0
  buffer_load_dwordx4 v5, s[12:15], s21 offen lds
  s_add_u32 m0, s22, 2048
  s_nop 0
  buffer_load_dwordx4 v6, s[12:15], s21 offen lds
  s_waitcnt vmcnt(12)
  s_barrier
  ds_read_b64_tr_b16 a[144:145], v8 offset:0
  ds_read_b64_tr_b16 a[146:147], v8 offset:1536
  ds_read_b64_tr_b16 a[148:149], v8 offset:32
  ds_read_b64_tr_b16 a[150:151], v8 offset:1568
  ds_read_b64_tr_b16 a[152:153], v8 offset:64
  ds_read_b64_tr_b16 a[154:155], v8 offset:1600
  ds_read_b64_tr_b16 a[156:157], v8 offset:12288
  ds_read_b64_tr_b16 a[158:159], v8 offset:13824
  ds_read_b64_tr_b16 a[160:161], v8 offset:12320
  ds_read_b64_tr_b16 a[162:163], v8 offset:13856
  ds_read_b64_tr_b16 a[164:165], v8 offset:12352
  ds_read_b64_tr_b16 a[166:167], v8 offset:13888
  ds_read_b64_tr_b16 a[168:169], v8 offset:24576
  ds_read_b64_tr_b16 a[170:171], v8 offset:26112
  ds_read_b64_tr_b16 a[172:173], v8 offset:24608
  ds_read_b64_tr_b16 a[174:175], v8 offset:26144
  ds_read_b64_tr_b16 a[176:177], v8 offset:24640
  ds_read_b64_tr_b16 a[178:179], v8 offset:26176
  ds_read_b64_tr_b16 a[180:181], v8 offset:36864
  ds_read_b64_tr_b16 a[182:183], v8 offset:38400
  ds_read_b64_tr_b16 a[184:185], v8 offset:36896
  ds_read_b64_tr_b16 a[186:187], v8 offset:38432
  ds_read_b64_tr_b16 a[188:189], v8 offset:36928
  ds_read_b64_tr_b16 a[190:191], v8 offset:38464
  s_waitcnt lgkmcnt(0)
  s_barrier
  s_waitcnt vmcnt(0)
  s_barrier
  ds_read_b64_tr_b16 a[192:193], v7 offset:0
  ds_read_b64_tr_b16 a[194:195], v7 offset:1536
  ds_read_b64_tr_b16 a[196:197], v7 offset:32
  ds_read_b64_tr_b16 a[198:199], v7 offset:1568
  ds_read_b64_tr_b16 a[200:201], v7 offset:64
  ds_read_b64_tr_b16 a[202:203], v7 offset:1600
  ds_read_b64_tr_b16 a[204:205], v7 offset:12288
  ds_read_b64_tr_b16 a[206:207], v7 offset:13824
  ds_read_b64_tr_b16 a[208:209], v7 offset:12320
  ds_read_b64_tr_b16 a[210:211], v7 offset:13856
  ds_read_b64_tr_b16 a[212:213], v7 offset:12352
  ds_read_b64_tr_b16 a[214:215], v7 offset:13888
  ds_read_b64_tr_b16 a[216:217], v7 offset:24576
  ds_read_b64_tr_b16 a[218:219], v7 offset:26112
  ds_read_b64_tr_b16 a[220:221], v7 offset:24608
  ds_read_b64_tr_b16 a[222:223], v7 offset:26144
  ds_read_b64_tr_b16 a[224:225], v7 offset:24640
  ds_read_b64_tr_b16 a[226:227], v7 offset:26176
  ds_read_b64_tr_b16 a[228:229], v7 offset:36864
  ds_read_b64_tr_b16 a[230:231], v7 offset:38400
  ds_read_b64_tr_b16 a[232:233], v7 offset:36896
  ds_read_b64_tr_b16 a[234:235], v7 offset:38432
  ds_read_b64_tr_b16 a[236:237], v7 offset:36928
  ds_read_b64_tr_b16 a[238:239], v7 offset:38464
  s_waitcnt lgkmcnt(0)
  s_barrier
  v_and_b32 v6, 7, v2
  v_add_u32 v4, 0, v3
  v_xor_b32 v4, v4, v6
  v_lshlrev_b32 v4, 4, v4
  v_lshl_add_u32 v14, v2, 7, v4
  v_add_u32 v16, 65536, v14
  v_add_u32 v18, 131072, v14
  v_add_u32 v4, 4, v3
  v_xor_b32 v4, v4, v6
  v_lshlrev_b32 v4, 4, v4
  v_lshl_add_u32 v15, v2, 7, v4
  v_add_u32 v17, 65536, v15
  v_add_u32 v19, 131072, v15
  v_lshlrev_b32 v26, 4, v1
  v_mov_b32 v28, 1
  v_mov_b32 v4, 0x40000000
  v_cmp_eq_u32 vcc, 0, v0
  s_nop 1
  v_cndmask_b32 v27, v4, 0, vcc
  s_mov_b32 s26, 4
  s_mul_i32 s27, s42, 12288
  s_mul_i32 s21, s43, 25165824
  s_add_u32 s27, s27, s21
  s_mul_i32 s21, s20, 3072
  s_add_u32 s27, s27, s21
  s_mov_b32 s28, 786432
  v_readfirstlane_b32 s21, v29
  s_cmp_lg_u32 s21, 0
  s_cbranch_scc1 kvz_193
  s_mov_b32 s21, 76
  v_mov_b32 v4, 0
  s_mov_b32 s101, 0
wf_194:
  buffer_load_dword v5, v4, s[32:35], s21 offen sc1
  s_add_u32 s101, s101, 1
  s_cmp_gt_u32 s101, 131072
  s_cbranch_scc1 main_end
  s_waitcnt vmcnt(0)
  v_readfirstlane_b32 s100, v5
  s_cmp_ge_u32 s100, 1
  s_cbranch_scc1 wf_195
  s_sleep 8
  s_branch wf_194
wf_195:
kvz_193:
  s_lshl_b32 s60, s40, 7
  s_add_u32 s60, s60, 0
  s_mov_b32 s48, 0x40000000
  s_mov_b32 s61, 0x40000000
  s_waitcnt vmcnt(4)
  s_barrier
  ds_read_b128 v[160:163], v16 offset:32768
  ds_read_b128 v[164:167], v16 offset:34816
  ds_read_b128 v[168:171], v16 offset:36864
  ds_read_b128 v[172:175], v16 offset:38912
  s_waitcnt lgkmcnt(3)
  .p2align 3
kvm_196:
  v_mfma_f32_16x16x32_bf16 v[64:67], a[0:3], v[160:163], 0
  s_add_u32 s29, s48, 0
  ds_read_b128 v[176:179], v17 offset:32768
  v_cvt_pk_bf16_f32 v204, v88, v89
  v_mfma_f32_16x16x32_bf16 v[68:71], a[4:7], v[160:163], 0
  v_cvt_pk_bf16_f32 v205, v90, v91
  v_cvt_pk_bf16_f32 v206, v92, v93
  v_mfma_f32_16x16x32_bf16 v[72:75], a[8:11], v[160:163], 0
  s_waitcnt lgkmcnt(3)
  v_cvt_pk_bf16_f32 v207, v94, v95
  v_cvt_pk_bf16_f32 v212, v96, v97
  v_mfma_f32_16x16x32_bf16 v[76:79], a[0:3], v[164:167], 0
  ds_read_b128 v[180:183], v17 offset:34816
  v_cvt_pk_bf16_f32 v213, v98, v99
  v_mfma_f32_16x16x32_bf16 v[80:83], a[4:7], v[164:167], 0
  v_cvt_pk_bf16_f32 v208, v100, v101
  v_cvt_pk_bf16_f32 v209, v102, v103
  v_mfma_f32_16x16x32_bf16 v[84:87], a[8:11], v[164:167], 0
  s_waitcnt lgkmcnt(3)
  v_cvt_pk_bf16_f32 v210, v104, v105
  v_cvt_pk_bf16_f32 v211, v106, v107
  v_mfma_f32_16x16x32_bf16 v[88:91], a[0:3], v[168:171], 0
  ds_read_b128 v[184:187], v17 offset:36864
  v_cvt_pk_bf16_f32 v214, v108, v109
  v_mfma_f32_16x16x32_bf16 v[92:95], a[4:7], v[168:171], 0
  s_add_u32 m0, s31, 122880
  v_cvt_pk_bf16_f32 v215, v110, v111
  buffer_store_dwordx4 v[192:195], v26, s[16:19], s29 offen offset:0 sc1
  v_mfma_f32_16x16x32_bf16 v[96:99], a[8:11], v[168:171], 0
  s_waitcnt lgkmcnt(3)
  buffer_load_dwordx4 v10, s[8:11], s30 offen lds
  v_mfma_f32_16x16x32_bf16 v[100:103], a[0:3], v[172:175], 0
  ds_read_b128 v[188:191], v17 offset:38912
  v_mfma_f32_16x16x32_bf16 v[104:107], a[4:7], v[172:175], 0
  v_mfma_f32_16x16x32_bf16 v[108:111], a[8:11], v[172:175], 0
  s_waitcnt lgkmcnt(3)
  v_mfma_f32_16x16x32_bf16 v[64:67], a[12:15], v[176:179], v[64:67]
  s_waitcnt vmcnt(4)
  s_barrier
  ds_read_b128 v[160:163], v16 offset:40960
  v_mfma_f32_16x16x32_bf16 v[68:71], a[16:19], v[176:179], v[68:71]
  s_add_u32 m0, s31, 123904
  v_mfma_f32_16x16x32_bf16 v[72:75], a[20:23], v[176:179], v[72:75]
  s_waitcnt lgkmcnt(3)
  buffer_load_dwordx4 v11, s[8:11], s30 offen lds
  buffer_store_dwordx4 v[196:199], v26, s[16:19], s29 offen offset:1024 sc1
  v_mfma_f32_16x16x32_bf16 v[76:79], a[12:15], v[180:183], v[76:79]
  s_add_u32 s30, s30, 128
  ds_read_b128 v[164:167], v16 offset:43008
  v_mfma_f32_16x16x32_bf16 v[80:83], a[16:19], v[180:183], v[80:83]
  v_mfma_f32_16x16x32_bf16 v[84:87], a[20:23], v[180:183], v[84:87]
  s_waitcnt lgkmcnt(3)
  v_mfma_f32_16x16x32_bf16 v[88:91], a[12:15], v[184:187], v[88:91]
  ds_read_b128 v[168:171], v16 offset:45056
  v_mfma_f32_16x16x32_bf16 v[92:95], a[16:19], v[184:187], v[92:95]
  v_mfma_f32_16x16x32_bf16 v[96:99], a[20:23], v[184:187], v[96:99]
  s_waitcnt lgkmcnt(3)
  v_mfma_f32_16x16x32_bf16 v[100:103], a[12:15], v[188:191], v[100:103]
  ds_read_b128 v[172:175], v16 offset:47104
  buffer_store_dwordx4 v[200:203], v26, s[16:19], s29 offen offset:2048 sc1
  v_mfma_f32_16x16x32_bf16 v[104:107], a[16:19], v[188:191], v[104:107]
  v_mfma_f32_16x16x32_bf16 v[108:111], a[20:23], v[188:191], v[108:111]
  s_waitcnt lgkmcnt(3)
  v_mfma_f32_16x16x32_bf16 v[64:67], a[24:27], v[160:163], v[64:67]
  ds_read_b128 v[176:179], v17 offset:40960
  v_mfma_f32_16x16x32_bf16 v[68:71], a[28:31], v[160:163], v[68:71]
  s_add_u32 m0, s31, 131072
  v_mfma_f32_16x16x32_bf16 v[72:75], a[32:35], v[160:163], v[72:75]
  s_waitcnt lgkmcnt(3)
  buffer_load_dwordx4 v10, s[8:11], s30 offen lds
  v_mfma_f32_16x16x32_bf16 v[76:79], a[24:27], v[164:167], v[76:79]
  s_add_u32 s29, s48, 393216
  ds_read_b128 v[180:183], v17 offset:43008
  v_mfma_f32_16x16x32_bf16 v[80:83], a[28:31], v[164:167], v[80:83]
  buffer_store_dwordx4 v[204:207], v26, s[16:19], s29 offen offset:0 sc1
  v_mfma_f32_16x16x32_bf16 v[84:87], a[32:35], v[164:167], v[84:87]
  s_waitcnt lgkmcnt(3)
  v_mfma_f32_16x16x32_bf16 v[88:91], a[24:27], v[168:171], v[88:91]
  ds_read_b128 v[184:187], v17 offset:45056
  v_mfma_f32_16x16x32_bf16 v[92:95], a[28:31], v[168:171], v[92:95]
  s_add_u32 m0, s31, 132096
  v_mfma_f32_16x16x32_bf16 v[96:99], a[32:35], v[168:171], v[96:99]
  s_waitcnt lgkmcnt(3)
  buffer_load_dwordx4 v11, s[8:11], s30 offen lds
  v_mfma_f32_16x16x32_bf16 v[100:103], a[24:27], v[172:175], v[100:103]
  s_add_u32 s30, s30, 128
  ds_read_b128 v[188:191], v17 offset:47104
  v_mfma_f32_16x16x32_bf16 v[104:107], a[28:31], v[172:175], v[104:107]
  v_mfma_f32_16x16x32_bf16 v[108:111], a[32:35], v[172:175], v[108:111]
  s_waitcnt lgkmcnt(3)
  buffer_store_dwordx4 v[208:211], v26, s[16:19], s29 offen offset:1024 sc1
  v_mfma_f32_16x16x32_bf16 v[64:67], a[36:39], v[176:179], v[64:67]
  s_waitcnt vmcnt(9)
  s_barrier
  ds_read_b128 v[160:163], v16 offset:49152
  v_mfma_f32_16x16x32_bf16 v[68:71], a[40:43], v[176:179], v[68:71]
  v_mfma_f32_16x16x32_bf16 v[72:75], a[44:47], v[176:179], v[72:75]
  s_waitcnt lgkmcnt(3)
  v_mfma_f32_16x16x32_bf16 v[76:79], a[36:39], v[180:183], v[76:79]
  ds_read_b128 v[164:167], v16 offset:51200
  v_mfma_f32_16x16x32_bf16 v[80:83], a[40:43], v[180:183], v[80:83]
  v_mfma_f32_16x16x32_bf16 v[84:87], a[44:47], v[180:183], v[84:87]
  s_waitcnt lgkmcnt(3)
  v_mfma_f32_16x16x32_bf16 v[88:91], a[36:39], v[184:187], v[88:91]
  ds_read_b128 v[168:171], v16 offset:53248
  buffer_store_dwordx4 v[212:215], v26, s[16:19], s29 offen offset:2048 sc1
  v_mfma_f32_16x16x32_bf16 v[92:95], a[40:43], v[184:187], v[92:95]
  v_mfma_f32_16x16x32_bf16 v[96:99], a[44:47], v[184:187], v[96:99]
  s_waitcnt lgkmcnt(3)
  v_mfma_f32_16x16x32_bf16 v[100:103], a[36:39], v[188:191], v[100:103]
  ds_read_b128 v[172:175], v16 offset:55296
  v_mfma_f32_16x16x32_bf16 v[104:107], a[40:43], v[188:191], v[104:107]
  v_mfma_f32_16x16x32_bf16 v[108:111], a[44:47], v[188:191], v[108:111]
  s_waitcnt lgkmcnt(3)
  v_mfma_f32_16x16x32_bf16 v[64:67], a[48:51], v[160:163], v[64:67]
  ds_read_b128 v[176:179], v17 offset:49152
  v_mfma_f32_16x16x32_bf16 v[68:71], a[52:55], v[160:163], v[68:71]
  s_add_u32 m0, s31, 98304
  v_mfma_f32_16x16x32_bf16 v[72:75], a[56:59], v[160:163], v[72:75]
  s_waitcnt lgkmcnt(3)
  buffer_load_dwordx4 v10, s[8:11], s30 offen lds
  v_mfma_f32_16x16x32_bf16 v[76:79], a[48:51], v[164:167], v[76:79]
  ds_read_b128 v[180:183], v17 offset:51200
  v_mfma_f32_16x16x32_bf16 v[80:83], a[52:55], v[164:167], v[80:83]
  v_mfma_f32_16x16x32_bf16 v[84:87], a[56:59], v[164:167], v[84:87]
  s_waitcnt lgkmcnt(3)
  v_mfma_f32_16x16x32_bf16 v[88:91], a[48:51], v[168:171], v[88:91]
  ds_read_b128 v[184:187], v17 offset:53248
  v_mfma_f32_16x16x32_bf16 v[92:95], a[52:55], v[168:171], v[92:95]
  s_add_u32 m0, s31, 99328
  v_mfma_f32_16x16x32_bf16 v[96:99], a[56:59], v[168:171], v[96:99]
  s_waitcnt lgkmcnt(3)
  buffer_load_dwordx4 v11, s[8:11], s30 offen lds
  v_mfma_f32_16x16x32_bf16 v[100:103], a[48:51], v[172:175], v[100:103]
  s_add_u32 s30, s30, 128
  ds_read_b128 v[188:191], v17 offset:55296
  v_mfma_f32_16x16x32_bf16 v[104:107], a[52:55], v[172:175], v[104:107]
  v_mfma_f32_16x16x32_bf16 v[108:111], a[56:59], v[172:175], v[108:111]
  s_waitcnt lgkmcnt(3)
  v_mfma_f32_16x16x32_bf16 v[64:67], a[60:63], v[176:179], v[64:67]
  s_waitcnt vmcnt(9)
  s_barrier
  ds_read_b128 v[160:163], v16 offset:57344
  v_mfma_f32_16x16x32_bf16 v[68:71], a[64:67], v[176:179], v[68:71]
  v_mfma_f32_16x16x32_bf16 v[72:75], a[68:71], v[176:179], v[72:75]
  s_waitcnt lgkmcnt(3)
  v_mfma_f32_16x16x32_bf16 v[76:79], a[60:63], v[180:183], v[76:79]
  ds_read_b128 v[164:167], v16 offset:59392
  v_mfma_f32_16x16x32_bf16 v[80:83], a[64:67], v[180:183], v[80:83]
  v_mfma_f32_16x16x32_bf16 v[84:87], a[68:71], v[180:183], v[84:87]
  s_waitcnt lgkmcnt(3)
  v_mfma_f32_16x16x32_bf16 v[88:91], a[60:63], v[184:187], v[88:91]
  ds_read_b128 v[168:171], v16 offset:61440
  v_mfma_f32_16x16x32_bf16 v[92:95], a[64:67], v[184:187], v[92:95]
  v_mfma_f32_16x16x32_bf16 v[96:99], a[68:71], v[184:187], v[96:99]
  s_waitcnt lgkmcnt(3)
  v_mfma_f32_16x16x32_bf16 v[100:103], a[60:63], v[188:191], v[100:103]
  ds_read_b128 v[172:175], v16 offset:63488
  v_mfma_f32_16x16x32_bf16 v[104:107], a[64:67], v[188:191], v[104:107]
  v_mfma_f32_16x16x32_bf16 v[108:111], a[68:71], v[188:191], v[108:111]
  s_waitcnt lgkmcnt(3)
  v_mfma_f32_16x16x32_bf16 v[64:67], a[72:75], v[160:163], v[64:67]
  ds_read_b128 v[176:179], v17 offset:57344
  v_mfma_f32_16x16x32_bf16 v[68:71], a[76:79], v[160:163], v[68:71]
  s_add_u32 m0, s31, 106496
  v_mfma_f32_16x16x32_bf16 v[72:75], a[80:83], v[160:163], v[72:75]
  s_waitcnt lgkmcnt(3)
  buffer_load_dwordx4 v10, s[8:11], s30 offen lds
  v_mfma_f32_16x16x32_bf16 v[76:79], a[72:75], v[164:167], v[76:79]
  ds_read_b128 v[180:183], v17 offset:59392
  v_mfma_f32_16x16x32_bf16 v[80:83], a[76:79], v[164:167], v[80:83]
  v_mfma_f32_16x16x32_bf16 v[84:87], a[80:83], v[164:167], v[84:87]
  s_waitcnt lgkmcnt(3)
  v_mfma_f32_16x16x32_bf16 v[88:91], a[72:75], v[168:171], v[88:91]
  ds_read_b128 v[184:187], v17 offset:61440
  v_mfma_f32_16x16x32_bf16 v[92:95], a[76:79], v[168:171], v[92:95]
  s_add_u32 m0, s31, 107520
  v_mfma_f32_16x16x32_bf16 v[96:99], a[80:83], v[168:171], v[96:99]
  s_waitcnt lgkmcnt(3)
  buffer_load_dwordx4 v11, s[8:11], s30 offen lds
  v_mfma_f32_16x16x32_bf16 v[100:103], a[72:75], v[172:175], v[100:103]
  s_add_u32 s30, s30, 128
  ds_read_b128 v[188:191], v17 offset:63488
  v_mfma_f32_16x16x32_bf16 v[104:107], a[76:79], v[172:175], v[104:107]
  v_mfma_f32_16x16x32_bf16 v[108:111], a[80:83], v[172:175], v[108:111]
  s_waitcnt lgkmcnt(3)
  v_mfma_f32_16x16x32_bf16 v[64:67], a[84:87], v[176:179], v[64:67]
  s_waitcnt vmcnt(4)
  s_barrier
  ds_read_b128 v[160:163], v18 offset:0
  v_mfma_f32_16x16x32_bf16 v[68:71], a[88:91], v[176:179], v[68:71]
  buffer_atomic_add v28, v27, s[72:75], s61 offen sc1
  v_mfma_f32_16x16x32_bf16 v[72:75], a[92:95], v[176:179], v[72:75]
  s_waitcnt lgkmcnt(3)
  s_mov_b32 s48, s27
  s_add_u32 s27, s27, s28
  v_mfma_f32_16x16x32_bf16 v[76:79], a[84:87], v[180:183], v[76:79]
  ds_read_b128 v[164:167], v18 offset:2048
  s_mov_b32 s61, s60
  v_mfma_f32_16x16x32_bf16 v[80:83], a[88:91], v[180:183], v[80:83]
  s_add_u32 s60, s60, 1024
  v_mfma_f32_16x16x32_bf16 v[84:87], a[92:95], v[180:183], v[84:87]
  s_waitcnt lgkmcnt(3)
  v_mfma_f32_16x16x32_bf16 v[88:91], a[84:87], v[184:187], v[88:91]
  ds_read_b128 v[168:171], v18 offset:4096
  v_mfma_f32_16x16x32_bf16 v[92:95], a[88:91], v[184:187], v[92:95]
  v_mfma_f32_16x16x32_bf16 v[96:99], a[92:95], v[184:187], v[96:99]
  s_waitcnt lgkmcnt(3)
  v_mfma_f32_16x16x32_bf16 v[100:103], a[84:87], v[188:191], v[100:103]
  ds_read_b128 v[172:175], v18 offset:6144
  v_mfma_f32_16x16x32_bf16 v[104:107], a[88:91], v[188:191], v[104:107]
  v_mfma_f32_16x16x32_bf16 v[108:111], a[92:95], v[188:191], v[108:111]
  s_waitcnt lgkmcnt(3)
  v_mfma_f32_16x16x32_bf16 v[64:67], a[96:99], v[160:163], v[64:67]
  ds_read_b128 v[176:179], v19 offset:0
  v_mfma_f32_16x16x32_bf16 v[68:71], a[100:103], v[160:163], v[68:71]
  s_add_u32 m0, s31, 114688
  v_mfma_f32_16x16x32_bf16 v[72:75], a[104:107], v[160:163], v[72:75]
  s_waitcnt lgkmcnt(3)
  buffer_load_dwordx4 v10, s[8:11], s30 offen lds
  v_mfma_f32_16x16x32_bf16 v[76:79], a[96:99], v[164:167], v[76:79]
  ds_read_b128 v[180:183], v19 offset:2048
  v_mfma_f32_16x16x32_bf16 v[80:83], a[100:103], v[164:167], v[80:83]
  v_mfma_f32_16x16x32_bf16 v[84:87], a[104:107], v[164:167], v[84:87]
  s_waitcnt lgkmcnt(3)
  v_mfma_f32_16x16x32_bf16 v[88:91], a[96:99], v[168:171], v[88:91]
  ds_read_b128 v[184:187], v19 offset:4096
  v_mfma_f32_16x16x32_bf16 v[92:95], a[100:103], v[168:171], v[92:95]
  s_add_u32 m0, s31, 115712
  v_mfma_f32_16x16x32_bf16 v[96:99], a[104:107], v[168:171], v[96:99]
  s_waitcnt lgkmcnt(3)
  buffer_load_dwordx4 v11, s[8:11], s30 offen lds
  v_mfma_f32_16x16x32_bf16 v[100:103], a[96:99], v[172:175], v[100:103]
  s_add_u32 s30, s30, 128
  ds_read_b128 v[188:191], v19 offset:6144
  v_mfma_f32_16x16x32_bf16 v[104:107], a[100:103], v[172:175], v[104:107]
  v_mfma_f32_16x16x32_bf16 v[108:111], a[104:107], v[172:175], v[108:111]
  s_waitcnt lgkmcnt(3)
  v_mfma_f32_16x16x32_bf16 v[64:67], a[108:111], v[176:179], v[64:67]
  s_waitcnt vmcnt(5)
  s_barrier
  ds_read_b128 v[160:163], v16 offset:32768
  v_mfma_f32_16x16x32_bf16 v[68:71], a[112:115], v[176:179], v[68:71]
  v_mfma_f32_16x16x32_bf16 v[72:75], a[116:119], v[176:179], v[72:75]
  s_waitcnt lgkmcnt(3)
  v_mfma_f32_16x16x32_bf16 v[76:79], a[108:111], v[180:183], v[76:79]
  ds_read_b128 v[164:167], v16 offset:34816
  v_mfma_f32_16x16x32_bf16 v[80:83], a[112:115], v[180:183], v[80:83]
  v_mfma_f32_16x16x32_bf16 v[84:87], a[116:119], v[180:183], v[84:87]
  s_waitcnt lgkmcnt(3)
  v_mfma_f32_16x16x32_bf16 v[88:91], a[108:111], v[184:187], v[88:91]
  ds_read_b128 v[168:171], v16 offset:36864
  v_mfma_f32_16x16x32_bf16 v[92:95], a[112:115], v[184:187], v[92:95]
  v_mfma_f32_16x16x32_bf16 v[96:99], a[116:119], v[184:187], v[96:99]
  s_waitcnt lgkmcnt(3)
  v_mfma_f32_16x16x32_bf16 v[100:103], a[108:111], v[188:191], v[100:103]
  ds_read_b128 v[172:175], v16 offset:38912
  v_mfma_f32_16x16x32_bf16 v[104:107], a[112:115], v[188:191], v[104:107]
  v_mfma_f32_16x16x32_bf16 v[108:111], a[116:119], v[188:191], v[108:111]
  s_waitcnt lgkmcnt(3)
  v_mfma_f32_16x16x32_bf16 v[64:67], a[120:123], v[160:163], v[64:67]
  ds_read_b128 v[176:179], v17 offset:32768
  v_mfma_f32_16x16x32_bf16 v[68:71], a[124:127], v[160:163], v[68:71]
  s_add_u32 m0, s31, 122880
  v_mfma_f32_16x16x32_bf16 v[72:75], a[128:131], v[160:163], v[72:75]
  s_waitcnt lgkmcnt(3)
  buffer_load_dwordx4 v10, s[8:11], s30 offen lds
  v_mfma_f32_16x16x32_bf16 v[76:79], a[120:123], v[164:167], v[76:79]
  ds_read_b128 v[180:183], v17 offset:34816
  v_mfma_f32_16x16x32_bf16 v[80:83], a[124:127], v[164:167], v[80:83]
  v_mfma_f32_16x16x32_bf16 v[84:87], a[128:131], v[164:167], v[84:87]
  s_waitcnt lgkmcnt(3)
  v_mfma_f32_16x16x32_bf16 v[88:91], a[120:123], v[168:171], v[88:91]
  ds_read_b128 v[184:187], v17 offset:36864
  v_mfma_f32_16x16x32_bf16 v[92:95], a[124:127], v[168:171], v[92:95]
  s_add_u32 m0, s31, 123904
  v_mfma_f32_16x16x32_bf16 v[96:99], a[128:131], v[168:171], v[96:99]
  s_waitcnt lgkmcnt(3)
  buffer_load_dwordx4 v11, s[8:11], s30 offen lds
  v_mfma_f32_16x16x32_bf16 v[100:103], a[120:123], v[172:175], v[100:103]
  s_add_u32 s30, s30, 128
  ds_read_b128 v[188:191], v17 offset:38912
  v_mfma_f32_16x16x32_bf16 v[104:107], a[124:127], v[172:175], v[104:107]
  v_mfma_f32_16x16x32_bf16 v[108:111], a[128:131], v[172:175], v[108:111]
  s_waitcnt lgkmcnt(3)
  v_mfma_f32_16x16x32_bf16 v[64:67], a[132:135], v[176:179], v[64:67]
  s_waitcnt vmcnt(5)
  s_barrier
  ds_read_b128 v[160:163], v16 offset:40960
  v_mfma_f32_16x16x32_bf16 v[68:71], a[136:139], v[176:179], v[68:71]
  v_mfma_f32_16x16x32_bf16 v[72:75], a[140:143], v[176:179], v[72:75]
  s_waitcnt lgkmcnt(3)
  v_mfma_f32_16x16x32_bf16 v[76:79], a[132:135], v[180:183], v[76:79]
  ds_read_b128 v[164:167], v16 offset:43008
  v_mfma_f32_16x16x32_bf16 v[80:83], a[136:139], v[180:183], v[80:83]
  v_mfma_f32_16x16x32_bf16 v[84:87], a[140:143], v[180:183], v[84:87]
  s_waitcnt lgkmcnt(3)
  v_mfma_f32_16x16x32_bf16 v[88:91], a[132:135], v[184:187], v[88:91]
  ds_read_b128 v[168:171], v16 offset:45056
  v_mfma_f32_16x16x32_bf16 v[92:95], a[136:139], v[184:187], v[92:95]
  v_mfma_f32_16x16x32_bf16 v[96:99], a[140:143], v[184:187], v[96:99]
  s_waitcnt lgkmcnt(3)
  v_mfma_f32_16x16x32_bf16 v[100:103], a[132:135], v[188:191], v[100:103]
  ds_read_b128 v[172:175], v16 offset:47104
  v_mfma_f32_16x16x32_bf16 v[104:107], a[136:139], v[188:191], v[104:107]
  v_mfma_f32_16x16x32_bf16 v[108:111], a[140:143], v[188:191], v[108:111]
  s_waitcnt lgkmcnt(3)
  v_mfma_f32_16x16x32_bf16 v[64:67], a[144:147], v[160:163], v[64:67]
  ds_read_b128 v[176:179], v17 offset:40960
  v_mfma_f32_16x16x32_bf16 v[68:71], a[148:151], v[160:163], v[68:71]
  s_add_u32 m0, s31, 131072
  v_mfma_f32_16x16x32_bf16 v[72:75], a[152:155], v[160:163], v[72:75]
  s_waitcnt lgkmcnt(3)
  buffer_load_dwordx4 v10, s[8:11], s30 offen lds
  v_mfma_f32_16x16x32_bf16 v[76:79], a[144:147], v[164:167], v[76:79]
  ds_read_b128 v[180:183], v17 offset:43008
  v_mfma_f32_16x16x32_bf16 v[80:83], a[148:151], v[164:167], v[80:83]
  v_mfma_f32_16x16x32_bf16 v[84:87], a[152:155], v[164:167], v[84:87]
  s_waitcnt lgkmcnt(3)
  v_mfma_f32_16x16x32_bf16 v[88:91], a[144:147], v[168:171], v[88:91]
  ds_read_b128 v[184:187], v17 offset:45056
  v_mfma_f32_16x16x32_bf16 v[92:95], a[148:151], v[168:171], v[92:95]
  s_add_u32 m0, s31, 132096
  v_mfma_f32_16x16x32_bf16 v[96:99], a[152:155], v[168:171], v[96:99]
  s_waitcnt lgkmcnt(3)
  buffer_load_dwordx4 v11, s[8:11], s30 offen lds
  v_mfma_f32_16x16x32_bf16 v[100:103], a[144:147], v[172:175], v[100:103]
  s_add_u32 s30, s30, s25
  ds_read_b128 v[188:191], v17 offset:47104
  v_mfma_f32_16x16x32_bf16 v[104:107], a[148:151], v[172:175], v[104:107]
  v_mfma_f32_16x16x32_bf16 v[108:111], a[152:155], v[172:175], v[108:111]
  s_waitcnt lgkmcnt(3)
  v_mfma_f32_16x16x32_bf16 v[64:67], a[156:159], v[176:179], v[64:67]
  s_waitcnt vmcnt(4)
  s_barrier
  ds_read_b128 v[160:163], v16 offset:49152
  v_mfma_f32_16x16x32_bf16 v[68:71], a[160:163], v[176:179], v[68:71]
  v_mfma_f32_16x16x32_bf16 v[72:75], a[164:167], v[176:179], v[72:75]
  s_waitcnt lgkmcnt(3)
  v_mfma_f32_16x16x32_bf16 v[76:79], a[156:159], v[180:183], v[76:79]
  ds_read_b128 v[164:167], v16 offset:51200
  v_mfma_f32_16x16x32_bf16 v[80:83], a[160:163], v[180:183], v[80:83]
  v_mfma_f32_16x16x32_bf16 v[84:87], a[164:167], v[180:183], v[84:87]
  s_waitcnt lgkmcnt(3)
  v_mfma_f32_16x16x32_bf16 v[88:91], a[156:159], v[184:187], v[88:91]
  ds_read_b128 v[168:171], v16 offset:53248
  v_mfma_f32_16x16x32_bf16 v[92:95], a[160:163], v[184:187], v[92:95]
  v_mfma_f32_16x16x32_bf16 v[96:99], a[164:167], v[184:187], v[96:99]
  s_waitcnt lgkmcnt(3)
  v_mfma_f32_16x16x32_bf16 v[100:103], a[156:159], v[188:191], v[100:103]
  ds_read_b128 v[172:175], v16 offset:55296
  v_mfma_f32_16x16x32_bf16 v[104:107], a[160:163], v[188:191], v[104:107]
  v_mfma_f32_16x16x32_bf16 v[108:111], a[164:167], v[188:191], v[108:111]
  s_waitcnt lgkmcnt(3)
  v_mfma_f32_16x16x32_bf16 v[64:67], a[168:171], v[160:163], v[64:67]
  ds_read_b128 v[176:179], v17 offset:49152
  v_mfma_f32_16x16x32_bf16 v[68:71], a[172:175], v[160:163], v[68:71]
  s_add_u32 m0, s31, 98304
  v_mfma_f32_16x16x32_bf16 v[72:75], a[176:179], v[160:163], v[72:75]
  s_waitcnt lgkmcnt(3)
  buffer_load_dwordx4 v10, s[8:11], s30 offen lds
  v_mfma_f32_16x16x32_bf16 v[76:79], a[168:171], v[164:167], v[76:79]
  ds_read_b128 v[180:183], v17 offset:51200
  v_mfma_f32_16x16x32_bf16 v[80:83], a[172:175], v[164:167], v[80:83]
  v_mfma_f32_16x16x32_bf16 v[84:87], a[176:179], v[164:167], v[84:87]
  s_waitcnt lgkmcnt(3)
  v_mfma_f32_16x16x32_bf16 v[88:91], a[168:171], v[168:171], v[88:91]
  ds_read_b128 v[184:187], v17 offset:53248
  v_mfma_f32_16x16x32_bf16 v[92:95], a[172:175], v[168:171], v[92:95]
  s_add_u32 m0, s31, 99328
  v_mfma_f32_16x16x32_bf16 v[96:99], a[176:179], v[168:171], v[96:99]
  s_waitcnt lgkmcnt(3)
  buffer_load_dwordx4 v11, s[8:11], s30 offen lds
  v_mfma_f32_16x16x32_bf16 v[100:103], a[168:171], v[172:175], v[100:103]
  s_add_u32 s30, s30, 128
  ds_read_b128 v[188:191], v17 offset:55296
  v_mfma_f32_16x16x32_bf16 v[104:107], a[172:175], v[172:175], v[104:107]
  v_mfma_f32_16x16x32_bf16 v[108:111], a[176:179], v[172:175], v[108:111]
  s_waitcnt lgkmcnt(3)
  v_mfma_f32_16x16x32_bf16 v[64:67], a[180:183], v[176:179], v[64:67]
  s_waitcnt vmcnt(4)
  s_barrier
  ds_read_b128 v[160:163], v16 offset:57344
  v_mfma_f32_16x16x32_bf16 v[68:71], a[184:187], v[176:179], v[68:71]
  v_mfma_f32_16x16x32_bf16 v[72:75], a[188:191], v[176:179], v[72:75]
  s_waitcnt lgkmcnt(3)
  v_mfma_f32_16x16x32_bf16 v[76:79], a[180:183], v[180:183], v[76:79]
  ds_read_b128 v[164:167], v16 offset:59392
  v_mfma_f32_16x16x32_bf16 v[80:83], a[184:187], v[180:183], v[80:83]
  v_mfma_f32_16x16x32_bf16 v[84:87], a[188:191], v[180:183], v[84:87]
  s_waitcnt lgkmcnt(3)
  v_mfma_f32_16x16x32_bf16 v[88:91], a[180:183], v[184:187], v[88:91]
  ds_read_b128 v[168:171], v16 offset:61440
  v_mfma_f32_16x16x32_bf16 v[92:95], a[184:187], v[184:187], v[92:95]
  v_mfma_f32_16x16x32_bf16 v[96:99], a[188:191], v[184:187], v[96:99]
  s_waitcnt lgkmcnt(3)
  v_mfma_f32_16x16x32_bf16 v[100:103], a[180:183], v[188:191], v[100:103]
  ds_read_b128 v[172:175], v16 offset:63488
  v_mfma_f32_16x16x32_bf16 v[104:107], a[184:187], v[188:191], v[104:107]
  v_mfma_f32_16x16x32_bf16 v[108:111], a[188:191], v[188:191], v[108:111]
  s_waitcnt lgkmcnt(3)
  v_mfma_f32_16x16x32_bf16 v[64:67], a[192:195], v[160:163], v[64:67]
  ds_read_b128 v[176:179], v17 offset:57344
  v_mfma_f32_16x16x32_bf16 v[68:71], a[196:199], v[160:163], v[68:71]
  s_add_u32 m0, s31, 106496
  v_mfma_f32_16x16x32_bf16 v[72:75], a[200:203], v[160:163], v[72:75]
  s_waitcnt lgkmcnt(3)
  buffer_load_dwordx4 v10, s[8:11], s30 offen lds
  v_mfma_f32_16x16x32_bf16 v[76:79], a[192:195], v[164:167], v[76:79]
  ds_read_b128 v[180:183], v17 offset:59392
  v_mfma_f32_16x16x32_bf16 v[80:83], a[196:199], v[164:167], v[80:83]
  v_mfma_f32_16x16x32_bf16 v[84:87], a[200:203], v[164:167], v[84:87]
  s_waitcnt lgkmcnt(3)
  v_mfma_f32_16x16x32_bf16 v[88:91], a[192:195], v[168:171], v[88:91]
  ds_read_b128 v[184:187], v17 offset:61440
  v_mfma_f32_16x16x32_bf16 v[92:95], a[196:199], v[168:171], v[92:95]
  s_add_u32 m0, s31, 107520
  v_mfma_f32_16x16x32_bf16 v[96:99], a[200:203], v[168:171], v[96:99]
  s_waitcnt lgkmcnt(3)
  buffer_load_dwordx4 v11, s[8:11], s30 offen lds
  v_mfma_f32_16x16x32_bf16 v[100:103], a[192:195], v[172:175], v[100:103]
  s_add_u32 s30, s30, 128
  ds_read_b128 v[188:191], v17 offset:63488
  v_mfma_f32_16x16x32_bf16 v[104:107], a[196:199], v[172:175], v[104:107]
  v_mfma_f32_16x16x32_bf16 v[108:111], a[200:203], v[172:175], v[108:111]
  s_waitcnt lgkmcnt(3)
  v_mfma_f32_16x16x32_bf16 v[64:67], a[204:207], v[176:179], v[64:67]
  s_waitcnt vmcnt(4)
  s_barrier
  ds_read_b128 v[160:163], v18 offset:0
  v_mfma_f32_16x16x32_bf16 v[68:71], a[208:211], v[176:179], v[68:71]
  v_mfma_f32_16x16x32_bf16 v[72:75], a[212:215], v[176:179], v[72:75]
  s_waitcnt lgkmcnt(3)
  v_mfma_f32_16x16x32_bf16 v[76:79], a[204:207], v[180:183], v[76:79]
  ds_read_b128 v[164:167], v18 offset:2048
  v_mfma_f32_16x16x32_bf16 v[80:83], a[208:211], v[180:183], v[80:83]
  v_mfma_f32_16x16x32_bf16 v[84:87], a[212:215], v[180:183], v[84:87]
  s_waitcnt lgkmcnt(3)
  v_mfma_f32_16x16x32_bf16 v[88:91], a[204:207], v[184:187], v[88:91]
  ds_read_b128 v[168:171], v18 offset:4096
  v_mfma_f32_16x16x32_bf16 v[92:95], a[208:211], v[184:187], v[92:95]
  v_mfma_f32_16x16x32_bf16 v[96:99], a[212:215], v[184:187], v[96:99]
  s_waitcnt lgkmcnt(3)
  v_mfma_f32_16x16x32_bf16 v[100:103], a[204:207], v[188:191], v[100:103]
  ds_read_b128 v[172:175], v18 offset:6144
  v_mfma_f32_16x16x32_bf16 v[104:107], a[208:211], v[188:191], v[104:107]
  v_mfma_f32_16x16x32_bf16 v[108:111], a[212:215], v[188:191], v[108:111]
  s_waitcnt lgkmcnt(3)
  v_mfma_f32_16x16x32_bf16 v[64:67], a[216:219], v[160:163], v[64:67]
  ds_read_b128 v[176:179], v19 offset:0
  v_mfma_f32_16x16x32_bf16 v[68:71], a[220:223], v[160:163], v[68:71]
  s_add_u32 m0, s31, 114688
  v_mfma_f32_16x16x32_bf16 v[72:75], a[224:227], v[160:163], v[72:75]
  s_waitcnt lgkmcnt(3)
  buffer_load_dwordx4 v10, s[8:11], s30 offen lds
  v_mfma_f32_16x16x32_bf16 v[76:79], a[216:219], v[164:167], v[76:79]
  ds_read_b128 v[180:183], v19 offset:2048
  v_mfma_f32_16x16x32_bf16 v[80:83], a[220:223], v[164:167], v[80:83]
  v_mfma_f32_16x16x32_bf16 v[84:87], a[224:227], v[164:167], v[84:87]
  s_waitcnt lgkmcnt(3)
  v_mfma_f32_16x16x32_bf16 v[88:91], a[216:219], v[168:171], v[88:91]
  ds_read_b128 v[184:187], v19 offset:4096
  v_mfma_f32_16x16x32_bf16 v[92:95], a[220:223], v[168:171], v[92:95]
  s_add_u32 m0, s31, 115712
  v_mfma_f32_16x16x32_bf16 v[96:99], a[224:227], v[168:171], v[96:99]
  s_waitcnt lgkmcnt(3)
  buffer_load_dwordx4 v11, s[8:11], s30 offen lds
  v_mfma_f32_16x16x32_bf16 v[100:103], a[216:219], v[172:175], v[100:103]
  s_add_u32 s30, s30, 128
  ds_read_b128 v[188:191], v19 offset:6144
  v_mfma_f32_16x16x32_bf16 v[104:107], a[220:223], v[172:175], v[104:107]
  v_mfma_f32_16x16x32_bf16 v[108:111], a[224:227], v[172:175], v[108:111]
  s_waitcnt lgkmcnt(3)
  v_mfma_f32_16x16x32_bf16 v[64:67], a[228:231], v[176:179], v[64:67]
  s_waitcnt vmcnt(4)
  s_barrier
  ds_read_b128 v[160:163], v16 offset:32768
  v_mfma_f32_16x16x32_bf16 v[68:71], a[232:235], v[176:179], v[68:71]
  v_mfma_f32_16x16x32_bf16 v[72:75], a[236:239], v[176:179], v[72:75]
  s_waitcnt lgkmcnt(3)
  v_mfma_f32_16x16x32_bf16 v[76:79], a[228:231], v[180:183], v[76:79]
  ds_read_b128 v[164:167], v16 offset:34816
  v_cvt_pk_bf16_f32 v192, v64, v65
  v_mfma_f32_16x16x32_bf16 v[80:83], a[232:235], v[180:183], v[80:83]
  v_cvt_pk_bf16_f32 v193, v66, v67
  v_cvt_pk_bf16_f32 v194, v68, v69
  v_mfma_f32_16x16x32_bf16 v[84:87], a[236:239], v[180:183], v[84:87]
  s_waitcnt lgkmcnt(3)
  v_cvt_pk_bf16_f32 v195, v70, v71
  v_cvt_pk_bf16_f32 v200, v72, v73
  v_mfma_f32_16x16x32_bf16 v[88:91], a[228:231], v[184:187], v[88:91]
  ds_read_b128 v[168:171], v16 offset:36864
  v_cvt_pk_bf16_f32 v201, v74, v75
  v_mfma_f32_16x16x32_bf16 v[92:95], a[232:235], v[184:187], v[92:95]
  v_cvt_pk_bf16_f32 v196, v76, v77
  v_cvt_pk_bf16_f32 v197, v78, v79
  v_mfma_f32_16x16x32_bf16 v[96:99], a[236:239], v[184:187], v[96:99]
  s_waitcnt lgkmcnt(3)
  v_cvt_pk_bf16_f32 v198, v80, v81
  v_cvt_pk_bf16_f32 v199, v82, v83
  v_mfma_f32_16x16x32_bf16 v[100:103], a[228:231], v[188:191], v[100:103]
  ds_read_b128 v[172:175], v16 offset:38912
  v_cvt_pk_bf16_f32 v202, v84, v85
  v_mfma_f32_16x16x32_bf16 v[104:107], a[232:235], v[188:191], v[104:107]
  s_sub_u32 s26, s26, 1
  s_cmp_gt_u32 s26, 0
  v_cvt_pk_bf16_f32 v203, v86, v87
  v_mfma_f32_16x16x32_bf16 v[108:111], a[236:239], v[188:191], v[108:111]
  s_waitcnt lgkmcnt(3)
  s_cbranch_scc1 kvm_196
  s_nop 7
  v_cvt_pk_bf16_f32 v204, v88, v89
  v_cvt_pk_bf16_f32 v205, v90, v91
  v_cvt_pk_bf16_f32 v206, v92, v93
  v_cvt_pk_bf16_f32 v207, v94, v95
  v_cvt_pk_bf16_f32 v212, v96, v97
  v_cvt_pk_bf16_f32 v213, v98, v99
  v_cvt_pk_bf16_f32 v208, v100, v101
  v_cvt_pk_bf16_f32 v209, v102, v103
  v_cvt_pk_bf16_f32 v210, v104, v105
  v_cvt_pk_bf16_f32 v211, v106, v107
  v_cvt_pk_bf16_f32 v214, v108, v109
  v_cvt_pk_bf16_f32 v215, v110, v111
  s_add_u32 s29, s48, 0
  buffer_store_dwordx4 v[192:195], v26, s[16:19], s29 offen offset:0 sc1
  buffer_store_dwordx4 v[196:199], v26, s[16:19], s29 offen offset:1024 sc1
  buffer_store_dwordx4 v[200:203], v26, s[16:19], s29 offen offset:2048 sc1
  s_add_u32 s29, s48, 393216
  buffer_store_dwordx4 v[204:207], v26, s[16:19], s29 offen offset:0 sc1
  buffer_store_dwordx4 v[208:211], v26, s[16:19], s29 offen offset:1024 sc1
  buffer_store_dwordx4 v[212:215], v26, s[16:19], s29 offen offset:2048 sc1
  s_mov_b32 s30, 327680
  s_mov_b32 s25, 162688
  v_lshrrev_b32 v4, 3, v1
  v_and_b32 v5, 7, v1
  v_xor_b32 v5, v5, v4
  s_mul_i32 s21, s20, 32
  v_add_u32 v4, s21, v4
  v_mul_u32_u24 v4, 1280, v4
  v_lshl_add_u32 v10, v5, 4, v4
  s_mul_i32 s31, s20, 4096
  v_add_u32 v11, 10240, v10
  v_add_u32 v12, 20480, v10
  v_add_u32 v13, 30720, v10
  s_add_u32 m0, s31, 0
  s_nop 0
  buffer_load_dwordx4 v10, s[8:11], s30 offen lds
  s_add_u32 m0, s31, 1024
  s_nop 0
  buffer_load_dwordx4 v11, s[8:11], s30 offen lds
  s_add_u32 m0, s31, 2048
  s_nop 0
  buffer_load_dwordx4 v12, s[8:11], s30 offen lds
  s_add_u32 m0, s31, 3072
  s_nop 0
  buffer_load_dwordx4 v13, s[8:11], s30 offen lds
  s_add_u32 s30, s30, 128
  s_add_u32 m0, s31, 16384
  s_nop 0
  buffer_load_dwordx4 v10, s[8:11], s30 offen lds
  s_add_u32 m0, s31, 17408
  s_nop 0
  buffer_load_dwordx4 v11, s[8:11], s30 offen lds
  s_add_u32 m0, s31, 18432
  s_nop 0
  buffer_load_dwordx4 v12, s[8:11], s30 offen lds
  s_add_u32 m0, s31, 19456
  s_nop 0
  buffer_load_dwordx4 v13, s[8:11], s30 offen lds
  s_add_u32 s30, s30, 128
  s_add_u32 m0, s31, 32768
  s_nop 0
  buffer_load_dwordx4 v10, s[8:11], s30 offen lds
  s_add_u32 m0, s31, 33792
  s_nop 0
  buffer_load_dwordx4 v11, s[8:11], s30 offen lds
  s_add_u32 m0, s31, 34816
  s_nop 0
  buffer_load_dwordx4 v12, s[8:11], s30 offen lds
  s_add_u32 m0, s31, 35840
  s_nop 0
  buffer_load_dwordx4 v13, s[8:11], s30 offen lds
  s_add_u32 s30, s30, 128
  s_add_u32 m0, s31, 49152
  s_nop 0
  buffer_load_dwordx4 v10, s[8:11], s30 offen lds
  s_add_u32 m0, s31, 50176
  s_nop 0
  buffer_load_dwordx4 v11, s[8:11], s30 offen lds
  s_add_u32 m0, s31, 51200
  s_nop 0
  buffer_load_dwordx4 v12, s[8:11], s30 offen lds
  s_add_u32 m0, s31, 52224
  s_nop 0
  buffer_load_dwordx4 v13, s[8:11], s30 offen lds
  s_add_u32 s30, s30, 128
  s_add_u32 m0, s31, 65536
  s_nop 0
  buffer_load_dwordx4 v10, s[8:11], s30 offen lds
  s_add_u32 m0, s31, 66560
  s_nop 0
  buffer_load_dwordx4 v11, s[8:11], s30 offen lds
  s_add_u32 m0, s31, 67584
  s_nop 0
  buffer_load_dwordx4 v12, s[8:11], s30 offen lds
  s_add_u32 m0, s31, 68608
  s_nop 0
  buffer_load_dwordx4 v13, s[8:11], s30 offen lds
  s_add_u32 s30, s30, 128
  s_add_u32 m0, s31, 81920
  s_nop 0
  buffer_load_dwordx4 v10, s[8:11], s30 offen lds
  s_add_u32 m0, s31, 82944
  s_nop 0
  buffer_load_dwordx4 v11, s[8:11], s30 offen lds
  s_add_u32 m0, s31, 83968
  s_nop 0
  buffer_load_dwordx4 v12, s[8:11], s30 offen lds
  s_add_u32 m0, s31, 84992
  s_nop 0
  buffer_load_dwordx4 v13, s[8:11], s30 offen lds
  s_add_u32 s30, s30, 128
  s_waitcnt vmcnt(24) lgkmcnt(0)
  s_barrier
  buffer_atomic_add v28, v27, s[72:75], s61 offen sc1
  s_add_u32 m0, s31, 98304
  s_nop 0
  buffer_load_dwordx4 v10, s[8:11], s30 offen lds
  s_add_u32 m0, s31, 99328
  s_nop 0
  buffer_load_dwordx4 v11, s[8:11], s30 offen lds
  s_add_u32 m0, s31, 100352
  s_nop 0
  buffer_load_dwordx4 v12, s[8:11], s30 offen lds
  s_add_u32 m0, s31, 101376
  s_nop 0
  buffer_load_dwordx4 v13, s[8:11], s30 offen lds
  s_add_u32 s30, s30, 128
  s_add_u32 m0, s31, 114688
  s_nop 0
  buffer_load_dwordx4 v10, s[8:11], s30 offen lds
  s_add_u32 m0, s31, 115712
  s_nop 0
  buffer_load_dwordx4 v11, s[8:11], s30 offen lds
  s_add_u32 m0, s31, 116736
  s_nop 0
  buffer_load_dwordx4 v12, s[8:11], s30 offen lds
  s_add_u32 m0, s31, 117760
  s_nop 0
  buffer_load_dwordx4 v13, s[8:11], s30 offen lds
  s_add_u32 s30, s30, 128
  s_mov_b32 s26, 14
  s_mov_b32 s28, 1572864
  s_mov_b32 s48, 0x40000000
  s_mov_b32 s61, 0x40000000
  s_waitcnt vmcnt(28)
  s_barrier
  ds_read_b128 v[160:163], v14 offset:0
  ds_read_b128 v[164:167], v14 offset:2048
  ds_read_b128 v[168:171], v14 offset:4096
  ds_read_b128 v[172:175], v14 offset:6144
  s_waitcnt lgkmcnt(3)
  .p2align 3
kvs_197:
  v_mfma_f32_16x16x32_bf16 v[64:67], a[0:3], v[160:163], 0
  s_add_u32 s29, s48, 0
  ds_read_b128 v[176:179], v14 offset:8192
  v_cvt_pk_bf16_f32 v221, v126, v127
  v_mfma_f32_16x16x32_bf16 v[68:71], a[4:7], v[160:163], 0
  v_cvt_pk_bf16_f32 v222, v128, v129
  v_cvt_pk_bf16_f32 v223, v130, v131
  v_mfma_f32_16x16x32_bf16 v[72:75], a[8:11], v[160:163], 0
  s_waitcnt lgkmcnt(3)
  v_cvt_pk_bf16_f32 v226, v132, v133
  v_cvt_pk_bf16_f32 v227, v134, v135
  v_mfma_f32_16x16x32_bf16 v[76:79], a[0:3], v[164:167], 0
  ds_read_b128 v[180:183], v14 offset:10240
  v_cvt_pk_bf16_f32 v228, v136, v137
  v_mfma_f32_16x16x32_bf16 v[80:83], a[4:7], v[164:167], 0
  v_cvt_pk_bf16_f32 v229, v138, v139
  v_cvt_pk_bf16_f32 v230, v140, v141
  v_mfma_f32_16x16x32_bf16 v[84:87], a[8:11], v[164:167], 0
  s_waitcnt lgkmcnt(3)
  v_cvt_pk_bf16_f32 v231, v142, v143
  v_cvt_pk_bf16_f32 v236, v144, v145
  v_mfma_f32_16x16x32_bf16 v[88:91], a[0:3], v[168:171], 0
  ds_read_b128 v[184:187], v14 offset:12288
  v_cvt_pk_bf16_f32 v237, v146, v147
  v_mfma_f32_16x16x32_bf16 v[92:95], a[4:7], v[168:171], 0
  v_cvt_pk_bf16_f32 v232, v148, v149
  v_cvt_pk_bf16_f32 v233, v150, v151
  v_mfma_f32_16x16x32_bf16 v[96:99], a[8:11], v[168:171], 0
  s_waitcnt lgkmcnt(3)
  v_cvt_pk_bf16_f32 v234, v152, v153
  v_cvt_pk_bf16_f32 v235, v154, v155
  v_mfma_f32_16x16x32_bf16 v[100:103], a[0:3], v[172:175], 0
  ds_read_b128 v[188:191], v14 offset:14336
  v_cvt_pk_bf16_f32 v238, v156, v157
  v_mfma_f32_16x16x32_bf16 v[104:107], a[4:7], v[172:175], 0
  v_cvt_pk_bf16_f32 v239, v158, v159
  buffer_store_dwordx4 v[192:195], v26, s[16:19], s29 offen offset:0 sc1
  v_mfma_f32_16x16x32_bf16 v[108:111], a[8:11], v[172:175], 0
  s_waitcnt lgkmcnt(3)
  v_mfma_f32_16x16x32_bf16 v[112:115], a[0:3], v[176:179], 0
  ds_read_b128 v[160:163], v15 offset:0
  v_mfma_f32_16x16x32_bf16 v[116:119], a[4:7], v[176:179], 0
  s_add_u32 m0, s31, 131072
  v_mfma_f32_16x16x32_bf16 v[120:123], a[8:11], v[176:179], 0
  s_waitcnt lgkmcnt(3)
  buffer_load_dwordx4 v10, s[8:11], s30 offen lds
  v_mfma_f32_16x16x32_bf16 v[124:127], a[0:3], v[180:183], 0
  ds_read_b128 v[164:167], v15 offset:2048
  v_mfma_f32_16x16x32_bf16 v[128:131], a[4:7], v[180:183], 0
  v_mfma_f32_16x16x32_bf16 v[132:135], a[8:11], v[180:183], 0
  s_waitcnt lgkmcnt(3)
  buffer_store_dwordx4 v[196:199], v26, s[16:19], s29 offen offset:1024 sc1
  v_mfma_f32_16x16x32_bf16 v[136:139], a[0:3], v[184:187], 0
  ds_read_b128 v[168:171], v15 offset:4096
  v_mfma_f32_16x16x32_bf16 v[140:143], a[4:7], v[184:187], 0
  s_add_u32 m0, s31, 132096
  v_mfma_f32_16x16x32_bf16 v[144:147], a[8:11], v[184:187], 0
  s_waitcnt lgkmcnt(3)
  buffer_load_dwordx4 v11, s[8:11], s30 offen lds
  v_mfma_f32_16x16x32_bf16 v[148:151], a[0:3], v[188:191], 0
  ds_read_b128 v[172:175], v15 offset:6144
  v_mfma_f32_16x16x32_bf16 v[152:155], a[4:7], v[188:191], 0
  v_mfma_f32_16x16x32_bf16 v[156:159], a[8:11], v[188:191], 0
  s_waitcnt lgkmcnt(3)
  v_mfma_f32_16x16x32_bf16 v[64:67], a[12:15], v[160:163], v[64:67]
  ds_read_b128 v[176:179], v15 offset:8192
  buffer_store_dwordx4 v[200:203], v26, s[16:19], s29 offen offset:2048 sc1
  v_mfma_f32_16x16x32_bf16 v[68:71], a[16:19], v[160:163], v[68:71]
  s_add_u32 m0, s31, 133120
  v_mfma_f32_16x16x32_bf16 v[72:75], a[20:23], v[160:163], v[72:75]
  s_waitcnt lgkmcnt(3)
  buffer_load_dwordx4 v12, s[8:11], s30 offen lds
  v_mfma_f32_16x16x32_bf16 v[76:79], a[12:15], v[164:167], v[76:79]
  ds_read_b128 v[180:183], v15 offset:10240
  v_mfma_f32_16x16x32_bf16 v[80:83], a[16:19], v[164:167], v[80:83]
  v_mfma_f32_16x16x32_bf16 v[84:87], a[20:23], v[164:167], v[84:87]
  s_waitcnt lgkmcnt(3)
  v_mfma_f32_16x16x32_bf16 v[88:91], a[12:15], v[168:171], v[88:91]
  s_add_u32 s29, s48, 393216
  ds_read_b128 v[184:187], v15 offset:12288
  v_mfma_f32_16x16x32_bf16 v[92:95], a[16:19], v[168:171], v[92:95]
  s_add_u32 m0, s31, 134144
  buffer_store_dwordx4 v[204:207], v26, s[16:19], s29 offen offset:0 sc1
  v_mfma_f32_16x16x32_bf16 v[96:99], a[20:23], v[168:171], v[96:99]
  s_waitcnt lgkmcnt(3)
  buffer_load_dwordx4 v13, s[8:11], s30 offen lds
  v_mfma_f32_16x16x32_bf16 v[100:103], a[12:15], v[172:175], v[100:103]
  s_add_u32 s30, s30, 128
  ds_read_b128 v[188:191], v15 offset:14336
  v_mfma_f32_16x16x32_bf16 v[104:107], a[16:19], v[172:175], v[104:107]
  v_mfma_f32_16x16x32_bf16 v[108:111], a[20:23], v[172:175], v[108:111]
  s_waitcnt lgkmcnt(3)
  v_mfma_f32_16x16x32_bf16 v[112:115], a[12:15], v[176:179], v[112:115]
  s_waitcnt vmcnt(32)
  s_barrier
  ds_read_b128 v[160:163], v14 offset:16384
  v_mfma_f32_16x16x32_bf16 v[116:119], a[16:19], v[176:179], v[116:119]
  v_mfma_f32_16x16x32_bf16 v[120:123], a[20:23], v[176:179], v[120:123]
  s_waitcnt lgkmcnt(3)
  buffer_store_dwordx4 v[208:211], v26, s[16:19], s29 offen offset:1024 sc1
  v_mfma_f32_16x16x32_bf16 v[124:127], a[12:15], v[180:183], v[124:127]
  ds_read_b128 v[164:167], v14 offset:18432
  v_mfma_f32_16x16x32_bf16 v[128:131], a[16:19], v[180:183], v[128:131]
  v_mfma_f32_16x16x32_bf16 v[132:135], a[20:23], v[180:183], v[132:135]
  s_waitcnt lgkmcnt(3)
  v_mfma_f32_16x16x32_bf16 v[136:139], a[12:15], v[184:187], v[136:139]
  ds_read_b128 v[168:171], v14 offset:20480
  v_mfma_f32_16x16x32_bf16 v[140:143], a[16:19], v[184:187], v[140:143]
  v_mfma_f32_16x16x32_bf16 v[144:147], a[20:23], v[184:187], v[144:147]
  s_waitcnt lgkmcnt(3)
  v_mfma_f32_16x16x32_bf16 v[148:151], a[12:15], v[188:191], v[148:151]
  ds_read_b128 v[172:175], v14 offset:22528
  buffer_store_dwordx4 v[212:215], v26, s[16:19], s29 offen offset:2048 sc1
  v_mfma_f32_16x16x32_bf16 v[152:155], a[16:19], v[188:191], v[152:155]
  v_mfma_f32_16x16x32_bf16 v[156:159], a[20:23], v[188:191], v[156:159]
  s_waitcnt lgkmcnt(3)
  v_mfma_f32_16x16x32_bf16 v[64:67], a[24:27], v[160:163], v[64:67]
  ds_read_b128 v[176:179], v14 offset:24576
  v_mfma_f32_16x16x32_bf16 v[68:71], a[28:31], v[160:163], v[68:71]
  s_add_u32 m0, s31, 147456
  v_mfma_f32_16x16x32_bf16 v[72:75], a[32:35], v[160:163], v[72:75]
  s_waitcnt lgkmcnt(3)
  buffer_load_dwordx4 v10, s[8:11], s30 offen lds
  v_mfma_f32_16x16x32_bf16 v[76:79], a[24:27], v[164:167], v[76:79]
  s_add_u32 s29, s48, 786432
  ds_read_b128 v[180:183], v14 offset:26624
  v_mfma_f32_16x16x32_bf16 v[80:83], a[28:31], v[164:167], v[80:83]
  buffer_store_dwordx4 v[216:219], v26, s[16:19], s29 offen offset:0 sc1
  v_mfma_f32_16x16x32_bf16 v[84:87], a[32:35], v[164:167], v[84:87]
  s_waitcnt lgkmcnt(3)
  v_mfma_f32_16x16x32_bf16 v[88:91], a[24:27], v[168:171], v[88:91]
  ds_read_b128 v[184:187], v14 offset:28672
  v_mfma_f32_16x16x32_bf16 v[92:95], a[28:31], v[168:171], v[92:95]
  s_add_u32 m0, s31, 148480
  v_mfma_f32_16x16x32_bf16 v[96:99], a[32:35], v[168:171], v[96:99]
  s_waitcnt lgkmcnt(3)
  buffer_load_dwordx4 v11, s[8:11], s30 offen lds
  v_mfma_f32_16x16x32_bf16 v[100:103], a[24:27], v[172:175], v[100:103]
  ds_read_b128 v[188:191], v14 offset:30720
  v_mfma_f32_16x16x32_bf16 v[104:107], a[28:31], v[172:175], v[104:107]
  v_mfma_f32_16x16x32_bf16 v[108:111], a[32:35], v[172:175], v[108:111]
  s_waitcnt lgkmcnt(3)
  buffer_store_dwordx4 v[220:223], v26, s[16:19], s29 offen offset:1024 sc1
  v_mfma_f32_16x16x32_bf16 v[112:115], a[24:27], v[176:179], v[112:115]
  ds_read_b128 v[160:163], v15 offset:16384
  v_mfma_f32_16x16x32_bf16 v[116:119], a[28:31], v[176:179], v[116:119]
  s_add_u32 m0, s31, 149504
  v_mfma_f32_16x16x32_bf16 v[120:123], a[32:35], v[176:179], v[120:123]
  s_waitcnt lgkmcnt(3)
  buffer_load_dwordx4 v12, s[8:11], s30 offen lds
  v_mfma_f32_16x16x32_bf16 v[124:127], a[24:27], v[180:183], v[124:127]
  ds_read_b128 v[164:167], v15 offset:18432
  v_mfma_f32_16x16x32_bf16 v[128:131], a[28:31], v[180:183], v[128:131]
  v_mfma_f32_16x16x32_bf16 v[132:135], a[32:35], v[180:183], v[132:135]
  s_waitcnt lgkmcnt(3)
  v_mfma_f32_16x16x32_bf16 v[136:139], a[24:27], v[184:187], v[136:139]
  ds_read_b128 v[168:171], v15 offset:20480
  buffer_store_dwordx4 v[224:227], v26, s[16:19], s29 offen offset:2048 sc1
  v_mfma_f32_16x16x32_bf16 v[140:143], a[28:31], v[184:187], v[140:143]
  s_add_u32 m0, s31, 150528
  v_mfma_f32_16x16x32_bf16 v[144:147], a[32:35], v[184:187], v[144:147]
  s_waitcnt lgkmcnt(3)
  buffer_load_dwordx4 v13, s[8:11], s30 offen lds
  v_mfma_f32_16x16x32_bf16 v[148:151], a[24:27], v[188:191], v[148:151]
  s_add_u32 s30, s30, s25
  ds_read_b128 v[172:175], v15 offset:22528
  v_mfma_f32_16x16x32_bf16 v[152:155], a[28:31], v[188:191], v[152:155]
  v_mfma_f32_16x16x32_bf16 v[156:159], a[32:35], v[188:191], v[156:159]
  s_waitcnt lgkmcnt(3)
  v_mfma_f32_16x16x32_bf16 v[64:67], a[36:39], v[160:163], v[64:67]
  s_add_u32 s29, s48, 1179648
  ds_read_b128 v[176:179], v15 offset:24576
  v_mfma_f32_16x16x32_bf16 v[68:71], a[40:43], v[160:163], v[68:71]
  buffer_store_dwordx4 v[228:231], v26, s[16:19], s29 offen offset:0 sc1
  v_mfma_f32_16x16x32_bf16 v[72:75], a[44:47], v[160:163], v[72:75]
  s_waitcnt lgkmcnt(3)
  v_mfma_f32_16x16x32_bf16 v[76:79], a[36:39], v[164:167], v[76:79]
  ds_read_b128 v[180:183], v15 offset:26624
  v_mfma_f32_16x16x32_bf16 v[80:83], a[40:43], v[164:167], v[80:83]
  v_mfma_f32_16x16x32_bf16 v[84:87], a[44:47], v[164:167], v[84:87]
  s_waitcnt lgkmcnt(3)
  v_mfma_f32_16x16x32_bf16 v[88:91], a[36:39], v[168:171], v[88:91]
  ds_read_b128 v[184:187], v15 offset:28672
  v_mfma_f32_16x16x32_bf16 v[92:95], a[40:43], v[168:171], v[92:95]
  v_mfma_f32_16x16x32_bf16 v[96:99], a[44:47], v[168:171], v[96:99]
  s_waitcnt lgkmcnt(3)
  buffer_store_dwordx4 v[232:235], v26, s[16:19], s29 offen offset:1024 sc1
  v_mfma_f32_16x16x32_bf16 v[100:103], a[36:39], v[172:175], v[100:103]
  ds_read_b128 v[188:191], v15 offset:30720
  v_mfma_f32_16x16x32_bf16 v[104:107], a[40:43], v[172:175], v[104:107]
  v_mfma_f32_16x16x32_bf16 v[108:111], a[44:47], v[172:175], v[108:111]
  s_waitcnt lgkmcnt(3)
  v_mfma_f32_16x16x32_bf16 v[112:115], a[36:39], v[176:179], v[112:115]
  s_waitcnt vmcnt(39)
  s_barrier
  ds_read_b128 v[160:163], v14 offset:32768
  v_mfma_f32_16x16x32_bf16 v[116:119], a[40:43], v[176:179], v[116:119]
  v_mfma_f32_16x16x32_bf16 v[120:123], a[44:47], v[176:179], v[120:123]
  s_waitcnt lgkmcnt(3)
  v_mfma_f32_16x16x32_bf16 v[124:127], a[36:39], v[180:183], v[124:127]
  ds_read_b128 v[164:167], v14 offset:34816
  buffer_store_dwordx4 v[236:239], v26, s[16:19], s29 offen offset:2048 sc1
  v_mfma_f32_16x16x32_bf16 v[128:131], a[40:43], v[180:183], v[128:131]
  v_mfma_f32_16x16x32_bf16 v[132:135], a[44:47], v[180:183], v[132:135]
  s_waitcnt lgkmcnt(3)
  v_mfma_f32_16x16x32_bf16 v[136:139], a[36:39], v[184:187], v[136:139]
  ds_read_b128 v[168:171], v14 offset:36864
  v_mfma_f32_16x16x32_bf16 v[140:143], a[40:43], v[184:187], v[140:143]
  v_mfma_f32_16x16x32_bf16 v[144:147], a[44:47], v[184:187], v[144:147]
  s_waitcnt lgkmcnt(3)
  v_mfma_f32_16x16x32_bf16 v[148:151], a[36:39], v[188:191], v[148:151]
  ds_read_b128 v[172:175], v14 offset:38912
  v_mfma_f32_16x16x32_bf16 v[152:155], a[40:43], v[188:191], v[152:155]
  v_mfma_f32_16x16x32_bf16 v[156:159], a[44:47], v[188:191], v[156:159]
  s_waitcnt lgkmcnt(3)
  v_mfma_f32_16x16x32_bf16 v[64:67], a[48:51], v[160:163], v[64:67]
  ds_read_b128 v[176:179], v14 offset:40960
  v_mfma_f32_16x16x32_bf16 v[68:71], a[52:55], v[160:163], v[68:71]
  s_add_u32 m0, s31, 0
  v_mfma_f32_16x16x32_bf16 v[72:75], a[56:59], v[160:163], v[72:75]
  s_waitcnt lgkmcnt(3)
  buffer_load_dwordx4 v10, s[8:11], s30 offen lds
  v_mfma_f32_16x16x32_bf16 v[76:79], a[48:51], v[164:167], v[76:79]
  ds_read_b128 v[180:183], v14 offset:43008
  v_mfma_f32_16x16x32_bf16 v[80:83], a[52:55], v[164:167], v[80:83]
  v_mfma_f32_16x16x32_bf16 v[84:87], a[56:59], v[164:167], v[84:87]
  s_waitcnt lgkmcnt(3)
  v_mfma_f32_16x16x32_bf16 v[88:91], a[48:51], v[168:171], v[88:91]
  ds_read_b128 v[184:187], v14 offset:45056
  v_mfma_f32_16x16x32_bf16 v[92:95], a[52:55], v[168:171], v[92:95]
  s_add_u32 m0, s31, 1024
  v_mfma_f32_16x16x32_bf16 v[96:99], a[56:59], v[168:171], v[96:99]
  s_waitcnt lgkmcnt(3)
  buffer_load_dwordx4 v11, s[8:11], s30 offen lds
  v_mfma_f32_16x16x32_bf16 v[100:103], a[48:51], v[172:175], v[100:103]
  ds_read_b128 v[188:191], v14 offset:47104
  v_mfma_f32_16x16x32_bf16 v[104:107], a[52:55], v[172:175], v[104:107]
  v_mfma_f32_16x16x32_bf16 v[108:111], a[56:59], v[172:175], v[108:111]
  s_waitcnt lgkmcnt(3)
  v_mfma_f32_16x16x32_bf16 v[112:115], a[48:51], v[176:179], v[112:115]
  ds_read_b128 v[160:163], v15 offset:32768
  v_mfma_f32_16x16x32_bf16 v[116:119], a[52:55], v[176:179], v[116:119]
  s_add_u32 m0, s31, 2048
  v_mfma_f32_16x16x32_bf16 v[120:123], a[56:59], v[176:179], v[120:123]
  s_waitcnt lgkmcnt(3)
  buffer_load_dwordx4 v12, s[8:11], s30 offen lds
  v_mfma_f32_16x16x32_bf16 v[124:127], a[48:51], v[180:183], v[124:127]
  ds_read_b128 v[164:167], v15 offset:34816
  v_mfma_f32_16x16x32_bf16 v[128:131], a[52:55], v[180:183], v[128:131]
  v_mfma_f32_16x16x32_bf16 v[132:135], a[56:59], v[180:183], v[132:135]
  s_waitcnt lgkmcnt(3)
  v_mfma_f32_16x16x32_bf16 v[136:139], a[48:51], v[184:187], v[136:139]
  ds_read_b128 v[168:171], v15 offset:36864
  v_mfma_f32_16x16x32_bf16 v[140:143], a[52:55], v[184:187], v[140:143]
  s_add_u32 m0, s31, 3072
  v_mfma_f32_16x16x32_bf16 v[144:147], a[56:59], v[184:187], v[144:147]
  s_waitcnt lgkmcnt(3)
  buffer_load_dwordx4 v13, s[8:11], s30 offen lds
  v_mfma_f32_16x16x32_bf16 v[148:151], a[48:51], v[188:191], v[148:151]
  s_add_u32 s30, s30, 128
  ds_read_b128 v[172:175], v15 offset:38912
  v_mfma_f32_16x16x32_bf16 v[152:155], a[52:55], v[188:191], v[152:155]
  v_mfma_f32_16x16x32_bf16 v[156:159], a[56:59], v[188:191], v[156:159]
  s_waitcnt lgkmcnt(3)
  v_mfma_f32_16x16x32_bf16 v[64:67], a[60:63], v[160:163], v[64:67]
  ds_read_b128 v[176:179], v15 offset:40960
  v_mfma_f32_16x16x32_bf16 v[68:71], a[64:67], v[160:163], v[68:71]
  v_mfma_f32_16x16x32_bf16 v[72:75], a[68:71], v[160:163], v[72:75]
  s_waitcnt lgkmcnt(3)
  v_mfma_f32_16x16x32_bf16 v[76:79], a[60:63], v[164:167], v[76:79]
  ds_read_b128 v[180:183], v15 offset:43008
  v_mfma_f32_16x16x32_bf16 v[80:83], a[64:67], v[164:167], v[80:83]
  v_mfma_f32_16x16x32_bf16 v[84:87], a[68:71], v[164:167], v[84:87]
  s_waitcnt lgkmcnt(3)
  v_mfma_f32_16x16x32_bf16 v[88:91], a[60:63], v[168:171], v[88:91]
  ds_read_b128 v[184:187], v15 offset:45056
  v_mfma_f32_16x16x32_bf16 v[92:95], a[64:67], v[168:171], v[92:95]
  v_mfma_f32_16x16x32_bf16 v[96:99], a[68:71], v[168:171], v[96:99]
  s_waitcnt lgkmcnt(3)
  v_mfma_f32_16x16x32_bf16 v[100:103], a[60:63], v[172:175], v[100:103]
  ds_read_b128 v[188:191], v15 offset:47104
  v_mfma_f32_16x16x32_bf16 v[104:107], a[64:67], v[172:175], v[104:107]
  v_mfma_f32_16x16x32_bf16 v[108:111], a[68:71], v[172:175], v[108:111]
  s_waitcnt lgkmcnt(3)
  v_mfma_f32_16x16x32_bf16 v[112:115], a[60:63], v[176:179], v[112:115]
  s_waitcnt vmcnt(40)
  s_barrier
  ds_read_b128 v[160:163], v14 offset:49152
  v_mfma_f32_16x16x32_bf16 v[116:119], a[64:67], v[176:179], v[116:119]
  v_mfma_f32_16x16x32_bf16 v[120:123], a[68:71], v[176:179], v[120:123]
  s_waitcnt lgkmcnt(3)
  v_mfma_f32_16x16x32_bf16 v[124:127], a[60:63], v[180:183], v[124:127]
  ds_read_b128 v[164:167], v14 offset:51200
  v_mfma_f32_16x16x32_bf16 v[128:131], a[64:67], v[180:183], v[128:131]
  v_mfma_f32_16x16x32_bf16 v[132:135], a[68:71], v[180:183], v[132:135]
  s_waitcnt lgkmcnt(3)
  v_mfma_f32_16x16x32_bf16 v[136:139], a[60:63], v[184:187], v[136:139]
  ds_read_b128 v[168:171], v14 offset:53248
  v_mfma_f32_16x16x32_bf16 v[140:143], a[64:67], v[184:187], v[140:143]
  v_mfma_f32_16x16x32_bf16 v[144:147], a[68:71], v[184:187], v[144:147]
  s_waitcnt lgkmcnt(3)
  v_mfma_f32_16x16x32_bf16 v[148:151], a[60:63], v[188:191], v[148:151]
  ds_read_b128 v[172:175], v14 offset:55296
  v_mfma_f32_16x16x32_bf16 v[152:155], a[64:67], v[188:191], v[152:155]
  v_mfma_f32_16x16x32_bf16 v[156:159], a[68:71], v[188:191], v[156:159]
  s_waitcnt lgkmcnt(3)
  v_mfma_f32_16x16x32_bf16 v[64:67], a[72:75], v[160:163], v[64:67]
  ds_read_b128 v[176:179], v14 offset:57344
  v_mfma_f32_16x16x32_bf16 v[68:71], a[76:79], v[160:163], v[68:71]
  s_add_u32 m0, s31, 16384
  v_mfma_f32_16x16x32_bf16 v[72:75], a[80:83], v[160:163], v[72:75]
  s_waitcnt lgkmcnt(3)
  buffer_load_dwordx4 v10, s[8:11], s30 offen lds
  v_mfma_f32_16x16x32_bf16 v[76:79], a[72:75], v[164:167], v[76:79]
  ds_read_b128 v[180:183], v14 offset:59392
  v_mfma_f32_16x16x32_bf16 v[80:83], a[76:79], v[164:167], v[80:83]
  v_mfma_f32_16x16x32_bf16 v[84:87], a[80:83], v[164:167], v[84:87]
  s_waitcnt lgkmcnt(3)
  v_mfma_f32_16x16x32_bf16 v[88:91], a[72:75], v[168:171], v[88:91]
  ds_read_b128 v[184:187], v14 offset:61440
  v_mfma_f32_16x16x32_bf16 v[92:95], a[76:79], v[168:171], v[92:95]
  s_add_u32 m0, s31, 17408
  v_mfma_f32_16x16x32_bf16 v[96:99], a[80:83], v[168:171], v[96:99]
  s_waitcnt lgkmcnt(3)
  buffer_load_dwordx4 v11, s[8:11], s30 offen lds
  v_mfma_f32_16x16x32_bf16 v[100:103], a[72:75], v[172:175], v[100:103]
  ds_read_b128 v[188:191], v14 offset:63488
  v_mfma_f32_16x16x32_bf16 v[104:107], a[76:79], v[172:175], v[104:107]
  v_mfma_f32_16x16x32_bf16 v[108:111], a[80:83], v[172:175], v[108:111]
  s_waitcnt lgkmcnt(3)
  v_mfma_f32_16x16x32_bf16 v[112:115], a[72:75], v[176:179], v[112:115]
  ds_read_b128 v[160:163], v15 offset:49152
  v_mfma_f32_16x16x32_bf16 v[116:119], a[76:79], v[176:179], v[116:119]
  s_add_u32 m0, s31, 18432
  v_mfma_f32_16x16x32_bf16 v[120:123], a[80:83], v[176:179], v[120:123]
  s_waitcnt lgkmcnt(3)
  buffer_load_dwordx4 v12, s[8:11], s30 offen lds
  v_mfma_f32_16x16x32_bf16 v[124:127], a[72:75], v[180:183], v[124:127]
  ds_read_b128 v[164:167], v15 offset:51200
  v_mfma_f32_16x16x32_bf16 v[128:131], a[76:79], v[180:183], v[128:131]
  v_mfma_f32_16x16x32_bf16 v[132:135], a[80:83], v[180:183], v[132:135]
  s_waitcnt lgkmcnt(3)
  v_mfma_f32_16x16x32_bf16 v[136:139], a[72:75], v[184:187], v[136:139]
  ds_read_b128 v[168:171], v15 offset:53248
  v_mfma_f32_16x16x32_bf16 v[140:143], a[76:79], v[184:187], v[140:143]
  s_add_u32 m0, s31, 19456
  v_mfma_f32_16x16x32_bf16 v[144:147], a[80:83], v[184:187], v[144:147]
  s_waitcnt lgkmcnt(3)
  buffer_load_dwordx4 v13, s[8:11], s30 offen lds
  v_mfma_f32_16x16x32_bf16 v[148:151], a[72:75], v[188:191], v[148:151]
  s_add_u32 s30, s30, 128
  ds_read_b128 v[172:175], v15 offset:55296
  v_mfma_f32_16x16x32_bf16 v[152:155], a[76:79], v[188:191], v[152:155]
  v_mfma_f32_16x16x32_bf16 v[156:159], a[80:83], v[188:191], v[156:159]
  s_waitcnt lgkmcnt(3)
  v_mfma_f32_16x16x32_bf16 v[64:67], a[84:87], v[160:163], v[64:67]
  ds_read_b128 v[176:179], v15 offset:57344
  v_mfma_f32_16x16x32_bf16 v[68:71], a[88:91], v[160:163], v[68:71]
  v_mfma_f32_16x16x32_bf16 v[72:75], a[92:95], v[160:163], v[72:75]
  s_waitcnt lgkmcnt(3)
  v_mfma_f32_16x16x32_bf16 v[76:79], a[84:87], v[164:167], v[76:79]
  ds_read_b128 v[180:183], v15 offset:59392
  v_mfma_f32_16x16x32_bf16 v[80:83], a[88:91], v[164:167], v[80:83]
  v_mfma_f32_16x16x32_bf16 v[84:87], a[92:95], v[164:167], v[84:87]
  s_waitcnt lgkmcnt(3)
  v_mfma_f32_16x16x32_bf16 v[88:91], a[84:87], v[168:171], v[88:91]
  ds_read_b128 v[184:187], v15 offset:61440
  v_mfma_f32_16x16x32_bf16 v[92:95], a[88:91], v[168:171], v[92:95]
  v_mfma_f32_16x16x32_bf16 v[96:99], a[92:95], v[168:171], v[96:99]
  s_waitcnt lgkmcnt(3)
  v_mfma_f32_16x16x32_bf16 v[100:103], a[84:87], v[172:175], v[100:103]
  ds_read_b128 v[188:191], v15 offset:63488
  v_mfma_f32_16x16x32_bf16 v[104:107], a[88:91], v[172:175], v[104:107]
  v_mfma_f32_16x16x32_bf16 v[108:111], a[92:95], v[172:175], v[108:111]
  s_waitcnt lgkmcnt(3)
  v_mfma_f32_16x16x32_bf16 v[112:115], a[84:87], v[176:179], v[112:115]
  s_waitcnt vmcnt(40)
  s_barrier
  ds_read_b128 v[160:163], v16 offset:0
  v_mfma_f32_16x16x32_bf16 v[116:119], a[88:91], v[176:179], v[116:119]
  v_mfma_f32_16x16x32_bf16 v[120:123], a[92:95], v[176:179], v[120:123]
  s_waitcnt lgkmcnt(3)
  v_mfma_f32_16x16x32_bf16 v[124:127], a[84:87], v[180:183], v[124:127]
  ds_read_b128 v[164:167], v16 offset:2048
  v_mfma_f32_16x16x32_bf16 v[128:131], a[88:91], v[180:183], v[128:131]
  v_mfma_f32_16x16x32_bf16 v[132:135], a[92:95], v[180:183], v[132:135]
  s_waitcnt lgkmcnt(3)
  v_mfma_f32_16x16x32_bf16 v[136:139], a[84:87], v[184:187], v[136:139]
  ds_read_b128 v[168:171], v16 offset:4096
  v_mfma_f32_16x16x32_bf16 v[140:143], a[88:91], v[184:187], v[140:143]
  v_mfma_f32_16x16x32_bf16 v[144:147], a[92:95], v[184:187], v[144:147]
  s_waitcnt lgkmcnt(3)
  v_mfma_f32_16x16x32_bf16 v[148:151], a[84:87], v[188:191], v[148:151]
  ds_read_b128 v[172:175], v16 offset:6144
  v_mfma_f32_16x16x32_bf16 v[152:155], a[88:91], v[188:191], v[152:155]
  v_mfma_f32_16x16x32_bf16 v[156:159], a[92:95], v[188:191], v[156:159]
  s_waitcnt lgkmcnt(3)
  v_mfma_f32_16x16x32_bf16 v[64:67], a[96:99], v[160:163], v[64:67]
  ds_read_b128 v[176:179], v16 offset:8192
  v_mfma_f32_16x16x32_bf16 v[68:71], a[100:103], v[160:163], v[68:71]
  s_add_u32 m0, s31, 32768
  v_mfma_f32_16x16x32_bf16 v[72:75], a[104:107], v[160:163], v[72:75]
  s_waitcnt lgkmcnt(3)
  buffer_load_dwordx4 v10, s[8:11], s30 offen lds
  v_mfma_f32_16x16x32_bf16 v[76:79], a[96:99], v[164:167], v[76:79]
  ds_read_b128 v[180:183], v16 offset:10240
  v_mfma_f32_16x16x32_bf16 v[80:83], a[100:103], v[164:167], v[80:83]
  v_mfma_f32_16x16x32_bf16 v[84:87], a[104:107], v[164:167], v[84:87]
  s_waitcnt lgkmcnt(3)
  v_mfma_f32_16x16x32_bf16 v[88:91], a[96:99], v[168:171], v[88:91]
  ds_read_b128 v[184:187], v16 offset:12288
  v_mfma_f32_16x16x32_bf16 v[92:95], a[100:103], v[168:171], v[92:95]
  s_add_u32 m0, s31, 33792
  v_mfma_f32_16x16x32_bf16 v[96:99], a[104:107], v[168:171], v[96:99]
  s_waitcnt lgkmcnt(3)
  buffer_load_dwordx4 v11, s[8:11], s30 offen lds
  v_mfma_f32_16x16x32_bf16 v[100:103], a[96:99], v[172:175], v[100:103]
  ds_read_b128 v[188:191], v16 offset:14336
  v_mfma_f32_16x16x32_bf16 v[104:107], a[100:103], v[172:175], v[104:107]
  v_mfma_f32_16x16x32_bf16 v[108:111], a[104:107], v[172:175], v[108:111]
  s_waitcnt lgkmcnt(3)
  v_mfma_f32_16x16x32_bf16 v[112:115], a[96:99], v[176:179], v[112:115]
  ds_read_b128 v[160:163], v17 offset:0
  v_mfma_f32_16x16x32_bf16 v[116:119], a[100:103], v[176:179], v[116:119]
  s_add_u32 m0, s31, 34816
  v_mfma_f32_16x16x32_bf16 v[120:123], a[104:107], v[176:179], v[120:123]
  s_waitcnt lgkmcnt(3)
  buffer_load_dwordx4 v12, s[8:11], s30 offen lds
  v_mfma_f32_16x16x32_bf16 v[124:127], a[96:99], v[180:183], v[124:127]
  ds_read_b128 v[164:167], v17 offset:2048
  v_mfma_f32_16x16x32_bf16 v[128:131], a[100:103], v[180:183], v[128:131]
  v_mfma_f32_16x16x32_bf16 v[132:135], a[104:107], v[180:183], v[132:135]
  s_waitcnt lgkmcnt(3)
  v_mfma_f32_16x16x32_bf16 v[136:139], a[96:99], v[184:187], v[136:139]
  ds_read_b128 v[168:171], v17 offset:4096
  v_mfma_f32_16x16x32_bf16 v[140:143], a[100:103], v[184:187], v[140:143]
  s_add_u32 m0, s31, 35840
  v_mfma_f32_16x16x32_bf16 v[144:147], a[104:107], v[184:187], v[144:147]
  s_waitcnt lgkmcnt(3)
  buffer_load_dwordx4 v13, s[8:11], s30 offen lds
  v_mfma_f32_16x16x32_bf16 v[148:151], a[96:99], v[188:191], v[148:151]
  s_add_u32 s30, s30, 128
  ds_read_b128 v[172:175], v17 offset:6144
  v_mfma_f32_16x16x32_bf16 v[152:155], a[100:103], v[188:191], v[152:155]
  v_mfma_f32_16x16x32_bf16 v[156:159], a[104:107], v[188:191], v[156:159]
  s_waitcnt lgkmcnt(3)
  v_mfma_f32_16x16x32_bf16 v[64:67], a[108:111], v[160:163], v[64:67]
  ds_read_b128 v[176:179], v17 offset:8192
  v_mfma_f32_16x16x32_bf16 v[68:71], a[112:115], v[160:163], v[68:71]
  v_mfma_f32_16x16x32_bf16 v[72:75], a[116:119], v[160:163], v[72:75]
  s_waitcnt lgkmcnt(3)
  v_mfma_f32_16x16x32_bf16 v[76:79], a[108:111], v[164:167], v[76:79]
  ds_read_b128 v[180:183], v17 offset:10240
  v_mfma_f32_16x16x32_bf16 v[80:83], a[112:115], v[164:167], v[80:83]
  v_mfma_f32_16x16x32_bf16 v[84:87], a[116:119], v[164:167], v[84:87]
  s_waitcnt lgkmcnt(3)
  v_mfma_f32_16x16x32_bf16 v[88:91], a[108:111], v[168:171], v[88:91]
  ds_read_b128 v[184:187], v17 offset:12288
  v_mfma_f32_16x16x32_bf16 v[92:95], a[112:115], v[168:171], v[92:95]
  v_mfma_f32_16x16x32_bf16 v[96:99], a[116:119], v[168:171], v[96:99]
  s_waitcnt lgkmcnt(3)
  v_mfma_f32_16x16x32_bf16 v[100:103], a[108:111], v[172:175], v[100:103]
  ds_read_b128 v[188:191], v17 offset:14336
  v_mfma_f32_16x16x32_bf16 v[104:107], a[112:115], v[172:175], v[104:107]
  v_mfma_f32_16x16x32_bf16 v[108:111], a[116:119], v[172:175], v[108:111]
  s_waitcnt lgkmcnt(3)
  v_mfma_f32_16x16x32_bf16 v[112:115], a[108:111], v[176:179], v[112:115]
  s_waitcnt vmcnt(12)
  s_barrier
  ds_read_b128 v[160:163], v16 offset:16384
  v_mfma_f32_16x16x32_bf16 v[116:119], a[112:115], v[176:179], v[116:119]
  buffer_atomic_add v28, v27, s[72:75], s61 offen sc1
  v_mfma_f32_16x16x32_bf16 v[120:123], a[116:119], v[176:179], v[120:123]
  s_waitcnt lgkmcnt(3)
  s_mov_b32 s48, s27
  s_add_u32 s27, s27, s28
  v_mfma_f32_16x16x32_bf16 v[124:127], a[108:111], v[180:183], v[124:127]
  ds_read_b128 v[164:167], v16 offset:18432
  s_mov_b32 s61, s60
  v_mfma_f32_16x16x32_bf16 v[128:131], a[112:115], v[180:183], v[128:131]
  s_add_u32 s60, s60, 1024
  v_mfma_f32_16x16x32_bf16 v[132:135], a[116:119], v[180:183], v[132:135]
  s_waitcnt lgkmcnt(3)
  v_mfma_f32_16x16x32_bf16 v[136:139], a[108:111], v[184:187], v[136:139]
  ds_read_b128 v[168:171], v16 offset:20480
  v_mfma_f32_16x16x32_bf16 v[140:143], a[112:115], v[184:187], v[140:143]
  v_mfma_f32_16x16x32_bf16 v[144:147], a[116:119], v[184:187], v[144:147]
  s_waitcnt lgkmcnt(3)
  v_mfma_f32_16x16x32_bf16 v[148:151], a[108:111], v[188:191], v[148:151]
  ds_read_b128 v[172:175], v16 offset:22528
  v_mfma_f32_16x16x32_bf16 v[152:155], a[112:115], v[188:191], v[152:155]
  v_mfma_f32_16x16x32_bf16 v[156:159], a[116:119], v[188:191], v[156:159]
  s_waitcnt lgkmcnt(3)
  v_mfma_f32_16x16x32_bf16 v[64:67], a[120:123], v[160:163], v[64:67]
  ds_read_b128 v[176:179], v16 offset:24576
  v_mfma_f32_16x16x32_bf16 v[68:71], a[124:127], v[160:163], v[68:71]
  s_add_u32 m0, s31, 49152
  v_mfma_f32_16x16x32_bf16 v[72:75], a[128:131], v[160:163], v[72:75]
  s_waitcnt lgkmcnt(3)
  buffer_load_dwordx4 v10, s[8:11], s30 offen lds
  v_mfma_f32_16x16x32_bf16 v[76:79], a[120:123], v[164:167], v[76:79]
  ds_read_b128 v[180:183], v16 offset:26624
  v_mfma_f32_16x16x32_bf16 v[80:83], a[124:127], v[164:167], v[80:83]
  v_mfma_f32_16x16x32_bf16 v[84:87], a[128:131], v[164:167], v[84:87]
  s_waitcnt lgkmcnt(3)
  v_mfma_f32_16x16x32_bf16 v[88:91], a[120:123], v[168:171], v[88:91]
  ds_read_b128 v[184:187], v16 offset:28672
  v_mfma_f32_16x16x32_bf16 v[92:95], a[124:127], v[168:171], v[92:95]
  s_add_u32 m0, s31, 50176
  v_mfma_f32_16x16x32_bf16 v[96:99], a[128:131], v[168:171], v[96:99]
  s_waitcnt lgkmcnt(3)
  buffer_load_dwordx4 v11, s[8:11], s30 offen lds
  v_mfma_f32_16x16x32_bf16 v[100:103], a[120:123], v[172:175], v[100:103]
  ds_read_b128 v[188:191], v16 offset:30720
  v_mfma_f32_16x16x32_bf16 v[104:107], a[124:127], v[172:175], v[104:107]
  v_mfma_f32_16x16x32_bf16 v[108:111], a[128:131], v[172:175], v[108:111]
  s_waitcnt lgkmcnt(3)
  v_mfma_f32_16x16x32_bf16 v[112:115], a[120:123], v[176:179], v[112:115]
  ds_read_b128 v[160:163], v17 offset:16384
  v_mfma_f32_16x16x32_bf16 v[116:119], a[124:127], v[176:179], v[116:119]
  s_add_u32 m0, s31, 51200
  v_mfma_f32_16x16x32_bf16 v[120:123], a[128:131], v[176:179], v[120:123]
  s_waitcnt lgkmcnt(3)
  buffer_load_dwordx4 v12, s[8:11], s30 offen lds
  v_mfma_f32_16x16x32_bf16 v[124:127], a[120:123], v[180:183], v[124:127]
  ds_read_b128 v[164:167], v17 offset:18432
  v_mfma_f32_16x16x32_bf16 v[128:131], a[124:127], v[180:183], v[128:131]
  v_mfma_f32_16x16x32_bf16 v[132:135], a[128:131], v[180:183], v[132:135]
  s_waitcnt lgkmcnt(3)
  v_mfma_f32_16x16x32_bf16 v[136:139], a[120:123], v[184:187], v[136:139]
  ds_read_b128 v[168:171], v17 offset:20480
  v_mfma_f32_16x16x32_bf16 v[140:143], a[124:127], v[184:187], v[140:143]
  s_add_u32 m0, s31, 52224
  v_mfma_f32_16x16x32_bf16 v[144:147], a[128:131], v[184:187], v[144:147]
  s_waitcnt lgkmcnt(3)
  buffer_load_dwordx4 v13, s[8:11], s30 offen lds
  v_mfma_f32_16x16x32_bf16 v[148:151], a[120:123], v[188:191], v[148:151]
  s_add_u32 s30, s30, 128
  ds_read_b128 v[172:175], v17 offset:22528
  v_mfma_f32_16x16x32_bf16 v[152:155], a[124:127], v[188:191], v[152:155]
  v_mfma_f32_16x16x32_bf16 v[156:159], a[128:131], v[188:191], v[156:159]
  s_waitcnt lgkmcnt(3)
  v_mfma_f32_16x16x32_bf16 v[64:67], a[132:135], v[160:163], v[64:67]
  ds_read_b128 v[176:179], v17 offset:24576
  v_mfma_f32_16x16x32_bf16 v[68:71], a[136:139], v[160:163], v[68:71]
  v_mfma_f32_16x16x32_bf16 v[72:75], a[140:143], v[160:163], v[72:75]
  s_waitcnt lgkmcnt(3)
  v_mfma_f32_16x16x32_bf16 v[76:79], a[132:135], v[164:167], v[76:79]
  ds_read_b128 v[180:183], v17 offset:26624
  v_mfma_f32_16x16x32_bf16 v[80:83], a[136:139], v[164:167], v[80:83]
  v_mfma_f32_16x16x32_bf16 v[84:87], a[140:143], v[164:167], v[84:87]
  s_waitcnt lgkmcnt(3)
  v_mfma_f32_16x16x32_bf16 v[88:91], a[132:135], v[168:171], v[88:91]
  ds_read_b128 v[184:187], v17 offset:28672
  v_mfma_f32_16x16x32_bf16 v[92:95], a[136:139], v[168:171], v[92:95]
  v_mfma_f32_16x16x32_bf16 v[96:99], a[140:143], v[168:171], v[96:99]
  s_waitcnt lgkmcnt(3)
  v_mfma_f32_16x16x32_bf16 v[100:103], a[132:135], v[172:175], v[100:103]
  ds_read_b128 v[188:191], v17 offset:30720
  v_mfma_f32_16x16x32_bf16 v[104:107], a[136:139], v[172:175], v[104:107]
  v_mfma_f32_16x16x32_bf16 v[108:111], a[140:143], v[172:175], v[108:111]
  s_waitcnt lgkmcnt(3)
  v_mfma_f32_16x16x32_bf16 v[112:115], a[132:135], v[176:179], v[112:115]
  s_waitcnt vmcnt(41)
  s_barrier
  ds_read_b128 v[160:163], v16 offset:32768
  v_mfma_f32_16x16x32_bf16 v[116:119], a[136:139], v[176:179], v[116:119]
  v_mfma_f32_16x16x32_bf16 v[120:123], a[140:143], v[176:179], v[120:123]
  s_waitcnt lgkmcnt(3)
  v_mfma_f32_16x16x32_bf16 v[124:127], a[132:135], v[180:183], v[124:127]
  ds_read_b128 v[164:167], v16 offset:34816
  v_mfma_f32_16x16x32_bf16 v[128:131], a[136:139], v[180:183], v[128:131]
  v_mfma_f32_16x16x32_bf16 v[132:135], a[140:143], v[180:183], v[132:135]
  s_waitcnt lgkmcnt(3)
  v_mfma_f32_16x16x32_bf16 v[136:139], a[132:135], v[184:187], v[136:139]
  ds_read_b128 v[168:171], v16 offset:36864
  v_mfma_f32_16x16x32_bf16 v[140:143], a[136:139], v[184:187], v[140:143]
  v_mfma_f32_16x16x32_bf16 v[144:147], a[140:143], v[184:187], v[144:147]
  s_waitcnt lgkmcnt(3)
  v_mfma_f32_16x16x32_bf16 v[148:151], a[132:135], v[188:191], v[148:151]
  ds_read_b128 v[172:175], v16 offset:38912
  v_mfma_f32_16x16x32_bf16 v[152:155], a[136:139], v[188:191], v[152:155]
  v_mfma_f32_16x16x32_bf16 v[156:159], a[140:143], v[188:191], v[156:159]
  s_waitcnt lgkmcnt(3)
  v_mfma_f32_16x16x32_bf16 v[64:67], a[144:147], v[160:163], v[64:67]
  ds_read_b128 v[176:179], v16 offset:40960
  v_mfma_f32_16x16x32_bf16 v[68:71], a[148:151], v[160:163], v[68:71]
  s_add_u32 m0, s31, 65536
  v_mfma_f32_16x16x32_bf16 v[72:75], a[152:155], v[160:163], v[72:75]
  s_waitcnt lgkmcnt(3)
  buffer_load_dwordx4 v10, s[8:11], s30 offen lds
  v_mfma_f32_16x16x32_bf16 v[76:79], a[144:147], v[164:167], v[76:79]
  ds_read_b128 v[180:183], v16 offset:43008
  v_mfma_f32_16x16x32_bf16 v[80:83], a[148:151], v[164:167], v[80:83]
  v_mfma_f32_16x16x32_bf16 v[84:87], a[152:155], v[164:167], v[84:87]
  s_waitcnt lgkmcnt(3)
  v_mfma_f32_16x16x32_bf16 v[88:91], a[144:147], v[168:171], v[88:91]
  ds_read_b128 v[184:187], v16 offset:45056
  v_mfma_f32_16x16x32_bf16 v[92:95], a[148:151], v[168:171], v[92:95]
  s_add_u32 m0, s31, 66560
  v_mfma_f32_16x16x32_bf16 v[96:99], a[152:155], v[168:171], v[96:99]
  s_waitcnt lgkmcnt(3)
  buffer_load_dwordx4 v11, s[8:11], s30 offen lds
  v_mfma_f32_16x16x32_bf16 v[100:103], a[144:147], v[172:175], v[100:103]
  ds_read_b128 v[188:191], v16 offset:47104
  v_mfma_f32_16x16x32_bf16 v[104:107], a[148:151], v[172:175], v[104:107]
  v_mfma_f32_16x16x32_bf16 v[108:111], a[152:155], v[172:175], v[108:111]
  s_waitcnt lgkmcnt(3)
  v_mfma_f32_16x16x32_bf16 v[112:115], a[144:147], v[176:179], v[112:115]
  ds_read_b128 v[160:163], v17 offset:32768
  v_mfma_f32_16x16x32_bf16 v[116:119], a[148:151], v[176:179], v[116:119]
  s_add_u32 m0, s31, 67584
  v_mfma_f32_16x16x32_bf16 v[120:123], a[152:155], v[176:179], v[120:123]
  s_waitcnt lgkmcnt(3)
  buffer_load_dwordx4 v12, s[8:11], s30 offen lds
  v_mfma_f32_16x16x32_bf16 v[124:127], a[144:147], v[180:183], v[124:127]
  ds_read_b128 v[164:167], v17 offset:34816
  v_mfma_f32_16x16x32_bf16 v[128:131], a[148:151], v[180:183], v[128:131]
  v_mfma_f32_16x16x32_bf16 v[132:135], a[152:155], v[180:183], v[132:135]
  s_waitcnt lgkmcnt(3)
  v_mfma_f32_16x16x32_bf16 v[136:139], a[144:147], v[184:187], v[136:139]
  ds_read_b128 v[168:171], v17 offset:36864
  v_mfma_f32_16x16x32_bf16 v[140:143], a[148:151], v[184:187], v[140:143]
  s_add_u32 m0, s31, 68608
  v_mfma_f32_16x16x32_bf16 v[144:147], a[152:155], v[184:187], v[144:147]
  s_waitcnt lgkmcnt(3)
  buffer_load_dwordx4 v13, s[8:11], s30 offen lds
  v_mfma_f32_16x16x32_bf16 v[148:151], a[144:147], v[188:191], v[148:151]
  s_add_u32 s30, s30, 128
  ds_read_b128 v[172:175], v17 offset:38912
  v_mfma_f32_16x16x32_bf16 v[152:155], a[148:151], v[188:191], v[152:155]
  v_mfma_f32_16x16x32_bf16 v[156:159], a[152:155], v[188:191], v[156:159]
  s_waitcnt lgkmcnt(3)
  v_mfma_f32_16x16x32_bf16 v[64:67], a[156:159], v[160:163], v[64:67]
  ds_read_b128 v[176:179], v17 offset:40960
  v_mfma_f32_16x16x32_bf16 v[68:71], a[160:163], v[160:163], v[68:71]
  v_mfma_f32_16x16x32_bf16 v[72:75], a[164:167], v[160:163], v[72:75]
  s_waitcnt lgkmcnt(3)
  v_mfma_f32_16x16x32_bf16 v[76:79], a[156:159], v[164:167], v[76:79]
  ds_read_b128 v[180:183], v17 offset:43008
  v_mfma_f32_16x16x32_bf16 v[80:83], a[160:163], v[164:167], v[80:83]
  v_mfma_f32_16x16x32_bf16 v[84:87], a[164:167], v[164:167], v[84:87]
  s_waitcnt lgkmcnt(3)
  v_mfma_f32_16x16x32_bf16 v[88:91], a[156:159], v[168:171], v[88:91]
  ds_read_b128 v[184:187], v17 offset:45056
  v_mfma_f32_16x16x32_bf16 v[92:95], a[160:163], v[168:171], v[92:95]
  v_mfma_f32_16x16x32_bf16 v[96:99], a[164:167], v[168:171], v[96:99]
  s_waitcnt lgkmcnt(3)
  v_mfma_f32_16x16x32_bf16 v[100:103], a[156:159], v[172:175], v[100:103]
  ds_read_b128 v[188:191], v17 offset:47104
  v_mfma_f32_16x16x32_bf16 v[104:107], a[160:163], v[172:175], v[104:107]
  v_mfma_f32_16x16x32_bf16 v[108:111], a[164:167], v[172:175], v[108:111]
  s_waitcnt lgkmcnt(3)
  v_mfma_f32_16x16x32_bf16 v[112:115], a[156:159], v[176:179], v[112:115]
  s_waitcnt vmcnt(41)
  s_barrier
  ds_read_b128 v[160:163], v16 offset:49152
  v_mfma_f32_16x16x32_bf16 v[116:119], a[160:163], v[176:179], v[116:119]
  v_mfma_f32_16x16x32_bf16 v[120:123], a[164:167], v[176:179], v[120:123]
  s_waitcnt lgkmcnt(3)
  v_mfma_f32_16x16x32_bf16 v[124:127], a[156:159], v[180:183], v[124:127]
  ds_read_b128 v[164:167], v16 offset:51200
  v_mfma_f32_16x16x32_bf16 v[128:131], a[160:163], v[180:183], v[128:131]
  v_mfma_f32_16x16x32_bf16 v[132:135], a[164:167], v[180:183], v[132:135]
  s_waitcnt lgkmcnt(3)
  v_mfma_f32_16x16x32_bf16 v[136:139], a[156:159], v[184:187], v[136:139]
  ds_read_b128 v[168:171], v16 offset:53248
  v_mfma_f32_16x16x32_bf16 v[140:143], a[160:163], v[184:187], v[140:143]
  v_mfma_f32_16x16x32_bf16 v[144:147], a[164:167], v[184:187], v[144:147]
  s_waitcnt lgkmcnt(3)
  v_mfma_f32_16x16x32_bf16 v[148:151], a[156:159], v[188:191], v[148:151]
  ds_read_b128 v[172:175], v16 offset:55296
  v_mfma_f32_16x16x32_bf16 v[152:155], a[160:163], v[188:191], v[152:155]
  v_mfma_f32_16x16x32_bf16 v[156:159], a[164:167], v[188:191], v[156:159]
  s_waitcnt lgkmcnt(3)
  v_mfma_f32_16x16x32_bf16 v[64:67], a[168:171], v[160:163], v[64:67]
  ds_read_b128 v[176:179], v16 offset:57344
  v_mfma_f32_16x16x32_bf16 v[68:71], a[172:175], v[160:163], v[68:71]
  s_add_u32 m0, s31, 81920
  v_mfma_f32_16x16x32_bf16 v[72:75], a[176:179], v[160:163], v[72:75]
  s_waitcnt lgkmcnt(3)
  buffer_load_dwordx4 v10, s[8:11], s30 offen lds
  v_mfma_f32_16x16x32_bf16 v[76:79], a[168:171], v[164:167], v[76:79]
  ds_read_b128 v[180:183], v16 offset:59392
  v_mfma_f32_16x16x32_bf16 v[80:83], a[172:175], v[164:167], v[80:83]
  v_mfma_f32_16x16x32_bf16 v[84:87], a[176:179], v[164:167], v[84:87]
  s_waitcnt lgkmcnt(3)
  v_mfma_f32_16x16x32_bf16 v[88:91], a[168:171], v[168:171], v[88:91]
  ds_read_b128 v[184:187], v16 offset:61440
  v_mfma_f32_16x16x32_bf16 v[92:95], a[172:175], v[168:171], v[92:95]
  s_add_u32 m0, s31, 82944
  v_mfma_f32_16x16x32_bf16 v[96:99], a[176:179], v[168:171], v[96:99]
  s_waitcnt lgkmcnt(3)
  buffer_load_dwordx4 v11, s[8:11], s30 offen lds
  v_mfma_f32_16x16x32_bf16 v[100:103], a[168:171], v[172:175], v[100:103]
  ds_read_b128 v[188:191], v16 offset:63488
  v_mfma_f32_16x16x32_bf16 v[104:107], a[172:175], v[172:175], v[104:107]
  v_mfma_f32_16x16x32_bf16 v[108:111], a[176:179], v[172:175], v[108:111]
  s_waitcnt lgkmcnt(3)
  v_mfma_f32_16x16x32_bf16 v[112:115], a[168:171], v[176:179], v[112:115]
  ds_read_b128 v[160:163], v17 offset:49152
  v_mfma_f32_16x16x32_bf16 v[116:119], a[172:175], v[176:179], v[116:119]
  s_add_u32 m0, s31, 83968
  v_mfma_f32_16x16x32_bf16 v[120:123], a[176:179], v[176:179], v[120:123]
  s_waitcnt lgkmcnt(3)
  buffer_load_dwordx4 v12, s[8:11], s30 offen lds
  v_mfma_f32_16x16x32_bf16 v[124:127], a[168:171], v[180:183], v[124:127]
  ds_read_b128 v[164:167], v17 offset:51200
  v_mfma_f32_16x16x32_bf16 v[128:131], a[172:175], v[180:183], v[128:131]
  v_mfma_f32_16x16x32_bf16 v[132:135], a[176:179], v[180:183], v[132:135]
  s_waitcnt lgkmcnt(3)
  v_mfma_f32_16x16x32_bf16 v[136:139], a[168:171], v[184:187], v[136:139]
  ds_read_b128 v[168:171], v17 offset:53248
  v_mfma_f32_16x16x32_bf16 v[140:143], a[172:175], v[184:187], v[140:143]
  s_add_u32 m0, s31, 84992
  v_mfma_f32_16x16x32_bf16 v[144:147], a[176:179], v[184:187], v[144:147]
  s_waitcnt lgkmcnt(3)
  buffer_load_dwordx4 v13, s[8:11], s30 offen lds
  v_mfma_f32_16x16x32_bf16 v[148:151], a[168:171], v[188:191], v[148:151]
  s_add_u32 s30, s30, 128
  ds_read_b128 v[172:175], v17 offset:55296
  v_mfma_f32_16x16x32_bf16 v[152:155], a[172:175], v[188:191], v[152:155]
  v_mfma_f32_16x16x32_bf16 v[156:159], a[176:179], v[188:191], v[156:159]
  s_waitcnt lgkmcnt(3)
  v_mfma_f32_16x16x32_bf16 v[64:67], a[180:183], v[160:163], v[64:67]
  ds_read_b128 v[176:179], v17 offset:57344
  v_mfma_f32_16x16x32_bf16 v[68:71], a[184:187], v[160:163], v[68:71]
  v_mfma_f32_16x16x32_bf16 v[72:75], a[188:191], v[160:163], v[72:75]
  s_waitcnt lgkmcnt(3)
  v_mfma_f32_16x16x32_bf16 v[76:79], a[180:183], v[164:167], v[76:79]
  ds_read_b128 v[180:183], v17 offset:59392
  v_mfma_f32_16x16x32_bf16 v[80:83], a[184:187], v[164:167], v[80:83]
  v_mfma_f32_16x16x32_bf16 v[84:87], a[188:191], v[164:167], v[84:87]
  s_waitcnt lgkmcnt(3)
  v_mfma_f32_16x16x32_bf16 v[88:91], a[180:183], v[168:171], v[88:91]
  ds_read_b128 v[184:187], v17 offset:61440
  v_mfma_f32_16x16x32_bf16 v[92:95], a[184:187], v[168:171], v[92:95]
  v_mfma_f32_16x16x32_bf16 v[96:99], a[188:191], v[168:171], v[96:99]
  s_waitcnt lgkmcnt(3)
  v_mfma_f32_16x16x32_bf16 v[100:103], a[180:183], v[172:175], v[100:103]
  ds_read_b128 v[188:191], v17 offset:63488
  v_mfma_f32_16x16x32_bf16 v[104:107], a[184:187], v[172:175], v[104:107]
  v_mfma_f32_16x16x32_bf16 v[108:111], a[188:191], v[172:175], v[108:111]
  s_waitcnt lgkmcnt(3)
  v_mfma_f32_16x16x32_bf16 v[112:115], a[180:183], v[176:179], v[112:115]
  s_waitcnt vmcnt(37)
  s_barrier
  ds_read_b128 v[160:163], v18 offset:0
  v_mfma_f32_16x16x32_bf16 v[116:119], a[184:187], v[176:179], v[116:119]
  v_mfma_f32_16x16x32_bf16 v[120:123], a[188:191], v[176:179], v[120:123]
  s_waitcnt lgkmcnt(3)
  v_mfma_f32_16x16x32_bf16 v[124:127], a[180:183], v[180:183], v[124:127]
  ds_read_b128 v[164:167], v18 offset:2048
  v_mfma_f32_16x16x32_bf16 v[128:131], a[184:187], v[180:183], v[128:131]
  v_mfma_f32_16x16x32_bf16 v[132:135], a[188:191], v[180:183], v[132:135]
  s_waitcnt lgkmcnt(3)
  v_mfma_f32_16x16x32_bf16 v[136:139], a[180:183], v[184:187], v[136:139]
  ds_read_b128 v[168:171], v18 offset:4096
  v_mfma_f32_16x16x32_bf16 v[140:143], a[184:187], v[184:187], v[140:143]
  v_mfma_f32_16x16x32_bf16 v[144:147], a[188:191], v[184:187], v[144:147]
  s_waitcnt lgkmcnt(3)
  v_mfma_f32_16x16x32_bf16 v[148:151], a[180:183], v[188:191], v[148:151]
  ds_read_b128 v[172:175], v18 offset:6144
  v_mfma_f32_16x16x32_bf16 v[152:155], a[184:187], v[188:191], v[152:155]
  v_mfma_f32_16x16x32_bf16 v[156:159], a[188:191], v[188:191], v[156:159]
  s_waitcnt lgkmcnt(3)
  v_mfma_f32_16x16x32_bf16 v[64:67], a[192:195], v[160:163], v[64:67]
  ds_read_b128 v[176:179], v18 offset:8192
  v_mfma_f32_16x16x32_bf16 v[68:71], a[196:199], v[160:163], v[68:71]
  s_add_u32 m0, s31, 98304
  v_mfma_f32_16x16x32_bf16 v[72:75], a[200:203], v[160:163], v[72:75]
  s_waitcnt lgkmcnt(3)
  buffer_load_dwordx4 v10, s[8:11], s30 offen lds
  v_mfma_f32_16x16x32_bf16 v[76:79], a[192:195], v[164:167], v[76:79]
  ds_read_b128 v[180:183], v18 offset:10240
  v_mfma_f32_16x16x32_bf16 v[80:83], a[196:199], v[164:167], v[80:83]
  v_mfma_f32_16x16x32_bf16 v[84:87], a[200:203], v[164:167], v[84:87]
  s_waitcnt lgkmcnt(3)
  v_mfma_f32_16x16x32_bf16 v[88:91], a[192:195], v[168:171], v[88:91]
  ds_read_b128 v[184:187], v18 offset:12288
  v_mfma_f32_16x16x32_bf16 v[92:95], a[196:199], v[168:171], v[92:95]
  s_add_u32 m0, s31, 99328
  v_mfma_f32_16x16x32_bf16 v[96:99], a[200:203], v[168:171], v[96:99]
  s_waitcnt lgkmcnt(3)
  buffer_load_dwordx4 v11, s[8:11], s30 offen lds
  v_mfma_f32_16x16x32_bf16 v[100:103], a[192:195], v[172:175], v[100:103]
  ds_read_b128 v[188:191], v18 offset:14336
  v_mfma_f32_16x16x32_bf16 v[104:107], a[196:199], v[172:175], v[104:107]
  v_mfma_f32_16x16x32_bf16 v[108:111], a[200:203], v[172:175], v[108:111]
  s_waitcnt lgkmcnt(3)
  v_mfma_f32_16x16x32_bf16 v[112:115], a[192:195], v[176:179], v[112:115]
  ds_read_b128 v[160:163], v19 offset:0
  v_mfma_f32_16x16x32_bf16 v[116:119], a[196:199], v[176:179], v[116:119]
  s_add_u32 m0, s31, 100352
  v_mfma_f32_16x16x32_bf16 v[120:123], a[200:203], v[176:179], v[120:123]
  s_waitcnt lgkmcnt(3)
  buffer_load_dwordx4 v12, s[8:11], s30 offen lds
  v_mfma_f32_16x16x32_bf16 v[124:127], a[192:195], v[180:183], v[124:127]
  ds_read_b128 v[164:167], v19 offset:2048
  v_mfma_f32_16x16x32_bf16 v[128:131], a[196:199], v[180:183], v[128:131]
  v_mfma_f32_16x16x32_bf16 v[132:135], a[200:203], v[180:183], v[132:135]
  s_waitcnt lgkmcnt(3)
  v_mfma_f32_16x16x32_bf16 v[136:139], a[192:195], v[184:187], v[136:139]
  ds_read_b128 v[168:171], v19 offset:4096
  v_mfma_f32_16x16x32_bf16 v[140:143], a[196:199], v[184:187], v[140:143]
  s_add_u32 m0, s31, 101376
  v_mfma_f32_16x16x32_bf16 v[144:147], a[200:203], v[184:187], v[144:147]
  s_waitcnt lgkmcnt(3)
  buffer_load_dwordx4 v13, s[8:11], s30 offen lds
  v_mfma_f32_16x16x32_bf16 v[148:151], a[192:195], v[188:191], v[148:151]
  s_add_u32 s30, s30, 128
  ds_read_b128 v[172:175], v19 offset:6144
  v_mfma_f32_16x16x32_bf16 v[152:155], a[196:199], v[188:191], v[152:155]
  v_mfma_f32_16x16x32_bf16 v[156:159], a[200:203], v[188:191], v[156:159]
  s_waitcnt lgkmcnt(3)
  v_mfma_f32_16x16x32_bf16 v[64:67], a[204:207], v[160:163], v[64:67]
  ds_read_b128 v[176:179], v19 offset:8192
  v_mfma_f32_16x16x32_bf16 v[68:71], a[208:211], v[160:163], v[68:71]
  v_mfma_f32_16x16x32_bf16 v[72:75], a[212:215], v[160:163], v[72:75]
  s_waitcnt lgkmcnt(3)
  v_mfma_f32_16x16x32_bf16 v[76:79], a[204:207], v[164:167], v[76:79]
  ds_read_b128 v[180:183], v19 offset:10240
  v_mfma_f32_16x16x32_bf16 v[80:83], a[208:211], v[164:167], v[80:83]
  v_mfma_f32_16x16x32_bf16 v[84:87], a[212:215], v[164:167], v[84:87]
  s_waitcnt lgkmcnt(3)
  v_mfma_f32_16x16x32_bf16 v[88:91], a[204:207], v[168:171], v[88:91]
  ds_read_b128 v[184:187], v19 offset:12288
  v_mfma_f32_16x16x32_bf16 v[92:95], a[208:211], v[168:171], v[92:95]
  v_mfma_f32_16x16x32_bf16 v[96:99], a[212:215], v[168:171], v[96:99]
  s_waitcnt lgkmcnt(3)
  v_mfma_f32_16x16x32_bf16 v[100:103], a[204:207], v[172:175], v[100:103]
  ds_read_b128 v[188:191], v19 offset:14336
  v_mfma_f32_16x16x32_bf16 v[104:107], a[208:211], v[172:175], v[104:107]
  v_mfma_f32_16x16x32_bf16 v[108:111], a[212:215], v[172:175], v[108:111]
  s_waitcnt lgkmcnt(3)
  v_mfma_f32_16x16x32_bf16 v[112:115], a[204:207], v[176:179], v[112:115]
  s_waitcnt vmcnt(32)
  s_barrier
  ds_read_b128 v[160:163], v18 offset:16384
  v_mfma_f32_16x16x32_bf16 v[116:119], a[208:211], v[176:179], v[116:119]
  v_mfma_f32_16x16x32_bf16 v[120:123], a[212:215], v[176:179], v[120:123]
  s_waitcnt lgkmcnt(3)
  v_mfma_f32_16x16x32_bf16 v[124:127], a[204:207], v[180:183], v[124:127]
  ds_read_b128 v[164:167], v18 offset:18432
  v_mfma_f32_16x16x32_bf16 v[128:131], a[208:211], v[180:183], v[128:131]
  v_mfma_f32_16x16x32_bf16 v[132:135], a[212:215], v[180:183], v[132:135]
  s_waitcnt lgkmcnt(3)
  v_mfma_f32_16x16x32_bf16 v[136:139], a[204:207], v[184:187], v[136:139]
  ds_read_b128 v[168:171], v18 offset:20480
  v_mfma_f32_16x16x32_bf16 v[140:143], a[208:211], v[184:187], v[140:143]
  v_mfma_f32_16x16x32_bf16 v[144:147], a[212:215], v[184:187], v[144:147]
  s_waitcnt lgkmcnt(3)
  v_mfma_f32_16x16x32_bf16 v[148:151], a[204:207], v[188:191], v[148:151]
  ds_read_b128 v[172:175], v18 offset:22528
  v_mfma_f32_16x16x32_bf16 v[152:155], a[208:211], v[188:191], v[152:155]
  v_mfma_f32_16x16x32_bf16 v[156:159], a[212:215], v[188:191], v[156:159]
  s_waitcnt lgkmcnt(3)
  v_mfma_f32_16x16x32_bf16 v[64:67], a[216:219], v[160:163], v[64:67]
  ds_read_b128 v[176:179], v18 offset:24576
  v_mfma_f32_16x16x32_bf16 v[68:71], a[220:223], v[160:163], v[68:71]
  s_add_u32 m0, s31, 114688
  v_mfma_f32_16x16x32_bf16 v[72:75], a[224:227], v[160:163], v[72:75]
  s_waitcnt lgkmcnt(3)
  buffer_load_dwordx4 v10, s[8:11], s30 offen lds
  v_mfma_f32_16x16x32_bf16 v[76:79], a[216:219], v[164:167], v[76:79]
  ds_read_b128 v[180:183], v18 offset:26624
  v_mfma_f32_16x16x32_bf16 v[80:83], a[220:223], v[164:167], v[80:83]
  v_mfma_f32_16x16x32_bf16 v[84:87], a[224:227], v[164:167], v[84:87]
  s_waitcnt lgkmcnt(3)
  v_mfma_f32_16x16x32_bf16 v[88:91], a[216:219], v[168:171], v[88:91]
  ds_read_b128 v[184:187], v18 offset:28672
  v_mfma_f32_16x16x32_bf16 v[92:95], a[220:223], v[168:171], v[92:95]
  s_add_u32 m0, s31, 115712
  v_mfma_f32_16x16x32_bf16 v[96:99], a[224:227], v[168:171], v[96:99]
  s_waitcnt lgkmcnt(3)
  buffer_load_dwordx4 v11, s[8:11], s30 offen lds
  v_mfma_f32_16x16x32_bf16 v[100:103], a[216:219], v[172:175], v[100:103]
  ds_read_b128 v[188:191], v18 offset:30720
  v_mfma_f32_16x16x32_bf16 v[104:107], a[220:223], v[172:175], v[104:107]
  v_mfma_f32_16x16x32_bf16 v[108:111], a[224:227], v[172:175], v[108:111]
  s_waitcnt lgkmcnt(3)
  v_mfma_f32_16x16x32_bf16 v[112:115], a[216:219], v[176:179], v[112:115]
  ds_read_b128 v[160:163], v19 offset:16384
  v_mfma_f32_16x16x32_bf16 v[116:119], a[220:223], v[176:179], v[116:119]
  s_add_u32 m0, s31, 116736
  v_mfma_f32_16x16x32_bf16 v[120:123], a[224:227], v[176:179], v[120:123]
  s_waitcnt lgkmcnt(3)
  buffer_load_dwordx4 v12, s[8:11], s30 offen lds
  v_mfma_f32_16x16x32_bf16 v[124:127], a[216:219], v[180:183], v[124:127]
  ds_read_b128 v[164:167], v19 offset:18432
  v_mfma_f32_16x16x32_bf16 v[128:131], a[220:223], v[180:183], v[128:131]
  v_mfma_f32_16x16x32_bf16 v[132:135], a[224:227], v[180:183], v[132:135]
  s_waitcnt lgkmcnt(3)
  v_mfma_f32_16x16x32_bf16 v[136:139], a[216:219], v[184:187], v[136:139]
  ds_read_b128 v[168:171], v19 offset:20480
  v_mfma_f32_16x16x32_bf16 v[140:143], a[220:223], v[184:187], v[140:143]
  s_add_u32 m0, s31, 117760
  v_mfma_f32_16x16x32_bf16 v[144:147], a[224:227], v[184:187], v[144:147]
  s_waitcnt lgkmcnt(3)
  buffer_load_dwordx4 v13, s[8:11], s30 offen lds
  v_mfma_f32_16x16x32_bf16 v[148:151], a[216:219], v[188:191], v[148:151]
  s_add_u32 s30, s30, 128
  ds_read_b128 v[172:175], v19 offset:22528
  v_mfma_f32_16x16x32_bf16 v[152:155], a[220:223], v[188:191], v[152:155]
  v_mfma_f32_16x16x32_bf16 v[156:159], a[224:227], v[188:191], v[156:159]
  s_waitcnt lgkmcnt(3)
  v_mfma_f32_16x16x32_bf16 v[64:67], a[228:231], v[160:163], v[64:67]
  ds_read_b128 v[176:179], v19 offset:24576
  v_mfma_f32_16x16x32_bf16 v[68:71], a[232:235], v[160:163], v[68:71]
  v_mfma_f32_16x16x32_bf16 v[72:75], a[236:239], v[160:163], v[72:75]
  s_waitcnt lgkmcnt(3)
  v_mfma_f32_16x16x32_bf16 v[76:79], a[228:231], v[164:167], v[76:79]
  ds_read_b128 v[180:183], v19 offset:26624
  v_cvt_pk_bf16_f32 v192, v64, v65
  v_mfma_f32_16x16x32_bf16 v[80:83], a[232:235], v[164:167], v[80:83]
  v_cvt_pk_bf16_f32 v193, v66, v67
  v_cvt_pk_bf16_f32 v194, v68, v69
  v_mfma_f32_16x16x32_bf16 v[84:87], a[236:239], v[164:167], v[84:87]
  s_waitcnt lgkmcnt(3)
  v_cvt_pk_bf16_f32 v195, v70, v71
  v_cvt_pk_bf16_f32 v200, v72, v73
  v_mfma_f32_16x16x32_bf16 v[88:91], a[228:231], v[168:171], v[88:91]
  ds_read_b128 v[184:187], v19 offset:28672
  v_cvt_pk_bf16_f32 v201, v74, v75
  v_mfma_f32_16x16x32_bf16 v[92:95], a[232:235], v[168:171], v[92:95]
  v_cvt_pk_bf16_f32 v196, v76, v77
  v_cvt_pk_bf16_f32 v197, v78, v79
  v_mfma_f32_16x16x32_bf16 v[96:99], a[236:239], v[168:171], v[96:99]
  s_waitcnt lgkmcnt(3)
  v_cvt_pk_bf16_f32 v198, v80, v81
  v_cvt_pk_bf16_f32 v199, v82, v83
  v_mfma_f32_16x16x32_bf16 v[100:103], a[228:231], v[172:175], v[100:103]
  ds_read_b128 v[188:191], v19 offset:30720
  v_cvt_pk_bf16_f32 v202, v84, v85
  v_mfma_f32_16x16x32_bf16 v[104:107], a[232:235], v[172:175], v[104:107]
  v_cvt_pk_bf16_f32 v203, v86, v87
  v_cvt_pk_bf16_f32 v204, v88, v89
  v_mfma_f32_16x16x32_bf16 v[108:111], a[236:239], v[172:175], v[108:111]
  s_waitcnt lgkmcnt(3)
  v_cvt_pk_bf16_f32 v205, v90, v91
  v_cvt_pk_bf16_f32 v206, v92, v93
  v_mfma_f32_16x16x32_bf16 v[112:115], a[228:231], v[176:179], v[112:115]
  s_waitcnt vmcnt(29)
  s_barrier
  ds_read_b128 v[160:163], v14 offset:0
  v_mfma_f32_16x16x32_bf16 v[116:119], a[232:235], v[176:179], v[116:119]
  v_cvt_pk_bf16_f32 v207, v94, v95
  v_cvt_pk_bf16_f32 v212, v96, v97
  v_mfma_f32_16x16x32_bf16 v[120:123], a[236:239], v[176:179], v[120:123]
  s_waitcnt lgkmcnt(3)
  v_cvt_pk_bf16_f32 v213, v98, v99
  v_cvt_pk_bf16_f32 v208, v100, v101
  v_mfma_f32_16x16x32_bf16 v[124:127], a[228:231], v[180:183], v[124:127]
  ds_read_b128 v[164:167], v14 offset:2048
  v_cvt_pk_bf16_f32 v209, v102, v103
  v_mfma_f32_16x16x32_bf16 v[128:131], a[232:235], v[180:183], v[128:131]
  v_cvt_pk_bf16_f32 v210, v104, v105
  v_cvt_pk_bf16_f32 v211, v106, v107
  v_mfma_f32_16x16x32_bf16 v[132:135], a[236:239], v[180:183], v[132:135]
  s_waitcnt lgkmcnt(3)
  v_cvt_pk_bf16_f32 v214, v108, v109
  v_cvt_pk_bf16_f32 v215, v110, v111
  v_mfma_f32_16x16x32_bf16 v[136:139], a[228:231], v[184:187], v[136:139]
  ds_read_b128 v[168:171], v14 offset:4096
  v_cvt_pk_bf16_f32 v216, v112, v113
  v_mfma_f32_16x16x32_bf16 v[140:143], a[232:235], v[184:187], v[140:143]
  v_cvt_pk_bf16_f32 v217, v114, v115
  v_cvt_pk_bf16_f32 v218, v116, v117
  v_mfma_f32_16x16x32_bf16 v[144:147], a[236:239], v[184:187], v[144:147]
  s_waitcnt lgkmcnt(3)
  v_cvt_pk_bf16_f32 v219, v118, v119
  v_cvt_pk_bf16_f32 v224, v120, v121
  v_mfma_f32_16x16x32_bf16 v[148:151], a[228:231], v[188:191], v[148:151]
  ds_read_b128 v[172:175], v14 offset:6144
  v_cvt_pk_bf16_f32 v225, v122, v123
  v_mfma_f32_16x16x32_bf16 v[152:155], a[232:235], v[188:191], v[152:155]
  s_sub_u32 s26, s26, 1
  s_cmp_gt_u32 s26, 0
  v_cvt_pk_bf16_f32 v220, v124, v125
  v_mfma_f32_16x16x32_bf16 v[156:159], a[236:239], v[188:191], v[156:159]
  s_waitcnt lgkmcnt(3)
  s_cbranch_scc1 kvs_197
  s_nop 7
  v_cvt_pk_bf16_f32 v221, v126, v127
  v_cvt_pk_bf16_f32 v222, v128, v129
  v_cvt_pk_bf16_f32 v223, v130, v131
  v_cvt_pk_bf16_f32 v226, v132, v133
  v_cvt_pk_bf16_f32 v227, v134, v135
  v_cvt_pk_bf16_f32 v228, v136, v137
  v_cvt_pk_bf16_f32 v229, v138, v139
  v_cvt_pk_bf16_f32 v230, v140, v141
  v_cvt_pk_bf16_f32 v231, v142, v143
  v_cvt_pk_bf16_f32 v236, v144, v145
  v_cvt_pk_bf16_f32 v237, v146, v147
  v_cvt_pk_bf16_f32 v232, v148, v149
  v_cvt_pk_bf16_f32 v233, v150, v151
  v_cvt_pk_bf16_f32 v234, v152, v153
  v_cvt_pk_bf16_f32 v235, v154, v155
  v_cvt_pk_bf16_f32 v238, v156, v157
  v_cvt_pk_bf16_f32 v239, v158, v159
  s_add_u32 s29, s48, 0
  buffer_store_dwordx4 v[192:195], v26, s[16:19], s29 offen offset:0 sc1
  buffer_store_dwordx4 v[196:199], v26, s[16:19], s29 offen offset:1024 sc1
  buffer_store_dwordx4 v[200:203], v26, s[16:19], s29 offen offset:2048 sc1
  s_add_u32 s29, s48, 393216
  buffer_store_dwordx4 v[204:207], v26, s[16:19], s29 offen offset:0 sc1
  buffer_store_dwordx4 v[208:211], v26, s[16:19], s29 offen offset:1024 sc1
  buffer_store_dwordx4 v[212:215], v26, s[16:19], s29 offen offset:2048 sc1
  s_add_u32 s29, s48, 786432
  buffer_store_dwordx4 v[216:219], v26, s[16:19], s29 offen offset:0 sc1
  buffer_store_dwordx4 v[220:223], v26, s[16:19], s29 offen offset:1024 sc1
  buffer_store_dwordx4 v[224:227], v26, s[16:19], s29 offen offset:2048 sc1
  s_add_u32 s29, s48, 1179648
  buffer_store_dwordx4 v[228:231], v26, s[16:19], s29 offen offset:0 sc1
  buffer_store_dwordx4 v[232:235], v26, s[16:19], s29 offen offset:1024 sc1
  buffer_store_dwordx4 v[236:239], v26, s[16:19], s29 offen offset:2048 sc1
  s_waitcnt vmcnt(0) lgkmcnt(0)
  s_barrier
  buffer_atomic_add v28, v27, s[72:75], s61 offen sc1
  s_branch queue
not_kv:
  s_cmp_ge_u32 s3, 96
  s_cbranch_scc1 not_vw
  s_sub_u32 s2, s3, 64
  s_load_dwordx2 s[6:7], s[0:1], 40
  s_load_dwordx2 s[38:39], s[0:1], 104
  v_lshlrev_b32 v4, 4, v1
  s_waitcnt lgkmcnt(0)
  s_mov_b32 s12, s6
  s_mov_b32 s13, s7
  s_mov_b32 s14, 7864320
  s_mov_b32 s15, 0x00020000
  s_add_u32 s16, s38, 25165824
  s_addc_u32 s17, s39, 0
  s_mov_b32 s18, 25165824
  s_mov_b32 s19, 0x00020000
  s_add_u32 s24, s38, 114294784
  s_addc_u32 s25, s39, 0
  s_mov_b32 s26, 83886080
  s_mov_b32 s27, 0x00020000
  s_add_u32 s72, s38, 81068032
  s_addc_u32 s73, s39, 0
  s_mov_b32 s74, 96768
  s_mov_b32 s75, 0x00020000
  s_mul_i32 s40, s2, 245760
  s_mul_i32 s22, s20, 30720
  s_add_u32 s40, s40, s22
  s_add_u32 m0, s22, 0
  s_add_u32 s21, s40, 0
  buffer_load_dwordx4 v4, s[12:15], s21 offen offset:0 lds
  buffer_load_dwordx4 v4, s[12:15], s21 offen offset:1024 lds
  buffer_load_dwordx4 v4, s[12:15], s21 offen offset:2048 lds
  buffer_load_dwordx4 v4, s[12:15], s21 offen offset:3072 lds
  s_add_u32 m0, s22, 4096
  s_add_u32 s21, s40, 4096
  buffer_load_dwordx4 v4, s[12:15], s21 offen offset:0 lds
  buffer_load_dwordx4 v4, s[12:15], s21 offen offset:1024 lds
  buffer_load_dwordx4 v4, s[12:15], s21 offen offset:2048 lds
  buffer_load_dwordx4 v4, s[12:15], s21 offen offset:3072 lds
  s_add_u32 m0, s22, 8192
  s_add_u32 s21, s40, 8192
  buffer_load_dwordx4 v4, s[12:15], s21 offen offset:0 lds
  buffer_load_dwordx4 v4, s[12:15], s21 offen offset:1024 lds
  buffer_load_dwordx4 v4, s[12:15], s21 offen offset:2048 lds
  buffer_load_dwordx4 v4, s[12:15], s21 offen offset:3072 lds
  s_add_u32 m0, s22, 12288
  s_add_u32 s21, s40, 12288
  buffer_load_dwordx4 v4, s[12:15], s21 offen offset:0 lds
  buffer_load_dwordx4 v4, s[12:15], s21 offen offset:1024 lds
  buffer_load_dwordx4 v4, s[12:15], s21 offen offset:2048 lds
  buffer_load_dwordx4 v4, s[12:15], s21 offen offset:3072 lds
  s_add_u32 m0, s22, 16384
  s_add_u32 s21, s40, 16384
  buffer_load_dwordx4 v4, s[12:15], s21 offen offset:0 lds
  buffer_load_dwordx4 v4, s[12:15], s21 offen offset:1024 lds
  buffer_load_dwordx4 v4, s[12:15], s21 offen offset:2048 lds
  buffer_load_dwordx4 v4, s[12:15], s21 offen offset:3072 lds
  s_add_u32 m0, s22, 20480
  s_add_u32 s21, s40, 20480
  buffer_load_dwordx4 v4, s[12:15], s21 offen offset:0 lds
  buffer_load_dwordx4 v4, s[12:15], s21 offen offset:1024 lds
  buffer_load_dwordx4 v4, s[12:15], s21 offen offset:2048 lds
  buffer_load_dwordx4 v4, s[12:15], s21 offen offset:3072 lds
  s_add_u32 m0, s22, 24576
  s_add_u32 s21, s40, 24576
  buffer_load_dwordx4 v4, s[12:15], s21 offen offset:0 lds
  buffer_load_dwordx4 v4, s[12:15], s21 offen offset:1024 lds
  buffer_load_dwordx4 v4, s[12:15], s21 offen offset:2048 lds
  buffer_load_dwordx4 v4, s[12:15], s21 offen offset:3072 lds
  s_add_u32 m0, s22, 28672
  s_add_u32 s21, s40, 28672
  buffer_load_dwordx4 v4, s[12:15], s21 offen offset:0 lds
  buffer_load_dwordx4 v4, s[12:15], s21 offen offset:1024 lds
  s_add_u32 s21, s40, 122880
  buffer_load_dwordx4 v[64:67], v4, s[12:15], s21 offen offset:0
  buffer_load_dwordx4 v[68:71], v4, s[12:15], s21 offen offset:1024
  buffer_load_dwordx4 v[72:75], v4, s[12:15], s21 offen offset:2048
  buffer_load_dwordx4 v[76:79], v4, s[12:15], s21 offen offset:3072
  s_add_u32 s21, s40, 126976
  buffer_load_dwordx4 v[80:83], v4, s[12:15], s21 offen offset:0
  buffer_load_dwordx4 v[84:87], v4, s[12:15], s21 offen offset:1024
  buffer_load_dwordx4 v[88:91], v4, s[12:15], s21 offen offset:2048
  buffer_load_dwordx4 v[92:95], v4, s[12:15], s21 offen offset:3072
  s_add_u32 s21, s40, 131072
  buffer_load_dwordx4 v[96:99], v4, s[12:15], s21 offen offset:0
  buffer_load_dwordx4 v[100:103], v4, s[12:15], s21 offen offset:1024
  buffer_load_dwordx4 v[104:107], v4, s[12:15], s21 offen offset:2048
  buffer_load_dwordx4 v[108:111], v4, s[12:15], s21 offen offset:3072
  s_add_u32 s21, s40, 135168
  buffer_load_dwordx4 v[112:115], v4, s[12:15], s21 offen offset:0
  buffer_load_dwordx4 v[116:119], v4, s[12:15], s21 offen offset:1024
  buffer_load_dwordx4 v[120:123], v4, s[12:15], s21 offen offset:2048
  buffer_load_dwordx4 v[124:127], v4, s[12:15], s21 offen offset:3072
  s_add_u32 s21, s40, 139264
  buffer_load_dwordx4 v[128:131], v4, s[12:15], s21 offen offset:0
  buffer_load_dwordx4 v[132:135], v4, s[12:15], s21 offen offset:1024
  buffer_load_dwordx4 v[136:139], v4, s[12:15], s21 offen offset:2048
  buffer_load_dwordx4 v[140:143], v4, s[12:15], s21 offen offset:3072
  s_add_u32 s21, s40, 143360
  buffer_load_dwordx4 v[144:147], v4, s[12:15], s21 offen offset:0
  buffer_load_dwordx4 v[148:151], v4, s[12:15], s21 offen offset:1024
  buffer_load_dwordx4 v[152:155], v4, s[12:15], s21 offen offset:2048
  buffer_load_dwordx4 v[156:159], v4, s[12:15], s21 offen offset:3072
  s_add_u32 s21, s40, 147456
  buffer_load_dwordx4 v[160:163], v4, s[12:15], s21 offen offset:0
  buffer_load_dwordx4 v[164:167], v4, s[12:15], s21 offen offset:1024
  buffer_load_dwordx4 v[168:171], v4, s[12:15], s21 offen offset:2048
  buffer_load_dwordx4 v[172:175], v4, s[12:15], s21 offen offset:3072
  s_add_u32 s21, s40, 151552
  buffer_load_dwordx4 v[176:179], v4, s[12:15], s21 offen offset:0
  buffer_load_dwordx4 v[180:183], v4, s[12:15], s21 offen offset:1024
  v_lshrrev_b32 v6, 2, v2
  v_lshl_add_u32 v6, v3, 2, v6
  v_mul_u32_u24 v6, 1280, v6
  v_and_b32 v7, 3, v2
  v_lshlrev_b32 v7, 3, v7
  s_mul_i32 s21, s20, 320
  v_add3_u32 v6, v6, v7, s21
  v_add_u32 v8, v6, v7
  v_add_u32 v7, 61440, v6
  v_add_u32 v9, 61440, v8
  v_add_u32 v5, s22, v4
  s_waitcnt vmcnt(30)
  s_barrier
  ds_read_b64_tr_b16 a[0:1], v8 offset:0
  ds_read_b64_tr_b16 a[2:3], v8 offset:20480
  ds_read_b64_tr_b16 a[24:25], v8 offset:8
  ds_read_b64_tr_b16 a[26:27], v8 offset:20488
  ds_read_b64_tr_b16 a[48:49], v6 offset:64
  ds_read_b64_tr_b16 a[50:51], v6 offset:20544
  ds_read_b64_tr_b16 a[72:73], v8 offset:96
  ds_read_b64_tr_b16 a[74:75], v8 offset:20576
  ds_read_b64_tr_b16 a[96:97], v8 offset:104
  ds_read_b64_tr_b16 a[98:99], v8 offset:20584
  ds_read_b64_tr_b16 a[120:121], v8 offset:160
  ds_read_b64_tr_b16 a[122:123], v8 offset:20640
  ds_read_b64_tr_b16 a[144:145], v8 offset:168
  ds_read_b64_tr_b16 a[146:147], v8 offset:20648
  ds_read_b64_tr_b16 a[168:169], v6 offset:224
  ds_read_b64_tr_b16 a[170:171], v6 offset:20704
  ds_read_b64_tr_b16 a[192:193], v8 offset:256
  ds_read_b64_tr_b16 a[194:195], v8 offset:20736
  ds_read_b64_tr_b16 a[216:217], v8 offset:264
  ds_read_b64_tr_b16 a[218:219], v8 offset:20744
  ds_read_b64_tr_b16 a[4:5], v9 offset:0
  ds_read_b64_tr_b16 a[6:7], v9 offset:20480
  ds_read_b64_tr_b16 a[28:29], v9 offset:8
  ds_read_b64_tr_b16 a[30:31], v9 offset:20488
  ds_read_b64_tr_b16 a[52:53], v7 offset:64
  ds_read_b64_tr_b16 a[54:55], v7 offset:20544
  ds_read_b64_tr_b16 a[76:77], v9 offset:96
  ds_read_b64_tr_b16 a[78:79], v9 offset:20576
  ds_read_b64_tr_b16 a[100:101], v9 offset:104
  ds_read_b64_tr_b16 a[102:103], v9 offset:20584
  ds_read_b64_tr_b16 a[124:125], v9 offset:160
  ds_read_b64_tr_b16 a[126:127], v9 offset:20640
  ds_read_b64_tr_b16 a[148:149], v9 offset:168
  ds_read_b64_tr_b16 a[150:151], v9 offset:20648
  ds_read_b64_tr_b16 a[172:173], v7 offset:224
  ds_read_b64_tr_b16 a[174:175], v7 offset:20704
  ds_read_b64_tr_b16 a[196:197], v9 offset:256
  ds_read_b64_tr_b16 a[198:199], v9 offset:20736
  ds_read_b64_tr_b16 a[220:221], v9 offset:264
  ds_read_b64_tr_b16 a[222:223], v9 offset:20744
  ds_read_b64_tr_b16 a[8:9], v8 offset:40960
  ds_read_b64_tr_b16 a[10:11], v9 offset:40960
  ds_read_b64_tr_b16 a[32:33], v8 offset:40968
  ds_read_b64_tr_b16 a[34:35], v9 offset:40968
  ds_read_b64_tr_b16 a[56:57], v6 offset:41024
  ds_read_b64_tr_b16 a[58:59], v7 offset:41024
  ds_read_b64_tr_b16 a[80:81], v8 offset:41056
  ds_read_b64_tr_b16 a[82:83], v9 offset:41056
  ds_read_b64_tr_b16 a[104:105], v8 offset:41064
  ds_read_b64_tr_b16 a[106:107], v9 offset:41064
  ds_read_b64_tr_b16 a[128:129], v8 offset:41120
  ds_read_b64_tr_b16 a[130:131], v9 offset:41120
  ds_read_b64_tr_b16 a[152:153], v8 offset:41128
  ds_read_b64_tr_b16 a[154:155], v9 offset:41128
  ds_read_b64_tr_b16 a[176:177], v6 offset:41184
  ds_read_b64_tr_b16 a[178:179], v7 offset:41184
  ds_read_b64_tr_b16 a[200:201], v8 offset:41216
  ds_read_b64_tr_b16 a[202:203], v9 offset:41216
  ds_read_b64_tr_b16 a[224:225], v8 offset:41224
  ds_read_b64_tr_b16 a[226:227], v9 offset:41224
  s_waitcnt lgkmcnt(0)
  s_barrier
  s_waitcnt vmcnt(0)
  ds_write_b128 v5, v[64:67] offset:0
  ds_write_b128 v5, v[68:71] offset:1024
  ds_write_b128 v5, v[72:75] offset:2048
  ds_write_b128 v5, v[76:79] offset:3072
  ds_write_b128 v5, v[80:83] offset:4096
  ds_write_b128 v5, v[84:87] offset:5120
  ds_write_b128 v5, v[88:91] offset:6144
  ds_write_b128 v5, v[92:95] offset:7168
  ds_write_b128 v5, v[96:99] offset:8192
  ds_write_b128 v5, v[100:103] offset:9216
  ds_write_b128 v5, v[104:107] offset:10240
  ds_write_b128 v5, v[108:111] offset:11264
  ds_write_b128 v5, v[112:115] offset:12288
  ds_write_b128 v5, v[116:119] offset:13312
  ds_write_b128 v5, v[120:123] offset:14336
  ds_write_b128 v5, v[124:127] offset:15360
  ds_write_b128 v5, v[128:131] offset:16384
  ds_write_b128 v5, v[132:135] offset:17408
  ds_write_b128 v5, v[136:139] offset:18432
  ds_write_b128 v5, v[140:143] offset:19456
  ds_write_b128 v5, v[144:147] offset:20480
  ds_write_b128 v5, v[148:151] offset:21504
  ds_write_b128 v5, v[152:155] offset:22528
  ds_write_b128 v5, v[156:159] offset:23552
  ds_write_b128 v5, v[160:163] offset:24576
  ds_write_b128 v5, v[164:167] offset:25600
  ds_write_b128 v5, v[168:171] offset:26624
  ds_write_b128 v5, v[172:175] offset:27648
  ds_write_b128 v5, v[176:179] offset:28672
  ds_write_b128 v5, v[180:183] offset:29696
  s_waitcnt lgkmcnt(0)
  s_barrier
  ds_read_b64_tr_b16 a[12:13], v8 offset:0
  ds_read_b64_tr_b16 a[14:15], v8 offset:20480
  ds_read_b64_tr_b16 a[36:37], v8 offset:8
  ds_read_b64_tr_b16 a[38:39], v8 offset:20488
  ds_read_b64_tr_b16 a[60:61], v6 offset:64
  ds_read_b64_tr_b16 a[62:63], v6 offset:20544
  ds_read_b64_tr_b16 a[84:85], v8 offset:96
  ds_read_b64_tr_b16 a[86:87], v8 offset:20576
  ds_read_b64_tr_b16 a[108:109], v8 offset:104
  ds_read_b64_tr_b16 a[110:111], v8 offset:20584
  ds_read_b64_tr_b16 a[132:133], v8 offset:160
  ds_read_b64_tr_b16 a[134:135], v8 offset:20640
  ds_read_b64_tr_b16 a[156:157], v8 offset:168
  ds_read_b64_tr_b16 a[158:159], v8 offset:20648
  ds_read_b64_tr_b16 a[180:181], v6 offset:224
  ds_read_b64_tr_b16 a[182:183], v6 offset:20704
  ds_read_b64_tr_b16 a[204:205], v8 offset:256
  ds_read_b64_tr_b16 a[206:207], v8 offset:20736
  ds_read_b64_tr_b16 a[228:229], v8 offset:264
  ds_read_b64_tr_b16 a[230:231], v8 offset:20744
  ds_read_b64_tr_b16 a[16:17], v9 offset:0
  ds_read_b64_tr_b16 a[18:19], v9 offset:20480
  ds_read_b64_tr_b16 a[40:41], v9 offset:8
  ds_read_b64_tr_b16 a[42:43], v9 offset:20488
  ds_read_b64_tr_b16 a[64:65], v7 offset:64
  ds_read_b64_tr_b16 a[66:67], v7 offset:20544
  ds_read_b64_tr_b16 a[88:89], v9 offset:96
  ds_read_b64_tr_b16 a[90:91], v9 offset:20576
  ds_read_b64_tr_b16 a[112:113], v9 offset:104
  ds_read_b64_tr_b16 a[114:115], v9 offset:20584
  ds_read_b64_tr_b16 a[136:137], v9 offset:160
  ds_read_b64_tr_b16 a[138:139], v9 offset:20640
  ds_read_b64_tr_b16 a[160:161], v9 offset:168
  ds_read_b64_tr_b16 a[162:163], v9 offset:20648
  ds_read_b64_tr_b16 a[184:185], v7 offset:224
  ds_read_b64_tr_b16 a[186:187], v7 offset:20704
  ds_read_b64_tr_b16 a[208:209], v9 offset:256
  ds_read_b64_tr_b16 a[210:211], v9 offset:20736
  ds_read_b64_tr_b16 a[232:233], v9 offset:264
  ds_read_b64_tr_b16 a[234:235], v9 offset:20744
  ds_read_b64_tr_b16 a[20:21], v8 offset:40960
  ds_read_b64_tr_b16 a[22:23], v9 offset:40960
  ds_read_b64_tr_b16 a[44:45], v8 offset:40968
  ds_read_b64_tr_b16 a[46:47], v9 offset:40968
  ds_read_b64_tr_b16 a[68:69], v6 offset:41024
  ds_read_b64_tr_b16 a[70:71], v7 offset:41024
  ds_read_b64_tr_b16 a[92:93], v8 offset:41056
  ds_read_b64_tr_b16 a[94:95], v9 offset:41056
  ds_read_b64_tr_b16 a[116:117], v8 offset:41064
  ds_read_b64_tr_b16 a[118:119], v9 offset:41064
  ds_read_b64_tr_b16 a[140:141], v8 offset:41120
  ds_read_b64_tr_b16 a[142:143], v9 offset:41120
  ds_read_b64_tr_b16 a[164:165], v8 offset:41128
  ds_read_b64_tr_b16 a[166:167], v9 offset:41128
  ds_read_b64_tr_b16 a[188:189], v6 offset:41184
  ds_read_b64_tr_b16 a[190:191], v7 offset:41184
  ds_read_b64_tr_b16 a[212:213], v8 offset:41216
  ds_read_b64_tr_b16 a[214:215], v9 offset:41216
  ds_read_b64_tr_b16 a[236:237], v8 offset:41224
  ds_read_b64_tr_b16 a[238:239], v9 offset:41224
  s_waitcnt lgkmcnt(0)
  s_barrier
  s_load_dwordx2 s[32:33], s[0:1], 96
  s_waitcnt lgkmcnt(0)
  s_mov_b32 s32, s32
  s_mov_b32 s33, s33
  s_mov_b32 s34, 256
  s_mov_b32 s35, 0x00020000
  s_mov_b32 s21, 76
  s_cmp_lg_u32 s20, 0
  s_cbranch_scc1 wf_199
  v_mov_b32 v4, 0
  s_mov_b32 s101, 0
wf_198:
  buffer_load_dword v5, v4, s[32:35], s21 offen sc1
  s_add_u32 s101, s101, 1
  s_cmp_gt_u32 s101, 131072
  s_cbranch_scc1 main_end
  s_waitcnt vmcnt(0)
  v_readfirstlane_b32 s100, v5
  s_cmp_ge_u32 s100, 1
  s_cbranch_scc1 wf_199
  s_sleep 8
  s_branch wf_198
wf_199:
  s_barrier
  s_mul_i32 s40, s2, 12288
  s_mul_i32 s47, s20, 3072
  s_add_u32 s40, s40, s47
  s_lshr_b32 s43, s2, 2
  s_lshl_b32 s43, s43, 7
  s_add_u32 s43, s43, 0
  s_lshl_b32 s44, s2, 7
  s_lshl_b32 s21, s20, 2
  s_add_u32 s44, s44, s21
  s_add_u32 s44, s44, 88576
  s_lshl_b32 s49, s20, 8
  s_add_u32 s49, s49, 12288
  s_mov_b32 s45, 0
  v_lshlrev_b32 v4, 4, v1
  v_min_u32 v14, 17, v1
  v_lshlrev_b32 v14, 10, v14
  v_mov_b32 v17, 1073741824
  v_cmp_eq_u32 vcc, 0, v1
  s_nop 1
  v_cndmask_b32 v17, v17, 0, vcc
vwr_200:
  s_cmp_lg_u32 s20, 0
  s_cbranch_scc1 vwr_202
  s_mov_b32 s101, 0
vwr_201:
  s_sleep 4
  buffer_load_dword v15, v14, s[72:75], s43 offen sc1
  s_add_u32 s101, s101, 1
  s_cmp_gt_u32 s101, 131072
  s_cbranch_scc1 main_end
  s_waitcnt vmcnt(0)
  v_cmp_le_u32 vcc, 8, v15
  s_nop 1
  s_ff0_i32_b32 s21, vcc_lo
  s_min_u32 s21, s21, 18
  s_lshl_b32 s22, s21, 1
  s_lshl_b32 s21, s21, 2
  s_sub_i32 s21, s21, 8
  s_max_i32 s46, s21, s22
  s_cmp_le_u32 s46, s45
  s_cbranch_scc1 vwr_201
  v_mov_b32 v15, s46
  v_mov_b32 v16, 65536
  ds_write_b32 v16, v15
  s_waitcnt lgkmcnt(0)
vwr_202:
  s_barrier
  v_mov_b32 v16, 65536
  ds_read_b32 v15, v16
  s_and_b32 s50, s45, 2
  s_lshl_b32 s50, s50, 14
  v_add_u32 v10, s50, v4
  v_add_u32 v11, 2048, v10
  v_add_u32 v12, 2056, v10
  v_lshl_add_u32 v13, v1, 2, s50
  s_mul_i32 s41, s45, 393216
  s_add_u32 s41, s41, s40
  s_mov_b32 s48, s45
  s_mul_i32 s42, s45, 1310720
  s_mul_i32 s21, s2, 40960
  s_add_u32 s42, s42, s21
  s_mul_i32 s21, s20, 10240
  s_add_u32 s42, s42, s21
  s_mov_b32 s51, 1073741824
  s_waitcnt lgkmcnt(0)
  v_readfirstlane_b32 s46, v15
  s_mov_b32 s52, s50
  s_cmp_lt_u32 s48, s46
  s_cselect_b32 s53, s41, 1073741824
  s_add_u32 s54, s52, 0
  s_add_u32 m0, s54, s47
  s_nop 0
  buffer_load_dwordx4 v4, s[16:19], s53 offen offset:0 sc1 lds
  buffer_load_dwordx4 v4, s[16:19], s53 offen offset:1024 sc1 lds
  buffer_load_dwordx4 v4, s[16:19], s53 offen offset:2048 sc1 lds
  s_nop 0
  s_add_u32 m0, s54, s49
  s_nop 0
  buffer_load_dword v14, s[72:75], s43 offen sc1 lds
  s_add_u32 s41, s41, 393216
  s_add_u32 s48, s48, 1
  s_cmp_lt_u32 s48, s46
  s_cselect_b32 s53, s41, 1073741824
  s_add_u32 s54, s52, 16384
  s_add_u32 m0, s54, s47
  s_nop 0
  buffer_load_dwordx4 v4, s[16:19], s53 offen offset:0 sc1 lds
  buffer_load_dwordx4 v4, s[16:19], s53 offen offset:1024 sc1 lds
  buffer_load_dwordx4 v4, s[16:19], s53 offen offset:2048 sc1 lds
  s_nop 0
  s_add_u32 m0, s54, s49
  s_nop 0
  buffer_load_dword v14, s[72:75], s43 offen sc1 lds
  s_add_u32 s41, s41, 393216
  s_add_u32 s48, s48, 1
  s_xor_b32 s52, s52, 32768
  s_cmp_lt_u32 s48, s46
  s_cselect_b32 s53, s41, 1073741824
  s_add_u32 s54, s52, 0
  s_add_u32 m0, s54, s47
  s_nop 0
  buffer_load_dwordx4 v4, s[16:19], s53 offen offset:0 sc1 lds
  buffer_load_dwordx4 v4, s[16:19], s53 offen offset:1024 sc1 lds
  buffer_load_dwordx4 v4, s[16:19], s53 offen offset:2048 sc1 lds
  s_nop 0
  s_add_u32 m0, s54, s49
  s_nop 0
  buffer_load_dword v14, s[72:75], s43 offen sc1 lds
  s_add_u32 s41, s41, 393216
  s_add_u32 s48, s48, 1
  s_waitcnt vmcnt(0)
  s_barrier
  ds_read_b128 v[64:67], v10 offset:0
  ds_read_b128 v[88:91], v10 offset:1024
  ds_read_b128 v[68:71], v10 offset:3072
  ds_read_b128 v[92:95], v10 offset:4096
  ds_read2st64_b64 v[72:75], v11 offset0:0 offset1:6
  ds_read2st64_b64 v[96:99], v12 offset0:0 offset1:6
  ds_read_b128 v[76:79], v10 offset:6144
  ds_read_b128 v[100:103], v10 offset:7168
  ds_read_b128 v[80:83], v10 offset:9216
  ds_read_b128 v[104:107], v10 offset:10240
  ds_read2st64_b64 v[84:87], v11 offset0:12 offset1:18
  ds_read2st64_b64 v[108:111], v12 offset0:12 offset1:18
  s_waitcnt lgkmcnt(0)
  .p2align 3
vwl_203:
  v_mfma_f32_16x16x32_bf16 v[160:163], v[64:67], a[0:3], 0
  v_mfma_f32_16x16x32_bf16 v[164:167], v[88:91], a[0:3], 0
  v_mfma_f32_16x16x32_bf16 v[160:163], v[68:71], a[4:7], v[160:163]
  v_cvt_pk_bf16_f32 v204, v184, v185
  v_cvt_pk_bf16_f32 v205, v186, v187
  v_mfma_f32_16x16x32_bf16 v[164:167], v[92:95], a[4:7], v[164:167]
  v_cvt_pk_bf16_f32 v206, v188, v189
  v_cvt_pk_bf16_f32 v207, v190, v191
  v_mfma_f32_16x16x32_bf16 v[160:163], v[72:75], a[8:11], v[160:163]
  buffer_store_dwordx4 v[204:207], v4, s[24:27], s51 offen offset:1024 sc1
  v_mfma_f32_16x16x32_bf16 v[164:167], v[96:99], a[8:11], v[164:167]
  v_mfma_f32_16x16x32_bf16 v[160:163], v[76:79], a[12:15], v[160:163]
  v_mfma_f32_16x16x32_bf16 v[164:167], v[100:103], a[12:15], v[164:167]
  s_waitcnt vmcnt(23)
  s_barrier
  ds_read_b32 v15, v13 offset:28672
  v_mfma_f32_16x16x32_bf16 v[160:163], v[80:83], a[16:19], v[160:163]
  ds_read_b128 v[112:115], v10 offset:16384
  v_mfma_f32_16x16x32_bf16 v[164:167], v[104:107], a[16:19], v[164:167]
  v_mfma_f32_16x16x32_bf16 v[160:163], v[84:87], a[20:23], v[160:163]
  ds_read_b128 v[136:139], v10 offset:17408
  v_mfma_f32_16x16x32_bf16 v[164:167], v[108:111], a[20:23], v[164:167]
  v_mfma_f32_16x16x32_bf16 v[168:171], v[64:67], a[24:27], 0
  ds_read_b128 v[116:119], v10 offset:19456
  v_mfma_f32_16x16x32_bf16 v[172:175], v[88:91], a[24:27], 0
  v_mfma_f32_16x16x32_bf16 v[168:171], v[68:71], a[28:31], v[168:171]
  v_cvt_pk_bf16_f32 v192, v160, v161
  v_cvt_pk_bf16_f32 v193, v162, v163
  v_mfma_f32_16x16x32_bf16 v[172:175], v[92:95], a[28:31], v[172:175]
  v_cvt_pk_bf16_f32 v194, v164, v165
  v_cvt_pk_bf16_f32 v195, v166, v167
  v_mfma_f32_16x16x32_bf16 v[168:171], v[72:75], a[32:35], v[168:171]
  s_add_u32 s55, s42, 0
  buffer_store_dwordx4 v[192:195], v4, s[24:27], s55 offen offset:0 sc1
  ds_read_b128 v[140:143], v10 offset:20480
  v_mfma_f32_16x16x32_bf16 v[172:175], v[96:99], a[32:35], v[172:175]
  v_mfma_f32_16x16x32_bf16 v[168:171], v[76:79], a[36:39], v[168:171]
  ds_read2st64_b64 v[120:123], v11 offset0:32 offset1:38
  v_mfma_f32_16x16x32_bf16 v[172:175], v[100:103], a[36:39], v[172:175]
  v_mfma_f32_16x16x32_bf16 v[168:171], v[80:83], a[40:43], v[168:171]
  ds_read2st64_b64 v[144:147], v12 offset0:32 offset1:38
  v_mfma_f32_16x16x32_bf16 v[172:175], v[104:107], a[40:43], v[172:175]
  v_mfma_f32_16x16x32_bf16 v[168:171], v[84:87], a[44:47], v[168:171]
  ds_read_b128 v[124:127], v10 offset:22528
  v_mfma_f32_16x16x32_bf16 v[172:175], v[108:111], a[44:47], v[172:175]
  v_mfma_f32_16x16x32_bf16 v[176:179], v[64:67], a[48:51], 0
  ds_read_b128 v[148:151], v10 offset:23552
  v_mfma_f32_16x16x32_bf16 v[180:183], v[88:91], a[48:51], 0
  v_mfma_f32_16x16x32_bf16 v[176:179], v[68:71], a[52:55], v[176:179]
  v_cvt_pk_bf16_f32 v196, v168, v169
  v_cvt_pk_bf16_f32 v197, v170, v171
  v_mfma_f32_16x16x32_bf16 v[180:183], v[92:95], a[52:55], v[180:183]
  v_cvt_pk_bf16_f32 v198, v172, v173
  v_cvt_pk_bf16_f32 v199, v174, v175
  v_mfma_f32_16x16x32_bf16 v[176:179], v[72:75], a[56:59], v[176:179]
  buffer_store_dwordx4 v[196:199], v4, s[24:27], s55 offen offset:1024 sc1
  ds_read_b128 v[128:131], v10 offset:25600
  v_mfma_f32_16x16x32_bf16 v[180:183], v[96:99], a[56:59], v[180:183]
  v_mfma_f32_16x16x32_bf16 v[176:179], v[76:79], a[60:63], v[176:179]
  ds_read_b128 v[152:155], v10 offset:26624
  v_mfma_f32_16x16x32_bf16 v[180:183], v[100:103], a[60:63], v[180:183]
  v_mfma_f32_16x16x32_bf16 v[176:179], v[80:83], a[64:67], v[176:179]
  ds_read2st64_b64 v[132:135], v11 offset0:44 offset1:50
  v_mfma_f32_16x16x32_bf16 v[180:183], v[104:107], a[64:67], v[180:183]
  v_mfma_f32_16x16x32_bf16 v[176:179], v[84:87], a[68:71], v[176:179]
  ds_read2st64_b64 v[156:159], v12 offset0:44 offset1:50
  v_mfma_f32_16x16x32_bf16 v[180:183], v[108:111], a[68:71], v[180:183]
  v_mfma_f32_16x16x32_bf16 v[184:187], v[64:67], a[72:75], 0
  v_mfma_f32_16x16x32_bf16 v[188:191], v[88:91], a[72:75], 0
  s_waitcnt lgkmcnt(12)
  v_cmp_le_u32 vcc, 8, v15
  v_mfma_f32_16x16x32_bf16 v[184:187], v[68:71], a[76:79], v[184:187]
  v_cvt_pk_bf16_f32 v200, v176, v177
  v_cvt_pk_bf16_f32 v201, v178, v179
  v_mfma_f32_16x16x32_bf16 v[188:191], v[92:95], a[76:79], v[188:191]
  v_cvt_pk_bf16_f32 v202, v180, v181
  v_cvt_pk_bf16_f32 v203, v182, v183
  v_mfma_f32_16x16x32_bf16 v[184:187], v[72:75], a[80:83], v[184:187]
  buffer_store_dwordx4 v[200:203], v4, s[24:27], s55 offen offset:2048 sc1
  s_ff0_i32_b32 s21, vcc_lo
  v_mfma_f32_16x16x32_bf16 v[188:191], v[96:99], a[80:83], v[188:191]
  s_min_u32 s21, s21, 18
  s_lshl_b32 s22, s21, 1
  s_lshl_b32 s21, s21, 2
  v_mfma_f32_16x16x32_bf16 v[184:187], v[76:79], a[84:87], v[184:187]
  s_sub_i32 s21, s21, 8
  s_max_i32 s21, s21, s22
  s_max_u32 s21, s21, s46
  v_mfma_f32_16x16x32_bf16 v[188:191], v[100:103], a[84:87], v[188:191]
  s_cmp_ge_u32 s46, s48
  s_cselect_b32 s46, s21, s46
  v_mfma_f32_16x16x32_bf16 v[184:187], v[80:83], a[88:91], v[184:187]
  s_cmp_lt_u32 s48, s46
  s_cselect_b32 s53, s41, 1073741824
  s_add_u32 s54, s52, 16384
  v_mfma_f32_16x16x32_bf16 v[188:191], v[104:107], a[88:91], v[188:191]
  s_add_u32 m0, s54, s47
  v_mfma_f32_16x16x32_bf16 v[184:187], v[84:87], a[92:95], v[184:187]
  buffer_load_dwordx4 v4, s[16:19], s53 offen offset:0 sc1 lds
  buffer_load_dwordx4 v4, s[16:19], s53 offen offset:1024 sc1 lds
  v_mfma_f32_16x16x32_bf16 v[188:191], v[108:111], a[92:95], v[188:191]
  buffer_load_dwordx4 v4, s[16:19], s53 offen offset:2048 sc1 lds
  v_mfma_f32_16x16x32_bf16 v[160:163], v[64:67], a[96:99], 0
  s_add_u32 m0, s54, s49
  v_mfma_f32_16x16x32_bf16 v[164:167], v[88:91], a[96:99], 0
  buffer_load_dword v14, s[72:75], s43 offen sc1 lds
  s_add_u32 s41, s41, 393216
  v_mfma_f32_16x16x32_bf16 v[160:163], v[68:71], a[100:103], v[160:163]
  v_cvt_pk_bf16_f32 v204, v184, v185
  v_cvt_pk_bf16_f32 v205, v186, v187
  v_mfma_f32_16x16x32_bf16 v[164:167], v[92:95], a[100:103], v[164:167]
  v_cvt_pk_bf16_f32 v206, v188, v189
  v_cvt_pk_bf16_f32 v207, v190, v191
  v_mfma_f32_16x16x32_bf16 v[160:163], v[72:75], a[104:107], v[160:163]
  buffer_store_dwordx4 v[204:207], v4, s[24:27], s55 offen offset:3072 sc1
  s_add_u32 s48, s48, 1
  v_mfma_f32_16x16x32_bf16 v[164:167], v[96:99], a[104:107], v[164:167]
  v_mfma_f32_16x16x32_bf16 v[160:163], v[76:79], a[108:111], v[160:163]
  v_mfma_f32_16x16x32_bf16 v[164:167], v[100:103], a[108:111], v[164:167]
  v_mfma_f32_16x16x32_bf16 v[160:163], v[80:83], a[112:115], v[160:163]
  v_mfma_f32_16x16x32_bf16 v[164:167], v[104:107], a[112:115], v[164:167]
  v_mfma_f32_16x16x32_bf16 v[160:163], v[84:87], a[116:119], v[160:163]
  v_mfma_f32_16x16x32_bf16 v[164:167], v[108:111], a[116:119], v[164:167]
  v_mfma_f32_16x16x32_bf16 v[168:171], v[64:67], a[120:123], 0
  v_mfma_f32_16x16x32_bf16 v[172:175], v[88:91], a[120:123], 0
  v_mfma_f32_16x16x32_bf16 v[168:171], v[68:71], a[124:127], v[168:171]
  v_cvt_pk_bf16_f32 v192, v160, v161
  v_cvt_pk_bf16_f32 v193, v162, v163
  v_mfma_f32_16x16x32_bf16 v[172:175], v[92:95], a[124:127], v[172:175]
  v_cvt_pk_bf16_f32 v194, v164, v165
  v_cvt_pk_bf16_f32 v195, v166, v167
  v_mfma_f32_16x16x32_bf16 v[168:171], v[72:75], a[128:131], v[168:171]
  s_add_u32 s55, s42, 4096
  buffer_store_dwordx4 v[192:195], v4, s[24:27], s55 offen offset:0 sc1
  v_mfma_f32_16x16x32_bf16 v[172:175], v[96:99], a[128:131], v[172:175]
  v_mfma_f32_16x16x32_bf16 v[168:171], v[76:79], a[132:135], v[168:171]
  v_mfma_f32_16x16x32_bf16 v[172:175], v[100:103], a[132:135], v[172:175]
  v_mfma_f32_16x16x32_bf16 v[168:171], v[80:83], a[136:139], v[168:171]
  v_mfma_f32_16x16x32_bf16 v[172:175], v[104:107], a[136:139], v[172:175]
  v_mfma_f32_16x16x32_bf16 v[168:171], v[84:87], a[140:143], v[168:171]
  v_mfma_f32_16x16x32_bf16 v[172:175], v[108:111], a[140:143], v[172:175]
  v_mfma_f32_16x16x32_bf16 v[176:179], v[64:67], a[144:147], 0
  v_mfma_f32_16x16x32_bf16 v[180:183], v[88:91], a[144:147], 0
  v_mfma_f32_16x16x32_bf16 v[176:179], v[68:71], a[148:151], v[176:179]
  v_cvt_pk_bf16_f32 v196, v168, v169
  v_cvt_pk_bf16_f32 v197, v170, v171
  v_mfma_f32_16x16x32_bf16 v[180:183], v[92:95], a[148:151], v[180:183]
  v_cvt_pk_bf16_f32 v198, v172, v173
  v_cvt_pk_bf16_f32 v199, v174, v175
  v_mfma_f32_16x16x32_bf16 v[176:179], v[72:75], a[152:155], v[176:179]
  buffer_store_dwordx4 v[196:199], v4, s[24:27], s55 offen offset:1024 sc1
  v_mfma_f32_16x16x32_bf16 v[180:183], v[96:99], a[152:155], v[180:183]
  v_mfma_f32_16x16x32_bf16 v[176:179], v[76:79], a[156:159], v[176:179]
  v_mfma_f32_16x16x32_bf16 v[180:183], v[100:103], a[156:159], v[180:183]
  v_mfma_f32_16x16x32_bf16 v[176:179], v[80:83], a[160:163], v[176:179]
  v_mfma_f32_16x16x32_bf16 v[180:183], v[104:107], a[160:163], v[180:183]
  v_mfma_f32_16x16x32_bf16 v[176:179], v[84:87], a[164:167], v[176:179]
  v_mfma_f32_16x16x32_bf16 v[180:183], v[108:111], a[164:167], v[180:183]
  v_mfma_f32_16x16x32_bf16 v[184:187], v[64:67], a[168:171], 0
  v_mfma_f32_16x16x32_bf16 v[188:191], v[88:91], a[168:171], 0
  v_mfma_f32_16x16x32_bf16 v[184:187], v[68:71], a[172:175], v[184:187]
  v_cvt_pk_bf16_f32 v200, v176, v177
  v_cvt_pk_bf16_f32 v201, v178, v179
  v_mfma_f32_16x16x32_bf16 v[188:191], v[92:95], a[172:175], v[188:191]
  v_cvt_pk_bf16_f32 v202, v180, v181
  v_cvt_pk_bf16_f32 v203, v182, v183
  v_mfma_f32_16x16x32_bf16 v[184:187], v[72:75], a[176:179], v[184:187]
  buffer_store_dwordx4 v[200:203], v4, s[24:27], s55 offen offset:2048 sc1
  v_mfma_f32_16x16x32_bf16 v[188:191], v[96:99], a[176:179], v[188:191]
  v_mfma_f32_16x16x32_bf16 v[184:187], v[76:79], a[180:183], v[184:187]
  v_mfma_f32_16x16x32_bf16 v[188:191], v[100:103], a[180:183], v[188:191]
  v_mfma_f32_16x16x32_bf16 v[184:187], v[80:83], a[184:187], v[184:187]
  v_mfma_f32_16x16x32_bf16 v[188:191], v[104:107], a[184:187], v[188:191]
  v_mfma_f32_16x16x32_bf16 v[184:187], v[84:87], a[188:191], v[184:187]
  v_mfma_f32_16x16x32_bf16 v[188:191], v[108:111], a[188:191], v[188:191]
  v_mfma_f32_16x16x32_bf16 v[160:163], v[64:67], a[192:195], 0
  s_min_u32 s21, s45, 52
  v_mov_b32 v16, s21
  s_waitcnt vmcnt(11)
  v_mfma_f32_16x16x32_bf16 v[164:167], v[88:91], a[192:195], 0
  buffer_store_dword v16, v17, s[72:75], s44 offen sc1
  v_mfma_f32_16x16x32_bf16 v[160:163], v[68:71], a[196:199], v[160:163]
  v_cvt_pk_bf16_f32 v204, v184, v185
  v_cvt_pk_bf16_f32 v205, v186, v187
  v_mfma_f32_16x16x32_bf16 v[164:167], v[92:95], a[196:199], v[164:167]
  v_cvt_pk_bf16_f32 v206, v188, v189
  v_cvt_pk_bf16_f32 v207, v190, v191
  v_mfma_f32_16x16x32_bf16 v[160:163], v[72:75], a[200:203], v[160:163]
  buffer_store_dwordx4 v[204:207], v4, s[24:27], s55 offen offset:3072 sc1
  v_mfma_f32_16x16x32_bf16 v[164:167], v[96:99], a[200:203], v[164:167]
  v_mfma_f32_16x16x32_bf16 v[160:163], v[76:79], a[204:207], v[160:163]
  v_mfma_f32_16x16x32_bf16 v[164:167], v[100:103], a[204:207], v[164:167]
  v_mfma_f32_16x16x32_bf16 v[160:163], v[80:83], a[208:211], v[160:163]
  v_mfma_f32_16x16x32_bf16 v[164:167], v[104:107], a[208:211], v[164:167]
  v_mfma_f32_16x16x32_bf16 v[160:163], v[84:87], a[212:215], v[160:163]
  v_mfma_f32_16x16x32_bf16 v[164:167], v[108:111], a[212:215], v[164:167]
  v_mfma_f32_16x16x32_bf16 v[168:171], v[64:67], a[216:219], 0
  v_mfma_f32_16x16x32_bf16 v[172:175], v[88:91], a[216:219], 0
  v_mfma_f32_16x16x32_bf16 v[168:171], v[68:71], a[220:223], v[168:171]
  v_cvt_pk_bf16_f32 v192, v160, v161
  v_cvt_pk_bf16_f32 v193, v162, v163
  v_mfma_f32_16x16x32_bf16 v[172:175], v[92:95], a[220:223], v[172:175]
  v_cvt_pk_bf16_f32 v194, v164, v165
  v_cvt_pk_bf16_f32 v195, v166, v167
  v_mfma_f32_16x16x32_bf16 v[168:171], v[72:75], a[224:227], v[168:171]
  s_add_u32 s55, s42, 8192
  buffer_store_dwordx4 v[192:195], v4, s[24:27], s55 offen offset:0 sc1
  v_mfma_f32_16x16x32_bf16 v[172:175], v[96:99], a[224:227], v[172:175]
  v_mfma_f32_16x16x32_bf16 v[168:171], v[76:79], a[228:231], v[168:171]
  s_add_u32 s51, s42, 8192
  s_add_u32 s42, s42, 1310720
  s_add_u32 s45, s45, 1
  v_mfma_f32_16x16x32_bf16 v[172:175], v[100:103], a[228:231], v[172:175]
  v_mfma_f32_16x16x32_bf16 v[168:171], v[80:83], a[232:235], v[168:171]
  v_mfma_f32_16x16x32_bf16 v[172:175], v[104:107], a[232:235], v[172:175]
  v_mfma_f32_16x16x32_bf16 v[168:171], v[84:87], a[236:239], v[168:171]
  v_mfma_f32_16x16x32_bf16 v[172:175], v[108:111], a[236:239], v[172:175]
  s_waitcnt lgkmcnt(0)
  v_mfma_f32_16x16x32_bf16 v[176:179], v[112:115], a[0:3], 0
  v_mfma_f32_16x16x32_bf16 v[180:183], v[136:139], a[0:3], 0
  v_mfma_f32_16x16x32_bf16 v[176:179], v[116:119], a[4:7], v[176:179]
  v_cvt_pk_bf16_f32 v196, v168, v169
  v_cvt_pk_bf16_f32 v197, v170, v171
  v_mfma_f32_16x16x32_bf16 v[180:183], v[140:143], a[4:7], v[180:183]
  v_cvt_pk_bf16_f32 v198, v172, v173
  v_cvt_pk_bf16_f32 v199, v174, v175
  v_mfma_f32_16x16x32_bf16 v[176:179], v[120:123], a[8:11], v[176:179]
  buffer_store_dwordx4 v[196:199], v4, s[24:27], s51 offen offset:1024 sc1
  v_mfma_f32_16x16x32_bf16 v[180:183], v[144:147], a[8:11], v[180:183]
  v_mfma_f32_16x16x32_bf16 v[176:179], v[124:127], a[12:15], v[176:179]
  v_mfma_f32_16x16x32_bf16 v[180:183], v[148:151], a[12:15], v[180:183]
  s_waitcnt vmcnt(22)
  s_barrier
  v_xor_b32 v10, 32768, v10
  v_mfma_f32_16x16x32_bf16 v[176:179], v[128:131], a[16:19], v[176:179]
  v_xor_b32 v11, 32768, v11
  v_xor_b32 v12, 32768, v12
  v_mfma_f32_16x16x32_bf16 v[180:183], v[152:155], a[16:19], v[180:183]
  v_xor_b32 v13, 32768, v13
  ds_read_b32 v15, v13 offset:12288
  v_mfma_f32_16x16x32_bf16 v[176:179], v[132:135], a[20:23], v[176:179]
  ds_read_b128 v[64:67], v10 offset:0
  v_mfma_f32_16x16x32_bf16 v[180:183], v[156:159], a[20:23], v[180:183]
  v_mfma_f32_16x16x32_bf16 v[184:187], v[112:115], a[24:27], 0
  ds_read_b128 v[88:91], v10 offset:1024
  v_mfma_f32_16x16x32_bf16 v[188:191], v[136:139], a[24:27], 0
  v_mfma_f32_16x16x32_bf16 v[184:187], v[116:119], a[28:31], v[184:187]
  v_cvt_pk_bf16_f32 v200, v176, v177
  v_cvt_pk_bf16_f32 v201, v178, v179
  v_mfma_f32_16x16x32_bf16 v[188:191], v[140:143], a[28:31], v[188:191]
  v_cvt_pk_bf16_f32 v202, v180, v181
  v_cvt_pk_bf16_f32 v203, v182, v183
  v_mfma_f32_16x16x32_bf16 v[184:187], v[120:123], a[32:35], v[184:187]
  s_add_u32 s55, s42, 0
  buffer_store_dwordx4 v[200:203], v4, s[24:27], s55 offen offset:0 sc1
  ds_read_b128 v[68:71], v10 offset:3072
  v_mfma_f32_16x16x32_bf16 v[188:191], v[144:147], a[32:35], v[188:191]
  v_mfma_f32_16x16x32_bf16 v[184:187], v[124:127], a[36:39], v[184:187]
  ds_read_b128 v[92:95], v10 offset:4096
  v_mfma_f32_16x16x32_bf16 v[188:191], v[148:151], a[36:39], v[188:191]
  v_mfma_f32_16x16x32_bf16 v[184:187], v[128:131], a[40:43], v[184:187]
  ds_read2st64_b64 v[72:75], v11 offset0:0 offset1:6
  v_mfma_f32_16x16x32_bf16 v[188:191], v[152:155], a[40:43], v[188:191]
  v_mfma_f32_16x16x32_bf16 v[184:187], v[132:135], a[44:47], v[184:187]
  ds_read2st64_b64 v[96:99], v12 offset0:0 offset1:6
  v_mfma_f32_16x16x32_bf16 v[188:191], v[156:159], a[44:47], v[188:191]
  v_mfma_f32_16x16x32_bf16 v[160:163], v[112:115], a[48:51], 0
  ds_read_b128 v[76:79], v10 offset:6144
  v_mfma_f32_16x16x32_bf16 v[164:167], v[136:139], a[48:51], 0
  v_mfma_f32_16x16x32_bf16 v[160:163], v[116:119], a[52:55], v[160:163]
  v_cvt_pk_bf16_f32 v204, v184, v185
  v_cvt_pk_bf16_f32 v205, v186, v187
  v_mfma_f32_16x16x32_bf16 v[164:167], v[140:143], a[52:55], v[164:167]
  v_cvt_pk_bf16_f32 v206, v188, v189
  v_cvt_pk_bf16_f32 v207, v190, v191
  v_mfma_f32_16x16x32_bf16 v[160:163], v[120:123], a[56:59], v[160:163]
  buffer_store_dwordx4 v[204:207], v4, s[24:27], s55 offen offset:1024 sc1
  ds_read_b128 v[100:103], v10 offset:7168
  v_mfma_f32_16x16x32_bf16 v[164:167], v[144:147], a[56:59], v[164:167]
  v_mfma_f32_16x16x32_bf16 v[160:163], v[124:127], a[60:63], v[160:163]
  ds_read_b128 v[80:83], v10 offset:9216
  v_mfma_f32_16x16x32_bf16 v[164:167], v[148:151], a[60:63], v[164:167]
  v_mfma_f32_16x16x32_bf16 v[160:163], v[128:131], a[64:67], v[160:163]
  ds_read_b128 v[104:107], v10 offset:10240
  v_mfma_f32_16x16x32_bf16 v[164:167], v[152:155], a[64:67], v[164:167]
  v_mfma_f32_16x16x32_bf16 v[160:163], v[132:135], a[68:71], v[160:163]
  ds_read2st64_b64 v[84:87], v11 offset0:12 offset1:18
  v_mfma_f32_16x16x32_bf16 v[164:167], v[156:159], a[68:71], v[164:167]
  v_mfma_f32_16x16x32_bf16 v[168:171], v[112:115], a[72:75], 0
  ds_read2st64_b64 v[108:111], v12 offset0:12 offset1:18
  v_mfma_f32_16x16x32_bf16 v[172:175], v[136:139], a[72:75], 0
  v_mfma_f32_16x16x32_bf16 v[168:171], v[116:119], a[76:79], v[168:171]
  v_cvt_pk_bf16_f32 v192, v160, v161
  v_cvt_pk_bf16_f32 v193, v162, v163
  v_mfma_f32_16x16x32_bf16 v[172:175], v[140:143], a[76:79], v[172:175]
  v_cvt_pk_bf16_f32 v194, v164, v165
  v_cvt_pk_bf16_f32 v195, v166, v167
  v_mfma_f32_16x16x32_bf16 v[168:171], v[120:123], a[80:83], v[168:171]
  buffer_store_dwordx4 v[192:195], v4, s[24:27], s55 offen offset:2048 sc1
  s_waitcnt lgkmcnt(12)
  v_mfma_f32_16x16x32_bf16 v[172:175], v[144:147], a[80:83], v[172:175]
  v_cmp_le_u32 vcc, 8, v15
  v_mfma_f32_16x16x32_bf16 v[168:171], v[124:127], a[84:87], v[168:171]
  s_ff0_i32_b32 s21, vcc_lo
  s_min_u32 s21, s21, 18
  s_lshl_b32 s22, s21, 1
  v_mfma_f32_16x16x32_bf16 v[172:175], v[148:151], a[84:87], v[172:175]
  s_lshl_b32 s21, s21, 2
  s_sub_i32 s21, s21, 8
  s_max_i32 s21, s21, s22
  v_mfma_f32_16x16x32_bf16 v[168:171], v[128:131], a[88:91], v[168:171]
  s_max_u32 s21, s21, s46
  s_cmp_ge_u32 s46, s48
  s_cselect_b32 s46, s21, s46
  v_mfma_f32_16x16x32_bf16 v[172:175], v[152:155], a[88:91], v[172:175]
  s_xor_b32 s52, s52, 32768
  s_cmp_lt_u32 s48, s46
  s_cselect_b32 s53, s41, 1073741824
  v_mfma_f32_16x16x32_bf16 v[168:171], v[132:135], a[92:95], v[168:171]
  s_add_u32 s54, s52, 0
  s_add_u32 m0, s54, s47
  v_mfma_f32_16x16x32_bf16 v[172:175], v[156:159], a[92:95], v[172:175]
  buffer_load_dwordx4 v4, s[16:19], s53 offen offset:0 sc1 lds
  buffer_load_dwordx4 v4, s[16:19], s53 offen offset:1024 sc1 lds
  v_mfma_f32_16x16x32_bf16 v[176:179], v[112:115], a[96:99], 0
  buffer_load_dwordx4 v4, s[16:19], s53 offen offset:2048 sc1 lds
  v_mfma_f32_16x16x32_bf16 v[180:183], v[136:139], a[96:99], 0
  s_add_u32 m0, s54, s49
  v_mfma_f32_16x16x32_bf16 v[176:179], v[116:119], a[100:103], v[176:179]
  v_cvt_pk_bf16_f32 v196, v168, v169
  v_cvt_pk_bf16_f32 v197, v170, v171
  v_mfma_f32_16x16x32_bf16 v[180:183], v[140:143], a[100:103], v[180:183]
  v_cvt_pk_bf16_f32 v198, v172, v173
  v_cvt_pk_bf16_f32 v199, v174, v175
  v_mfma_f32_16x16x32_bf16 v[176:179], v[120:123], a[104:107], v[176:179]
  buffer_store_dwordx4 v[196:199], v4, s[24:27], s55 offen offset:3072 sc1
  buffer_load_dword v14, s[72:75], s43 offen sc1 lds
  v_mfma_f32_16x16x32_bf16 v[180:183], v[144:147], a[104:107], v[180:183]
  s_add_u32 s41, s41, 393216
  s_add_u32 s48, s48, 1
  v_mfma_f32_16x16x32_bf16 v[176:179], v[124:127], a[108:111], v[176:179]
  v_mfma_f32_16x16x32_bf16 v[180:183], v[148:151], a[108:111], v[180:183]
  v_mfma_f32_16x16x32_bf16 v[176:179], v[128:131], a[112:115], v[176:179]
  v_mfma_f32_16x16x32_bf16 v[180:183], v[152:155], a[112:115], v[180:183]
  v_mfma_f32_16x16x32_bf16 v[176:179], v[132:135], a[116:119], v[176:179]
  v_mfma_f32_16x16x32_bf16 v[180:183], v[156:159], a[116:119], v[180:183]
  v_mfma_f32_16x16x32_bf16 v[184:187], v[112:115], a[120:123], 0
  v_mfma_f32_16x16x32_bf16 v[188:191], v[136:139], a[120:123], 0
  v_mfma_f32_16x16x32_bf16 v[184:187], v[116:119], a[124:127], v[184:187]
  v_cvt_pk_bf16_f32 v200, v176, v177
  v_cvt_pk_bf16_f32 v201, v178, v179
  v_mfma_f32_16x16x32_bf16 v[188:191], v[140:143], a[124:127], v[188:191]
  v_cvt_pk_bf16_f32 v202, v180, v181
  v_cvt_pk_bf16_f32 v203, v182, v183
  v_mfma_f32_16x16x32_bf16 v[184:187], v[120:123], a[128:131], v[184:187]
  s_add_u32 s55, s42, 4096
  buffer_store_dwordx4 v[200:203], v4, s[24:27], s55 offen offset:0 sc1
  v_mfma_f32_16x16x32_bf16 v[188:191], v[144:147], a[128:131], v[188:191]
  v_mfma_f32_16x16x32_bf16 v[184:187], v[124:127], a[132:135], v[184:187]
  v_mfma_f32_16x16x32_bf16 v[188:191], v[148:151], a[132:135], v[188:191]
  v_mfma_f32_16x16x32_bf16 v[184:187], v[128:131], a[136:139], v[184:187]
  v_mfma_f32_16x16x32_bf16 v[188:191], v[152:155], a[136:139], v[188:191]
  v_mfma_f32_16x16x32_bf16 v[184:187], v[132:135], a[140:143], v[184:187]
  v_mfma_f32_16x16x32_bf16 v[188:191], v[156:159], a[140:143], v[188:191]
  v_mfma_f32_16x16x32_bf16 v[160:163], v[112:115], a[144:147], 0
  v_mfma_f32_16x16x32_bf16 v[164:167], v[136:139], a[144:147], 0
  v_mfma_f32_16x16x32_bf16 v[160:163], v[116:119], a[148:151], v[160:163]
  v_cvt_pk_bf16_f32 v204, v184, v185
  v_cvt_pk_bf16_f32 v205, v186, v187
  v_mfma_f32_16x16x32_bf16 v[164:167], v[140:143], a[148:151], v[164:167]
  v_cvt_pk_bf16_f32 v206, v188, v189
  v_cvt_pk_bf16_f32 v207, v190, v191
  v_mfma_f32_16x16x32_bf16 v[160:163], v[120:123], a[152:155], v[160:163]
  buffer_store_dwordx4 v[204:207], v4, s[24:27], s55 offen offset:1024 sc1
  v_mfma_f32_16x16x32_bf16 v[164:167], v[144:147], a[152:155], v[164:167]
  v_mfma_f32_16x16x32_bf16 v[160:163], v[124:127], a[156:159], v[160:163]
  v_mfma_f32_16x16x32_bf16 v[164:167], v[148:151], a[156:159], v[164:167]
  v_mfma_f32_16x16x32_bf16 v[160:163], v[128:131], a[160:163], v[160:163]
  v_mfma_f32_16x16x32_bf16 v[164:167], v[152:155], a[160:163], v[164:167]
  v_mfma_f32_16x16x32_bf16 v[160:163], v[132:135], a[164:167], v[160:163]
  v_mfma_f32_16x16x32_bf16 v[164:167], v[156:159], a[164:167], v[164:167]
  v_mfma_f32_16x16x32_bf16 v[168:171], v[112:115], a[168:171], 0
  v_mfma_f32_16x16x32_bf16 v[172:175], v[136:139], a[168:171], 0
  v_mfma_f32_16x16x32_bf16 v[168:171], v[116:119], a[172:175], v[168:171]
  v_cvt_pk_bf16_f32 v192, v160, v161
  v_cvt_pk_bf16_f32 v193, v162, v163
  v_mfma_f32_16x16x32_bf16 v[172:175], v[140:143], a[172:175], v[172:175]
  v_cvt_pk_bf16_f32 v194, v164, v165
  v_cvt_pk_bf16_f32 v195, v166, v167
  v_mfma_f32_16x16x32_bf16 v[168:171], v[120:123], a[176:179], v[168:171]
  buffer_store_dwordx4 v[192:195], v4, s[24:27], s55 offen offset:2048 sc1
  v_mfma_f32_16x16x32_bf16 v[172:175], v[144:147], a[176:179], v[172:175]
  v_mfma_f32_16x16x32_bf16 v[168:171], v[124:127], a[180:183], v[168:171]
  v_mfma_f32_16x16x32_bf16 v[172:175], v[148:151], a[180:183], v[172:175]
  v_mfma_f32_16x16x32_bf16 v[168:171], v[128:131], a[184:187], v[168:171]
  v_mfma_f32_16x16x32_bf16 v[172:175], v[152:155], a[184:187], v[172:175]
  v_mfma_f32_16x16x32_bf16 v[168:171], v[132:135], a[188:191], v[168:171]
  v_mfma_f32_16x16x32_bf16 v[172:175], v[156:159], a[188:191], v[172:175]
  v_mfma_f32_16x16x32_bf16 v[176:179], v[112:115], a[192:195], 0
  s_min_u32 s21, s45, 52
  v_mov_b32 v16, s21
  s_waitcnt vmcnt(11)
  v_mfma_f32_16x16x32_bf16 v[180:183], v[136:139], a[192:195], 0
  buffer_store_dword v16, v17, s[72:75], s44 offen sc1
  v_mfma_f32_16x16x32_bf16 v[176:179], v[116:119], a[196:199], v[176:179]
  v_cvt_pk_bf16_f32 v196, v168, v169
  v_cvt_pk_bf16_f32 v197, v170, v171
  v_mfma_f32_16x16x32_bf16 v[180:183], v[140:143], a[196:199], v[180:183]
  v_cvt_pk_bf16_f32 v198, v172, v173
  v_cvt_pk_bf16_f32 v199, v174, v175
  v_mfma_f32_16x16x32_bf16 v[176:179], v[120:123], a[200:203], v[176:179]
  buffer_store_dwordx4 v[196:199], v4, s[24:27], s55 offen offset:3072 sc1
  v_mfma_f32_16x16x32_bf16 v[180:183], v[144:147], a[200:203], v[180:183]
  v_mfma_f32_16x16x32_bf16 v[176:179], v[124:127], a[204:207], v[176:179]
  v_mfma_f32_16x16x32_bf16 v[180:183], v[148:151], a[204:207], v[180:183]
  v_mfma_f32_16x16x32_bf16 v[176:179], v[128:131], a[208:211], v[176:179]
  v_mfma_f32_16x16x32_bf16 v[180:183], v[152:155], a[208:211], v[180:183]
  v_mfma_f32_16x16x32_bf16 v[176:179], v[132:135], a[212:215], v[176:179]
  v_mfma_f32_16x16x32_bf16 v[180:183], v[156:159], a[212:215], v[180:183]
  v_mfma_f32_16x16x32_bf16 v[184:187], v[112:115], a[216:219], 0
  v_mfma_f32_16x16x32_bf16 v[188:191], v[136:139], a[216:219], 0
  v_mfma_f32_16x16x32_bf16 v[184:187], v[116:119], a[220:223], v[184:187]
  v_cvt_pk_bf16_f32 v200, v176, v177
  v_cvt_pk_bf16_f32 v201, v178, v179
  v_mfma_f32_16x16x32_bf16 v[188:191], v[140:143], a[220:223], v[188:191]
  v_cvt_pk_bf16_f32 v202, v180, v181
  v_cvt_pk_bf16_f32 v203, v182, v183
  v_mfma_f32_16x16x32_bf16 v[184:187], v[120:123], a[224:227], v[184:187]
  s_add_u32 s55, s42, 8192
  buffer_store_dwordx4 v[200:203], v4, s[24:27], s55 offen offset:0 sc1
  v_mfma_f32_16x16x32_bf16 v[188:191], v[144:147], a[224:227], v[188:191]
  v_mfma_f32_16x16x32_bf16 v[184:187], v[124:127], a[228:231], v[184:187]
  s_add_u32 s51, s42, 8192
  s_add_u32 s42, s42, 1310720
  s_add_u32 s45, s45, 1
  v_mfma_f32_16x16x32_bf16 v[188:191], v[148:151], a[228:231], v[188:191]
  v_mfma_f32_16x16x32_bf16 v[184:187], v[128:131], a[232:235], v[184:187]
  v_mfma_f32_16x16x32_bf16 v[188:191], v[152:155], a[232:235], v[188:191]
  v_mfma_f32_16x16x32_bf16 v[184:187], v[132:135], a[236:239], v[184:187]
  s_cmp_lt_u32 s45, s46
  v_mfma_f32_16x16x32_bf16 v[188:191], v[156:159], a[236:239], v[188:191]
  s_waitcnt lgkmcnt(0)
  s_cbranch_scc1 vwl_203
  s_nop 7
  v_cvt_pk_bf16_f32 v204, v184, v185
  v_cvt_pk_bf16_f32 v205, v186, v187
  v_cvt_pk_bf16_f32 v206, v188, v189
  v_cvt_pk_bf16_f32 v207, v190, v191
  buffer_store_dwordx4 v[204:207], v4, s[24:27], s51 offen offset:1024 sc1
  s_min_u32 s21, s45, 52
  v_mov_b32 v16, s21
  s_waitcnt vmcnt(0)
  buffer_store_dword v16, v17, s[72:75], s44 offen sc1
  s_cmp_lt_u32 s45, 64
  s_cbranch_scc1 vwr_200
  s_add_u32 s84, s38, 50331648
  s_addc_u32 s85, s39, 0
  s_mov_b32 s86, 6291456
  s_mov_b32 s87, 0x00020000
  s_add_u32 s80, s38, 93323264
  s_addc_u32 s81, s39, 0
  s_mov_b32 s82, 20971520
  s_mov_b32 s83, 0x00020000
  s_add_u32 s88, s38, 85983232
  s_addc_u32 s89, s39, 0
  s_mov_b32 s90, 5242880
  s_mov_b32 s91, 0x00020000
  v_mov_b32 v244, -1
  v_mov_b32 v245, -1
  v_mov_b32 v246, -1
  v_mov_b32 v247, -1
  v_lshlrev_b32 v21, 3, v1
  s_mul_i32 s21, s2, 10240
  s_mul_i32 s22, s20, 2560
  s_add_u32 s21, s21, s22
  s_add_u32 s21, s21, 18350080
  buffer_store_dwordx4 v[244:247], v4, s[80:83], s21 offen sc1
  buffer_store_dwordx4 v[244:247], v4, s[80:83], s21 offen offset:1024 sc1
  buffer_store_dwordx2 v[244:245], v21, s[80:83], s21 offen offset:2048 sc1
  s_add_u32 s21, s21, 327680
  buffer_store_dwordx4 v[244:247], v4, s[80:83], s21 offen sc1
  buffer_store_dwordx4 v[244:247], v4, s[80:83], s21 offen offset:1024 sc1
  buffer_store_dwordx2 v[244:245], v21, s[80:83], s21 offen offset:2048 sc1
  s_add_u32 s21, s21, 327680
  buffer_store_dwordx4 v[244:247], v4, s[80:83], s21 offen sc1
  buffer_store_dwordx4 v[244:247], v4, s[80:83], s21 offen offset:1024 sc1
  buffer_store_dwordx2 v[244:245], v21, s[80:83], s21 offen offset:2048 sc1
  s_add_u32 s21, s21, 327680
  buffer_store_dwordx4 v[244:247], v4, s[80:83], s21 offen sc1
  buffer_store_dwordx4 v[244:247], v4, s[80:83], s21 offen offset:1024 sc1
  buffer_store_dwordx2 v[244:245], v21, s[80:83], s21 offen offset:2048 sc1
  s_add_u32 s21, s21, 327680
  buffer_store_dwordx4 v[244:247], v4, s[80:83], s21 offen sc1
  buffer_store_dwordx4 v[244:247], v4, s[80:83], s21 offen offset:1024 sc1
  buffer_store_dwordx2 v[244:245], v21, s[80:83], s21 offen offset:2048 sc1
  s_add_u32 s21, s21, 327680
  buffer_store_dwordx4 v[244:247], v4, s[80:83], s21 offen sc1
  buffer_store_dwordx4 v[244:247], v4, s[80:83], s21 offen offset:1024 sc1
  buffer_store_dwordx2 v[244:245], v21, s[80:83], s21 offen offset:2048 sc1
  s_add_u32 s21, s21, 327680
  buffer_store_dwordx4 v[244:247], v4, s[80:83], s21 offen sc1
  buffer_store_dwordx4 v[244:247], v4, s[80:83], s21 offen offset:1024 sc1
  buffer_store_dwordx2 v[244:245], v21, s[80:83], s21 offen offset:2048 sc1
  s_add_u32 s21, s21, 327680
  buffer_store_dwordx4 v[244:247], v4, s[80:83], s21 offen sc1
  buffer_store_dwordx4 v[244:247], v4, s[80:83], s21 offen offset:1024 sc1
  buffer_store_dwordx2 v[244:245], v21, s[80:83], s21 offen offset:2048 sc1
  s_add_u32 s21, s21, 327680
  s_and_b32 s21, s2, 3
  s_cmp_lg_u32 s21, s20
  s_cbranch_scc1 arm_204
  s_waitcnt vmcnt(12)
  s_mul_i32 s21, s2, 2560
  s_add_u32 s21, s21, 4587520
  buffer_store_dwordx4 v[244:247], v4, s[88:91], s21 offen sc1
  buffer_store_dwordx4 v[244:247], v4, s[88:91], s21 offen offset:1024 sc1
  buffer_store_dwordx2 v[244:245], v21, s[88:91], s21 offen offset:2048 sc1
  s_add_u32 s21, s21, 81920
  buffer_store_dwordx4 v[244:247], v4, s[88:91], s21 offen sc1
  buffer_store_dwordx4 v[244:247], v4, s[88:91], s21 offen offset:1024 sc1
  buffer_store_dwordx2 v[244:245], v21, s[88:91], s21 offen offset:2048 sc1
  s_add_u32 s21, s21, 81920
  buffer_store_dwordx4 v[244:247], v4, s[88:91], s21 offen sc1
  buffer_store_dwordx4 v[244:247], v4, s[88:91], s21 offen offset:1024 sc1
  buffer_store_dwordx2 v[244:245], v21, s[88:91], s21 offen offset:2048 sc1
  s_add_u32 s21, s21, 81920
  buffer_store_dwordx4 v[244:247], v4, s[88:91], s21 offen sc1
  buffer_store_dwordx4 v[244:247], v4, s[88:91], s21 offen offset:1024 sc1
  buffer_store_dwordx2 v[244:245], v21, s[88:91], s21 offen offset:2048 sc1
  s_add_u32 s21, s21, 81920
  buffer_store_dwordx4 v[244:247], v4, s[88:91], s21 offen sc1
  buffer_store_dwordx4 v[244:247], v4, s[88:91], s21 offen offset:1024 sc1
  buffer_store_dwordx2 v[244:245], v21, s[88:91], s21 offen offset:2048 sc1
  s_add_u32 s21, s21, 81920
  buffer_store_dwordx4 v[244:247], v4, s[88:91], s21 offen sc1
  buffer_store_dwordx4 v[244:247], v4, s[88:91], s21 offen offset:1024 sc1
  buffer_store_dwordx2 v[244:245], v21, s[88:91], s21 offen offset:2048 sc1
  s_add_u32 s21, s21, 81920
  buffer_store_dwordx4 v[244:247], v4, s[88:91], s21 offen sc1
  buffer_store_dwordx4 v[244:247], v4, s[88:91], s21 offen offset:1024 sc1
  buffer_store_dwordx2 v[244:245], v21, s[88:91], s21 offen offset:2048 sc1
  s_add_u32 s21, s21, 81920
  buffer_store_dwordx4 v[244:247], v4, s[88:91], s21 offen sc1
  buffer_store_dwordx4 v[244:247], v4, s[88:91], s21 offen offset:1024 sc1
  buffer_store_dwordx2 v[244:245], v21, s[88:91], s21 offen offset:2048 sc1
  s_add_u32 s21, s21, 81920
  s_mul_i32 s21, s2, 3072
  s_add_u32 s21, s21, 5898240
  buffer_store_dwordx4 v[244:247], v4, s[84:87], s21 offen offset:0 sc1
  buffer_store_dwordx4 v[244:247], v4, s[84:87], s21 offen offset:1024 sc1
  buffer_store_dwordx4 v[244:247], v4, s[84:87], s21 offen offset:2048 sc1
  s_add_u32 s21, s21, 98304
  buffer_store_dwordx4 v[244:247], v4, s[84:87], s21 offen offset:0 sc1
  buffer_store_dwordx4 v[244:247], v4, s[84:87], s21 offen offset:1024 sc1
  buffer_store_dwordx4 v[244:247], v4, s[84:87], s21 offen offset:2048 sc1
  s_add_u32 s21, s21, 98304
  buffer_store_dwordx4 v[244:247], v4, s[84:87], s21 offen offset:0 sc1
  buffer_store_dwordx4 v[244:247], v4, s[84:87], s21 offen offset:1024 sc1
  buffer_store_dwordx4 v[244:247], v4, s[84:87], s21 offen offset:2048 sc1
  s_add_u32 s21, s21, 98304
  buffer_store_dwordx4 v[244:247], v4, s[84:87], s21 offen offset:0 sc1
  buffer_store_dwordx4 v[244:247], v4, s[84:87], s21 offen offset:1024 sc1
  buffer_store_dwordx4 v[244:247], v4, s[84:87], s21 offen offset:2048 sc1
  s_add_u32 s21, s21, 98304
arm_204:
  v_mov_b32 v16, 64
  s_waitcnt vmcnt(0)
  buffer_store_dword v16, v17, s[72:75], s44 offen sc1
  s_mov_b32 s84, 0
  s_mov_b32 s85, -1
  s_mov_b32 s86, 0
  s_branch queue
not_vw:
  s_sub_u32 s2, s3, 96
  s_cmp_lg_u32 s2, 31
  s_cbranch_scc1 not_cal
  s_load_dwordx2 s[72:73], s[0:1], 104
  s_waitcnt lgkmcnt(0)
  s_add_u32 s72, s72, 81068032
  s_addc_u32 s73, s73, 0
  s_mov_b32 s74, 96768
  s_mov_b32 s75, 0x00020000
  v_lshlrev_b32 v8, 4, v0
  v_mov_b32 v4, 0
  v_mov_b32 v5, 0
  v_mov_b32 v6, 0
  v_mov_b32 v7, 0
  s_mov_b32 s21, 0
  buffer_store_dwordx4 v[4:7], v8, s[72:75], s21 offen sc1
  s_mov_b32 s21, 4096
  buffer_store_dwordx4 v[4:7], v8, s[72:75], s21 offen sc1
  s_mov_b32 s21, 8192
  buffer_store_dwordx4 v[4:7], v8, s[72:75], s21 offen sc1
  s_mov_b32 s21, 12288
  buffer_store_dwordx4 v[4:7], v8, s[72:75], s21 offen sc1
  s_mov_b32 s21, 16384
  buffer_store_dwordx4 v[4:7], v8, s[72:75], s21 offen sc1
  s_mov_b32 s21, 20480
  buffer_store_dwordx4 v[4:7], v8, s[72:75], s21 offen sc1
  s_mov_b32 s21, 24576
  buffer_store_dwordx4 v[4:7], v8, s[72:75], s21 offen sc1
  s_mov_b32 s21, 28672
  buffer_store_dwordx4 v[4:7], v8, s[72:75], s21 offen sc1
  s_mov_b32 s21, 32768
  buffer_store_dwordx4 v[4:7], v8, s[72:75], s21 offen sc1
  s_mov_b32 s21, 36864
  buffer_store_dwordx4 v[4:7], v8, s[72:75], s21 offen sc1
  s_mov_b32 s21, 40960
  buffer_store_dwordx4 v[4:7], v8, s[72:75], s21 offen sc1
  s_mov_b32 s21, 45056
  buffer_store_dwordx4 v[4:7], v8, s[72:75], s21 offen sc1
  s_mov_b32 s21, 49152
  buffer_store_dwordx4 v[4:7], v8, s[72:75], s21 offen sc1
  s_mov_b32 s21, 53248
  buffer_store_dwordx4 v[4:7], v8, s[72:75], s21 offen sc1
  s_mov_b32 s21, 57344
  buffer_store_dwordx4 v[4:7], v8, s[72:75], s21 offen sc1
  s_mov_b32 s21, 61440
  buffer_store_dwordx4 v[4:7], v8, s[72:75], s21 offen sc1
  s_mov_b32 s21, 65536
  buffer_store_dwordx4 v[4:7], v8, s[72:75], s21 offen sc1
  s_mov_b32 s21, 69632
  buffer_store_dwordx4 v[4:7], v8, s[72:75], s21 offen sc1
  s_mov_b32 s21, 73728
  buffer_store_dwordx4 v[4:7], v8, s[72:75], s21 offen sc1
  s_mov_b32 s21, 77824
  buffer_store_dwordx4 v[4:7], v8, s[72:75], s21 offen sc1
  s_mov_b32 s21, 81920
  buffer_store_dwordx4 v[4:7], v8, s[72:75], s21 offen sc1
  s_mov_b32 s21, 86016
  buffer_store_dwordx4 v[4:7], v8, s[72:75], s21 offen sc1
  s_mov_b32 s21, 90112
  buffer_store_dwordx4 v[4:7], v8, s[72:75], s21 offen sc1
  s_mov_b32 s21, 94208
  buffer_store_dwordx4 v[4:7], v8, s[72:75], s21 offen sc1
  s_waitcnt vmcnt(0)
  s_barrier
  s_cmp_lg_u32 s20, 0
  s_cbranch_scc1 cal_205
  s_mov_b64 exec, 1
  v_mov_b32 v4, 76
  v_mov_b32 v5, 1
  buffer_store_dword v5, v4, s[32:35], 0 offen sc1
  s_add_u32 s8, s38, 83886079
  s_addc_u32 s9, s39, 0
  s_and_b32 s8, s8, 0xffe00000
  s_mov_b32 s10, 2097152
  s_mov_b32 s11, 0x00020000
  v_mov_b32 v4, 0
  s_mov_b32 s40, -1
  s_mov_b32 s41, -1
  s_mov_b32 s42, 1048576
  s_mov_b32 s43, 0
  s_waitcnt vmcnt(0)
cal_206:
  s_add_u32 s21, s42, 0
  s_memtime s[98:99]
  s_waitcnt lgkmcnt(0)
  buffer_load_dword v5, v4, s[8:11], s21 offen sc1
  s_waitcnt vmcnt(0)
  s_memtime s[100:101]
  s_waitcnt lgkmcnt(0)
  s_sub_u32 s21, s100, s98
  s_min_u32 s40, s40, s21
  s_add_u32 s21, s42, 8192
  s_memtime s[98:99]
  s_waitcnt lgkmcnt(0)
  buffer_load_dword v5, v4, s[8:11], s21 offen sc1
  s_waitcnt vmcnt(0)
  s_memtime s[100:101]
  s_waitcnt lgkmcnt(0)
  s_sub_u32 s21, s100, s98
  s_min_u32 s41, s41, s21
  s_add_u32 s42, s42, 16640
  s_add_u32 s43, s43, 1
  s_cmp_lt_u32 s43, 8
  s_cbranch_scc1 cal_206
  s_cmp_lt_u32 s41, s40
  s_cselect_b32 s21, 1, 2
  v_mov_b32 v4, s21
  v_mov_b32 v5, s40
  v_mov_b32 v6, s41
  v_mov_b32 v8, 84
  buffer_store_dwordx3 v[4:6], v8, s[32:35], 0 offen sc1
  s_waitcnt vmcnt(0)
  s_mov_b64 exec, -1
cal_205:
not_cal:
  s_load_dwordx2 s[4:5], s[0:1], 0
  s_load_dwordx2 s[6:7], s[0:1], 64
  s_load_dwordx2 s[36:37], s[0:1], 80
  s_load_dwordx2 s[38:39], s[0:1], 104
  s_lshr_b32 s41, s2, 3
  s_lshl_b32 s41, s41, 1
  s_and_b32 s21, s2, 1
  s_add_u32 s41, s41, s21
  s_bfe_u32 s42, s2, 0x20001
  s_waitcnt lgkmcnt(0)
  s_mov_b32 s8, s4
  s_mov_b32 s9, s5
  s_mov_b32 s10, 2621440
  s_mov_b32 s11, 0x00020000
  s_mov_b32 s12, s6
  s_mov_b32 s13, s7
  s_mov_b32 s14, 2457600
  s_mov_b32 s15, 0x00020000
  s_mov_b32 s24, s36
  s_mov_b32 s25, s37
  s_mov_b32 s26, 1280
  s_mov_b32 s27, 0x00020000
  s_add_u32 s16, s38, 70778880
  s_addc_u32 s17, s39, 0
  s_mov_b32 s18, 2621440
  s_mov_b32 s19, 0x00020000
  s_add_u32 s76, s38, 81002496
  s_addc_u32 s77, s39, 0
  s_mov_b32 s78, 8192
  s_mov_b32 s79, 0x00020000
  s_add_u32 s72, s38, 81068032
  s_addc_u32 s73, s39, 0
  s_mov_b32 s74, 96768
  s_mov_b32 s75, 0x00020000
  s_lshl_b32 s59, s2, 2
  s_add_u32 s59, s59, s20
  s_lshl_b32 s59, s59, 4
  v_lshlrev_b32 v4, 2, v1
  s_mul_i32 s22, s59, 1280
  buffer_load_dword v16, v4, s[24:27], 0 offen offset:0
  buffer_load_dword v17, v4, s[24:27], 0 offen offset:256
  buffer_load_dword v18, v4, s[24:27], 0 offen offset:512
  buffer_load_dword v19, v4, s[24:27], 0 offen offset:768
  buffer_load_dword v20, v4, s[24:27], 0 offen offset:1024
  buffer_load_dword v64, v4, s[8:11], s22 offen offset:0
  buffer_load_dword v65, v4, s[8:11], s22 offen offset:256
  buffer_load_dword v66, v4, s[8:11], s22 offen offset:512
  buffer_load_dword v67, v4, s[8:11], s22 offen offset:768
  buffer_load_dword v68, v4, s[8:11], s22 offen offset:1024
  s_add_u32 s22, s22, 1280
  buffer_load_dword v69, v4, s[8:11], s22 offen offset:0
  buffer_load_dword v70, v4, s[8:11], s22 offen offset:256
  buffer_load_dword v71, v4, s[8:11], s22 offen offset:512
  buffer_load_dword v72, v4, s[8:11], s22 offen offset:768
  buffer_load_dword v73, v4, s[8:11], s22 offen offset:1024
  s_add_u32 s22, s22, 1280
  buffer_load_dword v74, v4, s[8:11], s22 offen offset:0
  buffer_load_dword v75, v4, s[8:11], s22 offen offset:256
  buffer_load_dword v76, v4, s[8:11], s22 offen offset:512
  buffer_load_dword v77, v4, s[8:11], s22 offen offset:768
  buffer_load_dword v78, v4, s[8:11], s22 offen offset:1024
  s_add_u32 s22, s22, 1280
  buffer_load_dword v79, v4, s[8:11], s22 offen offset:0
  buffer_load_dword v80, v4, s[8:11], s22 offen offset:256
  buffer_load_dword v81, v4, s[8:11], s22 offen offset:512
  buffer_load_dword v82, v4, s[8:11], s22 offen offset:768
  buffer_load_dword v83, v4, s[8:11], s22 offen offset:1024
  s_add_u32 s22, s22, 1280
  buffer_load_dword v84, v4, s[8:11], s22 offen offset:0
  buffer_load_dword v85, v4, s[8:11], s22 offen offset:256
  buffer_load_dword v86, v4, s[8:11], s22 offen offset:512
  buffer_load_dword v87, v4, s[8:11], s22 offen offset:768
  buffer_load_dword v88, v4, s[8:11], s22 offen offset:1024
  s_add_u32 s22, s22, 1280
  buffer_load_dword v89, v4, s[8:11], s22 offen offset:0
  buffer_load_dword v90, v4, s[8:11], s22 offen offset:256
  buffer_load_dword v91, v4, s[8:11], s22 offen offset:512
  buffer_load_dword v92, v4, s[8:11], s22 offen offset:768
  buffer_load_dword v93, v4, s[8:11], s22 offen offset:1024
  s_add_u32 s22, s22, 1280
  buffer_load_dword v94, v4, s[8:11], s22 offen offset:0
  buffer_load_dword v95, v4, s[8:11], s22 offen offset:256
  buffer_load_dword v96, v4, s[8:11], s22 offen offset:512
  buffer_load_dword v97, v4, s[8:11], s22 offen offset:768
  buffer_load_dword v98, v4, s[8:11], s22 offen offset:1024
  s_add_u32 s22, s22, 1280
  buffer_load_dword v99, v4, s[8:11], s22 offen offset:0
  buffer_load_dword v100, v4, s[8:11], s22 offen offset:256
  buffer_load_dword v101, v4, s[8:11], s22 offen offset:512
  buffer_load_dword v102, v4, s[8:11], s22 offen offset:768
  buffer_load_dword v103, v4, s[8:11], s22 offen offset:1024
  s_add_u32 s22, s22, 1280
  buffer_load_dword v104, v4, s[8:11], s22 offen offset:0
  buffer_load_dword v105, v4, s[8:11], s22 offen offset:256
  buffer_load_dword v106, v4, s[8:11], s22 offen offset:512
  buffer_load_dword v107, v4, s[8:11], s22 offen offset:768
  buffer_load_dword v108, v4, s[8:11], s22 offen offset:1024
  s_add_u32 s22, s22, 1280
  buffer_load_dword v109, v4, s[8:11], s22 offen offset:0
  buffer_load_dword v110, v4, s[8:11], s22 offen offset:256
  buffer_load_dword v111, v4, s[8:11], s22 offen offset:512
  buffer_load_dword v112, v4, s[8:11], s22 offen offset:768
  buffer_load_dword v113, v4, s[8:11], s22 offen offset:1024
  s_add_u32 s22, s22, 1280
  buffer_load_dword v114, v4, s[8:11], s22 offen offset:0
  buffer_load_dword v115, v4, s[8:11], s22 offen offset:256
  buffer_load_dword v116, v4, s[8:11], s22 offen offset:512
  buffer_load_dword v117, v4, s[8:11], s22 offen offset:768
  buffer_load_dword v118, v4, s[8:11], s22 offen offset:1024
  s_add_u32 s22, s22, 1280
  s_waitcnt vmcnt(55)
  v_lshlrev_b32 v8, 16, v16
  v_and_b32 v16, 0xffff0000, v16
  v_lshlrev_b32 v9, 16, v17
  v_and_b32 v17, 0xffff0000, v17
  v_lshlrev_b32 v10, 16, v18
  v_and_b32 v18, 0xffff0000, v18
  v_lshlrev_b32 v11, 16, v19
  v_and_b32 v19, 0xffff0000, v19
  v_lshlrev_b32 v12, 16, v20
  v_and_b32 v20, 0xffff0000, v20
  s_waitcnt vmcnt(50)
  v_mov_b32 v32, 0
  buffer_load_dword v119, v4, s[8:11], s22 offen offset:0
  buffer_load_dword v120, v4, s[8:11], s22 offen offset:256
  buffer_load_dword v121, v4, s[8:11], s22 offen offset:512
  buffer_load_dword v122, v4, s[8:11], s22 offen offset:768
  buffer_load_dword v123, v4, s[8:11], s22 offen offset:1024
  s_add_u32 s22, s22, 1280
  v_lshlrev_b32 v25, 16, v64
  v_and_b32 v26, 0xffff0000, v64
  v_mul_f32 v25, v25, v8
  v_mul_f32 v26, v26, v16
  v_cvt_pk_bf16_f32 v25, v25, v26
  v_lshlrev_b32 v26, 16, v25
  v_and_b32 v25, 0xffff0000, v25
  v_add_f32 v32, v32, v26
  v_add_f32 v32, v32, v25
  v_lshlrev_b32 v25, 16, v65
  v_and_b32 v26, 0xffff0000, v65
  v_mul_f32 v25, v25, v9
  v_mul_f32 v26, v26, v17
  v_cvt_pk_bf16_f32 v25, v25, v26
  v_lshlrev_b32 v26, 16, v25
  v_and_b32 v25, 0xffff0000, v25
  v_add_f32 v32, v32, v26
  v_add_f32 v32, v32, v25
  v_lshlrev_b32 v25, 16, v66
  v_and_b32 v26, 0xffff0000, v66
  v_mul_f32 v25, v25, v10
  v_mul_f32 v26, v26, v18
  v_cvt_pk_bf16_f32 v25, v25, v26
  v_lshlrev_b32 v26, 16, v25
  v_and_b32 v25, 0xffff0000, v25
  v_add_f32 v32, v32, v26
  v_add_f32 v32, v32, v25
  v_lshlrev_b32 v25, 16, v67
  v_and_b32 v26, 0xffff0000, v67
  v_mul_f32 v25, v25, v11
  v_mul_f32 v26, v26, v19
  v_cvt_pk_bf16_f32 v25, v25, v26
  v_lshlrev_b32 v26, 16, v25
  v_and_b32 v25, 0xffff0000, v25
  v_add_f32 v32, v32, v26
  v_add_f32 v32, v32, v25
  v_lshlrev_b32 v25, 16, v68
  v_and_b32 v26, 0xffff0000, v68
  v_mul_f32 v25, v25, v12
  v_mul_f32 v26, v26, v20
  v_cvt_pk_bf16_f32 v25, v25, v26
  v_lshlrev_b32 v26, 16, v25
  v_and_b32 v25, 0xffff0000, v25
  v_add_f32 v32, v32, v26
  v_add_f32 v32, v32, v25
  s_waitcnt vmcnt(50)
  v_mov_b32 v33, 0
  buffer_load_dword v124, v4, s[8:11], s22 offen offset:0
  buffer_load_dword v125, v4, s[8:11], s22 offen offset:256
  buffer_load_dword v126, v4, s[8:11], s22 offen offset:512
  buffer_load_dword v127, v4, s[8:11], s22 offen offset:768
  buffer_load_dword v128, v4, s[8:11], s22 offen offset:1024
  s_add_u32 s22, s22, 1280
  v_lshlrev_b32 v25, 16, v69
  v_and_b32 v26, 0xffff0000, v69
  v_mul_f32 v25, v25, v8
  v_mul_f32 v26, v26, v16
  v_cvt_pk_bf16_f32 v25, v25, v26
  v_lshlrev_b32 v26, 16, v25
  v_and_b32 v25, 0xffff0000, v25
  v_add_f32 v33, v33, v26
  v_add_f32 v33, v33, v25
  v_lshlrev_b32 v25, 16, v70
  v_and_b32 v26, 0xffff0000, v70
  v_mul_f32 v25, v25, v9
  v_mul_f32 v26, v26, v17
  v_cvt_pk_bf16_f32 v25, v25, v26
  v_lshlrev_b32 v26, 16, v25
  v_and_b32 v25, 0xffff0000, v25
  v_add_f32 v33, v33, v26
  v_add_f32 v33, v33, v25
  v_lshlrev_b32 v25, 16, v71
  v_and_b32 v26, 0xffff0000, v71
  v_mul_f32 v25, v25, v10
  v_mul_f32 v26, v26, v18
  v_cvt_pk_bf16_f32 v25, v25, v26
  v_lshlrev_b32 v26, 16, v25
  v_and_b32 v25, 0xffff0000, v25
  v_add_f32 v33, v33, v26
  v_add_f32 v33, v33, v25
  v_lshlrev_b32 v25, 16, v72
  v_and_b32 v26, 0xffff0000, v72
  v_mul_f32 v25, v25, v11
  v_mul_f32 v26, v26, v19
  v_cvt_pk_bf16_f32 v25, v25, v26
  v_lshlrev_b32 v26, 16, v25
  v_and_b32 v25, 0xffff0000, v25
  v_add_f32 v33, v33, v26
  v_add_f32 v33, v33, v25
  v_lshlrev_b32 v25, 16, v73
  v_and_b32 v26, 0xffff0000, v73
  v_mul_f32 v25, v25, v12
  v_mul_f32 v26, v26, v20
  v_cvt_pk_bf16_f32 v25, v25, v26
  v_lshlrev_b32 v26, 16, v25
  v_and_b32 v25, 0xffff0000, v25
  v_add_f32 v33, v33, v26
  v_add_f32 v33, v33, v25
  s_waitcnt vmcnt(50)
  v_mov_b32 v34, 0
  buffer_load_dword v129, v4, s[8:11], s22 offen offset:0
  buffer_load_dword v130, v4, s[8:11], s22 offen offset:256
  buffer_load_dword v131, v4, s[8:11], s22 offen offset:512
  buffer_load_dword v132, v4, s[8:11], s22 offen offset:768
  buffer_load_dword v133, v4, s[8:11], s22 offen offset:1024
  s_add_u32 s22, s22, 1280
  v_lshlrev_b32 v25, 16, v74
  v_and_b32 v26, 0xffff0000, v74
  v_mul_f32 v25, v25, v8
  v_mul_f32 v26, v26, v16
  v_cvt_pk_bf16_f32 v25, v25, v26
  v_lshlrev_b32 v26, 16, v25
  v_and_b32 v25, 0xffff0000, v25
  v_add_f32 v34, v34, v26
  v_add_f32 v34, v34, v25
  v_lshlrev_b32 v25, 16, v75
  v_and_b32 v26, 0xffff0000, v75
  v_mul_f32 v25, v25, v9
  v_mul_f32 v26, v26, v17
  v_cvt_pk_bf16_f32 v25, v25, v26
  v_lshlrev_b32 v26, 16, v25
  v_and_b32 v25, 0xffff0000, v25
  v_add_f32 v34, v34, v26
  v_add_f32 v34, v34, v25
  v_lshlrev_b32 v25, 16, v76
  v_and_b32 v26, 0xffff0000, v76
  v_mul_f32 v25, v25, v10
  v_mul_f32 v26, v26, v18
  v_cvt_pk_bf16_f32 v25, v25, v26
  v_lshlrev_b32 v26, 16, v25
  v_and_b32 v25, 0xffff0000, v25
  v_add_f32 v34, v34, v26
  v_add_f32 v34, v34, v25
  v_lshlrev_b32 v25, 16, v77
  v_and_b32 v26, 0xffff0000, v77
  v_mul_f32 v25, v25, v11
  v_mul_f32 v26, v26, v19
  v_cvt_pk_bf16_f32 v25, v25, v26
  v_lshlrev_b32 v26, 16, v25
  v_and_b32 v25, 0xffff0000, v25
  v_add_f32 v34, v34, v26
  v_add_f32 v34, v34, v25
  v_lshlrev_b32 v25, 16, v78
  v_and_b32 v26, 0xffff0000, v78
  v_mul_f32 v25, v25, v12
  v_mul_f32 v26, v26, v20
  v_cvt_pk_bf16_f32 v25, v25, v26
  v_lshlrev_b32 v26, 16, v25
  v_and_b32 v25, 0xffff0000, v25
  v_add_f32 v34, v34, v26
  v_add_f32 v34, v34, v25
  s_waitcnt vmcnt(50)
  v_mov_b32 v35, 0
  buffer_load_dword v134, v4, s[8:11], s22 offen offset:0
  buffer_load_dword v135, v4, s[8:11], s22 offen offset:256
  buffer_load_dword v136, v4, s[8:11], s22 offen offset:512
  buffer_load_dword v137, v4, s[8:11], s22 offen offset:768
  buffer_load_dword v138, v4, s[8:11], s22 offen offset:1024
  s_add_u32 s22, s22, 1280
  v_lshlrev_b32 v25, 16, v79
  v_and_b32 v26, 0xffff0000, v79
  v_mul_f32 v25, v25, v8
  v_mul_f32 v26, v26, v16
  v_cvt_pk_bf16_f32 v25, v25, v26
  v_lshlrev_b32 v26, 16, v25
  v_and_b32 v25, 0xffff0000, v25
  v_add_f32 v35, v35, v26
  v_add_f32 v35, v35, v25
  v_lshlrev_b32 v25, 16, v80
  v_and_b32 v26, 0xffff0000, v80
  v_mul_f32 v25, v25, v9
  v_mul_f32 v26, v26, v17
  v_cvt_pk_bf16_f32 v25, v25, v26
  v_lshlrev_b32 v26, 16, v25
  v_and_b32 v25, 0xffff0000, v25
  v_add_f32 v35, v35, v26
  v_add_f32 v35, v35, v25
  v_lshlrev_b32 v25, 16, v81
  v_and_b32 v26, 0xffff0000, v81
  v_mul_f32 v25, v25, v10
  v_mul_f32 v26, v26, v18
  v_cvt_pk_bf16_f32 v25, v25, v26
  v_lshlrev_b32 v26, 16, v25
  v_and_b32 v25, 0xffff0000, v25
  v_add_f32 v35, v35, v26
  v_add_f32 v35, v35, v25
  v_lshlrev_b32 v25, 16, v82
  v_and_b32 v26, 0xffff0000, v82
  v_mul_f32 v25, v25, v11
  v_mul_f32 v26, v26, v19
  v_cvt_pk_bf16_f32 v25, v25, v26
  v_lshlrev_b32 v26, 16, v25
  v_and_b32 v25, 0xffff0000, v25
  v_add_f32 v35, v35, v26
  v_add_f32 v35, v35, v25
  v_lshlrev_b32 v25, 16, v83
  v_and_b32 v26, 0xffff0000, v83
  v_mul_f32 v25, v25, v12
  v_mul_f32 v26, v26, v20
  v_cvt_pk_bf16_f32 v25, v25, v26
  v_lshlrev_b32 v26, 16, v25
  v_and_b32 v25, 0xffff0000, v25
  v_add_f32 v35, v35, v26
  v_add_f32 v35, v35, v25
  s_waitcnt vmcnt(50)
  v_mov_b32 v36, 0
  buffer_load_dword v139, v4, s[8:11], s22 offen offset:0
  buffer_load_dword v140, v4, s[8:11], s22 offen offset:256
  buffer_load_dword v141, v4, s[8:11], s22 offen offset:512
  buffer_load_dword v142, v4, s[8:11], s22 offen offset:768
  buffer_load_dword v143, v4, s[8:11], s22 offen offset:1024
  s_add_u32 s22, s22, 1280
  v_lshlrev_b32 v25, 16, v84
  v_and_b32 v26, 0xffff0000, v84
  v_mul_f32 v25, v25, v8
  v_mul_f32 v26, v26, v16
  v_cvt_pk_bf16_f32 v25, v25, v26
  v_lshlrev_b32 v26, 16, v25
  v_and_b32 v25, 0xffff0000, v25
  v_add_f32 v36, v36, v26
  v_add_f32 v36, v36, v25
  v_lshlrev_b32 v25, 16, v85
  v_and_b32 v26, 0xffff0000, v85
  v_mul_f32 v25, v25, v9
  v_mul_f32 v26, v26, v17
  v_cvt_pk_bf16_f32 v25, v25, v26
  v_lshlrev_b32 v26, 16, v25
  v_and_b32 v25, 0xffff0000, v25
  v_add_f32 v36, v36, v26
  v_add_f32 v36, v36, v25
  v_lshlrev_b32 v25, 16, v86
  v_and_b32 v26, 0xffff0000, v86
  v_mul_f32 v25, v25, v10
  v_mul_f32 v26, v26, v18
  v_cvt_pk_bf16_f32 v25, v25, v26
  v_lshlrev_b32 v26, 16, v25
  v_and_b32 v25, 0xffff0000, v25
  v_add_f32 v36, v36, v26
  v_add_f32 v36, v36, v25
  v_lshlrev_b32 v25, 16, v87
  v_and_b32 v26, 0xffff0000, v87
  v_mul_f32 v25, v25, v11
  v_mul_f32 v26, v26, v19
  v_cvt_pk_bf16_f32 v25, v25, v26
  v_lshlrev_b32 v26, 16, v25
  v_and_b32 v25, 0xffff0000, v25
  v_add_f32 v36, v36, v26
  v_add_f32 v36, v36, v25
  v_lshlrev_b32 v25, 16, v88
  v_and_b32 v26, 0xffff0000, v88
  v_mul_f32 v25, v25, v12
  v_mul_f32 v26, v26, v20
  v_cvt_pk_bf16_f32 v25, v25, v26
  v_lshlrev_b32 v26, 16, v25
  v_and_b32 v25, 0xffff0000, v25
  v_add_f32 v36, v36, v26
  v_add_f32 v36, v36, v25
  s_waitcnt vmcnt(50)
  v_mov_b32 v37, 0
  v_lshlrev_b32 v25, 16, v89
  v_and_b32 v26, 0xffff0000, v89
  v_mul_f32 v25, v25, v8
  v_mul_f32 v26, v26, v16
  v_cvt_pk_bf16_f32 v25, v25, v26
  v_lshlrev_b32 v26, 16, v25
  v_and_b32 v25, 0xffff0000, v25
  v_add_f32 v37, v37, v26
  v_add_f32 v37, v37, v25
  v_lshlrev_b32 v25, 16, v90
  v_and_b32 v26, 0xffff0000, v90
  v_mul_f32 v25, v25, v9
  v_mul_f32 v26, v26, v17
  v_cvt_pk_bf16_f32 v25, v25, v26
  v_lshlrev_b32 v26, 16, v25
  v_and_b32 v25, 0xffff0000, v25
  v_add_f32 v37, v37, v26
  v_add_f32 v37, v37, v25
  v_lshlrev_b32 v25, 16, v91
  v_and_b32 v26, 0xffff0000, v91
  v_mul_f32 v25, v25, v10
  v_mul_f32 v26, v26, v18
  v_cvt_pk_bf16_f32 v25, v25, v26
  v_lshlrev_b32 v26, 16, v25
  v_and_b32 v25, 0xffff0000, v25
  v_add_f32 v37, v37, v26
  v_add_f32 v37, v37, v25
  v_lshlrev_b32 v25, 16, v92
  v_and_b32 v26, 0xffff0000, v92
  v_mul_f32 v25, v25, v11
  v_mul_f32 v26, v26, v19
  v_cvt_pk_bf16_f32 v25, v25, v26
  v_lshlrev_b32 v26, 16, v25
  v_and_b32 v25, 0xffff0000, v25
  v_add_f32 v37, v37, v26
  v_add_f32 v37, v37, v25
  v_lshlrev_b32 v25, 16, v93
  v_and_b32 v26, 0xffff0000, v93
  v_mul_f32 v25, v25, v12
  v_mul_f32 v26, v26, v20
  v_cvt_pk_bf16_f32 v25, v25, v26
  v_lshlrev_b32 v26, 16, v25
  v_and_b32 v25, 0xffff0000, v25
  v_add_f32 v37, v37, v26
  v_add_f32 v37, v37, v25
  s_waitcnt vmcnt(45)
  v_mov_b32 v38, 0
  v_lshlrev_b32 v25, 16, v94
  v_and_b32 v26, 0xffff0000, v94
  v_mul_f32 v25, v25, v8
  v_mul_f32 v26, v26, v16
  v_cvt_pk_bf16_f32 v25, v25, v26
  v_lshlrev_b32 v26, 16, v25
  v_and_b32 v25, 0xffff0000, v25
  v_add_f32 v38, v38, v26
  v_add_f32 v38, v38, v25
  v_lshlrev_b32 v25, 16, v95
  v_and_b32 v26, 0xffff0000, v95
  v_mul_f32 v25, v25, v9
  v_mul_f32 v26, v26, v17
  v_cvt_pk_bf16_f32 v25, v25, v26
  v_lshlrev_b32 v26, 16, v25
  v_and_b32 v25, 0xffff0000, v25
  v_add_f32 v38, v38, v26
  v_add_f32 v38, v38, v25
  v_lshlrev_b32 v25, 16, v96
  v_and_b32 v26, 0xffff0000, v96
  v_mul_f32 v25, v25, v10
  v_mul_f32 v26, v26, v18
  v_cvt_pk_bf16_f32 v25, v25, v26
  v_lshlrev_b32 v26, 16, v25
  v_and_b32 v25, 0xffff0000, v25
  v_add_f32 v38, v38, v26
  v_add_f32 v38, v38, v25
  v_lshlrev_b32 v25, 16, v97
  v_and_b32 v26, 0xffff0000, v97
  v_mul_f32 v25, v25, v11
  v_mul_f32 v26, v26, v19
  v_cvt_pk_bf16_f32 v25, v25, v26
  v_lshlrev_b32 v26, 16, v25
  v_and_b32 v25, 0xffff0000, v25
  v_add_f32 v38, v38, v26
  v_add_f32 v38, v38, v25
  v_lshlrev_b32 v25, 16, v98
  v_and_b32 v26, 0xffff0000, v98
  v_mul_f32 v25, v25, v12
  v_mul_f32 v26, v26, v20
  v_cvt_pk_bf16_f32 v25, v25, v26
  v_lshlrev_b32 v26, 16, v25
  v_and_b32 v25, 0xffff0000, v25
  v_add_f32 v38, v38, v26
  v_add_f32 v38, v38, v25
  s_waitcnt vmcnt(40)
  v_mov_b32 v39, 0
  v_lshlrev_b32 v25, 16, v99
  v_and_b32 v26, 0xffff0000, v99
  v_mul_f32 v25, v25, v8
  v_mul_f32 v26, v26, v16
  v_cvt_pk_bf16_f32 v25, v25, v26
  v_lshlrev_b32 v26, 16, v25
  v_and_b32 v25, 0xffff0000, v25
  v_add_f32 v39, v39, v26
  v_add_f32 v39, v39, v25
  v_lshlrev_b32 v25, 16, v100
  v_and_b32 v26, 0xffff0000, v100
  v_mul_f32 v25, v25, v9
  v_mul_f32 v26, v26, v17
  v_cvt_pk_bf16_f32 v25, v25, v26
  v_lshlrev_b32 v26, 16, v25
  v_and_b32 v25, 0xffff0000, v25
  v_add_f32 v39, v39, v26
  v_add_f32 v39, v39, v25
  v_lshlrev_b32 v25, 16, v101
  v_and_b32 v26, 0xffff0000, v101
  v_mul_f32 v25, v25, v10
  v_mul_f32 v26, v26, v18
  v_cvt_pk_bf16_f32 v25, v25, v26
  v_lshlrev_b32 v26, 16, v25
  v_and_b32 v25, 0xffff0000, v25
  v_add_f32 v39, v39, v26
  v_add_f32 v39, v39, v25
  v_lshlrev_b32 v25, 16, v102
  v_and_b32 v26, 0xffff0000, v102
  v_mul_f32 v25, v25, v11
  v_mul_f32 v26, v26, v19
  v_cvt_pk_bf16_f32 v25, v25, v26
  v_lshlrev_b32 v26, 16, v25
  v_and_b32 v25, 0xffff0000, v25
  v_add_f32 v39, v39, v26
  v_add_f32 v39, v39, v25
  v_lshlrev_b32 v25, 16, v103
  v_and_b32 v26, 0xffff0000, v103
  v_mul_f32 v25, v25, v12
  v_mul_f32 v26, v26, v20
  v_cvt_pk_bf16_f32 v25, v25, v26
  v_lshlrev_b32 v26, 16, v25
  v_and_b32 v25, 0xffff0000, v25
  v_add_f32 v39, v39, v26
  v_add_f32 v39, v39, v25
  s_waitcnt vmcnt(35)
  v_mov_b32 v40, 0
  v_lshlrev_b32 v25, 16, v104
  v_and_b32 v26, 0xffff0000, v104
  v_mul_f32 v25, v25, v8
  v_mul_f32 v26, v26, v16
  v_cvt_pk_bf16_f32 v25, v25, v26
  v_lshlrev_b32 v26, 16, v25
  v_and_b32 v25, 0xffff0000, v25
  v_add_f32 v40, v40, v26
  v_add_f32 v40, v40, v25
  v_lshlrev_b32 v25, 16, v105
  v_and_b32 v26, 0xffff0000, v105
  v_mul_f32 v25, v25, v9
  v_mul_f32 v26, v26, v17
  v_cvt_pk_bf16_f32 v25, v25, v26
  v_lshlrev_b32 v26, 16, v25
  v_and_b32 v25, 0xffff0000, v25
  v_add_f32 v40, v40, v26
  v_add_f32 v40, v40, v25
  v_lshlrev_b32 v25, 16, v106
  v_and_b32 v26, 0xffff0000, v106
  v_mul_f32 v25, v25, v10
  v_mul_f32 v26, v26, v18
  v_cvt_pk_bf16_f32 v25, v25, v26
  v_lshlrev_b32 v26, 16, v25
  v_and_b32 v25, 0xffff0000, v25
  v_add_f32 v40, v40, v26
  v_add_f32 v40, v40, v25
  v_lshlrev_b32 v25, 16, v107
  v_and_b32 v26, 0xffff0000, v107
  v_mul_f32 v25, v25, v11
  v_mul_f32 v26, v26, v19
  v_cvt_pk_bf16_f32 v25, v25, v26
  v_lshlrev_b32 v26, 16, v25
  v_and_b32 v25, 0xffff0000, v25
  v_add_f32 v40, v40, v26
  v_add_f32 v40, v40, v25
  v_lshlrev_b32 v25, 16, v108
  v_and_b32 v26, 0xffff0000, v108
  v_mul_f32 v25, v25, v12
  v_mul_f32 v26, v26, v20
  v_cvt_pk_bf16_f32 v25, v25, v26
  v_lshlrev_b32 v26, 16, v25
  v_and_b32 v25, 0xffff0000, v25
  v_add_f32 v40, v40, v26
  v_add_f32 v40, v40, v25
  s_waitcnt vmcnt(30)
  v_mov_b32 v41, 0
  v_lshlrev_b32 v25, 16, v109
  v_and_b32 v26, 0xffff0000, v109
  v_mul_f32 v25, v25, v8
  v_mul_f32 v26, v26, v16
  v_cvt_pk_bf16_f32 v25, v25, v26
  v_lshlrev_b32 v26, 16, v25
  v_and_b32 v25, 0xffff0000, v25
  v_add_f32 v41, v41, v26
  v_add_f32 v41, v41, v25
  v_lshlrev_b32 v25, 16, v110
  v_and_b32 v26, 0xffff0000, v110
  v_mul_f32 v25, v25, v9
  v_mul_f32 v26, v26, v17
  v_cvt_pk_bf16_f32 v25, v25, v26
  v_lshlrev_b32 v26, 16, v25
  v_and_b32 v25, 0xffff0000, v25
  v_add_f32 v41, v41, v26
  v_add_f32 v41, v41, v25
  v_lshlrev_b32 v25, 16, v111
  v_and_b32 v26, 0xffff0000, v111
  v_mul_f32 v25, v25, v10
  v_mul_f32 v26, v26, v18
  v_cvt_pk_bf16_f32 v25, v25, v26
  v_lshlrev_b32 v26, 16, v25
  v_and_b32 v25, 0xffff0000, v25
  v_add_f32 v41, v41, v26
  v_add_f32 v41, v41, v25
  v_lshlrev_b32 v25, 16, v112
  v_and_b32 v26, 0xffff0000, v112
  v_mul_f32 v25, v25, v11
  v_mul_f32 v26, v26, v19
  v_cvt_pk_bf16_f32 v25, v25, v26
  v_lshlrev_b32 v26, 16, v25
  v_and_b32 v25, 0xffff0000, v25
  v_add_f32 v41, v41, v26
  v_add_f32 v41, v41, v25
  v_lshlrev_b32 v25, 16, v113
  v_and_b32 v26, 0xffff0000, v113
  v_mul_f32 v25, v25, v12
  v_mul_f32 v26, v26, v20
  v_cvt_pk_bf16_f32 v25, v25, v26
  v_lshlrev_b32 v26, 16, v25
  v_and_b32 v25, 0xffff0000, v25
  v_add_f32 v41, v41, v26
  v_add_f32 v41, v41, v25
  s_waitcnt vmcnt(25)
  v_mov_b32 v42, 0
  v_lshlrev_b32 v25, 16, v114
  v_and_b32 v26, 0xffff0000, v114
  v_mul_f32 v25, v25, v8
  v_mul_f32 v26, v26, v16
  v_cvt_pk_bf16_f32 v25, v25, v26
  v_lshlrev_b32 v26, 16, v25
  v_and_b32 v25, 0xffff0000, v25
  v_add_f32 v42, v42, v26
  v_add_f32 v42, v42, v25
  v_lshlrev_b32 v25, 16, v115
  v_and_b32 v26, 0xffff0000, v115
  v_mul_f32 v25, v25, v9
  v_mul_f32 v26, v26, v17
  v_cvt_pk_bf16_f32 v25, v25, v26
  v_lshlrev_b32 v26, 16, v25
  v_and_b32 v25, 0xffff0000, v25
  v_add_f32 v42, v42, v26
  v_add_f32 v42, v42, v25
  v_lshlrev_b32 v25, 16, v116
  v_and_b32 v26, 0xffff0000, v116
  v_mul_f32 v25, v25, v10
  v_mul_f32 v26, v26, v18
  v_cvt_pk_bf16_f32 v25, v25, v26
  v_lshlrev_b32 v26, 16, v25
  v_and_b32 v25, 0xffff0000, v25
  v_add_f32 v42, v42, v26
  v_add_f32 v42, v42, v25
  v_lshlrev_b32 v25, 16, v117
  v_and_b32 v26, 0xffff0000, v117
  v_mul_f32 v25, v25, v11
  v_mul_f32 v26, v26, v19
  v_cvt_pk_bf16_f32 v25, v25, v26
  v_lshlrev_b32 v26, 16, v25
  v_and_b32 v25, 0xffff0000, v25
  v_add_f32 v42, v42, v26
  v_add_f32 v42, v42, v25
  v_lshlrev_b32 v25, 16, v118
  v_and_b32 v26, 0xffff0000, v118
  v_mul_f32 v25, v25, v12
  v_mul_f32 v26, v26, v20
  v_cvt_pk_bf16_f32 v25, v25, v26
  v_lshlrev_b32 v26, 16, v25
  v_and_b32 v25, 0xffff0000, v25
  v_add_f32 v42, v42, v26
  v_add_f32 v42, v42, v25
  s_waitcnt vmcnt(20)
  v_mov_b32 v43, 0
  v_lshlrev_b32 v25, 16, v119
  v_and_b32 v26, 0xffff0000, v119
  v_mul_f32 v25, v25, v8
  v_mul_f32 v26, v26, v16
  v_cvt_pk_bf16_f32 v25, v25, v26
  v_lshlrev_b32 v26, 16, v25
  v_and_b32 v25, 0xffff0000, v25
  v_add_f32 v43, v43, v26
  v_add_f32 v43, v43, v25
  v_lshlrev_b32 v25, 16, v120
  v_and_b32 v26, 0xffff0000, v120
  v_mul_f32 v25, v25, v9
  v_mul_f32 v26, v26, v17
  v_cvt_pk_bf16_f32 v25, v25, v26
  v_lshlrev_b32 v26, 16, v25
  v_and_b32 v25, 0xffff0000, v25
  v_add_f32 v43, v43, v26
  v_add_f32 v43, v43, v25
  v_lshlrev_b32 v25, 16, v121
  v_and_b32 v26, 0xffff0000, v121
  v_mul_f32 v25, v25, v10
  v_mul_f32 v26, v26, v18
  v_cvt_pk_bf16_f32 v25, v25, v26
  v_lshlrev_b32 v26, 16, v25
  v_and_b32 v25, 0xffff0000, v25
  v_add_f32 v43, v43, v26
  v_add_f32 v43, v43, v25
  v_lshlrev_b32 v25, 16, v122
  v_and_b32 v26, 0xffff0000, v122
  v_mul_f32 v25, v25, v11
  v_mul_f32 v26, v26, v19
  v_cvt_pk_bf16_f32 v25, v25, v26
  v_lshlrev_b32 v26, 16, v25
  v_and_b32 v25, 0xffff0000, v25
  v_add_f32 v43, v43, v26
  v_add_f32 v43, v43, v25
  v_lshlrev_b32 v25, 16, v123
  v_and_b32 v26, 0xffff0000, v123
  v_mul_f32 v25, v25, v12
  v_mul_f32 v26, v26, v20
  v_cvt_pk_bf16_f32 v25, v25, v26
  v_lshlrev_b32 v26, 16, v25
  v_and_b32 v25, 0xffff0000, v25
  v_add_f32 v43, v43, v26
  v_add_f32 v43, v43, v25
  s_waitcnt vmcnt(15)
  v_mov_b32 v44, 0
  v_lshlrev_b32 v25, 16, v124
  v_and_b32 v26, 0xffff0000, v124
  v_mul_f32 v25, v25, v8
  v_mul_f32 v26, v26, v16
  v_cvt_pk_bf16_f32 v25, v25, v26
  v_lshlrev_b32 v26, 16, v25
  v_and_b32 v25, 0xffff0000, v25
  v_add_f32 v44, v44, v26
  v_add_f32 v44, v44, v25
  v_lshlrev_b32 v25, 16, v125
  v_and_b32 v26, 0xffff0000, v125
  v_mul_f32 v25, v25, v9
  v_mul_f32 v26, v26, v17
  v_cvt_pk_bf16_f32 v25, v25, v26
  v_lshlrev_b32 v26, 16, v25
  v_and_b32 v25, 0xffff0000, v25
  v_add_f32 v44, v44, v26
  v_add_f32 v44, v44, v25
  v_lshlrev_b32 v25, 16, v126
  v_and_b32 v26, 0xffff0000, v126
  v_mul_f32 v25, v25, v10
  v_mul_f32 v26, v26, v18
  v_cvt_pk_bf16_f32 v25, v25, v26
  v_lshlrev_b32 v26, 16, v25
  v_and_b32 v25, 0xffff0000, v25
  v_add_f32 v44, v44, v26
  v_add_f32 v44, v44, v25
  v_lshlrev_b32 v25, 16, v127
  v_and_b32 v26, 0xffff0000, v127
  v_mul_f32 v25, v25, v11
  v_mul_f32 v26, v26, v19
  v_cvt_pk_bf16_f32 v25, v25, v26
  v_lshlrev_b32 v26, 16, v25
  v_and_b32 v25, 0xffff0000, v25
  v_add_f32 v44, v44, v26
  v_add_f32 v44, v44, v25
  v_lshlrev_b32 v25, 16, v128
  v_and_b32 v26, 0xffff0000, v128
  v_mul_f32 v25, v25, v12
  v_mul_f32 v26, v26, v20
  v_cvt_pk_bf16_f32 v25, v25, v26
  v_lshlrev_b32 v26, 16, v25
  v_and_b32 v25, 0xffff0000, v25
  v_add_f32 v44, v44, v26
  v_add_f32 v44, v44, v25
  s_waitcnt vmcnt(10)
  v_mov_b32 v45, 0
  v_lshlrev_b32 v25, 16, v129
  v_and_b32 v26, 0xffff0000, v129
  v_mul_f32 v25, v25, v8
  v_mul_f32 v26, v26, v16
  v_cvt_pk_bf16_f32 v25, v25, v26
  v_lshlrev_b32 v26, 16, v25
  v_and_b32 v25, 0xffff0000, v25
  v_add_f32 v45, v45, v26
  v_add_f32 v45, v45, v25
  v_lshlrev_b32 v25, 16, v130
  v_and_b32 v26, 0xffff0000, v130
  v_mul_f32 v25, v25, v9
  v_mul_f32 v26, v26, v17
  v_cvt_pk_bf16_f32 v25, v25, v26
  v_lshlrev_b32 v26, 16, v25
  v_and_b32 v25, 0xffff0000, v25
  v_add_f32 v45, v45, v26
  v_add_f32 v45, v45, v25
  v_lshlrev_b32 v25, 16, v131
  v_and_b32 v26, 0xffff0000, v131
  v_mul_f32 v25, v25, v10
  v_mul_f32 v26, v26, v18
  v_cvt_pk_bf16_f32 v25, v25, v26
  v_lshlrev_b32 v26, 16, v25
  v_and_b32 v25, 0xffff0000, v25
  v_add_f32 v45, v45, v26
  v_add_f32 v45, v45, v25
  v_lshlrev_b32 v25, 16, v132
  v_and_b32 v26, 0xffff0000, v132
  v_mul_f32 v25, v25, v11
  v_mul_f32 v26, v26, v19
  v_cvt_pk_bf16_f32 v25, v25, v26
  v_lshlrev_b32 v26, 16, v25
  v_and_b32 v25, 0xffff0000, v25
  v_add_f32 v45, v45, v26
  v_add_f32 v45, v45, v25
  v_lshlrev_b32 v25, 16, v133
  v_and_b32 v26, 0xffff0000, v133
  v_mul_f32 v25, v25, v12
  v_mul_f32 v26, v26, v20
  v_cvt_pk_bf16_f32 v25, v25, v26
  v_lshlrev_b32 v26, 16, v25
  v_and_b32 v25, 0xffff0000, v25
  v_add_f32 v45, v45, v26
  v_add_f32 v45, v45, v25
  s_waitcnt vmcnt(5)
  v_mov_b32 v46, 0
  v_lshlrev_b32 v25, 16, v134
  v_and_b32 v26, 0xffff0000, v134
  v_mul_f32 v25, v25, v8
  v_mul_f32 v26, v26, v16
  v_cvt_pk_bf16_f32 v25, v25, v26
  v_lshlrev_b32 v26, 16, v25
  v_and_b32 v25, 0xffff0000, v25
  v_add_f32 v46, v46, v26
  v_add_f32 v46, v46, v25
  v_lshlrev_b32 v25, 16, v135
  v_and_b32 v26, 0xffff0000, v135
  v_mul_f32 v25, v25, v9
  v_mul_f32 v26, v26, v17
  v_cvt_pk_bf16_f32 v25, v25, v26
  v_lshlrev_b32 v26, 16, v25
  v_and_b32 v25, 0xffff0000, v25
  v_add_f32 v46, v46, v26
  v_add_f32 v46, v46, v25
  v_lshlrev_b32 v25, 16, v136
  v_and_b32 v26, 0xffff0000, v136
  v_mul_f32 v25, v25, v10
  v_mul_f32 v26, v26, v18
  v_cvt_pk_bf16_f32 v25, v25, v26
  v_lshlrev_b32 v26, 16, v25
  v_and_b32 v25, 0xffff0000, v25
  v_add_f32 v46, v46, v26
  v_add_f32 v46, v46, v25
  v_lshlrev_b32 v25, 16, v137
  v_and_b32 v26, 0xffff0000, v137
  v_mul_f32 v25, v25, v11
  v_mul_f32 v26, v26, v19
  v_cvt_pk_bf16_f32 v25, v25, v26
  v_lshlrev_b32 v26, 16, v25
  v_and_b32 v25, 0xffff0000, v25
  v_add_f32 v46, v46, v26
  v_add_f32 v46, v46, v25
  v_lshlrev_b32 v25, 16, v138
  v_and_b32 v26, 0xffff0000, v138
  v_mul_f32 v25, v25, v12
  v_mul_f32 v26, v26, v20
  v_cvt_pk_bf16_f32 v25, v25, v26
  v_lshlrev_b32 v26, 16, v25
  v_and_b32 v25, 0xffff0000, v25
  v_add_f32 v46, v46, v26
  v_add_f32 v46, v46, v25
  s_waitcnt vmcnt(0)
  v_mov_b32 v47, 0
  v_lshlrev_b32 v25, 16, v139
  v_and_b32 v26, 0xffff0000, v139
  v_mul_f32 v25, v25, v8
  v_mul_f32 v26, v26, v16
  v_cvt_pk_bf16_f32 v25, v25, v26
  v_lshlrev_b32 v26, 16, v25
  v_and_b32 v25, 0xffff0000, v25
  v_add_f32 v47, v47, v26
  v_add_f32 v47, v47, v25
  v_lshlrev_b32 v25, 16, v140
  v_and_b32 v26, 0xffff0000, v140
  v_mul_f32 v25, v25, v9
  v_mul_f32 v26, v26, v17
  v_cvt_pk_bf16_f32 v25, v25, v26
  v_lshlrev_b32 v26, 16, v25
  v_and_b32 v25, 0xffff0000, v25
  v_add_f32 v47, v47, v26
  v_add_f32 v47, v47, v25
  v_lshlrev_b32 v25, 16, v141
  v_and_b32 v26, 0xffff0000, v141
  v_mul_f32 v25, v25, v10
  v_mul_f32 v26, v26, v18
  v_cvt_pk_bf16_f32 v25, v25, v26
  v_lshlrev_b32 v26, 16, v25
  v_and_b32 v25, 0xffff0000, v25
  v_add_f32 v47, v47, v26
  v_add_f32 v47, v47, v25
  v_lshlrev_b32 v25, 16, v142
  v_and_b32 v26, 0xffff0000, v142
  v_mul_f32 v25, v25, v11
  v_mul_f32 v26, v26, v19
  v_cvt_pk_bf16_f32 v25, v25, v26
  v_lshlrev_b32 v26, 16, v25
  v_and_b32 v25, 0xffff0000, v25
  v_add_f32 v47, v47, v26
  v_add_f32 v47, v47, v25
  v_lshlrev_b32 v25, 16, v143
  v_and_b32 v26, 0xffff0000, v143
  v_mul_f32 v25, v25, v12
  v_mul_f32 v26, v26, v20
  v_cvt_pk_bf16_f32 v25, v25, v26
  v_lshlrev_b32 v26, 16, v25
  v_and_b32 v25, 0xffff0000, v25
  v_add_f32 v47, v47, v26
  v_add_f32 v47, v47, v25
  v_add_f32_dpp v32, v32, v32 row_ror:8 row_mask:0xf bank_mask:0xf
  v_add_f32_dpp v33, v33, v33 row_ror:8 row_mask:0xf bank_mask:0xf
  v_add_f32_dpp v34, v34, v34 row_ror:8 row_mask:0xf bank_mask:0xf
  v_add_f32_dpp v35, v35, v35 row_ror:8 row_mask:0xf bank_mask:0xf
  v_add_f32_dpp v36, v36, v36 row_ror:8 row_mask:0xf bank_mask:0xf
  v_add_f32_dpp v37, v37, v37 row_ror:8 row_mask:0xf bank_mask:0xf
  v_add_f32_dpp v38, v38, v38 row_ror:8 row_mask:0xf bank_mask:0xf
  v_add_f32_dpp v39, v39, v39 row_ror:8 row_mask:0xf bank_mask:0xf
  v_add_f32_dpp v40, v40, v40 row_ror:8 row_mask:0xf bank_mask:0xf
  v_add_f32_dpp v41, v41, v41 row_ror:8 row_mask:0xf bank_mask:0xf
  v_add_f32_dpp v42, v42, v42 row_ror:8 row_mask:0xf bank_mask:0xf
  v_add_f32_dpp v43, v43, v43 row_ror:8 row_mask:0xf bank_mask:0xf
  v_add_f32_dpp v44, v44, v44 row_ror:8 row_mask:0xf bank_mask:0xf
  v_add_f32_dpp v45, v45, v45 row_ror:8 row_mask:0xf bank_mask:0xf
  v_add_f32_dpp v46, v46, v46 row_ror:8 row_mask:0xf bank_mask:0xf
  v_add_f32_dpp v47, v47, v47 row_ror:8 row_mask:0xf bank_mask:0xf
  v_add_f32_dpp v32, v32, v32 row_ror:4 row_mask:0xf bank_mask:0xf
  v_add_f32_dpp v33, v33, v33 row_ror:4 row_mask:0xf bank_mask:0xf
  v_add_f32_dpp v34, v34, v34 row_ror:4 row_mask:0xf bank_mask:0xf
  v_add_f32_dpp v35, v35, v35 row_ror:4 row_mask:0xf bank_mask:0xf
  v_add_f32_dpp v36, v36, v36 row_ror:4 row_mask:0xf bank_mask:0xf
  v_add_f32_dpp v37, v37, v37 row_ror:4 row_mask:0xf bank_mask:0xf
  v_add_f32_dpp v38, v38, v38 row_ror:4 row_mask:0xf bank_mask:0xf
  v_add_f32_dpp v39, v39, v39 row_ror:4 row_mask:0xf bank_mask:0xf
  v_add_f32_dpp v40, v40, v40 row_ror:4 row_mask:0xf bank_mask:0xf
  v_add_f32_dpp v41, v41, v41 row_ror:4 row_mask:0xf bank_mask:0xf
  v_add_f32_dpp v42, v42, v42 row_ror:4 row_mask:0xf bank_mask:0xf
  v_add_f32_dpp v43, v43, v43 row_ror:4 row_mask:0xf bank_mask:0xf
  v_add_f32_dpp v44, v44, v44 row_ror:4 row_mask:0xf bank_mask:0xf
  v_add_f32_dpp v45, v45, v45 row_ror:4 row_mask:0xf bank_mask:0xf
  v_add_f32_dpp v46, v46, v46 row_ror:4 row_mask:0xf bank_mask:0xf
  v_add_f32_dpp v47, v47, v47 row_ror:4 row_mask:0xf bank_mask:0xf
  v_add_f32_dpp v32, v32, v32 row_ror:2 row_mask:0xf bank_mask:0xf
  v_add_f32_dpp v33, v33, v33 row_ror:2 row_mask:0xf bank_mask:0xf
  v_add_f32_dpp v34, v34, v34 row_ror:2 row_mask:0xf bank_mask:0xf
  v_add_f32_dpp v35, v35, v35 row_ror:2 row_mask:0xf bank_mask:0xf
  v_add_f32_dpp v36, v36, v36 row_ror:2 row_mask:0xf bank_mask:0xf
  v_add_f32_dpp v37, v37, v37 row_ror:2 row_mask:0xf bank_mask:0xf
  v_add_f32_dpp v38, v38, v38 row_ror:2 row_mask:0xf bank_mask:0xf
  v_add_f32_dpp v39, v39, v39 row_ror:2 row_mask:0xf bank_mask:0xf
  v_add_f32_dpp v40, v40, v40 row_ror:2 row_mask:0xf bank_mask:0xf
  v_add_f32_dpp v41, v41, v41 row_ror:2 row_mask:0xf bank_mask:0xf
  v_add_f32_dpp v42, v42, v42 row_ror:2 row_mask:0xf bank_mask:0xf
  v_add_f32_dpp v43, v43, v43 row_ror:2 row_mask:0xf bank_mask:0xf
  v_add_f32_dpp v44, v44, v44 row_ror:2 row_mask:0xf bank_mask:0xf
  v_add_f32_dpp v45, v45, v45 row_ror:2 row_mask:0xf bank_mask:0xf
  v_add_f32_dpp v46, v46, v46 row_ror:2 row_mask:0xf bank_mask:0xf
  v_add_f32_dpp v47, v47, v47 row_ror:2 row_mask:0xf bank_mask:0xf
  v_add_f32_dpp v32, v32, v32 row_ror:1 row_mask:0xf bank_mask:0xf
  v_add_f32_dpp v33, v33, v33 row_ror:1 row_mask:0xf bank_mask:0xf
  v_add_f32_dpp v34, v34, v34 row_ror:1 row_mask:0xf bank_mask:0xf
  v_add_f32_dpp v35, v35, v35 row_ror:1 row_mask:0xf bank_mask:0xf
  v_add_f32_dpp v36, v36, v36 row_ror:1 row_mask:0xf bank_mask:0xf
  v_add_f32_dpp v37, v37, v37 row_ror:1 row_mask:0xf bank_mask:0xf
  v_add_f32_dpp v38, v38, v38 row_ror:1 row_mask:0xf bank_mask:0xf
  v_add_f32_dpp v39, v39, v39 row_ror:1 row_mask:0xf bank_mask:0xf
  v_add_f32_dpp v40, v40, v40 row_ror:1 row_mask:0xf bank_mask:0xf
  v_add_f32_dpp v41, v41, v41 row_ror:1 row_mask:0xf bank_mask:0xf
  v_add_f32_dpp v42, v42, v42 row_ror:1 row_mask:0xf bank_mask:0xf
  v_add_f32_dpp v43, v43, v43 row_ror:1 row_mask:0xf bank_mask:0xf
  v_add_f32_dpp v44, v44, v44 row_ror:1 row_mask:0xf bank_mask:0xf
  v_add_f32_dpp v45, v45, v45 row_ror:1 row_mask:0xf bank_mask:0xf
  v_add_f32_dpp v46, v46, v46 row_ror:1 row_mask:0xf bank_mask:0xf
  v_add_f32_dpp v47, v47, v47 row_ror:1 row_mask:0xf bank_mask:0xf
  v_mov_b32 v24, v32
  v_cmp_eq_u32 vcc, 1, v2
  s_nop 1
  v_cndmask_b32 v24, v24, v33, vcc
  v_cmp_eq_u32 vcc, 2, v2
  s_nop 1
  v_cndmask_b32 v24, v24, v34, vcc
  v_cmp_eq_u32 vcc, 3, v2
  s_nop 1
  v_cndmask_b32 v24, v24, v35, vcc
  v_cmp_eq_u32 vcc, 4, v2
  s_nop 1
  v_cndmask_b32 v24, v24, v36, vcc
  v_cmp_eq_u32 vcc, 5, v2
  s_nop 1
  v_cndmask_b32 v24, v24, v37, vcc
  v_cmp_eq_u32 vcc, 6, v2
  s_nop 1
  v_cndmask_b32 v24, v24, v38, vcc
  v_cmp_eq_u32 vcc, 7, v2
  s_nop 1
  v_cndmask_b32 v24, v24, v39, vcc
  v_cmp_eq_u32 vcc, 8, v2
  s_nop 1
  v_cndmask_b32 v24, v24, v40, vcc
  v_cmp_eq_u32 vcc, 9, v2
  s_nop 1
  v_cndmask_b32 v24, v24, v41, vcc
  v_cmp_eq_u32 vcc, 10, v2
  s_nop 1
  v_cndmask_b32 v24, v24, v42, vcc
  v_cmp_eq_u32 vcc, 11, v2
  s_nop 1
  v_cndmask_b32 v24, v24, v43, vcc
  v_cmp_eq_u32 vcc, 12, v2
  s_nop 1
  v_cndmask_b32 v24, v24, v44, vcc
  v_cmp_eq_u32 vcc, 13, v2
  s_nop 1
  v_cndmask_b32 v24, v24, v45, vcc
  v_cmp_eq_u32 vcc, 14, v2
  s_nop 1
  v_cndmask_b32 v24, v24, v46, vcc
  v_cmp_eq_u32 vcc, 15, v2
  s_nop 1
  v_cndmask_b32 v24, v24, v47, vcc
  v_mov_b32 v25, v24
  s_nop 1
  v_permlane32_swap_b32 v24, v25
  v_add_f32 v24, v24, v25
  v_mov_b32 v25, v24
  s_nop 1
  v_permlane16_swap_b32 v24, v25
  v_add_f32 v24, v24, v25
  v_cvt_pk_bf16_f32 v25, v24, v24
  v_lshlrev_b32 v24, 16, v25
  v_mul_f32 v24, 0xbfb8aa3b, v24
  v_exp_f32 v24, v24
  s_nop 0
  v_add_f32 v24, 1.0, v24
  v_rcp_f32 v24, v24
  s_nop 0
  v_cvt_pk_bf16_f32 v25, v24, v24
  v_lshlrev_b32 v24, 16, v25
  s_lshl_b32 s21, s59, 2
  s_mov_b64 exec, 0xffff
  buffer_store_dword v24, v4, s[76:79], s21 offen sc1
  s_mov_b64 exec, -1
  s_sleep 127
  v_lshrrev_b32 v8, 5, v1
  v_or_b32 v9, 0, v8
  v_and_b32 v10, 31, v1
  v_lshlrev_b32 v9, 1, v9
  v_xor_b32 v10, v10, v9
  v_mul_u32_u24 v9, 6554, v10
  v_lshrrev_b32 v9, 16, v9
  v_mul_u32_u24 v11, 1120, v9
  v_lshl_add_u32 v11, v10, 4, v11
  v_mul_u32_u24 v8, 3840, v8
  v_add_u32 v11, v11, v8
  v_mov_b32 v9, 1073741824
  v_cmp_gt_u32 vcc, 30, v10
  s_nop 1
  v_cndmask_b32 v4, v9, v11, vcc
  v_lshrrev_b32 v8, 5, v1
  v_or_b32 v9, 2, v8
  v_and_b32 v10, 31, v1
  v_lshlrev_b32 v9, 1, v9
  v_xor_b32 v10, v10, v9
  v_mul_u32_u24 v9, 6554, v10
  v_lshrrev_b32 v9, 16, v9
  v_mul_u32_u24 v11, 1120, v9
  v_lshl_add_u32 v11, v10, 4, v11
  v_mul_u32_u24 v8, 3840, v8
  v_add_u32 v11, v11, v8
  v_mov_b32 v9, 1073741824
  v_cmp_gt_u32 vcc, 30, v10
  s_nop 1
  v_cndmask_b32 v5, v9, v11, vcc
  v_lshrrev_b32 v8, 5, v1
  v_or_b32 v9, 4, v8
  v_and_b32 v10, 31, v1
  v_lshlrev_b32 v9, 1, v9
  v_xor_b32 v10, v10, v9
  v_mul_u32_u24 v9, 6554, v10
  v_lshrrev_b32 v9, 16, v9
  v_mul_u32_u24 v11, 1120, v9
  v_lshl_add_u32 v11, v10, 4, v11
  v_mul_u32_u24 v8, 3840, v8
  v_add_u32 v11, v11, v8
  v_mov_b32 v9, 1073741824
  v_cmp_gt_u32 vcc, 30, v10
  s_nop 1
  v_cndmask_b32 v6, v9, v11, vcc
  v_lshrrev_b32 v8, 5, v1
  v_or_b32 v9, 6, v8
  v_and_b32 v10, 31, v1
  v_lshlrev_b32 v9, 1, v9
  v_xor_b32 v10, v10, v9
  v_mul_u32_u24 v9, 6554, v10
  v_lshrrev_b32 v9, 16, v9
  v_mul_u32_u24 v11, 1120, v9
  v_lshl_add_u32 v11, v10, 4, v11
  v_mul_u32_u24 v8, 3840, v8
  v_add_u32 v11, v11, v8
  v_mov_b32 v9, 1073741824
  v_cmp_gt_u32 vcc, 30, v10
  s_nop 1
  v_cndmask_b32 v7, v9, v11, vcc
  s_mul_i32 s44, s41, 160
  s_mul_i32 s21, s20, 122880
  s_add_u32 s44, s44, s21
  s_lshl_b32 s45, s20, 14
  s_add_u32 s21, s44, 0
  s_add_u32 m0, s45, 0
  s_nop 0
  buffer_load_dwordx4 v4, s[12:15], s21 offen lds
  s_add_u32 s21, s44, 7680
  s_add_u32 m0, s45, 1024
  s_nop 0
  buffer_load_dwordx4 v5, s[12:15], s21 offen lds
  s_add_u32 s21, s44, 15360
  s_add_u32 m0, s45, 2048
  s_nop 0
  buffer_load_dwordx4 v4, s[12:15], s21 offen lds
  s_add_u32 s21, s44, 23040
  s_add_u32 m0, s45, 3072
  s_nop 0
  buffer_load_dwordx4 v5, s[12:15], s21 offen lds
  s_add_u32 s21, s44, 30720
  s_add_u32 m0, s45, 4096
  s_nop 0
  buffer_load_dwordx4 v6, s[12:15], s21 offen lds
  s_add_u32 s21, s44, 38400
  s_add_u32 m0, s45, 5120
  s_nop 0
  buffer_load_dwordx4 v7, s[12:15], s21 offen lds
  s_add_u32 s21, s44, 46080
  s_add_u32 m0, s45, 6144
  s_nop 0
  buffer_load_dwordx4 v6, s[12:15], s21 offen lds
  s_add_u32 s21, s44, 53760
  s_add_u32 m0, s45, 7168
  s_nop 0
  buffer_load_dwordx4 v7, s[12:15], s21 offen lds
  s_add_u32 s21, s44, 61440
  s_add_u32 m0, s45, 8192
  s_nop 0
  buffer_load_dwordx4 v4, s[12:15], s21 offen lds
  s_add_u32 s21, s44, 69120
  s_add_u32 m0, s45, 9216
  s_nop 0
  buffer_load_dwordx4 v5, s[12:15], s21 offen lds
  s_add_u32 s21, s44, 76800
  s_add_u32 m0, s45, 10240
  s_nop 0
  buffer_load_dwordx4 v4, s[12:15], s21 offen lds
  s_add_u32 s21, s44, 84480
  s_add_u32 m0, s45, 11264
  s_nop 0
  buffer_load_dwordx4 v5, s[12:15], s21 offen lds
  s_add_u32 s21, s44, 92160
  s_add_u32 m0, s45, 12288
  s_nop 0
  buffer_load_dwordx4 v6, s[12:15], s21 offen lds
  s_add_u32 s21, s44, 99840
  s_add_u32 m0, s45, 13312
  s_nop 0
  buffer_load_dwordx4 v7, s[12:15], s21 offen lds
  s_add_u32 s21, s44, 107520
  s_add_u32 m0, s45, 14336
  s_nop 0
  buffer_load_dwordx4 v6, s[12:15], s21 offen lds
  s_add_u32 s21, s44, 115200
  s_add_u32 m0, s45, 15360
  s_nop 0
  buffer_load_dwordx4 v7, s[12:15], s21 offen lds
  s_add_u32 s21, s44, 491520
  s_add_u32 m0, s45, 65536
  s_nop 0
  buffer_load_dwordx4 v4, s[12:15], s21 offen lds
  s_add_u32 s21, s44, 499200
  s_add_u32 m0, s45, 66560
  s_nop 0
  buffer_load_dwordx4 v5, s[12:15], s21 offen lds
  s_add_u32 s21, s44, 506880
  s_add_u32 m0, s45, 67584
  s_nop 0
  buffer_load_dwordx4 v4, s[12:15], s21 offen lds
  s_add_u32 s21, s44, 514560
  s_add_u32 m0, s45, 68608
  s_nop 0
  buffer_load_dwordx4 v5, s[12:15], s21 offen lds
  s_add_u32 s21, s44, 522240
  s_add_u32 m0, s45, 69632
  s_nop 0
  buffer_load_dwordx4 v6, s[12:15], s21 offen lds
  s_add_u32 s21, s44, 529920
  s_add_u32 m0, s45, 70656
  s_nop 0
  buffer_load_dwordx4 v7, s[12:15], s21 offen lds
  s_add_u32 s21, s44, 537600
  s_add_u32 m0, s45, 71680
  s_nop 0
  buffer_load_dwordx4 v6, s[12:15], s21 offen lds
  s_add_u32 s21, s44, 545280
  s_add_u32 m0, s45, 72704
  s_nop 0
  buffer_load_dwordx4 v7, s[12:15], s21 offen lds
  s_add_u32 s21, s44, 552960
  s_add_u32 m0, s45, 73728
  s_nop 0
  buffer_load_dwordx4 v4, s[12:15], s21 offen lds
  s_add_u32 s21, s44, 560640
  s_add_u32 m0, s45, 74752
  s_nop 0
  buffer_load_dwordx4 v5, s[12:15], s21 offen lds
  s_add_u32 s21, s44, 568320
  s_add_u32 m0, s45, 75776
  s_nop 0
  buffer_load_dwordx4 v4, s[12:15], s21 offen lds
  s_add_u32 s21, s44, 576000
  s_add_u32 m0, s45, 76800
  s_nop 0
  buffer_load_dwordx4 v5, s[12:15], s21 offen lds
  s_add_u32 s21, s44, 583680
  s_add_u32 m0, s45, 77824
  s_nop 0
  buffer_load_dwordx4 v6, s[12:15], s21 offen lds
  s_add_u32 s21, s44, 591360
  s_add_u32 m0, s45, 78848
  s_nop 0
  buffer_load_dwordx4 v7, s[12:15], s21 offen lds
  s_add_u32 s21, s44, 599040
  s_add_u32 m0, s45, 79872
  s_nop 0
  buffer_load_dwordx4 v6, s[12:15], s21 offen lds
  s_add_u32 s21, s44, 606720
  s_add_u32 m0, s45, 80896
  s_nop 0
  buffer_load_dwordx4 v7, s[12:15], s21 offen lds
  s_add_u32 s21, s44, 983040
  buffer_load_dwordx4 v[64:67], v4, s[12:15], s21 offen
  s_add_u32 s21, s44, 990720
  buffer_load_dwordx4 v[68:71], v5, s[12:15], s21 offen
  s_add_u32 s21, s44, 998400
  buffer_load_dwordx4 v[72:75], v4, s[12:15], s21 offen
  s_add_u32 s21, s44, 1006080
  buffer_load_dwordx4 v[76:79], v5, s[12:15], s21 offen
  s_add_u32 s21, s44, 1013760
  buffer_load_dwordx4 v[80:83], v6, s[12:15], s21 offen
  s_add_u32 s21, s44, 1021440
  buffer_load_dwordx4 v[84:87], v7, s[12:15], s21 offen
  s_add_u32 s21, s44, 1029120
  buffer_load_dwordx4 v[88:91], v6, s[12:15], s21 offen
  s_add_u32 s21, s44, 1036800
  buffer_load_dwordx4 v[92:95], v7, s[12:15], s21 offen
  s_add_u32 s21, s44, 1044480
  buffer_load_dwordx4 v[96:99], v4, s[12:15], s21 offen
  s_add_u32 s21, s44, 1052160
  buffer_load_dwordx4 v[100:103], v5, s[12:15], s21 offen
  s_add_u32 s21, s44, 1059840
  buffer_load_dwordx4 v[104:107], v4, s[12:15], s21 offen
  s_add_u32 s21, s44, 1067520
  buffer_load_dwordx4 v[108:111], v5, s[12:15], s21 offen
  s_add_u32 s21, s44, 1075200
  buffer_load_dwordx4 v[112:115], v6, s[12:15], s21 offen
  s_add_u32 s21, s44, 1082880
  buffer_load_dwordx4 v[116:119], v7, s[12:15], s21 offen
  s_add_u32 s21, s44, 1090560
  buffer_load_dwordx4 v[120:123], v6, s[12:15], s21 offen
  s_add_u32 s21, s44, 1098240
  buffer_load_dwordx4 v[124:127], v7, s[12:15], s21 offen
  v_lshrrev_b32 v8, 2, v2
  v_and_b32 v9, 1, v3
  v_lshl_add_u32 v9, v9, 2, v8
  v_lshlrev_b32 v9, 5, v9
  v_lshl_add_u32 v8, v3, 3, v8
  v_lshlrev_b32 v8, 9, v8
  v_and_b32 v10, 3, v2
  s_mul_i32 s21, s20, 40
  v_lshl_add_u32 v11, v10, 3, s21
  v_add_u32 v11, 0, v11
  v_xor_b32 v11, v11, v9
  v_add_u32 v12, v11, v8
  v_add_u32 v16, 65536, v12
  v_lshl_add_u32 v11, v10, 3, s21
  v_add_u32 v11, 160, v11
  v_xor_b32 v11, v11, v9
  v_add_u32 v13, v11, v8
  v_add_u32 v17, 65536, v13
  v_mul_u32_u24 v11, 160, v10
  v_add3_u32 v11, v11, 32, s21
  v_min_u32 v11, 480, v11
  v_xor_b32 v11, v11, v9
  v_add_u32 v14, v11, v8
  v_add_u32 v18, 65536, v14
  v_lshl_add_u32 v11, v10, 3, s21
  v_add_u32 v11, 320, v11
  v_xor_b32 v11, v11, v9
  v_add_u32 v15, v11, v8
  v_add_u32 v19, 65536, v15
  v_lshl_add_u32 v23, v1, 4, s45
  v_add_u32 v29, 65536, v23
  s_waitcnt vmcnt(32)
  s_add_u32 s21, s44, 1474560
  buffer_load_dwordx4 v[128:131], v4, s[12:15], s21 offen
  s_add_u32 s21, s44, 1482240
  buffer_load_dwordx4 v[132:135], v5, s[12:15], s21 offen
  s_add_u32 s21, s44, 1489920
  buffer_load_dwordx4 v[136:139], v4, s[12:15], s21 offen
  s_add_u32 s21, s44, 1497600
  buffer_load_dwordx4 v[140:143], v5, s[12:15], s21 offen
  s_add_u32 s21, s44, 1505280
  buffer_load_dwordx4 v[144:147], v6, s[12:15], s21 offen
  s_add_u32 s21, s44, 1512960
  buffer_load_dwordx4 v[148:151], v7, s[12:15], s21 offen
  s_add_u32 s21, s44, 1520640
  buffer_load_dwordx4 v[152:155], v6, s[12:15], s21 offen
  s_add_u32 s21, s44, 1528320
  buffer_load_dwordx4 v[156:159], v7, s[12:15], s21 offen
  s_add_u32 s21, s44, 1536000
  buffer_load_dwordx4 v[160:163], v4, s[12:15], s21 offen
  s_add_u32 s21, s44, 1543680
  buffer_load_dwordx4 v[164:167], v5, s[12:15], s21 offen
  s_add_u32 s21, s44, 1551360
  buffer_load_dwordx4 v[168:171], v4, s[12:15], s21 offen
  s_add_u32 s21, s44, 1559040
  buffer_load_dwordx4 v[172:175], v5, s[12:15], s21 offen
  s_add_u32 s21, s44, 1566720
  buffer_load_dwordx4 v[176:179], v6, s[12:15], s21 offen
  s_add_u32 s21, s44, 1574400
  buffer_load_dwordx4 v[180:183], v7, s[12:15], s21 offen
  s_add_u32 s21, s44, 1582080
  buffer_load_dwordx4 v[184:187], v6, s[12:15], s21 offen
  s_add_u32 s21, s44, 1589760
  buffer_load_dwordx4 v[188:191], v7, s[12:15], s21 offen
  s_barrier
  ds_read_b64_tr_b16 a[0:1], v12 offset:0
  ds_read_b64_tr_b16 a[2:3], v12 offset:2048
  ds_read_b64_tr_b16 a[4:5], v13 offset:0
  ds_read_b64_tr_b16 a[6:7], v13 offset:2048
  ds_read_b64_tr_b16 a[8:9], v14 offset:0
  ds_read_b64_tr_b16 a[10:11], v14 offset:2048
  ds_read_b64_tr_b16 a[12:13], v15 offset:0
  ds_read_b64_tr_b16 a[14:15], v15 offset:2048
  ds_read_b64_tr_b16 a[16:17], v12 offset:16384
  ds_read_b64_tr_b16 a[18:19], v12 offset:18432
  ds_read_b64_tr_b16 a[20:21], v13 offset:16384
  ds_read_b64_tr_b16 a[22:23], v13 offset:18432
  ds_read_b64_tr_b16 a[24:25], v14 offset:16384
  ds_read_b64_tr_b16 a[26:27], v14 offset:18432
  ds_read_b64_tr_b16 a[28:29], v15 offset:16384
  ds_read_b64_tr_b16 a[30:31], v15 offset:18432
  ds_read_b64_tr_b16 a[32:33], v12 offset:32768
  ds_read_b64_tr_b16 a[34:35], v12 offset:34816
  ds_read_b64_tr_b16 a[36:37], v13 offset:32768
  ds_read_b64_tr_b16 a[38:39], v13 offset:34816
  ds_read_b64_tr_b16 a[40:41], v14 offset:32768
  ds_read_b64_tr_b16 a[42:43], v14 offset:34816
  ds_read_b64_tr_b16 a[44:45], v15 offset:32768
  ds_read_b64_tr_b16 a[46:47], v15 offset:34816
  ds_read_b64_tr_b16 a[48:49], v12 offset:49152
  ds_read_b64_tr_b16 a[50:51], v12 offset:51200
  ds_read_b64_tr_b16 a[52:53], v13 offset:49152
  ds_read_b64_tr_b16 a[54:55], v13 offset:51200
  ds_read_b64_tr_b16 a[56:57], v14 offset:49152
  ds_read_b64_tr_b16 a[58:59], v14 offset:51200
  ds_read_b64_tr_b16 a[60:61], v15 offset:49152
  ds_read_b64_tr_b16 a[62:63], v15 offset:51200
  s_waitcnt lgkmcnt(0)
  s_barrier
  s_waitcnt vmcnt(32)
  s_add_u32 s21, s44, 1966080
  buffer_load_dwordx4 v[192:195], v4, s[12:15], s21 offen
  s_add_u32 s21, s44, 1973760
  buffer_load_dwordx4 v[196:199], v5, s[12:15], s21 offen
  s_add_u32 s21, s44, 1981440
  buffer_load_dwordx4 v[200:203], v4, s[12:15], s21 offen
  s_add_u32 s21, s44, 1989120
  buffer_load_dwordx4 v[204:207], v5, s[12:15], s21 offen
  s_add_u32 s21, s44, 1996800
  buffer_load_dwordx4 v[208:211], v6, s[12:15], s21 offen
  s_add_u32 s21, s44, 2004480
  buffer_load_dwordx4 v[212:215], v7, s[12:15], s21 offen
  s_add_u32 s21, s44, 2012160
  buffer_load_dwordx4 v[216:219], v6, s[12:15], s21 offen
  s_add_u32 s21, s44, 2019840
  buffer_load_dwordx4 v[220:223], v7, s[12:15], s21 offen
  s_add_u32 s21, s44, 2027520
  buffer_load_dwordx4 v[224:227], v4, s[12:15], s21 offen
  s_add_u32 s21, s44, 2035200
  buffer_load_dwordx4 v[228:231], v5, s[12:15], s21 offen
  s_add_u32 s21, s44, 2042880
  buffer_load_dwordx4 v[232:235], v4, s[12:15], s21 offen
  s_add_u32 s21, s44, 2050560
  buffer_load_dwordx4 v[236:239], v5, s[12:15], s21 offen
  s_add_u32 s21, s44, 2058240
  buffer_load_dwordx4 v[240:243], v6, s[12:15], s21 offen
  s_add_u32 s21, s44, 2065920
  buffer_load_dwordx4 v[244:247], v7, s[12:15], s21 offen
  s_add_u32 s21, s44, 2073600
  buffer_load_dwordx4 v[248:251], v6, s[12:15], s21 offen
  s_add_u32 s21, s44, 2081280
  buffer_load_dwordx4 v[252:255], v7, s[12:15], s21 offen
  s_barrier
  ds_read_b64_tr_b16 a[64:65], v16 offset:0
  ds_read_b64_tr_b16 a[66:67], v16 offset:2048
  ds_read_b64_tr_b16 a[68:69], v17 offset:0
  ds_read_b64_tr_b16 a[70:71], v17 offset:2048
  ds_read_b64_tr_b16 a[72:73], v18 offset:0
  ds_read_b64_tr_b16 a[74:75], v18 offset:2048
  ds_read_b64_tr_b16 a[76:77], v19 offset:0
  ds_read_b64_tr_b16 a[78:79], v19 offset:2048
  ds_read_b64_tr_b16 a[80:81], v16 offset:16384
  ds_read_b64_tr_b16 a[82:83], v16 offset:18432
  ds_read_b64_tr_b16 a[84:85], v17 offset:16384
  ds_read_b64_tr_b16 a[86:87], v17 offset:18432
  ds_read_b64_tr_b16 a[88:89], v18 offset:16384
  ds_read_b64_tr_b16 a[90:91], v18 offset:18432
  ds_read_b64_tr_b16 a[92:93], v19 offset:16384
  ds_read_b64_tr_b16 a[94:95], v19 offset:18432
  ds_read_b64_tr_b16 a[96:97], v16 offset:32768
  ds_read_b64_tr_b16 a[98:99], v16 offset:34816
  ds_read_b64_tr_b16 a[100:101], v17 offset:32768
  ds_read_b64_tr_b16 a[102:103], v17 offset:34816
  ds_read_b64_tr_b16 a[104:105], v18 offset:32768
  ds_read_b64_tr_b16 a[106:107], v18 offset:34816
  ds_read_b64_tr_b16 a[108:109], v19 offset:32768
  ds_read_b64_tr_b16 a[110:111], v19 offset:34816
  ds_read_b64_tr_b16 a[112:113], v16 offset:49152
  ds_read_b64_tr_b16 a[114:115], v16 offset:51200
  ds_read_b64_tr_b16 a[116:117], v17 offset:49152
  ds_read_b64_tr_b16 a[118:119], v17 offset:51200
  ds_read_b64_tr_b16 a[120:121], v18 offset:49152
  ds_read_b64_tr_b16 a[122:123], v18 offset:51200
  ds_read_b64_tr_b16 a[124:125], v19 offset:49152
  ds_read_b64_tr_b16 a[126:127], v19 offset:51200
  s_waitcnt lgkmcnt(0)
  s_barrier
  s_waitcnt vmcnt(32)
  ds_write_b128 v23, v[64:67] offset:0
  ds_write_b128 v23, v[68:71] offset:1024
  ds_write_b128 v23, v[72:75] offset:2048
  ds_write_b128 v23, v[76:79] offset:3072
  ds_write_b128 v23, v[80:83] offset:4096
  ds_write_b128 v23, v[84:87] offset:5120
  ds_write_b128 v23, v[88:91] offset:6144
  ds_write_b128 v23, v[92:95] offset:7168
  ds_write_b128 v23, v[96:99] offset:8192
  ds_write_b128 v23, v[100:103] offset:9216
  ds_write_b128 v23, v[104:107] offset:10240
  ds_write_b128 v23, v[108:111] offset:11264
  ds_write_b128 v23, v[112:115] offset:12288
  ds_write_b128 v23, v[116:119] offset:13312
  ds_write_b128 v23, v[120:123] offset:14336
  ds_write_b128 v23, v[124:127] offset:15360
  s_waitcnt lgkmcnt(0)
  s_barrier
  ds_read_b64_tr_b16 a[128:129], v12 offset:0
  ds_read_b64_tr_b16 a[130:131], v12 offset:2048
  ds_read_b64_tr_b16 a[132:133], v13 offset:0
  ds_read_b64_tr_b16 a[134:135], v13 offset:2048
  ds_read_b64_tr_b16 a[136:137], v14 offset:0
  ds_read_b64_tr_b16 a[138:139], v14 offset:2048
  ds_read_b64_tr_b16 a[140:141], v15 offset:0
  ds_read_b64_tr_b16 a[142:143], v15 offset:2048
  ds_read_b64_tr_b16 a[144:145], v12 offset:16384
  ds_read_b64_tr_b16 a[146:147], v12 offset:18432
  ds_read_b64_tr_b16 a[148:149], v13 offset:16384
  ds_read_b64_tr_b16 a[150:151], v13 offset:18432
  ds_read_b64_tr_b16 a[152:153], v14 offset:16384
  ds_read_b64_tr_b16 a[154:155], v14 offset:18432
  ds_read_b64_tr_b16 a[156:157], v15 offset:16384
  ds_read_b64_tr_b16 a[158:159], v15 offset:18432
  ds_read_b64_tr_b16 a[160:161], v12 offset:32768
  ds_read_b64_tr_b16 a[162:163], v12 offset:34816
  ds_read_b64_tr_b16 a[164:165], v13 offset:32768
  ds_read_b64_tr_b16 a[166:167], v13 offset:34816
  ds_read_b64_tr_b16 a[168:169], v14 offset:32768
  ds_read_b64_tr_b16 a[170:171], v14 offset:34816
  ds_read_b64_tr_b16 a[172:173], v15 offset:32768
  ds_read_b64_tr_b16 a[174:175], v15 offset:34816
  ds_read_b64_tr_b16 a[176:177], v12 offset:49152
  ds_read_b64_tr_b16 a[178:179], v12 offset:51200
  ds_read_b64_tr_b16 a[180:181], v13 offset:49152
  ds_read_b64_tr_b16 a[182:183], v13 offset:51200
  ds_read_b64_tr_b16 a[184:185], v14 offset:49152
  ds_read_b64_tr_b16 a[186:187], v14 offset:51200
  ds_read_b64_tr_b16 a[188:189], v15 offset:49152
  ds_read_b64_tr_b16 a[190:191], v15 offset:51200
  s_waitcnt lgkmcnt(0)
  s_barrier
  s_waitcnt vmcnt(16)
  ds_write_b128 v29, v[128:131] offset:0
  ds_write_b128 v29, v[132:135] offset:1024
  ds_write_b128 v29, v[136:139] offset:2048
  ds_write_b128 v29, v[140:143] offset:3072
  ds_write_b128 v29, v[144:147] offset:4096
  ds_write_b128 v29, v[148:151] offset:5120
  ds_write_b128 v29, v[152:155] offset:6144
  ds_write_b128 v29, v[156:159] offset:7168
  ds_write_b128 v29, v[160:163] offset:8192
  ds_write_b128 v29, v[164:167] offset:9216
  ds_write_b128 v29, v[168:171] offset:10240
  ds_write_b128 v29, v[172:175] offset:11264
  ds_write_b128 v29, v[176:179] offset:12288
  ds_write_b128 v29, v[180:183] offset:13312
  ds_write_b128 v29, v[184:187] offset:14336
  ds_write_b128 v29, v[188:191] offset:15360
  s_waitcnt lgkmcnt(0)
  s_barrier
  ds_read_b64_tr_b16 a[192:193], v16 offset:0
  ds_read_b64_tr_b16 a[194:195], v16 offset:2048
  ds_read_b64_tr_b16 a[196:197], v17 offset:0
  ds_read_b64_tr_b16 a[198:199], v17 offset:2048
  ds_read_b64_tr_b16 a[200:201], v18 offset:0
  ds_read_b64_tr_b16 a[202:203], v18 offset:2048
  ds_read_b64_tr_b16 a[204:205], v19 offset:0
  ds_read_b64_tr_b16 a[206:207], v19 offset:2048
  ds_read_b64_tr_b16 a[208:209], v16 offset:16384
  ds_read_b64_tr_b16 a[210:211], v16 offset:18432
  ds_read_b64_tr_b16 a[212:213], v17 offset:16384
  ds_read_b64_tr_b16 a[214:215], v17 offset:18432
  ds_read_b64_tr_b16 a[216:217], v18 offset:16384
  ds_read_b64_tr_b16 a[218:219], v18 offset:18432
  ds_read_b64_tr_b16 a[220:221], v19 offset:16384
  ds_read_b64_tr_b16 a[222:223], v19 offset:18432
  ds_read_b64_tr_b16 a[224:225], v16 offset:32768
  ds_read_b64_tr_b16 a[226:227], v16 offset:34816
  ds_read_b64_tr_b16 a[228:229], v17 offset:32768
  ds_read_b64_tr_b16 a[230:231], v17 offset:34816
  ds_read_b64_tr_b16 a[232:233], v18 offset:32768
  ds_read_b64_tr_b16 a[234:235], v18 offset:34816
  ds_read_b64_tr_b16 a[236:237], v19 offset:32768
  ds_read_b64_tr_b16 a[238:239], v19 offset:34816
  ds_read_b64_tr_b16 a[240:241], v16 offset:49152
  ds_read_b64_tr_b16 a[242:243], v16 offset:51200
  ds_read_b64_tr_b16 a[244:245], v17 offset:49152
  ds_read_b64_tr_b16 a[246:247], v17 offset:51200
  ds_read_b64_tr_b16 a[248:249], v18 offset:49152
  ds_read_b64_tr_b16 a[250:251], v18 offset:51200
  ds_read_b64_tr_b16 a[252:253], v19 offset:49152
  ds_read_b64_tr_b16 a[254:255], v19 offset:51200
  s_waitcnt lgkmcnt(0)
  s_barrier
  s_waitcnt vmcnt(0)
  ds_write_b128 v23, v[192:195] offset:0
  ds_write_b128 v23, v[196:199] offset:1024
  ds_write_b128 v23, v[200:203] offset:2048
  ds_write_b128 v23, v[204:207] offset:3072
  ds_write_b128 v23, v[208:211] offset:4096
  ds_write_b128 v23, v[212:215] offset:5120
  ds_write_b128 v23, v[216:219] offset:6144
  ds_write_b128 v23, v[220:223] offset:7168
  ds_write_b128 v23, v[224:227] offset:8192
  ds_write_b128 v23, v[228:231] offset:9216
  ds_write_b128 v23, v[232:235] offset:10240
  ds_write_b128 v23, v[236:239] offset:11264
  ds_write_b128 v23, v[240:243] offset:12288
  ds_write_b128 v23, v[244:247] offset:13312
  ds_write_b128 v23, v[248:251] offset:14336
  ds_write_b128 v23, v[252:255] offset:15360
  s_waitcnt lgkmcnt(0)
  s_barrier
  ds_read_b64_tr_b16 v[192:193], v12 offset:0
  ds_read_b64_tr_b16 v[194:195], v12 offset:2048
  ds_read_b64_tr_b16 v[196:197], v13 offset:0
  ds_read_b64_tr_b16 v[198:199], v13 offset:2048
  ds_read_b64_tr_b16 v[200:201], v14 offset:0
  ds_read_b64_tr_b16 v[202:203], v14 offset:2048
  ds_read_b64_tr_b16 v[204:205], v15 offset:0
  ds_read_b64_tr_b16 v[206:207], v15 offset:2048
  ds_read_b64_tr_b16 v[208:209], v12 offset:16384
  ds_read_b64_tr_b16 v[210:211], v12 offset:18432
  ds_read_b64_tr_b16 v[212:213], v13 offset:16384
  ds_read_b64_tr_b16 v[214:215], v13 offset:18432
  ds_read_b64_tr_b16 v[216:217], v14 offset:16384
  ds_read_b64_tr_b16 v[218:219], v14 offset:18432
  ds_read_b64_tr_b16 v[220:221], v15 offset:16384
  ds_read_b64_tr_b16 v[222:223], v15 offset:18432
  ds_read_b64_tr_b16 v[224:225], v12 offset:32768
  ds_read_b64_tr_b16 v[226:227], v12 offset:34816
  ds_read_b64_tr_b16 v[228:229], v13 offset:32768
  ds_read_b64_tr_b16 v[230:231], v13 offset:34816
  ds_read_b64_tr_b16 v[232:233], v14 offset:32768
  ds_read_b64_tr_b16 v[234:235], v14 offset:34816
  ds_read_b64_tr_b16 v[236:237], v15 offset:32768
  ds_read_b64_tr_b16 v[238:239], v15 offset:34816
  ds_read_b64_tr_b16 v[240:241], v12 offset:49152
  ds_read_b64_tr_b16 v[242:243], v12 offset:51200
  ds_read_b64_tr_b16 v[244:245], v13 offset:49152
  ds_read_b64_tr_b16 v[246:247], v13 offset:51200
  ds_read_b64_tr_b16 v[248:249], v14 offset:49152
  ds_read_b64_tr_b16 v[250:251], v14 offset:51200
  ds_read_b64_tr_b16 v[252:253], v15 offset:49152
  ds_read_b64_tr_b16 v[254:255], v15 offset:51200
  s_waitcnt lgkmcnt(0)
  s_barrier
  v_lshrrev_b32 v8, 3, v1
  v_and_b32 v9, 7, v1
  v_xor_b32 v9, v9, v8
  s_and_b32 s21, s20, 1
  s_lshl_b32 s21, s21, 4
  s_lshr_b32 s22, s20, 1
  s_add_u32 s21, s21, s22
  v_lshl_add_u32 v8, v8, 1, s21
  v_mul_u32_u24 v8, 1280, v8
  v_lshl_add_u32 v4, v9, 4, v8
  s_lshl_b32 s31, s20, 10
  s_mul_i32 s30, s42, 655360
  s_sub_u32 s46, s30, 40960
  s_cmp_eq_u32 s42, 0
  s_cselect_b32 s46, 1073741824, s46
  s_add_u32 m0, s31, 0
  s_nop 0
  buffer_load_dwordx4 v4, s[8:11], s46 offen offset:0 lds
  s_add_u32 m0, s31, 3968
  s_nop 0
  buffer_load_dwordx4 v4, s[8:11], s46 offen offset:128 lds
  s_add_u32 m0, s31, 7936
  s_nop 0
  buffer_load_dwordx4 v4, s[8:11], s46 offen offset:256 lds
  s_add_u32 m0, s31, 11904
  s_nop 0
  buffer_load_dwordx4 v4, s[8:11], s46 offen offset:384 lds
  s_add_u32 m0, s31, 15872
  s_nop 0
  buffer_load_dwordx4 v4, s[8:11], s46 offen offset:512 lds
  s_add_u32 m0, s31, 19840
  s_nop 0
  buffer_load_dwordx4 v4, s[8:11], s46 offen offset:640 lds
  s_add_u32 m0, s31, 23808
  s_nop 0
  buffer_load_dwordx4 v4, s[8:11], s46 offen offset:768 lds
  s_add_u32 m0, s31, 27776
  s_nop 0
  buffer_load_dwordx4 v4, s[8:11], s46 offen offset:896 lds
  s_add_u32 m0, s31, 31744
  s_nop 0
  buffer_load_dwordx4 v4, s[8:11], s46 offen offset:1024 lds
  s_add_u32 m0, s31, 35712
  s_nop 0
  buffer_load_dwordx4 v4, s[8:11], s46 offen offset:1152 lds
  s_add_u32 s31, s31, 40960
  s_add_u32 m0, s31, 0
  s_nop 0
  buffer_load_dwordx4 v4, s[8:11], s30 offen offset:0 lds
  s_add_u32 m0, s31, 3968
  s_nop 0
  buffer_load_dwordx4 v4, s[8:11], s30 offen offset:128 lds
  s_add_u32 m0, s31, 7936
  s_nop 0
  buffer_load_dwordx4 v4, s[8:11], s30 offen offset:256 lds
  s_add_u32 m0, s31, 11904
  s_nop 0
  buffer_load_dwordx4 v4, s[8:11], s30 offen offset:384 lds
  s_add_u32 m0, s31, 15872
  s_nop 0
  buffer_load_dwordx4 v4, s[8:11], s30 offen offset:512 lds
  s_add_u32 m0, s31, 19840
  s_nop 0
  buffer_load_dwordx4 v4, s[8:11], s30 offen offset:640 lds
  s_add_u32 m0, s31, 23808
  s_nop 0
  buffer_load_dwordx4 v4, s[8:11], s30 offen offset:768 lds
  s_add_u32 m0, s31, 27776
  s_nop 0
  buffer_load_dwordx4 v4, s[8:11], s30 offen offset:896 lds
  s_add_u32 m0, s31, 31744
  s_nop 0
  buffer_load_dwordx4 v4, s[8:11], s30 offen offset:1024 lds
  s_add_u32 m0, s31, 35712
  s_nop 0
  buffer_load_dwordx4 v4, s[8:11], s30 offen offset:1152 lds
  s_add_u32 s31, s31, 40960
  s_add_u32 s30, s30, 40960
  v_and_b32 v10, 7, v2
  v_add_u32 v8, 0, v3
  v_xor_b32 v8, v8, v10
  v_lshlrev_b32 v8, 4, v8
  v_lshl_add_u32 v5, v2, 7, v8
  v_add_u32 v8, 4, v3
  v_xor_b32 v8, v8, v10
  v_lshlrev_b32 v8, 4, v8
  v_lshl_add_u32 v6, v2, 7, v8
  v_mov_b32 v7, v5
  v_mov_b32 v8, v6
  s_mov_b32 s33, 0
  v_lshlrev_b32 v15, 4, v1
  v_mov_b32 v16, 0xf149f2ca
  v_lshrrev_b32 v17, 3, v2
  v_mul_u32_u24 v17, 2560, v17
  v_lshlrev_b32 v18, 1, v10
  s_lshr_b32 s21, s20, 1
  s_lshl_b32 s21, s21, 10
  s_and_b32 s22, s20, 1
  s_lshl_b32 s22, s22, 3
  s_add_u32 s21, s21, s22
  s_add_u32 s21, s21, 131072
  v_lshl_add_u32 v9, v3, 4, v18
  v_lshl_add_u32 v9, v9, 4, v17
  v_add_u32 v9, s21, v9
  s_lshl_b32 s21, s20, 7
  s_add_u32 s21, s21, 133120
  v_lshl_add_u32 v10, v18, 3, v17
  v_add_u32 v10, s21, v10
  v_cmp_eq_u32 vcc, 2, v3
  v_lshlrev_b32 v19, 4, v1
  v_add_u32 v19, 136192, v19
  v_cndmask_b32 v10, v19, v10, vcc
  s_lshr_b32 s21, s20, 1
  s_and_b32 s22, s20, 1
  s_mul_i32 s23, s21, 2560
  s_lshl_b32 s47, s22, 10
  s_add_u32 s47, s47, s23
  s_add_u32 s47, s47, 131072
  v_add_u32 v11, s47, v15
  s_lshl_b32 s47, s22, 8
  s_add_u32 s47, s47, s23
  s_add_u32 s47, s47, 133120
  v_add_u32 v12, s47, v15
  s_mul_i32 s23, s22, 768
  s_sub_u32 s23, 2048, s23
  v_add_u32 v14, s23, v15
  v_mov_b32 v19, 1073741824
  v_cmp_gt_u32 vcc, 16, v1
  s_mul_i32 s47, s42, 655360
  s_mul_i32 s21, s21, 20480
  v_cndmask_b32 v14, v19, v14, vcc
  s_add_u32 s47, s47, s21
  s_mul_i32 s21, s41, 2560
  s_add_u32 s47, s47, s21
  s_lshl_b32 s22, s22, 10
  s_add_u32 s47, s47, s22
  s_mov_b32 s48, 1073741824
  s_mov_b32 s49, 1073741824
  v_cmp_eq_u32 s[62:63], 0, v3
  v_lshlrev_b32 v17, 2, v3
  v_sub_u32 v17, v17, v2
  s_mov_b32 s82, 0x3e64f92e
  s_mov_b32 s83, 0x3fb8aa3b
  v_mov_b32 v20, 0
  v_mov_b32 v21, 0
  v_mov_b32 v22, 0
  v_mov_b32 v23, 0
  v_add_u32 v18, 7, v17
  v_cmp_gt_u32 s[84:85], 8, v18
  v_cmp_le_i32 s[64:65], 16, v18
  v_mov_b32 v18, 65535
  v_cndmask_b32 v19, 0, v18, s[84:85]
  v_or_b32 v20, v20, v19
  v_cndmask_b32 v19, 0, v18, s[64:65]
  v_or_b32 v22, v22, v19
  s_mov_b64 s[54:55], s[84:85]
  s_or_b64 s[84:85], s[84:85], s[64:65]
  v_add_u32 v18, 8, v17
  v_cmp_gt_u32 s[86:87], 8, v18
  v_cmp_le_i32 s[66:67], 16, v18
  v_mov_b32 v18, 4294901760
  v_cndmask_b32 v19, 0, v18, s[86:87]
  v_or_b32 v20, v20, v19
  v_cndmask_b32 v19, 0, v18, s[66:67]
  v_or_b32 v22, v22, v19
  s_mov_b64 s[56:57], s[86:87]
  s_or_b64 s[86:87], s[86:87], s[66:67]
  v_add_u32 v18, 9, v17
  v_cmp_gt_u32 s[88:89], 8, v18
  v_cmp_le_i32 s[68:69], 16, v18
  v_mov_b32 v18, 65535
  v_cndmask_b32 v19, 0, v18, s[88:89]
  v_or_b32 v21, v21, v19
  v_cndmask_b32 v19, 0, v18, s[68:69]
  v_or_b32 v23, v23, v19
  s_mov_b64 s[58:59], s[88:89]
  s_or_b64 s[88:89], s[88:89], s[68:69]
  v_add_u32 v18, 10, v17
  v_cmp_gt_u32 s[90:91], 8, v18
  v_cmp_le_i32 s[70:71], 16, v18
  v_mov_b32 v18, 4294901760
  v_cndmask_b32 v19, 0, v18, s[90:91]
  v_or_b32 v21, v21, v19
  v_cndmask_b32 v19, 0, v18, s[70:71]
  v_or_b32 v23, v23, v19
  s_mov_b64 s[60:61], s[90:91]
  s_or_b64 s[90:91], s[90:91], s[70:71]
  v_mov_b32 v18, 0x3f80
  v_mov_b32 v19, 0x3f800000
  v_cmp_eq_i32 vcc, 0, v17
  v_cmp_eq_i32 s[22:23], -1, v17
  s_nop 1
  v_cndmask_b32 v24, 0, v18, vcc
  v_cndmask_b32 v24, v24, v19, s[22:23]
  v_cmp_eq_i32 vcc, -2, v17
  v_cmp_eq_i32 s[22:23], -3, v17
  s_nop 1
  v_cndmask_b32 v25, 0, v18, vcc
  v_cndmask_b32 v25, v25, v19, s[22:23]
  v_mov_b32 v26, 0
  v_mov_b32 v27, 0
  v_mov_b32 v60, 0
  v_mov_b32 v61, 0
  v_mov_b32 v62, 0
  v_mov_b32 v63, 0
  v_mov_b32 v64, 0
  v_mov_b32 v65, 0
  v_mov_b32 v66, 0
  v_mov_b32 v67, 0
  v_mov_b32 v68, 0
  v_mov_b32 v69, 0
  v_mov_b32 v70, 0
  v_mov_b32 v71, 0
  v_mov_b32 v72, 0
  v_mov_b32 v73, 0
  v_mov_b32 v74, 0
  v_mov_b32 v75, 0
  v_mov_b32 v76, 0
  v_mov_b32 v77, 0
  v_mov_b32 v78, 0
  v_mov_b32 v79, 0
  v_mov_b32 v80, 0
  v_mov_b32 v81, 0
  v_mov_b32 v82, 0
  v_mov_b32 v83, 0
  v_mov_b32 v84, 0
  v_mov_b32 v85, 0
  v_mov_b32 v86, 0
  v_mov_b32 v87, 0
  v_mov_b32 v88, 0
  v_mov_b32 v89, 0
  v_mov_b32 v90, 0
  v_mov_b32 v91, 0
  v_mov_b32 v92, 0
  v_mov_b32 v93, 0
  v_mov_b32 v94, 0
  v_mov_b32 v95, 0
  v_mov_b32 v96, 0
  v_mov_b32 v97, 0
  v_mov_b32 v98, 0
  v_mov_b32 v99, 0
  v_mov_b32 v100, 0
  v_mov_b32 v101, 0
  v_mov_b32 v102, 0
  v_mov_b32 v103, 0
  v_mov_b32 v104, 0
  v_mov_b32 v105, 0
  v_mov_b32 v106, 0
  v_mov_b32 v107, 0
  v_mov_b32 v108, 0
  v_mov_b32 v109, 0
  v_mov_b32 v110, 0
  v_mov_b32 v111, 0
  v_mov_b32 v112, 0
  v_mov_b32 v113, 0
  v_mov_b32 v114, 0
  v_mov_b32 v115, 0
  v_mov_b32 v116, 0
  v_mov_b32 v117, 0
  v_mov_b32 v118, 0
  v_mov_b32 v119, 0
  v_mov_b32 v120, 0
  v_mov_b32 v121, 0
  v_mov_b32 v122, 0
  v_mov_b32 v123, 0
  v_mov_b32 v124, 0
  v_mov_b32 v125, 0
  v_mov_b32 v126, 0
  v_mov_b32 v127, 0
  v_mov_b32 v128, 0
  v_mov_b32 v129, 0
  v_mov_b32 v130, 0
  v_mov_b32 v131, 0
  s_cmp_eq_u32 s42, 0
  s_cselect_b32 s53, 15, 99
  s_mov_b32 s26, 17
  s_waitcnt vmcnt(10)
  s_barrier
  ds_read_b128 v[28:31], v7 offset:0
  ds_read_b128 v[32:35], v8 offset:0
  ds_read_b128 v[36:39], v7 offset:4096
  ds_read_b128 v[40:43], v8 offset:4096
  s_waitcnt lgkmcnt(3)
  .p2align 3
bfl_207:
  v_mfma_f32_16x16x32_bf16 v[60:63], a[0:3], v[28:31], 0
  ds_read_b128 v[44:47], v7 offset:8192
  v_mfma_f32_16x16x32_bf16 v[64:67], a[4:7], v[28:31], 0
  v_mfma_f32_16x16x32_bf16 v[68:71], a[8:11], v[28:31], 0
  v_cvt_pk_bf16_f32 v128, v84, v85
  v_cvt_pk_bf16_f32 v129, v86, v87
  v_mfma_f32_16x16x32_bf16 v[72:75], v[28:31], a[12:15], 0
  s_waitcnt lgkmcnt(3)
  v_cvt_pk_bf16_f32 v124, v76, v77
  v_cvt_pk_bf16_f32 v125, v78, v79
  v_mfma_f32_16x16x32_bf16 v[60:63], a[16:19], v[32:35], v[60:63]
  ds_read_b128 v[48:51], v8 offset:8192
  v_cvt_pk_bf16_f32 v100, v80, v81
  v_mfma_f32_16x16x32_bf16 v[64:67], a[20:23], v[32:35], v[64:67]
  v_cvt_pk_bf16_f32 v101, v82, v83
  v_cvt_pk_bf16_f32 v116, v88, v89
  v_mfma_f32_16x16x32_bf16 v[68:71], a[24:27], v[32:35], v[68:71]
  s_add_u32 m0, s31, 0
  v_cvt_pk_bf16_f32 v117, v90, v91
  v_cndmask_b32 v126, 0, v128, s[62:63]
  v_mfma_f32_16x16x32_bf16 v[72:75], v[32:35], a[28:31], v[72:75]
  s_waitcnt lgkmcnt(3)
  v_cndmask_b32 v127, 0, v129, s[62:63]
  buffer_load_dwordx4 v4, s[8:11], s30 offen offset:0 lds
  v_mfma_f32_16x16x32_bf16 v[60:63], a[32:35], v[36:39], v[60:63]
  ds_read_b128 v[52:55], v7 offset:12288
  v_mfma_f32_16x16x32_bf16 v[64:67], a[36:39], v[36:39], v[64:67]
  v_mfma_f32_16x16x32_bf16 v[68:71], a[40:43], v[36:39], v[68:71]
  v_mfma_f32_16x16x32_bf16 v[72:75], v[36:39], a[44:47], v[72:75]
  v_mfma_f32_16x16x32_bf16 v[132:135], v[128:131], v[24:27], 0
  s_waitcnt lgkmcnt(3)
  v_permlane16_swap_b32 v128, v102
  v_permlane16_swap_b32 v129, v103
  v_mfma_f32_16x16x32_bf16 v[60:63], a[48:51], v[40:43], v[60:63]
  ds_read_b128 v[56:59], v8 offset:12288
  v_mfma_f32_16x16x32_bf16 v[64:67], a[52:55], v[40:43], v[64:67]
  v_mfma_f32_16x16x32_bf16 v[68:71], a[56:59], v[40:43], v[68:71]
  v_mfma_f32_16x16x32_bf16 v[72:75], v[40:43], a[60:63], v[72:75]
  v_mfma_f32_16x16x32_bf16 v[136:139], v[100:103], v[124:127], 0
  v_mfma_f32_16x16x32_bf16 v[140:143], v[104:107], v[124:127], 0
  s_add_u32 m0, s31, 3968
  s_waitcnt lgkmcnt(3)
  v_mfma_f32_16x16x32_bf16 v[60:63], a[64:67], v[44:47], v[60:63]
  ds_read_b128 v[28:31], v7 offset:16384
  buffer_load_dwordx4 v4, s[8:11], s30 offen offset:128 lds
  v_mfma_f32_16x16x32_bf16 v[64:67], a[68:71], v[44:47], v[64:67]
  v_mfma_f32_16x16x32_bf16 v[68:71], a[72:75], v[44:47], v[68:71]
  v_cvt_pk_bf16_f32 v120, v132, v133
  v_cvt_pk_bf16_f32 v121, v134, v135
  v_mfma_f32_16x16x32_bf16 v[72:75], v[44:47], a[76:79], v[72:75]
  s_waitcnt lgkmcnt(3)
  v_cndmask_b32 v136, v136, v140, s[64:65]
  v_cndmask_b32 v137, v137, v141, s[66:67]
  v_mfma_f32_16x16x32_bf16 v[60:63], a[80:83], v[48:51], v[60:63]
  ds_read_b128 v[32:35], v8 offset:16384
  v_cndmask_b32 v138, v138, v142, s[68:69]
  v_mfma_f32_16x16x32_bf16 v[64:67], a[84:87], v[48:51], v[64:67]
  v_cndmask_b32 v139, v139, v143, s[70:71]
  v_cvt_pk_bf16_f32 v17, v136, v137
  v_mfma_f32_16x16x32_bf16 v[68:71], a[88:91], v[48:51], v[68:71]
  v_lshlrev_b32 v136, 16, v17
  v_and_b32 v137, 0xffff0000, v17
  v_mfma_f32_16x16x32_bf16 v[72:75], v[48:51], a[92:95], v[72:75]
  s_waitcnt lgkmcnt(3)
  v_cvt_pk_bf16_f32 v17, v138, v139
  v_lshlrev_b32 v138, 16, v17
  v_mfma_f32_16x16x32_bf16 v[60:63], a[96:99], v[52:55], v[60:63]
  ds_read_b128 v[36:39], v7 offset:20480
  v_and_b32 v139, 0xffff0000, v17
  v_mfma_f32_16x16x32_bf16 v[64:67], a[100:103], v[52:55], v[64:67]
  v_mul_f32 v136, s82, v136
  v_mul_f32 v137, s82, v137
  v_mfma_f32_16x16x32_bf16 v[68:71], a[104:107], v[52:55], v[68:71]
  v_mul_f32 v138, s82, v138
  v_mul_f32 v139, s82, v139
  v_mfma_f32_16x16x32_bf16 v[72:75], v[52:55], a[108:111], v[72:75]
  s_waitcnt lgkmcnt(3)
  v_cvt_pk_bf16_f32 v17, v136, v137
  v_lshlrev_b32 v136, 16, v17
  v_mfma_f32_16x16x32_bf16 v[60:63], a[112:115], v[56:59], v[60:63]
  s_add_u32 m0, s31, 7936
  ds_read_b128 v[40:43], v8 offset:20480
  v_and_b32 v137, 0xffff0000, v17
  v_mfma_f32_16x16x32_bf16 v[64:67], a[116:119], v[56:59], v[64:67]
  v_cvt_pk_bf16_f32 v17, v138, v139
  v_lshlrev_b32 v138, 16, v17
  v_mfma_f32_16x16x32_bf16 v[68:71], a[120:123], v[56:59], v[68:71]
  v_and_b32 v139, 0xffff0000, v17
  v_cndmask_b32 v136, v16, v136, s[54:55]
  v_mfma_f32_16x16x32_bf16 v[72:75], v[56:59], a[124:127], v[72:75]
  s_waitcnt lgkmcnt(3)
  v_cndmask_b32 v137, v16, v137, s[56:57]
  v_cndmask_b32 v138, v16, v138, s[58:59]
  v_mfma_f32_16x16x32_bf16 v[60:63], a[128:131], v[28:31], v[60:63]
  ds_read_b128 v[44:47], v7 offset:24576
  v_cndmask_b32 v139, v16, v139, s[60:61]
  v_mfma_f32_16x16x32_bf16 v[64:67], a[132:135], v[28:31], v[64:67]
  v_max3_f32 v17, v136, v137, v138
  v_max_f32 v17, v17, v139
  v_mfma_f32_16x16x32_bf16 v[68:71], a[136:139], v[28:31], v[68:71]
  v_mov_b32 v18, v17
  buffer_load_dwordx4 v4, s[8:11], s30 offen offset:256 lds
  v_mfma_f32_16x16x32_bf16 v[72:75], v[28:31], a[140:143], v[72:75]
  s_waitcnt lgkmcnt(3)
  v_permlane32_swap_b32 v17, v18
  v_max_f32 v17, v17, v18
  v_mfma_f32_16x16x32_bf16 v[60:63], a[144:147], v[32:35], v[60:63]
  ds_read_b128 v[48:51], v8 offset:24576
  v_mov_b32 v18, v17
  v_mfma_f32_16x16x32_bf16 v[64:67], a[148:151], v[32:35], v[64:67]
  v_permlane16_swap_b32 v17, v18
  v_max_f32 v17, v17, v18
  v_mfma_f32_16x16x32_bf16 v[68:71], a[152:155], v[32:35], v[68:71]
  v_mul_f32 v17, s83, v17
  v_fma_f32 v136, v136, s83, -v17
  v_mfma_f32_16x16x32_bf16 v[72:75], v[32:35], a[156:159], v[72:75]
  s_waitcnt lgkmcnt(3)
  v_fma_f32 v137, v137, s83, -v17
  v_fma_f32 v138, v138, s83, -v17
  v_mfma_f32_16x16x32_bf16 v[60:63], a[160:163], v[36:39], v[60:63]
  s_add_u32 m0, s31, 11904
  ds_read_b128 v[52:55], v7 offset:28672
  v_fma_f32 v139, v139, s83, -v17
  v_mfma_f32_16x16x32_bf16 v[64:67], a[164:167], v[36:39], v[64:67]
  v_exp_f32 v136, v136
  v_mfma_f32_16x16x32_bf16 v[68:71], a[168:171], v[36:39], v[68:71]
  v_exp_f32 v137, v137
  v_mfma_f32_16x16x32_bf16 v[72:75], v[36:39], a[172:175], v[72:75]
  s_waitcnt lgkmcnt(3)
  v_exp_f32 v138, v138
  v_mfma_f32_16x16x32_bf16 v[60:63], a[176:179], v[40:43], v[60:63]
  ds_read_b128 v[56:59], v8 offset:28672
  buffer_load_dwordx4 v4, s[8:11], s30 offen offset:384 lds
  v_mfma_f32_16x16x32_bf16 v[64:67], a[180:183], v[40:43], v[64:67]
  v_exp_f32 v139, v139
  v_mfma_f32_16x16x32_bf16 v[68:71], a[184:187], v[40:43], v[68:71]
  v_add_f32 v17, v136, v137
  v_add_f32 v18, v138, v139
  v_mfma_f32_16x16x32_bf16 v[72:75], v[40:43], a[188:191], v[72:75]
  s_waitcnt lgkmcnt(3)
  v_add_f32 v17, v17, v18
  v_mov_b32 v18, v17
  v_mfma_f32_16x16x32_bf16 v[60:63], a[192:195], v[44:47], v[60:63]
  ds_read_b128 v[28:31], v7 offset:32768
  v_permlane32_swap_b32 v17, v18
  v_mfma_f32_16x16x32_bf16 v[64:67], a[196:199], v[44:47], v[64:67]
  v_add_f32 v17, v17, v18
  v_mov_b32 v18, v17
  v_mfma_f32_16x16x32_bf16 v[68:71], a[200:203], v[44:47], v[68:71]
  v_permlane16_swap_b32 v17, v18
  v_add_f32 v17, v17, v18
  v_mfma_f32_16x16x32_bf16 v[72:75], v[44:47], a[204:207], v[72:75]
  s_waitcnt lgkmcnt(3)
  v_rcp_f32 v17, v17
  v_mfma_f32_16x16x32_bf16 v[60:63], a[208:211], v[48:51], v[60:63]
  s_add_u32 m0, s31, 15872
  ds_read_b128 v[32:35], v8 offset:32768
  v_mul_f32 v136, v136, v17
  v_mfma_f32_16x16x32_bf16 v[64:67], a[212:215], v[48:51], v[64:67]
  v_mul_f32 v137, v137, v17
  v_mul_f32 v138, v138, v17
  v_mfma_f32_16x16x32_bf16 v[68:71], a[216:219], v[48:51], v[68:71]
  v_mul_f32 v139, v139, v17
  v_cvt_pk_bf16_f32 v144, v136, v137
  v_mfma_f32_16x16x32_bf16 v[72:75], v[48:51], a[220:223], v[72:75]
  s_waitcnt lgkmcnt(3)
  v_cvt_pk_bf16_f32 v145, v138, v139
  v_and_b32 v146, v144, v22
  v_mfma_f32_16x16x32_bf16 v[60:63], a[224:227], v[52:55], v[60:63]
  ds_read_b128 v[36:39], v7 offset:36864
  v_and_b32 v147, v145, v23
  v_mfma_f32_16x16x32_bf16 v[64:67], a[228:231], v[52:55], v[64:67]
  v_and_b32 v144, v144, v20
  v_and_b32 v145, v145, v21
  v_mfma_f32_16x16x32_bf16 v[68:71], a[232:235], v[52:55], v[68:71]
  buffer_load_dwordx4 v4, s[8:11], s30 offen offset:512 lds
  v_mfma_f32_16x16x32_bf16 v[72:75], v[52:55], a[236:239], v[72:75]
  s_waitcnt lgkmcnt(3)
  v_mfma_f32_16x16x32_bf16 v[60:63], a[240:243], v[56:59], v[60:63]
  ds_read_b128 v[40:43], v8 offset:36864
  v_mfma_f32_16x16x32_bf16 v[64:67], a[244:247], v[56:59], v[64:67]
  v_mfma_f32_16x16x32_bf16 v[68:71], a[248:251], v[56:59], v[68:71]
  v_mfma_f32_16x16x32_bf16 v[72:75], v[56:59], a[252:255], v[72:75]
  s_add_u32 m0, s31, 19840
  s_waitcnt lgkmcnt(3)
  v_mfma_f32_16x16x32_bf16 v[60:63], v[192:195], v[28:31], v[60:63]
  ds_read_b128 v[44:47], v7 offset:2048
  buffer_load_dwordx4 v4, s[8:11], s30 offen offset:640 lds
  v_mfma_f32_16x16x32_bf16 v[64:67], v[196:199], v[28:31], v[64:67]
  v_mfma_f32_16x16x32_bf16 v[68:71], v[200:203], v[28:31], v[68:71]
  v_mfma_f32_16x16x32_bf16 v[72:75], v[28:31], v[204:207], v[72:75]
  v_mfma_f32_16x16x32_bf16 v[148:151], v[116:119], v[144:147], 0
  s_cmp_le_u32 s26, s53
  s_cselect_b64 s[54:55], s[84:85], s[54:55]
  v_mfma_f32_16x16x32_bf16 v[152:155], v[120:123], v[144:147], 0
  s_waitcnt lgkmcnt(3)
  v_mov_b32 v104, v100
  v_mov_b32 v105, v101
  v_mfma_f32_16x16x32_bf16 v[60:63], v[208:211], v[32:35], v[60:63]
  ds_read_b128 v[48:51], v8 offset:2048
  v_mov_b32 v106, v102
  v_mfma_f32_16x16x32_bf16 v[64:67], v[212:215], v[32:35], v[64:67]
  v_mov_b32 v107, v103
  v_mov_b32 v118, v116
  v_mfma_f32_16x16x32_bf16 v[68:71], v[216:219], v[32:35], v[68:71]
  v_cvt_pk_bf16_f32 v156, v148, v149
  v_cvt_pk_bf16_f32 v157, v150, v151
  v_mfma_f32_16x16x32_bf16 v[72:75], v[32:35], v[220:223], v[72:75]
  s_waitcnt lgkmcnt(3)
  ds_write_b64 v9, v[156:157] offset:16
  v_cvt_pk_bf16_f32 v158, v152, v153
  v_mfma_f32_16x16x32_bf16 v[60:63], v[224:227], v[36:39], v[60:63]
  ds_read_b128 v[52:55], v7 offset:6144
  v_cvt_pk_bf16_f32 v159, v154, v155
  v_mfma_f32_16x16x32_bf16 v[64:67], v[228:231], v[36:39], v[64:67]
  s_add_u32 m0, s31, 23808
  ds_write_b64 v10, v[158:159] offset:8
  v_mov_b32 v119, v117
  v_mfma_f32_16x16x32_bf16 v[68:71], v[232:235], v[36:39], v[68:71]
  v_mov_b32 v122, v120
  v_mov_b32 v123, v121
  v_mfma_f32_16x16x32_bf16 v[72:75], v[36:39], v[236:239], v[72:75]
  s_waitcnt lgkmcnt(5)
  buffer_load_dwordx4 v4, s[8:11], s30 offen offset:768 lds
  v_mfma_f32_16x16x32_bf16 v[60:63], v[240:243], v[40:43], v[60:63]
  ds_read_b128 v[56:59], v8 offset:6144
  v_mfma_f32_16x16x32_bf16 v[64:67], v[244:247], v[40:43], v[64:67]
  s_cmp_le_u32 s26, s53
  s_cselect_b64 s[56:57], s[86:87], s[56:57]
  v_mfma_f32_16x16x32_bf16 v[68:71], v[248:251], v[40:43], v[68:71]
  s_cmp_le_u32 s26, s53
  s_cselect_b64 s[58:59], s[88:89], s[58:59]
  v_mfma_f32_16x16x32_bf16 v[72:75], v[40:43], v[252:255], v[72:75]
  s_waitcnt lgkmcnt(5)
  s_cmp_le_u32 s26, s53
  s_cselect_b64 s[60:61], s[90:91], s[60:61]
  v_mfma_f32_16x16x32_bf16 v[76:79], a[0:3], v[44:47], 0
  ds_read_b128 v[28:31], v7 offset:10240
  v_mfma_f32_16x16x32_bf16 v[80:83], a[4:7], v[44:47], 0
  s_waitcnt lgkmcnt(2)
  s_barrier
  v_mfma_f32_16x16x32_bf16 v[84:87], a[8:11], v[44:47], 0
  v_cvt_pk_bf16_f32 v128, v68, v69
  v_cvt_pk_bf16_f32 v129, v70, v71
  v_mfma_f32_16x16x32_bf16 v[88:91], v[44:47], a[12:15], 0
  s_waitcnt lgkmcnt(5)
  v_cvt_pk_bf16_f32 v124, v60, v61
  v_cvt_pk_bf16_f32 v125, v62, v63
  v_mfma_f32_16x16x32_bf16 v[76:79], a[16:19], v[48:51], v[76:79]
  ds_read_b128 v[32:35], v8 offset:10240
  v_cvt_pk_bf16_f32 v92, v64, v65
  v_mfma_f32_16x16x32_bf16 v[80:83], a[20:23], v[48:51], v[80:83]
  s_add_u32 m0, s31, 27776
  v_cvt_pk_bf16_f32 v93, v66, v67
  v_cvt_pk_bf16_f32 v108, v72, v73
  v_mfma_f32_16x16x32_bf16 v[84:87], a[24:27], v[48:51], v[84:87]
  v_cvt_pk_bf16_f32 v109, v74, v75
  v_cndmask_b32 v126, 0, v128, s[62:63]
  v_mfma_f32_16x16x32_bf16 v[88:91], v[48:51], a[28:31], v[88:91]
  s_waitcnt lgkmcnt(4)
  v_cndmask_b32 v127, 0, v129, s[62:63]
  v_xor_b32 v9, 8192, v9
  v_mfma_f32_16x16x32_bf16 v[76:79], a[32:35], v[52:55], v[76:79]
  ds_read_b128 v[36:39], v7 offset:14336
  v_xor_b32 v10, 8192, v10
  v_mfma_f32_16x16x32_bf16 v[80:83], a[36:39], v[52:55], v[80:83]
  ds_read_b128 v[160:163], v11
  ds_read_b128 v[164:167], v12
  v_mfma_f32_16x16x32_bf16 v[84:87], a[40:43], v[52:55], v[84:87]
  buffer_load_dwordx4 v4, s[8:11], s30 offen offset:896 lds
  v_mfma_f32_16x16x32_bf16 v[88:91], v[52:55], a[44:47], v[88:91]
  v_mfma_f32_16x16x32_bf16 v[132:135], v[128:131], v[24:27], 0
  s_waitcnt lgkmcnt(5)
  v_permlane16_swap_b32 v128, v94
  v_permlane16_swap_b32 v129, v95
  v_mfma_f32_16x16x32_bf16 v[76:79], a[48:51], v[56:59], v[76:79]
  ds_read_b128 v[40:43], v8 offset:14336
  v_mfma_f32_16x16x32_bf16 v[80:83], a[52:55], v[56:59], v[80:83]
  v_mfma_f32_16x16x32_bf16 v[84:87], a[56:59], v[56:59], v[84:87]
  s_waitcnt lgkmcnt(1)
  buffer_store_dwordx4 v[160:163], v15, s[16:19], s49 offen sc1
  buffer_store_dwordx4 v[164:167], v14, s[16:19], s49 offen sc1
  v_mfma_f32_16x16x32_bf16 v[88:91], v[56:59], a[60:63], v[88:91]
  v_xor_b32 v11, 8192, v11
  v_xor_b32 v12, 8192, v12
  v_mfma_f32_16x16x32_bf16 v[136:139], v[92:95], v[124:127], 0
  s_add_u32 m0, s31, 31744
  v_mfma_f32_16x16x32_bf16 v[140:143], v[96:99], v[124:127], 0
  s_waitcnt lgkmcnt(5)
  buffer_load_dwordx4 v4, s[8:11], s30 offen offset:1024 lds
  v_mfma_f32_16x16x32_bf16 v[76:79], a[64:67], v[28:31], v[76:79]
  ds_read_b128 v[44:47], v7 offset:18432
  v_mfma_f32_16x16x32_bf16 v[80:83], a[68:71], v[28:31], v[80:83]
  v_mfma_f32_16x16x32_bf16 v[84:87], a[72:75], v[28:31], v[84:87]
  v_cvt_pk_bf16_f32 v112, v132, v133
  v_cvt_pk_bf16_f32 v113, v134, v135
  v_mfma_f32_16x16x32_bf16 v[88:91], v[28:31], a[76:79], v[88:91]
  s_waitcnt lgkmcnt(5)
  v_cndmask_b32 v136, v136, v140, s[64:65]
  v_cndmask_b32 v137, v137, v141, s[66:67]
  v_mfma_f32_16x16x32_bf16 v[76:79], a[80:83], v[32:35], v[76:79]
  ds_read_b128 v[48:51], v8 offset:18432
  v_cndmask_b32 v138, v138, v142, s[68:69]
  v_mfma_f32_16x16x32_bf16 v[80:83], a[84:87], v[32:35], v[80:83]
  v_cndmask_b32 v139, v139, v143, s[70:71]
  v_cvt_pk_bf16_f32 v17, v136, v137
  v_mfma_f32_16x16x32_bf16 v[84:87], a[88:91], v[32:35], v[84:87]
  v_lshlrev_b32 v136, 16, v17
  v_and_b32 v137, 0xffff0000, v17
  v_mfma_f32_16x16x32_bf16 v[88:91], v[32:35], a[92:95], v[88:91]
  s_waitcnt lgkmcnt(5)
  v_cvt_pk_bf16_f32 v17, v138, v139
  v_lshlrev_b32 v138, 16, v17
  v_mfma_f32_16x16x32_bf16 v[76:79], a[96:99], v[36:39], v[76:79]
  ds_read_b128 v[52:55], v7 offset:22528
  v_and_b32 v139, 0xffff0000, v17
  v_mfma_f32_16x16x32_bf16 v[80:83], a[100:103], v[36:39], v[80:83]
  v_mul_f32 v136, s82, v136
  v_mul_f32 v137, s82, v137
  v_mfma_f32_16x16x32_bf16 v[84:87], a[104:107], v[36:39], v[84:87]
  s_add_u32 m0, s31, 35712
  v_mul_f32 v138, s82, v138
  v_mul_f32 v139, s82, v139
  v_mfma_f32_16x16x32_bf16 v[88:91], v[36:39], a[108:111], v[88:91]
  s_waitcnt lgkmcnt(3)
  v_cvt_pk_bf16_f32 v17, v136, v137
  v_lshlrev_b32 v136, 16, v17
  v_mfma_f32_16x16x32_bf16 v[76:79], a[112:115], v[40:43], v[76:79]
  ds_read_b128 v[56:59], v8 offset:22528
  v_and_b32 v137, 0xffff0000, v17
  v_mfma_f32_16x16x32_bf16 v[80:83], a[116:119], v[40:43], v[80:83]
  v_cvt_pk_bf16_f32 v17, v138, v139
  v_lshlrev_b32 v138, 16, v17
  v_mfma_f32_16x16x32_bf16 v[84:87], a[120:123], v[40:43], v[84:87]
  v_and_b32 v139, 0xffff0000, v17
  v_cndmask_b32 v136, v16, v136, s[54:55]
  v_mfma_f32_16x16x32_bf16 v[88:91], v[40:43], a[124:127], v[88:91]
  s_waitcnt lgkmcnt(3)
  v_cndmask_b32 v137, v16, v137, s[56:57]
  v_cndmask_b32 v138, v16, v138, s[58:59]
  v_mfma_f32_16x16x32_bf16 v[76:79], a[128:131], v[44:47], v[76:79]
  ds_read_b128 v[28:31], v7 offset:26624
  v_cndmask_b32 v139, v16, v139, s[60:61]
  v_mfma_f32_16x16x32_bf16 v[80:83], a[132:135], v[44:47], v[80:83]
  v_max3_f32 v17, v136, v137, v138
  v_max_f32 v17, v17, v139
  v_mfma_f32_16x16x32_bf16 v[84:87], a[136:139], v[44:47], v[84:87]
  v_mov_b32 v18, v17
  buffer_load_dwordx4 v4, s[8:11], s30 offen offset:1152 lds
  v_mfma_f32_16x16x32_bf16 v[88:91], v[44:47], a[140:143], v[88:91]
  s_waitcnt lgkmcnt(3)
  v_permlane32_swap_b32 v17, v18
  v_max_f32 v17, v17, v18
  v_mfma_f32_16x16x32_bf16 v[76:79], a[144:147], v[48:51], v[76:79]
  ds_read_b128 v[32:35], v8 offset:26624
  v_mov_b32 v18, v17
  v_mfma_f32_16x16x32_bf16 v[80:83], a[148:151], v[48:51], v[80:83]
  v_permlane16_swap_b32 v17, v18
  v_max_f32 v17, v17, v18
  v_mfma_f32_16x16x32_bf16 v[84:87], a[152:155], v[48:51], v[84:87]
  v_mul_f32 v17, s83, v17
  v_fma_f32 v136, v136, s83, -v17
  v_mfma_f32_16x16x32_bf16 v[88:91], v[48:51], a[156:159], v[88:91]
  s_waitcnt lgkmcnt(3)
  v_fma_f32 v137, v137, s83, -v17
  v_fma_f32 v138, v138, s83, -v17
  v_mfma_f32_16x16x32_bf16 v[76:79], a[160:163], v[52:55], v[76:79]
  ds_read_b128 v[36:39], v7 offset:30720
  v_fma_f32 v139, v139, s83, -v17
  v_mfma_f32_16x16x32_bf16 v[80:83], a[164:167], v[52:55], v[80:83]
  v_exp_f32 v136, v136
  v_mfma_f32_16x16x32_bf16 v[84:87], a[168:171], v[52:55], v[84:87]
  v_exp_f32 v137, v137
  v_mfma_f32_16x16x32_bf16 v[88:91], v[52:55], a[172:175], v[88:91]
  s_waitcnt lgkmcnt(3)
  v_exp_f32 v138, v138
  v_mfma_f32_16x16x32_bf16 v[76:79], a[176:179], v[56:59], v[76:79]
  ds_read_b128 v[40:43], v8 offset:30720
  s_add_u32 s30, s30, 40960
  v_mfma_f32_16x16x32_bf16 v[80:83], a[180:183], v[56:59], v[80:83]
  v_exp_f32 v139, v139
  v_mfma_f32_16x16x32_bf16 v[84:87], a[184:187], v[56:59], v[84:87]
  v_add_f32 v17, v136, v137
  v_add_f32 v18, v138, v139
  v_mfma_f32_16x16x32_bf16 v[88:91], v[56:59], a[188:191], v[88:91]
  s_waitcnt lgkmcnt(3)
  v_add_f32 v17, v17, v18
  v_mov_b32 v18, v17
  v_mfma_f32_16x16x32_bf16 v[76:79], a[192:195], v[28:31], v[76:79]
  ds_read_b128 v[44:47], v7 offset:34816
  v_permlane32_swap_b32 v17, v18
  v_mfma_f32_16x16x32_bf16 v[80:83], a[196:199], v[28:31], v[80:83]
  v_add_f32 v17, v17, v18
  v_mov_b32 v18, v17
  v_mfma_f32_16x16x32_bf16 v[84:87], a[200:203], v[28:31], v[84:87]
  v_permlane16_swap_b32 v17, v18
  v_add_f32 v17, v17, v18
  v_mfma_f32_16x16x32_bf16 v[88:91], v[28:31], a[204:207], v[88:91]
  s_waitcnt lgkmcnt(3)
  v_rcp_f32 v17, v17
  v_mfma_f32_16x16x32_bf16 v[76:79], a[208:211], v[32:35], v[76:79]
  ds_read_b128 v[48:51], v8 offset:34816
  v_mul_f32 v136, v136, v17
  v_mfma_f32_16x16x32_bf16 v[80:83], a[212:215], v[32:35], v[80:83]
  v_mul_f32 v137, v137, v17
  v_mul_f32 v138, v138, v17
  v_mfma_f32_16x16x32_bf16 v[84:87], a[216:219], v[32:35], v[84:87]
  v_mul_f32 v139, v139, v17
  v_cvt_pk_bf16_f32 v144, v136, v137
  v_mfma_f32_16x16x32_bf16 v[88:91], v[32:35], a[220:223], v[88:91]
  s_waitcnt lgkmcnt(3)
  v_cvt_pk_bf16_f32 v145, v138, v139
  v_and_b32 v146, v144, v22
  v_mfma_f32_16x16x32_bf16 v[76:79], a[224:227], v[36:39], v[76:79]
  ds_read_b128 v[52:55], v7 offset:38912
  v_and_b32 v147, v145, v23
  v_mfma_f32_16x16x32_bf16 v[80:83], a[228:231], v[36:39], v[80:83]
  v_and_b32 v144, v144, v20
  v_and_b32 v145, v145, v21
  v_mfma_f32_16x16x32_bf16 v[84:87], a[232:235], v[36:39], v[84:87]
  s_add_u32 s31, s31, 40960
  s_cmp_ge_u32 s31, 122880
  s_cselect_b32 s21, 122880, 0
  v_mfma_f32_16x16x32_bf16 v[88:91], v[36:39], a[236:239], v[88:91]
  s_waitcnt lgkmcnt(3)
  s_sub_u32 s31, s31, s21
  s_add_u32 s33, s33, 40960
  v_mfma_f32_16x16x32_bf16 v[76:79], a[240:243], v[40:43], v[76:79]
  ds_read_b128 v[56:59], v8 offset:38912
  v_mfma_f32_16x16x32_bf16 v[80:83], a[244:247], v[40:43], v[80:83]
  s_cmp_ge_u32 s33, 122880
  s_cselect_b32 s33, 0, s33
  v_mfma_f32_16x16x32_bf16 v[84:87], a[248:251], v[40:43], v[84:87]
  v_add_u32 v7, s33, v5
  v_add_u32 v8, s33, v6
  v_mfma_f32_16x16x32_bf16 v[88:91], v[40:43], a[252:255], v[88:91]
  s_waitcnt lgkmcnt(3)
  v_mfma_f32_16x16x32_bf16 v[76:79], v[192:195], v[44:47], v[76:79]
  s_waitcnt vmcnt(12)
  s_barrier
  ds_read_b128 v[28:31], v7 offset:0
  v_mfma_f32_16x16x32_bf16 v[80:83], v[196:199], v[44:47], v[80:83]
  v_mfma_f32_16x16x32_bf16 v[84:87], v[200:203], v[44:47], v[84:87]
  v_mfma_f32_16x16x32_bf16 v[88:91], v[44:47], v[204:207], v[88:91]
  v_mfma_f32_16x16x32_bf16 v[148:151], v[108:111], v[144:147], 0
  v_mfma_f32_16x16x32_bf16 v[152:155], v[112:115], v[144:147], 0
  s_waitcnt lgkmcnt(3)
  v_mov_b32 v96, v92
  v_mov_b32 v97, v93
  v_mfma_f32_16x16x32_bf16 v[76:79], v[208:211], v[48:51], v[76:79]
  ds_read_b128 v[32:35], v8 offset:0
  v_mov_b32 v98, v94
  v_mfma_f32_16x16x32_bf16 v[80:83], v[212:215], v[48:51], v[80:83]
  v_mov_b32 v99, v95
  v_mov_b32 v110, v108
  v_mfma_f32_16x16x32_bf16 v[84:87], v[216:219], v[48:51], v[84:87]
  v_cvt_pk_bf16_f32 v156, v148, v149
  v_cvt_pk_bf16_f32 v157, v150, v151
  v_mfma_f32_16x16x32_bf16 v[88:91], v[48:51], v[220:223], v[88:91]
  s_waitcnt lgkmcnt(3)
  ds_write_b64 v9, v[156:157] offset:0
  v_cvt_pk_bf16_f32 v158, v152, v153
  v_mfma_f32_16x16x32_bf16 v[76:79], v[224:227], v[52:55], v[76:79]
  ds_read_b128 v[36:39], v7 offset:4096
  v_cvt_pk_bf16_f32 v159, v154, v155
  v_mfma_f32_16x16x32_bf16 v[80:83], v[228:231], v[52:55], v[80:83]
  ds_write_b64 v10, v[158:159] offset:0
  v_mov_b32 v111, v109
  v_mfma_f32_16x16x32_bf16 v[84:87], v[232:235], v[52:55], v[84:87]
  v_mov_b32 v114, v112
  v_mov_b32 v115, v113
  v_mfma_f32_16x16x32_bf16 v[88:91], v[52:55], v[236:239], v[88:91]
  s_waitcnt lgkmcnt(5)
  s_mov_b32 s49, s48
  s_mov_b32 s48, s47
  v_mfma_f32_16x16x32_bf16 v[76:79], v[240:243], v[56:59], v[76:79]
  ds_read_b128 v[40:43], v8 offset:4096
  s_add_u32 s47, s47, 40960
  v_mfma_f32_16x16x32_bf16 v[80:83], v[244:247], v[56:59], v[80:83]
  s_sub_u32 s26, s26, 1
  v_mfma_f32_16x16x32_bf16 v[84:87], v[248:251], v[56:59], v[84:87]
  s_cmp_gt_u32 s26, 0
  v_mfma_f32_16x16x32_bf16 v[88:91], v[56:59], v[252:255], v[88:91]
  s_waitcnt lgkmcnt(5)
  s_cbranch_scc1 bfl_207
  s_nop 7
  v_cvt_pk_bf16_f32 v128, v84, v85
  v_cvt_pk_bf16_f32 v129, v86, v87
  v_cvt_pk_bf16_f32 v124, v76, v77
  v_cvt_pk_bf16_f32 v125, v78, v79
  v_cvt_pk_bf16_f32 v100, v80, v81
  v_cvt_pk_bf16_f32 v101, v82, v83
  v_cvt_pk_bf16_f32 v116, v88, v89
  v_cvt_pk_bf16_f32 v117, v90, v91
  v_cndmask_b32 v126, 0, v128, s[62:63]
  v_cndmask_b32 v127, 0, v129, s[62:63]
  s_nop 1
  v_mfma_f32_16x16x32_bf16 v[132:135], v[128:131], v[24:27], 0
  s_nop 7
  v_permlane16_swap_b32 v128, v102
  v_permlane16_swap_b32 v129, v103
  s_nop 1
  v_mfma_f32_16x16x32_bf16 v[136:139], v[100:103], v[124:127], 0
  v_mfma_f32_16x16x32_bf16 v[140:143], v[104:107], v[124:127], 0
  s_nop 7
  v_cvt_pk_bf16_f32 v120, v132, v133
  v_cvt_pk_bf16_f32 v121, v134, v135
  v_cndmask_b32 v136, v136, v140, s[64:65]
  v_cndmask_b32 v137, v137, v141, s[66:67]
  v_cndmask_b32 v138, v138, v142, s[68:69]
  v_cndmask_b32 v139, v139, v143, s[70:71]
  v_cvt_pk_bf16_f32 v17, v136, v137
  v_lshlrev_b32 v136, 16, v17
  v_and_b32 v137, 0xffff0000, v17
  v_cvt_pk_bf16_f32 v17, v138, v139
  v_lshlrev_b32 v138, 16, v17
  v_and_b32 v139, 0xffff0000, v17
  v_mul_f32 v136, s82, v136
  v_mul_f32 v137, s82, v137
  v_mul_f32 v138, s82, v138
  v_mul_f32 v139, s82, v139
  v_cvt_pk_bf16_f32 v17, v136, v137
  v_lshlrev_b32 v136, 16, v17
  v_and_b32 v137, 0xffff0000, v17
  v_cvt_pk_bf16_f32 v17, v138, v139
  v_lshlrev_b32 v138, 16, v17
  v_and_b32 v139, 0xffff0000, v17
  v_cndmask_b32 v136, v16, v136, s[54:55]
  v_cndmask_b32 v137, v16, v137, s[56:57]
  v_cndmask_b32 v138, v16, v138, s[58:59]
  v_cndmask_b32 v139, v16, v139, s[60:61]
  v_max3_f32 v17, v136, v137, v138
  v_max_f32 v17, v17, v139
  v_mov_b32 v18, v17
  s_nop 1
  v_permlane32_swap_b32 v17, v18
  v_max_f32 v17, v17, v18
  v_mov_b32 v18, v17
  s_nop 1
  v_permlane16_swap_b32 v17, v18
  v_max_f32 v17, v17, v18
  v_mul_f32 v17, s83, v17
  v_fma_f32 v136, v136, s83, -v17
  v_fma_f32 v137, v137, s83, -v17
  v_fma_f32 v138, v138, s83, -v17
  v_fma_f32 v139, v139, s83, -v17
  v_exp_f32 v136, v136
  v_exp_f32 v137, v137
  v_exp_f32 v138, v138
  v_exp_f32 v139, v139
  s_nop 1
  v_add_f32 v17, v136, v137
  v_add_f32 v18, v138, v139
  v_add_f32 v17, v17, v18
  v_mov_b32 v18, v17
  s_nop 1
  v_permlane32_swap_b32 v17, v18
  v_add_f32 v17, v17, v18
  v_mov_b32 v18, v17
  s_nop 1
  v_permlane16_swap_b32 v17, v18
  v_add_f32 v17, v17, v18
  v_rcp_f32 v17, v17
  s_nop 1
  v_mul_f32 v136, v136, v17
  v_mul_f32 v137, v137, v17
  v_mul_f32 v138, v138, v17
  v_mul_f32 v139, v139, v17
  v_cvt_pk_bf16_f32 v144, v136, v137
  v_cvt_pk_bf16_f32 v145, v138, v139
  v_and_b32 v146, v144, v22
  v_and_b32 v147, v145, v23
  v_and_b32 v144, v144, v20
  v_and_b32 v145, v145, v21
  s_nop 1
  v_mfma_f32_16x16x32_bf16 v[148:151], v[116:119], v[144:147], 0
  v_mfma_f32_16x16x32_bf16 v[152:155], v[120:123], v[144:147], 0
  s_nop 7
  v_mov_b32 v104, v100
  v_mov_b32 v105, v101
  v_mov_b32 v106, v102
  v_mov_b32 v107, v103
  v_mov_b32 v118, v116
  v_mov_b32 v119, v117
  v_mov_b32 v122, v120
  v_mov_b32 v123, v121
  v_cvt_pk_bf16_f32 v156, v148, v149
  v_cvt_pk_bf16_f32 v157, v150, v151
  ds_write_b64 v9, v[156:157] offset:16
  v_cvt_pk_bf16_f32 v158, v152, v153
  v_cvt_pk_bf16_f32 v159, v154, v155
  ds_write_b64 v10, v[158:159] offset:8
  s_waitcnt lgkmcnt(0)
  s_barrier
  ds_read_b128 v[160:163], v11
  ds_read_b128 v[164:167], v12
  s_waitcnt lgkmcnt(0)
  buffer_store_dwordx4 v[160:163], v15, s[16:19], s49 offen sc1
  buffer_store_dwordx4 v[164:167], v14, s[16:19], s49 offen sc1
  s_load_dwordx2 s[32:33], s[0:1], 96
  s_waitcnt lgkmcnt(0)
  s_mov_b32 s32, s32
  s_mov_b32 s33, s33
  s_mov_b32 s34, 256
  s_mov_b32 s35, 0x00020000
  s_mov_b32 s21, 76
  s_cmp_lg_u32 s20, 0
  s_cbranch_scc1 wf_209
  v_mov_b32 v4, 0
  s_mov_b32 s101, 0
wf_208:
  buffer_load_dword v5, v4, s[32:35], s21 offen sc1
  s_add_u32 s101, s101, 1
  s_cmp_gt_u32 s101, 131072
  s_cbranch_scc1 main_end
  s_waitcnt vmcnt(0)
  v_readfirstlane_b32 s100, v5
  s_cmp_ge_u32 s100, 1
  s_cbranch_scc1 wf_209
  s_sleep 8
  s_branch wf_208
wf_209:
  s_barrier
  s_waitcnt vmcnt(0)
  s_barrier
  s_lshl_b32 s21, s42, 7
  s_add_u32 s21, s21, 88064
  s_cmp_lg_u32 s20, 0
  s_cbranch_scc1 af_210
  v_mov_b32 v8, 0
  v_mov_b32 v9, 1
  s_mov_b64 exec, 1
  buffer_atomic_add v9, v8, s[72:75], s21 offen sc1
  s_mov_b64 exec, -1
  s_nop 1
af_210:
  s_barrier
  s_sub_u32 s2, s3, 96
  s_load_dwordx2 s[4:5], s[0:1], 0
  s_load_dwordx2 s[6:7], s[0:1], 16
  s_load_dwordx2 s[38:39], s[0:1], 104
  s_mov_b32 s42, s2
  s_waitcnt lgkmcnt(0)
  s_mov_b32 s8, s4
  s_mov_b32 s9, s5
  s_mov_b32 s10, 2621440
  s_mov_b32 s11, 0x00020000
  s_mov_b32 s12, s6
  s_mov_b32 s13, s7
  s_mov_b32 s14, 7864320
  s_mov_b32 s15, 0x00020000
  s_mov_b32 s16, s38
  s_mov_b32 s17, s39
  s_mov_b32 s18, 25165824
  s_mov_b32 s19, 0x00020000
  s_add_u32 s52, s38, 50331648
  s_addc_u32 s53, s39, 0
  s_mov_b32 s54, 6291456
  s_mov_b32 s55, 0x00020000
  s_add_u32 s56, s38, 85983232
  s_addc_u32 s57, s39, 0
  s_mov_b32 s58, 5242880
  s_mov_b32 s59, 0x00020000
  s_add_u32 s72, s38, 81068032
  s_addc_u32 s73, s39, 0
  s_mov_b32 s74, 96768
  s_mov_b32 s75, 0x00020000
  s_mul_i32 s44, s42, 384
  v_mov_b32 v9, 2731
  v_add_u32 v8, 0, v1
  v_mul_u32_u24 v7, v8, v9
  v_lshrrev_b32 v7, 16, v7
  v_mul_u32_u24 v4, 24, v7
  v_sub_u32 v8, v8, v4
  s_mov_b32 s21, 12288
  v_mul_lo_u32 v7, v7, s21
  v_lshl_add_u32 v4, v8, 4, v7
  v_add_u32 v8, 64, v1
  v_mul_u32_u24 v7, v8, v9
  v_lshrrev_b32 v7, 16, v7
  v_mul_u32_u24 v5, 24, v7
  v_sub_u32 v8, v8, v5
  s_mov_b32 s21, 12288
  v_mul_lo_u32 v7, v7, s21
  v_lshl_add_u32 v5, v8, 4, v7
  v_add_u32 v8, 128, v1
  v_mul_u32_u24 v7, v8, v9
  v_lshrrev_b32 v7, 16, v7
  v_mul_u32_u24 v6, 24, v7
  v_sub_u32 v8, v8, v6
  s_mov_b32 s21, 12288
  v_mul_lo_u32 v7, v7, s21
  v_lshl_add_u32 v6, v8, 4, v7
  v_lshrrev_b32 v7, 2, v2
  v_lshl_add_u32 v7, v3, 3, v7
  v_mul_u32_u24 v7, 384, v7
  v_and_b32 v8, 3, v2
  v_lshlrev_b32 v8, 3, v8
  s_mul_i32 s21, s20, 96
  v_add3_u32 v7, v7, v8, s21
  v_add_u32 v8, 61440, v7
  s_mul_i32 s21, s20, 491520
  s_add_u32 s21, s21, 0
  s_add_u32 s21, s21, s44
  s_mul_i32 s22, s20, 15360
  s_add_u32 s22, s22, 0
  s_add_u32 m0, s22, 0
  s_nop 0
  buffer_load_dwordx4 v4, s[12:15], s21 offen lds
  s_add_u32 m0, s22, 1024
  s_nop 0
  buffer_load_dwordx4 v5, s[12:15], s21 offen lds
  s_add_u32 m0, s22, 2048
  s_nop 0
  buffer_load_dwordx4 v6, s[12:15], s21 offen lds
  s_mul_i32 s21, s20, 491520
  s_add_u32 s21, s21, 98304
  s_add_u32 s21, s21, s44
  s_mul_i32 s22, s20, 15360
  s_add_u32 s22, s22, 3072
  s_add_u32 m0, s22, 0
  s_nop 0
  buffer_load_dwordx4 v4, s[12:15], s21 offen lds
  s_add_u32 m0, s22, 1024
  s_nop 0
  buffer_load_dwordx4 v5, s[12:15], s21 offen lds
  s_add_u32 m0, s22, 2048
  s_nop 0
  buffer_load_dwordx4 v6, s[12:15], s21 offen lds
  s_mul_i32 s21, s20, 491520
  s_add_u32 s21, s21, 196608
  s_add_u32 s21, s21, s44
  s_mul_i32 s22, s20, 15360
  s_add_u32 s22, s22, 6144
  s_add_u32 m0, s22, 0
  s_nop 0
  buffer_load_dwordx4 v4, s[12:15], s21 offen lds
  s_add_u32 m0, s22, 1024
  s_nop 0
  buffer_load_dwordx4 v5, s[12:15], s21 offen lds
  s_add_u32 m0, s22, 2048
  s_nop 0
  buffer_load_dwordx4 v6, s[12:15], s21 offen lds
  s_mul_i32 s21, s20, 491520
  s_add_u32 s21, s21, 294912
  s_add_u32 s21, s21, s44
  s_mul_i32 s22, s20, 15360
  s_add_u32 s22, s22, 9216
  s_add_u32 m0, s22, 0
  s_nop 0
  buffer_load_dwordx4 v4, s[12:15], s21 offen lds
  s_add_u32 m0, s22, 1024
  s_nop 0
  buffer_load_dwordx4 v5, s[12:15], s21 offen lds
  s_add_u32 m0, s22, 2048
  s_nop 0
  buffer_load_dwordx4 v6, s[12:15], s21 offen lds
  s_mul_i32 s21, s20, 491520
  s_add_u32 s21, s21, 393216
  s_add_u32 s21, s21, s44
  s_mul_i32 s22, s20, 15360
  s_add_u32 s22, s22, 12288
  s_add_u32 m0, s22, 0
  s_nop 0
  buffer_load_dwordx4 v4, s[12:15], s21 offen lds
  s_add_u32 m0, s22, 1024
  s_nop 0
  buffer_load_dwordx4 v5, s[12:15], s21 offen lds
  s_add_u32 m0, s22, 2048
  s_nop 0
  buffer_load_dwordx4 v6, s[12:15], s21 offen lds
  s_mul_i32 s21, s20, 491520
  s_add_u32 s21, s21, 1966080
  s_add_u32 s21, s21, s44
  s_mul_i32 s22, s20, 15360
  s_add_u32 s22, s22, 61440
  s_add_u32 m0, s22, 0
  s_nop 0
  buffer_load_dwordx4 v4, s[12:15], s21 offen lds
  s_add_u32 m0, s22, 1024
  s_nop 0
  buffer_load_dwordx4 v5, s[12:15], s21 offen lds
  s_add_u32 m0, s22, 2048
  s_nop 0
  buffer_load_dwordx4 v6, s[12:15], s21 offen lds
  s_mul_i32 s21, s20, 491520
  s_add_u32 s21, s21, 2064384
  s_add_u32 s21, s21, s44
  s_mul_i32 s22, s20, 15360
  s_add_u32 s22, s22, 64512
  s_add_u32 m0, s22, 0
  s_nop 0
  buffer_load_dwordx4 v4, s[12:15], s21 offen lds
  s_add_u32 m0, s22, 1024
  s_nop 0
  buffer_load_dwordx4 v5, s[12:15], s21 offen lds
  s_add_u32 m0, s22, 2048
  s_nop 0
  buffer_load_dwordx4 v6, s[12:15], s21 offen lds
  s_mul_i32 s21, s20, 491520
  s_add_u32 s21, s21, 2162688
  s_add_u32 s21, s21, s44
  s_mul_i32 s22, s20, 15360
  s_add_u32 s22, s22, 67584
  s_add_u32 m0, s22, 0
  s_nop 0
  buffer_load_dwordx4 v4, s[12:15], s21 offen lds
  s_add_u32 m0, s22, 1024
  s_nop 0
  buffer_load_dwordx4 v5, s[12:15], s21 offen lds
  s_add_u32 m0, s22, 2048
  s_nop 0
  buffer_load_dwordx4 v6, s[12:15], s21 offen lds
  s_mul_i32 s21, s20, 491520
  s_add_u32 s21, s21, 2260992
  s_add_u32 s21, s21, s44
  s_mul_i32 s22, s20, 15360
  s_add_u32 s22, s22, 70656
  s_add_u32 m0, s22, 0
  s_nop 0
  buffer_load_dwordx4 v4, s[12:15], s21 offen lds
  s_add_u32 m0, s22, 1024
  s_nop 0
  buffer_load_dwordx4 v5, s[12:15], s21 offen lds
  s_add_u32 m0, s22, 2048
  s_nop 0
  buffer_load_dwordx4 v6, s[12:15], s21 offen lds
  s_mul_i32 s21, s20, 491520
  s_add_u32 s21, s21, 2359296
  s_add_u32 s21, s21, s44
  s_mul_i32 s22, s20, 15360
  s_add_u32 s22, s22, 73728
  s_add_u32 m0, s22, 0
  s_nop 0
  buffer_load_dwordx4 v4, s[12:15], s21 offen lds
  s_add_u32 m0, s22, 1024
  s_nop 0
  buffer_load_dwordx4 v5, s[12:15], s21 offen lds
  s_add_u32 m0, s22, 2048
  s_nop 0
  buffer_load_dwordx4 v6, s[12:15], s21 offen lds
  s_mul_i32 s21, s20, 491520
  s_add_u32 s21, s21, 3932160
  s_add_u32 s21, s21, s44
  buffer_load_dwordx4 v[64:67], v4, s[12:15], s21 offen
  buffer_load_dwordx4 v[68:71], v5, s[12:15], s21 offen
  buffer_load_dwordx4 v[72:75], v6, s[12:15], s21 offen
  s_mul_i32 s21, s20, 491520
  s_add_u32 s21, s21, 4030464
  s_add_u32 s21, s21, s44
  buffer_load_dwordx4 v[76:79], v4, s[12:15], s21 offen
  buffer_load_dwordx4 v[80:83], v5, s[12:15], s21 offen
  buffer_load_dwordx4 v[84:87], v6, s[12:15], s21 offen
  s_mul_i32 s21, s20, 491520
  s_add_u32 s21, s21, 4128768
  s_add_u32 s21, s21, s44
  buffer_load_dwordx4 v[88:91], v4, s[12:15], s21 offen
  buffer_load_dwordx4 v[92:95], v5, s[12:15], s21 offen
  buffer_load_dwordx4 v[96:99], v6, s[12:15], s21 offen
  s_mul_i32 s21, s20, 491520
  s_add_u32 s21, s21, 4227072
  s_add_u32 s21, s21, s44
  buffer_load_dwordx4 v[100:103], v4, s[12:15], s21 offen
  buffer_load_dwordx4 v[104:107], v5, s[12:15], s21 offen
  buffer_load_dwordx4 v[108:111], v6, s[12:15], s21 offen
  s_mul_i32 s21, s20, 491520
  s_add_u32 s21, s21, 4325376
  s_add_u32 s21, s21, s44
  buffer_load_dwordx4 v[112:115], v4, s[12:15], s21 offen
  buffer_load_dwordx4 v[116:119], v5, s[12:15], s21 offen
  buffer_load_dwordx4 v[120:123], v6, s[12:15], s21 offen
  s_mul_i32 s21, s20, 491520
  s_add_u32 s21, s21, 5898240
  s_add_u32 s21, s21, s44
  buffer_load_dwordx4 v[124:127], v4, s[12:15], s21 offen
  buffer_load_dwordx4 v[128:131], v5, s[12:15], s21 offen
  buffer_load_dwordx4 v[132:135], v6, s[12:15], s21 offen
  s_mul_i32 s21, s20, 491520
  s_add_u32 s21, s21, 5996544
  s_add_u32 s21, s21, s44
  buffer_load_dwordx4 v[136:139], v4, s[12:15], s21 offen
  buffer_load_dwordx4 v[140:143], v5, s[12:15], s21 offen
  buffer_load_dwordx4 v[144:147], v6, s[12:15], s21 offen
  s_mul_i32 s21, s20, 491520
  s_add_u32 s21, s21, 6094848
  s_add_u32 s21, s21, s44
  buffer_load_dwordx4 v[148:151], v4, s[12:15], s21 offen
  buffer_load_dwordx4 v[152:155], v5, s[12:15], s21 offen
  buffer_load_dwordx4 v[156:159], v6, s[12:15], s21 offen
  s_mul_i32 s21, s20, 491520
  s_add_u32 s21, s21, 6193152
  s_add_u32 s21, s21, s44
  buffer_load_dwordx4 v[160:163], v4, s[12:15], s21 offen
  buffer_load_dwordx4 v[164:167], v5, s[12:15], s21 offen
  buffer_load_dwordx4 v[168:171], v6, s[12:15], s21 offen
  s_mul_i32 s21, s20, 491520
  s_add_u32 s21, s21, 6291456
  s_add_u32 s21, s21, s44
  buffer_load_dwordx4 v[172:175], v4, s[12:15], s21 offen
  buffer_load_dwordx4 v[176:179], v5, s[12:15], s21 offen
  buffer_load_dwordx4 v[180:183], v6, s[12:15], s21 offen
  s_mul_i32 s22, s20, 15360
  v_lshl_add_u32 v30, v1, 4, s22
  v_add_u32 v31, 61440, v30
  s_waitcnt vmcnt(45)
  s_barrier
  ds_read_b64_tr_b16 a[0:1], v7 offset:0
  ds_read_b64_tr_b16 a[2:3], v7 offset:1536
  ds_read_b64_tr_b16 a[4:5], v7 offset:32
  ds_read_b64_tr_b16 a[6:7], v7 offset:1568
  ds_read_b64_tr_b16 a[8:9], v7 offset:64
  ds_read_b64_tr_b16 a[10:11], v7 offset:1600
  ds_read_b64_tr_b16 a[12:13], v7 offset:12288
  ds_read_b64_tr_b16 a[14:15], v7 offset:13824
  ds_read_b64_tr_b16 a[16:17], v7 offset:12320
  ds_read_b64_tr_b16 a[18:19], v7 offset:13856
  ds_read_b64_tr_b16 a[20:21], v7 offset:12352
  ds_read_b64_tr_b16 a[22:23], v7 offset:13888
  ds_read_b64_tr_b16 a[24:25], v7 offset:24576
  ds_read_b64_tr_b16 a[26:27], v7 offset:26112
  ds_read_b64_tr_b16 a[28:29], v7 offset:24608
  ds_read_b64_tr_b16 a[30:31], v7 offset:26144
  ds_read_b64_tr_b16 a[32:33], v7 offset:24640
  ds_read_b64_tr_b16 a[34:35], v7 offset:26176
  ds_read_b64_tr_b16 a[36:37], v7 offset:36864
  ds_read_b64_tr_b16 a[38:39], v7 offset:38400
  ds_read_b64_tr_b16 a[40:41], v7 offset:36896
  ds_read_b64_tr_b16 a[42:43], v7 offset:38432
  ds_read_b64_tr_b16 a[44:45], v7 offset:36928
  ds_read_b64_tr_b16 a[46:47], v7 offset:38464
  ds_read_b64_tr_b16 a[48:49], v7 offset:49152
  ds_read_b64_tr_b16 a[50:51], v7 offset:50688
  ds_read_b64_tr_b16 a[52:53], v7 offset:49184
  ds_read_b64_tr_b16 a[54:55], v7 offset:50720
  ds_read_b64_tr_b16 a[56:57], v7 offset:49216
  ds_read_b64_tr_b16 a[58:59], v7 offset:50752
  s_waitcnt lgkmcnt(0)
  s_barrier
  s_waitcnt vmcnt(30)
  s_barrier
  ds_read_b64_tr_b16 a[60:61], v8 offset:0
  ds_read_b64_tr_b16 a[62:63], v8 offset:1536
  ds_read_b64_tr_b16 a[64:65], v8 offset:32
  ds_read_b64_tr_b16 a[66:67], v8 offset:1568
  ds_read_b64_tr_b16 a[68:69], v8 offset:64
  ds_read_b64_tr_b16 a[70:71], v8 offset:1600
  ds_read_b64_tr_b16 a[72:73], v8 offset:12288
  ds_read_b64_tr_b16 a[74:75], v8 offset:13824
  ds_read_b64_tr_b16 a[76:77], v8 offset:12320
  ds_read_b64_tr_b16 a[78:79], v8 offset:13856
  ds_read_b64_tr_b16 a[80:81], v8 offset:12352
  ds_read_b64_tr_b16 a[82:83], v8 offset:13888
  ds_read_b64_tr_b16 a[84:85], v8 offset:24576
  ds_read_b64_tr_b16 a[86:87], v8 offset:26112
  ds_read_b64_tr_b16 a[88:89], v8 offset:24608
  ds_read_b64_tr_b16 a[90:91], v8 offset:26144
  ds_read_b64_tr_b16 a[92:93], v8 offset:24640
  ds_read_b64_tr_b16 a[94:95], v8 offset:26176
  ds_read_b64_tr_b16 a[96:97], v8 offset:36864
  ds_read_b64_tr_b16 a[98:99], v8 offset:38400
  ds_read_b64_tr_b16 a[100:101], v8 offset:36896
  ds_read_b64_tr_b16 a[102:103], v8 offset:38432
  ds_read_b64_tr_b16 a[104:105], v8 offset:36928
  ds_read_b64_tr_b16 a[106:107], v8 offset:38464
  ds_read_b64_tr_b16 a[108:109], v8 offset:49152
  ds_read_b64_tr_b16 a[110:111], v8 offset:50688
  ds_read_b64_tr_b16 a[112:113], v8 offset:49184
  ds_read_b64_tr_b16 a[114:115], v8 offset:50720
  ds_read_b64_tr_b16 a[116:117], v8 offset:49216
  ds_read_b64_tr_b16 a[118:119], v8 offset:50752
  s_waitcnt lgkmcnt(0)
  s_barrier
  s_waitcnt vmcnt(15)
  ds_write_b128 v30, v[64:67] offset:0
  ds_write_b128 v30, v[68:71] offset:1024
  ds_write_b128 v30, v[72:75] offset:2048
  ds_write_b128 v30, v[76:79] offset:3072
  ds_write_b128 v30, v[80:83] offset:4096
  ds_write_b128 v30, v[84:87] offset:5120
  ds_write_b128 v30, v[88:91] offset:6144
  ds_write_b128 v30, v[92:95] offset:7168
  ds_write_b128 v30, v[96:99] offset:8192
  ds_write_b128 v30, v[100:103] offset:9216
  ds_write_b128 v30, v[104:107] offset:10240
  ds_write_b128 v30, v[108:111] offset:11264
  ds_write_b128 v30, v[112:115] offset:12288
  ds_write_b128 v30, v[116:119] offset:13312
  ds_write_b128 v30, v[120:123] offset:14336
  s_waitcnt lgkmcnt(0)
  s_barrier
  ds_read_b64_tr_b16 a[120:121], v7 offset:0
  ds_read_b64_tr_b16 a[122:123], v7 offset:1536
  ds_read_b64_tr_b16 a[124:125], v7 offset:32
  ds_read_b64_tr_b16 a[126:127], v7 offset:1568
  ds_read_b64_tr_b16 a[128:129], v7 offset:64
  ds_read_b64_tr_b16 a[130:131], v7 offset:1600
  ds_read_b64_tr_b16 a[132:133], v7 offset:12288
  ds_read_b64_tr_b16 a[134:135], v7 offset:13824
  ds_read_b64_tr_b16 a[136:137], v7 offset:12320
  ds_read_b64_tr_b16 a[138:139], v7 offset:13856
  ds_read_b64_tr_b16 a[140:141], v7 offset:12352
  ds_read_b64_tr_b16 a[142:143], v7 offset:13888
  ds_read_b64_tr_b16 a[144:145], v7 offset:24576
  ds_read_b64_tr_b16 a[146:147], v7 offset:26112
  ds_read_b64_tr_b16 a[148:149], v7 offset:24608
  ds_read_b64_tr_b16 a[150:151], v7 offset:26144
  ds_read_b64_tr_b16 a[152:153], v7 offset:24640
  ds_read_b64_tr_b16 a[154:155], v7 offset:26176
  ds_read_b64_tr_b16 a[156:157], v7 offset:36864
  ds_read_b64_tr_b16 a[158:159], v7 offset:38400
  ds_read_b64_tr_b16 a[160:161], v7 offset:36896
  ds_read_b64_tr_b16 a[162:163], v7 offset:38432
  ds_read_b64_tr_b16 a[164:165], v7 offset:36928
  ds_read_b64_tr_b16 a[166:167], v7 offset:38464
  ds_read_b64_tr_b16 a[168:169], v7 offset:49152
  ds_read_b64_tr_b16 a[170:171], v7 offset:50688
  ds_read_b64_tr_b16 a[172:173], v7 offset:49184
  ds_read_b64_tr_b16 a[174:175], v7 offset:50720
  ds_read_b64_tr_b16 a[176:177], v7 offset:49216
  ds_read_b64_tr_b16 a[178:179], v7 offset:50752
  s_waitcnt lgkmcnt(0)
  s_barrier
  s_waitcnt vmcnt(0)
  ds_write_b128 v31, v[124:127] offset:0
  ds_write_b128 v31, v[128:131] offset:1024
  ds_write_b128 v31, v[132:135] offset:2048
  ds_write_b128 v31, v[136:139] offset:3072
  ds_write_b128 v31, v[140:143] offset:4096
  ds_write_b128 v31, v[144:147] offset:5120
  ds_write_b128 v31, v[148:151] offset:6144
  ds_write_b128 v31, v[152:155] offset:7168
  ds_write_b128 v31, v[156:159] offset:8192
  ds_write_b128 v31, v[160:163] offset:9216
  ds_write_b128 v31, v[164:167] offset:10240
  ds_write_b128 v31, v[168:171] offset:11264
  ds_write_b128 v31, v[172:175] offset:12288
  ds_write_b128 v31, v[176:179] offset:13312
  ds_write_b128 v31, v[180:183] offset:14336
  s_waitcnt lgkmcnt(0)
  s_barrier
  ds_read_b64_tr_b16 a[180:181], v8 offset:0
  ds_read_b64_tr_b16 a[182:183], v8 offset:1536
  ds_read_b64_tr_b16 a[184:185], v8 offset:32
  ds_read_b64_tr_b16 a[186:187], v8 offset:1568
  ds_read_b64_tr_b16 a[188:189], v8 offset:64
  ds_read_b64_tr_b16 a[190:191], v8 offset:1600
  ds_read_b64_tr_b16 a[192:193], v8 offset:12288
  ds_read_b64_tr_b16 a[194:195], v8 offset:13824
  ds_read_b64_tr_b16 a[196:197], v8 offset:12320
  ds_read_b64_tr_b16 a[198:199], v8 offset:13856
  ds_read_b64_tr_b16 a[200:201], v8 offset:12352
  ds_read_b64_tr_b16 a[202:203], v8 offset:13888
  ds_read_b64_tr_b16 a[204:205], v8 offset:24576
  ds_read_b64_tr_b16 a[206:207], v8 offset:26112
  ds_read_b64_tr_b16 a[208:209], v8 offset:24608
  ds_read_b64_tr_b16 a[210:211], v8 offset:26144
  ds_read_b64_tr_b16 a[212:213], v8 offset:24640
  ds_read_b64_tr_b16 a[214:215], v8 offset:26176
  ds_read_b64_tr_b16 a[216:217], v8 offset:36864
  ds_read_b64_tr_b16 a[218:219], v8 offset:38400
  ds_read_b64_tr_b16 a[220:221], v8 offset:36896
  ds_read_b64_tr_b16 a[222:223], v8 offset:38432
  ds_read_b64_tr_b16 a[224:225], v8 offset:36928
  ds_read_b64_tr_b16 a[226:227], v8 offset:38464
  ds_read_b64_tr_b16 a[228:229], v8 offset:49152
  ds_read_b64_tr_b16 a[230:231], v8 offset:50688
  ds_read_b64_tr_b16 a[232:233], v8 offset:49184
  ds_read_b64_tr_b16 a[234:235], v8 offset:50720
  ds_read_b64_tr_b16 a[236:237], v8 offset:49216
  ds_read_b64_tr_b16 a[238:239], v8 offset:50752
  s_waitcnt lgkmcnt(0)
  s_barrier
  s_mov_b32 s30, 0
  s_mov_b32 s25, 162688
  s_mov_b32 s26, 16
  v_lshrrev_b32 v4, 3, v1
  v_and_b32 v5, 7, v1
  v_xor_b32 v5, v5, v4
  s_mul_i32 s21, s20, 32
  v_add_u32 v4, s21, v4
  v_mul_u32_u24 v4, 1280, v4
  v_lshl_add_u32 v10, v5, 4, v4
  s_mul_i32 s31, s20, 4096
  v_add_u32 v11, 10240, v10
  v_add_u32 v12, 20480, v10
  v_add_u32 v13, 30720, v10
  s_add_u32 m0, s31, 0
  s_nop 0
  buffer_load_dwordx4 v10, s[8:11], s30 offen lds
  s_add_u32 m0, s31, 1024
  s_nop 0
  buffer_load_dwordx4 v11, s[8:11], s30 offen lds
  s_add_u32 m0, s31, 2048
  s_nop 0
  buffer_load_dwordx4 v12, s[8:11], s30 offen lds
  s_add_u32 m0, s31, 3072
  s_nop 0
  buffer_load_dwordx4 v13, s[8:11], s30 offen lds
  s_add_u32 s30, s30, 128
  s_add_u32 m0, s31, 16384
  s_nop 0
  buffer_load_dwordx4 v10, s[8:11], s30 offen lds
  s_add_u32 m0, s31, 17408
  s_nop 0
  buffer_load_dwordx4 v11, s[8:11], s30 offen lds
  s_add_u32 m0, s31, 18432
  s_nop 0
  buffer_load_dwordx4 v12, s[8:11], s30 offen lds
  s_add_u32 m0, s31, 19456
  s_nop 0
  buffer_load_dwordx4 v13, s[8:11], s30 offen lds
  s_add_u32 s30, s30, 128
  s_add_u32 m0, s31, 32768
  s_nop 0
  buffer_load_dwordx4 v10, s[8:11], s30 offen lds
  s_add_u32 m0, s31, 33792
  s_nop 0
  buffer_load_dwordx4 v11, s[8:11], s30 offen lds
  s_add_u32 m0, s31, 34816
  s_nop 0
  buffer_load_dwordx4 v12, s[8:11], s30 offen lds
  s_add_u32 m0, s31, 35840
  s_nop 0
  buffer_load_dwordx4 v13, s[8:11], s30 offen lds
  s_add_u32 s30, s30, 128
  v_and_b32 v6, 7, v2
  v_add_u32 v4, 0, v3
  v_xor_b32 v4, v4, v6
  v_lshlrev_b32 v4, 4, v4
  v_lshl_add_u32 v14, v2, 7, v4
  v_add_u32 v16, 65536, v14
  v_add_u32 v18, 131072, v14
  v_add_u32 v4, 4, v3
  v_xor_b32 v4, v4, v6
  v_lshlrev_b32 v4, 4, v4
  v_lshl_add_u32 v15, v2, 7, v4
  v_add_u32 v17, 65536, v15
  v_add_u32 v19, 131072, v15
  v_lshlrev_b32 v26, 4, v1
  v_mov_b32 v28, 1
  v_mov_b32 v4, 0x40000000
  v_cmp_eq_u32 vcc, 0, v0
  s_nop 1
  v_cndmask_b32 v27, v4, 0, vcc
  s_mul_i32 s21, s20, 3072
  s_add_u32 s21, s21, 81920
  v_add_u32 v20, s21, v26
  s_mul_i32 s21, s20, 12288
  s_add_u32 s21, s21, 81920
  v_add_u32 v21, s21, v26
  v_add_u32 v22, 2048, v21
  v_add_u32 v23, 2056, v21
  v_and_b32 v4, 7, v2
  v_lshlrev_b32 v4, 4, v4
  v_lshl_add_u32 v24, v3, 7, v4
  v_lshrrev_b32 v25, 1, v24
  v_lshlrev_b32 v29, 3, v1
  v_and_b32 v4, 3, v1
  v_lshlrev_b32 v30, 3, v4
  v_mov_b32 v31, 0xf149f2ca
  v_mov_b32 v32, 0
  v_mov_b32 v4, 1073741824
  v_cmp_eq_u32 vcc, 0, v1
  v_lshlrev_b32 v5, 2, v3
  v_sub_u32 v5, v2, v5
  v_cndmask_b32 v33, v4, 0, vcc
  v_cmp_gt_u32 s[62:63], 2, v3
  s_mov_b32 s83, 0x3dd53b95
  s_lshl_b32 s77, s42, 7
  s_add_u32 s77, s77, 18432
  s_lshl_b32 s21, s20, 5
  s_add_u32 s21, s21, s42
  s_mul_i32 s45, s21, 12288
  s_mul_i32 s46, s21, 3072
  s_mul_i32 s47, s21, 2560
  s_lshl_b32 s48, s20, 3
  s_and_b32 s21, s42, 7
  s_add_u32 s48, s48, s21
  s_lshl_b32 s48, s48, 7
  s_add_u32 s48, s48, 22528
  s_add_u32 s43, s20, 1
  s_mov_b32 s49, 0
  s_mov_b32 s50, 1073741824
  s_mov_b32 s51, 1073741824
  s_mov_b32 s81, 1073741824
  s_mov_b32 s82, 1073741824
  v_cmp_le_i32 s[64:65], 0, v5
  v_cmp_le_i32 s[66:67], 1, v5
  v_cmp_le_i32 s[68:69], 2, v5
  v_cmp_le_i32 s[70:71], 3, v5
  s_waitcnt vmcnt(8)
  s_barrier
  ds_read_b128 v[160:163], v14 offset:0
  ds_read_b128 v[164:167], v14 offset:2048
  ds_read_b128 v[168:171], v14 offset:4096
  ds_read_b128 v[172:175], v14 offset:6144
  s_waitcnt lgkmcnt(3)
  .p2align 3
qa_211:
  v_mfma_f32_16x16x32_bf16 v[64:67], a[0:3], v[160:163], 0
  ds_read_b128 v[176:179], v14 offset:8192
  v_cvt_pk_bf16_f32 v221, v126, v127
  v_mfma_f32_16x16x32_bf16 v[68:71], a[4:7], v[160:163], 0
  v_cvt_pk_bf16_f32 v222, v128, v129
  v_cvt_pk_bf16_f32 v223, v130, v131
  v_mfma_f32_16x16x32_bf16 v[72:75], a[8:11], v[160:163], 0
  s_waitcnt lgkmcnt(3)
  v_cvt_pk_bf16_f32 v226, v132, v133
  v_cvt_pk_bf16_f32 v227, v134, v135
  v_mfma_f32_16x16x32_bf16 v[76:79], a[0:3], v[164:167], 0
  ds_read_b128 v[180:183], v14 offset:10240
  v_cvt_pk_bf16_f32 v228, v136, v137
  v_mfma_f32_16x16x32_bf16 v[80:83], a[4:7], v[164:167], 0
  v_cvt_pk_bf16_f32 v229, v138, v139
  v_cvt_pk_bf16_f32 v230, v140, v141
  v_mfma_f32_16x16x32_bf16 v[84:87], a[8:11], v[164:167], 0
  s_waitcnt lgkmcnt(3)
  v_cvt_pk_bf16_f32 v231, v142, v143
  v_cvt_pk_bf16_f32 v236, v144, v145
  v_mfma_f32_16x16x32_bf16 v[88:91], a[0:3], v[168:171], 0
  ds_read_b128 v[184:187], v14 offset:12288
  v_cvt_pk_bf16_f32 v237, v146, v147
  v_mfma_f32_16x16x32_bf16 v[92:95], a[4:7], v[168:171], 0
  v_cvt_pk_bf16_f32 v232, v148, v149
  v_cvt_pk_bf16_f32 v233, v150, v151
  v_mfma_f32_16x16x32_bf16 v[96:99], a[8:11], v[168:171], 0
  s_waitcnt lgkmcnt(3)
  v_cvt_pk_bf16_f32 v234, v152, v153
  v_cvt_pk_bf16_f32 v235, v154, v155
  v_mfma_f32_16x16x32_bf16 v[100:103], a[0:3], v[172:175], 0
  ds_read_b128 v[188:191], v14 offset:14336
  v_cvt_pk_bf16_f32 v238, v156, v157
  v_mfma_f32_16x16x32_bf16 v[104:107], a[4:7], v[172:175], 0
  v_cvt_pk_bf16_f32 v239, v158, v159
  ds_write_b128 v20, v[192:195] offset:0
  v_mfma_f32_16x16x32_bf16 v[108:111], a[8:11], v[172:175], 0
  s_waitcnt lgkmcnt(4)
  v_mfma_f32_16x16x32_bf16 v[112:115], a[0:3], v[176:179], 0
  ds_read_b128 v[160:163], v15 offset:0
  ds_write_b128 v20, v[196:199] offset:1024
  v_mfma_f32_16x16x32_bf16 v[116:119], a[4:7], v[176:179], 0
  s_add_u32 m0, s31, 49152
  v_mfma_f32_16x16x32_bf16 v[120:123], a[8:11], v[176:179], 0
  s_waitcnt lgkmcnt(5)
  buffer_load_dwordx4 v10, s[8:11], s30 offen lds
  ds_write_b128 v20, v[200:203] offset:2048
  v_mfma_f32_16x16x32_bf16 v[124:127], a[0:3], v[180:183], 0
  ds_read_b128 v[164:167], v15 offset:2048
  v_mfma_f32_16x16x32_bf16 v[128:131], a[4:7], v[180:183], 0
  ds_write_b128 v20, v[204:207] offset:12288
  v_mfma_f32_16x16x32_bf16 v[132:135], a[8:11], v[180:183], 0
  s_waitcnt lgkmcnt(7)
  v_mfma_f32_16x16x32_bf16 v[136:139], a[0:3], v[184:187], 0
  ds_read_b128 v[168:171], v15 offset:4096
  ds_write_b128 v20, v[208:211] offset:13312
  v_mfma_f32_16x16x32_bf16 v[140:143], a[4:7], v[184:187], 0
  s_add_u32 m0, s31, 50176
  v_mfma_f32_16x16x32_bf16 v[144:147], a[8:11], v[184:187], 0
  s_waitcnt lgkmcnt(8)
  buffer_load_dwordx4 v11, s[8:11], s30 offen lds
  ds_write_b128 v20, v[212:215] offset:14336
  v_mfma_f32_16x16x32_bf16 v[148:151], a[0:3], v[188:191], 0
  ds_read_b128 v[172:175], v15 offset:6144
  v_mfma_f32_16x16x32_bf16 v[152:155], a[4:7], v[188:191], 0
  ds_write_b128 v20, v[216:219] offset:24576
  v_mfma_f32_16x16x32_bf16 v[156:159], a[8:11], v[188:191], 0
  s_waitcnt lgkmcnt(9)
  v_mfma_f32_16x16x32_bf16 v[64:67], a[12:15], v[160:163], v[64:67]
  ds_read_b128 v[176:179], v15 offset:8192
  ds_write_b128 v20, v[220:223] offset:25600
  v_mfma_f32_16x16x32_bf16 v[68:71], a[16:19], v[160:163], v[68:71]
  s_add_u32 m0, s31, 51200
  v_mfma_f32_16x16x32_bf16 v[72:75], a[20:23], v[160:163], v[72:75]
  s_waitcnt lgkmcnt(8)
  buffer_load_dwordx4 v12, s[8:11], s30 offen lds
  ds_write_b128 v20, v[224:227] offset:26624
  v_mfma_f32_16x16x32_bf16 v[76:79], a[12:15], v[164:167], v[76:79]
  ds_read_b128 v[180:183], v15 offset:10240
  v_mfma_f32_16x16x32_bf16 v[80:83], a[16:19], v[164:167], v[80:83]
  ds_write_b128 v20, v[228:231] offset:36864
  v_mfma_f32_16x16x32_bf16 v[84:87], a[20:23], v[164:167], v[84:87]
  s_waitcnt lgkmcnt(9)
  v_mfma_f32_16x16x32_bf16 v[88:91], a[12:15], v[168:171], v[88:91]
  ds_read_b128 v[184:187], v15 offset:12288
  ds_write_b128 v20, v[232:235] offset:37888
  v_mfma_f32_16x16x32_bf16 v[92:95], a[16:19], v[168:171], v[92:95]
  s_add_u32 m0, s31, 52224
  v_mfma_f32_16x16x32_bf16 v[96:99], a[20:23], v[168:171], v[96:99]
  s_waitcnt lgkmcnt(8)
  buffer_load_dwordx4 v13, s[8:11], s30 offen lds
  ds_write_b128 v20, v[236:239] offset:38912
  v_mfma_f32_16x16x32_bf16 v[100:103], a[12:15], v[172:175], v[100:103]
  s_add_u32 s30, s30, 128
  ds_read_b128 v[188:191], v15 offset:14336
  s_waitcnt vmcnt(8)
  v_mfma_f32_16x16x32_bf16 v[104:107], a[16:19], v[172:175], v[104:107]
  v_cmp_gt_u32 vcc, s49, v32
  v_mfma_f32_16x16x32_bf16 v[108:111], a[20:23], v[172:175], v[108:111]
  s_waitcnt lgkmcnt(8)
  s_cbranch_vccnz qw_212
qj_213:
  s_waitcnt lgkmcnt(1)
  v_mfma_f32_16x16x32_bf16 v[112:115], a[12:15], v[176:179], v[112:115]
  s_waitcnt vmcnt(8)
  s_barrier
  ds_read_b128 v[160:163], v14 offset:16384
  v_mfma_f32_16x16x32_bf16 v[116:119], a[16:19], v[176:179], v[116:119]
  s_add_u32 s29, s50, 0
  buffer_load_dwordx4 v[192:195], v26, s[16:19], s29 offen offset:0 sc1
  v_mfma_f32_16x16x32_bf16 v[120:123], a[20:23], v[176:179], v[120:123]
  s_waitcnt lgkmcnt(6)
  v_mfma_f32_16x16x32_bf16 v[124:127], a[12:15], v[180:183], v[124:127]
  ds_read_b128 v[164:167], v14 offset:18432
  buffer_load_dwordx4 v[196:199], v26, s[16:19], s29 offen offset:1024 sc1
  v_mfma_f32_16x16x32_bf16 v[128:131], a[16:19], v[180:183], v[128:131]
  v_mfma_f32_16x16x32_bf16 v[132:135], a[20:23], v[180:183], v[132:135]
  s_waitcnt lgkmcnt(5)
  buffer_load_dwordx4 v[224:227], v26, s[16:19], s29 offen offset:2048 sc1
  v_mfma_f32_16x16x32_bf16 v[136:139], a[12:15], v[184:187], v[136:139]
  ds_read_b128 v[168:171], v14 offset:20480
  v_mfma_f32_16x16x32_bf16 v[140:143], a[16:19], v[184:187], v[140:143]
  s_add_u32 s29, s50, 3072
  buffer_load_dwordx4 v[200:203], v26, s[16:19], s29 offen offset:0 sc1
  v_mfma_f32_16x16x32_bf16 v[144:147], a[20:23], v[184:187], v[144:147]
  s_waitcnt lgkmcnt(3)
  v_mfma_f32_16x16x32_bf16 v[148:151], a[12:15], v[188:191], v[148:151]
  ds_read_b128 v[172:175], v14 offset:22528
  buffer_load_dwordx4 v[204:207], v26, s[16:19], s29 offen offset:1024 sc1
  v_mfma_f32_16x16x32_bf16 v[152:155], a[16:19], v[188:191], v[152:155]
  v_mfma_f32_16x16x32_bf16 v[156:159], a[20:23], v[188:191], v[156:159]
  s_waitcnt lgkmcnt(3)
  buffer_load_dwordx4 v[228:231], v26, s[16:19], s29 offen offset:2048 sc1
  v_mfma_f32_16x16x32_bf16 v[64:67], a[24:27], v[160:163], v[64:67]
  ds_read_b128 v[176:179], v14 offset:24576
  v_mfma_f32_16x16x32_bf16 v[68:71], a[28:31], v[160:163], v[68:71]
  s_add_u32 m0, s31, 65536
  s_add_u32 s29, s50, 6144
  buffer_load_dwordx4 v[208:211], v26, s[16:19], s29 offen offset:0 sc1
  v_mfma_f32_16x16x32_bf16 v[72:75], a[32:35], v[160:163], v[72:75]
  s_waitcnt lgkmcnt(3)
  buffer_load_dwordx4 v10, s[8:11], s30 offen lds
  v_mfma_f32_16x16x32_bf16 v[76:79], a[24:27], v[164:167], v[76:79]
  ds_read_b128 v[180:183], v14 offset:26624
  buffer_load_dwordx4 v[212:215], v26, s[16:19], s29 offen offset:1024 sc1
  v_mfma_f32_16x16x32_bf16 v[80:83], a[28:31], v[164:167], v[80:83]
  v_mfma_f32_16x16x32_bf16 v[84:87], a[32:35], v[164:167], v[84:87]
  s_waitcnt lgkmcnt(3)
  buffer_load_dwordx4 v[232:235], v26, s[16:19], s29 offen offset:2048 sc1
  v_mfma_f32_16x16x32_bf16 v[88:91], a[24:27], v[168:171], v[88:91]
  ds_read_b128 v[184:187], v14 offset:28672
  v_mfma_f32_16x16x32_bf16 v[92:95], a[28:31], v[168:171], v[92:95]
  s_add_u32 m0, s31, 66560
  s_add_u32 s29, s50, 9216
  buffer_load_dwordx4 v[216:219], v26, s[16:19], s29 offen offset:0 sc1
  v_mfma_f32_16x16x32_bf16 v[96:99], a[32:35], v[168:171], v[96:99]
  s_waitcnt lgkmcnt(3)
  buffer_load_dwordx4 v11, s[8:11], s30 offen lds
  v_mfma_f32_16x16x32_bf16 v[100:103], a[24:27], v[172:175], v[100:103]
  ds_read_b128 v[188:191], v14 offset:30720
  buffer_load_dwordx4 v[220:223], v26, s[16:19], s29 offen offset:1024 sc1
  v_mfma_f32_16x16x32_bf16 v[104:107], a[28:31], v[172:175], v[104:107]
  v_mfma_f32_16x16x32_bf16 v[108:111], a[32:35], v[172:175], v[108:111]
  s_waitcnt lgkmcnt(3)
  buffer_load_dwordx4 v[236:239], v26, s[16:19], s29 offen offset:2048 sc1
  v_mfma_f32_16x16x32_bf16 v[112:115], a[24:27], v[176:179], v[112:115]
  ds_read_b128 v[160:163], v15 offset:16384
  v_mfma_f32_16x16x32_bf16 v[116:119], a[28:31], v[176:179], v[116:119]
  s_add_u32 m0, s31, 67584
  buffer_load_dwordx4 a[240:243], v24, s[52:55], s51 offen offset:0 sc1
  v_mfma_f32_16x16x32_bf16 v[120:123], a[32:35], v[176:179], v[120:123]
  s_waitcnt lgkmcnt(3)
  buffer_load_dwordx4 v12, s[8:11], s30 offen lds
  v_mfma_f32_16x16x32_bf16 v[124:127], a[24:27], v[180:183], v[124:127]
  ds_read_b128 v[164:167], v15 offset:18432
  buffer_load_dwordx2 v[240:241], v25, s[52:55], s51 offen offset:512 sc1
  v_mfma_f32_16x16x32_bf16 v[128:131], a[28:31], v[180:183], v[128:131]
  v_mfma_f32_16x16x32_bf16 v[132:135], a[32:35], v[180:183], v[132:135]
  s_waitcnt lgkmcnt(3)
  buffer_load_dwordx4 a[244:247], v24, s[52:55], s51 offen offset:768 sc1
  v_mfma_f32_16x16x32_bf16 v[136:139], a[24:27], v[184:187], v[136:139]
  ds_read_b128 v[168:171], v15 offset:20480
  v_mfma_f32_16x16x32_bf16 v[140:143], a[28:31], v[184:187], v[140:143]
  s_add_u32 m0, s31, 68608
  buffer_load_dwordx2 v[242:243], v25, s[52:55], s51 offen offset:1280 sc1
  v_mfma_f32_16x16x32_bf16 v[144:147], a[32:35], v[184:187], v[144:147]
  s_waitcnt lgkmcnt(3)
  buffer_load_dwordx4 v13, s[8:11], s30 offen lds
  v_mfma_f32_16x16x32_bf16 v[148:151], a[24:27], v[188:191], v[148:151]
  s_add_u32 s30, s30, 128
  ds_read_b128 v[172:175], v15 offset:22528
  buffer_load_dwordx4 a[248:251], v24, s[52:55], s51 offen offset:1536 sc1
  v_mfma_f32_16x16x32_bf16 v[152:155], a[28:31], v[188:191], v[152:155]
  v_mfma_f32_16x16x32_bf16 v[156:159], a[32:35], v[188:191], v[156:159]
  s_waitcnt lgkmcnt(3)
  buffer_load_dwordx2 v[244:245], v25, s[52:55], s51 offen offset:2048 sc1
  v_mfma_f32_16x16x32_bf16 v[64:67], a[36:39], v[160:163], v[64:67]
  ds_read_b128 v[176:179], v15 offset:24576
  v_mfma_f32_16x16x32_bf16 v[68:71], a[40:43], v[160:163], v[68:71]
  buffer_load_dwordx4 a[252:255], v24, s[52:55], s51 offen offset:2304 sc1
  v_mfma_f32_16x16x32_bf16 v[72:75], a[44:47], v[160:163], v[72:75]
  s_waitcnt lgkmcnt(3)
  v_mfma_f32_16x16x32_bf16 v[76:79], a[36:39], v[164:167], v[76:79]
  ds_read_b128 v[180:183], v15 offset:26624
  buffer_load_dwordx2 v[246:247], v25, s[52:55], s51 offen offset:2816 sc1
  v_mfma_f32_16x16x32_bf16 v[80:83], a[40:43], v[164:167], v[80:83]
  v_mfma_f32_16x16x32_bf16 v[84:87], a[44:47], v[164:167], v[84:87]
  s_waitcnt lgkmcnt(3)
  v_mfma_f32_16x16x32_bf16 v[88:91], a[36:39], v[168:171], v[88:91]
  ds_read_b128 v[184:187], v15 offset:28672
  v_mfma_f32_16x16x32_bf16 v[92:95], a[40:43], v[168:171], v[92:95]
  v_mfma_f32_16x16x32_bf16 v[96:99], a[44:47], v[168:171], v[96:99]
  s_waitcnt lgkmcnt(3)
  v_mfma_f32_16x16x32_bf16 v[100:103], a[36:39], v[172:175], v[100:103]
  ds_read_b128 v[188:191], v15 offset:30720
  v_mfma_f32_16x16x32_bf16 v[104:107], a[40:43], v[172:175], v[104:107]
  v_mfma_f32_16x16x32_bf16 v[108:111], a[44:47], v[172:175], v[108:111]
  s_waitcnt lgkmcnt(3)
  v_mfma_f32_16x16x32_bf16 v[112:115], a[36:39], v[176:179], v[112:115]
  s_waitcnt vmcnt(28)
  s_barrier
  ds_read_b128 v[160:163], v14 offset:32768
  v_mfma_f32_16x16x32_bf16 v[116:119], a[40:43], v[176:179], v[116:119]
  v_mfma_f32_16x16x32_bf16 v[120:123], a[44:47], v[176:179], v[120:123]
  s_waitcnt lgkmcnt(3)
  v_mfma_f32_16x16x32_bf16 v[124:127], a[36:39], v[180:183], v[124:127]
  ds_read_b128 v[164:167], v14 offset:34816
  v_mfma_f32_16x16x32_bf16 v[128:131], a[40:43], v[180:183], v[128:131]
  v_mfma_f32_16x16x32_bf16 v[132:135], a[44:47], v[180:183], v[132:135]
  s_waitcnt lgkmcnt(3)
  v_mfma_f32_16x16x32_bf16 v[136:139], a[36:39], v[184:187], v[136:139]
  ds_read_b128 v[168:171], v14 offset:36864
  v_mfma_f32_16x16x32_bf16 v[140:143], a[40:43], v[184:187], v[140:143]
  v_mfma_f32_16x16x32_bf16 v[144:147], a[44:47], v[184:187], v[144:147]
  s_waitcnt lgkmcnt(3)
  v_mfma_f32_16x16x32_bf16 v[148:151], a[36:39], v[188:191], v[148:151]
  ds_read_b128 v[172:175], v14 offset:38912
  v_mfma_f32_16x16x32_bf16 v[152:155], a[40:43], v[188:191], v[152:155]
  v_mfma_f32_16x16x32_bf16 v[156:159], a[44:47], v[188:191], v[156:159]
  s_waitcnt lgkmcnt(3)
  v_mfma_f32_16x16x32_bf16 v[64:67], a[48:51], v[160:163], v[64:67]
  ds_read_b128 v[176:179], v14 offset:40960
  v_mfma_f32_16x16x32_bf16 v[68:71], a[52:55], v[160:163], v[68:71]
  s_add_u32 m0, s31, 0
  v_mfma_f32_16x16x32_bf16 v[72:75], a[56:59], v[160:163], v[72:75]
  s_waitcnt lgkmcnt(3)
  buffer_load_dwordx4 v10, s[8:11], s30 offen lds
  v_mfma_f32_16x16x32_bf16 v[76:79], a[48:51], v[164:167], v[76:79]
  ds_read_b128 v[180:183], v14 offset:43008
  v_mfma_f32_16x16x32_bf16 v[80:83], a[52:55], v[164:167], v[80:83]
  v_mfma_f32_16x16x32_bf16 v[84:87], a[56:59], v[164:167], v[84:87]
  s_waitcnt lgkmcnt(3)
  v_mfma_f32_16x16x32_bf16 v[88:91], a[48:51], v[168:171], v[88:91]
  ds_read_b128 v[184:187], v14 offset:45056
  v_mfma_f32_16x16x32_bf16 v[92:95], a[52:55], v[168:171], v[92:95]
  s_add_u32 m0, s31, 1024
  v_mfma_f32_16x16x32_bf16 v[96:99], a[56:59], v[168:171], v[96:99]
  s_waitcnt lgkmcnt(3)
  buffer_load_dwordx4 v11, s[8:11], s30 offen lds
  v_mfma_f32_16x16x32_bf16 v[100:103], a[48:51], v[172:175], v[100:103]
  ds_read_b128 v[188:191], v14 offset:47104
  v_mfma_f32_16x16x32_bf16 v[104:107], a[52:55], v[172:175], v[104:107]
  v_mfma_f32_16x16x32_bf16 v[108:111], a[56:59], v[172:175], v[108:111]
  s_waitcnt lgkmcnt(3)
  v_mfma_f32_16x16x32_bf16 v[112:115], a[48:51], v[176:179], v[112:115]
  ds_read_b128 v[160:163], v15 offset:32768
  v_mfma_f32_16x16x32_bf16 v[116:119], a[52:55], v[176:179], v[116:119]
  s_add_u32 m0, s31, 2048
  v_mfma_f32_16x16x32_bf16 v[120:123], a[56:59], v[176:179], v[120:123]
  s_waitcnt lgkmcnt(3)
  buffer_load_dwordx4 v12, s[8:11], s30 offen lds
  v_mfma_f32_16x16x32_bf16 v[124:127], a[48:51], v[180:183], v[124:127]
  ds_read_b128 v[164:167], v15 offset:34816
  v_mfma_f32_16x16x32_bf16 v[128:131], a[52:55], v[180:183], v[128:131]
  v_mfma_f32_16x16x32_bf16 v[132:135], a[56:59], v[180:183], v[132:135]
  s_waitcnt lgkmcnt(3)
  v_mfma_f32_16x16x32_bf16 v[136:139], a[48:51], v[184:187], v[136:139]
  ds_read_b128 v[168:171], v15 offset:36864
  v_mfma_f32_16x16x32_bf16 v[140:143], a[52:55], v[184:187], v[140:143]
  s_add_u32 m0, s31, 3072
  v_mfma_f32_16x16x32_bf16 v[144:147], a[56:59], v[184:187], v[144:147]
  s_waitcnt lgkmcnt(3)
  buffer_load_dwordx4 v13, s[8:11], s30 offen lds
  v_mfma_f32_16x16x32_bf16 v[148:151], a[48:51], v[188:191], v[148:151]
  s_add_u32 s30, s30, 128
  ds_read_b128 v[172:175], v15 offset:38912
  v_mfma_f32_16x16x32_bf16 v[152:155], a[52:55], v[188:191], v[152:155]
  v_mfma_f32_16x16x32_bf16 v[156:159], a[56:59], v[188:191], v[156:159]
  s_waitcnt lgkmcnt(3)
  v_mfma_f32_16x16x32_bf16 v[64:67], a[60:63], v[160:163], v[64:67]
  ds_read_b128 v[176:179], v15 offset:40960
  v_mfma_f32_16x16x32_bf16 v[68:71], a[64:67], v[160:163], v[68:71]
  v_mfma_f32_16x16x32_bf16 v[72:75], a[68:71], v[160:163], v[72:75]
  s_waitcnt lgkmcnt(3)
  v_mfma_f32_16x16x32_bf16 v[76:79], a[60:63], v[164:167], v[76:79]
  ds_read_b128 v[180:183], v15 offset:43008
  v_mfma_f32_16x16x32_bf16 v[80:83], a[64:67], v[164:167], v[80:83]
  v_mfma_f32_16x16x32_bf16 v[84:87], a[68:71], v[164:167], v[84:87]
  s_waitcnt lgkmcnt(3)
  v_mfma_f32_16x16x32_bf16 v[88:91], a[60:63], v[168:171], v[88:91]
  ds_read_b128 v[184:187], v15 offset:45056
  v_mfma_f32_16x16x32_bf16 v[92:95], a[64:67], v[168:171], v[92:95]
  v_mfma_f32_16x16x32_bf16 v[96:99], a[68:71], v[168:171], v[96:99]
  s_waitcnt lgkmcnt(3)
  v_mfma_f32_16x16x32_bf16 v[100:103], a[60:63], v[172:175], v[100:103]
  ds_read_b128 v[188:191], v15 offset:47104
  v_mfma_f32_16x16x32_bf16 v[104:107], a[64:67], v[172:175], v[104:107]
  v_mfma_f32_16x16x32_bf16 v[108:111], a[68:71], v[172:175], v[108:111]
  s_waitcnt lgkmcnt(3)
  v_mfma_f32_16x16x32_bf16 v[112:115], a[60:63], v[176:179], v[112:115]
  s_waitcnt vmcnt(28)
  s_barrier
  ds_read_b128 v[160:163], v14 offset:49152
  v_mfma_f32_16x16x32_bf16 v[116:119], a[64:67], v[176:179], v[116:119]
  v_mfma_f32_16x16x32_bf16 v[120:123], a[68:71], v[176:179], v[120:123]
  s_waitcnt lgkmcnt(3)
  v_mfma_f32_16x16x32_bf16 v[124:127], a[60:63], v[180:183], v[124:127]
  ds_read_b128 v[164:167], v14 offset:51200
  v_mfma_f32_16x16x32_bf16 v[128:131], a[64:67], v[180:183], v[128:131]
  v_mfma_f32_16x16x32_bf16 v[132:135], a[68:71], v[180:183], v[132:135]
  s_waitcnt lgkmcnt(3)
  v_mfma_f32_16x16x32_bf16 v[136:139], a[60:63], v[184:187], v[136:139]
  ds_read_b128 v[168:171], v14 offset:53248
  v_mfma_f32_16x16x32_bf16 v[140:143], a[64:67], v[184:187], v[140:143]
  v_mfma_f32_16x16x32_bf16 v[144:147], a[68:71], v[184:187], v[144:147]
  s_waitcnt lgkmcnt(3)
  v_mfma_f32_16x16x32_bf16 v[148:151], a[60:63], v[188:191], v[148:151]
  ds_read_b128 v[172:175], v14 offset:55296
  v_mfma_f32_16x16x32_bf16 v[152:155], a[64:67], v[188:191], v[152:155]
  v_mfma_f32_16x16x32_bf16 v[156:159], a[68:71], v[188:191], v[156:159]
  s_waitcnt lgkmcnt(3)
  v_mfma_f32_16x16x32_bf16 v[64:67], a[72:75], v[160:163], v[64:67]
  ds_read_b128 v[176:179], v14 offset:57344
  v_mfma_f32_16x16x32_bf16 v[68:71], a[76:79], v[160:163], v[68:71]
  s_add_u32 m0, s31, 16384
  v_mfma_f32_16x16x32_bf16 v[72:75], a[80:83], v[160:163], v[72:75]
  s_waitcnt lgkmcnt(3)
  buffer_load_dwordx4 v10, s[8:11], s30 offen lds
  v_mfma_f32_16x16x32_bf16 v[76:79], a[72:75], v[164:167], v[76:79]
  ds_read_b128 v[180:183], v14 offset:59392
  v_mfma_f32_16x16x32_bf16 v[80:83], a[76:79], v[164:167], v[80:83]
  v_mfma_f32_16x16x32_bf16 v[84:87], a[80:83], v[164:167], v[84:87]
  s_waitcnt lgkmcnt(3)
  v_mfma_f32_16x16x32_bf16 v[88:91], a[72:75], v[168:171], v[88:91]
  ds_read_b128 v[184:187], v14 offset:61440
  v_mfma_f32_16x16x32_bf16 v[92:95], a[76:79], v[168:171], v[92:95]
  s_add_u32 m0, s31, 17408
  v_mfma_f32_16x16x32_bf16 v[96:99], a[80:83], v[168:171], v[96:99]
  s_waitcnt lgkmcnt(3)
  buffer_load_dwordx4 v11, s[8:11], s30 offen lds
  v_mfma_f32_16x16x32_bf16 v[100:103], a[72:75], v[172:175], v[100:103]
  ds_read_b128 v[188:191], v14 offset:63488
  v_mfma_f32_16x16x32_bf16 v[104:107], a[76:79], v[172:175], v[104:107]
  v_mfma_f32_16x16x32_bf16 v[108:111], a[80:83], v[172:175], v[108:111]
  s_waitcnt lgkmcnt(3)
  v_mfma_f32_16x16x32_bf16 v[112:115], a[72:75], v[176:179], v[112:115]
  ds_read_b128 v[160:163], v15 offset:49152
  v_mfma_f32_16x16x32_bf16 v[116:119], a[76:79], v[176:179], v[116:119]
  s_add_u32 m0, s31, 18432
  v_mfma_f32_16x16x32_bf16 v[120:123], a[80:83], v[176:179], v[120:123]
  s_waitcnt lgkmcnt(3)
  buffer_load_dwordx4 v12, s[8:11], s30 offen lds
  v_mfma_f32_16x16x32_bf16 v[124:127], a[72:75], v[180:183], v[124:127]
  ds_read_b128 v[164:167], v15 offset:51200
  v_mfma_f32_16x16x32_bf16 v[128:131], a[76:79], v[180:183], v[128:131]
  v_mfma_f32_16x16x32_bf16 v[132:135], a[80:83], v[180:183], v[132:135]
  s_waitcnt lgkmcnt(3)
  v_mfma_f32_16x16x32_bf16 v[136:139], a[72:75], v[184:187], v[136:139]
  ds_read_b128 v[168:171], v15 offset:53248
  v_mfma_f32_16x16x32_bf16 v[140:143], a[76:79], v[184:187], v[140:143]
  s_add_u32 m0, s31, 19456
  v_mfma_f32_16x16x32_bf16 v[144:147], a[80:83], v[184:187], v[144:147]
  s_waitcnt lgkmcnt(3)
  buffer_load_dwordx4 v13, s[8:11], s30 offen lds
  v_mfma_f32_16x16x32_bf16 v[148:151], a[72:75], v[188:191], v[148:151]
  s_add_u32 s30, s30, 128
  ds_read_b128 v[172:175], v15 offset:55296
  v_mfma_f32_16x16x32_bf16 v[152:155], a[76:79], v[188:191], v[152:155]
  v_mfma_f32_16x16x32_bf16 v[156:159], a[80:83], v[188:191], v[156:159]
  s_waitcnt lgkmcnt(3)
  v_mfma_f32_16x16x32_bf16 v[64:67], a[84:87], v[160:163], v[64:67]
  ds_read_b128 v[176:179], v15 offset:57344
  v_mfma_f32_16x16x32_bf16 v[68:71], a[88:91], v[160:163], v[68:71]
  v_mfma_f32_16x16x32_bf16 v[72:75], a[92:95], v[160:163], v[72:75]
  s_waitcnt lgkmcnt(3)
  v_mfma_f32_16x16x32_bf16 v[76:79], a[84:87], v[164:167], v[76:79]
  ds_read_b128 v[180:183], v15 offset:59392
  v_mfma_f32_16x16x32_bf16 v[80:83], a[88:91], v[164:167], v[80:83]
  v_mfma_f32_16x16x32_bf16 v[84:87], a[92:95], v[164:167], v[84:87]
  s_waitcnt lgkmcnt(3)
  v_mfma_f32_16x16x32_bf16 v[88:91], a[84:87], v[168:171], v[88:91]
  ds_read_b128 v[184:187], v15 offset:61440
  v_mfma_f32_16x16x32_bf16 v[92:95], a[88:91], v[168:171], v[92:95]
  v_mfma_f32_16x16x32_bf16 v[96:99], a[92:95], v[168:171], v[96:99]
  s_waitcnt lgkmcnt(3)
  v_mfma_f32_16x16x32_bf16 v[100:103], a[84:87], v[172:175], v[100:103]
  ds_read_b128 v[188:191], v15 offset:63488
  v_mfma_f32_16x16x32_bf16 v[104:107], a[88:91], v[172:175], v[104:107]
  v_mfma_f32_16x16x32_bf16 v[108:111], a[92:95], v[172:175], v[108:111]
  s_waitcnt lgkmcnt(3)
  v_mfma_f32_16x16x32_bf16 v[112:115], a[84:87], v[176:179], v[112:115]
  s_waitcnt vmcnt(12)
  s_barrier
  ds_read_b128 v[160:163], v16 offset:0
  v_mfma_f32_16x16x32_bf16 v[116:119], a[88:91], v[176:179], v[116:119]
  v_mfma_f32_16x16x32_bf16 v[120:123], a[92:95], v[176:179], v[120:123]
  s_waitcnt lgkmcnt(3)
  v_mfma_f32_16x16x32_bf16 v[124:127], a[84:87], v[180:183], v[124:127]
  ds_read_b128 v[164:167], v16 offset:2048
  v_mfma_f32_16x16x32_bf16 v[128:131], a[88:91], v[180:183], v[128:131]
  v_mfma_f32_16x16x32_bf16 v[132:135], a[92:95], v[180:183], v[132:135]
  s_waitcnt lgkmcnt(3)
  v_mfma_f32_16x16x32_bf16 v[136:139], a[84:87], v[184:187], v[136:139]
  ds_read_b128 v[168:171], v16 offset:4096
  v_mfma_f32_16x16x32_bf16 v[140:143], a[88:91], v[184:187], v[140:143]
  v_mfma_f32_16x16x32_bf16 v[144:147], a[92:95], v[184:187], v[144:147]
  s_waitcnt lgkmcnt(3)
  v_mfma_f32_16x16x32_bf16 v[148:151], a[84:87], v[188:191], v[148:151]
  ds_read_b128 v[172:175], v16 offset:6144
  s_waitcnt vmcnt(8)
  v_mfma_f32_16x16x32_bf16 v[152:155], a[88:91], v[188:191], v[152:155]
  v_swap_b32 v226, v228
  v_swap_b32 v227, v229
  v_mfma_f32_16x16x32_bf16 v[156:159], a[92:95], v[188:191], v[156:159]
  s_waitcnt lgkmcnt(3)
  v_swap_b32 v234, v236
  v_swap_b32 v235, v237
  v_mfma_f32_16x16x32_bf16 v[64:67], a[96:99], v[160:163], v[64:67]
  ds_read_b128 v[176:179], v16 offset:8192
  v_mfma_f32_16x16x32_bf16 v[68:71], a[100:103], v[160:163], v[68:71]
  s_add_u32 m0, s31, 32768
  ds_read_b128 v[56:59], v21 offset:0
  ds_read_b128 v[60:63], v21 offset:1024
  v_mfma_f32_16x16x32_bf16 v[72:75], a[104:107], v[160:163], v[72:75]
  s_waitcnt lgkmcnt(5)
  buffer_load_dwordx4 v10, s[8:11], s30 offen lds
  v_mfma_f32_16x16x32_bf16 v[76:79], a[96:99], v[164:167], v[76:79]
  ds_read_b128 v[180:183], v16 offset:10240
  v_mfma_f32_16x16x32_bf16 v[80:83], a[100:103], v[164:167], v[80:83]
  v_mfma_f32_16x16x32_bf16 v[84:87], a[104:107], v[164:167], v[84:87]
  s_waitcnt lgkmcnt(5)
  v_mfma_f32_16x16x32_bf16 v[88:91], a[96:99], v[168:171], v[88:91]
  ds_read_b128 v[184:187], v16 offset:12288
  v_mfma_f32_16x16x32_bf16 v[92:95], a[100:103], v[168:171], v[92:95]
  s_add_u32 m0, s31, 33792
  ds_read_b128 v[248:251], v21 offset:3072
  ds_read_b128 v[252:255], v21 offset:4096
  v_mfma_f32_16x16x32_bf16 v[96:99], a[104:107], v[168:171], v[96:99]
  s_waitcnt lgkmcnt(4)
  buffer_load_dwordx4 v11, s[8:11], s30 offen lds
  v_mfma_f32_16x16x32_bf16 v[36:39], v[192:195], v[56:59], 0
  v_mfma_f32_16x16x32_bf16 v[44:47], v[192:195], v[60:63], 0
  v_mfma_f32_16x16x32_bf16 v[48:51], v[196:199], v[60:63], 0
  v_mfma_f32_16x16x32_bf16 v[40:43], a[240:243], v[56:59], 0
  v_mfma_f32_16x16x32_bf16 v[52:55], a[240:243], v[60:63], 0
  s_waitcnt lgkmcnt(7)
  ds_read2st64_b64 v[56:59], v22 offset0:0 offset1:6
  ds_read2st64_b64 v[60:63], v23 offset0:0 offset1:6
  v_mfma_f32_16x16x32_bf16 v[100:103], a[96:99], v[172:175], v[100:103]
  ds_read_b128 v[188:191], v16 offset:14336
  v_mfma_f32_16x16x32_bf16 v[104:107], a[100:103], v[172:175], v[104:107]
  v_mfma_f32_16x16x32_bf16 v[108:111], a[104:107], v[172:175], v[108:111]
  s_waitcnt lgkmcnt(9)
  v_mfma_f32_16x16x32_bf16 v[112:115], a[96:99], v[176:179], v[112:115]
  ds_read_b128 v[160:163], v17 offset:0
  v_mfma_f32_16x16x32_bf16 v[116:119], a[100:103], v[176:179], v[116:119]
  s_add_u32 m0, s31, 34816
  v_mfma_f32_16x16x32_bf16 v[120:123], a[104:107], v[176:179], v[120:123]
  s_waitcnt lgkmcnt(4)
  buffer_load_dwordx4 v12, s[8:11], s30 offen lds
  v_mfma_f32_16x16x32_bf16 v[36:39], v[200:203], v[248:251], v[36:39]
  v_mfma_f32_16x16x32_bf16 v[44:47], v[200:203], v[252:255], v[44:47]
  v_mfma_f32_16x16x32_bf16 v[48:51], v[204:207], v[252:255], v[48:51]
  v_mfma_f32_16x16x32_bf16 v[40:43], a[244:247], v[248:251], v[40:43]
  v_mfma_f32_16x16x32_bf16 v[52:55], a[244:247], v[252:255], v[52:55]
  s_waitcnt lgkmcnt(7)
  ds_read_b128 v[248:251], v21 offset:6144
  ds_read_b128 v[252:255], v21 offset:7168
  v_mfma_f32_16x16x32_bf16 v[124:127], a[96:99], v[180:183], v[124:127]
  ds_read_b128 v[164:167], v17 offset:2048
  v_mfma_f32_16x16x32_bf16 v[128:131], a[100:103], v[180:183], v[128:131]
  v_mfma_f32_16x16x32_bf16 v[132:135], a[104:107], v[180:183], v[132:135]
  s_waitcnt lgkmcnt(9)
  v_mfma_f32_16x16x32_bf16 v[136:139], a[96:99], v[184:187], v[136:139]
  ds_read_b128 v[168:171], v17 offset:4096
  v_mfma_f32_16x16x32_bf16 v[140:143], a[100:103], v[184:187], v[140:143]
  s_add_u32 m0, s31, 35840
  v_mfma_f32_16x16x32_bf16 v[144:147], a[104:107], v[184:187], v[144:147]
  s_waitcnt lgkmcnt(6)
  buffer_load_dwordx4 v13, s[8:11], s30 offen lds
  v_mfma_f32_16x16x32_bf16 v[36:39], v[224:227], v[56:59], v[36:39]
  s_add_u32 s30, s30, 128
  v_mfma_f32_16x16x32_bf16 v[44:47], v[224:227], v[60:63], v[44:47]
  v_mfma_f32_16x16x32_bf16 v[48:51], v[228:231], v[60:63], v[48:51]
  v_mfma_f32_16x16x32_bf16 v[40:43], v[240:243], v[56:59], v[40:43]
  v_mfma_f32_16x16x32_bf16 v[52:55], v[240:243], v[60:63], v[52:55]
  s_waitcnt lgkmcnt(5)
  ds_read_b128 v[56:59], v21 offset:9216
  ds_read_b128 v[60:63], v21 offset:10240
  v_mfma_f32_16x16x32_bf16 v[148:151], a[96:99], v[188:191], v[148:151]
  ds_read_b128 v[172:175], v17 offset:6144
  v_mfma_f32_16x16x32_bf16 v[152:155], a[100:103], v[188:191], v[152:155]
  v_mfma_f32_16x16x32_bf16 v[156:159], a[104:107], v[188:191], v[156:159]
  s_waitcnt lgkmcnt(7)
  v_mfma_f32_16x16x32_bf16 v[64:67], a[108:111], v[160:163], v[64:67]
  ds_read_b128 v[176:179], v17 offset:8192
  v_mfma_f32_16x16x32_bf16 v[68:71], a[112:115], v[160:163], v[68:71]
  v_mfma_f32_16x16x32_bf16 v[72:75], a[116:119], v[160:163], v[72:75]
  s_waitcnt lgkmcnt(6)
  v_mfma_f32_16x16x32_bf16 v[36:39], v[208:211], v[248:251], v[36:39]
  v_mfma_f32_16x16x32_bf16 v[44:47], v[208:211], v[252:255], v[44:47]
  v_mfma_f32_16x16x32_bf16 v[48:51], v[212:215], v[252:255], v[48:51]
  v_mfma_f32_16x16x32_bf16 v[40:43], a[248:251], v[248:251], v[40:43]
  v_mfma_f32_16x16x32_bf16 v[52:55], a[248:251], v[252:255], v[52:55]
  s_waitcnt lgkmcnt(5)
  ds_read2st64_b64 v[248:251], v22 offset0:12 offset1:18
  ds_read2st64_b64 v[252:255], v23 offset0:12 offset1:18
  v_mfma_f32_16x16x32_bf16 v[76:79], a[108:111], v[164:167], v[76:79]
  ds_read_b128 v[180:183], v17 offset:10240
  v_mfma_f32_16x16x32_bf16 v[80:83], a[112:115], v[164:167], v[80:83]
  v_mfma_f32_16x16x32_bf16 v[84:87], a[116:119], v[164:167], v[84:87]
  s_waitcnt lgkmcnt(7)
  v_mfma_f32_16x16x32_bf16 v[88:91], a[108:111], v[168:171], v[88:91]
  ds_read_b128 v[184:187], v17 offset:12288
  v_mfma_f32_16x16x32_bf16 v[92:95], a[112:115], v[168:171], v[92:95]
  v_mfma_f32_16x16x32_bf16 v[96:99], a[116:119], v[168:171], v[96:99]
  s_waitcnt lgkmcnt(6)
  v_mfma_f32_16x16x32_bf16 v[36:39], v[216:219], v[56:59], v[36:39]
  v_mfma_f32_16x16x32_bf16 v[44:47], v[216:219], v[60:63], v[44:47]
  v_mfma_f32_16x16x32_bf16 v[48:51], v[220:223], v[60:63], v[48:51]
  v_mfma_f32_16x16x32_bf16 v[40:43], a[252:255], v[56:59], v[40:43]
  v_mfma_f32_16x16x32_bf16 v[52:55], a[252:255], v[60:63], v[52:55]
  s_waitcnt lgkmcnt(5)
  v_mfma_f32_16x16x32_bf16 v[100:103], a[108:111], v[172:175], v[100:103]
  ds_read_b128 v[188:191], v17 offset:14336
  v_mfma_f32_16x16x32_bf16 v[104:107], a[112:115], v[172:175], v[104:107]
  v_mfma_f32_16x16x32_bf16 v[108:111], a[116:119], v[172:175], v[108:111]
  s_waitcnt lgkmcnt(5)
  v_mfma_f32_16x16x32_bf16 v[112:115], a[108:111], v[176:179], v[112:115]
  s_waitcnt vmcnt(8)
  s_barrier
  ds_read_b128 v[160:163], v14 offset:0
  v_mfma_f32_16x16x32_bf16 v[116:119], a[112:115], v[176:179], v[116:119]
  v_mfma_f32_16x16x32_bf16 v[120:123], a[116:119], v[176:179], v[120:123]
  s_waitcnt lgkmcnt(4)
  v_mfma_f32_16x16x32_bf16 v[36:39], v[232:235], v[248:251], v[36:39]
  v_mfma_f32_16x16x32_bf16 v[44:47], v[232:235], v[252:255], v[44:47]
  v_mfma_f32_16x16x32_bf16 v[48:51], v[236:239], v[252:255], v[48:51]
  v_mfma_f32_16x16x32_bf16 v[40:43], v[244:247], v[248:251], v[40:43]
  v_mfma_f32_16x16x32_bf16 v[52:55], v[244:247], v[252:255], v[52:55]
  s_waitcnt lgkmcnt(3)
  v_mfma_f32_16x16x32_bf16 v[124:127], a[108:111], v[180:183], v[124:127]
  ds_read_b128 v[164:167], v14 offset:2048
  v_mfma_f32_16x16x32_bf16 v[128:131], a[112:115], v[180:183], v[128:131]
  v_mfma_f32_16x16x32_bf16 v[132:135], a[116:119], v[180:183], v[132:135]
  s_waitcnt lgkmcnt(3)
  v_cndmask_b32 v36, v31, v36, s[64:65]
  v_cndmask_b32 v48, v31, v48, s[64:65]
  v_mfma_f32_16x16x32_bf16 v[136:139], a[108:111], v[184:187], v[136:139]
  ds_read_b128 v[168:171], v14 offset:4096
  v_cndmask_b32 v37, v31, v37, s[66:67]
  v_mfma_f32_16x16x32_bf16 v[140:143], a[112:115], v[184:187], v[140:143]
  v_cndmask_b32 v49, v31, v49, s[66:67]
  v_cndmask_b32 v38, v31, v38, s[68:69]
  v_mfma_f32_16x16x32_bf16 v[144:147], a[116:119], v[184:187], v[144:147]
  s_waitcnt lgkmcnt(3)
  v_cndmask_b32 v50, v31, v50, s[68:69]
  v_cndmask_b32 v39, v31, v39, s[70:71]
  v_mfma_f32_16x16x32_bf16 v[148:151], a[108:111], v[188:191], v[148:151]
  ds_read_b128 v[172:175], v14 offset:6144
  v_cndmask_b32 v51, v31, v51, s[70:71]
  v_mfma_f32_16x16x32_bf16 v[152:155], a[112:115], v[188:191], v[152:155]
  v_max3_f32 v34, v36, v37, v38
  v_max3_f32 v34, v34, v39, v40
  v_mfma_f32_16x16x32_bf16 v[156:159], a[116:119], v[188:191], v[156:159]
  s_waitcnt lgkmcnt(3)
  v_max3_f32 v34, v34, v41, v42
  v_max_f32 v34, v34, v43
  v_mfma_f32_16x16x32_bf16 v[64:67], a[120:123], v[160:163], v[64:67]
  ds_read_b128 v[176:179], v14 offset:8192
  v_mov_b32 v35, v34
  v_mfma_f32_16x16x32_bf16 v[68:71], a[124:127], v[160:163], v[68:71]
  s_add_u32 m0, s31, 49152
  v_permlane32_swap_b32 v34, v35
  v_max_f32 v34, v34, v35
  v_mfma_f32_16x16x32_bf16 v[72:75], a[128:131], v[160:163], v[72:75]
  s_waitcnt lgkmcnt(3)
  buffer_load_dwordx4 v10, s[8:11], s30 offen lds
  v_mov_b32 v35, v34
  v_mfma_f32_16x16x32_bf16 v[76:79], a[120:123], v[164:167], v[76:79]
  ds_read_b128 v[180:183], v14 offset:10240
  v_permlane16_swap_b32 v34, v35
  v_mfma_f32_16x16x32_bf16 v[80:83], a[124:127], v[164:167], v[80:83]
  v_max_f32 v34, v34, v35
  v_mul_f32 v34, s83, v34
  v_mfma_f32_16x16x32_bf16 v[84:87], a[128:131], v[164:167], v[84:87]
  s_waitcnt lgkmcnt(3)
  v_fma_f32 v36, v36, s83, -v34
  v_fma_f32 v37, v37, s83, -v34
  v_mfma_f32_16x16x32_bf16 v[88:91], a[120:123], v[168:171], v[88:91]
  ds_read_b128 v[184:187], v14 offset:12288
  v_fma_f32 v38, v38, s83, -v34
  v_mfma_f32_16x16x32_bf16 v[92:95], a[124:127], v[168:171], v[92:95]
  s_add_u32 m0, s31, 50176
  v_fma_f32 v39, v39, s83, -v34
  v_fma_f32 v40, v40, s83, -v34
  v_mfma_f32_16x16x32_bf16 v[96:99], a[128:131], v[168:171], v[96:99]
  s_waitcnt lgkmcnt(3)
  buffer_load_dwordx4 v11, s[8:11], s30 offen lds
  v_fma_f32 v41, v41, s83, -v34
  v_mfma_f32_16x16x32_bf16 v[100:103], a[120:123], v[172:175], v[100:103]
  ds_read_b128 v[188:191], v14 offset:14336
  v_fma_f32 v42, v42, s83, -v34
  v_mfma_f32_16x16x32_bf16 v[104:107], a[124:127], v[172:175], v[104:107]
  v_fma_f32 v43, v43, s83, -v34
  v_mfma_f32_16x16x32_bf16 v[108:111], a[128:131], v[172:175], v[108:111]
  s_waitcnt lgkmcnt(3)
  v_exp_f32 v36, v36
  v_mfma_f32_16x16x32_bf16 v[112:115], a[120:123], v[176:179], v[112:115]
  ds_read_b128 v[160:163], v15 offset:0
  v_mfma_f32_16x16x32_bf16 v[116:119], a[124:127], v[176:179], v[116:119]
  s_add_u32 m0, s31, 51200
  v_exp_f32 v37, v37
  v_mfma_f32_16x16x32_bf16 v[120:123], a[128:131], v[176:179], v[120:123]
  s_waitcnt lgkmcnt(3)
  buffer_load_dwordx4 v12, s[8:11], s30 offen lds
  v_mfma_f32_16x16x32_bf16 v[124:127], a[120:123], v[180:183], v[124:127]
  ds_read_b128 v[164:167], v15 offset:2048
  v_mfma_f32_16x16x32_bf16 v[128:131], a[124:127], v[180:183], v[128:131]
  v_exp_f32 v38, v38
  v_mfma_f32_16x16x32_bf16 v[132:135], a[128:131], v[180:183], v[132:135]
  s_waitcnt lgkmcnt(3)
  v_exp_f32 v39, v39
  v_mfma_f32_16x16x32_bf16 v[136:139], a[120:123], v[184:187], v[136:139]
  ds_read_b128 v[168:171], v15 offset:4096
  v_mfma_f32_16x16x32_bf16 v[140:143], a[124:127], v[184:187], v[140:143]
  s_add_u32 m0, s31, 52224
  v_exp_f32 v40, v40
  v_mfma_f32_16x16x32_bf16 v[144:147], a[128:131], v[184:187], v[144:147]
  s_waitcnt lgkmcnt(3)
  buffer_load_dwordx4 v13, s[8:11], s30 offen lds
  v_mfma_f32_16x16x32_bf16 v[148:151], a[120:123], v[188:191], v[148:151]
  s_add_u32 s30, s30, 128
  ds_read_b128 v[172:175], v15 offset:6144
  v_mfma_f32_16x16x32_bf16 v[152:155], a[124:127], v[188:191], v[152:155]
  v_exp_f32 v41, v41
  v_mfma_f32_16x16x32_bf16 v[156:159], a[128:131], v[188:191], v[156:159]
  s_waitcnt lgkmcnt(3)
  v_exp_f32 v42, v42
  v_mfma_f32_16x16x32_bf16 v[64:67], a[132:135], v[160:163], v[64:67]
  ds_read_b128 v[176:179], v15 offset:8192
  v_mfma_f32_16x16x32_bf16 v[68:71], a[136:139], v[160:163], v[68:71]
  v_exp_f32 v43, v43
  v_mfma_f32_16x16x32_bf16 v[72:75], a[140:143], v[160:163], v[72:75]
  s_waitcnt lgkmcnt(3)
  v_add_f32 v34, v40, v41
  v_add_f32 v34, v34, v42
  v_mfma_f32_16x16x32_bf16 v[76:79], a[132:135], v[164:167], v[76:79]
  ds_read_b128 v[180:183], v15 offset:10240
  v_add_f32 v34, v34, v43
  v_mfma_f32_16x16x32_bf16 v[80:83], a[136:139], v[164:167], v[80:83]
  v_cndmask_b32 v34, 0, v34, s[62:63]
  v_add_f32 v34, v34, v36
  v_mfma_f32_16x16x32_bf16 v[84:87], a[140:143], v[164:167], v[84:87]
  s_waitcnt lgkmcnt(3)
  v_add_f32 v34, v34, v37
  v_add_f32 v34, v34, v38
  v_mfma_f32_16x16x32_bf16 v[88:91], a[132:135], v[168:171], v[88:91]
  ds_read_b128 v[184:187], v15 offset:12288
  v_add_f32 v34, v34, v39
  v_mfma_f32_16x16x32_bf16 v[92:95], a[136:139], v[168:171], v[92:95]
  v_mov_b32 v35, v34
  v_mfma_f32_16x16x32_bf16 v[96:99], a[140:143], v[168:171], v[96:99]
  s_waitcnt lgkmcnt(3)
  v_permlane32_swap_b32 v34, v35
  v_add_f32 v34, v34, v35
  v_mfma_f32_16x16x32_bf16 v[100:103], a[132:135], v[172:175], v[100:103]
  ds_read_b128 v[188:191], v15 offset:14336
  v_mov_b32 v35, v34
  v_mfma_f32_16x16x32_bf16 v[104:107], a[136:139], v[172:175], v[104:107]
  v_permlane16_swap_b32 v34, v35
  v_add_f32 v34, v34, v35
  v_mfma_f32_16x16x32_bf16 v[108:111], a[140:143], v[172:175], v[108:111]
  s_waitcnt lgkmcnt(3)
  v_rcp_f32 v34, v34
  v_mfma_f32_16x16x32_bf16 v[112:115], a[132:135], v[176:179], v[112:115]
  s_waitcnt vmcnt(8)
  s_barrier
  ds_read_b128 v[160:163], v14 offset:16384
  v_mfma_f32_16x16x32_bf16 v[116:119], a[136:139], v[176:179], v[116:119]
  v_mul_f32 v36, v36, v34
  v_mul_f32 v37, v37, v34
  v_mfma_f32_16x16x32_bf16 v[120:123], a[140:143], v[176:179], v[120:123]
  s_waitcnt lgkmcnt(3)
  v_mul_f32 v38, v38, v34
  v_mul_f32 v39, v39, v34
  v_mfma_f32_16x16x32_bf16 v[124:127], a[132:135], v[180:183], v[124:127]
  ds_read_b128 v[164:167], v14 offset:18432
  v_mul_f32 v40, v40, v34
  v_mfma_f32_16x16x32_bf16 v[128:131], a[136:139], v[180:183], v[128:131]
  v_mul_f32 v41, v41, v34
  v_mul_f32 v42, v42, v34
  v_mfma_f32_16x16x32_bf16 v[132:135], a[140:143], v[180:183], v[132:135]
  s_waitcnt lgkmcnt(3)
  v_mul_f32 v43, v43, v34
  v_max3_f32 v34, v44, v45, v46
  v_mfma_f32_16x16x32_bf16 v[136:139], a[132:135], v[184:187], v[136:139]
  ds_read_b128 v[168:171], v14 offset:20480
  v_max3_f32 v34, v34, v47, v48
  v_mfma_f32_16x16x32_bf16 v[140:143], a[136:139], v[184:187], v[140:143]
  v_max3_f32 v34, v34, v49, v50
  v_max3_f32 v34, v34, v51, v52
  v_mfma_f32_16x16x32_bf16 v[144:147], a[140:143], v[184:187], v[144:147]
  s_waitcnt lgkmcnt(3)
  v_max3_f32 v34, v34, v53, v54
  v_max_f32 v34, v34, v55
  v_mfma_f32_16x16x32_bf16 v[148:151], a[132:135], v[188:191], v[148:151]
  ds_read_b128 v[172:175], v14 offset:22528
  v_mov_b32 v35, v34
  v_mfma_f32_16x16x32_bf16 v[152:155], a[136:139], v[188:191], v[152:155]
  v_permlane32_swap_b32 v34, v35
  v_max_f32 v34, v34, v35
  v_mfma_f32_16x16x32_bf16 v[156:159], a[140:143], v[188:191], v[156:159]
  s_waitcnt lgkmcnt(3)
  v_mov_b32 v35, v34
  v_mfma_f32_16x16x32_bf16 v[64:67], a[144:147], v[160:163], v[64:67]
  ds_read_b128 v[176:179], v14 offset:24576
  v_permlane16_swap_b32 v34, v35
  v_mfma_f32_16x16x32_bf16 v[68:71], a[148:151], v[160:163], v[68:71]
  s_add_u32 m0, s31, 65536
  v_max_f32 v34, v34, v35
  v_mul_f32 v34, s83, v34
  v_mfma_f32_16x16x32_bf16 v[72:75], a[152:155], v[160:163], v[72:75]
  s_waitcnt lgkmcnt(3)
  buffer_load_dwordx4 v10, s[8:11], s30 offen lds
  v_fma_f32 v44, v44, s83, -v34
  v_mfma_f32_16x16x32_bf16 v[76:79], a[144:147], v[164:167], v[76:79]
  ds_read_b128 v[180:183], v14 offset:26624
  v_fma_f32 v45, v45, s83, -v34
  v_mfma_f32_16x16x32_bf16 v[80:83], a[148:151], v[164:167], v[80:83]
  v_fma_f32 v46, v46, s83, -v34
  v_fma_f32 v47, v47, s83, -v34
  v_mfma_f32_16x16x32_bf16 v[84:87], a[152:155], v[164:167], v[84:87]
  s_waitcnt lgkmcnt(3)
  v_fma_f32 v48, v48, s83, -v34
  v_fma_f32 v49, v49, s83, -v34
  v_mfma_f32_16x16x32_bf16 v[88:91], a[144:147], v[168:171], v[88:91]
  ds_read_b128 v[184:187], v14 offset:28672
  v_fma_f32 v50, v50, s83, -v34
  v_mfma_f32_16x16x32_bf16 v[92:95], a[148:151], v[168:171], v[92:95]
  s_add_u32 m0, s31, 66560
  v_fma_f32 v51, v51, s83, -v34
  v_fma_f32 v52, v52, s83, -v34
  v_mfma_f32_16x16x32_bf16 v[96:99], a[152:155], v[168:171], v[96:99]
  s_waitcnt lgkmcnt(3)
  buffer_load_dwordx4 v11, s[8:11], s30 offen lds
  v_fma_f32 v53, v53, s83, -v34
  v_mfma_f32_16x16x32_bf16 v[100:103], a[144:147], v[172:175], v[100:103]
  ds_read_b128 v[188:191], v14 offset:30720
  v_fma_f32 v54, v54, s83, -v34
  v_mfma_f32_16x16x32_bf16 v[104:107], a[148:151], v[172:175], v[104:107]
  v_fma_f32 v55, v55, s83, -v34
  v_mfma_f32_16x16x32_bf16 v[108:111], a[152:155], v[172:175], v[108:111]
  s_waitcnt lgkmcnt(3)
  v_exp_f32 v44, v44
  v_mfma_f32_16x16x32_bf16 v[112:115], a[144:147], v[176:179], v[112:115]
  ds_read_b128 v[160:163], v15 offset:16384
  v_mfma_f32_16x16x32_bf16 v[116:119], a[148:151], v[176:179], v[116:119]
  s_add_u32 m0, s31, 67584
  v_exp_f32 v45, v45
  v_mfma_f32_16x16x32_bf16 v[120:123], a[152:155], v[176:179], v[120:123]
  s_waitcnt lgkmcnt(3)
  buffer_load_dwordx4 v12, s[8:11], s30 offen lds
  v_mfma_f32_16x16x32_bf16 v[124:127], a[144:147], v[180:183], v[124:127]
  ds_read_b128 v[164:167], v15 offset:18432
  v_mfma_f32_16x16x32_bf16 v[128:131], a[148:151], v[180:183], v[128:131]
  v_exp_f32 v46, v46
  v_mfma_f32_16x16x32_bf16 v[132:135], a[152:155], v[180:183], v[132:135]
  s_waitcnt lgkmcnt(3)
  v_exp_f32 v47, v47
  v_mfma_f32_16x16x32_bf16 v[136:139], a[144:147], v[184:187], v[136:139]
  ds_read_b128 v[168:171], v15 offset:20480
  v_mfma_f32_16x16x32_bf16 v[140:143], a[148:151], v[184:187], v[140:143]
  s_add_u32 m0, s31, 68608
  v_exp_f32 v48, v48
  v_mfma_f32_16x16x32_bf16 v[144:147], a[152:155], v[184:187], v[144:147]
  s_waitcnt lgkmcnt(3)
  buffer_load_dwordx4 v13, s[8:11], s30 offen lds
  v_mfma_f32_16x16x32_bf16 v[148:151], a[144:147], v[188:191], v[148:151]
  s_add_u32 s30, s30, s25
  ds_read_b128 v[172:175], v15 offset:22528
  v_mfma_f32_16x16x32_bf16 v[152:155], a[148:151], v[188:191], v[152:155]
  v_exp_f32 v49, v49
  v_mfma_f32_16x16x32_bf16 v[156:159], a[152:155], v[188:191], v[156:159]
  s_waitcnt lgkmcnt(3)
  v_exp_f32 v50, v50
  v_mfma_f32_16x16x32_bf16 v[64:67], a[156:159], v[160:163], v[64:67]
  ds_read_b128 v[176:179], v15 offset:24576
  v_mfma_f32_16x16x32_bf16 v[68:71], a[160:163], v[160:163], v[68:71]
  v_exp_f32 v51, v51
  v_mfma_f32_16x16x32_bf16 v[72:75], a[164:167], v[160:163], v[72:75]
  s_waitcnt lgkmcnt(3)
  v_exp_f32 v52, v52
  v_mfma_f32_16x16x32_bf16 v[76:79], a[156:159], v[164:167], v[76:79]
  ds_read_b128 v[180:183], v15 offset:26624
  v_mfma_f32_16x16x32_bf16 v[80:83], a[160:163], v[164:167], v[80:83]
  v_exp_f32 v53, v53
  v_mfma_f32_16x16x32_bf16 v[84:87], a[164:167], v[164:167], v[84:87]
  s_waitcnt lgkmcnt(3)
  v_exp_f32 v54, v54
  v_mfma_f32_16x16x32_bf16 v[88:91], a[156:159], v[168:171], v[88:91]
  ds_read_b128 v[184:187], v15 offset:28672
  v_mfma_f32_16x16x32_bf16 v[92:95], a[160:163], v[168:171], v[92:95]
  v_exp_f32 v55, v55
  v_mfma_f32_16x16x32_bf16 v[96:99], a[164:167], v[168:171], v[96:99]
  s_waitcnt lgkmcnt(3)
  v_add_f32 v34, v52, v53
  v_add_f32 v34, v34, v54
  v_mfma_f32_16x16x32_bf16 v[100:103], a[156:159], v[172:175], v[100:103]
  ds_read_b128 v[188:191], v15 offset:30720
  v_add_f32 v34, v34, v55
  v_mfma_f32_16x16x32_bf16 v[104:107], a[160:163], v[172:175], v[104:107]
  v_cndmask_b32 v34, 0, v34, s[62:63]
  v_add_f32 v34, v34, v44
  v_mfma_f32_16x16x32_bf16 v[108:111], a[164:167], v[172:175], v[108:111]
  s_waitcnt lgkmcnt(3)
  v_add_f32 v34, v34, v45
  v_add_f32 v34, v34, v46
  v_mfma_f32_16x16x32_bf16 v[112:115], a[156:159], v[176:179], v[112:115]
  s_waitcnt vmcnt(8)
  s_barrier
  ds_read_b128 v[160:163], v14 offset:32768
  v_mfma_f32_16x16x32_bf16 v[116:119], a[160:163], v[176:179], v[116:119]
  v_add_f32 v34, v34, v47
  v_add_f32 v34, v34, v48
  v_mfma_f32_16x16x32_bf16 v[120:123], a[164:167], v[176:179], v[120:123]
  s_waitcnt lgkmcnt(3)
  v_add_f32 v34, v34, v49
  v_add_f32 v34, v34, v50
  v_mfma_f32_16x16x32_bf16 v[124:127], a[156:159], v[180:183], v[124:127]
  ds_read_b128 v[164:167], v14 offset:34816
  v_add_f32 v34, v34, v51
  v_mfma_f32_16x16x32_bf16 v[128:131], a[160:163], v[180:183], v[128:131]
  v_mov_b32 v35, v34
  v_mfma_f32_16x16x32_bf16 v[132:135], a[164:167], v[180:183], v[132:135]
  s_waitcnt lgkmcnt(3)
  v_permlane32_swap_b32 v34, v35
  v_add_f32 v34, v34, v35
  v_mfma_f32_16x16x32_bf16 v[136:139], a[156:159], v[184:187], v[136:139]
  ds_read_b128 v[168:171], v14 offset:36864
  v_mov_b32 v35, v34
  v_mfma_f32_16x16x32_bf16 v[140:143], a[160:163], v[184:187], v[140:143]
  v_permlane16_swap_b32 v34, v35
  v_add_f32 v34, v34, v35
  v_mfma_f32_16x16x32_bf16 v[144:147], a[164:167], v[184:187], v[144:147]
  s_waitcnt lgkmcnt(3)
  v_rcp_f32 v34, v34
  v_mfma_f32_16x16x32_bf16 v[148:151], a[156:159], v[188:191], v[148:151]
  ds_read_b128 v[172:175], v14 offset:38912
  v_mul_f32 v44, v44, v34
  v_mfma_f32_16x16x32_bf16 v[152:155], a[160:163], v[188:191], v[152:155]
  v_mul_f32 v45, v45, v34
  v_mul_f32 v46, v46, v34
  v_mfma_f32_16x16x32_bf16 v[156:159], a[164:167], v[188:191], v[156:159]
  s_waitcnt lgkmcnt(3)
  v_mul_f32 v47, v47, v34
  v_mul_f32 v48, v48, v34
  v_mfma_f32_16x16x32_bf16 v[64:67], a[168:171], v[160:163], v[64:67]
  ds_read_b128 v[176:179], v14 offset:40960
  v_mul_f32 v49, v49, v34
  v_mfma_f32_16x16x32_bf16 v[68:71], a[172:175], v[160:163], v[68:71]
  s_add_u32 m0, s31, 0
  v_mul_f32 v50, v50, v34
  v_mul_f32 v51, v51, v34
  v_mfma_f32_16x16x32_bf16 v[72:75], a[176:179], v[160:163], v[72:75]
  s_waitcnt lgkmcnt(3)
  buffer_load_dwordx4 v10, s[8:11], s30 offen lds
  v_mul_f32 v52, v52, v34
  v_mfma_f32_16x16x32_bf16 v[76:79], a[168:171], v[164:167], v[76:79]
  ds_read_b128 v[180:183], v14 offset:43008
  v_mul_f32 v53, v53, v34
  v_mfma_f32_16x16x32_bf16 v[80:83], a[172:175], v[164:167], v[80:83]
  v_mul_f32 v54, v54, v34
  v_mul_f32 v55, v55, v34
  v_mfma_f32_16x16x32_bf16 v[84:87], a[176:179], v[164:167], v[84:87]
  s_waitcnt lgkmcnt(3)
  v_cvt_pk_bf16_f32 v56, v44, v45
  v_cvt_pk_bf16_f32 v57, v46, v47
  v_mfma_f32_16x16x32_bf16 v[88:91], a[168:171], v[168:171], v[88:91]
  ds_read_b128 v[184:187], v14 offset:45056
  v_cvt_pk_bf16_f32 v58, v48, v49
  v_mfma_f32_16x16x32_bf16 v[92:95], a[172:175], v[168:171], v[92:95]
  s_add_u32 m0, s31, 1024
  v_cvt_pk_bf16_f32 v59, v50, v51
  v_cvt_pk_bf16_f32 v60, v40, v41
  v_mfma_f32_16x16x32_bf16 v[96:99], a[176:179], v[168:171], v[96:99]
  s_waitcnt lgkmcnt(3)
  buffer_load_dwordx4 v11, s[8:11], s30 offen lds
  v_cvt_pk_bf16_f32 v61, v42, v43
  v_mfma_f32_16x16x32_bf16 v[100:103], a[168:171], v[172:175], v[100:103]
  ds_read_b128 v[188:191], v14 offset:47104
  v_cvt_pk_bf16_f32 v62, v52, v53
  v_mfma_f32_16x16x32_bf16 v[104:107], a[172:175], v[172:175], v[104:107]
  v_cvt_pk_bf16_f32 v63, v54, v55
  v_cvt_pk_bf16_f32 v248, v36, v37
  v_mfma_f32_16x16x32_bf16 v[108:111], a[176:179], v[172:175], v[108:111]
  s_waitcnt lgkmcnt(3)
  v_cvt_pk_bf16_f32 v249, v38, v39
  buffer_store_dwordx4 v[56:59], v26, s[56:59], s81 offen sc1
  v_mfma_f32_16x16x32_bf16 v[112:115], a[168:171], v[176:179], v[112:115]
  ds_read_b128 v[160:163], v15 offset:32768
  buffer_store_dwordx4 v[60:63], v26, s[56:59], s81 offen offset:1024 sc1
  v_mfma_f32_16x16x32_bf16 v[116:119], a[172:175], v[176:179], v[116:119]
  s_add_u32 m0, s31, 2048
  buffer_store_dwordx2 v[248:249], v29, s[56:59], s81 offen offset:2048 sc1
  v_mfma_f32_16x16x32_bf16 v[120:123], a[176:179], v[176:179], v[120:123]
  s_waitcnt lgkmcnt(3)
  buffer_load_dwordx4 v12, s[8:11], s30 offen lds
  v_mfma_f32_16x16x32_bf16 v[124:127], a[168:171], v[180:183], v[124:127]
  ds_read_b128 v[164:167], v15 offset:34816
  v_mfma_f32_16x16x32_bf16 v[128:131], a[172:175], v[180:183], v[128:131]
  v_mfma_f32_16x16x32_bf16 v[132:135], a[176:179], v[180:183], v[132:135]
  s_waitcnt lgkmcnt(3)
  v_mfma_f32_16x16x32_bf16 v[136:139], a[168:171], v[184:187], v[136:139]
  ds_read_b128 v[168:171], v15 offset:36864
  v_mfma_f32_16x16x32_bf16 v[140:143], a[172:175], v[184:187], v[140:143]
  s_add_u32 m0, s31, 3072
  v_mfma_f32_16x16x32_bf16 v[144:147], a[176:179], v[184:187], v[144:147]
  s_waitcnt lgkmcnt(3)
  buffer_load_dwordx4 v13, s[8:11], s30 offen lds
  v_mfma_f32_16x16x32_bf16 v[148:151], a[168:171], v[188:191], v[148:151]
  s_add_u32 s30, s30, 128
  ds_read_b128 v[172:175], v15 offset:38912
  v_mfma_f32_16x16x32_bf16 v[152:155], a[172:175], v[188:191], v[152:155]
  v_mfma_f32_16x16x32_bf16 v[156:159], a[176:179], v[188:191], v[156:159]
  s_waitcnt lgkmcnt(3)
  v_mfma_f32_16x16x32_bf16 v[64:67], a[180:183], v[160:163], v[64:67]
  ds_read_b128 v[176:179], v15 offset:40960
  v_mfma_f32_16x16x32_bf16 v[68:71], a[184:187], v[160:163], v[68:71]
  v_mfma_f32_16x16x32_bf16 v[72:75], a[188:191], v[160:163], v[72:75]
  s_waitcnt lgkmcnt(3)
  v_mfma_f32_16x16x32_bf16 v[76:79], a[180:183], v[164:167], v[76:79]
  ds_read_b128 v[180:183], v15 offset:43008
  v_mfma_f32_16x16x32_bf16 v[80:83], a[184:187], v[164:167], v[80:83]
  v_mfma_f32_16x16x32_bf16 v[84:87], a[188:191], v[164:167], v[84:87]
  s_waitcnt lgkmcnt(3)
  v_mfma_f32_16x16x32_bf16 v[88:91], a[180:183], v[168:171], v[88:91]
  ds_read_b128 v[184:187], v15 offset:45056
  v_mfma_f32_16x16x32_bf16 v[92:95], a[184:187], v[168:171], v[92:95]
  v_mfma_f32_16x16x32_bf16 v[96:99], a[188:191], v[168:171], v[96:99]
  s_waitcnt lgkmcnt(3)
  v_mfma_f32_16x16x32_bf16 v[100:103], a[180:183], v[172:175], v[100:103]
  ds_read_b128 v[188:191], v15 offset:47104
  v_mfma_f32_16x16x32_bf16 v[104:107], a[184:187], v[172:175], v[104:107]
  v_mfma_f32_16x16x32_bf16 v[108:111], a[188:191], v[172:175], v[108:111]
  s_waitcnt lgkmcnt(3)
  v_mfma_f32_16x16x32_bf16 v[112:115], a[180:183], v[176:179], v[112:115]
  s_waitcnt vmcnt(11)
  s_barrier
  ds_read_b128 v[160:163], v14 offset:49152
  v_mfma_f32_16x16x32_bf16 v[116:119], a[184:187], v[176:179], v[116:119]
  v_mfma_f32_16x16x32_bf16 v[120:123], a[188:191], v[176:179], v[120:123]
  s_waitcnt lgkmcnt(3)
  v_mfma_f32_16x16x32_bf16 v[124:127], a[180:183], v[180:183], v[124:127]
  ds_read_b128 v[164:167], v14 offset:51200
  v_mfma_f32_16x16x32_bf16 v[128:131], a[184:187], v[180:183], v[128:131]
  v_mfma_f32_16x16x32_bf16 v[132:135], a[188:191], v[180:183], v[132:135]
  s_waitcnt lgkmcnt(3)
  v_mfma_f32_16x16x32_bf16 v[136:139], a[180:183], v[184:187], v[136:139]
  ds_read_b128 v[168:171], v14 offset:53248
  v_mfma_f32_16x16x32_bf16 v[140:143], a[184:187], v[184:187], v[140:143]
  v_mfma_f32_16x16x32_bf16 v[144:147], a[188:191], v[184:187], v[144:147]
  s_waitcnt lgkmcnt(3)
  v_mfma_f32_16x16x32_bf16 v[148:151], a[180:183], v[188:191], v[148:151]
  ds_read_b128 v[172:175], v14 offset:55296
  v_mfma_f32_16x16x32_bf16 v[152:155], a[184:187], v[188:191], v[152:155]
  v_mfma_f32_16x16x32_bf16 v[156:159], a[188:191], v[188:191], v[156:159]
  s_waitcnt lgkmcnt(3)
  v_mfma_f32_16x16x32_bf16 v[64:67], a[192:195], v[160:163], v[64:67]
  ds_read_b128 v[176:179], v14 offset:57344
  v_mfma_f32_16x16x32_bf16 v[68:71], a[196:199], v[160:163], v[68:71]
  s_add_u32 m0, s31, 16384
  v_mfma_f32_16x16x32_bf16 v[72:75], a[200:203], v[160:163], v[72:75]
  s_waitcnt lgkmcnt(3)
  buffer_load_dwordx4 v10, s[8:11], s30 offen lds
  v_mfma_f32_16x16x32_bf16 v[76:79], a[192:195], v[164:167], v[76:79]
  ds_read_b128 v[180:183], v14 offset:59392
  v_mfma_f32_16x16x32_bf16 v[80:83], a[196:199], v[164:167], v[80:83]
  v_mfma_f32_16x16x32_bf16 v[84:87], a[200:203], v[164:167], v[84:87]
  s_waitcnt lgkmcnt(3)
  v_mfma_f32_16x16x32_bf16 v[88:91], a[192:195], v[168:171], v[88:91]
  ds_read_b128 v[184:187], v14 offset:61440
  v_mfma_f32_16x16x32_bf16 v[92:95], a[196:199], v[168:171], v[92:95]
  s_add_u32 m0, s31, 17408
  v_mfma_f32_16x16x32_bf16 v[96:99], a[200:203], v[168:171], v[96:99]
  s_waitcnt lgkmcnt(3)
  buffer_load_dwordx4 v11, s[8:11], s30 offen lds
  v_mfma_f32_16x16x32_bf16 v[100:103], a[192:195], v[172:175], v[100:103]
  ds_read_b128 v[188:191], v14 offset:63488
  v_mfma_f32_16x16x32_bf16 v[104:107], a[196:199], v[172:175], v[104:107]
  v_mfma_f32_16x16x32_bf16 v[108:111], a[200:203], v[172:175], v[108:111]
  s_waitcnt lgkmcnt(3)
  v_mfma_f32_16x16x32_bf16 v[112:115], a[192:195], v[176:179], v[112:115]
  ds_read_b128 v[160:163], v15 offset:49152
  v_mfma_f32_16x16x32_bf16 v[116:119], a[196:199], v[176:179], v[116:119]
  s_add_u32 m0, s31, 18432
  v_mfma_f32_16x16x32_bf16 v[120:123], a[200:203], v[176:179], v[120:123]
  s_waitcnt lgkmcnt(3)
  buffer_load_dwordx4 v12, s[8:11], s30 offen lds
  v_mfma_f32_16x16x32_bf16 v[124:127], a[192:195], v[180:183], v[124:127]
  ds_read_b128 v[164:167], v15 offset:51200
  v_mfma_f32_16x16x32_bf16 v[128:131], a[196:199], v[180:183], v[128:131]
  v_mfma_f32_16x16x32_bf16 v[132:135], a[200:203], v[180:183], v[132:135]
  s_waitcnt lgkmcnt(3)
  v_mfma_f32_16x16x32_bf16 v[136:139], a[192:195], v[184:187], v[136:139]
  ds_read_b128 v[168:171], v15 offset:53248
  v_mfma_f32_16x16x32_bf16 v[140:143], a[196:199], v[184:187], v[140:143]
  s_add_u32 m0, s31, 19456
  v_mfma_f32_16x16x32_bf16 v[144:147], a[200:203], v[184:187], v[144:147]
  s_waitcnt lgkmcnt(3)
  buffer_load_dwordx4 v13, s[8:11], s30 offen lds
  v_mfma_f32_16x16x32_bf16 v[148:151], a[192:195], v[188:191], v[148:151]
  s_add_u32 s30, s30, 128
  ds_read_b128 v[172:175], v15 offset:55296
  v_mfma_f32_16x16x32_bf16 v[152:155], a[196:199], v[188:191], v[152:155]
  v_mfma_f32_16x16x32_bf16 v[156:159], a[200:203], v[188:191], v[156:159]
  s_waitcnt lgkmcnt(3)
  v_mfma_f32_16x16x32_bf16 v[64:67], a[204:207], v[160:163], v[64:67]
  ds_read_b128 v[176:179], v15 offset:57344
  v_mfma_f32_16x16x32_bf16 v[68:71], a[208:211], v[160:163], v[68:71]
  v_mfma_f32_16x16x32_bf16 v[72:75], a[212:215], v[160:163], v[72:75]
  s_waitcnt lgkmcnt(3)
  v_mfma_f32_16x16x32_bf16 v[76:79], a[204:207], v[164:167], v[76:79]
  ds_read_b128 v[180:183], v15 offset:59392
  v_mfma_f32_16x16x32_bf16 v[80:83], a[208:211], v[164:167], v[80:83]
  v_mfma_f32_16x16x32_bf16 v[84:87], a[212:215], v[164:167], v[84:87]
  s_waitcnt lgkmcnt(3)
  v_mfma_f32_16x16x32_bf16 v[88:91], a[204:207], v[168:171], v[88:91]
  ds_read_b128 v[184:187], v15 offset:61440
  v_mfma_f32_16x16x32_bf16 v[92:95], a[208:211], v[168:171], v[92:95]
  v_mfma_f32_16x16x32_bf16 v[96:99], a[212:215], v[168:171], v[96:99]
  s_waitcnt lgkmcnt(3)
  v_mfma_f32_16x16x32_bf16 v[100:103], a[204:207], v[172:175], v[100:103]
  ds_read_b128 v[188:191], v15 offset:63488
  v_mfma_f32_16x16x32_bf16 v[104:107], a[208:211], v[172:175], v[104:107]
  v_mfma_f32_16x16x32_bf16 v[108:111], a[212:215], v[172:175], v[108:111]
  s_waitcnt lgkmcnt(3)
  v_mfma_f32_16x16x32_bf16 v[112:115], a[204:207], v[176:179], v[112:115]
  s_waitcnt vmcnt(11)
  s_barrier
  ds_read_b128 v[160:163], v16 offset:0
  v_mfma_f32_16x16x32_bf16 v[116:119], a[208:211], v[176:179], v[116:119]
  v_mfma_f32_16x16x32_bf16 v[120:123], a[212:215], v[176:179], v[120:123]
  s_waitcnt lgkmcnt(3)
  v_mfma_f32_16x16x32_bf16 v[124:127], a[204:207], v[180:183], v[124:127]
  ds_read_b128 v[164:167], v16 offset:2048
  v_mfma_f32_16x16x32_bf16 v[128:131], a[208:211], v[180:183], v[128:131]
  v_mfma_f32_16x16x32_bf16 v[132:135], a[212:215], v[180:183], v[132:135]
  s_waitcnt lgkmcnt(3)
  v_mfma_f32_16x16x32_bf16 v[136:139], a[204:207], v[184:187], v[136:139]
  ds_read_b128 v[168:171], v16 offset:4096
  v_mfma_f32_16x16x32_bf16 v[140:143], a[208:211], v[184:187], v[140:143]
  v_mfma_f32_16x16x32_bf16 v[144:147], a[212:215], v[184:187], v[144:147]
  s_waitcnt lgkmcnt(3)
  v_mfma_f32_16x16x32_bf16 v[148:151], a[204:207], v[188:191], v[148:151]
  ds_read_b128 v[172:175], v16 offset:6144
  v_mfma_f32_16x16x32_bf16 v[152:155], a[208:211], v[188:191], v[152:155]
  v_mfma_f32_16x16x32_bf16 v[156:159], a[212:215], v[188:191], v[156:159]
  s_waitcnt lgkmcnt(3)
  v_mfma_f32_16x16x32_bf16 v[64:67], a[216:219], v[160:163], v[64:67]
  ds_read_b128 v[176:179], v16 offset:8192
  v_mfma_f32_16x16x32_bf16 v[68:71], a[220:223], v[160:163], v[68:71]
  s_add_u32 m0, s31, 32768
  v_mfma_f32_16x16x32_bf16 v[72:75], a[224:227], v[160:163], v[72:75]
  s_waitcnt lgkmcnt(3)
  buffer_load_dwordx4 v10, s[8:11], s30 offen lds
  v_mfma_f32_16x16x32_bf16 v[76:79], a[216:219], v[164:167], v[76:79]
  ds_read_b128 v[180:183], v16 offset:10240
  v_mfma_f32_16x16x32_bf16 v[80:83], a[220:223], v[164:167], v[80:83]
  v_mfma_f32_16x16x32_bf16 v[84:87], a[224:227], v[164:167], v[84:87]
  s_waitcnt lgkmcnt(3)
  v_mfma_f32_16x16x32_bf16 v[88:91], a[216:219], v[168:171], v[88:91]
  ds_read_b128 v[184:187], v16 offset:12288
  buffer_load_dword v32, v30, s[72:75], s77 offen sc1
  v_mfma_f32_16x16x32_bf16 v[92:95], a[220:223], v[168:171], v[92:95]
  s_add_u32 m0, s31, 33792
  s_waitcnt vmcnt(8)
  buffer_atomic_add v28, v33, s[72:75], s82 offen sc1
  v_mfma_f32_16x16x32_bf16 v[96:99], a[224:227], v[168:171], v[96:99]
  s_waitcnt lgkmcnt(3)
  buffer_load_dwordx4 v11, s[8:11], s30 offen lds
  s_mov_b32 s49, s43
  v_mfma_f32_16x16x32_bf16 v[100:103], a[216:219], v[172:175], v[100:103]
  ds_read_b128 v[188:191], v16 offset:14336
  s_add_u32 s43, s43, 4
  v_mfma_f32_16x16x32_bf16 v[104:107], a[220:223], v[172:175], v[104:107]
  s_mov_b32 s50, s45
  s_add_u32 s45, s45, 1572864
  s_mov_b32 s51, s46
  v_mfma_f32_16x16x32_bf16 v[108:111], a[224:227], v[172:175], v[108:111]
  s_waitcnt lgkmcnt(3)
  s_add_u32 s46, s46, 393216
  s_mov_b32 s81, s47
  v_mfma_f32_16x16x32_bf16 v[112:115], a[216:219], v[176:179], v[112:115]
  ds_read_b128 v[160:163], v17 offset:0
  s_add_u32 s47, s47, 327680
  v_mfma_f32_16x16x32_bf16 v[116:119], a[220:223], v[176:179], v[116:119]
  s_add_u32 m0, s31, 34816
  s_mov_b32 s82, s48
  s_add_u32 s48, s48, 4096
  v_mfma_f32_16x16x32_bf16 v[120:123], a[224:227], v[176:179], v[120:123]
  s_waitcnt lgkmcnt(3)
  buffer_load_dwordx4 v12, s[8:11], s30 offen lds
  v_mfma_f32_16x16x32_bf16 v[124:127], a[216:219], v[180:183], v[124:127]
  ds_read_b128 v[164:167], v17 offset:2048
  v_mfma_f32_16x16x32_bf16 v[128:131], a[220:223], v[180:183], v[128:131]
  v_mfma_f32_16x16x32_bf16 v[132:135], a[224:227], v[180:183], v[132:135]
  s_waitcnt lgkmcnt(3)
  v_mfma_f32_16x16x32_bf16 v[136:139], a[216:219], v[184:187], v[136:139]
  ds_read_b128 v[168:171], v17 offset:4096
  v_mfma_f32_16x16x32_bf16 v[140:143], a[220:223], v[184:187], v[140:143]
  s_add_u32 m0, s31, 35840
  v_mfma_f32_16x16x32_bf16 v[144:147], a[224:227], v[184:187], v[144:147]
  s_waitcnt lgkmcnt(3)
  buffer_load_dwordx4 v13, s[8:11], s30 offen lds
  v_mfma_f32_16x16x32_bf16 v[148:151], a[216:219], v[188:191], v[148:151]
  s_add_u32 s30, s30, 128
  ds_read_b128 v[172:175], v17 offset:6144
  v_mfma_f32_16x16x32_bf16 v[152:155], a[220:223], v[188:191], v[152:155]
  v_mfma_f32_16x16x32_bf16 v[156:159], a[224:227], v[188:191], v[156:159]
  s_waitcnt lgkmcnt(3)
  v_mfma_f32_16x16x32_bf16 v[64:67], a[228:231], v[160:163], v[64:67]
  ds_read_b128 v[176:179], v17 offset:8192
  v_mfma_f32_16x16x32_bf16 v[68:71], a[232:235], v[160:163], v[68:71]
  v_mfma_f32_16x16x32_bf16 v[72:75], a[236:239], v[160:163], v[72:75]
  s_waitcnt lgkmcnt(3)
  v_mfma_f32_16x16x32_bf16 v[76:79], a[228:231], v[164:167], v[76:79]
  ds_read_b128 v[180:183], v17 offset:10240
  v_cvt_pk_bf16_f32 v192, v64, v65
  v_mfma_f32_16x16x32_bf16 v[80:83], a[232:235], v[164:167], v[80:83]
  v_cvt_pk_bf16_f32 v193, v66, v67
  v_cvt_pk_bf16_f32 v194, v68, v69
  v_mfma_f32_16x16x32_bf16 v[84:87], a[236:239], v[164:167], v[84:87]
  s_waitcnt lgkmcnt(3)
  v_cvt_pk_bf16_f32 v195, v70, v71
  v_cvt_pk_bf16_f32 v200, v72, v73
  v_mfma_f32_16x16x32_bf16 v[88:91], a[228:231], v[168:171], v[88:91]
  ds_read_b128 v[184:187], v17 offset:12288
  v_cvt_pk_bf16_f32 v201, v74, v75
  v_mfma_f32_16x16x32_bf16 v[92:95], a[232:235], v[168:171], v[92:95]
  v_cvt_pk_bf16_f32 v196, v76, v77
  v_cvt_pk_bf16_f32 v197, v78, v79
  v_mfma_f32_16x16x32_bf16 v[96:99], a[236:239], v[168:171], v[96:99]
  s_waitcnt lgkmcnt(3)
  v_cvt_pk_bf16_f32 v198, v80, v81
  v_cvt_pk_bf16_f32 v199, v82, v83
  v_mfma_f32_16x16x32_bf16 v[100:103], a[228:231], v[172:175], v[100:103]
  ds_read_b128 v[188:191], v17 offset:14336
  v_cvt_pk_bf16_f32 v202, v84, v85
  v_mfma_f32_16x16x32_bf16 v[104:107], a[232:235], v[172:175], v[104:107]
  v_cvt_pk_bf16_f32 v203, v86, v87
  v_cvt_pk_bf16_f32 v204, v88, v89
  v_mfma_f32_16x16x32_bf16 v[108:111], a[236:239], v[172:175], v[108:111]
  s_waitcnt lgkmcnt(3)
  v_cvt_pk_bf16_f32 v205, v90, v91
  v_cvt_pk_bf16_f32 v206, v92, v93
  v_mfma_f32_16x16x32_bf16 v[112:115], a[228:231], v[176:179], v[112:115]
  s_waitcnt vmcnt(10)
  s_barrier
  ds_read_b128 v[160:163], v14 offset:0
  v_mfma_f32_16x16x32_bf16 v[116:119], a[232:235], v[176:179], v[116:119]
  v_cvt_pk_bf16_f32 v207, v94, v95
  v_cvt_pk_bf16_f32 v212, v96, v97
  v_mfma_f32_16x16x32_bf16 v[120:123], a[236:239], v[176:179], v[120:123]
  s_waitcnt lgkmcnt(3)
  v_cvt_pk_bf16_f32 v213, v98, v99
  v_cvt_pk_bf16_f32 v208, v100, v101
  v_mfma_f32_16x16x32_bf16 v[124:127], a[228:231], v[180:183], v[124:127]
  ds_read_b128 v[164:167], v14 offset:2048
  v_cvt_pk_bf16_f32 v209, v102, v103
  v_mfma_f32_16x16x32_bf16 v[128:131], a[232:235], v[180:183], v[128:131]
  v_cvt_pk_bf16_f32 v210, v104, v105
  v_cvt_pk_bf16_f32 v211, v106, v107
  v_mfma_f32_16x16x32_bf16 v[132:135], a[236:239], v[180:183], v[132:135]
  s_waitcnt lgkmcnt(3)
  v_cvt_pk_bf16_f32 v214, v108, v109
  v_cvt_pk_bf16_f32 v215, v110, v111
  v_mfma_f32_16x16x32_bf16 v[136:139], a[228:231], v[184:187], v[136:139]
  ds_read_b128 v[168:171], v14 offset:4096
  v_cvt_pk_bf16_f32 v216, v112, v113
  v_mfma_f32_16x16x32_bf16 v[140:143], a[232:235], v[184:187], v[140:143]
  v_cvt_pk_bf16_f32 v217, v114, v115
  v_cvt_pk_bf16_f32 v218, v116, v117
  v_mfma_f32_16x16x32_bf16 v[144:147], a[236:239], v[184:187], v[144:147]
  s_waitcnt lgkmcnt(3)
  v_cvt_pk_bf16_f32 v219, v118, v119
  v_cvt_pk_bf16_f32 v224, v120, v121
  v_mfma_f32_16x16x32_bf16 v[148:151], a[228:231], v[188:191], v[148:151]
  ds_read_b128 v[172:175], v14 offset:6144
  v_cvt_pk_bf16_f32 v225, v122, v123
  v_mfma_f32_16x16x32_bf16 v[152:155], a[232:235], v[188:191], v[152:155]
  s_sub_u32 s26, s26, 1
  s_cmp_gt_u32 s26, 0
  v_cvt_pk_bf16_f32 v220, v124, v125
  v_mfma_f32_16x16x32_bf16 v[156:159], a[236:239], v[188:191], v[156:159]
  s_waitcnt lgkmcnt(3)
  s_cbranch_scc1 qa_211
  s_nop 7
  v_cvt_pk_bf16_f32 v221, v126, v127
  v_cvt_pk_bf16_f32 v222, v128, v129
  v_cvt_pk_bf16_f32 v223, v130, v131
  v_cvt_pk_bf16_f32 v226, v132, v133
  v_cvt_pk_bf16_f32 v227, v134, v135
  v_cvt_pk_bf16_f32 v228, v136, v137
  v_cvt_pk_bf16_f32 v229, v138, v139
  v_cvt_pk_bf16_f32 v230, v140, v141
  v_cvt_pk_bf16_f32 v231, v142, v143
  v_cvt_pk_bf16_f32 v236, v144, v145
  v_cvt_pk_bf16_f32 v237, v146, v147
  v_cvt_pk_bf16_f32 v232, v148, v149
  v_cvt_pk_bf16_f32 v233, v150, v151
  v_cvt_pk_bf16_f32 v234, v152, v153
  v_cvt_pk_bf16_f32 v235, v154, v155
  v_cvt_pk_bf16_f32 v238, v156, v157
  v_cvt_pk_bf16_f32 v239, v158, v159
  ds_write_b128 v20, v[192:195] offset:0
  ds_write_b128 v20, v[196:199] offset:1024
  ds_write_b128 v20, v[200:203] offset:2048
  ds_write_b128 v20, v[204:207] offset:12288
  ds_write_b128 v20, v[208:211] offset:13312
  ds_write_b128 v20, v[212:215] offset:14336
  ds_write_b128 v20, v[216:219] offset:24576
  ds_write_b128 v20, v[220:223] offset:25600
  ds_write_b128 v20, v[224:227] offset:26624
  ds_write_b128 v20, v[228:231] offset:36864
  ds_write_b128 v20, v[232:235] offset:37888
  ds_write_b128 v20, v[236:239] offset:38912
  s_waitcnt lgkmcnt(0)
  s_barrier
  s_add_u32 s29, s50, 0
  buffer_load_dwordx4 v[192:195], v26, s[16:19], s29 offen offset:0 sc1
  buffer_load_dwordx4 v[196:199], v26, s[16:19], s29 offen offset:1024 sc1
  buffer_load_dwordx4 v[224:227], v26, s[16:19], s29 offen offset:2048 sc1
  s_add_u32 s29, s50, 3072
  buffer_load_dwordx4 v[200:203], v26, s[16:19], s29 offen offset:0 sc1
  buffer_load_dwordx4 v[204:207], v26, s[16:19], s29 offen offset:1024 sc1
  buffer_load_dwordx4 v[228:231], v26, s[16:19], s29 offen offset:2048 sc1
  s_add_u32 s29, s50, 6144
  buffer_load_dwordx4 v[208:211], v26, s[16:19], s29 offen offset:0 sc1
  buffer_load_dwordx4 v[212:215], v26, s[16:19], s29 offen offset:1024 sc1
  buffer_load_dwordx4 v[232:235], v26, s[16:19], s29 offen offset:2048 sc1
  s_add_u32 s29, s50, 9216
  buffer_load_dwordx4 v[216:219], v26, s[16:19], s29 offen offset:0 sc1
  buffer_load_dwordx4 v[220:223], v26, s[16:19], s29 offen offset:1024 sc1
  buffer_load_dwordx4 v[236:239], v26, s[16:19], s29 offen offset:2048 sc1
  ds_read_b128 v[64:67], v21 offset:0
  ds_read_b128 v[68:71], v21 offset:1024
  ds_read_b128 v[72:75], v21 offset:3072
  ds_read_b128 v[76:79], v21 offset:4096
  ds_read2st64_b64 v[80:83], v22 offset0:0 offset1:6
  ds_read2st64_b64 v[84:87], v23 offset0:0 offset1:6
  ds_read_b128 v[88:91], v21 offset:6144
  ds_read_b128 v[92:95], v21 offset:7168
  ds_read_b128 v[96:99], v21 offset:9216
  ds_read_b128 v[100:103], v21 offset:10240
  ds_read2st64_b64 v[104:107], v22 offset0:12 offset1:18
  ds_read2st64_b64 v[108:111], v23 offset0:12 offset1:18
  s_waitcnt vmcnt(0) lgkmcnt(0)
  v_swap_b32 v226, v228
  v_swap_b32 v227, v229
  v_swap_b32 v234, v236
  v_swap_b32 v235, v237
  s_nop 1
  v_mfma_f32_16x16x32_bf16 v[36:39], v[192:195], v[64:67], 0
  v_mfma_f32_16x16x32_bf16 v[44:47], v[192:195], v[68:71], 0
  v_mfma_f32_16x16x32_bf16 v[48:51], v[196:199], v[68:71], 0
  v_mfma_f32_16x16x32_bf16 v[36:39], v[200:203], v[72:75], v[36:39]
  v_mfma_f32_16x16x32_bf16 v[44:47], v[200:203], v[76:79], v[44:47]
  v_mfma_f32_16x16x32_bf16 v[48:51], v[204:207], v[76:79], v[48:51]
  v_mfma_f32_16x16x32_bf16 v[36:39], v[224:227], v[80:83], v[36:39]
  v_mfma_f32_16x16x32_bf16 v[44:47], v[224:227], v[84:87], v[44:47]
  v_mfma_f32_16x16x32_bf16 v[48:51], v[228:231], v[84:87], v[48:51]
  v_mfma_f32_16x16x32_bf16 v[36:39], v[208:211], v[88:91], v[36:39]
  v_mfma_f32_16x16x32_bf16 v[44:47], v[208:211], v[92:95], v[44:47]
  v_mfma_f32_16x16x32_bf16 v[48:51], v[212:215], v[92:95], v[48:51]
  v_mfma_f32_16x16x32_bf16 v[36:39], v[216:219], v[96:99], v[36:39]
  v_mfma_f32_16x16x32_bf16 v[44:47], v[216:219], v[100:103], v[44:47]
  v_mfma_f32_16x16x32_bf16 v[48:51], v[220:223], v[100:103], v[48:51]
  v_mfma_f32_16x16x32_bf16 v[36:39], v[232:235], v[104:107], v[36:39]
  v_mfma_f32_16x16x32_bf16 v[44:47], v[232:235], v[108:111], v[44:47]
  v_mfma_f32_16x16x32_bf16 v[48:51], v[236:239], v[108:111], v[48:51]
  s_sub_u32 s23, s49, 1
  s_min_u32 s23, s23, 62
  s_mov_b32 s101, 0
wm_214:
  buffer_load_dword v34, v30, s[72:75], s77 offen sc1
  s_add_u32 s101, s101, 1
  s_cmp_gt_u32 s101, 131072
  s_cbranch_scc1 main_end
  s_waitcnt vmcnt(0)
  v_cmp_gt_u32 vcc, s23, v34
  v_readfirstlane_b32 s100, v34
  s_nop 0
  s_cbranch_vccz wm_215
  s_sleep 4
  s_add_u32 s100, s100, 2
  s_cmp_ge_u32 s100, s23
  s_cbranch_scc1 wm_214
  s_sleep 60
  s_branch wm_214
wm_215:
  s_mov_b32 s101, 0
  s_branch qtp_217
qtp_216:
  s_sleep 3
qtp_217:
  buffer_load_dwordx4 v[112:115], v24, s[52:55], s51 offen offset:0 sc1
  buffer_load_dwordx2 v[240:241], v25, s[52:55], s51 offen offset:512 sc1
  buffer_load_dwordx4 v[116:119], v24, s[52:55], s51 offen offset:768 sc1
  buffer_load_dwordx2 v[242:243], v25, s[52:55], s51 offen offset:1280 sc1
  buffer_load_dwordx4 v[120:123], v24, s[52:55], s51 offen offset:1536 sc1
  buffer_load_dwordx2 v[244:245], v25, s[52:55], s51 offen offset:2048 sc1
  buffer_load_dwordx4 v[124:127], v24, s[52:55], s51 offen offset:2304 sc1
  buffer_load_dwordx2 v[246:247], v25, s[52:55], s51 offen offset:2816 sc1
  s_add_u32 s101, s101, 1
  s_cmp_gt_u32 s101, 131072
  s_cbranch_scc1 main_end
  s_waitcnt vmcnt(0)
  v_max3_u32 v34, v112, v116, v120
  v_max3_u32 v34, v34, v124, v240
  v_max3_u32 v34, v34, v242, v244
  v_max_u32 v34, v34, v246
  v_cmp_eq_u32 vcc, -1, v34
  s_nop 1
  s_cbranch_vccnz qtp_216
  v_mfma_f32_16x16x32_bf16 v[40:43], v[112:115], v[64:67], 0
  v_mfma_f32_16x16x32_bf16 v[52:55], v[112:115], v[68:71], 0
  v_mfma_f32_16x16x32_bf16 v[40:43], v[116:119], v[72:75], v[40:43]
  v_mfma_f32_16x16x32_bf16 v[52:55], v[116:119], v[76:79], v[52:55]
  v_mfma_f32_16x16x32_bf16 v[40:43], v[240:243], v[80:83], v[40:43]
  v_mfma_f32_16x16x32_bf16 v[52:55], v[240:243], v[84:87], v[52:55]
  v_mfma_f32_16x16x32_bf16 v[40:43], v[120:123], v[88:91], v[40:43]
  v_mfma_f32_16x16x32_bf16 v[52:55], v[120:123], v[92:95], v[52:55]
  v_mfma_f32_16x16x32_bf16 v[40:43], v[124:127], v[96:99], v[40:43]
  v_mfma_f32_16x16x32_bf16 v[52:55], v[124:127], v[100:103], v[52:55]
  v_mfma_f32_16x16x32_bf16 v[40:43], v[244:247], v[104:107], v[40:43]
  v_mfma_f32_16x16x32_bf16 v[52:55], v[244:247], v[108:111], v[52:55]
  s_nop 4
  v_cndmask_b32 v36, v31, v36, s[64:65]
  v_cndmask_b32 v48, v31, v48, s[64:65]
  v_cndmask_b32 v37, v31, v37, s[66:67]
  v_cndmask_b32 v49, v31, v49, s[66:67]
  v_cndmask_b32 v38, v31, v38, s[68:69]
  v_cndmask_b32 v50, v31, v50, s[68:69]
  v_cndmask_b32 v39, v31, v39, s[70:71]
  v_cndmask_b32 v51, v31, v51, s[70:71]
  v_max3_f32 v34, v36, v37, v38
  v_max3_f32 v34, v34, v39, v40
  v_max3_f32 v34, v34, v41, v42
  v_max_f32 v34, v34, v43
  v_mov_b32 v35, v34
  s_nop 1
  v_permlane32_swap_b32 v34, v35
  v_max_f32 v34, v34, v35
  v_mov_b32 v35, v34
  s_nop 1
  v_permlane16_swap_b32 v34, v35
  v_max_f32 v34, v34, v35
  v_mul_f32 v34, s83, v34
  v_fma_f32 v36, v36, s83, -v34
  v_fma_f32 v37, v37, s83, -v34
  v_fma_f32 v38, v38, s83, -v34
  v_fma_f32 v39, v39, s83, -v34
  v_fma_f32 v40, v40, s83, -v34
  v_fma_f32 v41, v41, s83, -v34
  v_fma_f32 v42, v42, s83, -v34
  v_fma_f32 v43, v43, s83, -v34
  v_exp_f32 v36, v36
  v_exp_f32 v37, v37
  v_exp_f32 v38, v38
  v_exp_f32 v39, v39
  v_exp_f32 v40, v40
  v_exp_f32 v41, v41
  v_exp_f32 v42, v42
  v_exp_f32 v43, v43
  s_nop 0
  v_add_f32 v34, v40, v41
  v_add_f32 v34, v34, v42
  v_add_f32 v34, v34, v43
  v_cndmask_b32 v34, 0, v34, s[62:63]
  v_add_f32 v34, v34, v36
  v_add_f32 v34, v34, v37
  v_add_f32 v34, v34, v38
  v_add_f32 v34, v34, v39
  v_mov_b32 v35, v34
  s_nop 1
  v_permlane32_swap_b32 v34, v35
  v_add_f32 v34, v34, v35
  v_mov_b32 v35, v34
  s_nop 1
  v_permlane16_swap_b32 v34, v35
  v_add_f32 v34, v34, v35
  v_rcp_f32 v34, v34
  s_nop 0
  v_mul_f32 v36, v36, v34
  v_mul_f32 v37, v37, v34
  v_mul_f32 v38, v38, v34
  v_mul_f32 v39, v39, v34
  v_mul_f32 v40, v40, v34
  v_mul_f32 v41, v41, v34
  v_mul_f32 v42, v42, v34
  v_mul_f32 v43, v43, v34
  v_max3_f32 v34, v44, v45, v46
  v_max3_f32 v34, v34, v47, v48
  v_max3_f32 v34, v34, v49, v50
  v_max3_f32 v34, v34, v51, v52
  v_max3_f32 v34, v34, v53, v54
  v_max_f32 v34, v34, v55
  v_mov_b32 v35, v34
  s_nop 1
  v_permlane32_swap_b32 v34, v35
  v_max_f32 v34, v34, v35
  v_mov_b32 v35, v34
  s_nop 1
  v_permlane16_swap_b32 v34, v35
  v_max_f32 v34, v34, v35
  v_mul_f32 v34, s83, v34
  v_fma_f32 v44, v44, s83, -v34
  v_fma_f32 v45, v45, s83, -v34
  v_fma_f32 v46, v46, s83, -v34
  v_fma_f32 v47, v47, s83, -v34
  v_fma_f32 v48, v48, s83, -v34
  v_fma_f32 v49, v49, s83, -v34
  v_fma_f32 v50, v50, s83, -v34
  v_fma_f32 v51, v51, s83, -v34
  v_fma_f32 v52, v52, s83, -v34
  v_fma_f32 v53, v53, s83, -v34
  v_fma_f32 v54, v54, s83, -v34
  v_fma_f32 v55, v55, s83, -v34
  v_exp_f32 v44, v44
  v_exp_f32 v45, v45
  v_exp_f32 v46, v46
  v_exp_f32 v47, v47
  v_exp_f32 v48, v48
  v_exp_f32 v49, v49
  v_exp_f32 v50, v50
  v_exp_f32 v51, v51
  v_exp_f32 v52, v52
  v_exp_f32 v53, v53
  v_exp_f32 v54, v54
  v_exp_f32 v55, v55
  s_nop 0
  v_add_f32 v34, v52, v53
  v_add_f32 v34, v34, v54
  v_add_f32 v34, v34, v55
  v_cndmask_b32 v34, 0, v34, s[62:63]
  v_add_f32 v34, v34, v44
  v_add_f32 v34, v34, v45
  v_add_f32 v34, v34, v46
  v_add_f32 v34, v34, v47
  v_add_f32 v34, v34, v48
  v_add_f32 v34, v34, v49
  v_add_f32 v34, v34, v50
  v_add_f32 v34, v34, v51
  v_mov_b32 v35, v34
  s_nop 1
  v_permlane32_swap_b32 v34, v35
  v_add_f32 v34, v34, v35
  v_mov_b32 v35, v34
  s_nop 1
  v_permlane16_swap_b32 v34, v35
  v_add_f32 v34, v34, v35
  v_rcp_f32 v34, v34
  s_nop 0
  v_mul_f32 v44, v44, v34
  v_mul_f32 v45, v45, v34
  v_mul_f32 v46, v46, v34
  v_mul_f32 v47, v47, v34
  v_mul_f32 v48, v48, v34
  v_mul_f32 v49, v49, v34
  v_mul_f32 v50, v50, v34
  v_mul_f32 v51, v51, v34
  v_mul_f32 v52, v52, v34
  v_mul_f32 v53, v53, v34
  v_mul_f32 v54, v54, v34
  v_mul_f32 v55, v55, v34
  v_cvt_pk_bf16_f32 v56, v44, v45
  v_cvt_pk_bf16_f32 v57, v46, v47
  v_cvt_pk_bf16_f32 v58, v48, v49
  v_cvt_pk_bf16_f32 v59, v50, v51
  v_cvt_pk_bf16_f32 v60, v40, v41
  v_cvt_pk_bf16_f32 v61, v42, v43
  v_cvt_pk_bf16_f32 v62, v52, v53
  v_cvt_pk_bf16_f32 v63, v54, v55
  v_cvt_pk_bf16_f32 v248, v36, v37
  v_cvt_pk_bf16_f32 v249, v38, v39
  buffer_store_dwordx4 v[56:59], v26, s[56:59], s81 offen sc1
  buffer_store_dwordx4 v[60:63], v26, s[56:59], s81 offen offset:1024 sc1
  buffer_store_dwordx2 v[248:249], v29, s[56:59], s81 offen offset:2048 sc1
  s_waitcnt vmcnt(0)
  buffer_atomic_add v28, v33, s[72:75], s82 offen sc1
  s_branch qe_218
qw_212:
  s_mov_b32 s101, 0
wm_219:
  buffer_load_dword v32, v30, s[72:75], s77 offen sc1
  s_add_u32 s101, s101, 1
  s_cmp_gt_u32 s101, 131072
  s_cbranch_scc1 main_end
  s_waitcnt vmcnt(0)
  v_cmp_gt_u32 vcc, s49, v32
  v_readfirstlane_b32 s100, v32
  s_nop 0
  s_cbranch_vccz wm_220
  s_sleep 4
  s_add_u32 s100, s100, 2
  s_cmp_ge_u32 s100, s49
  s_cbranch_scc1 wm_219
  s_sleep 60
  s_branch wm_219
wm_220:
  s_branch qj_213
qe_218:
queue:
  s_load_dwordx2 s[4:5], s[0:1], 88
  s_load_dwordx2 s[6:7], s[0:1], 72
  s_load_dwordx2 s[38:39], s[0:1], 104
  s_and_b32 s41, s3, 7
  s_lshr_b32 s58, s3, 4
  s_bfe_u32 s21, s3, 0x20003
  s_cmp_lt_u32 s3, 64
  s_cselect_b32 s58, s58, s21
  s_lshl_b32 s59, s58, 3
  s_add_u32 s59, s59, s41
  s_lshl_b32 s59, s59, 7
  s_add_u32 s59, s59, 92672
  s_waitcnt vmcnt(0) lgkmcnt(0)
  s_barrier
  s_mov_b32 s8, s4
  s_mov_b32 s9, s5
  s_mov_b32 s10, 2621440
  s_mov_b32 s11, 0x00020000
  s_mov_b32 s12, s6
  s_mov_b32 s13, s7
  s_mov_b32 s14, 819200
  s_mov_b32 s15, 0x00020000
  s_add_u32 s16, s38, 85983232
  s_addc_u32 s17, s39, 0
  s_mov_b32 s18, 28311552
  s_mov_b32 s19, 0x00020000
  s_add_u32 s24, s38, 70778880
  s_addc_u32 s25, s39, 0
  s_mov_b32 s26, 2621440
  s_mov_b32 s27, 0x00020000
  s_add_u32 s28, s38, 81002496
  s_addc_u32 s29, s39, 0
  s_mov_b32 s30, 8192
  s_mov_b32 s31, 0x00020000
  s_add_u32 s72, s38, 81068032
  s_addc_u32 s73, s39, 0
  s_mov_b32 s74, 96768
  s_mov_b32 s75, 0x00020000
  v_mov_b32 v28, 0
  v_mov_b32 v30, 102400
  s_cmp_lg_u32 s20, 0
  s_cbranch_scc1 pvc_221
  v_mov_b32 v29, 1
  s_mov_b64 exec, 1
  buffer_atomic_add v29, v28, s[72:75], s59 offen sc0 sc1
  s_waitcnt vmcnt(0)
  ds_write_b32 v30, v29
  s_waitcnt lgkmcnt(0)
  s_mov_b64 exec, -1
pvc_221:
  s_barrier
  ds_read_b32 v23, v30
  s_waitcnt lgkmcnt(0)
  v_readfirstlane_b32 s2, v23
  s_cmp_ge_u32 s2, 16
  s_cbranch_scc1 main_fin
  s_mul_i32 s21, s20, 204800
  s_mul_i32 s22, s41, 160
  s_add_u32 s21, s21, s22
  s_mul_i32 s22, s20, 25600
  v_add_u32 v5, 0, v1
  v_mul_u32_u24 v6, 6554, v5
  v_lshrrev_b32 v6, 16, v6
  v_mul_u32_u24 v6, 1120, v6
  v_lshl_add_u32 v8, v5, 4, v6
  v_add_u32 v5, 64, v1
  v_mul_u32_u24 v6, 6554, v5
  v_lshrrev_b32 v6, 16, v6
  v_mul_u32_u24 v6, 1120, v6
  v_lshl_add_u32 v9, v5, 4, v6
  v_add_u32 v5, 128, v1
  v_mul_u32_u24 v6, 6554, v5
  v_lshrrev_b32 v6, 16, v6
  v_mul_u32_u24 v6, 1120, v6
  v_lshl_add_u32 v10, v5, 4, v6
  v_add_u32 v5, 192, v1
  v_mul_u32_u24 v6, 6554, v5
  v_lshrrev_b32 v6, 16, v6
  v_mul_u32_u24 v6, 1120, v6
  v_lshl_add_u32 v11, v5, 4, v6
  v_add_u32 v5, 256, v1
  v_mul_u32_u24 v6, 6554, v5
  v_lshrrev_b32 v6, 16, v6
  v_mul_u32_u24 v6, 1120, v6
  v_lshl_add_u32 v12, v5, 4, v6
  s_add_u32 m0, s22, 0
  s_nop 0
  buffer_load_dwordx4 v8, s[12:15], s21 offen lds
  s_add_u32 m0, s22, 1024
  s_nop 0
  buffer_load_dwordx4 v9, s[12:15], s21 offen lds
  s_add_u32 m0, s22, 2048
  s_nop 0
  buffer_load_dwordx4 v10, s[12:15], s21 offen lds
  s_add_u32 m0, s22, 3072
  s_nop 0
  buffer_load_dwordx4 v11, s[12:15], s21 offen lds
  s_add_u32 m0, s22, 4096
  s_nop 0
  buffer_load_dwordx4 v12, s[12:15], s21 offen lds
  s_add_u32 s21, s21, 40960
  s_add_u32 m0, s22, 5120
  s_nop 0
  buffer_load_dwordx4 v8, s[12:15], s21 offen lds
  s_add_u32 m0, s22, 6144
  s_nop 0
  buffer_load_dwordx4 v9, s[12:15], s21 offen lds
  s_add_u32 m0, s22, 7168
  s_nop 0
  buffer_load_dwordx4 v10, s[12:15], s21 offen lds
  s_add_u32 m0, s22, 8192
  s_nop 0
  buffer_load_dwordx4 v11, s[12:15], s21 offen lds
  s_add_u32 m0, s22, 9216
  s_nop 0
  buffer_load_dwordx4 v12, s[12:15], s21 offen lds
  s_add_u32 s21, s21, 40960
  s_add_u32 m0, s22, 10240
  s_nop 0
  buffer_load_dwordx4 v8, s[12:15], s21 offen lds
  s_add_u32 m0, s22, 11264
  s_nop 0
  buffer_load_dwordx4 v9, s[12:15], s21 offen lds
  s_add_u32 m0, s22, 12288
  s_nop 0
  buffer_load_dwordx4 v10, s[12:15], s21 offen lds
  s_add_u32 m0, s22, 13312
  s_nop 0
  buffer_load_dwordx4 v11, s[12:15], s21 offen lds
  s_add_u32 m0, s22, 14336
  s_nop 0
  buffer_load_dwordx4 v12, s[12:15], s21 offen lds
  s_add_u32 s21, s21, 40960
  s_add_u32 m0, s22, 15360
  s_nop 0
  buffer_load_dwordx4 v8, s[12:15], s21 offen lds
  s_add_u32 m0, s22, 16384
  s_nop 0
  buffer_load_dwordx4 v9, s[12:15], s21 offen lds
  s_add_u32 m0, s22, 17408
  s_nop 0
  buffer_load_dwordx4 v10, s[12:15], s21 offen lds
  s_add_u32 m0, s22, 18432
  s_nop 0
  buffer_load_dwordx4 v11, s[12:15], s21 offen lds
  s_add_u32 m0, s22, 19456
  s_nop 0
  buffer_load_dwordx4 v12, s[12:15], s21 offen lds
  s_add_u32 s21, s21, 40960
  s_add_u32 m0, s22, 20480
  s_nop 0
  buffer_load_dwordx4 v8, s[12:15], s21 offen lds
  s_add_u32 m0, s22, 21504
  s_nop 0
  buffer_load_dwordx4 v9, s[12:15], s21 offen lds
  s_add_u32 m0, s22, 22528
  s_nop 0
  buffer_load_dwordx4 v10, s[12:15], s21 offen lds
  s_add_u32 m0, s22, 23552
  s_nop 0
  buffer_load_dwordx4 v11, s[12:15], s21 offen lds
  s_add_u32 m0, s22, 24576
  s_nop 0
  buffer_load_dwordx4 v12, s[12:15], s21 offen lds
  s_add_u32 s21, s21, 40960
  v_and_b32 v25, 3, v1
  v_lshlrev_b32 v25, 7, v25
  s_mov_b32 s21, 88064
  v_lshrrev_b32 v5, 2, v2
  v_and_b32 v6, 3, v2
  v_lshlrev_b32 v6, 3, v6
  v_lshl_add_u32 v7, v3, 2, v5
  v_mul_u32_u24 v7, 160, v7
  v_add3_u32 v8, v7, v6, s22
  v_add_u32 v9, v8, v6
  v_mul_u32_u24 v7, 20, v3
  v_add_u32 v7, v7, v5
  v_mul_u32_u24 v7, 160, v7
  v_add3_u32 v10, v7, v6, s22
  v_add_u32 v11, v10, v6
  s_mov_b32 s101, 0
wm_222:
  buffer_load_dword v26, v25, s[72:75], s21 offen sc1
  s_add_u32 s101, s101, 1
  s_cmp_gt_u32 s101, 131072
  s_cbranch_scc1 main_end
  s_waitcnt vmcnt(0)
  v_cmp_gt_u32 vcc, 8, v26
  v_readfirstlane_b32 s100, v26
  s_nop 0
  s_cbranch_vccz wm_223
  s_sleep 16
  s_branch wm_222
wm_223:
  ds_read_b64_tr_b16 a[160:161], v9 offset:0
  ds_read_b64_tr_b16 a[162:163], v9 offset:3200
  ds_read_b64_tr_b16 a[164:165], v9 offset:8
  ds_read_b64_tr_b16 a[166:167], v9 offset:3208
  ds_read_b64_tr_b16 a[168:169], v8 offset:64
  ds_read_b64_tr_b16 a[170:171], v8 offset:3264
  ds_read_b64_tr_b16 a[172:173], v9 offset:96
  ds_read_b64_tr_b16 a[174:175], v9 offset:3296
  ds_read_b64_tr_b16 a[176:177], v9 offset:104
  ds_read_b64_tr_b16 a[178:179], v9 offset:3304
  ds_read_b64_tr_b16 a[180:181], v9 offset:6400
  ds_read_b64_tr_b16 a[182:183], v9 offset:9600
  ds_read_b64_tr_b16 a[184:185], v9 offset:6408
  ds_read_b64_tr_b16 a[186:187], v9 offset:9608
  ds_read_b64_tr_b16 a[188:189], v8 offset:6464
  ds_read_b64_tr_b16 a[190:191], v8 offset:9664
  ds_read_b64_tr_b16 a[192:193], v9 offset:6496
  ds_read_b64_tr_b16 a[194:195], v9 offset:9696
  ds_read_b64_tr_b16 a[196:197], v9 offset:6504
  ds_read_b64_tr_b16 a[198:199], v9 offset:9704
  ds_read_b64_tr_b16 a[200:201], v9 offset:12800
  ds_read_b64_tr_b16 a[202:203], v9 offset:16000
  ds_read_b64_tr_b16 a[204:205], v9 offset:12808
  ds_read_b64_tr_b16 a[206:207], v9 offset:16008
  ds_read_b64_tr_b16 a[208:209], v8 offset:12864
  ds_read_b64_tr_b16 a[210:211], v8 offset:16064
  ds_read_b64_tr_b16 a[212:213], v9 offset:12896
  ds_read_b64_tr_b16 a[214:215], v9 offset:16096
  ds_read_b64_tr_b16 a[216:217], v9 offset:12904
  ds_read_b64_tr_b16 a[218:219], v9 offset:16104
  ds_read_b64_tr_b16 a[220:221], v9 offset:19200
  ds_read_b64_tr_b16 a[222:223], v9 offset:22400
  ds_read_b64_tr_b16 a[224:225], v9 offset:19208
  ds_read_b64_tr_b16 a[226:227], v9 offset:22408
  ds_read_b64_tr_b16 a[228:229], v8 offset:19264
  ds_read_b64_tr_b16 a[230:231], v8 offset:22464
  ds_read_b64_tr_b16 a[232:233], v9 offset:19296
  ds_read_b64_tr_b16 a[234:235], v9 offset:22496
  ds_read_b64_tr_b16 a[236:237], v9 offset:19304
  ds_read_b64_tr_b16 a[238:239], v9 offset:22504
  ds_read_b64_tr_b16 a[240:241], v11 offset:2560
  ds_read_b64_tr_b16 a[242:243], v11 offset:15360
  ds_read_b64_tr_b16 a[244:245], v11 offset:2568
  ds_read_b64_tr_b16 a[246:247], v11 offset:15368
  ds_read_b64_tr_b16 a[248:249], v10 offset:2624
  ds_read_b64_tr_b16 a[250:251], v10 offset:15424
  ds_read_b64_tr_b16 a[252:253], v11 offset:2656
  ds_read_b64_tr_b16 a[254:255], v11 offset:15456
  ds_read_b64_tr_b16 v[252:253], v11 offset:2664
  ds_read_b64_tr_b16 v[254:255], v11 offset:15464
  s_waitcnt lgkmcnt(0)
  s_barrier
  s_add_u32 s12, s38, 114294784
  s_addc_u32 s13, s39, 0
  s_mov_b32 s14, 83886080
  s_mov_b32 s15, 0x00020000
  v_lshlrev_b32 v4, 4, v1
  v_lshlrev_b32 v5, 3, v1
  v_lshlrev_b32 v6, 2, v2
  v_and_b32 v7, 7, v1
  v_lshlrev_b32 v7, 7, v7
  v_bfe_u32 v31, v1, 3, 2
  v_lshl_add_u32 v31, v31, 2, v7
  s_lshl_b32 s21, s20, 10
  s_add_u32 s21, s21, 88576
  buffer_load_dword v8, v31, s[72:75], s21 offen sc1
  s_mov_b32 s63, 1
  v_mul_u32_u24 v9, 1280, v2
  v_lshl_add_u32 v13, v3, 3, v9
  v_lshl_add_u32 v9, v3, 4, v9
  s_mul_i32 s21, s20, 10240
  v_add_u32 v10, s21, v4
  s_and_b32 s43, s20, 1
  s_lshr_b32 s44, s20, 1
  s_mul_i32 s21, s44, 6
  s_add_u32 s21, s21, s43
  s_lshl_b32 s21, s21, 10
  v_add_u32 v11, s21, v4
  s_add_u32 s21, s43, 4
  s_lshl_b32 s21, s21, 10
  v_add_u32 v12, s21, v4
  v_lshrrev_b32 v20, 5, v1
  v_mul_u32_u24 v21, 2560, v20
  v_add_u32 v21, v21, v4
  v_and_b32 v22, 31, v1
  v_lshlrev_b32 v22, 4, v22
  v_mul_u32_u24 v14, 10240, v20
  v_add_u32 v22, v22, v14
  v_and_b32 v15, 1, v3
  v_lshl_add_u32 v14, v15, 6, v14
  v_lshrrev_b32 v16, 3, v2
  v_mul_u32_u24 v16, 576, v16
  v_lshl_add_u32 v16, v2, 3, v16
  v_add_u32 v14, v14, v16
  v_add_u32 v15, 40960, v11
  v_lshlrev_b32 v17, 2, v7
  v_bfe_u32 v16, v1, 3, 1
  v_lshl_add_u32 v17, v16, 3, v17
  v_cmp_gt_u32 s[66:67], 16, v1
  v_add_u32 v16, 40960, v12
  s_mov_b32 s50, 0
  s_lshr_b32 s52, s41, 1
  s_lshl_b32 s52, s52, 7
  s_and_b32 s21, s41, 1
  s_lshl_b32 s21, s21, 4
  s_add_u32 s52, s52, s21
  s_add_u32 s52, s52, 18432
  v_mov_b32 v70, 0
  v_mov_b32 v71, 0
  v_mov_b32 v78, 0
  v_mov_b32 v79, 0
  v_mov_b32 v86, 0
  v_mov_b32 v87, 0
  v_mov_b32 v94, 0
  v_mov_b32 v95, 0
  v_mov_b32 v102, 0
  v_mov_b32 v103, 0
  v_mov_b32 v110, 0
  v_mov_b32 v111, 0
  v_mov_b32 v118, 0
  v_mov_b32 v119, 0
  v_mov_b32 v126, 0
  v_mov_b32 v127, 0
pv_loop:
  s_lshl_b32 s40, s2, 2
  s_add_u32 s40, s40, s58
  s_lshl_b32 s2, s40, 3
  s_add_u32 s2, s2, s41
  s_mul_i32 s54, s40, 40960
  s_mul_i32 s21, s20, 5120
  s_add_u32 s54, s54, s21
  s_add_u32 s21, s54, 0
  buffer_load_dwordx4 v[192:195], v4, s[24:27], s21 offen offset:0 sc1
  buffer_load_dwordx4 v[196:199], v4, s[24:27], s21 offen offset:1024 sc1
  buffer_load_dwordx2 v[208:209], v5, s[24:27], s21 offen offset:2048 sc1
  s_add_u32 s21, s54, 2560
  buffer_load_dwordx4 v[200:203], v4, s[24:27], s21 offen offset:0 sc1
  buffer_load_dwordx4 v[204:207], v4, s[24:27], s21 offen offset:1024 sc1
  buffer_load_dwordx2 v[210:211], v5, s[24:27], s21 offen offset:2048 sc1
  s_add_u32 s21, s54, 20480
  buffer_load_dwordx4 v[212:215], v4, s[24:27], s21 offen offset:0 sc1
  buffer_load_dwordx4 v[216:219], v4, s[24:27], s21 offen offset:1024 sc1
  buffer_load_dwordx2 v[228:229], v5, s[24:27], s21 offen offset:2048 sc1
  s_add_u32 s21, s54, 23040
  buffer_load_dwordx4 v[220:223], v4, s[24:27], s21 offen offset:0 sc1
  buffer_load_dwordx4 v[224:227], v4, s[24:27], s21 offen offset:1024 sc1
  buffer_load_dwordx2 v[230:231], v5, s[24:27], s21 offen offset:2048 sc1
  s_lshl_b32 s21, s40, 10
  s_add_u32 s21, s21, 22528
  v_add_u32 v18, s21, v7
  v_add_u32 v19, s52, v17
  v_cndmask_b32 v18, v19, v18, s[66:67]
  s_add_u32 s21, s40, 1
  v_mov_b32 v19, s21
  v_cndmask_b32 v19, v19, 4, s[66:67]
  buffer_load_dword v27, v18, s[72:75], 0 offen sc1
  s_cmp_lg_u32 s20, 0
  s_cbranch_scc1 pv_224
  v_mov_b32 v29, 1
  s_mov_b64 exec, 1
  buffer_atomic_add v29, v28, s[72:75], s59 offen sc0 sc1
  s_mov_b64 exec, -1
pv_224:
  s_lshl_b32 s42, s40, 5
  s_lshl_b32 s21, s20, 3
  s_add_u32 s42, s42, s21
  s_mul_i32 s53, s42, 40960
  s_mul_i32 s22, s41, 5120
  s_add_u32 s53, s53, s22
  s_lshl_b32 s21, s40, 1
  s_add_u32 s21, s21, s43
  s_lshl_b32 s45, s21, 6
  s_mul_i32 s46, s21, 20480
  s_mul_i32 s22, s41, 160
  s_add_u32 s49, s46, s22
  s_mul_i32 s21, s44, 96
  s_add_u32 s46, s49, s21
  s_mul_i32 s47, s42, 2560
  s_mul_i32 s48, s42, 10240
  s_mul_i32 s22, s41, 1280
  s_add_u32 s48, s48, s22
  s_add_u32 s48, s48, 7340032
  s_add_u32 s23, s40, 1
  s_cmp_ge_u32 s50, s23
  s_cbranch_scc1 pv_225
  s_cmp_eq_u32 s63, 0
  s_cbranch_scc1 pv_228
  s_mov_b32 s63, 0
  s_waitcnt vmcnt(13)
  v_cmp_gt_u32 vcc, s23, v8
  s_nop 1
  s_cbranch_vccz pv_229
pv_228:
  s_lshl_b32 s21, s20, 10
  s_add_u32 s21, s21, 88576
  s_mov_b32 s101, 0
wm_232:
  buffer_load_dword v8, v31, s[72:75], s21 offen sc1
  s_add_u32 s101, s101, 1
  s_cmp_gt_u32 s101, 131072
  s_cbranch_scc1 main_end
  s_waitcnt vmcnt(0)
  v_cmp_gt_u32 vcc, s23, v8
  v_readfirstlane_b32 s100, v8
  s_nop 0
  s_cbranch_vccz wm_233
  s_sleep 8
  s_add_u32 s100, s100, 2
  s_cmp_ge_u32 s100, s23
  s_cbranch_scc1 wm_232
  s_sleep 60
  s_branch wm_232
wm_233:
pv_229:
  v_readlane_b32 s50, v8, 0
  v_readlane_b32 s21, v8, 1
  s_min_u32 s50, s50, s21
  v_readlane_b32 s21, v8, 2
  s_min_u32 s50, s50, s21
  v_readlane_b32 s21, v8, 3
  s_min_u32 s50, s50, s21
  v_readlane_b32 s21, v8, 4
  s_min_u32 s50, s50, s21
  v_readlane_b32 s21, v8, 5
  s_min_u32 s50, s50, s21
  v_readlane_b32 s21, v8, 6
  s_min_u32 s50, s50, s21
  v_readlane_b32 s21, v8, 7
  s_min_u32 s50, s50, s21
  v_readlane_b32 s21, v8, 8
  s_min_u32 s50, s50, s21
  v_readlane_b32 s21, v8, 9
  s_min_u32 s50, s50, s21
  v_readlane_b32 s21, v8, 10
  s_min_u32 s50, s50, s21
  v_readlane_b32 s21, v8, 11
  s_min_u32 s50, s50, s21
  v_readlane_b32 s21, v8, 12
  s_min_u32 s50, s50, s21
  v_readlane_b32 s21, v8, 13
  s_min_u32 s50, s50, s21
  v_readlane_b32 s21, v8, 14
  s_min_u32 s50, s50, s21
  v_readlane_b32 s21, v8, 15
  s_min_u32 s50, s50, s21
  v_readlane_b32 s21, v8, 16
  s_min_u32 s50, s50, s21
  v_readlane_b32 s21, v8, 17
  s_min_u32 s50, s50, s21
  v_readlane_b32 s21, v8, 18
  s_min_u32 s50, s50, s21
  v_readlane_b32 s21, v8, 19
  s_min_u32 s50, s50, s21
  v_readlane_b32 s21, v8, 20
  s_min_u32 s50, s50, s21
  v_readlane_b32 s21, v8, 21
  s_min_u32 s50, s50, s21
  v_readlane_b32 s21, v8, 22
  s_min_u32 s50, s50, s21
  v_readlane_b32 s21, v8, 23
  s_min_u32 s50, s50, s21
  v_readlane_b32 s21, v8, 24
  s_min_u32 s50, s50, s21
  v_readlane_b32 s21, v8, 25
  s_min_u32 s50, s50, s21
  v_readlane_b32 s21, v8, 26
  s_min_u32 s50, s50, s21
  v_readlane_b32 s21, v8, 27
  s_min_u32 s50, s50, s21
  v_readlane_b32 s21, v8, 28
  s_min_u32 s50, s50, s21
  v_readlane_b32 s21, v8, 29
  s_min_u32 s50, s50, s21
  v_readlane_b32 s21, v8, 30
  s_min_u32 s50, s50, s21
  v_readlane_b32 s21, v8, 31
  s_min_u32 s50, s50, s21
pv_225:
  buffer_load_dword v24, v6, s[28:31], s45 offen sc1
  buffer_load_dwordx4 a[0:3], v4, s[12:15], s53 offen offset:0 sc1
  buffer_load_dwordx4 a[4:7], v4, s[12:15], s53 offen offset:1024 sc1
  buffer_load_dwordx4 a[8:11], v4, s[12:15], s53 offen offset:2048 sc1
  buffer_load_dwordx4 a[12:15], v4, s[12:15], s53 offen offset:3072 sc1
  s_add_u32 s21, s53, 4096
  buffer_load_dwordx4 a[16:19], v4, s[12:15], s21 offen offset:0 sc1
  s_add_u32 s53, s53, 40960
  buffer_load_dwordx4 a[20:23], v4, s[12:15], s53 offen offset:0 sc1
  buffer_load_dwordx4 a[24:27], v4, s[12:15], s53 offen offset:1024 sc1
  buffer_load_dwordx4 a[28:31], v4, s[12:15], s53 offen offset:2048 sc1
  buffer_load_dwordx4 a[32:35], v4, s[12:15], s53 offen offset:3072 sc1
  s_add_u32 s21, s53, 4096
  buffer_load_dwordx4 a[36:39], v4, s[12:15], s21 offen offset:0 sc1
  s_add_u32 s53, s53, 40960
  buffer_load_dwordx4 a[40:43], v4, s[12:15], s53 offen offset:0 sc1
  buffer_load_dwordx4 a[44:47], v4, s[12:15], s53 offen offset:1024 sc1
  buffer_load_dwordx4 a[48:51], v4, s[12:15], s53 offen offset:2048 sc1
  buffer_load_dwordx4 a[52:55], v4, s[12:15], s53 offen offset:3072 sc1
  s_add_u32 s21, s53, 4096
  buffer_load_dwordx4 a[56:59], v4, s[12:15], s21 offen offset:0 sc1
  s_add_u32 s53, s53, 40960
  buffer_load_dwordx4 a[60:63], v4, s[12:15], s53 offen offset:0 sc1
  buffer_load_dwordx4 a[64:67], v4, s[12:15], s53 offen offset:1024 sc1
  buffer_load_dwordx4 a[68:71], v4, s[12:15], s53 offen offset:2048 sc1
  buffer_load_dwordx4 a[72:75], v4, s[12:15], s53 offen offset:3072 sc1
  s_add_u32 s21, s53, 4096
  buffer_load_dwordx4 a[76:79], v4, s[12:15], s21 offen offset:0 sc1
  s_add_u32 s53, s53, 40960
  buffer_load_dwordx4 a[80:83], v4, s[12:15], s53 offen offset:0 sc1
  buffer_load_dwordx4 a[84:87], v4, s[12:15], s53 offen offset:1024 sc1
  buffer_load_dwordx4 a[88:91], v4, s[12:15], s53 offen offset:2048 sc1
  buffer_load_dwordx4 a[92:95], v4, s[12:15], s53 offen offset:3072 sc1
  s_add_u32 s21, s53, 4096
  buffer_load_dwordx4 a[96:99], v4, s[12:15], s21 offen offset:0 sc1
  s_add_u32 s53, s53, 40960
  buffer_load_dwordx4 a[100:103], v4, s[12:15], s53 offen offset:0 sc1
  buffer_load_dwordx4 a[104:107], v4, s[12:15], s53 offen offset:1024 sc1
  buffer_load_dwordx4 a[108:111], v4, s[12:15], s53 offen offset:2048 sc1
  buffer_load_dwordx4 a[112:115], v4, s[12:15], s53 offen offset:3072 sc1
  s_add_u32 s21, s53, 4096
  buffer_load_dwordx4 a[116:119], v4, s[12:15], s21 offen offset:0 sc1
  s_add_u32 s53, s53, 40960
  buffer_load_dwordx4 a[120:123], v4, s[12:15], s53 offen offset:0 sc1
  buffer_load_dwordx4 a[124:127], v4, s[12:15], s53 offen offset:1024 sc1
  buffer_load_dwordx4 a[128:131], v4, s[12:15], s53 offen offset:2048 sc1
  buffer_load_dwordx4 a[132:135], v4, s[12:15], s53 offen offset:3072 sc1
  s_add_u32 s21, s53, 4096
  buffer_load_dwordx4 a[136:139], v4, s[12:15], s21 offen offset:0 sc1
  s_add_u32 s53, s53, 40960
  buffer_load_dwordx4 a[140:143], v4, s[12:15], s53 offen offset:0 sc1
  buffer_load_dwordx4 a[144:147], v4, s[12:15], s53 offen offset:1024 sc1
  buffer_load_dwordx4 a[148:151], v4, s[12:15], s53 offen offset:2048 sc1
  buffer_load_dwordx4 a[152:155], v4, s[12:15], s53 offen offset:3072 sc1
  s_add_u32 s21, s53, 4096
  buffer_load_dwordx4 a[156:159], v4, s[12:15], s21 offen offset:0 sc1
  s_add_u32 s53, s53, 40960
  s_waitcnt vmcnt(40)
  v_cmp_gt_u32 vcc, v19, v27
  s_nop 1
  s_cbranch_vccnz pvw_230
  buffer_load_dwordx4 v[64:67], v4, s[16:19], s47 offen sc1
  buffer_load_dwordx2 v[68:69], v5, s[16:19], s47 offen offset:2048 sc1
  buffer_load_dwordx4 v[128:131], v21, s[16:19], s47 offen offset:1024 sc1
  s_add_u32 s47, s47, 2560
  buffer_load_dwordx4 v[72:75], v4, s[16:19], s47 offen sc1
  buffer_load_dwordx2 v[76:77], v5, s[16:19], s47 offen offset:2048 sc1
  s_add_u32 s47, s47, 2560
  buffer_load_dwordx4 v[80:83], v4, s[16:19], s47 offen sc1
  buffer_load_dwordx2 v[84:85], v5, s[16:19], s47 offen offset:2048 sc1
  buffer_load_dwordx4 v[132:135], v21, s[16:19], s47 offen offset:1024 sc1
  s_add_u32 s47, s47, 2560
  buffer_load_dwordx4 v[88:91], v4, s[16:19], s47 offen sc1
  buffer_load_dwordx2 v[92:93], v5, s[16:19], s47 offen offset:2048 sc1
  s_add_u32 s47, s47, 2560
  buffer_load_dwordx4 v[32:35], v22, s[16:19], s48 offen offset:0 sc1
  buffer_load_dwordx4 v[40:43], v22, s[16:19], s48 offen offset:640 sc1
  buffer_load_dwordx2 v[184:185], v14, s[16:19], s48 offen offset:512 sc1
  s_add_u32 s48, s48, 20480
  buffer_load_dwordx4 v[36:39], v22, s[16:19], s48 offen offset:0 sc1
  buffer_load_dwordx4 v[44:47], v22, s[16:19], s48 offen offset:640 sc1
  buffer_load_dwordx2 v[186:187], v14, s[16:19], s48 offen offset:512 sc1
  s_add_u32 s48, s48, 20480
  v_mfma_f32_16x16x32_bf16 v[144:147], a[160:163], v[192:195], 0
  v_mfma_f32_16x16x32_bf16 v[148:151], a[160:163], v[212:215], 0
  v_mfma_f32_16x16x32_bf16 v[152:155], a[164:167], v[192:195], 0
  v_mfma_f32_16x16x32_bf16 v[156:159], a[164:167], v[212:215], 0
  v_mfma_f32_16x16x32_bf16 v[160:163], a[168:171], v[192:195], 0
  v_mfma_f32_16x16x32_bf16 v[164:167], a[168:171], v[212:215], 0
  v_mfma_f32_16x16x32_bf16 v[168:171], a[172:175], v[192:195], 0
  v_mfma_f32_16x16x32_bf16 v[172:175], a[172:175], v[212:215], 0
  v_mfma_f32_16x16x32_bf16 v[176:179], a[176:179], v[192:195], 0
  v_mfma_f32_16x16x32_bf16 v[180:183], a[176:179], v[212:215], 0
  v_mfma_f32_16x16x32_bf16 v[144:147], a[180:183], v[196:199], v[144:147]
  v_mfma_f32_16x16x32_bf16 v[148:151], a[180:183], v[216:219], v[148:151]
  v_mfma_f32_16x16x32_bf16 v[152:155], a[184:187], v[196:199], v[152:155]
  v_mfma_f32_16x16x32_bf16 v[156:159], a[184:187], v[216:219], v[156:159]
  v_mfma_f32_16x16x32_bf16 v[160:163], a[188:191], v[196:199], v[160:163]
  v_mfma_f32_16x16x32_bf16 v[164:167], a[188:191], v[216:219], v[164:167]
  v_mfma_f32_16x16x32_bf16 v[168:171], a[192:195], v[196:199], v[168:171]
  v_mfma_f32_16x16x32_bf16 v[172:175], a[192:195], v[216:219], v[172:175]
  v_mfma_f32_16x16x32_bf16 v[176:179], a[196:199], v[196:199], v[176:179]
  v_mfma_f32_16x16x32_bf16 v[180:183], a[196:199], v[216:219], v[180:183]
  v_mfma_f32_16x16x32_bf16 v[144:147], a[200:203], v[200:203], v[144:147]
  v_mfma_f32_16x16x32_bf16 v[148:151], a[200:203], v[220:223], v[148:151]
  v_mfma_f32_16x16x32_bf16 v[152:155], a[204:207], v[200:203], v[152:155]
  v_mfma_f32_16x16x32_bf16 v[156:159], a[204:207], v[220:223], v[156:159]
  v_mfma_f32_16x16x32_bf16 v[160:163], a[208:211], v[200:203], v[160:163]
  v_mfma_f32_16x16x32_bf16 v[164:167], a[208:211], v[220:223], v[164:167]
  v_mfma_f32_16x16x32_bf16 v[168:171], a[212:215], v[200:203], v[168:171]
  v_mfma_f32_16x16x32_bf16 v[172:175], a[212:215], v[220:223], v[172:175]
  v_mfma_f32_16x16x32_bf16 v[176:179], a[216:219], v[200:203], v[176:179]
  v_mfma_f32_16x16x32_bf16 v[180:183], a[216:219], v[220:223], v[180:183]
  v_mfma_f32_16x16x32_bf16 v[144:147], a[220:223], v[204:207], v[144:147]
  v_mfma_f32_16x16x32_bf16 v[148:151], a[220:223], v[224:227], v[148:151]
  v_mfma_f32_16x16x32_bf16 v[152:155], a[224:227], v[204:207], v[152:155]
  v_mfma_f32_16x16x32_bf16 v[156:159], a[224:227], v[224:227], v[156:159]
  v_mfma_f32_16x16x32_bf16 v[160:163], a[228:231], v[204:207], v[160:163]
  v_mfma_f32_16x16x32_bf16 v[164:167], a[228:231], v[224:227], v[164:167]
  v_mfma_f32_16x16x32_bf16 v[168:171], a[232:235], v[204:207], v[168:171]
  v_mfma_f32_16x16x32_bf16 v[172:175], a[232:235], v[224:227], v[172:175]
  v_mfma_f32_16x16x32_bf16 v[176:179], a[236:239], v[204:207], v[176:179]
  v_mfma_f32_16x16x32_bf16 v[180:183], a[236:239], v[224:227], v[180:183]
  v_mfma_f32_16x16x32_bf16 v[144:147], a[240:243], v[208:211], v[144:147]
  v_mfma_f32_16x16x32_bf16 v[148:151], a[240:243], v[228:231], v[148:151]
  v_mfma_f32_16x16x32_bf16 v[152:155], a[244:247], v[208:211], v[152:155]
  v_mfma_f32_16x16x32_bf16 v[156:159], a[244:247], v[228:231], v[156:159]
  v_mfma_f32_16x16x32_bf16 v[160:163], a[248:251], v[208:211], v[160:163]
  v_mfma_f32_16x16x32_bf16 v[164:167], a[248:251], v[228:231], v[164:167]
  v_mfma_f32_16x16x32_bf16 v[168:171], a[252:255], v[208:211], v[168:171]
  v_mfma_f32_16x16x32_bf16 v[172:175], a[252:255], v[228:231], v[172:175]
  v_mfma_f32_16x16x32_bf16 v[176:179], v[252:255], v[208:211], v[176:179]
  v_mfma_f32_16x16x32_bf16 v[180:183], v[252:255], v[228:231], v[180:183]
  ds_write_b128 v10, v[144:147] offset:40960
  ds_write_b128 v10, v[148:151] offset:41984
  ds_write_b128 v10, v[152:155] offset:43008
  ds_write_b128 v10, v[156:159] offset:44032
  ds_write_b128 v10, v[160:163] offset:45056
  ds_write_b128 v10, v[164:167] offset:46080
  ds_write_b128 v10, v[168:171] offset:47104
  ds_write_b128 v10, v[172:175] offset:48128
  s_nop 1
  ds_write_b128 v10, v[176:179] offset:49152
  ds_write_b128 v10, v[180:183] offset:50176
  s_waitcnt lgkmcnt(0)
  s_waitcnt vmcnt(40)
  buffer_load_dwordx4 v[96:99], v4, s[16:19], s47 offen sc1
  buffer_load_dwordx2 v[100:101], v5, s[16:19], s47 offen offset:2048 sc1
  buffer_load_dwordx4 v[136:139], v21, s[16:19], s47 offen offset:1024 sc1
  s_add_u32 s47, s47, 2560
  buffer_load_dwordx4 v[104:107], v4, s[16:19], s47 offen sc1
  buffer_load_dwordx2 v[108:109], v5, s[16:19], s47 offen offset:2048 sc1
  s_add_u32 s47, s47, 2560
  buffer_load_dwordx4 v[112:115], v4, s[16:19], s47 offen sc1
  buffer_load_dwordx2 v[116:117], v5, s[16:19], s47 offen offset:2048 sc1
  buffer_load_dwordx4 v[140:143], v21, s[16:19], s47 offen offset:1024 sc1
  s_add_u32 s47, s47, 2560
  buffer_load_dwordx4 v[120:123], v4, s[16:19], s47 offen sc1
  buffer_load_dwordx2 v[124:125], v5, s[16:19], s47 offen offset:2048 sc1
  s_add_u32 s47, s47, 2560
  buffer_load_dwordx4 v[48:51], v22, s[16:19], s48 offen offset:0 sc1
  buffer_load_dwordx4 v[56:59], v22, s[16:19], s48 offen offset:640 sc1
  buffer_load_dwordx2 v[188:189], v14, s[16:19], s48 offen offset:512 sc1
  s_add_u32 s48, s48, 20480
  buffer_load_dwordx4 v[52:55], v22, s[16:19], s48 offen offset:0 sc1
  buffer_load_dwordx4 v[60:63], v22, s[16:19], s48 offen offset:640 sc1
  buffer_load_dwordx2 v[190:191], v14, s[16:19], s48 offen offset:512 sc1
  s_add_u32 s48, s48, 20480
  s_barrier
  ds_read_b128 v[192:195], v15 offset:0
  ds_read_b128 v[196:199], v15 offset:10240
  ds_read_b128 v[200:203], v15 offset:20480
  ds_read_b128 v[204:207], v15 offset:30720
  ds_read_b128 v[208:211], v15 offset:2048
  ds_read_b128 v[212:215], v15 offset:12288
  ds_read_b128 v[216:219], v15 offset:22528
  ds_read_b128 v[220:223], v15 offset:32768
  ds_read_b128 v[224:227], v16 offset:0
  ds_read_b128 v[228:231], v16 offset:10240
  ds_read_b128 v[232:235], v16 offset:20480
  ds_read_b128 v[236:239], v16 offset:30720
  v_sub_f32 v25, 1.0, v24
  v_cvt_pk_bf16_f32 v26, v25, v25
  v_lshlrev_b32 v25, 16, v26
  s_waitcnt lgkmcnt(8)
  v_pk_add_f32 v[192:193], v[192:193], v[196:197]
  v_pk_add_f32 v[200:201], v[200:201], v[204:205]
  v_pk_add_f32 v[194:195], v[194:195], v[198:199]
  v_pk_add_f32 v[202:203], v[202:203], v[206:207]
  v_pk_add_f32 v[240:241], v[192:193], v[200:201]
  v_cvt_pk_bf16_f32 v26, v240, v241
  v_lshlrev_b32 v240, 16, v26
  v_and_b32 v241, 0xffff0000, v26
  v_mul_f32 v240, v240, v25
  v_mul_f32 v241, v241, v25
  v_cvt_pk_bf16_f32 v26, v240, v241
  v_lshlrev_b32 v240, 16, v26
  v_and_b32 v241, 0xffff0000, v26
  v_pk_add_f32 v[242:243], v[194:195], v[202:203]
  v_cvt_pk_bf16_f32 v26, v242, v243
  v_lshlrev_b32 v242, 16, v26
  v_and_b32 v243, 0xffff0000, v26
  v_mul_f32 v242, v242, v25
  v_mul_f32 v243, v243, v25
  v_cvt_pk_bf16_f32 v26, v242, v243
  v_lshlrev_b32 v242, 16, v26
  v_and_b32 v243, 0xffff0000, v26
  s_waitcnt lgkmcnt(4)
  v_pk_add_f32 v[208:209], v[208:209], v[212:213]
  v_pk_add_f32 v[216:217], v[216:217], v[220:221]
  v_pk_add_f32 v[210:211], v[210:211], v[214:215]
  v_pk_add_f32 v[218:219], v[218:219], v[222:223]
  v_pk_add_f32 v[244:245], v[208:209], v[216:217]
  v_cvt_pk_bf16_f32 v26, v244, v245
  v_lshlrev_b32 v244, 16, v26
  v_and_b32 v245, 0xffff0000, v26
  v_mul_f32 v244, v244, v25
  v_mul_f32 v245, v245, v25
  v_cvt_pk_bf16_f32 v26, v244, v245
  v_lshlrev_b32 v244, 16, v26
  v_and_b32 v245, 0xffff0000, v26
  v_pk_add_f32 v[246:247], v[210:211], v[218:219]
  v_cvt_pk_bf16_f32 v26, v246, v247
  v_lshlrev_b32 v246, 16, v26
  v_and_b32 v247, 0xffff0000, v26
  v_mul_f32 v246, v246, v25
  v_mul_f32 v247, v247, v25
  v_cvt_pk_bf16_f32 v26, v246, v247
  v_lshlrev_b32 v246, 16, v26
  v_and_b32 v247, 0xffff0000, v26
  s_waitcnt lgkmcnt(0)
  v_pk_add_f32 v[224:225], v[224:225], v[228:229]
  v_pk_add_f32 v[232:233], v[232:233], v[236:237]
  v_pk_add_f32 v[226:227], v[226:227], v[230:231]
  v_pk_add_f32 v[234:235], v[234:235], v[238:239]
  v_pk_add_f32 v[248:249], v[224:225], v[232:233]
  v_cvt_pk_bf16_f32 v26, v248, v249
  v_lshlrev_b32 v248, 16, v26
  v_and_b32 v249, 0xffff0000, v26
  v_mul_f32 v248, v248, v25
  v_mul_f32 v249, v249, v25
  v_cvt_pk_bf16_f32 v26, v248, v249
  v_lshlrev_b32 v248, 16, v26
  v_and_b32 v249, 0xffff0000, v26
  v_pk_add_f32 v[250:251], v[226:227], v[234:235]
  v_cvt_pk_bf16_f32 v26, v250, v251
  v_lshlrev_b32 v250, 16, v26
  v_and_b32 v251, 0xffff0000, v26
  v_mul_f32 v250, v250, v25
  v_mul_f32 v251, v251, v25
  v_cvt_pk_bf16_f32 v26, v250, v251
  v_lshlrev_b32 v250, 16, v26
  v_and_b32 v251, 0xffff0000, v26
  s_barrier
  s_branch pvg_234
pvw_230:
  v_mfma_f32_16x16x32_bf16 v[144:147], a[160:163], v[192:195], 0
  v_mfma_f32_16x16x32_bf16 v[148:151], a[160:163], v[212:215], 0
  v_mfma_f32_16x16x32_bf16 v[152:155], a[164:167], v[192:195], 0
  v_mfma_f32_16x16x32_bf16 v[156:159], a[164:167], v[212:215], 0
  v_mfma_f32_16x16x32_bf16 v[160:163], a[168:171], v[192:195], 0
  v_mfma_f32_16x16x32_bf16 v[164:167], a[168:171], v[212:215], 0
  v_mfma_f32_16x16x32_bf16 v[168:171], a[172:175], v[192:195], 0
  v_mfma_f32_16x16x32_bf16 v[172:175], a[172:175], v[212:215], 0
  v_mfma_f32_16x16x32_bf16 v[176:179], a[176:179], v[192:195], 0
  v_mfma_f32_16x16x32_bf16 v[180:183], a[176:179], v[212:215], 0
  v_mfma_f32_16x16x32_bf16 v[144:147], a[180:183], v[196:199], v[144:147]
  v_mfma_f32_16x16x32_bf16 v[148:151], a[180:183], v[216:219], v[148:151]
  v_mfma_f32_16x16x32_bf16 v[152:155], a[184:187], v[196:199], v[152:155]
  v_mfma_f32_16x16x32_bf16 v[156:159], a[184:187], v[216:219], v[156:159]
  v_mfma_f32_16x16x32_bf16 v[160:163], a[188:191], v[196:199], v[160:163]
  v_mfma_f32_16x16x32_bf16 v[164:167], a[188:191], v[216:219], v[164:167]
  v_mfma_f32_16x16x32_bf16 v[168:171], a[192:195], v[196:199], v[168:171]
  v_mfma_f32_16x16x32_bf16 v[172:175], a[192:195], v[216:219], v[172:175]
  v_mfma_f32_16x16x32_bf16 v[176:179], a[196:199], v[196:199], v[176:179]
  v_mfma_f32_16x16x32_bf16 v[180:183], a[196:199], v[216:219], v[180:183]
  v_mfma_f32_16x16x32_bf16 v[144:147], a[200:203], v[200:203], v[144:147]
  v_mfma_f32_16x16x32_bf16 v[148:151], a[200:203], v[220:223], v[148:151]
  v_mfma_f32_16x16x32_bf16 v[152:155], a[204:207], v[200:203], v[152:155]
  v_mfma_f32_16x16x32_bf16 v[156:159], a[204:207], v[220:223], v[156:159]
  v_mfma_f32_16x16x32_bf16 v[160:163], a[208:211], v[200:203], v[160:163]
  v_mfma_f32_16x16x32_bf16 v[164:167], a[208:211], v[220:223], v[164:167]
  v_mfma_f32_16x16x32_bf16 v[168:171], a[212:215], v[200:203], v[168:171]
  v_mfma_f32_16x16x32_bf16 v[172:175], a[212:215], v[220:223], v[172:175]
  v_mfma_f32_16x16x32_bf16 v[176:179], a[216:219], v[200:203], v[176:179]
  v_mfma_f32_16x16x32_bf16 v[180:183], a[216:219], v[220:223], v[180:183]
  v_mfma_f32_16x16x32_bf16 v[144:147], a[220:223], v[204:207], v[144:147]
  v_mfma_f32_16x16x32_bf16 v[148:151], a[220:223], v[224:227], v[148:151]
  v_mfma_f32_16x16x32_bf16 v[152:155], a[224:227], v[204:207], v[152:155]
  v_mfma_f32_16x16x32_bf16 v[156:159], a[224:227], v[224:227], v[156:159]
  v_mfma_f32_16x16x32_bf16 v[160:163], a[228:231], v[204:207], v[160:163]
  v_mfma_f32_16x16x32_bf16 v[164:167], a[228:231], v[224:227], v[164:167]
  v_mfma_f32_16x16x32_bf16 v[168:171], a[232:235], v[204:207], v[168:171]
  v_mfma_f32_16x16x32_bf16 v[172:175], a[232:235], v[224:227], v[172:175]
  v_mfma_f32_16x16x32_bf16 v[176:179], a[236:239], v[204:207], v[176:179]
  v_mfma_f32_16x16x32_bf16 v[180:183], a[236:239], v[224:227], v[180:183]
  v_mfma_f32_16x16x32_bf16 v[144:147], a[240:243], v[208:211], v[144:147]
  v_mfma_f32_16x16x32_bf16 v[148:151], a[240:243], v[228:231], v[148:151]
  v_mfma_f32_16x16x32_bf16 v[152:155], a[244:247], v[208:211], v[152:155]
  v_mfma_f32_16x16x32_bf16 v[156:159], a[244:247], v[228:231], v[156:159]
  v_mfma_f32_16x16x32_bf16 v[160:163], a[248:251], v[208:211], v[160:163]
  v_mfma_f32_16x16x32_bf16 v[164:167], a[248:251], v[228:231], v[164:167]
  v_mfma_f32_16x16x32_bf16 v[168:171], a[252:255], v[208:211], v[168:171]
  v_mfma_f32_16x16x32_bf16 v[172:175], a[252:255], v[228:231], v[172:175]
  v_mfma_f32_16x16x32_bf16 v[176:179], v[252:255], v[208:211], v[176:179]
  v_mfma_f32_16x16x32_bf16 v[180:183], v[252:255], v[228:231], v[180:183]
  ds_write_b128 v10, v[144:147] offset:40960
  ds_write_b128 v10, v[148:151] offset:41984
  ds_write_b128 v10, v[152:155] offset:43008
  ds_write_b128 v10, v[156:159] offset:44032
  ds_write_b128 v10, v[160:163] offset:45056
  ds_write_b128 v10, v[164:167] offset:46080
  ds_write_b128 v10, v[168:171] offset:47104
  ds_write_b128 v10, v[172:175] offset:48128
  s_nop 1
  ds_write_b128 v10, v[176:179] offset:49152
  ds_write_b128 v10, v[180:183] offset:50176
  s_waitcnt lgkmcnt(0)
  s_barrier
  ds_read_b128 v[192:195], v15 offset:0
  ds_read_b128 v[196:199], v15 offset:10240
  ds_read_b128 v[200:203], v15 offset:20480
  ds_read_b128 v[204:207], v15 offset:30720
  ds_read_b128 v[208:211], v15 offset:2048
  ds_read_b128 v[212:215], v15 offset:12288
  ds_read_b128 v[216:219], v15 offset:22528
  ds_read_b128 v[220:223], v15 offset:32768
  ds_read_b128 v[224:227], v16 offset:0
  ds_read_b128 v[228:231], v16 offset:10240
  ds_read_b128 v[232:235], v16 offset:20480
  ds_read_b128 v[236:239], v16 offset:30720
  v_sub_f32 v25, 1.0, v24
  v_cvt_pk_bf16_f32 v26, v25, v25
  v_lshlrev_b32 v25, 16, v26
  s_waitcnt lgkmcnt(8)
  v_pk_add_f32 v[192:193], v[192:193], v[196:197]
  v_pk_add_f32 v[200:201], v[200:201], v[204:205]
  v_pk_add_f32 v[194:195], v[194:195], v[198:199]
  v_pk_add_f32 v[202:203], v[202:203], v[206:207]
  v_pk_add_f32 v[240:241], v[192:193], v[200:201]
  v_cvt_pk_bf16_f32 v26, v240, v241
  v_lshlrev_b32 v240, 16, v26
  v_and_b32 v241, 0xffff0000, v26
  v_mul_f32 v240, v240, v25
  v_mul_f32 v241, v241, v25
  v_cvt_pk_bf16_f32 v26, v240, v241
  v_lshlrev_b32 v240, 16, v26
  v_and_b32 v241, 0xffff0000, v26
  v_pk_add_f32 v[242:243], v[194:195], v[202:203]
  v_cvt_pk_bf16_f32 v26, v242, v243
  v_lshlrev_b32 v242, 16, v26
  v_and_b32 v243, 0xffff0000, v26
  v_mul_f32 v242, v242, v25
  v_mul_f32 v243, v243, v25
  v_cvt_pk_bf16_f32 v26, v242, v243
  v_lshlrev_b32 v242, 16, v26
  v_and_b32 v243, 0xffff0000, v26
  s_waitcnt lgkmcnt(4)
  v_pk_add_f32 v[208:209], v[208:209], v[212:213]
  v_pk_add_f32 v[216:217], v[216:217], v[220:221]
  v_pk_add_f32 v[210:211], v[210:211], v[214:215]
  v_pk_add_f32 v[218:219], v[218:219], v[222:223]
  v_pk_add_f32 v[244:245], v[208:209], v[216:217]
  v_cvt_pk_bf16_f32 v26, v244, v245
  v_lshlrev_b32 v244, 16, v26
  v_and_b32 v245, 0xffff0000, v26
  v_mul_f32 v244, v244, v25
  v_mul_f32 v245, v245, v25
  v_cvt_pk_bf16_f32 v26, v244, v245
  v_lshlrev_b32 v244, 16, v26
  v_and_b32 v245, 0xffff0000, v26
  v_pk_add_f32 v[246:247], v[210:211], v[218:219]
  v_cvt_pk_bf16_f32 v26, v246, v247
  v_lshlrev_b32 v246, 16, v26
  v_and_b32 v247, 0xffff0000, v26
  v_mul_f32 v246, v246, v25
  v_mul_f32 v247, v247, v25
  v_cvt_pk_bf16_f32 v26, v246, v247
  v_lshlrev_b32 v246, 16, v26
  v_and_b32 v247, 0xffff0000, v26
  s_waitcnt lgkmcnt(0)
  v_pk_add_f32 v[224:225], v[224:225], v[228:229]
  v_pk_add_f32 v[232:233], v[232:233], v[236:237]
  v_pk_add_f32 v[226:227], v[226:227], v[230:231]
  v_pk_add_f32 v[234:235], v[234:235], v[238:239]
  v_pk_add_f32 v[248:249], v[224:225], v[232:233]
  v_cvt_pk_bf16_f32 v26, v248, v249
  v_lshlrev_b32 v248, 16, v26
  v_and_b32 v249, 0xffff0000, v26
  v_mul_f32 v248, v248, v25
  v_mul_f32 v249, v249, v25
  v_cvt_pk_bf16_f32 v26, v248, v249
  v_lshlrev_b32 v248, 16, v26
  v_and_b32 v249, 0xffff0000, v26
  v_pk_add_f32 v[250:251], v[226:227], v[234:235]
  v_cvt_pk_bf16_f32 v26, v250, v251
  v_lshlrev_b32 v250, 16, v26
  v_and_b32 v251, 0xffff0000, v26
  v_mul_f32 v250, v250, v25
  v_mul_f32 v251, v251, v25
  v_cvt_pk_bf16_f32 v26, v250, v251
  v_lshlrev_b32 v250, 16, v26
  v_and_b32 v251, 0xffff0000, v26
  s_cmp_ge_u32 s40, 56
  s_cbranch_scc1 pvt_235
  s_cmp_lg_u32 s20, 0
  s_cbranch_scc1 wr_237
  s_mov_b32 s101, 0
wr_236:
  buffer_load_dword v26, v18, s[72:75], 0 offen sc1
  s_add_u32 s101, s101, 1
  s_cmp_gt_u32 s101, 131072
  s_cbranch_scc1 main_end
  s_waitcnt vmcnt(0)
  v_cmp_gt_u32 vcc, v19, v26
  v_readfirstlane_b32 s100, v26
  s_nop 0
  s_cbranch_vccz wr_237
  s_sleep 2
  s_cmp_lg_u32 s100, 0
  s_cbranch_scc1 wr_236
  s_sleep 24
  s_branch wr_236
wr_237:
  s_barrier
  buffer_load_dwordx4 v[64:67], v4, s[16:19], s47 offen sc1
  buffer_load_dwordx2 v[68:69], v5, s[16:19], s47 offen offset:2048 sc1
  buffer_load_dwordx4 v[128:131], v21, s[16:19], s47 offen offset:1024 sc1
  s_add_u32 s47, s47, 2560
  buffer_load_dwordx4 v[72:75], v4, s[16:19], s47 offen sc1
  buffer_load_dwordx2 v[76:77], v5, s[16:19], s47 offen offset:2048 sc1
  s_add_u32 s47, s47, 2560
  buffer_load_dwordx4 v[80:83], v4, s[16:19], s47 offen sc1
  buffer_load_dwordx2 v[84:85], v5, s[16:19], s47 offen offset:2048 sc1
  buffer_load_dwordx4 v[132:135], v21, s[16:19], s47 offen offset:1024 sc1
  s_add_u32 s47, s47, 2560
  buffer_load_dwordx4 v[88:91], v4, s[16:19], s47 offen sc1
  buffer_load_dwordx2 v[92:93], v5, s[16:19], s47 offen offset:2048 sc1
  s_add_u32 s47, s47, 2560
  buffer_load_dwordx4 v[32:35], v22, s[16:19], s48 offen offset:0 sc1
  buffer_load_dwordx4 v[40:43], v22, s[16:19], s48 offen offset:640 sc1
  buffer_load_dwordx2 v[184:185], v14, s[16:19], s48 offen offset:512 sc1
  s_add_u32 s48, s48, 20480
  buffer_load_dwordx4 v[36:39], v22, s[16:19], s48 offen offset:0 sc1
  buffer_load_dwordx4 v[44:47], v22, s[16:19], s48 offen offset:640 sc1
  buffer_load_dwordx2 v[186:187], v14, s[16:19], s48 offen offset:512 sc1
  s_add_u32 s48, s48, 20480
  s_waitcnt vmcnt(40)
  buffer_load_dwordx4 v[96:99], v4, s[16:19], s47 offen sc1
  buffer_load_dwordx2 v[100:101], v5, s[16:19], s47 offen offset:2048 sc1
  buffer_load_dwordx4 v[136:139], v21, s[16:19], s47 offen offset:1024 sc1
  s_add_u32 s47, s47, 2560
  buffer_load_dwordx4 v[104:107], v4, s[16:19], s47 offen sc1
  buffer_load_dwordx2 v[108:109], v5, s[16:19], s47 offen offset:2048 sc1
  s_add_u32 s47, s47, 2560
  buffer_load_dwordx4 v[112:115], v4, s[16:19], s47 offen sc1
  buffer_load_dwordx2 v[116:117], v5, s[16:19], s47 offen offset:2048 sc1
  buffer_load_dwordx4 v[140:143], v21, s[16:19], s47 offen offset:1024 sc1
  s_add_u32 s47, s47, 2560
  buffer_load_dwordx4 v[120:123], v4, s[16:19], s47 offen sc1
  buffer_load_dwordx2 v[124:125], v5, s[16:19], s47 offen offset:2048 sc1
  s_add_u32 s47, s47, 2560
  buffer_load_dwordx4 v[48:51], v22, s[16:19], s48 offen offset:0 sc1
  buffer_load_dwordx4 v[56:59], v22, s[16:19], s48 offen offset:640 sc1
  buffer_load_dwordx2 v[188:189], v14, s[16:19], s48 offen offset:512 sc1
  s_add_u32 s48, s48, 20480
  buffer_load_dwordx4 v[52:55], v22, s[16:19], s48 offen offset:0 sc1
  buffer_load_dwordx4 v[60:63], v22, s[16:19], s48 offen offset:640 sc1
  buffer_load_dwordx2 v[190:191], v14, s[16:19], s48 offen offset:512 sc1
  s_add_u32 s48, s48, 20480
pvg_234:
  s_waitcnt vmcnt(30)
  v_mfma_f32_16x16x32_bf16 v[148:151], a[0:3], v[64:67], 0
  v_mfma_f32_16x16x32_bf16 v[144:147], a[0:3], v[68:71], 0
  v_mfma_f32_16x16x32_bf16 v[156:159], a[4:7], v[64:67], 0
  v_mfma_f32_16x16x32_bf16 v[152:155], a[4:7], v[68:71], 0
  v_mfma_f32_16x16x32_bf16 v[164:167], a[8:11], v[64:67], 0
  v_mfma_f32_16x16x32_bf16 v[160:163], a[8:11], v[68:71], 0
  v_mfma_f32_16x16x32_bf16 v[172:175], a[12:15], v[64:67], 0
  v_mfma_f32_16x16x32_bf16 v[168:171], a[12:15], v[68:71], 0
  v_mfma_f32_16x16x32_bf16 v[180:183], a[16:19], v[64:67], 0
  v_mfma_f32_16x16x32_bf16 v[176:179], a[16:19], v[68:71], 0
  s_waitcnt vmcnt(27)
  v_mfma_f32_16x16x32_bf16 v[148:151], a[20:23], v[72:75], v[148:151]
  v_mfma_f32_16x16x32_bf16 v[144:147], a[20:23], v[76:79], v[144:147]
  v_mfma_f32_16x16x32_bf16 v[156:159], a[24:27], v[72:75], v[156:159]
  v_mfma_f32_16x16x32_bf16 v[152:155], a[24:27], v[76:79], v[152:155]
  v_mfma_f32_16x16x32_bf16 v[164:167], a[28:31], v[72:75], v[164:167]
  v_mfma_f32_16x16x32_bf16 v[160:163], a[28:31], v[76:79], v[160:163]
  v_mfma_f32_16x16x32_bf16 v[172:175], a[32:35], v[72:75], v[172:175]
  v_mfma_f32_16x16x32_bf16 v[168:171], a[32:35], v[76:79], v[168:171]
  v_mfma_f32_16x16x32_bf16 v[180:183], a[36:39], v[72:75], v[180:183]
  v_mfma_f32_16x16x32_bf16 v[176:179], a[36:39], v[76:79], v[176:179]
  s_waitcnt vmcnt(25)
  v_mfma_f32_16x16x32_bf16 v[148:151], a[40:43], v[80:83], v[148:151]
  v_mfma_f32_16x16x32_bf16 v[144:147], a[40:43], v[84:87], v[144:147]
  v_mfma_f32_16x16x32_bf16 v[156:159], a[44:47], v[80:83], v[156:159]
  v_mfma_f32_16x16x32_bf16 v[152:155], a[44:47], v[84:87], v[152:155]
  v_mfma_f32_16x16x32_bf16 v[164:167], a[48:51], v[80:83], v[164:167]
  v_mfma_f32_16x16x32_bf16 v[160:163], a[48:51], v[84:87], v[160:163]
  v_mfma_f32_16x16x32_bf16 v[172:175], a[52:55], v[80:83], v[172:175]
  v_mfma_f32_16x16x32_bf16 v[168:171], a[52:55], v[84:87], v[168:171]
  v_mfma_f32_16x16x32_bf16 v[180:183], a[56:59], v[80:83], v[180:183]
  v_mfma_f32_16x16x32_bf16 v[176:179], a[56:59], v[84:87], v[176:179]
  s_waitcnt vmcnt(22)
  v_mfma_f32_16x16x32_bf16 v[148:151], a[60:63], v[88:91], v[148:151]
  v_mfma_f32_16x16x32_bf16 v[144:147], a[60:63], v[92:95], v[144:147]
  v_mfma_f32_16x16x32_bf16 v[156:159], a[64:67], v[88:91], v[156:159]
  v_mfma_f32_16x16x32_bf16 v[152:155], a[64:67], v[92:95], v[152:155]
  v_mfma_f32_16x16x32_bf16 v[164:167], a[68:71], v[88:91], v[164:167]
  v_mfma_f32_16x16x32_bf16 v[160:163], a[68:71], v[92:95], v[160:163]
  v_mfma_f32_16x16x32_bf16 v[172:175], a[72:75], v[88:91], v[172:175]
  v_mfma_f32_16x16x32_bf16 v[168:171], a[72:75], v[92:95], v[168:171]
  v_mfma_f32_16x16x32_bf16 v[180:183], a[76:79], v[88:91], v[180:183]
  v_mfma_f32_16x16x32_bf16 v[176:179], a[76:79], v[92:95], v[176:179]
  s_waitcnt vmcnt(16)
  v_swap_b32 v130, v132
  v_swap_b32 v131, v133
  v_swap_b32 v34, v36
  v_swap_b32 v35, v37
  v_swap_b32 v42, v44
  v_swap_b32 v43, v45
  s_nop 1
  v_mfma_f32_16x16x32_bf16 v[144:147], v[32:35], v[128:131], v[144:147]
  v_mfma_f32_16x16x32_bf16 v[148:151], v[32:35], v[132:135], v[148:151]
  v_mfma_f32_16x16x32_bf16 v[152:155], v[36:39], v[128:131], v[152:155]
  v_mfma_f32_16x16x32_bf16 v[156:159], v[36:39], v[132:135], v[156:159]
  v_mfma_f32_16x16x32_bf16 v[160:163], v[184:187], v[128:131], v[160:163]
  v_mfma_f32_16x16x32_bf16 v[164:167], v[184:187], v[132:135], v[164:167]
  v_mfma_f32_16x16x32_bf16 v[168:171], v[40:43], v[128:131], v[168:171]
  v_mfma_f32_16x16x32_bf16 v[172:175], v[40:43], v[132:135], v[172:175]
  v_mfma_f32_16x16x32_bf16 v[176:179], v[44:47], v[128:131], v[176:179]
  v_mfma_f32_16x16x32_bf16 v[180:183], v[44:47], v[132:135], v[180:183]
  s_waitcnt vmcnt(14)
  v_mfma_f32_16x16x32_bf16 v[148:151], a[80:83], v[96:99], v[148:151]
  v_mfma_f32_16x16x32_bf16 v[144:147], a[80:83], v[100:103], v[144:147]
  v_mfma_f32_16x16x32_bf16 v[156:159], a[84:87], v[96:99], v[156:159]
  v_mfma_f32_16x16x32_bf16 v[152:155], a[84:87], v[100:103], v[152:155]
  v_mfma_f32_16x16x32_bf16 v[164:167], a[88:91], v[96:99], v[164:167]
  v_mfma_f32_16x16x32_bf16 v[160:163], a[88:91], v[100:103], v[160:163]
  v_mfma_f32_16x16x32_bf16 v[172:175], a[92:95], v[96:99], v[172:175]
  v_mfma_f32_16x16x32_bf16 v[168:171], a[92:95], v[100:103], v[168:171]
  v_mfma_f32_16x16x32_bf16 v[180:183], a[96:99], v[96:99], v[180:183]
  v_mfma_f32_16x16x32_bf16 v[176:179], a[96:99], v[100:103], v[176:179]
  s_waitcnt vmcnt(11)
  v_mfma_f32_16x16x32_bf16 v[148:151], a[100:103], v[104:107], v[148:151]
  v_mfma_f32_16x16x32_bf16 v[144:147], a[100:103], v[108:111], v[144:147]
  v_mfma_f32_16x16x32_bf16 v[156:159], a[104:107], v[104:107], v[156:159]
  v_mfma_f32_16x16x32_bf16 v[152:155], a[104:107], v[108:111], v[152:155]
  v_mfma_f32_16x16x32_bf16 v[164:167], a[108:111], v[104:107], v[164:167]
  v_mfma_f32_16x16x32_bf16 v[160:163], a[108:111], v[108:111], v[160:163]
  v_mfma_f32_16x16x32_bf16 v[172:175], a[112:115], v[104:107], v[172:175]
  v_mfma_f32_16x16x32_bf16 v[168:171], a[112:115], v[108:111], v[168:171]
  v_mfma_f32_16x16x32_bf16 v[180:183], a[116:119], v[104:107], v[180:183]
  v_mfma_f32_16x16x32_bf16 v[176:179], a[116:119], v[108:111], v[176:179]
  s_waitcnt vmcnt(9)
  v_mfma_f32_16x16x32_bf16 v[148:151], a[120:123], v[112:115], v[148:151]
  v_mfma_f32_16x16x32_bf16 v[144:147], a[120:123], v[116:119], v[144:147]
  v_mfma_f32_16x16x32_bf16 v[156:159], a[124:127], v[112:115], v[156:159]
  v_mfma_f32_16x16x32_bf16 v[152:155], a[124:127], v[116:119], v[152:155]
  v_mfma_f32_16x16x32_bf16 v[164:167], a[128:131], v[112:115], v[164:167]
  v_mfma_f32_16x16x32_bf16 v[160:163], a[128:131], v[116:119], v[160:163]
  v_mfma_f32_16x16x32_bf16 v[172:175], a[132:135], v[112:115], v[172:175]
  v_mfma_f32_16x16x32_bf16 v[168:171], a[132:135], v[116:119], v[168:171]
  v_mfma_f32_16x16x32_bf16 v[180:183], a[136:139], v[112:115], v[180:183]
  v_mfma_f32_16x16x32_bf16 v[176:179], a[136:139], v[116:119], v[176:179]
  s_waitcnt vmcnt(6)
  v_mfma_f32_16x16x32_bf16 v[148:151], a[140:143], v[120:123], v[148:151]
  v_mfma_f32_16x16x32_bf16 v[144:147], a[140:143], v[124:127], v[144:147]
  v_mfma_f32_16x16x32_bf16 v[156:159], a[144:147], v[120:123], v[156:159]
  v_mfma_f32_16x16x32_bf16 v[152:155], a[144:147], v[124:127], v[152:155]
  v_mfma_f32_16x16x32_bf16 v[164:167], a[148:151], v[120:123], v[164:167]
  v_mfma_f32_16x16x32_bf16 v[160:163], a[148:151], v[124:127], v[160:163]
  v_mfma_f32_16x16x32_bf16 v[172:175], a[152:155], v[120:123], v[172:175]
  v_mfma_f32_16x16x32_bf16 v[168:171], a[152:155], v[124:127], v[168:171]
  v_mfma_f32_16x16x32_bf16 v[180:183], a[156:159], v[120:123], v[180:183]
  v_mfma_f32_16x16x32_bf16 v[176:179], a[156:159], v[124:127], v[176:179]
  s_waitcnt vmcnt(0)
  v_swap_b32 v138, v140
  v_swap_b32 v139, v141
  v_swap_b32 v50, v52
  v_swap_b32 v51, v53
  v_swap_b32 v58, v60
  v_swap_b32 v59, v61
  s_nop 1
  v_mfma_f32_16x16x32_bf16 v[144:147], v[48:51], v[136:139], v[144:147]
  v_mfma_f32_16x16x32_bf16 v[148:151], v[48:51], v[140:143], v[148:151]
  v_mfma_f32_16x16x32_bf16 v[152:155], v[52:55], v[136:139], v[152:155]
  v_mfma_f32_16x16x32_bf16 v[156:159], v[52:55], v[140:143], v[156:159]
  v_mfma_f32_16x16x32_bf16 v[160:163], v[188:191], v[136:139], v[160:163]
  v_mfma_f32_16x16x32_bf16 v[164:167], v[188:191], v[140:143], v[164:167]
  v_mfma_f32_16x16x32_bf16 v[168:171], v[56:59], v[136:139], v[168:171]
  v_mfma_f32_16x16x32_bf16 v[172:175], v[56:59], v[140:143], v[172:175]
  v_mfma_f32_16x16x32_bf16 v[176:179], v[60:63], v[136:139], v[176:179]
  v_mfma_f32_16x16x32_bf16 v[180:183], v[60:63], v[140:143], v[180:183]
  s_branch pve_231
pvt_235:
  s_sub_u32 s56, s40, 1
  s_lshl_b32 s21, s56, 10
  s_add_u32 s21, s21, 22528
  v_add_u32 v18, s21, v7
  v_add_u32 v19, s52, v17
  v_cndmask_b32 v18, v19, v18, s[66:67]
  s_add_u32 s21, s56, 1
  v_mov_b32 v19, s21
  v_cndmask_b32 v19, v19, 4, s[66:67]
  v_add_u32 v26, -1, v19
  v_cndmask_b32 v19, v26, v19, s[66:67]
  s_cmp_lg_u32 s20, 0
  s_cbranch_scc1 wr_239
  s_mov_b32 s101, 0
wr_238:
  buffer_load_dword v26, v18, s[72:75], 0 offen sc1
  s_add_u32 s101, s101, 1
  s_cmp_gt_u32 s101, 131072
  s_cbranch_scc1 main_end
  s_waitcnt vmcnt(0)
  v_cmp_gt_u32 vcc, v19, v26
  v_readfirstlane_b32 s100, v26
  s_nop 0
  s_cbranch_vccz wr_239
  s_sleep 4
  s_cmp_lg_u32 s100, 0
  s_cbranch_scc1 wr_238
  s_sleep 24
  s_branch wr_238
wr_239:
  s_barrier
  s_mov_b32 s56, s47
  s_mov_b32 s57, s48
  s_waitcnt vmcnt(20)
  buffer_load_dwordx4 v[64:67], v4, s[16:19], s56 offen sc1
  buffer_load_dwordx2 v[68:69], v5, s[16:19], s56 offen offset:2048 sc1
  buffer_load_dwordx4 v[128:131], v21, s[16:19], s56 offen offset:1024 sc1
  s_add_u32 s56, s56, 2560
  buffer_load_dwordx4 v[72:75], v4, s[16:19], s56 offen sc1
  buffer_load_dwordx2 v[76:77], v5, s[16:19], s56 offen offset:2048 sc1
  s_add_u32 s56, s56, 2560
  buffer_load_dwordx4 v[80:83], v4, s[16:19], s56 offen sc1
  buffer_load_dwordx2 v[84:85], v5, s[16:19], s56 offen offset:2048 sc1
  buffer_load_dwordx4 v[132:135], v21, s[16:19], s56 offen offset:1024 sc1
  s_add_u32 s56, s56, 2560
  buffer_load_dwordx4 v[88:91], v4, s[16:19], s56 offen sc1
  buffer_load_dwordx2 v[92:93], v5, s[16:19], s56 offen offset:2048 sc1
  s_add_u32 s56, s56, 2560
  buffer_load_dwordx4 v[32:35], v22, s[16:19], s57 offen offset:0 sc1
  buffer_load_dwordx4 v[40:43], v22, s[16:19], s57 offen offset:640 sc1
  buffer_load_dwordx2 v[184:185], v14, s[16:19], s57 offen offset:512 sc1
  s_add_u32 s57, s57, 20480
  buffer_load_dwordx4 v[36:39], v22, s[16:19], s57 offen offset:0 sc1
  buffer_load_dwordx4 v[44:47], v22, s[16:19], s57 offen offset:640 sc1
  buffer_load_dwordx2 v[186:187], v14, s[16:19], s57 offen offset:512 sc1
  s_add_u32 s57, s57, 20480
  buffer_load_dwordx4 v[96:99], v4, s[16:19], s56 offen sc1
  buffer_load_dwordx2 v[100:101], v5, s[16:19], s56 offen offset:2048 sc1
  buffer_load_dwordx4 v[136:139], v21, s[16:19], s56 offen offset:1024 sc1
  s_add_u32 s56, s56, 2560
  buffer_load_dwordx4 v[104:107], v4, s[16:19], s56 offen sc1
  buffer_load_dwordx2 v[108:109], v5, s[16:19], s56 offen offset:2048 sc1
  s_add_u32 s56, s56, 2560
  buffer_load_dwordx4 v[112:115], v4, s[16:19], s56 offen sc1
  buffer_load_dwordx2 v[116:117], v5, s[16:19], s56 offen offset:2048 sc1
  buffer_load_dwordx4 v[140:143], v21, s[16:19], s56 offen offset:1024 sc1
  s_add_u32 s56, s56, 2560
  buffer_load_dwordx4 v[120:123], v4, s[16:19], s56 offen sc1
  buffer_load_dwordx2 v[124:125], v5, s[16:19], s56 offen offset:2048 sc1
  s_add_u32 s56, s56, 2560
  buffer_load_dwordx4 v[48:51], v22, s[16:19], s57 offen offset:0 sc1
  buffer_load_dwordx4 v[56:59], v22, s[16:19], s57 offen offset:640 sc1
  buffer_load_dwordx2 v[188:189], v14, s[16:19], s57 offen offset:512 sc1
  s_add_u32 s57, s57, 20480
  buffer_load_dwordx4 v[52:55], v22, s[16:19], s57 offen offset:0 sc1
  buffer_load_dwordx4 v[60:63], v22, s[16:19], s57 offen offset:640 sc1
  buffer_load_dwordx2 v[190:191], v14, s[16:19], s57 offen offset:512 sc1
  s_add_u32 s57, s57, 20480
  s_mov_b32 s101, 0
  s_waitcnt vmcnt(16)
  s_branch pvr_241
pvr_240:
  s_sleep 2
  s_add_u32 s56, s47, 0
  s_add_u32 s57, s48, 0
  buffer_load_dwordx4 v[64:67], v4, s[16:19], s56 offen sc1
  buffer_load_dwordx2 v[68:69], v5, s[16:19], s56 offen offset:2048 sc1
  buffer_load_dwordx4 v[128:131], v21, s[16:19], s56 offen offset:1024 sc1
  s_add_u32 s56, s56, 2560
  buffer_load_dwordx4 v[72:75], v4, s[16:19], s56 offen sc1
  buffer_load_dwordx2 v[76:77], v5, s[16:19], s56 offen offset:2048 sc1
  s_add_u32 s56, s56, 2560
  buffer_load_dwordx4 v[80:83], v4, s[16:19], s56 offen sc1
  buffer_load_dwordx2 v[84:85], v5, s[16:19], s56 offen offset:2048 sc1
  buffer_load_dwordx4 v[132:135], v21, s[16:19], s56 offen offset:1024 sc1
  s_add_u32 s56, s56, 2560
  buffer_load_dwordx4 v[88:91], v4, s[16:19], s56 offen sc1
  buffer_load_dwordx2 v[92:93], v5, s[16:19], s56 offen offset:2048 sc1
  s_add_u32 s56, s56, 2560
  buffer_load_dwordx4 v[32:35], v22, s[16:19], s57 offen offset:0 sc1
  buffer_load_dwordx4 v[40:43], v22, s[16:19], s57 offen offset:640 sc1
  buffer_load_dwordx2 v[184:185], v14, s[16:19], s57 offen offset:512 sc1
  s_add_u32 s57, s57, 20480
  buffer_load_dwordx4 v[36:39], v22, s[16:19], s57 offen offset:0 sc1
  buffer_load_dwordx4 v[44:47], v22, s[16:19], s57 offen offset:640 sc1
  buffer_load_dwordx2 v[186:187], v14, s[16:19], s57 offen offset:512 sc1
  s_add_u32 s57, s57, 20480
  s_add_u32 s101, s101, 1
  s_cmp_gt_u32 s101, 131072
  s_cbranch_scc1 main_end
  s_waitcnt vmcnt(0)
pvr_241:
  v_max3_u32 v26, v64, v68, v72
  v_max3_u32 v26, v26, v76, v80
  v_max3_u32 v26, v26, v84, v88
  v_max3_u32 v26, v26, v92, v128
  v_max3_u32 v26, v26, v132, v32
  v_max3_u32 v26, v26, v36, v40
  v_max3_u32 v26, v26, v44, v184
  v_max3_u32 v26, v26, v186, v186
  v_cmp_eq_u32 vcc, -1, v26
  s_nop 1
  s_cbranch_vccnz pvr_240
  v_mfma_f32_16x16x32_bf16 v[148:151], a[0:3], v[64:67], 0
  v_mfma_f32_16x16x32_bf16 v[144:147], a[0:3], v[68:71], 0
  v_mfma_f32_16x16x32_bf16 v[156:159], a[4:7], v[64:67], 0
  v_mfma_f32_16x16x32_bf16 v[152:155], a[4:7], v[68:71], 0
  v_mfma_f32_16x16x32_bf16 v[164:167], a[8:11], v[64:67], 0
  v_mfma_f32_16x16x32_bf16 v[160:163], a[8:11], v[68:71], 0
  v_mfma_f32_16x16x32_bf16 v[172:175], a[12:15], v[64:67], 0
  v_mfma_f32_16x16x32_bf16 v[168:171], a[12:15], v[68:71], 0
  v_mfma_f32_16x16x32_bf16 v[180:183], a[16:19], v[64:67], 0
  v_mfma_f32_16x16x32_bf16 v[176:179], a[16:19], v[68:71], 0
  v_mfma_f32_16x16x32_bf16 v[148:151], a[20:23], v[72:75], v[148:151]
  v_mfma_f32_16x16x32_bf16 v[144:147], a[20:23], v[76:79], v[144:147]
  v_mfma_f32_16x16x32_bf16 v[156:159], a[24:27], v[72:75], v[156:159]
  v_mfma_f32_16x16x32_bf16 v[152:155], a[24:27], v[76:79], v[152:155]
  v_mfma_f32_16x16x32_bf16 v[164:167], a[28:31], v[72:75], v[164:167]
  v_mfma_f32_16x16x32_bf16 v[160:163], a[28:31], v[76:79], v[160:163]
  v_mfma_f32_16x16x32_bf16 v[172:175], a[32:35], v[72:75], v[172:175]
  v_mfma_f32_16x16x32_bf16 v[168:171], a[32:35], v[76:79], v[168:171]
  v_mfma_f32_16x16x32_bf16 v[180:183], a[36:39], v[72:75], v[180:183]
  v_mfma_f32_16x16x32_bf16 v[176:179], a[36:39], v[76:79], v[176:179]
  v_mfma_f32_16x16x32_bf16 v[148:151], a[40:43], v[80:83], v[148:151]
  v_mfma_f32_16x16x32_bf16 v[144:147], a[40:43], v[84:87], v[144:147]
  v_mfma_f32_16x16x32_bf16 v[156:159], a[44:47], v[80:83], v[156:159]
  v_mfma_f32_16x16x32_bf16 v[152:155], a[44:47], v[84:87], v[152:155]
  v_mfma_f32_16x16x32_bf16 v[164:167], a[48:51], v[80:83], v[164:167]
  v_mfma_f32_16x16x32_bf16 v[160:163], a[48:51], v[84:87], v[160:163]
  v_mfma_f32_16x16x32_bf16 v[172:175], a[52:55], v[80:83], v[172:175]
  v_mfma_f32_16x16x32_bf16 v[168:171], a[52:55], v[84:87], v[168:171]
  v_mfma_f32_16x16x32_bf16 v[180:183], a[56:59], v[80:83], v[180:183]
  v_mfma_f32_16x16x32_bf16 v[176:179], a[56:59], v[84:87], v[176:179]
  v_mfma_f32_16x16x32_bf16 v[148:151], a[60:63], v[88:91], v[148:151]
  v_mfma_f32_16x16x32_bf16 v[144:147], a[60:63], v[92:95], v[144:147]
  v_mfma_f32_16x16x32_bf16 v[156:159], a[64:67], v[88:91], v[156:159]
  v_mfma_f32_16x16x32_bf16 v[152:155], a[64:67], v[92:95], v[152:155]
  v_mfma_f32_16x16x32_bf16 v[164:167], a[68:71], v[88:91], v[164:167]
  v_mfma_f32_16x16x32_bf16 v[160:163], a[68:71], v[92:95], v[160:163]
  v_mfma_f32_16x16x32_bf16 v[172:175], a[72:75], v[88:91], v[172:175]
  v_mfma_f32_16x16x32_bf16 v[168:171], a[72:75], v[92:95], v[168:171]
  v_mfma_f32_16x16x32_bf16 v[180:183], a[76:79], v[88:91], v[180:183]
  v_mfma_f32_16x16x32_bf16 v[176:179], a[76:79], v[92:95], v[176:179]
  v_swap_b32 v130, v132
  v_swap_b32 v131, v133
  v_swap_b32 v34, v36
  v_swap_b32 v35, v37
  v_swap_b32 v42, v44
  v_swap_b32 v43, v45
  s_nop 1
  v_mfma_f32_16x16x32_bf16 v[144:147], v[32:35], v[128:131], v[144:147]
  v_mfma_f32_16x16x32_bf16 v[148:151], v[32:35], v[132:135], v[148:151]
  v_mfma_f32_16x16x32_bf16 v[152:155], v[36:39], v[128:131], v[152:155]
  v_mfma_f32_16x16x32_bf16 v[156:159], v[36:39], v[132:135], v[156:159]
  v_mfma_f32_16x16x32_bf16 v[160:163], v[184:187], v[128:131], v[160:163]
  v_mfma_f32_16x16x32_bf16 v[164:167], v[184:187], v[132:135], v[164:167]
  v_mfma_f32_16x16x32_bf16 v[168:171], v[40:43], v[128:131], v[168:171]
  v_mfma_f32_16x16x32_bf16 v[172:175], v[40:43], v[132:135], v[172:175]
  v_mfma_f32_16x16x32_bf16 v[176:179], v[44:47], v[128:131], v[176:179]
  v_mfma_f32_16x16x32_bf16 v[180:183], v[44:47], v[132:135], v[180:183]
  s_mov_b32 s101, 0
  s_waitcnt vmcnt(0)
  s_branch pvr_243
pvr_242:
  s_sleep 2
  s_add_u32 s56, s47, 10240
  s_add_u32 s57, s48, 40960
  buffer_load_dwordx4 v[96:99], v4, s[16:19], s56 offen sc1
  buffer_load_dwordx2 v[100:101], v5, s[16:19], s56 offen offset:2048 sc1
  buffer_load_dwordx4 v[136:139], v21, s[16:19], s56 offen offset:1024 sc1
  s_add_u32 s56, s56, 2560
  buffer_load_dwordx4 v[104:107], v4, s[16:19], s56 offen sc1
  buffer_load_dwordx2 v[108:109], v5, s[16:19], s56 offen offset:2048 sc1
  s_add_u32 s56, s56, 2560
  buffer_load_dwordx4 v[112:115], v4, s[16:19], s56 offen sc1
  buffer_load_dwordx2 v[116:117], v5, s[16:19], s56 offen offset:2048 sc1
  buffer_load_dwordx4 v[140:143], v21, s[16:19], s56 offen offset:1024 sc1
  s_add_u32 s56, s56, 2560
  buffer_load_dwordx4 v[120:123], v4, s[16:19], s56 offen sc1
  buffer_load_dwordx2 v[124:125], v5, s[16:19], s56 offen offset:2048 sc1
  s_add_u32 s56, s56, 2560
  buffer_load_dwordx4 v[48:51], v22, s[16:19], s57 offen offset:0 sc1
  buffer_load_dwordx4 v[56:59], v22, s[16:19], s57 offen offset:640 sc1
  buffer_load_dwordx2 v[188:189], v14, s[16:19], s57 offen offset:512 sc1
  s_add_u32 s57, s57, 20480
  buffer_load_dwordx4 v[52:55], v22, s[16:19], s57 offen offset:0 sc1
  buffer_load_dwordx4 v[60:63], v22, s[16:19], s57 offen offset:640 sc1
  buffer_load_dwordx2 v[190:191], v14, s[16:19], s57 offen offset:512 sc1
  s_add_u32 s57, s57, 20480
  s_add_u32 s101, s101, 1
  s_cmp_gt_u32 s101, 131072
  s_cbranch_scc1 main_end
  s_waitcnt vmcnt(0)
pvr_243:
  v_max3_u32 v26, v96, v100, v104
  v_max3_u32 v26, v26, v108, v112
  v_max3_u32 v26, v26, v116, v120
  v_max3_u32 v26, v26, v124, v136
  v_max3_u32 v26, v26, v140, v48
  v_max3_u32 v26, v26, v52, v56
  v_max3_u32 v26, v26, v60, v188
  v_max3_u32 v26, v26, v190, v190
  v_cmp_eq_u32 vcc, -1, v26
  s_nop 1
  s_cbranch_vccnz pvr_242
  v_mfma_f32_16x16x32_bf16 v[148:151], a[80:83], v[96:99], v[148:151]
  v_mfma_f32_16x16x32_bf16 v[144:147], a[80:83], v[100:103], v[144:147]
  v_mfma_f32_16x16x32_bf16 v[156:159], a[84:87], v[96:99], v[156:159]
  v_mfma_f32_16x16x32_bf16 v[152:155], a[84:87], v[100:103], v[152:155]
  v_mfma_f32_16x16x32_bf16 v[164:167], a[88:91], v[96:99], v[164:167]
  v_mfma_f32_16x16x32_bf16 v[160:163], a[88:91], v[100:103], v[160:163]
  v_mfma_f32_16x16x32_bf16 v[172:175], a[92:95], v[96:99], v[172:175]
  v_mfma_f32_16x16x32_bf16 v[168:171], a[92:95], v[100:103], v[168:171]
  v_mfma_f32_16x16x32_bf16 v[180:183], a[96:99], v[96:99], v[180:183]
  v_mfma_f32_16x16x32_bf16 v[176:179], a[96:99], v[100:103], v[176:179]
  v_mfma_f32_16x16x32_bf16 v[148:151], a[100:103], v[104:107], v[148:151]
  v_mfma_f32_16x16x32_bf16 v[144:147], a[100:103], v[108:111], v[144:147]
  v_mfma_f32_16x16x32_bf16 v[156:159], a[104:107], v[104:107], v[156:159]
  v_mfma_f32_16x16x32_bf16 v[152:155], a[104:107], v[108:111], v[152:155]
  v_mfma_f32_16x16x32_bf16 v[164:167], a[108:111], v[104:107], v[164:167]
  v_mfma_f32_16x16x32_bf16 v[160:163], a[108:111], v[108:111], v[160:163]
  v_mfma_f32_16x16x32_bf16 v[172:175], a[112:115], v[104:107], v[172:175]
  v_mfma_f32_16x16x32_bf16 v[168:171], a[112:115], v[108:111], v[168:171]
  v_mfma_f32_16x16x32_bf16 v[180:183], a[116:119], v[104:107], v[180:183]
  v_mfma_f32_16x16x32_bf16 v[176:179], a[116:119], v[108:111], v[176:179]
  v_mfma_f32_16x16x32_bf16 v[148:151], a[120:123], v[112:115], v[148:151]
  v_mfma_f32_16x16x32_bf16 v[144:147], a[120:123], v[116:119], v[144:147]
  v_mfma_f32_16x16x32_bf16 v[156:159], a[124:127], v[112:115], v[156:159]
  v_mfma_f32_16x16x32_bf16 v[152:155], a[124:127], v[116:119], v[152:155]
  v_mfma_f32_16x16x32_bf16 v[164:167], a[128:131], v[112:115], v[164:167]
  v_mfma_f32_16x16x32_bf16 v[160:163], a[128:131], v[116:119], v[160:163]
  v_mfma_f32_16x16x32_bf16 v[172:175], a[132:135], v[112:115], v[172:175]
  v_mfma_f32_16x16x32_bf16 v[168:171], a[132:135], v[116:119], v[168:171]
  v_mfma_f32_16x16x32_bf16 v[180:183], a[136:139], v[112:115], v[180:183]
  v_mfma_f32_16x16x32_bf16 v[176:179], a[136:139], v[116:119], v[176:179]
  v_mfma_f32_16x16x32_bf16 v[148:151], a[140:143], v[120:123], v[148:151]
  v_mfma_f32_16x16x32_bf16 v[144:147], a[140:143], v[124:127], v[144:147]
  v_mfma_f32_16x16x32_bf16 v[156:159], a[144:147], v[120:123], v[156:159]
  v_mfma_f32_16x16x32_bf16 v[152:155], a[144:147], v[124:127], v[152:155]
  v_mfma_f32_16x16x32_bf16 v[164:167], a[148:151], v[120:123], v[164:167]
  v_mfma_f32_16x16x32_bf16 v[160:163], a[148:151], v[124:127], v[160:163]
  v_mfma_f32_16x16x32_bf16 v[172:175], a[152:155], v[120:123], v[172:175]
  v_mfma_f32_16x16x32_bf16 v[168:171], a[152:155], v[124:127], v[168:171]
  v_mfma_f32_16x16x32_bf16 v[180:183], a[156:159], v[120:123], v[180:183]
  v_mfma_f32_16x16x32_bf16 v[176:179], a[156:159], v[124:127], v[176:179]
  v_swap_b32 v138, v140
  v_swap_b32 v139, v141
  v_swap_b32 v50, v52
  v_swap_b32 v51, v53
  v_swap_b32 v58, v60
  v_swap_b32 v59, v61
  s_nop 1
  v_mfma_f32_16x16x32_bf16 v[144:147], v[48:51], v[136:139], v[144:147]
  v_mfma_f32_16x16x32_bf16 v[148:151], v[48:51], v[140:143], v[148:151]
  v_mfma_f32_16x16x32_bf16 v[152:155], v[52:55], v[136:139], v[152:155]
  v_mfma_f32_16x16x32_bf16 v[156:159], v[52:55], v[140:143], v[156:159]
  v_mfma_f32_16x16x32_bf16 v[160:163], v[188:191], v[136:139], v[160:163]
  v_mfma_f32_16x16x32_bf16 v[164:167], v[188:191], v[140:143], v[164:167]
  v_mfma_f32_16x16x32_bf16 v[168:171], v[56:59], v[136:139], v[168:171]
  v_mfma_f32_16x16x32_bf16 v[172:175], v[56:59], v[140:143], v[172:175]
  v_mfma_f32_16x16x32_bf16 v[176:179], v[60:63], v[136:139], v[176:179]
  v_mfma_f32_16x16x32_bf16 v[180:183], v[60:63], v[140:143], v[180:183]
pve_231:
  s_nop 0
  ds_write_b128 v10, v[144:147] offset:0
  ds_write_b128 v10, v[148:151] offset:1024
  ds_write_b128 v10, v[152:155] offset:2048
  ds_write_b128 v10, v[156:159] offset:3072
  ds_write_b128 v10, v[160:163] offset:4096
  ds_write_b128 v10, v[164:167] offset:5120
  ds_write_b128 v10, v[168:171] offset:6144
  ds_write_b128 v10, v[172:175] offset:7168
  s_nop 1
  ds_write_b128 v10, v[176:179] offset:8192
  ds_write_b128 v10, v[180:183] offset:9216
  s_cmp_lg_u32 s20, 0
  s_cbranch_scc1 pvq_244
  s_mov_b64 exec, 1
  ds_write_b32 v30, v29
  s_mov_b64 exec, -1
pvq_244:
  s_waitcnt lgkmcnt(0)
  s_barrier
  ds_read_b32 v23, v30
  ds_read_b128 v[192:195], v11 offset:0
  ds_read_b128 v[196:199], v11 offset:10240
  ds_read_b128 v[200:203], v11 offset:20480
  ds_read_b128 v[204:207], v11 offset:30720
  ds_read_b128 v[208:211], v11 offset:2048
  ds_read_b128 v[212:215], v11 offset:12288
  ds_read_b128 v[216:219], v11 offset:22528
  ds_read_b128 v[220:223], v11 offset:32768
  ds_read_b128 v[224:227], v12 offset:0
  ds_read_b128 v[228:231], v12 offset:10240
  ds_read_b128 v[232:235], v12 offset:20480
  ds_read_b128 v[236:239], v12 offset:30720
  s_waitcnt lgkmcnt(8)
  v_pk_add_f32 v[192:193], v[192:193], v[196:197]
  v_pk_add_f32 v[200:201], v[200:201], v[204:205]
  v_pk_add_f32 v[194:195], v[194:195], v[198:199]
  v_pk_add_f32 v[202:203], v[202:203], v[206:207]
  v_pk_add_f32 v[192:193], v[192:193], v[200:201]
  v_pk_add_f32 v[194:195], v[194:195], v[202:203]
  v_cvt_pk_bf16_f32 v26, v192, v193
  v_lshlrev_b32 v192, 16, v26
  v_and_b32 v193, 0xffff0000, v26
  v_mul_f32 v192, v192, v24
  v_mul_f32 v193, v193, v24
  v_cvt_pk_bf16_f32 v26, v192, v193
  v_lshlrev_b32 v192, 16, v26
  v_and_b32 v193, 0xffff0000, v26
  v_add_f32 v192, v192, v240
  v_add_f32 v193, v193, v241
  v_cvt_pk_bf16_f32 v196, v192, v193
  v_cvt_pk_bf16_f32 v26, v194, v195
  v_lshlrev_b32 v194, 16, v26
  v_and_b32 v195, 0xffff0000, v26
  v_mul_f32 v194, v194, v24
  v_mul_f32 v195, v195, v24
  v_cvt_pk_bf16_f32 v26, v194, v195
  v_lshlrev_b32 v194, 16, v26
  v_and_b32 v195, 0xffff0000, v26
  v_add_f32 v194, v194, v242
  v_add_f32 v195, v195, v243
  v_cvt_pk_bf16_f32 v197, v194, v195
  s_waitcnt lgkmcnt(4)
  v_pk_add_f32 v[208:209], v[208:209], v[212:213]
  v_pk_add_f32 v[216:217], v[216:217], v[220:221]
  v_pk_add_f32 v[210:211], v[210:211], v[214:215]
  v_pk_add_f32 v[218:219], v[218:219], v[222:223]
  v_pk_add_f32 v[208:209], v[208:209], v[216:217]
  v_pk_add_f32 v[210:211], v[210:211], v[218:219]
  v_cvt_pk_bf16_f32 v26, v208, v209
  v_lshlrev_b32 v208, 16, v26
  v_and_b32 v209, 0xffff0000, v26
  v_mul_f32 v208, v208, v24
  v_mul_f32 v209, v209, v24
  v_cvt_pk_bf16_f32 v26, v208, v209
  v_lshlrev_b32 v208, 16, v26
  v_and_b32 v209, 0xffff0000, v26
  v_add_f32 v208, v208, v244
  v_add_f32 v209, v209, v245
  v_cvt_pk_bf16_f32 v198, v208, v209
  v_cvt_pk_bf16_f32 v26, v210, v211
  v_lshlrev_b32 v210, 16, v26
  v_and_b32 v211, 0xffff0000, v26
  v_mul_f32 v210, v210, v24
  v_mul_f32 v211, v211, v24
  v_cvt_pk_bf16_f32 v26, v210, v211
  v_lshlrev_b32 v210, 16, v26
  v_and_b32 v211, 0xffff0000, v26
  v_add_f32 v210, v210, v246
  v_add_f32 v211, v211, v247
  v_cvt_pk_bf16_f32 v199, v210, v211
  buffer_store_dwordx4 v[196:199], v9, s[8:11], s46 offen
  s_cmp_ge_u32 s20, 2
  s_cbranch_scc1 pvm_245
  s_waitcnt lgkmcnt(0)
  v_pk_add_f32 v[224:225], v[224:225], v[228:229]
  v_pk_add_f32 v[232:233], v[232:233], v[236:237]
  v_pk_add_f32 v[226:227], v[226:227], v[230:231]
  v_pk_add_f32 v[234:235], v[234:235], v[238:239]
  v_pk_add_f32 v[224:225], v[224:225], v[232:233]
  v_pk_add_f32 v[226:227], v[226:227], v[234:235]
  v_cvt_pk_bf16_f32 v26, v224, v225
  v_lshlrev_b32 v224, 16, v26
  v_and_b32 v225, 0xffff0000, v26
  v_mul_f32 v224, v224, v24
  v_mul_f32 v225, v225, v24
  v_cvt_pk_bf16_f32 v26, v224, v225
  v_lshlrev_b32 v224, 16, v26
  v_and_b32 v225, 0xffff0000, v26
  v_add_f32 v224, v224, v248
  v_add_f32 v225, v225, v249
  v_cvt_pk_bf16_f32 v228, v224, v225
  v_cvt_pk_bf16_f32 v26, v226, v227
  v_lshlrev_b32 v226, 16, v26
  v_and_b32 v227, 0xffff0000, v26
  v_mul_f32 v226, v226, v24
  v_mul_f32 v227, v227, v24
  v_cvt_pk_bf16_f32 v26, v226, v227
  v_lshlrev_b32 v226, 16, v26
  v_and_b32 v227, 0xffff0000, v26
  v_add_f32 v226, v226, v250
  v_add_f32 v227, v227, v251
  v_cvt_pk_bf16_f32 v229, v226, v227
  buffer_store_dwordx2 v[228:229], v13, s[8:11], s49 offen offset:64
pvm_245:
  s_waitcnt lgkmcnt(0)
  v_readfirstlane_b32 s2, v23
  s_barrier
  s_cmp_lt_u32 s2, 16
  s_cbranch_scc1 pv_loop
main_fin:
  s_waitcnt vmcnt(0)
main_end:
  s_endpgm
.section .rodata,"a"
.p2align 6
.amdhsa_kernel gated_mix__memory_aug_recurrent_mem_tr__sliding_local_dilated__prompt_kernel
  .amdhsa_next_free_vgpr 512
  .amdhsa_next_free_sgpr 102
  .amdhsa_accum_offset 256
  .amdhsa_group_segment_fixed_size 0
  .amdhsa_kernarg_size 112
  .amdhsa_user_sgpr_count 2
  .amdhsa_user_sgpr_kernarg_segment_ptr 1
  .amdhsa_system_sgpr_workgroup_id_x 1
.end_amdhsa_kernel
.text
```

```asm
; @launch kernel=gated_mix__memory_aug_recurrent_mem_tr__sliding_local_dilated__prompt_kernel grid=(256,1,1) block=(256,1,1) lds=163840
.amdgcn_target "amdgcn-amd-amdhsa--gfx950"
.text
.globl gated_mix__memory_aug_recurrent_mem_tr__sliding_local_dilated__prompt_kernel
.p2align 8
.type gated_mix__memory_aug_recurrent_mem_tr__sliding_local_dilated__prompt_kernel,@function
gated_mix__memory_aug_recurrent_mem_tr__sliding_local_dilated__prompt_kernel:
  s_cmp_ge_u32 s2, 256
  s_cbranch_scc1 end0
  s_load_dwordx2 s[4:5], s[0:1], 96
  s_load_dwordx2 s[38:39], s[0:1], 104
  v_lshrrev_b32 v1, 6, v0
  v_and_b32 v2, 15, v0
  v_readfirstlane_b32 s20, v1
  v_and_b32 v1, 63, v0
  v_lshrrev_b32 v3, 4, v1
  s_getreg_b32 s50, hwreg(HW_REG_XCC_ID)
  s_and_b32 s50, s50, 7
  s_waitcnt lgkmcnt(0)
  s_mov_b32 s32, s4
  s_mov_b32 s33, s5
  s_mov_b32 s34, 256
  s_mov_b32 s35, 0x00020000
  v_mov_b32 v21, 0
  s_cmp_lg_u32 s20, 0
  s_cbranch_scc1 rk_1
  s_and_b32 s21, s50, 1
  s_lshl_b32 s21, s21, 7
  s_lshl_b32 s22, s50, 1
  s_and_b32 s22, s22, 12
  s_add_u32 s21, s21, s22
  v_mov_b32 v22, s21
  v_mov_b32 v23, 1
  s_mov_b64 exec, 1
  buffer_atomic_add v23, v22, s[32:35], 0 offen sc0 sc1
  s_waitcnt vmcnt(0)
  v_readfirstlane_b32 s51, v23
  s_lshl_b32 s22, s50, 5
  s_add_u32 s22, s22, s51
  s_cmp_lt_u32 s51, 32
  s_cbranch_scc1 rk_2
  v_mov_b32 v24, 72
  v_mov_b32 v25, 1
  buffer_atomic_add v25, v24, s[32:35], 0 offen sc0 sc1
  s_waitcnt vmcnt(0)
  v_readfirstlane_b32 s23, v25
  s_mov_b32 s101, 0
  s_mov_b64 exec, -1
  v_lshlrev_b32 v24, 2, v1
rk_3:
  s_sleep 8
  buffer_load_dword v25, v24, s[32:35], 0 offen sc1
  s_add_u32 s101, s101, 1
  s_cmp_gt_u32 s101, 131072
  s_cbranch_scc1 end0
  s_waitcnt vmcnt(0)
  v_readlane_b32 s21, v25, 0
  v_readlane_b32 s22, v25, 32
  s_add_u32 s21, s21, s22
  v_readlane_b32 s22, v25, 1
  s_add_u32 s21, s21, s22
  v_readlane_b32 s22, v25, 33
  s_add_u32 s21, s21, s22
  v_readlane_b32 s22, v25, 2
  s_add_u32 s21, s21, s22
  v_readlane_b32 s22, v25, 34
  s_add_u32 s21, s21, s22
  v_readlane_b32 s22, v25, 3
  s_add_u32 s21, s21, s22
  v_readlane_b32 s22, v25, 35
  s_add_u32 s21, s21, s22
  s_cmp_lt_u32 s21, 256
  s_cbranch_scc1 rk_3
  s_mov_b64 exec, 1
  s_mov_b32 s24, 0
rk_5:
  s_and_b32 s21, s24, 1
  s_lshl_b32 s21, s21, 5
  s_lshr_b32 s22, s24, 1
  s_add_u32 s21, s21, s22
  v_readlane_b32 s21, v25, s21
  s_min_u32 s21, s21, 32
  s_sub_u32 s25, 32, s21
  s_cmp_lt_u32 s23, s25
  s_cbranch_scc1 rk_4
  s_sub_u32 s23, s23, s25
  s_add_u32 s24, s24, 1
  s_cmp_lt_u32 s24, 8
  s_cbranch_scc1 rk_5
  s_branch end0
rk_4:
  s_lshl_b32 s22, s24, 5
  s_add_u32 s22, s22, s21
  s_add_u32 s22, s22, s23
  s_or_b32 s22, s22, 0x100
rk_2:
  v_mov_b32 v23, s22
  ds_write_b32 v21, v23
  s_waitcnt lgkmcnt(0)
  s_mov_b64 exec, -1
rk_1:
  s_waitcnt vmcnt(0)
  s_barrier
  ds_read_b32 v23, v21
  s_waitcnt lgkmcnt(0)
  v_readfirstlane_b32 s22, v23
  s_barrier
  s_lshr_b32 s53, s22, 8
  s_and_b32 s22, s22, 255
  s_cmp_ge_u32 s22, 128
  s_cbranch_scc1 gemm_side
  s_lshr_b32 s50, s22, 4
  s_and_b32 s51, s22, 15
  s_load_dwordx2 s[4:5], s[0:1], 8
  s_load_dwordx4 s[40:43], s[0:1], 16
  s_load_dwordx4 s[44:47], s[0:1], 32
  s_load_dwordx2 s[48:49], s[0:1], 104
  s_lshr_b32 s55, s51, 2
  s_and_b32 s56, s51, 3
  s_lshl_b32 s57, s50, 2
  s_add_u32 s58, s57, s55
  s_add_u32 s59, s57, s20
  s_lshr_b32 s60, s51, 1
  s_and_b32 s61, s51, 1
  s_mul_i32 s81, s20, 40448
  v_lshlrev_b32 v4, 4, v1
  s_waitcnt lgkmcnt(0)
  s_mov_b32 s12, s44
  s_mov_b32 s13, s45
  s_mov_b32 s14, 7864320
  s_mov_b32 s15, 0x00020000
  s_mov_b32 s16, s46
  s_mov_b32 s17, s47
  s_mov_b32 s18, 7864320
  s_mov_b32 s19, 0x00020000
  s_mov_b32 s24, s40
  s_mov_b32 s25, s41
  s_mov_b32 s26, 7864320
  s_mov_b32 s27, 0x00020000
  s_mov_b32 s28, s42
  s_mov_b32 s29, s43
  s_mov_b32 s30, 7864320
  s_mov_b32 s31, 0x00020000
  s_mov_b32 s36, s4
  s_mov_b32 s37, s5
  s_mov_b32 s38, 10240
  s_mov_b32 s39, 0x00020000
  s_add_u32 s8, s48, 169869312
  s_addc_u32 s9, s49, 0
  s_mov_b32 s10, 491520
  s_mov_b32 s11, 0x00020000
  s_add_u32 s4, s48, 167772160
  s_addc_u32 s5, s49, 0
  s_mov_b32 s6, 1048576
  s_mov_b32 s7, 0x00020000
  v_add_u32 v66, 0, v1
  v_mul_u32_u24 v67, 2731, v66
  v_lshrrev_b32 v67, 16, v67
  v_mul_u32_u24 v48, 24, v67
  v_sub_u32 v66, v66, v48
  v_mul_u32_u24 v67, 12288, v67
  v_lshl_add_u32 v48, v66, 4, v67
  v_add_u32 v66, 64, v1
  v_mul_u32_u24 v67, 2731, v66
  v_lshrrev_b32 v67, 16, v67
  v_mul_u32_u24 v49, 24, v67
  v_sub_u32 v66, v66, v49
  v_mul_u32_u24 v67, 12288, v67
  v_lshl_add_u32 v49, v66, 4, v67
  v_add_u32 v66, 128, v1
  v_mul_u32_u24 v67, 2731, v66
  v_lshrrev_b32 v67, 16, v67
  v_mul_u32_u24 v50, 24, v67
  v_sub_u32 v66, v66, v50
  v_mul_u32_u24 v67, 12288, v67
  v_lshl_add_u32 v50, v66, 4, v67
  s_mul_i32 s21, s51, 491520
  s_mul_i32 s80, s59, 384
  s_add_u32 s21, s21, s80
  s_mov_b32 s23, s21
  v_add_u32 v66, 0, v1
  v_mul_u32_u24 v67, 10923, v66
  v_lshrrev_b32 v67, 16, v67
  v_mul_u32_u24 v60, 6, v67
  v_sub_u32 v66, v66, v60
  v_mul_u32_u24 v67, 1280, v67
  v_lshl_add_u32 v60, v66, 4, v67
  v_add_u32 v66, 64, v1
  v_mul_u32_u24 v67, 10923, v66
  v_lshrrev_b32 v67, 16, v67
  v_mul_u32_u24 v61, 6, v67
  v_sub_u32 v66, v66, v61
  v_mul_u32_u24 v67, 1280, v67
  v_lshl_add_u32 v61, v66, 4, v67
  v_add_u32 v66, 128, v1
  v_mul_u32_u24 v67, 10923, v66
  v_lshrrev_b32 v67, 16, v67
  v_mul_u32_u24 v62, 6, v67
  v_sub_u32 v66, v66, v62
  v_mul_u32_u24 v67, 1280, v67
  v_lshl_add_u32 v62, v66, 4, v67
  s_mul_i32 s21, s59, 245760
  s_mul_i32 s22, s60, 160
  s_add_u32 s21, s21, s22
  s_lshl_b32 s22, s61, 6
  s_add_u32 s21, s21, s22
  s_add_u32 m0, s81, 0
  s_nop 0
  buffer_load_dwordx4 v60, s[16:19], s21 offen lds
  s_add_u32 m0, s81, 1024
  s_nop 0
  buffer_load_dwordx4 v61, s[16:19], s21 offen lds
  s_add_u32 m0, s81, 2048
  s_nop 0
  buffer_load_dwordx4 v62, s[16:19], s21 offen lds
  s_add_u32 s21, s21, 40960
  s_add_u32 m0, s81, 3072
  s_nop 0
  buffer_load_dwordx4 v60, s[16:19], s21 offen lds
  s_add_u32 m0, s81, 4096
  s_nop 0
  buffer_load_dwordx4 v61, s[16:19], s21 offen lds
  s_add_u32 m0, s81, 5120
  s_nop 0
  buffer_load_dwordx4 v62, s[16:19], s21 offen lds
  s_add_u32 s21, s21, 40960
  s_add_u32 m0, s81, 6144
  s_nop 0
  buffer_load_dwordx4 v60, s[16:19], s21 offen lds
  s_add_u32 m0, s81, 7168
  s_nop 0
  buffer_load_dwordx4 v61, s[16:19], s21 offen lds
  s_add_u32 m0, s81, 8192
  s_nop 0
  buffer_load_dwordx4 v62, s[16:19], s21 offen lds
  s_add_u32 s21, s21, 40960
  s_add_u32 m0, s81, 9216
  s_nop 0
  buffer_load_dwordx4 v60, s[16:19], s21 offen lds
  s_add_u32 m0, s81, 10240
  s_nop 0
  buffer_load_dwordx4 v61, s[16:19], s21 offen lds
  s_add_u32 m0, s81, 11264
  s_nop 0
  buffer_load_dwordx4 v62, s[16:19], s21 offen lds
  s_add_u32 s21, s21, 40960
  s_add_u32 m0, s81, 12288
  s_nop 0
  buffer_load_dwordx4 v60, s[16:19], s21 offen lds
  s_add_u32 m0, s81, 13312
  s_nop 0
  buffer_load_dwordx4 v61, s[16:19], s21 offen lds
  s_add_u32 m0, s81, 14336
  s_nop 0
  buffer_load_dwordx4 v62, s[16:19], s21 offen lds
  s_add_u32 s21, s21, 40960
  s_add_u32 m0, s81, 15360
  s_nop 0
  buffer_load_dwordx4 v60, s[16:19], s21 offen lds
  s_add_u32 m0, s81, 16384
  s_nop 0
  buffer_load_dwordx4 v61, s[16:19], s21 offen lds
  s_add_u32 m0, s81, 17408
  s_nop 0
  buffer_load_dwordx4 v62, s[16:19], s21 offen lds
  s_add_u32 s21, s21, 40960
  v_add_u32 v66, 0, v1
  v_mul_u32_u24 v67, 2731, v66
  v_lshrrev_b32 v67, 16, v67
  v_mul_u32_u24 v48, 24, v67
  v_sub_u32 v66, v66, v48
  v_lshrrev_b32 v48, 2, v67
  v_lshlrev_b32 v48, 1, v48
  v_or_b32 v48, 0, v48
  v_xor_b32 v66, v66, v48
  v_add_u32 v67, 0, v67
  v_mul_u32_u24 v67, 12288, v67
  v_lshl_add_u32 v48, v66, 4, v67
  v_add_u32 v66, 64, v1
  v_mul_u32_u24 v67, 2731, v66
  v_lshrrev_b32 v67, 16, v67
  v_mul_u32_u24 v49, 24, v67
  v_sub_u32 v66, v66, v49
  v_lshrrev_b32 v49, 2, v67
  v_lshlrev_b32 v49, 1, v49
  v_or_b32 v49, 0, v49
  v_xor_b32 v66, v66, v49
  v_add_u32 v67, 0, v67
  v_mul_u32_u24 v67, 12288, v67
  v_lshl_add_u32 v49, v66, 4, v67
  v_add_u32 v66, 128, v1
  v_mul_u32_u24 v67, 2731, v66
  v_lshrrev_b32 v67, 16, v67
  v_mul_u32_u24 v50, 24, v67
  v_sub_u32 v66, v66, v50
  v_lshrrev_b32 v50, 2, v67
  v_lshlrev_b32 v50, 1, v50
  v_or_b32 v50, 0, v50
  v_xor_b32 v66, v66, v50
  v_add_u32 v67, 0, v67
  v_mul_u32_u24 v67, 12288, v67
  v_lshl_add_u32 v50, v66, 4, v67
  v_add_u32 v66, 0, v1
  v_mul_u32_u24 v67, 2731, v66
  v_lshrrev_b32 v67, 16, v67
  v_mul_u32_u24 v51, 24, v67
  v_sub_u32 v66, v66, v51
  v_lshrrev_b32 v51, 2, v67
  v_lshlrev_b32 v51, 1, v51
  v_or_b32 v51, 1, v51
  v_xor_b32 v66, v66, v51
  v_add_u32 v67, 8, v67
  v_mul_u32_u24 v67, 12288, v67
  v_lshl_add_u32 v51, v66, 4, v67
  v_add_u32 v66, 64, v1
  v_mul_u32_u24 v67, 2731, v66
  v_lshrrev_b32 v67, 16, v67
  v_mul_u32_u24 v52, 24, v67
  v_sub_u32 v66, v66, v52
  v_lshrrev_b32 v52, 2, v67
  v_lshlrev_b32 v52, 1, v52
  v_or_b32 v52, 1, v52
  v_xor_b32 v66, v66, v52
  v_add_u32 v67, 8, v67
  v_mul_u32_u24 v67, 12288, v67
  v_lshl_add_u32 v52, v66, 4, v67
  v_add_u32 v66, 128, v1
  v_mul_u32_u24 v67, 2731, v66
  v_lshrrev_b32 v67, 16, v67
  v_mul_u32_u24 v53, 24, v67
  v_sub_u32 v66, v66, v53
  v_lshrrev_b32 v53, 2, v67
  v_lshlrev_b32 v53, 1, v53
  v_or_b32 v53, 1, v53
  v_xor_b32 v66, v66, v53
  v_add_u32 v67, 8, v67
  v_mul_u32_u24 v67, 12288, v67
  v_lshl_add_u32 v53, v66, 4, v67
  v_add_u32 v66, 0, v1
  v_mul_u32_u24 v67, 2731, v66
  v_lshrrev_b32 v67, 16, v67
  v_mul_u32_u24 v54, 24, v67
  v_sub_u32 v66, v66, v54
  v_lshrrev_b32 v54, 2, v67
  v_lshlrev_b32 v54, 1, v54
  v_or_b32 v54, 4, v54
  v_xor_b32 v66, v66, v54
  v_add_u32 v67, 16, v67
  v_mul_u32_u24 v67, 12288, v67
  v_lshl_add_u32 v54, v66, 4, v67
  v_add_u32 v66, 64, v1
  v_mul_u32_u24 v67, 2731, v66
  v_lshrrev_b32 v67, 16, v67
  v_mul_u32_u24 v55, 24, v67
  v_sub_u32 v66, v66, v55
  v_lshrrev_b32 v55, 2, v67
  v_lshlrev_b32 v55, 1, v55
  v_or_b32 v55, 4, v55
  v_xor_b32 v66, v66, v55
  v_add_u32 v67, 16, v67
  v_mul_u32_u24 v67, 12288, v67
  v_lshl_add_u32 v55, v66, 4, v67
  v_add_u32 v66, 128, v1
  v_mul_u32_u24 v67, 2731, v66
  v_lshrrev_b32 v67, 16, v67
  v_mul_u32_u24 v56, 24, v67
  v_sub_u32 v66, v66, v56
  v_lshrrev_b32 v56, 2, v67
  v_lshlrev_b32 v56, 1, v56
  v_or_b32 v56, 4, v56
  v_xor_b32 v66, v66, v56
  v_add_u32 v67, 16, v67
  v_mul_u32_u24 v67, 12288, v67
  v_lshl_add_u32 v56, v66, 4, v67
  v_add_u32 v66, 0, v1
  v_mul_u32_u24 v67, 2731, v66
  v_lshrrev_b32 v67, 16, v67
  v_mul_u32_u24 v57, 24, v67
  v_sub_u32 v66, v66, v57
  v_lshrrev_b32 v57, 2, v67
  v_lshlrev_b32 v57, 1, v57
  v_or_b32 v57, 5, v57
  v_xor_b32 v66, v66, v57
  v_add_u32 v67, 24, v67
  v_mul_u32_u24 v67, 12288, v67
  v_lshl_add_u32 v57, v66, 4, v67
  v_add_u32 v66, 64, v1
  v_mul_u32_u24 v67, 2731, v66
  v_lshrrev_b32 v67, 16, v67
  v_mul_u32_u24 v58, 24, v67
  v_sub_u32 v66, v66, v58
  v_lshrrev_b32 v58, 2, v67
  v_lshlrev_b32 v58, 1, v58
  v_or_b32 v58, 5, v58
  v_xor_b32 v66, v66, v58
  v_add_u32 v67, 24, v67
  v_mul_u32_u24 v67, 12288, v67
  v_lshl_add_u32 v58, v66, 4, v67
  v_add_u32 v66, 128, v1
  v_mul_u32_u24 v67, 2731, v66
  v_lshrrev_b32 v67, 16, v67
  v_mul_u32_u24 v59, 24, v67
  v_sub_u32 v66, v66, v59
  v_lshrrev_b32 v59, 2, v67
  v_lshlrev_b32 v59, 1, v59
  v_or_b32 v59, 5, v59
  v_xor_b32 v66, v66, v59
  v_add_u32 v67, 24, v67
  v_mul_u32_u24 v67, 12288, v67
  v_lshl_add_u32 v59, v66, 4, v67
  s_add_u32 m0, s81, 24576
  s_nop 0
  buffer_load_dwordx4 v48, s[12:15], s80 offen lds
  s_add_u32 m0, s81, 25600
  s_nop 0
  buffer_load_dwordx4 v49, s[12:15], s80 offen lds
  s_add_u32 m0, s81, 26624
  s_nop 0
  buffer_load_dwordx4 v50, s[12:15], s80 offen lds
  s_add_u32 m0, s81, 27648
  s_nop 0
  buffer_load_dwordx4 v51, s[12:15], s80 offen lds
  s_add_u32 m0, s81, 28672
  s_nop 0
  buffer_load_dwordx4 v52, s[12:15], s80 offen lds
  s_add_u32 m0, s81, 29696
  s_nop 0
  buffer_load_dwordx4 v53, s[12:15], s80 offen lds
  s_add_u32 m0, s81, 30720
  s_nop 0
  buffer_load_dwordx4 v54, s[12:15], s80 offen lds
  s_add_u32 m0, s81, 31744
  s_nop 0
  buffer_load_dwordx4 v55, s[12:15], s80 offen lds
  s_add_u32 m0, s81, 32768
  s_nop 0
  buffer_load_dwordx4 v56, s[12:15], s80 offen lds
  s_add_u32 m0, s81, 33792
  s_nop 0
  buffer_load_dwordx4 v57, s[12:15], s80 offen lds
  s_add_u32 m0, s81, 34816
  s_nop 0
  buffer_load_dwordx4 v58, s[12:15], s80 offen lds
  s_add_u32 m0, s81, 35840
  s_nop 0
  buffer_load_dwordx4 v59, s[12:15], s80 offen lds
  s_add_u32 s80, s80, 393216
  v_add_u32 v66, 0, v1
  v_mul_u32_u24 v67, 10923, v66
  v_lshrrev_b32 v67, 16, v67
  v_mul_u32_u24 v63, 6, v67
  v_sub_u32 v66, v66, v63
  v_mul_u32_u24 v67, 12288, v67
  v_lshl_add_u32 v63, v66, 4, v67
  v_add_u32 v66, 64, v1
  v_mul_u32_u24 v67, 10923, v66
  v_lshrrev_b32 v67, 16, v67
  v_mul_u32_u24 v64, 6, v67
  v_sub_u32 v66, v66, v64
  v_mul_u32_u24 v67, 12288, v67
  v_lshl_add_u32 v64, v66, 4, v67
  v_add_u32 v66, 128, v1
  v_mul_u32_u24 v67, 10923, v66
  v_lshrrev_b32 v67, 16, v67
  v_mul_u32_u24 v65, 6, v67
  v_sub_u32 v66, v66, v65
  v_mul_u32_u24 v67, 12288, v67
  v_lshl_add_u32 v65, v66, 4, v67
  s_mul_i32 s79, s58, 384
  s_mul_i32 s22, s56, 96
  s_add_u32 s79, s79, s22
  s_mul_i32 s22, s20, 1966080
  s_add_u32 s79, s79, s22
  v_and_b32 v224, 7, v2
  v_lshrrev_b32 v225, 3, v2
  v_lshlrev_b32 v12, 3, v1
  v_mov_b32 v23, 0
  v_mov_b32 v226, 0x4444
  v_mov_b32 v227, 0xeeee
  v_cmp_eq_u32 vcc, 1, v225
  v_cmp_gt_u32 s[62:63], 8, v2
  v_cmp_le_u32 s[68:69], 8, v2
  v_cndmask_b32 v22, v226, v227, vcc
  v_cmp_gt_u32 vcc, 32, v1
  v_mov_b32 v226, 0x3dd53b95
  v_cmp_gt_u32 s[66:67], 40, v1
  v_cndmask_b32 v24, 1.0, v226, vcc
  v_cndmask_b32 v25, 1.0, v226, vcc
  v_min_u32 v226, 39, v1
  v_and_b32 v227, 31, v1
  v_lshlrev_b32 v227, 2, v227
  v_lshl_add_u32 v5, v226, 7, v227
  v_mul_u32_u24 v226, 192, v3
  v_lshl_add_u32 v226, v2, 3, v226
  s_mul_i32 s21, s20, 768
  s_add_u32 s21, s21, 10240
  v_add_u32 v6, s21, v226
  v_and_b32 v226, 3, v2
  v_mul_u32_u24 v226, 192, v226
  v_lshrrev_b32 v227, 2, v2
  v_lshl_add_u32 v227, v3, 2, v227
  v_lshl_add_u32 v226, v227, 3, v226
  v_add_u32 v7, 10240, v226
  s_mul_i32 s21, s58, 2560
  s_add_u32 s21, s21, 40960
  s_lshr_b32 s22, s56, 1
  s_lshl_b32 s22, s22, 10
  s_and_b32 s23, s56, 1
  s_lshl_b32 s23, s23, 3
  s_add_u32 s22, s22, s23
  s_lshl_b32 s23, s20, 7
  s_add_u32 s22, s22, s23
  s_add_u32 s22, s22, s21
  v_lshlrev_b32 v226, 8, v3
  v_lshl_add_u32 v226, v224, 4, v226
  v_add_u32 v8, s22, v226
  s_lshl_b32 s22, s56, 2
  s_add_u32 s22, s22, s21
  s_add_u32 s22, s22, 2048
  v_and_b32 v226, 0x1ff, v226
  v_add_u32 v226, s22, v226
  s_cmp_eq_u32 s20, 2
  s_cselect_b64 vcc, -1, 0
  v_cmp_le_u32 s[64:65], 32, v1
  v_cndmask_b32 v8, v8, v226, vcc
  s_cselect_b64 s[64:65], s[64:65], -1
  s_and_b64 s[64:65], s[64:65], s[62:63]
  s_mul_i32 s21, s59, 2560
  s_add_u32 s21, s21, 40960
  v_add_u32 v9, s21, v4
  v_and_b32 v226, 0x1ff, v4
  s_add_u32 s21, s21, 2048
  v_add_u32 v10, s21, v226
  v_lshrrev_b32 v226, 2, v2
  v_and_b32 v227, 1, v2
  v_lshl_add_u32 v228, v226, 1, v227
  v_and_b32 v227, 2, v2
  v_cmp_eq_u32 vcc, 0, v227
  s_lshr_b32 s21, s20, 1
  s_lshl_b32 s21, s21, 9
  s_and_b32 s22, s20, 1
  s_lshl_b32 s22, s22, 6
  s_add_u32 s21, s21, s22
  s_add_u32 s21, s21, 12544
  v_lshlrev_b32 v226, 7, v3
  v_lshl_add_u32 v226, v228, 3, v226
  v_add_u32 v226, s21, v226
  v_mov_b32 v227, 13568
  v_cndmask_b32 v11, v227, v226, vcc
  s_lshl_b32 s21, s20, 9
  s_add_u32 s21, s21, 40960
  v_lshlrev_b32 v226, 7, v3
  v_lshl_add_u32 v226, v228, 4, v226
  v_add_u32 v226, s21, v226
  v_mov_b32 v227, 46080
  v_cndmask_b32 v19, v227, v226, vcc
  s_lshl_b32 s21, s20, 11
  s_add_u32 s21, s21, 32768
  v_add_u32 v18, s21, v4
  s_and_b32 s21, s20, 1
  s_lshl_b32 s22, s21, 10
  s_add_u32 s22, s22, 43008
  v_add_u32 v20, s22, v4
  s_lshl_b32 s22, s21, 3
  s_add_u32 s22, s22, 45056
  v_add_u32 v21, s22, v4
  s_mul_i32 s21, s20, 640
  s_add_u32 s22, s21, 13824
  v_lshlrev_b32 v226, 4, v224
  v_lshl_add_u32 v227, v3, 7, v226
  v_add_u32 v13, s22, v227
  v_lshl_add_u32 v227, v3, 2, v226
  s_add_u32 s22, s22, 512
  v_add_u32 v14, s22, v227
  v_and_b32 v226, 0x1ff, v4
  v_lshrrev_b32 v228, 5, v1
  v_lshl_add_u32 v226, v228, 3, v226
  s_add_u32 s22, s21, 16384
  v_add_u32 v26, s22, v226
  v_lshl_add_u32 v228, v228, 1, v225
  v_mul_u32_u24 v228, 640, v228
  v_and_b32 v226, 1, v3
  v_lshl_add_u32 v228, v226, 6, v228
  v_lshl_add_u32 v228, v224, 3, v228
  v_add_u32 v43, 16896, v228
  s_and_b32 s21, s50, 1
  s_lshl_b32 s21, s21, 4
  s_add_u32 s21, s21, s51
  s_lshl_b32 s22, s20, 5
  s_add_u32 s21, s21, s22
  s_cmp_lt_u32 s21, 80
  s_cselect_b32 s78, 1, 0
  s_cselect_b32 s21, s21, 0
  s_lshl_b32 s22, s21, 7
  v_add_u32 v17, s22, v227
  s_lshr_b32 s22, s21, 3
  s_lshl_b32 s22, s22, 14
  s_and_b32 s21, s21, 7
  s_lshl_b32 s21, s21, 10
  s_add_u32 s21, s21, s22
  v_add_u32 v16, s21, v4
  s_mul_i32 s21, s60, 10
  s_mul_i32 s22, s61, 6
  s_add_u32 s22, s22, s21
  s_add_u32 s21, s21, s61
  s_add_u32 s21, s21, 4
  v_lshrrev_b32 v226, 3, v1
  v_cmp_gt_u32 vcc, 4, v226
  v_add_u32 v226, s22, v226
  v_mov_b32 v227, s21
  v_cndmask_b32 v226, v227, v226, vcc
  v_lshrrev_b32 v227, 3, v226
  v_lshlrev_b32 v227, 14, v227
  v_and_b32 v226, 7, v226
  v_lshl_add_u32 v226, v226, 10, v227
  v_lshl_add_u32 v226, v224, 4, v226
  s_lshl_b32 s21, s50, 7
  v_add_u32 v15, s21, v226
  v_and_b32 v226, 1, v2
  v_lshlrev_b32 v226, 4, v226
  v_mov_b32 v227, 0x3c00
  v_lshlrev_b32 v226, v226, v227
  v_lshrrev_b32 v227, 1, v2
  v_cmp_eq_u32 vcc, 0, v227
  s_nop 1
  v_cndmask_b32 v44, 0, v226, vcc
  v_cmp_eq_u32 vcc, 2, v227
  s_nop 1
  v_cndmask_b32 v45, 0, v226, vcc
  v_cmp_eq_u32 vcc, 4, v227
  s_nop 1
  v_cndmask_b32 v46, 0, v226, vcc
  v_cmp_eq_u32 vcc, 6, v227
  s_nop 1
  v_cndmask_b32 v47, 0, v226, vcc
  v_lshrrev_b32 v226, 5, v1
  v_lshlrev_b32 v226, 14, v226
  v_bfe_u32 v227, v1, 3, 2
  v_lshl_add_u32 v226, v227, 8, v226
  v_lshl_add_u32 v226, v224, 4, v226
  s_lshl_b32 s21, s61, 7
  v_add_u32 v32, s21, v226
  v_lshlrev_b32 v226, 4, v224
  v_lshl_add_u32 v36, v3, 7, v226
  v_lshrrev_b32 v37, 1, v36
  v_and_b32 v41, 3, v1
  v_lshlrev_b32 v41, 7, v41
  v_mov_b32 v226, 0x40000000
  v_cmp_gt_u32 vcc, 32, v1
  v_cndmask_b32 v36, v226, v36, s[68:69]
  v_cndmask_b32 v37, v226, v37, s[68:69]
  v_cndmask_b32 v38, v226, v4, vcc
  v_mov_b32 v28, -1
  v_mov_b32 v29, -1
  v_mov_b32 v30, -1
  v_mov_b32 v31, -1
  s_lshr_b32 s21, s50, 1
  s_mul_i32 s77, s21, 10240
  s_cmp_eq_u32 s20, 3
  s_cbranch_scc1 ar_8
  s_mov_b64 exec, s[64:65]
  s_cmp_eq_u32 s20, 2
  s_cbranch_scc1 ar_7
  s_mov_b32 s21, 0
  buffer_store_dwordx2 v[28:29], v8, s[8:11], s21 offen
  s_mov_b32 s21, 122880
  buffer_store_dwordx2 v[28:29], v8, s[8:11], s21 offen
  s_mov_b32 s21, 245760
  buffer_store_dwordx2 v[28:29], v8, s[8:11], s21 offen
  s_mov_b32 s21, 368640
  buffer_store_dwordx2 v[28:29], v8, s[8:11], s21 offen
  s_branch ar_9
ar_7:
  s_mov_b32 s21, 0
  buffer_store_dword v28, v8, s[8:11], s21 offen
  buffer_store_dword v28, v8, s[8:11], s21 offen offset:128
  s_mov_b32 s21, 122880
  buffer_store_dword v28, v8, s[8:11], s21 offen
  buffer_store_dword v28, v8, s[8:11], s21 offen offset:128
  s_mov_b32 s21, 245760
  buffer_store_dword v28, v8, s[8:11], s21 offen
  buffer_store_dword v28, v8, s[8:11], s21 offen offset:128
  s_mov_b32 s21, 368640
  buffer_store_dword v28, v8, s[8:11], s21 offen
  buffer_store_dword v28, v8, s[8:11], s21 offen offset:128
ar_9:
  s_cmp_eq_u32 s78, 0
  s_cbranch_scc1 ar_10
  s_mov_b64 exec, s[62:63]
  s_add_u32 s21, s77, 0
  buffer_store_dword v28, v17, s[8:11], s21 offen
  s_add_u32 s21, s77, 122880
  buffer_store_dword v28, v17, s[8:11], s21 offen
  s_add_u32 s21, s77, 245760
  buffer_store_dword v28, v17, s[8:11], s21 offen
  s_add_u32 s21, s77, 368640
  buffer_store_dword v28, v17, s[8:11], s21 offen
  s_branch ar_10
ar_8:
  s_mov_b64 exec, s[66:67]
  s_mov_b32 s21, 0
  buffer_store_dwordx4 v[28:31], v15, s[4:7], s21 offen sc1
  s_mov_b32 s21, 524288
  buffer_store_dwordx4 v[28:31], v15, s[4:7], s21 offen sc1
  s_mov_b32 s21, 8192
  buffer_store_dwordx4 v[28:31], v15, s[4:7], s21 offen sc1
  s_mov_b32 s21, 532480
  buffer_store_dwordx4 v[28:31], v15, s[4:7], s21 offen sc1
ar_10:
  s_mov_b64 exec, -1
  v_lshrrev_b32 v66, 2, v2
  v_lshl_add_u32 v66, v3, 3, v66
  v_mul_u32_u24 v66, 96, v66
  v_add_u32 v66, s81, v66
  v_and_b32 v67, 3, v2
  s_lshl_b32 s21, s61, 5
  v_lshl_add_u32 v68, v67, 4, v66
  v_add_u32 v68, s21, v68
  s_mul_i32 s21, s61, 48
  s_sub_u32 s21, 64, s21
  v_and_b32 v67, 1, v2
  v_lshl_add_u32 v69, v67, 3, v66
  v_add_u32 v69, s21, v69
  v_lshrrev_b32 v226, 3, v2
  v_lshlrev_b32 v226, 4, v226
  v_bfe_u32 v227, v2, 1, 1
  v_lshl_add_u32 v226, v227, 3, v226
  v_and_b32 v227, 5, v2
  v_add_u32 v226, v226, v227
  v_mul_u32_u24 v226, 384, v226
  v_add_u32 v226, s81, v226
  v_lshrrev_b32 v227, 1, v2
  v_xor_b32 v227, v227, v3
  v_lshl_add_u32 v70, v227, 4, v226
  v_xor_b32 v227, 4, v227
  v_lshl_add_u32 v71, v227, 4, v226
  s_waitcnt vmcnt(0)
  ds_read_b64_tr_b16 v[72:73], v68 offset:0
  ds_read_b64_tr_b16 v[74:75], v68 offset:384
  ds_read_b64_tr_b16 v[76:77], v68 offset:8
  ds_read_b64_tr_b16 v[78:79], v68 offset:392
  ds_read_b64_tr_b16 v[80:81], v69 offset:0
  ds_read_b64_tr_b16 v[82:83], v69 offset:384
  ds_read_b64_tr_b16 v[84:85], v68 offset:3072
  ds_read_b64_tr_b16 v[86:87], v68 offset:3456
  ds_read_b64_tr_b16 v[88:89], v68 offset:3080
  ds_read_b64_tr_b16 v[90:91], v68 offset:3464
  ds_read_b64_tr_b16 v[92:93], v69 offset:3072
  ds_read_b64_tr_b16 v[94:95], v69 offset:3456
  ds_read_b64_tr_b16 v[96:97], v68 offset:6144
  ds_read_b64_tr_b16 v[98:99], v68 offset:6528
  ds_read_b64_tr_b16 v[100:101], v68 offset:6152
  ds_read_b64_tr_b16 v[102:103], v68 offset:6536
  ds_read_b64_tr_b16 v[104:105], v69 offset:6144
  ds_read_b64_tr_b16 v[106:107], v69 offset:6528
  ds_read_b64_tr_b16 v[108:109], v68 offset:9216
  ds_read_b64_tr_b16 v[110:111], v68 offset:9600
  ds_read_b64_tr_b16 v[112:113], v68 offset:9224
  ds_read_b64_tr_b16 v[114:115], v68 offset:9608
  ds_read_b64_tr_b16 v[116:117], v69 offset:9216
  ds_read_b64_tr_b16 v[118:119], v69 offset:9600
  ds_read_b64_tr_b16 v[120:121], v68 offset:12288
  ds_read_b64_tr_b16 v[122:123], v68 offset:12672
  ds_read_b64_tr_b16 v[124:125], v68 offset:12296
  ds_read_b64_tr_b16 v[126:127], v68 offset:12680
  ds_read_b64_tr_b16 v[128:129], v69 offset:12288
  ds_read_b64_tr_b16 v[130:131], v69 offset:12672
  ds_read_b64_tr_b16 v[132:133], v68 offset:15360
  ds_read_b64_tr_b16 v[134:135], v68 offset:15744
  ds_read_b64_tr_b16 v[136:137], v68 offset:15368
  ds_read_b64_tr_b16 v[138:139], v68 offset:15752
  ds_read_b64_tr_b16 v[140:141], v69 offset:15360
  ds_read_b64_tr_b16 v[142:143], v69 offset:15744
  s_waitcnt lgkmcnt(0)
  s_barrier
  s_cmp_lg_u32 s20, 0
  s_cbranch_scc1 ic_11
  v_mov_b32 v68, 64
  v_mov_b32 v69, 1
  s_mov_b64 exec, 1
  buffer_atomic_add v69, v68, s[32:35], 0 offen sc1
  s_mov_b64 exec, -1
ic_11:
  s_add_u32 m0, s81, 0
  s_nop 0
  buffer_load_dwordx4 v48, s[12:15], s80 offen lds
  s_add_u32 m0, s81, 1024
  s_nop 0
  buffer_load_dwordx4 v49, s[12:15], s80 offen lds
  s_add_u32 m0, s81, 2048
  s_nop 0
  buffer_load_dwordx4 v50, s[12:15], s80 offen lds
  s_add_u32 m0, s81, 3072
  s_nop 0
  buffer_load_dwordx4 v51, s[12:15], s80 offen lds
  s_add_u32 m0, s81, 4096
  s_nop 0
  buffer_load_dwordx4 v52, s[12:15], s80 offen lds
  s_add_u32 m0, s81, 5120
  s_nop 0
  buffer_load_dwordx4 v53, s[12:15], s80 offen lds
  s_add_u32 m0, s81, 6144
  s_nop 0
  buffer_load_dwordx4 v54, s[12:15], s80 offen lds
  s_add_u32 m0, s81, 7168
  s_nop 0
  buffer_load_dwordx4 v55, s[12:15], s80 offen lds
  s_add_u32 m0, s81, 8192
  s_nop 0
  buffer_load_dwordx4 v56, s[12:15], s80 offen lds
  s_add_u32 m0, s81, 9216
  s_nop 0
  buffer_load_dwordx4 v57, s[12:15], s80 offen lds
  s_add_u32 m0, s81, 10240
  s_nop 0
  buffer_load_dwordx4 v58, s[12:15], s80 offen lds
  s_add_u32 m0, s81, 11264
  s_nop 0
  buffer_load_dwordx4 v59, s[12:15], s80 offen lds
  s_add_u32 s80, s80, 393216
  ds_read_b128 v[208:211], v70 offset:24576
  ds_read_b128 v[212:215], v71 offset:24576
  ds_read_b128 v[216:219], v70 offset:24704
  s_waitcnt lgkmcnt(2)
  v_mfma_f32_16x16x32_bf16 v[184:187], v[208:211], v[72:75], 0
  ds_read_b128 v[220:223], v71 offset:24704
  v_mfma_f32_16x16x32_bf16 v[188:191], v[208:211], v[76:79], 0
  s_add_u32 m0, s81, 12288
  s_nop 0
  buffer_load_dwordx4 v48, s[12:15], s80 offen lds
  v_mfma_f32_16x16x32_bf16 v[192:195], v[208:211], v[80:83], 0
  s_waitcnt lgkmcnt(2)
  v_mfma_f32_16x16x32_bf16 v[184:187], v[212:215], v[84:87], v[184:187]
  ds_read_b128 v[208:211], v70 offset:24832
  v_mfma_f32_16x16x32_bf16 v[188:191], v[212:215], v[88:91], v[188:191]
  s_add_u32 m0, s81, 13312
  s_nop 0
  buffer_load_dwordx4 v49, s[12:15], s80 offen lds
  v_mfma_f32_16x16x32_bf16 v[192:195], v[212:215], v[92:95], v[192:195]
  s_waitcnt lgkmcnt(2)
  v_mfma_f32_16x16x32_bf16 v[184:187], v[216:219], v[96:99], v[184:187]
  ds_read_b128 v[212:215], v71 offset:24832
  v_mfma_f32_16x16x32_bf16 v[188:191], v[216:219], v[100:103], v[188:191]
  s_add_u32 m0, s81, 14336
  s_nop 0
  buffer_load_dwordx4 v50, s[12:15], s80 offen lds
  v_mfma_f32_16x16x32_bf16 v[192:195], v[216:219], v[104:107], v[192:195]
  s_waitcnt lgkmcnt(2)
  v_mfma_f32_16x16x32_bf16 v[184:187], v[220:223], v[108:111], v[184:187]
  ds_read_b128 v[216:219], v70 offset:25344
  v_mfma_f32_16x16x32_bf16 v[188:191], v[220:223], v[112:115], v[188:191]
  s_add_u32 m0, s81, 15360
  s_nop 0
  buffer_load_dwordx4 v51, s[12:15], s80 offen lds
  v_mfma_f32_16x16x32_bf16 v[192:195], v[220:223], v[116:119], v[192:195]
  s_waitcnt lgkmcnt(2)
  v_mfma_f32_16x16x32_bf16 v[184:187], v[208:211], v[120:123], v[184:187]
  ds_read_b128 v[220:223], v71 offset:25344
  v_mfma_f32_16x16x32_bf16 v[188:191], v[208:211], v[124:127], v[188:191]
  s_add_u32 m0, s81, 16384
  s_nop 0
  buffer_load_dwordx4 v52, s[12:15], s80 offen lds
  v_mfma_f32_16x16x32_bf16 v[192:195], v[208:211], v[128:131], v[192:195]
  s_waitcnt lgkmcnt(2)
  v_mfma_f32_16x16x32_bf16 v[184:187], v[212:215], v[132:135], v[184:187]
  ds_read_b128 v[208:211], v70 offset:25472
  v_mfma_f32_16x16x32_bf16 v[188:191], v[212:215], v[136:139], v[188:191]
  s_add_u32 m0, s81, 17408
  s_nop 0
  buffer_load_dwordx4 v53, s[12:15], s80 offen lds
  v_mfma_f32_16x16x32_bf16 v[192:195], v[212:215], v[140:143], v[192:195]
  s_waitcnt lgkmcnt(2)
  v_mfma_f32_16x16x32_bf16 v[196:199], v[216:219], v[72:75], 0
  ds_read_b128 v[212:215], v71 offset:25472
  v_mfma_f32_16x16x32_bf16 v[200:203], v[216:219], v[76:79], 0
  s_add_u32 m0, s81, 18432
  s_nop 0
  buffer_load_dwordx4 v54, s[12:15], s80 offen lds
  v_mfma_f32_16x16x32_bf16 v[204:207], v[216:219], v[80:83], 0
  s_waitcnt lgkmcnt(2)
  v_mfma_f32_16x16x32_bf16 v[196:199], v[220:223], v[84:87], v[196:199]
  ds_read_b128 v[216:219], v70 offset:25600
  v_cvt_pk_bf16_f32 v248, v184, v185
  v_mfma_f32_16x16x32_bf16 v[200:203], v[220:223], v[88:91], v[200:203]
  s_add_u32 m0, s81, 19456
  s_nop 0
  buffer_load_dwordx4 v55, s[12:15], s80 offen lds
  v_mfma_f32_16x16x32_bf16 v[204:207], v[220:223], v[92:95], v[204:207]
  v_cvt_pk_bf16_f32 v249, v186, v187
  s_waitcnt lgkmcnt(2)
  v_mfma_f32_16x16x32_bf16 v[196:199], v[208:211], v[96:99], v[196:199]
  ds_read_b128 v[220:223], v71 offset:25600
  v_cvt_pk_bf16_f32 v250, v188, v189
  v_mfma_f32_16x16x32_bf16 v[200:203], v[208:211], v[100:103], v[200:203]
  s_add_u32 m0, s81, 20480
  s_nop 0
  buffer_load_dwordx4 v56, s[12:15], s80 offen lds
  v_mfma_f32_16x16x32_bf16 v[204:207], v[208:211], v[104:107], v[204:207]
  v_cvt_pk_bf16_f32 v251, v190, v191
  s_waitcnt lgkmcnt(2)
  v_mfma_f32_16x16x32_bf16 v[196:199], v[212:215], v[108:111], v[196:199]
  v_accvgpr_write_b32 a0, v248
  v_mfma_f32_16x16x32_bf16 v[200:203], v[212:215], v[112:115], v[200:203]
  s_add_u32 m0, s81, 21504
  s_nop 0
  buffer_load_dwordx4 v57, s[12:15], s80 offen lds
  v_mfma_f32_16x16x32_bf16 v[204:207], v[212:215], v[116:119], v[204:207]
  v_accvgpr_write_b32 a1, v249
  s_waitcnt lgkmcnt(1)
  v_mfma_f32_16x16x32_bf16 v[196:199], v[216:219], v[120:123], v[196:199]
  v_accvgpr_write_b32 a80, v250
  v_mfma_f32_16x16x32_bf16 v[200:203], v[216:219], v[124:127], v[200:203]
  s_add_u32 m0, s81, 22528
  s_nop 0
  buffer_load_dwordx4 v58, s[12:15], s80 offen lds
  v_mfma_f32_16x16x32_bf16 v[204:207], v[216:219], v[128:131], v[204:207]
  v_accvgpr_write_b32 a81, v251
  s_waitcnt lgkmcnt(0)
  v_mfma_f32_16x16x32_bf16 v[196:199], v[220:223], v[132:135], v[196:199]
  v_cvt_pk_bf16_f32 v144, v192, v193
  v_cvt_pk_bf16_f32 v145, v194, v195
  v_mfma_f32_16x16x32_bf16 v[200:203], v[220:223], v[136:139], v[200:203]
  s_add_u32 m0, s81, 23552
  s_nop 0
  buffer_load_dwordx4 v59, s[12:15], s80 offen lds
  s_add_u32 s80, s80, 393216
  v_mfma_f32_16x16x32_bf16 v[204:207], v[220:223], v[140:143], v[204:207]
  s_add_u32 s21, s79, 0
  buffer_load_dwordx4 a[160:163], v63, s[24:27], s21 offen
  s_add_u32 s21, s79, 0
  buffer_load_dwordx4 a[164:167], v64, s[24:27], s21 offen
  s_waitcnt vmcnt(14)
  ds_read_b128 v[208:211], v70 offset:0
  ds_read_b128 v[212:215], v71 offset:0
  ds_read_b128 v[216:219], v70 offset:128
  s_waitcnt lgkmcnt(2)
  v_mfma_f32_16x16x32_bf16 v[184:187], v[208:211], v[72:75], 0
  ds_read_b128 v[220:223], v71 offset:128
  v_mfma_f32_16x16x32_bf16 v[188:191], v[208:211], v[76:79], 0
  s_add_u32 m0, s81, 24576
  s_nop 0
  buffer_load_dwordx4 v48, s[12:15], s80 offen lds
  v_mfma_f32_16x16x32_bf16 v[192:195], v[208:211], v[80:83], 0
  s_waitcnt lgkmcnt(2)
  v_mfma_f32_16x16x32_bf16 v[184:187], v[212:215], v[84:87], v[184:187]
  ds_read_b128 v[208:211], v70 offset:256
  v_cvt_pk_bf16_f32 v248, v196, v197
  v_mfma_f32_16x16x32_bf16 v[188:191], v[212:215], v[88:91], v[188:191]
  s_add_u32 m0, s81, 25600
  s_nop 0
  buffer_load_dwordx4 v49, s[12:15], s80 offen lds
  v_mfma_f32_16x16x32_bf16 v[192:195], v[212:215], v[92:95], v[192:195]
  v_cvt_pk_bf16_f32 v249, v198, v199
  s_waitcnt lgkmcnt(2)
  v_mfma_f32_16x16x32_bf16 v[184:187], v[216:219], v[96:99], v[184:187]
  ds_read_b128 v[212:215], v71 offset:256
  v_cvt_pk_bf16_f32 v250, v200, v201
  v_mfma_f32_16x16x32_bf16 v[188:191], v[216:219], v[100:103], v[188:191]
  s_add_u32 m0, s81, 26624
  s_nop 0
  buffer_load_dwordx4 v50, s[12:15], s80 offen lds
  v_mfma_f32_16x16x32_bf16 v[192:195], v[216:219], v[104:107], v[192:195]
  v_cvt_pk_bf16_f32 v251, v202, v203
  s_waitcnt lgkmcnt(2)
  v_mfma_f32_16x16x32_bf16 v[184:187], v[220:223], v[108:111], v[184:187]
  ds_read_b128 v[216:219], v70 offset:768
  v_accvgpr_write_b32 a2, v248
  v_mfma_f32_16x16x32_bf16 v[188:191], v[220:223], v[112:115], v[188:191]
  s_add_u32 m0, s81, 27648
  s_nop 0
  buffer_load_dwordx4 v51, s[12:15], s80 offen lds
  v_mfma_f32_16x16x32_bf16 v[192:195], v[220:223], v[116:119], v[192:195]
  v_accvgpr_write_b32 a3, v249
  s_waitcnt lgkmcnt(2)
  v_mfma_f32_16x16x32_bf16 v[184:187], v[208:211], v[120:123], v[184:187]
  ds_read_b128 v[220:223], v71 offset:768
  v_accvgpr_write_b32 a82, v250
  v_mfma_f32_16x16x32_bf16 v[188:191], v[208:211], v[124:127], v[188:191]
  s_add_u32 m0, s81, 28672
  s_nop 0
  buffer_load_dwordx4 v52, s[12:15], s80 offen lds
  v_mfma_f32_16x16x32_bf16 v[192:195], v[208:211], v[128:131], v[192:195]
  v_accvgpr_write_b32 a83, v251
  s_waitcnt lgkmcnt(2)
  v_mfma_f32_16x16x32_bf16 v[184:187], v[212:215], v[132:135], v[184:187]
  ds_read_b128 v[208:211], v70 offset:896
  s_mov_b64 exec, s[68:69]
  v_cvt_pk_bf16_f32 v144, v204, v205
  v_cvt_pk_bf16_f32 v145, v206, v207
  s_mov_b64 exec, -1
  v_mfma_f32_16x16x32_bf16 v[188:191], v[212:215], v[136:139], v[188:191]
  s_add_u32 m0, s81, 29696
  s_nop 0
  buffer_load_dwordx4 v53, s[12:15], s80 offen lds
  v_mfma_f32_16x16x32_bf16 v[192:195], v[212:215], v[140:143], v[192:195]
  s_waitcnt lgkmcnt(2)
  v_mfma_f32_16x16x32_bf16 v[196:199], v[216:219], v[72:75], 0
  ds_read_b128 v[212:215], v71 offset:896
  v_mfma_f32_16x16x32_bf16 v[200:203], v[216:219], v[76:79], 0
  s_add_u32 m0, s81, 30720
  s_nop 0
  buffer_load_dwordx4 v54, s[12:15], s80 offen lds
  v_mfma_f32_16x16x32_bf16 v[204:207], v[216:219], v[80:83], 0
  s_waitcnt lgkmcnt(2)
  v_mfma_f32_16x16x32_bf16 v[196:199], v[220:223], v[84:87], v[196:199]
  ds_read_b128 v[216:219], v70 offset:1024
  v_cvt_pk_bf16_f32 v248, v184, v185
  v_mfma_f32_16x16x32_bf16 v[200:203], v[220:223], v[88:91], v[200:203]
  s_add_u32 m0, s81, 31744
  s_nop 0
  buffer_load_dwordx4 v55, s[12:15], s80 offen lds
  v_mfma_f32_16x16x32_bf16 v[204:207], v[220:223], v[92:95], v[204:207]
  v_cvt_pk_bf16_f32 v249, v186, v187
  s_waitcnt lgkmcnt(2)
  v_mfma_f32_16x16x32_bf16 v[196:199], v[208:211], v[96:99], v[196:199]
  ds_read_b128 v[220:223], v71 offset:1024
  v_cvt_pk_bf16_f32 v250, v188, v189
  v_mfma_f32_16x16x32_bf16 v[200:203], v[208:211], v[100:103], v[200:203]
  s_add_u32 m0, s81, 32768
  s_nop 0
  buffer_load_dwordx4 v56, s[12:15], s80 offen lds
  v_mfma_f32_16x16x32_bf16 v[204:207], v[208:211], v[104:107], v[204:207]
  v_cvt_pk_bf16_f32 v251, v190, v191
  s_waitcnt lgkmcnt(2)
  v_mfma_f32_16x16x32_bf16 v[196:199], v[212:215], v[108:111], v[196:199]
  v_accvgpr_write_b32 a4, v248
  v_mfma_f32_16x16x32_bf16 v[200:203], v[212:215], v[112:115], v[200:203]
  s_add_u32 m0, s81, 33792
  s_nop 0
  buffer_load_dwordx4 v57, s[12:15], s80 offen lds
  v_mfma_f32_16x16x32_bf16 v[204:207], v[212:215], v[116:119], v[204:207]
  v_accvgpr_write_b32 a5, v249
  s_waitcnt lgkmcnt(1)
  v_mfma_f32_16x16x32_bf16 v[196:199], v[216:219], v[120:123], v[196:199]
  v_accvgpr_write_b32 a84, v250
  v_mfma_f32_16x16x32_bf16 v[200:203], v[216:219], v[124:127], v[200:203]
  s_add_u32 m0, s81, 34816
  s_nop 0
  buffer_load_dwordx4 v58, s[12:15], s80 offen lds
  v_mfma_f32_16x16x32_bf16 v[204:207], v[216:219], v[128:131], v[204:207]
  v_accvgpr_write_b32 a85, v251
  s_waitcnt lgkmcnt(0)
  v_mfma_f32_16x16x32_bf16 v[196:199], v[220:223], v[132:135], v[196:199]
  v_cvt_pk_bf16_f32 v146, v192, v193
  v_cvt_pk_bf16_f32 v147, v194, v195
  v_mfma_f32_16x16x32_bf16 v[200:203], v[220:223], v[136:139], v[200:203]
  s_add_u32 m0, s81, 35840
  s_nop 0
  buffer_load_dwordx4 v59, s[12:15], s80 offen lds
  s_add_u32 s80, s80, 393216
  v_mfma_f32_16x16x32_bf16 v[204:207], v[220:223], v[140:143], v[204:207]
  s_add_u32 s21, s79, 0
  buffer_load_dwordx4 a[168:171], v65, s[24:27], s21 offen
  s_add_u32 s21, s79, 393216
  buffer_load_dwordx4 a[172:175], v63, s[24:27], s21 offen
  s_waitcnt vmcnt(16)
  ds_read_b128 v[208:211], v70 offset:12288
  ds_read_b128 v[212:215], v71 offset:12288
  ds_read_b128 v[216:219], v70 offset:12416
  s_waitcnt lgkmcnt(2)
  v_mfma_f32_16x16x32_bf16 v[184:187], v[208:211], v[72:75], 0
  ds_read_b128 v[220:223], v71 offset:12416
  v_mfma_f32_16x16x32_bf16 v[188:191], v[208:211], v[76:79], 0
  s_add_u32 m0, s81, 0
  s_nop 0
  buffer_load_dwordx4 v48, s[12:15], s80 offen lds
  v_mfma_f32_16x16x32_bf16 v[192:195], v[208:211], v[80:83], 0
  s_waitcnt lgkmcnt(2)
  v_mfma_f32_16x16x32_bf16 v[184:187], v[212:215], v[84:87], v[184:187]
  ds_read_b128 v[208:211], v70 offset:12544
  v_cvt_pk_bf16_f32 v248, v196, v197
  v_mfma_f32_16x16x32_bf16 v[188:191], v[212:215], v[88:91], v[188:191]
  s_add_u32 m0, s81, 1024
  s_nop 0
  buffer_load_dwordx4 v49, s[12:15], s80 offen lds
  v_mfma_f32_16x16x32_bf16 v[192:195], v[212:215], v[92:95], v[192:195]
  v_cvt_pk_bf16_f32 v249, v198, v199
  s_waitcnt lgkmcnt(2)
  v_mfma_f32_16x16x32_bf16 v[184:187], v[216:219], v[96:99], v[184:187]
  ds_read_b128 v[212:215], v71 offset:12544
  v_cvt_pk_bf16_f32 v250, v200, v201
  v_mfma_f32_16x16x32_bf16 v[188:191], v[216:219], v[100:103], v[188:191]
  s_add_u32 m0, s81, 2048
  s_nop 0
  buffer_load_dwordx4 v50, s[12:15], s80 offen lds
  v_mfma_f32_16x16x32_bf16 v[192:195], v[216:219], v[104:107], v[192:195]
  v_cvt_pk_bf16_f32 v251, v202, v203
  s_waitcnt lgkmcnt(2)
  v_mfma_f32_16x16x32_bf16 v[184:187], v[220:223], v[108:111], v[184:187]
  ds_read_b128 v[216:219], v70 offset:13056
  v_accvgpr_write_b32 a6, v248
  v_mfma_f32_16x16x32_bf16 v[188:191], v[220:223], v[112:115], v[188:191]
  s_add_u32 m0, s81, 3072
  s_nop 0
  buffer_load_dwordx4 v51, s[12:15], s80 offen lds
  v_mfma_f32_16x16x32_bf16 v[192:195], v[220:223], v[116:119], v[192:195]
  v_accvgpr_write_b32 a7, v249
  s_waitcnt lgkmcnt(2)
  v_mfma_f32_16x16x32_bf16 v[184:187], v[208:211], v[120:123], v[184:187]
  ds_read_b128 v[220:223], v71 offset:13056
  v_accvgpr_write_b32 a86, v250
  v_mfma_f32_16x16x32_bf16 v[188:191], v[208:211], v[124:127], v[188:191]
  s_add_u32 m0, s81, 4096
  s_nop 0
  buffer_load_dwordx4 v52, s[12:15], s80 offen lds
  v_mfma_f32_16x16x32_bf16 v[192:195], v[208:211], v[128:131], v[192:195]
  v_accvgpr_write_b32 a87, v251
  s_waitcnt lgkmcnt(2)
  v_mfma_f32_16x16x32_bf16 v[184:187], v[212:215], v[132:135], v[184:187]
  ds_read_b128 v[208:211], v70 offset:13184
  s_mov_b64 exec, s[68:69]
  v_cvt_pk_bf16_f32 v146, v204, v205
  v_cvt_pk_bf16_f32 v147, v206, v207
  s_mov_b64 exec, -1
  v_mfma_f32_16x16x32_bf16 v[188:191], v[212:215], v[136:139], v[188:191]
  s_add_u32 m0, s81, 5120
  s_nop 0
  buffer_load_dwordx4 v53, s[12:15], s80 offen lds
  v_mfma_f32_16x16x32_bf16 v[192:195], v[212:215], v[140:143], v[192:195]
  s_waitcnt lgkmcnt(2)
  v_mfma_f32_16x16x32_bf16 v[196:199], v[216:219], v[72:75], 0
  ds_read_b128 v[212:215], v71 offset:13184
  v_mfma_f32_16x16x32_bf16 v[200:203], v[216:219], v[76:79], 0
  s_add_u32 m0, s81, 6144
  s_nop 0
  buffer_load_dwordx4 v54, s[12:15], s80 offen lds
  v_mfma_f32_16x16x32_bf16 v[204:207], v[216:219], v[80:83], 0
  s_waitcnt lgkmcnt(2)
  v_mfma_f32_16x16x32_bf16 v[196:199], v[220:223], v[84:87], v[196:199]
  ds_read_b128 v[216:219], v70 offset:13312
  v_cvt_pk_bf16_f32 v248, v184, v185
  v_mfma_f32_16x16x32_bf16 v[200:203], v[220:223], v[88:91], v[200:203]
  s_add_u32 m0, s81, 7168
  s_nop 0
  buffer_load_dwordx4 v55, s[12:15], s80 offen lds
  v_mfma_f32_16x16x32_bf16 v[204:207], v[220:223], v[92:95], v[204:207]
  v_cvt_pk_bf16_f32 v249, v186, v187
  s_waitcnt lgkmcnt(2)
  v_mfma_f32_16x16x32_bf16 v[196:199], v[208:211], v[96:99], v[196:199]
  ds_read_b128 v[220:223], v71 offset:13312
  v_cvt_pk_bf16_f32 v250, v188, v189
  v_mfma_f32_16x16x32_bf16 v[200:203], v[208:211], v[100:103], v[200:203]
  s_add_u32 m0, s81, 8192
  s_nop 0
  buffer_load_dwordx4 v56, s[12:15], s80 offen lds
  v_mfma_f32_16x16x32_bf16 v[204:207], v[208:211], v[104:107], v[204:207]
  v_cvt_pk_bf16_f32 v251, v190, v191
  s_waitcnt lgkmcnt(2)
  v_mfma_f32_16x16x32_bf16 v[196:199], v[212:215], v[108:111], v[196:199]
  v_accvgpr_write_b32 a8, v248
  v_mfma_f32_16x16x32_bf16 v[200:203], v[212:215], v[112:115], v[200:203]
  s_add_u32 m0, s81, 9216
  s_nop 0
  buffer_load_dwordx4 v57, s[12:15], s80 offen lds
  v_mfma_f32_16x16x32_bf16 v[204:207], v[212:215], v[116:119], v[204:207]
  v_accvgpr_write_b32 a9, v249
  s_waitcnt lgkmcnt(1)
  v_mfma_f32_16x16x32_bf16 v[196:199], v[216:219], v[120:123], v[196:199]
  v_accvgpr_write_b32 a88, v250
  v_mfma_f32_16x16x32_bf16 v[200:203], v[216:219], v[124:127], v[200:203]
  s_add_u32 m0, s81, 10240
  s_nop 0
  buffer_load_dwordx4 v58, s[12:15], s80 offen lds
  v_mfma_f32_16x16x32_bf16 v[204:207], v[216:219], v[128:131], v[204:207]
  v_accvgpr_write_b32 a89, v251
  s_waitcnt lgkmcnt(0)
  v_mfma_f32_16x16x32_bf16 v[196:199], v[220:223], v[132:135], v[196:199]
  v_cvt_pk_bf16_f32 v148, v192, v193
  v_cvt_pk_bf16_f32 v149, v194, v195
  v_mfma_f32_16x16x32_bf16 v[200:203], v[220:223], v[136:139], v[200:203]
  s_add_u32 m0, s81, 11264
  s_nop 0
  buffer_load_dwordx4 v59, s[12:15], s80 offen lds
  s_add_u32 s80, s80, 393216
  v_mfma_f32_16x16x32_bf16 v[204:207], v[220:223], v[140:143], v[204:207]
  s_add_u32 s21, s79, 393216
  buffer_load_dwordx4 a[176:179], v64, s[24:27], s21 offen
  s_add_u32 s21, s79, 393216
  buffer_load_dwordx4 a[180:183], v65, s[24:27], s21 offen
  s_waitcnt vmcnt(16)
  ds_read_b128 v[208:211], v70 offset:24576
  ds_read_b128 v[212:215], v71 offset:24576
  ds_read_b128 v[216:219], v70 offset:24704
  s_waitcnt lgkmcnt(2)
  v_mfma_f32_16x16x32_bf16 v[184:187], v[208:211], v[72:75], 0
  ds_read_b128 v[220:223], v71 offset:24704
  v_mfma_f32_16x16x32_bf16 v[188:191], v[208:211], v[76:79], 0
  s_add_u32 m0, s81, 12288
  s_nop 0
  buffer_load_dwordx4 v48, s[12:15], s80 offen lds
  v_mfma_f32_16x16x32_bf16 v[192:195], v[208:211], v[80:83], 0
  s_waitcnt lgkmcnt(2)
  v_mfma_f32_16x16x32_bf16 v[184:187], v[212:215], v[84:87], v[184:187]
  ds_read_b128 v[208:211], v70 offset:24832
  v_cvt_pk_bf16_f32 v248, v196, v197
  v_mfma_f32_16x16x32_bf16 v[188:191], v[212:215], v[88:91], v[188:191]
  s_add_u32 m0, s81, 13312
  s_nop 0
  buffer_load_dwordx4 v49, s[12:15], s80 offen lds
  v_mfma_f32_16x16x32_bf16 v[192:195], v[212:215], v[92:95], v[192:195]
  v_cvt_pk_bf16_f32 v249, v198, v199
  s_waitcnt lgkmcnt(2)
  v_mfma_f32_16x16x32_bf16 v[184:187], v[216:219], v[96:99], v[184:187]
  ds_read_b128 v[212:215], v71 offset:24832
  v_cvt_pk_bf16_f32 v250, v200, v201
  v_mfma_f32_16x16x32_bf16 v[188:191], v[216:219], v[100:103], v[188:191]
  s_add_u32 m0, s81, 14336
  s_nop 0
  buffer_load_dwordx4 v50, s[12:15], s80 offen lds
  v_mfma_f32_16x16x32_bf16 v[192:195], v[216:219], v[104:107], v[192:195]
  v_cvt_pk_bf16_f32 v251, v202, v203
  s_waitcnt lgkmcnt(2)
  v_mfma_f32_16x16x32_bf16 v[184:187], v[220:223], v[108:111], v[184:187]
  ds_read_b128 v[216:219], v70 offset:25344
  v_accvgpr_write_b32 a10, v248
  v_mfma_f32_16x16x32_bf16 v[188:191], v[220:223], v[112:115], v[188:191]
  s_add_u32 m0, s81, 15360
  s_nop 0
  buffer_load_dwordx4 v51, s[12:15], s80 offen lds
  v_mfma_f32_16x16x32_bf16 v[192:195], v[220:223], v[116:119], v[192:195]
  v_accvgpr_write_b32 a11, v249
  s_waitcnt lgkmcnt(2)
  v_mfma_f32_16x16x32_bf16 v[184:187], v[208:211], v[120:123], v[184:187]
  ds_read_b128 v[220:223], v71 offset:25344
  v_accvgpr_write_b32 a90, v250
  v_mfma_f32_16x16x32_bf16 v[188:191], v[208:211], v[124:127], v[188:191]
  s_add_u32 m0, s81, 16384
  s_nop 0
  buffer_load_dwordx4 v52, s[12:15], s80 offen lds
  v_mfma_f32_16x16x32_bf16 v[192:195], v[208:211], v[128:131], v[192:195]
  v_accvgpr_write_b32 a91, v251
  s_waitcnt lgkmcnt(2)
  v_mfma_f32_16x16x32_bf16 v[184:187], v[212:215], v[132:135], v[184:187]
  ds_read_b128 v[208:211], v70 offset:25472
  s_mov_b64 exec, s[68:69]
  v_cvt_pk_bf16_f32 v148, v204, v205
  v_cvt_pk_bf16_f32 v149, v206, v207
  s_mov_b64 exec, -1
  v_mfma_f32_16x16x32_bf16 v[188:191], v[212:215], v[136:139], v[188:191]
  s_add_u32 m0, s81, 17408
  s_nop 0
  buffer_load_dwordx4 v53, s[12:15], s80 offen lds
  v_mfma_f32_16x16x32_bf16 v[192:195], v[212:215], v[140:143], v[192:195]
  s_waitcnt lgkmcnt(2)
  v_mfma_f32_16x16x32_bf16 v[196:199], v[216:219], v[72:75], 0
  ds_read_b128 v[212:215], v71 offset:25472
  v_mfma_f32_16x16x32_bf16 v[200:203], v[216:219], v[76:79], 0
  s_add_u32 m0, s81, 18432
  s_nop 0
  buffer_load_dwordx4 v54, s[12:15], s80 offen lds
  v_mfma_f32_16x16x32_bf16 v[204:207], v[216:219], v[80:83], 0
  s_waitcnt lgkmcnt(2)
  v_mfma_f32_16x16x32_bf16 v[196:199], v[220:223], v[84:87], v[196:199]
  ds_read_b128 v[216:219], v70 offset:25600
  v_cvt_pk_bf16_f32 v248, v184, v185
  v_mfma_f32_16x16x32_bf16 v[200:203], v[220:223], v[88:91], v[200:203]
  s_add_u32 m0, s81, 19456
  s_nop 0
  buffer_load_dwordx4 v55, s[12:15], s80 offen lds
  v_mfma_f32_16x16x32_bf16 v[204:207], v[220:223], v[92:95], v[204:207]
  v_cvt_pk_bf16_f32 v249, v186, v187
  s_waitcnt lgkmcnt(2)
  v_mfma_f32_16x16x32_bf16 v[196:199], v[208:211], v[96:99], v[196:199]
  ds_read_b128 v[220:223], v71 offset:25600
  v_cvt_pk_bf16_f32 v250, v188, v189
  v_mfma_f32_16x16x32_bf16 v[200:203], v[208:211], v[100:103], v[200:203]
  s_add_u32 m0, s81, 20480
  s_nop 0
  buffer_load_dwordx4 v56, s[12:15], s80 offen lds
  v_mfma_f32_16x16x32_bf16 v[204:207], v[208:211], v[104:107], v[204:207]
  v_cvt_pk_bf16_f32 v251, v190, v191
  s_waitcnt lgkmcnt(2)
  v_mfma_f32_16x16x32_bf16 v[196:199], v[212:215], v[108:111], v[196:199]
  v_accvgpr_write_b32 a12, v248
  v_mfma_f32_16x16x32_bf16 v[200:203], v[212:215], v[112:115], v[200:203]
  s_add_u32 m0, s81, 21504
  s_nop 0
  buffer_load_dwordx4 v57, s[12:15], s80 offen lds
  v_mfma_f32_16x16x32_bf16 v[204:207], v[212:215], v[116:119], v[204:207]
  v_accvgpr_write_b32 a13, v249
  s_waitcnt lgkmcnt(1)
  v_mfma_f32_16x16x32_bf16 v[196:199], v[216:219], v[120:123], v[196:199]
  v_accvgpr_write_b32 a92, v250
  v_mfma_f32_16x16x32_bf16 v[200:203], v[216:219], v[124:127], v[200:203]
  s_add_u32 m0, s81, 22528
  s_nop 0
  buffer_load_dwordx4 v58, s[12:15], s80 offen lds
  v_mfma_f32_16x16x32_bf16 v[204:207], v[216:219], v[128:131], v[204:207]
  v_accvgpr_write_b32 a93, v251
  s_waitcnt lgkmcnt(0)
  v_mfma_f32_16x16x32_bf16 v[196:199], v[220:223], v[132:135], v[196:199]
  v_cvt_pk_bf16_f32 v150, v192, v193
  v_cvt_pk_bf16_f32 v151, v194, v195
  v_mfma_f32_16x16x32_bf16 v[200:203], v[220:223], v[136:139], v[200:203]
  s_add_u32 m0, s81, 23552
  s_nop 0
  buffer_load_dwordx4 v59, s[12:15], s80 offen lds
  s_add_u32 s80, s80, 393216
  v_mfma_f32_16x16x32_bf16 v[204:207], v[220:223], v[140:143], v[204:207]
  s_add_u32 s21, s79, 786432
  buffer_load_dwordx4 a[184:187], v63, s[24:27], s21 offen
  s_add_u32 s21, s79, 786432
  buffer_load_dwordx4 a[188:191], v64, s[24:27], s21 offen
  s_waitcnt vmcnt(16)
  ds_read_b128 v[208:211], v70 offset:0
  ds_read_b128 v[212:215], v71 offset:0
  ds_read_b128 v[216:219], v70 offset:128
  s_waitcnt lgkmcnt(2)
  v_mfma_f32_16x16x32_bf16 v[184:187], v[208:211], v[72:75], 0
  ds_read_b128 v[220:223], v71 offset:128
  v_mfma_f32_16x16x32_bf16 v[188:191], v[208:211], v[76:79], 0
  s_add_u32 m0, s81, 24576
  s_nop 0
  buffer_load_dwordx4 v48, s[12:15], s80 offen lds
  v_mfma_f32_16x16x32_bf16 v[192:195], v[208:211], v[80:83], 0
  s_waitcnt lgkmcnt(2)
  v_mfma_f32_16x16x32_bf16 v[184:187], v[212:215], v[84:87], v[184:187]
  ds_read_b128 v[208:211], v70 offset:256
  v_cvt_pk_bf16_f32 v248, v196, v197
  v_mfma_f32_16x16x32_bf16 v[188:191], v[212:215], v[88:91], v[188:191]
  s_add_u32 m0, s81, 25600
  s_nop 0
  buffer_load_dwordx4 v49, s[12:15], s80 offen lds
  v_mfma_f32_16x16x32_bf16 v[192:195], v[212:215], v[92:95], v[192:195]
  v_cvt_pk_bf16_f32 v249, v198, v199
  s_waitcnt lgkmcnt(2)
  v_mfma_f32_16x16x32_bf16 v[184:187], v[216:219], v[96:99], v[184:187]
  ds_read_b128 v[212:215], v71 offset:256
  v_cvt_pk_bf16_f32 v250, v200, v201
  v_mfma_f32_16x16x32_bf16 v[188:191], v[216:219], v[100:103], v[188:191]
  s_add_u32 m0, s81, 26624
  s_nop 0
  buffer_load_dwordx4 v50, s[12:15], s80 offen lds
  v_mfma_f32_16x16x32_bf16 v[192:195], v[216:219], v[104:107], v[192:195]
  v_cvt_pk_bf16_f32 v251, v202, v203
  s_waitcnt lgkmcnt(2)
  v_mfma_f32_16x16x32_bf16 v[184:187], v[220:223], v[108:111], v[184:187]
  ds_read_b128 v[216:219], v70 offset:768
  v_accvgpr_write_b32 a14, v248
  v_mfma_f32_16x16x32_bf16 v[188:191], v[220:223], v[112:115], v[188:191]
  s_add_u32 m0, s81, 27648
  s_nop 0
  buffer_load_dwordx4 v51, s[12:15], s80 offen lds
  v_mfma_f32_16x16x32_bf16 v[192:195], v[220:223], v[116:119], v[192:195]
  v_accvgpr_write_b32 a15, v249
  s_waitcnt lgkmcnt(2)
  v_mfma_f32_16x16x32_bf16 v[184:187], v[208:211], v[120:123], v[184:187]
  ds_read_b128 v[220:223], v71 offset:768
  v_accvgpr_write_b32 a94, v250
  v_mfma_f32_16x16x32_bf16 v[188:191], v[208:211], v[124:127], v[188:191]
  s_add_u32 m0, s81, 28672
  s_nop 0
  buffer_load_dwordx4 v52, s[12:15], s80 offen lds
  v_mfma_f32_16x16x32_bf16 v[192:195], v[208:211], v[128:131], v[192:195]
  v_accvgpr_write_b32 a95, v251
  s_waitcnt lgkmcnt(2)
  v_mfma_f32_16x16x32_bf16 v[184:187], v[212:215], v[132:135], v[184:187]
  ds_read_b128 v[208:211], v70 offset:896
  s_mov_b64 exec, s[68:69]
  v_cvt_pk_bf16_f32 v150, v204, v205
  v_cvt_pk_bf16_f32 v151, v206, v207
  s_mov_b64 exec, -1
  v_mfma_f32_16x16x32_bf16 v[188:191], v[212:215], v[136:139], v[188:191]
  s_add_u32 m0, s81, 29696
  s_nop 0
  buffer_load_dwordx4 v53, s[12:15], s80 offen lds
  v_mfma_f32_16x16x32_bf16 v[192:195], v[212:215], v[140:143], v[192:195]
  s_waitcnt lgkmcnt(2)
  v_mfma_f32_16x16x32_bf16 v[196:199], v[216:219], v[72:75], 0
  ds_read_b128 v[212:215], v71 offset:896
  v_mfma_f32_16x16x32_bf16 v[200:203], v[216:219], v[76:79], 0
  s_add_u32 m0, s81, 30720
  s_nop 0
  buffer_load_dwordx4 v54, s[12:15], s80 offen lds
  v_mfma_f32_16x16x32_bf16 v[204:207], v[216:219], v[80:83], 0
  s_waitcnt lgkmcnt(2)
  v_mfma_f32_16x16x32_bf16 v[196:199], v[220:223], v[84:87], v[196:199]
  ds_read_b128 v[216:219], v70 offset:1024
  v_cvt_pk_bf16_f32 v248, v184, v185
  v_mfma_f32_16x16x32_bf16 v[200:203], v[220:223], v[88:91], v[200:203]
  s_add_u32 m0, s81, 31744
  s_nop 0
  buffer_load_dwordx4 v55, s[12:15], s80 offen lds
  v_mfma_f32_16x16x32_bf16 v[204:207], v[220:223], v[92:95], v[204:207]
  v_cvt_pk_bf16_f32 v249, v186, v187
  s_waitcnt lgkmcnt(2)
  v_mfma_f32_16x16x32_bf16 v[196:199], v[208:211], v[96:99], v[196:199]
  ds_read_b128 v[220:223], v71 offset:1024
  v_cvt_pk_bf16_f32 v250, v188, v189
  v_mfma_f32_16x16x32_bf16 v[200:203], v[208:211], v[100:103], v[200:203]
  s_add_u32 m0, s81, 32768
  s_nop 0
  buffer_load_dwordx4 v56, s[12:15], s80 offen lds
  v_mfma_f32_16x16x32_bf16 v[204:207], v[208:211], v[104:107], v[204:207]
  v_cvt_pk_bf16_f32 v251, v190, v191
  s_waitcnt lgkmcnt(2)
  v_mfma_f32_16x16x32_bf16 v[196:199], v[212:215], v[108:111], v[196:199]
  v_accvgpr_write_b32 a16, v248
  v_mfma_f32_16x16x32_bf16 v[200:203], v[212:215], v[112:115], v[200:203]
  s_add_u32 m0, s81, 33792
  s_nop 0
  buffer_load_dwordx4 v57, s[12:15], s80 offen lds
  v_mfma_f32_16x16x32_bf16 v[204:207], v[212:215], v[116:119], v[204:207]
  v_accvgpr_write_b32 a17, v249
  s_waitcnt lgkmcnt(1)
  v_mfma_f32_16x16x32_bf16 v[196:199], v[216:219], v[120:123], v[196:199]
  v_accvgpr_write_b32 a96, v250
  v_mfma_f32_16x16x32_bf16 v[200:203], v[216:219], v[124:127], v[200:203]
  s_add_u32 m0, s81, 34816
  s_nop 0
  buffer_load_dwordx4 v58, s[12:15], s80 offen lds
  v_mfma_f32_16x16x32_bf16 v[204:207], v[216:219], v[128:131], v[204:207]
  v_accvgpr_write_b32 a97, v251
  s_waitcnt lgkmcnt(0)
  v_mfma_f32_16x16x32_bf16 v[196:199], v[220:223], v[132:135], v[196:199]
  v_cvt_pk_bf16_f32 v152, v192, v193
  v_cvt_pk_bf16_f32 v153, v194, v195
  v_mfma_f32_16x16x32_bf16 v[200:203], v[220:223], v[136:139], v[200:203]
  s_add_u32 m0, s81, 35840
  s_nop 0
  buffer_load_dwordx4 v59, s[12:15], s80 offen lds
  s_add_u32 s80, s80, 393216
  v_mfma_f32_16x16x32_bf16 v[204:207], v[220:223], v[140:143], v[204:207]
  s_add_u32 s21, s79, 786432
  buffer_load_dwordx4 a[192:195], v65, s[24:27], s21 offen
  s_add_u32 s21, s79, 1179648
  buffer_load_dwordx4 a[196:199], v63, s[24:27], s21 offen
  s_waitcnt vmcnt(16)
  ds_read_b128 v[208:211], v70 offset:12288
  ds_read_b128 v[212:215], v71 offset:12288
  ds_read_b128 v[216:219], v70 offset:12416
  s_waitcnt lgkmcnt(2)
  v_mfma_f32_16x16x32_bf16 v[184:187], v[208:211], v[72:75], 0
  ds_read_b128 v[220:223], v71 offset:12416
  v_mfma_f32_16x16x32_bf16 v[188:191], v[208:211], v[76:79], 0
  s_add_u32 m0, s81, 0
  s_nop 0
  buffer_load_dwordx4 v48, s[12:15], s80 offen lds
  v_mfma_f32_16x16x32_bf16 v[192:195], v[208:211], v[80:83], 0
  s_waitcnt lgkmcnt(2)
  v_mfma_f32_16x16x32_bf16 v[184:187], v[212:215], v[84:87], v[184:187]
  ds_read_b128 v[208:211], v70 offset:12544
  v_cvt_pk_bf16_f32 v248, v196, v197
  v_mfma_f32_16x16x32_bf16 v[188:191], v[212:215], v[88:91], v[188:191]
  s_add_u32 m0, s81, 1024
  s_nop 0
  buffer_load_dwordx4 v49, s[12:15], s80 offen lds
  v_mfma_f32_16x16x32_bf16 v[192:195], v[212:215], v[92:95], v[192:195]
  v_cvt_pk_bf16_f32 v249, v198, v199
  s_waitcnt lgkmcnt(2)
  v_mfma_f32_16x16x32_bf16 v[184:187], v[216:219], v[96:99], v[184:187]
  ds_read_b128 v[212:215], v71 offset:12544
  v_cvt_pk_bf16_f32 v250, v200, v201
  v_mfma_f32_16x16x32_bf16 v[188:191], v[216:219], v[100:103], v[188:191]
  s_add_u32 m0, s81, 2048
  s_nop 0
  buffer_load_dwordx4 v50, s[12:15], s80 offen lds
  v_mfma_f32_16x16x32_bf16 v[192:195], v[216:219], v[104:107], v[192:195]
  v_cvt_pk_bf16_f32 v251, v202, v203
  s_waitcnt lgkmcnt(2)
  v_mfma_f32_16x16x32_bf16 v[184:187], v[220:223], v[108:111], v[184:187]
  ds_read_b128 v[216:219], v70 offset:13056
  v_accvgpr_write_b32 a18, v248
  v_mfma_f32_16x16x32_bf16 v[188:191], v[220:223], v[112:115], v[188:191]
  s_add_u32 m0, s81, 3072
  s_nop 0
  buffer_load_dwordx4 v51, s[12:15], s80 offen lds
  v_mfma_f32_16x16x32_bf16 v[192:195], v[220:223], v[116:119], v[192:195]
  v_accvgpr_write_b32 a19, v249
  s_waitcnt lgkmcnt(2)
  v_mfma_f32_16x16x32_bf16 v[184:187], v[208:211], v[120:123], v[184:187]
  ds_read_b128 v[220:223], v71 offset:13056
  v_accvgpr_write_b32 a98, v250
  v_mfma_f32_16x16x32_bf16 v[188:191], v[208:211], v[124:127], v[188:191]
  s_add_u32 m0, s81, 4096
  s_nop 0
  buffer_load_dwordx4 v52, s[12:15], s80 offen lds
  v_mfma_f32_16x16x32_bf16 v[192:195], v[208:211], v[128:131], v[192:195]
  v_accvgpr_write_b32 a99, v251
  s_waitcnt lgkmcnt(2)
  v_mfma_f32_16x16x32_bf16 v[184:187], v[212:215], v[132:135], v[184:187]
  ds_read_b128 v[208:211], v70 offset:13184
  s_mov_b64 exec, s[68:69]
  v_cvt_pk_bf16_f32 v152, v204, v205
  v_cvt_pk_bf16_f32 v153, v206, v207
  s_mov_b64 exec, -1
  v_mfma_f32_16x16x32_bf16 v[188:191], v[212:215], v[136:139], v[188:191]
  s_add_u32 m0, s81, 5120
  s_nop 0
  buffer_load_dwordx4 v53, s[12:15], s80 offen lds
  v_mfma_f32_16x16x32_bf16 v[192:195], v[212:215], v[140:143], v[192:195]
  s_waitcnt lgkmcnt(2)
  v_mfma_f32_16x16x32_bf16 v[196:199], v[216:219], v[72:75], 0
  ds_read_b128 v[212:215], v71 offset:13184
  v_mfma_f32_16x16x32_bf16 v[200:203], v[216:219], v[76:79], 0
  s_add_u32 m0, s81, 6144
  s_nop 0
  buffer_load_dwordx4 v54, s[12:15], s80 offen lds
  v_mfma_f32_16x16x32_bf16 v[204:207], v[216:219], v[80:83], 0
  s_waitcnt lgkmcnt(2)
  v_mfma_f32_16x16x32_bf16 v[196:199], v[220:223], v[84:87], v[196:199]
  ds_read_b128 v[216:219], v70 offset:13312
  v_cvt_pk_bf16_f32 v248, v184, v185
  v_mfma_f32_16x16x32_bf16 v[200:203], v[220:223], v[88:91], v[200:203]
  s_add_u32 m0, s81, 7168
  s_nop 0
  buffer_load_dwordx4 v55, s[12:15], s80 offen lds
  v_mfma_f32_16x16x32_bf16 v[204:207], v[220:223], v[92:95], v[204:207]
  v_cvt_pk_bf16_f32 v249, v186, v187
  s_waitcnt lgkmcnt(2)
  v_mfma_f32_16x16x32_bf16 v[196:199], v[208:211], v[96:99], v[196:199]
  ds_read_b128 v[220:223], v71 offset:13312
  v_cvt_pk_bf16_f32 v250, v188, v189
  v_mfma_f32_16x16x32_bf16 v[200:203], v[208:211], v[100:103], v[200:203]
  s_add_u32 m0, s81, 8192
  s_nop 0
  buffer_load_dwordx4 v56, s[12:15], s80 offen lds
  v_mfma_f32_16x16x32_bf16 v[204:207], v[208:211], v[104:107], v[204:207]
  v_cvt_pk_bf16_f32 v251, v190, v191
  s_waitcnt lgkmcnt(2)
  v_mfma_f32_16x16x32_bf16 v[196:199], v[212:215], v[108:111], v[196:199]
  v_accvgpr_write_b32 a20, v248
  v_mfma_f32_16x16x32_bf16 v[200:203], v[212:215], v[112:115], v[200:203]
  s_add_u32 m0, s81, 9216
  s_nop 0
  buffer_load_dwordx4 v57, s[12:15], s80 offen lds
  v_mfma_f32_16x16x32_bf16 v[204:207], v[212:215], v[116:119], v[204:207]
  v_accvgpr_write_b32 a21, v249
  s_waitcnt lgkmcnt(1)
  v_mfma_f32_16x16x32_bf16 v[196:199], v[216:219], v[120:123], v[196:199]
  v_accvgpr_write_b32 a100, v250
  v_mfma_f32_16x16x32_bf16 v[200:203], v[216:219], v[124:127], v[200:203]
  s_add_u32 m0, s81, 10240
  s_nop 0
  buffer_load_dwordx4 v58, s[12:15], s80 offen lds
  v_mfma_f32_16x16x32_bf16 v[204:207], v[216:219], v[128:131], v[204:207]
  v_accvgpr_write_b32 a101, v251
  s_waitcnt lgkmcnt(0)
  v_mfma_f32_16x16x32_bf16 v[196:199], v[220:223], v[132:135], v[196:199]
  v_cvt_pk_bf16_f32 v154, v192, v193
  v_cvt_pk_bf16_f32 v155, v194, v195
  v_mfma_f32_16x16x32_bf16 v[200:203], v[220:223], v[136:139], v[200:203]
  s_add_u32 m0, s81, 11264
  s_nop 0
  buffer_load_dwordx4 v59, s[12:15], s80 offen lds
  s_add_u32 s80, s80, 393216
  v_mfma_f32_16x16x32_bf16 v[204:207], v[220:223], v[140:143], v[204:207]
  s_add_u32 s21, s79, 1179648
  buffer_load_dwordx4 a[200:203], v64, s[24:27], s21 offen
  s_add_u32 s21, s79, 1179648
  buffer_load_dwordx4 a[204:207], v65, s[24:27], s21 offen
  s_waitcnt vmcnt(16)
  ds_read_b128 v[208:211], v70 offset:24576
  ds_read_b128 v[212:215], v71 offset:24576
  ds_read_b128 v[216:219], v70 offset:24704
  s_waitcnt lgkmcnt(2)
  v_mfma_f32_16x16x32_bf16 v[184:187], v[208:211], v[72:75], 0
  ds_read_b128 v[220:223], v71 offset:24704
  v_mfma_f32_16x16x32_bf16 v[188:191], v[208:211], v[76:79], 0
  s_add_u32 m0, s81, 12288
  s_nop 0
  buffer_load_dwordx4 v48, s[12:15], s80 offen lds
  v_mfma_f32_16x16x32_bf16 v[192:195], v[208:211], v[80:83], 0
  s_waitcnt lgkmcnt(2)
  v_mfma_f32_16x16x32_bf16 v[184:187], v[212:215], v[84:87], v[184:187]
  ds_read_b128 v[208:211], v70 offset:24832
  v_cvt_pk_bf16_f32 v248, v196, v197
  v_mfma_f32_16x16x32_bf16 v[188:191], v[212:215], v[88:91], v[188:191]
  s_add_u32 m0, s81, 13312
  s_nop 0
  buffer_load_dwordx4 v49, s[12:15], s80 offen lds
  v_mfma_f32_16x16x32_bf16 v[192:195], v[212:215], v[92:95], v[192:195]
  v_cvt_pk_bf16_f32 v249, v198, v199
  s_waitcnt lgkmcnt(2)
  v_mfma_f32_16x16x32_bf16 v[184:187], v[216:219], v[96:99], v[184:187]
  ds_read_b128 v[212:215], v71 offset:24832
  v_cvt_pk_bf16_f32 v250, v200, v201
  v_mfma_f32_16x16x32_bf16 v[188:191], v[216:219], v[100:103], v[188:191]
  s_add_u32 m0, s81, 14336
  s_nop 0
  buffer_load_dwordx4 v50, s[12:15], s80 offen lds
  v_mfma_f32_16x16x32_bf16 v[192:195], v[216:219], v[104:107], v[192:195]
  v_cvt_pk_bf16_f32 v251, v202, v203
  s_waitcnt lgkmcnt(2)
  v_mfma_f32_16x16x32_bf16 v[184:187], v[220:223], v[108:111], v[184:187]
  ds_read_b128 v[216:219], v70 offset:25344
  v_accvgpr_write_b32 a22, v248
  v_mfma_f32_16x16x32_bf16 v[188:191], v[220:223], v[112:115], v[188:191]
  s_add_u32 m0, s81, 15360
  s_nop 0
  buffer_load_dwordx4 v51, s[12:15], s80 offen lds
  v_mfma_f32_16x16x32_bf16 v[192:195], v[220:223], v[116:119], v[192:195]
  v_accvgpr_write_b32 a23, v249
  s_waitcnt lgkmcnt(2)
  v_mfma_f32_16x16x32_bf16 v[184:187], v[208:211], v[120:123], v[184:187]
  ds_read_b128 v[220:223], v71 offset:25344
  v_accvgpr_write_b32 a102, v250
  v_mfma_f32_16x16x32_bf16 v[188:191], v[208:211], v[124:127], v[188:191]
  s_add_u32 m0, s81, 16384
  s_nop 0
  buffer_load_dwordx4 v52, s[12:15], s80 offen lds
  v_mfma_f32_16x16x32_bf16 v[192:195], v[208:211], v[128:131], v[192:195]
  v_accvgpr_write_b32 a103, v251
  s_waitcnt lgkmcnt(2)
  v_mfma_f32_16x16x32_bf16 v[184:187], v[212:215], v[132:135], v[184:187]
  ds_read_b128 v[208:211], v70 offset:25472
  s_mov_b64 exec, s[68:69]
  v_cvt_pk_bf16_f32 v154, v204, v205
  v_cvt_pk_bf16_f32 v155, v206, v207
  s_mov_b64 exec, -1
  v_mfma_f32_16x16x32_bf16 v[188:191], v[212:215], v[136:139], v[188:191]
  s_add_u32 m0, s81, 17408
  s_nop 0
  buffer_load_dwordx4 v53, s[12:15], s80 offen lds
  v_mfma_f32_16x16x32_bf16 v[192:195], v[212:215], v[140:143], v[192:195]
  s_waitcnt lgkmcnt(2)
  v_mfma_f32_16x16x32_bf16 v[196:199], v[216:219], v[72:75], 0
  ds_read_b128 v[212:215], v71 offset:25472
  v_mfma_f32_16x16x32_bf16 v[200:203], v[216:219], v[76:79], 0
  s_add_u32 m0, s81, 18432
  s_nop 0
  buffer_load_dwordx4 v54, s[12:15], s80 offen lds
  v_mfma_f32_16x16x32_bf16 v[204:207], v[216:219], v[80:83], 0
  s_waitcnt lgkmcnt(2)
  v_mfma_f32_16x16x32_bf16 v[196:199], v[220:223], v[84:87], v[196:199]
  ds_read_b128 v[216:219], v70 offset:25600
  v_cvt_pk_bf16_f32 v248, v184, v185
  v_mfma_f32_16x16x32_bf16 v[200:203], v[220:223], v[88:91], v[200:203]
  s_add_u32 m0, s81, 19456
  s_nop 0
  buffer_load_dwordx4 v55, s[12:15], s80 offen lds
  v_mfma_f32_16x16x32_bf16 v[204:207], v[220:223], v[92:95], v[204:207]
  v_cvt_pk_bf16_f32 v249, v186, v187
  s_waitcnt lgkmcnt(2)
  v_mfma_f32_16x16x32_bf16 v[196:199], v[208:211], v[96:99], v[196:199]
  ds_read_b128 v[220:223], v71 offset:25600
  v_cvt_pk_bf16_f32 v250, v188, v189
  v_mfma_f32_16x16x32_bf16 v[200:203], v[208:211], v[100:103], v[200:203]
  s_add_u32 m0, s81, 20480
  s_nop 0
  buffer_load_dwordx4 v56, s[12:15], s80 offen lds
  v_mfma_f32_16x16x32_bf16 v[204:207], v[208:211], v[104:107], v[204:207]
  v_cvt_pk_bf16_f32 v251, v190, v191
  s_waitcnt lgkmcnt(2)
  v_mfma_f32_16x16x32_bf16 v[196:199], v[212:215], v[108:111], v[196:199]
  v_accvgpr_write_b32 a24, v248
  v_mfma_f32_16x16x32_bf16 v[200:203], v[212:215], v[112:115], v[200:203]
  s_add_u32 m0, s81, 21504
  s_nop 0
  buffer_load_dwordx4 v57, s[12:15], s80 offen lds
  v_mfma_f32_16x16x32_bf16 v[204:207], v[212:215], v[116:119], v[204:207]
  v_accvgpr_write_b32 a25, v249
  s_waitcnt lgkmcnt(1)
  v_mfma_f32_16x16x32_bf16 v[196:199], v[216:219], v[120:123], v[196:199]
  v_accvgpr_write_b32 a104, v250
  v_mfma_f32_16x16x32_bf16 v[200:203], v[216:219], v[124:127], v[200:203]
  s_add_u32 m0, s81, 22528
  s_nop 0
  buffer_load_dwordx4 v58, s[12:15], s80 offen lds
  v_mfma_f32_16x16x32_bf16 v[204:207], v[216:219], v[128:131], v[204:207]
  v_accvgpr_write_b32 a105, v251
  s_waitcnt lgkmcnt(0)
  v_mfma_f32_16x16x32_bf16 v[196:199], v[220:223], v[132:135], v[196:199]
  v_cvt_pk_bf16_f32 v156, v192, v193
  v_cvt_pk_bf16_f32 v157, v194, v195
  v_mfma_f32_16x16x32_bf16 v[200:203], v[220:223], v[136:139], v[200:203]
  s_add_u32 m0, s81, 23552
  s_nop 0
  buffer_load_dwordx4 v59, s[12:15], s80 offen lds
  s_add_u32 s80, s80, 393216
  v_mfma_f32_16x16x32_bf16 v[204:207], v[220:223], v[140:143], v[204:207]
  s_add_u32 s21, s79, 1572864
  buffer_load_dwordx4 a[208:211], v63, s[24:27], s21 offen
  s_add_u32 s21, s79, 1572864
  buffer_load_dwordx4 a[212:215], v64, s[24:27], s21 offen
  s_waitcnt vmcnt(16)
  ds_read_b128 v[208:211], v70 offset:0
  ds_read_b128 v[212:215], v71 offset:0
  ds_read_b128 v[216:219], v70 offset:128
  s_waitcnt lgkmcnt(2)
  v_mfma_f32_16x16x32_bf16 v[184:187], v[208:211], v[72:75], 0
  ds_read_b128 v[220:223], v71 offset:128
  v_mfma_f32_16x16x32_bf16 v[188:191], v[208:211], v[76:79], 0
  s_add_u32 m0, s81, 24576
  s_nop 0
  buffer_load_dwordx4 v48, s[12:15], s80 offen lds
  v_mfma_f32_16x16x32_bf16 v[192:195], v[208:211], v[80:83], 0
  s_waitcnt lgkmcnt(2)
  v_mfma_f32_16x16x32_bf16 v[184:187], v[212:215], v[84:87], v[184:187]
  ds_read_b128 v[208:211], v70 offset:256
  v_cvt_pk_bf16_f32 v248, v196, v197
  v_mfma_f32_16x16x32_bf16 v[188:191], v[212:215], v[88:91], v[188:191]
  s_add_u32 m0, s81, 25600
  s_nop 0
  buffer_load_dwordx4 v49, s[12:15], s80 offen lds
  v_mfma_f32_16x16x32_bf16 v[192:195], v[212:215], v[92:95], v[192:195]
  v_cvt_pk_bf16_f32 v249, v198, v199
  s_waitcnt lgkmcnt(2)
  v_mfma_f32_16x16x32_bf16 v[184:187], v[216:219], v[96:99], v[184:187]
  ds_read_b128 v[212:215], v71 offset:256
  v_cvt_pk_bf16_f32 v250, v200, v201
  v_mfma_f32_16x16x32_bf16 v[188:191], v[216:219], v[100:103], v[188:191]
  s_add_u32 m0, s81, 26624
  s_nop 0
  buffer_load_dwordx4 v50, s[12:15], s80 offen lds
  v_mfma_f32_16x16x32_bf16 v[192:195], v[216:219], v[104:107], v[192:195]
  v_cvt_pk_bf16_f32 v251, v202, v203
  s_waitcnt lgkmcnt(2)
  v_mfma_f32_16x16x32_bf16 v[184:187], v[220:223], v[108:111], v[184:187]
  ds_read_b128 v[216:219], v70 offset:768
  v_accvgpr_write_b32 a26, v248
  v_mfma_f32_16x16x32_bf16 v[188:191], v[220:223], v[112:115], v[188:191]
  s_add_u32 m0, s81, 27648
  s_nop 0
  buffer_load_dwordx4 v51, s[12:15], s80 offen lds
  v_mfma_f32_16x16x32_bf16 v[192:195], v[220:223], v[116:119], v[192:195]
  v_accvgpr_write_b32 a27, v249
  s_waitcnt lgkmcnt(2)
  v_mfma_f32_16x16x32_bf16 v[184:187], v[208:211], v[120:123], v[184:187]
  ds_read_b128 v[220:223], v71 offset:768
  v_accvgpr_write_b32 a106, v250
  v_mfma_f32_16x16x32_bf16 v[188:191], v[208:211], v[124:127], v[188:191]
  s_add_u32 m0, s81, 28672
  s_nop 0
  buffer_load_dwordx4 v52, s[12:15], s80 offen lds
  v_mfma_f32_16x16x32_bf16 v[192:195], v[208:211], v[128:131], v[192:195]
  v_accvgpr_write_b32 a107, v251
  s_waitcnt lgkmcnt(2)
  v_mfma_f32_16x16x32_bf16 v[184:187], v[212:215], v[132:135], v[184:187]
  ds_read_b128 v[208:211], v70 offset:896
  s_mov_b64 exec, s[68:69]
  v_cvt_pk_bf16_f32 v156, v204, v205
  v_cvt_pk_bf16_f32 v157, v206, v207
  s_mov_b64 exec, -1
  v_mfma_f32_16x16x32_bf16 v[188:191], v[212:215], v[136:139], v[188:191]
  s_add_u32 m0, s81, 29696
  s_nop 0
  buffer_load_dwordx4 v53, s[12:15], s80 offen lds
  v_mfma_f32_16x16x32_bf16 v[192:195], v[212:215], v[140:143], v[192:195]
  s_waitcnt lgkmcnt(2)
  v_mfma_f32_16x16x32_bf16 v[196:199], v[216:219], v[72:75], 0
  ds_read_b128 v[212:215], v71 offset:896
  v_mfma_f32_16x16x32_bf16 v[200:203], v[216:219], v[76:79], 0
  s_add_u32 m0, s81, 30720
  s_nop 0
  buffer_load_dwordx4 v54, s[12:15], s80 offen lds
  v_mfma_f32_16x16x32_bf16 v[204:207], v[216:219], v[80:83], 0
  s_waitcnt lgkmcnt(2)
  v_mfma_f32_16x16x32_bf16 v[196:199], v[220:223], v[84:87], v[196:199]
  ds_read_b128 v[216:219], v70 offset:1024
  v_cvt_pk_bf16_f32 v248, v184, v185
  v_mfma_f32_16x16x32_bf16 v[200:203], v[220:223], v[88:91], v[200:203]
  s_add_u32 m0, s81, 31744
  s_nop 0
  buffer_load_dwordx4 v55, s[12:15], s80 offen lds
  v_mfma_f32_16x16x32_bf16 v[204:207], v[220:223], v[92:95], v[204:207]
  v_cvt_pk_bf16_f32 v249, v186, v187
  s_waitcnt lgkmcnt(2)
  v_mfma_f32_16x16x32_bf16 v[196:199], v[208:211], v[96:99], v[196:199]
  ds_read_b128 v[220:223], v71 offset:1024
  v_cvt_pk_bf16_f32 v250, v188, v189
  v_mfma_f32_16x16x32_bf16 v[200:203], v[208:211], v[100:103], v[200:203]
  s_add_u32 m0, s81, 32768
  s_nop 0
  buffer_load_dwordx4 v56, s[12:15], s80 offen lds
  v_mfma_f32_16x16x32_bf16 v[204:207], v[208:211], v[104:107], v[204:207]
  v_cvt_pk_bf16_f32 v251, v190, v191
  s_waitcnt lgkmcnt(2)
  v_mfma_f32_16x16x32_bf16 v[196:199], v[212:215], v[108:111], v[196:199]
  v_accvgpr_write_b32 a28, v248
  v_mfma_f32_16x16x32_bf16 v[200:203], v[212:215], v[112:115], v[200:203]
  s_add_u32 m0, s81, 33792
  s_nop 0
  buffer_load_dwordx4 v57, s[12:15], s80 offen lds
  v_mfma_f32_16x16x32_bf16 v[204:207], v[212:215], v[116:119], v[204:207]
  v_accvgpr_write_b32 a29, v249
  s_waitcnt lgkmcnt(1)
  v_mfma_f32_16x16x32_bf16 v[196:199], v[216:219], v[120:123], v[196:199]
  v_accvgpr_write_b32 a108, v250
  v_mfma_f32_16x16x32_bf16 v[200:203], v[216:219], v[124:127], v[200:203]
  s_add_u32 m0, s81, 34816
  s_nop 0
  buffer_load_dwordx4 v58, s[12:15], s80 offen lds
  v_mfma_f32_16x16x32_bf16 v[204:207], v[216:219], v[128:131], v[204:207]
  v_accvgpr_write_b32 a109, v251
  s_waitcnt lgkmcnt(0)
  v_mfma_f32_16x16x32_bf16 v[196:199], v[220:223], v[132:135], v[196:199]
  v_cvt_pk_bf16_f32 v158, v192, v193
  v_cvt_pk_bf16_f32 v159, v194, v195
  v_mfma_f32_16x16x32_bf16 v[200:203], v[220:223], v[136:139], v[200:203]
  s_add_u32 m0, s81, 35840
  s_nop 0
  buffer_load_dwordx4 v59, s[12:15], s80 offen lds
  s_add_u32 s80, s80, 393216
  v_mfma_f32_16x16x32_bf16 v[204:207], v[220:223], v[140:143], v[204:207]
  s_add_u32 s21, s79, 1572864
  buffer_load_dwordx4 a[216:219], v65, s[24:27], s21 offen
  s_add_u32 s21, s79, 0
  buffer_load_dwordx4 a[220:223], v63, s[28:31], s21 offen
  s_waitcnt vmcnt(16)
  ds_read_b128 v[208:211], v70 offset:12288
  ds_read_b128 v[212:215], v71 offset:12288
  ds_read_b128 v[216:219], v70 offset:12416
  s_waitcnt lgkmcnt(2)
  v_mfma_f32_16x16x32_bf16 v[184:187], v[208:211], v[72:75], 0
  ds_read_b128 v[220:223], v71 offset:12416
  v_mfma_f32_16x16x32_bf16 v[188:191], v[208:211], v[76:79], 0
  s_add_u32 m0, s81, 0
  s_nop 0
  buffer_load_dwordx4 v48, s[12:15], s80 offen lds
  v_mfma_f32_16x16x32_bf16 v[192:195], v[208:211], v[80:83], 0
  s_waitcnt lgkmcnt(2)
  v_mfma_f32_16x16x32_bf16 v[184:187], v[212:215], v[84:87], v[184:187]
  ds_read_b128 v[208:211], v70 offset:12544
  v_cvt_pk_bf16_f32 v248, v196, v197
  v_mfma_f32_16x16x32_bf16 v[188:191], v[212:215], v[88:91], v[188:191]
  s_add_u32 m0, s81, 1024
  s_nop 0
  buffer_load_dwordx4 v49, s[12:15], s80 offen lds
  v_mfma_f32_16x16x32_bf16 v[192:195], v[212:215], v[92:95], v[192:195]
  v_cvt_pk_bf16_f32 v249, v198, v199
  s_waitcnt lgkmcnt(2)
  v_mfma_f32_16x16x32_bf16 v[184:187], v[216:219], v[96:99], v[184:187]
  ds_read_b128 v[212:215], v71 offset:12544
  v_cvt_pk_bf16_f32 v250, v200, v201
  v_mfma_f32_16x16x32_bf16 v[188:191], v[216:219], v[100:103], v[188:191]
  s_add_u32 m0, s81, 2048
  s_nop 0
  buffer_load_dwordx4 v50, s[12:15], s80 offen lds
  v_mfma_f32_16x16x32_bf16 v[192:195], v[216:219], v[104:107], v[192:195]
  v_cvt_pk_bf16_f32 v251, v202, v203
  s_waitcnt lgkmcnt(2)
  v_mfma_f32_16x16x32_bf16 v[184:187], v[220:223], v[108:111], v[184:187]
  ds_read_b128 v[216:219], v70 offset:13056
  v_accvgpr_write_b32 a30, v248
  v_mfma_f32_16x16x32_bf16 v[188:191], v[220:223], v[112:115], v[188:191]
  s_add_u32 m0, s81, 3072
  s_nop 0
  buffer_load_dwordx4 v51, s[12:15], s80 offen lds
  v_mfma_f32_16x16x32_bf16 v[192:195], v[220:223], v[116:119], v[192:195]
  v_accvgpr_write_b32 a31, v249
  s_waitcnt lgkmcnt(2)
  v_mfma_f32_16x16x32_bf16 v[184:187], v[208:211], v[120:123], v[184:187]
  ds_read_b128 v[220:223], v71 offset:13056
  v_accvgpr_write_b32 a110, v250
  v_mfma_f32_16x16x32_bf16 v[188:191], v[208:211], v[124:127], v[188:191]
  s_add_u32 m0, s81, 4096
  s_nop 0
  buffer_load_dwordx4 v52, s[12:15], s80 offen lds
  v_mfma_f32_16x16x32_bf16 v[192:195], v[208:211], v[128:131], v[192:195]
  v_accvgpr_write_b32 a111, v251
  s_waitcnt lgkmcnt(2)
  v_mfma_f32_16x16x32_bf16 v[184:187], v[212:215], v[132:135], v[184:187]
  ds_read_b128 v[208:211], v70 offset:13184
  s_mov_b64 exec, s[68:69]
  v_cvt_pk_bf16_f32 v158, v204, v205
  v_cvt_pk_bf16_f32 v159, v206, v207
  s_mov_b64 exec, -1
  v_mfma_f32_16x16x32_bf16 v[188:191], v[212:215], v[136:139], v[188:191]
  s_add_u32 m0, s81, 5120
  s_nop 0
  buffer_load_dwordx4 v53, s[12:15], s80 offen lds
  v_mfma_f32_16x16x32_bf16 v[192:195], v[212:215], v[140:143], v[192:195]
  s_waitcnt lgkmcnt(2)
  v_mfma_f32_16x16x32_bf16 v[196:199], v[216:219], v[72:75], 0
  ds_read_b128 v[212:215], v71 offset:13184
  v_mfma_f32_16x16x32_bf16 v[200:203], v[216:219], v[76:79], 0
  s_add_u32 m0, s81, 6144
  s_nop 0
  buffer_load_dwordx4 v54, s[12:15], s80 offen lds
  v_mfma_f32_16x16x32_bf16 v[204:207], v[216:219], v[80:83], 0
  s_waitcnt lgkmcnt(2)
  v_mfma_f32_16x16x32_bf16 v[196:199], v[220:223], v[84:87], v[196:199]
  ds_read_b128 v[216:219], v70 offset:13312
  v_cvt_pk_bf16_f32 v248, v184, v185
  v_mfma_f32_16x16x32_bf16 v[200:203], v[220:223], v[88:91], v[200:203]
  s_add_u32 m0, s81, 7168
  s_nop 0
  buffer_load_dwordx4 v55, s[12:15], s80 offen lds
  v_mfma_f32_16x16x32_bf16 v[204:207], v[220:223], v[92:95], v[204:207]
  v_cvt_pk_bf16_f32 v249, v186, v187
  s_waitcnt lgkmcnt(2)
  v_mfma_f32_16x16x32_bf16 v[196:199], v[208:211], v[96:99], v[196:199]
  ds_read_b128 v[220:223], v71 offset:13312
  v_cvt_pk_bf16_f32 v250, v188, v189
  v_mfma_f32_16x16x32_bf16 v[200:203], v[208:211], v[100:103], v[200:203]
  s_add_u32 m0, s81, 8192
  s_nop 0
  buffer_load_dwordx4 v56, s[12:15], s80 offen lds
  v_mfma_f32_16x16x32_bf16 v[204:207], v[208:211], v[104:107], v[204:207]
  v_cvt_pk_bf16_f32 v251, v190, v191
  s_waitcnt lgkmcnt(2)
  v_mfma_f32_16x16x32_bf16 v[196:199], v[212:215], v[108:111], v[196:199]
  v_accvgpr_write_b32 a32, v248
  v_mfma_f32_16x16x32_bf16 v[200:203], v[212:215], v[112:115], v[200:203]
  s_add_u32 m0, s81, 9216
  s_nop 0
  buffer_load_dwordx4 v57, s[12:15], s80 offen lds
  v_mfma_f32_16x16x32_bf16 v[204:207], v[212:215], v[116:119], v[204:207]
  v_accvgpr_write_b32 a33, v249
  s_waitcnt lgkmcnt(1)
  v_mfma_f32_16x16x32_bf16 v[196:199], v[216:219], v[120:123], v[196:199]
  v_accvgpr_write_b32 a112, v250
  v_mfma_f32_16x16x32_bf16 v[200:203], v[216:219], v[124:127], v[200:203]
  s_add_u32 m0, s81, 10240
  s_nop 0
  buffer_load_dwordx4 v58, s[12:15], s80 offen lds
  v_mfma_f32_16x16x32_bf16 v[204:207], v[216:219], v[128:131], v[204:207]
  v_accvgpr_write_b32 a113, v251
  s_waitcnt lgkmcnt(0)
  v_mfma_f32_16x16x32_bf16 v[196:199], v[220:223], v[132:135], v[196:199]
  v_cvt_pk_bf16_f32 v160, v192, v193
  v_cvt_pk_bf16_f32 v161, v194, v195
  v_mfma_f32_16x16x32_bf16 v[200:203], v[220:223], v[136:139], v[200:203]
  s_add_u32 m0, s81, 11264
  s_nop 0
  buffer_load_dwordx4 v59, s[12:15], s80 offen lds
  s_add_u32 s80, s80, 393216
  v_mfma_f32_16x16x32_bf16 v[204:207], v[220:223], v[140:143], v[204:207]
  s_add_u32 s21, s79, 0
  buffer_load_dwordx4 a[224:227], v64, s[28:31], s21 offen
  s_add_u32 s21, s79, 0
  buffer_load_dwordx4 a[228:231], v65, s[28:31], s21 offen
  s_waitcnt vmcnt(16)
  ds_read_b128 v[208:211], v70 offset:24576
  ds_read_b128 v[212:215], v71 offset:24576
  ds_read_b128 v[216:219], v70 offset:24704
  s_waitcnt lgkmcnt(2)
  v_mfma_f32_16x16x32_bf16 v[184:187], v[208:211], v[72:75], 0
  ds_read_b128 v[220:223], v71 offset:24704
  v_mfma_f32_16x16x32_bf16 v[188:191], v[208:211], v[76:79], 0
  s_add_u32 m0, s81, 12288
  s_nop 0
  buffer_load_dwordx4 v48, s[12:15], s80 offen lds
  v_mfma_f32_16x16x32_bf16 v[192:195], v[208:211], v[80:83], 0
  s_waitcnt lgkmcnt(2)
  v_mfma_f32_16x16x32_bf16 v[184:187], v[212:215], v[84:87], v[184:187]
  ds_read_b128 v[208:211], v70 offset:24832
  v_cvt_pk_bf16_f32 v248, v196, v197
  v_mfma_f32_16x16x32_bf16 v[188:191], v[212:215], v[88:91], v[188:191]
  s_add_u32 m0, s81, 13312
  s_nop 0
  buffer_load_dwordx4 v49, s[12:15], s80 offen lds
  v_mfma_f32_16x16x32_bf16 v[192:195], v[212:215], v[92:95], v[192:195]
  v_cvt_pk_bf16_f32 v249, v198, v199
  s_waitcnt lgkmcnt(2)
  v_mfma_f32_16x16x32_bf16 v[184:187], v[216:219], v[96:99], v[184:187]
  ds_read_b128 v[212:215], v71 offset:24832
  v_cvt_pk_bf16_f32 v250, v200, v201
  v_mfma_f32_16x16x32_bf16 v[188:191], v[216:219], v[100:103], v[188:191]
  s_add_u32 m0, s81, 14336
  s_nop 0
  buffer_load_dwordx4 v50, s[12:15], s80 offen lds
  v_mfma_f32_16x16x32_bf16 v[192:195], v[216:219], v[104:107], v[192:195]
  v_cvt_pk_bf16_f32 v251, v202, v203
  s_waitcnt lgkmcnt(2)
  v_mfma_f32_16x16x32_bf16 v[184:187], v[220:223], v[108:111], v[184:187]
  ds_read_b128 v[216:219], v70 offset:25344
  v_accvgpr_write_b32 a34, v248
  v_mfma_f32_16x16x32_bf16 v[188:191], v[220:223], v[112:115], v[188:191]
  s_add_u32 m0, s81, 15360
  s_nop 0
  buffer_load_dwordx4 v51, s[12:15], s80 offen lds
  v_mfma_f32_16x16x32_bf16 v[192:195], v[220:223], v[116:119], v[192:195]
  v_accvgpr_write_b32 a35, v249
  s_waitcnt lgkmcnt(2)
  v_mfma_f32_16x16x32_bf16 v[184:187], v[208:211], v[120:123], v[184:187]
  ds_read_b128 v[220:223], v71 offset:25344
  v_accvgpr_write_b32 a114, v250
  v_mfma_f32_16x16x32_bf16 v[188:191], v[208:211], v[124:127], v[188:191]
  s_add_u32 m0, s81, 16384
  s_nop 0
  buffer_load_dwordx4 v52, s[12:15], s80 offen lds
  v_mfma_f32_16x16x32_bf16 v[192:195], v[208:211], v[128:131], v[192:195]
  v_accvgpr_write_b32 a115, v251
  s_waitcnt lgkmcnt(2)
  v_mfma_f32_16x16x32_bf16 v[184:187], v[212:215], v[132:135], v[184:187]
  ds_read_b128 v[208:211], v70 offset:25472
  s_mov_b64 exec, s[68:69]
  v_cvt_pk_bf16_f32 v160, v204, v205
  v_cvt_pk_bf16_f32 v161, v206, v207
  s_mov_b64 exec, -1
  v_mfma_f32_16x16x32_bf16 v[188:191], v[212:215], v[136:139], v[188:191]
  s_add_u32 m0, s81, 17408
  s_nop 0
  buffer_load_dwordx4 v53, s[12:15], s80 offen lds
  v_mfma_f32_16x16x32_bf16 v[192:195], v[212:215], v[140:143], v[192:195]
  s_waitcnt lgkmcnt(2)
  v_mfma_f32_16x16x32_bf16 v[196:199], v[216:219], v[72:75], 0
  ds_read_b128 v[212:215], v71 offset:25472
  v_mfma_f32_16x16x32_bf16 v[200:203], v[216:219], v[76:79], 0
  s_add_u32 m0, s81, 18432
  s_nop 0
  buffer_load_dwordx4 v54, s[12:15], s80 offen lds
  v_mfma_f32_16x16x32_bf16 v[204:207], v[216:219], v[80:83], 0
  s_waitcnt lgkmcnt(2)
  v_mfma_f32_16x16x32_bf16 v[196:199], v[220:223], v[84:87], v[196:199]
  ds_read_b128 v[216:219], v70 offset:25600
  v_cvt_pk_bf16_f32 v248, v184, v185
  v_mfma_f32_16x16x32_bf16 v[200:203], v[220:223], v[88:91], v[200:203]
  s_add_u32 m0, s81, 19456
  s_nop 0
  buffer_load_dwordx4 v55, s[12:15], s80 offen lds
  v_mfma_f32_16x16x32_bf16 v[204:207], v[220:223], v[92:95], v[204:207]
  v_cvt_pk_bf16_f32 v249, v186, v187
  s_waitcnt lgkmcnt(2)
  v_mfma_f32_16x16x32_bf16 v[196:199], v[208:211], v[96:99], v[196:199]
  ds_read_b128 v[220:223], v71 offset:25600
  v_cvt_pk_bf16_f32 v250, v188, v189
  v_mfma_f32_16x16x32_bf16 v[200:203], v[208:211], v[100:103], v[200:203]
  s_add_u32 m0, s81, 20480
  s_nop 0
  buffer_load_dwordx4 v56, s[12:15], s80 offen lds
  v_mfma_f32_16x16x32_bf16 v[204:207], v[208:211], v[104:107], v[204:207]
  v_cvt_pk_bf16_f32 v251, v190, v191
  s_waitcnt lgkmcnt(2)
  v_mfma_f32_16x16x32_bf16 v[196:199], v[212:215], v[108:111], v[196:199]
  v_accvgpr_write_b32 a36, v248
  v_mfma_f32_16x16x32_bf16 v[200:203], v[212:215], v[112:115], v[200:203]
  s_add_u32 m0, s81, 21504
  s_nop 0
  buffer_load_dwordx4 v57, s[12:15], s80 offen lds
  v_mfma_f32_16x16x32_bf16 v[204:207], v[212:215], v[116:119], v[204:207]
  v_accvgpr_write_b32 a37, v249
  s_waitcnt lgkmcnt(1)
  v_mfma_f32_16x16x32_bf16 v[196:199], v[216:219], v[120:123], v[196:199]
  v_accvgpr_write_b32 a116, v250
  v_mfma_f32_16x16x32_bf16 v[200:203], v[216:219], v[124:127], v[200:203]
  s_add_u32 m0, s81, 22528
  s_nop 0
  buffer_load_dwordx4 v58, s[12:15], s80 offen lds
  v_mfma_f32_16x16x32_bf16 v[204:207], v[216:219], v[128:131], v[204:207]
  v_accvgpr_write_b32 a117, v251
  s_waitcnt lgkmcnt(0)
  v_mfma_f32_16x16x32_bf16 v[196:199], v[220:223], v[132:135], v[196:199]
  v_cvt_pk_bf16_f32 v162, v192, v193
  v_cvt_pk_bf16_f32 v163, v194, v195
  v_mfma_f32_16x16x32_bf16 v[200:203], v[220:223], v[136:139], v[200:203]
  s_add_u32 m0, s81, 23552
  s_nop 0
  buffer_load_dwordx4 v59, s[12:15], s80 offen lds
  s_add_u32 s80, s80, 393216
  v_mfma_f32_16x16x32_bf16 v[204:207], v[220:223], v[140:143], v[204:207]
  s_add_u32 s21, s79, 393216
  buffer_load_dwordx4 a[232:235], v63, s[28:31], s21 offen
  s_add_u32 s21, s79, 393216
  buffer_load_dwordx4 a[236:239], v64, s[28:31], s21 offen
  s_waitcnt vmcnt(16)
  ds_read_b128 v[208:211], v70 offset:0
  ds_read_b128 v[212:215], v71 offset:0
  ds_read_b128 v[216:219], v70 offset:128
  s_waitcnt lgkmcnt(2)
  v_mfma_f32_16x16x32_bf16 v[184:187], v[208:211], v[72:75], 0
  ds_read_b128 v[220:223], v71 offset:128
  v_mfma_f32_16x16x32_bf16 v[188:191], v[208:211], v[76:79], 0
  s_add_u32 m0, s81, 24576
  s_nop 0
  buffer_load_dwordx4 v48, s[12:15], s80 offen lds
  v_mfma_f32_16x16x32_bf16 v[192:195], v[208:211], v[80:83], 0
  s_waitcnt lgkmcnt(2)
  v_mfma_f32_16x16x32_bf16 v[184:187], v[212:215], v[84:87], v[184:187]
  ds_read_b128 v[208:211], v70 offset:256
  v_cvt_pk_bf16_f32 v248, v196, v197
  v_mfma_f32_16x16x32_bf16 v[188:191], v[212:215], v[88:91], v[188:191]
  s_add_u32 m0, s81, 25600
  s_nop 0
  buffer_load_dwordx4 v49, s[12:15], s80 offen lds
  v_mfma_f32_16x16x32_bf16 v[192:195], v[212:215], v[92:95], v[192:195]
  v_cvt_pk_bf16_f32 v249, v198, v199
  s_waitcnt lgkmcnt(2)
  v_mfma_f32_16x16x32_bf16 v[184:187], v[216:219], v[96:99], v[184:187]
  ds_read_b128 v[212:215], v71 offset:256
  v_cvt_pk_bf16_f32 v250, v200, v201
  v_mfma_f32_16x16x32_bf16 v[188:191], v[216:219], v[100:103], v[188:191]
  s_add_u32 m0, s81, 26624
  s_nop 0
  buffer_load_dwordx4 v50, s[12:15], s80 offen lds
  v_mfma_f32_16x16x32_bf16 v[192:195], v[216:219], v[104:107], v[192:195]
  v_cvt_pk_bf16_f32 v251, v202, v203
  s_waitcnt lgkmcnt(2)
  v_mfma_f32_16x16x32_bf16 v[184:187], v[220:223], v[108:111], v[184:187]
  ds_read_b128 v[216:219], v70 offset:768
  v_accvgpr_write_b32 a38, v248
  v_mfma_f32_16x16x32_bf16 v[188:191], v[220:223], v[112:115], v[188:191]
  s_add_u32 m0, s81, 27648
  s_nop 0
  buffer_load_dwordx4 v51, s[12:15], s80 offen lds
  v_mfma_f32_16x16x32_bf16 v[192:195], v[220:223], v[116:119], v[192:195]
  v_accvgpr_write_b32 a39, v249
  s_waitcnt lgkmcnt(2)
  v_mfma_f32_16x16x32_bf16 v[184:187], v[208:211], v[120:123], v[184:187]
  ds_read_b128 v[220:223], v71 offset:768
  v_accvgpr_write_b32 a118, v250
  v_mfma_f32_16x16x32_bf16 v[188:191], v[208:211], v[124:127], v[188:191]
  s_add_u32 m0, s81, 28672
  s_nop 0
  buffer_load_dwordx4 v52, s[12:15], s80 offen lds
  v_mfma_f32_16x16x32_bf16 v[192:195], v[208:211], v[128:131], v[192:195]
  v_accvgpr_write_b32 a119, v251
  s_waitcnt lgkmcnt(2)
  v_mfma_f32_16x16x32_bf16 v[184:187], v[212:215], v[132:135], v[184:187]
  ds_read_b128 v[208:211], v70 offset:896
  s_mov_b64 exec, s[68:69]
  v_cvt_pk_bf16_f32 v162, v204, v205
  v_cvt_pk_bf16_f32 v163, v206, v207
  s_mov_b64 exec, -1
  v_mfma_f32_16x16x32_bf16 v[188:191], v[212:215], v[136:139], v[188:191]
  s_add_u32 m0, s81, 29696
  s_nop 0
  buffer_load_dwordx4 v53, s[12:15], s80 offen lds
  v_mfma_f32_16x16x32_bf16 v[192:195], v[212:215], v[140:143], v[192:195]
  s_waitcnt lgkmcnt(2)
  v_mfma_f32_16x16x32_bf16 v[196:199], v[216:219], v[72:75], 0
  ds_read_b128 v[212:215], v71 offset:896
  v_mfma_f32_16x16x32_bf16 v[200:203], v[216:219], v[76:79], 0
  s_add_u32 m0, s81, 30720
  s_nop 0
  buffer_load_dwordx4 v54, s[12:15], s80 offen lds
  v_mfma_f32_16x16x32_bf16 v[204:207], v[216:219], v[80:83], 0
  s_waitcnt lgkmcnt(2)
  v_mfma_f32_16x16x32_bf16 v[196:199], v[220:223], v[84:87], v[196:199]
  ds_read_b128 v[216:219], v70 offset:1024
  v_cvt_pk_bf16_f32 v248, v184, v185
  v_mfma_f32_16x16x32_bf16 v[200:203], v[220:223], v[88:91], v[200:203]
  s_add_u32 m0, s81, 31744
  s_nop 0
  buffer_load_dwordx4 v55, s[12:15], s80 offen lds
  v_mfma_f32_16x16x32_bf16 v[204:207], v[220:223], v[92:95], v[204:207]
  v_cvt_pk_bf16_f32 v249, v186, v187
  s_waitcnt lgkmcnt(2)
  v_mfma_f32_16x16x32_bf16 v[196:199], v[208:211], v[96:99], v[196:199]
  ds_read_b128 v[220:223], v71 offset:1024
  v_cvt_pk_bf16_f32 v250, v188, v189
  v_mfma_f32_16x16x32_bf16 v[200:203], v[208:211], v[100:103], v[200:203]
  s_add_u32 m0, s81, 32768
  s_nop 0
  buffer_load_dwordx4 v56, s[12:15], s80 offen lds
  v_mfma_f32_16x16x32_bf16 v[204:207], v[208:211], v[104:107], v[204:207]
  v_cvt_pk_bf16_f32 v251, v190, v191
  s_waitcnt lgkmcnt(2)
  v_mfma_f32_16x16x32_bf16 v[196:199], v[212:215], v[108:111], v[196:199]
  v_accvgpr_write_b32 a40, v248
  v_mfma_f32_16x16x32_bf16 v[200:203], v[212:215], v[112:115], v[200:203]
  s_add_u32 m0, s81, 33792
  s_nop 0
  buffer_load_dwordx4 v57, s[12:15], s80 offen lds
  v_mfma_f32_16x16x32_bf16 v[204:207], v[212:215], v[116:119], v[204:207]
  v_accvgpr_write_b32 a41, v249
  s_waitcnt lgkmcnt(1)
  v_mfma_f32_16x16x32_bf16 v[196:199], v[216:219], v[120:123], v[196:199]
  v_accvgpr_write_b32 a120, v250
  v_mfma_f32_16x16x32_bf16 v[200:203], v[216:219], v[124:127], v[200:203]
  s_add_u32 m0, s81, 34816
  s_nop 0
  buffer_load_dwordx4 v58, s[12:15], s80 offen lds
  v_mfma_f32_16x16x32_bf16 v[204:207], v[216:219], v[128:131], v[204:207]
  v_accvgpr_write_b32 a121, v251
  s_waitcnt lgkmcnt(0)
  v_mfma_f32_16x16x32_bf16 v[196:199], v[220:223], v[132:135], v[196:199]
  v_cvt_pk_bf16_f32 v164, v192, v193
  v_cvt_pk_bf16_f32 v165, v194, v195
  v_mfma_f32_16x16x32_bf16 v[200:203], v[220:223], v[136:139], v[200:203]
  s_add_u32 m0, s81, 35840
  s_nop 0
  buffer_load_dwordx4 v59, s[12:15], s80 offen lds
  s_add_u32 s80, s80, 393216
  v_mfma_f32_16x16x32_bf16 v[204:207], v[220:223], v[140:143], v[204:207]
  s_add_u32 s21, s79, 393216
  buffer_load_dwordx4 a[240:243], v65, s[28:31], s21 offen
  s_add_u32 s21, s79, 786432
  buffer_load_dwordx4 a[244:247], v63, s[28:31], s21 offen
  s_waitcnt vmcnt(16)
  ds_read_b128 v[208:211], v70 offset:12288
  ds_read_b128 v[212:215], v71 offset:12288
  ds_read_b128 v[216:219], v70 offset:12416
  s_waitcnt lgkmcnt(2)
  v_mfma_f32_16x16x32_bf16 v[184:187], v[208:211], v[72:75], 0
  ds_read_b128 v[220:223], v71 offset:12416
  v_mfma_f32_16x16x32_bf16 v[188:191], v[208:211], v[76:79], 0
  s_add_u32 m0, s81, 0
  s_nop 0
  buffer_load_dwordx4 v48, s[12:15], s80 offen lds
  v_mfma_f32_16x16x32_bf16 v[192:195], v[208:211], v[80:83], 0
  s_waitcnt lgkmcnt(2)
  v_mfma_f32_16x16x32_bf16 v[184:187], v[212:215], v[84:87], v[184:187]
  ds_read_b128 v[208:211], v70 offset:12544
  v_cvt_pk_bf16_f32 v248, v196, v197
  v_mfma_f32_16x16x32_bf16 v[188:191], v[212:215], v[88:91], v[188:191]
  s_add_u32 m0, s81, 1024
  s_nop 0
  buffer_load_dwordx4 v49, s[12:15], s80 offen lds
  v_mfma_f32_16x16x32_bf16 v[192:195], v[212:215], v[92:95], v[192:195]
  v_cvt_pk_bf16_f32 v249, v198, v199
  s_waitcnt lgkmcnt(2)
  v_mfma_f32_16x16x32_bf16 v[184:187], v[216:219], v[96:99], v[184:187]
  ds_read_b128 v[212:215], v71 offset:12544
  v_cvt_pk_bf16_f32 v250, v200, v201
  v_mfma_f32_16x16x32_bf16 v[188:191], v[216:219], v[100:103], v[188:191]
  s_add_u32 m0, s81, 2048
  s_nop 0
  buffer_load_dwordx4 v50, s[12:15], s80 offen lds
  v_mfma_f32_16x16x32_bf16 v[192:195], v[216:219], v[104:107], v[192:195]
  v_cvt_pk_bf16_f32 v251, v202, v203
  s_waitcnt lgkmcnt(2)
  v_mfma_f32_16x16x32_bf16 v[184:187], v[220:223], v[108:111], v[184:187]
  ds_read_b128 v[216:219], v70 offset:13056
  v_accvgpr_write_b32 a42, v248
  v_mfma_f32_16x16x32_bf16 v[188:191], v[220:223], v[112:115], v[188:191]
  s_add_u32 m0, s81, 3072
  s_nop 0
  buffer_load_dwordx4 v51, s[12:15], s80 offen lds
  v_mfma_f32_16x16x32_bf16 v[192:195], v[220:223], v[116:119], v[192:195]
  v_accvgpr_write_b32 a43, v249
  s_waitcnt lgkmcnt(2)
  v_mfma_f32_16x16x32_bf16 v[184:187], v[208:211], v[120:123], v[184:187]
  ds_read_b128 v[220:223], v71 offset:13056
  v_accvgpr_write_b32 a122, v250
  v_mfma_f32_16x16x32_bf16 v[188:191], v[208:211], v[124:127], v[188:191]
  s_add_u32 m0, s81, 4096
  s_nop 0
  buffer_load_dwordx4 v52, s[12:15], s80 offen lds
  v_mfma_f32_16x16x32_bf16 v[192:195], v[208:211], v[128:131], v[192:195]
  v_accvgpr_write_b32 a123, v251
  s_waitcnt lgkmcnt(2)
  v_mfma_f32_16x16x32_bf16 v[184:187], v[212:215], v[132:135], v[184:187]
  ds_read_b128 v[208:211], v70 offset:13184
  s_mov_b64 exec, s[68:69]
  v_cvt_pk_bf16_f32 v164, v204, v205
  v_cvt_pk_bf16_f32 v165, v206, v207
  s_mov_b64 exec, -1
  v_mfma_f32_16x16x32_bf16 v[188:191], v[212:215], v[136:139], v[188:191]
  s_add_u32 m0, s81, 5120
  s_nop 0
  buffer_load_dwordx4 v53, s[12:15], s80 offen lds
  v_mfma_f32_16x16x32_bf16 v[192:195], v[212:215], v[140:143], v[192:195]
  s_waitcnt lgkmcnt(2)
  v_mfma_f32_16x16x32_bf16 v[196:199], v[216:219], v[72:75], 0
  ds_read_b128 v[212:215], v71 offset:13184
  v_mfma_f32_16x16x32_bf16 v[200:203], v[216:219], v[76:79], 0
  s_add_u32 m0, s81, 6144
  s_nop 0
  buffer_load_dwordx4 v54, s[12:15], s80 offen lds
  v_mfma_f32_16x16x32_bf16 v[204:207], v[216:219], v[80:83], 0
  s_waitcnt lgkmcnt(2)
  v_mfma_f32_16x16x32_bf16 v[196:199], v[220:223], v[84:87], v[196:199]
  ds_read_b128 v[216:219], v70 offset:13312
  v_cvt_pk_bf16_f32 v248, v184, v185
  v_mfma_f32_16x16x32_bf16 v[200:203], v[220:223], v[88:91], v[200:203]
  s_add_u32 m0, s81, 7168
  s_nop 0
  buffer_load_dwordx4 v55, s[12:15], s80 offen lds
  v_mfma_f32_16x16x32_bf16 v[204:207], v[220:223], v[92:95], v[204:207]
  v_cvt_pk_bf16_f32 v249, v186, v187
  s_waitcnt lgkmcnt(2)
  v_mfma_f32_16x16x32_bf16 v[196:199], v[208:211], v[96:99], v[196:199]
  ds_read_b128 v[220:223], v71 offset:13312
  v_cvt_pk_bf16_f32 v250, v188, v189
  v_mfma_f32_16x16x32_bf16 v[200:203], v[208:211], v[100:103], v[200:203]
  s_add_u32 m0, s81, 8192
  s_nop 0
  buffer_load_dwordx4 v56, s[12:15], s80 offen lds
  v_mfma_f32_16x16x32_bf16 v[204:207], v[208:211], v[104:107], v[204:207]
  v_cvt_pk_bf16_f32 v251, v190, v191
  s_waitcnt lgkmcnt(2)
  v_mfma_f32_16x16x32_bf16 v[196:199], v[212:215], v[108:111], v[196:199]
  v_accvgpr_write_b32 a44, v248
  v_mfma_f32_16x16x32_bf16 v[200:203], v[212:215], v[112:115], v[200:203]
  s_add_u32 m0, s81, 9216
  s_nop 0
  buffer_load_dwordx4 v57, s[12:15], s80 offen lds
  v_mfma_f32_16x16x32_bf16 v[204:207], v[212:215], v[116:119], v[204:207]
  v_accvgpr_write_b32 a45, v249
  s_waitcnt lgkmcnt(1)
  v_mfma_f32_16x16x32_bf16 v[196:199], v[216:219], v[120:123], v[196:199]
  v_accvgpr_write_b32 a124, v250
  v_mfma_f32_16x16x32_bf16 v[200:203], v[216:219], v[124:127], v[200:203]
  s_add_u32 m0, s81, 10240
  s_nop 0
  buffer_load_dwordx4 v58, s[12:15], s80 offen lds
  v_mfma_f32_16x16x32_bf16 v[204:207], v[216:219], v[128:131], v[204:207]
  v_accvgpr_write_b32 a125, v251
  s_waitcnt lgkmcnt(0)
  v_mfma_f32_16x16x32_bf16 v[196:199], v[220:223], v[132:135], v[196:199]
  v_cvt_pk_bf16_f32 v166, v192, v193
  v_cvt_pk_bf16_f32 v167, v194, v195
  v_mfma_f32_16x16x32_bf16 v[200:203], v[220:223], v[136:139], v[200:203]
  s_add_u32 m0, s81, 11264
  s_nop 0
  buffer_load_dwordx4 v59, s[12:15], s80 offen lds
  s_add_u32 s80, s80, 393216
  v_mfma_f32_16x16x32_bf16 v[204:207], v[220:223], v[140:143], v[204:207]
  s_add_u32 s21, s79, 786432
  buffer_load_dwordx4 a[248:251], v64, s[28:31], s21 offen
  s_add_u32 s21, s79, 786432
  buffer_load_dwordx4 a[252:255], v65, s[28:31], s21 offen
  s_waitcnt vmcnt(16)
  ds_read_b128 v[208:211], v70 offset:24576
  ds_read_b128 v[212:215], v71 offset:24576
  ds_read_b128 v[216:219], v70 offset:24704
  s_waitcnt lgkmcnt(2)
  v_mfma_f32_16x16x32_bf16 v[184:187], v[208:211], v[72:75], 0
  ds_read_b128 v[220:223], v71 offset:24704
  v_mfma_f32_16x16x32_bf16 v[188:191], v[208:211], v[76:79], 0
  s_add_u32 m0, s81, 12288
  s_nop 0
  buffer_load_dwordx4 v48, s[12:15], s80 offen lds
  v_mfma_f32_16x16x32_bf16 v[192:195], v[208:211], v[80:83], 0
  s_waitcnt lgkmcnt(2)
  v_mfma_f32_16x16x32_bf16 v[184:187], v[212:215], v[84:87], v[184:187]
  ds_read_b128 v[208:211], v70 offset:24832
  v_cvt_pk_bf16_f32 v248, v196, v197
  v_mfma_f32_16x16x32_bf16 v[188:191], v[212:215], v[88:91], v[188:191]
  s_add_u32 m0, s81, 13312
  s_nop 0
  buffer_load_dwordx4 v49, s[12:15], s80 offen lds
  v_mfma_f32_16x16x32_bf16 v[192:195], v[212:215], v[92:95], v[192:195]
  v_cvt_pk_bf16_f32 v249, v198, v199
  s_waitcnt lgkmcnt(2)
  v_mfma_f32_16x16x32_bf16 v[184:187], v[216:219], v[96:99], v[184:187]
  ds_read_b128 v[212:215], v71 offset:24832
  v_cvt_pk_bf16_f32 v250, v200, v201
  v_mfma_f32_16x16x32_bf16 v[188:191], v[216:219], v[100:103], v[188:191]
  s_add_u32 m0, s81, 14336
  s_nop 0
  buffer_load_dwordx4 v50, s[12:15], s80 offen lds
  v_mfma_f32_16x16x32_bf16 v[192:195], v[216:219], v[104:107], v[192:195]
  v_cvt_pk_bf16_f32 v251, v202, v203
  s_waitcnt lgkmcnt(2)
  v_mfma_f32_16x16x32_bf16 v[184:187], v[220:223], v[108:111], v[184:187]
  ds_read_b128 v[216:219], v70 offset:25344
  v_accvgpr_write_b32 a46, v248
  v_mfma_f32_16x16x32_bf16 v[188:191], v[220:223], v[112:115], v[188:191]
  s_add_u32 m0, s81, 15360
  s_nop 0
  buffer_load_dwordx4 v51, s[12:15], s80 offen lds
  v_mfma_f32_16x16x32_bf16 v[192:195], v[220:223], v[116:119], v[192:195]
  v_accvgpr_write_b32 a47, v249
  s_waitcnt lgkmcnt(2)
  v_mfma_f32_16x16x32_bf16 v[184:187], v[208:211], v[120:123], v[184:187]
  ds_read_b128 v[220:223], v71 offset:25344
  v_accvgpr_write_b32 a126, v250
  v_mfma_f32_16x16x32_bf16 v[188:191], v[208:211], v[124:127], v[188:191]
  s_add_u32 m0, s81, 16384
  s_nop 0
  buffer_load_dwordx4 v52, s[12:15], s80 offen lds
  v_mfma_f32_16x16x32_bf16 v[192:195], v[208:211], v[128:131], v[192:195]
  v_accvgpr_write_b32 a127, v251
  s_waitcnt lgkmcnt(2)
  v_mfma_f32_16x16x32_bf16 v[184:187], v[212:215], v[132:135], v[184:187]
  ds_read_b128 v[208:211], v70 offset:25472
  s_mov_b64 exec, s[68:69]
  v_cvt_pk_bf16_f32 v166, v204, v205
  v_cvt_pk_bf16_f32 v167, v206, v207
  s_mov_b64 exec, -1
  v_mfma_f32_16x16x32_bf16 v[188:191], v[212:215], v[136:139], v[188:191]
  s_add_u32 m0, s81, 17408
  s_nop 0
  buffer_load_dwordx4 v53, s[12:15], s80 offen lds
  v_mfma_f32_16x16x32_bf16 v[192:195], v[212:215], v[140:143], v[192:195]
  s_waitcnt lgkmcnt(2)
  v_mfma_f32_16x16x32_bf16 v[196:199], v[216:219], v[72:75], 0
  ds_read_b128 v[212:215], v71 offset:25472
  v_mfma_f32_16x16x32_bf16 v[200:203], v[216:219], v[76:79], 0
  s_add_u32 m0, s81, 18432
  s_nop 0
  buffer_load_dwordx4 v54, s[12:15], s80 offen lds
  v_mfma_f32_16x16x32_bf16 v[204:207], v[216:219], v[80:83], 0
  s_waitcnt lgkmcnt(2)
  v_mfma_f32_16x16x32_bf16 v[196:199], v[220:223], v[84:87], v[196:199]
  ds_read_b128 v[216:219], v70 offset:25600
  v_cvt_pk_bf16_f32 v248, v184, v185
  v_mfma_f32_16x16x32_bf16 v[200:203], v[220:223], v[88:91], v[200:203]
  s_add_u32 m0, s81, 19456
  s_nop 0
  buffer_load_dwordx4 v55, s[12:15], s80 offen lds
  v_mfma_f32_16x16x32_bf16 v[204:207], v[220:223], v[92:95], v[204:207]
  v_cvt_pk_bf16_f32 v249, v186, v187
  s_waitcnt lgkmcnt(2)
  v_mfma_f32_16x16x32_bf16 v[196:199], v[208:211], v[96:99], v[196:199]
  ds_read_b128 v[220:223], v71 offset:25600
  v_cvt_pk_bf16_f32 v250, v188, v189
  v_mfma_f32_16x16x32_bf16 v[200:203], v[208:211], v[100:103], v[200:203]
  s_add_u32 m0, s81, 20480
  s_nop 0
  buffer_load_dwordx4 v56, s[12:15], s80 offen lds
  v_mfma_f32_16x16x32_bf16 v[204:207], v[208:211], v[104:107], v[204:207]
  v_cvt_pk_bf16_f32 v251, v190, v191
  s_waitcnt lgkmcnt(2)
  v_mfma_f32_16x16x32_bf16 v[196:199], v[212:215], v[108:111], v[196:199]
  v_accvgpr_write_b32 a48, v248
  v_mfma_f32_16x16x32_bf16 v[200:203], v[212:215], v[112:115], v[200:203]
  s_add_u32 m0, s81, 21504
  s_nop 0
  buffer_load_dwordx4 v57, s[12:15], s80 offen lds
  v_mfma_f32_16x16x32_bf16 v[204:207], v[212:215], v[116:119], v[204:207]
  v_accvgpr_write_b32 a49, v249
  s_waitcnt lgkmcnt(1)
  v_mfma_f32_16x16x32_bf16 v[196:199], v[216:219], v[120:123], v[196:199]
  v_accvgpr_write_b32 a128, v250
  v_mfma_f32_16x16x32_bf16 v[200:203], v[216:219], v[124:127], v[200:203]
  s_add_u32 m0, s81, 22528
  s_nop 0
  buffer_load_dwordx4 v58, s[12:15], s80 offen lds
  v_mfma_f32_16x16x32_bf16 v[204:207], v[216:219], v[128:131], v[204:207]
  v_accvgpr_write_b32 a129, v251
  s_waitcnt lgkmcnt(0)
  v_mfma_f32_16x16x32_bf16 v[196:199], v[220:223], v[132:135], v[196:199]
  v_cvt_pk_bf16_f32 v168, v192, v193
  v_cvt_pk_bf16_f32 v169, v194, v195
  v_mfma_f32_16x16x32_bf16 v[200:203], v[220:223], v[136:139], v[200:203]
  s_add_u32 m0, s81, 23552
  s_nop 0
  buffer_load_dwordx4 v59, s[12:15], s80 offen lds
  s_add_u32 s80, s80, 393216
  v_mfma_f32_16x16x32_bf16 v[204:207], v[220:223], v[140:143], v[204:207]
  s_add_u32 s21, s79, 1179648
  buffer_load_dwordx4 v[224:227], v63, s[28:31], s21 offen
  s_add_u32 s21, s79, 1179648
  buffer_load_dwordx4 v[228:231], v64, s[28:31], s21 offen
  s_waitcnt vmcnt(16)
  ds_read_b128 v[208:211], v70 offset:0
  ds_read_b128 v[212:215], v71 offset:0
  ds_read_b128 v[216:219], v70 offset:128
  s_waitcnt lgkmcnt(2)
  v_mfma_f32_16x16x32_bf16 v[184:187], v[208:211], v[72:75], 0
  ds_read_b128 v[220:223], v71 offset:128
  v_mfma_f32_16x16x32_bf16 v[188:191], v[208:211], v[76:79], 0
  s_add_u32 m0, s81, 24576
  s_nop 0
  buffer_load_dwordx4 v48, s[12:15], s80 offen lds
  v_mfma_f32_16x16x32_bf16 v[192:195], v[208:211], v[80:83], 0
  s_waitcnt lgkmcnt(2)
  v_mfma_f32_16x16x32_bf16 v[184:187], v[212:215], v[84:87], v[184:187]
  ds_read_b128 v[208:211], v70 offset:256
  v_cvt_pk_bf16_f32 v248, v196, v197
  v_mfma_f32_16x16x32_bf16 v[188:191], v[212:215], v[88:91], v[188:191]
  s_add_u32 m0, s81, 25600
  s_nop 0
  buffer_load_dwordx4 v49, s[12:15], s80 offen lds
  v_mfma_f32_16x16x32_bf16 v[192:195], v[212:215], v[92:95], v[192:195]
  v_cvt_pk_bf16_f32 v249, v198, v199
  s_waitcnt lgkmcnt(2)
  v_mfma_f32_16x16x32_bf16 v[184:187], v[216:219], v[96:99], v[184:187]
  ds_read_b128 v[212:215], v71 offset:256
  v_cvt_pk_bf16_f32 v250, v200, v201
  v_mfma_f32_16x16x32_bf16 v[188:191], v[216:219], v[100:103], v[188:191]
  s_add_u32 m0, s81, 26624
  s_nop 0
  buffer_load_dwordx4 v50, s[12:15], s80 offen lds
  v_mfma_f32_16x16x32_bf16 v[192:195], v[216:219], v[104:107], v[192:195]
  v_cvt_pk_bf16_f32 v251, v202, v203
  s_waitcnt lgkmcnt(2)
  v_mfma_f32_16x16x32_bf16 v[184:187], v[220:223], v[108:111], v[184:187]
  ds_read_b128 v[216:219], v70 offset:768
  v_accvgpr_write_b32 a50, v248
  v_mfma_f32_16x16x32_bf16 v[188:191], v[220:223], v[112:115], v[188:191]
  s_add_u32 m0, s81, 27648
  s_nop 0
  buffer_load_dwordx4 v51, s[12:15], s80 offen lds
  v_mfma_f32_16x16x32_bf16 v[192:195], v[220:223], v[116:119], v[192:195]
  v_accvgpr_write_b32 a51, v249
  s_waitcnt lgkmcnt(2)
  v_mfma_f32_16x16x32_bf16 v[184:187], v[208:211], v[120:123], v[184:187]
  ds_read_b128 v[220:223], v71 offset:768
  v_accvgpr_write_b32 a130, v250
  v_mfma_f32_16x16x32_bf16 v[188:191], v[208:211], v[124:127], v[188:191]
  s_add_u32 m0, s81, 28672
  s_nop 0
  buffer_load_dwordx4 v52, s[12:15], s80 offen lds
  v_mfma_f32_16x16x32_bf16 v[192:195], v[208:211], v[128:131], v[192:195]
  v_accvgpr_write_b32 a131, v251
  s_waitcnt lgkmcnt(2)
  v_mfma_f32_16x16x32_bf16 v[184:187], v[212:215], v[132:135], v[184:187]
  ds_read_b128 v[208:211], v70 offset:896
  s_mov_b64 exec, s[68:69]
  v_cvt_pk_bf16_f32 v168, v204, v205
  v_cvt_pk_bf16_f32 v169, v206, v207
  s_mov_b64 exec, -1
  v_mfma_f32_16x16x32_bf16 v[188:191], v[212:215], v[136:139], v[188:191]
  s_add_u32 m0, s81, 29696
  s_nop 0
  buffer_load_dwordx4 v53, s[12:15], s80 offen lds
  v_mfma_f32_16x16x32_bf16 v[192:195], v[212:215], v[140:143], v[192:195]
  s_waitcnt lgkmcnt(2)
  v_mfma_f32_16x16x32_bf16 v[196:199], v[216:219], v[72:75], 0
  ds_read_b128 v[212:215], v71 offset:896
  v_mfma_f32_16x16x32_bf16 v[200:203], v[216:219], v[76:79], 0
  s_add_u32 m0, s81, 30720
  s_nop 0
  buffer_load_dwordx4 v54, s[12:15], s80 offen lds
  v_mfma_f32_16x16x32_bf16 v[204:207], v[216:219], v[80:83], 0
  s_waitcnt lgkmcnt(2)
  v_mfma_f32_16x16x32_bf16 v[196:199], v[220:223], v[84:87], v[196:199]
  ds_read_b128 v[216:219], v70 offset:1024
  v_cvt_pk_bf16_f32 v248, v184, v185
  v_mfma_f32_16x16x32_bf16 v[200:203], v[220:223], v[88:91], v[200:203]
  s_add_u32 m0, s81, 31744
  s_nop 0
  buffer_load_dwordx4 v55, s[12:15], s80 offen lds
  v_mfma_f32_16x16x32_bf16 v[204:207], v[220:223], v[92:95], v[204:207]
  v_cvt_pk_bf16_f32 v249, v186, v187
  s_waitcnt lgkmcnt(2)
  v_mfma_f32_16x16x32_bf16 v[196:199], v[208:211], v[96:99], v[196:199]
  ds_read_b128 v[220:223], v71 offset:1024
  v_cvt_pk_bf16_f32 v250, v188, v189
  v_mfma_f32_16x16x32_bf16 v[200:203], v[208:211], v[100:103], v[200:203]
  s_add_u32 m0, s81, 32768
  s_nop 0
  buffer_load_dwordx4 v56, s[12:15], s80 offen lds
  v_mfma_f32_16x16x32_bf16 v[204:207], v[208:211], v[104:107], v[204:207]
  v_cvt_pk_bf16_f32 v251, v190, v191
  s_waitcnt lgkmcnt(2)
  v_mfma_f32_16x16x32_bf16 v[196:199], v[212:215], v[108:111], v[196:199]
  v_accvgpr_write_b32 a52, v248
  v_mfma_f32_16x16x32_bf16 v[200:203], v[212:215], v[112:115], v[200:203]
  s_add_u32 m0, s81, 33792
  s_nop 0
  buffer_load_dwordx4 v57, s[12:15], s80 offen lds
  v_mfma_f32_16x16x32_bf16 v[204:207], v[212:215], v[116:119], v[204:207]
  v_accvgpr_write_b32 a53, v249
  s_waitcnt lgkmcnt(1)
  v_mfma_f32_16x16x32_bf16 v[196:199], v[216:219], v[120:123], v[196:199]
  v_accvgpr_write_b32 a132, v250
  v_mfma_f32_16x16x32_bf16 v[200:203], v[216:219], v[124:127], v[200:203]
  s_add_u32 m0, s81, 34816
  s_nop 0
  buffer_load_dwordx4 v58, s[12:15], s80 offen lds
  v_mfma_f32_16x16x32_bf16 v[204:207], v[216:219], v[128:131], v[204:207]
  v_accvgpr_write_b32 a133, v251
  s_waitcnt lgkmcnt(0)
  v_mfma_f32_16x16x32_bf16 v[196:199], v[220:223], v[132:135], v[196:199]
  v_cvt_pk_bf16_f32 v170, v192, v193
  v_cvt_pk_bf16_f32 v171, v194, v195
  v_mfma_f32_16x16x32_bf16 v[200:203], v[220:223], v[136:139], v[200:203]
  s_add_u32 m0, s81, 35840
  s_nop 0
  buffer_load_dwordx4 v59, s[12:15], s80 offen lds
  s_add_u32 s80, s80, 393216
  v_mfma_f32_16x16x32_bf16 v[204:207], v[220:223], v[140:143], v[204:207]
  s_add_u32 s21, s79, 1179648
  buffer_load_dwordx4 v[232:235], v65, s[28:31], s21 offen
  s_add_u32 s21, s79, 1572864
  buffer_load_dwordx4 v[236:239], v63, s[28:31], s21 offen
  s_waitcnt vmcnt(16)
  ds_read_b128 v[208:211], v70 offset:12288
  ds_read_b128 v[212:215], v71 offset:12288
  ds_read_b128 v[216:219], v70 offset:12416
  s_waitcnt lgkmcnt(2)
  v_mfma_f32_16x16x32_bf16 v[184:187], v[208:211], v[72:75], 0
  ds_read_b128 v[220:223], v71 offset:12416
  v_mfma_f32_16x16x32_bf16 v[188:191], v[208:211], v[76:79], 0
  s_add_u32 m0, s81, 0
  s_nop 0
  buffer_load_dwordx4 v48, s[12:15], s80 offen lds
  v_mfma_f32_16x16x32_bf16 v[192:195], v[208:211], v[80:83], 0
  s_waitcnt lgkmcnt(2)
  v_mfma_f32_16x16x32_bf16 v[184:187], v[212:215], v[84:87], v[184:187]
  ds_read_b128 v[208:211], v70 offset:12544
  v_cvt_pk_bf16_f32 v248, v196, v197
  v_mfma_f32_16x16x32_bf16 v[188:191], v[212:215], v[88:91], v[188:191]
  s_add_u32 m0, s81, 1024
  s_nop 0
  buffer_load_dwordx4 v49, s[12:15], s80 offen lds
  v_mfma_f32_16x16x32_bf16 v[192:195], v[212:215], v[92:95], v[192:195]
  v_cvt_pk_bf16_f32 v249, v198, v199
  s_waitcnt lgkmcnt(2)
  v_mfma_f32_16x16x32_bf16 v[184:187], v[216:219], v[96:99], v[184:187]
  ds_read_b128 v[212:215], v71 offset:12544
  v_cvt_pk_bf16_f32 v250, v200, v201
  v_mfma_f32_16x16x32_bf16 v[188:191], v[216:219], v[100:103], v[188:191]
  s_add_u32 m0, s81, 2048
  s_nop 0
  buffer_load_dwordx4 v50, s[12:15], s80 offen lds
  v_mfma_f32_16x16x32_bf16 v[192:195], v[216:219], v[104:107], v[192:195]
  v_cvt_pk_bf16_f32 v251, v202, v203
  s_waitcnt lgkmcnt(2)
  v_mfma_f32_16x16x32_bf16 v[184:187], v[220:223], v[108:111], v[184:187]
  ds_read_b128 v[216:219], v70 offset:13056
  v_accvgpr_write_b32 a54, v248
  v_mfma_f32_16x16x32_bf16 v[188:191], v[220:223], v[112:115], v[188:191]
  s_add_u32 m0, s81, 3072
  s_nop 0
  buffer_load_dwordx4 v51, s[12:15], s80 offen lds
  v_mfma_f32_16x16x32_bf16 v[192:195], v[220:223], v[116:119], v[192:195]
  v_accvgpr_write_b32 a55, v249
  s_waitcnt lgkmcnt(2)
  v_mfma_f32_16x16x32_bf16 v[184:187], v[208:211], v[120:123], v[184:187]
  ds_read_b128 v[220:223], v71 offset:13056
  v_accvgpr_write_b32 a134, v250
  v_mfma_f32_16x16x32_bf16 v[188:191], v[208:211], v[124:127], v[188:191]
  s_add_u32 m0, s81, 4096
  s_nop 0
  buffer_load_dwordx4 v52, s[12:15], s80 offen lds
  v_mfma_f32_16x16x32_bf16 v[192:195], v[208:211], v[128:131], v[192:195]
  v_accvgpr_write_b32 a135, v251
  s_waitcnt lgkmcnt(2)
  v_mfma_f32_16x16x32_bf16 v[184:187], v[212:215], v[132:135], v[184:187]
  ds_read_b128 v[208:211], v70 offset:13184
  s_mov_b64 exec, s[68:69]
  v_cvt_pk_bf16_f32 v170, v204, v205
  v_cvt_pk_bf16_f32 v171, v206, v207
  s_mov_b64 exec, -1
  v_mfma_f32_16x16x32_bf16 v[188:191], v[212:215], v[136:139], v[188:191]
  s_add_u32 m0, s81, 5120
  s_nop 0
  buffer_load_dwordx4 v53, s[12:15], s80 offen lds
  v_mfma_f32_16x16x32_bf16 v[192:195], v[212:215], v[140:143], v[192:195]
  s_waitcnt lgkmcnt(2)
  v_mfma_f32_16x16x32_bf16 v[196:199], v[216:219], v[72:75], 0
  ds_read_b128 v[212:215], v71 offset:13184
  v_mfma_f32_16x16x32_bf16 v[200:203], v[216:219], v[76:79], 0
  s_add_u32 m0, s81, 6144
  s_nop 0
  buffer_load_dwordx4 v54, s[12:15], s80 offen lds
  v_mfma_f32_16x16x32_bf16 v[204:207], v[216:219], v[80:83], 0
  s_waitcnt lgkmcnt(2)
  v_mfma_f32_16x16x32_bf16 v[196:199], v[220:223], v[84:87], v[196:199]
  ds_read_b128 v[216:219], v70 offset:13312
  v_cvt_pk_bf16_f32 v248, v184, v185
  v_mfma_f32_16x16x32_bf16 v[200:203], v[220:223], v[88:91], v[200:203]
  s_add_u32 m0, s81, 7168
  s_nop 0
  buffer_load_dwordx4 v55, s[12:15], s80 offen lds
  v_mfma_f32_16x16x32_bf16 v[204:207], v[220:223], v[92:95], v[204:207]
  v_cvt_pk_bf16_f32 v249, v186, v187
  s_waitcnt lgkmcnt(2)
  v_mfma_f32_16x16x32_bf16 v[196:199], v[208:211], v[96:99], v[196:199]
  ds_read_b128 v[220:223], v71 offset:13312
  v_cvt_pk_bf16_f32 v250, v188, v189
  v_mfma_f32_16x16x32_bf16 v[200:203], v[208:211], v[100:103], v[200:203]
  s_add_u32 m0, s81, 8192
  s_nop 0
  buffer_load_dwordx4 v56, s[12:15], s80 offen lds
  v_mfma_f32_16x16x32_bf16 v[204:207], v[208:211], v[104:107], v[204:207]
  v_cvt_pk_bf16_f32 v251, v190, v191
  s_waitcnt lgkmcnt(2)
  v_mfma_f32_16x16x32_bf16 v[196:199], v[212:215], v[108:111], v[196:199]
  v_accvgpr_write_b32 a56, v248
  v_mfma_f32_16x16x32_bf16 v[200:203], v[212:215], v[112:115], v[200:203]
  s_add_u32 m0, s81, 9216
  s_nop 0
  buffer_load_dwordx4 v57, s[12:15], s80 offen lds
  v_mfma_f32_16x16x32_bf16 v[204:207], v[212:215], v[116:119], v[204:207]
  v_accvgpr_write_b32 a57, v249
  s_waitcnt lgkmcnt(1)
  v_mfma_f32_16x16x32_bf16 v[196:199], v[216:219], v[120:123], v[196:199]
  v_accvgpr_write_b32 a136, v250
  v_mfma_f32_16x16x32_bf16 v[200:203], v[216:219], v[124:127], v[200:203]
  s_add_u32 m0, s81, 10240
  s_nop 0
  buffer_load_dwordx4 v58, s[12:15], s80 offen lds
  v_mfma_f32_16x16x32_bf16 v[204:207], v[216:219], v[128:131], v[204:207]
  v_accvgpr_write_b32 a137, v251
  s_waitcnt lgkmcnt(0)
  v_mfma_f32_16x16x32_bf16 v[196:199], v[220:223], v[132:135], v[196:199]
  v_cvt_pk_bf16_f32 v172, v192, v193
  v_cvt_pk_bf16_f32 v173, v194, v195
  v_mfma_f32_16x16x32_bf16 v[200:203], v[220:223], v[136:139], v[200:203]
  s_add_u32 m0, s81, 11264
  s_nop 0
  buffer_load_dwordx4 v59, s[12:15], s80 offen lds
  s_add_u32 s80, s80, 393216
  v_mfma_f32_16x16x32_bf16 v[204:207], v[220:223], v[140:143], v[204:207]
  s_add_u32 s21, s79, 1572864
  buffer_load_dwordx4 v[240:243], v64, s[28:31], s21 offen
  s_add_u32 s21, s79, 1572864
  buffer_load_dwordx4 v[244:247], v65, s[28:31], s21 offen
  s_waitcnt vmcnt(16)
  ds_read_b128 v[208:211], v70 offset:24576
  ds_read_b128 v[212:215], v71 offset:24576
  ds_read_b128 v[216:219], v70 offset:24704
  s_waitcnt lgkmcnt(2)
  v_mfma_f32_16x16x32_bf16 v[184:187], v[208:211], v[72:75], 0
  ds_read_b128 v[220:223], v71 offset:24704
  v_mfma_f32_16x16x32_bf16 v[188:191], v[208:211], v[76:79], 0
  s_add_u32 m0, s81, 12288
  s_nop 0
  buffer_load_dwordx4 v48, s[12:15], s80 offen lds
  v_mfma_f32_16x16x32_bf16 v[192:195], v[208:211], v[80:83], 0
  s_waitcnt lgkmcnt(2)
  v_mfma_f32_16x16x32_bf16 v[184:187], v[212:215], v[84:87], v[184:187]
  ds_read_b128 v[208:211], v70 offset:24832
  v_cvt_pk_bf16_f32 v248, v196, v197
  v_mfma_f32_16x16x32_bf16 v[188:191], v[212:215], v[88:91], v[188:191]
  s_add_u32 m0, s81, 13312
  s_nop 0
  buffer_load_dwordx4 v49, s[12:15], s80 offen lds
  v_mfma_f32_16x16x32_bf16 v[192:195], v[212:215], v[92:95], v[192:195]
  v_cvt_pk_bf16_f32 v249, v198, v199
  s_waitcnt lgkmcnt(2)
  v_mfma_f32_16x16x32_bf16 v[184:187], v[216:219], v[96:99], v[184:187]
  ds_read_b128 v[212:215], v71 offset:24832
  v_cvt_pk_bf16_f32 v250, v200, v201
  v_mfma_f32_16x16x32_bf16 v[188:191], v[216:219], v[100:103], v[188:191]
  s_add_u32 m0, s81, 14336
  s_nop 0
  buffer_load_dwordx4 v50, s[12:15], s80 offen lds
  v_mfma_f32_16x16x32_bf16 v[192:195], v[216:219], v[104:107], v[192:195]
  v_cvt_pk_bf16_f32 v251, v202, v203
  s_waitcnt lgkmcnt(2)
  v_mfma_f32_16x16x32_bf16 v[184:187], v[220:223], v[108:111], v[184:187]
  ds_read_b128 v[216:219], v70 offset:25344
  v_accvgpr_write_b32 a58, v248
  v_mfma_f32_16x16x32_bf16 v[188:191], v[220:223], v[112:115], v[188:191]
  s_add_u32 m0, s81, 15360
  s_nop 0
  buffer_load_dwordx4 v51, s[12:15], s80 offen lds
  v_mfma_f32_16x16x32_bf16 v[192:195], v[220:223], v[116:119], v[192:195]
  v_accvgpr_write_b32 a59, v249
  s_waitcnt lgkmcnt(2)
  v_mfma_f32_16x16x32_bf16 v[184:187], v[208:211], v[120:123], v[184:187]
  ds_read_b128 v[220:223], v71 offset:25344
  v_accvgpr_write_b32 a138, v250
  v_mfma_f32_16x16x32_bf16 v[188:191], v[208:211], v[124:127], v[188:191]
  s_add_u32 m0, s81, 16384
  s_nop 0
  buffer_load_dwordx4 v52, s[12:15], s80 offen lds
  v_mfma_f32_16x16x32_bf16 v[192:195], v[208:211], v[128:131], v[192:195]
  v_accvgpr_write_b32 a139, v251
  s_waitcnt lgkmcnt(2)
  v_mfma_f32_16x16x32_bf16 v[184:187], v[212:215], v[132:135], v[184:187]
  ds_read_b128 v[208:211], v70 offset:25472
  s_mov_b64 exec, s[68:69]
  v_cvt_pk_bf16_f32 v172, v204, v205
  v_cvt_pk_bf16_f32 v173, v206, v207
  s_mov_b64 exec, -1
  v_mfma_f32_16x16x32_bf16 v[188:191], v[212:215], v[136:139], v[188:191]
  s_add_u32 m0, s81, 17408
  s_nop 0
  buffer_load_dwordx4 v53, s[12:15], s80 offen lds
  v_mfma_f32_16x16x32_bf16 v[192:195], v[212:215], v[140:143], v[192:195]
  s_waitcnt lgkmcnt(2)
  v_mfma_f32_16x16x32_bf16 v[196:199], v[216:219], v[72:75], 0
  ds_read_b128 v[212:215], v71 offset:25472
  v_mfma_f32_16x16x32_bf16 v[200:203], v[216:219], v[76:79], 0
  s_add_u32 m0, s81, 18432
  s_nop 0
  buffer_load_dwordx4 v54, s[12:15], s80 offen lds
  v_mfma_f32_16x16x32_bf16 v[204:207], v[216:219], v[80:83], 0
  s_waitcnt lgkmcnt(2)
  v_mfma_f32_16x16x32_bf16 v[196:199], v[220:223], v[84:87], v[196:199]
  ds_read_b128 v[216:219], v70 offset:25600
  v_cvt_pk_bf16_f32 v248, v184, v185
  v_mfma_f32_16x16x32_bf16 v[200:203], v[220:223], v[88:91], v[200:203]
  s_add_u32 m0, s81, 19456
  s_nop 0
  buffer_load_dwordx4 v55, s[12:15], s80 offen lds
  v_mfma_f32_16x16x32_bf16 v[204:207], v[220:223], v[92:95], v[204:207]
  v_cvt_pk_bf16_f32 v249, v186, v187
  s_waitcnt lgkmcnt(2)
  v_mfma_f32_16x16x32_bf16 v[196:199], v[208:211], v[96:99], v[196:199]
  ds_read_b128 v[220:223], v71 offset:25600
  v_cvt_pk_bf16_f32 v250, v188, v189
  v_mfma_f32_16x16x32_bf16 v[200:203], v[208:211], v[100:103], v[200:203]
  s_add_u32 m0, s81, 20480
  s_nop 0
  buffer_load_dwordx4 v56, s[12:15], s80 offen lds
  v_mfma_f32_16x16x32_bf16 v[204:207], v[208:211], v[104:107], v[204:207]
  v_cvt_pk_bf16_f32 v251, v190, v191
  s_waitcnt lgkmcnt(2)
  v_mfma_f32_16x16x32_bf16 v[196:199], v[212:215], v[108:111], v[196:199]
  v_accvgpr_write_b32 a60, v248
  v_mfma_f32_16x16x32_bf16 v[200:203], v[212:215], v[112:115], v[200:203]
  s_add_u32 m0, s81, 21504
  s_nop 0
  buffer_load_dwordx4 v57, s[12:15], s80 offen lds
  v_mfma_f32_16x16x32_bf16 v[204:207], v[212:215], v[116:119], v[204:207]
  v_accvgpr_write_b32 a61, v249
  s_waitcnt lgkmcnt(1)
  v_mfma_f32_16x16x32_bf16 v[196:199], v[216:219], v[120:123], v[196:199]
  v_accvgpr_write_b32 a140, v250
  v_mfma_f32_16x16x32_bf16 v[200:203], v[216:219], v[124:127], v[200:203]
  s_add_u32 m0, s81, 22528
  s_nop 0
  buffer_load_dwordx4 v58, s[12:15], s80 offen lds
  v_mfma_f32_16x16x32_bf16 v[204:207], v[216:219], v[128:131], v[204:207]
  v_accvgpr_write_b32 a141, v251
  s_waitcnt lgkmcnt(0)
  v_mfma_f32_16x16x32_bf16 v[196:199], v[220:223], v[132:135], v[196:199]
  v_cvt_pk_bf16_f32 v174, v192, v193
  v_cvt_pk_bf16_f32 v175, v194, v195
  v_mfma_f32_16x16x32_bf16 v[200:203], v[220:223], v[136:139], v[200:203]
  s_add_u32 m0, s81, 23552
  s_nop 0
  buffer_load_dwordx4 v59, s[12:15], s80 offen lds
  s_add_u32 s80, s80, 393216
  v_mfma_f32_16x16x32_bf16 v[204:207], v[220:223], v[140:143], v[204:207]
  s_waitcnt vmcnt(14)
  ds_read_b128 v[208:211], v70 offset:0
  ds_read_b128 v[212:215], v71 offset:0
  ds_read_b128 v[216:219], v70 offset:128
  s_waitcnt lgkmcnt(2)
  v_mfma_f32_16x16x32_bf16 v[184:187], v[208:211], v[72:75], 0
  ds_read_b128 v[220:223], v71 offset:128
  v_mfma_f32_16x16x32_bf16 v[188:191], v[208:211], v[76:79], 0
  s_add_u32 m0, s81, 24576
  s_nop 0
  buffer_load_dwordx4 v48, s[12:15], s80 offen lds
  v_mfma_f32_16x16x32_bf16 v[192:195], v[208:211], v[80:83], 0
  s_waitcnt lgkmcnt(2)
  v_mfma_f32_16x16x32_bf16 v[184:187], v[212:215], v[84:87], v[184:187]
  ds_read_b128 v[208:211], v70 offset:256
  v_cvt_pk_bf16_f32 v248, v196, v197
  v_mfma_f32_16x16x32_bf16 v[188:191], v[212:215], v[88:91], v[188:191]
  s_add_u32 m0, s81, 25600
  s_nop 0
  buffer_load_dwordx4 v49, s[12:15], s80 offen lds
  v_mfma_f32_16x16x32_bf16 v[192:195], v[212:215], v[92:95], v[192:195]
  v_cvt_pk_bf16_f32 v249, v198, v199
  s_waitcnt lgkmcnt(2)
  v_mfma_f32_16x16x32_bf16 v[184:187], v[216:219], v[96:99], v[184:187]
  ds_read_b128 v[212:215], v71 offset:256
  v_cvt_pk_bf16_f32 v250, v200, v201
  v_mfma_f32_16x16x32_bf16 v[188:191], v[216:219], v[100:103], v[188:191]
  s_add_u32 m0, s81, 26624
  s_nop 0
  buffer_load_dwordx4 v50, s[12:15], s80 offen lds
  v_mfma_f32_16x16x32_bf16 v[192:195], v[216:219], v[104:107], v[192:195]
  v_cvt_pk_bf16_f32 v251, v202, v203
  s_waitcnt lgkmcnt(2)
  v_mfma_f32_16x16x32_bf16 v[184:187], v[220:223], v[108:111], v[184:187]
  ds_read_b128 v[216:219], v70 offset:768
  v_accvgpr_write_b32 a62, v248
  v_mfma_f32_16x16x32_bf16 v[188:191], v[220:223], v[112:115], v[188:191]
  s_add_u32 m0, s81, 27648
  s_nop 0
  buffer_load_dwordx4 v51, s[12:15], s80 offen lds
  v_mfma_f32_16x16x32_bf16 v[192:195], v[220:223], v[116:119], v[192:195]
  v_accvgpr_write_b32 a63, v249
  s_waitcnt lgkmcnt(2)
  v_mfma_f32_16x16x32_bf16 v[184:187], v[208:211], v[120:123], v[184:187]
  ds_read_b128 v[220:223], v71 offset:768
  v_accvgpr_write_b32 a142, v250
  v_mfma_f32_16x16x32_bf16 v[188:191], v[208:211], v[124:127], v[188:191]
  s_add_u32 m0, s81, 28672
  s_nop 0
  buffer_load_dwordx4 v52, s[12:15], s80 offen lds
  v_mfma_f32_16x16x32_bf16 v[192:195], v[208:211], v[128:131], v[192:195]
  v_accvgpr_write_b32 a143, v251
  s_waitcnt lgkmcnt(2)
  v_mfma_f32_16x16x32_bf16 v[184:187], v[212:215], v[132:135], v[184:187]
  ds_read_b128 v[208:211], v70 offset:896
  s_mov_b64 exec, s[68:69]
  v_cvt_pk_bf16_f32 v174, v204, v205
  v_cvt_pk_bf16_f32 v175, v206, v207
  s_mov_b64 exec, -1
  v_mfma_f32_16x16x32_bf16 v[188:191], v[212:215], v[136:139], v[188:191]
  s_add_u32 m0, s81, 29696
  s_nop 0
  buffer_load_dwordx4 v53, s[12:15], s80 offen lds
  v_mfma_f32_16x16x32_bf16 v[192:195], v[212:215], v[140:143], v[192:195]
  s_waitcnt lgkmcnt(2)
  v_mfma_f32_16x16x32_bf16 v[196:199], v[216:219], v[72:75], 0
  ds_read_b128 v[212:215], v71 offset:896
  v_mfma_f32_16x16x32_bf16 v[200:203], v[216:219], v[76:79], 0
  s_add_u32 m0, s81, 30720
  s_nop 0
  buffer_load_dwordx4 v54, s[12:15], s80 offen lds
  v_mfma_f32_16x16x32_bf16 v[204:207], v[216:219], v[80:83], 0
  s_waitcnt lgkmcnt(2)
  v_mfma_f32_16x16x32_bf16 v[196:199], v[220:223], v[84:87], v[196:199]
  ds_read_b128 v[216:219], v70 offset:1024
  v_cvt_pk_bf16_f32 v248, v184, v185
  v_mfma_f32_16x16x32_bf16 v[200:203], v[220:223], v[88:91], v[200:203]
  s_add_u32 m0, s81, 31744
  s_nop 0
  buffer_load_dwordx4 v55, s[12:15], s80 offen lds
  v_mfma_f32_16x16x32_bf16 v[204:207], v[220:223], v[92:95], v[204:207]
  v_cvt_pk_bf16_f32 v249, v186, v187
  s_waitcnt lgkmcnt(2)
  v_mfma_f32_16x16x32_bf16 v[196:199], v[208:211], v[96:99], v[196:199]
  ds_read_b128 v[220:223], v71 offset:1024
  v_cvt_pk_bf16_f32 v250, v188, v189
  v_mfma_f32_16x16x32_bf16 v[200:203], v[208:211], v[100:103], v[200:203]
  s_add_u32 m0, s81, 32768
  s_nop 0
  buffer_load_dwordx4 v56, s[12:15], s80 offen lds
  v_mfma_f32_16x16x32_bf16 v[204:207], v[208:211], v[104:107], v[204:207]
  v_cvt_pk_bf16_f32 v251, v190, v191
  s_waitcnt lgkmcnt(2)
  v_mfma_f32_16x16x32_bf16 v[196:199], v[212:215], v[108:111], v[196:199]
  v_accvgpr_write_b32 a64, v248
  v_mfma_f32_16x16x32_bf16 v[200:203], v[212:215], v[112:115], v[200:203]
  s_add_u32 m0, s81, 33792
  s_nop 0
  buffer_load_dwordx4 v57, s[12:15], s80 offen lds
  v_mfma_f32_16x16x32_bf16 v[204:207], v[212:215], v[116:119], v[204:207]
  v_accvgpr_write_b32 a65, v249
  s_waitcnt lgkmcnt(1)
  v_mfma_f32_16x16x32_bf16 v[196:199], v[216:219], v[120:123], v[196:199]
  v_accvgpr_write_b32 a144, v250
  v_mfma_f32_16x16x32_bf16 v[200:203], v[216:219], v[124:127], v[200:203]
  s_add_u32 m0, s81, 34816
  s_nop 0
  buffer_load_dwordx4 v58, s[12:15], s80 offen lds
  v_mfma_f32_16x16x32_bf16 v[204:207], v[216:219], v[128:131], v[204:207]
  v_accvgpr_write_b32 a145, v251
  s_waitcnt lgkmcnt(0)
  v_mfma_f32_16x16x32_bf16 v[196:199], v[220:223], v[132:135], v[196:199]
  v_cvt_pk_bf16_f32 v176, v192, v193
  v_cvt_pk_bf16_f32 v177, v194, v195
  v_mfma_f32_16x16x32_bf16 v[200:203], v[220:223], v[136:139], v[200:203]
  s_add_u32 m0, s81, 35840
  s_nop 0
  buffer_load_dwordx4 v59, s[12:15], s80 offen lds
  s_add_u32 s80, s80, 393216
  v_mfma_f32_16x16x32_bf16 v[204:207], v[220:223], v[140:143], v[204:207]
  s_waitcnt vmcnt(12)
  ds_read_b128 v[208:211], v70 offset:12288
  ds_read_b128 v[212:215], v71 offset:12288
  ds_read_b128 v[216:219], v70 offset:12416
  s_waitcnt lgkmcnt(2)
  v_mfma_f32_16x16x32_bf16 v[184:187], v[208:211], v[72:75], 0
  ds_read_b128 v[220:223], v71 offset:12416
  v_mfma_f32_16x16x32_bf16 v[188:191], v[208:211], v[76:79], 0
  s_add_u32 m0, s81, 0
  s_nop 0
  buffer_load_dwordx4 v48, s[12:15], s80 offen lds
  v_mfma_f32_16x16x32_bf16 v[192:195], v[208:211], v[80:83], 0
  s_waitcnt lgkmcnt(2)
  v_mfma_f32_16x16x32_bf16 v[184:187], v[212:215], v[84:87], v[184:187]
  ds_read_b128 v[208:211], v70 offset:12544
  v_cvt_pk_bf16_f32 v248, v196, v197
  v_mfma_f32_16x16x32_bf16 v[188:191], v[212:215], v[88:91], v[188:191]
  s_add_u32 m0, s81, 1024
  s_nop 0
  buffer_load_dwordx4 v49, s[12:15], s80 offen lds
  v_mfma_f32_16x16x32_bf16 v[192:195], v[212:215], v[92:95], v[192:195]
  v_cvt_pk_bf16_f32 v249, v198, v199
  s_waitcnt lgkmcnt(2)
  v_mfma_f32_16x16x32_bf16 v[184:187], v[216:219], v[96:99], v[184:187]
  ds_read_b128 v[212:215], v71 offset:12544
  v_cvt_pk_bf16_f32 v250, v200, v201
  v_mfma_f32_16x16x32_bf16 v[188:191], v[216:219], v[100:103], v[188:191]
  s_add_u32 m0, s81, 2048
  s_nop 0
  buffer_load_dwordx4 v50, s[12:15], s80 offen lds
  v_mfma_f32_16x16x32_bf16 v[192:195], v[216:219], v[104:107], v[192:195]
  v_cvt_pk_bf16_f32 v251, v202, v203
  s_waitcnt lgkmcnt(2)
  v_mfma_f32_16x16x32_bf16 v[184:187], v[220:223], v[108:111], v[184:187]
  ds_read_b128 v[216:219], v70 offset:13056
  v_accvgpr_write_b32 a66, v248
  v_mfma_f32_16x16x32_bf16 v[188:191], v[220:223], v[112:115], v[188:191]
  s_add_u32 m0, s81, 3072
  s_nop 0
  buffer_load_dwordx4 v51, s[12:15], s80 offen lds
  v_mfma_f32_16x16x32_bf16 v[192:195], v[220:223], v[116:119], v[192:195]
  v_accvgpr_write_b32 a67, v249
  s_waitcnt lgkmcnt(2)
  v_mfma_f32_16x16x32_bf16 v[184:187], v[208:211], v[120:123], v[184:187]
  ds_read_b128 v[220:223], v71 offset:13056
  v_accvgpr_write_b32 a146, v250
  v_mfma_f32_16x16x32_bf16 v[188:191], v[208:211], v[124:127], v[188:191]
  s_add_u32 m0, s81, 4096
  s_nop 0
  buffer_load_dwordx4 v52, s[12:15], s80 offen lds
  v_mfma_f32_16x16x32_bf16 v[192:195], v[208:211], v[128:131], v[192:195]
  v_accvgpr_write_b32 a147, v251
  s_waitcnt lgkmcnt(2)
  v_mfma_f32_16x16x32_bf16 v[184:187], v[212:215], v[132:135], v[184:187]
  ds_read_b128 v[208:211], v70 offset:13184
  s_mov_b64 exec, s[68:69]
  v_cvt_pk_bf16_f32 v176, v204, v205
  v_cvt_pk_bf16_f32 v177, v206, v207
  s_mov_b64 exec, -1
  v_mfma_f32_16x16x32_bf16 v[188:191], v[212:215], v[136:139], v[188:191]
  s_add_u32 m0, s81, 5120
  s_nop 0
  buffer_load_dwordx4 v53, s[12:15], s80 offen lds
  v_mfma_f32_16x16x32_bf16 v[192:195], v[212:215], v[140:143], v[192:195]
  s_waitcnt lgkmcnt(2)
  v_mfma_f32_16x16x32_bf16 v[196:199], v[216:219], v[72:75], 0
  ds_read_b128 v[212:215], v71 offset:13184
  v_mfma_f32_16x16x32_bf16 v[200:203], v[216:219], v[76:79], 0
  s_add_u32 m0, s81, 6144
  s_nop 0
  buffer_load_dwordx4 v54, s[12:15], s80 offen lds
  v_mfma_f32_16x16x32_bf16 v[204:207], v[216:219], v[80:83], 0
  s_waitcnt lgkmcnt(2)
  v_mfma_f32_16x16x32_bf16 v[196:199], v[220:223], v[84:87], v[196:199]
  ds_read_b128 v[216:219], v70 offset:13312
  v_cvt_pk_bf16_f32 v248, v184, v185
  v_mfma_f32_16x16x32_bf16 v[200:203], v[220:223], v[88:91], v[200:203]
  s_add_u32 m0, s81, 7168
  s_nop 0
  buffer_load_dwordx4 v55, s[12:15], s80 offen lds
  v_mfma_f32_16x16x32_bf16 v[204:207], v[220:223], v[92:95], v[204:207]
  v_cvt_pk_bf16_f32 v249, v186, v187
  s_waitcnt lgkmcnt(2)
  v_mfma_f32_16x16x32_bf16 v[196:199], v[208:211], v[96:99], v[196:199]
  ds_read_b128 v[220:223], v71 offset:13312
  v_cvt_pk_bf16_f32 v250, v188, v189
  v_mfma_f32_16x16x32_bf16 v[200:203], v[208:211], v[100:103], v[200:203]
  s_add_u32 m0, s81, 8192
  s_nop 0
  buffer_load_dwordx4 v56, s[12:15], s80 offen lds
  v_mfma_f32_16x16x32_bf16 v[204:207], v[208:211], v[104:107], v[204:207]
  v_cvt_pk_bf16_f32 v251, v190, v191
  s_waitcnt lgkmcnt(2)
  v_mfma_f32_16x16x32_bf16 v[196:199], v[212:215], v[108:111], v[196:199]
  v_accvgpr_write_b32 a68, v248
  v_mfma_f32_16x16x32_bf16 v[200:203], v[212:215], v[112:115], v[200:203]
  s_add_u32 m0, s81, 9216
  s_nop 0
  buffer_load_dwordx4 v57, s[12:15], s80 offen lds
  v_mfma_f32_16x16x32_bf16 v[204:207], v[212:215], v[116:119], v[204:207]
  v_accvgpr_write_b32 a69, v249
  s_waitcnt lgkmcnt(1)
  v_mfma_f32_16x16x32_bf16 v[196:199], v[216:219], v[120:123], v[196:199]
  v_accvgpr_write_b32 a148, v250
  v_mfma_f32_16x16x32_bf16 v[200:203], v[216:219], v[124:127], v[200:203]
  s_add_u32 m0, s81, 10240
  s_nop 0
  buffer_load_dwordx4 v58, s[12:15], s80 offen lds
  v_mfma_f32_16x16x32_bf16 v[204:207], v[216:219], v[128:131], v[204:207]
  v_accvgpr_write_b32 a149, v251
  s_waitcnt lgkmcnt(0)
  v_mfma_f32_16x16x32_bf16 v[196:199], v[220:223], v[132:135], v[196:199]
  v_cvt_pk_bf16_f32 v178, v192, v193
  v_cvt_pk_bf16_f32 v179, v194, v195
  v_mfma_f32_16x16x32_bf16 v[200:203], v[220:223], v[136:139], v[200:203]
  s_add_u32 m0, s81, 11264
  s_nop 0
  buffer_load_dwordx4 v59, s[12:15], s80 offen lds
  s_add_u32 s80, s80, 393216
  v_mfma_f32_16x16x32_bf16 v[204:207], v[220:223], v[140:143], v[204:207]
  s_waitcnt vmcnt(12)
  ds_read_b128 v[208:211], v70 offset:24576
  ds_read_b128 v[212:215], v71 offset:24576
  ds_read_b128 v[216:219], v70 offset:24704
  s_waitcnt lgkmcnt(2)
  v_mfma_f32_16x16x32_bf16 v[184:187], v[208:211], v[72:75], 0
  ds_read_b128 v[220:223], v71 offset:24704
  v_mfma_f32_16x16x32_bf16 v[188:191], v[208:211], v[76:79], 0
  v_mfma_f32_16x16x32_bf16 v[192:195], v[208:211], v[80:83], 0
  s_waitcnt lgkmcnt(2)
  v_mfma_f32_16x16x32_bf16 v[184:187], v[212:215], v[84:87], v[184:187]
  ds_read_b128 v[208:211], v70 offset:24832
  v_cvt_pk_bf16_f32 v248, v196, v197
  v_mfma_f32_16x16x32_bf16 v[188:191], v[212:215], v[88:91], v[188:191]
  v_mfma_f32_16x16x32_bf16 v[192:195], v[212:215], v[92:95], v[192:195]
  v_cvt_pk_bf16_f32 v249, v198, v199
  s_waitcnt lgkmcnt(2)
  v_mfma_f32_16x16x32_bf16 v[184:187], v[216:219], v[96:99], v[184:187]
  ds_read_b128 v[212:215], v71 offset:24832
  v_cvt_pk_bf16_f32 v250, v200, v201
  v_mfma_f32_16x16x32_bf16 v[188:191], v[216:219], v[100:103], v[188:191]
  v_mfma_f32_16x16x32_bf16 v[192:195], v[216:219], v[104:107], v[192:195]
  v_cvt_pk_bf16_f32 v251, v202, v203
  s_waitcnt lgkmcnt(2)
  v_mfma_f32_16x16x32_bf16 v[184:187], v[220:223], v[108:111], v[184:187]
  ds_read_b128 v[216:219], v70 offset:25344
  v_accvgpr_write_b32 a70, v248
  v_mfma_f32_16x16x32_bf16 v[188:191], v[220:223], v[112:115], v[188:191]
  v_mfma_f32_16x16x32_bf16 v[192:195], v[220:223], v[116:119], v[192:195]
  v_accvgpr_write_b32 a71, v249
  s_waitcnt lgkmcnt(2)
  v_mfma_f32_16x16x32_bf16 v[184:187], v[208:211], v[120:123], v[184:187]
  ds_read_b128 v[220:223], v71 offset:25344
  v_accvgpr_write_b32 a150, v250
  v_mfma_f32_16x16x32_bf16 v[188:191], v[208:211], v[124:127], v[188:191]
  v_mfma_f32_16x16x32_bf16 v[192:195], v[208:211], v[128:131], v[192:195]
  v_accvgpr_write_b32 a151, v251
  s_waitcnt lgkmcnt(2)
  v_mfma_f32_16x16x32_bf16 v[184:187], v[212:215], v[132:135], v[184:187]
  ds_read_b128 v[208:211], v70 offset:25472
  s_mov_b64 exec, s[68:69]
  v_cvt_pk_bf16_f32 v178, v204, v205
  v_cvt_pk_bf16_f32 v179, v206, v207
  s_mov_b64 exec, -1
  v_mfma_f32_16x16x32_bf16 v[188:191], v[212:215], v[136:139], v[188:191]
  v_mfma_f32_16x16x32_bf16 v[192:195], v[212:215], v[140:143], v[192:195]
  s_waitcnt lgkmcnt(2)
  v_mfma_f32_16x16x32_bf16 v[196:199], v[216:219], v[72:75], 0
  ds_read_b128 v[212:215], v71 offset:25472
  v_mfma_f32_16x16x32_bf16 v[200:203], v[216:219], v[76:79], 0
  v_mfma_f32_16x16x32_bf16 v[204:207], v[216:219], v[80:83], 0
  s_waitcnt lgkmcnt(2)
  v_mfma_f32_16x16x32_bf16 v[196:199], v[220:223], v[84:87], v[196:199]
  ds_read_b128 v[216:219], v70 offset:25600
  v_cvt_pk_bf16_f32 v248, v184, v185
  v_mfma_f32_16x16x32_bf16 v[200:203], v[220:223], v[88:91], v[200:203]
  v_mfma_f32_16x16x32_bf16 v[204:207], v[220:223], v[92:95], v[204:207]
  v_cvt_pk_bf16_f32 v249, v186, v187
  s_waitcnt lgkmcnt(2)
  v_mfma_f32_16x16x32_bf16 v[196:199], v[208:211], v[96:99], v[196:199]
  ds_read_b128 v[220:223], v71 offset:25600
  v_cvt_pk_bf16_f32 v250, v188, v189
  v_mfma_f32_16x16x32_bf16 v[200:203], v[208:211], v[100:103], v[200:203]
  v_mfma_f32_16x16x32_bf16 v[204:207], v[208:211], v[104:107], v[204:207]
  v_cvt_pk_bf16_f32 v251, v190, v191
  s_waitcnt lgkmcnt(2)
  v_mfma_f32_16x16x32_bf16 v[196:199], v[212:215], v[108:111], v[196:199]
  v_accvgpr_write_b32 a72, v248
  v_mfma_f32_16x16x32_bf16 v[200:203], v[212:215], v[112:115], v[200:203]
  v_mfma_f32_16x16x32_bf16 v[204:207], v[212:215], v[116:119], v[204:207]
  v_accvgpr_write_b32 a73, v249
  s_waitcnt lgkmcnt(1)
  v_mfma_f32_16x16x32_bf16 v[196:199], v[216:219], v[120:123], v[196:199]
  v_accvgpr_write_b32 a152, v250
  v_mfma_f32_16x16x32_bf16 v[200:203], v[216:219], v[124:127], v[200:203]
  v_mfma_f32_16x16x32_bf16 v[204:207], v[216:219], v[128:131], v[204:207]
  v_accvgpr_write_b32 a153, v251
  s_waitcnt lgkmcnt(0)
  v_mfma_f32_16x16x32_bf16 v[196:199], v[220:223], v[132:135], v[196:199]
  v_cvt_pk_bf16_f32 v180, v192, v193
  v_cvt_pk_bf16_f32 v181, v194, v195
  v_mfma_f32_16x16x32_bf16 v[200:203], v[220:223], v[136:139], v[200:203]
  v_mfma_f32_16x16x32_bf16 v[204:207], v[220:223], v[140:143], v[204:207]
  s_waitcnt vmcnt(0)
  ds_read_b128 v[208:211], v70 offset:0
  ds_read_b128 v[212:215], v71 offset:0
  ds_read_b128 v[216:219], v70 offset:128
  s_waitcnt lgkmcnt(2)
  v_mfma_f32_16x16x32_bf16 v[184:187], v[208:211], v[72:75], 0
  ds_read_b128 v[220:223], v71 offset:128
  v_mfma_f32_16x16x32_bf16 v[188:191], v[208:211], v[76:79], 0
  v_mfma_f32_16x16x32_bf16 v[192:195], v[208:211], v[80:83], 0
  s_waitcnt lgkmcnt(2)
  v_mfma_f32_16x16x32_bf16 v[184:187], v[212:215], v[84:87], v[184:187]
  ds_read_b128 v[208:211], v70 offset:256
  v_cvt_pk_bf16_f32 v248, v196, v197
  v_mfma_f32_16x16x32_bf16 v[188:191], v[212:215], v[88:91], v[188:191]
  v_mfma_f32_16x16x32_bf16 v[192:195], v[212:215], v[92:95], v[192:195]
  v_cvt_pk_bf16_f32 v249, v198, v199
  s_waitcnt lgkmcnt(2)
  v_mfma_f32_16x16x32_bf16 v[184:187], v[216:219], v[96:99], v[184:187]
  ds_read_b128 v[212:215], v71 offset:256
  v_cvt_pk_bf16_f32 v250, v200, v201
  v_mfma_f32_16x16x32_bf16 v[188:191], v[216:219], v[100:103], v[188:191]
  v_mfma_f32_16x16x32_bf16 v[192:195], v[216:219], v[104:107], v[192:195]
  v_cvt_pk_bf16_f32 v251, v202, v203
  s_waitcnt lgkmcnt(2)
  v_mfma_f32_16x16x32_bf16 v[184:187], v[220:223], v[108:111], v[184:187]
  ds_read_b128 v[216:219], v70 offset:768
  v_accvgpr_write_b32 a74, v248
  v_mfma_f32_16x16x32_bf16 v[188:191], v[220:223], v[112:115], v[188:191]
  v_mfma_f32_16x16x32_bf16 v[192:195], v[220:223], v[116:119], v[192:195]
  v_accvgpr_write_b32 a75, v249
  s_waitcnt lgkmcnt(2)
  v_mfma_f32_16x16x32_bf16 v[184:187], v[208:211], v[120:123], v[184:187]
  ds_read_b128 v[220:223], v71 offset:768
  v_accvgpr_write_b32 a154, v250
  v_mfma_f32_16x16x32_bf16 v[188:191], v[208:211], v[124:127], v[188:191]
  v_mfma_f32_16x16x32_bf16 v[192:195], v[208:211], v[128:131], v[192:195]
  v_accvgpr_write_b32 a155, v251
  s_waitcnt lgkmcnt(2)
  v_mfma_f32_16x16x32_bf16 v[184:187], v[212:215], v[132:135], v[184:187]
  ds_read_b128 v[208:211], v70 offset:896
  s_mov_b64 exec, s[68:69]
  v_cvt_pk_bf16_f32 v180, v204, v205
  v_cvt_pk_bf16_f32 v181, v206, v207
  s_mov_b64 exec, -1
  v_mfma_f32_16x16x32_bf16 v[188:191], v[212:215], v[136:139], v[188:191]
  v_mfma_f32_16x16x32_bf16 v[192:195], v[212:215], v[140:143], v[192:195]
  s_waitcnt lgkmcnt(2)
  v_mfma_f32_16x16x32_bf16 v[196:199], v[216:219], v[72:75], 0
  ds_read_b128 v[212:215], v71 offset:896
  v_mfma_f32_16x16x32_bf16 v[200:203], v[216:219], v[76:79], 0
  v_mfma_f32_16x16x32_bf16 v[204:207], v[216:219], v[80:83], 0
  s_waitcnt lgkmcnt(2)
  v_mfma_f32_16x16x32_bf16 v[196:199], v[220:223], v[84:87], v[196:199]
  ds_read_b128 v[216:219], v70 offset:1024
  v_cvt_pk_bf16_f32 v248, v184, v185
  v_mfma_f32_16x16x32_bf16 v[200:203], v[220:223], v[88:91], v[200:203]
  v_mfma_f32_16x16x32_bf16 v[204:207], v[220:223], v[92:95], v[204:207]
  v_cvt_pk_bf16_f32 v249, v186, v187
  s_waitcnt lgkmcnt(2)
  v_mfma_f32_16x16x32_bf16 v[196:199], v[208:211], v[96:99], v[196:199]
  ds_read_b128 v[220:223], v71 offset:1024
  v_cvt_pk_bf16_f32 v250, v188, v189
  v_mfma_f32_16x16x32_bf16 v[200:203], v[208:211], v[100:103], v[200:203]
  v_mfma_f32_16x16x32_bf16 v[204:207], v[208:211], v[104:107], v[204:207]
  v_cvt_pk_bf16_f32 v251, v190, v191
  s_waitcnt lgkmcnt(2)
  v_mfma_f32_16x16x32_bf16 v[196:199], v[212:215], v[108:111], v[196:199]
  v_accvgpr_write_b32 a76, v248
  v_mfma_f32_16x16x32_bf16 v[200:203], v[212:215], v[112:115], v[200:203]
  v_mfma_f32_16x16x32_bf16 v[204:207], v[212:215], v[116:119], v[204:207]
  v_accvgpr_write_b32 a77, v249
  s_waitcnt lgkmcnt(1)
  v_mfma_f32_16x16x32_bf16 v[196:199], v[216:219], v[120:123], v[196:199]
  v_accvgpr_write_b32 a156, v250
  v_mfma_f32_16x16x32_bf16 v[200:203], v[216:219], v[124:127], v[200:203]
  v_mfma_f32_16x16x32_bf16 v[204:207], v[216:219], v[128:131], v[204:207]
  v_accvgpr_write_b32 a157, v251
  s_waitcnt lgkmcnt(0)
  v_mfma_f32_16x16x32_bf16 v[196:199], v[220:223], v[132:135], v[196:199]
  v_cvt_pk_bf16_f32 v182, v192, v193
  v_cvt_pk_bf16_f32 v183, v194, v195
  v_mfma_f32_16x16x32_bf16 v[200:203], v[220:223], v[136:139], v[200:203]
  v_mfma_f32_16x16x32_bf16 v[204:207], v[220:223], v[140:143], v[204:207]
  s_nop 7
  v_cvt_pk_bf16_f32 v248, v196, v197
  v_cvt_pk_bf16_f32 v249, v198, v199
  v_cvt_pk_bf16_f32 v250, v200, v201
  v_cvt_pk_bf16_f32 v251, v202, v203
  v_accvgpr_write_b32 a78, v248
  v_accvgpr_write_b32 a79, v249
  v_accvgpr_write_b32 a158, v250
  v_accvgpr_write_b32 a159, v251
  s_mov_b64 exec, s[68:69]
  v_cvt_pk_bf16_f32 v182, v204, v205
  v_cvt_pk_bf16_f32 v183, v206, v207
  s_mov_b64 exec, -1
  s_waitcnt vmcnt(0)
  s_barrier
  s_mul_i32 s21, s20, 15360
  v_add_u32 v66, s21, v4
  v_add_u32 v67, 61440, v66
  ds_write_b128 v66, a[160:163] offset:0
  ds_write_b128 v66, a[164:167] offset:1024
  ds_write_b128 v66, a[168:171] offset:2048
  ds_write_b128 v66, a[172:175] offset:3072
  ds_write_b128 v66, a[176:179] offset:4096
  ds_write_b128 v66, a[180:183] offset:5120
  ds_write_b128 v66, a[184:187] offset:6144
  ds_write_b128 v66, a[188:191] offset:7168
  ds_write_b128 v66, a[192:195] offset:8192
  ds_write_b128 v66, a[196:199] offset:9216
  ds_write_b128 v66, a[200:203] offset:10240
  ds_write_b128 v66, a[204:207] offset:11264
  ds_write_b128 v66, a[208:211] offset:12288
  ds_write_b128 v66, a[212:215] offset:13312
  ds_write_b128 v66, a[216:219] offset:14336
  ds_write_b128 v67, a[220:223] offset:0
  ds_write_b128 v67, a[224:227] offset:1024
  ds_write_b128 v67, a[228:231] offset:2048
  ds_write_b128 v67, a[232:235] offset:3072
  ds_write_b128 v67, a[236:239] offset:4096
  ds_write_b128 v67, a[240:243] offset:5120
  ds_write_b128 v67, a[244:247] offset:6144
  ds_write_b128 v67, a[248:251] offset:7168
  ds_write_b128 v67, a[252:255] offset:8192
  ds_write_b128 v67, v[224:227] offset:9216
  ds_write_b128 v67, v[228:231] offset:10240
  ds_write_b128 v67, v[232:235] offset:11264
  ds_write_b128 v67, v[236:239] offset:12288
  ds_write_b128 v67, v[240:243] offset:13312
  ds_write_b128 v67, v[244:247] offset:14336
  s_lshr_b32 s21, s20, 1
  s_mul_i32 s21, s21, 20480
  s_and_b32 s22, s20, 1
  s_lshl_b32 s22, s22, 7
  s_add_u32 s21, s21, s22
  s_add_u32 s21, s21, 122880
  v_and_b32 v68, 7, v2
  v_lshlrev_b32 v68, 4, v68
  v_lshl_add_u32 v68, v3, 8, v68
  v_and_b32 v69, 8, v2
  v_add3_u32 v68, s21, v68, v69
  ds_write_b64 v68, v[144:145] offset:0
  ds_write_b64 v68, v[146:147] offset:1024
  ds_write_b64 v68, v[148:149] offset:2048
  ds_write_b64 v68, v[150:151] offset:3072
  ds_write_b64 v68, v[152:153] offset:4096
  ds_write_b64 v68, v[154:155] offset:5120
  ds_write_b64 v68, v[156:157] offset:6144
  ds_write_b64 v68, v[158:159] offset:7168
  ds_write_b64 v68, v[160:161] offset:8192
  ds_write_b64 v68, v[162:163] offset:9216
  ds_write_b64 v68, v[164:165] offset:10240
  ds_write_b64 v68, v[166:167] offset:11264
  ds_write_b64 v68, v[168:169] offset:12288
  ds_write_b64 v68, v[170:171] offset:13312
  ds_write_b64 v68, v[172:173] offset:14336
  ds_write_b64 v68, v[174:175] offset:15360
  ds_write_b64 v68, v[176:177] offset:16384
  ds_write_b64 v68, v[178:179] offset:17408
  ds_write_b64 v68, v[180:181] offset:18432
  ds_write_b64 v68, v[182:183] offset:19456
  v_lshrrev_b32 v72, 1, v3
  v_lshlrev_b32 v72, 4, v72
  v_and_b32 v73, 8, v2
  v_add_u32 v72, v72, v73
  v_and_b32 v73, 1, v3
  v_lshl_add_u32 v72, v73, 2, v72
  v_bfe_u32 v73, v2, 2, 1
  v_add_u32 v72, v72, v73
  v_mul_u32_u24 v72, 96, v72
  v_and_b32 v73, 3, v2
  v_lshl_add_u32 v72, v73, 3, v72
  s_lshl_b32 s21, s20, 5
  v_add_u32 v72, s21, v72
  v_add_u32 v73, 61440, v72
  v_cndmask_b32 v66, v72, v73, s[68:69]
  v_cndmask_b32 v67, v73, v72, s[68:69]
  v_add_u32 v68, 122880, v4
  s_waitcnt lgkmcnt(0)
  s_barrier
  s_cmp_eq_u32 s20, 3
  s_cbranch_scc1 w3_12
  ds_read_b64_tr_b16 a[160:161], v66 offset:0
  ds_read_b64_tr_b16 a[162:163], v66 offset:192
  ds_read_b64_tr_b16 a[164:165], v66 offset:3072
  ds_read_b64_tr_b16 a[166:167], v66 offset:3264
  ds_read_b64_tr_b16 a[168:169], v66 offset:6144
  ds_read_b64_tr_b16 a[170:171], v66 offset:6336
  ds_read_b64_tr_b16 a[172:173], v66 offset:9216
  ds_read_b64_tr_b16 a[174:175], v66 offset:9408
  ds_read_b64_tr_b16 a[176:177], v66 offset:12288
  ds_read_b64_tr_b16 a[178:179], v66 offset:12480
  ds_read_b64_tr_b16 a[180:181], v66 offset:15360
  ds_read_b64_tr_b16 a[182:183], v66 offset:15552
  ds_read_b64_tr_b16 a[184:185], v66 offset:18432
  ds_read_b64_tr_b16 a[186:187], v66 offset:18624
  ds_read_b64_tr_b16 a[188:189], v66 offset:21504
  ds_read_b64_tr_b16 a[190:191], v66 offset:21696
  ds_read_b64_tr_b16 a[192:193], v66 offset:24576
  ds_read_b64_tr_b16 a[194:195], v66 offset:24768
  ds_read_b64_tr_b16 a[196:197], v66 offset:27648
  ds_read_b64_tr_b16 a[198:199], v66 offset:27840
  ds_read_b64_tr_b16 a[200:201], v66 offset:30720
  ds_read_b64_tr_b16 a[202:203], v66 offset:30912
  ds_read_b64_tr_b16 a[204:205], v66 offset:33792
  ds_read_b64_tr_b16 a[206:207], v66 offset:33984
  ds_read_b64_tr_b16 a[208:209], v66 offset:36864
  ds_read_b64_tr_b16 a[210:211], v66 offset:37056
  ds_read_b64_tr_b16 a[212:213], v66 offset:39936
  ds_read_b64_tr_b16 a[214:215], v66 offset:40128
  ds_read_b64_tr_b16 a[216:217], v66 offset:43008
  ds_read_b64_tr_b16 a[218:219], v66 offset:43200
  ds_read_b64_tr_b16 a[220:221], v66 offset:46080
  ds_read_b64_tr_b16 a[222:223], v66 offset:46272
  ds_read_b64_tr_b16 a[224:225], v66 offset:49152
  ds_read_b64_tr_b16 a[226:227], v66 offset:49344
  ds_read_b64_tr_b16 a[228:229], v66 offset:52224
  ds_read_b64_tr_b16 a[230:231], v66 offset:52416
  ds_read_b64_tr_b16 a[232:233], v66 offset:55296
  ds_read_b64_tr_b16 a[234:235], v66 offset:55488
  ds_read_b64_tr_b16 a[236:237], v66 offset:58368
  ds_read_b64_tr_b16 a[238:239], v66 offset:58560
  ds_read_b64_tr_b16 a[240:241], v67 offset:0
  ds_read_b64_tr_b16 a[242:243], v67 offset:192
  ds_read_b64_tr_b16 a[244:245], v67 offset:3072
  ds_read_b64_tr_b16 a[246:247], v67 offset:3264
  ds_read_b64_tr_b16 a[248:249], v67 offset:6144
  ds_read_b64_tr_b16 a[250:251], v67 offset:6336
  ds_read_b64_tr_b16 a[252:253], v67 offset:9216
  ds_read_b64_tr_b16 a[254:255], v67 offset:9408
  ds_read_b64_tr_b16 v[192:193], v67 offset:12288
  ds_read_b64_tr_b16 v[194:195], v67 offset:12480
  ds_read_b64_tr_b16 v[196:197], v67 offset:15360
  ds_read_b64_tr_b16 v[198:199], v67 offset:15552
  ds_read_b64_tr_b16 v[200:201], v67 offset:18432
  ds_read_b64_tr_b16 v[202:203], v67 offset:18624
  ds_read_b64_tr_b16 v[204:205], v67 offset:21504
  ds_read_b64_tr_b16 v[206:207], v67 offset:21696
  ds_read_b64_tr_b16 v[208:209], v67 offset:24576
  ds_read_b64_tr_b16 v[210:211], v67 offset:24768
  ds_read_b64_tr_b16 v[212:213], v67 offset:27648
  ds_read_b64_tr_b16 v[214:215], v67 offset:27840
  ds_read_b64_tr_b16 v[216:217], v67 offset:30720
  ds_read_b64_tr_b16 v[218:219], v67 offset:30912
  ds_read_b64_tr_b16 v[220:221], v67 offset:33792
  ds_read_b64_tr_b16 v[222:223], v67 offset:33984
  ds_read_b64_tr_b16 v[224:225], v67 offset:36864
  ds_read_b64_tr_b16 v[226:227], v67 offset:37056
  ds_read_b64_tr_b16 v[228:229], v67 offset:39936
  ds_read_b64_tr_b16 v[230:231], v67 offset:40128
  ds_read_b64_tr_b16 v[232:233], v67 offset:43008
  ds_read_b64_tr_b16 v[234:235], v67 offset:43200
  ds_read_b64_tr_b16 v[236:237], v67 offset:46080
  ds_read_b64_tr_b16 v[238:239], v67 offset:46272
  ds_read_b64_tr_b16 v[240:241], v67 offset:49152
  ds_read_b64_tr_b16 v[242:243], v67 offset:49344
  ds_read_b64_tr_b16 v[244:245], v67 offset:52224
  ds_read_b64_tr_b16 v[246:247], v67 offset:52416
  ds_read_b64_tr_b16 v[248:249], v67 offset:55296
  ds_read_b64_tr_b16 v[250:251], v67 offset:55488
  ds_read_b64_tr_b16 v[252:253], v67 offset:58368
  ds_read_b64_tr_b16 v[254:255], v67 offset:58560
  s_branch w3_13
w3_12:
  ds_read_b128 a[160:163], v68 offset:0
  ds_read_b128 a[164:167], v68 offset:1024
  ds_read_b128 a[168:171], v68 offset:2048
  ds_read_b128 a[172:175], v68 offset:3072
  ds_read_b128 a[176:179], v68 offset:4096
  ds_read_b128 a[180:183], v68 offset:5120
  ds_read_b128 a[184:187], v68 offset:6144
  ds_read_b128 a[188:191], v68 offset:7168
  ds_read_b128 a[192:195], v68 offset:8192
  ds_read_b128 a[196:199], v68 offset:9216
  ds_read_b128 a[200:203], v68 offset:10240
  ds_read_b128 a[204:207], v68 offset:11264
  ds_read_b128 a[208:211], v68 offset:12288
  ds_read_b128 a[212:215], v68 offset:13312
  ds_read_b128 a[216:219], v68 offset:14336
  ds_read_b128 a[220:223], v68 offset:15360
  ds_read_b128 a[224:227], v68 offset:16384
  ds_read_b128 a[228:231], v68 offset:17408
  ds_read_b128 a[232:235], v68 offset:18432
  ds_read_b128 a[236:239], v68 offset:19456
  ds_read_b128 a[240:243], v68 offset:20480
  ds_read_b128 a[244:247], v68 offset:21504
  ds_read_b128 a[248:251], v68 offset:22528
  ds_read_b128 a[252:255], v68 offset:23552
  ds_read_b128 v[192:195], v68 offset:24576
  ds_read_b128 v[196:199], v68 offset:25600
  ds_read_b128 v[200:203], v68 offset:26624
  ds_read_b128 v[204:207], v68 offset:27648
  ds_read_b128 v[208:211], v68 offset:28672
  ds_read_b128 v[212:215], v68 offset:29696
  ds_read_b128 v[216:219], v68 offset:30720
  ds_read_b128 v[220:223], v68 offset:31744
  ds_read_b128 v[224:227], v68 offset:32768
  ds_read_b128 v[228:231], v68 offset:33792
  ds_read_b128 v[232:235], v68 offset:34816
  ds_read_b128 v[236:239], v68 offset:35840
  ds_read_b128 v[240:243], v68 offset:36864
  ds_read_b128 v[244:247], v68 offset:37888
  ds_read_b128 v[248:251], v68 offset:38912
  ds_read_b128 v[252:255], v68 offset:39936
w3_13:
  s_waitcnt lgkmcnt(0)
  s_barrier
  v_and_b32 v72, 7, v1
  v_mul_u32_u24 v72, 1280, v72
  v_lshrrev_b32 v73, 3, v1
  v_lshl_add_u32 v72, v73, 4, v72
  s_mul_i32 s21, s20, 3
  s_min_u32 s21, s21, 7
  s_lshl_b32 s22, s21, 7
  s_lshl_b32 s21, s21, 10
  s_add_u32 m0, s21, 0
  s_add_u32 s23, s22, 0
  buffer_load_dwordx4 v72, s[36:39], s23 offen lds
  s_add_u32 m0, s21, 1024
  s_add_u32 s23, s22, 128
  buffer_load_dwordx4 v72, s[36:39], s23 offen lds
  s_add_u32 m0, s21, 2048
  s_add_u32 s23, s22, 256
  buffer_load_dwordx4 v72, s[36:39], s23 offen lds
  v_mov_b32 v76, 0x3f803f80
  v_mov_b32 v77, 0x3f803f80
  v_mov_b32 v78, 0x3f803f80
  v_mov_b32 v79, 0x3f803f80
  v_mov_b32 v80, 0x3f003f00
  v_mov_b32 v81, 0x3f003f00
  ds_write_b128 v23, v[76:79] offset:46080
  ds_write_b128 v23, v[76:79] offset:62464
  ds_write_b64 v23, v[80:81] offset:13568
  s_waitcnt vmcnt(0)
  s_add_u32 s12, s48, 170983424
  s_addc_u32 s13, s49, 0
  s_mov_b32 s14, 96768
  s_mov_b32 s15, 0x00020000
  s_mov_b32 s16, s48
  s_mov_b32 s17, s49
  s_mov_b32 s18, 167772160
  s_mov_b32 s19, 0x00020000
  s_lshl_b32 s76, s50, 9
  s_and_b32 s21, s51, 12
  s_add_u32 s76, s76, s21
  s_add_u32 s76, s76, 88576
  s_cmp_lg_u32 s20, 0
  s_cbranch_scc1 fm_15
  v_lshlrev_b32 v67, 2, v1
  s_bfe_u32 s82, s50, 0x10001
  s_lshl_b32 s82, s82, 5
  s_lshr_b32 s21, s50, 2
  s_add_u32 s82, s82, s21
  s_mov_b32 s101, 0
  s_mov_b32 s83, 0
  s_branch fm_16
fm_14:
  s_sleep 8
fm_16:
  buffer_load_dword v66, v67, s[32:35], 0 offen sc1
  buffer_load_dword v42, v41, s[12:15], s76 offen sc1
  s_add_u32 s101, s101, 1
  s_cmp_gt_u32 s101, 131072
  s_cbranch_scc1 end0
  s_waitcnt vmcnt(0)
  s_mov_b32 s84, s83
  v_readlane_b32 s83, v66, 19
  s_cmp_eq_u32 s83, 0
  s_cbranch_scc1 fm_14
  s_cmp_eq_u32 s84, 0
  s_cbranch_scc1 fm_16
  v_readlane_b32 s22, v66, 0
  v_readlane_b32 s23, v66, 32
  s_add_u32 s22, s22, s23
  v_readlane_b32 s23, v66, 1
  s_add_u32 s22, s22, s23
  v_readlane_b32 s23, v66, 33
  s_add_u32 s22, s22, s23
  v_readlane_b32 s23, v66, 2
  s_add_u32 s22, s22, s23
  v_readlane_b32 s23, v66, 34
  s_add_u32 s22, s22, s23
  v_readlane_b32 s23, v66, 3
  s_add_u32 s22, s22, s23
  v_readlane_b32 s23, v66, 35
  s_add_u32 s22, s22, s23
  v_readlane_b32 s21, v66, 16
  s_mov_b32 s23, s83
  v_cmp_gt_u32 vcc, 2, v42
  s_cmp_ge_u32 s22, 256
  s_cselect_b32 s23, s23, 0
  s_cmp_ge_u32 s21, 128
  s_cselect_b32 s23, s23, 0
  s_cbranch_vccnz fm_14
  s_cmp_eq_u32 s23, 0
  s_cbranch_scc1 fm_14
  v_readlane_b32 s21, v66, s82
  v_cmp_ne_u32 vcc, 32, v66
  s_cmp_ge_u32 s21, 32
  s_cselect_b32 s84, 1, 0
  s_andn2_b32 s53, s84, s53
  s_and_b32 s21, vcc_lo, 15
  s_and_b32 s22, vcc_hi, 15
  s_or_b32 s21, s21, s22
  v_mov_b32 v76, s23
  v_mov_b32 v77, s53
  v_mov_b32 v78, s21
  ds_write_b96 v23, v[76:78] offset:13824
fm_15:
  s_waitcnt lgkmcnt(0)
  s_barrier
  ds_read_b96 v[76:78], v23 offset:13824
  s_lshl_b32 s70, s50, 4
  s_add_u32 s79, s70, s55
  s_add_u32 s70, s70, s51
  s_lshl_b32 s70, s70, 14
  s_lshl_b32 s79, s79, 14
  s_lshl_b32 s21, s56, 11
  s_add_u32 s79, s79, s21
  s_lshl_b32 s72, s50, 16
  s_lshl_b32 s21, s60, 10
  s_add_u32 s72, s72, s21
  s_add_u32 s72, s72, 134217728
  s_mov_b32 s74, 32768
  s_waitcnt lgkmcnt(0)
  v_readfirstlane_b32 s21, v76
  s_sub_u32 s21, s21, 1
  s_lshl_b32 s21, s21, 13
  s_add_u32 s73, s70, s21
  s_add_u32 s70, s73, 4096
  s_add_u32 s72, s72, s21
  s_xor_b32 s21, s21, 8192
  s_add_u32 s79, s79, s21
  s_cmp_lg_u32 s20, 3
  s_cbranch_scc1 pd_18
  s_add_u32 m0, s74, 0
  s_add_u32 s21, s79, 0
  buffer_load_dwordx4 v4, s[16:19], s21 offen offset:0 sc1 lds
  s_add_u32 m0, s74, 0
  s_add_u32 s21, s79, 0
  buffer_load_dwordx4 v4, s[16:19], s21 offen offset:1024 sc1 lds
  s_add_u32 m0, s74, 2048
  s_add_u32 s21, s79, 65536
  buffer_load_dwordx4 v4, s[16:19], s21 offen offset:0 sc1 lds
  s_add_u32 m0, s74, 10240
  s_nop 0
  buffer_load_dwordx4 v4, s[16:19], s73 offen offset:0 sc1 lds
  s_add_u32 m0, s74, 10240
  s_nop 0
  buffer_load_dwordx4 v4, s[16:19], s73 offen offset:1024 sc1 lds
  s_add_u32 m0, s74, 10240
  s_nop 0
  buffer_load_dwordx4 v4, s[16:19], s73 offen offset:2048 sc1 lds
  s_add_u32 m0, s74, 8192
  s_add_u32 s21, s72, 0
  buffer_load_dwordx4 v32, s[16:19], s21 offen sc1 lds
  s_add_u32 m0, s74, 9216
  s_add_u32 s21, s72, 32768
  buffer_load_dwordx4 v32, s[16:19], s21 offen sc1 lds
  s_add_u32 m0, s74, 2048
  s_add_u32 s21, s79, 65536
  buffer_load_dwordx4 v4, s[16:19], s21 offen offset:1024 sc1 lds
  s_add_u32 m0, s74, 4096
  s_add_u32 s21, s79, 131072
  buffer_load_dwordx4 v4, s[16:19], s21 offen offset:0 sc1 lds
  s_add_u32 m0, s74, 4096
  s_add_u32 s21, s79, 131072
  buffer_load_dwordx4 v4, s[16:19], s21 offen offset:1024 sc1 lds
  s_add_u32 m0, s74, 6144
  s_add_u32 s21, s79, 196608
  buffer_load_dwordx4 v4, s[16:19], s21 offen offset:0 sc1 lds
  s_add_u32 m0, s74, 6144
  s_add_u32 s21, s79, 196608
  buffer_load_dwordx4 v4, s[16:19], s21 offen offset:1024 sc1 lds
  s_xor_b32 s74, s74, 16384
  s_add_u32 s73, s73, 2097152
  s_xor_b32 s73, s73, 8192
  s_add_u32 s79, s79, 2097152
  s_xor_b32 s79, s79, 8192
  s_add_u32 s21, s72, 524288
  s_xor_b32 s72, s72, s21
  s_lshr_b32 s72, s72, 8
  s_and_b32 s72, s72, 8192
  s_xor_b32 s72, s72, s21
  s_add_u32 m0, s74, 9216
  s_add_u32 s21, s72, 32768
  buffer_load_dwordx4 v32, s[16:19], s21 offen sc1 lds
  s_add_u32 m0, s74, 2048
  s_add_u32 s21, s79, 65536
  buffer_load_dwordx4 v4, s[16:19], s21 offen offset:1024 sc1 lds
  s_add_u32 m0, s74, 4096
  s_add_u32 s21, s79, 131072
  buffer_load_dwordx4 v4, s[16:19], s21 offen offset:0 sc1 lds
  s_add_u32 m0, s74, 4096
  s_add_u32 s21, s79, 131072
  buffer_load_dwordx4 v4, s[16:19], s21 offen offset:1024 sc1 lds
  s_add_u32 m0, s74, 6144
  s_add_u32 s21, s79, 196608
  buffer_load_dwordx4 v4, s[16:19], s21 offen offset:0 sc1 lds
  s_add_u32 m0, s74, 6144
  s_add_u32 s21, s79, 196608
  buffer_load_dwordx4 v4, s[16:19], s21 offen offset:1024 sc1 lds
  v_mov_b32 v42, 0
  s_branch pd_19
pd_18:
  s_xor_b32 s74, s74, 16384
  s_add_u32 s73, s73, 2097152
  s_xor_b32 s73, s73, 8192
  s_add_u32 s79, s79, 2097152
  s_xor_b32 s79, s79, 8192
  s_add_u32 s21, s72, 524288
  s_xor_b32 s72, s72, s21
  s_lshr_b32 s72, s72, 8
  s_and_b32 s72, s72, 8192
  s_xor_b32 s72, s72, s21
  s_xor_b32 s74, s74, 16384
  s_add_u32 s73, s73, 2097152
  s_xor_b32 s73, s73, 8192
  s_add_u32 s79, s79, 2097152
  s_xor_b32 s79, s79, 8192
  s_add_u32 s21, s72, 524288
  s_xor_b32 s72, s72, s21
  s_lshr_b32 s72, s72, 8
  s_and_b32 s72, s72, 8192
  s_xor_b32 s72, s72, s21
pd_19:
  s_waitcnt lgkmcnt(0)
  v_readfirstlane_b32 s53, v77
  v_readfirstlane_b32 s21, v78
  s_cmp_eq_u32 s21, 0
  s_cbranch_scc1 fm_17
  s_cmp_eq_u32 s20, 3
  s_cbranch_scc1 ar_21
  s_mov_b64 exec, s[64:65]
  s_cmp_eq_u32 s20, 2
  s_cbranch_scc1 ar_20
  s_mov_b32 s21, 0
  buffer_store_dwordx2 v[28:29], v8, s[8:11], s21 offen sc1
  s_mov_b32 s21, 122880
  buffer_store_dwordx2 v[28:29], v8, s[8:11], s21 offen sc1
  s_mov_b32 s21, 245760
  buffer_store_dwordx2 v[28:29], v8, s[8:11], s21 offen sc1
  s_mov_b32 s21, 368640
  buffer_store_dwordx2 v[28:29], v8, s[8:11], s21 offen sc1
  s_branch ar_22
ar_20:
  s_mov_b32 s21, 0
  buffer_store_dword v28, v8, s[8:11], s21 offen sc1
  buffer_store_dword v28, v8, s[8:11], s21 offen offset:128 sc1
  s_mov_b32 s21, 122880
  buffer_store_dword v28, v8, s[8:11], s21 offen sc1
  buffer_store_dword v28, v8, s[8:11], s21 offen offset:128 sc1
  s_mov_b32 s21, 245760
  buffer_store_dword v28, v8, s[8:11], s21 offen sc1
  buffer_store_dword v28, v8, s[8:11], s21 offen offset:128 sc1
  s_mov_b32 s21, 368640
  buffer_store_dword v28, v8, s[8:11], s21 offen sc1
  buffer_store_dword v28, v8, s[8:11], s21 offen offset:128 sc1
ar_22:
  s_cmp_eq_u32 s78, 0
  s_cbranch_scc1 ar_23
  s_mov_b64 exec, s[62:63]
  s_add_u32 s21, s77, 0
  buffer_store_dword v28, v17, s[8:11], s21 offen sc1
  s_add_u32 s21, s77, 122880
  buffer_store_dword v28, v17, s[8:11], s21 offen sc1
  s_add_u32 s21, s77, 245760
  buffer_store_dword v28, v17, s[8:11], s21 offen sc1
  s_add_u32 s21, s77, 368640
  buffer_store_dword v28, v17, s[8:11], s21 offen sc1
  s_branch ar_23
ar_21:
  s_mov_b64 exec, s[66:67]
  s_mov_b32 s21, 0
  buffer_store_dwordx4 v[28:31], v15, s[4:7], s21 offen sc1
  s_mov_b32 s21, 524288
  buffer_store_dwordx4 v[28:31], v15, s[4:7], s21 offen sc1
  s_mov_b32 s21, 8192
  buffer_store_dwordx4 v[28:31], v15, s[4:7], s21 offen sc1
  s_mov_b32 s21, 532480
  buffer_store_dwordx4 v[28:31], v15, s[4:7], s21 offen sc1
ar_23:
  s_mov_b64 exec, -1
  s_waitcnt vmcnt(0)
  s_barrier
  s_mov_b32 s21, 100
  s_cmp_lg_u32 s20, 0
  s_cbranch_scc1 af_24
  v_mov_b32 v80, 0
  v_mov_b32 v81, 1
  s_mov_b64 exec, 1
  buffer_atomic_add v81, v80, s[32:35], s21 offen sc1
  s_mov_b64 exec, -1
  s_nop 1
af_24:
  s_cmp_lg_u32 s20, 0
  s_cbranch_scc1 wf_26
  v_mov_b32 v80, 0
  s_mov_b32 s101, 0
wf_25:
  buffer_load_dword v81, v80, s[32:35], s21 offen sc1
  s_add_u32 s101, s101, 1
  s_cmp_gt_u32 s101, 131072
  s_cbranch_scc1 end0
  s_waitcnt vmcnt(0)
  v_readfirstlane_b32 s100, v81
  s_cmp_ge_u32 s100, 128
  s_cbranch_scc1 wf_26
  s_sleep 8
  s_branch wf_25
wf_26:
  s_barrier
fm_17:
  v_add_u32 v76, -1, v76
  v_lshlrev_b32 v76, 13, v76
  v_add_u32 v15, v15, v76
  v_add_u32 v16, v16, v76
  s_mov_b32 s75, s77
  s_lshl_b32 s77, s58, 7
  s_lshl_b32 s21, s56, 3
  s_add_u32 s77, s77, s21
  s_add_u32 s77, s77, 18432
  s_mov_b32 s80, 0x53800000
  s_mov_b32 s52, 0
  s_mov_b32 s81, 0
  s_waitcnt vmcnt(0)
  s_barrier
  ds_read_b128 v[144:147], v18
  ds_read_b128 v[148:151], v18 offset:1024
  ds_read_b128 v[152:155], v19
  ds_read_b128 v[112:115], v20
  ds_read_b64 v[116:117], v21
  v_xor_b32 v18, 16384, v18
  v_xor_b32 v19, 16384, v19
  v_xor_b32 v20, 16384, v20
  v_xor_b32 v21, 16384, v21
  v_mov_b32 v88, 0
  v_mov_b32 v89, 0
  v_mov_b32 v90, 0
  v_mov_b32 v91, 0
  v_mov_b32 v92, 0
  v_mov_b32 v93, 0
  v_mov_b32 v94, 0
  v_mov_b32 v95, 0
  v_mov_b32 v96, 0
  v_mov_b32 v97, 0
  v_mov_b32 v98, 0
  v_mov_b32 v99, 0
  v_mov_b32 v100, 0
  v_mov_b32 v101, 0
  v_mov_b32 v102, 0
  v_mov_b32 v103, 0
  v_mov_b32 v110, 0
  v_mov_b32 v111, 0
  v_mov_b32 v118, 0
  v_mov_b32 v119, 0
  v_mov_b32 v142, 0
  v_mov_b32 v143, 0
  v_mov_b32 v162, 0
  v_mov_b32 v163, 0
  s_and_b32 s21, s52, 3
  s_mul_i32 s56, s21, 122880
  s_add_u32 s21, s52, 1
  s_and_b32 s21, s21, 3
  s_mul_i32 s55, s21, 122880
  s_add_u32 s55, s55, s75
  s_add_u32 s21, s52, 2
  s_and_b32 s21, s21, 3
  s_mul_i32 s57, s21, 122880
  s_add_u32 s21, s52, 3
  s_and_b32 s21, s21, 3
  s_mul_i32 s59, s21, 122880
  s_add_u32 s59, s59, s75
  s_bfe_u32 s61, s52, 0x10001
  s_and_b32 s21, s52, 1
  s_lshl_b32 s60, s21, 19
  s_mov_b32 s58, s55
  s_waitcnt lgkmcnt(0)
  s_mov_b32 s90, 0x40000000
  s_lshl_b32 s21, s53, 2
  s_add_u32 s21, s21, s20
  s_cmp_eq_u32 s21, 0
  s_cbranch_scc1 E_27
  s_cmp_eq_u32 s21, 4
  s_cbranch_scc1 E_28
  s_cmp_eq_u32 s21, 1
  s_cbranch_scc1 E_29
  s_cmp_eq_u32 s21, 5
  s_cbranch_scc1 E_30
  s_cmp_eq_u32 s21, 2
  s_cbranch_scc1 E_31
  s_cmp_eq_u32 s21, 6
  s_cbranch_scc1 E_32
  s_cmp_eq_u32 s21, 3
  s_cbranch_scc1 E_33
  s_cmp_eq_u32 s21, 7
  s_cbranch_scc1 E_34
  s_branch end0
E_28:
  v_add_u32 v190, 0, v4
  ds_read_b128 v[48:51], v4 offset:0
  ds_read_b128 v[52:55], v4 offset:1024
  ds_read_b128 v[56:59], v4 offset:2048
  s_waitcnt lgkmcnt(0)
  s_branch mo_40
  .p2align 3
top_35:
  s_waitcnt vmcnt(2)
  ds_write_b128 v190, v[48:51] offset:0
  v_cmp_eq_u32 s[22:23], -1, v48
  s_waitcnt vmcnt(1)
  ds_write_b128 v190, v[52:55] offset:1024
  v_cmp_eq_u32 s[98:99], -1, v52
  s_waitcnt vmcnt(0)
  ds_write_b128 v190, v[56:59] offset:2048
  v_cmp_eq_u32 s[100:101], -1, v56
  s_or_b64 vcc, s[22:23], s[98:99]
  s_or_b64 vcc, vcc, s[100:101]
  s_cbranch_scc1 mr_36
mo_40:
  s_waitcnt lgkmcnt(0)
  s_barrier
  ds_read_b128 v[60:63], v4 offset:3072
  ds_read_b128 v[64:67], v4 offset:4096
  v_smfmac_f32_16x16x64_bf16 v[92:95], v[48:51], a[240:247], v22
  ds_read_b128 v[68:71], v4 offset:5120
  v_smfmac_f32_16x16x64_bf16 v[88:91], v[48:51], a[160:167], v22
  ds_read_b128 v[72:75], v4 offset:6144
  v_smfmac_f32_16x16x64_bf16 v[92:95], v[52:55], a[248:255], v22
  ds_read_b128 v[76:79], v4 offset:7168
  v_smfmac_f32_16x16x64_bf16 v[88:91], v[52:55], a[168:175], v22
  ds_read_b128 v[80:83], v4 offset:8192
  v_smfmac_f32_16x16x64_bf16 v[92:95], v[56:59], v[192:199], v22
  ds_read_b128 v[84:87], v4 offset:9216
  v_smfmac_f32_16x16x64_bf16 v[88:91], v[56:59], a[176:183], v22
  s_waitcnt lgkmcnt(6)
  v_smfmac_f32_16x16x64_bf16 v[92:95], v[60:63], v[200:207], v22
  v_smfmac_f32_16x16x64_bf16 v[88:91], v[60:63], a[184:191], v22
  s_waitcnt lgkmcnt(5)
  v_smfmac_f32_16x16x64_bf16 v[92:95], v[64:67], v[208:215], v22
  s_waitcnt lgkmcnt(4)
  v_smfmac_f32_16x16x64_bf16 v[92:95], v[68:71], v[216:223], v22
  s_waitcnt lgkmcnt(3)
  v_smfmac_f32_16x16x64_bf16 v[92:95], v[72:75], v[224:231], v22
  s_waitcnt lgkmcnt(2)
  v_smfmac_f32_16x16x64_bf16 v[92:95], v[76:79], v[232:239], v22
  s_waitcnt lgkmcnt(1)
  v_smfmac_f32_16x16x64_bf16 v[92:95], v[80:83], v[240:247], v22
  s_waitcnt lgkmcnt(0)
  v_smfmac_f32_16x16x64_bf16 v[92:95], v[84:87], v[248:255], v22
  v_smfmac_f32_16x16x64_bf16 v[88:91], v[64:67], a[192:199], v22
  v_smfmac_f32_16x16x64_bf16 v[88:91], v[68:71], a[200:207], v22
  v_smfmac_f32_16x16x64_bf16 v[88:91], v[72:75], a[208:215], v22
  v_permlane32_swap_b32 v92, v93
  v_smfmac_f32_16x16x64_bf16 v[88:91], v[76:79], a[216:223], v22
  v_permlane32_swap_b32 v94, v95
  v_smfmac_f32_16x16x64_bf16 v[88:91], v[80:83], a[224:231], v22
  v_permlane32_swap_b32 v93, v92
  v_smfmac_f32_16x16x64_bf16 v[88:91], v[84:87], a[232:239], v22
  v_permlane32_swap_b32 v95, v94
  v_pk_mul_f32 v[120:121], v[92:93], v[24:25] op_sel:[1,0] op_sel_hi:[0,1]
  v_pk_mul_f32 v[122:123], v[94:95], v[24:25] op_sel:[1,0] op_sel_hi:[0,1]
  s_nop 4
  v_pk_fma_f32 v[88:89], v[88:89], v[24:25], v[120:121]
  v_pk_fma_f32 v[90:91], v[90:91], v[24:25], v[122:123]
  v_cvt_pk_bf16_f32 v120, v88, v89
  v_cvt_pk_bf16_f32 v121, v90, v91
  ds_write_b64 v6, v[120:121]
  v_cmp_u_f32 vcc, v88, v89
  v_cmp_u_f32 s[22:23], v90, v91
  s_nop 1
  s_or_b64 vcc, vcc, s[22:23]
  s_cbranch_vccnz mn_37
mk_38:
  s_waitcnt lgkmcnt(0)
  s_barrier
  ds_read_b64_tr_b16 v[104:105], v7 offset:0
  ds_read_b64_tr_b16 v[106:107], v7 offset:768
  ds_read_b64_tr_b16 v[108:109], v7 offset:1536
  ds_read_b64 v[140:141], v11
  s_cmp_eq_u32 s52, 63
  s_cbranch_scc1 last_39
  s_waitcnt lgkmcnt(2)
  v_mfma_f32_16x16x32_bf16 v[120:123], v[112:115], v[104:107], 0
  s_waitcnt lgkmcnt(1)
  v_mfma_f32_16x16x32_bf16 v[120:123], v[116:119], v[108:111], v[120:123]
  s_mov_b64 exec, s[64:65]
  s_nop 6
  v_cvt_pk_f16_f32 v120, v120, v121
  v_cvt_pk_f16_f32 v121, v122, v123
  buffer_store_dwordx2 v[120:121], v8, s[8:11], s56 offen
  s_mov_b64 exec, -1
  s_sleep 3
  s_nop 1
  v_smfmac_f32_16x16x64_bf16 v[96:99], v[48:51], a[0:7], v22
  v_smfmac_f32_16x16x64_bf16 v[100:103], v[48:51], a[80:87], v22
  v_smfmac_f32_16x16x64_bf16 v[96:99], v[52:55], a[8:15], v22
  v_smfmac_f32_16x16x64_bf16 v[100:103], v[52:55], a[88:95], v22
  v_smfmac_f32_16x16x64_bf16 v[96:99], v[56:59], a[16:23], v22
  v_smfmac_f32_16x16x64_bf16 v[100:103], v[56:59], a[96:103], v22
  v_smfmac_f32_16x16x64_bf16 v[96:99], v[60:63], a[24:31], v22
  v_smfmac_f32_16x16x64_bf16 v[96:99], v[64:67], a[32:39], v22
  v_smfmac_f32_16x16x64_bf16 v[96:99], v[68:71], a[40:47], v22
  v_smfmac_f32_16x16x64_bf16 v[96:99], v[72:75], a[48:55], v22
  v_smfmac_f32_16x16x64_bf16 v[96:99], v[76:79], a[56:63], v22
  buffer_load_dwordx4 v[124:127], v9, s[8:11], s56 offen sc1
  v_smfmac_f32_16x16x64_bf16 v[96:99], v[80:83], a[64:71], v22
  buffer_load_dwordx4 v[128:131], v9, s[8:11], s56 offen offset:1024 sc1
  v_smfmac_f32_16x16x64_bf16 v[96:99], v[84:87], a[72:79], v22
  buffer_load_dwordx4 v[132:135], v10, s[8:11], s56 offen sc1
  v_smfmac_f32_16x16x64_bf16 v[100:103], v[60:63], a[104:111], v22
  v_smfmac_f32_16x16x64_bf16 v[100:103], v[64:67], a[112:119], v22
  v_smfmac_f32_16x16x64_bf16 v[100:103], v[68:71], a[120:127], v22
  v_smfmac_f32_16x16x64_bf16 v[100:103], v[72:75], a[128:135], v22
  v_cvt_pk_bf16_f32 v136, v96, v97
  v_smfmac_f32_16x16x64_bf16 v[100:103], v[76:79], a[136:143], v22
  v_cvt_pk_bf16_f32 v137, v98, v99
  v_smfmac_f32_16x16x64_bf16 v[100:103], v[80:83], a[144:151], v22
  v_smfmac_f32_16x16x64_bf16 v[100:103], v[84:87], a[152:159], v22
  s_waitcnt vmcnt(2)
  v_pk_add_f16 v172, v124, v126
  v_pk_add_f16 v173, v125, v127
  s_waitcnt vmcnt(1)
  v_pk_add_f16 v174, v128, v130
  v_pk_add_f16 v175, v129, v131
  v_fma_mix_f32 v166, v172, 1.0, v174 op_sel:[0,0,0] op_sel_hi:[1,0,1]
  v_fma_mix_f32 v168, v173, 1.0, v175 op_sel:[0,0,0] op_sel_hi:[1,0,1]
  s_waitcnt vmcnt(0)
  v_pk_add_f16 v176, v132, v133
  v_pk_add_f16 v177, v134, v135
  v_fma_mix_f32 v170, v176, 1.0, v177 op_sel:[0,0,0] op_sel_hi:[1,0,1]
  v_fma_mix_f32 v167, v172, 1.0, v174 op_sel:[1,0,1] op_sel_hi:[1,0,1]
  v_cmp_u_f32 vcc, v166, v170
  v_fma_mix_f32 v169, v173, 1.0, v175 op_sel:[1,0,1] op_sel_hi:[1,0,1]
  v_fma_mix_f32 v171, v176, 1.0, v177 op_sel:[1,0,1] op_sel_hi:[1,0,1]
  v_cvt_pk_bf16_f32 v138, v100, v101
  s_cbranch_vccnz sr_41
sj_42:
ex_43:
  v_exp_f32 v172, v166
  v_exp_f32 v173, v167
  v_exp_f32 v174, v168
  v_cvt_pk_bf16_f32 v156, v172, v173
  v_exp_f32 v175, v169
  v_exp_f32 v176, v170
  v_cvt_pk_bf16_f32 v157, v174, v175
  v_mov_b32_dpp v158, v156 row_ror:8 row_mask:0xf bank_mask:0xf
  v_exp_f32 v177, v171
  v_mov_b32_dpp v159, v157 row_ror:8 row_mask:0xf bank_mask:0xf
  v_cvt_pk_bf16_f32 v160, v176, v177
  v_cvt_pk_bf16_f32 v139, v102, v103
  v_mfma_f32_16x16x32_bf16 v[178:181], v[152:155], v[156:159], 0
  s_waitcnt lgkmcnt(0)
  v_mov_b32_dpp v161, v160 row_ror:8 row_mask:0xf bank_mask:0xf
  v_mfma_f32_16x16x32_bf16 v[182:185], v[144:147], v[156:159], 0
  s_nop 0
  v_mfma_f32_16x16x32_bf16 v[178:181], v[140:143], v[160:163], v[178:181]
  v_mfma_f32_16x16x32_bf16 v[182:185], v[136:139], v[160:163], v[182:185]
  v_mfma_f32_16x16x32_bf16 v[186:189], v[148:151], v[156:159], 0
  v_mfma_f32_16x16x32_bf16 v[186:189], v[138:141], v[160:163], v[186:189]
  s_mov_b64 exec, s[62:63]
  v_rcp_f32 v164, v180
  s_nop 0
  v_pk_mul_f32 v[178:179], v[178:179], v[164:165] op_sel_hi:[1,0]
  v_pk_mul_f32 v[182:183], v[182:183], v[164:165] op_sel_hi:[1,0]
  v_pk_mul_f32 v[184:185], v[184:185], v[164:165] op_sel_hi:[1,0]
  v_cvt_pk_f16_f32 v64, v178, v179
  v_cvt_pk_f16_f32 v60, v182, v183
  v_pk_mul_f32 v[186:187], v[186:187], v[164:165] op_sel_hi:[1,0]
  v_pk_mul_f32 v[188:189], v[188:189], v[164:165] op_sel_hi:[1,0]
  v_cvt_pk_f16_f32 v61, v184, v185
  v_cvt_pk_f16_f32 v62, v186, v187
  v_cvt_pk_f16_f32 v63, v188, v189
  ds_write_b128 v13, v[60:63]
  ds_write_b32 v14, v64
  v_add_f32 v165, v164, v180
  v_cmp_ngt_f32 vcc, s80, v165
  s_mov_b64 exec, -1
  s_nop 0
  s_cbranch_vccnz fx_44
fk_45:
  s_waitcnt lgkmcnt(0)
  s_barrier
  s_add_u32 m0, s74, 9216
  s_add_u32 s21, s72, 32768
  buffer_load_dwordx4 v32, s[16:19], s21 offen sc1 lds
  s_add_u32 m0, s74, 4096
  s_add_u32 s21, s79, 131072
  buffer_load_dwordx4 v4, s[16:19], s21 offen offset:1024 sc1 lds
  s_xor_b32 s74, s74, 16384
  s_add_u32 s73, s73, 2097152
  s_xor_b32 s73, s73, 8192
  s_add_u32 s79, s79, 2097152
  s_xor_b32 s79, s79, 8192
  s_add_u32 s21, s72, 524288
  s_xor_b32 s72, s72, s21
  s_lshr_b32 s72, s72, 8
  s_and_b32 s72, s72, 8192
  s_xor_b32 s72, s72, s21
  s_nop 15
  s_nop 3
  v_permlane32_swap_b32 v96, v100
  v_permlane32_swap_b32 v97, v101
  v_permlane32_swap_b32 v98, v102
  v_permlane32_swap_b32 v99, v103
  v_pk_add_f32 v[96:97], v[96:97], v[100:101]
  v_pk_add_f32 v[98:99], v[98:99], v[102:103]
  v_cvt_pk_bf16_f32 v182, v96, v97
  v_cvt_pk_bf16_f32 v183, v98, v99
  v_min_u32 v182, -2, v182
  ds_write_b64 v26, v[182:183]
  ds_read_b128 v[144:147], v18
  ds_read_b128 v[148:151], v18 offset:1024
  ds_read_b128 v[152:155], v19
  ds_read_b128 v[112:115], v20
  ds_read_b64 v[116:117], v21
  v_xor_b32 v18, 16384, v18
  v_xor_b32 v19, 16384, v19
  v_xor_b32 v20, 16384, v20
  v_xor_b32 v21, 16384, v21
  v_mov_b32 v88, 0
  v_mov_b32 v89, 0
  v_mov_b32 v90, 0
  v_mov_b32 v91, 0
  v_mov_b32 v92, 0
  v_mov_b32 v93, 0
  v_mov_b32 v94, 0
  v_mov_b32 v95, 0
  v_mov_b32 v96, 0
  v_mov_b32 v97, 0
  v_mov_b32 v98, 0
  v_mov_b32 v99, 0
  v_mov_b32 v100, 0
  v_mov_b32 v101, 0
  v_mov_b32 v102, 0
  v_mov_b32 v103, 0
  s_mov_b32 s81, 0
  s_waitcnt lgkmcnt(0)
  s_barrier
  s_mov_b64 exec, s[64:65]
  buffer_store_dwordx2 v[28:29], v8, s[8:11], s57 offen
  s_mov_b64 exec, s[62:63]
  buffer_store_dword v28, v17, s[8:11], s59 offen
  s_mov_b64 exec, -1
  s_sleep 6
  s_nop 3
  buffer_load_dwordx4 v[68:71], v16, s[4:7], s60 offen sc1
  s_sleep 3
  s_nop 1
  buffer_load_dwordx4 v[72:75], v16, s[4:7], s60 offen sc1
  s_mov_b32 s54, 0
pp_47:
  s_waitcnt vmcnt(1)
  v_mfma_f32_16x16x32_f16 v[120:123], v[44:47], v[68:71], 0
  v_bitop3_b32 v27, v68, s61, 1 bitop3:0x28
  v_cmp_ne_u32 vcc, 0, v27
  s_nop 1
  s_cbranch_vccnz p2_49
  s_nop 2
pg_48:
  v_add_f32_dpp v120, v120, v120 row_ror:8 row_mask:0xf bank_mask:0xf
  v_add_f32_dpp v121, v121, v121 row_ror:8 row_mask:0xf bank_mask:0xf
  s_mov_b64 exec, s[62:63]
  v_cvt_pk_bf16_f32 v120, v120, v121
  v_min_u32 v120, -2, v120
  buffer_store_dword v120, v17, s[8:11], s55 offen
  s_mov_b64 exec, -1
nt_46:
  s_barrier
  s_mov_b32 s58, s55
  s_add_u32 s52, s52, 1
  s_and_b32 s21, s52, 3
  s_mul_i32 s56, s21, 122880
  s_add_u32 s21, s52, 1
  s_and_b32 s21, s21, 3
  s_mul_i32 s55, s21, 122880
  s_add_u32 s55, s55, s75
  s_add_u32 s21, s52, 2
  s_and_b32 s21, s21, 3
  s_mul_i32 s57, s21, 122880
  s_add_u32 s21, s52, 3
  s_and_b32 s21, s21, 3
  s_mul_i32 s59, s21, 122880
  s_add_u32 s59, s59, s75
  s_bfe_u32 s61, s52, 0x10001
  s_and_b32 s21, s52, 1
  s_lshl_b32 s60, s21, 19
  s_mov_b32 s54, 0
  s_sleep 3
  s_nop 2
  buffer_load_dwordx4 v[48:51], v190, s[8:11], s58 offen offset:0 sc1
  buffer_load_dwordx4 v[52:55], v190, s[8:11], s58 offen offset:1024 sc1
  buffer_load_dwordx4 v[56:59], v190, s[8:11], s58 offen offset:2048 sc1
  s_branch top_35
mr_36:
  s_mov_b64 exec, s[22:23]
  s_cbranch_execz ms_50
  buffer_load_dwordx4 v[48:51], v190, s[8:11], s58 offen offset:0 sc1
ms_50:
  s_mov_b64 exec, s[98:99]
  s_cbranch_execz ms_51
  buffer_load_dwordx4 v[52:55], v190, s[8:11], s58 offen offset:1024 sc1
ms_51:
  s_mov_b64 exec, s[100:101]
  s_cbranch_execz ms_52
  buffer_load_dwordx4 v[56:59], v190, s[8:11], s58 offen offset:2048 sc1
ms_52:
  s_add_u32 s54, s54, 1
  s_cmp_gt_u32 s54, 131072
  s_cbranch_scc1 end0
  s_waitcnt vmcnt(0)
  s_mov_b64 exec, s[22:23]
  ds_write_b128 v190, v[48:51] offset:0
  v_cmp_eq_u32 s[22:23], -1, v48
  s_mov_b64 exec, s[98:99]
  ds_write_b128 v190, v[52:55] offset:1024
  v_cmp_eq_u32 s[98:99], -1, v52
  s_mov_b64 exec, s[100:101]
  ds_write_b128 v190, v[56:59] offset:2048
  v_cmp_eq_u32 s[100:101], -1, v56
  s_mov_b64 exec, -1
  s_or_b64 vcc, s[22:23], s[98:99]
  s_or_b64 vcc, vcc, s[100:101]
  s_cbranch_scc1 mr_36
  s_branch mo_40
mn_37:
  v_max3_u32 v27, v48, v49, v50
  v_max3_u32 v27, v27, v51, v52
  v_max3_u32 v27, v27, v53, v54
  v_max3_u32 v27, v27, v55, v56
  v_max3_u32 v27, v27, v57, v58
  v_max3_u32 v27, v27, v59, v60
  v_max3_u32 v27, v27, v61, v62
  v_max3_u32 v27, v27, v63, v64
  v_max3_u32 v27, v27, v65, v66
  v_max3_u32 v27, v27, v67, v68
  v_max3_u32 v27, v27, v69, v70
  v_max3_u32 v27, v27, v71, v72
  v_max3_u32 v27, v27, v73, v74
  v_max3_u32 v27, v27, v75, v76
  v_max3_u32 v27, v27, v77, v78
  v_max3_u32 v27, v27, v79, v80
  v_max3_u32 v27, v27, v81, v82
  v_max3_u32 v27, v27, v83, v84
  v_max3_u32 v27, v27, v85, v86
  v_max3_u32 v27, v27, v87, v87
  v_cmp_eq_u32 vcc, -1, v27
  s_cmp_eq_u32 s52, 0
  s_cbranch_scc1 mk_38
  s_cbranch_vccz mk_38
  s_waitcnt lgkmcnt(0)
  s_barrier
  s_nop 7
  v_mov_b32 v88, 0
  v_mov_b32 v89, 0
  v_mov_b32 v90, 0
  v_mov_b32 v91, 0
  v_mov_b32 v92, 0
  v_mov_b32 v93, 0
  v_mov_b32 v94, 0
  v_mov_b32 v95, 0
  v_mov_b32 v96, 0
  v_mov_b32 v97, 0
  v_mov_b32 v98, 0
  v_mov_b32 v99, 0
  v_mov_b32 v100, 0
  v_mov_b32 v101, 0
  v_mov_b32 v102, 0
  v_mov_b32 v103, 0
  s_mov_b64 s[22:23], -1
  s_mov_b64 s[98:99], -1
  s_mov_b64 s[100:101], -1
  s_branch mr_36
sr_41:
  s_mov_b32 s54, 0
sr_53:
  s_mov_b64 exec, vcc
  buffer_load_dwordx4 v[124:127], v9, s[8:11], s56 offen sc1
  buffer_load_dwordx4 v[128:131], v9, s[8:11], s56 offen offset:1024 sc1
  buffer_load_dwordx4 v[132:135], v10, s[8:11], s56 offen sc1
  s_mov_b64 exec, -1
  s_add_u32 s54, s54, 1
  s_cmp_gt_u32 s54, 131072
  s_cbranch_scc1 end0
  s_and_b32 s21, s54, 31
  s_cbranch_scc0 sr_54
  s_waitcnt vmcnt(0)
  v_pk_add_f16 v172, v124, v126
  v_pk_add_f16 v173, v125, v127
  v_pk_add_f16 v174, v128, v130
  v_pk_add_f16 v175, v129, v131
  v_fma_mix_f32 v166, v172, 1.0, v174 op_sel:[0,0,0] op_sel_hi:[1,0,1]
  v_fma_mix_f32 v168, v173, 1.0, v175 op_sel:[0,0,0] op_sel_hi:[1,0,1]
  v_pk_add_f16 v176, v132, v133
  v_pk_add_f16 v177, v134, v135
  v_add_f32 v27, v166, v168
  v_fma_mix_f32 v170, v176, 1.0, v177 op_sel:[0,0,0] op_sel_hi:[1,0,1]
  v_fma_mix_f32 v167, v172, 1.0, v174 op_sel:[1,0,1] op_sel_hi:[1,0,1]
  v_cmp_u_f32 vcc, v27, v170
  v_fma_mix_f32 v169, v173, 1.0, v175 op_sel:[1,0,1] op_sel_hi:[1,0,1]
  v_fma_mix_f32 v171, v176, 1.0, v177 op_sel:[1,0,1] op_sel_hi:[1,0,1]
  s_cbranch_vccnz sr_53
  s_branch sj_42
sr_54:
  s_waitcnt vmcnt(0)
  v_pk_add_f16 v172, v124, v126
  v_pk_add_f16 v173, v125, v127
  v_pk_add_f16 v174, v128, v130
  v_pk_add_f16 v175, v129, v131
  v_fma_mix_f32 v166, v172, 1.0, v174 op_sel:[0,0,0] op_sel_hi:[1,0,1]
  v_fma_mix_f32 v168, v173, 1.0, v175 op_sel:[0,0,0] op_sel_hi:[1,0,1]
  v_pk_add_f16 v176, v132, v133
  v_pk_add_f16 v177, v134, v135
  v_add_f32 v27, v166, v168
  v_fma_mix_f32 v170, v176, 1.0, v177 op_sel:[0,0,0] op_sel_hi:[1,0,1]
  v_fma_mix_f32 v167, v172, 1.0, v174 op_sel:[1,0,1] op_sel_hi:[1,0,1]
  v_cmp_u_f32 vcc, v27, v170
  v_fma_mix_f32 v169, v173, 1.0, v175 op_sel:[1,0,1] op_sel_hi:[1,0,1]
  v_fma_mix_f32 v171, v176, 1.0, v177 op_sel:[1,0,1] op_sel_hi:[1,0,1]
  v_max3_u32 v27, v124, v126, v128
  v_max3_u32 v27, v27, v130, v132
  v_max3_u32 v27, v27, v133, v134
  v_max3_u32 v27, v27, v135, v135
  v_cmp_eq_u32 vcc, -1, v27
  s_nop 1
  s_cbranch_vccnz sr_53
  s_branch sj_42
fx_44:
  s_cmp_eq_u32 s81, 1
  s_cbranch_scc1 fk_45
  s_mov_b32 s81, 1
  v_max3_f32 v164, v166, v167, v168
  v_max3_f32 v165, v169, v170, v171
  v_max_f32 v164, v164, v165
  s_nop 1
  v_max_f32_dpp v164, v164, v164 row_ror:8 row_mask:0xf bank_mask:0xf
  v_mov_b32 v165, v164
  s_nop 1
  v_permlane32_swap_b32 v164, v165
  v_max_f32 v164, v164, v165
  v_mov_b32 v165, v164
  s_nop 1
  v_permlane16_swap_b32 v164, v165
  v_max_f32 v164, v164, v165
  v_sub_f32 v166, v166, v164
  v_sub_f32 v167, v167, v164
  v_sub_f32 v168, v168, v164
  v_sub_f32 v169, v169, v164
  v_sub_f32 v170, v170, v164
  v_sub_f32 v171, v171, v164
  s_branch ex_43
p2_49:
  buffer_load_dwordx4 v[68:71], v16, s[4:7], s60 offen sc1
  s_waitcnt vmcnt(1)
  v_mfma_f32_16x16x32_f16 v[120:123], v[44:47], v[72:75], 0
  v_bitop3_b32 v27, v72, s61, 1 bitop3:0x28
  v_cmp_ne_u32 vcc, 0, v27
  s_nop 1
  s_cbranch_vccz pg_48
  buffer_load_dwordx4 v[72:75], v16, s[4:7], s60 offen sc1
  s_add_u32 s54, s54, 1
  s_cmp_gt_u32 s54, 131072
  s_cbranch_scc1 end0
  s_branch pp_47
last_39:
  v_smfmac_f32_16x16x64_bf16 v[96:99], v[48:51], a[0:7], v22
  v_smfmac_f32_16x16x64_bf16 v[100:103], v[48:51], a[80:87], v22
  v_smfmac_f32_16x16x64_bf16 v[96:99], v[52:55], a[8:15], v22
  v_smfmac_f32_16x16x64_bf16 v[100:103], v[52:55], a[88:95], v22
  v_smfmac_f32_16x16x64_bf16 v[96:99], v[56:59], a[16:23], v22
  v_smfmac_f32_16x16x64_bf16 v[100:103], v[56:59], a[96:103], v22
  v_smfmac_f32_16x16x64_bf16 v[96:99], v[60:63], a[24:31], v22
  v_smfmac_f32_16x16x64_bf16 v[96:99], v[64:67], a[32:39], v22
  v_smfmac_f32_16x16x64_bf16 v[96:99], v[68:71], a[40:47], v22
  v_smfmac_f32_16x16x64_bf16 v[96:99], v[72:75], a[48:55], v22
  v_smfmac_f32_16x16x64_bf16 v[96:99], v[76:79], a[56:63], v22
  v_smfmac_f32_16x16x64_bf16 v[96:99], v[80:83], a[64:71], v22
  v_smfmac_f32_16x16x64_bf16 v[96:99], v[84:87], a[72:79], v22
  v_smfmac_f32_16x16x64_bf16 v[100:103], v[60:63], a[104:111], v22
  v_smfmac_f32_16x16x64_bf16 v[100:103], v[64:67], a[112:119], v22
  v_smfmac_f32_16x16x64_bf16 v[100:103], v[68:71], a[120:127], v22
  v_smfmac_f32_16x16x64_bf16 v[100:103], v[72:75], a[128:135], v22
  v_smfmac_f32_16x16x64_bf16 v[100:103], v[76:79], a[136:143], v22
  v_smfmac_f32_16x16x64_bf16 v[100:103], v[80:83], a[144:151], v22
  v_smfmac_f32_16x16x64_bf16 v[100:103], v[84:87], a[152:159], v22
  s_nop 7
  v_permlane32_swap_b32 v96, v100
  v_permlane32_swap_b32 v97, v101
  v_permlane32_swap_b32 v98, v102
  v_permlane32_swap_b32 v99, v103
  v_pk_add_f32 v[96:97], v[96:97], v[100:101]
  v_pk_add_f32 v[98:99], v[98:99], v[102:103]
  v_cvt_pk_bf16_f32 v182, v96, v97
  v_cvt_pk_bf16_f32 v183, v98, v99
  v_min_u32 v182, -2, v182
  ds_write_b64 v26, v[182:183]
  s_waitcnt lgkmcnt(0)
  s_barrier
  s_branch chain_done
E_30:
  v_add_u32 v190, 3072, v4
  ds_read_b128 v[60:63], v4 offset:3072
  ds_read_b128 v[64:67], v4 offset:4096
  ds_read_b128 v[68:71], v4 offset:5120
  s_waitcnt lgkmcnt(0)
  s_branch mo_60
  .p2align 3
top_55:
  s_waitcnt vmcnt(2)
  ds_write_b128 v190, v[60:63] offset:0
  v_cmp_eq_u32 s[22:23], -1, v60
  s_waitcnt vmcnt(1)
  ds_write_b128 v190, v[64:67] offset:1024
  v_cmp_eq_u32 s[98:99], -1, v64
  s_waitcnt vmcnt(0)
  ds_write_b128 v190, v[68:71] offset:2048
  v_cmp_eq_u32 s[100:101], -1, v68
  s_or_b64 vcc, s[22:23], s[98:99]
  s_or_b64 vcc, vcc, s[100:101]
  s_cbranch_scc1 mr_56
mo_60:
  s_waitcnt lgkmcnt(0)
  s_barrier
  ds_read_b128 v[48:51], v4 offset:0
  ds_read_b128 v[52:55], v4 offset:1024
  v_smfmac_f32_16x16x64_bf16 v[92:95], v[60:63], v[200:207], v22
  ds_read_b128 v[56:59], v4 offset:2048
  v_smfmac_f32_16x16x64_bf16 v[88:91], v[60:63], a[184:191], v22
  ds_read_b128 v[72:75], v4 offset:6144
  v_smfmac_f32_16x16x64_bf16 v[92:95], v[64:67], v[208:215], v22
  ds_read_b128 v[76:79], v4 offset:7168
  v_smfmac_f32_16x16x64_bf16 v[88:91], v[64:67], a[192:199], v22
  ds_read_b128 v[80:83], v4 offset:8192
  v_smfmac_f32_16x16x64_bf16 v[92:95], v[68:71], v[216:223], v22
  ds_read_b128 v[84:87], v4 offset:9216
  v_smfmac_f32_16x16x64_bf16 v[88:91], v[68:71], a[200:207], v22
  s_waitcnt lgkmcnt(6)
  v_smfmac_f32_16x16x64_bf16 v[92:95], v[48:51], a[240:247], v22
  v_smfmac_f32_16x16x64_bf16 v[88:91], v[48:51], a[160:167], v22
  s_waitcnt lgkmcnt(5)
  v_smfmac_f32_16x16x64_bf16 v[92:95], v[52:55], a[248:255], v22
  s_waitcnt lgkmcnt(4)
  v_smfmac_f32_16x16x64_bf16 v[92:95], v[56:59], v[192:199], v22
  s_waitcnt lgkmcnt(3)
  v_smfmac_f32_16x16x64_bf16 v[92:95], v[72:75], v[224:231], v22
  s_waitcnt lgkmcnt(2)
  v_smfmac_f32_16x16x64_bf16 v[92:95], v[76:79], v[232:239], v22
  s_waitcnt lgkmcnt(1)
  v_smfmac_f32_16x16x64_bf16 v[92:95], v[80:83], v[240:247], v22
  s_waitcnt lgkmcnt(0)
  v_smfmac_f32_16x16x64_bf16 v[92:95], v[84:87], v[248:255], v22
  v_smfmac_f32_16x16x64_bf16 v[88:91], v[52:55], a[168:175], v22
  v_smfmac_f32_16x16x64_bf16 v[88:91], v[56:59], a[176:183], v22
  v_smfmac_f32_16x16x64_bf16 v[88:91], v[72:75], a[208:215], v22
  v_permlane32_swap_b32 v92, v93
  v_smfmac_f32_16x16x64_bf16 v[88:91], v[76:79], a[216:223], v22
  v_permlane32_swap_b32 v94, v95
  v_smfmac_f32_16x16x64_bf16 v[88:91], v[80:83], a[224:231], v22
  v_permlane32_swap_b32 v93, v92
  v_smfmac_f32_16x16x64_bf16 v[88:91], v[84:87], a[232:239], v22
  v_permlane32_swap_b32 v95, v94
  v_pk_mul_f32 v[120:121], v[92:93], v[24:25] op_sel:[1,0] op_sel_hi:[0,1]
  v_pk_mul_f32 v[122:123], v[94:95], v[24:25] op_sel:[1,0] op_sel_hi:[0,1]
  s_nop 4
  v_pk_fma_f32 v[88:89], v[88:89], v[24:25], v[120:121]
  v_pk_fma_f32 v[90:91], v[90:91], v[24:25], v[122:123]
  v_cvt_pk_bf16_f32 v120, v88, v89
  v_cvt_pk_bf16_f32 v121, v90, v91
  ds_write_b64 v6, v[120:121]
  v_cmp_u_f32 vcc, v88, v89
  v_cmp_u_f32 s[22:23], v90, v91
  s_nop 1
  s_or_b64 vcc, vcc, s[22:23]
  s_cbranch_vccnz mn_57
mk_58:
  s_waitcnt lgkmcnt(0)
  s_barrier
  ds_read_b64_tr_b16 v[104:105], v7 offset:0
  ds_read_b64_tr_b16 v[106:107], v7 offset:768
  ds_read_b64_tr_b16 v[108:109], v7 offset:1536
  ds_read_b64 v[140:141], v11
  s_cmp_eq_u32 s52, 63
  s_cbranch_scc1 last_59
  s_waitcnt lgkmcnt(2)
  v_mfma_f32_16x16x32_bf16 v[120:123], v[112:115], v[104:107], 0
  s_waitcnt lgkmcnt(1)
  v_mfma_f32_16x16x32_bf16 v[120:123], v[116:119], v[108:111], v[120:123]
  s_mov_b64 exec, s[64:65]
  s_nop 6
  v_cvt_pk_f16_f32 v120, v120, v121
  v_cvt_pk_f16_f32 v121, v122, v123
  buffer_store_dwordx2 v[120:121], v8, s[8:11], s56 offen
  s_mov_b64 exec, -1
  s_sleep 3
  s_nop 1
  v_smfmac_f32_16x16x64_bf16 v[96:99], v[48:51], a[0:7], v22
  v_smfmac_f32_16x16x64_bf16 v[100:103], v[48:51], a[80:87], v22
  v_smfmac_f32_16x16x64_bf16 v[96:99], v[52:55], a[8:15], v22
  v_smfmac_f32_16x16x64_bf16 v[100:103], v[52:55], a[88:95], v22
  v_smfmac_f32_16x16x64_bf16 v[96:99], v[56:59], a[16:23], v22
  v_smfmac_f32_16x16x64_bf16 v[100:103], v[56:59], a[96:103], v22
  v_smfmac_f32_16x16x64_bf16 v[96:99], v[60:63], a[24:31], v22
  v_smfmac_f32_16x16x64_bf16 v[96:99], v[64:67], a[32:39], v22
  v_smfmac_f32_16x16x64_bf16 v[96:99], v[68:71], a[40:47], v22
  v_smfmac_f32_16x16x64_bf16 v[96:99], v[72:75], a[48:55], v22
  v_smfmac_f32_16x16x64_bf16 v[96:99], v[76:79], a[56:63], v22
  buffer_load_dwordx4 v[124:127], v9, s[8:11], s56 offen sc1
  v_smfmac_f32_16x16x64_bf16 v[96:99], v[80:83], a[64:71], v22
  buffer_load_dwordx4 v[128:131], v9, s[8:11], s56 offen offset:1024 sc1
  v_smfmac_f32_16x16x64_bf16 v[96:99], v[84:87], a[72:79], v22
  buffer_load_dwordx4 v[132:135], v10, s[8:11], s56 offen sc1
  v_smfmac_f32_16x16x64_bf16 v[100:103], v[60:63], a[104:111], v22
  v_smfmac_f32_16x16x64_bf16 v[100:103], v[64:67], a[112:119], v22
  v_smfmac_f32_16x16x64_bf16 v[100:103], v[68:71], a[120:127], v22
  v_smfmac_f32_16x16x64_bf16 v[100:103], v[72:75], a[128:135], v22
  v_cvt_pk_bf16_f32 v136, v96, v97
  v_smfmac_f32_16x16x64_bf16 v[100:103], v[76:79], a[136:143], v22
  v_cvt_pk_bf16_f32 v137, v98, v99
  v_smfmac_f32_16x16x64_bf16 v[100:103], v[80:83], a[144:151], v22
  v_smfmac_f32_16x16x64_bf16 v[100:103], v[84:87], a[152:159], v22
  s_waitcnt vmcnt(2)
  v_pk_add_f16 v172, v124, v126
  v_pk_add_f16 v173, v125, v127
  s_waitcnt vmcnt(1)
  v_pk_add_f16 v174, v128, v130
  v_pk_add_f16 v175, v129, v131
  v_fma_mix_f32 v166, v172, 1.0, v174 op_sel:[0,0,0] op_sel_hi:[1,0,1]
  v_fma_mix_f32 v168, v173, 1.0, v175 op_sel:[0,0,0] op_sel_hi:[1,0,1]
  s_waitcnt vmcnt(0)
  v_pk_add_f16 v176, v132, v133
  v_pk_add_f16 v177, v134, v135
  v_fma_mix_f32 v170, v176, 1.0, v177 op_sel:[0,0,0] op_sel_hi:[1,0,1]
  v_fma_mix_f32 v167, v172, 1.0, v174 op_sel:[1,0,1] op_sel_hi:[1,0,1]
  v_cmp_u_f32 vcc, v166, v170
  v_fma_mix_f32 v169, v173, 1.0, v175 op_sel:[1,0,1] op_sel_hi:[1,0,1]
  v_fma_mix_f32 v171, v176, 1.0, v177 op_sel:[1,0,1] op_sel_hi:[1,0,1]
  v_cvt_pk_bf16_f32 v138, v100, v101
  s_cbranch_vccnz sr_61
sj_62:
ex_63:
  v_exp_f32 v172, v166
  v_exp_f32 v173, v167
  v_exp_f32 v174, v168
  v_cvt_pk_bf16_f32 v156, v172, v173
  v_exp_f32 v175, v169
  v_exp_f32 v176, v170
  v_cvt_pk_bf16_f32 v157, v174, v175
  v_mov_b32_dpp v158, v156 row_ror:8 row_mask:0xf bank_mask:0xf
  v_exp_f32 v177, v171
  v_mov_b32_dpp v159, v157 row_ror:8 row_mask:0xf bank_mask:0xf
  v_cvt_pk_bf16_f32 v160, v176, v177
  v_cvt_pk_bf16_f32 v139, v102, v103
  v_mfma_f32_16x16x32_bf16 v[178:181], v[152:155], v[156:159], 0
  s_waitcnt lgkmcnt(0)
  v_mov_b32_dpp v161, v160 row_ror:8 row_mask:0xf bank_mask:0xf
  v_mfma_f32_16x16x32_bf16 v[182:185], v[144:147], v[156:159], 0
  s_nop 0
  v_mfma_f32_16x16x32_bf16 v[178:181], v[140:143], v[160:163], v[178:181]
  v_mfma_f32_16x16x32_bf16 v[182:185], v[136:139], v[160:163], v[182:185]
  v_mfma_f32_16x16x32_bf16 v[186:189], v[148:151], v[156:159], 0
  v_mfma_f32_16x16x32_bf16 v[186:189], v[138:141], v[160:163], v[186:189]
  s_mov_b64 exec, s[62:63]
  v_rcp_f32 v164, v180
  s_nop 0
  v_pk_mul_f32 v[178:179], v[178:179], v[164:165] op_sel_hi:[1,0]
  v_pk_mul_f32 v[182:183], v[182:183], v[164:165] op_sel_hi:[1,0]
  v_pk_mul_f32 v[184:185], v[184:185], v[164:165] op_sel_hi:[1,0]
  v_cvt_pk_f16_f32 v64, v178, v179
  v_cvt_pk_f16_f32 v60, v182, v183
  v_pk_mul_f32 v[186:187], v[186:187], v[164:165] op_sel_hi:[1,0]
  v_pk_mul_f32 v[188:189], v[188:189], v[164:165] op_sel_hi:[1,0]
  v_cvt_pk_f16_f32 v61, v184, v185
  v_cvt_pk_f16_f32 v62, v186, v187
  v_cvt_pk_f16_f32 v63, v188, v189
  ds_write_b128 v13, v[60:63]
  ds_write_b32 v14, v64
  v_add_f32 v165, v164, v180
  v_cmp_ngt_f32 vcc, s80, v165
  s_mov_b64 exec, -1
  s_nop 0
  s_cbranch_vccnz fx_64
fk_65:
  s_waitcnt lgkmcnt(0)
  s_barrier
  s_add_u32 m0, s74, 2048
  s_add_u32 s21, s79, 65536
  buffer_load_dwordx4 v4, s[16:19], s21 offen offset:1024 sc1 lds
  s_add_u32 m0, s74, 6144
  s_add_u32 s21, s79, 196608
  buffer_load_dwordx4 v4, s[16:19], s21 offen offset:0 sc1 lds
  s_xor_b32 s74, s74, 16384
  s_add_u32 s73, s73, 2097152
  s_xor_b32 s73, s73, 8192
  s_add_u32 s79, s79, 2097152
  s_xor_b32 s79, s79, 8192
  s_add_u32 s21, s72, 524288
  s_xor_b32 s72, s72, s21
  s_lshr_b32 s72, s72, 8
  s_and_b32 s72, s72, 8192
  s_xor_b32 s72, s72, s21
  s_nop 15
  s_nop 3
  v_permlane32_swap_b32 v96, v100
  v_permlane32_swap_b32 v97, v101
  v_permlane32_swap_b32 v98, v102
  v_permlane32_swap_b32 v99, v103
  v_pk_add_f32 v[96:97], v[96:97], v[100:101]
  v_pk_add_f32 v[98:99], v[98:99], v[102:103]
  v_cvt_pk_bf16_f32 v182, v96, v97
  v_cvt_pk_bf16_f32 v183, v98, v99
  v_min_u32 v182, -2, v182
  ds_write_b64 v26, v[182:183]
  ds_read_b128 v[144:147], v18
  ds_read_b128 v[148:151], v18 offset:1024
  ds_read_b128 v[152:155], v19
  ds_read_b128 v[112:115], v20
  ds_read_b64 v[116:117], v21
  v_xor_b32 v18, 16384, v18
  v_xor_b32 v19, 16384, v19
  v_xor_b32 v20, 16384, v20
  v_xor_b32 v21, 16384, v21
  v_mov_b32 v88, 0
  v_mov_b32 v89, 0
  v_mov_b32 v90, 0
  v_mov_b32 v91, 0
  v_mov_b32 v92, 0
  v_mov_b32 v93, 0
  v_mov_b32 v94, 0
  v_mov_b32 v95, 0
  v_mov_b32 v96, 0
  v_mov_b32 v97, 0
  v_mov_b32 v98, 0
  v_mov_b32 v99, 0
  v_mov_b32 v100, 0
  v_mov_b32 v101, 0
  v_mov_b32 v102, 0
  v_mov_b32 v103, 0
  s_mov_b32 s81, 0
  s_waitcnt lgkmcnt(0)
  s_barrier
  s_mov_b64 exec, s[64:65]
  buffer_store_dwordx2 v[28:29], v8, s[8:11], s57 offen
  s_mov_b64 exec, s[62:63]
  buffer_store_dword v28, v17, s[8:11], s59 offen
  s_mov_b64 exec, -1
  s_sleep 6
  s_nop 3
  buffer_load_dwordx4 v[68:71], v16, s[4:7], s60 offen sc1
  s_sleep 3
  s_nop 1
  buffer_load_dwordx4 v[72:75], v16, s[4:7], s60 offen sc1
  s_mov_b32 s54, 0
pp_67:
  s_waitcnt vmcnt(1)
  v_mfma_f32_16x16x32_f16 v[120:123], v[44:47], v[68:71], 0
  v_bitop3_b32 v27, v68, s61, 1 bitop3:0x28
  v_cmp_ne_u32 vcc, 0, v27
  s_nop 1
  s_cbranch_vccnz p2_69
  s_nop 2
pg_68:
  v_add_f32_dpp v120, v120, v120 row_ror:8 row_mask:0xf bank_mask:0xf
  v_add_f32_dpp v121, v121, v121 row_ror:8 row_mask:0xf bank_mask:0xf
  s_mov_b64 exec, s[62:63]
  v_cvt_pk_bf16_f32 v120, v120, v121
  v_min_u32 v120, -2, v120
  buffer_store_dword v120, v17, s[8:11], s55 offen
  s_mov_b64 exec, -1
nt_66:
  s_barrier
  s_mov_b32 s58, s55
  s_add_u32 s52, s52, 1
  s_and_b32 s21, s52, 3
  s_mul_i32 s56, s21, 122880
  s_add_u32 s21, s52, 1
  s_and_b32 s21, s21, 3
  s_mul_i32 s55, s21, 122880
  s_add_u32 s55, s55, s75
  s_add_u32 s21, s52, 2
  s_and_b32 s21, s21, 3
  s_mul_i32 s57, s21, 122880
  s_add_u32 s21, s52, 3
  s_and_b32 s21, s21, 3
  s_mul_i32 s59, s21, 122880
  s_add_u32 s59, s59, s75
  s_bfe_u32 s61, s52, 0x10001
  s_and_b32 s21, s52, 1
  s_lshl_b32 s60, s21, 19
  s_mov_b32 s54, 0
  s_sleep 3
  s_nop 2
  buffer_load_dwordx4 v[60:63], v190, s[8:11], s58 offen offset:0 sc1
  buffer_load_dwordx4 v[64:67], v190, s[8:11], s58 offen offset:1024 sc1
  buffer_load_dwordx4 v[68:71], v190, s[8:11], s58 offen offset:2048 sc1
  s_branch top_55
mr_56:
  s_mov_b64 exec, s[22:23]
  s_cbranch_execz ms_70
  buffer_load_dwordx4 v[60:63], v190, s[8:11], s58 offen offset:0 sc1
ms_70:
  s_mov_b64 exec, s[98:99]
  s_cbranch_execz ms_71
  buffer_load_dwordx4 v[64:67], v190, s[8:11], s58 offen offset:1024 sc1
ms_71:
  s_mov_b64 exec, s[100:101]
  s_cbranch_execz ms_72
  buffer_load_dwordx4 v[68:71], v190, s[8:11], s58 offen offset:2048 sc1
ms_72:
  s_add_u32 s54, s54, 1
  s_cmp_gt_u32 s54, 131072
  s_cbranch_scc1 end0
  s_waitcnt vmcnt(0)
  s_mov_b64 exec, s[22:23]
  ds_write_b128 v190, v[60:63] offset:0
  v_cmp_eq_u32 s[22:23], -1, v60
  s_mov_b64 exec, s[98:99]
  ds_write_b128 v190, v[64:67] offset:1024
  v_cmp_eq_u32 s[98:99], -1, v64
  s_mov_b64 exec, s[100:101]
  ds_write_b128 v190, v[68:71] offset:2048
  v_cmp_eq_u32 s[100:101], -1, v68
  s_mov_b64 exec, -1
  s_or_b64 vcc, s[22:23], s[98:99]
  s_or_b64 vcc, vcc, s[100:101]
  s_cbranch_scc1 mr_56
  s_branch mo_60
mn_57:
  v_max3_u32 v27, v48, v49, v50
  v_max3_u32 v27, v27, v51, v52
  v_max3_u32 v27, v27, v53, v54
  v_max3_u32 v27, v27, v55, v56
  v_max3_u32 v27, v27, v57, v58
  v_max3_u32 v27, v27, v59, v60
  v_max3_u32 v27, v27, v61, v62
  v_max3_u32 v27, v27, v63, v64
  v_max3_u32 v27, v27, v65, v66
  v_max3_u32 v27, v27, v67, v68
  v_max3_u32 v27, v27, v69, v70
  v_max3_u32 v27, v27, v71, v72
  v_max3_u32 v27, v27, v73, v74
  v_max3_u32 v27, v27, v75, v76
  v_max3_u32 v27, v27, v77, v78
  v_max3_u32 v27, v27, v79, v80
  v_max3_u32 v27, v27, v81, v82
  v_max3_u32 v27, v27, v83, v84
  v_max3_u32 v27, v27, v85, v86
  v_max3_u32 v27, v27, v87, v87
  v_cmp_eq_u32 vcc, -1, v27
  s_cmp_eq_u32 s52, 0
  s_cbranch_scc1 mk_58
  s_cbranch_vccz mk_58
  s_waitcnt lgkmcnt(0)
  s_barrier
  s_nop 7
  v_mov_b32 v88, 0
  v_mov_b32 v89, 0
  v_mov_b32 v90, 0
  v_mov_b32 v91, 0
  v_mov_b32 v92, 0
  v_mov_b32 v93, 0
  v_mov_b32 v94, 0
  v_mov_b32 v95, 0
  v_mov_b32 v96, 0
  v_mov_b32 v97, 0
  v_mov_b32 v98, 0
  v_mov_b32 v99, 0
  v_mov_b32 v100, 0
  v_mov_b32 v101, 0
  v_mov_b32 v102, 0
  v_mov_b32 v103, 0
  s_mov_b64 s[22:23], -1
  s_mov_b64 s[98:99], -1
  s_mov_b64 s[100:101], -1
  s_branch mr_56
sr_61:
  s_mov_b32 s54, 0
sr_73:
  s_mov_b64 exec, vcc
  buffer_load_dwordx4 v[124:127], v9, s[8:11], s56 offen sc1
  buffer_load_dwordx4 v[128:131], v9, s[8:11], s56 offen offset:1024 sc1
  buffer_load_dwordx4 v[132:135], v10, s[8:11], s56 offen sc1
  s_mov_b64 exec, -1
  s_add_u32 s54, s54, 1
  s_cmp_gt_u32 s54, 131072
  s_cbranch_scc1 end0
  s_and_b32 s21, s54, 31
  s_cbranch_scc0 sr_74
  s_waitcnt vmcnt(0)
  v_pk_add_f16 v172, v124, v126
  v_pk_add_f16 v173, v125, v127
  v_pk_add_f16 v174, v128, v130
  v_pk_add_f16 v175, v129, v131
  v_fma_mix_f32 v166, v172, 1.0, v174 op_sel:[0,0,0] op_sel_hi:[1,0,1]
  v_fma_mix_f32 v168, v173, 1.0, v175 op_sel:[0,0,0] op_sel_hi:[1,0,1]
  v_pk_add_f16 v176, v132, v133
  v_pk_add_f16 v177, v134, v135
  v_add_f32 v27, v166, v168
  v_fma_mix_f32 v170, v176, 1.0, v177 op_sel:[0,0,0] op_sel_hi:[1,0,1]
  v_fma_mix_f32 v167, v172, 1.0, v174 op_sel:[1,0,1] op_sel_hi:[1,0,1]
  v_cmp_u_f32 vcc, v27, v170
  v_fma_mix_f32 v169, v173, 1.0, v175 op_sel:[1,0,1] op_sel_hi:[1,0,1]
  v_fma_mix_f32 v171, v176, 1.0, v177 op_sel:[1,0,1] op_sel_hi:[1,0,1]
  s_cbranch_vccnz sr_73
  s_branch sj_62
sr_74:
  s_waitcnt vmcnt(0)
  v_pk_add_f16 v172, v124, v126
  v_pk_add_f16 v173, v125, v127
  v_pk_add_f16 v174, v128, v130
  v_pk_add_f16 v175, v129, v131
  v_fma_mix_f32 v166, v172, 1.0, v174 op_sel:[0,0,0] op_sel_hi:[1,0,1]
  v_fma_mix_f32 v168, v173, 1.0, v175 op_sel:[0,0,0] op_sel_hi:[1,0,1]
  v_pk_add_f16 v176, v132, v133
  v_pk_add_f16 v177, v134, v135
  v_add_f32 v27, v166, v168
  v_fma_mix_f32 v170, v176, 1.0, v177 op_sel:[0,0,0] op_sel_hi:[1,0,1]
  v_fma_mix_f32 v167, v172, 1.0, v174 op_sel:[1,0,1] op_sel_hi:[1,0,1]
  v_cmp_u_f32 vcc, v27, v170
  v_fma_mix_f32 v169, v173, 1.0, v175 op_sel:[1,0,1] op_sel_hi:[1,0,1]
  v_fma_mix_f32 v171, v176, 1.0, v177 op_sel:[1,0,1] op_sel_hi:[1,0,1]
  v_max3_u32 v27, v124, v126, v128
  v_max3_u32 v27, v27, v130, v132
  v_max3_u32 v27, v27, v133, v134
  v_max3_u32 v27, v27, v135, v135
  v_cmp_eq_u32 vcc, -1, v27
  s_nop 1
  s_cbranch_vccnz sr_73
  s_branch sj_62
fx_64:
  s_cmp_eq_u32 s81, 1
  s_cbranch_scc1 fk_65
  s_mov_b32 s81, 1
  v_max3_f32 v164, v166, v167, v168
  v_max3_f32 v165, v169, v170, v171
  v_max_f32 v164, v164, v165
  s_nop 1
  v_max_f32_dpp v164, v164, v164 row_ror:8 row_mask:0xf bank_mask:0xf
  v_mov_b32 v165, v164
  s_nop 1
  v_permlane32_swap_b32 v164, v165
  v_max_f32 v164, v164, v165
  v_mov_b32 v165, v164
  s_nop 1
  v_permlane16_swap_b32 v164, v165
  v_max_f32 v164, v164, v165
  v_sub_f32 v166, v166, v164
  v_sub_f32 v167, v167, v164
  v_sub_f32 v168, v168, v164
  v_sub_f32 v169, v169, v164
  v_sub_f32 v170, v170, v164
  v_sub_f32 v171, v171, v164
  s_branch ex_63
p2_69:
  buffer_load_dwordx4 v[68:71], v16, s[4:7], s60 offen sc1
  s_waitcnt vmcnt(1)
  v_mfma_f32_16x16x32_f16 v[120:123], v[44:47], v[72:75], 0
  v_bitop3_b32 v27, v72, s61, 1 bitop3:0x28
  v_cmp_ne_u32 vcc, 0, v27
  s_nop 1
  s_cbranch_vccz pg_68
  buffer_load_dwordx4 v[72:75], v16, s[4:7], s60 offen sc1
  s_add_u32 s54, s54, 1
  s_cmp_gt_u32 s54, 131072
  s_cbranch_scc1 end0
  s_branch pp_67
last_59:
  v_smfmac_f32_16x16x64_bf16 v[96:99], v[48:51], a[0:7], v22
  v_smfmac_f32_16x16x64_bf16 v[100:103], v[48:51], a[80:87], v22
  v_smfmac_f32_16x16x64_bf16 v[96:99], v[52:55], a[8:15], v22
  v_smfmac_f32_16x16x64_bf16 v[100:103], v[52:55], a[88:95], v22
  v_smfmac_f32_16x16x64_bf16 v[96:99], v[56:59], a[16:23], v22
  v_smfmac_f32_16x16x64_bf16 v[100:103], v[56:59], a[96:103], v22
  v_smfmac_f32_16x16x64_bf16 v[96:99], v[60:63], a[24:31], v22
  v_smfmac_f32_16x16x64_bf16 v[96:99], v[64:67], a[32:39], v22
  v_smfmac_f32_16x16x64_bf16 v[96:99], v[68:71], a[40:47], v22
  v_smfmac_f32_16x16x64_bf16 v[96:99], v[72:75], a[48:55], v22
  v_smfmac_f32_16x16x64_bf16 v[96:99], v[76:79], a[56:63], v22
  v_smfmac_f32_16x16x64_bf16 v[96:99], v[80:83], a[64:71], v22
  v_smfmac_f32_16x16x64_bf16 v[96:99], v[84:87], a[72:79], v22
  v_smfmac_f32_16x16x64_bf16 v[100:103], v[60:63], a[104:111], v22
  v_smfmac_f32_16x16x64_bf16 v[100:103], v[64:67], a[112:119], v22
  v_smfmac_f32_16x16x64_bf16 v[100:103], v[68:71], a[120:127], v22
  v_smfmac_f32_16x16x64_bf16 v[100:103], v[72:75], a[128:135], v22
  v_smfmac_f32_16x16x64_bf16 v[100:103], v[76:79], a[136:143], v22
  v_smfmac_f32_16x16x64_bf16 v[100:103], v[80:83], a[144:151], v22
  v_smfmac_f32_16x16x64_bf16 v[100:103], v[84:87], a[152:159], v22
  s_nop 7
  v_permlane32_swap_b32 v96, v100
  v_permlane32_swap_b32 v97, v101
  v_permlane32_swap_b32 v98, v102
  v_permlane32_swap_b32 v99, v103
  v_pk_add_f32 v[96:97], v[96:97], v[100:101]
  v_pk_add_f32 v[98:99], v[98:99], v[102:103]
  v_cvt_pk_bf16_f32 v182, v96, v97
  v_cvt_pk_bf16_f32 v183, v98, v99
  v_min_u32 v182, -2, v182
  ds_write_b64 v26, v[182:183]
  s_waitcnt lgkmcnt(0)
  s_barrier
  s_branch chain_done
E_32:
  v_add_u32 v190, 6144, v4
  ds_read_b128 v[72:75], v4 offset:6144
  ds_read_b128 v[76:79], v4 offset:7168
  ds_read_b128 v[80:83], v4 offset:8192
  s_waitcnt lgkmcnt(0)
  s_branch mo_80
  .p2align 3
top_75:
  s_waitcnt vmcnt(2)
  ds_write_b128 v190, v[72:75] offset:0
  v_cmp_eq_u32 s[22:23], -1, v72
  s_waitcnt vmcnt(1)
  ds_write_b128 v190, v[76:79] offset:1024
  v_cmp_eq_u32 s[98:99], -1, v76
  s_waitcnt vmcnt(0)
  ds_write_b128 v190, v[80:83] offset:2048
  v_cmp_eq_u32 s[100:101], -1, v80
  s_or_b64 vcc, s[22:23], s[98:99]
  s_or_b64 vcc, vcc, s[100:101]
  s_cbranch_scc1 mr_76
mo_80:
  s_waitcnt lgkmcnt(0)
  s_barrier
  ds_read_b128 v[48:51], v4 offset:0
  ds_read_b128 v[52:55], v4 offset:1024
  v_smfmac_f32_16x16x64_bf16 v[92:95], v[72:75], v[224:231], v22
  ds_read_b128 v[56:59], v4 offset:2048
  v_smfmac_f32_16x16x64_bf16 v[88:91], v[72:75], a[208:215], v22
  ds_read_b128 v[60:63], v4 offset:3072
  v_smfmac_f32_16x16x64_bf16 v[92:95], v[76:79], v[232:239], v22
  ds_read_b128 v[64:67], v4 offset:4096
  v_smfmac_f32_16x16x64_bf16 v[88:91], v[76:79], a[216:223], v22
  ds_read_b128 v[68:71], v4 offset:5120
  v_smfmac_f32_16x16x64_bf16 v[92:95], v[80:83], v[240:247], v22
  ds_read_b128 v[84:87], v4 offset:9216
  v_smfmac_f32_16x16x64_bf16 v[88:91], v[80:83], a[224:231], v22
  s_waitcnt lgkmcnt(6)
  v_smfmac_f32_16x16x64_bf16 v[92:95], v[48:51], a[240:247], v22
  v_smfmac_f32_16x16x64_bf16 v[88:91], v[48:51], a[160:167], v22
  s_waitcnt lgkmcnt(5)
  v_smfmac_f32_16x16x64_bf16 v[92:95], v[52:55], a[248:255], v22
  s_waitcnt lgkmcnt(4)
  v_smfmac_f32_16x16x64_bf16 v[92:95], v[56:59], v[192:199], v22
  s_waitcnt lgkmcnt(3)
  v_smfmac_f32_16x16x64_bf16 v[92:95], v[60:63], v[200:207], v22
  s_waitcnt lgkmcnt(2)
  v_smfmac_f32_16x16x64_bf16 v[92:95], v[64:67], v[208:215], v22
  s_waitcnt lgkmcnt(1)
  v_smfmac_f32_16x16x64_bf16 v[92:95], v[68:71], v[216:223], v22
  s_waitcnt lgkmcnt(0)
  v_smfmac_f32_16x16x64_bf16 v[92:95], v[84:87], v[248:255], v22
  v_smfmac_f32_16x16x64_bf16 v[88:91], v[52:55], a[168:175], v22
  v_smfmac_f32_16x16x64_bf16 v[88:91], v[56:59], a[176:183], v22
  v_smfmac_f32_16x16x64_bf16 v[88:91], v[60:63], a[184:191], v22
  v_permlane32_swap_b32 v92, v93
  v_smfmac_f32_16x16x64_bf16 v[88:91], v[64:67], a[192:199], v22
  v_permlane32_swap_b32 v94, v95
  v_smfmac_f32_16x16x64_bf16 v[88:91], v[68:71], a[200:207], v22
  v_permlane32_swap_b32 v93, v92
  v_smfmac_f32_16x16x64_bf16 v[88:91], v[84:87], a[232:239], v22
  v_permlane32_swap_b32 v95, v94
  v_pk_mul_f32 v[120:121], v[92:93], v[24:25] op_sel:[1,0] op_sel_hi:[0,1]
  v_pk_mul_f32 v[122:123], v[94:95], v[24:25] op_sel:[1,0] op_sel_hi:[0,1]
  s_nop 4
  v_pk_fma_f32 v[88:89], v[88:89], v[24:25], v[120:121]
  v_pk_fma_f32 v[90:91], v[90:91], v[24:25], v[122:123]
  v_cvt_pk_bf16_f32 v120, v88, v89
  v_cvt_pk_bf16_f32 v121, v90, v91
  ds_write_b64 v6, v[120:121]
  v_cmp_u_f32 vcc, v88, v89
  v_cmp_u_f32 s[22:23], v90, v91
  s_nop 1
  s_or_b64 vcc, vcc, s[22:23]
  s_cbranch_vccnz mn_77
mk_78:
  s_waitcnt lgkmcnt(0)
  s_barrier
  ds_read_b64_tr_b16 v[104:105], v7 offset:0
  ds_read_b64_tr_b16 v[106:107], v7 offset:768
  ds_read_b64_tr_b16 v[108:109], v7 offset:1536
  ds_read_b64 v[140:141], v11
  s_cmp_eq_u32 s52, 63
  s_cbranch_scc1 last_79
  s_waitcnt lgkmcnt(2)
  v_mfma_f32_16x16x32_bf16 v[120:123], v[104:107], v[104:107], 0
  s_waitcnt lgkmcnt(1)
  v_mfma_f32_16x16x32_bf16 v[120:123], v[108:111], v[108:111], v[120:123]
  s_mov_b64 exec, s[64:65]
  s_nop 6
  v_cvt_pk_f16_f32 v120, v120, v121
  buffer_store_dword v120, v8, s[8:11], s56 offen
  v_cvt_pk_f16_f32 v121, v122, v123
  buffer_store_dword v121, v8, s[8:11], s56 offen offset:128
  s_mov_b64 exec, -1
  s_sleep 3
  s_nop 1
  v_smfmac_f32_16x16x64_bf16 v[96:99], v[48:51], a[0:7], v22
  v_smfmac_f32_16x16x64_bf16 v[100:103], v[48:51], a[80:87], v22
  v_smfmac_f32_16x16x64_bf16 v[96:99], v[52:55], a[8:15], v22
  v_smfmac_f32_16x16x64_bf16 v[100:103], v[52:55], a[88:95], v22
  v_smfmac_f32_16x16x64_bf16 v[96:99], v[56:59], a[16:23], v22
  v_smfmac_f32_16x16x64_bf16 v[100:103], v[56:59], a[96:103], v22
  v_smfmac_f32_16x16x64_bf16 v[96:99], v[60:63], a[24:31], v22
  v_smfmac_f32_16x16x64_bf16 v[96:99], v[64:67], a[32:39], v22
  v_smfmac_f32_16x16x64_bf16 v[96:99], v[68:71], a[40:47], v22
  v_smfmac_f32_16x16x64_bf16 v[96:99], v[72:75], a[48:55], v22
  v_smfmac_f32_16x16x64_bf16 v[96:99], v[76:79], a[56:63], v22
  buffer_load_dwordx4 v[124:127], v9, s[8:11], s56 offen sc1
  v_smfmac_f32_16x16x64_bf16 v[96:99], v[80:83], a[64:71], v22
  buffer_load_dwordx4 v[128:131], v9, s[8:11], s56 offen offset:1024 sc1
  v_smfmac_f32_16x16x64_bf16 v[96:99], v[84:87], a[72:79], v22
  buffer_load_dwordx4 v[132:135], v10, s[8:11], s56 offen sc1
  v_smfmac_f32_16x16x64_bf16 v[100:103], v[60:63], a[104:111], v22
  v_smfmac_f32_16x16x64_bf16 v[100:103], v[64:67], a[112:119], v22
  v_smfmac_f32_16x16x64_bf16 v[100:103], v[68:71], a[120:127], v22
  v_smfmac_f32_16x16x64_bf16 v[100:103], v[72:75], a[128:135], v22
  v_cvt_pk_bf16_f32 v136, v96, v97
  v_smfmac_f32_16x16x64_bf16 v[100:103], v[76:79], a[136:143], v22
  v_cvt_pk_bf16_f32 v137, v98, v99
  v_smfmac_f32_16x16x64_bf16 v[100:103], v[80:83], a[144:151], v22
  v_smfmac_f32_16x16x64_bf16 v[100:103], v[84:87], a[152:159], v22
  s_waitcnt vmcnt(2)
  v_pk_add_f16 v172, v124, v126
  v_pk_add_f16 v173, v125, v127
  s_waitcnt vmcnt(1)
  v_pk_add_f16 v174, v128, v130
  v_pk_add_f16 v175, v129, v131
  v_fma_mix_f32 v166, v172, 1.0, v174 op_sel:[0,0,0] op_sel_hi:[1,0,1]
  v_fma_mix_f32 v168, v173, 1.0, v175 op_sel:[0,0,0] op_sel_hi:[1,0,1]
  s_waitcnt vmcnt(0)
  v_pk_add_f16 v176, v132, v133
  v_pk_add_f16 v177, v134, v135
  v_fma_mix_f32 v170, v176, 1.0, v177 op_sel:[0,0,0] op_sel_hi:[1,0,1]
  v_fma_mix_f32 v167, v172, 1.0, v174 op_sel:[1,0,1] op_sel_hi:[1,0,1]
  v_cmp_u_f32 vcc, v166, v170
  v_fma_mix_f32 v169, v173, 1.0, v175 op_sel:[1,0,1] op_sel_hi:[1,0,1]
  v_fma_mix_f32 v171, v176, 1.0, v177 op_sel:[1,0,1] op_sel_hi:[1,0,1]
  v_cvt_pk_bf16_f32 v138, v100, v101
  s_cbranch_vccnz sr_81
sj_82:
ex_83:
  v_exp_f32 v172, v166
  v_exp_f32 v173, v167
  v_exp_f32 v174, v168
  v_cvt_pk_bf16_f32 v156, v172, v173
  v_exp_f32 v175, v169
  v_exp_f32 v176, v170
  v_cvt_pk_bf16_f32 v157, v174, v175
  v_mov_b32_dpp v158, v156 row_ror:8 row_mask:0xf bank_mask:0xf
  v_exp_f32 v177, v171
  v_mov_b32_dpp v159, v157 row_ror:8 row_mask:0xf bank_mask:0xf
  v_cvt_pk_bf16_f32 v160, v176, v177
  v_cvt_pk_bf16_f32 v139, v102, v103
  v_mfma_f32_16x16x32_bf16 v[178:181], v[152:155], v[156:159], 0
  s_waitcnt lgkmcnt(0)
  v_mov_b32_dpp v161, v160 row_ror:8 row_mask:0xf bank_mask:0xf
  v_mfma_f32_16x16x32_bf16 v[182:185], v[144:147], v[156:159], 0
  s_nop 0
  v_mfma_f32_16x16x32_bf16 v[178:181], v[140:143], v[160:163], v[178:181]
  v_mfma_f32_16x16x32_bf16 v[182:185], v[136:139], v[160:163], v[182:185]
  v_mfma_f32_16x16x32_bf16 v[186:189], v[148:151], v[156:159], 0
  v_mfma_f32_16x16x32_bf16 v[186:189], v[138:141], v[160:163], v[186:189]
  s_mov_b64 exec, s[62:63]
  v_rcp_f32 v164, v180
  s_nop 0
  v_pk_mul_f32 v[178:179], v[178:179], v[164:165] op_sel_hi:[1,0]
  v_pk_mul_f32 v[182:183], v[182:183], v[164:165] op_sel_hi:[1,0]
  v_pk_mul_f32 v[184:185], v[184:185], v[164:165] op_sel_hi:[1,0]
  v_cvt_pk_f16_f32 v64, v178, v179
  v_cvt_pk_f16_f32 v60, v182, v183
  v_pk_mul_f32 v[186:187], v[186:187], v[164:165] op_sel_hi:[1,0]
  v_pk_mul_f32 v[188:189], v[188:189], v[164:165] op_sel_hi:[1,0]
  v_cvt_pk_f16_f32 v61, v184, v185
  v_cvt_pk_f16_f32 v62, v186, v187
  v_cvt_pk_f16_f32 v63, v188, v189
  ds_write_b128 v13, v[60:63]
  ds_write_b32 v14, v64
  v_add_f32 v165, v164, v180
  v_cmp_ngt_f32 vcc, s80, v165
  s_mov_b64 exec, -1
  s_nop 0
  s_cbranch_vccnz fx_84
fk_85:
  s_waitcnt lgkmcnt(0)
  s_barrier
  s_add_u32 m0, s74, 4096
  s_add_u32 s21, s79, 131072
  buffer_load_dwordx4 v4, s[16:19], s21 offen offset:0 sc1 lds
  s_add_u32 m0, s74, 6144
  s_add_u32 s21, s79, 196608
  buffer_load_dwordx4 v4, s[16:19], s21 offen offset:1024 sc1 lds
  s_xor_b32 s74, s74, 16384
  s_add_u32 s73, s73, 2097152
  s_xor_b32 s73, s73, 8192
  s_add_u32 s79, s79, 2097152
  s_xor_b32 s79, s79, 8192
  s_add_u32 s21, s72, 524288
  s_xor_b32 s72, s72, s21
  s_lshr_b32 s72, s72, 8
  s_and_b32 s72, s72, 8192
  s_xor_b32 s72, s72, s21
  s_nop 15
  s_nop 3
  v_permlane32_swap_b32 v96, v100
  v_permlane32_swap_b32 v97, v101
  v_permlane32_swap_b32 v98, v102
  v_permlane32_swap_b32 v99, v103
  v_pk_add_f32 v[96:97], v[96:97], v[100:101]
  v_pk_add_f32 v[98:99], v[98:99], v[102:103]
  v_cvt_pk_bf16_f32 v182, v96, v97
  v_cvt_pk_bf16_f32 v183, v98, v99
  v_min_u32 v182, -2, v182
  ds_write_b64 v26, v[182:183]
  ds_read_b128 v[144:147], v18
  ds_read_b128 v[148:151], v18 offset:1024
  ds_read_b128 v[152:155], v19
  v_xor_b32 v18, 16384, v18
  v_xor_b32 v19, 16384, v19
  v_mov_b32 v88, 0
  v_mov_b32 v89, 0
  v_mov_b32 v90, 0
  v_mov_b32 v91, 0
  v_mov_b32 v92, 0
  v_mov_b32 v93, 0
  v_mov_b32 v94, 0
  v_mov_b32 v95, 0
  v_mov_b32 v96, 0
  v_mov_b32 v97, 0
  v_mov_b32 v98, 0
  v_mov_b32 v99, 0
  v_mov_b32 v100, 0
  v_mov_b32 v101, 0
  v_mov_b32 v102, 0
  v_mov_b32 v103, 0
  s_mov_b32 s81, 0
  s_waitcnt lgkmcnt(0)
  s_barrier
  s_mov_b64 exec, s[64:65]
  buffer_store_dword v28, v8, s[8:11], s57 offen
  buffer_store_dword v28, v8, s[8:11], s57 offen offset:128
  s_mov_b64 exec, -1
  s_cmp_eq_u32 s78, 0
  s_cbranch_scc1 nt_86
  s_mov_b64 exec, s[62:63]
  buffer_store_dword v28, v17, s[8:11], s59 offen
  s_mov_b64 exec, -1
  s_sleep 6
  s_nop 3
  buffer_load_dwordx4 v[68:71], v16, s[4:7], s60 offen sc1
  s_sleep 3
  s_nop 1
  buffer_load_dwordx4 v[72:75], v16, s[4:7], s60 offen sc1
  s_mov_b32 s54, 0
pp_87:
  s_waitcnt vmcnt(1)
  v_mfma_f32_16x16x32_f16 v[120:123], v[44:47], v[68:71], 0
  v_bitop3_b32 v27, v68, s61, 1 bitop3:0x28
  v_cmp_ne_u32 vcc, 0, v27
  s_nop 1
  s_cbranch_vccnz p2_89
  s_nop 2
pg_88:
  v_add_f32_dpp v120, v120, v120 row_ror:8 row_mask:0xf bank_mask:0xf
  v_add_f32_dpp v121, v121, v121 row_ror:8 row_mask:0xf bank_mask:0xf
  s_mov_b64 exec, s[62:63]
  v_cvt_pk_bf16_f32 v120, v120, v121
  v_min_u32 v120, -2, v120
  buffer_store_dword v120, v17, s[8:11], s55 offen
  s_mov_b64 exec, -1
nt_86:
  s_barrier
  s_mov_b32 s58, s55
  s_add_u32 s52, s52, 1
  s_and_b32 s21, s52, 3
  s_mul_i32 s56, s21, 122880
  s_add_u32 s21, s52, 1
  s_and_b32 s21, s21, 3
  s_mul_i32 s55, s21, 122880
  s_add_u32 s55, s55, s75
  s_add_u32 s21, s52, 2
  s_and_b32 s21, s21, 3
  s_mul_i32 s57, s21, 122880
  s_add_u32 s21, s52, 3
  s_and_b32 s21, s21, 3
  s_mul_i32 s59, s21, 122880
  s_add_u32 s59, s59, s75
  s_bfe_u32 s61, s52, 0x10001
  s_and_b32 s21, s52, 1
  s_lshl_b32 s60, s21, 19
  s_mov_b32 s54, 0
  s_sleep 3
  s_nop 2
  buffer_load_dwordx4 v[72:75], v190, s[8:11], s58 offen offset:0 sc1
  buffer_load_dwordx4 v[76:79], v190, s[8:11], s58 offen offset:1024 sc1
  buffer_load_dwordx4 v[80:83], v190, s[8:11], s58 offen offset:2048 sc1
  s_branch top_75
mr_76:
  s_mov_b64 exec, s[22:23]
  s_cbranch_execz ms_90
  buffer_load_dwordx4 v[72:75], v190, s[8:11], s58 offen offset:0 sc1
ms_90:
  s_mov_b64 exec, s[98:99]
  s_cbranch_execz ms_91
  buffer_load_dwordx4 v[76:79], v190, s[8:11], s58 offen offset:1024 sc1
ms_91:
  s_mov_b64 exec, s[100:101]
  s_cbranch_execz ms_92
  buffer_load_dwordx4 v[80:83], v190, s[8:11], s58 offen offset:2048 sc1
ms_92:
  s_add_u32 s54, s54, 1
  s_cmp_gt_u32 s54, 131072
  s_cbranch_scc1 end0
  s_waitcnt vmcnt(0)
  s_mov_b64 exec, s[22:23]
  ds_write_b128 v190, v[72:75] offset:0
  v_cmp_eq_u32 s[22:23], -1, v72
  s_mov_b64 exec, s[98:99]
  ds_write_b128 v190, v[76:79] offset:1024
  v_cmp_eq_u32 s[98:99], -1, v76
  s_mov_b64 exec, s[100:101]
  ds_write_b128 v190, v[80:83] offset:2048
  v_cmp_eq_u32 s[100:101], -1, v80
  s_mov_b64 exec, -1
  s_or_b64 vcc, s[22:23], s[98:99]
  s_or_b64 vcc, vcc, s[100:101]
  s_cbranch_scc1 mr_76
  s_branch mo_80
mn_77:
  v_max3_u32 v27, v48, v49, v50
  v_max3_u32 v27, v27, v51, v52
  v_max3_u32 v27, v27, v53, v54
  v_max3_u32 v27, v27, v55, v56
  v_max3_u32 v27, v27, v57, v58
  v_max3_u32 v27, v27, v59, v60
  v_max3_u32 v27, v27, v61, v62
  v_max3_u32 v27, v27, v63, v64
  v_max3_u32 v27, v27, v65, v66
  v_max3_u32 v27, v27, v67, v68
  v_max3_u32 v27, v27, v69, v70
  v_max3_u32 v27, v27, v71, v72
  v_max3_u32 v27, v27, v73, v74
  v_max3_u32 v27, v27, v75, v76
  v_max3_u32 v27, v27, v77, v78
  v_max3_u32 v27, v27, v79, v80
  v_max3_u32 v27, v27, v81, v82
  v_max3_u32 v27, v27, v83, v84
  v_max3_u32 v27, v27, v85, v86
  v_max3_u32 v27, v27, v87, v87
  v_cmp_eq_u32 vcc, -1, v27
  s_cmp_eq_u32 s52, 0
  s_cbranch_scc1 mk_78
  s_cbranch_vccz mk_78
  s_waitcnt lgkmcnt(0)
  s_barrier
  s_nop 7
  v_mov_b32 v88, 0
  v_mov_b32 v89, 0
  v_mov_b32 v90, 0
  v_mov_b32 v91, 0
  v_mov_b32 v92, 0
  v_mov_b32 v93, 0
  v_mov_b32 v94, 0
  v_mov_b32 v95, 0
  v_mov_b32 v96, 0
  v_mov_b32 v97, 0
  v_mov_b32 v98, 0
  v_mov_b32 v99, 0
  v_mov_b32 v100, 0
  v_mov_b32 v101, 0
  v_mov_b32 v102, 0
  v_mov_b32 v103, 0
  s_mov_b64 s[22:23], -1
  s_mov_b64 s[98:99], -1
  s_mov_b64 s[100:101], -1
  s_branch mr_76
sr_81:
  s_mov_b32 s54, 0
sr_93:
  s_mov_b64 exec, vcc
  buffer_load_dwordx4 v[124:127], v9, s[8:11], s56 offen sc1
  buffer_load_dwordx4 v[128:131], v9, s[8:11], s56 offen offset:1024 sc1
  buffer_load_dwordx4 v[132:135], v10, s[8:11], s56 offen sc1
  s_mov_b64 exec, -1
  s_add_u32 s54, s54, 1
  s_cmp_gt_u32 s54, 131072
  s_cbranch_scc1 end0
  s_and_b32 s21, s54, 31
  s_cbranch_scc0 sr_94
  s_waitcnt vmcnt(0)
  v_pk_add_f16 v172, v124, v126
  v_pk_add_f16 v173, v125, v127
  v_pk_add_f16 v174, v128, v130
  v_pk_add_f16 v175, v129, v131
  v_fma_mix_f32 v166, v172, 1.0, v174 op_sel:[0,0,0] op_sel_hi:[1,0,1]
  v_fma_mix_f32 v168, v173, 1.0, v175 op_sel:[0,0,0] op_sel_hi:[1,0,1]
  v_pk_add_f16 v176, v132, v133
  v_pk_add_f16 v177, v134, v135
  v_add_f32 v27, v166, v168
  v_fma_mix_f32 v170, v176, 1.0, v177 op_sel:[0,0,0] op_sel_hi:[1,0,1]
  v_fma_mix_f32 v167, v172, 1.0, v174 op_sel:[1,0,1] op_sel_hi:[1,0,1]
  v_cmp_u_f32 vcc, v27, v170
  v_fma_mix_f32 v169, v173, 1.0, v175 op_sel:[1,0,1] op_sel_hi:[1,0,1]
  v_fma_mix_f32 v171, v176, 1.0, v177 op_sel:[1,0,1] op_sel_hi:[1,0,1]
  s_cbranch_vccnz sr_93
  s_branch sj_82
sr_94:
  s_waitcnt vmcnt(0)
  v_pk_add_f16 v172, v124, v126
  v_pk_add_f16 v173, v125, v127
  v_pk_add_f16 v174, v128, v130
  v_pk_add_f16 v175, v129, v131
  v_fma_mix_f32 v166, v172, 1.0, v174 op_sel:[0,0,0] op_sel_hi:[1,0,1]
  v_fma_mix_f32 v168, v173, 1.0, v175 op_sel:[0,0,0] op_sel_hi:[1,0,1]
  v_pk_add_f16 v176, v132, v133
  v_pk_add_f16 v177, v134, v135
  v_add_f32 v27, v166, v168
  v_fma_mix_f32 v170, v176, 1.0, v177 op_sel:[0,0,0] op_sel_hi:[1,0,1]
  v_fma_mix_f32 v167, v172, 1.0, v174 op_sel:[1,0,1] op_sel_hi:[1,0,1]
  v_cmp_u_f32 vcc, v27, v170
  v_fma_mix_f32 v169, v173, 1.0, v175 op_sel:[1,0,1] op_sel_hi:[1,0,1]
  v_fma_mix_f32 v171, v176, 1.0, v177 op_sel:[1,0,1] op_sel_hi:[1,0,1]
  v_max3_u32 v27, v124, v126, v128
  v_max3_u32 v27, v27, v130, v132
  v_max3_u32 v27, v27, v133, v134
  v_max3_u32 v27, v27, v135, v135
  v_cmp_eq_u32 vcc, -1, v27
  s_nop 1
  s_cbranch_vccnz sr_93
  s_branch sj_82
fx_84:
  s_cmp_eq_u32 s81, 1
  s_cbranch_scc1 fk_85
  s_mov_b32 s81, 1
  v_max3_f32 v164, v166, v167, v168
  v_max3_f32 v165, v169, v170, v171
  v_max_f32 v164, v164, v165
  s_nop 1
  v_max_f32_dpp v164, v164, v164 row_ror:8 row_mask:0xf bank_mask:0xf
  v_mov_b32 v165, v164
  s_nop 1
  v_permlane32_swap_b32 v164, v165
  v_max_f32 v164, v164, v165
  v_mov_b32 v165, v164
  s_nop 1
  v_permlane16_swap_b32 v164, v165
  v_max_f32 v164, v164, v165
  v_sub_f32 v166, v166, v164
  v_sub_f32 v167, v167, v164
  v_sub_f32 v168, v168, v164
  v_sub_f32 v169, v169, v164
  v_sub_f32 v170, v170, v164
  v_sub_f32 v171, v171, v164
  s_branch ex_83
p2_89:
  buffer_load_dwordx4 v[68:71], v16, s[4:7], s60 offen sc1
  s_waitcnt vmcnt(1)
  v_mfma_f32_16x16x32_f16 v[120:123], v[44:47], v[72:75], 0
  v_bitop3_b32 v27, v72, s61, 1 bitop3:0x28
  v_cmp_ne_u32 vcc, 0, v27
  s_nop 1
  s_cbranch_vccz pg_88
  buffer_load_dwordx4 v[72:75], v16, s[4:7], s60 offen sc1
  s_add_u32 s54, s54, 1
  s_cmp_gt_u32 s54, 131072
  s_cbranch_scc1 end0
  s_branch pp_87
last_79:
  v_smfmac_f32_16x16x64_bf16 v[96:99], v[48:51], a[0:7], v22
  v_smfmac_f32_16x16x64_bf16 v[100:103], v[48:51], a[80:87], v22
  v_smfmac_f32_16x16x64_bf16 v[96:99], v[52:55], a[8:15], v22
  v_smfmac_f32_16x16x64_bf16 v[100:103], v[52:55], a[88:95], v22
  v_smfmac_f32_16x16x64_bf16 v[96:99], v[56:59], a[16:23], v22
  v_smfmac_f32_16x16x64_bf16 v[100:103], v[56:59], a[96:103], v22
  v_smfmac_f32_16x16x64_bf16 v[96:99], v[60:63], a[24:31], v22
  v_smfmac_f32_16x16x64_bf16 v[96:99], v[64:67], a[32:39], v22
  v_smfmac_f32_16x16x64_bf16 v[96:99], v[68:71], a[40:47], v22
  v_smfmac_f32_16x16x64_bf16 v[96:99], v[72:75], a[48:55], v22
  v_smfmac_f32_16x16x64_bf16 v[96:99], v[76:79], a[56:63], v22
  v_smfmac_f32_16x16x64_bf16 v[96:99], v[80:83], a[64:71], v22
  v_smfmac_f32_16x16x64_bf16 v[96:99], v[84:87], a[72:79], v22
  v_smfmac_f32_16x16x64_bf16 v[100:103], v[60:63], a[104:111], v22
  v_smfmac_f32_16x16x64_bf16 v[100:103], v[64:67], a[112:119], v22
  v_smfmac_f32_16x16x64_bf16 v[100:103], v[68:71], a[120:127], v22
  v_smfmac_f32_16x16x64_bf16 v[100:103], v[72:75], a[128:135], v22
  v_smfmac_f32_16x16x64_bf16 v[100:103], v[76:79], a[136:143], v22
  v_smfmac_f32_16x16x64_bf16 v[100:103], v[80:83], a[144:151], v22
  v_smfmac_f32_16x16x64_bf16 v[100:103], v[84:87], a[152:159], v22
  s_nop 7
  v_permlane32_swap_b32 v96, v100
  v_permlane32_swap_b32 v97, v101
  v_permlane32_swap_b32 v98, v102
  v_permlane32_swap_b32 v99, v103
  v_pk_add_f32 v[96:97], v[96:97], v[100:101]
  v_pk_add_f32 v[98:99], v[98:99], v[102:103]
  v_cvt_pk_bf16_f32 v182, v96, v97
  v_cvt_pk_bf16_f32 v183, v98, v99
  v_min_u32 v182, -2, v182
  ds_write_b64 v26, v[182:183]
  s_waitcnt lgkmcnt(0)
  s_barrier
  s_branch chain_done
E_34:
  v_add_u32 v190, 9216, v4
  ds_read_b128 v[84:87], v4 offset:9216
  s_waitcnt lgkmcnt(0)
  s_branch mo_100
  .p2align 3
top_95:
  s_waitcnt vmcnt(0)
  ds_write_b128 v190, v[84:87] offset:0
  v_cmp_eq_u32 s[22:23], -1, v84
  s_or_b64 vcc, s[22:23], s[22:23]
  s_cbranch_scc1 mr_96
mo_100:
  s_waitcnt lgkmcnt(0)
  s_barrier
  ds_read_b128 v[48:51], v4 offset:0
  ds_read_b128 v[52:55], v4 offset:1024
  v_smfmac_f32_16x16x64_bf16 v[92:95], v[84:87], v[248:255], v22
  ds_read_b128 v[56:59], v4 offset:2048
  ds_read_b128 v[60:63], v4 offset:3072
  v_smfmac_f32_16x16x64_bf16 v[88:91], v[84:87], a[232:239], v22
  s_waitcnt lgkmcnt(3)
  s_add_u32 m0, s74, 0
  s_add_u32 s21, s79, 0
  buffer_load_dwordx4 v4, s[16:19], s21 offen offset:0 sc1 lds
  v_smfmac_f32_16x16x64_bf16 v[92:95], v[48:51], a[240:247], v22
  ds_read_b128 v[64:67], v4 offset:4096
  ds_read_b128 v[68:71], v4 offset:5120
  s_add_u32 s22, s52, 3
  s_min_u32 s22, s22, 64
  v_smfmac_f32_16x16x64_bf16 v[88:91], v[48:51], a[160:167], v22
  s_waitcnt lgkmcnt(4)
  s_add_u32 m0, s74, 0
  s_add_u32 s21, s79, 0
  buffer_load_dwordx4 v4, s[16:19], s21 offen offset:1024 sc1 lds
  v_cmp_gt_u32 vcc, s22, v42
  v_smfmac_f32_16x16x64_bf16 v[92:95], v[52:55], a[248:255], v22
  ds_read_b128 v[72:75], v4 offset:6144
  ds_read_b128 v[76:79], v4 offset:7168
  s_cbranch_vccnz kw_101
kv_102:
  v_smfmac_f32_16x16x64_bf16 v[88:91], v[52:55], a[168:175], v22
  s_waitcnt lgkmcnt(5)
  s_add_u32 m0, s74, 2048
  s_add_u32 s21, s79, 65536
  buffer_load_dwordx4 v4, s[16:19], s21 offen offset:0 sc1 lds
  v_smfmac_f32_16x16x64_bf16 v[92:95], v[56:59], v[192:199], v22
  ds_read_b128 v[80:83], v4 offset:8192
  v_smfmac_f32_16x16x64_bf16 v[88:91], v[56:59], a[176:183], v22
  s_waitcnt lgkmcnt(5)
  s_add_u32 m0, s74, 10240
  s_nop 0
  buffer_load_dwordx4 v4, s[16:19], s73 offen offset:0 sc1 lds
  v_smfmac_f32_16x16x64_bf16 v[92:95], v[60:63], v[200:207], v22
  s_waitcnt lgkmcnt(4)
  v_smfmac_f32_16x16x64_bf16 v[92:95], v[64:67], v[208:215], v22
  s_waitcnt lgkmcnt(3)
  s_add_u32 m0, s74, 10240
  s_nop 0
  buffer_load_dwordx4 v4, s[16:19], s73 offen offset:1024 sc1 lds
  v_smfmac_f32_16x16x64_bf16 v[92:95], v[68:71], v[216:223], v22
  s_waitcnt lgkmcnt(2)
  v_smfmac_f32_16x16x64_bf16 v[92:95], v[72:75], v[224:231], v22
  s_waitcnt lgkmcnt(1)
  s_add_u32 m0, s74, 10240
  s_nop 0
  buffer_load_dwordx4 v4, s[16:19], s73 offen offset:2048 sc1 lds
  v_smfmac_f32_16x16x64_bf16 v[92:95], v[76:79], v[232:239], v22
  s_waitcnt lgkmcnt(0)
  v_smfmac_f32_16x16x64_bf16 v[92:95], v[80:83], v[240:247], v22
  s_add_u32 m0, s74, 8192
  s_add_u32 s21, s72, 0
  buffer_load_dwordx4 v32, s[16:19], s21 offen sc1 lds
  v_smfmac_f32_16x16x64_bf16 v[88:91], v[60:63], a[184:191], v22
  v_smfmac_f32_16x16x64_bf16 v[88:91], v[64:67], a[192:199], v22
  v_smfmac_f32_16x16x64_bf16 v[88:91], v[68:71], a[200:207], v22
  v_cvt_pk_bf16_f32 v122, v92, v93
  v_smfmac_f32_16x16x64_bf16 v[88:91], v[72:75], a[208:215], v22
  v_cvt_pk_bf16_f32 v123, v94, v95
  v_smfmac_f32_16x16x64_bf16 v[88:91], v[76:79], a[216:223], v22
  ds_write_b64 v12, v[122:123] offset:13056
  v_smfmac_f32_16x16x64_bf16 v[88:91], v[80:83], a[224:231], v22
  s_nop 7
  v_cvt_pk_bf16_f32 v120, v88, v89
  v_cvt_pk_bf16_f32 v121, v90, v91
  ds_write_b64 v12, v[120:121] offset:12544
  v_smfmac_f32_16x16x64_bf16 v[96:99], v[48:51], a[0:7], v22
  v_cmp_u_f32 vcc, v88, v89
  v_smfmac_f32_16x16x64_bf16 v[100:103], v[48:51], a[80:87], v22
  v_cmp_u_f32 s[22:23], v90, v91
  s_nop 0
  s_or_b64 vcc, vcc, s[22:23]
  s_cbranch_vccnz mn_97
mk_98:
  s_waitcnt lgkmcnt(0)
  s_barrier
  ds_read_b64_tr_b16 v[104:105], v7 offset:0
  ds_read_b64_tr_b16 v[106:107], v7 offset:768
  ds_read_b64_tr_b16 v[108:109], v7 offset:1536
  ds_read_b64 v[140:141], v11
  s_cmp_eq_u32 s52, 63
  s_cbranch_scc1 last_99
  v_smfmac_f32_16x16x64_bf16 v[96:99], v[52:55], a[8:15], v22
  v_smfmac_f32_16x16x64_bf16 v[100:103], v[52:55], a[88:95], v22
  v_smfmac_f32_16x16x64_bf16 v[96:99], v[56:59], a[16:23], v22
  v_smfmac_f32_16x16x64_bf16 v[100:103], v[56:59], a[96:103], v22
  v_smfmac_f32_16x16x64_bf16 v[96:99], v[60:63], a[24:31], v22
  v_smfmac_f32_16x16x64_bf16 v[96:99], v[64:67], a[32:39], v22
  v_smfmac_f32_16x16x64_bf16 v[96:99], v[68:71], a[40:47], v22
  v_smfmac_f32_16x16x64_bf16 v[96:99], v[72:75], a[48:55], v22
  v_smfmac_f32_16x16x64_bf16 v[96:99], v[76:79], a[56:63], v22
  v_smfmac_f32_16x16x64_bf16 v[96:99], v[80:83], a[64:71], v22
  v_smfmac_f32_16x16x64_bf16 v[96:99], v[84:87], a[72:79], v22
  v_smfmac_f32_16x16x64_bf16 v[100:103], v[60:63], a[104:111], v22
  v_smfmac_f32_16x16x64_bf16 v[100:103], v[64:67], a[112:119], v22
  v_smfmac_f32_16x16x64_bf16 v[100:103], v[68:71], a[120:127], v22
  v_smfmac_f32_16x16x64_bf16 v[100:103], v[72:75], a[128:135], v22
  v_cvt_pk_bf16_f32 v136, v96, v97
  v_smfmac_f32_16x16x64_bf16 v[100:103], v[76:79], a[136:143], v22
  v_cvt_pk_bf16_f32 v137, v98, v99
  v_smfmac_f32_16x16x64_bf16 v[100:103], v[80:83], a[144:151], v22
  v_smfmac_f32_16x16x64_bf16 v[100:103], v[84:87], a[152:159], v22
  s_sleep 2
  s_nop 7
  buffer_load_dwordx4 v[124:127], v9, s[8:11], s56 offen sc1
  buffer_load_dwordx4 v[128:131], v9, s[8:11], s56 offen offset:1024 sc1
  s_nop 5
  buffer_load_dwordx4 v[132:135], v10, s[8:11], s56 offen sc1
  s_waitcnt vmcnt(2)
  v_pk_add_f16 v172, v124, v126
  v_pk_add_f16 v173, v125, v127
  s_waitcnt vmcnt(1)
  v_pk_add_f16 v174, v128, v130
  v_pk_add_f16 v175, v129, v131
  v_fma_mix_f32 v166, v172, 1.0, v174 op_sel:[0,0,0] op_sel_hi:[1,0,1]
  v_fma_mix_f32 v168, v173, 1.0, v175 op_sel:[0,0,0] op_sel_hi:[1,0,1]
  s_waitcnt vmcnt(0)
  v_pk_add_f16 v176, v132, v133
  v_pk_add_f16 v177, v134, v135
  v_fma_mix_f32 v170, v176, 1.0, v177 op_sel:[0,0,0] op_sel_hi:[1,0,1]
  v_fma_mix_f32 v167, v172, 1.0, v174 op_sel:[1,0,1] op_sel_hi:[1,0,1]
  v_cmp_u_f32 vcc, v166, v170
  v_fma_mix_f32 v169, v173, 1.0, v175 op_sel:[1,0,1] op_sel_hi:[1,0,1]
  v_fma_mix_f32 v171, v176, 1.0, v177 op_sel:[1,0,1] op_sel_hi:[1,0,1]
  v_cvt_pk_bf16_f32 v138, v100, v101
  s_cbranch_vccnz sr_103
sj_104:
ex_105:
  v_exp_f32 v172, v166
  v_exp_f32 v173, v167
  v_exp_f32 v174, v168
  v_cvt_pk_bf16_f32 v156, v172, v173
  v_exp_f32 v175, v169
  v_exp_f32 v176, v170
  v_cvt_pk_bf16_f32 v157, v174, v175
  v_mov_b32_dpp v158, v156 row_ror:8 row_mask:0xf bank_mask:0xf
  v_exp_f32 v177, v171
  v_mov_b32_dpp v159, v157 row_ror:8 row_mask:0xf bank_mask:0xf
  v_cvt_pk_bf16_f32 v160, v176, v177
  v_cvt_pk_bf16_f32 v139, v102, v103
  v_mfma_f32_16x16x32_bf16 v[178:181], v[152:155], v[156:159], 0
  s_waitcnt lgkmcnt(0)
  v_mov_b32_dpp v161, v160 row_ror:8 row_mask:0xf bank_mask:0xf
  v_mfma_f32_16x16x32_bf16 v[182:185], v[144:147], v[156:159], 0
  s_nop 0
  v_mfma_f32_16x16x32_bf16 v[178:181], v[140:143], v[160:163], v[178:181]
  v_mfma_f32_16x16x32_bf16 v[182:185], v[136:139], v[160:163], v[182:185]
  v_mfma_f32_16x16x32_bf16 v[186:189], v[148:151], v[156:159], 0
  v_mfma_f32_16x16x32_bf16 v[186:189], v[138:141], v[160:163], v[186:189]
  s_mov_b64 exec, s[62:63]
  v_rcp_f32 v164, v180
  s_nop 0
  v_pk_mul_f32 v[178:179], v[178:179], v[164:165] op_sel_hi:[1,0]
  v_pk_mul_f32 v[182:183], v[182:183], v[164:165] op_sel_hi:[1,0]
  v_pk_mul_f32 v[184:185], v[184:185], v[164:165] op_sel_hi:[1,0]
  v_cvt_pk_f16_f32 v64, v178, v179
  v_cvt_pk_f16_f32 v60, v182, v183
  v_pk_mul_f32 v[186:187], v[186:187], v[164:165] op_sel_hi:[1,0]
  v_pk_mul_f32 v[188:189], v[188:189], v[164:165] op_sel_hi:[1,0]
  v_cvt_pk_f16_f32 v61, v184, v185
  v_cvt_pk_f16_f32 v62, v186, v187
  v_cvt_pk_f16_f32 v63, v188, v189
  ds_write_b128 v13, v[60:63]
  ds_write_b32 v14, v64
  v_add_f32 v165, v164, v180
  v_cmp_ngt_f32 vcc, s80, v165
  s_mov_b64 exec, -1
  s_nop 0
  s_cbranch_vccnz fx_106
fk_107:
  s_waitcnt lgkmcnt(0)
  s_barrier
  ds_read_b128 v[166:169], v4 offset:13824
  ds_read_b128 v[170:173], v4 offset:14464
  ds_read_b128 v[174:177], v4 offset:15104
  ds_read_b128 v[178:181], v4 offset:15744
  s_mov_b64 exec, s[66:67]
  s_waitcnt lgkmcnt(2)
  v_pk_add_f16 v166, v166, v170
  v_pk_add_f16 v167, v167, v171
  v_pk_add_f16 v168, v168, v172
  v_pk_add_f16 v169, v169, v173
  s_waitcnt lgkmcnt(1)
  v_pk_add_f16 v166, v166, v174
  v_pk_add_f16 v167, v167, v175
  v_pk_add_f16 v168, v168, v176
  v_pk_add_f16 v169, v169, v177
  s_waitcnt lgkmcnt(0)
  v_pk_add_f16 v166, v166, v178
  v_pk_add_f16 v167, v167, v179
  v_pk_add_f16 v168, v168, v180
  v_pk_add_f16 v169, v169, v181
  v_and_or_b32 v166, v166, -2, s61
  buffer_store_dwordx4 v[166:169], v15, s[4:7], s60 offen sc1
  s_mov_b64 exec, -1
  v_permlane32_swap_b32 v96, v100
  v_permlane32_swap_b32 v97, v101
  v_permlane32_swap_b32 v98, v102
  v_permlane32_swap_b32 v99, v103
  v_pk_add_f32 v[96:97], v[96:97], v[100:101]
  v_pk_add_f32 v[98:99], v[98:99], v[102:103]
  v_cvt_pk_bf16_f32 v182, v96, v97
  v_cvt_pk_bf16_f32 v183, v98, v99
  v_min_u32 v182, -2, v182
  ds_write_b64 v26, v[182:183]
  v_permlane32_swap_b32 v88, v92
  v_permlane32_swap_b32 v89, v93
  v_permlane32_swap_b32 v90, v94
  v_permlane32_swap_b32 v91, v95
  v_pk_add_f32 v[88:89], v[88:89], v[92:93]
  v_pk_add_f32 v[90:91], v[90:91], v[94:95]
  v_cvt_pk_bf16_f32 v184, v88, v89
  v_cvt_pk_bf16_f32 v185, v90, v91
  v_min_u32 v184, -2, v184
  ds_write_b64 v43, v[184:185]
  ds_read_b128 v[144:147], v18
  ds_read_b128 v[148:151], v18 offset:1024
  ds_read_b128 v[152:155], v19
  v_xor_b32 v18, 16384, v18
  v_xor_b32 v19, 16384, v19
  v_mov_b32 v88, 0
  v_mov_b32 v89, 0
  v_mov_b32 v90, 0
  v_mov_b32 v91, 0
  v_mov_b32 v92, 0
  v_mov_b32 v93, 0
  v_mov_b32 v94, 0
  v_mov_b32 v95, 0
  v_mov_b32 v96, 0
  v_mov_b32 v97, 0
  v_mov_b32 v98, 0
  v_mov_b32 v99, 0
  v_mov_b32 v100, 0
  v_mov_b32 v101, 0
  v_mov_b32 v102, 0
  v_mov_b32 v103, 0
  s_mov_b32 s81, 0
  s_waitcnt lgkmcnt(0)
  s_barrier
  s_xor_b32 s74, s74, 16384
  s_add_u32 s73, s73, 2097152
  s_xor_b32 s73, s73, 8192
  s_add_u32 s79, s79, 2097152
  s_xor_b32 s79, s79, 8192
  s_add_u32 s21, s72, 524288
  s_xor_b32 s72, s72, s21
  s_lshr_b32 s72, s72, 8
  s_and_b32 s72, s72, 8192
  s_xor_b32 s72, s72, s21
  v_mov_b32 v28, s61
  v_mov_b32 v166, s52
  s_mov_b64 exec, 1
  buffer_store_dword v166, v23, s[12:15], s77 offen sc1
  s_mov_b64 exec, -1
  ds_read_b128 v[170:173], v4 offset:16384
  ds_read_b128 v[174:177], v4 offset:17408
  ds_read_b128 v[178:181], v4 offset:18432
  v_min_u32 v104, -2, v104
  v_min_u32 v108, -2, v108
  s_mov_b32 s90, s70
  s_add_u32 s70, s70, 2097152
  s_xor_b32 s70, s70, 8192
  buffer_store_dwordx4 v[104:107], v36, s[16:19], s90 offen offset:2560 sc1
  buffer_store_dwordx2 v[108:109], v37, s[16:19], s90 offen offset:3072 sc1
  s_waitcnt lgkmcnt(0)
  buffer_store_dwordx4 v[170:173], v4, s[16:19], s90 offen offset:0 sc1
  buffer_store_dwordx4 v[174:177], v4, s[16:19], s90 offen offset:1024 sc1
  buffer_store_dwordx4 v[178:181], v38, s[16:19], s90 offen offset:2048 sc1
  buffer_load_dword v42, v41, s[12:15], s76 offen sc1
nt_108:
  s_barrier
  s_mov_b32 s58, s55
  s_add_u32 s52, s52, 1
  s_and_b32 s21, s52, 3
  s_mul_i32 s56, s21, 122880
  s_add_u32 s21, s52, 1
  s_and_b32 s21, s21, 3
  s_mul_i32 s55, s21, 122880
  s_add_u32 s55, s55, s75
  s_add_u32 s21, s52, 2
  s_and_b32 s21, s21, 3
  s_mul_i32 s57, s21, 122880
  s_add_u32 s21, s52, 3
  s_and_b32 s21, s21, 3
  s_mul_i32 s59, s21, 122880
  s_add_u32 s59, s59, s75
  s_bfe_u32 s61, s52, 0x10001
  s_and_b32 s21, s52, 1
  s_lshl_b32 s60, s21, 19
  s_mov_b32 s54, 0
  s_sleep 3
  s_nop 2
  buffer_load_dwordx4 v[84:87], v190, s[8:11], s58 offen offset:0 sc1
  s_branch top_95
mr_96:
  s_mov_b64 exec, s[22:23]
  s_cbranch_execz ms_109
  buffer_load_dwordx4 v[84:87], v190, s[8:11], s58 offen offset:0 sc1
ms_109:
  s_add_u32 s54, s54, 1
  s_cmp_gt_u32 s54, 131072
  s_cbranch_scc1 end0
  s_waitcnt vmcnt(0)
  s_mov_b64 exec, s[22:23]
  ds_write_b128 v190, v[84:87] offset:0
  v_cmp_eq_u32 s[22:23], -1, v84
  s_mov_b64 exec, -1
  s_or_b64 vcc, s[22:23], s[22:23]
  s_cbranch_scc1 mr_96
  s_branch mo_100
kw_101:
  s_mov_b32 s101, 0
wm_110:
  buffer_load_dword v42, v41, s[12:15], s76 offen sc1
  s_add_u32 s101, s101, 1
  s_cmp_gt_u32 s101, 131072
  s_cbranch_scc1 end0
  s_waitcnt vmcnt(0)
  v_cmp_gt_u32 vcc, s22, v42
  v_readfirstlane_b32 s100, v42
  s_nop 0
  s_cbranch_vccz wm_111
  s_sleep 1
  s_branch wm_110
wm_111:
  s_branch kv_102
mn_97:
  v_max3_u32 v27, v48, v49, v50
  v_max3_u32 v27, v27, v51, v52
  v_max3_u32 v27, v27, v53, v54
  v_max3_u32 v27, v27, v55, v56
  v_max3_u32 v27, v27, v57, v58
  v_max3_u32 v27, v27, v59, v60
  v_max3_u32 v27, v27, v61, v62
  v_max3_u32 v27, v27, v63, v64
  v_max3_u32 v27, v27, v65, v66
  v_max3_u32 v27, v27, v67, v68
  v_max3_u32 v27, v27, v69, v70
  v_max3_u32 v27, v27, v71, v72
  v_max3_u32 v27, v27, v73, v74
  v_max3_u32 v27, v27, v75, v76
  v_max3_u32 v27, v27, v77, v78
  v_max3_u32 v27, v27, v79, v80
  v_max3_u32 v27, v27, v81, v82
  v_max3_u32 v27, v27, v83, v84
  v_max3_u32 v27, v27, v85, v86
  v_max3_u32 v27, v27, v87, v87
  v_cmp_eq_u32 vcc, -1, v27
  s_cmp_eq_u32 s52, 0
  s_cbranch_scc1 mk_98
  s_cbranch_vccz mk_98
  s_waitcnt lgkmcnt(0)
  s_barrier
  s_nop 7
  v_mov_b32 v88, 0
  v_mov_b32 v89, 0
  v_mov_b32 v90, 0
  v_mov_b32 v91, 0
  v_mov_b32 v92, 0
  v_mov_b32 v93, 0
  v_mov_b32 v94, 0
  v_mov_b32 v95, 0
  v_mov_b32 v96, 0
  v_mov_b32 v97, 0
  v_mov_b32 v98, 0
  v_mov_b32 v99, 0
  v_mov_b32 v100, 0
  v_mov_b32 v101, 0
  v_mov_b32 v102, 0
  v_mov_b32 v103, 0
  s_mov_b64 s[22:23], -1
  s_branch mr_96
sr_103:
  s_mov_b32 s54, 0
sr_112:
  s_mov_b64 exec, vcc
  buffer_load_dwordx4 v[124:127], v9, s[8:11], s56 offen sc1
  buffer_load_dwordx4 v[128:131], v9, s[8:11], s56 offen offset:1024 sc1
  buffer_load_dwordx4 v[132:135], v10, s[8:11], s56 offen sc1
  s_mov_b64 exec, -1
  s_add_u32 s54, s54, 1
  s_cmp_gt_u32 s54, 131072
  s_cbranch_scc1 end0
  s_and_b32 s21, s54, 31
  s_cbranch_scc0 sr_113
  s_waitcnt vmcnt(0)
  v_pk_add_f16 v172, v124, v126
  v_pk_add_f16 v173, v125, v127
  v_pk_add_f16 v174, v128, v130
  v_pk_add_f16 v175, v129, v131
  v_fma_mix_f32 v166, v172, 1.0, v174 op_sel:[0,0,0] op_sel_hi:[1,0,1]
  v_fma_mix_f32 v168, v173, 1.0, v175 op_sel:[0,0,0] op_sel_hi:[1,0,1]
  v_pk_add_f16 v176, v132, v133
  v_pk_add_f16 v177, v134, v135
  v_add_f32 v27, v166, v168
  v_fma_mix_f32 v170, v176, 1.0, v177 op_sel:[0,0,0] op_sel_hi:[1,0,1]
  v_fma_mix_f32 v167, v172, 1.0, v174 op_sel:[1,0,1] op_sel_hi:[1,0,1]
  v_cmp_u_f32 vcc, v27, v170
  v_fma_mix_f32 v169, v173, 1.0, v175 op_sel:[1,0,1] op_sel_hi:[1,0,1]
  v_fma_mix_f32 v171, v176, 1.0, v177 op_sel:[1,0,1] op_sel_hi:[1,0,1]
  s_cbranch_vccnz sr_112
  s_branch sj_104
sr_113:
  s_waitcnt vmcnt(0)
  v_pk_add_f16 v172, v124, v126
  v_pk_add_f16 v173, v125, v127
  v_pk_add_f16 v174, v128, v130
  v_pk_add_f16 v175, v129, v131
  v_fma_mix_f32 v166, v172, 1.0, v174 op_sel:[0,0,0] op_sel_hi:[1,0,1]
  v_fma_mix_f32 v168, v173, 1.0, v175 op_sel:[0,0,0] op_sel_hi:[1,0,1]
  v_pk_add_f16 v176, v132, v133
  v_pk_add_f16 v177, v134, v135
  v_add_f32 v27, v166, v168
  v_fma_mix_f32 v170, v176, 1.0, v177 op_sel:[0,0,0] op_sel_hi:[1,0,1]
  v_fma_mix_f32 v167, v172, 1.0, v174 op_sel:[1,0,1] op_sel_hi:[1,0,1]
  v_cmp_u_f32 vcc, v27, v170
  v_fma_mix_f32 v169, v173, 1.0, v175 op_sel:[1,0,1] op_sel_hi:[1,0,1]
  v_fma_mix_f32 v171, v176, 1.0, v177 op_sel:[1,0,1] op_sel_hi:[1,0,1]
  v_max3_u32 v27, v124, v126, v128
  v_max3_u32 v27, v27, v130, v132
  v_max3_u32 v27, v27, v133, v134
  v_max3_u32 v27, v27, v135, v135
  v_cmp_eq_u32 vcc, -1, v27
  s_nop 1
  s_cbranch_vccnz sr_112
  s_branch sj_104
fx_106:
  s_cmp_eq_u32 s81, 1
  s_cbranch_scc1 fk_107
  s_mov_b32 s81, 1
  v_max3_f32 v164, v166, v167, v168
  v_max3_f32 v165, v169, v170, v171
  v_max_f32 v164, v164, v165
  s_nop 1
  v_max_f32_dpp v164, v164, v164 row_ror:8 row_mask:0xf bank_mask:0xf
  v_mov_b32 v165, v164
  s_nop 1
  v_permlane32_swap_b32 v164, v165
  v_max_f32 v164, v164, v165
  v_mov_b32 v165, v164
  s_nop 1
  v_permlane16_swap_b32 v164, v165
  v_max_f32 v164, v164, v165
  v_sub_f32 v166, v166, v164
  v_sub_f32 v167, v167, v164
  v_sub_f32 v168, v168, v164
  v_sub_f32 v169, v169, v164
  v_sub_f32 v170, v170, v164
  v_sub_f32 v171, v171, v164
  s_branch ex_105
last_99:
  v_smfmac_f32_16x16x64_bf16 v[96:99], v[52:55], a[8:15], v22
  v_smfmac_f32_16x16x64_bf16 v[100:103], v[52:55], a[88:95], v22
  v_smfmac_f32_16x16x64_bf16 v[96:99], v[56:59], a[16:23], v22
  v_smfmac_f32_16x16x64_bf16 v[100:103], v[56:59], a[96:103], v22
  v_smfmac_f32_16x16x64_bf16 v[96:99], v[60:63], a[24:31], v22
  v_smfmac_f32_16x16x64_bf16 v[96:99], v[64:67], a[32:39], v22
  v_smfmac_f32_16x16x64_bf16 v[96:99], v[68:71], a[40:47], v22
  v_smfmac_f32_16x16x64_bf16 v[96:99], v[72:75], a[48:55], v22
  v_smfmac_f32_16x16x64_bf16 v[96:99], v[76:79], a[56:63], v22
  v_smfmac_f32_16x16x64_bf16 v[96:99], v[80:83], a[64:71], v22
  v_smfmac_f32_16x16x64_bf16 v[96:99], v[84:87], a[72:79], v22
  v_smfmac_f32_16x16x64_bf16 v[100:103], v[60:63], a[104:111], v22
  v_smfmac_f32_16x16x64_bf16 v[100:103], v[64:67], a[112:119], v22
  v_smfmac_f32_16x16x64_bf16 v[100:103], v[68:71], a[120:127], v22
  v_smfmac_f32_16x16x64_bf16 v[100:103], v[72:75], a[128:135], v22
  v_smfmac_f32_16x16x64_bf16 v[100:103], v[76:79], a[136:143], v22
  v_smfmac_f32_16x16x64_bf16 v[100:103], v[80:83], a[144:151], v22
  v_smfmac_f32_16x16x64_bf16 v[100:103], v[84:87], a[152:159], v22
  s_nop 7
  v_permlane32_swap_b32 v96, v100
  v_permlane32_swap_b32 v97, v101
  v_permlane32_swap_b32 v98, v102
  v_permlane32_swap_b32 v99, v103
  v_pk_add_f32 v[96:97], v[96:97], v[100:101]
  v_pk_add_f32 v[98:99], v[98:99], v[102:103]
  v_cvt_pk_bf16_f32 v182, v96, v97
  v_cvt_pk_bf16_f32 v183, v98, v99
  v_min_u32 v182, -2, v182
  ds_write_b64 v26, v[182:183]
  v_permlane32_swap_b32 v88, v92
  v_permlane32_swap_b32 v89, v93
  v_permlane32_swap_b32 v90, v94
  v_permlane32_swap_b32 v91, v95
  v_pk_add_f32 v[88:89], v[88:89], v[92:93]
  v_pk_add_f32 v[90:91], v[90:91], v[94:95]
  v_cvt_pk_bf16_f32 v184, v88, v89
  v_cvt_pk_bf16_f32 v185, v90, v91
  v_min_u32 v184, -2, v184
  ds_write_b64 v43, v[184:185]
  s_waitcnt lgkmcnt(0)
  s_barrier
  ds_read_b128 v[170:173], v4 offset:16384
  ds_read_b128 v[174:177], v4 offset:17408
  ds_read_b128 v[178:181], v4 offset:18432
  v_min_u32 v104, -2, v104
  v_min_u32 v108, -2, v108
  s_mov_b32 s90, s70
  s_add_u32 s70, s70, 2097152
  s_xor_b32 s70, s70, 8192
  buffer_store_dwordx4 v[104:107], v36, s[16:19], s90 offen offset:2560 sc1
  buffer_store_dwordx2 v[108:109], v37, s[16:19], s90 offen offset:3072 sc1
  s_waitcnt lgkmcnt(0)
  buffer_store_dwordx4 v[170:173], v4, s[16:19], s90 offen offset:0 sc1
  buffer_store_dwordx4 v[174:177], v4, s[16:19], s90 offen offset:1024 sc1
  buffer_store_dwordx4 v[178:181], v38, s[16:19], s90 offen offset:2048 sc1
  s_waitcnt vmcnt(0)
  v_mov_b32 v166, 64
  s_mov_b64 exec, 1
  buffer_store_dword v166, v23, s[12:15], s77 offen sc1
  s_mov_b64 exec, -1
  s_branch chain_done
E_27:
  v_add_u32 v190, 0, v4
  ds_read_b128 v[48:51], v4 offset:0
  ds_read_b128 v[52:55], v4 offset:1024
  ds_read_b128 v[56:59], v4 offset:2048
  s_waitcnt lgkmcnt(0)
  s_branch mo_119
  .p2align 3
top_114:
  s_waitcnt vmcnt(2)
  ds_write_b128 v190, v[48:51] offset:0
  v_cmp_eq_u32 s[22:23], -1, v48
  s_waitcnt vmcnt(1)
  ds_write_b128 v190, v[52:55] offset:1024
  v_cmp_eq_u32 s[98:99], -1, v52
  s_waitcnt vmcnt(0)
  ds_write_b128 v190, v[56:59] offset:2048
  v_cmp_eq_u32 s[100:101], -1, v56
  s_or_b64 vcc, s[22:23], s[98:99]
  s_or_b64 vcc, vcc, s[100:101]
  s_cbranch_scc1 mr_115
mo_119:
  s_waitcnt lgkmcnt(0)
  s_barrier
  ds_read_b128 v[60:63], v4 offset:3072
  ds_read_b128 v[64:67], v4 offset:4096
  v_smfmac_f32_16x16x64_bf16 v[92:95], v[48:51], a[240:247], v22
  ds_read_b128 v[68:71], v4 offset:5120
  v_smfmac_f32_16x16x64_bf16 v[88:91], v[48:51], a[160:167], v22
  ds_read_b128 v[72:75], v4 offset:6144
  v_smfmac_f32_16x16x64_bf16 v[92:95], v[52:55], a[248:255], v22
  ds_read_b128 v[76:79], v4 offset:7168
  v_smfmac_f32_16x16x64_bf16 v[88:91], v[52:55], a[168:175], v22
  ds_read_b128 v[80:83], v4 offset:8192
  v_smfmac_f32_16x16x64_bf16 v[92:95], v[56:59], v[192:199], v22
  ds_read_b128 v[84:87], v4 offset:9216
  v_smfmac_f32_16x16x64_bf16 v[88:91], v[56:59], a[176:183], v22
  s_waitcnt lgkmcnt(6)
  v_smfmac_f32_16x16x64_bf16 v[92:95], v[60:63], v[200:207], v22
  v_smfmac_f32_16x16x64_bf16 v[88:91], v[60:63], a[184:191], v22
  s_waitcnt lgkmcnt(5)
  v_smfmac_f32_16x16x64_bf16 v[92:95], v[64:67], v[208:215], v22
  s_waitcnt lgkmcnt(4)
  v_smfmac_f32_16x16x64_bf16 v[92:95], v[68:71], v[216:223], v22
  s_waitcnt lgkmcnt(3)
  v_smfmac_f32_16x16x64_bf16 v[92:95], v[72:75], v[224:231], v22
  s_waitcnt lgkmcnt(2)
  v_smfmac_f32_16x16x64_bf16 v[92:95], v[76:79], v[232:239], v22
  s_waitcnt lgkmcnt(1)
  v_smfmac_f32_16x16x64_bf16 v[92:95], v[80:83], v[240:247], v22
  s_waitcnt lgkmcnt(0)
  v_smfmac_f32_16x16x64_bf16 v[92:95], v[84:87], v[248:255], v22
  v_smfmac_f32_16x16x64_bf16 v[88:91], v[64:67], a[192:199], v22
  v_smfmac_f32_16x16x64_bf16 v[88:91], v[68:71], a[200:207], v22
  v_smfmac_f32_16x16x64_bf16 v[88:91], v[72:75], a[208:215], v22
  v_permlane32_swap_b32 v92, v93
  v_smfmac_f32_16x16x64_bf16 v[88:91], v[76:79], a[216:223], v22
  v_permlane32_swap_b32 v94, v95
  v_smfmac_f32_16x16x64_bf16 v[88:91], v[80:83], a[224:231], v22
  v_permlane32_swap_b32 v93, v92
  v_smfmac_f32_16x16x64_bf16 v[88:91], v[84:87], a[232:239], v22
  v_permlane32_swap_b32 v95, v94
  v_pk_mul_f32 v[120:121], v[92:93], v[24:25] op_sel:[1,0] op_sel_hi:[0,1]
  v_pk_mul_f32 v[122:123], v[94:95], v[24:25] op_sel:[1,0] op_sel_hi:[0,1]
  s_nop 4
  v_pk_fma_f32 v[88:89], v[88:89], v[24:25], v[120:121]
  v_pk_fma_f32 v[90:91], v[90:91], v[24:25], v[122:123]
  v_cvt_pk_bf16_f32 v120, v88, v89
  v_cvt_pk_bf16_f32 v121, v90, v91
  ds_write_b64 v6, v[120:121]
  v_cmp_u_f32 vcc, v88, v89
  v_cmp_u_f32 s[22:23], v90, v91
  s_nop 1
  s_or_b64 vcc, vcc, s[22:23]
  s_cbranch_vccnz mn_116
mk_117:
  s_waitcnt lgkmcnt(0)
  s_barrier
  ds_read_b64_tr_b16 v[104:105], v7 offset:0
  ds_read_b64_tr_b16 v[106:107], v7 offset:768
  ds_read_b64_tr_b16 v[108:109], v7 offset:1536
  ds_read_b64 v[140:141], v11
  s_cmp_eq_u32 s52, 63
  s_cbranch_scc1 last_118
  s_waitcnt lgkmcnt(2)
  v_mfma_f32_16x16x32_bf16 v[120:123], v[112:115], v[104:107], 0
  s_waitcnt lgkmcnt(1)
  v_mfma_f32_16x16x32_bf16 v[120:123], v[116:119], v[108:111], v[120:123]
  s_mov_b64 exec, s[64:65]
  s_nop 6
  v_cvt_pk_f16_f32 v120, v120, v121
  v_cvt_pk_f16_f32 v121, v122, v123
  buffer_store_dwordx2 v[120:121], v8, s[8:11], s56 offen sc1
  s_mov_b64 exec, -1
  s_sleep 3
  s_nop 1
  v_smfmac_f32_16x16x64_bf16 v[96:99], v[48:51], a[0:7], v22
  v_smfmac_f32_16x16x64_bf16 v[100:103], v[48:51], a[80:87], v22
  v_smfmac_f32_16x16x64_bf16 v[96:99], v[52:55], a[8:15], v22
  v_smfmac_f32_16x16x64_bf16 v[100:103], v[52:55], a[88:95], v22
  v_smfmac_f32_16x16x64_bf16 v[96:99], v[56:59], a[16:23], v22
  v_smfmac_f32_16x16x64_bf16 v[100:103], v[56:59], a[96:103], v22
  v_smfmac_f32_16x16x64_bf16 v[96:99], v[60:63], a[24:31], v22
  v_smfmac_f32_16x16x64_bf16 v[96:99], v[64:67], a[32:39], v22
  v_smfmac_f32_16x16x64_bf16 v[96:99], v[68:71], a[40:47], v22
  v_smfmac_f32_16x16x64_bf16 v[96:99], v[72:75], a[48:55], v22
  v_smfmac_f32_16x16x64_bf16 v[96:99], v[76:79], a[56:63], v22
  buffer_load_dwordx4 v[124:127], v9, s[8:11], s56 offen sc1
  v_smfmac_f32_16x16x64_bf16 v[96:99], v[80:83], a[64:71], v22
  buffer_load_dwordx4 v[128:131], v9, s[8:11], s56 offen offset:1024 sc1
  v_smfmac_f32_16x16x64_bf16 v[96:99], v[84:87], a[72:79], v22
  buffer_load_dwordx4 v[132:135], v10, s[8:11], s56 offen sc1
  v_smfmac_f32_16x16x64_bf16 v[100:103], v[60:63], a[104:111], v22
  v_smfmac_f32_16x16x64_bf16 v[100:103], v[64:67], a[112:119], v22
  v_smfmac_f32_16x16x64_bf16 v[100:103], v[68:71], a[120:127], v22
  v_smfmac_f32_16x16x64_bf16 v[100:103], v[72:75], a[128:135], v22
  v_cvt_pk_bf16_f32 v136, v96, v97
  v_smfmac_f32_16x16x64_bf16 v[100:103], v[76:79], a[136:143], v22
  v_cvt_pk_bf16_f32 v137, v98, v99
  v_smfmac_f32_16x16x64_bf16 v[100:103], v[80:83], a[144:151], v22
  v_smfmac_f32_16x16x64_bf16 v[100:103], v[84:87], a[152:159], v22
  s_waitcnt vmcnt(2)
  v_pk_add_f16 v172, v124, v126
  v_pk_add_f16 v173, v125, v127
  s_waitcnt vmcnt(1)
  v_pk_add_f16 v174, v128, v130
  v_pk_add_f16 v175, v129, v131
  v_fma_mix_f32 v166, v172, 1.0, v174 op_sel:[0,0,0] op_sel_hi:[1,0,1]
  v_fma_mix_f32 v168, v173, 1.0, v175 op_sel:[0,0,0] op_sel_hi:[1,0,1]
  s_waitcnt vmcnt(0)
  v_pk_add_f16 v176, v132, v133
  v_pk_add_f16 v177, v134, v135
  v_fma_mix_f32 v170, v176, 1.0, v177 op_sel:[0,0,0] op_sel_hi:[1,0,1]
  v_fma_mix_f32 v167, v172, 1.0, v174 op_sel:[1,0,1] op_sel_hi:[1,0,1]
  v_cmp_u_f32 vcc, v166, v170
  v_fma_mix_f32 v169, v173, 1.0, v175 op_sel:[1,0,1] op_sel_hi:[1,0,1]
  v_fma_mix_f32 v171, v176, 1.0, v177 op_sel:[1,0,1] op_sel_hi:[1,0,1]
  v_cvt_pk_bf16_f32 v138, v100, v101
  s_cbranch_vccnz sr_120
sj_121:
ex_122:
  v_exp_f32 v172, v166
  v_exp_f32 v173, v167
  v_exp_f32 v174, v168
  v_cvt_pk_bf16_f32 v156, v172, v173
  v_exp_f32 v175, v169
  v_exp_f32 v176, v170
  v_cvt_pk_bf16_f32 v157, v174, v175
  v_mov_b32_dpp v158, v156 row_ror:8 row_mask:0xf bank_mask:0xf
  v_exp_f32 v177, v171
  v_mov_b32_dpp v159, v157 row_ror:8 row_mask:0xf bank_mask:0xf
  v_cvt_pk_bf16_f32 v160, v176, v177
  v_cvt_pk_bf16_f32 v139, v102, v103
  v_mfma_f32_16x16x32_bf16 v[178:181], v[152:155], v[156:159], 0
  s_waitcnt lgkmcnt(0)
  v_mov_b32_dpp v161, v160 row_ror:8 row_mask:0xf bank_mask:0xf
  v_mfma_f32_16x16x32_bf16 v[182:185], v[144:147], v[156:159], 0
  s_nop 0
  v_mfma_f32_16x16x32_bf16 v[178:181], v[140:143], v[160:163], v[178:181]
  v_mfma_f32_16x16x32_bf16 v[182:185], v[136:139], v[160:163], v[182:185]
  v_mfma_f32_16x16x32_bf16 v[186:189], v[148:151], v[156:159], 0
  v_mfma_f32_16x16x32_bf16 v[186:189], v[138:141], v[160:163], v[186:189]
  s_mov_b64 exec, s[62:63]
  v_rcp_f32 v164, v180
  s_nop 0
  v_pk_mul_f32 v[178:179], v[178:179], v[164:165] op_sel_hi:[1,0]
  v_pk_mul_f32 v[182:183], v[182:183], v[164:165] op_sel_hi:[1,0]
  v_pk_mul_f32 v[184:185], v[184:185], v[164:165] op_sel_hi:[1,0]
  v_cvt_pk_f16_f32 v64, v178, v179
  v_cvt_pk_f16_f32 v60, v182, v183
  v_pk_mul_f32 v[186:187], v[186:187], v[164:165] op_sel_hi:[1,0]
  v_pk_mul_f32 v[188:189], v[188:189], v[164:165] op_sel_hi:[1,0]
  v_cvt_pk_f16_f32 v61, v184, v185
  v_cvt_pk_f16_f32 v62, v186, v187
  v_cvt_pk_f16_f32 v63, v188, v189
  ds_write_b128 v13, v[60:63]
  ds_write_b32 v14, v64
  v_add_f32 v165, v164, v180
  v_cmp_ngt_f32 vcc, s80, v165
  s_mov_b64 exec, -1
  s_nop 0
  s_cbranch_vccnz fx_123
fk_124:
  s_waitcnt lgkmcnt(0)
  s_barrier
  s_add_u32 m0, s74, 9216
  s_add_u32 s21, s72, 32768
  buffer_load_dwordx4 v32, s[16:19], s21 offen sc1 lds
  s_add_u32 m0, s74, 4096
  s_add_u32 s21, s79, 131072
  buffer_load_dwordx4 v4, s[16:19], s21 offen offset:1024 sc1 lds
  s_xor_b32 s74, s74, 16384
  s_add_u32 s73, s73, 2097152
  s_xor_b32 s73, s73, 8192
  s_add_u32 s79, s79, 2097152
  s_xor_b32 s79, s79, 8192
  s_add_u32 s21, s72, 524288
  s_xor_b32 s72, s72, s21
  s_lshr_b32 s72, s72, 8
  s_and_b32 s72, s72, 8192
  s_xor_b32 s72, s72, s21
  s_nop 15
  s_nop 3
  v_permlane32_swap_b32 v96, v100
  v_permlane32_swap_b32 v97, v101
  v_permlane32_swap_b32 v98, v102
  v_permlane32_swap_b32 v99, v103
  v_pk_add_f32 v[96:97], v[96:97], v[100:101]
  v_pk_add_f32 v[98:99], v[98:99], v[102:103]
  v_cvt_pk_bf16_f32 v182, v96, v97
  v_cvt_pk_bf16_f32 v183, v98, v99
  v_min_u32 v182, -2, v182
  ds_write_b64 v26, v[182:183]
  ds_read_b128 v[144:147], v18
  ds_read_b128 v[148:151], v18 offset:1024
  ds_read_b128 v[152:155], v19
  ds_read_b128 v[112:115], v20
  ds_read_b64 v[116:117], v21
  v_xor_b32 v18, 16384, v18
  v_xor_b32 v19, 16384, v19
  v_xor_b32 v20, 16384, v20
  v_xor_b32 v21, 16384, v21
  v_mov_b32 v88, 0
  v_mov_b32 v89, 0
  v_mov_b32 v90, 0
  v_mov_b32 v91, 0
  v_mov_b32 v92, 0
  v_mov_b32 v93, 0
  v_mov_b32 v94, 0
  v_mov_b32 v95, 0
  v_mov_b32 v96, 0
  v_mov_b32 v97, 0
  v_mov_b32 v98, 0
  v_mov_b32 v99, 0
  v_mov_b32 v100, 0
  v_mov_b32 v101, 0
  v_mov_b32 v102, 0
  v_mov_b32 v103, 0
  s_mov_b32 s81, 0
  s_waitcnt lgkmcnt(0)
  s_barrier
  s_mov_b64 exec, s[64:65]
  buffer_store_dwordx2 v[28:29], v8, s[8:11], s57 offen sc1
  s_mov_b64 exec, s[62:63]
  buffer_store_dword v28, v17, s[8:11], s59 offen sc1
  s_mov_b64 exec, -1
  s_sleep 6
  s_nop 3
  buffer_load_dwordx4 v[68:71], v16, s[4:7], s60 offen sc1
  s_sleep 3
  s_nop 1
  buffer_load_dwordx4 v[72:75], v16, s[4:7], s60 offen sc1
  s_mov_b32 s54, 0
pp_126:
  s_waitcnt vmcnt(1)
  v_mfma_f32_16x16x32_f16 v[120:123], v[44:47], v[68:71], 0
  v_bitop3_b32 v27, v68, s61, 1 bitop3:0x28
  v_cmp_ne_u32 vcc, 0, v27
  s_nop 1
  s_cbranch_vccnz p2_128
  s_nop 2
pg_127:
  v_add_f32_dpp v120, v120, v120 row_ror:8 row_mask:0xf bank_mask:0xf
  v_add_f32_dpp v121, v121, v121 row_ror:8 row_mask:0xf bank_mask:0xf
  s_mov_b64 exec, s[62:63]
  v_cvt_pk_bf16_f32 v120, v120, v121
  v_min_u32 v120, -2, v120
  buffer_store_dword v120, v17, s[8:11], s55 offen sc1
  s_mov_b64 exec, -1
nt_125:
  s_barrier
  s_mov_b32 s58, s55
  s_add_u32 s52, s52, 1
  s_and_b32 s21, s52, 3
  s_mul_i32 s56, s21, 122880
  s_add_u32 s21, s52, 1
  s_and_b32 s21, s21, 3
  s_mul_i32 s55, s21, 122880
  s_add_u32 s55, s55, s75
  s_add_u32 s21, s52, 2
  s_and_b32 s21, s21, 3
  s_mul_i32 s57, s21, 122880
  s_add_u32 s21, s52, 3
  s_and_b32 s21, s21, 3
  s_mul_i32 s59, s21, 122880
  s_add_u32 s59, s59, s75
  s_bfe_u32 s61, s52, 0x10001
  s_and_b32 s21, s52, 1
  s_lshl_b32 s60, s21, 19
  s_mov_b32 s54, 0
  s_sleep 3
  s_nop 2
  buffer_load_dwordx4 v[48:51], v190, s[8:11], s58 offen offset:0 sc1
  buffer_load_dwordx4 v[52:55], v190, s[8:11], s58 offen offset:1024 sc1
  buffer_load_dwordx4 v[56:59], v190, s[8:11], s58 offen offset:2048 sc1
  s_branch top_114
mr_115:
  s_mov_b64 exec, s[22:23]
  s_cbranch_execz ms_129
  buffer_load_dwordx4 v[48:51], v190, s[8:11], s58 offen offset:0 sc1
ms_129:
  s_mov_b64 exec, s[98:99]
  s_cbranch_execz ms_130
  buffer_load_dwordx4 v[52:55], v190, s[8:11], s58 offen offset:1024 sc1
ms_130:
  s_mov_b64 exec, s[100:101]
  s_cbranch_execz ms_131
  buffer_load_dwordx4 v[56:59], v190, s[8:11], s58 offen offset:2048 sc1
ms_131:
  s_add_u32 s54, s54, 1
  s_cmp_gt_u32 s54, 131072
  s_cbranch_scc1 end0
  s_waitcnt vmcnt(0)
  s_mov_b64 exec, s[22:23]
  ds_write_b128 v190, v[48:51] offset:0
  v_cmp_eq_u32 s[22:23], -1, v48
  s_mov_b64 exec, s[98:99]
  ds_write_b128 v190, v[52:55] offset:1024
  v_cmp_eq_u32 s[98:99], -1, v52
  s_mov_b64 exec, s[100:101]
  ds_write_b128 v190, v[56:59] offset:2048
  v_cmp_eq_u32 s[100:101], -1, v56
  s_mov_b64 exec, -1
  s_or_b64 vcc, s[22:23], s[98:99]
  s_or_b64 vcc, vcc, s[100:101]
  s_cbranch_scc1 mr_115
  s_branch mo_119
mn_116:
  v_max3_u32 v27, v48, v49, v50
  v_max3_u32 v27, v27, v51, v52
  v_max3_u32 v27, v27, v53, v54
  v_max3_u32 v27, v27, v55, v56
  v_max3_u32 v27, v27, v57, v58
  v_max3_u32 v27, v27, v59, v60
  v_max3_u32 v27, v27, v61, v62
  v_max3_u32 v27, v27, v63, v64
  v_max3_u32 v27, v27, v65, v66
  v_max3_u32 v27, v27, v67, v68
  v_max3_u32 v27, v27, v69, v70
  v_max3_u32 v27, v27, v71, v72
  v_max3_u32 v27, v27, v73, v74
  v_max3_u32 v27, v27, v75, v76
  v_max3_u32 v27, v27, v77, v78
  v_max3_u32 v27, v27, v79, v80
  v_max3_u32 v27, v27, v81, v82
  v_max3_u32 v27, v27, v83, v84
  v_max3_u32 v27, v27, v85, v86
  v_max3_u32 v27, v27, v87, v87
  v_cmp_eq_u32 vcc, -1, v27
  s_cmp_eq_u32 s52, 0
  s_cbranch_scc1 mk_117
  s_cbranch_vccz mk_117
  s_waitcnt lgkmcnt(0)
  s_barrier
  s_nop 7
  v_mov_b32 v88, 0
  v_mov_b32 v89, 0
  v_mov_b32 v90, 0
  v_mov_b32 v91, 0
  v_mov_b32 v92, 0
  v_mov_b32 v93, 0
  v_mov_b32 v94, 0
  v_mov_b32 v95, 0
  v_mov_b32 v96, 0
  v_mov_b32 v97, 0
  v_mov_b32 v98, 0
  v_mov_b32 v99, 0
  v_mov_b32 v100, 0
  v_mov_b32 v101, 0
  v_mov_b32 v102, 0
  v_mov_b32 v103, 0
  s_mov_b64 s[22:23], -1
  s_mov_b64 s[98:99], -1
  s_mov_b64 s[100:101], -1
  s_branch mr_115
sr_120:
  s_mov_b32 s54, 0
sr_132:
  s_mov_b64 exec, vcc
  buffer_load_dwordx4 v[124:127], v9, s[8:11], s56 offen sc1
  buffer_load_dwordx4 v[128:131], v9, s[8:11], s56 offen offset:1024 sc1
  buffer_load_dwordx4 v[132:135], v10, s[8:11], s56 offen sc1
  s_mov_b64 exec, -1
  s_add_u32 s54, s54, 1
  s_cmp_gt_u32 s54, 131072
  s_cbranch_scc1 end0
  s_and_b32 s21, s54, 31
  s_cbranch_scc0 sr_133
  s_waitcnt vmcnt(0)
  v_pk_add_f16 v172, v124, v126
  v_pk_add_f16 v173, v125, v127
  v_pk_add_f16 v174, v128, v130
  v_pk_add_f16 v175, v129, v131
  v_fma_mix_f32 v166, v172, 1.0, v174 op_sel:[0,0,0] op_sel_hi:[1,0,1]
  v_fma_mix_f32 v168, v173, 1.0, v175 op_sel:[0,0,0] op_sel_hi:[1,0,1]
  v_pk_add_f16 v176, v132, v133
  v_pk_add_f16 v177, v134, v135
  v_add_f32 v27, v166, v168
  v_fma_mix_f32 v170, v176, 1.0, v177 op_sel:[0,0,0] op_sel_hi:[1,0,1]
  v_fma_mix_f32 v167, v172, 1.0, v174 op_sel:[1,0,1] op_sel_hi:[1,0,1]
  v_cmp_u_f32 vcc, v27, v170
  v_fma_mix_f32 v169, v173, 1.0, v175 op_sel:[1,0,1] op_sel_hi:[1,0,1]
  v_fma_mix_f32 v171, v176, 1.0, v177 op_sel:[1,0,1] op_sel_hi:[1,0,1]
  s_cbranch_vccnz sr_132
  s_branch sj_121
sr_133:
  s_waitcnt vmcnt(0)
  v_pk_add_f16 v172, v124, v126
  v_pk_add_f16 v173, v125, v127
  v_pk_add_f16 v174, v128, v130
  v_pk_add_f16 v175, v129, v131
  v_fma_mix_f32 v166, v172, 1.0, v174 op_sel:[0,0,0] op_sel_hi:[1,0,1]
  v_fma_mix_f32 v168, v173, 1.0, v175 op_sel:[0,0,0] op_sel_hi:[1,0,1]
  v_pk_add_f16 v176, v132, v133
  v_pk_add_f16 v177, v134, v135
  v_add_f32 v27, v166, v168
  v_fma_mix_f32 v170, v176, 1.0, v177 op_sel:[0,0,0] op_sel_hi:[1,0,1]
  v_fma_mix_f32 v167, v172, 1.0, v174 op_sel:[1,0,1] op_sel_hi:[1,0,1]
  v_cmp_u_f32 vcc, v27, v170
  v_fma_mix_f32 v169, v173, 1.0, v175 op_sel:[1,0,1] op_sel_hi:[1,0,1]
  v_fma_mix_f32 v171, v176, 1.0, v177 op_sel:[1,0,1] op_sel_hi:[1,0,1]
  v_max3_u32 v27, v124, v126, v128
  v_max3_u32 v27, v27, v130, v132
  v_max3_u32 v27, v27, v133, v134
  v_max3_u32 v27, v27, v135, v135
  v_cmp_eq_u32 vcc, -1, v27
  s_nop 1
  s_cbranch_vccnz sr_132
  s_branch sj_121
fx_123:
  s_cmp_eq_u32 s81, 1
  s_cbranch_scc1 fk_124
  s_mov_b32 s81, 1
  v_max3_f32 v164, v166, v167, v168
  v_max3_f32 v165, v169, v170, v171
  v_max_f32 v164, v164, v165
  s_nop 1
  v_max_f32_dpp v164, v164, v164 row_ror:8 row_mask:0xf bank_mask:0xf
  v_mov_b32 v165, v164
  s_nop 1
  v_permlane32_swap_b32 v164, v165
  v_max_f32 v164, v164, v165
  v_mov_b32 v165, v164
  s_nop 1
  v_permlane16_swap_b32 v164, v165
  v_max_f32 v164, v164, v165
  v_sub_f32 v166, v166, v164
  v_sub_f32 v167, v167, v164
  v_sub_f32 v168, v168, v164
  v_sub_f32 v169, v169, v164
  v_sub_f32 v170, v170, v164
  v_sub_f32 v171, v171, v164
  s_branch ex_122
p2_128:
  buffer_load_dwordx4 v[68:71], v16, s[4:7], s60 offen sc1
  s_waitcnt vmcnt(1)
  v_mfma_f32_16x16x32_f16 v[120:123], v[44:47], v[72:75], 0
  v_bitop3_b32 v27, v72, s61, 1 bitop3:0x28
  v_cmp_ne_u32 vcc, 0, v27
  s_nop 1
  s_cbranch_vccz pg_127
  buffer_load_dwordx4 v[72:75], v16, s[4:7], s60 offen sc1
  s_add_u32 s54, s54, 1
  s_cmp_gt_u32 s54, 131072
  s_cbranch_scc1 end0
  s_branch pp_126
last_118:
  v_smfmac_f32_16x16x64_bf16 v[96:99], v[48:51], a[0:7], v22
  v_smfmac_f32_16x16x64_bf16 v[100:103], v[48:51], a[80:87], v22
  v_smfmac_f32_16x16x64_bf16 v[96:99], v[52:55], a[8:15], v22
  v_smfmac_f32_16x16x64_bf16 v[100:103], v[52:55], a[88:95], v22
  v_smfmac_f32_16x16x64_bf16 v[96:99], v[56:59], a[16:23], v22
  v_smfmac_f32_16x16x64_bf16 v[100:103], v[56:59], a[96:103], v22
  v_smfmac_f32_16x16x64_bf16 v[96:99], v[60:63], a[24:31], v22
  v_smfmac_f32_16x16x64_bf16 v[96:99], v[64:67], a[32:39], v22
  v_smfmac_f32_16x16x64_bf16 v[96:99], v[68:71], a[40:47], v22
  v_smfmac_f32_16x16x64_bf16 v[96:99], v[72:75], a[48:55], v22
  v_smfmac_f32_16x16x64_bf16 v[96:99], v[76:79], a[56:63], v22
  v_smfmac_f32_16x16x64_bf16 v[96:99], v[80:83], a[64:71], v22
  v_smfmac_f32_16x16x64_bf16 v[96:99], v[84:87], a[72:79], v22
  v_smfmac_f32_16x16x64_bf16 v[100:103], v[60:63], a[104:111], v22
  v_smfmac_f32_16x16x64_bf16 v[100:103], v[64:67], a[112:119], v22
  v_smfmac_f32_16x16x64_bf16 v[100:103], v[68:71], a[120:127], v22
  v_smfmac_f32_16x16x64_bf16 v[100:103], v[72:75], a[128:135], v22
  v_smfmac_f32_16x16x64_bf16 v[100:103], v[76:79], a[136:143], v22
  v_smfmac_f32_16x16x64_bf16 v[100:103], v[80:83], a[144:151], v22
  v_smfmac_f32_16x16x64_bf16 v[100:103], v[84:87], a[152:159], v22
  s_nop 7
  v_permlane32_swap_b32 v96, v100
  v_permlane32_swap_b32 v97, v101
  v_permlane32_swap_b32 v98, v102
  v_permlane32_swap_b32 v99, v103
  v_pk_add_f32 v[96:97], v[96:97], v[100:101]
  v_pk_add_f32 v[98:99], v[98:99], v[102:103]
  v_cvt_pk_bf16_f32 v182, v96, v97
  v_cvt_pk_bf16_f32 v183, v98, v99
  v_min_u32 v182, -2, v182
  ds_write_b64 v26, v[182:183]
  s_waitcnt lgkmcnt(0)
  s_barrier
  s_branch chain_done
E_29:
  v_add_u32 v190, 3072, v4
  ds_read_b128 v[60:63], v4 offset:3072
  ds_read_b128 v[64:67], v4 offset:4096
  ds_read_b128 v[68:71], v4 offset:5120
  s_waitcnt lgkmcnt(0)
  s_branch mo_139
  .p2align 3
top_134:
  s_waitcnt vmcnt(2)
  ds_write_b128 v190, v[60:63] offset:0
  v_cmp_eq_u32 s[22:23], -1, v60
  s_waitcnt vmcnt(1)
  ds_write_b128 v190, v[64:67] offset:1024
  v_cmp_eq_u32 s[98:99], -1, v64
  s_waitcnt vmcnt(0)
  ds_write_b128 v190, v[68:71] offset:2048
  v_cmp_eq_u32 s[100:101], -1, v68
  s_or_b64 vcc, s[22:23], s[98:99]
  s_or_b64 vcc, vcc, s[100:101]
  s_cbranch_scc1 mr_135
mo_139:
  s_waitcnt lgkmcnt(0)
  s_barrier
  ds_read_b128 v[48:51], v4 offset:0
  ds_read_b128 v[52:55], v4 offset:1024
  v_smfmac_f32_16x16x64_bf16 v[92:95], v[60:63], v[200:207], v22
  ds_read_b128 v[56:59], v4 offset:2048
  v_smfmac_f32_16x16x64_bf16 v[88:91], v[60:63], a[184:191], v22
  ds_read_b128 v[72:75], v4 offset:6144
  v_smfmac_f32_16x16x64_bf16 v[92:95], v[64:67], v[208:215], v22
  ds_read_b128 v[76:79], v4 offset:7168
  v_smfmac_f32_16x16x64_bf16 v[88:91], v[64:67], a[192:199], v22
  ds_read_b128 v[80:83], v4 offset:8192
  v_smfmac_f32_16x16x64_bf16 v[92:95], v[68:71], v[216:223], v22
  ds_read_b128 v[84:87], v4 offset:9216
  v_smfmac_f32_16x16x64_bf16 v[88:91], v[68:71], a[200:207], v22
  s_waitcnt lgkmcnt(6)
  v_smfmac_f32_16x16x64_bf16 v[92:95], v[48:51], a[240:247], v22
  v_smfmac_f32_16x16x64_bf16 v[88:91], v[48:51], a[160:167], v22
  s_waitcnt lgkmcnt(5)
  v_smfmac_f32_16x16x64_bf16 v[92:95], v[52:55], a[248:255], v22
  s_waitcnt lgkmcnt(4)
  v_smfmac_f32_16x16x64_bf16 v[92:95], v[56:59], v[192:199], v22
  s_waitcnt lgkmcnt(3)
  v_smfmac_f32_16x16x64_bf16 v[92:95], v[72:75], v[224:231], v22
  s_waitcnt lgkmcnt(2)
  v_smfmac_f32_16x16x64_bf16 v[92:95], v[76:79], v[232:239], v22
  s_waitcnt lgkmcnt(1)
  v_smfmac_f32_16x16x64_bf16 v[92:95], v[80:83], v[240:247], v22
  s_waitcnt lgkmcnt(0)
  v_smfmac_f32_16x16x64_bf16 v[92:95], v[84:87], v[248:255], v22
  v_smfmac_f32_16x16x64_bf16 v[88:91], v[52:55], a[168:175], v22
  v_smfmac_f32_16x16x64_bf16 v[88:91], v[56:59], a[176:183], v22
  v_smfmac_f32_16x16x64_bf16 v[88:91], v[72:75], a[208:215], v22
  v_permlane32_swap_b32 v92, v93
  v_smfmac_f32_16x16x64_bf16 v[88:91], v[76:79], a[216:223], v22
  v_permlane32_swap_b32 v94, v95
  v_smfmac_f32_16x16x64_bf16 v[88:91], v[80:83], a[224:231], v22
  v_permlane32_swap_b32 v93, v92
  v_smfmac_f32_16x16x64_bf16 v[88:91], v[84:87], a[232:239], v22
  v_permlane32_swap_b32 v95, v94
  v_pk_mul_f32 v[120:121], v[92:93], v[24:25] op_sel:[1,0] op_sel_hi:[0,1]
  v_pk_mul_f32 v[122:123], v[94:95], v[24:25] op_sel:[1,0] op_sel_hi:[0,1]
  s_nop 4
  v_pk_fma_f32 v[88:89], v[88:89], v[24:25], v[120:121]
  v_pk_fma_f32 v[90:91], v[90:91], v[24:25], v[122:123]
  v_cvt_pk_bf16_f32 v120, v88, v89
  v_cvt_pk_bf16_f32 v121, v90, v91
  ds_write_b64 v6, v[120:121]
  v_cmp_u_f32 vcc, v88, v89
  v_cmp_u_f32 s[22:23], v90, v91
  s_nop 1
  s_or_b64 vcc, vcc, s[22:23]
  s_cbranch_vccnz mn_136
mk_137:
  s_waitcnt lgkmcnt(0)
  s_barrier
  ds_read_b64_tr_b16 v[104:105], v7 offset:0
  ds_read_b64_tr_b16 v[106:107], v7 offset:768
  ds_read_b64_tr_b16 v[108:109], v7 offset:1536
  ds_read_b64 v[140:141], v11
  s_cmp_eq_u32 s52, 63
  s_cbranch_scc1 last_138
  s_waitcnt lgkmcnt(2)
  v_mfma_f32_16x16x32_bf16 v[120:123], v[112:115], v[104:107], 0
  s_waitcnt lgkmcnt(1)
  v_mfma_f32_16x16x32_bf16 v[120:123], v[116:119], v[108:111], v[120:123]
  s_mov_b64 exec, s[64:65]
  s_nop 6
  v_cvt_pk_f16_f32 v120, v120, v121
  v_cvt_pk_f16_f32 v121, v122, v123
  buffer_store_dwordx2 v[120:121], v8, s[8:11], s56 offen sc1
  s_mov_b64 exec, -1
  s_sleep 3
  s_nop 1
  v_smfmac_f32_16x16x64_bf16 v[96:99], v[48:51], a[0:7], v22
  v_smfmac_f32_16x16x64_bf16 v[100:103], v[48:51], a[80:87], v22
  v_smfmac_f32_16x16x64_bf16 v[96:99], v[52:55], a[8:15], v22
  v_smfmac_f32_16x16x64_bf16 v[100:103], v[52:55], a[88:95], v22
  v_smfmac_f32_16x16x64_bf16 v[96:99], v[56:59], a[16:23], v22
  v_smfmac_f32_16x16x64_bf16 v[100:103], v[56:59], a[96:103], v22
  v_smfmac_f32_16x16x64_bf16 v[96:99], v[60:63], a[24:31], v22
  v_smfmac_f32_16x16x64_bf16 v[96:99], v[64:67], a[32:39], v22
  v_smfmac_f32_16x16x64_bf16 v[96:99], v[68:71], a[40:47], v22
  v_smfmac_f32_16x16x64_bf16 v[96:99], v[72:75], a[48:55], v22
  v_smfmac_f32_16x16x64_bf16 v[96:99], v[76:79], a[56:63], v22
  buffer_load_dwordx4 v[124:127], v9, s[8:11], s56 offen sc1
  v_smfmac_f32_16x16x64_bf16 v[96:99], v[80:83], a[64:71], v22
  buffer_load_dwordx4 v[128:131], v9, s[8:11], s56 offen offset:1024 sc1
  v_smfmac_f32_16x16x64_bf16 v[96:99], v[84:87], a[72:79], v22
  buffer_load_dwordx4 v[132:135], v10, s[8:11], s56 offen sc1
  v_smfmac_f32_16x16x64_bf16 v[100:103], v[60:63], a[104:111], v22
  v_smfmac_f32_16x16x64_bf16 v[100:103], v[64:67], a[112:119], v22
  v_smfmac_f32_16x16x64_bf16 v[100:103], v[68:71], a[120:127], v22
  v_smfmac_f32_16x16x64_bf16 v[100:103], v[72:75], a[128:135], v22
  v_cvt_pk_bf16_f32 v136, v96, v97
  v_smfmac_f32_16x16x64_bf16 v[100:103], v[76:79], a[136:143], v22
  v_cvt_pk_bf16_f32 v137, v98, v99
  v_smfmac_f32_16x16x64_bf16 v[100:103], v[80:83], a[144:151], v22
  v_smfmac_f32_16x16x64_bf16 v[100:103], v[84:87], a[152:159], v22
  s_waitcnt vmcnt(2)
  v_pk_add_f16 v172, v124, v126
  v_pk_add_f16 v173, v125, v127
  s_waitcnt vmcnt(1)
  v_pk_add_f16 v174, v128, v130
  v_pk_add_f16 v175, v129, v131
  v_fma_mix_f32 v166, v172, 1.0, v174 op_sel:[0,0,0] op_sel_hi:[1,0,1]
  v_fma_mix_f32 v168, v173, 1.0, v175 op_sel:[0,0,0] op_sel_hi:[1,0,1]
  s_waitcnt vmcnt(0)
  v_pk_add_f16 v176, v132, v133
  v_pk_add_f16 v177, v134, v135
  v_fma_mix_f32 v170, v176, 1.0, v177 op_sel:[0,0,0] op_sel_hi:[1,0,1]
  v_fma_mix_f32 v167, v172, 1.0, v174 op_sel:[1,0,1] op_sel_hi:[1,0,1]
  v_cmp_u_f32 vcc, v166, v170
  v_fma_mix_f32 v169, v173, 1.0, v175 op_sel:[1,0,1] op_sel_hi:[1,0,1]
  v_fma_mix_f32 v171, v176, 1.0, v177 op_sel:[1,0,1] op_sel_hi:[1,0,1]
  v_cvt_pk_bf16_f32 v138, v100, v101
  s_cbranch_vccnz sr_140
sj_141:
ex_142:
  v_exp_f32 v172, v166
  v_exp_f32 v173, v167
  v_exp_f32 v174, v168
  v_cvt_pk_bf16_f32 v156, v172, v173
  v_exp_f32 v175, v169
  v_exp_f32 v176, v170
  v_cvt_pk_bf16_f32 v157, v174, v175
  v_mov_b32_dpp v158, v156 row_ror:8 row_mask:0xf bank_mask:0xf
  v_exp_f32 v177, v171
  v_mov_b32_dpp v159, v157 row_ror:8 row_mask:0xf bank_mask:0xf
  v_cvt_pk_bf16_f32 v160, v176, v177
  v_cvt_pk_bf16_f32 v139, v102, v103
  v_mfma_f32_16x16x32_bf16 v[178:181], v[152:155], v[156:159], 0
  s_waitcnt lgkmcnt(0)
  v_mov_b32_dpp v161, v160 row_ror:8 row_mask:0xf bank_mask:0xf
  v_mfma_f32_16x16x32_bf16 v[182:185], v[144:147], v[156:159], 0
  s_nop 0
  v_mfma_f32_16x16x32_bf16 v[178:181], v[140:143], v[160:163], v[178:181]
  v_mfma_f32_16x16x32_bf16 v[182:185], v[136:139], v[160:163], v[182:185]
  v_mfma_f32_16x16x32_bf16 v[186:189], v[148:151], v[156:159], 0
  v_mfma_f32_16x16x32_bf16 v[186:189], v[138:141], v[160:163], v[186:189]
  s_mov_b64 exec, s[62:63]
  v_rcp_f32 v164, v180
  s_nop 0
  v_pk_mul_f32 v[178:179], v[178:179], v[164:165] op_sel_hi:[1,0]
  v_pk_mul_f32 v[182:183], v[182:183], v[164:165] op_sel_hi:[1,0]
  v_pk_mul_f32 v[184:185], v[184:185], v[164:165] op_sel_hi:[1,0]
  v_cvt_pk_f16_f32 v64, v178, v179
  v_cvt_pk_f16_f32 v60, v182, v183
  v_pk_mul_f32 v[186:187], v[186:187], v[164:165] op_sel_hi:[1,0]
  v_pk_mul_f32 v[188:189], v[188:189], v[164:165] op_sel_hi:[1,0]
  v_cvt_pk_f16_f32 v61, v184, v185
  v_cvt_pk_f16_f32 v62, v186, v187
  v_cvt_pk_f16_f32 v63, v188, v189
  ds_write_b128 v13, v[60:63]
  ds_write_b32 v14, v64
  v_add_f32 v165, v164, v180
  v_cmp_ngt_f32 vcc, s80, v165
  s_mov_b64 exec, -1
  s_nop 0
  s_cbranch_vccnz fx_143
fk_144:
  s_waitcnt lgkmcnt(0)
  s_barrier
  s_add_u32 m0, s74, 2048
  s_add_u32 s21, s79, 65536
  buffer_load_dwordx4 v4, s[16:19], s21 offen offset:1024 sc1 lds
  s_add_u32 m0, s74, 6144
  s_add_u32 s21, s79, 196608
  buffer_load_dwordx4 v4, s[16:19], s21 offen offset:0 sc1 lds
  s_xor_b32 s74, s74, 16384
  s_add_u32 s73, s73, 2097152
  s_xor_b32 s73, s73, 8192
  s_add_u32 s79, s79, 2097152
  s_xor_b32 s79, s79, 8192
  s_add_u32 s21, s72, 524288
  s_xor_b32 s72, s72, s21
  s_lshr_b32 s72, s72, 8
  s_and_b32 s72, s72, 8192
  s_xor_b32 s72, s72, s21
  s_nop 15
  s_nop 3
  v_permlane32_swap_b32 v96, v100
  v_permlane32_swap_b32 v97, v101
  v_permlane32_swap_b32 v98, v102
  v_permlane32_swap_b32 v99, v103
  v_pk_add_f32 v[96:97], v[96:97], v[100:101]
  v_pk_add_f32 v[98:99], v[98:99], v[102:103]
  v_cvt_pk_bf16_f32 v182, v96, v97
  v_cvt_pk_bf16_f32 v183, v98, v99
  v_min_u32 v182, -2, v182
  ds_write_b64 v26, v[182:183]
  ds_read_b128 v[144:147], v18
  ds_read_b128 v[148:151], v18 offset:1024
  ds_read_b128 v[152:155], v19
  ds_read_b128 v[112:115], v20
  ds_read_b64 v[116:117], v21
  v_xor_b32 v18, 16384, v18
  v_xor_b32 v19, 16384, v19
  v_xor_b32 v20, 16384, v20
  v_xor_b32 v21, 16384, v21
  v_mov_b32 v88, 0
  v_mov_b32 v89, 0
  v_mov_b32 v90, 0
  v_mov_b32 v91, 0
  v_mov_b32 v92, 0
  v_mov_b32 v93, 0
  v_mov_b32 v94, 0
  v_mov_b32 v95, 0
  v_mov_b32 v96, 0
  v_mov_b32 v97, 0
  v_mov_b32 v98, 0
  v_mov_b32 v99, 0
  v_mov_b32 v100, 0
  v_mov_b32 v101, 0
  v_mov_b32 v102, 0
  v_mov_b32 v103, 0
  s_mov_b32 s81, 0
  s_waitcnt lgkmcnt(0)
  s_barrier
  s_mov_b64 exec, s[64:65]
  buffer_store_dwordx2 v[28:29], v8, s[8:11], s57 offen sc1
  s_mov_b64 exec, s[62:63]
  buffer_store_dword v28, v17, s[8:11], s59 offen sc1
  s_mov_b64 exec, -1
  s_sleep 6
  s_nop 3
  buffer_load_dwordx4 v[68:71], v16, s[4:7], s60 offen sc1
  s_sleep 3
  s_nop 1
  buffer_load_dwordx4 v[72:75], v16, s[4:7], s60 offen sc1
  s_mov_b32 s54, 0
pp_146:
  s_waitcnt vmcnt(1)
  v_mfma_f32_16x16x32_f16 v[120:123], v[44:47], v[68:71], 0
  v_bitop3_b32 v27, v68, s61, 1 bitop3:0x28
  v_cmp_ne_u32 vcc, 0, v27
  s_nop 1
  s_cbranch_vccnz p2_148
  s_nop 2
pg_147:
  v_add_f32_dpp v120, v120, v120 row_ror:8 row_mask:0xf bank_mask:0xf
  v_add_f32_dpp v121, v121, v121 row_ror:8 row_mask:0xf bank_mask:0xf
  s_mov_b64 exec, s[62:63]
  v_cvt_pk_bf16_f32 v120, v120, v121
  v_min_u32 v120, -2, v120
  buffer_store_dword v120, v17, s[8:11], s55 offen sc1
  s_mov_b64 exec, -1
nt_145:
  s_barrier
  s_mov_b32 s58, s55
  s_add_u32 s52, s52, 1
  s_and_b32 s21, s52, 3
  s_mul_i32 s56, s21, 122880
  s_add_u32 s21, s52, 1
  s_and_b32 s21, s21, 3
  s_mul_i32 s55, s21, 122880
  s_add_u32 s55, s55, s75
  s_add_u32 s21, s52, 2
  s_and_b32 s21, s21, 3
  s_mul_i32 s57, s21, 122880
  s_add_u32 s21, s52, 3
  s_and_b32 s21, s21, 3
  s_mul_i32 s59, s21, 122880
  s_add_u32 s59, s59, s75
  s_bfe_u32 s61, s52, 0x10001
  s_and_b32 s21, s52, 1
  s_lshl_b32 s60, s21, 19
  s_mov_b32 s54, 0
  s_sleep 3
  s_nop 2
  buffer_load_dwordx4 v[60:63], v190, s[8:11], s58 offen offset:0 sc1
  buffer_load_dwordx4 v[64:67], v190, s[8:11], s58 offen offset:1024 sc1
  buffer_load_dwordx4 v[68:71], v190, s[8:11], s58 offen offset:2048 sc1
  s_branch top_134
mr_135:
  s_mov_b64 exec, s[22:23]
  s_cbranch_execz ms_149
  buffer_load_dwordx4 v[60:63], v190, s[8:11], s58 offen offset:0 sc1
ms_149:
  s_mov_b64 exec, s[98:99]
  s_cbranch_execz ms_150
  buffer_load_dwordx4 v[64:67], v190, s[8:11], s58 offen offset:1024 sc1
ms_150:
  s_mov_b64 exec, s[100:101]
  s_cbranch_execz ms_151
  buffer_load_dwordx4 v[68:71], v190, s[8:11], s58 offen offset:2048 sc1
ms_151:
  s_add_u32 s54, s54, 1
  s_cmp_gt_u32 s54, 131072
  s_cbranch_scc1 end0
  s_waitcnt vmcnt(0)
  s_mov_b64 exec, s[22:23]
  ds_write_b128 v190, v[60:63] offset:0
  v_cmp_eq_u32 s[22:23], -1, v60
  s_mov_b64 exec, s[98:99]
  ds_write_b128 v190, v[64:67] offset:1024
  v_cmp_eq_u32 s[98:99], -1, v64
  s_mov_b64 exec, s[100:101]
  ds_write_b128 v190, v[68:71] offset:2048
  v_cmp_eq_u32 s[100:101], -1, v68
  s_mov_b64 exec, -1
  s_or_b64 vcc, s[22:23], s[98:99]
  s_or_b64 vcc, vcc, s[100:101]
  s_cbranch_scc1 mr_135
  s_branch mo_139
mn_136:
  v_max3_u32 v27, v48, v49, v50
  v_max3_u32 v27, v27, v51, v52
  v_max3_u32 v27, v27, v53, v54
  v_max3_u32 v27, v27, v55, v56
  v_max3_u32 v27, v27, v57, v58
  v_max3_u32 v27, v27, v59, v60
  v_max3_u32 v27, v27, v61, v62
  v_max3_u32 v27, v27, v63, v64
  v_max3_u32 v27, v27, v65, v66
  v_max3_u32 v27, v27, v67, v68
  v_max3_u32 v27, v27, v69, v70
  v_max3_u32 v27, v27, v71, v72
  v_max3_u32 v27, v27, v73, v74
  v_max3_u32 v27, v27, v75, v76
  v_max3_u32 v27, v27, v77, v78
  v_max3_u32 v27, v27, v79, v80
  v_max3_u32 v27, v27, v81, v82
  v_max3_u32 v27, v27, v83, v84
  v_max3_u32 v27, v27, v85, v86
  v_max3_u32 v27, v27, v87, v87
  v_cmp_eq_u32 vcc, -1, v27
  s_cmp_eq_u32 s52, 0
  s_cbranch_scc1 mk_137
  s_cbranch_vccz mk_137
  s_waitcnt lgkmcnt(0)
  s_barrier
  s_nop 7
  v_mov_b32 v88, 0
  v_mov_b32 v89, 0
  v_mov_b32 v90, 0
  v_mov_b32 v91, 0
  v_mov_b32 v92, 0
  v_mov_b32 v93, 0
  v_mov_b32 v94, 0
  v_mov_b32 v95, 0
  v_mov_b32 v96, 0
  v_mov_b32 v97, 0
  v_mov_b32 v98, 0
  v_mov_b32 v99, 0
  v_mov_b32 v100, 0
  v_mov_b32 v101, 0
  v_mov_b32 v102, 0
  v_mov_b32 v103, 0
  s_mov_b64 s[22:23], -1
  s_mov_b64 s[98:99], -1
  s_mov_b64 s[100:101], -1
  s_branch mr_135
sr_140:
  s_mov_b32 s54, 0
sr_152:
  s_mov_b64 exec, vcc
  buffer_load_dwordx4 v[124:127], v9, s[8:11], s56 offen sc1
  buffer_load_dwordx4 v[128:131], v9, s[8:11], s56 offen offset:1024 sc1
  buffer_load_dwordx4 v[132:135], v10, s[8:11], s56 offen sc1
  s_mov_b64 exec, -1
  s_add_u32 s54, s54, 1
  s_cmp_gt_u32 s54, 131072
  s_cbranch_scc1 end0
  s_and_b32 s21, s54, 31
  s_cbranch_scc0 sr_153
  s_waitcnt vmcnt(0)
  v_pk_add_f16 v172, v124, v126
  v_pk_add_f16 v173, v125, v127
  v_pk_add_f16 v174, v128, v130
  v_pk_add_f16 v175, v129, v131
  v_fma_mix_f32 v166, v172, 1.0, v174 op_sel:[0,0,0] op_sel_hi:[1,0,1]
  v_fma_mix_f32 v168, v173, 1.0, v175 op_sel:[0,0,0] op_sel_hi:[1,0,1]
  v_pk_add_f16 v176, v132, v133
  v_pk_add_f16 v177, v134, v135
  v_add_f32 v27, v166, v168
  v_fma_mix_f32 v170, v176, 1.0, v177 op_sel:[0,0,0] op_sel_hi:[1,0,1]
  v_fma_mix_f32 v167, v172, 1.0, v174 op_sel:[1,0,1] op_sel_hi:[1,0,1]
  v_cmp_u_f32 vcc, v27, v170
  v_fma_mix_f32 v169, v173, 1.0, v175 op_sel:[1,0,1] op_sel_hi:[1,0,1]
  v_fma_mix_f32 v171, v176, 1.0, v177 op_sel:[1,0,1] op_sel_hi:[1,0,1]
  s_cbranch_vccnz sr_152
  s_branch sj_141
sr_153:
  s_waitcnt vmcnt(0)
  v_pk_add_f16 v172, v124, v126
  v_pk_add_f16 v173, v125, v127
  v_pk_add_f16 v174, v128, v130
  v_pk_add_f16 v175, v129, v131
  v_fma_mix_f32 v166, v172, 1.0, v174 op_sel:[0,0,0] op_sel_hi:[1,0,1]
  v_fma_mix_f32 v168, v173, 1.0, v175 op_sel:[0,0,0] op_sel_hi:[1,0,1]
  v_pk_add_f16 v176, v132, v133
  v_pk_add_f16 v177, v134, v135
  v_add_f32 v27, v166, v168
  v_fma_mix_f32 v170, v176, 1.0, v177 op_sel:[0,0,0] op_sel_hi:[1,0,1]
  v_fma_mix_f32 v167, v172, 1.0, v174 op_sel:[1,0,1] op_sel_hi:[1,0,1]
  v_cmp_u_f32 vcc, v27, v170
  v_fma_mix_f32 v169, v173, 1.0, v175 op_sel:[1,0,1] op_sel_hi:[1,0,1]
  v_fma_mix_f32 v171, v176, 1.0, v177 op_sel:[1,0,1] op_sel_hi:[1,0,1]
  v_max3_u32 v27, v124, v126, v128
  v_max3_u32 v27, v27, v130, v132
  v_max3_u32 v27, v27, v133, v134
  v_max3_u32 v27, v27, v135, v135
  v_cmp_eq_u32 vcc, -1, v27
  s_nop 1
  s_cbranch_vccnz sr_152
  s_branch sj_141
fx_143:
  s_cmp_eq_u32 s81, 1
  s_cbranch_scc1 fk_144
  s_mov_b32 s81, 1
  v_max3_f32 v164, v166, v167, v168
  v_max3_f32 v165, v169, v170, v171
  v_max_f32 v164, v164, v165
  s_nop 1
  v_max_f32_dpp v164, v164, v164 row_ror:8 row_mask:0xf bank_mask:0xf
  v_mov_b32 v165, v164
  s_nop 1
  v_permlane32_swap_b32 v164, v165
  v_max_f32 v164, v164, v165
  v_mov_b32 v165, v164
  s_nop 1
  v_permlane16_swap_b32 v164, v165
  v_max_f32 v164, v164, v165
  v_sub_f32 v166, v166, v164
  v_sub_f32 v167, v167, v164
  v_sub_f32 v168, v168, v164
  v_sub_f32 v169, v169, v164
  v_sub_f32 v170, v170, v164
  v_sub_f32 v171, v171, v164
  s_branch ex_142
p2_148:
  buffer_load_dwordx4 v[68:71], v16, s[4:7], s60 offen sc1
  s_waitcnt vmcnt(1)
  v_mfma_f32_16x16x32_f16 v[120:123], v[44:47], v[72:75], 0
  v_bitop3_b32 v27, v72, s61, 1 bitop3:0x28
  v_cmp_ne_u32 vcc, 0, v27
  s_nop 1
  s_cbranch_vccz pg_147
  buffer_load_dwordx4 v[72:75], v16, s[4:7], s60 offen sc1
  s_add_u32 s54, s54, 1
  s_cmp_gt_u32 s54, 131072
  s_cbranch_scc1 end0
  s_branch pp_146
last_138:
  v_smfmac_f32_16x16x64_bf16 v[96:99], v[48:51], a[0:7], v22
  v_smfmac_f32_16x16x64_bf16 v[100:103], v[48:51], a[80:87], v22
  v_smfmac_f32_16x16x64_bf16 v[96:99], v[52:55], a[8:15], v22
  v_smfmac_f32_16x16x64_bf16 v[100:103], v[52:55], a[88:95], v22
  v_smfmac_f32_16x16x64_bf16 v[96:99], v[56:59], a[16:23], v22
  v_smfmac_f32_16x16x64_bf16 v[100:103], v[56:59], a[96:103], v22
  v_smfmac_f32_16x16x64_bf16 v[96:99], v[60:63], a[24:31], v22
  v_smfmac_f32_16x16x64_bf16 v[96:99], v[64:67], a[32:39], v22
  v_smfmac_f32_16x16x64_bf16 v[96:99], v[68:71], a[40:47], v22
  v_smfmac_f32_16x16x64_bf16 v[96:99], v[72:75], a[48:55], v22
  v_smfmac_f32_16x16x64_bf16 v[96:99], v[76:79], a[56:63], v22
  v_smfmac_f32_16x16x64_bf16 v[96:99], v[80:83], a[64:71], v22
  v_smfmac_f32_16x16x64_bf16 v[96:99], v[84:87], a[72:79], v22
  v_smfmac_f32_16x16x64_bf16 v[100:103], v[60:63], a[104:111], v22
  v_smfmac_f32_16x16x64_bf16 v[100:103], v[64:67], a[112:119], v22
  v_smfmac_f32_16x16x64_bf16 v[100:103], v[68:71], a[120:127], v22
  v_smfmac_f32_16x16x64_bf16 v[100:103], v[72:75], a[128:135], v22
  v_smfmac_f32_16x16x64_bf16 v[100:103], v[76:79], a[136:143], v22
  v_smfmac_f32_16x16x64_bf16 v[100:103], v[80:83], a[144:151], v22
  v_smfmac_f32_16x16x64_bf16 v[100:103], v[84:87], a[152:159], v22
  s_nop 7
  v_permlane32_swap_b32 v96, v100
  v_permlane32_swap_b32 v97, v101
  v_permlane32_swap_b32 v98, v102
  v_permlane32_swap_b32 v99, v103
  v_pk_add_f32 v[96:97], v[96:97], v[100:101]
  v_pk_add_f32 v[98:99], v[98:99], v[102:103]
  v_cvt_pk_bf16_f32 v182, v96, v97
  v_cvt_pk_bf16_f32 v183, v98, v99
  v_min_u32 v182, -2, v182
  ds_write_b64 v26, v[182:183]
  s_waitcnt lgkmcnt(0)
  s_barrier
  s_branch chain_done
E_31:
  v_add_u32 v190, 6144, v4
  ds_read_b128 v[72:75], v4 offset:6144
  ds_read_b128 v[76:79], v4 offset:7168
  ds_read_b128 v[80:83], v4 offset:8192
  s_waitcnt lgkmcnt(0)
  s_branch mo_159
  .p2align 3
top_154:
  s_waitcnt vmcnt(2)
  ds_write_b128 v190, v[72:75] offset:0
  v_cmp_eq_u32 s[22:23], -1, v72
  s_waitcnt vmcnt(1)
  ds_write_b128 v190, v[76:79] offset:1024
  v_cmp_eq_u32 s[98:99], -1, v76
  s_waitcnt vmcnt(0)
  ds_write_b128 v190, v[80:83] offset:2048
  v_cmp_eq_u32 s[100:101], -1, v80
  s_or_b64 vcc, s[22:23], s[98:99]
  s_or_b64 vcc, vcc, s[100:101]
  s_cbranch_scc1 mr_155
mo_159:
  s_waitcnt lgkmcnt(0)
  s_barrier
  ds_read_b128 v[48:51], v4 offset:0
  ds_read_b128 v[52:55], v4 offset:1024
  v_smfmac_f32_16x16x64_bf16 v[92:95], v[72:75], v[224:231], v22
  ds_read_b128 v[56:59], v4 offset:2048
  v_smfmac_f32_16x16x64_bf16 v[88:91], v[72:75], a[208:215], v22
  ds_read_b128 v[60:63], v4 offset:3072
  v_smfmac_f32_16x16x64_bf16 v[92:95], v[76:79], v[232:239], v22
  ds_read_b128 v[64:67], v4 offset:4096
  v_smfmac_f32_16x16x64_bf16 v[88:91], v[76:79], a[216:223], v22
  ds_read_b128 v[68:71], v4 offset:5120
  v_smfmac_f32_16x16x64_bf16 v[92:95], v[80:83], v[240:247], v22
  ds_read_b128 v[84:87], v4 offset:9216
  v_smfmac_f32_16x16x64_bf16 v[88:91], v[80:83], a[224:231], v22
  s_waitcnt lgkmcnt(6)
  v_smfmac_f32_16x16x64_bf16 v[92:95], v[48:51], a[240:247], v22
  v_smfmac_f32_16x16x64_bf16 v[88:91], v[48:51], a[160:167], v22
  s_waitcnt lgkmcnt(5)
  v_smfmac_f32_16x16x64_bf16 v[92:95], v[52:55], a[248:255], v22
  s_waitcnt lgkmcnt(4)
  v_smfmac_f32_16x16x64_bf16 v[92:95], v[56:59], v[192:199], v22
  s_waitcnt lgkmcnt(3)
  v_smfmac_f32_16x16x64_bf16 v[92:95], v[60:63], v[200:207], v22
  s_waitcnt lgkmcnt(2)
  v_smfmac_f32_16x16x64_bf16 v[92:95], v[64:67], v[208:215], v22
  s_waitcnt lgkmcnt(1)
  v_smfmac_f32_16x16x64_bf16 v[92:95], v[68:71], v[216:223], v22
  s_waitcnt lgkmcnt(0)
  v_smfmac_f32_16x16x64_bf16 v[92:95], v[84:87], v[248:255], v22
  v_smfmac_f32_16x16x64_bf16 v[88:91], v[52:55], a[168:175], v22
  v_smfmac_f32_16x16x64_bf16 v[88:91], v[56:59], a[176:183], v22
  v_smfmac_f32_16x16x64_bf16 v[88:91], v[60:63], a[184:191], v22
  v_permlane32_swap_b32 v92, v93
  v_smfmac_f32_16x16x64_bf16 v[88:91], v[64:67], a[192:199], v22
  v_permlane32_swap_b32 v94, v95
  v_smfmac_f32_16x16x64_bf16 v[88:91], v[68:71], a[200:207], v22
  v_permlane32_swap_b32 v93, v92
  v_smfmac_f32_16x16x64_bf16 v[88:91], v[84:87], a[232:239], v22
  v_permlane32_swap_b32 v95, v94
  v_pk_mul_f32 v[120:121], v[92:93], v[24:25] op_sel:[1,0] op_sel_hi:[0,1]
  v_pk_mul_f32 v[122:123], v[94:95], v[24:25] op_sel:[1,0] op_sel_hi:[0,1]
  s_nop 4
  v_pk_fma_f32 v[88:89], v[88:89], v[24:25], v[120:121]
  v_pk_fma_f32 v[90:91], v[90:91], v[24:25], v[122:123]
  v_cvt_pk_bf16_f32 v120, v88, v89
  v_cvt_pk_bf16_f32 v121, v90, v91
  ds_write_b64 v6, v[120:121]
  v_cmp_u_f32 vcc, v88, v89
  v_cmp_u_f32 s[22:23], v90, v91
  s_nop 1
  s_or_b64 vcc, vcc, s[22:23]
  s_cbranch_vccnz mn_156
mk_157:
  s_waitcnt lgkmcnt(0)
  s_barrier
  ds_read_b64_tr_b16 v[104:105], v7 offset:0
  ds_read_b64_tr_b16 v[106:107], v7 offset:768
  ds_read_b64_tr_b16 v[108:109], v7 offset:1536
  ds_read_b64 v[140:141], v11
  s_cmp_eq_u32 s52, 63
  s_cbranch_scc1 last_158
  s_waitcnt lgkmcnt(2)
  v_mfma_f32_16x16x32_bf16 v[120:123], v[104:107], v[104:107], 0
  s_waitcnt lgkmcnt(1)
  v_mfma_f32_16x16x32_bf16 v[120:123], v[108:111], v[108:111], v[120:123]
  s_mov_b64 exec, s[64:65]
  s_nop 6
  v_cvt_pk_f16_f32 v120, v120, v121
  buffer_store_dword v120, v8, s[8:11], s56 offen sc1
  v_cvt_pk_f16_f32 v121, v122, v123
  buffer_store_dword v121, v8, s[8:11], s56 offen offset:128 sc1
  s_mov_b64 exec, -1
  s_sleep 3
  s_nop 1
  v_smfmac_f32_16x16x64_bf16 v[96:99], v[48:51], a[0:7], v22
  v_smfmac_f32_16x16x64_bf16 v[100:103], v[48:51], a[80:87], v22
  v_smfmac_f32_16x16x64_bf16 v[96:99], v[52:55], a[8:15], v22
  v_smfmac_f32_16x16x64_bf16 v[100:103], v[52:55], a[88:95], v22
  v_smfmac_f32_16x16x64_bf16 v[96:99], v[56:59], a[16:23], v22
  v_smfmac_f32_16x16x64_bf16 v[100:103], v[56:59], a[96:103], v22
  v_smfmac_f32_16x16x64_bf16 v[96:99], v[60:63], a[24:31], v22
  v_smfmac_f32_16x16x64_bf16 v[96:99], v[64:67], a[32:39], v22
  v_smfmac_f32_16x16x64_bf16 v[96:99], v[68:71], a[40:47], v22
  v_smfmac_f32_16x16x64_bf16 v[96:99], v[72:75], a[48:55], v22
  v_smfmac_f32_16x16x64_bf16 v[96:99], v[76:79], a[56:63], v22
  buffer_load_dwordx4 v[124:127], v9, s[8:11], s56 offen sc1
  v_smfmac_f32_16x16x64_bf16 v[96:99], v[80:83], a[64:71], v22
  buffer_load_dwordx4 v[128:131], v9, s[8:11], s56 offen offset:1024 sc1
  v_smfmac_f32_16x16x64_bf16 v[96:99], v[84:87], a[72:79], v22
  buffer_load_dwordx4 v[132:135], v10, s[8:11], s56 offen sc1
  v_smfmac_f32_16x16x64_bf16 v[100:103], v[60:63], a[104:111], v22
  v_smfmac_f32_16x16x64_bf16 v[100:103], v[64:67], a[112:119], v22
  v_smfmac_f32_16x16x64_bf16 v[100:103], v[68:71], a[120:127], v22
  v_smfmac_f32_16x16x64_bf16 v[100:103], v[72:75], a[128:135], v22
  v_cvt_pk_bf16_f32 v136, v96, v97
  v_smfmac_f32_16x16x64_bf16 v[100:103], v[76:79], a[136:143], v22
  v_cvt_pk_bf16_f32 v137, v98, v99
  v_smfmac_f32_16x16x64_bf16 v[100:103], v[80:83], a[144:151], v22
  v_smfmac_f32_16x16x64_bf16 v[100:103], v[84:87], a[152:159], v22
  s_waitcnt vmcnt(2)
  v_pk_add_f16 v172, v124, v126
  v_pk_add_f16 v173, v125, v127
  s_waitcnt vmcnt(1)
  v_pk_add_f16 v174, v128, v130
  v_pk_add_f16 v175, v129, v131
  v_fma_mix_f32 v166, v172, 1.0, v174 op_sel:[0,0,0] op_sel_hi:[1,0,1]
  v_fma_mix_f32 v168, v173, 1.0, v175 op_sel:[0,0,0] op_sel_hi:[1,0,1]
  s_waitcnt vmcnt(0)
  v_pk_add_f16 v176, v132, v133
  v_pk_add_f16 v177, v134, v135
  v_fma_mix_f32 v170, v176, 1.0, v177 op_sel:[0,0,0] op_sel_hi:[1,0,1]
  v_fma_mix_f32 v167, v172, 1.0, v174 op_sel:[1,0,1] op_sel_hi:[1,0,1]
  v_cmp_u_f32 vcc, v166, v170
  v_fma_mix_f32 v169, v173, 1.0, v175 op_sel:[1,0,1] op_sel_hi:[1,0,1]
  v_fma_mix_f32 v171, v176, 1.0, v177 op_sel:[1,0,1] op_sel_hi:[1,0,1]
  v_cvt_pk_bf16_f32 v138, v100, v101
  s_cbranch_vccnz sr_160
sj_161:
ex_162:
  v_exp_f32 v172, v166
  v_exp_f32 v173, v167
  v_exp_f32 v174, v168
  v_cvt_pk_bf16_f32 v156, v172, v173
  v_exp_f32 v175, v169
  v_exp_f32 v176, v170
  v_cvt_pk_bf16_f32 v157, v174, v175
  v_mov_b32_dpp v158, v156 row_ror:8 row_mask:0xf bank_mask:0xf
  v_exp_f32 v177, v171
  v_mov_b32_dpp v159, v157 row_ror:8 row_mask:0xf bank_mask:0xf
  v_cvt_pk_bf16_f32 v160, v176, v177
  v_cvt_pk_bf16_f32 v139, v102, v103
  v_mfma_f32_16x16x32_bf16 v[178:181], v[152:155], v[156:159], 0
  s_waitcnt lgkmcnt(0)
  v_mov_b32_dpp v161, v160 row_ror:8 row_mask:0xf bank_mask:0xf
  v_mfma_f32_16x16x32_bf16 v[182:185], v[144:147], v[156:159], 0
  s_nop 0
  v_mfma_f32_16x16x32_bf16 v[178:181], v[140:143], v[160:163], v[178:181]
  v_mfma_f32_16x16x32_bf16 v[182:185], v[136:139], v[160:163], v[182:185]
  v_mfma_f32_16x16x32_bf16 v[186:189], v[148:151], v[156:159], 0
  v_mfma_f32_16x16x32_bf16 v[186:189], v[138:141], v[160:163], v[186:189]
  s_mov_b64 exec, s[62:63]
  v_rcp_f32 v164, v180
  s_nop 0
  v_pk_mul_f32 v[178:179], v[178:179], v[164:165] op_sel_hi:[1,0]
  v_pk_mul_f32 v[182:183], v[182:183], v[164:165] op_sel_hi:[1,0]
  v_pk_mul_f32 v[184:185], v[184:185], v[164:165] op_sel_hi:[1,0]
  v_cvt_pk_f16_f32 v64, v178, v179
  v_cvt_pk_f16_f32 v60, v182, v183
  v_pk_mul_f32 v[186:187], v[186:187], v[164:165] op_sel_hi:[1,0]
  v_pk_mul_f32 v[188:189], v[188:189], v[164:165] op_sel_hi:[1,0]
  v_cvt_pk_f16_f32 v61, v184, v185
  v_cvt_pk_f16_f32 v62, v186, v187
  v_cvt_pk_f16_f32 v63, v188, v189
  ds_write_b128 v13, v[60:63]
  ds_write_b32 v14, v64
  v_add_f32 v165, v164, v180
  v_cmp_ngt_f32 vcc, s80, v165
  s_mov_b64 exec, -1
  s_nop 0
  s_cbranch_vccnz fx_163
fk_164:
  s_waitcnt lgkmcnt(0)
  s_barrier
  s_add_u32 m0, s74, 4096
  s_add_u32 s21, s79, 131072
  buffer_load_dwordx4 v4, s[16:19], s21 offen offset:0 sc1 lds
  s_add_u32 m0, s74, 6144
  s_add_u32 s21, s79, 196608
  buffer_load_dwordx4 v4, s[16:19], s21 offen offset:1024 sc1 lds
  s_xor_b32 s74, s74, 16384
  s_add_u32 s73, s73, 2097152
  s_xor_b32 s73, s73, 8192
  s_add_u32 s79, s79, 2097152
  s_xor_b32 s79, s79, 8192
  s_add_u32 s21, s72, 524288
  s_xor_b32 s72, s72, s21
  s_lshr_b32 s72, s72, 8
  s_and_b32 s72, s72, 8192
  s_xor_b32 s72, s72, s21
  s_nop 15
  s_nop 3
  v_permlane32_swap_b32 v96, v100
  v_permlane32_swap_b32 v97, v101
  v_permlane32_swap_b32 v98, v102
  v_permlane32_swap_b32 v99, v103
  v_pk_add_f32 v[96:97], v[96:97], v[100:101]
  v_pk_add_f32 v[98:99], v[98:99], v[102:103]
  v_cvt_pk_bf16_f32 v182, v96, v97
  v_cvt_pk_bf16_f32 v183, v98, v99
  v_min_u32 v182, -2, v182
  ds_write_b64 v26, v[182:183]
  ds_read_b128 v[144:147], v18
  ds_read_b128 v[148:151], v18 offset:1024
  ds_read_b128 v[152:155], v19
  v_xor_b32 v18, 16384, v18
  v_xor_b32 v19, 16384, v19
  v_mov_b32 v88, 0
  v_mov_b32 v89, 0
  v_mov_b32 v90, 0
  v_mov_b32 v91, 0
  v_mov_b32 v92, 0
  v_mov_b32 v93, 0
  v_mov_b32 v94, 0
  v_mov_b32 v95, 0
  v_mov_b32 v96, 0
  v_mov_b32 v97, 0
  v_mov_b32 v98, 0
  v_mov_b32 v99, 0
  v_mov_b32 v100, 0
  v_mov_b32 v101, 0
  v_mov_b32 v102, 0
  v_mov_b32 v103, 0
  s_mov_b32 s81, 0
  s_waitcnt lgkmcnt(0)
  s_barrier
  s_mov_b64 exec, s[64:65]
  buffer_store_dword v28, v8, s[8:11], s57 offen sc1
  buffer_store_dword v28, v8, s[8:11], s57 offen offset:128 sc1
  s_mov_b64 exec, -1
  s_cmp_eq_u32 s78, 0
  s_cbranch_scc1 nt_165
  s_mov_b64 exec, s[62:63]
  buffer_store_dword v28, v17, s[8:11], s59 offen sc1
  s_mov_b64 exec, -1
  s_sleep 6
  s_nop 3
  buffer_load_dwordx4 v[68:71], v16, s[4:7], s60 offen sc1
  s_sleep 3
  s_nop 1
  buffer_load_dwordx4 v[72:75], v16, s[4:7], s60 offen sc1
  s_mov_b32 s54, 0
pp_166:
  s_waitcnt vmcnt(1)
  v_mfma_f32_16x16x32_f16 v[120:123], v[44:47], v[68:71], 0
  v_bitop3_b32 v27, v68, s61, 1 bitop3:0x28
  v_cmp_ne_u32 vcc, 0, v27
  s_nop 1
  s_cbranch_vccnz p2_168
  s_nop 2
pg_167:
  v_add_f32_dpp v120, v120, v120 row_ror:8 row_mask:0xf bank_mask:0xf
  v_add_f32_dpp v121, v121, v121 row_ror:8 row_mask:0xf bank_mask:0xf
  s_mov_b64 exec, s[62:63]
  v_cvt_pk_bf16_f32 v120, v120, v121
  v_min_u32 v120, -2, v120
  buffer_store_dword v120, v17, s[8:11], s55 offen sc1
  s_mov_b64 exec, -1
nt_165:
  s_barrier
  s_mov_b32 s58, s55
  s_add_u32 s52, s52, 1
  s_and_b32 s21, s52, 3
  s_mul_i32 s56, s21, 122880
  s_add_u32 s21, s52, 1
  s_and_b32 s21, s21, 3
  s_mul_i32 s55, s21, 122880
  s_add_u32 s55, s55, s75
  s_add_u32 s21, s52, 2
  s_and_b32 s21, s21, 3
  s_mul_i32 s57, s21, 122880
  s_add_u32 s21, s52, 3
  s_and_b32 s21, s21, 3
  s_mul_i32 s59, s21, 122880
  s_add_u32 s59, s59, s75
  s_bfe_u32 s61, s52, 0x10001
  s_and_b32 s21, s52, 1
  s_lshl_b32 s60, s21, 19
  s_mov_b32 s54, 0
  s_sleep 3
  s_nop 2
  buffer_load_dwordx4 v[72:75], v190, s[8:11], s58 offen offset:0 sc1
  buffer_load_dwordx4 v[76:79], v190, s[8:11], s58 offen offset:1024 sc1
  buffer_load_dwordx4 v[80:83], v190, s[8:11], s58 offen offset:2048 sc1
  s_branch top_154
mr_155:
  s_mov_b64 exec, s[22:23]
  s_cbranch_execz ms_169
  buffer_load_dwordx4 v[72:75], v190, s[8:11], s58 offen offset:0 sc1
ms_169:
  s_mov_b64 exec, s[98:99]
  s_cbranch_execz ms_170
  buffer_load_dwordx4 v[76:79], v190, s[8:11], s58 offen offset:1024 sc1
ms_170:
  s_mov_b64 exec, s[100:101]
  s_cbranch_execz ms_171
  buffer_load_dwordx4 v[80:83], v190, s[8:11], s58 offen offset:2048 sc1
ms_171:
  s_add_u32 s54, s54, 1
  s_cmp_gt_u32 s54, 131072
  s_cbranch_scc1 end0
  s_waitcnt vmcnt(0)
  s_mov_b64 exec, s[22:23]
  ds_write_b128 v190, v[72:75] offset:0
  v_cmp_eq_u32 s[22:23], -1, v72
  s_mov_b64 exec, s[98:99]
  ds_write_b128 v190, v[76:79] offset:1024
  v_cmp_eq_u32 s[98:99], -1, v76
  s_mov_b64 exec, s[100:101]
  ds_write_b128 v190, v[80:83] offset:2048
  v_cmp_eq_u32 s[100:101], -1, v80
  s_mov_b64 exec, -1
  s_or_b64 vcc, s[22:23], s[98:99]
  s_or_b64 vcc, vcc, s[100:101]
  s_cbranch_scc1 mr_155
  s_branch mo_159
mn_156:
  v_max3_u32 v27, v48, v49, v50
  v_max3_u32 v27, v27, v51, v52
  v_max3_u32 v27, v27, v53, v54
  v_max3_u32 v27, v27, v55, v56
  v_max3_u32 v27, v27, v57, v58
  v_max3_u32 v27, v27, v59, v60
  v_max3_u32 v27, v27, v61, v62
  v_max3_u32 v27, v27, v63, v64
  v_max3_u32 v27, v27, v65, v66
  v_max3_u32 v27, v27, v67, v68
  v_max3_u32 v27, v27, v69, v70
  v_max3_u32 v27, v27, v71, v72
  v_max3_u32 v27, v27, v73, v74
  v_max3_u32 v27, v27, v75, v76
  v_max3_u32 v27, v27, v77, v78
  v_max3_u32 v27, v27, v79, v80
  v_max3_u32 v27, v27, v81, v82
  v_max3_u32 v27, v27, v83, v84
  v_max3_u32 v27, v27, v85, v86
  v_max3_u32 v27, v27, v87, v87
  v_cmp_eq_u32 vcc, -1, v27
  s_cmp_eq_u32 s52, 0
  s_cbranch_scc1 mk_157
  s_cbranch_vccz mk_157
  s_waitcnt lgkmcnt(0)
  s_barrier
  s_nop 7
  v_mov_b32 v88, 0
  v_mov_b32 v89, 0
  v_mov_b32 v90, 0
  v_mov_b32 v91, 0
  v_mov_b32 v92, 0
  v_mov_b32 v93, 0
  v_mov_b32 v94, 0
  v_mov_b32 v95, 0
  v_mov_b32 v96, 0
  v_mov_b32 v97, 0
  v_mov_b32 v98, 0
  v_mov_b32 v99, 0
  v_mov_b32 v100, 0
  v_mov_b32 v101, 0
  v_mov_b32 v102, 0
  v_mov_b32 v103, 0
  s_mov_b64 s[22:23], -1
  s_mov_b64 s[98:99], -1
  s_mov_b64 s[100:101], -1
  s_branch mr_155
sr_160:
  s_mov_b32 s54, 0
sr_172:
  s_mov_b64 exec, vcc
  buffer_load_dwordx4 v[124:127], v9, s[8:11], s56 offen sc1
  buffer_load_dwordx4 v[128:131], v9, s[8:11], s56 offen offset:1024 sc1
  buffer_load_dwordx4 v[132:135], v10, s[8:11], s56 offen sc1
  s_mov_b64 exec, -1
  s_add_u32 s54, s54, 1
  s_cmp_gt_u32 s54, 131072
  s_cbranch_scc1 end0
  s_and_b32 s21, s54, 31
  s_cbranch_scc0 sr_173
  s_waitcnt vmcnt(0)
  v_pk_add_f16 v172, v124, v126
  v_pk_add_f16 v173, v125, v127
  v_pk_add_f16 v174, v128, v130
  v_pk_add_f16 v175, v129, v131
  v_fma_mix_f32 v166, v172, 1.0, v174 op_sel:[0,0,0] op_sel_hi:[1,0,1]
  v_fma_mix_f32 v168, v173, 1.0, v175 op_sel:[0,0,0] op_sel_hi:[1,0,1]
  v_pk_add_f16 v176, v132, v133
  v_pk_add_f16 v177, v134, v135
  v_add_f32 v27, v166, v168
  v_fma_mix_f32 v170, v176, 1.0, v177 op_sel:[0,0,0] op_sel_hi:[1,0,1]
  v_fma_mix_f32 v167, v172, 1.0, v174 op_sel:[1,0,1] op_sel_hi:[1,0,1]
  v_cmp_u_f32 vcc, v27, v170
  v_fma_mix_f32 v169, v173, 1.0, v175 op_sel:[1,0,1] op_sel_hi:[1,0,1]
  v_fma_mix_f32 v171, v176, 1.0, v177 op_sel:[1,0,1] op_sel_hi:[1,0,1]
  s_cbranch_vccnz sr_172
  s_branch sj_161
sr_173:
  s_waitcnt vmcnt(0)
  v_pk_add_f16 v172, v124, v126
  v_pk_add_f16 v173, v125, v127
  v_pk_add_f16 v174, v128, v130
  v_pk_add_f16 v175, v129, v131
  v_fma_mix_f32 v166, v172, 1.0, v174 op_sel:[0,0,0] op_sel_hi:[1,0,1]
  v_fma_mix_f32 v168, v173, 1.0, v175 op_sel:[0,0,0] op_sel_hi:[1,0,1]
  v_pk_add_f16 v176, v132, v133
  v_pk_add_f16 v177, v134, v135
  v_add_f32 v27, v166, v168
  v_fma_mix_f32 v170, v176, 1.0, v177 op_sel:[0,0,0] op_sel_hi:[1,0,1]
  v_fma_mix_f32 v167, v172, 1.0, v174 op_sel:[1,0,1] op_sel_hi:[1,0,1]
  v_cmp_u_f32 vcc, v27, v170
  v_fma_mix_f32 v169, v173, 1.0, v175 op_sel:[1,0,1] op_sel_hi:[1,0,1]
  v_fma_mix_f32 v171, v176, 1.0, v177 op_sel:[1,0,1] op_sel_hi:[1,0,1]
  v_max3_u32 v27, v124, v126, v128
  v_max3_u32 v27, v27, v130, v132
  v_max3_u32 v27, v27, v133, v134
  v_max3_u32 v27, v27, v135, v135
  v_cmp_eq_u32 vcc, -1, v27
  s_nop 1
  s_cbranch_vccnz sr_172
  s_branch sj_161
fx_163:
  s_cmp_eq_u32 s81, 1
  s_cbranch_scc1 fk_164
  s_mov_b32 s81, 1
  v_max3_f32 v164, v166, v167, v168
  v_max3_f32 v165, v169, v170, v171
  v_max_f32 v164, v164, v165
  s_nop 1
  v_max_f32_dpp v164, v164, v164 row_ror:8 row_mask:0xf bank_mask:0xf
  v_mov_b32 v165, v164
  s_nop 1
  v_permlane32_swap_b32 v164, v165
  v_max_f32 v164, v164, v165
  v_mov_b32 v165, v164
  s_nop 1
  v_permlane16_swap_b32 v164, v165
  v_max_f32 v164, v164, v165
  v_sub_f32 v166, v166, v164
  v_sub_f32 v167, v167, v164
  v_sub_f32 v168, v168, v164
  v_sub_f32 v169, v169, v164
  v_sub_f32 v170, v170, v164
  v_sub_f32 v171, v171, v164
  s_branch ex_162
p2_168:
  buffer_load_dwordx4 v[68:71], v16, s[4:7], s60 offen sc1
  s_waitcnt vmcnt(1)
  v_mfma_f32_16x16x32_f16 v[120:123], v[44:47], v[72:75], 0
  v_bitop3_b32 v27, v72, s61, 1 bitop3:0x28
  v_cmp_ne_u32 vcc, 0, v27
  s_nop 1
  s_cbranch_vccz pg_167
  buffer_load_dwordx4 v[72:75], v16, s[4:7], s60 offen sc1
  s_add_u32 s54, s54, 1
  s_cmp_gt_u32 s54, 131072
  s_cbranch_scc1 end0
  s_branch pp_166
last_158:
  v_smfmac_f32_16x16x64_bf16 v[96:99], v[48:51], a[0:7], v22
  v_smfmac_f32_16x16x64_bf16 v[100:103], v[48:51], a[80:87], v22
  v_smfmac_f32_16x16x64_bf16 v[96:99], v[52:55], a[8:15], v22
  v_smfmac_f32_16x16x64_bf16 v[100:103], v[52:55], a[88:95], v22
  v_smfmac_f32_16x16x64_bf16 v[96:99], v[56:59], a[16:23], v22
  v_smfmac_f32_16x16x64_bf16 v[100:103], v[56:59], a[96:103], v22
  v_smfmac_f32_16x16x64_bf16 v[96:99], v[60:63], a[24:31], v22
  v_smfmac_f32_16x16x64_bf16 v[96:99], v[64:67], a[32:39], v22
  v_smfmac_f32_16x16x64_bf16 v[96:99], v[68:71], a[40:47], v22
  v_smfmac_f32_16x16x64_bf16 v[96:99], v[72:75], a[48:55], v22
  v_smfmac_f32_16x16x64_bf16 v[96:99], v[76:79], a[56:63], v22
  v_smfmac_f32_16x16x64_bf16 v[96:99], v[80:83], a[64:71], v22
  v_smfmac_f32_16x16x64_bf16 v[96:99], v[84:87], a[72:79], v22
  v_smfmac_f32_16x16x64_bf16 v[100:103], v[60:63], a[104:111], v22
  v_smfmac_f32_16x16x64_bf16 v[100:103], v[64:67], a[112:119], v22
  v_smfmac_f32_16x16x64_bf16 v[100:103], v[68:71], a[120:127], v22
  v_smfmac_f32_16x16x64_bf16 v[100:103], v[72:75], a[128:135], v22
  v_smfmac_f32_16x16x64_bf16 v[100:103], v[76:79], a[136:143], v22
  v_smfmac_f32_16x16x64_bf16 v[100:103], v[80:83], a[144:151], v22
  v_smfmac_f32_16x16x64_bf16 v[100:103], v[84:87], a[152:159], v22
  s_nop 7
  v_permlane32_swap_b32 v96, v100
  v_permlane32_swap_b32 v97, v101
  v_permlane32_swap_b32 v98, v102
  v_permlane32_swap_b32 v99, v103
  v_pk_add_f32 v[96:97], v[96:97], v[100:101]
  v_pk_add_f32 v[98:99], v[98:99], v[102:103]
  v_cvt_pk_bf16_f32 v182, v96, v97
  v_cvt_pk_bf16_f32 v183, v98, v99
  v_min_u32 v182, -2, v182
  ds_write_b64 v26, v[182:183]
  s_waitcnt lgkmcnt(0)
  s_barrier
  s_branch chain_done
E_33:
  v_add_u32 v190, 9216, v4
  ds_read_b128 v[84:87], v4 offset:9216
  s_waitcnt lgkmcnt(0)
  s_branch mo_179
  .p2align 3
top_174:
  s_waitcnt vmcnt(0)
  ds_write_b128 v190, v[84:87] offset:0
  v_cmp_eq_u32 s[22:23], -1, v84
  s_or_b64 vcc, s[22:23], s[22:23]
  s_cbranch_scc1 mr_175
mo_179:
  s_waitcnt lgkmcnt(0)
  s_barrier
  ds_read_b128 v[48:51], v4 offset:0
  ds_read_b128 v[52:55], v4 offset:1024
  v_smfmac_f32_16x16x64_bf16 v[92:95], v[84:87], v[248:255], v22
  ds_read_b128 v[56:59], v4 offset:2048
  ds_read_b128 v[60:63], v4 offset:3072
  v_smfmac_f32_16x16x64_bf16 v[88:91], v[84:87], a[232:239], v22
  s_waitcnt lgkmcnt(3)
  s_add_u32 m0, s74, 0
  s_add_u32 s21, s79, 0
  buffer_load_dwordx4 v4, s[16:19], s21 offen offset:0 sc1 lds
  v_smfmac_f32_16x16x64_bf16 v[92:95], v[48:51], a[240:247], v22
  ds_read_b128 v[64:67], v4 offset:4096
  ds_read_b128 v[68:71], v4 offset:5120
  s_add_u32 s22, s52, 3
  s_min_u32 s22, s22, 64
  v_smfmac_f32_16x16x64_bf16 v[88:91], v[48:51], a[160:167], v22
  s_waitcnt lgkmcnt(4)
  s_add_u32 m0, s74, 0
  s_add_u32 s21, s79, 0
  buffer_load_dwordx4 v4, s[16:19], s21 offen offset:1024 sc1 lds
  v_cmp_gt_u32 vcc, s22, v42
  v_smfmac_f32_16x16x64_bf16 v[92:95], v[52:55], a[248:255], v22
  ds_read_b128 v[72:75], v4 offset:6144
  ds_read_b128 v[76:79], v4 offset:7168
  s_cbranch_vccnz kw_180
kv_181:
  v_smfmac_f32_16x16x64_bf16 v[88:91], v[52:55], a[168:175], v22
  s_waitcnt lgkmcnt(5)
  s_add_u32 m0, s74, 2048
  s_add_u32 s21, s79, 65536
  buffer_load_dwordx4 v4, s[16:19], s21 offen offset:0 sc1 lds
  v_smfmac_f32_16x16x64_bf16 v[92:95], v[56:59], v[192:199], v22
  ds_read_b128 v[80:83], v4 offset:8192
  v_smfmac_f32_16x16x64_bf16 v[88:91], v[56:59], a[176:183], v22
  s_waitcnt lgkmcnt(5)
  s_add_u32 m0, s74, 10240
  s_nop 0
  buffer_load_dwordx4 v4, s[16:19], s73 offen offset:0 sc1 lds
  v_smfmac_f32_16x16x64_bf16 v[92:95], v[60:63], v[200:207], v22
  s_waitcnt lgkmcnt(4)
  v_smfmac_f32_16x16x64_bf16 v[92:95], v[64:67], v[208:215], v22
  s_waitcnt lgkmcnt(3)
  s_add_u32 m0, s74, 10240
  s_nop 0
  buffer_load_dwordx4 v4, s[16:19], s73 offen offset:1024 sc1 lds
  v_smfmac_f32_16x16x64_bf16 v[92:95], v[68:71], v[216:223], v22
  s_waitcnt lgkmcnt(2)
  v_smfmac_f32_16x16x64_bf16 v[92:95], v[72:75], v[224:231], v22
  s_waitcnt lgkmcnt(1)
  s_add_u32 m0, s74, 10240
  s_nop 0
  buffer_load_dwordx4 v4, s[16:19], s73 offen offset:2048 sc1 lds
  v_smfmac_f32_16x16x64_bf16 v[92:95], v[76:79], v[232:239], v22
  s_waitcnt lgkmcnt(0)
  v_smfmac_f32_16x16x64_bf16 v[92:95], v[80:83], v[240:247], v22
  s_add_u32 m0, s74, 8192
  s_add_u32 s21, s72, 0
  buffer_load_dwordx4 v32, s[16:19], s21 offen sc1 lds
  v_smfmac_f32_16x16x64_bf16 v[88:91], v[60:63], a[184:191], v22
  v_smfmac_f32_16x16x64_bf16 v[88:91], v[64:67], a[192:199], v22
  v_smfmac_f32_16x16x64_bf16 v[88:91], v[68:71], a[200:207], v22
  v_cvt_pk_bf16_f32 v122, v92, v93
  v_smfmac_f32_16x16x64_bf16 v[88:91], v[72:75], a[208:215], v22
  v_cvt_pk_bf16_f32 v123, v94, v95
  v_smfmac_f32_16x16x64_bf16 v[88:91], v[76:79], a[216:223], v22
  ds_write_b64 v12, v[122:123] offset:13056
  v_smfmac_f32_16x16x64_bf16 v[88:91], v[80:83], a[224:231], v22
  s_nop 7
  v_cvt_pk_bf16_f32 v120, v88, v89
  v_cvt_pk_bf16_f32 v121, v90, v91
  ds_write_b64 v12, v[120:121] offset:12544
  v_smfmac_f32_16x16x64_bf16 v[96:99], v[48:51], a[0:7], v22
  v_cmp_u_f32 vcc, v88, v89
  v_smfmac_f32_16x16x64_bf16 v[100:103], v[48:51], a[80:87], v22
  v_cmp_u_f32 s[22:23], v90, v91
  s_nop 0
  s_or_b64 vcc, vcc, s[22:23]
  s_cbranch_vccnz mn_176
mk_177:
  s_waitcnt lgkmcnt(0)
  s_barrier
  ds_read_b64_tr_b16 v[104:105], v7 offset:0
  ds_read_b64_tr_b16 v[106:107], v7 offset:768
  ds_read_b64_tr_b16 v[108:109], v7 offset:1536
  ds_read_b64 v[140:141], v11
  s_cmp_eq_u32 s52, 63
  s_cbranch_scc1 last_178
  v_smfmac_f32_16x16x64_bf16 v[96:99], v[52:55], a[8:15], v22
  v_smfmac_f32_16x16x64_bf16 v[100:103], v[52:55], a[88:95], v22
  v_smfmac_f32_16x16x64_bf16 v[96:99], v[56:59], a[16:23], v22
  v_smfmac_f32_16x16x64_bf16 v[100:103], v[56:59], a[96:103], v22
  v_smfmac_f32_16x16x64_bf16 v[96:99], v[60:63], a[24:31], v22
  v_smfmac_f32_16x16x64_bf16 v[96:99], v[64:67], a[32:39], v22
  v_smfmac_f32_16x16x64_bf16 v[96:99], v[68:71], a[40:47], v22
  v_smfmac_f32_16x16x64_bf16 v[96:99], v[72:75], a[48:55], v22
  v_smfmac_f32_16x16x64_bf16 v[96:99], v[76:79], a[56:63], v22
  v_smfmac_f32_16x16x64_bf16 v[96:99], v[80:83], a[64:71], v22
  v_smfmac_f32_16x16x64_bf16 v[96:99], v[84:87], a[72:79], v22
  v_smfmac_f32_16x16x64_bf16 v[100:103], v[60:63], a[104:111], v22
  v_smfmac_f32_16x16x64_bf16 v[100:103], v[64:67], a[112:119], v22
  v_smfmac_f32_16x16x64_bf16 v[100:103], v[68:71], a[120:127], v22
  v_smfmac_f32_16x16x64_bf16 v[100:103], v[72:75], a[128:135], v22
  v_cvt_pk_bf16_f32 v136, v96, v97
  v_smfmac_f32_16x16x64_bf16 v[100:103], v[76:79], a[136:143], v22
  v_cvt_pk_bf16_f32 v137, v98, v99
  v_smfmac_f32_16x16x64_bf16 v[100:103], v[80:83], a[144:151], v22
  v_smfmac_f32_16x16x64_bf16 v[100:103], v[84:87], a[152:159], v22
  s_sleep 2
  s_nop 7
  buffer_load_dwordx4 v[124:127], v9, s[8:11], s56 offen sc1
  buffer_load_dwordx4 v[128:131], v9, s[8:11], s56 offen offset:1024 sc1
  s_nop 5
  buffer_load_dwordx4 v[132:135], v10, s[8:11], s56 offen sc1
  s_waitcnt vmcnt(2)
  v_pk_add_f16 v172, v124, v126
  v_pk_add_f16 v173, v125, v127
  s_waitcnt vmcnt(1)
  v_pk_add_f16 v174, v128, v130
  v_pk_add_f16 v175, v129, v131
  v_fma_mix_f32 v166, v172, 1.0, v174 op_sel:[0,0,0] op_sel_hi:[1,0,1]
  v_fma_mix_f32 v168, v173, 1.0, v175 op_sel:[0,0,0] op_sel_hi:[1,0,1]
  s_waitcnt vmcnt(0)
  v_pk_add_f16 v176, v132, v133
  v_pk_add_f16 v177, v134, v135
  v_fma_mix_f32 v170, v176, 1.0, v177 op_sel:[0,0,0] op_sel_hi:[1,0,1]
  v_fma_mix_f32 v167, v172, 1.0, v174 op_sel:[1,0,1] op_sel_hi:[1,0,1]
  v_cmp_u_f32 vcc, v166, v170
  v_fma_mix_f32 v169, v173, 1.0, v175 op_sel:[1,0,1] op_sel_hi:[1,0,1]
  v_fma_mix_f32 v171, v176, 1.0, v177 op_sel:[1,0,1] op_sel_hi:[1,0,1]
  v_cvt_pk_bf16_f32 v138, v100, v101
  s_cbranch_vccnz sr_182
sj_183:
ex_184:
  v_exp_f32 v172, v166
  v_exp_f32 v173, v167
  v_exp_f32 v174, v168
  v_cvt_pk_bf16_f32 v156, v172, v173
  v_exp_f32 v175, v169
  v_exp_f32 v176, v170
  v_cvt_pk_bf16_f32 v157, v174, v175
  v_mov_b32_dpp v158, v156 row_ror:8 row_mask:0xf bank_mask:0xf
  v_exp_f32 v177, v171
  v_mov_b32_dpp v159, v157 row_ror:8 row_mask:0xf bank_mask:0xf
  v_cvt_pk_bf16_f32 v160, v176, v177
  v_cvt_pk_bf16_f32 v139, v102, v103
  v_mfma_f32_16x16x32_bf16 v[178:181], v[152:155], v[156:159], 0
  s_waitcnt lgkmcnt(0)
  v_mov_b32_dpp v161, v160 row_ror:8 row_mask:0xf bank_mask:0xf
  v_mfma_f32_16x16x32_bf16 v[182:185], v[144:147], v[156:159], 0
  s_nop 0
  v_mfma_f32_16x16x32_bf16 v[178:181], v[140:143], v[160:163], v[178:181]
  v_mfma_f32_16x16x32_bf16 v[182:185], v[136:139], v[160:163], v[182:185]
  v_mfma_f32_16x16x32_bf16 v[186:189], v[148:151], v[156:159], 0
  v_mfma_f32_16x16x32_bf16 v[186:189], v[138:141], v[160:163], v[186:189]
  s_mov_b64 exec, s[62:63]
  v_rcp_f32 v164, v180
  s_nop 0
  v_pk_mul_f32 v[178:179], v[178:179], v[164:165] op_sel_hi:[1,0]
  v_pk_mul_f32 v[182:183], v[182:183], v[164:165] op_sel_hi:[1,0]
  v_pk_mul_f32 v[184:185], v[184:185], v[164:165] op_sel_hi:[1,0]
  v_cvt_pk_f16_f32 v64, v178, v179
  v_cvt_pk_f16_f32 v60, v182, v183
  v_pk_mul_f32 v[186:187], v[186:187], v[164:165] op_sel_hi:[1,0]
  v_pk_mul_f32 v[188:189], v[188:189], v[164:165] op_sel_hi:[1,0]
  v_cvt_pk_f16_f32 v61, v184, v185
  v_cvt_pk_f16_f32 v62, v186, v187
  v_cvt_pk_f16_f32 v63, v188, v189
  ds_write_b128 v13, v[60:63]
  ds_write_b32 v14, v64
  v_add_f32 v165, v164, v180
  v_cmp_ngt_f32 vcc, s80, v165
  s_mov_b64 exec, -1
  s_nop 0
  s_cbranch_vccnz fx_185
fk_186:
  s_waitcnt lgkmcnt(0)
  s_barrier
  ds_read_b128 v[166:169], v4 offset:13824
  ds_read_b128 v[170:173], v4 offset:14464
  ds_read_b128 v[174:177], v4 offset:15104
  ds_read_b128 v[178:181], v4 offset:15744
  s_mov_b64 exec, s[66:67]
  s_waitcnt lgkmcnt(2)
  v_pk_add_f16 v166, v166, v170
  v_pk_add_f16 v167, v167, v171
  v_pk_add_f16 v168, v168, v172
  v_pk_add_f16 v169, v169, v173
  s_waitcnt lgkmcnt(1)
  v_pk_add_f16 v166, v166, v174
  v_pk_add_f16 v167, v167, v175
  v_pk_add_f16 v168, v168, v176
  v_pk_add_f16 v169, v169, v177
  s_waitcnt lgkmcnt(0)
  v_pk_add_f16 v166, v166, v178
  v_pk_add_f16 v167, v167, v179
  v_pk_add_f16 v168, v168, v180
  v_pk_add_f16 v169, v169, v181
  v_and_or_b32 v166, v166, -2, s61
  buffer_store_dwordx4 v[166:169], v15, s[4:7], s60 offen sc1
  s_mov_b64 exec, -1
  v_permlane32_swap_b32 v96, v100
  v_permlane32_swap_b32 v97, v101
  v_permlane32_swap_b32 v98, v102
  v_permlane32_swap_b32 v99, v103
  v_pk_add_f32 v[96:97], v[96:97], v[100:101]
  v_pk_add_f32 v[98:99], v[98:99], v[102:103]
  v_cvt_pk_bf16_f32 v182, v96, v97
  v_cvt_pk_bf16_f32 v183, v98, v99
  v_min_u32 v182, -2, v182
  ds_write_b64 v26, v[182:183]
  v_permlane32_swap_b32 v88, v92
  v_permlane32_swap_b32 v89, v93
  v_permlane32_swap_b32 v90, v94
  v_permlane32_swap_b32 v91, v95
  v_pk_add_f32 v[88:89], v[88:89], v[92:93]
  v_pk_add_f32 v[90:91], v[90:91], v[94:95]
  v_cvt_pk_bf16_f32 v184, v88, v89
  v_cvt_pk_bf16_f32 v185, v90, v91
  v_min_u32 v184, -2, v184
  ds_write_b64 v43, v[184:185]
  ds_read_b128 v[144:147], v18
  ds_read_b128 v[148:151], v18 offset:1024
  ds_read_b128 v[152:155], v19
  v_xor_b32 v18, 16384, v18
  v_xor_b32 v19, 16384, v19
  v_mov_b32 v88, 0
  v_mov_b32 v89, 0
  v_mov_b32 v90, 0
  v_mov_b32 v91, 0
  v_mov_b32 v92, 0
  v_mov_b32 v93, 0
  v_mov_b32 v94, 0
  v_mov_b32 v95, 0
  v_mov_b32 v96, 0
  v_mov_b32 v97, 0
  v_mov_b32 v98, 0
  v_mov_b32 v99, 0
  v_mov_b32 v100, 0
  v_mov_b32 v101, 0
  v_mov_b32 v102, 0
  v_mov_b32 v103, 0
  s_mov_b32 s81, 0
  s_waitcnt lgkmcnt(0)
  s_barrier
  s_xor_b32 s74, s74, 16384
  s_add_u32 s73, s73, 2097152
  s_xor_b32 s73, s73, 8192
  s_add_u32 s79, s79, 2097152
  s_xor_b32 s79, s79, 8192
  s_add_u32 s21, s72, 524288
  s_xor_b32 s72, s72, s21
  s_lshr_b32 s72, s72, 8
  s_and_b32 s72, s72, 8192
  s_xor_b32 s72, s72, s21
  v_mov_b32 v28, s61
  v_mov_b32 v166, s52
  s_mov_b64 exec, 1
  buffer_store_dword v166, v23, s[12:15], s77 offen sc1
  s_mov_b64 exec, -1
  ds_read_b128 v[170:173], v4 offset:16384
  ds_read_b128 v[174:177], v4 offset:17408
  ds_read_b128 v[178:181], v4 offset:18432
  v_min_u32 v104, -2, v104
  v_min_u32 v108, -2, v108
  s_mov_b32 s90, s70
  s_add_u32 s70, s70, 2097152
  s_xor_b32 s70, s70, 8192
  buffer_store_dwordx4 v[104:107], v36, s[16:19], s90 offen offset:2560 sc1
  buffer_store_dwordx2 v[108:109], v37, s[16:19], s90 offen offset:3072 sc1
  s_waitcnt lgkmcnt(0)
  buffer_store_dwordx4 v[170:173], v4, s[16:19], s90 offen offset:0 sc1
  buffer_store_dwordx4 v[174:177], v4, s[16:19], s90 offen offset:1024 sc1
  buffer_store_dwordx4 v[178:181], v38, s[16:19], s90 offen offset:2048 sc1
  buffer_load_dword v42, v41, s[12:15], s76 offen sc1
nt_187:
  s_barrier
  s_mov_b32 s58, s55
  s_add_u32 s52, s52, 1
  s_and_b32 s21, s52, 3
  s_mul_i32 s56, s21, 122880
  s_add_u32 s21, s52, 1
  s_and_b32 s21, s21, 3
  s_mul_i32 s55, s21, 122880
  s_add_u32 s55, s55, s75
  s_add_u32 s21, s52, 2
  s_and_b32 s21, s21, 3
  s_mul_i32 s57, s21, 122880
  s_add_u32 s21, s52, 3
  s_and_b32 s21, s21, 3
  s_mul_i32 s59, s21, 122880
  s_add_u32 s59, s59, s75
  s_bfe_u32 s61, s52, 0x10001
  s_and_b32 s21, s52, 1
  s_lshl_b32 s60, s21, 19
  s_mov_b32 s54, 0
  s_sleep 3
  s_nop 2
  buffer_load_dwordx4 v[84:87], v190, s[8:11], s58 offen offset:0 sc1
  s_branch top_174
mr_175:
  s_mov_b64 exec, s[22:23]
  s_cbranch_execz ms_188
  buffer_load_dwordx4 v[84:87], v190, s[8:11], s58 offen offset:0 sc1
ms_188:
  s_add_u32 s54, s54, 1
  s_cmp_gt_u32 s54, 131072
  s_cbranch_scc1 end0
  s_waitcnt vmcnt(0)
  s_mov_b64 exec, s[22:23]
  ds_write_b128 v190, v[84:87] offset:0
  v_cmp_eq_u32 s[22:23], -1, v84
  s_mov_b64 exec, -1
  s_or_b64 vcc, s[22:23], s[22:23]
  s_cbranch_scc1 mr_175
  s_branch mo_179
kw_180:
  s_mov_b32 s101, 0
wm_189:
  buffer_load_dword v42, v41, s[12:15], s76 offen sc1
  s_add_u32 s101, s101, 1
  s_cmp_gt_u32 s101, 131072
  s_cbranch_scc1 end0
  s_waitcnt vmcnt(0)
  v_cmp_gt_u32 vcc, s22, v42
  v_readfirstlane_b32 s100, v42
  s_nop 0
  s_cbranch_vccz wm_190
  s_sleep 1
  s_branch wm_189
wm_190:
  s_branch kv_181
mn_176:
  v_max3_u32 v27, v48, v49, v50
  v_max3_u32 v27, v27, v51, v52
  v_max3_u32 v27, v27, v53, v54
  v_max3_u32 v27, v27, v55, v56
  v_max3_u32 v27, v27, v57, v58
  v_max3_u32 v27, v27, v59, v60
  v_max3_u32 v27, v27, v61, v62
  v_max3_u32 v27, v27, v63, v64
  v_max3_u32 v27, v27, v65, v66
  v_max3_u32 v27, v27, v67, v68
  v_max3_u32 v27, v27, v69, v70
  v_max3_u32 v27, v27, v71, v72
  v_max3_u32 v27, v27, v73, v74
  v_max3_u32 v27, v27, v75, v76
  v_max3_u32 v27, v27, v77, v78
  v_max3_u32 v27, v27, v79, v80
  v_max3_u32 v27, v27, v81, v82
  v_max3_u32 v27, v27, v83, v84
  v_max3_u32 v27, v27, v85, v86
  v_max3_u32 v27, v27, v87, v87
  v_cmp_eq_u32 vcc, -1, v27
  s_cmp_eq_u32 s52, 0
  s_cbranch_scc1 mk_177
  s_cbranch_vccz mk_177
  s_waitcnt lgkmcnt(0)
  s_barrier
  s_nop 7
  v_mov_b32 v88, 0
  v_mov_b32 v89, 0
  v_mov_b32 v90, 0
  v_mov_b32 v91, 0
  v_mov_b32 v92, 0
  v_mov_b32 v93, 0
  v_mov_b32 v94, 0
  v_mov_b32 v95, 0
  v_mov_b32 v96, 0
  v_mov_b32 v97, 0
  v_mov_b32 v98, 0
  v_mov_b32 v99, 0
  v_mov_b32 v100, 0
  v_mov_b32 v101, 0
  v_mov_b32 v102, 0
  v_mov_b32 v103, 0
  s_mov_b64 s[22:23], -1
  s_branch mr_175
sr_182:
  s_mov_b32 s54, 0
sr_191:
  s_mov_b64 exec, vcc
  buffer_load_dwordx4 v[124:127], v9, s[8:11], s56 offen sc1
  buffer_load_dwordx4 v[128:131], v9, s[8:11], s56 offen offset:1024 sc1
  buffer_load_dwordx4 v[132:135], v10, s[8:11], s56 offen sc1
  s_mov_b64 exec, -1
  s_add_u32 s54, s54, 1
  s_cmp_gt_u32 s54, 131072
  s_cbranch_scc1 end0
  s_and_b32 s21, s54, 31
  s_cbranch_scc0 sr_192
  s_waitcnt vmcnt(0)
  v_pk_add_f16 v172, v124, v126
  v_pk_add_f16 v173, v125, v127
  v_pk_add_f16 v174, v128, v130
  v_pk_add_f16 v175, v129, v131
  v_fma_mix_f32 v166, v172, 1.0, v174 op_sel:[0,0,0] op_sel_hi:[1,0,1]
  v_fma_mix_f32 v168, v173, 1.0, v175 op_sel:[0,0,0] op_sel_hi:[1,0,1]
  v_pk_add_f16 v176, v132, v133
  v_pk_add_f16 v177, v134, v135
  v_add_f32 v27, v166, v168
  v_fma_mix_f32 v170, v176, 1.0, v177 op_sel:[0,0,0] op_sel_hi:[1,0,1]
  v_fma_mix_f32 v167, v172, 1.0, v174 op_sel:[1,0,1] op_sel_hi:[1,0,1]
  v_cmp_u_f32 vcc, v27, v170
  v_fma_mix_f32 v169, v173, 1.0, v175 op_sel:[1,0,1] op_sel_hi:[1,0,1]
  v_fma_mix_f32 v171, v176, 1.0, v177 op_sel:[1,0,1] op_sel_hi:[1,0,1]
  s_cbranch_vccnz sr_191
  s_branch sj_183
sr_192:
  s_waitcnt vmcnt(0)
  v_pk_add_f16 v172, v124, v126
  v_pk_add_f16 v173, v125, v127
  v_pk_add_f16 v174, v128, v130
  v_pk_add_f16 v175, v129, v131
  v_fma_mix_f32 v166, v172, 1.0, v174 op_sel:[0,0,0] op_sel_hi:[1,0,1]
  v_fma_mix_f32 v168, v173, 1.0, v175 op_sel:[0,0,0] op_sel_hi:[1,0,1]
  v_pk_add_f16 v176, v132, v133
  v_pk_add_f16 v177, v134, v135
  v_add_f32 v27, v166, v168
  v_fma_mix_f32 v170, v176, 1.0, v177 op_sel:[0,0,0] op_sel_hi:[1,0,1]
  v_fma_mix_f32 v167, v172, 1.0, v174 op_sel:[1,0,1] op_sel_hi:[1,0,1]
  v_cmp_u_f32 vcc, v27, v170
  v_fma_mix_f32 v169, v173, 1.0, v175 op_sel:[1,0,1] op_sel_hi:[1,0,1]
  v_fma_mix_f32 v171, v176, 1.0, v177 op_sel:[1,0,1] op_sel_hi:[1,0,1]
  v_max3_u32 v27, v124, v126, v128
  v_max3_u32 v27, v27, v130, v132
  v_max3_u32 v27, v27, v133, v134
  v_max3_u32 v27, v27, v135, v135
  v_cmp_eq_u32 vcc, -1, v27
  s_nop 1
  s_cbranch_vccnz sr_191
  s_branch sj_183
fx_185:
  s_cmp_eq_u32 s81, 1
  s_cbranch_scc1 fk_186
  s_mov_b32 s81, 1
  v_max3_f32 v164, v166, v167, v168
  v_max3_f32 v165, v169, v170, v171
  v_max_f32 v164, v164, v165
  s_nop 1
  v_max_f32_dpp v164, v164, v164 row_ror:8 row_mask:0xf bank_mask:0xf
  v_mov_b32 v165, v164
  s_nop 1
  v_permlane32_swap_b32 v164, v165
  v_max_f32 v164, v164, v165
  v_mov_b32 v165, v164
  s_nop 1
  v_permlane16_swap_b32 v164, v165
  v_max_f32 v164, v164, v165
  v_sub_f32 v166, v166, v164
  v_sub_f32 v167, v167, v164
  v_sub_f32 v168, v168, v164
  v_sub_f32 v169, v169, v164
  v_sub_f32 v170, v170, v164
  v_sub_f32 v171, v171, v164
  s_branch ex_184
last_178:
  v_smfmac_f32_16x16x64_bf16 v[96:99], v[52:55], a[8:15], v22
  v_smfmac_f32_16x16x64_bf16 v[100:103], v[52:55], a[88:95], v22
  v_smfmac_f32_16x16x64_bf16 v[96:99], v[56:59], a[16:23], v22
  v_smfmac_f32_16x16x64_bf16 v[100:103], v[56:59], a[96:103], v22
  v_smfmac_f32_16x16x64_bf16 v[96:99], v[60:63], a[24:31], v22
  v_smfmac_f32_16x16x64_bf16 v[96:99], v[64:67], a[32:39], v22
  v_smfmac_f32_16x16x64_bf16 v[96:99], v[68:71], a[40:47], v22
  v_smfmac_f32_16x16x64_bf16 v[96:99], v[72:75], a[48:55], v22
  v_smfmac_f32_16x16x64_bf16 v[96:99], v[76:79], a[56:63], v22
  v_smfmac_f32_16x16x64_bf16 v[96:99], v[80:83], a[64:71], v22
  v_smfmac_f32_16x16x64_bf16 v[96:99], v[84:87], a[72:79], v22
  v_smfmac_f32_16x16x64_bf16 v[100:103], v[60:63], a[104:111], v22
  v_smfmac_f32_16x16x64_bf16 v[100:103], v[64:67], a[112:119], v22
  v_smfmac_f32_16x16x64_bf16 v[100:103], v[68:71], a[120:127], v22
  v_smfmac_f32_16x16x64_bf16 v[100:103], v[72:75], a[128:135], v22
  v_smfmac_f32_16x16x64_bf16 v[100:103], v[76:79], a[136:143], v22
  v_smfmac_f32_16x16x64_bf16 v[100:103], v[80:83], a[144:151], v22
  v_smfmac_f32_16x16x64_bf16 v[100:103], v[84:87], a[152:159], v22
  s_nop 7
  v_permlane32_swap_b32 v96, v100
  v_permlane32_swap_b32 v97, v101
  v_permlane32_swap_b32 v98, v102
  v_permlane32_swap_b32 v99, v103
  v_pk_add_f32 v[96:97], v[96:97], v[100:101]
  v_pk_add_f32 v[98:99], v[98:99], v[102:103]
  v_cvt_pk_bf16_f32 v182, v96, v97
  v_cvt_pk_bf16_f32 v183, v98, v99
  v_min_u32 v182, -2, v182
  ds_write_b64 v26, v[182:183]
  v_permlane32_swap_b32 v88, v92
  v_permlane32_swap_b32 v89, v93
  v_permlane32_swap_b32 v90, v94
  v_permlane32_swap_b32 v91, v95
  v_pk_add_f32 v[88:89], v[88:89], v[92:93]
  v_pk_add_f32 v[90:91], v[90:91], v[94:95]
  v_cvt_pk_bf16_f32 v184, v88, v89
  v_cvt_pk_bf16_f32 v185, v90, v91
  v_min_u32 v184, -2, v184
  ds_write_b64 v43, v[184:185]
  s_waitcnt lgkmcnt(0)
  s_barrier
  ds_read_b128 v[170:173], v4 offset:16384
  ds_read_b128 v[174:177], v4 offset:17408
  ds_read_b128 v[178:181], v4 offset:18432
  v_min_u32 v104, -2, v104
  v_min_u32 v108, -2, v108
  s_mov_b32 s90, s70
  s_add_u32 s70, s70, 2097152
  s_xor_b32 s70, s70, 8192
  buffer_store_dwordx4 v[104:107], v36, s[16:19], s90 offen offset:2560 sc1
  buffer_store_dwordx2 v[108:109], v37, s[16:19], s90 offen offset:3072 sc1
  s_waitcnt lgkmcnt(0)
  buffer_store_dwordx4 v[170:173], v4, s[16:19], s90 offen offset:0 sc1
  buffer_store_dwordx4 v[174:177], v4, s[16:19], s90 offen offset:1024 sc1
  buffer_store_dwordx4 v[178:181], v38, s[16:19], s90 offen offset:2048 sc1
  s_waitcnt vmcnt(0)
  v_mov_b32 v166, 64
  s_mov_b64 exec, 1
  buffer_store_dword v166, v23, s[12:15], s77 offen sc1
  s_mov_b64 exec, -1
  s_branch chain_done
chain_done:
end0:
  s_endpgm
gemm_side:
  s_bfe_u32 s23, s22, 0x20005
  s_add_u32 s22, s22, 31
  s_and_b32 s22, s22, 31
  s_lshl_b32 s21, s23, 3
  s_add_u32 s2, s21, s22
  s_add_u32 s3, s2, 72
  s_add_u32 s24, s2, 48
  s_add_u32 s2, s2, s21
  s_cmp_lt_u32 s22, 24
  s_cselect_b32 s3, s24, s3
  s_cmp_lt_u32 s22, 16
  s_cselect_b32 s3, s2, s3
  s_mov_b32 s2, s3
  s_cmp_ge_u32 s3, 64
  s_cbranch_scc1 not_kv
  s_load_dwordx2 s[4:5], s[0:1], 0
  s_load_dwordx2 s[6:7], s[0:1], 24
  s_load_dwordx2 s[36:37], s[0:1], 32
  s_load_dwordx2 s[38:39], s[0:1], 104
  s_and_b32 s43, s3, 1
  s_bfe_u32 s42, s3, 0x50001
  s_lshr_b32 s40, s42, 2
  s_waitcnt lgkmcnt(0)
  s_cmp_eq_u32 s43, 1
  s_cselect_b32 s6, s36, s6
  s_cselect_b32 s7, s37, s7
  s_mov_b32 s8, s4
  s_mov_b32 s9, s5
  s_mov_b32 s10, 2621440
  s_mov_b32 s11, 0x00020000
  s_mov_b32 s12, s6
  s_mov_b32 s13, s7
  s_mov_b32 s14, 7864320
  s_mov_b32 s15, 0x00020000
  s_mov_b32 s16, s38
  s_mov_b32 s17, s39
  s_mov_b32 s18, 167772160
  s_mov_b32 s19, 0x00020000
  s_add_u32 s72, s38, 170983424
  s_addc_u32 s73, s39, 0
  s_mov_b32 s74, 96768
  s_mov_b32 s75, 0x00020000
  s_mul_i32 s44, s42, 384
  s_mov_b32 s30, 0
  s_mov_b32 s25, 80768
  v_lshrrev_b32 v4, 3, v1
  v_and_b32 v5, 7, v1
  v_xor_b32 v5, v5, v4
  s_mul_i32 s21, s20, 16
  v_add_u32 v4, s21, v4
  v_mul_u32_u24 v4, 1280, v4
  v_lshl_add_u32 v10, v5, 4, v4
  s_mul_i32 s31, s20, 2048
  v_add_u32 v11, 10240, v10
  v_mov_b32 v9, 2731
  v_add_u32 v8, 0, v1
  v_mul_u32_u24 v7, v8, v9
  v_lshrrev_b32 v7, 16, v7
  v_mul_u32_u24 v4, 24, v7
  v_sub_u32 v8, v8, v4
  s_mov_b32 s21, 12288
  v_mul_lo_u32 v7, v7, s21
  v_lshl_add_u32 v4, v8, 4, v7
  v_add_u32 v8, 64, v1
  v_mul_u32_u24 v7, v8, v9
  v_lshrrev_b32 v7, 16, v7
  v_mul_u32_u24 v5, 24, v7
  v_sub_u32 v8, v8, v5
  s_mov_b32 s21, 12288
  v_mul_lo_u32 v7, v7, s21
  v_lshl_add_u32 v5, v8, 4, v7
  v_add_u32 v8, 128, v1
  v_mul_u32_u24 v7, v8, v9
  v_lshrrev_b32 v7, 16, v7
  v_mul_u32_u24 v6, 24, v7
  v_sub_u32 v8, v8, v6
  s_mov_b32 s21, 12288
  v_mul_lo_u32 v7, v7, s21
  v_lshl_add_u32 v6, v8, 4, v7
  v_lshrrev_b32 v7, 2, v2
  v_lshl_add_u32 v7, v3, 3, v7
  v_mul_u32_u24 v7, 384, v7
  v_and_b32 v8, 3, v2
  v_lshlrev_b32 v8, 3, v8
  s_mul_i32 s21, s20, 96
  v_add3_u32 v7, v7, v8, s21
  v_add_u32 v8, 49152, v7
  s_mul_i32 s21, s20, 393216
  s_add_u32 s21, s21, 0
  s_add_u32 s21, s21, s44
  s_mul_i32 s22, s20, 12288
  s_add_u32 s22, s22, 0
  s_add_u32 m0, s22, 0
  s_nop 0
  buffer_load_dwordx4 v4, s[12:15], s21 offen lds
  s_add_u32 m0, s22, 1024
  s_nop 0
  buffer_load_dwordx4 v5, s[12:15], s21 offen lds
  s_add_u32 m0, s22, 2048
  s_nop 0
  buffer_load_dwordx4 v6, s[12:15], s21 offen lds
  s_mul_i32 s21, s20, 393216
  s_add_u32 s21, s21, 98304
  s_add_u32 s21, s21, s44
  s_mul_i32 s22, s20, 12288
  s_add_u32 s22, s22, 3072
  s_add_u32 m0, s22, 0
  s_nop 0
  buffer_load_dwordx4 v4, s[12:15], s21 offen lds
  s_add_u32 m0, s22, 1024
  s_nop 0
  buffer_load_dwordx4 v5, s[12:15], s21 offen lds
  s_add_u32 m0, s22, 2048
  s_nop 0
  buffer_load_dwordx4 v6, s[12:15], s21 offen lds
  s_mul_i32 s21, s20, 393216
  s_add_u32 s21, s21, 196608
  s_add_u32 s21, s21, s44
  s_mul_i32 s22, s20, 12288
  s_add_u32 s22, s22, 6144
  s_add_u32 m0, s22, 0
  s_nop 0
  buffer_load_dwordx4 v4, s[12:15], s21 offen lds
  s_add_u32 m0, s22, 1024
  s_nop 0
  buffer_load_dwordx4 v5, s[12:15], s21 offen lds
  s_add_u32 m0, s22, 2048
  s_nop 0
  buffer_load_dwordx4 v6, s[12:15], s21 offen lds
  s_mul_i32 s21, s20, 393216
  s_add_u32 s21, s21, 294912
  s_add_u32 s21, s21, s44
  s_mul_i32 s22, s20, 12288
  s_add_u32 s22, s22, 9216
  s_add_u32 m0, s22, 0
  s_nop 0
  buffer_load_dwordx4 v4, s[12:15], s21 offen lds
  s_add_u32 m0, s22, 1024
  s_nop 0
  buffer_load_dwordx4 v5, s[12:15], s21 offen lds
  s_add_u32 m0, s22, 2048
  s_nop 0
  buffer_load_dwordx4 v6, s[12:15], s21 offen lds
  s_add_u32 m0, s31, 98304
  s_nop 0
  buffer_load_dwordx4 v10, s[8:11], s30 offen lds
  s_add_u32 m0, s31, 99328
  s_nop 0
  buffer_load_dwordx4 v11, s[8:11], s30 offen lds
  s_add_u32 s30, s30, 128
  s_add_u32 m0, s31, 106496
  s_nop 0
  buffer_load_dwordx4 v10, s[8:11], s30 offen lds
  s_add_u32 m0, s31, 107520
  s_nop 0
  buffer_load_dwordx4 v11, s[8:11], s30 offen lds
  s_add_u32 s30, s30, 128
  s_add_u32 m0, s31, 114688
  s_nop 0
  buffer_load_dwordx4 v10, s[8:11], s30 offen lds
  s_add_u32 m0, s31, 115712
  s_nop 0
  buffer_load_dwordx4 v11, s[8:11], s30 offen lds
  s_add_u32 s30, s30, 128
  s_mul_i32 s21, s20, 393216
  s_add_u32 s21, s21, 1572864
  s_add_u32 s21, s21, s44
  s_mul_i32 s22, s20, 12288
  s_add_u32 s22, s22, 49152
  s_add_u32 m0, s22, 0
  s_nop 0
  buffer_load_dwordx4 v4, s[12:15], s21 offen lds
  s_add_u32 m0, s22, 1024
  s_nop 0
  buffer_load_dwordx4 v5, s[12:15], s21 offen lds
  s_add_u32 m0, s22, 2048
  s_nop 0
  buffer_load_dwordx4 v6, s[12:15], s21 offen lds
  s_mul_i32 s21, s20, 393216
  s_add_u32 s21, s21, 1671168
  s_add_u32 s21, s21, s44
  s_mul_i32 s22, s20, 12288
  s_add_u32 s22, s22, 52224
  s_add_u32 m0, s22, 0
  s_nop 0
  buffer_load_dwordx4 v4, s[12:15], s21 offen lds
  s_add_u32 m0, s22, 1024
  s_nop 0
  buffer_load_dwordx4 v5, s[12:15], s21 offen lds
  s_add_u32 m0, s22, 2048
  s_nop 0
  buffer_load_dwordx4 v6, s[12:15], s21 offen lds
  s_mul_i32 s21, s20, 393216
  s_add_u32 s21, s21, 1769472
  s_add_u32 s21, s21, s44
  s_mul_i32 s22, s20, 12288
  s_add_u32 s22, s22, 55296
  s_add_u32 m0, s22, 0
  s_nop 0
  buffer_load_dwordx4 v4, s[12:15], s21 offen lds
  s_add_u32 m0, s22, 1024
  s_nop 0
  buffer_load_dwordx4 v5, s[12:15], s21 offen lds
  s_add_u32 m0, s22, 2048
  s_nop 0
  buffer_load_dwordx4 v6, s[12:15], s21 offen lds
  s_mul_i32 s21, s20, 393216
  s_add_u32 s21, s21, 1867776
  s_add_u32 s21, s21, s44
  s_mul_i32 s22, s20, 12288
  s_add_u32 s22, s22, 58368
  s_add_u32 m0, s22, 0
  s_nop 0
  buffer_load_dwordx4 v4, s[12:15], s21 offen lds
  s_add_u32 m0, s22, 1024
  s_nop 0
  buffer_load_dwordx4 v5, s[12:15], s21 offen lds
  s_add_u32 m0, s22, 2048
  s_nop 0
  buffer_load_dwordx4 v6, s[12:15], s21 offen lds
  s_waitcnt vmcnt(12)
  s_barrier
  ds_read_b64_tr_b16 a[0:1], v7 offset:0
  ds_read_b64_tr_b16 a[2:3], v7 offset:1536
  ds_read_b64_tr_b16 a[4:5], v7 offset:32
  ds_read_b64_tr_b16 a[6:7], v7 offset:1568
  ds_read_b64_tr_b16 a[8:9], v7 offset:64
  ds_read_b64_tr_b16 a[10:11], v7 offset:1600
  ds_read_b64_tr_b16 a[12:13], v7 offset:12288
  ds_read_b64_tr_b16 a[14:15], v7 offset:13824
  ds_read_b64_tr_b16 a[16:17], v7 offset:12320
  ds_read_b64_tr_b16 a[18:19], v7 offset:13856
  ds_read_b64_tr_b16 a[20:21], v7 offset:12352
  ds_read_b64_tr_b16 a[22:23], v7 offset:13888
  ds_read_b64_tr_b16 a[24:25], v7 offset:24576
  ds_read_b64_tr_b16 a[26:27], v7 offset:26112
  ds_read_b64_tr_b16 a[28:29], v7 offset:24608
  ds_read_b64_tr_b16 a[30:31], v7 offset:26144
  ds_read_b64_tr_b16 a[32:33], v7 offset:24640
  ds_read_b64_tr_b16 a[34:35], v7 offset:26176
  ds_read_b64_tr_b16 a[36:37], v7 offset:36864
  ds_read_b64_tr_b16 a[38:39], v7 offset:38400
  ds_read_b64_tr_b16 a[40:41], v7 offset:36896
  ds_read_b64_tr_b16 a[42:43], v7 offset:38432
  ds_read_b64_tr_b16 a[44:45], v7 offset:36928
  ds_read_b64_tr_b16 a[46:47], v7 offset:38464
  s_waitcnt lgkmcnt(0)
  s_barrier
  s_mul_i32 s21, s20, 393216
  s_add_u32 s21, s21, 3145728
  s_add_u32 s21, s21, s44
  s_mul_i32 s22, s20, 12288
  s_add_u32 s22, s22, 0
  s_add_u32 m0, s22, 0
  s_nop 0
  buffer_load_dwordx4 v4, s[12:15], s21 offen lds
  s_add_u32 m0, s22, 1024
  s_nop 0
  buffer_load_dwordx4 v5, s[12:15], s21 offen lds
  s_add_u32 m0, s22, 2048
  s_nop 0
  buffer_load_dwordx4 v6, s[12:15], s21 offen lds
  s_mul_i32 s21, s20, 393216
  s_add_u32 s21, s21, 3244032
  s_add_u32 s21, s21, s44
  s_mul_i32 s22, s20, 12288
  s_add_u32 s22, s22, 3072
  s_add_u32 m0, s22, 0
  s_nop 0
  buffer_load_dwordx4 v4, s[12:15], s21 offen lds
  s_add_u32 m0, s22, 1024
  s_nop 0
  buffer_load_dwordx4 v5, s[12:15], s21 offen lds
  s_add_u32 m0, s22, 2048
  s_nop 0
  buffer_load_dwordx4 v6, s[12:15], s21 offen lds
  s_mul_i32 s21, s20, 393216
  s_add_u32 s21, s21, 3342336
  s_add_u32 s21, s21, s44
  s_mul_i32 s22, s20, 12288
  s_add_u32 s22, s22, 6144
  s_add_u32 m0, s22, 0
  s_nop 0
  buffer_load_dwordx4 v4, s[12:15], s21 offen lds
  s_add_u32 m0, s22, 1024
  s_nop 0
  buffer_load_dwordx4 v5, s[12:15], s21 offen lds
  s_add_u32 m0, s22, 2048
  s_nop 0
  buffer_load_dwordx4 v6, s[12:15], s21 offen lds
  s_mul_i32 s21, s20, 393216
  s_add_u32 s21, s21, 3440640
  s_add_u32 s21, s21, s44
  s_mul_i32 s22, s20, 12288
  s_add_u32 s22, s22, 9216
  s_add_u32 m0, s22, 0
  s_nop 0
  buffer_load_dwordx4 v4, s[12:15], s21 offen lds
  s_add_u32 m0, s22, 1024
  s_nop 0
  buffer_load_dwordx4 v5, s[12:15], s21 offen lds
  s_add_u32 m0, s22, 2048
  s_nop 0
  buffer_load_dwordx4 v6, s[12:15], s21 offen lds
  s_waitcnt vmcnt(12)
  s_barrier
  ds_read_b64_tr_b16 a[48:49], v8 offset:0
  ds_read_b64_tr_b16 a[50:51], v8 offset:1536
  ds_read_b64_tr_b16 a[52:53], v8 offset:32
  ds_read_b64_tr_b16 a[54:55], v8 offset:1568
  ds_read_b64_tr_b16 a[56:57], v8 offset:64
  ds_read_b64_tr_b16 a[58:59], v8 offset:1600
  ds_read_b64_tr_b16 a[60:61], v8 offset:12288
  ds_read_b64_tr_b16 a[62:63], v8 offset:13824
  ds_read_b64_tr_b16 a[64:65], v8 offset:12320
  ds_read_b64_tr_b16 a[66:67], v8 offset:13856
  ds_read_b64_tr_b16 a[68:69], v8 offset:12352
  ds_read_b64_tr_b16 a[70:71], v8 offset:13888
  ds_read_b64_tr_b16 a[72:73], v8 offset:24576
  ds_read_b64_tr_b16 a[74:75], v8 offset:26112
  ds_read_b64_tr_b16 a[76:77], v8 offset:24608
  ds_read_b64_tr_b16 a[78:79], v8 offset:26144
  ds_read_b64_tr_b16 a[80:81], v8 offset:24640
  ds_read_b64_tr_b16 a[82:83], v8 offset:26176
  ds_read_b64_tr_b16 a[84:85], v8 offset:36864
  ds_read_b64_tr_b16 a[86:87], v8 offset:38400
  ds_read_b64_tr_b16 a[88:89], v8 offset:36896
  ds_read_b64_tr_b16 a[90:91], v8 offset:38432
  ds_read_b64_tr_b16 a[92:93], v8 offset:36928
  ds_read_b64_tr_b16 a[94:95], v8 offset:38464
  s_waitcnt lgkmcnt(0)
  s_barrier
  s_mul_i32 s21, s20, 393216
  s_add_u32 s21, s21, 4718592
  s_add_u32 s21, s21, s44
  s_mul_i32 s22, s20, 12288
  s_add_u32 s22, s22, 49152
  s_add_u32 m0, s22, 0
  s_nop 0
  buffer_load_dwordx4 v4, s[12:15], s21 offen lds
  s_add_u32 m0, s22, 1024
  s_nop 0
  buffer_load_dwordx4 v5, s[12:15], s21 offen lds
  s_add_u32 m0, s22, 2048
  s_nop 0
  buffer_load_dwordx4 v6, s[12:15], s21 offen lds
  s_mul_i32 s21, s20, 393216
  s_add_u32 s21, s21, 4816896
  s_add_u32 s21, s21, s44
  s_mul_i32 s22, s20, 12288
  s_add_u32 s22, s22, 52224
  s_add_u32 m0, s22, 0
  s_nop 0
  buffer_load_dwordx4 v4, s[12:15], s21 offen lds
  s_add_u32 m0, s22, 1024
  s_nop 0
  buffer_load_dwordx4 v5, s[12:15], s21 offen lds
  s_add_u32 m0, s22, 2048
  s_nop 0
  buffer_load_dwordx4 v6, s[12:15], s21 offen lds
  s_mul_i32 s21, s20, 393216
  s_add_u32 s21, s21, 4915200
  s_add_u32 s21, s21, s44
  s_mul_i32 s22, s20, 12288
  s_add_u32 s22, s22, 55296
  s_add_u32 m0, s22, 0
  s_nop 0
  buffer_load_dwordx4 v4, s[12:15], s21 offen lds
  s_add_u32 m0, s22, 1024
  s_nop 0
  buffer_load_dwordx4 v5, s[12:15], s21 offen lds
  s_add_u32 m0, s22, 2048
  s_nop 0
  buffer_load_dwordx4 v6, s[12:15], s21 offen lds
  s_mul_i32 s21, s20, 393216
  s_add_u32 s21, s21, 5013504
  s_add_u32 s21, s21, s44
  s_mul_i32 s22, s20, 12288
  s_add_u32 s22, s22, 58368
  s_add_u32 m0, s22, 0
  s_nop 0
  buffer_load_dwordx4 v4, s[12:15], s21 offen lds
  s_add_u32 m0, s22, 1024
  s_nop 0
  buffer_load_dwordx4 v5, s[12:15], s21 offen lds
  s_add_u32 m0, s22, 2048
  s_nop 0
  buffer_load_dwordx4 v6, s[12:15], s21 offen lds
  v_mov_b32 v29, 76
  buffer_load_dword v29, v29, s[32:35], 0 offen sc1
  s_waitcnt vmcnt(12)
  s_barrier
  ds_read_b64_tr_b16 a[96:97], v7 offset:0
  ds_read_b64_tr_b16 a[98:99], v7 offset:1536
  ds_read_b64_tr_b16 a[100:101], v7 offset:32
  ds_read_b64_tr_b16 a[102:103], v7 offset:1568
  ds_read_b64_tr_b16 a[104:105], v7 offset:64
  ds_read_b64_tr_b16 a[106:107], v7 offset:1600
  ds_read_b64_tr_b16 a[108:109], v7 offset:12288
  ds_read_b64_tr_b16 a[110:111], v7 offset:13824
  ds_read_b64_tr_b16 a[112:113], v7 offset:12320
  ds_read_b64_tr_b16 a[114:115], v7 offset:13856
  ds_read_b64_tr_b16 a[116:117], v7 offset:12352
  ds_read_b64_tr_b16 a[118:119], v7 offset:13888
  ds_read_b64_tr_b16 a[120:121], v7 offset:24576
  ds_read_b64_tr_b16 a[122:123], v7 offset:26112
  ds_read_b64_tr_b16 a[124:125], v7 offset:24608
  ds_read_b64_tr_b16 a[126:127], v7 offset:26144
  ds_read_b64_tr_b16 a[128:129], v7 offset:24640
  ds_read_b64_tr_b16 a[130:131], v7 offset:26176
  ds_read_b64_tr_b16 a[132:133], v7 offset:36864
  ds_read_b64_tr_b16 a[134:135], v7 offset:38400
  ds_read_b64_tr_b16 a[136:137], v7 offset:36896
  ds_read_b64_tr_b16 a[138:139], v7 offset:38432
  ds_read_b64_tr_b16 a[140:141], v7 offset:36928
  ds_read_b64_tr_b16 a[142:143], v7 offset:38464
  s_waitcnt lgkmcnt(0)
  s_barrier
  s_mul_i32 s21, s20, 393216
  s_add_u32 s21, s21, 6291456
  s_add_u32 s21, s21, s44
  s_mul_i32 s22, s20, 12288
  s_add_u32 s22, s22, 0
  s_add_u32 m0, s22, 0
  s_nop 0
  buffer_load_dwordx4 v4, s[12:15], s21 offen lds
  s_add_u32 m0, s22, 1024
  s_nop 0
  buffer_load_dwordx4 v5, s[12:15], s21 offen lds
  s_add_u32 m0, s22, 2048
  s_nop 0
  buffer_load_dwordx4 v6, s[12:15], s21 offen lds
  s_mul_i32 s21, s20, 393216
  s_add_u32 s21, s21, 6389760
  s_add_u32 s21, s21, s44
  s_mul_i32 s22, s20, 12288
  s_add_u32 s22, s22, 3072
  s_add_u32 m0, s22, 0
  s_nop 0
  buffer_load_dwordx4 v4, s[12:15], s21 offen lds
  s_add_u32 m0, s22, 1024
  s_nop 0
  buffer_load_dwordx4 v5, s[12:15], s21 offen lds
  s_add_u32 m0, s22, 2048
  s_nop 0
  buffer_load_dwordx4 v6, s[12:15], s21 offen lds
  s_mul_i32 s21, s20, 393216
  s_add_u32 s21, s21, 6488064
  s_add_u32 s21, s21, s44
  s_mul_i32 s22, s20, 12288
  s_add_u32 s22, s22, 6144
  s_add_u32 m0, s22, 0
  s_nop 0
  buffer_load_dwordx4 v4, s[12:15], s21 offen lds
  s_add_u32 m0, s22, 1024
  s_nop 0
  buffer_load_dwordx4 v5, s[12:15], s21 offen lds
  s_add_u32 m0, s22, 2048
  s_nop 0
  buffer_load_dwordx4 v6, s[12:15], s21 offen lds
  s_mul_i32 s21, s20, 393216
  s_add_u32 s21, s21, 6586368
  s_add_u32 s21, s21, s44
  s_mul_i32 s22, s20, 12288
  s_add_u32 s22, s22, 9216
  s_add_u32 m0, s22, 0
  s_nop 0
  buffer_load_dwordx4 v4, s[12:15], s21 offen lds
  s_add_u32 m0, s22, 1024
  s_nop 0
  buffer_load_dwordx4 v5, s[12:15], s21 offen lds
  s_add_u32 m0, s22, 2048
  s_nop 0
  buffer_load_dwordx4 v6, s[12:15], s21 offen lds
  s_waitcnt vmcnt(12)
  s_barrier
  ds_read_b64_tr_b16 a[144:145], v8 offset:0
  ds_read_b64_tr_b16 a[146:147], v8 offset:1536
  ds_read_b64_tr_b16 a[148:149], v8 offset:32
  ds_read_b64_tr_b16 a[150:151], v8 offset:1568
  ds_read_b64_tr_b16 a[152:153], v8 offset:64
  ds_read_b64_tr_b16 a[154:155], v8 offset:1600
  ds_read_b64_tr_b16 a[156:157], v8 offset:12288
  ds_read_b64_tr_b16 a[158:159], v8 offset:13824
  ds_read_b64_tr_b16 a[160:161], v8 offset:12320
  ds_read_b64_tr_b16 a[162:163], v8 offset:13856
  ds_read_b64_tr_b16 a[164:165], v8 offset:12352
  ds_read_b64_tr_b16 a[166:167], v8 offset:13888
  ds_read_b64_tr_b16 a[168:169], v8 offset:24576
  ds_read_b64_tr_b16 a[170:171], v8 offset:26112
  ds_read_b64_tr_b16 a[172:173], v8 offset:24608
  ds_read_b64_tr_b16 a[174:175], v8 offset:26144
  ds_read_b64_tr_b16 a[176:177], v8 offset:24640
  ds_read_b64_tr_b16 a[178:179], v8 offset:26176
  ds_read_b64_tr_b16 a[180:181], v8 offset:36864
  ds_read_b64_tr_b16 a[182:183], v8 offset:38400
  ds_read_b64_tr_b16 a[184:185], v8 offset:36896
  ds_read_b64_tr_b16 a[186:187], v8 offset:38432
  ds_read_b64_tr_b16 a[188:189], v8 offset:36928
  ds_read_b64_tr_b16 a[190:191], v8 offset:38464
  s_waitcnt lgkmcnt(0)
  s_barrier
  s_waitcnt vmcnt(0)
  s_barrier
  ds_read_b64_tr_b16 a[192:193], v7 offset:0
  ds_read_b64_tr_b16 a[194:195], v7 offset:1536
  ds_read_b64_tr_b16 a[196:197], v7 offset:32
  ds_read_b64_tr_b16 a[198:199], v7 offset:1568
  ds_read_b64_tr_b16 a[200:201], v7 offset:64
  ds_read_b64_tr_b16 a[202:203], v7 offset:1600
  ds_read_b64_tr_b16 a[204:205], v7 offset:12288
  ds_read_b64_tr_b16 a[206:207], v7 offset:13824
  ds_read_b64_tr_b16 a[208:209], v7 offset:12320
  ds_read_b64_tr_b16 a[210:211], v7 offset:13856
  ds_read_b64_tr_b16 a[212:213], v7 offset:12352
  ds_read_b64_tr_b16 a[214:215], v7 offset:13888
  ds_read_b64_tr_b16 a[216:217], v7 offset:24576
  ds_read_b64_tr_b16 a[218:219], v7 offset:26112
  ds_read_b64_tr_b16 a[220:221], v7 offset:24608
  ds_read_b64_tr_b16 a[222:223], v7 offset:26144
  ds_read_b64_tr_b16 a[224:225], v7 offset:24640
  ds_read_b64_tr_b16 a[226:227], v7 offset:26176
  ds_read_b64_tr_b16 a[228:229], v7 offset:36864
  ds_read_b64_tr_b16 a[230:231], v7 offset:38400
  ds_read_b64_tr_b16 a[232:233], v7 offset:36896
  ds_read_b64_tr_b16 a[234:235], v7 offset:38432
  ds_read_b64_tr_b16 a[236:237], v7 offset:36928
  ds_read_b64_tr_b16 a[238:239], v7 offset:38464
  s_waitcnt lgkmcnt(0)
  s_barrier
  v_and_b32 v6, 7, v2
  v_add_u32 v4, 0, v3
  v_xor_b32 v4, v4, v6
  v_lshlrev_b32 v4, 4, v4
  v_lshl_add_u32 v14, v2, 7, v4
  v_add_u32 v16, 65536, v14
  v_add_u32 v18, 131072, v14
  v_add_u32 v4, 4, v3
  v_xor_b32 v4, v4, v6
  v_lshlrev_b32 v4, 4, v4
  v_lshl_add_u32 v15, v2, 7, v4
  v_add_u32 v17, 65536, v15
  v_add_u32 v19, 131072, v15
  v_lshlrev_b32 v26, 4, v1
  v_mov_b32 v28, 1
  v_mov_b32 v4, 0x40000000
  v_cmp_eq_u32 vcc, 0, v0
  s_nop 1
  v_cndmask_b32 v27, v4, 0, vcc
  s_mov_b32 s26, 4
  s_lshl_b32 s27, s42, 2
  s_add_u32 s27, s27, s20
  s_lshl_b32 s27, s27, 14
  s_lshl_b32 s21, s43, 13
  s_xor_b32 s27, s27, s21
  v_readfirstlane_b32 s100, v29
  s_cmp_lg_u32 s100, 0
  s_cbranch_scc1 kvz_193
  s_mov_b32 s21, 76
  v_mov_b32 v4, 0
  s_mov_b32 s101, 0
wf_194:
  buffer_load_dword v5, v4, s[32:35], s21 offen sc1
  s_add_u32 s101, s101, 1
  s_cmp_gt_u32 s101, 131072
  s_cbranch_scc1 main_end
  s_waitcnt vmcnt(0)
  v_readfirstlane_b32 s100, v5
  s_cmp_ge_u32 s100, 1
  s_cbranch_scc1 wf_195
  s_sleep 8
  s_branch wf_194
wf_195:
kvz_193:
  s_sub_u32 s80, s100, 1
  s_lshl_b32 s80, s80, 13
  s_xor_b32 s27, s27, s80
  s_lshl_b32 s60, s40, 7
  s_add_u32 s60, s60, 0
  s_mov_b32 s48, 0x40000000
  s_mov_b32 s61, 0x40000000
  s_waitcnt vmcnt(4)
  s_barrier
  ds_read_b128 v[160:163], v16 offset:32768
  ds_read_b128 v[164:167], v16 offset:34816
  ds_read_b128 v[168:171], v16 offset:36864
  ds_read_b128 v[172:175], v16 offset:38912
  s_waitcnt lgkmcnt(3)
  .p2align 3
kvm_196:
  v_mfma_f32_16x16x32_bf16 v[64:67], a[0:3], v[160:163], 0
  s_xor_b32 s29, s48, 0
  ds_read_b128 v[176:179], v17 offset:32768
  v_cvt_pk_bf16_f32 v204, v88, v89
  v_mfma_f32_16x16x32_bf16 v[68:71], a[4:7], v[160:163], 0
  v_cvt_pk_bf16_f32 v205, v90, v91
  v_cvt_pk_bf16_f32 v206, v92, v93
  v_mfma_f32_16x16x32_bf16 v[72:75], a[8:11], v[160:163], 0
  s_waitcnt lgkmcnt(3)
  v_cvt_pk_bf16_f32 v207, v94, v95
  v_cvt_pk_bf16_f32 v212, v96, v97
  v_mfma_f32_16x16x32_bf16 v[76:79], a[0:3], v[164:167], 0
  ds_read_b128 v[180:183], v17 offset:34816
  v_cvt_pk_bf16_f32 v213, v98, v99
  v_mfma_f32_16x16x32_bf16 v[80:83], a[4:7], v[164:167], 0
  v_cvt_pk_bf16_f32 v208, v100, v101
  v_cvt_pk_bf16_f32 v209, v102, v103
  v_mfma_f32_16x16x32_bf16 v[84:87], a[8:11], v[164:167], 0
  s_waitcnt lgkmcnt(3)
  v_cvt_pk_bf16_f32 v210, v104, v105
  v_cvt_pk_bf16_f32 v211, v106, v107
  v_mfma_f32_16x16x32_bf16 v[88:91], a[0:3], v[168:171], 0
  ds_read_b128 v[184:187], v17 offset:36864
  v_cvt_pk_bf16_f32 v214, v108, v109
  v_mfma_f32_16x16x32_bf16 v[92:95], a[4:7], v[168:171], 0
  s_add_u32 m0, s31, 122880
  v_cvt_pk_bf16_f32 v215, v110, v111
  buffer_store_dwordx4 v[192:195], v26, s[16:19], s29 offen offset:0 sc1
  v_mfma_f32_16x16x32_bf16 v[96:99], a[8:11], v[168:171], 0
  s_waitcnt lgkmcnt(3)
  buffer_load_dwordx4 v10, s[8:11], s30 offen lds
  v_mfma_f32_16x16x32_bf16 v[100:103], a[0:3], v[172:175], 0
  ds_read_b128 v[188:191], v17 offset:38912
  v_mfma_f32_16x16x32_bf16 v[104:107], a[4:7], v[172:175], 0
  v_mfma_f32_16x16x32_bf16 v[108:111], a[8:11], v[172:175], 0
  s_waitcnt lgkmcnt(3)
  v_mfma_f32_16x16x32_bf16 v[64:67], a[12:15], v[176:179], v[64:67]
  s_waitcnt vmcnt(4)
  s_barrier
  ds_read_b128 v[160:163], v16 offset:40960
  v_mfma_f32_16x16x32_bf16 v[68:71], a[16:19], v[176:179], v[68:71]
  s_add_u32 m0, s31, 123904
  v_mfma_f32_16x16x32_bf16 v[72:75], a[20:23], v[176:179], v[72:75]
  s_waitcnt lgkmcnt(3)
  buffer_load_dwordx4 v11, s[8:11], s30 offen lds
  buffer_store_dwordx4 v[196:199], v26, s[16:19], s29 offen offset:1024 sc1
  v_mfma_f32_16x16x32_bf16 v[76:79], a[12:15], v[180:183], v[76:79]
  s_add_u32 s30, s30, 128
  ds_read_b128 v[164:167], v16 offset:43008
  v_mfma_f32_16x16x32_bf16 v[80:83], a[16:19], v[180:183], v[80:83]
  v_mfma_f32_16x16x32_bf16 v[84:87], a[20:23], v[180:183], v[84:87]
  s_waitcnt lgkmcnt(3)
  v_mfma_f32_16x16x32_bf16 v[88:91], a[12:15], v[184:187], v[88:91]
  ds_read_b128 v[168:171], v16 offset:45056
  v_mfma_f32_16x16x32_bf16 v[92:95], a[16:19], v[184:187], v[92:95]
  v_mfma_f32_16x16x32_bf16 v[96:99], a[20:23], v[184:187], v[96:99]
  s_waitcnt lgkmcnt(3)
  v_mfma_f32_16x16x32_bf16 v[100:103], a[12:15], v[188:191], v[100:103]
  ds_read_b128 v[172:175], v16 offset:47104
  buffer_store_dwordx4 v[200:203], v26, s[16:19], s29 offen offset:2048 sc1
  v_mfma_f32_16x16x32_bf16 v[104:107], a[16:19], v[188:191], v[104:107]
  v_mfma_f32_16x16x32_bf16 v[108:111], a[20:23], v[188:191], v[108:111]
  s_waitcnt lgkmcnt(3)
  v_mfma_f32_16x16x32_bf16 v[64:67], a[24:27], v[160:163], v[64:67]
  ds_read_b128 v[176:179], v17 offset:40960
  v_mfma_f32_16x16x32_bf16 v[68:71], a[28:31], v[160:163], v[68:71]
  s_add_u32 m0, s31, 131072
  v_mfma_f32_16x16x32_bf16 v[72:75], a[32:35], v[160:163], v[72:75]
  s_waitcnt lgkmcnt(3)
  buffer_load_dwordx4 v10, s[8:11], s30 offen lds
  v_mfma_f32_16x16x32_bf16 v[76:79], a[24:27], v[164:167], v[76:79]
  s_xor_b32 s29, s48, 2105344
  ds_read_b128 v[180:183], v17 offset:43008
  v_mfma_f32_16x16x32_bf16 v[80:83], a[28:31], v[164:167], v[80:83]
  buffer_store_dwordx4 v[204:207], v26, s[16:19], s29 offen offset:0 sc1
  v_mfma_f32_16x16x32_bf16 v[84:87], a[32:35], v[164:167], v[84:87]
  s_waitcnt lgkmcnt(3)
  v_mfma_f32_16x16x32_bf16 v[88:91], a[24:27], v[168:171], v[88:91]
  ds_read_b128 v[184:187], v17 offset:45056
  v_mfma_f32_16x16x32_bf16 v[92:95], a[28:31], v[168:171], v[92:95]
  s_add_u32 m0, s31, 132096
  v_mfma_f32_16x16x32_bf16 v[96:99], a[32:35], v[168:171], v[96:99]
  s_waitcnt lgkmcnt(3)
  buffer_load_dwordx4 v11, s[8:11], s30 offen lds
  v_mfma_f32_16x16x32_bf16 v[100:103], a[24:27], v[172:175], v[100:103]
  s_add_u32 s30, s30, 128
  ds_read_b128 v[188:191], v17 offset:47104
  v_mfma_f32_16x16x32_bf16 v[104:107], a[28:31], v[172:175], v[104:107]
  v_mfma_f32_16x16x32_bf16 v[108:111], a[32:35], v[172:175], v[108:111]
  s_waitcnt lgkmcnt(3)
  buffer_store_dwordx4 v[208:211], v26, s[16:19], s29 offen offset:1024 sc1
  v_mfma_f32_16x16x32_bf16 v[64:67], a[36:39], v[176:179], v[64:67]
  s_waitcnt vmcnt(9)
  s_barrier
  ds_read_b128 v[160:163], v16 offset:49152
  v_mfma_f32_16x16x32_bf16 v[68:71], a[40:43], v[176:179], v[68:71]
  v_mfma_f32_16x16x32_bf16 v[72:75], a[44:47], v[176:179], v[72:75]
  s_waitcnt lgkmcnt(3)
  v_mfma_f32_16x16x32_bf16 v[76:79], a[36:39], v[180:183], v[76:79]
  ds_read_b128 v[164:167], v16 offset:51200
  v_mfma_f32_16x16x32_bf16 v[80:83], a[40:43], v[180:183], v[80:83]
  v_mfma_f32_16x16x32_bf16 v[84:87], a[44:47], v[180:183], v[84:87]
  s_waitcnt lgkmcnt(3)
  v_mfma_f32_16x16x32_bf16 v[88:91], a[36:39], v[184:187], v[88:91]
  ds_read_b128 v[168:171], v16 offset:53248
  buffer_store_dwordx4 v[212:215], v26, s[16:19], s29 offen offset:2048 sc1
  v_mfma_f32_16x16x32_bf16 v[92:95], a[40:43], v[184:187], v[92:95]
  v_mfma_f32_16x16x32_bf16 v[96:99], a[44:47], v[184:187], v[96:99]
  s_waitcnt lgkmcnt(3)
  v_mfma_f32_16x16x32_bf16 v[100:103], a[36:39], v[188:191], v[100:103]
  ds_read_b128 v[172:175], v16 offset:55296
  v_mfma_f32_16x16x32_bf16 v[104:107], a[40:43], v[188:191], v[104:107]
  v_mfma_f32_16x16x32_bf16 v[108:111], a[44:47], v[188:191], v[108:111]
  s_waitcnt lgkmcnt(3)
  v_mfma_f32_16x16x32_bf16 v[64:67], a[48:51], v[160:163], v[64:67]
  ds_read_b128 v[176:179], v17 offset:49152
  v_mfma_f32_16x16x32_bf16 v[68:71], a[52:55], v[160:163], v[68:71]
  s_add_u32 m0, s31, 98304
  v_mfma_f32_16x16x32_bf16 v[72:75], a[56:59], v[160:163], v[72:75]
  s_waitcnt lgkmcnt(3)
  buffer_load_dwordx4 v10, s[8:11], s30 offen lds
  v_mfma_f32_16x16x32_bf16 v[76:79], a[48:51], v[164:167], v[76:79]
  ds_read_b128 v[180:183], v17 offset:51200
  v_mfma_f32_16x16x32_bf16 v[80:83], a[52:55], v[164:167], v[80:83]
  v_mfma_f32_16x16x32_bf16 v[84:87], a[56:59], v[164:167], v[84:87]
  s_waitcnt lgkmcnt(3)
  v_mfma_f32_16x16x32_bf16 v[88:91], a[48:51], v[168:171], v[88:91]
  ds_read_b128 v[184:187], v17 offset:53248
  v_mfma_f32_16x16x32_bf16 v[92:95], a[52:55], v[168:171], v[92:95]
  s_add_u32 m0, s31, 99328
  v_mfma_f32_16x16x32_bf16 v[96:99], a[56:59], v[168:171], v[96:99]
  s_waitcnt lgkmcnt(3)
  buffer_load_dwordx4 v11, s[8:11], s30 offen lds
  v_mfma_f32_16x16x32_bf16 v[100:103], a[48:51], v[172:175], v[100:103]
  s_add_u32 s30, s30, 128
  ds_read_b128 v[188:191], v17 offset:55296
  v_mfma_f32_16x16x32_bf16 v[104:107], a[52:55], v[172:175], v[104:107]
  v_mfma_f32_16x16x32_bf16 v[108:111], a[56:59], v[172:175], v[108:111]
  s_waitcnt lgkmcnt(3)
  v_mfma_f32_16x16x32_bf16 v[64:67], a[60:63], v[176:179], v[64:67]
  s_waitcnt vmcnt(9)
  s_barrier
  ds_read_b128 v[160:163], v16 offset:57344
  v_mfma_f32_16x16x32_bf16 v[68:71], a[64:67], v[176:179], v[68:71]
  v_mfma_f32_16x16x32_bf16 v[72:75], a[68:71], v[176:179], v[72:75]
  s_waitcnt lgkmcnt(3)
  v_mfma_f32_16x16x32_bf16 v[76:79], a[60:63], v[180:183], v[76:79]
  ds_read_b128 v[164:167], v16 offset:59392
  v_mfma_f32_16x16x32_bf16 v[80:83], a[64:67], v[180:183], v[80:83]
  v_mfma_f32_16x16x32_bf16 v[84:87], a[68:71], v[180:183], v[84:87]
  s_waitcnt lgkmcnt(3)
  v_mfma_f32_16x16x32_bf16 v[88:91], a[60:63], v[184:187], v[88:91]
  ds_read_b128 v[168:171], v16 offset:61440
  v_mfma_f32_16x16x32_bf16 v[92:95], a[64:67], v[184:187], v[92:95]
  v_mfma_f32_16x16x32_bf16 v[96:99], a[68:71], v[184:187], v[96:99]
  s_waitcnt lgkmcnt(3)
  v_mfma_f32_16x16x32_bf16 v[100:103], a[60:63], v[188:191], v[100:103]
  ds_read_b128 v[172:175], v16 offset:63488
  v_mfma_f32_16x16x32_bf16 v[104:107], a[64:67], v[188:191], v[104:107]
  v_mfma_f32_16x16x32_bf16 v[108:111], a[68:71], v[188:191], v[108:111]
  s_waitcnt lgkmcnt(3)
  v_mfma_f32_16x16x32_bf16 v[64:67], a[72:75], v[160:163], v[64:67]
  ds_read_b128 v[176:179], v17 offset:57344
  v_mfma_f32_16x16x32_bf16 v[68:71], a[76:79], v[160:163], v[68:71]
  s_add_u32 m0, s31, 106496
  v_mfma_f32_16x16x32_bf16 v[72:75], a[80:83], v[160:163], v[72:75]
  s_waitcnt lgkmcnt(3)
  buffer_load_dwordx4 v10, s[8:11], s30 offen lds
  v_mfma_f32_16x16x32_bf16 v[76:79], a[72:75], v[164:167], v[76:79]
  ds_read_b128 v[180:183], v17 offset:59392
  v_mfma_f32_16x16x32_bf16 v[80:83], a[76:79], v[164:167], v[80:83]
  v_mfma_f32_16x16x32_bf16 v[84:87], a[80:83], v[164:167], v[84:87]
  s_waitcnt lgkmcnt(3)
  v_mfma_f32_16x16x32_bf16 v[88:91], a[72:75], v[168:171], v[88:91]
  ds_read_b128 v[184:187], v17 offset:61440
  v_mfma_f32_16x16x32_bf16 v[92:95], a[76:79], v[168:171], v[92:95]
  s_add_u32 m0, s31, 107520
  v_mfma_f32_16x16x32_bf16 v[96:99], a[80:83], v[168:171], v[96:99]
  s_waitcnt lgkmcnt(3)
  buffer_load_dwordx4 v11, s[8:11], s30 offen lds
  v_mfma_f32_16x16x32_bf16 v[100:103], a[72:75], v[172:175], v[100:103]
  s_add_u32 s30, s30, 128
  ds_read_b128 v[188:191], v17 offset:63488
  v_mfma_f32_16x16x32_bf16 v[104:107], a[76:79], v[172:175], v[104:107]
  v_mfma_f32_16x16x32_bf16 v[108:111], a[80:83], v[172:175], v[108:111]
  s_waitcnt lgkmcnt(3)
  v_mfma_f32_16x16x32_bf16 v[64:67], a[84:87], v[176:179], v[64:67]
  s_waitcnt vmcnt(4)
  s_barrier
  ds_read_b128 v[160:163], v18 offset:0
  v_mfma_f32_16x16x32_bf16 v[68:71], a[88:91], v[176:179], v[68:71]
  buffer_atomic_add v28, v27, s[72:75], s61 offen sc1
  v_mfma_f32_16x16x32_bf16 v[72:75], a[92:95], v[176:179], v[72:75]
  s_waitcnt lgkmcnt(3)
  s_mov_b32 s48, s27
  s_add_u32 s27, s27, 4194304
  v_mfma_f32_16x16x32_bf16 v[76:79], a[84:87], v[180:183], v[76:79]
  s_mov_b32 s61, s60
  ds_read_b128 v[164:167], v18 offset:2048
  s_add_u32 s60, s60, 1024
  v_mfma_f32_16x16x32_bf16 v[80:83], a[88:91], v[180:183], v[80:83]
  v_mfma_f32_16x16x32_bf16 v[84:87], a[92:95], v[180:183], v[84:87]
  s_waitcnt lgkmcnt(3)
  v_mfma_f32_16x16x32_bf16 v[88:91], a[84:87], v[184:187], v[88:91]
  ds_read_b128 v[168:171], v18 offset:4096
  v_mfma_f32_16x16x32_bf16 v[92:95], a[88:91], v[184:187], v[92:95]
  v_mfma_f32_16x16x32_bf16 v[96:99], a[92:95], v[184:187], v[96:99]
  s_waitcnt lgkmcnt(3)
  v_mfma_f32_16x16x32_bf16 v[100:103], a[84:87], v[188:191], v[100:103]
  ds_read_b128 v[172:175], v18 offset:6144
  v_mfma_f32_16x16x32_bf16 v[104:107], a[88:91], v[188:191], v[104:107]
  v_mfma_f32_16x16x32_bf16 v[108:111], a[92:95], v[188:191], v[108:111]
  s_waitcnt lgkmcnt(3)
  v_mfma_f32_16x16x32_bf16 v[64:67], a[96:99], v[160:163], v[64:67]
  ds_read_b128 v[176:179], v19 offset:0
  v_mfma_f32_16x16x32_bf16 v[68:71], a[100:103], v[160:163], v[68:71]
  s_add_u32 m0, s31, 114688
  v_mfma_f32_16x16x32_bf16 v[72:75], a[104:107], v[160:163], v[72:75]
  s_waitcnt lgkmcnt(3)
  buffer_load_dwordx4 v10, s[8:11], s30 offen lds
  v_mfma_f32_16x16x32_bf16 v[76:79], a[96:99], v[164:167], v[76:79]
  ds_read_b128 v[180:183], v19 offset:2048
  v_mfma_f32_16x16x32_bf16 v[80:83], a[100:103], v[164:167], v[80:83]
  v_mfma_f32_16x16x32_bf16 v[84:87], a[104:107], v[164:167], v[84:87]
  s_waitcnt lgkmcnt(3)
  v_mfma_f32_16x16x32_bf16 v[88:91], a[96:99], v[168:171], v[88:91]
  ds_read_b128 v[184:187], v19 offset:4096
  v_mfma_f32_16x16x32_bf16 v[92:95], a[100:103], v[168:171], v[92:95]
  s_add_u32 m0, s31, 115712
  v_mfma_f32_16x16x32_bf16 v[96:99], a[104:107], v[168:171], v[96:99]
  s_waitcnt lgkmcnt(3)
  buffer_load_dwordx4 v11, s[8:11], s30 offen lds
  v_mfma_f32_16x16x32_bf16 v[100:103], a[96:99], v[172:175], v[100:103]
  s_add_u32 s30, s30, 128
  ds_read_b128 v[188:191], v19 offset:6144
  v_mfma_f32_16x16x32_bf16 v[104:107], a[100:103], v[172:175], v[104:107]
  v_mfma_f32_16x16x32_bf16 v[108:111], a[104:107], v[172:175], v[108:111]
  s_waitcnt lgkmcnt(3)
  v_mfma_f32_16x16x32_bf16 v[64:67], a[108:111], v[176:179], v[64:67]
  s_waitcnt vmcnt(5)
  s_barrier
  ds_read_b128 v[160:163], v16 offset:32768
  v_mfma_f32_16x16x32_bf16 v[68:71], a[112:115], v[176:179], v[68:71]
  v_mfma_f32_16x16x32_bf16 v[72:75], a[116:119], v[176:179], v[72:75]
  s_waitcnt lgkmcnt(3)
  v_mfma_f32_16x16x32_bf16 v[76:79], a[108:111], v[180:183], v[76:79]
  ds_read_b128 v[164:167], v16 offset:34816
  v_mfma_f32_16x16x32_bf16 v[80:83], a[112:115], v[180:183], v[80:83]
  v_mfma_f32_16x16x32_bf16 v[84:87], a[116:119], v[180:183], v[84:87]
  s_waitcnt lgkmcnt(3)
  v_mfma_f32_16x16x32_bf16 v[88:91], a[108:111], v[184:187], v[88:91]
  ds_read_b128 v[168:171], v16 offset:36864
  v_mfma_f32_16x16x32_bf16 v[92:95], a[112:115], v[184:187], v[92:95]
  v_mfma_f32_16x16x32_bf16 v[96:99], a[116:119], v[184:187], v[96:99]
  s_waitcnt lgkmcnt(3)
  v_mfma_f32_16x16x32_bf16 v[100:103], a[108:111], v[188:191], v[100:103]
  ds_read_b128 v[172:175], v16 offset:38912
  v_mfma_f32_16x16x32_bf16 v[104:107], a[112:115], v[188:191], v[104:107]
  v_mfma_f32_16x16x32_bf16 v[108:111], a[116:119], v[188:191], v[108:111]
  s_waitcnt lgkmcnt(3)
  v_mfma_f32_16x16x32_bf16 v[64:67], a[120:123], v[160:163], v[64:67]
  ds_read_b128 v[176:179], v17 offset:32768
  v_mfma_f32_16x16x32_bf16 v[68:71], a[124:127], v[160:163], v[68:71]
  s_add_u32 m0, s31, 122880
  v_mfma_f32_16x16x32_bf16 v[72:75], a[128:131], v[160:163], v[72:75]
  s_waitcnt lgkmcnt(3)
  buffer_load_dwordx4 v10, s[8:11], s30 offen lds
  v_mfma_f32_16x16x32_bf16 v[76:79], a[120:123], v[164:167], v[76:79]
  ds_read_b128 v[180:183], v17 offset:34816
  v_mfma_f32_16x16x32_bf16 v[80:83], a[124:127], v[164:167], v[80:83]
  v_mfma_f32_16x16x32_bf16 v[84:87], a[128:131], v[164:167], v[84:87]
  s_waitcnt lgkmcnt(3)
  v_mfma_f32_16x16x32_bf16 v[88:91], a[120:123], v[168:171], v[88:91]
  ds_read_b128 v[184:187], v17 offset:36864
  v_mfma_f32_16x16x32_bf16 v[92:95], a[124:127], v[168:171], v[92:95]
  s_add_u32 m0, s31, 123904
  v_mfma_f32_16x16x32_bf16 v[96:99], a[128:131], v[168:171], v[96:99]
  s_waitcnt lgkmcnt(3)
  buffer_load_dwordx4 v11, s[8:11], s30 offen lds
  v_mfma_f32_16x16x32_bf16 v[100:103], a[120:123], v[172:175], v[100:103]
  s_add_u32 s30, s30, 128
  ds_read_b128 v[188:191], v17 offset:38912
  v_mfma_f32_16x16x32_bf16 v[104:107], a[124:127], v[172:175], v[104:107]
  v_mfma_f32_16x16x32_bf16 v[108:111], a[128:131], v[172:175], v[108:111]
  s_waitcnt lgkmcnt(3)
  v_mfma_f32_16x16x32_bf16 v[64:67], a[132:135], v[176:179], v[64:67]
  s_waitcnt vmcnt(5)
  s_barrier
  ds_read_b128 v[160:163], v16 offset:40960
  v_mfma_f32_16x16x32_bf16 v[68:71], a[136:139], v[176:179], v[68:71]
  v_mfma_f32_16x16x32_bf16 v[72:75], a[140:143], v[176:179], v[72:75]
  s_waitcnt lgkmcnt(3)
  v_mfma_f32_16x16x32_bf16 v[76:79], a[132:135], v[180:183], v[76:79]
  ds_read_b128 v[164:167], v16 offset:43008
  v_mfma_f32_16x16x32_bf16 v[80:83], a[136:139], v[180:183], v[80:83]
  v_mfma_f32_16x16x32_bf16 v[84:87], a[140:143], v[180:183], v[84:87]
  s_waitcnt lgkmcnt(3)
  v_mfma_f32_16x16x32_bf16 v[88:91], a[132:135], v[184:187], v[88:91]
  ds_read_b128 v[168:171], v16 offset:45056
  v_mfma_f32_16x16x32_bf16 v[92:95], a[136:139], v[184:187], v[92:95]
  v_mfma_f32_16x16x32_bf16 v[96:99], a[140:143], v[184:187], v[96:99]
  s_waitcnt lgkmcnt(3)
  v_mfma_f32_16x16x32_bf16 v[100:103], a[132:135], v[188:191], v[100:103]
  ds_read_b128 v[172:175], v16 offset:47104
  v_mfma_f32_16x16x32_bf16 v[104:107], a[136:139], v[188:191], v[104:107]
  v_mfma_f32_16x16x32_bf16 v[108:111], a[140:143], v[188:191], v[108:111]
  s_waitcnt lgkmcnt(3)
  v_mfma_f32_16x16x32_bf16 v[64:67], a[144:147], v[160:163], v[64:67]
  ds_read_b128 v[176:179], v17 offset:40960
  v_mfma_f32_16x16x32_bf16 v[68:71], a[148:151], v[160:163], v[68:71]
  s_add_u32 m0, s31, 131072
  v_mfma_f32_16x16x32_bf16 v[72:75], a[152:155], v[160:163], v[72:75]
  s_waitcnt lgkmcnt(3)
  buffer_load_dwordx4 v10, s[8:11], s30 offen lds
  v_mfma_f32_16x16x32_bf16 v[76:79], a[144:147], v[164:167], v[76:79]
  ds_read_b128 v[180:183], v17 offset:43008
  v_mfma_f32_16x16x32_bf16 v[80:83], a[148:151], v[164:167], v[80:83]
  v_mfma_f32_16x16x32_bf16 v[84:87], a[152:155], v[164:167], v[84:87]
  s_waitcnt lgkmcnt(3)
  v_mfma_f32_16x16x32_bf16 v[88:91], a[144:147], v[168:171], v[88:91]
  ds_read_b128 v[184:187], v17 offset:45056
  v_mfma_f32_16x16x32_bf16 v[92:95], a[148:151], v[168:171], v[92:95]
  s_add_u32 m0, s31, 132096
  v_mfma_f32_16x16x32_bf16 v[96:99], a[152:155], v[168:171], v[96:99]
  s_waitcnt lgkmcnt(3)
  buffer_load_dwordx4 v11, s[8:11], s30 offen lds
  v_mfma_f32_16x16x32_bf16 v[100:103], a[144:147], v[172:175], v[100:103]
  s_add_u32 s30, s30, s25
  ds_read_b128 v[188:191], v17 offset:47104
  v_mfma_f32_16x16x32_bf16 v[104:107], a[148:151], v[172:175], v[104:107]
  v_mfma_f32_16x16x32_bf16 v[108:111], a[152:155], v[172:175], v[108:111]
  s_waitcnt lgkmcnt(3)
  v_mfma_f32_16x16x32_bf16 v[64:67], a[156:159], v[176:179], v[64:67]
  s_waitcnt vmcnt(4)
  s_barrier
  ds_read_b128 v[160:163], v16 offset:49152
  v_mfma_f32_16x16x32_bf16 v[68:71], a[160:163], v[176:179], v[68:71]
  v_mfma_f32_16x16x32_bf16 v[72:75], a[164:167], v[176:179], v[72:75]
  s_waitcnt lgkmcnt(3)
  v_mfma_f32_16x16x32_bf16 v[76:79], a[156:159], v[180:183], v[76:79]
  ds_read_b128 v[164:167], v16 offset:51200
  v_mfma_f32_16x16x32_bf16 v[80:83], a[160:163], v[180:183], v[80:83]
  v_mfma_f32_16x16x32_bf16 v[84:87], a[164:167], v[180:183], v[84:87]
  s_waitcnt lgkmcnt(3)
  v_mfma_f32_16x16x32_bf16 v[88:91], a[156:159], v[184:187], v[88:91]
  ds_read_b128 v[168:171], v16 offset:53248
  v_mfma_f32_16x16x32_bf16 v[92:95], a[160:163], v[184:187], v[92:95]
  v_mfma_f32_16x16x32_bf16 v[96:99], a[164:167], v[184:187], v[96:99]
  s_waitcnt lgkmcnt(3)
  v_mfma_f32_16x16x32_bf16 v[100:103], a[156:159], v[188:191], v[100:103]
  ds_read_b128 v[172:175], v16 offset:55296
  v_mfma_f32_16x16x32_bf16 v[104:107], a[160:163], v[188:191], v[104:107]
  v_mfma_f32_16x16x32_bf16 v[108:111], a[164:167], v[188:191], v[108:111]
  s_waitcnt lgkmcnt(3)
  v_mfma_f32_16x16x32_bf16 v[64:67], a[168:171], v[160:163], v[64:67]
  ds_read_b128 v[176:179], v17 offset:49152
  v_mfma_f32_16x16x32_bf16 v[68:71], a[172:175], v[160:163], v[68:71]
  s_add_u32 m0, s31, 98304
  v_mfma_f32_16x16x32_bf16 v[72:75], a[176:179], v[160:163], v[72:75]
  s_waitcnt lgkmcnt(3)
  buffer_load_dwordx4 v10, s[8:11], s30 offen lds
  v_mfma_f32_16x16x32_bf16 v[76:79], a[168:171], v[164:167], v[76:79]
  ds_read_b128 v[180:183], v17 offset:51200
  v_mfma_f32_16x16x32_bf16 v[80:83], a[172:175], v[164:167], v[80:83]
  v_mfma_f32_16x16x32_bf16 v[84:87], a[176:179], v[164:167], v[84:87]
  s_waitcnt lgkmcnt(3)
  v_mfma_f32_16x16x32_bf16 v[88:91], a[168:171], v[168:171], v[88:91]
  ds_read_b128 v[184:187], v17 offset:53248
  v_mfma_f32_16x16x32_bf16 v[92:95], a[172:175], v[168:171], v[92:95]
  s_add_u32 m0, s31, 99328
  v_mfma_f32_16x16x32_bf16 v[96:99], a[176:179], v[168:171], v[96:99]
  s_waitcnt lgkmcnt(3)
  buffer_load_dwordx4 v11, s[8:11], s30 offen lds
  v_mfma_f32_16x16x32_bf16 v[100:103], a[168:171], v[172:175], v[100:103]
  s_add_u32 s30, s30, 128
  ds_read_b128 v[188:191], v17 offset:55296
  v_mfma_f32_16x16x32_bf16 v[104:107], a[172:175], v[172:175], v[104:107]
  v_mfma_f32_16x16x32_bf16 v[108:111], a[176:179], v[172:175], v[108:111]
  s_waitcnt lgkmcnt(3)
  v_mfma_f32_16x16x32_bf16 v[64:67], a[180:183], v[176:179], v[64:67]
  s_waitcnt vmcnt(4)
  s_barrier
  ds_read_b128 v[160:163], v16 offset:57344
  v_mfma_f32_16x16x32_bf16 v[68:71], a[184:187], v[176:179], v[68:71]
  v_mfma_f32_16x16x32_bf16 v[72:75], a[188:191], v[176:179], v[72:75]
  s_waitcnt lgkmcnt(3)
  v_mfma_f32_16x16x32_bf16 v[76:79], a[180:183], v[180:183], v[76:79]
  ds_read_b128 v[164:167], v16 offset:59392
  v_mfma_f32_16x16x32_bf16 v[80:83], a[184:187], v[180:183], v[80:83]
  v_mfma_f32_16x16x32_bf16 v[84:87], a[188:191], v[180:183], v[84:87]
  s_waitcnt lgkmcnt(3)
  v_mfma_f32_16x16x32_bf16 v[88:91], a[180:183], v[184:187], v[88:91]
  ds_read_b128 v[168:171], v16 offset:61440
  v_mfma_f32_16x16x32_bf16 v[92:95], a[184:187], v[184:187], v[92:95]
  v_mfma_f32_16x16x32_bf16 v[96:99], a[188:191], v[184:187], v[96:99]
  s_waitcnt lgkmcnt(3)
  v_mfma_f32_16x16x32_bf16 v[100:103], a[180:183], v[188:191], v[100:103]
  ds_read_b128 v[172:175], v16 offset:63488
  v_mfma_f32_16x16x32_bf16 v[104:107], a[184:187], v[188:191], v[104:107]
  v_mfma_f32_16x16x32_bf16 v[108:111], a[188:191], v[188:191], v[108:111]
  s_waitcnt lgkmcnt(3)
  v_mfma_f32_16x16x32_bf16 v[64:67], a[192:195], v[160:163], v[64:67]
  ds_read_b128 v[176:179], v17 offset:57344
  v_mfma_f32_16x16x32_bf16 v[68:71], a[196:199], v[160:163], v[68:71]
  s_add_u32 m0, s31, 106496
  v_mfma_f32_16x16x32_bf16 v[72:75], a[200:203], v[160:163], v[72:75]
  s_waitcnt lgkmcnt(3)
  buffer_load_dwordx4 v10, s[8:11], s30 offen lds
  v_mfma_f32_16x16x32_bf16 v[76:79], a[192:195], v[164:167], v[76:79]
  ds_read_b128 v[180:183], v17 offset:59392
  v_mfma_f32_16x16x32_bf16 v[80:83], a[196:199], v[164:167], v[80:83]
  v_mfma_f32_16x16x32_bf16 v[84:87], a[200:203], v[164:167], v[84:87]
  s_waitcnt lgkmcnt(3)
  v_mfma_f32_16x16x32_bf16 v[88:91], a[192:195], v[168:171], v[88:91]
  ds_read_b128 v[184:187], v17 offset:61440
  v_mfma_f32_16x16x32_bf16 v[92:95], a[196:199], v[168:171], v[92:95]
  s_add_u32 m0, s31, 107520
  v_mfma_f32_16x16x32_bf16 v[96:99], a[200:203], v[168:171], v[96:99]
  s_waitcnt lgkmcnt(3)
  buffer_load_dwordx4 v11, s[8:11], s30 offen lds
  v_mfma_f32_16x16x32_bf16 v[100:103], a[192:195], v[172:175], v[100:103]
  s_add_u32 s30, s30, 128
  ds_read_b128 v[188:191], v17 offset:63488
  v_mfma_f32_16x16x32_bf16 v[104:107], a[196:199], v[172:175], v[104:107]
  v_mfma_f32_16x16x32_bf16 v[108:111], a[200:203], v[172:175], v[108:111]
  s_waitcnt lgkmcnt(3)
  v_mfma_f32_16x16x32_bf16 v[64:67], a[204:207], v[176:179], v[64:67]
  s_waitcnt vmcnt(4)
  s_barrier
  ds_read_b128 v[160:163], v18 offset:0
  v_mfma_f32_16x16x32_bf16 v[68:71], a[208:211], v[176:179], v[68:71]
  v_mfma_f32_16x16x32_bf16 v[72:75], a[212:215], v[176:179], v[72:75]
  s_waitcnt lgkmcnt(3)
  v_mfma_f32_16x16x32_bf16 v[76:79], a[204:207], v[180:183], v[76:79]
  ds_read_b128 v[164:167], v18 offset:2048
  v_mfma_f32_16x16x32_bf16 v[80:83], a[208:211], v[180:183], v[80:83]
  v_mfma_f32_16x16x32_bf16 v[84:87], a[212:215], v[180:183], v[84:87]
  s_waitcnt lgkmcnt(3)
  v_mfma_f32_16x16x32_bf16 v[88:91], a[204:207], v[184:187], v[88:91]
  ds_read_b128 v[168:171], v18 offset:4096
  v_mfma_f32_16x16x32_bf16 v[92:95], a[208:211], v[184:187], v[92:95]
  v_mfma_f32_16x16x32_bf16 v[96:99], a[212:215], v[184:187], v[96:99]
  s_waitcnt lgkmcnt(3)
  v_mfma_f32_16x16x32_bf16 v[100:103], a[204:207], v[188:191], v[100:103]
  ds_read_b128 v[172:175], v18 offset:6144
  v_mfma_f32_16x16x32_bf16 v[104:107], a[208:211], v[188:191], v[104:107]
  v_mfma_f32_16x16x32_bf16 v[108:111], a[212:215], v[188:191], v[108:111]
  s_waitcnt lgkmcnt(3)
  v_mfma_f32_16x16x32_bf16 v[64:67], a[216:219], v[160:163], v[64:67]
  ds_read_b128 v[176:179], v19 offset:0
  v_mfma_f32_16x16x32_bf16 v[68:71], a[220:223], v[160:163], v[68:71]
  s_add_u32 m0, s31, 114688
  v_mfma_f32_16x16x32_bf16 v[72:75], a[224:227], v[160:163], v[72:75]
  s_waitcnt lgkmcnt(3)
  buffer_load_dwordx4 v10, s[8:11], s30 offen lds
  v_mfma_f32_16x16x32_bf16 v[76:79], a[216:219], v[164:167], v[76:79]
  ds_read_b128 v[180:183], v19 offset:2048
  v_mfma_f32_16x16x32_bf16 v[80:83], a[220:223], v[164:167], v[80:83]
  v_mfma_f32_16x16x32_bf16 v[84:87], a[224:227], v[164:167], v[84:87]
  s_waitcnt lgkmcnt(3)
  v_mfma_f32_16x16x32_bf16 v[88:91], a[216:219], v[168:171], v[88:91]
  ds_read_b128 v[184:187], v19 offset:4096
  v_mfma_f32_16x16x32_bf16 v[92:95], a[220:223], v[168:171], v[92:95]
  s_add_u32 m0, s31, 115712
  v_mfma_f32_16x16x32_bf16 v[96:99], a[224:227], v[168:171], v[96:99]
  s_waitcnt lgkmcnt(3)
  buffer_load_dwordx4 v11, s[8:11], s30 offen lds
  v_mfma_f32_16x16x32_bf16 v[100:103], a[216:219], v[172:175], v[100:103]
  s_add_u32 s30, s30, 128
  ds_read_b128 v[188:191], v19 offset:6144
  v_mfma_f32_16x16x32_bf16 v[104:107], a[220:223], v[172:175], v[104:107]
  v_mfma_f32_16x16x32_bf16 v[108:111], a[224:227], v[172:175], v[108:111]
  s_waitcnt lgkmcnt(3)
  v_mfma_f32_16x16x32_bf16 v[64:67], a[228:231], v[176:179], v[64:67]
  s_waitcnt vmcnt(4)
  s_barrier
  ds_read_b128 v[160:163], v16 offset:32768
  v_mfma_f32_16x16x32_bf16 v[68:71], a[232:235], v[176:179], v[68:71]
  v_mfma_f32_16x16x32_bf16 v[72:75], a[236:239], v[176:179], v[72:75]
  s_waitcnt lgkmcnt(3)
  v_mfma_f32_16x16x32_bf16 v[76:79], a[228:231], v[180:183], v[76:79]
  ds_read_b128 v[164:167], v16 offset:34816
  v_cvt_pk_bf16_f32 v192, v64, v65
  v_mfma_f32_16x16x32_bf16 v[80:83], a[232:235], v[180:183], v[80:83]
  v_cvt_pk_bf16_f32 v193, v66, v67
  v_cvt_pk_bf16_f32 v194, v68, v69
  v_mfma_f32_16x16x32_bf16 v[84:87], a[236:239], v[180:183], v[84:87]
  s_waitcnt lgkmcnt(3)
  v_cvt_pk_bf16_f32 v195, v70, v71
  v_cvt_pk_bf16_f32 v200, v72, v73
  v_mfma_f32_16x16x32_bf16 v[88:91], a[228:231], v[184:187], v[88:91]
  ds_read_b128 v[168:171], v16 offset:36864
  v_cvt_pk_bf16_f32 v201, v74, v75
  v_mfma_f32_16x16x32_bf16 v[92:95], a[232:235], v[184:187], v[92:95]
  v_cvt_pk_bf16_f32 v196, v76, v77
  v_cvt_pk_bf16_f32 v197, v78, v79
  v_mfma_f32_16x16x32_bf16 v[96:99], a[236:239], v[184:187], v[96:99]
  s_waitcnt lgkmcnt(3)
  v_cvt_pk_bf16_f32 v198, v80, v81
  v_cvt_pk_bf16_f32 v199, v82, v83
  v_mfma_f32_16x16x32_bf16 v[100:103], a[228:231], v[188:191], v[100:103]
  ds_read_b128 v[172:175], v16 offset:38912
  v_cvt_pk_bf16_f32 v202, v84, v85
  v_mfma_f32_16x16x32_bf16 v[104:107], a[232:235], v[188:191], v[104:107]
  s_sub_u32 s26, s26, 1
  s_cmp_gt_u32 s26, 0
  v_cvt_pk_bf16_f32 v203, v86, v87
  v_mfma_f32_16x16x32_bf16 v[108:111], a[236:239], v[188:191], v[108:111]
  s_waitcnt lgkmcnt(3)
  s_cbranch_scc1 kvm_196
  s_nop 7
  v_cvt_pk_bf16_f32 v204, v88, v89
  v_cvt_pk_bf16_f32 v205, v90, v91
  v_cvt_pk_bf16_f32 v206, v92, v93
  v_cvt_pk_bf16_f32 v207, v94, v95
  v_cvt_pk_bf16_f32 v212, v96, v97
  v_cvt_pk_bf16_f32 v213, v98, v99
  v_cvt_pk_bf16_f32 v208, v100, v101
  v_cvt_pk_bf16_f32 v209, v102, v103
  v_cvt_pk_bf16_f32 v210, v104, v105
  v_cvt_pk_bf16_f32 v211, v106, v107
  v_cvt_pk_bf16_f32 v214, v108, v109
  v_cvt_pk_bf16_f32 v215, v110, v111
  s_xor_b32 s29, s48, 0
  buffer_store_dwordx4 v[192:195], v26, s[16:19], s29 offen offset:0 sc1
  buffer_store_dwordx4 v[196:199], v26, s[16:19], s29 offen offset:1024 sc1
  buffer_store_dwordx4 v[200:203], v26, s[16:19], s29 offen offset:2048 sc1
  s_xor_b32 s29, s48, 2105344
  buffer_store_dwordx4 v[204:207], v26, s[16:19], s29 offen offset:0 sc1
  buffer_store_dwordx4 v[208:211], v26, s[16:19], s29 offen offset:1024 sc1
  buffer_store_dwordx4 v[212:215], v26, s[16:19], s29 offen offset:2048 sc1
  s_mov_b32 s30, 327680
  s_mov_b32 s25, 162688
  v_lshrrev_b32 v4, 3, v1
  v_and_b32 v5, 7, v1
  v_xor_b32 v5, v5, v4
  s_mul_i32 s21, s20, 32
  v_add_u32 v4, s21, v4
  v_mul_u32_u24 v4, 1280, v4
  v_lshl_add_u32 v10, v5, 4, v4
  s_mul_i32 s31, s20, 4096
  v_add_u32 v11, 10240, v10
  v_add_u32 v12, 20480, v10
  v_add_u32 v13, 30720, v10
  s_add_u32 m0, s31, 0
  s_nop 0
  buffer_load_dwordx4 v10, s[8:11], s30 offen lds
  s_add_u32 m0, s31, 1024
  s_nop 0
  buffer_load_dwordx4 v11, s[8:11], s30 offen lds
  s_add_u32 m0, s31, 2048
  s_nop 0
  buffer_load_dwordx4 v12, s[8:11], s30 offen lds
  s_add_u32 m0, s31, 3072
  s_nop 0
  buffer_load_dwordx4 v13, s[8:11], s30 offen lds
  s_add_u32 s30, s30, 128
  s_add_u32 m0, s31, 16384
  s_nop 0
  buffer_load_dwordx4 v10, s[8:11], s30 offen lds
  s_add_u32 m0, s31, 17408
  s_nop 0
  buffer_load_dwordx4 v11, s[8:11], s30 offen lds
  s_add_u32 m0, s31, 18432
  s_nop 0
  buffer_load_dwordx4 v12, s[8:11], s30 offen lds
  s_add_u32 m0, s31, 19456
  s_nop 0
  buffer_load_dwordx4 v13, s[8:11], s30 offen lds
  s_add_u32 s30, s30, 128
  s_add_u32 m0, s31, 32768
  s_nop 0
  buffer_load_dwordx4 v10, s[8:11], s30 offen lds
  s_add_u32 m0, s31, 33792
  s_nop 0
  buffer_load_dwordx4 v11, s[8:11], s30 offen lds
  s_add_u32 m0, s31, 34816
  s_nop 0
  buffer_load_dwordx4 v12, s[8:11], s30 offen lds
  s_add_u32 m0, s31, 35840
  s_nop 0
  buffer_load_dwordx4 v13, s[8:11], s30 offen lds
  s_add_u32 s30, s30, 128
  s_add_u32 m0, s31, 49152
  s_nop 0
  buffer_load_dwordx4 v10, s[8:11], s30 offen lds
  s_add_u32 m0, s31, 50176
  s_nop 0
  buffer_load_dwordx4 v11, s[8:11], s30 offen lds
  s_add_u32 m0, s31, 51200
  s_nop 0
  buffer_load_dwordx4 v12, s[8:11], s30 offen lds
  s_add_u32 m0, s31, 52224
  s_nop 0
  buffer_load_dwordx4 v13, s[8:11], s30 offen lds
  s_add_u32 s30, s30, 128
  s_add_u32 m0, s31, 65536
  s_nop 0
  buffer_load_dwordx4 v10, s[8:11], s30 offen lds
  s_add_u32 m0, s31, 66560
  s_nop 0
  buffer_load_dwordx4 v11, s[8:11], s30 offen lds
  s_add_u32 m0, s31, 67584
  s_nop 0
  buffer_load_dwordx4 v12, s[8:11], s30 offen lds
  s_add_u32 m0, s31, 68608
  s_nop 0
  buffer_load_dwordx4 v13, s[8:11], s30 offen lds
  s_add_u32 s30, s30, 128
  s_add_u32 m0, s31, 81920
  s_nop 0
  buffer_load_dwordx4 v10, s[8:11], s30 offen lds
  s_add_u32 m0, s31, 82944
  s_nop 0
  buffer_load_dwordx4 v11, s[8:11], s30 offen lds
  s_add_u32 m0, s31, 83968
  s_nop 0
  buffer_load_dwordx4 v12, s[8:11], s30 offen lds
  s_add_u32 m0, s31, 84992
  s_nop 0
  buffer_load_dwordx4 v13, s[8:11], s30 offen lds
  s_add_u32 s30, s30, 128
  s_waitcnt vmcnt(24) lgkmcnt(0)
  s_barrier
  buffer_atomic_add v28, v27, s[72:75], s61 offen sc1
  s_add_u32 m0, s31, 98304
  s_nop 0
  buffer_load_dwordx4 v10, s[8:11], s30 offen lds
  s_add_u32 m0, s31, 99328
  s_nop 0
  buffer_load_dwordx4 v11, s[8:11], s30 offen lds
  s_add_u32 m0, s31, 100352
  s_nop 0
  buffer_load_dwordx4 v12, s[8:11], s30 offen lds
  s_add_u32 m0, s31, 101376
  s_nop 0
  buffer_load_dwordx4 v13, s[8:11], s30 offen lds
  s_add_u32 s30, s30, 128
  s_add_u32 m0, s31, 114688
  s_nop 0
  buffer_load_dwordx4 v10, s[8:11], s30 offen lds
  s_add_u32 m0, s31, 115712
  s_nop 0
  buffer_load_dwordx4 v11, s[8:11], s30 offen lds
  s_add_u32 m0, s31, 116736
  s_nop 0
  buffer_load_dwordx4 v12, s[8:11], s30 offen lds
  s_add_u32 m0, s31, 117760
  s_nop 0
  buffer_load_dwordx4 v13, s[8:11], s30 offen lds
  s_add_u32 s30, s30, 128
  s_mov_b32 s26, 14
  s_mov_b32 s48, 0x40000000
  s_mov_b32 s61, 0x40000000
  s_waitcnt vmcnt(28)
  s_barrier
  ds_read_b128 v[160:163], v14 offset:0
  ds_read_b128 v[164:167], v14 offset:2048
  ds_read_b128 v[168:171], v14 offset:4096
  ds_read_b128 v[172:175], v14 offset:6144
  s_waitcnt lgkmcnt(3)
  .p2align 3
kvs_197:
  v_mfma_f32_16x16x32_bf16 v[64:67], a[0:3], v[160:163], 0
  s_xor_b32 s29, s48, 0
  ds_read_b128 v[176:179], v14 offset:8192
  v_cvt_pk_bf16_f32 v221, v126, v127
  v_mfma_f32_16x16x32_bf16 v[68:71], a[4:7], v[160:163], 0
  v_cvt_pk_bf16_f32 v222, v128, v129
  v_cvt_pk_bf16_f32 v223, v130, v131
  v_mfma_f32_16x16x32_bf16 v[72:75], a[8:11], v[160:163], 0
  s_waitcnt lgkmcnt(3)
  v_cvt_pk_bf16_f32 v226, v132, v133
  v_cvt_pk_bf16_f32 v227, v134, v135
  v_mfma_f32_16x16x32_bf16 v[76:79], a[0:3], v[164:167], 0
  ds_read_b128 v[180:183], v14 offset:10240
  v_cvt_pk_bf16_f32 v228, v136, v137
  v_mfma_f32_16x16x32_bf16 v[80:83], a[4:7], v[164:167], 0
  v_cvt_pk_bf16_f32 v229, v138, v139
  v_cvt_pk_bf16_f32 v230, v140, v141
  v_mfma_f32_16x16x32_bf16 v[84:87], a[8:11], v[164:167], 0
  s_waitcnt lgkmcnt(3)
  v_cvt_pk_bf16_f32 v231, v142, v143
  v_cvt_pk_bf16_f32 v236, v144, v145
  v_mfma_f32_16x16x32_bf16 v[88:91], a[0:3], v[168:171], 0
  ds_read_b128 v[184:187], v14 offset:12288
  v_cvt_pk_bf16_f32 v237, v146, v147
  v_mfma_f32_16x16x32_bf16 v[92:95], a[4:7], v[168:171], 0
  v_cvt_pk_bf16_f32 v232, v148, v149
  v_cvt_pk_bf16_f32 v233, v150, v151
  v_mfma_f32_16x16x32_bf16 v[96:99], a[8:11], v[168:171], 0
  s_waitcnt lgkmcnt(3)
  v_cvt_pk_bf16_f32 v234, v152, v153
  v_cvt_pk_bf16_f32 v235, v154, v155
  v_mfma_f32_16x16x32_bf16 v[100:103], a[0:3], v[172:175], 0
  ds_read_b128 v[188:191], v14 offset:14336
  v_cvt_pk_bf16_f32 v238, v156, v157
  v_mfma_f32_16x16x32_bf16 v[104:107], a[4:7], v[172:175], 0
  v_cvt_pk_bf16_f32 v239, v158, v159
  buffer_store_dwordx4 v[192:195], v26, s[16:19], s29 offen offset:0 sc1
  v_mfma_f32_16x16x32_bf16 v[108:111], a[8:11], v[172:175], 0
  s_waitcnt lgkmcnt(3)
  v_mfma_f32_16x16x32_bf16 v[112:115], a[0:3], v[176:179], 0
  ds_read_b128 v[160:163], v15 offset:0
  v_mfma_f32_16x16x32_bf16 v[116:119], a[4:7], v[176:179], 0
  s_add_u32 m0, s31, 131072
  v_mfma_f32_16x16x32_bf16 v[120:123], a[8:11], v[176:179], 0
  s_waitcnt lgkmcnt(3)
  buffer_load_dwordx4 v10, s[8:11], s30 offen lds
  v_mfma_f32_16x16x32_bf16 v[124:127], a[0:3], v[180:183], 0
  ds_read_b128 v[164:167], v15 offset:2048
  v_mfma_f32_16x16x32_bf16 v[128:131], a[4:7], v[180:183], 0
  v_mfma_f32_16x16x32_bf16 v[132:135], a[8:11], v[180:183], 0
  s_waitcnt lgkmcnt(3)
  buffer_store_dwordx4 v[196:199], v26, s[16:19], s29 offen offset:1024 sc1
  v_mfma_f32_16x16x32_bf16 v[136:139], a[0:3], v[184:187], 0
  ds_read_b128 v[168:171], v15 offset:4096
  v_mfma_f32_16x16x32_bf16 v[140:143], a[4:7], v[184:187], 0
  s_add_u32 m0, s31, 132096
  v_mfma_f32_16x16x32_bf16 v[144:147], a[8:11], v[184:187], 0
  s_waitcnt lgkmcnt(3)
  buffer_load_dwordx4 v11, s[8:11], s30 offen lds
  v_mfma_f32_16x16x32_bf16 v[148:151], a[0:3], v[188:191], 0
  ds_read_b128 v[172:175], v15 offset:6144
  v_mfma_f32_16x16x32_bf16 v[152:155], a[4:7], v[188:191], 0
  v_mfma_f32_16x16x32_bf16 v[156:159], a[8:11], v[188:191], 0
  s_waitcnt lgkmcnt(3)
  v_mfma_f32_16x16x32_bf16 v[64:67], a[12:15], v[160:163], v[64:67]
  ds_read_b128 v[176:179], v15 offset:8192
  buffer_store_dwordx4 v[200:203], v26, s[16:19], s29 offen offset:2048 sc1
  v_mfma_f32_16x16x32_bf16 v[68:71], a[16:19], v[160:163], v[68:71]
  s_add_u32 m0, s31, 133120
  v_mfma_f32_16x16x32_bf16 v[72:75], a[20:23], v[160:163], v[72:75]
  s_waitcnt lgkmcnt(3)
  buffer_load_dwordx4 v12, s[8:11], s30 offen lds
  v_mfma_f32_16x16x32_bf16 v[76:79], a[12:15], v[164:167], v[76:79]
  ds_read_b128 v[180:183], v15 offset:10240
  v_mfma_f32_16x16x32_bf16 v[80:83], a[16:19], v[164:167], v[80:83]
  v_mfma_f32_16x16x32_bf16 v[84:87], a[20:23], v[164:167], v[84:87]
  s_waitcnt lgkmcnt(3)
  v_mfma_f32_16x16x32_bf16 v[88:91], a[12:15], v[168:171], v[88:91]
  s_xor_b32 s29, s48, 2105344
  ds_read_b128 v[184:187], v15 offset:12288
  v_mfma_f32_16x16x32_bf16 v[92:95], a[16:19], v[168:171], v[92:95]
  s_add_u32 m0, s31, 134144
  buffer_store_dwordx4 v[204:207], v26, s[16:19], s29 offen offset:0 sc1
  v_mfma_f32_16x16x32_bf16 v[96:99], a[20:23], v[168:171], v[96:99]
  s_waitcnt lgkmcnt(3)
  buffer_load_dwordx4 v13, s[8:11], s30 offen lds
  v_mfma_f32_16x16x32_bf16 v[100:103], a[12:15], v[172:175], v[100:103]
  s_add_u32 s30, s30, 128
  ds_read_b128 v[188:191], v15 offset:14336
  v_mfma_f32_16x16x32_bf16 v[104:107], a[16:19], v[172:175], v[104:107]
  v_mfma_f32_16x16x32_bf16 v[108:111], a[20:23], v[172:175], v[108:111]
  s_waitcnt lgkmcnt(3)
  v_mfma_f32_16x16x32_bf16 v[112:115], a[12:15], v[176:179], v[112:115]
  s_waitcnt vmcnt(32)
  s_barrier
  ds_read_b128 v[160:163], v14 offset:16384
  v_mfma_f32_16x16x32_bf16 v[116:119], a[16:19], v[176:179], v[116:119]
  v_mfma_f32_16x16x32_bf16 v[120:123], a[20:23], v[176:179], v[120:123]
  s_waitcnt lgkmcnt(3)
  buffer_store_dwordx4 v[208:211], v26, s[16:19], s29 offen offset:1024 sc1
  v_mfma_f32_16x16x32_bf16 v[124:127], a[12:15], v[180:183], v[124:127]
  ds_read_b128 v[164:167], v14 offset:18432
  v_mfma_f32_16x16x32_bf16 v[128:131], a[16:19], v[180:183], v[128:131]
  v_mfma_f32_16x16x32_bf16 v[132:135], a[20:23], v[180:183], v[132:135]
  s_waitcnt lgkmcnt(3)
  v_mfma_f32_16x16x32_bf16 v[136:139], a[12:15], v[184:187], v[136:139]
  ds_read_b128 v[168:171], v14 offset:20480
  v_mfma_f32_16x16x32_bf16 v[140:143], a[16:19], v[184:187], v[140:143]
  v_mfma_f32_16x16x32_bf16 v[144:147], a[20:23], v[184:187], v[144:147]
  s_waitcnt lgkmcnt(3)
  v_mfma_f32_16x16x32_bf16 v[148:151], a[12:15], v[188:191], v[148:151]
  ds_read_b128 v[172:175], v14 offset:22528
  buffer_store_dwordx4 v[212:215], v26, s[16:19], s29 offen offset:2048 sc1
  v_mfma_f32_16x16x32_bf16 v[152:155], a[16:19], v[188:191], v[152:155]
  v_mfma_f32_16x16x32_bf16 v[156:159], a[20:23], v[188:191], v[156:159]
  s_waitcnt lgkmcnt(3)
  v_mfma_f32_16x16x32_bf16 v[64:67], a[24:27], v[160:163], v[64:67]
  ds_read_b128 v[176:179], v14 offset:24576
  v_mfma_f32_16x16x32_bf16 v[68:71], a[28:31], v[160:163], v[68:71]
  s_add_u32 m0, s31, 147456
  v_mfma_f32_16x16x32_bf16 v[72:75], a[32:35], v[160:163], v[72:75]
  s_waitcnt lgkmcnt(3)
  buffer_load_dwordx4 v10, s[8:11], s30 offen lds
  v_mfma_f32_16x16x32_bf16 v[76:79], a[24:27], v[164:167], v[76:79]
  s_xor_b32 s29, s48, 4194304
  ds_read_b128 v[180:183], v14 offset:26624
  v_mfma_f32_16x16x32_bf16 v[80:83], a[28:31], v[164:167], v[80:83]
  buffer_store_dwordx4 v[216:219], v26, s[16:19], s29 offen offset:0 sc1
  v_mfma_f32_16x16x32_bf16 v[84:87], a[32:35], v[164:167], v[84:87]
  s_waitcnt lgkmcnt(3)
  v_mfma_f32_16x16x32_bf16 v[88:91], a[24:27], v[168:171], v[88:91]
  ds_read_b128 v[184:187], v14 offset:28672
  v_mfma_f32_16x16x32_bf16 v[92:95], a[28:31], v[168:171], v[92:95]
  s_add_u32 m0, s31, 148480
  v_mfma_f32_16x16x32_bf16 v[96:99], a[32:35], v[168:171], v[96:99]
  s_waitcnt lgkmcnt(3)
  buffer_load_dwordx4 v11, s[8:11], s30 offen lds
  v_mfma_f32_16x16x32_bf16 v[100:103], a[24:27], v[172:175], v[100:103]
  ds_read_b128 v[188:191], v14 offset:30720
  v_mfma_f32_16x16x32_bf16 v[104:107], a[28:31], v[172:175], v[104:107]
  v_mfma_f32_16x16x32_bf16 v[108:111], a[32:35], v[172:175], v[108:111]
  s_waitcnt lgkmcnt(3)
  buffer_store_dwordx4 v[220:223], v26, s[16:19], s29 offen offset:1024 sc1
  v_mfma_f32_16x16x32_bf16 v[112:115], a[24:27], v[176:179], v[112:115]
  ds_read_b128 v[160:163], v15 offset:16384
  v_mfma_f32_16x16x32_bf16 v[116:119], a[28:31], v[176:179], v[116:119]
  s_add_u32 m0, s31, 149504
  v_mfma_f32_16x16x32_bf16 v[120:123], a[32:35], v[176:179], v[120:123]
  s_waitcnt lgkmcnt(3)
  buffer_load_dwordx4 v12, s[8:11], s30 offen lds
  v_mfma_f32_16x16x32_bf16 v[124:127], a[24:27], v[180:183], v[124:127]
  ds_read_b128 v[164:167], v15 offset:18432
  v_mfma_f32_16x16x32_bf16 v[128:131], a[28:31], v[180:183], v[128:131]
  v_mfma_f32_16x16x32_bf16 v[132:135], a[32:35], v[180:183], v[132:135]
  s_waitcnt lgkmcnt(3)
  v_mfma_f32_16x16x32_bf16 v[136:139], a[24:27], v[184:187], v[136:139]
  ds_read_b128 v[168:171], v15 offset:20480
  buffer_store_dwordx4 v[224:227], v26, s[16:19], s29 offen offset:2048 sc1
  v_mfma_f32_16x16x32_bf16 v[140:143], a[28:31], v[184:187], v[140:143]
  s_add_u32 m0, s31, 150528
  v_mfma_f32_16x16x32_bf16 v[144:147], a[32:35], v[184:187], v[144:147]
  s_waitcnt lgkmcnt(3)
  buffer_load_dwordx4 v13, s[8:11], s30 offen lds
  v_mfma_f32_16x16x32_bf16 v[148:151], a[24:27], v[188:191], v[148:151]
  s_add_u32 s30, s30, s25
  ds_read_b128 v[172:175], v15 offset:22528
  v_mfma_f32_16x16x32_bf16 v[152:155], a[28:31], v[188:191], v[152:155]
  v_mfma_f32_16x16x32_bf16 v[156:159], a[32:35], v[188:191], v[156:159]
  s_waitcnt lgkmcnt(3)
  v_mfma_f32_16x16x32_bf16 v[64:67], a[36:39], v[160:163], v[64:67]
  s_xor_b32 s29, s48, 6299648
  ds_read_b128 v[176:179], v15 offset:24576
  v_mfma_f32_16x16x32_bf16 v[68:71], a[40:43], v[160:163], v[68:71]
  buffer_store_dwordx4 v[228:231], v26, s[16:19], s29 offen offset:0 sc1
  v_mfma_f32_16x16x32_bf16 v[72:75], a[44:47], v[160:163], v[72:75]
  s_waitcnt lgkmcnt(3)
  v_mfma_f32_16x16x32_bf16 v[76:79], a[36:39], v[164:167], v[76:79]
  ds_read_b128 v[180:183], v15 offset:26624
  v_mfma_f32_16x16x32_bf16 v[80:83], a[40:43], v[164:167], v[80:83]
  v_mfma_f32_16x16x32_bf16 v[84:87], a[44:47], v[164:167], v[84:87]
  s_waitcnt lgkmcnt(3)
  v_mfma_f32_16x16x32_bf16 v[88:91], a[36:39], v[168:171], v[88:91]
  ds_read_b128 v[184:187], v15 offset:28672
  v_mfma_f32_16x16x32_bf16 v[92:95], a[40:43], v[168:171], v[92:95]
  v_mfma_f32_16x16x32_bf16 v[96:99], a[44:47], v[168:171], v[96:99]
  s_waitcnt lgkmcnt(3)
  buffer_store_dwordx4 v[232:235], v26, s[16:19], s29 offen offset:1024 sc1
  v_mfma_f32_16x16x32_bf16 v[100:103], a[36:39], v[172:175], v[100:103]
  ds_read_b128 v[188:191], v15 offset:30720
  v_mfma_f32_16x16x32_bf16 v[104:107], a[40:43], v[172:175], v[104:107]
  v_mfma_f32_16x16x32_bf16 v[108:111], a[44:47], v[172:175], v[108:111]
  s_waitcnt lgkmcnt(3)
  v_mfma_f32_16x16x32_bf16 v[112:115], a[36:39], v[176:179], v[112:115]
  s_waitcnt vmcnt(39)
  s_barrier
  ds_read_b128 v[160:163], v14 offset:32768
  v_mfma_f32_16x16x32_bf16 v[116:119], a[40:43], v[176:179], v[116:119]
  v_mfma_f32_16x16x32_bf16 v[120:123], a[44:47], v[176:179], v[120:123]
  s_waitcnt lgkmcnt(3)
  v_mfma_f32_16x16x32_bf16 v[124:127], a[36:39], v[180:183], v[124:127]
  ds_read_b128 v[164:167], v14 offset:34816
  buffer_store_dwordx4 v[236:239], v26, s[16:19], s29 offen offset:2048 sc1
  v_mfma_f32_16x16x32_bf16 v[128:131], a[40:43], v[180:183], v[128:131]
  v_mfma_f32_16x16x32_bf16 v[132:135], a[44:47], v[180:183], v[132:135]
  s_waitcnt lgkmcnt(3)
  v_mfma_f32_16x16x32_bf16 v[136:139], a[36:39], v[184:187], v[136:139]
  ds_read_b128 v[168:171], v14 offset:36864
  v_mfma_f32_16x16x32_bf16 v[140:143], a[40:43], v[184:187], v[140:143]
  v_mfma_f32_16x16x32_bf16 v[144:147], a[44:47], v[184:187], v[144:147]
  s_waitcnt lgkmcnt(3)
  v_mfma_f32_16x16x32_bf16 v[148:151], a[36:39], v[188:191], v[148:151]
  ds_read_b128 v[172:175], v14 offset:38912
  v_mfma_f32_16x16x32_bf16 v[152:155], a[40:43], v[188:191], v[152:155]
  v_mfma_f32_16x16x32_bf16 v[156:159], a[44:47], v[188:191], v[156:159]
  s_waitcnt lgkmcnt(3)
  v_mfma_f32_16x16x32_bf16 v[64:67], a[48:51], v[160:163], v[64:67]
  ds_read_b128 v[176:179], v14 offset:40960
  v_mfma_f32_16x16x32_bf16 v[68:71], a[52:55], v[160:163], v[68:71]
  s_add_u32 m0, s31, 0
  v_mfma_f32_16x16x32_bf16 v[72:75], a[56:59], v[160:163], v[72:75]
  s_waitcnt lgkmcnt(3)
  buffer_load_dwordx4 v10, s[8:11], s30 offen lds
  v_mfma_f32_16x16x32_bf16 v[76:79], a[48:51], v[164:167], v[76:79]
  ds_read_b128 v[180:183], v14 offset:43008
  v_mfma_f32_16x16x32_bf16 v[80:83], a[52:55], v[164:167], v[80:83]
  v_mfma_f32_16x16x32_bf16 v[84:87], a[56:59], v[164:167], v[84:87]
  s_waitcnt lgkmcnt(3)
  v_mfma_f32_16x16x32_bf16 v[88:91], a[48:51], v[168:171], v[88:91]
  ds_read_b128 v[184:187], v14 offset:45056
  v_mfma_f32_16x16x32_bf16 v[92:95], a[52:55], v[168:171], v[92:95]
  s_add_u32 m0, s31, 1024
  v_mfma_f32_16x16x32_bf16 v[96:99], a[56:59], v[168:171], v[96:99]
  s_waitcnt lgkmcnt(3)
  buffer_load_dwordx4 v11, s[8:11], s30 offen lds
  v_mfma_f32_16x16x32_bf16 v[100:103], a[48:51], v[172:175], v[100:103]
  ds_read_b128 v[188:191], v14 offset:47104
  v_mfma_f32_16x16x32_bf16 v[104:107], a[52:55], v[172:175], v[104:107]
  v_mfma_f32_16x16x32_bf16 v[108:111], a[56:59], v[172:175], v[108:111]
  s_waitcnt lgkmcnt(3)
  v_mfma_f32_16x16x32_bf16 v[112:115], a[48:51], v[176:179], v[112:115]
  ds_read_b128 v[160:163], v15 offset:32768
  v_mfma_f32_16x16x32_bf16 v[116:119], a[52:55], v[176:179], v[116:119]
  s_add_u32 m0, s31, 2048
  v_mfma_f32_16x16x32_bf16 v[120:123], a[56:59], v[176:179], v[120:123]
  s_waitcnt lgkmcnt(3)
  buffer_load_dwordx4 v12, s[8:11], s30 offen lds
  v_mfma_f32_16x16x32_bf16 v[124:127], a[48:51], v[180:183], v[124:127]
  ds_read_b128 v[164:167], v15 offset:34816
  v_mfma_f32_16x16x32_bf16 v[128:131], a[52:55], v[180:183], v[128:131]
  v_mfma_f32_16x16x32_bf16 v[132:135], a[56:59], v[180:183], v[132:135]
  s_waitcnt lgkmcnt(3)
  v_mfma_f32_16x16x32_bf16 v[136:139], a[48:51], v[184:187], v[136:139]
  ds_read_b128 v[168:171], v15 offset:36864
  v_mfma_f32_16x16x32_bf16 v[140:143], a[52:55], v[184:187], v[140:143]
  s_add_u32 m0, s31, 3072
  v_mfma_f32_16x16x32_bf16 v[144:147], a[56:59], v[184:187], v[144:147]
  s_waitcnt lgkmcnt(3)
  buffer_load_dwordx4 v13, s[8:11], s30 offen lds
  v_mfma_f32_16x16x32_bf16 v[148:151], a[48:51], v[188:191], v[148:151]
  s_add_u32 s30, s30, 128
  ds_read_b128 v[172:175], v15 offset:38912
  v_mfma_f32_16x16x32_bf16 v[152:155], a[52:55], v[188:191], v[152:155]
  v_mfma_f32_16x16x32_bf16 v[156:159], a[56:59], v[188:191], v[156:159]
  s_waitcnt lgkmcnt(3)
  v_mfma_f32_16x16x32_bf16 v[64:67], a[60:63], v[160:163], v[64:67]
  ds_read_b128 v[176:179], v15 offset:40960
  v_mfma_f32_16x16x32_bf16 v[68:71], a[64:67], v[160:163], v[68:71]
  v_mfma_f32_16x16x32_bf16 v[72:75], a[68:71], v[160:163], v[72:75]
  s_waitcnt lgkmcnt(3)
  v_mfma_f32_16x16x32_bf16 v[76:79], a[60:63], v[164:167], v[76:79]
  ds_read_b128 v[180:183], v15 offset:43008
  v_mfma_f32_16x16x32_bf16 v[80:83], a[64:67], v[164:167], v[80:83]
  v_mfma_f32_16x16x32_bf16 v[84:87], a[68:71], v[164:167], v[84:87]
  s_waitcnt lgkmcnt(3)
  v_mfma_f32_16x16x32_bf16 v[88:91], a[60:63], v[168:171], v[88:91]
  ds_read_b128 v[184:187], v15 offset:45056
  v_mfma_f32_16x16x32_bf16 v[92:95], a[64:67], v[168:171], v[92:95]
  v_mfma_f32_16x16x32_bf16 v[96:99], a[68:71], v[168:171], v[96:99]
  s_waitcnt lgkmcnt(3)
  v_mfma_f32_16x16x32_bf16 v[100:103], a[60:63], v[172:175], v[100:103]
  ds_read_b128 v[188:191], v15 offset:47104
  v_mfma_f32_16x16x32_bf16 v[104:107], a[64:67], v[172:175], v[104:107]
  v_mfma_f32_16x16x32_bf16 v[108:111], a[68:71], v[172:175], v[108:111]
  s_waitcnt lgkmcnt(3)
  v_mfma_f32_16x16x32_bf16 v[112:115], a[60:63], v[176:179], v[112:115]
  s_waitcnt vmcnt(40)
  s_barrier
  ds_read_b128 v[160:163], v14 offset:49152
  v_mfma_f32_16x16x32_bf16 v[116:119], a[64:67], v[176:179], v[116:119]
  v_mfma_f32_16x16x32_bf16 v[120:123], a[68:71], v[176:179], v[120:123]
  s_waitcnt lgkmcnt(3)
  v_mfma_f32_16x16x32_bf16 v[124:127], a[60:63], v[180:183], v[124:127]
  ds_read_b128 v[164:167], v14 offset:51200
  v_mfma_f32_16x16x32_bf16 v[128:131], a[64:67], v[180:183], v[128:131]
  v_mfma_f32_16x16x32_bf16 v[132:135], a[68:71], v[180:183], v[132:135]
  s_waitcnt lgkmcnt(3)
  v_mfma_f32_16x16x32_bf16 v[136:139], a[60:63], v[184:187], v[136:139]
  ds_read_b128 v[168:171], v14 offset:53248
  v_mfma_f32_16x16x32_bf16 v[140:143], a[64:67], v[184:187], v[140:143]
  v_mfma_f32_16x16x32_bf16 v[144:147], a[68:71], v[184:187], v[144:147]
  s_waitcnt lgkmcnt(3)
  v_mfma_f32_16x16x32_bf16 v[148:151], a[60:63], v[188:191], v[148:151]
  ds_read_b128 v[172:175], v14 offset:55296
  v_mfma_f32_16x16x32_bf16 v[152:155], a[64:67], v[188:191], v[152:155]
  v_mfma_f32_16x16x32_bf16 v[156:159], a[68:71], v[188:191], v[156:159]
  s_waitcnt lgkmcnt(3)
  v_mfma_f32_16x16x32_bf16 v[64:67], a[72:75], v[160:163], v[64:67]
  ds_read_b128 v[176:179], v14 offset:57344
  v_mfma_f32_16x16x32_bf16 v[68:71], a[76:79], v[160:163], v[68:71]
  s_add_u32 m0, s31, 16384
  v_mfma_f32_16x16x32_bf16 v[72:75], a[80:83], v[160:163], v[72:75]
  s_waitcnt lgkmcnt(3)
  buffer_load_dwordx4 v10, s[8:11], s30 offen lds
  v_mfma_f32_16x16x32_bf16 v[76:79], a[72:75], v[164:167], v[76:79]
  ds_read_b128 v[180:183], v14 offset:59392
  v_mfma_f32_16x16x32_bf16 v[80:83], a[76:79], v[164:167], v[80:83]
  v_mfma_f32_16x16x32_bf16 v[84:87], a[80:83], v[164:167], v[84:87]
  s_waitcnt lgkmcnt(3)
  v_mfma_f32_16x16x32_bf16 v[88:91], a[72:75], v[168:171], v[88:91]
  ds_read_b128 v[184:187], v14 offset:61440
  v_mfma_f32_16x16x32_bf16 v[92:95], a[76:79], v[168:171], v[92:95]
  s_add_u32 m0, s31, 17408
  v_mfma_f32_16x16x32_bf16 v[96:99], a[80:83], v[168:171], v[96:99]
  s_waitcnt lgkmcnt(3)
  buffer_load_dwordx4 v11, s[8:11], s30 offen lds
  v_mfma_f32_16x16x32_bf16 v[100:103], a[72:75], v[172:175], v[100:103]
  ds_read_b128 v[188:191], v14 offset:63488
  v_mfma_f32_16x16x32_bf16 v[104:107], a[76:79], v[172:175], v[104:107]
  v_mfma_f32_16x16x32_bf16 v[108:111], a[80:83], v[172:175], v[108:111]
  s_waitcnt lgkmcnt(3)
  v_mfma_f32_16x16x32_bf16 v[112:115], a[72:75], v[176:179], v[112:115]
  ds_read_b128 v[160:163], v15 offset:49152
  v_mfma_f32_16x16x32_bf16 v[116:119], a[76:79], v[176:179], v[116:119]
  s_add_u32 m0, s31, 18432
  v_mfma_f32_16x16x32_bf16 v[120:123], a[80:83], v[176:179], v[120:123]
  s_waitcnt lgkmcnt(3)
  buffer_load_dwordx4 v12, s[8:11], s30 offen lds
  v_mfma_f32_16x16x32_bf16 v[124:127], a[72:75], v[180:183], v[124:127]
  ds_read_b128 v[164:167], v15 offset:51200
  v_mfma_f32_16x16x32_bf16 v[128:131], a[76:79], v[180:183], v[128:131]
  v_mfma_f32_16x16x32_bf16 v[132:135], a[80:83], v[180:183], v[132:135]
  s_waitcnt lgkmcnt(3)
  v_mfma_f32_16x16x32_bf16 v[136:139], a[72:75], v[184:187], v[136:139]
  ds_read_b128 v[168:171], v15 offset:53248
  v_mfma_f32_16x16x32_bf16 v[140:143], a[76:79], v[184:187], v[140:143]
  s_add_u32 m0, s31, 19456
  v_mfma_f32_16x16x32_bf16 v[144:147], a[80:83], v[184:187], v[144:147]
  s_waitcnt lgkmcnt(3)
  buffer_load_dwordx4 v13, s[8:11], s30 offen lds
  v_mfma_f32_16x16x32_bf16 v[148:151], a[72:75], v[188:191], v[148:151]
  s_add_u32 s30, s30, 128
  ds_read_b128 v[172:175], v15 offset:55296
  v_mfma_f32_16x16x32_bf16 v[152:155], a[76:79], v[188:191], v[152:155]
  v_mfma_f32_16x16x32_bf16 v[156:159], a[80:83], v[188:191], v[156:159]
  s_waitcnt lgkmcnt(3)
  v_mfma_f32_16x16x32_bf16 v[64:67], a[84:87], v[160:163], v[64:67]
  ds_read_b128 v[176:179], v15 offset:57344
  v_mfma_f32_16x16x32_bf16 v[68:71], a[88:91], v[160:163], v[68:71]
  v_mfma_f32_16x16x32_bf16 v[72:75], a[92:95], v[160:163], v[72:75]
  s_waitcnt lgkmcnt(3)
  v_mfma_f32_16x16x32_bf16 v[76:79], a[84:87], v[164:167], v[76:79]
  ds_read_b128 v[180:183], v15 offset:59392
  v_mfma_f32_16x16x32_bf16 v[80:83], a[88:91], v[164:167], v[80:83]
  v_mfma_f32_16x16x32_bf16 v[84:87], a[92:95], v[164:167], v[84:87]
  s_waitcnt lgkmcnt(3)
  v_mfma_f32_16x16x32_bf16 v[88:91], a[84:87], v[168:171], v[88:91]
  ds_read_b128 v[184:187], v15 offset:61440
  v_mfma_f32_16x16x32_bf16 v[92:95], a[88:91], v[168:171], v[92:95]
  v_mfma_f32_16x16x32_bf16 v[96:99], a[92:95], v[168:171], v[96:99]
  s_waitcnt lgkmcnt(3)
  v_mfma_f32_16x16x32_bf16 v[100:103], a[84:87], v[172:175], v[100:103]
  ds_read_b128 v[188:191], v15 offset:63488
  v_mfma_f32_16x16x32_bf16 v[104:107], a[88:91], v[172:175], v[104:107]
  v_mfma_f32_16x16x32_bf16 v[108:111], a[92:95], v[172:175], v[108:111]
  s_waitcnt lgkmcnt(3)
  v_mfma_f32_16x16x32_bf16 v[112:115], a[84:87], v[176:179], v[112:115]
  s_waitcnt vmcnt(40)
  s_barrier
  ds_read_b128 v[160:163], v16 offset:0
  v_mfma_f32_16x16x32_bf16 v[116:119], a[88:91], v[176:179], v[116:119]
  v_mfma_f32_16x16x32_bf16 v[120:123], a[92:95], v[176:179], v[120:123]
  s_waitcnt lgkmcnt(3)
  v_mfma_f32_16x16x32_bf16 v[124:127], a[84:87], v[180:183], v[124:127]
  ds_read_b128 v[164:167], v16 offset:2048
  v_mfma_f32_16x16x32_bf16 v[128:131], a[88:91], v[180:183], v[128:131]
  v_mfma_f32_16x16x32_bf16 v[132:135], a[92:95], v[180:183], v[132:135]
  s_waitcnt lgkmcnt(3)
  v_mfma_f32_16x16x32_bf16 v[136:139], a[84:87], v[184:187], v[136:139]
  ds_read_b128 v[168:171], v16 offset:4096
  v_mfma_f32_16x16x32_bf16 v[140:143], a[88:91], v[184:187], v[140:143]
  v_mfma_f32_16x16x32_bf16 v[144:147], a[92:95], v[184:187], v[144:147]
  s_waitcnt lgkmcnt(3)
  v_mfma_f32_16x16x32_bf16 v[148:151], a[84:87], v[188:191], v[148:151]
  ds_read_b128 v[172:175], v16 offset:6144
  v_mfma_f32_16x16x32_bf16 v[152:155], a[88:91], v[188:191], v[152:155]
  v_mfma_f32_16x16x32_bf16 v[156:159], a[92:95], v[188:191], v[156:159]
  s_waitcnt lgkmcnt(3)
  v_mfma_f32_16x16x32_bf16 v[64:67], a[96:99], v[160:163], v[64:67]
  ds_read_b128 v[176:179], v16 offset:8192
  v_mfma_f32_16x16x32_bf16 v[68:71], a[100:103], v[160:163], v[68:71]
  s_add_u32 m0, s31, 32768
  v_mfma_f32_16x16x32_bf16 v[72:75], a[104:107], v[160:163], v[72:75]
  s_waitcnt lgkmcnt(3)
  buffer_load_dwordx4 v10, s[8:11], s30 offen lds
  v_mfma_f32_16x16x32_bf16 v[76:79], a[96:99], v[164:167], v[76:79]
  ds_read_b128 v[180:183], v16 offset:10240
  v_mfma_f32_16x16x32_bf16 v[80:83], a[100:103], v[164:167], v[80:83]
  v_mfma_f32_16x16x32_bf16 v[84:87], a[104:107], v[164:167], v[84:87]
  s_waitcnt lgkmcnt(3)
  v_mfma_f32_16x16x32_bf16 v[88:91], a[96:99], v[168:171], v[88:91]
  ds_read_b128 v[184:187], v16 offset:12288
  v_mfma_f32_16x16x32_bf16 v[92:95], a[100:103], v[168:171], v[92:95]
  s_add_u32 m0, s31, 33792
  v_mfma_f32_16x16x32_bf16 v[96:99], a[104:107], v[168:171], v[96:99]
  s_waitcnt lgkmcnt(3)
  buffer_load_dwordx4 v11, s[8:11], s30 offen lds
  v_mfma_f32_16x16x32_bf16 v[100:103], a[96:99], v[172:175], v[100:103]
  ds_read_b128 v[188:191], v16 offset:14336
  v_mfma_f32_16x16x32_bf16 v[104:107], a[100:103], v[172:175], v[104:107]
  v_mfma_f32_16x16x32_bf16 v[108:111], a[104:107], v[172:175], v[108:111]
  s_waitcnt lgkmcnt(3)
  v_mfma_f32_16x16x32_bf16 v[112:115], a[96:99], v[176:179], v[112:115]
  ds_read_b128 v[160:163], v17 offset:0
  v_mfma_f32_16x16x32_bf16 v[116:119], a[100:103], v[176:179], v[116:119]
  s_add_u32 m0, s31, 34816
  v_mfma_f32_16x16x32_bf16 v[120:123], a[104:107], v[176:179], v[120:123]
  s_waitcnt lgkmcnt(3)
  buffer_load_dwordx4 v12, s[8:11], s30 offen lds
  v_mfma_f32_16x16x32_bf16 v[124:127], a[96:99], v[180:183], v[124:127]
  ds_read_b128 v[164:167], v17 offset:2048
  v_mfma_f32_16x16x32_bf16 v[128:131], a[100:103], v[180:183], v[128:131]
  v_mfma_f32_16x16x32_bf16 v[132:135], a[104:107], v[180:183], v[132:135]
  s_waitcnt lgkmcnt(3)
  v_mfma_f32_16x16x32_bf16 v[136:139], a[96:99], v[184:187], v[136:139]
  ds_read_b128 v[168:171], v17 offset:4096
  v_mfma_f32_16x16x32_bf16 v[140:143], a[100:103], v[184:187], v[140:143]
  s_add_u32 m0, s31, 35840
  v_mfma_f32_16x16x32_bf16 v[144:147], a[104:107], v[184:187], v[144:147]
  s_waitcnt lgkmcnt(3)
  buffer_load_dwordx4 v13, s[8:11], s30 offen lds
  v_mfma_f32_16x16x32_bf16 v[148:151], a[96:99], v[188:191], v[148:151]
  s_add_u32 s30, s30, 128
  ds_read_b128 v[172:175], v17 offset:6144
  v_mfma_f32_16x16x32_bf16 v[152:155], a[100:103], v[188:191], v[152:155]
  v_mfma_f32_16x16x32_bf16 v[156:159], a[104:107], v[188:191], v[156:159]
  s_waitcnt lgkmcnt(3)
  v_mfma_f32_16x16x32_bf16 v[64:67], a[108:111], v[160:163], v[64:67]
  ds_read_b128 v[176:179], v17 offset:8192
  v_mfma_f32_16x16x32_bf16 v[68:71], a[112:115], v[160:163], v[68:71]
  v_mfma_f32_16x16x32_bf16 v[72:75], a[116:119], v[160:163], v[72:75]
  s_waitcnt lgkmcnt(3)
  v_mfma_f32_16x16x32_bf16 v[76:79], a[108:111], v[164:167], v[76:79]
  ds_read_b128 v[180:183], v17 offset:10240
  v_mfma_f32_16x16x32_bf16 v[80:83], a[112:115], v[164:167], v[80:83]
  v_mfma_f32_16x16x32_bf16 v[84:87], a[116:119], v[164:167], v[84:87]
  s_waitcnt lgkmcnt(3)
  v_mfma_f32_16x16x32_bf16 v[88:91], a[108:111], v[168:171], v[88:91]
  ds_read_b128 v[184:187], v17 offset:12288
  v_mfma_f32_16x16x32_bf16 v[92:95], a[112:115], v[168:171], v[92:95]
  v_mfma_f32_16x16x32_bf16 v[96:99], a[116:119], v[168:171], v[96:99]
  s_waitcnt lgkmcnt(3)
  v_mfma_f32_16x16x32_bf16 v[100:103], a[108:111], v[172:175], v[100:103]
  ds_read_b128 v[188:191], v17 offset:14336
  v_mfma_f32_16x16x32_bf16 v[104:107], a[112:115], v[172:175], v[104:107]
  v_mfma_f32_16x16x32_bf16 v[108:111], a[116:119], v[172:175], v[108:111]
  s_waitcnt lgkmcnt(3)
  v_mfma_f32_16x16x32_bf16 v[112:115], a[108:111], v[176:179], v[112:115]
  s_waitcnt vmcnt(12)
  s_barrier
  ds_read_b128 v[160:163], v16 offset:16384
  v_mfma_f32_16x16x32_bf16 v[116:119], a[112:115], v[176:179], v[116:119]
  buffer_atomic_add v28, v27, s[72:75], s61 offen sc1
  v_mfma_f32_16x16x32_bf16 v[120:123], a[116:119], v[176:179], v[120:123]
  s_waitcnt lgkmcnt(3)
  s_mov_b32 s48, s27
  s_add_u32 s27, s27, 8388608
  v_mfma_f32_16x16x32_bf16 v[124:127], a[108:111], v[180:183], v[124:127]
  s_mov_b32 s61, s60
  ds_read_b128 v[164:167], v16 offset:18432
  s_add_u32 s60, s60, 1024
  v_mfma_f32_16x16x32_bf16 v[128:131], a[112:115], v[180:183], v[128:131]
  v_mfma_f32_16x16x32_bf16 v[132:135], a[116:119], v[180:183], v[132:135]
  s_waitcnt lgkmcnt(3)
  v_mfma_f32_16x16x32_bf16 v[136:139], a[108:111], v[184:187], v[136:139]
  ds_read_b128 v[168:171], v16 offset:20480
  v_mfma_f32_16x16x32_bf16 v[140:143], a[112:115], v[184:187], v[140:143]
  v_mfma_f32_16x16x32_bf16 v[144:147], a[116:119], v[184:187], v[144:147]
  s_waitcnt lgkmcnt(3)
  v_mfma_f32_16x16x32_bf16 v[148:151], a[108:111], v[188:191], v[148:151]
  ds_read_b128 v[172:175], v16 offset:22528
  v_mfma_f32_16x16x32_bf16 v[152:155], a[112:115], v[188:191], v[152:155]
  v_mfma_f32_16x16x32_bf16 v[156:159], a[116:119], v[188:191], v[156:159]
  s_waitcnt lgkmcnt(3)
  v_mfma_f32_16x16x32_bf16 v[64:67], a[120:123], v[160:163], v[64:67]
  ds_read_b128 v[176:179], v16 offset:24576
  v_mfma_f32_16x16x32_bf16 v[68:71], a[124:127], v[160:163], v[68:71]
  s_add_u32 m0, s31, 49152
  v_mfma_f32_16x16x32_bf16 v[72:75], a[128:131], v[160:163], v[72:75]
  s_waitcnt lgkmcnt(3)
  buffer_load_dwordx4 v10, s[8:11], s30 offen lds
  v_mfma_f32_16x16x32_bf16 v[76:79], a[120:123], v[164:167], v[76:79]
  ds_read_b128 v[180:183], v16 offset:26624
  v_mfma_f32_16x16x32_bf16 v[80:83], a[124:127], v[164:167], v[80:83]
  v_mfma_f32_16x16x32_bf16 v[84:87], a[128:131], v[164:167], v[84:87]
  s_waitcnt lgkmcnt(3)
  v_mfma_f32_16x16x32_bf16 v[88:91], a[120:123], v[168:171], v[88:91]
  ds_read_b128 v[184:187], v16 offset:28672
  v_mfma_f32_16x16x32_bf16 v[92:95], a[124:127], v[168:171], v[92:95]
  s_add_u32 m0, s31, 50176
  v_mfma_f32_16x16x32_bf16 v[96:99], a[128:131], v[168:171], v[96:99]
  s_waitcnt lgkmcnt(3)
  buffer_load_dwordx4 v11, s[8:11], s30 offen lds
  v_mfma_f32_16x16x32_bf16 v[100:103], a[120:123], v[172:175], v[100:103]
  ds_read_b128 v[188:191], v16 offset:30720
  v_mfma_f32_16x16x32_bf16 v[104:107], a[124:127], v[172:175], v[104:107]
  v_mfma_f32_16x16x32_bf16 v[108:111], a[128:131], v[172:175], v[108:111]
  s_waitcnt lgkmcnt(3)
  v_mfma_f32_16x16x32_bf16 v[112:115], a[120:123], v[176:179], v[112:115]
  ds_read_b128 v[160:163], v17 offset:16384
  v_mfma_f32_16x16x32_bf16 v[116:119], a[124:127], v[176:179], v[116:119]
  s_add_u32 m0, s31, 51200
  v_mfma_f32_16x16x32_bf16 v[120:123], a[128:131], v[176:179], v[120:123]
  s_waitcnt lgkmcnt(3)
  buffer_load_dwordx4 v12, s[8:11], s30 offen lds
  v_mfma_f32_16x16x32_bf16 v[124:127], a[120:123], v[180:183], v[124:127]
  ds_read_b128 v[164:167], v17 offset:18432
  v_mfma_f32_16x16x32_bf16 v[128:131], a[124:127], v[180:183], v[128:131]
  v_mfma_f32_16x16x32_bf16 v[132:135], a[128:131], v[180:183], v[132:135]
  s_waitcnt lgkmcnt(3)
  v_mfma_f32_16x16x32_bf16 v[136:139], a[120:123], v[184:187], v[136:139]
  ds_read_b128 v[168:171], v17 offset:20480
  v_mfma_f32_16x16x32_bf16 v[140:143], a[124:127], v[184:187], v[140:143]
  s_add_u32 m0, s31, 52224
  v_mfma_f32_16x16x32_bf16 v[144:147], a[128:131], v[184:187], v[144:147]
  s_waitcnt lgkmcnt(3)
  buffer_load_dwordx4 v13, s[8:11], s30 offen lds
  v_mfma_f32_16x16x32_bf16 v[148:151], a[120:123], v[188:191], v[148:151]
  s_add_u32 s30, s30, 128
  ds_read_b128 v[172:175], v17 offset:22528
  v_mfma_f32_16x16x32_bf16 v[152:155], a[124:127], v[188:191], v[152:155]
  v_mfma_f32_16x16x32_bf16 v[156:159], a[128:131], v[188:191], v[156:159]
  s_waitcnt lgkmcnt(3)
  v_mfma_f32_16x16x32_bf16 v[64:67], a[132:135], v[160:163], v[64:67]
  ds_read_b128 v[176:179], v17 offset:24576
  v_mfma_f32_16x16x32_bf16 v[68:71], a[136:139], v[160:163], v[68:71]
  v_mfma_f32_16x16x32_bf16 v[72:75], a[140:143], v[160:163], v[72:75]
  s_waitcnt lgkmcnt(3)
  v_mfma_f32_16x16x32_bf16 v[76:79], a[132:135], v[164:167], v[76:79]
  ds_read_b128 v[180:183], v17 offset:26624
  v_mfma_f32_16x16x32_bf16 v[80:83], a[136:139], v[164:167], v[80:83]
  v_mfma_f32_16x16x32_bf16 v[84:87], a[140:143], v[164:167], v[84:87]
  s_waitcnt lgkmcnt(3)
  v_mfma_f32_16x16x32_bf16 v[88:91], a[132:135], v[168:171], v[88:91]
  ds_read_b128 v[184:187], v17 offset:28672
  v_mfma_f32_16x16x32_bf16 v[92:95], a[136:139], v[168:171], v[92:95]
  v_mfma_f32_16x16x32_bf16 v[96:99], a[140:143], v[168:171], v[96:99]
  s_waitcnt lgkmcnt(3)
  v_mfma_f32_16x16x32_bf16 v[100:103], a[132:135], v[172:175], v[100:103]
  ds_read_b128 v[188:191], v17 offset:30720
  v_mfma_f32_16x16x32_bf16 v[104:107], a[136:139], v[172:175], v[104:107]
  v_mfma_f32_16x16x32_bf16 v[108:111], a[140:143], v[172:175], v[108:111]
  s_waitcnt lgkmcnt(3)
  v_mfma_f32_16x16x32_bf16 v[112:115], a[132:135], v[176:179], v[112:115]
  s_waitcnt vmcnt(41)
  s_barrier
  ds_read_b128 v[160:163], v16 offset:32768
  v_mfma_f32_16x16x32_bf16 v[116:119], a[136:139], v[176:179], v[116:119]
  v_mfma_f32_16x16x32_bf16 v[120:123], a[140:143], v[176:179], v[120:123]
  s_waitcnt lgkmcnt(3)
  v_mfma_f32_16x16x32_bf16 v[124:127], a[132:135], v[180:183], v[124:127]
  ds_read_b128 v[164:167], v16 offset:34816
  v_mfma_f32_16x16x32_bf16 v[128:131], a[136:139], v[180:183], v[128:131]
  v_mfma_f32_16x16x32_bf16 v[132:135], a[140:143], v[180:183], v[132:135]
  s_waitcnt lgkmcnt(3)
  v_mfma_f32_16x16x32_bf16 v[136:139], a[132:135], v[184:187], v[136:139]
  ds_read_b128 v[168:171], v16 offset:36864
  v_mfma_f32_16x16x32_bf16 v[140:143], a[136:139], v[184:187], v[140:143]
  v_mfma_f32_16x16x32_bf16 v[144:147], a[140:143], v[184:187], v[144:147]
  s_waitcnt lgkmcnt(3)
  v_mfma_f32_16x16x32_bf16 v[148:151], a[132:135], v[188:191], v[148:151]
  ds_read_b128 v[172:175], v16 offset:38912
  v_mfma_f32_16x16x32_bf16 v[152:155], a[136:139], v[188:191], v[152:155]
  v_mfma_f32_16x16x32_bf16 v[156:159], a[140:143], v[188:191], v[156:159]
  s_waitcnt lgkmcnt(3)
  v_mfma_f32_16x16x32_bf16 v[64:67], a[144:147], v[160:163], v[64:67]
  ds_read_b128 v[176:179], v16 offset:40960
  v_mfma_f32_16x16x32_bf16 v[68:71], a[148:151], v[160:163], v[68:71]
  s_add_u32 m0, s31, 65536
  v_mfma_f32_16x16x32_bf16 v[72:75], a[152:155], v[160:163], v[72:75]
  s_waitcnt lgkmcnt(3)
  buffer_load_dwordx4 v10, s[8:11], s30 offen lds
  v_mfma_f32_16x16x32_bf16 v[76:79], a[144:147], v[164:167], v[76:79]
  ds_read_b128 v[180:183], v16 offset:43008
  v_mfma_f32_16x16x32_bf16 v[80:83], a[148:151], v[164:167], v[80:83]
  v_mfma_f32_16x16x32_bf16 v[84:87], a[152:155], v[164:167], v[84:87]
  s_waitcnt lgkmcnt(3)
  v_mfma_f32_16x16x32_bf16 v[88:91], a[144:147], v[168:171], v[88:91]
  ds_read_b128 v[184:187], v16 offset:45056
  v_mfma_f32_16x16x32_bf16 v[92:95], a[148:151], v[168:171], v[92:95]
  s_add_u32 m0, s31, 66560
  v_mfma_f32_16x16x32_bf16 v[96:99], a[152:155], v[168:171], v[96:99]
  s_waitcnt lgkmcnt(3)
  buffer_load_dwordx4 v11, s[8:11], s30 offen lds
  v_mfma_f32_16x16x32_bf16 v[100:103], a[144:147], v[172:175], v[100:103]
  ds_read_b128 v[188:191], v16 offset:47104
  v_mfma_f32_16x16x32_bf16 v[104:107], a[148:151], v[172:175], v[104:107]
  v_mfma_f32_16x16x32_bf16 v[108:111], a[152:155], v[172:175], v[108:111]
  s_waitcnt lgkmcnt(3)
  v_mfma_f32_16x16x32_bf16 v[112:115], a[144:147], v[176:179], v[112:115]
  ds_read_b128 v[160:163], v17 offset:32768
  v_mfma_f32_16x16x32_bf16 v[116:119], a[148:151], v[176:179], v[116:119]
  s_add_u32 m0, s31, 67584
  v_mfma_f32_16x16x32_bf16 v[120:123], a[152:155], v[176:179], v[120:123]
  s_waitcnt lgkmcnt(3)
  buffer_load_dwordx4 v12, s[8:11], s30 offen lds
  v_mfma_f32_16x16x32_bf16 v[124:127], a[144:147], v[180:183], v[124:127]
  ds_read_b128 v[164:167], v17 offset:34816
  v_mfma_f32_16x16x32_bf16 v[128:131], a[148:151], v[180:183], v[128:131]
  v_mfma_f32_16x16x32_bf16 v[132:135], a[152:155], v[180:183], v[132:135]
  s_waitcnt lgkmcnt(3)
  v_mfma_f32_16x16x32_bf16 v[136:139], a[144:147], v[184:187], v[136:139]
  ds_read_b128 v[168:171], v17 offset:36864
  v_mfma_f32_16x16x32_bf16 v[140:143], a[148:151], v[184:187], v[140:143]
  s_add_u32 m0, s31, 68608
  v_mfma_f32_16x16x32_bf16 v[144:147], a[152:155], v[184:187], v[144:147]
  s_waitcnt lgkmcnt(3)
  buffer_load_dwordx4 v13, s[8:11], s30 offen lds
  v_mfma_f32_16x16x32_bf16 v[148:151], a[144:147], v[188:191], v[148:151]
  s_add_u32 s30, s30, 128
  ds_read_b128 v[172:175], v17 offset:38912
  v_mfma_f32_16x16x32_bf16 v[152:155], a[148:151], v[188:191], v[152:155]
  v_mfma_f32_16x16x32_bf16 v[156:159], a[152:155], v[188:191], v[156:159]
  s_waitcnt lgkmcnt(3)
  v_mfma_f32_16x16x32_bf16 v[64:67], a[156:159], v[160:163], v[64:67]
  ds_read_b128 v[176:179], v17 offset:40960
  v_mfma_f32_16x16x32_bf16 v[68:71], a[160:163], v[160:163], v[68:71]
  v_mfma_f32_16x16x32_bf16 v[72:75], a[164:167], v[160:163], v[72:75]
  s_waitcnt lgkmcnt(3)
  v_mfma_f32_16x16x32_bf16 v[76:79], a[156:159], v[164:167], v[76:79]
  ds_read_b128 v[180:183], v17 offset:43008
  v_mfma_f32_16x16x32_bf16 v[80:83], a[160:163], v[164:167], v[80:83]
  v_mfma_f32_16x16x32_bf16 v[84:87], a[164:167], v[164:167], v[84:87]
  s_waitcnt lgkmcnt(3)
  v_mfma_f32_16x16x32_bf16 v[88:91], a[156:159], v[168:171], v[88:91]
  ds_read_b128 v[184:187], v17 offset:45056
  v_mfma_f32_16x16x32_bf16 v[92:95], a[160:163], v[168:171], v[92:95]
  v_mfma_f32_16x16x32_bf16 v[96:99], a[164:167], v[168:171], v[96:99]
  s_waitcnt lgkmcnt(3)
  v_mfma_f32_16x16x32_bf16 v[100:103], a[156:159], v[172:175], v[100:103]
  ds_read_b128 v[188:191], v17 offset:47104
  v_mfma_f32_16x16x32_bf16 v[104:107], a[160:163], v[172:175], v[104:107]
  v_mfma_f32_16x16x32_bf16 v[108:111], a[164:167], v[172:175], v[108:111]
  s_waitcnt lgkmcnt(3)
  v_mfma_f32_16x16x32_bf16 v[112:115], a[156:159], v[176:179], v[112:115]
  s_waitcnt vmcnt(41)
  s_barrier
  ds_read_b128 v[160:163], v16 offset:49152
  v_mfma_f32_16x16x32_bf16 v[116:119], a[160:163], v[176:179], v[116:119]
  v_mfma_f32_16x16x32_bf16 v[120:123], a[164:167], v[176:179], v[120:123]
  s_waitcnt lgkmcnt(3)
  v_mfma_f32_16x16x32_bf16 v[124:127], a[156:159], v[180:183], v[124:127]
  ds_read_b128 v[164:167], v16 offset:51200
  v_mfma_f32_16x16x32_bf16 v[128:131], a[160:163], v[180:183], v[128:131]
  v_mfma_f32_16x16x32_bf16 v[132:135], a[164:167], v[180:183], v[132:135]
  s_waitcnt lgkmcnt(3)
  v_mfma_f32_16x16x32_bf16 v[136:139], a[156:159], v[184:187], v[136:139]
  ds_read_b128 v[168:171], v16 offset:53248
  v_mfma_f32_16x16x32_bf16 v[140:143], a[160:163], v[184:187], v[140:143]
  v_mfma_f32_16x16x32_bf16 v[144:147], a[164:167], v[184:187], v[144:147]
  s_waitcnt lgkmcnt(3)
  v_mfma_f32_16x16x32_bf16 v[148:151], a[156:159], v[188:191], v[148:151]
  ds_read_b128 v[172:175], v16 offset:55296
  v_mfma_f32_16x16x32_bf16 v[152:155], a[160:163], v[188:191], v[152:155]
  v_mfma_f32_16x16x32_bf16 v[156:159], a[164:167], v[188:191], v[156:159]
  s_waitcnt lgkmcnt(3)
  v_mfma_f32_16x16x32_bf16 v[64:67], a[168:171], v[160:163], v[64:67]
  ds_read_b128 v[176:179], v16 offset:57344
  v_mfma_f32_16x16x32_bf16 v[68:71], a[172:175], v[160:163], v[68:71]
  s_add_u32 m0, s31, 81920
  v_mfma_f32_16x16x32_bf16 v[72:75], a[176:179], v[160:163], v[72:75]
  s_waitcnt lgkmcnt(3)
  buffer_load_dwordx4 v10, s[8:11], s30 offen lds
  v_mfma_f32_16x16x32_bf16 v[76:79], a[168:171], v[164:167], v[76:79]
  ds_read_b128 v[180:183], v16 offset:59392
  v_mfma_f32_16x16x32_bf16 v[80:83], a[172:175], v[164:167], v[80:83]
  v_mfma_f32_16x16x32_bf16 v[84:87], a[176:179], v[164:167], v[84:87]
  s_waitcnt lgkmcnt(3)
  v_mfma_f32_16x16x32_bf16 v[88:91], a[168:171], v[168:171], v[88:91]
  ds_read_b128 v[184:187], v16 offset:61440
  v_mfma_f32_16x16x32_bf16 v[92:95], a[172:175], v[168:171], v[92:95]
  s_add_u32 m0, s31, 82944
  v_mfma_f32_16x16x32_bf16 v[96:99], a[176:179], v[168:171], v[96:99]
  s_waitcnt lgkmcnt(3)
  buffer_load_dwordx4 v11, s[8:11], s30 offen lds
  v_mfma_f32_16x16x32_bf16 v[100:103], a[168:171], v[172:175], v[100:103]
  ds_read_b128 v[188:191], v16 offset:63488
  v_mfma_f32_16x16x32_bf16 v[104:107], a[172:175], v[172:175], v[104:107]
  v_mfma_f32_16x16x32_bf16 v[108:111], a[176:179], v[172:175], v[108:111]
  s_waitcnt lgkmcnt(3)
  v_mfma_f32_16x16x32_bf16 v[112:115], a[168:171], v[176:179], v[112:115]
  ds_read_b128 v[160:163], v17 offset:49152
  v_mfma_f32_16x16x32_bf16 v[116:119], a[172:175], v[176:179], v[116:119]
  s_add_u32 m0, s31, 83968
  v_mfma_f32_16x16x32_bf16 v[120:123], a[176:179], v[176:179], v[120:123]
  s_waitcnt lgkmcnt(3)
  buffer_load_dwordx4 v12, s[8:11], s30 offen lds
  v_mfma_f32_16x16x32_bf16 v[124:127], a[168:171], v[180:183], v[124:127]
  ds_read_b128 v[164:167], v17 offset:51200
  v_mfma_f32_16x16x32_bf16 v[128:131], a[172:175], v[180:183], v[128:131]
  v_mfma_f32_16x16x32_bf16 v[132:135], a[176:179], v[180:183], v[132:135]
  s_waitcnt lgkmcnt(3)
  v_mfma_f32_16x16x32_bf16 v[136:139], a[168:171], v[184:187], v[136:139]
  ds_read_b128 v[168:171], v17 offset:53248
  v_mfma_f32_16x16x32_bf16 v[140:143], a[172:175], v[184:187], v[140:143]
  s_add_u32 m0, s31, 84992
  v_mfma_f32_16x16x32_bf16 v[144:147], a[176:179], v[184:187], v[144:147]
  s_waitcnt lgkmcnt(3)
  buffer_load_dwordx4 v13, s[8:11], s30 offen lds
  v_mfma_f32_16x16x32_bf16 v[148:151], a[168:171], v[188:191], v[148:151]
  s_add_u32 s30, s30, 128
  ds_read_b128 v[172:175], v17 offset:55296
  v_mfma_f32_16x16x32_bf16 v[152:155], a[172:175], v[188:191], v[152:155]
  v_mfma_f32_16x16x32_bf16 v[156:159], a[176:179], v[188:191], v[156:159]
  s_waitcnt lgkmcnt(3)
  v_mfma_f32_16x16x32_bf16 v[64:67], a[180:183], v[160:163], v[64:67]
  ds_read_b128 v[176:179], v17 offset:57344
  v_mfma_f32_16x16x32_bf16 v[68:71], a[184:187], v[160:163], v[68:71]
  v_mfma_f32_16x16x32_bf16 v[72:75], a[188:191], v[160:163], v[72:75]
  s_waitcnt lgkmcnt(3)
  v_mfma_f32_16x16x32_bf16 v[76:79], a[180:183], v[164:167], v[76:79]
  ds_read_b128 v[180:183], v17 offset:59392
  v_mfma_f32_16x16x32_bf16 v[80:83], a[184:187], v[164:167], v[80:83]
  v_mfma_f32_16x16x32_bf16 v[84:87], a[188:191], v[164:167], v[84:87]
  s_waitcnt lgkmcnt(3)
  v_mfma_f32_16x16x32_bf16 v[88:91], a[180:183], v[168:171], v[88:91]
  ds_read_b128 v[184:187], v17 offset:61440
  v_mfma_f32_16x16x32_bf16 v[92:95], a[184:187], v[168:171], v[92:95]
  v_mfma_f32_16x16x32_bf16 v[96:99], a[188:191], v[168:171], v[96:99]
  s_waitcnt lgkmcnt(3)
  v_mfma_f32_16x16x32_bf16 v[100:103], a[180:183], v[172:175], v[100:103]
  ds_read_b128 v[188:191], v17 offset:63488
  v_mfma_f32_16x16x32_bf16 v[104:107], a[184:187], v[172:175], v[104:107]
  v_mfma_f32_16x16x32_bf16 v[108:111], a[188:191], v[172:175], v[108:111]
  s_waitcnt lgkmcnt(3)
  v_mfma_f32_16x16x32_bf16 v[112:115], a[180:183], v[176:179], v[112:115]
  s_waitcnt vmcnt(37)
  s_barrier
  ds_read_b128 v[160:163], v18 offset:0
  v_mfma_f32_16x16x32_bf16 v[116:119], a[184:187], v[176:179], v[116:119]
  v_mfma_f32_16x16x32_bf16 v[120:123], a[188:191], v[176:179], v[120:123]
  s_waitcnt lgkmcnt(3)
  v_mfma_f32_16x16x32_bf16 v[124:127], a[180:183], v[180:183], v[124:127]
  ds_read_b128 v[164:167], v18 offset:2048
  v_mfma_f32_16x16x32_bf16 v[128:131], a[184:187], v[180:183], v[128:131]
  v_mfma_f32_16x16x32_bf16 v[132:135], a[188:191], v[180:183], v[132:135]
  s_waitcnt lgkmcnt(3)
  v_mfma_f32_16x16x32_bf16 v[136:139], a[180:183], v[184:187], v[136:139]
  ds_read_b128 v[168:171], v18 offset:4096
  v_mfma_f32_16x16x32_bf16 v[140:143], a[184:187], v[184:187], v[140:143]
  v_mfma_f32_16x16x32_bf16 v[144:147], a[188:191], v[184:187], v[144:147]
  s_waitcnt lgkmcnt(3)
  v_mfma_f32_16x16x32_bf16 v[148:151], a[180:183], v[188:191], v[148:151]
  ds_read_b128 v[172:175], v18 offset:6144
  v_mfma_f32_16x16x32_bf16 v[152:155], a[184:187], v[188:191], v[152:155]
  v_mfma_f32_16x16x32_bf16 v[156:159], a[188:191], v[188:191], v[156:159]
  s_waitcnt lgkmcnt(3)
  v_mfma_f32_16x16x32_bf16 v[64:67], a[192:195], v[160:163], v[64:67]
  ds_read_b128 v[176:179], v18 offset:8192
  v_mfma_f32_16x16x32_bf16 v[68:71], a[196:199], v[160:163], v[68:71]
  s_add_u32 m0, s31, 98304
  v_mfma_f32_16x16x32_bf16 v[72:75], a[200:203], v[160:163], v[72:75]
  s_waitcnt lgkmcnt(3)
  buffer_load_dwordx4 v10, s[8:11], s30 offen lds
  v_mfma_f32_16x16x32_bf16 v[76:79], a[192:195], v[164:167], v[76:79]
  ds_read_b128 v[180:183], v18 offset:10240
  v_mfma_f32_16x16x32_bf16 v[80:83], a[196:199], v[164:167], v[80:83]
  v_mfma_f32_16x16x32_bf16 v[84:87], a[200:203], v[164:167], v[84:87]
  s_waitcnt lgkmcnt(3)
  v_mfma_f32_16x16x32_bf16 v[88:91], a[192:195], v[168:171], v[88:91]
  ds_read_b128 v[184:187], v18 offset:12288
  v_mfma_f32_16x16x32_bf16 v[92:95], a[196:199], v[168:171], v[92:95]
  s_add_u32 m0, s31, 99328
  v_mfma_f32_16x16x32_bf16 v[96:99], a[200:203], v[168:171], v[96:99]
  s_waitcnt lgkmcnt(3)
  buffer_load_dwordx4 v11, s[8:11], s30 offen lds
  v_mfma_f32_16x16x32_bf16 v[100:103], a[192:195], v[172:175], v[100:103]
  ds_read_b128 v[188:191], v18 offset:14336
  v_mfma_f32_16x16x32_bf16 v[104:107], a[196:199], v[172:175], v[104:107]
  v_mfma_f32_16x16x32_bf16 v[108:111], a[200:203], v[172:175], v[108:111]
  s_waitcnt lgkmcnt(3)
  v_mfma_f32_16x16x32_bf16 v[112:115], a[192:195], v[176:179], v[112:115]
  ds_read_b128 v[160:163], v19 offset:0
  v_mfma_f32_16x16x32_bf16 v[116:119], a[196:199], v[176:179], v[116:119]
  s_add_u32 m0, s31, 100352
  v_mfma_f32_16x16x32_bf16 v[120:123], a[200:203], v[176:179], v[120:123]
  s_waitcnt lgkmcnt(3)
  buffer_load_dwordx4 v12, s[8:11], s30 offen lds
  v_mfma_f32_16x16x32_bf16 v[124:127], a[192:195], v[180:183], v[124:127]
  ds_read_b128 v[164:167], v19 offset:2048
  v_mfma_f32_16x16x32_bf16 v[128:131], a[196:199], v[180:183], v[128:131]
  v_mfma_f32_16x16x32_bf16 v[132:135], a[200:203], v[180:183], v[132:135]
  s_waitcnt lgkmcnt(3)
  v_mfma_f32_16x16x32_bf16 v[136:139], a[192:195], v[184:187], v[136:139]
  ds_read_b128 v[168:171], v19 offset:4096
  v_mfma_f32_16x16x32_bf16 v[140:143], a[196:199], v[184:187], v[140:143]
  s_add_u32 m0, s31, 101376
  v_mfma_f32_16x16x32_bf16 v[144:147], a[200:203], v[184:187], v[144:147]
  s_waitcnt lgkmcnt(3)
  buffer_load_dwordx4 v13, s[8:11], s30 offen lds
  v_mfma_f32_16x16x32_bf16 v[148:151], a[192:195], v[188:191], v[148:151]
  s_add_u32 s30, s30, 128
  ds_read_b128 v[172:175], v19 offset:6144
  v_mfma_f32_16x16x32_bf16 v[152:155], a[196:199], v[188:191], v[152:155]
  v_mfma_f32_16x16x32_bf16 v[156:159], a[200:203], v[188:191], v[156:159]
  s_waitcnt lgkmcnt(3)
  v_mfma_f32_16x16x32_bf16 v[64:67], a[204:207], v[160:163], v[64:67]
  ds_read_b128 v[176:179], v19 offset:8192
  v_mfma_f32_16x16x32_bf16 v[68:71], a[208:211], v[160:163], v[68:71]
  v_mfma_f32_16x16x32_bf16 v[72:75], a[212:215], v[160:163], v[72:75]
  s_waitcnt lgkmcnt(3)
  v_mfma_f32_16x16x32_bf16 v[76:79], a[204:207], v[164:167], v[76:79]
  ds_read_b128 v[180:183], v19 offset:10240
  v_mfma_f32_16x16x32_bf16 v[80:83], a[208:211], v[164:167], v[80:83]
  v_mfma_f32_16x16x32_bf16 v[84:87], a[212:215], v[164:167], v[84:87]
  s_waitcnt lgkmcnt(3)
  v_mfma_f32_16x16x32_bf16 v[88:91], a[204:207], v[168:171], v[88:91]
  ds_read_b128 v[184:187], v19 offset:12288
  v_mfma_f32_16x16x32_bf16 v[92:95], a[208:211], v[168:171], v[92:95]
  v_mfma_f32_16x16x32_bf16 v[96:99], a[212:215], v[168:171], v[96:99]
  s_waitcnt lgkmcnt(3)
  v_mfma_f32_16x16x32_bf16 v[100:103], a[204:207], v[172:175], v[100:103]
  ds_read_b128 v[188:191], v19 offset:14336
  v_mfma_f32_16x16x32_bf16 v[104:107], a[208:211], v[172:175], v[104:107]
  v_mfma_f32_16x16x32_bf16 v[108:111], a[212:215], v[172:175], v[108:111]
  s_waitcnt lgkmcnt(3)
  v_mfma_f32_16x16x32_bf16 v[112:115], a[204:207], v[176:179], v[112:115]
  s_waitcnt vmcnt(32)
  s_barrier
  ds_read_b128 v[160:163], v18 offset:16384
  v_mfma_f32_16x16x32_bf16 v[116:119], a[208:211], v[176:179], v[116:119]
  v_mfma_f32_16x16x32_bf16 v[120:123], a[212:215], v[176:179], v[120:123]
  s_waitcnt lgkmcnt(3)
  v_mfma_f32_16x16x32_bf16 v[124:127], a[204:207], v[180:183], v[124:127]
  ds_read_b128 v[164:167], v18 offset:18432
  v_mfma_f32_16x16x32_bf16 v[128:131], a[208:211], v[180:183], v[128:131]
  v_mfma_f32_16x16x32_bf16 v[132:135], a[212:215], v[180:183], v[132:135]
  s_waitcnt lgkmcnt(3)
  v_mfma_f32_16x16x32_bf16 v[136:139], a[204:207], v[184:187], v[136:139]
  ds_read_b128 v[168:171], v18 offset:20480
  v_mfma_f32_16x16x32_bf16 v[140:143], a[208:211], v[184:187], v[140:143]
  v_mfma_f32_16x16x32_bf16 v[144:147], a[212:215], v[184:187], v[144:147]
  s_waitcnt lgkmcnt(3)
  v_mfma_f32_16x16x32_bf16 v[148:151], a[204:207], v[188:191], v[148:151]
  ds_read_b128 v[172:175], v18 offset:22528
  v_mfma_f32_16x16x32_bf16 v[152:155], a[208:211], v[188:191], v[152:155]
  v_mfma_f32_16x16x32_bf16 v[156:159], a[212:215], v[188:191], v[156:159]
  s_waitcnt lgkmcnt(3)
  v_mfma_f32_16x16x32_bf16 v[64:67], a[216:219], v[160:163], v[64:67]
  ds_read_b128 v[176:179], v18 offset:24576
  v_mfma_f32_16x16x32_bf16 v[68:71], a[220:223], v[160:163], v[68:71]
  s_add_u32 m0, s31, 114688
  v_mfma_f32_16x16x32_bf16 v[72:75], a[224:227], v[160:163], v[72:75]
  s_waitcnt lgkmcnt(3)
  buffer_load_dwordx4 v10, s[8:11], s30 offen lds
  v_mfma_f32_16x16x32_bf16 v[76:79], a[216:219], v[164:167], v[76:79]
  ds_read_b128 v[180:183], v18 offset:26624
  v_mfma_f32_16x16x32_bf16 v[80:83], a[220:223], v[164:167], v[80:83]
  v_mfma_f32_16x16x32_bf16 v[84:87], a[224:227], v[164:167], v[84:87]
  s_waitcnt lgkmcnt(3)
  v_mfma_f32_16x16x32_bf16 v[88:91], a[216:219], v[168:171], v[88:91]
  ds_read_b128 v[184:187], v18 offset:28672
  v_mfma_f32_16x16x32_bf16 v[92:95], a[220:223], v[168:171], v[92:95]
  s_add_u32 m0, s31, 115712
  v_mfma_f32_16x16x32_bf16 v[96:99], a[224:227], v[168:171], v[96:99]
  s_waitcnt lgkmcnt(3)
  buffer_load_dwordx4 v11, s[8:11], s30 offen lds
  v_mfma_f32_16x16x32_bf16 v[100:103], a[216:219], v[172:175], v[100:103]
  ds_read_b128 v[188:191], v18 offset:30720
  v_mfma_f32_16x16x32_bf16 v[104:107], a[220:223], v[172:175], v[104:107]
  v_mfma_f32_16x16x32_bf16 v[108:111], a[224:227], v[172:175], v[108:111]
  s_waitcnt lgkmcnt(3)
  v_mfma_f32_16x16x32_bf16 v[112:115], a[216:219], v[176:179], v[112:115]
  ds_read_b128 v[160:163], v19 offset:16384
  v_mfma_f32_16x16x32_bf16 v[116:119], a[220:223], v[176:179], v[116:119]
  s_add_u32 m0, s31, 116736
  v_mfma_f32_16x16x32_bf16 v[120:123], a[224:227], v[176:179], v[120:123]
  s_waitcnt lgkmcnt(3)
  buffer_load_dwordx4 v12, s[8:11], s30 offen lds
  v_mfma_f32_16x16x32_bf16 v[124:127], a[216:219], v[180:183], v[124:127]
  ds_read_b128 v[164:167], v19 offset:18432
  v_mfma_f32_16x16x32_bf16 v[128:131], a[220:223], v[180:183], v[128:131]
  v_mfma_f32_16x16x32_bf16 v[132:135], a[224:227], v[180:183], v[132:135]
  s_waitcnt lgkmcnt(3)
  v_mfma_f32_16x16x32_bf16 v[136:139], a[216:219], v[184:187], v[136:139]
  ds_read_b128 v[168:171], v19 offset:20480
  v_mfma_f32_16x16x32_bf16 v[140:143], a[220:223], v[184:187], v[140:143]
  s_add_u32 m0, s31, 117760
  v_mfma_f32_16x16x32_bf16 v[144:147], a[224:227], v[184:187], v[144:147]
  s_waitcnt lgkmcnt(3)
  buffer_load_dwordx4 v13, s[8:11], s30 offen lds
  v_mfma_f32_16x16x32_bf16 v[148:151], a[216:219], v[188:191], v[148:151]
  s_add_u32 s30, s30, 128
  ds_read_b128 v[172:175], v19 offset:22528
  v_mfma_f32_16x16x32_bf16 v[152:155], a[220:223], v[188:191], v[152:155]
  v_mfma_f32_16x16x32_bf16 v[156:159], a[224:227], v[188:191], v[156:159]
  s_waitcnt lgkmcnt(3)
  v_mfma_f32_16x16x32_bf16 v[64:67], a[228:231], v[160:163], v[64:67]
  ds_read_b128 v[176:179], v19 offset:24576
  v_mfma_f32_16x16x32_bf16 v[68:71], a[232:235], v[160:163], v[68:71]
  v_mfma_f32_16x16x32_bf16 v[72:75], a[236:239], v[160:163], v[72:75]
  s_waitcnt lgkmcnt(3)
  v_mfma_f32_16x16x32_bf16 v[76:79], a[228:231], v[164:167], v[76:79]
  ds_read_b128 v[180:183], v19 offset:26624
  v_cvt_pk_bf16_f32 v192, v64, v65
  v_mfma_f32_16x16x32_bf16 v[80:83], a[232:235], v[164:167], v[80:83]
  v_cvt_pk_bf16_f32 v193, v66, v67
  v_cvt_pk_bf16_f32 v194, v68, v69
  v_mfma_f32_16x16x32_bf16 v[84:87], a[236:239], v[164:167], v[84:87]
  s_waitcnt lgkmcnt(3)
  v_cvt_pk_bf16_f32 v195, v70, v71
  v_cvt_pk_bf16_f32 v200, v72, v73
  v_mfma_f32_16x16x32_bf16 v[88:91], a[228:231], v[168:171], v[88:91]
  ds_read_b128 v[184:187], v19 offset:28672
  v_cvt_pk_bf16_f32 v201, v74, v75
  v_mfma_f32_16x16x32_bf16 v[92:95], a[232:235], v[168:171], v[92:95]
  v_cvt_pk_bf16_f32 v196, v76, v77
  v_cvt_pk_bf16_f32 v197, v78, v79
  v_mfma_f32_16x16x32_bf16 v[96:99], a[236:239], v[168:171], v[96:99]
  s_waitcnt lgkmcnt(3)
  v_cvt_pk_bf16_f32 v198, v80, v81
  v_cvt_pk_bf16_f32 v199, v82, v83
  v_mfma_f32_16x16x32_bf16 v[100:103], a[228:231], v[172:175], v[100:103]
  ds_read_b128 v[188:191], v19 offset:30720
  v_cvt_pk_bf16_f32 v202, v84, v85
  v_mfma_f32_16x16x32_bf16 v[104:107], a[232:235], v[172:175], v[104:107]
  v_cvt_pk_bf16_f32 v203, v86, v87
  v_cvt_pk_bf16_f32 v204, v88, v89
  v_mfma_f32_16x16x32_bf16 v[108:111], a[236:239], v[172:175], v[108:111]
  s_waitcnt lgkmcnt(3)
  v_cvt_pk_bf16_f32 v205, v90, v91
  v_cvt_pk_bf16_f32 v206, v92, v93
  v_mfma_f32_16x16x32_bf16 v[112:115], a[228:231], v[176:179], v[112:115]
  s_waitcnt vmcnt(29)
  s_barrier
  ds_read_b128 v[160:163], v14 offset:0
  v_mfma_f32_16x16x32_bf16 v[116:119], a[232:235], v[176:179], v[116:119]
  v_cvt_pk_bf16_f32 v207, v94, v95
  v_cvt_pk_bf16_f32 v212, v96, v97
  v_mfma_f32_16x16x32_bf16 v[120:123], a[236:239], v[176:179], v[120:123]
  s_waitcnt lgkmcnt(3)
  v_cvt_pk_bf16_f32 v213, v98, v99
  v_cvt_pk_bf16_f32 v208, v100, v101
  v_mfma_f32_16x16x32_bf16 v[124:127], a[228:231], v[180:183], v[124:127]
  ds_read_b128 v[164:167], v14 offset:2048
  v_cvt_pk_bf16_f32 v209, v102, v103
  v_mfma_f32_16x16x32_bf16 v[128:131], a[232:235], v[180:183], v[128:131]
  v_cvt_pk_bf16_f32 v210, v104, v105
  v_cvt_pk_bf16_f32 v211, v106, v107
  v_mfma_f32_16x16x32_bf16 v[132:135], a[236:239], v[180:183], v[132:135]
  s_waitcnt lgkmcnt(3)
  v_cvt_pk_bf16_f32 v214, v108, v109
  v_cvt_pk_bf16_f32 v215, v110, v111
  v_mfma_f32_16x16x32_bf16 v[136:139], a[228:231], v[184:187], v[136:139]
  ds_read_b128 v[168:171], v14 offset:4096
  v_cvt_pk_bf16_f32 v216, v112, v113
  v_mfma_f32_16x16x32_bf16 v[140:143], a[232:235], v[184:187], v[140:143]
  v_cvt_pk_bf16_f32 v217, v114, v115
  v_cvt_pk_bf16_f32 v218, v116, v117
  v_mfma_f32_16x16x32_bf16 v[144:147], a[236:239], v[184:187], v[144:147]
  s_waitcnt lgkmcnt(3)
  v_cvt_pk_bf16_f32 v219, v118, v119
  v_cvt_pk_bf16_f32 v224, v120, v121
  v_mfma_f32_16x16x32_bf16 v[148:151], a[228:231], v[188:191], v[148:151]
  ds_read_b128 v[172:175], v14 offset:6144
  v_cvt_pk_bf16_f32 v225, v122, v123
  v_mfma_f32_16x16x32_bf16 v[152:155], a[232:235], v[188:191], v[152:155]
  s_sub_u32 s26, s26, 1
  s_cmp_gt_u32 s26, 0
  v_cvt_pk_bf16_f32 v220, v124, v125
  v_mfma_f32_16x16x32_bf16 v[156:159], a[236:239], v[188:191], v[156:159]
  s_waitcnt lgkmcnt(3)
  s_cbranch_scc1 kvs_197
  s_nop 7
  v_cvt_pk_bf16_f32 v221, v126, v127
  v_cvt_pk_bf16_f32 v222, v128, v129
  v_cvt_pk_bf16_f32 v223, v130, v131
  v_cvt_pk_bf16_f32 v226, v132, v133
  v_cvt_pk_bf16_f32 v227, v134, v135
  v_cvt_pk_bf16_f32 v228, v136, v137
  v_cvt_pk_bf16_f32 v229, v138, v139
  v_cvt_pk_bf16_f32 v230, v140, v141
  v_cvt_pk_bf16_f32 v231, v142, v143
  v_cvt_pk_bf16_f32 v236, v144, v145
  v_cvt_pk_bf16_f32 v237, v146, v147
  v_cvt_pk_bf16_f32 v232, v148, v149
  v_cvt_pk_bf16_f32 v233, v150, v151
  v_cvt_pk_bf16_f32 v234, v152, v153
  v_cvt_pk_bf16_f32 v235, v154, v155
  v_cvt_pk_bf16_f32 v238, v156, v157
  v_cvt_pk_bf16_f32 v239, v158, v159
  s_xor_b32 s29, s48, 0
  buffer_store_dwordx4 v[192:195], v26, s[16:19], s29 offen offset:0 sc1
  buffer_store_dwordx4 v[196:199], v26, s[16:19], s29 offen offset:1024 sc1
  buffer_store_dwordx4 v[200:203], v26, s[16:19], s29 offen offset:2048 sc1
  s_xor_b32 s29, s48, 2105344
  buffer_store_dwordx4 v[204:207], v26, s[16:19], s29 offen offset:0 sc1
  buffer_store_dwordx4 v[208:211], v26, s[16:19], s29 offen offset:1024 sc1
  buffer_store_dwordx4 v[212:215], v26, s[16:19], s29 offen offset:2048 sc1
  s_xor_b32 s29, s48, 4194304
  buffer_store_dwordx4 v[216:219], v26, s[16:19], s29 offen offset:0 sc1
  buffer_store_dwordx4 v[220:223], v26, s[16:19], s29 offen offset:1024 sc1
  buffer_store_dwordx4 v[224:227], v26, s[16:19], s29 offen offset:2048 sc1
  s_xor_b32 s29, s48, 6299648
  buffer_store_dwordx4 v[228:231], v26, s[16:19], s29 offen offset:0 sc1
  buffer_store_dwordx4 v[232:235], v26, s[16:19], s29 offen offset:1024 sc1
  buffer_store_dwordx4 v[236:239], v26, s[16:19], s29 offen offset:2048 sc1
  s_waitcnt vmcnt(0) lgkmcnt(0)
  s_barrier
  buffer_atomic_add v28, v27, s[72:75], s61 offen sc1
  s_branch queue
not_kv:
  s_cmp_ge_u32 s3, 96
  s_cbranch_scc1 not_vw
  s_sub_u32 s2, s3, 64
  s_load_dwordx2 s[6:7], s[0:1], 40
  s_load_dwordx2 s[38:39], s[0:1], 104
  v_lshlrev_b32 v4, 4, v1
  s_waitcnt lgkmcnt(0)
  s_mov_b32 s12, s6
  s_mov_b32 s13, s7
  s_mov_b32 s14, 7864320
  s_mov_b32 s15, 0x00020000
  s_mov_b32 s16, s38
  s_mov_b32 s17, s39
  s_mov_b32 s18, 167772160
  s_mov_b32 s19, 0x00020000
  s_add_u32 s72, s38, 170983424
  s_addc_u32 s73, s39, 0
  s_mov_b32 s74, 96768
  s_mov_b32 s75, 0x00020000
  s_mul_i32 s40, s2, 245760
  s_mul_i32 s22, s20, 30720
  s_add_u32 s40, s40, s22
  s_add_u32 m0, s22, 0
  s_add_u32 s21, s40, 0
  buffer_load_dwordx4 v4, s[12:15], s21 offen offset:0 lds
  buffer_load_dwordx4 v4, s[12:15], s21 offen offset:1024 lds
  buffer_load_dwordx4 v4, s[12:15], s21 offen offset:2048 lds
  buffer_load_dwordx4 v4, s[12:15], s21 offen offset:3072 lds
  s_add_u32 m0, s22, 4096
  s_add_u32 s21, s40, 4096
  buffer_load_dwordx4 v4, s[12:15], s21 offen offset:0 lds
  buffer_load_dwordx4 v4, s[12:15], s21 offen offset:1024 lds
  buffer_load_dwordx4 v4, s[12:15], s21 offen offset:2048 lds
  buffer_load_dwordx4 v4, s[12:15], s21 offen offset:3072 lds
  s_add_u32 m0, s22, 8192
  s_add_u32 s21, s40, 8192
  buffer_load_dwordx4 v4, s[12:15], s21 offen offset:0 lds
  buffer_load_dwordx4 v4, s[12:15], s21 offen offset:1024 lds
  buffer_load_dwordx4 v4, s[12:15], s21 offen offset:2048 lds
  buffer_load_dwordx4 v4, s[12:15], s21 offen offset:3072 lds
  s_add_u32 m0, s22, 12288
  s_add_u32 s21, s40, 12288
  buffer_load_dwordx4 v4, s[12:15], s21 offen offset:0 lds
  buffer_load_dwordx4 v4, s[12:15], s21 offen offset:1024 lds
  buffer_load_dwordx4 v4, s[12:15], s21 offen offset:2048 lds
  buffer_load_dwordx4 v4, s[12:15], s21 offen offset:3072 lds
  s_add_u32 m0, s22, 16384
  s_add_u32 s21, s40, 16384
  buffer_load_dwordx4 v4, s[12:15], s21 offen offset:0 lds
  buffer_load_dwordx4 v4, s[12:15], s21 offen offset:1024 lds
  buffer_load_dwordx4 v4, s[12:15], s21 offen offset:2048 lds
  buffer_load_dwordx4 v4, s[12:15], s21 offen offset:3072 lds
  s_add_u32 m0, s22, 20480
  s_add_u32 s21, s40, 20480
  buffer_load_dwordx4 v4, s[12:15], s21 offen offset:0 lds
  buffer_load_dwordx4 v4, s[12:15], s21 offen offset:1024 lds
  buffer_load_dwordx4 v4, s[12:15], s21 offen offset:2048 lds
  buffer_load_dwordx4 v4, s[12:15], s21 offen offset:3072 lds
  s_add_u32 m0, s22, 24576
  s_add_u32 s21, s40, 24576
  buffer_load_dwordx4 v4, s[12:15], s21 offen offset:0 lds
  buffer_load_dwordx4 v4, s[12:15], s21 offen offset:1024 lds
  buffer_load_dwordx4 v4, s[12:15], s21 offen offset:2048 lds
  buffer_load_dwordx4 v4, s[12:15], s21 offen offset:3072 lds
  s_add_u32 m0, s22, 28672
  s_add_u32 s21, s40, 28672
  buffer_load_dwordx4 v4, s[12:15], s21 offen offset:0 lds
  buffer_load_dwordx4 v4, s[12:15], s21 offen offset:1024 lds
  s_add_u32 s21, s40, 122880
  buffer_load_dwordx4 v[64:67], v4, s[12:15], s21 offen offset:0
  buffer_load_dwordx4 v[68:71], v4, s[12:15], s21 offen offset:1024
  buffer_load_dwordx4 v[72:75], v4, s[12:15], s21 offen offset:2048
  buffer_load_dwordx4 v[76:79], v4, s[12:15], s21 offen offset:3072
  s_add_u32 s21, s40, 126976
  buffer_load_dwordx4 v[80:83], v4, s[12:15], s21 offen offset:0
  buffer_load_dwordx4 v[84:87], v4, s[12:15], s21 offen offset:1024
  buffer_load_dwordx4 v[88:91], v4, s[12:15], s21 offen offset:2048
  buffer_load_dwordx4 v[92:95], v4, s[12:15], s21 offen offset:3072
  s_add_u32 s21, s40, 131072
  buffer_load_dwordx4 v[96:99], v4, s[12:15], s21 offen offset:0
  buffer_load_dwordx4 v[100:103], v4, s[12:15], s21 offen offset:1024
  buffer_load_dwordx4 v[104:107], v4, s[12:15], s21 offen offset:2048
  buffer_load_dwordx4 v[108:111], v4, s[12:15], s21 offen offset:3072
  s_add_u32 s21, s40, 135168
  buffer_load_dwordx4 v[112:115], v4, s[12:15], s21 offen offset:0
  buffer_load_dwordx4 v[116:119], v4, s[12:15], s21 offen offset:1024
  buffer_load_dwordx4 v[120:123], v4, s[12:15], s21 offen offset:2048
  buffer_load_dwordx4 v[124:127], v4, s[12:15], s21 offen offset:3072
  s_add_u32 s21, s40, 139264
  buffer_load_dwordx4 v[128:131], v4, s[12:15], s21 offen offset:0
  buffer_load_dwordx4 v[132:135], v4, s[12:15], s21 offen offset:1024
  buffer_load_dwordx4 v[136:139], v4, s[12:15], s21 offen offset:2048
  buffer_load_dwordx4 v[140:143], v4, s[12:15], s21 offen offset:3072
  s_add_u32 s21, s40, 143360
  buffer_load_dwordx4 v[144:147], v4, s[12:15], s21 offen offset:0
  buffer_load_dwordx4 v[148:151], v4, s[12:15], s21 offen offset:1024
  buffer_load_dwordx4 v[152:155], v4, s[12:15], s21 offen offset:2048
  buffer_load_dwordx4 v[156:159], v4, s[12:15], s21 offen offset:3072
  s_add_u32 s21, s40, 147456
  buffer_load_dwordx4 v[160:163], v4, s[12:15], s21 offen offset:0
  buffer_load_dwordx4 v[164:167], v4, s[12:15], s21 offen offset:1024
  buffer_load_dwordx4 v[168:171], v4, s[12:15], s21 offen offset:2048
  buffer_load_dwordx4 v[172:175], v4, s[12:15], s21 offen offset:3072
  s_add_u32 s21, s40, 151552
  buffer_load_dwordx4 v[176:179], v4, s[12:15], s21 offen offset:0
  buffer_load_dwordx4 v[180:183], v4, s[12:15], s21 offen offset:1024
  v_lshrrev_b32 v6, 2, v2
  v_lshl_add_u32 v6, v3, 2, v6
  v_mul_u32_u24 v6, 1280, v6
  v_and_b32 v7, 3, v2
  v_lshlrev_b32 v7, 3, v7
  s_mul_i32 s21, s20, 320
  v_add3_u32 v6, v6, v7, s21
  v_add_u32 v8, v6, v7
  v_add_u32 v7, 61440, v6
  v_add_u32 v9, 61440, v8
  v_add_u32 v5, s22, v4
  s_waitcnt vmcnt(30)
  s_barrier
  ds_read_b64_tr_b16 a[0:1], v8 offset:0
  ds_read_b64_tr_b16 a[2:3], v8 offset:20480
  ds_read_b64_tr_b16 a[24:25], v8 offset:8
  ds_read_b64_tr_b16 a[26:27], v8 offset:20488
  ds_read_b64_tr_b16 a[48:49], v6 offset:64
  ds_read_b64_tr_b16 a[50:51], v6 offset:20544
  ds_read_b64_tr_b16 a[72:73], v8 offset:96
  ds_read_b64_tr_b16 a[74:75], v8 offset:20576
  ds_read_b64_tr_b16 a[96:97], v8 offset:104
  ds_read_b64_tr_b16 a[98:99], v8 offset:20584
  ds_read_b64_tr_b16 a[120:121], v8 offset:160
  ds_read_b64_tr_b16 a[122:123], v8 offset:20640
  ds_read_b64_tr_b16 a[144:145], v8 offset:168
  ds_read_b64_tr_b16 a[146:147], v8 offset:20648
  ds_read_b64_tr_b16 a[168:169], v6 offset:224
  ds_read_b64_tr_b16 a[170:171], v6 offset:20704
  ds_read_b64_tr_b16 a[192:193], v8 offset:256
  ds_read_b64_tr_b16 a[194:195], v8 offset:20736
  ds_read_b64_tr_b16 a[216:217], v8 offset:264
  ds_read_b64_tr_b16 a[218:219], v8 offset:20744
  ds_read_b64_tr_b16 a[4:5], v9 offset:0
  ds_read_b64_tr_b16 a[6:7], v9 offset:20480
  ds_read_b64_tr_b16 a[28:29], v9 offset:8
  ds_read_b64_tr_b16 a[30:31], v9 offset:20488
  ds_read_b64_tr_b16 a[52:53], v7 offset:64
  ds_read_b64_tr_b16 a[54:55], v7 offset:20544
  ds_read_b64_tr_b16 a[76:77], v9 offset:96
  ds_read_b64_tr_b16 a[78:79], v9 offset:20576
  ds_read_b64_tr_b16 a[100:101], v9 offset:104
  ds_read_b64_tr_b16 a[102:103], v9 offset:20584
  ds_read_b64_tr_b16 a[124:125], v9 offset:160
  ds_read_b64_tr_b16 a[126:127], v9 offset:20640
  ds_read_b64_tr_b16 a[148:149], v9 offset:168
  ds_read_b64_tr_b16 a[150:151], v9 offset:20648
  ds_read_b64_tr_b16 a[172:173], v7 offset:224
  ds_read_b64_tr_b16 a[174:175], v7 offset:20704
  ds_read_b64_tr_b16 a[196:197], v9 offset:256
  ds_read_b64_tr_b16 a[198:199], v9 offset:20736
  ds_read_b64_tr_b16 a[220:221], v9 offset:264
  ds_read_b64_tr_b16 a[222:223], v9 offset:20744
  ds_read_b64_tr_b16 a[8:9], v8 offset:40960
  ds_read_b64_tr_b16 a[10:11], v9 offset:40960
  ds_read_b64_tr_b16 a[32:33], v8 offset:40968
  ds_read_b64_tr_b16 a[34:35], v9 offset:40968
  ds_read_b64_tr_b16 a[56:57], v6 offset:41024
  ds_read_b64_tr_b16 a[58:59], v7 offset:41024
  ds_read_b64_tr_b16 a[80:81], v8 offset:41056
  ds_read_b64_tr_b16 a[82:83], v9 offset:41056
  ds_read_b64_tr_b16 a[104:105], v8 offset:41064
  ds_read_b64_tr_b16 a[106:107], v9 offset:41064
  ds_read_b64_tr_b16 a[128:129], v8 offset:41120
  ds_read_b64_tr_b16 a[130:131], v9 offset:41120
  ds_read_b64_tr_b16 a[152:153], v8 offset:41128
  ds_read_b64_tr_b16 a[154:155], v9 offset:41128
  ds_read_b64_tr_b16 a[176:177], v6 offset:41184
  ds_read_b64_tr_b16 a[178:179], v7 offset:41184
  ds_read_b64_tr_b16 a[200:201], v8 offset:41216
  ds_read_b64_tr_b16 a[202:203], v9 offset:41216
  ds_read_b64_tr_b16 a[224:225], v8 offset:41224
  ds_read_b64_tr_b16 a[226:227], v9 offset:41224
  s_waitcnt lgkmcnt(0)
  s_barrier
  s_waitcnt vmcnt(0)
  ds_write_b128 v5, v[64:67] offset:0
  ds_write_b128 v5, v[68:71] offset:1024
  ds_write_b128 v5, v[72:75] offset:2048
  ds_write_b128 v5, v[76:79] offset:3072
  ds_write_b128 v5, v[80:83] offset:4096
  ds_write_b128 v5, v[84:87] offset:5120
  ds_write_b128 v5, v[88:91] offset:6144
  ds_write_b128 v5, v[92:95] offset:7168
  ds_write_b128 v5, v[96:99] offset:8192
  ds_write_b128 v5, v[100:103] offset:9216
  ds_write_b128 v5, v[104:107] offset:10240
  ds_write_b128 v5, v[108:111] offset:11264
  ds_write_b128 v5, v[112:115] offset:12288
  ds_write_b128 v5, v[116:119] offset:13312
  ds_write_b128 v5, v[120:123] offset:14336
  ds_write_b128 v5, v[124:127] offset:15360
  ds_write_b128 v5, v[128:131] offset:16384
  ds_write_b128 v5, v[132:135] offset:17408
  ds_write_b128 v5, v[136:139] offset:18432
  ds_write_b128 v5, v[140:143] offset:19456
  ds_write_b128 v5, v[144:147] offset:20480
  ds_write_b128 v5, v[148:151] offset:21504
  ds_write_b128 v5, v[152:155] offset:22528
  ds_write_b128 v5, v[156:159] offset:23552
  ds_write_b128 v5, v[160:163] offset:24576
  ds_write_b128 v5, v[164:167] offset:25600
  ds_write_b128 v5, v[168:171] offset:26624
  ds_write_b128 v5, v[172:175] offset:27648
  ds_write_b128 v5, v[176:179] offset:28672
  ds_write_b128 v5, v[180:183] offset:29696
  s_waitcnt lgkmcnt(0)
  s_barrier
  ds_read_b64_tr_b16 a[12:13], v8 offset:0
  ds_read_b64_tr_b16 a[14:15], v8 offset:20480
  ds_read_b64_tr_b16 a[36:37], v8 offset:8
  ds_read_b64_tr_b16 a[38:39], v8 offset:20488
  ds_read_b64_tr_b16 a[60:61], v6 offset:64
  ds_read_b64_tr_b16 a[62:63], v6 offset:20544
  ds_read_b64_tr_b16 a[84:85], v8 offset:96
  ds_read_b64_tr_b16 a[86:87], v8 offset:20576
  ds_read_b64_tr_b16 a[108:109], v8 offset:104
  ds_read_b64_tr_b16 a[110:111], v8 offset:20584
  ds_read_b64_tr_b16 a[132:133], v8 offset:160
  ds_read_b64_tr_b16 a[134:135], v8 offset:20640
  ds_read_b64_tr_b16 a[156:157], v8 offset:168
  ds_read_b64_tr_b16 a[158:159], v8 offset:20648
  ds_read_b64_tr_b16 a[180:181], v6 offset:224
  ds_read_b64_tr_b16 a[182:183], v6 offset:20704
  ds_read_b64_tr_b16 a[204:205], v8 offset:256
  ds_read_b64_tr_b16 a[206:207], v8 offset:20736
  ds_read_b64_tr_b16 a[228:229], v8 offset:264
  ds_read_b64_tr_b16 a[230:231], v8 offset:20744
  ds_read_b64_tr_b16 a[16:17], v9 offset:0
  ds_read_b64_tr_b16 a[18:19], v9 offset:20480
  ds_read_b64_tr_b16 a[40:41], v9 offset:8
  ds_read_b64_tr_b16 a[42:43], v9 offset:20488
  ds_read_b64_tr_b16 a[64:65], v7 offset:64
  ds_read_b64_tr_b16 a[66:67], v7 offset:20544
  ds_read_b64_tr_b16 a[88:89], v9 offset:96
  ds_read_b64_tr_b16 a[90:91], v9 offset:20576
  ds_read_b64_tr_b16 a[112:113], v9 offset:104
  ds_read_b64_tr_b16 a[114:115], v9 offset:20584
  ds_read_b64_tr_b16 a[136:137], v9 offset:160
  ds_read_b64_tr_b16 a[138:139], v9 offset:20640
  ds_read_b64_tr_b16 a[160:161], v9 offset:168
  ds_read_b64_tr_b16 a[162:163], v9 offset:20648
  ds_read_b64_tr_b16 a[184:185], v7 offset:224
  ds_read_b64_tr_b16 a[186:187], v7 offset:20704
  ds_read_b64_tr_b16 a[208:209], v9 offset:256
  ds_read_b64_tr_b16 a[210:211], v9 offset:20736
  ds_read_b64_tr_b16 a[232:233], v9 offset:264
  ds_read_b64_tr_b16 a[234:235], v9 offset:20744
  ds_read_b64_tr_b16 a[20:21], v8 offset:40960
  ds_read_b64_tr_b16 a[22:23], v9 offset:40960
  ds_read_b64_tr_b16 a[44:45], v8 offset:40968
  ds_read_b64_tr_b16 a[46:47], v9 offset:40968
  ds_read_b64_tr_b16 a[68:69], v6 offset:41024
  ds_read_b64_tr_b16 a[70:71], v7 offset:41024
  ds_read_b64_tr_b16 a[92:93], v8 offset:41056
  ds_read_b64_tr_b16 a[94:95], v9 offset:41056
  ds_read_b64_tr_b16 a[116:117], v8 offset:41064
  ds_read_b64_tr_b16 a[118:119], v9 offset:41064
  ds_read_b64_tr_b16 a[140:141], v8 offset:41120
  ds_read_b64_tr_b16 a[142:143], v9 offset:41120
  ds_read_b64_tr_b16 a[164:165], v8 offset:41128
  ds_read_b64_tr_b16 a[166:167], v9 offset:41128
  ds_read_b64_tr_b16 a[188:189], v6 offset:41184
  ds_read_b64_tr_b16 a[190:191], v7 offset:41184
  ds_read_b64_tr_b16 a[212:213], v8 offset:41216
  ds_read_b64_tr_b16 a[214:215], v9 offset:41216
  ds_read_b64_tr_b16 a[236:237], v8 offset:41224
  ds_read_b64_tr_b16 a[238:239], v9 offset:41224
  s_waitcnt lgkmcnt(0)
  s_barrier
  s_load_dwordx2 s[32:33], s[0:1], 96
  s_waitcnt lgkmcnt(0)
  s_mov_b32 s32, s32
  s_mov_b32 s33, s33
  s_mov_b32 s34, 256
  s_mov_b32 s35, 0x00020000
  s_mov_b32 s21, 76
  v_mov_b32 v4, 0
  s_mov_b32 s101, 0
wf_198:
  buffer_load_dword v5, v4, s[32:35], s21 offen sc1
  s_add_u32 s101, s101, 1
  s_cmp_gt_u32 s101, 131072
  s_cbranch_scc1 main_end
  s_waitcnt vmcnt(0)
  v_readfirstlane_b32 s100, v5
  s_cmp_ge_u32 s100, 1
  s_cbranch_scc1 wf_199
  s_sleep 8
  s_branch wf_198
wf_199:
  s_sub_u32 s80, s100, 1
  s_lshl_b32 s80, s80, 13
  s_lshl_b32 s40, s2, 2
  s_add_u32 s40, s40, s20
  s_lshl_b32 s40, s40, 14
  s_xor_b32 s40, s40, s80
  s_xor_b32 s40, s40, 8192
  s_mul_i32 s47, s20, 3072
  s_lshr_b32 s43, s2, 2
  s_lshl_b32 s43, s43, 7
  s_add_u32 s43, s43, 0
  s_lshl_b32 s44, s2, 7
  s_lshl_b32 s21, s20, 2
  s_add_u32 s44, s44, s21
  s_add_u32 s44, s44, 88576
  s_lshl_b32 s49, s20, 8
  s_add_u32 s49, s49, 12288
  s_mov_b32 s45, 0
  v_lshlrev_b32 v4, 4, v1
  v_min_u32 v14, 17, v1
  v_lshlrev_b32 v14, 10, v14
  v_mov_b32 v17, 1073741824
  v_cmp_eq_u32 vcc, 0, v1
  s_nop 1
  v_cndmask_b32 v17, v17, 0, vcc
vwr_200:
  s_cmp_lg_u32 s20, 0
  s_cbranch_scc1 vwr_202
  s_mov_b32 s101, 0
vwr_201:
  s_sleep 4
  buffer_load_dword v15, v14, s[72:75], s43 offen sc1
  s_add_u32 s101, s101, 1
  s_cmp_gt_u32 s101, 131072
  s_cbranch_scc1 main_end
  s_waitcnt vmcnt(0)
  v_cmp_le_u32 vcc, 8, v15
  s_nop 1
  s_ff0_i32_b32 s21, vcc_lo
  s_min_u32 s21, s21, 18
  s_lshl_b32 s22, s21, 1
  s_lshl_b32 s21, s21, 2
  s_sub_i32 s21, s21, 8
  s_max_i32 s46, s21, s22
  s_cmp_le_u32 s46, s45
  s_cbranch_scc1 vwr_201
  v_mov_b32 v15, s46
  v_mov_b32 v16, 65536
  ds_write_b32 v16, v15
  s_waitcnt lgkmcnt(0)
vwr_202:
  s_barrier
  v_mov_b32 v16, 65536
  ds_read_b32 v15, v16
  s_and_b32 s50, s45, 2
  s_lshl_b32 s50, s50, 14
  v_add_u32 v10, s50, v4
  v_add_u32 v11, 2048, v10
  v_add_u32 v12, 2056, v10
  v_lshl_add_u32 v13, v1, 2, s50
  s_lshl_b32 s41, s45, 21
  s_add_u32 s41, s41, s40
  s_mov_b32 s48, s45
  s_mov_b32 s56, s41
  s_add_u32 s57, s56, 4096
  s_lshl_b32 s58, s45, 19
  s_lshl_b32 s21, s45, 11
  s_and_b32 s21, s21, 8192
  s_xor_b32 s21, s21, s80
  s_add_u32 s58, s58, s21
  s_add_u32 s58, s58, 134217728
  s_lshl_b32 s21, s2, 14
  s_lshl_b32 s22, s20, 11
  s_add_u32 s21, s21, s22
  s_add_u32 s58, s58, s21
  s_mov_b32 s51, 1073741824
  s_mov_b32 s59, 1073741824
  s_waitcnt lgkmcnt(0)
  v_readfirstlane_b32 s46, v15
  s_mov_b32 s52, s50
  s_cmp_lt_u32 s48, s46
  s_cselect_b32 s53, s41, 1073741824
  s_add_u32 s54, s52, 0
  s_add_u32 m0, s54, s47
  s_nop 0
  buffer_load_dwordx4 v4, s[16:19], s53 offen offset:0 sc1 lds
  buffer_load_dwordx4 v4, s[16:19], s53 offen offset:1024 sc1 lds
  buffer_load_dwordx4 v4, s[16:19], s53 offen offset:2048 sc1 lds
  s_nop 0
  s_add_u32 m0, s54, s49
  s_nop 0
  buffer_load_dword v14, s[72:75], s43 offen sc1 lds
  s_add_u32 s41, s41, 2097152
  s_xor_b32 s41, s41, 8192
  s_add_u32 s48, s48, 1
  s_cmp_lt_u32 s48, s46
  s_cselect_b32 s53, s41, 1073741824
  s_add_u32 s54, s52, 16384
  s_add_u32 m0, s54, s47
  s_nop 0
  buffer_load_dwordx4 v4, s[16:19], s53 offen offset:0 sc1 lds
  buffer_load_dwordx4 v4, s[16:19], s53 offen offset:1024 sc1 lds
  buffer_load_dwordx4 v4, s[16:19], s53 offen offset:2048 sc1 lds
  s_nop 0
  s_add_u32 m0, s54, s49
  s_nop 0
  buffer_load_dword v14, s[72:75], s43 offen sc1 lds
  s_add_u32 s41, s41, 2097152
  s_xor_b32 s41, s41, 8192
  s_add_u32 s48, s48, 1
  s_xor_b32 s52, s52, 32768
  s_cmp_lt_u32 s48, s46
  s_cselect_b32 s53, s41, 1073741824
  s_add_u32 s54, s52, 0
  s_add_u32 m0, s54, s47
  s_nop 0
  buffer_load_dwordx4 v4, s[16:19], s53 offen offset:0 sc1 lds
  buffer_load_dwordx4 v4, s[16:19], s53 offen offset:1024 sc1 lds
  buffer_load_dwordx4 v4, s[16:19], s53 offen offset:2048 sc1 lds
  s_nop 0
  s_add_u32 m0, s54, s49
  s_nop 0
  buffer_load_dword v14, s[72:75], s43 offen sc1 lds
  s_add_u32 s41, s41, 2097152
  s_xor_b32 s41, s41, 8192
  s_add_u32 s48, s48, 1
  s_waitcnt vmcnt(0)
  s_barrier
  ds_read_b128 v[64:67], v10 offset:0
  ds_read_b128 v[88:91], v10 offset:1024
  ds_read_b128 v[68:71], v10 offset:3072
  ds_read_b128 v[92:95], v10 offset:4096
  ds_read2st64_b64 v[72:75], v11 offset0:0 offset1:6
  ds_read2st64_b64 v[96:99], v12 offset0:0 offset1:6
  ds_read_b128 v[76:79], v10 offset:6144
  ds_read_b128 v[100:103], v10 offset:7168
  ds_read_b128 v[80:83], v10 offset:9216
  ds_read_b128 v[104:107], v10 offset:10240
  ds_read2st64_b64 v[84:87], v11 offset0:12 offset1:18
  ds_read2st64_b64 v[108:111], v12 offset0:12 offset1:18
  s_waitcnt lgkmcnt(0)
  .p2align 3
vwl_203:
  v_mfma_f32_16x16x32_bf16 v[160:163], v[64:67], a[0:3], 0
  v_mfma_f32_16x16x32_bf16 v[164:167], v[88:91], a[0:3], 0
  v_mfma_f32_16x16x32_bf16 v[160:163], v[68:71], a[4:7], v[160:163]
  v_cvt_pk_bf16_f32 v204, v184, v185
  v_cvt_pk_bf16_f32 v205, v186, v187
  v_mfma_f32_16x16x32_bf16 v[164:167], v[92:95], a[4:7], v[164:167]
  v_cvt_pk_bf16_f32 v206, v188, v189
  v_cvt_pk_bf16_f32 v207, v190, v191
  v_mfma_f32_16x16x32_bf16 v[160:163], v[72:75], a[8:11], v[160:163]
  buffer_store_dwordx4 v[204:207], v4, s[16:19], s51 offen offset:3072 sc1
  v_mfma_f32_16x16x32_bf16 v[164:167], v[96:99], a[8:11], v[164:167]
  v_mfma_f32_16x16x32_bf16 v[160:163], v[76:79], a[12:15], v[160:163]
  v_mfma_f32_16x16x32_bf16 v[164:167], v[100:103], a[12:15], v[164:167]
  s_waitcnt vmcnt(23)
  s_barrier
  ds_read_b32 v15, v13 offset:28672
  v_mfma_f32_16x16x32_bf16 v[160:163], v[80:83], a[16:19], v[160:163]
  ds_read_b128 v[112:115], v10 offset:16384
  v_mfma_f32_16x16x32_bf16 v[164:167], v[104:107], a[16:19], v[164:167]
  v_mfma_f32_16x16x32_bf16 v[160:163], v[84:87], a[20:23], v[160:163]
  ds_read_b128 v[136:139], v10 offset:17408
  v_mfma_f32_16x16x32_bf16 v[164:167], v[108:111], a[20:23], v[164:167]
  v_mfma_f32_16x16x32_bf16 v[168:171], v[64:67], a[24:27], 0
  ds_read_b128 v[116:119], v10 offset:19456
  v_mfma_f32_16x16x32_bf16 v[172:175], v[88:91], a[24:27], 0
  v_mfma_f32_16x16x32_bf16 v[168:171], v[68:71], a[28:31], v[168:171]
  v_cvt_pk_bf16_f32 v192, v160, v161
  v_cvt_pk_bf16_f32 v193, v162, v163
  v_mfma_f32_16x16x32_bf16 v[172:175], v[92:95], a[28:31], v[172:175]
  v_cvt_pk_bf16_f32 v194, v164, v165
  v_cvt_pk_bf16_f32 v195, v166, v167
  v_mfma_f32_16x16x32_bf16 v[168:171], v[72:75], a[32:35], v[168:171]
  buffer_store_dwordx4 v[192:195], v4, s[16:19], s56 offen offset:0 sc1
  ds_read_b128 v[140:143], v10 offset:20480
  v_mfma_f32_16x16x32_bf16 v[172:175], v[96:99], a[32:35], v[172:175]
  v_mfma_f32_16x16x32_bf16 v[168:171], v[76:79], a[36:39], v[168:171]
  ds_read2st64_b64 v[120:123], v11 offset0:32 offset1:38
  v_mfma_f32_16x16x32_bf16 v[172:175], v[100:103], a[36:39], v[172:175]
  v_mfma_f32_16x16x32_bf16 v[168:171], v[80:83], a[40:43], v[168:171]
  ds_read2st64_b64 v[144:147], v12 offset0:32 offset1:38
  v_mfma_f32_16x16x32_bf16 v[172:175], v[104:107], a[40:43], v[172:175]
  v_mfma_f32_16x16x32_bf16 v[168:171], v[84:87], a[44:47], v[168:171]
  ds_read_b128 v[124:127], v10 offset:22528
  v_mfma_f32_16x16x32_bf16 v[172:175], v[108:111], a[44:47], v[172:175]
  v_mfma_f32_16x16x32_bf16 v[176:179], v[64:67], a[48:51], 0
  ds_read_b128 v[148:151], v10 offset:23552
  v_mfma_f32_16x16x32_bf16 v[180:183], v[88:91], a[48:51], 0
  v_mfma_f32_16x16x32_bf16 v[176:179], v[68:71], a[52:55], v[176:179]
  v_cvt_pk_bf16_f32 v196, v168, v169
  v_cvt_pk_bf16_f32 v197, v170, v171
  v_mfma_f32_16x16x32_bf16 v[180:183], v[92:95], a[52:55], v[180:183]
  v_cvt_pk_bf16_f32 v198, v172, v173
  v_cvt_pk_bf16_f32 v199, v174, v175
  v_mfma_f32_16x16x32_bf16 v[176:179], v[72:75], a[56:59], v[176:179]
  buffer_store_dwordx4 v[196:199], v4, s[16:19], s56 offen offset:1024 sc1
  ds_read_b128 v[128:131], v10 offset:25600
  v_mfma_f32_16x16x32_bf16 v[180:183], v[96:99], a[56:59], v[180:183]
  v_mfma_f32_16x16x32_bf16 v[176:179], v[76:79], a[60:63], v[176:179]
  ds_read_b128 v[152:155], v10 offset:26624
  v_mfma_f32_16x16x32_bf16 v[180:183], v[100:103], a[60:63], v[180:183]
  v_mfma_f32_16x16x32_bf16 v[176:179], v[80:83], a[64:67], v[176:179]
  ds_read2st64_b64 v[132:135], v11 offset0:44 offset1:50
  v_mfma_f32_16x16x32_bf16 v[180:183], v[104:107], a[64:67], v[180:183]
  v_mfma_f32_16x16x32_bf16 v[176:179], v[84:87], a[68:71], v[176:179]
  ds_read2st64_b64 v[156:159], v12 offset0:44 offset1:50
  v_mfma_f32_16x16x32_bf16 v[180:183], v[108:111], a[68:71], v[180:183]
  v_mfma_f32_16x16x32_bf16 v[184:187], v[64:67], a[72:75], 0
  v_mfma_f32_16x16x32_bf16 v[188:191], v[88:91], a[72:75], 0
  s_waitcnt lgkmcnt(12)
  v_cmp_le_u32 vcc, 8, v15
  v_mfma_f32_16x16x32_bf16 v[184:187], v[68:71], a[76:79], v[184:187]
  v_cvt_pk_bf16_f32 v200, v176, v177
  v_cvt_pk_bf16_f32 v201, v178, v179
  v_mfma_f32_16x16x32_bf16 v[188:191], v[92:95], a[76:79], v[188:191]
  s_ff0_i32_b32 s21, vcc_lo
  v_cvt_pk_bf16_f32 v202, v180, v181
  v_cvt_pk_bf16_f32 v203, v182, v183
  v_mfma_f32_16x16x32_bf16 v[184:187], v[72:75], a[80:83], v[184:187]
  s_min_u32 s21, s21, 18
  buffer_store_dwordx4 v[200:203], v4, s[16:19], s58 offen offset:0 sc1
  s_lshl_b32 s22, s21, 1
  v_mfma_f32_16x16x32_bf16 v[188:191], v[96:99], a[80:83], v[188:191]
  s_lshl_b32 s21, s21, 2
  s_sub_i32 s21, s21, 8
  s_max_i32 s21, s21, s22
  v_mfma_f32_16x16x32_bf16 v[184:187], v[76:79], a[84:87], v[184:187]
  s_max_u32 s21, s21, s46
  s_cmp_ge_u32 s46, s48
  s_cselect_b32 s46, s21, s46
  v_mfma_f32_16x16x32_bf16 v[188:191], v[100:103], a[84:87], v[188:191]
  s_cmp_lt_u32 s48, s46
  s_cselect_b32 s53, s41, 1073741824
  s_add_u32 s54, s52, 16384
  v_mfma_f32_16x16x32_bf16 v[184:187], v[80:83], a[88:91], v[184:187]
  s_add_u32 m0, s54, s47
  v_mfma_f32_16x16x32_bf16 v[188:191], v[104:107], a[88:91], v[188:191]
  buffer_load_dwordx4 v4, s[16:19], s53 offen offset:0 sc1 lds
  buffer_load_dwordx4 v4, s[16:19], s53 offen offset:1024 sc1 lds
  v_mfma_f32_16x16x32_bf16 v[184:187], v[84:87], a[92:95], v[184:187]
  buffer_load_dwordx4 v4, s[16:19], s53 offen offset:2048 sc1 lds
  v_mfma_f32_16x16x32_bf16 v[188:191], v[108:111], a[92:95], v[188:191]
  s_add_u32 m0, s54, s49
  v_mfma_f32_16x16x32_bf16 v[160:163], v[64:67], a[96:99], 0
  buffer_load_dword v14, s[72:75], s43 offen sc1 lds
  s_add_u32 s41, s41, 2097152
  v_mfma_f32_16x16x32_bf16 v[164:167], v[88:91], a[96:99], 0
  s_xor_b32 s41, s41, 8192
  s_add_u32 s48, s48, 1
  v_mfma_f32_16x16x32_bf16 v[160:163], v[68:71], a[100:103], v[160:163]
  v_cvt_pk_bf16_f32 v204, v184, v185
  v_cvt_pk_bf16_f32 v205, v186, v187
  v_mfma_f32_16x16x32_bf16 v[164:167], v[92:95], a[100:103], v[164:167]
  v_cvt_pk_bf16_f32 v206, v188, v189
  v_cvt_pk_bf16_f32 v207, v190, v191
  v_mfma_f32_16x16x32_bf16 v[160:163], v[72:75], a[104:107], v[160:163]
  buffer_store_dwordx4 v[204:207], v4, s[16:19], s56 offen offset:2048 sc1
  v_mfma_f32_16x16x32_bf16 v[164:167], v[96:99], a[104:107], v[164:167]
  v_mfma_f32_16x16x32_bf16 v[160:163], v[76:79], a[108:111], v[160:163]
  v_mfma_f32_16x16x32_bf16 v[164:167], v[100:103], a[108:111], v[164:167]
  v_mfma_f32_16x16x32_bf16 v[160:163], v[80:83], a[112:115], v[160:163]
  v_mfma_f32_16x16x32_bf16 v[164:167], v[104:107], a[112:115], v[164:167]
  v_mfma_f32_16x16x32_bf16 v[160:163], v[84:87], a[116:119], v[160:163]
  v_mfma_f32_16x16x32_bf16 v[164:167], v[108:111], a[116:119], v[164:167]
  v_mfma_f32_16x16x32_bf16 v[168:171], v[64:67], a[120:123], 0
  v_mfma_f32_16x16x32_bf16 v[172:175], v[88:91], a[120:123], 0
  v_mfma_f32_16x16x32_bf16 v[168:171], v[68:71], a[124:127], v[168:171]
  v_cvt_pk_bf16_f32 v192, v160, v161
  v_cvt_pk_bf16_f32 v193, v162, v163
  v_mfma_f32_16x16x32_bf16 v[172:175], v[92:95], a[124:127], v[172:175]
  v_cvt_pk_bf16_f32 v194, v164, v165
  v_cvt_pk_bf16_f32 v195, v166, v167
  v_mfma_f32_16x16x32_bf16 v[168:171], v[72:75], a[128:131], v[168:171]
  buffer_store_dwordx4 v[192:195], v4, s[16:19], s56 offen offset:3072 sc1
  v_mfma_f32_16x16x32_bf16 v[172:175], v[96:99], a[128:131], v[172:175]
  v_mfma_f32_16x16x32_bf16 v[168:171], v[76:79], a[132:135], v[168:171]
  v_mfma_f32_16x16x32_bf16 v[172:175], v[100:103], a[132:135], v[172:175]
  v_mfma_f32_16x16x32_bf16 v[168:171], v[80:83], a[136:139], v[168:171]
  v_mfma_f32_16x16x32_bf16 v[172:175], v[104:107], a[136:139], v[172:175]
  v_mfma_f32_16x16x32_bf16 v[168:171], v[84:87], a[140:143], v[168:171]
  v_mfma_f32_16x16x32_bf16 v[172:175], v[108:111], a[140:143], v[172:175]
  v_mfma_f32_16x16x32_bf16 v[176:179], v[64:67], a[144:147], 0
  v_mfma_f32_16x16x32_bf16 v[180:183], v[88:91], a[144:147], 0
  v_mfma_f32_16x16x32_bf16 v[176:179], v[68:71], a[148:151], v[176:179]
  v_cvt_pk_bf16_f32 v196, v168, v169
  v_cvt_pk_bf16_f32 v197, v170, v171
  v_mfma_f32_16x16x32_bf16 v[180:183], v[92:95], a[148:151], v[180:183]
  v_cvt_pk_bf16_f32 v198, v172, v173
  v_cvt_pk_bf16_f32 v199, v174, v175
  v_mfma_f32_16x16x32_bf16 v[176:179], v[72:75], a[152:155], v[176:179]
  buffer_store_dwordx4 v[196:199], v4, s[16:19], s57 offen offset:0 sc1
  v_mfma_f32_16x16x32_bf16 v[180:183], v[96:99], a[152:155], v[180:183]
  v_mfma_f32_16x16x32_bf16 v[176:179], v[76:79], a[156:159], v[176:179]
  v_mfma_f32_16x16x32_bf16 v[180:183], v[100:103], a[156:159], v[180:183]
  v_mfma_f32_16x16x32_bf16 v[176:179], v[80:83], a[160:163], v[176:179]
  v_mfma_f32_16x16x32_bf16 v[180:183], v[104:107], a[160:163], v[180:183]
  v_mfma_f32_16x16x32_bf16 v[176:179], v[84:87], a[164:167], v[176:179]
  v_mfma_f32_16x16x32_bf16 v[180:183], v[108:111], a[164:167], v[180:183]
  v_mfma_f32_16x16x32_bf16 v[184:187], v[64:67], a[168:171], 0
  v_mfma_f32_16x16x32_bf16 v[188:191], v[88:91], a[168:171], 0
  v_mfma_f32_16x16x32_bf16 v[184:187], v[68:71], a[172:175], v[184:187]
  v_cvt_pk_bf16_f32 v200, v176, v177
  v_cvt_pk_bf16_f32 v201, v178, v179
  v_mfma_f32_16x16x32_bf16 v[188:191], v[92:95], a[172:175], v[188:191]
  v_cvt_pk_bf16_f32 v202, v180, v181
  v_cvt_pk_bf16_f32 v203, v182, v183
  v_mfma_f32_16x16x32_bf16 v[184:187], v[72:75], a[176:179], v[184:187]
  buffer_store_dwordx4 v[200:203], v4, s[16:19], s57 offen offset:1024 sc1
  v_mfma_f32_16x16x32_bf16 v[188:191], v[96:99], a[176:179], v[188:191]
  v_mfma_f32_16x16x32_bf16 v[184:187], v[76:79], a[180:183], v[184:187]
  v_mfma_f32_16x16x32_bf16 v[188:191], v[100:103], a[180:183], v[188:191]
  v_mfma_f32_16x16x32_bf16 v[184:187], v[80:83], a[184:187], v[184:187]
  v_mfma_f32_16x16x32_bf16 v[188:191], v[104:107], a[184:187], v[188:191]
  v_mfma_f32_16x16x32_bf16 v[184:187], v[84:87], a[188:191], v[184:187]
  v_mfma_f32_16x16x32_bf16 v[188:191], v[108:111], a[188:191], v[188:191]
  v_mfma_f32_16x16x32_bf16 v[160:163], v[64:67], a[192:195], 0
  s_min_u32 s21, s45, 52
  v_mov_b32 v16, s21
  s_waitcnt vmcnt(11)
  v_mfma_f32_16x16x32_bf16 v[164:167], v[88:91], a[192:195], 0
  buffer_store_dword v16, v17, s[72:75], s44 offen sc1
  v_mfma_f32_16x16x32_bf16 v[160:163], v[68:71], a[196:199], v[160:163]
  v_cvt_pk_bf16_f32 v204, v184, v185
  v_cvt_pk_bf16_f32 v205, v186, v187
  v_mfma_f32_16x16x32_bf16 v[164:167], v[92:95], a[196:199], v[164:167]
  v_cvt_pk_bf16_f32 v206, v188, v189
  v_cvt_pk_bf16_f32 v207, v190, v191
  v_mfma_f32_16x16x32_bf16 v[160:163], v[72:75], a[200:203], v[160:163]
  buffer_store_dwordx4 v[204:207], v4, s[16:19], s58 offen offset:1024 sc1
  v_mfma_f32_16x16x32_bf16 v[164:167], v[96:99], a[200:203], v[164:167]
  v_mfma_f32_16x16x32_bf16 v[160:163], v[76:79], a[204:207], v[160:163]
  s_add_u32 s56, s56, 2097152
  s_xor_b32 s56, s56, 8192
  s_add_u32 s59, s58, 524288
  v_mfma_f32_16x16x32_bf16 v[164:167], v[100:103], a[204:207], v[164:167]
  s_xor_b32 s58, s58, s59
  s_lshr_b32 s58, s58, 8
  s_and_b32 s58, s58, 8192
  v_mfma_f32_16x16x32_bf16 v[160:163], v[80:83], a[208:211], v[160:163]
  s_xor_b32 s58, s58, s59
  v_mfma_f32_16x16x32_bf16 v[164:167], v[104:107], a[208:211], v[164:167]
  v_mfma_f32_16x16x32_bf16 v[160:163], v[84:87], a[212:215], v[160:163]
  v_mfma_f32_16x16x32_bf16 v[164:167], v[108:111], a[212:215], v[164:167]
  v_mfma_f32_16x16x32_bf16 v[168:171], v[64:67], a[216:219], 0
  v_mfma_f32_16x16x32_bf16 v[172:175], v[88:91], a[216:219], 0
  v_mfma_f32_16x16x32_bf16 v[168:171], v[68:71], a[220:223], v[168:171]
  v_cvt_pk_bf16_f32 v192, v160, v161
  v_cvt_pk_bf16_f32 v193, v162, v163
  v_mfma_f32_16x16x32_bf16 v[172:175], v[92:95], a[220:223], v[172:175]
  v_cvt_pk_bf16_f32 v194, v164, v165
  v_cvt_pk_bf16_f32 v195, v166, v167
  v_mfma_f32_16x16x32_bf16 v[168:171], v[72:75], a[224:227], v[168:171]
  buffer_store_dwordx4 v[192:195], v4, s[16:19], s57 offen offset:2048 sc1
  v_mfma_f32_16x16x32_bf16 v[172:175], v[96:99], a[224:227], v[172:175]
  v_mfma_f32_16x16x32_bf16 v[168:171], v[76:79], a[228:231], v[168:171]
  s_mov_b32 s51, s57
  s_add_u32 s57, s56, 4096
  s_add_u32 s45, s45, 1
  v_mfma_f32_16x16x32_bf16 v[172:175], v[100:103], a[228:231], v[172:175]
  v_mfma_f32_16x16x32_bf16 v[168:171], v[80:83], a[232:235], v[168:171]
  v_mfma_f32_16x16x32_bf16 v[172:175], v[104:107], a[232:235], v[172:175]
  v_mfma_f32_16x16x32_bf16 v[168:171], v[84:87], a[236:239], v[168:171]
  v_mfma_f32_16x16x32_bf16 v[172:175], v[108:111], a[236:239], v[172:175]
  s_waitcnt lgkmcnt(0)
  v_mfma_f32_16x16x32_bf16 v[176:179], v[112:115], a[0:3], 0
  v_mfma_f32_16x16x32_bf16 v[180:183], v[136:139], a[0:3], 0
  v_mfma_f32_16x16x32_bf16 v[176:179], v[116:119], a[4:7], v[176:179]
  v_cvt_pk_bf16_f32 v196, v168, v169
  v_cvt_pk_bf16_f32 v197, v170, v171
  v_mfma_f32_16x16x32_bf16 v[180:183], v[140:143], a[4:7], v[180:183]
  v_cvt_pk_bf16_f32 v198, v172, v173
  v_cvt_pk_bf16_f32 v199, v174, v175
  v_mfma_f32_16x16x32_bf16 v[176:179], v[120:123], a[8:11], v[176:179]
  buffer_store_dwordx4 v[196:199], v4, s[16:19], s51 offen offset:3072 sc1
  v_mfma_f32_16x16x32_bf16 v[180:183], v[144:147], a[8:11], v[180:183]
  v_mfma_f32_16x16x32_bf16 v[176:179], v[124:127], a[12:15], v[176:179]
  v_mfma_f32_16x16x32_bf16 v[180:183], v[148:151], a[12:15], v[180:183]
  s_waitcnt vmcnt(22)
  s_barrier
  v_xor_b32 v10, 32768, v10
  v_mfma_f32_16x16x32_bf16 v[176:179], v[128:131], a[16:19], v[176:179]
  v_xor_b32 v11, 32768, v11
  v_xor_b32 v12, 32768, v12
  v_mfma_f32_16x16x32_bf16 v[180:183], v[152:155], a[16:19], v[180:183]
  v_xor_b32 v13, 32768, v13
  ds_read_b32 v15, v13 offset:12288
  v_mfma_f32_16x16x32_bf16 v[176:179], v[132:135], a[20:23], v[176:179]
  ds_read_b128 v[64:67], v10 offset:0
  v_mfma_f32_16x16x32_bf16 v[180:183], v[156:159], a[20:23], v[180:183]
  v_mfma_f32_16x16x32_bf16 v[184:187], v[112:115], a[24:27], 0
  ds_read_b128 v[88:91], v10 offset:1024
  v_mfma_f32_16x16x32_bf16 v[188:191], v[136:139], a[24:27], 0
  v_mfma_f32_16x16x32_bf16 v[184:187], v[116:119], a[28:31], v[184:187]
  v_cvt_pk_bf16_f32 v200, v176, v177
  v_cvt_pk_bf16_f32 v201, v178, v179
  v_mfma_f32_16x16x32_bf16 v[188:191], v[140:143], a[28:31], v[188:191]
  v_cvt_pk_bf16_f32 v202, v180, v181
  v_cvt_pk_bf16_f32 v203, v182, v183
  v_mfma_f32_16x16x32_bf16 v[184:187], v[120:123], a[32:35], v[184:187]
  buffer_store_dwordx4 v[200:203], v4, s[16:19], s56 offen offset:0 sc1
  ds_read_b128 v[68:71], v10 offset:3072
  v_mfma_f32_16x16x32_bf16 v[188:191], v[144:147], a[32:35], v[188:191]
  v_mfma_f32_16x16x32_bf16 v[184:187], v[124:127], a[36:39], v[184:187]
  ds_read_b128 v[92:95], v10 offset:4096
  v_mfma_f32_16x16x32_bf16 v[188:191], v[148:151], a[36:39], v[188:191]
  v_mfma_f32_16x16x32_bf16 v[184:187], v[128:131], a[40:43], v[184:187]
  ds_read2st64_b64 v[72:75], v11 offset0:0 offset1:6
  v_mfma_f32_16x16x32_bf16 v[188:191], v[152:155], a[40:43], v[188:191]
  v_mfma_f32_16x16x32_bf16 v[184:187], v[132:135], a[44:47], v[184:187]
  ds_read2st64_b64 v[96:99], v12 offset0:0 offset1:6
  v_mfma_f32_16x16x32_bf16 v[188:191], v[156:159], a[44:47], v[188:191]
  v_mfma_f32_16x16x32_bf16 v[160:163], v[112:115], a[48:51], 0
  ds_read_b128 v[76:79], v10 offset:6144
  v_mfma_f32_16x16x32_bf16 v[164:167], v[136:139], a[48:51], 0
  v_mfma_f32_16x16x32_bf16 v[160:163], v[116:119], a[52:55], v[160:163]
  v_cvt_pk_bf16_f32 v204, v184, v185
  v_cvt_pk_bf16_f32 v205, v186, v187
  v_mfma_f32_16x16x32_bf16 v[164:167], v[140:143], a[52:55], v[164:167]
  v_cvt_pk_bf16_f32 v206, v188, v189
  v_cvt_pk_bf16_f32 v207, v190, v191
  v_mfma_f32_16x16x32_bf16 v[160:163], v[120:123], a[56:59], v[160:163]
  buffer_store_dwordx4 v[204:207], v4, s[16:19], s56 offen offset:1024 sc1
  ds_read_b128 v[100:103], v10 offset:7168
  v_mfma_f32_16x16x32_bf16 v[164:167], v[144:147], a[56:59], v[164:167]
  v_mfma_f32_16x16x32_bf16 v[160:163], v[124:127], a[60:63], v[160:163]
  ds_read_b128 v[80:83], v10 offset:9216
  v_mfma_f32_16x16x32_bf16 v[164:167], v[148:151], a[60:63], v[164:167]
  v_mfma_f32_16x16x32_bf16 v[160:163], v[128:131], a[64:67], v[160:163]
  ds_read_b128 v[104:107], v10 offset:10240
  v_mfma_f32_16x16x32_bf16 v[164:167], v[152:155], a[64:67], v[164:167]
  v_mfma_f32_16x16x32_bf16 v[160:163], v[132:135], a[68:71], v[160:163]
  ds_read2st64_b64 v[84:87], v11 offset0:12 offset1:18
  v_mfma_f32_16x16x32_bf16 v[164:167], v[156:159], a[68:71], v[164:167]
  v_mfma_f32_16x16x32_bf16 v[168:171], v[112:115], a[72:75], 0
  ds_read2st64_b64 v[108:111], v12 offset0:12 offset1:18
  v_mfma_f32_16x16x32_bf16 v[172:175], v[136:139], a[72:75], 0
  v_mfma_f32_16x16x32_bf16 v[168:171], v[116:119], a[76:79], v[168:171]
  v_cvt_pk_bf16_f32 v192, v160, v161
  v_cvt_pk_bf16_f32 v193, v162, v163
  v_mfma_f32_16x16x32_bf16 v[172:175], v[140:143], a[76:79], v[172:175]
  v_cvt_pk_bf16_f32 v194, v164, v165
  v_cvt_pk_bf16_f32 v195, v166, v167
  v_mfma_f32_16x16x32_bf16 v[168:171], v[120:123], a[80:83], v[168:171]
  buffer_store_dwordx4 v[192:195], v4, s[16:19], s58 offen offset:0 sc1
  s_waitcnt lgkmcnt(12)
  v_mfma_f32_16x16x32_bf16 v[172:175], v[144:147], a[80:83], v[172:175]
  v_cmp_le_u32 vcc, 8, v15
  v_mfma_f32_16x16x32_bf16 v[168:171], v[124:127], a[84:87], v[168:171]
  s_ff0_i32_b32 s21, vcc_lo
  s_min_u32 s21, s21, 18
  s_lshl_b32 s22, s21, 1
  v_mfma_f32_16x16x32_bf16 v[172:175], v[148:151], a[84:87], v[172:175]
  s_lshl_b32 s21, s21, 2
  s_sub_i32 s21, s21, 8
  s_max_i32 s21, s21, s22
  v_mfma_f32_16x16x32_bf16 v[168:171], v[128:131], a[88:91], v[168:171]
  s_max_u32 s21, s21, s46
  s_cmp_ge_u32 s46, s48
  s_cselect_b32 s46, s21, s46
  v_mfma_f32_16x16x32_bf16 v[172:175], v[152:155], a[88:91], v[172:175]
  s_xor_b32 s52, s52, 32768
  s_cmp_lt_u32 s48, s46
  s_cselect_b32 s53, s41, 1073741824
  v_mfma_f32_16x16x32_bf16 v[168:171], v[132:135], a[92:95], v[168:171]
  s_add_u32 s54, s52, 0
  s_add_u32 m0, s54, s47
  v_mfma_f32_16x16x32_bf16 v[172:175], v[156:159], a[92:95], v[172:175]
  buffer_load_dwordx4 v4, s[16:19], s53 offen offset:0 sc1 lds
  buffer_load_dwordx4 v4, s[16:19], s53 offen offset:1024 sc1 lds
  v_mfma_f32_16x16x32_bf16 v[176:179], v[112:115], a[96:99], 0
  buffer_load_dwordx4 v4, s[16:19], s53 offen offset:2048 sc1 lds
  v_mfma_f32_16x16x32_bf16 v[180:183], v[136:139], a[96:99], 0
  s_add_u32 m0, s54, s49
  v_mfma_f32_16x16x32_bf16 v[176:179], v[116:119], a[100:103], v[176:179]
  v_cvt_pk_bf16_f32 v196, v168, v169
  v_cvt_pk_bf16_f32 v197, v170, v171
  v_mfma_f32_16x16x32_bf16 v[180:183], v[140:143], a[100:103], v[180:183]
  v_cvt_pk_bf16_f32 v198, v172, v173
  v_cvt_pk_bf16_f32 v199, v174, v175
  v_mfma_f32_16x16x32_bf16 v[176:179], v[120:123], a[104:107], v[176:179]
  buffer_store_dwordx4 v[196:199], v4, s[16:19], s56 offen offset:2048 sc1
  buffer_load_dword v14, s[72:75], s43 offen sc1 lds
  v_mfma_f32_16x16x32_bf16 v[180:183], v[144:147], a[104:107], v[180:183]
  s_add_u32 s41, s41, 2097152
  s_xor_b32 s41, s41, 8192
  s_add_u32 s48, s48, 1
  v_mfma_f32_16x16x32_bf16 v[176:179], v[124:127], a[108:111], v[176:179]
  v_mfma_f32_16x16x32_bf16 v[180:183], v[148:151], a[108:111], v[180:183]
  v_mfma_f32_16x16x32_bf16 v[176:179], v[128:131], a[112:115], v[176:179]
  v_mfma_f32_16x16x32_bf16 v[180:183], v[152:155], a[112:115], v[180:183]
  v_mfma_f32_16x16x32_bf16 v[176:179], v[132:135], a[116:119], v[176:179]
  v_mfma_f32_16x16x32_bf16 v[180:183], v[156:159], a[116:119], v[180:183]
  v_mfma_f32_16x16x32_bf16 v[184:187], v[112:115], a[120:123], 0
  v_mfma_f32_16x16x32_bf16 v[188:191], v[136:139], a[120:123], 0
  v_mfma_f32_16x16x32_bf16 v[184:187], v[116:119], a[124:127], v[184:187]
  v_cvt_pk_bf16_f32 v200, v176, v177
  v_cvt_pk_bf16_f32 v201, v178, v179
  v_mfma_f32_16x16x32_bf16 v[188:191], v[140:143], a[124:127], v[188:191]
  v_cvt_pk_bf16_f32 v202, v180, v181
  v_cvt_pk_bf16_f32 v203, v182, v183
  v_mfma_f32_16x16x32_bf16 v[184:187], v[120:123], a[128:131], v[184:187]
  buffer_store_dwordx4 v[200:203], v4, s[16:19], s56 offen offset:3072 sc1
  v_mfma_f32_16x16x32_bf16 v[188:191], v[144:147], a[128:131], v[188:191]
  v_mfma_f32_16x16x32_bf16 v[184:187], v[124:127], a[132:135], v[184:187]
  v_mfma_f32_16x16x32_bf16 v[188:191], v[148:151], a[132:135], v[188:191]
  v_mfma_f32_16x16x32_bf16 v[184:187], v[128:131], a[136:139], v[184:187]
  v_mfma_f32_16x16x32_bf16 v[188:191], v[152:155], a[136:139], v[188:191]
  v_mfma_f32_16x16x32_bf16 v[184:187], v[132:135], a[140:143], v[184:187]
  v_mfma_f32_16x16x32_bf16 v[188:191], v[156:159], a[140:143], v[188:191]
  v_mfma_f32_16x16x32_bf16 v[160:163], v[112:115], a[144:147], 0
  v_mfma_f32_16x16x32_bf16 v[164:167], v[136:139], a[144:147], 0
  v_mfma_f32_16x16x32_bf16 v[160:163], v[116:119], a[148:151], v[160:163]
  v_cvt_pk_bf16_f32 v204, v184, v185
  v_cvt_pk_bf16_f32 v205, v186, v187
  v_mfma_f32_16x16x32_bf16 v[164:167], v[140:143], a[148:151], v[164:167]
  v_cvt_pk_bf16_f32 v206, v188, v189
  v_cvt_pk_bf16_f32 v207, v190, v191
  v_mfma_f32_16x16x32_bf16 v[160:163], v[120:123], a[152:155], v[160:163]
  buffer_store_dwordx4 v[204:207], v4, s[16:19], s57 offen offset:0 sc1
  v_mfma_f32_16x16x32_bf16 v[164:167], v[144:147], a[152:155], v[164:167]
  v_mfma_f32_16x16x32_bf16 v[160:163], v[124:127], a[156:159], v[160:163]
  v_mfma_f32_16x16x32_bf16 v[164:167], v[148:151], a[156:159], v[164:167]
  v_mfma_f32_16x16x32_bf16 v[160:163], v[128:131], a[160:163], v[160:163]
  v_mfma_f32_16x16x32_bf16 v[164:167], v[152:155], a[160:163], v[164:167]
  v_mfma_f32_16x16x32_bf16 v[160:163], v[132:135], a[164:167], v[160:163]
  v_mfma_f32_16x16x32_bf16 v[164:167], v[156:159], a[164:167], v[164:167]
  v_mfma_f32_16x16x32_bf16 v[168:171], v[112:115], a[168:171], 0
  v_mfma_f32_16x16x32_bf16 v[172:175], v[136:139], a[168:171], 0
  v_mfma_f32_16x16x32_bf16 v[168:171], v[116:119], a[172:175], v[168:171]
  v_cvt_pk_bf16_f32 v192, v160, v161
  v_cvt_pk_bf16_f32 v193, v162, v163
  v_mfma_f32_16x16x32_bf16 v[172:175], v[140:143], a[172:175], v[172:175]
  v_cvt_pk_bf16_f32 v194, v164, v165
  v_cvt_pk_bf16_f32 v195, v166, v167
  v_mfma_f32_16x16x32_bf16 v[168:171], v[120:123], a[176:179], v[168:171]
  buffer_store_dwordx4 v[192:195], v4, s[16:19], s57 offen offset:1024 sc1
  v_mfma_f32_16x16x32_bf16 v[172:175], v[144:147], a[176:179], v[172:175]
  v_mfma_f32_16x16x32_bf16 v[168:171], v[124:127], a[180:183], v[168:171]
  v_mfma_f32_16x16x32_bf16 v[172:175], v[148:151], a[180:183], v[172:175]
  v_mfma_f32_16x16x32_bf16 v[168:171], v[128:131], a[184:187], v[168:171]
  v_mfma_f32_16x16x32_bf16 v[172:175], v[152:155], a[184:187], v[172:175]
  v_mfma_f32_16x16x32_bf16 v[168:171], v[132:135], a[188:191], v[168:171]
  v_mfma_f32_16x16x32_bf16 v[172:175], v[156:159], a[188:191], v[172:175]
  v_mfma_f32_16x16x32_bf16 v[176:179], v[112:115], a[192:195], 0
  s_min_u32 s21, s45, 52
  v_mov_b32 v16, s21
  s_waitcnt vmcnt(11)
  v_mfma_f32_16x16x32_bf16 v[180:183], v[136:139], a[192:195], 0
  buffer_store_dword v16, v17, s[72:75], s44 offen sc1
  v_mfma_f32_16x16x32_bf16 v[176:179], v[116:119], a[196:199], v[176:179]
  v_cvt_pk_bf16_f32 v196, v168, v169
  v_cvt_pk_bf16_f32 v197, v170, v171
  v_mfma_f32_16x16x32_bf16 v[180:183], v[140:143], a[196:199], v[180:183]
  v_cvt_pk_bf16_f32 v198, v172, v173
  v_cvt_pk_bf16_f32 v199, v174, v175
  v_mfma_f32_16x16x32_bf16 v[176:179], v[120:123], a[200:203], v[176:179]
  buffer_store_dwordx4 v[196:199], v4, s[16:19], s58 offen offset:1024 sc1
  v_mfma_f32_16x16x32_bf16 v[180:183], v[144:147], a[200:203], v[180:183]
  v_mfma_f32_16x16x32_bf16 v[176:179], v[124:127], a[204:207], v[176:179]
  s_add_u32 s56, s56, 2097152
  s_xor_b32 s56, s56, 8192
  s_add_u32 s59, s58, 524288
  v_mfma_f32_16x16x32_bf16 v[180:183], v[148:151], a[204:207], v[180:183]
  s_xor_b32 s58, s58, s59
  s_lshr_b32 s58, s58, 8
  s_and_b32 s58, s58, 8192
  v_mfma_f32_16x16x32_bf16 v[176:179], v[128:131], a[208:211], v[176:179]
  s_xor_b32 s58, s58, s59
  v_mfma_f32_16x16x32_bf16 v[180:183], v[152:155], a[208:211], v[180:183]
  v_mfma_f32_16x16x32_bf16 v[176:179], v[132:135], a[212:215], v[176:179]
  v_mfma_f32_16x16x32_bf16 v[180:183], v[156:159], a[212:215], v[180:183]
  v_mfma_f32_16x16x32_bf16 v[184:187], v[112:115], a[216:219], 0
  v_mfma_f32_16x16x32_bf16 v[188:191], v[136:139], a[216:219], 0
  v_mfma_f32_16x16x32_bf16 v[184:187], v[116:119], a[220:223], v[184:187]
  v_cvt_pk_bf16_f32 v200, v176, v177
  v_cvt_pk_bf16_f32 v201, v178, v179
  v_mfma_f32_16x16x32_bf16 v[188:191], v[140:143], a[220:223], v[188:191]
  v_cvt_pk_bf16_f32 v202, v180, v181
  v_cvt_pk_bf16_f32 v203, v182, v183
  v_mfma_f32_16x16x32_bf16 v[184:187], v[120:123], a[224:227], v[184:187]
  buffer_store_dwordx4 v[200:203], v4, s[16:19], s57 offen offset:2048 sc1
  v_mfma_f32_16x16x32_bf16 v[188:191], v[144:147], a[224:227], v[188:191]
  v_mfma_f32_16x16x32_bf16 v[184:187], v[124:127], a[228:231], v[184:187]
  s_mov_b32 s51, s57
  s_add_u32 s57, s56, 4096
  s_add_u32 s45, s45, 1
  v_mfma_f32_16x16x32_bf16 v[188:191], v[148:151], a[228:231], v[188:191]
  v_mfma_f32_16x16x32_bf16 v[184:187], v[128:131], a[232:235], v[184:187]
  v_mfma_f32_16x16x32_bf16 v[188:191], v[152:155], a[232:235], v[188:191]
  v_mfma_f32_16x16x32_bf16 v[184:187], v[132:135], a[236:239], v[184:187]
  s_cmp_lt_u32 s45, s46
  v_mfma_f32_16x16x32_bf16 v[188:191], v[156:159], a[236:239], v[188:191]
  s_waitcnt lgkmcnt(0)
  s_cbranch_scc1 vwl_203
  s_nop 7
  v_cvt_pk_bf16_f32 v204, v184, v185
  v_cvt_pk_bf16_f32 v205, v186, v187
  v_cvt_pk_bf16_f32 v206, v188, v189
  v_cvt_pk_bf16_f32 v207, v190, v191
  buffer_store_dwordx4 v[204:207], v4, s[16:19], s51 offen offset:3072 sc1
  s_min_u32 s21, s45, 52
  v_mov_b32 v16, s21
  s_waitcnt vmcnt(0)
  buffer_store_dword v16, v17, s[72:75], s44 offen sc1
  s_cmp_lt_u32 s45, 64
  s_cbranch_scc1 vwr_200
  v_mov_b32 v244, -1
  v_mov_b32 v245, -1
  v_mov_b32 v246, -1
  v_mov_b32 v247, -1
  v_lshlrev_b32 v21, 3, v1
  s_lshr_b32 s21, s2, 2
  s_lshl_b32 s21, s21, 2
  s_add_u32 s21, s21, s20
  s_lshl_b32 s21, s21, 2
  s_and_b32 s22, s2, 3
  s_add_u32 s21, s21, s22
  s_lshl_b32 s21, s21, 14
  s_xor_b32 s22, s21, s80
  s_xor_b32 s21, s22, 117444608
  buffer_store_dwordx4 v[244:247], v4, s[16:19], s21 offen offset:0 sc1
  buffer_store_dwordx4 v[244:247], v4, s[16:19], s21 offen offset:1024 sc1
  buffer_store_dwordx4 v[244:247], v4, s[16:19], s21 offen offset:2048 sc1
  buffer_store_dwordx4 v[244:247], v4, s[16:19], s21 offen offset:3072 sc1
  s_xor_b32 s21, s22, 119549952
  buffer_store_dwordx4 v[244:247], v4, s[16:19], s21 offen offset:0 sc1
  buffer_store_dwordx4 v[244:247], v4, s[16:19], s21 offen offset:1024 sc1
  buffer_store_dwordx4 v[244:247], v4, s[16:19], s21 offen offset:2048 sc1
  buffer_store_dwordx4 v[244:247], v4, s[16:19], s21 offen offset:3072 sc1
  s_xor_b32 s21, s22, 121638912
  buffer_store_dwordx4 v[244:247], v4, s[16:19], s21 offen offset:0 sc1
  buffer_store_dwordx4 v[244:247], v4, s[16:19], s21 offen offset:1024 sc1
  buffer_store_dwordx4 v[244:247], v4, s[16:19], s21 offen offset:2048 sc1
  buffer_store_dwordx4 v[244:247], v4, s[16:19], s21 offen offset:3072 sc1
  s_xor_b32 s21, s22, 123744256
  buffer_store_dwordx4 v[244:247], v4, s[16:19], s21 offen offset:0 sc1
  buffer_store_dwordx4 v[244:247], v4, s[16:19], s21 offen offset:1024 sc1
  buffer_store_dwordx4 v[244:247], v4, s[16:19], s21 offen offset:2048 sc1
  buffer_store_dwordx4 v[244:247], v4, s[16:19], s21 offen offset:3072 sc1
  s_xor_b32 s21, s22, 125833216
  buffer_store_dwordx4 v[244:247], v4, s[16:19], s21 offen offset:0 sc1
  buffer_store_dwordx4 v[244:247], v4, s[16:19], s21 offen offset:1024 sc1
  buffer_store_dwordx4 v[244:247], v4, s[16:19], s21 offen offset:2048 sc1
  buffer_store_dwordx4 v[244:247], v4, s[16:19], s21 offen offset:3072 sc1
  s_xor_b32 s21, s22, 127938560
  buffer_store_dwordx4 v[244:247], v4, s[16:19], s21 offen offset:0 sc1
  buffer_store_dwordx4 v[244:247], v4, s[16:19], s21 offen offset:1024 sc1
  buffer_store_dwordx4 v[244:247], v4, s[16:19], s21 offen offset:2048 sc1
  buffer_store_dwordx4 v[244:247], v4, s[16:19], s21 offen offset:3072 sc1
  s_xor_b32 s21, s22, 130027520
  buffer_store_dwordx4 v[244:247], v4, s[16:19], s21 offen offset:0 sc1
  buffer_store_dwordx4 v[244:247], v4, s[16:19], s21 offen offset:1024 sc1
  buffer_store_dwordx4 v[244:247], v4, s[16:19], s21 offen offset:2048 sc1
  buffer_store_dwordx4 v[244:247], v4, s[16:19], s21 offen offset:3072 sc1
  s_xor_b32 s21, s22, 132132864
  buffer_store_dwordx4 v[244:247], v4, s[16:19], s21 offen offset:0 sc1
  buffer_store_dwordx4 v[244:247], v4, s[16:19], s21 offen offset:1024 sc1
  buffer_store_dwordx4 v[244:247], v4, s[16:19], s21 offen offset:2048 sc1
  buffer_store_dwordx4 v[244:247], v4, s[16:19], s21 offen offset:3072 sc1
  s_and_b32 s21, s2, 3
  s_cmp_lg_u32 s21, s20
  s_cbranch_scc1 arm_204
  s_lshr_b32 s21, s2, 1
  s_lshl_b32 s21, s21, 14
  s_and_b32 s22, s2, 1
  s_mul_i32 s22, s22, 2560
  s_add_u32 s21, s21, s22
  s_xor_b32 s22, s21, s80
  s_xor_b32 s21, s22, 163586048
  buffer_store_dwordx4 v[244:247], v4, s[16:19], s21 offen sc1
  buffer_store_dwordx4 v[244:247], v4, s[16:19], s21 offen offset:1024 sc1
  buffer_store_dwordx2 v[244:245], v21, s[16:19], s21 offen offset:2048 sc1
  s_xor_b32 s21, s22, 164110336
  buffer_store_dwordx4 v[244:247], v4, s[16:19], s21 offen sc1
  buffer_store_dwordx4 v[244:247], v4, s[16:19], s21 offen offset:1024 sc1
  buffer_store_dwordx2 v[244:245], v21, s[16:19], s21 offen offset:2048 sc1
  s_xor_b32 s21, s22, 164634624
  buffer_store_dwordx4 v[244:247], v4, s[16:19], s21 offen sc1
  buffer_store_dwordx4 v[244:247], v4, s[16:19], s21 offen offset:1024 sc1
  buffer_store_dwordx2 v[244:245], v21, s[16:19], s21 offen offset:2048 sc1
  s_xor_b32 s21, s22, 165158912
  buffer_store_dwordx4 v[244:247], v4, s[16:19], s21 offen sc1
  buffer_store_dwordx4 v[244:247], v4, s[16:19], s21 offen offset:1024 sc1
  buffer_store_dwordx2 v[244:245], v21, s[16:19], s21 offen offset:2048 sc1
  s_xor_b32 s21, s22, 165675008
  buffer_store_dwordx4 v[244:247], v4, s[16:19], s21 offen sc1
  buffer_store_dwordx4 v[244:247], v4, s[16:19], s21 offen offset:1024 sc1
  buffer_store_dwordx2 v[244:245], v21, s[16:19], s21 offen offset:2048 sc1
  s_xor_b32 s21, s22, 166199296
  buffer_store_dwordx4 v[244:247], v4, s[16:19], s21 offen sc1
  buffer_store_dwordx4 v[244:247], v4, s[16:19], s21 offen offset:1024 sc1
  buffer_store_dwordx2 v[244:245], v21, s[16:19], s21 offen offset:2048 sc1
  s_xor_b32 s21, s22, 166723584
  buffer_store_dwordx4 v[244:247], v4, s[16:19], s21 offen sc1
  buffer_store_dwordx4 v[244:247], v4, s[16:19], s21 offen offset:1024 sc1
  buffer_store_dwordx2 v[244:245], v21, s[16:19], s21 offen offset:2048 sc1
  s_xor_b32 s21, s22, 167247872
  buffer_store_dwordx4 v[244:247], v4, s[16:19], s21 offen sc1
  buffer_store_dwordx4 v[244:247], v4, s[16:19], s21 offen offset:1024 sc1
  buffer_store_dwordx2 v[244:245], v21, s[16:19], s21 offen offset:2048 sc1
arm_204:
  v_mov_b32 v16, 64
  s_waitcnt vmcnt(0)
  buffer_store_dword v16, v17, s[72:75], s44 offen sc1
  s_branch queue
not_vw:
  s_sub_u32 s2, s3, 96
  s_cmp_lg_u32 s2, 31
  s_cbranch_scc1 not_cal
  s_load_dwordx2 s[72:73], s[0:1], 104
  s_waitcnt lgkmcnt(0)
  s_add_u32 s72, s72, 170983424
  s_addc_u32 s73, s73, 0
  s_mov_b32 s74, 96768
  s_mov_b32 s75, 0x00020000
  v_lshlrev_b32 v8, 4, v0
  v_mov_b32 v4, 0
  v_mov_b32 v5, 0
  v_mov_b32 v6, 0
  v_mov_b32 v7, 0
  s_mov_b32 s21, 0
  buffer_store_dwordx4 v[4:7], v8, s[72:75], s21 offen sc1
  s_mov_b32 s21, 4096
  buffer_store_dwordx4 v[4:7], v8, s[72:75], s21 offen sc1
  s_mov_b32 s21, 8192
  buffer_store_dwordx4 v[4:7], v8, s[72:75], s21 offen sc1
  s_mov_b32 s21, 12288
  buffer_store_dwordx4 v[4:7], v8, s[72:75], s21 offen sc1
  s_mov_b32 s21, 16384
  buffer_store_dwordx4 v[4:7], v8, s[72:75], s21 offen sc1
  s_mov_b32 s21, 20480
  buffer_store_dwordx4 v[4:7], v8, s[72:75], s21 offen sc1
  s_mov_b32 s21, 24576
  buffer_store_dwordx4 v[4:7], v8, s[72:75], s21 offen sc1
  s_mov_b32 s21, 28672
  buffer_store_dwordx4 v[4:7], v8, s[72:75], s21 offen sc1
  s_mov_b32 s21, 32768
  buffer_store_dwordx4 v[4:7], v8, s[72:75], s21 offen sc1
  s_mov_b32 s21, 36864
  buffer_store_dwordx4 v[4:7], v8, s[72:75], s21 offen sc1
  s_mov_b32 s21, 40960
  buffer_store_dwordx4 v[4:7], v8, s[72:75], s21 offen sc1
  s_mov_b32 s21, 45056
  buffer_store_dwordx4 v[4:7], v8, s[72:75], s21 offen sc1
  s_mov_b32 s21, 49152
  buffer_store_dwordx4 v[4:7], v8, s[72:75], s21 offen sc1
  s_mov_b32 s21, 53248
  buffer_store_dwordx4 v[4:7], v8, s[72:75], s21 offen sc1
  s_mov_b32 s21, 57344
  buffer_store_dwordx4 v[4:7], v8, s[72:75], s21 offen sc1
  s_mov_b32 s21, 61440
  buffer_store_dwordx4 v[4:7], v8, s[72:75], s21 offen sc1
  s_mov_b32 s21, 65536
  buffer_store_dwordx4 v[4:7], v8, s[72:75], s21 offen sc1
  s_mov_b32 s21, 69632
  buffer_store_dwordx4 v[4:7], v8, s[72:75], s21 offen sc1
  s_mov_b32 s21, 73728
  buffer_store_dwordx4 v[4:7], v8, s[72:75], s21 offen sc1
  s_mov_b32 s21, 77824
  buffer_store_dwordx4 v[4:7], v8, s[72:75], s21 offen sc1
  s_mov_b32 s21, 81920
  buffer_store_dwordx4 v[4:7], v8, s[72:75], s21 offen sc1
  s_mov_b32 s21, 86016
  buffer_store_dwordx4 v[4:7], v8, s[72:75], s21 offen sc1
  s_mov_b32 s21, 90112
  buffer_store_dwordx4 v[4:7], v8, s[72:75], s21 offen sc1
  s_mov_b32 s21, 94208
  buffer_store_dwordx4 v[4:7], v8, s[72:75], s21 offen sc1
  s_add_u32 s8, s38, 168820736
  s_addc_u32 s9, s39, 0
  s_mov_b32 s10, 131072
  s_mov_b32 s11, 0x00020000
  s_cmp_lg_u32 s20, 0
  s_cbranch_scc1 cal_205
  s_mov_b32 s40, -1
  s_mov_b32 s41, -1
  s_mov_b32 s43, 0
cal_206:
  s_mov_b32 s21, 0
  s_memtime s[98:99]
  s_waitcnt lgkmcnt(0)
  s_buffer_load_dword s22, s[8:11], s21 glc
  s_waitcnt lgkmcnt(0)
  s_memtime s[100:101]
  s_waitcnt lgkmcnt(0)
  s_sub_u32 s21, s100, s98
  s_min_u32 s40, s40, s21
  s_mov_b32 s21, 8192
  s_memtime s[98:99]
  s_waitcnt lgkmcnt(0)
  s_buffer_load_dword s22, s[8:11], s21 glc
  s_waitcnt lgkmcnt(0)
  s_memtime s[100:101]
  s_waitcnt lgkmcnt(0)
  s_sub_u32 s21, s100, s98
  s_min_u32 s41, s41, s21
  s_add_u32 s43, s43, 1
  s_cmp_lt_u32 s43, 6
  s_cbranch_scc1 cal_206
cal_205:
  s_waitcnt vmcnt(0)
  s_barrier
  s_cmp_lg_u32 s20, 0
  s_cbranch_scc1 cal_207
  s_cmp_lt_u32 s41, s40
  s_cselect_b32 s21, 1, 2
  v_mov_b32 v4, s21
  v_mov_b32 v5, s40
  v_mov_b32 v6, s41
  v_mov_b32 v8, 76
  s_mov_b64 exec, 1
  buffer_store_dwordx3 v[4:6], v8, s[32:35], 0 offen sc1
  s_mov_b64 exec, -1
cal_207:
not_cal:
  s_load_dwordx2 s[4:5], s[0:1], 0
  s_load_dwordx2 s[6:7], s[0:1], 64
  s_load_dwordx2 s[36:37], s[0:1], 80
  s_load_dwordx2 s[38:39], s[0:1], 104
  s_lshr_b32 s41, s2, 3
  s_lshl_b32 s41, s41, 1
  s_and_b32 s21, s2, 1
  s_add_u32 s41, s41, s21
  s_bfe_u32 s42, s2, 0x20001
  s_waitcnt lgkmcnt(0)
  s_mov_b32 s8, s4
  s_mov_b32 s9, s5
  s_mov_b32 s10, 2621440
  s_mov_b32 s11, 0x00020000
  s_mov_b32 s12, s6
  s_mov_b32 s13, s7
  s_mov_b32 s14, 2457600
  s_mov_b32 s15, 0x00020000
  s_mov_b32 s24, s36
  s_mov_b32 s25, s37
  s_mov_b32 s26, 1280
  s_mov_b32 s27, 0x00020000
  s_mov_b32 s16, s38
  s_mov_b32 s17, s39
  s_mov_b32 s18, 167772160
  s_mov_b32 s19, 0x00020000
  s_add_u32 s76, s38, 170917888
  s_addc_u32 s77, s39, 0
  s_mov_b32 s78, 8192
  s_mov_b32 s79, 0x00020000
  s_add_u32 s72, s38, 170983424
  s_addc_u32 s73, s39, 0
  s_mov_b32 s74, 96768
  s_mov_b32 s75, 0x00020000
  s_lshl_b32 s59, s2, 2
  s_add_u32 s59, s59, s20
  s_lshl_b32 s59, s59, 4
  v_lshlrev_b32 v4, 2, v1
  s_mul_i32 s22, s59, 1280
  buffer_load_dword v16, v4, s[24:27], 0 offen offset:0
  buffer_load_dword v17, v4, s[24:27], 0 offen offset:256
  buffer_load_dword v18, v4, s[24:27], 0 offen offset:512
  buffer_load_dword v19, v4, s[24:27], 0 offen offset:768
  buffer_load_dword v20, v4, s[24:27], 0 offen offset:1024
  buffer_load_dword v64, v4, s[8:11], s22 offen offset:0
  buffer_load_dword v65, v4, s[8:11], s22 offen offset:256
  buffer_load_dword v66, v4, s[8:11], s22 offen offset:512
  buffer_load_dword v67, v4, s[8:11], s22 offen offset:768
  buffer_load_dword v68, v4, s[8:11], s22 offen offset:1024
  s_add_u32 s22, s22, 1280
  buffer_load_dword v69, v4, s[8:11], s22 offen offset:0
  buffer_load_dword v70, v4, s[8:11], s22 offen offset:256
  buffer_load_dword v71, v4, s[8:11], s22 offen offset:512
  buffer_load_dword v72, v4, s[8:11], s22 offen offset:768
  buffer_load_dword v73, v4, s[8:11], s22 offen offset:1024
  s_add_u32 s22, s22, 1280
  buffer_load_dword v74, v4, s[8:11], s22 offen offset:0
  buffer_load_dword v75, v4, s[8:11], s22 offen offset:256
  buffer_load_dword v76, v4, s[8:11], s22 offen offset:512
  buffer_load_dword v77, v4, s[8:11], s22 offen offset:768
  buffer_load_dword v78, v4, s[8:11], s22 offen offset:1024
  s_add_u32 s22, s22, 1280
  buffer_load_dword v79, v4, s[8:11], s22 offen offset:0
  buffer_load_dword v80, v4, s[8:11], s22 offen offset:256
  buffer_load_dword v81, v4, s[8:11], s22 offen offset:512
  buffer_load_dword v82, v4, s[8:11], s22 offen offset:768
  buffer_load_dword v83, v4, s[8:11], s22 offen offset:1024
  s_add_u32 s22, s22, 1280
  buffer_load_dword v84, v4, s[8:11], s22 offen offset:0
  buffer_load_dword v85, v4, s[8:11], s22 offen offset:256
  buffer_load_dword v86, v4, s[8:11], s22 offen offset:512
  buffer_load_dword v87, v4, s[8:11], s22 offen offset:768
  buffer_load_dword v88, v4, s[8:11], s22 offen offset:1024
  s_add_u32 s22, s22, 1280
  buffer_load_dword v89, v4, s[8:11], s22 offen offset:0
  buffer_load_dword v90, v4, s[8:11], s22 offen offset:256
  buffer_load_dword v91, v4, s[8:11], s22 offen offset:512
  buffer_load_dword v92, v4, s[8:11], s22 offen offset:768
  buffer_load_dword v93, v4, s[8:11], s22 offen offset:1024
  s_add_u32 s22, s22, 1280
  buffer_load_dword v94, v4, s[8:11], s22 offen offset:0
  buffer_load_dword v95, v4, s[8:11], s22 offen offset:256
  buffer_load_dword v96, v4, s[8:11], s22 offen offset:512
  buffer_load_dword v97, v4, s[8:11], s22 offen offset:768
  buffer_load_dword v98, v4, s[8:11], s22 offen offset:1024
  s_add_u32 s22, s22, 1280
  buffer_load_dword v99, v4, s[8:11], s22 offen offset:0
  buffer_load_dword v100, v4, s[8:11], s22 offen offset:256
  buffer_load_dword v101, v4, s[8:11], s22 offen offset:512
  buffer_load_dword v102, v4, s[8:11], s22 offen offset:768
  buffer_load_dword v103, v4, s[8:11], s22 offen offset:1024
  s_add_u32 s22, s22, 1280
  buffer_load_dword v104, v4, s[8:11], s22 offen offset:0
  buffer_load_dword v105, v4, s[8:11], s22 offen offset:256
  buffer_load_dword v106, v4, s[8:11], s22 offen offset:512
  buffer_load_dword v107, v4, s[8:11], s22 offen offset:768
  buffer_load_dword v108, v4, s[8:11], s22 offen offset:1024
  s_add_u32 s22, s22, 1280
  buffer_load_dword v109, v4, s[8:11], s22 offen offset:0
  buffer_load_dword v110, v4, s[8:11], s22 offen offset:256
  buffer_load_dword v111, v4, s[8:11], s22 offen offset:512
  buffer_load_dword v112, v4, s[8:11], s22 offen offset:768
  buffer_load_dword v113, v4, s[8:11], s22 offen offset:1024
  s_add_u32 s22, s22, 1280
  buffer_load_dword v114, v4, s[8:11], s22 offen offset:0
  buffer_load_dword v115, v4, s[8:11], s22 offen offset:256
  buffer_load_dword v116, v4, s[8:11], s22 offen offset:512
  buffer_load_dword v117, v4, s[8:11], s22 offen offset:768
  buffer_load_dword v118, v4, s[8:11], s22 offen offset:1024
  s_add_u32 s22, s22, 1280
  s_waitcnt vmcnt(55)
  v_lshlrev_b32 v8, 16, v16
  v_and_b32 v16, 0xffff0000, v16
  v_lshlrev_b32 v9, 16, v17
  v_and_b32 v17, 0xffff0000, v17
  v_lshlrev_b32 v10, 16, v18
  v_and_b32 v18, 0xffff0000, v18
  v_lshlrev_b32 v11, 16, v19
  v_and_b32 v19, 0xffff0000, v19
  v_lshlrev_b32 v12, 16, v20
  v_and_b32 v20, 0xffff0000, v20
  s_waitcnt vmcnt(50)
  v_mov_b32 v32, 0
  buffer_load_dword v119, v4, s[8:11], s22 offen offset:0
  buffer_load_dword v120, v4, s[8:11], s22 offen offset:256
  buffer_load_dword v121, v4, s[8:11], s22 offen offset:512
  buffer_load_dword v122, v4, s[8:11], s22 offen offset:768
  buffer_load_dword v123, v4, s[8:11], s22 offen offset:1024
  s_add_u32 s22, s22, 1280
  v_lshlrev_b32 v25, 16, v64
  v_and_b32 v26, 0xffff0000, v64
  v_mul_f32 v25, v25, v8
  v_mul_f32 v26, v26, v16
  v_cvt_pk_bf16_f32 v25, v25, v26
  v_lshlrev_b32 v26, 16, v25
  v_and_b32 v25, 0xffff0000, v25
  v_add_f32 v32, v32, v26
  v_add_f32 v32, v32, v25
  v_lshlrev_b32 v25, 16, v65
  v_and_b32 v26, 0xffff0000, v65
  v_mul_f32 v25, v25, v9
  v_mul_f32 v26, v26, v17
  v_cvt_pk_bf16_f32 v25, v25, v26
  v_lshlrev_b32 v26, 16, v25
  v_and_b32 v25, 0xffff0000, v25
  v_add_f32 v32, v32, v26
  v_add_f32 v32, v32, v25
  v_lshlrev_b32 v25, 16, v66
  v_and_b32 v26, 0xffff0000, v66
  v_mul_f32 v25, v25, v10
  v_mul_f32 v26, v26, v18
  v_cvt_pk_bf16_f32 v25, v25, v26
  v_lshlrev_b32 v26, 16, v25
  v_and_b32 v25, 0xffff0000, v25
  v_add_f32 v32, v32, v26
  v_add_f32 v32, v32, v25
  v_lshlrev_b32 v25, 16, v67
  v_and_b32 v26, 0xffff0000, v67
  v_mul_f32 v25, v25, v11
  v_mul_f32 v26, v26, v19
  v_cvt_pk_bf16_f32 v25, v25, v26
  v_lshlrev_b32 v26, 16, v25
  v_and_b32 v25, 0xffff0000, v25
  v_add_f32 v32, v32, v26
  v_add_f32 v32, v32, v25
  v_lshlrev_b32 v25, 16, v68
  v_and_b32 v26, 0xffff0000, v68
  v_mul_f32 v25, v25, v12
  v_mul_f32 v26, v26, v20
  v_cvt_pk_bf16_f32 v25, v25, v26
  v_lshlrev_b32 v26, 16, v25
  v_and_b32 v25, 0xffff0000, v25
  v_add_f32 v32, v32, v26
  v_add_f32 v32, v32, v25
  s_waitcnt vmcnt(50)
  v_mov_b32 v33, 0
  buffer_load_dword v124, v4, s[8:11], s22 offen offset:0
  buffer_load_dword v125, v4, s[8:11], s22 offen offset:256
  buffer_load_dword v126, v4, s[8:11], s22 offen offset:512
  buffer_load_dword v127, v4, s[8:11], s22 offen offset:768
  buffer_load_dword v128, v4, s[8:11], s22 offen offset:1024
  s_add_u32 s22, s22, 1280
  v_lshlrev_b32 v25, 16, v69
  v_and_b32 v26, 0xffff0000, v69
  v_mul_f32 v25, v25, v8
  v_mul_f32 v26, v26, v16
  v_cvt_pk_bf16_f32 v25, v25, v26
  v_lshlrev_b32 v26, 16, v25
  v_and_b32 v25, 0xffff0000, v25
  v_add_f32 v33, v33, v26
  v_add_f32 v33, v33, v25
  v_lshlrev_b32 v25, 16, v70
  v_and_b32 v26, 0xffff0000, v70
  v_mul_f32 v25, v25, v9
  v_mul_f32 v26, v26, v17
  v_cvt_pk_bf16_f32 v25, v25, v26
  v_lshlrev_b32 v26, 16, v25
  v_and_b32 v25, 0xffff0000, v25
  v_add_f32 v33, v33, v26
  v_add_f32 v33, v33, v25
  v_lshlrev_b32 v25, 16, v71
  v_and_b32 v26, 0xffff0000, v71
  v_mul_f32 v25, v25, v10
  v_mul_f32 v26, v26, v18
  v_cvt_pk_bf16_f32 v25, v25, v26
  v_lshlrev_b32 v26, 16, v25
  v_and_b32 v25, 0xffff0000, v25
  v_add_f32 v33, v33, v26
  v_add_f32 v33, v33, v25
  v_lshlrev_b32 v25, 16, v72
  v_and_b32 v26, 0xffff0000, v72
  v_mul_f32 v25, v25, v11
  v_mul_f32 v26, v26, v19
  v_cvt_pk_bf16_f32 v25, v25, v26
  v_lshlrev_b32 v26, 16, v25
  v_and_b32 v25, 0xffff0000, v25
  v_add_f32 v33, v33, v26
  v_add_f32 v33, v33, v25
  v_lshlrev_b32 v25, 16, v73
  v_and_b32 v26, 0xffff0000, v73
  v_mul_f32 v25, v25, v12
  v_mul_f32 v26, v26, v20
  v_cvt_pk_bf16_f32 v25, v25, v26
  v_lshlrev_b32 v26, 16, v25
  v_and_b32 v25, 0xffff0000, v25
  v_add_f32 v33, v33, v26
  v_add_f32 v33, v33, v25
  s_waitcnt vmcnt(50)
  v_mov_b32 v34, 0
  buffer_load_dword v129, v4, s[8:11], s22 offen offset:0
  buffer_load_dword v130, v4, s[8:11], s22 offen offset:256
  buffer_load_dword v131, v4, s[8:11], s22 offen offset:512
  buffer_load_dword v132, v4, s[8:11], s22 offen offset:768
  buffer_load_dword v133, v4, s[8:11], s22 offen offset:1024
  s_add_u32 s22, s22, 1280
  v_lshlrev_b32 v25, 16, v74
  v_and_b32 v26, 0xffff0000, v74
  v_mul_f32 v25, v25, v8
  v_mul_f32 v26, v26, v16
  v_cvt_pk_bf16_f32 v25, v25, v26
  v_lshlrev_b32 v26, 16, v25
  v_and_b32 v25, 0xffff0000, v25
  v_add_f32 v34, v34, v26
  v_add_f32 v34, v34, v25
  v_lshlrev_b32 v25, 16, v75
  v_and_b32 v26, 0xffff0000, v75
  v_mul_f32 v25, v25, v9
  v_mul_f32 v26, v26, v17
  v_cvt_pk_bf16_f32 v25, v25, v26
  v_lshlrev_b32 v26, 16, v25
  v_and_b32 v25, 0xffff0000, v25
  v_add_f32 v34, v34, v26
  v_add_f32 v34, v34, v25
  v_lshlrev_b32 v25, 16, v76
  v_and_b32 v26, 0xffff0000, v76
  v_mul_f32 v25, v25, v10
  v_mul_f32 v26, v26, v18
  v_cvt_pk_bf16_f32 v25, v25, v26
  v_lshlrev_b32 v26, 16, v25
  v_and_b32 v25, 0xffff0000, v25
  v_add_f32 v34, v34, v26
  v_add_f32 v34, v34, v25
  v_lshlrev_b32 v25, 16, v77
  v_and_b32 v26, 0xffff0000, v77
  v_mul_f32 v25, v25, v11
  v_mul_f32 v26, v26, v19
  v_cvt_pk_bf16_f32 v25, v25, v26
  v_lshlrev_b32 v26, 16, v25
  v_and_b32 v25, 0xffff0000, v25
  v_add_f32 v34, v34, v26
  v_add_f32 v34, v34, v25
  v_lshlrev_b32 v25, 16, v78
  v_and_b32 v26, 0xffff0000, v78
  v_mul_f32 v25, v25, v12
  v_mul_f32 v26, v26, v20
  v_cvt_pk_bf16_f32 v25, v25, v26
  v_lshlrev_b32 v26, 16, v25
  v_and_b32 v25, 0xffff0000, v25
  v_add_f32 v34, v34, v26
  v_add_f32 v34, v34, v25
  s_waitcnt vmcnt(50)
  v_mov_b32 v35, 0
  buffer_load_dword v134, v4, s[8:11], s22 offen offset:0
  buffer_load_dword v135, v4, s[8:11], s22 offen offset:256
  buffer_load_dword v136, v4, s[8:11], s22 offen offset:512
  buffer_load_dword v137, v4, s[8:11], s22 offen offset:768
  buffer_load_dword v138, v4, s[8:11], s22 offen offset:1024
  s_add_u32 s22, s22, 1280
  v_lshlrev_b32 v25, 16, v79
  v_and_b32 v26, 0xffff0000, v79
  v_mul_f32 v25, v25, v8
  v_mul_f32 v26, v26, v16
  v_cvt_pk_bf16_f32 v25, v25, v26
  v_lshlrev_b32 v26, 16, v25
  v_and_b32 v25, 0xffff0000, v25
  v_add_f32 v35, v35, v26
  v_add_f32 v35, v35, v25
  v_lshlrev_b32 v25, 16, v80
  v_and_b32 v26, 0xffff0000, v80
  v_mul_f32 v25, v25, v9
  v_mul_f32 v26, v26, v17
  v_cvt_pk_bf16_f32 v25, v25, v26
  v_lshlrev_b32 v26, 16, v25
  v_and_b32 v25, 0xffff0000, v25
  v_add_f32 v35, v35, v26
  v_add_f32 v35, v35, v25
  v_lshlrev_b32 v25, 16, v81
  v_and_b32 v26, 0xffff0000, v81
  v_mul_f32 v25, v25, v10
  v_mul_f32 v26, v26, v18
  v_cvt_pk_bf16_f32 v25, v25, v26
  v_lshlrev_b32 v26, 16, v25
  v_and_b32 v25, 0xffff0000, v25
  v_add_f32 v35, v35, v26
  v_add_f32 v35, v35, v25
  v_lshlrev_b32 v25, 16, v82
  v_and_b32 v26, 0xffff0000, v82
  v_mul_f32 v25, v25, v11
  v_mul_f32 v26, v26, v19
  v_cvt_pk_bf16_f32 v25, v25, v26
  v_lshlrev_b32 v26, 16, v25
  v_and_b32 v25, 0xffff0000, v25
  v_add_f32 v35, v35, v26
  v_add_f32 v35, v35, v25
  v_lshlrev_b32 v25, 16, v83
  v_and_b32 v26, 0xffff0000, v83
  v_mul_f32 v25, v25, v12
  v_mul_f32 v26, v26, v20
  v_cvt_pk_bf16_f32 v25, v25, v26
  v_lshlrev_b32 v26, 16, v25
  v_and_b32 v25, 0xffff0000, v25
  v_add_f32 v35, v35, v26
  v_add_f32 v35, v35, v25
  s_waitcnt vmcnt(50)
  v_mov_b32 v36, 0
  buffer_load_dword v139, v4, s[8:11], s22 offen offset:0
  buffer_load_dword v140, v4, s[8:11], s22 offen offset:256
  buffer_load_dword v141, v4, s[8:11], s22 offen offset:512
  buffer_load_dword v142, v4, s[8:11], s22 offen offset:768
  buffer_load_dword v143, v4, s[8:11], s22 offen offset:1024
  s_add_u32 s22, s22, 1280
  v_lshlrev_b32 v25, 16, v84
  v_and_b32 v26, 0xffff0000, v84
  v_mul_f32 v25, v25, v8
  v_mul_f32 v26, v26, v16
  v_cvt_pk_bf16_f32 v25, v25, v26
  v_lshlrev_b32 v26, 16, v25
  v_and_b32 v25, 0xffff0000, v25
  v_add_f32 v36, v36, v26
  v_add_f32 v36, v36, v25
  v_lshlrev_b32 v25, 16, v85
  v_and_b32 v26, 0xffff0000, v85
  v_mul_f32 v25, v25, v9
  v_mul_f32 v26, v26, v17
  v_cvt_pk_bf16_f32 v25, v25, v26
  v_lshlrev_b32 v26, 16, v25
  v_and_b32 v25, 0xffff0000, v25
  v_add_f32 v36, v36, v26
  v_add_f32 v36, v36, v25
  v_lshlrev_b32 v25, 16, v86
  v_and_b32 v26, 0xffff0000, v86
  v_mul_f32 v25, v25, v10
  v_mul_f32 v26, v26, v18
  v_cvt_pk_bf16_f32 v25, v25, v26
  v_lshlrev_b32 v26, 16, v25
  v_and_b32 v25, 0xffff0000, v25
  v_add_f32 v36, v36, v26
  v_add_f32 v36, v36, v25
  v_lshlrev_b32 v25, 16, v87
  v_and_b32 v26, 0xffff0000, v87
  v_mul_f32 v25, v25, v11
  v_mul_f32 v26, v26, v19
  v_cvt_pk_bf16_f32 v25, v25, v26
  v_lshlrev_b32 v26, 16, v25
  v_and_b32 v25, 0xffff0000, v25
  v_add_f32 v36, v36, v26
  v_add_f32 v36, v36, v25
  v_lshlrev_b32 v25, 16, v88
  v_and_b32 v26, 0xffff0000, v88
  v_mul_f32 v25, v25, v12
  v_mul_f32 v26, v26, v20
  v_cvt_pk_bf16_f32 v25, v25, v26
  v_lshlrev_b32 v26, 16, v25
  v_and_b32 v25, 0xffff0000, v25
  v_add_f32 v36, v36, v26
  v_add_f32 v36, v36, v25
  s_waitcnt vmcnt(50)
  v_mov_b32 v37, 0
  v_lshlrev_b32 v25, 16, v89
  v_and_b32 v26, 0xffff0000, v89
  v_mul_f32 v25, v25, v8
  v_mul_f32 v26, v26, v16
  v_cvt_pk_bf16_f32 v25, v25, v26
  v_lshlrev_b32 v26, 16, v25
  v_and_b32 v25, 0xffff0000, v25
  v_add_f32 v37, v37, v26
  v_add_f32 v37, v37, v25
  v_lshlrev_b32 v25, 16, v90
  v_and_b32 v26, 0xffff0000, v90
  v_mul_f32 v25, v25, v9
  v_mul_f32 v26, v26, v17
  v_cvt_pk_bf16_f32 v25, v25, v26
  v_lshlrev_b32 v26, 16, v25
  v_and_b32 v25, 0xffff0000, v25
  v_add_f32 v37, v37, v26
  v_add_f32 v37, v37, v25
  v_lshlrev_b32 v25, 16, v91
  v_and_b32 v26, 0xffff0000, v91
  v_mul_f32 v25, v25, v10
  v_mul_f32 v26, v26, v18
  v_cvt_pk_bf16_f32 v25, v25, v26
  v_lshlrev_b32 v26, 16, v25
  v_and_b32 v25, 0xffff0000, v25
  v_add_f32 v37, v37, v26
  v_add_f32 v37, v37, v25
  v_lshlrev_b32 v25, 16, v92
  v_and_b32 v26, 0xffff0000, v92
  v_mul_f32 v25, v25, v11
  v_mul_f32 v26, v26, v19
  v_cvt_pk_bf16_f32 v25, v25, v26
  v_lshlrev_b32 v26, 16, v25
  v_and_b32 v25, 0xffff0000, v25
  v_add_f32 v37, v37, v26
  v_add_f32 v37, v37, v25
  v_lshlrev_b32 v25, 16, v93
  v_and_b32 v26, 0xffff0000, v93
  v_mul_f32 v25, v25, v12
  v_mul_f32 v26, v26, v20
  v_cvt_pk_bf16_f32 v25, v25, v26
  v_lshlrev_b32 v26, 16, v25
  v_and_b32 v25, 0xffff0000, v25
  v_add_f32 v37, v37, v26
  v_add_f32 v37, v37, v25
  s_waitcnt vmcnt(45)
  v_mov_b32 v38, 0
  v_lshlrev_b32 v25, 16, v94
  v_and_b32 v26, 0xffff0000, v94
  v_mul_f32 v25, v25, v8
  v_mul_f32 v26, v26, v16
  v_cvt_pk_bf16_f32 v25, v25, v26
  v_lshlrev_b32 v26, 16, v25
  v_and_b32 v25, 0xffff0000, v25
  v_add_f32 v38, v38, v26
  v_add_f32 v38, v38, v25
  v_lshlrev_b32 v25, 16, v95
  v_and_b32 v26, 0xffff0000, v95
  v_mul_f32 v25, v25, v9
  v_mul_f32 v26, v26, v17
  v_cvt_pk_bf16_f32 v25, v25, v26
  v_lshlrev_b32 v26, 16, v25
  v_and_b32 v25, 0xffff0000, v25
  v_add_f32 v38, v38, v26
  v_add_f32 v38, v38, v25
  v_lshlrev_b32 v25, 16, v96
  v_and_b32 v26, 0xffff0000, v96
  v_mul_f32 v25, v25, v10
  v_mul_f32 v26, v26, v18
  v_cvt_pk_bf16_f32 v25, v25, v26
  v_lshlrev_b32 v26, 16, v25
  v_and_b32 v25, 0xffff0000, v25
  v_add_f32 v38, v38, v26
  v_add_f32 v38, v38, v25
  v_lshlrev_b32 v25, 16, v97
  v_and_b32 v26, 0xffff0000, v97
  v_mul_f32 v25, v25, v11
  v_mul_f32 v26, v26, v19
  v_cvt_pk_bf16_f32 v25, v25, v26
  v_lshlrev_b32 v26, 16, v25
  v_and_b32 v25, 0xffff0000, v25
  v_add_f32 v38, v38, v26
  v_add_f32 v38, v38, v25
  v_lshlrev_b32 v25, 16, v98
  v_and_b32 v26, 0xffff0000, v98
  v_mul_f32 v25, v25, v12
  v_mul_f32 v26, v26, v20
  v_cvt_pk_bf16_f32 v25, v25, v26
  v_lshlrev_b32 v26, 16, v25
  v_and_b32 v25, 0xffff0000, v25
  v_add_f32 v38, v38, v26
  v_add_f32 v38, v38, v25
  s_waitcnt vmcnt(40)
  v_mov_b32 v39, 0
  v_lshlrev_b32 v25, 16, v99
  v_and_b32 v26, 0xffff0000, v99
  v_mul_f32 v25, v25, v8
  v_mul_f32 v26, v26, v16
  v_cvt_pk_bf16_f32 v25, v25, v26
  v_lshlrev_b32 v26, 16, v25
  v_and_b32 v25, 0xffff0000, v25
  v_add_f32 v39, v39, v26
  v_add_f32 v39, v39, v25
  v_lshlrev_b32 v25, 16, v100
  v_and_b32 v26, 0xffff0000, v100
  v_mul_f32 v25, v25, v9
  v_mul_f32 v26, v26, v17
  v_cvt_pk_bf16_f32 v25, v25, v26
  v_lshlrev_b32 v26, 16, v25
  v_and_b32 v25, 0xffff0000, v25
  v_add_f32 v39, v39, v26
  v_add_f32 v39, v39, v25
  v_lshlrev_b32 v25, 16, v101
  v_and_b32 v26, 0xffff0000, v101
  v_mul_f32 v25, v25, v10
  v_mul_f32 v26, v26, v18
  v_cvt_pk_bf16_f32 v25, v25, v26
  v_lshlrev_b32 v26, 16, v25
  v_and_b32 v25, 0xffff0000, v25
  v_add_f32 v39, v39, v26
  v_add_f32 v39, v39, v25
  v_lshlrev_b32 v25, 16, v102
  v_and_b32 v26, 0xffff0000, v102
  v_mul_f32 v25, v25, v11
  v_mul_f32 v26, v26, v19
  v_cvt_pk_bf16_f32 v25, v25, v26
  v_lshlrev_b32 v26, 16, v25
  v_and_b32 v25, 0xffff0000, v25
  v_add_f32 v39, v39, v26
  v_add_f32 v39, v39, v25
  v_lshlrev_b32 v25, 16, v103
  v_and_b32 v26, 0xffff0000, v103
  v_mul_f32 v25, v25, v12
  v_mul_f32 v26, v26, v20
  v_cvt_pk_bf16_f32 v25, v25, v26
  v_lshlrev_b32 v26, 16, v25
  v_and_b32 v25, 0xffff0000, v25
  v_add_f32 v39, v39, v26
  v_add_f32 v39, v39, v25
  s_waitcnt vmcnt(35)
  v_mov_b32 v40, 0
  v_lshlrev_b32 v25, 16, v104
  v_and_b32 v26, 0xffff0000, v104
  v_mul_f32 v25, v25, v8
  v_mul_f32 v26, v26, v16
  v_cvt_pk_bf16_f32 v25, v25, v26
  v_lshlrev_b32 v26, 16, v25
  v_and_b32 v25, 0xffff0000, v25
  v_add_f32 v40, v40, v26
  v_add_f32 v40, v40, v25
  v_lshlrev_b32 v25, 16, v105
  v_and_b32 v26, 0xffff0000, v105
  v_mul_f32 v25, v25, v9
  v_mul_f32 v26, v26, v17
  v_cvt_pk_bf16_f32 v25, v25, v26
  v_lshlrev_b32 v26, 16, v25
  v_and_b32 v25, 0xffff0000, v25
  v_add_f32 v40, v40, v26
  v_add_f32 v40, v40, v25
  v_lshlrev_b32 v25, 16, v106
  v_and_b32 v26, 0xffff0000, v106
  v_mul_f32 v25, v25, v10
  v_mul_f32 v26, v26, v18
  v_cvt_pk_bf16_f32 v25, v25, v26
  v_lshlrev_b32 v26, 16, v25
  v_and_b32 v25, 0xffff0000, v25
  v_add_f32 v40, v40, v26
  v_add_f32 v40, v40, v25
  v_lshlrev_b32 v25, 16, v107
  v_and_b32 v26, 0xffff0000, v107
  v_mul_f32 v25, v25, v11
  v_mul_f32 v26, v26, v19
  v_cvt_pk_bf16_f32 v25, v25, v26
  v_lshlrev_b32 v26, 16, v25
  v_and_b32 v25, 0xffff0000, v25
  v_add_f32 v40, v40, v26
  v_add_f32 v40, v40, v25
  v_lshlrev_b32 v25, 16, v108
  v_and_b32 v26, 0xffff0000, v108
  v_mul_f32 v25, v25, v12
  v_mul_f32 v26, v26, v20
  v_cvt_pk_bf16_f32 v25, v25, v26
  v_lshlrev_b32 v26, 16, v25
  v_and_b32 v25, 0xffff0000, v25
  v_add_f32 v40, v40, v26
  v_add_f32 v40, v40, v25
  s_waitcnt vmcnt(30)
  v_mov_b32 v41, 0
  v_lshlrev_b32 v25, 16, v109
  v_and_b32 v26, 0xffff0000, v109
  v_mul_f32 v25, v25, v8
  v_mul_f32 v26, v26, v16
  v_cvt_pk_bf16_f32 v25, v25, v26
  v_lshlrev_b32 v26, 16, v25
  v_and_b32 v25, 0xffff0000, v25
  v_add_f32 v41, v41, v26
  v_add_f32 v41, v41, v25
  v_lshlrev_b32 v25, 16, v110
  v_and_b32 v26, 0xffff0000, v110
  v_mul_f32 v25, v25, v9
  v_mul_f32 v26, v26, v17
  v_cvt_pk_bf16_f32 v25, v25, v26
  v_lshlrev_b32 v26, 16, v25
  v_and_b32 v25, 0xffff0000, v25
  v_add_f32 v41, v41, v26
  v_add_f32 v41, v41, v25
  v_lshlrev_b32 v25, 16, v111
  v_and_b32 v26, 0xffff0000, v111
  v_mul_f32 v25, v25, v10
  v_mul_f32 v26, v26, v18
  v_cvt_pk_bf16_f32 v25, v25, v26
  v_lshlrev_b32 v26, 16, v25
  v_and_b32 v25, 0xffff0000, v25
  v_add_f32 v41, v41, v26
  v_add_f32 v41, v41, v25
  v_lshlrev_b32 v25, 16, v112
  v_and_b32 v26, 0xffff0000, v112
  v_mul_f32 v25, v25, v11
  v_mul_f32 v26, v26, v19
  v_cvt_pk_bf16_f32 v25, v25, v26
  v_lshlrev_b32 v26, 16, v25
  v_and_b32 v25, 0xffff0000, v25
  v_add_f32 v41, v41, v26
  v_add_f32 v41, v41, v25
  v_lshlrev_b32 v25, 16, v113
  v_and_b32 v26, 0xffff0000, v113
  v_mul_f32 v25, v25, v12
  v_mul_f32 v26, v26, v20
  v_cvt_pk_bf16_f32 v25, v25, v26
  v_lshlrev_b32 v26, 16, v25
  v_and_b32 v25, 0xffff0000, v25
  v_add_f32 v41, v41, v26
  v_add_f32 v41, v41, v25
  s_waitcnt vmcnt(25)
  v_mov_b32 v42, 0
  v_lshlrev_b32 v25, 16, v114
  v_and_b32 v26, 0xffff0000, v114
  v_mul_f32 v25, v25, v8
  v_mul_f32 v26, v26, v16
  v_cvt_pk_bf16_f32 v25, v25, v26
  v_lshlrev_b32 v26, 16, v25
  v_and_b32 v25, 0xffff0000, v25
  v_add_f32 v42, v42, v26
  v_add_f32 v42, v42, v25
  v_lshlrev_b32 v25, 16, v115
  v_and_b32 v26, 0xffff0000, v115
  v_mul_f32 v25, v25, v9
  v_mul_f32 v26, v26, v17
  v_cvt_pk_bf16_f32 v25, v25, v26
  v_lshlrev_b32 v26, 16, v25
  v_and_b32 v25, 0xffff0000, v25
  v_add_f32 v42, v42, v26
  v_add_f32 v42, v42, v25
  v_lshlrev_b32 v25, 16, v116
  v_and_b32 v26, 0xffff0000, v116
  v_mul_f32 v25, v25, v10
  v_mul_f32 v26, v26, v18
  v_cvt_pk_bf16_f32 v25, v25, v26
  v_lshlrev_b32 v26, 16, v25
  v_and_b32 v25, 0xffff0000, v25
  v_add_f32 v42, v42, v26
  v_add_f32 v42, v42, v25
  v_lshlrev_b32 v25, 16, v117
  v_and_b32 v26, 0xffff0000, v117
  v_mul_f32 v25, v25, v11
  v_mul_f32 v26, v26, v19
  v_cvt_pk_bf16_f32 v25, v25, v26
  v_lshlrev_b32 v26, 16, v25
  v_and_b32 v25, 0xffff0000, v25
  v_add_f32 v42, v42, v26
  v_add_f32 v42, v42, v25
  v_lshlrev_b32 v25, 16, v118
  v_and_b32 v26, 0xffff0000, v118
  v_mul_f32 v25, v25, v12
  v_mul_f32 v26, v26, v20
  v_cvt_pk_bf16_f32 v25, v25, v26
  v_lshlrev_b32 v26, 16, v25
  v_and_b32 v25, 0xffff0000, v25
  v_add_f32 v42, v42, v26
  v_add_f32 v42, v42, v25
  s_waitcnt vmcnt(20)
  v_mov_b32 v43, 0
  v_lshlrev_b32 v25, 16, v119
  v_and_b32 v26, 0xffff0000, v119
  v_mul_f32 v25, v25, v8
  v_mul_f32 v26, v26, v16
  v_cvt_pk_bf16_f32 v25, v25, v26
  v_lshlrev_b32 v26, 16, v25
  v_and_b32 v25, 0xffff0000, v25
  v_add_f32 v43, v43, v26
  v_add_f32 v43, v43, v25
  v_lshlrev_b32 v25, 16, v120
  v_and_b32 v26, 0xffff0000, v120
  v_mul_f32 v25, v25, v9
  v_mul_f32 v26, v26, v17
  v_cvt_pk_bf16_f32 v25, v25, v26
  v_lshlrev_b32 v26, 16, v25
  v_and_b32 v25, 0xffff0000, v25
  v_add_f32 v43, v43, v26
  v_add_f32 v43, v43, v25
  v_lshlrev_b32 v25, 16, v121
  v_and_b32 v26, 0xffff0000, v121
  v_mul_f32 v25, v25, v10
  v_mul_f32 v26, v26, v18
  v_cvt_pk_bf16_f32 v25, v25, v26
  v_lshlrev_b32 v26, 16, v25
  v_and_b32 v25, 0xffff0000, v25
  v_add_f32 v43, v43, v26
  v_add_f32 v43, v43, v25
  v_lshlrev_b32 v25, 16, v122
  v_and_b32 v26, 0xffff0000, v122
  v_mul_f32 v25, v25, v11
  v_mul_f32 v26, v26, v19
  v_cvt_pk_bf16_f32 v25, v25, v26
  v_lshlrev_b32 v26, 16, v25
  v_and_b32 v25, 0xffff0000, v25
  v_add_f32 v43, v43, v26
  v_add_f32 v43, v43, v25
  v_lshlrev_b32 v25, 16, v123
  v_and_b32 v26, 0xffff0000, v123
  v_mul_f32 v25, v25, v12
  v_mul_f32 v26, v26, v20
  v_cvt_pk_bf16_f32 v25, v25, v26
  v_lshlrev_b32 v26, 16, v25
  v_and_b32 v25, 0xffff0000, v25
  v_add_f32 v43, v43, v26
  v_add_f32 v43, v43, v25
  s_waitcnt vmcnt(15)
  v_mov_b32 v44, 0
  v_lshlrev_b32 v25, 16, v124
  v_and_b32 v26, 0xffff0000, v124
  v_mul_f32 v25, v25, v8
  v_mul_f32 v26, v26, v16
  v_cvt_pk_bf16_f32 v25, v25, v26
  v_lshlrev_b32 v26, 16, v25
  v_and_b32 v25, 0xffff0000, v25
  v_add_f32 v44, v44, v26
  v_add_f32 v44, v44, v25
  v_lshlrev_b32 v25, 16, v125
  v_and_b32 v26, 0xffff0000, v125
  v_mul_f32 v25, v25, v9
  v_mul_f32 v26, v26, v17
  v_cvt_pk_bf16_f32 v25, v25, v26
  v_lshlrev_b32 v26, 16, v25
  v_and_b32 v25, 0xffff0000, v25
  v_add_f32 v44, v44, v26
  v_add_f32 v44, v44, v25
  v_lshlrev_b32 v25, 16, v126
  v_and_b32 v26, 0xffff0000, v126
  v_mul_f32 v25, v25, v10
  v_mul_f32 v26, v26, v18
  v_cvt_pk_bf16_f32 v25, v25, v26
  v_lshlrev_b32 v26, 16, v25
  v_and_b32 v25, 0xffff0000, v25
  v_add_f32 v44, v44, v26
  v_add_f32 v44, v44, v25
  v_lshlrev_b32 v25, 16, v127
  v_and_b32 v26, 0xffff0000, v127
  v_mul_f32 v25, v25, v11
  v_mul_f32 v26, v26, v19
  v_cvt_pk_bf16_f32 v25, v25, v26
  v_lshlrev_b32 v26, 16, v25
  v_and_b32 v25, 0xffff0000, v25
  v_add_f32 v44, v44, v26
  v_add_f32 v44, v44, v25
  v_lshlrev_b32 v25, 16, v128
  v_and_b32 v26, 0xffff0000, v128
  v_mul_f32 v25, v25, v12
  v_mul_f32 v26, v26, v20
  v_cvt_pk_bf16_f32 v25, v25, v26
  v_lshlrev_b32 v26, 16, v25
  v_and_b32 v25, 0xffff0000, v25
  v_add_f32 v44, v44, v26
  v_add_f32 v44, v44, v25
  s_waitcnt vmcnt(10)
  v_mov_b32 v45, 0
  v_lshlrev_b32 v25, 16, v129
  v_and_b32 v26, 0xffff0000, v129
  v_mul_f32 v25, v25, v8
  v_mul_f32 v26, v26, v16
  v_cvt_pk_bf16_f32 v25, v25, v26
  v_lshlrev_b32 v26, 16, v25
  v_and_b32 v25, 0xffff0000, v25
  v_add_f32 v45, v45, v26
  v_add_f32 v45, v45, v25
  v_lshlrev_b32 v25, 16, v130
  v_and_b32 v26, 0xffff0000, v130
  v_mul_f32 v25, v25, v9
  v_mul_f32 v26, v26, v17
  v_cvt_pk_bf16_f32 v25, v25, v26
  v_lshlrev_b32 v26, 16, v25
  v_and_b32 v25, 0xffff0000, v25
  v_add_f32 v45, v45, v26
  v_add_f32 v45, v45, v25
  v_lshlrev_b32 v25, 16, v131
  v_and_b32 v26, 0xffff0000, v131
  v_mul_f32 v25, v25, v10
  v_mul_f32 v26, v26, v18
  v_cvt_pk_bf16_f32 v25, v25, v26
  v_lshlrev_b32 v26, 16, v25
  v_and_b32 v25, 0xffff0000, v25
  v_add_f32 v45, v45, v26
  v_add_f32 v45, v45, v25
  v_lshlrev_b32 v25, 16, v132
  v_and_b32 v26, 0xffff0000, v132
  v_mul_f32 v25, v25, v11
  v_mul_f32 v26, v26, v19
  v_cvt_pk_bf16_f32 v25, v25, v26
  v_lshlrev_b32 v26, 16, v25
  v_and_b32 v25, 0xffff0000, v25
  v_add_f32 v45, v45, v26
  v_add_f32 v45, v45, v25
  v_lshlrev_b32 v25, 16, v133
  v_and_b32 v26, 0xffff0000, v133
  v_mul_f32 v25, v25, v12
  v_mul_f32 v26, v26, v20
  v_cvt_pk_bf16_f32 v25, v25, v26
  v_lshlrev_b32 v26, 16, v25
  v_and_b32 v25, 0xffff0000, v25
  v_add_f32 v45, v45, v26
  v_add_f32 v45, v45, v25
  s_waitcnt vmcnt(5)
  v_mov_b32 v46, 0
  v_lshlrev_b32 v25, 16, v134
  v_and_b32 v26, 0xffff0000, v134
  v_mul_f32 v25, v25, v8
  v_mul_f32 v26, v26, v16
  v_cvt_pk_bf16_f32 v25, v25, v26
  v_lshlrev_b32 v26, 16, v25
  v_and_b32 v25, 0xffff0000, v25
  v_add_f32 v46, v46, v26
  v_add_f32 v46, v46, v25
  v_lshlrev_b32 v25, 16, v135
  v_and_b32 v26, 0xffff0000, v135
  v_mul_f32 v25, v25, v9
  v_mul_f32 v26, v26, v17
  v_cvt_pk_bf16_f32 v25, v25, v26
  v_lshlrev_b32 v26, 16, v25
  v_and_b32 v25, 0xffff0000, v25
  v_add_f32 v46, v46, v26
  v_add_f32 v46, v46, v25
  v_lshlrev_b32 v25, 16, v136
  v_and_b32 v26, 0xffff0000, v136
  v_mul_f32 v25, v25, v10
  v_mul_f32 v26, v26, v18
  v_cvt_pk_bf16_f32 v25, v25, v26
  v_lshlrev_b32 v26, 16, v25
  v_and_b32 v25, 0xffff0000, v25
  v_add_f32 v46, v46, v26
  v_add_f32 v46, v46, v25
  v_lshlrev_b32 v25, 16, v137
  v_and_b32 v26, 0xffff0000, v137
  v_mul_f32 v25, v25, v11
  v_mul_f32 v26, v26, v19
  v_cvt_pk_bf16_f32 v25, v25, v26
  v_lshlrev_b32 v26, 16, v25
  v_and_b32 v25, 0xffff0000, v25
  v_add_f32 v46, v46, v26
  v_add_f32 v46, v46, v25
  v_lshlrev_b32 v25, 16, v138
  v_and_b32 v26, 0xffff0000, v138
  v_mul_f32 v25, v25, v12
  v_mul_f32 v26, v26, v20
  v_cvt_pk_bf16_f32 v25, v25, v26
  v_lshlrev_b32 v26, 16, v25
  v_and_b32 v25, 0xffff0000, v25
  v_add_f32 v46, v46, v26
  v_add_f32 v46, v46, v25
  s_waitcnt vmcnt(0)
  v_mov_b32 v47, 0
  v_lshlrev_b32 v25, 16, v139
  v_and_b32 v26, 0xffff0000, v139
  v_mul_f32 v25, v25, v8
  v_mul_f32 v26, v26, v16
  v_cvt_pk_bf16_f32 v25, v25, v26
  v_lshlrev_b32 v26, 16, v25
  v_and_b32 v25, 0xffff0000, v25
  v_add_f32 v47, v47, v26
  v_add_f32 v47, v47, v25
  v_lshlrev_b32 v25, 16, v140
  v_and_b32 v26, 0xffff0000, v140
  v_mul_f32 v25, v25, v9
  v_mul_f32 v26, v26, v17
  v_cvt_pk_bf16_f32 v25, v25, v26
  v_lshlrev_b32 v26, 16, v25
  v_and_b32 v25, 0xffff0000, v25
  v_add_f32 v47, v47, v26
  v_add_f32 v47, v47, v25
  v_lshlrev_b32 v25, 16, v141
  v_and_b32 v26, 0xffff0000, v141
  v_mul_f32 v25, v25, v10
  v_mul_f32 v26, v26, v18
  v_cvt_pk_bf16_f32 v25, v25, v26
  v_lshlrev_b32 v26, 16, v25
  v_and_b32 v25, 0xffff0000, v25
  v_add_f32 v47, v47, v26
  v_add_f32 v47, v47, v25
  v_lshlrev_b32 v25, 16, v142
  v_and_b32 v26, 0xffff0000, v142
  v_mul_f32 v25, v25, v11
  v_mul_f32 v26, v26, v19
  v_cvt_pk_bf16_f32 v25, v25, v26
  v_lshlrev_b32 v26, 16, v25
  v_and_b32 v25, 0xffff0000, v25
  v_add_f32 v47, v47, v26
  v_add_f32 v47, v47, v25
  v_lshlrev_b32 v25, 16, v143
  v_and_b32 v26, 0xffff0000, v143
  v_mul_f32 v25, v25, v12
  v_mul_f32 v26, v26, v20
  v_cvt_pk_bf16_f32 v25, v25, v26
  v_lshlrev_b32 v26, 16, v25
  v_and_b32 v25, 0xffff0000, v25
  v_add_f32 v47, v47, v26
  v_add_f32 v47, v47, v25
  v_add_f32_dpp v32, v32, v32 row_ror:8 row_mask:0xf bank_mask:0xf
  v_add_f32_dpp v33, v33, v33 row_ror:8 row_mask:0xf bank_mask:0xf
  v_add_f32_dpp v34, v34, v34 row_ror:8 row_mask:0xf bank_mask:0xf
  v_add_f32_dpp v35, v35, v35 row_ror:8 row_mask:0xf bank_mask:0xf
  v_add_f32_dpp v36, v36, v36 row_ror:8 row_mask:0xf bank_mask:0xf
  v_add_f32_dpp v37, v37, v37 row_ror:8 row_mask:0xf bank_mask:0xf
  v_add_f32_dpp v38, v38, v38 row_ror:8 row_mask:0xf bank_mask:0xf
  v_add_f32_dpp v39, v39, v39 row_ror:8 row_mask:0xf bank_mask:0xf
  v_add_f32_dpp v40, v40, v40 row_ror:8 row_mask:0xf bank_mask:0xf
  v_add_f32_dpp v41, v41, v41 row_ror:8 row_mask:0xf bank_mask:0xf
  v_add_f32_dpp v42, v42, v42 row_ror:8 row_mask:0xf bank_mask:0xf
  v_add_f32_dpp v43, v43, v43 row_ror:8 row_mask:0xf bank_mask:0xf
  v_add_f32_dpp v44, v44, v44 row_ror:8 row_mask:0xf bank_mask:0xf
  v_add_f32_dpp v45, v45, v45 row_ror:8 row_mask:0xf bank_mask:0xf
  v_add_f32_dpp v46, v46, v46 row_ror:8 row_mask:0xf bank_mask:0xf
  v_add_f32_dpp v47, v47, v47 row_ror:8 row_mask:0xf bank_mask:0xf
  v_add_f32_dpp v32, v32, v32 row_ror:4 row_mask:0xf bank_mask:0xf
  v_add_f32_dpp v33, v33, v33 row_ror:4 row_mask:0xf bank_mask:0xf
  v_add_f32_dpp v34, v34, v34 row_ror:4 row_mask:0xf bank_mask:0xf
  v_add_f32_dpp v35, v35, v35 row_ror:4 row_mask:0xf bank_mask:0xf
  v_add_f32_dpp v36, v36, v36 row_ror:4 row_mask:0xf bank_mask:0xf
  v_add_f32_dpp v37, v37, v37 row_ror:4 row_mask:0xf bank_mask:0xf
  v_add_f32_dpp v38, v38, v38 row_ror:4 row_mask:0xf bank_mask:0xf
  v_add_f32_dpp v39, v39, v39 row_ror:4 row_mask:0xf bank_mask:0xf
  v_add_f32_dpp v40, v40, v40 row_ror:4 row_mask:0xf bank_mask:0xf
  v_add_f32_dpp v41, v41, v41 row_ror:4 row_mask:0xf bank_mask:0xf
  v_add_f32_dpp v42, v42, v42 row_ror:4 row_mask:0xf bank_mask:0xf
  v_add_f32_dpp v43, v43, v43 row_ror:4 row_mask:0xf bank_mask:0xf
  v_add_f32_dpp v44, v44, v44 row_ror:4 row_mask:0xf bank_mask:0xf
  v_add_f32_dpp v45, v45, v45 row_ror:4 row_mask:0xf bank_mask:0xf
  v_add_f32_dpp v46, v46, v46 row_ror:4 row_mask:0xf bank_mask:0xf
  v_add_f32_dpp v47, v47, v47 row_ror:4 row_mask:0xf bank_mask:0xf
  v_add_f32_dpp v32, v32, v32 row_ror:2 row_mask:0xf bank_mask:0xf
  v_add_f32_dpp v33, v33, v33 row_ror:2 row_mask:0xf bank_mask:0xf
  v_add_f32_dpp v34, v34, v34 row_ror:2 row_mask:0xf bank_mask:0xf
  v_add_f32_dpp v35, v35, v35 row_ror:2 row_mask:0xf bank_mask:0xf
  v_add_f32_dpp v36, v36, v36 row_ror:2 row_mask:0xf bank_mask:0xf
  v_add_f32_dpp v37, v37, v37 row_ror:2 row_mask:0xf bank_mask:0xf
  v_add_f32_dpp v38, v38, v38 row_ror:2 row_mask:0xf bank_mask:0xf
  v_add_f32_dpp v39, v39, v39 row_ror:2 row_mask:0xf bank_mask:0xf
  v_add_f32_dpp v40, v40, v40 row_ror:2 row_mask:0xf bank_mask:0xf
  v_add_f32_dpp v41, v41, v41 row_ror:2 row_mask:0xf bank_mask:0xf
  v_add_f32_dpp v42, v42, v42 row_ror:2 row_mask:0xf bank_mask:0xf
  v_add_f32_dpp v43, v43, v43 row_ror:2 row_mask:0xf bank_mask:0xf
  v_add_f32_dpp v44, v44, v44 row_ror:2 row_mask:0xf bank_mask:0xf
  v_add_f32_dpp v45, v45, v45 row_ror:2 row_mask:0xf bank_mask:0xf
  v_add_f32_dpp v46, v46, v46 row_ror:2 row_mask:0xf bank_mask:0xf
  v_add_f32_dpp v47, v47, v47 row_ror:2 row_mask:0xf bank_mask:0xf
  v_add_f32_dpp v32, v32, v32 row_ror:1 row_mask:0xf bank_mask:0xf
  v_add_f32_dpp v33, v33, v33 row_ror:1 row_mask:0xf bank_mask:0xf
  v_add_f32_dpp v34, v34, v34 row_ror:1 row_mask:0xf bank_mask:0xf
  v_add_f32_dpp v35, v35, v35 row_ror:1 row_mask:0xf bank_mask:0xf
  v_add_f32_dpp v36, v36, v36 row_ror:1 row_mask:0xf bank_mask:0xf
  v_add_f32_dpp v37, v37, v37 row_ror:1 row_mask:0xf bank_mask:0xf
  v_add_f32_dpp v38, v38, v38 row_ror:1 row_mask:0xf bank_mask:0xf
  v_add_f32_dpp v39, v39, v39 row_ror:1 row_mask:0xf bank_mask:0xf
  v_add_f32_dpp v40, v40, v40 row_ror:1 row_mask:0xf bank_mask:0xf
  v_add_f32_dpp v41, v41, v41 row_ror:1 row_mask:0xf bank_mask:0xf
  v_add_f32_dpp v42, v42, v42 row_ror:1 row_mask:0xf bank_mask:0xf
  v_add_f32_dpp v43, v43, v43 row_ror:1 row_mask:0xf bank_mask:0xf
  v_add_f32_dpp v44, v44, v44 row_ror:1 row_mask:0xf bank_mask:0xf
  v_add_f32_dpp v45, v45, v45 row_ror:1 row_mask:0xf bank_mask:0xf
  v_add_f32_dpp v46, v46, v46 row_ror:1 row_mask:0xf bank_mask:0xf
  v_add_f32_dpp v47, v47, v47 row_ror:1 row_mask:0xf bank_mask:0xf
  v_mov_b32 v24, v32
  v_cmp_eq_u32 vcc, 1, v2
  s_nop 1
  v_cndmask_b32 v24, v24, v33, vcc
  v_cmp_eq_u32 vcc, 2, v2
  s_nop 1
  v_cndmask_b32 v24, v24, v34, vcc
  v_cmp_eq_u32 vcc, 3, v2
  s_nop 1
  v_cndmask_b32 v24, v24, v35, vcc
  v_cmp_eq_u32 vcc, 4, v2
  s_nop 1
  v_cndmask_b32 v24, v24, v36, vcc
  v_cmp_eq_u32 vcc, 5, v2
  s_nop 1
  v_cndmask_b32 v24, v24, v37, vcc
  v_cmp_eq_u32 vcc, 6, v2
  s_nop 1
  v_cndmask_b32 v24, v24, v38, vcc
  v_cmp_eq_u32 vcc, 7, v2
  s_nop 1
  v_cndmask_b32 v24, v24, v39, vcc
  v_cmp_eq_u32 vcc, 8, v2
  s_nop 1
  v_cndmask_b32 v24, v24, v40, vcc
  v_cmp_eq_u32 vcc, 9, v2
  s_nop 1
  v_cndmask_b32 v24, v24, v41, vcc
  v_cmp_eq_u32 vcc, 10, v2
  s_nop 1
  v_cndmask_b32 v24, v24, v42, vcc
  v_cmp_eq_u32 vcc, 11, v2
  s_nop 1
  v_cndmask_b32 v24, v24, v43, vcc
  v_cmp_eq_u32 vcc, 12, v2
  s_nop 1
  v_cndmask_b32 v24, v24, v44, vcc
  v_cmp_eq_u32 vcc, 13, v2
  s_nop 1
  v_cndmask_b32 v24, v24, v45, vcc
  v_cmp_eq_u32 vcc, 14, v2
  s_nop 1
  v_cndmask_b32 v24, v24, v46, vcc
  v_cmp_eq_u32 vcc, 15, v2
  s_nop 1
  v_cndmask_b32 v24, v24, v47, vcc
  v_mov_b32 v25, v24
  s_nop 1
  v_permlane32_swap_b32 v24, v25
  v_add_f32 v24, v24, v25
  v_mov_b32 v25, v24
  s_nop 1
  v_permlane16_swap_b32 v24, v25
  v_add_f32 v24, v24, v25
  v_cvt_pk_bf16_f32 v25, v24, v24
  v_lshlrev_b32 v24, 16, v25
  v_mul_f32 v24, 0xbfb8aa3b, v24
  v_exp_f32 v24, v24
  s_nop 0
  v_add_f32 v24, 1.0, v24
  v_rcp_f32 v24, v24
  s_nop 0
  v_cvt_pk_bf16_f32 v25, v24, v24
  v_lshlrev_b32 v24, 16, v25
  s_lshl_b32 s21, s59, 2
  s_mov_b64 exec, 0xffff
  buffer_store_dword v24, v4, s[76:79], s21 offen sc1
  s_mov_b64 exec, -1
  s_sleep 127
  v_lshrrev_b32 v8, 5, v1
  v_or_b32 v9, 0, v8
  v_and_b32 v10, 31, v1
  v_lshlrev_b32 v9, 1, v9
  v_xor_b32 v10, v10, v9
  v_mul_u32_u24 v9, 6554, v10
  v_lshrrev_b32 v9, 16, v9
  v_mul_u32_u24 v11, 1120, v9
  v_lshl_add_u32 v11, v10, 4, v11
  v_mul_u32_u24 v8, 3840, v8
  v_add_u32 v11, v11, v8
  v_mov_b32 v9, 1073741824
  v_cmp_gt_u32 vcc, 30, v10
  s_nop 1
  v_cndmask_b32 v4, v9, v11, vcc
  v_lshrrev_b32 v8, 5, v1
  v_or_b32 v9, 2, v8
  v_and_b32 v10, 31, v1
  v_lshlrev_b32 v9, 1, v9
  v_xor_b32 v10, v10, v9
  v_mul_u32_u24 v9, 6554, v10
  v_lshrrev_b32 v9, 16, v9
  v_mul_u32_u24 v11, 1120, v9
  v_lshl_add_u32 v11, v10, 4, v11
  v_mul_u32_u24 v8, 3840, v8
  v_add_u32 v11, v11, v8
  v_mov_b32 v9, 1073741824
  v_cmp_gt_u32 vcc, 30, v10
  s_nop 1
  v_cndmask_b32 v5, v9, v11, vcc
  v_lshrrev_b32 v8, 5, v1
  v_or_b32 v9, 4, v8
  v_and_b32 v10, 31, v1
  v_lshlrev_b32 v9, 1, v9
  v_xor_b32 v10, v10, v9
  v_mul_u32_u24 v9, 6554, v10
  v_lshrrev_b32 v9, 16, v9
  v_mul_u32_u24 v11, 1120, v9
  v_lshl_add_u32 v11, v10, 4, v11
  v_mul_u32_u24 v8, 3840, v8
  v_add_u32 v11, v11, v8
  v_mov_b32 v9, 1073741824
  v_cmp_gt_u32 vcc, 30, v10
  s_nop 1
  v_cndmask_b32 v6, v9, v11, vcc
  v_lshrrev_b32 v8, 5, v1
  v_or_b32 v9, 6, v8
  v_and_b32 v10, 31, v1
  v_lshlrev_b32 v9, 1, v9
  v_xor_b32 v10, v10, v9
  v_mul_u32_u24 v9, 6554, v10
  v_lshrrev_b32 v9, 16, v9
  v_mul_u32_u24 v11, 1120, v9
  v_lshl_add_u32 v11, v10, 4, v11
  v_mul_u32_u24 v8, 3840, v8
  v_add_u32 v11, v11, v8
  v_mov_b32 v9, 1073741824
  v_cmp_gt_u32 vcc, 30, v10
  s_nop 1
  v_cndmask_b32 v7, v9, v11, vcc
  s_mul_i32 s44, s41, 160
  s_mul_i32 s21, s20, 122880
  s_add_u32 s44, s44, s21
  s_lshl_b32 s45, s20, 14
  s_add_u32 s21, s44, 0
  s_add_u32 m0, s45, 0
  s_nop 0
  buffer_load_dwordx4 v4, s[12:15], s21 offen lds
  s_add_u32 s21, s44, 7680
  s_add_u32 m0, s45, 1024
  s_nop 0
  buffer_load_dwordx4 v5, s[12:15], s21 offen lds
  s_add_u32 s21, s44, 15360
  s_add_u32 m0, s45, 2048
  s_nop 0
  buffer_load_dwordx4 v4, s[12:15], s21 offen lds
  s_add_u32 s21, s44, 23040
  s_add_u32 m0, s45, 3072
  s_nop 0
  buffer_load_dwordx4 v5, s[12:15], s21 offen lds
  s_add_u32 s21, s44, 30720
  s_add_u32 m0, s45, 4096
  s_nop 0
  buffer_load_dwordx4 v6, s[12:15], s21 offen lds
  s_add_u32 s21, s44, 38400
  s_add_u32 m0, s45, 5120
  s_nop 0
  buffer_load_dwordx4 v7, s[12:15], s21 offen lds
  s_add_u32 s21, s44, 46080
  s_add_u32 m0, s45, 6144
  s_nop 0
  buffer_load_dwordx4 v6, s[12:15], s21 offen lds
  s_add_u32 s21, s44, 53760
  s_add_u32 m0, s45, 7168
  s_nop 0
  buffer_load_dwordx4 v7, s[12:15], s21 offen lds
  s_add_u32 s21, s44, 61440
  s_add_u32 m0, s45, 8192
  s_nop 0
  buffer_load_dwordx4 v4, s[12:15], s21 offen lds
  s_add_u32 s21, s44, 69120
  s_add_u32 m0, s45, 9216
  s_nop 0
  buffer_load_dwordx4 v5, s[12:15], s21 offen lds
  s_add_u32 s21, s44, 76800
  s_add_u32 m0, s45, 10240
  s_nop 0
  buffer_load_dwordx4 v4, s[12:15], s21 offen lds
  s_add_u32 s21, s44, 84480
  s_add_u32 m0, s45, 11264
  s_nop 0
  buffer_load_dwordx4 v5, s[12:15], s21 offen lds
  s_add_u32 s21, s44, 92160
  s_add_u32 m0, s45, 12288
  s_nop 0
  buffer_load_dwordx4 v6, s[12:15], s21 offen lds
  s_add_u32 s21, s44, 99840
  s_add_u32 m0, s45, 13312
  s_nop 0
  buffer_load_dwordx4 v7, s[12:15], s21 offen lds
  s_add_u32 s21, s44, 107520
  s_add_u32 m0, s45, 14336
  s_nop 0
  buffer_load_dwordx4 v6, s[12:15], s21 offen lds
  s_add_u32 s21, s44, 115200
  s_add_u32 m0, s45, 15360
  s_nop 0
  buffer_load_dwordx4 v7, s[12:15], s21 offen lds
  s_add_u32 s21, s44, 491520
  s_add_u32 m0, s45, 65536
  s_nop 0
  buffer_load_dwordx4 v4, s[12:15], s21 offen lds
  s_add_u32 s21, s44, 499200
  s_add_u32 m0, s45, 66560
  s_nop 0
  buffer_load_dwordx4 v5, s[12:15], s21 offen lds
  s_add_u32 s21, s44, 506880
  s_add_u32 m0, s45, 67584
  s_nop 0
  buffer_load_dwordx4 v4, s[12:15], s21 offen lds
  s_add_u32 s21, s44, 514560
  s_add_u32 m0, s45, 68608
  s_nop 0
  buffer_load_dwordx4 v5, s[12:15], s21 offen lds
  s_add_u32 s21, s44, 522240
  s_add_u32 m0, s45, 69632
  s_nop 0
  buffer_load_dwordx4 v6, s[12:15], s21 offen lds
  s_add_u32 s21, s44, 529920
  s_add_u32 m0, s45, 70656
  s_nop 0
  buffer_load_dwordx4 v7, s[12:15], s21 offen lds
  s_add_u32 s21, s44, 537600
  s_add_u32 m0, s45, 71680
  s_nop 0
  buffer_load_dwordx4 v6, s[12:15], s21 offen lds
  s_add_u32 s21, s44, 545280
  s_add_u32 m0, s45, 72704
  s_nop 0
  buffer_load_dwordx4 v7, s[12:15], s21 offen lds
  s_add_u32 s21, s44, 552960
  s_add_u32 m0, s45, 73728
  s_nop 0
  buffer_load_dwordx4 v4, s[12:15], s21 offen lds
  s_add_u32 s21, s44, 560640
  s_add_u32 m0, s45, 74752
  s_nop 0
  buffer_load_dwordx4 v5, s[12:15], s21 offen lds
  s_add_u32 s21, s44, 568320
  s_add_u32 m0, s45, 75776
  s_nop 0
  buffer_load_dwordx4 v4, s[12:15], s21 offen lds
  s_add_u32 s21, s44, 576000
  s_add_u32 m0, s45, 76800
  s_nop 0
  buffer_load_dwordx4 v5, s[12:15], s21 offen lds
  s_add_u32 s21, s44, 583680
  s_add_u32 m0, s45, 77824
  s_nop 0
  buffer_load_dwordx4 v6, s[12:15], s21 offen lds
  s_add_u32 s21, s44, 591360
  s_add_u32 m0, s45, 78848
  s_nop 0
  buffer_load_dwordx4 v7, s[12:15], s21 offen lds
  s_add_u32 s21, s44, 599040
  s_add_u32 m0, s45, 79872
  s_nop 0
  buffer_load_dwordx4 v6, s[12:15], s21 offen lds
  s_add_u32 s21, s44, 606720
  s_add_u32 m0, s45, 80896
  s_nop 0
  buffer_load_dwordx4 v7, s[12:15], s21 offen lds
  s_add_u32 s21, s44, 983040
  buffer_load_dwordx4 v[64:67], v4, s[12:15], s21 offen
  s_add_u32 s21, s44, 990720
  buffer_load_dwordx4 v[68:71], v5, s[12:15], s21 offen
  s_add_u32 s21, s44, 998400
  buffer_load_dwordx4 v[72:75], v4, s[12:15], s21 offen
  s_add_u32 s21, s44, 1006080
  buffer_load_dwordx4 v[76:79], v5, s[12:15], s21 offen
  s_add_u32 s21, s44, 1013760
  buffer_load_dwordx4 v[80:83], v6, s[12:15], s21 offen
  s_add_u32 s21, s44, 1021440
  buffer_load_dwordx4 v[84:87], v7, s[12:15], s21 offen
  s_add_u32 s21, s44, 1029120
  buffer_load_dwordx4 v[88:91], v6, s[12:15], s21 offen
  s_add_u32 s21, s44, 1036800
  buffer_load_dwordx4 v[92:95], v7, s[12:15], s21 offen
  s_add_u32 s21, s44, 1044480
  buffer_load_dwordx4 v[96:99], v4, s[12:15], s21 offen
  s_add_u32 s21, s44, 1052160
  buffer_load_dwordx4 v[100:103], v5, s[12:15], s21 offen
  s_add_u32 s21, s44, 1059840
  buffer_load_dwordx4 v[104:107], v4, s[12:15], s21 offen
  s_add_u32 s21, s44, 1067520
  buffer_load_dwordx4 v[108:111], v5, s[12:15], s21 offen
  s_add_u32 s21, s44, 1075200
  buffer_load_dwordx4 v[112:115], v6, s[12:15], s21 offen
  s_add_u32 s21, s44, 1082880
  buffer_load_dwordx4 v[116:119], v7, s[12:15], s21 offen
  s_add_u32 s21, s44, 1090560
  buffer_load_dwordx4 v[120:123], v6, s[12:15], s21 offen
  s_add_u32 s21, s44, 1098240
  buffer_load_dwordx4 v[124:127], v7, s[12:15], s21 offen
  v_lshrrev_b32 v8, 2, v2
  v_and_b32 v9, 1, v3
  v_lshl_add_u32 v9, v9, 2, v8
  v_lshlrev_b32 v9, 5, v9
  v_lshl_add_u32 v8, v3, 3, v8
  v_lshlrev_b32 v8, 9, v8
  v_and_b32 v10, 3, v2
  s_mul_i32 s21, s20, 40
  v_lshl_add_u32 v11, v10, 3, s21
  v_add_u32 v11, 0, v11
  v_xor_b32 v11, v11, v9
  v_add_u32 v12, v11, v8
  v_add_u32 v16, 65536, v12
  v_lshl_add_u32 v11, v10, 3, s21
  v_add_u32 v11, 160, v11
  v_xor_b32 v11, v11, v9
  v_add_u32 v13, v11, v8
  v_add_u32 v17, 65536, v13
  v_mul_u32_u24 v11, 160, v10
  v_add3_u32 v11, v11, 32, s21
  v_min_u32 v11, 480, v11
  v_xor_b32 v11, v11, v9
  v_add_u32 v14, v11, v8
  v_add_u32 v18, 65536, v14
  v_lshl_add_u32 v11, v10, 3, s21
  v_add_u32 v11, 320, v11
  v_xor_b32 v11, v11, v9
  v_add_u32 v15, v11, v8
  v_add_u32 v19, 65536, v15
  v_lshl_add_u32 v23, v1, 4, s45
  v_add_u32 v29, 65536, v23
  s_waitcnt vmcnt(32)
  s_add_u32 s21, s44, 1474560
  buffer_load_dwordx4 v[128:131], v4, s[12:15], s21 offen
  s_add_u32 s21, s44, 1482240
  buffer_load_dwordx4 v[132:135], v5, s[12:15], s21 offen
  s_add_u32 s21, s44, 1489920
  buffer_load_dwordx4 v[136:139], v4, s[12:15], s21 offen
  s_add_u32 s21, s44, 1497600
  buffer_load_dwordx4 v[140:143], v5, s[12:15], s21 offen
  s_add_u32 s21, s44, 1505280
  buffer_load_dwordx4 v[144:147], v6, s[12:15], s21 offen
  s_add_u32 s21, s44, 1512960
  buffer_load_dwordx4 v[148:151], v7, s[12:15], s21 offen
  s_add_u32 s21, s44, 1520640
  buffer_load_dwordx4 v[152:155], v6, s[12:15], s21 offen
  s_add_u32 s21, s44, 1528320
  buffer_load_dwordx4 v[156:159], v7, s[12:15], s21 offen
  s_add_u32 s21, s44, 1536000
  buffer_load_dwordx4 v[160:163], v4, s[12:15], s21 offen
  s_add_u32 s21, s44, 1543680
  buffer_load_dwordx4 v[164:167], v5, s[12:15], s21 offen
  s_add_u32 s21, s44, 1551360
  buffer_load_dwordx4 v[168:171], v4, s[12:15], s21 offen
  s_add_u32 s21, s44, 1559040
  buffer_load_dwordx4 v[172:175], v5, s[12:15], s21 offen
  s_add_u32 s21, s44, 1566720
  buffer_load_dwordx4 v[176:179], v6, s[12:15], s21 offen
  s_add_u32 s21, s44, 1574400
  buffer_load_dwordx4 v[180:183], v7, s[12:15], s21 offen
  s_add_u32 s21, s44, 1582080
  buffer_load_dwordx4 v[184:187], v6, s[12:15], s21 offen
  s_add_u32 s21, s44, 1589760
  buffer_load_dwordx4 v[188:191], v7, s[12:15], s21 offen
  s_barrier
  ds_read_b64_tr_b16 a[0:1], v12 offset:0
  ds_read_b64_tr_b16 a[2:3], v12 offset:2048
  ds_read_b64_tr_b16 a[4:5], v13 offset:0
  ds_read_b64_tr_b16 a[6:7], v13 offset:2048
  ds_read_b64_tr_b16 a[8:9], v14 offset:0
  ds_read_b64_tr_b16 a[10:11], v14 offset:2048
  ds_read_b64_tr_b16 a[12:13], v15 offset:0
  ds_read_b64_tr_b16 a[14:15], v15 offset:2048
  ds_read_b64_tr_b16 a[16:17], v12 offset:16384
  ds_read_b64_tr_b16 a[18:19], v12 offset:18432
  ds_read_b64_tr_b16 a[20:21], v13 offset:16384
  ds_read_b64_tr_b16 a[22:23], v13 offset:18432
  ds_read_b64_tr_b16 a[24:25], v14 offset:16384
  ds_read_b64_tr_b16 a[26:27], v14 offset:18432
  ds_read_b64_tr_b16 a[28:29], v15 offset:16384
  ds_read_b64_tr_b16 a[30:31], v15 offset:18432
  ds_read_b64_tr_b16 a[32:33], v12 offset:32768
  ds_read_b64_tr_b16 a[34:35], v12 offset:34816
  ds_read_b64_tr_b16 a[36:37], v13 offset:32768
  ds_read_b64_tr_b16 a[38:39], v13 offset:34816
  ds_read_b64_tr_b16 a[40:41], v14 offset:32768
  ds_read_b64_tr_b16 a[42:43], v14 offset:34816
  ds_read_b64_tr_b16 a[44:45], v15 offset:32768
  ds_read_b64_tr_b16 a[46:47], v15 offset:34816
  ds_read_b64_tr_b16 a[48:49], v12 offset:49152
  ds_read_b64_tr_b16 a[50:51], v12 offset:51200
  ds_read_b64_tr_b16 a[52:53], v13 offset:49152
  ds_read_b64_tr_b16 a[54:55], v13 offset:51200
  ds_read_b64_tr_b16 a[56:57], v14 offset:49152
  ds_read_b64_tr_b16 a[58:59], v14 offset:51200
  ds_read_b64_tr_b16 a[60:61], v15 offset:49152
  ds_read_b64_tr_b16 a[62:63], v15 offset:51200
  s_waitcnt lgkmcnt(0)
  s_barrier
  s_waitcnt vmcnt(32)
  s_add_u32 s21, s44, 1966080
  buffer_load_dwordx4 v[192:195], v4, s[12:15], s21 offen
  s_add_u32 s21, s44, 1973760
  buffer_load_dwordx4 v[196:199], v5, s[12:15], s21 offen
  s_add_u32 s21, s44, 1981440
  buffer_load_dwordx4 v[200:203], v4, s[12:15], s21 offen
  s_add_u32 s21, s44, 1989120
  buffer_load_dwordx4 v[204:207], v5, s[12:15], s21 offen
  s_add_u32 s21, s44, 1996800
  buffer_load_dwordx4 v[208:211], v6, s[12:15], s21 offen
  s_add_u32 s21, s44, 2004480
  buffer_load_dwordx4 v[212:215], v7, s[12:15], s21 offen
  s_add_u32 s21, s44, 2012160
  buffer_load_dwordx4 v[216:219], v6, s[12:15], s21 offen
  s_add_u32 s21, s44, 2019840
  buffer_load_dwordx4 v[220:223], v7, s[12:15], s21 offen
  s_add_u32 s21, s44, 2027520
  buffer_load_dwordx4 v[224:227], v4, s[12:15], s21 offen
  s_add_u32 s21, s44, 2035200
  buffer_load_dwordx4 v[228:231], v5, s[12:15], s21 offen
  s_add_u32 s21, s44, 2042880
  buffer_load_dwordx4 v[232:235], v4, s[12:15], s21 offen
  s_add_u32 s21, s44, 2050560
  buffer_load_dwordx4 v[236:239], v5, s[12:15], s21 offen
  s_add_u32 s21, s44, 2058240
  buffer_load_dwordx4 v[240:243], v6, s[12:15], s21 offen
  s_add_u32 s21, s44, 2065920
  buffer_load_dwordx4 v[244:247], v7, s[12:15], s21 offen
  s_add_u32 s21, s44, 2073600
  buffer_load_dwordx4 v[248:251], v6, s[12:15], s21 offen
  s_add_u32 s21, s44, 2081280
  buffer_load_dwordx4 v[252:255], v7, s[12:15], s21 offen
  s_barrier
  ds_read_b64_tr_b16 a[64:65], v16 offset:0
  ds_read_b64_tr_b16 a[66:67], v16 offset:2048
  ds_read_b64_tr_b16 a[68:69], v17 offset:0
  ds_read_b64_tr_b16 a[70:71], v17 offset:2048
  ds_read_b64_tr_b16 a[72:73], v18 offset:0
  ds_read_b64_tr_b16 a[74:75], v18 offset:2048
  ds_read_b64_tr_b16 a[76:77], v19 offset:0
  ds_read_b64_tr_b16 a[78:79], v19 offset:2048
  ds_read_b64_tr_b16 a[80:81], v16 offset:16384
  ds_read_b64_tr_b16 a[82:83], v16 offset:18432
  ds_read_b64_tr_b16 a[84:85], v17 offset:16384
  ds_read_b64_tr_b16 a[86:87], v17 offset:18432
  ds_read_b64_tr_b16 a[88:89], v18 offset:16384
  ds_read_b64_tr_b16 a[90:91], v18 offset:18432
  ds_read_b64_tr_b16 a[92:93], v19 offset:16384
  ds_read_b64_tr_b16 a[94:95], v19 offset:18432
  ds_read_b64_tr_b16 a[96:97], v16 offset:32768
  ds_read_b64_tr_b16 a[98:99], v16 offset:34816
  ds_read_b64_tr_b16 a[100:101], v17 offset:32768
  ds_read_b64_tr_b16 a[102:103], v17 offset:34816
  ds_read_b64_tr_b16 a[104:105], v18 offset:32768
  ds_read_b64_tr_b16 a[106:107], v18 offset:34816
  ds_read_b64_tr_b16 a[108:109], v19 offset:32768
  ds_read_b64_tr_b16 a[110:111], v19 offset:34816
  ds_read_b64_tr_b16 a[112:113], v16 offset:49152
  ds_read_b64_tr_b16 a[114:115], v16 offset:51200
  ds_read_b64_tr_b16 a[116:117], v17 offset:49152
  ds_read_b64_tr_b16 a[118:119], v17 offset:51200
  ds_read_b64_tr_b16 a[120:121], v18 offset:49152
  ds_read_b64_tr_b16 a[122:123], v18 offset:51200
  ds_read_b64_tr_b16 a[124:125], v19 offset:49152
  ds_read_b64_tr_b16 a[126:127], v19 offset:51200
  s_waitcnt lgkmcnt(0)
  s_barrier
  s_waitcnt vmcnt(32)
  ds_write_b128 v23, v[64:67] offset:0
  ds_write_b128 v23, v[68:71] offset:1024
  ds_write_b128 v23, v[72:75] offset:2048
  ds_write_b128 v23, v[76:79] offset:3072
  ds_write_b128 v23, v[80:83] offset:4096
  ds_write_b128 v23, v[84:87] offset:5120
  ds_write_b128 v23, v[88:91] offset:6144
  ds_write_b128 v23, v[92:95] offset:7168
  ds_write_b128 v23, v[96:99] offset:8192
  ds_write_b128 v23, v[100:103] offset:9216
  ds_write_b128 v23, v[104:107] offset:10240
  ds_write_b128 v23, v[108:111] offset:11264
  ds_write_b128 v23, v[112:115] offset:12288
  ds_write_b128 v23, v[116:119] offset:13312
  ds_write_b128 v23, v[120:123] offset:14336
  ds_write_b128 v23, v[124:127] offset:15360
  s_waitcnt lgkmcnt(0)
  s_barrier
  ds_read_b64_tr_b16 a[128:129], v12 offset:0
  ds_read_b64_tr_b16 a[130:131], v12 offset:2048
  ds_read_b64_tr_b16 a[132:133], v13 offset:0
  ds_read_b64_tr_b16 a[134:135], v13 offset:2048
  ds_read_b64_tr_b16 a[136:137], v14 offset:0
  ds_read_b64_tr_b16 a[138:139], v14 offset:2048
  ds_read_b64_tr_b16 a[140:141], v15 offset:0
  ds_read_b64_tr_b16 a[142:143], v15 offset:2048
  ds_read_b64_tr_b16 a[144:145], v12 offset:16384
  ds_read_b64_tr_b16 a[146:147], v12 offset:18432
  ds_read_b64_tr_b16 a[148:149], v13 offset:16384
  ds_read_b64_tr_b16 a[150:151], v13 offset:18432
  ds_read_b64_tr_b16 a[152:153], v14 offset:16384
  ds_read_b64_tr_b16 a[154:155], v14 offset:18432
  ds_read_b64_tr_b16 a[156:157], v15 offset:16384
  ds_read_b64_tr_b16 a[158:159], v15 offset:18432
  ds_read_b64_tr_b16 a[160:161], v12 offset:32768
  ds_read_b64_tr_b16 a[162:163], v12 offset:34816
  ds_read_b64_tr_b16 a[164:165], v13 offset:32768
  ds_read_b64_tr_b16 a[166:167], v13 offset:34816
  ds_read_b64_tr_b16 a[168:169], v14 offset:32768
  ds_read_b64_tr_b16 a[170:171], v14 offset:34816
  ds_read_b64_tr_b16 a[172:173], v15 offset:32768
  ds_read_b64_tr_b16 a[174:175], v15 offset:34816
  ds_read_b64_tr_b16 a[176:177], v12 offset:49152
  ds_read_b64_tr_b16 a[178:179], v12 offset:51200
  ds_read_b64_tr_b16 a[180:181], v13 offset:49152
  ds_read_b64_tr_b16 a[182:183], v13 offset:51200
  ds_read_b64_tr_b16 a[184:185], v14 offset:49152
  ds_read_b64_tr_b16 a[186:187], v14 offset:51200
  ds_read_b64_tr_b16 a[188:189], v15 offset:49152
  ds_read_b64_tr_b16 a[190:191], v15 offset:51200
  s_waitcnt lgkmcnt(0)
  s_barrier
  s_waitcnt vmcnt(16)
  ds_write_b128 v29, v[128:131] offset:0
  ds_write_b128 v29, v[132:135] offset:1024
  ds_write_b128 v29, v[136:139] offset:2048
  ds_write_b128 v29, v[140:143] offset:3072
  ds_write_b128 v29, v[144:147] offset:4096
  ds_write_b128 v29, v[148:151] offset:5120
  ds_write_b128 v29, v[152:155] offset:6144
  ds_write_b128 v29, v[156:159] offset:7168
  ds_write_b128 v29, v[160:163] offset:8192
  ds_write_b128 v29, v[164:167] offset:9216
  ds_write_b128 v29, v[168:171] offset:10240
  ds_write_b128 v29, v[172:175] offset:11264
  ds_write_b128 v29, v[176:179] offset:12288
  ds_write_b128 v29, v[180:183] offset:13312
  ds_write_b128 v29, v[184:187] offset:14336
  ds_write_b128 v29, v[188:191] offset:15360
  s_waitcnt lgkmcnt(0)
  s_barrier
  ds_read_b64_tr_b16 a[192:193], v16 offset:0
  ds_read_b64_tr_b16 a[194:195], v16 offset:2048
  ds_read_b64_tr_b16 a[196:197], v17 offset:0
  ds_read_b64_tr_b16 a[198:199], v17 offset:2048
  ds_read_b64_tr_b16 a[200:201], v18 offset:0
  ds_read_b64_tr_b16 a[202:203], v18 offset:2048
  ds_read_b64_tr_b16 a[204:205], v19 offset:0
  ds_read_b64_tr_b16 a[206:207], v19 offset:2048
  ds_read_b64_tr_b16 a[208:209], v16 offset:16384
  ds_read_b64_tr_b16 a[210:211], v16 offset:18432
  ds_read_b64_tr_b16 a[212:213], v17 offset:16384
  ds_read_b64_tr_b16 a[214:215], v17 offset:18432
  ds_read_b64_tr_b16 a[216:217], v18 offset:16384
  ds_read_b64_tr_b16 a[218:219], v18 offset:18432
  ds_read_b64_tr_b16 a[220:221], v19 offset:16384
  ds_read_b64_tr_b16 a[222:223], v19 offset:18432
  ds_read_b64_tr_b16 a[224:225], v16 offset:32768
  ds_read_b64_tr_b16 a[226:227], v16 offset:34816
  ds_read_b64_tr_b16 a[228:229], v17 offset:32768
  ds_read_b64_tr_b16 a[230:231], v17 offset:34816
  ds_read_b64_tr_b16 a[232:233], v18 offset:32768
  ds_read_b64_tr_b16 a[234:235], v18 offset:34816
  ds_read_b64_tr_b16 a[236:237], v19 offset:32768
  ds_read_b64_tr_b16 a[238:239], v19 offset:34816
  ds_read_b64_tr_b16 a[240:241], v16 offset:49152
  ds_read_b64_tr_b16 a[242:243], v16 offset:51200
  ds_read_b64_tr_b16 a[244:245], v17 offset:49152
  ds_read_b64_tr_b16 a[246:247], v17 offset:51200
  ds_read_b64_tr_b16 a[248:249], v18 offset:49152
  ds_read_b64_tr_b16 a[250:251], v18 offset:51200
  ds_read_b64_tr_b16 a[252:253], v19 offset:49152
  ds_read_b64_tr_b16 a[254:255], v19 offset:51200
  s_waitcnt lgkmcnt(0)
  s_barrier
  s_waitcnt vmcnt(0)
  ds_write_b128 v23, v[192:195] offset:0
  ds_write_b128 v23, v[196:199] offset:1024
  ds_write_b128 v23, v[200:203] offset:2048
  ds_write_b128 v23, v[204:207] offset:3072
  ds_write_b128 v23, v[208:211] offset:4096
  ds_write_b128 v23, v[212:215] offset:5120
  ds_write_b128 v23, v[216:219] offset:6144
  ds_write_b128 v23, v[220:223] offset:7168
  ds_write_b128 v23, v[224:227] offset:8192
  ds_write_b128 v23, v[228:231] offset:9216
  ds_write_b128 v23, v[232:235] offset:10240
  ds_write_b128 v23, v[236:239] offset:11264
  ds_write_b128 v23, v[240:243] offset:12288
  ds_write_b128 v23, v[244:247] offset:13312
  ds_write_b128 v23, v[248:251] offset:14336
  ds_write_b128 v23, v[252:255] offset:15360
  s_waitcnt lgkmcnt(0)
  s_barrier
  ds_read_b64_tr_b16 v[192:193], v12 offset:0
  ds_read_b64_tr_b16 v[194:195], v12 offset:2048
  ds_read_b64_tr_b16 v[196:197], v13 offset:0
  ds_read_b64_tr_b16 v[198:199], v13 offset:2048
  ds_read_b64_tr_b16 v[200:201], v14 offset:0
  ds_read_b64_tr_b16 v[202:203], v14 offset:2048
  ds_read_b64_tr_b16 v[204:205], v15 offset:0
  ds_read_b64_tr_b16 v[206:207], v15 offset:2048
  ds_read_b64_tr_b16 v[208:209], v12 offset:16384
  ds_read_b64_tr_b16 v[210:211], v12 offset:18432
  ds_read_b64_tr_b16 v[212:213], v13 offset:16384
  ds_read_b64_tr_b16 v[214:215], v13 offset:18432
  ds_read_b64_tr_b16 v[216:217], v14 offset:16384
  ds_read_b64_tr_b16 v[218:219], v14 offset:18432
  ds_read_b64_tr_b16 v[220:221], v15 offset:16384
  ds_read_b64_tr_b16 v[222:223], v15 offset:18432
  ds_read_b64_tr_b16 v[224:225], v12 offset:32768
  ds_read_b64_tr_b16 v[226:227], v12 offset:34816
  ds_read_b64_tr_b16 v[228:229], v13 offset:32768
  ds_read_b64_tr_b16 v[230:231], v13 offset:34816
  ds_read_b64_tr_b16 v[232:233], v14 offset:32768
  ds_read_b64_tr_b16 v[234:235], v14 offset:34816
  ds_read_b64_tr_b16 v[236:237], v15 offset:32768
  ds_read_b64_tr_b16 v[238:239], v15 offset:34816
  ds_read_b64_tr_b16 v[240:241], v12 offset:49152
  ds_read_b64_tr_b16 v[242:243], v12 offset:51200
  ds_read_b64_tr_b16 v[244:245], v13 offset:49152
  ds_read_b64_tr_b16 v[246:247], v13 offset:51200
  ds_read_b64_tr_b16 v[248:249], v14 offset:49152
  ds_read_b64_tr_b16 v[250:251], v14 offset:51200
  ds_read_b64_tr_b16 v[252:253], v15 offset:49152
  ds_read_b64_tr_b16 v[254:255], v15 offset:51200
  s_waitcnt lgkmcnt(0)
  s_barrier
  s_load_dwordx2 s[32:33], s[0:1], 96
  s_waitcnt lgkmcnt(0)
  s_mov_b32 s32, s32
  s_mov_b32 s33, s33
  s_mov_b32 s34, 256
  s_mov_b32 s35, 0x00020000
  s_mov_b32 s21, 76
  v_mov_b32 v4, 0
  s_mov_b32 s101, 0
wf_208:
  buffer_load_dword v5, v4, s[32:35], s21 offen sc1
  s_add_u32 s101, s101, 1
  s_cmp_gt_u32 s101, 131072
  s_cbranch_scc1 main_end
  s_waitcnt vmcnt(0)
  v_readfirstlane_b32 s100, v5
  s_cmp_ge_u32 s100, 1
  s_cbranch_scc1 wf_209
  s_sleep 8
  s_branch wf_208
wf_209:
  s_sub_u32 s80, s100, 1
  s_lshl_b32 s80, s80, 13
  v_lshrrev_b32 v8, 3, v1
  v_and_b32 v9, 7, v1
  v_xor_b32 v9, v9, v8
  s_and_b32 s21, s20, 1
  s_lshl_b32 s21, s21, 4
  s_lshr_b32 s22, s20, 1
  s_add_u32 s21, s21, s22
  v_lshl_add_u32 v8, v8, 1, s21
  v_mul_u32_u24 v8, 1280, v8
  v_lshl_add_u32 v4, v9, 4, v8
  s_lshl_b32 s31, s20, 10
  s_mul_i32 s30, s42, 655360
  s_sub_u32 s46, s30, 40960
  s_cmp_eq_u32 s42, 0
  s_cselect_b32 s46, 1073741824, s46
  s_add_u32 m0, s31, 0
  s_nop 0
  buffer_load_dwordx4 v4, s[8:11], s46 offen offset:0 lds
  s_add_u32 m0, s31, 3968
  s_nop 0
  buffer_load_dwordx4 v4, s[8:11], s46 offen offset:128 lds
  s_add_u32 m0, s31, 7936
  s_nop 0
  buffer_load_dwordx4 v4, s[8:11], s46 offen offset:256 lds
  s_add_u32 m0, s31, 11904
  s_nop 0
  buffer_load_dwordx4 v4, s[8:11], s46 offen offset:384 lds
  s_add_u32 m0, s31, 15872
  s_nop 0
  buffer_load_dwordx4 v4, s[8:11], s46 offen offset:512 lds
  s_add_u32 m0, s31, 19840
  s_nop 0
  buffer_load_dwordx4 v4, s[8:11], s46 offen offset:640 lds
  s_add_u32 m0, s31, 23808
  s_nop 0
  buffer_load_dwordx4 v4, s[8:11], s46 offen offset:768 lds
  s_add_u32 m0, s31, 27776
  s_nop 0
  buffer_load_dwordx4 v4, s[8:11], s46 offen offset:896 lds
  s_add_u32 m0, s31, 31744
  s_nop 0
  buffer_load_dwordx4 v4, s[8:11], s46 offen offset:1024 lds
  s_add_u32 m0, s31, 35712
  s_nop 0
  buffer_load_dwordx4 v4, s[8:11], s46 offen offset:1152 lds
  s_add_u32 s31, s31, 40960
  s_add_u32 m0, s31, 0
  s_nop 0
  buffer_load_dwordx4 v4, s[8:11], s30 offen offset:0 lds
  s_add_u32 m0, s31, 3968
  s_nop 0
  buffer_load_dwordx4 v4, s[8:11], s30 offen offset:128 lds
  s_add_u32 m0, s31, 7936
  s_nop 0
  buffer_load_dwordx4 v4, s[8:11], s30 offen offset:256 lds
  s_add_u32 m0, s31, 11904
  s_nop 0
  buffer_load_dwordx4 v4, s[8:11], s30 offen offset:384 lds
  s_add_u32 m0, s31, 15872
  s_nop 0
  buffer_load_dwordx4 v4, s[8:11], s30 offen offset:512 lds
  s_add_u32 m0, s31, 19840
  s_nop 0
  buffer_load_dwordx4 v4, s[8:11], s30 offen offset:640 lds
  s_add_u32 m0, s31, 23808
  s_nop 0
  buffer_load_dwordx4 v4, s[8:11], s30 offen offset:768 lds
  s_add_u32 m0, s31, 27776
  s_nop 0
  buffer_load_dwordx4 v4, s[8:11], s30 offen offset:896 lds
  s_add_u32 m0, s31, 31744
  s_nop 0
  buffer_load_dwordx4 v4, s[8:11], s30 offen offset:1024 lds
  s_add_u32 m0, s31, 35712
  s_nop 0
  buffer_load_dwordx4 v4, s[8:11], s30 offen offset:1152 lds
  s_add_u32 s31, s31, 40960
  s_add_u32 s30, s30, 40960
  v_and_b32 v10, 7, v2
  v_add_u32 v8, 0, v3
  v_xor_b32 v8, v8, v10
  v_lshlrev_b32 v8, 4, v8
  v_lshl_add_u32 v5, v2, 7, v8
  v_add_u32 v8, 4, v3
  v_xor_b32 v8, v8, v10
  v_lshlrev_b32 v8, 4, v8
  v_lshl_add_u32 v6, v2, 7, v8
  v_mov_b32 v7, v5
  v_mov_b32 v8, v6
  s_mov_b32 s33, 0
  v_lshlrev_b32 v15, 4, v1
  v_mov_b32 v16, 0xf149f2ca
  v_lshrrev_b32 v17, 3, v2
  v_mul_u32_u24 v17, 2560, v17
  v_lshlrev_b32 v18, 1, v10
  s_lshr_b32 s21, s20, 1
  s_lshl_b32 s21, s21, 10
  s_and_b32 s22, s20, 1
  s_lshl_b32 s22, s22, 3
  s_add_u32 s21, s21, s22
  s_add_u32 s21, s21, 131072
  v_lshl_add_u32 v9, v3, 4, v18
  v_lshl_add_u32 v9, v9, 4, v17
  v_add_u32 v9, s21, v9
  s_lshl_b32 s21, s20, 7
  s_add_u32 s21, s21, 133120
  v_lshl_add_u32 v10, v18, 3, v17
  v_add_u32 v10, s21, v10
  v_cmp_eq_u32 vcc, 2, v3
  v_lshlrev_b32 v19, 4, v1
  v_add_u32 v19, 136192, v19
  v_cndmask_b32 v10, v19, v10, vcc
  s_lshr_b32 s21, s20, 1
  s_and_b32 s22, s20, 1
  s_mul_i32 s23, s21, 2560
  s_lshl_b32 s47, s22, 10
  s_add_u32 s47, s47, s23
  s_add_u32 s47, s47, 131072
  v_add_u32 v11, s47, v15
  s_lshl_b32 s47, s22, 8
  s_add_u32 s47, s47, s23
  s_add_u32 s47, s47, 133120
  v_add_u32 v12, s47, v15
  s_mul_i32 s23, s22, 768
  s_sub_u32 s23, 2048, s23
  v_add_u32 v14, s23, v15
  v_mov_b32 v19, 1073741824
  v_cmp_gt_u32 vcc, 16, v1
  s_lshl_b32 s47, s42, 23
  s_lshl_b32 s21, s21, 14
  v_cndmask_b32 v14, v19, v14, vcc
  s_add_u32 s47, s47, s21
  s_lshr_b32 s21, s41, 1
  s_lshl_b32 s21, s21, 15
  s_add_u32 s47, s47, s21
  s_and_b32 s21, s41, 1
  s_mul_i32 s21, s21, 2560
  s_add_u32 s47, s47, s21
  s_xor_b32 s21, s80, 134488064
  s_add_u32 s47, s47, s21
  s_lshl_b32 s22, s22, 10
  s_add_u32 s47, s47, s22
  s_mov_b32 s48, 1073741824
  s_mov_b32 s49, 1073741824
  v_cmp_eq_u32 s[62:63], 0, v3
  v_lshlrev_b32 v17, 2, v3
  v_sub_u32 v17, v17, v2
  s_mov_b32 s82, 0x3e64f92e
  s_mov_b32 s83, 0x3fb8aa3b
  v_mov_b32 v20, 0
  v_mov_b32 v21, 0
  v_mov_b32 v22, 0
  v_mov_b32 v23, 0
  v_add_u32 v18, 7, v17
  v_cmp_gt_u32 s[84:85], 8, v18
  v_cmp_le_i32 s[64:65], 16, v18
  v_mov_b32 v18, 65535
  v_cndmask_b32 v19, 0, v18, s[84:85]
  v_or_b32 v20, v20, v19
  v_cndmask_b32 v19, 0, v18, s[64:65]
  v_or_b32 v22, v22, v19
  s_mov_b64 s[54:55], s[84:85]
  s_or_b64 s[84:85], s[84:85], s[64:65]
  v_add_u32 v18, 8, v17
  v_cmp_gt_u32 s[86:87], 8, v18
  v_cmp_le_i32 s[66:67], 16, v18
  v_mov_b32 v18, 4294901760
  v_cndmask_b32 v19, 0, v18, s[86:87]
  v_or_b32 v20, v20, v19
  v_cndmask_b32 v19, 0, v18, s[66:67]
  v_or_b32 v22, v22, v19
  s_mov_b64 s[56:57], s[86:87]
  s_or_b64 s[86:87], s[86:87], s[66:67]
  v_add_u32 v18, 9, v17
  v_cmp_gt_u32 s[88:89], 8, v18
  v_cmp_le_i32 s[68:69], 16, v18
  v_mov_b32 v18, 65535
  v_cndmask_b32 v19, 0, v18, s[88:89]
  v_or_b32 v21, v21, v19
  v_cndmask_b32 v19, 0, v18, s[68:69]
  v_or_b32 v23, v23, v19
  s_mov_b64 s[58:59], s[88:89]
  s_or_b64 s[88:89], s[88:89], s[68:69]
  v_add_u32 v18, 10, v17
  v_cmp_gt_u32 s[90:91], 8, v18
  v_cmp_le_i32 s[70:71], 16, v18
  v_mov_b32 v18, 4294901760
  v_cndmask_b32 v19, 0, v18, s[90:91]
  v_or_b32 v21, v21, v19
  v_cndmask_b32 v19, 0, v18, s[70:71]
  v_or_b32 v23, v23, v19
  s_mov_b64 s[60:61], s[90:91]
  s_or_b64 s[90:91], s[90:91], s[70:71]
  v_mov_b32 v18, 0x3f80
  v_mov_b32 v19, 0x3f800000
  v_cmp_eq_i32 vcc, 0, v17
  v_cmp_eq_i32 s[22:23], -1, v17
  s_nop 1
  v_cndmask_b32 v24, 0, v18, vcc
  v_cndmask_b32 v24, v24, v19, s[22:23]
  v_cmp_eq_i32 vcc, -2, v17
  v_cmp_eq_i32 s[22:23], -3, v17
  s_nop 1
  v_cndmask_b32 v25, 0, v18, vcc
  v_cndmask_b32 v25, v25, v19, s[22:23]
  v_mov_b32 v26, 0
  v_mov_b32 v27, 0
  v_mov_b32 v60, 0
  v_mov_b32 v61, 0
  v_mov_b32 v62, 0
  v_mov_b32 v63, 0
  v_mov_b32 v64, 0
  v_mov_b32 v65, 0
  v_mov_b32 v66, 0
  v_mov_b32 v67, 0
  v_mov_b32 v68, 0
  v_mov_b32 v69, 0
  v_mov_b32 v70, 0
  v_mov_b32 v71, 0
  v_mov_b32 v72, 0
  v_mov_b32 v73, 0
  v_mov_b32 v74, 0
  v_mov_b32 v75, 0
  v_mov_b32 v76, 0
  v_mov_b32 v77, 0
  v_mov_b32 v78, 0
  v_mov_b32 v79, 0
  v_mov_b32 v80, 0
  v_mov_b32 v81, 0
  v_mov_b32 v82, 0
  v_mov_b32 v83, 0
  v_mov_b32 v84, 0
  v_mov_b32 v85, 0
  v_mov_b32 v86, 0
  v_mov_b32 v87, 0
  v_mov_b32 v88, 0
  v_mov_b32 v89, 0
  v_mov_b32 v90, 0
  v_mov_b32 v91, 0
  v_mov_b32 v92, 0
  v_mov_b32 v93, 0
  v_mov_b32 v94, 0
  v_mov_b32 v95, 0
  v_mov_b32 v96, 0
  v_mov_b32 v97, 0
  v_mov_b32 v98, 0
  v_mov_b32 v99, 0
  v_mov_b32 v100, 0
  v_mov_b32 v101, 0
  v_mov_b32 v102, 0
  v_mov_b32 v103, 0
  v_mov_b32 v104, 0
  v_mov_b32 v105, 0
  v_mov_b32 v106, 0
  v_mov_b32 v107, 0
  v_mov_b32 v108, 0
  v_mov_b32 v109, 0
  v_mov_b32 v110, 0
  v_mov_b32 v111, 0
  v_mov_b32 v112, 0
  v_mov_b32 v113, 0
  v_mov_b32 v114, 0
  v_mov_b32 v115, 0
  v_mov_b32 v116, 0
  v_mov_b32 v117, 0
  v_mov_b32 v118, 0
  v_mov_b32 v119, 0
  v_mov_b32 v120, 0
  v_mov_b32 v121, 0
  v_mov_b32 v122, 0
  v_mov_b32 v123, 0
  v_mov_b32 v124, 0
  v_mov_b32 v125, 0
  v_mov_b32 v126, 0
  v_mov_b32 v127, 0
  v_mov_b32 v128, 0
  v_mov_b32 v129, 0
  v_mov_b32 v130, 0
  v_mov_b32 v131, 0
  s_cmp_eq_u32 s42, 0
  s_cselect_b32 s53, 15, 99
  s_mov_b32 s26, 17
  s_waitcnt vmcnt(10)
  s_barrier
  ds_read_b128 v[28:31], v7 offset:0
  ds_read_b128 v[32:35], v8 offset:0
  ds_read_b128 v[36:39], v7 offset:4096
  ds_read_b128 v[40:43], v8 offset:4096
  s_waitcnt lgkmcnt(3)
  .p2align 3
bfl_210:
  v_mfma_f32_16x16x32_bf16 v[60:63], a[0:3], v[28:31], 0
  ds_read_b128 v[44:47], v7 offset:8192
  v_mfma_f32_16x16x32_bf16 v[64:67], a[4:7], v[28:31], 0
  v_mfma_f32_16x16x32_bf16 v[68:71], a[8:11], v[28:31], 0
  v_cvt_pk_bf16_f32 v128, v84, v85
  v_cvt_pk_bf16_f32 v129, v86, v87
  v_mfma_f32_16x16x32_bf16 v[72:75], v[28:31], a[12:15], 0
  s_waitcnt lgkmcnt(3)
  v_cvt_pk_bf16_f32 v124, v76, v77
  v_cvt_pk_bf16_f32 v125, v78, v79
  v_mfma_f32_16x16x32_bf16 v[60:63], a[16:19], v[32:35], v[60:63]
  ds_read_b128 v[48:51], v8 offset:8192
  v_cvt_pk_bf16_f32 v100, v80, v81
  v_mfma_f32_16x16x32_bf16 v[64:67], a[20:23], v[32:35], v[64:67]
  v_cvt_pk_bf16_f32 v101, v82, v83
  v_cvt_pk_bf16_f32 v116, v88, v89
  v_mfma_f32_16x16x32_bf16 v[68:71], a[24:27], v[32:35], v[68:71]
  s_add_u32 m0, s31, 0
  v_cvt_pk_bf16_f32 v117, v90, v91
  v_cndmask_b32 v126, 0, v128, s[62:63]
  v_mfma_f32_16x16x32_bf16 v[72:75], v[32:35], a[28:31], v[72:75]
  s_waitcnt lgkmcnt(3)
  v_cndmask_b32 v127, 0, v129, s[62:63]
  buffer_load_dwordx4 v4, s[8:11], s30 offen offset:0 lds
  v_mfma_f32_16x16x32_bf16 v[60:63], a[32:35], v[36:39], v[60:63]
  ds_read_b128 v[52:55], v7 offset:12288
  v_mfma_f32_16x16x32_bf16 v[64:67], a[36:39], v[36:39], v[64:67]
  v_mfma_f32_16x16x32_bf16 v[68:71], a[40:43], v[36:39], v[68:71]
  v_mfma_f32_16x16x32_bf16 v[72:75], v[36:39], a[44:47], v[72:75]
  v_mfma_f32_16x16x32_bf16 v[132:135], v[128:131], v[24:27], 0
  s_waitcnt lgkmcnt(3)
  v_permlane16_swap_b32 v128, v102
  v_permlane16_swap_b32 v129, v103
  v_mfma_f32_16x16x32_bf16 v[60:63], a[48:51], v[40:43], v[60:63]
  ds_read_b128 v[56:59], v8 offset:12288
  v_mfma_f32_16x16x32_bf16 v[64:67], a[52:55], v[40:43], v[64:67]
  v_mfma_f32_16x16x32_bf16 v[68:71], a[56:59], v[40:43], v[68:71]
  v_mfma_f32_16x16x32_bf16 v[72:75], v[40:43], a[60:63], v[72:75]
  v_mfma_f32_16x16x32_bf16 v[136:139], v[100:103], v[124:127], 0
  v_mfma_f32_16x16x32_bf16 v[140:143], v[104:107], v[124:127], 0
  s_add_u32 m0, s31, 3968
  s_waitcnt lgkmcnt(3)
  v_mfma_f32_16x16x32_bf16 v[60:63], a[64:67], v[44:47], v[60:63]
  ds_read_b128 v[28:31], v7 offset:16384
  buffer_load_dwordx4 v4, s[8:11], s30 offen offset:128 lds
  v_mfma_f32_16x16x32_bf16 v[64:67], a[68:71], v[44:47], v[64:67]
  v_mfma_f32_16x16x32_bf16 v[68:71], a[72:75], v[44:47], v[68:71]
  v_cvt_pk_bf16_f32 v120, v132, v133
  v_cvt_pk_bf16_f32 v121, v134, v135
  v_mfma_f32_16x16x32_bf16 v[72:75], v[44:47], a[76:79], v[72:75]
  s_waitcnt lgkmcnt(3)
  v_cndmask_b32 v136, v136, v140, s[64:65]
  v_cndmask_b32 v137, v137, v141, s[66:67]
  v_mfma_f32_16x16x32_bf16 v[60:63], a[80:83], v[48:51], v[60:63]
  ds_read_b128 v[32:35], v8 offset:16384
  v_cndmask_b32 v138, v138, v142, s[68:69]
  v_mfma_f32_16x16x32_bf16 v[64:67], a[84:87], v[48:51], v[64:67]
  v_cndmask_b32 v139, v139, v143, s[70:71]
  v_cvt_pk_bf16_f32 v17, v136, v137
  v_mfma_f32_16x16x32_bf16 v[68:71], a[88:91], v[48:51], v[68:71]
  v_lshlrev_b32 v136, 16, v17
  v_and_b32 v137, 0xffff0000, v17
  v_mfma_f32_16x16x32_bf16 v[72:75], v[48:51], a[92:95], v[72:75]
  s_waitcnt lgkmcnt(3)
  v_cvt_pk_bf16_f32 v17, v138, v139
  v_lshlrev_b32 v138, 16, v17
  v_mfma_f32_16x16x32_bf16 v[60:63], a[96:99], v[52:55], v[60:63]
  ds_read_b128 v[36:39], v7 offset:20480
  v_and_b32 v139, 0xffff0000, v17
  v_mfma_f32_16x16x32_bf16 v[64:67], a[100:103], v[52:55], v[64:67]
  v_mul_f32 v136, s82, v136
  v_mul_f32 v137, s82, v137
  v_mfma_f32_16x16x32_bf16 v[68:71], a[104:107], v[52:55], v[68:71]
  v_mul_f32 v138, s82, v138
  v_mul_f32 v139, s82, v139
  v_mfma_f32_16x16x32_bf16 v[72:75], v[52:55], a[108:111], v[72:75]
  s_waitcnt lgkmcnt(3)
  v_cvt_pk_bf16_f32 v17, v136, v137
  v_lshlrev_b32 v136, 16, v17
  v_mfma_f32_16x16x32_bf16 v[60:63], a[112:115], v[56:59], v[60:63]
  s_add_u32 m0, s31, 7936
  ds_read_b128 v[40:43], v8 offset:20480
  v_and_b32 v137, 0xffff0000, v17
  v_mfma_f32_16x16x32_bf16 v[64:67], a[116:119], v[56:59], v[64:67]
  v_cvt_pk_bf16_f32 v17, v138, v139
  v_lshlrev_b32 v138, 16, v17
  v_mfma_f32_16x16x32_bf16 v[68:71], a[120:123], v[56:59], v[68:71]
  v_and_b32 v139, 0xffff0000, v17
  v_cndmask_b32 v136, v16, v136, s[54:55]
  v_mfma_f32_16x16x32_bf16 v[72:75], v[56:59], a[124:127], v[72:75]
  s_waitcnt lgkmcnt(3)
  v_cndmask_b32 v137, v16, v137, s[56:57]
  v_cndmask_b32 v138, v16, v138, s[58:59]
  v_mfma_f32_16x16x32_bf16 v[60:63], a[128:131], v[28:31], v[60:63]
  ds_read_b128 v[44:47], v7 offset:24576
  v_cndmask_b32 v139, v16, v139, s[60:61]
  v_mfma_f32_16x16x32_bf16 v[64:67], a[132:135], v[28:31], v[64:67]
  v_max3_f32 v17, v136, v137, v138
  v_max_f32 v17, v17, v139
  v_mfma_f32_16x16x32_bf16 v[68:71], a[136:139], v[28:31], v[68:71]
  v_mov_b32 v18, v17
  buffer_load_dwordx4 v4, s[8:11], s30 offen offset:256 lds
  v_mfma_f32_16x16x32_bf16 v[72:75], v[28:31], a[140:143], v[72:75]
  s_waitcnt lgkmcnt(3)
  v_permlane32_swap_b32 v17, v18
  v_max_f32 v17, v17, v18
  v_mfma_f32_16x16x32_bf16 v[60:63], a[144:147], v[32:35], v[60:63]
  ds_read_b128 v[48:51], v8 offset:24576
  v_mov_b32 v18, v17
  v_mfma_f32_16x16x32_bf16 v[64:67], a[148:151], v[32:35], v[64:67]
  v_permlane16_swap_b32 v17, v18
  v_max_f32 v17, v17, v18
  v_mfma_f32_16x16x32_bf16 v[68:71], a[152:155], v[32:35], v[68:71]
  v_mul_f32 v17, s83, v17
  v_fma_f32 v136, v136, s83, -v17
  v_mfma_f32_16x16x32_bf16 v[72:75], v[32:35], a[156:159], v[72:75]
  s_waitcnt lgkmcnt(3)
  v_fma_f32 v137, v137, s83, -v17
  v_fma_f32 v138, v138, s83, -v17
  v_mfma_f32_16x16x32_bf16 v[60:63], a[160:163], v[36:39], v[60:63]
  s_add_u32 m0, s31, 11904
  ds_read_b128 v[52:55], v7 offset:28672
  v_fma_f32 v139, v139, s83, -v17
  v_mfma_f32_16x16x32_bf16 v[64:67], a[164:167], v[36:39], v[64:67]
  v_exp_f32 v136, v136
  v_mfma_f32_16x16x32_bf16 v[68:71], a[168:171], v[36:39], v[68:71]
  v_exp_f32 v137, v137
  v_mfma_f32_16x16x32_bf16 v[72:75], v[36:39], a[172:175], v[72:75]
  s_waitcnt lgkmcnt(3)
  v_exp_f32 v138, v138
  v_mfma_f32_16x16x32_bf16 v[60:63], a[176:179], v[40:43], v[60:63]
  ds_read_b128 v[56:59], v8 offset:28672
  buffer_load_dwordx4 v4, s[8:11], s30 offen offset:384 lds
  v_mfma_f32_16x16x32_bf16 v[64:67], a[180:183], v[40:43], v[64:67]
  v_exp_f32 v139, v139
  v_mfma_f32_16x16x32_bf16 v[68:71], a[184:187], v[40:43], v[68:71]
  v_add_f32 v17, v136, v137
  v_add_f32 v18, v138, v139
  v_mfma_f32_16x16x32_bf16 v[72:75], v[40:43], a[188:191], v[72:75]
  s_waitcnt lgkmcnt(3)
  v_add_f32 v17, v17, v18
  v_mov_b32 v18, v17
  v_mfma_f32_16x16x32_bf16 v[60:63], a[192:195], v[44:47], v[60:63]
  ds_read_b128 v[28:31], v7 offset:32768
  v_permlane32_swap_b32 v17, v18
  v_mfma_f32_16x16x32_bf16 v[64:67], a[196:199], v[44:47], v[64:67]
  v_add_f32 v17, v17, v18
  v_mov_b32 v18, v17
  v_mfma_f32_16x16x32_bf16 v[68:71], a[200:203], v[44:47], v[68:71]
  v_permlane16_swap_b32 v17, v18
  v_add_f32 v17, v17, v18
  v_mfma_f32_16x16x32_bf16 v[72:75], v[44:47], a[204:207], v[72:75]
  s_waitcnt lgkmcnt(3)
  v_rcp_f32 v17, v17
  v_mfma_f32_16x16x32_bf16 v[60:63], a[208:211], v[48:51], v[60:63]
  s_add_u32 m0, s31, 15872
  ds_read_b128 v[32:35], v8 offset:32768
  v_mul_f32 v136, v136, v17
  v_mfma_f32_16x16x32_bf16 v[64:67], a[212:215], v[48:51], v[64:67]
  v_mul_f32 v137, v137, v17
  v_mul_f32 v138, v138, v17
  v_mfma_f32_16x16x32_bf16 v[68:71], a[216:219], v[48:51], v[68:71]
  v_mul_f32 v139, v139, v17
  v_cvt_pk_bf16_f32 v144, v136, v137
  v_mfma_f32_16x16x32_bf16 v[72:75], v[48:51], a[220:223], v[72:75]
  s_waitcnt lgkmcnt(3)
  v_cvt_pk_bf16_f32 v145, v138, v139
  v_and_b32 v146, v144, v22
  v_mfma_f32_16x16x32_bf16 v[60:63], a[224:227], v[52:55], v[60:63]
  ds_read_b128 v[36:39], v7 offset:36864
  v_and_b32 v147, v145, v23
  v_mfma_f32_16x16x32_bf16 v[64:67], a[228:231], v[52:55], v[64:67]
  v_and_b32 v144, v144, v20
  v_and_b32 v145, v145, v21
  v_mfma_f32_16x16x32_bf16 v[68:71], a[232:235], v[52:55], v[68:71]
  buffer_load_dwordx4 v4, s[8:11], s30 offen offset:512 lds
  v_mfma_f32_16x16x32_bf16 v[72:75], v[52:55], a[236:239], v[72:75]
  s_waitcnt lgkmcnt(3)
  v_mfma_f32_16x16x32_bf16 v[60:63], a[240:243], v[56:59], v[60:63]
  ds_read_b128 v[40:43], v8 offset:36864
  v_mfma_f32_16x16x32_bf16 v[64:67], a[244:247], v[56:59], v[64:67]
  v_mfma_f32_16x16x32_bf16 v[68:71], a[248:251], v[56:59], v[68:71]
  v_mfma_f32_16x16x32_bf16 v[72:75], v[56:59], a[252:255], v[72:75]
  s_add_u32 m0, s31, 19840
  s_waitcnt lgkmcnt(3)
  v_mfma_f32_16x16x32_bf16 v[60:63], v[192:195], v[28:31], v[60:63]
  ds_read_b128 v[44:47], v7 offset:2048
  buffer_load_dwordx4 v4, s[8:11], s30 offen offset:640 lds
  v_mfma_f32_16x16x32_bf16 v[64:67], v[196:199], v[28:31], v[64:67]
  v_mfma_f32_16x16x32_bf16 v[68:71], v[200:203], v[28:31], v[68:71]
  v_mfma_f32_16x16x32_bf16 v[72:75], v[28:31], v[204:207], v[72:75]
  v_mfma_f32_16x16x32_bf16 v[148:151], v[116:119], v[144:147], 0
  s_cmp_le_u32 s26, s53
  s_cselect_b64 s[54:55], s[84:85], s[54:55]
  v_mfma_f32_16x16x32_bf16 v[152:155], v[120:123], v[144:147], 0
  s_waitcnt lgkmcnt(3)
  v_mov_b32 v104, v100
  v_mov_b32 v105, v101
  v_mfma_f32_16x16x32_bf16 v[60:63], v[208:211], v[32:35], v[60:63]
  ds_read_b128 v[48:51], v8 offset:2048
  v_mov_b32 v106, v102
  v_mfma_f32_16x16x32_bf16 v[64:67], v[212:215], v[32:35], v[64:67]
  v_mov_b32 v107, v103
  v_mov_b32 v118, v116
  v_mfma_f32_16x16x32_bf16 v[68:71], v[216:219], v[32:35], v[68:71]
  v_cvt_pk_bf16_f32 v156, v148, v149
  v_cvt_pk_bf16_f32 v157, v150, v151
  v_mfma_f32_16x16x32_bf16 v[72:75], v[32:35], v[220:223], v[72:75]
  s_waitcnt lgkmcnt(3)
  ds_write_b64 v9, v[156:157] offset:16
  v_cvt_pk_bf16_f32 v158, v152, v153
  v_mfma_f32_16x16x32_bf16 v[60:63], v[224:227], v[36:39], v[60:63]
  ds_read_b128 v[52:55], v7 offset:6144
  v_cvt_pk_bf16_f32 v159, v154, v155
  v_mfma_f32_16x16x32_bf16 v[64:67], v[228:231], v[36:39], v[64:67]
  s_add_u32 m0, s31, 23808
  ds_write_b64 v10, v[158:159] offset:8
  v_mov_b32 v119, v117
  v_mfma_f32_16x16x32_bf16 v[68:71], v[232:235], v[36:39], v[68:71]
  v_mov_b32 v122, v120
  v_mov_b32 v123, v121
  v_mfma_f32_16x16x32_bf16 v[72:75], v[36:39], v[236:239], v[72:75]
  s_waitcnt lgkmcnt(5)
  buffer_load_dwordx4 v4, s[8:11], s30 offen offset:768 lds
  v_mfma_f32_16x16x32_bf16 v[60:63], v[240:243], v[40:43], v[60:63]
  ds_read_b128 v[56:59], v8 offset:6144
  v_mfma_f32_16x16x32_bf16 v[64:67], v[244:247], v[40:43], v[64:67]
  s_cmp_le_u32 s26, s53
  s_cselect_b64 s[56:57], s[86:87], s[56:57]
  v_mfma_f32_16x16x32_bf16 v[68:71], v[248:251], v[40:43], v[68:71]
  s_cmp_le_u32 s26, s53
  s_cselect_b64 s[58:59], s[88:89], s[58:59]
  v_mfma_f32_16x16x32_bf16 v[72:75], v[40:43], v[252:255], v[72:75]
  s_waitcnt lgkmcnt(5)
  s_cmp_le_u32 s26, s53
  s_cselect_b64 s[60:61], s[90:91], s[60:61]
  v_mfma_f32_16x16x32_bf16 v[76:79], a[0:3], v[44:47], 0
  ds_read_b128 v[28:31], v7 offset:10240
  v_mfma_f32_16x16x32_bf16 v[80:83], a[4:7], v[44:47], 0
  s_waitcnt lgkmcnt(2)
  s_barrier
  v_mfma_f32_16x16x32_bf16 v[84:87], a[8:11], v[44:47], 0
  v_cvt_pk_bf16_f32 v128, v68, v69
  v_cvt_pk_bf16_f32 v129, v70, v71
  v_mfma_f32_16x16x32_bf16 v[88:91], v[44:47], a[12:15], 0
  s_waitcnt lgkmcnt(5)
  v_cvt_pk_bf16_f32 v124, v60, v61
  v_cvt_pk_bf16_f32 v125, v62, v63
  v_mfma_f32_16x16x32_bf16 v[76:79], a[16:19], v[48:51], v[76:79]
  ds_read_b128 v[32:35], v8 offset:10240
  v_cvt_pk_bf16_f32 v92, v64, v65
  v_mfma_f32_16x16x32_bf16 v[80:83], a[20:23], v[48:51], v[80:83]
  s_add_u32 m0, s31, 27776
  v_cvt_pk_bf16_f32 v93, v66, v67
  v_cvt_pk_bf16_f32 v108, v72, v73
  v_mfma_f32_16x16x32_bf16 v[84:87], a[24:27], v[48:51], v[84:87]
  v_cvt_pk_bf16_f32 v109, v74, v75
  v_cndmask_b32 v126, 0, v128, s[62:63]
  v_mfma_f32_16x16x32_bf16 v[88:91], v[48:51], a[28:31], v[88:91]
  s_waitcnt lgkmcnt(4)
  v_cndmask_b32 v127, 0, v129, s[62:63]
  v_xor_b32 v9, 8192, v9
  v_mfma_f32_16x16x32_bf16 v[76:79], a[32:35], v[52:55], v[76:79]
  ds_read_b128 v[36:39], v7 offset:14336
  v_xor_b32 v10, 8192, v10
  v_mfma_f32_16x16x32_bf16 v[80:83], a[36:39], v[52:55], v[80:83]
  ds_read_b128 v[160:163], v11
  ds_read_b128 v[164:167], v12
  v_mfma_f32_16x16x32_bf16 v[84:87], a[40:43], v[52:55], v[84:87]
  buffer_load_dwordx4 v4, s[8:11], s30 offen offset:896 lds
  v_mfma_f32_16x16x32_bf16 v[88:91], v[52:55], a[44:47], v[88:91]
  v_mfma_f32_16x16x32_bf16 v[132:135], v[128:131], v[24:27], 0
  s_waitcnt lgkmcnt(5)
  v_permlane16_swap_b32 v128, v94
  v_permlane16_swap_b32 v129, v95
  v_mfma_f32_16x16x32_bf16 v[76:79], a[48:51], v[56:59], v[76:79]
  ds_read_b128 v[40:43], v8 offset:14336
  v_mfma_f32_16x16x32_bf16 v[80:83], a[52:55], v[56:59], v[80:83]
  v_mfma_f32_16x16x32_bf16 v[84:87], a[56:59], v[56:59], v[84:87]
  s_waitcnt lgkmcnt(1)
  buffer_store_dwordx4 v[160:163], v15, s[16:19], s49 offen sc1
  buffer_store_dwordx4 v[164:167], v14, s[16:19], s49 offen sc1
  v_mfma_f32_16x16x32_bf16 v[88:91], v[56:59], a[60:63], v[88:91]
  v_xor_b32 v11, 8192, v11
  v_xor_b32 v12, 8192, v12
  v_mfma_f32_16x16x32_bf16 v[136:139], v[92:95], v[124:127], 0
  s_add_u32 m0, s31, 31744
  s_mov_b32 s49, s48
  s_mov_b32 s48, s47
  v_mfma_f32_16x16x32_bf16 v[140:143], v[96:99], v[124:127], 0
  s_add_u32 s22, s47, 524288
  s_waitcnt lgkmcnt(5)
  buffer_load_dwordx4 v4, s[8:11], s30 offen offset:1024 lds
  v_mfma_f32_16x16x32_bf16 v[76:79], a[64:67], v[28:31], v[76:79]
  s_xor_b32 s47, s47, s22
  ds_read_b128 v[44:47], v7 offset:18432
  s_lshr_b32 s47, s47, 8
  v_mfma_f32_16x16x32_bf16 v[80:83], a[68:71], v[28:31], v[80:83]
  s_and_b32 s47, s47, 8192
  s_xor_b32 s47, s47, s22
  s_sub_u32 s26, s26, 1
  v_mfma_f32_16x16x32_bf16 v[84:87], a[72:75], v[28:31], v[84:87]
  v_cvt_pk_bf16_f32 v112, v132, v133
  v_cvt_pk_bf16_f32 v113, v134, v135
  v_mfma_f32_16x16x32_bf16 v[88:91], v[28:31], a[76:79], v[88:91]
  s_waitcnt lgkmcnt(5)
  v_cndmask_b32 v136, v136, v140, s[64:65]
  v_cndmask_b32 v137, v137, v141, s[66:67]
  v_mfma_f32_16x16x32_bf16 v[76:79], a[80:83], v[32:35], v[76:79]
  ds_read_b128 v[48:51], v8 offset:18432
  v_cndmask_b32 v138, v138, v142, s[68:69]
  v_mfma_f32_16x16x32_bf16 v[80:83], a[84:87], v[32:35], v[80:83]
  v_cndmask_b32 v139, v139, v143, s[70:71]
  v_cvt_pk_bf16_f32 v17, v136, v137
  v_mfma_f32_16x16x32_bf16 v[84:87], a[88:91], v[32:35], v[84:87]
  v_lshlrev_b32 v136, 16, v17
  v_and_b32 v137, 0xffff0000, v17
  v_mfma_f32_16x16x32_bf16 v[88:91], v[32:35], a[92:95], v[88:91]
  s_waitcnt lgkmcnt(5)
  v_cvt_pk_bf16_f32 v17, v138, v139
  v_lshlrev_b32 v138, 16, v17
  v_mfma_f32_16x16x32_bf16 v[76:79], a[96:99], v[36:39], v[76:79]
  ds_read_b128 v[52:55], v7 offset:22528
  v_and_b32 v139, 0xffff0000, v17
  v_mfma_f32_16x16x32_bf16 v[80:83], a[100:103], v[36:39], v[80:83]
  v_mul_f32 v136, s82, v136
  v_mul_f32 v137, s82, v137
  v_mfma_f32_16x16x32_bf16 v[84:87], a[104:107], v[36:39], v[84:87]
  s_add_u32 m0, s31, 35712
  v_mul_f32 v138, s82, v138
  v_mul_f32 v139, s82, v139
  v_mfma_f32_16x16x32_bf16 v[88:91], v[36:39], a[108:111], v[88:91]
  s_waitcnt lgkmcnt(3)
  v_cvt_pk_bf16_f32 v17, v136, v137
  v_lshlrev_b32 v136, 16, v17
  v_mfma_f32_16x16x32_bf16 v[76:79], a[112:115], v[40:43], v[76:79]
  ds_read_b128 v[56:59], v8 offset:22528
  v_and_b32 v137, 0xffff0000, v17
  v_mfma_f32_16x16x32_bf16 v[80:83], a[116:119], v[40:43], v[80:83]
  v_cvt_pk_bf16_f32 v17, v138, v139
  v_lshlrev_b32 v138, 16, v17
  v_mfma_f32_16x16x32_bf16 v[84:87], a[120:123], v[40:43], v[84:87]
  v_and_b32 v139, 0xffff0000, v17
  v_cndmask_b32 v136, v16, v136, s[54:55]
  v_mfma_f32_16x16x32_bf16 v[88:91], v[40:43], a[124:127], v[88:91]
  s_waitcnt lgkmcnt(3)
  v_cndmask_b32 v137, v16, v137, s[56:57]
  v_cndmask_b32 v138, v16, v138, s[58:59]
  v_mfma_f32_16x16x32_bf16 v[76:79], a[128:131], v[44:47], v[76:79]
  ds_read_b128 v[28:31], v7 offset:26624
  v_cndmask_b32 v139, v16, v139, s[60:61]
  v_mfma_f32_16x16x32_bf16 v[80:83], a[132:135], v[44:47], v[80:83]
  v_max3_f32 v17, v136, v137, v138
  v_max_f32 v17, v17, v139
  v_mfma_f32_16x16x32_bf16 v[84:87], a[136:139], v[44:47], v[84:87]
  v_mov_b32 v18, v17
  buffer_load_dwordx4 v4, s[8:11], s30 offen offset:1152 lds
  v_mfma_f32_16x16x32_bf16 v[88:91], v[44:47], a[140:143], v[88:91]
  s_waitcnt lgkmcnt(3)
  v_permlane32_swap_b32 v17, v18
  v_max_f32 v17, v17, v18
  v_mfma_f32_16x16x32_bf16 v[76:79], a[144:147], v[48:51], v[76:79]
  s_add_u32 s30, s30, 40960
  ds_read_b128 v[32:35], v8 offset:26624
  v_mov_b32 v18, v17
  v_mfma_f32_16x16x32_bf16 v[80:83], a[148:151], v[48:51], v[80:83]
  s_add_u32 s31, s31, 40960
  v_permlane16_swap_b32 v17, v18
  v_max_f32 v17, v17, v18
  v_mfma_f32_16x16x32_bf16 v[84:87], a[152:155], v[48:51], v[84:87]
  v_mul_f32 v17, s83, v17
  v_fma_f32 v136, v136, s83, -v17
  v_mfma_f32_16x16x32_bf16 v[88:91], v[48:51], a[156:159], v[88:91]
  s_waitcnt lgkmcnt(3)
  v_fma_f32 v137, v137, s83, -v17
  v_fma_f32 v138, v138, s83, -v17
  v_mfma_f32_16x16x32_bf16 v[76:79], a[160:163], v[52:55], v[76:79]
  ds_read_b128 v[36:39], v7 offset:30720
  v_fma_f32 v139, v139, s83, -v17
  v_mfma_f32_16x16x32_bf16 v[80:83], a[164:167], v[52:55], v[80:83]
  v_exp_f32 v136, v136
  v_mfma_f32_16x16x32_bf16 v[84:87], a[168:171], v[52:55], v[84:87]
  v_exp_f32 v137, v137
  v_mfma_f32_16x16x32_bf16 v[88:91], v[52:55], a[172:175], v[88:91]
  s_waitcnt lgkmcnt(3)
  v_exp_f32 v138, v138
  v_mfma_f32_16x16x32_bf16 v[76:79], a[176:179], v[56:59], v[76:79]
  ds_read_b128 v[40:43], v8 offset:30720
  v_mfma_f32_16x16x32_bf16 v[80:83], a[180:183], v[56:59], v[80:83]
  v_exp_f32 v139, v139
  v_mfma_f32_16x16x32_bf16 v[84:87], a[184:187], v[56:59], v[84:87]
  v_add_f32 v17, v136, v137
  v_add_f32 v18, v138, v139
  v_mfma_f32_16x16x32_bf16 v[88:91], v[56:59], a[188:191], v[88:91]
  s_waitcnt lgkmcnt(3)
  v_add_f32 v17, v17, v18
  v_mov_b32 v18, v17
  v_mfma_f32_16x16x32_bf16 v[76:79], a[192:195], v[28:31], v[76:79]
  ds_read_b128 v[44:47], v7 offset:34816
  v_permlane32_swap_b32 v17, v18
  v_mfma_f32_16x16x32_bf16 v[80:83], a[196:199], v[28:31], v[80:83]
  v_add_f32 v17, v17, v18
  v_mov_b32 v18, v17
  v_mfma_f32_16x16x32_bf16 v[84:87], a[200:203], v[28:31], v[84:87]
  v_permlane16_swap_b32 v17, v18
  v_add_f32 v17, v17, v18
  v_mfma_f32_16x16x32_bf16 v[88:91], v[28:31], a[204:207], v[88:91]
  s_waitcnt lgkmcnt(3)
  v_rcp_f32 v17, v17
  v_mfma_f32_16x16x32_bf16 v[76:79], a[208:211], v[32:35], v[76:79]
  ds_read_b128 v[48:51], v8 offset:34816
  v_mul_f32 v136, v136, v17
  v_mfma_f32_16x16x32_bf16 v[80:83], a[212:215], v[32:35], v[80:83]
  v_mul_f32 v137, v137, v17
  v_mul_f32 v138, v138, v17
  v_mfma_f32_16x16x32_bf16 v[84:87], a[216:219], v[32:35], v[84:87]
  v_mul_f32 v139, v139, v17
  v_cvt_pk_bf16_f32 v144, v136, v137
  v_mfma_f32_16x16x32_bf16 v[88:91], v[32:35], a[220:223], v[88:91]
  s_waitcnt lgkmcnt(3)
  v_cvt_pk_bf16_f32 v145, v138, v139
  v_and_b32 v146, v144, v22
  v_mfma_f32_16x16x32_bf16 v[76:79], a[224:227], v[36:39], v[76:79]
  ds_read_b128 v[52:55], v7 offset:38912
  v_and_b32 v147, v145, v23
  v_mfma_f32_16x16x32_bf16 v[80:83], a[228:231], v[36:39], v[80:83]
  v_and_b32 v144, v144, v20
  v_and_b32 v145, v145, v21
  v_mfma_f32_16x16x32_bf16 v[84:87], a[232:235], v[36:39], v[84:87]
  s_cmp_ge_u32 s31, 122880
  s_cselect_b32 s21, 122880, 0
  s_sub_u32 s31, s31, s21
  v_mfma_f32_16x16x32_bf16 v[88:91], v[36:39], a[236:239], v[88:91]
  s_add_u32 s33, s33, 40960
  s_waitcnt lgkmcnt(3)
  v_mfma_f32_16x16x32_bf16 v[76:79], a[240:243], v[40:43], v[76:79]
  ds_read_b128 v[56:59], v8 offset:38912
  v_mfma_f32_16x16x32_bf16 v[80:83], a[244:247], v[40:43], v[80:83]
  s_cmp_ge_u32 s33, 122880
  s_cselect_b32 s33, 0, s33
  v_mfma_f32_16x16x32_bf16 v[84:87], a[248:251], v[40:43], v[84:87]
  v_add_u32 v7, s33, v5
  v_add_u32 v8, s33, v6
  v_mfma_f32_16x16x32_bf16 v[88:91], v[40:43], a[252:255], v[88:91]
  s_waitcnt lgkmcnt(3)
  v_mfma_f32_16x16x32_bf16 v[76:79], v[192:195], v[44:47], v[76:79]
  s_waitcnt vmcnt(12)
  s_barrier
  ds_read_b128 v[28:31], v7 offset:0
  v_mfma_f32_16x16x32_bf16 v[80:83], v[196:199], v[44:47], v[80:83]
  v_mfma_f32_16x16x32_bf16 v[84:87], v[200:203], v[44:47], v[84:87]
  v_mfma_f32_16x16x32_bf16 v[88:91], v[44:47], v[204:207], v[88:91]
  v_mfma_f32_16x16x32_bf16 v[148:151], v[108:111], v[144:147], 0
  v_mfma_f32_16x16x32_bf16 v[152:155], v[112:115], v[144:147], 0
  s_waitcnt lgkmcnt(3)
  v_mov_b32 v96, v92
  v_mov_b32 v97, v93
  v_mfma_f32_16x16x32_bf16 v[76:79], v[208:211], v[48:51], v[76:79]
  ds_read_b128 v[32:35], v8 offset:0
  v_mov_b32 v98, v94
  v_mfma_f32_16x16x32_bf16 v[80:83], v[212:215], v[48:51], v[80:83]
  v_mov_b32 v99, v95
  v_mov_b32 v110, v108
  v_mfma_f32_16x16x32_bf16 v[84:87], v[216:219], v[48:51], v[84:87]
  v_cvt_pk_bf16_f32 v156, v148, v149
  v_cvt_pk_bf16_f32 v157, v150, v151
  v_mfma_f32_16x16x32_bf16 v[88:91], v[48:51], v[220:223], v[88:91]
  s_waitcnt lgkmcnt(3)
  ds_write_b64 v9, v[156:157] offset:0
  v_cvt_pk_bf16_f32 v158, v152, v153
  v_mfma_f32_16x16x32_bf16 v[76:79], v[224:227], v[52:55], v[76:79]
  ds_read_b128 v[36:39], v7 offset:4096
  v_cvt_pk_bf16_f32 v159, v154, v155
  v_mfma_f32_16x16x32_bf16 v[80:83], v[228:231], v[52:55], v[80:83]
  ds_write_b64 v10, v[158:159] offset:0
  v_mov_b32 v111, v109
  v_mfma_f32_16x16x32_bf16 v[84:87], v[232:235], v[52:55], v[84:87]
  v_mov_b32 v114, v112
  v_mov_b32 v115, v113
  v_mfma_f32_16x16x32_bf16 v[88:91], v[52:55], v[236:239], v[88:91]
  s_waitcnt lgkmcnt(5)
  v_mfma_f32_16x16x32_bf16 v[76:79], v[240:243], v[56:59], v[76:79]
  ds_read_b128 v[40:43], v8 offset:4096
  v_mfma_f32_16x16x32_bf16 v[80:83], v[244:247], v[56:59], v[80:83]
  v_mfma_f32_16x16x32_bf16 v[84:87], v[248:251], v[56:59], v[84:87]
  s_cmp_gt_u32 s26, 0
  v_mfma_f32_16x16x32_bf16 v[88:91], v[56:59], v[252:255], v[88:91]
  s_waitcnt lgkmcnt(5)
  s_cbranch_scc1 bfl_210
  s_nop 7
  v_cvt_pk_bf16_f32 v128, v84, v85
  v_cvt_pk_bf16_f32 v129, v86, v87
  v_cvt_pk_bf16_f32 v124, v76, v77
  v_cvt_pk_bf16_f32 v125, v78, v79
  v_cvt_pk_bf16_f32 v100, v80, v81
  v_cvt_pk_bf16_f32 v101, v82, v83
  v_cvt_pk_bf16_f32 v116, v88, v89
  v_cvt_pk_bf16_f32 v117, v90, v91
  v_cndmask_b32 v126, 0, v128, s[62:63]
  v_cndmask_b32 v127, 0, v129, s[62:63]
  s_nop 1
  v_mfma_f32_16x16x32_bf16 v[132:135], v[128:131], v[24:27], 0
  s_nop 7
  v_permlane16_swap_b32 v128, v102
  v_permlane16_swap_b32 v129, v103
  s_nop 1
  v_mfma_f32_16x16x32_bf16 v[136:139], v[100:103], v[124:127], 0
  v_mfma_f32_16x16x32_bf16 v[140:143], v[104:107], v[124:127], 0
  s_nop 7
  v_cvt_pk_bf16_f32 v120, v132, v133
  v_cvt_pk_bf16_f32 v121, v134, v135
  v_cndmask_b32 v136, v136, v140, s[64:65]
  v_cndmask_b32 v137, v137, v141, s[66:67]
  v_cndmask_b32 v138, v138, v142, s[68:69]
  v_cndmask_b32 v139, v139, v143, s[70:71]
  v_cvt_pk_bf16_f32 v17, v136, v137
  v_lshlrev_b32 v136, 16, v17
  v_and_b32 v137, 0xffff0000, v17
  v_cvt_pk_bf16_f32 v17, v138, v139
  v_lshlrev_b32 v138, 16, v17
  v_and_b32 v139, 0xffff0000, v17
  v_mul_f32 v136, s82, v136
  v_mul_f32 v137, s82, v137
  v_mul_f32 v138, s82, v138
  v_mul_f32 v139, s82, v139
  v_cvt_pk_bf16_f32 v17, v136, v137
  v_lshlrev_b32 v136, 16, v17
  v_and_b32 v137, 0xffff0000, v17
  v_cvt_pk_bf16_f32 v17, v138, v139
  v_lshlrev_b32 v138, 16, v17
  v_and_b32 v139, 0xffff0000, v17
  v_cndmask_b32 v136, v16, v136, s[54:55]
  v_cndmask_b32 v137, v16, v137, s[56:57]
  v_cndmask_b32 v138, v16, v138, s[58:59]
  v_cndmask_b32 v139, v16, v139, s[60:61]
  v_max3_f32 v17, v136, v137, v138
  v_max_f32 v17, v17, v139
  v_mov_b32 v18, v17
  s_nop 1
  v_permlane32_swap_b32 v17, v18
  v_max_f32 v17, v17, v18
  v_mov_b32 v18, v17
  s_nop 1
  v_permlane16_swap_b32 v17, v18
  v_max_f32 v17, v17, v18
  v_mul_f32 v17, s83, v17
  v_fma_f32 v136, v136, s83, -v17
  v_fma_f32 v137, v137, s83, -v17
  v_fma_f32 v138, v138, s83, -v17
  v_fma_f32 v139, v139, s83, -v17
  v_exp_f32 v136, v136
  v_exp_f32 v137, v137
  v_exp_f32 v138, v138
  v_exp_f32 v139, v139
  s_nop 1
  v_add_f32 v17, v136, v137
  v_add_f32 v18, v138, v139
  v_add_f32 v17, v17, v18
  v_mov_b32 v18, v17
  s_nop 1
  v_permlane32_swap_b32 v17, v18
  v_add_f32 v17, v17, v18
  v_mov_b32 v18, v17
  s_nop 1
  v_permlane16_swap_b32 v17, v18
  v_add_f32 v17, v17, v18
  v_rcp_f32 v17, v17
  s_nop 1
  v_mul_f32 v136, v136, v17
  v_mul_f32 v137, v137, v17
  v_mul_f32 v138, v138, v17
  v_mul_f32 v139, v139, v17
  v_cvt_pk_bf16_f32 v144, v136, v137
  v_cvt_pk_bf16_f32 v145, v138, v139
  v_and_b32 v146, v144, v22
  v_and_b32 v147, v145, v23
  v_and_b32 v144, v144, v20
  v_and_b32 v145, v145, v21
  s_nop 1
  v_mfma_f32_16x16x32_bf16 v[148:151], v[116:119], v[144:147], 0
  v_mfma_f32_16x16x32_bf16 v[152:155], v[120:123], v[144:147], 0
  s_nop 7
  v_mov_b32 v104, v100
  v_mov_b32 v105, v101
  v_mov_b32 v106, v102
  v_mov_b32 v107, v103
  v_mov_b32 v118, v116
  v_mov_b32 v119, v117
  v_mov_b32 v122, v120
  v_mov_b32 v123, v121
  v_cvt_pk_bf16_f32 v156, v148, v149
  v_cvt_pk_bf16_f32 v157, v150, v151
  ds_write_b64 v9, v[156:157] offset:16
  v_cvt_pk_bf16_f32 v158, v152, v153
  v_cvt_pk_bf16_f32 v159, v154, v155
  ds_write_b64 v10, v[158:159] offset:8
  s_waitcnt lgkmcnt(0)
  s_barrier
  ds_read_b128 v[160:163], v11
  ds_read_b128 v[164:167], v12
  s_waitcnt lgkmcnt(0)
  buffer_store_dwordx4 v[160:163], v15, s[16:19], s49 offen sc1
  buffer_store_dwordx4 v[164:167], v14, s[16:19], s49 offen sc1
  s_waitcnt vmcnt(0)
  s_barrier
  s_lshl_b32 s21, s42, 7
  s_add_u32 s21, s21, 88064
  s_cmp_lg_u32 s20, 0
  s_cbranch_scc1 af_211
  v_mov_b32 v8, 0
  v_mov_b32 v9, 1
  s_mov_b64 exec, 1
  buffer_atomic_add v9, v8, s[72:75], s21 offen sc1
  s_mov_b64 exec, -1
  s_nop 1
af_211:
  s_barrier
  s_sub_u32 s2, s3, 96
  s_load_dwordx2 s[4:5], s[0:1], 0
  s_load_dwordx2 s[6:7], s[0:1], 16
  s_load_dwordx2 s[38:39], s[0:1], 104
  s_mov_b32 s42, s2
  s_waitcnt lgkmcnt(0)
  s_mov_b32 s8, s4
  s_mov_b32 s9, s5
  s_mov_b32 s10, 2621440
  s_mov_b32 s11, 0x00020000
  s_mov_b32 s12, s6
  s_mov_b32 s13, s7
  s_mov_b32 s14, 7864320
  s_mov_b32 s15, 0x00020000
  s_mov_b32 s16, s38
  s_mov_b32 s17, s39
  s_mov_b32 s18, 167772160
  s_mov_b32 s19, 0x00020000
  s_add_u32 s72, s38, 170983424
  s_addc_u32 s73, s39, 0
  s_mov_b32 s74, 96768
  s_mov_b32 s75, 0x00020000
  s_mul_i32 s44, s42, 384
  v_mov_b32 v9, 2731
  v_add_u32 v8, 0, v1
  v_mul_u32_u24 v7, v8, v9
  v_lshrrev_b32 v7, 16, v7
  v_mul_u32_u24 v4, 24, v7
  v_sub_u32 v8, v8, v4
  s_mov_b32 s21, 12288
  v_mul_lo_u32 v7, v7, s21
  v_lshl_add_u32 v4, v8, 4, v7
  v_add_u32 v8, 64, v1
  v_mul_u32_u24 v7, v8, v9
  v_lshrrev_b32 v7, 16, v7
  v_mul_u32_u24 v5, 24, v7
  v_sub_u32 v8, v8, v5
  s_mov_b32 s21, 12288
  v_mul_lo_u32 v7, v7, s21
  v_lshl_add_u32 v5, v8, 4, v7
  v_add_u32 v8, 128, v1
  v_mul_u32_u24 v7, v8, v9
  v_lshrrev_b32 v7, 16, v7
  v_mul_u32_u24 v6, 24, v7
  v_sub_u32 v8, v8, v6
  s_mov_b32 s21, 12288
  v_mul_lo_u32 v7, v7, s21
  v_lshl_add_u32 v6, v8, 4, v7
  v_lshrrev_b32 v7, 2, v2
  v_lshl_add_u32 v7, v3, 3, v7
  v_mul_u32_u24 v7, 384, v7
  v_and_b32 v8, 3, v2
  v_lshlrev_b32 v8, 3, v8
  s_mul_i32 s21, s20, 96
  v_add3_u32 v7, v7, v8, s21
  v_add_u32 v8, 61440, v7
  s_mul_i32 s21, s20, 491520
  s_add_u32 s21, s21, 0
  s_add_u32 s21, s21, s44
  s_mul_i32 s22, s20, 15360
  s_add_u32 s22, s22, 0
  s_add_u32 m0, s22, 0
  s_nop 0
  buffer_load_dwordx4 v4, s[12:15], s21 offen lds
  s_add_u32 m0, s22, 1024
  s_nop 0
  buffer_load_dwordx4 v5, s[12:15], s21 offen lds
  s_add_u32 m0, s22, 2048
  s_nop 0
  buffer_load_dwordx4 v6, s[12:15], s21 offen lds
  s_mul_i32 s21, s20, 491520
  s_add_u32 s21, s21, 98304
  s_add_u32 s21, s21, s44
  s_mul_i32 s22, s20, 15360
  s_add_u32 s22, s22, 3072
  s_add_u32 m0, s22, 0
  s_nop 0
  buffer_load_dwordx4 v4, s[12:15], s21 offen lds
  s_add_u32 m0, s22, 1024
  s_nop 0
  buffer_load_dwordx4 v5, s[12:15], s21 offen lds
  s_add_u32 m0, s22, 2048
  s_nop 0
  buffer_load_dwordx4 v6, s[12:15], s21 offen lds
  s_mul_i32 s21, s20, 491520
  s_add_u32 s21, s21, 196608
  s_add_u32 s21, s21, s44
  s_mul_i32 s22, s20, 15360
  s_add_u32 s22, s22, 6144
  s_add_u32 m0, s22, 0
  s_nop 0
  buffer_load_dwordx4 v4, s[12:15], s21 offen lds
  s_add_u32 m0, s22, 1024
  s_nop 0
  buffer_load_dwordx4 v5, s[12:15], s21 offen lds
  s_add_u32 m0, s22, 2048
  s_nop 0
  buffer_load_dwordx4 v6, s[12:15], s21 offen lds
  s_mul_i32 s21, s20, 491520
  s_add_u32 s21, s21, 294912
  s_add_u32 s21, s21, s44
  s_mul_i32 s22, s20, 15360
  s_add_u32 s22, s22, 9216
  s_add_u32 m0, s22, 0
  s_nop 0
  buffer_load_dwordx4 v4, s[12:15], s21 offen lds
  s_add_u32 m0, s22, 1024
  s_nop 0
  buffer_load_dwordx4 v5, s[12:15], s21 offen lds
  s_add_u32 m0, s22, 2048
  s_nop 0
  buffer_load_dwordx4 v6, s[12:15], s21 offen lds
  s_mul_i32 s21, s20, 491520
  s_add_u32 s21, s21, 393216
  s_add_u32 s21, s21, s44
  s_mul_i32 s22, s20, 15360
  s_add_u32 s22, s22, 12288
  s_add_u32 m0, s22, 0
  s_nop 0
  buffer_load_dwordx4 v4, s[12:15], s21 offen lds
  s_add_u32 m0, s22, 1024
  s_nop 0
  buffer_load_dwordx4 v5, s[12:15], s21 offen lds
  s_add_u32 m0, s22, 2048
  s_nop 0
  buffer_load_dwordx4 v6, s[12:15], s21 offen lds
  s_mul_i32 s21, s20, 491520
  s_add_u32 s21, s21, 1966080
  s_add_u32 s21, s21, s44
  s_mul_i32 s22, s20, 15360
  s_add_u32 s22, s22, 61440
  s_add_u32 m0, s22, 0
  s_nop 0
  buffer_load_dwordx4 v4, s[12:15], s21 offen lds
  s_add_u32 m0, s22, 1024
  s_nop 0
  buffer_load_dwordx4 v5, s[12:15], s21 offen lds
  s_add_u32 m0, s22, 2048
  s_nop 0
  buffer_load_dwordx4 v6, s[12:15], s21 offen lds
  s_mul_i32 s21, s20, 491520
  s_add_u32 s21, s21, 2064384
  s_add_u32 s21, s21, s44
  s_mul_i32 s22, s20, 15360
  s_add_u32 s22, s22, 64512
  s_add_u32 m0, s22, 0
  s_nop 0
  buffer_load_dwordx4 v4, s[12:15], s21 offen lds
  s_add_u32 m0, s22, 1024
  s_nop 0
  buffer_load_dwordx4 v5, s[12:15], s21 offen lds
  s_add_u32 m0, s22, 2048
  s_nop 0
  buffer_load_dwordx4 v6, s[12:15], s21 offen lds
  s_mul_i32 s21, s20, 491520
  s_add_u32 s21, s21, 2162688
  s_add_u32 s21, s21, s44
  s_mul_i32 s22, s20, 15360
  s_add_u32 s22, s22, 67584
  s_add_u32 m0, s22, 0
  s_nop 0
  buffer_load_dwordx4 v4, s[12:15], s21 offen lds
  s_add_u32 m0, s22, 1024
  s_nop 0
  buffer_load_dwordx4 v5, s[12:15], s21 offen lds
  s_add_u32 m0, s22, 2048
  s_nop 0
  buffer_load_dwordx4 v6, s[12:15], s21 offen lds
  s_mul_i32 s21, s20, 491520
  s_add_u32 s21, s21, 2260992
  s_add_u32 s21, s21, s44
  s_mul_i32 s22, s20, 15360
  s_add_u32 s22, s22, 70656
  s_add_u32 m0, s22, 0
  s_nop 0
  buffer_load_dwordx4 v4, s[12:15], s21 offen lds
  s_add_u32 m0, s22, 1024
  s_nop 0
  buffer_load_dwordx4 v5, s[12:15], s21 offen lds
  s_add_u32 m0, s22, 2048
  s_nop 0
  buffer_load_dwordx4 v6, s[12:15], s21 offen lds
  s_mul_i32 s21, s20, 491520
  s_add_u32 s21, s21, 2359296
  s_add_u32 s21, s21, s44
  s_mul_i32 s22, s20, 15360
  s_add_u32 s22, s22, 73728
  s_add_u32 m0, s22, 0
  s_nop 0
  buffer_load_dwordx4 v4, s[12:15], s21 offen lds
  s_add_u32 m0, s22, 1024
  s_nop 0
  buffer_load_dwordx4 v5, s[12:15], s21 offen lds
  s_add_u32 m0, s22, 2048
  s_nop 0
  buffer_load_dwordx4 v6, s[12:15], s21 offen lds
  s_mul_i32 s21, s20, 491520
  s_add_u32 s21, s21, 3932160
  s_add_u32 s21, s21, s44
  buffer_load_dwordx4 v[64:67], v4, s[12:15], s21 offen
  buffer_load_dwordx4 v[68:71], v5, s[12:15], s21 offen
  buffer_load_dwordx4 v[72:75], v6, s[12:15], s21 offen
  s_mul_i32 s21, s20, 491520
  s_add_u32 s21, s21, 4030464
  s_add_u32 s21, s21, s44
  buffer_load_dwordx4 v[76:79], v4, s[12:15], s21 offen
  buffer_load_dwordx4 v[80:83], v5, s[12:15], s21 offen
  buffer_load_dwordx4 v[84:87], v6, s[12:15], s21 offen
  s_mul_i32 s21, s20, 491520
  s_add_u32 s21, s21, 4128768
  s_add_u32 s21, s21, s44
  buffer_load_dwordx4 v[88:91], v4, s[12:15], s21 offen
  buffer_load_dwordx4 v[92:95], v5, s[12:15], s21 offen
  buffer_load_dwordx4 v[96:99], v6, s[12:15], s21 offen
  s_mul_i32 s21, s20, 491520
  s_add_u32 s21, s21, 4227072
  s_add_u32 s21, s21, s44
  buffer_load_dwordx4 v[100:103], v4, s[12:15], s21 offen
  buffer_load_dwordx4 v[104:107], v5, s[12:15], s21 offen
  buffer_load_dwordx4 v[108:111], v6, s[12:15], s21 offen
  s_mul_i32 s21, s20, 491520
  s_add_u32 s21, s21, 4325376
  s_add_u32 s21, s21, s44
  buffer_load_dwordx4 v[112:115], v4, s[12:15], s21 offen
  buffer_load_dwordx4 v[116:119], v5, s[12:15], s21 offen
  buffer_load_dwordx4 v[120:123], v6, s[12:15], s21 offen
  s_mul_i32 s21, s20, 491520
  s_add_u32 s21, s21, 5898240
  s_add_u32 s21, s21, s44
  buffer_load_dwordx4 v[124:127], v4, s[12:15], s21 offen
  buffer_load_dwordx4 v[128:131], v5, s[12:15], s21 offen
  buffer_load_dwordx4 v[132:135], v6, s[12:15], s21 offen
  s_mul_i32 s21, s20, 491520
  s_add_u32 s21, s21, 5996544
  s_add_u32 s21, s21, s44
  buffer_load_dwordx4 v[136:139], v4, s[12:15], s21 offen
  buffer_load_dwordx4 v[140:143], v5, s[12:15], s21 offen
  buffer_load_dwordx4 v[144:147], v6, s[12:15], s21 offen
  s_mul_i32 s21, s20, 491520
  s_add_u32 s21, s21, 6094848
  s_add_u32 s21, s21, s44
  buffer_load_dwordx4 v[148:151], v4, s[12:15], s21 offen
  buffer_load_dwordx4 v[152:155], v5, s[12:15], s21 offen
  buffer_load_dwordx4 v[156:159], v6, s[12:15], s21 offen
  s_mul_i32 s21, s20, 491520
  s_add_u32 s21, s21, 6193152
  s_add_u32 s21, s21, s44
  buffer_load_dwordx4 v[160:163], v4, s[12:15], s21 offen
  buffer_load_dwordx4 v[164:167], v5, s[12:15], s21 offen
  buffer_load_dwordx4 v[168:171], v6, s[12:15], s21 offen
  s_mul_i32 s21, s20, 491520
  s_add_u32 s21, s21, 6291456
  s_add_u32 s21, s21, s44
  buffer_load_dwordx4 v[172:175], v4, s[12:15], s21 offen
  buffer_load_dwordx4 v[176:179], v5, s[12:15], s21 offen
  buffer_load_dwordx4 v[180:183], v6, s[12:15], s21 offen
  s_mul_i32 s22, s20, 15360
  v_lshl_add_u32 v30, v1, 4, s22
  v_add_u32 v31, 61440, v30
  s_waitcnt vmcnt(45)
  s_barrier
  ds_read_b64_tr_b16 a[0:1], v7 offset:0
  ds_read_b64_tr_b16 a[2:3], v7 offset:1536
  ds_read_b64_tr_b16 a[4:5], v7 offset:32
  ds_read_b64_tr_b16 a[6:7], v7 offset:1568
  ds_read_b64_tr_b16 a[8:9], v7 offset:64
  ds_read_b64_tr_b16 a[10:11], v7 offset:1600
  ds_read_b64_tr_b16 a[12:13], v7 offset:12288
  ds_read_b64_tr_b16 a[14:15], v7 offset:13824
  ds_read_b64_tr_b16 a[16:17], v7 offset:12320
  ds_read_b64_tr_b16 a[18:19], v7 offset:13856
  ds_read_b64_tr_b16 a[20:21], v7 offset:12352
  ds_read_b64_tr_b16 a[22:23], v7 offset:13888
  ds_read_b64_tr_b16 a[24:25], v7 offset:24576
  ds_read_b64_tr_b16 a[26:27], v7 offset:26112
  ds_read_b64_tr_b16 a[28:29], v7 offset:24608
  ds_read_b64_tr_b16 a[30:31], v7 offset:26144
  ds_read_b64_tr_b16 a[32:33], v7 offset:24640
  ds_read_b64_tr_b16 a[34:35], v7 offset:26176
  ds_read_b64_tr_b16 a[36:37], v7 offset:36864
  ds_read_b64_tr_b16 a[38:39], v7 offset:38400
  ds_read_b64_tr_b16 a[40:41], v7 offset:36896
  ds_read_b64_tr_b16 a[42:43], v7 offset:38432
  ds_read_b64_tr_b16 a[44:45], v7 offset:36928
  ds_read_b64_tr_b16 a[46:47], v7 offset:38464
  ds_read_b64_tr_b16 a[48:49], v7 offset:49152
  ds_read_b64_tr_b16 a[50:51], v7 offset:50688
  ds_read_b64_tr_b16 a[52:53], v7 offset:49184
  ds_read_b64_tr_b16 a[54:55], v7 offset:50720
  ds_read_b64_tr_b16 a[56:57], v7 offset:49216
  ds_read_b64_tr_b16 a[58:59], v7 offset:50752
  s_waitcnt lgkmcnt(0)
  s_barrier
  s_waitcnt vmcnt(30)
  s_barrier
  ds_read_b64_tr_b16 a[60:61], v8 offset:0
  ds_read_b64_tr_b16 a[62:63], v8 offset:1536
  ds_read_b64_tr_b16 a[64:65], v8 offset:32
  ds_read_b64_tr_b16 a[66:67], v8 offset:1568
  ds_read_b64_tr_b16 a[68:69], v8 offset:64
  ds_read_b64_tr_b16 a[70:71], v8 offset:1600
  ds_read_b64_tr_b16 a[72:73], v8 offset:12288
  ds_read_b64_tr_b16 a[74:75], v8 offset:13824
  ds_read_b64_tr_b16 a[76:77], v8 offset:12320
  ds_read_b64_tr_b16 a[78:79], v8 offset:13856
  ds_read_b64_tr_b16 a[80:81], v8 offset:12352
  ds_read_b64_tr_b16 a[82:83], v8 offset:13888
  ds_read_b64_tr_b16 a[84:85], v8 offset:24576
  ds_read_b64_tr_b16 a[86:87], v8 offset:26112
  ds_read_b64_tr_b16 a[88:89], v8 offset:24608
  ds_read_b64_tr_b16 a[90:91], v8 offset:26144
  ds_read_b64_tr_b16 a[92:93], v8 offset:24640
  ds_read_b64_tr_b16 a[94:95], v8 offset:26176
  ds_read_b64_tr_b16 a[96:97], v8 offset:36864
  ds_read_b64_tr_b16 a[98:99], v8 offset:38400
  ds_read_b64_tr_b16 a[100:101], v8 offset:36896
  ds_read_b64_tr_b16 a[102:103], v8 offset:38432
  ds_read_b64_tr_b16 a[104:105], v8 offset:36928
  ds_read_b64_tr_b16 a[106:107], v8 offset:38464
  ds_read_b64_tr_b16 a[108:109], v8 offset:49152
  ds_read_b64_tr_b16 a[110:111], v8 offset:50688
  ds_read_b64_tr_b16 a[112:113], v8 offset:49184
  ds_read_b64_tr_b16 a[114:115], v8 offset:50720
  ds_read_b64_tr_b16 a[116:117], v8 offset:49216
  ds_read_b64_tr_b16 a[118:119], v8 offset:50752
  s_waitcnt lgkmcnt(0)
  s_barrier
  s_waitcnt vmcnt(15)
  ds_write_b128 v30, v[64:67] offset:0
  ds_write_b128 v30, v[68:71] offset:1024
  ds_write_b128 v30, v[72:75] offset:2048
  ds_write_b128 v30, v[76:79] offset:3072
  ds_write_b128 v30, v[80:83] offset:4096
  ds_write_b128 v30, v[84:87] offset:5120
  ds_write_b128 v30, v[88:91] offset:6144
  ds_write_b128 v30, v[92:95] offset:7168
  ds_write_b128 v30, v[96:99] offset:8192
  ds_write_b128 v30, v[100:103] offset:9216
  ds_write_b128 v30, v[104:107] offset:10240
  ds_write_b128 v30, v[108:111] offset:11264
  ds_write_b128 v30, v[112:115] offset:12288
  ds_write_b128 v30, v[116:119] offset:13312
  ds_write_b128 v30, v[120:123] offset:14336
  s_waitcnt lgkmcnt(0)
  s_barrier
  ds_read_b64_tr_b16 a[120:121], v7 offset:0
  ds_read_b64_tr_b16 a[122:123], v7 offset:1536
  ds_read_b64_tr_b16 a[124:125], v7 offset:32
  ds_read_b64_tr_b16 a[126:127], v7 offset:1568
  ds_read_b64_tr_b16 a[128:129], v7 offset:64
  ds_read_b64_tr_b16 a[130:131], v7 offset:1600
  ds_read_b64_tr_b16 a[132:133], v7 offset:12288
  ds_read_b64_tr_b16 a[134:135], v7 offset:13824
  ds_read_b64_tr_b16 a[136:137], v7 offset:12320
  ds_read_b64_tr_b16 a[138:139], v7 offset:13856
  ds_read_b64_tr_b16 a[140:141], v7 offset:12352
  ds_read_b64_tr_b16 a[142:143], v7 offset:13888
  ds_read_b64_tr_b16 a[144:145], v7 offset:24576
  ds_read_b64_tr_b16 a[146:147], v7 offset:26112
  ds_read_b64_tr_b16 a[148:149], v7 offset:24608
  ds_read_b64_tr_b16 a[150:151], v7 offset:26144
  ds_read_b64_tr_b16 a[152:153], v7 offset:24640
  ds_read_b64_tr_b16 a[154:155], v7 offset:26176
  ds_read_b64_tr_b16 a[156:157], v7 offset:36864
  ds_read_b64_tr_b16 a[158:159], v7 offset:38400
  ds_read_b64_tr_b16 a[160:161], v7 offset:36896
  ds_read_b64_tr_b16 a[162:163], v7 offset:38432
  ds_read_b64_tr_b16 a[164:165], v7 offset:36928
  ds_read_b64_tr_b16 a[166:167], v7 offset:38464
  ds_read_b64_tr_b16 a[168:169], v7 offset:49152
  ds_read_b64_tr_b16 a[170:171], v7 offset:50688
  ds_read_b64_tr_b16 a[172:173], v7 offset:49184
  ds_read_b64_tr_b16 a[174:175], v7 offset:50720
  ds_read_b64_tr_b16 a[176:177], v7 offset:49216
  ds_read_b64_tr_b16 a[178:179], v7 offset:50752
  s_waitcnt lgkmcnt(0)
  s_barrier
  s_waitcnt vmcnt(0)
  ds_write_b128 v31, v[124:127] offset:0
  ds_write_b128 v31, v[128:131] offset:1024
  ds_write_b128 v31, v[132:135] offset:2048
  ds_write_b128 v31, v[136:139] offset:3072
  ds_write_b128 v31, v[140:143] offset:4096
  ds_write_b128 v31, v[144:147] offset:5120
  ds_write_b128 v31, v[148:151] offset:6144
  ds_write_b128 v31, v[152:155] offset:7168
  ds_write_b128 v31, v[156:159] offset:8192
  ds_write_b128 v31, v[160:163] offset:9216
  ds_write_b128 v31, v[164:167] offset:10240
  ds_write_b128 v31, v[168:171] offset:11264
  ds_write_b128 v31, v[172:175] offset:12288
  ds_write_b128 v31, v[176:179] offset:13312
  ds_write_b128 v31, v[180:183] offset:14336
  s_waitcnt lgkmcnt(0)
  s_barrier
  ds_read_b64_tr_b16 a[180:181], v8 offset:0
  ds_read_b64_tr_b16 a[182:183], v8 offset:1536
  ds_read_b64_tr_b16 a[184:185], v8 offset:32
  ds_read_b64_tr_b16 a[186:187], v8 offset:1568
  ds_read_b64_tr_b16 a[188:189], v8 offset:64
  ds_read_b64_tr_b16 a[190:191], v8 offset:1600
  ds_read_b64_tr_b16 a[192:193], v8 offset:12288
  ds_read_b64_tr_b16 a[194:195], v8 offset:13824
  ds_read_b64_tr_b16 a[196:197], v8 offset:12320
  ds_read_b64_tr_b16 a[198:199], v8 offset:13856
  ds_read_b64_tr_b16 a[200:201], v8 offset:12352
  ds_read_b64_tr_b16 a[202:203], v8 offset:13888
  ds_read_b64_tr_b16 a[204:205], v8 offset:24576
  ds_read_b64_tr_b16 a[206:207], v8 offset:26112
  ds_read_b64_tr_b16 a[208:209], v8 offset:24608
  ds_read_b64_tr_b16 a[210:211], v8 offset:26144
  ds_read_b64_tr_b16 a[212:213], v8 offset:24640
  ds_read_b64_tr_b16 a[214:215], v8 offset:26176
  ds_read_b64_tr_b16 a[216:217], v8 offset:36864
  ds_read_b64_tr_b16 a[218:219], v8 offset:38400
  ds_read_b64_tr_b16 a[220:221], v8 offset:36896
  ds_read_b64_tr_b16 a[222:223], v8 offset:38432
  ds_read_b64_tr_b16 a[224:225], v8 offset:36928
  ds_read_b64_tr_b16 a[226:227], v8 offset:38464
  ds_read_b64_tr_b16 a[228:229], v8 offset:49152
  ds_read_b64_tr_b16 a[230:231], v8 offset:50688
  ds_read_b64_tr_b16 a[232:233], v8 offset:49184
  ds_read_b64_tr_b16 a[234:235], v8 offset:50720
  ds_read_b64_tr_b16 a[236:237], v8 offset:49216
  ds_read_b64_tr_b16 a[238:239], v8 offset:50752
  s_waitcnt lgkmcnt(0)
  s_barrier
  s_mov_b32 s30, 0
  s_mov_b32 s25, 162688
  s_mov_b32 s26, 16
  v_lshrrev_b32 v4, 3, v1
  v_and_b32 v5, 7, v1
  v_xor_b32 v5, v5, v4
  s_mul_i32 s21, s20, 32
  v_add_u32 v4, s21, v4
  v_mul_u32_u24 v4, 1280, v4
  v_lshl_add_u32 v10, v5, 4, v4
  s_mul_i32 s31, s20, 4096
  v_add_u32 v11, 10240, v10
  v_add_u32 v12, 20480, v10
  v_add_u32 v13, 30720, v10
  s_add_u32 m0, s31, 0
  s_nop 0
  buffer_load_dwordx4 v10, s[8:11], s30 offen lds
  s_add_u32 m0, s31, 1024
  s_nop 0
  buffer_load_dwordx4 v11, s[8:11], s30 offen lds
  s_add_u32 m0, s31, 2048
  s_nop 0
  buffer_load_dwordx4 v12, s[8:11], s30 offen lds
  s_add_u32 m0, s31, 3072
  s_nop 0
  buffer_load_dwordx4 v13, s[8:11], s30 offen lds
  s_add_u32 s30, s30, 128
  s_add_u32 m0, s31, 16384
  s_nop 0
  buffer_load_dwordx4 v10, s[8:11], s30 offen lds
  s_add_u32 m0, s31, 17408
  s_nop 0
  buffer_load_dwordx4 v11, s[8:11], s30 offen lds
  s_add_u32 m0, s31, 18432
  s_nop 0
  buffer_load_dwordx4 v12, s[8:11], s30 offen lds
  s_add_u32 m0, s31, 19456
  s_nop 0
  buffer_load_dwordx4 v13, s[8:11], s30 offen lds
  s_add_u32 s30, s30, 128
  s_add_u32 m0, s31, 32768
  s_nop 0
  buffer_load_dwordx4 v10, s[8:11], s30 offen lds
  s_add_u32 m0, s31, 33792
  s_nop 0
  buffer_load_dwordx4 v11, s[8:11], s30 offen lds
  s_add_u32 m0, s31, 34816
  s_nop 0
  buffer_load_dwordx4 v12, s[8:11], s30 offen lds
  s_add_u32 m0, s31, 35840
  s_nop 0
  buffer_load_dwordx4 v13, s[8:11], s30 offen lds
  s_add_u32 s30, s30, 128
  v_and_b32 v6, 7, v2
  v_add_u32 v4, 0, v3
  v_xor_b32 v4, v4, v6
  v_lshlrev_b32 v4, 4, v4
  v_lshl_add_u32 v14, v2, 7, v4
  v_add_u32 v16, 65536, v14
  v_add_u32 v18, 131072, v14
  v_add_u32 v4, 4, v3
  v_xor_b32 v4, v4, v6
  v_lshlrev_b32 v4, 4, v4
  v_lshl_add_u32 v15, v2, 7, v4
  v_add_u32 v17, 65536, v15
  v_add_u32 v19, 131072, v15
  v_lshlrev_b32 v26, 4, v1
  v_mov_b32 v28, 1
  v_mov_b32 v4, 0x40000000
  v_cmp_eq_u32 vcc, 0, v0
  s_nop 1
  v_cndmask_b32 v27, v4, 0, vcc
  s_mul_i32 s21, s20, 3072
  s_add_u32 s21, s21, 81920
  v_add_u32 v20, s21, v26
  s_mul_i32 s21, s20, 12288
  s_add_u32 s21, s21, 81920
  v_add_u32 v21, s21, v26
  v_add_u32 v22, 2048, v21
  v_add_u32 v23, 2056, v21
  v_and_b32 v4, 7, v2
  v_lshlrev_b32 v4, 4, v4
  v_lshl_add_u32 v24, v3, 7, v4
  v_lshrrev_b32 v25, 1, v24
  v_lshlrev_b32 v29, 3, v1
  v_and_b32 v4, 3, v1
  v_lshlrev_b32 v30, 3, v4
  v_mov_b32 v31, 0xf149f2ca
  v_mov_b32 v32, 0
  v_mov_b32 v4, 1073741824
  v_cmp_eq_u32 vcc, 0, v1
  v_lshlrev_b32 v5, 2, v3
  v_sub_u32 v5, v2, v5
  v_cndmask_b32 v33, v4, 0, vcc
  v_cmp_gt_u32 s[62:63], 2, v3
  s_mov_b32 s83, 0x3dd53b95
  s_lshl_b32 s77, s42, 7
  s_add_u32 s77, s77, 18432
  s_lshl_b32 s45, s20, 21
  s_lshl_b32 s21, s20, 13
  s_and_b32 s21, s21, 8192
  s_xor_b32 s21, s21, s80
  s_add_u32 s45, s45, s21
  s_lshl_b32 s21, s42, 16
  s_add_u32 s45, s45, s21
  s_lshr_b32 s47, s42, 1
  s_lshl_b32 s47, s47, 14
  s_and_b32 s22, s42, 1
  s_mul_i32 s22, s22, 2560
  s_add_u32 s47, s47, s22
  s_lshl_b32 s21, s20, 19
  s_lshl_b32 s22, s20, 11
  s_and_b32 s22, s22, 8192
  s_xor_b32 s22, s22, s80
  s_add_u32 s21, s21, s22
  s_add_u32 s21, s21, 134217728
  s_xor_b32 s21, s21, 8192
  s_add_u32 s47, s47, s21
  s_lshl_b32 s48, s20, 3
  s_and_b32 s21, s42, 7
  s_add_u32 s48, s48, s21
  s_lshl_b32 s48, s48, 7
  s_add_u32 s48, s48, 22528
  s_add_u32 s43, s20, 1
  s_mov_b32 s49, 0
  s_mov_b32 s50, 1073741824
  s_mov_b32 s81, 1073741824
  s_mov_b32 s82, 1073741824
  v_cmp_le_i32 s[64:65], 0, v5
  v_cmp_le_i32 s[66:67], 1, v5
  v_cmp_le_i32 s[68:69], 2, v5
  v_cmp_le_i32 s[70:71], 3, v5
  s_waitcnt vmcnt(8)
  s_barrier
  ds_read_b128 v[160:163], v14 offset:0
  ds_read_b128 v[164:167], v14 offset:2048
  ds_read_b128 v[168:171], v14 offset:4096
  ds_read_b128 v[172:175], v14 offset:6144
  s_waitcnt lgkmcnt(3)
  .p2align 3
qa_212:
  v_mfma_f32_16x16x32_bf16 v[64:67], a[0:3], v[160:163], 0
  ds_read_b128 v[176:179], v14 offset:8192
  v_cvt_pk_bf16_f32 v221, v126, v127
  v_mfma_f32_16x16x32_bf16 v[68:71], a[4:7], v[160:163], 0
  v_cvt_pk_bf16_f32 v222, v128, v129
  v_cvt_pk_bf16_f32 v223, v130, v131
  v_mfma_f32_16x16x32_bf16 v[72:75], a[8:11], v[160:163], 0
  s_waitcnt lgkmcnt(3)
  v_cvt_pk_bf16_f32 v226, v132, v133
  v_cvt_pk_bf16_f32 v227, v134, v135
  v_mfma_f32_16x16x32_bf16 v[76:79], a[0:3], v[164:167], 0
  ds_read_b128 v[180:183], v14 offset:10240
  v_cvt_pk_bf16_f32 v228, v136, v137
  v_mfma_f32_16x16x32_bf16 v[80:83], a[4:7], v[164:167], 0
  v_cvt_pk_bf16_f32 v229, v138, v139
  v_cvt_pk_bf16_f32 v230, v140, v141
  v_mfma_f32_16x16x32_bf16 v[84:87], a[8:11], v[164:167], 0
  s_waitcnt lgkmcnt(3)
  v_cvt_pk_bf16_f32 v231, v142, v143
  v_cvt_pk_bf16_f32 v236, v144, v145
  v_mfma_f32_16x16x32_bf16 v[88:91], a[0:3], v[168:171], 0
  ds_read_b128 v[184:187], v14 offset:12288
  v_cvt_pk_bf16_f32 v237, v146, v147
  v_mfma_f32_16x16x32_bf16 v[92:95], a[4:7], v[168:171], 0
  v_cvt_pk_bf16_f32 v232, v148, v149
  v_cvt_pk_bf16_f32 v233, v150, v151
  v_mfma_f32_16x16x32_bf16 v[96:99], a[8:11], v[168:171], 0
  s_waitcnt lgkmcnt(3)
  v_cvt_pk_bf16_f32 v234, v152, v153
  v_cvt_pk_bf16_f32 v235, v154, v155
  v_mfma_f32_16x16x32_bf16 v[100:103], a[0:3], v[172:175], 0
  ds_read_b128 v[188:191], v14 offset:14336
  v_cvt_pk_bf16_f32 v238, v156, v157
  v_mfma_f32_16x16x32_bf16 v[104:107], a[4:7], v[172:175], 0
  v_cvt_pk_bf16_f32 v239, v158, v159
  ds_write_b128 v20, v[192:195] offset:0
  v_mfma_f32_16x16x32_bf16 v[108:111], a[8:11], v[172:175], 0
  s_waitcnt lgkmcnt(4)
  v_mfma_f32_16x16x32_bf16 v[112:115], a[0:3], v[176:179], 0
  ds_read_b128 v[160:163], v15 offset:0
  ds_write_b128 v20, v[196:199] offset:1024
  v_mfma_f32_16x16x32_bf16 v[116:119], a[4:7], v[176:179], 0
  s_add_u32 m0, s31, 49152
  v_mfma_f32_16x16x32_bf16 v[120:123], a[8:11], v[176:179], 0
  s_waitcnt lgkmcnt(5)
  buffer_load_dwordx4 v10, s[8:11], s30 offen lds
  ds_write_b128 v20, v[200:203] offset:2048
  v_mfma_f32_16x16x32_bf16 v[124:127], a[0:3], v[180:183], 0
  ds_read_b128 v[164:167], v15 offset:2048
  v_mfma_f32_16x16x32_bf16 v[128:131], a[4:7], v[180:183], 0
  ds_write_b128 v20, v[204:207] offset:12288
  v_mfma_f32_16x16x32_bf16 v[132:135], a[8:11], v[180:183], 0
  s_waitcnt lgkmcnt(7)
  v_mfma_f32_16x16x32_bf16 v[136:139], a[0:3], v[184:187], 0
  ds_read_b128 v[168:171], v15 offset:4096
  ds_write_b128 v20, v[208:211] offset:13312
  v_mfma_f32_16x16x32_bf16 v[140:143], a[4:7], v[184:187], 0
  s_add_u32 m0, s31, 50176
  v_mfma_f32_16x16x32_bf16 v[144:147], a[8:11], v[184:187], 0
  s_waitcnt lgkmcnt(8)
  buffer_load_dwordx4 v11, s[8:11], s30 offen lds
  ds_write_b128 v20, v[212:215] offset:14336
  v_mfma_f32_16x16x32_bf16 v[148:151], a[0:3], v[188:191], 0
  ds_read_b128 v[172:175], v15 offset:6144
  v_mfma_f32_16x16x32_bf16 v[152:155], a[4:7], v[188:191], 0
  ds_write_b128 v20, v[216:219] offset:24576
  v_mfma_f32_16x16x32_bf16 v[156:159], a[8:11], v[188:191], 0
  s_waitcnt lgkmcnt(9)
  v_mfma_f32_16x16x32_bf16 v[64:67], a[12:15], v[160:163], v[64:67]
  ds_read_b128 v[176:179], v15 offset:8192
  ds_write_b128 v20, v[220:223] offset:25600
  v_mfma_f32_16x16x32_bf16 v[68:71], a[16:19], v[160:163], v[68:71]
  s_add_u32 m0, s31, 51200
  v_mfma_f32_16x16x32_bf16 v[72:75], a[20:23], v[160:163], v[72:75]
  s_waitcnt lgkmcnt(8)
  buffer_load_dwordx4 v12, s[8:11], s30 offen lds
  ds_write_b128 v20, v[224:227] offset:26624
  v_mfma_f32_16x16x32_bf16 v[76:79], a[12:15], v[164:167], v[76:79]
  ds_read_b128 v[180:183], v15 offset:10240
  v_mfma_f32_16x16x32_bf16 v[80:83], a[16:19], v[164:167], v[80:83]
  ds_write_b128 v20, v[228:231] offset:36864
  v_mfma_f32_16x16x32_bf16 v[84:87], a[20:23], v[164:167], v[84:87]
  s_waitcnt lgkmcnt(9)
  v_mfma_f32_16x16x32_bf16 v[88:91], a[12:15], v[168:171], v[88:91]
  ds_read_b128 v[184:187], v15 offset:12288
  ds_write_b128 v20, v[232:235] offset:37888
  v_mfma_f32_16x16x32_bf16 v[92:95], a[16:19], v[168:171], v[92:95]
  s_add_u32 m0, s31, 52224
  v_mfma_f32_16x16x32_bf16 v[96:99], a[20:23], v[168:171], v[96:99]
  s_waitcnt lgkmcnt(8)
  buffer_load_dwordx4 v13, s[8:11], s30 offen lds
  ds_write_b128 v20, v[236:239] offset:38912
  v_mfma_f32_16x16x32_bf16 v[100:103], a[12:15], v[172:175], v[100:103]
  s_add_u32 s30, s30, 128
  ds_read_b128 v[188:191], v15 offset:14336
  s_waitcnt vmcnt(8)
  v_mfma_f32_16x16x32_bf16 v[104:107], a[16:19], v[172:175], v[104:107]
  v_cmp_gt_u32 vcc, s49, v32
  v_mfma_f32_16x16x32_bf16 v[108:111], a[20:23], v[172:175], v[108:111]
  s_waitcnt lgkmcnt(8)
  s_cbranch_vccnz qw_213
qj_214:
  s_waitcnt lgkmcnt(1)
  v_mfma_f32_16x16x32_bf16 v[112:115], a[12:15], v[176:179], v[112:115]
  s_waitcnt vmcnt(8)
  s_barrier
  ds_read_b128 v[160:163], v14 offset:16384
  v_mfma_f32_16x16x32_bf16 v[116:119], a[16:19], v[176:179], v[116:119]
  s_add_u32 s29, s50, 0
  buffer_load_dwordx4 v[192:195], v26, s[16:19], s29 offen offset:0 sc1
  v_mfma_f32_16x16x32_bf16 v[120:123], a[20:23], v[176:179], v[120:123]
  s_waitcnt lgkmcnt(6)
  v_mfma_f32_16x16x32_bf16 v[124:127], a[12:15], v[180:183], v[124:127]
  ds_read_b128 v[164:167], v14 offset:18432
  buffer_load_dwordx4 v[196:199], v26, s[16:19], s29 offen offset:1024 sc1
  v_mfma_f32_16x16x32_bf16 v[128:131], a[16:19], v[180:183], v[128:131]
  v_mfma_f32_16x16x32_bf16 v[132:135], a[20:23], v[180:183], v[132:135]
  s_waitcnt lgkmcnt(5)
  buffer_load_dwordx4 v[224:227], v26, s[16:19], s29 offen offset:2048 sc1
  v_mfma_f32_16x16x32_bf16 v[136:139], a[12:15], v[184:187], v[136:139]
  ds_read_b128 v[168:171], v14 offset:20480
  v_mfma_f32_16x16x32_bf16 v[140:143], a[16:19], v[184:187], v[140:143]
  s_add_u32 s29, s50, 16384
  buffer_load_dwordx4 v[200:203], v26, s[16:19], s29 offen offset:0 sc1
  v_mfma_f32_16x16x32_bf16 v[144:147], a[20:23], v[184:187], v[144:147]
  s_waitcnt lgkmcnt(3)
  v_mfma_f32_16x16x32_bf16 v[148:151], a[12:15], v[188:191], v[148:151]
  ds_read_b128 v[172:175], v14 offset:22528
  buffer_load_dwordx4 v[204:207], v26, s[16:19], s29 offen offset:1024 sc1
  v_mfma_f32_16x16x32_bf16 v[152:155], a[16:19], v[188:191], v[152:155]
  v_mfma_f32_16x16x32_bf16 v[156:159], a[20:23], v[188:191], v[156:159]
  s_waitcnt lgkmcnt(3)
  buffer_load_dwordx4 v[228:231], v26, s[16:19], s29 offen offset:2048 sc1
  v_mfma_f32_16x16x32_bf16 v[64:67], a[24:27], v[160:163], v[64:67]
  ds_read_b128 v[176:179], v14 offset:24576
  v_mfma_f32_16x16x32_bf16 v[68:71], a[28:31], v[160:163], v[68:71]
  s_add_u32 m0, s31, 65536
  s_add_u32 s29, s50, 32768
  buffer_load_dwordx4 v[208:211], v26, s[16:19], s29 offen offset:0 sc1
  v_mfma_f32_16x16x32_bf16 v[72:75], a[32:35], v[160:163], v[72:75]
  s_waitcnt lgkmcnt(3)
  buffer_load_dwordx4 v10, s[8:11], s30 offen lds
  v_mfma_f32_16x16x32_bf16 v[76:79], a[24:27], v[164:167], v[76:79]
  ds_read_b128 v[180:183], v14 offset:26624
  buffer_load_dwordx4 v[212:215], v26, s[16:19], s29 offen offset:1024 sc1
  v_mfma_f32_16x16x32_bf16 v[80:83], a[28:31], v[164:167], v[80:83]
  v_mfma_f32_16x16x32_bf16 v[84:87], a[32:35], v[164:167], v[84:87]
  s_waitcnt lgkmcnt(3)
  buffer_load_dwordx4 v[232:235], v26, s[16:19], s29 offen offset:2048 sc1
  v_mfma_f32_16x16x32_bf16 v[88:91], a[24:27], v[168:171], v[88:91]
  ds_read_b128 v[184:187], v14 offset:28672
  v_mfma_f32_16x16x32_bf16 v[92:95], a[28:31], v[168:171], v[92:95]
  s_add_u32 m0, s31, 66560
  s_add_u32 s29, s50, 49152
  buffer_load_dwordx4 v[216:219], v26, s[16:19], s29 offen offset:0 sc1
  v_mfma_f32_16x16x32_bf16 v[96:99], a[32:35], v[168:171], v[96:99]
  s_waitcnt lgkmcnt(3)
  buffer_load_dwordx4 v11, s[8:11], s30 offen lds
  v_mfma_f32_16x16x32_bf16 v[100:103], a[24:27], v[172:175], v[100:103]
  ds_read_b128 v[188:191], v14 offset:30720
  buffer_load_dwordx4 v[220:223], v26, s[16:19], s29 offen offset:1024 sc1
  v_mfma_f32_16x16x32_bf16 v[104:107], a[28:31], v[172:175], v[104:107]
  v_mfma_f32_16x16x32_bf16 v[108:111], a[32:35], v[172:175], v[108:111]
  s_waitcnt lgkmcnt(3)
  buffer_load_dwordx4 v[236:239], v26, s[16:19], s29 offen offset:2048 sc1
  v_mfma_f32_16x16x32_bf16 v[112:115], a[24:27], v[176:179], v[112:115]
  ds_read_b128 v[160:163], v15 offset:16384
  v_mfma_f32_16x16x32_bf16 v[116:119], a[28:31], v[176:179], v[116:119]
  s_add_u32 m0, s31, 67584
  s_add_u32 s29, s50, 4096
  buffer_load_dwordx4 a[240:243], v24, s[16:19], s29 offen offset:2560 sc1
  v_mfma_f32_16x16x32_bf16 v[120:123], a[32:35], v[176:179], v[120:123]
  s_waitcnt lgkmcnt(3)
  buffer_load_dwordx4 v12, s[8:11], s30 offen lds
  v_mfma_f32_16x16x32_bf16 v[124:127], a[24:27], v[180:183], v[124:127]
  ds_read_b128 v[164:167], v15 offset:18432
  buffer_load_dwordx2 v[240:241], v25, s[16:19], s29 offen offset:3072 sc1
  v_mfma_f32_16x16x32_bf16 v[128:131], a[28:31], v[180:183], v[128:131]
  v_mfma_f32_16x16x32_bf16 v[132:135], a[32:35], v[180:183], v[132:135]
  s_waitcnt lgkmcnt(3)
  s_add_u32 s29, s50, 20480
  buffer_load_dwordx4 a[244:247], v24, s[16:19], s29 offen offset:2560 sc1
  v_mfma_f32_16x16x32_bf16 v[136:139], a[24:27], v[184:187], v[136:139]
  ds_read_b128 v[168:171], v15 offset:20480
  v_mfma_f32_16x16x32_bf16 v[140:143], a[28:31], v[184:187], v[140:143]
  s_add_u32 m0, s31, 68608
  buffer_load_dwordx2 v[242:243], v25, s[16:19], s29 offen offset:3072 sc1
  v_mfma_f32_16x16x32_bf16 v[144:147], a[32:35], v[184:187], v[144:147]
  s_waitcnt lgkmcnt(3)
  buffer_load_dwordx4 v13, s[8:11], s30 offen lds
  v_mfma_f32_16x16x32_bf16 v[148:151], a[24:27], v[188:191], v[148:151]
  s_add_u32 s30, s30, 128
  ds_read_b128 v[172:175], v15 offset:22528
  s_add_u32 s29, s50, 36864
  v_mfma_f32_16x16x32_bf16 v[152:155], a[28:31], v[188:191], v[152:155]
  buffer_load_dwordx4 a[248:251], v24, s[16:19], s29 offen offset:2560 sc1
  v_mfma_f32_16x16x32_bf16 v[156:159], a[32:35], v[188:191], v[156:159]
  s_waitcnt lgkmcnt(3)
  v_mfma_f32_16x16x32_bf16 v[64:67], a[36:39], v[160:163], v[64:67]
  ds_read_b128 v[176:179], v15 offset:24576
  buffer_load_dwordx2 v[244:245], v25, s[16:19], s29 offen offset:3072 sc1
  v_mfma_f32_16x16x32_bf16 v[68:71], a[40:43], v[160:163], v[68:71]
  v_mfma_f32_16x16x32_bf16 v[72:75], a[44:47], v[160:163], v[72:75]
  s_waitcnt lgkmcnt(3)
  s_add_u32 s29, s50, 53248
  buffer_load_dwordx4 a[252:255], v24, s[16:19], s29 offen offset:2560 sc1
  v_mfma_f32_16x16x32_bf16 v[76:79], a[36:39], v[164:167], v[76:79]
  ds_read_b128 v[180:183], v15 offset:26624
  v_mfma_f32_16x16x32_bf16 v[80:83], a[40:43], v[164:167], v[80:83]
  buffer_load_dwordx2 v[246:247], v25, s[16:19], s29 offen offset:3072 sc1
  v_mfma_f32_16x16x32_bf16 v[84:87], a[44:47], v[164:167], v[84:87]
  s_waitcnt lgkmcnt(3)
  v_mfma_f32_16x16x32_bf16 v[88:91], a[36:39], v[168:171], v[88:91]
  ds_read_b128 v[184:187], v15 offset:28672
  v_mfma_f32_16x16x32_bf16 v[92:95], a[40:43], v[168:171], v[92:95]
  v_mfma_f32_16x16x32_bf16 v[96:99], a[44:47], v[168:171], v[96:99]
  s_waitcnt lgkmcnt(3)
  v_mfma_f32_16x16x32_bf16 v[100:103], a[36:39], v[172:175], v[100:103]
  ds_read_b128 v[188:191], v15 offset:30720
  v_mfma_f32_16x16x32_bf16 v[104:107], a[40:43], v[172:175], v[104:107]
  v_mfma_f32_16x16x32_bf16 v[108:111], a[44:47], v[172:175], v[108:111]
  s_waitcnt lgkmcnt(3)
  v_mfma_f32_16x16x32_bf16 v[112:115], a[36:39], v[176:179], v[112:115]
  s_waitcnt vmcnt(28)
  s_barrier
  ds_read_b128 v[160:163], v14 offset:32768
  v_mfma_f32_16x16x32_bf16 v[116:119], a[40:43], v[176:179], v[116:119]
  v_mfma_f32_16x16x32_bf16 v[120:123], a[44:47], v[176:179], v[120:123]
  s_waitcnt lgkmcnt(3)
  v_mfma_f32_16x16x32_bf16 v[124:127], a[36:39], v[180:183], v[124:127]
  ds_read_b128 v[164:167], v14 offset:34816
  v_mfma_f32_16x16x32_bf16 v[128:131], a[40:43], v[180:183], v[128:131]
  v_mfma_f32_16x16x32_bf16 v[132:135], a[44:47], v[180:183], v[132:135]
  s_waitcnt lgkmcnt(3)
  v_mfma_f32_16x16x32_bf16 v[136:139], a[36:39], v[184:187], v[136:139]
  ds_read_b128 v[168:171], v14 offset:36864
  v_mfma_f32_16x16x32_bf16 v[140:143], a[40:43], v[184:187], v[140:143]
  v_mfma_f32_16x16x32_bf16 v[144:147], a[44:47], v[184:187], v[144:147]
  s_waitcnt lgkmcnt(3)
  v_mfma_f32_16x16x32_bf16 v[148:151], a[36:39], v[188:191], v[148:151]
  ds_read_b128 v[172:175], v14 offset:38912
  v_mfma_f32_16x16x32_bf16 v[152:155], a[40:43], v[188:191], v[152:155]
  v_mfma_f32_16x16x32_bf16 v[156:159], a[44:47], v[188:191], v[156:159]
  s_waitcnt lgkmcnt(3)
  v_mfma_f32_16x16x32_bf16 v[64:67], a[48:51], v[160:163], v[64:67]
  ds_read_b128 v[176:179], v14 offset:40960
  v_mfma_f32_16x16x32_bf16 v[68:71], a[52:55], v[160:163], v[68:71]
  s_add_u32 m0, s31, 0
  v_mfma_f32_16x16x32_bf16 v[72:75], a[56:59], v[160:163], v[72:75]
  s_waitcnt lgkmcnt(3)
  buffer_load_dwordx4 v10, s[8:11], s30 offen lds
  v_mfma_f32_16x16x32_bf16 v[76:79], a[48:51], v[164:167], v[76:79]
  ds_read_b128 v[180:183], v14 offset:43008
  v_mfma_f32_16x16x32_bf16 v[80:83], a[52:55], v[164:167], v[80:83]
  v_mfma_f32_16x16x32_bf16 v[84:87], a[56:59], v[164:167], v[84:87]
  s_waitcnt lgkmcnt(3)
  v_mfma_f32_16x16x32_bf16 v[88:91], a[48:51], v[168:171], v[88:91]
  ds_read_b128 v[184:187], v14 offset:45056
  v_mfma_f32_16x16x32_bf16 v[92:95], a[52:55], v[168:171], v[92:95]
  s_add_u32 m0, s31, 1024
  v_mfma_f32_16x16x32_bf16 v[96:99], a[56:59], v[168:171], v[96:99]
  s_waitcnt lgkmcnt(3)
  buffer_load_dwordx4 v11, s[8:11], s30 offen lds
  v_mfma_f32_16x16x32_bf16 v[100:103], a[48:51], v[172:175], v[100:103]
  ds_read_b128 v[188:191], v14 offset:47104
  v_mfma_f32_16x16x32_bf16 v[104:107], a[52:55], v[172:175], v[104:107]
  v_mfma_f32_16x16x32_bf16 v[108:111], a[56:59], v[172:175], v[108:111]
  s_waitcnt lgkmcnt(3)
  v_mfma_f32_16x16x32_bf16 v[112:115], a[48:51], v[176:179], v[112:115]
  ds_read_b128 v[160:163], v15 offset:32768
  v_mfma_f32_16x16x32_bf16 v[116:119], a[52:55], v[176:179], v[116:119]
  s_add_u32 m0, s31, 2048
  v_mfma_f32_16x16x32_bf16 v[120:123], a[56:59], v[176:179], v[120:123]
  s_waitcnt lgkmcnt(3)
  buffer_load_dwordx4 v12, s[8:11], s30 offen lds
  v_mfma_f32_16x16x32_bf16 v[124:127], a[48:51], v[180:183], v[124:127]
  ds_read_b128 v[164:167], v15 offset:34816
  v_mfma_f32_16x16x32_bf16 v[128:131], a[52:55], v[180:183], v[128:131]
  v_mfma_f32_16x16x32_bf16 v[132:135], a[56:59], v[180:183], v[132:135]
  s_waitcnt lgkmcnt(3)
  v_mfma_f32_16x16x32_bf16 v[136:139], a[48:51], v[184:187], v[136:139]
  ds_read_b128 v[168:171], v15 offset:36864
  v_mfma_f32_16x16x32_bf16 v[140:143], a[52:55], v[184:187], v[140:143]
  s_add_u32 m0, s31, 3072
  v_mfma_f32_16x16x32_bf16 v[144:147], a[56:59], v[184:187], v[144:147]
  s_waitcnt lgkmcnt(3)
  buffer_load_dwordx4 v13, s[8:11], s30 offen lds
  v_mfma_f32_16x16x32_bf16 v[148:151], a[48:51], v[188:191], v[148:151]
  s_add_u32 s30, s30, 128
  ds_read_b128 v[172:175], v15 offset:38912
  v_mfma_f32_16x16x32_bf16 v[152:155], a[52:55], v[188:191], v[152:155]
  v_mfma_f32_16x16x32_bf16 v[156:159], a[56:59], v[188:191], v[156:159]
  s_waitcnt lgkmcnt(3)
  v_mfma_f32_16x16x32_bf16 v[64:67], a[60:63], v[160:163], v[64:67]
  ds_read_b128 v[176:179], v15 offset:40960
  v_mfma_f32_16x16x32_bf16 v[68:71], a[64:67], v[160:163], v[68:71]
  v_mfma_f32_16x16x32_bf16 v[72:75], a[68:71], v[160:163], v[72:75]
  s_waitcnt lgkmcnt(3)
  v_mfma_f32_16x16x32_bf16 v[76:79], a[60:63], v[164:167], v[76:79]
  ds_read_b128 v[180:183], v15 offset:43008
  v_mfma_f32_16x16x32_bf16 v[80:83], a[64:67], v[164:167], v[80:83]
  v_mfma_f32_16x16x32_bf16 v[84:87], a[68:71], v[164:167], v[84:87]
  s_waitcnt lgkmcnt(3)
  v_mfma_f32_16x16x32_bf16 v[88:91], a[60:63], v[168:171], v[88:91]
  ds_read_b128 v[184:187], v15 offset:45056
  v_mfma_f32_16x16x32_bf16 v[92:95], a[64:67], v[168:171], v[92:95]
  v_mfma_f32_16x16x32_bf16 v[96:99], a[68:71], v[168:171], v[96:99]
  s_waitcnt lgkmcnt(3)
  v_mfma_f32_16x16x32_bf16 v[100:103], a[60:63], v[172:175], v[100:103]
  ds_read_b128 v[188:191], v15 offset:47104
  v_mfma_f32_16x16x32_bf16 v[104:107], a[64:67], v[172:175], v[104:107]
  v_mfma_f32_16x16x32_bf16 v[108:111], a[68:71], v[172:175], v[108:111]
  s_waitcnt lgkmcnt(3)
  v_mfma_f32_16x16x32_bf16 v[112:115], a[60:63], v[176:179], v[112:115]
  s_waitcnt vmcnt(28)
  s_barrier
  ds_read_b128 v[160:163], v14 offset:49152
  v_mfma_f32_16x16x32_bf16 v[116:119], a[64:67], v[176:179], v[116:119]
  v_mfma_f32_16x16x32_bf16 v[120:123], a[68:71], v[176:179], v[120:123]
  s_waitcnt lgkmcnt(3)
  v_mfma_f32_16x16x32_bf16 v[124:127], a[60:63], v[180:183], v[124:127]
  ds_read_b128 v[164:167], v14 offset:51200
  v_mfma_f32_16x16x32_bf16 v[128:131], a[64:67], v[180:183], v[128:131]
  v_mfma_f32_16x16x32_bf16 v[132:135], a[68:71], v[180:183], v[132:135]
  s_waitcnt lgkmcnt(3)
  v_mfma_f32_16x16x32_bf16 v[136:139], a[60:63], v[184:187], v[136:139]
  ds_read_b128 v[168:171], v14 offset:53248
  v_mfma_f32_16x16x32_bf16 v[140:143], a[64:67], v[184:187], v[140:143]
  v_mfma_f32_16x16x32_bf16 v[144:147], a[68:71], v[184:187], v[144:147]
  s_waitcnt lgkmcnt(3)
  v_mfma_f32_16x16x32_bf16 v[148:151], a[60:63], v[188:191], v[148:151]
  ds_read_b128 v[172:175], v14 offset:55296
  v_mfma_f32_16x16x32_bf16 v[152:155], a[64:67], v[188:191], v[152:155]
  v_mfma_f32_16x16x32_bf16 v[156:159], a[68:71], v[188:191], v[156:159]
  s_waitcnt lgkmcnt(3)
  v_mfma_f32_16x16x32_bf16 v[64:67], a[72:75], v[160:163], v[64:67]
  ds_read_b128 v[176:179], v14 offset:57344
  v_mfma_f32_16x16x32_bf16 v[68:71], a[76:79], v[160:163], v[68:71]
  s_add_u32 m0, s31, 16384
  v_mfma_f32_16x16x32_bf16 v[72:75], a[80:83], v[160:163], v[72:75]
  s_waitcnt lgkmcnt(3)
  buffer_load_dwordx4 v10, s[8:11], s30 offen lds
  v_mfma_f32_16x16x32_bf16 v[76:79], a[72:75], v[164:167], v[76:79]
  ds_read_b128 v[180:183], v14 offset:59392
  v_mfma_f32_16x16x32_bf16 v[80:83], a[76:79], v[164:167], v[80:83]
  v_mfma_f32_16x16x32_bf16 v[84:87], a[80:83], v[164:167], v[84:87]
  s_waitcnt lgkmcnt(3)
  v_mfma_f32_16x16x32_bf16 v[88:91], a[72:75], v[168:171], v[88:91]
  ds_read_b128 v[184:187], v14 offset:61440
  v_mfma_f32_16x16x32_bf16 v[92:95], a[76:79], v[168:171], v[92:95]
  s_add_u32 m0, s31, 17408
  v_mfma_f32_16x16x32_bf16 v[96:99], a[80:83], v[168:171], v[96:99]
  s_waitcnt lgkmcnt(3)
  buffer_load_dwordx4 v11, s[8:11], s30 offen lds
  v_mfma_f32_16x16x32_bf16 v[100:103], a[72:75], v[172:175], v[100:103]
  ds_read_b128 v[188:191], v14 offset:63488
  v_mfma_f32_16x16x32_bf16 v[104:107], a[76:79], v[172:175], v[104:107]
  v_mfma_f32_16x16x32_bf16 v[108:111], a[80:83], v[172:175], v[108:111]
  s_waitcnt lgkmcnt(3)
  v_mfma_f32_16x16x32_bf16 v[112:115], a[72:75], v[176:179], v[112:115]
  ds_read_b128 v[160:163], v15 offset:49152
  v_mfma_f32_16x16x32_bf16 v[116:119], a[76:79], v[176:179], v[116:119]
  s_add_u32 m0, s31, 18432
  v_mfma_f32_16x16x32_bf16 v[120:123], a[80:83], v[176:179], v[120:123]
  s_waitcnt lgkmcnt(3)
  buffer_load_dwordx4 v12, s[8:11], s30 offen lds
  v_mfma_f32_16x16x32_bf16 v[124:127], a[72:75], v[180:183], v[124:127]
  ds_read_b128 v[164:167], v15 offset:51200
  v_mfma_f32_16x16x32_bf16 v[128:131], a[76:79], v[180:183], v[128:131]
  v_mfma_f32_16x16x32_bf16 v[132:135], a[80:83], v[180:183], v[132:135]
  s_waitcnt lgkmcnt(3)
  v_mfma_f32_16x16x32_bf16 v[136:139], a[72:75], v[184:187], v[136:139]
  ds_read_b128 v[168:171], v15 offset:53248
  v_mfma_f32_16x16x32_bf16 v[140:143], a[76:79], v[184:187], v[140:143]
  s_add_u32 m0, s31, 19456
  v_mfma_f32_16x16x32_bf16 v[144:147], a[80:83], v[184:187], v[144:147]
  s_waitcnt lgkmcnt(3)
  buffer_load_dwordx4 v13, s[8:11], s30 offen lds
  v_mfma_f32_16x16x32_bf16 v[148:151], a[72:75], v[188:191], v[148:151]
  s_add_u32 s30, s30, 128
  ds_read_b128 v[172:175], v15 offset:55296
  v_mfma_f32_16x16x32_bf16 v[152:155], a[76:79], v[188:191], v[152:155]
  v_mfma_f32_16x16x32_bf16 v[156:159], a[80:83], v[188:191], v[156:159]
  s_waitcnt lgkmcnt(3)
  v_mfma_f32_16x16x32_bf16 v[64:67], a[84:87], v[160:163], v[64:67]
  ds_read_b128 v[176:179], v15 offset:57344
  v_mfma_f32_16x16x32_bf16 v[68:71], a[88:91], v[160:163], v[68:71]
  v_mfma_f32_16x16x32_bf16 v[72:75], a[92:95], v[160:163], v[72:75]
  s_waitcnt lgkmcnt(3)
  v_mfma_f32_16x16x32_bf16 v[76:79], a[84:87], v[164:167], v[76:79]
  ds_read_b128 v[180:183], v15 offset:59392
  v_mfma_f32_16x16x32_bf16 v[80:83], a[88:91], v[164:167], v[80:83]
  v_mfma_f32_16x16x32_bf16 v[84:87], a[92:95], v[164:167], v[84:87]
  s_waitcnt lgkmcnt(3)
  v_mfma_f32_16x16x32_bf16 v[88:91], a[84:87], v[168:171], v[88:91]
  ds_read_b128 v[184:187], v15 offset:61440
  v_mfma_f32_16x16x32_bf16 v[92:95], a[88:91], v[168:171], v[92:95]
  v_mfma_f32_16x16x32_bf16 v[96:99], a[92:95], v[168:171], v[96:99]
  s_waitcnt lgkmcnt(3)
  v_mfma_f32_16x16x32_bf16 v[100:103], a[84:87], v[172:175], v[100:103]
  ds_read_b128 v[188:191], v15 offset:63488
  v_mfma_f32_16x16x32_bf16 v[104:107], a[88:91], v[172:175], v[104:107]
  v_mfma_f32_16x16x32_bf16 v[108:111], a[92:95], v[172:175], v[108:111]
  s_waitcnt lgkmcnt(3)
  v_mfma_f32_16x16x32_bf16 v[112:115], a[84:87], v[176:179], v[112:115]
  s_waitcnt vmcnt(12)
  s_barrier
  ds_read_b128 v[160:163], v16 offset:0
  v_mfma_f32_16x16x32_bf16 v[116:119], a[88:91], v[176:179], v[116:119]
  v_mfma_f32_16x16x32_bf16 v[120:123], a[92:95], v[176:179], v[120:123]
  s_waitcnt lgkmcnt(3)
  v_mfma_f32_16x16x32_bf16 v[124:127], a[84:87], v[180:183], v[124:127]
  ds_read_b128 v[164:167], v16 offset:2048
  v_mfma_f32_16x16x32_bf16 v[128:131], a[88:91], v[180:183], v[128:131]
  v_mfma_f32_16x16x32_bf16 v[132:135], a[92:95], v[180:183], v[132:135]
  s_waitcnt lgkmcnt(3)
  v_mfma_f32_16x16x32_bf16 v[136:139], a[84:87], v[184:187], v[136:139]
  ds_read_b128 v[168:171], v16 offset:4096
  v_mfma_f32_16x16x32_bf16 v[140:143], a[88:91], v[184:187], v[140:143]
  v_mfma_f32_16x16x32_bf16 v[144:147], a[92:95], v[184:187], v[144:147]
  s_waitcnt lgkmcnt(3)
  v_mfma_f32_16x16x32_bf16 v[148:151], a[84:87], v[188:191], v[148:151]
  ds_read_b128 v[172:175], v16 offset:6144
  s_waitcnt vmcnt(8)
  v_mfma_f32_16x16x32_bf16 v[152:155], a[88:91], v[188:191], v[152:155]
  v_swap_b32 v226, v228
  v_swap_b32 v227, v229
  v_mfma_f32_16x16x32_bf16 v[156:159], a[92:95], v[188:191], v[156:159]
  s_waitcnt lgkmcnt(3)
  v_swap_b32 v234, v236
  v_swap_b32 v235, v237
  v_mfma_f32_16x16x32_bf16 v[64:67], a[96:99], v[160:163], v[64:67]
  ds_read_b128 v[176:179], v16 offset:8192
  v_mfma_f32_16x16x32_bf16 v[68:71], a[100:103], v[160:163], v[68:71]
  s_add_u32 m0, s31, 32768
  ds_read_b128 v[56:59], v21 offset:0
  ds_read_b128 v[60:63], v21 offset:1024
  v_mfma_f32_16x16x32_bf16 v[72:75], a[104:107], v[160:163], v[72:75]
  s_waitcnt lgkmcnt(5)
  buffer_load_dwordx4 v10, s[8:11], s30 offen lds
  v_mfma_f32_16x16x32_bf16 v[76:79], a[96:99], v[164:167], v[76:79]
  ds_read_b128 v[180:183], v16 offset:10240
  v_mfma_f32_16x16x32_bf16 v[80:83], a[100:103], v[164:167], v[80:83]
  v_mfma_f32_16x16x32_bf16 v[84:87], a[104:107], v[164:167], v[84:87]
  s_waitcnt lgkmcnt(5)
  v_mfma_f32_16x16x32_bf16 v[88:91], a[96:99], v[168:171], v[88:91]
  ds_read_b128 v[184:187], v16 offset:12288
  v_mfma_f32_16x16x32_bf16 v[92:95], a[100:103], v[168:171], v[92:95]
  s_add_u32 m0, s31, 33792
  ds_read_b128 v[248:251], v21 offset:3072
  ds_read_b128 v[252:255], v21 offset:4096
  v_mfma_f32_16x16x32_bf16 v[96:99], a[104:107], v[168:171], v[96:99]
  s_waitcnt lgkmcnt(4)
  buffer_load_dwordx4 v11, s[8:11], s30 offen lds
  v_mfma_f32_16x16x32_bf16 v[36:39], v[192:195], v[56:59], 0
  v_mfma_f32_16x16x32_bf16 v[44:47], v[192:195], v[60:63], 0
  v_mfma_f32_16x16x32_bf16 v[48:51], v[196:199], v[60:63], 0
  v_mfma_f32_16x16x32_bf16 v[40:43], a[240:243], v[56:59], 0
  v_mfma_f32_16x16x32_bf16 v[52:55], a[240:243], v[60:63], 0
  s_waitcnt lgkmcnt(7)
  ds_read2st64_b64 v[56:59], v22 offset0:0 offset1:6
  ds_read2st64_b64 v[60:63], v23 offset0:0 offset1:6
  v_mfma_f32_16x16x32_bf16 v[100:103], a[96:99], v[172:175], v[100:103]
  ds_read_b128 v[188:191], v16 offset:14336
  v_mfma_f32_16x16x32_bf16 v[104:107], a[100:103], v[172:175], v[104:107]
  v_mfma_f32_16x16x32_bf16 v[108:111], a[104:107], v[172:175], v[108:111]
  s_waitcnt lgkmcnt(9)
  v_mfma_f32_16x16x32_bf16 v[112:115], a[96:99], v[176:179], v[112:115]
  ds_read_b128 v[160:163], v17 offset:0
  v_mfma_f32_16x16x32_bf16 v[116:119], a[100:103], v[176:179], v[116:119]
  s_add_u32 m0, s31, 34816
  v_mfma_f32_16x16x32_bf16 v[120:123], a[104:107], v[176:179], v[120:123]
  s_waitcnt lgkmcnt(4)
  buffer_load_dwordx4 v12, s[8:11], s30 offen lds
  v_mfma_f32_16x16x32_bf16 v[36:39], v[200:203], v[248:251], v[36:39]
  v_mfma_f32_16x16x32_bf16 v[44:47], v[200:203], v[252:255], v[44:47]
  v_mfma_f32_16x16x32_bf16 v[48:51], v[204:207], v[252:255], v[48:51]
  v_mfma_f32_16x16x32_bf16 v[40:43], a[244:247], v[248:251], v[40:43]
  v_mfma_f32_16x16x32_bf16 v[52:55], a[244:247], v[252:255], v[52:55]
  s_waitcnt lgkmcnt(7)
  ds_read_b128 v[248:251], v21 offset:6144
  ds_read_b128 v[252:255], v21 offset:7168
  v_mfma_f32_16x16x32_bf16 v[124:127], a[96:99], v[180:183], v[124:127]
  ds_read_b128 v[164:167], v17 offset:2048
  v_mfma_f32_16x16x32_bf16 v[128:131], a[100:103], v[180:183], v[128:131]
  v_mfma_f32_16x16x32_bf16 v[132:135], a[104:107], v[180:183], v[132:135]
  s_waitcnt lgkmcnt(9)
  v_mfma_f32_16x16x32_bf16 v[136:139], a[96:99], v[184:187], v[136:139]
  ds_read_b128 v[168:171], v17 offset:4096
  v_mfma_f32_16x16x32_bf16 v[140:143], a[100:103], v[184:187], v[140:143]
  s_add_u32 m0, s31, 35840
  v_mfma_f32_16x16x32_bf16 v[144:147], a[104:107], v[184:187], v[144:147]
  s_waitcnt lgkmcnt(6)
  buffer_load_dwordx4 v13, s[8:11], s30 offen lds
  v_mfma_f32_16x16x32_bf16 v[36:39], v[224:227], v[56:59], v[36:39]
  s_add_u32 s30, s30, 128
  v_mfma_f32_16x16x32_bf16 v[44:47], v[224:227], v[60:63], v[44:47]
  v_mfma_f32_16x16x32_bf16 v[48:51], v[228:231], v[60:63], v[48:51]
  v_mfma_f32_16x16x32_bf16 v[40:43], v[240:243], v[56:59], v[40:43]
  v_mfma_f32_16x16x32_bf16 v[52:55], v[240:243], v[60:63], v[52:55]
  s_waitcnt lgkmcnt(5)
  ds_read_b128 v[56:59], v21 offset:9216
  ds_read_b128 v[60:63], v21 offset:10240
  v_mfma_f32_16x16x32_bf16 v[148:151], a[96:99], v[188:191], v[148:151]
  ds_read_b128 v[172:175], v17 offset:6144
  v_mfma_f32_16x16x32_bf16 v[152:155], a[100:103], v[188:191], v[152:155]
  v_mfma_f32_16x16x32_bf16 v[156:159], a[104:107], v[188:191], v[156:159]
  s_waitcnt lgkmcnt(7)
  v_mfma_f32_16x16x32_bf16 v[64:67], a[108:111], v[160:163], v[64:67]
  ds_read_b128 v[176:179], v17 offset:8192
  v_mfma_f32_16x16x32_bf16 v[68:71], a[112:115], v[160:163], v[68:71]
  v_mfma_f32_16x16x32_bf16 v[72:75], a[116:119], v[160:163], v[72:75]
  s_waitcnt lgkmcnt(6)
  v_mfma_f32_16x16x32_bf16 v[36:39], v[208:211], v[248:251], v[36:39]
  v_mfma_f32_16x16x32_bf16 v[44:47], v[208:211], v[252:255], v[44:47]
  v_mfma_f32_16x16x32_bf16 v[48:51], v[212:215], v[252:255], v[48:51]
  v_mfma_f32_16x16x32_bf16 v[40:43], a[248:251], v[248:251], v[40:43]
  v_mfma_f32_16x16x32_bf16 v[52:55], a[248:251], v[252:255], v[52:55]
  s_waitcnt lgkmcnt(5)
  ds_read2st64_b64 v[248:251], v22 offset0:12 offset1:18
  ds_read2st64_b64 v[252:255], v23 offset0:12 offset1:18
  v_mfma_f32_16x16x32_bf16 v[76:79], a[108:111], v[164:167], v[76:79]
  ds_read_b128 v[180:183], v17 offset:10240
  v_mfma_f32_16x16x32_bf16 v[80:83], a[112:115], v[164:167], v[80:83]
  v_mfma_f32_16x16x32_bf16 v[84:87], a[116:119], v[164:167], v[84:87]
  s_waitcnt lgkmcnt(7)
  v_mfma_f32_16x16x32_bf16 v[88:91], a[108:111], v[168:171], v[88:91]
  ds_read_b128 v[184:187], v17 offset:12288
  v_mfma_f32_16x16x32_bf16 v[92:95], a[112:115], v[168:171], v[92:95]
  v_mfma_f32_16x16x32_bf16 v[96:99], a[116:119], v[168:171], v[96:99]
  s_waitcnt lgkmcnt(6)
  v_mfma_f32_16x16x32_bf16 v[36:39], v[216:219], v[56:59], v[36:39]
  v_mfma_f32_16x16x32_bf16 v[44:47], v[216:219], v[60:63], v[44:47]
  v_mfma_f32_16x16x32_bf16 v[48:51], v[220:223], v[60:63], v[48:51]
  v_mfma_f32_16x16x32_bf16 v[40:43], a[252:255], v[56:59], v[40:43]
  v_mfma_f32_16x16x32_bf16 v[52:55], a[252:255], v[60:63], v[52:55]
  s_waitcnt lgkmcnt(5)
  v_mfma_f32_16x16x32_bf16 v[100:103], a[108:111], v[172:175], v[100:103]
  ds_read_b128 v[188:191], v17 offset:14336
  v_mfma_f32_16x16x32_bf16 v[104:107], a[112:115], v[172:175], v[104:107]
  v_mfma_f32_16x16x32_bf16 v[108:111], a[116:119], v[172:175], v[108:111]
  s_waitcnt lgkmcnt(5)
  v_mfma_f32_16x16x32_bf16 v[112:115], a[108:111], v[176:179], v[112:115]
  s_waitcnt vmcnt(8)
  s_barrier
  ds_read_b128 v[160:163], v14 offset:0
  v_mfma_f32_16x16x32_bf16 v[116:119], a[112:115], v[176:179], v[116:119]
  v_mfma_f32_16x16x32_bf16 v[120:123], a[116:119], v[176:179], v[120:123]
  s_waitcnt lgkmcnt(4)
  v_mfma_f32_16x16x32_bf16 v[36:39], v[232:235], v[248:251], v[36:39]
  v_mfma_f32_16x16x32_bf16 v[44:47], v[232:235], v[252:255], v[44:47]
  v_mfma_f32_16x16x32_bf16 v[48:51], v[236:239], v[252:255], v[48:51]
  v_mfma_f32_16x16x32_bf16 v[40:43], v[244:247], v[248:251], v[40:43]
  v_mfma_f32_16x16x32_bf16 v[52:55], v[244:247], v[252:255], v[52:55]
  s_waitcnt lgkmcnt(3)
  v_mfma_f32_16x16x32_bf16 v[124:127], a[108:111], v[180:183], v[124:127]
  ds_read_b128 v[164:167], v14 offset:2048
  v_mfma_f32_16x16x32_bf16 v[128:131], a[112:115], v[180:183], v[128:131]
  v_mfma_f32_16x16x32_bf16 v[132:135], a[116:119], v[180:183], v[132:135]
  s_waitcnt lgkmcnt(3)
  v_cndmask_b32 v36, v31, v36, s[64:65]
  v_cndmask_b32 v48, v31, v48, s[64:65]
  v_mfma_f32_16x16x32_bf16 v[136:139], a[108:111], v[184:187], v[136:139]
  ds_read_b128 v[168:171], v14 offset:4096
  v_cndmask_b32 v37, v31, v37, s[66:67]
  v_mfma_f32_16x16x32_bf16 v[140:143], a[112:115], v[184:187], v[140:143]
  v_cndmask_b32 v49, v31, v49, s[66:67]
  v_cndmask_b32 v38, v31, v38, s[68:69]
  v_mfma_f32_16x16x32_bf16 v[144:147], a[116:119], v[184:187], v[144:147]
  s_waitcnt lgkmcnt(3)
  v_cndmask_b32 v50, v31, v50, s[68:69]
  v_cndmask_b32 v39, v31, v39, s[70:71]
  v_mfma_f32_16x16x32_bf16 v[148:151], a[108:111], v[188:191], v[148:151]
  ds_read_b128 v[172:175], v14 offset:6144
  v_cndmask_b32 v51, v31, v51, s[70:71]
  v_mfma_f32_16x16x32_bf16 v[152:155], a[112:115], v[188:191], v[152:155]
  v_max3_f32 v34, v36, v37, v38
  v_max3_f32 v34, v34, v39, v40
  v_mfma_f32_16x16x32_bf16 v[156:159], a[116:119], v[188:191], v[156:159]
  s_waitcnt lgkmcnt(3)
  v_max3_f32 v34, v34, v41, v42
  v_max_f32 v34, v34, v43
  v_mfma_f32_16x16x32_bf16 v[64:67], a[120:123], v[160:163], v[64:67]
  ds_read_b128 v[176:179], v14 offset:8192
  v_mov_b32 v35, v34
  v_mfma_f32_16x16x32_bf16 v[68:71], a[124:127], v[160:163], v[68:71]
  s_add_u32 m0, s31, 49152
  v_permlane32_swap_b32 v34, v35
  v_max_f32 v34, v34, v35
  v_mfma_f32_16x16x32_bf16 v[72:75], a[128:131], v[160:163], v[72:75]
  s_waitcnt lgkmcnt(3)
  buffer_load_dwordx4 v10, s[8:11], s30 offen lds
  v_mov_b32 v35, v34
  v_mfma_f32_16x16x32_bf16 v[76:79], a[120:123], v[164:167], v[76:79]
  ds_read_b128 v[180:183], v14 offset:10240
  v_permlane16_swap_b32 v34, v35
  v_mfma_f32_16x16x32_bf16 v[80:83], a[124:127], v[164:167], v[80:83]
  v_max_f32 v34, v34, v35
  v_mul_f32 v34, s83, v34
  v_mfma_f32_16x16x32_bf16 v[84:87], a[128:131], v[164:167], v[84:87]
  s_waitcnt lgkmcnt(3)
  v_fma_f32 v36, v36, s83, -v34
  v_fma_f32 v37, v37, s83, -v34
  v_mfma_f32_16x16x32_bf16 v[88:91], a[120:123], v[168:171], v[88:91]
  ds_read_b128 v[184:187], v14 offset:12288
  v_fma_f32 v38, v38, s83, -v34
  v_mfma_f32_16x16x32_bf16 v[92:95], a[124:127], v[168:171], v[92:95]
  s_add_u32 m0, s31, 50176
  v_fma_f32 v39, v39, s83, -v34
  v_fma_f32 v40, v40, s83, -v34
  v_mfma_f32_16x16x32_bf16 v[96:99], a[128:131], v[168:171], v[96:99]
  s_waitcnt lgkmcnt(3)
  buffer_load_dwordx4 v11, s[8:11], s30 offen lds
  v_fma_f32 v41, v41, s83, -v34
  v_mfma_f32_16x16x32_bf16 v[100:103], a[120:123], v[172:175], v[100:103]
  ds_read_b128 v[188:191], v14 offset:14336
  v_fma_f32 v42, v42, s83, -v34
  v_mfma_f32_16x16x32_bf16 v[104:107], a[124:127], v[172:175], v[104:107]
  v_fma_f32 v43, v43, s83, -v34
  v_mfma_f32_16x16x32_bf16 v[108:111], a[128:131], v[172:175], v[108:111]
  s_waitcnt lgkmcnt(3)
  v_exp_f32 v36, v36
  v_mfma_f32_16x16x32_bf16 v[112:115], a[120:123], v[176:179], v[112:115]
  ds_read_b128 v[160:163], v15 offset:0
  v_mfma_f32_16x16x32_bf16 v[116:119], a[124:127], v[176:179], v[116:119]
  s_add_u32 m0, s31, 51200
  v_exp_f32 v37, v37
  v_mfma_f32_16x16x32_bf16 v[120:123], a[128:131], v[176:179], v[120:123]
  s_waitcnt lgkmcnt(3)
  buffer_load_dwordx4 v12, s[8:11], s30 offen lds
  v_mfma_f32_16x16x32_bf16 v[124:127], a[120:123], v[180:183], v[124:127]
  ds_read_b128 v[164:167], v15 offset:2048
  v_mfma_f32_16x16x32_bf16 v[128:131], a[124:127], v[180:183], v[128:131]
  v_exp_f32 v38, v38
  v_mfma_f32_16x16x32_bf16 v[132:135], a[128:131], v[180:183], v[132:135]
  s_waitcnt lgkmcnt(3)
  v_exp_f32 v39, v39
  v_mfma_f32_16x16x32_bf16 v[136:139], a[120:123], v[184:187], v[136:139]
  ds_read_b128 v[168:171], v15 offset:4096
  v_mfma_f32_16x16x32_bf16 v[140:143], a[124:127], v[184:187], v[140:143]
  s_add_u32 m0, s31, 52224
  v_exp_f32 v40, v40
  v_mfma_f32_16x16x32_bf16 v[144:147], a[128:131], v[184:187], v[144:147]
  s_waitcnt lgkmcnt(3)
  buffer_load_dwordx4 v13, s[8:11], s30 offen lds
  v_mfma_f32_16x16x32_bf16 v[148:151], a[120:123], v[188:191], v[148:151]
  s_add_u32 s30, s30, 128
  ds_read_b128 v[172:175], v15 offset:6144
  v_mfma_f32_16x16x32_bf16 v[152:155], a[124:127], v[188:191], v[152:155]
  v_exp_f32 v41, v41
  v_mfma_f32_16x16x32_bf16 v[156:159], a[128:131], v[188:191], v[156:159]
  s_waitcnt lgkmcnt(3)
  v_exp_f32 v42, v42
  v_mfma_f32_16x16x32_bf16 v[64:67], a[132:135], v[160:163], v[64:67]
  ds_read_b128 v[176:179], v15 offset:8192
  v_mfma_f32_16x16x32_bf16 v[68:71], a[136:139], v[160:163], v[68:71]
  v_exp_f32 v43, v43
  v_mfma_f32_16x16x32_bf16 v[72:75], a[140:143], v[160:163], v[72:75]
  s_waitcnt lgkmcnt(3)
  v_add_f32 v34, v40, v41
  v_add_f32 v34, v34, v42
  v_mfma_f32_16x16x32_bf16 v[76:79], a[132:135], v[164:167], v[76:79]
  ds_read_b128 v[180:183], v15 offset:10240
  v_add_f32 v34, v34, v43
  v_mfma_f32_16x16x32_bf16 v[80:83], a[136:139], v[164:167], v[80:83]
  v_cndmask_b32 v34, 0, v34, s[62:63]
  v_add_f32 v34, v34, v36
  v_mfma_f32_16x16x32_bf16 v[84:87], a[140:143], v[164:167], v[84:87]
  s_waitcnt lgkmcnt(3)
  v_add_f32 v34, v34, v37
  v_add_f32 v34, v34, v38
  v_mfma_f32_16x16x32_bf16 v[88:91], a[132:135], v[168:171], v[88:91]
  ds_read_b128 v[184:187], v15 offset:12288
  v_add_f32 v34, v34, v39
  v_mfma_f32_16x16x32_bf16 v[92:95], a[136:139], v[168:171], v[92:95]
  v_mov_b32 v35, v34
  v_mfma_f32_16x16x32_bf16 v[96:99], a[140:143], v[168:171], v[96:99]
  s_waitcnt lgkmcnt(3)
  v_permlane32_swap_b32 v34, v35
  v_add_f32 v34, v34, v35
  v_mfma_f32_16x16x32_bf16 v[100:103], a[132:135], v[172:175], v[100:103]
  ds_read_b128 v[188:191], v15 offset:14336
  v_mov_b32 v35, v34
  v_mfma_f32_16x16x32_bf16 v[104:107], a[136:139], v[172:175], v[104:107]
  v_permlane16_swap_b32 v34, v35
  v_add_f32 v34, v34, v35
  v_mfma_f32_16x16x32_bf16 v[108:111], a[140:143], v[172:175], v[108:111]
  s_waitcnt lgkmcnt(3)
  v_rcp_f32 v34, v34
  v_mfma_f32_16x16x32_bf16 v[112:115], a[132:135], v[176:179], v[112:115]
  s_waitcnt vmcnt(8)
  s_barrier
  ds_read_b128 v[160:163], v14 offset:16384
  v_mfma_f32_16x16x32_bf16 v[116:119], a[136:139], v[176:179], v[116:119]
  v_mul_f32 v36, v36, v34
  v_mul_f32 v37, v37, v34
  v_mfma_f32_16x16x32_bf16 v[120:123], a[140:143], v[176:179], v[120:123]
  s_waitcnt lgkmcnt(3)
  v_mul_f32 v38, v38, v34
  v_mul_f32 v39, v39, v34
  v_mfma_f32_16x16x32_bf16 v[124:127], a[132:135], v[180:183], v[124:127]
  ds_read_b128 v[164:167], v14 offset:18432
  v_mul_f32 v40, v40, v34
  v_mfma_f32_16x16x32_bf16 v[128:131], a[136:139], v[180:183], v[128:131]
  v_mul_f32 v41, v41, v34
  v_mul_f32 v42, v42, v34
  v_mfma_f32_16x16x32_bf16 v[132:135], a[140:143], v[180:183], v[132:135]
  s_waitcnt lgkmcnt(3)
  v_mul_f32 v43, v43, v34
  v_max3_f32 v34, v44, v45, v46
  v_mfma_f32_16x16x32_bf16 v[136:139], a[132:135], v[184:187], v[136:139]
  ds_read_b128 v[168:171], v14 offset:20480
  v_max3_f32 v34, v34, v47, v48
  v_mfma_f32_16x16x32_bf16 v[140:143], a[136:139], v[184:187], v[140:143]
  v_max3_f32 v34, v34, v49, v50
  v_max3_f32 v34, v34, v51, v52
  v_mfma_f32_16x16x32_bf16 v[144:147], a[140:143], v[184:187], v[144:147]
  s_waitcnt lgkmcnt(3)
  v_max3_f32 v34, v34, v53, v54
  v_max_f32 v34, v34, v55
  v_mfma_f32_16x16x32_bf16 v[148:151], a[132:135], v[188:191], v[148:151]
  ds_read_b128 v[172:175], v14 offset:22528
  v_mov_b32 v35, v34
  v_mfma_f32_16x16x32_bf16 v[152:155], a[136:139], v[188:191], v[152:155]
  v_permlane32_swap_b32 v34, v35
  v_max_f32 v34, v34, v35
  v_mfma_f32_16x16x32_bf16 v[156:159], a[140:143], v[188:191], v[156:159]
  s_waitcnt lgkmcnt(3)
  v_mov_b32 v35, v34
  v_mfma_f32_16x16x32_bf16 v[64:67], a[144:147], v[160:163], v[64:67]
  ds_read_b128 v[176:179], v14 offset:24576
  v_permlane16_swap_b32 v34, v35
  v_mfma_f32_16x16x32_bf16 v[68:71], a[148:151], v[160:163], v[68:71]
  s_add_u32 m0, s31, 65536
  v_max_f32 v34, v34, v35
  v_mul_f32 v34, s83, v34
  v_mfma_f32_16x16x32_bf16 v[72:75], a[152:155], v[160:163], v[72:75]
  s_waitcnt lgkmcnt(3)
  buffer_load_dwordx4 v10, s[8:11], s30 offen lds
  v_fma_f32 v44, v44, s83, -v34
  v_mfma_f32_16x16x32_bf16 v[76:79], a[144:147], v[164:167], v[76:79]
  ds_read_b128 v[180:183], v14 offset:26624
  v_fma_f32 v45, v45, s83, -v34
  v_mfma_f32_16x16x32_bf16 v[80:83], a[148:151], v[164:167], v[80:83]
  v_fma_f32 v46, v46, s83, -v34
  v_fma_f32 v47, v47, s83, -v34
  v_mfma_f32_16x16x32_bf16 v[84:87], a[152:155], v[164:167], v[84:87]
  s_waitcnt lgkmcnt(3)
  v_fma_f32 v48, v48, s83, -v34
  v_fma_f32 v49, v49, s83, -v34
  v_mfma_f32_16x16x32_bf16 v[88:91], a[144:147], v[168:171], v[88:91]
  ds_read_b128 v[184:187], v14 offset:28672
  v_fma_f32 v50, v50, s83, -v34
  v_mfma_f32_16x16x32_bf16 v[92:95], a[148:151], v[168:171], v[92:95]
  s_add_u32 m0, s31, 66560
  v_fma_f32 v51, v51, s83, -v34
  v_fma_f32 v52, v52, s83, -v34
  v_mfma_f32_16x16x32_bf16 v[96:99], a[152:155], v[168:171], v[96:99]
  s_waitcnt lgkmcnt(3)
  buffer_load_dwordx4 v11, s[8:11], s30 offen lds
  v_fma_f32 v53, v53, s83, -v34
  v_mfma_f32_16x16x32_bf16 v[100:103], a[144:147], v[172:175], v[100:103]
  ds_read_b128 v[188:191], v14 offset:30720
  v_fma_f32 v54, v54, s83, -v34
  v_mfma_f32_16x16x32_bf16 v[104:107], a[148:151], v[172:175], v[104:107]
  v_fma_f32 v55, v55, s83, -v34
  v_mfma_f32_16x16x32_bf16 v[108:111], a[152:155], v[172:175], v[108:111]
  s_waitcnt lgkmcnt(3)
  v_exp_f32 v44, v44
  v_mfma_f32_16x16x32_bf16 v[112:115], a[144:147], v[176:179], v[112:115]
  ds_read_b128 v[160:163], v15 offset:16384
  v_mfma_f32_16x16x32_bf16 v[116:119], a[148:151], v[176:179], v[116:119]
  s_add_u32 m0, s31, 67584
  v_exp_f32 v45, v45
  v_mfma_f32_16x16x32_bf16 v[120:123], a[152:155], v[176:179], v[120:123]
  s_waitcnt lgkmcnt(3)
  buffer_load_dwordx4 v12, s[8:11], s30 offen lds
  v_mfma_f32_16x16x32_bf16 v[124:127], a[144:147], v[180:183], v[124:127]
  ds_read_b128 v[164:167], v15 offset:18432
  v_mfma_f32_16x16x32_bf16 v[128:131], a[148:151], v[180:183], v[128:131]
  v_exp_f32 v46, v46
  v_mfma_f32_16x16x32_bf16 v[132:135], a[152:155], v[180:183], v[132:135]
  s_waitcnt lgkmcnt(3)
  v_exp_f32 v47, v47
  v_mfma_f32_16x16x32_bf16 v[136:139], a[144:147], v[184:187], v[136:139]
  ds_read_b128 v[168:171], v15 offset:20480
  v_mfma_f32_16x16x32_bf16 v[140:143], a[148:151], v[184:187], v[140:143]
  s_add_u32 m0, s31, 68608
  v_exp_f32 v48, v48
  v_mfma_f32_16x16x32_bf16 v[144:147], a[152:155], v[184:187], v[144:147]
  s_waitcnt lgkmcnt(3)
  buffer_load_dwordx4 v13, s[8:11], s30 offen lds
  v_mfma_f32_16x16x32_bf16 v[148:151], a[144:147], v[188:191], v[148:151]
  s_add_u32 s30, s30, s25
  ds_read_b128 v[172:175], v15 offset:22528
  v_mfma_f32_16x16x32_bf16 v[152:155], a[148:151], v[188:191], v[152:155]
  v_exp_f32 v49, v49
  v_mfma_f32_16x16x32_bf16 v[156:159], a[152:155], v[188:191], v[156:159]
  s_waitcnt lgkmcnt(3)
  v_exp_f32 v50, v50
  v_mfma_f32_16x16x32_bf16 v[64:67], a[156:159], v[160:163], v[64:67]
  ds_read_b128 v[176:179], v15 offset:24576
  v_mfma_f32_16x16x32_bf16 v[68:71], a[160:163], v[160:163], v[68:71]
  v_exp_f32 v51, v51
  v_mfma_f32_16x16x32_bf16 v[72:75], a[164:167], v[160:163], v[72:75]
  s_waitcnt lgkmcnt(3)
  v_exp_f32 v52, v52
  v_mfma_f32_16x16x32_bf16 v[76:79], a[156:159], v[164:167], v[76:79]
  ds_read_b128 v[180:183], v15 offset:26624
  v_mfma_f32_16x16x32_bf16 v[80:83], a[160:163], v[164:167], v[80:83]
  v_exp_f32 v53, v53
  v_mfma_f32_16x16x32_bf16 v[84:87], a[164:167], v[164:167], v[84:87]
  s_waitcnt lgkmcnt(3)
  v_exp_f32 v54, v54
  v_mfma_f32_16x16x32_bf16 v[88:91], a[156:159], v[168:171], v[88:91]
  ds_read_b128 v[184:187], v15 offset:28672
  v_mfma_f32_16x16x32_bf16 v[92:95], a[160:163], v[168:171], v[92:95]
  v_exp_f32 v55, v55
  v_mfma_f32_16x16x32_bf16 v[96:99], a[164:167], v[168:171], v[96:99]
  s_waitcnt lgkmcnt(3)
  v_add_f32 v34, v52, v53
  v_add_f32 v34, v34, v54
  v_mfma_f32_16x16x32_bf16 v[100:103], a[156:159], v[172:175], v[100:103]
  ds_read_b128 v[188:191], v15 offset:30720
  v_add_f32 v34, v34, v55
  v_mfma_f32_16x16x32_bf16 v[104:107], a[160:163], v[172:175], v[104:107]
  v_cndmask_b32 v34, 0, v34, s[62:63]
  v_add_f32 v34, v34, v44
  v_mfma_f32_16x16x32_bf16 v[108:111], a[164:167], v[172:175], v[108:111]
  s_waitcnt lgkmcnt(3)
  v_add_f32 v34, v34, v45
  v_add_f32 v34, v34, v46
  v_mfma_f32_16x16x32_bf16 v[112:115], a[156:159], v[176:179], v[112:115]
  s_waitcnt vmcnt(8)
  s_barrier
  ds_read_b128 v[160:163], v14 offset:32768
  v_mfma_f32_16x16x32_bf16 v[116:119], a[160:163], v[176:179], v[116:119]
  v_add_f32 v34, v34, v47
  v_add_f32 v34, v34, v48
  v_mfma_f32_16x16x32_bf16 v[120:123], a[164:167], v[176:179], v[120:123]
  s_waitcnt lgkmcnt(3)
  v_add_f32 v34, v34, v49
  v_add_f32 v34, v34, v50
  v_mfma_f32_16x16x32_bf16 v[124:127], a[156:159], v[180:183], v[124:127]
  ds_read_b128 v[164:167], v14 offset:34816
  v_add_f32 v34, v34, v51
  v_mfma_f32_16x16x32_bf16 v[128:131], a[160:163], v[180:183], v[128:131]
  v_mov_b32 v35, v34
  v_mfma_f32_16x16x32_bf16 v[132:135], a[164:167], v[180:183], v[132:135]
  s_waitcnt lgkmcnt(3)
  v_permlane32_swap_b32 v34, v35
  v_add_f32 v34, v34, v35
  v_mfma_f32_16x16x32_bf16 v[136:139], a[156:159], v[184:187], v[136:139]
  ds_read_b128 v[168:171], v14 offset:36864
  v_mov_b32 v35, v34
  v_mfma_f32_16x16x32_bf16 v[140:143], a[160:163], v[184:187], v[140:143]
  v_permlane16_swap_b32 v34, v35
  v_add_f32 v34, v34, v35
  v_mfma_f32_16x16x32_bf16 v[144:147], a[164:167], v[184:187], v[144:147]
  s_waitcnt lgkmcnt(3)
  v_rcp_f32 v34, v34
  v_mfma_f32_16x16x32_bf16 v[148:151], a[156:159], v[188:191], v[148:151]
  ds_read_b128 v[172:175], v14 offset:38912
  v_mul_f32 v44, v44, v34
  v_mfma_f32_16x16x32_bf16 v[152:155], a[160:163], v[188:191], v[152:155]
  v_mul_f32 v45, v45, v34
  v_mul_f32 v46, v46, v34
  v_mfma_f32_16x16x32_bf16 v[156:159], a[164:167], v[188:191], v[156:159]
  s_waitcnt lgkmcnt(3)
  v_mul_f32 v47, v47, v34
  v_mul_f32 v48, v48, v34
  v_mfma_f32_16x16x32_bf16 v[64:67], a[168:171], v[160:163], v[64:67]
  ds_read_b128 v[176:179], v14 offset:40960
  v_mul_f32 v49, v49, v34
  v_mfma_f32_16x16x32_bf16 v[68:71], a[172:175], v[160:163], v[68:71]
  s_add_u32 m0, s31, 0
  v_mul_f32 v50, v50, v34
  v_mul_f32 v51, v51, v34
  v_mfma_f32_16x16x32_bf16 v[72:75], a[176:179], v[160:163], v[72:75]
  s_waitcnt lgkmcnt(3)
  buffer_load_dwordx4 v10, s[8:11], s30 offen lds
  v_mul_f32 v52, v52, v34
  v_mfma_f32_16x16x32_bf16 v[76:79], a[168:171], v[164:167], v[76:79]
  ds_read_b128 v[180:183], v14 offset:43008
  v_mul_f32 v53, v53, v34
  v_mfma_f32_16x16x32_bf16 v[80:83], a[172:175], v[164:167], v[80:83]
  v_mul_f32 v54, v54, v34
  v_mul_f32 v55, v55, v34
  v_mfma_f32_16x16x32_bf16 v[84:87], a[176:179], v[164:167], v[84:87]
  s_waitcnt lgkmcnt(3)
  v_cvt_pk_bf16_f32 v56, v44, v45
  v_cvt_pk_bf16_f32 v57, v46, v47
  v_mfma_f32_16x16x32_bf16 v[88:91], a[168:171], v[168:171], v[88:91]
  ds_read_b128 v[184:187], v14 offset:45056
  v_cvt_pk_bf16_f32 v58, v48, v49
  v_mfma_f32_16x16x32_bf16 v[92:95], a[172:175], v[168:171], v[92:95]
  s_add_u32 m0, s31, 1024
  v_cvt_pk_bf16_f32 v59, v50, v51
  v_cvt_pk_bf16_f32 v60, v40, v41
  v_mfma_f32_16x16x32_bf16 v[96:99], a[176:179], v[168:171], v[96:99]
  s_waitcnt lgkmcnt(3)
  buffer_load_dwordx4 v11, s[8:11], s30 offen lds
  v_cvt_pk_bf16_f32 v61, v42, v43
  v_mfma_f32_16x16x32_bf16 v[100:103], a[168:171], v[172:175], v[100:103]
  ds_read_b128 v[188:191], v14 offset:47104
  v_cvt_pk_bf16_f32 v62, v52, v53
  v_mfma_f32_16x16x32_bf16 v[104:107], a[172:175], v[172:175], v[104:107]
  v_cvt_pk_bf16_f32 v63, v54, v55
  v_cvt_pk_bf16_f32 v248, v36, v37
  v_mfma_f32_16x16x32_bf16 v[108:111], a[176:179], v[172:175], v[108:111]
  s_waitcnt lgkmcnt(3)
  v_cvt_pk_bf16_f32 v249, v38, v39
  buffer_store_dwordx4 v[56:59], v26, s[16:19], s81 offen sc1
  v_mfma_f32_16x16x32_bf16 v[112:115], a[168:171], v[176:179], v[112:115]
  ds_read_b128 v[160:163], v15 offset:32768
  buffer_store_dwordx4 v[60:63], v26, s[16:19], s81 offen offset:1024 sc1
  v_mfma_f32_16x16x32_bf16 v[116:119], a[172:175], v[176:179], v[116:119]
  s_add_u32 m0, s31, 2048
  buffer_store_dwordx2 v[248:249], v29, s[16:19], s81 offen offset:2048 sc1
  v_mfma_f32_16x16x32_bf16 v[120:123], a[176:179], v[176:179], v[120:123]
  s_waitcnt lgkmcnt(3)
  buffer_load_dwordx4 v12, s[8:11], s30 offen lds
  v_mfma_f32_16x16x32_bf16 v[124:127], a[168:171], v[180:183], v[124:127]
  ds_read_b128 v[164:167], v15 offset:34816
  v_mfma_f32_16x16x32_bf16 v[128:131], a[172:175], v[180:183], v[128:131]
  v_mfma_f32_16x16x32_bf16 v[132:135], a[176:179], v[180:183], v[132:135]
  s_waitcnt lgkmcnt(3)
  v_mfma_f32_16x16x32_bf16 v[136:139], a[168:171], v[184:187], v[136:139]
  ds_read_b128 v[168:171], v15 offset:36864
  v_mfma_f32_16x16x32_bf16 v[140:143], a[172:175], v[184:187], v[140:143]
  s_add_u32 m0, s31, 3072
  v_mfma_f32_16x16x32_bf16 v[144:147], a[176:179], v[184:187], v[144:147]
  s_waitcnt lgkmcnt(3)
  buffer_load_dwordx4 v13, s[8:11], s30 offen lds
  v_mfma_f32_16x16x32_bf16 v[148:151], a[168:171], v[188:191], v[148:151]
  s_add_u32 s30, s30, 128
  ds_read_b128 v[172:175], v15 offset:38912
  v_mfma_f32_16x16x32_bf16 v[152:155], a[172:175], v[188:191], v[152:155]
  v_mfma_f32_16x16x32_bf16 v[156:159], a[176:179], v[188:191], v[156:159]
  s_waitcnt lgkmcnt(3)
  v_mfma_f32_16x16x32_bf16 v[64:67], a[180:183], v[160:163], v[64:67]
  ds_read_b128 v[176:179], v15 offset:40960
  v_mfma_f32_16x16x32_bf16 v[68:71], a[184:187], v[160:163], v[68:71]
  v_mfma_f32_16x16x32_bf16 v[72:75], a[188:191], v[160:163], v[72:75]
  s_waitcnt lgkmcnt(3)
  v_mfma_f32_16x16x32_bf16 v[76:79], a[180:183], v[164:167], v[76:79]
  ds_read_b128 v[180:183], v15 offset:43008
  v_mfma_f32_16x16x32_bf16 v[80:83], a[184:187], v[164:167], v[80:83]
  v_mfma_f32_16x16x32_bf16 v[84:87], a[188:191], v[164:167], v[84:87]
  s_waitcnt lgkmcnt(3)
  v_mfma_f32_16x16x32_bf16 v[88:91], a[180:183], v[168:171], v[88:91]
  ds_read_b128 v[184:187], v15 offset:45056
  v_mfma_f32_16x16x32_bf16 v[92:95], a[184:187], v[168:171], v[92:95]
  v_mfma_f32_16x16x32_bf16 v[96:99], a[188:191], v[168:171], v[96:99]
  s_waitcnt lgkmcnt(3)
  v_mfma_f32_16x16x32_bf16 v[100:103], a[180:183], v[172:175], v[100:103]
  ds_read_b128 v[188:191], v15 offset:47104
  v_mfma_f32_16x16x32_bf16 v[104:107], a[184:187], v[172:175], v[104:107]
  v_mfma_f32_16x16x32_bf16 v[108:111], a[188:191], v[172:175], v[108:111]
  s_waitcnt lgkmcnt(3)
  v_mfma_f32_16x16x32_bf16 v[112:115], a[180:183], v[176:179], v[112:115]
  s_waitcnt vmcnt(11)
  s_barrier
  ds_read_b128 v[160:163], v14 offset:49152
  v_mfma_f32_16x16x32_bf16 v[116:119], a[184:187], v[176:179], v[116:119]
  v_mfma_f32_16x16x32_bf16 v[120:123], a[188:191], v[176:179], v[120:123]
  s_waitcnt lgkmcnt(3)
  v_mfma_f32_16x16x32_bf16 v[124:127], a[180:183], v[180:183], v[124:127]
  ds_read_b128 v[164:167], v14 offset:51200
  v_mfma_f32_16x16x32_bf16 v[128:131], a[184:187], v[180:183], v[128:131]
  v_mfma_f32_16x16x32_bf16 v[132:135], a[188:191], v[180:183], v[132:135]
  s_waitcnt lgkmcnt(3)
  v_mfma_f32_16x16x32_bf16 v[136:139], a[180:183], v[184:187], v[136:139]
  ds_read_b128 v[168:171], v14 offset:53248
  v_mfma_f32_16x16x32_bf16 v[140:143], a[184:187], v[184:187], v[140:143]
  v_mfma_f32_16x16x32_bf16 v[144:147], a[188:191], v[184:187], v[144:147]
  s_waitcnt lgkmcnt(3)
  v_mfma_f32_16x16x32_bf16 v[148:151], a[180:183], v[188:191], v[148:151]
  ds_read_b128 v[172:175], v14 offset:55296
  v_mfma_f32_16x16x32_bf16 v[152:155], a[184:187], v[188:191], v[152:155]
  v_mfma_f32_16x16x32_bf16 v[156:159], a[188:191], v[188:191], v[156:159]
  s_waitcnt lgkmcnt(3)
  v_mfma_f32_16x16x32_bf16 v[64:67], a[192:195], v[160:163], v[64:67]
  ds_read_b128 v[176:179], v14 offset:57344
  v_mfma_f32_16x16x32_bf16 v[68:71], a[196:199], v[160:163], v[68:71]
  s_add_u32 m0, s31, 16384
  v_mfma_f32_16x16x32_bf16 v[72:75], a[200:203], v[160:163], v[72:75]
  s_waitcnt lgkmcnt(3)
  buffer_load_dwordx4 v10, s[8:11], s30 offen lds
  v_mfma_f32_16x16x32_bf16 v[76:79], a[192:195], v[164:167], v[76:79]
  ds_read_b128 v[180:183], v14 offset:59392
  v_mfma_f32_16x16x32_bf16 v[80:83], a[196:199], v[164:167], v[80:83]
  v_mfma_f32_16x16x32_bf16 v[84:87], a[200:203], v[164:167], v[84:87]
  s_waitcnt lgkmcnt(3)
  v_mfma_f32_16x16x32_bf16 v[88:91], a[192:195], v[168:171], v[88:91]
  ds_read_b128 v[184:187], v14 offset:61440
  v_mfma_f32_16x16x32_bf16 v[92:95], a[196:199], v[168:171], v[92:95]
  s_add_u32 m0, s31, 17408
  v_mfma_f32_16x16x32_bf16 v[96:99], a[200:203], v[168:171], v[96:99]
  s_waitcnt lgkmcnt(3)
  buffer_load_dwordx4 v11, s[8:11], s30 offen lds
  v_mfma_f32_16x16x32_bf16 v[100:103], a[192:195], v[172:175], v[100:103]
  ds_read_b128 v[188:191], v14 offset:63488
  v_mfma_f32_16x16x32_bf16 v[104:107], a[196:199], v[172:175], v[104:107]
  v_mfma_f32_16x16x32_bf16 v[108:111], a[200:203], v[172:175], v[108:111]
  s_waitcnt lgkmcnt(3)
  v_mfma_f32_16x16x32_bf16 v[112:115], a[192:195], v[176:179], v[112:115]
  ds_read_b128 v[160:163], v15 offset:49152
  v_mfma_f32_16x16x32_bf16 v[116:119], a[196:199], v[176:179], v[116:119]
  s_add_u32 m0, s31, 18432
  v_mfma_f32_16x16x32_bf16 v[120:123], a[200:203], v[176:179], v[120:123]
  s_waitcnt lgkmcnt(3)
  buffer_load_dwordx4 v12, s[8:11], s30 offen lds
  v_mfma_f32_16x16x32_bf16 v[124:127], a[192:195], v[180:183], v[124:127]
  ds_read_b128 v[164:167], v15 offset:51200
  v_mfma_f32_16x16x32_bf16 v[128:131], a[196:199], v[180:183], v[128:131]
  v_mfma_f32_16x16x32_bf16 v[132:135], a[200:203], v[180:183], v[132:135]
  s_waitcnt lgkmcnt(3)
  v_mfma_f32_16x16x32_bf16 v[136:139], a[192:195], v[184:187], v[136:139]
  ds_read_b128 v[168:171], v15 offset:53248
  v_mfma_f32_16x16x32_bf16 v[140:143], a[196:199], v[184:187], v[140:143]
  s_add_u32 m0, s31, 19456
  v_mfma_f32_16x16x32_bf16 v[144:147], a[200:203], v[184:187], v[144:147]
  s_waitcnt lgkmcnt(3)
  buffer_load_dwordx4 v13, s[8:11], s30 offen lds
  v_mfma_f32_16x16x32_bf16 v[148:151], a[192:195], v[188:191], v[148:151]
  s_add_u32 s30, s30, 128
  ds_read_b128 v[172:175], v15 offset:55296
  v_mfma_f32_16x16x32_bf16 v[152:155], a[196:199], v[188:191], v[152:155]
  v_mfma_f32_16x16x32_bf16 v[156:159], a[200:203], v[188:191], v[156:159]
  s_waitcnt lgkmcnt(3)
  v_mfma_f32_16x16x32_bf16 v[64:67], a[204:207], v[160:163], v[64:67]
  ds_read_b128 v[176:179], v15 offset:57344
  v_mfma_f32_16x16x32_bf16 v[68:71], a[208:211], v[160:163], v[68:71]
  v_mfma_f32_16x16x32_bf16 v[72:75], a[212:215], v[160:163], v[72:75]
  s_waitcnt lgkmcnt(3)
  v_mfma_f32_16x16x32_bf16 v[76:79], a[204:207], v[164:167], v[76:79]
  ds_read_b128 v[180:183], v15 offset:59392
  v_mfma_f32_16x16x32_bf16 v[80:83], a[208:211], v[164:167], v[80:83]
  v_mfma_f32_16x16x32_bf16 v[84:87], a[212:215], v[164:167], v[84:87]
  s_waitcnt lgkmcnt(3)
  v_mfma_f32_16x16x32_bf16 v[88:91], a[204:207], v[168:171], v[88:91]
  ds_read_b128 v[184:187], v15 offset:61440
  v_mfma_f32_16x16x32_bf16 v[92:95], a[208:211], v[168:171], v[92:95]
  v_mfma_f32_16x16x32_bf16 v[96:99], a[212:215], v[168:171], v[96:99]
  s_waitcnt lgkmcnt(3)
  v_mfma_f32_16x16x32_bf16 v[100:103], a[204:207], v[172:175], v[100:103]
  ds_read_b128 v[188:191], v15 offset:63488
  v_mfma_f32_16x16x32_bf16 v[104:107], a[208:211], v[172:175], v[104:107]
  v_mfma_f32_16x16x32_bf16 v[108:111], a[212:215], v[172:175], v[108:111]
  s_waitcnt lgkmcnt(3)
  v_mfma_f32_16x16x32_bf16 v[112:115], a[204:207], v[176:179], v[112:115]
  s_waitcnt vmcnt(11)
  s_barrier
  ds_read_b128 v[160:163], v16 offset:0
  v_mfma_f32_16x16x32_bf16 v[116:119], a[208:211], v[176:179], v[116:119]
  v_mfma_f32_16x16x32_bf16 v[120:123], a[212:215], v[176:179], v[120:123]
  s_waitcnt lgkmcnt(3)
  v_mfma_f32_16x16x32_bf16 v[124:127], a[204:207], v[180:183], v[124:127]
  ds_read_b128 v[164:167], v16 offset:2048
  v_mfma_f32_16x16x32_bf16 v[128:131], a[208:211], v[180:183], v[128:131]
  v_mfma_f32_16x16x32_bf16 v[132:135], a[212:215], v[180:183], v[132:135]
  s_waitcnt lgkmcnt(3)
  v_mfma_f32_16x16x32_bf16 v[136:139], a[204:207], v[184:187], v[136:139]
  ds_read_b128 v[168:171], v16 offset:4096
  v_mfma_f32_16x16x32_bf16 v[140:143], a[208:211], v[184:187], v[140:143]
  v_mfma_f32_16x16x32_bf16 v[144:147], a[212:215], v[184:187], v[144:147]
  s_waitcnt lgkmcnt(3)
  v_mfma_f32_16x16x32_bf16 v[148:151], a[204:207], v[188:191], v[148:151]
  ds_read_b128 v[172:175], v16 offset:6144
  v_mfma_f32_16x16x32_bf16 v[152:155], a[208:211], v[188:191], v[152:155]
  v_mfma_f32_16x16x32_bf16 v[156:159], a[212:215], v[188:191], v[156:159]
  s_waitcnt lgkmcnt(3)
  v_mfma_f32_16x16x32_bf16 v[64:67], a[216:219], v[160:163], v[64:67]
  ds_read_b128 v[176:179], v16 offset:8192
  v_mfma_f32_16x16x32_bf16 v[68:71], a[220:223], v[160:163], v[68:71]
  s_add_u32 m0, s31, 32768
  v_mfma_f32_16x16x32_bf16 v[72:75], a[224:227], v[160:163], v[72:75]
  s_waitcnt lgkmcnt(3)
  buffer_load_dwordx4 v10, s[8:11], s30 offen lds
  v_mfma_f32_16x16x32_bf16 v[76:79], a[216:219], v[164:167], v[76:79]
  ds_read_b128 v[180:183], v16 offset:10240
  v_mfma_f32_16x16x32_bf16 v[80:83], a[220:223], v[164:167], v[80:83]
  v_mfma_f32_16x16x32_bf16 v[84:87], a[224:227], v[164:167], v[84:87]
  s_waitcnt lgkmcnt(3)
  v_mfma_f32_16x16x32_bf16 v[88:91], a[216:219], v[168:171], v[88:91]
  ds_read_b128 v[184:187], v16 offset:12288
  buffer_load_dword v32, v30, s[72:75], s77 offen sc1
  v_mfma_f32_16x16x32_bf16 v[92:95], a[220:223], v[168:171], v[92:95]
  s_add_u32 m0, s31, 33792
  s_waitcnt vmcnt(8)
  buffer_atomic_add v28, v33, s[72:75], s82 offen sc1
  v_mfma_f32_16x16x32_bf16 v[96:99], a[224:227], v[168:171], v[96:99]
  s_mov_b32 s49, s43
  s_waitcnt lgkmcnt(3)
  buffer_load_dwordx4 v11, s[8:11], s30 offen lds
  v_mfma_f32_16x16x32_bf16 v[100:103], a[216:219], v[172:175], v[100:103]
  s_add_u32 s43, s43, 4
  ds_read_b128 v[188:191], v16 offset:14336
  s_mov_b32 s50, s45
  v_mfma_f32_16x16x32_bf16 v[104:107], a[220:223], v[172:175], v[104:107]
  s_add_u32 s45, s45, 8388608
  s_mov_b32 s81, s47
  s_add_u32 s47, s47, 2097152
  v_mfma_f32_16x16x32_bf16 v[108:111], a[224:227], v[172:175], v[108:111]
  s_xor_b32 s47, s47, 8192
  s_waitcnt lgkmcnt(3)
  s_mov_b32 s82, s48
  v_mfma_f32_16x16x32_bf16 v[112:115], a[216:219], v[176:179], v[112:115]
  s_add_u32 s48, s48, 4096
  ds_read_b128 v[160:163], v17 offset:0
  v_mfma_f32_16x16x32_bf16 v[116:119], a[220:223], v[176:179], v[116:119]
  s_add_u32 m0, s31, 34816
  v_mfma_f32_16x16x32_bf16 v[120:123], a[224:227], v[176:179], v[120:123]
  s_waitcnt lgkmcnt(3)
  buffer_load_dwordx4 v12, s[8:11], s30 offen lds
  v_mfma_f32_16x16x32_bf16 v[124:127], a[216:219], v[180:183], v[124:127]
  ds_read_b128 v[164:167], v17 offset:2048
  v_mfma_f32_16x16x32_bf16 v[128:131], a[220:223], v[180:183], v[128:131]
  v_mfma_f32_16x16x32_bf16 v[132:135], a[224:227], v[180:183], v[132:135]
  s_waitcnt lgkmcnt(3)
  v_mfma_f32_16x16x32_bf16 v[136:139], a[216:219], v[184:187], v[136:139]
  ds_read_b128 v[168:171], v17 offset:4096
  v_mfma_f32_16x16x32_bf16 v[140:143], a[220:223], v[184:187], v[140:143]
  s_add_u32 m0, s31, 35840
  v_mfma_f32_16x16x32_bf16 v[144:147], a[224:227], v[184:187], v[144:147]
  s_waitcnt lgkmcnt(3)
  buffer_load_dwordx4 v13, s[8:11], s30 offen lds
  v_mfma_f32_16x16x32_bf16 v[148:151], a[216:219], v[188:191], v[148:151]
  s_add_u32 s30, s30, 128
  ds_read_b128 v[172:175], v17 offset:6144
  v_mfma_f32_16x16x32_bf16 v[152:155], a[220:223], v[188:191], v[152:155]
  v_mfma_f32_16x16x32_bf16 v[156:159], a[224:227], v[188:191], v[156:159]
  s_waitcnt lgkmcnt(3)
  v_mfma_f32_16x16x32_bf16 v[64:67], a[228:231], v[160:163], v[64:67]
  ds_read_b128 v[176:179], v17 offset:8192
  v_mfma_f32_16x16x32_bf16 v[68:71], a[232:235], v[160:163], v[68:71]
  v_mfma_f32_16x16x32_bf16 v[72:75], a[236:239], v[160:163], v[72:75]
  s_waitcnt lgkmcnt(3)
  v_mfma_f32_16x16x32_bf16 v[76:79], a[228:231], v[164:167], v[76:79]
  ds_read_b128 v[180:183], v17 offset:10240
  v_cvt_pk_bf16_f32 v192, v64, v65
  v_mfma_f32_16x16x32_bf16 v[80:83], a[232:235], v[164:167], v[80:83]
  v_cvt_pk_bf16_f32 v193, v66, v67
  v_cvt_pk_bf16_f32 v194, v68, v69
  v_mfma_f32_16x16x32_bf16 v[84:87], a[236:239], v[164:167], v[84:87]
  s_waitcnt lgkmcnt(3)
  v_cvt_pk_bf16_f32 v195, v70, v71
  v_cvt_pk_bf16_f32 v200, v72, v73
  v_mfma_f32_16x16x32_bf16 v[88:91], a[228:231], v[168:171], v[88:91]
  ds_read_b128 v[184:187], v17 offset:12288
  v_cvt_pk_bf16_f32 v201, v74, v75
  v_mfma_f32_16x16x32_bf16 v[92:95], a[232:235], v[168:171], v[92:95]
  v_cvt_pk_bf16_f32 v196, v76, v77
  v_cvt_pk_bf16_f32 v197, v78, v79
  v_mfma_f32_16x16x32_bf16 v[96:99], a[236:239], v[168:171], v[96:99]
  s_waitcnt lgkmcnt(3)
  v_cvt_pk_bf16_f32 v198, v80, v81
  v_cvt_pk_bf16_f32 v199, v82, v83
  v_mfma_f32_16x16x32_bf16 v[100:103], a[228:231], v[172:175], v[100:103]
  ds_read_b128 v[188:191], v17 offset:14336
  v_cvt_pk_bf16_f32 v202, v84, v85
  v_mfma_f32_16x16x32_bf16 v[104:107], a[232:235], v[172:175], v[104:107]
  v_cvt_pk_bf16_f32 v203, v86, v87
  v_cvt_pk_bf16_f32 v204, v88, v89
  v_mfma_f32_16x16x32_bf16 v[108:111], a[236:239], v[172:175], v[108:111]
  s_waitcnt lgkmcnt(3)
  v_cvt_pk_bf16_f32 v205, v90, v91
  v_cvt_pk_bf16_f32 v206, v92, v93
  v_mfma_f32_16x16x32_bf16 v[112:115], a[228:231], v[176:179], v[112:115]
  s_waitcnt vmcnt(10)
  s_barrier
  ds_read_b128 v[160:163], v14 offset:0
  v_mfma_f32_16x16x32_bf16 v[116:119], a[232:235], v[176:179], v[116:119]
  v_cvt_pk_bf16_f32 v207, v94, v95
  v_cvt_pk_bf16_f32 v212, v96, v97
  v_mfma_f32_16x16x32_bf16 v[120:123], a[236:239], v[176:179], v[120:123]
  s_waitcnt lgkmcnt(3)
  v_cvt_pk_bf16_f32 v213, v98, v99
  v_cvt_pk_bf16_f32 v208, v100, v101
  v_mfma_f32_16x16x32_bf16 v[124:127], a[228:231], v[180:183], v[124:127]
  ds_read_b128 v[164:167], v14 offset:2048
  v_cvt_pk_bf16_f32 v209, v102, v103
  v_mfma_f32_16x16x32_bf16 v[128:131], a[232:235], v[180:183], v[128:131]
  v_cvt_pk_bf16_f32 v210, v104, v105
  v_cvt_pk_bf16_f32 v211, v106, v107
  v_mfma_f32_16x16x32_bf16 v[132:135], a[236:239], v[180:183], v[132:135]
  s_waitcnt lgkmcnt(3)
  v_cvt_pk_bf16_f32 v214, v108, v109
  v_cvt_pk_bf16_f32 v215, v110, v111
  v_mfma_f32_16x16x32_bf16 v[136:139], a[228:231], v[184:187], v[136:139]
  ds_read_b128 v[168:171], v14 offset:4096
  v_cvt_pk_bf16_f32 v216, v112, v113
  v_mfma_f32_16x16x32_bf16 v[140:143], a[232:235], v[184:187], v[140:143]
  v_cvt_pk_bf16_f32 v217, v114, v115
  v_cvt_pk_bf16_f32 v218, v116, v117
  v_mfma_f32_16x16x32_bf16 v[144:147], a[236:239], v[184:187], v[144:147]
  s_waitcnt lgkmcnt(3)
  v_cvt_pk_bf16_f32 v219, v118, v119
  v_cvt_pk_bf16_f32 v224, v120, v121
  v_mfma_f32_16x16x32_bf16 v[148:151], a[228:231], v[188:191], v[148:151]
  ds_read_b128 v[172:175], v14 offset:6144
  v_cvt_pk_bf16_f32 v225, v122, v123
  v_mfma_f32_16x16x32_bf16 v[152:155], a[232:235], v[188:191], v[152:155]
  s_sub_u32 s26, s26, 1
  s_cmp_gt_u32 s26, 0
  v_cvt_pk_bf16_f32 v220, v124, v125
  v_mfma_f32_16x16x32_bf16 v[156:159], a[236:239], v[188:191], v[156:159]
  s_waitcnt lgkmcnt(3)
  s_cbranch_scc1 qa_212
  s_nop 7
  v_cvt_pk_bf16_f32 v221, v126, v127
  v_cvt_pk_bf16_f32 v222, v128, v129
  v_cvt_pk_bf16_f32 v223, v130, v131
  v_cvt_pk_bf16_f32 v226, v132, v133
  v_cvt_pk_bf16_f32 v227, v134, v135
  v_cvt_pk_bf16_f32 v228, v136, v137
  v_cvt_pk_bf16_f32 v229, v138, v139
  v_cvt_pk_bf16_f32 v230, v140, v141
  v_cvt_pk_bf16_f32 v231, v142, v143
  v_cvt_pk_bf16_f32 v236, v144, v145
  v_cvt_pk_bf16_f32 v237, v146, v147
  v_cvt_pk_bf16_f32 v232, v148, v149
  v_cvt_pk_bf16_f32 v233, v150, v151
  v_cvt_pk_bf16_f32 v234, v152, v153
  v_cvt_pk_bf16_f32 v235, v154, v155
  v_cvt_pk_bf16_f32 v238, v156, v157
  v_cvt_pk_bf16_f32 v239, v158, v159
  ds_write_b128 v20, v[192:195] offset:0
  ds_write_b128 v20, v[196:199] offset:1024
  ds_write_b128 v20, v[200:203] offset:2048
  ds_write_b128 v20, v[204:207] offset:12288
  ds_write_b128 v20, v[208:211] offset:13312
  ds_write_b128 v20, v[212:215] offset:14336
  ds_write_b128 v20, v[216:219] offset:24576
  ds_write_b128 v20, v[220:223] offset:25600
  ds_write_b128 v20, v[224:227] offset:26624
  ds_write_b128 v20, v[228:231] offset:36864
  ds_write_b128 v20, v[232:235] offset:37888
  ds_write_b128 v20, v[236:239] offset:38912
  s_waitcnt lgkmcnt(0)
  s_barrier
  s_add_u32 s29, s50, 0
  buffer_load_dwordx4 v[192:195], v26, s[16:19], s29 offen offset:0 sc1
  buffer_load_dwordx4 v[196:199], v26, s[16:19], s29 offen offset:1024 sc1
  buffer_load_dwordx4 v[224:227], v26, s[16:19], s29 offen offset:2048 sc1
  s_add_u32 s29, s50, 16384
  buffer_load_dwordx4 v[200:203], v26, s[16:19], s29 offen offset:0 sc1
  buffer_load_dwordx4 v[204:207], v26, s[16:19], s29 offen offset:1024 sc1
  buffer_load_dwordx4 v[228:231], v26, s[16:19], s29 offen offset:2048 sc1
  s_add_u32 s29, s50, 32768
  buffer_load_dwordx4 v[208:211], v26, s[16:19], s29 offen offset:0 sc1
  buffer_load_dwordx4 v[212:215], v26, s[16:19], s29 offen offset:1024 sc1
  buffer_load_dwordx4 v[232:235], v26, s[16:19], s29 offen offset:2048 sc1
  s_add_u32 s29, s50, 49152
  buffer_load_dwordx4 v[216:219], v26, s[16:19], s29 offen offset:0 sc1
  buffer_load_dwordx4 v[220:223], v26, s[16:19], s29 offen offset:1024 sc1
  buffer_load_dwordx4 v[236:239], v26, s[16:19], s29 offen offset:2048 sc1
  ds_read_b128 v[64:67], v21 offset:0
  ds_read_b128 v[68:71], v21 offset:1024
  ds_read_b128 v[72:75], v21 offset:3072
  ds_read_b128 v[76:79], v21 offset:4096
  ds_read2st64_b64 v[80:83], v22 offset0:0 offset1:6
  ds_read2st64_b64 v[84:87], v23 offset0:0 offset1:6
  ds_read_b128 v[88:91], v21 offset:6144
  ds_read_b128 v[92:95], v21 offset:7168
  ds_read_b128 v[96:99], v21 offset:9216
  ds_read_b128 v[100:103], v21 offset:10240
  ds_read2st64_b64 v[104:107], v22 offset0:12 offset1:18
  ds_read2st64_b64 v[108:111], v23 offset0:12 offset1:18
  s_waitcnt vmcnt(0) lgkmcnt(0)
  v_swap_b32 v226, v228
  v_swap_b32 v227, v229
  v_swap_b32 v234, v236
  v_swap_b32 v235, v237
  s_nop 1
  v_mfma_f32_16x16x32_bf16 v[36:39], v[192:195], v[64:67], 0
  v_mfma_f32_16x16x32_bf16 v[44:47], v[192:195], v[68:71], 0
  v_mfma_f32_16x16x32_bf16 v[48:51], v[196:199], v[68:71], 0
  v_mfma_f32_16x16x32_bf16 v[36:39], v[200:203], v[72:75], v[36:39]
  v_mfma_f32_16x16x32_bf16 v[44:47], v[200:203], v[76:79], v[44:47]
  v_mfma_f32_16x16x32_bf16 v[48:51], v[204:207], v[76:79], v[48:51]
  v_mfma_f32_16x16x32_bf16 v[36:39], v[224:227], v[80:83], v[36:39]
  v_mfma_f32_16x16x32_bf16 v[44:47], v[224:227], v[84:87], v[44:47]
  v_mfma_f32_16x16x32_bf16 v[48:51], v[228:231], v[84:87], v[48:51]
  v_mfma_f32_16x16x32_bf16 v[36:39], v[208:211], v[88:91], v[36:39]
  v_mfma_f32_16x16x32_bf16 v[44:47], v[208:211], v[92:95], v[44:47]
  v_mfma_f32_16x16x32_bf16 v[48:51], v[212:215], v[92:95], v[48:51]
  v_mfma_f32_16x16x32_bf16 v[36:39], v[216:219], v[96:99], v[36:39]
  v_mfma_f32_16x16x32_bf16 v[44:47], v[216:219], v[100:103], v[44:47]
  v_mfma_f32_16x16x32_bf16 v[48:51], v[220:223], v[100:103], v[48:51]
  v_mfma_f32_16x16x32_bf16 v[36:39], v[232:235], v[104:107], v[36:39]
  v_mfma_f32_16x16x32_bf16 v[44:47], v[232:235], v[108:111], v[44:47]
  v_mfma_f32_16x16x32_bf16 v[48:51], v[236:239], v[108:111], v[48:51]
  s_sub_u32 s23, s49, 1
  s_min_u32 s23, s23, 62
  s_mov_b32 s101, 0
wm_215:
  buffer_load_dword v34, v30, s[72:75], s77 offen sc1
  s_add_u32 s101, s101, 1
  s_cmp_gt_u32 s101, 131072
  s_cbranch_scc1 main_end
  s_waitcnt vmcnt(0)
  v_cmp_gt_u32 vcc, s23, v34
  v_readfirstlane_b32 s100, v34
  s_nop 0
  s_cbranch_vccz wm_216
  s_sleep 4
  s_add_u32 s100, s100, 2
  s_cmp_ge_u32 s100, s23
  s_cbranch_scc1 wm_215
  s_sleep 60
  s_branch wm_215
wm_216:
  s_mov_b32 s101, 0
  s_branch qtp_218
qtp_217:
  s_sleep 3
qtp_218:
  s_add_u32 s29, s50, 4096
  buffer_load_dwordx4 v[112:115], v24, s[16:19], s29 offen offset:2560 sc1
  buffer_load_dwordx2 v[240:241], v25, s[16:19], s29 offen offset:3072 sc1
  s_add_u32 s29, s50, 20480
  buffer_load_dwordx4 v[116:119], v24, s[16:19], s29 offen offset:2560 sc1
  buffer_load_dwordx2 v[242:243], v25, s[16:19], s29 offen offset:3072 sc1
  s_add_u32 s29, s50, 36864
  buffer_load_dwordx4 v[120:123], v24, s[16:19], s29 offen offset:2560 sc1
  buffer_load_dwordx2 v[244:245], v25, s[16:19], s29 offen offset:3072 sc1
  s_add_u32 s29, s50, 53248
  buffer_load_dwordx4 v[124:127], v24, s[16:19], s29 offen offset:2560 sc1
  buffer_load_dwordx2 v[246:247], v25, s[16:19], s29 offen offset:3072 sc1
  s_add_u32 s101, s101, 1
  s_cmp_gt_u32 s101, 131072
  s_cbranch_scc1 main_end
  s_waitcnt vmcnt(0)
  v_max3_u32 v34, v112, v116, v120
  v_max3_u32 v34, v34, v124, v240
  v_max3_u32 v34, v34, v242, v244
  v_max_u32 v34, v34, v246
  v_cmp_eq_u32 vcc, -1, v34
  s_nop 1
  s_cbranch_vccnz qtp_217
  v_mfma_f32_16x16x32_bf16 v[40:43], v[112:115], v[64:67], 0
  v_mfma_f32_16x16x32_bf16 v[52:55], v[112:115], v[68:71], 0
  v_mfma_f32_16x16x32_bf16 v[40:43], v[116:119], v[72:75], v[40:43]
  v_mfma_f32_16x16x32_bf16 v[52:55], v[116:119], v[76:79], v[52:55]
  v_mfma_f32_16x16x32_bf16 v[40:43], v[240:243], v[80:83], v[40:43]
  v_mfma_f32_16x16x32_bf16 v[52:55], v[240:243], v[84:87], v[52:55]
  v_mfma_f32_16x16x32_bf16 v[40:43], v[120:123], v[88:91], v[40:43]
  v_mfma_f32_16x16x32_bf16 v[52:55], v[120:123], v[92:95], v[52:55]
  v_mfma_f32_16x16x32_bf16 v[40:43], v[124:127], v[96:99], v[40:43]
  v_mfma_f32_16x16x32_bf16 v[52:55], v[124:127], v[100:103], v[52:55]
  v_mfma_f32_16x16x32_bf16 v[40:43], v[244:247], v[104:107], v[40:43]
  v_mfma_f32_16x16x32_bf16 v[52:55], v[244:247], v[108:111], v[52:55]
  s_nop 4
  v_cndmask_b32 v36, v31, v36, s[64:65]
  v_cndmask_b32 v48, v31, v48, s[64:65]
  v_cndmask_b32 v37, v31, v37, s[66:67]
  v_cndmask_b32 v49, v31, v49, s[66:67]
  v_cndmask_b32 v38, v31, v38, s[68:69]
  v_cndmask_b32 v50, v31, v50, s[68:69]
  v_cndmask_b32 v39, v31, v39, s[70:71]
  v_cndmask_b32 v51, v31, v51, s[70:71]
  v_max3_f32 v34, v36, v37, v38
  v_max3_f32 v34, v34, v39, v40
  v_max3_f32 v34, v34, v41, v42
  v_max_f32 v34, v34, v43
  v_mov_b32 v35, v34
  s_nop 1
  v_permlane32_swap_b32 v34, v35
  v_max_f32 v34, v34, v35
  v_mov_b32 v35, v34
  s_nop 1
  v_permlane16_swap_b32 v34, v35
  v_max_f32 v34, v34, v35
  v_mul_f32 v34, s83, v34
  v_fma_f32 v36, v36, s83, -v34
  v_fma_f32 v37, v37, s83, -v34
  v_fma_f32 v38, v38, s83, -v34
  v_fma_f32 v39, v39, s83, -v34
  v_fma_f32 v40, v40, s83, -v34
  v_fma_f32 v41, v41, s83, -v34
  v_fma_f32 v42, v42, s83, -v34
  v_fma_f32 v43, v43, s83, -v34
  v_exp_f32 v36, v36
  v_exp_f32 v37, v37
  v_exp_f32 v38, v38
  v_exp_f32 v39, v39
  v_exp_f32 v40, v40
  v_exp_f32 v41, v41
  v_exp_f32 v42, v42
  v_exp_f32 v43, v43
  s_nop 0
  v_add_f32 v34, v40, v41
  v_add_f32 v34, v34, v42
  v_add_f32 v34, v34, v43
  v_cndmask_b32 v34, 0, v34, s[62:63]
  v_add_f32 v34, v34, v36
  v_add_f32 v34, v34, v37
  v_add_f32 v34, v34, v38
  v_add_f32 v34, v34, v39
  v_mov_b32 v35, v34
  s_nop 1
  v_permlane32_swap_b32 v34, v35
  v_add_f32 v34, v34, v35
  v_mov_b32 v35, v34
  s_nop 1
  v_permlane16_swap_b32 v34, v35
  v_add_f32 v34, v34, v35
  v_rcp_f32 v34, v34
  s_nop 0
  v_mul_f32 v36, v36, v34
  v_mul_f32 v37, v37, v34
  v_mul_f32 v38, v38, v34
  v_mul_f32 v39, v39, v34
  v_mul_f32 v40, v40, v34
  v_mul_f32 v41, v41, v34
  v_mul_f32 v42, v42, v34
  v_mul_f32 v43, v43, v34
  v_max3_f32 v34, v44, v45, v46
  v_max3_f32 v34, v34, v47, v48
  v_max3_f32 v34, v34, v49, v50
  v_max3_f32 v34, v34, v51, v52
  v_max3_f32 v34, v34, v53, v54
  v_max_f32 v34, v34, v55
  v_mov_b32 v35, v34
  s_nop 1
  v_permlane32_swap_b32 v34, v35
  v_max_f32 v34, v34, v35
  v_mov_b32 v35, v34
  s_nop 1
  v_permlane16_swap_b32 v34, v35
  v_max_f32 v34, v34, v35
  v_mul_f32 v34, s83, v34
  v_fma_f32 v44, v44, s83, -v34
  v_fma_f32 v45, v45, s83, -v34
  v_fma_f32 v46, v46, s83, -v34
  v_fma_f32 v47, v47, s83, -v34
  v_fma_f32 v48, v48, s83, -v34
  v_fma_f32 v49, v49, s83, -v34
  v_fma_f32 v50, v50, s83, -v34
  v_fma_f32 v51, v51, s83, -v34
  v_fma_f32 v52, v52, s83, -v34
  v_fma_f32 v53, v53, s83, -v34
  v_fma_f32 v54, v54, s83, -v34
  v_fma_f32 v55, v55, s83, -v34
  v_exp_f32 v44, v44
  v_exp_f32 v45, v45
  v_exp_f32 v46, v46
  v_exp_f32 v47, v47
  v_exp_f32 v48, v48
  v_exp_f32 v49, v49
  v_exp_f32 v50, v50
  v_exp_f32 v51, v51
  v_exp_f32 v52, v52
  v_exp_f32 v53, v53
  v_exp_f32 v54, v54
  v_exp_f32 v55, v55
  s_nop 0
  v_add_f32 v34, v52, v53
  v_add_f32 v34, v34, v54
  v_add_f32 v34, v34, v55
  v_cndmask_b32 v34, 0, v34, s[62:63]
  v_add_f32 v34, v34, v44
  v_add_f32 v34, v34, v45
  v_add_f32 v34, v34, v46
  v_add_f32 v34, v34, v47
  v_add_f32 v34, v34, v48
  v_add_f32 v34, v34, v49
  v_add_f32 v34, v34, v50
  v_add_f32 v34, v34, v51
  v_mov_b32 v35, v34
  s_nop 1
  v_permlane32_swap_b32 v34, v35
  v_add_f32 v34, v34, v35
  v_mov_b32 v35, v34
  s_nop 1
  v_permlane16_swap_b32 v34, v35
  v_add_f32 v34, v34, v35
  v_rcp_f32 v34, v34
  s_nop 0
  v_mul_f32 v44, v44, v34
  v_mul_f32 v45, v45, v34
  v_mul_f32 v46, v46, v34
  v_mul_f32 v47, v47, v34
  v_mul_f32 v48, v48, v34
  v_mul_f32 v49, v49, v34
  v_mul_f32 v50, v50, v34
  v_mul_f32 v51, v51, v34
  v_mul_f32 v52, v52, v34
  v_mul_f32 v53, v53, v34
  v_mul_f32 v54, v54, v34
  v_mul_f32 v55, v55, v34
  v_cvt_pk_bf16_f32 v56, v44, v45
  v_cvt_pk_bf16_f32 v57, v46, v47
  v_cvt_pk_bf16_f32 v58, v48, v49
  v_cvt_pk_bf16_f32 v59, v50, v51
  v_cvt_pk_bf16_f32 v60, v40, v41
  v_cvt_pk_bf16_f32 v61, v42, v43
  v_cvt_pk_bf16_f32 v62, v52, v53
  v_cvt_pk_bf16_f32 v63, v54, v55
  v_cvt_pk_bf16_f32 v248, v36, v37
  v_cvt_pk_bf16_f32 v249, v38, v39
  buffer_store_dwordx4 v[56:59], v26, s[16:19], s81 offen sc1
  buffer_store_dwordx4 v[60:63], v26, s[16:19], s81 offen offset:1024 sc1
  buffer_store_dwordx2 v[248:249], v29, s[16:19], s81 offen offset:2048 sc1
  s_waitcnt vmcnt(0)
  buffer_atomic_add v28, v33, s[72:75], s82 offen sc1
  s_branch qe_219
qw_213:
  s_mov_b32 s101, 0
wm_220:
  buffer_load_dword v32, v30, s[72:75], s77 offen sc1
  s_add_u32 s101, s101, 1
  s_cmp_gt_u32 s101, 131072
  s_cbranch_scc1 main_end
  s_waitcnt vmcnt(0)
  v_cmp_gt_u32 vcc, s49, v32
  v_readfirstlane_b32 s100, v32
  s_nop 0
  s_cbranch_vccz wm_221
  s_sleep 4
  s_add_u32 s100, s100, 2
  s_cmp_ge_u32 s100, s49
  s_cbranch_scc1 wm_220
  s_sleep 60
  s_branch wm_220
wm_221:
  s_branch qj_214
qe_219:
queue:
  s_lshr_b32 s21, s3, 5
  s_cmp_eq_u32 s21, 2
  s_cbranch_scc1 main_fin
  s_load_dwordx2 s[4:5], s[0:1], 88
  s_load_dwordx2 s[6:7], s[0:1], 72
  s_load_dwordx2 s[38:39], s[0:1], 104
  s_and_b32 s41, s3, 7
  s_lshr_b32 s58, s3, 4
  s_bfe_u32 s21, s3, 0x20003
  s_cmp_lt_u32 s3, 64
  s_cselect_b32 s58, s58, s21
  s_lshl_b32 s59, s58, 3
  s_add_u32 s59, s59, s41
  s_lshl_b32 s59, s59, 7
  s_add_u32 s59, s59, 92672
  s_waitcnt vmcnt(0) lgkmcnt(0)
  s_barrier
  s_mov_b32 s8, s4
  s_mov_b32 s9, s5
  s_mov_b32 s10, 2621440
  s_mov_b32 s11, 0x00020000
  s_mov_b32 s12, s6
  s_mov_b32 s13, s7
  s_mov_b32 s14, 819200
  s_mov_b32 s15, 0x00020000
  s_mov_b32 s16, s38
  s_mov_b32 s17, s39
  s_mov_b32 s18, 167772160
  s_mov_b32 s19, 0x00020000
  s_add_u32 s28, s38, 170917888
  s_addc_u32 s29, s39, 0
  s_mov_b32 s30, 8192
  s_mov_b32 s31, 0x00020000
  s_add_u32 s72, s38, 170983424
  s_addc_u32 s73, s39, 0
  s_mov_b32 s74, 96768
  s_mov_b32 s75, 0x00020000
  v_mov_b32 v28, 0
  v_mov_b32 v30, 102400
  s_cmp_lg_u32 s20, 0
  s_cbranch_scc1 pvc_222
  v_mov_b32 v29, 1
  s_mov_b64 exec, 1
  buffer_atomic_add v29, v28, s[72:75], s59 offen sc0 sc1
  s_waitcnt vmcnt(0)
  ds_write_b32 v30, v29
  s_waitcnt lgkmcnt(0)
  s_mov_b64 exec, -1
pvc_222:
  s_barrier
  ds_read_b32 v23, v30
  s_waitcnt lgkmcnt(0)
  v_readfirstlane_b32 s2, v23
  s_cmp_ge_u32 s2, 16
  s_cbranch_scc1 main_fin
  s_mul_i32 s21, s20, 204800
  s_mul_i32 s22, s41, 160
  s_add_u32 s21, s21, s22
  s_mul_i32 s22, s20, 25600
  v_add_u32 v5, 0, v1
  v_mul_u32_u24 v6, 6554, v5
  v_lshrrev_b32 v6, 16, v6
  v_mul_u32_u24 v6, 1120, v6
  v_lshl_add_u32 v8, v5, 4, v6
  v_add_u32 v5, 64, v1
  v_mul_u32_u24 v6, 6554, v5
  v_lshrrev_b32 v6, 16, v6
  v_mul_u32_u24 v6, 1120, v6
  v_lshl_add_u32 v9, v5, 4, v6
  v_add_u32 v5, 128, v1
  v_mul_u32_u24 v6, 6554, v5
  v_lshrrev_b32 v6, 16, v6
  v_mul_u32_u24 v6, 1120, v6
  v_lshl_add_u32 v10, v5, 4, v6
  v_add_u32 v5, 192, v1
  v_mul_u32_u24 v6, 6554, v5
  v_lshrrev_b32 v6, 16, v6
  v_mul_u32_u24 v6, 1120, v6
  v_lshl_add_u32 v11, v5, 4, v6
  v_add_u32 v5, 256, v1
  v_mul_u32_u24 v6, 6554, v5
  v_lshrrev_b32 v6, 16, v6
  v_mul_u32_u24 v6, 1120, v6
  v_lshl_add_u32 v12, v5, 4, v6
  s_add_u32 m0, s22, 0
  s_nop 0
  buffer_load_dwordx4 v8, s[12:15], s21 offen lds
  s_add_u32 m0, s22, 1024
  s_nop 0
  buffer_load_dwordx4 v9, s[12:15], s21 offen lds
  s_add_u32 m0, s22, 2048
  s_nop 0
  buffer_load_dwordx4 v10, s[12:15], s21 offen lds
  s_add_u32 m0, s22, 3072
  s_nop 0
  buffer_load_dwordx4 v11, s[12:15], s21 offen lds
  s_add_u32 m0, s22, 4096
  s_nop 0
  buffer_load_dwordx4 v12, s[12:15], s21 offen lds
  s_add_u32 s21, s21, 40960
  s_add_u32 m0, s22, 5120
  s_nop 0
  buffer_load_dwordx4 v8, s[12:15], s21 offen lds
  s_add_u32 m0, s22, 6144
  s_nop 0
  buffer_load_dwordx4 v9, s[12:15], s21 offen lds
  s_add_u32 m0, s22, 7168
  s_nop 0
  buffer_load_dwordx4 v10, s[12:15], s21 offen lds
  s_add_u32 m0, s22, 8192
  s_nop 0
  buffer_load_dwordx4 v11, s[12:15], s21 offen lds
  s_add_u32 m0, s22, 9216
  s_nop 0
  buffer_load_dwordx4 v12, s[12:15], s21 offen lds
  s_add_u32 s21, s21, 40960
  s_add_u32 m0, s22, 10240
  s_nop 0
  buffer_load_dwordx4 v8, s[12:15], s21 offen lds
  s_add_u32 m0, s22, 11264
  s_nop 0
  buffer_load_dwordx4 v9, s[12:15], s21 offen lds
  s_add_u32 m0, s22, 12288
  s_nop 0
  buffer_load_dwordx4 v10, s[12:15], s21 offen lds
  s_add_u32 m0, s22, 13312
  s_nop 0
  buffer_load_dwordx4 v11, s[12:15], s21 offen lds
  s_add_u32 m0, s22, 14336
  s_nop 0
  buffer_load_dwordx4 v12, s[12:15], s21 offen lds
  s_add_u32 s21, s21, 40960
  s_add_u32 m0, s22, 15360
  s_nop 0
  buffer_load_dwordx4 v8, s[12:15], s21 offen lds
  s_add_u32 m0, s22, 16384
  s_nop 0
  buffer_load_dwordx4 v9, s[12:15], s21 offen lds
  s_add_u32 m0, s22, 17408
  s_nop 0
  buffer_load_dwordx4 v10, s[12:15], s21 offen lds
  s_add_u32 m0, s22, 18432
  s_nop 0
  buffer_load_dwordx4 v11, s[12:15], s21 offen lds
  s_add_u32 m0, s22, 19456
  s_nop 0
  buffer_load_dwordx4 v12, s[12:15], s21 offen lds
  s_add_u32 s21, s21, 40960
  s_add_u32 m0, s22, 20480
  s_nop 0
  buffer_load_dwordx4 v8, s[12:15], s21 offen lds
  s_add_u32 m0, s22, 21504
  s_nop 0
  buffer_load_dwordx4 v9, s[12:15], s21 offen lds
  s_add_u32 m0, s22, 22528
  s_nop 0
  buffer_load_dwordx4 v10, s[12:15], s21 offen lds
  s_add_u32 m0, s22, 23552
  s_nop 0
  buffer_load_dwordx4 v11, s[12:15], s21 offen lds
  s_add_u32 m0, s22, 24576
  s_nop 0
  buffer_load_dwordx4 v12, s[12:15], s21 offen lds
  s_add_u32 s21, s21, 40960
  v_and_b32 v25, 3, v1
  v_lshlrev_b32 v25, 7, v25
  s_mov_b32 s21, 88064
  v_lshrrev_b32 v5, 2, v2
  v_and_b32 v6, 3, v2
  v_lshlrev_b32 v6, 3, v6
  v_lshl_add_u32 v7, v3, 2, v5
  v_mul_u32_u24 v7, 160, v7
  v_add3_u32 v8, v7, v6, s22
  v_add_u32 v9, v8, v6
  v_mul_u32_u24 v7, 20, v3
  v_add_u32 v7, v7, v5
  v_mul_u32_u24 v7, 160, v7
  v_add3_u32 v10, v7, v6, s22
  v_add_u32 v11, v10, v6
  s_mov_b32 s101, 0
wm_223:
  buffer_load_dword v26, v25, s[72:75], s21 offen sc1
  s_add_u32 s101, s101, 1
  s_cmp_gt_u32 s101, 131072
  s_cbranch_scc1 main_end
  s_waitcnt vmcnt(0)
  v_cmp_gt_u32 vcc, 8, v26
  v_readfirstlane_b32 s100, v26
  s_nop 0
  s_cbranch_vccz wm_224
  s_sleep 16
  s_branch wm_223
wm_224:
  ds_read_b64_tr_b16 a[160:161], v9 offset:0
  ds_read_b64_tr_b16 a[162:163], v9 offset:3200
  ds_read_b64_tr_b16 a[164:165], v9 offset:8
  ds_read_b64_tr_b16 a[166:167], v9 offset:3208
  ds_read_b64_tr_b16 a[168:169], v8 offset:64
  ds_read_b64_tr_b16 a[170:171], v8 offset:3264
  ds_read_b64_tr_b16 a[172:173], v9 offset:96
  ds_read_b64_tr_b16 a[174:175], v9 offset:3296
  ds_read_b64_tr_b16 a[176:177], v9 offset:104
  ds_read_b64_tr_b16 a[178:179], v9 offset:3304
  ds_read_b64_tr_b16 a[180:181], v9 offset:6400
  ds_read_b64_tr_b16 a[182:183], v9 offset:9600
  ds_read_b64_tr_b16 a[184:185], v9 offset:6408
  ds_read_b64_tr_b16 a[186:187], v9 offset:9608
  ds_read_b64_tr_b16 a[188:189], v8 offset:6464
  ds_read_b64_tr_b16 a[190:191], v8 offset:9664
  ds_read_b64_tr_b16 a[192:193], v9 offset:6496
  ds_read_b64_tr_b16 a[194:195], v9 offset:9696
  ds_read_b64_tr_b16 a[196:197], v9 offset:6504
  ds_read_b64_tr_b16 a[198:199], v9 offset:9704
  ds_read_b64_tr_b16 a[200:201], v9 offset:12800
  ds_read_b64_tr_b16 a[202:203], v9 offset:16000
  ds_read_b64_tr_b16 a[204:205], v9 offset:12808
  ds_read_b64_tr_b16 a[206:207], v9 offset:16008
  ds_read_b64_tr_b16 a[208:209], v8 offset:12864
  ds_read_b64_tr_b16 a[210:211], v8 offset:16064
  ds_read_b64_tr_b16 a[212:213], v9 offset:12896
  ds_read_b64_tr_b16 a[214:215], v9 offset:16096
  ds_read_b64_tr_b16 a[216:217], v9 offset:12904
  ds_read_b64_tr_b16 a[218:219], v9 offset:16104
  ds_read_b64_tr_b16 a[220:221], v9 offset:19200
  ds_read_b64_tr_b16 a[222:223], v9 offset:22400
  ds_read_b64_tr_b16 a[224:225], v9 offset:19208
  ds_read_b64_tr_b16 a[226:227], v9 offset:22408
  ds_read_b64_tr_b16 a[228:229], v8 offset:19264
  ds_read_b64_tr_b16 a[230:231], v8 offset:22464
  ds_read_b64_tr_b16 a[232:233], v9 offset:19296
  ds_read_b64_tr_b16 a[234:235], v9 offset:22496
  ds_read_b64_tr_b16 a[236:237], v9 offset:19304
  ds_read_b64_tr_b16 a[238:239], v9 offset:22504
  ds_read_b64_tr_b16 a[240:241], v11 offset:2560
  ds_read_b64_tr_b16 a[242:243], v11 offset:15360
  ds_read_b64_tr_b16 a[244:245], v11 offset:2568
  ds_read_b64_tr_b16 a[246:247], v11 offset:15368
  ds_read_b64_tr_b16 a[248:249], v10 offset:2624
  ds_read_b64_tr_b16 a[250:251], v10 offset:15424
  ds_read_b64_tr_b16 a[252:253], v11 offset:2656
  ds_read_b64_tr_b16 a[254:255], v11 offset:15456
  ds_read_b64_tr_b16 v[252:253], v11 offset:2664
  ds_read_b64_tr_b16 v[254:255], v11 offset:15464
  s_waitcnt lgkmcnt(0)
  s_barrier
  v_lshlrev_b32 v4, 4, v1
  v_lshlrev_b32 v5, 3, v1
  v_lshlrev_b32 v6, 2, v2
  v_and_b32 v7, 7, v1
  v_lshlrev_b32 v7, 7, v7
  v_bfe_u32 v31, v1, 3, 2
  v_lshl_add_u32 v31, v31, 2, v7
  s_lshl_b32 s21, s20, 10
  s_add_u32 s21, s21, 88576
  buffer_load_dword v8, v31, s[72:75], s21 offen sc1
  s_mov_b32 s63, 1
  s_mov_b32 s60, 0
  v_mul_u32_u24 v9, 1280, v2
  v_lshl_add_u32 v13, v3, 3, v9
  v_lshl_add_u32 v9, v3, 4, v9
  s_mul_i32 s21, s20, 10240
  v_add_u32 v10, s21, v4
  s_and_b32 s43, s20, 1
  s_lshr_b32 s44, s20, 1
  s_mul_i32 s21, s44, 6
  s_add_u32 s21, s21, s43
  s_lshl_b32 s21, s21, 10
  v_add_u32 v11, s21, v4
  s_add_u32 s21, s43, 4
  s_lshl_b32 s21, s21, 10
  v_add_u32 v12, s21, v4
  v_lshrrev_b32 v20, 5, v1
  v_mul_u32_u24 v21, 2560, v20
  v_add_u32 v21, v21, v4
  v_and_b32 v22, 31, v1
  v_lshlrev_b32 v22, 4, v22
  v_mul_u32_u24 v14, 640, v20
  v_add_u32 v22, v22, v14
  v_and_b32 v15, 1, v3
  v_lshl_add_u32 v14, v15, 6, v14
  v_lshrrev_b32 v16, 3, v2
  v_mul_u32_u24 v16, 16320, v16
  v_lshl_add_u32 v16, v2, 3, v16
  v_add_u32 v14, v14, v16
  v_add_u32 v15, 40960, v11
  v_lshlrev_b32 v17, 2, v7
  v_bfe_u32 v16, v1, 3, 1
  v_lshl_add_u32 v17, v16, 3, v17
  v_cmp_gt_u32 s[66:67], 16, v1
  v_add_u32 v16, 40960, v12
  s_mov_b32 s50, 0
  s_lshr_b32 s52, s41, 1
  s_lshl_b32 s52, s52, 7
  s_and_b32 s21, s41, 1
  s_lshl_b32 s21, s21, 4
  s_add_u32 s52, s52, s21
  s_add_u32 s52, s52, 18432
  v_mov_b32 v70, 0
  v_mov_b32 v71, 0
  v_mov_b32 v78, 0
  v_mov_b32 v79, 0
  v_mov_b32 v86, 0
  v_mov_b32 v87, 0
  v_mov_b32 v94, 0
  v_mov_b32 v95, 0
  v_mov_b32 v102, 0
  v_mov_b32 v103, 0
  v_mov_b32 v110, 0
  v_mov_b32 v111, 0
  v_mov_b32 v118, 0
  v_mov_b32 v119, 0
  v_mov_b32 v126, 0
  v_mov_b32 v127, 0
pv_loop:
  s_lshl_b32 s40, s2, 2
  s_add_u32 s40, s40, s58
  s_lshl_b32 s2, s40, 3
  s_add_u32 s2, s2, s41
  s_lshl_b32 s61, s40, 21
  s_lshl_b32 s21, s40, 13
  s_and_b32 s21, s21, 8192
  s_xor_b32 s21, s21, s80
  s_add_u32 s61, s61, s21
  s_lshl_b32 s55, s40, 19
  s_lshl_b32 s21, s40, 11
  s_and_b32 s21, s21, 8192
  s_xor_b32 s21, s21, s80
  s_add_u32 s55, s55, s21
  s_add_u32 s55, s55, 134217728
  s_lshl_b32 s21, s20, 15
  s_xor_b32 s54, s55, 270336
  s_add_u32 s54, s54, s21
  s_add_u32 s21, s54, 0
  buffer_load_dwordx4 v[192:195], v4, s[16:19], s21 offen offset:0 sc1
  buffer_load_dwordx4 v[196:199], v4, s[16:19], s21 offen offset:1024 sc1
  buffer_load_dwordx2 v[208:209], v5, s[16:19], s21 offen offset:2048 sc1
  s_add_u32 s21, s54, 2560
  buffer_load_dwordx4 v[200:203], v4, s[16:19], s21 offen offset:0 sc1
  buffer_load_dwordx4 v[204:207], v4, s[16:19], s21 offen offset:1024 sc1
  buffer_load_dwordx2 v[210:211], v5, s[16:19], s21 offen offset:2048 sc1
  s_add_u32 s21, s54, 16384
  buffer_load_dwordx4 v[212:215], v4, s[16:19], s21 offen offset:0 sc1
  buffer_load_dwordx4 v[216:219], v4, s[16:19], s21 offen offset:1024 sc1
  buffer_load_dwordx2 v[228:229], v5, s[16:19], s21 offen offset:2048 sc1
  s_add_u32 s21, s54, 18944
  buffer_load_dwordx4 v[220:223], v4, s[16:19], s21 offen offset:0 sc1
  buffer_load_dwordx4 v[224:227], v4, s[16:19], s21 offen offset:1024 sc1
  buffer_load_dwordx2 v[230:231], v5, s[16:19], s21 offen offset:2048 sc1
  s_lshl_b32 s21, s40, 10
  s_add_u32 s21, s21, 22528
  v_add_u32 v18, s21, v7
  v_add_u32 v19, s52, v17
  v_cndmask_b32 v18, v19, v18, s[66:67]
  s_add_u32 s21, s40, 1
  v_mov_b32 v19, s21
  v_cndmask_b32 v19, v19, 4, s[66:67]
  buffer_load_dword v27, v18, s[72:75], 0 offen sc1
  s_cmp_lg_u32 s20, 0
  s_cbranch_scc1 pv_225
  v_mov_b32 v29, 1
  s_mov_b64 exec, 1
  buffer_atomic_add v29, v28, s[72:75], s59 offen sc0 sc1
  s_mov_b64 exec, -1
pv_225:
  s_lshl_b32 s21, s20, 17
  s_lshl_b32 s22, s41, 10
  s_add_u32 s42, s21, s22
  s_lshl_b32 s53, s20, 19
  s_lshr_b32 s22, s41, 1
  s_lshl_b32 s22, s22, 14
  s_add_u32 s53, s53, s22
  s_and_b32 s22, s41, 1
  s_lshl_b32 s22, s22, 12
  s_add_u32 s53, s53, s22
  s_lshl_b32 s21, s40, 1
  s_add_u32 s21, s21, s43
  s_lshl_b32 s45, s21, 6
  s_mul_i32 s46, s21, 20480
  s_mul_i32 s22, s41, 160
  s_add_u32 s49, s46, s22
  s_mul_i32 s21, s44, 96
  s_add_u32 s46, s49, s21
  s_lshl_b32 s21, s20, 16
  s_xor_b32 s47, s55, 8192
  s_add_u32 s47, s47, s21
  s_lshl_b32 s21, s20, 19
  s_add_u32 s48, s61, s21
  s_lshl_b32 s21, s41, 15
  s_add_u32 s48, s48, s21
  s_add_u32 s48, s48, 4096
  s_add_u32 s23, s40, 1
  s_cmp_ge_u32 s50, s23
  s_cbranch_scc1 pv_226
  s_cmp_eq_u32 s63, 0
  s_cbranch_scc1 pv_229
  s_mov_b32 s63, 0
  s_waitcnt vmcnt(13)
  v_cmp_gt_u32 vcc, s23, v8
  s_nop 1
  s_cbranch_vccz pv_230
pv_229:
  s_lshl_b32 s21, s20, 10
  s_add_u32 s21, s21, 88576
  s_mov_b32 s101, 0
wm_233:
  buffer_load_dword v8, v31, s[72:75], s21 offen sc1
  s_add_u32 s101, s101, 1
  s_cmp_gt_u32 s101, 131072
  s_cbranch_scc1 main_end
  s_waitcnt vmcnt(0)
  v_cmp_gt_u32 vcc, s23, v8
  v_readfirstlane_b32 s100, v8
  s_nop 0
  s_cbranch_vccz wm_234
  s_sleep 8
  s_add_u32 s100, s100, 2
  s_cmp_ge_u32 s100, s23
  s_cbranch_scc1 wm_233
  s_sleep 60
  s_branch wm_233
wm_234:
pv_230:
  v_readlane_b32 s50, v8, 0
  v_readlane_b32 s21, v8, 1
  s_min_u32 s50, s50, s21
  v_readlane_b32 s21, v8, 2
  s_min_u32 s50, s50, s21
  v_readlane_b32 s21, v8, 3
  s_min_u32 s50, s50, s21
  v_readlane_b32 s21, v8, 4
  s_min_u32 s50, s50, s21
  v_readlane_b32 s21, v8, 5
  s_min_u32 s50, s50, s21
  v_readlane_b32 s21, v8, 6
  s_min_u32 s50, s50, s21
  v_readlane_b32 s21, v8, 7
  s_min_u32 s50, s50, s21
  v_readlane_b32 s21, v8, 8
  s_min_u32 s50, s50, s21
  v_readlane_b32 s21, v8, 9
  s_min_u32 s50, s50, s21
  v_readlane_b32 s21, v8, 10
  s_min_u32 s50, s50, s21
  v_readlane_b32 s21, v8, 11
  s_min_u32 s50, s50, s21
  v_readlane_b32 s21, v8, 12
  s_min_u32 s50, s50, s21
  v_readlane_b32 s21, v8, 13
  s_min_u32 s50, s50, s21
  v_readlane_b32 s21, v8, 14
  s_min_u32 s50, s50, s21
  v_readlane_b32 s21, v8, 15
  s_min_u32 s50, s50, s21
  v_readlane_b32 s21, v8, 16
  s_min_u32 s50, s50, s21
  v_readlane_b32 s21, v8, 17
  s_min_u32 s50, s50, s21
  v_readlane_b32 s21, v8, 18
  s_min_u32 s50, s50, s21
  v_readlane_b32 s21, v8, 19
  s_min_u32 s50, s50, s21
  v_readlane_b32 s21, v8, 20
  s_min_u32 s50, s50, s21
  v_readlane_b32 s21, v8, 21
  s_min_u32 s50, s50, s21
  v_readlane_b32 s21, v8, 22
  s_min_u32 s50, s50, s21
  v_readlane_b32 s21, v8, 23
  s_min_u32 s50, s50, s21
  v_readlane_b32 s21, v8, 24
  s_min_u32 s50, s50, s21
  v_readlane_b32 s21, v8, 25
  s_min_u32 s50, s50, s21
  v_readlane_b32 s21, v8, 26
  s_min_u32 s50, s50, s21
  v_readlane_b32 s21, v8, 27
  s_min_u32 s50, s50, s21
  v_readlane_b32 s21, v8, 28
  s_min_u32 s50, s50, s21
  v_readlane_b32 s21, v8, 29
  s_min_u32 s50, s50, s21
  v_readlane_b32 s21, v8, 30
  s_min_u32 s50, s50, s21
  v_readlane_b32 s21, v8, 31
  s_min_u32 s50, s50, s21
pv_226:
  buffer_load_dword v24, v6, s[28:31], s45 offen sc1
  s_xor_b32 s68, s61, 8192
  s_add_u32 s68, s68, s53
  s_add_u32 s70, s55, s42
  buffer_load_dwordx4 a[0:3], v4, s[16:19], s68 offen offset:0 sc1
  buffer_load_dwordx4 a[4:7], v4, s[16:19], s68 offen offset:1024 sc1
  buffer_load_dwordx4 a[8:11], v4, s[16:19], s70 offen sc1
  s_add_u32 s70, s70, 16384
  buffer_load_dwordx4 a[12:15], v4, s[16:19], s68 offen offset:2048 sc1
  buffer_load_dwordx4 a[16:19], v4, s[16:19], s68 offen offset:3072 sc1
  s_add_u32 s68, s68, 65536
  buffer_load_dwordx4 a[20:23], v4, s[16:19], s68 offen offset:0 sc1
  buffer_load_dwordx4 a[24:27], v4, s[16:19], s68 offen offset:1024 sc1
  buffer_load_dwordx4 a[28:31], v4, s[16:19], s70 offen sc1
  s_add_u32 s70, s70, 16384
  buffer_load_dwordx4 a[32:35], v4, s[16:19], s68 offen offset:2048 sc1
  buffer_load_dwordx4 a[36:39], v4, s[16:19], s68 offen offset:3072 sc1
  s_add_u32 s68, s68, 65536
  buffer_load_dwordx4 a[40:43], v4, s[16:19], s68 offen offset:0 sc1
  buffer_load_dwordx4 a[44:47], v4, s[16:19], s68 offen offset:1024 sc1
  buffer_load_dwordx4 a[48:51], v4, s[16:19], s70 offen sc1
  s_add_u32 s70, s70, 16384
  buffer_load_dwordx4 a[52:55], v4, s[16:19], s68 offen offset:2048 sc1
  buffer_load_dwordx4 a[56:59], v4, s[16:19], s68 offen offset:3072 sc1
  s_add_u32 s68, s68, 65536
  buffer_load_dwordx4 a[60:63], v4, s[16:19], s68 offen offset:0 sc1
  buffer_load_dwordx4 a[64:67], v4, s[16:19], s68 offen offset:1024 sc1
  buffer_load_dwordx4 a[68:71], v4, s[16:19], s70 offen sc1
  s_add_u32 s70, s70, 16384
  buffer_load_dwordx4 a[72:75], v4, s[16:19], s68 offen offset:2048 sc1
  buffer_load_dwordx4 a[76:79], v4, s[16:19], s68 offen offset:3072 sc1
  s_add_u32 s68, s68, 65536
  buffer_load_dwordx4 a[80:83], v4, s[16:19], s68 offen offset:0 sc1
  buffer_load_dwordx4 a[84:87], v4, s[16:19], s68 offen offset:1024 sc1
  buffer_load_dwordx4 a[88:91], v4, s[16:19], s70 offen sc1
  s_add_u32 s70, s70, 16384
  buffer_load_dwordx4 a[92:95], v4, s[16:19], s68 offen offset:2048 sc1
  buffer_load_dwordx4 a[96:99], v4, s[16:19], s68 offen offset:3072 sc1
  s_add_u32 s68, s68, 65536
  buffer_load_dwordx4 a[100:103], v4, s[16:19], s68 offen offset:0 sc1
  buffer_load_dwordx4 a[104:107], v4, s[16:19], s68 offen offset:1024 sc1
  buffer_load_dwordx4 a[108:111], v4, s[16:19], s70 offen sc1
  s_add_u32 s70, s70, 16384
  buffer_load_dwordx4 a[112:115], v4, s[16:19], s68 offen offset:2048 sc1
  buffer_load_dwordx4 a[116:119], v4, s[16:19], s68 offen offset:3072 sc1
  s_add_u32 s68, s68, 65536
  buffer_load_dwordx4 a[120:123], v4, s[16:19], s68 offen offset:0 sc1
  buffer_load_dwordx4 a[124:127], v4, s[16:19], s68 offen offset:1024 sc1
  buffer_load_dwordx4 a[128:131], v4, s[16:19], s70 offen sc1
  s_add_u32 s70, s70, 16384
  buffer_load_dwordx4 a[132:135], v4, s[16:19], s68 offen offset:2048 sc1
  buffer_load_dwordx4 a[136:139], v4, s[16:19], s68 offen offset:3072 sc1
  s_add_u32 s68, s68, 65536
  buffer_load_dwordx4 a[140:143], v4, s[16:19], s68 offen offset:0 sc1
  buffer_load_dwordx4 a[144:147], v4, s[16:19], s68 offen offset:1024 sc1
  buffer_load_dwordx4 a[148:151], v4, s[16:19], s70 offen sc1
  s_add_u32 s70, s70, 16384
  buffer_load_dwordx4 a[152:155], v4, s[16:19], s68 offen offset:2048 sc1
  buffer_load_dwordx4 a[156:159], v4, s[16:19], s68 offen offset:3072 sc1
  s_add_u32 s68, s68, 65536
  s_waitcnt vmcnt(40)
  v_cmp_gt_u32 vcc, v19, v27
  s_nop 1
  s_cbranch_vccnz pvw_231
  buffer_load_dwordx4 v[64:67], v4, s[16:19], s47 offen sc1
  buffer_load_dwordx2 v[68:69], v5, s[16:19], s47 offen offset:2048 sc1
  buffer_load_dwordx4 v[128:131], v21, s[16:19], s47 offen offset:1024 sc1
  s_add_u32 s47, s47, 2560
  buffer_load_dwordx4 v[72:75], v4, s[16:19], s47 offen sc1
  buffer_load_dwordx2 v[76:77], v5, s[16:19], s47 offen offset:2048 sc1
  s_add_u32 s47, s47, 13824
  buffer_load_dwordx4 v[80:83], v4, s[16:19], s47 offen sc1
  buffer_load_dwordx2 v[84:85], v5, s[16:19], s47 offen offset:2048 sc1
  buffer_load_dwordx4 v[132:135], v21, s[16:19], s47 offen offset:1024 sc1
  s_add_u32 s47, s47, 2560
  buffer_load_dwordx4 v[88:91], v4, s[16:19], s47 offen sc1
  buffer_load_dwordx2 v[92:93], v5, s[16:19], s47 offen offset:2048 sc1
  s_add_u32 s47, s47, 13824
  s_add_u32 s21, s48, 16384
  buffer_load_dwordx4 v[32:35], v22, s[16:19], s48 offen offset:0 sc1
  buffer_load_dwordx4 v[40:43], v22, s[16:19], s21 offen offset:0 sc1
  buffer_load_dwordx2 v[184:185], v14, s[16:19], s48 offen offset:512 sc1
  buffer_load_dwordx4 v[36:39], v22, s[16:19], s48 offen offset:1280 sc1
  buffer_load_dwordx4 v[44:47], v22, s[16:19], s21 offen offset:1280 sc1
  buffer_load_dwordx2 v[186:187], v14, s[16:19], s48 offen offset:1792 sc1
  s_add_u32 s48, s48, 262144
  v_mfma_f32_16x16x32_bf16 v[144:147], a[160:163], v[192:195], 0
  v_mfma_f32_16x16x32_bf16 v[148:151], a[160:163], v[212:215], 0
  v_mfma_f32_16x16x32_bf16 v[152:155], a[164:167], v[192:195], 0
  v_mfma_f32_16x16x32_bf16 v[156:159], a[164:167], v[212:215], 0
  v_mfma_f32_16x16x32_bf16 v[160:163], a[168:171], v[192:195], 0
  v_mfma_f32_16x16x32_bf16 v[164:167], a[168:171], v[212:215], 0
  v_mfma_f32_16x16x32_bf16 v[168:171], a[172:175], v[192:195], 0
  v_mfma_f32_16x16x32_bf16 v[172:175], a[172:175], v[212:215], 0
  v_mfma_f32_16x16x32_bf16 v[176:179], a[176:179], v[192:195], 0
  v_mfma_f32_16x16x32_bf16 v[180:183], a[176:179], v[212:215], 0
  v_mfma_f32_16x16x32_bf16 v[144:147], a[180:183], v[196:199], v[144:147]
  v_mfma_f32_16x16x32_bf16 v[148:151], a[180:183], v[216:219], v[148:151]
  v_mfma_f32_16x16x32_bf16 v[152:155], a[184:187], v[196:199], v[152:155]
  v_mfma_f32_16x16x32_bf16 v[156:159], a[184:187], v[216:219], v[156:159]
  v_mfma_f32_16x16x32_bf16 v[160:163], a[188:191], v[196:199], v[160:163]
  v_mfma_f32_16x16x32_bf16 v[164:167], a[188:191], v[216:219], v[164:167]
  v_mfma_f32_16x16x32_bf16 v[168:171], a[192:195], v[196:199], v[168:171]
  v_mfma_f32_16x16x32_bf16 v[172:175], a[192:195], v[216:219], v[172:175]
  v_mfma_f32_16x16x32_bf16 v[176:179], a[196:199], v[196:199], v[176:179]
  v_mfma_f32_16x16x32_bf16 v[180:183], a[196:199], v[216:219], v[180:183]
  v_mfma_f32_16x16x32_bf16 v[144:147], a[200:203], v[200:203], v[144:147]
  v_mfma_f32_16x16x32_bf16 v[148:151], a[200:203], v[220:223], v[148:151]
  v_mfma_f32_16x16x32_bf16 v[152:155], a[204:207], v[200:203], v[152:155]
  v_mfma_f32_16x16x32_bf16 v[156:159], a[204:207], v[220:223], v[156:159]
  v_mfma_f32_16x16x32_bf16 v[160:163], a[208:211], v[200:203], v[160:163]
  v_mfma_f32_16x16x32_bf16 v[164:167], a[208:211], v[220:223], v[164:167]
  v_mfma_f32_16x16x32_bf16 v[168:171], a[212:215], v[200:203], v[168:171]
  v_mfma_f32_16x16x32_bf16 v[172:175], a[212:215], v[220:223], v[172:175]
  v_mfma_f32_16x16x32_bf16 v[176:179], a[216:219], v[200:203], v[176:179]
  v_mfma_f32_16x16x32_bf16 v[180:183], a[216:219], v[220:223], v[180:183]
  v_mfma_f32_16x16x32_bf16 v[144:147], a[220:223], v[204:207], v[144:147]
  v_mfma_f32_16x16x32_bf16 v[148:151], a[220:223], v[224:227], v[148:151]
  v_mfma_f32_16x16x32_bf16 v[152:155], a[224:227], v[204:207], v[152:155]
  v_mfma_f32_16x16x32_bf16 v[156:159], a[224:227], v[224:227], v[156:159]
  v_mfma_f32_16x16x32_bf16 v[160:163], a[228:231], v[204:207], v[160:163]
  v_mfma_f32_16x16x32_bf16 v[164:167], a[228:231], v[224:227], v[164:167]
  v_mfma_f32_16x16x32_bf16 v[168:171], a[232:235], v[204:207], v[168:171]
  v_mfma_f32_16x16x32_bf16 v[172:175], a[232:235], v[224:227], v[172:175]
  v_mfma_f32_16x16x32_bf16 v[176:179], a[236:239], v[204:207], v[176:179]
  v_mfma_f32_16x16x32_bf16 v[180:183], a[236:239], v[224:227], v[180:183]
  v_mfma_f32_16x16x32_bf16 v[144:147], a[240:243], v[208:211], v[144:147]
  v_mfma_f32_16x16x32_bf16 v[148:151], a[240:243], v[228:231], v[148:151]
  v_mfma_f32_16x16x32_bf16 v[152:155], a[244:247], v[208:211], v[152:155]
  v_mfma_f32_16x16x32_bf16 v[156:159], a[244:247], v[228:231], v[156:159]
  v_mfma_f32_16x16x32_bf16 v[160:163], a[248:251], v[208:211], v[160:163]
  v_mfma_f32_16x16x32_bf16 v[164:167], a[248:251], v[228:231], v[164:167]
  v_mfma_f32_16x16x32_bf16 v[168:171], a[252:255], v[208:211], v[168:171]
  v_mfma_f32_16x16x32_bf16 v[172:175], a[252:255], v[228:231], v[172:175]
  v_mfma_f32_16x16x32_bf16 v[176:179], v[252:255], v[208:211], v[176:179]
  v_mfma_f32_16x16x32_bf16 v[180:183], v[252:255], v[228:231], v[180:183]
  ds_write_b128 v10, v[144:147] offset:40960
  ds_write_b128 v10, v[148:151] offset:41984
  ds_write_b128 v10, v[152:155] offset:43008
  ds_write_b128 v10, v[156:159] offset:44032
  ds_write_b128 v10, v[160:163] offset:45056
  ds_write_b128 v10, v[164:167] offset:46080
  ds_write_b128 v10, v[168:171] offset:47104
  ds_write_b128 v10, v[172:175] offset:48128
  s_nop 1
  ds_write_b128 v10, v[176:179] offset:49152
  ds_write_b128 v10, v[180:183] offset:50176
  s_waitcnt lgkmcnt(0)
  s_waitcnt vmcnt(40)
  buffer_load_dwordx4 v[96:99], v4, s[16:19], s47 offen sc1
  buffer_load_dwordx2 v[100:101], v5, s[16:19], s47 offen offset:2048 sc1
  buffer_load_dwordx4 v[136:139], v21, s[16:19], s47 offen offset:1024 sc1
  s_add_u32 s47, s47, 2560
  buffer_load_dwordx4 v[104:107], v4, s[16:19], s47 offen sc1
  buffer_load_dwordx2 v[108:109], v5, s[16:19], s47 offen offset:2048 sc1
  s_add_u32 s47, s47, 13824
  buffer_load_dwordx4 v[112:115], v4, s[16:19], s47 offen sc1
  buffer_load_dwordx2 v[116:117], v5, s[16:19], s47 offen offset:2048 sc1
  buffer_load_dwordx4 v[140:143], v21, s[16:19], s47 offen offset:1024 sc1
  s_add_u32 s47, s47, 2560
  buffer_load_dwordx4 v[120:123], v4, s[16:19], s47 offen sc1
  buffer_load_dwordx2 v[124:125], v5, s[16:19], s47 offen offset:2048 sc1
  s_add_u32 s47, s47, 13824
  s_add_u32 s21, s48, 16384
  buffer_load_dwordx4 v[48:51], v22, s[16:19], s48 offen offset:0 sc1
  buffer_load_dwordx4 v[56:59], v22, s[16:19], s21 offen offset:0 sc1
  buffer_load_dwordx2 v[188:189], v14, s[16:19], s48 offen offset:512 sc1
  buffer_load_dwordx4 v[52:55], v22, s[16:19], s48 offen offset:1280 sc1
  buffer_load_dwordx4 v[60:63], v22, s[16:19], s21 offen offset:1280 sc1
  buffer_load_dwordx2 v[190:191], v14, s[16:19], s48 offen offset:1792 sc1
  s_add_u32 s48, s48, 262144
  s_barrier
  ds_read_b128 v[192:195], v15 offset:0
  ds_read_b128 v[196:199], v15 offset:10240
  ds_read_b128 v[200:203], v15 offset:20480
  ds_read_b128 v[204:207], v15 offset:30720
  ds_read_b128 v[208:211], v15 offset:2048
  ds_read_b128 v[212:215], v15 offset:12288
  ds_read_b128 v[216:219], v15 offset:22528
  ds_read_b128 v[220:223], v15 offset:32768
  ds_read_b128 v[224:227], v16 offset:0
  ds_read_b128 v[228:231], v16 offset:10240
  ds_read_b128 v[232:235], v16 offset:20480
  ds_read_b128 v[236:239], v16 offset:30720
  v_sub_f32 v25, 1.0, v24
  v_cvt_pk_bf16_f32 v26, v25, v25
  v_lshlrev_b32 v25, 16, v26
  s_waitcnt lgkmcnt(8)
  v_pk_add_f32 v[192:193], v[192:193], v[196:197]
  v_pk_add_f32 v[200:201], v[200:201], v[204:205]
  v_pk_add_f32 v[194:195], v[194:195], v[198:199]
  v_pk_add_f32 v[202:203], v[202:203], v[206:207]
  v_pk_add_f32 v[240:241], v[192:193], v[200:201]
  v_cvt_pk_bf16_f32 v26, v240, v241
  v_lshlrev_b32 v240, 16, v26
  v_and_b32 v241, 0xffff0000, v26
  v_mul_f32 v240, v240, v25
  v_mul_f32 v241, v241, v25
  v_cvt_pk_bf16_f32 v26, v240, v241
  v_lshlrev_b32 v240, 16, v26
  v_and_b32 v241, 0xffff0000, v26
  v_pk_add_f32 v[242:243], v[194:195], v[202:203]
  v_cvt_pk_bf16_f32 v26, v242, v243
  v_lshlrev_b32 v242, 16, v26
  v_and_b32 v243, 0xffff0000, v26
  v_mul_f32 v242, v242, v25
  v_mul_f32 v243, v243, v25
  v_cvt_pk_bf16_f32 v26, v242, v243
  v_lshlrev_b32 v242, 16, v26
  v_and_b32 v243, 0xffff0000, v26
  s_waitcnt lgkmcnt(4)
  v_pk_add_f32 v[208:209], v[208:209], v[212:213]
  v_pk_add_f32 v[216:217], v[216:217], v[220:221]
  v_pk_add_f32 v[210:211], v[210:211], v[214:215]
  v_pk_add_f32 v[218:219], v[218:219], v[222:223]
  v_pk_add_f32 v[244:245], v[208:209], v[216:217]
  v_cvt_pk_bf16_f32 v26, v244, v245
  v_lshlrev_b32 v244, 16, v26
  v_and_b32 v245, 0xffff0000, v26
  v_mul_f32 v244, v244, v25
  v_mul_f32 v245, v245, v25
  v_cvt_pk_bf16_f32 v26, v244, v245
  v_lshlrev_b32 v244, 16, v26
  v_and_b32 v245, 0xffff0000, v26
  v_pk_add_f32 v[246:247], v[210:211], v[218:219]
  v_cvt_pk_bf16_f32 v26, v246, v247
  v_lshlrev_b32 v246, 16, v26
  v_and_b32 v247, 0xffff0000, v26
  v_mul_f32 v246, v246, v25
  v_mul_f32 v247, v247, v25
  v_cvt_pk_bf16_f32 v26, v246, v247
  v_lshlrev_b32 v246, 16, v26
  v_and_b32 v247, 0xffff0000, v26
  s_waitcnt lgkmcnt(0)
  v_pk_add_f32 v[224:225], v[224:225], v[228:229]
  v_pk_add_f32 v[232:233], v[232:233], v[236:237]
  v_pk_add_f32 v[226:227], v[226:227], v[230:231]
  v_pk_add_f32 v[234:235], v[234:235], v[238:239]
  v_pk_add_f32 v[248:249], v[224:225], v[232:233]
  v_cvt_pk_bf16_f32 v26, v248, v249
  v_lshlrev_b32 v248, 16, v26
  v_and_b32 v249, 0xffff0000, v26
  v_mul_f32 v248, v248, v25
  v_mul_f32 v249, v249, v25
  v_cvt_pk_bf16_f32 v26, v248, v249
  v_lshlrev_b32 v248, 16, v26
  v_and_b32 v249, 0xffff0000, v26
  v_pk_add_f32 v[250:251], v[226:227], v[234:235]
  v_cvt_pk_bf16_f32 v26, v250, v251
  v_lshlrev_b32 v250, 16, v26
  v_and_b32 v251, 0xffff0000, v26
  v_mul_f32 v250, v250, v25
  v_mul_f32 v251, v251, v25
  v_cvt_pk_bf16_f32 v26, v250, v251
  v_lshlrev_b32 v250, 16, v26
  v_and_b32 v251, 0xffff0000, v26
  s_barrier
  s_branch pvg_235
pvw_231:
  v_mfma_f32_16x16x32_bf16 v[144:147], a[160:163], v[192:195], 0
  v_mfma_f32_16x16x32_bf16 v[148:151], a[160:163], v[212:215], 0
  v_mfma_f32_16x16x32_bf16 v[152:155], a[164:167], v[192:195], 0
  v_mfma_f32_16x16x32_bf16 v[156:159], a[164:167], v[212:215], 0
  v_mfma_f32_16x16x32_bf16 v[160:163], a[168:171], v[192:195], 0
  v_mfma_f32_16x16x32_bf16 v[164:167], a[168:171], v[212:215], 0
  v_mfma_f32_16x16x32_bf16 v[168:171], a[172:175], v[192:195], 0
  v_mfma_f32_16x16x32_bf16 v[172:175], a[172:175], v[212:215], 0
  v_mfma_f32_16x16x32_bf16 v[176:179], a[176:179], v[192:195], 0
  v_mfma_f32_16x16x32_bf16 v[180:183], a[176:179], v[212:215], 0
  v_mfma_f32_16x16x32_bf16 v[144:147], a[180:183], v[196:199], v[144:147]
  v_mfma_f32_16x16x32_bf16 v[148:151], a[180:183], v[216:219], v[148:151]
  v_mfma_f32_16x16x32_bf16 v[152:155], a[184:187], v[196:199], v[152:155]
  v_mfma_f32_16x16x32_bf16 v[156:159], a[184:187], v[216:219], v[156:159]
  v_mfma_f32_16x16x32_bf16 v[160:163], a[188:191], v[196:199], v[160:163]
  v_mfma_f32_16x16x32_bf16 v[164:167], a[188:191], v[216:219], v[164:167]
  v_mfma_f32_16x16x32_bf16 v[168:171], a[192:195], v[196:199], v[168:171]
  v_mfma_f32_16x16x32_bf16 v[172:175], a[192:195], v[216:219], v[172:175]
  v_mfma_f32_16x16x32_bf16 v[176:179], a[196:199], v[196:199], v[176:179]
  v_mfma_f32_16x16x32_bf16 v[180:183], a[196:199], v[216:219], v[180:183]
  v_mfma_f32_16x16x32_bf16 v[144:147], a[200:203], v[200:203], v[144:147]
  v_mfma_f32_16x16x32_bf16 v[148:151], a[200:203], v[220:223], v[148:151]
  v_mfma_f32_16x16x32_bf16 v[152:155], a[204:207], v[200:203], v[152:155]
  v_mfma_f32_16x16x32_bf16 v[156:159], a[204:207], v[220:223], v[156:159]
  v_mfma_f32_16x16x32_bf16 v[160:163], a[208:211], v[200:203], v[160:163]
  v_mfma_f32_16x16x32_bf16 v[164:167], a[208:211], v[220:223], v[164:167]
  v_mfma_f32_16x16x32_bf16 v[168:171], a[212:215], v[200:203], v[168:171]
  v_mfma_f32_16x16x32_bf16 v[172:175], a[212:215], v[220:223], v[172:175]
  v_mfma_f32_16x16x32_bf16 v[176:179], a[216:219], v[200:203], v[176:179]
  v_mfma_f32_16x16x32_bf16 v[180:183], a[216:219], v[220:223], v[180:183]
  v_mfma_f32_16x16x32_bf16 v[144:147], a[220:223], v[204:207], v[144:147]
  v_mfma_f32_16x16x32_bf16 v[148:151], a[220:223], v[224:227], v[148:151]
  v_mfma_f32_16x16x32_bf16 v[152:155], a[224:227], v[204:207], v[152:155]
  v_mfma_f32_16x16x32_bf16 v[156:159], a[224:227], v[224:227], v[156:159]
  v_mfma_f32_16x16x32_bf16 v[160:163], a[228:231], v[204:207], v[160:163]
  v_mfma_f32_16x16x32_bf16 v[164:167], a[228:231], v[224:227], v[164:167]
  v_mfma_f32_16x16x32_bf16 v[168:171], a[232:235], v[204:207], v[168:171]
  v_mfma_f32_16x16x32_bf16 v[172:175], a[232:235], v[224:227], v[172:175]
  v_mfma_f32_16x16x32_bf16 v[176:179], a[236:239], v[204:207], v[176:179]
  v_mfma_f32_16x16x32_bf16 v[180:183], a[236:239], v[224:227], v[180:183]
  v_mfma_f32_16x16x32_bf16 v[144:147], a[240:243], v[208:211], v[144:147]
  v_mfma_f32_16x16x32_bf16 v[148:151], a[240:243], v[228:231], v[148:151]
  v_mfma_f32_16x16x32_bf16 v[152:155], a[244:247], v[208:211], v[152:155]
  v_mfma_f32_16x16x32_bf16 v[156:159], a[244:247], v[228:231], v[156:159]
  v_mfma_f32_16x16x32_bf16 v[160:163], a[248:251], v[208:211], v[160:163]
  v_mfma_f32_16x16x32_bf16 v[164:167], a[248:251], v[228:231], v[164:167]
  v_mfma_f32_16x16x32_bf16 v[168:171], a[252:255], v[208:211], v[168:171]
  v_mfma_f32_16x16x32_bf16 v[172:175], a[252:255], v[228:231], v[172:175]
  v_mfma_f32_16x16x32_bf16 v[176:179], v[252:255], v[208:211], v[176:179]
  v_mfma_f32_16x16x32_bf16 v[180:183], v[252:255], v[228:231], v[180:183]
  ds_write_b128 v10, v[144:147] offset:40960
  ds_write_b128 v10, v[148:151] offset:41984
  ds_write_b128 v10, v[152:155] offset:43008
  ds_write_b128 v10, v[156:159] offset:44032
  ds_write_b128 v10, v[160:163] offset:45056
  ds_write_b128 v10, v[164:167] offset:46080
  ds_write_b128 v10, v[168:171] offset:47104
  ds_write_b128 v10, v[172:175] offset:48128
  s_nop 1
  ds_write_b128 v10, v[176:179] offset:49152
  ds_write_b128 v10, v[180:183] offset:50176
  s_waitcnt lgkmcnt(0)
  s_barrier
  ds_read_b128 v[192:195], v15 offset:0
  ds_read_b128 v[196:199], v15 offset:10240
  ds_read_b128 v[200:203], v15 offset:20480
  ds_read_b128 v[204:207], v15 offset:30720
  ds_read_b128 v[208:211], v15 offset:2048
  ds_read_b128 v[212:215], v15 offset:12288
  ds_read_b128 v[216:219], v15 offset:22528
  ds_read_b128 v[220:223], v15 offset:32768
  ds_read_b128 v[224:227], v16 offset:0
  ds_read_b128 v[228:231], v16 offset:10240
  ds_read_b128 v[232:235], v16 offset:20480
  ds_read_b128 v[236:239], v16 offset:30720
  v_sub_f32 v25, 1.0, v24
  v_cvt_pk_bf16_f32 v26, v25, v25
  v_lshlrev_b32 v25, 16, v26
  s_waitcnt lgkmcnt(8)
  v_pk_add_f32 v[192:193], v[192:193], v[196:197]
  v_pk_add_f32 v[200:201], v[200:201], v[204:205]
  v_pk_add_f32 v[194:195], v[194:195], v[198:199]
  v_pk_add_f32 v[202:203], v[202:203], v[206:207]
  v_pk_add_f32 v[240:241], v[192:193], v[200:201]
  v_cvt_pk_bf16_f32 v26, v240, v241
  v_lshlrev_b32 v240, 16, v26
  v_and_b32 v241, 0xffff0000, v26
  v_mul_f32 v240, v240, v25
  v_mul_f32 v241, v241, v25
  v_cvt_pk_bf16_f32 v26, v240, v241
  v_lshlrev_b32 v240, 16, v26
  v_and_b32 v241, 0xffff0000, v26
  v_pk_add_f32 v[242:243], v[194:195], v[202:203]
  v_cvt_pk_bf16_f32 v26, v242, v243
  v_lshlrev_b32 v242, 16, v26
  v_and_b32 v243, 0xffff0000, v26
  v_mul_f32 v242, v242, v25
  v_mul_f32 v243, v243, v25
  v_cvt_pk_bf16_f32 v26, v242, v243
  v_lshlrev_b32 v242, 16, v26
  v_and_b32 v243, 0xffff0000, v26
  s_waitcnt lgkmcnt(4)
  v_pk_add_f32 v[208:209], v[208:209], v[212:213]
  v_pk_add_f32 v[216:217], v[216:217], v[220:221]
  v_pk_add_f32 v[210:211], v[210:211], v[214:215]
  v_pk_add_f32 v[218:219], v[218:219], v[222:223]
  v_pk_add_f32 v[244:245], v[208:209], v[216:217]
  v_cvt_pk_bf16_f32 v26, v244, v245
  v_lshlrev_b32 v244, 16, v26
  v_and_b32 v245, 0xffff0000, v26
  v_mul_f32 v244, v244, v25
  v_mul_f32 v245, v245, v25
  v_cvt_pk_bf16_f32 v26, v244, v245
  v_lshlrev_b32 v244, 16, v26
  v_and_b32 v245, 0xffff0000, v26
  v_pk_add_f32 v[246:247], v[210:211], v[218:219]
  v_cvt_pk_bf16_f32 v26, v246, v247
  v_lshlrev_b32 v246, 16, v26
  v_and_b32 v247, 0xffff0000, v26
  v_mul_f32 v246, v246, v25
  v_mul_f32 v247, v247, v25
  v_cvt_pk_bf16_f32 v26, v246, v247
  v_lshlrev_b32 v246, 16, v26
  v_and_b32 v247, 0xffff0000, v26
  s_waitcnt lgkmcnt(0)
  v_pk_add_f32 v[224:225], v[224:225], v[228:229]
  v_pk_add_f32 v[232:233], v[232:233], v[236:237]
  v_pk_add_f32 v[226:227], v[226:227], v[230:231]
  v_pk_add_f32 v[234:235], v[234:235], v[238:239]
  v_pk_add_f32 v[248:249], v[224:225], v[232:233]
  v_cvt_pk_bf16_f32 v26, v248, v249
  v_lshlrev_b32 v248, 16, v26
  v_and_b32 v249, 0xffff0000, v26
  v_mul_f32 v248, v248, v25
  v_mul_f32 v249, v249, v25
  v_cvt_pk_bf16_f32 v26, v248, v249
  v_lshlrev_b32 v248, 16, v26
  v_and_b32 v249, 0xffff0000, v26
  v_pk_add_f32 v[250:251], v[226:227], v[234:235]
  v_cvt_pk_bf16_f32 v26, v250, v251
  v_lshlrev_b32 v250, 16, v26
  v_and_b32 v251, 0xffff0000, v26
  v_mul_f32 v250, v250, v25
  v_mul_f32 v251, v251, v25
  v_cvt_pk_bf16_f32 v26, v250, v251
  v_lshlrev_b32 v250, 16, v26
  v_and_b32 v251, 0xffff0000, v26
  s_cmp_ge_u32 s40, 56
  s_cbranch_scc1 pvt_236
  s_cmp_lg_u32 s20, 0
  s_cbranch_scc1 wr_238
  s_mov_b32 s101, 0
wr_237:
  buffer_load_dword v26, v18, s[72:75], 0 offen sc1
  s_add_u32 s101, s101, 1
  s_cmp_gt_u32 s101, 131072
  s_cbranch_scc1 main_end
  s_waitcnt vmcnt(0)
  v_cmp_gt_u32 vcc, v19, v26
  v_readfirstlane_b32 s100, v26
  s_nop 0
  s_cbranch_vccz wr_238
  s_sleep 2
  s_cmp_lg_u32 s100, 0
  s_cbranch_scc1 wr_237
  s_sleep 24
  s_branch wr_237
wr_238:
  s_barrier
  buffer_load_dwordx4 v[64:67], v4, s[16:19], s47 offen sc1
  buffer_load_dwordx2 v[68:69], v5, s[16:19], s47 offen offset:2048 sc1
  buffer_load_dwordx4 v[128:131], v21, s[16:19], s47 offen offset:1024 sc1
  s_add_u32 s47, s47, 2560
  buffer_load_dwordx4 v[72:75], v4, s[16:19], s47 offen sc1
  buffer_load_dwordx2 v[76:77], v5, s[16:19], s47 offen offset:2048 sc1
  s_add_u32 s47, s47, 13824
  buffer_load_dwordx4 v[80:83], v4, s[16:19], s47 offen sc1
  buffer_load_dwordx2 v[84:85], v5, s[16:19], s47 offen offset:2048 sc1
  buffer_load_dwordx4 v[132:135], v21, s[16:19], s47 offen offset:1024 sc1
  s_add_u32 s47, s47, 2560
  buffer_load_dwordx4 v[88:91], v4, s[16:19], s47 offen sc1
  buffer_load_dwordx2 v[92:93], v5, s[16:19], s47 offen offset:2048 sc1
  s_add_u32 s47, s47, 13824
  s_add_u32 s21, s48, 16384
  buffer_load_dwordx4 v[32:35], v22, s[16:19], s48 offen offset:0 sc1
  buffer_load_dwordx4 v[40:43], v22, s[16:19], s21 offen offset:0 sc1
  buffer_load_dwordx2 v[184:185], v14, s[16:19], s48 offen offset:512 sc1
  buffer_load_dwordx4 v[36:39], v22, s[16:19], s48 offen offset:1280 sc1
  buffer_load_dwordx4 v[44:47], v22, s[16:19], s21 offen offset:1280 sc1
  buffer_load_dwordx2 v[186:187], v14, s[16:19], s48 offen offset:1792 sc1
  s_add_u32 s48, s48, 262144
  s_waitcnt vmcnt(40)
  buffer_load_dwordx4 v[96:99], v4, s[16:19], s47 offen sc1
  buffer_load_dwordx2 v[100:101], v5, s[16:19], s47 offen offset:2048 sc1
  buffer_load_dwordx4 v[136:139], v21, s[16:19], s47 offen offset:1024 sc1
  s_add_u32 s47, s47, 2560
  buffer_load_dwordx4 v[104:107], v4, s[16:19], s47 offen sc1
  buffer_load_dwordx2 v[108:109], v5, s[16:19], s47 offen offset:2048 sc1
  s_add_u32 s47, s47, 13824
  buffer_load_dwordx4 v[112:115], v4, s[16:19], s47 offen sc1
  buffer_load_dwordx2 v[116:117], v5, s[16:19], s47 offen offset:2048 sc1
  buffer_load_dwordx4 v[140:143], v21, s[16:19], s47 offen offset:1024 sc1
  s_add_u32 s47, s47, 2560
  buffer_load_dwordx4 v[120:123], v4, s[16:19], s47 offen sc1
  buffer_load_dwordx2 v[124:125], v5, s[16:19], s47 offen offset:2048 sc1
  s_add_u32 s47, s47, 13824
  s_add_u32 s21, s48, 16384
  buffer_load_dwordx4 v[48:51], v22, s[16:19], s48 offen offset:0 sc1
  buffer_load_dwordx4 v[56:59], v22, s[16:19], s21 offen offset:0 sc1
  buffer_load_dwordx2 v[188:189], v14, s[16:19], s48 offen offset:512 sc1
  buffer_load_dwordx4 v[52:55], v22, s[16:19], s48 offen offset:1280 sc1
  buffer_load_dwordx4 v[60:63], v22, s[16:19], s21 offen offset:1280 sc1
  buffer_load_dwordx2 v[190:191], v14, s[16:19], s48 offen offset:1792 sc1
  s_add_u32 s48, s48, 262144
pvg_235:
  s_waitcnt vmcnt(30)
  v_mfma_f32_16x16x32_bf16 v[148:151], a[0:3], v[64:67], 0
  v_mfma_f32_16x16x32_bf16 v[144:147], a[0:3], v[68:71], 0
  v_mfma_f32_16x16x32_bf16 v[156:159], a[4:7], v[64:67], 0
  v_mfma_f32_16x16x32_bf16 v[152:155], a[4:7], v[68:71], 0
  v_mfma_f32_16x16x32_bf16 v[164:167], a[8:11], v[64:67], 0
  v_mfma_f32_16x16x32_bf16 v[160:163], a[8:11], v[68:71], 0
  v_mfma_f32_16x16x32_bf16 v[172:175], a[12:15], v[64:67], 0
  v_mfma_f32_16x16x32_bf16 v[168:171], a[12:15], v[68:71], 0
  v_mfma_f32_16x16x32_bf16 v[180:183], a[16:19], v[64:67], 0
  v_mfma_f32_16x16x32_bf16 v[176:179], a[16:19], v[68:71], 0
  s_waitcnt vmcnt(27)
  v_mfma_f32_16x16x32_bf16 v[148:151], a[20:23], v[72:75], v[148:151]
  v_mfma_f32_16x16x32_bf16 v[144:147], a[20:23], v[76:79], v[144:147]
  v_mfma_f32_16x16x32_bf16 v[156:159], a[24:27], v[72:75], v[156:159]
  v_mfma_f32_16x16x32_bf16 v[152:155], a[24:27], v[76:79], v[152:155]
  v_mfma_f32_16x16x32_bf16 v[164:167], a[28:31], v[72:75], v[164:167]
  v_mfma_f32_16x16x32_bf16 v[160:163], a[28:31], v[76:79], v[160:163]
  v_mfma_f32_16x16x32_bf16 v[172:175], a[32:35], v[72:75], v[172:175]
  v_mfma_f32_16x16x32_bf16 v[168:171], a[32:35], v[76:79], v[168:171]
  v_mfma_f32_16x16x32_bf16 v[180:183], a[36:39], v[72:75], v[180:183]
  v_mfma_f32_16x16x32_bf16 v[176:179], a[36:39], v[76:79], v[176:179]
  s_waitcnt vmcnt(25)
  v_mfma_f32_16x16x32_bf16 v[148:151], a[40:43], v[80:83], v[148:151]
  v_mfma_f32_16x16x32_bf16 v[144:147], a[40:43], v[84:87], v[144:147]
  v_mfma_f32_16x16x32_bf16 v[156:159], a[44:47], v[80:83], v[156:159]
  v_mfma_f32_16x16x32_bf16 v[152:155], a[44:47], v[84:87], v[152:155]
  v_mfma_f32_16x16x32_bf16 v[164:167], a[48:51], v[80:83], v[164:167]
  v_mfma_f32_16x16x32_bf16 v[160:163], a[48:51], v[84:87], v[160:163]
  v_mfma_f32_16x16x32_bf16 v[172:175], a[52:55], v[80:83], v[172:175]
  v_mfma_f32_16x16x32_bf16 v[168:171], a[52:55], v[84:87], v[168:171]
  v_mfma_f32_16x16x32_bf16 v[180:183], a[56:59], v[80:83], v[180:183]
  v_mfma_f32_16x16x32_bf16 v[176:179], a[56:59], v[84:87], v[176:179]
  s_waitcnt vmcnt(22)
  v_mfma_f32_16x16x32_bf16 v[148:151], a[60:63], v[88:91], v[148:151]
  v_mfma_f32_16x16x32_bf16 v[144:147], a[60:63], v[92:95], v[144:147]
  v_mfma_f32_16x16x32_bf16 v[156:159], a[64:67], v[88:91], v[156:159]
  v_mfma_f32_16x16x32_bf16 v[152:155], a[64:67], v[92:95], v[152:155]
  v_mfma_f32_16x16x32_bf16 v[164:167], a[68:71], v[88:91], v[164:167]
  v_mfma_f32_16x16x32_bf16 v[160:163], a[68:71], v[92:95], v[160:163]
  v_mfma_f32_16x16x32_bf16 v[172:175], a[72:75], v[88:91], v[172:175]
  v_mfma_f32_16x16x32_bf16 v[168:171], a[72:75], v[92:95], v[168:171]
  v_mfma_f32_16x16x32_bf16 v[180:183], a[76:79], v[88:91], v[180:183]
  v_mfma_f32_16x16x32_bf16 v[176:179], a[76:79], v[92:95], v[176:179]
  s_waitcnt vmcnt(16)
  v_swap_b32 v130, v132
  v_swap_b32 v131, v133
  v_swap_b32 v34, v36
  v_swap_b32 v35, v37
  v_swap_b32 v42, v44
  v_swap_b32 v43, v45
  s_nop 1
  v_mfma_f32_16x16x32_bf16 v[144:147], v[32:35], v[128:131], v[144:147]
  v_mfma_f32_16x16x32_bf16 v[148:151], v[32:35], v[132:135], v[148:151]
  v_mfma_f32_16x16x32_bf16 v[152:155], v[36:39], v[128:131], v[152:155]
  v_mfma_f32_16x16x32_bf16 v[156:159], v[36:39], v[132:135], v[156:159]
  v_mfma_f32_16x16x32_bf16 v[160:163], v[184:187], v[128:131], v[160:163]
  v_mfma_f32_16x16x32_bf16 v[164:167], v[184:187], v[132:135], v[164:167]
  v_mfma_f32_16x16x32_bf16 v[168:171], v[40:43], v[128:131], v[168:171]
  v_mfma_f32_16x16x32_bf16 v[172:175], v[40:43], v[132:135], v[172:175]
  v_mfma_f32_16x16x32_bf16 v[176:179], v[44:47], v[128:131], v[176:179]
  v_mfma_f32_16x16x32_bf16 v[180:183], v[44:47], v[132:135], v[180:183]
  s_waitcnt vmcnt(14)
  v_mfma_f32_16x16x32_bf16 v[148:151], a[80:83], v[96:99], v[148:151]
  v_mfma_f32_16x16x32_bf16 v[144:147], a[80:83], v[100:103], v[144:147]
  v_mfma_f32_16x16x32_bf16 v[156:159], a[84:87], v[96:99], v[156:159]
  v_mfma_f32_16x16x32_bf16 v[152:155], a[84:87], v[100:103], v[152:155]
  v_mfma_f32_16x16x32_bf16 v[164:167], a[88:91], v[96:99], v[164:167]
  v_mfma_f32_16x16x32_bf16 v[160:163], a[88:91], v[100:103], v[160:163]
  v_mfma_f32_16x16x32_bf16 v[172:175], a[92:95], v[96:99], v[172:175]
  v_mfma_f32_16x16x32_bf16 v[168:171], a[92:95], v[100:103], v[168:171]
  v_mfma_f32_16x16x32_bf16 v[180:183], a[96:99], v[96:99], v[180:183]
  v_mfma_f32_16x16x32_bf16 v[176:179], a[96:99], v[100:103], v[176:179]
  s_waitcnt vmcnt(11)
  v_mfma_f32_16x16x32_bf16 v[148:151], a[100:103], v[104:107], v[148:151]
  v_mfma_f32_16x16x32_bf16 v[144:147], a[100:103], v[108:111], v[144:147]
  v_mfma_f32_16x16x32_bf16 v[156:159], a[104:107], v[104:107], v[156:159]
  v_mfma_f32_16x16x32_bf16 v[152:155], a[104:107], v[108:111], v[152:155]
  v_mfma_f32_16x16x32_bf16 v[164:167], a[108:111], v[104:107], v[164:167]
  v_mfma_f32_16x16x32_bf16 v[160:163], a[108:111], v[108:111], v[160:163]
  v_mfma_f32_16x16x32_bf16 v[172:175], a[112:115], v[104:107], v[172:175]
  v_mfma_f32_16x16x32_bf16 v[168:171], a[112:115], v[108:111], v[168:171]
  v_mfma_f32_16x16x32_bf16 v[180:183], a[116:119], v[104:107], v[180:183]
  v_mfma_f32_16x16x32_bf16 v[176:179], a[116:119], v[108:111], v[176:179]
  s_waitcnt vmcnt(9)
  v_mfma_f32_16x16x32_bf16 v[148:151], a[120:123], v[112:115], v[148:151]
  v_mfma_f32_16x16x32_bf16 v[144:147], a[120:123], v[116:119], v[144:147]
  v_mfma_f32_16x16x32_bf16 v[156:159], a[124:127], v[112:115], v[156:159]
  v_mfma_f32_16x16x32_bf16 v[152:155], a[124:127], v[116:119], v[152:155]
  v_mfma_f32_16x16x32_bf16 v[164:167], a[128:131], v[112:115], v[164:167]
  v_mfma_f32_16x16x32_bf16 v[160:163], a[128:131], v[116:119], v[160:163]
  v_mfma_f32_16x16x32_bf16 v[172:175], a[132:135], v[112:115], v[172:175]
  v_mfma_f32_16x16x32_bf16 v[168:171], a[132:135], v[116:119], v[168:171]
  v_mfma_f32_16x16x32_bf16 v[180:183], a[136:139], v[112:115], v[180:183]
  v_mfma_f32_16x16x32_bf16 v[176:179], a[136:139], v[116:119], v[176:179]
  s_waitcnt vmcnt(6)
  v_mfma_f32_16x16x32_bf16 v[148:151], a[140:143], v[120:123], v[148:151]
  v_mfma_f32_16x16x32_bf16 v[144:147], a[140:143], v[124:127], v[144:147]
  v_mfma_f32_16x16x32_bf16 v[156:159], a[144:147], v[120:123], v[156:159]
  v_mfma_f32_16x16x32_bf16 v[152:155], a[144:147], v[124:127], v[152:155]
  v_mfma_f32_16x16x32_bf16 v[164:167], a[148:151], v[120:123], v[164:167]
  v_mfma_f32_16x16x32_bf16 v[160:163], a[148:151], v[124:127], v[160:163]
  v_mfma_f32_16x16x32_bf16 v[172:175], a[152:155], v[120:123], v[172:175]
  v_mfma_f32_16x16x32_bf16 v[168:171], a[152:155], v[124:127], v[168:171]
  v_mfma_f32_16x16x32_bf16 v[180:183], a[156:159], v[120:123], v[180:183]
  v_mfma_f32_16x16x32_bf16 v[176:179], a[156:159], v[124:127], v[176:179]
  s_waitcnt vmcnt(0)
  v_swap_b32 v138, v140
  v_swap_b32 v139, v141
  v_swap_b32 v50, v52
  v_swap_b32 v51, v53
  v_swap_b32 v58, v60
  v_swap_b32 v59, v61
  s_nop 1
  v_mfma_f32_16x16x32_bf16 v[144:147], v[48:51], v[136:139], v[144:147]
  v_mfma_f32_16x16x32_bf16 v[148:151], v[48:51], v[140:143], v[148:151]
  v_mfma_f32_16x16x32_bf16 v[152:155], v[52:55], v[136:139], v[152:155]
  v_mfma_f32_16x16x32_bf16 v[156:159], v[52:55], v[140:143], v[156:159]
  v_mfma_f32_16x16x32_bf16 v[160:163], v[188:191], v[136:139], v[160:163]
  v_mfma_f32_16x16x32_bf16 v[164:167], v[188:191], v[140:143], v[164:167]
  v_mfma_f32_16x16x32_bf16 v[168:171], v[56:59], v[136:139], v[168:171]
  v_mfma_f32_16x16x32_bf16 v[172:175], v[56:59], v[140:143], v[172:175]
  v_mfma_f32_16x16x32_bf16 v[176:179], v[60:63], v[136:139], v[176:179]
  v_mfma_f32_16x16x32_bf16 v[180:183], v[60:63], v[140:143], v[180:183]
  s_branch pve_232
pvt_236:
  s_sub_u32 s56, s40, 1
  s_lshl_b32 s21, s56, 10
  s_add_u32 s21, s21, 22528
  v_add_u32 v18, s21, v7
  v_add_u32 v19, s52, v17
  v_cndmask_b32 v18, v19, v18, s[66:67]
  s_add_u32 s21, s56, 1
  v_mov_b32 v19, s21
  v_cndmask_b32 v19, v19, 4, s[66:67]
  v_add_u32 v26, -1, v19
  v_cndmask_b32 v19, v26, v19, s[66:67]
  s_cmp_lg_u32 s20, 0
  s_cbranch_scc1 wr_240
  s_mov_b32 s101, 0
wr_239:
  buffer_load_dword v26, v18, s[72:75], 0 offen sc1
  s_add_u32 s101, s101, 1
  s_cmp_gt_u32 s101, 131072
  s_cbranch_scc1 main_end
  s_waitcnt vmcnt(0)
  v_cmp_gt_u32 vcc, v19, v26
  v_readfirstlane_b32 s100, v26
  s_nop 0
  s_cbranch_vccz wr_240
  s_sleep 4
  s_cmp_lg_u32 s100, 0
  s_cbranch_scc1 wr_239
  s_sleep 24
  s_branch wr_239
wr_240:
  s_barrier
  s_mov_b32 s56, s47
  s_mov_b32 s57, s48
  s_waitcnt vmcnt(20)
  buffer_load_dwordx4 v[64:67], v4, s[16:19], s56 offen sc1
  buffer_load_dwordx2 v[68:69], v5, s[16:19], s56 offen offset:2048 sc1
  buffer_load_dwordx4 v[128:131], v21, s[16:19], s56 offen offset:1024 sc1
  s_add_u32 s56, s56, 2560
  buffer_load_dwordx4 v[72:75], v4, s[16:19], s56 offen sc1
  buffer_load_dwordx2 v[76:77], v5, s[16:19], s56 offen offset:2048 sc1
  s_add_u32 s56, s56, 13824
  buffer_load_dwordx4 v[80:83], v4, s[16:19], s56 offen sc1
  buffer_load_dwordx2 v[84:85], v5, s[16:19], s56 offen offset:2048 sc1
  buffer_load_dwordx4 v[132:135], v21, s[16:19], s56 offen offset:1024 sc1
  s_add_u32 s56, s56, 2560
  buffer_load_dwordx4 v[88:91], v4, s[16:19], s56 offen sc1
  buffer_load_dwordx2 v[92:93], v5, s[16:19], s56 offen offset:2048 sc1
  s_add_u32 s56, s56, 13824
  s_add_u32 s21, s57, 16384
  buffer_load_dwordx4 v[32:35], v22, s[16:19], s57 offen offset:0 sc1
  buffer_load_dwordx4 v[40:43], v22, s[16:19], s21 offen offset:0 sc1
  buffer_load_dwordx2 v[184:185], v14, s[16:19], s57 offen offset:512 sc1
  buffer_load_dwordx4 v[36:39], v22, s[16:19], s57 offen offset:1280 sc1
  buffer_load_dwordx4 v[44:47], v22, s[16:19], s21 offen offset:1280 sc1
  buffer_load_dwordx2 v[186:187], v14, s[16:19], s57 offen offset:1792 sc1
  s_add_u32 s57, s57, 262144
  buffer_load_dwordx4 v[96:99], v4, s[16:19], s56 offen sc1
  buffer_load_dwordx2 v[100:101], v5, s[16:19], s56 offen offset:2048 sc1
  buffer_load_dwordx4 v[136:139], v21, s[16:19], s56 offen offset:1024 sc1
  s_add_u32 s56, s56, 2560
  buffer_load_dwordx4 v[104:107], v4, s[16:19], s56 offen sc1
  buffer_load_dwordx2 v[108:109], v5, s[16:19], s56 offen offset:2048 sc1
  s_add_u32 s56, s56, 13824
  buffer_load_dwordx4 v[112:115], v4, s[16:19], s56 offen sc1
  buffer_load_dwordx2 v[116:117], v5, s[16:19], s56 offen offset:2048 sc1
  buffer_load_dwordx4 v[140:143], v21, s[16:19], s56 offen offset:1024 sc1
  s_add_u32 s56, s56, 2560
  buffer_load_dwordx4 v[120:123], v4, s[16:19], s56 offen sc1
  buffer_load_dwordx2 v[124:125], v5, s[16:19], s56 offen offset:2048 sc1
  s_add_u32 s56, s56, 13824
  s_add_u32 s21, s57, 16384
  buffer_load_dwordx4 v[48:51], v22, s[16:19], s57 offen offset:0 sc1
  buffer_load_dwordx4 v[56:59], v22, s[16:19], s21 offen offset:0 sc1
  buffer_load_dwordx2 v[188:189], v14, s[16:19], s57 offen offset:512 sc1
  buffer_load_dwordx4 v[52:55], v22, s[16:19], s57 offen offset:1280 sc1
  buffer_load_dwordx4 v[60:63], v22, s[16:19], s21 offen offset:1280 sc1
  buffer_load_dwordx2 v[190:191], v14, s[16:19], s57 offen offset:1792 sc1
  s_add_u32 s57, s57, 262144
  s_mov_b32 s101, 0
  s_waitcnt vmcnt(16)
  s_branch pvr_242
pvr_241:
  s_sleep 2
  s_add_u32 s56, s47, 0
  s_add_u32 s57, s48, 0
  buffer_load_dwordx4 v[64:67], v4, s[16:19], s56 offen sc1
  buffer_load_dwordx2 v[68:69], v5, s[16:19], s56 offen offset:2048 sc1
  buffer_load_dwordx4 v[128:131], v21, s[16:19], s56 offen offset:1024 sc1
  s_add_u32 s56, s56, 2560
  buffer_load_dwordx4 v[72:75], v4, s[16:19], s56 offen sc1
  buffer_load_dwordx2 v[76:77], v5, s[16:19], s56 offen offset:2048 sc1
  s_add_u32 s56, s56, 13824
  buffer_load_dwordx4 v[80:83], v4, s[16:19], s56 offen sc1
  buffer_load_dwordx2 v[84:85], v5, s[16:19], s56 offen offset:2048 sc1
  buffer_load_dwordx4 v[132:135], v21, s[16:19], s56 offen offset:1024 sc1
  s_add_u32 s56, s56, 2560
  buffer_load_dwordx4 v[88:91], v4, s[16:19], s56 offen sc1
  buffer_load_dwordx2 v[92:93], v5, s[16:19], s56 offen offset:2048 sc1
  s_add_u32 s56, s56, 13824
  s_add_u32 s21, s57, 16384
  buffer_load_dwordx4 v[32:35], v22, s[16:19], s57 offen offset:0 sc1
  buffer_load_dwordx4 v[40:43], v22, s[16:19], s21 offen offset:0 sc1
  buffer_load_dwordx2 v[184:185], v14, s[16:19], s57 offen offset:512 sc1
  buffer_load_dwordx4 v[36:39], v22, s[16:19], s57 offen offset:1280 sc1
  buffer_load_dwordx4 v[44:47], v22, s[16:19], s21 offen offset:1280 sc1
  buffer_load_dwordx2 v[186:187], v14, s[16:19], s57 offen offset:1792 sc1
  s_add_u32 s57, s57, 262144
  s_add_u32 s101, s101, 1
  s_cmp_gt_u32 s101, 131072
  s_cbranch_scc1 main_end
  s_waitcnt vmcnt(0)
pvr_242:
  v_max3_u32 v26, v64, v68, v72
  v_max3_u32 v26, v26, v76, v80
  v_max3_u32 v26, v26, v84, v88
  v_max3_u32 v26, v26, v92, v128
  v_max3_u32 v26, v26, v132, v32
  v_max3_u32 v26, v26, v36, v40
  v_max3_u32 v26, v26, v44, v184
  v_max3_u32 v26, v26, v186, v186
  v_cmp_eq_u32 vcc, -1, v26
  s_nop 1
  s_cbranch_vccnz pvr_241
  v_mfma_f32_16x16x32_bf16 v[148:151], a[0:3], v[64:67], 0
  v_mfma_f32_16x16x32_bf16 v[144:147], a[0:3], v[68:71], 0
  v_mfma_f32_16x16x32_bf16 v[156:159], a[4:7], v[64:67], 0
  v_mfma_f32_16x16x32_bf16 v[152:155], a[4:7], v[68:71], 0
  v_mfma_f32_16x16x32_bf16 v[164:167], a[8:11], v[64:67], 0
  v_mfma_f32_16x16x32_bf16 v[160:163], a[8:11], v[68:71], 0
  v_mfma_f32_16x16x32_bf16 v[172:175], a[12:15], v[64:67], 0
  v_mfma_f32_16x16x32_bf16 v[168:171], a[12:15], v[68:71], 0
  v_mfma_f32_16x16x32_bf16 v[180:183], a[16:19], v[64:67], 0
  v_mfma_f32_16x16x32_bf16 v[176:179], a[16:19], v[68:71], 0
  v_mfma_f32_16x16x32_bf16 v[148:151], a[20:23], v[72:75], v[148:151]
  v_mfma_f32_16x16x32_bf16 v[144:147], a[20:23], v[76:79], v[144:147]
  v_mfma_f32_16x16x32_bf16 v[156:159], a[24:27], v[72:75], v[156:159]
  v_mfma_f32_16x16x32_bf16 v[152:155], a[24:27], v[76:79], v[152:155]
  v_mfma_f32_16x16x32_bf16 v[164:167], a[28:31], v[72:75], v[164:167]
  v_mfma_f32_16x16x32_bf16 v[160:163], a[28:31], v[76:79], v[160:163]
  v_mfma_f32_16x16x32_bf16 v[172:175], a[32:35], v[72:75], v[172:175]
  v_mfma_f32_16x16x32_bf16 v[168:171], a[32:35], v[76:79], v[168:171]
  v_mfma_f32_16x16x32_bf16 v[180:183], a[36:39], v[72:75], v[180:183]
  v_mfma_f32_16x16x32_bf16 v[176:179], a[36:39], v[76:79], v[176:179]
  v_mfma_f32_16x16x32_bf16 v[148:151], a[40:43], v[80:83], v[148:151]
  v_mfma_f32_16x16x32_bf16 v[144:147], a[40:43], v[84:87], v[144:147]
  v_mfma_f32_16x16x32_bf16 v[156:159], a[44:47], v[80:83], v[156:159]
  v_mfma_f32_16x16x32_bf16 v[152:155], a[44:47], v[84:87], v[152:155]
  v_mfma_f32_16x16x32_bf16 v[164:167], a[48:51], v[80:83], v[164:167]
  v_mfma_f32_16x16x32_bf16 v[160:163], a[48:51], v[84:87], v[160:163]
  v_mfma_f32_16x16x32_bf16 v[172:175], a[52:55], v[80:83], v[172:175]
  v_mfma_f32_16x16x32_bf16 v[168:171], a[52:55], v[84:87], v[168:171]
  v_mfma_f32_16x16x32_bf16 v[180:183], a[56:59], v[80:83], v[180:183]
  v_mfma_f32_16x16x32_bf16 v[176:179], a[56:59], v[84:87], v[176:179]
  v_mfma_f32_16x16x32_bf16 v[148:151], a[60:63], v[88:91], v[148:151]
  v_mfma_f32_16x16x32_bf16 v[144:147], a[60:63], v[92:95], v[144:147]
  v_mfma_f32_16x16x32_bf16 v[156:159], a[64:67], v[88:91], v[156:159]
  v_mfma_f32_16x16x32_bf16 v[152:155], a[64:67], v[92:95], v[152:155]
  v_mfma_f32_16x16x32_bf16 v[164:167], a[68:71], v[88:91], v[164:167]
  v_mfma_f32_16x16x32_bf16 v[160:163], a[68:71], v[92:95], v[160:163]
  v_mfma_f32_16x16x32_bf16 v[172:175], a[72:75], v[88:91], v[172:175]
  v_mfma_f32_16x16x32_bf16 v[168:171], a[72:75], v[92:95], v[168:171]
  v_mfma_f32_16x16x32_bf16 v[180:183], a[76:79], v[88:91], v[180:183]
  v_mfma_f32_16x16x32_bf16 v[176:179], a[76:79], v[92:95], v[176:179]
  v_swap_b32 v130, v132
  v_swap_b32 v131, v133
  v_swap_b32 v34, v36
  v_swap_b32 v35, v37
  v_swap_b32 v42, v44
  v_swap_b32 v43, v45
  s_nop 1
  v_mfma_f32_16x16x32_bf16 v[144:147], v[32:35], v[128:131], v[144:147]
  v_mfma_f32_16x16x32_bf16 v[148:151], v[32:35], v[132:135], v[148:151]
  v_mfma_f32_16x16x32_bf16 v[152:155], v[36:39], v[128:131], v[152:155]
  v_mfma_f32_16x16x32_bf16 v[156:159], v[36:39], v[132:135], v[156:159]
  v_mfma_f32_16x16x32_bf16 v[160:163], v[184:187], v[128:131], v[160:163]
  v_mfma_f32_16x16x32_bf16 v[164:167], v[184:187], v[132:135], v[164:167]
  v_mfma_f32_16x16x32_bf16 v[168:171], v[40:43], v[128:131], v[168:171]
  v_mfma_f32_16x16x32_bf16 v[172:175], v[40:43], v[132:135], v[172:175]
  v_mfma_f32_16x16x32_bf16 v[176:179], v[44:47], v[128:131], v[176:179]
  v_mfma_f32_16x16x32_bf16 v[180:183], v[44:47], v[132:135], v[180:183]
  s_mov_b32 s101, 0
  s_waitcnt vmcnt(0)
  s_branch pvr_244
pvr_243:
  s_sleep 2
  s_add_u32 s56, s47, 32768
  s_add_u32 s57, s48, 262144
  buffer_load_dwordx4 v[96:99], v4, s[16:19], s56 offen sc1
  buffer_load_dwordx2 v[100:101], v5, s[16:19], s56 offen offset:2048 sc1
  buffer_load_dwordx4 v[136:139], v21, s[16:19], s56 offen offset:1024 sc1
  s_add_u32 s56, s56, 2560
  buffer_load_dwordx4 v[104:107], v4, s[16:19], s56 offen sc1
  buffer_load_dwordx2 v[108:109], v5, s[16:19], s56 offen offset:2048 sc1
  s_add_u32 s56, s56, 13824
  buffer_load_dwordx4 v[112:115], v4, s[16:19], s56 offen sc1
  buffer_load_dwordx2 v[116:117], v5, s[16:19], s56 offen offset:2048 sc1
  buffer_load_dwordx4 v[140:143], v21, s[16:19], s56 offen offset:1024 sc1
  s_add_u32 s56, s56, 2560
  buffer_load_dwordx4 v[120:123], v4, s[16:19], s56 offen sc1
  buffer_load_dwordx2 v[124:125], v5, s[16:19], s56 offen offset:2048 sc1
  s_add_u32 s56, s56, 13824
  s_add_u32 s21, s57, 16384
  buffer_load_dwordx4 v[48:51], v22, s[16:19], s57 offen offset:0 sc1
  buffer_load_dwordx4 v[56:59], v22, s[16:19], s21 offen offset:0 sc1
  buffer_load_dwordx2 v[188:189], v14, s[16:19], s57 offen offset:512 sc1
  buffer_load_dwordx4 v[52:55], v22, s[16:19], s57 offen offset:1280 sc1
  buffer_load_dwordx4 v[60:63], v22, s[16:19], s21 offen offset:1280 sc1
  buffer_load_dwordx2 v[190:191], v14, s[16:19], s57 offen offset:1792 sc1
  s_add_u32 s57, s57, 262144
  s_add_u32 s101, s101, 1
  s_cmp_gt_u32 s101, 131072
  s_cbranch_scc1 main_end
  s_waitcnt vmcnt(0)
pvr_244:
  v_max3_u32 v26, v96, v100, v104
  v_max3_u32 v26, v26, v108, v112
  v_max3_u32 v26, v26, v116, v120
  v_max3_u32 v26, v26, v124, v136
  v_max3_u32 v26, v26, v140, v48
  v_max3_u32 v26, v26, v52, v56
  v_max3_u32 v26, v26, v60, v188
  v_max3_u32 v26, v26, v190, v190
  v_cmp_eq_u32 vcc, -1, v26
  s_nop 1
  s_cbranch_vccnz pvr_243
  v_mfma_f32_16x16x32_bf16 v[148:151], a[80:83], v[96:99], v[148:151]
  v_mfma_f32_16x16x32_bf16 v[144:147], a[80:83], v[100:103], v[144:147]
  v_mfma_f32_16x16x32_bf16 v[156:159], a[84:87], v[96:99], v[156:159]
  v_mfma_f32_16x16x32_bf16 v[152:155], a[84:87], v[100:103], v[152:155]
  v_mfma_f32_16x16x32_bf16 v[164:167], a[88:91], v[96:99], v[164:167]
  v_mfma_f32_16x16x32_bf16 v[160:163], a[88:91], v[100:103], v[160:163]
  v_mfma_f32_16x16x32_bf16 v[172:175], a[92:95], v[96:99], v[172:175]
  v_mfma_f32_16x16x32_bf16 v[168:171], a[92:95], v[100:103], v[168:171]
  v_mfma_f32_16x16x32_bf16 v[180:183], a[96:99], v[96:99], v[180:183]
  v_mfma_f32_16x16x32_bf16 v[176:179], a[96:99], v[100:103], v[176:179]
  v_mfma_f32_16x16x32_bf16 v[148:151], a[100:103], v[104:107], v[148:151]
  v_mfma_f32_16x16x32_bf16 v[144:147], a[100:103], v[108:111], v[144:147]
  v_mfma_f32_16x16x32_bf16 v[156:159], a[104:107], v[104:107], v[156:159]
  v_mfma_f32_16x16x32_bf16 v[152:155], a[104:107], v[108:111], v[152:155]
  v_mfma_f32_16x16x32_bf16 v[164:167], a[108:111], v[104:107], v[164:167]
  v_mfma_f32_16x16x32_bf16 v[160:163], a[108:111], v[108:111], v[160:163]
  v_mfma_f32_16x16x32_bf16 v[172:175], a[112:115], v[104:107], v[172:175]
  v_mfma_f32_16x16x32_bf16 v[168:171], a[112:115], v[108:111], v[168:171]
  v_mfma_f32_16x16x32_bf16 v[180:183], a[116:119], v[104:107], v[180:183]
  v_mfma_f32_16x16x32_bf16 v[176:179], a[116:119], v[108:111], v[176:179]
  v_mfma_f32_16x16x32_bf16 v[148:151], a[120:123], v[112:115], v[148:151]
  v_mfma_f32_16x16x32_bf16 v[144:147], a[120:123], v[116:119], v[144:147]
  v_mfma_f32_16x16x32_bf16 v[156:159], a[124:127], v[112:115], v[156:159]
  v_mfma_f32_16x16x32_bf16 v[152:155], a[124:127], v[116:119], v[152:155]
  v_mfma_f32_16x16x32_bf16 v[164:167], a[128:131], v[112:115], v[164:167]
  v_mfma_f32_16x16x32_bf16 v[160:163], a[128:131], v[116:119], v[160:163]
  v_mfma_f32_16x16x32_bf16 v[172:175], a[132:135], v[112:115], v[172:175]
  v_mfma_f32_16x16x32_bf16 v[168:171], a[132:135], v[116:119], v[168:171]
  v_mfma_f32_16x16x32_bf16 v[180:183], a[136:139], v[112:115], v[180:183]
  v_mfma_f32_16x16x32_bf16 v[176:179], a[136:139], v[116:119], v[176:179]
  v_mfma_f32_16x16x32_bf16 v[148:151], a[140:143], v[120:123], v[148:151]
  v_mfma_f32_16x16x32_bf16 v[144:147], a[140:143], v[124:127], v[144:147]
  v_mfma_f32_16x16x32_bf16 v[156:159], a[144:147], v[120:123], v[156:159]
  v_mfma_f32_16x16x32_bf16 v[152:155], a[144:147], v[124:127], v[152:155]
  v_mfma_f32_16x16x32_bf16 v[164:167], a[148:151], v[120:123], v[164:167]
  v_mfma_f32_16x16x32_bf16 v[160:163], a[148:151], v[124:127], v[160:163]
  v_mfma_f32_16x16x32_bf16 v[172:175], a[152:155], v[120:123], v[172:175]
  v_mfma_f32_16x16x32_bf16 v[168:171], a[152:155], v[124:127], v[168:171]
  v_mfma_f32_16x16x32_bf16 v[180:183], a[156:159], v[120:123], v[180:183]
  v_mfma_f32_16x16x32_bf16 v[176:179], a[156:159], v[124:127], v[176:179]
  v_swap_b32 v138, v140
  v_swap_b32 v139, v141
  v_swap_b32 v50, v52
  v_swap_b32 v51, v53
  v_swap_b32 v58, v60
  v_swap_b32 v59, v61
  s_nop 1
  v_mfma_f32_16x16x32_bf16 v[144:147], v[48:51], v[136:139], v[144:147]
  v_mfma_f32_16x16x32_bf16 v[148:151], v[48:51], v[140:143], v[148:151]
  v_mfma_f32_16x16x32_bf16 v[152:155], v[52:55], v[136:139], v[152:155]
  v_mfma_f32_16x16x32_bf16 v[156:159], v[52:55], v[140:143], v[156:159]
  v_mfma_f32_16x16x32_bf16 v[160:163], v[188:191], v[136:139], v[160:163]
  v_mfma_f32_16x16x32_bf16 v[164:167], v[188:191], v[140:143], v[164:167]
  v_mfma_f32_16x16x32_bf16 v[168:171], v[56:59], v[136:139], v[168:171]
  v_mfma_f32_16x16x32_bf16 v[172:175], v[56:59], v[140:143], v[172:175]
  v_mfma_f32_16x16x32_bf16 v[176:179], v[60:63], v[136:139], v[176:179]
  v_mfma_f32_16x16x32_bf16 v[180:183], v[60:63], v[140:143], v[180:183]
pve_232:
  s_nop 0
  ds_write_b128 v10, v[144:147] offset:0
  ds_write_b128 v10, v[148:151] offset:1024
  ds_write_b128 v10, v[152:155] offset:2048
  ds_write_b128 v10, v[156:159] offset:3072
  ds_write_b128 v10, v[160:163] offset:4096
  ds_write_b128 v10, v[164:167] offset:5120
  ds_write_b128 v10, v[168:171] offset:6144
  ds_write_b128 v10, v[172:175] offset:7168
  s_nop 1
  ds_write_b128 v10, v[176:179] offset:8192
  ds_write_b128 v10, v[180:183] offset:9216
  s_cmp_lg_u32 s20, 0
  s_cbranch_scc1 pvq_245
  s_mov_b64 exec, 1
  ds_write_b32 v30, v29
  s_mov_b64 exec, -1
pvq_245:
  s_waitcnt lgkmcnt(0)
  s_barrier
  ds_read_b32 v23, v30
  ds_read_b128 v[192:195], v11 offset:0
  ds_read_b128 v[196:199], v11 offset:10240
  ds_read_b128 v[200:203], v11 offset:20480
  ds_read_b128 v[204:207], v11 offset:30720
  ds_read_b128 v[208:211], v11 offset:2048
  ds_read_b128 v[212:215], v11 offset:12288
  ds_read_b128 v[216:219], v11 offset:22528
  ds_read_b128 v[220:223], v11 offset:32768
  ds_read_b128 v[224:227], v12 offset:0
  ds_read_b128 v[228:231], v12 offset:10240
  ds_read_b128 v[232:235], v12 offset:20480
  ds_read_b128 v[236:239], v12 offset:30720
  s_waitcnt lgkmcnt(8)
  v_pk_add_f32 v[192:193], v[192:193], v[196:197]
  v_pk_add_f32 v[200:201], v[200:201], v[204:205]
  v_pk_add_f32 v[194:195], v[194:195], v[198:199]
  v_pk_add_f32 v[202:203], v[202:203], v[206:207]
  v_pk_add_f32 v[192:193], v[192:193], v[200:201]
  v_pk_add_f32 v[194:195], v[194:195], v[202:203]
  v_cvt_pk_bf16_f32 v26, v192, v193
  v_lshlrev_b32 v192, 16, v26
  v_and_b32 v193, 0xffff0000, v26
  v_mul_f32 v192, v192, v24
  v_mul_f32 v193, v193, v24
  v_cvt_pk_bf16_f32 v26, v192, v193
  v_lshlrev_b32 v192, 16, v26
  v_and_b32 v193, 0xffff0000, v26
  v_add_f32 v192, v192, v240
  v_add_f32 v193, v193, v241
  v_cvt_pk_bf16_f32 v196, v192, v193
  v_cvt_pk_bf16_f32 v26, v194, v195
  v_lshlrev_b32 v194, 16, v26
  v_and_b32 v195, 0xffff0000, v26
  v_mul_f32 v194, v194, v24
  v_mul_f32 v195, v195, v24
  v_cvt_pk_bf16_f32 v26, v194, v195
  v_lshlrev_b32 v194, 16, v26
  v_and_b32 v195, 0xffff0000, v26
  v_add_f32 v194, v194, v242
  v_add_f32 v195, v195, v243
  v_cvt_pk_bf16_f32 v197, v194, v195
  s_waitcnt lgkmcnt(4)
  v_pk_add_f32 v[208:209], v[208:209], v[212:213]
  v_pk_add_f32 v[216:217], v[216:217], v[220:221]
  v_pk_add_f32 v[210:211], v[210:211], v[214:215]
  v_pk_add_f32 v[218:219], v[218:219], v[222:223]
  v_pk_add_f32 v[208:209], v[208:209], v[216:217]
  v_pk_add_f32 v[210:211], v[210:211], v[218:219]
  v_cvt_pk_bf16_f32 v26, v208, v209
  v_lshlrev_b32 v208, 16, v26
  v_and_b32 v209, 0xffff0000, v26
  v_mul_f32 v208, v208, v24
  v_mul_f32 v209, v209, v24
  v_cvt_pk_bf16_f32 v26, v208, v209
  v_lshlrev_b32 v208, 16, v26
  v_and_b32 v209, 0xffff0000, v26
  v_add_f32 v208, v208, v244
  v_add_f32 v209, v209, v245
  v_cvt_pk_bf16_f32 v198, v208, v209
  v_cvt_pk_bf16_f32 v26, v210, v211
  v_lshlrev_b32 v210, 16, v26
  v_and_b32 v211, 0xffff0000, v26
  v_mul_f32 v210, v210, v24
  v_mul_f32 v211, v211, v24
  v_cvt_pk_bf16_f32 v26, v210, v211
  v_lshlrev_b32 v210, 16, v26
  v_and_b32 v211, 0xffff0000, v26
  v_add_f32 v210, v210, v246
  v_add_f32 v211, v211, v247
  v_cvt_pk_bf16_f32 v199, v210, v211
  buffer_store_dwordx4 v[196:199], v9, s[8:11], s46 offen
  s_cmp_ge_u32 s20, 2
  s_cbranch_scc1 pvm_246
  s_waitcnt lgkmcnt(0)
  v_pk_add_f32 v[224:225], v[224:225], v[228:229]
  v_pk_add_f32 v[232:233], v[232:233], v[236:237]
  v_pk_add_f32 v[226:227], v[226:227], v[230:231]
  v_pk_add_f32 v[234:235], v[234:235], v[238:239]
  v_pk_add_f32 v[224:225], v[224:225], v[232:233]
  v_pk_add_f32 v[226:227], v[226:227], v[234:235]
  v_cvt_pk_bf16_f32 v26, v224, v225
  v_lshlrev_b32 v224, 16, v26
  v_and_b32 v225, 0xffff0000, v26
  v_mul_f32 v224, v224, v24
  v_mul_f32 v225, v225, v24
  v_cvt_pk_bf16_f32 v26, v224, v225
  v_lshlrev_b32 v224, 16, v26
  v_and_b32 v225, 0xffff0000, v26
  v_add_f32 v224, v224, v248
  v_add_f32 v225, v225, v249
  v_cvt_pk_bf16_f32 v228, v224, v225
  v_cvt_pk_bf16_f32 v26, v226, v227
  v_lshlrev_b32 v226, 16, v26
  v_and_b32 v227, 0xffff0000, v26
  v_mul_f32 v226, v226, v24
  v_mul_f32 v227, v227, v24
  v_cvt_pk_bf16_f32 v26, v226, v227
  v_lshlrev_b32 v226, 16, v26
  v_and_b32 v227, 0xffff0000, v26
  v_add_f32 v226, v226, v250
  v_add_f32 v227, v227, v251
  v_cvt_pk_bf16_f32 v229, v226, v227
  buffer_store_dwordx2 v[228:229], v13, s[8:11], s49 offen offset:64
pvm_246:
  s_waitcnt lgkmcnt(0)
  v_readfirstlane_b32 s2, v23
  s_barrier
  s_add_u32 s60, s60, 1
  s_max_u32 s21, s2, s60
  s_cmp_lt_u32 s21, 16
  s_cbranch_scc1 pv_loop
main_fin:
  s_waitcnt vmcnt(0)
main_end:
  s_endpgm
.section .rodata,"a"
.p2align 6
.amdhsa_kernel gated_mix__memory_aug_recurrent_mem_tr__sliding_local_dilated__prompt_kernel
  .amdhsa_next_free_vgpr 512
  .amdhsa_next_free_sgpr 102
  .amdhsa_accum_offset 256
  .amdhsa_group_segment_fixed_size 0
  .amdhsa_kernarg_size 112
  .amdhsa_user_sgpr_count 2
  .amdhsa_user_sgpr_kernarg_segment_ptr 1
  .amdhsa_system_sgpr_workgroup_id_x 1
.end_amdhsa_kernel
.text
```

```asm
; @launch kernel=gated_mix__memory_aug_recurrent_mem_tr__sliding_local_dilated__prompt_kernel grid=(256,1,1) block=(256,1,1) lds=163840
.amdgcn_target "amdgcn-amd-amdhsa--gfx950"
.text
.globl gated_mix__memory_aug_recurrent_mem_tr__sliding_local_dilated__prompt_kernel
.p2align 8
.type gated_mix__memory_aug_recurrent_mem_tr__sliding_local_dilated__prompt_kernel,@function
gated_mix__memory_aug_recurrent_mem_tr__sliding_local_dilated__prompt_kernel:
  s_cmp_ge_u32 s2, 256
  s_cbranch_scc1 end0
  s_load_dwordx2 s[4:5], s[0:1], 96
  s_load_dwordx2 s[38:39], s[0:1], 104
  v_lshrrev_b32 v1, 6, v0
  v_and_b32 v2, 15, v0
  v_readfirstlane_b32 s20, v1
  v_and_b32 v1, 63, v0
  v_lshrrev_b32 v3, 4, v1
  s_getreg_b32 s50, hwreg(HW_REG_XCC_ID)
  s_and_b32 s50, s50, 7
  s_waitcnt lgkmcnt(0)
  s_mov_b32 s32, s4
  s_mov_b32 s33, s5
  s_mov_b32 s34, 256
  s_mov_b32 s35, 0x00020000
  v_mov_b32 v21, 0
  s_cmp_lg_u32 s20, 0
  s_cbranch_scc1 rk_1
  s_and_b32 s21, s50, 1
  s_lshl_b32 s21, s21, 7
  s_lshl_b32 s22, s50, 1
  s_and_b32 s22, s22, 12
  s_add_u32 s21, s21, s22
  v_mov_b32 v22, s21
  v_mov_b32 v23, 1
  s_mov_b64 exec, 1
  buffer_atomic_add v23, v22, s[32:35], 0 offen sc0 sc1
  s_waitcnt vmcnt(0)
  v_readfirstlane_b32 s51, v23
  s_lshl_b32 s22, s50, 5
  s_add_u32 s22, s22, s51
  s_cmp_lt_u32 s51, 32
  s_cbranch_scc1 rk_2
  v_mov_b32 v24, 72
  v_mov_b32 v25, 1
  buffer_atomic_add v25, v24, s[32:35], 0 offen sc0 sc1
  s_waitcnt vmcnt(0)
  v_readfirstlane_b32 s23, v25
  s_mov_b32 s101, 0
  s_mov_b64 exec, -1
  v_lshlrev_b32 v24, 2, v1
rk_3:
  s_sleep 8
  buffer_load_dword v25, v24, s[32:35], 0 offen sc1
  s_add_u32 s101, s101, 1
  s_cmp_gt_u32 s101, 131072
  s_cbranch_scc1 end0
  s_waitcnt vmcnt(0)
  v_readlane_b32 s21, v25, 0
  v_readlane_b32 s22, v25, 32
  s_add_u32 s21, s21, s22
  v_readlane_b32 s22, v25, 1
  s_add_u32 s21, s21, s22
  v_readlane_b32 s22, v25, 33
  s_add_u32 s21, s21, s22
  v_readlane_b32 s22, v25, 2
  s_add_u32 s21, s21, s22
  v_readlane_b32 s22, v25, 34
  s_add_u32 s21, s21, s22
  v_readlane_b32 s22, v25, 3
  s_add_u32 s21, s21, s22
  v_readlane_b32 s22, v25, 35
  s_add_u32 s21, s21, s22
  s_cmp_lt_u32 s21, 256
  s_cbranch_scc1 rk_3
  s_mov_b64 exec, 1
  s_mov_b32 s24, 0
rk_5:
  s_and_b32 s21, s24, 1
  s_lshl_b32 s21, s21, 5
  s_lshr_b32 s22, s24, 1
  s_add_u32 s21, s21, s22
  v_readlane_b32 s21, v25, s21
  s_min_u32 s21, s21, 32
  s_sub_u32 s25, 32, s21
  s_cmp_lt_u32 s23, s25
  s_cbranch_scc1 rk_4
  s_sub_u32 s23, s23, s25
  s_add_u32 s24, s24, 1
  s_cmp_lt_u32 s24, 8
  s_cbranch_scc1 rk_5
  s_branch end0
rk_4:
  s_lshl_b32 s22, s24, 5
  s_add_u32 s22, s22, s21
  s_add_u32 s22, s22, s23
  s_or_b32 s22, s22, 0x100
rk_2:
  v_mov_b32 v23, s22
  ds_write_b32 v21, v23
  s_waitcnt lgkmcnt(0)
  s_mov_b64 exec, -1
rk_1:
  s_waitcnt vmcnt(0)
  s_barrier
  ds_read_b32 v23, v21
  s_waitcnt lgkmcnt(0)
  v_readfirstlane_b32 s22, v23
  s_barrier
  s_lshr_b32 s53, s22, 8
  s_and_b32 s22, s22, 255
  s_cmp_ge_u32 s22, 128
  s_cbranch_scc1 gemm_side
  s_lshr_b32 s50, s22, 4
  s_and_b32 s51, s22, 15
  s_load_dwordx2 s[4:5], s[0:1], 8
  s_load_dwordx4 s[40:43], s[0:1], 16
  s_load_dwordx4 s[44:47], s[0:1], 32
  s_load_dwordx2 s[48:49], s[0:1], 104
  s_lshr_b32 s55, s51, 2
  s_and_b32 s56, s51, 3
  s_lshl_b32 s57, s50, 2
  s_add_u32 s58, s57, s55
  s_add_u32 s59, s57, s20
  s_lshr_b32 s60, s51, 1
  s_and_b32 s61, s51, 1
  s_mul_i32 s81, s20, 40960
  v_lshlrev_b32 v4, 4, v1
  s_waitcnt lgkmcnt(0)
  s_mov_b32 s12, s44
  s_mov_b32 s13, s45
  s_mov_b32 s14, 7864320
  s_mov_b32 s15, 0x00020000
  s_mov_b32 s16, s46
  s_mov_b32 s17, s47
  s_mov_b32 s18, 7864320
  s_mov_b32 s19, 0x00020000
  s_mov_b32 s24, s40
  s_mov_b32 s25, s41
  s_mov_b32 s26, 7864320
  s_mov_b32 s27, 0x00020000
  s_mov_b32 s28, s42
  s_mov_b32 s29, s43
  s_mov_b32 s30, 7864320
  s_mov_b32 s31, 0x00020000
  s_mov_b32 s36, s4
  s_mov_b32 s37, s5
  s_mov_b32 s38, 10240
  s_mov_b32 s39, 0x00020000
  s_add_u32 s8, s48, 169869312
  s_addc_u32 s9, s49, 0
  s_mov_b32 s10, 495616
  s_mov_b32 s11, 0x00020000
  s_add_u32 s4, s48, 167772160
  s_addc_u32 s5, s49, 0
  s_mov_b32 s6, 1048576
  s_mov_b32 s7, 0x00020000
  v_add_u32 v66, 0, v1
  v_mul_u32_u24 v67, 2731, v66
  v_lshrrev_b32 v67, 16, v67
  v_mul_u32_u24 v48, 24, v67
  v_sub_u32 v66, v66, v48
  v_mul_u32_u24 v67, 12288, v67
  v_lshl_add_u32 v48, v66, 4, v67
  v_add_u32 v66, 64, v1
  v_mul_u32_u24 v67, 2731, v66
  v_lshrrev_b32 v67, 16, v67
  v_mul_u32_u24 v49, 24, v67
  v_sub_u32 v66, v66, v49
  v_mul_u32_u24 v67, 12288, v67
  v_lshl_add_u32 v49, v66, 4, v67
  v_add_u32 v66, 128, v1
  v_mul_u32_u24 v67, 2731, v66
  v_lshrrev_b32 v67, 16, v67
  v_mul_u32_u24 v50, 24, v67
  v_sub_u32 v66, v66, v50
  v_mul_u32_u24 v67, 12288, v67
  v_lshl_add_u32 v50, v66, 4, v67
  s_mul_i32 s21, s51, 491520
  s_mul_i32 s80, s59, 384
  s_add_u32 s21, s21, s80
  s_mov_b32 s23, s21
  v_add_u32 v66, 0, v1
  v_mul_u32_u24 v67, 10923, v66
  v_lshrrev_b32 v67, 16, v67
  v_mul_u32_u24 v60, 6, v67
  v_sub_u32 v66, v66, v60
  v_mul_u32_u24 v67, 1280, v67
  v_lshl_add_u32 v60, v66, 4, v67
  v_add_u32 v66, 64, v1
  v_mul_u32_u24 v67, 10923, v66
  v_lshrrev_b32 v67, 16, v67
  v_mul_u32_u24 v61, 6, v67
  v_sub_u32 v66, v66, v61
  v_mul_u32_u24 v67, 1280, v67
  v_lshl_add_u32 v61, v66, 4, v67
  v_add_u32 v66, 128, v1
  v_mul_u32_u24 v67, 10923, v66
  v_lshrrev_b32 v67, 16, v67
  v_mul_u32_u24 v62, 6, v67
  v_sub_u32 v66, v66, v62
  v_mul_u32_u24 v67, 1280, v67
  v_lshl_add_u32 v62, v66, 4, v67
  s_mul_i32 s21, s59, 245760
  s_mul_i32 s22, s60, 160
  s_add_u32 s21, s21, s22
  s_lshl_b32 s22, s61, 6
  s_add_u32 s21, s21, s22
  s_add_u32 m0, s81, 0
  s_nop 0
  buffer_load_dwordx4 v60, s[16:19], s21 offen lds
  s_add_u32 m0, s81, 1024
  s_nop 0
  buffer_load_dwordx4 v61, s[16:19], s21 offen lds
  s_add_u32 m0, s81, 2048
  s_nop 0
  buffer_load_dwordx4 v62, s[16:19], s21 offen lds
  s_add_u32 s21, s21, 40960
  s_add_u32 m0, s81, 3072
  s_nop 0
  buffer_load_dwordx4 v60, s[16:19], s21 offen lds
  s_add_u32 m0, s81, 4096
  s_nop 0
  buffer_load_dwordx4 v61, s[16:19], s21 offen lds
  s_add_u32 m0, s81, 5120
  s_nop 0
  buffer_load_dwordx4 v62, s[16:19], s21 offen lds
  s_add_u32 s21, s21, 40960
  s_add_u32 m0, s81, 6144
  s_nop 0
  buffer_load_dwordx4 v60, s[16:19], s21 offen lds
  s_add_u32 m0, s81, 7168
  s_nop 0
  buffer_load_dwordx4 v61, s[16:19], s21 offen lds
  s_add_u32 m0, s81, 8192
  s_nop 0
  buffer_load_dwordx4 v62, s[16:19], s21 offen lds
  s_add_u32 s21, s21, 40960
  s_add_u32 m0, s81, 9216
  s_nop 0
  buffer_load_dwordx4 v60, s[16:19], s21 offen lds
  s_add_u32 m0, s81, 10240
  s_nop 0
  buffer_load_dwordx4 v61, s[16:19], s21 offen lds
  s_add_u32 m0, s81, 11264
  s_nop 0
  buffer_load_dwordx4 v62, s[16:19], s21 offen lds
  s_add_u32 s21, s21, 40960
  s_add_u32 m0, s81, 12288
  s_nop 0
  buffer_load_dwordx4 v60, s[16:19], s21 offen lds
  s_add_u32 m0, s81, 13312
  s_nop 0
  buffer_load_dwordx4 v61, s[16:19], s21 offen lds
  s_add_u32 m0, s81, 14336
  s_nop 0
  buffer_load_dwordx4 v62, s[16:19], s21 offen lds
  s_add_u32 s21, s21, 40960
  s_add_u32 m0, s81, 15360
  s_nop 0
  buffer_load_dwordx4 v60, s[16:19], s21 offen lds
  s_add_u32 m0, s81, 16384
  s_nop 0
  buffer_load_dwordx4 v61, s[16:19], s21 offen lds
  s_add_u32 m0, s81, 17408
  s_nop 0
  buffer_load_dwordx4 v62, s[16:19], s21 offen lds
  s_add_u32 s21, s21, 40960
  v_add_u32 v66, 0, v1
  v_mul_u32_u24 v67, 2731, v66
  v_lshrrev_b32 v67, 16, v67
  v_mul_u32_u24 v48, 24, v67
  v_sub_u32 v66, v66, v48
  v_lshrrev_b32 v48, 2, v67
  v_lshlrev_b32 v48, 1, v48
  v_or_b32 v48, 0, v48
  v_xor_b32 v66, v66, v48
  v_add_u32 v67, 0, v67
  v_mul_u32_u24 v67, 12288, v67
  v_lshl_add_u32 v48, v66, 4, v67
  v_add_u32 v66, 64, v1
  v_mul_u32_u24 v67, 2731, v66
  v_lshrrev_b32 v67, 16, v67
  v_mul_u32_u24 v49, 24, v67
  v_sub_u32 v66, v66, v49
  v_lshrrev_b32 v49, 2, v67
  v_lshlrev_b32 v49, 1, v49
  v_or_b32 v49, 0, v49
  v_xor_b32 v66, v66, v49
  v_add_u32 v67, 0, v67
  v_mul_u32_u24 v67, 12288, v67
  v_lshl_add_u32 v49, v66, 4, v67
  v_add_u32 v66, 128, v1
  v_mul_u32_u24 v67, 2731, v66
  v_lshrrev_b32 v67, 16, v67
  v_mul_u32_u24 v50, 24, v67
  v_sub_u32 v66, v66, v50
  v_lshrrev_b32 v50, 2, v67
  v_lshlrev_b32 v50, 1, v50
  v_or_b32 v50, 0, v50
  v_xor_b32 v66, v66, v50
  v_add_u32 v67, 0, v67
  v_mul_u32_u24 v67, 12288, v67
  v_lshl_add_u32 v50, v66, 4, v67
  v_add_u32 v66, 0, v1
  v_mul_u32_u24 v67, 2731, v66
  v_lshrrev_b32 v67, 16, v67
  v_mul_u32_u24 v51, 24, v67
  v_sub_u32 v66, v66, v51
  v_lshrrev_b32 v51, 2, v67
  v_lshlrev_b32 v51, 1, v51
  v_or_b32 v51, 1, v51
  v_xor_b32 v66, v66, v51
  v_add_u32 v67, 8, v67
  v_mul_u32_u24 v67, 12288, v67
  v_lshl_add_u32 v51, v66, 4, v67
  v_add_u32 v66, 64, v1
  v_mul_u32_u24 v67, 2731, v66
  v_lshrrev_b32 v67, 16, v67
  v_mul_u32_u24 v52, 24, v67
  v_sub_u32 v66, v66, v52
  v_lshrrev_b32 v52, 2, v67
  v_lshlrev_b32 v52, 1, v52
  v_or_b32 v52, 1, v52
  v_xor_b32 v66, v66, v52
  v_add_u32 v67, 8, v67
  v_mul_u32_u24 v67, 12288, v67
  v_lshl_add_u32 v52, v66, 4, v67
  v_add_u32 v66, 128, v1
  v_mul_u32_u24 v67, 2731, v66
  v_lshrrev_b32 v67, 16, v67
  v_mul_u32_u24 v53, 24, v67
  v_sub_u32 v66, v66, v53
  v_lshrrev_b32 v53, 2, v67
  v_lshlrev_b32 v53, 1, v53
  v_or_b32 v53, 1, v53
  v_xor_b32 v66, v66, v53
  v_add_u32 v67, 8, v67
  v_mul_u32_u24 v67, 12288, v67
  v_lshl_add_u32 v53, v66, 4, v67
  v_add_u32 v66, 0, v1
  v_mul_u32_u24 v67, 2731, v66
  v_lshrrev_b32 v67, 16, v67
  v_mul_u32_u24 v54, 24, v67
  v_sub_u32 v66, v66, v54
  v_lshrrev_b32 v54, 2, v67
  v_lshlrev_b32 v54, 1, v54
  v_or_b32 v54, 4, v54
  v_xor_b32 v66, v66, v54
  v_add_u32 v67, 16, v67
  v_mul_u32_u24 v67, 12288, v67
  v_lshl_add_u32 v54, v66, 4, v67
  v_add_u32 v66, 64, v1
  v_mul_u32_u24 v67, 2731, v66
  v_lshrrev_b32 v67, 16, v67
  v_mul_u32_u24 v55, 24, v67
  v_sub_u32 v66, v66, v55
  v_lshrrev_b32 v55, 2, v67
  v_lshlrev_b32 v55, 1, v55
  v_or_b32 v55, 4, v55
  v_xor_b32 v66, v66, v55
  v_add_u32 v67, 16, v67
  v_mul_u32_u24 v67, 12288, v67
  v_lshl_add_u32 v55, v66, 4, v67
  v_add_u32 v66, 128, v1
  v_mul_u32_u24 v67, 2731, v66
  v_lshrrev_b32 v67, 16, v67
  v_mul_u32_u24 v56, 24, v67
  v_sub_u32 v66, v66, v56
  v_lshrrev_b32 v56, 2, v67
  v_lshlrev_b32 v56, 1, v56
  v_or_b32 v56, 4, v56
  v_xor_b32 v66, v66, v56
  v_add_u32 v67, 16, v67
  v_mul_u32_u24 v67, 12288, v67
  v_lshl_add_u32 v56, v66, 4, v67
  v_add_u32 v66, 0, v1
  v_mul_u32_u24 v67, 2731, v66
  v_lshrrev_b32 v67, 16, v67
  v_mul_u32_u24 v57, 24, v67
  v_sub_u32 v66, v66, v57
  v_lshrrev_b32 v57, 2, v67
  v_lshlrev_b32 v57, 1, v57
  v_or_b32 v57, 5, v57
  v_xor_b32 v66, v66, v57
  v_add_u32 v67, 24, v67
  v_mul_u32_u24 v67, 12288, v67
  v_lshl_add_u32 v57, v66, 4, v67
  v_add_u32 v66, 64, v1
  v_mul_u32_u24 v67, 2731, v66
  v_lshrrev_b32 v67, 16, v67
  v_mul_u32_u24 v58, 24, v67
  v_sub_u32 v66, v66, v58
  v_lshrrev_b32 v58, 2, v67
  v_lshlrev_b32 v58, 1, v58
  v_or_b32 v58, 5, v58
  v_xor_b32 v66, v66, v58
  v_add_u32 v67, 24, v67
  v_mul_u32_u24 v67, 12288, v67
  v_lshl_add_u32 v58, v66, 4, v67
  v_add_u32 v66, 128, v1
  v_mul_u32_u24 v67, 2731, v66
  v_lshrrev_b32 v67, 16, v67
  v_mul_u32_u24 v59, 24, v67
  v_sub_u32 v66, v66, v59
  v_lshrrev_b32 v59, 2, v67
  v_lshlrev_b32 v59, 1, v59
  v_or_b32 v59, 5, v59
  v_xor_b32 v66, v66, v59
  v_add_u32 v67, 24, v67
  v_mul_u32_u24 v67, 12288, v67
  v_lshl_add_u32 v59, v66, 4, v67
  s_add_u32 m0, s81, 24576
  s_nop 0
  buffer_load_dwordx4 v48, s[12:15], s80 offen lds
  s_add_u32 m0, s81, 25600
  s_nop 0
  buffer_load_dwordx4 v49, s[12:15], s80 offen lds
  s_add_u32 m0, s81, 26624
  s_nop 0
  buffer_load_dwordx4 v50, s[12:15], s80 offen lds
  s_add_u32 m0, s81, 27648
  s_nop 0
  buffer_load_dwordx4 v51, s[12:15], s80 offen lds
  s_add_u32 m0, s81, 28672
  s_nop 0
  buffer_load_dwordx4 v52, s[12:15], s80 offen lds
  s_add_u32 m0, s81, 29696
  s_nop 0
  buffer_load_dwordx4 v53, s[12:15], s80 offen lds
  s_add_u32 m0, s81, 30720
  s_nop 0
  buffer_load_dwordx4 v54, s[12:15], s80 offen lds
  s_add_u32 m0, s81, 31744
  s_nop 0
  buffer_load_dwordx4 v55, s[12:15], s80 offen lds
  s_add_u32 m0, s81, 32768
  s_nop 0
  buffer_load_dwordx4 v56, s[12:15], s80 offen lds
  s_add_u32 m0, s81, 33792
  s_nop 0
  buffer_load_dwordx4 v57, s[12:15], s80 offen lds
  s_add_u32 m0, s81, 34816
  s_nop 0
  buffer_load_dwordx4 v58, s[12:15], s80 offen lds
  s_add_u32 m0, s81, 35840
  s_nop 0
  buffer_load_dwordx4 v59, s[12:15], s80 offen lds
  s_add_u32 s80, s80, 393216
  v_add_u32 v66, 0, v1
  v_mul_u32_u24 v67, 10923, v66
  v_lshrrev_b32 v67, 16, v67
  v_mul_u32_u24 v63, 6, v67
  v_sub_u32 v66, v66, v63
  v_mul_u32_u24 v67, 12288, v67
  v_lshl_add_u32 v63, v66, 4, v67
  v_add_u32 v66, 64, v1
  v_mul_u32_u24 v67, 10923, v66
  v_lshrrev_b32 v67, 16, v67
  v_mul_u32_u24 v64, 6, v67
  v_sub_u32 v66, v66, v64
  v_mul_u32_u24 v67, 12288, v67
  v_lshl_add_u32 v64, v66, 4, v67
  v_add_u32 v66, 128, v1
  v_mul_u32_u24 v67, 10923, v66
  v_lshrrev_b32 v67, 16, v67
  v_mul_u32_u24 v65, 6, v67
  v_sub_u32 v66, v66, v65
  v_mul_u32_u24 v67, 12288, v67
  v_lshl_add_u32 v65, v66, 4, v67
  s_mul_i32 s79, s58, 384
  s_mul_i32 s22, s56, 96
  s_add_u32 s79, s79, s22
  s_mul_i32 s22, s20, 1966080
  s_add_u32 s79, s79, s22
  v_and_b32 v224, 7, v2
  v_lshrrev_b32 v225, 3, v2
  v_lshlrev_b32 v12, 3, v1
  v_mov_b32 v23, 0
  v_mov_b32 v226, 0x4444
  v_mov_b32 v227, 0xeeee
  v_cmp_eq_u32 vcc, 1, v225
  v_cmp_gt_u32 s[62:63], 8, v2
  v_cmp_le_u32 s[68:69], 8, v2
  v_cndmask_b32 v22, v226, v227, vcc
  v_cmp_gt_u32 vcc, 32, v1
  v_mov_b32 v226, 0x3dd53b95
  v_cmp_gt_u32 s[66:67], 40, v1
  v_cndmask_b32 v24, 1.0, v226, vcc
  v_cndmask_b32 v25, 1.0, v226, vcc
  v_min_u32 v226, 39, v1
  v_and_b32 v227, 31, v1
  v_lshlrev_b32 v227, 2, v227
  v_lshl_add_u32 v5, v226, 7, v227
  v_mul_u32_u24 v226, 192, v3
  v_lshl_add_u32 v226, v2, 3, v226
  s_mul_i32 s21, s20, 768
  s_add_u32 s21, s21, 10240
  v_add_u32 v6, s21, v226
  v_and_b32 v226, 3, v2
  v_mul_u32_u24 v226, 192, v226
  v_lshrrev_b32 v227, 2, v2
  v_lshl_add_u32 v227, v3, 2, v227
  v_lshl_add_u32 v226, v227, 3, v226
  v_add_u32 v7, 10240, v226
  s_mul_i32 s21, s58, 2560
  s_add_u32 s21, s21, 40960
  s_lshr_b32 s22, s56, 1
  s_lshl_b32 s22, s22, 10
  s_and_b32 s23, s56, 1
  s_lshl_b32 s23, s23, 3
  s_add_u32 s22, s22, s23
  s_lshl_b32 s23, s20, 7
  s_add_u32 s22, s22, s23
  s_add_u32 s22, s22, s21
  v_lshlrev_b32 v226, 8, v3
  v_lshl_add_u32 v226, v224, 4, v226
  v_add_u32 v8, s22, v226
  s_lshl_b32 s22, s56, 2
  s_add_u32 s22, s22, s21
  s_add_u32 s22, s22, 2048
  v_and_b32 v226, 0x1ff, v226
  v_add_u32 v226, s22, v226
  s_cmp_eq_u32 s20, 2
  s_cselect_b64 vcc, -1, 0
  v_cmp_le_u32 s[64:65], 32, v1
  v_cndmask_b32 v8, v8, v226, vcc
  s_cselect_b64 s[64:65], s[64:65], -1
  s_and_b64 s[64:65], s[64:65], s[62:63]
  s_mul_i32 s21, s59, 2560
  s_add_u32 s21, s21, 40960
  v_add_u32 v9, s21, v4
  v_and_b32 v226, 0x1ff, v4
  s_add_u32 s21, s21, 2048
  v_add_u32 v10, s21, v226
  v_lshrrev_b32 v226, 2, v2
  v_and_b32 v227, 1, v2
  v_lshl_add_u32 v228, v226, 1, v227
  v_and_b32 v227, 2, v2
  v_cmp_eq_u32 vcc, 0, v227
  s_lshr_b32 s21, s20, 1
  s_lshl_b32 s21, s21, 9
  s_and_b32 s22, s20, 1
  s_lshl_b32 s22, s22, 6
  s_add_u32 s21, s21, s22
  s_add_u32 s21, s21, 12544
  v_lshlrev_b32 v226, 7, v3
  v_lshl_add_u32 v226, v228, 3, v226
  v_add_u32 v226, s21, v226
  v_mov_b32 v227, 13568
  v_cndmask_b32 v11, v227, v226, vcc
  s_lshl_b32 s21, s20, 9
  s_add_u32 s21, s21, 40960
  v_lshlrev_b32 v226, 7, v3
  v_lshl_add_u32 v226, v228, 4, v226
  v_add_u32 v226, s21, v226
  v_mov_b32 v227, 46080
  v_cndmask_b32 v19, v227, v226, vcc
  s_lshl_b32 s21, s20, 11
  s_add_u32 s21, s21, 32768
  v_add_u32 v18, s21, v4
  s_and_b32 s21, s20, 1
  s_lshl_b32 s22, s21, 10
  s_add_u32 s22, s22, 43008
  v_add_u32 v20, s22, v4
  s_lshl_b32 s22, s21, 3
  s_add_u32 s22, s22, 45056
  v_add_u32 v21, s22, v4
  s_mul_i32 s21, s20, 640
  s_add_u32 s22, s21, 13824
  v_lshlrev_b32 v226, 4, v224
  v_lshl_add_u32 v227, v3, 7, v226
  v_add_u32 v13, s22, v227
  v_lshl_add_u32 v227, v3, 2, v226
  s_add_u32 s22, s22, 512
  v_add_u32 v14, s22, v227
  v_and_b32 v226, 0x1ff, v4
  v_lshrrev_b32 v228, 5, v1
  v_lshl_add_u32 v226, v228, 3, v226
  s_add_u32 s22, s21, 16384
  v_add_u32 v26, s22, v226
  v_lshl_add_u32 v228, v228, 1, v225
  v_mul_u32_u24 v228, 640, v228
  v_and_b32 v226, 1, v3
  v_lshl_add_u32 v228, v226, 6, v228
  v_lshl_add_u32 v228, v224, 3, v228
  v_add_u32 v43, 16896, v228
  s_and_b32 s21, s50, 1
  s_lshl_b32 s21, s21, 4
  s_add_u32 s21, s21, s51
  s_lshl_b32 s22, s20, 5
  s_add_u32 s21, s21, s22
  s_cmp_lt_u32 s21, 80
  s_cselect_b32 s78, 1, 0
  s_cselect_b32 s21, s21, 0
  s_lshl_b32 s22, s21, 7
  v_add_u32 v17, s22, v227
  s_lshr_b32 s22, s21, 3
  s_lshl_b32 s22, s22, 14
  s_and_b32 s21, s21, 7
  s_lshl_b32 s21, s21, 10
  s_add_u32 s21, s21, s22
  v_add_u32 v16, s21, v4
  s_mul_i32 s21, s60, 10
  s_mul_i32 s22, s61, 6
  s_add_u32 s22, s22, s21
  s_add_u32 s21, s21, s61
  s_add_u32 s21, s21, 4
  v_lshrrev_b32 v226, 3, v1
  v_cmp_gt_u32 vcc, 4, v226
  v_add_u32 v226, s22, v226
  v_mov_b32 v227, s21
  v_cndmask_b32 v226, v227, v226, vcc
  v_lshrrev_b32 v227, 3, v226
  v_lshlrev_b32 v227, 14, v227
  v_and_b32 v226, 7, v226
  v_lshl_add_u32 v226, v226, 10, v227
  v_lshl_add_u32 v226, v224, 4, v226
  s_lshl_b32 s21, s50, 7
  v_add_u32 v15, s21, v226
  v_and_b32 v226, 1, v2
  v_lshlrev_b32 v226, 4, v226
  v_mov_b32 v227, 0x3c00
  v_lshlrev_b32 v226, v226, v227
  v_lshrrev_b32 v227, 1, v2
  v_cmp_eq_u32 vcc, 0, v227
  s_nop 1
  v_cndmask_b32 v44, 0, v226, vcc
  v_cmp_eq_u32 vcc, 2, v227
  s_nop 1
  v_cndmask_b32 v45, 0, v226, vcc
  v_cmp_eq_u32 vcc, 4, v227
  s_nop 1
  v_cndmask_b32 v46, 0, v226, vcc
  v_cmp_eq_u32 vcc, 6, v227
  s_nop 1
  v_cndmask_b32 v47, 0, v226, vcc
  v_lshrrev_b32 v226, 5, v1
  v_lshlrev_b32 v226, 14, v226
  v_bfe_u32 v227, v1, 3, 2
  v_lshl_add_u32 v226, v227, 8, v226
  v_lshl_add_u32 v226, v224, 4, v226
  s_lshl_b32 s21, s61, 7
  v_add_u32 v32, s21, v226
  v_lshlrev_b32 v226, 4, v224
  v_lshl_add_u32 v36, v3, 7, v226
  v_lshrrev_b32 v37, 1, v36
  v_and_b32 v41, 3, v1
  v_lshlrev_b32 v41, 7, v41
  v_mov_b32 v226, 0x40000000
  v_cmp_gt_u32 vcc, 32, v1
  v_cndmask_b32 v36, v226, v36, s[68:69]
  v_cndmask_b32 v37, v226, v37, s[68:69]
  v_cndmask_b32 v38, v226, v4, vcc
  s_lshr_b32 s21, s50, 1
  s_lshl_b32 s21, s21, 8
  s_add_u32 s21, s21, 491520
  v_and_b32 v227, 31, v1
  v_lshl_add_u32 v33, v227, 2, s21
  s_and_b32 s22, s50, 1
  s_lshl_b32 s22, s22, 4
  s_add_u32 s22, s22, s51
  v_cmp_eq_u32 vcc, s22, v1
  s_nop 1
  v_cndmask_b32 v34, v226, v33, vcc
  v_mov_b32 v28, -1
  v_mov_b32 v29, -1
  v_mov_b32 v30, -1
  v_mov_b32 v31, -1
  s_lshr_b32 s21, s50, 1
  s_mul_i32 s77, s21, 10240
  s_cmp_eq_u32 s20, 3
  s_cbranch_scc1 ar_8
  s_mov_b64 exec, s[64:65]
  s_cmp_eq_u32 s20, 2
  s_cbranch_scc1 ar_7
  s_mov_b32 s21, 0
  buffer_store_dwordx2 v[28:29], v8, s[8:11], s21 offen
  s_mov_b32 s21, 122880
  buffer_store_dwordx2 v[28:29], v8, s[8:11], s21 offen
  s_mov_b32 s21, 245760
  buffer_store_dwordx2 v[28:29], v8, s[8:11], s21 offen
  s_mov_b32 s21, 368640
  buffer_store_dwordx2 v[28:29], v8, s[8:11], s21 offen
  s_branch ar_9
ar_7:
  s_mov_b32 s21, 0
  buffer_store_dword v28, v8, s[8:11], s21 offen
  buffer_store_dword v28, v8, s[8:11], s21 offen offset:128
  s_mov_b32 s21, 122880
  buffer_store_dword v28, v8, s[8:11], s21 offen
  buffer_store_dword v28, v8, s[8:11], s21 offen offset:128
  s_mov_b32 s21, 245760
  buffer_store_dword v28, v8, s[8:11], s21 offen
  buffer_store_dword v28, v8, s[8:11], s21 offen offset:128
  s_mov_b32 s21, 368640
  buffer_store_dword v28, v8, s[8:11], s21 offen
  buffer_store_dword v28, v8, s[8:11], s21 offen offset:128
ar_9:
  s_cmp_eq_u32 s78, 0
  s_cbranch_scc1 ar_10
  s_mov_b64 exec, s[62:63]
  s_add_u32 s21, s77, 0
  buffer_store_dword v28, v17, s[8:11], s21 offen
  s_add_u32 s21, s77, 122880
  buffer_store_dword v28, v17, s[8:11], s21 offen
  s_add_u32 s21, s77, 245760
  buffer_store_dword v28, v17, s[8:11], s21 offen
  s_add_u32 s21, s77, 368640
  buffer_store_dword v28, v17, s[8:11], s21 offen
  s_branch ar_10
ar_8:
  buffer_store_dword v28, v34, s[8:11], 0 offen
  s_mov_b64 exec, s[66:67]
  s_mov_b32 s21, 0
  buffer_store_dwordx4 v[28:31], v15, s[4:7], s21 offen sc1
  s_mov_b32 s21, 262144
  buffer_store_dwordx4 v[28:31], v15, s[4:7], s21 offen sc1
  s_mov_b32 s21, 524288
  buffer_store_dwordx4 v[28:31], v15, s[4:7], s21 offen sc1
  s_mov_b32 s21, 786432
  buffer_store_dwordx4 v[28:31], v15, s[4:7], s21 offen sc1
  s_mov_b32 s21, 8192
  buffer_store_dwordx4 v[28:31], v15, s[4:7], s21 offen sc1
  s_mov_b32 s21, 270336
  buffer_store_dwordx4 v[28:31], v15, s[4:7], s21 offen sc1
  s_mov_b32 s21, 532480
  buffer_store_dwordx4 v[28:31], v15, s[4:7], s21 offen sc1
  s_mov_b32 s21, 794624
  buffer_store_dwordx4 v[28:31], v15, s[4:7], s21 offen sc1
ar_10:
  s_mov_b64 exec, -1
  v_lshrrev_b32 v66, 2, v2
  v_lshl_add_u32 v66, v3, 3, v66
  v_mul_u32_u24 v66, 96, v66
  v_add_u32 v66, s81, v66
  v_and_b32 v67, 3, v2
  s_lshl_b32 s21, s61, 5
  v_lshl_add_u32 v68, v67, 4, v66
  v_add_u32 v68, s21, v68
  s_mul_i32 s21, s61, 48
  s_sub_u32 s21, 64, s21
  v_and_b32 v67, 1, v2
  v_lshl_add_u32 v69, v67, 3, v66
  v_add_u32 v69, s21, v69
  v_lshrrev_b32 v226, 3, v2
  v_lshlrev_b32 v226, 4, v226
  v_bfe_u32 v227, v2, 1, 1
  v_lshl_add_u32 v226, v227, 3, v226
  v_and_b32 v227, 5, v2
  v_add_u32 v226, v226, v227
  v_mul_u32_u24 v226, 384, v226
  v_add_u32 v226, s81, v226
  v_lshrrev_b32 v227, 1, v2
  v_xor_b32 v227, v227, v3
  v_lshl_add_u32 v70, v227, 4, v226
  v_xor_b32 v227, 4, v227
  v_lshl_add_u32 v71, v227, 4, v226
  s_waitcnt vmcnt(0)
  ds_read_b64_tr_b16 v[72:73], v68 offset:0
  ds_read_b64_tr_b16 v[74:75], v68 offset:384
  ds_read_b64_tr_b16 v[76:77], v68 offset:8
  ds_read_b64_tr_b16 v[78:79], v68 offset:392
  ds_read_b64_tr_b16 v[80:81], v69 offset:0
  ds_read_b64_tr_b16 v[82:83], v69 offset:384
  ds_read_b64_tr_b16 v[84:85], v68 offset:3072
  ds_read_b64_tr_b16 v[86:87], v68 offset:3456
  ds_read_b64_tr_b16 v[88:89], v68 offset:3080
  ds_read_b64_tr_b16 v[90:91], v68 offset:3464
  ds_read_b64_tr_b16 v[92:93], v69 offset:3072
  ds_read_b64_tr_b16 v[94:95], v69 offset:3456
  ds_read_b64_tr_b16 v[96:97], v68 offset:6144
  ds_read_b64_tr_b16 v[98:99], v68 offset:6528
  ds_read_b64_tr_b16 v[100:101], v68 offset:6152
  ds_read_b64_tr_b16 v[102:103], v68 offset:6536
  ds_read_b64_tr_b16 v[104:105], v69 offset:6144
  ds_read_b64_tr_b16 v[106:107], v69 offset:6528
  ds_read_b64_tr_b16 v[108:109], v68 offset:9216
  ds_read_b64_tr_b16 v[110:111], v68 offset:9600
  ds_read_b64_tr_b16 v[112:113], v68 offset:9224
  ds_read_b64_tr_b16 v[114:115], v68 offset:9608
  ds_read_b64_tr_b16 v[116:117], v69 offset:9216
  ds_read_b64_tr_b16 v[118:119], v69 offset:9600
  ds_read_b64_tr_b16 v[120:121], v68 offset:12288
  ds_read_b64_tr_b16 v[122:123], v68 offset:12672
  ds_read_b64_tr_b16 v[124:125], v68 offset:12296
  ds_read_b64_tr_b16 v[126:127], v68 offset:12680
  ds_read_b64_tr_b16 v[128:129], v69 offset:12288
  ds_read_b64_tr_b16 v[130:131], v69 offset:12672
  ds_read_b64_tr_b16 v[132:133], v68 offset:15360
  ds_read_b64_tr_b16 v[134:135], v68 offset:15744
  ds_read_b64_tr_b16 v[136:137], v68 offset:15368
  ds_read_b64_tr_b16 v[138:139], v68 offset:15752
  ds_read_b64_tr_b16 v[140:141], v69 offset:15360
  ds_read_b64_tr_b16 v[142:143], v69 offset:15744
  s_waitcnt lgkmcnt(0)
  s_barrier
  s_cmp_lg_u32 s20, 0
  s_cbranch_scc1 ic_11
  v_mov_b32 v68, 64
  v_mov_b32 v69, 1
  s_mov_b64 exec, 1
  buffer_atomic_add v69, v68, s[32:35], 0 offen sc1
  s_mov_b64 exec, -1
ic_11:
  s_add_u32 m0, s81, 0
  s_nop 0
  buffer_load_dwordx4 v48, s[12:15], s80 offen lds
  s_add_u32 m0, s81, 1024
  s_nop 0
  buffer_load_dwordx4 v49, s[12:15], s80 offen lds
  s_add_u32 m0, s81, 2048
  s_nop 0
  buffer_load_dwordx4 v50, s[12:15], s80 offen lds
  s_add_u32 m0, s81, 3072
  s_nop 0
  buffer_load_dwordx4 v51, s[12:15], s80 offen lds
  s_add_u32 m0, s81, 4096
  s_nop 0
  buffer_load_dwordx4 v52, s[12:15], s80 offen lds
  s_add_u32 m0, s81, 5120
  s_nop 0
  buffer_load_dwordx4 v53, s[12:15], s80 offen lds
  s_add_u32 m0, s81, 6144
  s_nop 0
  buffer_load_dwordx4 v54, s[12:15], s80 offen lds
  s_add_u32 m0, s81, 7168
  s_nop 0
  buffer_load_dwordx4 v55, s[12:15], s80 offen lds
  s_add_u32 m0, s81, 8192
  s_nop 0
  buffer_load_dwordx4 v56, s[12:15], s80 offen lds
  s_add_u32 m0, s81, 9216
  s_nop 0
  buffer_load_dwordx4 v57, s[12:15], s80 offen lds
  s_add_u32 m0, s81, 10240
  s_nop 0
  buffer_load_dwordx4 v58, s[12:15], s80 offen lds
  s_add_u32 m0, s81, 11264
  s_nop 0
  buffer_load_dwordx4 v59, s[12:15], s80 offen lds
  s_add_u32 s80, s80, 393216
  s_add_u32 s16, s48, 168886272
  s_addc_u32 s17, s49, 0
  s_mov_b32 s18, 49152
  s_mov_b32 s19, 0x00020000
  v_add_u32 v68, s81, v4
  v_and_b32 v69, 7, v2
  v_lshl_add_u32 v69, v3, 3, v69
  v_and_b32 v67, 8, v2
  v_lshl_add_u32 v69, v69, 4, v67
  v_add_u32 v69, s81, v69
  v_lshlrev_b32 v67, 2, v1
  s_lshl_b32 s90, s50, 9
  s_and_b32 s21, s51, 12
  s_add_u32 s90, s90, s21
  s_add_u32 s90, s90, 4096
  ds_read_b128 v[208:211], v70 offset:24576
  ds_read_b128 v[212:215], v71 offset:24576
  ds_read_b128 v[216:219], v70 offset:24704
  s_waitcnt lgkmcnt(2)
  v_mfma_f32_16x16x32_bf16 v[184:187], v[208:211], v[72:75], 0
  ds_read_b128 v[220:223], v71 offset:24704
  v_mfma_f32_16x16x32_bf16 v[188:191], v[208:211], v[76:79], 0
  s_add_u32 m0, s81, 12288
  s_nop 0
  buffer_load_dwordx4 v48, s[12:15], s80 offen lds
  v_mfma_f32_16x16x32_bf16 v[192:195], v[208:211], v[80:83], 0
  s_waitcnt lgkmcnt(2)
  v_mfma_f32_16x16x32_bf16 v[184:187], v[212:215], v[84:87], v[184:187]
  ds_read_b128 v[208:211], v70 offset:24832
  v_mfma_f32_16x16x32_bf16 v[188:191], v[212:215], v[88:91], v[188:191]
  s_add_u32 m0, s81, 13312
  s_nop 0
  buffer_load_dwordx4 v49, s[12:15], s80 offen lds
  v_mfma_f32_16x16x32_bf16 v[192:195], v[212:215], v[92:95], v[192:195]
  s_waitcnt lgkmcnt(2)
  v_mfma_f32_16x16x32_bf16 v[184:187], v[216:219], v[96:99], v[184:187]
  ds_read_b128 v[212:215], v71 offset:24832
  v_mfma_f32_16x16x32_bf16 v[188:191], v[216:219], v[100:103], v[188:191]
  s_add_u32 m0, s81, 14336
  s_nop 0
  buffer_load_dwordx4 v50, s[12:15], s80 offen lds
  v_mfma_f32_16x16x32_bf16 v[192:195], v[216:219], v[104:107], v[192:195]
  s_waitcnt lgkmcnt(2)
  v_mfma_f32_16x16x32_bf16 v[184:187], v[220:223], v[108:111], v[184:187]
  ds_read_b128 v[216:219], v70 offset:25344
  v_mfma_f32_16x16x32_bf16 v[188:191], v[220:223], v[112:115], v[188:191]
  s_add_u32 m0, s81, 15360
  s_nop 0
  buffer_load_dwordx4 v51, s[12:15], s80 offen lds
  v_mfma_f32_16x16x32_bf16 v[192:195], v[220:223], v[116:119], v[192:195]
  s_waitcnt lgkmcnt(2)
  v_mfma_f32_16x16x32_bf16 v[184:187], v[208:211], v[120:123], v[184:187]
  ds_read_b128 v[220:223], v71 offset:25344
  v_mfma_f32_16x16x32_bf16 v[188:191], v[208:211], v[124:127], v[188:191]
  s_add_u32 m0, s81, 16384
  s_nop 0
  buffer_load_dwordx4 v52, s[12:15], s80 offen lds
  v_mfma_f32_16x16x32_bf16 v[192:195], v[208:211], v[128:131], v[192:195]
  s_waitcnt lgkmcnt(2)
  v_mfma_f32_16x16x32_bf16 v[184:187], v[212:215], v[132:135], v[184:187]
  ds_read_b128 v[208:211], v70 offset:25472
  v_mfma_f32_16x16x32_bf16 v[188:191], v[212:215], v[136:139], v[188:191]
  s_add_u32 m0, s81, 17408
  s_nop 0
  buffer_load_dwordx4 v53, s[12:15], s80 offen lds
  v_mfma_f32_16x16x32_bf16 v[192:195], v[212:215], v[140:143], v[192:195]
  s_waitcnt lgkmcnt(2)
  v_mfma_f32_16x16x32_bf16 v[196:199], v[216:219], v[72:75], 0
  ds_read_b128 v[212:215], v71 offset:25472
  v_mfma_f32_16x16x32_bf16 v[200:203], v[216:219], v[76:79], 0
  s_add_u32 m0, s81, 18432
  s_nop 0
  buffer_load_dwordx4 v54, s[12:15], s80 offen lds
  v_mfma_f32_16x16x32_bf16 v[204:207], v[216:219], v[80:83], 0
  s_waitcnt lgkmcnt(2)
  v_mfma_f32_16x16x32_bf16 v[196:199], v[220:223], v[84:87], v[196:199]
  ds_read_b128 v[216:219], v70 offset:25600
  v_cvt_pk_bf16_f32 v248, v184, v185
  v_mfma_f32_16x16x32_bf16 v[200:203], v[220:223], v[88:91], v[200:203]
  s_add_u32 m0, s81, 19456
  s_nop 0
  buffer_load_dwordx4 v55, s[12:15], s80 offen lds
  v_mfma_f32_16x16x32_bf16 v[204:207], v[220:223], v[92:95], v[204:207]
  v_cvt_pk_bf16_f32 v249, v186, v187
  s_waitcnt lgkmcnt(2)
  v_mfma_f32_16x16x32_bf16 v[196:199], v[208:211], v[96:99], v[196:199]
  ds_read_b128 v[220:223], v71 offset:25600
  v_cvt_pk_bf16_f32 v250, v188, v189
  v_mfma_f32_16x16x32_bf16 v[200:203], v[208:211], v[100:103], v[200:203]
  s_add_u32 m0, s81, 20480
  s_nop 0
  buffer_load_dwordx4 v56, s[12:15], s80 offen lds
  v_mfma_f32_16x16x32_bf16 v[204:207], v[208:211], v[104:107], v[204:207]
  v_cvt_pk_bf16_f32 v251, v190, v191
  s_waitcnt lgkmcnt(2)
  v_mfma_f32_16x16x32_bf16 v[196:199], v[212:215], v[108:111], v[196:199]
  v_accvgpr_write_b32 a0, v248
  v_mfma_f32_16x16x32_bf16 v[200:203], v[212:215], v[112:115], v[200:203]
  s_add_u32 m0, s81, 21504
  s_nop 0
  buffer_load_dwordx4 v57, s[12:15], s80 offen lds
  v_mfma_f32_16x16x32_bf16 v[204:207], v[212:215], v[116:119], v[204:207]
  v_accvgpr_write_b32 a1, v249
  s_waitcnt lgkmcnt(1)
  v_mfma_f32_16x16x32_bf16 v[196:199], v[216:219], v[120:123], v[196:199]
  v_accvgpr_write_b32 a80, v250
  v_mfma_f32_16x16x32_bf16 v[200:203], v[216:219], v[124:127], v[200:203]
  s_add_u32 m0, s81, 22528
  s_nop 0
  buffer_load_dwordx4 v58, s[12:15], s80 offen lds
  v_mfma_f32_16x16x32_bf16 v[204:207], v[216:219], v[128:131], v[204:207]
  v_accvgpr_write_b32 a81, v251
  s_waitcnt lgkmcnt(0)
  v_mfma_f32_16x16x32_bf16 v[196:199], v[220:223], v[132:135], v[196:199]
  v_cvt_pk_bf16_f32 v144, v192, v193
  v_cvt_pk_bf16_f32 v145, v194, v195
  v_mfma_f32_16x16x32_bf16 v[200:203], v[220:223], v[136:139], v[200:203]
  s_add_u32 m0, s81, 23552
  s_nop 0
  buffer_load_dwordx4 v59, s[12:15], s80 offen lds
  s_add_u32 s80, s80, 393216
  v_mfma_f32_16x16x32_bf16 v[204:207], v[220:223], v[140:143], v[204:207]
  s_waitcnt vmcnt(12)
  ds_read_b128 v[208:211], v70 offset:0
  ds_read_b128 v[212:215], v71 offset:0
  ds_read_b128 v[216:219], v70 offset:128
  s_waitcnt lgkmcnt(2)
  v_mfma_f32_16x16x32_bf16 v[184:187], v[208:211], v[72:75], 0
  ds_read_b128 v[220:223], v71 offset:128
  v_mfma_f32_16x16x32_bf16 v[188:191], v[208:211], v[76:79], 0
  s_add_u32 m0, s81, 24576
  s_nop 0
  buffer_load_dwordx4 v48, s[12:15], s80 offen lds
  v_mfma_f32_16x16x32_bf16 v[192:195], v[208:211], v[80:83], 0
  s_waitcnt lgkmcnt(2)
  v_mfma_f32_16x16x32_bf16 v[184:187], v[212:215], v[84:87], v[184:187]
  ds_read_b128 v[208:211], v70 offset:256
  v_cvt_pk_bf16_f32 v248, v196, v197
  v_mfma_f32_16x16x32_bf16 v[188:191], v[212:215], v[88:91], v[188:191]
  s_add_u32 m0, s81, 25600
  s_nop 0
  buffer_load_dwordx4 v49, s[12:15], s80 offen lds
  v_mfma_f32_16x16x32_bf16 v[192:195], v[212:215], v[92:95], v[192:195]
  v_cvt_pk_bf16_f32 v249, v198, v199
  s_waitcnt lgkmcnt(2)
  v_mfma_f32_16x16x32_bf16 v[184:187], v[216:219], v[96:99], v[184:187]
  ds_read_b128 v[212:215], v71 offset:256
  v_cvt_pk_bf16_f32 v250, v200, v201
  v_mfma_f32_16x16x32_bf16 v[188:191], v[216:219], v[100:103], v[188:191]
  s_add_u32 m0, s81, 26624
  s_nop 0
  buffer_load_dwordx4 v50, s[12:15], s80 offen lds
  v_mfma_f32_16x16x32_bf16 v[192:195], v[216:219], v[104:107], v[192:195]
  v_cvt_pk_bf16_f32 v251, v202, v203
  s_waitcnt lgkmcnt(2)
  v_mfma_f32_16x16x32_bf16 v[184:187], v[220:223], v[108:111], v[184:187]
  ds_read_b128 v[216:219], v70 offset:768
  v_accvgpr_write_b32 a2, v248
  v_mfma_f32_16x16x32_bf16 v[188:191], v[220:223], v[112:115], v[188:191]
  s_add_u32 m0, s81, 27648
  s_nop 0
  buffer_load_dwordx4 v51, s[12:15], s80 offen lds
  v_mfma_f32_16x16x32_bf16 v[192:195], v[220:223], v[116:119], v[192:195]
  v_accvgpr_write_b32 a3, v249
  s_waitcnt lgkmcnt(2)
  v_mfma_f32_16x16x32_bf16 v[184:187], v[208:211], v[120:123], v[184:187]
  ds_read_b128 v[220:223], v71 offset:768
  v_accvgpr_write_b32 a82, v250
  v_mfma_f32_16x16x32_bf16 v[188:191], v[208:211], v[124:127], v[188:191]
  s_add_u32 m0, s81, 28672
  s_nop 0
  buffer_load_dwordx4 v52, s[12:15], s80 offen lds
  v_mfma_f32_16x16x32_bf16 v[192:195], v[208:211], v[128:131], v[192:195]
  v_accvgpr_write_b32 a83, v251
  s_waitcnt lgkmcnt(2)
  v_mfma_f32_16x16x32_bf16 v[184:187], v[212:215], v[132:135], v[184:187]
  ds_read_b128 v[208:211], v70 offset:896
  s_mov_b64 exec, s[68:69]
  v_cvt_pk_bf16_f32 v144, v204, v205
  v_cvt_pk_bf16_f32 v145, v206, v207
  s_mov_b64 exec, -1
  v_mfma_f32_16x16x32_bf16 v[188:191], v[212:215], v[136:139], v[188:191]
  s_add_u32 m0, s81, 29696
  s_nop 0
  buffer_load_dwordx4 v53, s[12:15], s80 offen lds
  v_mfma_f32_16x16x32_bf16 v[192:195], v[212:215], v[140:143], v[192:195]
  s_waitcnt lgkmcnt(2)
  v_mfma_f32_16x16x32_bf16 v[196:199], v[216:219], v[72:75], 0
  ds_read_b128 v[212:215], v71 offset:896
  v_mfma_f32_16x16x32_bf16 v[200:203], v[216:219], v[76:79], 0
  s_add_u32 m0, s81, 30720
  s_nop 0
  buffer_load_dwordx4 v54, s[12:15], s80 offen lds
  v_mfma_f32_16x16x32_bf16 v[204:207], v[216:219], v[80:83], 0
  s_waitcnt lgkmcnt(2)
  v_mfma_f32_16x16x32_bf16 v[196:199], v[220:223], v[84:87], v[196:199]
  ds_read_b128 v[216:219], v70 offset:1024
  v_cvt_pk_bf16_f32 v248, v184, v185
  v_mfma_f32_16x16x32_bf16 v[200:203], v[220:223], v[88:91], v[200:203]
  s_add_u32 m0, s81, 31744
  s_nop 0
  buffer_load_dwordx4 v55, s[12:15], s80 offen lds
  v_mfma_f32_16x16x32_bf16 v[204:207], v[220:223], v[92:95], v[204:207]
  v_cvt_pk_bf16_f32 v249, v186, v187
  s_waitcnt lgkmcnt(2)
  v_mfma_f32_16x16x32_bf16 v[196:199], v[208:211], v[96:99], v[196:199]
  ds_read_b128 v[220:223], v71 offset:1024
  v_cvt_pk_bf16_f32 v250, v188, v189
  v_mfma_f32_16x16x32_bf16 v[200:203], v[208:211], v[100:103], v[200:203]
  s_add_u32 m0, s81, 32768
  s_nop 0
  buffer_load_dwordx4 v56, s[12:15], s80 offen lds
  v_mfma_f32_16x16x32_bf16 v[204:207], v[208:211], v[104:107], v[204:207]
  v_cvt_pk_bf16_f32 v251, v190, v191
  s_waitcnt lgkmcnt(2)
  v_mfma_f32_16x16x32_bf16 v[196:199], v[212:215], v[108:111], v[196:199]
  v_accvgpr_write_b32 a4, v248
  v_mfma_f32_16x16x32_bf16 v[200:203], v[212:215], v[112:115], v[200:203]
  s_add_u32 m0, s81, 33792
  s_nop 0
  buffer_load_dwordx4 v57, s[12:15], s80 offen lds
  v_mfma_f32_16x16x32_bf16 v[204:207], v[212:215], v[116:119], v[204:207]
  v_accvgpr_write_b32 a5, v249
  s_waitcnt lgkmcnt(1)
  v_mfma_f32_16x16x32_bf16 v[196:199], v[216:219], v[120:123], v[196:199]
  v_accvgpr_write_b32 a84, v250
  v_mfma_f32_16x16x32_bf16 v[200:203], v[216:219], v[124:127], v[200:203]
  s_add_u32 m0, s81, 34816
  s_nop 0
  buffer_load_dwordx4 v58, s[12:15], s80 offen lds
  v_mfma_f32_16x16x32_bf16 v[204:207], v[216:219], v[128:131], v[204:207]
  v_accvgpr_write_b32 a85, v251
  s_waitcnt lgkmcnt(0)
  v_mfma_f32_16x16x32_bf16 v[196:199], v[220:223], v[132:135], v[196:199]
  v_cvt_pk_bf16_f32 v146, v192, v193
  v_cvt_pk_bf16_f32 v147, v194, v195
  v_mfma_f32_16x16x32_bf16 v[200:203], v[220:223], v[136:139], v[200:203]
  s_add_u32 m0, s81, 35840
  s_nop 0
  buffer_load_dwordx4 v59, s[12:15], s80 offen lds
  s_add_u32 s80, s80, 393216
  v_mfma_f32_16x16x32_bf16 v[204:207], v[220:223], v[140:143], v[204:207]
  s_waitcnt vmcnt(12)
  ds_read_b128 v[208:211], v70 offset:12288
  ds_read_b128 v[212:215], v71 offset:12288
  ds_read_b128 v[216:219], v70 offset:12416
  s_waitcnt lgkmcnt(2)
  v_mfma_f32_16x16x32_bf16 v[184:187], v[208:211], v[72:75], 0
  ds_read_b128 v[220:223], v71 offset:12416
  v_mfma_f32_16x16x32_bf16 v[188:191], v[208:211], v[76:79], 0
  s_add_u32 m0, s81, 0
  s_nop 0
  buffer_load_dwordx4 v48, s[12:15], s80 offen lds
  v_mfma_f32_16x16x32_bf16 v[192:195], v[208:211], v[80:83], 0
  s_waitcnt lgkmcnt(2)
  v_mfma_f32_16x16x32_bf16 v[184:187], v[212:215], v[84:87], v[184:187]
  ds_read_b128 v[208:211], v70 offset:12544
  v_cvt_pk_bf16_f32 v248, v196, v197
  v_mfma_f32_16x16x32_bf16 v[188:191], v[212:215], v[88:91], v[188:191]
  s_add_u32 m0, s81, 1024
  s_nop 0
  buffer_load_dwordx4 v49, s[12:15], s80 offen lds
  v_mfma_f32_16x16x32_bf16 v[192:195], v[212:215], v[92:95], v[192:195]
  v_cvt_pk_bf16_f32 v249, v198, v199
  s_waitcnt lgkmcnt(2)
  v_mfma_f32_16x16x32_bf16 v[184:187], v[216:219], v[96:99], v[184:187]
  ds_read_b128 v[212:215], v71 offset:12544
  v_cvt_pk_bf16_f32 v250, v200, v201
  v_mfma_f32_16x16x32_bf16 v[188:191], v[216:219], v[100:103], v[188:191]
  s_add_u32 m0, s81, 2048
  s_nop 0
  buffer_load_dwordx4 v50, s[12:15], s80 offen lds
  v_mfma_f32_16x16x32_bf16 v[192:195], v[216:219], v[104:107], v[192:195]
  v_cvt_pk_bf16_f32 v251, v202, v203
  s_waitcnt lgkmcnt(2)
  v_mfma_f32_16x16x32_bf16 v[184:187], v[220:223], v[108:111], v[184:187]
  ds_read_b128 v[216:219], v70 offset:13056
  v_accvgpr_write_b32 a6, v248
  v_mfma_f32_16x16x32_bf16 v[188:191], v[220:223], v[112:115], v[188:191]
  s_add_u32 m0, s81, 3072
  s_nop 0
  buffer_load_dwordx4 v51, s[12:15], s80 offen lds
  v_mfma_f32_16x16x32_bf16 v[192:195], v[220:223], v[116:119], v[192:195]
  v_accvgpr_write_b32 a7, v249
  s_waitcnt lgkmcnt(2)
  v_mfma_f32_16x16x32_bf16 v[184:187], v[208:211], v[120:123], v[184:187]
  ds_read_b128 v[220:223], v71 offset:13056
  v_accvgpr_write_b32 a86, v250
  v_mfma_f32_16x16x32_bf16 v[188:191], v[208:211], v[124:127], v[188:191]
  s_add_u32 m0, s81, 4096
  s_nop 0
  buffer_load_dwordx4 v52, s[12:15], s80 offen lds
  v_mfma_f32_16x16x32_bf16 v[192:195], v[208:211], v[128:131], v[192:195]
  v_accvgpr_write_b32 a87, v251
  s_waitcnt lgkmcnt(2)
  v_mfma_f32_16x16x32_bf16 v[184:187], v[212:215], v[132:135], v[184:187]
  ds_read_b128 v[208:211], v70 offset:13184
  s_mov_b64 exec, s[68:69]
  v_cvt_pk_bf16_f32 v146, v204, v205
  v_cvt_pk_bf16_f32 v147, v206, v207
  s_mov_b64 exec, -1
  v_mfma_f32_16x16x32_bf16 v[188:191], v[212:215], v[136:139], v[188:191]
  s_add_u32 m0, s81, 5120
  s_nop 0
  buffer_load_dwordx4 v53, s[12:15], s80 offen lds
  v_mfma_f32_16x16x32_bf16 v[192:195], v[212:215], v[140:143], v[192:195]
  s_waitcnt lgkmcnt(2)
  v_mfma_f32_16x16x32_bf16 v[196:199], v[216:219], v[72:75], 0
  ds_read_b128 v[212:215], v71 offset:13184
  v_mfma_f32_16x16x32_bf16 v[200:203], v[216:219], v[76:79], 0
  s_add_u32 m0, s81, 6144
  s_nop 0
  buffer_load_dwordx4 v54, s[12:15], s80 offen lds
  v_mfma_f32_16x16x32_bf16 v[204:207], v[216:219], v[80:83], 0
  s_waitcnt lgkmcnt(2)
  v_mfma_f32_16x16x32_bf16 v[196:199], v[220:223], v[84:87], v[196:199]
  ds_read_b128 v[216:219], v70 offset:13312
  v_cvt_pk_bf16_f32 v248, v184, v185
  v_mfma_f32_16x16x32_bf16 v[200:203], v[220:223], v[88:91], v[200:203]
  s_add_u32 m0, s81, 7168
  s_nop 0
  buffer_load_dwordx4 v55, s[12:15], s80 offen lds
  v_mfma_f32_16x16x32_bf16 v[204:207], v[220:223], v[92:95], v[204:207]
  v_cvt_pk_bf16_f32 v249, v186, v187
  s_waitcnt lgkmcnt(2)
  v_mfma_f32_16x16x32_bf16 v[196:199], v[208:211], v[96:99], v[196:199]
  ds_read_b128 v[220:223], v71 offset:13312
  v_cvt_pk_bf16_f32 v250, v188, v189
  v_mfma_f32_16x16x32_bf16 v[200:203], v[208:211], v[100:103], v[200:203]
  s_add_u32 m0, s81, 8192
  s_nop 0
  buffer_load_dwordx4 v56, s[12:15], s80 offen lds
  v_mfma_f32_16x16x32_bf16 v[204:207], v[208:211], v[104:107], v[204:207]
  v_cvt_pk_bf16_f32 v251, v190, v191
  s_waitcnt lgkmcnt(2)
  v_mfma_f32_16x16x32_bf16 v[196:199], v[212:215], v[108:111], v[196:199]
  v_accvgpr_write_b32 a8, v248
  v_mfma_f32_16x16x32_bf16 v[200:203], v[212:215], v[112:115], v[200:203]
  s_add_u32 m0, s81, 9216
  s_nop 0
  buffer_load_dwordx4 v57, s[12:15], s80 offen lds
  v_mfma_f32_16x16x32_bf16 v[204:207], v[212:215], v[116:119], v[204:207]
  v_accvgpr_write_b32 a9, v249
  s_waitcnt lgkmcnt(1)
  v_mfma_f32_16x16x32_bf16 v[196:199], v[216:219], v[120:123], v[196:199]
  v_accvgpr_write_b32 a88, v250
  v_mfma_f32_16x16x32_bf16 v[200:203], v[216:219], v[124:127], v[200:203]
  s_add_u32 m0, s81, 10240
  s_nop 0
  buffer_load_dwordx4 v58, s[12:15], s80 offen lds
  v_mfma_f32_16x16x32_bf16 v[204:207], v[216:219], v[128:131], v[204:207]
  v_accvgpr_write_b32 a89, v251
  s_waitcnt lgkmcnt(0)
  v_mfma_f32_16x16x32_bf16 v[196:199], v[220:223], v[132:135], v[196:199]
  v_cvt_pk_bf16_f32 v148, v192, v193
  v_cvt_pk_bf16_f32 v149, v194, v195
  v_mfma_f32_16x16x32_bf16 v[200:203], v[220:223], v[136:139], v[200:203]
  s_add_u32 m0, s81, 11264
  s_nop 0
  buffer_load_dwordx4 v59, s[12:15], s80 offen lds
  s_add_u32 s80, s80, 393216
  v_mfma_f32_16x16x32_bf16 v[204:207], v[220:223], v[140:143], v[204:207]
  s_waitcnt vmcnt(12)
  ds_read_b128 v[208:211], v70 offset:24576
  ds_read_b128 v[212:215], v71 offset:24576
  ds_read_b128 v[216:219], v70 offset:24704
  s_waitcnt lgkmcnt(2)
  v_mfma_f32_16x16x32_bf16 v[184:187], v[208:211], v[72:75], 0
  ds_read_b128 v[220:223], v71 offset:24704
  v_mfma_f32_16x16x32_bf16 v[188:191], v[208:211], v[76:79], 0
  s_add_u32 m0, s81, 12288
  s_nop 0
  buffer_load_dwordx4 v48, s[12:15], s80 offen lds
  v_mfma_f32_16x16x32_bf16 v[192:195], v[208:211], v[80:83], 0
  s_waitcnt lgkmcnt(2)
  v_mfma_f32_16x16x32_bf16 v[184:187], v[212:215], v[84:87], v[184:187]
  ds_read_b128 v[208:211], v70 offset:24832
  v_cvt_pk_bf16_f32 v248, v196, v197
  v_mfma_f32_16x16x32_bf16 v[188:191], v[212:215], v[88:91], v[188:191]
  s_add_u32 m0, s81, 13312
  s_nop 0
  buffer_load_dwordx4 v49, s[12:15], s80 offen lds
  v_mfma_f32_16x16x32_bf16 v[192:195], v[212:215], v[92:95], v[192:195]
  v_cvt_pk_bf16_f32 v249, v198, v199
  s_waitcnt lgkmcnt(2)
  v_mfma_f32_16x16x32_bf16 v[184:187], v[216:219], v[96:99], v[184:187]
  ds_read_b128 v[212:215], v71 offset:24832
  v_cvt_pk_bf16_f32 v250, v200, v201
  v_mfma_f32_16x16x32_bf16 v[188:191], v[216:219], v[100:103], v[188:191]
  s_add_u32 m0, s81, 14336
  s_nop 0
  buffer_load_dwordx4 v50, s[12:15], s80 offen lds
  v_mfma_f32_16x16x32_bf16 v[192:195], v[216:219], v[104:107], v[192:195]
  v_cvt_pk_bf16_f32 v251, v202, v203
  s_waitcnt lgkmcnt(2)
  v_mfma_f32_16x16x32_bf16 v[184:187], v[220:223], v[108:111], v[184:187]
  ds_read_b128 v[216:219], v70 offset:25344
  v_accvgpr_write_b32 a10, v248
  v_mfma_f32_16x16x32_bf16 v[188:191], v[220:223], v[112:115], v[188:191]
  s_add_u32 m0, s81, 15360
  s_nop 0
  buffer_load_dwordx4 v51, s[12:15], s80 offen lds
  v_mfma_f32_16x16x32_bf16 v[192:195], v[220:223], v[116:119], v[192:195]
  v_accvgpr_write_b32 a11, v249
  s_waitcnt lgkmcnt(2)
  v_mfma_f32_16x16x32_bf16 v[184:187], v[208:211], v[120:123], v[184:187]
  ds_read_b128 v[220:223], v71 offset:25344
  v_accvgpr_write_b32 a90, v250
  v_mfma_f32_16x16x32_bf16 v[188:191], v[208:211], v[124:127], v[188:191]
  s_add_u32 m0, s81, 16384
  s_nop 0
  buffer_load_dwordx4 v52, s[12:15], s80 offen lds
  v_mfma_f32_16x16x32_bf16 v[192:195], v[208:211], v[128:131], v[192:195]
  v_accvgpr_write_b32 a91, v251
  s_waitcnt lgkmcnt(2)
  v_mfma_f32_16x16x32_bf16 v[184:187], v[212:215], v[132:135], v[184:187]
  ds_read_b128 v[208:211], v70 offset:25472
  s_mov_b64 exec, s[68:69]
  v_cvt_pk_bf16_f32 v148, v204, v205
  v_cvt_pk_bf16_f32 v149, v206, v207
  s_mov_b64 exec, -1
  v_mfma_f32_16x16x32_bf16 v[188:191], v[212:215], v[136:139], v[188:191]
  s_add_u32 m0, s81, 17408
  s_nop 0
  buffer_load_dwordx4 v53, s[12:15], s80 offen lds
  v_mfma_f32_16x16x32_bf16 v[192:195], v[212:215], v[140:143], v[192:195]
  s_waitcnt lgkmcnt(2)
  v_mfma_f32_16x16x32_bf16 v[196:199], v[216:219], v[72:75], 0
  ds_read_b128 v[212:215], v71 offset:25472
  v_mfma_f32_16x16x32_bf16 v[200:203], v[216:219], v[76:79], 0
  s_add_u32 m0, s81, 18432
  s_nop 0
  buffer_load_dwordx4 v54, s[12:15], s80 offen lds
  v_mfma_f32_16x16x32_bf16 v[204:207], v[216:219], v[80:83], 0
  s_waitcnt lgkmcnt(2)
  v_mfma_f32_16x16x32_bf16 v[196:199], v[220:223], v[84:87], v[196:199]
  ds_read_b128 v[216:219], v70 offset:25600
  v_cvt_pk_bf16_f32 v248, v184, v185
  v_mfma_f32_16x16x32_bf16 v[200:203], v[220:223], v[88:91], v[200:203]
  s_add_u32 m0, s81, 19456
  s_nop 0
  buffer_load_dwordx4 v55, s[12:15], s80 offen lds
  v_mfma_f32_16x16x32_bf16 v[204:207], v[220:223], v[92:95], v[204:207]
  v_cvt_pk_bf16_f32 v249, v186, v187
  s_waitcnt lgkmcnt(2)
  v_mfma_f32_16x16x32_bf16 v[196:199], v[208:211], v[96:99], v[196:199]
  ds_read_b128 v[220:223], v71 offset:25600
  v_cvt_pk_bf16_f32 v250, v188, v189
  v_mfma_f32_16x16x32_bf16 v[200:203], v[208:211], v[100:103], v[200:203]
  s_add_u32 m0, s81, 20480
  s_nop 0
  buffer_load_dwordx4 v56, s[12:15], s80 offen lds
  v_mfma_f32_16x16x32_bf16 v[204:207], v[208:211], v[104:107], v[204:207]
  v_cvt_pk_bf16_f32 v251, v190, v191
  s_waitcnt lgkmcnt(2)
  v_mfma_f32_16x16x32_bf16 v[196:199], v[212:215], v[108:111], v[196:199]
  v_accvgpr_write_b32 a12, v248
  v_mfma_f32_16x16x32_bf16 v[200:203], v[212:215], v[112:115], v[200:203]
  s_add_u32 m0, s81, 21504
  s_nop 0
  buffer_load_dwordx4 v57, s[12:15], s80 offen lds
  v_mfma_f32_16x16x32_bf16 v[204:207], v[212:215], v[116:119], v[204:207]
  v_accvgpr_write_b32 a13, v249
  s_waitcnt lgkmcnt(1)
  v_mfma_f32_16x16x32_bf16 v[196:199], v[216:219], v[120:123], v[196:199]
  v_accvgpr_write_b32 a92, v250
  v_mfma_f32_16x16x32_bf16 v[200:203], v[216:219], v[124:127], v[200:203]
  s_add_u32 m0, s81, 22528
  s_nop 0
  buffer_load_dwordx4 v58, s[12:15], s80 offen lds
  v_mfma_f32_16x16x32_bf16 v[204:207], v[216:219], v[128:131], v[204:207]
  v_accvgpr_write_b32 a93, v251
  s_waitcnt lgkmcnt(0)
  v_mfma_f32_16x16x32_bf16 v[196:199], v[220:223], v[132:135], v[196:199]
  v_cvt_pk_bf16_f32 v150, v192, v193
  v_cvt_pk_bf16_f32 v151, v194, v195
  v_mfma_f32_16x16x32_bf16 v[200:203], v[220:223], v[136:139], v[200:203]
  s_add_u32 m0, s81, 23552
  s_nop 0
  buffer_load_dwordx4 v59, s[12:15], s80 offen lds
  s_add_u32 s80, s80, 393216
  v_mfma_f32_16x16x32_bf16 v[204:207], v[220:223], v[140:143], v[204:207]
  s_waitcnt vmcnt(12)
  ds_read_b128 v[208:211], v70 offset:0
  ds_read_b128 v[212:215], v71 offset:0
  ds_read_b128 v[216:219], v70 offset:128
  s_waitcnt lgkmcnt(2)
  v_mfma_f32_16x16x32_bf16 v[184:187], v[208:211], v[72:75], 0
  ds_read_b128 v[220:223], v71 offset:128
  v_mfma_f32_16x16x32_bf16 v[188:191], v[208:211], v[76:79], 0
  s_add_u32 m0, s81, 24576
  s_nop 0
  buffer_load_dwordx4 v48, s[12:15], s80 offen lds
  v_mfma_f32_16x16x32_bf16 v[192:195], v[208:211], v[80:83], 0
  s_waitcnt lgkmcnt(2)
  v_mfma_f32_16x16x32_bf16 v[184:187], v[212:215], v[84:87], v[184:187]
  ds_read_b128 v[208:211], v70 offset:256
  v_cvt_pk_bf16_f32 v248, v196, v197
  v_mfma_f32_16x16x32_bf16 v[188:191], v[212:215], v[88:91], v[188:191]
  s_add_u32 m0, s81, 25600
  s_nop 0
  buffer_load_dwordx4 v49, s[12:15], s80 offen lds
  v_mfma_f32_16x16x32_bf16 v[192:195], v[212:215], v[92:95], v[192:195]
  v_cvt_pk_bf16_f32 v249, v198, v199
  s_waitcnt lgkmcnt(2)
  v_mfma_f32_16x16x32_bf16 v[184:187], v[216:219], v[96:99], v[184:187]
  ds_read_b128 v[212:215], v71 offset:256
  v_cvt_pk_bf16_f32 v250, v200, v201
  v_mfma_f32_16x16x32_bf16 v[188:191], v[216:219], v[100:103], v[188:191]
  s_add_u32 m0, s81, 26624
  s_nop 0
  buffer_load_dwordx4 v50, s[12:15], s80 offen lds
  v_mfma_f32_16x16x32_bf16 v[192:195], v[216:219], v[104:107], v[192:195]
  v_cvt_pk_bf16_f32 v251, v202, v203
  s_waitcnt lgkmcnt(2)
  v_mfma_f32_16x16x32_bf16 v[184:187], v[220:223], v[108:111], v[184:187]
  ds_read_b128 v[216:219], v70 offset:768
  v_accvgpr_write_b32 a14, v248
  v_mfma_f32_16x16x32_bf16 v[188:191], v[220:223], v[112:115], v[188:191]
  s_add_u32 m0, s81, 27648
  s_nop 0
  buffer_load_dwordx4 v51, s[12:15], s80 offen lds
  v_mfma_f32_16x16x32_bf16 v[192:195], v[220:223], v[116:119], v[192:195]
  v_accvgpr_write_b32 a15, v249
  s_waitcnt lgkmcnt(2)
  v_mfma_f32_16x16x32_bf16 v[184:187], v[208:211], v[120:123], v[184:187]
  ds_read_b128 v[220:223], v71 offset:768
  v_accvgpr_write_b32 a94, v250
  v_mfma_f32_16x16x32_bf16 v[188:191], v[208:211], v[124:127], v[188:191]
  s_add_u32 m0, s81, 28672
  s_nop 0
  buffer_load_dwordx4 v52, s[12:15], s80 offen lds
  v_mfma_f32_16x16x32_bf16 v[192:195], v[208:211], v[128:131], v[192:195]
  v_accvgpr_write_b32 a95, v251
  s_waitcnt lgkmcnt(2)
  v_mfma_f32_16x16x32_bf16 v[184:187], v[212:215], v[132:135], v[184:187]
  ds_read_b128 v[208:211], v70 offset:896
  s_mov_b64 exec, s[68:69]
  v_cvt_pk_bf16_f32 v150, v204, v205
  v_cvt_pk_bf16_f32 v151, v206, v207
  s_mov_b64 exec, -1
  v_mfma_f32_16x16x32_bf16 v[188:191], v[212:215], v[136:139], v[188:191]
  s_add_u32 m0, s81, 29696
  s_nop 0
  buffer_load_dwordx4 v53, s[12:15], s80 offen lds
  v_mfma_f32_16x16x32_bf16 v[192:195], v[212:215], v[140:143], v[192:195]
  s_waitcnt lgkmcnt(2)
  v_mfma_f32_16x16x32_bf16 v[196:199], v[216:219], v[72:75], 0
  ds_read_b128 v[212:215], v71 offset:896
  v_mfma_f32_16x16x32_bf16 v[200:203], v[216:219], v[76:79], 0
  s_add_u32 m0, s81, 30720
  s_nop 0
  buffer_load_dwordx4 v54, s[12:15], s80 offen lds
  v_mfma_f32_16x16x32_bf16 v[204:207], v[216:219], v[80:83], 0
  s_waitcnt lgkmcnt(2)
  v_mfma_f32_16x16x32_bf16 v[196:199], v[220:223], v[84:87], v[196:199]
  ds_read_b128 v[216:219], v70 offset:1024
  v_cvt_pk_bf16_f32 v248, v184, v185
  v_mfma_f32_16x16x32_bf16 v[200:203], v[220:223], v[88:91], v[200:203]
  s_add_u32 m0, s81, 31744
  s_nop 0
  buffer_load_dwordx4 v55, s[12:15], s80 offen lds
  v_mfma_f32_16x16x32_bf16 v[204:207], v[220:223], v[92:95], v[204:207]
  v_cvt_pk_bf16_f32 v249, v186, v187
  s_waitcnt lgkmcnt(2)
  v_mfma_f32_16x16x32_bf16 v[196:199], v[208:211], v[96:99], v[196:199]
  ds_read_b128 v[220:223], v71 offset:1024
  v_cvt_pk_bf16_f32 v250, v188, v189
  v_mfma_f32_16x16x32_bf16 v[200:203], v[208:211], v[100:103], v[200:203]
  s_add_u32 m0, s81, 32768
  s_nop 0
  buffer_load_dwordx4 v56, s[12:15], s80 offen lds
  v_mfma_f32_16x16x32_bf16 v[204:207], v[208:211], v[104:107], v[204:207]
  v_cvt_pk_bf16_f32 v251, v190, v191
  s_waitcnt lgkmcnt(2)
  v_mfma_f32_16x16x32_bf16 v[196:199], v[212:215], v[108:111], v[196:199]
  v_accvgpr_write_b32 a16, v248
  v_mfma_f32_16x16x32_bf16 v[200:203], v[212:215], v[112:115], v[200:203]
  s_add_u32 m0, s81, 33792
  s_nop 0
  buffer_load_dwordx4 v57, s[12:15], s80 offen lds
  v_mfma_f32_16x16x32_bf16 v[204:207], v[212:215], v[116:119], v[204:207]
  v_accvgpr_write_b32 a17, v249
  s_waitcnt lgkmcnt(1)
  v_mfma_f32_16x16x32_bf16 v[196:199], v[216:219], v[120:123], v[196:199]
  v_accvgpr_write_b32 a96, v250
  v_mfma_f32_16x16x32_bf16 v[200:203], v[216:219], v[124:127], v[200:203]
  s_add_u32 m0, s81, 34816
  s_nop 0
  buffer_load_dwordx4 v58, s[12:15], s80 offen lds
  v_mfma_f32_16x16x32_bf16 v[204:207], v[216:219], v[128:131], v[204:207]
  v_accvgpr_write_b32 a97, v251
  s_waitcnt lgkmcnt(0)
  v_mfma_f32_16x16x32_bf16 v[196:199], v[220:223], v[132:135], v[196:199]
  v_cvt_pk_bf16_f32 v152, v192, v193
  v_cvt_pk_bf16_f32 v153, v194, v195
  v_mfma_f32_16x16x32_bf16 v[200:203], v[220:223], v[136:139], v[200:203]
  s_add_u32 m0, s81, 35840
  s_nop 0
  buffer_load_dwordx4 v59, s[12:15], s80 offen lds
  s_add_u32 s80, s80, 393216
  v_mfma_f32_16x16x32_bf16 v[204:207], v[220:223], v[140:143], v[204:207]
  s_waitcnt vmcnt(12)
  ds_read_b128 v[208:211], v70 offset:12288
  ds_read_b128 v[212:215], v71 offset:12288
  ds_read_b128 v[216:219], v70 offset:12416
  s_waitcnt lgkmcnt(2)
  v_mfma_f32_16x16x32_bf16 v[184:187], v[208:211], v[72:75], 0
  ds_read_b128 v[220:223], v71 offset:12416
  v_mfma_f32_16x16x32_bf16 v[188:191], v[208:211], v[76:79], 0
  s_add_u32 m0, s81, 0
  s_nop 0
  buffer_load_dwordx4 v48, s[12:15], s80 offen lds
  v_mfma_f32_16x16x32_bf16 v[192:195], v[208:211], v[80:83], 0
  s_waitcnt lgkmcnt(2)
  v_mfma_f32_16x16x32_bf16 v[184:187], v[212:215], v[84:87], v[184:187]
  ds_read_b128 v[208:211], v70 offset:12544
  v_cvt_pk_bf16_f32 v248, v196, v197
  v_mfma_f32_16x16x32_bf16 v[188:191], v[212:215], v[88:91], v[188:191]
  s_add_u32 m0, s81, 1024
  s_nop 0
  buffer_load_dwordx4 v49, s[12:15], s80 offen lds
  v_mfma_f32_16x16x32_bf16 v[192:195], v[212:215], v[92:95], v[192:195]
  v_cvt_pk_bf16_f32 v249, v198, v199
  s_waitcnt lgkmcnt(2)
  v_mfma_f32_16x16x32_bf16 v[184:187], v[216:219], v[96:99], v[184:187]
  ds_read_b128 v[212:215], v71 offset:12544
  v_cvt_pk_bf16_f32 v250, v200, v201
  v_mfma_f32_16x16x32_bf16 v[188:191], v[216:219], v[100:103], v[188:191]
  s_add_u32 m0, s81, 2048
  s_nop 0
  buffer_load_dwordx4 v50, s[12:15], s80 offen lds
  v_mfma_f32_16x16x32_bf16 v[192:195], v[216:219], v[104:107], v[192:195]
  v_cvt_pk_bf16_f32 v251, v202, v203
  s_waitcnt lgkmcnt(2)
  v_mfma_f32_16x16x32_bf16 v[184:187], v[220:223], v[108:111], v[184:187]
  ds_read_b128 v[216:219], v70 offset:13056
  v_accvgpr_write_b32 a18, v248
  v_mfma_f32_16x16x32_bf16 v[188:191], v[220:223], v[112:115], v[188:191]
  s_add_u32 m0, s81, 3072
  s_nop 0
  buffer_load_dwordx4 v51, s[12:15], s80 offen lds
  v_mfma_f32_16x16x32_bf16 v[192:195], v[220:223], v[116:119], v[192:195]
  v_accvgpr_write_b32 a19, v249
  s_waitcnt lgkmcnt(2)
  v_mfma_f32_16x16x32_bf16 v[184:187], v[208:211], v[120:123], v[184:187]
  ds_read_b128 v[220:223], v71 offset:13056
  v_accvgpr_write_b32 a98, v250
  v_mfma_f32_16x16x32_bf16 v[188:191], v[208:211], v[124:127], v[188:191]
  s_add_u32 m0, s81, 4096
  s_nop 0
  buffer_load_dwordx4 v52, s[12:15], s80 offen lds
  v_mfma_f32_16x16x32_bf16 v[192:195], v[208:211], v[128:131], v[192:195]
  v_accvgpr_write_b32 a99, v251
  s_waitcnt lgkmcnt(2)
  v_mfma_f32_16x16x32_bf16 v[184:187], v[212:215], v[132:135], v[184:187]
  ds_read_b128 v[208:211], v70 offset:13184
  s_mov_b64 exec, s[68:69]
  v_cvt_pk_bf16_f32 v152, v204, v205
  v_cvt_pk_bf16_f32 v153, v206, v207
  s_mov_b64 exec, -1
  v_mfma_f32_16x16x32_bf16 v[188:191], v[212:215], v[136:139], v[188:191]
  s_add_u32 m0, s81, 5120
  s_nop 0
  buffer_load_dwordx4 v53, s[12:15], s80 offen lds
  v_mfma_f32_16x16x32_bf16 v[192:195], v[212:215], v[140:143], v[192:195]
  s_waitcnt lgkmcnt(2)
  v_mfma_f32_16x16x32_bf16 v[196:199], v[216:219], v[72:75], 0
  ds_read_b128 v[212:215], v71 offset:13184
  v_mfma_f32_16x16x32_bf16 v[200:203], v[216:219], v[76:79], 0
  s_add_u32 m0, s81, 6144
  s_nop 0
  buffer_load_dwordx4 v54, s[12:15], s80 offen lds
  v_mfma_f32_16x16x32_bf16 v[204:207], v[216:219], v[80:83], 0
  s_waitcnt lgkmcnt(2)
  v_mfma_f32_16x16x32_bf16 v[196:199], v[220:223], v[84:87], v[196:199]
  ds_read_b128 v[216:219], v70 offset:13312
  v_cvt_pk_bf16_f32 v248, v184, v185
  v_mfma_f32_16x16x32_bf16 v[200:203], v[220:223], v[88:91], v[200:203]
  s_add_u32 m0, s81, 7168
  s_nop 0
  buffer_load_dwordx4 v55, s[12:15], s80 offen lds
  v_mfma_f32_16x16x32_bf16 v[204:207], v[220:223], v[92:95], v[204:207]
  v_cvt_pk_bf16_f32 v249, v186, v187
  s_waitcnt lgkmcnt(2)
  v_mfma_f32_16x16x32_bf16 v[196:199], v[208:211], v[96:99], v[196:199]
  ds_read_b128 v[220:223], v71 offset:13312
  v_cvt_pk_bf16_f32 v250, v188, v189
  v_mfma_f32_16x16x32_bf16 v[200:203], v[208:211], v[100:103], v[200:203]
  s_add_u32 m0, s81, 8192
  s_nop 0
  buffer_load_dwordx4 v56, s[12:15], s80 offen lds
  v_mfma_f32_16x16x32_bf16 v[204:207], v[208:211], v[104:107], v[204:207]
  v_cvt_pk_bf16_f32 v251, v190, v191
  s_waitcnt lgkmcnt(2)
  v_mfma_f32_16x16x32_bf16 v[196:199], v[212:215], v[108:111], v[196:199]
  v_accvgpr_write_b32 a20, v248
  v_mfma_f32_16x16x32_bf16 v[200:203], v[212:215], v[112:115], v[200:203]
  s_add_u32 m0, s81, 9216
  s_nop 0
  buffer_load_dwordx4 v57, s[12:15], s80 offen lds
  v_mfma_f32_16x16x32_bf16 v[204:207], v[212:215], v[116:119], v[204:207]
  v_accvgpr_write_b32 a21, v249
  s_waitcnt lgkmcnt(1)
  v_mfma_f32_16x16x32_bf16 v[196:199], v[216:219], v[120:123], v[196:199]
  v_accvgpr_write_b32 a100, v250
  v_mfma_f32_16x16x32_bf16 v[200:203], v[216:219], v[124:127], v[200:203]
  s_add_u32 m0, s81, 10240
  s_nop 0
  buffer_load_dwordx4 v58, s[12:15], s80 offen lds
  v_mfma_f32_16x16x32_bf16 v[204:207], v[216:219], v[128:131], v[204:207]
  v_accvgpr_write_b32 a101, v251
  s_waitcnt lgkmcnt(0)
  v_mfma_f32_16x16x32_bf16 v[196:199], v[220:223], v[132:135], v[196:199]
  v_cvt_pk_bf16_f32 v154, v192, v193
  v_cvt_pk_bf16_f32 v155, v194, v195
  v_mfma_f32_16x16x32_bf16 v[200:203], v[220:223], v[136:139], v[200:203]
  s_add_u32 m0, s81, 11264
  s_nop 0
  buffer_load_dwordx4 v59, s[12:15], s80 offen lds
  s_add_u32 s80, s80, 393216
  v_mfma_f32_16x16x32_bf16 v[204:207], v[220:223], v[140:143], v[204:207]
  s_add_u32 s21, s79, 0
  buffer_load_dwordx4 a[172:175], v63, s[28:31], s21 offen
  s_add_u32 s21, s79, 0
  buffer_load_dwordx4 a[176:179], v64, s[28:31], s21 offen
  s_add_u32 s21, s79, 0
  buffer_load_dwordx4 a[180:183], v65, s[28:31], s21 offen
  s_waitcnt vmcnt(15)
  ds_read_b128 v[208:211], v70 offset:24576
  ds_read_b128 v[212:215], v71 offset:24576
  ds_read_b128 v[216:219], v70 offset:24704
  s_waitcnt lgkmcnt(2)
  v_mfma_f32_16x16x32_bf16 v[184:187], v[208:211], v[72:75], 0
  ds_read_b128 v[220:223], v71 offset:24704
  v_mfma_f32_16x16x32_bf16 v[188:191], v[208:211], v[76:79], 0
  s_add_u32 m0, s81, 12288
  s_nop 0
  buffer_load_dwordx4 v48, s[12:15], s80 offen lds
  v_mfma_f32_16x16x32_bf16 v[192:195], v[208:211], v[80:83], 0
  s_waitcnt lgkmcnt(2)
  v_mfma_f32_16x16x32_bf16 v[184:187], v[212:215], v[84:87], v[184:187]
  ds_read_b128 v[208:211], v70 offset:24832
  v_cvt_pk_bf16_f32 v248, v196, v197
  v_mfma_f32_16x16x32_bf16 v[188:191], v[212:215], v[88:91], v[188:191]
  s_add_u32 m0, s81, 13312
  s_nop 0
  buffer_load_dwordx4 v49, s[12:15], s80 offen lds
  v_mfma_f32_16x16x32_bf16 v[192:195], v[212:215], v[92:95], v[192:195]
  v_cvt_pk_bf16_f32 v249, v198, v199
  s_waitcnt lgkmcnt(2)
  v_mfma_f32_16x16x32_bf16 v[184:187], v[216:219], v[96:99], v[184:187]
  ds_read_b128 v[212:215], v71 offset:24832
  v_cvt_pk_bf16_f32 v250, v200, v201
  v_mfma_f32_16x16x32_bf16 v[188:191], v[216:219], v[100:103], v[188:191]
  s_add_u32 m0, s81, 14336
  s_nop 0
  buffer_load_dwordx4 v50, s[12:15], s80 offen lds
  v_mfma_f32_16x16x32_bf16 v[192:195], v[216:219], v[104:107], v[192:195]
  v_cvt_pk_bf16_f32 v251, v202, v203
  s_waitcnt lgkmcnt(2)
  v_mfma_f32_16x16x32_bf16 v[184:187], v[220:223], v[108:111], v[184:187]
  ds_read_b128 v[216:219], v70 offset:25344
  v_accvgpr_write_b32 a22, v248
  v_mfma_f32_16x16x32_bf16 v[188:191], v[220:223], v[112:115], v[188:191]
  s_add_u32 m0, s81, 15360
  s_nop 0
  buffer_load_dwordx4 v51, s[12:15], s80 offen lds
  v_mfma_f32_16x16x32_bf16 v[192:195], v[220:223], v[116:119], v[192:195]
  v_accvgpr_write_b32 a23, v249
  s_waitcnt lgkmcnt(2)
  v_mfma_f32_16x16x32_bf16 v[184:187], v[208:211], v[120:123], v[184:187]
  ds_read_b128 v[220:223], v71 offset:25344
  v_accvgpr_write_b32 a102, v250
  v_mfma_f32_16x16x32_bf16 v[188:191], v[208:211], v[124:127], v[188:191]
  s_add_u32 m0, s81, 16384
  s_nop 0
  buffer_load_dwordx4 v52, s[12:15], s80 offen lds
  v_mfma_f32_16x16x32_bf16 v[192:195], v[208:211], v[128:131], v[192:195]
  v_accvgpr_write_b32 a103, v251
  s_waitcnt lgkmcnt(2)
  v_mfma_f32_16x16x32_bf16 v[184:187], v[212:215], v[132:135], v[184:187]
  ds_read_b128 v[208:211], v70 offset:25472
  s_mov_b64 exec, s[68:69]
  v_cvt_pk_bf16_f32 v154, v204, v205
  v_cvt_pk_bf16_f32 v155, v206, v207
  s_mov_b64 exec, -1
  v_mfma_f32_16x16x32_bf16 v[188:191], v[212:215], v[136:139], v[188:191]
  s_add_u32 m0, s81, 17408
  s_nop 0
  buffer_load_dwordx4 v53, s[12:15], s80 offen lds
  v_mfma_f32_16x16x32_bf16 v[192:195], v[212:215], v[140:143], v[192:195]
  s_waitcnt lgkmcnt(2)
  v_mfma_f32_16x16x32_bf16 v[196:199], v[216:219], v[72:75], 0
  ds_read_b128 v[212:215], v71 offset:25472
  v_mfma_f32_16x16x32_bf16 v[200:203], v[216:219], v[76:79], 0
  s_add_u32 m0, s81, 18432
  s_nop 0
  buffer_load_dwordx4 v54, s[12:15], s80 offen lds
  v_mfma_f32_16x16x32_bf16 v[204:207], v[216:219], v[80:83], 0
  s_waitcnt lgkmcnt(2)
  v_mfma_f32_16x16x32_bf16 v[196:199], v[220:223], v[84:87], v[196:199]
  ds_read_b128 v[216:219], v70 offset:25600
  v_cvt_pk_bf16_f32 v248, v184, v185
  v_mfma_f32_16x16x32_bf16 v[200:203], v[220:223], v[88:91], v[200:203]
  s_add_u32 m0, s81, 19456
  s_nop 0
  buffer_load_dwordx4 v55, s[12:15], s80 offen lds
  v_mfma_f32_16x16x32_bf16 v[204:207], v[220:223], v[92:95], v[204:207]
  v_cvt_pk_bf16_f32 v249, v186, v187
  s_waitcnt lgkmcnt(2)
  v_mfma_f32_16x16x32_bf16 v[196:199], v[208:211], v[96:99], v[196:199]
  ds_read_b128 v[220:223], v71 offset:25600
  v_cvt_pk_bf16_f32 v250, v188, v189
  v_mfma_f32_16x16x32_bf16 v[200:203], v[208:211], v[100:103], v[200:203]
  s_add_u32 m0, s81, 20480
  s_nop 0
  buffer_load_dwordx4 v56, s[12:15], s80 offen lds
  v_mfma_f32_16x16x32_bf16 v[204:207], v[208:211], v[104:107], v[204:207]
  v_cvt_pk_bf16_f32 v251, v190, v191
  s_waitcnt lgkmcnt(2)
  v_mfma_f32_16x16x32_bf16 v[196:199], v[212:215], v[108:111], v[196:199]
  v_accvgpr_write_b32 a24, v248
  v_mfma_f32_16x16x32_bf16 v[200:203], v[212:215], v[112:115], v[200:203]
  s_add_u32 m0, s81, 21504
  s_nop 0
  buffer_load_dwordx4 v57, s[12:15], s80 offen lds
  v_mfma_f32_16x16x32_bf16 v[204:207], v[212:215], v[116:119], v[204:207]
  v_accvgpr_write_b32 a25, v249
  s_waitcnt lgkmcnt(1)
  v_mfma_f32_16x16x32_bf16 v[196:199], v[216:219], v[120:123], v[196:199]
  v_accvgpr_write_b32 a104, v250
  v_mfma_f32_16x16x32_bf16 v[200:203], v[216:219], v[124:127], v[200:203]
  s_add_u32 m0, s81, 22528
  s_nop 0
  buffer_load_dwordx4 v58, s[12:15], s80 offen lds
  v_mfma_f32_16x16x32_bf16 v[204:207], v[216:219], v[128:131], v[204:207]
  v_accvgpr_write_b32 a105, v251
  s_waitcnt lgkmcnt(0)
  v_mfma_f32_16x16x32_bf16 v[196:199], v[220:223], v[132:135], v[196:199]
  v_cvt_pk_bf16_f32 v156, v192, v193
  v_cvt_pk_bf16_f32 v157, v194, v195
  v_mfma_f32_16x16x32_bf16 v[200:203], v[220:223], v[136:139], v[200:203]
  s_add_u32 m0, s81, 23552
  s_nop 0
  buffer_load_dwordx4 v59, s[12:15], s80 offen lds
  s_add_u32 s80, s80, 393216
  v_mfma_f32_16x16x32_bf16 v[204:207], v[220:223], v[140:143], v[204:207]
  s_add_u32 s21, s79, 393216
  buffer_load_dwordx4 a[196:199], v63, s[28:31], s21 offen
  s_add_u32 s21, s79, 393216
  buffer_load_dwordx4 a[200:203], v64, s[28:31], s21 offen
  s_add_u32 s21, s79, 393216
  buffer_load_dwordx4 a[204:207], v65, s[28:31], s21 offen
  s_waitcnt vmcnt(18)
  ds_read_b128 v[208:211], v70 offset:0
  ds_read_b128 v[212:215], v71 offset:0
  ds_read_b128 v[216:219], v70 offset:128
  s_waitcnt lgkmcnt(2)
  v_mfma_f32_16x16x32_bf16 v[184:187], v[208:211], v[72:75], 0
  ds_read_b128 v[220:223], v71 offset:128
  v_mfma_f32_16x16x32_bf16 v[188:191], v[208:211], v[76:79], 0
  s_add_u32 m0, s81, 24576
  s_nop 0
  buffer_load_dwordx4 v48, s[12:15], s80 offen lds
  v_mfma_f32_16x16x32_bf16 v[192:195], v[208:211], v[80:83], 0
  s_waitcnt lgkmcnt(2)
  v_mfma_f32_16x16x32_bf16 v[184:187], v[212:215], v[84:87], v[184:187]
  ds_read_b128 v[208:211], v70 offset:256
  v_cvt_pk_bf16_f32 v248, v196, v197
  v_mfma_f32_16x16x32_bf16 v[188:191], v[212:215], v[88:91], v[188:191]
  s_add_u32 m0, s81, 25600
  s_nop 0
  buffer_load_dwordx4 v49, s[12:15], s80 offen lds
  v_mfma_f32_16x16x32_bf16 v[192:195], v[212:215], v[92:95], v[192:195]
  v_cvt_pk_bf16_f32 v249, v198, v199
  s_waitcnt lgkmcnt(2)
  v_mfma_f32_16x16x32_bf16 v[184:187], v[216:219], v[96:99], v[184:187]
  ds_read_b128 v[212:215], v71 offset:256
  v_cvt_pk_bf16_f32 v250, v200, v201
  v_mfma_f32_16x16x32_bf16 v[188:191], v[216:219], v[100:103], v[188:191]
  s_add_u32 m0, s81, 26624
  s_nop 0
  buffer_load_dwordx4 v50, s[12:15], s80 offen lds
  v_mfma_f32_16x16x32_bf16 v[192:195], v[216:219], v[104:107], v[192:195]
  v_cvt_pk_bf16_f32 v251, v202, v203
  s_waitcnt lgkmcnt(2)
  v_mfma_f32_16x16x32_bf16 v[184:187], v[220:223], v[108:111], v[184:187]
  ds_read_b128 v[216:219], v70 offset:768
  v_accvgpr_write_b32 a26, v248
  v_mfma_f32_16x16x32_bf16 v[188:191], v[220:223], v[112:115], v[188:191]
  s_add_u32 m0, s81, 27648
  s_nop 0
  buffer_load_dwordx4 v51, s[12:15], s80 offen lds
  v_mfma_f32_16x16x32_bf16 v[192:195], v[220:223], v[116:119], v[192:195]
  v_accvgpr_write_b32 a27, v249
  s_waitcnt lgkmcnt(2)
  v_mfma_f32_16x16x32_bf16 v[184:187], v[208:211], v[120:123], v[184:187]
  ds_read_b128 v[220:223], v71 offset:768
  v_accvgpr_write_b32 a106, v250
  v_mfma_f32_16x16x32_bf16 v[188:191], v[208:211], v[124:127], v[188:191]
  s_add_u32 m0, s81, 28672
  s_nop 0
  buffer_load_dwordx4 v52, s[12:15], s80 offen lds
  v_mfma_f32_16x16x32_bf16 v[192:195], v[208:211], v[128:131], v[192:195]
  v_accvgpr_write_b32 a107, v251
  s_waitcnt lgkmcnt(2)
  v_mfma_f32_16x16x32_bf16 v[184:187], v[212:215], v[132:135], v[184:187]
  ds_read_b128 v[208:211], v70 offset:896
  s_mov_b64 exec, s[68:69]
  v_cvt_pk_bf16_f32 v156, v204, v205
  v_cvt_pk_bf16_f32 v157, v206, v207
  s_mov_b64 exec, -1
  v_mfma_f32_16x16x32_bf16 v[188:191], v[212:215], v[136:139], v[188:191]
  s_add_u32 m0, s81, 29696
  s_nop 0
  buffer_load_dwordx4 v53, s[12:15], s80 offen lds
  v_mfma_f32_16x16x32_bf16 v[192:195], v[212:215], v[140:143], v[192:195]
  s_waitcnt lgkmcnt(2)
  v_mfma_f32_16x16x32_bf16 v[196:199], v[216:219], v[72:75], 0
  ds_read_b128 v[212:215], v71 offset:896
  v_mfma_f32_16x16x32_bf16 v[200:203], v[216:219], v[76:79], 0
  s_add_u32 m0, s81, 30720
  s_nop 0
  buffer_load_dwordx4 v54, s[12:15], s80 offen lds
  v_mfma_f32_16x16x32_bf16 v[204:207], v[216:219], v[80:83], 0
  s_waitcnt lgkmcnt(2)
  v_mfma_f32_16x16x32_bf16 v[196:199], v[220:223], v[84:87], v[196:199]
  ds_read_b128 v[216:219], v70 offset:1024
  v_cvt_pk_bf16_f32 v248, v184, v185
  v_mfma_f32_16x16x32_bf16 v[200:203], v[220:223], v[88:91], v[200:203]
  s_add_u32 m0, s81, 31744
  s_nop 0
  buffer_load_dwordx4 v55, s[12:15], s80 offen lds
  v_mfma_f32_16x16x32_bf16 v[204:207], v[220:223], v[92:95], v[204:207]
  v_cvt_pk_bf16_f32 v249, v186, v187
  s_waitcnt lgkmcnt(2)
  v_mfma_f32_16x16x32_bf16 v[196:199], v[208:211], v[96:99], v[196:199]
  ds_read_b128 v[220:223], v71 offset:1024
  v_cvt_pk_bf16_f32 v250, v188, v189
  v_mfma_f32_16x16x32_bf16 v[200:203], v[208:211], v[100:103], v[200:203]
  s_add_u32 m0, s81, 32768
  s_nop 0
  buffer_load_dwordx4 v56, s[12:15], s80 offen lds
  v_mfma_f32_16x16x32_bf16 v[204:207], v[208:211], v[104:107], v[204:207]
  v_cvt_pk_bf16_f32 v251, v190, v191
  s_waitcnt lgkmcnt(2)
  v_mfma_f32_16x16x32_bf16 v[196:199], v[212:215], v[108:111], v[196:199]
  v_accvgpr_write_b32 a28, v248
  v_mfma_f32_16x16x32_bf16 v[200:203], v[212:215], v[112:115], v[200:203]
  s_add_u32 m0, s81, 33792
  s_nop 0
  buffer_load_dwordx4 v57, s[12:15], s80 offen lds
  v_mfma_f32_16x16x32_bf16 v[204:207], v[212:215], v[116:119], v[204:207]
  v_accvgpr_write_b32 a29, v249
  s_waitcnt lgkmcnt(1)
  v_mfma_f32_16x16x32_bf16 v[196:199], v[216:219], v[120:123], v[196:199]
  v_accvgpr_write_b32 a108, v250
  v_mfma_f32_16x16x32_bf16 v[200:203], v[216:219], v[124:127], v[200:203]
  s_add_u32 m0, s81, 34816
  s_nop 0
  buffer_load_dwordx4 v58, s[12:15], s80 offen lds
  v_mfma_f32_16x16x32_bf16 v[204:207], v[216:219], v[128:131], v[204:207]
  v_accvgpr_write_b32 a109, v251
  s_waitcnt lgkmcnt(0)
  v_mfma_f32_16x16x32_bf16 v[196:199], v[220:223], v[132:135], v[196:199]
  v_cvt_pk_bf16_f32 v158, v192, v193
  v_cvt_pk_bf16_f32 v159, v194, v195
  v_mfma_f32_16x16x32_bf16 v[200:203], v[220:223], v[136:139], v[200:203]
  s_add_u32 m0, s81, 35840
  s_nop 0
  buffer_load_dwordx4 v59, s[12:15], s80 offen lds
  s_add_u32 s80, s80, 393216
  v_mfma_f32_16x16x32_bf16 v[204:207], v[220:223], v[140:143], v[204:207]
  s_add_u32 s21, s79, 786432
  buffer_load_dwordx4 a[220:223], v63, s[28:31], s21 offen
  s_add_u32 s21, s79, 786432
  buffer_load_dwordx4 a[224:227], v64, s[28:31], s21 offen
  s_add_u32 s21, s79, 786432
  buffer_load_dwordx4 a[228:231], v65, s[28:31], s21 offen
  s_waitcnt vmcnt(18)
  ds_read_b128 v[208:211], v70 offset:12288
  ds_read_b128 v[212:215], v71 offset:12288
  ds_read_b128 v[216:219], v70 offset:12416
  s_waitcnt lgkmcnt(2)
  v_mfma_f32_16x16x32_bf16 v[184:187], v[208:211], v[72:75], 0
  ds_read_b128 v[220:223], v71 offset:12416
  v_mfma_f32_16x16x32_bf16 v[188:191], v[208:211], v[76:79], 0
  s_add_u32 m0, s81, 0
  s_nop 0
  buffer_load_dwordx4 v48, s[12:15], s80 offen lds
  v_mfma_f32_16x16x32_bf16 v[192:195], v[208:211], v[80:83], 0
  s_waitcnt lgkmcnt(2)
  v_mfma_f32_16x16x32_bf16 v[184:187], v[212:215], v[84:87], v[184:187]
  ds_read_b128 v[208:211], v70 offset:12544
  v_cvt_pk_bf16_f32 v248, v196, v197
  v_mfma_f32_16x16x32_bf16 v[188:191], v[212:215], v[88:91], v[188:191]
  s_add_u32 m0, s81, 1024
  s_nop 0
  buffer_load_dwordx4 v49, s[12:15], s80 offen lds
  v_mfma_f32_16x16x32_bf16 v[192:195], v[212:215], v[92:95], v[192:195]
  v_cvt_pk_bf16_f32 v249, v198, v199
  s_waitcnt lgkmcnt(2)
  v_mfma_f32_16x16x32_bf16 v[184:187], v[216:219], v[96:99], v[184:187]
  ds_read_b128 v[212:215], v71 offset:12544
  v_cvt_pk_bf16_f32 v250, v200, v201
  v_mfma_f32_16x16x32_bf16 v[188:191], v[216:219], v[100:103], v[188:191]
  s_add_u32 m0, s81, 2048
  s_nop 0
  buffer_load_dwordx4 v50, s[12:15], s80 offen lds
  v_mfma_f32_16x16x32_bf16 v[192:195], v[216:219], v[104:107], v[192:195]
  v_cvt_pk_bf16_f32 v251, v202, v203
  s_waitcnt lgkmcnt(2)
  v_mfma_f32_16x16x32_bf16 v[184:187], v[220:223], v[108:111], v[184:187]
  ds_read_b128 v[216:219], v70 offset:13056
  v_accvgpr_write_b32 a30, v248
  v_mfma_f32_16x16x32_bf16 v[188:191], v[220:223], v[112:115], v[188:191]
  s_add_u32 m0, s81, 3072
  s_nop 0
  buffer_load_dwordx4 v51, s[12:15], s80 offen lds
  v_mfma_f32_16x16x32_bf16 v[192:195], v[220:223], v[116:119], v[192:195]
  v_accvgpr_write_b32 a31, v249
  s_waitcnt lgkmcnt(2)
  v_mfma_f32_16x16x32_bf16 v[184:187], v[208:211], v[120:123], v[184:187]
  ds_read_b128 v[220:223], v71 offset:13056
  v_accvgpr_write_b32 a110, v250
  v_mfma_f32_16x16x32_bf16 v[188:191], v[208:211], v[124:127], v[188:191]
  s_add_u32 m0, s81, 4096
  s_nop 0
  buffer_load_dwordx4 v52, s[12:15], s80 offen lds
  v_mfma_f32_16x16x32_bf16 v[192:195], v[208:211], v[128:131], v[192:195]
  v_accvgpr_write_b32 a111, v251
  s_waitcnt lgkmcnt(2)
  v_mfma_f32_16x16x32_bf16 v[184:187], v[212:215], v[132:135], v[184:187]
  ds_read_b128 v[208:211], v70 offset:13184
  s_mov_b64 exec, s[68:69]
  v_cvt_pk_bf16_f32 v158, v204, v205
  v_cvt_pk_bf16_f32 v159, v206, v207
  s_mov_b64 exec, -1
  v_mfma_f32_16x16x32_bf16 v[188:191], v[212:215], v[136:139], v[188:191]
  s_add_u32 m0, s81, 5120
  s_nop 0
  buffer_load_dwordx4 v53, s[12:15], s80 offen lds
  v_mfma_f32_16x16x32_bf16 v[192:195], v[212:215], v[140:143], v[192:195]
  s_waitcnt lgkmcnt(2)
  v_mfma_f32_16x16x32_bf16 v[196:199], v[216:219], v[72:75], 0
  ds_read_b128 v[212:215], v71 offset:13184
  v_mfma_f32_16x16x32_bf16 v[200:203], v[216:219], v[76:79], 0
  s_add_u32 m0, s81, 6144
  s_nop 0
  buffer_load_dwordx4 v54, s[12:15], s80 offen lds
  v_mfma_f32_16x16x32_bf16 v[204:207], v[216:219], v[80:83], 0
  s_waitcnt lgkmcnt(2)
  v_mfma_f32_16x16x32_bf16 v[196:199], v[220:223], v[84:87], v[196:199]
  ds_read_b128 v[216:219], v70 offset:13312
  v_cvt_pk_bf16_f32 v248, v184, v185
  v_mfma_f32_16x16x32_bf16 v[200:203], v[220:223], v[88:91], v[200:203]
  s_add_u32 m0, s81, 7168
  s_nop 0
  buffer_load_dwordx4 v55, s[12:15], s80 offen lds
  v_mfma_f32_16x16x32_bf16 v[204:207], v[220:223], v[92:95], v[204:207]
  v_cvt_pk_bf16_f32 v249, v186, v187
  s_waitcnt lgkmcnt(2)
  v_mfma_f32_16x16x32_bf16 v[196:199], v[208:211], v[96:99], v[196:199]
  ds_read_b128 v[220:223], v71 offset:13312
  v_cvt_pk_bf16_f32 v250, v188, v189
  v_mfma_f32_16x16x32_bf16 v[200:203], v[208:211], v[100:103], v[200:203]
  s_add_u32 m0, s81, 8192
  s_nop 0
  buffer_load_dwordx4 v56, s[12:15], s80 offen lds
  v_mfma_f32_16x16x32_bf16 v[204:207], v[208:211], v[104:107], v[204:207]
  v_cvt_pk_bf16_f32 v251, v190, v191
  s_waitcnt lgkmcnt(2)
  v_mfma_f32_16x16x32_bf16 v[196:199], v[212:215], v[108:111], v[196:199]
  v_accvgpr_write_b32 a32, v248
  v_mfma_f32_16x16x32_bf16 v[200:203], v[212:215], v[112:115], v[200:203]
  s_add_u32 m0, s81, 9216
  s_nop 0
  buffer_load_dwordx4 v57, s[12:15], s80 offen lds
  v_mfma_f32_16x16x32_bf16 v[204:207], v[212:215], v[116:119], v[204:207]
  v_accvgpr_write_b32 a33, v249
  s_waitcnt lgkmcnt(1)
  v_mfma_f32_16x16x32_bf16 v[196:199], v[216:219], v[120:123], v[196:199]
  v_accvgpr_write_b32 a112, v250
  v_mfma_f32_16x16x32_bf16 v[200:203], v[216:219], v[124:127], v[200:203]
  s_add_u32 m0, s81, 10240
  s_nop 0
  buffer_load_dwordx4 v58, s[12:15], s80 offen lds
  v_mfma_f32_16x16x32_bf16 v[204:207], v[216:219], v[128:131], v[204:207]
  v_accvgpr_write_b32 a113, v251
  s_waitcnt lgkmcnt(0)
  v_mfma_f32_16x16x32_bf16 v[196:199], v[220:223], v[132:135], v[196:199]
  v_cvt_pk_bf16_f32 v160, v192, v193
  v_cvt_pk_bf16_f32 v161, v194, v195
  v_mfma_f32_16x16x32_bf16 v[200:203], v[220:223], v[136:139], v[200:203]
  s_add_u32 m0, s81, 11264
  s_nop 0
  buffer_load_dwordx4 v59, s[12:15], s80 offen lds
  s_add_u32 s80, s80, 393216
  v_mfma_f32_16x16x32_bf16 v[204:207], v[220:223], v[140:143], v[204:207]
  s_add_u32 s21, s79, 1179648
  buffer_load_dwordx4 a[244:247], v63, s[28:31], s21 offen
  s_add_u32 s21, s79, 1179648
  buffer_load_dwordx4 a[248:251], v64, s[28:31], s21 offen
  s_add_u32 s21, s79, 1179648
  buffer_load_dwordx4 a[252:255], v65, s[28:31], s21 offen
  s_waitcnt vmcnt(18)
  ds_read_b128 v[208:211], v70 offset:24576
  ds_read_b128 v[212:215], v71 offset:24576
  ds_read_b128 v[216:219], v70 offset:24704
  s_waitcnt lgkmcnt(2)
  v_mfma_f32_16x16x32_bf16 v[184:187], v[208:211], v[72:75], 0
  ds_read_b128 v[220:223], v71 offset:24704
  v_mfma_f32_16x16x32_bf16 v[188:191], v[208:211], v[76:79], 0
  s_add_u32 m0, s81, 12288
  s_nop 0
  buffer_load_dwordx4 v48, s[12:15], s80 offen lds
  v_mfma_f32_16x16x32_bf16 v[192:195], v[208:211], v[80:83], 0
  s_waitcnt lgkmcnt(2)
  v_mfma_f32_16x16x32_bf16 v[184:187], v[212:215], v[84:87], v[184:187]
  ds_read_b128 v[208:211], v70 offset:24832
  v_cvt_pk_bf16_f32 v248, v196, v197
  v_mfma_f32_16x16x32_bf16 v[188:191], v[212:215], v[88:91], v[188:191]
  s_add_u32 m0, s81, 13312
  s_nop 0
  buffer_load_dwordx4 v49, s[12:15], s80 offen lds
  v_mfma_f32_16x16x32_bf16 v[192:195], v[212:215], v[92:95], v[192:195]
  v_cvt_pk_bf16_f32 v249, v198, v199
  s_waitcnt lgkmcnt(2)
  v_mfma_f32_16x16x32_bf16 v[184:187], v[216:219], v[96:99], v[184:187]
  ds_read_b128 v[212:215], v71 offset:24832
  v_cvt_pk_bf16_f32 v250, v200, v201
  v_mfma_f32_16x16x32_bf16 v[188:191], v[216:219], v[100:103], v[188:191]
  s_add_u32 m0, s81, 14336
  s_nop 0
  buffer_load_dwordx4 v50, s[12:15], s80 offen lds
  v_mfma_f32_16x16x32_bf16 v[192:195], v[216:219], v[104:107], v[192:195]
  v_cvt_pk_bf16_f32 v251, v202, v203
  s_waitcnt lgkmcnt(2)
  v_mfma_f32_16x16x32_bf16 v[184:187], v[220:223], v[108:111], v[184:187]
  ds_read_b128 v[216:219], v70 offset:25344
  v_accvgpr_write_b32 a34, v248
  v_mfma_f32_16x16x32_bf16 v[188:191], v[220:223], v[112:115], v[188:191]
  s_add_u32 m0, s81, 15360
  s_nop 0
  buffer_load_dwordx4 v51, s[12:15], s80 offen lds
  v_mfma_f32_16x16x32_bf16 v[192:195], v[220:223], v[116:119], v[192:195]
  v_accvgpr_write_b32 a35, v249
  s_waitcnt lgkmcnt(2)
  v_mfma_f32_16x16x32_bf16 v[184:187], v[208:211], v[120:123], v[184:187]
  ds_read_b128 v[220:223], v71 offset:25344
  v_accvgpr_write_b32 a114, v250
  v_mfma_f32_16x16x32_bf16 v[188:191], v[208:211], v[124:127], v[188:191]
  s_add_u32 m0, s81, 16384
  s_nop 0
  buffer_load_dwordx4 v52, s[12:15], s80 offen lds
  v_mfma_f32_16x16x32_bf16 v[192:195], v[208:211], v[128:131], v[192:195]
  v_accvgpr_write_b32 a115, v251
  s_waitcnt lgkmcnt(2)
  v_mfma_f32_16x16x32_bf16 v[184:187], v[212:215], v[132:135], v[184:187]
  ds_read_b128 v[208:211], v70 offset:25472
  s_mov_b64 exec, s[68:69]
  v_cvt_pk_bf16_f32 v160, v204, v205
  v_cvt_pk_bf16_f32 v161, v206, v207
  s_mov_b64 exec, -1
  v_mfma_f32_16x16x32_bf16 v[188:191], v[212:215], v[136:139], v[188:191]
  s_add_u32 m0, s81, 17408
  s_nop 0
  buffer_load_dwordx4 v53, s[12:15], s80 offen lds
  v_mfma_f32_16x16x32_bf16 v[192:195], v[212:215], v[140:143], v[192:195]
  s_waitcnt lgkmcnt(2)
  v_mfma_f32_16x16x32_bf16 v[196:199], v[216:219], v[72:75], 0
  ds_read_b128 v[212:215], v71 offset:25472
  v_mfma_f32_16x16x32_bf16 v[200:203], v[216:219], v[76:79], 0
  s_add_u32 m0, s81, 18432
  s_nop 0
  buffer_load_dwordx4 v54, s[12:15], s80 offen lds
  v_mfma_f32_16x16x32_bf16 v[204:207], v[216:219], v[80:83], 0
  s_waitcnt lgkmcnt(2)
  v_mfma_f32_16x16x32_bf16 v[196:199], v[220:223], v[84:87], v[196:199]
  ds_read_b128 v[216:219], v70 offset:25600
  v_cvt_pk_bf16_f32 v248, v184, v185
  v_mfma_f32_16x16x32_bf16 v[200:203], v[220:223], v[88:91], v[200:203]
  s_add_u32 m0, s81, 19456
  s_nop 0
  buffer_load_dwordx4 v55, s[12:15], s80 offen lds
  v_mfma_f32_16x16x32_bf16 v[204:207], v[220:223], v[92:95], v[204:207]
  v_cvt_pk_bf16_f32 v249, v186, v187
  s_waitcnt lgkmcnt(2)
  v_mfma_f32_16x16x32_bf16 v[196:199], v[208:211], v[96:99], v[196:199]
  ds_read_b128 v[220:223], v71 offset:25600
  v_cvt_pk_bf16_f32 v250, v188, v189
  v_mfma_f32_16x16x32_bf16 v[200:203], v[208:211], v[100:103], v[200:203]
  s_add_u32 m0, s81, 20480
  s_nop 0
  buffer_load_dwordx4 v56, s[12:15], s80 offen lds
  v_mfma_f32_16x16x32_bf16 v[204:207], v[208:211], v[104:107], v[204:207]
  v_cvt_pk_bf16_f32 v251, v190, v191
  s_waitcnt lgkmcnt(2)
  v_mfma_f32_16x16x32_bf16 v[196:199], v[212:215], v[108:111], v[196:199]
  v_accvgpr_write_b32 a36, v248
  v_mfma_f32_16x16x32_bf16 v[200:203], v[212:215], v[112:115], v[200:203]
  s_add_u32 m0, s81, 21504
  s_nop 0
  buffer_load_dwordx4 v57, s[12:15], s80 offen lds
  v_mfma_f32_16x16x32_bf16 v[204:207], v[212:215], v[116:119], v[204:207]
  v_accvgpr_write_b32 a37, v249
  s_waitcnt lgkmcnt(1)
  v_mfma_f32_16x16x32_bf16 v[196:199], v[216:219], v[120:123], v[196:199]
  v_accvgpr_write_b32 a116, v250
  v_mfma_f32_16x16x32_bf16 v[200:203], v[216:219], v[124:127], v[200:203]
  s_add_u32 m0, s81, 22528
  s_nop 0
  buffer_load_dwordx4 v58, s[12:15], s80 offen lds
  v_mfma_f32_16x16x32_bf16 v[204:207], v[216:219], v[128:131], v[204:207]
  v_accvgpr_write_b32 a117, v251
  s_waitcnt lgkmcnt(0)
  v_mfma_f32_16x16x32_bf16 v[196:199], v[220:223], v[132:135], v[196:199]
  v_cvt_pk_bf16_f32 v162, v192, v193
  v_cvt_pk_bf16_f32 v163, v194, v195
  v_mfma_f32_16x16x32_bf16 v[200:203], v[220:223], v[136:139], v[200:203]
  s_add_u32 m0, s81, 23552
  s_nop 0
  buffer_load_dwordx4 v59, s[12:15], s80 offen lds
  s_add_u32 s80, s80, 393216
  v_mfma_f32_16x16x32_bf16 v[204:207], v[220:223], v[140:143], v[204:207]
  s_add_u32 s21, s79, 1572864
  buffer_load_dwordx4 v[236:239], v63, s[28:31], s21 offen
  s_add_u32 s21, s79, 1572864
  buffer_load_dwordx4 v[240:243], v64, s[28:31], s21 offen
  s_add_u32 s21, s79, 1572864
  buffer_load_dwordx4 v[244:247], v65, s[28:31], s21 offen
  s_waitcnt vmcnt(18)
  ds_read_b128 v[208:211], v70 offset:0
  ds_read_b128 v[212:215], v71 offset:0
  ds_read_b128 v[216:219], v70 offset:128
  s_waitcnt lgkmcnt(2)
  v_mfma_f32_16x16x32_bf16 v[184:187], v[208:211], v[72:75], 0
  ds_read_b128 v[220:223], v71 offset:128
  v_mfma_f32_16x16x32_bf16 v[188:191], v[208:211], v[76:79], 0
  s_add_u32 m0, s81, 24576
  s_nop 0
  buffer_load_dwordx4 v48, s[12:15], s80 offen lds
  ds_write_b64 v69, v[144:145] offset:36864
  v_mfma_f32_16x16x32_bf16 v[192:195], v[208:211], v[80:83], 0
  s_waitcnt lgkmcnt(3)
  v_mfma_f32_16x16x32_bf16 v[184:187], v[212:215], v[84:87], v[184:187]
  ds_read_b128 v[208:211], v70 offset:256
  v_cvt_pk_bf16_f32 v248, v196, v197
  v_mfma_f32_16x16x32_bf16 v[188:191], v[212:215], v[88:91], v[188:191]
  s_add_u32 m0, s81, 25600
  s_nop 0
  buffer_load_dwordx4 v49, s[12:15], s80 offen lds
  ds_write_b64 v69, v[146:147] offset:37376
  v_mfma_f32_16x16x32_bf16 v[192:195], v[212:215], v[92:95], v[192:195]
  v_cvt_pk_bf16_f32 v249, v198, v199
  s_waitcnt lgkmcnt(4)
  v_mfma_f32_16x16x32_bf16 v[184:187], v[216:219], v[96:99], v[184:187]
  ds_read_b128 v[212:215], v71 offset:256
  v_cvt_pk_bf16_f32 v250, v200, v201
  v_mfma_f32_16x16x32_bf16 v[188:191], v[216:219], v[100:103], v[188:191]
  s_add_u32 m0, s81, 26624
  s_nop 0
  buffer_load_dwordx4 v50, s[12:15], s80 offen lds
  ds_write_b64 v69, v[148:149] offset:37888
  v_mfma_f32_16x16x32_bf16 v[192:195], v[216:219], v[104:107], v[192:195]
  v_cvt_pk_bf16_f32 v251, v202, v203
  s_waitcnt lgkmcnt(5)
  v_mfma_f32_16x16x32_bf16 v[184:187], v[220:223], v[108:111], v[184:187]
  ds_read_b128 v[216:219], v70 offset:768
  v_accvgpr_write_b32 a38, v248
  v_mfma_f32_16x16x32_bf16 v[188:191], v[220:223], v[112:115], v[188:191]
  s_add_u32 m0, s81, 27648
  s_nop 0
  buffer_load_dwordx4 v51, s[12:15], s80 offen lds
  ds_write_b64 v69, v[150:151] offset:38400
  v_mfma_f32_16x16x32_bf16 v[192:195], v[220:223], v[116:119], v[192:195]
  v_accvgpr_write_b32 a39, v249
  s_waitcnt lgkmcnt(5)
  v_mfma_f32_16x16x32_bf16 v[184:187], v[208:211], v[120:123], v[184:187]
  ds_read_b128 v[220:223], v71 offset:768
  v_accvgpr_write_b32 a118, v250
  v_mfma_f32_16x16x32_bf16 v[188:191], v[208:211], v[124:127], v[188:191]
  s_add_u32 m0, s81, 28672
  s_nop 0
  buffer_load_dwordx4 v52, s[12:15], s80 offen lds
  ds_write_b64 v69, v[152:153] offset:38912
  v_mfma_f32_16x16x32_bf16 v[192:195], v[208:211], v[128:131], v[192:195]
  v_accvgpr_write_b32 a119, v251
  s_waitcnt lgkmcnt(5)
  v_mfma_f32_16x16x32_bf16 v[184:187], v[212:215], v[132:135], v[184:187]
  ds_read_b128 v[208:211], v70 offset:896
  s_mov_b64 exec, s[68:69]
  v_cvt_pk_bf16_f32 v162, v204, v205
  v_cvt_pk_bf16_f32 v163, v206, v207
  s_mov_b64 exec, -1
  v_mfma_f32_16x16x32_bf16 v[188:191], v[212:215], v[136:139], v[188:191]
  s_add_u32 m0, s81, 29696
  s_nop 0
  buffer_load_dwordx4 v53, s[12:15], s80 offen lds
  ds_write_b64 v69, v[154:155] offset:39424
  v_mfma_f32_16x16x32_bf16 v[192:195], v[212:215], v[140:143], v[192:195]
  s_waitcnt lgkmcnt(5)
  v_mfma_f32_16x16x32_bf16 v[196:199], v[216:219], v[72:75], 0
  ds_read_b128 v[212:215], v71 offset:896
  v_mfma_f32_16x16x32_bf16 v[200:203], v[216:219], v[76:79], 0
  s_add_u32 m0, s81, 30720
  s_nop 0
  buffer_load_dwordx4 v54, s[12:15], s80 offen lds
  ds_write_b64 v69, v[156:157] offset:39936
  v_mfma_f32_16x16x32_bf16 v[204:207], v[216:219], v[80:83], 0
  s_waitcnt lgkmcnt(5)
  v_mfma_f32_16x16x32_bf16 v[196:199], v[220:223], v[84:87], v[196:199]
  ds_read_b128 v[216:219], v70 offset:1024
  v_cvt_pk_bf16_f32 v248, v184, v185
  v_mfma_f32_16x16x32_bf16 v[200:203], v[220:223], v[88:91], v[200:203]
  s_add_u32 m0, s81, 31744
  s_nop 0
  buffer_load_dwordx4 v55, s[12:15], s80 offen lds
  ds_write_b64 v69, v[158:159] offset:40448
  v_mfma_f32_16x16x32_bf16 v[204:207], v[220:223], v[92:95], v[204:207]
  v_cvt_pk_bf16_f32 v249, v186, v187
  s_waitcnt lgkmcnt(5)
  v_mfma_f32_16x16x32_bf16 v[196:199], v[208:211], v[96:99], v[196:199]
  ds_read_b128 v[220:223], v71 offset:1024
  v_cvt_pk_bf16_f32 v250, v188, v189
  v_mfma_f32_16x16x32_bf16 v[200:203], v[208:211], v[100:103], v[200:203]
  s_add_u32 m0, s81, 32768
  s_nop 0
  buffer_load_dwordx4 v56, s[12:15], s80 offen lds
  v_mfma_f32_16x16x32_bf16 v[204:207], v[208:211], v[104:107], v[204:207]
  v_cvt_pk_bf16_f32 v251, v190, v191
  s_waitcnt lgkmcnt(4)
  v_mfma_f32_16x16x32_bf16 v[196:199], v[212:215], v[108:111], v[196:199]
  v_accvgpr_write_b32 a40, v248
  v_mfma_f32_16x16x32_bf16 v[200:203], v[212:215], v[112:115], v[200:203]
  s_add_u32 m0, s81, 33792
  s_nop 0
  buffer_load_dwordx4 v57, s[12:15], s80 offen lds
  v_mfma_f32_16x16x32_bf16 v[204:207], v[212:215], v[116:119], v[204:207]
  v_accvgpr_write_b32 a41, v249
  s_waitcnt lgkmcnt(2)
  v_mfma_f32_16x16x32_bf16 v[196:199], v[216:219], v[120:123], v[196:199]
  v_accvgpr_write_b32 a120, v250
  v_mfma_f32_16x16x32_bf16 v[200:203], v[216:219], v[124:127], v[200:203]
  s_add_u32 m0, s81, 34816
  s_nop 0
  buffer_load_dwordx4 v58, s[12:15], s80 offen lds
  v_mfma_f32_16x16x32_bf16 v[204:207], v[216:219], v[128:131], v[204:207]
  v_accvgpr_write_b32 a121, v251
  s_waitcnt lgkmcnt(0)
  v_mfma_f32_16x16x32_bf16 v[196:199], v[220:223], v[132:135], v[196:199]
  v_cvt_pk_bf16_f32 v164, v192, v193
  v_cvt_pk_bf16_f32 v165, v194, v195
  v_mfma_f32_16x16x32_bf16 v[200:203], v[220:223], v[136:139], v[200:203]
  s_add_u32 m0, s81, 35840
  s_nop 0
  buffer_load_dwordx4 v59, s[12:15], s80 offen lds
  s_add_u32 s80, s80, 393216
  v_mfma_f32_16x16x32_bf16 v[204:207], v[220:223], v[140:143], v[204:207]
  s_add_u32 s21, s79, 0
  buffer_load_dwordx4 a[160:163], v63, s[24:27], s21 offen
  s_add_u32 s21, s79, 0
  buffer_load_dwordx4 a[164:167], v64, s[24:27], s21 offen
  s_add_u32 s21, s79, 0
  buffer_load_dwordx4 a[168:171], v65, s[24:27], s21 offen
  s_waitcnt vmcnt(18)
  ds_read_b128 v[208:211], v70 offset:12288
  ds_read_b128 v[212:215], v71 offset:12288
  ds_read_b128 v[216:219], v70 offset:12416
  s_waitcnt lgkmcnt(2)
  v_mfma_f32_16x16x32_bf16 v[184:187], v[208:211], v[72:75], 0
  ds_read_b128 v[220:223], v71 offset:12416
  v_mfma_f32_16x16x32_bf16 v[188:191], v[208:211], v[76:79], 0
  s_add_u32 m0, s81, 0
  s_nop 0
  buffer_load_dwordx4 v48, s[12:15], s80 offen lds
  v_mfma_f32_16x16x32_bf16 v[192:195], v[208:211], v[80:83], 0
  s_waitcnt lgkmcnt(2)
  v_mfma_f32_16x16x32_bf16 v[184:187], v[212:215], v[84:87], v[184:187]
  ds_read_b128 v[208:211], v70 offset:12544
  v_cvt_pk_bf16_f32 v248, v196, v197
  v_mfma_f32_16x16x32_bf16 v[188:191], v[212:215], v[88:91], v[188:191]
  s_add_u32 m0, s81, 1024
  s_nop 0
  buffer_load_dwordx4 v49, s[12:15], s80 offen lds
  v_mfma_f32_16x16x32_bf16 v[192:195], v[212:215], v[92:95], v[192:195]
  v_cvt_pk_bf16_f32 v249, v198, v199
  s_waitcnt lgkmcnt(2)
  v_mfma_f32_16x16x32_bf16 v[184:187], v[216:219], v[96:99], v[184:187]
  ds_read_b128 v[212:215], v71 offset:12544
  v_cvt_pk_bf16_f32 v250, v200, v201
  v_mfma_f32_16x16x32_bf16 v[188:191], v[216:219], v[100:103], v[188:191]
  s_add_u32 m0, s81, 2048
  s_nop 0
  buffer_load_dwordx4 v50, s[12:15], s80 offen lds
  v_mfma_f32_16x16x32_bf16 v[192:195], v[216:219], v[104:107], v[192:195]
  v_cvt_pk_bf16_f32 v251, v202, v203
  s_waitcnt lgkmcnt(2)
  v_mfma_f32_16x16x32_bf16 v[184:187], v[220:223], v[108:111], v[184:187]
  ds_read_b128 v[216:219], v70 offset:13056
  v_accvgpr_write_b32 a42, v248
  v_mfma_f32_16x16x32_bf16 v[188:191], v[220:223], v[112:115], v[188:191]
  s_add_u32 m0, s81, 3072
  s_nop 0
  buffer_load_dwordx4 v51, s[12:15], s80 offen lds
  v_mfma_f32_16x16x32_bf16 v[192:195], v[220:223], v[116:119], v[192:195]
  v_accvgpr_write_b32 a43, v249
  s_waitcnt lgkmcnt(2)
  v_mfma_f32_16x16x32_bf16 v[184:187], v[208:211], v[120:123], v[184:187]
  ds_read_b128 v[220:223], v71 offset:13056
  v_accvgpr_write_b32 a122, v250
  v_mfma_f32_16x16x32_bf16 v[188:191], v[208:211], v[124:127], v[188:191]
  s_add_u32 m0, s81, 4096
  s_nop 0
  buffer_load_dwordx4 v52, s[12:15], s80 offen lds
  v_mfma_f32_16x16x32_bf16 v[192:195], v[208:211], v[128:131], v[192:195]
  v_accvgpr_write_b32 a123, v251
  s_waitcnt lgkmcnt(2)
  v_mfma_f32_16x16x32_bf16 v[184:187], v[212:215], v[132:135], v[184:187]
  ds_read_b128 v[208:211], v70 offset:13184
  s_mov_b64 exec, s[68:69]
  v_cvt_pk_bf16_f32 v164, v204, v205
  v_cvt_pk_bf16_f32 v165, v206, v207
  s_mov_b64 exec, -1
  v_mfma_f32_16x16x32_bf16 v[188:191], v[212:215], v[136:139], v[188:191]
  s_add_u32 m0, s81, 5120
  s_nop 0
  buffer_load_dwordx4 v53, s[12:15], s80 offen lds
  v_mfma_f32_16x16x32_bf16 v[192:195], v[212:215], v[140:143], v[192:195]
  s_waitcnt lgkmcnt(2)
  v_mfma_f32_16x16x32_bf16 v[196:199], v[216:219], v[72:75], 0
  ds_read_b128 v[212:215], v71 offset:13184
  v_mfma_f32_16x16x32_bf16 v[200:203], v[216:219], v[76:79], 0
  s_add_u32 m0, s81, 6144
  s_nop 0
  buffer_load_dwordx4 v54, s[12:15], s80 offen lds
  v_mfma_f32_16x16x32_bf16 v[204:207], v[216:219], v[80:83], 0
  s_waitcnt lgkmcnt(2)
  v_mfma_f32_16x16x32_bf16 v[196:199], v[220:223], v[84:87], v[196:199]
  ds_read_b128 v[216:219], v70 offset:13312
  v_cvt_pk_bf16_f32 v248, v184, v185
  v_mfma_f32_16x16x32_bf16 v[200:203], v[220:223], v[88:91], v[200:203]
  s_add_u32 m0, s81, 7168
  s_nop 0
  buffer_load_dwordx4 v55, s[12:15], s80 offen lds
  v_mfma_f32_16x16x32_bf16 v[204:207], v[220:223], v[92:95], v[204:207]
  v_cvt_pk_bf16_f32 v249, v186, v187
  s_waitcnt lgkmcnt(2)
  v_mfma_f32_16x16x32_bf16 v[196:199], v[208:211], v[96:99], v[196:199]
  ds_read_b128 v[220:223], v71 offset:13312
  v_cvt_pk_bf16_f32 v250, v188, v189
  v_mfma_f32_16x16x32_bf16 v[200:203], v[208:211], v[100:103], v[200:203]
  s_add_u32 m0, s81, 8192
  s_nop 0
  buffer_load_dwordx4 v56, s[12:15], s80 offen lds
  v_mfma_f32_16x16x32_bf16 v[204:207], v[208:211], v[104:107], v[204:207]
  v_cvt_pk_bf16_f32 v251, v190, v191
  s_waitcnt lgkmcnt(2)
  v_mfma_f32_16x16x32_bf16 v[196:199], v[212:215], v[108:111], v[196:199]
  v_accvgpr_write_b32 a44, v248
  v_mfma_f32_16x16x32_bf16 v[200:203], v[212:215], v[112:115], v[200:203]
  s_add_u32 m0, s81, 9216
  s_nop 0
  buffer_load_dwordx4 v57, s[12:15], s80 offen lds
  v_mfma_f32_16x16x32_bf16 v[204:207], v[212:215], v[116:119], v[204:207]
  v_accvgpr_write_b32 a45, v249
  s_waitcnt lgkmcnt(1)
  v_mfma_f32_16x16x32_bf16 v[196:199], v[216:219], v[120:123], v[196:199]
  v_accvgpr_write_b32 a124, v250
  v_mfma_f32_16x16x32_bf16 v[200:203], v[216:219], v[124:127], v[200:203]
  s_add_u32 m0, s81, 10240
  s_nop 0
  buffer_load_dwordx4 v58, s[12:15], s80 offen lds
  v_mfma_f32_16x16x32_bf16 v[204:207], v[216:219], v[128:131], v[204:207]
  v_accvgpr_write_b32 a125, v251
  s_waitcnt lgkmcnt(0)
  v_mfma_f32_16x16x32_bf16 v[196:199], v[220:223], v[132:135], v[196:199]
  v_cvt_pk_bf16_f32 v166, v192, v193
  v_cvt_pk_bf16_f32 v167, v194, v195
  v_mfma_f32_16x16x32_bf16 v[200:203], v[220:223], v[136:139], v[200:203]
  s_add_u32 m0, s81, 11264
  s_nop 0
  buffer_load_dwordx4 v59, s[12:15], s80 offen lds
  s_add_u32 s80, s80, 393216
  v_mfma_f32_16x16x32_bf16 v[204:207], v[220:223], v[140:143], v[204:207]
  s_add_u32 s21, s79, 393216
  buffer_load_dwordx4 a[184:187], v63, s[24:27], s21 offen
  s_add_u32 s21, s79, 393216
  buffer_load_dwordx4 a[188:191], v64, s[24:27], s21 offen
  s_add_u32 s21, s79, 393216
  buffer_load_dwordx4 a[192:195], v65, s[24:27], s21 offen
  s_waitcnt vmcnt(18)
  ds_read_b128 v[208:211], v70 offset:24576
  ds_read_b128 v[212:215], v71 offset:24576
  ds_read_b128 v[216:219], v70 offset:24704
  s_waitcnt lgkmcnt(2)
  v_mfma_f32_16x16x32_bf16 v[184:187], v[208:211], v[72:75], 0
  ds_read_b128 v[220:223], v71 offset:24704
  v_mfma_f32_16x16x32_bf16 v[188:191], v[208:211], v[76:79], 0
  s_add_u32 m0, s81, 12288
  s_nop 0
  buffer_load_dwordx4 v48, s[12:15], s80 offen lds
  v_mfma_f32_16x16x32_bf16 v[192:195], v[208:211], v[80:83], 0
  s_waitcnt lgkmcnt(2)
  v_mfma_f32_16x16x32_bf16 v[184:187], v[212:215], v[84:87], v[184:187]
  ds_read_b128 v[208:211], v70 offset:24832
  v_cvt_pk_bf16_f32 v248, v196, v197
  v_mfma_f32_16x16x32_bf16 v[188:191], v[212:215], v[88:91], v[188:191]
  s_add_u32 m0, s81, 13312
  s_nop 0
  buffer_load_dwordx4 v49, s[12:15], s80 offen lds
  v_mfma_f32_16x16x32_bf16 v[192:195], v[212:215], v[92:95], v[192:195]
  v_cvt_pk_bf16_f32 v249, v198, v199
  s_waitcnt lgkmcnt(2)
  v_mfma_f32_16x16x32_bf16 v[184:187], v[216:219], v[96:99], v[184:187]
  ds_read_b128 v[212:215], v71 offset:24832
  v_cvt_pk_bf16_f32 v250, v200, v201
  v_mfma_f32_16x16x32_bf16 v[188:191], v[216:219], v[100:103], v[188:191]
  s_add_u32 m0, s81, 14336
  s_nop 0
  buffer_load_dwordx4 v50, s[12:15], s80 offen lds
  v_mfma_f32_16x16x32_bf16 v[192:195], v[216:219], v[104:107], v[192:195]
  v_cvt_pk_bf16_f32 v251, v202, v203
  s_waitcnt lgkmcnt(2)
  v_mfma_f32_16x16x32_bf16 v[184:187], v[220:223], v[108:111], v[184:187]
  ds_read_b128 v[216:219], v70 offset:25344
  v_accvgpr_write_b32 a46, v248
  v_mfma_f32_16x16x32_bf16 v[188:191], v[220:223], v[112:115], v[188:191]
  s_add_u32 m0, s81, 15360
  s_nop 0
  buffer_load_dwordx4 v51, s[12:15], s80 offen lds
  v_mfma_f32_16x16x32_bf16 v[192:195], v[220:223], v[116:119], v[192:195]
  v_accvgpr_write_b32 a47, v249
  s_waitcnt lgkmcnt(2)
  v_mfma_f32_16x16x32_bf16 v[184:187], v[208:211], v[120:123], v[184:187]
  ds_read_b128 v[220:223], v71 offset:25344
  v_accvgpr_write_b32 a126, v250
  v_mfma_f32_16x16x32_bf16 v[188:191], v[208:211], v[124:127], v[188:191]
  s_add_u32 m0, s81, 16384
  s_nop 0
  buffer_load_dwordx4 v52, s[12:15], s80 offen lds
  v_mfma_f32_16x16x32_bf16 v[192:195], v[208:211], v[128:131], v[192:195]
  v_accvgpr_write_b32 a127, v251
  s_waitcnt lgkmcnt(2)
  v_mfma_f32_16x16x32_bf16 v[184:187], v[212:215], v[132:135], v[184:187]
  ds_read_b128 v[208:211], v70 offset:25472
  s_mov_b64 exec, s[68:69]
  v_cvt_pk_bf16_f32 v166, v204, v205
  v_cvt_pk_bf16_f32 v167, v206, v207
  s_mov_b64 exec, -1
  v_mfma_f32_16x16x32_bf16 v[188:191], v[212:215], v[136:139], v[188:191]
  s_add_u32 m0, s81, 17408
  s_nop 0
  buffer_load_dwordx4 v53, s[12:15], s80 offen lds
  v_mfma_f32_16x16x32_bf16 v[192:195], v[212:215], v[140:143], v[192:195]
  s_waitcnt lgkmcnt(2)
  v_mfma_f32_16x16x32_bf16 v[196:199], v[216:219], v[72:75], 0
  ds_read_b128 v[212:215], v71 offset:25472
  v_mfma_f32_16x16x32_bf16 v[200:203], v[216:219], v[76:79], 0
  s_add_u32 m0, s81, 18432
  s_nop 0
  buffer_load_dwordx4 v54, s[12:15], s80 offen lds
  v_mfma_f32_16x16x32_bf16 v[204:207], v[216:219], v[80:83], 0
  s_waitcnt lgkmcnt(2)
  v_mfma_f32_16x16x32_bf16 v[196:199], v[220:223], v[84:87], v[196:199]
  ds_read_b128 v[216:219], v70 offset:25600
  v_cvt_pk_bf16_f32 v248, v184, v185
  v_mfma_f32_16x16x32_bf16 v[200:203], v[220:223], v[88:91], v[200:203]
  s_add_u32 m0, s81, 19456
  s_nop 0
  buffer_load_dwordx4 v55, s[12:15], s80 offen lds
  v_mfma_f32_16x16x32_bf16 v[204:207], v[220:223], v[92:95], v[204:207]
  v_cvt_pk_bf16_f32 v249, v186, v187
  s_waitcnt lgkmcnt(2)
  v_mfma_f32_16x16x32_bf16 v[196:199], v[208:211], v[96:99], v[196:199]
  ds_read_b128 v[220:223], v71 offset:25600
  v_cvt_pk_bf16_f32 v250, v188, v189
  v_mfma_f32_16x16x32_bf16 v[200:203], v[208:211], v[100:103], v[200:203]
  s_add_u32 m0, s81, 20480
  s_nop 0
  buffer_load_dwordx4 v56, s[12:15], s80 offen lds
  v_mfma_f32_16x16x32_bf16 v[204:207], v[208:211], v[104:107], v[204:207]
  v_cvt_pk_bf16_f32 v251, v190, v191
  s_waitcnt lgkmcnt(2)
  v_mfma_f32_16x16x32_bf16 v[196:199], v[212:215], v[108:111], v[196:199]
  v_accvgpr_write_b32 a48, v248
  v_mfma_f32_16x16x32_bf16 v[200:203], v[212:215], v[112:115], v[200:203]
  s_add_u32 m0, s81, 21504
  s_nop 0
  buffer_load_dwordx4 v57, s[12:15], s80 offen lds
  v_mfma_f32_16x16x32_bf16 v[204:207], v[212:215], v[116:119], v[204:207]
  v_accvgpr_write_b32 a49, v249
  s_waitcnt lgkmcnt(1)
  v_mfma_f32_16x16x32_bf16 v[196:199], v[216:219], v[120:123], v[196:199]
  v_accvgpr_write_b32 a128, v250
  v_mfma_f32_16x16x32_bf16 v[200:203], v[216:219], v[124:127], v[200:203]
  s_add_u32 m0, s81, 22528
  s_nop 0
  buffer_load_dwordx4 v58, s[12:15], s80 offen lds
  v_mfma_f32_16x16x32_bf16 v[204:207], v[216:219], v[128:131], v[204:207]
  v_accvgpr_write_b32 a129, v251
  s_waitcnt lgkmcnt(0)
  v_mfma_f32_16x16x32_bf16 v[196:199], v[220:223], v[132:135], v[196:199]
  v_cvt_pk_bf16_f32 v168, v192, v193
  v_cvt_pk_bf16_f32 v169, v194, v195
  v_mfma_f32_16x16x32_bf16 v[200:203], v[220:223], v[136:139], v[200:203]
  s_add_u32 m0, s81, 23552
  s_nop 0
  buffer_load_dwordx4 v59, s[12:15], s80 offen lds
  s_add_u32 s80, s80, 393216
  v_mfma_f32_16x16x32_bf16 v[204:207], v[220:223], v[140:143], v[204:207]
  s_add_u32 s21, s79, 786432
  buffer_load_dwordx4 a[208:211], v63, s[24:27], s21 offen
  s_add_u32 s21, s79, 786432
  buffer_load_dwordx4 a[212:215], v64, s[24:27], s21 offen
  s_add_u32 s21, s79, 786432
  buffer_load_dwordx4 a[216:219], v65, s[24:27], s21 offen
  s_waitcnt vmcnt(18)
  buffer_load_dword v66, v67, s[32:35], 0 offen sc1
  ds_read_b128 v[208:211], v70 offset:0
  ds_read_b128 v[212:215], v71 offset:0
  ds_read_b128 v[216:219], v70 offset:128
  s_waitcnt lgkmcnt(2)
  v_mfma_f32_16x16x32_bf16 v[184:187], v[208:211], v[72:75], 0
  ds_read_b128 v[220:223], v71 offset:128
  v_mfma_f32_16x16x32_bf16 v[188:191], v[208:211], v[76:79], 0
  s_add_u32 m0, s81, 24576
  s_nop 0
  buffer_load_dwordx4 v48, s[12:15], s80 offen lds
  v_mfma_f32_16x16x32_bf16 v[192:195], v[208:211], v[80:83], 0
  s_waitcnt lgkmcnt(2)
  v_mfma_f32_16x16x32_bf16 v[184:187], v[212:215], v[84:87], v[184:187]
  ds_read_b128 v[208:211], v70 offset:256
  v_cvt_pk_bf16_f32 v248, v196, v197
  v_mfma_f32_16x16x32_bf16 v[188:191], v[212:215], v[88:91], v[188:191]
  s_add_u32 m0, s81, 25600
  s_nop 0
  buffer_load_dwordx4 v49, s[12:15], s80 offen lds
  v_mfma_f32_16x16x32_bf16 v[192:195], v[212:215], v[92:95], v[192:195]
  v_cvt_pk_bf16_f32 v249, v198, v199
  s_waitcnt lgkmcnt(2)
  v_mfma_f32_16x16x32_bf16 v[184:187], v[216:219], v[96:99], v[184:187]
  ds_read_b128 v[212:215], v71 offset:256
  v_cvt_pk_bf16_f32 v250, v200, v201
  v_mfma_f32_16x16x32_bf16 v[188:191], v[216:219], v[100:103], v[188:191]
  s_add_u32 m0, s81, 26624
  s_nop 0
  buffer_load_dwordx4 v50, s[12:15], s80 offen lds
  v_mfma_f32_16x16x32_bf16 v[192:195], v[216:219], v[104:107], v[192:195]
  v_cvt_pk_bf16_f32 v251, v202, v203
  s_waitcnt lgkmcnt(2)
  v_mfma_f32_16x16x32_bf16 v[184:187], v[220:223], v[108:111], v[184:187]
  ds_read_b128 v[216:219], v70 offset:768
  v_accvgpr_write_b32 a50, v248
  v_mfma_f32_16x16x32_bf16 v[188:191], v[220:223], v[112:115], v[188:191]
  s_add_u32 m0, s81, 27648
  s_nop 0
  buffer_load_dwordx4 v51, s[12:15], s80 offen lds
  v_mfma_f32_16x16x32_bf16 v[192:195], v[220:223], v[116:119], v[192:195]
  v_accvgpr_write_b32 a51, v249
  s_waitcnt lgkmcnt(2)
  v_mfma_f32_16x16x32_bf16 v[184:187], v[208:211], v[120:123], v[184:187]
  ds_read_b128 v[220:223], v71 offset:768
  v_accvgpr_write_b32 a130, v250
  v_mfma_f32_16x16x32_bf16 v[188:191], v[208:211], v[124:127], v[188:191]
  s_add_u32 m0, s81, 28672
  s_nop 0
  buffer_load_dwordx4 v52, s[12:15], s80 offen lds
  v_mfma_f32_16x16x32_bf16 v[192:195], v[208:211], v[128:131], v[192:195]
  v_accvgpr_write_b32 a131, v251
  s_waitcnt lgkmcnt(2)
  v_mfma_f32_16x16x32_bf16 v[184:187], v[212:215], v[132:135], v[184:187]
  ds_read_b128 v[208:211], v70 offset:896
  s_mov_b64 exec, s[68:69]
  v_cvt_pk_bf16_f32 v168, v204, v205
  v_cvt_pk_bf16_f32 v169, v206, v207
  s_mov_b64 exec, -1
  v_mfma_f32_16x16x32_bf16 v[188:191], v[212:215], v[136:139], v[188:191]
  s_add_u32 m0, s81, 29696
  s_nop 0
  buffer_load_dwordx4 v53, s[12:15], s80 offen lds
  v_mfma_f32_16x16x32_bf16 v[192:195], v[212:215], v[140:143], v[192:195]
  s_waitcnt lgkmcnt(2)
  v_mfma_f32_16x16x32_bf16 v[196:199], v[216:219], v[72:75], 0
  ds_read_b128 v[212:215], v71 offset:896
  v_mfma_f32_16x16x32_bf16 v[200:203], v[216:219], v[76:79], 0
  s_add_u32 m0, s81, 30720
  s_nop 0
  buffer_load_dwordx4 v54, s[12:15], s80 offen lds
  v_mfma_f32_16x16x32_bf16 v[204:207], v[216:219], v[80:83], 0
  s_waitcnt lgkmcnt(2)
  v_mfma_f32_16x16x32_bf16 v[196:199], v[220:223], v[84:87], v[196:199]
  ds_read_b128 v[216:219], v70 offset:1024
  v_cvt_pk_bf16_f32 v248, v184, v185
  v_mfma_f32_16x16x32_bf16 v[200:203], v[220:223], v[88:91], v[200:203]
  s_add_u32 m0, s81, 31744
  s_nop 0
  buffer_load_dwordx4 v55, s[12:15], s80 offen lds
  v_mfma_f32_16x16x32_bf16 v[204:207], v[220:223], v[92:95], v[204:207]
  v_cvt_pk_bf16_f32 v249, v186, v187
  s_waitcnt lgkmcnt(2)
  v_mfma_f32_16x16x32_bf16 v[196:199], v[208:211], v[96:99], v[196:199]
  ds_read_b128 v[220:223], v71 offset:1024
  v_cvt_pk_bf16_f32 v250, v188, v189
  v_mfma_f32_16x16x32_bf16 v[200:203], v[208:211], v[100:103], v[200:203]
  s_add_u32 m0, s81, 32768
  s_nop 0
  buffer_load_dwordx4 v56, s[12:15], s80 offen lds
  v_mfma_f32_16x16x32_bf16 v[204:207], v[208:211], v[104:107], v[204:207]
  v_cvt_pk_bf16_f32 v251, v190, v191
  s_waitcnt lgkmcnt(2)
  v_mfma_f32_16x16x32_bf16 v[196:199], v[212:215], v[108:111], v[196:199]
  v_accvgpr_write_b32 a52, v248
  v_mfma_f32_16x16x32_bf16 v[200:203], v[212:215], v[112:115], v[200:203]
  s_add_u32 m0, s81, 33792
  s_nop 0
  buffer_load_dwordx4 v57, s[12:15], s80 offen lds
  v_mfma_f32_16x16x32_bf16 v[204:207], v[212:215], v[116:119], v[204:207]
  v_accvgpr_write_b32 a53, v249
  s_waitcnt lgkmcnt(1)
  v_mfma_f32_16x16x32_bf16 v[196:199], v[216:219], v[120:123], v[196:199]
  v_accvgpr_write_b32 a132, v250
  v_mfma_f32_16x16x32_bf16 v[200:203], v[216:219], v[124:127], v[200:203]
  s_add_u32 m0, s81, 34816
  s_nop 0
  buffer_load_dwordx4 v58, s[12:15], s80 offen lds
  v_mfma_f32_16x16x32_bf16 v[204:207], v[216:219], v[128:131], v[204:207]
  v_accvgpr_write_b32 a133, v251
  s_waitcnt lgkmcnt(0)
  v_mfma_f32_16x16x32_bf16 v[196:199], v[220:223], v[132:135], v[196:199]
  v_cvt_pk_bf16_f32 v170, v192, v193
  v_cvt_pk_bf16_f32 v171, v194, v195
  v_mfma_f32_16x16x32_bf16 v[200:203], v[220:223], v[136:139], v[200:203]
  s_add_u32 m0, s81, 35840
  s_nop 0
  buffer_load_dwordx4 v59, s[12:15], s80 offen lds
  s_add_u32 s80, s80, 393216
  v_mfma_f32_16x16x32_bf16 v[204:207], v[220:223], v[140:143], v[204:207]
  s_add_u32 s21, s79, 1179648
  buffer_load_dwordx4 a[232:235], v63, s[24:27], s21 offen
  s_add_u32 s21, s79, 1179648
  buffer_load_dwordx4 a[236:239], v64, s[24:27], s21 offen
  s_add_u32 s21, s79, 1179648
  buffer_load_dwordx4 a[240:243], v65, s[24:27], s21 offen
  s_waitcnt vmcnt(19)
  ds_read_b128 v[208:211], v70 offset:12288
  ds_read_b128 v[212:215], v71 offset:12288
  ds_read_b128 v[216:219], v70 offset:12416
  s_waitcnt lgkmcnt(2)
  v_mfma_f32_16x16x32_bf16 v[184:187], v[208:211], v[72:75], 0
  ds_read_b128 v[220:223], v71 offset:12416
  v_mfma_f32_16x16x32_bf16 v[188:191], v[208:211], v[76:79], 0
  s_add_u32 m0, s81, 0
  s_nop 0
  buffer_load_dwordx4 v48, s[12:15], s80 offen lds
  v_mfma_f32_16x16x32_bf16 v[192:195], v[208:211], v[80:83], 0
  s_waitcnt lgkmcnt(2)
  v_mfma_f32_16x16x32_bf16 v[184:187], v[212:215], v[84:87], v[184:187]
  ds_read_b128 v[208:211], v70 offset:12544
  v_cvt_pk_bf16_f32 v248, v196, v197
  v_mfma_f32_16x16x32_bf16 v[188:191], v[212:215], v[88:91], v[188:191]
  s_add_u32 m0, s81, 1024
  s_nop 0
  buffer_load_dwordx4 v49, s[12:15], s80 offen lds
  v_mfma_f32_16x16x32_bf16 v[192:195], v[212:215], v[92:95], v[192:195]
  v_cvt_pk_bf16_f32 v249, v198, v199
  s_waitcnt lgkmcnt(2)
  v_mfma_f32_16x16x32_bf16 v[184:187], v[216:219], v[96:99], v[184:187]
  ds_read_b128 v[212:215], v71 offset:12544
  v_cvt_pk_bf16_f32 v250, v200, v201
  v_mfma_f32_16x16x32_bf16 v[188:191], v[216:219], v[100:103], v[188:191]
  s_add_u32 m0, s81, 2048
  s_nop 0
  buffer_load_dwordx4 v50, s[12:15], s80 offen lds
  v_mfma_f32_16x16x32_bf16 v[192:195], v[216:219], v[104:107], v[192:195]
  v_cvt_pk_bf16_f32 v251, v202, v203
  s_waitcnt lgkmcnt(2)
  v_mfma_f32_16x16x32_bf16 v[184:187], v[220:223], v[108:111], v[184:187]
  ds_read_b128 v[216:219], v70 offset:13056
  v_accvgpr_write_b32 a54, v248
  v_mfma_f32_16x16x32_bf16 v[188:191], v[220:223], v[112:115], v[188:191]
  s_add_u32 m0, s81, 3072
  s_nop 0
  buffer_load_dwordx4 v51, s[12:15], s80 offen lds
  v_mfma_f32_16x16x32_bf16 v[192:195], v[220:223], v[116:119], v[192:195]
  v_accvgpr_write_b32 a55, v249
  s_waitcnt lgkmcnt(2)
  v_mfma_f32_16x16x32_bf16 v[184:187], v[208:211], v[120:123], v[184:187]
  ds_read_b128 v[220:223], v71 offset:13056
  v_accvgpr_write_b32 a134, v250
  v_mfma_f32_16x16x32_bf16 v[188:191], v[208:211], v[124:127], v[188:191]
  s_add_u32 m0, s81, 4096
  s_nop 0
  buffer_load_dwordx4 v52, s[12:15], s80 offen lds
  v_mfma_f32_16x16x32_bf16 v[192:195], v[208:211], v[128:131], v[192:195]
  v_accvgpr_write_b32 a135, v251
  s_waitcnt lgkmcnt(2)
  v_mfma_f32_16x16x32_bf16 v[184:187], v[212:215], v[132:135], v[184:187]
  ds_read_b128 v[208:211], v70 offset:13184
  s_mov_b64 exec, s[68:69]
  v_cvt_pk_bf16_f32 v170, v204, v205
  v_cvt_pk_bf16_f32 v171, v206, v207
  s_mov_b64 exec, -1
  v_mfma_f32_16x16x32_bf16 v[188:191], v[212:215], v[136:139], v[188:191]
  s_add_u32 m0, s81, 5120
  s_nop 0
  buffer_load_dwordx4 v53, s[12:15], s80 offen lds
  v_mfma_f32_16x16x32_bf16 v[192:195], v[212:215], v[140:143], v[192:195]
  s_waitcnt lgkmcnt(2)
  v_mfma_f32_16x16x32_bf16 v[196:199], v[216:219], v[72:75], 0
  ds_read_b128 v[212:215], v71 offset:13184
  v_mfma_f32_16x16x32_bf16 v[200:203], v[216:219], v[76:79], 0
  s_add_u32 m0, s81, 6144
  s_nop 0
  buffer_load_dwordx4 v54, s[12:15], s80 offen lds
  v_mfma_f32_16x16x32_bf16 v[204:207], v[216:219], v[80:83], 0
  s_waitcnt lgkmcnt(2)
  v_mfma_f32_16x16x32_bf16 v[196:199], v[220:223], v[84:87], v[196:199]
  ds_read_b128 v[216:219], v70 offset:13312
  v_cvt_pk_bf16_f32 v248, v184, v185
  v_mfma_f32_16x16x32_bf16 v[200:203], v[220:223], v[88:91], v[200:203]
  s_add_u32 m0, s81, 7168
  s_nop 0
  buffer_load_dwordx4 v55, s[12:15], s80 offen lds
  v_mfma_f32_16x16x32_bf16 v[204:207], v[220:223], v[92:95], v[204:207]
  v_cvt_pk_bf16_f32 v249, v186, v187
  s_waitcnt lgkmcnt(2)
  v_mfma_f32_16x16x32_bf16 v[196:199], v[208:211], v[96:99], v[196:199]
  ds_read_b128 v[220:223], v71 offset:13312
  v_cvt_pk_bf16_f32 v250, v188, v189
  v_mfma_f32_16x16x32_bf16 v[200:203], v[208:211], v[100:103], v[200:203]
  s_add_u32 m0, s81, 8192
  s_nop 0
  buffer_load_dwordx4 v56, s[12:15], s80 offen lds
  v_mfma_f32_16x16x32_bf16 v[204:207], v[208:211], v[104:107], v[204:207]
  v_cvt_pk_bf16_f32 v251, v190, v191
  s_waitcnt lgkmcnt(2)
  v_mfma_f32_16x16x32_bf16 v[196:199], v[212:215], v[108:111], v[196:199]
  v_accvgpr_write_b32 a56, v248
  v_mfma_f32_16x16x32_bf16 v[200:203], v[212:215], v[112:115], v[200:203]
  s_add_u32 m0, s81, 9216
  s_nop 0
  buffer_load_dwordx4 v57, s[12:15], s80 offen lds
  v_mfma_f32_16x16x32_bf16 v[204:207], v[212:215], v[116:119], v[204:207]
  v_accvgpr_write_b32 a57, v249
  s_waitcnt lgkmcnt(1)
  v_mfma_f32_16x16x32_bf16 v[196:199], v[216:219], v[120:123], v[196:199]
  v_accvgpr_write_b32 a136, v250
  v_mfma_f32_16x16x32_bf16 v[200:203], v[216:219], v[124:127], v[200:203]
  s_add_u32 m0, s81, 10240
  s_nop 0
  buffer_load_dwordx4 v58, s[12:15], s80 offen lds
  v_mfma_f32_16x16x32_bf16 v[204:207], v[216:219], v[128:131], v[204:207]
  v_accvgpr_write_b32 a137, v251
  s_waitcnt lgkmcnt(0)
  v_mfma_f32_16x16x32_bf16 v[196:199], v[220:223], v[132:135], v[196:199]
  v_cvt_pk_bf16_f32 v172, v192, v193
  v_cvt_pk_bf16_f32 v173, v194, v195
  v_mfma_f32_16x16x32_bf16 v[200:203], v[220:223], v[136:139], v[200:203]
  s_add_u32 m0, s81, 11264
  s_nop 0
  buffer_load_dwordx4 v59, s[12:15], s80 offen lds
  s_add_u32 s80, s80, 393216
  v_mfma_f32_16x16x32_bf16 v[204:207], v[220:223], v[140:143], v[204:207]
  s_add_u32 s21, s79, 1572864
  buffer_load_dwordx4 v[224:227], v63, s[24:27], s21 offen
  s_add_u32 s21, s79, 1572864
  buffer_load_dwordx4 v[228:231], v64, s[24:27], s21 offen
  s_add_u32 s21, s79, 1572864
  buffer_load_dwordx4 v[232:235], v65, s[24:27], s21 offen
  s_waitcnt vmcnt(18)
  ds_read_b128 v[208:211], v70 offset:24576
  ds_read_b128 v[212:215], v71 offset:24576
  ds_read_b128 v[216:219], v70 offset:24704
  s_waitcnt lgkmcnt(2)
  v_mfma_f32_16x16x32_bf16 v[184:187], v[208:211], v[72:75], 0
  ds_read_b128 v[220:223], v71 offset:24704
  v_mfma_f32_16x16x32_bf16 v[188:191], v[208:211], v[76:79], 0
  s_add_u32 m0, s81, 12288
  s_nop 0
  buffer_load_dwordx4 v48, s[12:15], s80 offen lds
  v_mfma_f32_16x16x32_bf16 v[192:195], v[208:211], v[80:83], 0
  s_waitcnt lgkmcnt(2)
  v_mfma_f32_16x16x32_bf16 v[184:187], v[212:215], v[84:87], v[184:187]
  ds_read_b128 v[208:211], v70 offset:24832
  v_cvt_pk_bf16_f32 v248, v196, v197
  v_mfma_f32_16x16x32_bf16 v[188:191], v[212:215], v[88:91], v[188:191]
  s_add_u32 m0, s81, 13312
  s_nop 0
  buffer_load_dwordx4 v49, s[12:15], s80 offen lds
  v_mfma_f32_16x16x32_bf16 v[192:195], v[212:215], v[92:95], v[192:195]
  v_cvt_pk_bf16_f32 v249, v198, v199
  s_waitcnt lgkmcnt(2)
  v_mfma_f32_16x16x32_bf16 v[184:187], v[216:219], v[96:99], v[184:187]
  ds_read_b128 v[212:215], v71 offset:24832
  v_cvt_pk_bf16_f32 v250, v200, v201
  v_mfma_f32_16x16x32_bf16 v[188:191], v[216:219], v[100:103], v[188:191]
  s_add_u32 m0, s81, 14336
  s_nop 0
  buffer_load_dwordx4 v50, s[12:15], s80 offen lds
  v_mfma_f32_16x16x32_bf16 v[192:195], v[216:219], v[104:107], v[192:195]
  v_cvt_pk_bf16_f32 v251, v202, v203
  s_waitcnt lgkmcnt(2)
  v_mfma_f32_16x16x32_bf16 v[184:187], v[220:223], v[108:111], v[184:187]
  ds_read_b128 v[216:219], v70 offset:25344
  v_accvgpr_write_b32 a58, v248
  v_mfma_f32_16x16x32_bf16 v[188:191], v[220:223], v[112:115], v[188:191]
  s_add_u32 m0, s81, 15360
  s_nop 0
  buffer_load_dwordx4 v51, s[12:15], s80 offen lds
  v_mfma_f32_16x16x32_bf16 v[192:195], v[220:223], v[116:119], v[192:195]
  v_accvgpr_write_b32 a59, v249
  s_waitcnt lgkmcnt(2)
  v_mfma_f32_16x16x32_bf16 v[184:187], v[208:211], v[120:123], v[184:187]
  ds_read_b128 v[220:223], v71 offset:25344
  v_accvgpr_write_b32 a138, v250
  v_mfma_f32_16x16x32_bf16 v[188:191], v[208:211], v[124:127], v[188:191]
  s_add_u32 m0, s81, 16384
  s_nop 0
  buffer_load_dwordx4 v52, s[12:15], s80 offen lds
  v_mfma_f32_16x16x32_bf16 v[192:195], v[208:211], v[128:131], v[192:195]
  v_accvgpr_write_b32 a139, v251
  s_waitcnt lgkmcnt(2)
  v_mfma_f32_16x16x32_bf16 v[184:187], v[212:215], v[132:135], v[184:187]
  ds_read_b128 v[208:211], v70 offset:25472
  s_mov_b64 exec, s[68:69]
  v_cvt_pk_bf16_f32 v172, v204, v205
  v_cvt_pk_bf16_f32 v173, v206, v207
  s_mov_b64 exec, -1
  v_mfma_f32_16x16x32_bf16 v[188:191], v[212:215], v[136:139], v[188:191]
  s_add_u32 m0, s81, 17408
  s_nop 0
  buffer_load_dwordx4 v53, s[12:15], s80 offen lds
  v_mfma_f32_16x16x32_bf16 v[192:195], v[212:215], v[140:143], v[192:195]
  s_waitcnt lgkmcnt(2)
  v_mfma_f32_16x16x32_bf16 v[196:199], v[216:219], v[72:75], 0
  ds_read_b128 v[212:215], v71 offset:25472
  v_mfma_f32_16x16x32_bf16 v[200:203], v[216:219], v[76:79], 0
  s_add_u32 m0, s81, 18432
  s_nop 0
  buffer_load_dwordx4 v54, s[12:15], s80 offen lds
  v_mfma_f32_16x16x32_bf16 v[204:207], v[216:219], v[80:83], 0
  s_waitcnt lgkmcnt(2)
  v_mfma_f32_16x16x32_bf16 v[196:199], v[220:223], v[84:87], v[196:199]
  ds_read_b128 v[216:219], v70 offset:25600
  v_cvt_pk_bf16_f32 v248, v184, v185
  v_mfma_f32_16x16x32_bf16 v[200:203], v[220:223], v[88:91], v[200:203]
  s_add_u32 m0, s81, 19456
  s_nop 0
  buffer_load_dwordx4 v55, s[12:15], s80 offen lds
  v_mfma_f32_16x16x32_bf16 v[204:207], v[220:223], v[92:95], v[204:207]
  v_cvt_pk_bf16_f32 v249, v186, v187
  s_waitcnt lgkmcnt(2)
  v_mfma_f32_16x16x32_bf16 v[196:199], v[208:211], v[96:99], v[196:199]
  ds_read_b128 v[220:223], v71 offset:25600
  v_cvt_pk_bf16_f32 v250, v188, v189
  v_mfma_f32_16x16x32_bf16 v[200:203], v[208:211], v[100:103], v[200:203]
  s_add_u32 m0, s81, 20480
  s_nop 0
  buffer_load_dwordx4 v56, s[12:15], s80 offen lds
  v_mfma_f32_16x16x32_bf16 v[204:207], v[208:211], v[104:107], v[204:207]
  v_cvt_pk_bf16_f32 v251, v190, v191
  s_waitcnt lgkmcnt(2)
  v_mfma_f32_16x16x32_bf16 v[196:199], v[212:215], v[108:111], v[196:199]
  v_accvgpr_write_b32 a60, v248
  v_mfma_f32_16x16x32_bf16 v[200:203], v[212:215], v[112:115], v[200:203]
  s_add_u32 m0, s81, 21504
  s_nop 0
  buffer_load_dwordx4 v57, s[12:15], s80 offen lds
  v_mfma_f32_16x16x32_bf16 v[204:207], v[212:215], v[116:119], v[204:207]
  v_accvgpr_write_b32 a61, v249
  s_waitcnt lgkmcnt(1)
  v_mfma_f32_16x16x32_bf16 v[196:199], v[216:219], v[120:123], v[196:199]
  v_accvgpr_write_b32 a140, v250
  v_mfma_f32_16x16x32_bf16 v[200:203], v[216:219], v[124:127], v[200:203]
  s_add_u32 m0, s81, 22528
  s_nop 0
  buffer_load_dwordx4 v58, s[12:15], s80 offen lds
  v_mfma_f32_16x16x32_bf16 v[204:207], v[216:219], v[128:131], v[204:207]
  v_accvgpr_write_b32 a141, v251
  s_waitcnt lgkmcnt(0)
  v_mfma_f32_16x16x32_bf16 v[196:199], v[220:223], v[132:135], v[196:199]
  v_cvt_pk_bf16_f32 v174, v192, v193
  v_cvt_pk_bf16_f32 v175, v194, v195
  v_mfma_f32_16x16x32_bf16 v[200:203], v[220:223], v[136:139], v[200:203]
  s_add_u32 m0, s81, 23552
  s_nop 0
  buffer_load_dwordx4 v59, s[12:15], s80 offen lds
  s_add_u32 s80, s80, 393216
  v_mfma_f32_16x16x32_bf16 v[204:207], v[220:223], v[140:143], v[204:207]
  s_waitcnt vmcnt(15)
  s_and_b32 s21, s50, 1
  s_lshl_b32 s21, s21, 4
  s_add_u32 s21, s21, s51
  s_lshl_b32 s22, s21, 10
  s_add_u32 s22, s22, s77
  s_add_u32 s23, s77, 30720
  s_cmp_lt_u32 s21, 10
  s_cselect_b32 s23, 0, s23
  s_add_u32 s22, s22, s23
  s_mul_i32 s23, s20, 122880
  s_add_u32 s22, s22, s23
  buffer_load_dwordx4 v[252:255], v4, s[8:11], s22 offen sc1
  ds_read_b128 v[208:211], v70 offset:0
  ds_read_b128 v[212:215], v71 offset:0
  ds_read_b128 v[216:219], v70 offset:128
  s_waitcnt lgkmcnt(2)
  v_mfma_f32_16x16x32_bf16 v[184:187], v[208:211], v[72:75], 0
  ds_read_b128 v[220:223], v71 offset:128
  v_mfma_f32_16x16x32_bf16 v[188:191], v[208:211], v[76:79], 0
  s_add_u32 m0, s81, 24576
  s_nop 0
  buffer_load_dwordx4 v48, s[12:15], s80 offen lds
  v_mfma_f32_16x16x32_bf16 v[192:195], v[208:211], v[80:83], 0
  s_waitcnt lgkmcnt(2)
  v_mfma_f32_16x16x32_bf16 v[184:187], v[212:215], v[84:87], v[184:187]
  ds_read_b128 v[208:211], v70 offset:256
  v_cvt_pk_bf16_f32 v248, v196, v197
  v_mfma_f32_16x16x32_bf16 v[188:191], v[212:215], v[88:91], v[188:191]
  s_add_u32 m0, s81, 25600
  s_nop 0
  buffer_load_dwordx4 v49, s[12:15], s80 offen lds
  v_mfma_f32_16x16x32_bf16 v[192:195], v[212:215], v[92:95], v[192:195]
  v_cvt_pk_bf16_f32 v249, v198, v199
  s_waitcnt lgkmcnt(2)
  v_mfma_f32_16x16x32_bf16 v[184:187], v[216:219], v[96:99], v[184:187]
  ds_read_b128 v[212:215], v71 offset:256
  v_cvt_pk_bf16_f32 v250, v200, v201
  v_mfma_f32_16x16x32_bf16 v[188:191], v[216:219], v[100:103], v[188:191]
  s_add_u32 m0, s81, 26624
  s_nop 0
  buffer_load_dwordx4 v50, s[12:15], s80 offen lds
  v_mfma_f32_16x16x32_bf16 v[192:195], v[216:219], v[104:107], v[192:195]
  v_cvt_pk_bf16_f32 v251, v202, v203
  s_waitcnt lgkmcnt(2)
  v_mfma_f32_16x16x32_bf16 v[184:187], v[220:223], v[108:111], v[184:187]
  ds_read_b128 v[216:219], v70 offset:768
  v_accvgpr_write_b32 a62, v248
  v_mfma_f32_16x16x32_bf16 v[188:191], v[220:223], v[112:115], v[188:191]
  s_add_u32 m0, s81, 27648
  s_nop 0
  buffer_load_dwordx4 v51, s[12:15], s80 offen lds
  v_mfma_f32_16x16x32_bf16 v[192:195], v[220:223], v[116:119], v[192:195]
  v_accvgpr_write_b32 a63, v249
  s_waitcnt lgkmcnt(2)
  v_mfma_f32_16x16x32_bf16 v[184:187], v[208:211], v[120:123], v[184:187]
  ds_read_b128 v[220:223], v71 offset:768
  v_accvgpr_write_b32 a142, v250
  v_mfma_f32_16x16x32_bf16 v[188:191], v[208:211], v[124:127], v[188:191]
  s_add_u32 m0, s81, 28672
  s_nop 0
  buffer_load_dwordx4 v52, s[12:15], s80 offen lds
  v_mfma_f32_16x16x32_bf16 v[192:195], v[208:211], v[128:131], v[192:195]
  v_accvgpr_write_b32 a143, v251
  s_waitcnt lgkmcnt(2)
  v_mfma_f32_16x16x32_bf16 v[184:187], v[212:215], v[132:135], v[184:187]
  ds_read_b128 v[208:211], v70 offset:896
  s_mov_b64 exec, s[68:69]
  v_cvt_pk_bf16_f32 v174, v204, v205
  v_cvt_pk_bf16_f32 v175, v206, v207
  s_mov_b64 exec, -1
  v_mfma_f32_16x16x32_bf16 v[188:191], v[212:215], v[136:139], v[188:191]
  s_add_u32 m0, s81, 29696
  s_nop 0
  buffer_load_dwordx4 v53, s[12:15], s80 offen lds
  v_mfma_f32_16x16x32_bf16 v[192:195], v[212:215], v[140:143], v[192:195]
  s_waitcnt lgkmcnt(2)
  v_mfma_f32_16x16x32_bf16 v[196:199], v[216:219], v[72:75], 0
  ds_read_b128 v[212:215], v71 offset:896
  v_mfma_f32_16x16x32_bf16 v[200:203], v[216:219], v[76:79], 0
  s_add_u32 m0, s81, 30720
  s_nop 0
  buffer_load_dwordx4 v54, s[12:15], s80 offen lds
  v_mfma_f32_16x16x32_bf16 v[204:207], v[216:219], v[80:83], 0
  s_waitcnt lgkmcnt(2)
  v_mfma_f32_16x16x32_bf16 v[196:199], v[220:223], v[84:87], v[196:199]
  ds_read_b128 v[216:219], v70 offset:1024
  v_cvt_pk_bf16_f32 v248, v184, v185
  v_mfma_f32_16x16x32_bf16 v[200:203], v[220:223], v[88:91], v[200:203]
  s_add_u32 m0, s81, 31744
  s_nop 0
  buffer_load_dwordx4 v55, s[12:15], s80 offen lds
  v_mfma_f32_16x16x32_bf16 v[204:207], v[220:223], v[92:95], v[204:207]
  v_cvt_pk_bf16_f32 v249, v186, v187
  s_waitcnt lgkmcnt(2)
  v_mfma_f32_16x16x32_bf16 v[196:199], v[208:211], v[96:99], v[196:199]
  ds_read_b128 v[220:223], v71 offset:1024
  v_cvt_pk_bf16_f32 v250, v188, v189
  v_mfma_f32_16x16x32_bf16 v[200:203], v[208:211], v[100:103], v[200:203]
  s_add_u32 m0, s81, 32768
  s_nop 0
  buffer_load_dwordx4 v56, s[12:15], s80 offen lds
  v_mfma_f32_16x16x32_bf16 v[204:207], v[208:211], v[104:107], v[204:207]
  v_cvt_pk_bf16_f32 v251, v190, v191
  s_waitcnt lgkmcnt(2)
  v_mfma_f32_16x16x32_bf16 v[196:199], v[212:215], v[108:111], v[196:199]
  v_accvgpr_write_b32 a64, v248
  v_mfma_f32_16x16x32_bf16 v[200:203], v[212:215], v[112:115], v[200:203]
  s_add_u32 m0, s81, 33792
  s_nop 0
  buffer_load_dwordx4 v57, s[12:15], s80 offen lds
  v_mfma_f32_16x16x32_bf16 v[204:207], v[212:215], v[116:119], v[204:207]
  v_accvgpr_write_b32 a65, v249
  s_waitcnt lgkmcnt(1)
  v_mfma_f32_16x16x32_bf16 v[196:199], v[216:219], v[120:123], v[196:199]
  v_accvgpr_write_b32 a144, v250
  v_mfma_f32_16x16x32_bf16 v[200:203], v[216:219], v[124:127], v[200:203]
  s_add_u32 m0, s81, 34816
  s_nop 0
  buffer_load_dwordx4 v58, s[12:15], s80 offen lds
  v_mfma_f32_16x16x32_bf16 v[204:207], v[216:219], v[128:131], v[204:207]
  v_accvgpr_write_b32 a145, v251
  s_waitcnt lgkmcnt(0)
  v_mfma_f32_16x16x32_bf16 v[196:199], v[220:223], v[132:135], v[196:199]
  v_cvt_pk_bf16_f32 v176, v192, v193
  v_cvt_pk_bf16_f32 v177, v194, v195
  v_mfma_f32_16x16x32_bf16 v[200:203], v[220:223], v[136:139], v[200:203]
  s_add_u32 m0, s81, 35840
  s_nop 0
  buffer_load_dwordx4 v59, s[12:15], s80 offen lds
  s_add_u32 s80, s80, 393216
  v_mfma_f32_16x16x32_bf16 v[204:207], v[220:223], v[140:143], v[204:207]
  s_waitcnt vmcnt(13)
  ds_read_b128 v[208:211], v70 offset:12288
  ds_read_b128 v[212:215], v71 offset:12288
  ds_read_b128 v[216:219], v70 offset:12416
  s_waitcnt lgkmcnt(2)
  v_mfma_f32_16x16x32_bf16 v[184:187], v[208:211], v[72:75], 0
  ds_read_b128 v[220:223], v71 offset:12416
  v_mfma_f32_16x16x32_bf16 v[188:191], v[208:211], v[76:79], 0
  s_add_u32 m0, s81, 0
  s_nop 0
  buffer_load_dwordx4 v48, s[12:15], s80 offen lds
  v_mfma_f32_16x16x32_bf16 v[192:195], v[208:211], v[80:83], 0
  s_waitcnt lgkmcnt(2)
  v_mfma_f32_16x16x32_bf16 v[184:187], v[212:215], v[84:87], v[184:187]
  ds_read_b128 v[208:211], v70 offset:12544
  v_cvt_pk_bf16_f32 v248, v196, v197
  v_mfma_f32_16x16x32_bf16 v[188:191], v[212:215], v[88:91], v[188:191]
  s_add_u32 m0, s81, 1024
  s_nop 0
  buffer_load_dwordx4 v49, s[12:15], s80 offen lds
  v_mfma_f32_16x16x32_bf16 v[192:195], v[212:215], v[92:95], v[192:195]
  v_cvt_pk_bf16_f32 v249, v198, v199
  s_waitcnt lgkmcnt(2)
  v_mfma_f32_16x16x32_bf16 v[184:187], v[216:219], v[96:99], v[184:187]
  ds_read_b128 v[212:215], v71 offset:12544
  v_cvt_pk_bf16_f32 v250, v200, v201
  v_mfma_f32_16x16x32_bf16 v[188:191], v[216:219], v[100:103], v[188:191]
  s_add_u32 m0, s81, 2048
  s_nop 0
  buffer_load_dwordx4 v50, s[12:15], s80 offen lds
  v_mfma_f32_16x16x32_bf16 v[192:195], v[216:219], v[104:107], v[192:195]
  v_cvt_pk_bf16_f32 v251, v202, v203
  s_waitcnt lgkmcnt(2)
  v_mfma_f32_16x16x32_bf16 v[184:187], v[220:223], v[108:111], v[184:187]
  ds_read_b128 v[216:219], v70 offset:13056
  v_accvgpr_write_b32 a66, v248
  v_mfma_f32_16x16x32_bf16 v[188:191], v[220:223], v[112:115], v[188:191]
  s_add_u32 m0, s81, 3072
  s_nop 0
  buffer_load_dwordx4 v51, s[12:15], s80 offen lds
  v_mfma_f32_16x16x32_bf16 v[192:195], v[220:223], v[116:119], v[192:195]
  v_accvgpr_write_b32 a67, v249
  s_waitcnt lgkmcnt(2)
  v_mfma_f32_16x16x32_bf16 v[184:187], v[208:211], v[120:123], v[184:187]
  ds_read_b128 v[220:223], v71 offset:13056
  v_accvgpr_write_b32 a146, v250
  v_mfma_f32_16x16x32_bf16 v[188:191], v[208:211], v[124:127], v[188:191]
  s_add_u32 m0, s81, 4096
  s_nop 0
  buffer_load_dwordx4 v52, s[12:15], s80 offen lds
  v_mfma_f32_16x16x32_bf16 v[192:195], v[208:211], v[128:131], v[192:195]
  v_accvgpr_write_b32 a147, v251
  s_waitcnt lgkmcnt(2)
  v_mfma_f32_16x16x32_bf16 v[184:187], v[212:215], v[132:135], v[184:187]
  ds_read_b128 v[208:211], v70 offset:13184
  s_mov_b64 exec, s[68:69]
  v_cvt_pk_bf16_f32 v176, v204, v205
  v_cvt_pk_bf16_f32 v177, v206, v207
  s_mov_b64 exec, -1
  v_mfma_f32_16x16x32_bf16 v[188:191], v[212:215], v[136:139], v[188:191]
  s_add_u32 m0, s81, 5120
  s_nop 0
  buffer_load_dwordx4 v53, s[12:15], s80 offen lds
  v_mfma_f32_16x16x32_bf16 v[192:195], v[212:215], v[140:143], v[192:195]
  s_waitcnt lgkmcnt(2)
  v_mfma_f32_16x16x32_bf16 v[196:199], v[216:219], v[72:75], 0
  ds_read_b128 v[212:215], v71 offset:13184
  v_mfma_f32_16x16x32_bf16 v[200:203], v[216:219], v[76:79], 0
  s_add_u32 m0, s81, 6144
  s_nop 0
  buffer_load_dwordx4 v54, s[12:15], s80 offen lds
  v_mfma_f32_16x16x32_bf16 v[204:207], v[216:219], v[80:83], 0
  s_waitcnt lgkmcnt(2)
  v_mfma_f32_16x16x32_bf16 v[196:199], v[220:223], v[84:87], v[196:199]
  ds_read_b128 v[216:219], v70 offset:13312
  v_cvt_pk_bf16_f32 v248, v184, v185
  v_mfma_f32_16x16x32_bf16 v[200:203], v[220:223], v[88:91], v[200:203]
  s_add_u32 m0, s81, 7168
  s_nop 0
  buffer_load_dwordx4 v55, s[12:15], s80 offen lds
  v_mfma_f32_16x16x32_bf16 v[204:207], v[220:223], v[92:95], v[204:207]
  v_cvt_pk_bf16_f32 v249, v186, v187
  s_waitcnt lgkmcnt(2)
  v_mfma_f32_16x16x32_bf16 v[196:199], v[208:211], v[96:99], v[196:199]
  ds_read_b128 v[220:223], v71 offset:13312
  v_cvt_pk_bf16_f32 v250, v188, v189
  v_mfma_f32_16x16x32_bf16 v[200:203], v[208:211], v[100:103], v[200:203]
  s_add_u32 m0, s81, 8192
  s_nop 0
  buffer_load_dwordx4 v56, s[12:15], s80 offen lds
  v_mfma_f32_16x16x32_bf16 v[204:207], v[208:211], v[104:107], v[204:207]
  v_cvt_pk_bf16_f32 v251, v190, v191
  s_waitcnt lgkmcnt(2)
  v_mfma_f32_16x16x32_bf16 v[196:199], v[212:215], v[108:111], v[196:199]
  v_accvgpr_write_b32 a68, v248
  v_mfma_f32_16x16x32_bf16 v[200:203], v[212:215], v[112:115], v[200:203]
  s_add_u32 m0, s81, 9216
  s_nop 0
  buffer_load_dwordx4 v57, s[12:15], s80 offen lds
  v_mfma_f32_16x16x32_bf16 v[204:207], v[212:215], v[116:119], v[204:207]
  v_accvgpr_write_b32 a69, v249
  s_waitcnt lgkmcnt(1)
  v_mfma_f32_16x16x32_bf16 v[196:199], v[216:219], v[120:123], v[196:199]
  v_accvgpr_write_b32 a148, v250
  v_mfma_f32_16x16x32_bf16 v[200:203], v[216:219], v[124:127], v[200:203]
  s_add_u32 m0, s81, 10240
  s_nop 0
  buffer_load_dwordx4 v58, s[12:15], s80 offen lds
  v_mfma_f32_16x16x32_bf16 v[204:207], v[216:219], v[128:131], v[204:207]
  v_accvgpr_write_b32 a149, v251
  s_waitcnt lgkmcnt(0)
  v_mfma_f32_16x16x32_bf16 v[196:199], v[220:223], v[132:135], v[196:199]
  v_cvt_pk_bf16_f32 v178, v192, v193
  v_cvt_pk_bf16_f32 v179, v194, v195
  v_mfma_f32_16x16x32_bf16 v[200:203], v[220:223], v[136:139], v[200:203]
  s_add_u32 m0, s81, 11264
  s_nop 0
  buffer_load_dwordx4 v59, s[12:15], s80 offen lds
  s_add_u32 s80, s80, 393216
  v_mfma_f32_16x16x32_bf16 v[204:207], v[220:223], v[140:143], v[204:207]
  s_waitcnt vmcnt(12)
  v_readlane_b32 s83, v66, 19
  s_sub_u32 s21, s83, 1
  s_lshl_b32 s21, s21, 13
  s_and_b32 s21, s21, 8192
  s_xor_b32 s76, s90, s21
  buffer_load_dword v66, v67, s[32:35], 0 offen sc1
  buffer_load_dword v42, v41, s[16:19], s76 offen sc1
  ds_read_b128 v[208:211], v70 offset:24576
  ds_read_b128 v[212:215], v71 offset:24576
  ds_read_b128 v[216:219], v70 offset:24704
  s_waitcnt lgkmcnt(2)
  v_mfma_f32_16x16x32_bf16 v[184:187], v[208:211], v[72:75], 0
  ds_read_b128 v[220:223], v71 offset:24704
  v_mfma_f32_16x16x32_bf16 v[188:191], v[208:211], v[76:79], 0
  ds_write_b128 v68, a[160:163] offset:12288
  v_mfma_f32_16x16x32_bf16 v[192:195], v[208:211], v[80:83], 0
  s_waitcnt lgkmcnt(3)
  v_mfma_f32_16x16x32_bf16 v[184:187], v[212:215], v[84:87], v[184:187]
  ds_read_b128 v[208:211], v70 offset:24832
  v_cvt_pk_bf16_f32 v248, v196, v197
  v_mfma_f32_16x16x32_bf16 v[188:191], v[212:215], v[88:91], v[188:191]
  ds_write_b128 v68, a[164:167] offset:13312
  v_mfma_f32_16x16x32_bf16 v[192:195], v[212:215], v[92:95], v[192:195]
  v_cvt_pk_bf16_f32 v249, v198, v199
  s_waitcnt lgkmcnt(4)
  v_mfma_f32_16x16x32_bf16 v[184:187], v[216:219], v[96:99], v[184:187]
  ds_read_b128 v[212:215], v71 offset:24832
  v_cvt_pk_bf16_f32 v250, v200, v201
  v_mfma_f32_16x16x32_bf16 v[188:191], v[216:219], v[100:103], v[188:191]
  ds_write_b128 v68, a[168:171] offset:14336
  v_mfma_f32_16x16x32_bf16 v[192:195], v[216:219], v[104:107], v[192:195]
  v_cvt_pk_bf16_f32 v251, v202, v203
  s_waitcnt lgkmcnt(5)
  v_mfma_f32_16x16x32_bf16 v[184:187], v[220:223], v[108:111], v[184:187]
  ds_read_b128 v[216:219], v70 offset:25344
  v_accvgpr_write_b32 a70, v248
  v_mfma_f32_16x16x32_bf16 v[188:191], v[220:223], v[112:115], v[188:191]
  ds_write_b128 v68, a[172:175] offset:15360
  v_mfma_f32_16x16x32_bf16 v[192:195], v[220:223], v[116:119], v[192:195]
  v_accvgpr_write_b32 a71, v249
  s_waitcnt lgkmcnt(5)
  v_mfma_f32_16x16x32_bf16 v[184:187], v[208:211], v[120:123], v[184:187]
  ds_read_b128 v[220:223], v71 offset:25344
  v_accvgpr_write_b32 a150, v250
  v_mfma_f32_16x16x32_bf16 v[188:191], v[208:211], v[124:127], v[188:191]
  ds_write_b128 v68, a[176:179] offset:16384
  v_mfma_f32_16x16x32_bf16 v[192:195], v[208:211], v[128:131], v[192:195]
  v_accvgpr_write_b32 a151, v251
  s_waitcnt lgkmcnt(5)
  v_mfma_f32_16x16x32_bf16 v[184:187], v[212:215], v[132:135], v[184:187]
  ds_read_b128 v[208:211], v70 offset:25472
  s_mov_b64 exec, s[68:69]
  v_cvt_pk_bf16_f32 v178, v204, v205
  v_cvt_pk_bf16_f32 v179, v206, v207
  s_mov_b64 exec, -1
  v_mfma_f32_16x16x32_bf16 v[188:191], v[212:215], v[136:139], v[188:191]
  ds_write_b128 v68, a[180:183] offset:17408
  v_mfma_f32_16x16x32_bf16 v[192:195], v[212:215], v[140:143], v[192:195]
  s_waitcnt lgkmcnt(5)
  v_mfma_f32_16x16x32_bf16 v[196:199], v[216:219], v[72:75], 0
  ds_read_b128 v[212:215], v71 offset:25472
  v_mfma_f32_16x16x32_bf16 v[200:203], v[216:219], v[76:79], 0
  ds_write_b128 v68, a[184:187] offset:18432
  v_mfma_f32_16x16x32_bf16 v[204:207], v[216:219], v[80:83], 0
  s_waitcnt lgkmcnt(5)
  v_mfma_f32_16x16x32_bf16 v[196:199], v[220:223], v[84:87], v[196:199]
  ds_read_b128 v[216:219], v70 offset:25600
  v_cvt_pk_bf16_f32 v248, v184, v185
  v_mfma_f32_16x16x32_bf16 v[200:203], v[220:223], v[88:91], v[200:203]
  ds_write_b128 v68, a[188:191] offset:19456
  v_mfma_f32_16x16x32_bf16 v[204:207], v[220:223], v[92:95], v[204:207]
  v_cvt_pk_bf16_f32 v249, v186, v187
  s_waitcnt lgkmcnt(5)
  v_mfma_f32_16x16x32_bf16 v[196:199], v[208:211], v[96:99], v[196:199]
  ds_read_b128 v[220:223], v71 offset:25600
  v_cvt_pk_bf16_f32 v250, v188, v189
  v_mfma_f32_16x16x32_bf16 v[200:203], v[208:211], v[100:103], v[200:203]
  ds_write_b128 v68, a[192:195] offset:20480
  v_mfma_f32_16x16x32_bf16 v[204:207], v[208:211], v[104:107], v[204:207]
  v_cvt_pk_bf16_f32 v251, v190, v191
  s_waitcnt lgkmcnt(5)
  v_mfma_f32_16x16x32_bf16 v[196:199], v[212:215], v[108:111], v[196:199]
  v_accvgpr_write_b32 a72, v248
  v_mfma_f32_16x16x32_bf16 v[200:203], v[212:215], v[112:115], v[200:203]
  ds_write_b128 v68, a[196:199] offset:21504
  v_mfma_f32_16x16x32_bf16 v[204:207], v[212:215], v[116:119], v[204:207]
  v_accvgpr_write_b32 a73, v249
  s_waitcnt lgkmcnt(4)
  v_mfma_f32_16x16x32_bf16 v[196:199], v[216:219], v[120:123], v[196:199]
  v_accvgpr_write_b32 a152, v250
  v_mfma_f32_16x16x32_bf16 v[200:203], v[216:219], v[124:127], v[200:203]
  ds_write_b128 v68, a[200:203] offset:22528
  v_mfma_f32_16x16x32_bf16 v[204:207], v[216:219], v[128:131], v[204:207]
  v_accvgpr_write_b32 a153, v251
  s_waitcnt lgkmcnt(3)
  v_mfma_f32_16x16x32_bf16 v[196:199], v[220:223], v[132:135], v[196:199]
  v_cvt_pk_bf16_f32 v180, v192, v193
  v_cvt_pk_bf16_f32 v181, v194, v195
  v_mfma_f32_16x16x32_bf16 v[200:203], v[220:223], v[136:139], v[200:203]
  ds_write_b128 v68, a[204:207] offset:23552
  v_mfma_f32_16x16x32_bf16 v[204:207], v[220:223], v[140:143], v[204:207]
  s_waitcnt vmcnt(2)
  ds_read_b128 v[208:211], v70 offset:0
  ds_read_b128 v[212:215], v71 offset:0
  ds_read_b128 v[216:219], v70 offset:128
  s_waitcnt lgkmcnt(2)
  v_mfma_f32_16x16x32_bf16 v[184:187], v[208:211], v[72:75], 0
  ds_read_b128 v[220:223], v71 offset:128
  v_mfma_f32_16x16x32_bf16 v[188:191], v[208:211], v[76:79], 0
  ds_write_b128 v68, a[208:211] offset:24576
  v_mfma_f32_16x16x32_bf16 v[192:195], v[208:211], v[80:83], 0
  s_waitcnt lgkmcnt(3)
  v_mfma_f32_16x16x32_bf16 v[184:187], v[212:215], v[84:87], v[184:187]
  ds_read_b128 v[208:211], v70 offset:256
  v_cvt_pk_bf16_f32 v248, v196, v197
  v_mfma_f32_16x16x32_bf16 v[188:191], v[212:215], v[88:91], v[188:191]
  ds_write_b128 v68, a[212:215] offset:25600
  v_mfma_f32_16x16x32_bf16 v[192:195], v[212:215], v[92:95], v[192:195]
  v_cvt_pk_bf16_f32 v249, v198, v199
  s_waitcnt lgkmcnt(4)
  v_mfma_f32_16x16x32_bf16 v[184:187], v[216:219], v[96:99], v[184:187]
  ds_read_b128 v[212:215], v71 offset:256
  v_cvt_pk_bf16_f32 v250, v200, v201
  v_mfma_f32_16x16x32_bf16 v[188:191], v[216:219], v[100:103], v[188:191]
  ds_write_b128 v68, a[216:219] offset:26624
  v_mfma_f32_16x16x32_bf16 v[192:195], v[216:219], v[104:107], v[192:195]
  v_cvt_pk_bf16_f32 v251, v202, v203
  s_waitcnt lgkmcnt(5)
  v_mfma_f32_16x16x32_bf16 v[184:187], v[220:223], v[108:111], v[184:187]
  ds_read_b128 v[216:219], v70 offset:768
  v_accvgpr_write_b32 a74, v248
  v_mfma_f32_16x16x32_bf16 v[188:191], v[220:223], v[112:115], v[188:191]
  ds_write_b128 v68, a[220:223] offset:27648
  v_mfma_f32_16x16x32_bf16 v[192:195], v[220:223], v[116:119], v[192:195]
  v_accvgpr_write_b32 a75, v249
  s_waitcnt lgkmcnt(5)
  v_mfma_f32_16x16x32_bf16 v[184:187], v[208:211], v[120:123], v[184:187]
  ds_read_b128 v[220:223], v71 offset:768
  v_accvgpr_write_b32 a154, v250
  v_mfma_f32_16x16x32_bf16 v[188:191], v[208:211], v[124:127], v[188:191]
  ds_write_b128 v68, a[224:227] offset:28672
  v_mfma_f32_16x16x32_bf16 v[192:195], v[208:211], v[128:131], v[192:195]
  v_accvgpr_write_b32 a155, v251
  s_waitcnt lgkmcnt(5)
  v_mfma_f32_16x16x32_bf16 v[184:187], v[212:215], v[132:135], v[184:187]
  ds_read_b128 v[208:211], v70 offset:896
  s_mov_b64 exec, s[68:69]
  v_cvt_pk_bf16_f32 v180, v204, v205
  v_cvt_pk_bf16_f32 v181, v206, v207
  s_mov_b64 exec, -1
  v_mfma_f32_16x16x32_bf16 v[188:191], v[212:215], v[136:139], v[188:191]
  ds_write_b128 v68, a[228:231] offset:29696
  v_mfma_f32_16x16x32_bf16 v[192:195], v[212:215], v[140:143], v[192:195]
  s_waitcnt lgkmcnt(5)
  v_mfma_f32_16x16x32_bf16 v[196:199], v[216:219], v[72:75], 0
  ds_read_b128 v[212:215], v71 offset:896
  v_mfma_f32_16x16x32_bf16 v[200:203], v[216:219], v[76:79], 0
  ds_write_b128 v68, a[232:235] offset:30720
  v_mfma_f32_16x16x32_bf16 v[204:207], v[216:219], v[80:83], 0
  s_waitcnt lgkmcnt(5)
  v_mfma_f32_16x16x32_bf16 v[196:199], v[220:223], v[84:87], v[196:199]
  ds_read_b128 v[216:219], v70 offset:1024
  v_cvt_pk_bf16_f32 v248, v184, v185
  v_mfma_f32_16x16x32_bf16 v[200:203], v[220:223], v[88:91], v[200:203]
  ds_write_b128 v68, a[236:239] offset:31744
  v_mfma_f32_16x16x32_bf16 v[204:207], v[220:223], v[92:95], v[204:207]
  v_cvt_pk_bf16_f32 v249, v186, v187
  s_waitcnt lgkmcnt(5)
  v_mfma_f32_16x16x32_bf16 v[196:199], v[208:211], v[96:99], v[196:199]
  ds_read_b128 v[220:223], v71 offset:1024
  v_cvt_pk_bf16_f32 v250, v188, v189
  v_mfma_f32_16x16x32_bf16 v[200:203], v[208:211], v[100:103], v[200:203]
  ds_write_b128 v68, a[240:243] offset:32768
  v_mfma_f32_16x16x32_bf16 v[204:207], v[208:211], v[104:107], v[204:207]
  v_cvt_pk_bf16_f32 v251, v190, v191
  s_waitcnt lgkmcnt(5)
  v_mfma_f32_16x16x32_bf16 v[196:199], v[212:215], v[108:111], v[196:199]
  v_accvgpr_write_b32 a76, v248
  v_mfma_f32_16x16x32_bf16 v[200:203], v[212:215], v[112:115], v[200:203]
  ds_write_b128 v68, a[244:247] offset:33792
  v_mfma_f32_16x16x32_bf16 v[204:207], v[212:215], v[116:119], v[204:207]
  v_accvgpr_write_b32 a77, v249
  s_waitcnt lgkmcnt(4)
  v_mfma_f32_16x16x32_bf16 v[196:199], v[216:219], v[120:123], v[196:199]
  v_accvgpr_write_b32 a156, v250
  v_mfma_f32_16x16x32_bf16 v[200:203], v[216:219], v[124:127], v[200:203]
  ds_write_b128 v68, a[248:251] offset:34816
  v_mfma_f32_16x16x32_bf16 v[204:207], v[216:219], v[128:131], v[204:207]
  v_accvgpr_write_b32 a157, v251
  s_waitcnt lgkmcnt(3)
  v_mfma_f32_16x16x32_bf16 v[196:199], v[220:223], v[132:135], v[196:199]
  v_cvt_pk_bf16_f32 v182, v192, v193
  v_cvt_pk_bf16_f32 v183, v194, v195
  v_mfma_f32_16x16x32_bf16 v[200:203], v[220:223], v[136:139], v[200:203]
  ds_write_b128 v68, a[252:255] offset:35840
  v_mfma_f32_16x16x32_bf16 v[204:207], v[220:223], v[140:143], v[204:207]
  s_nop 7
  v_cvt_pk_bf16_f32 v248, v196, v197
  v_cvt_pk_bf16_f32 v249, v198, v199
  v_cvt_pk_bf16_f32 v250, v200, v201
  v_cvt_pk_bf16_f32 v251, v202, v203
  v_accvgpr_write_b32 a78, v248
  v_accvgpr_write_b32 a79, v249
  v_accvgpr_write_b32 a158, v250
  v_accvgpr_write_b32 a159, v251
  s_mov_b64 exec, s[68:69]
  v_cvt_pk_bf16_f32 v182, v204, v205
  v_cvt_pk_bf16_f32 v183, v206, v207
  s_mov_b64 exec, -1
  ds_write_b128 v68, v[224:227] offset:0
  ds_write_b128 v68, v[228:231] offset:1024
  ds_write_b128 v68, v[232:235] offset:2048
  ds_write_b128 v68, v[236:239] offset:3072
  ds_write_b128 v68, v[240:243] offset:4096
  ds_write_b128 v68, v[244:247] offset:5120
  ds_write_b64 v69, v[160:161] offset:6144
  ds_write_b64 v69, v[162:163] offset:6656
  ds_write_b64 v69, v[164:165] offset:7168
  ds_write_b64 v69, v[166:167] offset:7680
  ds_write_b64 v69, v[168:169] offset:8192
  ds_write_b64 v69, v[170:171] offset:8704
  ds_write_b64 v69, v[172:173] offset:9216
  ds_write_b64 v69, v[174:175] offset:9728
  ds_write_b64 v69, v[176:177] offset:10240
  ds_write_b64 v69, v[178:179] offset:10752
  ds_write_b64 v69, v[180:181] offset:11264
  ds_write_b64 v69, v[182:183] offset:11776
  v_lshrrev_b32 v100, 1, v3
  v_lshlrev_b32 v100, 4, v100
  v_and_b32 v101, 8, v2
  v_add_u32 v100, v100, v101
  v_and_b32 v101, 1, v3
  v_lshl_add_u32 v100, v101, 2, v100
  v_bfe_u32 v101, v2, 2, 1
  v_add_u32 v100, v100, v101
  v_mul_u32_u24 v100, 96, v100
  v_and_b32 v101, 3, v2
  v_lshl_add_u32 v100, v101, 3, v100
  s_lshl_b32 s21, s20, 5
  v_add_u32 v100, s21, v100
  v_add_u32 v101, 3072, v100
  v_cndmask_b32 v88, v100, v101, s[68:69]
  v_cndmask_b32 v92, v101, v100, s[68:69]
  v_add_u32 v89, 40960, v88
  v_add_u32 v93, 40960, v92
  v_add_u32 v90, 81920, v88
  v_add_u32 v94, 81920, v92
  v_add_u32 v91, 122880, v88
  v_add_u32 v95, 122880, v92
  v_and_b32 v100, 7, v2
  v_lshl_add_u32 v100, v3, 3, v100
  v_lshrrev_b32 v101, 3, v2
  v_mul_u32_u24 v101, 40960, v101
  v_lshl_add_u32 v96, v100, 4, v101
  v_add_u32 v97, 81920, v96
  s_bfe_u32 s82, s50, 0x10001
  s_lshl_b32 s82, s82, 5
  s_lshr_b32 s21, s50, 2
  s_add_u32 s82, s82, s21
  s_mov_b32 s101, 0
  s_branch fm_13
fm_12:
  s_sleep 8
fm_14:
  buffer_load_dword v66, v67, s[32:35], 0 offen sc1
  buffer_load_dword v42, v41, s[16:19], s76 offen sc1
  s_add_u32 s101, s101, 1
  s_cmp_gt_u32 s101, 131072
  s_cbranch_scc1 end0
fm_13:
  s_waitcnt vmcnt(0)
  s_mov_b32 s84, s83
  v_readlane_b32 s83, v66, 19
  s_sub_u32 s21, s83, 1
  s_lshl_b32 s21, s21, 13
  s_and_b32 s21, s21, 8192
  s_xor_b32 s76, s90, s21
  s_cmp_eq_u32 s83, 0
  s_cbranch_scc1 fm_12
  s_cmp_eq_u32 s84, 0
  s_cbranch_scc1 fm_14
  v_readlane_b32 s22, v66, 0
  v_readlane_b32 s23, v66, 32
  s_add_u32 s22, s22, s23
  v_readlane_b32 s23, v66, 1
  s_add_u32 s22, s22, s23
  v_readlane_b32 s23, v66, 33
  s_add_u32 s22, s22, s23
  v_readlane_b32 s23, v66, 2
  s_add_u32 s22, s22, s23
  v_readlane_b32 s23, v66, 34
  s_add_u32 s22, s22, s23
  v_readlane_b32 s23, v66, 3
  s_add_u32 s22, s22, s23
  v_readlane_b32 s23, v66, 35
  s_add_u32 s22, s22, s23
  v_readlane_b32 s21, v66, 16
  v_cmp_gt_u32 vcc, 2, v42
  s_cmp_lt_u32 s22, 256
  s_cbranch_scc1 fm_12
  s_cmp_lt_u32 s21, 128
  s_cbranch_scc1 fm_12
  s_cbranch_vccnz fm_12
  v_readlane_b32 s21, v66, s82
  v_cmp_ne_u32 vcc, 32, v66
  s_cmp_ge_u32 s21, 32
  s_cselect_b32 s84, 1, 0
  s_andn2_b32 s53, s84, s53
  s_and_b32 s21, vcc_lo, 15
  s_and_b32 s22, vcc_hi, 15
  s_or_b32 s85, s21, s22
  s_xor_b32 s83, s76, s90
  s_lshl_b32 s70, s50, 4
  s_add_u32 s79, s70, s55
  s_add_u32 s70, s70, s51
  s_lshl_b32 s70, s70, 14
  s_lshl_b32 s79, s79, 14
  s_lshl_b32 s21, s56, 11
  s_add_u32 s79, s79, s21
  s_lshl_b32 s72, s50, 16
  s_lshl_b32 s21, s60, 10
  s_add_u32 s72, s72, s21
  s_add_u32 s72, s72, 134217728
  s_mov_b32 s74, 32768
  s_add_u32 s73, s70, s83
  s_add_u32 s70, s73, 4096
  s_add_u32 s72, s72, s83
  s_xor_b32 s21, s83, 8192
  s_add_u32 s79, s79, s21
  s_add_u32 s12, s48, 168886272
  s_addc_u32 s13, s49, 0
  s_mov_b32 s14, 49152
  s_mov_b32 s15, 0x00020000
  s_mov_b32 s16, s48
  s_mov_b32 s17, s49
  s_mov_b32 s18, 167772160
  s_mov_b32 s19, 0x00020000
  s_waitcnt lgkmcnt(0)
  s_lshl_b32 s21, s20, 16
  s_add_u32 s21, s21, s79
  buffer_load_dwordx4 v[144:147], v4, s[16:19], s21 offen sc1
  buffer_load_dwordx4 v[148:151], v4, s[16:19], s21 offen offset:1024 sc1
  v_subrev_u32 v100, 43008, v20
  v_subrev_u32 v101, 43008, v21
  buffer_load_dwordx4 v[112:115], v100, s[16:19], s73 offen sc1
  buffer_load_dwordx2 v[116:117], v101, s[16:19], s73 offen sc1
  v_and_b32 v100, 127, v19
  v_lshl_add_u32 v100, v3, 8, v100
  v_and_b32 v101, 2, v2
  v_cmp_eq_u32 vcc, 0, v101
  s_lshl_b32 s21, s20, 14
  s_lshl_b32 s22, s61, 7
  s_add_u32 s21, s21, s22
  s_add_u32 s21, s21, s72
  v_mov_b32 v152, 0x3f803f80
  v_mov_b32 v153, 0x3f803f80
  v_mov_b32 v154, 0x3f803f80
  v_mov_b32 v155, 0x3f803f80
  s_mov_b64 exec, vcc
  buffer_load_dwordx4 v[152:155], v100, s[16:19], s21 offen sc1
  s_mov_b64 exec, -1
  v_and_b32 v100, 7, v1
  v_mul_u32_u24 v100, 1280, v100
  v_lshrrev_b32 v101, 3, v1
  v_lshl_add_u32 v100, v101, 4, v100
  buffer_load_dwordx4 v[48:51], v100, s[36:39], 0 offen offset:0
  buffer_load_dwordx4 v[52:55], v100, s[36:39], 0 offen offset:128
  buffer_load_dwordx4 v[56:59], v100, s[36:39], 0 offen offset:256
  buffer_load_dwordx4 v[60:63], v100, s[36:39], 0 offen offset:384
  buffer_load_dwordx4 v[64:67], v100, s[36:39], 0 offen offset:512
  buffer_load_dwordx4 v[68:71], v100, s[36:39], 0 offen offset:640
  buffer_load_dwordx4 v[72:75], v100, s[36:39], 0 offen offset:768
  buffer_load_dwordx4 v[76:79], v100, s[36:39], 0 offen offset:896
  buffer_load_dwordx4 v[80:83], v100, s[36:39], 0 offen offset:1024
  buffer_load_dwordx4 v[84:87], v100, s[36:39], 0 offen offset:1152
  s_barrier
  s_cmp_eq_u32 s20, 3
  s_cbranch_scc1 w3_16
  ds_read_b64_tr_b16 a[160:161], v88 offset:12288
  ds_read_b64_tr_b16 a[162:163], v88 offset:12480
  ds_read_b64_tr_b16 a[164:165], v88 offset:18432
  ds_read_b64_tr_b16 a[166:167], v88 offset:18624
  ds_read_b64_tr_b16 a[168:169], v88 offset:24576
  ds_read_b64_tr_b16 a[170:171], v88 offset:24768
  ds_read_b64_tr_b16 a[172:173], v88 offset:30720
  ds_read_b64_tr_b16 a[174:175], v88 offset:30912
  ds_read_b64_tr_b16 a[176:177], v88 offset:0
  ds_read_b64_tr_b16 a[178:179], v88 offset:192
  ds_read_b64_tr_b16 a[180:181], v89 offset:12288
  ds_read_b64_tr_b16 a[182:183], v89 offset:12480
  ds_read_b64_tr_b16 a[184:185], v89 offset:18432
  ds_read_b64_tr_b16 a[186:187], v89 offset:18624
  ds_read_b64_tr_b16 a[188:189], v89 offset:24576
  ds_read_b64_tr_b16 a[190:191], v89 offset:24768
  ds_read_b64_tr_b16 a[192:193], v89 offset:30720
  ds_read_b64_tr_b16 a[194:195], v89 offset:30912
  ds_read_b64_tr_b16 a[196:197], v89 offset:0
  ds_read_b64_tr_b16 a[198:199], v89 offset:192
  ds_read_b64_tr_b16 a[200:201], v90 offset:12288
  ds_read_b64_tr_b16 a[202:203], v90 offset:12480
  ds_read_b64_tr_b16 a[204:205], v90 offset:18432
  ds_read_b64_tr_b16 a[206:207], v90 offset:18624
  ds_read_b64_tr_b16 a[208:209], v90 offset:24576
  ds_read_b64_tr_b16 a[210:211], v90 offset:24768
  ds_read_b64_tr_b16 a[212:213], v90 offset:30720
  ds_read_b64_tr_b16 a[214:215], v90 offset:30912
  ds_read_b64_tr_b16 a[216:217], v90 offset:0
  ds_read_b64_tr_b16 a[218:219], v90 offset:192
  ds_read_b64_tr_b16 a[220:221], v91 offset:12288
  ds_read_b64_tr_b16 a[222:223], v91 offset:12480
  ds_read_b64_tr_b16 a[224:225], v91 offset:18432
  ds_read_b64_tr_b16 a[226:227], v91 offset:18624
  ds_read_b64_tr_b16 a[228:229], v91 offset:24576
  ds_read_b64_tr_b16 a[230:231], v91 offset:24768
  ds_read_b64_tr_b16 a[232:233], v91 offset:30720
  ds_read_b64_tr_b16 a[234:235], v91 offset:30912
  ds_read_b64_tr_b16 a[236:237], v91 offset:0
  ds_read_b64_tr_b16 a[238:239], v91 offset:192
  ds_read_b64_tr_b16 a[240:241], v92 offset:12288
  ds_read_b64_tr_b16 a[242:243], v92 offset:12480
  ds_read_b64_tr_b16 a[244:245], v92 offset:18432
  ds_read_b64_tr_b16 a[246:247], v92 offset:18624
  ds_read_b64_tr_b16 a[248:249], v92 offset:24576
  ds_read_b64_tr_b16 a[250:251], v92 offset:24768
  ds_read_b64_tr_b16 a[252:253], v92 offset:30720
  ds_read_b64_tr_b16 a[254:255], v92 offset:30912
  ds_read_b64_tr_b16 v[192:193], v92 offset:0
  ds_read_b64_tr_b16 v[194:195], v92 offset:192
  ds_read_b64_tr_b16 v[196:197], v93 offset:12288
  ds_read_b64_tr_b16 v[198:199], v93 offset:12480
  ds_read_b64_tr_b16 v[200:201], v93 offset:18432
  ds_read_b64_tr_b16 v[202:203], v93 offset:18624
  ds_read_b64_tr_b16 v[204:205], v93 offset:24576
  ds_read_b64_tr_b16 v[206:207], v93 offset:24768
  ds_read_b64_tr_b16 v[208:209], v93 offset:30720
  ds_read_b64_tr_b16 v[210:211], v93 offset:30912
  ds_read_b64_tr_b16 v[212:213], v93 offset:0
  ds_read_b64_tr_b16 v[214:215], v93 offset:192
  ds_read_b64_tr_b16 v[216:217], v94 offset:12288
  ds_read_b64_tr_b16 v[218:219], v94 offset:12480
  ds_read_b64_tr_b16 v[220:221], v94 offset:18432
  ds_read_b64_tr_b16 v[222:223], v94 offset:18624
  ds_read_b64_tr_b16 v[224:225], v94 offset:24576
  ds_read_b64_tr_b16 v[226:227], v94 offset:24768
  ds_read_b64_tr_b16 v[228:229], v94 offset:30720
  ds_read_b64_tr_b16 v[230:231], v94 offset:30912
  ds_read_b64_tr_b16 v[232:233], v94 offset:0
  ds_read_b64_tr_b16 v[234:235], v94 offset:192
  ds_read_b64_tr_b16 v[236:237], v95 offset:12288
  ds_read_b64_tr_b16 v[238:239], v95 offset:12480
  ds_read_b64_tr_b16 v[240:241], v95 offset:18432
  ds_read_b64_tr_b16 v[242:243], v95 offset:18624
  ds_read_b64_tr_b16 v[244:245], v95 offset:24576
  ds_read_b64_tr_b16 v[246:247], v95 offset:24768
  ds_read_b64_tr_b16 v[248:249], v95 offset:30720
  ds_read_b64_tr_b16 v[250:251], v95 offset:30912
  ds_read_b64_tr_b16 v[252:253], v95 offset:0
  ds_read_b64_tr_b16 v[254:255], v95 offset:192
  s_branch w3_17
w3_16:
  ds_read_b128 a[160:163], v96 offset:36864
  ds_read_b128 a[164:167], v96 offset:37376
  ds_read_b128 a[168:171], v96 offset:37888
  ds_read_b128 a[172:175], v96 offset:38400
  ds_read_b128 a[176:179], v96 offset:38912
  ds_read_b128 a[180:183], v96 offset:39424
  ds_read_b128 a[184:187], v96 offset:39936
  ds_read_b128 a[188:191], v96 offset:40448
  ds_read_b128 a[192:195], v96 offset:6144
  ds_read_b128 a[196:199], v96 offset:6656
  ds_read_b128 a[200:203], v96 offset:7168
  ds_read_b128 a[204:207], v96 offset:7680
  ds_read_b128 a[208:211], v96 offset:8192
  ds_read_b128 a[212:215], v96 offset:8704
  ds_read_b128 a[216:219], v96 offset:9216
  ds_read_b128 a[220:223], v96 offset:9728
  ds_read_b128 a[224:227], v96 offset:10240
  ds_read_b128 a[228:231], v96 offset:10752
  ds_read_b128 a[232:235], v96 offset:11264
  ds_read_b128 a[236:239], v96 offset:11776
  ds_read_b128 a[240:243], v97 offset:36864
  ds_read_b128 a[244:247], v97 offset:37376
  ds_read_b128 a[248:251], v97 offset:37888
  ds_read_b128 a[252:255], v97 offset:38400
  ds_read_b128 v[192:195], v97 offset:38912
  ds_read_b128 v[196:199], v97 offset:39424
  ds_read_b128 v[200:203], v97 offset:39936
  ds_read_b128 v[204:207], v97 offset:40448
  ds_read_b128 v[208:211], v97 offset:6144
  ds_read_b128 v[212:215], v97 offset:6656
  ds_read_b128 v[216:219], v97 offset:7168
  ds_read_b128 v[220:223], v97 offset:7680
  ds_read_b128 v[224:227], v97 offset:8192
  ds_read_b128 v[228:231], v97 offset:8704
  ds_read_b128 v[232:235], v97 offset:9216
  ds_read_b128 v[236:239], v97 offset:9728
  ds_read_b128 v[240:243], v97 offset:10240
  ds_read_b128 v[244:247], v97 offset:10752
  ds_read_b128 v[248:251], v97 offset:11264
  ds_read_b128 v[252:255], v97 offset:11776
w3_17:
  s_cmp_eq_u32 s85, 0
  s_cbranch_scc1 fm_15
  s_cmp_eq_u32 s20, 3
  s_cbranch_scc1 ar_19
  s_mov_b64 exec, s[64:65]
  s_cmp_eq_u32 s20, 2
  s_cbranch_scc1 ar_18
  s_mov_b32 s21, 0
  buffer_store_dwordx2 v[28:29], v8, s[8:11], s21 offen sc1
  s_mov_b32 s21, 122880
  buffer_store_dwordx2 v[28:29], v8, s[8:11], s21 offen sc1
  s_mov_b32 s21, 245760
  buffer_store_dwordx2 v[28:29], v8, s[8:11], s21 offen sc1
  s_mov_b32 s21, 368640
  buffer_store_dwordx2 v[28:29], v8, s[8:11], s21 offen sc1
  s_branch ar_20
ar_18:
  s_mov_b32 s21, 0
  buffer_store_dword v28, v8, s[8:11], s21 offen sc1
  buffer_store_dword v28, v8, s[8:11], s21 offen offset:128 sc1
  s_mov_b32 s21, 122880
  buffer_store_dword v28, v8, s[8:11], s21 offen sc1
  buffer_store_dword v28, v8, s[8:11], s21 offen offset:128 sc1
  s_mov_b32 s21, 245760
  buffer_store_dword v28, v8, s[8:11], s21 offen sc1
  buffer_store_dword v28, v8, s[8:11], s21 offen offset:128 sc1
  s_mov_b32 s21, 368640
  buffer_store_dword v28, v8, s[8:11], s21 offen sc1
  buffer_store_dword v28, v8, s[8:11], s21 offen offset:128 sc1
ar_20:
  s_cmp_eq_u32 s78, 0
  s_cbranch_scc1 ar_21
  s_mov_b64 exec, s[62:63]
  s_add_u32 s21, s77, 0
  buffer_store_dword v28, v17, s[8:11], s21 offen sc1
  s_add_u32 s21, s77, 122880
  buffer_store_dword v28, v17, s[8:11], s21 offen sc1
  s_add_u32 s21, s77, 245760
  buffer_store_dword v28, v17, s[8:11], s21 offen sc1
  s_add_u32 s21, s77, 368640
  buffer_store_dword v28, v17, s[8:11], s21 offen sc1
  s_branch ar_21
ar_19:
  buffer_store_dword v28, v34, s[8:11], 0 offen sc1
  s_mov_b64 exec, s[66:67]
  s_mov_b32 s21, 0
  buffer_store_dwordx4 v[28:31], v15, s[4:7], s21 offen sc1
  s_mov_b32 s21, 262144
  buffer_store_dwordx4 v[28:31], v15, s[4:7], s21 offen sc1
  s_mov_b32 s21, 524288
  buffer_store_dwordx4 v[28:31], v15, s[4:7], s21 offen sc1
  s_mov_b32 s21, 786432
  buffer_store_dwordx4 v[28:31], v15, s[4:7], s21 offen sc1
  s_mov_b32 s21, 8192
  buffer_store_dwordx4 v[28:31], v15, s[4:7], s21 offen sc1
  s_mov_b32 s21, 270336
  buffer_store_dwordx4 v[28:31], v15, s[4:7], s21 offen sc1
  s_mov_b32 s21, 532480
  buffer_store_dwordx4 v[28:31], v15, s[4:7], s21 offen sc1
  s_mov_b32 s21, 794624
  buffer_store_dwordx4 v[28:31], v15, s[4:7], s21 offen sc1
ar_21:
  s_mov_b64 exec, -1
  s_waitcnt vmcnt(0)
  s_barrier
  s_mov_b32 s21, 100
  s_cmp_lg_u32 s20, 0
  s_cbranch_scc1 af_22
  v_mov_b32 v166, 0
  v_mov_b32 v167, 1
  s_mov_b64 exec, 1
  buffer_atomic_add v167, v166, s[32:35], s21 offen sc1
  s_mov_b64 exec, -1
  s_nop 1
af_22:
  s_cmp_lg_u32 s20, 0
  s_cbranch_scc1 wf_24
  v_mov_b32 v166, 0
  s_mov_b32 s101, 0
wf_23:
  buffer_load_dword v167, v166, s[32:35], s21 offen sc1
  s_add_u32 s101, s101, 1
  s_cmp_gt_u32 s101, 131072
  s_cbranch_scc1 end0
  s_waitcnt vmcnt(0)
  v_readfirstlane_b32 s100, v167
  s_cmp_ge_u32 s100, 128
  s_cbranch_scc1 wf_24
  s_sleep 8
  s_branch wf_23
wf_24:
  s_barrier
fm_15:
  s_xor_b32 s74, s74, 16384
  s_add_u32 s73, s73, 2097152
  s_xor_b32 s73, s73, 8192
  s_add_u32 s79, s79, 2097152
  s_xor_b32 s79, s79, 8192
  s_add_u32 s21, s72, 524288
  s_xor_b32 s72, s72, s21
  s_lshr_b32 s72, s72, 8
  s_and_b32 s72, s72, 8192
  s_xor_b32 s72, s72, s21
  v_add_u32 v15, s83, v15
  v_add_u32 v16, s83, v16
  s_mov_b32 s75, s77
  s_lshl_b32 s77, s58, 7
  s_lshl_b32 s21, s56, 3
  s_add_u32 s77, s77, s21
  s_add_u32 s77, s77, 0
  s_xor_b32 s77, s77, s83
  s_mov_b32 s80, 0x53800000
  s_mov_b32 s52, 0
  s_mov_b32 s81, 0
  v_xor_b32 v18, 16384, v18
  v_xor_b32 v19, 16384, v19
  v_xor_b32 v20, 16384, v20
  v_xor_b32 v21, 16384, v21
  v_mov_b32 v168, 0x3f803f80
  v_mov_b32 v169, 0x3f803f80
  v_mov_b32 v170, 0x3f803f80
  v_mov_b32 v171, 0x3f803f80
  v_mov_b32 v166, 0x3f003f00
  v_mov_b32 v167, 0x3f003f00
  s_waitcnt lgkmcnt(0)
  s_barrier
  ds_write_b128 v23, v[168:171] offset:46080
  ds_write_b128 v23, v[168:171] offset:62464
  ds_write_b64 v23, v[166:167] offset:13568
  v_mov_b32 v88, 0
  v_mov_b32 v89, 0
  v_mov_b32 v90, 0
  v_mov_b32 v91, 0
  v_mov_b32 v92, 0
  v_mov_b32 v93, 0
  v_mov_b32 v94, 0
  v_mov_b32 v95, 0
  v_mov_b32 v96, 0
  v_mov_b32 v97, 0
  v_mov_b32 v98, 0
  v_mov_b32 v99, 0
  v_mov_b32 v100, 0
  v_mov_b32 v101, 0
  v_mov_b32 v102, 0
  v_mov_b32 v103, 0
  v_mov_b32 v110, 0
  v_mov_b32 v111, 0
  v_mov_b32 v118, 0
  v_mov_b32 v119, 0
  v_mov_b32 v142, 0
  v_mov_b32 v143, 0
  v_mov_b32 v162, 0
  v_mov_b32 v163, 0
  s_and_b32 s21, s52, 3
  s_mul_i32 s56, s21, 122880
  s_add_u32 s21, s52, 1
  s_and_b32 s21, s21, 3
  s_mul_i32 s55, s21, 122880
  s_add_u32 s55, s55, s75
  s_add_u32 s21, s52, 2
  s_and_b32 s21, s21, 3
  s_mul_i32 s57, s21, 122880
  s_add_u32 s21, s52, 3
  s_and_b32 s21, s21, 3
  s_mul_i32 s59, s21, 122880
  s_add_u32 s59, s59, s75
  s_bfe_u32 s61, s52, 0x10002
  s_and_b32 s21, s52, 3
  s_lshl_b32 s60, s21, 18
  s_mov_b32 s58, s55
  s_waitcnt lgkmcnt(0)
  s_mov_b32 s90, 0x40000000
  s_lshl_b32 s21, s53, 2
  s_add_u32 s21, s21, s20
  s_cmp_eq_u32 s21, 0
  s_cbranch_scc1 E_25
  s_cmp_eq_u32 s21, 4
  s_cbranch_scc1 E_26
  s_cmp_eq_u32 s21, 1
  s_cbranch_scc1 E_27
  s_cmp_eq_u32 s21, 5
  s_cbranch_scc1 E_28
  s_cmp_eq_u32 s21, 2
  s_cbranch_scc1 E_29
  s_cmp_eq_u32 s21, 6
  s_cbranch_scc1 E_30
  s_cmp_eq_u32 s21, 3
  s_cbranch_scc1 E_31
  s_cmp_eq_u32 s21, 7
  s_cbranch_scc1 E_32
  s_branch end0
E_26:
  v_add_u32 v190, 0, v4
  s_waitcnt vmcnt(0)
  ds_write_b128 v190, v[48:51] offset:0
  ds_write_b128 v190, v[52:55] offset:1024
  ds_write_b128 v190, v[56:59] offset:2048
  s_add_u32 m0, s74, 9216
  s_add_u32 s21, s72, 32768
  buffer_load_dwordx4 v32, s[16:19], s21 offen sc1 lds
  s_add_u32 m0, s74, 4096
  s_add_u32 s21, s79, 131072
  buffer_load_dwordx4 v4, s[16:19], s21 offen offset:1024 sc1 lds
  s_xor_b32 s74, s74, 16384
  s_add_u32 s73, s73, 2097152
  s_xor_b32 s73, s73, 8192
  s_add_u32 s79, s79, 2097152
  s_xor_b32 s79, s79, 8192
  s_add_u32 s21, s72, 524288
  s_xor_b32 s72, s72, s21
  s_lshr_b32 s72, s72, 8
  s_and_b32 s72, s72, 8192
  s_xor_b32 s72, s72, s21
  s_branch mo_38
  .p2align 3
top_33:
  s_waitcnt vmcnt(2)
  ds_write_b128 v190, v[48:51] offset:0
  v_cmp_eq_u32 s[22:23], -1, v48
  s_waitcnt vmcnt(1)
  ds_write_b128 v190, v[52:55] offset:1024
  v_cmp_eq_u32 s[98:99], -1, v52
  s_waitcnt vmcnt(0)
  ds_write_b128 v190, v[56:59] offset:2048
  v_cmp_eq_u32 s[100:101], -1, v56
  s_or_b64 vcc, s[22:23], s[98:99]
  s_or_b64 vcc, vcc, s[100:101]
  s_cbranch_scc1 mr_34
mo_38:
  s_waitcnt lgkmcnt(0)
  s_barrier
  ds_read_b128 v[60:63], v4 offset:3072
  ds_read_b128 v[64:67], v4 offset:4096
  v_smfmac_f32_16x16x64_bf16 v[92:95], v[48:51], a[240:247], v22
  ds_read_b128 v[68:71], v4 offset:5120
  v_smfmac_f32_16x16x64_bf16 v[88:91], v[48:51], a[160:167], v22
  ds_read_b128 v[72:75], v4 offset:6144
  v_smfmac_f32_16x16x64_bf16 v[92:95], v[52:55], a[248:255], v22
  ds_read_b128 v[76:79], v4 offset:7168
  v_smfmac_f32_16x16x64_bf16 v[88:91], v[52:55], a[168:175], v22
  ds_read_b128 v[80:83], v4 offset:8192
  v_smfmac_f32_16x16x64_bf16 v[92:95], v[56:59], v[192:199], v22
  ds_read_b128 v[84:87], v4 offset:9216
  v_smfmac_f32_16x16x64_bf16 v[88:91], v[56:59], a[176:183], v22
  s_waitcnt lgkmcnt(6)
  v_smfmac_f32_16x16x64_bf16 v[92:95], v[60:63], v[200:207], v22
  v_smfmac_f32_16x16x64_bf16 v[88:91], v[60:63], a[184:191], v22
  s_waitcnt lgkmcnt(5)
  v_smfmac_f32_16x16x64_bf16 v[92:95], v[64:67], v[208:215], v22
  s_waitcnt lgkmcnt(4)
  v_smfmac_f32_16x16x64_bf16 v[92:95], v[68:71], v[216:223], v22
  s_waitcnt lgkmcnt(3)
  v_smfmac_f32_16x16x64_bf16 v[92:95], v[72:75], v[224:231], v22
  s_waitcnt lgkmcnt(2)
  v_smfmac_f32_16x16x64_bf16 v[92:95], v[76:79], v[232:239], v22
  s_waitcnt lgkmcnt(1)
  v_smfmac_f32_16x16x64_bf16 v[92:95], v[80:83], v[240:247], v22
  s_waitcnt lgkmcnt(0)
  v_smfmac_f32_16x16x64_bf16 v[92:95], v[84:87], v[248:255], v22
  v_smfmac_f32_16x16x64_bf16 v[88:91], v[64:67], a[192:199], v22
  v_smfmac_f32_16x16x64_bf16 v[88:91], v[68:71], a[200:207], v22
  v_smfmac_f32_16x16x64_bf16 v[88:91], v[72:75], a[208:215], v22
  v_permlane32_swap_b32 v92, v93
  v_smfmac_f32_16x16x64_bf16 v[88:91], v[76:79], a[216:223], v22
  v_permlane32_swap_b32 v94, v95
  v_smfmac_f32_16x16x64_bf16 v[88:91], v[80:83], a[224:231], v22
  v_permlane32_swap_b32 v93, v92
  v_smfmac_f32_16x16x64_bf16 v[88:91], v[84:87], a[232:239], v22
  v_permlane32_swap_b32 v95, v94
  v_pk_mul_f32 v[120:121], v[92:93], v[24:25] op_sel:[1,0] op_sel_hi:[0,1]
  v_pk_mul_f32 v[122:123], v[94:95], v[24:25] op_sel:[1,0] op_sel_hi:[0,1]
  s_nop 4
  v_pk_fma_f32 v[88:89], v[88:89], v[24:25], v[120:121]
  v_pk_fma_f32 v[90:91], v[90:91], v[24:25], v[122:123]
  v_cvt_pk_bf16_f32 v120, v88, v89
  v_cvt_pk_bf16_f32 v121, v90, v91
  ds_write_b64 v6, v[120:121]
  v_cmp_u_f32 vcc, v88, v89
  v_cmp_u_f32 s[22:23], v90, v91
  s_nop 1
  s_or_b64 vcc, vcc, s[22:23]
  s_cbranch_vccnz mn_35
mk_36:
  s_waitcnt lgkmcnt(0)
  s_barrier
  ds_read_b64_tr_b16 v[104:105], v7 offset:0
  ds_read_b64_tr_b16 v[106:107], v7 offset:768
  ds_read_b64_tr_b16 v[108:109], v7 offset:1536
  ds_read_b64 v[140:141], v11
  s_cmp_eq_u32 s52, 63
  s_cbranch_scc1 last_37
  s_waitcnt lgkmcnt(2)
  v_mfma_f32_16x16x32_bf16 v[120:123], v[112:115], v[104:107], 0
  s_waitcnt lgkmcnt(1)
  v_mfma_f32_16x16x32_bf16 v[120:123], v[116:119], v[108:111], v[120:123]
  s_mov_b64 exec, s[64:65]
  s_nop 6
  v_cvt_pk_f16_f32 v120, v120, v121
  v_cvt_pk_f16_f32 v121, v122, v123
  buffer_store_dwordx2 v[120:121], v8, s[8:11], s56 offen
  s_mov_b64 exec, -1
  s_sleep 3
  s_nop 1
  v_smfmac_f32_16x16x64_bf16 v[96:99], v[48:51], a[0:7], v22
  v_smfmac_f32_16x16x64_bf16 v[100:103], v[48:51], a[80:87], v22
  v_smfmac_f32_16x16x64_bf16 v[96:99], v[52:55], a[8:15], v22
  v_smfmac_f32_16x16x64_bf16 v[100:103], v[52:55], a[88:95], v22
  v_smfmac_f32_16x16x64_bf16 v[96:99], v[56:59], a[16:23], v22
  v_smfmac_f32_16x16x64_bf16 v[100:103], v[56:59], a[96:103], v22
  v_smfmac_f32_16x16x64_bf16 v[96:99], v[60:63], a[24:31], v22
  v_smfmac_f32_16x16x64_bf16 v[96:99], v[64:67], a[32:39], v22
  v_smfmac_f32_16x16x64_bf16 v[96:99], v[68:71], a[40:47], v22
  v_smfmac_f32_16x16x64_bf16 v[96:99], v[72:75], a[48:55], v22
  v_smfmac_f32_16x16x64_bf16 v[96:99], v[76:79], a[56:63], v22
  buffer_load_dwordx4 v[124:127], v9, s[8:11], s56 offen sc1
  v_smfmac_f32_16x16x64_bf16 v[96:99], v[80:83], a[64:71], v22
  buffer_load_dwordx4 v[128:131], v9, s[8:11], s56 offen offset:1024 sc1
  v_smfmac_f32_16x16x64_bf16 v[96:99], v[84:87], a[72:79], v22
  buffer_load_dwordx4 v[132:135], v10, s[8:11], s56 offen sc1
  v_smfmac_f32_16x16x64_bf16 v[100:103], v[60:63], a[104:111], v22
  v_smfmac_f32_16x16x64_bf16 v[100:103], v[64:67], a[112:119], v22
  v_smfmac_f32_16x16x64_bf16 v[100:103], v[68:71], a[120:127], v22
  v_smfmac_f32_16x16x64_bf16 v[100:103], v[72:75], a[128:135], v22
  v_cvt_pk_bf16_f32 v136, v96, v97
  v_smfmac_f32_16x16x64_bf16 v[100:103], v[76:79], a[136:143], v22
  v_cvt_pk_bf16_f32 v137, v98, v99
  v_smfmac_f32_16x16x64_bf16 v[100:103], v[80:83], a[144:151], v22
  v_smfmac_f32_16x16x64_bf16 v[100:103], v[84:87], a[152:159], v22
  s_waitcnt vmcnt(2)
  v_pk_add_f16 v172, v124, v126
  v_pk_add_f16 v173, v125, v127
  s_waitcnt vmcnt(1)
  v_pk_add_f16 v174, v128, v130
  v_pk_add_f16 v175, v129, v131
  v_fma_mix_f32 v166, v172, 1.0, v174 op_sel:[0,0,0] op_sel_hi:[1,0,1]
  v_fma_mix_f32 v168, v173, 1.0, v175 op_sel:[0,0,0] op_sel_hi:[1,0,1]
  s_waitcnt vmcnt(0)
  v_pk_add_f16 v176, v132, v133
  v_pk_add_f16 v177, v134, v135
  v_fma_mix_f32 v170, v176, 1.0, v177 op_sel:[0,0,0] op_sel_hi:[1,0,1]
  v_fma_mix_f32 v167, v172, 1.0, v174 op_sel:[1,0,1] op_sel_hi:[1,0,1]
  v_cmp_u_f32 vcc, v166, v170
  v_fma_mix_f32 v169, v173, 1.0, v175 op_sel:[1,0,1] op_sel_hi:[1,0,1]
  v_fma_mix_f32 v171, v176, 1.0, v177 op_sel:[1,0,1] op_sel_hi:[1,0,1]
  v_cvt_pk_bf16_f32 v138, v100, v101
  s_cbranch_vccnz sr_39
sj_40:
ex_41:
  v_exp_f32 v172, v166
  v_exp_f32 v173, v167
  v_exp_f32 v174, v168
  v_cvt_pk_bf16_f32 v156, v172, v173
  v_exp_f32 v175, v169
  v_exp_f32 v176, v170
  v_cvt_pk_bf16_f32 v157, v174, v175
  v_mov_b32_dpp v158, v156 row_ror:8 row_mask:0xf bank_mask:0xf
  v_exp_f32 v177, v171
  v_mov_b32_dpp v159, v157 row_ror:8 row_mask:0xf bank_mask:0xf
  v_cvt_pk_bf16_f32 v160, v176, v177
  v_cvt_pk_bf16_f32 v139, v102, v103
  v_mfma_f32_16x16x32_bf16 v[178:181], v[152:155], v[156:159], 0
  s_waitcnt lgkmcnt(0)
  v_mov_b32_dpp v161, v160 row_ror:8 row_mask:0xf bank_mask:0xf
  v_mfma_f32_16x16x32_bf16 v[182:185], v[144:147], v[156:159], 0
  s_nop 0
  v_mfma_f32_16x16x32_bf16 v[178:181], v[140:143], v[160:163], v[178:181]
  v_mfma_f32_16x16x32_bf16 v[182:185], v[136:139], v[160:163], v[182:185]
  v_mfma_f32_16x16x32_bf16 v[186:189], v[148:151], v[156:159], 0
  v_mfma_f32_16x16x32_bf16 v[186:189], v[138:141], v[160:163], v[186:189]
  s_mov_b64 exec, s[62:63]
  v_rcp_f32 v164, v180
  s_nop 0
  v_pk_mul_f32 v[178:179], v[178:179], v[164:165] op_sel_hi:[1,0]
  v_pk_mul_f32 v[182:183], v[182:183], v[164:165] op_sel_hi:[1,0]
  v_pk_mul_f32 v[184:185], v[184:185], v[164:165] op_sel_hi:[1,0]
  v_cvt_pk_f16_f32 v64, v178, v179
  v_cvt_pk_f16_f32 v60, v182, v183
  v_pk_mul_f32 v[186:187], v[186:187], v[164:165] op_sel_hi:[1,0]
  v_pk_mul_f32 v[188:189], v[188:189], v[164:165] op_sel_hi:[1,0]
  v_cvt_pk_f16_f32 v61, v184, v185
  v_cvt_pk_f16_f32 v62, v186, v187
  v_cvt_pk_f16_f32 v63, v188, v189
  ds_write_b128 v13, v[60:63]
  ds_write_b32 v14, v64
  v_add_f32 v165, v164, v180
  v_cmp_ngt_f32 vcc, s80, v165
  s_mov_b64 exec, -1
  s_nop 0
  s_cbranch_vccnz fx_42
fk_43:
  s_waitcnt lgkmcnt(0)
  s_barrier
  s_add_u32 m0, s74, 9216
  s_add_u32 s21, s72, 32768
  buffer_load_dwordx4 v32, s[16:19], s21 offen sc1 lds
  s_add_u32 m0, s74, 4096
  s_add_u32 s21, s79, 131072
  buffer_load_dwordx4 v4, s[16:19], s21 offen offset:1024 sc1 lds
  s_xor_b32 s74, s74, 16384
  s_add_u32 s73, s73, 2097152
  s_xor_b32 s73, s73, 8192
  s_add_u32 s79, s79, 2097152
  s_xor_b32 s79, s79, 8192
  s_add_u32 s21, s72, 524288
  s_xor_b32 s72, s72, s21
  s_lshr_b32 s72, s72, 8
  s_and_b32 s72, s72, 8192
  s_xor_b32 s72, s72, s21
  s_nop 15
  s_nop 3
  v_permlane32_swap_b32 v96, v100
  v_permlane32_swap_b32 v97, v101
  v_permlane32_swap_b32 v98, v102
  v_permlane32_swap_b32 v99, v103
  v_pk_add_f32 v[96:97], v[96:97], v[100:101]
  v_pk_add_f32 v[98:99], v[98:99], v[102:103]
  v_cvt_pk_bf16_f32 v182, v96, v97
  v_cvt_pk_bf16_f32 v183, v98, v99
  v_min_u32 v182, -2, v182
  ds_write_b64 v26, v[182:183]
  ds_read_b128 v[144:147], v18
  ds_read_b128 v[148:151], v18 offset:1024
  ds_read_b128 v[152:155], v19
  ds_read_b128 v[112:115], v20
  ds_read_b64 v[116:117], v21
  v_xor_b32 v18, 16384, v18
  v_xor_b32 v19, 16384, v19
  v_xor_b32 v20, 16384, v20
  v_xor_b32 v21, 16384, v21
  v_mov_b32 v88, 0
  v_mov_b32 v89, 0
  v_mov_b32 v90, 0
  v_mov_b32 v91, 0
  v_mov_b32 v92, 0
  v_mov_b32 v93, 0
  v_mov_b32 v94, 0
  v_mov_b32 v95, 0
  v_mov_b32 v96, 0
  v_mov_b32 v97, 0
  v_mov_b32 v98, 0
  v_mov_b32 v99, 0
  v_mov_b32 v100, 0
  v_mov_b32 v101, 0
  v_mov_b32 v102, 0
  v_mov_b32 v103, 0
  s_mov_b32 s81, 0
  s_waitcnt lgkmcnt(0)
  s_barrier
  s_mov_b64 exec, s[64:65]
  buffer_store_dwordx2 v[28:29], v8, s[8:11], s57 offen
  s_mov_b64 exec, s[62:63]
  buffer_store_dword v28, v17, s[8:11], s59 offen
  s_mov_b64 exec, -1
  s_sleep 6
  s_nop 3
  buffer_load_dwordx4 v[68:71], v16, s[4:7], s60 offen sc1
  s_sleep 3
  s_nop 1
  buffer_load_dwordx4 v[72:75], v16, s[4:7], s60 offen sc1
  s_waitcnt vmcnt(1)
  v_mfma_f32_16x16x32_f16 v[120:123], v[44:47], v[68:71], 0
  v_bitop3_b32 v27, v68, s61, 1 bitop3:0x28
  v_cmp_ne_u32 vcc, 0, v27
  s_nop 1
  s_cbranch_vccnz p2_48
  s_nop 2
pg_47:
  v_add_f32_dpp v120, v120, v120 row_ror:8 row_mask:0xf bank_mask:0xf
  v_add_f32_dpp v121, v121, v121 row_ror:8 row_mask:0xf bank_mask:0xf
  s_mov_b64 exec, s[62:63]
  v_cvt_pk_bf16_f32 v120, v120, v121
  v_min_u32 v120, -2, v120
  buffer_store_dword v120, v17, s[8:11], s55 offen
  s_mov_b64 exec, -1
nt_44:
  s_barrier
  s_mov_b32 s58, s55
  s_add_u32 s52, s52, 1
  s_and_b32 s21, s52, 3
  s_mul_i32 s56, s21, 122880
  s_add_u32 s21, s52, 1
  s_and_b32 s21, s21, 3
  s_mul_i32 s55, s21, 122880
  s_add_u32 s55, s55, s75
  s_add_u32 s21, s52, 2
  s_and_b32 s21, s21, 3
  s_mul_i32 s57, s21, 122880
  s_add_u32 s21, s52, 3
  s_and_b32 s21, s21, 3
  s_mul_i32 s59, s21, 122880
  s_add_u32 s59, s59, s75
  s_bfe_u32 s61, s52, 0x10002
  s_and_b32 s21, s52, 3
  s_lshl_b32 s60, s21, 18
  s_mov_b32 s54, 0
  s_sleep 3
  s_nop 2
  buffer_load_dwordx4 v[48:51], v190, s[8:11], s58 offen offset:0 sc1
  buffer_load_dwordx4 v[52:55], v190, s[8:11], s58 offen offset:1024 sc1
  buffer_load_dwordx4 v[56:59], v190, s[8:11], s58 offen offset:2048 sc1
  s_branch top_33
mr_34:
  s_mov_b64 exec, s[22:23]
  s_cbranch_execz ms_49
  buffer_load_dwordx4 v[48:51], v190, s[8:11], s58 offen offset:0 sc1
ms_49:
  s_mov_b64 exec, s[98:99]
  s_cbranch_execz ms_50
  buffer_load_dwordx4 v[52:55], v190, s[8:11], s58 offen offset:1024 sc1
ms_50:
  s_mov_b64 exec, s[100:101]
  s_cbranch_execz ms_51
  buffer_load_dwordx4 v[56:59], v190, s[8:11], s58 offen offset:2048 sc1
ms_51:
  s_add_u32 s54, s54, 1
  s_cmp_gt_u32 s54, 131072
  s_cbranch_scc1 end0
  s_waitcnt vmcnt(0)
  s_mov_b64 exec, s[22:23]
  ds_write_b128 v190, v[48:51] offset:0
  v_cmp_eq_u32 s[22:23], -1, v48
  s_mov_b64 exec, s[98:99]
  ds_write_b128 v190, v[52:55] offset:1024
  v_cmp_eq_u32 s[98:99], -1, v52
  s_mov_b64 exec, s[100:101]
  ds_write_b128 v190, v[56:59] offset:2048
  v_cmp_eq_u32 s[100:101], -1, v56
  s_mov_b64 exec, -1
  s_or_b64 vcc, s[22:23], s[98:99]
  s_or_b64 vcc, vcc, s[100:101]
  s_cbranch_scc1 mr_34
  s_branch mo_38
mn_35:
  v_max3_u32 v27, v48, v49, v50
  v_max3_u32 v27, v27, v51, v52
  v_max3_u32 v27, v27, v53, v54
  v_max3_u32 v27, v27, v55, v56
  v_max3_u32 v27, v27, v57, v58
  v_max3_u32 v27, v27, v59, v60
  v_max3_u32 v27, v27, v61, v62
  v_max3_u32 v27, v27, v63, v64
  v_max3_u32 v27, v27, v65, v66
  v_max3_u32 v27, v27, v67, v68
  v_max3_u32 v27, v27, v69, v70
  v_max3_u32 v27, v27, v71, v72
  v_max3_u32 v27, v27, v73, v74
  v_max3_u32 v27, v27, v75, v76
  v_max3_u32 v27, v27, v77, v78
  v_max3_u32 v27, v27, v79, v80
  v_max3_u32 v27, v27, v81, v82
  v_max3_u32 v27, v27, v83, v84
  v_max3_u32 v27, v27, v85, v86
  v_max3_u32 v27, v27, v87, v87
  v_cmp_eq_u32 vcc, -1, v27
  s_cmp_eq_u32 s52, 0
  s_cbranch_scc1 mk_36
  s_cbranch_vccz mk_36
  s_waitcnt lgkmcnt(0)
  s_barrier
  s_nop 7
  v_mov_b32 v88, 0
  v_mov_b32 v89, 0
  v_mov_b32 v90, 0
  v_mov_b32 v91, 0
  v_mov_b32 v92, 0
  v_mov_b32 v93, 0
  v_mov_b32 v94, 0
  v_mov_b32 v95, 0
  v_mov_b32 v96, 0
  v_mov_b32 v97, 0
  v_mov_b32 v98, 0
  v_mov_b32 v99, 0
  v_mov_b32 v100, 0
  v_mov_b32 v101, 0
  v_mov_b32 v102, 0
  v_mov_b32 v103, 0
  s_mov_b64 s[22:23], -1
  s_mov_b64 s[98:99], -1
  s_mov_b64 s[100:101], -1
  s_branch mr_34
sr_39:
  s_mov_b32 s54, 0
sr_52:
  s_mov_b64 exec, vcc
  buffer_load_dwordx4 v[124:127], v9, s[8:11], s56 offen sc1
  buffer_load_dwordx4 v[128:131], v9, s[8:11], s56 offen offset:1024 sc1
  buffer_load_dwordx4 v[132:135], v10, s[8:11], s56 offen sc1
  s_mov_b64 exec, -1
  s_add_u32 s54, s54, 1
  s_cmp_gt_u32 s54, 131072
  s_cbranch_scc1 end0
  s_and_b32 s21, s54, 31
  s_cbranch_scc0 sr_53
  s_waitcnt vmcnt(0)
  v_pk_add_f16 v172, v124, v126
  v_pk_add_f16 v173, v125, v127
  v_pk_add_f16 v174, v128, v130
  v_pk_add_f16 v175, v129, v131
  v_fma_mix_f32 v166, v172, 1.0, v174 op_sel:[0,0,0] op_sel_hi:[1,0,1]
  v_fma_mix_f32 v168, v173, 1.0, v175 op_sel:[0,0,0] op_sel_hi:[1,0,1]
  v_pk_add_f16 v176, v132, v133
  v_pk_add_f16 v177, v134, v135
  v_add_f32 v27, v166, v168
  v_fma_mix_f32 v170, v176, 1.0, v177 op_sel:[0,0,0] op_sel_hi:[1,0,1]
  v_fma_mix_f32 v167, v172, 1.0, v174 op_sel:[1,0,1] op_sel_hi:[1,0,1]
  v_cmp_u_f32 vcc, v27, v170
  v_fma_mix_f32 v169, v173, 1.0, v175 op_sel:[1,0,1] op_sel_hi:[1,0,1]
  v_fma_mix_f32 v171, v176, 1.0, v177 op_sel:[1,0,1] op_sel_hi:[1,0,1]
  s_cbranch_vccnz sr_52
  s_branch sj_40
sr_53:
  s_waitcnt vmcnt(0)
  v_pk_add_f16 v172, v124, v126
  v_pk_add_f16 v173, v125, v127
  v_pk_add_f16 v174, v128, v130
  v_pk_add_f16 v175, v129, v131
  v_fma_mix_f32 v166, v172, 1.0, v174 op_sel:[0,0,0] op_sel_hi:[1,0,1]
  v_fma_mix_f32 v168, v173, 1.0, v175 op_sel:[0,0,0] op_sel_hi:[1,0,1]
  v_pk_add_f16 v176, v132, v133
  v_pk_add_f16 v177, v134, v135
  v_add_f32 v27, v166, v168
  v_fma_mix_f32 v170, v176, 1.0, v177 op_sel:[0,0,0] op_sel_hi:[1,0,1]
  v_fma_mix_f32 v167, v172, 1.0, v174 op_sel:[1,0,1] op_sel_hi:[1,0,1]
  v_cmp_u_f32 vcc, v27, v170
  v_fma_mix_f32 v169, v173, 1.0, v175 op_sel:[1,0,1] op_sel_hi:[1,0,1]
  v_fma_mix_f32 v171, v176, 1.0, v177 op_sel:[1,0,1] op_sel_hi:[1,0,1]
  v_max3_u32 v27, v124, v126, v128
  v_max3_u32 v27, v27, v130, v132
  v_max3_u32 v27, v27, v133, v134
  v_max3_u32 v27, v27, v135, v135
  v_cmp_eq_u32 vcc, -1, v27
  s_nop 1
  s_cbranch_vccnz sr_52
  s_branch sj_40
fx_42:
  s_cmp_eq_u32 s81, 1
  s_cbranch_scc1 fk_43
  s_mov_b32 s81, 1
  v_max3_f32 v164, v166, v167, v168
  v_max3_f32 v165, v169, v170, v171
  v_max_f32 v164, v164, v165
  s_nop 1
  v_max_f32_dpp v164, v164, v164 row_ror:8 row_mask:0xf bank_mask:0xf
  v_mov_b32 v165, v164
  s_nop 1
  v_permlane32_swap_b32 v164, v165
  v_max_f32 v164, v164, v165
  v_mov_b32 v165, v164
  s_nop 1
  v_permlane16_swap_b32 v164, v165
  v_max_f32 v164, v164, v165
  v_sub_f32 v166, v166, v164
  v_sub_f32 v167, v167, v164
  v_sub_f32 v168, v168, v164
  v_sub_f32 v169, v169, v164
  v_sub_f32 v170, v170, v164
  v_sub_f32 v171, v171, v164
  s_branch ex_41
p2_48:
  s_mov_b32 s54, 0
  buffer_load_dwordx4 v[68:71], v16, s[4:7], s60 offen sc1
  s_waitcnt vmcnt(1)
  v_mfma_f32_16x16x32_f16 v[120:123], v[44:47], v[72:75], 0
  v_bitop3_b32 v27, v72, s61, 1 bitop3:0x28
  v_cmp_ne_u32 vcc, 0, v27
  s_nop 1
  s_cbranch_vccz pg_47
  buffer_load_dwordx4 v[72:75], v16, s[4:7], s60 offen sc1
pp_46:
  s_waitcnt vmcnt(1)
  v_mfma_f32_16x16x32_f16 v[120:123], v[44:47], v[68:71], 0
  v_bitop3_b32 v27, v68, s61, 1 bitop3:0x28
  v_cmp_ne_u32 vcc, 0, v27
  s_nop 1
  s_cbranch_vccz pg_47
  buffer_load_dwordx4 v[68:71], v16, s[4:7], s60 offen sc1
  s_waitcnt vmcnt(1)
  v_mfma_f32_16x16x32_f16 v[120:123], v[44:47], v[72:75], 0
  v_bitop3_b32 v27, v72, s61, 1 bitop3:0x28
  v_cmp_ne_u32 vcc, 0, v27
  s_nop 1
  s_cbranch_vccz pg_47
  buffer_load_dwordx4 v[72:75], v16, s[4:7], s60 offen sc1
  s_add_u32 s54, s54, 1
  s_cmp_gt_u32 s54, 131072
  s_cbranch_scc1 end0
  s_branch pp_46
last_37:
  v_smfmac_f32_16x16x64_bf16 v[96:99], v[48:51], a[0:7], v22
  v_smfmac_f32_16x16x64_bf16 v[100:103], v[48:51], a[80:87], v22
  v_smfmac_f32_16x16x64_bf16 v[96:99], v[52:55], a[8:15], v22
  v_smfmac_f32_16x16x64_bf16 v[100:103], v[52:55], a[88:95], v22
  v_smfmac_f32_16x16x64_bf16 v[96:99], v[56:59], a[16:23], v22
  v_smfmac_f32_16x16x64_bf16 v[100:103], v[56:59], a[96:103], v22
  v_smfmac_f32_16x16x64_bf16 v[96:99], v[60:63], a[24:31], v22
  v_smfmac_f32_16x16x64_bf16 v[96:99], v[64:67], a[32:39], v22
  v_smfmac_f32_16x16x64_bf16 v[96:99], v[68:71], a[40:47], v22
  v_smfmac_f32_16x16x64_bf16 v[96:99], v[72:75], a[48:55], v22
  v_smfmac_f32_16x16x64_bf16 v[96:99], v[76:79], a[56:63], v22
  v_smfmac_f32_16x16x64_bf16 v[96:99], v[80:83], a[64:71], v22
  v_smfmac_f32_16x16x64_bf16 v[96:99], v[84:87], a[72:79], v22
  v_smfmac_f32_16x16x64_bf16 v[100:103], v[60:63], a[104:111], v22
  v_smfmac_f32_16x16x64_bf16 v[100:103], v[64:67], a[112:119], v22
  v_smfmac_f32_16x16x64_bf16 v[100:103], v[68:71], a[120:127], v22
  v_smfmac_f32_16x16x64_bf16 v[100:103], v[72:75], a[128:135], v22
  v_smfmac_f32_16x16x64_bf16 v[100:103], v[76:79], a[136:143], v22
  v_smfmac_f32_16x16x64_bf16 v[100:103], v[80:83], a[144:151], v22
  v_smfmac_f32_16x16x64_bf16 v[100:103], v[84:87], a[152:159], v22
  s_nop 7
  v_permlane32_swap_b32 v96, v100
  v_permlane32_swap_b32 v97, v101
  v_permlane32_swap_b32 v98, v102
  v_permlane32_swap_b32 v99, v103
  v_pk_add_f32 v[96:97], v[96:97], v[100:101]
  v_pk_add_f32 v[98:99], v[98:99], v[102:103]
  v_cvt_pk_bf16_f32 v182, v96, v97
  v_cvt_pk_bf16_f32 v183, v98, v99
  v_min_u32 v182, -2, v182
  ds_write_b64 v26, v[182:183]
  s_waitcnt lgkmcnt(0)
  s_barrier
  s_branch chain_done
E_28:
  v_add_u32 v190, 3072, v4
  s_waitcnt vmcnt(0)
  ds_write_b128 v190, v[60:63] offset:0
  ds_write_b128 v190, v[64:67] offset:1024
  ds_write_b128 v190, v[68:71] offset:2048
  s_add_u32 m0, s74, 2048
  s_add_u32 s21, s79, 65536
  buffer_load_dwordx4 v4, s[16:19], s21 offen offset:1024 sc1 lds
  s_add_u32 m0, s74, 6144
  s_add_u32 s21, s79, 196608
  buffer_load_dwordx4 v4, s[16:19], s21 offen offset:0 sc1 lds
  s_xor_b32 s74, s74, 16384
  s_add_u32 s73, s73, 2097152
  s_xor_b32 s73, s73, 8192
  s_add_u32 s79, s79, 2097152
  s_xor_b32 s79, s79, 8192
  s_add_u32 s21, s72, 524288
  s_xor_b32 s72, s72, s21
  s_lshr_b32 s72, s72, 8
  s_and_b32 s72, s72, 8192
  s_xor_b32 s72, s72, s21
  s_branch mo_59
  .p2align 3
top_54:
  s_waitcnt vmcnt(2)
  ds_write_b128 v190, v[60:63] offset:0
  v_cmp_eq_u32 s[22:23], -1, v60
  s_waitcnt vmcnt(1)
  ds_write_b128 v190, v[64:67] offset:1024
  v_cmp_eq_u32 s[98:99], -1, v64
  s_waitcnt vmcnt(0)
  ds_write_b128 v190, v[68:71] offset:2048
  v_cmp_eq_u32 s[100:101], -1, v68
  s_or_b64 vcc, s[22:23], s[98:99]
  s_or_b64 vcc, vcc, s[100:101]
  s_cbranch_scc1 mr_55
mo_59:
  s_waitcnt lgkmcnt(0)
  s_barrier
  ds_read_b128 v[48:51], v4 offset:0
  ds_read_b128 v[52:55], v4 offset:1024
  v_smfmac_f32_16x16x64_bf16 v[92:95], v[60:63], v[200:207], v22
  ds_read_b128 v[56:59], v4 offset:2048
  v_smfmac_f32_16x16x64_bf16 v[88:91], v[60:63], a[184:191], v22
  ds_read_b128 v[72:75], v4 offset:6144
  v_smfmac_f32_16x16x64_bf16 v[92:95], v[64:67], v[208:215], v22
  ds_read_b128 v[76:79], v4 offset:7168
  v_smfmac_f32_16x16x64_bf16 v[88:91], v[64:67], a[192:199], v22
  ds_read_b128 v[80:83], v4 offset:8192
  v_smfmac_f32_16x16x64_bf16 v[92:95], v[68:71], v[216:223], v22
  ds_read_b128 v[84:87], v4 offset:9216
  v_smfmac_f32_16x16x64_bf16 v[88:91], v[68:71], a[200:207], v22
  s_waitcnt lgkmcnt(6)
  v_smfmac_f32_16x16x64_bf16 v[92:95], v[48:51], a[240:247], v22
  v_smfmac_f32_16x16x64_bf16 v[88:91], v[48:51], a[160:167], v22
  s_waitcnt lgkmcnt(5)
  v_smfmac_f32_16x16x64_bf16 v[92:95], v[52:55], a[248:255], v22
  s_waitcnt lgkmcnt(4)
  v_smfmac_f32_16x16x64_bf16 v[92:95], v[56:59], v[192:199], v22
  s_waitcnt lgkmcnt(3)
  v_smfmac_f32_16x16x64_bf16 v[92:95], v[72:75], v[224:231], v22
  s_waitcnt lgkmcnt(2)
  v_smfmac_f32_16x16x64_bf16 v[92:95], v[76:79], v[232:239], v22
  s_waitcnt lgkmcnt(1)
  v_smfmac_f32_16x16x64_bf16 v[92:95], v[80:83], v[240:247], v22
  s_waitcnt lgkmcnt(0)
  v_smfmac_f32_16x16x64_bf16 v[92:95], v[84:87], v[248:255], v22
  v_smfmac_f32_16x16x64_bf16 v[88:91], v[52:55], a[168:175], v22
  v_smfmac_f32_16x16x64_bf16 v[88:91], v[56:59], a[176:183], v22
  v_smfmac_f32_16x16x64_bf16 v[88:91], v[72:75], a[208:215], v22
  v_permlane32_swap_b32 v92, v93
  v_smfmac_f32_16x16x64_bf16 v[88:91], v[76:79], a[216:223], v22
  v_permlane32_swap_b32 v94, v95
  v_smfmac_f32_16x16x64_bf16 v[88:91], v[80:83], a[224:231], v22
  v_permlane32_swap_b32 v93, v92
  v_smfmac_f32_16x16x64_bf16 v[88:91], v[84:87], a[232:239], v22
  v_permlane32_swap_b32 v95, v94
  v_pk_mul_f32 v[120:121], v[92:93], v[24:25] op_sel:[1,0] op_sel_hi:[0,1]
  v_pk_mul_f32 v[122:123], v[94:95], v[24:25] op_sel:[1,0] op_sel_hi:[0,1]
  s_nop 4
  v_pk_fma_f32 v[88:89], v[88:89], v[24:25], v[120:121]
  v_pk_fma_f32 v[90:91], v[90:91], v[24:25], v[122:123]
  v_cvt_pk_bf16_f32 v120, v88, v89
  v_cvt_pk_bf16_f32 v121, v90, v91
  ds_write_b64 v6, v[120:121]
  v_cmp_u_f32 vcc, v88, v89
  v_cmp_u_f32 s[22:23], v90, v91
  s_nop 1
  s_or_b64 vcc, vcc, s[22:23]
  s_cbranch_vccnz mn_56
mk_57:
  s_waitcnt lgkmcnt(0)
  s_barrier
  ds_read_b64_tr_b16 v[104:105], v7 offset:0
  ds_read_b64_tr_b16 v[106:107], v7 offset:768
  ds_read_b64_tr_b16 v[108:109], v7 offset:1536
  ds_read_b64 v[140:141], v11
  s_cmp_eq_u32 s52, 63
  s_cbranch_scc1 last_58
  s_waitcnt lgkmcnt(2)
  v_mfma_f32_16x16x32_bf16 v[120:123], v[112:115], v[104:107], 0
  s_waitcnt lgkmcnt(1)
  v_mfma_f32_16x16x32_bf16 v[120:123], v[116:119], v[108:111], v[120:123]
  s_mov_b64 exec, s[64:65]
  s_nop 6
  v_cvt_pk_f16_f32 v120, v120, v121
  v_cvt_pk_f16_f32 v121, v122, v123
  buffer_store_dwordx2 v[120:121], v8, s[8:11], s56 offen
  s_mov_b64 exec, -1
  s_sleep 3
  s_nop 1
  v_smfmac_f32_16x16x64_bf16 v[96:99], v[48:51], a[0:7], v22
  v_smfmac_f32_16x16x64_bf16 v[100:103], v[48:51], a[80:87], v22
  v_smfmac_f32_16x16x64_bf16 v[96:99], v[52:55], a[8:15], v22
  v_smfmac_f32_16x16x64_bf16 v[100:103], v[52:55], a[88:95], v22
  v_smfmac_f32_16x16x64_bf16 v[96:99], v[56:59], a[16:23], v22
  v_smfmac_f32_16x16x64_bf16 v[100:103], v[56:59], a[96:103], v22
  v_smfmac_f32_16x16x64_bf16 v[96:99], v[60:63], a[24:31], v22
  v_smfmac_f32_16x16x64_bf16 v[96:99], v[64:67], a[32:39], v22
  v_smfmac_f32_16x16x64_bf16 v[96:99], v[68:71], a[40:47], v22
  v_smfmac_f32_16x16x64_bf16 v[96:99], v[72:75], a[48:55], v22
  v_smfmac_f32_16x16x64_bf16 v[96:99], v[76:79], a[56:63], v22
  buffer_load_dwordx4 v[124:127], v9, s[8:11], s56 offen sc1
  v_smfmac_f32_16x16x64_bf16 v[96:99], v[80:83], a[64:71], v22
  buffer_load_dwordx4 v[128:131], v9, s[8:11], s56 offen offset:1024 sc1
  v_smfmac_f32_16x16x64_bf16 v[96:99], v[84:87], a[72:79], v22
  buffer_load_dwordx4 v[132:135], v10, s[8:11], s56 offen sc1
  v_smfmac_f32_16x16x64_bf16 v[100:103], v[60:63], a[104:111], v22
  v_smfmac_f32_16x16x64_bf16 v[100:103], v[64:67], a[112:119], v22
  v_smfmac_f32_16x16x64_bf16 v[100:103], v[68:71], a[120:127], v22
  v_smfmac_f32_16x16x64_bf16 v[100:103], v[72:75], a[128:135], v22
  v_cvt_pk_bf16_f32 v136, v96, v97
  v_smfmac_f32_16x16x64_bf16 v[100:103], v[76:79], a[136:143], v22
  v_cvt_pk_bf16_f32 v137, v98, v99
  v_smfmac_f32_16x16x64_bf16 v[100:103], v[80:83], a[144:151], v22
  v_smfmac_f32_16x16x64_bf16 v[100:103], v[84:87], a[152:159], v22
  s_waitcnt vmcnt(2)
  v_pk_add_f16 v172, v124, v126
  v_pk_add_f16 v173, v125, v127
  s_waitcnt vmcnt(1)
  v_pk_add_f16 v174, v128, v130
  v_pk_add_f16 v175, v129, v131
  v_fma_mix_f32 v166, v172, 1.0, v174 op_sel:[0,0,0] op_sel_hi:[1,0,1]
  v_fma_mix_f32 v168, v173, 1.0, v175 op_sel:[0,0,0] op_sel_hi:[1,0,1]
  s_waitcnt vmcnt(0)
  v_pk_add_f16 v176, v132, v133
  v_pk_add_f16 v177, v134, v135
  v_fma_mix_f32 v170, v176, 1.0, v177 op_sel:[0,0,0] op_sel_hi:[1,0,1]
  v_fma_mix_f32 v167, v172, 1.0, v174 op_sel:[1,0,1] op_sel_hi:[1,0,1]
  v_cmp_u_f32 vcc, v166, v170
  v_fma_mix_f32 v169, v173, 1.0, v175 op_sel:[1,0,1] op_sel_hi:[1,0,1]
  v_fma_mix_f32 v171, v176, 1.0, v177 op_sel:[1,0,1] op_sel_hi:[1,0,1]
  v_cvt_pk_bf16_f32 v138, v100, v101
  s_cbranch_vccnz sr_60
sj_61:
ex_62:
  v_exp_f32 v172, v166
  v_exp_f32 v173, v167
  v_exp_f32 v174, v168
  v_cvt_pk_bf16_f32 v156, v172, v173
  v_exp_f32 v175, v169
  v_exp_f32 v176, v170
  v_cvt_pk_bf16_f32 v157, v174, v175
  v_mov_b32_dpp v158, v156 row_ror:8 row_mask:0xf bank_mask:0xf
  v_exp_f32 v177, v171
  v_mov_b32_dpp v159, v157 row_ror:8 row_mask:0xf bank_mask:0xf
  v_cvt_pk_bf16_f32 v160, v176, v177
  v_cvt_pk_bf16_f32 v139, v102, v103
  v_mfma_f32_16x16x32_bf16 v[178:181], v[152:155], v[156:159], 0
  s_waitcnt lgkmcnt(0)
  v_mov_b32_dpp v161, v160 row_ror:8 row_mask:0xf bank_mask:0xf
  v_mfma_f32_16x16x32_bf16 v[182:185], v[144:147], v[156:159], 0
  s_nop 0
  v_mfma_f32_16x16x32_bf16 v[178:181], v[140:143], v[160:163], v[178:181]
  v_mfma_f32_16x16x32_bf16 v[182:185], v[136:139], v[160:163], v[182:185]
  v_mfma_f32_16x16x32_bf16 v[186:189], v[148:151], v[156:159], 0
  v_mfma_f32_16x16x32_bf16 v[186:189], v[138:141], v[160:163], v[186:189]
  s_mov_b64 exec, s[62:63]
  v_rcp_f32 v164, v180
  s_nop 0
  v_pk_mul_f32 v[178:179], v[178:179], v[164:165] op_sel_hi:[1,0]
  v_pk_mul_f32 v[182:183], v[182:183], v[164:165] op_sel_hi:[1,0]
  v_pk_mul_f32 v[184:185], v[184:185], v[164:165] op_sel_hi:[1,0]
  v_cvt_pk_f16_f32 v64, v178, v179
  v_cvt_pk_f16_f32 v60, v182, v183
  v_pk_mul_f32 v[186:187], v[186:187], v[164:165] op_sel_hi:[1,0]
  v_pk_mul_f32 v[188:189], v[188:189], v[164:165] op_sel_hi:[1,0]
  v_cvt_pk_f16_f32 v61, v184, v185
  v_cvt_pk_f16_f32 v62, v186, v187
  v_cvt_pk_f16_f32 v63, v188, v189
  ds_write_b128 v13, v[60:63]
  ds_write_b32 v14, v64
  v_add_f32 v165, v164, v180
  v_cmp_ngt_f32 vcc, s80, v165
  s_mov_b64 exec, -1
  s_nop 0
  s_cbranch_vccnz fx_63
fk_64:
  s_waitcnt lgkmcnt(0)
  s_barrier
  s_add_u32 m0, s74, 2048
  s_add_u32 s21, s79, 65536
  buffer_load_dwordx4 v4, s[16:19], s21 offen offset:1024 sc1 lds
  s_add_u32 m0, s74, 6144
  s_add_u32 s21, s79, 196608
  buffer_load_dwordx4 v4, s[16:19], s21 offen offset:0 sc1 lds
  s_xor_b32 s74, s74, 16384
  s_add_u32 s73, s73, 2097152
  s_xor_b32 s73, s73, 8192
  s_add_u32 s79, s79, 2097152
  s_xor_b32 s79, s79, 8192
  s_add_u32 s21, s72, 524288
  s_xor_b32 s72, s72, s21
  s_lshr_b32 s72, s72, 8
  s_and_b32 s72, s72, 8192
  s_xor_b32 s72, s72, s21
  s_nop 15
  s_nop 3
  v_permlane32_swap_b32 v96, v100
  v_permlane32_swap_b32 v97, v101
  v_permlane32_swap_b32 v98, v102
  v_permlane32_swap_b32 v99, v103
  v_pk_add_f32 v[96:97], v[96:97], v[100:101]
  v_pk_add_f32 v[98:99], v[98:99], v[102:103]
  v_cvt_pk_bf16_f32 v182, v96, v97
  v_cvt_pk_bf16_f32 v183, v98, v99
  v_min_u32 v182, -2, v182
  ds_write_b64 v26, v[182:183]
  ds_read_b128 v[144:147], v18
  ds_read_b128 v[148:151], v18 offset:1024
  ds_read_b128 v[152:155], v19
  ds_read_b128 v[112:115], v20
  ds_read_b64 v[116:117], v21
  v_xor_b32 v18, 16384, v18
  v_xor_b32 v19, 16384, v19
  v_xor_b32 v20, 16384, v20
  v_xor_b32 v21, 16384, v21
  v_mov_b32 v88, 0
  v_mov_b32 v89, 0
  v_mov_b32 v90, 0
  v_mov_b32 v91, 0
  v_mov_b32 v92, 0
  v_mov_b32 v93, 0
  v_mov_b32 v94, 0
  v_mov_b32 v95, 0
  v_mov_b32 v96, 0
  v_mov_b32 v97, 0
  v_mov_b32 v98, 0
  v_mov_b32 v99, 0
  v_mov_b32 v100, 0
  v_mov_b32 v101, 0
  v_mov_b32 v102, 0
  v_mov_b32 v103, 0
  s_mov_b32 s81, 0
  s_waitcnt lgkmcnt(0)
  s_barrier
  s_mov_b64 exec, s[64:65]
  buffer_store_dwordx2 v[28:29], v8, s[8:11], s57 offen
  s_mov_b64 exec, s[62:63]
  buffer_store_dword v28, v17, s[8:11], s59 offen
  s_mov_b64 exec, -1
  s_sleep 6
  s_nop 3
  buffer_load_dwordx4 v[68:71], v16, s[4:7], s60 offen sc1
  s_sleep 3
  s_nop 1
  buffer_load_dwordx4 v[72:75], v16, s[4:7], s60 offen sc1
  s_waitcnt vmcnt(1)
  v_mfma_f32_16x16x32_f16 v[120:123], v[44:47], v[68:71], 0
  v_bitop3_b32 v27, v68, s61, 1 bitop3:0x28
  v_cmp_ne_u32 vcc, 0, v27
  s_nop 1
  s_cbranch_vccnz p2_69
  s_nop 2
pg_68:
  v_add_f32_dpp v120, v120, v120 row_ror:8 row_mask:0xf bank_mask:0xf
  v_add_f32_dpp v121, v121, v121 row_ror:8 row_mask:0xf bank_mask:0xf
  s_mov_b64 exec, s[62:63]
  v_cvt_pk_bf16_f32 v120, v120, v121
  v_min_u32 v120, -2, v120
  buffer_store_dword v120, v17, s[8:11], s55 offen
  s_mov_b64 exec, -1
nt_65:
  s_barrier
  s_mov_b32 s58, s55
  s_add_u32 s52, s52, 1
  s_and_b32 s21, s52, 3
  s_mul_i32 s56, s21, 122880
  s_add_u32 s21, s52, 1
  s_and_b32 s21, s21, 3
  s_mul_i32 s55, s21, 122880
  s_add_u32 s55, s55, s75
  s_add_u32 s21, s52, 2
  s_and_b32 s21, s21, 3
  s_mul_i32 s57, s21, 122880
  s_add_u32 s21, s52, 3
  s_and_b32 s21, s21, 3
  s_mul_i32 s59, s21, 122880
  s_add_u32 s59, s59, s75
  s_bfe_u32 s61, s52, 0x10002
  s_and_b32 s21, s52, 3
  s_lshl_b32 s60, s21, 18
  s_mov_b32 s54, 0
  s_sleep 3
  s_nop 2
  buffer_load_dwordx4 v[60:63], v190, s[8:11], s58 offen offset:0 sc1
  buffer_load_dwordx4 v[64:67], v190, s[8:11], s58 offen offset:1024 sc1
  buffer_load_dwordx4 v[68:71], v190, s[8:11], s58 offen offset:2048 sc1
  s_branch top_54
mr_55:
  s_mov_b64 exec, s[22:23]
  s_cbranch_execz ms_70
  buffer_load_dwordx4 v[60:63], v190, s[8:11], s58 offen offset:0 sc1
ms_70:
  s_mov_b64 exec, s[98:99]
  s_cbranch_execz ms_71
  buffer_load_dwordx4 v[64:67], v190, s[8:11], s58 offen offset:1024 sc1
ms_71:
  s_mov_b64 exec, s[100:101]
  s_cbranch_execz ms_72
  buffer_load_dwordx4 v[68:71], v190, s[8:11], s58 offen offset:2048 sc1
ms_72:
  s_add_u32 s54, s54, 1
  s_cmp_gt_u32 s54, 131072
  s_cbranch_scc1 end0
  s_waitcnt vmcnt(0)
  s_mov_b64 exec, s[22:23]
  ds_write_b128 v190, v[60:63] offset:0
  v_cmp_eq_u32 s[22:23], -1, v60
  s_mov_b64 exec, s[98:99]
  ds_write_b128 v190, v[64:67] offset:1024
  v_cmp_eq_u32 s[98:99], -1, v64
  s_mov_b64 exec, s[100:101]
  ds_write_b128 v190, v[68:71] offset:2048
  v_cmp_eq_u32 s[100:101], -1, v68
  s_mov_b64 exec, -1
  s_or_b64 vcc, s[22:23], s[98:99]
  s_or_b64 vcc, vcc, s[100:101]
  s_cbranch_scc1 mr_55
  s_branch mo_59
mn_56:
  v_max3_u32 v27, v48, v49, v50
  v_max3_u32 v27, v27, v51, v52
  v_max3_u32 v27, v27, v53, v54
  v_max3_u32 v27, v27, v55, v56
  v_max3_u32 v27, v27, v57, v58
  v_max3_u32 v27, v27, v59, v60
  v_max3_u32 v27, v27, v61, v62
  v_max3_u32 v27, v27, v63, v64
  v_max3_u32 v27, v27, v65, v66
  v_max3_u32 v27, v27, v67, v68
  v_max3_u32 v27, v27, v69, v70
  v_max3_u32 v27, v27, v71, v72
  v_max3_u32 v27, v27, v73, v74
  v_max3_u32 v27, v27, v75, v76
  v_max3_u32 v27, v27, v77, v78
  v_max3_u32 v27, v27, v79, v80
  v_max3_u32 v27, v27, v81, v82
  v_max3_u32 v27, v27, v83, v84
  v_max3_u32 v27, v27, v85, v86
  v_max3_u32 v27, v27, v87, v87
  v_cmp_eq_u32 vcc, -1, v27
  s_cmp_eq_u32 s52, 0
  s_cbranch_scc1 mk_57
  s_cbranch_vccz mk_57
  s_waitcnt lgkmcnt(0)
  s_barrier
  s_nop 7
  v_mov_b32 v88, 0
  v_mov_b32 v89, 0
  v_mov_b32 v90, 0
  v_mov_b32 v91, 0
  v_mov_b32 v92, 0
  v_mov_b32 v93, 0
  v_mov_b32 v94, 0
  v_mov_b32 v95, 0
  v_mov_b32 v96, 0
  v_mov_b32 v97, 0
  v_mov_b32 v98, 0
  v_mov_b32 v99, 0
  v_mov_b32 v100, 0
  v_mov_b32 v101, 0
  v_mov_b32 v102, 0
  v_mov_b32 v103, 0
  s_mov_b64 s[22:23], -1
  s_mov_b64 s[98:99], -1
  s_mov_b64 s[100:101], -1
  s_branch mr_55
sr_60:
  s_mov_b32 s54, 0
sr_73:
  s_mov_b64 exec, vcc
  buffer_load_dwordx4 v[124:127], v9, s[8:11], s56 offen sc1
  buffer_load_dwordx4 v[128:131], v9, s[8:11], s56 offen offset:1024 sc1
  buffer_load_dwordx4 v[132:135], v10, s[8:11], s56 offen sc1
  s_mov_b64 exec, -1
  s_add_u32 s54, s54, 1
  s_cmp_gt_u32 s54, 131072
  s_cbranch_scc1 end0
  s_and_b32 s21, s54, 31
  s_cbranch_scc0 sr_74
  s_waitcnt vmcnt(0)
  v_pk_add_f16 v172, v124, v126
  v_pk_add_f16 v173, v125, v127
  v_pk_add_f16 v174, v128, v130
  v_pk_add_f16 v175, v129, v131
  v_fma_mix_f32 v166, v172, 1.0, v174 op_sel:[0,0,0] op_sel_hi:[1,0,1]
  v_fma_mix_f32 v168, v173, 1.0, v175 op_sel:[0,0,0] op_sel_hi:[1,0,1]
  v_pk_add_f16 v176, v132, v133
  v_pk_add_f16 v177, v134, v135
  v_add_f32 v27, v166, v168
  v_fma_mix_f32 v170, v176, 1.0, v177 op_sel:[0,0,0] op_sel_hi:[1,0,1]
  v_fma_mix_f32 v167, v172, 1.0, v174 op_sel:[1,0,1] op_sel_hi:[1,0,1]
  v_cmp_u_f32 vcc, v27, v170
  v_fma_mix_f32 v169, v173, 1.0, v175 op_sel:[1,0,1] op_sel_hi:[1,0,1]
  v_fma_mix_f32 v171, v176, 1.0, v177 op_sel:[1,0,1] op_sel_hi:[1,0,1]
  s_cbranch_vccnz sr_73
  s_branch sj_61
sr_74:
  s_waitcnt vmcnt(0)
  v_pk_add_f16 v172, v124, v126
  v_pk_add_f16 v173, v125, v127
  v_pk_add_f16 v174, v128, v130
  v_pk_add_f16 v175, v129, v131
  v_fma_mix_f32 v166, v172, 1.0, v174 op_sel:[0,0,0] op_sel_hi:[1,0,1]
  v_fma_mix_f32 v168, v173, 1.0, v175 op_sel:[0,0,0] op_sel_hi:[1,0,1]
  v_pk_add_f16 v176, v132, v133
  v_pk_add_f16 v177, v134, v135
  v_add_f32 v27, v166, v168
  v_fma_mix_f32 v170, v176, 1.0, v177 op_sel:[0,0,0] op_sel_hi:[1,0,1]
  v_fma_mix_f32 v167, v172, 1.0, v174 op_sel:[1,0,1] op_sel_hi:[1,0,1]
  v_cmp_u_f32 vcc, v27, v170
  v_fma_mix_f32 v169, v173, 1.0, v175 op_sel:[1,0,1] op_sel_hi:[1,0,1]
  v_fma_mix_f32 v171, v176, 1.0, v177 op_sel:[1,0,1] op_sel_hi:[1,0,1]
  v_max3_u32 v27, v124, v126, v128
  v_max3_u32 v27, v27, v130, v132
  v_max3_u32 v27, v27, v133, v134
  v_max3_u32 v27, v27, v135, v135
  v_cmp_eq_u32 vcc, -1, v27
  s_nop 1
  s_cbranch_vccnz sr_73
  s_branch sj_61
fx_63:
  s_cmp_eq_u32 s81, 1
  s_cbranch_scc1 fk_64
  s_mov_b32 s81, 1
  v_max3_f32 v164, v166, v167, v168
  v_max3_f32 v165, v169, v170, v171
  v_max_f32 v164, v164, v165
  s_nop 1
  v_max_f32_dpp v164, v164, v164 row_ror:8 row_mask:0xf bank_mask:0xf
  v_mov_b32 v165, v164
  s_nop 1
  v_permlane32_swap_b32 v164, v165
  v_max_f32 v164, v164, v165
  v_mov_b32 v165, v164
  s_nop 1
  v_permlane16_swap_b32 v164, v165
  v_max_f32 v164, v164, v165
  v_sub_f32 v166, v166, v164
  v_sub_f32 v167, v167, v164
  v_sub_f32 v168, v168, v164
  v_sub_f32 v169, v169, v164
  v_sub_f32 v170, v170, v164
  v_sub_f32 v171, v171, v164
  s_branch ex_62
p2_69:
  s_mov_b32 s54, 0
  buffer_load_dwordx4 v[68:71], v16, s[4:7], s60 offen sc1
  s_waitcnt vmcnt(1)
  v_mfma_f32_16x16x32_f16 v[120:123], v[44:47], v[72:75], 0
  v_bitop3_b32 v27, v72, s61, 1 bitop3:0x28
  v_cmp_ne_u32 vcc, 0, v27
  s_nop 1
  s_cbranch_vccz pg_68
  buffer_load_dwordx4 v[72:75], v16, s[4:7], s60 offen sc1
pp_67:
  s_waitcnt vmcnt(1)
  v_mfma_f32_16x16x32_f16 v[120:123], v[44:47], v[68:71], 0
  v_bitop3_b32 v27, v68, s61, 1 bitop3:0x28
  v_cmp_ne_u32 vcc, 0, v27
  s_nop 1
  s_cbranch_vccz pg_68
  buffer_load_dwordx4 v[68:71], v16, s[4:7], s60 offen sc1
  s_waitcnt vmcnt(1)
  v_mfma_f32_16x16x32_f16 v[120:123], v[44:47], v[72:75], 0
  v_bitop3_b32 v27, v72, s61, 1 bitop3:0x28
  v_cmp_ne_u32 vcc, 0, v27
  s_nop 1
  s_cbranch_vccz pg_68
  buffer_load_dwordx4 v[72:75], v16, s[4:7], s60 offen sc1
  s_add_u32 s54, s54, 1
  s_cmp_gt_u32 s54, 131072
  s_cbranch_scc1 end0
  s_branch pp_67
last_58:
  v_smfmac_f32_16x16x64_bf16 v[96:99], v[48:51], a[0:7], v22
  v_smfmac_f32_16x16x64_bf16 v[100:103], v[48:51], a[80:87], v22
  v_smfmac_f32_16x16x64_bf16 v[96:99], v[52:55], a[8:15], v22
  v_smfmac_f32_16x16x64_bf16 v[100:103], v[52:55], a[88:95], v22
  v_smfmac_f32_16x16x64_bf16 v[96:99], v[56:59], a[16:23], v22
  v_smfmac_f32_16x16x64_bf16 v[100:103], v[56:59], a[96:103], v22
  v_smfmac_f32_16x16x64_bf16 v[96:99], v[60:63], a[24:31], v22
  v_smfmac_f32_16x16x64_bf16 v[96:99], v[64:67], a[32:39], v22
  v_smfmac_f32_16x16x64_bf16 v[96:99], v[68:71], a[40:47], v22
  v_smfmac_f32_16x16x64_bf16 v[96:99], v[72:75], a[48:55], v22
  v_smfmac_f32_16x16x64_bf16 v[96:99], v[76:79], a[56:63], v22
  v_smfmac_f32_16x16x64_bf16 v[96:99], v[80:83], a[64:71], v22
  v_smfmac_f32_16x16x64_bf16 v[96:99], v[84:87], a[72:79], v22
  v_smfmac_f32_16x16x64_bf16 v[100:103], v[60:63], a[104:111], v22
  v_smfmac_f32_16x16x64_bf16 v[100:103], v[64:67], a[112:119], v22
  v_smfmac_f32_16x16x64_bf16 v[100:103], v[68:71], a[120:127], v22
  v_smfmac_f32_16x16x64_bf16 v[100:103], v[72:75], a[128:135], v22
  v_smfmac_f32_16x16x64_bf16 v[100:103], v[76:79], a[136:143], v22
  v_smfmac_f32_16x16x64_bf16 v[100:103], v[80:83], a[144:151], v22
  v_smfmac_f32_16x16x64_bf16 v[100:103], v[84:87], a[152:159], v22
  s_nop 7
  v_permlane32_swap_b32 v96, v100
  v_permlane32_swap_b32 v97, v101
  v_permlane32_swap_b32 v98, v102
  v_permlane32_swap_b32 v99, v103
  v_pk_add_f32 v[96:97], v[96:97], v[100:101]
  v_pk_add_f32 v[98:99], v[98:99], v[102:103]
  v_cvt_pk_bf16_f32 v182, v96, v97
  v_cvt_pk_bf16_f32 v183, v98, v99
  v_min_u32 v182, -2, v182
  ds_write_b64 v26, v[182:183]
  s_waitcnt lgkmcnt(0)
  s_barrier
  s_branch chain_done
E_30:
  v_add_u32 v190, 6144, v4
  s_waitcnt vmcnt(0)
  ds_write_b128 v190, v[72:75] offset:0
  ds_write_b128 v190, v[76:79] offset:1024
  ds_write_b128 v190, v[80:83] offset:2048
  s_add_u32 m0, s74, 4096
  s_add_u32 s21, s79, 131072
  buffer_load_dwordx4 v4, s[16:19], s21 offen offset:0 sc1 lds
  s_add_u32 m0, s74, 6144
  s_add_u32 s21, s79, 196608
  buffer_load_dwordx4 v4, s[16:19], s21 offen offset:1024 sc1 lds
  s_xor_b32 s74, s74, 16384
  s_add_u32 s73, s73, 2097152
  s_xor_b32 s73, s73, 8192
  s_add_u32 s79, s79, 2097152
  s_xor_b32 s79, s79, 8192
  s_add_u32 s21, s72, 524288
  s_xor_b32 s72, s72, s21
  s_lshr_b32 s72, s72, 8
  s_and_b32 s72, s72, 8192
  s_xor_b32 s72, s72, s21
  s_branch mo_80
  .p2align 3
top_75:
  s_waitcnt vmcnt(2)
  ds_write_b128 v190, v[72:75] offset:0
  v_cmp_eq_u32 s[22:23], -1, v72
  s_waitcnt vmcnt(1)
  ds_write_b128 v190, v[76:79] offset:1024
  v_cmp_eq_u32 s[98:99], -1, v76
  s_waitcnt vmcnt(0)
  ds_write_b128 v190, v[80:83] offset:2048
  v_cmp_eq_u32 s[100:101], -1, v80
  s_or_b64 vcc, s[22:23], s[98:99]
  s_or_b64 vcc, vcc, s[100:101]
  s_cbranch_scc1 mr_76
mo_80:
  s_waitcnt lgkmcnt(0)
  s_barrier
  ds_read_b128 v[48:51], v4 offset:0
  ds_read_b128 v[52:55], v4 offset:1024
  v_smfmac_f32_16x16x64_bf16 v[92:95], v[72:75], v[224:231], v22
  ds_read_b128 v[56:59], v4 offset:2048
  v_smfmac_f32_16x16x64_bf16 v[88:91], v[72:75], a[208:215], v22
  ds_read_b128 v[60:63], v4 offset:3072
  v_smfmac_f32_16x16x64_bf16 v[92:95], v[76:79], v[232:239], v22
  ds_read_b128 v[64:67], v4 offset:4096
  v_smfmac_f32_16x16x64_bf16 v[88:91], v[76:79], a[216:223], v22
  ds_read_b128 v[68:71], v4 offset:5120
  v_smfmac_f32_16x16x64_bf16 v[92:95], v[80:83], v[240:247], v22
  ds_read_b128 v[84:87], v4 offset:9216
  v_smfmac_f32_16x16x64_bf16 v[88:91], v[80:83], a[224:231], v22
  s_waitcnt lgkmcnt(6)
  v_smfmac_f32_16x16x64_bf16 v[92:95], v[48:51], a[240:247], v22
  v_smfmac_f32_16x16x64_bf16 v[88:91], v[48:51], a[160:167], v22
  s_waitcnt lgkmcnt(5)
  v_smfmac_f32_16x16x64_bf16 v[92:95], v[52:55], a[248:255], v22
  s_waitcnt lgkmcnt(4)
  v_smfmac_f32_16x16x64_bf16 v[92:95], v[56:59], v[192:199], v22
  s_waitcnt lgkmcnt(3)
  v_smfmac_f32_16x16x64_bf16 v[92:95], v[60:63], v[200:207], v22
  s_waitcnt lgkmcnt(2)
  v_smfmac_f32_16x16x64_bf16 v[92:95], v[64:67], v[208:215], v22
  s_waitcnt lgkmcnt(1)
  v_smfmac_f32_16x16x64_bf16 v[92:95], v[68:71], v[216:223], v22
  s_waitcnt lgkmcnt(0)
  v_smfmac_f32_16x16x64_bf16 v[92:95], v[84:87], v[248:255], v22
  v_smfmac_f32_16x16x64_bf16 v[88:91], v[52:55], a[168:175], v22
  v_smfmac_f32_16x16x64_bf16 v[88:91], v[56:59], a[176:183], v22
  v_smfmac_f32_16x16x64_bf16 v[88:91], v[60:63], a[184:191], v22
  v_permlane32_swap_b32 v92, v93
  v_smfmac_f32_16x16x64_bf16 v[88:91], v[64:67], a[192:199], v22
  v_permlane32_swap_b32 v94, v95
  v_smfmac_f32_16x16x64_bf16 v[88:91], v[68:71], a[200:207], v22
  v_permlane32_swap_b32 v93, v92
  v_smfmac_f32_16x16x64_bf16 v[88:91], v[84:87], a[232:239], v22
  v_permlane32_swap_b32 v95, v94
  v_pk_mul_f32 v[120:121], v[92:93], v[24:25] op_sel:[1,0] op_sel_hi:[0,1]
  v_pk_mul_f32 v[122:123], v[94:95], v[24:25] op_sel:[1,0] op_sel_hi:[0,1]
  s_nop 4
  v_pk_fma_f32 v[88:89], v[88:89], v[24:25], v[120:121]
  v_pk_fma_f32 v[90:91], v[90:91], v[24:25], v[122:123]
  v_cvt_pk_bf16_f32 v120, v88, v89
  v_cvt_pk_bf16_f32 v121, v90, v91
  ds_write_b64 v6, v[120:121]
  v_cmp_u_f32 vcc, v88, v89
  v_cmp_u_f32 s[22:23], v90, v91
  s_nop 1
  s_or_b64 vcc, vcc, s[22:23]
  s_cbranch_vccnz mn_77
mk_78:
  s_waitcnt lgkmcnt(0)
  s_barrier
  ds_read_b64_tr_b16 v[104:105], v7 offset:0
  ds_read_b64_tr_b16 v[106:107], v7 offset:768
  ds_read_b64_tr_b16 v[108:109], v7 offset:1536
  ds_read_b64 v[140:141], v11
  s_cmp_eq_u32 s52, 63
  s_cbranch_scc1 last_79
  s_waitcnt lgkmcnt(2)
  v_mfma_f32_16x16x32_bf16 v[120:123], v[104:107], v[104:107], 0
  s_waitcnt lgkmcnt(1)
  v_mfma_f32_16x16x32_bf16 v[120:123], v[108:111], v[108:111], v[120:123]
  s_mov_b64 exec, s[64:65]
  s_nop 6
  v_cvt_pk_f16_f32 v120, v120, v121
  buffer_store_dword v120, v8, s[8:11], s56 offen
  v_cvt_pk_f16_f32 v121, v122, v123
  buffer_store_dword v121, v8, s[8:11], s56 offen offset:128
  s_mov_b64 exec, -1
  s_sleep 3
  s_nop 1
  v_smfmac_f32_16x16x64_bf16 v[96:99], v[48:51], a[0:7], v22
  v_smfmac_f32_16x16x64_bf16 v[100:103], v[48:51], a[80:87], v22
  v_smfmac_f32_16x16x64_bf16 v[96:99], v[52:55], a[8:15], v22
  v_smfmac_f32_16x16x64_bf16 v[100:103], v[52:55], a[88:95], v22
  v_smfmac_f32_16x16x64_bf16 v[96:99], v[56:59], a[16:23], v22
  v_smfmac_f32_16x16x64_bf16 v[100:103], v[56:59], a[96:103], v22
  v_smfmac_f32_16x16x64_bf16 v[96:99], v[60:63], a[24:31], v22
  v_smfmac_f32_16x16x64_bf16 v[96:99], v[64:67], a[32:39], v22
  v_smfmac_f32_16x16x64_bf16 v[96:99], v[68:71], a[40:47], v22
  v_smfmac_f32_16x16x64_bf16 v[96:99], v[72:75], a[48:55], v22
  v_smfmac_f32_16x16x64_bf16 v[96:99], v[76:79], a[56:63], v22
  buffer_load_dwordx4 v[124:127], v9, s[8:11], s56 offen sc1
  v_smfmac_f32_16x16x64_bf16 v[96:99], v[80:83], a[64:71], v22
  buffer_load_dwordx4 v[128:131], v9, s[8:11], s56 offen offset:1024 sc1
  v_smfmac_f32_16x16x64_bf16 v[96:99], v[84:87], a[72:79], v22
  buffer_load_dwordx4 v[132:135], v10, s[8:11], s56 offen sc1
  v_smfmac_f32_16x16x64_bf16 v[100:103], v[60:63], a[104:111], v22
  v_smfmac_f32_16x16x64_bf16 v[100:103], v[64:67], a[112:119], v22
  v_smfmac_f32_16x16x64_bf16 v[100:103], v[68:71], a[120:127], v22
  v_smfmac_f32_16x16x64_bf16 v[100:103], v[72:75], a[128:135], v22
  v_cvt_pk_bf16_f32 v136, v96, v97
  v_smfmac_f32_16x16x64_bf16 v[100:103], v[76:79], a[136:143], v22
  v_cvt_pk_bf16_f32 v137, v98, v99
  v_smfmac_f32_16x16x64_bf16 v[100:103], v[80:83], a[144:151], v22
  v_smfmac_f32_16x16x64_bf16 v[100:103], v[84:87], a[152:159], v22
  s_waitcnt vmcnt(2)
  v_pk_add_f16 v172, v124, v126
  v_pk_add_f16 v173, v125, v127
  s_waitcnt vmcnt(1)
  v_pk_add_f16 v174, v128, v130
  v_pk_add_f16 v175, v129, v131
  v_fma_mix_f32 v166, v172, 1.0, v174 op_sel:[0,0,0] op_sel_hi:[1,0,1]
  v_fma_mix_f32 v168, v173, 1.0, v175 op_sel:[0,0,0] op_sel_hi:[1,0,1]
  s_waitcnt vmcnt(0)
  v_pk_add_f16 v176, v132, v133
  v_pk_add_f16 v177, v134, v135
  v_fma_mix_f32 v170, v176, 1.0, v177 op_sel:[0,0,0] op_sel_hi:[1,0,1]
  v_fma_mix_f32 v167, v172, 1.0, v174 op_sel:[1,0,1] op_sel_hi:[1,0,1]
  v_cmp_u_f32 vcc, v166, v170
  v_fma_mix_f32 v169, v173, 1.0, v175 op_sel:[1,0,1] op_sel_hi:[1,0,1]
  v_fma_mix_f32 v171, v176, 1.0, v177 op_sel:[1,0,1] op_sel_hi:[1,0,1]
  v_cvt_pk_bf16_f32 v138, v100, v101
  s_cbranch_vccnz sr_81
sj_82:
ex_83:
  v_exp_f32 v172, v166
  v_exp_f32 v173, v167
  v_exp_f32 v174, v168
  v_cvt_pk_bf16_f32 v156, v172, v173
  v_exp_f32 v175, v169
  v_exp_f32 v176, v170
  v_cvt_pk_bf16_f32 v157, v174, v175
  v_mov_b32_dpp v158, v156 row_ror:8 row_mask:0xf bank_mask:0xf
  v_exp_f32 v177, v171
  v_mov_b32_dpp v159, v157 row_ror:8 row_mask:0xf bank_mask:0xf
  v_cvt_pk_bf16_f32 v160, v176, v177
  v_cvt_pk_bf16_f32 v139, v102, v103
  v_mfma_f32_16x16x32_bf16 v[178:181], v[152:155], v[156:159], 0
  s_waitcnt lgkmcnt(0)
  v_mov_b32_dpp v161, v160 row_ror:8 row_mask:0xf bank_mask:0xf
  v_mfma_f32_16x16x32_bf16 v[182:185], v[144:147], v[156:159], 0
  s_nop 0
  v_mfma_f32_16x16x32_bf16 v[178:181], v[140:143], v[160:163], v[178:181]
  v_mfma_f32_16x16x32_bf16 v[182:185], v[136:139], v[160:163], v[182:185]
  v_mfma_f32_16x16x32_bf16 v[186:189], v[148:151], v[156:159], 0
  v_mfma_f32_16x16x32_bf16 v[186:189], v[138:141], v[160:163], v[186:189]
  s_mov_b64 exec, s[62:63]
  v_rcp_f32 v164, v180
  s_nop 0
  v_pk_mul_f32 v[178:179], v[178:179], v[164:165] op_sel_hi:[1,0]
  v_pk_mul_f32 v[182:183], v[182:183], v[164:165] op_sel_hi:[1,0]
  v_pk_mul_f32 v[184:185], v[184:185], v[164:165] op_sel_hi:[1,0]
  v_cvt_pk_f16_f32 v64, v178, v179
  v_cvt_pk_f16_f32 v60, v182, v183
  v_pk_mul_f32 v[186:187], v[186:187], v[164:165] op_sel_hi:[1,0]
  v_pk_mul_f32 v[188:189], v[188:189], v[164:165] op_sel_hi:[1,0]
  v_cvt_pk_f16_f32 v61, v184, v185
  v_cvt_pk_f16_f32 v62, v186, v187
  v_cvt_pk_f16_f32 v63, v188, v189
  ds_write_b128 v13, v[60:63]
  ds_write_b32 v14, v64
  v_add_f32 v165, v164, v180
  v_cmp_ngt_f32 vcc, s80, v165
  s_mov_b64 exec, -1
  s_nop 0
  s_cbranch_vccnz fx_84
fk_85:
  s_waitcnt lgkmcnt(0)
  s_barrier
  s_add_u32 m0, s74, 4096
  s_add_u32 s21, s79, 131072
  buffer_load_dwordx4 v4, s[16:19], s21 offen offset:0 sc1 lds
  s_add_u32 m0, s74, 6144
  s_add_u32 s21, s79, 196608
  buffer_load_dwordx4 v4, s[16:19], s21 offen offset:1024 sc1 lds
  s_xor_b32 s74, s74, 16384
  s_add_u32 s73, s73, 2097152
  s_xor_b32 s73, s73, 8192
  s_add_u32 s79, s79, 2097152
  s_xor_b32 s79, s79, 8192
  s_add_u32 s21, s72, 524288
  s_xor_b32 s72, s72, s21
  s_lshr_b32 s72, s72, 8
  s_and_b32 s72, s72, 8192
  s_xor_b32 s72, s72, s21
  s_nop 15
  s_nop 3
  v_permlane32_swap_b32 v96, v100
  v_permlane32_swap_b32 v97, v101
  v_permlane32_swap_b32 v98, v102
  v_permlane32_swap_b32 v99, v103
  v_pk_add_f32 v[96:97], v[96:97], v[100:101]
  v_pk_add_f32 v[98:99], v[98:99], v[102:103]
  v_cvt_pk_bf16_f32 v182, v96, v97
  v_cvt_pk_bf16_f32 v183, v98, v99
  v_min_u32 v182, -2, v182
  ds_write_b64 v26, v[182:183]
  ds_read_b128 v[144:147], v18
  ds_read_b128 v[148:151], v18 offset:1024
  ds_read_b128 v[152:155], v19
  v_xor_b32 v18, 16384, v18
  v_xor_b32 v19, 16384, v19
  v_mov_b32 v88, 0
  v_mov_b32 v89, 0
  v_mov_b32 v90, 0
  v_mov_b32 v91, 0
  v_mov_b32 v92, 0
  v_mov_b32 v93, 0
  v_mov_b32 v94, 0
  v_mov_b32 v95, 0
  v_mov_b32 v96, 0
  v_mov_b32 v97, 0
  v_mov_b32 v98, 0
  v_mov_b32 v99, 0
  v_mov_b32 v100, 0
  v_mov_b32 v101, 0
  v_mov_b32 v102, 0
  v_mov_b32 v103, 0
  s_mov_b32 s81, 0
  s_waitcnt lgkmcnt(0)
  s_barrier
  s_mov_b64 exec, s[64:65]
  buffer_store_dword v28, v8, s[8:11], s57 offen
  buffer_store_dword v28, v8, s[8:11], s57 offen offset:128
  s_mov_b64 exec, -1
  s_cmp_eq_u32 s78, 0
  s_cbranch_scc1 nt_87
  s_mov_b64 exec, s[62:63]
  buffer_store_dword v28, v17, s[8:11], s59 offen
  s_mov_b64 exec, -1
  s_sleep 6
  s_nop 3
  buffer_load_dwordx4 v[68:71], v16, s[4:7], s60 offen sc1
  s_sleep 3
  s_nop 1
  buffer_load_dwordx4 v[72:75], v16, s[4:7], s60 offen sc1
  s_waitcnt vmcnt(1)
  v_mfma_f32_16x16x32_f16 v[120:123], v[44:47], v[68:71], 0
  v_bitop3_b32 v27, v68, s61, 1 bitop3:0x28
  v_cmp_ne_u32 vcc, 0, v27
  s_nop 1
  s_cbranch_vccnz p2_90
  s_nop 2
pg_89:
  v_add_f32_dpp v120, v120, v120 row_ror:8 row_mask:0xf bank_mask:0xf
  v_add_f32_dpp v121, v121, v121 row_ror:8 row_mask:0xf bank_mask:0xf
  s_mov_b64 exec, s[62:63]
  v_cvt_pk_bf16_f32 v120, v120, v121
  v_min_u32 v120, -2, v120
  buffer_store_dword v120, v17, s[8:11], s55 offen
  s_mov_b64 exec, -1
nt_86:
  s_barrier
  s_mov_b32 s58, s55
  s_add_u32 s52, s52, 1
  s_and_b32 s21, s52, 3
  s_mul_i32 s56, s21, 122880
  s_add_u32 s21, s52, 1
  s_and_b32 s21, s21, 3
  s_mul_i32 s55, s21, 122880
  s_add_u32 s55, s55, s75
  s_add_u32 s21, s52, 2
  s_and_b32 s21, s21, 3
  s_mul_i32 s57, s21, 122880
  s_add_u32 s21, s52, 3
  s_and_b32 s21, s21, 3
  s_mul_i32 s59, s21, 122880
  s_add_u32 s59, s59, s75
  s_bfe_u32 s61, s52, 0x10002
  s_and_b32 s21, s52, 3
  s_lshl_b32 s60, s21, 18
  s_mov_b32 s54, 0
  s_sleep 3
  s_nop 2
  buffer_load_dwordx4 v[72:75], v190, s[8:11], s58 offen offset:0 sc1
  buffer_load_dwordx4 v[76:79], v190, s[8:11], s58 offen offset:1024 sc1
  buffer_load_dwordx4 v[80:83], v190, s[8:11], s58 offen offset:2048 sc1
  s_branch top_75
mr_76:
  s_mov_b64 exec, s[22:23]
  s_cbranch_execz ms_91
  buffer_load_dwordx4 v[72:75], v190, s[8:11], s58 offen offset:0 sc1
ms_91:
  s_mov_b64 exec, s[98:99]
  s_cbranch_execz ms_92
  buffer_load_dwordx4 v[76:79], v190, s[8:11], s58 offen offset:1024 sc1
ms_92:
  s_mov_b64 exec, s[100:101]
  s_cbranch_execz ms_93
  buffer_load_dwordx4 v[80:83], v190, s[8:11], s58 offen offset:2048 sc1
ms_93:
  s_add_u32 s54, s54, 1
  s_cmp_gt_u32 s54, 131072
  s_cbranch_scc1 end0
  s_waitcnt vmcnt(0)
  s_mov_b64 exec, s[22:23]
  ds_write_b128 v190, v[72:75] offset:0
  v_cmp_eq_u32 s[22:23], -1, v72
  s_mov_b64 exec, s[98:99]
  ds_write_b128 v190, v[76:79] offset:1024
  v_cmp_eq_u32 s[98:99], -1, v76
  s_mov_b64 exec, s[100:101]
  ds_write_b128 v190, v[80:83] offset:2048
  v_cmp_eq_u32 s[100:101], -1, v80
  s_mov_b64 exec, -1
  s_or_b64 vcc, s[22:23], s[98:99]
  s_or_b64 vcc, vcc, s[100:101]
  s_cbranch_scc1 mr_76
  s_branch mo_80
mn_77:
  v_max3_u32 v27, v48, v49, v50
  v_max3_u32 v27, v27, v51, v52
  v_max3_u32 v27, v27, v53, v54
  v_max3_u32 v27, v27, v55, v56
  v_max3_u32 v27, v27, v57, v58
  v_max3_u32 v27, v27, v59, v60
  v_max3_u32 v27, v27, v61, v62
  v_max3_u32 v27, v27, v63, v64
  v_max3_u32 v27, v27, v65, v66
  v_max3_u32 v27, v27, v67, v68
  v_max3_u32 v27, v27, v69, v70
  v_max3_u32 v27, v27, v71, v72
  v_max3_u32 v27, v27, v73, v74
  v_max3_u32 v27, v27, v75, v76
  v_max3_u32 v27, v27, v77, v78
  v_max3_u32 v27, v27, v79, v80
  v_max3_u32 v27, v27, v81, v82
  v_max3_u32 v27, v27, v83, v84
  v_max3_u32 v27, v27, v85, v86
  v_max3_u32 v27, v27, v87, v87
  v_cmp_eq_u32 vcc, -1, v27
  s_cmp_eq_u32 s52, 0
  s_cbranch_scc1 mk_78
  s_cbranch_vccz mk_78
  s_waitcnt lgkmcnt(0)
  s_barrier
  s_nop 7
  v_mov_b32 v88, 0
  v_mov_b32 v89, 0
  v_mov_b32 v90, 0
  v_mov_b32 v91, 0
  v_mov_b32 v92, 0
  v_mov_b32 v93, 0
  v_mov_b32 v94, 0
  v_mov_b32 v95, 0
  v_mov_b32 v96, 0
  v_mov_b32 v97, 0
  v_mov_b32 v98, 0
  v_mov_b32 v99, 0
  v_mov_b32 v100, 0
  v_mov_b32 v101, 0
  v_mov_b32 v102, 0
  v_mov_b32 v103, 0
  s_mov_b64 s[22:23], -1
  s_mov_b64 s[98:99], -1
  s_mov_b64 s[100:101], -1
  s_branch mr_76
sr_81:
  s_mov_b32 s54, 0
sr_94:
  s_mov_b64 exec, vcc
  buffer_load_dwordx4 v[124:127], v9, s[8:11], s56 offen sc1
  buffer_load_dwordx4 v[128:131], v9, s[8:11], s56 offen offset:1024 sc1
  buffer_load_dwordx4 v[132:135], v10, s[8:11], s56 offen sc1
  s_mov_b64 exec, -1
  s_add_u32 s54, s54, 1
  s_cmp_gt_u32 s54, 131072
  s_cbranch_scc1 end0
  s_and_b32 s21, s54, 31
  s_cbranch_scc0 sr_95
  s_waitcnt vmcnt(0)
  v_pk_add_f16 v172, v124, v126
  v_pk_add_f16 v173, v125, v127
  v_pk_add_f16 v174, v128, v130
  v_pk_add_f16 v175, v129, v131
  v_fma_mix_f32 v166, v172, 1.0, v174 op_sel:[0,0,0] op_sel_hi:[1,0,1]
  v_fma_mix_f32 v168, v173, 1.0, v175 op_sel:[0,0,0] op_sel_hi:[1,0,1]
  v_pk_add_f16 v176, v132, v133
  v_pk_add_f16 v177, v134, v135
  v_add_f32 v27, v166, v168
  v_fma_mix_f32 v170, v176, 1.0, v177 op_sel:[0,0,0] op_sel_hi:[1,0,1]
  v_fma_mix_f32 v167, v172, 1.0, v174 op_sel:[1,0,1] op_sel_hi:[1,0,1]
  v_cmp_u_f32 vcc, v27, v170
  v_fma_mix_f32 v169, v173, 1.0, v175 op_sel:[1,0,1] op_sel_hi:[1,0,1]
  v_fma_mix_f32 v171, v176, 1.0, v177 op_sel:[1,0,1] op_sel_hi:[1,0,1]
  s_cbranch_vccnz sr_94
  s_branch sj_82
sr_95:
  s_waitcnt vmcnt(0)
  v_pk_add_f16 v172, v124, v126
  v_pk_add_f16 v173, v125, v127
  v_pk_add_f16 v174, v128, v130
  v_pk_add_f16 v175, v129, v131
  v_fma_mix_f32 v166, v172, 1.0, v174 op_sel:[0,0,0] op_sel_hi:[1,0,1]
  v_fma_mix_f32 v168, v173, 1.0, v175 op_sel:[0,0,0] op_sel_hi:[1,0,1]
  v_pk_add_f16 v176, v132, v133
  v_pk_add_f16 v177, v134, v135
  v_add_f32 v27, v166, v168
  v_fma_mix_f32 v170, v176, 1.0, v177 op_sel:[0,0,0] op_sel_hi:[1,0,1]
  v_fma_mix_f32 v167, v172, 1.0, v174 op_sel:[1,0,1] op_sel_hi:[1,0,1]
  v_cmp_u_f32 vcc, v27, v170
  v_fma_mix_f32 v169, v173, 1.0, v175 op_sel:[1,0,1] op_sel_hi:[1,0,1]
  v_fma_mix_f32 v171, v176, 1.0, v177 op_sel:[1,0,1] op_sel_hi:[1,0,1]
  v_max3_u32 v27, v124, v126, v128
  v_max3_u32 v27, v27, v130, v132
  v_max3_u32 v27, v27, v133, v134
  v_max3_u32 v27, v27, v135, v135
  v_cmp_eq_u32 vcc, -1, v27
  s_nop 1
  s_cbranch_vccnz sr_94
  s_branch sj_82
fx_84:
  s_cmp_eq_u32 s81, 1
  s_cbranch_scc1 fk_85
  s_mov_b32 s81, 1
  v_max3_f32 v164, v166, v167, v168
  v_max3_f32 v165, v169, v170, v171
  v_max_f32 v164, v164, v165
  s_nop 1
  v_max_f32_dpp v164, v164, v164 row_ror:8 row_mask:0xf bank_mask:0xf
  v_mov_b32 v165, v164
  s_nop 1
  v_permlane32_swap_b32 v164, v165
  v_max_f32 v164, v164, v165
  v_mov_b32 v165, v164
  s_nop 1
  v_permlane16_swap_b32 v164, v165
  v_max_f32 v164, v164, v165
  v_sub_f32 v166, v166, v164
  v_sub_f32 v167, v167, v164
  v_sub_f32 v168, v168, v164
  v_sub_f32 v169, v169, v164
  v_sub_f32 v170, v170, v164
  v_sub_f32 v171, v171, v164
  s_branch ex_83
nt_87:
  s_branch nt_86
p2_90:
  s_mov_b32 s54, 0
  buffer_load_dwordx4 v[68:71], v16, s[4:7], s60 offen sc1
  s_waitcnt vmcnt(1)
  v_mfma_f32_16x16x32_f16 v[120:123], v[44:47], v[72:75], 0
  v_bitop3_b32 v27, v72, s61, 1 bitop3:0x28
  v_cmp_ne_u32 vcc, 0, v27
  s_nop 1
  s_cbranch_vccz pg_89
  buffer_load_dwordx4 v[72:75], v16, s[4:7], s60 offen sc1
pp_88:
  s_waitcnt vmcnt(1)
  v_mfma_f32_16x16x32_f16 v[120:123], v[44:47], v[68:71], 0
  v_bitop3_b32 v27, v68, s61, 1 bitop3:0x28
  v_cmp_ne_u32 vcc, 0, v27
  s_nop 1
  s_cbranch_vccz pg_89
  buffer_load_dwordx4 v[68:71], v16, s[4:7], s60 offen sc1
  s_waitcnt vmcnt(1)
  v_mfma_f32_16x16x32_f16 v[120:123], v[44:47], v[72:75], 0
  v_bitop3_b32 v27, v72, s61, 1 bitop3:0x28
  v_cmp_ne_u32 vcc, 0, v27
  s_nop 1
  s_cbranch_vccz pg_89
  buffer_load_dwordx4 v[72:75], v16, s[4:7], s60 offen sc1
  s_add_u32 s54, s54, 1
  s_cmp_gt_u32 s54, 131072
  s_cbranch_scc1 end0
  s_branch pp_88
last_79:
  v_smfmac_f32_16x16x64_bf16 v[96:99], v[48:51], a[0:7], v22
  v_smfmac_f32_16x16x64_bf16 v[100:103], v[48:51], a[80:87], v22
  v_smfmac_f32_16x16x64_bf16 v[96:99], v[52:55], a[8:15], v22
  v_smfmac_f32_16x16x64_bf16 v[100:103], v[52:55], a[88:95], v22
  v_smfmac_f32_16x16x64_bf16 v[96:99], v[56:59], a[16:23], v22
  v_smfmac_f32_16x16x64_bf16 v[100:103], v[56:59], a[96:103], v22
  v_smfmac_f32_16x16x64_bf16 v[96:99], v[60:63], a[24:31], v22
  v_smfmac_f32_16x16x64_bf16 v[96:99], v[64:67], a[32:39], v22
  v_smfmac_f32_16x16x64_bf16 v[96:99], v[68:71], a[40:47], v22
  v_smfmac_f32_16x16x64_bf16 v[96:99], v[72:75], a[48:55], v22
  v_smfmac_f32_16x16x64_bf16 v[96:99], v[76:79], a[56:63], v22
  v_smfmac_f32_16x16x64_bf16 v[96:99], v[80:83], a[64:71], v22
  v_smfmac_f32_16x16x64_bf16 v[96:99], v[84:87], a[72:79], v22
  v_smfmac_f32_16x16x64_bf16 v[100:103], v[60:63], a[104:111], v22
  v_smfmac_f32_16x16x64_bf16 v[100:103], v[64:67], a[112:119], v22
  v_smfmac_f32_16x16x64_bf16 v[100:103], v[68:71], a[120:127], v22
  v_smfmac_f32_16x16x64_bf16 v[100:103], v[72:75], a[128:135], v22
  v_smfmac_f32_16x16x64_bf16 v[100:103], v[76:79], a[136:143], v22
  v_smfmac_f32_16x16x64_bf16 v[100:103], v[80:83], a[144:151], v22
  v_smfmac_f32_16x16x64_bf16 v[100:103], v[84:87], a[152:159], v22
  s_nop 7
  v_permlane32_swap_b32 v96, v100
  v_permlane32_swap_b32 v97, v101
  v_permlane32_swap_b32 v98, v102
  v_permlane32_swap_b32 v99, v103
  v_pk_add_f32 v[96:97], v[96:97], v[100:101]
  v_pk_add_f32 v[98:99], v[98:99], v[102:103]
  v_cvt_pk_bf16_f32 v182, v96, v97
  v_cvt_pk_bf16_f32 v183, v98, v99
  v_min_u32 v182, -2, v182
  ds_write_b64 v26, v[182:183]
  s_waitcnt lgkmcnt(0)
  s_barrier
  s_branch chain_done
E_32:
  v_add_u32 v190, 9216, v4
  s_waitcnt vmcnt(0)
  ds_write_b128 v190, v[84:87] offset:0
  s_branch mo_101
  .p2align 3
top_96:
  s_waitcnt vmcnt(0)
  ds_write_b128 v190, v[84:87] offset:0
  v_cmp_eq_u32 s[22:23], -1, v84
  s_or_b64 vcc, s[22:23], s[22:23]
  s_cbranch_scc1 mr_97
mo_101:
  s_waitcnt lgkmcnt(0)
  s_barrier
  ds_read_b128 v[48:51], v4 offset:0
  ds_read_b128 v[52:55], v4 offset:1024
  v_smfmac_f32_16x16x64_bf16 v[92:95], v[84:87], v[248:255], v22
  ds_read_b128 v[56:59], v4 offset:2048
  ds_read_b128 v[60:63], v4 offset:3072
  v_smfmac_f32_16x16x64_bf16 v[88:91], v[84:87], a[232:239], v22
  s_waitcnt lgkmcnt(3)
  s_add_u32 m0, s74, 0
  s_add_u32 s21, s79, 0
  buffer_load_dwordx4 v4, s[16:19], s21 offen offset:0 sc1 lds
  v_smfmac_f32_16x16x64_bf16 v[92:95], v[48:51], a[240:247], v22
  ds_read_b128 v[64:67], v4 offset:4096
  ds_read_b128 v[68:71], v4 offset:5120
  s_add_u32 s22, s52, 3
  s_min_u32 s22, s22, 64
  v_smfmac_f32_16x16x64_bf16 v[88:91], v[48:51], a[160:167], v22
  s_waitcnt lgkmcnt(4)
  s_add_u32 m0, s74, 0
  s_add_u32 s21, s79, 0
  buffer_load_dwordx4 v4, s[16:19], s21 offen offset:1024 sc1 lds
  v_cmp_gt_u32 vcc, s22, v42
  v_smfmac_f32_16x16x64_bf16 v[92:95], v[52:55], a[248:255], v22
  ds_read_b128 v[72:75], v4 offset:6144
  ds_read_b128 v[76:79], v4 offset:7168
  s_cbranch_vccnz kw_102
kv_103:
  v_smfmac_f32_16x16x64_bf16 v[88:91], v[52:55], a[168:175], v22
  s_waitcnt lgkmcnt(5)
  s_add_u32 m0, s74, 2048
  s_add_u32 s21, s79, 65536
  buffer_load_dwordx4 v4, s[16:19], s21 offen offset:0 sc1 lds
  v_smfmac_f32_16x16x64_bf16 v[92:95], v[56:59], v[192:199], v22
  ds_read_b128 v[80:83], v4 offset:8192
  v_smfmac_f32_16x16x64_bf16 v[88:91], v[56:59], a[176:183], v22
  s_waitcnt lgkmcnt(5)
  s_add_u32 m0, s74, 10240
  s_nop 0
  buffer_load_dwordx4 v4, s[16:19], s73 offen offset:0 sc1 lds
  v_smfmac_f32_16x16x64_bf16 v[92:95], v[60:63], v[200:207], v22
  s_waitcnt lgkmcnt(4)
  v_smfmac_f32_16x16x64_bf16 v[92:95], v[64:67], v[208:215], v22
  s_waitcnt lgkmcnt(3)
  s_add_u32 m0, s74, 10240
  s_nop 0
  buffer_load_dwordx4 v4, s[16:19], s73 offen offset:1024 sc1 lds
  v_smfmac_f32_16x16x64_bf16 v[92:95], v[68:71], v[216:223], v22
  s_waitcnt lgkmcnt(2)
  v_smfmac_f32_16x16x64_bf16 v[92:95], v[72:75], v[224:231], v22
  s_waitcnt lgkmcnt(1)
  s_add_u32 m0, s74, 10240
  s_nop 0
  buffer_load_dwordx4 v4, s[16:19], s73 offen offset:2048 sc1 lds
  v_smfmac_f32_16x16x64_bf16 v[92:95], v[76:79], v[232:239], v22
  s_waitcnt lgkmcnt(0)
  v_smfmac_f32_16x16x64_bf16 v[92:95], v[80:83], v[240:247], v22
  s_add_u32 m0, s74, 8192
  s_add_u32 s21, s72, 0
  buffer_load_dwordx4 v32, s[16:19], s21 offen sc1 lds
  v_smfmac_f32_16x16x64_bf16 v[88:91], v[60:63], a[184:191], v22
  v_smfmac_f32_16x16x64_bf16 v[88:91], v[64:67], a[192:199], v22
  v_smfmac_f32_16x16x64_bf16 v[88:91], v[68:71], a[200:207], v22
  v_cvt_pk_bf16_f32 v122, v92, v93
  v_smfmac_f32_16x16x64_bf16 v[88:91], v[72:75], a[208:215], v22
  v_cvt_pk_bf16_f32 v123, v94, v95
  v_smfmac_f32_16x16x64_bf16 v[88:91], v[76:79], a[216:223], v22
  ds_write_b64 v12, v[122:123] offset:13056
  v_smfmac_f32_16x16x64_bf16 v[88:91], v[80:83], a[224:231], v22
  s_nop 7
  v_cvt_pk_bf16_f32 v120, v88, v89
  v_cvt_pk_bf16_f32 v121, v90, v91
  ds_write_b64 v12, v[120:121] offset:12544
  v_smfmac_f32_16x16x64_bf16 v[96:99], v[48:51], a[0:7], v22
  v_cmp_u_f32 vcc, v88, v89
  v_smfmac_f32_16x16x64_bf16 v[100:103], v[48:51], a[80:87], v22
  v_cmp_u_f32 s[22:23], v90, v91
  s_nop 0
  s_or_b64 vcc, vcc, s[22:23]
  s_cbranch_vccnz mn_98
mk_99:
  s_waitcnt lgkmcnt(0)
  s_barrier
  ds_read_b64_tr_b16 v[104:105], v7 offset:0
  ds_read_b64_tr_b16 v[106:107], v7 offset:768
  ds_read_b64_tr_b16 v[108:109], v7 offset:1536
  ds_read_b64 v[140:141], v11
  s_cmp_eq_u32 s52, 63
  s_cbranch_scc1 last_100
  v_smfmac_f32_16x16x64_bf16 v[96:99], v[52:55], a[8:15], v22
  v_smfmac_f32_16x16x64_bf16 v[100:103], v[52:55], a[88:95], v22
  v_smfmac_f32_16x16x64_bf16 v[96:99], v[56:59], a[16:23], v22
  v_smfmac_f32_16x16x64_bf16 v[100:103], v[56:59], a[96:103], v22
  v_smfmac_f32_16x16x64_bf16 v[96:99], v[60:63], a[24:31], v22
  v_smfmac_f32_16x16x64_bf16 v[96:99], v[64:67], a[32:39], v22
  v_smfmac_f32_16x16x64_bf16 v[96:99], v[68:71], a[40:47], v22
  v_smfmac_f32_16x16x64_bf16 v[96:99], v[72:75], a[48:55], v22
  v_smfmac_f32_16x16x64_bf16 v[96:99], v[76:79], a[56:63], v22
  v_smfmac_f32_16x16x64_bf16 v[96:99], v[80:83], a[64:71], v22
  v_smfmac_f32_16x16x64_bf16 v[96:99], v[84:87], a[72:79], v22
  v_smfmac_f32_16x16x64_bf16 v[100:103], v[60:63], a[104:111], v22
  v_smfmac_f32_16x16x64_bf16 v[100:103], v[64:67], a[112:119], v22
  v_smfmac_f32_16x16x64_bf16 v[100:103], v[68:71], a[120:127], v22
  v_smfmac_f32_16x16x64_bf16 v[100:103], v[72:75], a[128:135], v22
  v_cvt_pk_bf16_f32 v136, v96, v97
  v_smfmac_f32_16x16x64_bf16 v[100:103], v[76:79], a[136:143], v22
  v_cvt_pk_bf16_f32 v137, v98, v99
  v_smfmac_f32_16x16x64_bf16 v[100:103], v[80:83], a[144:151], v22
  v_smfmac_f32_16x16x64_bf16 v[100:103], v[84:87], a[152:159], v22
  s_sleep 2
  s_nop 7
  buffer_load_dwordx4 v[124:127], v9, s[8:11], s56 offen sc1
  buffer_load_dwordx4 v[128:131], v9, s[8:11], s56 offen offset:1024 sc1
  s_nop 5
  buffer_load_dwordx4 v[132:135], v10, s[8:11], s56 offen sc1
  s_waitcnt vmcnt(2)
  v_pk_add_f16 v172, v124, v126
  v_pk_add_f16 v173, v125, v127
  s_waitcnt vmcnt(1)
  v_pk_add_f16 v174, v128, v130
  v_pk_add_f16 v175, v129, v131
  v_fma_mix_f32 v166, v172, 1.0, v174 op_sel:[0,0,0] op_sel_hi:[1,0,1]
  v_fma_mix_f32 v168, v173, 1.0, v175 op_sel:[0,0,0] op_sel_hi:[1,0,1]
  s_waitcnt vmcnt(0)
  v_pk_add_f16 v176, v132, v133
  v_pk_add_f16 v177, v134, v135
  v_fma_mix_f32 v170, v176, 1.0, v177 op_sel:[0,0,0] op_sel_hi:[1,0,1]
  v_fma_mix_f32 v167, v172, 1.0, v174 op_sel:[1,0,1] op_sel_hi:[1,0,1]
  v_cmp_u_f32 vcc, v166, v170
  v_fma_mix_f32 v169, v173, 1.0, v175 op_sel:[1,0,1] op_sel_hi:[1,0,1]
  v_fma_mix_f32 v171, v176, 1.0, v177 op_sel:[1,0,1] op_sel_hi:[1,0,1]
  v_cvt_pk_bf16_f32 v138, v100, v101
  s_cbranch_vccnz sr_104
sj_105:
ex_106:
  v_exp_f32 v172, v166
  v_exp_f32 v173, v167
  v_exp_f32 v174, v168
  v_cvt_pk_bf16_f32 v156, v172, v173
  v_exp_f32 v175, v169
  v_exp_f32 v176, v170
  v_cvt_pk_bf16_f32 v157, v174, v175
  v_mov_b32_dpp v158, v156 row_ror:8 row_mask:0xf bank_mask:0xf
  v_exp_f32 v177, v171
  v_mov_b32_dpp v159, v157 row_ror:8 row_mask:0xf bank_mask:0xf
  v_cvt_pk_bf16_f32 v160, v176, v177
  v_cvt_pk_bf16_f32 v139, v102, v103
  v_mfma_f32_16x16x32_bf16 v[178:181], v[152:155], v[156:159], 0
  s_waitcnt lgkmcnt(0)
  v_mov_b32_dpp v161, v160 row_ror:8 row_mask:0xf bank_mask:0xf
  v_mfma_f32_16x16x32_bf16 v[182:185], v[144:147], v[156:159], 0
  s_nop 0
  v_mfma_f32_16x16x32_bf16 v[178:181], v[140:143], v[160:163], v[178:181]
  v_mfma_f32_16x16x32_bf16 v[182:185], v[136:139], v[160:163], v[182:185]
  v_mfma_f32_16x16x32_bf16 v[186:189], v[148:151], v[156:159], 0
  v_mfma_f32_16x16x32_bf16 v[186:189], v[138:141], v[160:163], v[186:189]
  s_mov_b64 exec, s[62:63]
  v_rcp_f32 v164, v180
  s_nop 0
  v_pk_mul_f32 v[178:179], v[178:179], v[164:165] op_sel_hi:[1,0]
  v_pk_mul_f32 v[182:183], v[182:183], v[164:165] op_sel_hi:[1,0]
  v_pk_mul_f32 v[184:185], v[184:185], v[164:165] op_sel_hi:[1,0]
  v_cvt_pk_f16_f32 v64, v178, v179
  v_cvt_pk_f16_f32 v60, v182, v183
  v_pk_mul_f32 v[186:187], v[186:187], v[164:165] op_sel_hi:[1,0]
  v_pk_mul_f32 v[188:189], v[188:189], v[164:165] op_sel_hi:[1,0]
  v_cvt_pk_f16_f32 v61, v184, v185
  v_cvt_pk_f16_f32 v62, v186, v187
  v_cvt_pk_f16_f32 v63, v188, v189
  ds_write_b128 v13, v[60:63]
  ds_write_b32 v14, v64
  v_add_f32 v165, v164, v180
  v_cmp_ngt_f32 vcc, s80, v165
  s_mov_b64 exec, -1
  s_nop 0
  s_cbranch_vccnz fx_107
fk_108:
  s_waitcnt lgkmcnt(0)
  s_barrier
  ds_read_b128 v[166:169], v4 offset:13824
  ds_read_b128 v[170:173], v4 offset:14464
  ds_read_b128 v[174:177], v4 offset:15104
  ds_read_b128 v[178:181], v4 offset:15744
  s_mov_b64 exec, s[66:67]
  s_waitcnt lgkmcnt(2)
  v_pk_add_f16 v166, v166, v170
  v_pk_add_f16 v167, v167, v171
  v_pk_add_f16 v168, v168, v172
  v_pk_add_f16 v169, v169, v173
  s_waitcnt lgkmcnt(1)
  v_pk_add_f16 v166, v166, v174
  v_pk_add_f16 v167, v167, v175
  v_pk_add_f16 v168, v168, v176
  v_pk_add_f16 v169, v169, v177
  s_waitcnt lgkmcnt(0)
  v_pk_add_f16 v166, v166, v178
  v_pk_add_f16 v167, v167, v179
  v_pk_add_f16 v168, v168, v180
  v_pk_add_f16 v169, v169, v181
  v_and_or_b32 v166, v166, -2, s61
  buffer_store_dwordx4 v[166:169], v15, s[4:7], s60 offen sc1
  s_mov_b64 exec, -1
  v_permlane32_swap_b32 v96, v100
  v_permlane32_swap_b32 v97, v101
  v_permlane32_swap_b32 v98, v102
  v_permlane32_swap_b32 v99, v103
  v_pk_add_f32 v[96:97], v[96:97], v[100:101]
  v_pk_add_f32 v[98:99], v[98:99], v[102:103]
  v_cvt_pk_bf16_f32 v182, v96, v97
  v_cvt_pk_bf16_f32 v183, v98, v99
  v_min_u32 v182, -2, v182
  ds_write_b64 v26, v[182:183]
  v_permlane32_swap_b32 v88, v92
  v_permlane32_swap_b32 v89, v93
  v_permlane32_swap_b32 v90, v94
  v_permlane32_swap_b32 v91, v95
  v_pk_add_f32 v[88:89], v[88:89], v[92:93]
  v_pk_add_f32 v[90:91], v[90:91], v[94:95]
  v_cvt_pk_bf16_f32 v184, v88, v89
  v_cvt_pk_bf16_f32 v185, v90, v91
  v_min_u32 v184, -2, v184
  ds_write_b64 v43, v[184:185]
  ds_read_b128 v[144:147], v18
  ds_read_b128 v[148:151], v18 offset:1024
  ds_read_b128 v[152:155], v19
  v_xor_b32 v18, 16384, v18
  v_xor_b32 v19, 16384, v19
  v_mov_b32 v88, 0
  v_mov_b32 v89, 0
  v_mov_b32 v90, 0
  v_mov_b32 v91, 0
  v_mov_b32 v92, 0
  v_mov_b32 v93, 0
  v_mov_b32 v94, 0
  v_mov_b32 v95, 0
  v_mov_b32 v96, 0
  v_mov_b32 v97, 0
  v_mov_b32 v98, 0
  v_mov_b32 v99, 0
  v_mov_b32 v100, 0
  v_mov_b32 v101, 0
  v_mov_b32 v102, 0
  v_mov_b32 v103, 0
  s_mov_b32 s81, 0
  s_waitcnt lgkmcnt(0)
  s_barrier
  s_xor_b32 s74, s74, 16384
  s_add_u32 s73, s73, 2097152
  s_xor_b32 s73, s73, 8192
  s_add_u32 s79, s79, 2097152
  s_xor_b32 s79, s79, 8192
  s_add_u32 s21, s72, 524288
  s_xor_b32 s72, s72, s21
  s_lshr_b32 s72, s72, 8
  s_and_b32 s72, s72, 8192
  s_xor_b32 s72, s72, s21
  s_add_u32 s21, s52, 7
  s_lshr_b32 s21, s21, 2
  v_mov_b32 v28, s21
  v_mov_b32 v166, s52
  s_and_b32 s21, s52, 3
  s_cmp_lt_u32 s52, 54
  s_cselect_b32 s21, s21, 0
  s_cmp_lg_u32 s21, 0
  s_cbranch_scc1 fs_110
  s_mov_b64 exec, 1
  buffer_store_dword v166, v23, s[12:15], s77 offen sc1
  s_mov_b64 exec, -1
fs_110:
  ds_read_b128 v[170:173], v4 offset:16384
  ds_read_b128 v[174:177], v4 offset:17408
  ds_read_b128 v[178:181], v4 offset:18432
  v_min_u32 v104, -2, v104
  v_min_u32 v108, -2, v108
  s_mov_b32 s90, s70
  s_add_u32 s70, s70, 2097152
  s_xor_b32 s70, s70, 8192
  buffer_store_dwordx4 v[104:107], v36, s[16:19], s90 offen offset:2560 sc1
  buffer_store_dwordx2 v[108:109], v37, s[16:19], s90 offen offset:3072 sc1
  s_waitcnt lgkmcnt(0)
  buffer_store_dwordx4 v[170:173], v4, s[16:19], s90 offen offset:0 sc1
  buffer_store_dwordx4 v[174:177], v4, s[16:19], s90 offen offset:1024 sc1
  buffer_store_dwordx4 v[178:181], v38, s[16:19], s90 offen offset:2048 sc1
  s_add_u32 s22, s52, 5
  s_min_u32 s22, s22, 64
  v_cmp_gt_u32 vcc, s22, v42
  s_cbranch_vccz fv_111
  buffer_load_dword v42, v41, s[12:15], s76 offen sc1
fv_111:
nt_109:
  s_barrier
  s_mov_b32 s58, s55
  s_add_u32 s52, s52, 1
  s_and_b32 s21, s52, 3
  s_mul_i32 s56, s21, 122880
  s_add_u32 s21, s52, 1
  s_and_b32 s21, s21, 3
  s_mul_i32 s55, s21, 122880
  s_add_u32 s55, s55, s75
  s_add_u32 s21, s52, 2
  s_and_b32 s21, s21, 3
  s_mul_i32 s57, s21, 122880
  s_add_u32 s21, s52, 3
  s_and_b32 s21, s21, 3
  s_mul_i32 s59, s21, 122880
  s_add_u32 s59, s59, s75
  s_bfe_u32 s61, s52, 0x10002
  s_and_b32 s21, s52, 3
  s_lshl_b32 s60, s21, 18
  s_mov_b32 s54, 0
  s_sleep 3
  s_nop 2
  buffer_load_dwordx4 v[84:87], v190, s[8:11], s58 offen offset:0 sc1
  s_branch top_96
mr_97:
  s_mov_b64 exec, s[22:23]
  s_cbranch_execz ms_112
  buffer_load_dwordx4 v[84:87], v190, s[8:11], s58 offen offset:0 sc1
ms_112:
  s_add_u32 s54, s54, 1
  s_cmp_gt_u32 s54, 131072
  s_cbranch_scc1 end0
  s_waitcnt vmcnt(0)
  s_mov_b64 exec, s[22:23]
  ds_write_b128 v190, v[84:87] offset:0
  v_cmp_eq_u32 s[22:23], -1, v84
  s_mov_b64 exec, -1
  s_or_b64 vcc, s[22:23], s[22:23]
  s_cbranch_scc1 mr_97
  s_branch mo_101
kw_102:
  s_mov_b32 s101, 0
wm_113:
  buffer_load_dword v42, v41, s[12:15], s76 offen sc1
  s_add_u32 s101, s101, 1
  s_cmp_gt_u32 s101, 131072
  s_cbranch_scc1 end0
  s_waitcnt vmcnt(0)
  v_cmp_gt_u32 vcc, s22, v42
  v_readfirstlane_b32 s100, v42
  s_nop 0
  s_cbranch_vccz wm_114
  s_sleep 1
  s_branch wm_113
wm_114:
  s_branch kv_103
mn_98:
  v_max3_u32 v27, v48, v49, v50
  v_max3_u32 v27, v27, v51, v52
  v_max3_u32 v27, v27, v53, v54
  v_max3_u32 v27, v27, v55, v56
  v_max3_u32 v27, v27, v57, v58
  v_max3_u32 v27, v27, v59, v60
  v_max3_u32 v27, v27, v61, v62
  v_max3_u32 v27, v27, v63, v64
  v_max3_u32 v27, v27, v65, v66
  v_max3_u32 v27, v27, v67, v68
  v_max3_u32 v27, v27, v69, v70
  v_max3_u32 v27, v27, v71, v72
  v_max3_u32 v27, v27, v73, v74
  v_max3_u32 v27, v27, v75, v76
  v_max3_u32 v27, v27, v77, v78
  v_max3_u32 v27, v27, v79, v80
  v_max3_u32 v27, v27, v81, v82
  v_max3_u32 v27, v27, v83, v84
  v_max3_u32 v27, v27, v85, v86
  v_max3_u32 v27, v27, v87, v87
  v_cmp_eq_u32 vcc, -1, v27
  s_cmp_eq_u32 s52, 0
  s_cbranch_scc1 mk_99
  s_cbranch_vccz mk_99
  s_waitcnt lgkmcnt(0)
  s_barrier
  s_nop 7
  v_mov_b32 v88, 0
  v_mov_b32 v89, 0
  v_mov_b32 v90, 0
  v_mov_b32 v91, 0
  v_mov_b32 v92, 0
  v_mov_b32 v93, 0
  v_mov_b32 v94, 0
  v_mov_b32 v95, 0
  v_mov_b32 v96, 0
  v_mov_b32 v97, 0
  v_mov_b32 v98, 0
  v_mov_b32 v99, 0
  v_mov_b32 v100, 0
  v_mov_b32 v101, 0
  v_mov_b32 v102, 0
  v_mov_b32 v103, 0
  s_mov_b64 s[22:23], -1
  s_branch mr_97
sr_104:
  s_mov_b32 s54, 0
sr_115:
  s_mov_b64 exec, vcc
  buffer_load_dwordx4 v[124:127], v9, s[8:11], s56 offen sc1
  buffer_load_dwordx4 v[128:131], v9, s[8:11], s56 offen offset:1024 sc1
  buffer_load_dwordx4 v[132:135], v10, s[8:11], s56 offen sc1
  s_mov_b64 exec, -1
  s_add_u32 s54, s54, 1
  s_cmp_gt_u32 s54, 131072
  s_cbranch_scc1 end0
  s_and_b32 s21, s54, 31
  s_cbranch_scc0 sr_116
  s_waitcnt vmcnt(0)
  v_pk_add_f16 v172, v124, v126
  v_pk_add_f16 v173, v125, v127
  v_pk_add_f16 v174, v128, v130
  v_pk_add_f16 v175, v129, v131
  v_fma_mix_f32 v166, v172, 1.0, v174 op_sel:[0,0,0] op_sel_hi:[1,0,1]
  v_fma_mix_f32 v168, v173, 1.0, v175 op_sel:[0,0,0] op_sel_hi:[1,0,1]
  v_pk_add_f16 v176, v132, v133
  v_pk_add_f16 v177, v134, v135
  v_add_f32 v27, v166, v168
  v_fma_mix_f32 v170, v176, 1.0, v177 op_sel:[0,0,0] op_sel_hi:[1,0,1]
  v_fma_mix_f32 v167, v172, 1.0, v174 op_sel:[1,0,1] op_sel_hi:[1,0,1]
  v_cmp_u_f32 vcc, v27, v170
  v_fma_mix_f32 v169, v173, 1.0, v175 op_sel:[1,0,1] op_sel_hi:[1,0,1]
  v_fma_mix_f32 v171, v176, 1.0, v177 op_sel:[1,0,1] op_sel_hi:[1,0,1]
  s_cbranch_vccnz sr_115
  s_branch sj_105
sr_116:
  s_waitcnt vmcnt(0)
  v_pk_add_f16 v172, v124, v126
  v_pk_add_f16 v173, v125, v127
  v_pk_add_f16 v174, v128, v130
  v_pk_add_f16 v175, v129, v131
  v_fma_mix_f32 v166, v172, 1.0, v174 op_sel:[0,0,0] op_sel_hi:[1,0,1]
  v_fma_mix_f32 v168, v173, 1.0, v175 op_sel:[0,0,0] op_sel_hi:[1,0,1]
  v_pk_add_f16 v176, v132, v133
  v_pk_add_f16 v177, v134, v135
  v_add_f32 v27, v166, v168
  v_fma_mix_f32 v170, v176, 1.0, v177 op_sel:[0,0,0] op_sel_hi:[1,0,1]
  v_fma_mix_f32 v167, v172, 1.0, v174 op_sel:[1,0,1] op_sel_hi:[1,0,1]
  v_cmp_u_f32 vcc, v27, v170
  v_fma_mix_f32 v169, v173, 1.0, v175 op_sel:[1,0,1] op_sel_hi:[1,0,1]
  v_fma_mix_f32 v171, v176, 1.0, v177 op_sel:[1,0,1] op_sel_hi:[1,0,1]
  v_max3_u32 v27, v124, v126, v128
  v_max3_u32 v27, v27, v130, v132
  v_max3_u32 v27, v27, v133, v134
  v_max3_u32 v27, v27, v135, v135
  v_cmp_eq_u32 vcc, -1, v27
  s_nop 1
  s_cbranch_vccnz sr_115
  s_branch sj_105
fx_107:
  s_cmp_eq_u32 s81, 1
  s_cbranch_scc1 fk_108
  s_mov_b32 s81, 1
  v_max3_f32 v164, v166, v167, v168
  v_max3_f32 v165, v169, v170, v171
  v_max_f32 v164, v164, v165
  s_nop 1
  v_max_f32_dpp v164, v164, v164 row_ror:8 row_mask:0xf bank_mask:0xf
  v_mov_b32 v165, v164
  s_nop 1
  v_permlane32_swap_b32 v164, v165
  v_max_f32 v164, v164, v165
  v_mov_b32 v165, v164
  s_nop 1
  v_permlane16_swap_b32 v164, v165
  v_max_f32 v164, v164, v165
  v_sub_f32 v166, v166, v164
  v_sub_f32 v167, v167, v164
  v_sub_f32 v168, v168, v164
  v_sub_f32 v169, v169, v164
  v_sub_f32 v170, v170, v164
  v_sub_f32 v171, v171, v164
  s_branch ex_106
last_100:
  s_waitcnt lgkmcnt(0)
  v_min_u32 v104, -2, v104
  v_min_u32 v108, -2, v108
  s_mov_b32 s90, s70
  buffer_store_dwordx4 v[104:107], v36, s[16:19], s90 offen offset:2560 sc1
  buffer_store_dwordx2 v[108:109], v37, s[16:19], s90 offen offset:3072 sc1
  v_smfmac_f32_16x16x64_bf16 v[96:99], v[52:55], a[8:15], v22
  v_smfmac_f32_16x16x64_bf16 v[100:103], v[52:55], a[88:95], v22
  v_smfmac_f32_16x16x64_bf16 v[96:99], v[56:59], a[16:23], v22
  v_smfmac_f32_16x16x64_bf16 v[100:103], v[56:59], a[96:103], v22
  v_smfmac_f32_16x16x64_bf16 v[96:99], v[60:63], a[24:31], v22
  v_smfmac_f32_16x16x64_bf16 v[96:99], v[64:67], a[32:39], v22
  v_smfmac_f32_16x16x64_bf16 v[96:99], v[68:71], a[40:47], v22
  v_smfmac_f32_16x16x64_bf16 v[96:99], v[72:75], a[48:55], v22
  v_smfmac_f32_16x16x64_bf16 v[96:99], v[76:79], a[56:63], v22
  v_smfmac_f32_16x16x64_bf16 v[96:99], v[80:83], a[64:71], v22
  v_smfmac_f32_16x16x64_bf16 v[96:99], v[84:87], a[72:79], v22
  v_smfmac_f32_16x16x64_bf16 v[100:103], v[60:63], a[104:111], v22
  v_smfmac_f32_16x16x64_bf16 v[100:103], v[64:67], a[112:119], v22
  v_smfmac_f32_16x16x64_bf16 v[100:103], v[68:71], a[120:127], v22
  v_smfmac_f32_16x16x64_bf16 v[100:103], v[72:75], a[128:135], v22
  v_smfmac_f32_16x16x64_bf16 v[100:103], v[76:79], a[136:143], v22
  v_smfmac_f32_16x16x64_bf16 v[100:103], v[80:83], a[144:151], v22
  v_smfmac_f32_16x16x64_bf16 v[100:103], v[84:87], a[152:159], v22
  s_nop 7
  v_permlane32_swap_b32 v96, v100
  v_permlane32_swap_b32 v97, v101
  v_permlane32_swap_b32 v98, v102
  v_permlane32_swap_b32 v99, v103
  v_pk_add_f32 v[96:97], v[96:97], v[100:101]
  v_pk_add_f32 v[98:99], v[98:99], v[102:103]
  v_cvt_pk_bf16_f32 v182, v96, v97
  v_cvt_pk_bf16_f32 v183, v98, v99
  v_min_u32 v182, -2, v182
  ds_write_b64 v26, v[182:183]
  v_permlane32_swap_b32 v88, v92
  v_permlane32_swap_b32 v89, v93
  v_permlane32_swap_b32 v90, v94
  v_permlane32_swap_b32 v91, v95
  v_pk_add_f32 v[88:89], v[88:89], v[92:93]
  v_pk_add_f32 v[90:91], v[90:91], v[94:95]
  v_cvt_pk_bf16_f32 v184, v88, v89
  v_cvt_pk_bf16_f32 v185, v90, v91
  v_min_u32 v184, -2, v184
  ds_write_b64 v43, v[184:185]
  s_waitcnt lgkmcnt(0)
  s_barrier
  ds_read_b128 v[170:173], v4 offset:16384
  ds_read_b128 v[174:177], v4 offset:17408
  ds_read_b128 v[178:181], v4 offset:18432
  v_min_u32 v104, -2, v104
  v_min_u32 v108, -2, v108
  s_mov_b32 s90, s70
  s_add_u32 s70, s70, 2097152
  s_xor_b32 s70, s70, 8192
  s_waitcnt lgkmcnt(0)
  buffer_store_dwordx4 v[170:173], v4, s[16:19], s90 offen offset:0 sc1
  buffer_store_dwordx4 v[174:177], v4, s[16:19], s90 offen offset:1024 sc1
  buffer_store_dwordx4 v[178:181], v38, s[16:19], s90 offen offset:2048 sc1
  s_waitcnt vmcnt(0)
  v_mov_b32 v166, 64
  s_mov_b64 exec, 1
  buffer_store_dword v166, v23, s[12:15], s77 offen sc1
  s_mov_b64 exec, -1
  s_branch chain_done
E_25:
  v_add_u32 v190, 0, v4
  s_waitcnt vmcnt(0)
  ds_write_b128 v190, v[48:51] offset:0
  ds_write_b128 v190, v[52:55] offset:1024
  ds_write_b128 v190, v[56:59] offset:2048
  s_add_u32 m0, s74, 9216
  s_add_u32 s21, s72, 32768
  buffer_load_dwordx4 v32, s[16:19], s21 offen sc1 lds
  s_add_u32 m0, s74, 4096
  s_add_u32 s21, s79, 131072
  buffer_load_dwordx4 v4, s[16:19], s21 offen offset:1024 sc1 lds
  s_xor_b32 s74, s74, 16384
  s_add_u32 s73, s73, 2097152
  s_xor_b32 s73, s73, 8192
  s_add_u32 s79, s79, 2097152
  s_xor_b32 s79, s79, 8192
  s_add_u32 s21, s72, 524288
  s_xor_b32 s72, s72, s21
  s_lshr_b32 s72, s72, 8
  s_and_b32 s72, s72, 8192
  s_xor_b32 s72, s72, s21
  s_branch mo_122
  .p2align 3
top_117:
  s_waitcnt vmcnt(2)
  ds_write_b128 v190, v[48:51] offset:0
  v_cmp_eq_u32 s[22:23], -1, v48
  s_waitcnt vmcnt(1)
  ds_write_b128 v190, v[52:55] offset:1024
  v_cmp_eq_u32 s[98:99], -1, v52
  s_waitcnt vmcnt(0)
  ds_write_b128 v190, v[56:59] offset:2048
  v_cmp_eq_u32 s[100:101], -1, v56
  s_or_b64 vcc, s[22:23], s[98:99]
  s_or_b64 vcc, vcc, s[100:101]
  s_cbranch_scc1 mr_118
mo_122:
  s_waitcnt lgkmcnt(0)
  s_barrier
  ds_read_b128 v[60:63], v4 offset:3072
  ds_read_b128 v[64:67], v4 offset:4096
  v_smfmac_f32_16x16x64_bf16 v[92:95], v[48:51], a[240:247], v22
  ds_read_b128 v[68:71], v4 offset:5120
  v_smfmac_f32_16x16x64_bf16 v[88:91], v[48:51], a[160:167], v22
  ds_read_b128 v[72:75], v4 offset:6144
  v_smfmac_f32_16x16x64_bf16 v[92:95], v[52:55], a[248:255], v22
  ds_read_b128 v[76:79], v4 offset:7168
  v_smfmac_f32_16x16x64_bf16 v[88:91], v[52:55], a[168:175], v22
  ds_read_b128 v[80:83], v4 offset:8192
  v_smfmac_f32_16x16x64_bf16 v[92:95], v[56:59], v[192:199], v22
  ds_read_b128 v[84:87], v4 offset:9216
  v_smfmac_f32_16x16x64_bf16 v[88:91], v[56:59], a[176:183], v22
  s_waitcnt lgkmcnt(6)
  v_smfmac_f32_16x16x64_bf16 v[92:95], v[60:63], v[200:207], v22
  v_smfmac_f32_16x16x64_bf16 v[88:91], v[60:63], a[184:191], v22
  s_waitcnt lgkmcnt(5)
  v_smfmac_f32_16x16x64_bf16 v[92:95], v[64:67], v[208:215], v22
  s_waitcnt lgkmcnt(4)
  v_smfmac_f32_16x16x64_bf16 v[92:95], v[68:71], v[216:223], v22
  s_waitcnt lgkmcnt(3)
  v_smfmac_f32_16x16x64_bf16 v[92:95], v[72:75], v[224:231], v22
  s_waitcnt lgkmcnt(2)
  v_smfmac_f32_16x16x64_bf16 v[92:95], v[76:79], v[232:239], v22
  s_waitcnt lgkmcnt(1)
  v_smfmac_f32_16x16x64_bf16 v[92:95], v[80:83], v[240:247], v22
  s_waitcnt lgkmcnt(0)
  v_smfmac_f32_16x16x64_bf16 v[92:95], v[84:87], v[248:255], v22
  v_smfmac_f32_16x16x64_bf16 v[88:91], v[64:67], a[192:199], v22
  v_smfmac_f32_16x16x64_bf16 v[88:91], v[68:71], a[200:207], v22
  v_smfmac_f32_16x16x64_bf16 v[88:91], v[72:75], a[208:215], v22
  v_permlane32_swap_b32 v92, v93
  v_smfmac_f32_16x16x64_bf16 v[88:91], v[76:79], a[216:223], v22
  v_permlane32_swap_b32 v94, v95
  v_smfmac_f32_16x16x64_bf16 v[88:91], v[80:83], a[224:231], v22
  v_permlane32_swap_b32 v93, v92
  v_smfmac_f32_16x16x64_bf16 v[88:91], v[84:87], a[232:239], v22
  v_permlane32_swap_b32 v95, v94
  v_pk_mul_f32 v[120:121], v[92:93], v[24:25] op_sel:[1,0] op_sel_hi:[0,1]
  v_pk_mul_f32 v[122:123], v[94:95], v[24:25] op_sel:[1,0] op_sel_hi:[0,1]
  s_nop 4
  v_pk_fma_f32 v[88:89], v[88:89], v[24:25], v[120:121]
  v_pk_fma_f32 v[90:91], v[90:91], v[24:25], v[122:123]
  v_cvt_pk_bf16_f32 v120, v88, v89
  v_cvt_pk_bf16_f32 v121, v90, v91
  ds_write_b64 v6, v[120:121]
  v_cmp_u_f32 vcc, v88, v89
  v_cmp_u_f32 s[22:23], v90, v91
  s_nop 1
  s_or_b64 vcc, vcc, s[22:23]
  s_cbranch_vccnz mn_119
mk_120:
  s_waitcnt lgkmcnt(0)
  s_barrier
  ds_read_b64_tr_b16 v[104:105], v7 offset:0
  ds_read_b64_tr_b16 v[106:107], v7 offset:768
  ds_read_b64_tr_b16 v[108:109], v7 offset:1536
  ds_read_b64 v[140:141], v11
  s_cmp_eq_u32 s52, 63
  s_cbranch_scc1 last_121
  s_waitcnt lgkmcnt(2)
  v_mfma_f32_16x16x32_bf16 v[120:123], v[112:115], v[104:107], 0
  s_waitcnt lgkmcnt(1)
  v_mfma_f32_16x16x32_bf16 v[120:123], v[116:119], v[108:111], v[120:123]
  s_mov_b64 exec, s[64:65]
  s_nop 6
  v_cvt_pk_f16_f32 v120, v120, v121
  v_cvt_pk_f16_f32 v121, v122, v123
  buffer_store_dwordx2 v[120:121], v8, s[8:11], s56 offen sc1
  s_mov_b64 exec, -1
  s_sleep 3
  s_nop 1
  v_smfmac_f32_16x16x64_bf16 v[96:99], v[48:51], a[0:7], v22
  v_smfmac_f32_16x16x64_bf16 v[100:103], v[48:51], a[80:87], v22
  v_smfmac_f32_16x16x64_bf16 v[96:99], v[52:55], a[8:15], v22
  v_smfmac_f32_16x16x64_bf16 v[100:103], v[52:55], a[88:95], v22
  v_smfmac_f32_16x16x64_bf16 v[96:99], v[56:59], a[16:23], v22
  v_smfmac_f32_16x16x64_bf16 v[100:103], v[56:59], a[96:103], v22
  v_smfmac_f32_16x16x64_bf16 v[96:99], v[60:63], a[24:31], v22
  v_smfmac_f32_16x16x64_bf16 v[96:99], v[64:67], a[32:39], v22
  v_smfmac_f32_16x16x64_bf16 v[96:99], v[68:71], a[40:47], v22
  v_smfmac_f32_16x16x64_bf16 v[96:99], v[72:75], a[48:55], v22
  v_smfmac_f32_16x16x64_bf16 v[96:99], v[76:79], a[56:63], v22
  buffer_load_dwordx4 v[124:127], v9, s[8:11], s56 offen sc1
  v_smfmac_f32_16x16x64_bf16 v[96:99], v[80:83], a[64:71], v22
  buffer_load_dwordx4 v[128:131], v9, s[8:11], s56 offen offset:1024 sc1
  v_smfmac_f32_16x16x64_bf16 v[96:99], v[84:87], a[72:79], v22
  buffer_load_dwordx4 v[132:135], v10, s[8:11], s56 offen sc1
  v_smfmac_f32_16x16x64_bf16 v[100:103], v[60:63], a[104:111], v22
  v_smfmac_f32_16x16x64_bf16 v[100:103], v[64:67], a[112:119], v22
  v_smfmac_f32_16x16x64_bf16 v[100:103], v[68:71], a[120:127], v22
  v_smfmac_f32_16x16x64_bf16 v[100:103], v[72:75], a[128:135], v22
  v_cvt_pk_bf16_f32 v136, v96, v97
  v_smfmac_f32_16x16x64_bf16 v[100:103], v[76:79], a[136:143], v22
  v_cvt_pk_bf16_f32 v137, v98, v99
  v_smfmac_f32_16x16x64_bf16 v[100:103], v[80:83], a[144:151], v22
  v_smfmac_f32_16x16x64_bf16 v[100:103], v[84:87], a[152:159], v22
  s_waitcnt vmcnt(2)
  v_pk_add_f16 v172, v124, v126
  v_pk_add_f16 v173, v125, v127
  s_waitcnt vmcnt(1)
  v_pk_add_f16 v174, v128, v130
  v_pk_add_f16 v175, v129, v131
  v_fma_mix_f32 v166, v172, 1.0, v174 op_sel:[0,0,0] op_sel_hi:[1,0,1]
  v_fma_mix_f32 v168, v173, 1.0, v175 op_sel:[0,0,0] op_sel_hi:[1,0,1]
  s_waitcnt vmcnt(0)
  v_pk_add_f16 v176, v132, v133
  v_pk_add_f16 v177, v134, v135
  v_fma_mix_f32 v170, v176, 1.0, v177 op_sel:[0,0,0] op_sel_hi:[1,0,1]
  v_fma_mix_f32 v167, v172, 1.0, v174 op_sel:[1,0,1] op_sel_hi:[1,0,1]
  v_cmp_u_f32 vcc, v166, v170
  v_fma_mix_f32 v169, v173, 1.0, v175 op_sel:[1,0,1] op_sel_hi:[1,0,1]
  v_fma_mix_f32 v171, v176, 1.0, v177 op_sel:[1,0,1] op_sel_hi:[1,0,1]
  v_cvt_pk_bf16_f32 v138, v100, v101
  s_cbranch_vccnz sr_123
sj_124:
ex_125:
  v_exp_f32 v172, v166
  v_exp_f32 v173, v167
  v_exp_f32 v174, v168
  v_cvt_pk_bf16_f32 v156, v172, v173
  v_exp_f32 v175, v169
  v_exp_f32 v176, v170
  v_cvt_pk_bf16_f32 v157, v174, v175
  v_mov_b32_dpp v158, v156 row_ror:8 row_mask:0xf bank_mask:0xf
  v_exp_f32 v177, v171
  v_mov_b32_dpp v159, v157 row_ror:8 row_mask:0xf bank_mask:0xf
  v_cvt_pk_bf16_f32 v160, v176, v177
  v_cvt_pk_bf16_f32 v139, v102, v103
  v_mfma_f32_16x16x32_bf16 v[178:181], v[152:155], v[156:159], 0
  s_waitcnt lgkmcnt(0)
  v_mov_b32_dpp v161, v160 row_ror:8 row_mask:0xf bank_mask:0xf
  v_mfma_f32_16x16x32_bf16 v[182:185], v[144:147], v[156:159], 0
  s_nop 0
  v_mfma_f32_16x16x32_bf16 v[178:181], v[140:143], v[160:163], v[178:181]
  v_mfma_f32_16x16x32_bf16 v[182:185], v[136:139], v[160:163], v[182:185]
  v_mfma_f32_16x16x32_bf16 v[186:189], v[148:151], v[156:159], 0
  v_mfma_f32_16x16x32_bf16 v[186:189], v[138:141], v[160:163], v[186:189]
  s_mov_b64 exec, s[62:63]
  v_rcp_f32 v164, v180
  s_nop 0
  v_pk_mul_f32 v[178:179], v[178:179], v[164:165] op_sel_hi:[1,0]
  v_pk_mul_f32 v[182:183], v[182:183], v[164:165] op_sel_hi:[1,0]
  v_pk_mul_f32 v[184:185], v[184:185], v[164:165] op_sel_hi:[1,0]
  v_cvt_pk_f16_f32 v64, v178, v179
  v_cvt_pk_f16_f32 v60, v182, v183
  v_pk_mul_f32 v[186:187], v[186:187], v[164:165] op_sel_hi:[1,0]
  v_pk_mul_f32 v[188:189], v[188:189], v[164:165] op_sel_hi:[1,0]
  v_cvt_pk_f16_f32 v61, v184, v185
  v_cvt_pk_f16_f32 v62, v186, v187
  v_cvt_pk_f16_f32 v63, v188, v189
  ds_write_b128 v13, v[60:63]
  ds_write_b32 v14, v64
  v_add_f32 v165, v164, v180
  v_cmp_ngt_f32 vcc, s80, v165
  s_mov_b64 exec, -1
  s_nop 0
  s_cbranch_vccnz fx_126
fk_127:
  s_waitcnt lgkmcnt(0)
  s_barrier
  s_add_u32 m0, s74, 9216
  s_add_u32 s21, s72, 32768
  buffer_load_dwordx4 v32, s[16:19], s21 offen sc1 lds
  s_add_u32 m0, s74, 4096
  s_add_u32 s21, s79, 131072
  buffer_load_dwordx4 v4, s[16:19], s21 offen offset:1024 sc1 lds
  s_xor_b32 s74, s74, 16384
  s_add_u32 s73, s73, 2097152
  s_xor_b32 s73, s73, 8192
  s_add_u32 s79, s79, 2097152
  s_xor_b32 s79, s79, 8192
  s_add_u32 s21, s72, 524288
  s_xor_b32 s72, s72, s21
  s_lshr_b32 s72, s72, 8
  s_and_b32 s72, s72, 8192
  s_xor_b32 s72, s72, s21
  s_nop 15
  s_nop 3
  v_permlane32_swap_b32 v96, v100
  v_permlane32_swap_b32 v97, v101
  v_permlane32_swap_b32 v98, v102
  v_permlane32_swap_b32 v99, v103
  v_pk_add_f32 v[96:97], v[96:97], v[100:101]
  v_pk_add_f32 v[98:99], v[98:99], v[102:103]
  v_cvt_pk_bf16_f32 v182, v96, v97
  v_cvt_pk_bf16_f32 v183, v98, v99
  v_min_u32 v182, -2, v182
  ds_write_b64 v26, v[182:183]
  ds_read_b128 v[144:147], v18
  ds_read_b128 v[148:151], v18 offset:1024
  ds_read_b128 v[152:155], v19
  ds_read_b128 v[112:115], v20
  ds_read_b64 v[116:117], v21
  v_xor_b32 v18, 16384, v18
  v_xor_b32 v19, 16384, v19
  v_xor_b32 v20, 16384, v20
  v_xor_b32 v21, 16384, v21
  v_mov_b32 v88, 0
  v_mov_b32 v89, 0
  v_mov_b32 v90, 0
  v_mov_b32 v91, 0
  v_mov_b32 v92, 0
  v_mov_b32 v93, 0
  v_mov_b32 v94, 0
  v_mov_b32 v95, 0
  v_mov_b32 v96, 0
  v_mov_b32 v97, 0
  v_mov_b32 v98, 0
  v_mov_b32 v99, 0
  v_mov_b32 v100, 0
  v_mov_b32 v101, 0
  v_mov_b32 v102, 0
  v_mov_b32 v103, 0
  s_mov_b32 s81, 0
  s_waitcnt lgkmcnt(0)
  s_barrier
  s_mov_b64 exec, s[64:65]
  buffer_store_dwordx2 v[28:29], v8, s[8:11], s57 offen sc1
  s_mov_b64 exec, s[62:63]
  buffer_store_dword v28, v17, s[8:11], s59 offen sc1
  s_mov_b64 exec, -1
  s_sleep 6
  s_nop 3
  buffer_load_dwordx4 v[68:71], v16, s[4:7], s60 offen sc1
  s_sleep 3
  s_nop 1
  buffer_load_dwordx4 v[72:75], v16, s[4:7], s60 offen sc1
  s_waitcnt vmcnt(1)
  v_mfma_f32_16x16x32_f16 v[120:123], v[44:47], v[68:71], 0
  v_bitop3_b32 v27, v68, s61, 1 bitop3:0x28
  v_cmp_ne_u32 vcc, 0, v27
  s_nop 1
  s_cbranch_vccnz p2_132
  s_nop 2
pg_131:
  v_add_f32_dpp v120, v120, v120 row_ror:8 row_mask:0xf bank_mask:0xf
  v_add_f32_dpp v121, v121, v121 row_ror:8 row_mask:0xf bank_mask:0xf
  s_mov_b64 exec, s[62:63]
  v_cvt_pk_bf16_f32 v120, v120, v121
  v_min_u32 v120, -2, v120
  buffer_store_dword v120, v17, s[8:11], s55 offen sc1
  s_mov_b64 exec, -1
nt_128:
  s_barrier
  s_mov_b32 s58, s55
  s_add_u32 s52, s52, 1
  s_and_b32 s21, s52, 3
  s_mul_i32 s56, s21, 122880
  s_add_u32 s21, s52, 1
  s_and_b32 s21, s21, 3
  s_mul_i32 s55, s21, 122880
  s_add_u32 s55, s55, s75
  s_add_u32 s21, s52, 2
  s_and_b32 s21, s21, 3
  s_mul_i32 s57, s21, 122880
  s_add_u32 s21, s52, 3
  s_and_b32 s21, s21, 3
  s_mul_i32 s59, s21, 122880
  s_add_u32 s59, s59, s75
  s_bfe_u32 s61, s52, 0x10002
  s_and_b32 s21, s52, 3
  s_lshl_b32 s60, s21, 18
  s_mov_b32 s54, 0
  s_sleep 3
  s_nop 2
  buffer_load_dwordx4 v[48:51], v190, s[8:11], s58 offen offset:0 sc1
  buffer_load_dwordx4 v[52:55], v190, s[8:11], s58 offen offset:1024 sc1
  buffer_load_dwordx4 v[56:59], v190, s[8:11], s58 offen offset:2048 sc1
  s_branch top_117
mr_118:
  s_mov_b64 exec, s[22:23]
  s_cbranch_execz ms_133
  buffer_load_dwordx4 v[48:51], v190, s[8:11], s58 offen offset:0 sc1
ms_133:
  s_mov_b64 exec, s[98:99]
  s_cbranch_execz ms_134
  buffer_load_dwordx4 v[52:55], v190, s[8:11], s58 offen offset:1024 sc1
ms_134:
  s_mov_b64 exec, s[100:101]
  s_cbranch_execz ms_135
  buffer_load_dwordx4 v[56:59], v190, s[8:11], s58 offen offset:2048 sc1
ms_135:
  s_add_u32 s54, s54, 1
  s_cmp_gt_u32 s54, 131072
  s_cbranch_scc1 end0
  s_waitcnt vmcnt(0)
  s_mov_b64 exec, s[22:23]
  ds_write_b128 v190, v[48:51] offset:0
  v_cmp_eq_u32 s[22:23], -1, v48
  s_mov_b64 exec, s[98:99]
  ds_write_b128 v190, v[52:55] offset:1024
  v_cmp_eq_u32 s[98:99], -1, v52
  s_mov_b64 exec, s[100:101]
  ds_write_b128 v190, v[56:59] offset:2048
  v_cmp_eq_u32 s[100:101], -1, v56
  s_mov_b64 exec, -1
  s_or_b64 vcc, s[22:23], s[98:99]
  s_or_b64 vcc, vcc, s[100:101]
  s_cbranch_scc1 mr_118
  s_branch mo_122
mn_119:
  v_max3_u32 v27, v48, v49, v50
  v_max3_u32 v27, v27, v51, v52
  v_max3_u32 v27, v27, v53, v54
  v_max3_u32 v27, v27, v55, v56
  v_max3_u32 v27, v27, v57, v58
  v_max3_u32 v27, v27, v59, v60
  v_max3_u32 v27, v27, v61, v62
  v_max3_u32 v27, v27, v63, v64
  v_max3_u32 v27, v27, v65, v66
  v_max3_u32 v27, v27, v67, v68
  v_max3_u32 v27, v27, v69, v70
  v_max3_u32 v27, v27, v71, v72
  v_max3_u32 v27, v27, v73, v74
  v_max3_u32 v27, v27, v75, v76
  v_max3_u32 v27, v27, v77, v78
  v_max3_u32 v27, v27, v79, v80
  v_max3_u32 v27, v27, v81, v82
  v_max3_u32 v27, v27, v83, v84
  v_max3_u32 v27, v27, v85, v86
  v_max3_u32 v27, v27, v87, v87
  v_cmp_eq_u32 vcc, -1, v27
  s_cmp_eq_u32 s52, 0
  s_cbranch_scc1 mk_120
  s_cbranch_vccz mk_120
  s_waitcnt lgkmcnt(0)
  s_barrier
  s_nop 7
  v_mov_b32 v88, 0
  v_mov_b32 v89, 0
  v_mov_b32 v90, 0
  v_mov_b32 v91, 0
  v_mov_b32 v92, 0
  v_mov_b32 v93, 0
  v_mov_b32 v94, 0
  v_mov_b32 v95, 0
  v_mov_b32 v96, 0
  v_mov_b32 v97, 0
  v_mov_b32 v98, 0
  v_mov_b32 v99, 0
  v_mov_b32 v100, 0
  v_mov_b32 v101, 0
  v_mov_b32 v102, 0
  v_mov_b32 v103, 0
  s_mov_b64 s[22:23], -1
  s_mov_b64 s[98:99], -1
  s_mov_b64 s[100:101], -1
  s_branch mr_118
sr_123:
  s_mov_b32 s54, 0
sr_136:
  s_mov_b64 exec, vcc
  buffer_load_dwordx4 v[124:127], v9, s[8:11], s56 offen sc1
  buffer_load_dwordx4 v[128:131], v9, s[8:11], s56 offen offset:1024 sc1
  buffer_load_dwordx4 v[132:135], v10, s[8:11], s56 offen sc1
  s_mov_b64 exec, -1
  s_add_u32 s54, s54, 1
  s_cmp_gt_u32 s54, 131072
  s_cbranch_scc1 end0
  s_and_b32 s21, s54, 31
  s_cbranch_scc0 sr_137
  s_waitcnt vmcnt(0)
  v_pk_add_f16 v172, v124, v126
  v_pk_add_f16 v173, v125, v127
  v_pk_add_f16 v174, v128, v130
  v_pk_add_f16 v175, v129, v131
  v_fma_mix_f32 v166, v172, 1.0, v174 op_sel:[0,0,0] op_sel_hi:[1,0,1]
  v_fma_mix_f32 v168, v173, 1.0, v175 op_sel:[0,0,0] op_sel_hi:[1,0,1]
  v_pk_add_f16 v176, v132, v133
  v_pk_add_f16 v177, v134, v135
  v_add_f32 v27, v166, v168
  v_fma_mix_f32 v170, v176, 1.0, v177 op_sel:[0,0,0] op_sel_hi:[1,0,1]
  v_fma_mix_f32 v167, v172, 1.0, v174 op_sel:[1,0,1] op_sel_hi:[1,0,1]
  v_cmp_u_f32 vcc, v27, v170
  v_fma_mix_f32 v169, v173, 1.0, v175 op_sel:[1,0,1] op_sel_hi:[1,0,1]
  v_fma_mix_f32 v171, v176, 1.0, v177 op_sel:[1,0,1] op_sel_hi:[1,0,1]
  s_cbranch_vccnz sr_136
  s_branch sj_124
sr_137:
  s_waitcnt vmcnt(0)
  v_pk_add_f16 v172, v124, v126
  v_pk_add_f16 v173, v125, v127
  v_pk_add_f16 v174, v128, v130
  v_pk_add_f16 v175, v129, v131
  v_fma_mix_f32 v166, v172, 1.0, v174 op_sel:[0,0,0] op_sel_hi:[1,0,1]
  v_fma_mix_f32 v168, v173, 1.0, v175 op_sel:[0,0,0] op_sel_hi:[1,0,1]
  v_pk_add_f16 v176, v132, v133
  v_pk_add_f16 v177, v134, v135
  v_add_f32 v27, v166, v168
  v_fma_mix_f32 v170, v176, 1.0, v177 op_sel:[0,0,0] op_sel_hi:[1,0,1]
  v_fma_mix_f32 v167, v172, 1.0, v174 op_sel:[1,0,1] op_sel_hi:[1,0,1]
  v_cmp_u_f32 vcc, v27, v170
  v_fma_mix_f32 v169, v173, 1.0, v175 op_sel:[1,0,1] op_sel_hi:[1,0,1]
  v_fma_mix_f32 v171, v176, 1.0, v177 op_sel:[1,0,1] op_sel_hi:[1,0,1]
  v_max3_u32 v27, v124, v126, v128
  v_max3_u32 v27, v27, v130, v132
  v_max3_u32 v27, v27, v133, v134
  v_max3_u32 v27, v27, v135, v135
  v_cmp_eq_u32 vcc, -1, v27
  s_nop 1
  s_cbranch_vccnz sr_136
  s_branch sj_124
fx_126:
  s_cmp_eq_u32 s81, 1
  s_cbranch_scc1 fk_127
  s_mov_b32 s81, 1
  v_max3_f32 v164, v166, v167, v168
  v_max3_f32 v165, v169, v170, v171
  v_max_f32 v164, v164, v165
  s_nop 1
  v_max_f32_dpp v164, v164, v164 row_ror:8 row_mask:0xf bank_mask:0xf
  v_mov_b32 v165, v164
  s_nop 1
  v_permlane32_swap_b32 v164, v165
  v_max_f32 v164, v164, v165
  v_mov_b32 v165, v164
  s_nop 1
  v_permlane16_swap_b32 v164, v165
  v_max_f32 v164, v164, v165
  v_sub_f32 v166, v166, v164
  v_sub_f32 v167, v167, v164
  v_sub_f32 v168, v168, v164
  v_sub_f32 v169, v169, v164
  v_sub_f32 v170, v170, v164
  v_sub_f32 v171, v171, v164
  s_branch ex_125
p2_132:
  s_mov_b32 s54, 0
  buffer_load_dwordx4 v[68:71], v16, s[4:7], s60 offen sc1
  s_waitcnt vmcnt(1)
  v_mfma_f32_16x16x32_f16 v[120:123], v[44:47], v[72:75], 0
  v_bitop3_b32 v27, v72, s61, 1 bitop3:0x28
  v_cmp_ne_u32 vcc, 0, v27
  s_nop 1
  s_cbranch_vccz pg_131
  buffer_load_dwordx4 v[72:75], v16, s[4:7], s60 offen sc1
pp_130:
  s_waitcnt vmcnt(1)
  v_mfma_f32_16x16x32_f16 v[120:123], v[44:47], v[68:71], 0
  v_bitop3_b32 v27, v68, s61, 1 bitop3:0x28
  v_cmp_ne_u32 vcc, 0, v27
  s_nop 1
  s_cbranch_vccz pg_131
  buffer_load_dwordx4 v[68:71], v16, s[4:7], s60 offen sc1
  s_waitcnt vmcnt(1)
  v_mfma_f32_16x16x32_f16 v[120:123], v[44:47], v[72:75], 0
  v_bitop3_b32 v27, v72, s61, 1 bitop3:0x28
  v_cmp_ne_u32 vcc, 0, v27
  s_nop 1
  s_cbranch_vccz pg_131
  buffer_load_dwordx4 v[72:75], v16, s[4:7], s60 offen sc1
  s_add_u32 s54, s54, 1
  s_cmp_gt_u32 s54, 131072
  s_cbranch_scc1 end0
  s_branch pp_130
last_121:
  v_smfmac_f32_16x16x64_bf16 v[96:99], v[48:51], a[0:7], v22
  v_smfmac_f32_16x16x64_bf16 v[100:103], v[48:51], a[80:87], v22
  v_smfmac_f32_16x16x64_bf16 v[96:99], v[52:55], a[8:15], v22
  v_smfmac_f32_16x16x64_bf16 v[100:103], v[52:55], a[88:95], v22
  v_smfmac_f32_16x16x64_bf16 v[96:99], v[56:59], a[16:23], v22
  v_smfmac_f32_16x16x64_bf16 v[100:103], v[56:59], a[96:103], v22
  v_smfmac_f32_16x16x64_bf16 v[96:99], v[60:63], a[24:31], v22
  v_smfmac_f32_16x16x64_bf16 v[96:99], v[64:67], a[32:39], v22
  v_smfmac_f32_16x16x64_bf16 v[96:99], v[68:71], a[40:47], v22
  v_smfmac_f32_16x16x64_bf16 v[96:99], v[72:75], a[48:55], v22
  v_smfmac_f32_16x16x64_bf16 v[96:99], v[76:79], a[56:63], v22
  v_smfmac_f32_16x16x64_bf16 v[96:99], v[80:83], a[64:71], v22
  v_smfmac_f32_16x16x64_bf16 v[96:99], v[84:87], a[72:79], v22
  v_smfmac_f32_16x16x64_bf16 v[100:103], v[60:63], a[104:111], v22
  v_smfmac_f32_16x16x64_bf16 v[100:103], v[64:67], a[112:119], v22
  v_smfmac_f32_16x16x64_bf16 v[100:103], v[68:71], a[120:127], v22
  v_smfmac_f32_16x16x64_bf16 v[100:103], v[72:75], a[128:135], v22
  v_smfmac_f32_16x16x64_bf16 v[100:103], v[76:79], a[136:143], v22
  v_smfmac_f32_16x16x64_bf16 v[100:103], v[80:83], a[144:151], v22
  v_smfmac_f32_16x16x64_bf16 v[100:103], v[84:87], a[152:159], v22
  s_nop 7
  v_permlane32_swap_b32 v96, v100
  v_permlane32_swap_b32 v97, v101
  v_permlane32_swap_b32 v98, v102
  v_permlane32_swap_b32 v99, v103
  v_pk_add_f32 v[96:97], v[96:97], v[100:101]
  v_pk_add_f32 v[98:99], v[98:99], v[102:103]
  v_cvt_pk_bf16_f32 v182, v96, v97
  v_cvt_pk_bf16_f32 v183, v98, v99
  v_min_u32 v182, -2, v182
  ds_write_b64 v26, v[182:183]
  s_waitcnt lgkmcnt(0)
  s_barrier
  s_branch chain_done
E_27:
  v_add_u32 v190, 3072, v4
  s_waitcnt vmcnt(0)
  ds_write_b128 v190, v[60:63] offset:0
  ds_write_b128 v190, v[64:67] offset:1024
  ds_write_b128 v190, v[68:71] offset:2048
  s_add_u32 m0, s74, 2048
  s_add_u32 s21, s79, 65536
  buffer_load_dwordx4 v4, s[16:19], s21 offen offset:1024 sc1 lds
  s_add_u32 m0, s74, 6144
  s_add_u32 s21, s79, 196608
  buffer_load_dwordx4 v4, s[16:19], s21 offen offset:0 sc1 lds
  s_xor_b32 s74, s74, 16384
  s_add_u32 s73, s73, 2097152
  s_xor_b32 s73, s73, 8192
  s_add_u32 s79, s79, 2097152
  s_xor_b32 s79, s79, 8192
  s_add_u32 s21, s72, 524288
  s_xor_b32 s72, s72, s21
  s_lshr_b32 s72, s72, 8
  s_and_b32 s72, s72, 8192
  s_xor_b32 s72, s72, s21
  s_branch mo_143
  .p2align 3
top_138:
  s_waitcnt vmcnt(2)
  ds_write_b128 v190, v[60:63] offset:0
  v_cmp_eq_u32 s[22:23], -1, v60
  s_waitcnt vmcnt(1)
  ds_write_b128 v190, v[64:67] offset:1024
  v_cmp_eq_u32 s[98:99], -1, v64
  s_waitcnt vmcnt(0)
  ds_write_b128 v190, v[68:71] offset:2048
  v_cmp_eq_u32 s[100:101], -1, v68
  s_or_b64 vcc, s[22:23], s[98:99]
  s_or_b64 vcc, vcc, s[100:101]
  s_cbranch_scc1 mr_139
mo_143:
  s_waitcnt lgkmcnt(0)
  s_barrier
  ds_read_b128 v[48:51], v4 offset:0
  ds_read_b128 v[52:55], v4 offset:1024
  v_smfmac_f32_16x16x64_bf16 v[92:95], v[60:63], v[200:207], v22
  ds_read_b128 v[56:59], v4 offset:2048
  v_smfmac_f32_16x16x64_bf16 v[88:91], v[60:63], a[184:191], v22
  ds_read_b128 v[72:75], v4 offset:6144
  v_smfmac_f32_16x16x64_bf16 v[92:95], v[64:67], v[208:215], v22
  ds_read_b128 v[76:79], v4 offset:7168
  v_smfmac_f32_16x16x64_bf16 v[88:91], v[64:67], a[192:199], v22
  ds_read_b128 v[80:83], v4 offset:8192
  v_smfmac_f32_16x16x64_bf16 v[92:95], v[68:71], v[216:223], v22
  ds_read_b128 v[84:87], v4 offset:9216
  v_smfmac_f32_16x16x64_bf16 v[88:91], v[68:71], a[200:207], v22
  s_waitcnt lgkmcnt(6)
  v_smfmac_f32_16x16x64_bf16 v[92:95], v[48:51], a[240:247], v22
  v_smfmac_f32_16x16x64_bf16 v[88:91], v[48:51], a[160:167], v22
  s_waitcnt lgkmcnt(5)
  v_smfmac_f32_16x16x64_bf16 v[92:95], v[52:55], a[248:255], v22
  s_waitcnt lgkmcnt(4)
  v_smfmac_f32_16x16x64_bf16 v[92:95], v[56:59], v[192:199], v22
  s_waitcnt lgkmcnt(3)
  v_smfmac_f32_16x16x64_bf16 v[92:95], v[72:75], v[224:231], v22
  s_waitcnt lgkmcnt(2)
  v_smfmac_f32_16x16x64_bf16 v[92:95], v[76:79], v[232:239], v22
  s_waitcnt lgkmcnt(1)
  v_smfmac_f32_16x16x64_bf16 v[92:95], v[80:83], v[240:247], v22
  s_waitcnt lgkmcnt(0)
  v_smfmac_f32_16x16x64_bf16 v[92:95], v[84:87], v[248:255], v22
  v_smfmac_f32_16x16x64_bf16 v[88:91], v[52:55], a[168:175], v22
  v_smfmac_f32_16x16x64_bf16 v[88:91], v[56:59], a[176:183], v22
  v_smfmac_f32_16x16x64_bf16 v[88:91], v[72:75], a[208:215], v22
  v_permlane32_swap_b32 v92, v93
  v_smfmac_f32_16x16x64_bf16 v[88:91], v[76:79], a[216:223], v22
  v_permlane32_swap_b32 v94, v95
  v_smfmac_f32_16x16x64_bf16 v[88:91], v[80:83], a[224:231], v22
  v_permlane32_swap_b32 v93, v92
  v_smfmac_f32_16x16x64_bf16 v[88:91], v[84:87], a[232:239], v22
  v_permlane32_swap_b32 v95, v94
  v_pk_mul_f32 v[120:121], v[92:93], v[24:25] op_sel:[1,0] op_sel_hi:[0,1]
  v_pk_mul_f32 v[122:123], v[94:95], v[24:25] op_sel:[1,0] op_sel_hi:[0,1]
  s_nop 4
  v_pk_fma_f32 v[88:89], v[88:89], v[24:25], v[120:121]
  v_pk_fma_f32 v[90:91], v[90:91], v[24:25], v[122:123]
  v_cvt_pk_bf16_f32 v120, v88, v89
  v_cvt_pk_bf16_f32 v121, v90, v91
  ds_write_b64 v6, v[120:121]
  v_cmp_u_f32 vcc, v88, v89
  v_cmp_u_f32 s[22:23], v90, v91
  s_nop 1
  s_or_b64 vcc, vcc, s[22:23]
  s_cbranch_vccnz mn_140
mk_141:
  s_waitcnt lgkmcnt(0)
  s_barrier
  ds_read_b64_tr_b16 v[104:105], v7 offset:0
  ds_read_b64_tr_b16 v[106:107], v7 offset:768
  ds_read_b64_tr_b16 v[108:109], v7 offset:1536
  ds_read_b64 v[140:141], v11
  s_cmp_eq_u32 s52, 63
  s_cbranch_scc1 last_142
  s_waitcnt lgkmcnt(2)
  v_mfma_f32_16x16x32_bf16 v[120:123], v[112:115], v[104:107], 0
  s_waitcnt lgkmcnt(1)
  v_mfma_f32_16x16x32_bf16 v[120:123], v[116:119], v[108:111], v[120:123]
  s_mov_b64 exec, s[64:65]
  s_nop 6
  v_cvt_pk_f16_f32 v120, v120, v121
  v_cvt_pk_f16_f32 v121, v122, v123
  buffer_store_dwordx2 v[120:121], v8, s[8:11], s56 offen sc1
  s_mov_b64 exec, -1
  s_sleep 3
  s_nop 1
  v_smfmac_f32_16x16x64_bf16 v[96:99], v[48:51], a[0:7], v22
  v_smfmac_f32_16x16x64_bf16 v[100:103], v[48:51], a[80:87], v22
  v_smfmac_f32_16x16x64_bf16 v[96:99], v[52:55], a[8:15], v22
  v_smfmac_f32_16x16x64_bf16 v[100:103], v[52:55], a[88:95], v22
  v_smfmac_f32_16x16x64_bf16 v[96:99], v[56:59], a[16:23], v22
  v_smfmac_f32_16x16x64_bf16 v[100:103], v[56:59], a[96:103], v22
  v_smfmac_f32_16x16x64_bf16 v[96:99], v[60:63], a[24:31], v22
  v_smfmac_f32_16x16x64_bf16 v[96:99], v[64:67], a[32:39], v22
  v_smfmac_f32_16x16x64_bf16 v[96:99], v[68:71], a[40:47], v22
  v_smfmac_f32_16x16x64_bf16 v[96:99], v[72:75], a[48:55], v22
  v_smfmac_f32_16x16x64_bf16 v[96:99], v[76:79], a[56:63], v22
  buffer_load_dwordx4 v[124:127], v9, s[8:11], s56 offen sc1
  v_smfmac_f32_16x16x64_bf16 v[96:99], v[80:83], a[64:71], v22
  buffer_load_dwordx4 v[128:131], v9, s[8:11], s56 offen offset:1024 sc1
  v_smfmac_f32_16x16x64_bf16 v[96:99], v[84:87], a[72:79], v22
  buffer_load_dwordx4 v[132:135], v10, s[8:11], s56 offen sc1
  v_smfmac_f32_16x16x64_bf16 v[100:103], v[60:63], a[104:111], v22
  v_smfmac_f32_16x16x64_bf16 v[100:103], v[64:67], a[112:119], v22
  v_smfmac_f32_16x16x64_bf16 v[100:103], v[68:71], a[120:127], v22
  v_smfmac_f32_16x16x64_bf16 v[100:103], v[72:75], a[128:135], v22
  v_cvt_pk_bf16_f32 v136, v96, v97
  v_smfmac_f32_16x16x64_bf16 v[100:103], v[76:79], a[136:143], v22
  v_cvt_pk_bf16_f32 v137, v98, v99
  v_smfmac_f32_16x16x64_bf16 v[100:103], v[80:83], a[144:151], v22
  v_smfmac_f32_16x16x64_bf16 v[100:103], v[84:87], a[152:159], v22
  s_waitcnt vmcnt(2)
  v_pk_add_f16 v172, v124, v126
  v_pk_add_f16 v173, v125, v127
  s_waitcnt vmcnt(1)
  v_pk_add_f16 v174, v128, v130
  v_pk_add_f16 v175, v129, v131
  v_fma_mix_f32 v166, v172, 1.0, v174 op_sel:[0,0,0] op_sel_hi:[1,0,1]
  v_fma_mix_f32 v168, v173, 1.0, v175 op_sel:[0,0,0] op_sel_hi:[1,0,1]
  s_waitcnt vmcnt(0)
  v_pk_add_f16 v176, v132, v133
  v_pk_add_f16 v177, v134, v135
  v_fma_mix_f32 v170, v176, 1.0, v177 op_sel:[0,0,0] op_sel_hi:[1,0,1]
  v_fma_mix_f32 v167, v172, 1.0, v174 op_sel:[1,0,1] op_sel_hi:[1,0,1]
  v_cmp_u_f32 vcc, v166, v170
  v_fma_mix_f32 v169, v173, 1.0, v175 op_sel:[1,0,1] op_sel_hi:[1,0,1]
  v_fma_mix_f32 v171, v176, 1.0, v177 op_sel:[1,0,1] op_sel_hi:[1,0,1]
  v_cvt_pk_bf16_f32 v138, v100, v101
  s_cbranch_vccnz sr_144
sj_145:
ex_146:
  v_exp_f32 v172, v166
  v_exp_f32 v173, v167
  v_exp_f32 v174, v168
  v_cvt_pk_bf16_f32 v156, v172, v173
  v_exp_f32 v175, v169
  v_exp_f32 v176, v170
  v_cvt_pk_bf16_f32 v157, v174, v175
  v_mov_b32_dpp v158, v156 row_ror:8 row_mask:0xf bank_mask:0xf
  v_exp_f32 v177, v171
  v_mov_b32_dpp v159, v157 row_ror:8 row_mask:0xf bank_mask:0xf
  v_cvt_pk_bf16_f32 v160, v176, v177
  v_cvt_pk_bf16_f32 v139, v102, v103
  v_mfma_f32_16x16x32_bf16 v[178:181], v[152:155], v[156:159], 0
  s_waitcnt lgkmcnt(0)
  v_mov_b32_dpp v161, v160 row_ror:8 row_mask:0xf bank_mask:0xf
  v_mfma_f32_16x16x32_bf16 v[182:185], v[144:147], v[156:159], 0
  s_nop 0
  v_mfma_f32_16x16x32_bf16 v[178:181], v[140:143], v[160:163], v[178:181]
  v_mfma_f32_16x16x32_bf16 v[182:185], v[136:139], v[160:163], v[182:185]
  v_mfma_f32_16x16x32_bf16 v[186:189], v[148:151], v[156:159], 0
  v_mfma_f32_16x16x32_bf16 v[186:189], v[138:141], v[160:163], v[186:189]
  s_mov_b64 exec, s[62:63]
  v_rcp_f32 v164, v180
  s_nop 0
  v_pk_mul_f32 v[178:179], v[178:179], v[164:165] op_sel_hi:[1,0]
  v_pk_mul_f32 v[182:183], v[182:183], v[164:165] op_sel_hi:[1,0]
  v_pk_mul_f32 v[184:185], v[184:185], v[164:165] op_sel_hi:[1,0]
  v_cvt_pk_f16_f32 v64, v178, v179
  v_cvt_pk_f16_f32 v60, v182, v183
  v_pk_mul_f32 v[186:187], v[186:187], v[164:165] op_sel_hi:[1,0]
  v_pk_mul_f32 v[188:189], v[188:189], v[164:165] op_sel_hi:[1,0]
  v_cvt_pk_f16_f32 v61, v184, v185
  v_cvt_pk_f16_f32 v62, v186, v187
  v_cvt_pk_f16_f32 v63, v188, v189
  ds_write_b128 v13, v[60:63]
  ds_write_b32 v14, v64
  v_add_f32 v165, v164, v180
  v_cmp_ngt_f32 vcc, s80, v165
  s_mov_b64 exec, -1
  s_nop 0
  s_cbranch_vccnz fx_147
fk_148:
  s_waitcnt lgkmcnt(0)
  s_barrier
  s_add_u32 m0, s74, 2048
  s_add_u32 s21, s79, 65536
  buffer_load_dwordx4 v4, s[16:19], s21 offen offset:1024 sc1 lds
  s_add_u32 m0, s74, 6144
  s_add_u32 s21, s79, 196608
  buffer_load_dwordx4 v4, s[16:19], s21 offen offset:0 sc1 lds
  s_xor_b32 s74, s74, 16384
  s_add_u32 s73, s73, 2097152
  s_xor_b32 s73, s73, 8192
  s_add_u32 s79, s79, 2097152
  s_xor_b32 s79, s79, 8192
  s_add_u32 s21, s72, 524288
  s_xor_b32 s72, s72, s21
  s_lshr_b32 s72, s72, 8
  s_and_b32 s72, s72, 8192
  s_xor_b32 s72, s72, s21
  s_nop 15
  s_nop 3
  v_permlane32_swap_b32 v96, v100
  v_permlane32_swap_b32 v97, v101
  v_permlane32_swap_b32 v98, v102
  v_permlane32_swap_b32 v99, v103
  v_pk_add_f32 v[96:97], v[96:97], v[100:101]
  v_pk_add_f32 v[98:99], v[98:99], v[102:103]
  v_cvt_pk_bf16_f32 v182, v96, v97
  v_cvt_pk_bf16_f32 v183, v98, v99
  v_min_u32 v182, -2, v182
  ds_write_b64 v26, v[182:183]
  ds_read_b128 v[144:147], v18
  ds_read_b128 v[148:151], v18 offset:1024
  ds_read_b128 v[152:155], v19
  ds_read_b128 v[112:115], v20
  ds_read_b64 v[116:117], v21
  v_xor_b32 v18, 16384, v18
  v_xor_b32 v19, 16384, v19
  v_xor_b32 v20, 16384, v20
  v_xor_b32 v21, 16384, v21
  v_mov_b32 v88, 0
  v_mov_b32 v89, 0
  v_mov_b32 v90, 0
  v_mov_b32 v91, 0
  v_mov_b32 v92, 0
  v_mov_b32 v93, 0
  v_mov_b32 v94, 0
  v_mov_b32 v95, 0
  v_mov_b32 v96, 0
  v_mov_b32 v97, 0
  v_mov_b32 v98, 0
  v_mov_b32 v99, 0
  v_mov_b32 v100, 0
  v_mov_b32 v101, 0
  v_mov_b32 v102, 0
  v_mov_b32 v103, 0
  s_mov_b32 s81, 0
  s_waitcnt lgkmcnt(0)
  s_barrier
  s_mov_b64 exec, s[64:65]
  buffer_store_dwordx2 v[28:29], v8, s[8:11], s57 offen sc1
  s_mov_b64 exec, s[62:63]
  buffer_store_dword v28, v17, s[8:11], s59 offen sc1
  s_mov_b64 exec, -1
  s_sleep 6
  s_nop 3
  buffer_load_dwordx4 v[68:71], v16, s[4:7], s60 offen sc1
  s_sleep 3
  s_nop 1
  buffer_load_dwordx4 v[72:75], v16, s[4:7], s60 offen sc1
  s_waitcnt vmcnt(1)
  v_mfma_f32_16x16x32_f16 v[120:123], v[44:47], v[68:71], 0
  v_bitop3_b32 v27, v68, s61, 1 bitop3:0x28
  v_cmp_ne_u32 vcc, 0, v27
  s_nop 1
  s_cbranch_vccnz p2_153
  s_nop 2
pg_152:
  v_add_f32_dpp v120, v120, v120 row_ror:8 row_mask:0xf bank_mask:0xf
  v_add_f32_dpp v121, v121, v121 row_ror:8 row_mask:0xf bank_mask:0xf
  s_mov_b64 exec, s[62:63]
  v_cvt_pk_bf16_f32 v120, v120, v121
  v_min_u32 v120, -2, v120
  buffer_store_dword v120, v17, s[8:11], s55 offen sc1
  s_mov_b64 exec, -1
nt_149:
  s_barrier
  s_mov_b32 s58, s55
  s_add_u32 s52, s52, 1
  s_and_b32 s21, s52, 3
  s_mul_i32 s56, s21, 122880
  s_add_u32 s21, s52, 1
  s_and_b32 s21, s21, 3
  s_mul_i32 s55, s21, 122880
  s_add_u32 s55, s55, s75
  s_add_u32 s21, s52, 2
  s_and_b32 s21, s21, 3
  s_mul_i32 s57, s21, 122880
  s_add_u32 s21, s52, 3
  s_and_b32 s21, s21, 3
  s_mul_i32 s59, s21, 122880
  s_add_u32 s59, s59, s75
  s_bfe_u32 s61, s52, 0x10002
  s_and_b32 s21, s52, 3
  s_lshl_b32 s60, s21, 18
  s_mov_b32 s54, 0
  s_sleep 3
  s_nop 2
  buffer_load_dwordx4 v[60:63], v190, s[8:11], s58 offen offset:0 sc1
  buffer_load_dwordx4 v[64:67], v190, s[8:11], s58 offen offset:1024 sc1
  buffer_load_dwordx4 v[68:71], v190, s[8:11], s58 offen offset:2048 sc1
  s_branch top_138
mr_139:
  s_mov_b64 exec, s[22:23]
  s_cbranch_execz ms_154
  buffer_load_dwordx4 v[60:63], v190, s[8:11], s58 offen offset:0 sc1
ms_154:
  s_mov_b64 exec, s[98:99]
  s_cbranch_execz ms_155
  buffer_load_dwordx4 v[64:67], v190, s[8:11], s58 offen offset:1024 sc1
ms_155:
  s_mov_b64 exec, s[100:101]
  s_cbranch_execz ms_156
  buffer_load_dwordx4 v[68:71], v190, s[8:11], s58 offen offset:2048 sc1
ms_156:
  s_add_u32 s54, s54, 1
  s_cmp_gt_u32 s54, 131072
  s_cbranch_scc1 end0
  s_waitcnt vmcnt(0)
  s_mov_b64 exec, s[22:23]
  ds_write_b128 v190, v[60:63] offset:0
  v_cmp_eq_u32 s[22:23], -1, v60
  s_mov_b64 exec, s[98:99]
  ds_write_b128 v190, v[64:67] offset:1024
  v_cmp_eq_u32 s[98:99], -1, v64
  s_mov_b64 exec, s[100:101]
  ds_write_b128 v190, v[68:71] offset:2048
  v_cmp_eq_u32 s[100:101], -1, v68
  s_mov_b64 exec, -1
  s_or_b64 vcc, s[22:23], s[98:99]
  s_or_b64 vcc, vcc, s[100:101]
  s_cbranch_scc1 mr_139
  s_branch mo_143
mn_140:
  v_max3_u32 v27, v48, v49, v50
  v_max3_u32 v27, v27, v51, v52
  v_max3_u32 v27, v27, v53, v54
  v_max3_u32 v27, v27, v55, v56
  v_max3_u32 v27, v27, v57, v58
  v_max3_u32 v27, v27, v59, v60
  v_max3_u32 v27, v27, v61, v62
  v_max3_u32 v27, v27, v63, v64
  v_max3_u32 v27, v27, v65, v66
  v_max3_u32 v27, v27, v67, v68
  v_max3_u32 v27, v27, v69, v70
  v_max3_u32 v27, v27, v71, v72
  v_max3_u32 v27, v27, v73, v74
  v_max3_u32 v27, v27, v75, v76
  v_max3_u32 v27, v27, v77, v78
  v_max3_u32 v27, v27, v79, v80
  v_max3_u32 v27, v27, v81, v82
  v_max3_u32 v27, v27, v83, v84
  v_max3_u32 v27, v27, v85, v86
  v_max3_u32 v27, v27, v87, v87
  v_cmp_eq_u32 vcc, -1, v27
  s_cmp_eq_u32 s52, 0
  s_cbranch_scc1 mk_141
  s_cbranch_vccz mk_141
  s_waitcnt lgkmcnt(0)
  s_barrier
  s_nop 7
  v_mov_b32 v88, 0
  v_mov_b32 v89, 0
  v_mov_b32 v90, 0
  v_mov_b32 v91, 0
  v_mov_b32 v92, 0
  v_mov_b32 v93, 0
  v_mov_b32 v94, 0
  v_mov_b32 v95, 0
  v_mov_b32 v96, 0
  v_mov_b32 v97, 0
  v_mov_b32 v98, 0
  v_mov_b32 v99, 0
  v_mov_b32 v100, 0
  v_mov_b32 v101, 0
  v_mov_b32 v102, 0
  v_mov_b32 v103, 0
  s_mov_b64 s[22:23], -1
  s_mov_b64 s[98:99], -1
  s_mov_b64 s[100:101], -1
  s_branch mr_139
sr_144:
  s_mov_b32 s54, 0
sr_157:
  s_mov_b64 exec, vcc
  buffer_load_dwordx4 v[124:127], v9, s[8:11], s56 offen sc1
  buffer_load_dwordx4 v[128:131], v9, s[8:11], s56 offen offset:1024 sc1
  buffer_load_dwordx4 v[132:135], v10, s[8:11], s56 offen sc1
  s_mov_b64 exec, -1
  s_add_u32 s54, s54, 1
  s_cmp_gt_u32 s54, 131072
  s_cbranch_scc1 end0
  s_and_b32 s21, s54, 31
  s_cbranch_scc0 sr_158
  s_waitcnt vmcnt(0)
  v_pk_add_f16 v172, v124, v126
  v_pk_add_f16 v173, v125, v127
  v_pk_add_f16 v174, v128, v130
  v_pk_add_f16 v175, v129, v131
  v_fma_mix_f32 v166, v172, 1.0, v174 op_sel:[0,0,0] op_sel_hi:[1,0,1]
  v_fma_mix_f32 v168, v173, 1.0, v175 op_sel:[0,0,0] op_sel_hi:[1,0,1]
  v_pk_add_f16 v176, v132, v133
  v_pk_add_f16 v177, v134, v135
  v_add_f32 v27, v166, v168
  v_fma_mix_f32 v170, v176, 1.0, v177 op_sel:[0,0,0] op_sel_hi:[1,0,1]
  v_fma_mix_f32 v167, v172, 1.0, v174 op_sel:[1,0,1] op_sel_hi:[1,0,1]
  v_cmp_u_f32 vcc, v27, v170
  v_fma_mix_f32 v169, v173, 1.0, v175 op_sel:[1,0,1] op_sel_hi:[1,0,1]
  v_fma_mix_f32 v171, v176, 1.0, v177 op_sel:[1,0,1] op_sel_hi:[1,0,1]
  s_cbranch_vccnz sr_157
  s_branch sj_145
sr_158:
  s_waitcnt vmcnt(0)
  v_pk_add_f16 v172, v124, v126
  v_pk_add_f16 v173, v125, v127
  v_pk_add_f16 v174, v128, v130
  v_pk_add_f16 v175, v129, v131
  v_fma_mix_f32 v166, v172, 1.0, v174 op_sel:[0,0,0] op_sel_hi:[1,0,1]
  v_fma_mix_f32 v168, v173, 1.0, v175 op_sel:[0,0,0] op_sel_hi:[1,0,1]
  v_pk_add_f16 v176, v132, v133
  v_pk_add_f16 v177, v134, v135
  v_add_f32 v27, v166, v168
  v_fma_mix_f32 v170, v176, 1.0, v177 op_sel:[0,0,0] op_sel_hi:[1,0,1]
  v_fma_mix_f32 v167, v172, 1.0, v174 op_sel:[1,0,1] op_sel_hi:[1,0,1]
  v_cmp_u_f32 vcc, v27, v170
  v_fma_mix_f32 v169, v173, 1.0, v175 op_sel:[1,0,1] op_sel_hi:[1,0,1]
  v_fma_mix_f32 v171, v176, 1.0, v177 op_sel:[1,0,1] op_sel_hi:[1,0,1]
  v_max3_u32 v27, v124, v126, v128
  v_max3_u32 v27, v27, v130, v132
  v_max3_u32 v27, v27, v133, v134
  v_max3_u32 v27, v27, v135, v135
  v_cmp_eq_u32 vcc, -1, v27
  s_nop 1
  s_cbranch_vccnz sr_157
  s_branch sj_145
fx_147:
  s_cmp_eq_u32 s81, 1
  s_cbranch_scc1 fk_148
  s_mov_b32 s81, 1
  v_max3_f32 v164, v166, v167, v168
  v_max3_f32 v165, v169, v170, v171
  v_max_f32 v164, v164, v165
  s_nop 1
  v_max_f32_dpp v164, v164, v164 row_ror:8 row_mask:0xf bank_mask:0xf
  v_mov_b32 v165, v164
  s_nop 1
  v_permlane32_swap_b32 v164, v165
  v_max_f32 v164, v164, v165
  v_mov_b32 v165, v164
  s_nop 1
  v_permlane16_swap_b32 v164, v165
  v_max_f32 v164, v164, v165
  v_sub_f32 v166, v166, v164
  v_sub_f32 v167, v167, v164
  v_sub_f32 v168, v168, v164
  v_sub_f32 v169, v169, v164
  v_sub_f32 v170, v170, v164
  v_sub_f32 v171, v171, v164
  s_branch ex_146
p2_153:
  s_mov_b32 s54, 0
  buffer_load_dwordx4 v[68:71], v16, s[4:7], s60 offen sc1
  s_waitcnt vmcnt(1)
  v_mfma_f32_16x16x32_f16 v[120:123], v[44:47], v[72:75], 0
  v_bitop3_b32 v27, v72, s61, 1 bitop3:0x28
  v_cmp_ne_u32 vcc, 0, v27
  s_nop 1
  s_cbranch_vccz pg_152
  buffer_load_dwordx4 v[72:75], v16, s[4:7], s60 offen sc1
pp_151:
  s_waitcnt vmcnt(1)
  v_mfma_f32_16x16x32_f16 v[120:123], v[44:47], v[68:71], 0
  v_bitop3_b32 v27, v68, s61, 1 bitop3:0x28
  v_cmp_ne_u32 vcc, 0, v27
  s_nop 1
  s_cbranch_vccz pg_152
  buffer_load_dwordx4 v[68:71], v16, s[4:7], s60 offen sc1
  s_waitcnt vmcnt(1)
  v_mfma_f32_16x16x32_f16 v[120:123], v[44:47], v[72:75], 0
  v_bitop3_b32 v27, v72, s61, 1 bitop3:0x28
  v_cmp_ne_u32 vcc, 0, v27
  s_nop 1
  s_cbranch_vccz pg_152
  buffer_load_dwordx4 v[72:75], v16, s[4:7], s60 offen sc1
  s_add_u32 s54, s54, 1
  s_cmp_gt_u32 s54, 131072
  s_cbranch_scc1 end0
  s_branch pp_151
last_142:
  v_smfmac_f32_16x16x64_bf16 v[96:99], v[48:51], a[0:7], v22
  v_smfmac_f32_16x16x64_bf16 v[100:103], v[48:51], a[80:87], v22
  v_smfmac_f32_16x16x64_bf16 v[96:99], v[52:55], a[8:15], v22
  v_smfmac_f32_16x16x64_bf16 v[100:103], v[52:55], a[88:95], v22
  v_smfmac_f32_16x16x64_bf16 v[96:99], v[56:59], a[16:23], v22
  v_smfmac_f32_16x16x64_bf16 v[100:103], v[56:59], a[96:103], v22
  v_smfmac_f32_16x16x64_bf16 v[96:99], v[60:63], a[24:31], v22
  v_smfmac_f32_16x16x64_bf16 v[96:99], v[64:67], a[32:39], v22
  v_smfmac_f32_16x16x64_bf16 v[96:99], v[68:71], a[40:47], v22
  v_smfmac_f32_16x16x64_bf16 v[96:99], v[72:75], a[48:55], v22
  v_smfmac_f32_16x16x64_bf16 v[96:99], v[76:79], a[56:63], v22
  v_smfmac_f32_16x16x64_bf16 v[96:99], v[80:83], a[64:71], v22
  v_smfmac_f32_16x16x64_bf16 v[96:99], v[84:87], a[72:79], v22
  v_smfmac_f32_16x16x64_bf16 v[100:103], v[60:63], a[104:111], v22
  v_smfmac_f32_16x16x64_bf16 v[100:103], v[64:67], a[112:119], v22
  v_smfmac_f32_16x16x64_bf16 v[100:103], v[68:71], a[120:127], v22
  v_smfmac_f32_16x16x64_bf16 v[100:103], v[72:75], a[128:135], v22
  v_smfmac_f32_16x16x64_bf16 v[100:103], v[76:79], a[136:143], v22
  v_smfmac_f32_16x16x64_bf16 v[100:103], v[80:83], a[144:151], v22
  v_smfmac_f32_16x16x64_bf16 v[100:103], v[84:87], a[152:159], v22
  s_nop 7
  v_permlane32_swap_b32 v96, v100
  v_permlane32_swap_b32 v97, v101
  v_permlane32_swap_b32 v98, v102
  v_permlane32_swap_b32 v99, v103
  v_pk_add_f32 v[96:97], v[96:97], v[100:101]
  v_pk_add_f32 v[98:99], v[98:99], v[102:103]
  v_cvt_pk_bf16_f32 v182, v96, v97
  v_cvt_pk_bf16_f32 v183, v98, v99
  v_min_u32 v182, -2, v182
  ds_write_b64 v26, v[182:183]
  s_waitcnt lgkmcnt(0)
  s_barrier
  s_branch chain_done
E_29:
  v_add_u32 v190, 6144, v4
  s_waitcnt vmcnt(0)
  ds_write_b128 v190, v[72:75] offset:0
  ds_write_b128 v190, v[76:79] offset:1024
  ds_write_b128 v190, v[80:83] offset:2048
  s_add_u32 m0, s74, 4096
  s_add_u32 s21, s79, 131072
  buffer_load_dwordx4 v4, s[16:19], s21 offen offset:0 sc1 lds
  s_add_u32 m0, s74, 6144
  s_add_u32 s21, s79, 196608
  buffer_load_dwordx4 v4, s[16:19], s21 offen offset:1024 sc1 lds
  s_xor_b32 s74, s74, 16384
  s_add_u32 s73, s73, 2097152
  s_xor_b32 s73, s73, 8192
  s_add_u32 s79, s79, 2097152
  s_xor_b32 s79, s79, 8192
  s_add_u32 s21, s72, 524288
  s_xor_b32 s72, s72, s21
  s_lshr_b32 s72, s72, 8
  s_and_b32 s72, s72, 8192
  s_xor_b32 s72, s72, s21
  s_branch mo_164
  .p2align 3
top_159:
  s_waitcnt vmcnt(2)
  ds_write_b128 v190, v[72:75] offset:0
  v_cmp_eq_u32 s[22:23], -1, v72
  s_waitcnt vmcnt(1)
  ds_write_b128 v190, v[76:79] offset:1024
  v_cmp_eq_u32 s[98:99], -1, v76
  s_waitcnt vmcnt(0)
  ds_write_b128 v190, v[80:83] offset:2048
  v_cmp_eq_u32 s[100:101], -1, v80
  s_or_b64 vcc, s[22:23], s[98:99]
  s_or_b64 vcc, vcc, s[100:101]
  s_cbranch_scc1 mr_160
mo_164:
  s_waitcnt lgkmcnt(0)
  s_barrier
  ds_read_b128 v[48:51], v4 offset:0
  ds_read_b128 v[52:55], v4 offset:1024
  v_smfmac_f32_16x16x64_bf16 v[92:95], v[72:75], v[224:231], v22
  ds_read_b128 v[56:59], v4 offset:2048
  v_smfmac_f32_16x16x64_bf16 v[88:91], v[72:75], a[208:215], v22
  ds_read_b128 v[60:63], v4 offset:3072
  v_smfmac_f32_16x16x64_bf16 v[92:95], v[76:79], v[232:239], v22
  ds_read_b128 v[64:67], v4 offset:4096
  v_smfmac_f32_16x16x64_bf16 v[88:91], v[76:79], a[216:223], v22
  ds_read_b128 v[68:71], v4 offset:5120
  v_smfmac_f32_16x16x64_bf16 v[92:95], v[80:83], v[240:247], v22
  ds_read_b128 v[84:87], v4 offset:9216
  v_smfmac_f32_16x16x64_bf16 v[88:91], v[80:83], a[224:231], v22
  s_waitcnt lgkmcnt(6)
  v_smfmac_f32_16x16x64_bf16 v[92:95], v[48:51], a[240:247], v22
  v_smfmac_f32_16x16x64_bf16 v[88:91], v[48:51], a[160:167], v22
  s_waitcnt lgkmcnt(5)
  v_smfmac_f32_16x16x64_bf16 v[92:95], v[52:55], a[248:255], v22
  s_waitcnt lgkmcnt(4)
  v_smfmac_f32_16x16x64_bf16 v[92:95], v[56:59], v[192:199], v22
  s_waitcnt lgkmcnt(3)
  v_smfmac_f32_16x16x64_bf16 v[92:95], v[60:63], v[200:207], v22
  s_waitcnt lgkmcnt(2)
  v_smfmac_f32_16x16x64_bf16 v[92:95], v[64:67], v[208:215], v22
  s_waitcnt lgkmcnt(1)
  v_smfmac_f32_16x16x64_bf16 v[92:95], v[68:71], v[216:223], v22
  s_waitcnt lgkmcnt(0)
  v_smfmac_f32_16x16x64_bf16 v[92:95], v[84:87], v[248:255], v22
  v_smfmac_f32_16x16x64_bf16 v[88:91], v[52:55], a[168:175], v22
  v_smfmac_f32_16x16x64_bf16 v[88:91], v[56:59], a[176:183], v22
  v_smfmac_f32_16x16x64_bf16 v[88:91], v[60:63], a[184:191], v22
  v_permlane32_swap_b32 v92, v93
  v_smfmac_f32_16x16x64_bf16 v[88:91], v[64:67], a[192:199], v22
  v_permlane32_swap_b32 v94, v95
  v_smfmac_f32_16x16x64_bf16 v[88:91], v[68:71], a[200:207], v22
  v_permlane32_swap_b32 v93, v92
  v_smfmac_f32_16x16x64_bf16 v[88:91], v[84:87], a[232:239], v22
  v_permlane32_swap_b32 v95, v94
  v_pk_mul_f32 v[120:121], v[92:93], v[24:25] op_sel:[1,0] op_sel_hi:[0,1]
  v_pk_mul_f32 v[122:123], v[94:95], v[24:25] op_sel:[1,0] op_sel_hi:[0,1]
  s_nop 4
  v_pk_fma_f32 v[88:89], v[88:89], v[24:25], v[120:121]
  v_pk_fma_f32 v[90:91], v[90:91], v[24:25], v[122:123]
  v_cvt_pk_bf16_f32 v120, v88, v89
  v_cvt_pk_bf16_f32 v121, v90, v91
  ds_write_b64 v6, v[120:121]
  v_cmp_u_f32 vcc, v88, v89
  v_cmp_u_f32 s[22:23], v90, v91
  s_nop 1
  s_or_b64 vcc, vcc, s[22:23]
  s_cbranch_vccnz mn_161
mk_162:
  s_waitcnt lgkmcnt(0)
  s_barrier
  ds_read_b64_tr_b16 v[104:105], v7 offset:0
  ds_read_b64_tr_b16 v[106:107], v7 offset:768
  ds_read_b64_tr_b16 v[108:109], v7 offset:1536
  ds_read_b64 v[140:141], v11
  s_cmp_eq_u32 s52, 63
  s_cbranch_scc1 last_163
  s_waitcnt lgkmcnt(2)
  v_mfma_f32_16x16x32_bf16 v[120:123], v[104:107], v[104:107], 0
  s_waitcnt lgkmcnt(1)
  v_mfma_f32_16x16x32_bf16 v[120:123], v[108:111], v[108:111], v[120:123]
  s_mov_b64 exec, s[64:65]
  s_nop 6
  v_cvt_pk_f16_f32 v120, v120, v121
  buffer_store_dword v120, v8, s[8:11], s56 offen sc1
  v_cvt_pk_f16_f32 v121, v122, v123
  buffer_store_dword v121, v8, s[8:11], s56 offen offset:128 sc1
  s_mov_b64 exec, -1
  s_sleep 3
  s_nop 1
  v_smfmac_f32_16x16x64_bf16 v[96:99], v[48:51], a[0:7], v22
  v_smfmac_f32_16x16x64_bf16 v[100:103], v[48:51], a[80:87], v22
  v_smfmac_f32_16x16x64_bf16 v[96:99], v[52:55], a[8:15], v22
  v_smfmac_f32_16x16x64_bf16 v[100:103], v[52:55], a[88:95], v22
  v_smfmac_f32_16x16x64_bf16 v[96:99], v[56:59], a[16:23], v22
  v_smfmac_f32_16x16x64_bf16 v[100:103], v[56:59], a[96:103], v22
  v_smfmac_f32_16x16x64_bf16 v[96:99], v[60:63], a[24:31], v22
  v_smfmac_f32_16x16x64_bf16 v[96:99], v[64:67], a[32:39], v22
  v_smfmac_f32_16x16x64_bf16 v[96:99], v[68:71], a[40:47], v22
  v_smfmac_f32_16x16x64_bf16 v[96:99], v[72:75], a[48:55], v22
  v_smfmac_f32_16x16x64_bf16 v[96:99], v[76:79], a[56:63], v22
  buffer_load_dwordx4 v[124:127], v9, s[8:11], s56 offen sc1
  v_smfmac_f32_16x16x64_bf16 v[96:99], v[80:83], a[64:71], v22
  buffer_load_dwordx4 v[128:131], v9, s[8:11], s56 offen offset:1024 sc1
  v_smfmac_f32_16x16x64_bf16 v[96:99], v[84:87], a[72:79], v22
  buffer_load_dwordx4 v[132:135], v10, s[8:11], s56 offen sc1
  v_smfmac_f32_16x16x64_bf16 v[100:103], v[60:63], a[104:111], v22
  v_smfmac_f32_16x16x64_bf16 v[100:103], v[64:67], a[112:119], v22
  v_smfmac_f32_16x16x64_bf16 v[100:103], v[68:71], a[120:127], v22
  v_smfmac_f32_16x16x64_bf16 v[100:103], v[72:75], a[128:135], v22
  v_cvt_pk_bf16_f32 v136, v96, v97
  v_smfmac_f32_16x16x64_bf16 v[100:103], v[76:79], a[136:143], v22
  v_cvt_pk_bf16_f32 v137, v98, v99
  v_smfmac_f32_16x16x64_bf16 v[100:103], v[80:83], a[144:151], v22
  v_smfmac_f32_16x16x64_bf16 v[100:103], v[84:87], a[152:159], v22
  s_waitcnt vmcnt(2)
  v_pk_add_f16 v172, v124, v126
  v_pk_add_f16 v173, v125, v127
  s_waitcnt vmcnt(1)
  v_pk_add_f16 v174, v128, v130
  v_pk_add_f16 v175, v129, v131
  v_fma_mix_f32 v166, v172, 1.0, v174 op_sel:[0,0,0] op_sel_hi:[1,0,1]
  v_fma_mix_f32 v168, v173, 1.0, v175 op_sel:[0,0,0] op_sel_hi:[1,0,1]
  s_waitcnt vmcnt(0)
  v_pk_add_f16 v176, v132, v133
  v_pk_add_f16 v177, v134, v135
  v_fma_mix_f32 v170, v176, 1.0, v177 op_sel:[0,0,0] op_sel_hi:[1,0,1]
  v_fma_mix_f32 v167, v172, 1.0, v174 op_sel:[1,0,1] op_sel_hi:[1,0,1]
  v_cmp_u_f32 vcc, v166, v170
  v_fma_mix_f32 v169, v173, 1.0, v175 op_sel:[1,0,1] op_sel_hi:[1,0,1]
  v_fma_mix_f32 v171, v176, 1.0, v177 op_sel:[1,0,1] op_sel_hi:[1,0,1]
  v_cvt_pk_bf16_f32 v138, v100, v101
  s_cbranch_vccnz sr_165
sj_166:
ex_167:
  v_exp_f32 v172, v166
  v_exp_f32 v173, v167
  v_exp_f32 v174, v168
  v_cvt_pk_bf16_f32 v156, v172, v173
  v_exp_f32 v175, v169
  v_exp_f32 v176, v170
  v_cvt_pk_bf16_f32 v157, v174, v175
  v_mov_b32_dpp v158, v156 row_ror:8 row_mask:0xf bank_mask:0xf
  v_exp_f32 v177, v171
  v_mov_b32_dpp v159, v157 row_ror:8 row_mask:0xf bank_mask:0xf
  v_cvt_pk_bf16_f32 v160, v176, v177
  v_cvt_pk_bf16_f32 v139, v102, v103
  v_mfma_f32_16x16x32_bf16 v[178:181], v[152:155], v[156:159], 0
  s_waitcnt lgkmcnt(0)
  v_mov_b32_dpp v161, v160 row_ror:8 row_mask:0xf bank_mask:0xf
  v_mfma_f32_16x16x32_bf16 v[182:185], v[144:147], v[156:159], 0
  s_nop 0
  v_mfma_f32_16x16x32_bf16 v[178:181], v[140:143], v[160:163], v[178:181]
  v_mfma_f32_16x16x32_bf16 v[182:185], v[136:139], v[160:163], v[182:185]
  v_mfma_f32_16x16x32_bf16 v[186:189], v[148:151], v[156:159], 0
  v_mfma_f32_16x16x32_bf16 v[186:189], v[138:141], v[160:163], v[186:189]
  s_mov_b64 exec, s[62:63]
  v_rcp_f32 v164, v180
  s_nop 0
  v_pk_mul_f32 v[178:179], v[178:179], v[164:165] op_sel_hi:[1,0]
  v_pk_mul_f32 v[182:183], v[182:183], v[164:165] op_sel_hi:[1,0]
  v_pk_mul_f32 v[184:185], v[184:185], v[164:165] op_sel_hi:[1,0]
  v_cvt_pk_f16_f32 v64, v178, v179
  v_cvt_pk_f16_f32 v60, v182, v183
  v_pk_mul_f32 v[186:187], v[186:187], v[164:165] op_sel_hi:[1,0]
  v_pk_mul_f32 v[188:189], v[188:189], v[164:165] op_sel_hi:[1,0]
  v_cvt_pk_f16_f32 v61, v184, v185
  v_cvt_pk_f16_f32 v62, v186, v187
  v_cvt_pk_f16_f32 v63, v188, v189
  ds_write_b128 v13, v[60:63]
  ds_write_b32 v14, v64
  v_add_f32 v165, v164, v180
  v_cmp_ngt_f32 vcc, s80, v165
  s_mov_b64 exec, -1
  s_nop 0
  s_cbranch_vccnz fx_168
fk_169:
  s_waitcnt lgkmcnt(0)
  s_barrier
  s_add_u32 m0, s74, 4096
  s_add_u32 s21, s79, 131072
  buffer_load_dwordx4 v4, s[16:19], s21 offen offset:0 sc1 lds
  s_add_u32 m0, s74, 6144
  s_add_u32 s21, s79, 196608
  buffer_load_dwordx4 v4, s[16:19], s21 offen offset:1024 sc1 lds
  s_xor_b32 s74, s74, 16384
  s_add_u32 s73, s73, 2097152
  s_xor_b32 s73, s73, 8192
  s_add_u32 s79, s79, 2097152
  s_xor_b32 s79, s79, 8192
  s_add_u32 s21, s72, 524288
  s_xor_b32 s72, s72, s21
  s_lshr_b32 s72, s72, 8
  s_and_b32 s72, s72, 8192
  s_xor_b32 s72, s72, s21
  s_nop 15
  s_nop 3
  v_permlane32_swap_b32 v96, v100
  v_permlane32_swap_b32 v97, v101
  v_permlane32_swap_b32 v98, v102
  v_permlane32_swap_b32 v99, v103
  v_pk_add_f32 v[96:97], v[96:97], v[100:101]
  v_pk_add_f32 v[98:99], v[98:99], v[102:103]
  v_cvt_pk_bf16_f32 v182, v96, v97
  v_cvt_pk_bf16_f32 v183, v98, v99
  v_min_u32 v182, -2, v182
  ds_write_b64 v26, v[182:183]
  ds_read_b128 v[144:147], v18
  ds_read_b128 v[148:151], v18 offset:1024
  ds_read_b128 v[152:155], v19
  v_xor_b32 v18, 16384, v18
  v_xor_b32 v19, 16384, v19
  v_mov_b32 v88, 0
  v_mov_b32 v89, 0
  v_mov_b32 v90, 0
  v_mov_b32 v91, 0
  v_mov_b32 v92, 0
  v_mov_b32 v93, 0
  v_mov_b32 v94, 0
  v_mov_b32 v95, 0
  v_mov_b32 v96, 0
  v_mov_b32 v97, 0
  v_mov_b32 v98, 0
  v_mov_b32 v99, 0
  v_mov_b32 v100, 0
  v_mov_b32 v101, 0
  v_mov_b32 v102, 0
  v_mov_b32 v103, 0
  s_mov_b32 s81, 0
  s_waitcnt lgkmcnt(0)
  s_barrier
  s_mov_b64 exec, s[64:65]
  buffer_store_dword v28, v8, s[8:11], s57 offen sc1
  buffer_store_dword v28, v8, s[8:11], s57 offen offset:128 sc1
  s_mov_b64 exec, -1
  s_cmp_eq_u32 s78, 0
  s_cbranch_scc1 nt_171
  s_mov_b64 exec, s[62:63]
  buffer_store_dword v28, v17, s[8:11], s59 offen sc1
  s_mov_b64 exec, -1
  s_sleep 6
  s_nop 3
  buffer_load_dwordx4 v[68:71], v16, s[4:7], s60 offen sc1
  s_sleep 3
  s_nop 1
  buffer_load_dwordx4 v[72:75], v16, s[4:7], s60 offen sc1
  s_waitcnt vmcnt(1)
  v_mfma_f32_16x16x32_f16 v[120:123], v[44:47], v[68:71], 0
  v_bitop3_b32 v27, v68, s61, 1 bitop3:0x28
  v_cmp_ne_u32 vcc, 0, v27
  s_nop 1
  s_cbranch_vccnz p2_174
  s_nop 2
pg_173:
  v_add_f32_dpp v120, v120, v120 row_ror:8 row_mask:0xf bank_mask:0xf
  v_add_f32_dpp v121, v121, v121 row_ror:8 row_mask:0xf bank_mask:0xf
  s_mov_b64 exec, s[62:63]
  v_cvt_pk_bf16_f32 v120, v120, v121
  v_min_u32 v120, -2, v120
  buffer_store_dword v120, v17, s[8:11], s55 offen sc1
  s_mov_b64 exec, -1
nt_170:
  s_barrier
  s_mov_b32 s58, s55
  s_add_u32 s52, s52, 1
  s_and_b32 s21, s52, 3
  s_mul_i32 s56, s21, 122880
  s_add_u32 s21, s52, 1
  s_and_b32 s21, s21, 3
  s_mul_i32 s55, s21, 122880
  s_add_u32 s55, s55, s75
  s_add_u32 s21, s52, 2
  s_and_b32 s21, s21, 3
  s_mul_i32 s57, s21, 122880
  s_add_u32 s21, s52, 3
  s_and_b32 s21, s21, 3
  s_mul_i32 s59, s21, 122880
  s_add_u32 s59, s59, s75
  s_bfe_u32 s61, s52, 0x10002
  s_and_b32 s21, s52, 3
  s_lshl_b32 s60, s21, 18
  s_mov_b32 s54, 0
  s_sleep 3
  s_nop 2
  buffer_load_dwordx4 v[72:75], v190, s[8:11], s58 offen offset:0 sc1
  buffer_load_dwordx4 v[76:79], v190, s[8:11], s58 offen offset:1024 sc1
  buffer_load_dwordx4 v[80:83], v190, s[8:11], s58 offen offset:2048 sc1
  s_branch top_159
mr_160:
  s_mov_b64 exec, s[22:23]
  s_cbranch_execz ms_175
  buffer_load_dwordx4 v[72:75], v190, s[8:11], s58 offen offset:0 sc1
ms_175:
  s_mov_b64 exec, s[98:99]
  s_cbranch_execz ms_176
  buffer_load_dwordx4 v[76:79], v190, s[8:11], s58 offen offset:1024 sc1
ms_176:
  s_mov_b64 exec, s[100:101]
  s_cbranch_execz ms_177
  buffer_load_dwordx4 v[80:83], v190, s[8:11], s58 offen offset:2048 sc1
ms_177:
  s_add_u32 s54, s54, 1
  s_cmp_gt_u32 s54, 131072
  s_cbranch_scc1 end0
  s_waitcnt vmcnt(0)
  s_mov_b64 exec, s[22:23]
  ds_write_b128 v190, v[72:75] offset:0
  v_cmp_eq_u32 s[22:23], -1, v72
  s_mov_b64 exec, s[98:99]
  ds_write_b128 v190, v[76:79] offset:1024
  v_cmp_eq_u32 s[98:99], -1, v76
  s_mov_b64 exec, s[100:101]
  ds_write_b128 v190, v[80:83] offset:2048
  v_cmp_eq_u32 s[100:101], -1, v80
  s_mov_b64 exec, -1
  s_or_b64 vcc, s[22:23], s[98:99]
  s_or_b64 vcc, vcc, s[100:101]
  s_cbranch_scc1 mr_160
  s_branch mo_164
mn_161:
  v_max3_u32 v27, v48, v49, v50
  v_max3_u32 v27, v27, v51, v52
  v_max3_u32 v27, v27, v53, v54
  v_max3_u32 v27, v27, v55, v56
  v_max3_u32 v27, v27, v57, v58
  v_max3_u32 v27, v27, v59, v60
  v_max3_u32 v27, v27, v61, v62
  v_max3_u32 v27, v27, v63, v64
  v_max3_u32 v27, v27, v65, v66
  v_max3_u32 v27, v27, v67, v68
  v_max3_u32 v27, v27, v69, v70
  v_max3_u32 v27, v27, v71, v72
  v_max3_u32 v27, v27, v73, v74
  v_max3_u32 v27, v27, v75, v76
  v_max3_u32 v27, v27, v77, v78
  v_max3_u32 v27, v27, v79, v80
  v_max3_u32 v27, v27, v81, v82
  v_max3_u32 v27, v27, v83, v84
  v_max3_u32 v27, v27, v85, v86
  v_max3_u32 v27, v27, v87, v87
  v_cmp_eq_u32 vcc, -1, v27
  s_cmp_eq_u32 s52, 0
  s_cbranch_scc1 mk_162
  s_cbranch_vccz mk_162
  s_waitcnt lgkmcnt(0)
  s_barrier
  s_nop 7
  v_mov_b32 v88, 0
  v_mov_b32 v89, 0
  v_mov_b32 v90, 0
  v_mov_b32 v91, 0
  v_mov_b32 v92, 0
  v_mov_b32 v93, 0
  v_mov_b32 v94, 0
  v_mov_b32 v95, 0
  v_mov_b32 v96, 0
  v_mov_b32 v97, 0
  v_mov_b32 v98, 0
  v_mov_b32 v99, 0
  v_mov_b32 v100, 0
  v_mov_b32 v101, 0
  v_mov_b32 v102, 0
  v_mov_b32 v103, 0
  s_mov_b64 s[22:23], -1
  s_mov_b64 s[98:99], -1
  s_mov_b64 s[100:101], -1
  s_branch mr_160
sr_165:
  s_mov_b32 s54, 0
sr_178:
  s_mov_b64 exec, vcc
  buffer_load_dwordx4 v[124:127], v9, s[8:11], s56 offen sc1
  buffer_load_dwordx4 v[128:131], v9, s[8:11], s56 offen offset:1024 sc1
  buffer_load_dwordx4 v[132:135], v10, s[8:11], s56 offen sc1
  s_mov_b64 exec, -1
  s_add_u32 s54, s54, 1
  s_cmp_gt_u32 s54, 131072
  s_cbranch_scc1 end0
  s_and_b32 s21, s54, 31
  s_cbranch_scc0 sr_179
  s_waitcnt vmcnt(0)
  v_pk_add_f16 v172, v124, v126
  v_pk_add_f16 v173, v125, v127
  v_pk_add_f16 v174, v128, v130
  v_pk_add_f16 v175, v129, v131
  v_fma_mix_f32 v166, v172, 1.0, v174 op_sel:[0,0,0] op_sel_hi:[1,0,1]
  v_fma_mix_f32 v168, v173, 1.0, v175 op_sel:[0,0,0] op_sel_hi:[1,0,1]
  v_pk_add_f16 v176, v132, v133
  v_pk_add_f16 v177, v134, v135
  v_add_f32 v27, v166, v168
  v_fma_mix_f32 v170, v176, 1.0, v177 op_sel:[0,0,0] op_sel_hi:[1,0,1]
  v_fma_mix_f32 v167, v172, 1.0, v174 op_sel:[1,0,1] op_sel_hi:[1,0,1]
  v_cmp_u_f32 vcc, v27, v170
  v_fma_mix_f32 v169, v173, 1.0, v175 op_sel:[1,0,1] op_sel_hi:[1,0,1]
  v_fma_mix_f32 v171, v176, 1.0, v177 op_sel:[1,0,1] op_sel_hi:[1,0,1]
  s_cbranch_vccnz sr_178
  s_branch sj_166
sr_179:
  s_waitcnt vmcnt(0)
  v_pk_add_f16 v172, v124, v126
  v_pk_add_f16 v173, v125, v127
  v_pk_add_f16 v174, v128, v130
  v_pk_add_f16 v175, v129, v131
  v_fma_mix_f32 v166, v172, 1.0, v174 op_sel:[0,0,0] op_sel_hi:[1,0,1]
  v_fma_mix_f32 v168, v173, 1.0, v175 op_sel:[0,0,0] op_sel_hi:[1,0,1]
  v_pk_add_f16 v176, v132, v133
  v_pk_add_f16 v177, v134, v135
  v_add_f32 v27, v166, v168
  v_fma_mix_f32 v170, v176, 1.0, v177 op_sel:[0,0,0] op_sel_hi:[1,0,1]
  v_fma_mix_f32 v167, v172, 1.0, v174 op_sel:[1,0,1] op_sel_hi:[1,0,1]
  v_cmp_u_f32 vcc, v27, v170
  v_fma_mix_f32 v169, v173, 1.0, v175 op_sel:[1,0,1] op_sel_hi:[1,0,1]
  v_fma_mix_f32 v171, v176, 1.0, v177 op_sel:[1,0,1] op_sel_hi:[1,0,1]
  v_max3_u32 v27, v124, v126, v128
  v_max3_u32 v27, v27, v130, v132
  v_max3_u32 v27, v27, v133, v134
  v_max3_u32 v27, v27, v135, v135
  v_cmp_eq_u32 vcc, -1, v27
  s_nop 1
  s_cbranch_vccnz sr_178
  s_branch sj_166
fx_168:
  s_cmp_eq_u32 s81, 1
  s_cbranch_scc1 fk_169
  s_mov_b32 s81, 1
  v_max3_f32 v164, v166, v167, v168
  v_max3_f32 v165, v169, v170, v171
  v_max_f32 v164, v164, v165
  s_nop 1
  v_max_f32_dpp v164, v164, v164 row_ror:8 row_mask:0xf bank_mask:0xf
  v_mov_b32 v165, v164
  s_nop 1
  v_permlane32_swap_b32 v164, v165
  v_max_f32 v164, v164, v165
  v_mov_b32 v165, v164
  s_nop 1
  v_permlane16_swap_b32 v164, v165
  v_max_f32 v164, v164, v165
  v_sub_f32 v166, v166, v164
  v_sub_f32 v167, v167, v164
  v_sub_f32 v168, v168, v164
  v_sub_f32 v169, v169, v164
  v_sub_f32 v170, v170, v164
  v_sub_f32 v171, v171, v164
  s_branch ex_167
nt_171:
  s_branch nt_170
p2_174:
  s_mov_b32 s54, 0
  buffer_load_dwordx4 v[68:71], v16, s[4:7], s60 offen sc1
  s_waitcnt vmcnt(1)
  v_mfma_f32_16x16x32_f16 v[120:123], v[44:47], v[72:75], 0
  v_bitop3_b32 v27, v72, s61, 1 bitop3:0x28
  v_cmp_ne_u32 vcc, 0, v27
  s_nop 1
  s_cbranch_vccz pg_173
  buffer_load_dwordx4 v[72:75], v16, s[4:7], s60 offen sc1
pp_172:
  s_waitcnt vmcnt(1)
  v_mfma_f32_16x16x32_f16 v[120:123], v[44:47], v[68:71], 0
  v_bitop3_b32 v27, v68, s61, 1 bitop3:0x28
  v_cmp_ne_u32 vcc, 0, v27
  s_nop 1
  s_cbranch_vccz pg_173
  buffer_load_dwordx4 v[68:71], v16, s[4:7], s60 offen sc1
  s_waitcnt vmcnt(1)
  v_mfma_f32_16x16x32_f16 v[120:123], v[44:47], v[72:75], 0
  v_bitop3_b32 v27, v72, s61, 1 bitop3:0x28
  v_cmp_ne_u32 vcc, 0, v27
  s_nop 1
  s_cbranch_vccz pg_173
  buffer_load_dwordx4 v[72:75], v16, s[4:7], s60 offen sc1
  s_add_u32 s54, s54, 1
  s_cmp_gt_u32 s54, 131072
  s_cbranch_scc1 end0
  s_branch pp_172
last_163:
  v_smfmac_f32_16x16x64_bf16 v[96:99], v[48:51], a[0:7], v22
  v_smfmac_f32_16x16x64_bf16 v[100:103], v[48:51], a[80:87], v22
  v_smfmac_f32_16x16x64_bf16 v[96:99], v[52:55], a[8:15], v22
  v_smfmac_f32_16x16x64_bf16 v[100:103], v[52:55], a[88:95], v22
  v_smfmac_f32_16x16x64_bf16 v[96:99], v[56:59], a[16:23], v22
  v_smfmac_f32_16x16x64_bf16 v[100:103], v[56:59], a[96:103], v22
  v_smfmac_f32_16x16x64_bf16 v[96:99], v[60:63], a[24:31], v22
  v_smfmac_f32_16x16x64_bf16 v[96:99], v[64:67], a[32:39], v22
  v_smfmac_f32_16x16x64_bf16 v[96:99], v[68:71], a[40:47], v22
  v_smfmac_f32_16x16x64_bf16 v[96:99], v[72:75], a[48:55], v22
  v_smfmac_f32_16x16x64_bf16 v[96:99], v[76:79], a[56:63], v22
  v_smfmac_f32_16x16x64_bf16 v[96:99], v[80:83], a[64:71], v22
  v_smfmac_f32_16x16x64_bf16 v[96:99], v[84:87], a[72:79], v22
  v_smfmac_f32_16x16x64_bf16 v[100:103], v[60:63], a[104:111], v22
  v_smfmac_f32_16x16x64_bf16 v[100:103], v[64:67], a[112:119], v22
  v_smfmac_f32_16x16x64_bf16 v[100:103], v[68:71], a[120:127], v22
  v_smfmac_f32_16x16x64_bf16 v[100:103], v[72:75], a[128:135], v22
  v_smfmac_f32_16x16x64_bf16 v[100:103], v[76:79], a[136:143], v22
  v_smfmac_f32_16x16x64_bf16 v[100:103], v[80:83], a[144:151], v22
  v_smfmac_f32_16x16x64_bf16 v[100:103], v[84:87], a[152:159], v22
  s_nop 7
  v_permlane32_swap_b32 v96, v100
  v_permlane32_swap_b32 v97, v101
  v_permlane32_swap_b32 v98, v102
  v_permlane32_swap_b32 v99, v103
  v_pk_add_f32 v[96:97], v[96:97], v[100:101]
  v_pk_add_f32 v[98:99], v[98:99], v[102:103]
  v_cvt_pk_bf16_f32 v182, v96, v97
  v_cvt_pk_bf16_f32 v183, v98, v99
  v_min_u32 v182, -2, v182
  ds_write_b64 v26, v[182:183]
  s_waitcnt lgkmcnt(0)
  s_barrier
  s_branch chain_done
E_31:
  v_add_u32 v190, 9216, v4
  s_waitcnt vmcnt(0)
  ds_write_b128 v190, v[84:87] offset:0
  s_branch mo_185
  .p2align 3
top_180:
  s_waitcnt vmcnt(0)
  ds_write_b128 v190, v[84:87] offset:0
  v_cmp_eq_u32 s[22:23], -1, v84
  s_or_b64 vcc, s[22:23], s[22:23]
  s_cbranch_scc1 mr_181
mo_185:
  s_waitcnt lgkmcnt(0)
  s_barrier
  ds_read_b128 v[48:51], v4 offset:0
  ds_read_b128 v[52:55], v4 offset:1024
  v_smfmac_f32_16x16x64_bf16 v[92:95], v[84:87], v[248:255], v22
  ds_read_b128 v[56:59], v4 offset:2048
  ds_read_b128 v[60:63], v4 offset:3072
  v_smfmac_f32_16x16x64_bf16 v[88:91], v[84:87], a[232:239], v22
  s_waitcnt lgkmcnt(3)
  s_add_u32 m0, s74, 0
  s_add_u32 s21, s79, 0
  buffer_load_dwordx4 v4, s[16:19], s21 offen offset:0 sc1 lds
  v_smfmac_f32_16x16x64_bf16 v[92:95], v[48:51], a[240:247], v22
  ds_read_b128 v[64:67], v4 offset:4096
  ds_read_b128 v[68:71], v4 offset:5120
  s_add_u32 s22, s52, 3
  s_min_u32 s22, s22, 64
  v_smfmac_f32_16x16x64_bf16 v[88:91], v[48:51], a[160:167], v22
  s_waitcnt lgkmcnt(4)
  s_add_u32 m0, s74, 0
  s_add_u32 s21, s79, 0
  buffer_load_dwordx4 v4, s[16:19], s21 offen offset:1024 sc1 lds
  v_cmp_gt_u32 vcc, s22, v42
  v_smfmac_f32_16x16x64_bf16 v[92:95], v[52:55], a[248:255], v22
  ds_read_b128 v[72:75], v4 offset:6144
  ds_read_b128 v[76:79], v4 offset:7168
  s_cbranch_vccnz kw_186
kv_187:
  v_smfmac_f32_16x16x64_bf16 v[88:91], v[52:55], a[168:175], v22
  s_waitcnt lgkmcnt(5)
  s_add_u32 m0, s74, 2048
  s_add_u32 s21, s79, 65536
  buffer_load_dwordx4 v4, s[16:19], s21 offen offset:0 sc1 lds
  v_smfmac_f32_16x16x64_bf16 v[92:95], v[56:59], v[192:199], v22
  ds_read_b128 v[80:83], v4 offset:8192
  v_smfmac_f32_16x16x64_bf16 v[88:91], v[56:59], a[176:183], v22
  s_waitcnt lgkmcnt(5)
  s_add_u32 m0, s74, 10240
  s_nop 0
  buffer_load_dwordx4 v4, s[16:19], s73 offen offset:0 sc1 lds
  v_smfmac_f32_16x16x64_bf16 v[92:95], v[60:63], v[200:207], v22
  s_waitcnt lgkmcnt(4)
  v_smfmac_f32_16x16x64_bf16 v[92:95], v[64:67], v[208:215], v22
  s_waitcnt lgkmcnt(3)
  s_add_u32 m0, s74, 10240
  s_nop 0
  buffer_load_dwordx4 v4, s[16:19], s73 offen offset:1024 sc1 lds
  v_smfmac_f32_16x16x64_bf16 v[92:95], v[68:71], v[216:223], v22
  s_waitcnt lgkmcnt(2)
  v_smfmac_f32_16x16x64_bf16 v[92:95], v[72:75], v[224:231], v22
  s_waitcnt lgkmcnt(1)
  s_add_u32 m0, s74, 10240
  s_nop 0
  buffer_load_dwordx4 v4, s[16:19], s73 offen offset:2048 sc1 lds
  v_smfmac_f32_16x16x64_bf16 v[92:95], v[76:79], v[232:239], v22
  s_waitcnt lgkmcnt(0)
  v_smfmac_f32_16x16x64_bf16 v[92:95], v[80:83], v[240:247], v22
  s_add_u32 m0, s74, 8192
  s_add_u32 s21, s72, 0
  buffer_load_dwordx4 v32, s[16:19], s21 offen sc1 lds
  v_smfmac_f32_16x16x64_bf16 v[88:91], v[60:63], a[184:191], v22
  v_smfmac_f32_16x16x64_bf16 v[88:91], v[64:67], a[192:199], v22
  v_smfmac_f32_16x16x64_bf16 v[88:91], v[68:71], a[200:207], v22
  v_cvt_pk_bf16_f32 v122, v92, v93
  v_smfmac_f32_16x16x64_bf16 v[88:91], v[72:75], a[208:215], v22
  v_cvt_pk_bf16_f32 v123, v94, v95
  v_smfmac_f32_16x16x64_bf16 v[88:91], v[76:79], a[216:223], v22
  ds_write_b64 v12, v[122:123] offset:13056
  v_smfmac_f32_16x16x64_bf16 v[88:91], v[80:83], a[224:231], v22
  s_nop 7
  v_cvt_pk_bf16_f32 v120, v88, v89
  v_cvt_pk_bf16_f32 v121, v90, v91
  ds_write_b64 v12, v[120:121] offset:12544
  v_smfmac_f32_16x16x64_bf16 v[96:99], v[48:51], a[0:7], v22
  v_cmp_u_f32 vcc, v88, v89
  v_smfmac_f32_16x16x64_bf16 v[100:103], v[48:51], a[80:87], v22
  v_cmp_u_f32 s[22:23], v90, v91
  s_nop 0
  s_or_b64 vcc, vcc, s[22:23]
  s_cbranch_vccnz mn_182
mk_183:
  s_waitcnt lgkmcnt(0)
  s_barrier
  ds_read_b64_tr_b16 v[104:105], v7 offset:0
  ds_read_b64_tr_b16 v[106:107], v7 offset:768
  ds_read_b64_tr_b16 v[108:109], v7 offset:1536
  ds_read_b64 v[140:141], v11
  s_cmp_eq_u32 s52, 63
  s_cbranch_scc1 last_184
  v_smfmac_f32_16x16x64_bf16 v[96:99], v[52:55], a[8:15], v22
  v_smfmac_f32_16x16x64_bf16 v[100:103], v[52:55], a[88:95], v22
  v_smfmac_f32_16x16x64_bf16 v[96:99], v[56:59], a[16:23], v22
  v_smfmac_f32_16x16x64_bf16 v[100:103], v[56:59], a[96:103], v22
  v_smfmac_f32_16x16x64_bf16 v[96:99], v[60:63], a[24:31], v22
  v_smfmac_f32_16x16x64_bf16 v[96:99], v[64:67], a[32:39], v22
  v_smfmac_f32_16x16x64_bf16 v[96:99], v[68:71], a[40:47], v22
  v_smfmac_f32_16x16x64_bf16 v[96:99], v[72:75], a[48:55], v22
  v_smfmac_f32_16x16x64_bf16 v[96:99], v[76:79], a[56:63], v22
  v_smfmac_f32_16x16x64_bf16 v[96:99], v[80:83], a[64:71], v22
  v_smfmac_f32_16x16x64_bf16 v[96:99], v[84:87], a[72:79], v22
  v_smfmac_f32_16x16x64_bf16 v[100:103], v[60:63], a[104:111], v22
  v_smfmac_f32_16x16x64_bf16 v[100:103], v[64:67], a[112:119], v22
  v_smfmac_f32_16x16x64_bf16 v[100:103], v[68:71], a[120:127], v22
  v_smfmac_f32_16x16x64_bf16 v[100:103], v[72:75], a[128:135], v22
  v_cvt_pk_bf16_f32 v136, v96, v97
  v_smfmac_f32_16x16x64_bf16 v[100:103], v[76:79], a[136:143], v22
  v_cvt_pk_bf16_f32 v137, v98, v99
  v_smfmac_f32_16x16x64_bf16 v[100:103], v[80:83], a[144:151], v22
  v_smfmac_f32_16x16x64_bf16 v[100:103], v[84:87], a[152:159], v22
  s_sleep 2
  s_nop 7
  buffer_load_dwordx4 v[124:127], v9, s[8:11], s56 offen sc1
  buffer_load_dwordx4 v[128:131], v9, s[8:11], s56 offen offset:1024 sc1
  s_nop 5
  buffer_load_dwordx4 v[132:135], v10, s[8:11], s56 offen sc1
  s_waitcnt vmcnt(2)
  v_pk_add_f16 v172, v124, v126
  v_pk_add_f16 v173, v125, v127
  s_waitcnt vmcnt(1)
  v_pk_add_f16 v174, v128, v130
  v_pk_add_f16 v175, v129, v131
  v_fma_mix_f32 v166, v172, 1.0, v174 op_sel:[0,0,0] op_sel_hi:[1,0,1]
  v_fma_mix_f32 v168, v173, 1.0, v175 op_sel:[0,0,0] op_sel_hi:[1,0,1]
  s_waitcnt vmcnt(0)
  v_pk_add_f16 v176, v132, v133
  v_pk_add_f16 v177, v134, v135
  v_fma_mix_f32 v170, v176, 1.0, v177 op_sel:[0,0,0] op_sel_hi:[1,0,1]
  v_fma_mix_f32 v167, v172, 1.0, v174 op_sel:[1,0,1] op_sel_hi:[1,0,1]
  v_cmp_u_f32 vcc, v166, v170
  v_fma_mix_f32 v169, v173, 1.0, v175 op_sel:[1,0,1] op_sel_hi:[1,0,1]
  v_fma_mix_f32 v171, v176, 1.0, v177 op_sel:[1,0,1] op_sel_hi:[1,0,1]
  v_cvt_pk_bf16_f32 v138, v100, v101
  s_cbranch_vccnz sr_188
sj_189:
ex_190:
  v_exp_f32 v172, v166
  v_exp_f32 v173, v167
  v_exp_f32 v174, v168
  v_cvt_pk_bf16_f32 v156, v172, v173
  v_exp_f32 v175, v169
  v_exp_f32 v176, v170
  v_cvt_pk_bf16_f32 v157, v174, v175
  v_mov_b32_dpp v158, v156 row_ror:8 row_mask:0xf bank_mask:0xf
  v_exp_f32 v177, v171
  v_mov_b32_dpp v159, v157 row_ror:8 row_mask:0xf bank_mask:0xf
  v_cvt_pk_bf16_f32 v160, v176, v177
  v_cvt_pk_bf16_f32 v139, v102, v103
  v_mfma_f32_16x16x32_bf16 v[178:181], v[152:155], v[156:159], 0
  s_waitcnt lgkmcnt(0)
  v_mov_b32_dpp v161, v160 row_ror:8 row_mask:0xf bank_mask:0xf
  v_mfma_f32_16x16x32_bf16 v[182:185], v[144:147], v[156:159], 0
  s_nop 0
  v_mfma_f32_16x16x32_bf16 v[178:181], v[140:143], v[160:163], v[178:181]
  v_mfma_f32_16x16x32_bf16 v[182:185], v[136:139], v[160:163], v[182:185]
  v_mfma_f32_16x16x32_bf16 v[186:189], v[148:151], v[156:159], 0
  v_mfma_f32_16x16x32_bf16 v[186:189], v[138:141], v[160:163], v[186:189]
  s_mov_b64 exec, s[62:63]
  v_rcp_f32 v164, v180
  s_nop 0
  v_pk_mul_f32 v[178:179], v[178:179], v[164:165] op_sel_hi:[1,0]
  v_pk_mul_f32 v[182:183], v[182:183], v[164:165] op_sel_hi:[1,0]
  v_pk_mul_f32 v[184:185], v[184:185], v[164:165] op_sel_hi:[1,0]
  v_cvt_pk_f16_f32 v64, v178, v179
  v_cvt_pk_f16_f32 v60, v182, v183
  v_pk_mul_f32 v[186:187], v[186:187], v[164:165] op_sel_hi:[1,0]
  v_pk_mul_f32 v[188:189], v[188:189], v[164:165] op_sel_hi:[1,0]
  v_cvt_pk_f16_f32 v61, v184, v185
  v_cvt_pk_f16_f32 v62, v186, v187
  v_cvt_pk_f16_f32 v63, v188, v189
  ds_write_b128 v13, v[60:63]
  ds_write_b32 v14, v64
  v_add_f32 v165, v164, v180
  v_cmp_ngt_f32 vcc, s80, v165
  s_mov_b64 exec, -1
  s_nop 0
  s_cbranch_vccnz fx_191
fk_192:
  s_waitcnt lgkmcnt(0)
  s_barrier
  ds_read_b128 v[166:169], v4 offset:13824
  ds_read_b128 v[170:173], v4 offset:14464
  ds_read_b128 v[174:177], v4 offset:15104
  ds_read_b128 v[178:181], v4 offset:15744
  s_mov_b64 exec, s[66:67]
  s_waitcnt lgkmcnt(2)
  v_pk_add_f16 v166, v166, v170
  v_pk_add_f16 v167, v167, v171
  v_pk_add_f16 v168, v168, v172
  v_pk_add_f16 v169, v169, v173
  s_waitcnt lgkmcnt(1)
  v_pk_add_f16 v166, v166, v174
  v_pk_add_f16 v167, v167, v175
  v_pk_add_f16 v168, v168, v176
  v_pk_add_f16 v169, v169, v177
  s_waitcnt lgkmcnt(0)
  v_pk_add_f16 v166, v166, v178
  v_pk_add_f16 v167, v167, v179
  v_pk_add_f16 v168, v168, v180
  v_pk_add_f16 v169, v169, v181
  v_and_or_b32 v166, v166, -2, s61
  buffer_store_dwordx4 v[166:169], v15, s[4:7], s60 offen sc1
  s_mov_b64 exec, -1
  v_permlane32_swap_b32 v96, v100
  v_permlane32_swap_b32 v97, v101
  v_permlane32_swap_b32 v98, v102
  v_permlane32_swap_b32 v99, v103
  v_pk_add_f32 v[96:97], v[96:97], v[100:101]
  v_pk_add_f32 v[98:99], v[98:99], v[102:103]
  v_cvt_pk_bf16_f32 v182, v96, v97
  v_cvt_pk_bf16_f32 v183, v98, v99
  v_min_u32 v182, -2, v182
  ds_write_b64 v26, v[182:183]
  v_permlane32_swap_b32 v88, v92
  v_permlane32_swap_b32 v89, v93
  v_permlane32_swap_b32 v90, v94
  v_permlane32_swap_b32 v91, v95
  v_pk_add_f32 v[88:89], v[88:89], v[92:93]
  v_pk_add_f32 v[90:91], v[90:91], v[94:95]
  v_cvt_pk_bf16_f32 v184, v88, v89
  v_cvt_pk_bf16_f32 v185, v90, v91
  v_min_u32 v184, -2, v184
  ds_write_b64 v43, v[184:185]
  ds_read_b128 v[144:147], v18
  ds_read_b128 v[148:151], v18 offset:1024
  ds_read_b128 v[152:155], v19
  v_xor_b32 v18, 16384, v18
  v_xor_b32 v19, 16384, v19
  v_mov_b32 v88, 0
  v_mov_b32 v89, 0
  v_mov_b32 v90, 0
  v_mov_b32 v91, 0
  v_mov_b32 v92, 0
  v_mov_b32 v93, 0
  v_mov_b32 v94, 0
  v_mov_b32 v95, 0
  v_mov_b32 v96, 0
  v_mov_b32 v97, 0
  v_mov_b32 v98, 0
  v_mov_b32 v99, 0
  v_mov_b32 v100, 0
  v_mov_b32 v101, 0
  v_mov_b32 v102, 0
  v_mov_b32 v103, 0
  s_mov_b32 s81, 0
  s_waitcnt lgkmcnt(0)
  s_barrier
  s_xor_b32 s74, s74, 16384
  s_add_u32 s73, s73, 2097152
  s_xor_b32 s73, s73, 8192
  s_add_u32 s79, s79, 2097152
  s_xor_b32 s79, s79, 8192
  s_add_u32 s21, s72, 524288
  s_xor_b32 s72, s72, s21
  s_lshr_b32 s72, s72, 8
  s_and_b32 s72, s72, 8192
  s_xor_b32 s72, s72, s21
  s_add_u32 s21, s52, 7
  s_lshr_b32 s21, s21, 2
  v_mov_b32 v28, s21
  v_mov_b32 v166, s52
  s_and_b32 s21, s52, 3
  s_cmp_lt_u32 s52, 54
  s_cselect_b32 s21, s21, 0
  s_cmp_lg_u32 s21, 0
  s_cbranch_scc1 fs_194
  s_mov_b64 exec, 1
  buffer_store_dword v166, v23, s[12:15], s77 offen sc1
  s_mov_b64 exec, -1
fs_194:
  ds_read_b128 v[170:173], v4 offset:16384
  ds_read_b128 v[174:177], v4 offset:17408
  ds_read_b128 v[178:181], v4 offset:18432
  v_min_u32 v104, -2, v104
  v_min_u32 v108, -2, v108
  s_mov_b32 s90, s70
  s_add_u32 s70, s70, 2097152
  s_xor_b32 s70, s70, 8192
  buffer_store_dwordx4 v[104:107], v36, s[16:19], s90 offen offset:2560 sc1
  buffer_store_dwordx2 v[108:109], v37, s[16:19], s90 offen offset:3072 sc1
  s_waitcnt lgkmcnt(0)
  buffer_store_dwordx4 v[170:173], v4, s[16:19], s90 offen offset:0 sc1
  buffer_store_dwordx4 v[174:177], v4, s[16:19], s90 offen offset:1024 sc1
  buffer_store_dwordx4 v[178:181], v38, s[16:19], s90 offen offset:2048 sc1
  s_add_u32 s22, s52, 5
  s_min_u32 s22, s22, 64
  v_cmp_gt_u32 vcc, s22, v42
  s_cbranch_vccz fv_195
  buffer_load_dword v42, v41, s[12:15], s76 offen sc1
fv_195:
nt_193:
  s_barrier
  s_mov_b32 s58, s55
  s_add_u32 s52, s52, 1
  s_and_b32 s21, s52, 3
  s_mul_i32 s56, s21, 122880
  s_add_u32 s21, s52, 1
  s_and_b32 s21, s21, 3
  s_mul_i32 s55, s21, 122880
  s_add_u32 s55, s55, s75
  s_add_u32 s21, s52, 2
  s_and_b32 s21, s21, 3
  s_mul_i32 s57, s21, 122880
  s_add_u32 s21, s52, 3
  s_and_b32 s21, s21, 3
  s_mul_i32 s59, s21, 122880
  s_add_u32 s59, s59, s75
  s_bfe_u32 s61, s52, 0x10002
  s_and_b32 s21, s52, 3
  s_lshl_b32 s60, s21, 18
  s_mov_b32 s54, 0
  s_sleep 3
  s_nop 2
  buffer_load_dwordx4 v[84:87], v190, s[8:11], s58 offen offset:0 sc1
  s_branch top_180
mr_181:
  s_mov_b64 exec, s[22:23]
  s_cbranch_execz ms_196
  buffer_load_dwordx4 v[84:87], v190, s[8:11], s58 offen offset:0 sc1
ms_196:
  s_add_u32 s54, s54, 1
  s_cmp_gt_u32 s54, 131072
  s_cbranch_scc1 end0
  s_waitcnt vmcnt(0)
  s_mov_b64 exec, s[22:23]
  ds_write_b128 v190, v[84:87] offset:0
  v_cmp_eq_u32 s[22:23], -1, v84
  s_mov_b64 exec, -1
  s_or_b64 vcc, s[22:23], s[22:23]
  s_cbranch_scc1 mr_181
  s_branch mo_185
kw_186:
  s_mov_b32 s101, 0
wm_197:
  buffer_load_dword v42, v41, s[12:15], s76 offen sc1
  s_add_u32 s101, s101, 1
  s_cmp_gt_u32 s101, 131072
  s_cbranch_scc1 end0
  s_waitcnt vmcnt(0)
  v_cmp_gt_u32 vcc, s22, v42
  v_readfirstlane_b32 s100, v42
  s_nop 0
  s_cbranch_vccz wm_198
  s_sleep 1
  s_branch wm_197
wm_198:
  s_branch kv_187
mn_182:
  v_max3_u32 v27, v48, v49, v50
  v_max3_u32 v27, v27, v51, v52
  v_max3_u32 v27, v27, v53, v54
  v_max3_u32 v27, v27, v55, v56
  v_max3_u32 v27, v27, v57, v58
  v_max3_u32 v27, v27, v59, v60
  v_max3_u32 v27, v27, v61, v62
  v_max3_u32 v27, v27, v63, v64
  v_max3_u32 v27, v27, v65, v66
  v_max3_u32 v27, v27, v67, v68
  v_max3_u32 v27, v27, v69, v70
  v_max3_u32 v27, v27, v71, v72
  v_max3_u32 v27, v27, v73, v74
  v_max3_u32 v27, v27, v75, v76
  v_max3_u32 v27, v27, v77, v78
  v_max3_u32 v27, v27, v79, v80
  v_max3_u32 v27, v27, v81, v82
  v_max3_u32 v27, v27, v83, v84
  v_max3_u32 v27, v27, v85, v86
  v_max3_u32 v27, v27, v87, v87
  v_cmp_eq_u32 vcc, -1, v27
  s_cmp_eq_u32 s52, 0
  s_cbranch_scc1 mk_183
  s_cbranch_vccz mk_183
  s_waitcnt lgkmcnt(0)
  s_barrier
  s_nop 7
  v_mov_b32 v88, 0
  v_mov_b32 v89, 0
  v_mov_b32 v90, 0
  v_mov_b32 v91, 0
  v_mov_b32 v92, 0
  v_mov_b32 v93, 0
  v_mov_b32 v94, 0
  v_mov_b32 v95, 0
  v_mov_b32 v96, 0
  v_mov_b32 v97, 0
  v_mov_b32 v98, 0
  v_mov_b32 v99, 0
  v_mov_b32 v100, 0
  v_mov_b32 v101, 0
  v_mov_b32 v102, 0
  v_mov_b32 v103, 0
  s_mov_b64 s[22:23], -1
  s_branch mr_181
sr_188:
  s_mov_b32 s54, 0
sr_199:
  s_mov_b64 exec, vcc
  buffer_load_dwordx4 v[124:127], v9, s[8:11], s56 offen sc1
  buffer_load_dwordx4 v[128:131], v9, s[8:11], s56 offen offset:1024 sc1
  buffer_load_dwordx4 v[132:135], v10, s[8:11], s56 offen sc1
  s_mov_b64 exec, -1
  s_add_u32 s54, s54, 1
  s_cmp_gt_u32 s54, 131072
  s_cbranch_scc1 end0
  s_and_b32 s21, s54, 31
  s_cbranch_scc0 sr_200
  s_waitcnt vmcnt(0)
  v_pk_add_f16 v172, v124, v126
  v_pk_add_f16 v173, v125, v127
  v_pk_add_f16 v174, v128, v130
  v_pk_add_f16 v175, v129, v131
  v_fma_mix_f32 v166, v172, 1.0, v174 op_sel:[0,0,0] op_sel_hi:[1,0,1]
  v_fma_mix_f32 v168, v173, 1.0, v175 op_sel:[0,0,0] op_sel_hi:[1,0,1]
  v_pk_add_f16 v176, v132, v133
  v_pk_add_f16 v177, v134, v135
  v_add_f32 v27, v166, v168
  v_fma_mix_f32 v170, v176, 1.0, v177 op_sel:[0,0,0] op_sel_hi:[1,0,1]
  v_fma_mix_f32 v167, v172, 1.0, v174 op_sel:[1,0,1] op_sel_hi:[1,0,1]
  v_cmp_u_f32 vcc, v27, v170
  v_fma_mix_f32 v169, v173, 1.0, v175 op_sel:[1,0,1] op_sel_hi:[1,0,1]
  v_fma_mix_f32 v171, v176, 1.0, v177 op_sel:[1,0,1] op_sel_hi:[1,0,1]
  s_cbranch_vccnz sr_199
  s_branch sj_189
sr_200:
  s_waitcnt vmcnt(0)
  v_pk_add_f16 v172, v124, v126
  v_pk_add_f16 v173, v125, v127
  v_pk_add_f16 v174, v128, v130
  v_pk_add_f16 v175, v129, v131
  v_fma_mix_f32 v166, v172, 1.0, v174 op_sel:[0,0,0] op_sel_hi:[1,0,1]
  v_fma_mix_f32 v168, v173, 1.0, v175 op_sel:[0,0,0] op_sel_hi:[1,0,1]
  v_pk_add_f16 v176, v132, v133
  v_pk_add_f16 v177, v134, v135
  v_add_f32 v27, v166, v168
  v_fma_mix_f32 v170, v176, 1.0, v177 op_sel:[0,0,0] op_sel_hi:[1,0,1]
  v_fma_mix_f32 v167, v172, 1.0, v174 op_sel:[1,0,1] op_sel_hi:[1,0,1]
  v_cmp_u_f32 vcc, v27, v170
  v_fma_mix_f32 v169, v173, 1.0, v175 op_sel:[1,0,1] op_sel_hi:[1,0,1]
  v_fma_mix_f32 v171, v176, 1.0, v177 op_sel:[1,0,1] op_sel_hi:[1,0,1]
  v_max3_u32 v27, v124, v126, v128
  v_max3_u32 v27, v27, v130, v132
  v_max3_u32 v27, v27, v133, v134
  v_max3_u32 v27, v27, v135, v135
  v_cmp_eq_u32 vcc, -1, v27
  s_nop 1
  s_cbranch_vccnz sr_199
  s_branch sj_189
fx_191:
  s_cmp_eq_u32 s81, 1
  s_cbranch_scc1 fk_192
  s_mov_b32 s81, 1
  v_max3_f32 v164, v166, v167, v168
  v_max3_f32 v165, v169, v170, v171
  v_max_f32 v164, v164, v165
  s_nop 1
  v_max_f32_dpp v164, v164, v164 row_ror:8 row_mask:0xf bank_mask:0xf
  v_mov_b32 v165, v164
  s_nop 1
  v_permlane32_swap_b32 v164, v165
  v_max_f32 v164, v164, v165
  v_mov_b32 v165, v164
  s_nop 1
  v_permlane16_swap_b32 v164, v165
  v_max_f32 v164, v164, v165
  v_sub_f32 v166, v166, v164
  v_sub_f32 v167, v167, v164
  v_sub_f32 v168, v168, v164
  v_sub_f32 v169, v169, v164
  v_sub_f32 v170, v170, v164
  v_sub_f32 v171, v171, v164
  s_branch ex_190
last_184:
  s_waitcnt lgkmcnt(0)
  v_min_u32 v104, -2, v104
  v_min_u32 v108, -2, v108
  s_mov_b32 s90, s70
  buffer_store_dwordx4 v[104:107], v36, s[16:19], s90 offen offset:2560 sc1
  buffer_store_dwordx2 v[108:109], v37, s[16:19], s90 offen offset:3072 sc1
  v_smfmac_f32_16x16x64_bf16 v[96:99], v[52:55], a[8:15], v22
  v_smfmac_f32_16x16x64_bf16 v[100:103], v[52:55], a[88:95], v22
  v_smfmac_f32_16x16x64_bf16 v[96:99], v[56:59], a[16:23], v22
  v_smfmac_f32_16x16x64_bf16 v[100:103], v[56:59], a[96:103], v22
  v_smfmac_f32_16x16x64_bf16 v[96:99], v[60:63], a[24:31], v22
  v_smfmac_f32_16x16x64_bf16 v[96:99], v[64:67], a[32:39], v22
  v_smfmac_f32_16x16x64_bf16 v[96:99], v[68:71], a[40:47], v22
  v_smfmac_f32_16x16x64_bf16 v[96:99], v[72:75], a[48:55], v22
  v_smfmac_f32_16x16x64_bf16 v[96:99], v[76:79], a[56:63], v22
  v_smfmac_f32_16x16x64_bf16 v[96:99], v[80:83], a[64:71], v22
  v_smfmac_f32_16x16x64_bf16 v[96:99], v[84:87], a[72:79], v22
  v_smfmac_f32_16x16x64_bf16 v[100:103], v[60:63], a[104:111], v22
  v_smfmac_f32_16x16x64_bf16 v[100:103], v[64:67], a[112:119], v22
  v_smfmac_f32_16x16x64_bf16 v[100:103], v[68:71], a[120:127], v22
  v_smfmac_f32_16x16x64_bf16 v[100:103], v[72:75], a[128:135], v22
  v_smfmac_f32_16x16x64_bf16 v[100:103], v[76:79], a[136:143], v22
  v_smfmac_f32_16x16x64_bf16 v[100:103], v[80:83], a[144:151], v22
  v_smfmac_f32_16x16x64_bf16 v[100:103], v[84:87], a[152:159], v22
  s_nop 7
  v_permlane32_swap_b32 v96, v100
  v_permlane32_swap_b32 v97, v101
  v_permlane32_swap_b32 v98, v102
  v_permlane32_swap_b32 v99, v103
  v_pk_add_f32 v[96:97], v[96:97], v[100:101]
  v_pk_add_f32 v[98:99], v[98:99], v[102:103]
  v_cvt_pk_bf16_f32 v182, v96, v97
  v_cvt_pk_bf16_f32 v183, v98, v99
  v_min_u32 v182, -2, v182
  ds_write_b64 v26, v[182:183]
  v_permlane32_swap_b32 v88, v92
  v_permlane32_swap_b32 v89, v93
  v_permlane32_swap_b32 v90, v94
  v_permlane32_swap_b32 v91, v95
  v_pk_add_f32 v[88:89], v[88:89], v[92:93]
  v_pk_add_f32 v[90:91], v[90:91], v[94:95]
  v_cvt_pk_bf16_f32 v184, v88, v89
  v_cvt_pk_bf16_f32 v185, v90, v91
  v_min_u32 v184, -2, v184
  ds_write_b64 v43, v[184:185]
  s_waitcnt lgkmcnt(0)
  s_barrier
  ds_read_b128 v[170:173], v4 offset:16384
  ds_read_b128 v[174:177], v4 offset:17408
  ds_read_b128 v[178:181], v4 offset:18432
  v_min_u32 v104, -2, v104
  v_min_u32 v108, -2, v108
  s_mov_b32 s90, s70
  s_add_u32 s70, s70, 2097152
  s_xor_b32 s70, s70, 8192
  s_waitcnt lgkmcnt(0)
  buffer_store_dwordx4 v[170:173], v4, s[16:19], s90 offen offset:0 sc1
  buffer_store_dwordx4 v[174:177], v4, s[16:19], s90 offen offset:1024 sc1
  buffer_store_dwordx4 v[178:181], v38, s[16:19], s90 offen offset:2048 sc1
  s_waitcnt vmcnt(0)
  v_mov_b32 v166, 64
  s_mov_b64 exec, 1
  buffer_store_dword v166, v23, s[12:15], s77 offen sc1
  s_mov_b64 exec, -1
  s_branch chain_done
chain_done:
end0:
  s_endpgm
gemm_side:
  s_bfe_u32 s23, s22, 0x20005
  s_add_u32 s22, s22, 31
  s_and_b32 s22, s22, 31
  s_lshl_b32 s21, s23, 3
  s_add_u32 s2, s21, s22
  s_add_u32 s3, s2, 72
  s_add_u32 s24, s2, 48
  s_add_u32 s2, s2, s21
  s_cmp_lt_u32 s22, 24
  s_cselect_b32 s3, s24, s3
  s_cmp_lt_u32 s22, 16
  s_cselect_b32 s3, s2, s3
  s_mov_b32 s2, s3
  s_cmp_ge_u32 s3, 64
  s_cbranch_scc1 not_kv
  s_load_dwordx2 s[4:5], s[0:1], 0
  s_load_dwordx2 s[6:7], s[0:1], 24
  s_load_dwordx2 s[36:37], s[0:1], 32
  s_load_dwordx2 s[38:39], s[0:1], 104
  s_and_b32 s43, s3, 1
  s_bfe_u32 s42, s3, 0x50001
  s_lshr_b32 s40, s42, 2
  s_waitcnt lgkmcnt(0)
  s_cmp_eq_u32 s43, 1
  s_cselect_b32 s6, s36, s6
  s_cselect_b32 s7, s37, s7
  s_mov_b32 s8, s4
  s_mov_b32 s9, s5
  s_mov_b32 s10, 2621440
  s_mov_b32 s11, 0x00020000
  s_mov_b32 s12, s6
  s_mov_b32 s13, s7
  s_mov_b32 s14, 7864320
  s_mov_b32 s15, 0x00020000
  s_mov_b32 s16, s38
  s_mov_b32 s17, s39
  s_mov_b32 s18, 167772160
  s_mov_b32 s19, 0x00020000
  s_add_u32 s72, s38, 168886272
  s_addc_u32 s73, s39, 0
  s_mov_b32 s74, 49152
  s_mov_b32 s75, 0x00020000
  s_mul_i32 s44, s42, 384
  s_mov_b32 s30, 0
  s_mov_b32 s25, 80768
  v_lshrrev_b32 v4, 3, v1
  v_and_b32 v5, 7, v1
  v_xor_b32 v5, v5, v4
  s_mul_i32 s21, s20, 16
  v_add_u32 v4, s21, v4
  v_mul_u32_u24 v4, 1280, v4
  v_lshl_add_u32 v10, v5, 4, v4
  s_mul_i32 s31, s20, 2048
  v_add_u32 v11, 10240, v10
  v_mov_b32 v9, 2731
  v_add_u32 v8, 0, v1
  v_mul_u32_u24 v7, v8, v9
  v_lshrrev_b32 v7, 16, v7
  v_mul_u32_u24 v4, 24, v7
  v_sub_u32 v8, v8, v4
  s_mov_b32 s21, 12288
  v_mul_lo_u32 v7, v7, s21
  v_lshl_add_u32 v4, v8, 4, v7
  v_add_u32 v8, 64, v1
  v_mul_u32_u24 v7, v8, v9
  v_lshrrev_b32 v7, 16, v7
  v_mul_u32_u24 v5, 24, v7
  v_sub_u32 v8, v8, v5
  s_mov_b32 s21, 12288
  v_mul_lo_u32 v7, v7, s21
  v_lshl_add_u32 v5, v8, 4, v7
  v_add_u32 v8, 128, v1
  v_mul_u32_u24 v7, v8, v9
  v_lshrrev_b32 v7, 16, v7
  v_mul_u32_u24 v6, 24, v7
  v_sub_u32 v8, v8, v6
  s_mov_b32 s21, 12288
  v_mul_lo_u32 v7, v7, s21
  v_lshl_add_u32 v6, v8, 4, v7
  v_lshrrev_b32 v7, 2, v2
  v_lshl_add_u32 v7, v3, 3, v7
  v_mul_u32_u24 v7, 384, v7
  v_and_b32 v8, 3, v2
  v_lshlrev_b32 v8, 3, v8
  s_mul_i32 s21, s20, 96
  v_add3_u32 v7, v7, v8, s21
  v_add_u32 v8, 49152, v7
  s_mul_i32 s21, s20, 393216
  s_add_u32 s21, s21, 0
  s_add_u32 s21, s21, s44
  s_mul_i32 s22, s20, 12288
  s_add_u32 s22, s22, 0
  s_add_u32 m0, s22, 0
  s_nop 0
  buffer_load_dwordx4 v4, s[12:15], s21 offen lds
  s_add_u32 m0, s22, 1024
  s_nop 0
  buffer_load_dwordx4 v5, s[12:15], s21 offen lds
  s_add_u32 m0, s22, 2048
  s_nop 0
  buffer_load_dwordx4 v6, s[12:15], s21 offen lds
  s_mul_i32 s21, s20, 393216
  s_add_u32 s21, s21, 98304
  s_add_u32 s21, s21, s44
  s_mul_i32 s22, s20, 12288
  s_add_u32 s22, s22, 3072
  s_add_u32 m0, s22, 0
  s_nop 0
  buffer_load_dwordx4 v4, s[12:15], s21 offen lds
  s_add_u32 m0, s22, 1024
  s_nop 0
  buffer_load_dwordx4 v5, s[12:15], s21 offen lds
  s_add_u32 m0, s22, 2048
  s_nop 0
  buffer_load_dwordx4 v6, s[12:15], s21 offen lds
  s_mul_i32 s21, s20, 393216
  s_add_u32 s21, s21, 196608
  s_add_u32 s21, s21, s44
  s_mul_i32 s22, s20, 12288
  s_add_u32 s22, s22, 6144
  s_add_u32 m0, s22, 0
  s_nop 0
  buffer_load_dwordx4 v4, s[12:15], s21 offen lds
  s_add_u32 m0, s22, 1024
  s_nop 0
  buffer_load_dwordx4 v5, s[12:15], s21 offen lds
  s_add_u32 m0, s22, 2048
  s_nop 0
  buffer_load_dwordx4 v6, s[12:15], s21 offen lds
  s_mul_i32 s21, s20, 393216
  s_add_u32 s21, s21, 294912
  s_add_u32 s21, s21, s44
  s_mul_i32 s22, s20, 12288
  s_add_u32 s22, s22, 9216
  s_add_u32 m0, s22, 0
  s_nop 0
  buffer_load_dwordx4 v4, s[12:15], s21 offen lds
  s_add_u32 m0, s22, 1024
  s_nop 0
  buffer_load_dwordx4 v5, s[12:15], s21 offen lds
  s_add_u32 m0, s22, 2048
  s_nop 0
  buffer_load_dwordx4 v6, s[12:15], s21 offen lds
  s_add_u32 m0, s31, 98304
  s_nop 0
  buffer_load_dwordx4 v10, s[8:11], s30 offen lds
  s_add_u32 m0, s31, 99328
  s_nop 0
  buffer_load_dwordx4 v11, s[8:11], s30 offen lds
  s_add_u32 s30, s30, 128
  s_add_u32 m0, s31, 106496
  s_nop 0
  buffer_load_dwordx4 v10, s[8:11], s30 offen lds
  s_add_u32 m0, s31, 107520
  s_nop 0
  buffer_load_dwordx4 v11, s[8:11], s30 offen lds
  s_add_u32 s30, s30, 128
  s_add_u32 m0, s31, 114688
  s_nop 0
  buffer_load_dwordx4 v10, s[8:11], s30 offen lds
  s_add_u32 m0, s31, 115712
  s_nop 0
  buffer_load_dwordx4 v11, s[8:11], s30 offen lds
  s_add_u32 s30, s30, 128
  s_add_u32 m0, s31, 122880
  s_nop 0
  buffer_load_dwordx4 v10, s[8:11], s30 offen lds
  s_add_u32 m0, s31, 123904
  s_nop 0
  buffer_load_dwordx4 v11, s[8:11], s30 offen lds
  s_add_u32 s30, s30, 128
  s_add_u32 m0, s31, 131072
  s_nop 0
  buffer_load_dwordx4 v10, s[8:11], s30 offen lds
  s_add_u32 m0, s31, 132096
  s_nop 0
  buffer_load_dwordx4 v11, s[8:11], s30 offen lds
  s_add_u32 s30, s30, 128
  s_add_u32 m0, s31, 139264
  s_nop 0
  buffer_load_dwordx4 v10, s[8:11], s30 offen lds
  s_add_u32 m0, s31, 140288
  s_nop 0
  buffer_load_dwordx4 v11, s[8:11], s30 offen lds
  s_add_u32 s30, s30, 128
  s_add_u32 m0, s31, 147456
  s_nop 0
  buffer_load_dwordx4 v10, s[8:11], s30 offen lds
  s_add_u32 m0, s31, 148480
  s_nop 0
  buffer_load_dwordx4 v11, s[8:11], s30 offen lds
  s_add_u32 s30, s30, 128
  s_add_u32 m0, s31, 155648
  s_nop 0
  buffer_load_dwordx4 v10, s[8:11], s30 offen lds
  s_add_u32 m0, s31, 156672
  s_nop 0
  buffer_load_dwordx4 v11, s[8:11], s30 offen lds
  s_add_u32 s30, s30, 128
  s_mul_i32 s21, s20, 393216
  s_add_u32 s21, s21, 1572864
  s_add_u32 s21, s21, s44
  s_mul_i32 s22, s20, 12288
  s_add_u32 s22, s22, 49152
  s_add_u32 m0, s22, 0
  s_nop 0
  buffer_load_dwordx4 v4, s[12:15], s21 offen lds
  s_add_u32 m0, s22, 1024
  s_nop 0
  buffer_load_dwordx4 v5, s[12:15], s21 offen lds
  s_add_u32 m0, s22, 2048
  s_nop 0
  buffer_load_dwordx4 v6, s[12:15], s21 offen lds
  s_mul_i32 s21, s20, 393216
  s_add_u32 s21, s21, 1671168
  s_add_u32 s21, s21, s44
  s_mul_i32 s22, s20, 12288
  s_add_u32 s22, s22, 52224
  s_add_u32 m0, s22, 0
  s_nop 0
  buffer_load_dwordx4 v4, s[12:15], s21 offen lds
  s_add_u32 m0, s22, 1024
  s_nop 0
  buffer_load_dwordx4 v5, s[12:15], s21 offen lds
  s_add_u32 m0, s22, 2048
  s_nop 0
  buffer_load_dwordx4 v6, s[12:15], s21 offen lds
  s_mul_i32 s21, s20, 393216
  s_add_u32 s21, s21, 1769472
  s_add_u32 s21, s21, s44
  s_mul_i32 s22, s20, 12288
  s_add_u32 s22, s22, 55296
  s_add_u32 m0, s22, 0
  s_nop 0
  buffer_load_dwordx4 v4, s[12:15], s21 offen lds
  s_add_u32 m0, s22, 1024
  s_nop 0
  buffer_load_dwordx4 v5, s[12:15], s21 offen lds
  s_add_u32 m0, s22, 2048
  s_nop 0
  buffer_load_dwordx4 v6, s[12:15], s21 offen lds
  s_mul_i32 s21, s20, 393216
  s_add_u32 s21, s21, 1867776
  s_add_u32 s21, s21, s44
  s_mul_i32 s22, s20, 12288
  s_add_u32 s22, s22, 58368
  s_add_u32 m0, s22, 0
  s_nop 0
  buffer_load_dwordx4 v4, s[12:15], s21 offen lds
  s_add_u32 m0, s22, 1024
  s_nop 0
  buffer_load_dwordx4 v5, s[12:15], s21 offen lds
  s_add_u32 m0, s22, 2048
  s_nop 0
  buffer_load_dwordx4 v6, s[12:15], s21 offen lds
  s_waitcnt vmcnt(12)
  s_barrier
  ds_read_b64_tr_b16 a[0:1], v7 offset:0
  ds_read_b64_tr_b16 a[2:3], v7 offset:1536
  ds_read_b64_tr_b16 a[4:5], v7 offset:32
  ds_read_b64_tr_b16 a[6:7], v7 offset:1568
  ds_read_b64_tr_b16 a[8:9], v7 offset:64
  ds_read_b64_tr_b16 a[10:11], v7 offset:1600
  ds_read_b64_tr_b16 a[12:13], v7 offset:12288
  ds_read_b64_tr_b16 a[14:15], v7 offset:13824
  ds_read_b64_tr_b16 a[16:17], v7 offset:12320
  ds_read_b64_tr_b16 a[18:19], v7 offset:13856
  ds_read_b64_tr_b16 a[20:21], v7 offset:12352
  ds_read_b64_tr_b16 a[22:23], v7 offset:13888
  ds_read_b64_tr_b16 a[24:25], v7 offset:24576
  ds_read_b64_tr_b16 a[26:27], v7 offset:26112
  ds_read_b64_tr_b16 a[28:29], v7 offset:24608
  ds_read_b64_tr_b16 a[30:31], v7 offset:26144
  ds_read_b64_tr_b16 a[32:33], v7 offset:24640
  ds_read_b64_tr_b16 a[34:35], v7 offset:26176
  ds_read_b64_tr_b16 a[36:37], v7 offset:36864
  ds_read_b64_tr_b16 a[38:39], v7 offset:38400
  ds_read_b64_tr_b16 a[40:41], v7 offset:36896
  ds_read_b64_tr_b16 a[42:43], v7 offset:38432
  ds_read_b64_tr_b16 a[44:45], v7 offset:36928
  ds_read_b64_tr_b16 a[46:47], v7 offset:38464
  s_waitcnt lgkmcnt(0)
  s_barrier
  s_mul_i32 s21, s20, 393216
  s_add_u32 s21, s21, 3145728
  s_add_u32 s21, s21, s44
  s_mul_i32 s22, s20, 12288
  s_add_u32 s22, s22, 0
  s_add_u32 m0, s22, 0
  s_nop 0
  buffer_load_dwordx4 v4, s[12:15], s21 offen lds
  s_add_u32 m0, s22, 1024
  s_nop 0
  buffer_load_dwordx4 v5, s[12:15], s21 offen lds
  s_add_u32 m0, s22, 2048
  s_nop 0
  buffer_load_dwordx4 v6, s[12:15], s21 offen lds
  s_mul_i32 s21, s20, 393216
  s_add_u32 s21, s21, 3244032
  s_add_u32 s21, s21, s44
  s_mul_i32 s22, s20, 12288
  s_add_u32 s22, s22, 3072
  s_add_u32 m0, s22, 0
  s_nop 0
  buffer_load_dwordx4 v4, s[12:15], s21 offen lds
  s_add_u32 m0, s22, 1024
  s_nop 0
  buffer_load_dwordx4 v5, s[12:15], s21 offen lds
  s_add_u32 m0, s22, 2048
  s_nop 0
  buffer_load_dwordx4 v6, s[12:15], s21 offen lds
  s_mul_i32 s21, s20, 393216
  s_add_u32 s21, s21, 3342336
  s_add_u32 s21, s21, s44
  s_mul_i32 s22, s20, 12288
  s_add_u32 s22, s22, 6144
  s_add_u32 m0, s22, 0
  s_nop 0
  buffer_load_dwordx4 v4, s[12:15], s21 offen lds
  s_add_u32 m0, s22, 1024
  s_nop 0
  buffer_load_dwordx4 v5, s[12:15], s21 offen lds
  s_add_u32 m0, s22, 2048
  s_nop 0
  buffer_load_dwordx4 v6, s[12:15], s21 offen lds
  s_mul_i32 s21, s20, 393216
  s_add_u32 s21, s21, 3440640
  s_add_u32 s21, s21, s44
  s_mul_i32 s22, s20, 12288
  s_add_u32 s22, s22, 9216
  s_add_u32 m0, s22, 0
  s_nop 0
  buffer_load_dwordx4 v4, s[12:15], s21 offen lds
  s_add_u32 m0, s22, 1024
  s_nop 0
  buffer_load_dwordx4 v5, s[12:15], s21 offen lds
  s_add_u32 m0, s22, 2048
  s_nop 0
  buffer_load_dwordx4 v6, s[12:15], s21 offen lds
  s_waitcnt vmcnt(12)
  s_barrier
  ds_read_b64_tr_b16 a[48:49], v8 offset:0
  ds_read_b64_tr_b16 a[50:51], v8 offset:1536
  ds_read_b64_tr_b16 a[52:53], v8 offset:32
  ds_read_b64_tr_b16 a[54:55], v8 offset:1568
  ds_read_b64_tr_b16 a[56:57], v8 offset:64
  ds_read_b64_tr_b16 a[58:59], v8 offset:1600
  ds_read_b64_tr_b16 a[60:61], v8 offset:12288
  ds_read_b64_tr_b16 a[62:63], v8 offset:13824
  ds_read_b64_tr_b16 a[64:65], v8 offset:12320
  ds_read_b64_tr_b16 a[66:67], v8 offset:13856
  ds_read_b64_tr_b16 a[68:69], v8 offset:12352
  ds_read_b64_tr_b16 a[70:71], v8 offset:13888
  ds_read_b64_tr_b16 a[72:73], v8 offset:24576
  ds_read_b64_tr_b16 a[74:75], v8 offset:26112
  ds_read_b64_tr_b16 a[76:77], v8 offset:24608
  ds_read_b64_tr_b16 a[78:79], v8 offset:26144
  ds_read_b64_tr_b16 a[80:81], v8 offset:24640
  ds_read_b64_tr_b16 a[82:83], v8 offset:26176
  ds_read_b64_tr_b16 a[84:85], v8 offset:36864
  ds_read_b64_tr_b16 a[86:87], v8 offset:38400
  ds_read_b64_tr_b16 a[88:89], v8 offset:36896
  ds_read_b64_tr_b16 a[90:91], v8 offset:38432
  ds_read_b64_tr_b16 a[92:93], v8 offset:36928
  ds_read_b64_tr_b16 a[94:95], v8 offset:38464
  s_waitcnt lgkmcnt(0)
  s_barrier
  s_mul_i32 s21, s20, 393216
  s_add_u32 s21, s21, 4718592
  s_add_u32 s21, s21, s44
  s_mul_i32 s22, s20, 12288
  s_add_u32 s22, s22, 49152
  s_add_u32 m0, s22, 0
  s_nop 0
  buffer_load_dwordx4 v4, s[12:15], s21 offen lds
  s_add_u32 m0, s22, 1024
  s_nop 0
  buffer_load_dwordx4 v5, s[12:15], s21 offen lds
  s_add_u32 m0, s22, 2048
  s_nop 0
  buffer_load_dwordx4 v6, s[12:15], s21 offen lds
  s_mul_i32 s21, s20, 393216
  s_add_u32 s21, s21, 4816896
  s_add_u32 s21, s21, s44
  s_mul_i32 s22, s20, 12288
  s_add_u32 s22, s22, 52224
  s_add_u32 m0, s22, 0
  s_nop 0
  buffer_load_dwordx4 v4, s[12:15], s21 offen lds
  s_add_u32 m0, s22, 1024
  s_nop 0
  buffer_load_dwordx4 v5, s[12:15], s21 offen lds
  s_add_u32 m0, s22, 2048
  s_nop 0
  buffer_load_dwordx4 v6, s[12:15], s21 offen lds
  s_mul_i32 s21, s20, 393216
  s_add_u32 s21, s21, 4915200
  s_add_u32 s21, s21, s44
  s_mul_i32 s22, s20, 12288
  s_add_u32 s22, s22, 55296
  s_add_u32 m0, s22, 0
  s_nop 0
  buffer_load_dwordx4 v4, s[12:15], s21 offen lds
  s_add_u32 m0, s22, 1024
  s_nop 0
  buffer_load_dwordx4 v5, s[12:15], s21 offen lds
  s_add_u32 m0, s22, 2048
  s_nop 0
  buffer_load_dwordx4 v6, s[12:15], s21 offen lds
  s_mul_i32 s21, s20, 393216
  s_add_u32 s21, s21, 5013504
  s_add_u32 s21, s21, s44
  s_mul_i32 s22, s20, 12288
  s_add_u32 s22, s22, 58368
  s_add_u32 m0, s22, 0
  s_nop 0
  buffer_load_dwordx4 v4, s[12:15], s21 offen lds
  s_add_u32 m0, s22, 1024
  s_nop 0
  buffer_load_dwordx4 v5, s[12:15], s21 offen lds
  s_add_u32 m0, s22, 2048
  s_nop 0
  buffer_load_dwordx4 v6, s[12:15], s21 offen lds
  v_mov_b32 v29, 76
  buffer_load_dword v29, v29, s[32:35], 0 offen sc1
  s_waitcnt vmcnt(12)
  s_barrier
  ds_read_b64_tr_b16 a[96:97], v7 offset:0
  ds_read_b64_tr_b16 a[98:99], v7 offset:1536
  ds_read_b64_tr_b16 a[100:101], v7 offset:32
  ds_read_b64_tr_b16 a[102:103], v7 offset:1568
  ds_read_b64_tr_b16 a[104:105], v7 offset:64
  ds_read_b64_tr_b16 a[106:107], v7 offset:1600
  ds_read_b64_tr_b16 a[108:109], v7 offset:12288
  ds_read_b64_tr_b16 a[110:111], v7 offset:13824
  ds_read_b64_tr_b16 a[112:113], v7 offset:12320
  ds_read_b64_tr_b16 a[114:115], v7 offset:13856
  ds_read_b64_tr_b16 a[116:117], v7 offset:12352
  ds_read_b64_tr_b16 a[118:119], v7 offset:13888
  ds_read_b64_tr_b16 a[120:121], v7 offset:24576
  ds_read_b64_tr_b16 a[122:123], v7 offset:26112
  ds_read_b64_tr_b16 a[124:125], v7 offset:24608
  ds_read_b64_tr_b16 a[126:127], v7 offset:26144
  ds_read_b64_tr_b16 a[128:129], v7 offset:24640
  ds_read_b64_tr_b16 a[130:131], v7 offset:26176
  ds_read_b64_tr_b16 a[132:133], v7 offset:36864
  ds_read_b64_tr_b16 a[134:135], v7 offset:38400
  ds_read_b64_tr_b16 a[136:137], v7 offset:36896
  ds_read_b64_tr_b16 a[138:139], v7 offset:38432
  ds_read_b64_tr_b16 a[140:141], v7 offset:36928
  ds_read_b64_tr_b16 a[142:143], v7 offset:38464
  s_waitcnt lgkmcnt(0)
  s_barrier
  s_mul_i32 s21, s20, 393216
  s_add_u32 s21, s21, 6291456
  s_add_u32 s21, s21, s44
  s_mul_i32 s22, s20, 12288
  s_add_u32 s22, s22, 0
  s_add_u32 m0, s22, 0
  s_nop 0
  buffer_load_dwordx4 v4, s[12:15], s21 offen lds
  s_add_u32 m0, s22, 1024
  s_nop 0
  buffer_load_dwordx4 v5, s[12:15], s21 offen lds
  s_add_u32 m0, s22, 2048
  s_nop 0
  buffer_load_dwordx4 v6, s[12:15], s21 offen lds
  s_mul_i32 s21, s20, 393216
  s_add_u32 s21, s21, 6389760
  s_add_u32 s21, s21, s44
  s_mul_i32 s22, s20, 12288
  s_add_u32 s22, s22, 3072
  s_add_u32 m0, s22, 0
  s_nop 0
  buffer_load_dwordx4 v4, s[12:15], s21 offen lds
  s_add_u32 m0, s22, 1024
  s_nop 0
  buffer_load_dwordx4 v5, s[12:15], s21 offen lds
  s_add_u32 m0, s22, 2048
  s_nop 0
  buffer_load_dwordx4 v6, s[12:15], s21 offen lds
  s_mul_i32 s21, s20, 393216
  s_add_u32 s21, s21, 6488064
  s_add_u32 s21, s21, s44
  s_mul_i32 s22, s20, 12288
  s_add_u32 s22, s22, 6144
  s_add_u32 m0, s22, 0
  s_nop 0
  buffer_load_dwordx4 v4, s[12:15], s21 offen lds
  s_add_u32 m0, s22, 1024
  s_nop 0
  buffer_load_dwordx4 v5, s[12:15], s21 offen lds
  s_add_u32 m0, s22, 2048
  s_nop 0
  buffer_load_dwordx4 v6, s[12:15], s21 offen lds
  s_mul_i32 s21, s20, 393216
  s_add_u32 s21, s21, 6586368
  s_add_u32 s21, s21, s44
  s_mul_i32 s22, s20, 12288
  s_add_u32 s22, s22, 9216
  s_add_u32 m0, s22, 0
  s_nop 0
  buffer_load_dwordx4 v4, s[12:15], s21 offen lds
  s_add_u32 m0, s22, 1024
  s_nop 0
  buffer_load_dwordx4 v5, s[12:15], s21 offen lds
  s_add_u32 m0, s22, 2048
  s_nop 0
  buffer_load_dwordx4 v6, s[12:15], s21 offen lds
  s_waitcnt vmcnt(12)
  s_barrier
  ds_read_b64_tr_b16 a[144:145], v8 offset:0
  ds_read_b64_tr_b16 a[146:147], v8 offset:1536
  ds_read_b64_tr_b16 a[148:149], v8 offset:32
  ds_read_b64_tr_b16 a[150:151], v8 offset:1568
  ds_read_b64_tr_b16 a[152:153], v8 offset:64
  ds_read_b64_tr_b16 a[154:155], v8 offset:1600
  ds_read_b64_tr_b16 a[156:157], v8 offset:12288
  ds_read_b64_tr_b16 a[158:159], v8 offset:13824
  ds_read_b64_tr_b16 a[160:161], v8 offset:12320
  ds_read_b64_tr_b16 a[162:163], v8 offset:13856
  ds_read_b64_tr_b16 a[164:165], v8 offset:12352
  ds_read_b64_tr_b16 a[166:167], v8 offset:13888
  ds_read_b64_tr_b16 a[168:169], v8 offset:24576
  ds_read_b64_tr_b16 a[170:171], v8 offset:26112
  ds_read_b64_tr_b16 a[172:173], v8 offset:24608
  ds_read_b64_tr_b16 a[174:175], v8 offset:26144
  ds_read_b64_tr_b16 a[176:177], v8 offset:24640
  ds_read_b64_tr_b16 a[178:179], v8 offset:26176
  ds_read_b64_tr_b16 a[180:181], v8 offset:36864
  ds_read_b64_tr_b16 a[182:183], v8 offset:38400
  ds_read_b64_tr_b16 a[184:185], v8 offset:36896
  ds_read_b64_tr_b16 a[186:187], v8 offset:38432
  ds_read_b64_tr_b16 a[188:189], v8 offset:36928
  ds_read_b64_tr_b16 a[190:191], v8 offset:38464
  s_waitcnt lgkmcnt(0)
  s_barrier
  s_waitcnt vmcnt(0)
  s_barrier
  ds_read_b64_tr_b16 a[192:193], v7 offset:0
  ds_read_b64_tr_b16 a[194:195], v7 offset:1536
  ds_read_b64_tr_b16 a[196:197], v7 offset:32
  ds_read_b64_tr_b16 a[198:199], v7 offset:1568
  ds_read_b64_tr_b16 a[200:201], v7 offset:64
  ds_read_b64_tr_b16 a[202:203], v7 offset:1600
  ds_read_b64_tr_b16 a[204:205], v7 offset:12288
  ds_read_b64_tr_b16 a[206:207], v7 offset:13824
  ds_read_b64_tr_b16 a[208:209], v7 offset:12320
  ds_read_b64_tr_b16 a[210:211], v7 offset:13856
  ds_read_b64_tr_b16 a[212:213], v7 offset:12352
  ds_read_b64_tr_b16 a[214:215], v7 offset:13888
  ds_read_b64_tr_b16 a[216:217], v7 offset:24576
  ds_read_b64_tr_b16 a[218:219], v7 offset:26112
  ds_read_b64_tr_b16 a[220:221], v7 offset:24608
  ds_read_b64_tr_b16 a[222:223], v7 offset:26144
  ds_read_b64_tr_b16 a[224:225], v7 offset:24640
  ds_read_b64_tr_b16 a[226:227], v7 offset:26176
  ds_read_b64_tr_b16 a[228:229], v7 offset:36864
  ds_read_b64_tr_b16 a[230:231], v7 offset:38400
  ds_read_b64_tr_b16 a[232:233], v7 offset:36896
  ds_read_b64_tr_b16 a[234:235], v7 offset:38432
  ds_read_b64_tr_b16 a[236:237], v7 offset:36928
  ds_read_b64_tr_b16 a[238:239], v7 offset:38464
  s_waitcnt lgkmcnt(0)
  s_barrier
  v_and_b32 v6, 7, v2
  v_add_u32 v4, 0, v3
  v_xor_b32 v4, v4, v6
  v_lshlrev_b32 v4, 4, v4
  v_lshl_add_u32 v14, v2, 7, v4
  v_add_u32 v16, 65536, v14
  v_add_u32 v18, 131072, v14
  v_add_u32 v4, 4, v3
  v_xor_b32 v4, v4, v6
  v_lshlrev_b32 v4, 4, v4
  v_lshl_add_u32 v15, v2, 7, v4
  v_add_u32 v17, 65536, v15
  v_add_u32 v19, 131072, v15
  v_lshlrev_b32 v26, 4, v1
  v_mov_b32 v28, 1
  v_mov_b32 v4, 0x40000000
  v_cmp_eq_u32 vcc, 0, v0
  s_nop 1
  v_cndmask_b32 v27, v4, 0, vcc
  s_mov_b32 s26, 6
  s_lshl_b32 s27, s42, 2
  s_add_u32 s27, s27, s20
  s_lshl_b32 s27, s27, 14
  s_lshl_b32 s21, s43, 13
  s_xor_b32 s27, s27, s21
  v_readfirstlane_b32 s100, v29
  s_cmp_lg_u32 s100, 0
  s_cbranch_scc1 kvz_201
  s_mov_b32 s21, 76
  v_mov_b32 v4, 0
  s_mov_b32 s101, 0
wf_202:
  buffer_load_dword v5, v4, s[32:35], s21 offen sc1
  s_add_u32 s101, s101, 1
  s_cmp_gt_u32 s101, 131072
  s_cbranch_scc1 main_end
  s_waitcnt vmcnt(0)
  v_readfirstlane_b32 s100, v5
  s_cmp_ge_u32 s100, 1
  s_cbranch_scc1 wf_203
  s_sleep 8
  s_branch wf_202
wf_203:
kvz_201:
  s_sub_u32 s80, s100, 1
  s_lshl_b32 s80, s80, 13
  s_xor_b32 s27, s27, s80
  s_lshl_b32 s60, s40, 7
  s_add_u32 s60, s60, 28672
  s_xor_b32 s60, s60, s80
  s_mov_b32 s48, 0x40000000
  s_mov_b32 s61, 0x40000000
  s_waitcnt vmcnt(14)
  s_barrier
  ds_read_b128 v[160:163], v16 offset:32768
  ds_read_b128 v[164:167], v16 offset:34816
  ds_read_b128 v[168:171], v16 offset:36864
  ds_read_b128 v[172:175], v16 offset:38912
  s_waitcnt lgkmcnt(3)
  .p2align 3
kvm_204:
  v_mfma_f32_16x16x32_bf16 v[64:67], a[0:3], v[160:163], 0
  s_xor_b32 s29, s48, 0
  ds_read_b128 v[176:179], v17 offset:32768
  v_cvt_pk_bf16_f32 v204, v88, v89
  v_mfma_f32_16x16x32_bf16 v[68:71], a[4:7], v[160:163], 0
  v_cvt_pk_bf16_f32 v205, v90, v91
  v_cvt_pk_bf16_f32 v206, v92, v93
  v_mfma_f32_16x16x32_bf16 v[72:75], a[8:11], v[160:163], 0
  s_waitcnt lgkmcnt(3)
  v_cvt_pk_bf16_f32 v207, v94, v95
  v_cvt_pk_bf16_f32 v212, v96, v97
  v_mfma_f32_16x16x32_bf16 v[76:79], a[0:3], v[164:167], 0
  ds_read_b128 v[180:183], v17 offset:34816
  v_cvt_pk_bf16_f32 v213, v98, v99
  v_mfma_f32_16x16x32_bf16 v[80:83], a[4:7], v[164:167], 0
  v_cvt_pk_bf16_f32 v208, v100, v101
  v_cvt_pk_bf16_f32 v209, v102, v103
  v_mfma_f32_16x16x32_bf16 v[84:87], a[8:11], v[164:167], 0
  s_waitcnt lgkmcnt(3)
  v_cvt_pk_bf16_f32 v210, v104, v105
  v_cvt_pk_bf16_f32 v211, v106, v107
  v_mfma_f32_16x16x32_bf16 v[88:91], a[0:3], v[168:171], 0
  ds_read_b128 v[184:187], v17 offset:36864
  v_cvt_pk_bf16_f32 v214, v108, v109
  v_mfma_f32_16x16x32_bf16 v[92:95], a[4:7], v[168:171], 0
  s_add_u32 m0, s31, 81920
  v_cvt_pk_bf16_f32 v215, v110, v111
  buffer_store_dwordx4 v[192:195], v26, s[16:19], s29 offen offset:0 sc1
  v_mfma_f32_16x16x32_bf16 v[96:99], a[8:11], v[168:171], 0
  s_waitcnt lgkmcnt(3)
  buffer_load_dwordx4 v10, s[8:11], s30 offen lds
  v_mfma_f32_16x16x32_bf16 v[100:103], a[0:3], v[172:175], 0
  ds_read_b128 v[188:191], v17 offset:38912
  v_mfma_f32_16x16x32_bf16 v[104:107], a[4:7], v[172:175], 0
  v_mfma_f32_16x16x32_bf16 v[108:111], a[8:11], v[172:175], 0
  s_waitcnt lgkmcnt(3)
  buffer_store_dwordx4 v[196:199], v26, s[16:19], s29 offen offset:1024 sc1
  v_mfma_f32_16x16x32_bf16 v[64:67], a[12:15], v[176:179], v[64:67]
  s_waitcnt vmcnt(15)
  s_barrier
  ds_read_b128 v[160:163], v16 offset:40960
  v_mfma_f32_16x16x32_bf16 v[68:71], a[16:19], v[176:179], v[68:71]
  s_add_u32 m0, s31, 82944
  v_mfma_f32_16x16x32_bf16 v[72:75], a[20:23], v[176:179], v[72:75]
  s_waitcnt lgkmcnt(3)
  buffer_load_dwordx4 v11, s[8:11], s30 offen lds
  v_mfma_f32_16x16x32_bf16 v[76:79], a[12:15], v[180:183], v[76:79]
  s_add_u32 s30, s30, 128
  ds_read_b128 v[164:167], v16 offset:43008
  buffer_store_dwordx4 v[200:203], v26, s[16:19], s29 offen offset:2048 sc1
  v_mfma_f32_16x16x32_bf16 v[80:83], a[16:19], v[180:183], v[80:83]
  v_mfma_f32_16x16x32_bf16 v[84:87], a[20:23], v[180:183], v[84:87]
  s_waitcnt lgkmcnt(3)
  v_mfma_f32_16x16x32_bf16 v[88:91], a[12:15], v[184:187], v[88:91]
  s_xor_b32 s29, s48, 2105344
  ds_read_b128 v[168:171], v16 offset:45056
  v_mfma_f32_16x16x32_bf16 v[92:95], a[16:19], v[184:187], v[92:95]
  buffer_store_dwordx4 v[204:207], v26, s[16:19], s29 offen offset:0 sc1
  v_mfma_f32_16x16x32_bf16 v[96:99], a[20:23], v[184:187], v[96:99]
  s_waitcnt lgkmcnt(3)
  v_mfma_f32_16x16x32_bf16 v[100:103], a[12:15], v[188:191], v[100:103]
  ds_read_b128 v[172:175], v16 offset:47104
  v_mfma_f32_16x16x32_bf16 v[104:107], a[16:19], v[188:191], v[104:107]
  v_mfma_f32_16x16x32_bf16 v[108:111], a[20:23], v[188:191], v[108:111]
  s_waitcnt lgkmcnt(3)
  buffer_store_dwordx4 v[208:211], v26, s[16:19], s29 offen offset:1024 sc1
  v_mfma_f32_16x16x32_bf16 v[64:67], a[24:27], v[160:163], v[64:67]
  ds_read_b128 v[176:179], v17 offset:40960
  v_mfma_f32_16x16x32_bf16 v[68:71], a[28:31], v[160:163], v[68:71]
  s_add_u32 m0, s31, 90112
  v_mfma_f32_16x16x32_bf16 v[72:75], a[32:35], v[160:163], v[72:75]
  s_waitcnt lgkmcnt(3)
  buffer_load_dwordx4 v10, s[8:11], s30 offen lds
  v_mfma_f32_16x16x32_bf16 v[76:79], a[24:27], v[164:167], v[76:79]
  ds_read_b128 v[180:183], v17 offset:43008
  buffer_store_dwordx4 v[212:215], v26, s[16:19], s29 offen offset:2048 sc1
  v_mfma_f32_16x16x32_bf16 v[80:83], a[28:31], v[164:167], v[80:83]
  v_mfma_f32_16x16x32_bf16 v[84:87], a[32:35], v[164:167], v[84:87]
  s_waitcnt lgkmcnt(3)
  v_mfma_f32_16x16x32_bf16 v[88:91], a[24:27], v[168:171], v[88:91]
  ds_read_b128 v[184:187], v17 offset:45056
  v_mfma_f32_16x16x32_bf16 v[92:95], a[28:31], v[168:171], v[92:95]
  s_add_u32 m0, s31, 91136
  v_mfma_f32_16x16x32_bf16 v[96:99], a[32:35], v[168:171], v[96:99]
  s_waitcnt lgkmcnt(3)
  buffer_load_dwordx4 v11, s[8:11], s30 offen lds
  v_mfma_f32_16x16x32_bf16 v[100:103], a[24:27], v[172:175], v[100:103]
  s_add_u32 s30, s30, s25
  ds_read_b128 v[188:191], v17 offset:47104
  v_mfma_f32_16x16x32_bf16 v[104:107], a[28:31], v[172:175], v[104:107]
  v_mfma_f32_16x16x32_bf16 v[108:111], a[32:35], v[172:175], v[108:111]
  s_waitcnt lgkmcnt(3)
  v_mfma_f32_16x16x32_bf16 v[64:67], a[36:39], v[176:179], v[64:67]
  s_waitcnt vmcnt(20)
  s_barrier
  ds_read_b128 v[160:163], v16 offset:49152
  v_mfma_f32_16x16x32_bf16 v[68:71], a[40:43], v[176:179], v[68:71]
  v_mfma_f32_16x16x32_bf16 v[72:75], a[44:47], v[176:179], v[72:75]
  s_waitcnt lgkmcnt(3)
  v_mfma_f32_16x16x32_bf16 v[76:79], a[36:39], v[180:183], v[76:79]
  ds_read_b128 v[164:167], v16 offset:51200
  v_mfma_f32_16x16x32_bf16 v[80:83], a[40:43], v[180:183], v[80:83]
  v_mfma_f32_16x16x32_bf16 v[84:87], a[44:47], v[180:183], v[84:87]
  s_waitcnt lgkmcnt(3)
  v_mfma_f32_16x16x32_bf16 v[88:91], a[36:39], v[184:187], v[88:91]
  ds_read_b128 v[168:171], v16 offset:53248
  v_mfma_f32_16x16x32_bf16 v[92:95], a[40:43], v[184:187], v[92:95]
  v_mfma_f32_16x16x32_bf16 v[96:99], a[44:47], v[184:187], v[96:99]
  s_waitcnt lgkmcnt(3)
  v_mfma_f32_16x16x32_bf16 v[100:103], a[36:39], v[188:191], v[100:103]
  ds_read_b128 v[172:175], v16 offset:55296
  v_mfma_f32_16x16x32_bf16 v[104:107], a[40:43], v[188:191], v[104:107]
  v_mfma_f32_16x16x32_bf16 v[108:111], a[44:47], v[188:191], v[108:111]
  s_waitcnt lgkmcnt(3)
  v_mfma_f32_16x16x32_bf16 v[64:67], a[48:51], v[160:163], v[64:67]
  ds_read_b128 v[176:179], v17 offset:49152
  v_mfma_f32_16x16x32_bf16 v[68:71], a[52:55], v[160:163], v[68:71]
  s_add_u32 m0, s31, 98304
  v_mfma_f32_16x16x32_bf16 v[72:75], a[56:59], v[160:163], v[72:75]
  s_waitcnt lgkmcnt(3)
  buffer_load_dwordx4 v10, s[8:11], s30 offen lds
  v_mfma_f32_16x16x32_bf16 v[76:79], a[48:51], v[164:167], v[76:79]
  ds_read_b128 v[180:183], v17 offset:51200
  v_mfma_f32_16x16x32_bf16 v[80:83], a[52:55], v[164:167], v[80:83]
  v_mfma_f32_16x16x32_bf16 v[84:87], a[56:59], v[164:167], v[84:87]
  s_waitcnt lgkmcnt(3)
  v_mfma_f32_16x16x32_bf16 v[88:91], a[48:51], v[168:171], v[88:91]
  ds_read_b128 v[184:187], v17 offset:53248
  v_mfma_f32_16x16x32_bf16 v[92:95], a[52:55], v[168:171], v[92:95]
  s_add_u32 m0, s31, 99328
  v_mfma_f32_16x16x32_bf16 v[96:99], a[56:59], v[168:171], v[96:99]
  s_waitcnt lgkmcnt(3)
  buffer_load_dwordx4 v11, s[8:11], s30 offen lds
  v_mfma_f32_16x16x32_bf16 v[100:103], a[48:51], v[172:175], v[100:103]
  s_add_u32 s30, s30, 128
  ds_read_b128 v[188:191], v17 offset:55296
  v_mfma_f32_16x16x32_bf16 v[104:107], a[52:55], v[172:175], v[104:107]
  v_mfma_f32_16x16x32_bf16 v[108:111], a[56:59], v[172:175], v[108:111]
  s_waitcnt lgkmcnt(3)
  v_mfma_f32_16x16x32_bf16 v[64:67], a[60:63], v[176:179], v[64:67]
  s_waitcnt vmcnt(20)
  s_barrier
  ds_read_b128 v[160:163], v16 offset:57344
  v_mfma_f32_16x16x32_bf16 v[68:71], a[64:67], v[176:179], v[68:71]
  v_mfma_f32_16x16x32_bf16 v[72:75], a[68:71], v[176:179], v[72:75]
  s_waitcnt lgkmcnt(3)
  v_mfma_f32_16x16x32_bf16 v[76:79], a[60:63], v[180:183], v[76:79]
  ds_read_b128 v[164:167], v16 offset:59392
  v_mfma_f32_16x16x32_bf16 v[80:83], a[64:67], v[180:183], v[80:83]
  v_mfma_f32_16x16x32_bf16 v[84:87], a[68:71], v[180:183], v[84:87]
  s_waitcnt lgkmcnt(3)
  v_mfma_f32_16x16x32_bf16 v[88:91], a[60:63], v[184:187], v[88:91]
  ds_read_b128 v[168:171], v16 offset:61440
  v_mfma_f32_16x16x32_bf16 v[92:95], a[64:67], v[184:187], v[92:95]
  v_mfma_f32_16x16x32_bf16 v[96:99], a[68:71], v[184:187], v[96:99]
  s_waitcnt lgkmcnt(3)
  v_mfma_f32_16x16x32_bf16 v[100:103], a[60:63], v[188:191], v[100:103]
  ds_read_b128 v[172:175], v16 offset:63488
  v_mfma_f32_16x16x32_bf16 v[104:107], a[64:67], v[188:191], v[104:107]
  v_mfma_f32_16x16x32_bf16 v[108:111], a[68:71], v[188:191], v[108:111]
  s_waitcnt lgkmcnt(3)
  v_mfma_f32_16x16x32_bf16 v[64:67], a[72:75], v[160:163], v[64:67]
  ds_read_b128 v[176:179], v17 offset:57344
  v_mfma_f32_16x16x32_bf16 v[68:71], a[76:79], v[160:163], v[68:71]
  s_add_u32 m0, s31, 106496
  v_mfma_f32_16x16x32_bf16 v[72:75], a[80:83], v[160:163], v[72:75]
  s_waitcnt lgkmcnt(3)
  buffer_load_dwordx4 v10, s[8:11], s30 offen lds
  v_mfma_f32_16x16x32_bf16 v[76:79], a[72:75], v[164:167], v[76:79]
  ds_read_b128 v[180:183], v17 offset:59392
  v_mfma_f32_16x16x32_bf16 v[80:83], a[76:79], v[164:167], v[80:83]
  v_mfma_f32_16x16x32_bf16 v[84:87], a[80:83], v[164:167], v[84:87]
  s_waitcnt lgkmcnt(3)
  v_mfma_f32_16x16x32_bf16 v[88:91], a[72:75], v[168:171], v[88:91]
  ds_read_b128 v[184:187], v17 offset:61440
  v_mfma_f32_16x16x32_bf16 v[92:95], a[76:79], v[168:171], v[92:95]
  s_add_u32 m0, s31, 107520
  v_mfma_f32_16x16x32_bf16 v[96:99], a[80:83], v[168:171], v[96:99]
  s_waitcnt lgkmcnt(3)
  buffer_load_dwordx4 v11, s[8:11], s30 offen lds
  v_mfma_f32_16x16x32_bf16 v[100:103], a[72:75], v[172:175], v[100:103]
  s_add_u32 s30, s30, 128
  ds_read_b128 v[188:191], v17 offset:63488
  v_mfma_f32_16x16x32_bf16 v[104:107], a[76:79], v[172:175], v[104:107]
  v_mfma_f32_16x16x32_bf16 v[108:111], a[80:83], v[172:175], v[108:111]
  s_waitcnt lgkmcnt(3)
  v_mfma_f32_16x16x32_bf16 v[64:67], a[84:87], v[176:179], v[64:67]
  s_waitcnt vmcnt(5)
  s_barrier
  ds_read_b128 v[160:163], v18 offset:0
  v_mfma_f32_16x16x32_bf16 v[68:71], a[88:91], v[176:179], v[68:71]
  buffer_atomic_add v28, v27, s[72:75], s61 offen sc1
  v_mfma_f32_16x16x32_bf16 v[72:75], a[92:95], v[176:179], v[72:75]
  s_waitcnt lgkmcnt(3)
  s_mov_b32 s48, s27
  s_add_u32 s27, s27, 4194304
  v_mfma_f32_16x16x32_bf16 v[76:79], a[84:87], v[180:183], v[76:79]
  s_mov_b32 s61, s60
  ds_read_b128 v[164:167], v18 offset:2048
  s_add_u32 s60, s60, 4
  v_mfma_f32_16x16x32_bf16 v[80:83], a[88:91], v[180:183], v[80:83]
  v_mfma_f32_16x16x32_bf16 v[84:87], a[92:95], v[180:183], v[84:87]
  s_waitcnt lgkmcnt(3)
  v_mfma_f32_16x16x32_bf16 v[88:91], a[84:87], v[184:187], v[88:91]
  ds_read_b128 v[168:171], v18 offset:4096
  v_mfma_f32_16x16x32_bf16 v[92:95], a[88:91], v[184:187], v[92:95]
  v_mfma_f32_16x16x32_bf16 v[96:99], a[92:95], v[184:187], v[96:99]
  s_waitcnt lgkmcnt(3)
  v_mfma_f32_16x16x32_bf16 v[100:103], a[84:87], v[188:191], v[100:103]
  ds_read_b128 v[172:175], v18 offset:6144
  v_mfma_f32_16x16x32_bf16 v[104:107], a[88:91], v[188:191], v[104:107]
  v_mfma_f32_16x16x32_bf16 v[108:111], a[92:95], v[188:191], v[108:111]
  s_waitcnt lgkmcnt(3)
  v_mfma_f32_16x16x32_bf16 v[64:67], a[96:99], v[160:163], v[64:67]
  ds_read_b128 v[176:179], v19 offset:0
  v_mfma_f32_16x16x32_bf16 v[68:71], a[100:103], v[160:163], v[68:71]
  s_add_u32 m0, s31, 114688
  v_mfma_f32_16x16x32_bf16 v[72:75], a[104:107], v[160:163], v[72:75]
  s_waitcnt lgkmcnt(3)
  buffer_load_dwordx4 v10, s[8:11], s30 offen lds
  v_mfma_f32_16x16x32_bf16 v[76:79], a[96:99], v[164:167], v[76:79]
  ds_read_b128 v[180:183], v19 offset:2048
  v_mfma_f32_16x16x32_bf16 v[80:83], a[100:103], v[164:167], v[80:83]
  v_mfma_f32_16x16x32_bf16 v[84:87], a[104:107], v[164:167], v[84:87]
  s_waitcnt lgkmcnt(3)
  v_mfma_f32_16x16x32_bf16 v[88:91], a[96:99], v[168:171], v[88:91]
  ds_read_b128 v[184:187], v19 offset:4096
  v_mfma_f32_16x16x32_bf16 v[92:95], a[100:103], v[168:171], v[92:95]
  s_add_u32 m0, s31, 115712
  v_mfma_f32_16x16x32_bf16 v[96:99], a[104:107], v[168:171], v[96:99]
  s_waitcnt lgkmcnt(3)
  buffer_load_dwordx4 v11, s[8:11], s30 offen lds
  v_mfma_f32_16x16x32_bf16 v[100:103], a[96:99], v[172:175], v[100:103]
  s_add_u32 s30, s30, 128
  ds_read_b128 v[188:191], v19 offset:6144
  v_mfma_f32_16x16x32_bf16 v[104:107], a[100:103], v[172:175], v[104:107]
  v_mfma_f32_16x16x32_bf16 v[108:111], a[104:107], v[172:175], v[108:111]
  s_waitcnt lgkmcnt(3)
  v_mfma_f32_16x16x32_bf16 v[64:67], a[108:111], v[176:179], v[64:67]
  s_waitcnt vmcnt(21)
  s_barrier
  ds_read_b128 v[160:163], v18 offset:8192
  v_mfma_f32_16x16x32_bf16 v[68:71], a[112:115], v[176:179], v[68:71]
  v_mfma_f32_16x16x32_bf16 v[72:75], a[116:119], v[176:179], v[72:75]
  s_waitcnt lgkmcnt(3)
  v_mfma_f32_16x16x32_bf16 v[76:79], a[108:111], v[180:183], v[76:79]
  ds_read_b128 v[164:167], v18 offset:10240
  v_mfma_f32_16x16x32_bf16 v[80:83], a[112:115], v[180:183], v[80:83]
  v_mfma_f32_16x16x32_bf16 v[84:87], a[116:119], v[180:183], v[84:87]
  s_waitcnt lgkmcnt(3)
  v_mfma_f32_16x16x32_bf16 v[88:91], a[108:111], v[184:187], v[88:91]
  ds_read_b128 v[168:171], v18 offset:12288
  v_mfma_f32_16x16x32_bf16 v[92:95], a[112:115], v[184:187], v[92:95]
  v_mfma_f32_16x16x32_bf16 v[96:99], a[116:119], v[184:187], v[96:99]
  s_waitcnt lgkmcnt(3)
  v_mfma_f32_16x16x32_bf16 v[100:103], a[108:111], v[188:191], v[100:103]
  ds_read_b128 v[172:175], v18 offset:14336
  v_mfma_f32_16x16x32_bf16 v[104:107], a[112:115], v[188:191], v[104:107]
  v_mfma_f32_16x16x32_bf16 v[108:111], a[116:119], v[188:191], v[108:111]
  s_waitcnt lgkmcnt(3)
  v_mfma_f32_16x16x32_bf16 v[64:67], a[120:123], v[160:163], v[64:67]
  ds_read_b128 v[176:179], v19 offset:8192
  v_mfma_f32_16x16x32_bf16 v[68:71], a[124:127], v[160:163], v[68:71]
  s_add_u32 m0, s31, 122880
  v_mfma_f32_16x16x32_bf16 v[72:75], a[128:131], v[160:163], v[72:75]
  s_waitcnt lgkmcnt(3)
  buffer_load_dwordx4 v10, s[8:11], s30 offen lds
  v_mfma_f32_16x16x32_bf16 v[76:79], a[120:123], v[164:167], v[76:79]
  ds_read_b128 v[180:183], v19 offset:10240
  v_mfma_f32_16x16x32_bf16 v[80:83], a[124:127], v[164:167], v[80:83]
  v_mfma_f32_16x16x32_bf16 v[84:87], a[128:131], v[164:167], v[84:87]
  s_waitcnt lgkmcnt(3)
  v_mfma_f32_16x16x32_bf16 v[88:91], a[120:123], v[168:171], v[88:91]
  ds_read_b128 v[184:187], v19 offset:12288
  v_mfma_f32_16x16x32_bf16 v[92:95], a[124:127], v[168:171], v[92:95]
  s_add_u32 m0, s31, 123904
  v_mfma_f32_16x16x32_bf16 v[96:99], a[128:131], v[168:171], v[96:99]
  s_waitcnt lgkmcnt(3)
  buffer_load_dwordx4 v11, s[8:11], s30 offen lds
  v_mfma_f32_16x16x32_bf16 v[100:103], a[120:123], v[172:175], v[100:103]
  s_add_u32 s30, s30, 128
  ds_read_b128 v[188:191], v19 offset:14336
  v_mfma_f32_16x16x32_bf16 v[104:107], a[124:127], v[172:175], v[104:107]
  v_mfma_f32_16x16x32_bf16 v[108:111], a[128:131], v[172:175], v[108:111]
  s_waitcnt lgkmcnt(3)
  v_mfma_f32_16x16x32_bf16 v[64:67], a[132:135], v[176:179], v[64:67]
  s_waitcnt vmcnt(21)
  s_barrier
  ds_read_b128 v[160:163], v18 offset:16384
  v_mfma_f32_16x16x32_bf16 v[68:71], a[136:139], v[176:179], v[68:71]
  v_mfma_f32_16x16x32_bf16 v[72:75], a[140:143], v[176:179], v[72:75]
  s_waitcnt lgkmcnt(3)
  v_mfma_f32_16x16x32_bf16 v[76:79], a[132:135], v[180:183], v[76:79]
  ds_read_b128 v[164:167], v18 offset:18432
  v_mfma_f32_16x16x32_bf16 v[80:83], a[136:139], v[180:183], v[80:83]
  v_mfma_f32_16x16x32_bf16 v[84:87], a[140:143], v[180:183], v[84:87]
  s_waitcnt lgkmcnt(3)
  v_mfma_f32_16x16x32_bf16 v[88:91], a[132:135], v[184:187], v[88:91]
  ds_read_b128 v[168:171], v18 offset:20480
  v_mfma_f32_16x16x32_bf16 v[92:95], a[136:139], v[184:187], v[92:95]
  v_mfma_f32_16x16x32_bf16 v[96:99], a[140:143], v[184:187], v[96:99]
  s_waitcnt lgkmcnt(3)
  v_mfma_f32_16x16x32_bf16 v[100:103], a[132:135], v[188:191], v[100:103]
  ds_read_b128 v[172:175], v18 offset:22528
  v_mfma_f32_16x16x32_bf16 v[104:107], a[136:139], v[188:191], v[104:107]
  v_mfma_f32_16x16x32_bf16 v[108:111], a[140:143], v[188:191], v[108:111]
  s_waitcnt lgkmcnt(3)
  v_mfma_f32_16x16x32_bf16 v[64:67], a[144:147], v[160:163], v[64:67]
  ds_read_b128 v[176:179], v19 offset:16384
  v_mfma_f32_16x16x32_bf16 v[68:71], a[148:151], v[160:163], v[68:71]
  s_add_u32 m0, s31, 131072
  v_mfma_f32_16x16x32_bf16 v[72:75], a[152:155], v[160:163], v[72:75]
  s_waitcnt lgkmcnt(3)
  buffer_load_dwordx4 v10, s[8:11], s30 offen lds
  v_mfma_f32_16x16x32_bf16 v[76:79], a[144:147], v[164:167], v[76:79]
  ds_read_b128 v[180:183], v19 offset:18432
  v_mfma_f32_16x16x32_bf16 v[80:83], a[148:151], v[164:167], v[80:83]
  v_mfma_f32_16x16x32_bf16 v[84:87], a[152:155], v[164:167], v[84:87]
  s_waitcnt lgkmcnt(3)
  v_mfma_f32_16x16x32_bf16 v[88:91], a[144:147], v[168:171], v[88:91]
  ds_read_b128 v[184:187], v19 offset:20480
  v_mfma_f32_16x16x32_bf16 v[92:95], a[148:151], v[168:171], v[92:95]
  s_add_u32 m0, s31, 132096
  v_mfma_f32_16x16x32_bf16 v[96:99], a[152:155], v[168:171], v[96:99]
  s_waitcnt lgkmcnt(3)
  buffer_load_dwordx4 v11, s[8:11], s30 offen lds
  v_mfma_f32_16x16x32_bf16 v[100:103], a[144:147], v[172:175], v[100:103]
  s_add_u32 s30, s30, 128
  ds_read_b128 v[188:191], v19 offset:22528
  v_mfma_f32_16x16x32_bf16 v[104:107], a[148:151], v[172:175], v[104:107]
  v_mfma_f32_16x16x32_bf16 v[108:111], a[152:155], v[172:175], v[108:111]
  s_waitcnt lgkmcnt(3)
  v_mfma_f32_16x16x32_bf16 v[64:67], a[156:159], v[176:179], v[64:67]
  s_waitcnt vmcnt(21)
  s_barrier
  ds_read_b128 v[160:163], v18 offset:24576
  v_mfma_f32_16x16x32_bf16 v[68:71], a[160:163], v[176:179], v[68:71]
  v_mfma_f32_16x16x32_bf16 v[72:75], a[164:167], v[176:179], v[72:75]
  s_waitcnt lgkmcnt(3)
  v_mfma_f32_16x16x32_bf16 v[76:79], a[156:159], v[180:183], v[76:79]
  ds_read_b128 v[164:167], v18 offset:26624
  v_mfma_f32_16x16x32_bf16 v[80:83], a[160:163], v[180:183], v[80:83]
  v_mfma_f32_16x16x32_bf16 v[84:87], a[164:167], v[180:183], v[84:87]
  s_waitcnt lgkmcnt(3)
  v_mfma_f32_16x16x32_bf16 v[88:91], a[156:159], v[184:187], v[88:91]
  ds_read_b128 v[168:171], v18 offset:28672
  v_mfma_f32_16x16x32_bf16 v[92:95], a[160:163], v[184:187], v[92:95]
  v_mfma_f32_16x16x32_bf16 v[96:99], a[164:167], v[184:187], v[96:99]
  s_waitcnt lgkmcnt(3)
  v_mfma_f32_16x16x32_bf16 v[100:103], a[156:159], v[188:191], v[100:103]
  ds_read_b128 v[172:175], v18 offset:30720
  v_mfma_f32_16x16x32_bf16 v[104:107], a[160:163], v[188:191], v[104:107]
  v_mfma_f32_16x16x32_bf16 v[108:111], a[164:167], v[188:191], v[108:111]
  s_waitcnt lgkmcnt(3)
  v_mfma_f32_16x16x32_bf16 v[64:67], a[168:171], v[160:163], v[64:67]
  ds_read_b128 v[176:179], v19 offset:24576
  v_mfma_f32_16x16x32_bf16 v[68:71], a[172:175], v[160:163], v[68:71]
  s_add_u32 m0, s31, 139264
  v_mfma_f32_16x16x32_bf16 v[72:75], a[176:179], v[160:163], v[72:75]
  s_waitcnt lgkmcnt(3)
  buffer_load_dwordx4 v10, s[8:11], s30 offen lds
  v_mfma_f32_16x16x32_bf16 v[76:79], a[168:171], v[164:167], v[76:79]
  ds_read_b128 v[180:183], v19 offset:26624
  v_mfma_f32_16x16x32_bf16 v[80:83], a[172:175], v[164:167], v[80:83]
  v_mfma_f32_16x16x32_bf16 v[84:87], a[176:179], v[164:167], v[84:87]
  s_waitcnt lgkmcnt(3)
  v_mfma_f32_16x16x32_bf16 v[88:91], a[168:171], v[168:171], v[88:91]
  ds_read_b128 v[184:187], v19 offset:28672
  v_mfma_f32_16x16x32_bf16 v[92:95], a[172:175], v[168:171], v[92:95]
  s_add_u32 m0, s31, 140288
  v_mfma_f32_16x16x32_bf16 v[96:99], a[176:179], v[168:171], v[96:99]
  s_waitcnt lgkmcnt(3)
  buffer_load_dwordx4 v11, s[8:11], s30 offen lds
  v_mfma_f32_16x16x32_bf16 v[100:103], a[168:171], v[172:175], v[100:103]
  s_add_u32 s30, s30, 128
  ds_read_b128 v[188:191], v19 offset:30720
  v_mfma_f32_16x16x32_bf16 v[104:107], a[172:175], v[172:175], v[104:107]
  v_mfma_f32_16x16x32_bf16 v[108:111], a[176:179], v[172:175], v[108:111]
  s_waitcnt lgkmcnt(3)
  v_mfma_f32_16x16x32_bf16 v[64:67], a[180:183], v[176:179], v[64:67]
  s_waitcnt vmcnt(19)
  s_barrier
  ds_read_b128 v[160:163], v16 offset:16384
  v_mfma_f32_16x16x32_bf16 v[68:71], a[184:187], v[176:179], v[68:71]
  v_mfma_f32_16x16x32_bf16 v[72:75], a[188:191], v[176:179], v[72:75]
  s_waitcnt lgkmcnt(3)
  v_mfma_f32_16x16x32_bf16 v[76:79], a[180:183], v[180:183], v[76:79]
  ds_read_b128 v[164:167], v16 offset:18432
  v_mfma_f32_16x16x32_bf16 v[80:83], a[184:187], v[180:183], v[80:83]
  v_mfma_f32_16x16x32_bf16 v[84:87], a[188:191], v[180:183], v[84:87]
  s_waitcnt lgkmcnt(3)
  v_mfma_f32_16x16x32_bf16 v[88:91], a[180:183], v[184:187], v[88:91]
  ds_read_b128 v[168:171], v16 offset:20480
  v_mfma_f32_16x16x32_bf16 v[92:95], a[184:187], v[184:187], v[92:95]
  v_mfma_f32_16x16x32_bf16 v[96:99], a[188:191], v[184:187], v[96:99]
  s_waitcnt lgkmcnt(3)
  v_mfma_f32_16x16x32_bf16 v[100:103], a[180:183], v[188:191], v[100:103]
  ds_read_b128 v[172:175], v16 offset:22528
  v_mfma_f32_16x16x32_bf16 v[104:107], a[184:187], v[188:191], v[104:107]
  v_mfma_f32_16x16x32_bf16 v[108:111], a[188:191], v[188:191], v[108:111]
  s_waitcnt lgkmcnt(3)
  v_mfma_f32_16x16x32_bf16 v[64:67], a[192:195], v[160:163], v[64:67]
  ds_read_b128 v[176:179], v17 offset:16384
  v_mfma_f32_16x16x32_bf16 v[68:71], a[196:199], v[160:163], v[68:71]
  s_add_u32 m0, s31, 147456
  v_mfma_f32_16x16x32_bf16 v[72:75], a[200:203], v[160:163], v[72:75]
  s_waitcnt lgkmcnt(3)
  buffer_load_dwordx4 v10, s[8:11], s30 offen lds
  v_mfma_f32_16x16x32_bf16 v[76:79], a[192:195], v[164:167], v[76:79]
  ds_read_b128 v[180:183], v17 offset:18432
  v_mfma_f32_16x16x32_bf16 v[80:83], a[196:199], v[164:167], v[80:83]
  v_mfma_f32_16x16x32_bf16 v[84:87], a[200:203], v[164:167], v[84:87]
  s_waitcnt lgkmcnt(3)
  v_mfma_f32_16x16x32_bf16 v[88:91], a[192:195], v[168:171], v[88:91]
  ds_read_b128 v[184:187], v17 offset:20480
  v_mfma_f32_16x16x32_bf16 v[92:95], a[196:199], v[168:171], v[92:95]
  s_add_u32 m0, s31, 148480
  v_mfma_f32_16x16x32_bf16 v[96:99], a[200:203], v[168:171], v[96:99]
  s_waitcnt lgkmcnt(3)
  buffer_load_dwordx4 v11, s[8:11], s30 offen lds
  v_mfma_f32_16x16x32_bf16 v[100:103], a[192:195], v[172:175], v[100:103]
  s_add_u32 s30, s30, 128
  ds_read_b128 v[188:191], v17 offset:22528
  v_mfma_f32_16x16x32_bf16 v[104:107], a[196:199], v[172:175], v[104:107]
  v_mfma_f32_16x16x32_bf16 v[108:111], a[200:203], v[172:175], v[108:111]
  s_waitcnt lgkmcnt(3)
  v_mfma_f32_16x16x32_bf16 v[64:67], a[204:207], v[176:179], v[64:67]
  s_waitcnt vmcnt(15)
  s_barrier
  ds_read_b128 v[160:163], v16 offset:24576
  v_mfma_f32_16x16x32_bf16 v[68:71], a[208:211], v[176:179], v[68:71]
  v_mfma_f32_16x16x32_bf16 v[72:75], a[212:215], v[176:179], v[72:75]
  s_waitcnt lgkmcnt(3)
  v_mfma_f32_16x16x32_bf16 v[76:79], a[204:207], v[180:183], v[76:79]
  ds_read_b128 v[164:167], v16 offset:26624
  v_mfma_f32_16x16x32_bf16 v[80:83], a[208:211], v[180:183], v[80:83]
  v_mfma_f32_16x16x32_bf16 v[84:87], a[212:215], v[180:183], v[84:87]
  s_waitcnt lgkmcnt(3)
  v_mfma_f32_16x16x32_bf16 v[88:91], a[204:207], v[184:187], v[88:91]
  ds_read_b128 v[168:171], v16 offset:28672
  v_mfma_f32_16x16x32_bf16 v[92:95], a[208:211], v[184:187], v[92:95]
  v_mfma_f32_16x16x32_bf16 v[96:99], a[212:215], v[184:187], v[96:99]
  s_waitcnt lgkmcnt(3)
  v_mfma_f32_16x16x32_bf16 v[100:103], a[204:207], v[188:191], v[100:103]
  ds_read_b128 v[172:175], v16 offset:30720
  v_mfma_f32_16x16x32_bf16 v[104:107], a[208:211], v[188:191], v[104:107]
  v_mfma_f32_16x16x32_bf16 v[108:111], a[212:215], v[188:191], v[108:111]
  s_waitcnt lgkmcnt(3)
  v_mfma_f32_16x16x32_bf16 v[64:67], a[216:219], v[160:163], v[64:67]
  ds_read_b128 v[176:179], v17 offset:24576
  v_mfma_f32_16x16x32_bf16 v[68:71], a[220:223], v[160:163], v[68:71]
  s_add_u32 m0, s31, 155648
  v_mfma_f32_16x16x32_bf16 v[72:75], a[224:227], v[160:163], v[72:75]
  s_waitcnt lgkmcnt(3)
  buffer_load_dwordx4 v10, s[8:11], s30 offen lds
  v_mfma_f32_16x16x32_bf16 v[76:79], a[216:219], v[164:167], v[76:79]
  ds_read_b128 v[180:183], v17 offset:26624
  v_mfma_f32_16x16x32_bf16 v[80:83], a[220:223], v[164:167], v[80:83]
  v_mfma_f32_16x16x32_bf16 v[84:87], a[224:227], v[164:167], v[84:87]
  s_waitcnt lgkmcnt(3)
  v_mfma_f32_16x16x32_bf16 v[88:91], a[216:219], v[168:171], v[88:91]
  ds_read_b128 v[184:187], v17 offset:28672
  v_mfma_f32_16x16x32_bf16 v[92:95], a[220:223], v[168:171], v[92:95]
  s_add_u32 m0, s31, 156672
  v_mfma_f32_16x16x32_bf16 v[96:99], a[224:227], v[168:171], v[96:99]
  s_waitcnt lgkmcnt(3)
  buffer_load_dwordx4 v11, s[8:11], s30 offen lds
  v_mfma_f32_16x16x32_bf16 v[100:103], a[216:219], v[172:175], v[100:103]
  s_add_u32 s30, s30, 128
  ds_read_b128 v[188:191], v17 offset:30720
  v_mfma_f32_16x16x32_bf16 v[104:107], a[220:223], v[172:175], v[104:107]
  v_mfma_f32_16x16x32_bf16 v[108:111], a[224:227], v[172:175], v[108:111]
  s_waitcnt lgkmcnt(3)
  v_mfma_f32_16x16x32_bf16 v[64:67], a[228:231], v[176:179], v[64:67]
  s_waitcnt vmcnt(15)
  s_barrier
  ds_read_b128 v[160:163], v16 offset:32768
  v_mfma_f32_16x16x32_bf16 v[68:71], a[232:235], v[176:179], v[68:71]
  v_mfma_f32_16x16x32_bf16 v[72:75], a[236:239], v[176:179], v[72:75]
  s_waitcnt lgkmcnt(3)
  v_mfma_f32_16x16x32_bf16 v[76:79], a[228:231], v[180:183], v[76:79]
  ds_read_b128 v[164:167], v16 offset:34816
  v_cvt_pk_bf16_f32 v192, v64, v65
  v_mfma_f32_16x16x32_bf16 v[80:83], a[232:235], v[180:183], v[80:83]
  v_cvt_pk_bf16_f32 v193, v66, v67
  v_cvt_pk_bf16_f32 v194, v68, v69
  v_mfma_f32_16x16x32_bf16 v[84:87], a[236:239], v[180:183], v[84:87]
  s_waitcnt lgkmcnt(3)
  v_cvt_pk_bf16_f32 v195, v70, v71
  v_cvt_pk_bf16_f32 v200, v72, v73
  v_mfma_f32_16x16x32_bf16 v[88:91], a[228:231], v[184:187], v[88:91]
  ds_read_b128 v[168:171], v16 offset:36864
  v_cvt_pk_bf16_f32 v201, v74, v75
  v_mfma_f32_16x16x32_bf16 v[92:95], a[232:235], v[184:187], v[92:95]
  v_cvt_pk_bf16_f32 v196, v76, v77
  v_cvt_pk_bf16_f32 v197, v78, v79
  v_mfma_f32_16x16x32_bf16 v[96:99], a[236:239], v[184:187], v[96:99]
  s_waitcnt lgkmcnt(3)
  v_cvt_pk_bf16_f32 v198, v80, v81
  v_cvt_pk_bf16_f32 v199, v82, v83
  v_mfma_f32_16x16x32_bf16 v[100:103], a[228:231], v[188:191], v[100:103]
  ds_read_b128 v[172:175], v16 offset:38912
  v_cvt_pk_bf16_f32 v202, v84, v85
  v_mfma_f32_16x16x32_bf16 v[104:107], a[232:235], v[188:191], v[104:107]
  s_sub_u32 s26, s26, 1
  s_cmp_gt_u32 s26, 0
  v_cvt_pk_bf16_f32 v203, v86, v87
  v_mfma_f32_16x16x32_bf16 v[108:111], a[236:239], v[188:191], v[108:111]
  s_waitcnt lgkmcnt(3)
  s_cbranch_scc1 kvm_204
  s_nop 7
  v_cvt_pk_bf16_f32 v204, v88, v89
  v_cvt_pk_bf16_f32 v205, v90, v91
  v_cvt_pk_bf16_f32 v206, v92, v93
  v_cvt_pk_bf16_f32 v207, v94, v95
  v_cvt_pk_bf16_f32 v212, v96, v97
  v_cvt_pk_bf16_f32 v213, v98, v99
  v_cvt_pk_bf16_f32 v208, v100, v101
  v_cvt_pk_bf16_f32 v209, v102, v103
  v_cvt_pk_bf16_f32 v210, v104, v105
  v_cvt_pk_bf16_f32 v211, v106, v107
  v_cvt_pk_bf16_f32 v214, v108, v109
  v_cvt_pk_bf16_f32 v215, v110, v111
  s_xor_b32 s29, s48, 0
  buffer_store_dwordx4 v[192:195], v26, s[16:19], s29 offen offset:0 sc1
  buffer_store_dwordx4 v[196:199], v26, s[16:19], s29 offen offset:1024 sc1
  buffer_store_dwordx4 v[200:203], v26, s[16:19], s29 offen offset:2048 sc1
  s_xor_b32 s29, s48, 2105344
  buffer_store_dwordx4 v[204:207], v26, s[16:19], s29 offen offset:0 sc1
  buffer_store_dwordx4 v[208:211], v26, s[16:19], s29 offen offset:1024 sc1
  buffer_store_dwordx4 v[212:215], v26, s[16:19], s29 offen offset:2048 sc1
  s_mov_b32 s30, 491520
  s_mov_b32 s25, 162688
  v_lshrrev_b32 v4, 3, v1
  v_and_b32 v5, 7, v1
  v_xor_b32 v5, v5, v4
  s_mul_i32 s21, s20, 32
  v_add_u32 v4, s21, v4
  v_mul_u32_u24 v4, 1280, v4
  v_lshl_add_u32 v10, v5, 4, v4
  s_mul_i32 s31, s20, 4096
  v_add_u32 v11, 10240, v10
  v_add_u32 v12, 20480, v10
  v_add_u32 v13, 30720, v10
  s_add_u32 m0, s31, 0
  s_nop 0
  buffer_load_dwordx4 v10, s[8:11], s30 offen lds
  s_add_u32 m0, s31, 1024
  s_nop 0
  buffer_load_dwordx4 v11, s[8:11], s30 offen lds
  s_add_u32 m0, s31, 2048
  s_nop 0
  buffer_load_dwordx4 v12, s[8:11], s30 offen lds
  s_add_u32 m0, s31, 3072
  s_nop 0
  buffer_load_dwordx4 v13, s[8:11], s30 offen lds
  s_add_u32 s30, s30, 128
  s_add_u32 m0, s31, 16384
  s_nop 0
  buffer_load_dwordx4 v10, s[8:11], s30 offen lds
  s_add_u32 m0, s31, 17408
  s_nop 0
  buffer_load_dwordx4 v11, s[8:11], s30 offen lds
  s_add_u32 m0, s31, 18432
  s_nop 0
  buffer_load_dwordx4 v12, s[8:11], s30 offen lds
  s_add_u32 m0, s31, 19456
  s_nop 0
  buffer_load_dwordx4 v13, s[8:11], s30 offen lds
  s_add_u32 s30, s30, 128
  s_add_u32 m0, s31, 32768
  s_nop 0
  buffer_load_dwordx4 v10, s[8:11], s30 offen lds
  s_add_u32 m0, s31, 33792
  s_nop 0
  buffer_load_dwordx4 v11, s[8:11], s30 offen lds
  s_add_u32 m0, s31, 34816
  s_nop 0
  buffer_load_dwordx4 v12, s[8:11], s30 offen lds
  s_add_u32 m0, s31, 35840
  s_nop 0
  buffer_load_dwordx4 v13, s[8:11], s30 offen lds
  s_add_u32 s30, s30, 128
  s_add_u32 m0, s31, 49152
  s_nop 0
  buffer_load_dwordx4 v10, s[8:11], s30 offen lds
  s_add_u32 m0, s31, 50176
  s_nop 0
  buffer_load_dwordx4 v11, s[8:11], s30 offen lds
  s_add_u32 m0, s31, 51200
  s_nop 0
  buffer_load_dwordx4 v12, s[8:11], s30 offen lds
  s_add_u32 m0, s31, 52224
  s_nop 0
  buffer_load_dwordx4 v13, s[8:11], s30 offen lds
  s_add_u32 s30, s30, 128
  s_add_u32 m0, s31, 65536
  s_nop 0
  buffer_load_dwordx4 v10, s[8:11], s30 offen lds
  s_add_u32 m0, s31, 66560
  s_nop 0
  buffer_load_dwordx4 v11, s[8:11], s30 offen lds
  s_add_u32 m0, s31, 67584
  s_nop 0
  buffer_load_dwordx4 v12, s[8:11], s30 offen lds
  s_add_u32 m0, s31, 68608
  s_nop 0
  buffer_load_dwordx4 v13, s[8:11], s30 offen lds
  s_add_u32 s30, s30, 128
  s_waitcnt vmcnt(20) lgkmcnt(0)
  s_barrier
  buffer_atomic_add v28, v27, s[72:75], s61 offen sc1
  s_add_u32 m0, s31, 81920
  s_nop 0
  buffer_load_dwordx4 v10, s[8:11], s30 offen lds
  s_add_u32 m0, s31, 82944
  s_nop 0
  buffer_load_dwordx4 v11, s[8:11], s30 offen lds
  s_add_u32 m0, s31, 83968
  s_nop 0
  buffer_load_dwordx4 v12, s[8:11], s30 offen lds
  s_add_u32 m0, s31, 84992
  s_nop 0
  buffer_load_dwordx4 v13, s[8:11], s30 offen lds
  s_add_u32 s30, s30, 128
  s_mov_b32 s26, 13
  s_mov_b32 s48, 0x40000000
  s_mov_b32 s61, 0x40000000
  s_waitcnt vmcnt(16)
  s_barrier
  ds_read_b128 v[160:163], v14 offset:0
  ds_read_b128 v[164:167], v14 offset:2048
  ds_read_b128 v[168:171], v14 offset:4096
  ds_read_b128 v[172:175], v14 offset:6144
  s_waitcnt lgkmcnt(3)
  .p2align 3
kvs_205:
  v_mfma_f32_16x16x32_bf16 v[64:67], a[0:3], v[160:163], 0
  s_xor_b32 s29, s48, 0
  ds_read_b128 v[176:179], v14 offset:8192
  v_cvt_pk_bf16_f32 v221, v126, v127
  v_mfma_f32_16x16x32_bf16 v[68:71], a[4:7], v[160:163], 0
  v_cvt_pk_bf16_f32 v222, v128, v129
  v_cvt_pk_bf16_f32 v223, v130, v131
  v_mfma_f32_16x16x32_bf16 v[72:75], a[8:11], v[160:163], 0
  s_waitcnt lgkmcnt(3)
  v_cvt_pk_bf16_f32 v226, v132, v133
  v_cvt_pk_bf16_f32 v227, v134, v135
  v_mfma_f32_16x16x32_bf16 v[76:79], a[0:3], v[164:167], 0
  ds_read_b128 v[180:183], v14 offset:10240
  v_cvt_pk_bf16_f32 v228, v136, v137
  v_mfma_f32_16x16x32_bf16 v[80:83], a[4:7], v[164:167], 0
  v_cvt_pk_bf16_f32 v229, v138, v139
  v_cvt_pk_bf16_f32 v230, v140, v141
  v_mfma_f32_16x16x32_bf16 v[84:87], a[8:11], v[164:167], 0
  s_waitcnt lgkmcnt(3)
  v_cvt_pk_bf16_f32 v231, v142, v143
  v_cvt_pk_bf16_f32 v236, v144, v145
  v_mfma_f32_16x16x32_bf16 v[88:91], a[0:3], v[168:171], 0
  ds_read_b128 v[184:187], v14 offset:12288
  v_cvt_pk_bf16_f32 v237, v146, v147
  v_mfma_f32_16x16x32_bf16 v[92:95], a[4:7], v[168:171], 0
  v_cvt_pk_bf16_f32 v232, v148, v149
  v_cvt_pk_bf16_f32 v233, v150, v151
  v_mfma_f32_16x16x32_bf16 v[96:99], a[8:11], v[168:171], 0
  s_waitcnt lgkmcnt(3)
  v_cvt_pk_bf16_f32 v234, v152, v153
  v_cvt_pk_bf16_f32 v235, v154, v155
  v_mfma_f32_16x16x32_bf16 v[100:103], a[0:3], v[172:175], 0
  ds_read_b128 v[188:191], v14 offset:14336
  v_cvt_pk_bf16_f32 v238, v156, v157
  v_mfma_f32_16x16x32_bf16 v[104:107], a[4:7], v[172:175], 0
  v_cvt_pk_bf16_f32 v239, v158, v159
  buffer_store_dwordx4 v[192:195], v26, s[16:19], s29 offen offset:0 sc1
  v_mfma_f32_16x16x32_bf16 v[108:111], a[8:11], v[172:175], 0
  s_waitcnt lgkmcnt(3)
  v_mfma_f32_16x16x32_bf16 v[112:115], a[0:3], v[176:179], 0
  ds_read_b128 v[160:163], v15 offset:0
  v_mfma_f32_16x16x32_bf16 v[116:119], a[4:7], v[176:179], 0
  s_add_u32 m0, s31, 98304
  v_mfma_f32_16x16x32_bf16 v[120:123], a[8:11], v[176:179], 0
  s_waitcnt lgkmcnt(3)
  buffer_load_dwordx4 v10, s[8:11], s30 offen lds
  v_mfma_f32_16x16x32_bf16 v[124:127], a[0:3], v[180:183], 0
  ds_read_b128 v[164:167], v15 offset:2048
  v_mfma_f32_16x16x32_bf16 v[128:131], a[4:7], v[180:183], 0
  v_mfma_f32_16x16x32_bf16 v[132:135], a[8:11], v[180:183], 0
  s_waitcnt lgkmcnt(3)
  buffer_store_dwordx4 v[196:199], v26, s[16:19], s29 offen offset:1024 sc1
  v_mfma_f32_16x16x32_bf16 v[136:139], a[0:3], v[184:187], 0
  ds_read_b128 v[168:171], v15 offset:4096
  v_mfma_f32_16x16x32_bf16 v[140:143], a[4:7], v[184:187], 0
  s_add_u32 m0, s31, 99328
  v_mfma_f32_16x16x32_bf16 v[144:147], a[8:11], v[184:187], 0
  s_waitcnt lgkmcnt(3)
  buffer_load_dwordx4 v11, s[8:11], s30 offen lds
  v_mfma_f32_16x16x32_bf16 v[148:151], a[0:3], v[188:191], 0
  ds_read_b128 v[172:175], v15 offset:6144
  v_mfma_f32_16x16x32_bf16 v[152:155], a[4:7], v[188:191], 0
  v_mfma_f32_16x16x32_bf16 v[156:159], a[8:11], v[188:191], 0
  s_waitcnt lgkmcnt(3)
  v_mfma_f32_16x16x32_bf16 v[64:67], a[12:15], v[160:163], v[64:67]
  ds_read_b128 v[176:179], v15 offset:8192
  buffer_store_dwordx4 v[200:203], v26, s[16:19], s29 offen offset:2048 sc1
  v_mfma_f32_16x16x32_bf16 v[68:71], a[16:19], v[160:163], v[68:71]
  s_add_u32 m0, s31, 100352
  v_mfma_f32_16x16x32_bf16 v[72:75], a[20:23], v[160:163], v[72:75]
  s_waitcnt lgkmcnt(3)
  buffer_load_dwordx4 v12, s[8:11], s30 offen lds
  v_mfma_f32_16x16x32_bf16 v[76:79], a[12:15], v[164:167], v[76:79]
  ds_read_b128 v[180:183], v15 offset:10240
  v_mfma_f32_16x16x32_bf16 v[80:83], a[16:19], v[164:167], v[80:83]
  v_mfma_f32_16x16x32_bf16 v[84:87], a[20:23], v[164:167], v[84:87]
  s_waitcnt lgkmcnt(3)
  v_mfma_f32_16x16x32_bf16 v[88:91], a[12:15], v[168:171], v[88:91]
  s_xor_b32 s29, s48, 2105344
  ds_read_b128 v[184:187], v15 offset:12288
  v_mfma_f32_16x16x32_bf16 v[92:95], a[16:19], v[168:171], v[92:95]
  s_add_u32 m0, s31, 101376
  buffer_store_dwordx4 v[204:207], v26, s[16:19], s29 offen offset:0 sc1
  v_mfma_f32_16x16x32_bf16 v[96:99], a[20:23], v[168:171], v[96:99]
  s_waitcnt lgkmcnt(3)
  buffer_load_dwordx4 v13, s[8:11], s30 offen lds
  v_mfma_f32_16x16x32_bf16 v[100:103], a[12:15], v[172:175], v[100:103]
  s_add_u32 s30, s30, 128
  ds_read_b128 v[188:191], v15 offset:14336
  v_mfma_f32_16x16x32_bf16 v[104:107], a[16:19], v[172:175], v[104:107]
  v_mfma_f32_16x16x32_bf16 v[108:111], a[20:23], v[172:175], v[108:111]
  s_waitcnt lgkmcnt(3)
  v_mfma_f32_16x16x32_bf16 v[112:115], a[12:15], v[176:179], v[112:115]
  ds_read_b128 v[160:163], v14 offset:16384
  v_mfma_f32_16x16x32_bf16 v[116:119], a[16:19], v[176:179], v[116:119]
  v_mfma_f32_16x16x32_bf16 v[120:123], a[20:23], v[176:179], v[120:123]
  s_waitcnt lgkmcnt(3)
  buffer_store_dwordx4 v[208:211], v26, s[16:19], s29 offen offset:1024 sc1
  v_mfma_f32_16x16x32_bf16 v[124:127], a[12:15], v[180:183], v[124:127]
  ds_read_b128 v[164:167], v14 offset:18432
  v_mfma_f32_16x16x32_bf16 v[128:131], a[16:19], v[180:183], v[128:131]
  v_mfma_f32_16x16x32_bf16 v[132:135], a[20:23], v[180:183], v[132:135]
  s_waitcnt lgkmcnt(3)
  v_mfma_f32_16x16x32_bf16 v[136:139], a[12:15], v[184:187], v[136:139]
  ds_read_b128 v[168:171], v14 offset:20480
  v_mfma_f32_16x16x32_bf16 v[140:143], a[16:19], v[184:187], v[140:143]
  v_mfma_f32_16x16x32_bf16 v[144:147], a[20:23], v[184:187], v[144:147]
  s_waitcnt lgkmcnt(3)
  v_mfma_f32_16x16x32_bf16 v[148:151], a[12:15], v[188:191], v[148:151]
  ds_read_b128 v[172:175], v14 offset:22528
  buffer_store_dwordx4 v[212:215], v26, s[16:19], s29 offen offset:2048 sc1
  v_mfma_f32_16x16x32_bf16 v[152:155], a[16:19], v[188:191], v[152:155]
  v_mfma_f32_16x16x32_bf16 v[156:159], a[20:23], v[188:191], v[156:159]
  s_waitcnt lgkmcnt(3)
  v_mfma_f32_16x16x32_bf16 v[64:67], a[24:27], v[160:163], v[64:67]
  ds_read_b128 v[176:179], v14 offset:24576
  v_mfma_f32_16x16x32_bf16 v[68:71], a[28:31], v[160:163], v[68:71]
  s_add_u32 m0, s31, 114688
  v_mfma_f32_16x16x32_bf16 v[72:75], a[32:35], v[160:163], v[72:75]
  s_waitcnt lgkmcnt(3)
  buffer_load_dwordx4 v10, s[8:11], s30 offen lds
  v_mfma_f32_16x16x32_bf16 v[76:79], a[24:27], v[164:167], v[76:79]
  s_xor_b32 s29, s48, 4194304
  ds_read_b128 v[180:183], v14 offset:26624
  v_mfma_f32_16x16x32_bf16 v[80:83], a[28:31], v[164:167], v[80:83]
  buffer_store_dwordx4 v[216:219], v26, s[16:19], s29 offen offset:0 sc1
  v_mfma_f32_16x16x32_bf16 v[84:87], a[32:35], v[164:167], v[84:87]
  s_waitcnt lgkmcnt(3)
  v_mfma_f32_16x16x32_bf16 v[88:91], a[24:27], v[168:171], v[88:91]
  ds_read_b128 v[184:187], v14 offset:28672
  v_mfma_f32_16x16x32_bf16 v[92:95], a[28:31], v[168:171], v[92:95]
  s_add_u32 m0, s31, 115712
  v_mfma_f32_16x16x32_bf16 v[96:99], a[32:35], v[168:171], v[96:99]
  s_waitcnt lgkmcnt(3)
  buffer_load_dwordx4 v11, s[8:11], s30 offen lds
  v_mfma_f32_16x16x32_bf16 v[100:103], a[24:27], v[172:175], v[100:103]
  ds_read_b128 v[188:191], v14 offset:30720
  v_mfma_f32_16x16x32_bf16 v[104:107], a[28:31], v[172:175], v[104:107]
  v_mfma_f32_16x16x32_bf16 v[108:111], a[32:35], v[172:175], v[108:111]
  s_waitcnt lgkmcnt(3)
  buffer_store_dwordx4 v[220:223], v26, s[16:19], s29 offen offset:1024 sc1
  v_mfma_f32_16x16x32_bf16 v[112:115], a[24:27], v[176:179], v[112:115]
  ds_read_b128 v[160:163], v15 offset:16384
  v_mfma_f32_16x16x32_bf16 v[116:119], a[28:31], v[176:179], v[116:119]
  s_add_u32 m0, s31, 116736
  v_mfma_f32_16x16x32_bf16 v[120:123], a[32:35], v[176:179], v[120:123]
  s_waitcnt lgkmcnt(3)
  buffer_load_dwordx4 v12, s[8:11], s30 offen lds
  v_mfma_f32_16x16x32_bf16 v[124:127], a[24:27], v[180:183], v[124:127]
  ds_read_b128 v[164:167], v15 offset:18432
  v_mfma_f32_16x16x32_bf16 v[128:131], a[28:31], v[180:183], v[128:131]
  v_mfma_f32_16x16x32_bf16 v[132:135], a[32:35], v[180:183], v[132:135]
  s_waitcnt lgkmcnt(3)
  v_mfma_f32_16x16x32_bf16 v[136:139], a[24:27], v[184:187], v[136:139]
  ds_read_b128 v[168:171], v15 offset:20480
  buffer_store_dwordx4 v[224:227], v26, s[16:19], s29 offen offset:2048 sc1
  v_mfma_f32_16x16x32_bf16 v[140:143], a[28:31], v[184:187], v[140:143]
  s_add_u32 m0, s31, 117760
  v_mfma_f32_16x16x32_bf16 v[144:147], a[32:35], v[184:187], v[144:147]
  s_waitcnt lgkmcnt(3)
  buffer_load_dwordx4 v13, s[8:11], s30 offen lds
  v_mfma_f32_16x16x32_bf16 v[148:151], a[24:27], v[188:191], v[148:151]
  s_add_u32 s30, s30, 128
  ds_read_b128 v[172:175], v15 offset:22528
  v_mfma_f32_16x16x32_bf16 v[152:155], a[28:31], v[188:191], v[152:155]
  v_mfma_f32_16x16x32_bf16 v[156:159], a[32:35], v[188:191], v[156:159]
  s_waitcnt lgkmcnt(3)
  v_mfma_f32_16x16x32_bf16 v[64:67], a[36:39], v[160:163], v[64:67]
  s_xor_b32 s29, s48, 6299648
  ds_read_b128 v[176:179], v15 offset:24576
  v_mfma_f32_16x16x32_bf16 v[68:71], a[40:43], v[160:163], v[68:71]
  buffer_store_dwordx4 v[228:231], v26, s[16:19], s29 offen offset:0 sc1
  v_mfma_f32_16x16x32_bf16 v[72:75], a[44:47], v[160:163], v[72:75]
  s_waitcnt lgkmcnt(3)
  v_mfma_f32_16x16x32_bf16 v[76:79], a[36:39], v[164:167], v[76:79]
  ds_read_b128 v[180:183], v15 offset:26624
  v_mfma_f32_16x16x32_bf16 v[80:83], a[40:43], v[164:167], v[80:83]
  v_mfma_f32_16x16x32_bf16 v[84:87], a[44:47], v[164:167], v[84:87]
  s_waitcnt lgkmcnt(3)
  v_mfma_f32_16x16x32_bf16 v[88:91], a[36:39], v[168:171], v[88:91]
  ds_read_b128 v[184:187], v15 offset:28672
  v_mfma_f32_16x16x32_bf16 v[92:95], a[40:43], v[168:171], v[92:95]
  v_mfma_f32_16x16x32_bf16 v[96:99], a[44:47], v[168:171], v[96:99]
  s_waitcnt lgkmcnt(3)
  buffer_store_dwordx4 v[232:235], v26, s[16:19], s29 offen offset:1024 sc1
  v_mfma_f32_16x16x32_bf16 v[100:103], a[36:39], v[172:175], v[100:103]
  ds_read_b128 v[188:191], v15 offset:30720
  v_mfma_f32_16x16x32_bf16 v[104:107], a[40:43], v[172:175], v[104:107]
  v_mfma_f32_16x16x32_bf16 v[108:111], a[44:47], v[172:175], v[108:111]
  s_waitcnt lgkmcnt(3)
  v_mfma_f32_16x16x32_bf16 v[112:115], a[36:39], v[176:179], v[112:115]
  s_waitcnt vmcnt(27)
  s_barrier
  ds_read_b128 v[160:163], v14 offset:32768
  v_mfma_f32_16x16x32_bf16 v[116:119], a[40:43], v[176:179], v[116:119]
  v_mfma_f32_16x16x32_bf16 v[120:123], a[44:47], v[176:179], v[120:123]
  s_waitcnt lgkmcnt(3)
  v_mfma_f32_16x16x32_bf16 v[124:127], a[36:39], v[180:183], v[124:127]
  ds_read_b128 v[164:167], v14 offset:34816
  buffer_store_dwordx4 v[236:239], v26, s[16:19], s29 offen offset:2048 sc1
  v_mfma_f32_16x16x32_bf16 v[128:131], a[40:43], v[180:183], v[128:131]
  v_mfma_f32_16x16x32_bf16 v[132:135], a[44:47], v[180:183], v[132:135]
  s_waitcnt lgkmcnt(3)
  v_mfma_f32_16x16x32_bf16 v[136:139], a[36:39], v[184:187], v[136:139]
  ds_read_b128 v[168:171], v14 offset:36864
  v_mfma_f32_16x16x32_bf16 v[140:143], a[40:43], v[184:187], v[140:143]
  v_mfma_f32_16x16x32_bf16 v[144:147], a[44:47], v[184:187], v[144:147]
  s_waitcnt lgkmcnt(3)
  v_mfma_f32_16x16x32_bf16 v[148:151], a[36:39], v[188:191], v[148:151]
  ds_read_b128 v[172:175], v14 offset:38912
  v_mfma_f32_16x16x32_bf16 v[152:155], a[40:43], v[188:191], v[152:155]
  v_mfma_f32_16x16x32_bf16 v[156:159], a[44:47], v[188:191], v[156:159]
  s_waitcnt lgkmcnt(3)
  v_mfma_f32_16x16x32_bf16 v[64:67], a[48:51], v[160:163], v[64:67]
  ds_read_b128 v[176:179], v14 offset:40960
  v_mfma_f32_16x16x32_bf16 v[68:71], a[52:55], v[160:163], v[68:71]
  s_add_u32 m0, s31, 131072
  v_mfma_f32_16x16x32_bf16 v[72:75], a[56:59], v[160:163], v[72:75]
  s_waitcnt lgkmcnt(3)
  buffer_load_dwordx4 v10, s[8:11], s30 offen lds
  v_mfma_f32_16x16x32_bf16 v[76:79], a[48:51], v[164:167], v[76:79]
  ds_read_b128 v[180:183], v14 offset:43008
  v_mfma_f32_16x16x32_bf16 v[80:83], a[52:55], v[164:167], v[80:83]
  v_mfma_f32_16x16x32_bf16 v[84:87], a[56:59], v[164:167], v[84:87]
  s_waitcnt lgkmcnt(3)
  v_mfma_f32_16x16x32_bf16 v[88:91], a[48:51], v[168:171], v[88:91]
  ds_read_b128 v[184:187], v14 offset:45056
  v_mfma_f32_16x16x32_bf16 v[92:95], a[52:55], v[168:171], v[92:95]
  s_add_u32 m0, s31, 132096
  v_mfma_f32_16x16x32_bf16 v[96:99], a[56:59], v[168:171], v[96:99]
  s_waitcnt lgkmcnt(3)
  buffer_load_dwordx4 v11, s[8:11], s30 offen lds
  v_mfma_f32_16x16x32_bf16 v[100:103], a[48:51], v[172:175], v[100:103]
  ds_read_b128 v[188:191], v14 offset:47104
  v_mfma_f32_16x16x32_bf16 v[104:107], a[52:55], v[172:175], v[104:107]
  v_mfma_f32_16x16x32_bf16 v[108:111], a[56:59], v[172:175], v[108:111]
  s_waitcnt lgkmcnt(3)
  v_mfma_f32_16x16x32_bf16 v[112:115], a[48:51], v[176:179], v[112:115]
  ds_read_b128 v[160:163], v15 offset:32768
  v_mfma_f32_16x16x32_bf16 v[116:119], a[52:55], v[176:179], v[116:119]
  s_add_u32 m0, s31, 133120
  v_mfma_f32_16x16x32_bf16 v[120:123], a[56:59], v[176:179], v[120:123]
  s_waitcnt lgkmcnt(3)
  buffer_load_dwordx4 v12, s[8:11], s30 offen lds
  v_mfma_f32_16x16x32_bf16 v[124:127], a[48:51], v[180:183], v[124:127]
  ds_read_b128 v[164:167], v15 offset:34816
  v_mfma_f32_16x16x32_bf16 v[128:131], a[52:55], v[180:183], v[128:131]
  v_mfma_f32_16x16x32_bf16 v[132:135], a[56:59], v[180:183], v[132:135]
  s_waitcnt lgkmcnt(3)
  v_mfma_f32_16x16x32_bf16 v[136:139], a[48:51], v[184:187], v[136:139]
  ds_read_b128 v[168:171], v15 offset:36864
  v_mfma_f32_16x16x32_bf16 v[140:143], a[52:55], v[184:187], v[140:143]
  s_add_u32 m0, s31, 134144
  v_mfma_f32_16x16x32_bf16 v[144:147], a[56:59], v[184:187], v[144:147]
  s_waitcnt lgkmcnt(3)
  buffer_load_dwordx4 v13, s[8:11], s30 offen lds
  v_mfma_f32_16x16x32_bf16 v[148:151], a[48:51], v[188:191], v[148:151]
  s_add_u32 s30, s30, 128
  ds_read_b128 v[172:175], v15 offset:38912
  v_mfma_f32_16x16x32_bf16 v[152:155], a[52:55], v[188:191], v[152:155]
  v_mfma_f32_16x16x32_bf16 v[156:159], a[56:59], v[188:191], v[156:159]
  s_waitcnt lgkmcnt(3)
  v_mfma_f32_16x16x32_bf16 v[64:67], a[60:63], v[160:163], v[64:67]
  ds_read_b128 v[176:179], v15 offset:40960
  v_mfma_f32_16x16x32_bf16 v[68:71], a[64:67], v[160:163], v[68:71]
  v_mfma_f32_16x16x32_bf16 v[72:75], a[68:71], v[160:163], v[72:75]
  s_waitcnt lgkmcnt(3)
  v_mfma_f32_16x16x32_bf16 v[76:79], a[60:63], v[164:167], v[76:79]
  ds_read_b128 v[180:183], v15 offset:43008
  v_mfma_f32_16x16x32_bf16 v[80:83], a[64:67], v[164:167], v[80:83]
  v_mfma_f32_16x16x32_bf16 v[84:87], a[68:71], v[164:167], v[84:87]
  s_waitcnt lgkmcnt(3)
  v_mfma_f32_16x16x32_bf16 v[88:91], a[60:63], v[168:171], v[88:91]
  ds_read_b128 v[184:187], v15 offset:45056
  v_mfma_f32_16x16x32_bf16 v[92:95], a[64:67], v[168:171], v[92:95]
  v_mfma_f32_16x16x32_bf16 v[96:99], a[68:71], v[168:171], v[96:99]
  s_waitcnt lgkmcnt(3)
  v_mfma_f32_16x16x32_bf16 v[100:103], a[60:63], v[172:175], v[100:103]
  ds_read_b128 v[188:191], v15 offset:47104
  v_mfma_f32_16x16x32_bf16 v[104:107], a[64:67], v[172:175], v[104:107]
  v_mfma_f32_16x16x32_bf16 v[108:111], a[68:71], v[172:175], v[108:111]
  s_waitcnt lgkmcnt(3)
  v_mfma_f32_16x16x32_bf16 v[112:115], a[60:63], v[176:179], v[112:115]
  ds_read_b128 v[160:163], v14 offset:49152
  v_mfma_f32_16x16x32_bf16 v[116:119], a[64:67], v[176:179], v[116:119]
  v_mfma_f32_16x16x32_bf16 v[120:123], a[68:71], v[176:179], v[120:123]
  s_waitcnt lgkmcnt(3)
  v_mfma_f32_16x16x32_bf16 v[124:127], a[60:63], v[180:183], v[124:127]
  ds_read_b128 v[164:167], v14 offset:51200
  v_mfma_f32_16x16x32_bf16 v[128:131], a[64:67], v[180:183], v[128:131]
  v_mfma_f32_16x16x32_bf16 v[132:135], a[68:71], v[180:183], v[132:135]
  s_waitcnt lgkmcnt(3)
  v_mfma_f32_16x16x32_bf16 v[136:139], a[60:63], v[184:187], v[136:139]
  ds_read_b128 v[168:171], v14 offset:53248
  v_mfma_f32_16x16x32_bf16 v[140:143], a[64:67], v[184:187], v[140:143]
  v_mfma_f32_16x16x32_bf16 v[144:147], a[68:71], v[184:187], v[144:147]
  s_waitcnt lgkmcnt(3)
  v_mfma_f32_16x16x32_bf16 v[148:151], a[60:63], v[188:191], v[148:151]
  ds_read_b128 v[172:175], v14 offset:55296
  v_mfma_f32_16x16x32_bf16 v[152:155], a[64:67], v[188:191], v[152:155]
  v_mfma_f32_16x16x32_bf16 v[156:159], a[68:71], v[188:191], v[156:159]
  s_waitcnt lgkmcnt(3)
  v_mfma_f32_16x16x32_bf16 v[64:67], a[72:75], v[160:163], v[64:67]
  ds_read_b128 v[176:179], v14 offset:57344
  v_mfma_f32_16x16x32_bf16 v[68:71], a[76:79], v[160:163], v[68:71]
  s_add_u32 m0, s31, 147456
  v_mfma_f32_16x16x32_bf16 v[72:75], a[80:83], v[160:163], v[72:75]
  s_waitcnt lgkmcnt(3)
  buffer_load_dwordx4 v10, s[8:11], s30 offen lds
  v_mfma_f32_16x16x32_bf16 v[76:79], a[72:75], v[164:167], v[76:79]
  ds_read_b128 v[180:183], v14 offset:59392
  v_mfma_f32_16x16x32_bf16 v[80:83], a[76:79], v[164:167], v[80:83]
  v_mfma_f32_16x16x32_bf16 v[84:87], a[80:83], v[164:167], v[84:87]
  s_waitcnt lgkmcnt(3)
  v_mfma_f32_16x16x32_bf16 v[88:91], a[72:75], v[168:171], v[88:91]
  ds_read_b128 v[184:187], v14 offset:61440
  v_mfma_f32_16x16x32_bf16 v[92:95], a[76:79], v[168:171], v[92:95]
  s_add_u32 m0, s31, 148480
  v_mfma_f32_16x16x32_bf16 v[96:99], a[80:83], v[168:171], v[96:99]
  s_waitcnt lgkmcnt(3)
  buffer_load_dwordx4 v11, s[8:11], s30 offen lds
  v_mfma_f32_16x16x32_bf16 v[100:103], a[72:75], v[172:175], v[100:103]
  ds_read_b128 v[188:191], v14 offset:63488
  v_mfma_f32_16x16x32_bf16 v[104:107], a[76:79], v[172:175], v[104:107]
  v_mfma_f32_16x16x32_bf16 v[108:111], a[80:83], v[172:175], v[108:111]
  s_waitcnt lgkmcnt(3)
  v_mfma_f32_16x16x32_bf16 v[112:115], a[72:75], v[176:179], v[112:115]
  ds_read_b128 v[160:163], v15 offset:49152
  v_mfma_f32_16x16x32_bf16 v[116:119], a[76:79], v[176:179], v[116:119]
  s_add_u32 m0, s31, 149504
  v_mfma_f32_16x16x32_bf16 v[120:123], a[80:83], v[176:179], v[120:123]
  s_waitcnt lgkmcnt(3)
  buffer_load_dwordx4 v12, s[8:11], s30 offen lds
  v_mfma_f32_16x16x32_bf16 v[124:127], a[72:75], v[180:183], v[124:127]
  ds_read_b128 v[164:167], v15 offset:51200
  v_mfma_f32_16x16x32_bf16 v[128:131], a[76:79], v[180:183], v[128:131]
  v_mfma_f32_16x16x32_bf16 v[132:135], a[80:83], v[180:183], v[132:135]
  s_waitcnt lgkmcnt(3)
  v_mfma_f32_16x16x32_bf16 v[136:139], a[72:75], v[184:187], v[136:139]
  ds_read_b128 v[168:171], v15 offset:53248
  v_mfma_f32_16x16x32_bf16 v[140:143], a[76:79], v[184:187], v[140:143]
  s_add_u32 m0, s31, 150528
  v_mfma_f32_16x16x32_bf16 v[144:147], a[80:83], v[184:187], v[144:147]
  s_waitcnt lgkmcnt(3)
  buffer_load_dwordx4 v13, s[8:11], s30 offen lds
  v_mfma_f32_16x16x32_bf16 v[148:151], a[72:75], v[188:191], v[148:151]
  s_add_u32 s30, s30, s25
  ds_read_b128 v[172:175], v15 offset:55296
  v_mfma_f32_16x16x32_bf16 v[152:155], a[76:79], v[188:191], v[152:155]
  v_mfma_f32_16x16x32_bf16 v[156:159], a[80:83], v[188:191], v[156:159]
  s_waitcnt lgkmcnt(3)
  v_mfma_f32_16x16x32_bf16 v[64:67], a[84:87], v[160:163], v[64:67]
  ds_read_b128 v[176:179], v15 offset:57344
  v_mfma_f32_16x16x32_bf16 v[68:71], a[88:91], v[160:163], v[68:71]
  v_mfma_f32_16x16x32_bf16 v[72:75], a[92:95], v[160:163], v[72:75]
  s_waitcnt lgkmcnt(3)
  v_mfma_f32_16x16x32_bf16 v[76:79], a[84:87], v[164:167], v[76:79]
  ds_read_b128 v[180:183], v15 offset:59392
  v_mfma_f32_16x16x32_bf16 v[80:83], a[88:91], v[164:167], v[80:83]
  v_mfma_f32_16x16x32_bf16 v[84:87], a[92:95], v[164:167], v[84:87]
  s_waitcnt lgkmcnt(3)
  v_mfma_f32_16x16x32_bf16 v[88:91], a[84:87], v[168:171], v[88:91]
  ds_read_b128 v[184:187], v15 offset:61440
  v_mfma_f32_16x16x32_bf16 v[92:95], a[88:91], v[168:171], v[92:95]
  v_mfma_f32_16x16x32_bf16 v[96:99], a[92:95], v[168:171], v[96:99]
  s_waitcnt lgkmcnt(3)
  v_mfma_f32_16x16x32_bf16 v[100:103], a[84:87], v[172:175], v[100:103]
  ds_read_b128 v[188:191], v15 offset:63488
  v_mfma_f32_16x16x32_bf16 v[104:107], a[88:91], v[172:175], v[104:107]
  v_mfma_f32_16x16x32_bf16 v[108:111], a[92:95], v[172:175], v[108:111]
  s_waitcnt lgkmcnt(3)
  v_mfma_f32_16x16x32_bf16 v[112:115], a[84:87], v[176:179], v[112:115]
  s_waitcnt vmcnt(28)
  s_barrier
  ds_read_b128 v[160:163], v16 offset:0
  v_mfma_f32_16x16x32_bf16 v[116:119], a[88:91], v[176:179], v[116:119]
  v_mfma_f32_16x16x32_bf16 v[120:123], a[92:95], v[176:179], v[120:123]
  s_waitcnt lgkmcnt(3)
  v_mfma_f32_16x16x32_bf16 v[124:127], a[84:87], v[180:183], v[124:127]
  ds_read_b128 v[164:167], v16 offset:2048
  v_mfma_f32_16x16x32_bf16 v[128:131], a[88:91], v[180:183], v[128:131]
  v_mfma_f32_16x16x32_bf16 v[132:135], a[92:95], v[180:183], v[132:135]
  s_waitcnt lgkmcnt(3)
  v_mfma_f32_16x16x32_bf16 v[136:139], a[84:87], v[184:187], v[136:139]
  ds_read_b128 v[168:171], v16 offset:4096
  v_mfma_f32_16x16x32_bf16 v[140:143], a[88:91], v[184:187], v[140:143]
  v_mfma_f32_16x16x32_bf16 v[144:147], a[92:95], v[184:187], v[144:147]
  s_waitcnt lgkmcnt(3)
  v_mfma_f32_16x16x32_bf16 v[148:151], a[84:87], v[188:191], v[148:151]
  ds_read_b128 v[172:175], v16 offset:6144
  v_mfma_f32_16x16x32_bf16 v[152:155], a[88:91], v[188:191], v[152:155]
  v_mfma_f32_16x16x32_bf16 v[156:159], a[92:95], v[188:191], v[156:159]
  s_waitcnt lgkmcnt(3)
  v_mfma_f32_16x16x32_bf16 v[64:67], a[96:99], v[160:163], v[64:67]
  ds_read_b128 v[176:179], v16 offset:8192
  v_mfma_f32_16x16x32_bf16 v[68:71], a[100:103], v[160:163], v[68:71]
  s_add_u32 m0, s31, 0
  v_mfma_f32_16x16x32_bf16 v[72:75], a[104:107], v[160:163], v[72:75]
  s_waitcnt lgkmcnt(3)
  buffer_load_dwordx4 v10, s[8:11], s30 offen lds
  v_mfma_f32_16x16x32_bf16 v[76:79], a[96:99], v[164:167], v[76:79]
  ds_read_b128 v[180:183], v16 offset:10240
  v_mfma_f32_16x16x32_bf16 v[80:83], a[100:103], v[164:167], v[80:83]
  v_mfma_f32_16x16x32_bf16 v[84:87], a[104:107], v[164:167], v[84:87]
  s_waitcnt lgkmcnt(3)
  v_mfma_f32_16x16x32_bf16 v[88:91], a[96:99], v[168:171], v[88:91]
  ds_read_b128 v[184:187], v16 offset:12288
  v_mfma_f32_16x16x32_bf16 v[92:95], a[100:103], v[168:171], v[92:95]
  s_add_u32 m0, s31, 1024
  v_mfma_f32_16x16x32_bf16 v[96:99], a[104:107], v[168:171], v[96:99]
  s_waitcnt lgkmcnt(3)
  buffer_load_dwordx4 v11, s[8:11], s30 offen lds
  v_mfma_f32_16x16x32_bf16 v[100:103], a[96:99], v[172:175], v[100:103]
  ds_read_b128 v[188:191], v16 offset:14336
  v_mfma_f32_16x16x32_bf16 v[104:107], a[100:103], v[172:175], v[104:107]
  v_mfma_f32_16x16x32_bf16 v[108:111], a[104:107], v[172:175], v[108:111]
  s_waitcnt lgkmcnt(3)
  v_mfma_f32_16x16x32_bf16 v[112:115], a[96:99], v[176:179], v[112:115]
  ds_read_b128 v[160:163], v17 offset:0
  v_mfma_f32_16x16x32_bf16 v[116:119], a[100:103], v[176:179], v[116:119]
  s_add_u32 m0, s31, 2048
  v_mfma_f32_16x16x32_bf16 v[120:123], a[104:107], v[176:179], v[120:123]
  s_waitcnt lgkmcnt(3)
  buffer_load_dwordx4 v12, s[8:11], s30 offen lds
  v_mfma_f32_16x16x32_bf16 v[124:127], a[96:99], v[180:183], v[124:127]
  ds_read_b128 v[164:167], v17 offset:2048
  v_mfma_f32_16x16x32_bf16 v[128:131], a[100:103], v[180:183], v[128:131]
  v_mfma_f32_16x16x32_bf16 v[132:135], a[104:107], v[180:183], v[132:135]
  s_waitcnt lgkmcnt(3)
  v_mfma_f32_16x16x32_bf16 v[136:139], a[96:99], v[184:187], v[136:139]
  ds_read_b128 v[168:171], v17 offset:4096
  v_mfma_f32_16x16x32_bf16 v[140:143], a[100:103], v[184:187], v[140:143]
  s_add_u32 m0, s31, 3072
  v_mfma_f32_16x16x32_bf16 v[144:147], a[104:107], v[184:187], v[144:147]
  s_waitcnt lgkmcnt(3)
  buffer_load_dwordx4 v13, s[8:11], s30 offen lds
  v_mfma_f32_16x16x32_bf16 v[148:151], a[96:99], v[188:191], v[148:151]
  s_add_u32 s30, s30, 128
  ds_read_b128 v[172:175], v17 offset:6144
  v_mfma_f32_16x16x32_bf16 v[152:155], a[100:103], v[188:191], v[152:155]
  v_mfma_f32_16x16x32_bf16 v[156:159], a[104:107], v[188:191], v[156:159]
  s_waitcnt lgkmcnt(3)
  v_mfma_f32_16x16x32_bf16 v[64:67], a[108:111], v[160:163], v[64:67]
  ds_read_b128 v[176:179], v17 offset:8192
  v_mfma_f32_16x16x32_bf16 v[68:71], a[112:115], v[160:163], v[68:71]
  v_mfma_f32_16x16x32_bf16 v[72:75], a[116:119], v[160:163], v[72:75]
  s_waitcnt lgkmcnt(3)
  v_mfma_f32_16x16x32_bf16 v[76:79], a[108:111], v[164:167], v[76:79]
  ds_read_b128 v[180:183], v17 offset:10240
  v_mfma_f32_16x16x32_bf16 v[80:83], a[112:115], v[164:167], v[80:83]
  v_mfma_f32_16x16x32_bf16 v[84:87], a[116:119], v[164:167], v[84:87]
  s_waitcnt lgkmcnt(3)
  v_mfma_f32_16x16x32_bf16 v[88:91], a[108:111], v[168:171], v[88:91]
  ds_read_b128 v[184:187], v17 offset:12288
  v_mfma_f32_16x16x32_bf16 v[92:95], a[112:115], v[168:171], v[92:95]
  v_mfma_f32_16x16x32_bf16 v[96:99], a[116:119], v[168:171], v[96:99]
  s_waitcnt lgkmcnt(3)
  v_mfma_f32_16x16x32_bf16 v[100:103], a[108:111], v[172:175], v[100:103]
  ds_read_b128 v[188:191], v17 offset:14336
  v_mfma_f32_16x16x32_bf16 v[104:107], a[112:115], v[172:175], v[104:107]
  v_mfma_f32_16x16x32_bf16 v[108:111], a[116:119], v[172:175], v[108:111]
  s_waitcnt lgkmcnt(3)
  v_mfma_f32_16x16x32_bf16 v[112:115], a[108:111], v[176:179], v[112:115]
  ds_read_b128 v[160:163], v16 offset:16384
  v_mfma_f32_16x16x32_bf16 v[116:119], a[112:115], v[176:179], v[116:119]
  v_mfma_f32_16x16x32_bf16 v[120:123], a[116:119], v[176:179], v[120:123]
  s_waitcnt lgkmcnt(3)
  v_mfma_f32_16x16x32_bf16 v[124:127], a[108:111], v[180:183], v[124:127]
  ds_read_b128 v[164:167], v16 offset:18432
  v_mfma_f32_16x16x32_bf16 v[128:131], a[112:115], v[180:183], v[128:131]
  v_mfma_f32_16x16x32_bf16 v[132:135], a[116:119], v[180:183], v[132:135]
  s_waitcnt lgkmcnt(3)
  v_mfma_f32_16x16x32_bf16 v[136:139], a[108:111], v[184:187], v[136:139]
  ds_read_b128 v[168:171], v16 offset:20480
  v_mfma_f32_16x16x32_bf16 v[140:143], a[112:115], v[184:187], v[140:143]
  v_mfma_f32_16x16x32_bf16 v[144:147], a[116:119], v[184:187], v[144:147]
  s_waitcnt lgkmcnt(3)
  v_mfma_f32_16x16x32_bf16 v[148:151], a[108:111], v[188:191], v[148:151]
  ds_read_b128 v[172:175], v16 offset:22528
  v_mfma_f32_16x16x32_bf16 v[152:155], a[112:115], v[188:191], v[152:155]
  v_mfma_f32_16x16x32_bf16 v[156:159], a[116:119], v[188:191], v[156:159]
  s_waitcnt lgkmcnt(3)
  v_mfma_f32_16x16x32_bf16 v[64:67], a[120:123], v[160:163], v[64:67]
  ds_read_b128 v[176:179], v16 offset:24576
  v_mfma_f32_16x16x32_bf16 v[68:71], a[124:127], v[160:163], v[68:71]
  s_add_u32 m0, s31, 16384
  v_mfma_f32_16x16x32_bf16 v[72:75], a[128:131], v[160:163], v[72:75]
  s_waitcnt lgkmcnt(3)
  buffer_load_dwordx4 v10, s[8:11], s30 offen lds
  v_mfma_f32_16x16x32_bf16 v[76:79], a[120:123], v[164:167], v[76:79]
  ds_read_b128 v[180:183], v16 offset:26624
  v_mfma_f32_16x16x32_bf16 v[80:83], a[124:127], v[164:167], v[80:83]
  v_mfma_f32_16x16x32_bf16 v[84:87], a[128:131], v[164:167], v[84:87]
  s_waitcnt lgkmcnt(3)
  v_mfma_f32_16x16x32_bf16 v[88:91], a[120:123], v[168:171], v[88:91]
  ds_read_b128 v[184:187], v16 offset:28672
  v_mfma_f32_16x16x32_bf16 v[92:95], a[124:127], v[168:171], v[92:95]
  s_add_u32 m0, s31, 17408
  v_mfma_f32_16x16x32_bf16 v[96:99], a[128:131], v[168:171], v[96:99]
  s_waitcnt lgkmcnt(3)
  buffer_load_dwordx4 v11, s[8:11], s30 offen lds
  v_mfma_f32_16x16x32_bf16 v[100:103], a[120:123], v[172:175], v[100:103]
  ds_read_b128 v[188:191], v16 offset:30720
  v_mfma_f32_16x16x32_bf16 v[104:107], a[124:127], v[172:175], v[104:107]
  v_mfma_f32_16x16x32_bf16 v[108:111], a[128:131], v[172:175], v[108:111]
  s_waitcnt lgkmcnt(3)
  v_mfma_f32_16x16x32_bf16 v[112:115], a[120:123], v[176:179], v[112:115]
  ds_read_b128 v[160:163], v17 offset:16384
  v_mfma_f32_16x16x32_bf16 v[116:119], a[124:127], v[176:179], v[116:119]
  s_add_u32 m0, s31, 18432
  v_mfma_f32_16x16x32_bf16 v[120:123], a[128:131], v[176:179], v[120:123]
  s_waitcnt lgkmcnt(3)
  buffer_load_dwordx4 v12, s[8:11], s30 offen lds
  v_mfma_f32_16x16x32_bf16 v[124:127], a[120:123], v[180:183], v[124:127]
  ds_read_b128 v[164:167], v17 offset:18432
  v_mfma_f32_16x16x32_bf16 v[128:131], a[124:127], v[180:183], v[128:131]
  v_mfma_f32_16x16x32_bf16 v[132:135], a[128:131], v[180:183], v[132:135]
  s_waitcnt lgkmcnt(3)
  v_mfma_f32_16x16x32_bf16 v[136:139], a[120:123], v[184:187], v[136:139]
  ds_read_b128 v[168:171], v17 offset:20480
  v_mfma_f32_16x16x32_bf16 v[140:143], a[124:127], v[184:187], v[140:143]
  s_add_u32 m0, s31, 19456
  v_mfma_f32_16x16x32_bf16 v[144:147], a[128:131], v[184:187], v[144:147]
  s_waitcnt lgkmcnt(3)
  buffer_load_dwordx4 v13, s[8:11], s30 offen lds
  v_mfma_f32_16x16x32_bf16 v[148:151], a[120:123], v[188:191], v[148:151]
  s_add_u32 s30, s30, 128
  ds_read_b128 v[172:175], v17 offset:22528
  v_mfma_f32_16x16x32_bf16 v[152:155], a[124:127], v[188:191], v[152:155]
  v_mfma_f32_16x16x32_bf16 v[156:159], a[128:131], v[188:191], v[156:159]
  s_waitcnt lgkmcnt(3)
  v_mfma_f32_16x16x32_bf16 v[64:67], a[132:135], v[160:163], v[64:67]
  ds_read_b128 v[176:179], v17 offset:24576
  v_mfma_f32_16x16x32_bf16 v[68:71], a[136:139], v[160:163], v[68:71]
  v_mfma_f32_16x16x32_bf16 v[72:75], a[140:143], v[160:163], v[72:75]
  s_waitcnt lgkmcnt(3)
  v_mfma_f32_16x16x32_bf16 v[76:79], a[132:135], v[164:167], v[76:79]
  ds_read_b128 v[180:183], v17 offset:26624
  v_mfma_f32_16x16x32_bf16 v[80:83], a[136:139], v[164:167], v[80:83]
  v_mfma_f32_16x16x32_bf16 v[84:87], a[140:143], v[164:167], v[84:87]
  s_waitcnt lgkmcnt(3)
  v_mfma_f32_16x16x32_bf16 v[88:91], a[132:135], v[168:171], v[88:91]
  ds_read_b128 v[184:187], v17 offset:28672
  v_mfma_f32_16x16x32_bf16 v[92:95], a[136:139], v[168:171], v[92:95]
  v_mfma_f32_16x16x32_bf16 v[96:99], a[140:143], v[168:171], v[96:99]
  s_waitcnt lgkmcnt(3)
  v_mfma_f32_16x16x32_bf16 v[100:103], a[132:135], v[172:175], v[100:103]
  ds_read_b128 v[188:191], v17 offset:30720
  v_mfma_f32_16x16x32_bf16 v[104:107], a[136:139], v[172:175], v[104:107]
  v_mfma_f32_16x16x32_bf16 v[108:111], a[140:143], v[172:175], v[108:111]
  s_waitcnt lgkmcnt(3)
  v_mfma_f32_16x16x32_bf16 v[112:115], a[132:135], v[176:179], v[112:115]
  s_waitcnt vmcnt(16)
  s_barrier
  ds_read_b128 v[160:163], v16 offset:32768
  v_mfma_f32_16x16x32_bf16 v[116:119], a[136:139], v[176:179], v[116:119]
  buffer_atomic_add v28, v27, s[72:75], s61 offen sc1
  v_mfma_f32_16x16x32_bf16 v[120:123], a[140:143], v[176:179], v[120:123]
  s_waitcnt lgkmcnt(3)
  s_mov_b32 s48, s27
  s_add_u32 s27, s27, 8388608
  v_mfma_f32_16x16x32_bf16 v[124:127], a[132:135], v[180:183], v[124:127]
  s_mov_b32 s61, s60
  ds_read_b128 v[164:167], v16 offset:34816
  s_add_u32 s60, s60, 4
  v_mfma_f32_16x16x32_bf16 v[128:131], a[136:139], v[180:183], v[128:131]
  v_mfma_f32_16x16x32_bf16 v[132:135], a[140:143], v[180:183], v[132:135]
  s_waitcnt lgkmcnt(3)
  v_mfma_f32_16x16x32_bf16 v[136:139], a[132:135], v[184:187], v[136:139]
  ds_read_b128 v[168:171], v16 offset:36864
  v_mfma_f32_16x16x32_bf16 v[140:143], a[136:139], v[184:187], v[140:143]
  v_mfma_f32_16x16x32_bf16 v[144:147], a[140:143], v[184:187], v[144:147]
  s_waitcnt lgkmcnt(3)
  v_mfma_f32_16x16x32_bf16 v[148:151], a[132:135], v[188:191], v[148:151]
  ds_read_b128 v[172:175], v16 offset:38912
  v_mfma_f32_16x16x32_bf16 v[152:155], a[136:139], v[188:191], v[152:155]
  v_mfma_f32_16x16x32_bf16 v[156:159], a[140:143], v[188:191], v[156:159]
  s_waitcnt lgkmcnt(3)
  v_mfma_f32_16x16x32_bf16 v[64:67], a[144:147], v[160:163], v[64:67]
  ds_read_b128 v[176:179], v16 offset:40960
  v_mfma_f32_16x16x32_bf16 v[68:71], a[148:151], v[160:163], v[68:71]
  s_add_u32 m0, s31, 32768
  v_mfma_f32_16x16x32_bf16 v[72:75], a[152:155], v[160:163], v[72:75]
  s_waitcnt lgkmcnt(3)
  buffer_load_dwordx4 v10, s[8:11], s30 offen lds
  v_mfma_f32_16x16x32_bf16 v[76:79], a[144:147], v[164:167], v[76:79]
  ds_read_b128 v[180:183], v16 offset:43008
  v_mfma_f32_16x16x32_bf16 v[80:83], a[148:151], v[164:167], v[80:83]
  v_mfma_f32_16x16x32_bf16 v[84:87], a[152:155], v[164:167], v[84:87]
  s_waitcnt lgkmcnt(3)
  v_mfma_f32_16x16x32_bf16 v[88:91], a[144:147], v[168:171], v[88:91]
  ds_read_b128 v[184:187], v16 offset:45056
  v_mfma_f32_16x16x32_bf16 v[92:95], a[148:151], v[168:171], v[92:95]
  s_add_u32 m0, s31, 33792
  v_mfma_f32_16x16x32_bf16 v[96:99], a[152:155], v[168:171], v[96:99]
  s_waitcnt lgkmcnt(3)
  buffer_load_dwordx4 v11, s[8:11], s30 offen lds
  v_mfma_f32_16x16x32_bf16 v[100:103], a[144:147], v[172:175], v[100:103]
  ds_read_b128 v[188:191], v16 offset:47104
  v_mfma_f32_16x16x32_bf16 v[104:107], a[148:151], v[172:175], v[104:107]
  v_mfma_f32_16x16x32_bf16 v[108:111], a[152:155], v[172:175], v[108:111]
  s_waitcnt lgkmcnt(3)
  v_mfma_f32_16x16x32_bf16 v[112:115], a[144:147], v[176:179], v[112:115]
  ds_read_b128 v[160:163], v17 offset:32768
  v_mfma_f32_16x16x32_bf16 v[116:119], a[148:151], v[176:179], v[116:119]
  s_add_u32 m0, s31, 34816
  v_mfma_f32_16x16x32_bf16 v[120:123], a[152:155], v[176:179], v[120:123]
  s_waitcnt lgkmcnt(3)
  buffer_load_dwordx4 v12, s[8:11], s30 offen lds
  v_mfma_f32_16x16x32_bf16 v[124:127], a[144:147], v[180:183], v[124:127]
  ds_read_b128 v[164:167], v17 offset:34816
  v_mfma_f32_16x16x32_bf16 v[128:131], a[148:151], v[180:183], v[128:131]
  v_mfma_f32_16x16x32_bf16 v[132:135], a[152:155], v[180:183], v[132:135]
  s_waitcnt lgkmcnt(3)
  v_mfma_f32_16x16x32_bf16 v[136:139], a[144:147], v[184:187], v[136:139]
  ds_read_b128 v[168:171], v17 offset:36864
  v_mfma_f32_16x16x32_bf16 v[140:143], a[148:151], v[184:187], v[140:143]
  s_add_u32 m0, s31, 35840
  v_mfma_f32_16x16x32_bf16 v[144:147], a[152:155], v[184:187], v[144:147]
  s_waitcnt lgkmcnt(3)
  buffer_load_dwordx4 v13, s[8:11], s30 offen lds
  v_mfma_f32_16x16x32_bf16 v[148:151], a[144:147], v[188:191], v[148:151]
  s_add_u32 s30, s30, 128
  ds_read_b128 v[172:175], v17 offset:38912
  v_mfma_f32_16x16x32_bf16 v[152:155], a[148:151], v[188:191], v[152:155]
  v_mfma_f32_16x16x32_bf16 v[156:159], a[152:155], v[188:191], v[156:159]
  s_waitcnt lgkmcnt(3)
  v_mfma_f32_16x16x32_bf16 v[64:67], a[156:159], v[160:163], v[64:67]
  ds_read_b128 v[176:179], v17 offset:40960
  v_mfma_f32_16x16x32_bf16 v[68:71], a[160:163], v[160:163], v[68:71]
  v_mfma_f32_16x16x32_bf16 v[72:75], a[164:167], v[160:163], v[72:75]
  s_waitcnt lgkmcnt(3)
  v_mfma_f32_16x16x32_bf16 v[76:79], a[156:159], v[164:167], v[76:79]
  ds_read_b128 v[180:183], v17 offset:43008
  v_mfma_f32_16x16x32_bf16 v[80:83], a[160:163], v[164:167], v[80:83]
  v_mfma_f32_16x16x32_bf16 v[84:87], a[164:167], v[164:167], v[84:87]
  s_waitcnt lgkmcnt(3)
  v_mfma_f32_16x16x32_bf16 v[88:91], a[156:159], v[168:171], v[88:91]
  ds_read_b128 v[184:187], v17 offset:45056
  v_mfma_f32_16x16x32_bf16 v[92:95], a[160:163], v[168:171], v[92:95]
  v_mfma_f32_16x16x32_bf16 v[96:99], a[164:167], v[168:171], v[96:99]
  s_waitcnt lgkmcnt(3)
  v_mfma_f32_16x16x32_bf16 v[100:103], a[156:159], v[172:175], v[100:103]
  ds_read_b128 v[188:191], v17 offset:47104
  v_mfma_f32_16x16x32_bf16 v[104:107], a[160:163], v[172:175], v[104:107]
  v_mfma_f32_16x16x32_bf16 v[108:111], a[164:167], v[172:175], v[108:111]
  s_waitcnt lgkmcnt(3)
  v_mfma_f32_16x16x32_bf16 v[112:115], a[156:159], v[176:179], v[112:115]
  ds_read_b128 v[160:163], v16 offset:49152
  v_mfma_f32_16x16x32_bf16 v[116:119], a[160:163], v[176:179], v[116:119]
  v_mfma_f32_16x16x32_bf16 v[120:123], a[164:167], v[176:179], v[120:123]
  s_waitcnt lgkmcnt(3)
  v_mfma_f32_16x16x32_bf16 v[124:127], a[156:159], v[180:183], v[124:127]
  ds_read_b128 v[164:167], v16 offset:51200
  v_mfma_f32_16x16x32_bf16 v[128:131], a[160:163], v[180:183], v[128:131]
  v_mfma_f32_16x16x32_bf16 v[132:135], a[164:167], v[180:183], v[132:135]
  s_waitcnt lgkmcnt(3)
  v_mfma_f32_16x16x32_bf16 v[136:139], a[156:159], v[184:187], v[136:139]
  ds_read_b128 v[168:171], v16 offset:53248
  v_mfma_f32_16x16x32_bf16 v[140:143], a[160:163], v[184:187], v[140:143]
  v_mfma_f32_16x16x32_bf16 v[144:147], a[164:167], v[184:187], v[144:147]
  s_waitcnt lgkmcnt(3)
  v_mfma_f32_16x16x32_bf16 v[148:151], a[156:159], v[188:191], v[148:151]
  ds_read_b128 v[172:175], v16 offset:55296
  v_mfma_f32_16x16x32_bf16 v[152:155], a[160:163], v[188:191], v[152:155]
  v_mfma_f32_16x16x32_bf16 v[156:159], a[164:167], v[188:191], v[156:159]
  s_waitcnt lgkmcnt(3)
  v_mfma_f32_16x16x32_bf16 v[64:67], a[168:171], v[160:163], v[64:67]
  ds_read_b128 v[176:179], v16 offset:57344
  v_mfma_f32_16x16x32_bf16 v[68:71], a[172:175], v[160:163], v[68:71]
  s_add_u32 m0, s31, 49152
  v_mfma_f32_16x16x32_bf16 v[72:75], a[176:179], v[160:163], v[72:75]
  s_waitcnt lgkmcnt(3)
  buffer_load_dwordx4 v10, s[8:11], s30 offen lds
  v_mfma_f32_16x16x32_bf16 v[76:79], a[168:171], v[164:167], v[76:79]
  ds_read_b128 v[180:183], v16 offset:59392
  v_mfma_f32_16x16x32_bf16 v[80:83], a[172:175], v[164:167], v[80:83]
  v_mfma_f32_16x16x32_bf16 v[84:87], a[176:179], v[164:167], v[84:87]
  s_waitcnt lgkmcnt(3)
  v_mfma_f32_16x16x32_bf16 v[88:91], a[168:171], v[168:171], v[88:91]
  ds_read_b128 v[184:187], v16 offset:61440
  v_mfma_f32_16x16x32_bf16 v[92:95], a[172:175], v[168:171], v[92:95]
  s_add_u32 m0, s31, 50176
  v_mfma_f32_16x16x32_bf16 v[96:99], a[176:179], v[168:171], v[96:99]
  s_waitcnt lgkmcnt(3)
  buffer_load_dwordx4 v11, s[8:11], s30 offen lds
  v_mfma_f32_16x16x32_bf16 v[100:103], a[168:171], v[172:175], v[100:103]
  ds_read_b128 v[188:191], v16 offset:63488
  v_mfma_f32_16x16x32_bf16 v[104:107], a[172:175], v[172:175], v[104:107]
  v_mfma_f32_16x16x32_bf16 v[108:111], a[176:179], v[172:175], v[108:111]
  s_waitcnt lgkmcnt(3)
  v_mfma_f32_16x16x32_bf16 v[112:115], a[168:171], v[176:179], v[112:115]
  ds_read_b128 v[160:163], v17 offset:49152
  v_mfma_f32_16x16x32_bf16 v[116:119], a[172:175], v[176:179], v[116:119]
  s_add_u32 m0, s31, 51200
  v_mfma_f32_16x16x32_bf16 v[120:123], a[176:179], v[176:179], v[120:123]
  s_waitcnt lgkmcnt(3)
  buffer_load_dwordx4 v12, s[8:11], s30 offen lds
  v_mfma_f32_16x16x32_bf16 v[124:127], a[168:171], v[180:183], v[124:127]
  ds_read_b128 v[164:167], v17 offset:51200
  v_mfma_f32_16x16x32_bf16 v[128:131], a[172:175], v[180:183], v[128:131]
  v_mfma_f32_16x16x32_bf16 v[132:135], a[176:179], v[180:183], v[132:135]
  s_waitcnt lgkmcnt(3)
  v_mfma_f32_16x16x32_bf16 v[136:139], a[168:171], v[184:187], v[136:139]
  ds_read_b128 v[168:171], v17 offset:53248
  v_mfma_f32_16x16x32_bf16 v[140:143], a[172:175], v[184:187], v[140:143]
  s_add_u32 m0, s31, 52224
  v_mfma_f32_16x16x32_bf16 v[144:147], a[176:179], v[184:187], v[144:147]
  s_waitcnt lgkmcnt(3)
  buffer_load_dwordx4 v13, s[8:11], s30 offen lds
  v_mfma_f32_16x16x32_bf16 v[148:151], a[168:171], v[188:191], v[148:151]
  s_add_u32 s30, s30, 128
  ds_read_b128 v[172:175], v17 offset:55296
  v_mfma_f32_16x16x32_bf16 v[152:155], a[172:175], v[188:191], v[152:155]
  v_mfma_f32_16x16x32_bf16 v[156:159], a[176:179], v[188:191], v[156:159]
  s_waitcnt lgkmcnt(3)
  v_mfma_f32_16x16x32_bf16 v[64:67], a[180:183], v[160:163], v[64:67]
  ds_read_b128 v[176:179], v17 offset:57344
  v_mfma_f32_16x16x32_bf16 v[68:71], a[184:187], v[160:163], v[68:71]
  v_mfma_f32_16x16x32_bf16 v[72:75], a[188:191], v[160:163], v[72:75]
  s_waitcnt lgkmcnt(3)
  v_mfma_f32_16x16x32_bf16 v[76:79], a[180:183], v[164:167], v[76:79]
  ds_read_b128 v[180:183], v17 offset:59392
  v_mfma_f32_16x16x32_bf16 v[80:83], a[184:187], v[164:167], v[80:83]
  v_mfma_f32_16x16x32_bf16 v[84:87], a[188:191], v[164:167], v[84:87]
  s_waitcnt lgkmcnt(3)
  v_mfma_f32_16x16x32_bf16 v[88:91], a[180:183], v[168:171], v[88:91]
  ds_read_b128 v[184:187], v17 offset:61440
  v_mfma_f32_16x16x32_bf16 v[92:95], a[184:187], v[168:171], v[92:95]
  v_mfma_f32_16x16x32_bf16 v[96:99], a[188:191], v[168:171], v[96:99]
  s_waitcnt lgkmcnt(3)
  v_mfma_f32_16x16x32_bf16 v[100:103], a[180:183], v[172:175], v[100:103]
  ds_read_b128 v[188:191], v17 offset:63488
  v_mfma_f32_16x16x32_bf16 v[104:107], a[184:187], v[172:175], v[104:107]
  v_mfma_f32_16x16x32_bf16 v[108:111], a[188:191], v[172:175], v[108:111]
  s_waitcnt lgkmcnt(3)
  v_mfma_f32_16x16x32_bf16 v[112:115], a[180:183], v[176:179], v[112:115]
  s_waitcnt vmcnt(17)
  s_barrier
  ds_read_b128 v[160:163], v18 offset:0
  v_mfma_f32_16x16x32_bf16 v[116:119], a[184:187], v[176:179], v[116:119]
  v_mfma_f32_16x16x32_bf16 v[120:123], a[188:191], v[176:179], v[120:123]
  s_waitcnt lgkmcnt(3)
  v_mfma_f32_16x16x32_bf16 v[124:127], a[180:183], v[180:183], v[124:127]
  ds_read_b128 v[164:167], v18 offset:2048
  v_mfma_f32_16x16x32_bf16 v[128:131], a[184:187], v[180:183], v[128:131]
  v_mfma_f32_16x16x32_bf16 v[132:135], a[188:191], v[180:183], v[132:135]
  s_waitcnt lgkmcnt(3)
  v_mfma_f32_16x16x32_bf16 v[136:139], a[180:183], v[184:187], v[136:139]
  ds_read_b128 v[168:171], v18 offset:4096
  v_mfma_f32_16x16x32_bf16 v[140:143], a[184:187], v[184:187], v[140:143]
  v_mfma_f32_16x16x32_bf16 v[144:147], a[188:191], v[184:187], v[144:147]
  s_waitcnt lgkmcnt(3)
  v_mfma_f32_16x16x32_bf16 v[148:151], a[180:183], v[188:191], v[148:151]
  ds_read_b128 v[172:175], v18 offset:6144
  v_mfma_f32_16x16x32_bf16 v[152:155], a[184:187], v[188:191], v[152:155]
  v_mfma_f32_16x16x32_bf16 v[156:159], a[188:191], v[188:191], v[156:159]
  s_waitcnt lgkmcnt(3)
  v_mfma_f32_16x16x32_bf16 v[64:67], a[192:195], v[160:163], v[64:67]
  ds_read_b128 v[176:179], v18 offset:8192
  v_mfma_f32_16x16x32_bf16 v[68:71], a[196:199], v[160:163], v[68:71]
  s_add_u32 m0, s31, 65536
  v_mfma_f32_16x16x32_bf16 v[72:75], a[200:203], v[160:163], v[72:75]
  s_waitcnt lgkmcnt(3)
  buffer_load_dwordx4 v10, s[8:11], s30 offen lds
  v_mfma_f32_16x16x32_bf16 v[76:79], a[192:195], v[164:167], v[76:79]
  ds_read_b128 v[180:183], v18 offset:10240
  v_mfma_f32_16x16x32_bf16 v[80:83], a[196:199], v[164:167], v[80:83]
  v_mfma_f32_16x16x32_bf16 v[84:87], a[200:203], v[164:167], v[84:87]
  s_waitcnt lgkmcnt(3)
  v_mfma_f32_16x16x32_bf16 v[88:91], a[192:195], v[168:171], v[88:91]
  ds_read_b128 v[184:187], v18 offset:12288
  v_mfma_f32_16x16x32_bf16 v[92:95], a[196:199], v[168:171], v[92:95]
  s_add_u32 m0, s31, 66560
  v_mfma_f32_16x16x32_bf16 v[96:99], a[200:203], v[168:171], v[96:99]
  s_waitcnt lgkmcnt(3)
  buffer_load_dwordx4 v11, s[8:11], s30 offen lds
  v_mfma_f32_16x16x32_bf16 v[100:103], a[192:195], v[172:175], v[100:103]
  ds_read_b128 v[188:191], v18 offset:14336
  v_mfma_f32_16x16x32_bf16 v[104:107], a[196:199], v[172:175], v[104:107]
  v_mfma_f32_16x16x32_bf16 v[108:111], a[200:203], v[172:175], v[108:111]
  s_waitcnt lgkmcnt(3)
  v_mfma_f32_16x16x32_bf16 v[112:115], a[192:195], v[176:179], v[112:115]
  ds_read_b128 v[160:163], v19 offset:0
  v_mfma_f32_16x16x32_bf16 v[116:119], a[196:199], v[176:179], v[116:119]
  s_add_u32 m0, s31, 67584
  v_mfma_f32_16x16x32_bf16 v[120:123], a[200:203], v[176:179], v[120:123]
  s_waitcnt lgkmcnt(3)
  buffer_load_dwordx4 v12, s[8:11], s30 offen lds
  v_mfma_f32_16x16x32_bf16 v[124:127], a[192:195], v[180:183], v[124:127]
  ds_read_b128 v[164:167], v19 offset:2048
  v_mfma_f32_16x16x32_bf16 v[128:131], a[196:199], v[180:183], v[128:131]
  v_mfma_f32_16x16x32_bf16 v[132:135], a[200:203], v[180:183], v[132:135]
  s_waitcnt lgkmcnt(3)
  v_mfma_f32_16x16x32_bf16 v[136:139], a[192:195], v[184:187], v[136:139]
  ds_read_b128 v[168:171], v19 offset:4096
  v_mfma_f32_16x16x32_bf16 v[140:143], a[196:199], v[184:187], v[140:143]
  s_add_u32 m0, s31, 68608
  v_mfma_f32_16x16x32_bf16 v[144:147], a[200:203], v[184:187], v[144:147]
  s_waitcnt lgkmcnt(3)
  buffer_load_dwordx4 v13, s[8:11], s30 offen lds
  v_mfma_f32_16x16x32_bf16 v[148:151], a[192:195], v[188:191], v[148:151]
  s_add_u32 s30, s30, 128
  ds_read_b128 v[172:175], v19 offset:6144
  v_mfma_f32_16x16x32_bf16 v[152:155], a[196:199], v[188:191], v[152:155]
  v_mfma_f32_16x16x32_bf16 v[156:159], a[200:203], v[188:191], v[156:159]
  s_waitcnt lgkmcnt(3)
  v_mfma_f32_16x16x32_bf16 v[64:67], a[204:207], v[160:163], v[64:67]
  ds_read_b128 v[176:179], v19 offset:8192
  v_mfma_f32_16x16x32_bf16 v[68:71], a[208:211], v[160:163], v[68:71]
  v_mfma_f32_16x16x32_bf16 v[72:75], a[212:215], v[160:163], v[72:75]
  s_waitcnt lgkmcnt(3)
  v_mfma_f32_16x16x32_bf16 v[76:79], a[204:207], v[164:167], v[76:79]
  ds_read_b128 v[180:183], v19 offset:10240
  v_mfma_f32_16x16x32_bf16 v[80:83], a[208:211], v[164:167], v[80:83]
  v_mfma_f32_16x16x32_bf16 v[84:87], a[212:215], v[164:167], v[84:87]
  s_waitcnt lgkmcnt(3)
  v_mfma_f32_16x16x32_bf16 v[88:91], a[204:207], v[168:171], v[88:91]
  ds_read_b128 v[184:187], v19 offset:12288
  v_mfma_f32_16x16x32_bf16 v[92:95], a[208:211], v[168:171], v[92:95]
  v_mfma_f32_16x16x32_bf16 v[96:99], a[212:215], v[168:171], v[96:99]
  s_waitcnt lgkmcnt(3)
  v_mfma_f32_16x16x32_bf16 v[100:103], a[204:207], v[172:175], v[100:103]
  ds_read_b128 v[188:191], v19 offset:14336
  v_mfma_f32_16x16x32_bf16 v[104:107], a[208:211], v[172:175], v[104:107]
  v_mfma_f32_16x16x32_bf16 v[108:111], a[212:215], v[172:175], v[108:111]
  s_waitcnt lgkmcnt(3)
  v_mfma_f32_16x16x32_bf16 v[112:115], a[204:207], v[176:179], v[112:115]
  ds_read_b128 v[160:163], v18 offset:16384
  v_mfma_f32_16x16x32_bf16 v[116:119], a[208:211], v[176:179], v[116:119]
  v_mfma_f32_16x16x32_bf16 v[120:123], a[212:215], v[176:179], v[120:123]
  s_waitcnt lgkmcnt(3)
  v_mfma_f32_16x16x32_bf16 v[124:127], a[204:207], v[180:183], v[124:127]
  ds_read_b128 v[164:167], v18 offset:18432
  v_mfma_f32_16x16x32_bf16 v[128:131], a[208:211], v[180:183], v[128:131]
  v_mfma_f32_16x16x32_bf16 v[132:135], a[212:215], v[180:183], v[132:135]
  s_waitcnt lgkmcnt(3)
  v_mfma_f32_16x16x32_bf16 v[136:139], a[204:207], v[184:187], v[136:139]
  ds_read_b128 v[168:171], v18 offset:20480
  v_mfma_f32_16x16x32_bf16 v[140:143], a[208:211], v[184:187], v[140:143]
  v_mfma_f32_16x16x32_bf16 v[144:147], a[212:215], v[184:187], v[144:147]
  s_waitcnt lgkmcnt(3)
  v_mfma_f32_16x16x32_bf16 v[148:151], a[204:207], v[188:191], v[148:151]
  ds_read_b128 v[172:175], v18 offset:22528
  v_mfma_f32_16x16x32_bf16 v[152:155], a[208:211], v[188:191], v[152:155]
  v_mfma_f32_16x16x32_bf16 v[156:159], a[212:215], v[188:191], v[156:159]
  s_waitcnt lgkmcnt(3)
  v_mfma_f32_16x16x32_bf16 v[64:67], a[216:219], v[160:163], v[64:67]
  ds_read_b128 v[176:179], v18 offset:24576
  v_mfma_f32_16x16x32_bf16 v[68:71], a[220:223], v[160:163], v[68:71]
  s_add_u32 m0, s31, 81920
  v_mfma_f32_16x16x32_bf16 v[72:75], a[224:227], v[160:163], v[72:75]
  s_waitcnt lgkmcnt(3)
  buffer_load_dwordx4 v10, s[8:11], s30 offen lds
  v_mfma_f32_16x16x32_bf16 v[76:79], a[216:219], v[164:167], v[76:79]
  ds_read_b128 v[180:183], v18 offset:26624
  v_mfma_f32_16x16x32_bf16 v[80:83], a[220:223], v[164:167], v[80:83]
  v_mfma_f32_16x16x32_bf16 v[84:87], a[224:227], v[164:167], v[84:87]
  s_waitcnt lgkmcnt(3)
  v_mfma_f32_16x16x32_bf16 v[88:91], a[216:219], v[168:171], v[88:91]
  ds_read_b128 v[184:187], v18 offset:28672
  v_mfma_f32_16x16x32_bf16 v[92:95], a[220:223], v[168:171], v[92:95]
  s_add_u32 m0, s31, 82944
  v_mfma_f32_16x16x32_bf16 v[96:99], a[224:227], v[168:171], v[96:99]
  s_waitcnt lgkmcnt(3)
  buffer_load_dwordx4 v11, s[8:11], s30 offen lds
  v_mfma_f32_16x16x32_bf16 v[100:103], a[216:219], v[172:175], v[100:103]
  ds_read_b128 v[188:191], v18 offset:30720
  v_mfma_f32_16x16x32_bf16 v[104:107], a[220:223], v[172:175], v[104:107]
  v_mfma_f32_16x16x32_bf16 v[108:111], a[224:227], v[172:175], v[108:111]
  s_waitcnt lgkmcnt(3)
  v_mfma_f32_16x16x32_bf16 v[112:115], a[216:219], v[176:179], v[112:115]
  ds_read_b128 v[160:163], v19 offset:16384
  v_mfma_f32_16x16x32_bf16 v[116:119], a[220:223], v[176:179], v[116:119]
  s_add_u32 m0, s31, 83968
  v_mfma_f32_16x16x32_bf16 v[120:123], a[224:227], v[176:179], v[120:123]
  s_waitcnt lgkmcnt(3)
  buffer_load_dwordx4 v12, s[8:11], s30 offen lds
  v_mfma_f32_16x16x32_bf16 v[124:127], a[216:219], v[180:183], v[124:127]
  ds_read_b128 v[164:167], v19 offset:18432
  v_mfma_f32_16x16x32_bf16 v[128:131], a[220:223], v[180:183], v[128:131]
  v_mfma_f32_16x16x32_bf16 v[132:135], a[224:227], v[180:183], v[132:135]
  s_waitcnt lgkmcnt(3)
  v_mfma_f32_16x16x32_bf16 v[136:139], a[216:219], v[184:187], v[136:139]
  ds_read_b128 v[168:171], v19 offset:20480
  v_mfma_f32_16x16x32_bf16 v[140:143], a[220:223], v[184:187], v[140:143]
  s_add_u32 m0, s31, 84992
  v_mfma_f32_16x16x32_bf16 v[144:147], a[224:227], v[184:187], v[144:147]
  s_waitcnt lgkmcnt(3)
  buffer_load_dwordx4 v13, s[8:11], s30 offen lds
  v_mfma_f32_16x16x32_bf16 v[148:151], a[216:219], v[188:191], v[148:151]
  s_add_u32 s30, s30, 128
  ds_read_b128 v[172:175], v19 offset:22528
  v_mfma_f32_16x16x32_bf16 v[152:155], a[220:223], v[188:191], v[152:155]
  v_mfma_f32_16x16x32_bf16 v[156:159], a[224:227], v[188:191], v[156:159]
  s_waitcnt lgkmcnt(3)
  v_mfma_f32_16x16x32_bf16 v[64:67], a[228:231], v[160:163], v[64:67]
  ds_read_b128 v[176:179], v19 offset:24576
  v_mfma_f32_16x16x32_bf16 v[68:71], a[232:235], v[160:163], v[68:71]
  v_mfma_f32_16x16x32_bf16 v[72:75], a[236:239], v[160:163], v[72:75]
  s_waitcnt lgkmcnt(3)
  v_mfma_f32_16x16x32_bf16 v[76:79], a[228:231], v[164:167], v[76:79]
  ds_read_b128 v[180:183], v19 offset:26624
  v_cvt_pk_bf16_f32 v192, v64, v65
  v_mfma_f32_16x16x32_bf16 v[80:83], a[232:235], v[164:167], v[80:83]
  v_cvt_pk_bf16_f32 v193, v66, v67
  v_cvt_pk_bf16_f32 v194, v68, v69
  v_mfma_f32_16x16x32_bf16 v[84:87], a[236:239], v[164:167], v[84:87]
  s_waitcnt lgkmcnt(3)
  v_cvt_pk_bf16_f32 v195, v70, v71
  v_cvt_pk_bf16_f32 v200, v72, v73
  v_mfma_f32_16x16x32_bf16 v[88:91], a[228:231], v[168:171], v[88:91]
  ds_read_b128 v[184:187], v19 offset:28672
  v_cvt_pk_bf16_f32 v201, v74, v75
  v_mfma_f32_16x16x32_bf16 v[92:95], a[232:235], v[168:171], v[92:95]
  v_cvt_pk_bf16_f32 v196, v76, v77
  v_cvt_pk_bf16_f32 v197, v78, v79
  v_mfma_f32_16x16x32_bf16 v[96:99], a[236:239], v[168:171], v[96:99]
  s_waitcnt lgkmcnt(3)
  v_cvt_pk_bf16_f32 v198, v80, v81
  v_cvt_pk_bf16_f32 v199, v82, v83
  v_mfma_f32_16x16x32_bf16 v[100:103], a[228:231], v[172:175], v[100:103]
  ds_read_b128 v[188:191], v19 offset:30720
  v_cvt_pk_bf16_f32 v202, v84, v85
  v_mfma_f32_16x16x32_bf16 v[104:107], a[232:235], v[172:175], v[104:107]
  v_cvt_pk_bf16_f32 v203, v86, v87
  v_cvt_pk_bf16_f32 v204, v88, v89
  v_mfma_f32_16x16x32_bf16 v[108:111], a[236:239], v[172:175], v[108:111]
  s_waitcnt lgkmcnt(3)
  v_cvt_pk_bf16_f32 v205, v90, v91
  v_cvt_pk_bf16_f32 v206, v92, v93
  v_mfma_f32_16x16x32_bf16 v[112:115], a[228:231], v[176:179], v[112:115]
  s_waitcnt vmcnt(17)
  s_barrier
  ds_read_b128 v[160:163], v14 offset:0
  v_mfma_f32_16x16x32_bf16 v[116:119], a[232:235], v[176:179], v[116:119]
  v_cvt_pk_bf16_f32 v207, v94, v95
  v_cvt_pk_bf16_f32 v212, v96, v97
  v_mfma_f32_16x16x32_bf16 v[120:123], a[236:239], v[176:179], v[120:123]
  s_waitcnt lgkmcnt(3)
  v_cvt_pk_bf16_f32 v213, v98, v99
  v_cvt_pk_bf16_f32 v208, v100, v101
  v_mfma_f32_16x16x32_bf16 v[124:127], a[228:231], v[180:183], v[124:127]
  ds_read_b128 v[164:167], v14 offset:2048
  v_cvt_pk_bf16_f32 v209, v102, v103
  v_mfma_f32_16x16x32_bf16 v[128:131], a[232:235], v[180:183], v[128:131]
  v_cvt_pk_bf16_f32 v210, v104, v105
  v_cvt_pk_bf16_f32 v211, v106, v107
  v_mfma_f32_16x16x32_bf16 v[132:135], a[236:239], v[180:183], v[132:135]
  s_waitcnt lgkmcnt(3)
  v_cvt_pk_bf16_f32 v214, v108, v109
  v_cvt_pk_bf16_f32 v215, v110, v111
  v_mfma_f32_16x16x32_bf16 v[136:139], a[228:231], v[184:187], v[136:139]
  ds_read_b128 v[168:171], v14 offset:4096
  v_cvt_pk_bf16_f32 v216, v112, v113
  v_mfma_f32_16x16x32_bf16 v[140:143], a[232:235], v[184:187], v[140:143]
  v_cvt_pk_bf16_f32 v217, v114, v115
  v_cvt_pk_bf16_f32 v218, v116, v117
  v_mfma_f32_16x16x32_bf16 v[144:147], a[236:239], v[184:187], v[144:147]
  s_waitcnt lgkmcnt(3)
  v_cvt_pk_bf16_f32 v219, v118, v119
  v_cvt_pk_bf16_f32 v224, v120, v121
  v_mfma_f32_16x16x32_bf16 v[148:151], a[228:231], v[188:191], v[148:151]
  ds_read_b128 v[172:175], v14 offset:6144
  v_cvt_pk_bf16_f32 v225, v122, v123
  v_mfma_f32_16x16x32_bf16 v[152:155], a[232:235], v[188:191], v[152:155]
  s_sub_u32 s26, s26, 1
  s_cmp_gt_u32 s26, 0
  v_cvt_pk_bf16_f32 v220, v124, v125
  v_mfma_f32_16x16x32_bf16 v[156:159], a[236:239], v[188:191], v[156:159]
  s_waitcnt lgkmcnt(3)
  s_cbranch_scc1 kvs_205
  s_nop 7
  v_cvt_pk_bf16_f32 v221, v126, v127
  v_cvt_pk_bf16_f32 v222, v128, v129
  v_cvt_pk_bf16_f32 v223, v130, v131
  v_cvt_pk_bf16_f32 v226, v132, v133
  v_cvt_pk_bf16_f32 v227, v134, v135
  v_cvt_pk_bf16_f32 v228, v136, v137
  v_cvt_pk_bf16_f32 v229, v138, v139
  v_cvt_pk_bf16_f32 v230, v140, v141
  v_cvt_pk_bf16_f32 v231, v142, v143
  v_cvt_pk_bf16_f32 v236, v144, v145
  v_cvt_pk_bf16_f32 v237, v146, v147
  v_cvt_pk_bf16_f32 v232, v148, v149
  v_cvt_pk_bf16_f32 v233, v150, v151
  v_cvt_pk_bf16_f32 v234, v152, v153
  v_cvt_pk_bf16_f32 v235, v154, v155
  v_cvt_pk_bf16_f32 v238, v156, v157
  v_cvt_pk_bf16_f32 v239, v158, v159
  s_xor_b32 s29, s48, 0
  buffer_store_dwordx4 v[192:195], v26, s[16:19], s29 offen offset:0 sc1
  buffer_store_dwordx4 v[196:199], v26, s[16:19], s29 offen offset:1024 sc1
  buffer_store_dwordx4 v[200:203], v26, s[16:19], s29 offen offset:2048 sc1
  s_xor_b32 s29, s48, 2105344
  buffer_store_dwordx4 v[204:207], v26, s[16:19], s29 offen offset:0 sc1
  buffer_store_dwordx4 v[208:211], v26, s[16:19], s29 offen offset:1024 sc1
  buffer_store_dwordx4 v[212:215], v26, s[16:19], s29 offen offset:2048 sc1
  s_xor_b32 s29, s48, 4194304
  buffer_store_dwordx4 v[216:219], v26, s[16:19], s29 offen offset:0 sc1
  buffer_store_dwordx4 v[220:223], v26, s[16:19], s29 offen offset:1024 sc1
  buffer_store_dwordx4 v[224:227], v26, s[16:19], s29 offen offset:2048 sc1
  s_xor_b32 s29, s48, 6299648
  buffer_store_dwordx4 v[228:231], v26, s[16:19], s29 offen offset:0 sc1
  buffer_store_dwordx4 v[232:235], v26, s[16:19], s29 offen offset:1024 sc1
  buffer_store_dwordx4 v[236:239], v26, s[16:19], s29 offen offset:2048 sc1
  s_waitcnt vmcnt(0) lgkmcnt(0)
  s_barrier
  buffer_atomic_add v28, v27, s[72:75], s61 offen sc1
  s_branch queue
not_kv:
  s_cmp_ge_u32 s3, 96
  s_cbranch_scc1 not_vw
  s_sub_u32 s2, s3, 64
  s_load_dwordx2 s[6:7], s[0:1], 40
  s_load_dwordx2 s[38:39], s[0:1], 104
  v_lshlrev_b32 v4, 4, v1
  s_waitcnt lgkmcnt(0)
  s_mov_b32 s12, s6
  s_mov_b32 s13, s7
  s_mov_b32 s14, 7864320
  s_mov_b32 s15, 0x00020000
  s_mov_b32 s16, s38
  s_mov_b32 s17, s39
  s_mov_b32 s18, 167772160
  s_mov_b32 s19, 0x00020000
  s_add_u32 s72, s38, 168886272
  s_addc_u32 s73, s39, 0
  s_mov_b32 s74, 49152
  s_mov_b32 s75, 0x00020000
  s_mul_i32 s40, s2, 245760
  s_mul_i32 s22, s20, 30720
  s_add_u32 s40, s40, s22
  s_add_u32 m0, s22, 0
  s_add_u32 s21, s40, 0
  buffer_load_dwordx4 v4, s[12:15], s21 offen offset:0 lds
  buffer_load_dwordx4 v4, s[12:15], s21 offen offset:1024 lds
  buffer_load_dwordx4 v4, s[12:15], s21 offen offset:2048 lds
  buffer_load_dwordx4 v4, s[12:15], s21 offen offset:3072 lds
  s_add_u32 m0, s22, 4096
  s_add_u32 s21, s40, 4096
  buffer_load_dwordx4 v4, s[12:15], s21 offen offset:0 lds
  buffer_load_dwordx4 v4, s[12:15], s21 offen offset:1024 lds
  buffer_load_dwordx4 v4, s[12:15], s21 offen offset:2048 lds
  buffer_load_dwordx4 v4, s[12:15], s21 offen offset:3072 lds
  s_add_u32 m0, s22, 8192
  s_add_u32 s21, s40, 8192
  buffer_load_dwordx4 v4, s[12:15], s21 offen offset:0 lds
  buffer_load_dwordx4 v4, s[12:15], s21 offen offset:1024 lds
  buffer_load_dwordx4 v4, s[12:15], s21 offen offset:2048 lds
  buffer_load_dwordx4 v4, s[12:15], s21 offen offset:3072 lds
  s_add_u32 m0, s22, 12288
  s_add_u32 s21, s40, 12288
  buffer_load_dwordx4 v4, s[12:15], s21 offen offset:0 lds
  buffer_load_dwordx4 v4, s[12:15], s21 offen offset:1024 lds
  buffer_load_dwordx4 v4, s[12:15], s21 offen offset:2048 lds
  buffer_load_dwordx4 v4, s[12:15], s21 offen offset:3072 lds
  s_add_u32 m0, s22, 16384
  s_add_u32 s21, s40, 16384
  buffer_load_dwordx4 v4, s[12:15], s21 offen offset:0 lds
  buffer_load_dwordx4 v4, s[12:15], s21 offen offset:1024 lds
  buffer_load_dwordx4 v4, s[12:15], s21 offen offset:2048 lds
  buffer_load_dwordx4 v4, s[12:15], s21 offen offset:3072 lds
  s_add_u32 m0, s22, 20480
  s_add_u32 s21, s40, 20480
  buffer_load_dwordx4 v4, s[12:15], s21 offen offset:0 lds
  buffer_load_dwordx4 v4, s[12:15], s21 offen offset:1024 lds
  buffer_load_dwordx4 v4, s[12:15], s21 offen offset:2048 lds
  buffer_load_dwordx4 v4, s[12:15], s21 offen offset:3072 lds
  s_add_u32 m0, s22, 24576
  s_add_u32 s21, s40, 24576
  buffer_load_dwordx4 v4, s[12:15], s21 offen offset:0 lds
  buffer_load_dwordx4 v4, s[12:15], s21 offen offset:1024 lds
  buffer_load_dwordx4 v4, s[12:15], s21 offen offset:2048 lds
  buffer_load_dwordx4 v4, s[12:15], s21 offen offset:3072 lds
  s_add_u32 m0, s22, 28672
  s_add_u32 s21, s40, 28672
  buffer_load_dwordx4 v4, s[12:15], s21 offen offset:0 lds
  buffer_load_dwordx4 v4, s[12:15], s21 offen offset:1024 lds
  s_add_u32 s21, s40, 122880
  buffer_load_dwordx4 v[64:67], v4, s[12:15], s21 offen offset:0
  buffer_load_dwordx4 v[68:71], v4, s[12:15], s21 offen offset:1024
  buffer_load_dwordx4 v[72:75], v4, s[12:15], s21 offen offset:2048
  buffer_load_dwordx4 v[76:79], v4, s[12:15], s21 offen offset:3072
  s_add_u32 s21, s40, 126976
  buffer_load_dwordx4 v[80:83], v4, s[12:15], s21 offen offset:0
  buffer_load_dwordx4 v[84:87], v4, s[12:15], s21 offen offset:1024
  buffer_load_dwordx4 v[88:91], v4, s[12:15], s21 offen offset:2048
  buffer_load_dwordx4 v[92:95], v4, s[12:15], s21 offen offset:3072
  s_add_u32 s21, s40, 131072
  buffer_load_dwordx4 v[96:99], v4, s[12:15], s21 offen offset:0
  buffer_load_dwordx4 v[100:103], v4, s[12:15], s21 offen offset:1024
  buffer_load_dwordx4 v[104:107], v4, s[12:15], s21 offen offset:2048
  buffer_load_dwordx4 v[108:111], v4, s[12:15], s21 offen offset:3072
  s_add_u32 s21, s40, 135168
  buffer_load_dwordx4 v[112:115], v4, s[12:15], s21 offen offset:0
  buffer_load_dwordx4 v[116:119], v4, s[12:15], s21 offen offset:1024
  buffer_load_dwordx4 v[120:123], v4, s[12:15], s21 offen offset:2048
  buffer_load_dwordx4 v[124:127], v4, s[12:15], s21 offen offset:3072
  s_add_u32 s21, s40, 139264
  buffer_load_dwordx4 v[128:131], v4, s[12:15], s21 offen offset:0
  buffer_load_dwordx4 v[132:135], v4, s[12:15], s21 offen offset:1024
  buffer_load_dwordx4 v[136:139], v4, s[12:15], s21 offen offset:2048
  buffer_load_dwordx4 v[140:143], v4, s[12:15], s21 offen offset:3072
  s_add_u32 s21, s40, 143360
  buffer_load_dwordx4 v[144:147], v4, s[12:15], s21 offen offset:0
  buffer_load_dwordx4 v[148:151], v4, s[12:15], s21 offen offset:1024
  buffer_load_dwordx4 v[152:155], v4, s[12:15], s21 offen offset:2048
  buffer_load_dwordx4 v[156:159], v4, s[12:15], s21 offen offset:3072
  s_add_u32 s21, s40, 147456
  buffer_load_dwordx4 v[160:163], v4, s[12:15], s21 offen offset:0
  buffer_load_dwordx4 v[164:167], v4, s[12:15], s21 offen offset:1024
  buffer_load_dwordx4 v[168:171], v4, s[12:15], s21 offen offset:2048
  buffer_load_dwordx4 v[172:175], v4, s[12:15], s21 offen offset:3072
  s_add_u32 s21, s40, 151552
  buffer_load_dwordx4 v[176:179], v4, s[12:15], s21 offen offset:0
  buffer_load_dwordx4 v[180:183], v4, s[12:15], s21 offen offset:1024
  v_lshrrev_b32 v6, 2, v2
  v_lshl_add_u32 v6, v3, 2, v6
  v_mul_u32_u24 v6, 1280, v6
  v_and_b32 v7, 3, v2
  v_lshlrev_b32 v7, 3, v7
  s_mul_i32 s21, s20, 320
  v_add3_u32 v6, v6, v7, s21
  v_add_u32 v8, v6, v7
  v_add_u32 v7, 61440, v6
  v_add_u32 v9, 61440, v8
  v_add_u32 v5, s22, v4
  s_waitcnt vmcnt(30)
  s_load_dwordx2 s[36:37], s[0:1], 16
  s_lshl_b32 s23, s2, 2
  s_add_u32 s23, s23, s20
  s_mul_i32 s23, s23, 61440
  s_add_u32 s23, s23, 0
  s_waitcnt lgkmcnt(0)
  s_mov_b32 s24, s36
  s_mov_b32 s25, s37
  s_mov_b32 s26, 7864320
  s_mov_b32 s27, 0x00020000
  buffer_load_dwordx4 v[200:203], v4, s[24:27], s23 offen offset:0
  buffer_load_dwordx4 v[200:203], v4, s[24:27], s23 offen offset:1024
  buffer_load_dwordx4 v[200:203], v4, s[24:27], s23 offen offset:2048
  buffer_load_dwordx4 v[200:203], v4, s[24:27], s23 offen offset:3072
  s_add_u32 s23, s23, 4096
  buffer_load_dwordx4 v[200:203], v4, s[24:27], s23 offen offset:0
  buffer_load_dwordx4 v[200:203], v4, s[24:27], s23 offen offset:1024
  buffer_load_dwordx4 v[200:203], v4, s[24:27], s23 offen offset:2048
  buffer_load_dwordx4 v[200:203], v4, s[24:27], s23 offen offset:3072
  s_add_u32 s23, s23, 4096
  buffer_load_dwordx4 v[200:203], v4, s[24:27], s23 offen offset:0
  buffer_load_dwordx4 v[200:203], v4, s[24:27], s23 offen offset:1024
  buffer_load_dwordx4 v[200:203], v4, s[24:27], s23 offen offset:2048
  buffer_load_dwordx4 v[200:203], v4, s[24:27], s23 offen offset:3072
  s_add_u32 s23, s23, 4096
  buffer_load_dwordx4 v[200:203], v4, s[24:27], s23 offen offset:0
  buffer_load_dwordx4 v[200:203], v4, s[24:27], s23 offen offset:1024
  buffer_load_dwordx4 v[200:203], v4, s[24:27], s23 offen offset:2048
  buffer_load_dwordx4 v[200:203], v4, s[24:27], s23 offen offset:3072
  s_add_u32 s23, s23, 4096
  buffer_load_dwordx4 v[200:203], v4, s[24:27], s23 offen offset:0
  buffer_load_dwordx4 v[200:203], v4, s[24:27], s23 offen offset:1024
  buffer_load_dwordx4 v[200:203], v4, s[24:27], s23 offen offset:2048
  buffer_load_dwordx4 v[200:203], v4, s[24:27], s23 offen offset:3072
  s_add_u32 s23, s23, 4096
  buffer_load_dwordx4 v[200:203], v4, s[24:27], s23 offen offset:0
  buffer_load_dwordx4 v[200:203], v4, s[24:27], s23 offen offset:1024
  buffer_load_dwordx4 v[200:203], v4, s[24:27], s23 offen offset:2048
  buffer_load_dwordx4 v[200:203], v4, s[24:27], s23 offen offset:3072
  s_add_u32 s23, s23, 4096
  buffer_load_dwordx4 v[200:203], v4, s[24:27], s23 offen offset:0
  buffer_load_dwordx4 v[200:203], v4, s[24:27], s23 offen offset:1024
  buffer_load_dwordx4 v[200:203], v4, s[24:27], s23 offen offset:2048
  buffer_load_dwordx4 v[200:203], v4, s[24:27], s23 offen offset:3072
  s_add_u32 s23, s23, 4096
  buffer_load_dwordx4 v[200:203], v4, s[24:27], s23 offen offset:0
  buffer_load_dwordx4 v[200:203], v4, s[24:27], s23 offen offset:1024
  s_barrier
  ds_read_b64_tr_b16 a[0:1], v8 offset:0
  ds_read_b64_tr_b16 a[2:3], v8 offset:20480
  ds_read_b64_tr_b16 a[24:25], v8 offset:8
  ds_read_b64_tr_b16 a[26:27], v8 offset:20488
  ds_read_b64_tr_b16 a[48:49], v6 offset:64
  ds_read_b64_tr_b16 a[50:51], v6 offset:20544
  ds_read_b64_tr_b16 a[72:73], v8 offset:96
  ds_read_b64_tr_b16 a[74:75], v8 offset:20576
  ds_read_b64_tr_b16 a[96:97], v8 offset:104
  ds_read_b64_tr_b16 a[98:99], v8 offset:20584
  ds_read_b64_tr_b16 a[120:121], v8 offset:160
  ds_read_b64_tr_b16 a[122:123], v8 offset:20640
  ds_read_b64_tr_b16 a[144:145], v8 offset:168
  ds_read_b64_tr_b16 a[146:147], v8 offset:20648
  ds_read_b64_tr_b16 a[168:169], v6 offset:224
  ds_read_b64_tr_b16 a[170:171], v6 offset:20704
  ds_read_b64_tr_b16 a[192:193], v8 offset:256
  ds_read_b64_tr_b16 a[194:195], v8 offset:20736
  ds_read_b64_tr_b16 a[216:217], v8 offset:264
  ds_read_b64_tr_b16 a[218:219], v8 offset:20744
  ds_read_b64_tr_b16 a[4:5], v9 offset:0
  ds_read_b64_tr_b16 a[6:7], v9 offset:20480
  ds_read_b64_tr_b16 a[28:29], v9 offset:8
  ds_read_b64_tr_b16 a[30:31], v9 offset:20488
  ds_read_b64_tr_b16 a[52:53], v7 offset:64
  ds_read_b64_tr_b16 a[54:55], v7 offset:20544
  ds_read_b64_tr_b16 a[76:77], v9 offset:96
  ds_read_b64_tr_b16 a[78:79], v9 offset:20576
  ds_read_b64_tr_b16 a[100:101], v9 offset:104
  ds_read_b64_tr_b16 a[102:103], v9 offset:20584
  ds_read_b64_tr_b16 a[124:125], v9 offset:160
  ds_read_b64_tr_b16 a[126:127], v9 offset:20640
  ds_read_b64_tr_b16 a[148:149], v9 offset:168
  ds_read_b64_tr_b16 a[150:151], v9 offset:20648
  ds_read_b64_tr_b16 a[172:173], v7 offset:224
  ds_read_b64_tr_b16 a[174:175], v7 offset:20704
  ds_read_b64_tr_b16 a[196:197], v9 offset:256
  ds_read_b64_tr_b16 a[198:199], v9 offset:20736
  ds_read_b64_tr_b16 a[220:221], v9 offset:264
  ds_read_b64_tr_b16 a[222:223], v9 offset:20744
  ds_read_b64_tr_b16 a[8:9], v8 offset:40960
  ds_read_b64_tr_b16 a[10:11], v9 offset:40960
  ds_read_b64_tr_b16 a[32:33], v8 offset:40968
  ds_read_b64_tr_b16 a[34:35], v9 offset:40968
  ds_read_b64_tr_b16 a[56:57], v6 offset:41024
  ds_read_b64_tr_b16 a[58:59], v7 offset:41024
  ds_read_b64_tr_b16 a[80:81], v8 offset:41056
  ds_read_b64_tr_b16 a[82:83], v9 offset:41056
  ds_read_b64_tr_b16 a[104:105], v8 offset:41064
  ds_read_b64_tr_b16 a[106:107], v9 offset:41064
  ds_read_b64_tr_b16 a[128:129], v8 offset:41120
  ds_read_b64_tr_b16 a[130:131], v9 offset:41120
  ds_read_b64_tr_b16 a[152:153], v8 offset:41128
  ds_read_b64_tr_b16 a[154:155], v9 offset:41128
  ds_read_b64_tr_b16 a[176:177], v6 offset:41184
  ds_read_b64_tr_b16 a[178:179], v7 offset:41184
  ds_read_b64_tr_b16 a[200:201], v8 offset:41216
  ds_read_b64_tr_b16 a[202:203], v9 offset:41216
  ds_read_b64_tr_b16 a[224:225], v8 offset:41224
  ds_read_b64_tr_b16 a[226:227], v9 offset:41224
  s_waitcnt lgkmcnt(0)
  s_barrier
  s_waitcnt vmcnt(30)
  ds_write_b128 v5, v[64:67] offset:0
  ds_write_b128 v5, v[68:71] offset:1024
  ds_write_b128 v5, v[72:75] offset:2048
  ds_write_b128 v5, v[76:79] offset:3072
  ds_write_b128 v5, v[80:83] offset:4096
  ds_write_b128 v5, v[84:87] offset:5120
  ds_write_b128 v5, v[88:91] offset:6144
  ds_write_b128 v5, v[92:95] offset:7168
  ds_write_b128 v5, v[96:99] offset:8192
  ds_write_b128 v5, v[100:103] offset:9216
  ds_write_b128 v5, v[104:107] offset:10240
  ds_write_b128 v5, v[108:111] offset:11264
  ds_write_b128 v5, v[112:115] offset:12288
  ds_write_b128 v5, v[116:119] offset:13312
  ds_write_b128 v5, v[120:123] offset:14336
  ds_write_b128 v5, v[124:127] offset:15360
  ds_write_b128 v5, v[128:131] offset:16384
  ds_write_b128 v5, v[132:135] offset:17408
  ds_write_b128 v5, v[136:139] offset:18432
  ds_write_b128 v5, v[140:143] offset:19456
  ds_write_b128 v5, v[144:147] offset:20480
  ds_write_b128 v5, v[148:151] offset:21504
  ds_write_b128 v5, v[152:155] offset:22528
  ds_write_b128 v5, v[156:159] offset:23552
  ds_write_b128 v5, v[160:163] offset:24576
  ds_write_b128 v5, v[164:167] offset:25600
  ds_write_b128 v5, v[168:171] offset:26624
  ds_write_b128 v5, v[172:175] offset:27648
  ds_write_b128 v5, v[176:179] offset:28672
  ds_write_b128 v5, v[180:183] offset:29696
  s_waitcnt lgkmcnt(0)
  s_barrier
  ds_read_b64_tr_b16 a[12:13], v8 offset:0
  ds_read_b64_tr_b16 a[14:15], v8 offset:20480
  ds_read_b64_tr_b16 a[36:37], v8 offset:8
  ds_read_b64_tr_b16 a[38:39], v8 offset:20488
  ds_read_b64_tr_b16 a[60:61], v6 offset:64
  ds_read_b64_tr_b16 a[62:63], v6 offset:20544
  ds_read_b64_tr_b16 a[84:85], v8 offset:96
  ds_read_b64_tr_b16 a[86:87], v8 offset:20576
  ds_read_b64_tr_b16 a[108:109], v8 offset:104
  ds_read_b64_tr_b16 a[110:111], v8 offset:20584
  ds_read_b64_tr_b16 a[132:133], v8 offset:160
  ds_read_b64_tr_b16 a[134:135], v8 offset:20640
  ds_read_b64_tr_b16 a[156:157], v8 offset:168
  ds_read_b64_tr_b16 a[158:159], v8 offset:20648
  ds_read_b64_tr_b16 a[180:181], v6 offset:224
  ds_read_b64_tr_b16 a[182:183], v6 offset:20704
  ds_read_b64_tr_b16 a[204:205], v8 offset:256
  ds_read_b64_tr_b16 a[206:207], v8 offset:20736
  ds_read_b64_tr_b16 a[228:229], v8 offset:264
  ds_read_b64_tr_b16 a[230:231], v8 offset:20744
  ds_read_b64_tr_b16 a[16:17], v9 offset:0
  ds_read_b64_tr_b16 a[18:19], v9 offset:20480
  ds_read_b64_tr_b16 a[40:41], v9 offset:8
  ds_read_b64_tr_b16 a[42:43], v9 offset:20488
  ds_read_b64_tr_b16 a[64:65], v7 offset:64
  ds_read_b64_tr_b16 a[66:67], v7 offset:20544
  ds_read_b64_tr_b16 a[88:89], v9 offset:96
  ds_read_b64_tr_b16 a[90:91], v9 offset:20576
  ds_read_b64_tr_b16 a[112:113], v9 offset:104
  ds_read_b64_tr_b16 a[114:115], v9 offset:20584
  ds_read_b64_tr_b16 a[136:137], v9 offset:160
  ds_read_b64_tr_b16 a[138:139], v9 offset:20640
  ds_read_b64_tr_b16 a[160:161], v9 offset:168
  ds_read_b64_tr_b16 a[162:163], v9 offset:20648
  ds_read_b64_tr_b16 a[184:185], v7 offset:224
  ds_read_b64_tr_b16 a[186:187], v7 offset:20704
  ds_read_b64_tr_b16 a[208:209], v9 offset:256
  ds_read_b64_tr_b16 a[210:211], v9 offset:20736
  ds_read_b64_tr_b16 a[232:233], v9 offset:264
  ds_read_b64_tr_b16 a[234:235], v9 offset:20744
  ds_read_b64_tr_b16 a[20:21], v8 offset:40960
  ds_read_b64_tr_b16 a[22:23], v9 offset:40960
  ds_read_b64_tr_b16 a[44:45], v8 offset:40968
  ds_read_b64_tr_b16 a[46:47], v9 offset:40968
  ds_read_b64_tr_b16 a[68:69], v6 offset:41024
  ds_read_b64_tr_b16 a[70:71], v7 offset:41024
  ds_read_b64_tr_b16 a[92:93], v8 offset:41056
  ds_read_b64_tr_b16 a[94:95], v9 offset:41056
  ds_read_b64_tr_b16 a[116:117], v8 offset:41064
  ds_read_b64_tr_b16 a[118:119], v9 offset:41064
  ds_read_b64_tr_b16 a[140:141], v8 offset:41120
  ds_read_b64_tr_b16 a[142:143], v9 offset:41120
  ds_read_b64_tr_b16 a[164:165], v8 offset:41128
  ds_read_b64_tr_b16 a[166:167], v9 offset:41128
  ds_read_b64_tr_b16 a[188:189], v6 offset:41184
  ds_read_b64_tr_b16 a[190:191], v7 offset:41184
  ds_read_b64_tr_b16 a[212:213], v8 offset:41216
  ds_read_b64_tr_b16 a[214:215], v9 offset:41216
  ds_read_b64_tr_b16 a[236:237], v8 offset:41224
  ds_read_b64_tr_b16 a[238:239], v9 offset:41224
  s_waitcnt lgkmcnt(0)
  s_barrier
  s_load_dwordx2 s[32:33], s[0:1], 96
  s_waitcnt lgkmcnt(0)
  s_mov_b32 s32, s32
  s_mov_b32 s33, s33
  s_mov_b32 s34, 256
  s_mov_b32 s35, 0x00020000
  s_mov_b32 s21, 76
  v_mov_b32 v4, 0
  s_mov_b32 s101, 0
wf_206:
  buffer_load_dword v5, v4, s[32:35], s21 offen sc1
  s_add_u32 s101, s101, 1
  s_cmp_gt_u32 s101, 131072
  s_cbranch_scc1 main_end
  s_waitcnt vmcnt(0)
  v_readfirstlane_b32 s100, v5
  s_cmp_ge_u32 s100, 1
  s_cbranch_scc1 wf_207
  s_sleep 8
  s_branch wf_206
wf_207:
  s_sub_u32 s80, s100, 1
  s_lshl_b32 s80, s80, 13
  s_lshl_b32 s40, s2, 2
  s_add_u32 s40, s40, s20
  s_lshl_b32 s40, s40, 14
  s_xor_b32 s40, s40, s80
  s_xor_b32 s40, s40, 8192
  s_mul_i32 s47, s20, 3072
  s_lshr_b32 s43, s2, 2
  s_lshl_b32 s43, s43, 7
  s_add_u32 s43, s43, 28672
  s_xor_b32 s43, s43, s80
  s_lshl_b32 s44, s2, 7
  s_lshl_b32 s21, s20, 2
  s_add_u32 s44, s44, s21
  s_add_u32 s44, s44, 4096
  s_xor_b32 s44, s44, s80
  s_lshl_b32 s49, s20, 8
  s_add_u32 s49, s49, 12288
  s_mov_b32 s45, 0
  v_lshlrev_b32 v4, 4, v1
  v_min_u32 v14, 18, v1
  v_lshlrev_b32 v14, 2, v14
  v_mov_b32 v17, 1073741824
  v_cmp_eq_u32 vcc, 0, v1
  s_nop 1
  v_cndmask_b32 v17, v17, 0, vcc
  v_mov_b32 v16, 0
  v_mov_b32 v18, 65536
vwr_208:
  s_cmp_lg_u32 s20, 0
  s_cbranch_scc1 vwr_211
  s_mov_b32 s101, 0
  s_branch vwr_210
vwr_209:
  s_cmp_lg_u32 s101, 1
  s_cbranch_scc1 vwr_212
  buffer_store_dword v16, v17, s[72:75], s44 offen sc1
vwr_212:
  s_sleep 4
vwr_210:
  buffer_load_dword v15, v14, s[72:75], s43 offen sc1
  s_add_u32 s101, s101, 1
  s_cmp_gt_u32 s101, 131072
  s_cbranch_scc1 main_end
  s_waitcnt vmcnt(0)
  v_cmp_le_u32 vcc, 8, v15
  s_nop 1
  s_ff0_i32_b32 s21, vcc_lo
  s_min_u32 s21, s21, 19
  s_lshl_b32 s22, s21, 1
  s_lshl_b32 s21, s21, 2
  s_sub_i32 s21, s21, 12
  s_max_i32 s46, s21, s22
  s_cmp_le_u32 s46, s45
  s_cbranch_scc1 vwr_209
  v_mov_b32 v15, s46
  ds_write_b32 v18, v15
  s_waitcnt lgkmcnt(0)
  s_barrier
  s_branch vwr_213
vwr_211:
  s_waitcnt vmcnt(0)
  buffer_store_dword v16, v17, s[72:75], s44 offen sc1
  s_barrier
  ds_read_b32 v15, v18
  s_waitcnt lgkmcnt(0)
  v_readfirstlane_b32 s46, v15
vwr_213:
  s_and_b32 s50, s45, 2
  s_lshl_b32 s50, s50, 14
  v_add_u32 v10, s50, v4
  v_add_u32 v11, 2048, v10
  v_add_u32 v12, 2056, v10
  v_lshl_add_u32 v13, v1, 2, s50
  s_lshl_b32 s41, s45, 21
  s_add_u32 s41, s41, s40
  s_mov_b32 s48, s45
  s_mov_b32 s56, s41
  s_add_u32 s57, s56, 4096
  s_lshl_b32 s58, s45, 19
  s_lshl_b32 s21, s45, 11
  s_and_b32 s21, s21, 8192
  s_xor_b32 s21, s21, s80
  s_add_u32 s58, s58, s21
  s_add_u32 s58, s58, 134217728
  s_lshl_b32 s21, s2, 14
  s_lshl_b32 s22, s20, 11
  s_add_u32 s21, s21, s22
  s_add_u32 s58, s58, s21
  s_mov_b32 s51, 1073741824
  s_mov_b32 s59, 1073741824
  s_mov_b32 s52, s50
  s_cmp_lt_u32 s48, s46
  s_cselect_b32 s53, s41, 1073741824
  s_add_u32 s54, s52, 0
  s_add_u32 m0, s54, s47
  s_nop 0
  buffer_load_dwordx4 v4, s[16:19], s53 offen offset:0 sc1 lds
  buffer_load_dwordx4 v4, s[16:19], s53 offen offset:1024 sc1 lds
  buffer_load_dwordx4 v4, s[16:19], s53 offen offset:2048 sc1 lds
  s_nop 0
  s_add_u32 m0, s54, s49
  s_nop 0
  buffer_load_dword v14, s[72:75], s43 offen sc1 lds
  s_add_u32 s41, s41, 2097152
  s_xor_b32 s41, s41, 8192
  s_add_u32 s48, s48, 1
  s_cmp_lt_u32 s48, s46
  s_cselect_b32 s53, s41, 1073741824
  s_add_u32 s54, s52, 16384
  s_add_u32 m0, s54, s47
  s_nop 0
  buffer_load_dwordx4 v4, s[16:19], s53 offen offset:0 sc1 lds
  buffer_load_dwordx4 v4, s[16:19], s53 offen offset:1024 sc1 lds
  buffer_load_dwordx4 v4, s[16:19], s53 offen offset:2048 sc1 lds
  s_nop 0
  s_add_u32 m0, s54, s49
  s_nop 0
  buffer_load_dword v14, s[72:75], s43 offen sc1 lds
  s_add_u32 s41, s41, 2097152
  s_xor_b32 s41, s41, 8192
  s_add_u32 s48, s48, 1
  s_xor_b32 s52, s52, 32768
  s_cmp_lt_u32 s48, s46
  s_cselect_b32 s53, s41, 1073741824
  s_add_u32 s54, s52, 0
  s_add_u32 m0, s54, s47
  s_nop 0
  buffer_load_dwordx4 v4, s[16:19], s53 offen offset:0 sc1 lds
  buffer_load_dwordx4 v4, s[16:19], s53 offen offset:1024 sc1 lds
  buffer_load_dwordx4 v4, s[16:19], s53 offen offset:2048 sc1 lds
  s_nop 0
  s_add_u32 m0, s54, s49
  s_nop 0
  buffer_load_dword v14, s[72:75], s43 offen sc1 lds
  s_add_u32 s41, s41, 2097152
  s_xor_b32 s41, s41, 8192
  s_add_u32 s48, s48, 1
  s_waitcnt vmcnt(0)
  buffer_store_dword v16, v17, s[72:75], s44 offen sc1
  s_barrier
  ds_read_b128 v[64:67], v10 offset:0
  ds_read_b128 v[88:91], v10 offset:1024
  ds_read_b128 v[68:71], v10 offset:3072
  ds_read_b128 v[92:95], v10 offset:4096
  ds_read2st64_b64 v[72:75], v11 offset0:0 offset1:6
  ds_read2st64_b64 v[96:99], v12 offset0:0 offset1:6
  ds_read_b128 v[76:79], v10 offset:6144
  ds_read_b128 v[100:103], v10 offset:7168
  ds_read_b128 v[80:83], v10 offset:9216
  ds_read_b128 v[104:107], v10 offset:10240
  ds_read2st64_b64 v[84:87], v11 offset0:12 offset1:18
  ds_read2st64_b64 v[108:111], v12 offset0:12 offset1:18
  s_waitcnt lgkmcnt(0)
  .p2align 3
vwl_214:
  v_mfma_f32_16x16x32_bf16 v[160:163], v[64:67], a[0:3], 0
  v_mfma_f32_16x16x32_bf16 v[164:167], v[88:91], a[0:3], 0
  v_mfma_f32_16x16x32_bf16 v[160:163], v[68:71], a[4:7], v[160:163]
  v_cvt_pk_bf16_f32 v204, v184, v185
  v_cvt_pk_bf16_f32 v205, v186, v187
  v_mfma_f32_16x16x32_bf16 v[164:167], v[92:95], a[4:7], v[164:167]
  v_cvt_pk_bf16_f32 v206, v188, v189
  v_cvt_pk_bf16_f32 v207, v190, v191
  v_mfma_f32_16x16x32_bf16 v[160:163], v[72:75], a[8:11], v[160:163]
  buffer_store_dwordx4 v[204:207], v4, s[16:19], s51 offen offset:3072 sc1
  v_mfma_f32_16x16x32_bf16 v[164:167], v[96:99], a[8:11], v[164:167]
  v_mfma_f32_16x16x32_bf16 v[160:163], v[76:79], a[12:15], v[160:163]
  v_mfma_f32_16x16x32_bf16 v[164:167], v[100:103], a[12:15], v[164:167]
  s_waitcnt vmcnt(23)
  s_barrier
  ds_read_b32 v15, v13 offset:28672
  v_mfma_f32_16x16x32_bf16 v[160:163], v[80:83], a[16:19], v[160:163]
  ds_read_b128 v[112:115], v10 offset:16384
  v_mfma_f32_16x16x32_bf16 v[164:167], v[104:107], a[16:19], v[164:167]
  v_mfma_f32_16x16x32_bf16 v[160:163], v[84:87], a[20:23], v[160:163]
  ds_read_b128 v[136:139], v10 offset:17408
  v_mfma_f32_16x16x32_bf16 v[164:167], v[108:111], a[20:23], v[164:167]
  v_mfma_f32_16x16x32_bf16 v[168:171], v[64:67], a[24:27], 0
  ds_read_b128 v[116:119], v10 offset:19456
  v_mfma_f32_16x16x32_bf16 v[172:175], v[88:91], a[24:27], 0
  v_mfma_f32_16x16x32_bf16 v[168:171], v[68:71], a[28:31], v[168:171]
  v_cvt_pk_bf16_f32 v192, v160, v161
  v_cvt_pk_bf16_f32 v193, v162, v163
  v_mfma_f32_16x16x32_bf16 v[172:175], v[92:95], a[28:31], v[172:175]
  v_cvt_pk_bf16_f32 v194, v164, v165
  v_cvt_pk_bf16_f32 v195, v166, v167
  v_mfma_f32_16x16x32_bf16 v[168:171], v[72:75], a[32:35], v[168:171]
  buffer_store_dwordx4 v[192:195], v4, s[16:19], s56 offen offset:0 sc1
  ds_read_b128 v[140:143], v10 offset:20480
  v_mfma_f32_16x16x32_bf16 v[172:175], v[96:99], a[32:35], v[172:175]
  v_mfma_f32_16x16x32_bf16 v[168:171], v[76:79], a[36:39], v[168:171]
  ds_read2st64_b64 v[120:123], v11 offset0:32 offset1:38
  v_mfma_f32_16x16x32_bf16 v[172:175], v[100:103], a[36:39], v[172:175]
  v_mfma_f32_16x16x32_bf16 v[168:171], v[80:83], a[40:43], v[168:171]
  ds_read2st64_b64 v[144:147], v12 offset0:32 offset1:38
  v_mfma_f32_16x16x32_bf16 v[172:175], v[104:107], a[40:43], v[172:175]
  v_mfma_f32_16x16x32_bf16 v[168:171], v[84:87], a[44:47], v[168:171]
  ds_read_b128 v[124:127], v10 offset:22528
  v_mfma_f32_16x16x32_bf16 v[172:175], v[108:111], a[44:47], v[172:175]
  v_mfma_f32_16x16x32_bf16 v[176:179], v[64:67], a[48:51], 0
  ds_read_b128 v[148:151], v10 offset:23552
  v_mfma_f32_16x16x32_bf16 v[180:183], v[88:91], a[48:51], 0
  v_mfma_f32_16x16x32_bf16 v[176:179], v[68:71], a[52:55], v[176:179]
  v_cvt_pk_bf16_f32 v196, v168, v169
  v_cvt_pk_bf16_f32 v197, v170, v171
  v_mfma_f32_16x16x32_bf16 v[180:183], v[92:95], a[52:55], v[180:183]
  v_cvt_pk_bf16_f32 v198, v172, v173
  v_cvt_pk_bf16_f32 v199, v174, v175
  v_mfma_f32_16x16x32_bf16 v[176:179], v[72:75], a[56:59], v[176:179]
  buffer_store_dwordx4 v[196:199], v4, s[16:19], s56 offen offset:1024 sc1
  ds_read_b128 v[128:131], v10 offset:25600
  v_mfma_f32_16x16x32_bf16 v[180:183], v[96:99], a[56:59], v[180:183]
  v_mfma_f32_16x16x32_bf16 v[176:179], v[76:79], a[60:63], v[176:179]
  ds_read_b128 v[152:155], v10 offset:26624
  v_mfma_f32_16x16x32_bf16 v[180:183], v[100:103], a[60:63], v[180:183]
  v_mfma_f32_16x16x32_bf16 v[176:179], v[80:83], a[64:67], v[176:179]
  ds_read2st64_b64 v[132:135], v11 offset0:44 offset1:50
  v_mfma_f32_16x16x32_bf16 v[180:183], v[104:107], a[64:67], v[180:183]
  v_mfma_f32_16x16x32_bf16 v[176:179], v[84:87], a[68:71], v[176:179]
  ds_read2st64_b64 v[156:159], v12 offset0:44 offset1:50
  v_mfma_f32_16x16x32_bf16 v[180:183], v[108:111], a[68:71], v[180:183]
  v_mfma_f32_16x16x32_bf16 v[184:187], v[64:67], a[72:75], 0
  v_mfma_f32_16x16x32_bf16 v[188:191], v[88:91], a[72:75], 0
  s_waitcnt lgkmcnt(12)
  v_cmp_le_u32 vcc, 8, v15
  v_mfma_f32_16x16x32_bf16 v[184:187], v[68:71], a[76:79], v[184:187]
  v_cvt_pk_bf16_f32 v200, v176, v177
  v_cvt_pk_bf16_f32 v201, v178, v179
  v_mfma_f32_16x16x32_bf16 v[188:191], v[92:95], a[76:79], v[188:191]
  s_ff0_i32_b32 s21, vcc_lo
  v_cvt_pk_bf16_f32 v202, v180, v181
  v_cvt_pk_bf16_f32 v203, v182, v183
  v_mfma_f32_16x16x32_bf16 v[184:187], v[72:75], a[80:83], v[184:187]
  s_min_u32 s21, s21, 19
  buffer_store_dwordx4 v[200:203], v4, s[16:19], s58 offen offset:0 sc1
  s_lshl_b32 s22, s21, 1
  v_mfma_f32_16x16x32_bf16 v[188:191], v[96:99], a[80:83], v[188:191]
  s_lshl_b32 s21, s21, 2
  s_sub_i32 s21, s21, 12
  s_max_i32 s21, s21, s22
  v_mfma_f32_16x16x32_bf16 v[184:187], v[76:79], a[84:87], v[184:187]
  s_max_u32 s42, s21, s46
  s_cmp_ge_u32 s46, s48
  s_cselect_b32 s46, s42, s46
  v_mfma_f32_16x16x32_bf16 v[188:191], v[100:103], a[84:87], v[188:191]
  s_cmp_lt_u32 s48, s46
  s_cselect_b32 s53, s41, 1073741824
  s_add_u32 s54, s52, 16384
  v_mfma_f32_16x16x32_bf16 v[184:187], v[80:83], a[88:91], v[184:187]
  s_add_u32 m0, s54, s47
  v_mfma_f32_16x16x32_bf16 v[188:191], v[104:107], a[88:91], v[188:191]
  buffer_load_dwordx4 v4, s[16:19], s53 offen offset:0 sc1 lds
  buffer_load_dwordx4 v4, s[16:19], s53 offen offset:1024 sc1 lds
  v_mfma_f32_16x16x32_bf16 v[184:187], v[84:87], a[92:95], v[184:187]
  buffer_load_dwordx4 v4, s[16:19], s53 offen offset:2048 sc1 lds
  v_mfma_f32_16x16x32_bf16 v[188:191], v[108:111], a[92:95], v[188:191]
  s_add_u32 m0, s54, s49
  v_mfma_f32_16x16x32_bf16 v[160:163], v[64:67], a[96:99], 0
  buffer_load_dword v14, s[72:75], s43 offen sc1 lds
  s_add_u32 s41, s41, 2097152
  v_mfma_f32_16x16x32_bf16 v[164:167], v[88:91], a[96:99], 0
  s_xor_b32 s41, s41, 8192
  s_add_u32 s48, s48, 1
  v_mfma_f32_16x16x32_bf16 v[160:163], v[68:71], a[100:103], v[160:163]
  v_cvt_pk_bf16_f32 v204, v184, v185
  v_cvt_pk_bf16_f32 v205, v186, v187
  v_mfma_f32_16x16x32_bf16 v[164:167], v[92:95], a[100:103], v[164:167]
  v_cvt_pk_bf16_f32 v206, v188, v189
  v_cvt_pk_bf16_f32 v207, v190, v191
  v_mfma_f32_16x16x32_bf16 v[160:163], v[72:75], a[104:107], v[160:163]
  buffer_store_dwordx4 v[204:207], v4, s[16:19], s56 offen offset:2048 sc1
  v_mfma_f32_16x16x32_bf16 v[164:167], v[96:99], a[104:107], v[164:167]
  v_mfma_f32_16x16x32_bf16 v[160:163], v[76:79], a[108:111], v[160:163]
  v_mfma_f32_16x16x32_bf16 v[164:167], v[100:103], a[108:111], v[164:167]
  v_mfma_f32_16x16x32_bf16 v[160:163], v[80:83], a[112:115], v[160:163]
  v_mfma_f32_16x16x32_bf16 v[164:167], v[104:107], a[112:115], v[164:167]
  v_mfma_f32_16x16x32_bf16 v[160:163], v[84:87], a[116:119], v[160:163]
  v_mfma_f32_16x16x32_bf16 v[164:167], v[108:111], a[116:119], v[164:167]
  v_mfma_f32_16x16x32_bf16 v[168:171], v[64:67], a[120:123], 0
  v_mfma_f32_16x16x32_bf16 v[172:175], v[88:91], a[120:123], 0
  v_mfma_f32_16x16x32_bf16 v[168:171], v[68:71], a[124:127], v[168:171]
  v_cvt_pk_bf16_f32 v192, v160, v161
  v_cvt_pk_bf16_f32 v193, v162, v163
  v_mfma_f32_16x16x32_bf16 v[172:175], v[92:95], a[124:127], v[172:175]
  v_cvt_pk_bf16_f32 v194, v164, v165
  v_cvt_pk_bf16_f32 v195, v166, v167
  v_mfma_f32_16x16x32_bf16 v[168:171], v[72:75], a[128:131], v[168:171]
  buffer_store_dwordx4 v[192:195], v4, s[16:19], s56 offen offset:3072 sc1
  v_mfma_f32_16x16x32_bf16 v[172:175], v[96:99], a[128:131], v[172:175]
  v_mfma_f32_16x16x32_bf16 v[168:171], v[76:79], a[132:135], v[168:171]
  v_mfma_f32_16x16x32_bf16 v[172:175], v[100:103], a[132:135], v[172:175]
  v_mfma_f32_16x16x32_bf16 v[168:171], v[80:83], a[136:139], v[168:171]
  v_mfma_f32_16x16x32_bf16 v[172:175], v[104:107], a[136:139], v[172:175]
  v_mfma_f32_16x16x32_bf16 v[168:171], v[84:87], a[140:143], v[168:171]
  v_mfma_f32_16x16x32_bf16 v[172:175], v[108:111], a[140:143], v[172:175]
  v_mfma_f32_16x16x32_bf16 v[176:179], v[64:67], a[144:147], 0
  v_mfma_f32_16x16x32_bf16 v[180:183], v[88:91], a[144:147], 0
  v_mfma_f32_16x16x32_bf16 v[176:179], v[68:71], a[148:151], v[176:179]
  v_cvt_pk_bf16_f32 v196, v168, v169
  v_cvt_pk_bf16_f32 v197, v170, v171
  v_mfma_f32_16x16x32_bf16 v[180:183], v[92:95], a[148:151], v[180:183]
  v_cvt_pk_bf16_f32 v198, v172, v173
  v_cvt_pk_bf16_f32 v199, v174, v175
  v_mfma_f32_16x16x32_bf16 v[176:179], v[72:75], a[152:155], v[176:179]
  buffer_store_dwordx4 v[196:199], v4, s[16:19], s57 offen offset:0 sc1
  v_mfma_f32_16x16x32_bf16 v[180:183], v[96:99], a[152:155], v[180:183]
  v_mfma_f32_16x16x32_bf16 v[176:179], v[76:79], a[156:159], v[176:179]
  v_mfma_f32_16x16x32_bf16 v[180:183], v[100:103], a[156:159], v[180:183]
  v_mfma_f32_16x16x32_bf16 v[176:179], v[80:83], a[160:163], v[176:179]
  v_mfma_f32_16x16x32_bf16 v[180:183], v[104:107], a[160:163], v[180:183]
  v_mfma_f32_16x16x32_bf16 v[176:179], v[84:87], a[164:167], v[176:179]
  v_mfma_f32_16x16x32_bf16 v[180:183], v[108:111], a[164:167], v[180:183]
  v_mfma_f32_16x16x32_bf16 v[184:187], v[64:67], a[168:171], 0
  v_mfma_f32_16x16x32_bf16 v[188:191], v[88:91], a[168:171], 0
  v_mfma_f32_16x16x32_bf16 v[184:187], v[68:71], a[172:175], v[184:187]
  v_cvt_pk_bf16_f32 v200, v176, v177
  v_cvt_pk_bf16_f32 v201, v178, v179
  v_mfma_f32_16x16x32_bf16 v[188:191], v[92:95], a[172:175], v[188:191]
  v_cvt_pk_bf16_f32 v202, v180, v181
  v_cvt_pk_bf16_f32 v203, v182, v183
  v_mfma_f32_16x16x32_bf16 v[184:187], v[72:75], a[176:179], v[184:187]
  buffer_store_dwordx4 v[200:203], v4, s[16:19], s57 offen offset:1024 sc1
  v_mfma_f32_16x16x32_bf16 v[188:191], v[96:99], a[176:179], v[188:191]
  v_mfma_f32_16x16x32_bf16 v[184:187], v[76:79], a[180:183], v[184:187]
  v_mfma_f32_16x16x32_bf16 v[188:191], v[100:103], a[180:183], v[188:191]
  v_mfma_f32_16x16x32_bf16 v[184:187], v[80:83], a[184:187], v[184:187]
  v_mfma_f32_16x16x32_bf16 v[188:191], v[104:107], a[184:187], v[188:191]
  v_mfma_f32_16x16x32_bf16 v[184:187], v[84:87], a[188:191], v[184:187]
  v_mfma_f32_16x16x32_bf16 v[188:191], v[108:111], a[188:191], v[188:191]
  v_mfma_f32_16x16x32_bf16 v[160:163], v[64:67], a[192:195], 0
  s_min_u32 s21, s45, 52
  v_mov_b32 v16, s21
  s_waitcnt vmcnt(11)
  v_mfma_f32_16x16x32_bf16 v[164:167], v[88:91], a[192:195], 0
  buffer_store_dword v16, v17, s[72:75], s44 offen sc1
  v_mfma_f32_16x16x32_bf16 v[160:163], v[68:71], a[196:199], v[160:163]
  v_cvt_pk_bf16_f32 v204, v184, v185
  v_cvt_pk_bf16_f32 v205, v186, v187
  v_mfma_f32_16x16x32_bf16 v[164:167], v[92:95], a[196:199], v[164:167]
  v_cvt_pk_bf16_f32 v206, v188, v189
  v_cvt_pk_bf16_f32 v207, v190, v191
  v_mfma_f32_16x16x32_bf16 v[160:163], v[72:75], a[200:203], v[160:163]
  buffer_store_dwordx4 v[204:207], v4, s[16:19], s58 offen offset:1024 sc1
  v_mfma_f32_16x16x32_bf16 v[164:167], v[96:99], a[200:203], v[164:167]
  v_mfma_f32_16x16x32_bf16 v[160:163], v[76:79], a[204:207], v[160:163]
  s_add_u32 s56, s56, 2097152
  s_xor_b32 s56, s56, 8192
  s_add_u32 s59, s58, 524288
  v_mfma_f32_16x16x32_bf16 v[164:167], v[100:103], a[204:207], v[164:167]
  s_xor_b32 s58, s58, s59
  s_lshr_b32 s58, s58, 8
  s_and_b32 s58, s58, 8192
  v_mfma_f32_16x16x32_bf16 v[160:163], v[80:83], a[208:211], v[160:163]
  s_xor_b32 s58, s58, s59
  v_mfma_f32_16x16x32_bf16 v[164:167], v[104:107], a[208:211], v[164:167]
  v_mfma_f32_16x16x32_bf16 v[160:163], v[84:87], a[212:215], v[160:163]
  v_mfma_f32_16x16x32_bf16 v[164:167], v[108:111], a[212:215], v[164:167]
  v_mfma_f32_16x16x32_bf16 v[168:171], v[64:67], a[216:219], 0
  v_mfma_f32_16x16x32_bf16 v[172:175], v[88:91], a[216:219], 0
  v_mfma_f32_16x16x32_bf16 v[168:171], v[68:71], a[220:223], v[168:171]
  v_cvt_pk_bf16_f32 v192, v160, v161
  v_cvt_pk_bf16_f32 v193, v162, v163
  v_mfma_f32_16x16x32_bf16 v[172:175], v[92:95], a[220:223], v[172:175]
  v_cvt_pk_bf16_f32 v194, v164, v165
  v_cvt_pk_bf16_f32 v195, v166, v167
  v_mfma_f32_16x16x32_bf16 v[168:171], v[72:75], a[224:227], v[168:171]
  buffer_store_dwordx4 v[192:195], v4, s[16:19], s57 offen offset:2048 sc1
  v_mfma_f32_16x16x32_bf16 v[172:175], v[96:99], a[224:227], v[172:175]
  v_mfma_f32_16x16x32_bf16 v[168:171], v[76:79], a[228:231], v[168:171]
  s_mov_b32 s51, s57
  s_add_u32 s57, s56, 4096
  s_add_u32 s45, s45, 1
  v_mfma_f32_16x16x32_bf16 v[172:175], v[100:103], a[228:231], v[172:175]
  v_mfma_f32_16x16x32_bf16 v[168:171], v[80:83], a[232:235], v[168:171]
  v_mfma_f32_16x16x32_bf16 v[172:175], v[104:107], a[232:235], v[172:175]
  v_mfma_f32_16x16x32_bf16 v[168:171], v[84:87], a[236:239], v[168:171]
  v_mfma_f32_16x16x32_bf16 v[172:175], v[108:111], a[236:239], v[172:175]
  s_waitcnt lgkmcnt(0)
  v_mfma_f32_16x16x32_bf16 v[176:179], v[112:115], a[0:3], 0
  v_mfma_f32_16x16x32_bf16 v[180:183], v[136:139], a[0:3], 0
  v_mfma_f32_16x16x32_bf16 v[176:179], v[116:119], a[4:7], v[176:179]
  v_cvt_pk_bf16_f32 v196, v168, v169
  v_cvt_pk_bf16_f32 v197, v170, v171
  v_mfma_f32_16x16x32_bf16 v[180:183], v[140:143], a[4:7], v[180:183]
  v_cvt_pk_bf16_f32 v198, v172, v173
  v_cvt_pk_bf16_f32 v199, v174, v175
  v_mfma_f32_16x16x32_bf16 v[176:179], v[120:123], a[8:11], v[176:179]
  buffer_store_dwordx4 v[196:199], v4, s[16:19], s51 offen offset:3072 sc1
  v_mfma_f32_16x16x32_bf16 v[180:183], v[144:147], a[8:11], v[180:183]
  v_mfma_f32_16x16x32_bf16 v[176:179], v[124:127], a[12:15], v[176:179]
  v_mfma_f32_16x16x32_bf16 v[180:183], v[148:151], a[12:15], v[180:183]
  s_waitcnt vmcnt(22)
  s_barrier
  v_xor_b32 v10, 32768, v10
  v_mfma_f32_16x16x32_bf16 v[176:179], v[128:131], a[16:19], v[176:179]
  v_xor_b32 v11, 32768, v11
  v_xor_b32 v12, 32768, v12
  v_mfma_f32_16x16x32_bf16 v[180:183], v[152:155], a[16:19], v[180:183]
  v_xor_b32 v13, 32768, v13
  ds_read_b32 v15, v13 offset:12288
  v_mfma_f32_16x16x32_bf16 v[176:179], v[132:135], a[20:23], v[176:179]
  ds_read_b128 v[64:67], v10 offset:0
  v_mfma_f32_16x16x32_bf16 v[180:183], v[156:159], a[20:23], v[180:183]
  v_mfma_f32_16x16x32_bf16 v[184:187], v[112:115], a[24:27], 0
  ds_read_b128 v[88:91], v10 offset:1024
  v_mfma_f32_16x16x32_bf16 v[188:191], v[136:139], a[24:27], 0
  v_mfma_f32_16x16x32_bf16 v[184:187], v[116:119], a[28:31], v[184:187]
  v_cvt_pk_bf16_f32 v200, v176, v177
  v_cvt_pk_bf16_f32 v201, v178, v179
  v_mfma_f32_16x16x32_bf16 v[188:191], v[140:143], a[28:31], v[188:191]
  v_cvt_pk_bf16_f32 v202, v180, v181
  v_cvt_pk_bf16_f32 v203, v182, v183
  v_mfma_f32_16x16x32_bf16 v[184:187], v[120:123], a[32:35], v[184:187]
  buffer_store_dwordx4 v[200:203], v4, s[16:19], s56 offen offset:0 sc1
  ds_read_b128 v[68:71], v10 offset:3072
  v_mfma_f32_16x16x32_bf16 v[188:191], v[144:147], a[32:35], v[188:191]
  v_mfma_f32_16x16x32_bf16 v[184:187], v[124:127], a[36:39], v[184:187]
  ds_read_b128 v[92:95], v10 offset:4096
  v_mfma_f32_16x16x32_bf16 v[188:191], v[148:151], a[36:39], v[188:191]
  v_mfma_f32_16x16x32_bf16 v[184:187], v[128:131], a[40:43], v[184:187]
  ds_read2st64_b64 v[72:75], v11 offset0:0 offset1:6
  v_mfma_f32_16x16x32_bf16 v[188:191], v[152:155], a[40:43], v[188:191]
  v_mfma_f32_16x16x32_bf16 v[184:187], v[132:135], a[44:47], v[184:187]
  ds_read2st64_b64 v[96:99], v12 offset0:0 offset1:6
  v_mfma_f32_16x16x32_bf16 v[188:191], v[156:159], a[44:47], v[188:191]
  v_mfma_f32_16x16x32_bf16 v[160:163], v[112:115], a[48:51], 0
  ds_read_b128 v[76:79], v10 offset:6144
  v_mfma_f32_16x16x32_bf16 v[164:167], v[136:139], a[48:51], 0
  v_mfma_f32_16x16x32_bf16 v[160:163], v[116:119], a[52:55], v[160:163]
  v_cvt_pk_bf16_f32 v204, v184, v185
  v_cvt_pk_bf16_f32 v205, v186, v187
  v_mfma_f32_16x16x32_bf16 v[164:167], v[140:143], a[52:55], v[164:167]
  v_cvt_pk_bf16_f32 v206, v188, v189
  v_cvt_pk_bf16_f32 v207, v190, v191
  v_mfma_f32_16x16x32_bf16 v[160:163], v[120:123], a[56:59], v[160:163]
  buffer_store_dwordx4 v[204:207], v4, s[16:19], s56 offen offset:1024 sc1
  ds_read_b128 v[100:103], v10 offset:7168
  v_mfma_f32_16x16x32_bf16 v[164:167], v[144:147], a[56:59], v[164:167]
  v_mfma_f32_16x16x32_bf16 v[160:163], v[124:127], a[60:63], v[160:163]
  ds_read_b128 v[80:83], v10 offset:9216
  v_mfma_f32_16x16x32_bf16 v[164:167], v[148:151], a[60:63], v[164:167]
  v_mfma_f32_16x16x32_bf16 v[160:163], v[128:131], a[64:67], v[160:163]
  ds_read_b128 v[104:107], v10 offset:10240
  v_mfma_f32_16x16x32_bf16 v[164:167], v[152:155], a[64:67], v[164:167]
  v_mfma_f32_16x16x32_bf16 v[160:163], v[132:135], a[68:71], v[160:163]
  ds_read2st64_b64 v[84:87], v11 offset0:12 offset1:18
  v_mfma_f32_16x16x32_bf16 v[164:167], v[156:159], a[68:71], v[164:167]
  v_mfma_f32_16x16x32_bf16 v[168:171], v[112:115], a[72:75], 0
  ds_read2st64_b64 v[108:111], v12 offset0:12 offset1:18
  v_mfma_f32_16x16x32_bf16 v[172:175], v[136:139], a[72:75], 0
  v_mfma_f32_16x16x32_bf16 v[168:171], v[116:119], a[76:79], v[168:171]
  v_cvt_pk_bf16_f32 v192, v160, v161
  v_cvt_pk_bf16_f32 v193, v162, v163
  v_mfma_f32_16x16x32_bf16 v[172:175], v[140:143], a[76:79], v[172:175]
  v_cvt_pk_bf16_f32 v194, v164, v165
  v_cvt_pk_bf16_f32 v195, v166, v167
  v_mfma_f32_16x16x32_bf16 v[168:171], v[120:123], a[80:83], v[168:171]
  buffer_store_dwordx4 v[192:195], v4, s[16:19], s58 offen offset:0 sc1
  s_waitcnt lgkmcnt(12)
  v_mfma_f32_16x16x32_bf16 v[172:175], v[144:147], a[80:83], v[172:175]
  v_cmp_le_u32 vcc, 8, v15
  v_mfma_f32_16x16x32_bf16 v[168:171], v[124:127], a[84:87], v[168:171]
  s_ff0_i32_b32 s21, vcc_lo
  s_min_u32 s21, s21, 19
  s_lshl_b32 s22, s21, 1
  v_mfma_f32_16x16x32_bf16 v[172:175], v[148:151], a[84:87], v[172:175]
  s_lshl_b32 s21, s21, 2
  s_sub_i32 s21, s21, 12
  s_max_i32 s21, s21, s22
  v_mfma_f32_16x16x32_bf16 v[168:171], v[128:131], a[88:91], v[168:171]
  s_max_u32 s42, s21, s46
  s_cmp_ge_u32 s46, s48
  s_cselect_b32 s46, s42, s46
  v_mfma_f32_16x16x32_bf16 v[172:175], v[152:155], a[88:91], v[172:175]
  s_xor_b32 s52, s52, 32768
  s_cmp_lt_u32 s48, s46
  s_cselect_b32 s53, s41, 1073741824
  v_mfma_f32_16x16x32_bf16 v[168:171], v[132:135], a[92:95], v[168:171]
  s_add_u32 s54, s52, 0
  s_add_u32 m0, s54, s47
  v_mfma_f32_16x16x32_bf16 v[172:175], v[156:159], a[92:95], v[172:175]
  buffer_load_dwordx4 v4, s[16:19], s53 offen offset:0 sc1 lds
  buffer_load_dwordx4 v4, s[16:19], s53 offen offset:1024 sc1 lds
  v_mfma_f32_16x16x32_bf16 v[176:179], v[112:115], a[96:99], 0
  buffer_load_dwordx4 v4, s[16:19], s53 offen offset:2048 sc1 lds
  v_mfma_f32_16x16x32_bf16 v[180:183], v[136:139], a[96:99], 0
  s_add_u32 m0, s54, s49
  v_mfma_f32_16x16x32_bf16 v[176:179], v[116:119], a[100:103], v[176:179]
  v_cvt_pk_bf16_f32 v196, v168, v169
  v_cvt_pk_bf16_f32 v197, v170, v171
  v_mfma_f32_16x16x32_bf16 v[180:183], v[140:143], a[100:103], v[180:183]
  v_cvt_pk_bf16_f32 v198, v172, v173
  v_cvt_pk_bf16_f32 v199, v174, v175
  v_mfma_f32_16x16x32_bf16 v[176:179], v[120:123], a[104:107], v[176:179]
  buffer_store_dwordx4 v[196:199], v4, s[16:19], s56 offen offset:2048 sc1
  buffer_load_dword v14, s[72:75], s43 offen sc1 lds
  v_mfma_f32_16x16x32_bf16 v[180:183], v[144:147], a[104:107], v[180:183]
  s_add_u32 s41, s41, 2097152
  s_xor_b32 s41, s41, 8192
  s_add_u32 s48, s48, 1
  v_mfma_f32_16x16x32_bf16 v[176:179], v[124:127], a[108:111], v[176:179]
  v_mfma_f32_16x16x32_bf16 v[180:183], v[148:151], a[108:111], v[180:183]
  v_mfma_f32_16x16x32_bf16 v[176:179], v[128:131], a[112:115], v[176:179]
  v_mfma_f32_16x16x32_bf16 v[180:183], v[152:155], a[112:115], v[180:183]
  v_mfma_f32_16x16x32_bf16 v[176:179], v[132:135], a[116:119], v[176:179]
  v_mfma_f32_16x16x32_bf16 v[180:183], v[156:159], a[116:119], v[180:183]
  v_mfma_f32_16x16x32_bf16 v[184:187], v[112:115], a[120:123], 0
  v_mfma_f32_16x16x32_bf16 v[188:191], v[136:139], a[120:123], 0
  v_mfma_f32_16x16x32_bf16 v[184:187], v[116:119], a[124:127], v[184:187]
  v_cvt_pk_bf16_f32 v200, v176, v177
  v_cvt_pk_bf16_f32 v201, v178, v179
  v_mfma_f32_16x16x32_bf16 v[188:191], v[140:143], a[124:127], v[188:191]
  v_cvt_pk_bf16_f32 v202, v180, v181
  v_cvt_pk_bf16_f32 v203, v182, v183
  v_mfma_f32_16x16x32_bf16 v[184:187], v[120:123], a[128:131], v[184:187]
  buffer_store_dwordx4 v[200:203], v4, s[16:19], s56 offen offset:3072 sc1
  v_mfma_f32_16x16x32_bf16 v[188:191], v[144:147], a[128:131], v[188:191]
  v_mfma_f32_16x16x32_bf16 v[184:187], v[124:127], a[132:135], v[184:187]
  v_mfma_f32_16x16x32_bf16 v[188:191], v[148:151], a[132:135], v[188:191]
  v_mfma_f32_16x16x32_bf16 v[184:187], v[128:131], a[136:139], v[184:187]
  v_mfma_f32_16x16x32_bf16 v[188:191], v[152:155], a[136:139], v[188:191]
  v_mfma_f32_16x16x32_bf16 v[184:187], v[132:135], a[140:143], v[184:187]
  v_mfma_f32_16x16x32_bf16 v[188:191], v[156:159], a[140:143], v[188:191]
  v_mfma_f32_16x16x32_bf16 v[160:163], v[112:115], a[144:147], 0
  v_mfma_f32_16x16x32_bf16 v[164:167], v[136:139], a[144:147], 0
  v_mfma_f32_16x16x32_bf16 v[160:163], v[116:119], a[148:151], v[160:163]
  v_cvt_pk_bf16_f32 v204, v184, v185
  v_cvt_pk_bf16_f32 v205, v186, v187
  v_mfma_f32_16x16x32_bf16 v[164:167], v[140:143], a[148:151], v[164:167]
  v_cvt_pk_bf16_f32 v206, v188, v189
  v_cvt_pk_bf16_f32 v207, v190, v191
  v_mfma_f32_16x16x32_bf16 v[160:163], v[120:123], a[152:155], v[160:163]
  buffer_store_dwordx4 v[204:207], v4, s[16:19], s57 offen offset:0 sc1
  v_mfma_f32_16x16x32_bf16 v[164:167], v[144:147], a[152:155], v[164:167]
  v_mfma_f32_16x16x32_bf16 v[160:163], v[124:127], a[156:159], v[160:163]
  v_mfma_f32_16x16x32_bf16 v[164:167], v[148:151], a[156:159], v[164:167]
  v_mfma_f32_16x16x32_bf16 v[160:163], v[128:131], a[160:163], v[160:163]
  v_mfma_f32_16x16x32_bf16 v[164:167], v[152:155], a[160:163], v[164:167]
  v_mfma_f32_16x16x32_bf16 v[160:163], v[132:135], a[164:167], v[160:163]
  v_mfma_f32_16x16x32_bf16 v[164:167], v[156:159], a[164:167], v[164:167]
  v_mfma_f32_16x16x32_bf16 v[168:171], v[112:115], a[168:171], 0
  v_mfma_f32_16x16x32_bf16 v[172:175], v[136:139], a[168:171], 0
  v_mfma_f32_16x16x32_bf16 v[168:171], v[116:119], a[172:175], v[168:171]
  v_cvt_pk_bf16_f32 v192, v160, v161
  v_cvt_pk_bf16_f32 v193, v162, v163
  v_mfma_f32_16x16x32_bf16 v[172:175], v[140:143], a[172:175], v[172:175]
  v_cvt_pk_bf16_f32 v194, v164, v165
  v_cvt_pk_bf16_f32 v195, v166, v167
  v_mfma_f32_16x16x32_bf16 v[168:171], v[120:123], a[176:179], v[168:171]
  buffer_store_dwordx4 v[192:195], v4, s[16:19], s57 offen offset:1024 sc1
  v_mfma_f32_16x16x32_bf16 v[172:175], v[144:147], a[176:179], v[172:175]
  v_mfma_f32_16x16x32_bf16 v[168:171], v[124:127], a[180:183], v[168:171]
  v_mfma_f32_16x16x32_bf16 v[172:175], v[148:151], a[180:183], v[172:175]
  v_mfma_f32_16x16x32_bf16 v[168:171], v[128:131], a[184:187], v[168:171]
  v_mfma_f32_16x16x32_bf16 v[172:175], v[152:155], a[184:187], v[172:175]
  v_mfma_f32_16x16x32_bf16 v[168:171], v[132:135], a[188:191], v[168:171]
  v_mfma_f32_16x16x32_bf16 v[172:175], v[156:159], a[188:191], v[172:175]
  v_mfma_f32_16x16x32_bf16 v[176:179], v[112:115], a[192:195], 0
  s_min_u32 s21, s45, 52
  v_mov_b32 v16, s21
  s_waitcnt vmcnt(11)
  v_mfma_f32_16x16x32_bf16 v[180:183], v[136:139], a[192:195], 0
  buffer_store_dword v16, v17, s[72:75], s44 offen sc1
  v_mfma_f32_16x16x32_bf16 v[176:179], v[116:119], a[196:199], v[176:179]
  v_cvt_pk_bf16_f32 v196, v168, v169
  v_cvt_pk_bf16_f32 v197, v170, v171
  v_mfma_f32_16x16x32_bf16 v[180:183], v[140:143], a[196:199], v[180:183]
  v_cvt_pk_bf16_f32 v198, v172, v173
  v_cvt_pk_bf16_f32 v199, v174, v175
  v_mfma_f32_16x16x32_bf16 v[176:179], v[120:123], a[200:203], v[176:179]
  buffer_store_dwordx4 v[196:199], v4, s[16:19], s58 offen offset:1024 sc1
  v_mfma_f32_16x16x32_bf16 v[180:183], v[144:147], a[200:203], v[180:183]
  v_mfma_f32_16x16x32_bf16 v[176:179], v[124:127], a[204:207], v[176:179]
  s_add_u32 s56, s56, 2097152
  s_xor_b32 s56, s56, 8192
  s_add_u32 s59, s58, 524288
  v_mfma_f32_16x16x32_bf16 v[180:183], v[148:151], a[204:207], v[180:183]
  s_xor_b32 s58, s58, s59
  s_lshr_b32 s58, s58, 8
  s_and_b32 s58, s58, 8192
  v_mfma_f32_16x16x32_bf16 v[176:179], v[128:131], a[208:211], v[176:179]
  s_xor_b32 s58, s58, s59
  v_mfma_f32_16x16x32_bf16 v[180:183], v[152:155], a[208:211], v[180:183]
  v_mfma_f32_16x16x32_bf16 v[176:179], v[132:135], a[212:215], v[176:179]
  v_mfma_f32_16x16x32_bf16 v[180:183], v[156:159], a[212:215], v[180:183]
  v_mfma_f32_16x16x32_bf16 v[184:187], v[112:115], a[216:219], 0
  v_mfma_f32_16x16x32_bf16 v[188:191], v[136:139], a[216:219], 0
  v_mfma_f32_16x16x32_bf16 v[184:187], v[116:119], a[220:223], v[184:187]
  v_cvt_pk_bf16_f32 v200, v176, v177
  v_cvt_pk_bf16_f32 v201, v178, v179
  v_mfma_f32_16x16x32_bf16 v[188:191], v[140:143], a[220:223], v[188:191]
  v_cvt_pk_bf16_f32 v202, v180, v181
  v_cvt_pk_bf16_f32 v203, v182, v183
  v_mfma_f32_16x16x32_bf16 v[184:187], v[120:123], a[224:227], v[184:187]
  buffer_store_dwordx4 v[200:203], v4, s[16:19], s57 offen offset:2048 sc1
  v_mfma_f32_16x16x32_bf16 v[188:191], v[144:147], a[224:227], v[188:191]
  v_mfma_f32_16x16x32_bf16 v[184:187], v[124:127], a[228:231], v[184:187]
  s_mov_b32 s51, s57
  s_add_u32 s57, s56, 4096
  s_add_u32 s45, s45, 1
  v_mfma_f32_16x16x32_bf16 v[188:191], v[148:151], a[228:231], v[188:191]
  v_mfma_f32_16x16x32_bf16 v[184:187], v[128:131], a[232:235], v[184:187]
  v_mfma_f32_16x16x32_bf16 v[188:191], v[152:155], a[232:235], v[188:191]
  v_mfma_f32_16x16x32_bf16 v[184:187], v[132:135], a[236:239], v[184:187]
  s_cmp_lt_u32 s45, s46
  v_mfma_f32_16x16x32_bf16 v[188:191], v[156:159], a[236:239], v[188:191]
  s_waitcnt lgkmcnt(0)
  s_cbranch_scc1 vwl_214
  s_nop 7
  v_cvt_pk_bf16_f32 v204, v184, v185
  v_cvt_pk_bf16_f32 v205, v186, v187
  v_cvt_pk_bf16_f32 v206, v188, v189
  v_cvt_pk_bf16_f32 v207, v190, v191
  buffer_store_dwordx4 v[204:207], v4, s[16:19], s51 offen offset:3072 sc1
  s_min_u32 s21, s45, 52
  v_mov_b32 v16, s21
  s_barrier
  s_mov_b32 s46, s42
  s_cmp_gt_u32 s42, s45
  s_cbranch_scc1 vwr_213
  s_cmp_lt_u32 s45, 64
  s_cbranch_scc1 vwr_208
  v_mov_b32 v244, -1
  v_mov_b32 v245, -1
  v_mov_b32 v246, -1
  v_mov_b32 v247, -1
  v_lshlrev_b32 v21, 3, v1
  s_lshr_b32 s21, s2, 2
  s_lshl_b32 s21, s21, 2
  s_add_u32 s21, s21, s20
  s_lshl_b32 s21, s21, 2
  s_and_b32 s22, s2, 3
  s_add_u32 s21, s21, s22
  s_lshl_b32 s21, s21, 14
  s_xor_b32 s22, s21, s80
  s_xor_b32 s21, s22, 117444608
  buffer_store_dwordx4 v[244:247], v4, s[16:19], s21 offen offset:0 sc1
  buffer_store_dwordx4 v[244:247], v4, s[16:19], s21 offen offset:1024 sc1
  buffer_store_dwordx4 v[244:247], v4, s[16:19], s21 offen offset:2048 sc1
  buffer_store_dwordx4 v[244:247], v4, s[16:19], s21 offen offset:3072 sc1
  s_xor_b32 s21, s22, 119549952
  buffer_store_dwordx4 v[244:247], v4, s[16:19], s21 offen offset:0 sc1
  buffer_store_dwordx4 v[244:247], v4, s[16:19], s21 offen offset:1024 sc1
  buffer_store_dwordx4 v[244:247], v4, s[16:19], s21 offen offset:2048 sc1
  buffer_store_dwordx4 v[244:247], v4, s[16:19], s21 offen offset:3072 sc1
  s_xor_b32 s21, s22, 121638912
  buffer_store_dwordx4 v[244:247], v4, s[16:19], s21 offen offset:0 sc1
  buffer_store_dwordx4 v[244:247], v4, s[16:19], s21 offen offset:1024 sc1
  buffer_store_dwordx4 v[244:247], v4, s[16:19], s21 offen offset:2048 sc1
  buffer_store_dwordx4 v[244:247], v4, s[16:19], s21 offen offset:3072 sc1
  s_xor_b32 s21, s22, 123744256
  buffer_store_dwordx4 v[244:247], v4, s[16:19], s21 offen offset:0 sc1
  buffer_store_dwordx4 v[244:247], v4, s[16:19], s21 offen offset:1024 sc1
  buffer_store_dwordx4 v[244:247], v4, s[16:19], s21 offen offset:2048 sc1
  buffer_store_dwordx4 v[244:247], v4, s[16:19], s21 offen offset:3072 sc1
  s_xor_b32 s21, s22, 125833216
  buffer_store_dwordx4 v[244:247], v4, s[16:19], s21 offen offset:0 sc1
  buffer_store_dwordx4 v[244:247], v4, s[16:19], s21 offen offset:1024 sc1
  buffer_store_dwordx4 v[244:247], v4, s[16:19], s21 offen offset:2048 sc1
  buffer_store_dwordx4 v[244:247], v4, s[16:19], s21 offen offset:3072 sc1
  s_xor_b32 s21, s22, 127938560
  buffer_store_dwordx4 v[244:247], v4, s[16:19], s21 offen offset:0 sc1
  buffer_store_dwordx4 v[244:247], v4, s[16:19], s21 offen offset:1024 sc1
  buffer_store_dwordx4 v[244:247], v4, s[16:19], s21 offen offset:2048 sc1
  buffer_store_dwordx4 v[244:247], v4, s[16:19], s21 offen offset:3072 sc1
  s_xor_b32 s21, s22, 130027520
  buffer_store_dwordx4 v[244:247], v4, s[16:19], s21 offen offset:0 sc1
  buffer_store_dwordx4 v[244:247], v4, s[16:19], s21 offen offset:1024 sc1
  buffer_store_dwordx4 v[244:247], v4, s[16:19], s21 offen offset:2048 sc1
  buffer_store_dwordx4 v[244:247], v4, s[16:19], s21 offen offset:3072 sc1
  s_xor_b32 s21, s22, 132132864
  buffer_store_dwordx4 v[244:247], v4, s[16:19], s21 offen offset:0 sc1
  buffer_store_dwordx4 v[244:247], v4, s[16:19], s21 offen offset:1024 sc1
  buffer_store_dwordx4 v[244:247], v4, s[16:19], s21 offen offset:2048 sc1
  buffer_store_dwordx4 v[244:247], v4, s[16:19], s21 offen offset:3072 sc1
  s_and_b32 s21, s2, 3
  s_cmp_lg_u32 s21, s20
  s_cbranch_scc1 arm_215
  s_lshr_b32 s21, s2, 1
  s_lshl_b32 s21, s21, 14
  s_and_b32 s22, s2, 1
  s_mul_i32 s22, s22, 2560
  s_add_u32 s21, s21, s22
  s_xor_b32 s22, s21, s80
  s_xor_b32 s21, s22, 163586048
  buffer_store_dwordx4 v[244:247], v4, s[16:19], s21 offen sc1
  buffer_store_dwordx4 v[244:247], v4, s[16:19], s21 offen offset:1024 sc1
  buffer_store_dwordx2 v[244:245], v21, s[16:19], s21 offen offset:2048 sc1
  s_xor_b32 s21, s22, 164110336
  buffer_store_dwordx4 v[244:247], v4, s[16:19], s21 offen sc1
  buffer_store_dwordx4 v[244:247], v4, s[16:19], s21 offen offset:1024 sc1
  buffer_store_dwordx2 v[244:245], v21, s[16:19], s21 offen offset:2048 sc1
  s_xor_b32 s21, s22, 164634624
  buffer_store_dwordx4 v[244:247], v4, s[16:19], s21 offen sc1
  buffer_store_dwordx4 v[244:247], v4, s[16:19], s21 offen offset:1024 sc1
  buffer_store_dwordx2 v[244:245], v21, s[16:19], s21 offen offset:2048 sc1
  s_xor_b32 s21, s22, 165158912
  buffer_store_dwordx4 v[244:247], v4, s[16:19], s21 offen sc1
  buffer_store_dwordx4 v[244:247], v4, s[16:19], s21 offen offset:1024 sc1
  buffer_store_dwordx2 v[244:245], v21, s[16:19], s21 offen offset:2048 sc1
  s_xor_b32 s21, s22, 165675008
  buffer_store_dwordx4 v[244:247], v4, s[16:19], s21 offen sc1
  buffer_store_dwordx4 v[244:247], v4, s[16:19], s21 offen offset:1024 sc1
  buffer_store_dwordx2 v[244:245], v21, s[16:19], s21 offen offset:2048 sc1
  s_xor_b32 s21, s22, 166199296
  buffer_store_dwordx4 v[244:247], v4, s[16:19], s21 offen sc1
  buffer_store_dwordx4 v[244:247], v4, s[16:19], s21 offen offset:1024 sc1
  buffer_store_dwordx2 v[244:245], v21, s[16:19], s21 offen offset:2048 sc1
  s_xor_b32 s21, s22, 166723584
  buffer_store_dwordx4 v[244:247], v4, s[16:19], s21 offen sc1
  buffer_store_dwordx4 v[244:247], v4, s[16:19], s21 offen offset:1024 sc1
  buffer_store_dwordx2 v[244:245], v21, s[16:19], s21 offen offset:2048 sc1
  s_xor_b32 s21, s22, 167247872
  buffer_store_dwordx4 v[244:247], v4, s[16:19], s21 offen sc1
  buffer_store_dwordx4 v[244:247], v4, s[16:19], s21 offen offset:1024 sc1
  buffer_store_dwordx2 v[244:245], v21, s[16:19], s21 offen offset:2048 sc1
arm_215:
  v_mov_b32 v16, 64
  s_waitcnt vmcnt(0)
  buffer_store_dword v16, v17, s[72:75], s44 offen sc1
  s_branch queue
not_vw:
  s_sub_u32 s2, s3, 96
  s_cmp_lg_u32 s2, 31
  s_cbranch_scc1 not_cal
  s_load_dwordx2 s[72:73], s[0:1], 104
  s_waitcnt lgkmcnt(0)
  s_add_u32 s72, s72, 168886272
  s_addc_u32 s73, s73, 0
  s_mov_b32 s74, 49152
  s_mov_b32 s75, 0x00020000
  v_lshlrev_b32 v8, 4, v0
  v_mov_b32 v4, 0
  v_mov_b32 v5, 0
  v_mov_b32 v6, 0
  v_mov_b32 v7, 0
  s_mov_b32 s21, 0
  buffer_store_dwordx4 v[4:7], v8, s[72:75], s21 offen sc1
  s_mov_b32 s21, 4096
  buffer_store_dwordx4 v[4:7], v8, s[72:75], s21 offen sc1
  s_mov_b32 s21, 8192
  buffer_store_dwordx4 v[4:7], v8, s[72:75], s21 offen sc1
  s_mov_b32 s21, 12288
  buffer_store_dwordx4 v[4:7], v8, s[72:75], s21 offen sc1
  s_mov_b32 s21, 16384
  buffer_store_dwordx4 v[4:7], v8, s[72:75], s21 offen sc1
  s_mov_b32 s21, 20480
  buffer_store_dwordx4 v[4:7], v8, s[72:75], s21 offen sc1
  s_mov_b32 s21, 24576
  buffer_store_dwordx4 v[4:7], v8, s[72:75], s21 offen sc1
  s_mov_b32 s21, 28672
  buffer_store_dwordx4 v[4:7], v8, s[72:75], s21 offen sc1
  s_mov_b32 s21, 32768
  buffer_store_dwordx4 v[4:7], v8, s[72:75], s21 offen sc1
  s_mov_b32 s21, 36864
  buffer_store_dwordx4 v[4:7], v8, s[72:75], s21 offen sc1
  s_mov_b32 s21, 40960
  buffer_store_dwordx4 v[4:7], v8, s[72:75], s21 offen sc1
  s_mov_b32 s21, 45056
  buffer_store_dwordx4 v[4:7], v8, s[72:75], s21 offen sc1
  s_add_u32 s8, s38, 168820736
  s_addc_u32 s9, s39, 0
  s_mov_b32 s10, 131072
  s_mov_b32 s11, 0x00020000
  s_cmp_lg_u32 s20, 0
  s_cbranch_scc1 cal_216
  s_mov_b32 s40, -1
  s_mov_b32 s41, -1
  s_mov_b32 s43, 0
cal_217:
  s_mov_b32 s21, 0
  s_memtime s[98:99]
  s_waitcnt lgkmcnt(0)
  s_buffer_load_dword s22, s[8:11], s21 glc
  s_waitcnt lgkmcnt(0)
  s_memtime s[100:101]
  s_waitcnt lgkmcnt(0)
  s_sub_u32 s21, s100, s98
  s_min_u32 s40, s40, s21
  s_mov_b32 s21, 8192
  s_memtime s[98:99]
  s_waitcnt lgkmcnt(0)
  s_buffer_load_dword s22, s[8:11], s21 glc
  s_waitcnt lgkmcnt(0)
  s_memtime s[100:101]
  s_waitcnt lgkmcnt(0)
  s_sub_u32 s21, s100, s98
  s_min_u32 s41, s41, s21
  s_add_u32 s43, s43, 1
  s_cmp_lt_u32 s43, 6
  s_cbranch_scc1 cal_217
cal_216:
  s_waitcnt vmcnt(0)
  s_barrier
  s_cmp_lg_u32 s20, 0
  s_cbranch_scc1 cal_218
  s_cmp_lt_u32 s41, s40
  s_cselect_b32 s21, 1, 2
  v_mov_b32 v4, s21
  v_mov_b32 v5, s40
  v_mov_b32 v6, s41
  v_mov_b32 v8, 76
  s_mov_b64 exec, 1
  buffer_store_dwordx3 v[4:6], v8, s[32:35], 0 offen sc1
  s_mov_b64 exec, -1
cal_218:
not_cal:
  s_load_dwordx2 s[4:5], s[0:1], 0
  s_load_dwordx2 s[6:7], s[0:1], 64
  s_load_dwordx2 s[38:39], s[0:1], 104
  s_lshr_b32 s41, s2, 3
  s_lshl_b32 s41, s41, 1
  s_and_b32 s21, s2, 1
  s_add_u32 s41, s41, s21
  s_bfe_u32 s42, s2, 0x20001
  s_waitcnt lgkmcnt(0)
  s_mov_b32 s8, s4
  s_mov_b32 s9, s5
  s_mov_b32 s10, 2621440
  s_mov_b32 s11, 0x00020000
  s_mov_b32 s12, s6
  s_mov_b32 s13, s7
  s_mov_b32 s14, 2457600
  s_mov_b32 s15, 0x00020000
  s_mov_b32 s16, s38
  s_mov_b32 s17, s39
  s_mov_b32 s18, 167772160
  s_mov_b32 s19, 0x00020000
  s_add_u32 s72, s38, 168886272
  s_addc_u32 s73, s39, 0
  s_mov_b32 s74, 49152
  s_mov_b32 s75, 0x00020000
  v_lshrrev_b32 v8, 5, v1
  v_or_b32 v9, 0, v8
  v_and_b32 v10, 31, v1
  v_lshlrev_b32 v9, 1, v9
  v_xor_b32 v10, v10, v9
  v_mul_u32_u24 v9, 6554, v10
  v_lshrrev_b32 v9, 16, v9
  v_mul_u32_u24 v11, 1120, v9
  v_lshl_add_u32 v11, v10, 4, v11
  v_mul_u32_u24 v8, 3840, v8
  v_add_u32 v11, v11, v8
  v_mov_b32 v9, 1073741824
  v_cmp_gt_u32 vcc, 30, v10
  s_nop 1
  v_cndmask_b32 v4, v9, v11, vcc
  v_lshrrev_b32 v8, 5, v1
  v_or_b32 v9, 2, v8
  v_and_b32 v10, 31, v1
  v_lshlrev_b32 v9, 1, v9
  v_xor_b32 v10, v10, v9
  v_mul_u32_u24 v9, 6554, v10
  v_lshrrev_b32 v9, 16, v9
  v_mul_u32_u24 v11, 1120, v9
  v_lshl_add_u32 v11, v10, 4, v11
  v_mul_u32_u24 v8, 3840, v8
  v_add_u32 v11, v11, v8
  v_mov_b32 v9, 1073741824
  v_cmp_gt_u32 vcc, 30, v10
  s_nop 1
  v_cndmask_b32 v5, v9, v11, vcc
  v_lshrrev_b32 v8, 5, v1
  v_or_b32 v9, 4, v8
  v_and_b32 v10, 31, v1
  v_lshlrev_b32 v9, 1, v9
  v_xor_b32 v10, v10, v9
  v_mul_u32_u24 v9, 6554, v10
  v_lshrrev_b32 v9, 16, v9
  v_mul_u32_u24 v11, 1120, v9
  v_lshl_add_u32 v11, v10, 4, v11
  v_mul_u32_u24 v8, 3840, v8
  v_add_u32 v11, v11, v8
  v_mov_b32 v9, 1073741824
  v_cmp_gt_u32 vcc, 30, v10
  s_nop 1
  v_cndmask_b32 v6, v9, v11, vcc
  v_lshrrev_b32 v8, 5, v1
  v_or_b32 v9, 6, v8
  v_and_b32 v10, 31, v1
  v_lshlrev_b32 v9, 1, v9
  v_xor_b32 v10, v10, v9
  v_mul_u32_u24 v9, 6554, v10
  v_lshrrev_b32 v9, 16, v9
  v_mul_u32_u24 v11, 1120, v9
  v_lshl_add_u32 v11, v10, 4, v11
  v_mul_u32_u24 v8, 3840, v8
  v_add_u32 v11, v11, v8
  v_mov_b32 v9, 1073741824
  v_cmp_gt_u32 vcc, 30, v10
  s_nop 1
  v_cndmask_b32 v7, v9, v11, vcc
  s_mul_i32 s44, s41, 160
  s_mul_i32 s21, s20, 122880
  s_add_u32 s44, s44, s21
  s_lshl_b32 s45, s20, 14
  s_add_u32 s21, s44, 0
  s_add_u32 m0, s45, 0
  s_nop 0
  buffer_load_dwordx4 v4, s[12:15], s21 offen lds
  s_add_u32 s21, s44, 7680
  s_add_u32 m0, s45, 1024
  s_nop 0
  buffer_load_dwordx4 v5, s[12:15], s21 offen lds
  s_add_u32 s21, s44, 15360
  s_add_u32 m0, s45, 2048
  s_nop 0
  buffer_load_dwordx4 v4, s[12:15], s21 offen lds
  s_add_u32 s21, s44, 23040
  s_add_u32 m0, s45, 3072
  s_nop 0
  buffer_load_dwordx4 v5, s[12:15], s21 offen lds
  s_add_u32 s21, s44, 30720
  s_add_u32 m0, s45, 4096
  s_nop 0
  buffer_load_dwordx4 v6, s[12:15], s21 offen lds
  s_add_u32 s21, s44, 38400
  s_add_u32 m0, s45, 5120
  s_nop 0
  buffer_load_dwordx4 v7, s[12:15], s21 offen lds
  s_add_u32 s21, s44, 46080
  s_add_u32 m0, s45, 6144
  s_nop 0
  buffer_load_dwordx4 v6, s[12:15], s21 offen lds
  s_add_u32 s21, s44, 53760
  s_add_u32 m0, s45, 7168
  s_nop 0
  buffer_load_dwordx4 v7, s[12:15], s21 offen lds
  s_add_u32 s21, s44, 61440
  s_add_u32 m0, s45, 8192
  s_nop 0
  buffer_load_dwordx4 v4, s[12:15], s21 offen lds
  s_add_u32 s21, s44, 69120
  s_add_u32 m0, s45, 9216
  s_nop 0
  buffer_load_dwordx4 v5, s[12:15], s21 offen lds
  s_add_u32 s21, s44, 76800
  s_add_u32 m0, s45, 10240
  s_nop 0
  buffer_load_dwordx4 v4, s[12:15], s21 offen lds
  s_add_u32 s21, s44, 84480
  s_add_u32 m0, s45, 11264
  s_nop 0
  buffer_load_dwordx4 v5, s[12:15], s21 offen lds
  s_add_u32 s21, s44, 92160
  s_add_u32 m0, s45, 12288
  s_nop 0
  buffer_load_dwordx4 v6, s[12:15], s21 offen lds
  s_add_u32 s21, s44, 99840
  s_add_u32 m0, s45, 13312
  s_nop 0
  buffer_load_dwordx4 v7, s[12:15], s21 offen lds
  s_add_u32 s21, s44, 107520
  s_add_u32 m0, s45, 14336
  s_nop 0
  buffer_load_dwordx4 v6, s[12:15], s21 offen lds
  s_add_u32 s21, s44, 115200
  s_add_u32 m0, s45, 15360
  s_nop 0
  buffer_load_dwordx4 v7, s[12:15], s21 offen lds
  s_add_u32 s21, s44, 491520
  s_add_u32 m0, s45, 65536
  s_nop 0
  buffer_load_dwordx4 v4, s[12:15], s21 offen lds
  s_add_u32 s21, s44, 499200
  s_add_u32 m0, s45, 66560
  s_nop 0
  buffer_load_dwordx4 v5, s[12:15], s21 offen lds
  s_add_u32 s21, s44, 506880
  s_add_u32 m0, s45, 67584
  s_nop 0
  buffer_load_dwordx4 v4, s[12:15], s21 offen lds
  s_add_u32 s21, s44, 514560
  s_add_u32 m0, s45, 68608
  s_nop 0
  buffer_load_dwordx4 v5, s[12:15], s21 offen lds
  s_add_u32 s21, s44, 522240
  s_add_u32 m0, s45, 69632
  s_nop 0
  buffer_load_dwordx4 v6, s[12:15], s21 offen lds
  s_add_u32 s21, s44, 529920
  s_add_u32 m0, s45, 70656
  s_nop 0
  buffer_load_dwordx4 v7, s[12:15], s21 offen lds
  s_add_u32 s21, s44, 537600
  s_add_u32 m0, s45, 71680
  s_nop 0
  buffer_load_dwordx4 v6, s[12:15], s21 offen lds
  s_add_u32 s21, s44, 545280
  s_add_u32 m0, s45, 72704
  s_nop 0
  buffer_load_dwordx4 v7, s[12:15], s21 offen lds
  s_add_u32 s21, s44, 552960
  s_add_u32 m0, s45, 73728
  s_nop 0
  buffer_load_dwordx4 v4, s[12:15], s21 offen lds
  s_add_u32 s21, s44, 560640
  s_add_u32 m0, s45, 74752
  s_nop 0
  buffer_load_dwordx4 v5, s[12:15], s21 offen lds
  s_add_u32 s21, s44, 568320
  s_add_u32 m0, s45, 75776
  s_nop 0
  buffer_load_dwordx4 v4, s[12:15], s21 offen lds
  s_add_u32 s21, s44, 576000
  s_add_u32 m0, s45, 76800
  s_nop 0
  buffer_load_dwordx4 v5, s[12:15], s21 offen lds
  s_add_u32 s21, s44, 583680
  s_add_u32 m0, s45, 77824
  s_nop 0
  buffer_load_dwordx4 v6, s[12:15], s21 offen lds
  s_add_u32 s21, s44, 591360
  s_add_u32 m0, s45, 78848
  s_nop 0
  buffer_load_dwordx4 v7, s[12:15], s21 offen lds
  s_add_u32 s21, s44, 599040
  s_add_u32 m0, s45, 79872
  s_nop 0
  buffer_load_dwordx4 v6, s[12:15], s21 offen lds
  s_add_u32 s21, s44, 606720
  s_add_u32 m0, s45, 80896
  s_nop 0
  buffer_load_dwordx4 v7, s[12:15], s21 offen lds
  s_add_u32 s21, s44, 983040
  buffer_load_dwordx4 v[64:67], v4, s[12:15], s21 offen
  s_add_u32 s21, s44, 990720
  buffer_load_dwordx4 v[68:71], v5, s[12:15], s21 offen
  s_add_u32 s21, s44, 998400
  buffer_load_dwordx4 v[72:75], v4, s[12:15], s21 offen
  s_add_u32 s21, s44, 1006080
  buffer_load_dwordx4 v[76:79], v5, s[12:15], s21 offen
  s_add_u32 s21, s44, 1013760
  buffer_load_dwordx4 v[80:83], v6, s[12:15], s21 offen
  s_add_u32 s21, s44, 1021440
  buffer_load_dwordx4 v[84:87], v7, s[12:15], s21 offen
  s_add_u32 s21, s44, 1029120
  buffer_load_dwordx4 v[88:91], v6, s[12:15], s21 offen
  s_add_u32 s21, s44, 1036800
  buffer_load_dwordx4 v[92:95], v7, s[12:15], s21 offen
  s_add_u32 s21, s44, 1044480
  buffer_load_dwordx4 v[96:99], v4, s[12:15], s21 offen
  s_add_u32 s21, s44, 1052160
  buffer_load_dwordx4 v[100:103], v5, s[12:15], s21 offen
  s_add_u32 s21, s44, 1059840
  buffer_load_dwordx4 v[104:107], v4, s[12:15], s21 offen
  s_add_u32 s21, s44, 1067520
  buffer_load_dwordx4 v[108:111], v5, s[12:15], s21 offen
  s_add_u32 s21, s44, 1075200
  buffer_load_dwordx4 v[112:115], v6, s[12:15], s21 offen
  s_add_u32 s21, s44, 1082880
  buffer_load_dwordx4 v[116:119], v7, s[12:15], s21 offen
  s_add_u32 s21, s44, 1090560
  buffer_load_dwordx4 v[120:123], v6, s[12:15], s21 offen
  s_add_u32 s21, s44, 1098240
  buffer_load_dwordx4 v[124:127], v7, s[12:15], s21 offen
  v_lshrrev_b32 v8, 2, v2
  v_and_b32 v9, 1, v3
  v_lshl_add_u32 v9, v9, 2, v8
  v_lshlrev_b32 v9, 5, v9
  v_lshl_add_u32 v8, v3, 3, v8
  v_lshlrev_b32 v8, 9, v8
  v_and_b32 v10, 3, v2
  s_mul_i32 s21, s20, 40
  v_lshl_add_u32 v11, v10, 3, s21
  v_add_u32 v11, 0, v11
  v_xor_b32 v11, v11, v9
  v_add_u32 v12, v11, v8
  v_add_u32 v16, 65536, v12
  v_lshl_add_u32 v11, v10, 3, s21
  v_add_u32 v11, 160, v11
  v_xor_b32 v11, v11, v9
  v_add_u32 v13, v11, v8
  v_add_u32 v17, 65536, v13
  v_mul_u32_u24 v11, 160, v10
  v_add3_u32 v11, v11, 32, s21
  v_min_u32 v11, 480, v11
  v_xor_b32 v11, v11, v9
  v_add_u32 v14, v11, v8
  v_add_u32 v18, 65536, v14
  v_lshl_add_u32 v11, v10, 3, s21
  v_add_u32 v11, 320, v11
  v_xor_b32 v11, v11, v9
  v_add_u32 v15, v11, v8
  v_add_u32 v19, 65536, v15
  v_lshl_add_u32 v23, v1, 4, s45
  v_add_u32 v29, 65536, v23
  s_waitcnt vmcnt(32)
  s_add_u32 s21, s44, 1474560
  buffer_load_dwordx4 v[128:131], v4, s[12:15], s21 offen
  s_add_u32 s21, s44, 1482240
  buffer_load_dwordx4 v[132:135], v5, s[12:15], s21 offen
  s_add_u32 s21, s44, 1489920
  buffer_load_dwordx4 v[136:139], v4, s[12:15], s21 offen
  s_add_u32 s21, s44, 1497600
  buffer_load_dwordx4 v[140:143], v5, s[12:15], s21 offen
  s_add_u32 s21, s44, 1505280
  buffer_load_dwordx4 v[144:147], v6, s[12:15], s21 offen
  s_add_u32 s21, s44, 1512960
  buffer_load_dwordx4 v[148:151], v7, s[12:15], s21 offen
  s_add_u32 s21, s44, 1520640
  buffer_load_dwordx4 v[152:155], v6, s[12:15], s21 offen
  s_add_u32 s21, s44, 1528320
  buffer_load_dwordx4 v[156:159], v7, s[12:15], s21 offen
  s_add_u32 s21, s44, 1536000
  buffer_load_dwordx4 v[160:163], v4, s[12:15], s21 offen
  s_add_u32 s21, s44, 1543680
  buffer_load_dwordx4 v[164:167], v5, s[12:15], s21 offen
  s_add_u32 s21, s44, 1551360
  buffer_load_dwordx4 v[168:171], v4, s[12:15], s21 offen
  s_add_u32 s21, s44, 1559040
  buffer_load_dwordx4 v[172:175], v5, s[12:15], s21 offen
  s_add_u32 s21, s44, 1566720
  buffer_load_dwordx4 v[176:179], v6, s[12:15], s21 offen
  s_add_u32 s21, s44, 1574400
  buffer_load_dwordx4 v[180:183], v7, s[12:15], s21 offen
  s_add_u32 s21, s44, 1582080
  buffer_load_dwordx4 v[184:187], v6, s[12:15], s21 offen
  s_add_u32 s21, s44, 1589760
  buffer_load_dwordx4 v[188:191], v7, s[12:15], s21 offen
  s_barrier
  ds_read_b64_tr_b16 a[0:1], v12 offset:0
  ds_read_b64_tr_b16 a[2:3], v12 offset:2048
  ds_read_b64_tr_b16 a[4:5], v13 offset:0
  ds_read_b64_tr_b16 a[6:7], v13 offset:2048
  ds_read_b64_tr_b16 a[8:9], v14 offset:0
  ds_read_b64_tr_b16 a[10:11], v14 offset:2048
  ds_read_b64_tr_b16 a[12:13], v15 offset:0
  ds_read_b64_tr_b16 a[14:15], v15 offset:2048
  ds_read_b64_tr_b16 a[16:17], v12 offset:16384
  ds_read_b64_tr_b16 a[18:19], v12 offset:18432
  ds_read_b64_tr_b16 a[20:21], v13 offset:16384
  ds_read_b64_tr_b16 a[22:23], v13 offset:18432
  ds_read_b64_tr_b16 a[24:25], v14 offset:16384
  ds_read_b64_tr_b16 a[26:27], v14 offset:18432
  ds_read_b64_tr_b16 a[28:29], v15 offset:16384
  ds_read_b64_tr_b16 a[30:31], v15 offset:18432
  ds_read_b64_tr_b16 a[32:33], v12 offset:32768
  ds_read_b64_tr_b16 a[34:35], v12 offset:34816
  ds_read_b64_tr_b16 a[36:37], v13 offset:32768
  ds_read_b64_tr_b16 a[38:39], v13 offset:34816
  ds_read_b64_tr_b16 a[40:41], v14 offset:32768
  ds_read_b64_tr_b16 a[42:43], v14 offset:34816
  ds_read_b64_tr_b16 a[44:45], v15 offset:32768
  ds_read_b64_tr_b16 a[46:47], v15 offset:34816
  ds_read_b64_tr_b16 a[48:49], v12 offset:49152
  ds_read_b64_tr_b16 a[50:51], v12 offset:51200
  ds_read_b64_tr_b16 a[52:53], v13 offset:49152
  ds_read_b64_tr_b16 a[54:55], v13 offset:51200
  ds_read_b64_tr_b16 a[56:57], v14 offset:49152
  ds_read_b64_tr_b16 a[58:59], v14 offset:51200
  ds_read_b64_tr_b16 a[60:61], v15 offset:49152
  ds_read_b64_tr_b16 a[62:63], v15 offset:51200
  s_waitcnt lgkmcnt(0)
  s_barrier
  s_waitcnt vmcnt(32)
  s_add_u32 s21, s44, 1966080
  buffer_load_dwordx4 v[192:195], v4, s[12:15], s21 offen
  s_add_u32 s21, s44, 1973760
  buffer_load_dwordx4 v[196:199], v5, s[12:15], s21 offen
  s_add_u32 s21, s44, 1981440
  buffer_load_dwordx4 v[200:203], v4, s[12:15], s21 offen
  s_add_u32 s21, s44, 1989120
  buffer_load_dwordx4 v[204:207], v5, s[12:15], s21 offen
  s_add_u32 s21, s44, 1996800
  buffer_load_dwordx4 v[208:211], v6, s[12:15], s21 offen
  s_add_u32 s21, s44, 2004480
  buffer_load_dwordx4 v[212:215], v7, s[12:15], s21 offen
  s_add_u32 s21, s44, 2012160
  buffer_load_dwordx4 v[216:219], v6, s[12:15], s21 offen
  s_add_u32 s21, s44, 2019840
  buffer_load_dwordx4 v[220:223], v7, s[12:15], s21 offen
  s_add_u32 s21, s44, 2027520
  buffer_load_dwordx4 v[224:227], v4, s[12:15], s21 offen
  s_add_u32 s21, s44, 2035200
  buffer_load_dwordx4 v[228:231], v5, s[12:15], s21 offen
  s_add_u32 s21, s44, 2042880
  buffer_load_dwordx4 v[232:235], v4, s[12:15], s21 offen
  s_add_u32 s21, s44, 2050560
  buffer_load_dwordx4 v[236:239], v5, s[12:15], s21 offen
  s_add_u32 s21, s44, 2058240
  buffer_load_dwordx4 v[240:243], v6, s[12:15], s21 offen
  s_add_u32 s21, s44, 2065920
  buffer_load_dwordx4 v[244:247], v7, s[12:15], s21 offen
  s_add_u32 s21, s44, 2073600
  buffer_load_dwordx4 v[248:251], v6, s[12:15], s21 offen
  s_add_u32 s21, s44, 2081280
  buffer_load_dwordx4 v[252:255], v7, s[12:15], s21 offen
  s_barrier
  ds_read_b64_tr_b16 a[64:65], v16 offset:0
  ds_read_b64_tr_b16 a[66:67], v16 offset:2048
  ds_read_b64_tr_b16 a[68:69], v17 offset:0
  ds_read_b64_tr_b16 a[70:71], v17 offset:2048
  ds_read_b64_tr_b16 a[72:73], v18 offset:0
  ds_read_b64_tr_b16 a[74:75], v18 offset:2048
  ds_read_b64_tr_b16 a[76:77], v19 offset:0
  ds_read_b64_tr_b16 a[78:79], v19 offset:2048
  ds_read_b64_tr_b16 a[80:81], v16 offset:16384
  ds_read_b64_tr_b16 a[82:83], v16 offset:18432
  ds_read_b64_tr_b16 a[84:85], v17 offset:16384
  ds_read_b64_tr_b16 a[86:87], v17 offset:18432
  ds_read_b64_tr_b16 a[88:89], v18 offset:16384
  ds_read_b64_tr_b16 a[90:91], v18 offset:18432
  ds_read_b64_tr_b16 a[92:93], v19 offset:16384
  ds_read_b64_tr_b16 a[94:95], v19 offset:18432
  ds_read_b64_tr_b16 a[96:97], v16 offset:32768
  ds_read_b64_tr_b16 a[98:99], v16 offset:34816
  ds_read_b64_tr_b16 a[100:101], v17 offset:32768
  ds_read_b64_tr_b16 a[102:103], v17 offset:34816
  ds_read_b64_tr_b16 a[104:105], v18 offset:32768
  ds_read_b64_tr_b16 a[106:107], v18 offset:34816
  ds_read_b64_tr_b16 a[108:109], v19 offset:32768
  ds_read_b64_tr_b16 a[110:111], v19 offset:34816
  ds_read_b64_tr_b16 a[112:113], v16 offset:49152
  ds_read_b64_tr_b16 a[114:115], v16 offset:51200
  ds_read_b64_tr_b16 a[116:117], v17 offset:49152
  ds_read_b64_tr_b16 a[118:119], v17 offset:51200
  ds_read_b64_tr_b16 a[120:121], v18 offset:49152
  ds_read_b64_tr_b16 a[122:123], v18 offset:51200
  ds_read_b64_tr_b16 a[124:125], v19 offset:49152
  ds_read_b64_tr_b16 a[126:127], v19 offset:51200
  s_waitcnt lgkmcnt(0)
  s_barrier
  s_waitcnt vmcnt(32)
  v_lshlrev_b32 v30, 4, v1
  s_load_dwordx2 s[36:37], s[0:1], 16
  s_lshl_b32 s23, s2, 2
  s_add_u32 s23, s23, s20
  s_mul_i32 s23, s23, 61440
  s_add_u32 s23, s23, 30720
  s_waitcnt lgkmcnt(0)
  s_mov_b32 s24, s36
  s_mov_b32 s25, s37
  s_mov_b32 s26, 7864320
  s_mov_b32 s27, 0x00020000
  buffer_load_dwordx4 v[32:35], v30, s[24:27], s23 offen offset:0
  buffer_load_dwordx4 v[32:35], v30, s[24:27], s23 offen offset:1024
  buffer_load_dwordx4 v[32:35], v30, s[24:27], s23 offen offset:2048
  buffer_load_dwordx4 v[32:35], v30, s[24:27], s23 offen offset:3072
  s_add_u32 s23, s23, 4096
  buffer_load_dwordx4 v[32:35], v30, s[24:27], s23 offen offset:0
  buffer_load_dwordx4 v[32:35], v30, s[24:27], s23 offen offset:1024
  buffer_load_dwordx4 v[32:35], v30, s[24:27], s23 offen offset:2048
  buffer_load_dwordx4 v[32:35], v30, s[24:27], s23 offen offset:3072
  s_add_u32 s23, s23, 4096
  buffer_load_dwordx4 v[32:35], v30, s[24:27], s23 offen offset:0
  buffer_load_dwordx4 v[32:35], v30, s[24:27], s23 offen offset:1024
  buffer_load_dwordx4 v[32:35], v30, s[24:27], s23 offen offset:2048
  buffer_load_dwordx4 v[32:35], v30, s[24:27], s23 offen offset:3072
  s_add_u32 s23, s23, 4096
  buffer_load_dwordx4 v[32:35], v30, s[24:27], s23 offen offset:0
  buffer_load_dwordx4 v[32:35], v30, s[24:27], s23 offen offset:1024
  buffer_load_dwordx4 v[32:35], v30, s[24:27], s23 offen offset:2048
  buffer_load_dwordx4 v[32:35], v30, s[24:27], s23 offen offset:3072
  s_add_u32 s23, s23, 4096
  buffer_load_dwordx4 v[32:35], v30, s[24:27], s23 offen offset:0
  buffer_load_dwordx4 v[32:35], v30, s[24:27], s23 offen offset:1024
  buffer_load_dwordx4 v[32:35], v30, s[24:27], s23 offen offset:2048
  buffer_load_dwordx4 v[32:35], v30, s[24:27], s23 offen offset:3072
  s_add_u32 s23, s23, 4096
  buffer_load_dwordx4 v[32:35], v30, s[24:27], s23 offen offset:0
  buffer_load_dwordx4 v[32:35], v30, s[24:27], s23 offen offset:1024
  buffer_load_dwordx4 v[32:35], v30, s[24:27], s23 offen offset:2048
  buffer_load_dwordx4 v[32:35], v30, s[24:27], s23 offen offset:3072
  s_add_u32 s23, s23, 4096
  buffer_load_dwordx4 v[32:35], v30, s[24:27], s23 offen offset:0
  buffer_load_dwordx4 v[32:35], v30, s[24:27], s23 offen offset:1024
  buffer_load_dwordx4 v[32:35], v30, s[24:27], s23 offen offset:2048
  buffer_load_dwordx4 v[32:35], v30, s[24:27], s23 offen offset:3072
  s_add_u32 s23, s23, 4096
  buffer_load_dwordx4 v[32:35], v30, s[24:27], s23 offen offset:0
  buffer_load_dwordx4 v[32:35], v30, s[24:27], s23 offen offset:1024
  ds_write_b128 v23, v[64:67] offset:0
  ds_write_b128 v23, v[68:71] offset:1024
  ds_write_b128 v23, v[72:75] offset:2048
  ds_write_b128 v23, v[76:79] offset:3072
  ds_write_b128 v23, v[80:83] offset:4096
  ds_write_b128 v23, v[84:87] offset:5120
  ds_write_b128 v23, v[88:91] offset:6144
  ds_write_b128 v23, v[92:95] offset:7168
  ds_write_b128 v23, v[96:99] offset:8192
  ds_write_b128 v23, v[100:103] offset:9216
  ds_write_b128 v23, v[104:107] offset:10240
  ds_write_b128 v23, v[108:111] offset:11264
  ds_write_b128 v23, v[112:115] offset:12288
  ds_write_b128 v23, v[116:119] offset:13312
  ds_write_b128 v23, v[120:123] offset:14336
  ds_write_b128 v23, v[124:127] offset:15360
  s_waitcnt lgkmcnt(0)
  s_barrier
  ds_read_b64_tr_b16 a[128:129], v12 offset:0
  ds_read_b64_tr_b16 a[130:131], v12 offset:2048
  ds_read_b64_tr_b16 a[132:133], v13 offset:0
  ds_read_b64_tr_b16 a[134:135], v13 offset:2048
  ds_read_b64_tr_b16 a[136:137], v14 offset:0
  ds_read_b64_tr_b16 a[138:139], v14 offset:2048
  ds_read_b64_tr_b16 a[140:141], v15 offset:0
  ds_read_b64_tr_b16 a[142:143], v15 offset:2048
  ds_read_b64_tr_b16 a[144:145], v12 offset:16384
  ds_read_b64_tr_b16 a[146:147], v12 offset:18432
  ds_read_b64_tr_b16 a[148:149], v13 offset:16384
  ds_read_b64_tr_b16 a[150:151], v13 offset:18432
  ds_read_b64_tr_b16 a[152:153], v14 offset:16384
  ds_read_b64_tr_b16 a[154:155], v14 offset:18432
  ds_read_b64_tr_b16 a[156:157], v15 offset:16384
  ds_read_b64_tr_b16 a[158:159], v15 offset:18432
  ds_read_b64_tr_b16 a[160:161], v12 offset:32768
  ds_read_b64_tr_b16 a[162:163], v12 offset:34816
  ds_read_b64_tr_b16 a[164:165], v13 offset:32768
  ds_read_b64_tr_b16 a[166:167], v13 offset:34816
  ds_read_b64_tr_b16 a[168:169], v14 offset:32768
  ds_read_b64_tr_b16 a[170:171], v14 offset:34816
  ds_read_b64_tr_b16 a[172:173], v15 offset:32768
  ds_read_b64_tr_b16 a[174:175], v15 offset:34816
  ds_read_b64_tr_b16 a[176:177], v12 offset:49152
  ds_read_b64_tr_b16 a[178:179], v12 offset:51200
  ds_read_b64_tr_b16 a[180:181], v13 offset:49152
  ds_read_b64_tr_b16 a[182:183], v13 offset:51200
  ds_read_b64_tr_b16 a[184:185], v14 offset:49152
  ds_read_b64_tr_b16 a[186:187], v14 offset:51200
  ds_read_b64_tr_b16 a[188:189], v15 offset:49152
  ds_read_b64_tr_b16 a[190:191], v15 offset:51200
  s_waitcnt lgkmcnt(0)
  s_barrier
  s_waitcnt vmcnt(46)
  ds_write_b128 v29, v[128:131] offset:0
  ds_write_b128 v29, v[132:135] offset:1024
  ds_write_b128 v29, v[136:139] offset:2048
  ds_write_b128 v29, v[140:143] offset:3072
  ds_write_b128 v29, v[144:147] offset:4096
  ds_write_b128 v29, v[148:151] offset:5120
  ds_write_b128 v29, v[152:155] offset:6144
  ds_write_b128 v29, v[156:159] offset:7168
  ds_write_b128 v29, v[160:163] offset:8192
  ds_write_b128 v29, v[164:167] offset:9216
  ds_write_b128 v29, v[168:171] offset:10240
  ds_write_b128 v29, v[172:175] offset:11264
  ds_write_b128 v29, v[176:179] offset:12288
  ds_write_b128 v29, v[180:183] offset:13312
  ds_write_b128 v29, v[184:187] offset:14336
  ds_write_b128 v29, v[188:191] offset:15360
  s_waitcnt lgkmcnt(0)
  s_barrier
  ds_read_b64_tr_b16 a[192:193], v16 offset:0
  ds_read_b64_tr_b16 a[194:195], v16 offset:2048
  ds_read_b64_tr_b16 a[196:197], v17 offset:0
  ds_read_b64_tr_b16 a[198:199], v17 offset:2048
  ds_read_b64_tr_b16 a[200:201], v18 offset:0
  ds_read_b64_tr_b16 a[202:203], v18 offset:2048
  ds_read_b64_tr_b16 a[204:205], v19 offset:0
  ds_read_b64_tr_b16 a[206:207], v19 offset:2048
  ds_read_b64_tr_b16 a[208:209], v16 offset:16384
  ds_read_b64_tr_b16 a[210:211], v16 offset:18432
  ds_read_b64_tr_b16 a[212:213], v17 offset:16384
  ds_read_b64_tr_b16 a[214:215], v17 offset:18432
  ds_read_b64_tr_b16 a[216:217], v18 offset:16384
  ds_read_b64_tr_b16 a[218:219], v18 offset:18432
  ds_read_b64_tr_b16 a[220:221], v19 offset:16384
  ds_read_b64_tr_b16 a[222:223], v19 offset:18432
  ds_read_b64_tr_b16 a[224:225], v16 offset:32768
  ds_read_b64_tr_b16 a[226:227], v16 offset:34816
  ds_read_b64_tr_b16 a[228:229], v17 offset:32768
  ds_read_b64_tr_b16 a[230:231], v17 offset:34816
  ds_read_b64_tr_b16 a[232:233], v18 offset:32768
  ds_read_b64_tr_b16 a[234:235], v18 offset:34816
  ds_read_b64_tr_b16 a[236:237], v19 offset:32768
  ds_read_b64_tr_b16 a[238:239], v19 offset:34816
  ds_read_b64_tr_b16 a[240:241], v16 offset:49152
  ds_read_b64_tr_b16 a[242:243], v16 offset:51200
  ds_read_b64_tr_b16 a[244:245], v17 offset:49152
  ds_read_b64_tr_b16 a[246:247], v17 offset:51200
  ds_read_b64_tr_b16 a[248:249], v18 offset:49152
  ds_read_b64_tr_b16 a[250:251], v18 offset:51200
  ds_read_b64_tr_b16 a[252:253], v19 offset:49152
  ds_read_b64_tr_b16 a[254:255], v19 offset:51200
  s_waitcnt lgkmcnt(0)
  s_barrier
  s_waitcnt vmcnt(30)
  ds_write_b128 v23, v[192:195] offset:0
  ds_write_b128 v23, v[196:199] offset:1024
  ds_write_b128 v23, v[200:203] offset:2048
  ds_write_b128 v23, v[204:207] offset:3072
  ds_write_b128 v23, v[208:211] offset:4096
  ds_write_b128 v23, v[212:215] offset:5120
  ds_write_b128 v23, v[216:219] offset:6144
  ds_write_b128 v23, v[220:223] offset:7168
  ds_write_b128 v23, v[224:227] offset:8192
  ds_write_b128 v23, v[228:231] offset:9216
  ds_write_b128 v23, v[232:235] offset:10240
  ds_write_b128 v23, v[236:239] offset:11264
  ds_write_b128 v23, v[240:243] offset:12288
  ds_write_b128 v23, v[244:247] offset:13312
  ds_write_b128 v23, v[248:251] offset:14336
  ds_write_b128 v23, v[252:255] offset:15360
  s_waitcnt lgkmcnt(0)
  s_barrier
  ds_read_b64_tr_b16 v[192:193], v12 offset:0
  ds_read_b64_tr_b16 v[194:195], v12 offset:2048
  ds_read_b64_tr_b16 v[196:197], v13 offset:0
  ds_read_b64_tr_b16 v[198:199], v13 offset:2048
  ds_read_b64_tr_b16 v[200:201], v14 offset:0
  ds_read_b64_tr_b16 v[202:203], v14 offset:2048
  ds_read_b64_tr_b16 v[204:205], v15 offset:0
  ds_read_b64_tr_b16 v[206:207], v15 offset:2048
  ds_read_b64_tr_b16 v[208:209], v12 offset:16384
  ds_read_b64_tr_b16 v[210:211], v12 offset:18432
  ds_read_b64_tr_b16 v[212:213], v13 offset:16384
  ds_read_b64_tr_b16 v[214:215], v13 offset:18432
  ds_read_b64_tr_b16 v[216:217], v14 offset:16384
  ds_read_b64_tr_b16 v[218:219], v14 offset:18432
  ds_read_b64_tr_b16 v[220:221], v15 offset:16384
  ds_read_b64_tr_b16 v[222:223], v15 offset:18432
  ds_read_b64_tr_b16 v[224:225], v12 offset:32768
  ds_read_b64_tr_b16 v[226:227], v12 offset:34816
  ds_read_b64_tr_b16 v[228:229], v13 offset:32768
  ds_read_b64_tr_b16 v[230:231], v13 offset:34816
  ds_read_b64_tr_b16 v[232:233], v14 offset:32768
  ds_read_b64_tr_b16 v[234:235], v14 offset:34816
  ds_read_b64_tr_b16 v[236:237], v15 offset:32768
  ds_read_b64_tr_b16 v[238:239], v15 offset:34816
  ds_read_b64_tr_b16 v[240:241], v12 offset:49152
  ds_read_b64_tr_b16 v[242:243], v12 offset:51200
  ds_read_b64_tr_b16 v[244:245], v13 offset:49152
  ds_read_b64_tr_b16 v[246:247], v13 offset:51200
  ds_read_b64_tr_b16 v[248:249], v14 offset:49152
  ds_read_b64_tr_b16 v[250:251], v14 offset:51200
  ds_read_b64_tr_b16 v[252:253], v15 offset:49152
  ds_read_b64_tr_b16 v[254:255], v15 offset:51200
  s_waitcnt lgkmcnt(0)
  s_barrier
  s_load_dwordx2 s[32:33], s[0:1], 96
  s_waitcnt lgkmcnt(0)
  s_mov_b32 s32, s32
  s_mov_b32 s33, s33
  s_mov_b32 s34, 256
  s_mov_b32 s35, 0x00020000
  s_mov_b32 s21, 76
  v_mov_b32 v4, 0
  s_mov_b32 s101, 0
wf_219:
  buffer_load_dword v5, v4, s[32:35], s21 offen sc1
  s_add_u32 s101, s101, 1
  s_cmp_gt_u32 s101, 131072
  s_cbranch_scc1 main_end
  s_waitcnt vmcnt(0)
  v_readfirstlane_b32 s100, v5
  s_cmp_ge_u32 s100, 1
  s_cbranch_scc1 wf_220
  s_sleep 8
  s_branch wf_219
wf_220:
  s_sub_u32 s80, s100, 1
  s_lshl_b32 s80, s80, 13
  v_lshrrev_b32 v8, 3, v1
  v_and_b32 v9, 7, v1
  v_xor_b32 v9, v9, v8
  s_and_b32 s21, s20, 1
  s_lshl_b32 s21, s21, 4
  s_lshr_b32 s22, s20, 1
  s_add_u32 s21, s21, s22
  v_lshl_add_u32 v8, v8, 1, s21
  v_mul_u32_u24 v8, 1280, v8
  v_lshl_add_u32 v4, v9, 4, v8
  s_lshl_b32 s31, s20, 10
  s_mul_i32 s30, s42, 655360
  s_sub_u32 s46, s30, 40960
  s_cmp_eq_u32 s42, 0
  s_cselect_b32 s46, 1073741824, s46
  s_add_u32 m0, s31, 0
  s_nop 0
  buffer_load_dwordx4 v4, s[8:11], s46 offen offset:0 lds
  s_add_u32 m0, s31, 3968
  s_nop 0
  buffer_load_dwordx4 v4, s[8:11], s46 offen offset:128 lds
  s_add_u32 m0, s31, 7936
  s_nop 0
  buffer_load_dwordx4 v4, s[8:11], s46 offen offset:256 lds
  s_add_u32 m0, s31, 11904
  s_nop 0
  buffer_load_dwordx4 v4, s[8:11], s46 offen offset:384 lds
  s_add_u32 m0, s31, 15872
  s_nop 0
  buffer_load_dwordx4 v4, s[8:11], s46 offen offset:512 lds
  s_add_u32 m0, s31, 19840
  s_nop 0
  buffer_load_dwordx4 v4, s[8:11], s46 offen offset:640 lds
  s_add_u32 m0, s31, 23808
  s_nop 0
  buffer_load_dwordx4 v4, s[8:11], s46 offen offset:768 lds
  s_add_u32 m0, s31, 27776
  s_nop 0
  buffer_load_dwordx4 v4, s[8:11], s46 offen offset:896 lds
  s_add_u32 m0, s31, 31744
  s_nop 0
  buffer_load_dwordx4 v4, s[8:11], s46 offen offset:1024 lds
  s_add_u32 m0, s31, 35712
  s_nop 0
  buffer_load_dwordx4 v4, s[8:11], s46 offen offset:1152 lds
  s_add_u32 s31, s31, 40960
  s_add_u32 m0, s31, 0
  s_nop 0
  buffer_load_dwordx4 v4, s[8:11], s30 offen offset:0 lds
  s_add_u32 m0, s31, 3968
  s_nop 0
  buffer_load_dwordx4 v4, s[8:11], s30 offen offset:128 lds
  s_add_u32 m0, s31, 7936
  s_nop 0
  buffer_load_dwordx4 v4, s[8:11], s30 offen offset:256 lds
  s_add_u32 m0, s31, 11904
  s_nop 0
  buffer_load_dwordx4 v4, s[8:11], s30 offen offset:384 lds
  s_add_u32 m0, s31, 15872
  s_nop 0
  buffer_load_dwordx4 v4, s[8:11], s30 offen offset:512 lds
  s_add_u32 m0, s31, 19840
  s_nop 0
  buffer_load_dwordx4 v4, s[8:11], s30 offen offset:640 lds
  s_add_u32 m0, s31, 23808
  s_nop 0
  buffer_load_dwordx4 v4, s[8:11], s30 offen offset:768 lds
  s_add_u32 m0, s31, 27776
  s_nop 0
  buffer_load_dwordx4 v4, s[8:11], s30 offen offset:896 lds
  s_add_u32 m0, s31, 31744
  s_nop 0
  buffer_load_dwordx4 v4, s[8:11], s30 offen offset:1024 lds
  s_add_u32 m0, s31, 35712
  s_nop 0
  buffer_load_dwordx4 v4, s[8:11], s30 offen offset:1152 lds
  s_add_u32 s31, s31, 40960
  s_add_u32 s30, s30, 40960
  v_and_b32 v10, 7, v2
  v_add_u32 v8, 0, v3
  v_xor_b32 v8, v8, v10
  v_lshlrev_b32 v8, 4, v8
  v_lshl_add_u32 v5, v2, 7, v8
  v_add_u32 v8, 4, v3
  v_xor_b32 v8, v8, v10
  v_lshlrev_b32 v8, 4, v8
  v_lshl_add_u32 v6, v2, 7, v8
  v_mov_b32 v7, v5
  v_mov_b32 v8, v6
  s_mov_b32 s33, 0
  v_lshlrev_b32 v15, 4, v1
  v_mov_b32 v16, 0xf149f2ca
  v_lshrrev_b32 v17, 3, v2
  v_mul_u32_u24 v17, 2560, v17
  v_lshlrev_b32 v18, 1, v10
  s_lshr_b32 s21, s20, 1
  s_lshl_b32 s21, s21, 10
  s_and_b32 s22, s20, 1
  s_lshl_b32 s22, s22, 3
  s_add_u32 s21, s21, s22
  s_add_u32 s21, s21, 131072
  v_lshl_add_u32 v9, v3, 4, v18
  v_lshl_add_u32 v9, v9, 4, v17
  v_add_u32 v9, s21, v9
  s_lshl_b32 s21, s20, 7
  s_add_u32 s21, s21, 133120
  v_lshl_add_u32 v10, v18, 3, v17
  v_add_u32 v10, s21, v10
  v_cmp_eq_u32 vcc, 2, v3
  v_lshlrev_b32 v19, 4, v1
  v_add_u32 v19, 136192, v19
  v_cndmask_b32 v10, v19, v10, vcc
  s_lshr_b32 s21, s20, 1
  s_and_b32 s22, s20, 1
  s_mul_i32 s23, s21, 2560
  s_lshl_b32 s47, s22, 10
  s_add_u32 s47, s47, s23
  s_add_u32 s47, s47, 131072
  v_add_u32 v11, s47, v15
  s_lshl_b32 s47, s22, 8
  s_add_u32 s47, s47, s23
  s_add_u32 s47, s47, 133120
  v_add_u32 v12, s47, v15
  s_mul_i32 s23, s22, 768
  s_sub_u32 s23, 2048, s23
  v_add_u32 v14, s23, v15
  v_mov_b32 v19, 1073741824
  v_cmp_gt_u32 vcc, 16, v1
  s_lshl_b32 s47, s42, 23
  s_lshl_b32 s21, s21, 14
  v_cndmask_b32 v14, v19, v14, vcc
  s_add_u32 s47, s47, s21
  s_lshr_b32 s21, s41, 1
  s_lshl_b32 s21, s21, 15
  s_add_u32 s47, s47, s21
  s_and_b32 s21, s41, 1
  s_mul_i32 s21, s21, 2560
  s_add_u32 s47, s47, s21
  s_xor_b32 s21, s80, 134488064
  s_add_u32 s47, s47, s21
  s_lshl_b32 s22, s22, 10
  s_add_u32 s47, s47, s22
  s_mov_b32 s48, 1073741824
  s_mov_b32 s49, 1073741824
  v_cmp_eq_u32 s[62:63], 0, v3
  v_lshlrev_b32 v17, 2, v3
  v_sub_u32 v17, v17, v2
  s_mov_b32 s82, 0x3e64f92e
  s_mov_b32 s83, 0x3fb8aa3b
  v_mov_b32 v20, 0
  v_mov_b32 v21, 0
  v_mov_b32 v22, 0
  v_mov_b32 v23, 0
  v_add_u32 v18, 7, v17
  v_cmp_gt_u32 s[84:85], 8, v18
  v_cmp_le_i32 s[64:65], 16, v18
  v_mov_b32 v18, 65535
  v_cndmask_b32 v19, 0, v18, s[84:85]
  v_or_b32 v20, v20, v19
  v_cndmask_b32 v19, 0, v18, s[64:65]
  v_or_b32 v22, v22, v19
  s_mov_b64 s[54:55], s[84:85]
  s_or_b64 s[84:85], s[84:85], s[64:65]
  v_add_u32 v18, 8, v17
  v_cmp_gt_u32 s[86:87], 8, v18
  v_cmp_le_i32 s[66:67], 16, v18
  v_mov_b32 v18, 4294901760
  v_cndmask_b32 v19, 0, v18, s[86:87]
  v_or_b32 v20, v20, v19
  v_cndmask_b32 v19, 0, v18, s[66:67]
  v_or_b32 v22, v22, v19
  s_mov_b64 s[56:57], s[86:87]
  s_or_b64 s[86:87], s[86:87], s[66:67]
  v_add_u32 v18, 9, v17
  v_cmp_gt_u32 s[88:89], 8, v18
  v_cmp_le_i32 s[68:69], 16, v18
  v_mov_b32 v18, 65535
  v_cndmask_b32 v19, 0, v18, s[88:89]
  v_or_b32 v21, v21, v19
  v_cndmask_b32 v19, 0, v18, s[68:69]
  v_or_b32 v23, v23, v19
  s_mov_b64 s[58:59], s[88:89]
  s_or_b64 s[88:89], s[88:89], s[68:69]
  v_add_u32 v18, 10, v17
  v_cmp_gt_u32 s[90:91], 8, v18
  v_cmp_le_i32 s[70:71], 16, v18
  v_mov_b32 v18, 4294901760
  v_cndmask_b32 v19, 0, v18, s[90:91]
  v_or_b32 v21, v21, v19
  v_cndmask_b32 v19, 0, v18, s[70:71]
  v_or_b32 v23, v23, v19
  s_mov_b64 s[60:61], s[90:91]
  s_or_b64 s[90:91], s[90:91], s[70:71]
  v_mov_b32 v18, 0x3f80
  v_mov_b32 v19, 0x3f800000
  v_cmp_eq_i32 vcc, 0, v17
  v_cmp_eq_i32 s[22:23], -1, v17
  s_nop 1
  v_cndmask_b32 v24, 0, v18, vcc
  v_cndmask_b32 v24, v24, v19, s[22:23]
  v_cmp_eq_i32 vcc, -2, v17
  v_cmp_eq_i32 s[22:23], -3, v17
  s_nop 1
  v_cndmask_b32 v25, 0, v18, vcc
  v_cndmask_b32 v25, v25, v19, s[22:23]
  v_mov_b32 v26, 0
  v_mov_b32 v27, 0
  v_mov_b32 v60, 0
  v_mov_b32 v61, 0
  v_mov_b32 v62, 0
  v_mov_b32 v63, 0
  v_mov_b32 v64, 0
  v_mov_b32 v65, 0
  v_mov_b32 v66, 0
  v_mov_b32 v67, 0
  v_mov_b32 v68, 0
  v_mov_b32 v69, 0
  v_mov_b32 v70, 0
  v_mov_b32 v71, 0
  v_mov_b32 v72, 0
  v_mov_b32 v73, 0
  v_mov_b32 v74, 0
  v_mov_b32 v75, 0
  v_mov_b32 v76, 0
  v_mov_b32 v77, 0
  v_mov_b32 v78, 0
  v_mov_b32 v79, 0
  v_mov_b32 v80, 0
  v_mov_b32 v81, 0
  v_mov_b32 v82, 0
  v_mov_b32 v83, 0
  v_mov_b32 v84, 0
  v_mov_b32 v85, 0
  v_mov_b32 v86, 0
  v_mov_b32 v87, 0
  v_mov_b32 v88, 0
  v_mov_b32 v89, 0
  v_mov_b32 v90, 0
  v_mov_b32 v91, 0
  v_mov_b32 v92, 0
  v_mov_b32 v93, 0
  v_mov_b32 v94, 0
  v_mov_b32 v95, 0
  v_mov_b32 v96, 0
  v_mov_b32 v97, 0
  v_mov_b32 v98, 0
  v_mov_b32 v99, 0
  v_mov_b32 v100, 0
  v_mov_b32 v101, 0
  v_mov_b32 v102, 0
  v_mov_b32 v103, 0
  v_mov_b32 v104, 0
  v_mov_b32 v105, 0
  v_mov_b32 v106, 0
  v_mov_b32 v107, 0
  v_mov_b32 v108, 0
  v_mov_b32 v109, 0
  v_mov_b32 v110, 0
  v_mov_b32 v111, 0
  v_mov_b32 v112, 0
  v_mov_b32 v113, 0
  v_mov_b32 v114, 0
  v_mov_b32 v115, 0
  v_mov_b32 v116, 0
  v_mov_b32 v117, 0
  v_mov_b32 v118, 0
  v_mov_b32 v119, 0
  v_mov_b32 v120, 0
  v_mov_b32 v121, 0
  v_mov_b32 v122, 0
  v_mov_b32 v123, 0
  v_mov_b32 v124, 0
  v_mov_b32 v125, 0
  v_mov_b32 v126, 0
  v_mov_b32 v127, 0
  v_mov_b32 v128, 0
  v_mov_b32 v129, 0
  v_mov_b32 v130, 0
  v_mov_b32 v131, 0
  s_cmp_eq_u32 s42, 0
  s_cselect_b32 s53, 15, 99
  s_mov_b32 s26, 17
  s_waitcnt vmcnt(10)
  s_barrier
  ds_read_b128 v[28:31], v7 offset:0
  ds_read_b128 v[32:35], v8 offset:0
  ds_read_b128 v[36:39], v7 offset:4096
  ds_read_b128 v[40:43], v8 offset:4096
  s_waitcnt lgkmcnt(3)
  .p2align 3
bfl_221:
  v_mfma_f32_16x16x32_bf16 v[60:63], a[0:3], v[28:31], 0
  ds_read_b128 v[44:47], v7 offset:8192
  v_mfma_f32_16x16x32_bf16 v[64:67], a[4:7], v[28:31], 0
  v_mfma_f32_16x16x32_bf16 v[68:71], a[8:11], v[28:31], 0
  v_cvt_pk_bf16_f32 v128, v84, v85
  v_cvt_pk_bf16_f32 v129, v86, v87
  v_mfma_f32_16x16x32_bf16 v[72:75], v[28:31], a[12:15], 0
  s_waitcnt lgkmcnt(3)
  v_cvt_pk_bf16_f32 v124, v76, v77
  v_cvt_pk_bf16_f32 v125, v78, v79
  v_mfma_f32_16x16x32_bf16 v[60:63], a[16:19], v[32:35], v[60:63]
  ds_read_b128 v[48:51], v8 offset:8192
  v_cvt_pk_bf16_f32 v100, v80, v81
  v_mfma_f32_16x16x32_bf16 v[64:67], a[20:23], v[32:35], v[64:67]
  v_cvt_pk_bf16_f32 v101, v82, v83
  v_cvt_pk_bf16_f32 v116, v88, v89
  v_mfma_f32_16x16x32_bf16 v[68:71], a[24:27], v[32:35], v[68:71]
  s_add_u32 m0, s31, 0
  v_cvt_pk_bf16_f32 v117, v90, v91
  v_cndmask_b32 v126, 0, v128, s[62:63]
  v_mfma_f32_16x16x32_bf16 v[72:75], v[32:35], a[28:31], v[72:75]
  s_waitcnt lgkmcnt(3)
  v_cndmask_b32 v127, 0, v129, s[62:63]
  buffer_load_dwordx4 v4, s[8:11], s30 offen offset:0 lds
  v_mfma_f32_16x16x32_bf16 v[60:63], a[32:35], v[36:39], v[60:63]
  ds_read_b128 v[52:55], v7 offset:12288
  v_mfma_f32_16x16x32_bf16 v[64:67], a[36:39], v[36:39], v[64:67]
  v_mfma_f32_16x16x32_bf16 v[68:71], a[40:43], v[36:39], v[68:71]
  v_mfma_f32_16x16x32_bf16 v[72:75], v[36:39], a[44:47], v[72:75]
  v_mfma_f32_16x16x32_bf16 v[132:135], v[128:131], v[24:27], 0
  s_waitcnt lgkmcnt(3)
  v_permlane16_swap_b32 v128, v102
  v_permlane16_swap_b32 v129, v103
  v_mfma_f32_16x16x32_bf16 v[60:63], a[48:51], v[40:43], v[60:63]
  ds_read_b128 v[56:59], v8 offset:12288
  v_mfma_f32_16x16x32_bf16 v[64:67], a[52:55], v[40:43], v[64:67]
  v_mfma_f32_16x16x32_bf16 v[68:71], a[56:59], v[40:43], v[68:71]
  v_mfma_f32_16x16x32_bf16 v[72:75], v[40:43], a[60:63], v[72:75]
  v_mfma_f32_16x16x32_bf16 v[136:139], v[100:103], v[124:127], 0
  v_mfma_f32_16x16x32_bf16 v[140:143], v[104:107], v[124:127], 0
  s_add_u32 m0, s31, 3968
  s_waitcnt lgkmcnt(3)
  v_mfma_f32_16x16x32_bf16 v[60:63], a[64:67], v[44:47], v[60:63]
  ds_read_b128 v[28:31], v7 offset:16384
  buffer_load_dwordx4 v4, s[8:11], s30 offen offset:128 lds
  v_mfma_f32_16x16x32_bf16 v[64:67], a[68:71], v[44:47], v[64:67]
  v_mfma_f32_16x16x32_bf16 v[68:71], a[72:75], v[44:47], v[68:71]
  v_cvt_pk_bf16_f32 v120, v132, v133
  v_cvt_pk_bf16_f32 v121, v134, v135
  v_mfma_f32_16x16x32_bf16 v[72:75], v[44:47], a[76:79], v[72:75]
  s_waitcnt lgkmcnt(3)
  v_cndmask_b32 v136, v136, v140, s[64:65]
  v_cndmask_b32 v137, v137, v141, s[66:67]
  v_mfma_f32_16x16x32_bf16 v[60:63], a[80:83], v[48:51], v[60:63]
  ds_read_b128 v[32:35], v8 offset:16384
  v_cndmask_b32 v138, v138, v142, s[68:69]
  v_mfma_f32_16x16x32_bf16 v[64:67], a[84:87], v[48:51], v[64:67]
  v_cndmask_b32 v139, v139, v143, s[70:71]
  v_cvt_pk_bf16_f32 v17, v136, v137
  v_mfma_f32_16x16x32_bf16 v[68:71], a[88:91], v[48:51], v[68:71]
  v_lshlrev_b32 v136, 16, v17
  v_and_b32 v137, 0xffff0000, v17
  v_mfma_f32_16x16x32_bf16 v[72:75], v[48:51], a[92:95], v[72:75]
  s_waitcnt lgkmcnt(3)
  v_cvt_pk_bf16_f32 v17, v138, v139
  v_lshlrev_b32 v138, 16, v17
  v_mfma_f32_16x16x32_bf16 v[60:63], a[96:99], v[52:55], v[60:63]
  ds_read_b128 v[36:39], v7 offset:20480
  v_and_b32 v139, 0xffff0000, v17
  v_mfma_f32_16x16x32_bf16 v[64:67], a[100:103], v[52:55], v[64:67]
  v_mul_f32 v136, s82, v136
  v_mul_f32 v137, s82, v137
  v_mfma_f32_16x16x32_bf16 v[68:71], a[104:107], v[52:55], v[68:71]
  v_mul_f32 v138, s82, v138
  v_mul_f32 v139, s82, v139
  v_mfma_f32_16x16x32_bf16 v[72:75], v[52:55], a[108:111], v[72:75]
  s_waitcnt lgkmcnt(3)
  v_cvt_pk_bf16_f32 v17, v136, v137
  v_lshlrev_b32 v136, 16, v17
  v_mfma_f32_16x16x32_bf16 v[60:63], a[112:115], v[56:59], v[60:63]
  s_add_u32 m0, s31, 7936
  ds_read_b128 v[40:43], v8 offset:20480
  v_and_b32 v137, 0xffff0000, v17
  v_mfma_f32_16x16x32_bf16 v[64:67], a[116:119], v[56:59], v[64:67]
  v_cvt_pk_bf16_f32 v17, v138, v139
  v_lshlrev_b32 v138, 16, v17
  v_mfma_f32_16x16x32_bf16 v[68:71], a[120:123], v[56:59], v[68:71]
  v_and_b32 v139, 0xffff0000, v17
  v_cndmask_b32 v136, v16, v136, s[54:55]
  v_mfma_f32_16x16x32_bf16 v[72:75], v[56:59], a[124:127], v[72:75]
  s_waitcnt lgkmcnt(3)
  v_cndmask_b32 v137, v16, v137, s[56:57]
  v_cndmask_b32 v138, v16, v138, s[58:59]
  v_mfma_f32_16x16x32_bf16 v[60:63], a[128:131], v[28:31], v[60:63]
  ds_read_b128 v[44:47], v7 offset:24576
  v_cndmask_b32 v139, v16, v139, s[60:61]
  v_mfma_f32_16x16x32_bf16 v[64:67], a[132:135], v[28:31], v[64:67]
  v_max3_f32 v17, v136, v137, v138
  v_max_f32 v17, v17, v139
  v_mfma_f32_16x16x32_bf16 v[68:71], a[136:139], v[28:31], v[68:71]
  v_mov_b32 v18, v17
  buffer_load_dwordx4 v4, s[8:11], s30 offen offset:256 lds
  v_mfma_f32_16x16x32_bf16 v[72:75], v[28:31], a[140:143], v[72:75]
  s_waitcnt lgkmcnt(3)
  v_permlane32_swap_b32 v17, v18
  v_max_f32 v17, v17, v18
  v_mfma_f32_16x16x32_bf16 v[60:63], a[144:147], v[32:35], v[60:63]
  ds_read_b128 v[48:51], v8 offset:24576
  v_mov_b32 v18, v17
  v_mfma_f32_16x16x32_bf16 v[64:67], a[148:151], v[32:35], v[64:67]
  v_permlane16_swap_b32 v17, v18
  v_max_f32 v17, v17, v18
  v_mfma_f32_16x16x32_bf16 v[68:71], a[152:155], v[32:35], v[68:71]
  v_mul_f32 v17, s83, v17
  v_fma_f32 v136, v136, s83, -v17
  v_mfma_f32_16x16x32_bf16 v[72:75], v[32:35], a[156:159], v[72:75]
  s_waitcnt lgkmcnt(3)
  v_fma_f32 v137, v137, s83, -v17
  v_fma_f32 v138, v138, s83, -v17
  v_mfma_f32_16x16x32_bf16 v[60:63], a[160:163], v[36:39], v[60:63]
  s_add_u32 m0, s31, 11904
  ds_read_b128 v[52:55], v7 offset:28672
  v_fma_f32 v139, v139, s83, -v17
  v_mfma_f32_16x16x32_bf16 v[64:67], a[164:167], v[36:39], v[64:67]
  v_exp_f32 v136, v136
  v_mfma_f32_16x16x32_bf16 v[68:71], a[168:171], v[36:39], v[68:71]
  v_exp_f32 v137, v137
  v_mfma_f32_16x16x32_bf16 v[72:75], v[36:39], a[172:175], v[72:75]
  s_waitcnt lgkmcnt(3)
  v_exp_f32 v138, v138
  v_mfma_f32_16x16x32_bf16 v[60:63], a[176:179], v[40:43], v[60:63]
  ds_read_b128 v[56:59], v8 offset:28672
  buffer_load_dwordx4 v4, s[8:11], s30 offen offset:384 lds
  v_mfma_f32_16x16x32_bf16 v[64:67], a[180:183], v[40:43], v[64:67]
  v_exp_f32 v139, v139
  v_mfma_f32_16x16x32_bf16 v[68:71], a[184:187], v[40:43], v[68:71]
  v_add_f32 v17, v136, v137
  v_add_f32 v18, v138, v139
  v_mfma_f32_16x16x32_bf16 v[72:75], v[40:43], a[188:191], v[72:75]
  s_waitcnt lgkmcnt(3)
  v_add_f32 v17, v17, v18
  v_mov_b32 v18, v17
  v_mfma_f32_16x16x32_bf16 v[60:63], a[192:195], v[44:47], v[60:63]
  ds_read_b128 v[28:31], v7 offset:32768
  v_permlane32_swap_b32 v17, v18
  v_mfma_f32_16x16x32_bf16 v[64:67], a[196:199], v[44:47], v[64:67]
  v_add_f32 v17, v17, v18
  v_mov_b32 v18, v17
  v_mfma_f32_16x16x32_bf16 v[68:71], a[200:203], v[44:47], v[68:71]
  v_permlane16_swap_b32 v17, v18
  v_add_f32 v17, v17, v18
  v_mfma_f32_16x16x32_bf16 v[72:75], v[44:47], a[204:207], v[72:75]
  s_waitcnt lgkmcnt(3)
  v_rcp_f32 v17, v17
  v_mfma_f32_16x16x32_bf16 v[60:63], a[208:211], v[48:51], v[60:63]
  s_add_u32 m0, s31, 15872
  ds_read_b128 v[32:35], v8 offset:32768
  v_mul_f32 v136, v136, v17
  v_mfma_f32_16x16x32_bf16 v[64:67], a[212:215], v[48:51], v[64:67]
  v_mul_f32 v137, v137, v17
  v_mul_f32 v138, v138, v17
  v_mfma_f32_16x16x32_bf16 v[68:71], a[216:219], v[48:51], v[68:71]
  v_mul_f32 v139, v139, v17
  v_cvt_pk_bf16_f32 v144, v136, v137
  v_mfma_f32_16x16x32_bf16 v[72:75], v[48:51], a[220:223], v[72:75]
  s_waitcnt lgkmcnt(3)
  v_cvt_pk_bf16_f32 v145, v138, v139
  v_and_b32 v146, v144, v22
  v_mfma_f32_16x16x32_bf16 v[60:63], a[224:227], v[52:55], v[60:63]
  ds_read_b128 v[36:39], v7 offset:36864
  v_and_b32 v147, v145, v23
  v_mfma_f32_16x16x32_bf16 v[64:67], a[228:231], v[52:55], v[64:67]
  v_and_b32 v144, v144, v20
  v_and_b32 v145, v145, v21
  v_mfma_f32_16x16x32_bf16 v[68:71], a[232:235], v[52:55], v[68:71]
  buffer_load_dwordx4 v4, s[8:11], s30 offen offset:512 lds
  v_mfma_f32_16x16x32_bf16 v[72:75], v[52:55], a[236:239], v[72:75]
  s_waitcnt lgkmcnt(3)
  v_mfma_f32_16x16x32_bf16 v[60:63], a[240:243], v[56:59], v[60:63]
  ds_read_b128 v[40:43], v8 offset:36864
  v_mfma_f32_16x16x32_bf16 v[64:67], a[244:247], v[56:59], v[64:67]
  v_mfma_f32_16x16x32_bf16 v[68:71], a[248:251], v[56:59], v[68:71]
  v_mfma_f32_16x16x32_bf16 v[72:75], v[56:59], a[252:255], v[72:75]
  s_add_u32 m0, s31, 19840
  s_waitcnt lgkmcnt(3)
  v_mfma_f32_16x16x32_bf16 v[60:63], v[192:195], v[28:31], v[60:63]
  ds_read_b128 v[44:47], v7 offset:2048
  buffer_load_dwordx4 v4, s[8:11], s30 offen offset:640 lds
  v_mfma_f32_16x16x32_bf16 v[64:67], v[196:199], v[28:31], v[64:67]
  v_mfma_f32_16x16x32_bf16 v[68:71], v[200:203], v[28:31], v[68:71]
  v_mfma_f32_16x16x32_bf16 v[72:75], v[28:31], v[204:207], v[72:75]
  v_mfma_f32_16x16x32_bf16 v[148:151], v[116:119], v[144:147], 0
  s_cmp_le_u32 s26, s53
  s_cselect_b64 s[54:55], s[84:85], s[54:55]
  v_mfma_f32_16x16x32_bf16 v[152:155], v[120:123], v[144:147], 0
  s_waitcnt lgkmcnt(3)
  v_mov_b32 v104, v100
  v_mov_b32 v105, v101
  v_mfma_f32_16x16x32_bf16 v[60:63], v[208:211], v[32:35], v[60:63]
  ds_read_b128 v[48:51], v8 offset:2048
  v_mov_b32 v106, v102
  v_mfma_f32_16x16x32_bf16 v[64:67], v[212:215], v[32:35], v[64:67]
  v_mov_b32 v107, v103
  v_mov_b32 v118, v116
  v_mfma_f32_16x16x32_bf16 v[68:71], v[216:219], v[32:35], v[68:71]
  v_cvt_pk_bf16_f32 v156, v148, v149
  v_cvt_pk_bf16_f32 v157, v150, v151
  v_mfma_f32_16x16x32_bf16 v[72:75], v[32:35], v[220:223], v[72:75]
  s_waitcnt lgkmcnt(3)
  ds_write_b64 v9, v[156:157] offset:16
  v_cvt_pk_bf16_f32 v158, v152, v153
  v_mfma_f32_16x16x32_bf16 v[60:63], v[224:227], v[36:39], v[60:63]
  ds_read_b128 v[52:55], v7 offset:6144
  v_cvt_pk_bf16_f32 v159, v154, v155
  v_mfma_f32_16x16x32_bf16 v[64:67], v[228:231], v[36:39], v[64:67]
  s_add_u32 m0, s31, 23808
  ds_write_b64 v10, v[158:159] offset:8
  v_mov_b32 v119, v117
  v_mfma_f32_16x16x32_bf16 v[68:71], v[232:235], v[36:39], v[68:71]
  v_mov_b32 v122, v120
  v_mov_b32 v123, v121
  v_mfma_f32_16x16x32_bf16 v[72:75], v[36:39], v[236:239], v[72:75]
  s_waitcnt lgkmcnt(5)
  buffer_load_dwordx4 v4, s[8:11], s30 offen offset:768 lds
  v_mfma_f32_16x16x32_bf16 v[60:63], v[240:243], v[40:43], v[60:63]
  ds_read_b128 v[56:59], v8 offset:6144
  v_mfma_f32_16x16x32_bf16 v[64:67], v[244:247], v[40:43], v[64:67]
  s_cmp_le_u32 s26, s53
  s_cselect_b64 s[56:57], s[86:87], s[56:57]
  v_mfma_f32_16x16x32_bf16 v[68:71], v[248:251], v[40:43], v[68:71]
  s_cmp_le_u32 s26, s53
  s_cselect_b64 s[58:59], s[88:89], s[58:59]
  v_mfma_f32_16x16x32_bf16 v[72:75], v[40:43], v[252:255], v[72:75]
  s_waitcnt lgkmcnt(5)
  s_cmp_le_u32 s26, s53
  s_cselect_b64 s[60:61], s[90:91], s[60:61]
  v_mfma_f32_16x16x32_bf16 v[76:79], a[0:3], v[44:47], 0
  ds_read_b128 v[28:31], v7 offset:10240
  v_mfma_f32_16x16x32_bf16 v[80:83], a[4:7], v[44:47], 0
  s_waitcnt lgkmcnt(2)
  s_barrier
  v_mfma_f32_16x16x32_bf16 v[84:87], a[8:11], v[44:47], 0
  v_cvt_pk_bf16_f32 v128, v68, v69
  v_cvt_pk_bf16_f32 v129, v70, v71
  v_mfma_f32_16x16x32_bf16 v[88:91], v[44:47], a[12:15], 0
  s_waitcnt lgkmcnt(5)
  v_cvt_pk_bf16_f32 v124, v60, v61
  v_cvt_pk_bf16_f32 v125, v62, v63
  v_mfma_f32_16x16x32_bf16 v[76:79], a[16:19], v[48:51], v[76:79]
  ds_read_b128 v[32:35], v8 offset:10240
  v_cvt_pk_bf16_f32 v92, v64, v65
  v_mfma_f32_16x16x32_bf16 v[80:83], a[20:23], v[48:51], v[80:83]
  s_add_u32 m0, s31, 27776
  v_cvt_pk_bf16_f32 v93, v66, v67
  v_cvt_pk_bf16_f32 v108, v72, v73
  v_mfma_f32_16x16x32_bf16 v[84:87], a[24:27], v[48:51], v[84:87]
  v_cvt_pk_bf16_f32 v109, v74, v75
  v_cndmask_b32 v126, 0, v128, s[62:63]
  v_mfma_f32_16x16x32_bf16 v[88:91], v[48:51], a[28:31], v[88:91]
  s_waitcnt lgkmcnt(4)
  v_cndmask_b32 v127, 0, v129, s[62:63]
  v_xor_b32 v9, 8192, v9
  v_mfma_f32_16x16x32_bf16 v[76:79], a[32:35], v[52:55], v[76:79]
  ds_read_b128 v[36:39], v7 offset:14336
  v_xor_b32 v10, 8192, v10
  v_mfma_f32_16x16x32_bf16 v[80:83], a[36:39], v[52:55], v[80:83]
  ds_read_b128 v[160:163], v11
  ds_read_b128 v[164:167], v12
  v_mfma_f32_16x16x32_bf16 v[84:87], a[40:43], v[52:55], v[84:87]
  buffer_load_dwordx4 v4, s[8:11], s30 offen offset:896 lds
  v_mfma_f32_16x16x32_bf16 v[88:91], v[52:55], a[44:47], v[88:91]
  v_mfma_f32_16x16x32_bf16 v[132:135], v[128:131], v[24:27], 0
  s_waitcnt lgkmcnt(5)
  v_permlane16_swap_b32 v128, v94
  v_permlane16_swap_b32 v129, v95
  v_mfma_f32_16x16x32_bf16 v[76:79], a[48:51], v[56:59], v[76:79]
  ds_read_b128 v[40:43], v8 offset:14336
  v_mfma_f32_16x16x32_bf16 v[80:83], a[52:55], v[56:59], v[80:83]
  v_mfma_f32_16x16x32_bf16 v[84:87], a[56:59], v[56:59], v[84:87]
  s_waitcnt lgkmcnt(1)
  buffer_store_dwordx4 v[160:163], v15, s[16:19], s49 offen sc1
  buffer_store_dwordx4 v[164:167], v14, s[16:19], s49 offen sc1
  v_mfma_f32_16x16x32_bf16 v[88:91], v[56:59], a[60:63], v[88:91]
  v_xor_b32 v11, 8192, v11
  v_xor_b32 v12, 8192, v12
  v_mfma_f32_16x16x32_bf16 v[136:139], v[92:95], v[124:127], 0
  s_add_u32 m0, s31, 31744
  s_mov_b32 s49, s48
  s_mov_b32 s48, s47
  v_mfma_f32_16x16x32_bf16 v[140:143], v[96:99], v[124:127], 0
  s_add_u32 s22, s47, 524288
  s_waitcnt lgkmcnt(5)
  buffer_load_dwordx4 v4, s[8:11], s30 offen offset:1024 lds
  v_mfma_f32_16x16x32_bf16 v[76:79], a[64:67], v[28:31], v[76:79]
  s_xor_b32 s47, s47, s22
  ds_read_b128 v[44:47], v7 offset:18432
  s_lshr_b32 s47, s47, 8
  v_mfma_f32_16x16x32_bf16 v[80:83], a[68:71], v[28:31], v[80:83]
  s_and_b32 s47, s47, 8192
  s_xor_b32 s47, s47, s22
  s_sub_u32 s26, s26, 1
  v_mfma_f32_16x16x32_bf16 v[84:87], a[72:75], v[28:31], v[84:87]
  v_cvt_pk_bf16_f32 v112, v132, v133
  v_cvt_pk_bf16_f32 v113, v134, v135
  v_mfma_f32_16x16x32_bf16 v[88:91], v[28:31], a[76:79], v[88:91]
  s_waitcnt lgkmcnt(5)
  v_cndmask_b32 v136, v136, v140, s[64:65]
  v_cndmask_b32 v137, v137, v141, s[66:67]
  v_mfma_f32_16x16x32_bf16 v[76:79], a[80:83], v[32:35], v[76:79]
  ds_read_b128 v[48:51], v8 offset:18432
  v_cndmask_b32 v138, v138, v142, s[68:69]
  v_mfma_f32_16x16x32_bf16 v[80:83], a[84:87], v[32:35], v[80:83]
  v_cndmask_b32 v139, v139, v143, s[70:71]
  v_cvt_pk_bf16_f32 v17, v136, v137
  v_mfma_f32_16x16x32_bf16 v[84:87], a[88:91], v[32:35], v[84:87]
  v_lshlrev_b32 v136, 16, v17
  v_and_b32 v137, 0xffff0000, v17
  v_mfma_f32_16x16x32_bf16 v[88:91], v[32:35], a[92:95], v[88:91]
  s_waitcnt lgkmcnt(5)
  v_cvt_pk_bf16_f32 v17, v138, v139
  v_lshlrev_b32 v138, 16, v17
  v_mfma_f32_16x16x32_bf16 v[76:79], a[96:99], v[36:39], v[76:79]
  ds_read_b128 v[52:55], v7 offset:22528
  v_and_b32 v139, 0xffff0000, v17
  v_mfma_f32_16x16x32_bf16 v[80:83], a[100:103], v[36:39], v[80:83]
  v_mul_f32 v136, s82, v136
  v_mul_f32 v137, s82, v137
  v_mfma_f32_16x16x32_bf16 v[84:87], a[104:107], v[36:39], v[84:87]
  s_add_u32 m0, s31, 35712
  v_mul_f32 v138, s82, v138
  v_mul_f32 v139, s82, v139
  v_mfma_f32_16x16x32_bf16 v[88:91], v[36:39], a[108:111], v[88:91]
  s_waitcnt lgkmcnt(3)
  v_cvt_pk_bf16_f32 v17, v136, v137
  v_lshlrev_b32 v136, 16, v17
  v_mfma_f32_16x16x32_bf16 v[76:79], a[112:115], v[40:43], v[76:79]
  ds_read_b128 v[56:59], v8 offset:22528
  v_and_b32 v137, 0xffff0000, v17
  v_mfma_f32_16x16x32_bf16 v[80:83], a[116:119], v[40:43], v[80:83]
  v_cvt_pk_bf16_f32 v17, v138, v139
  v_lshlrev_b32 v138, 16, v17
  v_mfma_f32_16x16x32_bf16 v[84:87], a[120:123], v[40:43], v[84:87]
  v_and_b32 v139, 0xffff0000, v17
  v_cndmask_b32 v136, v16, v136, s[54:55]
  v_mfma_f32_16x16x32_bf16 v[88:91], v[40:43], a[124:127], v[88:91]
  s_waitcnt lgkmcnt(3)
  v_cndmask_b32 v137, v16, v137, s[56:57]
  v_cndmask_b32 v138, v16, v138, s[58:59]
  v_mfma_f32_16x16x32_bf16 v[76:79], a[128:131], v[44:47], v[76:79]
  ds_read_b128 v[28:31], v7 offset:26624
  v_cndmask_b32 v139, v16, v139, s[60:61]
  v_mfma_f32_16x16x32_bf16 v[80:83], a[132:135], v[44:47], v[80:83]
  v_max3_f32 v17, v136, v137, v138
  v_max_f32 v17, v17, v139
  v_mfma_f32_16x16x32_bf16 v[84:87], a[136:139], v[44:47], v[84:87]
  v_mov_b32 v18, v17
  buffer_load_dwordx4 v4, s[8:11], s30 offen offset:1152 lds
  v_mfma_f32_16x16x32_bf16 v[88:91], v[44:47], a[140:143], v[88:91]
  s_waitcnt lgkmcnt(3)
  v_permlane32_swap_b32 v17, v18
  v_max_f32 v17, v17, v18
  v_mfma_f32_16x16x32_bf16 v[76:79], a[144:147], v[48:51], v[76:79]
  s_add_u32 s30, s30, 40960
  ds_read_b128 v[32:35], v8 offset:26624
  v_mov_b32 v18, v17
  v_mfma_f32_16x16x32_bf16 v[80:83], a[148:151], v[48:51], v[80:83]
  s_add_u32 s31, s31, 40960
  v_permlane16_swap_b32 v17, v18
  v_max_f32 v17, v17, v18
  v_mfma_f32_16x16x32_bf16 v[84:87], a[152:155], v[48:51], v[84:87]
  v_mul_f32 v17, s83, v17
  v_fma_f32 v136, v136, s83, -v17
  v_mfma_f32_16x16x32_bf16 v[88:91], v[48:51], a[156:159], v[88:91]
  s_waitcnt lgkmcnt(3)
  v_fma_f32 v137, v137, s83, -v17
  v_fma_f32 v138, v138, s83, -v17
  v_mfma_f32_16x16x32_bf16 v[76:79], a[160:163], v[52:55], v[76:79]
  ds_read_b128 v[36:39], v7 offset:30720
  v_fma_f32 v139, v139, s83, -v17
  v_mfma_f32_16x16x32_bf16 v[80:83], a[164:167], v[52:55], v[80:83]
  v_exp_f32 v136, v136
  v_mfma_f32_16x16x32_bf16 v[84:87], a[168:171], v[52:55], v[84:87]
  v_exp_f32 v137, v137
  v_mfma_f32_16x16x32_bf16 v[88:91], v[52:55], a[172:175], v[88:91]
  s_waitcnt lgkmcnt(3)
  v_exp_f32 v138, v138
  v_mfma_f32_16x16x32_bf16 v[76:79], a[176:179], v[56:59], v[76:79]
  ds_read_b128 v[40:43], v8 offset:30720
  v_mfma_f32_16x16x32_bf16 v[80:83], a[180:183], v[56:59], v[80:83]
  v_exp_f32 v139, v139
  v_mfma_f32_16x16x32_bf16 v[84:87], a[184:187], v[56:59], v[84:87]
  v_add_f32 v17, v136, v137
  v_add_f32 v18, v138, v139
  v_mfma_f32_16x16x32_bf16 v[88:91], v[56:59], a[188:191], v[88:91]
  s_waitcnt lgkmcnt(3)
  v_add_f32 v17, v17, v18
  v_mov_b32 v18, v17
  v_mfma_f32_16x16x32_bf16 v[76:79], a[192:195], v[28:31], v[76:79]
  ds_read_b128 v[44:47], v7 offset:34816
  v_permlane32_swap_b32 v17, v18
  v_mfma_f32_16x16x32_bf16 v[80:83], a[196:199], v[28:31], v[80:83]
  v_add_f32 v17, v17, v18
  v_mov_b32 v18, v17
  v_mfma_f32_16x16x32_bf16 v[84:87], a[200:203], v[28:31], v[84:87]
  v_permlane16_swap_b32 v17, v18
  v_add_f32 v17, v17, v18
  v_mfma_f32_16x16x32_bf16 v[88:91], v[28:31], a[204:207], v[88:91]
  s_waitcnt lgkmcnt(3)
  v_rcp_f32 v17, v17
  v_mfma_f32_16x16x32_bf16 v[76:79], a[208:211], v[32:35], v[76:79]
  ds_read_b128 v[48:51], v8 offset:34816
  v_mul_f32 v136, v136, v17
  v_mfma_f32_16x16x32_bf16 v[80:83], a[212:215], v[32:35], v[80:83]
  v_mul_f32 v137, v137, v17
  v_mul_f32 v138, v138, v17
  v_mfma_f32_16x16x32_bf16 v[84:87], a[216:219], v[32:35], v[84:87]
  v_mul_f32 v139, v139, v17
  v_cvt_pk_bf16_f32 v144, v136, v137
  v_mfma_f32_16x16x32_bf16 v[88:91], v[32:35], a[220:223], v[88:91]
  s_waitcnt lgkmcnt(3)
  v_cvt_pk_bf16_f32 v145, v138, v139
  v_and_b32 v146, v144, v22
  v_mfma_f32_16x16x32_bf16 v[76:79], a[224:227], v[36:39], v[76:79]
  ds_read_b128 v[52:55], v7 offset:38912
  v_and_b32 v147, v145, v23
  v_mfma_f32_16x16x32_bf16 v[80:83], a[228:231], v[36:39], v[80:83]
  v_and_b32 v144, v144, v20
  v_and_b32 v145, v145, v21
  v_mfma_f32_16x16x32_bf16 v[84:87], a[232:235], v[36:39], v[84:87]
  s_cmp_ge_u32 s31, 122880
  s_cselect_b32 s21, 122880, 0
  s_sub_u32 s31, s31, s21
  v_mfma_f32_16x16x32_bf16 v[88:91], v[36:39], a[236:239], v[88:91]
  s_add_u32 s33, s33, 40960
  s_waitcnt lgkmcnt(3)
  v_mfma_f32_16x16x32_bf16 v[76:79], a[240:243], v[40:43], v[76:79]
  ds_read_b128 v[56:59], v8 offset:38912
  v_mfma_f32_16x16x32_bf16 v[80:83], a[244:247], v[40:43], v[80:83]
  s_cmp_ge_u32 s33, 122880
  s_cselect_b32 s33, 0, s33
  v_mfma_f32_16x16x32_bf16 v[84:87], a[248:251], v[40:43], v[84:87]
  v_add_u32 v7, s33, v5
  v_add_u32 v8, s33, v6
  v_mfma_f32_16x16x32_bf16 v[88:91], v[40:43], a[252:255], v[88:91]
  s_waitcnt lgkmcnt(3)
  v_mfma_f32_16x16x32_bf16 v[76:79], v[192:195], v[44:47], v[76:79]
  s_waitcnt vmcnt(12)
  s_barrier
  ds_read_b128 v[28:31], v7 offset:0
  v_mfma_f32_16x16x32_bf16 v[80:83], v[196:199], v[44:47], v[80:83]
  v_mfma_f32_16x16x32_bf16 v[84:87], v[200:203], v[44:47], v[84:87]
  v_mfma_f32_16x16x32_bf16 v[88:91], v[44:47], v[204:207], v[88:91]
  v_mfma_f32_16x16x32_bf16 v[148:151], v[108:111], v[144:147], 0
  v_mfma_f32_16x16x32_bf16 v[152:155], v[112:115], v[144:147], 0
  s_waitcnt lgkmcnt(3)
  v_mov_b32 v96, v92
  v_mov_b32 v97, v93
  v_mfma_f32_16x16x32_bf16 v[76:79], v[208:211], v[48:51], v[76:79]
  ds_read_b128 v[32:35], v8 offset:0
  v_mov_b32 v98, v94
  v_mfma_f32_16x16x32_bf16 v[80:83], v[212:215], v[48:51], v[80:83]
  v_mov_b32 v99, v95
  v_mov_b32 v110, v108
  v_mfma_f32_16x16x32_bf16 v[84:87], v[216:219], v[48:51], v[84:87]
  v_cvt_pk_bf16_f32 v156, v148, v149
  v_cvt_pk_bf16_f32 v157, v150, v151
  v_mfma_f32_16x16x32_bf16 v[88:91], v[48:51], v[220:223], v[88:91]
  s_waitcnt lgkmcnt(3)
  ds_write_b64 v9, v[156:157] offset:0
  v_cvt_pk_bf16_f32 v158, v152, v153
  v_mfma_f32_16x16x32_bf16 v[76:79], v[224:227], v[52:55], v[76:79]
  ds_read_b128 v[36:39], v7 offset:4096
  v_cvt_pk_bf16_f32 v159, v154, v155
  v_mfma_f32_16x16x32_bf16 v[80:83], v[228:231], v[52:55], v[80:83]
  ds_write_b64 v10, v[158:159] offset:0
  v_mov_b32 v111, v109
  v_mfma_f32_16x16x32_bf16 v[84:87], v[232:235], v[52:55], v[84:87]
  v_mov_b32 v114, v112
  v_mov_b32 v115, v113
  v_mfma_f32_16x16x32_bf16 v[88:91], v[52:55], v[236:239], v[88:91]
  s_waitcnt lgkmcnt(5)
  v_mfma_f32_16x16x32_bf16 v[76:79], v[240:243], v[56:59], v[76:79]
  ds_read_b128 v[40:43], v8 offset:4096
  v_mfma_f32_16x16x32_bf16 v[80:83], v[244:247], v[56:59], v[80:83]
  v_mfma_f32_16x16x32_bf16 v[84:87], v[248:251], v[56:59], v[84:87]
  s_cmp_gt_u32 s26, 0
  v_mfma_f32_16x16x32_bf16 v[88:91], v[56:59], v[252:255], v[88:91]
  s_waitcnt lgkmcnt(5)
  s_cbranch_scc1 bfl_221
  s_nop 7
  v_cvt_pk_bf16_f32 v128, v84, v85
  v_cvt_pk_bf16_f32 v129, v86, v87
  v_cvt_pk_bf16_f32 v124, v76, v77
  v_cvt_pk_bf16_f32 v125, v78, v79
  v_cvt_pk_bf16_f32 v100, v80, v81
  v_cvt_pk_bf16_f32 v101, v82, v83
  v_cvt_pk_bf16_f32 v116, v88, v89
  v_cvt_pk_bf16_f32 v117, v90, v91
  v_cndmask_b32 v126, 0, v128, s[62:63]
  v_cndmask_b32 v127, 0, v129, s[62:63]
  s_nop 1
  v_mfma_f32_16x16x32_bf16 v[132:135], v[128:131], v[24:27], 0
  s_nop 7
  v_permlane16_swap_b32 v128, v102
  v_permlane16_swap_b32 v129, v103
  s_nop 1
  v_mfma_f32_16x16x32_bf16 v[136:139], v[100:103], v[124:127], 0
  v_mfma_f32_16x16x32_bf16 v[140:143], v[104:107], v[124:127], 0
  s_nop 7
  v_cvt_pk_bf16_f32 v120, v132, v133
  v_cvt_pk_bf16_f32 v121, v134, v135
  v_cndmask_b32 v136, v136, v140, s[64:65]
  v_cndmask_b32 v137, v137, v141, s[66:67]
  v_cndmask_b32 v138, v138, v142, s[68:69]
  v_cndmask_b32 v139, v139, v143, s[70:71]
  v_cvt_pk_bf16_f32 v17, v136, v137
  v_lshlrev_b32 v136, 16, v17
  v_and_b32 v137, 0xffff0000, v17
  v_cvt_pk_bf16_f32 v17, v138, v139
  v_lshlrev_b32 v138, 16, v17
  v_and_b32 v139, 0xffff0000, v17
  v_mul_f32 v136, s82, v136
  v_mul_f32 v137, s82, v137
  v_mul_f32 v138, s82, v138
  v_mul_f32 v139, s82, v139
  v_cvt_pk_bf16_f32 v17, v136, v137
  v_lshlrev_b32 v136, 16, v17
  v_and_b32 v137, 0xffff0000, v17
  v_cvt_pk_bf16_f32 v17, v138, v139
  v_lshlrev_b32 v138, 16, v17
  v_and_b32 v139, 0xffff0000, v17
  v_cndmask_b32 v136, v16, v136, s[54:55]
  v_cndmask_b32 v137, v16, v137, s[56:57]
  v_cndmask_b32 v138, v16, v138, s[58:59]
  v_cndmask_b32 v139, v16, v139, s[60:61]
  v_max3_f32 v17, v136, v137, v138
  v_max_f32 v17, v17, v139
  v_mov_b32 v18, v17
  s_nop 1
  v_permlane32_swap_b32 v17, v18
  v_max_f32 v17, v17, v18
  v_mov_b32 v18, v17
  s_nop 1
  v_permlane16_swap_b32 v17, v18
  v_max_f32 v17, v17, v18
  v_mul_f32 v17, s83, v17
  v_fma_f32 v136, v136, s83, -v17
  v_fma_f32 v137, v137, s83, -v17
  v_fma_f32 v138, v138, s83, -v17
  v_fma_f32 v139, v139, s83, -v17
  v_exp_f32 v136, v136
  v_exp_f32 v137, v137
  v_exp_f32 v138, v138
  v_exp_f32 v139, v139
  s_nop 1
  v_add_f32 v17, v136, v137
  v_add_f32 v18, v138, v139
  v_add_f32 v17, v17, v18
  v_mov_b32 v18, v17
  s_nop 1
  v_permlane32_swap_b32 v17, v18
  v_add_f32 v17, v17, v18
  v_mov_b32 v18, v17
  s_nop 1
  v_permlane16_swap_b32 v17, v18
  v_add_f32 v17, v17, v18
  v_rcp_f32 v17, v17
  s_nop 1
  v_mul_f32 v136, v136, v17
  v_mul_f32 v137, v137, v17
  v_mul_f32 v138, v138, v17
  v_mul_f32 v139, v139, v17
  v_cvt_pk_bf16_f32 v144, v136, v137
  v_cvt_pk_bf16_f32 v145, v138, v139
  v_and_b32 v146, v144, v22
  v_and_b32 v147, v145, v23
  v_and_b32 v144, v144, v20
  v_and_b32 v145, v145, v21
  s_nop 1
  v_mfma_f32_16x16x32_bf16 v[148:151], v[116:119], v[144:147], 0
  v_mfma_f32_16x16x32_bf16 v[152:155], v[120:123], v[144:147], 0
  s_nop 7
  v_mov_b32 v104, v100
  v_mov_b32 v105, v101
  v_mov_b32 v106, v102
  v_mov_b32 v107, v103
  v_mov_b32 v118, v116
  v_mov_b32 v119, v117
  v_mov_b32 v122, v120
  v_mov_b32 v123, v121
  v_cvt_pk_bf16_f32 v156, v148, v149
  v_cvt_pk_bf16_f32 v157, v150, v151
  ds_write_b64 v9, v[156:157] offset:16
  v_cvt_pk_bf16_f32 v158, v152, v153
  v_cvt_pk_bf16_f32 v159, v154, v155
  ds_write_b64 v10, v[158:159] offset:8
  s_waitcnt lgkmcnt(0)
  s_barrier
  ds_read_b128 v[160:163], v11
  ds_read_b128 v[164:167], v12
  s_waitcnt lgkmcnt(0)
  buffer_store_dwordx4 v[160:163], v15, s[16:19], s49 offen sc1
  buffer_store_dwordx4 v[164:167], v14, s[16:19], s49 offen sc1
  s_waitcnt vmcnt(0)
  s_barrier
  s_lshl_b32 s21, s42, 7
  s_add_u32 s21, s21, 29696
  s_xor_b32 s21, s21, s80
  s_cmp_lg_u32 s20, 0
  s_cbranch_scc1 af_222
  v_mov_b32 v8, 0
  v_mov_b32 v9, 1
  s_mov_b64 exec, 1
  buffer_atomic_add v9, v8, s[72:75], s21 offen sc1
  s_mov_b64 exec, -1
  s_nop 1
af_222:
  s_barrier
  s_sub_u32 s2, s3, 96
  s_load_dwordx2 s[4:5], s[0:1], 0
  s_load_dwordx2 s[6:7], s[0:1], 16
  s_load_dwordx2 s[38:39], s[0:1], 104
  s_mov_b32 s42, s2
  s_waitcnt lgkmcnt(0)
  s_mov_b32 s8, s4
  s_mov_b32 s9, s5
  s_mov_b32 s10, 2621440
  s_mov_b32 s11, 0x00020000
  s_mov_b32 s12, s6
  s_mov_b32 s13, s7
  s_mov_b32 s14, 7864320
  s_mov_b32 s15, 0x00020000
  s_mov_b32 s16, s38
  s_mov_b32 s17, s39
  s_mov_b32 s18, 167772160
  s_mov_b32 s19, 0x00020000
  s_add_u32 s72, s38, 168886272
  s_addc_u32 s73, s39, 0
  s_mov_b32 s74, 49152
  s_mov_b32 s75, 0x00020000
  s_mul_i32 s44, s42, 384
  s_load_dwordx2 s[36:37], s[0:1], 80
  s_waitcnt lgkmcnt(0)
  s_mov_b32 s24, s36
  s_mov_b32 s25, s37
  s_mov_b32 s26, 1280
  s_mov_b32 s27, 0x00020000
  s_add_u32 s76, s38, 170917888
  s_addc_u32 s77, s39, 0
  s_mov_b32 s78, 8192
  s_mov_b32 s79, 0x00020000
  s_lshl_b32 s59, s2, 2
  s_add_u32 s59, s59, s20
  s_lshl_b32 s59, s59, 4
  v_lshlrev_b32 v10, 2, v1
  v_lshlrev_b32 v11, 4, v1
  s_mul_i32 s22, s59, 1280
  buffer_load_dwordx4 v[12:15], v11, s[24:27], 0 offen
  buffer_load_dword v16, v10, s[24:27], 0 offen offset:1024
  buffer_load_dwordx4 v[192:195], v11, s[8:11], s22 offen
  buffer_load_dword v48, v10, s[8:11], s22 offen offset:1024
  s_add_u32 s22, s22, 1280
  buffer_load_dwordx4 v[196:199], v11, s[8:11], s22 offen
  buffer_load_dword v49, v10, s[8:11], s22 offen offset:1024
  s_add_u32 s22, s22, 1280
  buffer_load_dwordx4 v[200:203], v11, s[8:11], s22 offen
  buffer_load_dword v50, v10, s[8:11], s22 offen offset:1024
  s_add_u32 s22, s22, 1280
  buffer_load_dwordx4 v[204:207], v11, s[8:11], s22 offen
  buffer_load_dword v51, v10, s[8:11], s22 offen offset:1024
  s_add_u32 s22, s22, 1280
  buffer_load_dwordx4 v[208:211], v11, s[8:11], s22 offen
  buffer_load_dword v52, v10, s[8:11], s22 offen offset:1024
  s_add_u32 s22, s22, 1280
  buffer_load_dwordx4 v[212:215], v11, s[8:11], s22 offen
  buffer_load_dword v53, v10, s[8:11], s22 offen offset:1024
  s_add_u32 s22, s22, 1280
  buffer_load_dwordx4 v[216:219], v11, s[8:11], s22 offen
  buffer_load_dword v54, v10, s[8:11], s22 offen offset:1024
  s_add_u32 s22, s22, 1280
  buffer_load_dwordx4 v[220:223], v11, s[8:11], s22 offen
  buffer_load_dword v55, v10, s[8:11], s22 offen offset:1024
  s_add_u32 s22, s22, 1280
  buffer_load_dwordx4 v[224:227], v11, s[8:11], s22 offen
  buffer_load_dword v56, v10, s[8:11], s22 offen offset:1024
  s_add_u32 s22, s22, 1280
  buffer_load_dwordx4 v[228:231], v11, s[8:11], s22 offen
  buffer_load_dword v57, v10, s[8:11], s22 offen offset:1024
  s_add_u32 s22, s22, 1280
  buffer_load_dwordx4 v[232:235], v11, s[8:11], s22 offen
  buffer_load_dword v58, v10, s[8:11], s22 offen offset:1024
  s_add_u32 s22, s22, 1280
  buffer_load_dwordx4 v[236:239], v11, s[8:11], s22 offen
  buffer_load_dword v59, v10, s[8:11], s22 offen offset:1024
  s_add_u32 s22, s22, 1280
  buffer_load_dwordx4 v[240:243], v11, s[8:11], s22 offen
  buffer_load_dword v60, v10, s[8:11], s22 offen offset:1024
  s_add_u32 s22, s22, 1280
  buffer_load_dwordx4 v[244:247], v11, s[8:11], s22 offen
  buffer_load_dword v61, v10, s[8:11], s22 offen offset:1024
  s_add_u32 s22, s22, 1280
  buffer_load_dwordx4 v[248:251], v11, s[8:11], s22 offen
  buffer_load_dword v62, v10, s[8:11], s22 offen offset:1024
  s_add_u32 s22, s22, 1280
  buffer_load_dwordx4 v[252:255], v11, s[8:11], s22 offen
  buffer_load_dword v63, v10, s[8:11], s22 offen offset:1024
  s_add_u32 s22, s22, 1280
  s_waitcnt vmcnt(30)
  v_mov_b32 v9, 2731
  v_add_u32 v8, 0, v1
  v_mul_u32_u24 v7, v8, v9
  v_lshrrev_b32 v7, 16, v7
  v_mul_u32_u24 v4, 24, v7
  v_sub_u32 v8, v8, v4
  s_mov_b32 s21, 12288
  v_mul_lo_u32 v7, v7, s21
  v_lshl_add_u32 v4, v8, 4, v7
  v_add_u32 v8, 64, v1
  v_mul_u32_u24 v7, v8, v9
  v_lshrrev_b32 v7, 16, v7
  v_mul_u32_u24 v5, 24, v7
  v_sub_u32 v8, v8, v5
  s_mov_b32 s21, 12288
  v_mul_lo_u32 v7, v7, s21
  v_lshl_add_u32 v5, v8, 4, v7
  v_add_u32 v8, 128, v1
  v_mul_u32_u24 v7, v8, v9
  v_lshrrev_b32 v7, 16, v7
  v_mul_u32_u24 v6, 24, v7
  v_sub_u32 v8, v8, v6
  s_mov_b32 s21, 12288
  v_mul_lo_u32 v7, v7, s21
  v_lshl_add_u32 v6, v8, 4, v7
  v_lshrrev_b32 v7, 2, v2
  v_lshl_add_u32 v7, v3, 3, v7
  v_mul_u32_u24 v7, 384, v7
  v_and_b32 v8, 3, v2
  v_lshlrev_b32 v8, 3, v8
  s_mul_i32 s21, s20, 96
  v_add3_u32 v7, v7, v8, s21
  v_add_u32 v8, 61440, v7
  s_mul_i32 s21, s20, 491520
  s_add_u32 s21, s21, 0
  s_add_u32 s21, s21, s44
  s_mul_i32 s22, s20, 15360
  s_add_u32 s22, s22, 0
  s_add_u32 m0, s22, 0
  s_nop 0
  buffer_load_dwordx4 v4, s[12:15], s21 offen lds
  s_add_u32 m0, s22, 1024
  s_nop 0
  buffer_load_dwordx4 v5, s[12:15], s21 offen lds
  s_add_u32 m0, s22, 2048
  s_nop 0
  buffer_load_dwordx4 v6, s[12:15], s21 offen lds
  s_mul_i32 s21, s20, 491520
  s_add_u32 s21, s21, 98304
  s_add_u32 s21, s21, s44
  s_mul_i32 s22, s20, 15360
  s_add_u32 s22, s22, 3072
  s_add_u32 m0, s22, 0
  s_nop 0
  buffer_load_dwordx4 v4, s[12:15], s21 offen lds
  s_add_u32 m0, s22, 1024
  s_nop 0
  buffer_load_dwordx4 v5, s[12:15], s21 offen lds
  s_add_u32 m0, s22, 2048
  s_nop 0
  buffer_load_dwordx4 v6, s[12:15], s21 offen lds
  s_mul_i32 s21, s20, 491520
  s_add_u32 s21, s21, 196608
  s_add_u32 s21, s21, s44
  s_mul_i32 s22, s20, 15360
  s_add_u32 s22, s22, 6144
  s_add_u32 m0, s22, 0
  s_nop 0
  buffer_load_dwordx4 v4, s[12:15], s21 offen lds
  s_add_u32 m0, s22, 1024
  s_nop 0
  buffer_load_dwordx4 v5, s[12:15], s21 offen lds
  s_add_u32 m0, s22, 2048
  s_nop 0
  buffer_load_dwordx4 v6, s[12:15], s21 offen lds
  s_mul_i32 s21, s20, 491520
  s_add_u32 s21, s21, 294912
  s_add_u32 s21, s21, s44
  s_mul_i32 s22, s20, 15360
  s_add_u32 s22, s22, 9216
  s_add_u32 m0, s22, 0
  s_nop 0
  buffer_load_dwordx4 v4, s[12:15], s21 offen lds
  s_add_u32 m0, s22, 1024
  s_nop 0
  buffer_load_dwordx4 v5, s[12:15], s21 offen lds
  s_add_u32 m0, s22, 2048
  s_nop 0
  buffer_load_dwordx4 v6, s[12:15], s21 offen lds
  s_mul_i32 s21, s20, 491520
  s_add_u32 s21, s21, 393216
  s_add_u32 s21, s21, s44
  s_mul_i32 s22, s20, 15360
  s_add_u32 s22, s22, 12288
  s_add_u32 m0, s22, 0
  s_nop 0
  buffer_load_dwordx4 v4, s[12:15], s21 offen lds
  s_add_u32 m0, s22, 1024
  s_nop 0
  buffer_load_dwordx4 v5, s[12:15], s21 offen lds
  s_add_u32 m0, s22, 2048
  s_nop 0
  buffer_load_dwordx4 v6, s[12:15], s21 offen lds
  s_mul_i32 s21, s20, 491520
  s_add_u32 s21, s21, 1966080
  s_add_u32 s21, s21, s44
  s_mul_i32 s22, s20, 15360
  s_add_u32 s22, s22, 61440
  s_add_u32 m0, s22, 0
  s_nop 0
  buffer_load_dwordx4 v4, s[12:15], s21 offen lds
  s_add_u32 m0, s22, 1024
  s_nop 0
  buffer_load_dwordx4 v5, s[12:15], s21 offen lds
  s_add_u32 m0, s22, 2048
  s_nop 0
  buffer_load_dwordx4 v6, s[12:15], s21 offen lds
  s_mul_i32 s21, s20, 491520
  s_add_u32 s21, s21, 2064384
  s_add_u32 s21, s21, s44
  s_mul_i32 s22, s20, 15360
  s_add_u32 s22, s22, 64512
  s_add_u32 m0, s22, 0
  s_nop 0
  buffer_load_dwordx4 v4, s[12:15], s21 offen lds
  s_add_u32 m0, s22, 1024
  s_nop 0
  buffer_load_dwordx4 v5, s[12:15], s21 offen lds
  s_add_u32 m0, s22, 2048
  s_nop 0
  buffer_load_dwordx4 v6, s[12:15], s21 offen lds
  s_mul_i32 s21, s20, 491520
  s_add_u32 s21, s21, 2162688
  s_add_u32 s21, s21, s44
  s_mul_i32 s22, s20, 15360
  s_add_u32 s22, s22, 67584
  s_add_u32 m0, s22, 0
  s_nop 0
  buffer_load_dwordx4 v4, s[12:15], s21 offen lds
  s_add_u32 m0, s22, 1024
  s_nop 0
  buffer_load_dwordx4 v5, s[12:15], s21 offen lds
  s_add_u32 m0, s22, 2048
  s_nop 0
  buffer_load_dwordx4 v6, s[12:15], s21 offen lds
  s_mul_i32 s21, s20, 491520
  s_add_u32 s21, s21, 2260992
  s_add_u32 s21, s21, s44
  s_mul_i32 s22, s20, 15360
  s_add_u32 s22, s22, 70656
  s_add_u32 m0, s22, 0
  s_nop 0
  buffer_load_dwordx4 v4, s[12:15], s21 offen lds
  s_add_u32 m0, s22, 1024
  s_nop 0
  buffer_load_dwordx4 v5, s[12:15], s21 offen lds
  s_add_u32 m0, s22, 2048
  s_nop 0
  buffer_load_dwordx4 v6, s[12:15], s21 offen lds
  s_mul_i32 s21, s20, 491520
  s_add_u32 s21, s21, 2359296
  s_add_u32 s21, s21, s44
  s_mul_i32 s22, s20, 15360
  s_add_u32 s22, s22, 73728
  s_add_u32 m0, s22, 0
  s_nop 0
  buffer_load_dwordx4 v4, s[12:15], s21 offen lds
  s_add_u32 m0, s22, 1024
  s_nop 0
  buffer_load_dwordx4 v5, s[12:15], s21 offen lds
  s_add_u32 m0, s22, 2048
  s_nop 0
  buffer_load_dwordx4 v6, s[12:15], s21 offen lds
  s_waitcnt vmcnt(30)
  s_mul_i32 s21, s20, 491520
  s_add_u32 s21, s21, 3932160
  s_add_u32 s21, s21, s44
  buffer_load_dwordx4 v[64:67], v4, s[12:15], s21 offen
  buffer_load_dwordx4 v[68:71], v5, s[12:15], s21 offen
  buffer_load_dwordx4 v[72:75], v6, s[12:15], s21 offen
  s_mul_i32 s21, s20, 491520
  s_add_u32 s21, s21, 4030464
  s_add_u32 s21, s21, s44
  buffer_load_dwordx4 v[76:79], v4, s[12:15], s21 offen
  buffer_load_dwordx4 v[80:83], v5, s[12:15], s21 offen
  buffer_load_dwordx4 v[84:87], v6, s[12:15], s21 offen
  s_mul_i32 s21, s20, 491520
  s_add_u32 s21, s21, 4128768
  s_add_u32 s21, s21, s44
  buffer_load_dwordx4 v[88:91], v4, s[12:15], s21 offen
  buffer_load_dwordx4 v[92:95], v5, s[12:15], s21 offen
  buffer_load_dwordx4 v[96:99], v6, s[12:15], s21 offen
  s_mul_i32 s21, s20, 491520
  s_add_u32 s21, s21, 4227072
  s_add_u32 s21, s21, s44
  buffer_load_dwordx4 v[100:103], v4, s[12:15], s21 offen
  buffer_load_dwordx4 v[104:107], v5, s[12:15], s21 offen
  buffer_load_dwordx4 v[108:111], v6, s[12:15], s21 offen
  s_mul_i32 s21, s20, 491520
  s_add_u32 s21, s21, 4325376
  s_add_u32 s21, s21, s44
  buffer_load_dwordx4 v[112:115], v4, s[12:15], s21 offen
  buffer_load_dwordx4 v[116:119], v5, s[12:15], s21 offen
  buffer_load_dwordx4 v[120:123], v6, s[12:15], s21 offen
  s_mul_i32 s21, s20, 491520
  s_add_u32 s21, s21, 5898240
  s_add_u32 s21, s21, s44
  buffer_load_dwordx4 v[124:127], v4, s[12:15], s21 offen
  buffer_load_dwordx4 v[128:131], v5, s[12:15], s21 offen
  buffer_load_dwordx4 v[132:135], v6, s[12:15], s21 offen
  s_mul_i32 s21, s20, 491520
  s_add_u32 s21, s21, 5996544
  s_add_u32 s21, s21, s44
  buffer_load_dwordx4 v[136:139], v4, s[12:15], s21 offen
  buffer_load_dwordx4 v[140:143], v5, s[12:15], s21 offen
  buffer_load_dwordx4 v[144:147], v6, s[12:15], s21 offen
  s_mul_i32 s21, s20, 491520
  s_add_u32 s21, s21, 6094848
  s_add_u32 s21, s21, s44
  buffer_load_dwordx4 v[148:151], v4, s[12:15], s21 offen
  buffer_load_dwordx4 v[152:155], v5, s[12:15], s21 offen
  buffer_load_dwordx4 v[156:159], v6, s[12:15], s21 offen
  s_mul_i32 s21, s20, 491520
  s_add_u32 s21, s21, 6193152
  s_add_u32 s21, s21, s44
  buffer_load_dwordx4 v[160:163], v4, s[12:15], s21 offen
  buffer_load_dwordx4 v[164:167], v5, s[12:15], s21 offen
  buffer_load_dwordx4 v[168:171], v6, s[12:15], s21 offen
  s_mul_i32 s21, s20, 491520
  s_add_u32 s21, s21, 6291456
  s_add_u32 s21, s21, s44
  buffer_load_dwordx4 v[172:175], v4, s[12:15], s21 offen
  buffer_load_dwordx4 v[176:179], v5, s[12:15], s21 offen
  buffer_load_dwordx4 v[180:183], v6, s[12:15], s21 offen
  s_mul_i32 s22, s20, 15360
  v_lshl_add_u32 v30, v1, 4, s22
  v_add_u32 v31, 61440, v30
  v_lshlrev_b32 v17, 16, v12
  v_and_b32 v12, 0xffff0000, v12
  v_lshlrev_b32 v18, 16, v13
  v_and_b32 v13, 0xffff0000, v13
  v_lshlrev_b32 v19, 16, v14
  v_and_b32 v14, 0xffff0000, v14
  v_lshlrev_b32 v20, 16, v15
  v_and_b32 v15, 0xffff0000, v15
  v_lshlrev_b32 v21, 16, v16
  v_and_b32 v16, 0xffff0000, v16
  v_mov_b32 v32, 0
  v_lshlrev_b32 v25, 16, v192
  v_and_b32 v26, 0xffff0000, v192
  v_mul_f32 v25, v25, v17
  v_mul_f32 v26, v26, v12
  v_cvt_pk_bf16_f32 v25, v25, v26
  v_lshlrev_b32 v26, 16, v25
  v_and_b32 v25, 0xffff0000, v25
  v_add_f32 v32, v32, v26
  v_add_f32 v32, v32, v25
  v_lshlrev_b32 v25, 16, v193
  v_and_b32 v26, 0xffff0000, v193
  v_mul_f32 v25, v25, v18
  v_mul_f32 v26, v26, v13
  v_cvt_pk_bf16_f32 v25, v25, v26
  v_lshlrev_b32 v26, 16, v25
  v_and_b32 v25, 0xffff0000, v25
  v_add_f32 v32, v32, v26
  v_add_f32 v32, v32, v25
  v_lshlrev_b32 v25, 16, v194
  v_and_b32 v26, 0xffff0000, v194
  v_mul_f32 v25, v25, v19
  v_mul_f32 v26, v26, v14
  v_cvt_pk_bf16_f32 v25, v25, v26
  v_lshlrev_b32 v26, 16, v25
  v_and_b32 v25, 0xffff0000, v25
  v_add_f32 v32, v32, v26
  v_add_f32 v32, v32, v25
  v_lshlrev_b32 v25, 16, v195
  v_and_b32 v26, 0xffff0000, v195
  v_mul_f32 v25, v25, v20
  v_mul_f32 v26, v26, v15
  v_cvt_pk_bf16_f32 v25, v25, v26
  v_lshlrev_b32 v26, 16, v25
  v_and_b32 v25, 0xffff0000, v25
  v_add_f32 v32, v32, v26
  v_add_f32 v32, v32, v25
  v_lshlrev_b32 v25, 16, v48
  v_and_b32 v26, 0xffff0000, v48
  v_mul_f32 v25, v25, v21
  v_mul_f32 v26, v26, v16
  v_cvt_pk_bf16_f32 v25, v25, v26
  v_lshlrev_b32 v26, 16, v25
  v_and_b32 v25, 0xffff0000, v25
  v_add_f32 v32, v32, v26
  v_add_f32 v32, v32, v25
  v_mov_b32 v33, 0
  v_lshlrev_b32 v25, 16, v196
  v_and_b32 v26, 0xffff0000, v196
  v_mul_f32 v25, v25, v17
  v_mul_f32 v26, v26, v12
  v_cvt_pk_bf16_f32 v25, v25, v26
  v_lshlrev_b32 v26, 16, v25
  v_and_b32 v25, 0xffff0000, v25
  v_add_f32 v33, v33, v26
  v_add_f32 v33, v33, v25
  v_lshlrev_b32 v25, 16, v197
  v_and_b32 v26, 0xffff0000, v197
  v_mul_f32 v25, v25, v18
  v_mul_f32 v26, v26, v13
  v_cvt_pk_bf16_f32 v25, v25, v26
  v_lshlrev_b32 v26, 16, v25
  v_and_b32 v25, 0xffff0000, v25
  v_add_f32 v33, v33, v26
  v_add_f32 v33, v33, v25
  v_lshlrev_b32 v25, 16, v198
  v_and_b32 v26, 0xffff0000, v198
  v_mul_f32 v25, v25, v19
  v_mul_f32 v26, v26, v14
  v_cvt_pk_bf16_f32 v25, v25, v26
  v_lshlrev_b32 v26, 16, v25
  v_and_b32 v25, 0xffff0000, v25
  v_add_f32 v33, v33, v26
  v_add_f32 v33, v33, v25
  v_lshlrev_b32 v25, 16, v199
  v_and_b32 v26, 0xffff0000, v199
  v_mul_f32 v25, v25, v20
  v_mul_f32 v26, v26, v15
  v_cvt_pk_bf16_f32 v25, v25, v26
  v_lshlrev_b32 v26, 16, v25
  v_and_b32 v25, 0xffff0000, v25
  v_add_f32 v33, v33, v26
  v_add_f32 v33, v33, v25
  v_lshlrev_b32 v25, 16, v49
  v_and_b32 v26, 0xffff0000, v49
  v_mul_f32 v25, v25, v21
  v_mul_f32 v26, v26, v16
  v_cvt_pk_bf16_f32 v25, v25, v26
  v_lshlrev_b32 v26, 16, v25
  v_and_b32 v25, 0xffff0000, v25
  v_add_f32 v33, v33, v26
  v_add_f32 v33, v33, v25
  v_mov_b32 v34, 0
  v_lshlrev_b32 v25, 16, v200
  v_and_b32 v26, 0xffff0000, v200
  v_mul_f32 v25, v25, v17
  v_mul_f32 v26, v26, v12
  v_cvt_pk_bf16_f32 v25, v25, v26
  v_lshlrev_b32 v26, 16, v25
  v_and_b32 v25, 0xffff0000, v25
  v_add_f32 v34, v34, v26
  v_add_f32 v34, v34, v25
  v_lshlrev_b32 v25, 16, v201
  v_and_b32 v26, 0xffff0000, v201
  v_mul_f32 v25, v25, v18
  v_mul_f32 v26, v26, v13
  v_cvt_pk_bf16_f32 v25, v25, v26
  v_lshlrev_b32 v26, 16, v25
  v_and_b32 v25, 0xffff0000, v25
  v_add_f32 v34, v34, v26
  v_add_f32 v34, v34, v25
  v_lshlrev_b32 v25, 16, v202
  v_and_b32 v26, 0xffff0000, v202
  v_mul_f32 v25, v25, v19
  v_mul_f32 v26, v26, v14
  v_cvt_pk_bf16_f32 v25, v25, v26
  v_lshlrev_b32 v26, 16, v25
  v_and_b32 v25, 0xffff0000, v25
  v_add_f32 v34, v34, v26
  v_add_f32 v34, v34, v25
  v_lshlrev_b32 v25, 16, v203
  v_and_b32 v26, 0xffff0000, v203
  v_mul_f32 v25, v25, v20
  v_mul_f32 v26, v26, v15
  v_cvt_pk_bf16_f32 v25, v25, v26
  v_lshlrev_b32 v26, 16, v25
  v_and_b32 v25, 0xffff0000, v25
  v_add_f32 v34, v34, v26
  v_add_f32 v34, v34, v25
  v_lshlrev_b32 v25, 16, v50
  v_and_b32 v26, 0xffff0000, v50
  v_mul_f32 v25, v25, v21
  v_mul_f32 v26, v26, v16
  v_cvt_pk_bf16_f32 v25, v25, v26
  v_lshlrev_b32 v26, 16, v25
  v_and_b32 v25, 0xffff0000, v25
  v_add_f32 v34, v34, v26
  v_add_f32 v34, v34, v25
  v_mov_b32 v35, 0
  v_lshlrev_b32 v25, 16, v204
  v_and_b32 v26, 0xffff0000, v204
  v_mul_f32 v25, v25, v17
  v_mul_f32 v26, v26, v12
  v_cvt_pk_bf16_f32 v25, v25, v26
  v_lshlrev_b32 v26, 16, v25
  v_and_b32 v25, 0xffff0000, v25
  v_add_f32 v35, v35, v26
  v_add_f32 v35, v35, v25
  v_lshlrev_b32 v25, 16, v205
  v_and_b32 v26, 0xffff0000, v205
  v_mul_f32 v25, v25, v18
  v_mul_f32 v26, v26, v13
  v_cvt_pk_bf16_f32 v25, v25, v26
  v_lshlrev_b32 v26, 16, v25
  v_and_b32 v25, 0xffff0000, v25
  v_add_f32 v35, v35, v26
  v_add_f32 v35, v35, v25
  v_lshlrev_b32 v25, 16, v206
  v_and_b32 v26, 0xffff0000, v206
  v_mul_f32 v25, v25, v19
  v_mul_f32 v26, v26, v14
  v_cvt_pk_bf16_f32 v25, v25, v26
  v_lshlrev_b32 v26, 16, v25
  v_and_b32 v25, 0xffff0000, v25
  v_add_f32 v35, v35, v26
  v_add_f32 v35, v35, v25
  v_lshlrev_b32 v25, 16, v207
  v_and_b32 v26, 0xffff0000, v207
  v_mul_f32 v25, v25, v20
  v_mul_f32 v26, v26, v15
  v_cvt_pk_bf16_f32 v25, v25, v26
  v_lshlrev_b32 v26, 16, v25
  v_and_b32 v25, 0xffff0000, v25
  v_add_f32 v35, v35, v26
  v_add_f32 v35, v35, v25
  v_lshlrev_b32 v25, 16, v51
  v_and_b32 v26, 0xffff0000, v51
  v_mul_f32 v25, v25, v21
  v_mul_f32 v26, v26, v16
  v_cvt_pk_bf16_f32 v25, v25, v26
  v_lshlrev_b32 v26, 16, v25
  v_and_b32 v25, 0xffff0000, v25
  v_add_f32 v35, v35, v26
  v_add_f32 v35, v35, v25
  v_mov_b32 v36, 0
  v_lshlrev_b32 v25, 16, v208
  v_and_b32 v26, 0xffff0000, v208
  v_mul_f32 v25, v25, v17
  v_mul_f32 v26, v26, v12
  v_cvt_pk_bf16_f32 v25, v25, v26
  v_lshlrev_b32 v26, 16, v25
  v_and_b32 v25, 0xffff0000, v25
  v_add_f32 v36, v36, v26
  v_add_f32 v36, v36, v25
  v_lshlrev_b32 v25, 16, v209
  v_and_b32 v26, 0xffff0000, v209
  v_mul_f32 v25, v25, v18
  v_mul_f32 v26, v26, v13
  v_cvt_pk_bf16_f32 v25, v25, v26
  v_lshlrev_b32 v26, 16, v25
  v_and_b32 v25, 0xffff0000, v25
  v_add_f32 v36, v36, v26
  v_add_f32 v36, v36, v25
  v_lshlrev_b32 v25, 16, v210
  v_and_b32 v26, 0xffff0000, v210
  v_mul_f32 v25, v25, v19
  v_mul_f32 v26, v26, v14
  v_cvt_pk_bf16_f32 v25, v25, v26
  v_lshlrev_b32 v26, 16, v25
  v_and_b32 v25, 0xffff0000, v25
  v_add_f32 v36, v36, v26
  v_add_f32 v36, v36, v25
  v_lshlrev_b32 v25, 16, v211
  v_and_b32 v26, 0xffff0000, v211
  v_mul_f32 v25, v25, v20
  v_mul_f32 v26, v26, v15
  v_cvt_pk_bf16_f32 v25, v25, v26
  v_lshlrev_b32 v26, 16, v25
  v_and_b32 v25, 0xffff0000, v25
  v_add_f32 v36, v36, v26
  v_add_f32 v36, v36, v25
  v_lshlrev_b32 v25, 16, v52
  v_and_b32 v26, 0xffff0000, v52
  v_mul_f32 v25, v25, v21
  v_mul_f32 v26, v26, v16
  v_cvt_pk_bf16_f32 v25, v25, v26
  v_lshlrev_b32 v26, 16, v25
  v_and_b32 v25, 0xffff0000, v25
  v_add_f32 v36, v36, v26
  v_add_f32 v36, v36, v25
  v_mov_b32 v37, 0
  v_lshlrev_b32 v25, 16, v212
  v_and_b32 v26, 0xffff0000, v212
  v_mul_f32 v25, v25, v17
  v_mul_f32 v26, v26, v12
  v_cvt_pk_bf16_f32 v25, v25, v26
  v_lshlrev_b32 v26, 16, v25
  v_and_b32 v25, 0xffff0000, v25
  v_add_f32 v37, v37, v26
  v_add_f32 v37, v37, v25
  v_lshlrev_b32 v25, 16, v213
  v_and_b32 v26, 0xffff0000, v213
  v_mul_f32 v25, v25, v18
  v_mul_f32 v26, v26, v13
  v_cvt_pk_bf16_f32 v25, v25, v26
  v_lshlrev_b32 v26, 16, v25
  v_and_b32 v25, 0xffff0000, v25
  v_add_f32 v37, v37, v26
  v_add_f32 v37, v37, v25
  v_lshlrev_b32 v25, 16, v214
  v_and_b32 v26, 0xffff0000, v214
  v_mul_f32 v25, v25, v19
  v_mul_f32 v26, v26, v14
  v_cvt_pk_bf16_f32 v25, v25, v26
  v_lshlrev_b32 v26, 16, v25
  v_and_b32 v25, 0xffff0000, v25
  v_add_f32 v37, v37, v26
  v_add_f32 v37, v37, v25
  v_lshlrev_b32 v25, 16, v215
  v_and_b32 v26, 0xffff0000, v215
  v_mul_f32 v25, v25, v20
  v_mul_f32 v26, v26, v15
  v_cvt_pk_bf16_f32 v25, v25, v26
  v_lshlrev_b32 v26, 16, v25
  v_and_b32 v25, 0xffff0000, v25
  v_add_f32 v37, v37, v26
  v_add_f32 v37, v37, v25
  v_lshlrev_b32 v25, 16, v53
  v_and_b32 v26, 0xffff0000, v53
  v_mul_f32 v25, v25, v21
  v_mul_f32 v26, v26, v16
  v_cvt_pk_bf16_f32 v25, v25, v26
  v_lshlrev_b32 v26, 16, v25
  v_and_b32 v25, 0xffff0000, v25
  v_add_f32 v37, v37, v26
  v_add_f32 v37, v37, v25
  v_mov_b32 v38, 0
  v_lshlrev_b32 v25, 16, v216
  v_and_b32 v26, 0xffff0000, v216
  v_mul_f32 v25, v25, v17
  v_mul_f32 v26, v26, v12
  v_cvt_pk_bf16_f32 v25, v25, v26
  v_lshlrev_b32 v26, 16, v25
  v_and_b32 v25, 0xffff0000, v25
  v_add_f32 v38, v38, v26
  v_add_f32 v38, v38, v25
  v_lshlrev_b32 v25, 16, v217
  v_and_b32 v26, 0xffff0000, v217
  v_mul_f32 v25, v25, v18
  v_mul_f32 v26, v26, v13
  v_cvt_pk_bf16_f32 v25, v25, v26
  v_lshlrev_b32 v26, 16, v25
  v_and_b32 v25, 0xffff0000, v25
  v_add_f32 v38, v38, v26
  v_add_f32 v38, v38, v25
  v_lshlrev_b32 v25, 16, v218
  v_and_b32 v26, 0xffff0000, v218
  v_mul_f32 v25, v25, v19
  v_mul_f32 v26, v26, v14
  v_cvt_pk_bf16_f32 v25, v25, v26
  v_lshlrev_b32 v26, 16, v25
  v_and_b32 v25, 0xffff0000, v25
  v_add_f32 v38, v38, v26
  v_add_f32 v38, v38, v25
  v_lshlrev_b32 v25, 16, v219
  v_and_b32 v26, 0xffff0000, v219
  v_mul_f32 v25, v25, v20
  v_mul_f32 v26, v26, v15
  v_cvt_pk_bf16_f32 v25, v25, v26
  v_lshlrev_b32 v26, 16, v25
  v_and_b32 v25, 0xffff0000, v25
  v_add_f32 v38, v38, v26
  v_add_f32 v38, v38, v25
  v_lshlrev_b32 v25, 16, v54
  v_and_b32 v26, 0xffff0000, v54
  v_mul_f32 v25, v25, v21
  v_mul_f32 v26, v26, v16
  v_cvt_pk_bf16_f32 v25, v25, v26
  v_lshlrev_b32 v26, 16, v25
  v_and_b32 v25, 0xffff0000, v25
  v_add_f32 v38, v38, v26
  v_add_f32 v38, v38, v25
  v_mov_b32 v39, 0
  v_lshlrev_b32 v25, 16, v220
  v_and_b32 v26, 0xffff0000, v220
  v_mul_f32 v25, v25, v17
  v_mul_f32 v26, v26, v12
  v_cvt_pk_bf16_f32 v25, v25, v26
  v_lshlrev_b32 v26, 16, v25
  v_and_b32 v25, 0xffff0000, v25
  v_add_f32 v39, v39, v26
  v_add_f32 v39, v39, v25
  v_lshlrev_b32 v25, 16, v221
  v_and_b32 v26, 0xffff0000, v221
  v_mul_f32 v25, v25, v18
  v_mul_f32 v26, v26, v13
  v_cvt_pk_bf16_f32 v25, v25, v26
  v_lshlrev_b32 v26, 16, v25
  v_and_b32 v25, 0xffff0000, v25
  v_add_f32 v39, v39, v26
  v_add_f32 v39, v39, v25
  v_lshlrev_b32 v25, 16, v222
  v_and_b32 v26, 0xffff0000, v222
  v_mul_f32 v25, v25, v19
  v_mul_f32 v26, v26, v14
  v_cvt_pk_bf16_f32 v25, v25, v26
  v_lshlrev_b32 v26, 16, v25
  v_and_b32 v25, 0xffff0000, v25
  v_add_f32 v39, v39, v26
  v_add_f32 v39, v39, v25
  v_lshlrev_b32 v25, 16, v223
  v_and_b32 v26, 0xffff0000, v223
  v_mul_f32 v25, v25, v20
  v_mul_f32 v26, v26, v15
  v_cvt_pk_bf16_f32 v25, v25, v26
  v_lshlrev_b32 v26, 16, v25
  v_and_b32 v25, 0xffff0000, v25
  v_add_f32 v39, v39, v26
  v_add_f32 v39, v39, v25
  v_lshlrev_b32 v25, 16, v55
  v_and_b32 v26, 0xffff0000, v55
  v_mul_f32 v25, v25, v21
  v_mul_f32 v26, v26, v16
  v_cvt_pk_bf16_f32 v25, v25, v26
  v_lshlrev_b32 v26, 16, v25
  v_and_b32 v25, 0xffff0000, v25
  v_add_f32 v39, v39, v26
  v_add_f32 v39, v39, v25
  v_mov_b32 v40, 0
  v_lshlrev_b32 v25, 16, v224
  v_and_b32 v26, 0xffff0000, v224
  v_mul_f32 v25, v25, v17
  v_mul_f32 v26, v26, v12
  v_cvt_pk_bf16_f32 v25, v25, v26
  v_lshlrev_b32 v26, 16, v25
  v_and_b32 v25, 0xffff0000, v25
  v_add_f32 v40, v40, v26
  v_add_f32 v40, v40, v25
  v_lshlrev_b32 v25, 16, v225
  v_and_b32 v26, 0xffff0000, v225
  v_mul_f32 v25, v25, v18
  v_mul_f32 v26, v26, v13
  v_cvt_pk_bf16_f32 v25, v25, v26
  v_lshlrev_b32 v26, 16, v25
  v_and_b32 v25, 0xffff0000, v25
  v_add_f32 v40, v40, v26
  v_add_f32 v40, v40, v25
  v_lshlrev_b32 v25, 16, v226
  v_and_b32 v26, 0xffff0000, v226
  v_mul_f32 v25, v25, v19
  v_mul_f32 v26, v26, v14
  v_cvt_pk_bf16_f32 v25, v25, v26
  v_lshlrev_b32 v26, 16, v25
  v_and_b32 v25, 0xffff0000, v25
  v_add_f32 v40, v40, v26
  v_add_f32 v40, v40, v25
  v_lshlrev_b32 v25, 16, v227
  v_and_b32 v26, 0xffff0000, v227
  v_mul_f32 v25, v25, v20
  v_mul_f32 v26, v26, v15
  v_cvt_pk_bf16_f32 v25, v25, v26
  v_lshlrev_b32 v26, 16, v25
  v_and_b32 v25, 0xffff0000, v25
  v_add_f32 v40, v40, v26
  v_add_f32 v40, v40, v25
  v_lshlrev_b32 v25, 16, v56
  v_and_b32 v26, 0xffff0000, v56
  v_mul_f32 v25, v25, v21
  v_mul_f32 v26, v26, v16
  v_cvt_pk_bf16_f32 v25, v25, v26
  v_lshlrev_b32 v26, 16, v25
  v_and_b32 v25, 0xffff0000, v25
  v_add_f32 v40, v40, v26
  v_add_f32 v40, v40, v25
  v_mov_b32 v41, 0
  v_lshlrev_b32 v25, 16, v228
  v_and_b32 v26, 0xffff0000, v228
  v_mul_f32 v25, v25, v17
  v_mul_f32 v26, v26, v12
  v_cvt_pk_bf16_f32 v25, v25, v26
  v_lshlrev_b32 v26, 16, v25
  v_and_b32 v25, 0xffff0000, v25
  v_add_f32 v41, v41, v26
  v_add_f32 v41, v41, v25
  v_lshlrev_b32 v25, 16, v229
  v_and_b32 v26, 0xffff0000, v229
  v_mul_f32 v25, v25, v18
  v_mul_f32 v26, v26, v13
  v_cvt_pk_bf16_f32 v25, v25, v26
  v_lshlrev_b32 v26, 16, v25
  v_and_b32 v25, 0xffff0000, v25
  v_add_f32 v41, v41, v26
  v_add_f32 v41, v41, v25
  v_lshlrev_b32 v25, 16, v230
  v_and_b32 v26, 0xffff0000, v230
  v_mul_f32 v25, v25, v19
  v_mul_f32 v26, v26, v14
  v_cvt_pk_bf16_f32 v25, v25, v26
  v_lshlrev_b32 v26, 16, v25
  v_and_b32 v25, 0xffff0000, v25
  v_add_f32 v41, v41, v26
  v_add_f32 v41, v41, v25
  v_lshlrev_b32 v25, 16, v231
  v_and_b32 v26, 0xffff0000, v231
  v_mul_f32 v25, v25, v20
  v_mul_f32 v26, v26, v15
  v_cvt_pk_bf16_f32 v25, v25, v26
  v_lshlrev_b32 v26, 16, v25
  v_and_b32 v25, 0xffff0000, v25
  v_add_f32 v41, v41, v26
  v_add_f32 v41, v41, v25
  v_lshlrev_b32 v25, 16, v57
  v_and_b32 v26, 0xffff0000, v57
  v_mul_f32 v25, v25, v21
  v_mul_f32 v26, v26, v16
  v_cvt_pk_bf16_f32 v25, v25, v26
  v_lshlrev_b32 v26, 16, v25
  v_and_b32 v25, 0xffff0000, v25
  v_add_f32 v41, v41, v26
  v_add_f32 v41, v41, v25
  v_mov_b32 v42, 0
  v_lshlrev_b32 v25, 16, v232
  v_and_b32 v26, 0xffff0000, v232
  v_mul_f32 v25, v25, v17
  v_mul_f32 v26, v26, v12
  v_cvt_pk_bf16_f32 v25, v25, v26
  v_lshlrev_b32 v26, 16, v25
  v_and_b32 v25, 0xffff0000, v25
  v_add_f32 v42, v42, v26
  v_add_f32 v42, v42, v25
  v_lshlrev_b32 v25, 16, v233
  v_and_b32 v26, 0xffff0000, v233
  v_mul_f32 v25, v25, v18
  v_mul_f32 v26, v26, v13
  v_cvt_pk_bf16_f32 v25, v25, v26
  v_lshlrev_b32 v26, 16, v25
  v_and_b32 v25, 0xffff0000, v25
  v_add_f32 v42, v42, v26
  v_add_f32 v42, v42, v25
  v_lshlrev_b32 v25, 16, v234
  v_and_b32 v26, 0xffff0000, v234
  v_mul_f32 v25, v25, v19
  v_mul_f32 v26, v26, v14
  v_cvt_pk_bf16_f32 v25, v25, v26
  v_lshlrev_b32 v26, 16, v25
  v_and_b32 v25, 0xffff0000, v25
  v_add_f32 v42, v42, v26
  v_add_f32 v42, v42, v25
  v_lshlrev_b32 v25, 16, v235
  v_and_b32 v26, 0xffff0000, v235
  v_mul_f32 v25, v25, v20
  v_mul_f32 v26, v26, v15
  v_cvt_pk_bf16_f32 v25, v25, v26
  v_lshlrev_b32 v26, 16, v25
  v_and_b32 v25, 0xffff0000, v25
  v_add_f32 v42, v42, v26
  v_add_f32 v42, v42, v25
  v_lshlrev_b32 v25, 16, v58
  v_and_b32 v26, 0xffff0000, v58
  v_mul_f32 v25, v25, v21
  v_mul_f32 v26, v26, v16
  v_cvt_pk_bf16_f32 v25, v25, v26
  v_lshlrev_b32 v26, 16, v25
  v_and_b32 v25, 0xffff0000, v25
  v_add_f32 v42, v42, v26
  v_add_f32 v42, v42, v25
  v_mov_b32 v43, 0
  v_lshlrev_b32 v25, 16, v236
  v_and_b32 v26, 0xffff0000, v236
  v_mul_f32 v25, v25, v17
  v_mul_f32 v26, v26, v12
  v_cvt_pk_bf16_f32 v25, v25, v26
  v_lshlrev_b32 v26, 16, v25
  v_and_b32 v25, 0xffff0000, v25
  v_add_f32 v43, v43, v26
  v_add_f32 v43, v43, v25
  v_lshlrev_b32 v25, 16, v237
  v_and_b32 v26, 0xffff0000, v237
  v_mul_f32 v25, v25, v18
  v_mul_f32 v26, v26, v13
  v_cvt_pk_bf16_f32 v25, v25, v26
  v_lshlrev_b32 v26, 16, v25
  v_and_b32 v25, 0xffff0000, v25
  v_add_f32 v43, v43, v26
  v_add_f32 v43, v43, v25
  v_lshlrev_b32 v25, 16, v238
  v_and_b32 v26, 0xffff0000, v238
  v_mul_f32 v25, v25, v19
  v_mul_f32 v26, v26, v14
  v_cvt_pk_bf16_f32 v25, v25, v26
  v_lshlrev_b32 v26, 16, v25
  v_and_b32 v25, 0xffff0000, v25
  v_add_f32 v43, v43, v26
  v_add_f32 v43, v43, v25
  v_lshlrev_b32 v25, 16, v239
  v_and_b32 v26, 0xffff0000, v239
  v_mul_f32 v25, v25, v20
  v_mul_f32 v26, v26, v15
  v_cvt_pk_bf16_f32 v25, v25, v26
  v_lshlrev_b32 v26, 16, v25
  v_and_b32 v25, 0xffff0000, v25
  v_add_f32 v43, v43, v26
  v_add_f32 v43, v43, v25
  v_lshlrev_b32 v25, 16, v59
  v_and_b32 v26, 0xffff0000, v59
  v_mul_f32 v25, v25, v21
  v_mul_f32 v26, v26, v16
  v_cvt_pk_bf16_f32 v25, v25, v26
  v_lshlrev_b32 v26, 16, v25
  v_and_b32 v25, 0xffff0000, v25
  v_add_f32 v43, v43, v26
  v_add_f32 v43, v43, v25
  v_mov_b32 v44, 0
  v_lshlrev_b32 v25, 16, v240
  v_and_b32 v26, 0xffff0000, v240
  v_mul_f32 v25, v25, v17
  v_mul_f32 v26, v26, v12
  v_cvt_pk_bf16_f32 v25, v25, v26
  v_lshlrev_b32 v26, 16, v25
  v_and_b32 v25, 0xffff0000, v25
  v_add_f32 v44, v44, v26
  v_add_f32 v44, v44, v25
  v_lshlrev_b32 v25, 16, v241
  v_and_b32 v26, 0xffff0000, v241
  v_mul_f32 v25, v25, v18
  v_mul_f32 v26, v26, v13
  v_cvt_pk_bf16_f32 v25, v25, v26
  v_lshlrev_b32 v26, 16, v25
  v_and_b32 v25, 0xffff0000, v25
  v_add_f32 v44, v44, v26
  v_add_f32 v44, v44, v25
  v_lshlrev_b32 v25, 16, v242
  v_and_b32 v26, 0xffff0000, v242
  v_mul_f32 v25, v25, v19
  v_mul_f32 v26, v26, v14
  v_cvt_pk_bf16_f32 v25, v25, v26
  v_lshlrev_b32 v26, 16, v25
  v_and_b32 v25, 0xffff0000, v25
  v_add_f32 v44, v44, v26
  v_add_f32 v44, v44, v25
  v_lshlrev_b32 v25, 16, v243
  v_and_b32 v26, 0xffff0000, v243
  v_mul_f32 v25, v25, v20
  v_mul_f32 v26, v26, v15
  v_cvt_pk_bf16_f32 v25, v25, v26
  v_lshlrev_b32 v26, 16, v25
  v_and_b32 v25, 0xffff0000, v25
  v_add_f32 v44, v44, v26
  v_add_f32 v44, v44, v25
  v_lshlrev_b32 v25, 16, v60
  v_and_b32 v26, 0xffff0000, v60
  v_mul_f32 v25, v25, v21
  v_mul_f32 v26, v26, v16
  v_cvt_pk_bf16_f32 v25, v25, v26
  v_lshlrev_b32 v26, 16, v25
  v_and_b32 v25, 0xffff0000, v25
  v_add_f32 v44, v44, v26
  v_add_f32 v44, v44, v25
  v_mov_b32 v45, 0
  v_lshlrev_b32 v25, 16, v244
  v_and_b32 v26, 0xffff0000, v244
  v_mul_f32 v25, v25, v17
  v_mul_f32 v26, v26, v12
  v_cvt_pk_bf16_f32 v25, v25, v26
  v_lshlrev_b32 v26, 16, v25
  v_and_b32 v25, 0xffff0000, v25
  v_add_f32 v45, v45, v26
  v_add_f32 v45, v45, v25
  v_lshlrev_b32 v25, 16, v245
  v_and_b32 v26, 0xffff0000, v245
  v_mul_f32 v25, v25, v18
  v_mul_f32 v26, v26, v13
  v_cvt_pk_bf16_f32 v25, v25, v26
  v_lshlrev_b32 v26, 16, v25
  v_and_b32 v25, 0xffff0000, v25
  v_add_f32 v45, v45, v26
  v_add_f32 v45, v45, v25
  v_lshlrev_b32 v25, 16, v246
  v_and_b32 v26, 0xffff0000, v246
  v_mul_f32 v25, v25, v19
  v_mul_f32 v26, v26, v14
  v_cvt_pk_bf16_f32 v25, v25, v26
  v_lshlrev_b32 v26, 16, v25
  v_and_b32 v25, 0xffff0000, v25
  v_add_f32 v45, v45, v26
  v_add_f32 v45, v45, v25
  v_lshlrev_b32 v25, 16, v247
  v_and_b32 v26, 0xffff0000, v247
  v_mul_f32 v25, v25, v20
  v_mul_f32 v26, v26, v15
  v_cvt_pk_bf16_f32 v25, v25, v26
  v_lshlrev_b32 v26, 16, v25
  v_and_b32 v25, 0xffff0000, v25
  v_add_f32 v45, v45, v26
  v_add_f32 v45, v45, v25
  v_lshlrev_b32 v25, 16, v61
  v_and_b32 v26, 0xffff0000, v61
  v_mul_f32 v25, v25, v21
  v_mul_f32 v26, v26, v16
  v_cvt_pk_bf16_f32 v25, v25, v26
  v_lshlrev_b32 v26, 16, v25
  v_and_b32 v25, 0xffff0000, v25
  v_add_f32 v45, v45, v26
  v_add_f32 v45, v45, v25
  v_mov_b32 v46, 0
  v_lshlrev_b32 v25, 16, v248
  v_and_b32 v26, 0xffff0000, v248
  v_mul_f32 v25, v25, v17
  v_mul_f32 v26, v26, v12
  v_cvt_pk_bf16_f32 v25, v25, v26
  v_lshlrev_b32 v26, 16, v25
  v_and_b32 v25, 0xffff0000, v25
  v_add_f32 v46, v46, v26
  v_add_f32 v46, v46, v25
  v_lshlrev_b32 v25, 16, v249
  v_and_b32 v26, 0xffff0000, v249
  v_mul_f32 v25, v25, v18
  v_mul_f32 v26, v26, v13
  v_cvt_pk_bf16_f32 v25, v25, v26
  v_lshlrev_b32 v26, 16, v25
  v_and_b32 v25, 0xffff0000, v25
  v_add_f32 v46, v46, v26
  v_add_f32 v46, v46, v25
  v_lshlrev_b32 v25, 16, v250
  v_and_b32 v26, 0xffff0000, v250
  v_mul_f32 v25, v25, v19
  v_mul_f32 v26, v26, v14
  v_cvt_pk_bf16_f32 v25, v25, v26
  v_lshlrev_b32 v26, 16, v25
  v_and_b32 v25, 0xffff0000, v25
  v_add_f32 v46, v46, v26
  v_add_f32 v46, v46, v25
  v_lshlrev_b32 v25, 16, v251
  v_and_b32 v26, 0xffff0000, v251
  v_mul_f32 v25, v25, v20
  v_mul_f32 v26, v26, v15
  v_cvt_pk_bf16_f32 v25, v25, v26
  v_lshlrev_b32 v26, 16, v25
  v_and_b32 v25, 0xffff0000, v25
  v_add_f32 v46, v46, v26
  v_add_f32 v46, v46, v25
  v_lshlrev_b32 v25, 16, v62
  v_and_b32 v26, 0xffff0000, v62
  v_mul_f32 v25, v25, v21
  v_mul_f32 v26, v26, v16
  v_cvt_pk_bf16_f32 v25, v25, v26
  v_lshlrev_b32 v26, 16, v25
  v_and_b32 v25, 0xffff0000, v25
  v_add_f32 v46, v46, v26
  v_add_f32 v46, v46, v25
  v_mov_b32 v47, 0
  v_lshlrev_b32 v25, 16, v252
  v_and_b32 v26, 0xffff0000, v252
  v_mul_f32 v25, v25, v17
  v_mul_f32 v26, v26, v12
  v_cvt_pk_bf16_f32 v25, v25, v26
  v_lshlrev_b32 v26, 16, v25
  v_and_b32 v25, 0xffff0000, v25
  v_add_f32 v47, v47, v26
  v_add_f32 v47, v47, v25
  v_lshlrev_b32 v25, 16, v253
  v_and_b32 v26, 0xffff0000, v253
  v_mul_f32 v25, v25, v18
  v_mul_f32 v26, v26, v13
  v_cvt_pk_bf16_f32 v25, v25, v26
  v_lshlrev_b32 v26, 16, v25
  v_and_b32 v25, 0xffff0000, v25
  v_add_f32 v47, v47, v26
  v_add_f32 v47, v47, v25
  v_lshlrev_b32 v25, 16, v254
  v_and_b32 v26, 0xffff0000, v254
  v_mul_f32 v25, v25, v19
  v_mul_f32 v26, v26, v14
  v_cvt_pk_bf16_f32 v25, v25, v26
  v_lshlrev_b32 v26, 16, v25
  v_and_b32 v25, 0xffff0000, v25
  v_add_f32 v47, v47, v26
  v_add_f32 v47, v47, v25
  v_lshlrev_b32 v25, 16, v255
  v_and_b32 v26, 0xffff0000, v255
  v_mul_f32 v25, v25, v20
  v_mul_f32 v26, v26, v15
  v_cvt_pk_bf16_f32 v25, v25, v26
  v_lshlrev_b32 v26, 16, v25
  v_and_b32 v25, 0xffff0000, v25
  v_add_f32 v47, v47, v26
  v_add_f32 v47, v47, v25
  v_lshlrev_b32 v25, 16, v63
  v_and_b32 v26, 0xffff0000, v63
  v_mul_f32 v25, v25, v21
  v_mul_f32 v26, v26, v16
  v_cvt_pk_bf16_f32 v25, v25, v26
  v_lshlrev_b32 v26, 16, v25
  v_and_b32 v25, 0xffff0000, v25
  v_add_f32 v47, v47, v26
  v_add_f32 v47, v47, v25
  v_add_f32_dpp v32, v32, v32 row_ror:8 row_mask:0xf bank_mask:0xf
  v_add_f32_dpp v33, v33, v33 row_ror:8 row_mask:0xf bank_mask:0xf
  v_add_f32_dpp v34, v34, v34 row_ror:8 row_mask:0xf bank_mask:0xf
  v_add_f32_dpp v35, v35, v35 row_ror:8 row_mask:0xf bank_mask:0xf
  v_add_f32_dpp v36, v36, v36 row_ror:8 row_mask:0xf bank_mask:0xf
  v_add_f32_dpp v37, v37, v37 row_ror:8 row_mask:0xf bank_mask:0xf
  v_add_f32_dpp v38, v38, v38 row_ror:8 row_mask:0xf bank_mask:0xf
  v_add_f32_dpp v39, v39, v39 row_ror:8 row_mask:0xf bank_mask:0xf
  v_add_f32_dpp v40, v40, v40 row_ror:8 row_mask:0xf bank_mask:0xf
  v_add_f32_dpp v41, v41, v41 row_ror:8 row_mask:0xf bank_mask:0xf
  v_add_f32_dpp v42, v42, v42 row_ror:8 row_mask:0xf bank_mask:0xf
  v_add_f32_dpp v43, v43, v43 row_ror:8 row_mask:0xf bank_mask:0xf
  v_add_f32_dpp v44, v44, v44 row_ror:8 row_mask:0xf bank_mask:0xf
  v_add_f32_dpp v45, v45, v45 row_ror:8 row_mask:0xf bank_mask:0xf
  v_add_f32_dpp v46, v46, v46 row_ror:8 row_mask:0xf bank_mask:0xf
  v_add_f32_dpp v47, v47, v47 row_ror:8 row_mask:0xf bank_mask:0xf
  v_add_f32_dpp v32, v32, v32 row_ror:4 row_mask:0xf bank_mask:0xf
  v_add_f32_dpp v33, v33, v33 row_ror:4 row_mask:0xf bank_mask:0xf
  v_add_f32_dpp v34, v34, v34 row_ror:4 row_mask:0xf bank_mask:0xf
  v_add_f32_dpp v35, v35, v35 row_ror:4 row_mask:0xf bank_mask:0xf
  v_add_f32_dpp v36, v36, v36 row_ror:4 row_mask:0xf bank_mask:0xf
  v_add_f32_dpp v37, v37, v37 row_ror:4 row_mask:0xf bank_mask:0xf
  v_add_f32_dpp v38, v38, v38 row_ror:4 row_mask:0xf bank_mask:0xf
  v_add_f32_dpp v39, v39, v39 row_ror:4 row_mask:0xf bank_mask:0xf
  v_add_f32_dpp v40, v40, v40 row_ror:4 row_mask:0xf bank_mask:0xf
  v_add_f32_dpp v41, v41, v41 row_ror:4 row_mask:0xf bank_mask:0xf
  v_add_f32_dpp v42, v42, v42 row_ror:4 row_mask:0xf bank_mask:0xf
  v_add_f32_dpp v43, v43, v43 row_ror:4 row_mask:0xf bank_mask:0xf
  v_add_f32_dpp v44, v44, v44 row_ror:4 row_mask:0xf bank_mask:0xf
  v_add_f32_dpp v45, v45, v45 row_ror:4 row_mask:0xf bank_mask:0xf
  v_add_f32_dpp v46, v46, v46 row_ror:4 row_mask:0xf bank_mask:0xf
  v_add_f32_dpp v47, v47, v47 row_ror:4 row_mask:0xf bank_mask:0xf
  v_add_f32_dpp v32, v32, v32 row_ror:2 row_mask:0xf bank_mask:0xf
  v_add_f32_dpp v33, v33, v33 row_ror:2 row_mask:0xf bank_mask:0xf
  v_add_f32_dpp v34, v34, v34 row_ror:2 row_mask:0xf bank_mask:0xf
  v_add_f32_dpp v35, v35, v35 row_ror:2 row_mask:0xf bank_mask:0xf
  v_add_f32_dpp v36, v36, v36 row_ror:2 row_mask:0xf bank_mask:0xf
  v_add_f32_dpp v37, v37, v37 row_ror:2 row_mask:0xf bank_mask:0xf
  v_add_f32_dpp v38, v38, v38 row_ror:2 row_mask:0xf bank_mask:0xf
  v_add_f32_dpp v39, v39, v39 row_ror:2 row_mask:0xf bank_mask:0xf
  v_add_f32_dpp v40, v40, v40 row_ror:2 row_mask:0xf bank_mask:0xf
  v_add_f32_dpp v41, v41, v41 row_ror:2 row_mask:0xf bank_mask:0xf
  v_add_f32_dpp v42, v42, v42 row_ror:2 row_mask:0xf bank_mask:0xf
  v_add_f32_dpp v43, v43, v43 row_ror:2 row_mask:0xf bank_mask:0xf
  v_add_f32_dpp v44, v44, v44 row_ror:2 row_mask:0xf bank_mask:0xf
  v_add_f32_dpp v45, v45, v45 row_ror:2 row_mask:0xf bank_mask:0xf
  v_add_f32_dpp v46, v46, v46 row_ror:2 row_mask:0xf bank_mask:0xf
  v_add_f32_dpp v47, v47, v47 row_ror:2 row_mask:0xf bank_mask:0xf
  v_add_f32_dpp v32, v32, v32 row_ror:1 row_mask:0xf bank_mask:0xf
  v_add_f32_dpp v33, v33, v33 row_ror:1 row_mask:0xf bank_mask:0xf
  v_add_f32_dpp v34, v34, v34 row_ror:1 row_mask:0xf bank_mask:0xf
  v_add_f32_dpp v35, v35, v35 row_ror:1 row_mask:0xf bank_mask:0xf
  v_add_f32_dpp v36, v36, v36 row_ror:1 row_mask:0xf bank_mask:0xf
  v_add_f32_dpp v37, v37, v37 row_ror:1 row_mask:0xf bank_mask:0xf
  v_add_f32_dpp v38, v38, v38 row_ror:1 row_mask:0xf bank_mask:0xf
  v_add_f32_dpp v39, v39, v39 row_ror:1 row_mask:0xf bank_mask:0xf
  v_add_f32_dpp v40, v40, v40 row_ror:1 row_mask:0xf bank_mask:0xf
  v_add_f32_dpp v41, v41, v41 row_ror:1 row_mask:0xf bank_mask:0xf
  v_add_f32_dpp v42, v42, v42 row_ror:1 row_mask:0xf bank_mask:0xf
  v_add_f32_dpp v43, v43, v43 row_ror:1 row_mask:0xf bank_mask:0xf
  v_add_f32_dpp v44, v44, v44 row_ror:1 row_mask:0xf bank_mask:0xf
  v_add_f32_dpp v45, v45, v45 row_ror:1 row_mask:0xf bank_mask:0xf
  v_add_f32_dpp v46, v46, v46 row_ror:1 row_mask:0xf bank_mask:0xf
  v_add_f32_dpp v47, v47, v47 row_ror:1 row_mask:0xf bank_mask:0xf
  v_mov_b32 v24, v32
  v_cmp_eq_u32 vcc, 1, v2
  s_nop 1
  v_cndmask_b32 v24, v24, v33, vcc
  v_cmp_eq_u32 vcc, 2, v2
  s_nop 1
  v_cndmask_b32 v24, v24, v34, vcc
  v_cmp_eq_u32 vcc, 3, v2
  s_nop 1
  v_cndmask_b32 v24, v24, v35, vcc
  v_cmp_eq_u32 vcc, 4, v2
  s_nop 1
  v_cndmask_b32 v24, v24, v36, vcc
  v_cmp_eq_u32 vcc, 5, v2
  s_nop 1
  v_cndmask_b32 v24, v24, v37, vcc
  v_cmp_eq_u32 vcc, 6, v2
  s_nop 1
  v_cndmask_b32 v24, v24, v38, vcc
  v_cmp_eq_u32 vcc, 7, v2
  s_nop 1
  v_cndmask_b32 v24, v24, v39, vcc
  v_cmp_eq_u32 vcc, 8, v2
  s_nop 1
  v_cndmask_b32 v24, v24, v40, vcc
  v_cmp_eq_u32 vcc, 9, v2
  s_nop 1
  v_cndmask_b32 v24, v24, v41, vcc
  v_cmp_eq_u32 vcc, 10, v2
  s_nop 1
  v_cndmask_b32 v24, v24, v42, vcc
  v_cmp_eq_u32 vcc, 11, v2
  s_nop 1
  v_cndmask_b32 v24, v24, v43, vcc
  v_cmp_eq_u32 vcc, 12, v2
  s_nop 1
  v_cndmask_b32 v24, v24, v44, vcc
  v_cmp_eq_u32 vcc, 13, v2
  s_nop 1
  v_cndmask_b32 v24, v24, v45, vcc
  v_cmp_eq_u32 vcc, 14, v2
  s_nop 1
  v_cndmask_b32 v24, v24, v46, vcc
  v_cmp_eq_u32 vcc, 15, v2
  s_nop 1
  v_cndmask_b32 v24, v24, v47, vcc
  v_mov_b32 v25, v24
  s_nop 1
  v_permlane32_swap_b32 v24, v25
  v_add_f32 v24, v24, v25
  v_mov_b32 v25, v24
  s_nop 1
  v_permlane16_swap_b32 v24, v25
  v_add_f32 v24, v24, v25
  v_cvt_pk_bf16_f32 v25, v24, v24
  v_lshlrev_b32 v24, 16, v25
  v_mul_f32 v24, 0xbfb8aa3b, v24
  v_exp_f32 v24, v24
  s_nop 0
  v_add_f32 v24, 1.0, v24
  v_rcp_f32 v24, v24
  s_nop 0
  v_cvt_pk_bf16_f32 v25, v24, v24
  v_lshlrev_b32 v24, 16, v25
  s_lshl_b32 s21, s59, 2
  s_mov_b64 exec, 0xffff
  buffer_store_dword v24, v10, s[76:79], s21 offen sc1
  s_mov_b64 exec, -1
  s_waitcnt vmcnt(45)
  s_barrier
  ds_read_b64_tr_b16 a[0:1], v7 offset:0
  ds_read_b64_tr_b16 a[2:3], v7 offset:1536
  ds_read_b64_tr_b16 a[4:5], v7 offset:32
  ds_read_b64_tr_b16 a[6:7], v7 offset:1568
  ds_read_b64_tr_b16 a[8:9], v7 offset:64
  ds_read_b64_tr_b16 a[10:11], v7 offset:1600
  ds_read_b64_tr_b16 a[12:13], v7 offset:12288
  ds_read_b64_tr_b16 a[14:15], v7 offset:13824
  ds_read_b64_tr_b16 a[16:17], v7 offset:12320
  ds_read_b64_tr_b16 a[18:19], v7 offset:13856
  ds_read_b64_tr_b16 a[20:21], v7 offset:12352
  ds_read_b64_tr_b16 a[22:23], v7 offset:13888
  ds_read_b64_tr_b16 a[24:25], v7 offset:24576
  ds_read_b64_tr_b16 a[26:27], v7 offset:26112
  ds_read_b64_tr_b16 a[28:29], v7 offset:24608
  ds_read_b64_tr_b16 a[30:31], v7 offset:26144
  ds_read_b64_tr_b16 a[32:33], v7 offset:24640
  ds_read_b64_tr_b16 a[34:35], v7 offset:26176
  ds_read_b64_tr_b16 a[36:37], v7 offset:36864
  ds_read_b64_tr_b16 a[38:39], v7 offset:38400
  ds_read_b64_tr_b16 a[40:41], v7 offset:36896
  ds_read_b64_tr_b16 a[42:43], v7 offset:38432
  ds_read_b64_tr_b16 a[44:45], v7 offset:36928
  ds_read_b64_tr_b16 a[46:47], v7 offset:38464
  ds_read_b64_tr_b16 a[48:49], v7 offset:49152
  ds_read_b64_tr_b16 a[50:51], v7 offset:50688
  ds_read_b64_tr_b16 a[52:53], v7 offset:49184
  ds_read_b64_tr_b16 a[54:55], v7 offset:50720
  ds_read_b64_tr_b16 a[56:57], v7 offset:49216
  ds_read_b64_tr_b16 a[58:59], v7 offset:50752
  s_waitcnt lgkmcnt(0)
  s_barrier
  s_waitcnt vmcnt(30)
  s_barrier
  ds_read_b64_tr_b16 a[60:61], v8 offset:0
  ds_read_b64_tr_b16 a[62:63], v8 offset:1536
  ds_read_b64_tr_b16 a[64:65], v8 offset:32
  ds_read_b64_tr_b16 a[66:67], v8 offset:1568
  ds_read_b64_tr_b16 a[68:69], v8 offset:64
  ds_read_b64_tr_b16 a[70:71], v8 offset:1600
  ds_read_b64_tr_b16 a[72:73], v8 offset:12288
  ds_read_b64_tr_b16 a[74:75], v8 offset:13824
  ds_read_b64_tr_b16 a[76:77], v8 offset:12320
  ds_read_b64_tr_b16 a[78:79], v8 offset:13856
  ds_read_b64_tr_b16 a[80:81], v8 offset:12352
  ds_read_b64_tr_b16 a[82:83], v8 offset:13888
  ds_read_b64_tr_b16 a[84:85], v8 offset:24576
  ds_read_b64_tr_b16 a[86:87], v8 offset:26112
  ds_read_b64_tr_b16 a[88:89], v8 offset:24608
  ds_read_b64_tr_b16 a[90:91], v8 offset:26144
  ds_read_b64_tr_b16 a[92:93], v8 offset:24640
  ds_read_b64_tr_b16 a[94:95], v8 offset:26176
  ds_read_b64_tr_b16 a[96:97], v8 offset:36864
  ds_read_b64_tr_b16 a[98:99], v8 offset:38400
  ds_read_b64_tr_b16 a[100:101], v8 offset:36896
  ds_read_b64_tr_b16 a[102:103], v8 offset:38432
  ds_read_b64_tr_b16 a[104:105], v8 offset:36928
  ds_read_b64_tr_b16 a[106:107], v8 offset:38464
  ds_read_b64_tr_b16 a[108:109], v8 offset:49152
  ds_read_b64_tr_b16 a[110:111], v8 offset:50688
  ds_read_b64_tr_b16 a[112:113], v8 offset:49184
  ds_read_b64_tr_b16 a[114:115], v8 offset:50720
  ds_read_b64_tr_b16 a[116:117], v8 offset:49216
  ds_read_b64_tr_b16 a[118:119], v8 offset:50752
  s_waitcnt lgkmcnt(0)
  s_barrier
  s_waitcnt vmcnt(15)
  ds_write_b128 v30, v[64:67] offset:0
  ds_write_b128 v30, v[68:71] offset:1024
  ds_write_b128 v30, v[72:75] offset:2048
  ds_write_b128 v30, v[76:79] offset:3072
  ds_write_b128 v30, v[80:83] offset:4096
  ds_write_b128 v30, v[84:87] offset:5120
  ds_write_b128 v30, v[88:91] offset:6144
  ds_write_b128 v30, v[92:95] offset:7168
  ds_write_b128 v30, v[96:99] offset:8192
  ds_write_b128 v30, v[100:103] offset:9216
  ds_write_b128 v30, v[104:107] offset:10240
  ds_write_b128 v30, v[108:111] offset:11264
  ds_write_b128 v30, v[112:115] offset:12288
  ds_write_b128 v30, v[116:119] offset:13312
  ds_write_b128 v30, v[120:123] offset:14336
  s_waitcnt lgkmcnt(0)
  s_barrier
  ds_read_b64_tr_b16 a[120:121], v7 offset:0
  ds_read_b64_tr_b16 a[122:123], v7 offset:1536
  ds_read_b64_tr_b16 a[124:125], v7 offset:32
  ds_read_b64_tr_b16 a[126:127], v7 offset:1568
  ds_read_b64_tr_b16 a[128:129], v7 offset:64
  ds_read_b64_tr_b16 a[130:131], v7 offset:1600
  ds_read_b64_tr_b16 a[132:133], v7 offset:12288
  ds_read_b64_tr_b16 a[134:135], v7 offset:13824
  ds_read_b64_tr_b16 a[136:137], v7 offset:12320
  ds_read_b64_tr_b16 a[138:139], v7 offset:13856
  ds_read_b64_tr_b16 a[140:141], v7 offset:12352
  ds_read_b64_tr_b16 a[142:143], v7 offset:13888
  ds_read_b64_tr_b16 a[144:145], v7 offset:24576
  ds_read_b64_tr_b16 a[146:147], v7 offset:26112
  ds_read_b64_tr_b16 a[148:149], v7 offset:24608
  ds_read_b64_tr_b16 a[150:151], v7 offset:26144
  ds_read_b64_tr_b16 a[152:153], v7 offset:24640
  ds_read_b64_tr_b16 a[154:155], v7 offset:26176
  ds_read_b64_tr_b16 a[156:157], v7 offset:36864
  ds_read_b64_tr_b16 a[158:159], v7 offset:38400
  ds_read_b64_tr_b16 a[160:161], v7 offset:36896
  ds_read_b64_tr_b16 a[162:163], v7 offset:38432
  ds_read_b64_tr_b16 a[164:165], v7 offset:36928
  ds_read_b64_tr_b16 a[166:167], v7 offset:38464
  ds_read_b64_tr_b16 a[168:169], v7 offset:49152
  ds_read_b64_tr_b16 a[170:171], v7 offset:50688
  ds_read_b64_tr_b16 a[172:173], v7 offset:49184
  ds_read_b64_tr_b16 a[174:175], v7 offset:50720
  ds_read_b64_tr_b16 a[176:177], v7 offset:49216
  ds_read_b64_tr_b16 a[178:179], v7 offset:50752
  s_waitcnt lgkmcnt(0)
  s_barrier
  s_waitcnt vmcnt(0)
  ds_write_b128 v31, v[124:127] offset:0
  ds_write_b128 v31, v[128:131] offset:1024
  ds_write_b128 v31, v[132:135] offset:2048
  ds_write_b128 v31, v[136:139] offset:3072
  ds_write_b128 v31, v[140:143] offset:4096
  ds_write_b128 v31, v[144:147] offset:5120
  ds_write_b128 v31, v[148:151] offset:6144
  ds_write_b128 v31, v[152:155] offset:7168
  ds_write_b128 v31, v[156:159] offset:8192
  ds_write_b128 v31, v[160:163] offset:9216
  ds_write_b128 v31, v[164:167] offset:10240
  ds_write_b128 v31, v[168:171] offset:11264
  ds_write_b128 v31, v[172:175] offset:12288
  ds_write_b128 v31, v[176:179] offset:13312
  ds_write_b128 v31, v[180:183] offset:14336
  s_waitcnt lgkmcnt(0)
  s_barrier
  ds_read_b64_tr_b16 a[180:181], v8 offset:0
  ds_read_b64_tr_b16 a[182:183], v8 offset:1536
  ds_read_b64_tr_b16 a[184:185], v8 offset:32
  ds_read_b64_tr_b16 a[186:187], v8 offset:1568
  ds_read_b64_tr_b16 a[188:189], v8 offset:64
  ds_read_b64_tr_b16 a[190:191], v8 offset:1600
  ds_read_b64_tr_b16 a[192:193], v8 offset:12288
  ds_read_b64_tr_b16 a[194:195], v8 offset:13824
  ds_read_b64_tr_b16 a[196:197], v8 offset:12320
  ds_read_b64_tr_b16 a[198:199], v8 offset:13856
  ds_read_b64_tr_b16 a[200:201], v8 offset:12352
  ds_read_b64_tr_b16 a[202:203], v8 offset:13888
  ds_read_b64_tr_b16 a[204:205], v8 offset:24576
  ds_read_b64_tr_b16 a[206:207], v8 offset:26112
  ds_read_b64_tr_b16 a[208:209], v8 offset:24608
  ds_read_b64_tr_b16 a[210:211], v8 offset:26144
  ds_read_b64_tr_b16 a[212:213], v8 offset:24640
  ds_read_b64_tr_b16 a[214:215], v8 offset:26176
  ds_read_b64_tr_b16 a[216:217], v8 offset:36864
  ds_read_b64_tr_b16 a[218:219], v8 offset:38400
  ds_read_b64_tr_b16 a[220:221], v8 offset:36896
  ds_read_b64_tr_b16 a[222:223], v8 offset:38432
  ds_read_b64_tr_b16 a[224:225], v8 offset:36928
  ds_read_b64_tr_b16 a[226:227], v8 offset:38464
  ds_read_b64_tr_b16 a[228:229], v8 offset:49152
  ds_read_b64_tr_b16 a[230:231], v8 offset:50688
  ds_read_b64_tr_b16 a[232:233], v8 offset:49184
  ds_read_b64_tr_b16 a[234:235], v8 offset:50720
  ds_read_b64_tr_b16 a[236:237], v8 offset:49216
  ds_read_b64_tr_b16 a[238:239], v8 offset:50752
  s_waitcnt lgkmcnt(0)
  s_barrier
  s_and_b32 s21, s2, 3
  s_lshl_b32 s21, s21, 7
  s_add_u32 s21, s21, 29696
  s_xor_b32 s21, s21, s80
  s_cmp_lg_u32 s20, 0
  s_cbranch_scc1 af_223
  v_mov_b32 v8, 0
  v_mov_b32 v9, 1
  s_mov_b64 exec, 1
  buffer_atomic_add v9, v8, s[72:75], s21 offen sc1
  s_mov_b64 exec, -1
  s_nop 1
af_223:
  s_mov_b32 s30, 0
  s_mov_b32 s25, 162688
  s_mov_b32 s26, 16
  v_lshrrev_b32 v4, 3, v1
  v_and_b32 v5, 7, v1
  v_xor_b32 v5, v5, v4
  s_mul_i32 s21, s20, 32
  v_add_u32 v4, s21, v4
  v_mul_u32_u24 v4, 1280, v4
  v_lshl_add_u32 v10, v5, 4, v4
  s_mul_i32 s31, s20, 4096
  v_add_u32 v11, 10240, v10
  v_add_u32 v12, 20480, v10
  v_add_u32 v13, 30720, v10
  s_add_u32 m0, s31, 0
  s_nop 0
  buffer_load_dwordx4 v10, s[8:11], s30 offen lds
  s_add_u32 m0, s31, 1024
  s_nop 0
  buffer_load_dwordx4 v11, s[8:11], s30 offen lds
  s_add_u32 m0, s31, 2048
  s_nop 0
  buffer_load_dwordx4 v12, s[8:11], s30 offen lds
  s_add_u32 m0, s31, 3072
  s_nop 0
  buffer_load_dwordx4 v13, s[8:11], s30 offen lds
  s_add_u32 s30, s30, 128
  s_add_u32 m0, s31, 16384
  s_nop 0
  buffer_load_dwordx4 v10, s[8:11], s30 offen lds
  s_add_u32 m0, s31, 17408
  s_nop 0
  buffer_load_dwordx4 v11, s[8:11], s30 offen lds
  s_add_u32 m0, s31, 18432
  s_nop 0
  buffer_load_dwordx4 v12, s[8:11], s30 offen lds
  s_add_u32 m0, s31, 19456
  s_nop 0
  buffer_load_dwordx4 v13, s[8:11], s30 offen lds
  s_add_u32 s30, s30, 128
  s_add_u32 m0, s31, 32768
  s_nop 0
  buffer_load_dwordx4 v10, s[8:11], s30 offen lds
  s_add_u32 m0, s31, 33792
  s_nop 0
  buffer_load_dwordx4 v11, s[8:11], s30 offen lds
  s_add_u32 m0, s31, 34816
  s_nop 0
  buffer_load_dwordx4 v12, s[8:11], s30 offen lds
  s_add_u32 m0, s31, 35840
  s_nop 0
  buffer_load_dwordx4 v13, s[8:11], s30 offen lds
  s_add_u32 s30, s30, 128
  v_and_b32 v6, 7, v2
  v_add_u32 v4, 0, v3
  v_xor_b32 v4, v4, v6
  v_lshlrev_b32 v4, 4, v4
  v_lshl_add_u32 v14, v2, 7, v4
  v_add_u32 v16, 65536, v14
  v_add_u32 v18, 131072, v14
  v_add_u32 v4, 4, v3
  v_xor_b32 v4, v4, v6
  v_lshlrev_b32 v4, 4, v4
  v_lshl_add_u32 v15, v2, 7, v4
  v_add_u32 v17, 65536, v15
  v_add_u32 v19, 131072, v15
  v_lshlrev_b32 v26, 4, v1
  v_mov_b32 v28, 1
  v_mov_b32 v4, 0x40000000
  v_cmp_eq_u32 vcc, 0, v0
  s_nop 1
  v_cndmask_b32 v27, v4, 0, vcc
  s_mul_i32 s21, s20, 3072
  s_add_u32 s21, s21, 81920
  v_add_u32 v20, s21, v26
  s_mul_i32 s21, s20, 12288
  s_add_u32 s21, s21, 81920
  v_add_u32 v21, s21, v26
  v_add_u32 v22, 2048, v21
  v_add_u32 v23, 2056, v21
  v_and_b32 v4, 7, v2
  v_lshlrev_b32 v4, 4, v4
  v_lshl_add_u32 v24, v3, 7, v4
  v_lshrrev_b32 v25, 1, v24
  v_lshlrev_b32 v29, 3, v1
  v_and_b32 v4, 3, v1
  v_lshlrev_b32 v30, 3, v4
  v_mov_b32 v31, 0xf149f2ca
  v_mov_b32 v32, 0
  v_mov_b32 v4, 1073741824
  v_cmp_eq_u32 vcc, 0, v1
  v_lshlrev_b32 v5, 2, v3
  v_sub_u32 v5, v2, v5
  v_cndmask_b32 v33, v4, 0, vcc
  v_cmp_gt_u32 s[62:63], 2, v3
  s_mov_b32 s83, 0x3dd53b95
  s_lshl_b32 s77, s42, 7
  s_add_u32 s77, s77, 0
  s_xor_b32 s77, s77, s80
  s_lshl_b32 s45, s20, 21
  s_lshl_b32 s21, s20, 13
  s_and_b32 s21, s21, 8192
  s_xor_b32 s21, s21, s80
  s_add_u32 s45, s45, s21
  s_lshl_b32 s21, s42, 16
  s_add_u32 s45, s45, s21
  s_lshr_b32 s47, s42, 1
  s_lshl_b32 s47, s47, 14
  s_and_b32 s22, s42, 1
  s_mul_i32 s22, s22, 2560
  s_add_u32 s47, s47, s22
  s_lshl_b32 s21, s20, 19
  s_lshl_b32 s22, s20, 11
  s_and_b32 s22, s22, 8192
  s_xor_b32 s22, s22, s80
  s_add_u32 s21, s21, s22
  s_add_u32 s21, s21, 134217728
  s_xor_b32 s21, s21, 8192
  s_add_u32 s47, s47, s21
  s_lshl_b32 s48, s20, 7
  s_add_u32 s48, s48, 8192
  s_xor_b32 s48, s48, s80
  s_add_u32 s43, s20, 1
  s_mov_b32 s49, 0
  s_mov_b32 s50, 1073741824
  s_mov_b32 s81, 1073741824
  s_mov_b32 s82, 1073741824
  v_cmp_le_i32 s[64:65], 0, v5
  v_cmp_le_i32 s[66:67], 1, v5
  v_cmp_le_i32 s[68:69], 2, v5
  v_cmp_le_i32 s[70:71], 3, v5
  s_waitcnt vmcnt(8)
  s_barrier
  ds_read_b128 v[160:163], v14 offset:0
  ds_read_b128 v[164:167], v14 offset:2048
  ds_read_b128 v[168:171], v14 offset:4096
  ds_read_b128 v[172:175], v14 offset:6144
  s_waitcnt lgkmcnt(3)
  .p2align 3
qa_226:
  v_mfma_f32_16x16x32_bf16 v[64:67], a[0:3], v[160:163], 0
  ds_read_b128 v[176:179], v14 offset:8192
  v_cvt_pk_bf16_f32 v221, v126, v127
  v_mfma_f32_16x16x32_bf16 v[68:71], a[4:7], v[160:163], 0
  v_cvt_pk_bf16_f32 v222, v128, v129
  v_cvt_pk_bf16_f32 v223, v130, v131
  v_mfma_f32_16x16x32_bf16 v[72:75], a[8:11], v[160:163], 0
  s_waitcnt lgkmcnt(3)
  v_cvt_pk_bf16_f32 v226, v132, v133
  v_cvt_pk_bf16_f32 v227, v134, v135
  v_mfma_f32_16x16x32_bf16 v[76:79], a[0:3], v[164:167], 0
  ds_read_b128 v[180:183], v14 offset:10240
  v_cvt_pk_bf16_f32 v228, v136, v137
  v_mfma_f32_16x16x32_bf16 v[80:83], a[4:7], v[164:167], 0
  v_cvt_pk_bf16_f32 v229, v138, v139
  v_cvt_pk_bf16_f32 v230, v140, v141
  v_mfma_f32_16x16x32_bf16 v[84:87], a[8:11], v[164:167], 0
  s_waitcnt lgkmcnt(3)
  v_cvt_pk_bf16_f32 v231, v142, v143
  v_cvt_pk_bf16_f32 v236, v144, v145
  v_mfma_f32_16x16x32_bf16 v[88:91], a[0:3], v[168:171], 0
  ds_read_b128 v[184:187], v14 offset:12288
  v_cvt_pk_bf16_f32 v237, v146, v147
  v_mfma_f32_16x16x32_bf16 v[92:95], a[4:7], v[168:171], 0
  v_cvt_pk_bf16_f32 v232, v148, v149
  v_cvt_pk_bf16_f32 v233, v150, v151
  v_mfma_f32_16x16x32_bf16 v[96:99], a[8:11], v[168:171], 0
  s_waitcnt lgkmcnt(3)
  v_cvt_pk_bf16_f32 v234, v152, v153
  v_cvt_pk_bf16_f32 v235, v154, v155
  v_mfma_f32_16x16x32_bf16 v[100:103], a[0:3], v[172:175], 0
  ds_read_b128 v[188:191], v14 offset:14336
  v_cvt_pk_bf16_f32 v238, v156, v157
  v_mfma_f32_16x16x32_bf16 v[104:107], a[4:7], v[172:175], 0
  v_cvt_pk_bf16_f32 v239, v158, v159
  ds_write_b128 v20, v[192:195] offset:0
  v_mfma_f32_16x16x32_bf16 v[108:111], a[8:11], v[172:175], 0
  s_waitcnt lgkmcnt(4)
  v_mfma_f32_16x16x32_bf16 v[112:115], a[0:3], v[176:179], 0
  ds_read_b128 v[160:163], v15 offset:0
  ds_write_b128 v20, v[196:199] offset:1024
  v_mfma_f32_16x16x32_bf16 v[116:119], a[4:7], v[176:179], 0
  s_add_u32 m0, s31, 49152
  v_mfma_f32_16x16x32_bf16 v[120:123], a[8:11], v[176:179], 0
  s_waitcnt lgkmcnt(5)
  buffer_load_dwordx4 v10, s[8:11], s30 offen lds
  ds_write_b128 v20, v[200:203] offset:2048
  v_mfma_f32_16x16x32_bf16 v[124:127], a[0:3], v[180:183], 0
  ds_read_b128 v[164:167], v15 offset:2048
  v_mfma_f32_16x16x32_bf16 v[128:131], a[4:7], v[180:183], 0
  ds_write_b128 v20, v[204:207] offset:12288
  v_mfma_f32_16x16x32_bf16 v[132:135], a[8:11], v[180:183], 0
  s_waitcnt lgkmcnt(7)
  v_mfma_f32_16x16x32_bf16 v[136:139], a[0:3], v[184:187], 0
  ds_read_b128 v[168:171], v15 offset:4096
  ds_write_b128 v20, v[208:211] offset:13312
  v_mfma_f32_16x16x32_bf16 v[140:143], a[4:7], v[184:187], 0
  s_add_u32 m0, s31, 50176
  v_mfma_f32_16x16x32_bf16 v[144:147], a[8:11], v[184:187], 0
  s_waitcnt lgkmcnt(8)
  buffer_load_dwordx4 v11, s[8:11], s30 offen lds
  ds_write_b128 v20, v[212:215] offset:14336
  v_mfma_f32_16x16x32_bf16 v[148:151], a[0:3], v[188:191], 0
  ds_read_b128 v[172:175], v15 offset:6144
  v_mfma_f32_16x16x32_bf16 v[152:155], a[4:7], v[188:191], 0
  ds_write_b128 v20, v[216:219] offset:24576
  v_mfma_f32_16x16x32_bf16 v[156:159], a[8:11], v[188:191], 0
  s_waitcnt lgkmcnt(9)
  v_mfma_f32_16x16x32_bf16 v[64:67], a[12:15], v[160:163], v[64:67]
  ds_read_b128 v[176:179], v15 offset:8192
  ds_write_b128 v20, v[220:223] offset:25600
  v_mfma_f32_16x16x32_bf16 v[68:71], a[16:19], v[160:163], v[68:71]
  s_add_u32 m0, s31, 51200
  v_mfma_f32_16x16x32_bf16 v[72:75], a[20:23], v[160:163], v[72:75]
  s_waitcnt lgkmcnt(8)
  buffer_load_dwordx4 v12, s[8:11], s30 offen lds
  ds_write_b128 v20, v[224:227] offset:26624
  v_mfma_f32_16x16x32_bf16 v[76:79], a[12:15], v[164:167], v[76:79]
  ds_read_b128 v[180:183], v15 offset:10240
  v_mfma_f32_16x16x32_bf16 v[80:83], a[16:19], v[164:167], v[80:83]
  ds_write_b128 v20, v[228:231] offset:36864
  v_mfma_f32_16x16x32_bf16 v[84:87], a[20:23], v[164:167], v[84:87]
  s_waitcnt lgkmcnt(9)
  v_mfma_f32_16x16x32_bf16 v[88:91], a[12:15], v[168:171], v[88:91]
  ds_read_b128 v[184:187], v15 offset:12288
  ds_write_b128 v20, v[232:235] offset:37888
  v_mfma_f32_16x16x32_bf16 v[92:95], a[16:19], v[168:171], v[92:95]
  s_add_u32 m0, s31, 52224
  v_mfma_f32_16x16x32_bf16 v[96:99], a[20:23], v[168:171], v[96:99]
  s_waitcnt lgkmcnt(8)
  buffer_load_dwordx4 v13, s[8:11], s30 offen lds
  ds_write_b128 v20, v[236:239] offset:38912
  v_mfma_f32_16x16x32_bf16 v[100:103], a[12:15], v[172:175], v[100:103]
  s_add_u32 s30, s30, 128
  ds_read_b128 v[188:191], v15 offset:14336
  s_waitcnt vmcnt(8)
  v_mfma_f32_16x16x32_bf16 v[104:107], a[16:19], v[172:175], v[104:107]
  v_cmp_gt_u32 vcc, s49, v32
  v_mfma_f32_16x16x32_bf16 v[108:111], a[20:23], v[172:175], v[108:111]
  s_waitcnt lgkmcnt(8)
  s_cbranch_vccnz qw_227
qj_228:
  s_waitcnt lgkmcnt(1)
  v_mfma_f32_16x16x32_bf16 v[112:115], a[12:15], v[176:179], v[112:115]
  s_waitcnt vmcnt(8)
  s_barrier
  ds_read_b128 v[160:163], v14 offset:16384
  v_mfma_f32_16x16x32_bf16 v[116:119], a[16:19], v[176:179], v[116:119]
  s_add_u32 s29, s50, 0
  buffer_load_dwordx4 v[192:195], v26, s[16:19], s29 offen offset:0 sc1
  v_mfma_f32_16x16x32_bf16 v[120:123], a[20:23], v[176:179], v[120:123]
  s_waitcnt lgkmcnt(6)
  v_mfma_f32_16x16x32_bf16 v[124:127], a[12:15], v[180:183], v[124:127]
  ds_read_b128 v[164:167], v14 offset:18432
  buffer_load_dwordx4 v[196:199], v26, s[16:19], s29 offen offset:1024 sc1
  v_mfma_f32_16x16x32_bf16 v[128:131], a[16:19], v[180:183], v[128:131]
  v_mfma_f32_16x16x32_bf16 v[132:135], a[20:23], v[180:183], v[132:135]
  s_waitcnt lgkmcnt(5)
  buffer_load_dwordx4 v[224:227], v26, s[16:19], s29 offen offset:2048 sc1
  v_mfma_f32_16x16x32_bf16 v[136:139], a[12:15], v[184:187], v[136:139]
  ds_read_b128 v[168:171], v14 offset:20480
  v_mfma_f32_16x16x32_bf16 v[140:143], a[16:19], v[184:187], v[140:143]
  s_add_u32 s29, s50, 16384
  buffer_load_dwordx4 v[200:203], v26, s[16:19], s29 offen offset:0 sc1
  v_mfma_f32_16x16x32_bf16 v[144:147], a[20:23], v[184:187], v[144:147]
  s_waitcnt lgkmcnt(3)
  v_mfma_f32_16x16x32_bf16 v[148:151], a[12:15], v[188:191], v[148:151]
  ds_read_b128 v[172:175], v14 offset:22528
  buffer_load_dwordx4 v[204:207], v26, s[16:19], s29 offen offset:1024 sc1
  v_mfma_f32_16x16x32_bf16 v[152:155], a[16:19], v[188:191], v[152:155]
  v_mfma_f32_16x16x32_bf16 v[156:159], a[20:23], v[188:191], v[156:159]
  s_waitcnt lgkmcnt(3)
  buffer_load_dwordx4 v[228:231], v26, s[16:19], s29 offen offset:2048 sc1
  v_mfma_f32_16x16x32_bf16 v[64:67], a[24:27], v[160:163], v[64:67]
  ds_read_b128 v[176:179], v14 offset:24576
  v_mfma_f32_16x16x32_bf16 v[68:71], a[28:31], v[160:163], v[68:71]
  s_add_u32 m0, s31, 65536
  s_add_u32 s29, s50, 32768
  buffer_load_dwordx4 v[208:211], v26, s[16:19], s29 offen offset:0 sc1
  v_mfma_f32_16x16x32_bf16 v[72:75], a[32:35], v[160:163], v[72:75]
  s_waitcnt lgkmcnt(3)
  buffer_load_dwordx4 v10, s[8:11], s30 offen lds
  v_mfma_f32_16x16x32_bf16 v[76:79], a[24:27], v[164:167], v[76:79]
  ds_read_b128 v[180:183], v14 offset:26624
  buffer_load_dwordx4 v[212:215], v26, s[16:19], s29 offen offset:1024 sc1
  v_mfma_f32_16x16x32_bf16 v[80:83], a[28:31], v[164:167], v[80:83]
  v_mfma_f32_16x16x32_bf16 v[84:87], a[32:35], v[164:167], v[84:87]
  s_waitcnt lgkmcnt(3)
  buffer_load_dwordx4 v[232:235], v26, s[16:19], s29 offen offset:2048 sc1
  v_mfma_f32_16x16x32_bf16 v[88:91], a[24:27], v[168:171], v[88:91]
  ds_read_b128 v[184:187], v14 offset:28672
  v_mfma_f32_16x16x32_bf16 v[92:95], a[28:31], v[168:171], v[92:95]
  s_add_u32 m0, s31, 66560
  s_add_u32 s29, s50, 49152
  buffer_load_dwordx4 v[216:219], v26, s[16:19], s29 offen offset:0 sc1
  v_mfma_f32_16x16x32_bf16 v[96:99], a[32:35], v[168:171], v[96:99]
  s_waitcnt lgkmcnt(3)
  buffer_load_dwordx4 v11, s[8:11], s30 offen lds
  v_mfma_f32_16x16x32_bf16 v[100:103], a[24:27], v[172:175], v[100:103]
  ds_read_b128 v[188:191], v14 offset:30720
  buffer_load_dwordx4 v[220:223], v26, s[16:19], s29 offen offset:1024 sc1
  v_mfma_f32_16x16x32_bf16 v[104:107], a[28:31], v[172:175], v[104:107]
  v_mfma_f32_16x16x32_bf16 v[108:111], a[32:35], v[172:175], v[108:111]
  s_waitcnt lgkmcnt(3)
  buffer_load_dwordx4 v[236:239], v26, s[16:19], s29 offen offset:2048 sc1
  v_mfma_f32_16x16x32_bf16 v[112:115], a[24:27], v[176:179], v[112:115]
  ds_read_b128 v[160:163], v15 offset:16384
  v_mfma_f32_16x16x32_bf16 v[116:119], a[28:31], v[176:179], v[116:119]
  s_add_u32 m0, s31, 67584
  s_add_u32 s29, s50, 4096
  buffer_load_dwordx4 a[240:243], v24, s[16:19], s29 offen offset:2560 sc1
  v_mfma_f32_16x16x32_bf16 v[120:123], a[32:35], v[176:179], v[120:123]
  s_waitcnt lgkmcnt(3)
  buffer_load_dwordx4 v12, s[8:11], s30 offen lds
  v_mfma_f32_16x16x32_bf16 v[124:127], a[24:27], v[180:183], v[124:127]
  ds_read_b128 v[164:167], v15 offset:18432
  buffer_load_dwordx2 v[240:241], v25, s[16:19], s29 offen offset:3072 sc1
  v_mfma_f32_16x16x32_bf16 v[128:131], a[28:31], v[180:183], v[128:131]
  v_mfma_f32_16x16x32_bf16 v[132:135], a[32:35], v[180:183], v[132:135]
  s_waitcnt lgkmcnt(3)
  s_add_u32 s29, s50, 20480
  buffer_load_dwordx4 a[244:247], v24, s[16:19], s29 offen offset:2560 sc1
  v_mfma_f32_16x16x32_bf16 v[136:139], a[24:27], v[184:187], v[136:139]
  ds_read_b128 v[168:171], v15 offset:20480
  v_mfma_f32_16x16x32_bf16 v[140:143], a[28:31], v[184:187], v[140:143]
  s_add_u32 m0, s31, 68608
  buffer_load_dwordx2 v[242:243], v25, s[16:19], s29 offen offset:3072 sc1
  v_mfma_f32_16x16x32_bf16 v[144:147], a[32:35], v[184:187], v[144:147]
  s_waitcnt lgkmcnt(3)
  buffer_load_dwordx4 v13, s[8:11], s30 offen lds
  v_mfma_f32_16x16x32_bf16 v[148:151], a[24:27], v[188:191], v[148:151]
  s_add_u32 s30, s30, 128
  ds_read_b128 v[172:175], v15 offset:22528
  s_add_u32 s29, s50, 36864
  v_mfma_f32_16x16x32_bf16 v[152:155], a[28:31], v[188:191], v[152:155]
  buffer_load_dwordx4 a[248:251], v24, s[16:19], s29 offen offset:2560 sc1
  v_mfma_f32_16x16x32_bf16 v[156:159], a[32:35], v[188:191], v[156:159]
  s_waitcnt lgkmcnt(3)
  v_mfma_f32_16x16x32_bf16 v[64:67], a[36:39], v[160:163], v[64:67]
  ds_read_b128 v[176:179], v15 offset:24576
  buffer_load_dwordx2 v[244:245], v25, s[16:19], s29 offen offset:3072 sc1
  v_mfma_f32_16x16x32_bf16 v[68:71], a[40:43], v[160:163], v[68:71]
  v_mfma_f32_16x16x32_bf16 v[72:75], a[44:47], v[160:163], v[72:75]
  s_waitcnt lgkmcnt(3)
  s_add_u32 s29, s50, 53248
  buffer_load_dwordx4 a[252:255], v24, s[16:19], s29 offen offset:2560 sc1
  v_mfma_f32_16x16x32_bf16 v[76:79], a[36:39], v[164:167], v[76:79]
  ds_read_b128 v[180:183], v15 offset:26624
  v_mfma_f32_16x16x32_bf16 v[80:83], a[40:43], v[164:167], v[80:83]
  buffer_load_dwordx2 v[246:247], v25, s[16:19], s29 offen offset:3072 sc1
  v_mfma_f32_16x16x32_bf16 v[84:87], a[44:47], v[164:167], v[84:87]
  s_waitcnt lgkmcnt(3)
  v_mfma_f32_16x16x32_bf16 v[88:91], a[36:39], v[168:171], v[88:91]
  ds_read_b128 v[184:187], v15 offset:28672
  v_mfma_f32_16x16x32_bf16 v[92:95], a[40:43], v[168:171], v[92:95]
  v_mfma_f32_16x16x32_bf16 v[96:99], a[44:47], v[168:171], v[96:99]
  s_waitcnt lgkmcnt(3)
  v_mfma_f32_16x16x32_bf16 v[100:103], a[36:39], v[172:175], v[100:103]
  ds_read_b128 v[188:191], v15 offset:30720
  v_mfma_f32_16x16x32_bf16 v[104:107], a[40:43], v[172:175], v[104:107]
  v_mfma_f32_16x16x32_bf16 v[108:111], a[44:47], v[172:175], v[108:111]
  s_waitcnt lgkmcnt(3)
  v_mfma_f32_16x16x32_bf16 v[112:115], a[36:39], v[176:179], v[112:115]
  s_waitcnt vmcnt(28)
  s_barrier
  ds_read_b128 v[160:163], v14 offset:32768
  v_mfma_f32_16x16x32_bf16 v[116:119], a[40:43], v[176:179], v[116:119]
  v_mfma_f32_16x16x32_bf16 v[120:123], a[44:47], v[176:179], v[120:123]
  s_waitcnt lgkmcnt(3)
  v_mfma_f32_16x16x32_bf16 v[124:127], a[36:39], v[180:183], v[124:127]
  ds_read_b128 v[164:167], v14 offset:34816
  v_mfma_f32_16x16x32_bf16 v[128:131], a[40:43], v[180:183], v[128:131]
  v_mfma_f32_16x16x32_bf16 v[132:135], a[44:47], v[180:183], v[132:135]
  s_waitcnt lgkmcnt(3)
  v_mfma_f32_16x16x32_bf16 v[136:139], a[36:39], v[184:187], v[136:139]
  ds_read_b128 v[168:171], v14 offset:36864
  v_mfma_f32_16x16x32_bf16 v[140:143], a[40:43], v[184:187], v[140:143]
  v_mfma_f32_16x16x32_bf16 v[144:147], a[44:47], v[184:187], v[144:147]
  s_waitcnt lgkmcnt(3)
  v_mfma_f32_16x16x32_bf16 v[148:151], a[36:39], v[188:191], v[148:151]
  ds_read_b128 v[172:175], v14 offset:38912
  v_mfma_f32_16x16x32_bf16 v[152:155], a[40:43], v[188:191], v[152:155]
  v_mfma_f32_16x16x32_bf16 v[156:159], a[44:47], v[188:191], v[156:159]
  s_waitcnt lgkmcnt(3)
  v_mfma_f32_16x16x32_bf16 v[64:67], a[48:51], v[160:163], v[64:67]
  ds_read_b128 v[176:179], v14 offset:40960
  v_mfma_f32_16x16x32_bf16 v[68:71], a[52:55], v[160:163], v[68:71]
  s_add_u32 m0, s31, 0
  v_mfma_f32_16x16x32_bf16 v[72:75], a[56:59], v[160:163], v[72:75]
  s_waitcnt lgkmcnt(3)
  buffer_load_dwordx4 v10, s[8:11], s30 offen lds
  v_mfma_f32_16x16x32_bf16 v[76:79], a[48:51], v[164:167], v[76:79]
  ds_read_b128 v[180:183], v14 offset:43008
  v_mfma_f32_16x16x32_bf16 v[80:83], a[52:55], v[164:167], v[80:83]
  v_mfma_f32_16x16x32_bf16 v[84:87], a[56:59], v[164:167], v[84:87]
  s_waitcnt lgkmcnt(3)
  v_mfma_f32_16x16x32_bf16 v[88:91], a[48:51], v[168:171], v[88:91]
  ds_read_b128 v[184:187], v14 offset:45056
  v_mfma_f32_16x16x32_bf16 v[92:95], a[52:55], v[168:171], v[92:95]
  s_add_u32 m0, s31, 1024
  v_mfma_f32_16x16x32_bf16 v[96:99], a[56:59], v[168:171], v[96:99]
  s_waitcnt lgkmcnt(3)
  buffer_load_dwordx4 v11, s[8:11], s30 offen lds
  v_mfma_f32_16x16x32_bf16 v[100:103], a[48:51], v[172:175], v[100:103]
  ds_read_b128 v[188:191], v14 offset:47104
  v_mfma_f32_16x16x32_bf16 v[104:107], a[52:55], v[172:175], v[104:107]
  v_mfma_f32_16x16x32_bf16 v[108:111], a[56:59], v[172:175], v[108:111]
  s_waitcnt lgkmcnt(3)
  v_mfma_f32_16x16x32_bf16 v[112:115], a[48:51], v[176:179], v[112:115]
  ds_read_b128 v[160:163], v15 offset:32768
  v_mfma_f32_16x16x32_bf16 v[116:119], a[52:55], v[176:179], v[116:119]
  s_add_u32 m0, s31, 2048
  v_mfma_f32_16x16x32_bf16 v[120:123], a[56:59], v[176:179], v[120:123]
  s_waitcnt lgkmcnt(3)
  buffer_load_dwordx4 v12, s[8:11], s30 offen lds
  v_mfma_f32_16x16x32_bf16 v[124:127], a[48:51], v[180:183], v[124:127]
  ds_read_b128 v[164:167], v15 offset:34816
  v_mfma_f32_16x16x32_bf16 v[128:131], a[52:55], v[180:183], v[128:131]
  v_mfma_f32_16x16x32_bf16 v[132:135], a[56:59], v[180:183], v[132:135]
  s_waitcnt lgkmcnt(3)
  v_mfma_f32_16x16x32_bf16 v[136:139], a[48:51], v[184:187], v[136:139]
  ds_read_b128 v[168:171], v15 offset:36864
  v_mfma_f32_16x16x32_bf16 v[140:143], a[52:55], v[184:187], v[140:143]
  s_add_u32 m0, s31, 3072
  v_mfma_f32_16x16x32_bf16 v[144:147], a[56:59], v[184:187], v[144:147]
  s_waitcnt lgkmcnt(3)
  buffer_load_dwordx4 v13, s[8:11], s30 offen lds
  v_mfma_f32_16x16x32_bf16 v[148:151], a[48:51], v[188:191], v[148:151]
  s_add_u32 s30, s30, 128
  ds_read_b128 v[172:175], v15 offset:38912
  v_mfma_f32_16x16x32_bf16 v[152:155], a[52:55], v[188:191], v[152:155]
  v_mfma_f32_16x16x32_bf16 v[156:159], a[56:59], v[188:191], v[156:159]
  s_waitcnt lgkmcnt(3)
  v_mfma_f32_16x16x32_bf16 v[64:67], a[60:63], v[160:163], v[64:67]
  ds_read_b128 v[176:179], v15 offset:40960
  v_mfma_f32_16x16x32_bf16 v[68:71], a[64:67], v[160:163], v[68:71]
  v_mfma_f32_16x16x32_bf16 v[72:75], a[68:71], v[160:163], v[72:75]
  s_waitcnt lgkmcnt(3)
  v_mfma_f32_16x16x32_bf16 v[76:79], a[60:63], v[164:167], v[76:79]
  ds_read_b128 v[180:183], v15 offset:43008
  v_mfma_f32_16x16x32_bf16 v[80:83], a[64:67], v[164:167], v[80:83]
  v_mfma_f32_16x16x32_bf16 v[84:87], a[68:71], v[164:167], v[84:87]
  s_waitcnt lgkmcnt(3)
  v_mfma_f32_16x16x32_bf16 v[88:91], a[60:63], v[168:171], v[88:91]
  ds_read_b128 v[184:187], v15 offset:45056
  v_mfma_f32_16x16x32_bf16 v[92:95], a[64:67], v[168:171], v[92:95]
  v_mfma_f32_16x16x32_bf16 v[96:99], a[68:71], v[168:171], v[96:99]
  s_waitcnt lgkmcnt(3)
  v_mfma_f32_16x16x32_bf16 v[100:103], a[60:63], v[172:175], v[100:103]
  ds_read_b128 v[188:191], v15 offset:47104
  v_mfma_f32_16x16x32_bf16 v[104:107], a[64:67], v[172:175], v[104:107]
  v_mfma_f32_16x16x32_bf16 v[108:111], a[68:71], v[172:175], v[108:111]
  s_waitcnt lgkmcnt(3)
  v_mfma_f32_16x16x32_bf16 v[112:115], a[60:63], v[176:179], v[112:115]
  s_waitcnt vmcnt(28)
  s_barrier
  ds_read_b128 v[160:163], v14 offset:49152
  v_mfma_f32_16x16x32_bf16 v[116:119], a[64:67], v[176:179], v[116:119]
  v_mfma_f32_16x16x32_bf16 v[120:123], a[68:71], v[176:179], v[120:123]
  s_waitcnt lgkmcnt(3)
  v_mfma_f32_16x16x32_bf16 v[124:127], a[60:63], v[180:183], v[124:127]
  ds_read_b128 v[164:167], v14 offset:51200
  v_mfma_f32_16x16x32_bf16 v[128:131], a[64:67], v[180:183], v[128:131]
  v_mfma_f32_16x16x32_bf16 v[132:135], a[68:71], v[180:183], v[132:135]
  s_waitcnt lgkmcnt(3)
  v_mfma_f32_16x16x32_bf16 v[136:139], a[60:63], v[184:187], v[136:139]
  ds_read_b128 v[168:171], v14 offset:53248
  v_mfma_f32_16x16x32_bf16 v[140:143], a[64:67], v[184:187], v[140:143]
  v_mfma_f32_16x16x32_bf16 v[144:147], a[68:71], v[184:187], v[144:147]
  s_waitcnt lgkmcnt(3)
  v_mfma_f32_16x16x32_bf16 v[148:151], a[60:63], v[188:191], v[148:151]
  ds_read_b128 v[172:175], v14 offset:55296
  v_mfma_f32_16x16x32_bf16 v[152:155], a[64:67], v[188:191], v[152:155]
  v_mfma_f32_16x16x32_bf16 v[156:159], a[68:71], v[188:191], v[156:159]
  s_waitcnt lgkmcnt(3)
  v_mfma_f32_16x16x32_bf16 v[64:67], a[72:75], v[160:163], v[64:67]
  ds_read_b128 v[176:179], v14 offset:57344
  v_mfma_f32_16x16x32_bf16 v[68:71], a[76:79], v[160:163], v[68:71]
  s_add_u32 m0, s31, 16384
  v_mfma_f32_16x16x32_bf16 v[72:75], a[80:83], v[160:163], v[72:75]
  s_waitcnt lgkmcnt(3)
  buffer_load_dwordx4 v10, s[8:11], s30 offen lds
  v_mfma_f32_16x16x32_bf16 v[76:79], a[72:75], v[164:167], v[76:79]
  ds_read_b128 v[180:183], v14 offset:59392
  v_mfma_f32_16x16x32_bf16 v[80:83], a[76:79], v[164:167], v[80:83]
  v_mfma_f32_16x16x32_bf16 v[84:87], a[80:83], v[164:167], v[84:87]
  s_waitcnt lgkmcnt(3)
  v_mfma_f32_16x16x32_bf16 v[88:91], a[72:75], v[168:171], v[88:91]
  ds_read_b128 v[184:187], v14 offset:61440
  v_mfma_f32_16x16x32_bf16 v[92:95], a[76:79], v[168:171], v[92:95]
  s_add_u32 m0, s31, 17408
  v_mfma_f32_16x16x32_bf16 v[96:99], a[80:83], v[168:171], v[96:99]
  s_waitcnt lgkmcnt(3)
  buffer_load_dwordx4 v11, s[8:11], s30 offen lds
  v_mfma_f32_16x16x32_bf16 v[100:103], a[72:75], v[172:175], v[100:103]
  ds_read_b128 v[188:191], v14 offset:63488
  v_mfma_f32_16x16x32_bf16 v[104:107], a[76:79], v[172:175], v[104:107]
  v_mfma_f32_16x16x32_bf16 v[108:111], a[80:83], v[172:175], v[108:111]
  s_waitcnt lgkmcnt(3)
  v_mfma_f32_16x16x32_bf16 v[112:115], a[72:75], v[176:179], v[112:115]
  ds_read_b128 v[160:163], v15 offset:49152
  v_mfma_f32_16x16x32_bf16 v[116:119], a[76:79], v[176:179], v[116:119]
  s_add_u32 m0, s31, 18432
  v_mfma_f32_16x16x32_bf16 v[120:123], a[80:83], v[176:179], v[120:123]
  s_waitcnt lgkmcnt(3)
  buffer_load_dwordx4 v12, s[8:11], s30 offen lds
  v_mfma_f32_16x16x32_bf16 v[124:127], a[72:75], v[180:183], v[124:127]
  ds_read_b128 v[164:167], v15 offset:51200
  v_mfma_f32_16x16x32_bf16 v[128:131], a[76:79], v[180:183], v[128:131]
  v_mfma_f32_16x16x32_bf16 v[132:135], a[80:83], v[180:183], v[132:135]
  s_waitcnt lgkmcnt(3)
  v_mfma_f32_16x16x32_bf16 v[136:139], a[72:75], v[184:187], v[136:139]
  ds_read_b128 v[168:171], v15 offset:53248
  v_mfma_f32_16x16x32_bf16 v[140:143], a[76:79], v[184:187], v[140:143]
  s_add_u32 m0, s31, 19456
  v_mfma_f32_16x16x32_bf16 v[144:147], a[80:83], v[184:187], v[144:147]
  s_waitcnt lgkmcnt(3)
  buffer_load_dwordx4 v13, s[8:11], s30 offen lds
  v_mfma_f32_16x16x32_bf16 v[148:151], a[72:75], v[188:191], v[148:151]
  s_add_u32 s30, s30, 128
  ds_read_b128 v[172:175], v15 offset:55296
  v_mfma_f32_16x16x32_bf16 v[152:155], a[76:79], v[188:191], v[152:155]
  v_mfma_f32_16x16x32_bf16 v[156:159], a[80:83], v[188:191], v[156:159]
  s_waitcnt lgkmcnt(3)
  v_mfma_f32_16x16x32_bf16 v[64:67], a[84:87], v[160:163], v[64:67]
  ds_read_b128 v[176:179], v15 offset:57344
  v_mfma_f32_16x16x32_bf16 v[68:71], a[88:91], v[160:163], v[68:71]
  v_mfma_f32_16x16x32_bf16 v[72:75], a[92:95], v[160:163], v[72:75]
  s_waitcnt lgkmcnt(3)
  v_mfma_f32_16x16x32_bf16 v[76:79], a[84:87], v[164:167], v[76:79]
  ds_read_b128 v[180:183], v15 offset:59392
  v_mfma_f32_16x16x32_bf16 v[80:83], a[88:91], v[164:167], v[80:83]
  v_mfma_f32_16x16x32_bf16 v[84:87], a[92:95], v[164:167], v[84:87]
  s_waitcnt lgkmcnt(3)
  v_mfma_f32_16x16x32_bf16 v[88:91], a[84:87], v[168:171], v[88:91]
  ds_read_b128 v[184:187], v15 offset:61440
  v_mfma_f32_16x16x32_bf16 v[92:95], a[88:91], v[168:171], v[92:95]
  v_mfma_f32_16x16x32_bf16 v[96:99], a[92:95], v[168:171], v[96:99]
  s_waitcnt lgkmcnt(3)
  v_mfma_f32_16x16x32_bf16 v[100:103], a[84:87], v[172:175], v[100:103]
  ds_read_b128 v[188:191], v15 offset:63488
  v_mfma_f32_16x16x32_bf16 v[104:107], a[88:91], v[172:175], v[104:107]
  v_mfma_f32_16x16x32_bf16 v[108:111], a[92:95], v[172:175], v[108:111]
  s_waitcnt lgkmcnt(3)
  v_mfma_f32_16x16x32_bf16 v[112:115], a[84:87], v[176:179], v[112:115]
  s_waitcnt vmcnt(12)
  s_barrier
  ds_read_b128 v[160:163], v16 offset:0
  v_mfma_f32_16x16x32_bf16 v[116:119], a[88:91], v[176:179], v[116:119]
  v_mfma_f32_16x16x32_bf16 v[120:123], a[92:95], v[176:179], v[120:123]
  s_waitcnt lgkmcnt(3)
  v_mfma_f32_16x16x32_bf16 v[124:127], a[84:87], v[180:183], v[124:127]
  ds_read_b128 v[164:167], v16 offset:2048
  v_mfma_f32_16x16x32_bf16 v[128:131], a[88:91], v[180:183], v[128:131]
  v_mfma_f32_16x16x32_bf16 v[132:135], a[92:95], v[180:183], v[132:135]
  s_waitcnt lgkmcnt(3)
  v_mfma_f32_16x16x32_bf16 v[136:139], a[84:87], v[184:187], v[136:139]
  ds_read_b128 v[168:171], v16 offset:4096
  v_mfma_f32_16x16x32_bf16 v[140:143], a[88:91], v[184:187], v[140:143]
  v_mfma_f32_16x16x32_bf16 v[144:147], a[92:95], v[184:187], v[144:147]
  s_waitcnt lgkmcnt(3)
  v_mfma_f32_16x16x32_bf16 v[148:151], a[84:87], v[188:191], v[148:151]
  ds_read_b128 v[172:175], v16 offset:6144
  s_waitcnt vmcnt(8)
  v_mfma_f32_16x16x32_bf16 v[152:155], a[88:91], v[188:191], v[152:155]
  v_swap_b32 v226, v228
  v_swap_b32 v227, v229
  v_mfma_f32_16x16x32_bf16 v[156:159], a[92:95], v[188:191], v[156:159]
  s_waitcnt lgkmcnt(3)
  v_swap_b32 v234, v236
  v_swap_b32 v235, v237
  v_mfma_f32_16x16x32_bf16 v[64:67], a[96:99], v[160:163], v[64:67]
  ds_read_b128 v[176:179], v16 offset:8192
  v_mfma_f32_16x16x32_bf16 v[68:71], a[100:103], v[160:163], v[68:71]
  s_add_u32 m0, s31, 32768
  ds_read_b128 v[56:59], v21 offset:0
  ds_read_b128 v[60:63], v21 offset:1024
  v_mfma_f32_16x16x32_bf16 v[72:75], a[104:107], v[160:163], v[72:75]
  s_waitcnt lgkmcnt(5)
  buffer_load_dwordx4 v10, s[8:11], s30 offen lds
  v_mfma_f32_16x16x32_bf16 v[76:79], a[96:99], v[164:167], v[76:79]
  ds_read_b128 v[180:183], v16 offset:10240
  v_mfma_f32_16x16x32_bf16 v[80:83], a[100:103], v[164:167], v[80:83]
  v_mfma_f32_16x16x32_bf16 v[84:87], a[104:107], v[164:167], v[84:87]
  s_waitcnt lgkmcnt(5)
  v_mfma_f32_16x16x32_bf16 v[88:91], a[96:99], v[168:171], v[88:91]
  ds_read_b128 v[184:187], v16 offset:12288
  v_mfma_f32_16x16x32_bf16 v[92:95], a[100:103], v[168:171], v[92:95]
  s_add_u32 m0, s31, 33792
  ds_read_b128 v[248:251], v21 offset:3072
  ds_read_b128 v[252:255], v21 offset:4096
  v_mfma_f32_16x16x32_bf16 v[96:99], a[104:107], v[168:171], v[96:99]
  s_waitcnt lgkmcnt(4)
  buffer_load_dwordx4 v11, s[8:11], s30 offen lds
  v_mfma_f32_16x16x32_bf16 v[36:39], v[192:195], v[56:59], 0
  v_mfma_f32_16x16x32_bf16 v[44:47], v[192:195], v[60:63], 0
  v_mfma_f32_16x16x32_bf16 v[48:51], v[196:199], v[60:63], 0
  v_mfma_f32_16x16x32_bf16 v[40:43], a[240:243], v[56:59], 0
  v_mfma_f32_16x16x32_bf16 v[52:55], a[240:243], v[60:63], 0
  s_waitcnt lgkmcnt(7)
  ds_read2st64_b64 v[56:59], v22 offset0:0 offset1:6
  ds_read2st64_b64 v[60:63], v23 offset0:0 offset1:6
  v_mfma_f32_16x16x32_bf16 v[100:103], a[96:99], v[172:175], v[100:103]
  ds_read_b128 v[188:191], v16 offset:14336
  v_mfma_f32_16x16x32_bf16 v[104:107], a[100:103], v[172:175], v[104:107]
  v_mfma_f32_16x16x32_bf16 v[108:111], a[104:107], v[172:175], v[108:111]
  s_waitcnt lgkmcnt(9)
  v_mfma_f32_16x16x32_bf16 v[112:115], a[96:99], v[176:179], v[112:115]
  ds_read_b128 v[160:163], v17 offset:0
  v_mfma_f32_16x16x32_bf16 v[116:119], a[100:103], v[176:179], v[116:119]
  s_add_u32 m0, s31, 34816
  v_mfma_f32_16x16x32_bf16 v[120:123], a[104:107], v[176:179], v[120:123]
  s_waitcnt lgkmcnt(4)
  buffer_load_dwordx4 v12, s[8:11], s30 offen lds
  v_mfma_f32_16x16x32_bf16 v[36:39], v[200:203], v[248:251], v[36:39]
  v_mfma_f32_16x16x32_bf16 v[44:47], v[200:203], v[252:255], v[44:47]
  v_mfma_f32_16x16x32_bf16 v[48:51], v[204:207], v[252:255], v[48:51]
  v_mfma_f32_16x16x32_bf16 v[40:43], a[244:247], v[248:251], v[40:43]
  v_mfma_f32_16x16x32_bf16 v[52:55], a[244:247], v[252:255], v[52:55]
  s_waitcnt lgkmcnt(7)
  ds_read_b128 v[248:251], v21 offset:6144
  ds_read_b128 v[252:255], v21 offset:7168
  v_mfma_f32_16x16x32_bf16 v[124:127], a[96:99], v[180:183], v[124:127]
  ds_read_b128 v[164:167], v17 offset:2048
  v_mfma_f32_16x16x32_bf16 v[128:131], a[100:103], v[180:183], v[128:131]
  v_mfma_f32_16x16x32_bf16 v[132:135], a[104:107], v[180:183], v[132:135]
  s_waitcnt lgkmcnt(9)
  v_mfma_f32_16x16x32_bf16 v[136:139], a[96:99], v[184:187], v[136:139]
  ds_read_b128 v[168:171], v17 offset:4096
  v_mfma_f32_16x16x32_bf16 v[140:143], a[100:103], v[184:187], v[140:143]
  s_add_u32 m0, s31, 35840
  v_mfma_f32_16x16x32_bf16 v[144:147], a[104:107], v[184:187], v[144:147]
  s_waitcnt lgkmcnt(6)
  buffer_load_dwordx4 v13, s[8:11], s30 offen lds
  v_mfma_f32_16x16x32_bf16 v[36:39], v[224:227], v[56:59], v[36:39]
  s_add_u32 s30, s30, 128
  v_mfma_f32_16x16x32_bf16 v[44:47], v[224:227], v[60:63], v[44:47]
  v_mfma_f32_16x16x32_bf16 v[48:51], v[228:231], v[60:63], v[48:51]
  v_mfma_f32_16x16x32_bf16 v[40:43], v[240:243], v[56:59], v[40:43]
  v_mfma_f32_16x16x32_bf16 v[52:55], v[240:243], v[60:63], v[52:55]
  s_waitcnt lgkmcnt(5)
  ds_read_b128 v[56:59], v21 offset:9216
  ds_read_b128 v[60:63], v21 offset:10240
  v_mfma_f32_16x16x32_bf16 v[148:151], a[96:99], v[188:191], v[148:151]
  ds_read_b128 v[172:175], v17 offset:6144
  v_mfma_f32_16x16x32_bf16 v[152:155], a[100:103], v[188:191], v[152:155]
  v_mfma_f32_16x16x32_bf16 v[156:159], a[104:107], v[188:191], v[156:159]
  s_waitcnt lgkmcnt(7)
  v_mfma_f32_16x16x32_bf16 v[64:67], a[108:111], v[160:163], v[64:67]
  ds_read_b128 v[176:179], v17 offset:8192
  v_mfma_f32_16x16x32_bf16 v[68:71], a[112:115], v[160:163], v[68:71]
  v_mfma_f32_16x16x32_bf16 v[72:75], a[116:119], v[160:163], v[72:75]
  s_waitcnt lgkmcnt(6)
  v_mfma_f32_16x16x32_bf16 v[36:39], v[208:211], v[248:251], v[36:39]
  v_mfma_f32_16x16x32_bf16 v[44:47], v[208:211], v[252:255], v[44:47]
  v_mfma_f32_16x16x32_bf16 v[48:51], v[212:215], v[252:255], v[48:51]
  v_mfma_f32_16x16x32_bf16 v[40:43], a[248:251], v[248:251], v[40:43]
  v_mfma_f32_16x16x32_bf16 v[52:55], a[248:251], v[252:255], v[52:55]
  s_waitcnt lgkmcnt(5)
  ds_read2st64_b64 v[248:251], v22 offset0:12 offset1:18
  ds_read2st64_b64 v[252:255], v23 offset0:12 offset1:18
  v_mfma_f32_16x16x32_bf16 v[76:79], a[108:111], v[164:167], v[76:79]
  ds_read_b128 v[180:183], v17 offset:10240
  v_mfma_f32_16x16x32_bf16 v[80:83], a[112:115], v[164:167], v[80:83]
  v_mfma_f32_16x16x32_bf16 v[84:87], a[116:119], v[164:167], v[84:87]
  s_waitcnt lgkmcnt(7)
  v_mfma_f32_16x16x32_bf16 v[88:91], a[108:111], v[168:171], v[88:91]
  ds_read_b128 v[184:187], v17 offset:12288
  v_mfma_f32_16x16x32_bf16 v[92:95], a[112:115], v[168:171], v[92:95]
  v_mfma_f32_16x16x32_bf16 v[96:99], a[116:119], v[168:171], v[96:99]
  s_waitcnt lgkmcnt(6)
  v_mfma_f32_16x16x32_bf16 v[36:39], v[216:219], v[56:59], v[36:39]
  v_mfma_f32_16x16x32_bf16 v[44:47], v[216:219], v[60:63], v[44:47]
  v_mfma_f32_16x16x32_bf16 v[48:51], v[220:223], v[60:63], v[48:51]
  v_mfma_f32_16x16x32_bf16 v[40:43], a[252:255], v[56:59], v[40:43]
  v_mfma_f32_16x16x32_bf16 v[52:55], a[252:255], v[60:63], v[52:55]
  s_waitcnt lgkmcnt(5)
  v_mfma_f32_16x16x32_bf16 v[100:103], a[108:111], v[172:175], v[100:103]
  ds_read_b128 v[188:191], v17 offset:14336
  v_mfma_f32_16x16x32_bf16 v[104:107], a[112:115], v[172:175], v[104:107]
  v_mfma_f32_16x16x32_bf16 v[108:111], a[116:119], v[172:175], v[108:111]
  s_waitcnt lgkmcnt(5)
  v_mfma_f32_16x16x32_bf16 v[112:115], a[108:111], v[176:179], v[112:115]
  s_waitcnt vmcnt(8)
  s_barrier
  ds_read_b128 v[160:163], v14 offset:0
  v_mfma_f32_16x16x32_bf16 v[116:119], a[112:115], v[176:179], v[116:119]
  v_mfma_f32_16x16x32_bf16 v[120:123], a[116:119], v[176:179], v[120:123]
  s_waitcnt lgkmcnt(4)
  v_mfma_f32_16x16x32_bf16 v[36:39], v[232:235], v[248:251], v[36:39]
  v_mfma_f32_16x16x32_bf16 v[44:47], v[232:235], v[252:255], v[44:47]
  v_mfma_f32_16x16x32_bf16 v[48:51], v[236:239], v[252:255], v[48:51]
  v_mfma_f32_16x16x32_bf16 v[40:43], v[244:247], v[248:251], v[40:43]
  v_mfma_f32_16x16x32_bf16 v[52:55], v[244:247], v[252:255], v[52:55]
  s_waitcnt lgkmcnt(3)
  v_mfma_f32_16x16x32_bf16 v[124:127], a[108:111], v[180:183], v[124:127]
  ds_read_b128 v[164:167], v14 offset:2048
  v_mfma_f32_16x16x32_bf16 v[128:131], a[112:115], v[180:183], v[128:131]
  v_mfma_f32_16x16x32_bf16 v[132:135], a[116:119], v[180:183], v[132:135]
  s_waitcnt lgkmcnt(3)
  v_cndmask_b32 v36, v31, v36, s[64:65]
  v_cndmask_b32 v48, v31, v48, s[64:65]
  v_mfma_f32_16x16x32_bf16 v[136:139], a[108:111], v[184:187], v[136:139]
  ds_read_b128 v[168:171], v14 offset:4096
  v_cndmask_b32 v37, v31, v37, s[66:67]
  v_mfma_f32_16x16x32_bf16 v[140:143], a[112:115], v[184:187], v[140:143]
  v_cndmask_b32 v49, v31, v49, s[66:67]
  v_cndmask_b32 v38, v31, v38, s[68:69]
  v_mfma_f32_16x16x32_bf16 v[144:147], a[116:119], v[184:187], v[144:147]
  s_waitcnt lgkmcnt(3)
  v_cndmask_b32 v50, v31, v50, s[68:69]
  v_cndmask_b32 v39, v31, v39, s[70:71]
  v_mfma_f32_16x16x32_bf16 v[148:151], a[108:111], v[188:191], v[148:151]
  ds_read_b128 v[172:175], v14 offset:6144
  v_cndmask_b32 v51, v31, v51, s[70:71]
  v_mfma_f32_16x16x32_bf16 v[152:155], a[112:115], v[188:191], v[152:155]
  v_max3_f32 v34, v36, v37, v38
  v_max3_f32 v34, v34, v39, v40
  v_mfma_f32_16x16x32_bf16 v[156:159], a[116:119], v[188:191], v[156:159]
  s_waitcnt lgkmcnt(3)
  v_max3_f32 v34, v34, v41, v42
  v_max_f32 v34, v34, v43
  v_mfma_f32_16x16x32_bf16 v[64:67], a[120:123], v[160:163], v[64:67]
  ds_read_b128 v[176:179], v14 offset:8192
  v_mov_b32 v35, v34
  v_mfma_f32_16x16x32_bf16 v[68:71], a[124:127], v[160:163], v[68:71]
  s_add_u32 m0, s31, 49152
  v_permlane32_swap_b32 v34, v35
  v_max_f32 v34, v34, v35
  v_mfma_f32_16x16x32_bf16 v[72:75], a[128:131], v[160:163], v[72:75]
  s_waitcnt lgkmcnt(3)
  buffer_load_dwordx4 v10, s[8:11], s30 offen lds
  v_mov_b32 v35, v34
  v_mfma_f32_16x16x32_bf16 v[76:79], a[120:123], v[164:167], v[76:79]
  ds_read_b128 v[180:183], v14 offset:10240
  v_permlane16_swap_b32 v34, v35
  v_mfma_f32_16x16x32_bf16 v[80:83], a[124:127], v[164:167], v[80:83]
  v_max_f32 v34, v34, v35
  v_mul_f32 v34, s83, v34
  v_mfma_f32_16x16x32_bf16 v[84:87], a[128:131], v[164:167], v[84:87]
  s_waitcnt lgkmcnt(3)
  v_fma_f32 v36, v36, s83, -v34
  v_fma_f32 v37, v37, s83, -v34
  v_mfma_f32_16x16x32_bf16 v[88:91], a[120:123], v[168:171], v[88:91]
  ds_read_b128 v[184:187], v14 offset:12288
  v_fma_f32 v38, v38, s83, -v34
  v_mfma_f32_16x16x32_bf16 v[92:95], a[124:127], v[168:171], v[92:95]
  s_add_u32 m0, s31, 50176
  v_fma_f32 v39, v39, s83, -v34
  v_fma_f32 v40, v40, s83, -v34
  v_mfma_f32_16x16x32_bf16 v[96:99], a[128:131], v[168:171], v[96:99]
  s_waitcnt lgkmcnt(3)
  buffer_load_dwordx4 v11, s[8:11], s30 offen lds
  v_fma_f32 v41, v41, s83, -v34
  v_mfma_f32_16x16x32_bf16 v[100:103], a[120:123], v[172:175], v[100:103]
  ds_read_b128 v[188:191], v14 offset:14336
  v_fma_f32 v42, v42, s83, -v34
  v_mfma_f32_16x16x32_bf16 v[104:107], a[124:127], v[172:175], v[104:107]
  v_fma_f32 v43, v43, s83, -v34
  v_mfma_f32_16x16x32_bf16 v[108:111], a[128:131], v[172:175], v[108:111]
  s_waitcnt lgkmcnt(3)
  v_exp_f32 v36, v36
  v_mfma_f32_16x16x32_bf16 v[112:115], a[120:123], v[176:179], v[112:115]
  ds_read_b128 v[160:163], v15 offset:0
  v_mfma_f32_16x16x32_bf16 v[116:119], a[124:127], v[176:179], v[116:119]
  s_add_u32 m0, s31, 51200
  v_exp_f32 v37, v37
  v_mfma_f32_16x16x32_bf16 v[120:123], a[128:131], v[176:179], v[120:123]
  s_waitcnt lgkmcnt(3)
  buffer_load_dwordx4 v12, s[8:11], s30 offen lds
  v_mfma_f32_16x16x32_bf16 v[124:127], a[120:123], v[180:183], v[124:127]
  ds_read_b128 v[164:167], v15 offset:2048
  v_mfma_f32_16x16x32_bf16 v[128:131], a[124:127], v[180:183], v[128:131]
  v_exp_f32 v38, v38
  v_mfma_f32_16x16x32_bf16 v[132:135], a[128:131], v[180:183], v[132:135]
  s_waitcnt lgkmcnt(3)
  v_exp_f32 v39, v39
  v_mfma_f32_16x16x32_bf16 v[136:139], a[120:123], v[184:187], v[136:139]
  ds_read_b128 v[168:171], v15 offset:4096
  v_mfma_f32_16x16x32_bf16 v[140:143], a[124:127], v[184:187], v[140:143]
  s_add_u32 m0, s31, 52224
  v_exp_f32 v40, v40
  v_mfma_f32_16x16x32_bf16 v[144:147], a[128:131], v[184:187], v[144:147]
  s_waitcnt lgkmcnt(3)
  buffer_load_dwordx4 v13, s[8:11], s30 offen lds
  v_mfma_f32_16x16x32_bf16 v[148:151], a[120:123], v[188:191], v[148:151]
  s_add_u32 s30, s30, 128
  ds_read_b128 v[172:175], v15 offset:6144
  v_mfma_f32_16x16x32_bf16 v[152:155], a[124:127], v[188:191], v[152:155]
  v_exp_f32 v41, v41
  v_mfma_f32_16x16x32_bf16 v[156:159], a[128:131], v[188:191], v[156:159]
  s_waitcnt lgkmcnt(3)
  v_exp_f32 v42, v42
  v_mfma_f32_16x16x32_bf16 v[64:67], a[132:135], v[160:163], v[64:67]
  ds_read_b128 v[176:179], v15 offset:8192
  v_mfma_f32_16x16x32_bf16 v[68:71], a[136:139], v[160:163], v[68:71]
  v_exp_f32 v43, v43
  v_mfma_f32_16x16x32_bf16 v[72:75], a[140:143], v[160:163], v[72:75]
  s_waitcnt lgkmcnt(3)
  v_add_f32 v34, v40, v41
  v_add_f32 v34, v34, v42
  v_mfma_f32_16x16x32_bf16 v[76:79], a[132:135], v[164:167], v[76:79]
  ds_read_b128 v[180:183], v15 offset:10240
  v_add_f32 v34, v34, v43
  v_mfma_f32_16x16x32_bf16 v[80:83], a[136:139], v[164:167], v[80:83]
  v_cndmask_b32 v34, 0, v34, s[62:63]
  v_add_f32 v34, v34, v36
  v_mfma_f32_16x16x32_bf16 v[84:87], a[140:143], v[164:167], v[84:87]
  s_waitcnt lgkmcnt(3)
  v_add_f32 v34, v34, v37
  v_add_f32 v34, v34, v38
  v_mfma_f32_16x16x32_bf16 v[88:91], a[132:135], v[168:171], v[88:91]
  ds_read_b128 v[184:187], v15 offset:12288
  v_add_f32 v34, v34, v39
  v_mfma_f32_16x16x32_bf16 v[92:95], a[136:139], v[168:171], v[92:95]
  v_mov_b32 v35, v34
  v_mfma_f32_16x16x32_bf16 v[96:99], a[140:143], v[168:171], v[96:99]
  s_waitcnt lgkmcnt(3)
  v_permlane32_swap_b32 v34, v35
  v_add_f32 v34, v34, v35
  v_mfma_f32_16x16x32_bf16 v[100:103], a[132:135], v[172:175], v[100:103]
  ds_read_b128 v[188:191], v15 offset:14336
  v_mov_b32 v35, v34
  v_mfma_f32_16x16x32_bf16 v[104:107], a[136:139], v[172:175], v[104:107]
  v_permlane16_swap_b32 v34, v35
  v_add_f32 v34, v34, v35
  v_mfma_f32_16x16x32_bf16 v[108:111], a[140:143], v[172:175], v[108:111]
  s_waitcnt lgkmcnt(3)
  v_rcp_f32 v34, v34
  v_mfma_f32_16x16x32_bf16 v[112:115], a[132:135], v[176:179], v[112:115]
  s_waitcnt vmcnt(8)
  s_barrier
  ds_read_b128 v[160:163], v14 offset:16384
  v_mfma_f32_16x16x32_bf16 v[116:119], a[136:139], v[176:179], v[116:119]
  v_mul_f32 v36, v36, v34
  v_mul_f32 v37, v37, v34
  v_mfma_f32_16x16x32_bf16 v[120:123], a[140:143], v[176:179], v[120:123]
  s_waitcnt lgkmcnt(3)
  v_mul_f32 v38, v38, v34
  v_mul_f32 v39, v39, v34
  v_mfma_f32_16x16x32_bf16 v[124:127], a[132:135], v[180:183], v[124:127]
  ds_read_b128 v[164:167], v14 offset:18432
  v_mul_f32 v40, v40, v34
  v_mfma_f32_16x16x32_bf16 v[128:131], a[136:139], v[180:183], v[128:131]
  v_mul_f32 v41, v41, v34
  v_mul_f32 v42, v42, v34
  v_mfma_f32_16x16x32_bf16 v[132:135], a[140:143], v[180:183], v[132:135]
  s_waitcnt lgkmcnt(3)
  v_mul_f32 v43, v43, v34
  v_max3_f32 v34, v44, v45, v46
  v_mfma_f32_16x16x32_bf16 v[136:139], a[132:135], v[184:187], v[136:139]
  ds_read_b128 v[168:171], v14 offset:20480
  v_max3_f32 v34, v34, v47, v48
  v_mfma_f32_16x16x32_bf16 v[140:143], a[136:139], v[184:187], v[140:143]
  v_max3_f32 v34, v34, v49, v50
  v_max3_f32 v34, v34, v51, v52
  v_mfma_f32_16x16x32_bf16 v[144:147], a[140:143], v[184:187], v[144:147]
  s_waitcnt lgkmcnt(3)
  v_max3_f32 v34, v34, v53, v54
  v_max_f32 v34, v34, v55
  v_mfma_f32_16x16x32_bf16 v[148:151], a[132:135], v[188:191], v[148:151]
  ds_read_b128 v[172:175], v14 offset:22528
  v_mov_b32 v35, v34
  v_mfma_f32_16x16x32_bf16 v[152:155], a[136:139], v[188:191], v[152:155]
  v_permlane32_swap_b32 v34, v35
  v_max_f32 v34, v34, v35
  v_mfma_f32_16x16x32_bf16 v[156:159], a[140:143], v[188:191], v[156:159]
  s_waitcnt lgkmcnt(3)
  v_mov_b32 v35, v34
  v_mfma_f32_16x16x32_bf16 v[64:67], a[144:147], v[160:163], v[64:67]
  ds_read_b128 v[176:179], v14 offset:24576
  v_permlane16_swap_b32 v34, v35
  v_mfma_f32_16x16x32_bf16 v[68:71], a[148:151], v[160:163], v[68:71]
  s_add_u32 m0, s31, 65536
  v_max_f32 v34, v34, v35
  v_mul_f32 v34, s83, v34
  v_mfma_f32_16x16x32_bf16 v[72:75], a[152:155], v[160:163], v[72:75]
  s_waitcnt lgkmcnt(3)
  buffer_load_dwordx4 v10, s[8:11], s30 offen lds
  v_fma_f32 v44, v44, s83, -v34
  v_mfma_f32_16x16x32_bf16 v[76:79], a[144:147], v[164:167], v[76:79]
  ds_read_b128 v[180:183], v14 offset:26624
  v_fma_f32 v45, v45, s83, -v34
  v_mfma_f32_16x16x32_bf16 v[80:83], a[148:151], v[164:167], v[80:83]
  v_fma_f32 v46, v46, s83, -v34
  v_fma_f32 v47, v47, s83, -v34
  v_mfma_f32_16x16x32_bf16 v[84:87], a[152:155], v[164:167], v[84:87]
  s_waitcnt lgkmcnt(3)
  v_fma_f32 v48, v48, s83, -v34
  v_fma_f32 v49, v49, s83, -v34
  v_mfma_f32_16x16x32_bf16 v[88:91], a[144:147], v[168:171], v[88:91]
  ds_read_b128 v[184:187], v14 offset:28672
  v_fma_f32 v50, v50, s83, -v34
  v_mfma_f32_16x16x32_bf16 v[92:95], a[148:151], v[168:171], v[92:95]
  s_add_u32 m0, s31, 66560
  v_fma_f32 v51, v51, s83, -v34
  v_fma_f32 v52, v52, s83, -v34
  v_mfma_f32_16x16x32_bf16 v[96:99], a[152:155], v[168:171], v[96:99]
  s_waitcnt lgkmcnt(3)
  buffer_load_dwordx4 v11, s[8:11], s30 offen lds
  v_fma_f32 v53, v53, s83, -v34
  v_mfma_f32_16x16x32_bf16 v[100:103], a[144:147], v[172:175], v[100:103]
  ds_read_b128 v[188:191], v14 offset:30720
  v_fma_f32 v54, v54, s83, -v34
  v_mfma_f32_16x16x32_bf16 v[104:107], a[148:151], v[172:175], v[104:107]
  v_fma_f32 v55, v55, s83, -v34
  v_mfma_f32_16x16x32_bf16 v[108:111], a[152:155], v[172:175], v[108:111]
  s_waitcnt lgkmcnt(3)
  v_exp_f32 v44, v44
  v_mfma_f32_16x16x32_bf16 v[112:115], a[144:147], v[176:179], v[112:115]
  ds_read_b128 v[160:163], v15 offset:16384
  v_mfma_f32_16x16x32_bf16 v[116:119], a[148:151], v[176:179], v[116:119]
  s_add_u32 m0, s31, 67584
  v_exp_f32 v45, v45
  v_mfma_f32_16x16x32_bf16 v[120:123], a[152:155], v[176:179], v[120:123]
  s_waitcnt lgkmcnt(3)
  buffer_load_dwordx4 v12, s[8:11], s30 offen lds
  v_mfma_f32_16x16x32_bf16 v[124:127], a[144:147], v[180:183], v[124:127]
  ds_read_b128 v[164:167], v15 offset:18432
  v_mfma_f32_16x16x32_bf16 v[128:131], a[148:151], v[180:183], v[128:131]
  v_exp_f32 v46, v46
  v_mfma_f32_16x16x32_bf16 v[132:135], a[152:155], v[180:183], v[132:135]
  s_waitcnt lgkmcnt(3)
  v_exp_f32 v47, v47
  v_mfma_f32_16x16x32_bf16 v[136:139], a[144:147], v[184:187], v[136:139]
  ds_read_b128 v[168:171], v15 offset:20480
  v_mfma_f32_16x16x32_bf16 v[140:143], a[148:151], v[184:187], v[140:143]
  s_add_u32 m0, s31, 68608
  v_exp_f32 v48, v48
  v_mfma_f32_16x16x32_bf16 v[144:147], a[152:155], v[184:187], v[144:147]
  s_waitcnt lgkmcnt(3)
  buffer_load_dwordx4 v13, s[8:11], s30 offen lds
  v_mfma_f32_16x16x32_bf16 v[148:151], a[144:147], v[188:191], v[148:151]
  s_add_u32 s30, s30, s25
  ds_read_b128 v[172:175], v15 offset:22528
  v_mfma_f32_16x16x32_bf16 v[152:155], a[148:151], v[188:191], v[152:155]
  v_exp_f32 v49, v49
  v_mfma_f32_16x16x32_bf16 v[156:159], a[152:155], v[188:191], v[156:159]
  s_waitcnt lgkmcnt(3)
  v_exp_f32 v50, v50
  v_mfma_f32_16x16x32_bf16 v[64:67], a[156:159], v[160:163], v[64:67]
  ds_read_b128 v[176:179], v15 offset:24576
  v_mfma_f32_16x16x32_bf16 v[68:71], a[160:163], v[160:163], v[68:71]
  v_exp_f32 v51, v51
  v_mfma_f32_16x16x32_bf16 v[72:75], a[164:167], v[160:163], v[72:75]
  s_waitcnt lgkmcnt(3)
  v_exp_f32 v52, v52
  v_mfma_f32_16x16x32_bf16 v[76:79], a[156:159], v[164:167], v[76:79]
  ds_read_b128 v[180:183], v15 offset:26624
  v_mfma_f32_16x16x32_bf16 v[80:83], a[160:163], v[164:167], v[80:83]
  v_exp_f32 v53, v53
  v_mfma_f32_16x16x32_bf16 v[84:87], a[164:167], v[164:167], v[84:87]
  s_waitcnt lgkmcnt(3)
  v_exp_f32 v54, v54
  v_mfma_f32_16x16x32_bf16 v[88:91], a[156:159], v[168:171], v[88:91]
  ds_read_b128 v[184:187], v15 offset:28672
  v_mfma_f32_16x16x32_bf16 v[92:95], a[160:163], v[168:171], v[92:95]
  v_exp_f32 v55, v55
  v_mfma_f32_16x16x32_bf16 v[96:99], a[164:167], v[168:171], v[96:99]
  s_waitcnt lgkmcnt(3)
  v_add_f32 v34, v52, v53
  v_add_f32 v34, v34, v54
  v_mfma_f32_16x16x32_bf16 v[100:103], a[156:159], v[172:175], v[100:103]
  ds_read_b128 v[188:191], v15 offset:30720
  v_add_f32 v34, v34, v55
  v_mfma_f32_16x16x32_bf16 v[104:107], a[160:163], v[172:175], v[104:107]
  v_cndmask_b32 v34, 0, v34, s[62:63]
  v_add_f32 v34, v34, v44
  v_mfma_f32_16x16x32_bf16 v[108:111], a[164:167], v[172:175], v[108:111]
  s_waitcnt lgkmcnt(3)
  v_add_f32 v34, v34, v45
  v_add_f32 v34, v34, v46
  v_mfma_f32_16x16x32_bf16 v[112:115], a[156:159], v[176:179], v[112:115]
  s_waitcnt vmcnt(8)
  s_barrier
  ds_read_b128 v[160:163], v14 offset:32768
  v_mfma_f32_16x16x32_bf16 v[116:119], a[160:163], v[176:179], v[116:119]
  v_add_f32 v34, v34, v47
  v_add_f32 v34, v34, v48
  v_mfma_f32_16x16x32_bf16 v[120:123], a[164:167], v[176:179], v[120:123]
  s_waitcnt lgkmcnt(3)
  v_add_f32 v34, v34, v49
  v_add_f32 v34, v34, v50
  v_mfma_f32_16x16x32_bf16 v[124:127], a[156:159], v[180:183], v[124:127]
  ds_read_b128 v[164:167], v14 offset:34816
  v_add_f32 v34, v34, v51
  v_mfma_f32_16x16x32_bf16 v[128:131], a[160:163], v[180:183], v[128:131]
  v_mov_b32 v35, v34
  v_mfma_f32_16x16x32_bf16 v[132:135], a[164:167], v[180:183], v[132:135]
  s_waitcnt lgkmcnt(3)
  v_permlane32_swap_b32 v34, v35
  v_add_f32 v34, v34, v35
  v_mfma_f32_16x16x32_bf16 v[136:139], a[156:159], v[184:187], v[136:139]
  ds_read_b128 v[168:171], v14 offset:36864
  v_mov_b32 v35, v34
  v_mfma_f32_16x16x32_bf16 v[140:143], a[160:163], v[184:187], v[140:143]
  v_permlane16_swap_b32 v34, v35
  v_add_f32 v34, v34, v35
  v_mfma_f32_16x16x32_bf16 v[144:147], a[164:167], v[184:187], v[144:147]
  s_waitcnt lgkmcnt(3)
  v_rcp_f32 v34, v34
  v_mfma_f32_16x16x32_bf16 v[148:151], a[156:159], v[188:191], v[148:151]
  ds_read_b128 v[172:175], v14 offset:38912
  v_mul_f32 v44, v44, v34
  v_mfma_f32_16x16x32_bf16 v[152:155], a[160:163], v[188:191], v[152:155]
  v_mul_f32 v45, v45, v34
  v_mul_f32 v46, v46, v34
  v_mfma_f32_16x16x32_bf16 v[156:159], a[164:167], v[188:191], v[156:159]
  s_waitcnt lgkmcnt(3)
  v_mul_f32 v47, v47, v34
  v_mul_f32 v48, v48, v34
  v_mfma_f32_16x16x32_bf16 v[64:67], a[168:171], v[160:163], v[64:67]
  ds_read_b128 v[176:179], v14 offset:40960
  v_mul_f32 v49, v49, v34
  v_mfma_f32_16x16x32_bf16 v[68:71], a[172:175], v[160:163], v[68:71]
  s_add_u32 m0, s31, 0
  v_mul_f32 v50, v50, v34
  v_mul_f32 v51, v51, v34
  v_mfma_f32_16x16x32_bf16 v[72:75], a[176:179], v[160:163], v[72:75]
  s_waitcnt lgkmcnt(3)
  buffer_load_dwordx4 v10, s[8:11], s30 offen lds
  v_mul_f32 v52, v52, v34
  v_mfma_f32_16x16x32_bf16 v[76:79], a[168:171], v[164:167], v[76:79]
  ds_read_b128 v[180:183], v14 offset:43008
  v_mul_f32 v53, v53, v34
  v_mfma_f32_16x16x32_bf16 v[80:83], a[172:175], v[164:167], v[80:83]
  v_mul_f32 v54, v54, v34
  v_mul_f32 v55, v55, v34
  v_mfma_f32_16x16x32_bf16 v[84:87], a[176:179], v[164:167], v[84:87]
  s_waitcnt lgkmcnt(3)
  v_cvt_pk_bf16_f32 v56, v44, v45
  v_cvt_pk_bf16_f32 v57, v46, v47
  v_mfma_f32_16x16x32_bf16 v[88:91], a[168:171], v[168:171], v[88:91]
  ds_read_b128 v[184:187], v14 offset:45056
  v_cvt_pk_bf16_f32 v58, v48, v49
  v_mfma_f32_16x16x32_bf16 v[92:95], a[172:175], v[168:171], v[92:95]
  s_add_u32 m0, s31, 1024
  v_cvt_pk_bf16_f32 v59, v50, v51
  v_cvt_pk_bf16_f32 v60, v40, v41
  v_mfma_f32_16x16x32_bf16 v[96:99], a[176:179], v[168:171], v[96:99]
  s_waitcnt lgkmcnt(3)
  buffer_load_dwordx4 v11, s[8:11], s30 offen lds
  v_cvt_pk_bf16_f32 v61, v42, v43
  v_mfma_f32_16x16x32_bf16 v[100:103], a[168:171], v[172:175], v[100:103]
  ds_read_b128 v[188:191], v14 offset:47104
  v_cvt_pk_bf16_f32 v62, v52, v53
  v_mfma_f32_16x16x32_bf16 v[104:107], a[172:175], v[172:175], v[104:107]
  v_cvt_pk_bf16_f32 v63, v54, v55
  v_cvt_pk_bf16_f32 v248, v36, v37
  v_mfma_f32_16x16x32_bf16 v[108:111], a[176:179], v[172:175], v[108:111]
  s_waitcnt lgkmcnt(3)
  v_cvt_pk_bf16_f32 v249, v38, v39
  buffer_store_dwordx4 v[56:59], v26, s[16:19], s81 offen sc1
  v_mfma_f32_16x16x32_bf16 v[112:115], a[168:171], v[176:179], v[112:115]
  ds_read_b128 v[160:163], v15 offset:32768
  buffer_store_dwordx4 v[60:63], v26, s[16:19], s81 offen offset:1024 sc1
  v_mfma_f32_16x16x32_bf16 v[116:119], a[172:175], v[176:179], v[116:119]
  s_add_u32 m0, s31, 2048
  buffer_store_dwordx2 v[248:249], v29, s[16:19], s81 offen offset:2048 sc1
  v_mfma_f32_16x16x32_bf16 v[120:123], a[176:179], v[176:179], v[120:123]
  s_waitcnt lgkmcnt(3)
  buffer_load_dwordx4 v12, s[8:11], s30 offen lds
  v_mfma_f32_16x16x32_bf16 v[124:127], a[168:171], v[180:183], v[124:127]
  ds_read_b128 v[164:167], v15 offset:34816
  v_mfma_f32_16x16x32_bf16 v[128:131], a[172:175], v[180:183], v[128:131]
  v_mfma_f32_16x16x32_bf16 v[132:135], a[176:179], v[180:183], v[132:135]
  s_waitcnt lgkmcnt(3)
  v_mfma_f32_16x16x32_bf16 v[136:139], a[168:171], v[184:187], v[136:139]
  ds_read_b128 v[168:171], v15 offset:36864
  v_mfma_f32_16x16x32_bf16 v[140:143], a[172:175], v[184:187], v[140:143]
  s_add_u32 m0, s31, 3072
  v_mfma_f32_16x16x32_bf16 v[144:147], a[176:179], v[184:187], v[144:147]
  s_waitcnt lgkmcnt(3)
  buffer_load_dwordx4 v13, s[8:11], s30 offen lds
  v_mfma_f32_16x16x32_bf16 v[148:151], a[168:171], v[188:191], v[148:151]
  s_add_u32 s30, s30, 128
  ds_read_b128 v[172:175], v15 offset:38912
  v_mfma_f32_16x16x32_bf16 v[152:155], a[172:175], v[188:191], v[152:155]
  v_mfma_f32_16x16x32_bf16 v[156:159], a[176:179], v[188:191], v[156:159]
  s_waitcnt lgkmcnt(3)
  v_mfma_f32_16x16x32_bf16 v[64:67], a[180:183], v[160:163], v[64:67]
  ds_read_b128 v[176:179], v15 offset:40960
  v_mfma_f32_16x16x32_bf16 v[68:71], a[184:187], v[160:163], v[68:71]
  v_mfma_f32_16x16x32_bf16 v[72:75], a[188:191], v[160:163], v[72:75]
  s_waitcnt lgkmcnt(3)
  v_mfma_f32_16x16x32_bf16 v[76:79], a[180:183], v[164:167], v[76:79]
  ds_read_b128 v[180:183], v15 offset:43008
  v_mfma_f32_16x16x32_bf16 v[80:83], a[184:187], v[164:167], v[80:83]
  v_mfma_f32_16x16x32_bf16 v[84:87], a[188:191], v[164:167], v[84:87]
  s_waitcnt lgkmcnt(3)
  v_mfma_f32_16x16x32_bf16 v[88:91], a[180:183], v[168:171], v[88:91]
  ds_read_b128 v[184:187], v15 offset:45056
  v_mfma_f32_16x16x32_bf16 v[92:95], a[184:187], v[168:171], v[92:95]
  v_mfma_f32_16x16x32_bf16 v[96:99], a[188:191], v[168:171], v[96:99]
  s_waitcnt lgkmcnt(3)
  v_mfma_f32_16x16x32_bf16 v[100:103], a[180:183], v[172:175], v[100:103]
  ds_read_b128 v[188:191], v15 offset:47104
  v_mfma_f32_16x16x32_bf16 v[104:107], a[184:187], v[172:175], v[104:107]
  v_mfma_f32_16x16x32_bf16 v[108:111], a[188:191], v[172:175], v[108:111]
  s_waitcnt lgkmcnt(3)
  v_mfma_f32_16x16x32_bf16 v[112:115], a[180:183], v[176:179], v[112:115]
  s_waitcnt vmcnt(11)
  s_barrier
  ds_read_b128 v[160:163], v14 offset:49152
  v_mfma_f32_16x16x32_bf16 v[116:119], a[184:187], v[176:179], v[116:119]
  v_mfma_f32_16x16x32_bf16 v[120:123], a[188:191], v[176:179], v[120:123]
  s_waitcnt lgkmcnt(3)
  v_mfma_f32_16x16x32_bf16 v[124:127], a[180:183], v[180:183], v[124:127]
  ds_read_b128 v[164:167], v14 offset:51200
  v_mfma_f32_16x16x32_bf16 v[128:131], a[184:187], v[180:183], v[128:131]
  v_mfma_f32_16x16x32_bf16 v[132:135], a[188:191], v[180:183], v[132:135]
  s_waitcnt lgkmcnt(3)
  v_mfma_f32_16x16x32_bf16 v[136:139], a[180:183], v[184:187], v[136:139]
  ds_read_b128 v[168:171], v14 offset:53248
  v_mfma_f32_16x16x32_bf16 v[140:143], a[184:187], v[184:187], v[140:143]
  v_mfma_f32_16x16x32_bf16 v[144:147], a[188:191], v[184:187], v[144:147]
  s_waitcnt lgkmcnt(3)
  v_mfma_f32_16x16x32_bf16 v[148:151], a[180:183], v[188:191], v[148:151]
  ds_read_b128 v[172:175], v14 offset:55296
  v_mfma_f32_16x16x32_bf16 v[152:155], a[184:187], v[188:191], v[152:155]
  v_mfma_f32_16x16x32_bf16 v[156:159], a[188:191], v[188:191], v[156:159]
  s_waitcnt lgkmcnt(3)
  v_mfma_f32_16x16x32_bf16 v[64:67], a[192:195], v[160:163], v[64:67]
  ds_read_b128 v[176:179], v14 offset:57344
  v_mfma_f32_16x16x32_bf16 v[68:71], a[196:199], v[160:163], v[68:71]
  s_add_u32 m0, s31, 16384
  v_mfma_f32_16x16x32_bf16 v[72:75], a[200:203], v[160:163], v[72:75]
  s_waitcnt lgkmcnt(3)
  buffer_load_dwordx4 v10, s[8:11], s30 offen lds
  v_mfma_f32_16x16x32_bf16 v[76:79], a[192:195], v[164:167], v[76:79]
  ds_read_b128 v[180:183], v14 offset:59392
  v_mfma_f32_16x16x32_bf16 v[80:83], a[196:199], v[164:167], v[80:83]
  v_mfma_f32_16x16x32_bf16 v[84:87], a[200:203], v[164:167], v[84:87]
  s_waitcnt lgkmcnt(3)
  v_mfma_f32_16x16x32_bf16 v[88:91], a[192:195], v[168:171], v[88:91]
  ds_read_b128 v[184:187], v14 offset:61440
  v_mfma_f32_16x16x32_bf16 v[92:95], a[196:199], v[168:171], v[92:95]
  s_add_u32 m0, s31, 17408
  v_mfma_f32_16x16x32_bf16 v[96:99], a[200:203], v[168:171], v[96:99]
  s_waitcnt lgkmcnt(3)
  buffer_load_dwordx4 v11, s[8:11], s30 offen lds
  v_mfma_f32_16x16x32_bf16 v[100:103], a[192:195], v[172:175], v[100:103]
  ds_read_b128 v[188:191], v14 offset:63488
  v_mfma_f32_16x16x32_bf16 v[104:107], a[196:199], v[172:175], v[104:107]
  v_mfma_f32_16x16x32_bf16 v[108:111], a[200:203], v[172:175], v[108:111]
  s_waitcnt lgkmcnt(3)
  v_mfma_f32_16x16x32_bf16 v[112:115], a[192:195], v[176:179], v[112:115]
  ds_read_b128 v[160:163], v15 offset:49152
  v_mfma_f32_16x16x32_bf16 v[116:119], a[196:199], v[176:179], v[116:119]
  s_add_u32 m0, s31, 18432
  v_mfma_f32_16x16x32_bf16 v[120:123], a[200:203], v[176:179], v[120:123]
  s_waitcnt lgkmcnt(3)
  buffer_load_dwordx4 v12, s[8:11], s30 offen lds
  v_mfma_f32_16x16x32_bf16 v[124:127], a[192:195], v[180:183], v[124:127]
  ds_read_b128 v[164:167], v15 offset:51200
  v_mfma_f32_16x16x32_bf16 v[128:131], a[196:199], v[180:183], v[128:131]
  v_mfma_f32_16x16x32_bf16 v[132:135], a[200:203], v[180:183], v[132:135]
  s_waitcnt lgkmcnt(3)
  v_mfma_f32_16x16x32_bf16 v[136:139], a[192:195], v[184:187], v[136:139]
  ds_read_b128 v[168:171], v15 offset:53248
  v_mfma_f32_16x16x32_bf16 v[140:143], a[196:199], v[184:187], v[140:143]
  s_add_u32 m0, s31, 19456
  v_mfma_f32_16x16x32_bf16 v[144:147], a[200:203], v[184:187], v[144:147]
  s_waitcnt lgkmcnt(3)
  buffer_load_dwordx4 v13, s[8:11], s30 offen lds
  v_mfma_f32_16x16x32_bf16 v[148:151], a[192:195], v[188:191], v[148:151]
  s_add_u32 s30, s30, 128
  ds_read_b128 v[172:175], v15 offset:55296
  v_mfma_f32_16x16x32_bf16 v[152:155], a[196:199], v[188:191], v[152:155]
  v_mfma_f32_16x16x32_bf16 v[156:159], a[200:203], v[188:191], v[156:159]
  s_waitcnt lgkmcnt(3)
  v_mfma_f32_16x16x32_bf16 v[64:67], a[204:207], v[160:163], v[64:67]
  ds_read_b128 v[176:179], v15 offset:57344
  v_mfma_f32_16x16x32_bf16 v[68:71], a[208:211], v[160:163], v[68:71]
  v_mfma_f32_16x16x32_bf16 v[72:75], a[212:215], v[160:163], v[72:75]
  s_waitcnt lgkmcnt(3)
  v_mfma_f32_16x16x32_bf16 v[76:79], a[204:207], v[164:167], v[76:79]
  ds_read_b128 v[180:183], v15 offset:59392
  v_mfma_f32_16x16x32_bf16 v[80:83], a[208:211], v[164:167], v[80:83]
  v_mfma_f32_16x16x32_bf16 v[84:87], a[212:215], v[164:167], v[84:87]
  s_waitcnt lgkmcnt(3)
  v_mfma_f32_16x16x32_bf16 v[88:91], a[204:207], v[168:171], v[88:91]
  ds_read_b128 v[184:187], v15 offset:61440
  v_mfma_f32_16x16x32_bf16 v[92:95], a[208:211], v[168:171], v[92:95]
  v_mfma_f32_16x16x32_bf16 v[96:99], a[212:215], v[168:171], v[96:99]
  s_waitcnt lgkmcnt(3)
  v_mfma_f32_16x16x32_bf16 v[100:103], a[204:207], v[172:175], v[100:103]
  ds_read_b128 v[188:191], v15 offset:63488
  v_mfma_f32_16x16x32_bf16 v[104:107], a[208:211], v[172:175], v[104:107]
  v_mfma_f32_16x16x32_bf16 v[108:111], a[212:215], v[172:175], v[108:111]
  s_waitcnt lgkmcnt(3)
  v_mfma_f32_16x16x32_bf16 v[112:115], a[204:207], v[176:179], v[112:115]
  s_waitcnt vmcnt(11)
  s_barrier
  ds_read_b128 v[160:163], v16 offset:0
  v_mfma_f32_16x16x32_bf16 v[116:119], a[208:211], v[176:179], v[116:119]
  v_mfma_f32_16x16x32_bf16 v[120:123], a[212:215], v[176:179], v[120:123]
  s_waitcnt lgkmcnt(3)
  v_mfma_f32_16x16x32_bf16 v[124:127], a[204:207], v[180:183], v[124:127]
  ds_read_b128 v[164:167], v16 offset:2048
  v_mfma_f32_16x16x32_bf16 v[128:131], a[208:211], v[180:183], v[128:131]
  v_mfma_f32_16x16x32_bf16 v[132:135], a[212:215], v[180:183], v[132:135]
  s_waitcnt lgkmcnt(3)
  v_mfma_f32_16x16x32_bf16 v[136:139], a[204:207], v[184:187], v[136:139]
  ds_read_b128 v[168:171], v16 offset:4096
  v_mfma_f32_16x16x32_bf16 v[140:143], a[208:211], v[184:187], v[140:143]
  v_mfma_f32_16x16x32_bf16 v[144:147], a[212:215], v[184:187], v[144:147]
  s_waitcnt lgkmcnt(3)
  v_mfma_f32_16x16x32_bf16 v[148:151], a[204:207], v[188:191], v[148:151]
  ds_read_b128 v[172:175], v16 offset:6144
  v_mfma_f32_16x16x32_bf16 v[152:155], a[208:211], v[188:191], v[152:155]
  v_mfma_f32_16x16x32_bf16 v[156:159], a[212:215], v[188:191], v[156:159]
  s_waitcnt lgkmcnt(3)
  v_mfma_f32_16x16x32_bf16 v[64:67], a[216:219], v[160:163], v[64:67]
  ds_read_b128 v[176:179], v16 offset:8192
  v_mfma_f32_16x16x32_bf16 v[68:71], a[220:223], v[160:163], v[68:71]
  s_add_u32 m0, s31, 32768
  v_mfma_f32_16x16x32_bf16 v[72:75], a[224:227], v[160:163], v[72:75]
  s_waitcnt lgkmcnt(3)
  buffer_load_dwordx4 v10, s[8:11], s30 offen lds
  v_mfma_f32_16x16x32_bf16 v[76:79], a[216:219], v[164:167], v[76:79]
  ds_read_b128 v[180:183], v16 offset:10240
  v_mfma_f32_16x16x32_bf16 v[80:83], a[220:223], v[164:167], v[80:83]
  v_mfma_f32_16x16x32_bf16 v[84:87], a[224:227], v[164:167], v[84:87]
  s_waitcnt lgkmcnt(3)
  v_mfma_f32_16x16x32_bf16 v[88:91], a[216:219], v[168:171], v[88:91]
  ds_read_b128 v[184:187], v16 offset:12288
  buffer_load_dword v32, v30, s[72:75], s77 offen sc1
  v_mfma_f32_16x16x32_bf16 v[92:95], a[220:223], v[168:171], v[92:95]
  s_add_u32 m0, s31, 33792
  s_waitcnt vmcnt(8)
  buffer_atomic_add v28, v33, s[72:75], s82 offen sc1
  v_mfma_f32_16x16x32_bf16 v[96:99], a[224:227], v[168:171], v[96:99]
  s_waitcnt lgkmcnt(3)
  buffer_load_dwordx4 v11, s[8:11], s30 offen lds
  v_mfma_f32_16x16x32_bf16 v[100:103], a[216:219], v[172:175], v[100:103]
  ds_read_b128 v[188:191], v16 offset:14336
  v_mfma_f32_16x16x32_bf16 v[104:107], a[220:223], v[172:175], v[104:107]
  s_cmp_le_u32 s26, 2
  s_cbranch_scc1 qa2_224
  s_mov_b32 s49, s43
  s_mov_b32 s50, s45
  s_mov_b32 s81, s47
  s_mov_b32 s82, s48
  s_add_u32 s43, s43, 4
  s_add_u32 s45, s45, 8388608
  s_add_u32 s47, s47, 2097152
  s_xor_b32 s47, s47, 8192
  s_add_u32 s48, s48, 512
qa3_225:
  v_mfma_f32_16x16x32_bf16 v[108:111], a[224:227], v[172:175], v[108:111]
  s_waitcnt lgkmcnt(3)
  v_mfma_f32_16x16x32_bf16 v[112:115], a[216:219], v[176:179], v[112:115]
  ds_read_b128 v[160:163], v17 offset:0
  v_mfma_f32_16x16x32_bf16 v[116:119], a[220:223], v[176:179], v[116:119]
  s_add_u32 m0, s31, 34816
  v_mfma_f32_16x16x32_bf16 v[120:123], a[224:227], v[176:179], v[120:123]
  s_waitcnt lgkmcnt(3)
  buffer_load_dwordx4 v12, s[8:11], s30 offen lds
  v_mfma_f32_16x16x32_bf16 v[124:127], a[216:219], v[180:183], v[124:127]
  ds_read_b128 v[164:167], v17 offset:2048
  v_mfma_f32_16x16x32_bf16 v[128:131], a[220:223], v[180:183], v[128:131]
  v_mfma_f32_16x16x32_bf16 v[132:135], a[224:227], v[180:183], v[132:135]
  s_waitcnt lgkmcnt(3)
  v_mfma_f32_16x16x32_bf16 v[136:139], a[216:219], v[184:187], v[136:139]
  ds_read_b128 v[168:171], v17 offset:4096
  v_mfma_f32_16x16x32_bf16 v[140:143], a[220:223], v[184:187], v[140:143]
  s_add_u32 m0, s31, 35840
  v_mfma_f32_16x16x32_bf16 v[144:147], a[224:227], v[184:187], v[144:147]
  s_waitcnt lgkmcnt(3)
  buffer_load_dwordx4 v13, s[8:11], s30 offen lds
  v_mfma_f32_16x16x32_bf16 v[148:151], a[216:219], v[188:191], v[148:151]
  s_add_u32 s30, s30, 128
  ds_read_b128 v[172:175], v17 offset:6144
  v_mfma_f32_16x16x32_bf16 v[152:155], a[220:223], v[188:191], v[152:155]
  v_mfma_f32_16x16x32_bf16 v[156:159], a[224:227], v[188:191], v[156:159]
  s_waitcnt lgkmcnt(3)
  v_mfma_f32_16x16x32_bf16 v[64:67], a[228:231], v[160:163], v[64:67]
  ds_read_b128 v[176:179], v17 offset:8192
  v_mfma_f32_16x16x32_bf16 v[68:71], a[232:235], v[160:163], v[68:71]
  v_mfma_f32_16x16x32_bf16 v[72:75], a[236:239], v[160:163], v[72:75]
  s_waitcnt lgkmcnt(3)
  v_mfma_f32_16x16x32_bf16 v[76:79], a[228:231], v[164:167], v[76:79]
  ds_read_b128 v[180:183], v17 offset:10240
  v_cvt_pk_bf16_f32 v192, v64, v65
  v_mfma_f32_16x16x32_bf16 v[80:83], a[232:235], v[164:167], v[80:83]
  v_cvt_pk_bf16_f32 v193, v66, v67
  v_cvt_pk_bf16_f32 v194, v68, v69
  v_mfma_f32_16x16x32_bf16 v[84:87], a[236:239], v[164:167], v[84:87]
  s_waitcnt lgkmcnt(3)
  v_cvt_pk_bf16_f32 v195, v70, v71
  v_cvt_pk_bf16_f32 v200, v72, v73
  v_mfma_f32_16x16x32_bf16 v[88:91], a[228:231], v[168:171], v[88:91]
  ds_read_b128 v[184:187], v17 offset:12288
  v_cvt_pk_bf16_f32 v201, v74, v75
  v_mfma_f32_16x16x32_bf16 v[92:95], a[232:235], v[168:171], v[92:95]
  v_cvt_pk_bf16_f32 v196, v76, v77
  v_cvt_pk_bf16_f32 v197, v78, v79
  v_mfma_f32_16x16x32_bf16 v[96:99], a[236:239], v[168:171], v[96:99]
  s_waitcnt lgkmcnt(3)
  v_cvt_pk_bf16_f32 v198, v80, v81
  v_cvt_pk_bf16_f32 v199, v82, v83
  v_mfma_f32_16x16x32_bf16 v[100:103], a[228:231], v[172:175], v[100:103]
  ds_read_b128 v[188:191], v17 offset:14336
  v_cvt_pk_bf16_f32 v202, v84, v85
  v_mfma_f32_16x16x32_bf16 v[104:107], a[232:235], v[172:175], v[104:107]
  v_cvt_pk_bf16_f32 v203, v86, v87
  v_cvt_pk_bf16_f32 v204, v88, v89
  v_mfma_f32_16x16x32_bf16 v[108:111], a[236:239], v[172:175], v[108:111]
  s_waitcnt lgkmcnt(3)
  v_cvt_pk_bf16_f32 v205, v90, v91
  v_cvt_pk_bf16_f32 v206, v92, v93
  v_mfma_f32_16x16x32_bf16 v[112:115], a[228:231], v[176:179], v[112:115]
  s_waitcnt vmcnt(10)
  s_barrier
  ds_read_b128 v[160:163], v14 offset:0
  v_mfma_f32_16x16x32_bf16 v[116:119], a[232:235], v[176:179], v[116:119]
  v_cvt_pk_bf16_f32 v207, v94, v95
  v_cvt_pk_bf16_f32 v212, v96, v97
  v_mfma_f32_16x16x32_bf16 v[120:123], a[236:239], v[176:179], v[120:123]
  s_waitcnt lgkmcnt(3)
  v_cvt_pk_bf16_f32 v213, v98, v99
  v_cvt_pk_bf16_f32 v208, v100, v101
  v_mfma_f32_16x16x32_bf16 v[124:127], a[228:231], v[180:183], v[124:127]
  ds_read_b128 v[164:167], v14 offset:2048
  v_cvt_pk_bf16_f32 v209, v102, v103
  v_mfma_f32_16x16x32_bf16 v[128:131], a[232:235], v[180:183], v[128:131]
  v_cvt_pk_bf16_f32 v210, v104, v105
  v_cvt_pk_bf16_f32 v211, v106, v107
  v_mfma_f32_16x16x32_bf16 v[132:135], a[236:239], v[180:183], v[132:135]
  s_waitcnt lgkmcnt(3)
  v_cvt_pk_bf16_f32 v214, v108, v109
  v_cvt_pk_bf16_f32 v215, v110, v111
  v_mfma_f32_16x16x32_bf16 v[136:139], a[228:231], v[184:187], v[136:139]
  ds_read_b128 v[168:171], v14 offset:4096
  v_cvt_pk_bf16_f32 v216, v112, v113
  v_mfma_f32_16x16x32_bf16 v[140:143], a[232:235], v[184:187], v[140:143]
  v_cvt_pk_bf16_f32 v217, v114, v115
  v_cvt_pk_bf16_f32 v218, v116, v117
  v_mfma_f32_16x16x32_bf16 v[144:147], a[236:239], v[184:187], v[144:147]
  s_waitcnt lgkmcnt(3)
  v_cvt_pk_bf16_f32 v219, v118, v119
  v_cvt_pk_bf16_f32 v224, v120, v121
  v_mfma_f32_16x16x32_bf16 v[148:151], a[228:231], v[188:191], v[148:151]
  ds_read_b128 v[172:175], v14 offset:6144
  v_cvt_pk_bf16_f32 v225, v122, v123
  v_mfma_f32_16x16x32_bf16 v[152:155], a[232:235], v[188:191], v[152:155]
  s_sub_u32 s26, s26, 1
  s_cmp_gt_u32 s26, 0
  v_cvt_pk_bf16_f32 v220, v124, v125
  v_mfma_f32_16x16x32_bf16 v[156:159], a[236:239], v[188:191], v[156:159]
  s_waitcnt lgkmcnt(3)
  s_cbranch_scc1 qa_226
  s_nop 7
  v_cvt_pk_bf16_f32 v221, v126, v127
  v_cvt_pk_bf16_f32 v222, v128, v129
  v_cvt_pk_bf16_f32 v223, v130, v131
  v_cvt_pk_bf16_f32 v226, v132, v133
  v_cvt_pk_bf16_f32 v227, v134, v135
  v_cvt_pk_bf16_f32 v228, v136, v137
  v_cvt_pk_bf16_f32 v229, v138, v139
  v_cvt_pk_bf16_f32 v230, v140, v141
  v_cvt_pk_bf16_f32 v231, v142, v143
  v_cvt_pk_bf16_f32 v236, v144, v145
  v_cvt_pk_bf16_f32 v237, v146, v147
  v_cvt_pk_bf16_f32 v232, v148, v149
  v_cvt_pk_bf16_f32 v233, v150, v151
  v_cvt_pk_bf16_f32 v234, v152, v153
  v_cvt_pk_bf16_f32 v235, v154, v155
  v_cvt_pk_bf16_f32 v238, v156, v157
  v_cvt_pk_bf16_f32 v239, v158, v159
  s_waitcnt lgkmcnt(0)
  s_mov_b32 s23, 54
  s_mov_b32 s101, 0
wm_229:
  buffer_load_dword v34, v30, s[72:75], s77 offen sc1
  s_add_u32 s101, s101, 1
  s_cmp_gt_u32 s101, 131072
  s_cbranch_scc1 main_end
  s_waitcnt vmcnt(0)
  v_cmp_gt_u32 vcc, s23, v34
  v_readfirstlane_b32 s100, v34
  s_nop 0
  s_cbranch_vccz wm_230
  s_sleep 4
  s_add_u32 s100, s100, 2
  s_cmp_ge_u32 s100, s23
  s_cbranch_scc1 wm_229
  s_sleep 60
  s_branch wm_229
wm_230:
  s_mov_b32 s49, s43
  s_mov_b32 s50, s45
  s_mov_b32 s81, s47
  s_mov_b32 s82, s48
  s_add_u32 s43, s43, 4
  s_add_u32 s45, s45, 8388608
  s_add_u32 s47, s47, 2097152
  s_xor_b32 s47, s47, 8192
  s_add_u32 s48, s48, 512
  s_add_u32 s29, s50, 0
  buffer_load_dwordx4 v[112:115], v26, s[16:19], s29 offen offset:0 sc1
  buffer_load_dwordx4 v[116:119], v26, s[16:19], s29 offen offset:1024 sc1
  buffer_load_dwordx4 v[144:147], v26, s[16:19], s29 offen offset:2048 sc1
  s_add_u32 s29, s50, 16384
  buffer_load_dwordx4 v[120:123], v26, s[16:19], s29 offen offset:0 sc1
  buffer_load_dwordx4 v[124:127], v26, s[16:19], s29 offen offset:1024 sc1
  buffer_load_dwordx4 v[148:151], v26, s[16:19], s29 offen offset:2048 sc1
  s_add_u32 s29, s50, 32768
  buffer_load_dwordx4 v[128:131], v26, s[16:19], s29 offen offset:0 sc1
  buffer_load_dwordx4 v[132:135], v26, s[16:19], s29 offen offset:1024 sc1
  buffer_load_dwordx4 v[152:155], v26, s[16:19], s29 offen offset:2048 sc1
  s_add_u32 s29, s50, 49152
  buffer_load_dwordx4 v[136:139], v26, s[16:19], s29 offen offset:0 sc1
  buffer_load_dwordx4 v[140:143], v26, s[16:19], s29 offen offset:1024 sc1
  buffer_load_dwordx4 v[156:159], v26, s[16:19], s29 offen offset:2048 sc1
  ds_read_b128 v[64:67], v21 offset:0
  ds_read_b128 v[68:71], v21 offset:1024
  ds_read_b128 v[72:75], v21 offset:3072
  ds_read_b128 v[76:79], v21 offset:4096
  ds_read2st64_b64 v[80:83], v22 offset0:0 offset1:6
  ds_read2st64_b64 v[84:87], v23 offset0:0 offset1:6
  ds_read_b128 v[88:91], v21 offset:6144
  ds_read_b128 v[92:95], v21 offset:7168
  ds_read_b128 v[96:99], v21 offset:9216
  ds_read_b128 v[100:103], v21 offset:10240
  ds_read2st64_b64 v[104:107], v22 offset0:12 offset1:18
  ds_read2st64_b64 v[108:111], v23 offset0:12 offset1:18
  s_waitcnt lgkmcnt(0)
  s_barrier
  ds_write_b128 v20, v[192:195] offset:0
  ds_write_b128 v20, v[196:199] offset:1024
  ds_write_b128 v20, v[200:203] offset:2048
  ds_write_b128 v20, v[204:207] offset:12288
  ds_write_b128 v20, v[208:211] offset:13312
  ds_write_b128 v20, v[212:215] offset:14336
  ds_write_b128 v20, v[216:219] offset:24576
  ds_write_b128 v20, v[220:223] offset:25600
  ds_write_b128 v20, v[224:227] offset:26624
  ds_write_b128 v20, v[228:231] offset:36864
  ds_write_b128 v20, v[232:235] offset:37888
  ds_write_b128 v20, v[236:239] offset:38912
  s_waitcnt lgkmcnt(0)
  s_barrier
  s_waitcnt vmcnt(0) lgkmcnt(0)
  v_swap_b32 v146, v148
  v_swap_b32 v147, v149
  v_swap_b32 v154, v156
  v_swap_b32 v155, v157
  s_nop 1
  v_mfma_f32_16x16x32_bf16 v[36:39], v[112:115], v[64:67], 0
  v_mfma_f32_16x16x32_bf16 v[44:47], v[112:115], v[68:71], 0
  v_mfma_f32_16x16x32_bf16 v[48:51], v[116:119], v[68:71], 0
  v_mfma_f32_16x16x32_bf16 v[36:39], v[120:123], v[72:75], v[36:39]
  v_mfma_f32_16x16x32_bf16 v[44:47], v[120:123], v[76:79], v[44:47]
  v_mfma_f32_16x16x32_bf16 v[48:51], v[124:127], v[76:79], v[48:51]
  v_mfma_f32_16x16x32_bf16 v[36:39], v[144:147], v[80:83], v[36:39]
  v_mfma_f32_16x16x32_bf16 v[44:47], v[144:147], v[84:87], v[44:47]
  v_mfma_f32_16x16x32_bf16 v[48:51], v[148:151], v[84:87], v[48:51]
  v_mfma_f32_16x16x32_bf16 v[36:39], v[128:131], v[88:91], v[36:39]
  v_mfma_f32_16x16x32_bf16 v[44:47], v[128:131], v[92:95], v[44:47]
  v_mfma_f32_16x16x32_bf16 v[48:51], v[132:135], v[92:95], v[48:51]
  v_mfma_f32_16x16x32_bf16 v[36:39], v[136:139], v[96:99], v[36:39]
  v_mfma_f32_16x16x32_bf16 v[44:47], v[136:139], v[100:103], v[44:47]
  v_mfma_f32_16x16x32_bf16 v[48:51], v[140:143], v[100:103], v[48:51]
  v_mfma_f32_16x16x32_bf16 v[36:39], v[152:155], v[104:107], v[36:39]
  v_mfma_f32_16x16x32_bf16 v[44:47], v[152:155], v[108:111], v[44:47]
  v_mfma_f32_16x16x32_bf16 v[48:51], v[156:159], v[108:111], v[48:51]
  s_sub_u32 s23, s49, 1
  s_min_u32 s23, s23, 62
  s_mov_b32 s101, 0
wm_231:
  buffer_load_dword v34, v30, s[72:75], s77 offen sc1
  s_add_u32 s101, s101, 1
  s_cmp_gt_u32 s101, 131072
  s_cbranch_scc1 main_end
  s_waitcnt vmcnt(0)
  v_cmp_gt_u32 vcc, s23, v34
  v_readfirstlane_b32 s100, v34
  s_nop 0
  s_cbranch_vccz wm_232
  s_sleep 4
  s_add_u32 s100, s100, 2
  s_cmp_ge_u32 s100, s23
  s_cbranch_scc1 wm_231
  s_sleep 40
  s_branch wm_231
wm_232:
  s_mov_b32 s101, 0
  s_branch qtp_234
qtp_233:
  s_sleep 2
qtp_234:
  s_add_u32 s29, s50, 4096
  buffer_load_dwordx4 v[160:163], v24, s[16:19], s29 offen offset:2560 sc1
  buffer_load_dwordx2 v[240:241], v25, s[16:19], s29 offen offset:3072 sc1
  s_add_u32 s29, s50, 20480
  buffer_load_dwordx4 v[164:167], v24, s[16:19], s29 offen offset:2560 sc1
  buffer_load_dwordx2 v[242:243], v25, s[16:19], s29 offen offset:3072 sc1
  s_add_u32 s29, s50, 36864
  buffer_load_dwordx4 v[168:171], v24, s[16:19], s29 offen offset:2560 sc1
  buffer_load_dwordx2 v[244:245], v25, s[16:19], s29 offen offset:3072 sc1
  s_add_u32 s29, s50, 53248
  buffer_load_dwordx4 v[172:175], v24, s[16:19], s29 offen offset:2560 sc1
  buffer_load_dwordx2 v[246:247], v25, s[16:19], s29 offen offset:3072 sc1
  s_add_u32 s101, s101, 1
  s_cmp_gt_u32 s101, 131072
  s_cbranch_scc1 main_end
  s_waitcnt vmcnt(0)
  v_max3_u32 v34, v160, v164, v168
  v_max3_u32 v34, v34, v172, v240
  v_max3_u32 v34, v34, v242, v244
  v_max_u32 v34, v34, v246
  v_cmp_eq_u32 vcc, -1, v34
  s_nop 1
  s_cbranch_vccnz qtp_233
  v_mfma_f32_16x16x32_bf16 v[40:43], v[160:163], v[64:67], 0
  v_mfma_f32_16x16x32_bf16 v[52:55], v[160:163], v[68:71], 0
  v_mfma_f32_16x16x32_bf16 v[40:43], v[164:167], v[72:75], v[40:43]
  v_mfma_f32_16x16x32_bf16 v[52:55], v[164:167], v[76:79], v[52:55]
  v_mfma_f32_16x16x32_bf16 v[40:43], v[240:243], v[80:83], v[40:43]
  v_mfma_f32_16x16x32_bf16 v[52:55], v[240:243], v[84:87], v[52:55]
  v_mfma_f32_16x16x32_bf16 v[40:43], v[168:171], v[88:91], v[40:43]
  v_mfma_f32_16x16x32_bf16 v[52:55], v[168:171], v[92:95], v[52:55]
  v_mfma_f32_16x16x32_bf16 v[40:43], v[172:175], v[96:99], v[40:43]
  v_mfma_f32_16x16x32_bf16 v[52:55], v[172:175], v[100:103], v[52:55]
  v_mfma_f32_16x16x32_bf16 v[40:43], v[244:247], v[104:107], v[40:43]
  v_mfma_f32_16x16x32_bf16 v[52:55], v[244:247], v[108:111], v[52:55]
  s_nop 4
  v_cndmask_b32 v36, v31, v36, s[64:65]
  v_cndmask_b32 v48, v31, v48, s[64:65]
  v_cndmask_b32 v37, v31, v37, s[66:67]
  v_cndmask_b32 v49, v31, v49, s[66:67]
  v_cndmask_b32 v38, v31, v38, s[68:69]
  v_cndmask_b32 v50, v31, v50, s[68:69]
  v_cndmask_b32 v39, v31, v39, s[70:71]
  v_cndmask_b32 v51, v31, v51, s[70:71]
  v_max3_f32 v34, v36, v37, v38
  v_max3_f32 v34, v34, v39, v40
  v_max3_f32 v34, v34, v41, v42
  v_max_f32 v34, v34, v43
  v_mov_b32 v35, v34
  s_nop 1
  v_permlane32_swap_b32 v34, v35
  v_max_f32 v34, v34, v35
  v_mov_b32 v35, v34
  s_nop 1
  v_permlane16_swap_b32 v34, v35
  v_max_f32 v34, v34, v35
  v_mul_f32 v34, s83, v34
  v_fma_f32 v36, v36, s83, -v34
  v_fma_f32 v37, v37, s83, -v34
  v_fma_f32 v38, v38, s83, -v34
  v_fma_f32 v39, v39, s83, -v34
  v_fma_f32 v40, v40, s83, -v34
  v_fma_f32 v41, v41, s83, -v34
  v_fma_f32 v42, v42, s83, -v34
  v_fma_f32 v43, v43, s83, -v34
  v_exp_f32 v36, v36
  v_exp_f32 v37, v37
  v_exp_f32 v38, v38
  v_exp_f32 v39, v39
  v_exp_f32 v40, v40
  v_exp_f32 v41, v41
  v_exp_f32 v42, v42
  v_exp_f32 v43, v43
  s_nop 0
  v_add_f32 v34, v40, v41
  v_add_f32 v34, v34, v42
  v_add_f32 v34, v34, v43
  v_cndmask_b32 v34, 0, v34, s[62:63]
  v_add_f32 v34, v34, v36
  v_add_f32 v34, v34, v37
  v_add_f32 v34, v34, v38
  v_add_f32 v34, v34, v39
  v_mov_b32 v35, v34
  s_nop 1
  v_permlane32_swap_b32 v34, v35
  v_add_f32 v34, v34, v35
  v_mov_b32 v35, v34
  s_nop 1
  v_permlane16_swap_b32 v34, v35
  v_add_f32 v34, v34, v35
  v_rcp_f32 v34, v34
  s_nop 0
  v_mul_f32 v36, v36, v34
  v_mul_f32 v37, v37, v34
  v_mul_f32 v38, v38, v34
  v_mul_f32 v39, v39, v34
  v_mul_f32 v40, v40, v34
  v_mul_f32 v41, v41, v34
  v_mul_f32 v42, v42, v34
  v_mul_f32 v43, v43, v34
  v_max3_f32 v34, v44, v45, v46
  v_max3_f32 v34, v34, v47, v48
  v_max3_f32 v34, v34, v49, v50
  v_max3_f32 v34, v34, v51, v52
  v_max3_f32 v34, v34, v53, v54
  v_max_f32 v34, v34, v55
  v_mov_b32 v35, v34
  s_nop 1
  v_permlane32_swap_b32 v34, v35
  v_max_f32 v34, v34, v35
  v_mov_b32 v35, v34
  s_nop 1
  v_permlane16_swap_b32 v34, v35
  v_max_f32 v34, v34, v35
  v_mul_f32 v34, s83, v34
  v_fma_f32 v44, v44, s83, -v34
  v_fma_f32 v45, v45, s83, -v34
  v_fma_f32 v46, v46, s83, -v34
  v_fma_f32 v47, v47, s83, -v34
  v_fma_f32 v48, v48, s83, -v34
  v_fma_f32 v49, v49, s83, -v34
  v_fma_f32 v50, v50, s83, -v34
  v_fma_f32 v51, v51, s83, -v34
  v_fma_f32 v52, v52, s83, -v34
  v_fma_f32 v53, v53, s83, -v34
  v_fma_f32 v54, v54, s83, -v34
  v_fma_f32 v55, v55, s83, -v34
  v_exp_f32 v44, v44
  v_exp_f32 v45, v45
  v_exp_f32 v46, v46
  v_exp_f32 v47, v47
  v_exp_f32 v48, v48
  v_exp_f32 v49, v49
  v_exp_f32 v50, v50
  v_exp_f32 v51, v51
  v_exp_f32 v52, v52
  v_exp_f32 v53, v53
  v_exp_f32 v54, v54
  v_exp_f32 v55, v55
  s_nop 0
  v_add_f32 v34, v52, v53
  v_add_f32 v34, v34, v54
  v_add_f32 v34, v34, v55
  v_cndmask_b32 v34, 0, v34, s[62:63]
  v_add_f32 v34, v34, v44
  v_add_f32 v34, v34, v45
  v_add_f32 v34, v34, v46
  v_add_f32 v34, v34, v47
  v_add_f32 v34, v34, v48
  v_add_f32 v34, v34, v49
  v_add_f32 v34, v34, v50
  v_add_f32 v34, v34, v51
  v_mov_b32 v35, v34
  s_nop 1
  v_permlane32_swap_b32 v34, v35
  v_add_f32 v34, v34, v35
  v_mov_b32 v35, v34
  s_nop 1
  v_permlane16_swap_b32 v34, v35
  v_add_f32 v34, v34, v35
  v_rcp_f32 v34, v34
  s_nop 0
  v_mul_f32 v44, v44, v34
  v_mul_f32 v45, v45, v34
  v_mul_f32 v46, v46, v34
  v_mul_f32 v47, v47, v34
  v_mul_f32 v48, v48, v34
  v_mul_f32 v49, v49, v34
  v_mul_f32 v50, v50, v34
  v_mul_f32 v51, v51, v34
  v_mul_f32 v52, v52, v34
  v_mul_f32 v53, v53, v34
  v_mul_f32 v54, v54, v34
  v_mul_f32 v55, v55, v34
  v_cvt_pk_bf16_f32 v56, v44, v45
  v_cvt_pk_bf16_f32 v57, v46, v47
  v_cvt_pk_bf16_f32 v58, v48, v49
  v_cvt_pk_bf16_f32 v59, v50, v51
  v_cvt_pk_bf16_f32 v60, v40, v41
  v_cvt_pk_bf16_f32 v61, v42, v43
  v_cvt_pk_bf16_f32 v62, v52, v53
  v_cvt_pk_bf16_f32 v63, v54, v55
  v_cvt_pk_bf16_f32 v248, v36, v37
  v_cvt_pk_bf16_f32 v249, v38, v39
  buffer_store_dwordx4 v[56:59], v26, s[16:19], s81 offen sc1
  buffer_store_dwordx4 v[60:63], v26, s[16:19], s81 offen offset:1024 sc1
  buffer_store_dwordx2 v[248:249], v29, s[16:19], s81 offen offset:2048 sc1
  s_mov_b32 s84, s82
  s_mov_b32 s49, s43
  s_mov_b32 s50, s45
  s_mov_b32 s81, s47
  s_mov_b32 s82, s48
  s_add_u32 s43, s43, 4
  s_add_u32 s45, s45, 8388608
  s_add_u32 s47, s47, 2097152
  s_xor_b32 s47, s47, 8192
  s_add_u32 s48, s48, 512
  s_add_u32 s29, s50, 0
  buffer_load_dwordx4 v[112:115], v26, s[16:19], s29 offen offset:0 sc1
  buffer_load_dwordx4 v[116:119], v26, s[16:19], s29 offen offset:1024 sc1
  buffer_load_dwordx4 v[144:147], v26, s[16:19], s29 offen offset:2048 sc1
  s_add_u32 s29, s50, 16384
  buffer_load_dwordx4 v[120:123], v26, s[16:19], s29 offen offset:0 sc1
  buffer_load_dwordx4 v[124:127], v26, s[16:19], s29 offen offset:1024 sc1
  buffer_load_dwordx4 v[148:151], v26, s[16:19], s29 offen offset:2048 sc1
  s_add_u32 s29, s50, 32768
  buffer_load_dwordx4 v[128:131], v26, s[16:19], s29 offen offset:0 sc1
  buffer_load_dwordx4 v[132:135], v26, s[16:19], s29 offen offset:1024 sc1
  buffer_load_dwordx4 v[152:155], v26, s[16:19], s29 offen offset:2048 sc1
  s_add_u32 s29, s50, 49152
  buffer_load_dwordx4 v[136:139], v26, s[16:19], s29 offen offset:0 sc1
  buffer_load_dwordx4 v[140:143], v26, s[16:19], s29 offen offset:1024 sc1
  buffer_load_dwordx4 v[156:159], v26, s[16:19], s29 offen offset:2048 sc1
  ds_read_b128 v[64:67], v21 offset:0
  ds_read_b128 v[68:71], v21 offset:1024
  ds_read_b128 v[72:75], v21 offset:3072
  ds_read_b128 v[76:79], v21 offset:4096
  ds_read2st64_b64 v[80:83], v22 offset0:0 offset1:6
  ds_read2st64_b64 v[84:87], v23 offset0:0 offset1:6
  ds_read_b128 v[88:91], v21 offset:6144
  ds_read_b128 v[92:95], v21 offset:7168
  ds_read_b128 v[96:99], v21 offset:9216
  ds_read_b128 v[100:103], v21 offset:10240
  ds_read2st64_b64 v[104:107], v22 offset0:12 offset1:18
  ds_read2st64_b64 v[108:111], v23 offset0:12 offset1:18
  s_waitcnt vmcnt(0) lgkmcnt(0)
  buffer_atomic_add v28, v33, s[72:75], s84 offen sc1
  v_swap_b32 v146, v148
  v_swap_b32 v147, v149
  v_swap_b32 v154, v156
  v_swap_b32 v155, v157
  s_nop 1
  v_mfma_f32_16x16x32_bf16 v[36:39], v[112:115], v[64:67], 0
  v_mfma_f32_16x16x32_bf16 v[44:47], v[112:115], v[68:71], 0
  v_mfma_f32_16x16x32_bf16 v[48:51], v[116:119], v[68:71], 0
  v_mfma_f32_16x16x32_bf16 v[36:39], v[120:123], v[72:75], v[36:39]
  v_mfma_f32_16x16x32_bf16 v[44:47], v[120:123], v[76:79], v[44:47]
  v_mfma_f32_16x16x32_bf16 v[48:51], v[124:127], v[76:79], v[48:51]
  v_mfma_f32_16x16x32_bf16 v[36:39], v[144:147], v[80:83], v[36:39]
  v_mfma_f32_16x16x32_bf16 v[44:47], v[144:147], v[84:87], v[44:47]
  v_mfma_f32_16x16x32_bf16 v[48:51], v[148:151], v[84:87], v[48:51]
  v_mfma_f32_16x16x32_bf16 v[36:39], v[128:131], v[88:91], v[36:39]
  v_mfma_f32_16x16x32_bf16 v[44:47], v[128:131], v[92:95], v[44:47]
  v_mfma_f32_16x16x32_bf16 v[48:51], v[132:135], v[92:95], v[48:51]
  v_mfma_f32_16x16x32_bf16 v[36:39], v[136:139], v[96:99], v[36:39]
  v_mfma_f32_16x16x32_bf16 v[44:47], v[136:139], v[100:103], v[44:47]
  v_mfma_f32_16x16x32_bf16 v[48:51], v[140:143], v[100:103], v[48:51]
  v_mfma_f32_16x16x32_bf16 v[36:39], v[152:155], v[104:107], v[36:39]
  v_mfma_f32_16x16x32_bf16 v[44:47], v[152:155], v[108:111], v[44:47]
  v_mfma_f32_16x16x32_bf16 v[48:51], v[156:159], v[108:111], v[48:51]
  s_sub_u32 s23, s49, 1
  s_min_u32 s23, s23, 62
  s_mov_b32 s101, 0
wm_235:
  buffer_load_dword v34, v30, s[72:75], s77 offen sc1
  s_add_u32 s101, s101, 1
  s_cmp_gt_u32 s101, 131072
  s_cbranch_scc1 main_end
  s_waitcnt vmcnt(0)
  v_cmp_gt_u32 vcc, s23, v34
  v_readfirstlane_b32 s100, v34
  s_nop 0
  s_cbranch_vccz wm_236
  s_sleep 4
  s_add_u32 s100, s100, 2
  s_cmp_ge_u32 s100, s23
  s_cbranch_scc1 wm_235
  s_sleep 40
  s_branch wm_235
wm_236:
  s_mov_b32 s101, 0
  s_branch qtp_238
qtp_237:
  s_sleep 2
qtp_238:
  s_add_u32 s29, s50, 4096
  buffer_load_dwordx4 v[160:163], v24, s[16:19], s29 offen offset:2560 sc1
  buffer_load_dwordx2 v[240:241], v25, s[16:19], s29 offen offset:3072 sc1
  s_add_u32 s29, s50, 20480
  buffer_load_dwordx4 v[164:167], v24, s[16:19], s29 offen offset:2560 sc1
  buffer_load_dwordx2 v[242:243], v25, s[16:19], s29 offen offset:3072 sc1
  s_add_u32 s29, s50, 36864
  buffer_load_dwordx4 v[168:171], v24, s[16:19], s29 offen offset:2560 sc1
  buffer_load_dwordx2 v[244:245], v25, s[16:19], s29 offen offset:3072 sc1
  s_add_u32 s29, s50, 53248
  buffer_load_dwordx4 v[172:175], v24, s[16:19], s29 offen offset:2560 sc1
  buffer_load_dwordx2 v[246:247], v25, s[16:19], s29 offen offset:3072 sc1
  s_add_u32 s101, s101, 1
  s_cmp_gt_u32 s101, 131072
  s_cbranch_scc1 main_end
  s_waitcnt vmcnt(0)
  v_max3_u32 v34, v160, v164, v168
  v_max3_u32 v34, v34, v172, v240
  v_max3_u32 v34, v34, v242, v244
  v_max_u32 v34, v34, v246
  v_cmp_eq_u32 vcc, -1, v34
  s_nop 1
  s_cbranch_vccnz qtp_237
  v_mfma_f32_16x16x32_bf16 v[40:43], v[160:163], v[64:67], 0
  v_mfma_f32_16x16x32_bf16 v[52:55], v[160:163], v[68:71], 0
  v_mfma_f32_16x16x32_bf16 v[40:43], v[164:167], v[72:75], v[40:43]
  v_mfma_f32_16x16x32_bf16 v[52:55], v[164:167], v[76:79], v[52:55]
  v_mfma_f32_16x16x32_bf16 v[40:43], v[240:243], v[80:83], v[40:43]
  v_mfma_f32_16x16x32_bf16 v[52:55], v[240:243], v[84:87], v[52:55]
  v_mfma_f32_16x16x32_bf16 v[40:43], v[168:171], v[88:91], v[40:43]
  v_mfma_f32_16x16x32_bf16 v[52:55], v[168:171], v[92:95], v[52:55]
  v_mfma_f32_16x16x32_bf16 v[40:43], v[172:175], v[96:99], v[40:43]
  v_mfma_f32_16x16x32_bf16 v[52:55], v[172:175], v[100:103], v[52:55]
  v_mfma_f32_16x16x32_bf16 v[40:43], v[244:247], v[104:107], v[40:43]
  v_mfma_f32_16x16x32_bf16 v[52:55], v[244:247], v[108:111], v[52:55]
  s_nop 4
  v_cndmask_b32 v36, v31, v36, s[64:65]
  v_cndmask_b32 v48, v31, v48, s[64:65]
  v_cndmask_b32 v37, v31, v37, s[66:67]
  v_cndmask_b32 v49, v31, v49, s[66:67]
  v_cndmask_b32 v38, v31, v38, s[68:69]
  v_cndmask_b32 v50, v31, v50, s[68:69]
  v_cndmask_b32 v39, v31, v39, s[70:71]
  v_cndmask_b32 v51, v31, v51, s[70:71]
  v_max3_f32 v34, v36, v37, v38
  v_max3_f32 v34, v34, v39, v40
  v_max3_f32 v34, v34, v41, v42
  v_max_f32 v34, v34, v43
  v_mov_b32 v35, v34
  s_nop 1
  v_permlane32_swap_b32 v34, v35
  v_max_f32 v34, v34, v35
  v_mov_b32 v35, v34
  s_nop 1
  v_permlane16_swap_b32 v34, v35
  v_max_f32 v34, v34, v35
  v_mul_f32 v34, s83, v34
  v_fma_f32 v36, v36, s83, -v34
  v_fma_f32 v37, v37, s83, -v34
  v_fma_f32 v38, v38, s83, -v34
  v_fma_f32 v39, v39, s83, -v34
  v_fma_f32 v40, v40, s83, -v34
  v_fma_f32 v41, v41, s83, -v34
  v_fma_f32 v42, v42, s83, -v34
  v_fma_f32 v43, v43, s83, -v34
  v_exp_f32 v36, v36
  v_exp_f32 v37, v37
  v_exp_f32 v38, v38
  v_exp_f32 v39, v39
  v_exp_f32 v40, v40
  v_exp_f32 v41, v41
  v_exp_f32 v42, v42
  v_exp_f32 v43, v43
  s_nop 0
  v_add_f32 v34, v40, v41
  v_add_f32 v34, v34, v42
  v_add_f32 v34, v34, v43
  v_cndmask_b32 v34, 0, v34, s[62:63]
  v_add_f32 v34, v34, v36
  v_add_f32 v34, v34, v37
  v_add_f32 v34, v34, v38
  v_add_f32 v34, v34, v39
  v_mov_b32 v35, v34
  s_nop 1
  v_permlane32_swap_b32 v34, v35
  v_add_f32 v34, v34, v35
  v_mov_b32 v35, v34
  s_nop 1
  v_permlane16_swap_b32 v34, v35
  v_add_f32 v34, v34, v35
  v_rcp_f32 v34, v34
  s_nop 0
  v_mul_f32 v36, v36, v34
  v_mul_f32 v37, v37, v34
  v_mul_f32 v38, v38, v34
  v_mul_f32 v39, v39, v34
  v_mul_f32 v40, v40, v34
  v_mul_f32 v41, v41, v34
  v_mul_f32 v42, v42, v34
  v_mul_f32 v43, v43, v34
  v_max3_f32 v34, v44, v45, v46
  v_max3_f32 v34, v34, v47, v48
  v_max3_f32 v34, v34, v49, v50
  v_max3_f32 v34, v34, v51, v52
  v_max3_f32 v34, v34, v53, v54
  v_max_f32 v34, v34, v55
  v_mov_b32 v35, v34
  s_nop 1
  v_permlane32_swap_b32 v34, v35
  v_max_f32 v34, v34, v35
  v_mov_b32 v35, v34
  s_nop 1
  v_permlane16_swap_b32 v34, v35
  v_max_f32 v34, v34, v35
  v_mul_f32 v34, s83, v34
  v_fma_f32 v44, v44, s83, -v34
  v_fma_f32 v45, v45, s83, -v34
  v_fma_f32 v46, v46, s83, -v34
  v_fma_f32 v47, v47, s83, -v34
  v_fma_f32 v48, v48, s83, -v34
  v_fma_f32 v49, v49, s83, -v34
  v_fma_f32 v50, v50, s83, -v34
  v_fma_f32 v51, v51, s83, -v34
  v_fma_f32 v52, v52, s83, -v34
  v_fma_f32 v53, v53, s83, -v34
  v_fma_f32 v54, v54, s83, -v34
  v_fma_f32 v55, v55, s83, -v34
  v_exp_f32 v44, v44
  v_exp_f32 v45, v45
  v_exp_f32 v46, v46
  v_exp_f32 v47, v47
  v_exp_f32 v48, v48
  v_exp_f32 v49, v49
  v_exp_f32 v50, v50
  v_exp_f32 v51, v51
  v_exp_f32 v52, v52
  v_exp_f32 v53, v53
  v_exp_f32 v54, v54
  v_exp_f32 v55, v55
  s_nop 0
  v_add_f32 v34, v52, v53
  v_add_f32 v34, v34, v54
  v_add_f32 v34, v34, v55
  v_cndmask_b32 v34, 0, v34, s[62:63]
  v_add_f32 v34, v34, v44
  v_add_f32 v34, v34, v45
  v_add_f32 v34, v34, v46
  v_add_f32 v34, v34, v47
  v_add_f32 v34, v34, v48
  v_add_f32 v34, v34, v49
  v_add_f32 v34, v34, v50
  v_add_f32 v34, v34, v51
  v_mov_b32 v35, v34
  s_nop 1
  v_permlane32_swap_b32 v34, v35
  v_add_f32 v34, v34, v35
  v_mov_b32 v35, v34
  s_nop 1
  v_permlane16_swap_b32 v34, v35
  v_add_f32 v34, v34, v35
  v_rcp_f32 v34, v34
  s_nop 0
  v_mul_f32 v44, v44, v34
  v_mul_f32 v45, v45, v34
  v_mul_f32 v46, v46, v34
  v_mul_f32 v47, v47, v34
  v_mul_f32 v48, v48, v34
  v_mul_f32 v49, v49, v34
  v_mul_f32 v50, v50, v34
  v_mul_f32 v51, v51, v34
  v_mul_f32 v52, v52, v34
  v_mul_f32 v53, v53, v34
  v_mul_f32 v54, v54, v34
  v_mul_f32 v55, v55, v34
  v_cvt_pk_bf16_f32 v56, v44, v45
  v_cvt_pk_bf16_f32 v57, v46, v47
  v_cvt_pk_bf16_f32 v58, v48, v49
  v_cvt_pk_bf16_f32 v59, v50, v51
  v_cvt_pk_bf16_f32 v60, v40, v41
  v_cvt_pk_bf16_f32 v61, v42, v43
  v_cvt_pk_bf16_f32 v62, v52, v53
  v_cvt_pk_bf16_f32 v63, v54, v55
  v_cvt_pk_bf16_f32 v248, v36, v37
  v_cvt_pk_bf16_f32 v249, v38, v39
  buffer_store_dwordx4 v[56:59], v26, s[16:19], s81 offen sc1
  buffer_store_dwordx4 v[60:63], v26, s[16:19], s81 offen offset:1024 sc1
  buffer_store_dwordx2 v[248:249], v29, s[16:19], s81 offen offset:2048 sc1
  s_mov_b32 s84, s82
  s_waitcnt vmcnt(0)
  buffer_atomic_add v28, v33, s[72:75], s82 offen sc1
  s_branch qe_239
qw_227:
  s_mov_b32 s101, 0
wm_240:
  buffer_load_dword v32, v30, s[72:75], s77 offen sc1
  s_add_u32 s101, s101, 1
  s_cmp_gt_u32 s101, 131072
  s_cbranch_scc1 main_end
  s_waitcnt vmcnt(0)
  v_cmp_gt_u32 vcc, s49, v32
  v_readfirstlane_b32 s100, v32
  s_nop 0
  s_cbranch_vccz wm_241
  s_sleep 4
  s_add_u32 s100, s100, 2
  s_cmp_ge_u32 s100, s49
  s_cbranch_scc1 wm_240
  s_sleep 60
  s_branch wm_240
wm_241:
  s_branch qj_228
qa2_224:
  s_mov_b32 s49, 0
  s_mov_b32 s50, 1073741824
  s_mov_b32 s81, 1073741824
  s_mov_b32 s82, 1073741824
  s_branch qa3_225
qe_239:
queue:
  s_lshr_b32 s21, s3, 5
  s_cmp_eq_u32 s21, 2
  s_cbranch_scc1 main_fin
  s_load_dwordx2 s[4:5], s[0:1], 88
  s_load_dwordx2 s[6:7], s[0:1], 72
  s_load_dwordx2 s[38:39], s[0:1], 104
  s_and_b32 s41, s3, 7
  s_lshr_b32 s58, s3, 4
  s_bfe_u32 s21, s3, 0x20003
  s_cmp_lt_u32 s3, 64
  s_cselect_b32 s58, s58, s21
  s_lshl_b32 s59, s58, 3
  s_add_u32 s59, s59, s41
  s_lshl_b32 s59, s59, 7
  s_add_u32 s59, s59, 40960
  s_xor_b32 s59, s59, s80
  s_waitcnt vmcnt(0) lgkmcnt(0)
  s_barrier
  s_mov_b32 s8, s4
  s_mov_b32 s9, s5
  s_mov_b32 s10, 2621440
  s_mov_b32 s11, 0x00020000
  s_mov_b32 s12, s6
  s_mov_b32 s13, s7
  s_mov_b32 s14, 819200
  s_mov_b32 s15, 0x00020000
  s_mov_b32 s16, s38
  s_mov_b32 s17, s39
  s_mov_b32 s18, 167772160
  s_mov_b32 s19, 0x00020000
  s_add_u32 s28, s38, 170917888
  s_addc_u32 s29, s39, 0
  s_mov_b32 s30, 8192
  s_mov_b32 s31, 0x00020000
  s_add_u32 s72, s38, 168886272
  s_addc_u32 s73, s39, 0
  s_mov_b32 s74, 49152
  s_mov_b32 s75, 0x00020000
  v_mov_b32 v28, 0
  v_mov_b32 v30, 102400
  s_cmp_lg_u32 s20, 0
  s_cbranch_scc1 pvc_242
  v_mov_b32 v29, 1
  s_mov_b64 exec, 1
  buffer_atomic_add v29, v28, s[72:75], s59 offen sc0 sc1
  s_waitcnt vmcnt(0)
  ds_write_b32 v30, v29
  s_waitcnt lgkmcnt(0)
  s_mov_b64 exec, -1
pvc_242:
  s_barrier
  ds_read_b32 v23, v30
  s_waitcnt lgkmcnt(0)
  v_readfirstlane_b32 s2, v23
  s_cmp_ge_u32 s2, 16
  s_cbranch_scc1 main_fin
  s_mul_i32 s21, s20, 204800
  s_mul_i32 s22, s41, 160
  s_add_u32 s21, s21, s22
  s_mul_i32 s22, s20, 25600
  v_add_u32 v5, 0, v1
  v_mul_u32_u24 v6, 6554, v5
  v_lshrrev_b32 v6, 16, v6
  v_mul_u32_u24 v6, 1120, v6
  v_lshl_add_u32 v8, v5, 4, v6
  v_add_u32 v5, 64, v1
  v_mul_u32_u24 v6, 6554, v5
  v_lshrrev_b32 v6, 16, v6
  v_mul_u32_u24 v6, 1120, v6
  v_lshl_add_u32 v9, v5, 4, v6
  v_add_u32 v5, 128, v1
  v_mul_u32_u24 v6, 6554, v5
  v_lshrrev_b32 v6, 16, v6
  v_mul_u32_u24 v6, 1120, v6
  v_lshl_add_u32 v10, v5, 4, v6
  v_add_u32 v5, 192, v1
  v_mul_u32_u24 v6, 6554, v5
  v_lshrrev_b32 v6, 16, v6
  v_mul_u32_u24 v6, 1120, v6
  v_lshl_add_u32 v11, v5, 4, v6
  v_add_u32 v5, 256, v1
  v_mul_u32_u24 v6, 6554, v5
  v_lshrrev_b32 v6, 16, v6
  v_mul_u32_u24 v6, 1120, v6
  v_lshl_add_u32 v12, v5, 4, v6
  s_add_u32 m0, s22, 0
  s_nop 0
  buffer_load_dwordx4 v8, s[12:15], s21 offen lds
  s_add_u32 m0, s22, 1024
  s_nop 0
  buffer_load_dwordx4 v9, s[12:15], s21 offen lds
  s_add_u32 m0, s22, 2048
  s_nop 0
  buffer_load_dwordx4 v10, s[12:15], s21 offen lds
  s_add_u32 m0, s22, 3072
  s_nop 0
  buffer_load_dwordx4 v11, s[12:15], s21 offen lds
  s_add_u32 m0, s22, 4096
  s_nop 0
  buffer_load_dwordx4 v12, s[12:15], s21 offen lds
  s_add_u32 s21, s21, 40960
  s_add_u32 m0, s22, 5120
  s_nop 0
  buffer_load_dwordx4 v8, s[12:15], s21 offen lds
  s_add_u32 m0, s22, 6144
  s_nop 0
  buffer_load_dwordx4 v9, s[12:15], s21 offen lds
  s_add_u32 m0, s22, 7168
  s_nop 0
  buffer_load_dwordx4 v10, s[12:15], s21 offen lds
  s_add_u32 m0, s22, 8192
  s_nop 0
  buffer_load_dwordx4 v11, s[12:15], s21 offen lds
  s_add_u32 m0, s22, 9216
  s_nop 0
  buffer_load_dwordx4 v12, s[12:15], s21 offen lds
  s_add_u32 s21, s21, 40960
  s_add_u32 m0, s22, 10240
  s_nop 0
  buffer_load_dwordx4 v8, s[12:15], s21 offen lds
  s_add_u32 m0, s22, 11264
  s_nop 0
  buffer_load_dwordx4 v9, s[12:15], s21 offen lds
  s_add_u32 m0, s22, 12288
  s_nop 0
  buffer_load_dwordx4 v10, s[12:15], s21 offen lds
  s_add_u32 m0, s22, 13312
  s_nop 0
  buffer_load_dwordx4 v11, s[12:15], s21 offen lds
  s_add_u32 m0, s22, 14336
  s_nop 0
  buffer_load_dwordx4 v12, s[12:15], s21 offen lds
  s_add_u32 s21, s21, 40960
  s_add_u32 m0, s22, 15360
  s_nop 0
  buffer_load_dwordx4 v8, s[12:15], s21 offen lds
  s_add_u32 m0, s22, 16384
  s_nop 0
  buffer_load_dwordx4 v9, s[12:15], s21 offen lds
  s_add_u32 m0, s22, 17408
  s_nop 0
  buffer_load_dwordx4 v10, s[12:15], s21 offen lds
  s_add_u32 m0, s22, 18432
  s_nop 0
  buffer_load_dwordx4 v11, s[12:15], s21 offen lds
  s_add_u32 m0, s22, 19456
  s_nop 0
  buffer_load_dwordx4 v12, s[12:15], s21 offen lds
  s_add_u32 s21, s21, 40960
  s_add_u32 m0, s22, 20480
  s_nop 0
  buffer_load_dwordx4 v8, s[12:15], s21 offen lds
  s_add_u32 m0, s22, 21504
  s_nop 0
  buffer_load_dwordx4 v9, s[12:15], s21 offen lds
  s_add_u32 m0, s22, 22528
  s_nop 0
  buffer_load_dwordx4 v10, s[12:15], s21 offen lds
  s_add_u32 m0, s22, 23552
  s_nop 0
  buffer_load_dwordx4 v11, s[12:15], s21 offen lds
  s_add_u32 m0, s22, 24576
  s_nop 0
  buffer_load_dwordx4 v12, s[12:15], s21 offen lds
  s_add_u32 s21, s21, 40960
  v_and_b32 v25, 3, v1
  v_lshlrev_b32 v25, 7, v25
  s_mov_b32 s21, 29696
  s_xor_b32 s21, s21, s80
  v_lshrrev_b32 v5, 2, v2
  v_and_b32 v6, 3, v2
  v_lshlrev_b32 v6, 3, v6
  v_lshl_add_u32 v7, v3, 2, v5
  v_mul_u32_u24 v7, 160, v7
  v_add3_u32 v8, v7, v6, s22
  v_add_u32 v9, v8, v6
  v_mul_u32_u24 v7, 20, v3
  v_add_u32 v7, v7, v5
  v_mul_u32_u24 v7, 160, v7
  v_add3_u32 v10, v7, v6, s22
  v_add_u32 v11, v10, v6
  s_mov_b32 s101, 0
wm_243:
  buffer_load_dword v26, v25, s[72:75], s21 offen sc1
  s_add_u32 s101, s101, 1
  s_cmp_gt_u32 s101, 131072
  s_cbranch_scc1 main_end
  s_waitcnt vmcnt(0)
  v_cmp_gt_u32 vcc, 16, v26
  v_readfirstlane_b32 s100, v26
  s_nop 0
  s_cbranch_vccz wm_244
  s_sleep 16
  s_branch wm_243
wm_244:
  ds_read_b64_tr_b16 a[160:161], v9 offset:0
  ds_read_b64_tr_b16 a[162:163], v9 offset:3200
  ds_read_b64_tr_b16 a[164:165], v9 offset:8
  ds_read_b64_tr_b16 a[166:167], v9 offset:3208
  ds_read_b64_tr_b16 a[168:169], v8 offset:64
  ds_read_b64_tr_b16 a[170:171], v8 offset:3264
  ds_read_b64_tr_b16 a[172:173], v9 offset:96
  ds_read_b64_tr_b16 a[174:175], v9 offset:3296
  ds_read_b64_tr_b16 a[176:177], v9 offset:104
  ds_read_b64_tr_b16 a[178:179], v9 offset:3304
  ds_read_b64_tr_b16 a[180:181], v9 offset:6400
  ds_read_b64_tr_b16 a[182:183], v9 offset:9600
  ds_read_b64_tr_b16 a[184:185], v9 offset:6408
  ds_read_b64_tr_b16 a[186:187], v9 offset:9608
  ds_read_b64_tr_b16 a[188:189], v8 offset:6464
  ds_read_b64_tr_b16 a[190:191], v8 offset:9664
  ds_read_b64_tr_b16 a[192:193], v9 offset:6496
  ds_read_b64_tr_b16 a[194:195], v9 offset:9696
  ds_read_b64_tr_b16 a[196:197], v9 offset:6504
  ds_read_b64_tr_b16 a[198:199], v9 offset:9704
  ds_read_b64_tr_b16 a[200:201], v9 offset:12800
  ds_read_b64_tr_b16 a[202:203], v9 offset:16000
  ds_read_b64_tr_b16 a[204:205], v9 offset:12808
  ds_read_b64_tr_b16 a[206:207], v9 offset:16008
  ds_read_b64_tr_b16 a[208:209], v8 offset:12864
  ds_read_b64_tr_b16 a[210:211], v8 offset:16064
  ds_read_b64_tr_b16 a[212:213], v9 offset:12896
  ds_read_b64_tr_b16 a[214:215], v9 offset:16096
  ds_read_b64_tr_b16 a[216:217], v9 offset:12904
  ds_read_b64_tr_b16 a[218:219], v9 offset:16104
  ds_read_b64_tr_b16 a[220:221], v9 offset:19200
  ds_read_b64_tr_b16 a[222:223], v9 offset:22400
  ds_read_b64_tr_b16 a[224:225], v9 offset:19208
  ds_read_b64_tr_b16 a[226:227], v9 offset:22408
  ds_read_b64_tr_b16 a[228:229], v8 offset:19264
  ds_read_b64_tr_b16 a[230:231], v8 offset:22464
  ds_read_b64_tr_b16 a[232:233], v9 offset:19296
  ds_read_b64_tr_b16 a[234:235], v9 offset:22496
  ds_read_b64_tr_b16 a[236:237], v9 offset:19304
  ds_read_b64_tr_b16 a[238:239], v9 offset:22504
  ds_read_b64_tr_b16 a[240:241], v11 offset:2560
  ds_read_b64_tr_b16 a[242:243], v11 offset:15360
  ds_read_b64_tr_b16 a[244:245], v11 offset:2568
  ds_read_b64_tr_b16 a[246:247], v11 offset:15368
  ds_read_b64_tr_b16 a[248:249], v10 offset:2624
  ds_read_b64_tr_b16 a[250:251], v10 offset:15424
  ds_read_b64_tr_b16 a[252:253], v11 offset:2656
  ds_read_b64_tr_b16 a[254:255], v11 offset:15456
  ds_read_b64_tr_b16 v[252:253], v11 offset:2664
  ds_read_b64_tr_b16 v[254:255], v11 offset:15464
  s_waitcnt lgkmcnt(0)
  s_barrier
  v_lshlrev_b32 v4, 4, v1
  v_lshlrev_b32 v5, 3, v1
  v_lshlrev_b32 v6, 2, v2
  v_and_b32 v7, 7, v1
  v_lshlrev_b32 v7, 7, v7
  v_bfe_u32 v31, v1, 3, 2
  v_lshl_add_u32 v31, v31, 2, v7
  s_lshl_b32 s21, s20, 10
  s_add_u32 s21, s21, 4096
  s_xor_b32 s21, s21, s80
  buffer_load_dword v8, v31, s[72:75], s21 offen sc1
  s_mov_b32 s63, 1
  s_mov_b32 s60, 0
  v_mul_u32_u24 v9, 1280, v2
  v_lshl_add_u32 v13, v3, 3, v9
  v_lshl_add_u32 v9, v3, 4, v9
  s_mul_i32 s21, s20, 10240
  v_add_u32 v10, s21, v4
  s_and_b32 s43, s20, 1
  s_lshr_b32 s44, s20, 1
  s_mul_i32 s21, s44, 6
  s_add_u32 s21, s21, s43
  s_lshl_b32 s21, s21, 10
  v_add_u32 v11, s21, v4
  s_add_u32 s21, s43, 4
  s_lshl_b32 s21, s21, 10
  v_add_u32 v12, s21, v4
  v_lshrrev_b32 v20, 5, v1
  v_mul_u32_u24 v21, 2560, v20
  v_add_u32 v21, v21, v4
  v_and_b32 v22, 31, v1
  v_lshlrev_b32 v22, 4, v22
  v_mul_u32_u24 v14, 640, v20
  v_add_u32 v22, v22, v14
  v_and_b32 v15, 1, v3
  v_lshl_add_u32 v14, v15, 6, v14
  v_lshrrev_b32 v16, 3, v2
  v_mul_u32_u24 v16, 16320, v16
  v_lshl_add_u32 v16, v2, 3, v16
  v_add_u32 v14, v14, v16
  v_add_u32 v15, 40960, v11
  v_lshlrev_b32 v17, 2, v7
  v_bfe_u32 v16, v1, 3, 1
  v_lshl_add_u32 v17, v16, 3, v17
  v_cmp_gt_u32 s[66:67], 16, v1
  v_add_u32 v16, 40960, v12
  s_mov_b32 s50, 0
  s_lshr_b32 s52, s41, 1
  s_lshl_b32 s52, s52, 7
  s_and_b32 s21, s41, 1
  s_lshl_b32 s21, s21, 4
  s_add_u32 s52, s52, s21
  s_add_u32 s52, s52, 0
  s_xor_b32 s52, s52, s80
  v_mov_b32 v70, 0
  v_mov_b32 v71, 0
  v_mov_b32 v78, 0
  v_mov_b32 v79, 0
  v_mov_b32 v86, 0
  v_mov_b32 v87, 0
  v_mov_b32 v94, 0
  v_mov_b32 v95, 0
  v_mov_b32 v102, 0
  v_mov_b32 v103, 0
  v_mov_b32 v110, 0
  v_mov_b32 v111, 0
  v_mov_b32 v118, 0
  v_mov_b32 v119, 0
  v_mov_b32 v126, 0
  v_mov_b32 v127, 0
pv_loop:
  s_lshl_b32 s40, s2, 2
  s_add_u32 s40, s40, s58
  s_lshl_b32 s2, s40, 3
  s_add_u32 s2, s2, s41
  s_lshl_b32 s61, s40, 21
  s_lshl_b32 s21, s40, 13
  s_and_b32 s21, s21, 8192
  s_xor_b32 s21, s21, s80
  s_add_u32 s61, s61, s21
  s_lshl_b32 s55, s40, 19
  s_lshl_b32 s21, s40, 11
  s_and_b32 s21, s21, 8192
  s_xor_b32 s21, s21, s80
  s_add_u32 s55, s55, s21
  s_add_u32 s55, s55, 134217728
  s_lshl_b32 s21, s20, 15
  s_xor_b32 s54, s55, 270336
  s_add_u32 s54, s54, s21
  s_add_u32 s21, s54, 0
  buffer_load_dwordx4 v[192:195], v4, s[16:19], s21 offen offset:0 sc1
  buffer_load_dwordx4 v[196:199], v4, s[16:19], s21 offen offset:1024 sc1
  buffer_load_dwordx2 v[208:209], v5, s[16:19], s21 offen offset:2048 sc1
  s_add_u32 s21, s54, 2560
  buffer_load_dwordx4 v[200:203], v4, s[16:19], s21 offen offset:0 sc1
  buffer_load_dwordx4 v[204:207], v4, s[16:19], s21 offen offset:1024 sc1
  buffer_load_dwordx2 v[210:211], v5, s[16:19], s21 offen offset:2048 sc1
  s_add_u32 s21, s54, 16384
  buffer_load_dwordx4 v[212:215], v4, s[16:19], s21 offen offset:0 sc1
  buffer_load_dwordx4 v[216:219], v4, s[16:19], s21 offen offset:1024 sc1
  buffer_load_dwordx2 v[228:229], v5, s[16:19], s21 offen offset:2048 sc1
  s_add_u32 s21, s54, 18944
  buffer_load_dwordx4 v[220:223], v4, s[16:19], s21 offen offset:0 sc1
  buffer_load_dwordx4 v[224:227], v4, s[16:19], s21 offen offset:1024 sc1
  buffer_load_dwordx2 v[230:231], v5, s[16:19], s21 offen offset:2048 sc1
  s_lshl_b32 s21, s40, 7
  s_add_u32 s21, s21, 8192
  s_xor_b32 s21, s21, s80
  v_mov_b32 v18, s21
  v_add_u32 v19, s52, v17
  v_cndmask_b32 v18, v19, v18, s[66:67]
  s_add_u32 s21, s40, 1
  v_mov_b32 v19, s21
  v_cndmask_b32 v19, v19, 32, s[66:67]
  buffer_load_dword v27, v18, s[72:75], 0 offen sc1
  s_cmp_lg_u32 s20, 0
  s_cbranch_scc1 pv_245
  v_mov_b32 v29, 1
  s_mov_b64 exec, 1
  buffer_atomic_add v29, v28, s[72:75], s59 offen sc0 sc1
  s_mov_b64 exec, -1
pv_245:
  s_lshl_b32 s21, s20, 17
  s_lshl_b32 s22, s41, 10
  s_add_u32 s42, s21, s22
  s_lshl_b32 s53, s20, 19
  s_lshr_b32 s22, s41, 1
  s_lshl_b32 s22, s22, 14
  s_add_u32 s53, s53, s22
  s_and_b32 s22, s41, 1
  s_lshl_b32 s22, s22, 12
  s_add_u32 s53, s53, s22
  s_lshl_b32 s21, s40, 1
  s_add_u32 s21, s21, s43
  s_lshl_b32 s45, s21, 6
  s_mul_i32 s46, s21, 20480
  s_mul_i32 s22, s41, 160
  s_add_u32 s49, s46, s22
  s_mul_i32 s21, s44, 96
  s_add_u32 s46, s49, s21
  s_lshl_b32 s21, s20, 16
  s_xor_b32 s47, s55, 8192
  s_add_u32 s47, s47, s21
  s_lshl_b32 s21, s20, 19
  s_add_u32 s48, s61, s21
  s_lshl_b32 s21, s41, 15
  s_add_u32 s48, s48, s21
  s_add_u32 s48, s48, 4096
  s_add_u32 s23, s40, 1
  s_cmp_ge_u32 s50, s23
  s_cbranch_scc1 pv_246
  s_cmp_eq_u32 s63, 0
  s_cbranch_scc1 pv_249
  s_mov_b32 s63, 0
  s_waitcnt vmcnt(13)
  v_cmp_gt_u32 vcc, s23, v8
  s_nop 1
  s_cbranch_vccz pv_250
pv_249:
  s_lshl_b32 s21, s20, 10
  s_add_u32 s21, s21, 4096
  s_xor_b32 s21, s21, s80
  s_mov_b32 s101, 0
wm_253:
  buffer_load_dword v8, v31, s[72:75], s21 offen sc1
  s_add_u32 s101, s101, 1
  s_cmp_gt_u32 s101, 131072
  s_cbranch_scc1 main_end
  s_waitcnt vmcnt(0)
  v_cmp_gt_u32 vcc, s23, v8
  v_readfirstlane_b32 s100, v8
  s_nop 0
  s_cbranch_vccz wm_254
  s_sleep 8
  s_add_u32 s100, s100, 2
  s_cmp_ge_u32 s100, s23
  s_cbranch_scc1 wm_253
  s_sleep 60
  s_branch wm_253
wm_254:
pv_250:
  v_readlane_b32 s50, v8, 0
  v_readlane_b32 s21, v8, 1
  s_min_u32 s50, s50, s21
  v_readlane_b32 s21, v8, 2
  s_min_u32 s50, s50, s21
  v_readlane_b32 s21, v8, 3
  s_min_u32 s50, s50, s21
  v_readlane_b32 s21, v8, 4
  s_min_u32 s50, s50, s21
  v_readlane_b32 s21, v8, 5
  s_min_u32 s50, s50, s21
  v_readlane_b32 s21, v8, 6
  s_min_u32 s50, s50, s21
  v_readlane_b32 s21, v8, 7
  s_min_u32 s50, s50, s21
  v_readlane_b32 s21, v8, 8
  s_min_u32 s50, s50, s21
  v_readlane_b32 s21, v8, 9
  s_min_u32 s50, s50, s21
  v_readlane_b32 s21, v8, 10
  s_min_u32 s50, s50, s21
  v_readlane_b32 s21, v8, 11
  s_min_u32 s50, s50, s21
  v_readlane_b32 s21, v8, 12
  s_min_u32 s50, s50, s21
  v_readlane_b32 s21, v8, 13
  s_min_u32 s50, s50, s21
  v_readlane_b32 s21, v8, 14
  s_min_u32 s50, s50, s21
  v_readlane_b32 s21, v8, 15
  s_min_u32 s50, s50, s21
  v_readlane_b32 s21, v8, 16
  s_min_u32 s50, s50, s21
  v_readlane_b32 s21, v8, 17
  s_min_u32 s50, s50, s21
  v_readlane_b32 s21, v8, 18
  s_min_u32 s50, s50, s21
  v_readlane_b32 s21, v8, 19
  s_min_u32 s50, s50, s21
  v_readlane_b32 s21, v8, 20
  s_min_u32 s50, s50, s21
  v_readlane_b32 s21, v8, 21
  s_min_u32 s50, s50, s21
  v_readlane_b32 s21, v8, 22
  s_min_u32 s50, s50, s21
  v_readlane_b32 s21, v8, 23
  s_min_u32 s50, s50, s21
  v_readlane_b32 s21, v8, 24
  s_min_u32 s50, s50, s21
  v_readlane_b32 s21, v8, 25
  s_min_u32 s50, s50, s21
  v_readlane_b32 s21, v8, 26
  s_min_u32 s50, s50, s21
  v_readlane_b32 s21, v8, 27
  s_min_u32 s50, s50, s21
  v_readlane_b32 s21, v8, 28
  s_min_u32 s50, s50, s21
  v_readlane_b32 s21, v8, 29
  s_min_u32 s50, s50, s21
  v_readlane_b32 s21, v8, 30
  s_min_u32 s50, s50, s21
  v_readlane_b32 s21, v8, 31
  s_min_u32 s50, s50, s21
pv_246:
  buffer_load_dword v24, v6, s[28:31], s45 offen sc1
  s_xor_b32 s68, s61, 8192
  s_add_u32 s68, s68, s53
  s_add_u32 s70, s55, s42
  buffer_load_dwordx4 a[0:3], v4, s[16:19], s68 offen offset:0 sc1
  buffer_load_dwordx4 a[4:7], v4, s[16:19], s68 offen offset:1024 sc1
  buffer_load_dwordx4 a[8:11], v4, s[16:19], s70 offen sc1
  s_add_u32 s70, s70, 16384
  buffer_load_dwordx4 a[12:15], v4, s[16:19], s68 offen offset:2048 sc1
  buffer_load_dwordx4 a[16:19], v4, s[16:19], s68 offen offset:3072 sc1
  s_add_u32 s68, s68, 65536
  buffer_load_dwordx4 a[20:23], v4, s[16:19], s68 offen offset:0 sc1
  buffer_load_dwordx4 a[24:27], v4, s[16:19], s68 offen offset:1024 sc1
  buffer_load_dwordx4 a[28:31], v4, s[16:19], s70 offen sc1
  s_add_u32 s70, s70, 16384
  buffer_load_dwordx4 a[32:35], v4, s[16:19], s68 offen offset:2048 sc1
  buffer_load_dwordx4 a[36:39], v4, s[16:19], s68 offen offset:3072 sc1
  s_add_u32 s68, s68, 65536
  buffer_load_dwordx4 a[40:43], v4, s[16:19], s68 offen offset:0 sc1
  buffer_load_dwordx4 a[44:47], v4, s[16:19], s68 offen offset:1024 sc1
  buffer_load_dwordx4 a[48:51], v4, s[16:19], s70 offen sc1
  s_add_u32 s70, s70, 16384
  buffer_load_dwordx4 a[52:55], v4, s[16:19], s68 offen offset:2048 sc1
  buffer_load_dwordx4 a[56:59], v4, s[16:19], s68 offen offset:3072 sc1
  s_add_u32 s68, s68, 65536
  buffer_load_dwordx4 a[60:63], v4, s[16:19], s68 offen offset:0 sc1
  buffer_load_dwordx4 a[64:67], v4, s[16:19], s68 offen offset:1024 sc1
  buffer_load_dwordx4 a[68:71], v4, s[16:19], s70 offen sc1
  s_add_u32 s70, s70, 16384
  buffer_load_dwordx4 a[72:75], v4, s[16:19], s68 offen offset:2048 sc1
  buffer_load_dwordx4 a[76:79], v4, s[16:19], s68 offen offset:3072 sc1
  s_add_u32 s68, s68, 65536
  buffer_load_dwordx4 a[80:83], v4, s[16:19], s68 offen offset:0 sc1
  buffer_load_dwordx4 a[84:87], v4, s[16:19], s68 offen offset:1024 sc1
  buffer_load_dwordx4 a[88:91], v4, s[16:19], s70 offen sc1
  s_add_u32 s70, s70, 16384
  buffer_load_dwordx4 a[92:95], v4, s[16:19], s68 offen offset:2048 sc1
  buffer_load_dwordx4 a[96:99], v4, s[16:19], s68 offen offset:3072 sc1
  s_add_u32 s68, s68, 65536
  buffer_load_dwordx4 a[100:103], v4, s[16:19], s68 offen offset:0 sc1
  buffer_load_dwordx4 a[104:107], v4, s[16:19], s68 offen offset:1024 sc1
  buffer_load_dwordx4 a[108:111], v4, s[16:19], s70 offen sc1
  s_add_u32 s70, s70, 16384
  buffer_load_dwordx4 a[112:115], v4, s[16:19], s68 offen offset:2048 sc1
  buffer_load_dwordx4 a[116:119], v4, s[16:19], s68 offen offset:3072 sc1
  s_add_u32 s68, s68, 65536
  buffer_load_dwordx4 a[120:123], v4, s[16:19], s68 offen offset:0 sc1
  buffer_load_dwordx4 a[124:127], v4, s[16:19], s68 offen offset:1024 sc1
  buffer_load_dwordx4 a[128:131], v4, s[16:19], s70 offen sc1
  s_add_u32 s70, s70, 16384
  buffer_load_dwordx4 a[132:135], v4, s[16:19], s68 offen offset:2048 sc1
  buffer_load_dwordx4 a[136:139], v4, s[16:19], s68 offen offset:3072 sc1
  s_add_u32 s68, s68, 65536
  buffer_load_dwordx4 a[140:143], v4, s[16:19], s68 offen offset:0 sc1
  buffer_load_dwordx4 a[144:147], v4, s[16:19], s68 offen offset:1024 sc1
  buffer_load_dwordx4 a[148:151], v4, s[16:19], s70 offen sc1
  s_add_u32 s70, s70, 16384
  buffer_load_dwordx4 a[152:155], v4, s[16:19], s68 offen offset:2048 sc1
  buffer_load_dwordx4 a[156:159], v4, s[16:19], s68 offen offset:3072 sc1
  s_add_u32 s68, s68, 65536
  s_waitcnt vmcnt(40)
  v_cmp_gt_u32 vcc, v19, v27
  s_nop 1
  s_cbranch_vccnz pvw_251
  buffer_load_dwordx4 v[64:67], v4, s[16:19], s47 offen sc1
  buffer_load_dwordx2 v[68:69], v5, s[16:19], s47 offen offset:2048 sc1
  buffer_load_dwordx4 v[128:131], v21, s[16:19], s47 offen offset:1024 sc1
  s_add_u32 s47, s47, 2560
  buffer_load_dwordx4 v[72:75], v4, s[16:19], s47 offen sc1
  buffer_load_dwordx2 v[76:77], v5, s[16:19], s47 offen offset:2048 sc1
  s_add_u32 s47, s47, 13824
  buffer_load_dwordx4 v[80:83], v4, s[16:19], s47 offen sc1
  buffer_load_dwordx2 v[84:85], v5, s[16:19], s47 offen offset:2048 sc1
  buffer_load_dwordx4 v[132:135], v21, s[16:19], s47 offen offset:1024 sc1
  s_add_u32 s47, s47, 2560
  buffer_load_dwordx4 v[88:91], v4, s[16:19], s47 offen sc1
  buffer_load_dwordx2 v[92:93], v5, s[16:19], s47 offen offset:2048 sc1
  s_add_u32 s47, s47, 13824
  s_add_u32 s21, s48, 16384
  buffer_load_dwordx4 v[32:35], v22, s[16:19], s48 offen offset:0 sc1
  buffer_load_dwordx4 v[40:43], v22, s[16:19], s21 offen offset:0 sc1
  buffer_load_dwordx2 v[184:185], v14, s[16:19], s48 offen offset:512 sc1
  buffer_load_dwordx4 v[36:39], v22, s[16:19], s48 offen offset:1280 sc1
  buffer_load_dwordx4 v[44:47], v22, s[16:19], s21 offen offset:1280 sc1
  buffer_load_dwordx2 v[186:187], v14, s[16:19], s48 offen offset:1792 sc1
  s_add_u32 s48, s48, 262144
  v_mfma_f32_16x16x32_bf16 v[144:147], a[160:163], v[192:195], 0
  v_mfma_f32_16x16x32_bf16 v[148:151], a[160:163], v[212:215], 0
  v_mfma_f32_16x16x32_bf16 v[152:155], a[164:167], v[192:195], 0
  v_mfma_f32_16x16x32_bf16 v[156:159], a[164:167], v[212:215], 0
  v_mfma_f32_16x16x32_bf16 v[160:163], a[168:171], v[192:195], 0
  v_mfma_f32_16x16x32_bf16 v[164:167], a[168:171], v[212:215], 0
  v_mfma_f32_16x16x32_bf16 v[168:171], a[172:175], v[192:195], 0
  v_mfma_f32_16x16x32_bf16 v[172:175], a[172:175], v[212:215], 0
  v_mfma_f32_16x16x32_bf16 v[176:179], a[176:179], v[192:195], 0
  v_mfma_f32_16x16x32_bf16 v[180:183], a[176:179], v[212:215], 0
  v_mfma_f32_16x16x32_bf16 v[144:147], a[180:183], v[196:199], v[144:147]
  v_mfma_f32_16x16x32_bf16 v[148:151], a[180:183], v[216:219], v[148:151]
  v_mfma_f32_16x16x32_bf16 v[152:155], a[184:187], v[196:199], v[152:155]
  v_mfma_f32_16x16x32_bf16 v[156:159], a[184:187], v[216:219], v[156:159]
  v_mfma_f32_16x16x32_bf16 v[160:163], a[188:191], v[196:199], v[160:163]
  v_mfma_f32_16x16x32_bf16 v[164:167], a[188:191], v[216:219], v[164:167]
  v_mfma_f32_16x16x32_bf16 v[168:171], a[192:195], v[196:199], v[168:171]
  v_mfma_f32_16x16x32_bf16 v[172:175], a[192:195], v[216:219], v[172:175]
  v_mfma_f32_16x16x32_bf16 v[176:179], a[196:199], v[196:199], v[176:179]
  v_mfma_f32_16x16x32_bf16 v[180:183], a[196:199], v[216:219], v[180:183]
  v_mfma_f32_16x16x32_bf16 v[144:147], a[200:203], v[200:203], v[144:147]
  v_mfma_f32_16x16x32_bf16 v[148:151], a[200:203], v[220:223], v[148:151]
  v_mfma_f32_16x16x32_bf16 v[152:155], a[204:207], v[200:203], v[152:155]
  v_mfma_f32_16x16x32_bf16 v[156:159], a[204:207], v[220:223], v[156:159]
  v_mfma_f32_16x16x32_bf16 v[160:163], a[208:211], v[200:203], v[160:163]
  v_mfma_f32_16x16x32_bf16 v[164:167], a[208:211], v[220:223], v[164:167]
  v_mfma_f32_16x16x32_bf16 v[168:171], a[212:215], v[200:203], v[168:171]
  v_mfma_f32_16x16x32_bf16 v[172:175], a[212:215], v[220:223], v[172:175]
  v_mfma_f32_16x16x32_bf16 v[176:179], a[216:219], v[200:203], v[176:179]
  v_mfma_f32_16x16x32_bf16 v[180:183], a[216:219], v[220:223], v[180:183]
  v_mfma_f32_16x16x32_bf16 v[144:147], a[220:223], v[204:207], v[144:147]
  v_mfma_f32_16x16x32_bf16 v[148:151], a[220:223], v[224:227], v[148:151]
  v_mfma_f32_16x16x32_bf16 v[152:155], a[224:227], v[204:207], v[152:155]
  v_mfma_f32_16x16x32_bf16 v[156:159], a[224:227], v[224:227], v[156:159]
  v_mfma_f32_16x16x32_bf16 v[160:163], a[228:231], v[204:207], v[160:163]
  v_mfma_f32_16x16x32_bf16 v[164:167], a[228:231], v[224:227], v[164:167]
  v_mfma_f32_16x16x32_bf16 v[168:171], a[232:235], v[204:207], v[168:171]
  v_mfma_f32_16x16x32_bf16 v[172:175], a[232:235], v[224:227], v[172:175]
  v_mfma_f32_16x16x32_bf16 v[176:179], a[236:239], v[204:207], v[176:179]
  v_mfma_f32_16x16x32_bf16 v[180:183], a[236:239], v[224:227], v[180:183]
  v_mfma_f32_16x16x32_bf16 v[144:147], a[240:243], v[208:211], v[144:147]
  v_mfma_f32_16x16x32_bf16 v[148:151], a[240:243], v[228:231], v[148:151]
  v_mfma_f32_16x16x32_bf16 v[152:155], a[244:247], v[208:211], v[152:155]
  v_mfma_f32_16x16x32_bf16 v[156:159], a[244:247], v[228:231], v[156:159]
  v_mfma_f32_16x16x32_bf16 v[160:163], a[248:251], v[208:211], v[160:163]
  v_mfma_f32_16x16x32_bf16 v[164:167], a[248:251], v[228:231], v[164:167]
  v_mfma_f32_16x16x32_bf16 v[168:171], a[252:255], v[208:211], v[168:171]
  v_mfma_f32_16x16x32_bf16 v[172:175], a[252:255], v[228:231], v[172:175]
  v_mfma_f32_16x16x32_bf16 v[176:179], v[252:255], v[208:211], v[176:179]
  v_mfma_f32_16x16x32_bf16 v[180:183], v[252:255], v[228:231], v[180:183]
  ds_write_b128 v10, v[144:147] offset:40960
  ds_write_b128 v10, v[148:151] offset:41984
  ds_write_b128 v10, v[152:155] offset:43008
  ds_write_b128 v10, v[156:159] offset:44032
  ds_write_b128 v10, v[160:163] offset:45056
  ds_write_b128 v10, v[164:167] offset:46080
  ds_write_b128 v10, v[168:171] offset:47104
  ds_write_b128 v10, v[172:175] offset:48128
  s_nop 1
  ds_write_b128 v10, v[176:179] offset:49152
  ds_write_b128 v10, v[180:183] offset:50176
  s_waitcnt lgkmcnt(0)
  s_waitcnt vmcnt(40)
  buffer_load_dwordx4 v[96:99], v4, s[16:19], s47 offen sc1
  buffer_load_dwordx2 v[100:101], v5, s[16:19], s47 offen offset:2048 sc1
  buffer_load_dwordx4 v[136:139], v21, s[16:19], s47 offen offset:1024 sc1
  s_add_u32 s47, s47, 2560
  buffer_load_dwordx4 v[104:107], v4, s[16:19], s47 offen sc1
  buffer_load_dwordx2 v[108:109], v5, s[16:19], s47 offen offset:2048 sc1
  s_add_u32 s47, s47, 13824
  buffer_load_dwordx4 v[112:115], v4, s[16:19], s47 offen sc1
  buffer_load_dwordx2 v[116:117], v5, s[16:19], s47 offen offset:2048 sc1
  buffer_load_dwordx4 v[140:143], v21, s[16:19], s47 offen offset:1024 sc1
  s_add_u32 s47, s47, 2560
  buffer_load_dwordx4 v[120:123], v4, s[16:19], s47 offen sc1
  buffer_load_dwordx2 v[124:125], v5, s[16:19], s47 offen offset:2048 sc1
  s_add_u32 s47, s47, 13824
  s_add_u32 s21, s48, 16384
  buffer_load_dwordx4 v[48:51], v22, s[16:19], s48 offen offset:0 sc1
  buffer_load_dwordx4 v[56:59], v22, s[16:19], s21 offen offset:0 sc1
  buffer_load_dwordx2 v[188:189], v14, s[16:19], s48 offen offset:512 sc1
  buffer_load_dwordx4 v[52:55], v22, s[16:19], s48 offen offset:1280 sc1
  buffer_load_dwordx4 v[60:63], v22, s[16:19], s21 offen offset:1280 sc1
  buffer_load_dwordx2 v[190:191], v14, s[16:19], s48 offen offset:1792 sc1
  s_add_u32 s48, s48, 262144
  s_barrier
  ds_read_b128 v[192:195], v15 offset:0
  ds_read_b128 v[196:199], v15 offset:10240
  ds_read_b128 v[200:203], v15 offset:20480
  ds_read_b128 v[204:207], v15 offset:30720
  ds_read_b128 v[208:211], v15 offset:2048
  ds_read_b128 v[212:215], v15 offset:12288
  ds_read_b128 v[216:219], v15 offset:22528
  ds_read_b128 v[220:223], v15 offset:32768
  ds_read_b128 v[224:227], v16 offset:0
  ds_read_b128 v[228:231], v16 offset:10240
  ds_read_b128 v[232:235], v16 offset:20480
  ds_read_b128 v[236:239], v16 offset:30720
  v_sub_f32 v25, 1.0, v24
  v_cvt_pk_bf16_f32 v26, v25, v25
  v_lshlrev_b32 v25, 16, v26
  s_waitcnt lgkmcnt(8)
  v_pk_add_f32 v[192:193], v[192:193], v[196:197]
  v_pk_add_f32 v[200:201], v[200:201], v[204:205]
  v_pk_add_f32 v[194:195], v[194:195], v[198:199]
  v_pk_add_f32 v[202:203], v[202:203], v[206:207]
  v_pk_add_f32 v[240:241], v[192:193], v[200:201]
  v_cvt_pk_bf16_f32 v26, v240, v241
  v_lshlrev_b32 v240, 16, v26
  v_and_b32 v241, 0xffff0000, v26
  v_mul_f32 v240, v240, v25
  v_mul_f32 v241, v241, v25
  v_cvt_pk_bf16_f32 v26, v240, v241
  v_lshlrev_b32 v240, 16, v26
  v_and_b32 v241, 0xffff0000, v26
  v_pk_add_f32 v[242:243], v[194:195], v[202:203]
  v_cvt_pk_bf16_f32 v26, v242, v243
  v_lshlrev_b32 v242, 16, v26
  v_and_b32 v243, 0xffff0000, v26
  v_mul_f32 v242, v242, v25
  v_mul_f32 v243, v243, v25
  v_cvt_pk_bf16_f32 v26, v242, v243
  v_lshlrev_b32 v242, 16, v26
  v_and_b32 v243, 0xffff0000, v26
  s_waitcnt lgkmcnt(4)
  v_pk_add_f32 v[208:209], v[208:209], v[212:213]
  v_pk_add_f32 v[216:217], v[216:217], v[220:221]
  v_pk_add_f32 v[210:211], v[210:211], v[214:215]
  v_pk_add_f32 v[218:219], v[218:219], v[222:223]
  v_pk_add_f32 v[244:245], v[208:209], v[216:217]
  v_cvt_pk_bf16_f32 v26, v244, v245
  v_lshlrev_b32 v244, 16, v26
  v_and_b32 v245, 0xffff0000, v26
  v_mul_f32 v244, v244, v25
  v_mul_f32 v245, v245, v25
  v_cvt_pk_bf16_f32 v26, v244, v245
  v_lshlrev_b32 v244, 16, v26
  v_and_b32 v245, 0xffff0000, v26
  v_pk_add_f32 v[246:247], v[210:211], v[218:219]
  v_cvt_pk_bf16_f32 v26, v246, v247
  v_lshlrev_b32 v246, 16, v26
  v_and_b32 v247, 0xffff0000, v26
  v_mul_f32 v246, v246, v25
  v_mul_f32 v247, v247, v25
  v_cvt_pk_bf16_f32 v26, v246, v247
  v_lshlrev_b32 v246, 16, v26
  v_and_b32 v247, 0xffff0000, v26
  s_waitcnt lgkmcnt(0)
  v_pk_add_f32 v[224:225], v[224:225], v[228:229]
  v_pk_add_f32 v[232:233], v[232:233], v[236:237]
  v_pk_add_f32 v[226:227], v[226:227], v[230:231]
  v_pk_add_f32 v[234:235], v[234:235], v[238:239]
  v_pk_add_f32 v[248:249], v[224:225], v[232:233]
  v_cvt_pk_bf16_f32 v26, v248, v249
  v_lshlrev_b32 v248, 16, v26
  v_and_b32 v249, 0xffff0000, v26
  v_mul_f32 v248, v248, v25
  v_mul_f32 v249, v249, v25
  v_cvt_pk_bf16_f32 v26, v248, v249
  v_lshlrev_b32 v248, 16, v26
  v_and_b32 v249, 0xffff0000, v26
  v_pk_add_f32 v[250:251], v[226:227], v[234:235]
  v_cvt_pk_bf16_f32 v26, v250, v251
  v_lshlrev_b32 v250, 16, v26
  v_and_b32 v251, 0xffff0000, v26
  v_mul_f32 v250, v250, v25
  v_mul_f32 v251, v251, v25
  v_cvt_pk_bf16_f32 v26, v250, v251
  v_lshlrev_b32 v250, 16, v26
  v_and_b32 v251, 0xffff0000, v26
  s_barrier
  s_branch pvg_255
pvw_251:
  v_mfma_f32_16x16x32_bf16 v[144:147], a[160:163], v[192:195], 0
  v_mfma_f32_16x16x32_bf16 v[148:151], a[160:163], v[212:215], 0
  v_mfma_f32_16x16x32_bf16 v[152:155], a[164:167], v[192:195], 0
  v_mfma_f32_16x16x32_bf16 v[156:159], a[164:167], v[212:215], 0
  v_mfma_f32_16x16x32_bf16 v[160:163], a[168:171], v[192:195], 0
  v_mfma_f32_16x16x32_bf16 v[164:167], a[168:171], v[212:215], 0
  v_mfma_f32_16x16x32_bf16 v[168:171], a[172:175], v[192:195], 0
  v_mfma_f32_16x16x32_bf16 v[172:175], a[172:175], v[212:215], 0
  v_mfma_f32_16x16x32_bf16 v[176:179], a[176:179], v[192:195], 0
  v_mfma_f32_16x16x32_bf16 v[180:183], a[176:179], v[212:215], 0
  v_mfma_f32_16x16x32_bf16 v[144:147], a[180:183], v[196:199], v[144:147]
  v_mfma_f32_16x16x32_bf16 v[148:151], a[180:183], v[216:219], v[148:151]
  v_mfma_f32_16x16x32_bf16 v[152:155], a[184:187], v[196:199], v[152:155]
  v_mfma_f32_16x16x32_bf16 v[156:159], a[184:187], v[216:219], v[156:159]
  v_mfma_f32_16x16x32_bf16 v[160:163], a[188:191], v[196:199], v[160:163]
  v_mfma_f32_16x16x32_bf16 v[164:167], a[188:191], v[216:219], v[164:167]
  v_mfma_f32_16x16x32_bf16 v[168:171], a[192:195], v[196:199], v[168:171]
  v_mfma_f32_16x16x32_bf16 v[172:175], a[192:195], v[216:219], v[172:175]
  v_mfma_f32_16x16x32_bf16 v[176:179], a[196:199], v[196:199], v[176:179]
  v_mfma_f32_16x16x32_bf16 v[180:183], a[196:199], v[216:219], v[180:183]
  v_mfma_f32_16x16x32_bf16 v[144:147], a[200:203], v[200:203], v[144:147]
  v_mfma_f32_16x16x32_bf16 v[148:151], a[200:203], v[220:223], v[148:151]
  v_mfma_f32_16x16x32_bf16 v[152:155], a[204:207], v[200:203], v[152:155]
  v_mfma_f32_16x16x32_bf16 v[156:159], a[204:207], v[220:223], v[156:159]
  v_mfma_f32_16x16x32_bf16 v[160:163], a[208:211], v[200:203], v[160:163]
  v_mfma_f32_16x16x32_bf16 v[164:167], a[208:211], v[220:223], v[164:167]
  v_mfma_f32_16x16x32_bf16 v[168:171], a[212:215], v[200:203], v[168:171]
  v_mfma_f32_16x16x32_bf16 v[172:175], a[212:215], v[220:223], v[172:175]
  v_mfma_f32_16x16x32_bf16 v[176:179], a[216:219], v[200:203], v[176:179]
  v_mfma_f32_16x16x32_bf16 v[180:183], a[216:219], v[220:223], v[180:183]
  v_mfma_f32_16x16x32_bf16 v[144:147], a[220:223], v[204:207], v[144:147]
  v_mfma_f32_16x16x32_bf16 v[148:151], a[220:223], v[224:227], v[148:151]
  v_mfma_f32_16x16x32_bf16 v[152:155], a[224:227], v[204:207], v[152:155]
  v_mfma_f32_16x16x32_bf16 v[156:159], a[224:227], v[224:227], v[156:159]
  v_mfma_f32_16x16x32_bf16 v[160:163], a[228:231], v[204:207], v[160:163]
  v_mfma_f32_16x16x32_bf16 v[164:167], a[228:231], v[224:227], v[164:167]
  v_mfma_f32_16x16x32_bf16 v[168:171], a[232:235], v[204:207], v[168:171]
  v_mfma_f32_16x16x32_bf16 v[172:175], a[232:235], v[224:227], v[172:175]
  v_mfma_f32_16x16x32_bf16 v[176:179], a[236:239], v[204:207], v[176:179]
  v_mfma_f32_16x16x32_bf16 v[180:183], a[236:239], v[224:227], v[180:183]
  v_mfma_f32_16x16x32_bf16 v[144:147], a[240:243], v[208:211], v[144:147]
  v_mfma_f32_16x16x32_bf16 v[148:151], a[240:243], v[228:231], v[148:151]
  v_mfma_f32_16x16x32_bf16 v[152:155], a[244:247], v[208:211], v[152:155]
  v_mfma_f32_16x16x32_bf16 v[156:159], a[244:247], v[228:231], v[156:159]
  v_mfma_f32_16x16x32_bf16 v[160:163], a[248:251], v[208:211], v[160:163]
  v_mfma_f32_16x16x32_bf16 v[164:167], a[248:251], v[228:231], v[164:167]
  v_mfma_f32_16x16x32_bf16 v[168:171], a[252:255], v[208:211], v[168:171]
  v_mfma_f32_16x16x32_bf16 v[172:175], a[252:255], v[228:231], v[172:175]
  v_mfma_f32_16x16x32_bf16 v[176:179], v[252:255], v[208:211], v[176:179]
  v_mfma_f32_16x16x32_bf16 v[180:183], v[252:255], v[228:231], v[180:183]
  ds_write_b128 v10, v[144:147] offset:40960
  ds_write_b128 v10, v[148:151] offset:41984
  ds_write_b128 v10, v[152:155] offset:43008
  ds_write_b128 v10, v[156:159] offset:44032
  ds_write_b128 v10, v[160:163] offset:45056
  ds_write_b128 v10, v[164:167] offset:46080
  ds_write_b128 v10, v[168:171] offset:47104
  ds_write_b128 v10, v[172:175] offset:48128
  s_nop 1
  ds_write_b128 v10, v[176:179] offset:49152
  ds_write_b128 v10, v[180:183] offset:50176
  s_waitcnt lgkmcnt(0)
  s_barrier
  ds_read_b128 v[192:195], v15 offset:0
  ds_read_b128 v[196:199], v15 offset:10240
  ds_read_b128 v[200:203], v15 offset:20480
  ds_read_b128 v[204:207], v15 offset:30720
  ds_read_b128 v[208:211], v15 offset:2048
  ds_read_b128 v[212:215], v15 offset:12288
  ds_read_b128 v[216:219], v15 offset:22528
  ds_read_b128 v[220:223], v15 offset:32768
  ds_read_b128 v[224:227], v16 offset:0
  ds_read_b128 v[228:231], v16 offset:10240
  ds_read_b128 v[232:235], v16 offset:20480
  ds_read_b128 v[236:239], v16 offset:30720
  v_sub_f32 v25, 1.0, v24
  v_cvt_pk_bf16_f32 v26, v25, v25
  v_lshlrev_b32 v25, 16, v26
  s_waitcnt lgkmcnt(8)
  v_pk_add_f32 v[192:193], v[192:193], v[196:197]
  v_pk_add_f32 v[200:201], v[200:201], v[204:205]
  v_pk_add_f32 v[194:195], v[194:195], v[198:199]
  v_pk_add_f32 v[202:203], v[202:203], v[206:207]
  v_pk_add_f32 v[240:241], v[192:193], v[200:201]
  v_cvt_pk_bf16_f32 v26, v240, v241
  v_lshlrev_b32 v240, 16, v26
  v_and_b32 v241, 0xffff0000, v26
  v_mul_f32 v240, v240, v25
  v_mul_f32 v241, v241, v25
  v_cvt_pk_bf16_f32 v26, v240, v241
  v_lshlrev_b32 v240, 16, v26
  v_and_b32 v241, 0xffff0000, v26
  v_pk_add_f32 v[242:243], v[194:195], v[202:203]
  v_cvt_pk_bf16_f32 v26, v242, v243
  v_lshlrev_b32 v242, 16, v26
  v_and_b32 v243, 0xffff0000, v26
  v_mul_f32 v242, v242, v25
  v_mul_f32 v243, v243, v25
  v_cvt_pk_bf16_f32 v26, v242, v243
  v_lshlrev_b32 v242, 16, v26
  v_and_b32 v243, 0xffff0000, v26
  s_waitcnt lgkmcnt(4)
  v_pk_add_f32 v[208:209], v[208:209], v[212:213]
  v_pk_add_f32 v[216:217], v[216:217], v[220:221]
  v_pk_add_f32 v[210:211], v[210:211], v[214:215]
  v_pk_add_f32 v[218:219], v[218:219], v[222:223]
  v_pk_add_f32 v[244:245], v[208:209], v[216:217]
  v_cvt_pk_bf16_f32 v26, v244, v245
  v_lshlrev_b32 v244, 16, v26
  v_and_b32 v245, 0xffff0000, v26
  v_mul_f32 v244, v244, v25
  v_mul_f32 v245, v245, v25
  v_cvt_pk_bf16_f32 v26, v244, v245
  v_lshlrev_b32 v244, 16, v26
  v_and_b32 v245, 0xffff0000, v26
  v_pk_add_f32 v[246:247], v[210:211], v[218:219]
  v_cvt_pk_bf16_f32 v26, v246, v247
  v_lshlrev_b32 v246, 16, v26
  v_and_b32 v247, 0xffff0000, v26
  v_mul_f32 v246, v246, v25
  v_mul_f32 v247, v247, v25
  v_cvt_pk_bf16_f32 v26, v246, v247
  v_lshlrev_b32 v246, 16, v26
  v_and_b32 v247, 0xffff0000, v26
  s_waitcnt lgkmcnt(0)
  v_pk_add_f32 v[224:225], v[224:225], v[228:229]
  v_pk_add_f32 v[232:233], v[232:233], v[236:237]
  v_pk_add_f32 v[226:227], v[226:227], v[230:231]
  v_pk_add_f32 v[234:235], v[234:235], v[238:239]
  v_pk_add_f32 v[248:249], v[224:225], v[232:233]
  v_cvt_pk_bf16_f32 v26, v248, v249
  v_lshlrev_b32 v248, 16, v26
  v_and_b32 v249, 0xffff0000, v26
  v_mul_f32 v248, v248, v25
  v_mul_f32 v249, v249, v25
  v_cvt_pk_bf16_f32 v26, v248, v249
  v_lshlrev_b32 v248, 16, v26
  v_and_b32 v249, 0xffff0000, v26
  v_pk_add_f32 v[250:251], v[226:227], v[234:235]
  v_cvt_pk_bf16_f32 v26, v250, v251
  v_lshlrev_b32 v250, 16, v26
  v_and_b32 v251, 0xffff0000, v26
  v_mul_f32 v250, v250, v25
  v_mul_f32 v251, v251, v25
  v_cvt_pk_bf16_f32 v26, v250, v251
  v_lshlrev_b32 v250, 16, v26
  v_and_b32 v251, 0xffff0000, v26
  s_cmp_ge_u32 s40, 56
  s_cbranch_scc1 pvt_256
  s_cmp_lg_u32 s20, 0
  s_cbranch_scc1 wr_258
  s_mov_b32 s101, 0
wr_257:
  buffer_load_dword v26, v18, s[72:75], 0 offen sc1
  s_add_u32 s101, s101, 1
  s_cmp_gt_u32 s101, 131072
  s_cbranch_scc1 main_end
  s_waitcnt vmcnt(0)
  v_cmp_gt_u32 vcc, v19, v26
  v_readfirstlane_b32 s100, v26
  s_nop 0
  s_cbranch_vccz wr_258
  s_sleep 2
  s_cmp_lg_u32 s100, 0
  s_cbranch_scc1 wr_257
  s_sleep 24
  s_branch wr_257
wr_258:
  s_barrier
  buffer_load_dwordx4 v[64:67], v4, s[16:19], s47 offen sc1
  buffer_load_dwordx2 v[68:69], v5, s[16:19], s47 offen offset:2048 sc1
  buffer_load_dwordx4 v[128:131], v21, s[16:19], s47 offen offset:1024 sc1
  s_add_u32 s47, s47, 2560
  buffer_load_dwordx4 v[72:75], v4, s[16:19], s47 offen sc1
  buffer_load_dwordx2 v[76:77], v5, s[16:19], s47 offen offset:2048 sc1
  s_add_u32 s47, s47, 13824
  buffer_load_dwordx4 v[80:83], v4, s[16:19], s47 offen sc1
  buffer_load_dwordx2 v[84:85], v5, s[16:19], s47 offen offset:2048 sc1
  buffer_load_dwordx4 v[132:135], v21, s[16:19], s47 offen offset:1024 sc1
  s_add_u32 s47, s47, 2560
  buffer_load_dwordx4 v[88:91], v4, s[16:19], s47 offen sc1
  buffer_load_dwordx2 v[92:93], v5, s[16:19], s47 offen offset:2048 sc1
  s_add_u32 s47, s47, 13824
  s_add_u32 s21, s48, 16384
  buffer_load_dwordx4 v[32:35], v22, s[16:19], s48 offen offset:0 sc1
  buffer_load_dwordx4 v[40:43], v22, s[16:19], s21 offen offset:0 sc1
  buffer_load_dwordx2 v[184:185], v14, s[16:19], s48 offen offset:512 sc1
  buffer_load_dwordx4 v[36:39], v22, s[16:19], s48 offen offset:1280 sc1
  buffer_load_dwordx4 v[44:47], v22, s[16:19], s21 offen offset:1280 sc1
  buffer_load_dwordx2 v[186:187], v14, s[16:19], s48 offen offset:1792 sc1
  s_add_u32 s48, s48, 262144
  s_waitcnt vmcnt(40)
  buffer_load_dwordx4 v[96:99], v4, s[16:19], s47 offen sc1
  buffer_load_dwordx2 v[100:101], v5, s[16:19], s47 offen offset:2048 sc1
  buffer_load_dwordx4 v[136:139], v21, s[16:19], s47 offen offset:1024 sc1
  s_add_u32 s47, s47, 2560
  buffer_load_dwordx4 v[104:107], v4, s[16:19], s47 offen sc1
  buffer_load_dwordx2 v[108:109], v5, s[16:19], s47 offen offset:2048 sc1
  s_add_u32 s47, s47, 13824
  buffer_load_dwordx4 v[112:115], v4, s[16:19], s47 offen sc1
  buffer_load_dwordx2 v[116:117], v5, s[16:19], s47 offen offset:2048 sc1
  buffer_load_dwordx4 v[140:143], v21, s[16:19], s47 offen offset:1024 sc1
  s_add_u32 s47, s47, 2560
  buffer_load_dwordx4 v[120:123], v4, s[16:19], s47 offen sc1
  buffer_load_dwordx2 v[124:125], v5, s[16:19], s47 offen offset:2048 sc1
  s_add_u32 s47, s47, 13824
  s_add_u32 s21, s48, 16384
  buffer_load_dwordx4 v[48:51], v22, s[16:19], s48 offen offset:0 sc1
  buffer_load_dwordx4 v[56:59], v22, s[16:19], s21 offen offset:0 sc1
  buffer_load_dwordx2 v[188:189], v14, s[16:19], s48 offen offset:512 sc1
  buffer_load_dwordx4 v[52:55], v22, s[16:19], s48 offen offset:1280 sc1
  buffer_load_dwordx4 v[60:63], v22, s[16:19], s21 offen offset:1280 sc1
  buffer_load_dwordx2 v[190:191], v14, s[16:19], s48 offen offset:1792 sc1
  s_add_u32 s48, s48, 262144
pvg_255:
  s_waitcnt vmcnt(30)
  v_mfma_f32_16x16x32_bf16 v[148:151], a[0:3], v[64:67], 0
  v_mfma_f32_16x16x32_bf16 v[144:147], a[0:3], v[68:71], 0
  v_mfma_f32_16x16x32_bf16 v[156:159], a[4:7], v[64:67], 0
  v_mfma_f32_16x16x32_bf16 v[152:155], a[4:7], v[68:71], 0
  v_mfma_f32_16x16x32_bf16 v[164:167], a[8:11], v[64:67], 0
  v_mfma_f32_16x16x32_bf16 v[160:163], a[8:11], v[68:71], 0
  v_mfma_f32_16x16x32_bf16 v[172:175], a[12:15], v[64:67], 0
  v_mfma_f32_16x16x32_bf16 v[168:171], a[12:15], v[68:71], 0
  v_mfma_f32_16x16x32_bf16 v[180:183], a[16:19], v[64:67], 0
  v_mfma_f32_16x16x32_bf16 v[176:179], a[16:19], v[68:71], 0
  s_waitcnt vmcnt(27)
  v_mfma_f32_16x16x32_bf16 v[148:151], a[20:23], v[72:75], v[148:151]
  v_mfma_f32_16x16x32_bf16 v[144:147], a[20:23], v[76:79], v[144:147]
  v_mfma_f32_16x16x32_bf16 v[156:159], a[24:27], v[72:75], v[156:159]
  v_mfma_f32_16x16x32_bf16 v[152:155], a[24:27], v[76:79], v[152:155]
  v_mfma_f32_16x16x32_bf16 v[164:167], a[28:31], v[72:75], v[164:167]
  v_mfma_f32_16x16x32_bf16 v[160:163], a[28:31], v[76:79], v[160:163]
  v_mfma_f32_16x16x32_bf16 v[172:175], a[32:35], v[72:75], v[172:175]
  v_mfma_f32_16x16x32_bf16 v[168:171], a[32:35], v[76:79], v[168:171]
  v_mfma_f32_16x16x32_bf16 v[180:183], a[36:39], v[72:75], v[180:183]
  v_mfma_f32_16x16x32_bf16 v[176:179], a[36:39], v[76:79], v[176:179]
  s_waitcnt vmcnt(25)
  v_mfma_f32_16x16x32_bf16 v[148:151], a[40:43], v[80:83], v[148:151]
  v_mfma_f32_16x16x32_bf16 v[144:147], a[40:43], v[84:87], v[144:147]
  v_mfma_f32_16x16x32_bf16 v[156:159], a[44:47], v[80:83], v[156:159]
  v_mfma_f32_16x16x32_bf16 v[152:155], a[44:47], v[84:87], v[152:155]
  v_mfma_f32_16x16x32_bf16 v[164:167], a[48:51], v[80:83], v[164:167]
  v_mfma_f32_16x16x32_bf16 v[160:163], a[48:51], v[84:87], v[160:163]
  v_mfma_f32_16x16x32_bf16 v[172:175], a[52:55], v[80:83], v[172:175]
  v_mfma_f32_16x16x32_bf16 v[168:171], a[52:55], v[84:87], v[168:171]
  v_mfma_f32_16x16x32_bf16 v[180:183], a[56:59], v[80:83], v[180:183]
  v_mfma_f32_16x16x32_bf16 v[176:179], a[56:59], v[84:87], v[176:179]
  s_waitcnt vmcnt(22)
  v_mfma_f32_16x16x32_bf16 v[148:151], a[60:63], v[88:91], v[148:151]
  v_mfma_f32_16x16x32_bf16 v[144:147], a[60:63], v[92:95], v[144:147]
  v_mfma_f32_16x16x32_bf16 v[156:159], a[64:67], v[88:91], v[156:159]
  v_mfma_f32_16x16x32_bf16 v[152:155], a[64:67], v[92:95], v[152:155]
  v_mfma_f32_16x16x32_bf16 v[164:167], a[68:71], v[88:91], v[164:167]
  v_mfma_f32_16x16x32_bf16 v[160:163], a[68:71], v[92:95], v[160:163]
  v_mfma_f32_16x16x32_bf16 v[172:175], a[72:75], v[88:91], v[172:175]
  v_mfma_f32_16x16x32_bf16 v[168:171], a[72:75], v[92:95], v[168:171]
  v_mfma_f32_16x16x32_bf16 v[180:183], a[76:79], v[88:91], v[180:183]
  v_mfma_f32_16x16x32_bf16 v[176:179], a[76:79], v[92:95], v[176:179]
  s_waitcnt vmcnt(16)
  v_swap_b32 v130, v132
  v_swap_b32 v131, v133
  v_swap_b32 v34, v36
  v_swap_b32 v35, v37
  v_swap_b32 v42, v44
  v_swap_b32 v43, v45
  s_nop 1
  v_mfma_f32_16x16x32_bf16 v[144:147], v[32:35], v[128:131], v[144:147]
  v_mfma_f32_16x16x32_bf16 v[148:151], v[32:35], v[132:135], v[148:151]
  v_mfma_f32_16x16x32_bf16 v[152:155], v[36:39], v[128:131], v[152:155]
  v_mfma_f32_16x16x32_bf16 v[156:159], v[36:39], v[132:135], v[156:159]
  v_mfma_f32_16x16x32_bf16 v[160:163], v[184:187], v[128:131], v[160:163]
  v_mfma_f32_16x16x32_bf16 v[164:167], v[184:187], v[132:135], v[164:167]
  v_mfma_f32_16x16x32_bf16 v[168:171], v[40:43], v[128:131], v[168:171]
  v_mfma_f32_16x16x32_bf16 v[172:175], v[40:43], v[132:135], v[172:175]
  v_mfma_f32_16x16x32_bf16 v[176:179], v[44:47], v[128:131], v[176:179]
  v_mfma_f32_16x16x32_bf16 v[180:183], v[44:47], v[132:135], v[180:183]
  s_waitcnt vmcnt(14)
  v_mfma_f32_16x16x32_bf16 v[148:151], a[80:83], v[96:99], v[148:151]
  v_mfma_f32_16x16x32_bf16 v[144:147], a[80:83], v[100:103], v[144:147]
  v_mfma_f32_16x16x32_bf16 v[156:159], a[84:87], v[96:99], v[156:159]
  v_mfma_f32_16x16x32_bf16 v[152:155], a[84:87], v[100:103], v[152:155]
  v_mfma_f32_16x16x32_bf16 v[164:167], a[88:91], v[96:99], v[164:167]
  v_mfma_f32_16x16x32_bf16 v[160:163], a[88:91], v[100:103], v[160:163]
  v_mfma_f32_16x16x32_bf16 v[172:175], a[92:95], v[96:99], v[172:175]
  v_mfma_f32_16x16x32_bf16 v[168:171], a[92:95], v[100:103], v[168:171]
  v_mfma_f32_16x16x32_bf16 v[180:183], a[96:99], v[96:99], v[180:183]
  v_mfma_f32_16x16x32_bf16 v[176:179], a[96:99], v[100:103], v[176:179]
  s_waitcnt vmcnt(11)
  v_mfma_f32_16x16x32_bf16 v[148:151], a[100:103], v[104:107], v[148:151]
  v_mfma_f32_16x16x32_bf16 v[144:147], a[100:103], v[108:111], v[144:147]
  v_mfma_f32_16x16x32_bf16 v[156:159], a[104:107], v[104:107], v[156:159]
  v_mfma_f32_16x16x32_bf16 v[152:155], a[104:107], v[108:111], v[152:155]
  v_mfma_f32_16x16x32_bf16 v[164:167], a[108:111], v[104:107], v[164:167]
  v_mfma_f32_16x16x32_bf16 v[160:163], a[108:111], v[108:111], v[160:163]
  v_mfma_f32_16x16x32_bf16 v[172:175], a[112:115], v[104:107], v[172:175]
  v_mfma_f32_16x16x32_bf16 v[168:171], a[112:115], v[108:111], v[168:171]
  v_mfma_f32_16x16x32_bf16 v[180:183], a[116:119], v[104:107], v[180:183]
  v_mfma_f32_16x16x32_bf16 v[176:179], a[116:119], v[108:111], v[176:179]
  s_waitcnt vmcnt(9)
  v_mfma_f32_16x16x32_bf16 v[148:151], a[120:123], v[112:115], v[148:151]
  v_mfma_f32_16x16x32_bf16 v[144:147], a[120:123], v[116:119], v[144:147]
  v_mfma_f32_16x16x32_bf16 v[156:159], a[124:127], v[112:115], v[156:159]
  v_mfma_f32_16x16x32_bf16 v[152:155], a[124:127], v[116:119], v[152:155]
  v_mfma_f32_16x16x32_bf16 v[164:167], a[128:131], v[112:115], v[164:167]
  v_mfma_f32_16x16x32_bf16 v[160:163], a[128:131], v[116:119], v[160:163]
  v_mfma_f32_16x16x32_bf16 v[172:175], a[132:135], v[112:115], v[172:175]
  v_mfma_f32_16x16x32_bf16 v[168:171], a[132:135], v[116:119], v[168:171]
  v_mfma_f32_16x16x32_bf16 v[180:183], a[136:139], v[112:115], v[180:183]
  v_mfma_f32_16x16x32_bf16 v[176:179], a[136:139], v[116:119], v[176:179]
  s_waitcnt vmcnt(6)
  v_mfma_f32_16x16x32_bf16 v[148:151], a[140:143], v[120:123], v[148:151]
  v_mfma_f32_16x16x32_bf16 v[144:147], a[140:143], v[124:127], v[144:147]
  v_mfma_f32_16x16x32_bf16 v[156:159], a[144:147], v[120:123], v[156:159]
  v_mfma_f32_16x16x32_bf16 v[152:155], a[144:147], v[124:127], v[152:155]
  v_mfma_f32_16x16x32_bf16 v[164:167], a[148:151], v[120:123], v[164:167]
  v_mfma_f32_16x16x32_bf16 v[160:163], a[148:151], v[124:127], v[160:163]
  v_mfma_f32_16x16x32_bf16 v[172:175], a[152:155], v[120:123], v[172:175]
  v_mfma_f32_16x16x32_bf16 v[168:171], a[152:155], v[124:127], v[168:171]
  v_mfma_f32_16x16x32_bf16 v[180:183], a[156:159], v[120:123], v[180:183]
  v_mfma_f32_16x16x32_bf16 v[176:179], a[156:159], v[124:127], v[176:179]
  s_waitcnt vmcnt(0)
  v_swap_b32 v138, v140
  v_swap_b32 v139, v141
  v_swap_b32 v50, v52
  v_swap_b32 v51, v53
  v_swap_b32 v58, v60
  v_swap_b32 v59, v61
  s_nop 1
  v_mfma_f32_16x16x32_bf16 v[144:147], v[48:51], v[136:139], v[144:147]
  v_mfma_f32_16x16x32_bf16 v[148:151], v[48:51], v[140:143], v[148:151]
  v_mfma_f32_16x16x32_bf16 v[152:155], v[52:55], v[136:139], v[152:155]
  v_mfma_f32_16x16x32_bf16 v[156:159], v[52:55], v[140:143], v[156:159]
  v_mfma_f32_16x16x32_bf16 v[160:163], v[188:191], v[136:139], v[160:163]
  v_mfma_f32_16x16x32_bf16 v[164:167], v[188:191], v[140:143], v[164:167]
  v_mfma_f32_16x16x32_bf16 v[168:171], v[56:59], v[136:139], v[168:171]
  v_mfma_f32_16x16x32_bf16 v[172:175], v[56:59], v[140:143], v[172:175]
  v_mfma_f32_16x16x32_bf16 v[176:179], v[60:63], v[136:139], v[176:179]
  v_mfma_f32_16x16x32_bf16 v[180:183], v[60:63], v[140:143], v[180:183]
  s_branch pve_252
pvt_256:
  s_min_u32 s21, s40, 62
  v_mov_b32 v19, s21
  v_add_u32 v18, s52, v17
  s_cmp_lg_u32 s20, 0
  s_cbranch_scc1 wr_260
  s_mov_b32 s101, 0
wr_259:
  buffer_load_dword v26, v18, s[72:75], 0 offen sc1
  s_add_u32 s101, s101, 1
  s_cmp_gt_u32 s101, 131072
  s_cbranch_scc1 main_end
  s_waitcnt vmcnt(0)
  v_cmp_gt_u32 vcc, v19, v26
  v_readfirstlane_b32 s100, v26
  s_nop 0
  s_cbranch_vccz wr_260
  s_sleep 6
  s_cmp_lg_u32 s100, 0
  s_cbranch_scc1 wr_259
  s_sleep 0
  s_branch wr_259
wr_260:
  s_barrier
  s_mov_b32 s57, s48
  s_add_u32 s21, s57, 16384
  buffer_load_dwordx4 v[32:35], v22, s[16:19], s57 offen offset:0 sc1
  buffer_load_dwordx4 v[40:43], v22, s[16:19], s21 offen offset:0 sc1
  buffer_load_dwordx2 v[184:185], v14, s[16:19], s57 offen offset:512 sc1
  buffer_load_dwordx4 v[36:39], v22, s[16:19], s57 offen offset:1280 sc1
  buffer_load_dwordx4 v[44:47], v22, s[16:19], s21 offen offset:1280 sc1
  buffer_load_dwordx2 v[186:187], v14, s[16:19], s57 offen offset:1792 sc1
  s_add_u32 s57, s57, 262144
  s_add_u32 s21, s57, 16384
  buffer_load_dwordx4 v[48:51], v22, s[16:19], s57 offen offset:0 sc1
  buffer_load_dwordx4 v[56:59], v22, s[16:19], s21 offen offset:0 sc1
  buffer_load_dwordx2 v[188:189], v14, s[16:19], s57 offen offset:512 sc1
  buffer_load_dwordx4 v[52:55], v22, s[16:19], s57 offen offset:1280 sc1
  buffer_load_dwordx4 v[60:63], v22, s[16:19], s21 offen offset:1280 sc1
  buffer_load_dwordx2 v[190:191], v14, s[16:19], s57 offen offset:1792 sc1
  s_add_u32 s57, s57, 262144
  s_mov_b32 s101, 0
  s_waitcnt vmcnt(0)
  s_branch pvr_262
pvr_261:
  s_sleep 6
  s_mov_b32 s57, s48
  s_add_u32 s21, s57, 16384
  buffer_load_dwordx4 v[32:35], v22, s[16:19], s57 offen offset:0 sc1
  buffer_load_dwordx4 v[40:43], v22, s[16:19], s21 offen offset:0 sc1
  buffer_load_dwordx2 v[184:185], v14, s[16:19], s57 offen offset:512 sc1
  buffer_load_dwordx4 v[36:39], v22, s[16:19], s57 offen offset:1280 sc1
  buffer_load_dwordx4 v[44:47], v22, s[16:19], s21 offen offset:1280 sc1
  buffer_load_dwordx2 v[186:187], v14, s[16:19], s57 offen offset:1792 sc1
  s_add_u32 s57, s57, 262144
  s_add_u32 s21, s57, 16384
  buffer_load_dwordx4 v[48:51], v22, s[16:19], s57 offen offset:0 sc1
  buffer_load_dwordx4 v[56:59], v22, s[16:19], s21 offen offset:0 sc1
  buffer_load_dwordx2 v[188:189], v14, s[16:19], s57 offen offset:512 sc1
  buffer_load_dwordx4 v[52:55], v22, s[16:19], s57 offen offset:1280 sc1
  buffer_load_dwordx4 v[60:63], v22, s[16:19], s21 offen offset:1280 sc1
  buffer_load_dwordx2 v[190:191], v14, s[16:19], s57 offen offset:1792 sc1
  s_add_u32 s57, s57, 262144
  s_add_u32 s101, s101, 1
  s_cmp_gt_u32 s101, 131072
  s_cbranch_scc1 main_end
  s_waitcnt vmcnt(0)
pvr_262:
  v_max3_u32 v26, v32, v36, v40
  v_max3_u32 v26, v26, v44, v184
  v_max3_u32 v26, v26, v186, v48
  v_max3_u32 v26, v26, v52, v56
  v_max3_u32 v26, v26, v60, v188
  v_max3_u32 v26, v26, v190, v190
  v_cmp_eq_u32 vcc, -1, v26
  s_nop 1
  s_cbranch_vccnz pvr_261
  s_add_u32 s56, s47, 0
  buffer_load_dwordx4 v[64:67], v4, s[16:19], s56 offen sc1
  buffer_load_dwordx2 v[68:69], v5, s[16:19], s56 offen offset:2048 sc1
  buffer_load_dwordx4 v[128:131], v21, s[16:19], s56 offen offset:1024 sc1
  s_add_u32 s56, s56, 2560
  buffer_load_dwordx4 v[72:75], v4, s[16:19], s56 offen sc1
  buffer_load_dwordx2 v[76:77], v5, s[16:19], s56 offen offset:2048 sc1
  s_add_u32 s56, s56, 13824
  buffer_load_dwordx4 v[80:83], v4, s[16:19], s56 offen sc1
  buffer_load_dwordx2 v[84:85], v5, s[16:19], s56 offen offset:2048 sc1
  buffer_load_dwordx4 v[132:135], v21, s[16:19], s56 offen offset:1024 sc1
  s_add_u32 s56, s56, 2560
  buffer_load_dwordx4 v[88:91], v4, s[16:19], s56 offen sc1
  buffer_load_dwordx2 v[92:93], v5, s[16:19], s56 offen offset:2048 sc1
  s_add_u32 s56, s56, 13824
  s_mov_b32 s101, 0
  s_waitcnt vmcnt(0)
  s_branch pvr_264
pvr_263:
  s_sleep 2
  s_add_u32 s56, s47, 0
  buffer_load_dwordx4 v[64:67], v4, s[16:19], s56 offen sc1
  buffer_load_dwordx2 v[68:69], v5, s[16:19], s56 offen offset:2048 sc1
  buffer_load_dwordx4 v[128:131], v21, s[16:19], s56 offen offset:1024 sc1
  s_add_u32 s56, s56, 2560
  buffer_load_dwordx4 v[72:75], v4, s[16:19], s56 offen sc1
  buffer_load_dwordx2 v[76:77], v5, s[16:19], s56 offen offset:2048 sc1
  s_add_u32 s56, s56, 13824
  buffer_load_dwordx4 v[80:83], v4, s[16:19], s56 offen sc1
  buffer_load_dwordx2 v[84:85], v5, s[16:19], s56 offen offset:2048 sc1
  buffer_load_dwordx4 v[132:135], v21, s[16:19], s56 offen offset:1024 sc1
  s_add_u32 s56, s56, 2560
  buffer_load_dwordx4 v[88:91], v4, s[16:19], s56 offen sc1
  buffer_load_dwordx2 v[92:93], v5, s[16:19], s56 offen offset:2048 sc1
  s_add_u32 s56, s56, 13824
  s_add_u32 s101, s101, 1
  s_cmp_gt_u32 s101, 131072
  s_cbranch_scc1 main_end
  s_waitcnt vmcnt(0)
pvr_264:
  v_max3_u32 v26, v64, v68, v72
  v_max3_u32 v26, v26, v76, v80
  v_max3_u32 v26, v26, v84, v88
  v_max3_u32 v26, v26, v92, v128
  v_max3_u32 v26, v26, v132, v132
  v_cmp_eq_u32 vcc, -1, v26
  s_nop 1
  s_cbranch_vccnz pvr_263
  s_add_u32 s56, s47, 32768
  buffer_load_dwordx4 v[96:99], v4, s[16:19], s56 offen sc1
  buffer_load_dwordx2 v[100:101], v5, s[16:19], s56 offen offset:2048 sc1
  buffer_load_dwordx4 v[136:139], v21, s[16:19], s56 offen offset:1024 sc1
  s_add_u32 s56, s56, 2560
  buffer_load_dwordx4 v[104:107], v4, s[16:19], s56 offen sc1
  buffer_load_dwordx2 v[108:109], v5, s[16:19], s56 offen offset:2048 sc1
  s_add_u32 s56, s56, 13824
  buffer_load_dwordx4 v[112:115], v4, s[16:19], s56 offen sc1
  buffer_load_dwordx2 v[116:117], v5, s[16:19], s56 offen offset:2048 sc1
  buffer_load_dwordx4 v[140:143], v21, s[16:19], s56 offen offset:1024 sc1
  s_add_u32 s56, s56, 2560
  buffer_load_dwordx4 v[120:123], v4, s[16:19], s56 offen sc1
  buffer_load_dwordx2 v[124:125], v5, s[16:19], s56 offen offset:2048 sc1
  s_add_u32 s56, s56, 13824
  v_mfma_f32_16x16x32_bf16 v[148:151], a[0:3], v[64:67], 0
  v_mfma_f32_16x16x32_bf16 v[144:147], a[0:3], v[68:71], 0
  v_mfma_f32_16x16x32_bf16 v[156:159], a[4:7], v[64:67], 0
  v_mfma_f32_16x16x32_bf16 v[152:155], a[4:7], v[68:71], 0
  v_mfma_f32_16x16x32_bf16 v[164:167], a[8:11], v[64:67], 0
  v_mfma_f32_16x16x32_bf16 v[160:163], a[8:11], v[68:71], 0
  v_mfma_f32_16x16x32_bf16 v[172:175], a[12:15], v[64:67], 0
  v_mfma_f32_16x16x32_bf16 v[168:171], a[12:15], v[68:71], 0
  v_mfma_f32_16x16x32_bf16 v[180:183], a[16:19], v[64:67], 0
  v_mfma_f32_16x16x32_bf16 v[176:179], a[16:19], v[68:71], 0
  v_mfma_f32_16x16x32_bf16 v[148:151], a[20:23], v[72:75], v[148:151]
  v_mfma_f32_16x16x32_bf16 v[144:147], a[20:23], v[76:79], v[144:147]
  v_mfma_f32_16x16x32_bf16 v[156:159], a[24:27], v[72:75], v[156:159]
  v_mfma_f32_16x16x32_bf16 v[152:155], a[24:27], v[76:79], v[152:155]
  v_mfma_f32_16x16x32_bf16 v[164:167], a[28:31], v[72:75], v[164:167]
  v_mfma_f32_16x16x32_bf16 v[160:163], a[28:31], v[76:79], v[160:163]
  v_mfma_f32_16x16x32_bf16 v[172:175], a[32:35], v[72:75], v[172:175]
  v_mfma_f32_16x16x32_bf16 v[168:171], a[32:35], v[76:79], v[168:171]
  v_mfma_f32_16x16x32_bf16 v[180:183], a[36:39], v[72:75], v[180:183]
  v_mfma_f32_16x16x32_bf16 v[176:179], a[36:39], v[76:79], v[176:179]
  v_mfma_f32_16x16x32_bf16 v[148:151], a[40:43], v[80:83], v[148:151]
  v_mfma_f32_16x16x32_bf16 v[144:147], a[40:43], v[84:87], v[144:147]
  v_mfma_f32_16x16x32_bf16 v[156:159], a[44:47], v[80:83], v[156:159]
  v_mfma_f32_16x16x32_bf16 v[152:155], a[44:47], v[84:87], v[152:155]
  v_mfma_f32_16x16x32_bf16 v[164:167], a[48:51], v[80:83], v[164:167]
  v_mfma_f32_16x16x32_bf16 v[160:163], a[48:51], v[84:87], v[160:163]
  v_mfma_f32_16x16x32_bf16 v[172:175], a[52:55], v[80:83], v[172:175]
  v_mfma_f32_16x16x32_bf16 v[168:171], a[52:55], v[84:87], v[168:171]
  v_mfma_f32_16x16x32_bf16 v[180:183], a[56:59], v[80:83], v[180:183]
  v_mfma_f32_16x16x32_bf16 v[176:179], a[56:59], v[84:87], v[176:179]
  v_mfma_f32_16x16x32_bf16 v[148:151], a[60:63], v[88:91], v[148:151]
  v_mfma_f32_16x16x32_bf16 v[144:147], a[60:63], v[92:95], v[144:147]
  v_mfma_f32_16x16x32_bf16 v[156:159], a[64:67], v[88:91], v[156:159]
  v_mfma_f32_16x16x32_bf16 v[152:155], a[64:67], v[92:95], v[152:155]
  v_mfma_f32_16x16x32_bf16 v[164:167], a[68:71], v[88:91], v[164:167]
  v_mfma_f32_16x16x32_bf16 v[160:163], a[68:71], v[92:95], v[160:163]
  v_mfma_f32_16x16x32_bf16 v[172:175], a[72:75], v[88:91], v[172:175]
  v_mfma_f32_16x16x32_bf16 v[168:171], a[72:75], v[92:95], v[168:171]
  v_mfma_f32_16x16x32_bf16 v[180:183], a[76:79], v[88:91], v[180:183]
  v_mfma_f32_16x16x32_bf16 v[176:179], a[76:79], v[92:95], v[176:179]
  v_swap_b32 v130, v132
  v_swap_b32 v131, v133
  v_swap_b32 v34, v36
  v_swap_b32 v35, v37
  v_swap_b32 v42, v44
  v_swap_b32 v43, v45
  s_nop 1
  v_mfma_f32_16x16x32_bf16 v[144:147], v[32:35], v[128:131], v[144:147]
  v_mfma_f32_16x16x32_bf16 v[148:151], v[32:35], v[132:135], v[148:151]
  v_mfma_f32_16x16x32_bf16 v[152:155], v[36:39], v[128:131], v[152:155]
  v_mfma_f32_16x16x32_bf16 v[156:159], v[36:39], v[132:135], v[156:159]
  v_mfma_f32_16x16x32_bf16 v[160:163], v[184:187], v[128:131], v[160:163]
  v_mfma_f32_16x16x32_bf16 v[164:167], v[184:187], v[132:135], v[164:167]
  v_mfma_f32_16x16x32_bf16 v[168:171], v[40:43], v[128:131], v[168:171]
  v_mfma_f32_16x16x32_bf16 v[172:175], v[40:43], v[132:135], v[172:175]
  v_mfma_f32_16x16x32_bf16 v[176:179], v[44:47], v[128:131], v[176:179]
  v_mfma_f32_16x16x32_bf16 v[180:183], v[44:47], v[132:135], v[180:183]
  s_mov_b32 s101, 0
  s_waitcnt vmcnt(0)
  s_branch pvr_266
pvr_265:
  s_sleep 1
  s_add_u32 s56, s47, 32768
  buffer_load_dwordx4 v[96:99], v4, s[16:19], s56 offen sc1
  buffer_load_dwordx2 v[100:101], v5, s[16:19], s56 offen offset:2048 sc1
  buffer_load_dwordx4 v[136:139], v21, s[16:19], s56 offen offset:1024 sc1
  s_add_u32 s56, s56, 2560
  buffer_load_dwordx4 v[104:107], v4, s[16:19], s56 offen sc1
  buffer_load_dwordx2 v[108:109], v5, s[16:19], s56 offen offset:2048 sc1
  s_add_u32 s56, s56, 13824
  buffer_load_dwordx4 v[112:115], v4, s[16:19], s56 offen sc1
  buffer_load_dwordx2 v[116:117], v5, s[16:19], s56 offen offset:2048 sc1
  buffer_load_dwordx4 v[140:143], v21, s[16:19], s56 offen offset:1024 sc1
  s_add_u32 s56, s56, 2560
  buffer_load_dwordx4 v[120:123], v4, s[16:19], s56 offen sc1
  buffer_load_dwordx2 v[124:125], v5, s[16:19], s56 offen offset:2048 sc1
  s_add_u32 s56, s56, 13824
  s_add_u32 s101, s101, 1
  s_cmp_gt_u32 s101, 131072
  s_cbranch_scc1 main_end
  s_waitcnt vmcnt(0)
pvr_266:
  v_max3_u32 v26, v96, v100, v104
  v_max3_u32 v26, v26, v108, v112
  v_max3_u32 v26, v26, v116, v120
  v_max3_u32 v26, v26, v124, v136
  v_max3_u32 v26, v26, v140, v140
  v_cmp_eq_u32 vcc, -1, v26
  s_nop 1
  s_cbranch_vccnz pvr_265
  v_mfma_f32_16x16x32_bf16 v[148:151], a[80:83], v[96:99], v[148:151]
  v_mfma_f32_16x16x32_bf16 v[144:147], a[80:83], v[100:103], v[144:147]
  v_mfma_f32_16x16x32_bf16 v[156:159], a[84:87], v[96:99], v[156:159]
  v_mfma_f32_16x16x32_bf16 v[152:155], a[84:87], v[100:103], v[152:155]
  v_mfma_f32_16x16x32_bf16 v[164:167], a[88:91], v[96:99], v[164:167]
  v_mfma_f32_16x16x32_bf16 v[160:163], a[88:91], v[100:103], v[160:163]
  v_mfma_f32_16x16x32_bf16 v[172:175], a[92:95], v[96:99], v[172:175]
  v_mfma_f32_16x16x32_bf16 v[168:171], a[92:95], v[100:103], v[168:171]
  v_mfma_f32_16x16x32_bf16 v[180:183], a[96:99], v[96:99], v[180:183]
  v_mfma_f32_16x16x32_bf16 v[176:179], a[96:99], v[100:103], v[176:179]
  v_mfma_f32_16x16x32_bf16 v[148:151], a[100:103], v[104:107], v[148:151]
  v_mfma_f32_16x16x32_bf16 v[144:147], a[100:103], v[108:111], v[144:147]
  v_mfma_f32_16x16x32_bf16 v[156:159], a[104:107], v[104:107], v[156:159]
  v_mfma_f32_16x16x32_bf16 v[152:155], a[104:107], v[108:111], v[152:155]
  v_mfma_f32_16x16x32_bf16 v[164:167], a[108:111], v[104:107], v[164:167]
  v_mfma_f32_16x16x32_bf16 v[160:163], a[108:111], v[108:111], v[160:163]
  v_mfma_f32_16x16x32_bf16 v[172:175], a[112:115], v[104:107], v[172:175]
  v_mfma_f32_16x16x32_bf16 v[168:171], a[112:115], v[108:111], v[168:171]
  v_mfma_f32_16x16x32_bf16 v[180:183], a[116:119], v[104:107], v[180:183]
  v_mfma_f32_16x16x32_bf16 v[176:179], a[116:119], v[108:111], v[176:179]
  v_mfma_f32_16x16x32_bf16 v[148:151], a[120:123], v[112:115], v[148:151]
  v_mfma_f32_16x16x32_bf16 v[144:147], a[120:123], v[116:119], v[144:147]
  v_mfma_f32_16x16x32_bf16 v[156:159], a[124:127], v[112:115], v[156:159]
  v_mfma_f32_16x16x32_bf16 v[152:155], a[124:127], v[116:119], v[152:155]
  v_mfma_f32_16x16x32_bf16 v[164:167], a[128:131], v[112:115], v[164:167]
  v_mfma_f32_16x16x32_bf16 v[160:163], a[128:131], v[116:119], v[160:163]
  v_mfma_f32_16x16x32_bf16 v[172:175], a[132:135], v[112:115], v[172:175]
  v_mfma_f32_16x16x32_bf16 v[168:171], a[132:135], v[116:119], v[168:171]
  v_mfma_f32_16x16x32_bf16 v[180:183], a[136:139], v[112:115], v[180:183]
  v_mfma_f32_16x16x32_bf16 v[176:179], a[136:139], v[116:119], v[176:179]
  v_mfma_f32_16x16x32_bf16 v[148:151], a[140:143], v[120:123], v[148:151]
  v_mfma_f32_16x16x32_bf16 v[144:147], a[140:143], v[124:127], v[144:147]
  v_mfma_f32_16x16x32_bf16 v[156:159], a[144:147], v[120:123], v[156:159]
  v_mfma_f32_16x16x32_bf16 v[152:155], a[144:147], v[124:127], v[152:155]
  v_mfma_f32_16x16x32_bf16 v[164:167], a[148:151], v[120:123], v[164:167]
  v_mfma_f32_16x16x32_bf16 v[160:163], a[148:151], v[124:127], v[160:163]
  v_mfma_f32_16x16x32_bf16 v[172:175], a[152:155], v[120:123], v[172:175]
  v_mfma_f32_16x16x32_bf16 v[168:171], a[152:155], v[124:127], v[168:171]
  v_mfma_f32_16x16x32_bf16 v[180:183], a[156:159], v[120:123], v[180:183]
  v_mfma_f32_16x16x32_bf16 v[176:179], a[156:159], v[124:127], v[176:179]
  v_swap_b32 v138, v140
  v_swap_b32 v139, v141
  v_swap_b32 v50, v52
  v_swap_b32 v51, v53
  v_swap_b32 v58, v60
  v_swap_b32 v59, v61
  s_nop 1
  v_mfma_f32_16x16x32_bf16 v[144:147], v[48:51], v[136:139], v[144:147]
  v_mfma_f32_16x16x32_bf16 v[148:151], v[48:51], v[140:143], v[148:151]
  v_mfma_f32_16x16x32_bf16 v[152:155], v[52:55], v[136:139], v[152:155]
  v_mfma_f32_16x16x32_bf16 v[156:159], v[52:55], v[140:143], v[156:159]
  v_mfma_f32_16x16x32_bf16 v[160:163], v[188:191], v[136:139], v[160:163]
  v_mfma_f32_16x16x32_bf16 v[164:167], v[188:191], v[140:143], v[164:167]
  v_mfma_f32_16x16x32_bf16 v[168:171], v[56:59], v[136:139], v[168:171]
  v_mfma_f32_16x16x32_bf16 v[172:175], v[56:59], v[140:143], v[172:175]
  v_mfma_f32_16x16x32_bf16 v[176:179], v[60:63], v[136:139], v[176:179]
  v_mfma_f32_16x16x32_bf16 v[180:183], v[60:63], v[140:143], v[180:183]
pve_252:
  s_nop 0
  ds_write_b128 v10, v[144:147] offset:0
  ds_write_b128 v10, v[148:151] offset:1024
  ds_write_b128 v10, v[152:155] offset:2048
  ds_write_b128 v10, v[156:159] offset:3072
  ds_write_b128 v10, v[160:163] offset:4096
  ds_write_b128 v10, v[164:167] offset:5120
  ds_write_b128 v10, v[168:171] offset:6144
  ds_write_b128 v10, v[172:175] offset:7168
  s_nop 1
  ds_write_b128 v10, v[176:179] offset:8192
  ds_write_b128 v10, v[180:183] offset:9216
  s_cmp_lg_u32 s20, 0
  s_cbranch_scc1 pvq_267
  s_mov_b64 exec, 1
  ds_write_b32 v30, v29
  s_mov_b64 exec, -1
pvq_267:
  s_waitcnt lgkmcnt(0)
  s_barrier
  ds_read_b32 v23, v30
  ds_read_b128 v[192:195], v11 offset:0
  ds_read_b128 v[196:199], v11 offset:10240
  ds_read_b128 v[200:203], v11 offset:20480
  ds_read_b128 v[204:207], v11 offset:30720
  ds_read_b128 v[208:211], v11 offset:2048
  ds_read_b128 v[212:215], v11 offset:12288
  ds_read_b128 v[216:219], v11 offset:22528
  ds_read_b128 v[220:223], v11 offset:32768
  ds_read_b128 v[224:227], v12 offset:0
  ds_read_b128 v[228:231], v12 offset:10240
  ds_read_b128 v[232:235], v12 offset:20480
  ds_read_b128 v[236:239], v12 offset:30720
  s_waitcnt lgkmcnt(8)
  v_pk_add_f32 v[192:193], v[192:193], v[196:197]
  v_pk_add_f32 v[200:201], v[200:201], v[204:205]
  v_pk_add_f32 v[194:195], v[194:195], v[198:199]
  v_pk_add_f32 v[202:203], v[202:203], v[206:207]
  v_pk_add_f32 v[192:193], v[192:193], v[200:201]
  v_pk_add_f32 v[194:195], v[194:195], v[202:203]
  v_cvt_pk_bf16_f32 v26, v192, v193
  v_lshlrev_b32 v192, 16, v26
  v_and_b32 v193, 0xffff0000, v26
  v_mul_f32 v192, v192, v24
  v_mul_f32 v193, v193, v24
  v_cvt_pk_bf16_f32 v26, v192, v193
  v_lshlrev_b32 v192, 16, v26
  v_and_b32 v193, 0xffff0000, v26
  v_add_f32 v192, v192, v240
  v_add_f32 v193, v193, v241
  v_cvt_pk_bf16_f32 v196, v192, v193
  v_cvt_pk_bf16_f32 v26, v194, v195
  v_lshlrev_b32 v194, 16, v26
  v_and_b32 v195, 0xffff0000, v26
  v_mul_f32 v194, v194, v24
  v_mul_f32 v195, v195, v24
  v_cvt_pk_bf16_f32 v26, v194, v195
  v_lshlrev_b32 v194, 16, v26
  v_and_b32 v195, 0xffff0000, v26
  v_add_f32 v194, v194, v242
  v_add_f32 v195, v195, v243
  v_cvt_pk_bf16_f32 v197, v194, v195
  s_waitcnt lgkmcnt(4)
  v_pk_add_f32 v[208:209], v[208:209], v[212:213]
  v_pk_add_f32 v[216:217], v[216:217], v[220:221]
  v_pk_add_f32 v[210:211], v[210:211], v[214:215]
  v_pk_add_f32 v[218:219], v[218:219], v[222:223]
  v_pk_add_f32 v[208:209], v[208:209], v[216:217]
  v_pk_add_f32 v[210:211], v[210:211], v[218:219]
  v_cvt_pk_bf16_f32 v26, v208, v209
  v_lshlrev_b32 v208, 16, v26
  v_and_b32 v209, 0xffff0000, v26
  v_mul_f32 v208, v208, v24
  v_mul_f32 v209, v209, v24
  v_cvt_pk_bf16_f32 v26, v208, v209
  v_lshlrev_b32 v208, 16, v26
  v_and_b32 v209, 0xffff0000, v26
  v_add_f32 v208, v208, v244
  v_add_f32 v209, v209, v245
  v_cvt_pk_bf16_f32 v198, v208, v209
  v_cvt_pk_bf16_f32 v26, v210, v211
  v_lshlrev_b32 v210, 16, v26
  v_and_b32 v211, 0xffff0000, v26
  v_mul_f32 v210, v210, v24
  v_mul_f32 v211, v211, v24
  v_cvt_pk_bf16_f32 v26, v210, v211
  v_lshlrev_b32 v210, 16, v26
  v_and_b32 v211, 0xffff0000, v26
  v_add_f32 v210, v210, v246
  v_add_f32 v211, v211, v247
  v_cvt_pk_bf16_f32 v199, v210, v211
  buffer_store_dwordx4 v[196:199], v9, s[8:11], s46 offen
  s_cmp_ge_u32 s20, 2
  s_cbranch_scc1 pvm_268
  s_waitcnt lgkmcnt(0)
  v_pk_add_f32 v[224:225], v[224:225], v[228:229]
  v_pk_add_f32 v[232:233], v[232:233], v[236:237]
  v_pk_add_f32 v[226:227], v[226:227], v[230:231]
  v_pk_add_f32 v[234:235], v[234:235], v[238:239]
  v_pk_add_f32 v[224:225], v[224:225], v[232:233]
  v_pk_add_f32 v[226:227], v[226:227], v[234:235]
  v_cvt_pk_bf16_f32 v26, v224, v225
  v_lshlrev_b32 v224, 16, v26
  v_and_b32 v225, 0xffff0000, v26
  v_mul_f32 v224, v224, v24
  v_mul_f32 v225, v225, v24
  v_cvt_pk_bf16_f32 v26, v224, v225
  v_lshlrev_b32 v224, 16, v26
  v_and_b32 v225, 0xffff0000, v26
  v_add_f32 v224, v224, v248
  v_add_f32 v225, v225, v249
  v_cvt_pk_bf16_f32 v228, v224, v225
  v_cvt_pk_bf16_f32 v26, v226, v227
  v_lshlrev_b32 v226, 16, v26
  v_and_b32 v227, 0xffff0000, v26
  v_mul_f32 v226, v226, v24
  v_mul_f32 v227, v227, v24
  v_cvt_pk_bf16_f32 v26, v226, v227
  v_lshlrev_b32 v226, 16, v26
  v_and_b32 v227, 0xffff0000, v26
  v_add_f32 v226, v226, v250
  v_add_f32 v227, v227, v251
  v_cvt_pk_bf16_f32 v229, v226, v227
  buffer_store_dwordx2 v[228:229], v13, s[8:11], s49 offen offset:64
pvm_268:
  s_waitcnt lgkmcnt(0)
  v_readfirstlane_b32 s2, v23
  s_barrier
  s_add_u32 s60, s60, 1
  s_max_u32 s21, s2, s60
  s_cmp_lt_u32 s21, 16
  s_cbranch_scc1 pv_loop
main_fin:
  s_waitcnt vmcnt(0)
main_end:
  s_endpgm
.section .rodata,"a"
.p2align 6
.amdhsa_kernel gated_mix__memory_aug_recurrent_mem_tr__sliding_local_dilated__prompt_kernel
  .amdhsa_next_free_vgpr 512
  .amdhsa_next_free_sgpr 102
  .amdhsa_accum_offset 256
  .amdhsa_group_segment_fixed_size 0
  .amdhsa_kernarg_size 112
  .amdhsa_user_sgpr_count 2
  .amdhsa_user_sgpr_kernarg_segment_ptr 1
  .amdhsa_system_sgpr_workgroup_id_x 1
.end_amdhsa_kernel
.text
```

```asm
; @launch kernel=gated_mix__memory_aug_recurrent_mem_tr__sliding_local_dilated__prompt_kernel grid=(256,1,1) block=(256,1,1) lds=163840
.amdgcn_target "amdgcn-amd-amdhsa--gfx950"
.text
.globl gated_mix__memory_aug_recurrent_mem_tr__sliding_local_dilated__prompt_kernel
.p2align 8
.type gated_mix__memory_aug_recurrent_mem_tr__sliding_local_dilated__prompt_kernel,@function
gated_mix__memory_aug_recurrent_mem_tr__sliding_local_dilated__prompt_kernel:
  s_cmp_ge_u32 s2, 256
  s_cbranch_scc1 end0
  s_load_dwordx2 s[4:5], s[0:1], 96
  s_load_dwordx2 s[38:39], s[0:1], 104
  s_load_dwordx2 s[64:65], s[0:1], 0
  v_lshrrev_b32 v1, 6, v0
  v_and_b32 v2, 15, v0
  v_readfirstlane_b32 s20, v1
  v_and_b32 v1, 63, v0
  v_lshrrev_b32 v3, 4, v1
  s_getreg_b32 s50, hwreg(HW_REG_XCC_ID)
  s_and_b32 s50, s50, 7
  s_waitcnt lgkmcnt(0)
  s_mov_b32 s32, s4
  s_mov_b32 s33, s5
  s_mov_b32 s34, 256
  s_mov_b32 s35, 0x00020000
  v_mov_b32 v21, 0
  s_cmp_lg_u32 s20, 0
  s_cbranch_scc1 rk_1
  s_and_b32 s21, s50, 1
  s_lshl_b32 s21, s21, 7
  s_lshl_b32 s22, s50, 1
  s_and_b32 s22, s22, 12
  s_add_u32 s21, s21, s22
  v_mov_b32 v22, s21
  v_mov_b32 v23, 1
  s_mov_b64 exec, 1
  buffer_atomic_add v23, v22, s[32:35], 0 offen sc0 sc1
  s_waitcnt vmcnt(0)
  v_readfirstlane_b32 s51, v23
  s_lshl_b32 s22, s50, 5
  s_add_u32 s22, s22, s51
  s_cmp_lt_u32 s51, 32
  s_cbranch_scc1 rk_2
  v_mov_b32 v24, 72
  v_mov_b32 v25, 1
  buffer_atomic_add v25, v24, s[32:35], 0 offen sc0 sc1
  s_waitcnt vmcnt(0)
  v_readfirstlane_b32 s23, v25
  s_mov_b32 s101, 0
  s_mov_b64 exec, -1
  v_lshlrev_b32 v24, 2, v1
rk_3:
  s_sleep 8
  buffer_load_dword v25, v24, s[32:35], 0 offen sc1
  s_add_u32 s101, s101, 1
  s_cmp_gt_u32 s101, 131072
  s_cbranch_scc1 end0
  s_waitcnt vmcnt(0)
  v_readlane_b32 s21, v25, 0
  v_readlane_b32 s22, v25, 32
  s_add_u32 s21, s21, s22
  v_readlane_b32 s22, v25, 1
  s_add_u32 s21, s21, s22
  v_readlane_b32 s22, v25, 33
  s_add_u32 s21, s21, s22
  v_readlane_b32 s22, v25, 2
  s_add_u32 s21, s21, s22
  v_readlane_b32 s22, v25, 34
  s_add_u32 s21, s21, s22
  v_readlane_b32 s22, v25, 3
  s_add_u32 s21, s21, s22
  v_readlane_b32 s22, v25, 35
  s_add_u32 s21, s21, s22
  s_cmp_lt_u32 s21, 256
  s_cbranch_scc1 rk_3
  s_mov_b64 exec, 1
  s_mov_b32 s24, 0
rk_5:
  s_and_b32 s21, s24, 1
  s_lshl_b32 s21, s21, 5
  s_lshr_b32 s22, s24, 1
  s_add_u32 s21, s21, s22
  v_readlane_b32 s21, v25, s21
  s_min_u32 s21, s21, 32
  s_sub_u32 s25, 32, s21
  s_cmp_lt_u32 s23, s25
  s_cbranch_scc1 rk_4
  s_sub_u32 s23, s23, s25
  s_add_u32 s24, s24, 1
  s_cmp_lt_u32 s24, 8
  s_cbranch_scc1 rk_5
  s_branch end0
rk_4:
  s_lshl_b32 s22, s24, 5
  s_add_u32 s22, s22, s21
  s_add_u32 s22, s22, s23
  s_or_b32 s22, s22, 0x100
rk_2:
  v_mov_b32 v23, s22
  ds_write_b32 v21, v23
  s_waitcnt lgkmcnt(0)
  s_mov_b64 exec, -1
rk_1:
  s_waitcnt vmcnt(0)
  s_barrier
  ds_read_b32 v23, v21
  s_waitcnt lgkmcnt(0)
  v_readfirstlane_b32 s22, v23
  s_barrier
  s_lshr_b32 s53, s22, 8
  s_and_b32 s22, s22, 255
  s_cmp_ge_u32 s22, 128
  s_cbranch_scc1 gemm_side
  s_lshr_b32 s50, s22, 4
  s_and_b32 s51, s22, 15
  s_load_dwordx2 s[4:5], s[0:1], 8
  s_load_dwordx4 s[40:43], s[0:1], 16
  s_load_dwordx4 s[44:47], s[0:1], 32
  s_load_dwordx2 s[48:49], s[0:1], 104
  s_lshr_b32 s55, s51, 2
  s_and_b32 s56, s51, 3
  s_lshl_b32 s57, s50, 2
  s_add_u32 s58, s57, s55
  s_add_u32 s59, s57, s20
  s_lshr_b32 s60, s51, 1
  s_and_b32 s61, s51, 1
  s_mul_i32 s81, s20, 40960
  v_lshlrev_b32 v4, 4, v1
  s_waitcnt lgkmcnt(0)
  s_mov_b32 s12, s44
  s_mov_b32 s13, s45
  s_mov_b32 s14, 7864320
  s_mov_b32 s15, 0x00020000
  s_mov_b32 s16, s46
  s_mov_b32 s17, s47
  s_mov_b32 s18, 7864320
  s_mov_b32 s19, 0x00020000
  s_mov_b32 s24, s40
  s_mov_b32 s25, s41
  s_mov_b32 s26, 7864320
  s_mov_b32 s27, 0x00020000
  s_mov_b32 s28, s42
  s_mov_b32 s29, s43
  s_mov_b32 s30, 7864320
  s_mov_b32 s31, 0x00020000
  s_mov_b32 s36, s4
  s_mov_b32 s37, s5
  s_mov_b32 s38, 10240
  s_mov_b32 s39, 0x00020000
  s_add_u32 s8, s48, 174063616
  s_addc_u32 s9, s49, 0
  s_mov_b32 s10, 495616
  s_mov_b32 s11, 0x00020000
  s_add_u32 s4, s48, 171966464
  s_addc_u32 s5, s49, 0
  s_mov_b32 s6, 1048576
  s_mov_b32 s7, 0x00020000
  v_add_u32 v66, 0, v1
  v_mul_u32_u24 v67, 2731, v66
  v_lshrrev_b32 v67, 16, v67
  v_mul_u32_u24 v48, 24, v67
  v_sub_u32 v66, v66, v48
  v_mul_u32_u24 v67, 12288, v67
  v_lshl_add_u32 v48, v66, 4, v67
  v_add_u32 v66, 64, v1
  v_mul_u32_u24 v67, 2731, v66
  v_lshrrev_b32 v67, 16, v67
  v_mul_u32_u24 v49, 24, v67
  v_sub_u32 v66, v66, v49
  v_mul_u32_u24 v67, 12288, v67
  v_lshl_add_u32 v49, v66, 4, v67
  v_add_u32 v66, 128, v1
  v_mul_u32_u24 v67, 2731, v66
  v_lshrrev_b32 v67, 16, v67
  v_mul_u32_u24 v50, 24, v67
  v_sub_u32 v66, v66, v50
  v_mul_u32_u24 v67, 12288, v67
  v_lshl_add_u32 v50, v66, 4, v67
  s_mul_i32 s21, s51, 491520
  s_mul_i32 s80, s59, 384
  s_add_u32 s21, s21, s80
  s_mov_b32 s23, s21
  v_add_u32 v66, 0, v1
  v_mul_u32_u24 v67, 10923, v66
  v_lshrrev_b32 v67, 16, v67
  v_mul_u32_u24 v60, 6, v67
  v_sub_u32 v66, v66, v60
  v_mul_u32_u24 v67, 1280, v67
  v_lshl_add_u32 v60, v66, 4, v67
  v_add_u32 v66, 64, v1
  v_mul_u32_u24 v67, 10923, v66
  v_lshrrev_b32 v67, 16, v67
  v_mul_u32_u24 v61, 6, v67
  v_sub_u32 v66, v66, v61
  v_mul_u32_u24 v67, 1280, v67
  v_lshl_add_u32 v61, v66, 4, v67
  v_add_u32 v66, 128, v1
  v_mul_u32_u24 v67, 10923, v66
  v_lshrrev_b32 v67, 16, v67
  v_mul_u32_u24 v62, 6, v67
  v_sub_u32 v66, v66, v62
  v_mul_u32_u24 v67, 1280, v67
  v_lshl_add_u32 v62, v66, 4, v67
  s_mul_i32 s21, s59, 245760
  s_mul_i32 s22, s60, 160
  s_add_u32 s21, s21, s22
  s_lshl_b32 s22, s61, 6
  s_add_u32 s21, s21, s22
  s_add_u32 m0, s81, 0
  s_nop 0
  buffer_load_dwordx4 v60, s[16:19], s21 offen lds
  s_add_u32 m0, s81, 1024
  s_nop 0
  buffer_load_dwordx4 v61, s[16:19], s21 offen lds
  s_add_u32 m0, s81, 2048
  s_nop 0
  buffer_load_dwordx4 v62, s[16:19], s21 offen lds
  s_add_u32 s21, s21, 40960
  s_add_u32 m0, s81, 3072
  s_nop 0
  buffer_load_dwordx4 v60, s[16:19], s21 offen lds
  s_add_u32 m0, s81, 4096
  s_nop 0
  buffer_load_dwordx4 v61, s[16:19], s21 offen lds
  s_add_u32 m0, s81, 5120
  s_nop 0
  buffer_load_dwordx4 v62, s[16:19], s21 offen lds
  s_add_u32 s21, s21, 40960
  s_add_u32 m0, s81, 6144
  s_nop 0
  buffer_load_dwordx4 v60, s[16:19], s21 offen lds
  s_add_u32 m0, s81, 7168
  s_nop 0
  buffer_load_dwordx4 v61, s[16:19], s21 offen lds
  s_add_u32 m0, s81, 8192
  s_nop 0
  buffer_load_dwordx4 v62, s[16:19], s21 offen lds
  s_add_u32 s21, s21, 40960
  s_add_u32 m0, s81, 9216
  s_nop 0
  buffer_load_dwordx4 v60, s[16:19], s21 offen lds
  s_add_u32 m0, s81, 10240
  s_nop 0
  buffer_load_dwordx4 v61, s[16:19], s21 offen lds
  s_add_u32 m0, s81, 11264
  s_nop 0
  buffer_load_dwordx4 v62, s[16:19], s21 offen lds
  s_add_u32 s21, s21, 40960
  s_add_u32 m0, s81, 12288
  s_nop 0
  buffer_load_dwordx4 v60, s[16:19], s21 offen lds
  s_add_u32 m0, s81, 13312
  s_nop 0
  buffer_load_dwordx4 v61, s[16:19], s21 offen lds
  s_add_u32 m0, s81, 14336
  s_nop 0
  buffer_load_dwordx4 v62, s[16:19], s21 offen lds
  s_add_u32 s21, s21, 40960
  s_add_u32 m0, s81, 15360
  s_nop 0
  buffer_load_dwordx4 v60, s[16:19], s21 offen lds
  s_add_u32 m0, s81, 16384
  s_nop 0
  buffer_load_dwordx4 v61, s[16:19], s21 offen lds
  s_add_u32 m0, s81, 17408
  s_nop 0
  buffer_load_dwordx4 v62, s[16:19], s21 offen lds
  s_add_u32 s21, s21, 40960
  v_add_u32 v66, 0, v1
  v_mul_u32_u24 v67, 2731, v66
  v_lshrrev_b32 v67, 16, v67
  v_mul_u32_u24 v48, 24, v67
  v_sub_u32 v66, v66, v48
  v_lshrrev_b32 v48, 2, v67
  v_lshlrev_b32 v48, 1, v48
  v_or_b32 v48, 0, v48
  v_xor_b32 v66, v66, v48
  v_add_u32 v67, 0, v67
  v_mul_u32_u24 v67, 12288, v67
  v_lshl_add_u32 v48, v66, 4, v67
  v_add_u32 v66, 64, v1
  v_mul_u32_u24 v67, 2731, v66
  v_lshrrev_b32 v67, 16, v67
  v_mul_u32_u24 v49, 24, v67
  v_sub_u32 v66, v66, v49
  v_lshrrev_b32 v49, 2, v67
  v_lshlrev_b32 v49, 1, v49
  v_or_b32 v49, 0, v49
  v_xor_b32 v66, v66, v49
  v_add_u32 v67, 0, v67
  v_mul_u32_u24 v67, 12288, v67
  v_lshl_add_u32 v49, v66, 4, v67
  v_add_u32 v66, 128, v1
  v_mul_u32_u24 v67, 2731, v66
  v_lshrrev_b32 v67, 16, v67
  v_mul_u32_u24 v50, 24, v67
  v_sub_u32 v66, v66, v50
  v_lshrrev_b32 v50, 2, v67
  v_lshlrev_b32 v50, 1, v50
  v_or_b32 v50, 0, v50
  v_xor_b32 v66, v66, v50
  v_add_u32 v67, 0, v67
  v_mul_u32_u24 v67, 12288, v67
  v_lshl_add_u32 v50, v66, 4, v67
  v_add_u32 v66, 0, v1
  v_mul_u32_u24 v67, 2731, v66
  v_lshrrev_b32 v67, 16, v67
  v_mul_u32_u24 v51, 24, v67
  v_sub_u32 v66, v66, v51
  v_lshrrev_b32 v51, 2, v67
  v_lshlrev_b32 v51, 1, v51
  v_or_b32 v51, 1, v51
  v_xor_b32 v66, v66, v51
  v_add_u32 v67, 8, v67
  v_mul_u32_u24 v67, 12288, v67
  v_lshl_add_u32 v51, v66, 4, v67
  v_add_u32 v66, 64, v1
  v_mul_u32_u24 v67, 2731, v66
  v_lshrrev_b32 v67, 16, v67
  v_mul_u32_u24 v52, 24, v67
  v_sub_u32 v66, v66, v52
  v_lshrrev_b32 v52, 2, v67
  v_lshlrev_b32 v52, 1, v52
  v_or_b32 v52, 1, v52
  v_xor_b32 v66, v66, v52
  v_add_u32 v67, 8, v67
  v_mul_u32_u24 v67, 12288, v67
  v_lshl_add_u32 v52, v66, 4, v67
  v_add_u32 v66, 128, v1
  v_mul_u32_u24 v67, 2731, v66
  v_lshrrev_b32 v67, 16, v67
  v_mul_u32_u24 v53, 24, v67
  v_sub_u32 v66, v66, v53
  v_lshrrev_b32 v53, 2, v67
  v_lshlrev_b32 v53, 1, v53
  v_or_b32 v53, 1, v53
  v_xor_b32 v66, v66, v53
  v_add_u32 v67, 8, v67
  v_mul_u32_u24 v67, 12288, v67
  v_lshl_add_u32 v53, v66, 4, v67
  v_add_u32 v66, 0, v1
  v_mul_u32_u24 v67, 2731, v66
  v_lshrrev_b32 v67, 16, v67
  v_mul_u32_u24 v54, 24, v67
  v_sub_u32 v66, v66, v54
  v_lshrrev_b32 v54, 2, v67
  v_lshlrev_b32 v54, 1, v54
  v_or_b32 v54, 4, v54
  v_xor_b32 v66, v66, v54
  v_add_u32 v67, 16, v67
  v_mul_u32_u24 v67, 12288, v67
  v_lshl_add_u32 v54, v66, 4, v67
  v_add_u32 v66, 64, v1
  v_mul_u32_u24 v67, 2731, v66
  v_lshrrev_b32 v67, 16, v67
  v_mul_u32_u24 v55, 24, v67
  v_sub_u32 v66, v66, v55
  v_lshrrev_b32 v55, 2, v67
  v_lshlrev_b32 v55, 1, v55
  v_or_b32 v55, 4, v55
  v_xor_b32 v66, v66, v55
  v_add_u32 v67, 16, v67
  v_mul_u32_u24 v67, 12288, v67
  v_lshl_add_u32 v55, v66, 4, v67
  v_add_u32 v66, 128, v1
  v_mul_u32_u24 v67, 2731, v66
  v_lshrrev_b32 v67, 16, v67
  v_mul_u32_u24 v56, 24, v67
  v_sub_u32 v66, v66, v56
  v_lshrrev_b32 v56, 2, v67
  v_lshlrev_b32 v56, 1, v56
  v_or_b32 v56, 4, v56
  v_xor_b32 v66, v66, v56
  v_add_u32 v67, 16, v67
  v_mul_u32_u24 v67, 12288, v67
  v_lshl_add_u32 v56, v66, 4, v67
  v_add_u32 v66, 0, v1
  v_mul_u32_u24 v67, 2731, v66
  v_lshrrev_b32 v67, 16, v67
  v_mul_u32_u24 v57, 24, v67
  v_sub_u32 v66, v66, v57
  v_lshrrev_b32 v57, 2, v67
  v_lshlrev_b32 v57, 1, v57
  v_or_b32 v57, 5, v57
  v_xor_b32 v66, v66, v57
  v_add_u32 v67, 24, v67
  v_mul_u32_u24 v67, 12288, v67
  v_lshl_add_u32 v57, v66, 4, v67
  v_add_u32 v66, 64, v1
  v_mul_u32_u24 v67, 2731, v66
  v_lshrrev_b32 v67, 16, v67
  v_mul_u32_u24 v58, 24, v67
  v_sub_u32 v66, v66, v58
  v_lshrrev_b32 v58, 2, v67
  v_lshlrev_b32 v58, 1, v58
  v_or_b32 v58, 5, v58
  v_xor_b32 v66, v66, v58
  v_add_u32 v67, 24, v67
  v_mul_u32_u24 v67, 12288, v67
  v_lshl_add_u32 v58, v66, 4, v67
  v_add_u32 v66, 128, v1
  v_mul_u32_u24 v67, 2731, v66
  v_lshrrev_b32 v67, 16, v67
  v_mul_u32_u24 v59, 24, v67
  v_sub_u32 v66, v66, v59
  v_lshrrev_b32 v59, 2, v67
  v_lshlrev_b32 v59, 1, v59
  v_or_b32 v59, 5, v59
  v_xor_b32 v66, v66, v59
  v_add_u32 v67, 24, v67
  v_mul_u32_u24 v67, 12288, v67
  v_lshl_add_u32 v59, v66, 4, v67
  s_add_u32 m0, s81, 24576
  s_nop 0
  buffer_load_dwordx4 v48, s[12:15], s80 offen lds
  s_add_u32 m0, s81, 25600
  s_nop 0
  buffer_load_dwordx4 v49, s[12:15], s80 offen lds
  s_add_u32 m0, s81, 26624
  s_nop 0
  buffer_load_dwordx4 v50, s[12:15], s80 offen lds
  s_add_u32 m0, s81, 27648
  s_nop 0
  buffer_load_dwordx4 v51, s[12:15], s80 offen lds
  s_add_u32 m0, s81, 28672
  s_nop 0
  buffer_load_dwordx4 v52, s[12:15], s80 offen lds
  s_add_u32 m0, s81, 29696
  s_nop 0
  buffer_load_dwordx4 v53, s[12:15], s80 offen lds
  s_add_u32 m0, s81, 30720
  s_nop 0
  buffer_load_dwordx4 v54, s[12:15], s80 offen lds
  s_add_u32 m0, s81, 31744
  s_nop 0
  buffer_load_dwordx4 v55, s[12:15], s80 offen lds
  s_add_u32 m0, s81, 32768
  s_nop 0
  buffer_load_dwordx4 v56, s[12:15], s80 offen lds
  s_add_u32 m0, s81, 33792
  s_nop 0
  buffer_load_dwordx4 v57, s[12:15], s80 offen lds
  s_add_u32 m0, s81, 34816
  s_nop 0
  buffer_load_dwordx4 v58, s[12:15], s80 offen lds
  s_add_u32 m0, s81, 35840
  s_nop 0
  buffer_load_dwordx4 v59, s[12:15], s80 offen lds
  s_add_u32 s80, s80, 393216
  v_add_u32 v66, 0, v1
  v_mul_u32_u24 v67, 10923, v66
  v_lshrrev_b32 v67, 16, v67
  v_mul_u32_u24 v63, 6, v67
  v_sub_u32 v66, v66, v63
  v_mul_u32_u24 v67, 12288, v67
  v_lshl_add_u32 v63, v66, 4, v67
  v_add_u32 v66, 64, v1
  v_mul_u32_u24 v67, 10923, v66
  v_lshrrev_b32 v67, 16, v67
  v_mul_u32_u24 v64, 6, v67
  v_sub_u32 v66, v66, v64
  v_mul_u32_u24 v67, 12288, v67
  v_lshl_add_u32 v64, v66, 4, v67
  v_add_u32 v66, 128, v1
  v_mul_u32_u24 v67, 10923, v66
  v_lshrrev_b32 v67, 16, v67
  v_mul_u32_u24 v65, 6, v67
  v_sub_u32 v66, v66, v65
  v_mul_u32_u24 v67, 12288, v67
  v_lshl_add_u32 v65, v66, 4, v67
  s_mul_i32 s79, s58, 384
  s_mul_i32 s22, s56, 96
  s_add_u32 s79, s79, s22
  s_mul_i32 s22, s20, 1966080
  s_add_u32 s79, s79, s22
  v_and_b32 v224, 7, v2
  v_lshrrev_b32 v225, 3, v2
  v_lshlrev_b32 v12, 3, v1
  v_mov_b32 v23, 0
  v_mov_b32 v226, 0x4444
  v_mov_b32 v227, 0xeeee
  v_cmp_eq_u32 vcc, 1, v225
  v_cmp_gt_u32 s[62:63], 8, v2
  v_cmp_le_u32 s[68:69], 8, v2
  v_cndmask_b32 v22, v226, v227, vcc
  v_cmp_gt_u32 vcc, 32, v1
  v_mov_b32 v226, 0x3dd53b95
  v_cmp_gt_u32 s[66:67], 40, v1
  v_cndmask_b32 v24, 1.0, v226, vcc
  v_cndmask_b32 v25, 1.0, v226, vcc
  v_min_u32 v226, 39, v1
  v_and_b32 v227, 31, v1
  v_lshlrev_b32 v227, 2, v227
  v_lshl_add_u32 v5, v226, 7, v227
  v_mul_u32_u24 v226, 192, v3
  v_lshl_add_u32 v226, v2, 3, v226
  s_mul_i32 s21, s20, 768
  s_add_u32 s21, s21, 10240
  v_add_u32 v6, s21, v226
  v_and_b32 v226, 3, v2
  v_mul_u32_u24 v226, 192, v226
  v_lshrrev_b32 v227, 2, v2
  v_lshl_add_u32 v227, v3, 2, v227
  v_lshl_add_u32 v226, v227, 3, v226
  v_add_u32 v7, 10240, v226
  s_mul_i32 s21, s58, 2560
  s_add_u32 s21, s21, 40960
  s_lshr_b32 s22, s56, 1
  s_lshl_b32 s22, s22, 10
  s_and_b32 s23, s56, 1
  s_lshl_b32 s23, s23, 3
  s_add_u32 s22, s22, s23
  s_lshl_b32 s23, s20, 7
  s_add_u32 s22, s22, s23
  s_add_u32 s22, s22, s21
  v_lshlrev_b32 v226, 8, v3
  v_lshl_add_u32 v226, v224, 4, v226
  v_add_u32 v8, s22, v226
  s_lshl_b32 s22, s56, 2
  s_add_u32 s22, s22, s21
  s_add_u32 s22, s22, 2048
  v_and_b32 v226, 0x1ff, v226
  v_add_u32 v226, s22, v226
  s_cmp_eq_u32 s20, 2
  s_cselect_b64 vcc, -1, 0
  v_cmp_le_u32 s[64:65], 32, v1
  v_cndmask_b32 v8, v8, v226, vcc
  s_cselect_b64 s[64:65], s[64:65], -1
  s_and_b64 s[64:65], s[64:65], s[62:63]
  s_mul_i32 s21, s59, 2560
  s_add_u32 s21, s21, 40960
  v_add_u32 v9, s21, v4
  v_and_b32 v226, 0x1ff, v4
  s_add_u32 s21, s21, 2048
  v_add_u32 v10, s21, v226
  v_lshrrev_b32 v226, 2, v2
  v_and_b32 v227, 1, v2
  v_lshl_add_u32 v228, v226, 1, v227
  v_and_b32 v227, 2, v2
  v_cmp_eq_u32 vcc, 0, v227
  s_lshr_b32 s21, s20, 1
  s_lshl_b32 s21, s21, 9
  s_and_b32 s22, s20, 1
  s_lshl_b32 s22, s22, 6
  s_add_u32 s21, s21, s22
  s_add_u32 s21, s21, 12544
  v_lshlrev_b32 v226, 7, v3
  v_lshl_add_u32 v226, v228, 3, v226
  v_add_u32 v226, s21, v226
  v_mov_b32 v227, 13568
  v_cndmask_b32 v11, v227, v226, vcc
  s_lshl_b32 s21, s20, 9
  s_add_u32 s21, s21, 40960
  v_lshlrev_b32 v226, 7, v3
  v_lshl_add_u32 v226, v228, 4, v226
  v_add_u32 v226, s21, v226
  v_mov_b32 v227, 46080
  v_cndmask_b32 v19, v227, v226, vcc
  s_lshl_b32 s21, s20, 11
  s_add_u32 s21, s21, 32768
  v_add_u32 v18, s21, v4
  s_and_b32 s21, s20, 1
  s_lshl_b32 s22, s21, 10
  s_add_u32 s22, s22, 43008
  v_add_u32 v20, s22, v4
  s_lshl_b32 s22, s21, 3
  s_add_u32 s22, s22, 45056
  v_add_u32 v21, s22, v4
  s_mul_i32 s21, s20, 640
  s_add_u32 s22, s21, 13824
  v_lshlrev_b32 v226, 4, v224
  v_lshl_add_u32 v227, v3, 7, v226
  v_add_u32 v13, s22, v227
  v_lshl_add_u32 v227, v3, 2, v226
  s_add_u32 s22, s22, 512
  v_add_u32 v14, s22, v227
  v_and_b32 v226, 0x1ff, v4
  v_lshrrev_b32 v228, 5, v1
  v_lshl_add_u32 v226, v228, 3, v226
  s_add_u32 s22, s21, 16384
  v_add_u32 v26, s22, v226
  v_lshl_add_u32 v228, v228, 1, v225
  v_mul_u32_u24 v228, 640, v228
  v_and_b32 v226, 1, v3
  v_lshl_add_u32 v228, v226, 6, v228
  v_lshl_add_u32 v228, v224, 3, v228
  v_add_u32 v43, 16896, v228
  s_and_b32 s21, s50, 1
  s_lshl_b32 s21, s21, 4
  s_add_u32 s21, s21, s51
  s_lshl_b32 s22, s20, 5
  s_add_u32 s21, s21, s22
  s_cmp_lt_u32 s21, 80
  s_cselect_b32 s78, 1, 0
  s_cselect_b32 s21, s21, 0
  s_lshl_b32 s22, s21, 7
  v_add_u32 v17, s22, v227
  s_lshr_b32 s22, s21, 3
  s_lshl_b32 s22, s22, 14
  s_and_b32 s21, s21, 7
  s_lshl_b32 s21, s21, 10
  s_add_u32 s21, s21, s22
  v_add_u32 v16, s21, v4
  s_mul_i32 s21, s60, 10
  s_mul_i32 s22, s61, 6
  s_add_u32 s22, s22, s21
  s_add_u32 s21, s21, s61
  s_add_u32 s21, s21, 4
  v_lshrrev_b32 v226, 3, v1
  v_cmp_gt_u32 vcc, 4, v226
  v_add_u32 v226, s22, v226
  v_mov_b32 v227, s21
  v_cndmask_b32 v226, v227, v226, vcc
  v_lshrrev_b32 v227, 3, v226
  v_lshlrev_b32 v227, 14, v227
  v_and_b32 v226, 7, v226
  v_lshl_add_u32 v226, v226, 10, v227
  v_lshl_add_u32 v226, v224, 4, v226
  s_lshl_b32 s21, s50, 7
  v_add_u32 v15, s21, v226
  v_and_b32 v226, 1, v2
  v_lshlrev_b32 v226, 4, v226
  v_mov_b32 v227, 0x3c00
  v_lshlrev_b32 v226, v226, v227
  v_lshrrev_b32 v227, 1, v2
  v_cmp_eq_u32 vcc, 0, v227
  s_nop 1
  v_cndmask_b32 v44, 0, v226, vcc
  v_cmp_eq_u32 vcc, 2, v227
  s_nop 1
  v_cndmask_b32 v45, 0, v226, vcc
  v_cmp_eq_u32 vcc, 4, v227
  s_nop 1
  v_cndmask_b32 v46, 0, v226, vcc
  v_cmp_eq_u32 vcc, 6, v227
  s_nop 1
  v_cndmask_b32 v47, 0, v226, vcc
  v_lshrrev_b32 v226, 5, v1
  v_lshlrev_b32 v226, 14, v226
  v_bfe_u32 v227, v1, 3, 2
  v_lshl_add_u32 v226, v227, 8, v226
  v_lshl_add_u32 v226, v224, 4, v226
  s_lshl_b32 s21, s61, 7
  v_add_u32 v32, s21, v226
  v_lshlrev_b32 v226, 4, v224
  v_lshl_add_u32 v36, v3, 7, v226
  v_lshrrev_b32 v37, 1, v36
  v_and_b32 v41, 3, v1
  v_lshlrev_b32 v41, 7, v41
  v_mov_b32 v226, 0x40000000
  v_cmp_gt_u32 vcc, 32, v1
  v_cndmask_b32 v36, v226, v36, s[68:69]
  v_cndmask_b32 v37, v226, v37, s[68:69]
  v_cndmask_b32 v38, v226, v4, vcc
  s_lshr_b32 s21, s50, 1
  s_lshl_b32 s21, s21, 8
  s_add_u32 s21, s21, 491520
  v_and_b32 v227, 31, v1
  v_lshl_add_u32 v33, v227, 2, s21
  s_and_b32 s22, s50, 1
  s_lshl_b32 s22, s22, 4
  s_add_u32 s22, s22, s51
  v_cmp_eq_u32 vcc, s22, v1
  s_nop 1
  v_cndmask_b32 v34, v226, v33, vcc
  v_mov_b32 v28, -1
  v_mov_b32 v29, -1
  v_mov_b32 v30, -1
  v_mov_b32 v31, -1
  s_lshr_b32 s21, s50, 1
  s_mul_i32 s77, s21, 10240
  s_cmp_eq_u32 s20, 3
  s_cbranch_scc1 ar_8
  s_mov_b64 exec, s[64:65]
  s_cmp_eq_u32 s20, 2
  s_cbranch_scc1 ar_7
  s_mov_b32 s21, 0
  buffer_store_dwordx2 v[28:29], v8, s[8:11], s21 offen
  s_mov_b32 s21, 122880
  buffer_store_dwordx2 v[28:29], v8, s[8:11], s21 offen
  s_mov_b32 s21, 245760
  buffer_store_dwordx2 v[28:29], v8, s[8:11], s21 offen
  s_mov_b32 s21, 368640
  buffer_store_dwordx2 v[28:29], v8, s[8:11], s21 offen
  s_branch ar_9
ar_7:
  s_mov_b32 s21, 0
  buffer_store_dword v28, v8, s[8:11], s21 offen
  buffer_store_dword v28, v8, s[8:11], s21 offen offset:128
  s_mov_b32 s21, 122880
  buffer_store_dword v28, v8, s[8:11], s21 offen
  buffer_store_dword v28, v8, s[8:11], s21 offen offset:128
  s_mov_b32 s21, 245760
  buffer_store_dword v28, v8, s[8:11], s21 offen
  buffer_store_dword v28, v8, s[8:11], s21 offen offset:128
  s_mov_b32 s21, 368640
  buffer_store_dword v28, v8, s[8:11], s21 offen
  buffer_store_dword v28, v8, s[8:11], s21 offen offset:128
ar_9:
  s_cmp_eq_u32 s78, 0
  s_cbranch_scc1 ar_10
  s_mov_b64 exec, s[62:63]
  s_add_u32 s21, s77, 0
  buffer_store_dword v28, v17, s[8:11], s21 offen
  s_add_u32 s21, s77, 122880
  buffer_store_dword v28, v17, s[8:11], s21 offen
  s_add_u32 s21, s77, 245760
  buffer_store_dword v28, v17, s[8:11], s21 offen
  s_add_u32 s21, s77, 368640
  buffer_store_dword v28, v17, s[8:11], s21 offen
  s_branch ar_10
ar_8:
  buffer_store_dword v28, v34, s[8:11], 0 offen
  s_mov_b64 exec, s[66:67]
  s_mov_b32 s21, 0
  buffer_store_dwordx4 v[28:31], v15, s[4:7], s21 offen sc1
  s_mov_b32 s21, 262144
  buffer_store_dwordx4 v[28:31], v15, s[4:7], s21 offen sc1
  s_mov_b32 s21, 524288
  buffer_store_dwordx4 v[28:31], v15, s[4:7], s21 offen sc1
  s_mov_b32 s21, 786432
  buffer_store_dwordx4 v[28:31], v15, s[4:7], s21 offen sc1
  s_mov_b32 s21, 8192
  buffer_store_dwordx4 v[28:31], v15, s[4:7], s21 offen sc1
  s_mov_b32 s21, 270336
  buffer_store_dwordx4 v[28:31], v15, s[4:7], s21 offen sc1
  s_mov_b32 s21, 532480
  buffer_store_dwordx4 v[28:31], v15, s[4:7], s21 offen sc1
  s_mov_b32 s21, 794624
  buffer_store_dwordx4 v[28:31], v15, s[4:7], s21 offen sc1
ar_10:
  s_mov_b64 exec, -1
  v_lshrrev_b32 v66, 2, v2
  v_lshl_add_u32 v66, v3, 3, v66
  v_mul_u32_u24 v66, 96, v66
  v_add_u32 v66, s81, v66
  v_and_b32 v67, 3, v2
  s_lshl_b32 s21, s61, 5
  v_lshl_add_u32 v68, v67, 4, v66
  v_add_u32 v68, s21, v68
  s_mul_i32 s21, s61, 48
  s_sub_u32 s21, 64, s21
  v_and_b32 v67, 1, v2
  v_lshl_add_u32 v69, v67, 3, v66
  v_add_u32 v69, s21, v69
  v_lshrrev_b32 v226, 3, v2
  v_lshlrev_b32 v226, 4, v226
  v_bfe_u32 v227, v2, 1, 1
  v_lshl_add_u32 v226, v227, 3, v226
  v_and_b32 v227, 5, v2
  v_add_u32 v226, v226, v227
  v_mul_u32_u24 v226, 384, v226
  v_add_u32 v226, s81, v226
  v_lshrrev_b32 v227, 1, v2
  v_xor_b32 v227, v227, v3
  v_lshl_add_u32 v70, v227, 4, v226
  v_xor_b32 v227, 4, v227
  v_lshl_add_u32 v71, v227, 4, v226
  s_waitcnt vmcnt(0)
  ds_read_b64_tr_b16 v[72:73], v68 offset:0
  ds_read_b64_tr_b16 v[74:75], v68 offset:384
  ds_read_b64_tr_b16 v[76:77], v68 offset:8
  ds_read_b64_tr_b16 v[78:79], v68 offset:392
  ds_read_b64_tr_b16 v[80:81], v69 offset:0
  ds_read_b64_tr_b16 v[82:83], v69 offset:384
  ds_read_b64_tr_b16 v[84:85], v68 offset:3072
  ds_read_b64_tr_b16 v[86:87], v68 offset:3456
  ds_read_b64_tr_b16 v[88:89], v68 offset:3080
  ds_read_b64_tr_b16 v[90:91], v68 offset:3464
  ds_read_b64_tr_b16 v[92:93], v69 offset:3072
  ds_read_b64_tr_b16 v[94:95], v69 offset:3456
  ds_read_b64_tr_b16 v[96:97], v68 offset:6144
  ds_read_b64_tr_b16 v[98:99], v68 offset:6528
  ds_read_b64_tr_b16 v[100:101], v68 offset:6152
  ds_read_b64_tr_b16 v[102:103], v68 offset:6536
  ds_read_b64_tr_b16 v[104:105], v69 offset:6144
  ds_read_b64_tr_b16 v[106:107], v69 offset:6528
  ds_read_b64_tr_b16 v[108:109], v68 offset:9216
  ds_read_b64_tr_b16 v[110:111], v68 offset:9600
  ds_read_b64_tr_b16 v[112:113], v68 offset:9224
  ds_read_b64_tr_b16 v[114:115], v68 offset:9608
  ds_read_b64_tr_b16 v[116:117], v69 offset:9216
  ds_read_b64_tr_b16 v[118:119], v69 offset:9600
  ds_read_b64_tr_b16 v[120:121], v68 offset:12288
  ds_read_b64_tr_b16 v[122:123], v68 offset:12672
  ds_read_b64_tr_b16 v[124:125], v68 offset:12296
  ds_read_b64_tr_b16 v[126:127], v68 offset:12680
  ds_read_b64_tr_b16 v[128:129], v69 offset:12288
  ds_read_b64_tr_b16 v[130:131], v69 offset:12672
  ds_read_b64_tr_b16 v[132:133], v68 offset:15360
  ds_read_b64_tr_b16 v[134:135], v68 offset:15744
  ds_read_b64_tr_b16 v[136:137], v68 offset:15368
  ds_read_b64_tr_b16 v[138:139], v68 offset:15752
  ds_read_b64_tr_b16 v[140:141], v69 offset:15360
  ds_read_b64_tr_b16 v[142:143], v69 offset:15744
  s_waitcnt lgkmcnt(0)
  s_barrier
  s_cmp_lg_u32 s20, 0
  s_cbranch_scc1 ic_11
  v_mov_b32 v68, 64
  v_mov_b32 v69, 1
  s_mov_b64 exec, 1
  buffer_atomic_add v69, v68, s[32:35], 0 offen sc1
  s_mov_b64 exec, -1
ic_11:
  s_add_u32 m0, s81, 0
  s_nop 0
  buffer_load_dwordx4 v48, s[12:15], s80 offen lds
  s_add_u32 m0, s81, 1024
  s_nop 0
  buffer_load_dwordx4 v49, s[12:15], s80 offen lds
  s_add_u32 m0, s81, 2048
  s_nop 0
  buffer_load_dwordx4 v50, s[12:15], s80 offen lds
  s_add_u32 m0, s81, 3072
  s_nop 0
  buffer_load_dwordx4 v51, s[12:15], s80 offen lds
  s_add_u32 m0, s81, 4096
  s_nop 0
  buffer_load_dwordx4 v52, s[12:15], s80 offen lds
  s_add_u32 m0, s81, 5120
  s_nop 0
  buffer_load_dwordx4 v53, s[12:15], s80 offen lds
  s_add_u32 m0, s81, 6144
  s_nop 0
  buffer_load_dwordx4 v54, s[12:15], s80 offen lds
  s_add_u32 m0, s81, 7168
  s_nop 0
  buffer_load_dwordx4 v55, s[12:15], s80 offen lds
  s_add_u32 m0, s81, 8192
  s_nop 0
  buffer_load_dwordx4 v56, s[12:15], s80 offen lds
  s_add_u32 m0, s81, 9216
  s_nop 0
  buffer_load_dwordx4 v57, s[12:15], s80 offen lds
  s_add_u32 m0, s81, 10240
  s_nop 0
  buffer_load_dwordx4 v58, s[12:15], s80 offen lds
  s_add_u32 m0, s81, 11264
  s_nop 0
  buffer_load_dwordx4 v59, s[12:15], s80 offen lds
  s_add_u32 s80, s80, 393216
  s_add_u32 s16, s48, 173080576
  s_addc_u32 s17, s49, 0
  s_mov_b32 s18, 49152
  s_mov_b32 s19, 0x00020000
  v_add_u32 v68, s81, v4
  v_and_b32 v69, 7, v2
  v_lshl_add_u32 v69, v3, 3, v69
  v_and_b32 v67, 8, v2
  v_lshl_add_u32 v69, v69, 4, v67
  v_add_u32 v69, s81, v69
  v_lshlrev_b32 v67, 2, v1
  s_lshl_b32 s90, s50, 9
  s_and_b32 s21, s51, 12
  s_add_u32 s90, s90, s21
  s_add_u32 s90, s90, 4096
  ds_read_b128 v[208:211], v70 offset:24576
  ds_read_b128 v[212:215], v71 offset:24576
  ds_read_b128 v[216:219], v70 offset:24704
  s_waitcnt lgkmcnt(2)
  v_mfma_f32_16x16x32_bf16 v[184:187], v[208:211], v[72:75], 0
  ds_read_b128 v[220:223], v71 offset:24704
  v_mfma_f32_16x16x32_bf16 v[188:191], v[208:211], v[76:79], 0
  s_add_u32 m0, s81, 12288
  s_nop 0
  buffer_load_dwordx4 v48, s[12:15], s80 offen lds
  v_mfma_f32_16x16x32_bf16 v[192:195], v[208:211], v[80:83], 0
  s_waitcnt lgkmcnt(2)
  v_mfma_f32_16x16x32_bf16 v[184:187], v[212:215], v[84:87], v[184:187]
  ds_read_b128 v[208:211], v70 offset:24832
  v_mfma_f32_16x16x32_bf16 v[188:191], v[212:215], v[88:91], v[188:191]
  s_add_u32 m0, s81, 13312
  s_nop 0
  buffer_load_dwordx4 v49, s[12:15], s80 offen lds
  v_mfma_f32_16x16x32_bf16 v[192:195], v[212:215], v[92:95], v[192:195]
  s_waitcnt lgkmcnt(2)
  v_mfma_f32_16x16x32_bf16 v[184:187], v[216:219], v[96:99], v[184:187]
  ds_read_b128 v[212:215], v71 offset:24832
  v_mfma_f32_16x16x32_bf16 v[188:191], v[216:219], v[100:103], v[188:191]
  s_add_u32 m0, s81, 14336
  s_nop 0
  buffer_load_dwordx4 v50, s[12:15], s80 offen lds
  v_mfma_f32_16x16x32_bf16 v[192:195], v[216:219], v[104:107], v[192:195]
  s_waitcnt lgkmcnt(2)
  v_mfma_f32_16x16x32_bf16 v[184:187], v[220:223], v[108:111], v[184:187]
  ds_read_b128 v[216:219], v70 offset:25344
  v_mfma_f32_16x16x32_bf16 v[188:191], v[220:223], v[112:115], v[188:191]
  s_add_u32 m0, s81, 15360
  s_nop 0
  buffer_load_dwordx4 v51, s[12:15], s80 offen lds
  v_mfma_f32_16x16x32_bf16 v[192:195], v[220:223], v[116:119], v[192:195]
  s_waitcnt lgkmcnt(2)
  v_mfma_f32_16x16x32_bf16 v[184:187], v[208:211], v[120:123], v[184:187]
  ds_read_b128 v[220:223], v71 offset:25344
  v_mfma_f32_16x16x32_bf16 v[188:191], v[208:211], v[124:127], v[188:191]
  s_add_u32 m0, s81, 16384
  s_nop 0
  buffer_load_dwordx4 v52, s[12:15], s80 offen lds
  v_mfma_f32_16x16x32_bf16 v[192:195], v[208:211], v[128:131], v[192:195]
  s_waitcnt lgkmcnt(2)
  v_mfma_f32_16x16x32_bf16 v[184:187], v[212:215], v[132:135], v[184:187]
  ds_read_b128 v[208:211], v70 offset:25472
  v_mfma_f32_16x16x32_bf16 v[188:191], v[212:215], v[136:139], v[188:191]
  s_add_u32 m0, s81, 17408
  s_nop 0
  buffer_load_dwordx4 v53, s[12:15], s80 offen lds
  v_mfma_f32_16x16x32_bf16 v[192:195], v[212:215], v[140:143], v[192:195]
  s_waitcnt lgkmcnt(2)
  v_mfma_f32_16x16x32_bf16 v[196:199], v[216:219], v[72:75], 0
  ds_read_b128 v[212:215], v71 offset:25472
  v_mfma_f32_16x16x32_bf16 v[200:203], v[216:219], v[76:79], 0
  s_add_u32 m0, s81, 18432
  s_nop 0
  buffer_load_dwordx4 v54, s[12:15], s80 offen lds
  v_mfma_f32_16x16x32_bf16 v[204:207], v[216:219], v[80:83], 0
  s_waitcnt lgkmcnt(2)
  v_mfma_f32_16x16x32_bf16 v[196:199], v[220:223], v[84:87], v[196:199]
  ds_read_b128 v[216:219], v70 offset:25600
  v_cvt_pk_bf16_f32 v248, v184, v185
  v_mfma_f32_16x16x32_bf16 v[200:203], v[220:223], v[88:91], v[200:203]
  s_add_u32 m0, s81, 19456
  s_nop 0
  buffer_load_dwordx4 v55, s[12:15], s80 offen lds
  v_mfma_f32_16x16x32_bf16 v[204:207], v[220:223], v[92:95], v[204:207]
  v_cvt_pk_bf16_f32 v249, v186, v187
  s_waitcnt lgkmcnt(2)
  v_mfma_f32_16x16x32_bf16 v[196:199], v[208:211], v[96:99], v[196:199]
  ds_read_b128 v[220:223], v71 offset:25600
  v_cvt_pk_bf16_f32 v250, v188, v189
  v_mfma_f32_16x16x32_bf16 v[200:203], v[208:211], v[100:103], v[200:203]
  s_add_u32 m0, s81, 20480
  s_nop 0
  buffer_load_dwordx4 v56, s[12:15], s80 offen lds
  v_mfma_f32_16x16x32_bf16 v[204:207], v[208:211], v[104:107], v[204:207]
  v_cvt_pk_bf16_f32 v251, v190, v191
  s_waitcnt lgkmcnt(2)
  v_mfma_f32_16x16x32_bf16 v[196:199], v[212:215], v[108:111], v[196:199]
  v_accvgpr_write_b32 a0, v248
  v_mfma_f32_16x16x32_bf16 v[200:203], v[212:215], v[112:115], v[200:203]
  s_add_u32 m0, s81, 21504
  s_nop 0
  buffer_load_dwordx4 v57, s[12:15], s80 offen lds
  v_mfma_f32_16x16x32_bf16 v[204:207], v[212:215], v[116:119], v[204:207]
  v_accvgpr_write_b32 a1, v249
  s_waitcnt lgkmcnt(1)
  v_mfma_f32_16x16x32_bf16 v[196:199], v[216:219], v[120:123], v[196:199]
  v_accvgpr_write_b32 a80, v250
  v_mfma_f32_16x16x32_bf16 v[200:203], v[216:219], v[124:127], v[200:203]
  s_add_u32 m0, s81, 22528
  s_nop 0
  buffer_load_dwordx4 v58, s[12:15], s80 offen lds
  v_mfma_f32_16x16x32_bf16 v[204:207], v[216:219], v[128:131], v[204:207]
  v_accvgpr_write_b32 a81, v251
  s_waitcnt lgkmcnt(0)
  v_mfma_f32_16x16x32_bf16 v[196:199], v[220:223], v[132:135], v[196:199]
  v_cvt_pk_bf16_f32 v144, v192, v193
  v_cvt_pk_bf16_f32 v145, v194, v195
  v_mfma_f32_16x16x32_bf16 v[200:203], v[220:223], v[136:139], v[200:203]
  s_add_u32 m0, s81, 23552
  s_nop 0
  buffer_load_dwordx4 v59, s[12:15], s80 offen lds
  s_add_u32 s80, s80, 393216
  v_mfma_f32_16x16x32_bf16 v[204:207], v[220:223], v[140:143], v[204:207]
  s_waitcnt vmcnt(12)
  ds_read_b128 v[208:211], v70 offset:0
  ds_read_b128 v[212:215], v71 offset:0
  ds_read_b128 v[216:219], v70 offset:128
  s_waitcnt lgkmcnt(2)
  v_mfma_f32_16x16x32_bf16 v[184:187], v[208:211], v[72:75], 0
  ds_read_b128 v[220:223], v71 offset:128
  v_mfma_f32_16x16x32_bf16 v[188:191], v[208:211], v[76:79], 0
  s_add_u32 m0, s81, 24576
  s_nop 0
  buffer_load_dwordx4 v48, s[12:15], s80 offen lds
  v_mfma_f32_16x16x32_bf16 v[192:195], v[208:211], v[80:83], 0
  s_waitcnt lgkmcnt(2)
  v_mfma_f32_16x16x32_bf16 v[184:187], v[212:215], v[84:87], v[184:187]
  ds_read_b128 v[208:211], v70 offset:256
  v_cvt_pk_bf16_f32 v248, v196, v197
  v_mfma_f32_16x16x32_bf16 v[188:191], v[212:215], v[88:91], v[188:191]
  s_add_u32 m0, s81, 25600
  s_nop 0
  buffer_load_dwordx4 v49, s[12:15], s80 offen lds
  v_mfma_f32_16x16x32_bf16 v[192:195], v[212:215], v[92:95], v[192:195]
  v_cvt_pk_bf16_f32 v249, v198, v199
  s_waitcnt lgkmcnt(2)
  v_mfma_f32_16x16x32_bf16 v[184:187], v[216:219], v[96:99], v[184:187]
  ds_read_b128 v[212:215], v71 offset:256
  v_cvt_pk_bf16_f32 v250, v200, v201
  v_mfma_f32_16x16x32_bf16 v[188:191], v[216:219], v[100:103], v[188:191]
  s_add_u32 m0, s81, 26624
  s_nop 0
  buffer_load_dwordx4 v50, s[12:15], s80 offen lds
  v_mfma_f32_16x16x32_bf16 v[192:195], v[216:219], v[104:107], v[192:195]
  v_cvt_pk_bf16_f32 v251, v202, v203
  s_waitcnt lgkmcnt(2)
  v_mfma_f32_16x16x32_bf16 v[184:187], v[220:223], v[108:111], v[184:187]
  ds_read_b128 v[216:219], v70 offset:768
  v_accvgpr_write_b32 a2, v248
  v_mfma_f32_16x16x32_bf16 v[188:191], v[220:223], v[112:115], v[188:191]
  s_add_u32 m0, s81, 27648
  s_nop 0
  buffer_load_dwordx4 v51, s[12:15], s80 offen lds
  v_mfma_f32_16x16x32_bf16 v[192:195], v[220:223], v[116:119], v[192:195]
  v_accvgpr_write_b32 a3, v249
  s_waitcnt lgkmcnt(2)
  v_mfma_f32_16x16x32_bf16 v[184:187], v[208:211], v[120:123], v[184:187]
  ds_read_b128 v[220:223], v71 offset:768
  v_accvgpr_write_b32 a82, v250
  v_mfma_f32_16x16x32_bf16 v[188:191], v[208:211], v[124:127], v[188:191]
  s_add_u32 m0, s81, 28672
  s_nop 0
  buffer_load_dwordx4 v52, s[12:15], s80 offen lds
  v_mfma_f32_16x16x32_bf16 v[192:195], v[208:211], v[128:131], v[192:195]
  v_accvgpr_write_b32 a83, v251
  s_waitcnt lgkmcnt(2)
  v_mfma_f32_16x16x32_bf16 v[184:187], v[212:215], v[132:135], v[184:187]
  ds_read_b128 v[208:211], v70 offset:896
  s_mov_b64 exec, s[68:69]
  v_cvt_pk_bf16_f32 v144, v204, v205
  v_cvt_pk_bf16_f32 v145, v206, v207
  s_mov_b64 exec, -1
  v_mfma_f32_16x16x32_bf16 v[188:191], v[212:215], v[136:139], v[188:191]
  s_add_u32 m0, s81, 29696
  s_nop 0
  buffer_load_dwordx4 v53, s[12:15], s80 offen lds
  v_mfma_f32_16x16x32_bf16 v[192:195], v[212:215], v[140:143], v[192:195]
  s_waitcnt lgkmcnt(2)
  v_mfma_f32_16x16x32_bf16 v[196:199], v[216:219], v[72:75], 0
  ds_read_b128 v[212:215], v71 offset:896
  v_mfma_f32_16x16x32_bf16 v[200:203], v[216:219], v[76:79], 0
  s_add_u32 m0, s81, 30720
  s_nop 0
  buffer_load_dwordx4 v54, s[12:15], s80 offen lds
  v_mfma_f32_16x16x32_bf16 v[204:207], v[216:219], v[80:83], 0
  s_waitcnt lgkmcnt(2)
  v_mfma_f32_16x16x32_bf16 v[196:199], v[220:223], v[84:87], v[196:199]
  ds_read_b128 v[216:219], v70 offset:1024
  v_cvt_pk_bf16_f32 v248, v184, v185
  v_mfma_f32_16x16x32_bf16 v[200:203], v[220:223], v[88:91], v[200:203]
  s_add_u32 m0, s81, 31744
  s_nop 0
  buffer_load_dwordx4 v55, s[12:15], s80 offen lds
  v_mfma_f32_16x16x32_bf16 v[204:207], v[220:223], v[92:95], v[204:207]
  v_cvt_pk_bf16_f32 v249, v186, v187
  s_waitcnt lgkmcnt(2)
  v_mfma_f32_16x16x32_bf16 v[196:199], v[208:211], v[96:99], v[196:199]
  ds_read_b128 v[220:223], v71 offset:1024
  v_cvt_pk_bf16_f32 v250, v188, v189
  v_mfma_f32_16x16x32_bf16 v[200:203], v[208:211], v[100:103], v[200:203]
  s_add_u32 m0, s81, 32768
  s_nop 0
  buffer_load_dwordx4 v56, s[12:15], s80 offen lds
  v_mfma_f32_16x16x32_bf16 v[204:207], v[208:211], v[104:107], v[204:207]
  v_cvt_pk_bf16_f32 v251, v190, v191
  s_waitcnt lgkmcnt(2)
  v_mfma_f32_16x16x32_bf16 v[196:199], v[212:215], v[108:111], v[196:199]
  v_accvgpr_write_b32 a4, v248
  v_mfma_f32_16x16x32_bf16 v[200:203], v[212:215], v[112:115], v[200:203]
  s_add_u32 m0, s81, 33792
  s_nop 0
  buffer_load_dwordx4 v57, s[12:15], s80 offen lds
  v_mfma_f32_16x16x32_bf16 v[204:207], v[212:215], v[116:119], v[204:207]
  v_accvgpr_write_b32 a5, v249
  s_waitcnt lgkmcnt(1)
  v_mfma_f32_16x16x32_bf16 v[196:199], v[216:219], v[120:123], v[196:199]
  v_accvgpr_write_b32 a84, v250
  v_mfma_f32_16x16x32_bf16 v[200:203], v[216:219], v[124:127], v[200:203]
  s_add_u32 m0, s81, 34816
  s_nop 0
  buffer_load_dwordx4 v58, s[12:15], s80 offen lds
  v_mfma_f32_16x16x32_bf16 v[204:207], v[216:219], v[128:131], v[204:207]
  v_accvgpr_write_b32 a85, v251
  s_waitcnt lgkmcnt(0)
  v_mfma_f32_16x16x32_bf16 v[196:199], v[220:223], v[132:135], v[196:199]
  v_cvt_pk_bf16_f32 v146, v192, v193
  v_cvt_pk_bf16_f32 v147, v194, v195
  v_mfma_f32_16x16x32_bf16 v[200:203], v[220:223], v[136:139], v[200:203]
  s_add_u32 m0, s81, 35840
  s_nop 0
  buffer_load_dwordx4 v59, s[12:15], s80 offen lds
  s_add_u32 s80, s80, 393216
  v_mfma_f32_16x16x32_bf16 v[204:207], v[220:223], v[140:143], v[204:207]
  s_waitcnt vmcnt(12)
  ds_read_b128 v[208:211], v70 offset:12288
  ds_read_b128 v[212:215], v71 offset:12288
  ds_read_b128 v[216:219], v70 offset:12416
  s_waitcnt lgkmcnt(2)
  v_mfma_f32_16x16x32_bf16 v[184:187], v[208:211], v[72:75], 0
  ds_read_b128 v[220:223], v71 offset:12416
  v_mfma_f32_16x16x32_bf16 v[188:191], v[208:211], v[76:79], 0
  s_add_u32 m0, s81, 0
  s_nop 0
  buffer_load_dwordx4 v48, s[12:15], s80 offen lds
  v_mfma_f32_16x16x32_bf16 v[192:195], v[208:211], v[80:83], 0
  s_waitcnt lgkmcnt(2)
  v_mfma_f32_16x16x32_bf16 v[184:187], v[212:215], v[84:87], v[184:187]
  ds_read_b128 v[208:211], v70 offset:12544
  v_cvt_pk_bf16_f32 v248, v196, v197
  v_mfma_f32_16x16x32_bf16 v[188:191], v[212:215], v[88:91], v[188:191]
  s_add_u32 m0, s81, 1024
  s_nop 0
  buffer_load_dwordx4 v49, s[12:15], s80 offen lds
  v_mfma_f32_16x16x32_bf16 v[192:195], v[212:215], v[92:95], v[192:195]
  v_cvt_pk_bf16_f32 v249, v198, v199
  s_waitcnt lgkmcnt(2)
  v_mfma_f32_16x16x32_bf16 v[184:187], v[216:219], v[96:99], v[184:187]
  ds_read_b128 v[212:215], v71 offset:12544
  v_cvt_pk_bf16_f32 v250, v200, v201
  v_mfma_f32_16x16x32_bf16 v[188:191], v[216:219], v[100:103], v[188:191]
  s_add_u32 m0, s81, 2048
  s_nop 0
  buffer_load_dwordx4 v50, s[12:15], s80 offen lds
  v_mfma_f32_16x16x32_bf16 v[192:195], v[216:219], v[104:107], v[192:195]
  v_cvt_pk_bf16_f32 v251, v202, v203
  s_waitcnt lgkmcnt(2)
  v_mfma_f32_16x16x32_bf16 v[184:187], v[220:223], v[108:111], v[184:187]
  ds_read_b128 v[216:219], v70 offset:13056
  v_accvgpr_write_b32 a6, v248
  v_mfma_f32_16x16x32_bf16 v[188:191], v[220:223], v[112:115], v[188:191]
  s_add_u32 m0, s81, 3072
  s_nop 0
  buffer_load_dwordx4 v51, s[12:15], s80 offen lds
  v_mfma_f32_16x16x32_bf16 v[192:195], v[220:223], v[116:119], v[192:195]
  v_accvgpr_write_b32 a7, v249
  s_waitcnt lgkmcnt(2)
  v_mfma_f32_16x16x32_bf16 v[184:187], v[208:211], v[120:123], v[184:187]
  ds_read_b128 v[220:223], v71 offset:13056
  v_accvgpr_write_b32 a86, v250
  v_mfma_f32_16x16x32_bf16 v[188:191], v[208:211], v[124:127], v[188:191]
  s_add_u32 m0, s81, 4096
  s_nop 0
  buffer_load_dwordx4 v52, s[12:15], s80 offen lds
  v_mfma_f32_16x16x32_bf16 v[192:195], v[208:211], v[128:131], v[192:195]
  v_accvgpr_write_b32 a87, v251
  s_waitcnt lgkmcnt(2)
  v_mfma_f32_16x16x32_bf16 v[184:187], v[212:215], v[132:135], v[184:187]
  ds_read_b128 v[208:211], v70 offset:13184
  s_mov_b64 exec, s[68:69]
  v_cvt_pk_bf16_f32 v146, v204, v205
  v_cvt_pk_bf16_f32 v147, v206, v207
  s_mov_b64 exec, -1
  v_mfma_f32_16x16x32_bf16 v[188:191], v[212:215], v[136:139], v[188:191]
  s_add_u32 m0, s81, 5120
  s_nop 0
  buffer_load_dwordx4 v53, s[12:15], s80 offen lds
  v_mfma_f32_16x16x32_bf16 v[192:195], v[212:215], v[140:143], v[192:195]
  s_waitcnt lgkmcnt(2)
  v_mfma_f32_16x16x32_bf16 v[196:199], v[216:219], v[72:75], 0
  ds_read_b128 v[212:215], v71 offset:13184
  v_mfma_f32_16x16x32_bf16 v[200:203], v[216:219], v[76:79], 0
  s_add_u32 m0, s81, 6144
  s_nop 0
  buffer_load_dwordx4 v54, s[12:15], s80 offen lds
  v_mfma_f32_16x16x32_bf16 v[204:207], v[216:219], v[80:83], 0
  s_waitcnt lgkmcnt(2)
  v_mfma_f32_16x16x32_bf16 v[196:199], v[220:223], v[84:87], v[196:199]
  ds_read_b128 v[216:219], v70 offset:13312
  v_cvt_pk_bf16_f32 v248, v184, v185
  v_mfma_f32_16x16x32_bf16 v[200:203], v[220:223], v[88:91], v[200:203]
  s_add_u32 m0, s81, 7168
  s_nop 0
  buffer_load_dwordx4 v55, s[12:15], s80 offen lds
  v_mfma_f32_16x16x32_bf16 v[204:207], v[220:223], v[92:95], v[204:207]
  v_cvt_pk_bf16_f32 v249, v186, v187
  s_waitcnt lgkmcnt(2)
  v_mfma_f32_16x16x32_bf16 v[196:199], v[208:211], v[96:99], v[196:199]
  ds_read_b128 v[220:223], v71 offset:13312
  v_cvt_pk_bf16_f32 v250, v188, v189
  v_mfma_f32_16x16x32_bf16 v[200:203], v[208:211], v[100:103], v[200:203]
  s_add_u32 m0, s81, 8192
  s_nop 0
  buffer_load_dwordx4 v56, s[12:15], s80 offen lds
  v_mfma_f32_16x16x32_bf16 v[204:207], v[208:211], v[104:107], v[204:207]
  v_cvt_pk_bf16_f32 v251, v190, v191
  s_waitcnt lgkmcnt(2)
  v_mfma_f32_16x16x32_bf16 v[196:199], v[212:215], v[108:111], v[196:199]
  v_accvgpr_write_b32 a8, v248
  v_mfma_f32_16x16x32_bf16 v[200:203], v[212:215], v[112:115], v[200:203]
  s_add_u32 m0, s81, 9216
  s_nop 0
  buffer_load_dwordx4 v57, s[12:15], s80 offen lds
  v_mfma_f32_16x16x32_bf16 v[204:207], v[212:215], v[116:119], v[204:207]
  v_accvgpr_write_b32 a9, v249
  s_waitcnt lgkmcnt(1)
  v_mfma_f32_16x16x32_bf16 v[196:199], v[216:219], v[120:123], v[196:199]
  v_accvgpr_write_b32 a88, v250
  v_mfma_f32_16x16x32_bf16 v[200:203], v[216:219], v[124:127], v[200:203]
  s_add_u32 m0, s81, 10240
  s_nop 0
  buffer_load_dwordx4 v58, s[12:15], s80 offen lds
  v_mfma_f32_16x16x32_bf16 v[204:207], v[216:219], v[128:131], v[204:207]
  v_accvgpr_write_b32 a89, v251
  s_waitcnt lgkmcnt(0)
  v_mfma_f32_16x16x32_bf16 v[196:199], v[220:223], v[132:135], v[196:199]
  v_cvt_pk_bf16_f32 v148, v192, v193
  v_cvt_pk_bf16_f32 v149, v194, v195
  v_mfma_f32_16x16x32_bf16 v[200:203], v[220:223], v[136:139], v[200:203]
  s_add_u32 m0, s81, 11264
  s_nop 0
  buffer_load_dwordx4 v59, s[12:15], s80 offen lds
  s_add_u32 s80, s80, 393216
  v_mfma_f32_16x16x32_bf16 v[204:207], v[220:223], v[140:143], v[204:207]
  s_waitcnt vmcnt(12)
  ds_read_b128 v[208:211], v70 offset:24576
  ds_read_b128 v[212:215], v71 offset:24576
  ds_read_b128 v[216:219], v70 offset:24704
  s_waitcnt lgkmcnt(2)
  v_mfma_f32_16x16x32_bf16 v[184:187], v[208:211], v[72:75], 0
  ds_read_b128 v[220:223], v71 offset:24704
  v_mfma_f32_16x16x32_bf16 v[188:191], v[208:211], v[76:79], 0
  s_add_u32 m0, s81, 12288
  s_nop 0
  buffer_load_dwordx4 v48, s[12:15], s80 offen lds
  v_mfma_f32_16x16x32_bf16 v[192:195], v[208:211], v[80:83], 0
  s_waitcnt lgkmcnt(2)
  v_mfma_f32_16x16x32_bf16 v[184:187], v[212:215], v[84:87], v[184:187]
  ds_read_b128 v[208:211], v70 offset:24832
  v_cvt_pk_bf16_f32 v248, v196, v197
  v_mfma_f32_16x16x32_bf16 v[188:191], v[212:215], v[88:91], v[188:191]
  s_add_u32 m0, s81, 13312
  s_nop 0
  buffer_load_dwordx4 v49, s[12:15], s80 offen lds
  v_mfma_f32_16x16x32_bf16 v[192:195], v[212:215], v[92:95], v[192:195]
  v_cvt_pk_bf16_f32 v249, v198, v199
  s_waitcnt lgkmcnt(2)
  v_mfma_f32_16x16x32_bf16 v[184:187], v[216:219], v[96:99], v[184:187]
  ds_read_b128 v[212:215], v71 offset:24832
  v_cvt_pk_bf16_f32 v250, v200, v201
  v_mfma_f32_16x16x32_bf16 v[188:191], v[216:219], v[100:103], v[188:191]
  s_add_u32 m0, s81, 14336
  s_nop 0
  buffer_load_dwordx4 v50, s[12:15], s80 offen lds
  v_mfma_f32_16x16x32_bf16 v[192:195], v[216:219], v[104:107], v[192:195]
  v_cvt_pk_bf16_f32 v251, v202, v203
  s_waitcnt lgkmcnt(2)
  v_mfma_f32_16x16x32_bf16 v[184:187], v[220:223], v[108:111], v[184:187]
  ds_read_b128 v[216:219], v70 offset:25344
  v_accvgpr_write_b32 a10, v248
  v_mfma_f32_16x16x32_bf16 v[188:191], v[220:223], v[112:115], v[188:191]
  s_add_u32 m0, s81, 15360
  s_nop 0
  buffer_load_dwordx4 v51, s[12:15], s80 offen lds
  v_mfma_f32_16x16x32_bf16 v[192:195], v[220:223], v[116:119], v[192:195]
  v_accvgpr_write_b32 a11, v249
  s_waitcnt lgkmcnt(2)
  v_mfma_f32_16x16x32_bf16 v[184:187], v[208:211], v[120:123], v[184:187]
  ds_read_b128 v[220:223], v71 offset:25344
  v_accvgpr_write_b32 a90, v250
  v_mfma_f32_16x16x32_bf16 v[188:191], v[208:211], v[124:127], v[188:191]
  s_add_u32 m0, s81, 16384
  s_nop 0
  buffer_load_dwordx4 v52, s[12:15], s80 offen lds
  v_mfma_f32_16x16x32_bf16 v[192:195], v[208:211], v[128:131], v[192:195]
  v_accvgpr_write_b32 a91, v251
  s_waitcnt lgkmcnt(2)
  v_mfma_f32_16x16x32_bf16 v[184:187], v[212:215], v[132:135], v[184:187]
  ds_read_b128 v[208:211], v70 offset:25472
  s_mov_b64 exec, s[68:69]
  v_cvt_pk_bf16_f32 v148, v204, v205
  v_cvt_pk_bf16_f32 v149, v206, v207
  s_mov_b64 exec, -1
  v_mfma_f32_16x16x32_bf16 v[188:191], v[212:215], v[136:139], v[188:191]
  s_add_u32 m0, s81, 17408
  s_nop 0
  buffer_load_dwordx4 v53, s[12:15], s80 offen lds
  v_mfma_f32_16x16x32_bf16 v[192:195], v[212:215], v[140:143], v[192:195]
  s_waitcnt lgkmcnt(2)
  v_mfma_f32_16x16x32_bf16 v[196:199], v[216:219], v[72:75], 0
  ds_read_b128 v[212:215], v71 offset:25472
  v_mfma_f32_16x16x32_bf16 v[200:203], v[216:219], v[76:79], 0
  s_add_u32 m0, s81, 18432
  s_nop 0
  buffer_load_dwordx4 v54, s[12:15], s80 offen lds
  v_mfma_f32_16x16x32_bf16 v[204:207], v[216:219], v[80:83], 0
  s_waitcnt lgkmcnt(2)
  v_mfma_f32_16x16x32_bf16 v[196:199], v[220:223], v[84:87], v[196:199]
  ds_read_b128 v[216:219], v70 offset:25600
  v_cvt_pk_bf16_f32 v248, v184, v185
  v_mfma_f32_16x16x32_bf16 v[200:203], v[220:223], v[88:91], v[200:203]
  s_add_u32 m0, s81, 19456
  s_nop 0
  buffer_load_dwordx4 v55, s[12:15], s80 offen lds
  v_mfma_f32_16x16x32_bf16 v[204:207], v[220:223], v[92:95], v[204:207]
  v_cvt_pk_bf16_f32 v249, v186, v187
  s_waitcnt lgkmcnt(2)
  v_mfma_f32_16x16x32_bf16 v[196:199], v[208:211], v[96:99], v[196:199]
  ds_read_b128 v[220:223], v71 offset:25600
  v_cvt_pk_bf16_f32 v250, v188, v189
  v_mfma_f32_16x16x32_bf16 v[200:203], v[208:211], v[100:103], v[200:203]
  s_add_u32 m0, s81, 20480
  s_nop 0
  buffer_load_dwordx4 v56, s[12:15], s80 offen lds
  v_mfma_f32_16x16x32_bf16 v[204:207], v[208:211], v[104:107], v[204:207]
  v_cvt_pk_bf16_f32 v251, v190, v191
  s_waitcnt lgkmcnt(2)
  v_mfma_f32_16x16x32_bf16 v[196:199], v[212:215], v[108:111], v[196:199]
  v_accvgpr_write_b32 a12, v248
  v_mfma_f32_16x16x32_bf16 v[200:203], v[212:215], v[112:115], v[200:203]
  s_add_u32 m0, s81, 21504
  s_nop 0
  buffer_load_dwordx4 v57, s[12:15], s80 offen lds
  v_mfma_f32_16x16x32_bf16 v[204:207], v[212:215], v[116:119], v[204:207]
  v_accvgpr_write_b32 a13, v249
  s_waitcnt lgkmcnt(1)
  v_mfma_f32_16x16x32_bf16 v[196:199], v[216:219], v[120:123], v[196:199]
  v_accvgpr_write_b32 a92, v250
  v_mfma_f32_16x16x32_bf16 v[200:203], v[216:219], v[124:127], v[200:203]
  s_add_u32 m0, s81, 22528
  s_nop 0
  buffer_load_dwordx4 v58, s[12:15], s80 offen lds
  v_mfma_f32_16x16x32_bf16 v[204:207], v[216:219], v[128:131], v[204:207]
  v_accvgpr_write_b32 a93, v251
  s_waitcnt lgkmcnt(0)
  v_mfma_f32_16x16x32_bf16 v[196:199], v[220:223], v[132:135], v[196:199]
  v_cvt_pk_bf16_f32 v150, v192, v193
  v_cvt_pk_bf16_f32 v151, v194, v195
  v_mfma_f32_16x16x32_bf16 v[200:203], v[220:223], v[136:139], v[200:203]
  s_add_u32 m0, s81, 23552
  s_nop 0
  buffer_load_dwordx4 v59, s[12:15], s80 offen lds
  s_add_u32 s80, s80, 393216
  v_mfma_f32_16x16x32_bf16 v[204:207], v[220:223], v[140:143], v[204:207]
  s_waitcnt vmcnt(12)
  ds_read_b128 v[208:211], v70 offset:0
  ds_read_b128 v[212:215], v71 offset:0
  ds_read_b128 v[216:219], v70 offset:128
  s_waitcnt lgkmcnt(2)
  v_mfma_f32_16x16x32_bf16 v[184:187], v[208:211], v[72:75], 0
  ds_read_b128 v[220:223], v71 offset:128
  v_mfma_f32_16x16x32_bf16 v[188:191], v[208:211], v[76:79], 0
  s_add_u32 m0, s81, 24576
  s_nop 0
  buffer_load_dwordx4 v48, s[12:15], s80 offen lds
  v_mfma_f32_16x16x32_bf16 v[192:195], v[208:211], v[80:83], 0
  s_waitcnt lgkmcnt(2)
  v_mfma_f32_16x16x32_bf16 v[184:187], v[212:215], v[84:87], v[184:187]
  ds_read_b128 v[208:211], v70 offset:256
  v_cvt_pk_bf16_f32 v248, v196, v197
  v_mfma_f32_16x16x32_bf16 v[188:191], v[212:215], v[88:91], v[188:191]
  s_add_u32 m0, s81, 25600
  s_nop 0
  buffer_load_dwordx4 v49, s[12:15], s80 offen lds
  v_mfma_f32_16x16x32_bf16 v[192:195], v[212:215], v[92:95], v[192:195]
  v_cvt_pk_bf16_f32 v249, v198, v199
  s_waitcnt lgkmcnt(2)
  v_mfma_f32_16x16x32_bf16 v[184:187], v[216:219], v[96:99], v[184:187]
  ds_read_b128 v[212:215], v71 offset:256
  v_cvt_pk_bf16_f32 v250, v200, v201
  v_mfma_f32_16x16x32_bf16 v[188:191], v[216:219], v[100:103], v[188:191]
  s_add_u32 m0, s81, 26624
  s_nop 0
  buffer_load_dwordx4 v50, s[12:15], s80 offen lds
  v_mfma_f32_16x16x32_bf16 v[192:195], v[216:219], v[104:107], v[192:195]
  v_cvt_pk_bf16_f32 v251, v202, v203
  s_waitcnt lgkmcnt(2)
  v_mfma_f32_16x16x32_bf16 v[184:187], v[220:223], v[108:111], v[184:187]
  ds_read_b128 v[216:219], v70 offset:768
  v_accvgpr_write_b32 a14, v248
  v_mfma_f32_16x16x32_bf16 v[188:191], v[220:223], v[112:115], v[188:191]
  s_add_u32 m0, s81, 27648
  s_nop 0
  buffer_load_dwordx4 v51, s[12:15], s80 offen lds
  v_mfma_f32_16x16x32_bf16 v[192:195], v[220:223], v[116:119], v[192:195]
  v_accvgpr_write_b32 a15, v249
  s_waitcnt lgkmcnt(2)
  v_mfma_f32_16x16x32_bf16 v[184:187], v[208:211], v[120:123], v[184:187]
  ds_read_b128 v[220:223], v71 offset:768
  v_accvgpr_write_b32 a94, v250
  v_mfma_f32_16x16x32_bf16 v[188:191], v[208:211], v[124:127], v[188:191]
  s_add_u32 m0, s81, 28672
  s_nop 0
  buffer_load_dwordx4 v52, s[12:15], s80 offen lds
  v_mfma_f32_16x16x32_bf16 v[192:195], v[208:211], v[128:131], v[192:195]
  v_accvgpr_write_b32 a95, v251
  s_waitcnt lgkmcnt(2)
  v_mfma_f32_16x16x32_bf16 v[184:187], v[212:215], v[132:135], v[184:187]
  ds_read_b128 v[208:211], v70 offset:896
  s_mov_b64 exec, s[68:69]
  v_cvt_pk_bf16_f32 v150, v204, v205
  v_cvt_pk_bf16_f32 v151, v206, v207
  s_mov_b64 exec, -1
  v_mfma_f32_16x16x32_bf16 v[188:191], v[212:215], v[136:139], v[188:191]
  s_add_u32 m0, s81, 29696
  s_nop 0
  buffer_load_dwordx4 v53, s[12:15], s80 offen lds
  v_mfma_f32_16x16x32_bf16 v[192:195], v[212:215], v[140:143], v[192:195]
  s_waitcnt lgkmcnt(2)
  v_mfma_f32_16x16x32_bf16 v[196:199], v[216:219], v[72:75], 0
  ds_read_b128 v[212:215], v71 offset:896
  v_mfma_f32_16x16x32_bf16 v[200:203], v[216:219], v[76:79], 0
  s_add_u32 m0, s81, 30720
  s_nop 0
  buffer_load_dwordx4 v54, s[12:15], s80 offen lds
  v_mfma_f32_16x16x32_bf16 v[204:207], v[216:219], v[80:83], 0
  s_waitcnt lgkmcnt(2)
  v_mfma_f32_16x16x32_bf16 v[196:199], v[220:223], v[84:87], v[196:199]
  ds_read_b128 v[216:219], v70 offset:1024
  v_cvt_pk_bf16_f32 v248, v184, v185
  v_mfma_f32_16x16x32_bf16 v[200:203], v[220:223], v[88:91], v[200:203]
  s_add_u32 m0, s81, 31744
  s_nop 0
  buffer_load_dwordx4 v55, s[12:15], s80 offen lds
  v_mfma_f32_16x16x32_bf16 v[204:207], v[220:223], v[92:95], v[204:207]
  v_cvt_pk_bf16_f32 v249, v186, v187
  s_waitcnt lgkmcnt(2)
  v_mfma_f32_16x16x32_bf16 v[196:199], v[208:211], v[96:99], v[196:199]
  ds_read_b128 v[220:223], v71 offset:1024
  v_cvt_pk_bf16_f32 v250, v188, v189
  v_mfma_f32_16x16x32_bf16 v[200:203], v[208:211], v[100:103], v[200:203]
  s_add_u32 m0, s81, 32768
  s_nop 0
  buffer_load_dwordx4 v56, s[12:15], s80 offen lds
  v_mfma_f32_16x16x32_bf16 v[204:207], v[208:211], v[104:107], v[204:207]
  v_cvt_pk_bf16_f32 v251, v190, v191
  s_waitcnt lgkmcnt(2)
  v_mfma_f32_16x16x32_bf16 v[196:199], v[212:215], v[108:111], v[196:199]
  v_accvgpr_write_b32 a16, v248
  v_mfma_f32_16x16x32_bf16 v[200:203], v[212:215], v[112:115], v[200:203]
  s_add_u32 m0, s81, 33792
  s_nop 0
  buffer_load_dwordx4 v57, s[12:15], s80 offen lds
  v_mfma_f32_16x16x32_bf16 v[204:207], v[212:215], v[116:119], v[204:207]
  v_accvgpr_write_b32 a17, v249
  s_waitcnt lgkmcnt(1)
  v_mfma_f32_16x16x32_bf16 v[196:199], v[216:219], v[120:123], v[196:199]
  v_accvgpr_write_b32 a96, v250
  v_mfma_f32_16x16x32_bf16 v[200:203], v[216:219], v[124:127], v[200:203]
  s_add_u32 m0, s81, 34816
  s_nop 0
  buffer_load_dwordx4 v58, s[12:15], s80 offen lds
  v_mfma_f32_16x16x32_bf16 v[204:207], v[216:219], v[128:131], v[204:207]
  v_accvgpr_write_b32 a97, v251
  s_waitcnt lgkmcnt(0)
  v_mfma_f32_16x16x32_bf16 v[196:199], v[220:223], v[132:135], v[196:199]
  v_cvt_pk_bf16_f32 v152, v192, v193
  v_cvt_pk_bf16_f32 v153, v194, v195
  v_mfma_f32_16x16x32_bf16 v[200:203], v[220:223], v[136:139], v[200:203]
  s_add_u32 m0, s81, 35840
  s_nop 0
  buffer_load_dwordx4 v59, s[12:15], s80 offen lds
  s_add_u32 s80, s80, 393216
  v_mfma_f32_16x16x32_bf16 v[204:207], v[220:223], v[140:143], v[204:207]
  s_waitcnt vmcnt(12)
  ds_read_b128 v[208:211], v70 offset:12288
  ds_read_b128 v[212:215], v71 offset:12288
  ds_read_b128 v[216:219], v70 offset:12416
  s_waitcnt lgkmcnt(2)
  v_mfma_f32_16x16x32_bf16 v[184:187], v[208:211], v[72:75], 0
  ds_read_b128 v[220:223], v71 offset:12416
  v_mfma_f32_16x16x32_bf16 v[188:191], v[208:211], v[76:79], 0
  s_add_u32 m0, s81, 0
  s_nop 0
  buffer_load_dwordx4 v48, s[12:15], s80 offen lds
  v_mfma_f32_16x16x32_bf16 v[192:195], v[208:211], v[80:83], 0
  s_waitcnt lgkmcnt(2)
  v_mfma_f32_16x16x32_bf16 v[184:187], v[212:215], v[84:87], v[184:187]
  ds_read_b128 v[208:211], v70 offset:12544
  v_cvt_pk_bf16_f32 v248, v196, v197
  v_mfma_f32_16x16x32_bf16 v[188:191], v[212:215], v[88:91], v[188:191]
  s_add_u32 m0, s81, 1024
  s_nop 0
  buffer_load_dwordx4 v49, s[12:15], s80 offen lds
  v_mfma_f32_16x16x32_bf16 v[192:195], v[212:215], v[92:95], v[192:195]
  v_cvt_pk_bf16_f32 v249, v198, v199
  s_waitcnt lgkmcnt(2)
  v_mfma_f32_16x16x32_bf16 v[184:187], v[216:219], v[96:99], v[184:187]
  ds_read_b128 v[212:215], v71 offset:12544
  v_cvt_pk_bf16_f32 v250, v200, v201
  v_mfma_f32_16x16x32_bf16 v[188:191], v[216:219], v[100:103], v[188:191]
  s_add_u32 m0, s81, 2048
  s_nop 0
  buffer_load_dwordx4 v50, s[12:15], s80 offen lds
  v_mfma_f32_16x16x32_bf16 v[192:195], v[216:219], v[104:107], v[192:195]
  v_cvt_pk_bf16_f32 v251, v202, v203
  s_waitcnt lgkmcnt(2)
  v_mfma_f32_16x16x32_bf16 v[184:187], v[220:223], v[108:111], v[184:187]
  ds_read_b128 v[216:219], v70 offset:13056
  v_accvgpr_write_b32 a18, v248
  v_mfma_f32_16x16x32_bf16 v[188:191], v[220:223], v[112:115], v[188:191]
  s_add_u32 m0, s81, 3072
  s_nop 0
  buffer_load_dwordx4 v51, s[12:15], s80 offen lds
  v_mfma_f32_16x16x32_bf16 v[192:195], v[220:223], v[116:119], v[192:195]
  v_accvgpr_write_b32 a19, v249
  s_waitcnt lgkmcnt(2)
  v_mfma_f32_16x16x32_bf16 v[184:187], v[208:211], v[120:123], v[184:187]
  ds_read_b128 v[220:223], v71 offset:13056
  v_accvgpr_write_b32 a98, v250
  v_mfma_f32_16x16x32_bf16 v[188:191], v[208:211], v[124:127], v[188:191]
  s_add_u32 m0, s81, 4096
  s_nop 0
  buffer_load_dwordx4 v52, s[12:15], s80 offen lds
  v_mfma_f32_16x16x32_bf16 v[192:195], v[208:211], v[128:131], v[192:195]
  v_accvgpr_write_b32 a99, v251
  s_waitcnt lgkmcnt(2)
  v_mfma_f32_16x16x32_bf16 v[184:187], v[212:215], v[132:135], v[184:187]
  ds_read_b128 v[208:211], v70 offset:13184
  s_mov_b64 exec, s[68:69]
  v_cvt_pk_bf16_f32 v152, v204, v205
  v_cvt_pk_bf16_f32 v153, v206, v207
  s_mov_b64 exec, -1
  v_mfma_f32_16x16x32_bf16 v[188:191], v[212:215], v[136:139], v[188:191]
  s_add_u32 m0, s81, 5120
  s_nop 0
  buffer_load_dwordx4 v53, s[12:15], s80 offen lds
  v_mfma_f32_16x16x32_bf16 v[192:195], v[212:215], v[140:143], v[192:195]
  s_waitcnt lgkmcnt(2)
  v_mfma_f32_16x16x32_bf16 v[196:199], v[216:219], v[72:75], 0
  ds_read_b128 v[212:215], v71 offset:13184
  v_mfma_f32_16x16x32_bf16 v[200:203], v[216:219], v[76:79], 0
  s_add_u32 m0, s81, 6144
  s_nop 0
  buffer_load_dwordx4 v54, s[12:15], s80 offen lds
  v_mfma_f32_16x16x32_bf16 v[204:207], v[216:219], v[80:83], 0
  s_waitcnt lgkmcnt(2)
  v_mfma_f32_16x16x32_bf16 v[196:199], v[220:223], v[84:87], v[196:199]
  ds_read_b128 v[216:219], v70 offset:13312
  v_cvt_pk_bf16_f32 v248, v184, v185
  v_mfma_f32_16x16x32_bf16 v[200:203], v[220:223], v[88:91], v[200:203]
  s_add_u32 m0, s81, 7168
  s_nop 0
  buffer_load_dwordx4 v55, s[12:15], s80 offen lds
  v_mfma_f32_16x16x32_bf16 v[204:207], v[220:223], v[92:95], v[204:207]
  v_cvt_pk_bf16_f32 v249, v186, v187
  s_waitcnt lgkmcnt(2)
  v_mfma_f32_16x16x32_bf16 v[196:199], v[208:211], v[96:99], v[196:199]
  ds_read_b128 v[220:223], v71 offset:13312
  v_cvt_pk_bf16_f32 v250, v188, v189
  v_mfma_f32_16x16x32_bf16 v[200:203], v[208:211], v[100:103], v[200:203]
  s_add_u32 m0, s81, 8192
  s_nop 0
  buffer_load_dwordx4 v56, s[12:15], s80 offen lds
  v_mfma_f32_16x16x32_bf16 v[204:207], v[208:211], v[104:107], v[204:207]
  v_cvt_pk_bf16_f32 v251, v190, v191
  s_waitcnt lgkmcnt(2)
  v_mfma_f32_16x16x32_bf16 v[196:199], v[212:215], v[108:111], v[196:199]
  v_accvgpr_write_b32 a20, v248
  v_mfma_f32_16x16x32_bf16 v[200:203], v[212:215], v[112:115], v[200:203]
  s_add_u32 m0, s81, 9216
  s_nop 0
  buffer_load_dwordx4 v57, s[12:15], s80 offen lds
  v_mfma_f32_16x16x32_bf16 v[204:207], v[212:215], v[116:119], v[204:207]
  v_accvgpr_write_b32 a21, v249
  s_waitcnt lgkmcnt(1)
  v_mfma_f32_16x16x32_bf16 v[196:199], v[216:219], v[120:123], v[196:199]
  v_accvgpr_write_b32 a100, v250
  v_mfma_f32_16x16x32_bf16 v[200:203], v[216:219], v[124:127], v[200:203]
  s_add_u32 m0, s81, 10240
  s_nop 0
  buffer_load_dwordx4 v58, s[12:15], s80 offen lds
  v_mfma_f32_16x16x32_bf16 v[204:207], v[216:219], v[128:131], v[204:207]
  v_accvgpr_write_b32 a101, v251
  s_waitcnt lgkmcnt(0)
  v_mfma_f32_16x16x32_bf16 v[196:199], v[220:223], v[132:135], v[196:199]
  v_cvt_pk_bf16_f32 v154, v192, v193
  v_cvt_pk_bf16_f32 v155, v194, v195
  v_mfma_f32_16x16x32_bf16 v[200:203], v[220:223], v[136:139], v[200:203]
  s_add_u32 m0, s81, 11264
  s_nop 0
  buffer_load_dwordx4 v59, s[12:15], s80 offen lds
  s_add_u32 s80, s80, 393216
  v_mfma_f32_16x16x32_bf16 v[204:207], v[220:223], v[140:143], v[204:207]
  s_add_u32 s21, s79, 0
  buffer_load_dwordx4 a[172:175], v63, s[28:31], s21 offen
  s_add_u32 s21, s79, 0
  buffer_load_dwordx4 a[176:179], v64, s[28:31], s21 offen
  s_add_u32 s21, s79, 0
  buffer_load_dwordx4 a[180:183], v65, s[28:31], s21 offen
  s_waitcnt vmcnt(15)
  ds_read_b128 v[208:211], v70 offset:24576
  ds_read_b128 v[212:215], v71 offset:24576
  ds_read_b128 v[216:219], v70 offset:24704
  s_waitcnt lgkmcnt(2)
  v_mfma_f32_16x16x32_bf16 v[184:187], v[208:211], v[72:75], 0
  ds_read_b128 v[220:223], v71 offset:24704
  v_mfma_f32_16x16x32_bf16 v[188:191], v[208:211], v[76:79], 0
  s_add_u32 m0, s81, 12288
  s_nop 0
  buffer_load_dwordx4 v48, s[12:15], s80 offen lds
  v_mfma_f32_16x16x32_bf16 v[192:195], v[208:211], v[80:83], 0
  s_waitcnt lgkmcnt(2)
  v_mfma_f32_16x16x32_bf16 v[184:187], v[212:215], v[84:87], v[184:187]
  ds_read_b128 v[208:211], v70 offset:24832
  v_cvt_pk_bf16_f32 v248, v196, v197
  v_mfma_f32_16x16x32_bf16 v[188:191], v[212:215], v[88:91], v[188:191]
  s_add_u32 m0, s81, 13312
  s_nop 0
  buffer_load_dwordx4 v49, s[12:15], s80 offen lds
  v_mfma_f32_16x16x32_bf16 v[192:195], v[212:215], v[92:95], v[192:195]
  v_cvt_pk_bf16_f32 v249, v198, v199
  s_waitcnt lgkmcnt(2)
  v_mfma_f32_16x16x32_bf16 v[184:187], v[216:219], v[96:99], v[184:187]
  ds_read_b128 v[212:215], v71 offset:24832
  v_cvt_pk_bf16_f32 v250, v200, v201
  v_mfma_f32_16x16x32_bf16 v[188:191], v[216:219], v[100:103], v[188:191]
  s_add_u32 m0, s81, 14336
  s_nop 0
  buffer_load_dwordx4 v50, s[12:15], s80 offen lds
  v_mfma_f32_16x16x32_bf16 v[192:195], v[216:219], v[104:107], v[192:195]
  v_cvt_pk_bf16_f32 v251, v202, v203
  s_waitcnt lgkmcnt(2)
  v_mfma_f32_16x16x32_bf16 v[184:187], v[220:223], v[108:111], v[184:187]
  ds_read_b128 v[216:219], v70 offset:25344
  v_accvgpr_write_b32 a22, v248
  v_mfma_f32_16x16x32_bf16 v[188:191], v[220:223], v[112:115], v[188:191]
  s_add_u32 m0, s81, 15360
  s_nop 0
  buffer_load_dwordx4 v51, s[12:15], s80 offen lds
  v_mfma_f32_16x16x32_bf16 v[192:195], v[220:223], v[116:119], v[192:195]
  v_accvgpr_write_b32 a23, v249
  s_waitcnt lgkmcnt(2)
  v_mfma_f32_16x16x32_bf16 v[184:187], v[208:211], v[120:123], v[184:187]
  ds_read_b128 v[220:223], v71 offset:25344
  v_accvgpr_write_b32 a102, v250
  v_mfma_f32_16x16x32_bf16 v[188:191], v[208:211], v[124:127], v[188:191]
  s_add_u32 m0, s81, 16384
  s_nop 0
  buffer_load_dwordx4 v52, s[12:15], s80 offen lds
  v_mfma_f32_16x16x32_bf16 v[192:195], v[208:211], v[128:131], v[192:195]
  v_accvgpr_write_b32 a103, v251
  s_waitcnt lgkmcnt(2)
  v_mfma_f32_16x16x32_bf16 v[184:187], v[212:215], v[132:135], v[184:187]
  ds_read_b128 v[208:211], v70 offset:25472
  s_mov_b64 exec, s[68:69]
  v_cvt_pk_bf16_f32 v154, v204, v205
  v_cvt_pk_bf16_f32 v155, v206, v207
  s_mov_b64 exec, -1
  v_mfma_f32_16x16x32_bf16 v[188:191], v[212:215], v[136:139], v[188:191]
  s_add_u32 m0, s81, 17408
  s_nop 0
  buffer_load_dwordx4 v53, s[12:15], s80 offen lds
  v_mfma_f32_16x16x32_bf16 v[192:195], v[212:215], v[140:143], v[192:195]
  s_waitcnt lgkmcnt(2)
  v_mfma_f32_16x16x32_bf16 v[196:199], v[216:219], v[72:75], 0
  ds_read_b128 v[212:215], v71 offset:25472
  v_mfma_f32_16x16x32_bf16 v[200:203], v[216:219], v[76:79], 0
  s_add_u32 m0, s81, 18432
  s_nop 0
  buffer_load_dwordx4 v54, s[12:15], s80 offen lds
  v_mfma_f32_16x16x32_bf16 v[204:207], v[216:219], v[80:83], 0
  s_waitcnt lgkmcnt(2)
  v_mfma_f32_16x16x32_bf16 v[196:199], v[220:223], v[84:87], v[196:199]
  ds_read_b128 v[216:219], v70 offset:25600
  v_cvt_pk_bf16_f32 v248, v184, v185
  v_mfma_f32_16x16x32_bf16 v[200:203], v[220:223], v[88:91], v[200:203]
  s_add_u32 m0, s81, 19456
  s_nop 0
  buffer_load_dwordx4 v55, s[12:15], s80 offen lds
  v_mfma_f32_16x16x32_bf16 v[204:207], v[220:223], v[92:95], v[204:207]
  v_cvt_pk_bf16_f32 v249, v186, v187
  s_waitcnt lgkmcnt(2)
  v_mfma_f32_16x16x32_bf16 v[196:199], v[208:211], v[96:99], v[196:199]
  ds_read_b128 v[220:223], v71 offset:25600
  v_cvt_pk_bf16_f32 v250, v188, v189
  v_mfma_f32_16x16x32_bf16 v[200:203], v[208:211], v[100:103], v[200:203]
  s_add_u32 m0, s81, 20480
  s_nop 0
  buffer_load_dwordx4 v56, s[12:15], s80 offen lds
  v_mfma_f32_16x16x32_bf16 v[204:207], v[208:211], v[104:107], v[204:207]
  v_cvt_pk_bf16_f32 v251, v190, v191
  s_waitcnt lgkmcnt(2)
  v_mfma_f32_16x16x32_bf16 v[196:199], v[212:215], v[108:111], v[196:199]
  v_accvgpr_write_b32 a24, v248
  v_mfma_f32_16x16x32_bf16 v[200:203], v[212:215], v[112:115], v[200:203]
  s_add_u32 m0, s81, 21504
  s_nop 0
  buffer_load_dwordx4 v57, s[12:15], s80 offen lds
  v_mfma_f32_16x16x32_bf16 v[204:207], v[212:215], v[116:119], v[204:207]
  v_accvgpr_write_b32 a25, v249
  s_waitcnt lgkmcnt(1)
  v_mfma_f32_16x16x32_bf16 v[196:199], v[216:219], v[120:123], v[196:199]
  v_accvgpr_write_b32 a104, v250
  v_mfma_f32_16x16x32_bf16 v[200:203], v[216:219], v[124:127], v[200:203]
  s_add_u32 m0, s81, 22528
  s_nop 0
  buffer_load_dwordx4 v58, s[12:15], s80 offen lds
  v_mfma_f32_16x16x32_bf16 v[204:207], v[216:219], v[128:131], v[204:207]
  v_accvgpr_write_b32 a105, v251
  s_waitcnt lgkmcnt(0)
  v_mfma_f32_16x16x32_bf16 v[196:199], v[220:223], v[132:135], v[196:199]
  v_cvt_pk_bf16_f32 v156, v192, v193
  v_cvt_pk_bf16_f32 v157, v194, v195
  v_mfma_f32_16x16x32_bf16 v[200:203], v[220:223], v[136:139], v[200:203]
  s_add_u32 m0, s81, 23552
  s_nop 0
  buffer_load_dwordx4 v59, s[12:15], s80 offen lds
  s_add_u32 s80, s80, 393216
  v_mfma_f32_16x16x32_bf16 v[204:207], v[220:223], v[140:143], v[204:207]
  s_add_u32 s21, s79, 393216
  buffer_load_dwordx4 a[196:199], v63, s[28:31], s21 offen
  s_add_u32 s21, s79, 393216
  buffer_load_dwordx4 a[200:203], v64, s[28:31], s21 offen
  s_add_u32 s21, s79, 393216
  buffer_load_dwordx4 a[204:207], v65, s[28:31], s21 offen
  s_waitcnt vmcnt(18)
  ds_read_b128 v[208:211], v70 offset:0
  ds_read_b128 v[212:215], v71 offset:0
  ds_read_b128 v[216:219], v70 offset:128
  s_waitcnt lgkmcnt(2)
  v_mfma_f32_16x16x32_bf16 v[184:187], v[208:211], v[72:75], 0
  ds_read_b128 v[220:223], v71 offset:128
  v_mfma_f32_16x16x32_bf16 v[188:191], v[208:211], v[76:79], 0
  s_add_u32 m0, s81, 24576
  s_nop 0
  buffer_load_dwordx4 v48, s[12:15], s80 offen lds
  v_mfma_f32_16x16x32_bf16 v[192:195], v[208:211], v[80:83], 0
  s_waitcnt lgkmcnt(2)
  v_mfma_f32_16x16x32_bf16 v[184:187], v[212:215], v[84:87], v[184:187]
  ds_read_b128 v[208:211], v70 offset:256
  v_cvt_pk_bf16_f32 v248, v196, v197
  v_mfma_f32_16x16x32_bf16 v[188:191], v[212:215], v[88:91], v[188:191]
  s_add_u32 m0, s81, 25600
  s_nop 0
  buffer_load_dwordx4 v49, s[12:15], s80 offen lds
  v_mfma_f32_16x16x32_bf16 v[192:195], v[212:215], v[92:95], v[192:195]
  v_cvt_pk_bf16_f32 v249, v198, v199
  s_waitcnt lgkmcnt(2)
  v_mfma_f32_16x16x32_bf16 v[184:187], v[216:219], v[96:99], v[184:187]
  ds_read_b128 v[212:215], v71 offset:256
  v_cvt_pk_bf16_f32 v250, v200, v201
  v_mfma_f32_16x16x32_bf16 v[188:191], v[216:219], v[100:103], v[188:191]
  s_add_u32 m0, s81, 26624
  s_nop 0
  buffer_load_dwordx4 v50, s[12:15], s80 offen lds
  v_mfma_f32_16x16x32_bf16 v[192:195], v[216:219], v[104:107], v[192:195]
  v_cvt_pk_bf16_f32 v251, v202, v203
  s_waitcnt lgkmcnt(2)
  v_mfma_f32_16x16x32_bf16 v[184:187], v[220:223], v[108:111], v[184:187]
  ds_read_b128 v[216:219], v70 offset:768
  v_accvgpr_write_b32 a26, v248
  v_mfma_f32_16x16x32_bf16 v[188:191], v[220:223], v[112:115], v[188:191]
  s_add_u32 m0, s81, 27648
  s_nop 0
  buffer_load_dwordx4 v51, s[12:15], s80 offen lds
  v_mfma_f32_16x16x32_bf16 v[192:195], v[220:223], v[116:119], v[192:195]
  v_accvgpr_write_b32 a27, v249
  s_waitcnt lgkmcnt(2)
  v_mfma_f32_16x16x32_bf16 v[184:187], v[208:211], v[120:123], v[184:187]
  ds_read_b128 v[220:223], v71 offset:768
  v_accvgpr_write_b32 a106, v250
  v_mfma_f32_16x16x32_bf16 v[188:191], v[208:211], v[124:127], v[188:191]
  s_add_u32 m0, s81, 28672
  s_nop 0
  buffer_load_dwordx4 v52, s[12:15], s80 offen lds
  v_mfma_f32_16x16x32_bf16 v[192:195], v[208:211], v[128:131], v[192:195]
  v_accvgpr_write_b32 a107, v251
  s_waitcnt lgkmcnt(2)
  v_mfma_f32_16x16x32_bf16 v[184:187], v[212:215], v[132:135], v[184:187]
  ds_read_b128 v[208:211], v70 offset:896
  s_mov_b64 exec, s[68:69]
  v_cvt_pk_bf16_f32 v156, v204, v205
  v_cvt_pk_bf16_f32 v157, v206, v207
  s_mov_b64 exec, -1
  v_mfma_f32_16x16x32_bf16 v[188:191], v[212:215], v[136:139], v[188:191]
  s_add_u32 m0, s81, 29696
  s_nop 0
  buffer_load_dwordx4 v53, s[12:15], s80 offen lds
  v_mfma_f32_16x16x32_bf16 v[192:195], v[212:215], v[140:143], v[192:195]
  s_waitcnt lgkmcnt(2)
  v_mfma_f32_16x16x32_bf16 v[196:199], v[216:219], v[72:75], 0
  ds_read_b128 v[212:215], v71 offset:896
  v_mfma_f32_16x16x32_bf16 v[200:203], v[216:219], v[76:79], 0
  s_add_u32 m0, s81, 30720
  s_nop 0
  buffer_load_dwordx4 v54, s[12:15], s80 offen lds
  v_mfma_f32_16x16x32_bf16 v[204:207], v[216:219], v[80:83], 0
  s_waitcnt lgkmcnt(2)
  v_mfma_f32_16x16x32_bf16 v[196:199], v[220:223], v[84:87], v[196:199]
  ds_read_b128 v[216:219], v70 offset:1024
  v_cvt_pk_bf16_f32 v248, v184, v185
  v_mfma_f32_16x16x32_bf16 v[200:203], v[220:223], v[88:91], v[200:203]
  s_add_u32 m0, s81, 31744
  s_nop 0
  buffer_load_dwordx4 v55, s[12:15], s80 offen lds
  v_mfma_f32_16x16x32_bf16 v[204:207], v[220:223], v[92:95], v[204:207]
  v_cvt_pk_bf16_f32 v249, v186, v187
  s_waitcnt lgkmcnt(2)
  v_mfma_f32_16x16x32_bf16 v[196:199], v[208:211], v[96:99], v[196:199]
  ds_read_b128 v[220:223], v71 offset:1024
  v_cvt_pk_bf16_f32 v250, v188, v189
  v_mfma_f32_16x16x32_bf16 v[200:203], v[208:211], v[100:103], v[200:203]
  s_add_u32 m0, s81, 32768
  s_nop 0
  buffer_load_dwordx4 v56, s[12:15], s80 offen lds
  v_mfma_f32_16x16x32_bf16 v[204:207], v[208:211], v[104:107], v[204:207]
  v_cvt_pk_bf16_f32 v251, v190, v191
  s_waitcnt lgkmcnt(2)
  v_mfma_f32_16x16x32_bf16 v[196:199], v[212:215], v[108:111], v[196:199]
  v_accvgpr_write_b32 a28, v248
  v_mfma_f32_16x16x32_bf16 v[200:203], v[212:215], v[112:115], v[200:203]
  s_add_u32 m0, s81, 33792
  s_nop 0
  buffer_load_dwordx4 v57, s[12:15], s80 offen lds
  v_mfma_f32_16x16x32_bf16 v[204:207], v[212:215], v[116:119], v[204:207]
  v_accvgpr_write_b32 a29, v249
  s_waitcnt lgkmcnt(1)
  v_mfma_f32_16x16x32_bf16 v[196:199], v[216:219], v[120:123], v[196:199]
  v_accvgpr_write_b32 a108, v250
  v_mfma_f32_16x16x32_bf16 v[200:203], v[216:219], v[124:127], v[200:203]
  s_add_u32 m0, s81, 34816
  s_nop 0
  buffer_load_dwordx4 v58, s[12:15], s80 offen lds
  v_mfma_f32_16x16x32_bf16 v[204:207], v[216:219], v[128:131], v[204:207]
  v_accvgpr_write_b32 a109, v251
  s_waitcnt lgkmcnt(0)
  v_mfma_f32_16x16x32_bf16 v[196:199], v[220:223], v[132:135], v[196:199]
  v_cvt_pk_bf16_f32 v158, v192, v193
  v_cvt_pk_bf16_f32 v159, v194, v195
  v_mfma_f32_16x16x32_bf16 v[200:203], v[220:223], v[136:139], v[200:203]
  s_add_u32 m0, s81, 35840
  s_nop 0
  buffer_load_dwordx4 v59, s[12:15], s80 offen lds
  s_add_u32 s80, s80, 393216
  v_mfma_f32_16x16x32_bf16 v[204:207], v[220:223], v[140:143], v[204:207]
  s_add_u32 s21, s79, 786432
  buffer_load_dwordx4 a[220:223], v63, s[28:31], s21 offen
  s_add_u32 s21, s79, 786432
  buffer_load_dwordx4 a[224:227], v64, s[28:31], s21 offen
  s_add_u32 s21, s79, 786432
  buffer_load_dwordx4 a[228:231], v65, s[28:31], s21 offen
  s_waitcnt vmcnt(18)
  ds_read_b128 v[208:211], v70 offset:12288
  ds_read_b128 v[212:215], v71 offset:12288
  ds_read_b128 v[216:219], v70 offset:12416
  s_waitcnt lgkmcnt(2)
  v_mfma_f32_16x16x32_bf16 v[184:187], v[208:211], v[72:75], 0
  ds_read_b128 v[220:223], v71 offset:12416
  v_mfma_f32_16x16x32_bf16 v[188:191], v[208:211], v[76:79], 0
  s_add_u32 m0, s81, 0
  s_nop 0
  buffer_load_dwordx4 v48, s[12:15], s80 offen lds
  v_mfma_f32_16x16x32_bf16 v[192:195], v[208:211], v[80:83], 0
  s_waitcnt lgkmcnt(2)
  v_mfma_f32_16x16x32_bf16 v[184:187], v[212:215], v[84:87], v[184:187]
  ds_read_b128 v[208:211], v70 offset:12544
  v_cvt_pk_bf16_f32 v248, v196, v197
  v_mfma_f32_16x16x32_bf16 v[188:191], v[212:215], v[88:91], v[188:191]
  s_add_u32 m0, s81, 1024
  s_nop 0
  buffer_load_dwordx4 v49, s[12:15], s80 offen lds
  v_mfma_f32_16x16x32_bf16 v[192:195], v[212:215], v[92:95], v[192:195]
  v_cvt_pk_bf16_f32 v249, v198, v199
  s_waitcnt lgkmcnt(2)
  v_mfma_f32_16x16x32_bf16 v[184:187], v[216:219], v[96:99], v[184:187]
  ds_read_b128 v[212:215], v71 offset:12544
  v_cvt_pk_bf16_f32 v250, v200, v201
  v_mfma_f32_16x16x32_bf16 v[188:191], v[216:219], v[100:103], v[188:191]
  s_add_u32 m0, s81, 2048
  s_nop 0
  buffer_load_dwordx4 v50, s[12:15], s80 offen lds
  v_mfma_f32_16x16x32_bf16 v[192:195], v[216:219], v[104:107], v[192:195]
  v_cvt_pk_bf16_f32 v251, v202, v203
  s_waitcnt lgkmcnt(2)
  v_mfma_f32_16x16x32_bf16 v[184:187], v[220:223], v[108:111], v[184:187]
  ds_read_b128 v[216:219], v70 offset:13056
  v_accvgpr_write_b32 a30, v248
  v_mfma_f32_16x16x32_bf16 v[188:191], v[220:223], v[112:115], v[188:191]
  s_add_u32 m0, s81, 3072
  s_nop 0
  buffer_load_dwordx4 v51, s[12:15], s80 offen lds
  v_mfma_f32_16x16x32_bf16 v[192:195], v[220:223], v[116:119], v[192:195]
  v_accvgpr_write_b32 a31, v249
  s_waitcnt lgkmcnt(2)
  v_mfma_f32_16x16x32_bf16 v[184:187], v[208:211], v[120:123], v[184:187]
  ds_read_b128 v[220:223], v71 offset:13056
  v_accvgpr_write_b32 a110, v250
  v_mfma_f32_16x16x32_bf16 v[188:191], v[208:211], v[124:127], v[188:191]
  s_add_u32 m0, s81, 4096
  s_nop 0
  buffer_load_dwordx4 v52, s[12:15], s80 offen lds
  v_mfma_f32_16x16x32_bf16 v[192:195], v[208:211], v[128:131], v[192:195]
  v_accvgpr_write_b32 a111, v251
  s_waitcnt lgkmcnt(2)
  v_mfma_f32_16x16x32_bf16 v[184:187], v[212:215], v[132:135], v[184:187]
  ds_read_b128 v[208:211], v70 offset:13184
  s_mov_b64 exec, s[68:69]
  v_cvt_pk_bf16_f32 v158, v204, v205
  v_cvt_pk_bf16_f32 v159, v206, v207
  s_mov_b64 exec, -1
  v_mfma_f32_16x16x32_bf16 v[188:191], v[212:215], v[136:139], v[188:191]
  s_add_u32 m0, s81, 5120
  s_nop 0
  buffer_load_dwordx4 v53, s[12:15], s80 offen lds
  v_mfma_f32_16x16x32_bf16 v[192:195], v[212:215], v[140:143], v[192:195]
  s_waitcnt lgkmcnt(2)
  v_mfma_f32_16x16x32_bf16 v[196:199], v[216:219], v[72:75], 0
  ds_read_b128 v[212:215], v71 offset:13184
  v_mfma_f32_16x16x32_bf16 v[200:203], v[216:219], v[76:79], 0
  s_add_u32 m0, s81, 6144
  s_nop 0
  buffer_load_dwordx4 v54, s[12:15], s80 offen lds
  v_mfma_f32_16x16x32_bf16 v[204:207], v[216:219], v[80:83], 0
  s_waitcnt lgkmcnt(2)
  v_mfma_f32_16x16x32_bf16 v[196:199], v[220:223], v[84:87], v[196:199]
  ds_read_b128 v[216:219], v70 offset:13312
  v_cvt_pk_bf16_f32 v248, v184, v185
  v_mfma_f32_16x16x32_bf16 v[200:203], v[220:223], v[88:91], v[200:203]
  s_add_u32 m0, s81, 7168
  s_nop 0
  buffer_load_dwordx4 v55, s[12:15], s80 offen lds
  v_mfma_f32_16x16x32_bf16 v[204:207], v[220:223], v[92:95], v[204:207]
  v_cvt_pk_bf16_f32 v249, v186, v187
  s_waitcnt lgkmcnt(2)
  v_mfma_f32_16x16x32_bf16 v[196:199], v[208:211], v[96:99], v[196:199]
  ds_read_b128 v[220:223], v71 offset:13312
  v_cvt_pk_bf16_f32 v250, v188, v189
  v_mfma_f32_16x16x32_bf16 v[200:203], v[208:211], v[100:103], v[200:203]
  s_add_u32 m0, s81, 8192
  s_nop 0
  buffer_load_dwordx4 v56, s[12:15], s80 offen lds
  v_mfma_f32_16x16x32_bf16 v[204:207], v[208:211], v[104:107], v[204:207]
  v_cvt_pk_bf16_f32 v251, v190, v191
  s_waitcnt lgkmcnt(2)
  v_mfma_f32_16x16x32_bf16 v[196:199], v[212:215], v[108:111], v[196:199]
  v_accvgpr_write_b32 a32, v248
  v_mfma_f32_16x16x32_bf16 v[200:203], v[212:215], v[112:115], v[200:203]
  s_add_u32 m0, s81, 9216
  s_nop 0
  buffer_load_dwordx4 v57, s[12:15], s80 offen lds
  v_mfma_f32_16x16x32_bf16 v[204:207], v[212:215], v[116:119], v[204:207]
  v_accvgpr_write_b32 a33, v249
  s_waitcnt lgkmcnt(1)
  v_mfma_f32_16x16x32_bf16 v[196:199], v[216:219], v[120:123], v[196:199]
  v_accvgpr_write_b32 a112, v250
  v_mfma_f32_16x16x32_bf16 v[200:203], v[216:219], v[124:127], v[200:203]
  s_add_u32 m0, s81, 10240
  s_nop 0
  buffer_load_dwordx4 v58, s[12:15], s80 offen lds
  v_mfma_f32_16x16x32_bf16 v[204:207], v[216:219], v[128:131], v[204:207]
  v_accvgpr_write_b32 a113, v251
  s_waitcnt lgkmcnt(0)
  v_mfma_f32_16x16x32_bf16 v[196:199], v[220:223], v[132:135], v[196:199]
  v_cvt_pk_bf16_f32 v160, v192, v193
  v_cvt_pk_bf16_f32 v161, v194, v195
  v_mfma_f32_16x16x32_bf16 v[200:203], v[220:223], v[136:139], v[200:203]
  s_add_u32 m0, s81, 11264
  s_nop 0
  buffer_load_dwordx4 v59, s[12:15], s80 offen lds
  s_add_u32 s80, s80, 393216
  v_mfma_f32_16x16x32_bf16 v[204:207], v[220:223], v[140:143], v[204:207]
  s_add_u32 s21, s79, 1179648
  buffer_load_dwordx4 a[244:247], v63, s[28:31], s21 offen
  s_add_u32 s21, s79, 1179648
  buffer_load_dwordx4 a[248:251], v64, s[28:31], s21 offen
  s_add_u32 s21, s79, 1179648
  buffer_load_dwordx4 a[252:255], v65, s[28:31], s21 offen
  s_waitcnt vmcnt(18)
  ds_read_b128 v[208:211], v70 offset:24576
  ds_read_b128 v[212:215], v71 offset:24576
  ds_read_b128 v[216:219], v70 offset:24704
  s_waitcnt lgkmcnt(2)
  v_mfma_f32_16x16x32_bf16 v[184:187], v[208:211], v[72:75], 0
  ds_read_b128 v[220:223], v71 offset:24704
  v_mfma_f32_16x16x32_bf16 v[188:191], v[208:211], v[76:79], 0
  s_add_u32 m0, s81, 12288
  s_nop 0
  buffer_load_dwordx4 v48, s[12:15], s80 offen lds
  v_mfma_f32_16x16x32_bf16 v[192:195], v[208:211], v[80:83], 0
  s_waitcnt lgkmcnt(2)
  v_mfma_f32_16x16x32_bf16 v[184:187], v[212:215], v[84:87], v[184:187]
  ds_read_b128 v[208:211], v70 offset:24832
  v_cvt_pk_bf16_f32 v248, v196, v197
  v_mfma_f32_16x16x32_bf16 v[188:191], v[212:215], v[88:91], v[188:191]
  s_add_u32 m0, s81, 13312
  s_nop 0
  buffer_load_dwordx4 v49, s[12:15], s80 offen lds
  v_mfma_f32_16x16x32_bf16 v[192:195], v[212:215], v[92:95], v[192:195]
  v_cvt_pk_bf16_f32 v249, v198, v199
  s_waitcnt lgkmcnt(2)
  v_mfma_f32_16x16x32_bf16 v[184:187], v[216:219], v[96:99], v[184:187]
  ds_read_b128 v[212:215], v71 offset:24832
  v_cvt_pk_bf16_f32 v250, v200, v201
  v_mfma_f32_16x16x32_bf16 v[188:191], v[216:219], v[100:103], v[188:191]
  s_add_u32 m0, s81, 14336
  s_nop 0
  buffer_load_dwordx4 v50, s[12:15], s80 offen lds
  v_mfma_f32_16x16x32_bf16 v[192:195], v[216:219], v[104:107], v[192:195]
  v_cvt_pk_bf16_f32 v251, v202, v203
  s_waitcnt lgkmcnt(2)
  v_mfma_f32_16x16x32_bf16 v[184:187], v[220:223], v[108:111], v[184:187]
  ds_read_b128 v[216:219], v70 offset:25344
  v_accvgpr_write_b32 a34, v248
  v_mfma_f32_16x16x32_bf16 v[188:191], v[220:223], v[112:115], v[188:191]
  s_add_u32 m0, s81, 15360
  s_nop 0
  buffer_load_dwordx4 v51, s[12:15], s80 offen lds
  v_mfma_f32_16x16x32_bf16 v[192:195], v[220:223], v[116:119], v[192:195]
  v_accvgpr_write_b32 a35, v249
  s_waitcnt lgkmcnt(2)
  v_mfma_f32_16x16x32_bf16 v[184:187], v[208:211], v[120:123], v[184:187]
  ds_read_b128 v[220:223], v71 offset:25344
  v_accvgpr_write_b32 a114, v250
  v_mfma_f32_16x16x32_bf16 v[188:191], v[208:211], v[124:127], v[188:191]
  s_add_u32 m0, s81, 16384
  s_nop 0
  buffer_load_dwordx4 v52, s[12:15], s80 offen lds
  v_mfma_f32_16x16x32_bf16 v[192:195], v[208:211], v[128:131], v[192:195]
  v_accvgpr_write_b32 a115, v251
  s_waitcnt lgkmcnt(2)
  v_mfma_f32_16x16x32_bf16 v[184:187], v[212:215], v[132:135], v[184:187]
  ds_read_b128 v[208:211], v70 offset:25472
  s_mov_b64 exec, s[68:69]
  v_cvt_pk_bf16_f32 v160, v204, v205
  v_cvt_pk_bf16_f32 v161, v206, v207
  s_mov_b64 exec, -1
  v_mfma_f32_16x16x32_bf16 v[188:191], v[212:215], v[136:139], v[188:191]
  s_add_u32 m0, s81, 17408
  s_nop 0
  buffer_load_dwordx4 v53, s[12:15], s80 offen lds
  v_mfma_f32_16x16x32_bf16 v[192:195], v[212:215], v[140:143], v[192:195]
  s_waitcnt lgkmcnt(2)
  v_mfma_f32_16x16x32_bf16 v[196:199], v[216:219], v[72:75], 0
  ds_read_b128 v[212:215], v71 offset:25472
  v_mfma_f32_16x16x32_bf16 v[200:203], v[216:219], v[76:79], 0
  s_add_u32 m0, s81, 18432
  s_nop 0
  buffer_load_dwordx4 v54, s[12:15], s80 offen lds
  v_mfma_f32_16x16x32_bf16 v[204:207], v[216:219], v[80:83], 0
  s_waitcnt lgkmcnt(2)
  v_mfma_f32_16x16x32_bf16 v[196:199], v[220:223], v[84:87], v[196:199]
  ds_read_b128 v[216:219], v70 offset:25600
  v_cvt_pk_bf16_f32 v248, v184, v185
  v_mfma_f32_16x16x32_bf16 v[200:203], v[220:223], v[88:91], v[200:203]
  s_add_u32 m0, s81, 19456
  s_nop 0
  buffer_load_dwordx4 v55, s[12:15], s80 offen lds
  v_mfma_f32_16x16x32_bf16 v[204:207], v[220:223], v[92:95], v[204:207]
  v_cvt_pk_bf16_f32 v249, v186, v187
  s_waitcnt lgkmcnt(2)
  v_mfma_f32_16x16x32_bf16 v[196:199], v[208:211], v[96:99], v[196:199]
  ds_read_b128 v[220:223], v71 offset:25600
  v_cvt_pk_bf16_f32 v250, v188, v189
  v_mfma_f32_16x16x32_bf16 v[200:203], v[208:211], v[100:103], v[200:203]
  s_add_u32 m0, s81, 20480
  s_nop 0
  buffer_load_dwordx4 v56, s[12:15], s80 offen lds
  v_mfma_f32_16x16x32_bf16 v[204:207], v[208:211], v[104:107], v[204:207]
  v_cvt_pk_bf16_f32 v251, v190, v191
  s_waitcnt lgkmcnt(2)
  v_mfma_f32_16x16x32_bf16 v[196:199], v[212:215], v[108:111], v[196:199]
  v_accvgpr_write_b32 a36, v248
  v_mfma_f32_16x16x32_bf16 v[200:203], v[212:215], v[112:115], v[200:203]
  s_add_u32 m0, s81, 21504
  s_nop 0
  buffer_load_dwordx4 v57, s[12:15], s80 offen lds
  v_mfma_f32_16x16x32_bf16 v[204:207], v[212:215], v[116:119], v[204:207]
  v_accvgpr_write_b32 a37, v249
  s_waitcnt lgkmcnt(1)
  v_mfma_f32_16x16x32_bf16 v[196:199], v[216:219], v[120:123], v[196:199]
  v_accvgpr_write_b32 a116, v250
  v_mfma_f32_16x16x32_bf16 v[200:203], v[216:219], v[124:127], v[200:203]
  s_add_u32 m0, s81, 22528
  s_nop 0
  buffer_load_dwordx4 v58, s[12:15], s80 offen lds
  v_mfma_f32_16x16x32_bf16 v[204:207], v[216:219], v[128:131], v[204:207]
  v_accvgpr_write_b32 a117, v251
  s_waitcnt lgkmcnt(0)
  v_mfma_f32_16x16x32_bf16 v[196:199], v[220:223], v[132:135], v[196:199]
  v_cvt_pk_bf16_f32 v162, v192, v193
  v_cvt_pk_bf16_f32 v163, v194, v195
  v_mfma_f32_16x16x32_bf16 v[200:203], v[220:223], v[136:139], v[200:203]
  s_add_u32 m0, s81, 23552
  s_nop 0
  buffer_load_dwordx4 v59, s[12:15], s80 offen lds
  s_add_u32 s80, s80, 393216
  v_mfma_f32_16x16x32_bf16 v[204:207], v[220:223], v[140:143], v[204:207]
  s_add_u32 s21, s79, 1572864
  buffer_load_dwordx4 v[236:239], v63, s[28:31], s21 offen
  s_add_u32 s21, s79, 1572864
  buffer_load_dwordx4 v[240:243], v64, s[28:31], s21 offen
  s_add_u32 s21, s79, 1572864
  buffer_load_dwordx4 v[244:247], v65, s[28:31], s21 offen
  s_waitcnt vmcnt(18)
  ds_read_b128 v[208:211], v70 offset:0
  ds_read_b128 v[212:215], v71 offset:0
  ds_read_b128 v[216:219], v70 offset:128
  s_waitcnt lgkmcnt(2)
  v_mfma_f32_16x16x32_bf16 v[184:187], v[208:211], v[72:75], 0
  ds_read_b128 v[220:223], v71 offset:128
  v_mfma_f32_16x16x32_bf16 v[188:191], v[208:211], v[76:79], 0
  s_add_u32 m0, s81, 24576
  s_nop 0
  buffer_load_dwordx4 v48, s[12:15], s80 offen lds
  ds_write_b64 v69, v[144:145] offset:36864
  v_mfma_f32_16x16x32_bf16 v[192:195], v[208:211], v[80:83], 0
  s_waitcnt lgkmcnt(3)
  v_mfma_f32_16x16x32_bf16 v[184:187], v[212:215], v[84:87], v[184:187]
  ds_read_b128 v[208:211], v70 offset:256
  v_cvt_pk_bf16_f32 v248, v196, v197
  v_mfma_f32_16x16x32_bf16 v[188:191], v[212:215], v[88:91], v[188:191]
  s_add_u32 m0, s81, 25600
  s_nop 0
  buffer_load_dwordx4 v49, s[12:15], s80 offen lds
  ds_write_b64 v69, v[146:147] offset:37376
  v_mfma_f32_16x16x32_bf16 v[192:195], v[212:215], v[92:95], v[192:195]
  v_cvt_pk_bf16_f32 v249, v198, v199
  s_waitcnt lgkmcnt(4)
  v_mfma_f32_16x16x32_bf16 v[184:187], v[216:219], v[96:99], v[184:187]
  ds_read_b128 v[212:215], v71 offset:256
  v_cvt_pk_bf16_f32 v250, v200, v201
  v_mfma_f32_16x16x32_bf16 v[188:191], v[216:219], v[100:103], v[188:191]
  s_add_u32 m0, s81, 26624
  s_nop 0
  buffer_load_dwordx4 v50, s[12:15], s80 offen lds
  ds_write_b64 v69, v[148:149] offset:37888
  v_mfma_f32_16x16x32_bf16 v[192:195], v[216:219], v[104:107], v[192:195]
  v_cvt_pk_bf16_f32 v251, v202, v203
  s_waitcnt lgkmcnt(5)
  v_mfma_f32_16x16x32_bf16 v[184:187], v[220:223], v[108:111], v[184:187]
  ds_read_b128 v[216:219], v70 offset:768
  v_accvgpr_write_b32 a38, v248
  v_mfma_f32_16x16x32_bf16 v[188:191], v[220:223], v[112:115], v[188:191]
  s_add_u32 m0, s81, 27648
  s_nop 0
  buffer_load_dwordx4 v51, s[12:15], s80 offen lds
  ds_write_b64 v69, v[150:151] offset:38400
  v_mfma_f32_16x16x32_bf16 v[192:195], v[220:223], v[116:119], v[192:195]
  v_accvgpr_write_b32 a39, v249
  s_waitcnt lgkmcnt(5)
  v_mfma_f32_16x16x32_bf16 v[184:187], v[208:211], v[120:123], v[184:187]
  ds_read_b128 v[220:223], v71 offset:768
  v_accvgpr_write_b32 a118, v250
  v_mfma_f32_16x16x32_bf16 v[188:191], v[208:211], v[124:127], v[188:191]
  s_add_u32 m0, s81, 28672
  s_nop 0
  buffer_load_dwordx4 v52, s[12:15], s80 offen lds
  ds_write_b64 v69, v[152:153] offset:38912
  v_mfma_f32_16x16x32_bf16 v[192:195], v[208:211], v[128:131], v[192:195]
  v_accvgpr_write_b32 a119, v251
  s_waitcnt lgkmcnt(5)
  v_mfma_f32_16x16x32_bf16 v[184:187], v[212:215], v[132:135], v[184:187]
  ds_read_b128 v[208:211], v70 offset:896
  s_mov_b64 exec, s[68:69]
  v_cvt_pk_bf16_f32 v162, v204, v205
  v_cvt_pk_bf16_f32 v163, v206, v207
  s_mov_b64 exec, -1
  v_mfma_f32_16x16x32_bf16 v[188:191], v[212:215], v[136:139], v[188:191]
  s_add_u32 m0, s81, 29696
  s_nop 0
  buffer_load_dwordx4 v53, s[12:15], s80 offen lds
  ds_write_b64 v69, v[154:155] offset:39424
  v_mfma_f32_16x16x32_bf16 v[192:195], v[212:215], v[140:143], v[192:195]
  s_waitcnt lgkmcnt(5)
  v_mfma_f32_16x16x32_bf16 v[196:199], v[216:219], v[72:75], 0
  ds_read_b128 v[212:215], v71 offset:896
  v_mfma_f32_16x16x32_bf16 v[200:203], v[216:219], v[76:79], 0
  s_add_u32 m0, s81, 30720
  s_nop 0
  buffer_load_dwordx4 v54, s[12:15], s80 offen lds
  ds_write_b64 v69, v[156:157] offset:39936
  v_mfma_f32_16x16x32_bf16 v[204:207], v[216:219], v[80:83], 0
  s_waitcnt lgkmcnt(5)
  v_mfma_f32_16x16x32_bf16 v[196:199], v[220:223], v[84:87], v[196:199]
  ds_read_b128 v[216:219], v70 offset:1024
  v_cvt_pk_bf16_f32 v248, v184, v185
  v_mfma_f32_16x16x32_bf16 v[200:203], v[220:223], v[88:91], v[200:203]
  s_add_u32 m0, s81, 31744
  s_nop 0
  buffer_load_dwordx4 v55, s[12:15], s80 offen lds
  ds_write_b64 v69, v[158:159] offset:40448
  v_mfma_f32_16x16x32_bf16 v[204:207], v[220:223], v[92:95], v[204:207]
  v_cvt_pk_bf16_f32 v249, v186, v187
  s_waitcnt lgkmcnt(5)
  v_mfma_f32_16x16x32_bf16 v[196:199], v[208:211], v[96:99], v[196:199]
  ds_read_b128 v[220:223], v71 offset:1024
  v_cvt_pk_bf16_f32 v250, v188, v189
  v_mfma_f32_16x16x32_bf16 v[200:203], v[208:211], v[100:103], v[200:203]
  s_add_u32 m0, s81, 32768
  s_nop 0
  buffer_load_dwordx4 v56, s[12:15], s80 offen lds
  v_mfma_f32_16x16x32_bf16 v[204:207], v[208:211], v[104:107], v[204:207]
  v_cvt_pk_bf16_f32 v251, v190, v191
  s_waitcnt lgkmcnt(4)
  v_mfma_f32_16x16x32_bf16 v[196:199], v[212:215], v[108:111], v[196:199]
  v_accvgpr_write_b32 a40, v248
  v_mfma_f32_16x16x32_bf16 v[200:203], v[212:215], v[112:115], v[200:203]
  s_add_u32 m0, s81, 33792
  s_nop 0
  buffer_load_dwordx4 v57, s[12:15], s80 offen lds
  v_mfma_f32_16x16x32_bf16 v[204:207], v[212:215], v[116:119], v[204:207]
  v_accvgpr_write_b32 a41, v249
  s_waitcnt lgkmcnt(2)
  v_mfma_f32_16x16x32_bf16 v[196:199], v[216:219], v[120:123], v[196:199]
  v_accvgpr_write_b32 a120, v250
  v_mfma_f32_16x16x32_bf16 v[200:203], v[216:219], v[124:127], v[200:203]
  s_add_u32 m0, s81, 34816
  s_nop 0
  buffer_load_dwordx4 v58, s[12:15], s80 offen lds
  v_mfma_f32_16x16x32_bf16 v[204:207], v[216:219], v[128:131], v[204:207]
  v_accvgpr_write_b32 a121, v251
  s_waitcnt lgkmcnt(0)
  v_mfma_f32_16x16x32_bf16 v[196:199], v[220:223], v[132:135], v[196:199]
  v_cvt_pk_bf16_f32 v164, v192, v193
  v_cvt_pk_bf16_f32 v165, v194, v195
  v_mfma_f32_16x16x32_bf16 v[200:203], v[220:223], v[136:139], v[200:203]
  s_add_u32 m0, s81, 35840
  s_nop 0
  buffer_load_dwordx4 v59, s[12:15], s80 offen lds
  s_add_u32 s80, s80, 393216
  v_mfma_f32_16x16x32_bf16 v[204:207], v[220:223], v[140:143], v[204:207]
  s_add_u32 s21, s79, 0
  buffer_load_dwordx4 a[160:163], v63, s[24:27], s21 offen
  s_add_u32 s21, s79, 0
  buffer_load_dwordx4 a[164:167], v64, s[24:27], s21 offen
  s_add_u32 s21, s79, 0
  buffer_load_dwordx4 a[168:171], v65, s[24:27], s21 offen
  s_waitcnt vmcnt(18)
  ds_read_b128 v[208:211], v70 offset:12288
  ds_read_b128 v[212:215], v71 offset:12288
  ds_read_b128 v[216:219], v70 offset:12416
  s_waitcnt lgkmcnt(2)
  v_mfma_f32_16x16x32_bf16 v[184:187], v[208:211], v[72:75], 0
  ds_read_b128 v[220:223], v71 offset:12416
  v_mfma_f32_16x16x32_bf16 v[188:191], v[208:211], v[76:79], 0
  s_add_u32 m0, s81, 0
  s_nop 0
  buffer_load_dwordx4 v48, s[12:15], s80 offen lds
  v_mfma_f32_16x16x32_bf16 v[192:195], v[208:211], v[80:83], 0
  s_waitcnt lgkmcnt(2)
  v_mfma_f32_16x16x32_bf16 v[184:187], v[212:215], v[84:87], v[184:187]
  ds_read_b128 v[208:211], v70 offset:12544
  v_cvt_pk_bf16_f32 v248, v196, v197
  v_mfma_f32_16x16x32_bf16 v[188:191], v[212:215], v[88:91], v[188:191]
  s_add_u32 m0, s81, 1024
  s_nop 0
  buffer_load_dwordx4 v49, s[12:15], s80 offen lds
  v_mfma_f32_16x16x32_bf16 v[192:195], v[212:215], v[92:95], v[192:195]
  v_cvt_pk_bf16_f32 v249, v198, v199
  s_waitcnt lgkmcnt(2)
  v_mfma_f32_16x16x32_bf16 v[184:187], v[216:219], v[96:99], v[184:187]
  ds_read_b128 v[212:215], v71 offset:12544
  v_cvt_pk_bf16_f32 v250, v200, v201
  v_mfma_f32_16x16x32_bf16 v[188:191], v[216:219], v[100:103], v[188:191]
  s_add_u32 m0, s81, 2048
  s_nop 0
  buffer_load_dwordx4 v50, s[12:15], s80 offen lds
  v_mfma_f32_16x16x32_bf16 v[192:195], v[216:219], v[104:107], v[192:195]
  v_cvt_pk_bf16_f32 v251, v202, v203
  s_waitcnt lgkmcnt(2)
  v_mfma_f32_16x16x32_bf16 v[184:187], v[220:223], v[108:111], v[184:187]
  ds_read_b128 v[216:219], v70 offset:13056
  v_accvgpr_write_b32 a42, v248
  v_mfma_f32_16x16x32_bf16 v[188:191], v[220:223], v[112:115], v[188:191]
  s_add_u32 m0, s81, 3072
  s_nop 0
  buffer_load_dwordx4 v51, s[12:15], s80 offen lds
  v_mfma_f32_16x16x32_bf16 v[192:195], v[220:223], v[116:119], v[192:195]
  v_accvgpr_write_b32 a43, v249
  s_waitcnt lgkmcnt(2)
  v_mfma_f32_16x16x32_bf16 v[184:187], v[208:211], v[120:123], v[184:187]
  ds_read_b128 v[220:223], v71 offset:13056
  v_accvgpr_write_b32 a122, v250
  v_mfma_f32_16x16x32_bf16 v[188:191], v[208:211], v[124:127], v[188:191]
  s_add_u32 m0, s81, 4096
  s_nop 0
  buffer_load_dwordx4 v52, s[12:15], s80 offen lds
  v_mfma_f32_16x16x32_bf16 v[192:195], v[208:211], v[128:131], v[192:195]
  v_accvgpr_write_b32 a123, v251
  s_waitcnt lgkmcnt(2)
  v_mfma_f32_16x16x32_bf16 v[184:187], v[212:215], v[132:135], v[184:187]
  ds_read_b128 v[208:211], v70 offset:13184
  s_mov_b64 exec, s[68:69]
  v_cvt_pk_bf16_f32 v164, v204, v205
  v_cvt_pk_bf16_f32 v165, v206, v207
  s_mov_b64 exec, -1
  v_mfma_f32_16x16x32_bf16 v[188:191], v[212:215], v[136:139], v[188:191]
  s_add_u32 m0, s81, 5120
  s_nop 0
  buffer_load_dwordx4 v53, s[12:15], s80 offen lds
  v_mfma_f32_16x16x32_bf16 v[192:195], v[212:215], v[140:143], v[192:195]
  s_waitcnt lgkmcnt(2)
  v_mfma_f32_16x16x32_bf16 v[196:199], v[216:219], v[72:75], 0
  ds_read_b128 v[212:215], v71 offset:13184
  v_mfma_f32_16x16x32_bf16 v[200:203], v[216:219], v[76:79], 0
  s_add_u32 m0, s81, 6144
  s_nop 0
  buffer_load_dwordx4 v54, s[12:15], s80 offen lds
  v_mfma_f32_16x16x32_bf16 v[204:207], v[216:219], v[80:83], 0
  s_waitcnt lgkmcnt(2)
  v_mfma_f32_16x16x32_bf16 v[196:199], v[220:223], v[84:87], v[196:199]
  ds_read_b128 v[216:219], v70 offset:13312
  v_cvt_pk_bf16_f32 v248, v184, v185
  v_mfma_f32_16x16x32_bf16 v[200:203], v[220:223], v[88:91], v[200:203]
  s_add_u32 m0, s81, 7168
  s_nop 0
  buffer_load_dwordx4 v55, s[12:15], s80 offen lds
  v_mfma_f32_16x16x32_bf16 v[204:207], v[220:223], v[92:95], v[204:207]
  v_cvt_pk_bf16_f32 v249, v186, v187
  s_waitcnt lgkmcnt(2)
  v_mfma_f32_16x16x32_bf16 v[196:199], v[208:211], v[96:99], v[196:199]
  ds_read_b128 v[220:223], v71 offset:13312
  v_cvt_pk_bf16_f32 v250, v188, v189
  v_mfma_f32_16x16x32_bf16 v[200:203], v[208:211], v[100:103], v[200:203]
  s_add_u32 m0, s81, 8192
  s_nop 0
  buffer_load_dwordx4 v56, s[12:15], s80 offen lds
  v_mfma_f32_16x16x32_bf16 v[204:207], v[208:211], v[104:107], v[204:207]
  v_cvt_pk_bf16_f32 v251, v190, v191
  s_waitcnt lgkmcnt(2)
  v_mfma_f32_16x16x32_bf16 v[196:199], v[212:215], v[108:111], v[196:199]
  v_accvgpr_write_b32 a44, v248
  v_mfma_f32_16x16x32_bf16 v[200:203], v[212:215], v[112:115], v[200:203]
  s_add_u32 m0, s81, 9216
  s_nop 0
  buffer_load_dwordx4 v57, s[12:15], s80 offen lds
  v_mfma_f32_16x16x32_bf16 v[204:207], v[212:215], v[116:119], v[204:207]
  v_accvgpr_write_b32 a45, v249
  s_waitcnt lgkmcnt(1)
  v_mfma_f32_16x16x32_bf16 v[196:199], v[216:219], v[120:123], v[196:199]
  v_accvgpr_write_b32 a124, v250
  v_mfma_f32_16x16x32_bf16 v[200:203], v[216:219], v[124:127], v[200:203]
  s_add_u32 m0, s81, 10240
  s_nop 0
  buffer_load_dwordx4 v58, s[12:15], s80 offen lds
  v_mfma_f32_16x16x32_bf16 v[204:207], v[216:219], v[128:131], v[204:207]
  v_accvgpr_write_b32 a125, v251
  s_waitcnt lgkmcnt(0)
  v_mfma_f32_16x16x32_bf16 v[196:199], v[220:223], v[132:135], v[196:199]
  v_cvt_pk_bf16_f32 v166, v192, v193
  v_cvt_pk_bf16_f32 v167, v194, v195
  v_mfma_f32_16x16x32_bf16 v[200:203], v[220:223], v[136:139], v[200:203]
  s_add_u32 m0, s81, 11264
  s_nop 0
  buffer_load_dwordx4 v59, s[12:15], s80 offen lds
  s_add_u32 s80, s80, 393216
  v_mfma_f32_16x16x32_bf16 v[204:207], v[220:223], v[140:143], v[204:207]
  s_add_u32 s21, s79, 393216
  buffer_load_dwordx4 a[184:187], v63, s[24:27], s21 offen
  s_add_u32 s21, s79, 393216
  buffer_load_dwordx4 a[188:191], v64, s[24:27], s21 offen
  s_add_u32 s21, s79, 393216
  buffer_load_dwordx4 a[192:195], v65, s[24:27], s21 offen
  s_waitcnt vmcnt(18)
  ds_read_b128 v[208:211], v70 offset:24576
  ds_read_b128 v[212:215], v71 offset:24576
  ds_read_b128 v[216:219], v70 offset:24704
  s_waitcnt lgkmcnt(2)
  v_mfma_f32_16x16x32_bf16 v[184:187], v[208:211], v[72:75], 0
  ds_read_b128 v[220:223], v71 offset:24704
  v_mfma_f32_16x16x32_bf16 v[188:191], v[208:211], v[76:79], 0
  s_add_u32 m0, s81, 12288
  s_nop 0
  buffer_load_dwordx4 v48, s[12:15], s80 offen lds
  v_mfma_f32_16x16x32_bf16 v[192:195], v[208:211], v[80:83], 0
  s_waitcnt lgkmcnt(2)
  v_mfma_f32_16x16x32_bf16 v[184:187], v[212:215], v[84:87], v[184:187]
  ds_read_b128 v[208:211], v70 offset:24832
  v_cvt_pk_bf16_f32 v248, v196, v197
  v_mfma_f32_16x16x32_bf16 v[188:191], v[212:215], v[88:91], v[188:191]
  s_add_u32 m0, s81, 13312
  s_nop 0
  buffer_load_dwordx4 v49, s[12:15], s80 offen lds
  v_mfma_f32_16x16x32_bf16 v[192:195], v[212:215], v[92:95], v[192:195]
  v_cvt_pk_bf16_f32 v249, v198, v199
  s_waitcnt lgkmcnt(2)
  v_mfma_f32_16x16x32_bf16 v[184:187], v[216:219], v[96:99], v[184:187]
  ds_read_b128 v[212:215], v71 offset:24832
  v_cvt_pk_bf16_f32 v250, v200, v201
  v_mfma_f32_16x16x32_bf16 v[188:191], v[216:219], v[100:103], v[188:191]
  s_add_u32 m0, s81, 14336
  s_nop 0
  buffer_load_dwordx4 v50, s[12:15], s80 offen lds
  v_mfma_f32_16x16x32_bf16 v[192:195], v[216:219], v[104:107], v[192:195]
  v_cvt_pk_bf16_f32 v251, v202, v203
  s_waitcnt lgkmcnt(2)
  v_mfma_f32_16x16x32_bf16 v[184:187], v[220:223], v[108:111], v[184:187]
  ds_read_b128 v[216:219], v70 offset:25344
  v_accvgpr_write_b32 a46, v248
  v_mfma_f32_16x16x32_bf16 v[188:191], v[220:223], v[112:115], v[188:191]
  s_add_u32 m0, s81, 15360
  s_nop 0
  buffer_load_dwordx4 v51, s[12:15], s80 offen lds
  v_mfma_f32_16x16x32_bf16 v[192:195], v[220:223], v[116:119], v[192:195]
  v_accvgpr_write_b32 a47, v249
  s_waitcnt lgkmcnt(2)
  v_mfma_f32_16x16x32_bf16 v[184:187], v[208:211], v[120:123], v[184:187]
  ds_read_b128 v[220:223], v71 offset:25344
  v_accvgpr_write_b32 a126, v250
  v_mfma_f32_16x16x32_bf16 v[188:191], v[208:211], v[124:127], v[188:191]
  s_add_u32 m0, s81, 16384
  s_nop 0
  buffer_load_dwordx4 v52, s[12:15], s80 offen lds
  v_mfma_f32_16x16x32_bf16 v[192:195], v[208:211], v[128:131], v[192:195]
  v_accvgpr_write_b32 a127, v251
  s_waitcnt lgkmcnt(2)
  v_mfma_f32_16x16x32_bf16 v[184:187], v[212:215], v[132:135], v[184:187]
  ds_read_b128 v[208:211], v70 offset:25472
  s_mov_b64 exec, s[68:69]
  v_cvt_pk_bf16_f32 v166, v204, v205
  v_cvt_pk_bf16_f32 v167, v206, v207
  s_mov_b64 exec, -1
  v_mfma_f32_16x16x32_bf16 v[188:191], v[212:215], v[136:139], v[188:191]
  s_add_u32 m0, s81, 17408
  s_nop 0
  buffer_load_dwordx4 v53, s[12:15], s80 offen lds
  v_mfma_f32_16x16x32_bf16 v[192:195], v[212:215], v[140:143], v[192:195]
  s_waitcnt lgkmcnt(2)
  v_mfma_f32_16x16x32_bf16 v[196:199], v[216:219], v[72:75], 0
  ds_read_b128 v[212:215], v71 offset:25472
  v_mfma_f32_16x16x32_bf16 v[200:203], v[216:219], v[76:79], 0
  s_add_u32 m0, s81, 18432
  s_nop 0
  buffer_load_dwordx4 v54, s[12:15], s80 offen lds
  v_mfma_f32_16x16x32_bf16 v[204:207], v[216:219], v[80:83], 0
  s_waitcnt lgkmcnt(2)
  v_mfma_f32_16x16x32_bf16 v[196:199], v[220:223], v[84:87], v[196:199]
  ds_read_b128 v[216:219], v70 offset:25600
  v_cvt_pk_bf16_f32 v248, v184, v185
  v_mfma_f32_16x16x32_bf16 v[200:203], v[220:223], v[88:91], v[200:203]
  s_add_u32 m0, s81, 19456
  s_nop 0
  buffer_load_dwordx4 v55, s[12:15], s80 offen lds
  v_mfma_f32_16x16x32_bf16 v[204:207], v[220:223], v[92:95], v[204:207]
  v_cvt_pk_bf16_f32 v249, v186, v187
  s_waitcnt lgkmcnt(2)
  v_mfma_f32_16x16x32_bf16 v[196:199], v[208:211], v[96:99], v[196:199]
  ds_read_b128 v[220:223], v71 offset:25600
  v_cvt_pk_bf16_f32 v250, v188, v189
  v_mfma_f32_16x16x32_bf16 v[200:203], v[208:211], v[100:103], v[200:203]
  s_add_u32 m0, s81, 20480
  s_nop 0
  buffer_load_dwordx4 v56, s[12:15], s80 offen lds
  v_mfma_f32_16x16x32_bf16 v[204:207], v[208:211], v[104:107], v[204:207]
  v_cvt_pk_bf16_f32 v251, v190, v191
  s_waitcnt lgkmcnt(2)
  v_mfma_f32_16x16x32_bf16 v[196:199], v[212:215], v[108:111], v[196:199]
  v_accvgpr_write_b32 a48, v248
  v_mfma_f32_16x16x32_bf16 v[200:203], v[212:215], v[112:115], v[200:203]
  s_add_u32 m0, s81, 21504
  s_nop 0
  buffer_load_dwordx4 v57, s[12:15], s80 offen lds
  v_mfma_f32_16x16x32_bf16 v[204:207], v[212:215], v[116:119], v[204:207]
  v_accvgpr_write_b32 a49, v249
  s_waitcnt lgkmcnt(1)
  v_mfma_f32_16x16x32_bf16 v[196:199], v[216:219], v[120:123], v[196:199]
  v_accvgpr_write_b32 a128, v250
  v_mfma_f32_16x16x32_bf16 v[200:203], v[216:219], v[124:127], v[200:203]
  s_add_u32 m0, s81, 22528
  s_nop 0
  buffer_load_dwordx4 v58, s[12:15], s80 offen lds
  v_mfma_f32_16x16x32_bf16 v[204:207], v[216:219], v[128:131], v[204:207]
  v_accvgpr_write_b32 a129, v251
  s_waitcnt lgkmcnt(0)
  v_mfma_f32_16x16x32_bf16 v[196:199], v[220:223], v[132:135], v[196:199]
  v_cvt_pk_bf16_f32 v168, v192, v193
  v_cvt_pk_bf16_f32 v169, v194, v195
  v_mfma_f32_16x16x32_bf16 v[200:203], v[220:223], v[136:139], v[200:203]
  s_add_u32 m0, s81, 23552
  s_nop 0
  buffer_load_dwordx4 v59, s[12:15], s80 offen lds
  s_add_u32 s80, s80, 393216
  v_mfma_f32_16x16x32_bf16 v[204:207], v[220:223], v[140:143], v[204:207]
  s_add_u32 s21, s79, 786432
  buffer_load_dwordx4 a[208:211], v63, s[24:27], s21 offen
  s_add_u32 s21, s79, 786432
  buffer_load_dwordx4 a[212:215], v64, s[24:27], s21 offen
  s_add_u32 s21, s79, 786432
  buffer_load_dwordx4 a[216:219], v65, s[24:27], s21 offen
  s_waitcnt vmcnt(18)
  buffer_load_dword v66, v67, s[32:35], 0 offen sc1
  ds_read_b128 v[208:211], v70 offset:0
  ds_read_b128 v[212:215], v71 offset:0
  ds_read_b128 v[216:219], v70 offset:128
  s_waitcnt lgkmcnt(2)
  v_mfma_f32_16x16x32_bf16 v[184:187], v[208:211], v[72:75], 0
  ds_read_b128 v[220:223], v71 offset:128
  v_mfma_f32_16x16x32_bf16 v[188:191], v[208:211], v[76:79], 0
  s_add_u32 m0, s81, 24576
  s_nop 0
  buffer_load_dwordx4 v48, s[12:15], s80 offen lds
  v_mfma_f32_16x16x32_bf16 v[192:195], v[208:211], v[80:83], 0
  s_waitcnt lgkmcnt(2)
  v_mfma_f32_16x16x32_bf16 v[184:187], v[212:215], v[84:87], v[184:187]
  ds_read_b128 v[208:211], v70 offset:256
  v_cvt_pk_bf16_f32 v248, v196, v197
  v_mfma_f32_16x16x32_bf16 v[188:191], v[212:215], v[88:91], v[188:191]
  s_add_u32 m0, s81, 25600
  s_nop 0
  buffer_load_dwordx4 v49, s[12:15], s80 offen lds
  v_mfma_f32_16x16x32_bf16 v[192:195], v[212:215], v[92:95], v[192:195]
  v_cvt_pk_bf16_f32 v249, v198, v199
  s_waitcnt lgkmcnt(2)
  v_mfma_f32_16x16x32_bf16 v[184:187], v[216:219], v[96:99], v[184:187]
  ds_read_b128 v[212:215], v71 offset:256
  v_cvt_pk_bf16_f32 v250, v200, v201
  v_mfma_f32_16x16x32_bf16 v[188:191], v[216:219], v[100:103], v[188:191]
  s_add_u32 m0, s81, 26624
  s_nop 0
  buffer_load_dwordx4 v50, s[12:15], s80 offen lds
  v_mfma_f32_16x16x32_bf16 v[192:195], v[216:219], v[104:107], v[192:195]
  v_cvt_pk_bf16_f32 v251, v202, v203
  s_waitcnt lgkmcnt(2)
  v_mfma_f32_16x16x32_bf16 v[184:187], v[220:223], v[108:111], v[184:187]
  ds_read_b128 v[216:219], v70 offset:768
  v_accvgpr_write_b32 a50, v248
  v_mfma_f32_16x16x32_bf16 v[188:191], v[220:223], v[112:115], v[188:191]
  s_add_u32 m0, s81, 27648
  s_nop 0
  buffer_load_dwordx4 v51, s[12:15], s80 offen lds
  v_mfma_f32_16x16x32_bf16 v[192:195], v[220:223], v[116:119], v[192:195]
  v_accvgpr_write_b32 a51, v249
  s_waitcnt lgkmcnt(2)
  v_mfma_f32_16x16x32_bf16 v[184:187], v[208:211], v[120:123], v[184:187]
  ds_read_b128 v[220:223], v71 offset:768
  v_accvgpr_write_b32 a130, v250
  v_mfma_f32_16x16x32_bf16 v[188:191], v[208:211], v[124:127], v[188:191]
  s_add_u32 m0, s81, 28672
  s_nop 0
  buffer_load_dwordx4 v52, s[12:15], s80 offen lds
  v_mfma_f32_16x16x32_bf16 v[192:195], v[208:211], v[128:131], v[192:195]
  v_accvgpr_write_b32 a131, v251
  s_waitcnt lgkmcnt(2)
  v_mfma_f32_16x16x32_bf16 v[184:187], v[212:215], v[132:135], v[184:187]
  ds_read_b128 v[208:211], v70 offset:896
  s_mov_b64 exec, s[68:69]
  v_cvt_pk_bf16_f32 v168, v204, v205
  v_cvt_pk_bf16_f32 v169, v206, v207
  s_mov_b64 exec, -1
  v_mfma_f32_16x16x32_bf16 v[188:191], v[212:215], v[136:139], v[188:191]
  s_add_u32 m0, s81, 29696
  s_nop 0
  buffer_load_dwordx4 v53, s[12:15], s80 offen lds
  v_mfma_f32_16x16x32_bf16 v[192:195], v[212:215], v[140:143], v[192:195]
  s_waitcnt lgkmcnt(2)
  v_mfma_f32_16x16x32_bf16 v[196:199], v[216:219], v[72:75], 0
  ds_read_b128 v[212:215], v71 offset:896
  v_mfma_f32_16x16x32_bf16 v[200:203], v[216:219], v[76:79], 0
  s_add_u32 m0, s81, 30720
  s_nop 0
  buffer_load_dwordx4 v54, s[12:15], s80 offen lds
  v_mfma_f32_16x16x32_bf16 v[204:207], v[216:219], v[80:83], 0
  s_waitcnt lgkmcnt(2)
  v_mfma_f32_16x16x32_bf16 v[196:199], v[220:223], v[84:87], v[196:199]
  ds_read_b128 v[216:219], v70 offset:1024
  v_cvt_pk_bf16_f32 v248, v184, v185
  v_mfma_f32_16x16x32_bf16 v[200:203], v[220:223], v[88:91], v[200:203]
  s_add_u32 m0, s81, 31744
  s_nop 0
  buffer_load_dwordx4 v55, s[12:15], s80 offen lds
  v_mfma_f32_16x16x32_bf16 v[204:207], v[220:223], v[92:95], v[204:207]
  v_cvt_pk_bf16_f32 v249, v186, v187
  s_waitcnt lgkmcnt(2)
  v_mfma_f32_16x16x32_bf16 v[196:199], v[208:211], v[96:99], v[196:199]
  ds_read_b128 v[220:223], v71 offset:1024
  v_cvt_pk_bf16_f32 v250, v188, v189
  v_mfma_f32_16x16x32_bf16 v[200:203], v[208:211], v[100:103], v[200:203]
  s_add_u32 m0, s81, 32768
  s_nop 0
  buffer_load_dwordx4 v56, s[12:15], s80 offen lds
  v_mfma_f32_16x16x32_bf16 v[204:207], v[208:211], v[104:107], v[204:207]
  v_cvt_pk_bf16_f32 v251, v190, v191
  s_waitcnt lgkmcnt(2)
  v_mfma_f32_16x16x32_bf16 v[196:199], v[212:215], v[108:111], v[196:199]
  v_accvgpr_write_b32 a52, v248
  v_mfma_f32_16x16x32_bf16 v[200:203], v[212:215], v[112:115], v[200:203]
  s_add_u32 m0, s81, 33792
  s_nop 0
  buffer_load_dwordx4 v57, s[12:15], s80 offen lds
  v_mfma_f32_16x16x32_bf16 v[204:207], v[212:215], v[116:119], v[204:207]
  v_accvgpr_write_b32 a53, v249
  s_waitcnt lgkmcnt(1)
  v_mfma_f32_16x16x32_bf16 v[196:199], v[216:219], v[120:123], v[196:199]
  v_accvgpr_write_b32 a132, v250
  v_mfma_f32_16x16x32_bf16 v[200:203], v[216:219], v[124:127], v[200:203]
  s_add_u32 m0, s81, 34816
  s_nop 0
  buffer_load_dwordx4 v58, s[12:15], s80 offen lds
  v_mfma_f32_16x16x32_bf16 v[204:207], v[216:219], v[128:131], v[204:207]
  v_accvgpr_write_b32 a133, v251
  s_waitcnt lgkmcnt(0)
  v_mfma_f32_16x16x32_bf16 v[196:199], v[220:223], v[132:135], v[196:199]
  v_cvt_pk_bf16_f32 v170, v192, v193
  v_cvt_pk_bf16_f32 v171, v194, v195
  v_mfma_f32_16x16x32_bf16 v[200:203], v[220:223], v[136:139], v[200:203]
  s_add_u32 m0, s81, 35840
  s_nop 0
  buffer_load_dwordx4 v59, s[12:15], s80 offen lds
  s_add_u32 s80, s80, 393216
  v_mfma_f32_16x16x32_bf16 v[204:207], v[220:223], v[140:143], v[204:207]
  s_add_u32 s21, s79, 1179648
  buffer_load_dwordx4 a[232:235], v63, s[24:27], s21 offen
  s_add_u32 s21, s79, 1179648
  buffer_load_dwordx4 a[236:239], v64, s[24:27], s21 offen
  s_add_u32 s21, s79, 1179648
  buffer_load_dwordx4 a[240:243], v65, s[24:27], s21 offen
  s_waitcnt vmcnt(19)
  ds_read_b128 v[208:211], v70 offset:12288
  ds_read_b128 v[212:215], v71 offset:12288
  ds_read_b128 v[216:219], v70 offset:12416
  s_waitcnt lgkmcnt(2)
  v_mfma_f32_16x16x32_bf16 v[184:187], v[208:211], v[72:75], 0
  ds_read_b128 v[220:223], v71 offset:12416
  v_mfma_f32_16x16x32_bf16 v[188:191], v[208:211], v[76:79], 0
  s_add_u32 m0, s81, 0
  s_nop 0
  buffer_load_dwordx4 v48, s[12:15], s80 offen lds
  v_mfma_f32_16x16x32_bf16 v[192:195], v[208:211], v[80:83], 0
  s_waitcnt lgkmcnt(2)
  v_mfma_f32_16x16x32_bf16 v[184:187], v[212:215], v[84:87], v[184:187]
  ds_read_b128 v[208:211], v70 offset:12544
  v_cvt_pk_bf16_f32 v248, v196, v197
  v_mfma_f32_16x16x32_bf16 v[188:191], v[212:215], v[88:91], v[188:191]
  s_add_u32 m0, s81, 1024
  s_nop 0
  buffer_load_dwordx4 v49, s[12:15], s80 offen lds
  v_mfma_f32_16x16x32_bf16 v[192:195], v[212:215], v[92:95], v[192:195]
  v_cvt_pk_bf16_f32 v249, v198, v199
  s_waitcnt lgkmcnt(2)
  v_mfma_f32_16x16x32_bf16 v[184:187], v[216:219], v[96:99], v[184:187]
  ds_read_b128 v[212:215], v71 offset:12544
  v_cvt_pk_bf16_f32 v250, v200, v201
  v_mfma_f32_16x16x32_bf16 v[188:191], v[216:219], v[100:103], v[188:191]
  s_add_u32 m0, s81, 2048
  s_nop 0
  buffer_load_dwordx4 v50, s[12:15], s80 offen lds
  v_mfma_f32_16x16x32_bf16 v[192:195], v[216:219], v[104:107], v[192:195]
  v_cvt_pk_bf16_f32 v251, v202, v203
  s_waitcnt lgkmcnt(2)
  v_mfma_f32_16x16x32_bf16 v[184:187], v[220:223], v[108:111], v[184:187]
  ds_read_b128 v[216:219], v70 offset:13056
  v_accvgpr_write_b32 a54, v248
  v_mfma_f32_16x16x32_bf16 v[188:191], v[220:223], v[112:115], v[188:191]
  s_add_u32 m0, s81, 3072
  s_nop 0
  buffer_load_dwordx4 v51, s[12:15], s80 offen lds
  v_mfma_f32_16x16x32_bf16 v[192:195], v[220:223], v[116:119], v[192:195]
  v_accvgpr_write_b32 a55, v249
  s_waitcnt lgkmcnt(2)
  v_mfma_f32_16x16x32_bf16 v[184:187], v[208:211], v[120:123], v[184:187]
  ds_read_b128 v[220:223], v71 offset:13056
  v_accvgpr_write_b32 a134, v250
  v_mfma_f32_16x16x32_bf16 v[188:191], v[208:211], v[124:127], v[188:191]
  s_add_u32 m0, s81, 4096
  s_nop 0
  buffer_load_dwordx4 v52, s[12:15], s80 offen lds
  v_mfma_f32_16x16x32_bf16 v[192:195], v[208:211], v[128:131], v[192:195]
  v_accvgpr_write_b32 a135, v251
  s_waitcnt lgkmcnt(2)
  v_mfma_f32_16x16x32_bf16 v[184:187], v[212:215], v[132:135], v[184:187]
  ds_read_b128 v[208:211], v70 offset:13184
  s_mov_b64 exec, s[68:69]
  v_cvt_pk_bf16_f32 v170, v204, v205
  v_cvt_pk_bf16_f32 v171, v206, v207
  s_mov_b64 exec, -1
  v_mfma_f32_16x16x32_bf16 v[188:191], v[212:215], v[136:139], v[188:191]
  s_add_u32 m0, s81, 5120
  s_nop 0
  buffer_load_dwordx4 v53, s[12:15], s80 offen lds
  v_mfma_f32_16x16x32_bf16 v[192:195], v[212:215], v[140:143], v[192:195]
  s_waitcnt lgkmcnt(2)
  v_mfma_f32_16x16x32_bf16 v[196:199], v[216:219], v[72:75], 0
  ds_read_b128 v[212:215], v71 offset:13184
  v_mfma_f32_16x16x32_bf16 v[200:203], v[216:219], v[76:79], 0
  s_add_u32 m0, s81, 6144
  s_nop 0
  buffer_load_dwordx4 v54, s[12:15], s80 offen lds
  v_mfma_f32_16x16x32_bf16 v[204:207], v[216:219], v[80:83], 0
  s_waitcnt lgkmcnt(2)
  v_mfma_f32_16x16x32_bf16 v[196:199], v[220:223], v[84:87], v[196:199]
  ds_read_b128 v[216:219], v70 offset:13312
  v_cvt_pk_bf16_f32 v248, v184, v185
  v_mfma_f32_16x16x32_bf16 v[200:203], v[220:223], v[88:91], v[200:203]
  s_add_u32 m0, s81, 7168
  s_nop 0
  buffer_load_dwordx4 v55, s[12:15], s80 offen lds
  v_mfma_f32_16x16x32_bf16 v[204:207], v[220:223], v[92:95], v[204:207]
  v_cvt_pk_bf16_f32 v249, v186, v187
  s_waitcnt lgkmcnt(2)
  v_mfma_f32_16x16x32_bf16 v[196:199], v[208:211], v[96:99], v[196:199]
  ds_read_b128 v[220:223], v71 offset:13312
  v_cvt_pk_bf16_f32 v250, v188, v189
  v_mfma_f32_16x16x32_bf16 v[200:203], v[208:211], v[100:103], v[200:203]
  s_add_u32 m0, s81, 8192
  s_nop 0
  buffer_load_dwordx4 v56, s[12:15], s80 offen lds
  v_mfma_f32_16x16x32_bf16 v[204:207], v[208:211], v[104:107], v[204:207]
  v_cvt_pk_bf16_f32 v251, v190, v191
  s_waitcnt lgkmcnt(2)
  v_mfma_f32_16x16x32_bf16 v[196:199], v[212:215], v[108:111], v[196:199]
  v_accvgpr_write_b32 a56, v248
  v_mfma_f32_16x16x32_bf16 v[200:203], v[212:215], v[112:115], v[200:203]
  s_add_u32 m0, s81, 9216
  s_nop 0
  buffer_load_dwordx4 v57, s[12:15], s80 offen lds
  v_mfma_f32_16x16x32_bf16 v[204:207], v[212:215], v[116:119], v[204:207]
  v_accvgpr_write_b32 a57, v249
  s_waitcnt lgkmcnt(1)
  v_mfma_f32_16x16x32_bf16 v[196:199], v[216:219], v[120:123], v[196:199]
  v_accvgpr_write_b32 a136, v250
  v_mfma_f32_16x16x32_bf16 v[200:203], v[216:219], v[124:127], v[200:203]
  s_add_u32 m0, s81, 10240
  s_nop 0
  buffer_load_dwordx4 v58, s[12:15], s80 offen lds
  v_mfma_f32_16x16x32_bf16 v[204:207], v[216:219], v[128:131], v[204:207]
  v_accvgpr_write_b32 a137, v251
  s_waitcnt lgkmcnt(0)
  v_mfma_f32_16x16x32_bf16 v[196:199], v[220:223], v[132:135], v[196:199]
  v_cvt_pk_bf16_f32 v172, v192, v193
  v_cvt_pk_bf16_f32 v173, v194, v195
  v_mfma_f32_16x16x32_bf16 v[200:203], v[220:223], v[136:139], v[200:203]
  s_add_u32 m0, s81, 11264
  s_nop 0
  buffer_load_dwordx4 v59, s[12:15], s80 offen lds
  s_add_u32 s80, s80, 393216
  v_mfma_f32_16x16x32_bf16 v[204:207], v[220:223], v[140:143], v[204:207]
  s_add_u32 s21, s79, 1572864
  buffer_load_dwordx4 v[224:227], v63, s[24:27], s21 offen
  s_add_u32 s21, s79, 1572864
  buffer_load_dwordx4 v[228:231], v64, s[24:27], s21 offen
  s_add_u32 s21, s79, 1572864
  buffer_load_dwordx4 v[232:235], v65, s[24:27], s21 offen
  s_waitcnt vmcnt(18)
  ds_read_b128 v[208:211], v70 offset:24576
  ds_read_b128 v[212:215], v71 offset:24576
  ds_read_b128 v[216:219], v70 offset:24704
  s_waitcnt lgkmcnt(2)
  v_mfma_f32_16x16x32_bf16 v[184:187], v[208:211], v[72:75], 0
  ds_read_b128 v[220:223], v71 offset:24704
  v_mfma_f32_16x16x32_bf16 v[188:191], v[208:211], v[76:79], 0
  s_add_u32 m0, s81, 12288
  s_nop 0
  buffer_load_dwordx4 v48, s[12:15], s80 offen lds
  v_mfma_f32_16x16x32_bf16 v[192:195], v[208:211], v[80:83], 0
  s_waitcnt lgkmcnt(2)
  v_mfma_f32_16x16x32_bf16 v[184:187], v[212:215], v[84:87], v[184:187]
  ds_read_b128 v[208:211], v70 offset:24832
  v_cvt_pk_bf16_f32 v248, v196, v197
  v_mfma_f32_16x16x32_bf16 v[188:191], v[212:215], v[88:91], v[188:191]
  s_add_u32 m0, s81, 13312
  s_nop 0
  buffer_load_dwordx4 v49, s[12:15], s80 offen lds
  v_mfma_f32_16x16x32_bf16 v[192:195], v[212:215], v[92:95], v[192:195]
  v_cvt_pk_bf16_f32 v249, v198, v199
  s_waitcnt lgkmcnt(2)
  v_mfma_f32_16x16x32_bf16 v[184:187], v[216:219], v[96:99], v[184:187]
  ds_read_b128 v[212:215], v71 offset:24832
  v_cvt_pk_bf16_f32 v250, v200, v201
  v_mfma_f32_16x16x32_bf16 v[188:191], v[216:219], v[100:103], v[188:191]
  s_add_u32 m0, s81, 14336
  s_nop 0
  buffer_load_dwordx4 v50, s[12:15], s80 offen lds
  v_mfma_f32_16x16x32_bf16 v[192:195], v[216:219], v[104:107], v[192:195]
  v_cvt_pk_bf16_f32 v251, v202, v203
  s_waitcnt lgkmcnt(2)
  v_mfma_f32_16x16x32_bf16 v[184:187], v[220:223], v[108:111], v[184:187]
  ds_read_b128 v[216:219], v70 offset:25344
  v_accvgpr_write_b32 a58, v248
  v_mfma_f32_16x16x32_bf16 v[188:191], v[220:223], v[112:115], v[188:191]
  s_add_u32 m0, s81, 15360
  s_nop 0
  buffer_load_dwordx4 v51, s[12:15], s80 offen lds
  v_mfma_f32_16x16x32_bf16 v[192:195], v[220:223], v[116:119], v[192:195]
  v_accvgpr_write_b32 a59, v249
  s_waitcnt lgkmcnt(2)
  v_mfma_f32_16x16x32_bf16 v[184:187], v[208:211], v[120:123], v[184:187]
  ds_read_b128 v[220:223], v71 offset:25344
  v_accvgpr_write_b32 a138, v250
  v_mfma_f32_16x16x32_bf16 v[188:191], v[208:211], v[124:127], v[188:191]
  s_add_u32 m0, s81, 16384
  s_nop 0
  buffer_load_dwordx4 v52, s[12:15], s80 offen lds
  v_mfma_f32_16x16x32_bf16 v[192:195], v[208:211], v[128:131], v[192:195]
  v_accvgpr_write_b32 a139, v251
  s_waitcnt lgkmcnt(2)
  v_mfma_f32_16x16x32_bf16 v[184:187], v[212:215], v[132:135], v[184:187]
  ds_read_b128 v[208:211], v70 offset:25472
  s_mov_b64 exec, s[68:69]
  v_cvt_pk_bf16_f32 v172, v204, v205
  v_cvt_pk_bf16_f32 v173, v206, v207
  s_mov_b64 exec, -1
  v_mfma_f32_16x16x32_bf16 v[188:191], v[212:215], v[136:139], v[188:191]
  s_add_u32 m0, s81, 17408
  s_nop 0
  buffer_load_dwordx4 v53, s[12:15], s80 offen lds
  v_mfma_f32_16x16x32_bf16 v[192:195], v[212:215], v[140:143], v[192:195]
  s_waitcnt lgkmcnt(2)
  v_mfma_f32_16x16x32_bf16 v[196:199], v[216:219], v[72:75], 0
  ds_read_b128 v[212:215], v71 offset:25472
  v_mfma_f32_16x16x32_bf16 v[200:203], v[216:219], v[76:79], 0
  s_add_u32 m0, s81, 18432
  s_nop 0
  buffer_load_dwordx4 v54, s[12:15], s80 offen lds
  v_mfma_f32_16x16x32_bf16 v[204:207], v[216:219], v[80:83], 0
  s_waitcnt lgkmcnt(2)
  v_mfma_f32_16x16x32_bf16 v[196:199], v[220:223], v[84:87], v[196:199]
  ds_read_b128 v[216:219], v70 offset:25600
  v_cvt_pk_bf16_f32 v248, v184, v185
  v_mfma_f32_16x16x32_bf16 v[200:203], v[220:223], v[88:91], v[200:203]
  s_add_u32 m0, s81, 19456
  s_nop 0
  buffer_load_dwordx4 v55, s[12:15], s80 offen lds
  v_mfma_f32_16x16x32_bf16 v[204:207], v[220:223], v[92:95], v[204:207]
  v_cvt_pk_bf16_f32 v249, v186, v187
  s_waitcnt lgkmcnt(2)
  v_mfma_f32_16x16x32_bf16 v[196:199], v[208:211], v[96:99], v[196:199]
  ds_read_b128 v[220:223], v71 offset:25600
  v_cvt_pk_bf16_f32 v250, v188, v189
  v_mfma_f32_16x16x32_bf16 v[200:203], v[208:211], v[100:103], v[200:203]
  s_add_u32 m0, s81, 20480
  s_nop 0
  buffer_load_dwordx4 v56, s[12:15], s80 offen lds
  v_mfma_f32_16x16x32_bf16 v[204:207], v[208:211], v[104:107], v[204:207]
  v_cvt_pk_bf16_f32 v251, v190, v191
  s_waitcnt lgkmcnt(2)
  v_mfma_f32_16x16x32_bf16 v[196:199], v[212:215], v[108:111], v[196:199]
  v_accvgpr_write_b32 a60, v248
  v_mfma_f32_16x16x32_bf16 v[200:203], v[212:215], v[112:115], v[200:203]
  s_add_u32 m0, s81, 21504
  s_nop 0
  buffer_load_dwordx4 v57, s[12:15], s80 offen lds
  v_mfma_f32_16x16x32_bf16 v[204:207], v[212:215], v[116:119], v[204:207]
  v_accvgpr_write_b32 a61, v249
  s_waitcnt lgkmcnt(1)
  v_mfma_f32_16x16x32_bf16 v[196:199], v[216:219], v[120:123], v[196:199]
  v_accvgpr_write_b32 a140, v250
  v_mfma_f32_16x16x32_bf16 v[200:203], v[216:219], v[124:127], v[200:203]
  s_add_u32 m0, s81, 22528
  s_nop 0
  buffer_load_dwordx4 v58, s[12:15], s80 offen lds
  v_mfma_f32_16x16x32_bf16 v[204:207], v[216:219], v[128:131], v[204:207]
  v_accvgpr_write_b32 a141, v251
  s_waitcnt lgkmcnt(0)
  v_mfma_f32_16x16x32_bf16 v[196:199], v[220:223], v[132:135], v[196:199]
  v_cvt_pk_bf16_f32 v174, v192, v193
  v_cvt_pk_bf16_f32 v175, v194, v195
  v_mfma_f32_16x16x32_bf16 v[200:203], v[220:223], v[136:139], v[200:203]
  s_add_u32 m0, s81, 23552
  s_nop 0
  buffer_load_dwordx4 v59, s[12:15], s80 offen lds
  s_add_u32 s80, s80, 393216
  v_mfma_f32_16x16x32_bf16 v[204:207], v[220:223], v[140:143], v[204:207]
  s_waitcnt vmcnt(15)
  s_and_b32 s21, s50, 1
  s_lshl_b32 s21, s21, 4
  s_add_u32 s21, s21, s51
  s_lshl_b32 s22, s21, 10
  s_add_u32 s22, s22, s77
  s_add_u32 s23, s77, 30720
  s_cmp_lt_u32 s21, 10
  s_cselect_b32 s23, 0, s23
  s_add_u32 s22, s22, s23
  s_mul_i32 s23, s20, 122880
  s_add_u32 s22, s22, s23
  buffer_load_dwordx4 v[252:255], v4, s[8:11], s22 offen sc1
  ds_read_b128 v[208:211], v70 offset:0
  ds_read_b128 v[212:215], v71 offset:0
  ds_read_b128 v[216:219], v70 offset:128
  s_waitcnt lgkmcnt(2)
  v_mfma_f32_16x16x32_bf16 v[184:187], v[208:211], v[72:75], 0
  ds_read_b128 v[220:223], v71 offset:128
  v_mfma_f32_16x16x32_bf16 v[188:191], v[208:211], v[76:79], 0
  s_add_u32 m0, s81, 24576
  s_nop 0
  buffer_load_dwordx4 v48, s[12:15], s80 offen lds
  v_mfma_f32_16x16x32_bf16 v[192:195], v[208:211], v[80:83], 0
  s_waitcnt lgkmcnt(2)
  v_mfma_f32_16x16x32_bf16 v[184:187], v[212:215], v[84:87], v[184:187]
  ds_read_b128 v[208:211], v70 offset:256
  v_cvt_pk_bf16_f32 v248, v196, v197
  v_mfma_f32_16x16x32_bf16 v[188:191], v[212:215], v[88:91], v[188:191]
  s_add_u32 m0, s81, 25600
  s_nop 0
  buffer_load_dwordx4 v49, s[12:15], s80 offen lds
  v_mfma_f32_16x16x32_bf16 v[192:195], v[212:215], v[92:95], v[192:195]
  v_cvt_pk_bf16_f32 v249, v198, v199
  s_waitcnt lgkmcnt(2)
  v_mfma_f32_16x16x32_bf16 v[184:187], v[216:219], v[96:99], v[184:187]
  ds_read_b128 v[212:215], v71 offset:256
  v_cvt_pk_bf16_f32 v250, v200, v201
  v_mfma_f32_16x16x32_bf16 v[188:191], v[216:219], v[100:103], v[188:191]
  s_add_u32 m0, s81, 26624
  s_nop 0
  buffer_load_dwordx4 v50, s[12:15], s80 offen lds
  v_mfma_f32_16x16x32_bf16 v[192:195], v[216:219], v[104:107], v[192:195]
  v_cvt_pk_bf16_f32 v251, v202, v203
  s_waitcnt lgkmcnt(2)
  v_mfma_f32_16x16x32_bf16 v[184:187], v[220:223], v[108:111], v[184:187]
  ds_read_b128 v[216:219], v70 offset:768
  v_accvgpr_write_b32 a62, v248
  v_mfma_f32_16x16x32_bf16 v[188:191], v[220:223], v[112:115], v[188:191]
  s_add_u32 m0, s81, 27648
  s_nop 0
  buffer_load_dwordx4 v51, s[12:15], s80 offen lds
  v_mfma_f32_16x16x32_bf16 v[192:195], v[220:223], v[116:119], v[192:195]
  v_accvgpr_write_b32 a63, v249
  s_waitcnt lgkmcnt(2)
  v_mfma_f32_16x16x32_bf16 v[184:187], v[208:211], v[120:123], v[184:187]
  ds_read_b128 v[220:223], v71 offset:768
  v_accvgpr_write_b32 a142, v250
  v_mfma_f32_16x16x32_bf16 v[188:191], v[208:211], v[124:127], v[188:191]
  s_add_u32 m0, s81, 28672
  s_nop 0
  buffer_load_dwordx4 v52, s[12:15], s80 offen lds
  v_mfma_f32_16x16x32_bf16 v[192:195], v[208:211], v[128:131], v[192:195]
  v_accvgpr_write_b32 a143, v251
  s_waitcnt lgkmcnt(2)
  v_mfma_f32_16x16x32_bf16 v[184:187], v[212:215], v[132:135], v[184:187]
  ds_read_b128 v[208:211], v70 offset:896
  s_mov_b64 exec, s[68:69]
  v_cvt_pk_bf16_f32 v174, v204, v205
  v_cvt_pk_bf16_f32 v175, v206, v207
  s_mov_b64 exec, -1
  v_mfma_f32_16x16x32_bf16 v[188:191], v[212:215], v[136:139], v[188:191]
  s_add_u32 m0, s81, 29696
  s_nop 0
  buffer_load_dwordx4 v53, s[12:15], s80 offen lds
  v_mfma_f32_16x16x32_bf16 v[192:195], v[212:215], v[140:143], v[192:195]
  s_waitcnt lgkmcnt(2)
  v_mfma_f32_16x16x32_bf16 v[196:199], v[216:219], v[72:75], 0
  ds_read_b128 v[212:215], v71 offset:896
  v_mfma_f32_16x16x32_bf16 v[200:203], v[216:219], v[76:79], 0
  s_add_u32 m0, s81, 30720
  s_nop 0
  buffer_load_dwordx4 v54, s[12:15], s80 offen lds
  v_mfma_f32_16x16x32_bf16 v[204:207], v[216:219], v[80:83], 0
  s_waitcnt lgkmcnt(2)
  v_mfma_f32_16x16x32_bf16 v[196:199], v[220:223], v[84:87], v[196:199]
  ds_read_b128 v[216:219], v70 offset:1024
  v_cvt_pk_bf16_f32 v248, v184, v185
  v_mfma_f32_16x16x32_bf16 v[200:203], v[220:223], v[88:91], v[200:203]
  s_add_u32 m0, s81, 31744
  s_nop 0
  buffer_load_dwordx4 v55, s[12:15], s80 offen lds
  v_mfma_f32_16x16x32_bf16 v[204:207], v[220:223], v[92:95], v[204:207]
  v_cvt_pk_bf16_f32 v249, v186, v187
  s_waitcnt lgkmcnt(2)
  v_mfma_f32_16x16x32_bf16 v[196:199], v[208:211], v[96:99], v[196:199]
  ds_read_b128 v[220:223], v71 offset:1024
  v_cvt_pk_bf16_f32 v250, v188, v189
  v_mfma_f32_16x16x32_bf16 v[200:203], v[208:211], v[100:103], v[200:203]
  s_add_u32 m0, s81, 32768
  s_nop 0
  buffer_load_dwordx4 v56, s[12:15], s80 offen lds
  v_mfma_f32_16x16x32_bf16 v[204:207], v[208:211], v[104:107], v[204:207]
  v_cvt_pk_bf16_f32 v251, v190, v191
  s_waitcnt lgkmcnt(2)
  v_mfma_f32_16x16x32_bf16 v[196:199], v[212:215], v[108:111], v[196:199]
  v_accvgpr_write_b32 a64, v248
  v_mfma_f32_16x16x32_bf16 v[200:203], v[212:215], v[112:115], v[200:203]
  s_add_u32 m0, s81, 33792
  s_nop 0
  buffer_load_dwordx4 v57, s[12:15], s80 offen lds
  v_mfma_f32_16x16x32_bf16 v[204:207], v[212:215], v[116:119], v[204:207]
  v_accvgpr_write_b32 a65, v249
  s_waitcnt lgkmcnt(1)
  v_mfma_f32_16x16x32_bf16 v[196:199], v[216:219], v[120:123], v[196:199]
  v_accvgpr_write_b32 a144, v250
  v_mfma_f32_16x16x32_bf16 v[200:203], v[216:219], v[124:127], v[200:203]
  s_add_u32 m0, s81, 34816
  s_nop 0
  buffer_load_dwordx4 v58, s[12:15], s80 offen lds
  v_mfma_f32_16x16x32_bf16 v[204:207], v[216:219], v[128:131], v[204:207]
  v_accvgpr_write_b32 a145, v251
  s_waitcnt lgkmcnt(0)
  v_mfma_f32_16x16x32_bf16 v[196:199], v[220:223], v[132:135], v[196:199]
  v_cvt_pk_bf16_f32 v176, v192, v193
  v_cvt_pk_bf16_f32 v177, v194, v195
  v_mfma_f32_16x16x32_bf16 v[200:203], v[220:223], v[136:139], v[200:203]
  s_add_u32 m0, s81, 35840
  s_nop 0
  buffer_load_dwordx4 v59, s[12:15], s80 offen lds
  s_add_u32 s80, s80, 393216
  v_mfma_f32_16x16x32_bf16 v[204:207], v[220:223], v[140:143], v[204:207]
  s_waitcnt vmcnt(13)
  ds_read_b128 v[208:211], v70 offset:12288
  ds_read_b128 v[212:215], v71 offset:12288
  ds_read_b128 v[216:219], v70 offset:12416
  s_waitcnt lgkmcnt(2)
  v_mfma_f32_16x16x32_bf16 v[184:187], v[208:211], v[72:75], 0
  ds_read_b128 v[220:223], v71 offset:12416
  v_mfma_f32_16x16x32_bf16 v[188:191], v[208:211], v[76:79], 0
  s_add_u32 m0, s81, 0
  s_nop 0
  buffer_load_dwordx4 v48, s[12:15], s80 offen lds
  v_mfma_f32_16x16x32_bf16 v[192:195], v[208:211], v[80:83], 0
  s_waitcnt lgkmcnt(2)
  v_mfma_f32_16x16x32_bf16 v[184:187], v[212:215], v[84:87], v[184:187]
  ds_read_b128 v[208:211], v70 offset:12544
  v_cvt_pk_bf16_f32 v248, v196, v197
  v_mfma_f32_16x16x32_bf16 v[188:191], v[212:215], v[88:91], v[188:191]
  s_add_u32 m0, s81, 1024
  s_nop 0
  buffer_load_dwordx4 v49, s[12:15], s80 offen lds
  v_mfma_f32_16x16x32_bf16 v[192:195], v[212:215], v[92:95], v[192:195]
  v_cvt_pk_bf16_f32 v249, v198, v199
  s_waitcnt lgkmcnt(2)
  v_mfma_f32_16x16x32_bf16 v[184:187], v[216:219], v[96:99], v[184:187]
  ds_read_b128 v[212:215], v71 offset:12544
  v_cvt_pk_bf16_f32 v250, v200, v201
  v_mfma_f32_16x16x32_bf16 v[188:191], v[216:219], v[100:103], v[188:191]
  s_add_u32 m0, s81, 2048
  s_nop 0
  buffer_load_dwordx4 v50, s[12:15], s80 offen lds
  v_mfma_f32_16x16x32_bf16 v[192:195], v[216:219], v[104:107], v[192:195]
  v_cvt_pk_bf16_f32 v251, v202, v203
  s_waitcnt lgkmcnt(2)
  v_mfma_f32_16x16x32_bf16 v[184:187], v[220:223], v[108:111], v[184:187]
  ds_read_b128 v[216:219], v70 offset:13056
  v_accvgpr_write_b32 a66, v248
  v_mfma_f32_16x16x32_bf16 v[188:191], v[220:223], v[112:115], v[188:191]
  s_add_u32 m0, s81, 3072
  s_nop 0
  buffer_load_dwordx4 v51, s[12:15], s80 offen lds
  v_mfma_f32_16x16x32_bf16 v[192:195], v[220:223], v[116:119], v[192:195]
  v_accvgpr_write_b32 a67, v249
  s_waitcnt lgkmcnt(2)
  v_mfma_f32_16x16x32_bf16 v[184:187], v[208:211], v[120:123], v[184:187]
  ds_read_b128 v[220:223], v71 offset:13056
  v_accvgpr_write_b32 a146, v250
  v_mfma_f32_16x16x32_bf16 v[188:191], v[208:211], v[124:127], v[188:191]
  s_add_u32 m0, s81, 4096
  s_nop 0
  buffer_load_dwordx4 v52, s[12:15], s80 offen lds
  v_mfma_f32_16x16x32_bf16 v[192:195], v[208:211], v[128:131], v[192:195]
  v_accvgpr_write_b32 a147, v251
  s_waitcnt lgkmcnt(2)
  v_mfma_f32_16x16x32_bf16 v[184:187], v[212:215], v[132:135], v[184:187]
  ds_read_b128 v[208:211], v70 offset:13184
  s_mov_b64 exec, s[68:69]
  v_cvt_pk_bf16_f32 v176, v204, v205
  v_cvt_pk_bf16_f32 v177, v206, v207
  s_mov_b64 exec, -1
  v_mfma_f32_16x16x32_bf16 v[188:191], v[212:215], v[136:139], v[188:191]
  s_add_u32 m0, s81, 5120
  s_nop 0
  buffer_load_dwordx4 v53, s[12:15], s80 offen lds
  v_mfma_f32_16x16x32_bf16 v[192:195], v[212:215], v[140:143], v[192:195]
  s_waitcnt lgkmcnt(2)
  v_mfma_f32_16x16x32_bf16 v[196:199], v[216:219], v[72:75], 0
  ds_read_b128 v[212:215], v71 offset:13184
  v_mfma_f32_16x16x32_bf16 v[200:203], v[216:219], v[76:79], 0
  s_add_u32 m0, s81, 6144
  s_nop 0
  buffer_load_dwordx4 v54, s[12:15], s80 offen lds
  v_mfma_f32_16x16x32_bf16 v[204:207], v[216:219], v[80:83], 0
  s_waitcnt lgkmcnt(2)
  v_mfma_f32_16x16x32_bf16 v[196:199], v[220:223], v[84:87], v[196:199]
  ds_read_b128 v[216:219], v70 offset:13312
  v_cvt_pk_bf16_f32 v248, v184, v185
  v_mfma_f32_16x16x32_bf16 v[200:203], v[220:223], v[88:91], v[200:203]
  s_add_u32 m0, s81, 7168
  s_nop 0
  buffer_load_dwordx4 v55, s[12:15], s80 offen lds
  v_mfma_f32_16x16x32_bf16 v[204:207], v[220:223], v[92:95], v[204:207]
  v_cvt_pk_bf16_f32 v249, v186, v187
  s_waitcnt lgkmcnt(2)
  v_mfma_f32_16x16x32_bf16 v[196:199], v[208:211], v[96:99], v[196:199]
  ds_read_b128 v[220:223], v71 offset:13312
  v_cvt_pk_bf16_f32 v250, v188, v189
  v_mfma_f32_16x16x32_bf16 v[200:203], v[208:211], v[100:103], v[200:203]
  s_add_u32 m0, s81, 8192
  s_nop 0
  buffer_load_dwordx4 v56, s[12:15], s80 offen lds
  v_mfma_f32_16x16x32_bf16 v[204:207], v[208:211], v[104:107], v[204:207]
  v_cvt_pk_bf16_f32 v251, v190, v191
  s_waitcnt lgkmcnt(2)
  v_mfma_f32_16x16x32_bf16 v[196:199], v[212:215], v[108:111], v[196:199]
  v_accvgpr_write_b32 a68, v248
  v_mfma_f32_16x16x32_bf16 v[200:203], v[212:215], v[112:115], v[200:203]
  s_add_u32 m0, s81, 9216
  s_nop 0
  buffer_load_dwordx4 v57, s[12:15], s80 offen lds
  v_mfma_f32_16x16x32_bf16 v[204:207], v[212:215], v[116:119], v[204:207]
  v_accvgpr_write_b32 a69, v249
  s_waitcnt lgkmcnt(1)
  v_mfma_f32_16x16x32_bf16 v[196:199], v[216:219], v[120:123], v[196:199]
  v_accvgpr_write_b32 a148, v250
  v_mfma_f32_16x16x32_bf16 v[200:203], v[216:219], v[124:127], v[200:203]
  s_add_u32 m0, s81, 10240
  s_nop 0
  buffer_load_dwordx4 v58, s[12:15], s80 offen lds
  v_mfma_f32_16x16x32_bf16 v[204:207], v[216:219], v[128:131], v[204:207]
  v_accvgpr_write_b32 a149, v251
  s_waitcnt lgkmcnt(0)
  v_mfma_f32_16x16x32_bf16 v[196:199], v[220:223], v[132:135], v[196:199]
  v_cvt_pk_bf16_f32 v178, v192, v193
  v_cvt_pk_bf16_f32 v179, v194, v195
  v_mfma_f32_16x16x32_bf16 v[200:203], v[220:223], v[136:139], v[200:203]
  s_add_u32 m0, s81, 11264
  s_nop 0
  buffer_load_dwordx4 v59, s[12:15], s80 offen lds
  s_add_u32 s80, s80, 393216
  v_mfma_f32_16x16x32_bf16 v[204:207], v[220:223], v[140:143], v[204:207]
  s_waitcnt vmcnt(12)
  v_readlane_b32 s83, v66, 19
  s_sub_u32 s21, s83, 1
  s_lshl_b32 s21, s21, 13
  s_and_b32 s21, s21, 8192
  s_xor_b32 s76, s90, s21
  buffer_load_dword v66, v67, s[32:35], 0 offen sc1
  buffer_load_dword v42, v41, s[16:19], s76 offen sc1
  ds_read_b128 v[208:211], v70 offset:24576
  ds_read_b128 v[212:215], v71 offset:24576
  ds_read_b128 v[216:219], v70 offset:24704
  s_waitcnt lgkmcnt(2)
  v_mfma_f32_16x16x32_bf16 v[184:187], v[208:211], v[72:75], 0
  ds_read_b128 v[220:223], v71 offset:24704
  v_mfma_f32_16x16x32_bf16 v[188:191], v[208:211], v[76:79], 0
  ds_write_b128 v68, a[160:163] offset:12288
  v_mfma_f32_16x16x32_bf16 v[192:195], v[208:211], v[80:83], 0
  s_waitcnt lgkmcnt(3)
  v_mfma_f32_16x16x32_bf16 v[184:187], v[212:215], v[84:87], v[184:187]
  ds_read_b128 v[208:211], v70 offset:24832
  v_cvt_pk_bf16_f32 v248, v196, v197
  v_mfma_f32_16x16x32_bf16 v[188:191], v[212:215], v[88:91], v[188:191]
  ds_write_b128 v68, a[164:167] offset:13312
  v_mfma_f32_16x16x32_bf16 v[192:195], v[212:215], v[92:95], v[192:195]
  v_cvt_pk_bf16_f32 v249, v198, v199
  s_waitcnt lgkmcnt(4)
  v_mfma_f32_16x16x32_bf16 v[184:187], v[216:219], v[96:99], v[184:187]
  ds_read_b128 v[212:215], v71 offset:24832
  v_cvt_pk_bf16_f32 v250, v200, v201
  v_mfma_f32_16x16x32_bf16 v[188:191], v[216:219], v[100:103], v[188:191]
  ds_write_b128 v68, a[168:171] offset:14336
  v_mfma_f32_16x16x32_bf16 v[192:195], v[216:219], v[104:107], v[192:195]
  v_cvt_pk_bf16_f32 v251, v202, v203
  s_waitcnt lgkmcnt(5)
  v_mfma_f32_16x16x32_bf16 v[184:187], v[220:223], v[108:111], v[184:187]
  ds_read_b128 v[216:219], v70 offset:25344
  v_accvgpr_write_b32 a70, v248
  v_mfma_f32_16x16x32_bf16 v[188:191], v[220:223], v[112:115], v[188:191]
  ds_write_b128 v68, a[172:175] offset:15360
  v_mfma_f32_16x16x32_bf16 v[192:195], v[220:223], v[116:119], v[192:195]
  v_accvgpr_write_b32 a71, v249
  s_waitcnt lgkmcnt(5)
  v_mfma_f32_16x16x32_bf16 v[184:187], v[208:211], v[120:123], v[184:187]
  ds_read_b128 v[220:223], v71 offset:25344
  v_accvgpr_write_b32 a150, v250
  v_mfma_f32_16x16x32_bf16 v[188:191], v[208:211], v[124:127], v[188:191]
  ds_write_b128 v68, a[176:179] offset:16384
  v_mfma_f32_16x16x32_bf16 v[192:195], v[208:211], v[128:131], v[192:195]
  v_accvgpr_write_b32 a151, v251
  s_waitcnt lgkmcnt(5)
  v_mfma_f32_16x16x32_bf16 v[184:187], v[212:215], v[132:135], v[184:187]
  ds_read_b128 v[208:211], v70 offset:25472
  s_mov_b64 exec, s[68:69]
  v_cvt_pk_bf16_f32 v178, v204, v205
  v_cvt_pk_bf16_f32 v179, v206, v207
  s_mov_b64 exec, -1
  v_mfma_f32_16x16x32_bf16 v[188:191], v[212:215], v[136:139], v[188:191]
  ds_write_b128 v68, a[180:183] offset:17408
  v_mfma_f32_16x16x32_bf16 v[192:195], v[212:215], v[140:143], v[192:195]
  s_waitcnt lgkmcnt(5)
  v_mfma_f32_16x16x32_bf16 v[196:199], v[216:219], v[72:75], 0
  ds_read_b128 v[212:215], v71 offset:25472
  v_mfma_f32_16x16x32_bf16 v[200:203], v[216:219], v[76:79], 0
  ds_write_b128 v68, a[184:187] offset:18432
  v_mfma_f32_16x16x32_bf16 v[204:207], v[216:219], v[80:83], 0
  s_waitcnt lgkmcnt(5)
  v_mfma_f32_16x16x32_bf16 v[196:199], v[220:223], v[84:87], v[196:199]
  ds_read_b128 v[216:219], v70 offset:25600
  v_cvt_pk_bf16_f32 v248, v184, v185
  v_mfma_f32_16x16x32_bf16 v[200:203], v[220:223], v[88:91], v[200:203]
  ds_write_b128 v68, a[188:191] offset:19456
  v_mfma_f32_16x16x32_bf16 v[204:207], v[220:223], v[92:95], v[204:207]
  v_cvt_pk_bf16_f32 v249, v186, v187
  s_waitcnt lgkmcnt(5)
  v_mfma_f32_16x16x32_bf16 v[196:199], v[208:211], v[96:99], v[196:199]
  ds_read_b128 v[220:223], v71 offset:25600
  v_cvt_pk_bf16_f32 v250, v188, v189
  v_mfma_f32_16x16x32_bf16 v[200:203], v[208:211], v[100:103], v[200:203]
  ds_write_b128 v68, a[192:195] offset:20480
  v_mfma_f32_16x16x32_bf16 v[204:207], v[208:211], v[104:107], v[204:207]
  v_cvt_pk_bf16_f32 v251, v190, v191
  s_waitcnt lgkmcnt(5)
  v_mfma_f32_16x16x32_bf16 v[196:199], v[212:215], v[108:111], v[196:199]
  v_accvgpr_write_b32 a72, v248
  v_mfma_f32_16x16x32_bf16 v[200:203], v[212:215], v[112:115], v[200:203]
  ds_write_b128 v68, a[196:199] offset:21504
  v_mfma_f32_16x16x32_bf16 v[204:207], v[212:215], v[116:119], v[204:207]
  v_accvgpr_write_b32 a73, v249
  s_waitcnt lgkmcnt(4)
  v_mfma_f32_16x16x32_bf16 v[196:199], v[216:219], v[120:123], v[196:199]
  v_accvgpr_write_b32 a152, v250
  v_mfma_f32_16x16x32_bf16 v[200:203], v[216:219], v[124:127], v[200:203]
  ds_write_b128 v68, a[200:203] offset:22528
  v_mfma_f32_16x16x32_bf16 v[204:207], v[216:219], v[128:131], v[204:207]
  v_accvgpr_write_b32 a153, v251
  s_waitcnt lgkmcnt(3)
  v_mfma_f32_16x16x32_bf16 v[196:199], v[220:223], v[132:135], v[196:199]
  v_cvt_pk_bf16_f32 v180, v192, v193
  v_cvt_pk_bf16_f32 v181, v194, v195
  v_mfma_f32_16x16x32_bf16 v[200:203], v[220:223], v[136:139], v[200:203]
  ds_write_b128 v68, a[204:207] offset:23552
  v_mfma_f32_16x16x32_bf16 v[204:207], v[220:223], v[140:143], v[204:207]
  s_waitcnt vmcnt(2)
  ds_read_b128 v[208:211], v70 offset:0
  ds_read_b128 v[212:215], v71 offset:0
  ds_read_b128 v[216:219], v70 offset:128
  s_waitcnt lgkmcnt(2)
  v_mfma_f32_16x16x32_bf16 v[184:187], v[208:211], v[72:75], 0
  ds_read_b128 v[220:223], v71 offset:128
  v_mfma_f32_16x16x32_bf16 v[188:191], v[208:211], v[76:79], 0
  ds_write_b128 v68, a[208:211] offset:24576
  v_mfma_f32_16x16x32_bf16 v[192:195], v[208:211], v[80:83], 0
  s_waitcnt lgkmcnt(3)
  v_mfma_f32_16x16x32_bf16 v[184:187], v[212:215], v[84:87], v[184:187]
  ds_read_b128 v[208:211], v70 offset:256
  v_cvt_pk_bf16_f32 v248, v196, v197
  v_mfma_f32_16x16x32_bf16 v[188:191], v[212:215], v[88:91], v[188:191]
  ds_write_b128 v68, a[212:215] offset:25600
  v_mfma_f32_16x16x32_bf16 v[192:195], v[212:215], v[92:95], v[192:195]
  v_cvt_pk_bf16_f32 v249, v198, v199
  s_waitcnt lgkmcnt(4)
  v_mfma_f32_16x16x32_bf16 v[184:187], v[216:219], v[96:99], v[184:187]
  ds_read_b128 v[212:215], v71 offset:256
  v_cvt_pk_bf16_f32 v250, v200, v201
  v_mfma_f32_16x16x32_bf16 v[188:191], v[216:219], v[100:103], v[188:191]
  ds_write_b128 v68, a[216:219] offset:26624
  v_mfma_f32_16x16x32_bf16 v[192:195], v[216:219], v[104:107], v[192:195]
  v_cvt_pk_bf16_f32 v251, v202, v203
  s_waitcnt lgkmcnt(5)
  v_mfma_f32_16x16x32_bf16 v[184:187], v[220:223], v[108:111], v[184:187]
  ds_read_b128 v[216:219], v70 offset:768
  v_accvgpr_write_b32 a74, v248
  v_mfma_f32_16x16x32_bf16 v[188:191], v[220:223], v[112:115], v[188:191]
  ds_write_b128 v68, a[220:223] offset:27648
  v_mfma_f32_16x16x32_bf16 v[192:195], v[220:223], v[116:119], v[192:195]
  v_accvgpr_write_b32 a75, v249
  s_waitcnt lgkmcnt(5)
  v_mfma_f32_16x16x32_bf16 v[184:187], v[208:211], v[120:123], v[184:187]
  ds_read_b128 v[220:223], v71 offset:768
  v_accvgpr_write_b32 a154, v250
  v_mfma_f32_16x16x32_bf16 v[188:191], v[208:211], v[124:127], v[188:191]
  ds_write_b128 v68, a[224:227] offset:28672
  v_mfma_f32_16x16x32_bf16 v[192:195], v[208:211], v[128:131], v[192:195]
  v_accvgpr_write_b32 a155, v251
  s_waitcnt lgkmcnt(5)
  v_mfma_f32_16x16x32_bf16 v[184:187], v[212:215], v[132:135], v[184:187]
  ds_read_b128 v[208:211], v70 offset:896
  s_mov_b64 exec, s[68:69]
  v_cvt_pk_bf16_f32 v180, v204, v205
  v_cvt_pk_bf16_f32 v181, v206, v207
  s_mov_b64 exec, -1
  v_mfma_f32_16x16x32_bf16 v[188:191], v[212:215], v[136:139], v[188:191]
  ds_write_b128 v68, a[228:231] offset:29696
  v_mfma_f32_16x16x32_bf16 v[192:195], v[212:215], v[140:143], v[192:195]
  s_waitcnt lgkmcnt(5)
  v_mfma_f32_16x16x32_bf16 v[196:199], v[216:219], v[72:75], 0
  ds_read_b128 v[212:215], v71 offset:896
  v_mfma_f32_16x16x32_bf16 v[200:203], v[216:219], v[76:79], 0
  ds_write_b128 v68, a[232:235] offset:30720
  v_mfma_f32_16x16x32_bf16 v[204:207], v[216:219], v[80:83], 0
  s_waitcnt lgkmcnt(5)
  v_mfma_f32_16x16x32_bf16 v[196:199], v[220:223], v[84:87], v[196:199]
  ds_read_b128 v[216:219], v70 offset:1024
  v_cvt_pk_bf16_f32 v248, v184, v185
  v_mfma_f32_16x16x32_bf16 v[200:203], v[220:223], v[88:91], v[200:203]
  ds_write_b128 v68, a[236:239] offset:31744
  v_mfma_f32_16x16x32_bf16 v[204:207], v[220:223], v[92:95], v[204:207]
  v_cvt_pk_bf16_f32 v249, v186, v187
  s_waitcnt lgkmcnt(5)
  v_mfma_f32_16x16x32_bf16 v[196:199], v[208:211], v[96:99], v[196:199]
  ds_read_b128 v[220:223], v71 offset:1024
  v_cvt_pk_bf16_f32 v250, v188, v189
  v_mfma_f32_16x16x32_bf16 v[200:203], v[208:211], v[100:103], v[200:203]
  ds_write_b128 v68, a[240:243] offset:32768
  v_mfma_f32_16x16x32_bf16 v[204:207], v[208:211], v[104:107], v[204:207]
  v_cvt_pk_bf16_f32 v251, v190, v191
  s_waitcnt lgkmcnt(5)
  v_mfma_f32_16x16x32_bf16 v[196:199], v[212:215], v[108:111], v[196:199]
  v_accvgpr_write_b32 a76, v248
  v_mfma_f32_16x16x32_bf16 v[200:203], v[212:215], v[112:115], v[200:203]
  ds_write_b128 v68, a[244:247] offset:33792
  v_mfma_f32_16x16x32_bf16 v[204:207], v[212:215], v[116:119], v[204:207]
  v_accvgpr_write_b32 a77, v249
  s_waitcnt lgkmcnt(4)
  v_mfma_f32_16x16x32_bf16 v[196:199], v[216:219], v[120:123], v[196:199]
  v_accvgpr_write_b32 a156, v250
  v_mfma_f32_16x16x32_bf16 v[200:203], v[216:219], v[124:127], v[200:203]
  ds_write_b128 v68, a[248:251] offset:34816
  v_mfma_f32_16x16x32_bf16 v[204:207], v[216:219], v[128:131], v[204:207]
  v_accvgpr_write_b32 a157, v251
  s_waitcnt lgkmcnt(3)
  v_mfma_f32_16x16x32_bf16 v[196:199], v[220:223], v[132:135], v[196:199]
  v_cvt_pk_bf16_f32 v182, v192, v193
  v_cvt_pk_bf16_f32 v183, v194, v195
  v_mfma_f32_16x16x32_bf16 v[200:203], v[220:223], v[136:139], v[200:203]
  ds_write_b128 v68, a[252:255] offset:35840
  v_mfma_f32_16x16x32_bf16 v[204:207], v[220:223], v[140:143], v[204:207]
  s_nop 7
  v_cvt_pk_bf16_f32 v248, v196, v197
  v_cvt_pk_bf16_f32 v249, v198, v199
  v_cvt_pk_bf16_f32 v250, v200, v201
  v_cvt_pk_bf16_f32 v251, v202, v203
  v_accvgpr_write_b32 a78, v248
  v_accvgpr_write_b32 a79, v249
  v_accvgpr_write_b32 a158, v250
  v_accvgpr_write_b32 a159, v251
  s_mov_b64 exec, s[68:69]
  v_cvt_pk_bf16_f32 v182, v204, v205
  v_cvt_pk_bf16_f32 v183, v206, v207
  s_mov_b64 exec, -1
  ds_write_b128 v68, v[224:227] offset:0
  ds_write_b128 v68, v[228:231] offset:1024
  ds_write_b128 v68, v[232:235] offset:2048
  ds_write_b128 v68, v[236:239] offset:3072
  ds_write_b128 v68, v[240:243] offset:4096
  ds_write_b128 v68, v[244:247] offset:5120
  ds_write_b64 v69, v[160:161] offset:6144
  ds_write_b64 v69, v[162:163] offset:6656
  ds_write_b64 v69, v[164:165] offset:7168
  ds_write_b64 v69, v[166:167] offset:7680
  ds_write_b64 v69, v[168:169] offset:8192
  ds_write_b64 v69, v[170:171] offset:8704
  ds_write_b64 v69, v[172:173] offset:9216
  ds_write_b64 v69, v[174:175] offset:9728
  ds_write_b64 v69, v[176:177] offset:10240
  ds_write_b64 v69, v[178:179] offset:10752
  ds_write_b64 v69, v[180:181] offset:11264
  ds_write_b64 v69, v[182:183] offset:11776
  v_lshrrev_b32 v100, 1, v3
  v_lshlrev_b32 v100, 4, v100
  v_and_b32 v101, 8, v2
  v_add_u32 v100, v100, v101
  v_and_b32 v101, 1, v3
  v_lshl_add_u32 v100, v101, 2, v100
  v_bfe_u32 v101, v2, 2, 1
  v_add_u32 v100, v100, v101
  v_mul_u32_u24 v100, 96, v100
  v_and_b32 v101, 3, v2
  v_lshl_add_u32 v100, v101, 3, v100
  s_lshl_b32 s21, s20, 5
  v_add_u32 v100, s21, v100
  v_add_u32 v101, 3072, v100
  v_cndmask_b32 v88, v100, v101, s[68:69]
  v_cndmask_b32 v92, v101, v100, s[68:69]
  v_add_u32 v89, 40960, v88
  v_add_u32 v93, 40960, v92
  v_add_u32 v90, 81920, v88
  v_add_u32 v94, 81920, v92
  v_add_u32 v91, 122880, v88
  v_add_u32 v95, 122880, v92
  v_and_b32 v100, 7, v2
  v_lshl_add_u32 v100, v3, 3, v100
  v_lshrrev_b32 v101, 3, v2
  v_mul_u32_u24 v101, 40960, v101
  v_lshl_add_u32 v96, v100, 4, v101
  v_add_u32 v97, 81920, v96
  s_bfe_u32 s82, s50, 0x10001
  s_lshl_b32 s82, s82, 5
  s_lshr_b32 s21, s50, 2
  s_add_u32 s82, s82, s21
  s_mov_b32 s101, 0
  s_branch fm_13
fm_12:
  s_sleep 8
fm_14:
  buffer_load_dword v66, v67, s[32:35], 0 offen sc1
  buffer_load_dword v42, v41, s[16:19], s76 offen sc1
  s_add_u32 s101, s101, 1
  s_cmp_gt_u32 s101, 131072
  s_cbranch_scc1 end0
fm_13:
  s_waitcnt vmcnt(0)
  s_mov_b32 s84, s83
  v_readlane_b32 s83, v66, 19
  s_sub_u32 s21, s83, 1
  s_lshl_b32 s21, s21, 13
  s_and_b32 s21, s21, 8192
  s_xor_b32 s76, s90, s21
  s_cmp_eq_u32 s83, 0
  s_cbranch_scc1 fm_12
  s_cmp_eq_u32 s84, 0
  s_cbranch_scc1 fm_14
  v_readlane_b32 s22, v66, 0
  v_readlane_b32 s23, v66, 32
  s_add_u32 s22, s22, s23
  v_readlane_b32 s23, v66, 1
  s_add_u32 s22, s22, s23
  v_readlane_b32 s23, v66, 33
  s_add_u32 s22, s22, s23
  v_readlane_b32 s23, v66, 2
  s_add_u32 s22, s22, s23
  v_readlane_b32 s23, v66, 34
  s_add_u32 s22, s22, s23
  v_readlane_b32 s23, v66, 3
  s_add_u32 s22, s22, s23
  v_readlane_b32 s23, v66, 35
  s_add_u32 s22, s22, s23
  v_readlane_b32 s21, v66, 16
  v_cmp_gt_u32 vcc, 2, v42
  s_cmp_lt_u32 s22, 256
  s_cbranch_scc1 fm_12
  s_cmp_lt_u32 s21, 128
  s_cbranch_scc1 fm_12
  s_cbranch_vccnz fm_12
  v_readlane_b32 s21, v66, s82
  v_cmp_ne_u32 vcc, 32, v66
  s_cmp_ge_u32 s21, 32
  s_cselect_b32 s84, 1, 0
  s_andn2_b32 s53, s84, s53
  s_and_b32 s21, vcc_lo, 15
  s_and_b32 s22, vcc_hi, 15
  s_or_b32 s85, s21, s22
  s_xor_b32 s83, s76, s90
  s_lshl_b32 s70, s50, 4
  s_add_u32 s79, s70, s55
  s_add_u32 s70, s70, s51
  s_lshl_b32 s70, s70, 14
  s_lshl_b32 s79, s79, 14
  s_lshl_b32 s21, s56, 11
  s_add_u32 s79, s79, s21
  s_lshl_b32 s72, s50, 16
  s_lshl_b32 s21, s60, 10
  s_add_u32 s72, s72, s21
  s_add_u32 s72, s72, 134217728
  s_mov_b32 s74, 32768
  s_add_u32 s73, s70, s83
  s_add_u32 s70, s73, 4096
  s_add_u32 s72, s72, s83
  s_xor_b32 s21, s83, 8192
  s_add_u32 s79, s79, s21
  s_add_u32 s12, s48, 173080576
  s_addc_u32 s13, s49, 0
  s_mov_b32 s14, 49152
  s_mov_b32 s15, 0x00020000
  s_mov_b32 s16, s48
  s_mov_b32 s17, s49
  s_mov_b32 s18, 171966464
  s_mov_b32 s19, 0x00020000
  s_waitcnt lgkmcnt(0)
  s_lshl_b32 s21, s20, 16
  s_add_u32 s21, s21, s79
  buffer_load_dwordx4 v[144:147], v4, s[16:19], s21 offen sc1
  buffer_load_dwordx4 v[148:151], v4, s[16:19], s21 offen offset:1024 sc1
  v_subrev_u32 v100, 43008, v20
  v_subrev_u32 v101, 43008, v21
  buffer_load_dwordx4 v[112:115], v100, s[16:19], s73 offen sc1
  buffer_load_dwordx2 v[116:117], v101, s[16:19], s73 offen sc1
  v_and_b32 v100, 127, v19
  v_lshl_add_u32 v100, v3, 8, v100
  v_and_b32 v101, 2, v2
  v_cmp_eq_u32 vcc, 0, v101
  s_lshl_b32 s21, s20, 14
  s_lshl_b32 s22, s61, 7
  s_add_u32 s21, s21, s22
  s_add_u32 s21, s21, s72
  v_mov_b32 v152, 0x3f803f80
  v_mov_b32 v153, 0x3f803f80
  v_mov_b32 v154, 0x3f803f80
  v_mov_b32 v155, 0x3f803f80
  s_mov_b64 exec, vcc
  buffer_load_dwordx4 v[152:155], v100, s[16:19], s21 offen sc1
  s_mov_b64 exec, -1
  v_and_b32 v100, 7, v1
  v_mul_u32_u24 v100, 1280, v100
  v_lshrrev_b32 v101, 3, v1
  v_lshl_add_u32 v100, v101, 4, v100
  buffer_load_dwordx4 v[48:51], v100, s[36:39], 0 offen offset:0
  buffer_load_dwordx4 v[52:55], v100, s[36:39], 0 offen offset:128
  buffer_load_dwordx4 v[56:59], v100, s[36:39], 0 offen offset:256
  buffer_load_dwordx4 v[60:63], v100, s[36:39], 0 offen offset:384
  buffer_load_dwordx4 v[64:67], v100, s[36:39], 0 offen offset:512
  buffer_load_dwordx4 v[68:71], v100, s[36:39], 0 offen offset:640
  buffer_load_dwordx4 v[72:75], v100, s[36:39], 0 offen offset:768
  buffer_load_dwordx4 v[76:79], v100, s[36:39], 0 offen offset:896
  buffer_load_dwordx4 v[80:83], v100, s[36:39], 0 offen offset:1024
  buffer_load_dwordx4 v[84:87], v100, s[36:39], 0 offen offset:1152
  s_barrier
  s_cmp_eq_u32 s20, 3
  s_cbranch_scc1 w3_16
  ds_read_b64_tr_b16 a[160:161], v88 offset:12288
  ds_read_b64_tr_b16 a[162:163], v88 offset:12480
  ds_read_b64_tr_b16 a[164:165], v88 offset:18432
  ds_read_b64_tr_b16 a[166:167], v88 offset:18624
  ds_read_b64_tr_b16 a[168:169], v88 offset:24576
  ds_read_b64_tr_b16 a[170:171], v88 offset:24768
  ds_read_b64_tr_b16 a[172:173], v88 offset:30720
  ds_read_b64_tr_b16 a[174:175], v88 offset:30912
  ds_read_b64_tr_b16 a[176:177], v88 offset:0
  ds_read_b64_tr_b16 a[178:179], v88 offset:192
  ds_read_b64_tr_b16 a[180:181], v89 offset:12288
  ds_read_b64_tr_b16 a[182:183], v89 offset:12480
  ds_read_b64_tr_b16 a[184:185], v89 offset:18432
  ds_read_b64_tr_b16 a[186:187], v89 offset:18624
  ds_read_b64_tr_b16 a[188:189], v89 offset:24576
  ds_read_b64_tr_b16 a[190:191], v89 offset:24768
  ds_read_b64_tr_b16 a[192:193], v89 offset:30720
  ds_read_b64_tr_b16 a[194:195], v89 offset:30912
  ds_read_b64_tr_b16 a[196:197], v89 offset:0
  ds_read_b64_tr_b16 a[198:199], v89 offset:192
  ds_read_b64_tr_b16 a[200:201], v90 offset:12288
  ds_read_b64_tr_b16 a[202:203], v90 offset:12480
  ds_read_b64_tr_b16 a[204:205], v90 offset:18432
  ds_read_b64_tr_b16 a[206:207], v90 offset:18624
  ds_read_b64_tr_b16 a[208:209], v90 offset:24576
  ds_read_b64_tr_b16 a[210:211], v90 offset:24768
  ds_read_b64_tr_b16 a[212:213], v90 offset:30720
  ds_read_b64_tr_b16 a[214:215], v90 offset:30912
  ds_read_b64_tr_b16 a[216:217], v90 offset:0
  ds_read_b64_tr_b16 a[218:219], v90 offset:192
  ds_read_b64_tr_b16 a[220:221], v91 offset:12288
  ds_read_b64_tr_b16 a[222:223], v91 offset:12480
  ds_read_b64_tr_b16 a[224:225], v91 offset:18432
  ds_read_b64_tr_b16 a[226:227], v91 offset:18624
  ds_read_b64_tr_b16 a[228:229], v91 offset:24576
  ds_read_b64_tr_b16 a[230:231], v91 offset:24768
  ds_read_b64_tr_b16 a[232:233], v91 offset:30720
  ds_read_b64_tr_b16 a[234:235], v91 offset:30912
  ds_read_b64_tr_b16 a[236:237], v91 offset:0
  ds_read_b64_tr_b16 a[238:239], v91 offset:192
  ds_read_b64_tr_b16 a[240:241], v92 offset:12288
  ds_read_b64_tr_b16 a[242:243], v92 offset:12480
  ds_read_b64_tr_b16 a[244:245], v92 offset:18432
  ds_read_b64_tr_b16 a[246:247], v92 offset:18624
  ds_read_b64_tr_b16 a[248:249], v92 offset:24576
  ds_read_b64_tr_b16 a[250:251], v92 offset:24768
  ds_read_b64_tr_b16 a[252:253], v92 offset:30720
  ds_read_b64_tr_b16 a[254:255], v92 offset:30912
  ds_read_b64_tr_b16 v[192:193], v92 offset:0
  ds_read_b64_tr_b16 v[194:195], v92 offset:192
  ds_read_b64_tr_b16 v[196:197], v93 offset:12288
  ds_read_b64_tr_b16 v[198:199], v93 offset:12480
  ds_read_b64_tr_b16 v[200:201], v93 offset:18432
  ds_read_b64_tr_b16 v[202:203], v93 offset:18624
  ds_read_b64_tr_b16 v[204:205], v93 offset:24576
  ds_read_b64_tr_b16 v[206:207], v93 offset:24768
  ds_read_b64_tr_b16 v[208:209], v93 offset:30720
  ds_read_b64_tr_b16 v[210:211], v93 offset:30912
  ds_read_b64_tr_b16 v[212:213], v93 offset:0
  ds_read_b64_tr_b16 v[214:215], v93 offset:192
  ds_read_b64_tr_b16 v[216:217], v94 offset:12288
  ds_read_b64_tr_b16 v[218:219], v94 offset:12480
  ds_read_b64_tr_b16 v[220:221], v94 offset:18432
  ds_read_b64_tr_b16 v[222:223], v94 offset:18624
  ds_read_b64_tr_b16 v[224:225], v94 offset:24576
  ds_read_b64_tr_b16 v[226:227], v94 offset:24768
  ds_read_b64_tr_b16 v[228:229], v94 offset:30720
  ds_read_b64_tr_b16 v[230:231], v94 offset:30912
  ds_read_b64_tr_b16 v[232:233], v94 offset:0
  ds_read_b64_tr_b16 v[234:235], v94 offset:192
  ds_read_b64_tr_b16 v[236:237], v95 offset:12288
  ds_read_b64_tr_b16 v[238:239], v95 offset:12480
  ds_read_b64_tr_b16 v[240:241], v95 offset:18432
  ds_read_b64_tr_b16 v[242:243], v95 offset:18624
  ds_read_b64_tr_b16 v[244:245], v95 offset:24576
  ds_read_b64_tr_b16 v[246:247], v95 offset:24768
  ds_read_b64_tr_b16 v[248:249], v95 offset:30720
  ds_read_b64_tr_b16 v[250:251], v95 offset:30912
  ds_read_b64_tr_b16 v[252:253], v95 offset:0
  ds_read_b64_tr_b16 v[254:255], v95 offset:192
  s_branch w3_17
w3_16:
  ds_read_b128 a[160:163], v96 offset:36864
  ds_read_b128 a[164:167], v96 offset:37376
  ds_read_b128 a[168:171], v96 offset:37888
  ds_read_b128 a[172:175], v96 offset:38400
  ds_read_b128 a[176:179], v96 offset:38912
  ds_read_b128 a[180:183], v96 offset:39424
  ds_read_b128 a[184:187], v96 offset:39936
  ds_read_b128 a[188:191], v96 offset:40448
  ds_read_b128 a[192:195], v96 offset:6144
  ds_read_b128 a[196:199], v96 offset:6656
  ds_read_b128 a[200:203], v96 offset:7168
  ds_read_b128 a[204:207], v96 offset:7680
  ds_read_b128 a[208:211], v96 offset:8192
  ds_read_b128 a[212:215], v96 offset:8704
  ds_read_b128 a[216:219], v96 offset:9216
  ds_read_b128 a[220:223], v96 offset:9728
  ds_read_b128 a[224:227], v96 offset:10240
  ds_read_b128 a[228:231], v96 offset:10752
  ds_read_b128 a[232:235], v96 offset:11264
  ds_read_b128 a[236:239], v96 offset:11776
  ds_read_b128 a[240:243], v97 offset:36864
  ds_read_b128 a[244:247], v97 offset:37376
  ds_read_b128 a[248:251], v97 offset:37888
  ds_read_b128 a[252:255], v97 offset:38400
  ds_read_b128 v[192:195], v97 offset:38912
  ds_read_b128 v[196:199], v97 offset:39424
  ds_read_b128 v[200:203], v97 offset:39936
  ds_read_b128 v[204:207], v97 offset:40448
  ds_read_b128 v[208:211], v97 offset:6144
  ds_read_b128 v[212:215], v97 offset:6656
  ds_read_b128 v[216:219], v97 offset:7168
  ds_read_b128 v[220:223], v97 offset:7680
  ds_read_b128 v[224:227], v97 offset:8192
  ds_read_b128 v[228:231], v97 offset:8704
  ds_read_b128 v[232:235], v97 offset:9216
  ds_read_b128 v[236:239], v97 offset:9728
  ds_read_b128 v[240:243], v97 offset:10240
  ds_read_b128 v[244:247], v97 offset:10752
  ds_read_b128 v[248:251], v97 offset:11264
  ds_read_b128 v[252:255], v97 offset:11776
w3_17:
  s_cmp_eq_u32 s85, 0
  s_cbranch_scc1 fm_15
  s_cmp_eq_u32 s20, 3
  s_cbranch_scc1 ar_19
  s_mov_b64 exec, s[64:65]
  s_cmp_eq_u32 s20, 2
  s_cbranch_scc1 ar_18
  s_mov_b32 s21, 0
  buffer_store_dwordx2 v[28:29], v8, s[8:11], s21 offen sc1
  s_mov_b32 s21, 122880
  buffer_store_dwordx2 v[28:29], v8, s[8:11], s21 offen sc1
  s_mov_b32 s21, 245760
  buffer_store_dwordx2 v[28:29], v8, s[8:11], s21 offen sc1
  s_mov_b32 s21, 368640
  buffer_store_dwordx2 v[28:29], v8, s[8:11], s21 offen sc1
  s_branch ar_20
ar_18:
  s_mov_b32 s21, 0
  buffer_store_dword v28, v8, s[8:11], s21 offen sc1
  buffer_store_dword v28, v8, s[8:11], s21 offen offset:128 sc1
  s_mov_b32 s21, 122880
  buffer_store_dword v28, v8, s[8:11], s21 offen sc1
  buffer_store_dword v28, v8, s[8:11], s21 offen offset:128 sc1
  s_mov_b32 s21, 245760
  buffer_store_dword v28, v8, s[8:11], s21 offen sc1
  buffer_store_dword v28, v8, s[8:11], s21 offen offset:128 sc1
  s_mov_b32 s21, 368640
  buffer_store_dword v28, v8, s[8:11], s21 offen sc1
  buffer_store_dword v28, v8, s[8:11], s21 offen offset:128 sc1
ar_20:
  s_cmp_eq_u32 s78, 0
  s_cbranch_scc1 ar_21
  s_mov_b64 exec, s[62:63]
  s_add_u32 s21, s77, 0
  buffer_store_dword v28, v17, s[8:11], s21 offen sc1
  s_add_u32 s21, s77, 122880
  buffer_store_dword v28, v17, s[8:11], s21 offen sc1
  s_add_u32 s21, s77, 245760
  buffer_store_dword v28, v17, s[8:11], s21 offen sc1
  s_add_u32 s21, s77, 368640
  buffer_store_dword v28, v17, s[8:11], s21 offen sc1
  s_branch ar_21
ar_19:
  buffer_store_dword v28, v34, s[8:11], 0 offen sc1
  s_mov_b64 exec, s[66:67]
  s_mov_b32 s21, 0
  buffer_store_dwordx4 v[28:31], v15, s[4:7], s21 offen sc1
  s_mov_b32 s21, 262144
  buffer_store_dwordx4 v[28:31], v15, s[4:7], s21 offen sc1
  s_mov_b32 s21, 524288
  buffer_store_dwordx4 v[28:31], v15, s[4:7], s21 offen sc1
  s_mov_b32 s21, 786432
  buffer_store_dwordx4 v[28:31], v15, s[4:7], s21 offen sc1
  s_mov_b32 s21, 8192
  buffer_store_dwordx4 v[28:31], v15, s[4:7], s21 offen sc1
  s_mov_b32 s21, 270336
  buffer_store_dwordx4 v[28:31], v15, s[4:7], s21 offen sc1
  s_mov_b32 s21, 532480
  buffer_store_dwordx4 v[28:31], v15, s[4:7], s21 offen sc1
  s_mov_b32 s21, 794624
  buffer_store_dwordx4 v[28:31], v15, s[4:7], s21 offen sc1
ar_21:
  s_mov_b64 exec, -1
  s_waitcnt vmcnt(0)
  s_barrier
  s_mov_b32 s21, 100
  s_cmp_lg_u32 s20, 0
  s_cbranch_scc1 af_22
  v_mov_b32 v166, 0
  v_mov_b32 v167, 1
  s_mov_b64 exec, 1
  buffer_atomic_add v167, v166, s[32:35], s21 offen sc1
  s_mov_b64 exec, -1
  s_nop 1
af_22:
  s_cmp_lg_u32 s20, 0
  s_cbranch_scc1 wf_24
  v_mov_b32 v166, 0
  s_mov_b32 s101, 0
wf_23:
  buffer_load_dword v167, v166, s[32:35], s21 offen sc1
  s_add_u32 s101, s101, 1
  s_cmp_gt_u32 s101, 131072
  s_cbranch_scc1 end0
  s_waitcnt vmcnt(0)
  v_readfirstlane_b32 s100, v167
  s_cmp_ge_u32 s100, 128
  s_cbranch_scc1 wf_24
  s_sleep 8
  s_branch wf_23
wf_24:
  s_barrier
fm_15:
  s_xor_b32 s74, s74, 16384
  s_add_u32 s73, s73, 2097152
  s_xor_b32 s73, s73, 8192
  s_add_u32 s79, s79, 2097152
  s_xor_b32 s79, s79, 8192
  s_add_u32 s21, s72, 524288
  s_xor_b32 s72, s72, s21
  s_lshr_b32 s72, s72, 8
  s_and_b32 s72, s72, 8192
  s_xor_b32 s72, s72, s21
  s_add_u32 s71, s73, 4096
  s_mov_b32 s91, 1024
  s_cmp_lt_u32 s73, 0
  s_cselect_b32 s71, s71, s79
  s_cselect_b32 s91, s91, 65536
  v_add_u32 v15, s83, v15
  v_add_u32 v16, s83, v16
  s_mov_b32 s75, s77
  s_lshl_b32 s77, s58, 7
  s_lshl_b32 s21, s56, 3
  s_add_u32 s77, s77, s21
  s_add_u32 s77, s77, 0
  s_xor_b32 s77, s77, s83
  s_mov_b32 s80, 0x53800000
  s_mov_b32 s52, 0
  s_mov_b32 s81, 0
  v_xor_b32 v18, 16384, v18
  v_xor_b32 v19, 16384, v19
  v_xor_b32 v20, 16384, v20
  v_xor_b32 v21, 16384, v21
  v_mov_b32 v168, 0x3f803f80
  v_mov_b32 v169, 0x3f803f80
  v_mov_b32 v170, 0x3f803f80
  v_mov_b32 v171, 0x3f803f80
  v_mov_b32 v166, 0x3f003f00
  v_mov_b32 v167, 0x3f003f00
  s_waitcnt lgkmcnt(0)
  s_barrier
  ds_write_b128 v23, v[168:171] offset:46080
  ds_write_b128 v23, v[168:171] offset:62464
  ds_write_b64 v23, v[166:167] offset:13568
  v_mov_b32 v88, 0
  v_mov_b32 v89, 0
  v_mov_b32 v90, 0
  v_mov_b32 v91, 0
  v_mov_b32 v92, 0
  v_mov_b32 v93, 0
  v_mov_b32 v94, 0
  v_mov_b32 v95, 0
  v_mov_b32 v96, 0
  v_mov_b32 v97, 0
  v_mov_b32 v98, 0
  v_mov_b32 v99, 0
  v_mov_b32 v100, 0
  v_mov_b32 v101, 0
  v_mov_b32 v102, 0
  v_mov_b32 v103, 0
  v_mov_b32 v110, 0
  v_mov_b32 v111, 0
  v_mov_b32 v118, 0
  v_mov_b32 v119, 0
  v_mov_b32 v142, 0
  v_mov_b32 v143, 0
  v_mov_b32 v162, 0
  v_mov_b32 v163, 0
  s_and_b32 s21, s52, 3
  s_mul_i32 s56, s21, 122880
  s_add_u32 s21, s52, 1
  s_and_b32 s21, s21, 3
  s_mul_i32 s55, s21, 122880
  s_add_u32 s55, s55, s75
  s_add_u32 s21, s52, 2
  s_and_b32 s21, s21, 3
  s_mul_i32 s57, s21, 122880
  s_add_u32 s21, s52, 3
  s_and_b32 s21, s21, 3
  s_mul_i32 s59, s21, 122880
  s_add_u32 s59, s59, s75
  s_bfe_u32 s61, s52, 0x10002
  s_and_b32 s21, s52, 3
  s_lshl_b32 s60, s21, 18
  s_mov_b32 s58, s55
  s_waitcnt lgkmcnt(0)
  s_mov_b32 s90, 0x40000000
  s_lshl_b32 s21, s53, 2
  s_add_u32 s21, s21, s20
  s_cmp_eq_u32 s21, 0
  s_cbranch_scc1 E_25
  s_cmp_eq_u32 s21, 4
  s_cbranch_scc1 E_26
  s_cmp_eq_u32 s21, 1
  s_cbranch_scc1 E_27
  s_cmp_eq_u32 s21, 5
  s_cbranch_scc1 E_28
  s_cmp_eq_u32 s21, 2
  s_cbranch_scc1 E_29
  s_cmp_eq_u32 s21, 6
  s_cbranch_scc1 E_30
  s_cmp_eq_u32 s21, 3
  s_cbranch_scc1 E_31
  s_cmp_eq_u32 s21, 7
  s_cbranch_scc1 E_32
  s_branch end0
E_26:
  v_add_u32 v190, 0, v4
  s_waitcnt vmcnt(0)
  ds_write_b128 v190, v[48:51] offset:0
  ds_write_b128 v190, v[52:55] offset:1024
  ds_write_b128 v190, v[56:59] offset:2048
  s_add_u32 m0, s74, 9216
  s_add_u32 s21, s72, 32768
  buffer_load_dwordx4 v32, s[16:19], s21 offen sc1 lds
  s_add_u32 m0, s74, 2048
  s_mul_i32 s21, s91, 1
  s_add_u32 s21, s21, s71
  buffer_load_dwordx4 v4, s[16:19], s21 offen sc1 lds
  s_xor_b32 s74, s74, 16384
  s_add_u32 s73, s73, 2097152
  s_xor_b32 s73, s73, 8192
  s_add_u32 s79, s79, 2097152
  s_xor_b32 s79, s79, 8192
  s_add_u32 s21, s72, 524288
  s_xor_b32 s72, s72, s21
  s_lshr_b32 s72, s72, 8
  s_and_b32 s72, s72, 8192
  s_xor_b32 s72, s72, s21
  s_add_u32 s71, s73, 4096
  s_mov_b32 s91, 1024
  s_cmp_lt_u32 s73, 0
  s_cselect_b32 s71, s71, s79
  s_cselect_b32 s91, s91, 65536
  s_branch mo_38
  .p2align 3
top_33:
  s_waitcnt vmcnt(2)
  ds_write_b128 v190, v[48:51] offset:0
  v_cmp_eq_u32 s[22:23], -1, v48
  s_waitcnt vmcnt(1)
  ds_write_b128 v190, v[52:55] offset:1024
  v_cmp_eq_u32 s[98:99], -1, v52
  s_waitcnt vmcnt(0)
  ds_write_b128 v190, v[56:59] offset:2048
  v_cmp_eq_u32 s[100:101], -1, v56
  s_or_b64 vcc, s[22:23], s[98:99]
  s_or_b64 vcc, vcc, s[100:101]
  s_cbranch_scc1 mr_34
mo_38:
  s_waitcnt lgkmcnt(0)
  s_barrier
  ds_read_b128 v[60:63], v4 offset:3072
  ds_read_b128 v[64:67], v4 offset:4096
  v_smfmac_f32_16x16x64_bf16 v[92:95], v[48:51], a[240:247], v22
  ds_read_b128 v[68:71], v4 offset:5120
  v_smfmac_f32_16x16x64_bf16 v[88:91], v[48:51], a[160:167], v22
  ds_read_b128 v[72:75], v4 offset:6144
  v_smfmac_f32_16x16x64_bf16 v[92:95], v[52:55], a[248:255], v22
  ds_read_b128 v[76:79], v4 offset:7168
  v_smfmac_f32_16x16x64_bf16 v[88:91], v[52:55], a[168:175], v22
  ds_read_b128 v[80:83], v4 offset:8192
  v_smfmac_f32_16x16x64_bf16 v[92:95], v[56:59], v[192:199], v22
  ds_read_b128 v[84:87], v4 offset:9216
  v_smfmac_f32_16x16x64_bf16 v[88:91], v[56:59], a[176:183], v22
  s_waitcnt lgkmcnt(6)
  v_smfmac_f32_16x16x64_bf16 v[92:95], v[60:63], v[200:207], v22
  v_smfmac_f32_16x16x64_bf16 v[88:91], v[60:63], a[184:191], v22
  s_waitcnt lgkmcnt(5)
  v_smfmac_f32_16x16x64_bf16 v[92:95], v[64:67], v[208:215], v22
  s_waitcnt lgkmcnt(4)
  v_smfmac_f32_16x16x64_bf16 v[92:95], v[68:71], v[216:223], v22
  s_waitcnt lgkmcnt(3)
  v_smfmac_f32_16x16x64_bf16 v[92:95], v[72:75], v[224:231], v22
  s_waitcnt lgkmcnt(2)
  v_smfmac_f32_16x16x64_bf16 v[92:95], v[76:79], v[232:239], v22
  s_waitcnt lgkmcnt(1)
  v_smfmac_f32_16x16x64_bf16 v[92:95], v[80:83], v[240:247], v22
  s_waitcnt lgkmcnt(0)
  v_smfmac_f32_16x16x64_bf16 v[92:95], v[84:87], v[248:255], v22
  v_smfmac_f32_16x16x64_bf16 v[88:91], v[64:67], a[192:199], v22
  v_smfmac_f32_16x16x64_bf16 v[88:91], v[68:71], a[200:207], v22
  v_smfmac_f32_16x16x64_bf16 v[88:91], v[72:75], a[208:215], v22
  v_permlane32_swap_b32 v92, v93
  v_smfmac_f32_16x16x64_bf16 v[88:91], v[76:79], a[216:223], v22
  v_permlane32_swap_b32 v94, v95
  v_smfmac_f32_16x16x64_bf16 v[88:91], v[80:83], a[224:231], v22
  v_permlane32_swap_b32 v93, v92
  v_smfmac_f32_16x16x64_bf16 v[88:91], v[84:87], a[232:239], v22
  v_permlane32_swap_b32 v95, v94
  v_pk_mul_f32 v[120:121], v[92:93], v[24:25] op_sel:[1,0] op_sel_hi:[0,1]
  v_pk_mul_f32 v[122:123], v[94:95], v[24:25] op_sel:[1,0] op_sel_hi:[0,1]
  s_nop 4
  v_pk_fma_f32 v[88:89], v[88:89], v[24:25], v[120:121]
  v_pk_fma_f32 v[90:91], v[90:91], v[24:25], v[122:123]
  v_cvt_pk_bf16_f32 v120, v88, v89
  v_cvt_pk_bf16_f32 v121, v90, v91
  ds_write_b64 v6, v[120:121]
  v_cmp_u_f32 vcc, v88, v89
  v_cmp_u_f32 s[22:23], v90, v91
  s_nop 1
  s_or_b64 vcc, vcc, s[22:23]
  s_cbranch_vccnz mn_35
mk_36:
  s_waitcnt lgkmcnt(0)
  s_barrier
  ds_read_b64_tr_b16 v[104:105], v7 offset:0
  ds_read_b64_tr_b16 v[106:107], v7 offset:768
  ds_read_b64_tr_b16 v[108:109], v7 offset:1536
  ds_read_b64 v[140:141], v11
  s_cmp_eq_u32 s52, 63
  s_cbranch_scc1 last_37
  s_waitcnt lgkmcnt(2)
  v_mfma_f32_16x16x32_bf16 v[120:123], v[112:115], v[104:107], 0
  s_waitcnt lgkmcnt(1)
  v_mfma_f32_16x16x32_bf16 v[120:123], v[116:119], v[108:111], v[120:123]
  s_mov_b64 exec, s[64:65]
  s_nop 6
  v_cvt_pk_f16_f32 v120, v120, v121
  v_cvt_pk_f16_f32 v121, v122, v123
  buffer_store_dwordx2 v[120:121], v8, s[8:11], s56 offen
  s_mov_b64 exec, -1
  s_sleep 3
  s_nop 1
  v_smfmac_f32_16x16x64_bf16 v[96:99], v[48:51], a[0:7], v22
  v_smfmac_f32_16x16x64_bf16 v[100:103], v[48:51], a[80:87], v22
  v_smfmac_f32_16x16x64_bf16 v[96:99], v[52:55], a[8:15], v22
  v_smfmac_f32_16x16x64_bf16 v[100:103], v[52:55], a[88:95], v22
  v_smfmac_f32_16x16x64_bf16 v[96:99], v[56:59], a[16:23], v22
  v_smfmac_f32_16x16x64_bf16 v[100:103], v[56:59], a[96:103], v22
  v_smfmac_f32_16x16x64_bf16 v[96:99], v[60:63], a[24:31], v22
  v_smfmac_f32_16x16x64_bf16 v[96:99], v[64:67], a[32:39], v22
  v_smfmac_f32_16x16x64_bf16 v[96:99], v[68:71], a[40:47], v22
  v_smfmac_f32_16x16x64_bf16 v[96:99], v[72:75], a[48:55], v22
  v_smfmac_f32_16x16x64_bf16 v[96:99], v[76:79], a[56:63], v22
  buffer_load_dwordx4 v[124:127], v9, s[8:11], s56 offen sc1
  v_smfmac_f32_16x16x64_bf16 v[96:99], v[80:83], a[64:71], v22
  buffer_load_dwordx4 v[128:131], v9, s[8:11], s56 offen offset:1024 sc1
  v_smfmac_f32_16x16x64_bf16 v[96:99], v[84:87], a[72:79], v22
  buffer_load_dwordx4 v[132:135], v10, s[8:11], s56 offen sc1
  v_smfmac_f32_16x16x64_bf16 v[100:103], v[60:63], a[104:111], v22
  v_smfmac_f32_16x16x64_bf16 v[100:103], v[64:67], a[112:119], v22
  v_smfmac_f32_16x16x64_bf16 v[100:103], v[68:71], a[120:127], v22
  v_smfmac_f32_16x16x64_bf16 v[100:103], v[72:75], a[128:135], v22
  v_cvt_pk_bf16_f32 v136, v96, v97
  v_smfmac_f32_16x16x64_bf16 v[100:103], v[76:79], a[136:143], v22
  v_cvt_pk_bf16_f32 v137, v98, v99
  v_smfmac_f32_16x16x64_bf16 v[100:103], v[80:83], a[144:151], v22
  v_smfmac_f32_16x16x64_bf16 v[100:103], v[84:87], a[152:159], v22
  s_waitcnt vmcnt(2)
  v_pk_add_f16 v172, v124, v126
  v_pk_add_f16 v173, v125, v127
  s_waitcnt vmcnt(1)
  v_pk_add_f16 v174, v128, v130
  v_pk_add_f16 v175, v129, v131
  v_fma_mix_f32 v166, v172, 1.0, v174 op_sel:[0,0,0] op_sel_hi:[1,0,1]
  v_fma_mix_f32 v168, v173, 1.0, v175 op_sel:[0,0,0] op_sel_hi:[1,0,1]
  s_waitcnt vmcnt(0)
  v_pk_add_f16 v176, v132, v133
  v_pk_add_f16 v177, v134, v135
  v_fma_mix_f32 v170, v176, 1.0, v177 op_sel:[0,0,0] op_sel_hi:[1,0,1]
  v_fma_mix_f32 v167, v172, 1.0, v174 op_sel:[1,0,1] op_sel_hi:[1,0,1]
  v_cmp_u_f32 vcc, v166, v170
  v_fma_mix_f32 v169, v173, 1.0, v175 op_sel:[1,0,1] op_sel_hi:[1,0,1]
  v_fma_mix_f32 v171, v176, 1.0, v177 op_sel:[1,0,1] op_sel_hi:[1,0,1]
  v_cvt_pk_bf16_f32 v138, v100, v101
  s_cbranch_vccnz sr_39
sj_40:
ex_41:
  v_exp_f32 v172, v166
  v_exp_f32 v173, v167
  v_exp_f32 v174, v168
  v_cvt_pk_bf16_f32 v156, v172, v173
  v_exp_f32 v175, v169
  v_exp_f32 v176, v170
  v_cvt_pk_bf16_f32 v157, v174, v175
  v_mov_b32_dpp v158, v156 row_ror:8 row_mask:0xf bank_mask:0xf
  v_exp_f32 v177, v171
  v_mov_b32_dpp v159, v157 row_ror:8 row_mask:0xf bank_mask:0xf
  v_cvt_pk_bf16_f32 v160, v176, v177
  v_cvt_pk_bf16_f32 v139, v102, v103
  v_mfma_f32_16x16x32_bf16 v[178:181], v[152:155], v[156:159], 0
  s_waitcnt lgkmcnt(0)
  v_mov_b32_dpp v161, v160 row_ror:8 row_mask:0xf bank_mask:0xf
  v_mfma_f32_16x16x32_bf16 v[182:185], v[144:147], v[156:159], 0
  s_nop 0
  v_mfma_f32_16x16x32_bf16 v[178:181], v[140:143], v[160:163], v[178:181]
  v_mfma_f32_16x16x32_bf16 v[182:185], v[136:139], v[160:163], v[182:185]
  v_mfma_f32_16x16x32_bf16 v[186:189], v[148:151], v[156:159], 0
  v_mfma_f32_16x16x32_bf16 v[186:189], v[138:141], v[160:163], v[186:189]
  s_mov_b64 exec, s[62:63]
  v_rcp_f32 v164, v180
  s_nop 0
  v_pk_mul_f32 v[178:179], v[178:179], v[164:165] op_sel_hi:[1,0]
  v_pk_mul_f32 v[182:183], v[182:183], v[164:165] op_sel_hi:[1,0]
  v_pk_mul_f32 v[184:185], v[184:185], v[164:165] op_sel_hi:[1,0]
  v_cvt_pk_f16_f32 v64, v178, v179
  v_cvt_pk_f16_f32 v60, v182, v183
  v_pk_mul_f32 v[186:187], v[186:187], v[164:165] op_sel_hi:[1,0]
  v_pk_mul_f32 v[188:189], v[188:189], v[164:165] op_sel_hi:[1,0]
  v_cvt_pk_f16_f32 v61, v184, v185
  v_cvt_pk_f16_f32 v62, v186, v187
  v_cvt_pk_f16_f32 v63, v188, v189
  ds_write_b128 v13, v[60:63]
  ds_write_b32 v14, v64
  v_add_f32 v165, v164, v180
  v_cmp_ngt_f32 vcc, s80, v165
  s_mov_b64 exec, -1
  s_nop 0
  s_cbranch_vccnz fx_42
fk_43:
  s_waitcnt lgkmcnt(0)
  s_barrier
  s_add_u32 m0, s74, 9216
  s_add_u32 s21, s72, 32768
  buffer_load_dwordx4 v32, s[16:19], s21 offen sc1 lds
  s_add_u32 m0, s74, 2048
  s_mul_i32 s21, s91, 1
  s_add_u32 s21, s21, s71
  buffer_load_dwordx4 v4, s[16:19], s21 offen sc1 lds
  s_xor_b32 s74, s74, 16384
  s_add_u32 s73, s73, 2097152
  s_xor_b32 s73, s73, 8192
  s_add_u32 s79, s79, 2097152
  s_xor_b32 s79, s79, 8192
  s_add_u32 s21, s72, 524288
  s_xor_b32 s72, s72, s21
  s_lshr_b32 s72, s72, 8
  s_and_b32 s72, s72, 8192
  s_xor_b32 s72, s72, s21
  s_add_u32 s71, s73, 4096
  s_mov_b32 s91, 1024
  s_cmp_lt_u32 s73, 0
  s_cselect_b32 s71, s71, s79
  s_cselect_b32 s91, s91, 65536
  s_nop 15
  s_nop 3
  v_permlane32_swap_b32 v96, v100
  v_permlane32_swap_b32 v97, v101
  v_permlane32_swap_b32 v98, v102
  v_permlane32_swap_b32 v99, v103
  v_pk_add_f32 v[96:97], v[96:97], v[100:101]
  v_pk_add_f32 v[98:99], v[98:99], v[102:103]
  v_cvt_pk_bf16_f32 v182, v96, v97
  v_cvt_pk_bf16_f32 v183, v98, v99
  v_min_u32 v182, -2, v182
  ds_write_b64 v26, v[182:183]
  ds_read_b128 v[144:147], v18
  ds_read_b128 v[148:151], v18 offset:1024
  ds_read_b128 v[152:155], v19
  ds_read_b128 v[112:115], v20
  ds_read_b64 v[116:117], v21
  v_xor_b32 v18, 16384, v18
  v_xor_b32 v19, 16384, v19
  v_xor_b32 v20, 16384, v20
  v_xor_b32 v21, 16384, v21
  v_mov_b32 v88, 0
  v_mov_b32 v89, 0
  v_mov_b32 v90, 0
  v_mov_b32 v91, 0
  v_mov_b32 v92, 0
  v_mov_b32 v93, 0
  v_mov_b32 v94, 0
  v_mov_b32 v95, 0
  v_mov_b32 v96, 0
  v_mov_b32 v97, 0
  v_mov_b32 v98, 0
  v_mov_b32 v99, 0
  v_mov_b32 v100, 0
  v_mov_b32 v101, 0
  v_mov_b32 v102, 0
  v_mov_b32 v103, 0
  s_mov_b32 s81, 0
  s_waitcnt lgkmcnt(0)
  s_barrier
  s_mov_b64 exec, s[64:65]
  buffer_store_dwordx2 v[28:29], v8, s[8:11], s57 offen
  s_mov_b64 exec, s[62:63]
  buffer_store_dword v28, v17, s[8:11], s59 offen
  s_mov_b64 exec, -1
  s_sleep 6
  s_nop 3
  buffer_load_dwordx4 v[68:71], v16, s[4:7], s60 offen sc1
  s_sleep 3
  s_nop 1
  buffer_load_dwordx4 v[72:75], v16, s[4:7], s60 offen sc1
  s_waitcnt vmcnt(1)
  v_mfma_f32_16x16x32_f16 v[120:123], v[44:47], v[68:71], 0
  v_bitop3_b32 v27, v68, s61, 1 bitop3:0x28
  v_cmp_ne_u32 vcc, 0, v27
  s_nop 1
  s_cbranch_vccnz p2_48
  s_nop 2
pg_47:
  v_add_f32_dpp v120, v120, v120 row_ror:8 row_mask:0xf bank_mask:0xf
  v_add_f32_dpp v121, v121, v121 row_ror:8 row_mask:0xf bank_mask:0xf
  s_mov_b64 exec, s[62:63]
  v_cvt_pk_bf16_f32 v120, v120, v121
  v_min_u32 v120, -2, v120
  buffer_store_dword v120, v17, s[8:11], s55 offen
  s_mov_b64 exec, -1
nt_44:
  s_barrier
  s_mov_b32 s58, s55
  s_add_u32 s52, s52, 1
  s_and_b32 s21, s52, 3
  s_mul_i32 s56, s21, 122880
  s_add_u32 s21, s52, 1
  s_and_b32 s21, s21, 3
  s_mul_i32 s55, s21, 122880
  s_add_u32 s55, s55, s75
  s_add_u32 s21, s52, 2
  s_and_b32 s21, s21, 3
  s_mul_i32 s57, s21, 122880
  s_add_u32 s21, s52, 3
  s_and_b32 s21, s21, 3
  s_mul_i32 s59, s21, 122880
  s_add_u32 s59, s59, s75
  s_bfe_u32 s61, s52, 0x10002
  s_and_b32 s21, s52, 3
  s_lshl_b32 s60, s21, 18
  s_mov_b32 s54, 0
  s_sleep 3
  s_nop 2
  buffer_load_dwordx4 v[48:51], v190, s[8:11], s58 offen offset:0 sc1
  buffer_load_dwordx4 v[52:55], v190, s[8:11], s58 offen offset:1024 sc1
  buffer_load_dwordx4 v[56:59], v190, s[8:11], s58 offen offset:2048 sc1
  s_branch top_33
mr_34:
  s_mov_b64 exec, s[22:23]
  s_cbranch_execz ms_49
  buffer_load_dwordx4 v[48:51], v190, s[8:11], s58 offen offset:0 sc1
ms_49:
  s_mov_b64 exec, s[98:99]
  s_cbranch_execz ms_50
  buffer_load_dwordx4 v[52:55], v190, s[8:11], s58 offen offset:1024 sc1
ms_50:
  s_mov_b64 exec, s[100:101]
  s_cbranch_execz ms_51
  buffer_load_dwordx4 v[56:59], v190, s[8:11], s58 offen offset:2048 sc1
ms_51:
  s_add_u32 s54, s54, 1
  s_cmp_gt_u32 s54, 131072
  s_cbranch_scc1 end0
  s_waitcnt vmcnt(0)
  s_mov_b64 exec, s[22:23]
  ds_write_b128 v190, v[48:51] offset:0
  v_cmp_eq_u32 s[22:23], -1, v48
  s_mov_b64 exec, s[98:99]
  ds_write_b128 v190, v[52:55] offset:1024
  v_cmp_eq_u32 s[98:99], -1, v52
  s_mov_b64 exec, s[100:101]
  ds_write_b128 v190, v[56:59] offset:2048
  v_cmp_eq_u32 s[100:101], -1, v56
  s_mov_b64 exec, -1
  s_or_b64 vcc, s[22:23], s[98:99]
  s_or_b64 vcc, vcc, s[100:101]
  s_cbranch_scc1 mr_34
  s_branch mo_38
mn_35:
  v_max3_u32 v27, v48, v49, v50
  v_max3_u32 v27, v27, v51, v52
  v_max3_u32 v27, v27, v53, v54
  v_max3_u32 v27, v27, v55, v56
  v_max3_u32 v27, v27, v57, v58
  v_max3_u32 v27, v27, v59, v60
  v_max3_u32 v27, v27, v61, v62
  v_max3_u32 v27, v27, v63, v64
  v_max3_u32 v27, v27, v65, v66
  v_max3_u32 v27, v27, v67, v68
  v_max3_u32 v27, v27, v69, v70
  v_max3_u32 v27, v27, v71, v72
  v_max3_u32 v27, v27, v73, v74
  v_max3_u32 v27, v27, v75, v76
  v_max3_u32 v27, v27, v77, v78
  v_max3_u32 v27, v27, v79, v80
  v_max3_u32 v27, v27, v81, v82
  v_max3_u32 v27, v27, v83, v84
  v_max3_u32 v27, v27, v85, v86
  v_max3_u32 v27, v27, v87, v87
  v_cmp_eq_u32 vcc, -1, v27
  s_cmp_eq_u32 s52, 0
  s_cbranch_scc1 mk_36
  s_cbranch_vccz mk_36
  s_waitcnt lgkmcnt(0)
  s_barrier
  s_nop 7
  v_mov_b32 v88, 0
  v_mov_b32 v89, 0
  v_mov_b32 v90, 0
  v_mov_b32 v91, 0
  v_mov_b32 v92, 0
  v_mov_b32 v93, 0
  v_mov_b32 v94, 0
  v_mov_b32 v95, 0
  v_mov_b32 v96, 0
  v_mov_b32 v97, 0
  v_mov_b32 v98, 0
  v_mov_b32 v99, 0
  v_mov_b32 v100, 0
  v_mov_b32 v101, 0
  v_mov_b32 v102, 0
  v_mov_b32 v103, 0
  s_mov_b64 s[22:23], -1
  s_mov_b64 s[98:99], -1
  s_mov_b64 s[100:101], -1
  s_branch mr_34
sr_39:
  s_mov_b32 s54, 0
sr_52:
  s_mov_b64 exec, vcc
  buffer_load_dwordx4 v[124:127], v9, s[8:11], s56 offen sc1
  buffer_load_dwordx4 v[128:131], v9, s[8:11], s56 offen offset:1024 sc1
  buffer_load_dwordx4 v[132:135], v10, s[8:11], s56 offen sc1
  s_mov_b64 exec, -1
  s_add_u32 s54, s54, 1
  s_cmp_gt_u32 s54, 131072
  s_cbranch_scc1 end0
  s_and_b32 s21, s54, 31
  s_cbranch_scc0 sr_53
  s_waitcnt vmcnt(0)
  v_pk_add_f16 v172, v124, v126
  v_pk_add_f16 v173, v125, v127
  v_pk_add_f16 v174, v128, v130
  v_pk_add_f16 v175, v129, v131
  v_fma_mix_f32 v166, v172, 1.0, v174 op_sel:[0,0,0] op_sel_hi:[1,0,1]
  v_fma_mix_f32 v168, v173, 1.0, v175 op_sel:[0,0,0] op_sel_hi:[1,0,1]
  v_pk_add_f16 v176, v132, v133
  v_pk_add_f16 v177, v134, v135
  v_add_f32 v27, v166, v168
  v_fma_mix_f32 v170, v176, 1.0, v177 op_sel:[0,0,0] op_sel_hi:[1,0,1]
  v_fma_mix_f32 v167, v172, 1.0, v174 op_sel:[1,0,1] op_sel_hi:[1,0,1]
  v_cmp_u_f32 vcc, v27, v170
  v_fma_mix_f32 v169, v173, 1.0, v175 op_sel:[1,0,1] op_sel_hi:[1,0,1]
  v_fma_mix_f32 v171, v176, 1.0, v177 op_sel:[1,0,1] op_sel_hi:[1,0,1]
  s_cbranch_vccnz sr_52
  s_branch sj_40
sr_53:
  s_waitcnt vmcnt(0)
  v_pk_add_f16 v172, v124, v126
  v_pk_add_f16 v173, v125, v127
  v_pk_add_f16 v174, v128, v130
  v_pk_add_f16 v175, v129, v131
  v_fma_mix_f32 v166, v172, 1.0, v174 op_sel:[0,0,0] op_sel_hi:[1,0,1]
  v_fma_mix_f32 v168, v173, 1.0, v175 op_sel:[0,0,0] op_sel_hi:[1,0,1]
  v_pk_add_f16 v176, v132, v133
  v_pk_add_f16 v177, v134, v135
  v_add_f32 v27, v166, v168
  v_fma_mix_f32 v170, v176, 1.0, v177 op_sel:[0,0,0] op_sel_hi:[1,0,1]
  v_fma_mix_f32 v167, v172, 1.0, v174 op_sel:[1,0,1] op_sel_hi:[1,0,1]
  v_cmp_u_f32 vcc, v27, v170
  v_fma_mix_f32 v169, v173, 1.0, v175 op_sel:[1,0,1] op_sel_hi:[1,0,1]
  v_fma_mix_f32 v171, v176, 1.0, v177 op_sel:[1,0,1] op_sel_hi:[1,0,1]
  v_max3_u32 v27, v124, v126, v128
  v_max3_u32 v27, v27, v130, v132
  v_max3_u32 v27, v27, v133, v134
  v_max3_u32 v27, v27, v135, v135
  v_cmp_eq_u32 vcc, -1, v27
  s_nop 1
  s_cbranch_vccnz sr_52
  s_branch sj_40
fx_42:
  s_cmp_eq_u32 s81, 1
  s_cbranch_scc1 fk_43
  s_mov_b32 s81, 1
  v_max3_f32 v164, v166, v167, v168
  v_max3_f32 v165, v169, v170, v171
  v_max_f32 v164, v164, v165
  s_nop 1
  v_max_f32_dpp v164, v164, v164 row_ror:8 row_mask:0xf bank_mask:0xf
  v_mov_b32 v165, v164
  s_nop 1
  v_permlane32_swap_b32 v164, v165
  v_max_f32 v164, v164, v165
  v_mov_b32 v165, v164
  s_nop 1
  v_permlane16_swap_b32 v164, v165
  v_max_f32 v164, v164, v165
  v_sub_f32 v166, v166, v164
  v_sub_f32 v167, v167, v164
  v_sub_f32 v168, v168, v164
  v_sub_f32 v169, v169, v164
  v_sub_f32 v170, v170, v164
  v_sub_f32 v171, v171, v164
  s_branch ex_41
p2_48:
  s_mov_b32 s54, 0
  buffer_load_dwordx4 v[68:71], v16, s[4:7], s60 offen sc1
  s_waitcnt vmcnt(1)
  v_mfma_f32_16x16x32_f16 v[120:123], v[44:47], v[72:75], 0
  v_bitop3_b32 v27, v72, s61, 1 bitop3:0x28
  v_cmp_ne_u32 vcc, 0, v27
  s_nop 1
  s_cbranch_vccz pg_47
  buffer_load_dwordx4 v[72:75], v16, s[4:7], s60 offen sc1
pp_46:
  s_waitcnt vmcnt(1)
  v_mfma_f32_16x16x32_f16 v[120:123], v[44:47], v[68:71], 0
  v_bitop3_b32 v27, v68, s61, 1 bitop3:0x28
  v_cmp_ne_u32 vcc, 0, v27
  s_nop 1
  s_cbranch_vccz pg_47
  buffer_load_dwordx4 v[68:71], v16, s[4:7], s60 offen sc1
  s_waitcnt vmcnt(1)
  v_mfma_f32_16x16x32_f16 v[120:123], v[44:47], v[72:75], 0
  v_bitop3_b32 v27, v72, s61, 1 bitop3:0x28
  v_cmp_ne_u32 vcc, 0, v27
  s_nop 1
  s_cbranch_vccz pg_47
  buffer_load_dwordx4 v[72:75], v16, s[4:7], s60 offen sc1
  s_add_u32 s54, s54, 1
  s_cmp_gt_u32 s54, 131072
  s_cbranch_scc1 end0
  s_branch pp_46
last_37:
  v_smfmac_f32_16x16x64_bf16 v[96:99], v[48:51], a[0:7], v22
  v_smfmac_f32_16x16x64_bf16 v[100:103], v[48:51], a[80:87], v22
  v_smfmac_f32_16x16x64_bf16 v[96:99], v[52:55], a[8:15], v22
  v_smfmac_f32_16x16x64_bf16 v[100:103], v[52:55], a[88:95], v22
  v_smfmac_f32_16x16x64_bf16 v[96:99], v[56:59], a[16:23], v22
  v_smfmac_f32_16x16x64_bf16 v[100:103], v[56:59], a[96:103], v22
  v_smfmac_f32_16x16x64_bf16 v[96:99], v[60:63], a[24:31], v22
  v_smfmac_f32_16x16x64_bf16 v[96:99], v[64:67], a[32:39], v22
  v_smfmac_f32_16x16x64_bf16 v[96:99], v[68:71], a[40:47], v22
  v_smfmac_f32_16x16x64_bf16 v[96:99], v[72:75], a[48:55], v22
  v_smfmac_f32_16x16x64_bf16 v[96:99], v[76:79], a[56:63], v22
  v_smfmac_f32_16x16x64_bf16 v[96:99], v[80:83], a[64:71], v22
  v_smfmac_f32_16x16x64_bf16 v[96:99], v[84:87], a[72:79], v22
  v_smfmac_f32_16x16x64_bf16 v[100:103], v[60:63], a[104:111], v22
  v_smfmac_f32_16x16x64_bf16 v[100:103], v[64:67], a[112:119], v22
  v_smfmac_f32_16x16x64_bf16 v[100:103], v[68:71], a[120:127], v22
  v_smfmac_f32_16x16x64_bf16 v[100:103], v[72:75], a[128:135], v22
  v_smfmac_f32_16x16x64_bf16 v[100:103], v[76:79], a[136:143], v22
  v_smfmac_f32_16x16x64_bf16 v[100:103], v[80:83], a[144:151], v22
  v_smfmac_f32_16x16x64_bf16 v[100:103], v[84:87], a[152:159], v22
  s_nop 7
  v_permlane32_swap_b32 v96, v100
  v_permlane32_swap_b32 v97, v101
  v_permlane32_swap_b32 v98, v102
  v_permlane32_swap_b32 v99, v103
  v_pk_add_f32 v[96:97], v[96:97], v[100:101]
  v_pk_add_f32 v[98:99], v[98:99], v[102:103]
  v_cvt_pk_bf16_f32 v182, v96, v97
  v_cvt_pk_bf16_f32 v183, v98, v99
  v_min_u32 v182, -2, v182
  ds_write_b64 v26, v[182:183]
  s_waitcnt lgkmcnt(0)
  s_barrier
  s_branch chain_done
E_28:
  v_add_u32 v190, 3072, v4
  s_waitcnt vmcnt(0)
  ds_write_b128 v190, v[60:63] offset:0
  ds_write_b128 v190, v[64:67] offset:1024
  ds_write_b128 v190, v[68:71] offset:2048
  s_add_u32 m0, s74, 6144
  s_add_u32 s21, s79, 196608
  buffer_load_dwordx4 v4, s[16:19], s21 offen offset:1024 sc1 lds
  s_add_u32 m0, s74, 4096
  s_mul_i32 s21, s91, 2
  s_add_u32 s21, s21, s71
  buffer_load_dwordx4 v4, s[16:19], s21 offen sc1 lds
  s_xor_b32 s74, s74, 16384
  s_add_u32 s73, s73, 2097152
  s_xor_b32 s73, s73, 8192
  s_add_u32 s79, s79, 2097152
  s_xor_b32 s79, s79, 8192
  s_add_u32 s21, s72, 524288
  s_xor_b32 s72, s72, s21
  s_lshr_b32 s72, s72, 8
  s_and_b32 s72, s72, 8192
  s_xor_b32 s72, s72, s21
  s_add_u32 s71, s73, 4096
  s_mov_b32 s91, 1024
  s_cmp_lt_u32 s73, 0
  s_cselect_b32 s71, s71, s79
  s_cselect_b32 s91, s91, 65536
  s_branch mo_59
  .p2align 3
top_54:
  s_waitcnt vmcnt(2)
  ds_write_b128 v190, v[60:63] offset:0
  v_cmp_eq_u32 s[22:23], -1, v60
  s_waitcnt vmcnt(1)
  ds_write_b128 v190, v[64:67] offset:1024
  v_cmp_eq_u32 s[98:99], -1, v64
  s_waitcnt vmcnt(0)
  ds_write_b128 v190, v[68:71] offset:2048
  v_cmp_eq_u32 s[100:101], -1, v68
  s_or_b64 vcc, s[22:23], s[98:99]
  s_or_b64 vcc, vcc, s[100:101]
  s_cbranch_scc1 mr_55
mo_59:
  s_waitcnt lgkmcnt(0)
  s_barrier
  ds_read_b128 v[48:51], v4 offset:0
  ds_read_b128 v[52:55], v4 offset:1024
  v_smfmac_f32_16x16x64_bf16 v[92:95], v[60:63], v[200:207], v22
  ds_read_b128 v[56:59], v4 offset:2048
  v_smfmac_f32_16x16x64_bf16 v[88:91], v[60:63], a[184:191], v22
  ds_read_b128 v[72:75], v4 offset:6144
  v_smfmac_f32_16x16x64_bf16 v[92:95], v[64:67], v[208:215], v22
  ds_read_b128 v[76:79], v4 offset:7168
  v_smfmac_f32_16x16x64_bf16 v[88:91], v[64:67], a[192:199], v22
  ds_read_b128 v[80:83], v4 offset:8192
  v_smfmac_f32_16x16x64_bf16 v[92:95], v[68:71], v[216:223], v22
  ds_read_b128 v[84:87], v4 offset:9216
  v_smfmac_f32_16x16x64_bf16 v[88:91], v[68:71], a[200:207], v22
  s_waitcnt lgkmcnt(6)
  v_smfmac_f32_16x16x64_bf16 v[92:95], v[48:51], a[240:247], v22
  v_smfmac_f32_16x16x64_bf16 v[88:91], v[48:51], a[160:167], v22
  s_waitcnt lgkmcnt(5)
  v_smfmac_f32_16x16x64_bf16 v[92:95], v[52:55], a[248:255], v22
  s_waitcnt lgkmcnt(4)
  v_smfmac_f32_16x16x64_bf16 v[92:95], v[56:59], v[192:199], v22
  s_waitcnt lgkmcnt(3)
  v_smfmac_f32_16x16x64_bf16 v[92:95], v[72:75], v[224:231], v22
  s_waitcnt lgkmcnt(2)
  v_smfmac_f32_16x16x64_bf16 v[92:95], v[76:79], v[232:239], v22
  s_waitcnt lgkmcnt(1)
  v_smfmac_f32_16x16x64_bf16 v[92:95], v[80:83], v[240:247], v22
  s_waitcnt lgkmcnt(0)
  v_smfmac_f32_16x16x64_bf16 v[92:95], v[84:87], v[248:255], v22
  v_smfmac_f32_16x16x64_bf16 v[88:91], v[52:55], a[168:175], v22
  v_smfmac_f32_16x16x64_bf16 v[88:91], v[56:59], a[176:183], v22
  v_smfmac_f32_16x16x64_bf16 v[88:91], v[72:75], a[208:215], v22
  v_permlane32_swap_b32 v92, v93
  v_smfmac_f32_16x16x64_bf16 v[88:91], v[76:79], a[216:223], v22
  v_permlane32_swap_b32 v94, v95
  v_smfmac_f32_16x16x64_bf16 v[88:91], v[80:83], a[224:231], v22
  v_permlane32_swap_b32 v93, v92
  v_smfmac_f32_16x16x64_bf16 v[88:91], v[84:87], a[232:239], v22
  v_permlane32_swap_b32 v95, v94
  v_pk_mul_f32 v[120:121], v[92:93], v[24:25] op_sel:[1,0] op_sel_hi:[0,1]
  v_pk_mul_f32 v[122:123], v[94:95], v[24:25] op_sel:[1,0] op_sel_hi:[0,1]
  s_nop 4
  v_pk_fma_f32 v[88:89], v[88:89], v[24:25], v[120:121]
  v_pk_fma_f32 v[90:91], v[90:91], v[24:25], v[122:123]
  v_cvt_pk_bf16_f32 v120, v88, v89
  v_cvt_pk_bf16_f32 v121, v90, v91
  ds_write_b64 v6, v[120:121]
  v_cmp_u_f32 vcc, v88, v89
  v_cmp_u_f32 s[22:23], v90, v91
  s_nop 1
  s_or_b64 vcc, vcc, s[22:23]
  s_cbranch_vccnz mn_56
mk_57:
  s_waitcnt lgkmcnt(0)
  s_barrier
  ds_read_b64_tr_b16 v[104:105], v7 offset:0
  ds_read_b64_tr_b16 v[106:107], v7 offset:768
  ds_read_b64_tr_b16 v[108:109], v7 offset:1536
  ds_read_b64 v[140:141], v11
  s_cmp_eq_u32 s52, 63
  s_cbranch_scc1 last_58
  s_waitcnt lgkmcnt(2)
  v_mfma_f32_16x16x32_bf16 v[120:123], v[112:115], v[104:107], 0
  s_waitcnt lgkmcnt(1)
  v_mfma_f32_16x16x32_bf16 v[120:123], v[116:119], v[108:111], v[120:123]
  s_mov_b64 exec, s[64:65]
  s_nop 6
  v_cvt_pk_f16_f32 v120, v120, v121
  v_cvt_pk_f16_f32 v121, v122, v123
  buffer_store_dwordx2 v[120:121], v8, s[8:11], s56 offen
  s_mov_b64 exec, -1
  s_sleep 3
  s_nop 1
  v_smfmac_f32_16x16x64_bf16 v[96:99], v[48:51], a[0:7], v22
  v_smfmac_f32_16x16x64_bf16 v[100:103], v[48:51], a[80:87], v22
  v_smfmac_f32_16x16x64_bf16 v[96:99], v[52:55], a[8:15], v22
  v_smfmac_f32_16x16x64_bf16 v[100:103], v[52:55], a[88:95], v22
  v_smfmac_f32_16x16x64_bf16 v[96:99], v[56:59], a[16:23], v22
  v_smfmac_f32_16x16x64_bf16 v[100:103], v[56:59], a[96:103], v22
  v_smfmac_f32_16x16x64_bf16 v[96:99], v[60:63], a[24:31], v22
  v_smfmac_f32_16x16x64_bf16 v[96:99], v[64:67], a[32:39], v22
  v_smfmac_f32_16x16x64_bf16 v[96:99], v[68:71], a[40:47], v22
  v_smfmac_f32_16x16x64_bf16 v[96:99], v[72:75], a[48:55], v22
  v_smfmac_f32_16x16x64_bf16 v[96:99], v[76:79], a[56:63], v22
  buffer_load_dwordx4 v[124:127], v9, s[8:11], s56 offen sc1
  v_smfmac_f32_16x16x64_bf16 v[96:99], v[80:83], a[64:71], v22
  buffer_load_dwordx4 v[128:131], v9, s[8:11], s56 offen offset:1024 sc1
  v_smfmac_f32_16x16x64_bf16 v[96:99], v[84:87], a[72:79], v22
  buffer_load_dwordx4 v[132:135], v10, s[8:11], s56 offen sc1
  v_smfmac_f32_16x16x64_bf16 v[100:103], v[60:63], a[104:111], v22
  v_smfmac_f32_16x16x64_bf16 v[100:103], v[64:67], a[112:119], v22
  v_smfmac_f32_16x16x64_bf16 v[100:103], v[68:71], a[120:127], v22
  v_smfmac_f32_16x16x64_bf16 v[100:103], v[72:75], a[128:135], v22
  v_cvt_pk_bf16_f32 v136, v96, v97
  v_smfmac_f32_16x16x64_bf16 v[100:103], v[76:79], a[136:143], v22
  v_cvt_pk_bf16_f32 v137, v98, v99
  v_smfmac_f32_16x16x64_bf16 v[100:103], v[80:83], a[144:151], v22
  v_smfmac_f32_16x16x64_bf16 v[100:103], v[84:87], a[152:159], v22
  s_waitcnt vmcnt(2)
  v_pk_add_f16 v172, v124, v126
  v_pk_add_f16 v173, v125, v127
  s_waitcnt vmcnt(1)
  v_pk_add_f16 v174, v128, v130
  v_pk_add_f16 v175, v129, v131
  v_fma_mix_f32 v166, v172, 1.0, v174 op_sel:[0,0,0] op_sel_hi:[1,0,1]
  v_fma_mix_f32 v168, v173, 1.0, v175 op_sel:[0,0,0] op_sel_hi:[1,0,1]
  s_waitcnt vmcnt(0)
  v_pk_add_f16 v176, v132, v133
  v_pk_add_f16 v177, v134, v135
  v_fma_mix_f32 v170, v176, 1.0, v177 op_sel:[0,0,0] op_sel_hi:[1,0,1]
  v_fma_mix_f32 v167, v172, 1.0, v174 op_sel:[1,0,1] op_sel_hi:[1,0,1]
  v_cmp_u_f32 vcc, v166, v170
  v_fma_mix_f32 v169, v173, 1.0, v175 op_sel:[1,0,1] op_sel_hi:[1,0,1]
  v_fma_mix_f32 v171, v176, 1.0, v177 op_sel:[1,0,1] op_sel_hi:[1,0,1]
  v_cvt_pk_bf16_f32 v138, v100, v101
  s_cbranch_vccnz sr_60
sj_61:
ex_62:
  v_exp_f32 v172, v166
  v_exp_f32 v173, v167
  v_exp_f32 v174, v168
  v_cvt_pk_bf16_f32 v156, v172, v173
  v_exp_f32 v175, v169
  v_exp_f32 v176, v170
  v_cvt_pk_bf16_f32 v157, v174, v175
  v_mov_b32_dpp v158, v156 row_ror:8 row_mask:0xf bank_mask:0xf
  v_exp_f32 v177, v171
  v_mov_b32_dpp v159, v157 row_ror:8 row_mask:0xf bank_mask:0xf
  v_cvt_pk_bf16_f32 v160, v176, v177
  v_cvt_pk_bf16_f32 v139, v102, v103
  v_mfma_f32_16x16x32_bf16 v[178:181], v[152:155], v[156:159], 0
  s_waitcnt lgkmcnt(0)
  v_mov_b32_dpp v161, v160 row_ror:8 row_mask:0xf bank_mask:0xf
  v_mfma_f32_16x16x32_bf16 v[182:185], v[144:147], v[156:159], 0
  s_nop 0
  v_mfma_f32_16x16x32_bf16 v[178:181], v[140:143], v[160:163], v[178:181]
  v_mfma_f32_16x16x32_bf16 v[182:185], v[136:139], v[160:163], v[182:185]
  v_mfma_f32_16x16x32_bf16 v[186:189], v[148:151], v[156:159], 0
  v_mfma_f32_16x16x32_bf16 v[186:189], v[138:141], v[160:163], v[186:189]
  s_mov_b64 exec, s[62:63]
  v_rcp_f32 v164, v180
  s_nop 0
  v_pk_mul_f32 v[178:179], v[178:179], v[164:165] op_sel_hi:[1,0]
  v_pk_mul_f32 v[182:183], v[182:183], v[164:165] op_sel_hi:[1,0]
  v_pk_mul_f32 v[184:185], v[184:185], v[164:165] op_sel_hi:[1,0]
  v_cvt_pk_f16_f32 v64, v178, v179
  v_cvt_pk_f16_f32 v60, v182, v183
  v_pk_mul_f32 v[186:187], v[186:187], v[164:165] op_sel_hi:[1,0]
  v_pk_mul_f32 v[188:189], v[188:189], v[164:165] op_sel_hi:[1,0]
  v_cvt_pk_f16_f32 v61, v184, v185
  v_cvt_pk_f16_f32 v62, v186, v187
  v_cvt_pk_f16_f32 v63, v188, v189
  ds_write_b128 v13, v[60:63]
  ds_write_b32 v14, v64
  v_add_f32 v165, v164, v180
  v_cmp_ngt_f32 vcc, s80, v165
  s_mov_b64 exec, -1
  s_nop 0
  s_cbranch_vccnz fx_63
fk_64:
  s_waitcnt lgkmcnt(0)
  s_barrier
  s_add_u32 m0, s74, 6144
  s_add_u32 s21, s79, 196608
  buffer_load_dwordx4 v4, s[16:19], s21 offen offset:1024 sc1 lds
  s_add_u32 m0, s74, 4096
  s_mul_i32 s21, s91, 2
  s_add_u32 s21, s21, s71
  buffer_load_dwordx4 v4, s[16:19], s21 offen sc1 lds
  s_xor_b32 s74, s74, 16384
  s_add_u32 s73, s73, 2097152
  s_xor_b32 s73, s73, 8192
  s_add_u32 s79, s79, 2097152
  s_xor_b32 s79, s79, 8192
  s_add_u32 s21, s72, 524288
  s_xor_b32 s72, s72, s21
  s_lshr_b32 s72, s72, 8
  s_and_b32 s72, s72, 8192
  s_xor_b32 s72, s72, s21
  s_add_u32 s71, s73, 4096
  s_mov_b32 s91, 1024
  s_cmp_lt_u32 s73, 0
  s_cselect_b32 s71, s71, s79
  s_cselect_b32 s91, s91, 65536
  s_nop 15
  s_nop 3
  v_permlane32_swap_b32 v96, v100
  v_permlane32_swap_b32 v97, v101
  v_permlane32_swap_b32 v98, v102
  v_permlane32_swap_b32 v99, v103
  v_pk_add_f32 v[96:97], v[96:97], v[100:101]
  v_pk_add_f32 v[98:99], v[98:99], v[102:103]
  v_cvt_pk_bf16_f32 v182, v96, v97
  v_cvt_pk_bf16_f32 v183, v98, v99
  v_min_u32 v182, -2, v182
  ds_write_b64 v26, v[182:183]
  ds_read_b128 v[144:147], v18
  ds_read_b128 v[148:151], v18 offset:1024
  ds_read_b128 v[152:155], v19
  ds_read_b128 v[112:115], v20
  ds_read_b64 v[116:117], v21
  v_xor_b32 v18, 16384, v18
  v_xor_b32 v19, 16384, v19
  v_xor_b32 v20, 16384, v20
  v_xor_b32 v21, 16384, v21
  v_mov_b32 v88, 0
  v_mov_b32 v89, 0
  v_mov_b32 v90, 0
  v_mov_b32 v91, 0
  v_mov_b32 v92, 0
  v_mov_b32 v93, 0
  v_mov_b32 v94, 0
  v_mov_b32 v95, 0
  v_mov_b32 v96, 0
  v_mov_b32 v97, 0
  v_mov_b32 v98, 0
  v_mov_b32 v99, 0
  v_mov_b32 v100, 0
  v_mov_b32 v101, 0
  v_mov_b32 v102, 0
  v_mov_b32 v103, 0
  s_mov_b32 s81, 0
  s_waitcnt lgkmcnt(0)
  s_barrier
  s_mov_b64 exec, s[64:65]
  buffer_store_dwordx2 v[28:29], v8, s[8:11], s57 offen
  s_mov_b64 exec, s[62:63]
  buffer_store_dword v28, v17, s[8:11], s59 offen
  s_mov_b64 exec, -1
  s_sleep 6
  s_nop 3
  buffer_load_dwordx4 v[68:71], v16, s[4:7], s60 offen sc1
  s_sleep 3
  s_nop 1
  buffer_load_dwordx4 v[72:75], v16, s[4:7], s60 offen sc1
  s_waitcnt vmcnt(1)
  v_mfma_f32_16x16x32_f16 v[120:123], v[44:47], v[68:71], 0
  v_bitop3_b32 v27, v68, s61, 1 bitop3:0x28
  v_cmp_ne_u32 vcc, 0, v27
  s_nop 1
  s_cbranch_vccnz p2_69
  s_nop 2
pg_68:
  v_add_f32_dpp v120, v120, v120 row_ror:8 row_mask:0xf bank_mask:0xf
  v_add_f32_dpp v121, v121, v121 row_ror:8 row_mask:0xf bank_mask:0xf
  s_mov_b64 exec, s[62:63]
  v_cvt_pk_bf16_f32 v120, v120, v121
  v_min_u32 v120, -2, v120
  buffer_store_dword v120, v17, s[8:11], s55 offen
  s_mov_b64 exec, -1
nt_65:
  s_barrier
  s_mov_b32 s58, s55
  s_add_u32 s52, s52, 1
  s_and_b32 s21, s52, 3
  s_mul_i32 s56, s21, 122880
  s_add_u32 s21, s52, 1
  s_and_b32 s21, s21, 3
  s_mul_i32 s55, s21, 122880
  s_add_u32 s55, s55, s75
  s_add_u32 s21, s52, 2
  s_and_b32 s21, s21, 3
  s_mul_i32 s57, s21, 122880
  s_add_u32 s21, s52, 3
  s_and_b32 s21, s21, 3
  s_mul_i32 s59, s21, 122880
  s_add_u32 s59, s59, s75
  s_bfe_u32 s61, s52, 0x10002
  s_and_b32 s21, s52, 3
  s_lshl_b32 s60, s21, 18
  s_mov_b32 s54, 0
  s_sleep 3
  s_nop 2
  buffer_load_dwordx4 v[60:63], v190, s[8:11], s58 offen offset:0 sc1
  buffer_load_dwordx4 v[64:67], v190, s[8:11], s58 offen offset:1024 sc1
  buffer_load_dwordx4 v[68:71], v190, s[8:11], s58 offen offset:2048 sc1
  s_branch top_54
mr_55:
  s_mov_b64 exec, s[22:23]
  s_cbranch_execz ms_70
  buffer_load_dwordx4 v[60:63], v190, s[8:11], s58 offen offset:0 sc1
ms_70:
  s_mov_b64 exec, s[98:99]
  s_cbranch_execz ms_71
  buffer_load_dwordx4 v[64:67], v190, s[8:11], s58 offen offset:1024 sc1
ms_71:
  s_mov_b64 exec, s[100:101]
  s_cbranch_execz ms_72
  buffer_load_dwordx4 v[68:71], v190, s[8:11], s58 offen offset:2048 sc1
ms_72:
  s_add_u32 s54, s54, 1
  s_cmp_gt_u32 s54, 131072
  s_cbranch_scc1 end0
  s_waitcnt vmcnt(0)
  s_mov_b64 exec, s[22:23]
  ds_write_b128 v190, v[60:63] offset:0
  v_cmp_eq_u32 s[22:23], -1, v60
  s_mov_b64 exec, s[98:99]
  ds_write_b128 v190, v[64:67] offset:1024
  v_cmp_eq_u32 s[98:99], -1, v64
  s_mov_b64 exec, s[100:101]
  ds_write_b128 v190, v[68:71] offset:2048
  v_cmp_eq_u32 s[100:101], -1, v68
  s_mov_b64 exec, -1
  s_or_b64 vcc, s[22:23], s[98:99]
  s_or_b64 vcc, vcc, s[100:101]
  s_cbranch_scc1 mr_55
  s_branch mo_59
mn_56:
  v_max3_u32 v27, v48, v49, v50
  v_max3_u32 v27, v27, v51, v52
  v_max3_u32 v27, v27, v53, v54
  v_max3_u32 v27, v27, v55, v56
  v_max3_u32 v27, v27, v57, v58
  v_max3_u32 v27, v27, v59, v60
  v_max3_u32 v27, v27, v61, v62
  v_max3_u32 v27, v27, v63, v64
  v_max3_u32 v27, v27, v65, v66
  v_max3_u32 v27, v27, v67, v68
  v_max3_u32 v27, v27, v69, v70
  v_max3_u32 v27, v27, v71, v72
  v_max3_u32 v27, v27, v73, v74
  v_max3_u32 v27, v27, v75, v76
  v_max3_u32 v27, v27, v77, v78
  v_max3_u32 v27, v27, v79, v80
  v_max3_u32 v27, v27, v81, v82
  v_max3_u32 v27, v27, v83, v84
  v_max3_u32 v27, v27, v85, v86
  v_max3_u32 v27, v27, v87, v87
  v_cmp_eq_u32 vcc, -1, v27
  s_cmp_eq_u32 s52, 0
  s_cbranch_scc1 mk_57
  s_cbranch_vccz mk_57
  s_waitcnt lgkmcnt(0)
  s_barrier
  s_nop 7
  v_mov_b32 v88, 0
  v_mov_b32 v89, 0
  v_mov_b32 v90, 0
  v_mov_b32 v91, 0
  v_mov_b32 v92, 0
  v_mov_b32 v93, 0
  v_mov_b32 v94, 0
  v_mov_b32 v95, 0
  v_mov_b32 v96, 0
  v_mov_b32 v97, 0
  v_mov_b32 v98, 0
  v_mov_b32 v99, 0
  v_mov_b32 v100, 0
  v_mov_b32 v101, 0
  v_mov_b32 v102, 0
  v_mov_b32 v103, 0
  s_mov_b64 s[22:23], -1
  s_mov_b64 s[98:99], -1
  s_mov_b64 s[100:101], -1
  s_branch mr_55
sr_60:
  s_mov_b32 s54, 0
sr_73:
  s_mov_b64 exec, vcc
  buffer_load_dwordx4 v[124:127], v9, s[8:11], s56 offen sc1
  buffer_load_dwordx4 v[128:131], v9, s[8:11], s56 offen offset:1024 sc1
  buffer_load_dwordx4 v[132:135], v10, s[8:11], s56 offen sc1
  s_mov_b64 exec, -1
  s_add_u32 s54, s54, 1
  s_cmp_gt_u32 s54, 131072
  s_cbranch_scc1 end0
  s_and_b32 s21, s54, 31
  s_cbranch_scc0 sr_74
  s_waitcnt vmcnt(0)
  v_pk_add_f16 v172, v124, v126
  v_pk_add_f16 v173, v125, v127
  v_pk_add_f16 v174, v128, v130
  v_pk_add_f16 v175, v129, v131
  v_fma_mix_f32 v166, v172, 1.0, v174 op_sel:[0,0,0] op_sel_hi:[1,0,1]
  v_fma_mix_f32 v168, v173, 1.0, v175 op_sel:[0,0,0] op_sel_hi:[1,0,1]
  v_pk_add_f16 v176, v132, v133
  v_pk_add_f16 v177, v134, v135
  v_add_f32 v27, v166, v168
  v_fma_mix_f32 v170, v176, 1.0, v177 op_sel:[0,0,0] op_sel_hi:[1,0,1]
  v_fma_mix_f32 v167, v172, 1.0, v174 op_sel:[1,0,1] op_sel_hi:[1,0,1]
  v_cmp_u_f32 vcc, v27, v170
  v_fma_mix_f32 v169, v173, 1.0, v175 op_sel:[1,0,1] op_sel_hi:[1,0,1]
  v_fma_mix_f32 v171, v176, 1.0, v177 op_sel:[1,0,1] op_sel_hi:[1,0,1]
  s_cbranch_vccnz sr_73
  s_branch sj_61
sr_74:
  s_waitcnt vmcnt(0)
  v_pk_add_f16 v172, v124, v126
  v_pk_add_f16 v173, v125, v127
  v_pk_add_f16 v174, v128, v130
  v_pk_add_f16 v175, v129, v131
  v_fma_mix_f32 v166, v172, 1.0, v174 op_sel:[0,0,0] op_sel_hi:[1,0,1]
  v_fma_mix_f32 v168, v173, 1.0, v175 op_sel:[0,0,0] op_sel_hi:[1,0,1]
  v_pk_add_f16 v176, v132, v133
  v_pk_add_f16 v177, v134, v135
  v_add_f32 v27, v166, v168
  v_fma_mix_f32 v170, v176, 1.0, v177 op_sel:[0,0,0] op_sel_hi:[1,0,1]
  v_fma_mix_f32 v167, v172, 1.0, v174 op_sel:[1,0,1] op_sel_hi:[1,0,1]
  v_cmp_u_f32 vcc, v27, v170
  v_fma_mix_f32 v169, v173, 1.0, v175 op_sel:[1,0,1] op_sel_hi:[1,0,1]
  v_fma_mix_f32 v171, v176, 1.0, v177 op_sel:[1,0,1] op_sel_hi:[1,0,1]
  v_max3_u32 v27, v124, v126, v128
  v_max3_u32 v27, v27, v130, v132
  v_max3_u32 v27, v27, v133, v134
  v_max3_u32 v27, v27, v135, v135
  v_cmp_eq_u32 vcc, -1, v27
  s_nop 1
  s_cbranch_vccnz sr_73
  s_branch sj_61
fx_63:
  s_cmp_eq_u32 s81, 1
  s_cbranch_scc1 fk_64
  s_mov_b32 s81, 1
  v_max3_f32 v164, v166, v167, v168
  v_max3_f32 v165, v169, v170, v171
  v_max_f32 v164, v164, v165
  s_nop 1
  v_max_f32_dpp v164, v164, v164 row_ror:8 row_mask:0xf bank_mask:0xf
  v_mov_b32 v165, v164
  s_nop 1
  v_permlane32_swap_b32 v164, v165
  v_max_f32 v164, v164, v165
  v_mov_b32 v165, v164
  s_nop 1
  v_permlane16_swap_b32 v164, v165
  v_max_f32 v164, v164, v165
  v_sub_f32 v166, v166, v164
  v_sub_f32 v167, v167, v164
  v_sub_f32 v168, v168, v164
  v_sub_f32 v169, v169, v164
  v_sub_f32 v170, v170, v164
  v_sub_f32 v171, v171, v164
  s_branch ex_62
p2_69:
  s_mov_b32 s54, 0
  buffer_load_dwordx4 v[68:71], v16, s[4:7], s60 offen sc1
  s_waitcnt vmcnt(1)
  v_mfma_f32_16x16x32_f16 v[120:123], v[44:47], v[72:75], 0
  v_bitop3_b32 v27, v72, s61, 1 bitop3:0x28
  v_cmp_ne_u32 vcc, 0, v27
  s_nop 1
  s_cbranch_vccz pg_68
  buffer_load_dwordx4 v[72:75], v16, s[4:7], s60 offen sc1
pp_67:
  s_waitcnt vmcnt(1)
  v_mfma_f32_16x16x32_f16 v[120:123], v[44:47], v[68:71], 0
  v_bitop3_b32 v27, v68, s61, 1 bitop3:0x28
  v_cmp_ne_u32 vcc, 0, v27
  s_nop 1
  s_cbranch_vccz pg_68
  buffer_load_dwordx4 v[68:71], v16, s[4:7], s60 offen sc1
  s_waitcnt vmcnt(1)
  v_mfma_f32_16x16x32_f16 v[120:123], v[44:47], v[72:75], 0
  v_bitop3_b32 v27, v72, s61, 1 bitop3:0x28
  v_cmp_ne_u32 vcc, 0, v27
  s_nop 1
  s_cbranch_vccz pg_68
  buffer_load_dwordx4 v[72:75], v16, s[4:7], s60 offen sc1
  s_add_u32 s54, s54, 1
  s_cmp_gt_u32 s54, 131072
  s_cbranch_scc1 end0
  s_branch pp_67
last_58:
  v_smfmac_f32_16x16x64_bf16 v[96:99], v[48:51], a[0:7], v22
  v_smfmac_f32_16x16x64_bf16 v[100:103], v[48:51], a[80:87], v22
  v_smfmac_f32_16x16x64_bf16 v[96:99], v[52:55], a[8:15], v22
  v_smfmac_f32_16x16x64_bf16 v[100:103], v[52:55], a[88:95], v22
  v_smfmac_f32_16x16x64_bf16 v[96:99], v[56:59], a[16:23], v22
  v_smfmac_f32_16x16x64_bf16 v[100:103], v[56:59], a[96:103], v22
  v_smfmac_f32_16x16x64_bf16 v[96:99], v[60:63], a[24:31], v22
  v_smfmac_f32_16x16x64_bf16 v[96:99], v[64:67], a[32:39], v22
  v_smfmac_f32_16x16x64_bf16 v[96:99], v[68:71], a[40:47], v22
  v_smfmac_f32_16x16x64_bf16 v[96:99], v[72:75], a[48:55], v22
  v_smfmac_f32_16x16x64_bf16 v[96:99], v[76:79], a[56:63], v22
  v_smfmac_f32_16x16x64_bf16 v[96:99], v[80:83], a[64:71], v22
  v_smfmac_f32_16x16x64_bf16 v[96:99], v[84:87], a[72:79], v22
  v_smfmac_f32_16x16x64_bf16 v[100:103], v[60:63], a[104:111], v22
  v_smfmac_f32_16x16x64_bf16 v[100:103], v[64:67], a[112:119], v22
  v_smfmac_f32_16x16x64_bf16 v[100:103], v[68:71], a[120:127], v22
  v_smfmac_f32_16x16x64_bf16 v[100:103], v[72:75], a[128:135], v22
  v_smfmac_f32_16x16x64_bf16 v[100:103], v[76:79], a[136:143], v22
  v_smfmac_f32_16x16x64_bf16 v[100:103], v[80:83], a[144:151], v22
  v_smfmac_f32_16x16x64_bf16 v[100:103], v[84:87], a[152:159], v22
  s_nop 7
  v_permlane32_swap_b32 v96, v100
  v_permlane32_swap_b32 v97, v101
  v_permlane32_swap_b32 v98, v102
  v_permlane32_swap_b32 v99, v103
  v_pk_add_f32 v[96:97], v[96:97], v[100:101]
  v_pk_add_f32 v[98:99], v[98:99], v[102:103]
  v_cvt_pk_bf16_f32 v182, v96, v97
  v_cvt_pk_bf16_f32 v183, v98, v99
  v_min_u32 v182, -2, v182
  ds_write_b64 v26, v[182:183]
  s_waitcnt lgkmcnt(0)
  s_barrier
  s_branch chain_done
E_30:
  v_add_u32 v190, 6144, v4
  s_waitcnt vmcnt(0)
  ds_write_b128 v190, v[72:75] offset:0
  ds_write_b128 v190, v[76:79] offset:1024
  ds_write_b128 v190, v[80:83] offset:2048
  s_add_u32 m0, s74, 0
  s_mul_i32 s21, s91, 0
  s_add_u32 s21, s21, s71
  buffer_load_dwordx4 v4, s[16:19], s21 offen sc1 lds
  s_add_u32 m0, s74, 6144
  s_mul_i32 s21, s91, 3
  s_add_u32 s21, s21, s71
  buffer_load_dwordx4 v4, s[16:19], s21 offen sc1 lds
  s_xor_b32 s74, s74, 16384
  s_add_u32 s73, s73, 2097152
  s_xor_b32 s73, s73, 8192
  s_add_u32 s79, s79, 2097152
  s_xor_b32 s79, s79, 8192
  s_add_u32 s21, s72, 524288
  s_xor_b32 s72, s72, s21
  s_lshr_b32 s72, s72, 8
  s_and_b32 s72, s72, 8192
  s_xor_b32 s72, s72, s21
  s_add_u32 s71, s73, 4096
  s_mov_b32 s91, 1024
  s_cmp_lt_u32 s73, 0
  s_cselect_b32 s71, s71, s79
  s_cselect_b32 s91, s91, 65536
  s_branch mo_80
  .p2align 3
top_75:
  s_waitcnt vmcnt(2)
  ds_write_b128 v190, v[72:75] offset:0
  v_cmp_eq_u32 s[22:23], -1, v72
  s_waitcnt vmcnt(1)
  ds_write_b128 v190, v[76:79] offset:1024
  v_cmp_eq_u32 s[98:99], -1, v76
  s_waitcnt vmcnt(0)
  ds_write_b128 v190, v[80:83] offset:2048
  v_cmp_eq_u32 s[100:101], -1, v80
  s_or_b64 vcc, s[22:23], s[98:99]
  s_or_b64 vcc, vcc, s[100:101]
  s_cbranch_scc1 mr_76
mo_80:
  s_waitcnt lgkmcnt(0)
  s_barrier
  ds_read_b128 v[48:51], v4 offset:0
  ds_read_b128 v[52:55], v4 offset:1024
  v_smfmac_f32_16x16x64_bf16 v[92:95], v[72:75], v[224:231], v22
  ds_read_b128 v[56:59], v4 offset:2048
  v_smfmac_f32_16x16x64_bf16 v[88:91], v[72:75], a[208:215], v22
  ds_read_b128 v[60:63], v4 offset:3072
  v_smfmac_f32_16x16x64_bf16 v[92:95], v[76:79], v[232:239], v22
  ds_read_b128 v[64:67], v4 offset:4096
  v_smfmac_f32_16x16x64_bf16 v[88:91], v[76:79], a[216:223], v22
  ds_read_b128 v[68:71], v4 offset:5120
  v_smfmac_f32_16x16x64_bf16 v[92:95], v[80:83], v[240:247], v22
  ds_read_b128 v[84:87], v4 offset:9216
  v_smfmac_f32_16x16x64_bf16 v[88:91], v[80:83], a[224:231], v22
  s_waitcnt lgkmcnt(6)
  v_smfmac_f32_16x16x64_bf16 v[92:95], v[48:51], a[240:247], v22
  v_smfmac_f32_16x16x64_bf16 v[88:91], v[48:51], a[160:167], v22
  s_waitcnt lgkmcnt(5)
  v_smfmac_f32_16x16x64_bf16 v[92:95], v[52:55], a[248:255], v22
  s_waitcnt lgkmcnt(4)
  v_smfmac_f32_16x16x64_bf16 v[92:95], v[56:59], v[192:199], v22
  s_waitcnt lgkmcnt(3)
  v_smfmac_f32_16x16x64_bf16 v[92:95], v[60:63], v[200:207], v22
  s_waitcnt lgkmcnt(2)
  v_smfmac_f32_16x16x64_bf16 v[92:95], v[64:67], v[208:215], v22
  s_waitcnt lgkmcnt(1)
  v_smfmac_f32_16x16x64_bf16 v[92:95], v[68:71], v[216:223], v22
  s_waitcnt lgkmcnt(0)
  v_smfmac_f32_16x16x64_bf16 v[92:95], v[84:87], v[248:255], v22
  v_smfmac_f32_16x16x64_bf16 v[88:91], v[52:55], a[168:175], v22
  v_smfmac_f32_16x16x64_bf16 v[88:91], v[56:59], a[176:183], v22
  v_smfmac_f32_16x16x64_bf16 v[88:91], v[60:63], a[184:191], v22
  v_permlane32_swap_b32 v92, v93
  v_smfmac_f32_16x16x64_bf16 v[88:91], v[64:67], a[192:199], v22
  v_permlane32_swap_b32 v94, v95
  v_smfmac_f32_16x16x64_bf16 v[88:91], v[68:71], a[200:207], v22
  v_permlane32_swap_b32 v93, v92
  v_smfmac_f32_16x16x64_bf16 v[88:91], v[84:87], a[232:239], v22
  v_permlane32_swap_b32 v95, v94
  v_pk_mul_f32 v[120:121], v[92:93], v[24:25] op_sel:[1,0] op_sel_hi:[0,1]
  v_pk_mul_f32 v[122:123], v[94:95], v[24:25] op_sel:[1,0] op_sel_hi:[0,1]
  s_nop 4
  v_pk_fma_f32 v[88:89], v[88:89], v[24:25], v[120:121]
  v_pk_fma_f32 v[90:91], v[90:91], v[24:25], v[122:123]
  v_cvt_pk_bf16_f32 v120, v88, v89
  v_cvt_pk_bf16_f32 v121, v90, v91
  ds_write_b64 v6, v[120:121]
  v_cmp_u_f32 vcc, v88, v89
  v_cmp_u_f32 s[22:23], v90, v91
  s_nop 1
  s_or_b64 vcc, vcc, s[22:23]
  s_cbranch_vccnz mn_77
mk_78:
  s_waitcnt lgkmcnt(0)
  s_barrier
  ds_read_b64_tr_b16 v[104:105], v7 offset:0
  ds_read_b64_tr_b16 v[106:107], v7 offset:768
  ds_read_b64_tr_b16 v[108:109], v7 offset:1536
  ds_read_b64 v[140:141], v11
  s_cmp_eq_u32 s52, 63
  s_cbranch_scc1 last_79
  s_waitcnt lgkmcnt(2)
  v_mfma_f32_16x16x32_bf16 v[120:123], v[104:107], v[104:107], 0
  s_waitcnt lgkmcnt(1)
  v_mfma_f32_16x16x32_bf16 v[120:123], v[108:111], v[108:111], v[120:123]
  s_mov_b64 exec, s[64:65]
  s_nop 6
  v_cvt_pk_f16_f32 v120, v120, v121
  buffer_store_dword v120, v8, s[8:11], s56 offen
  v_cvt_pk_f16_f32 v121, v122, v123
  buffer_store_dword v121, v8, s[8:11], s56 offen offset:128
  s_mov_b64 exec, -1
  s_sleep 3
  s_nop 1
  v_smfmac_f32_16x16x64_bf16 v[96:99], v[48:51], a[0:7], v22
  v_smfmac_f32_16x16x64_bf16 v[100:103], v[48:51], a[80:87], v22
  v_smfmac_f32_16x16x64_bf16 v[96:99], v[52:55], a[8:15], v22
  v_smfmac_f32_16x16x64_bf16 v[100:103], v[52:55], a[88:95], v22
  v_smfmac_f32_16x16x64_bf16 v[96:99], v[56:59], a[16:23], v22
  v_smfmac_f32_16x16x64_bf16 v[100:103], v[56:59], a[96:103], v22
  v_smfmac_f32_16x16x64_bf16 v[96:99], v[60:63], a[24:31], v22
  v_smfmac_f32_16x16x64_bf16 v[96:99], v[64:67], a[32:39], v22
  v_smfmac_f32_16x16x64_bf16 v[96:99], v[68:71], a[40:47], v22
  v_smfmac_f32_16x16x64_bf16 v[96:99], v[72:75], a[48:55], v22
  v_smfmac_f32_16x16x64_bf16 v[96:99], v[76:79], a[56:63], v22
  buffer_load_dwordx4 v[124:127], v9, s[8:11], s56 offen sc1
  v_smfmac_f32_16x16x64_bf16 v[96:99], v[80:83], a[64:71], v22
  buffer_load_dwordx4 v[128:131], v9, s[8:11], s56 offen offset:1024 sc1
  v_smfmac_f32_16x16x64_bf16 v[96:99], v[84:87], a[72:79], v22
  buffer_load_dwordx4 v[132:135], v10, s[8:11], s56 offen sc1
  v_smfmac_f32_16x16x64_bf16 v[100:103], v[60:63], a[104:111], v22
  v_smfmac_f32_16x16x64_bf16 v[100:103], v[64:67], a[112:119], v22
  v_smfmac_f32_16x16x64_bf16 v[100:103], v[68:71], a[120:127], v22
  v_smfmac_f32_16x16x64_bf16 v[100:103], v[72:75], a[128:135], v22
  v_cvt_pk_bf16_f32 v136, v96, v97
  v_smfmac_f32_16x16x64_bf16 v[100:103], v[76:79], a[136:143], v22
  v_cvt_pk_bf16_f32 v137, v98, v99
  v_smfmac_f32_16x16x64_bf16 v[100:103], v[80:83], a[144:151], v22
  v_smfmac_f32_16x16x64_bf16 v[100:103], v[84:87], a[152:159], v22
  s_waitcnt vmcnt(2)
  v_pk_add_f16 v172, v124, v126
  v_pk_add_f16 v173, v125, v127
  s_waitcnt vmcnt(1)
  v_pk_add_f16 v174, v128, v130
  v_pk_add_f16 v175, v129, v131
  v_fma_mix_f32 v166, v172, 1.0, v174 op_sel:[0,0,0] op_sel_hi:[1,0,1]
  v_fma_mix_f32 v168, v173, 1.0, v175 op_sel:[0,0,0] op_sel_hi:[1,0,1]
  s_waitcnt vmcnt(0)
  v_pk_add_f16 v176, v132, v133
  v_pk_add_f16 v177, v134, v135
  v_fma_mix_f32 v170, v176, 1.0, v177 op_sel:[0,0,0] op_sel_hi:[1,0,1]
  v_fma_mix_f32 v167, v172, 1.0, v174 op_sel:[1,0,1] op_sel_hi:[1,0,1]
  v_cmp_u_f32 vcc, v166, v170
  v_fma_mix_f32 v169, v173, 1.0, v175 op_sel:[1,0,1] op_sel_hi:[1,0,1]
  v_fma_mix_f32 v171, v176, 1.0, v177 op_sel:[1,0,1] op_sel_hi:[1,0,1]
  v_cvt_pk_bf16_f32 v138, v100, v101
  s_cbranch_vccnz sr_81
sj_82:
ex_83:
  v_exp_f32 v172, v166
  v_exp_f32 v173, v167
  v_exp_f32 v174, v168
  v_cvt_pk_bf16_f32 v156, v172, v173
  v_exp_f32 v175, v169
  v_exp_f32 v176, v170
  v_cvt_pk_bf16_f32 v157, v174, v175
  v_mov_b32_dpp v158, v156 row_ror:8 row_mask:0xf bank_mask:0xf
  v_exp_f32 v177, v171
  v_mov_b32_dpp v159, v157 row_ror:8 row_mask:0xf bank_mask:0xf
  v_cvt_pk_bf16_f32 v160, v176, v177
  v_cvt_pk_bf16_f32 v139, v102, v103
  v_mfma_f32_16x16x32_bf16 v[178:181], v[152:155], v[156:159], 0
  s_waitcnt lgkmcnt(0)
  v_mov_b32_dpp v161, v160 row_ror:8 row_mask:0xf bank_mask:0xf
  v_mfma_f32_16x16x32_bf16 v[182:185], v[144:147], v[156:159], 0
  s_nop 0
  v_mfma_f32_16x16x32_bf16 v[178:181], v[140:143], v[160:163], v[178:181]
  v_mfma_f32_16x16x32_bf16 v[182:185], v[136:139], v[160:163], v[182:185]
  v_mfma_f32_16x16x32_bf16 v[186:189], v[148:151], v[156:159], 0
  v_mfma_f32_16x16x32_bf16 v[186:189], v[138:141], v[160:163], v[186:189]
  s_mov_b64 exec, s[62:63]
  v_rcp_f32 v164, v180
  s_nop 0
  v_pk_mul_f32 v[178:179], v[178:179], v[164:165] op_sel_hi:[1,0]
  v_pk_mul_f32 v[182:183], v[182:183], v[164:165] op_sel_hi:[1,0]
  v_pk_mul_f32 v[184:185], v[184:185], v[164:165] op_sel_hi:[1,0]
  v_cvt_pk_f16_f32 v64, v178, v179
  v_cvt_pk_f16_f32 v60, v182, v183
  v_pk_mul_f32 v[186:187], v[186:187], v[164:165] op_sel_hi:[1,0]
  v_pk_mul_f32 v[188:189], v[188:189], v[164:165] op_sel_hi:[1,0]
  v_cvt_pk_f16_f32 v61, v184, v185
  v_cvt_pk_f16_f32 v62, v186, v187
  v_cvt_pk_f16_f32 v63, v188, v189
  ds_write_b128 v13, v[60:63]
  ds_write_b32 v14, v64
  v_add_f32 v165, v164, v180
  v_cmp_ngt_f32 vcc, s80, v165
  s_mov_b64 exec, -1
  s_nop 0
  s_cbranch_vccnz fx_84
fk_85:
  s_waitcnt lgkmcnt(0)
  s_barrier
  s_add_u32 m0, s74, 0
  s_mul_i32 s21, s91, 0
  s_add_u32 s21, s21, s71
  buffer_load_dwordx4 v4, s[16:19], s21 offen sc1 lds
  s_add_u32 m0, s74, 6144
  s_mul_i32 s21, s91, 3
  s_add_u32 s21, s21, s71
  buffer_load_dwordx4 v4, s[16:19], s21 offen sc1 lds
  s_xor_b32 s74, s74, 16384
  s_add_u32 s73, s73, 2097152
  s_xor_b32 s73, s73, 8192
  s_add_u32 s79, s79, 2097152
  s_xor_b32 s79, s79, 8192
  s_add_u32 s21, s72, 524288
  s_xor_b32 s72, s72, s21
  s_lshr_b32 s72, s72, 8
  s_and_b32 s72, s72, 8192
  s_xor_b32 s72, s72, s21
  s_add_u32 s71, s73, 4096
  s_mov_b32 s91, 1024
  s_cmp_lt_u32 s73, 0
  s_cselect_b32 s71, s71, s79
  s_cselect_b32 s91, s91, 65536
  s_nop 15
  s_nop 3
  v_permlane32_swap_b32 v96, v100
  v_permlane32_swap_b32 v97, v101
  v_permlane32_swap_b32 v98, v102
  v_permlane32_swap_b32 v99, v103
  v_pk_add_f32 v[96:97], v[96:97], v[100:101]
  v_pk_add_f32 v[98:99], v[98:99], v[102:103]
  v_cvt_pk_bf16_f32 v182, v96, v97
  v_cvt_pk_bf16_f32 v183, v98, v99
  v_min_u32 v182, -2, v182
  ds_write_b64 v26, v[182:183]
  ds_read_b128 v[144:147], v18
  ds_read_b128 v[148:151], v18 offset:1024
  ds_read_b128 v[152:155], v19
  v_xor_b32 v18, 16384, v18
  v_xor_b32 v19, 16384, v19
  v_mov_b32 v88, 0
  v_mov_b32 v89, 0
  v_mov_b32 v90, 0
  v_mov_b32 v91, 0
  v_mov_b32 v92, 0
  v_mov_b32 v93, 0
  v_mov_b32 v94, 0
  v_mov_b32 v95, 0
  v_mov_b32 v96, 0
  v_mov_b32 v97, 0
  v_mov_b32 v98, 0
  v_mov_b32 v99, 0
  v_mov_b32 v100, 0
  v_mov_b32 v101, 0
  v_mov_b32 v102, 0
  v_mov_b32 v103, 0
  s_mov_b32 s81, 0
  s_waitcnt lgkmcnt(0)
  s_barrier
  s_mov_b64 exec, s[64:65]
  buffer_store_dword v28, v8, s[8:11], s57 offen
  buffer_store_dword v28, v8, s[8:11], s57 offen offset:128
  s_mov_b64 exec, -1
  s_cmp_eq_u32 s78, 0
  s_cbranch_scc1 nt_87
  s_mov_b64 exec, s[62:63]
  buffer_store_dword v28, v17, s[8:11], s59 offen
  s_mov_b64 exec, -1
  s_sleep 6
  s_nop 3
  buffer_load_dwordx4 v[68:71], v16, s[4:7], s60 offen sc1
  s_sleep 3
  s_nop 1
  buffer_load_dwordx4 v[72:75], v16, s[4:7], s60 offen sc1
  s_waitcnt vmcnt(1)
  v_mfma_f32_16x16x32_f16 v[120:123], v[44:47], v[68:71], 0
  v_bitop3_b32 v27, v68, s61, 1 bitop3:0x28
  v_cmp_ne_u32 vcc, 0, v27
  s_nop 1
  s_cbranch_vccnz p2_90
  s_nop 2
pg_89:
  v_add_f32_dpp v120, v120, v120 row_ror:8 row_mask:0xf bank_mask:0xf
  v_add_f32_dpp v121, v121, v121 row_ror:8 row_mask:0xf bank_mask:0xf
  s_mov_b64 exec, s[62:63]
  v_cvt_pk_bf16_f32 v120, v120, v121
  v_min_u32 v120, -2, v120
  buffer_store_dword v120, v17, s[8:11], s55 offen
  s_mov_b64 exec, -1
nt_86:
  s_barrier
  s_mov_b32 s58, s55
  s_add_u32 s52, s52, 1
  s_and_b32 s21, s52, 3
  s_mul_i32 s56, s21, 122880
  s_add_u32 s21, s52, 1
  s_and_b32 s21, s21, 3
  s_mul_i32 s55, s21, 122880
  s_add_u32 s55, s55, s75
  s_add_u32 s21, s52, 2
  s_and_b32 s21, s21, 3
  s_mul_i32 s57, s21, 122880
  s_add_u32 s21, s52, 3
  s_and_b32 s21, s21, 3
  s_mul_i32 s59, s21, 122880
  s_add_u32 s59, s59, s75
  s_bfe_u32 s61, s52, 0x10002
  s_and_b32 s21, s52, 3
  s_lshl_b32 s60, s21, 18
  s_mov_b32 s54, 0
  s_sleep 3
  s_nop 2
  buffer_load_dwordx4 v[72:75], v190, s[8:11], s58 offen offset:0 sc1
  buffer_load_dwordx4 v[76:79], v190, s[8:11], s58 offen offset:1024 sc1
  buffer_load_dwordx4 v[80:83], v190, s[8:11], s58 offen offset:2048 sc1
  s_branch top_75
mr_76:
  s_mov_b64 exec, s[22:23]
  s_cbranch_execz ms_91
  buffer_load_dwordx4 v[72:75], v190, s[8:11], s58 offen offset:0 sc1
ms_91:
  s_mov_b64 exec, s[98:99]
  s_cbranch_execz ms_92
  buffer_load_dwordx4 v[76:79], v190, s[8:11], s58 offen offset:1024 sc1
ms_92:
  s_mov_b64 exec, s[100:101]
  s_cbranch_execz ms_93
  buffer_load_dwordx4 v[80:83], v190, s[8:11], s58 offen offset:2048 sc1
ms_93:
  s_add_u32 s54, s54, 1
  s_cmp_gt_u32 s54, 131072
  s_cbranch_scc1 end0
  s_waitcnt vmcnt(0)
  s_mov_b64 exec, s[22:23]
  ds_write_b128 v190, v[72:75] offset:0
  v_cmp_eq_u32 s[22:23], -1, v72
  s_mov_b64 exec, s[98:99]
  ds_write_b128 v190, v[76:79] offset:1024
  v_cmp_eq_u32 s[98:99], -1, v76
  s_mov_b64 exec, s[100:101]
  ds_write_b128 v190, v[80:83] offset:2048
  v_cmp_eq_u32 s[100:101], -1, v80
  s_mov_b64 exec, -1
  s_or_b64 vcc, s[22:23], s[98:99]
  s_or_b64 vcc, vcc, s[100:101]
  s_cbranch_scc1 mr_76
  s_branch mo_80
mn_77:
  v_max3_u32 v27, v48, v49, v50
  v_max3_u32 v27, v27, v51, v52
  v_max3_u32 v27, v27, v53, v54
  v_max3_u32 v27, v27, v55, v56
  v_max3_u32 v27, v27, v57, v58
  v_max3_u32 v27, v27, v59, v60
  v_max3_u32 v27, v27, v61, v62
  v_max3_u32 v27, v27, v63, v64
  v_max3_u32 v27, v27, v65, v66
  v_max3_u32 v27, v27, v67, v68
  v_max3_u32 v27, v27, v69, v70
  v_max3_u32 v27, v27, v71, v72
  v_max3_u32 v27, v27, v73, v74
  v_max3_u32 v27, v27, v75, v76
  v_max3_u32 v27, v27, v77, v78
  v_max3_u32 v27, v27, v79, v80
  v_max3_u32 v27, v27, v81, v82
  v_max3_u32 v27, v27, v83, v84
  v_max3_u32 v27, v27, v85, v86
  v_max3_u32 v27, v27, v87, v87
  v_cmp_eq_u32 vcc, -1, v27
  s_cmp_eq_u32 s52, 0
  s_cbranch_scc1 mk_78
  s_cbranch_vccz mk_78
  s_waitcnt lgkmcnt(0)
  s_barrier
  s_nop 7
  v_mov_b32 v88, 0
  v_mov_b32 v89, 0
  v_mov_b32 v90, 0
  v_mov_b32 v91, 0
  v_mov_b32 v92, 0
  v_mov_b32 v93, 0
  v_mov_b32 v94, 0
  v_mov_b32 v95, 0
  v_mov_b32 v96, 0
  v_mov_b32 v97, 0
  v_mov_b32 v98, 0
  v_mov_b32 v99, 0
  v_mov_b32 v100, 0
  v_mov_b32 v101, 0
  v_mov_b32 v102, 0
  v_mov_b32 v103, 0
  s_mov_b64 s[22:23], -1
  s_mov_b64 s[98:99], -1
  s_mov_b64 s[100:101], -1
  s_branch mr_76
sr_81:
  s_mov_b32 s54, 0
sr_94:
  s_mov_b64 exec, vcc
  buffer_load_dwordx4 v[124:127], v9, s[8:11], s56 offen sc1
  buffer_load_dwordx4 v[128:131], v9, s[8:11], s56 offen offset:1024 sc1
  buffer_load_dwordx4 v[132:135], v10, s[8:11], s56 offen sc1
  s_mov_b64 exec, -1
  s_add_u32 s54, s54, 1
  s_cmp_gt_u32 s54, 131072
  s_cbranch_scc1 end0
  s_and_b32 s21, s54, 31
  s_cbranch_scc0 sr_95
  s_waitcnt vmcnt(0)
  v_pk_add_f16 v172, v124, v126
  v_pk_add_f16 v173, v125, v127
  v_pk_add_f16 v174, v128, v130
  v_pk_add_f16 v175, v129, v131
  v_fma_mix_f32 v166, v172, 1.0, v174 op_sel:[0,0,0] op_sel_hi:[1,0,1]
  v_fma_mix_f32 v168, v173, 1.0, v175 op_sel:[0,0,0] op_sel_hi:[1,0,1]
  v_pk_add_f16 v176, v132, v133
  v_pk_add_f16 v177, v134, v135
  v_add_f32 v27, v166, v168
  v_fma_mix_f32 v170, v176, 1.0, v177 op_sel:[0,0,0] op_sel_hi:[1,0,1]
  v_fma_mix_f32 v167, v172, 1.0, v174 op_sel:[1,0,1] op_sel_hi:[1,0,1]
  v_cmp_u_f32 vcc, v27, v170
  v_fma_mix_f32 v169, v173, 1.0, v175 op_sel:[1,0,1] op_sel_hi:[1,0,1]
  v_fma_mix_f32 v171, v176, 1.0, v177 op_sel:[1,0,1] op_sel_hi:[1,0,1]
  s_cbranch_vccnz sr_94
  s_branch sj_82
sr_95:
  s_waitcnt vmcnt(0)
  v_pk_add_f16 v172, v124, v126
  v_pk_add_f16 v173, v125, v127
  v_pk_add_f16 v174, v128, v130
  v_pk_add_f16 v175, v129, v131
  v_fma_mix_f32 v166, v172, 1.0, v174 op_sel:[0,0,0] op_sel_hi:[1,0,1]
  v_fma_mix_f32 v168, v173, 1.0, v175 op_sel:[0,0,0] op_sel_hi:[1,0,1]
  v_pk_add_f16 v176, v132, v133
  v_pk_add_f16 v177, v134, v135
  v_add_f32 v27, v166, v168
  v_fma_mix_f32 v170, v176, 1.0, v177 op_sel:[0,0,0] op_sel_hi:[1,0,1]
  v_fma_mix_f32 v167, v172, 1.0, v174 op_sel:[1,0,1] op_sel_hi:[1,0,1]
  v_cmp_u_f32 vcc, v27, v170
  v_fma_mix_f32 v169, v173, 1.0, v175 op_sel:[1,0,1] op_sel_hi:[1,0,1]
  v_fma_mix_f32 v171, v176, 1.0, v177 op_sel:[1,0,1] op_sel_hi:[1,0,1]
  v_max3_u32 v27, v124, v126, v128
  v_max3_u32 v27, v27, v130, v132
  v_max3_u32 v27, v27, v133, v134
  v_max3_u32 v27, v27, v135, v135
  v_cmp_eq_u32 vcc, -1, v27
  s_nop 1
  s_cbranch_vccnz sr_94
  s_branch sj_82
fx_84:
  s_cmp_eq_u32 s81, 1
  s_cbranch_scc1 fk_85
  s_mov_b32 s81, 1
  v_max3_f32 v164, v166, v167, v168
  v_max3_f32 v165, v169, v170, v171
  v_max_f32 v164, v164, v165
  s_nop 1
  v_max_f32_dpp v164, v164, v164 row_ror:8 row_mask:0xf bank_mask:0xf
  v_mov_b32 v165, v164
  s_nop 1
  v_permlane32_swap_b32 v164, v165
  v_max_f32 v164, v164, v165
  v_mov_b32 v165, v164
  s_nop 1
  v_permlane16_swap_b32 v164, v165
  v_max_f32 v164, v164, v165
  v_sub_f32 v166, v166, v164
  v_sub_f32 v167, v167, v164
  v_sub_f32 v168, v168, v164
  v_sub_f32 v169, v169, v164
  v_sub_f32 v170, v170, v164
  v_sub_f32 v171, v171, v164
  s_branch ex_83
nt_87:
  s_branch nt_86
p2_90:
  s_mov_b32 s54, 0
  buffer_load_dwordx4 v[68:71], v16, s[4:7], s60 offen sc1
  s_waitcnt vmcnt(1)
  v_mfma_f32_16x16x32_f16 v[120:123], v[44:47], v[72:75], 0
  v_bitop3_b32 v27, v72, s61, 1 bitop3:0x28
  v_cmp_ne_u32 vcc, 0, v27
  s_nop 1
  s_cbranch_vccz pg_89
  buffer_load_dwordx4 v[72:75], v16, s[4:7], s60 offen sc1
pp_88:
  s_waitcnt vmcnt(1)
  v_mfma_f32_16x16x32_f16 v[120:123], v[44:47], v[68:71], 0
  v_bitop3_b32 v27, v68, s61, 1 bitop3:0x28
  v_cmp_ne_u32 vcc, 0, v27
  s_nop 1
  s_cbranch_vccz pg_89
  buffer_load_dwordx4 v[68:71], v16, s[4:7], s60 offen sc1
  s_waitcnt vmcnt(1)
  v_mfma_f32_16x16x32_f16 v[120:123], v[44:47], v[72:75], 0
  v_bitop3_b32 v27, v72, s61, 1 bitop3:0x28
  v_cmp_ne_u32 vcc, 0, v27
  s_nop 1
  s_cbranch_vccz pg_89
  buffer_load_dwordx4 v[72:75], v16, s[4:7], s60 offen sc1
  s_add_u32 s54, s54, 1
  s_cmp_gt_u32 s54, 131072
  s_cbranch_scc1 end0
  s_branch pp_88
last_79:
  v_smfmac_f32_16x16x64_bf16 v[96:99], v[48:51], a[0:7], v22
  v_smfmac_f32_16x16x64_bf16 v[100:103], v[48:51], a[80:87], v22
  v_smfmac_f32_16x16x64_bf16 v[96:99], v[52:55], a[8:15], v22
  v_smfmac_f32_16x16x64_bf16 v[100:103], v[52:55], a[88:95], v22
  v_smfmac_f32_16x16x64_bf16 v[96:99], v[56:59], a[16:23], v22
  v_smfmac_f32_16x16x64_bf16 v[100:103], v[56:59], a[96:103], v22
  v_smfmac_f32_16x16x64_bf16 v[96:99], v[60:63], a[24:31], v22
  v_smfmac_f32_16x16x64_bf16 v[96:99], v[64:67], a[32:39], v22
  v_smfmac_f32_16x16x64_bf16 v[96:99], v[68:71], a[40:47], v22
  v_smfmac_f32_16x16x64_bf16 v[96:99], v[72:75], a[48:55], v22
  v_smfmac_f32_16x16x64_bf16 v[96:99], v[76:79], a[56:63], v22
  v_smfmac_f32_16x16x64_bf16 v[96:99], v[80:83], a[64:71], v22
  v_smfmac_f32_16x16x64_bf16 v[96:99], v[84:87], a[72:79], v22
  v_smfmac_f32_16x16x64_bf16 v[100:103], v[60:63], a[104:111], v22
  v_smfmac_f32_16x16x64_bf16 v[100:103], v[64:67], a[112:119], v22
  v_smfmac_f32_16x16x64_bf16 v[100:103], v[68:71], a[120:127], v22
  v_smfmac_f32_16x16x64_bf16 v[100:103], v[72:75], a[128:135], v22
  v_smfmac_f32_16x16x64_bf16 v[100:103], v[76:79], a[136:143], v22
  v_smfmac_f32_16x16x64_bf16 v[100:103], v[80:83], a[144:151], v22
  v_smfmac_f32_16x16x64_bf16 v[100:103], v[84:87], a[152:159], v22
  s_nop 7
  v_permlane32_swap_b32 v96, v100
  v_permlane32_swap_b32 v97, v101
  v_permlane32_swap_b32 v98, v102
  v_permlane32_swap_b32 v99, v103
  v_pk_add_f32 v[96:97], v[96:97], v[100:101]
  v_pk_add_f32 v[98:99], v[98:99], v[102:103]
  v_cvt_pk_bf16_f32 v182, v96, v97
  v_cvt_pk_bf16_f32 v183, v98, v99
  v_min_u32 v182, -2, v182
  ds_write_b64 v26, v[182:183]
  s_waitcnt lgkmcnt(0)
  s_barrier
  s_branch chain_done
E_32:
  v_add_u32 v190, 9216, v4
  s_waitcnt vmcnt(0)
  ds_write_b128 v190, v[84:87] offset:0
  s_branch mo_101
  .p2align 3
top_96:
  s_waitcnt vmcnt(0)
  ds_write_b128 v190, v[84:87] offset:0
  v_cmp_eq_u32 s[22:23], -1, v84
  s_or_b64 vcc, s[22:23], s[22:23]
  s_cbranch_scc1 mr_97
mo_101:
  s_waitcnt lgkmcnt(0)
  s_barrier
  ds_read_b128 v[48:51], v4 offset:0
  ds_read_b128 v[52:55], v4 offset:1024
  v_smfmac_f32_16x16x64_bf16 v[92:95], v[84:87], v[248:255], v22
  ds_read_b128 v[56:59], v4 offset:2048
  ds_read_b128 v[60:63], v4 offset:3072
  v_smfmac_f32_16x16x64_bf16 v[88:91], v[84:87], a[232:239], v22
  s_waitcnt lgkmcnt(3)
  s_add_u32 m0, s74, 0
  s_add_u32 s21, s79, 0
  buffer_load_dwordx4 v4, s[16:19], s21 offen offset:1024 sc1 lds
  v_smfmac_f32_16x16x64_bf16 v[92:95], v[48:51], a[240:247], v22
  ds_read_b128 v[64:67], v4 offset:4096
  ds_read_b128 v[68:71], v4 offset:5120
  s_add_u32 s22, s52, 3
  s_min_u32 s22, s22, 64
  v_smfmac_f32_16x16x64_bf16 v[88:91], v[48:51], a[160:167], v22
  s_waitcnt lgkmcnt(4)
  s_add_u32 m0, s74, 2048
  s_add_u32 s21, s79, 65536
  buffer_load_dwordx4 v4, s[16:19], s21 offen offset:1024 sc1 lds
  v_cmp_gt_u32 vcc, s22, v42
  v_smfmac_f32_16x16x64_bf16 v[92:95], v[52:55], a[248:255], v22
  ds_read_b128 v[72:75], v4 offset:6144
  ds_read_b128 v[76:79], v4 offset:7168
  s_cbranch_vccnz kw_102
kv_103:
  v_smfmac_f32_16x16x64_bf16 v[88:91], v[52:55], a[168:175], v22
  s_waitcnt lgkmcnt(5)
  s_add_u32 m0, s74, 4096
  s_add_u32 s21, s79, 131072
  buffer_load_dwordx4 v4, s[16:19], s21 offen offset:1024 sc1 lds
  v_smfmac_f32_16x16x64_bf16 v[92:95], v[56:59], v[192:199], v22
  ds_read_b128 v[80:83], v4 offset:8192
  v_smfmac_f32_16x16x64_bf16 v[88:91], v[56:59], a[176:183], v22
  s_waitcnt lgkmcnt(5)
  s_add_u32 m0, s74, 10240
  s_nop 0
  buffer_load_dwordx4 v4, s[16:19], s73 offen offset:0 sc1 lds
  v_smfmac_f32_16x16x64_bf16 v[92:95], v[60:63], v[200:207], v22
  s_waitcnt lgkmcnt(4)
  v_smfmac_f32_16x16x64_bf16 v[92:95], v[64:67], v[208:215], v22
  s_waitcnt lgkmcnt(3)
  s_add_u32 m0, s74, 10240
  s_nop 0
  buffer_load_dwordx4 v4, s[16:19], s73 offen offset:1024 sc1 lds
  v_smfmac_f32_16x16x64_bf16 v[92:95], v[68:71], v[216:223], v22
  s_waitcnt lgkmcnt(2)
  v_smfmac_f32_16x16x64_bf16 v[92:95], v[72:75], v[224:231], v22
  s_waitcnt lgkmcnt(1)
  s_add_u32 m0, s74, 10240
  s_nop 0
  buffer_load_dwordx4 v4, s[16:19], s73 offen offset:2048 sc1 lds
  v_smfmac_f32_16x16x64_bf16 v[92:95], v[76:79], v[232:239], v22
  s_waitcnt lgkmcnt(0)
  v_smfmac_f32_16x16x64_bf16 v[92:95], v[80:83], v[240:247], v22
  s_add_u32 m0, s74, 8192
  s_add_u32 s21, s72, 0
  buffer_load_dwordx4 v32, s[16:19], s21 offen sc1 lds
  v_smfmac_f32_16x16x64_bf16 v[88:91], v[60:63], a[184:191], v22
  v_smfmac_f32_16x16x64_bf16 v[88:91], v[64:67], a[192:199], v22
  v_smfmac_f32_16x16x64_bf16 v[88:91], v[68:71], a[200:207], v22
  v_cvt_pk_bf16_f32 v122, v92, v93
  v_smfmac_f32_16x16x64_bf16 v[88:91], v[72:75], a[208:215], v22
  v_cvt_pk_bf16_f32 v123, v94, v95
  v_smfmac_f32_16x16x64_bf16 v[88:91], v[76:79], a[216:223], v22
  ds_write_b64 v12, v[122:123] offset:13056
  v_smfmac_f32_16x16x64_bf16 v[88:91], v[80:83], a[224:231], v22
  s_nop 7
  v_cvt_pk_bf16_f32 v120, v88, v89
  v_cvt_pk_bf16_f32 v121, v90, v91
  ds_write_b64 v12, v[120:121] offset:12544
  v_smfmac_f32_16x16x64_bf16 v[96:99], v[48:51], a[0:7], v22
  v_cmp_u_f32 vcc, v88, v89
  v_smfmac_f32_16x16x64_bf16 v[100:103], v[48:51], a[80:87], v22
  v_cmp_u_f32 s[22:23], v90, v91
  s_nop 0
  s_or_b64 vcc, vcc, s[22:23]
  s_cbranch_vccnz mn_98
mk_99:
  s_waitcnt lgkmcnt(0)
  s_barrier
  ds_read_b64_tr_b16 v[104:105], v7 offset:0
  ds_read_b64_tr_b16 v[106:107], v7 offset:768
  ds_read_b64_tr_b16 v[108:109], v7 offset:1536
  ds_read_b64 v[140:141], v11
  s_cmp_eq_u32 s52, 63
  s_cbranch_scc1 last_100
  v_smfmac_f32_16x16x64_bf16 v[96:99], v[52:55], a[8:15], v22
  v_smfmac_f32_16x16x64_bf16 v[100:103], v[52:55], a[88:95], v22
  v_smfmac_f32_16x16x64_bf16 v[96:99], v[56:59], a[16:23], v22
  v_smfmac_f32_16x16x64_bf16 v[100:103], v[56:59], a[96:103], v22
  v_smfmac_f32_16x16x64_bf16 v[96:99], v[60:63], a[24:31], v22
  v_smfmac_f32_16x16x64_bf16 v[96:99], v[64:67], a[32:39], v22
  v_smfmac_f32_16x16x64_bf16 v[96:99], v[68:71], a[40:47], v22
  v_smfmac_f32_16x16x64_bf16 v[96:99], v[72:75], a[48:55], v22
  v_smfmac_f32_16x16x64_bf16 v[96:99], v[76:79], a[56:63], v22
  v_smfmac_f32_16x16x64_bf16 v[96:99], v[80:83], a[64:71], v22
  v_smfmac_f32_16x16x64_bf16 v[96:99], v[84:87], a[72:79], v22
  v_smfmac_f32_16x16x64_bf16 v[100:103], v[60:63], a[104:111], v22
  v_smfmac_f32_16x16x64_bf16 v[100:103], v[64:67], a[112:119], v22
  v_smfmac_f32_16x16x64_bf16 v[100:103], v[68:71], a[120:127], v22
  v_smfmac_f32_16x16x64_bf16 v[100:103], v[72:75], a[128:135], v22
  v_cvt_pk_bf16_f32 v136, v96, v97
  v_smfmac_f32_16x16x64_bf16 v[100:103], v[76:79], a[136:143], v22
  v_cvt_pk_bf16_f32 v137, v98, v99
  v_smfmac_f32_16x16x64_bf16 v[100:103], v[80:83], a[144:151], v22
  v_smfmac_f32_16x16x64_bf16 v[100:103], v[84:87], a[152:159], v22
  s_sleep 2
  s_nop 7
  buffer_load_dwordx4 v[124:127], v9, s[8:11], s56 offen sc1
  buffer_load_dwordx4 v[128:131], v9, s[8:11], s56 offen offset:1024 sc1
  s_nop 5
  buffer_load_dwordx4 v[132:135], v10, s[8:11], s56 offen sc1
  s_waitcnt vmcnt(2)
  v_pk_add_f16 v172, v124, v126
  v_pk_add_f16 v173, v125, v127
  s_waitcnt vmcnt(1)
  v_pk_add_f16 v174, v128, v130
  v_pk_add_f16 v175, v129, v131
  v_fma_mix_f32 v166, v172, 1.0, v174 op_sel:[0,0,0] op_sel_hi:[1,0,1]
  v_fma_mix_f32 v168, v173, 1.0, v175 op_sel:[0,0,0] op_sel_hi:[1,0,1]
  s_waitcnt vmcnt(0)
  v_pk_add_f16 v176, v132, v133
  v_pk_add_f16 v177, v134, v135
  v_fma_mix_f32 v170, v176, 1.0, v177 op_sel:[0,0,0] op_sel_hi:[1,0,1]
  v_fma_mix_f32 v167, v172, 1.0, v174 op_sel:[1,0,1] op_sel_hi:[1,0,1]
  v_cmp_u_f32 vcc, v166, v170
  v_fma_mix_f32 v169, v173, 1.0, v175 op_sel:[1,0,1] op_sel_hi:[1,0,1]
  v_fma_mix_f32 v171, v176, 1.0, v177 op_sel:[1,0,1] op_sel_hi:[1,0,1]
  v_cvt_pk_bf16_f32 v138, v100, v101
  s_cbranch_vccnz sr_104
sj_105:
ex_106:
  v_exp_f32 v172, v166
  v_exp_f32 v173, v167
  v_exp_f32 v174, v168
  v_cvt_pk_bf16_f32 v156, v172, v173
  v_exp_f32 v175, v169
  v_exp_f32 v176, v170
  v_cvt_pk_bf16_f32 v157, v174, v175
  v_mov_b32_dpp v158, v156 row_ror:8 row_mask:0xf bank_mask:0xf
  v_exp_f32 v177, v171
  v_mov_b32_dpp v159, v157 row_ror:8 row_mask:0xf bank_mask:0xf
  v_cvt_pk_bf16_f32 v160, v176, v177
  v_cvt_pk_bf16_f32 v139, v102, v103
  v_mfma_f32_16x16x32_bf16 v[178:181], v[152:155], v[156:159], 0
  s_waitcnt lgkmcnt(0)
  v_mov_b32_dpp v161, v160 row_ror:8 row_mask:0xf bank_mask:0xf
  v_mfma_f32_16x16x32_bf16 v[182:185], v[144:147], v[156:159], 0
  s_nop 0
  v_mfma_f32_16x16x32_bf16 v[178:181], v[140:143], v[160:163], v[178:181]
  v_mfma_f32_16x16x32_bf16 v[182:185], v[136:139], v[160:163], v[182:185]
  v_mfma_f32_16x16x32_bf16 v[186:189], v[148:151], v[156:159], 0
  v_mfma_f32_16x16x32_bf16 v[186:189], v[138:141], v[160:163], v[186:189]
  s_mov_b64 exec, s[62:63]
  v_rcp_f32 v164, v180
  s_nop 0
  v_pk_mul_f32 v[178:179], v[178:179], v[164:165] op_sel_hi:[1,0]
  v_pk_mul_f32 v[182:183], v[182:183], v[164:165] op_sel_hi:[1,0]
  v_pk_mul_f32 v[184:185], v[184:185], v[164:165] op_sel_hi:[1,0]
  v_cvt_pk_f16_f32 v64, v178, v179
  v_cvt_pk_f16_f32 v60, v182, v183
  v_pk_mul_f32 v[186:187], v[186:187], v[164:165] op_sel_hi:[1,0]
  v_pk_mul_f32 v[188:189], v[188:189], v[164:165] op_sel_hi:[1,0]
  v_cvt_pk_f16_f32 v61, v184, v185
  v_cvt_pk_f16_f32 v62, v186, v187
  v_cvt_pk_f16_f32 v63, v188, v189
  ds_write_b128 v13, v[60:63]
  ds_write_b32 v14, v64
  v_add_f32 v165, v164, v180
  v_cmp_ngt_f32 vcc, s80, v165
  s_mov_b64 exec, -1
  s_nop 0
  s_cbranch_vccnz fx_107
fk_108:
  s_waitcnt lgkmcnt(0)
  s_barrier
  ds_read_b128 v[166:169], v4 offset:13824
  ds_read_b128 v[170:173], v4 offset:14464
  ds_read_b128 v[174:177], v4 offset:15104
  ds_read_b128 v[178:181], v4 offset:15744
  s_mov_b64 exec, s[66:67]
  s_waitcnt lgkmcnt(2)
  v_pk_add_f16 v166, v166, v170
  v_pk_add_f16 v167, v167, v171
  v_pk_add_f16 v168, v168, v172
  v_pk_add_f16 v169, v169, v173
  s_waitcnt lgkmcnt(1)
  v_pk_add_f16 v166, v166, v174
  v_pk_add_f16 v167, v167, v175
  v_pk_add_f16 v168, v168, v176
  v_pk_add_f16 v169, v169, v177
  s_waitcnt lgkmcnt(0)
  v_pk_add_f16 v166, v166, v178
  v_pk_add_f16 v167, v167, v179
  v_pk_add_f16 v168, v168, v180
  v_pk_add_f16 v169, v169, v181
  v_and_or_b32 v166, v166, -2, s61
  buffer_store_dwordx4 v[166:169], v15, s[4:7], s60 offen sc1
  s_mov_b64 exec, -1
  v_permlane32_swap_b32 v96, v100
  v_permlane32_swap_b32 v97, v101
  v_permlane32_swap_b32 v98, v102
  v_permlane32_swap_b32 v99, v103
  v_pk_add_f32 v[96:97], v[96:97], v[100:101]
  v_pk_add_f32 v[98:99], v[98:99], v[102:103]
  v_cvt_pk_bf16_f32 v182, v96, v97
  v_cvt_pk_bf16_f32 v183, v98, v99
  v_min_u32 v182, -2, v182
  ds_write_b64 v26, v[182:183]
  v_permlane32_swap_b32 v88, v92
  v_permlane32_swap_b32 v89, v93
  v_permlane32_swap_b32 v90, v94
  v_permlane32_swap_b32 v91, v95
  v_pk_add_f32 v[88:89], v[88:89], v[92:93]
  v_pk_add_f32 v[90:91], v[90:91], v[94:95]
  v_cvt_pk_bf16_f32 v184, v88, v89
  v_cvt_pk_bf16_f32 v185, v90, v91
  v_min_u32 v184, -2, v184
  ds_write_b64 v43, v[184:185]
  ds_read_b128 v[144:147], v18
  ds_read_b128 v[148:151], v18 offset:1024
  ds_read_b128 v[152:155], v19
  v_xor_b32 v18, 16384, v18
  v_xor_b32 v19, 16384, v19
  v_mov_b32 v88, 0
  v_mov_b32 v89, 0
  v_mov_b32 v90, 0
  v_mov_b32 v91, 0
  v_mov_b32 v92, 0
  v_mov_b32 v93, 0
  v_mov_b32 v94, 0
  v_mov_b32 v95, 0
  v_mov_b32 v96, 0
  v_mov_b32 v97, 0
  v_mov_b32 v98, 0
  v_mov_b32 v99, 0
  v_mov_b32 v100, 0
  v_mov_b32 v101, 0
  v_mov_b32 v102, 0
  v_mov_b32 v103, 0
  s_mov_b32 s81, 0
  s_waitcnt lgkmcnt(0)
  s_barrier
  s_xor_b32 s74, s74, 16384
  s_add_u32 s73, s73, 2097152
  s_xor_b32 s73, s73, 8192
  s_add_u32 s79, s79, 2097152
  s_xor_b32 s79, s79, 8192
  s_add_u32 s21, s72, 524288
  s_xor_b32 s72, s72, s21
  s_lshr_b32 s72, s72, 8
  s_and_b32 s72, s72, 8192
  s_xor_b32 s72, s72, s21
  s_add_u32 s71, s73, 4096
  s_mov_b32 s91, 1024
  s_cmp_lt_u32 s73, 0
  s_cselect_b32 s71, s71, s79
  s_cselect_b32 s91, s91, 65536
  s_add_u32 s21, s52, 7
  s_lshr_b32 s21, s21, 2
  v_mov_b32 v28, s21
  v_mov_b32 v166, s52
  s_and_b32 s21, s52, 3
  s_cmp_lt_u32 s52, 54
  s_cselect_b32 s21, s21, 0
  s_cmp_lg_u32 s21, 0
  s_cbranch_scc1 fs_110
  s_mov_b64 exec, 1
  buffer_store_dword v166, v23, s[12:15], s77 offen sc1
  s_mov_b64 exec, -1
fs_110:
  ds_read_b128 v[170:173], v4 offset:16384
  ds_read_b128 v[174:177], v4 offset:17408
  ds_read_b128 v[178:181], v4 offset:18432
  v_min_u32 v104, -2, v104
  v_min_u32 v108, -2, v108
  s_mov_b32 s90, s70
  s_add_u32 s70, s70, 2097152
  s_xor_b32 s70, s70, 8192
  buffer_store_dwordx4 v[104:107], v36, s[16:19], s90 offen offset:2560 sc1
  buffer_store_dwordx2 v[108:109], v37, s[16:19], s90 offen offset:3072 sc1
  s_waitcnt lgkmcnt(0)
  buffer_store_dwordx4 v[170:173], v4, s[16:19], s90 offen offset:0 sc1
  buffer_store_dwordx4 v[174:177], v4, s[16:19], s90 offen offset:1024 sc1
  buffer_store_dwordx4 v[178:181], v38, s[16:19], s90 offen offset:2048 sc1
  s_add_u32 s22, s52, 5
  s_min_u32 s22, s22, 64
  v_cmp_gt_u32 vcc, s22, v42
  s_cbranch_vccz fv_111
  buffer_load_dword v42, v41, s[12:15], s76 offen sc1
fv_111:
nt_109:
  s_barrier
  s_mov_b32 s58, s55
  s_add_u32 s52, s52, 1
  s_and_b32 s21, s52, 3
  s_mul_i32 s56, s21, 122880
  s_add_u32 s21, s52, 1
  s_and_b32 s21, s21, 3
  s_mul_i32 s55, s21, 122880
  s_add_u32 s55, s55, s75
  s_add_u32 s21, s52, 2
  s_and_b32 s21, s21, 3
  s_mul_i32 s57, s21, 122880
  s_add_u32 s21, s52, 3
  s_and_b32 s21, s21, 3
  s_mul_i32 s59, s21, 122880
  s_add_u32 s59, s59, s75
  s_bfe_u32 s61, s52, 0x10002
  s_and_b32 s21, s52, 3
  s_lshl_b32 s60, s21, 18
  s_mov_b32 s54, 0
  s_sleep 3
  s_nop 2
  buffer_load_dwordx4 v[84:87], v190, s[8:11], s58 offen offset:0 sc1
  s_branch top_96
mr_97:
  s_mov_b64 exec, s[22:23]
  s_cbranch_execz ms_112
  buffer_load_dwordx4 v[84:87], v190, s[8:11], s58 offen offset:0 sc1
ms_112:
  s_add_u32 s54, s54, 1
  s_cmp_gt_u32 s54, 131072
  s_cbranch_scc1 end0
  s_waitcnt vmcnt(0)
  s_mov_b64 exec, s[22:23]
  ds_write_b128 v190, v[84:87] offset:0
  v_cmp_eq_u32 s[22:23], -1, v84
  s_mov_b64 exec, -1
  s_or_b64 vcc, s[22:23], s[22:23]
  s_cbranch_scc1 mr_97
  s_branch mo_101
kw_102:
  s_mov_b32 s101, 0
wm_113:
  buffer_load_dword v42, v41, s[12:15], s76 offen sc1
  s_add_u32 s101, s101, 1
  s_cmp_gt_u32 s101, 131072
  s_cbranch_scc1 end0
  s_waitcnt vmcnt(0)
  v_cmp_gt_u32 vcc, s22, v42
  v_readfirstlane_b32 s100, v42
  s_nop 0
  s_cbranch_vccz wm_114
  s_sleep 1
  s_branch wm_113
wm_114:
  s_branch kv_103
mn_98:
  v_max3_u32 v27, v48, v49, v50
  v_max3_u32 v27, v27, v51, v52
  v_max3_u32 v27, v27, v53, v54
  v_max3_u32 v27, v27, v55, v56
  v_max3_u32 v27, v27, v57, v58
  v_max3_u32 v27, v27, v59, v60
  v_max3_u32 v27, v27, v61, v62
  v_max3_u32 v27, v27, v63, v64
  v_max3_u32 v27, v27, v65, v66
  v_max3_u32 v27, v27, v67, v68
  v_max3_u32 v27, v27, v69, v70
  v_max3_u32 v27, v27, v71, v72
  v_max3_u32 v27, v27, v73, v74
  v_max3_u32 v27, v27, v75, v76
  v_max3_u32 v27, v27, v77, v78
  v_max3_u32 v27, v27, v79, v80
  v_max3_u32 v27, v27, v81, v82
  v_max3_u32 v27, v27, v83, v84
  v_max3_u32 v27, v27, v85, v86
  v_max3_u32 v27, v27, v87, v87
  v_cmp_eq_u32 vcc, -1, v27
  s_cmp_eq_u32 s52, 0
  s_cbranch_scc1 mk_99
  s_cbranch_vccz mk_99
  s_waitcnt lgkmcnt(0)
  s_barrier
  s_nop 7
  v_mov_b32 v88, 0
  v_mov_b32 v89, 0
  v_mov_b32 v90, 0
  v_mov_b32 v91, 0
  v_mov_b32 v92, 0
  v_mov_b32 v93, 0
  v_mov_b32 v94, 0
  v_mov_b32 v95, 0
  v_mov_b32 v96, 0
  v_mov_b32 v97, 0
  v_mov_b32 v98, 0
  v_mov_b32 v99, 0
  v_mov_b32 v100, 0
  v_mov_b32 v101, 0
  v_mov_b32 v102, 0
  v_mov_b32 v103, 0
  s_mov_b64 s[22:23], -1
  s_branch mr_97
sr_104:
  s_mov_b32 s54, 0
sr_115:
  s_mov_b64 exec, vcc
  buffer_load_dwordx4 v[124:127], v9, s[8:11], s56 offen sc1
  buffer_load_dwordx4 v[128:131], v9, s[8:11], s56 offen offset:1024 sc1
  buffer_load_dwordx4 v[132:135], v10, s[8:11], s56 offen sc1
  s_mov_b64 exec, -1
  s_add_u32 s54, s54, 1
  s_cmp_gt_u32 s54, 131072
  s_cbranch_scc1 end0
  s_and_b32 s21, s54, 31
  s_cbranch_scc0 sr_116
  s_waitcnt vmcnt(0)
  v_pk_add_f16 v172, v124, v126
  v_pk_add_f16 v173, v125, v127
  v_pk_add_f16 v174, v128, v130
  v_pk_add_f16 v175, v129, v131
  v_fma_mix_f32 v166, v172, 1.0, v174 op_sel:[0,0,0] op_sel_hi:[1,0,1]
  v_fma_mix_f32 v168, v173, 1.0, v175 op_sel:[0,0,0] op_sel_hi:[1,0,1]
  v_pk_add_f16 v176, v132, v133
  v_pk_add_f16 v177, v134, v135
  v_add_f32 v27, v166, v168
  v_fma_mix_f32 v170, v176, 1.0, v177 op_sel:[0,0,0] op_sel_hi:[1,0,1]
  v_fma_mix_f32 v167, v172, 1.0, v174 op_sel:[1,0,1] op_sel_hi:[1,0,1]
  v_cmp_u_f32 vcc, v27, v170
  v_fma_mix_f32 v169, v173, 1.0, v175 op_sel:[1,0,1] op_sel_hi:[1,0,1]
  v_fma_mix_f32 v171, v176, 1.0, v177 op_sel:[1,0,1] op_sel_hi:[1,0,1]
  s_cbranch_vccnz sr_115
  s_branch sj_105
sr_116:
  s_waitcnt vmcnt(0)
  v_pk_add_f16 v172, v124, v126
  v_pk_add_f16 v173, v125, v127
  v_pk_add_f16 v174, v128, v130
  v_pk_add_f16 v175, v129, v131
  v_fma_mix_f32 v166, v172, 1.0, v174 op_sel:[0,0,0] op_sel_hi:[1,0,1]
  v_fma_mix_f32 v168, v173, 1.0, v175 op_sel:[0,0,0] op_sel_hi:[1,0,1]
  v_pk_add_f16 v176, v132, v133
  v_pk_add_f16 v177, v134, v135
  v_add_f32 v27, v166, v168
  v_fma_mix_f32 v170, v176, 1.0, v177 op_sel:[0,0,0] op_sel_hi:[1,0,1]
  v_fma_mix_f32 v167, v172, 1.0, v174 op_sel:[1,0,1] op_sel_hi:[1,0,1]
  v_cmp_u_f32 vcc, v27, v170
  v_fma_mix_f32 v169, v173, 1.0, v175 op_sel:[1,0,1] op_sel_hi:[1,0,1]
  v_fma_mix_f32 v171, v176, 1.0, v177 op_sel:[1,0,1] op_sel_hi:[1,0,1]
  v_max3_u32 v27, v124, v126, v128
  v_max3_u32 v27, v27, v130, v132
  v_max3_u32 v27, v27, v133, v134
  v_max3_u32 v27, v27, v135, v135
  v_cmp_eq_u32 vcc, -1, v27
  s_nop 1
  s_cbranch_vccnz sr_115
  s_branch sj_105
fx_107:
  s_cmp_eq_u32 s81, 1
  s_cbranch_scc1 fk_108
  s_mov_b32 s81, 1
  v_max3_f32 v164, v166, v167, v168
  v_max3_f32 v165, v169, v170, v171
  v_max_f32 v164, v164, v165
  s_nop 1
  v_max_f32_dpp v164, v164, v164 row_ror:8 row_mask:0xf bank_mask:0xf
  v_mov_b32 v165, v164
  s_nop 1
  v_permlane32_swap_b32 v164, v165
  v_max_f32 v164, v164, v165
  v_mov_b32 v165, v164
  s_nop 1
  v_permlane16_swap_b32 v164, v165
  v_max_f32 v164, v164, v165
  v_sub_f32 v166, v166, v164
  v_sub_f32 v167, v167, v164
  v_sub_f32 v168, v168, v164
  v_sub_f32 v169, v169, v164
  v_sub_f32 v170, v170, v164
  v_sub_f32 v171, v171, v164
  s_branch ex_106
last_100:
  s_waitcnt lgkmcnt(0)
  v_min_u32 v104, -2, v104
  v_min_u32 v108, -2, v108
  s_mov_b32 s90, s70
  buffer_store_dwordx4 v[104:107], v36, s[16:19], s90 offen offset:2560 sc1
  buffer_store_dwordx2 v[108:109], v37, s[16:19], s90 offen offset:3072 sc1
  v_smfmac_f32_16x16x64_bf16 v[96:99], v[52:55], a[8:15], v22
  v_smfmac_f32_16x16x64_bf16 v[100:103], v[52:55], a[88:95], v22
  v_smfmac_f32_16x16x64_bf16 v[96:99], v[56:59], a[16:23], v22
  v_smfmac_f32_16x16x64_bf16 v[100:103], v[56:59], a[96:103], v22
  v_smfmac_f32_16x16x64_bf16 v[96:99], v[60:63], a[24:31], v22
  v_smfmac_f32_16x16x64_bf16 v[96:99], v[64:67], a[32:39], v22
  v_smfmac_f32_16x16x64_bf16 v[96:99], v[68:71], a[40:47], v22
  v_smfmac_f32_16x16x64_bf16 v[96:99], v[72:75], a[48:55], v22
  v_smfmac_f32_16x16x64_bf16 v[96:99], v[76:79], a[56:63], v22
  v_smfmac_f32_16x16x64_bf16 v[96:99], v[80:83], a[64:71], v22
  v_smfmac_f32_16x16x64_bf16 v[96:99], v[84:87], a[72:79], v22
  v_smfmac_f32_16x16x64_bf16 v[100:103], v[60:63], a[104:111], v22
  v_smfmac_f32_16x16x64_bf16 v[100:103], v[64:67], a[112:119], v22
  v_smfmac_f32_16x16x64_bf16 v[100:103], v[68:71], a[120:127], v22
  v_smfmac_f32_16x16x64_bf16 v[100:103], v[72:75], a[128:135], v22
  v_smfmac_f32_16x16x64_bf16 v[100:103], v[76:79], a[136:143], v22
  v_smfmac_f32_16x16x64_bf16 v[100:103], v[80:83], a[144:151], v22
  v_smfmac_f32_16x16x64_bf16 v[100:103], v[84:87], a[152:159], v22
  s_nop 7
  v_permlane32_swap_b32 v96, v100
  v_permlane32_swap_b32 v97, v101
  v_permlane32_swap_b32 v98, v102
  v_permlane32_swap_b32 v99, v103
  v_pk_add_f32 v[96:97], v[96:97], v[100:101]
  v_pk_add_f32 v[98:99], v[98:99], v[102:103]
  v_cvt_pk_bf16_f32 v182, v96, v97
  v_cvt_pk_bf16_f32 v183, v98, v99
  v_min_u32 v182, -2, v182
  ds_write_b64 v26, v[182:183]
  v_permlane32_swap_b32 v88, v92
  v_permlane32_swap_b32 v89, v93
  v_permlane32_swap_b32 v90, v94
  v_permlane32_swap_b32 v91, v95
  v_pk_add_f32 v[88:89], v[88:89], v[92:93]
  v_pk_add_f32 v[90:91], v[90:91], v[94:95]
  v_cvt_pk_bf16_f32 v184, v88, v89
  v_cvt_pk_bf16_f32 v185, v90, v91
  v_min_u32 v184, -2, v184
  ds_write_b64 v43, v[184:185]
  s_waitcnt lgkmcnt(0)
  s_barrier
  ds_read_b128 v[170:173], v4 offset:16384
  ds_read_b128 v[174:177], v4 offset:17408
  ds_read_b128 v[178:181], v4 offset:18432
  v_min_u32 v104, -2, v104
  v_min_u32 v108, -2, v108
  s_mov_b32 s90, s70
  s_add_u32 s70, s70, 2097152
  s_xor_b32 s70, s70, 8192
  s_waitcnt lgkmcnt(0)
  buffer_store_dwordx4 v[170:173], v4, s[16:19], s90 offen offset:0 sc1
  buffer_store_dwordx4 v[174:177], v4, s[16:19], s90 offen offset:1024 sc1
  buffer_store_dwordx4 v[178:181], v38, s[16:19], s90 offen offset:2048 sc1
  s_waitcnt vmcnt(0)
  v_mov_b32 v166, 64
  s_mov_b64 exec, 1
  buffer_store_dword v166, v23, s[12:15], s77 offen sc1
  s_mov_b64 exec, -1
  s_branch chain_done
E_25:
  v_add_u32 v190, 0, v4
  s_waitcnt vmcnt(0)
  ds_write_b128 v190, v[48:51] offset:0
  ds_write_b128 v190, v[52:55] offset:1024
  ds_write_b128 v190, v[56:59] offset:2048
  s_add_u32 m0, s74, 9216
  s_add_u32 s21, s72, 32768
  buffer_load_dwordx4 v32, s[16:19], s21 offen sc1 lds
  s_add_u32 m0, s74, 2048
  s_mul_i32 s21, s91, 1
  s_add_u32 s21, s21, s71
  buffer_load_dwordx4 v4, s[16:19], s21 offen sc1 lds
  s_xor_b32 s74, s74, 16384
  s_add_u32 s73, s73, 2097152
  s_xor_b32 s73, s73, 8192
  s_add_u32 s79, s79, 2097152
  s_xor_b32 s79, s79, 8192
  s_add_u32 s21, s72, 524288
  s_xor_b32 s72, s72, s21
  s_lshr_b32 s72, s72, 8
  s_and_b32 s72, s72, 8192
  s_xor_b32 s72, s72, s21
  s_add_u32 s71, s73, 4096
  s_mov_b32 s91, 1024
  s_cmp_lt_u32 s73, 0
  s_cselect_b32 s71, s71, s79
  s_cselect_b32 s91, s91, 65536
  s_branch mo_122
  .p2align 3
top_117:
  s_waitcnt vmcnt(2)
  ds_write_b128 v190, v[48:51] offset:0
  v_cmp_eq_u32 s[22:23], -1, v48
  s_waitcnt vmcnt(1)
  ds_write_b128 v190, v[52:55] offset:1024
  v_cmp_eq_u32 s[98:99], -1, v52
  s_waitcnt vmcnt(0)
  ds_write_b128 v190, v[56:59] offset:2048
  v_cmp_eq_u32 s[100:101], -1, v56
  s_or_b64 vcc, s[22:23], s[98:99]
  s_or_b64 vcc, vcc, s[100:101]
  s_cbranch_scc1 mr_118
mo_122:
  s_waitcnt lgkmcnt(0)
  s_barrier
  ds_read_b128 v[60:63], v4 offset:3072
  ds_read_b128 v[64:67], v4 offset:4096
  v_smfmac_f32_16x16x64_bf16 v[92:95], v[48:51], a[240:247], v22
  ds_read_b128 v[68:71], v4 offset:5120
  v_smfmac_f32_16x16x64_bf16 v[88:91], v[48:51], a[160:167], v22
  ds_read_b128 v[72:75], v4 offset:6144
  v_smfmac_f32_16x16x64_bf16 v[92:95], v[52:55], a[248:255], v22
  ds_read_b128 v[76:79], v4 offset:7168
  v_smfmac_f32_16x16x64_bf16 v[88:91], v[52:55], a[168:175], v22
  ds_read_b128 v[80:83], v4 offset:8192
  v_smfmac_f32_16x16x64_bf16 v[92:95], v[56:59], v[192:199], v22
  ds_read_b128 v[84:87], v4 offset:9216
  v_smfmac_f32_16x16x64_bf16 v[88:91], v[56:59], a[176:183], v22
  s_waitcnt lgkmcnt(6)
  v_smfmac_f32_16x16x64_bf16 v[92:95], v[60:63], v[200:207], v22
  v_smfmac_f32_16x16x64_bf16 v[88:91], v[60:63], a[184:191], v22
  s_waitcnt lgkmcnt(5)
  v_smfmac_f32_16x16x64_bf16 v[92:95], v[64:67], v[208:215], v22
  s_waitcnt lgkmcnt(4)
  v_smfmac_f32_16x16x64_bf16 v[92:95], v[68:71], v[216:223], v22
  s_waitcnt lgkmcnt(3)
  v_smfmac_f32_16x16x64_bf16 v[92:95], v[72:75], v[224:231], v22
  s_waitcnt lgkmcnt(2)
  v_smfmac_f32_16x16x64_bf16 v[92:95], v[76:79], v[232:239], v22
  s_waitcnt lgkmcnt(1)
  v_smfmac_f32_16x16x64_bf16 v[92:95], v[80:83], v[240:247], v22
  s_waitcnt lgkmcnt(0)
  v_smfmac_f32_16x16x64_bf16 v[92:95], v[84:87], v[248:255], v22
  v_smfmac_f32_16x16x64_bf16 v[88:91], v[64:67], a[192:199], v22
  v_smfmac_f32_16x16x64_bf16 v[88:91], v[68:71], a[200:207], v22
  v_smfmac_f32_16x16x64_bf16 v[88:91], v[72:75], a[208:215], v22
  v_permlane32_swap_b32 v92, v93
  v_smfmac_f32_16x16x64_bf16 v[88:91], v[76:79], a[216:223], v22
  v_permlane32_swap_b32 v94, v95
  v_smfmac_f32_16x16x64_bf16 v[88:91], v[80:83], a[224:231], v22
  v_permlane32_swap_b32 v93, v92
  v_smfmac_f32_16x16x64_bf16 v[88:91], v[84:87], a[232:239], v22
  v_permlane32_swap_b32 v95, v94
  v_pk_mul_f32 v[120:121], v[92:93], v[24:25] op_sel:[1,0] op_sel_hi:[0,1]
  v_pk_mul_f32 v[122:123], v[94:95], v[24:25] op_sel:[1,0] op_sel_hi:[0,1]
  s_nop 4
  v_pk_fma_f32 v[88:89], v[88:89], v[24:25], v[120:121]
  v_pk_fma_f32 v[90:91], v[90:91], v[24:25], v[122:123]
  v_cvt_pk_bf16_f32 v120, v88, v89
  v_cvt_pk_bf16_f32 v121, v90, v91
  ds_write_b64 v6, v[120:121]
  v_cmp_u_f32 vcc, v88, v89
  v_cmp_u_f32 s[22:23], v90, v91
  s_nop 1
  s_or_b64 vcc, vcc, s[22:23]
  s_cbranch_vccnz mn_119
mk_120:
  s_waitcnt lgkmcnt(0)
  s_barrier
  ds_read_b64_tr_b16 v[104:105], v7 offset:0
  ds_read_b64_tr_b16 v[106:107], v7 offset:768
  ds_read_b64_tr_b16 v[108:109], v7 offset:1536
  ds_read_b64 v[140:141], v11
  s_cmp_eq_u32 s52, 63
  s_cbranch_scc1 last_121
  s_waitcnt lgkmcnt(2)
  v_mfma_f32_16x16x32_bf16 v[120:123], v[112:115], v[104:107], 0
  s_waitcnt lgkmcnt(1)
  v_mfma_f32_16x16x32_bf16 v[120:123], v[116:119], v[108:111], v[120:123]
  s_mov_b64 exec, s[64:65]
  s_nop 6
  v_cvt_pk_f16_f32 v120, v120, v121
  v_cvt_pk_f16_f32 v121, v122, v123
  buffer_store_dwordx2 v[120:121], v8, s[8:11], s56 offen sc1
  s_mov_b64 exec, -1
  s_sleep 3
  s_nop 1
  v_smfmac_f32_16x16x64_bf16 v[96:99], v[48:51], a[0:7], v22
  v_smfmac_f32_16x16x64_bf16 v[100:103], v[48:51], a[80:87], v22
  v_smfmac_f32_16x16x64_bf16 v[96:99], v[52:55], a[8:15], v22
  v_smfmac_f32_16x16x64_bf16 v[100:103], v[52:55], a[88:95], v22
  v_smfmac_f32_16x16x64_bf16 v[96:99], v[56:59], a[16:23], v22
  v_smfmac_f32_16x16x64_bf16 v[100:103], v[56:59], a[96:103], v22
  v_smfmac_f32_16x16x64_bf16 v[96:99], v[60:63], a[24:31], v22
  v_smfmac_f32_16x16x64_bf16 v[96:99], v[64:67], a[32:39], v22
  v_smfmac_f32_16x16x64_bf16 v[96:99], v[68:71], a[40:47], v22
  v_smfmac_f32_16x16x64_bf16 v[96:99], v[72:75], a[48:55], v22
  v_smfmac_f32_16x16x64_bf16 v[96:99], v[76:79], a[56:63], v22
  buffer_load_dwordx4 v[124:127], v9, s[8:11], s56 offen sc1
  v_smfmac_f32_16x16x64_bf16 v[96:99], v[80:83], a[64:71], v22
  buffer_load_dwordx4 v[128:131], v9, s[8:11], s56 offen offset:1024 sc1
  v_smfmac_f32_16x16x64_bf16 v[96:99], v[84:87], a[72:79], v22
  buffer_load_dwordx4 v[132:135], v10, s[8:11], s56 offen sc1
  v_smfmac_f32_16x16x64_bf16 v[100:103], v[60:63], a[104:111], v22
  v_smfmac_f32_16x16x64_bf16 v[100:103], v[64:67], a[112:119], v22
  v_smfmac_f32_16x16x64_bf16 v[100:103], v[68:71], a[120:127], v22
  v_smfmac_f32_16x16x64_bf16 v[100:103], v[72:75], a[128:135], v22
  v_cvt_pk_bf16_f32 v136, v96, v97
  v_smfmac_f32_16x16x64_bf16 v[100:103], v[76:79], a[136:143], v22
  v_cvt_pk_bf16_f32 v137, v98, v99
  v_smfmac_f32_16x16x64_bf16 v[100:103], v[80:83], a[144:151], v22
  v_smfmac_f32_16x16x64_bf16 v[100:103], v[84:87], a[152:159], v22
  s_waitcnt vmcnt(2)
  v_pk_add_f16 v172, v124, v126
  v_pk_add_f16 v173, v125, v127
  s_waitcnt vmcnt(1)
  v_pk_add_f16 v174, v128, v130
  v_pk_add_f16 v175, v129, v131
  v_fma_mix_f32 v166, v172, 1.0, v174 op_sel:[0,0,0] op_sel_hi:[1,0,1]
  v_fma_mix_f32 v168, v173, 1.0, v175 op_sel:[0,0,0] op_sel_hi:[1,0,1]
  s_waitcnt vmcnt(0)
  v_pk_add_f16 v176, v132, v133
  v_pk_add_f16 v177, v134, v135
  v_fma_mix_f32 v170, v176, 1.0, v177 op_sel:[0,0,0] op_sel_hi:[1,0,1]
  v_fma_mix_f32 v167, v172, 1.0, v174 op_sel:[1,0,1] op_sel_hi:[1,0,1]
  v_cmp_u_f32 vcc, v166, v170
  v_fma_mix_f32 v169, v173, 1.0, v175 op_sel:[1,0,1] op_sel_hi:[1,0,1]
  v_fma_mix_f32 v171, v176, 1.0, v177 op_sel:[1,0,1] op_sel_hi:[1,0,1]
  v_cvt_pk_bf16_f32 v138, v100, v101
  s_cbranch_vccnz sr_123
sj_124:
ex_125:
  v_exp_f32 v172, v166
  v_exp_f32 v173, v167
  v_exp_f32 v174, v168
  v_cvt_pk_bf16_f32 v156, v172, v173
  v_exp_f32 v175, v169
  v_exp_f32 v176, v170
  v_cvt_pk_bf16_f32 v157, v174, v175
  v_mov_b32_dpp v158, v156 row_ror:8 row_mask:0xf bank_mask:0xf
  v_exp_f32 v177, v171
  v_mov_b32_dpp v159, v157 row_ror:8 row_mask:0xf bank_mask:0xf
  v_cvt_pk_bf16_f32 v160, v176, v177
  v_cvt_pk_bf16_f32 v139, v102, v103
  v_mfma_f32_16x16x32_bf16 v[178:181], v[152:155], v[156:159], 0
  s_waitcnt lgkmcnt(0)
  v_mov_b32_dpp v161, v160 row_ror:8 row_mask:0xf bank_mask:0xf
  v_mfma_f32_16x16x32_bf16 v[182:185], v[144:147], v[156:159], 0
  s_nop 0
  v_mfma_f32_16x16x32_bf16 v[178:181], v[140:143], v[160:163], v[178:181]
  v_mfma_f32_16x16x32_bf16 v[182:185], v[136:139], v[160:163], v[182:185]
  v_mfma_f32_16x16x32_bf16 v[186:189], v[148:151], v[156:159], 0
  v_mfma_f32_16x16x32_bf16 v[186:189], v[138:141], v[160:163], v[186:189]
  s_mov_b64 exec, s[62:63]
  v_rcp_f32 v164, v180
  s_nop 0
  v_pk_mul_f32 v[178:179], v[178:179], v[164:165] op_sel_hi:[1,0]
  v_pk_mul_f32 v[182:183], v[182:183], v[164:165] op_sel_hi:[1,0]
  v_pk_mul_f32 v[184:185], v[184:185], v[164:165] op_sel_hi:[1,0]
  v_cvt_pk_f16_f32 v64, v178, v179
  v_cvt_pk_f16_f32 v60, v182, v183
  v_pk_mul_f32 v[186:187], v[186:187], v[164:165] op_sel_hi:[1,0]
  v_pk_mul_f32 v[188:189], v[188:189], v[164:165] op_sel_hi:[1,0]
  v_cvt_pk_f16_f32 v61, v184, v185
  v_cvt_pk_f16_f32 v62, v186, v187
  v_cvt_pk_f16_f32 v63, v188, v189
  ds_write_b128 v13, v[60:63]
  ds_write_b32 v14, v64
  v_add_f32 v165, v164, v180
  v_cmp_ngt_f32 vcc, s80, v165
  s_mov_b64 exec, -1
  s_nop 0
  s_cbranch_vccnz fx_126
fk_127:
  s_waitcnt lgkmcnt(0)
  s_barrier
  s_add_u32 m0, s74, 9216
  s_add_u32 s21, s72, 32768
  buffer_load_dwordx4 v32, s[16:19], s21 offen sc1 lds
  s_add_u32 m0, s74, 2048
  s_mul_i32 s21, s91, 1
  s_add_u32 s21, s21, s71
  buffer_load_dwordx4 v4, s[16:19], s21 offen sc1 lds
  s_xor_b32 s74, s74, 16384
  s_add_u32 s73, s73, 2097152
  s_xor_b32 s73, s73, 8192
  s_add_u32 s79, s79, 2097152
  s_xor_b32 s79, s79, 8192
  s_add_u32 s21, s72, 524288
  s_xor_b32 s72, s72, s21
  s_lshr_b32 s72, s72, 8
  s_and_b32 s72, s72, 8192
  s_xor_b32 s72, s72, s21
  s_add_u32 s71, s73, 4096
  s_mov_b32 s91, 1024
  s_cmp_lt_u32 s73, 0
  s_cselect_b32 s71, s71, s79
  s_cselect_b32 s91, s91, 65536
  s_nop 15
  s_nop 3
  v_permlane32_swap_b32 v96, v100
  v_permlane32_swap_b32 v97, v101
  v_permlane32_swap_b32 v98, v102
  v_permlane32_swap_b32 v99, v103
  v_pk_add_f32 v[96:97], v[96:97], v[100:101]
  v_pk_add_f32 v[98:99], v[98:99], v[102:103]
  v_cvt_pk_bf16_f32 v182, v96, v97
  v_cvt_pk_bf16_f32 v183, v98, v99
  v_min_u32 v182, -2, v182
  ds_write_b64 v26, v[182:183]
  ds_read_b128 v[144:147], v18
  ds_read_b128 v[148:151], v18 offset:1024
  ds_read_b128 v[152:155], v19
  ds_read_b128 v[112:115], v20
  ds_read_b64 v[116:117], v21
  v_xor_b32 v18, 16384, v18
  v_xor_b32 v19, 16384, v19
  v_xor_b32 v20, 16384, v20
  v_xor_b32 v21, 16384, v21
  v_mov_b32 v88, 0
  v_mov_b32 v89, 0
  v_mov_b32 v90, 0
  v_mov_b32 v91, 0
  v_mov_b32 v92, 0
  v_mov_b32 v93, 0
  v_mov_b32 v94, 0
  v_mov_b32 v95, 0
  v_mov_b32 v96, 0
  v_mov_b32 v97, 0
  v_mov_b32 v98, 0
  v_mov_b32 v99, 0
  v_mov_b32 v100, 0
  v_mov_b32 v101, 0
  v_mov_b32 v102, 0
  v_mov_b32 v103, 0
  s_mov_b32 s81, 0
  s_waitcnt lgkmcnt(0)
  s_barrier
  s_mov_b64 exec, s[64:65]
  buffer_store_dwordx2 v[28:29], v8, s[8:11], s57 offen sc1
  s_mov_b64 exec, s[62:63]
  buffer_store_dword v28, v17, s[8:11], s59 offen sc1
  s_mov_b64 exec, -1
  s_sleep 6
  s_nop 3
  buffer_load_dwordx4 v[68:71], v16, s[4:7], s60 offen sc1
  s_sleep 3
  s_nop 1
  buffer_load_dwordx4 v[72:75], v16, s[4:7], s60 offen sc1
  s_waitcnt vmcnt(1)
  v_mfma_f32_16x16x32_f16 v[120:123], v[44:47], v[68:71], 0
  v_bitop3_b32 v27, v68, s61, 1 bitop3:0x28
  v_cmp_ne_u32 vcc, 0, v27
  s_nop 1
  s_cbranch_vccnz p2_132
  s_nop 2
pg_131:
  v_add_f32_dpp v120, v120, v120 row_ror:8 row_mask:0xf bank_mask:0xf
  v_add_f32_dpp v121, v121, v121 row_ror:8 row_mask:0xf bank_mask:0xf
  s_mov_b64 exec, s[62:63]
  v_cvt_pk_bf16_f32 v120, v120, v121
  v_min_u32 v120, -2, v120
  buffer_store_dword v120, v17, s[8:11], s55 offen sc1
  s_mov_b64 exec, -1
nt_128:
  s_barrier
  s_mov_b32 s58, s55
  s_add_u32 s52, s52, 1
  s_and_b32 s21, s52, 3
  s_mul_i32 s56, s21, 122880
  s_add_u32 s21, s52, 1
  s_and_b32 s21, s21, 3
  s_mul_i32 s55, s21, 122880
  s_add_u32 s55, s55, s75
  s_add_u32 s21, s52, 2
  s_and_b32 s21, s21, 3
  s_mul_i32 s57, s21, 122880
  s_add_u32 s21, s52, 3
  s_and_b32 s21, s21, 3
  s_mul_i32 s59, s21, 122880
  s_add_u32 s59, s59, s75
  s_bfe_u32 s61, s52, 0x10002
  s_and_b32 s21, s52, 3
  s_lshl_b32 s60, s21, 18
  s_mov_b32 s54, 0
  s_sleep 3
  s_nop 2
  buffer_load_dwordx4 v[48:51], v190, s[8:11], s58 offen offset:0 sc1
  buffer_load_dwordx4 v[52:55], v190, s[8:11], s58 offen offset:1024 sc1
  buffer_load_dwordx4 v[56:59], v190, s[8:11], s58 offen offset:2048 sc1
  s_branch top_117
mr_118:
  s_mov_b64 exec, s[22:23]
  s_cbranch_execz ms_133
  buffer_load_dwordx4 v[48:51], v190, s[8:11], s58 offen offset:0 sc1
ms_133:
  s_mov_b64 exec, s[98:99]
  s_cbranch_execz ms_134
  buffer_load_dwordx4 v[52:55], v190, s[8:11], s58 offen offset:1024 sc1
ms_134:
  s_mov_b64 exec, s[100:101]
  s_cbranch_execz ms_135
  buffer_load_dwordx4 v[56:59], v190, s[8:11], s58 offen offset:2048 sc1
ms_135:
  s_add_u32 s54, s54, 1
  s_cmp_gt_u32 s54, 131072
  s_cbranch_scc1 end0
  s_waitcnt vmcnt(0)
  s_mov_b64 exec, s[22:23]
  ds_write_b128 v190, v[48:51] offset:0
  v_cmp_eq_u32 s[22:23], -1, v48
  s_mov_b64 exec, s[98:99]
  ds_write_b128 v190, v[52:55] offset:1024
  v_cmp_eq_u32 s[98:99], -1, v52
  s_mov_b64 exec, s[100:101]
  ds_write_b128 v190, v[56:59] offset:2048
  v_cmp_eq_u32 s[100:101], -1, v56
  s_mov_b64 exec, -1
  s_or_b64 vcc, s[22:23], s[98:99]
  s_or_b64 vcc, vcc, s[100:101]
  s_cbranch_scc1 mr_118
  s_branch mo_122
mn_119:
  v_max3_u32 v27, v48, v49, v50
  v_max3_u32 v27, v27, v51, v52
  v_max3_u32 v27, v27, v53, v54
  v_max3_u32 v27, v27, v55, v56
  v_max3_u32 v27, v27, v57, v58
  v_max3_u32 v27, v27, v59, v60
  v_max3_u32 v27, v27, v61, v62
  v_max3_u32 v27, v27, v63, v64
  v_max3_u32 v27, v27, v65, v66
  v_max3_u32 v27, v27, v67, v68
  v_max3_u32 v27, v27, v69, v70
  v_max3_u32 v27, v27, v71, v72
  v_max3_u32 v27, v27, v73, v74
  v_max3_u32 v27, v27, v75, v76
  v_max3_u32 v27, v27, v77, v78
  v_max3_u32 v27, v27, v79, v80
  v_max3_u32 v27, v27, v81, v82
  v_max3_u32 v27, v27, v83, v84
  v_max3_u32 v27, v27, v85, v86
  v_max3_u32 v27, v27, v87, v87
  v_cmp_eq_u32 vcc, -1, v27
  s_cmp_eq_u32 s52, 0
  s_cbranch_scc1 mk_120
  s_cbranch_vccz mk_120
  s_waitcnt lgkmcnt(0)
  s_barrier
  s_nop 7
  v_mov_b32 v88, 0
  v_mov_b32 v89, 0
  v_mov_b32 v90, 0
  v_mov_b32 v91, 0
  v_mov_b32 v92, 0
  v_mov_b32 v93, 0
  v_mov_b32 v94, 0
  v_mov_b32 v95, 0
  v_mov_b32 v96, 0
  v_mov_b32 v97, 0
  v_mov_b32 v98, 0
  v_mov_b32 v99, 0
  v_mov_b32 v100, 0
  v_mov_b32 v101, 0
  v_mov_b32 v102, 0
  v_mov_b32 v103, 0
  s_mov_b64 s[22:23], -1
  s_mov_b64 s[98:99], -1
  s_mov_b64 s[100:101], -1
  s_branch mr_118
sr_123:
  s_mov_b32 s54, 0
sr_136:
  s_mov_b64 exec, vcc
  buffer_load_dwordx4 v[124:127], v9, s[8:11], s56 offen sc1
  buffer_load_dwordx4 v[128:131], v9, s[8:11], s56 offen offset:1024 sc1
  buffer_load_dwordx4 v[132:135], v10, s[8:11], s56 offen sc1
  s_mov_b64 exec, -1
  s_add_u32 s54, s54, 1
  s_cmp_gt_u32 s54, 131072
  s_cbranch_scc1 end0
  s_and_b32 s21, s54, 31
  s_cbranch_scc0 sr_137
  s_waitcnt vmcnt(0)
  v_pk_add_f16 v172, v124, v126
  v_pk_add_f16 v173, v125, v127
  v_pk_add_f16 v174, v128, v130
  v_pk_add_f16 v175, v129, v131
  v_fma_mix_f32 v166, v172, 1.0, v174 op_sel:[0,0,0] op_sel_hi:[1,0,1]
  v_fma_mix_f32 v168, v173, 1.0, v175 op_sel:[0,0,0] op_sel_hi:[1,0,1]
  v_pk_add_f16 v176, v132, v133
  v_pk_add_f16 v177, v134, v135
  v_add_f32 v27, v166, v168
  v_fma_mix_f32 v170, v176, 1.0, v177 op_sel:[0,0,0] op_sel_hi:[1,0,1]
  v_fma_mix_f32 v167, v172, 1.0, v174 op_sel:[1,0,1] op_sel_hi:[1,0,1]
  v_cmp_u_f32 vcc, v27, v170
  v_fma_mix_f32 v169, v173, 1.0, v175 op_sel:[1,0,1] op_sel_hi:[1,0,1]
  v_fma_mix_f32 v171, v176, 1.0, v177 op_sel:[1,0,1] op_sel_hi:[1,0,1]
  s_cbranch_vccnz sr_136
  s_branch sj_124
sr_137:
  s_waitcnt vmcnt(0)
  v_pk_add_f16 v172, v124, v126
  v_pk_add_f16 v173, v125, v127
  v_pk_add_f16 v174, v128, v130
  v_pk_add_f16 v175, v129, v131
  v_fma_mix_f32 v166, v172, 1.0, v174 op_sel:[0,0,0] op_sel_hi:[1,0,1]
  v_fma_mix_f32 v168, v173, 1.0, v175 op_sel:[0,0,0] op_sel_hi:[1,0,1]
  v_pk_add_f16 v176, v132, v133
  v_pk_add_f16 v177, v134, v135
  v_add_f32 v27, v166, v168
  v_fma_mix_f32 v170, v176, 1.0, v177 op_sel:[0,0,0] op_sel_hi:[1,0,1]
  v_fma_mix_f32 v167, v172, 1.0, v174 op_sel:[1,0,1] op_sel_hi:[1,0,1]
  v_cmp_u_f32 vcc, v27, v170
  v_fma_mix_f32 v169, v173, 1.0, v175 op_sel:[1,0,1] op_sel_hi:[1,0,1]
  v_fma_mix_f32 v171, v176, 1.0, v177 op_sel:[1,0,1] op_sel_hi:[1,0,1]
  v_max3_u32 v27, v124, v126, v128
  v_max3_u32 v27, v27, v130, v132
  v_max3_u32 v27, v27, v133, v134
  v_max3_u32 v27, v27, v135, v135
  v_cmp_eq_u32 vcc, -1, v27
  s_nop 1
  s_cbranch_vccnz sr_136
  s_branch sj_124
fx_126:
  s_cmp_eq_u32 s81, 1
  s_cbranch_scc1 fk_127
  s_mov_b32 s81, 1
  v_max3_f32 v164, v166, v167, v168
  v_max3_f32 v165, v169, v170, v171
  v_max_f32 v164, v164, v165
  s_nop 1
  v_max_f32_dpp v164, v164, v164 row_ror:8 row_mask:0xf bank_mask:0xf
  v_mov_b32 v165, v164
  s_nop 1
  v_permlane32_swap_b32 v164, v165
  v_max_f32 v164, v164, v165
  v_mov_b32 v165, v164
  s_nop 1
  v_permlane16_swap_b32 v164, v165
  v_max_f32 v164, v164, v165
  v_sub_f32 v166, v166, v164
  v_sub_f32 v167, v167, v164
  v_sub_f32 v168, v168, v164
  v_sub_f32 v169, v169, v164
  v_sub_f32 v170, v170, v164
  v_sub_f32 v171, v171, v164
  s_branch ex_125
p2_132:
  s_mov_b32 s54, 0
  buffer_load_dwordx4 v[68:71], v16, s[4:7], s60 offen sc1
  s_waitcnt vmcnt(1)
  v_mfma_f32_16x16x32_f16 v[120:123], v[44:47], v[72:75], 0
  v_bitop3_b32 v27, v72, s61, 1 bitop3:0x28
  v_cmp_ne_u32 vcc, 0, v27
  s_nop 1
  s_cbranch_vccz pg_131
  buffer_load_dwordx4 v[72:75], v16, s[4:7], s60 offen sc1
pp_130:
  s_waitcnt vmcnt(1)
  v_mfma_f32_16x16x32_f16 v[120:123], v[44:47], v[68:71], 0
  v_bitop3_b32 v27, v68, s61, 1 bitop3:0x28
  v_cmp_ne_u32 vcc, 0, v27
  s_nop 1
  s_cbranch_vccz pg_131
  buffer_load_dwordx4 v[68:71], v16, s[4:7], s60 offen sc1
  s_waitcnt vmcnt(1)
  v_mfma_f32_16x16x32_f16 v[120:123], v[44:47], v[72:75], 0
  v_bitop3_b32 v27, v72, s61, 1 bitop3:0x28
  v_cmp_ne_u32 vcc, 0, v27
  s_nop 1
  s_cbranch_vccz pg_131
  buffer_load_dwordx4 v[72:75], v16, s[4:7], s60 offen sc1
  s_add_u32 s54, s54, 1
  s_cmp_gt_u32 s54, 131072
  s_cbranch_scc1 end0
  s_branch pp_130
last_121:
  v_smfmac_f32_16x16x64_bf16 v[96:99], v[48:51], a[0:7], v22
  v_smfmac_f32_16x16x64_bf16 v[100:103], v[48:51], a[80:87], v22
  v_smfmac_f32_16x16x64_bf16 v[96:99], v[52:55], a[8:15], v22
  v_smfmac_f32_16x16x64_bf16 v[100:103], v[52:55], a[88:95], v22
  v_smfmac_f32_16x16x64_bf16 v[96:99], v[56:59], a[16:23], v22
  v_smfmac_f32_16x16x64_bf16 v[100:103], v[56:59], a[96:103], v22
  v_smfmac_f32_16x16x64_bf16 v[96:99], v[60:63], a[24:31], v22
  v_smfmac_f32_16x16x64_bf16 v[96:99], v[64:67], a[32:39], v22
  v_smfmac_f32_16x16x64_bf16 v[96:99], v[68:71], a[40:47], v22
  v_smfmac_f32_16x16x64_bf16 v[96:99], v[72:75], a[48:55], v22
  v_smfmac_f32_16x16x64_bf16 v[96:99], v[76:79], a[56:63], v22
  v_smfmac_f32_16x16x64_bf16 v[96:99], v[80:83], a[64:71], v22
  v_smfmac_f32_16x16x64_bf16 v[96:99], v[84:87], a[72:79], v22
  v_smfmac_f32_16x16x64_bf16 v[100:103], v[60:63], a[104:111], v22
  v_smfmac_f32_16x16x64_bf16 v[100:103], v[64:67], a[112:119], v22
  v_smfmac_f32_16x16x64_bf16 v[100:103], v[68:71], a[120:127], v22
  v_smfmac_f32_16x16x64_bf16 v[100:103], v[72:75], a[128:135], v22
  v_smfmac_f32_16x16x64_bf16 v[100:103], v[76:79], a[136:143], v22
  v_smfmac_f32_16x16x64_bf16 v[100:103], v[80:83], a[144:151], v22
  v_smfmac_f32_16x16x64_bf16 v[100:103], v[84:87], a[152:159], v22
  s_nop 7
  v_permlane32_swap_b32 v96, v100
  v_permlane32_swap_b32 v97, v101
  v_permlane32_swap_b32 v98, v102
  v_permlane32_swap_b32 v99, v103
  v_pk_add_f32 v[96:97], v[96:97], v[100:101]
  v_pk_add_f32 v[98:99], v[98:99], v[102:103]
  v_cvt_pk_bf16_f32 v182, v96, v97
  v_cvt_pk_bf16_f32 v183, v98, v99
  v_min_u32 v182, -2, v182
  ds_write_b64 v26, v[182:183]
  s_waitcnt lgkmcnt(0)
  s_barrier
  s_branch chain_done
E_27:
  v_add_u32 v190, 3072, v4
  s_waitcnt vmcnt(0)
  ds_write_b128 v190, v[60:63] offset:0
  ds_write_b128 v190, v[64:67] offset:1024
  ds_write_b128 v190, v[68:71] offset:2048
  s_add_u32 m0, s74, 6144
  s_add_u32 s21, s79, 196608
  buffer_load_dwordx4 v4, s[16:19], s21 offen offset:1024 sc1 lds
  s_add_u32 m0, s74, 4096
  s_mul_i32 s21, s91, 2
  s_add_u32 s21, s21, s71
  buffer_load_dwordx4 v4, s[16:19], s21 offen sc1 lds
  s_xor_b32 s74, s74, 16384
  s_add_u32 s73, s73, 2097152
  s_xor_b32 s73, s73, 8192
  s_add_u32 s79, s79, 2097152
  s_xor_b32 s79, s79, 8192
  s_add_u32 s21, s72, 524288
  s_xor_b32 s72, s72, s21
  s_lshr_b32 s72, s72, 8
  s_and_b32 s72, s72, 8192
  s_xor_b32 s72, s72, s21
  s_add_u32 s71, s73, 4096
  s_mov_b32 s91, 1024
  s_cmp_lt_u32 s73, 0
  s_cselect_b32 s71, s71, s79
  s_cselect_b32 s91, s91, 65536
  s_branch mo_143
  .p2align 3
top_138:
  s_waitcnt vmcnt(2)
  ds_write_b128 v190, v[60:63] offset:0
  v_cmp_eq_u32 s[22:23], -1, v60
  s_waitcnt vmcnt(1)
  ds_write_b128 v190, v[64:67] offset:1024
  v_cmp_eq_u32 s[98:99], -1, v64
  s_waitcnt vmcnt(0)
  ds_write_b128 v190, v[68:71] offset:2048
  v_cmp_eq_u32 s[100:101], -1, v68
  s_or_b64 vcc, s[22:23], s[98:99]
  s_or_b64 vcc, vcc, s[100:101]
  s_cbranch_scc1 mr_139
mo_143:
  s_waitcnt lgkmcnt(0)
  s_barrier
  ds_read_b128 v[48:51], v4 offset:0
  ds_read_b128 v[52:55], v4 offset:1024
  v_smfmac_f32_16x16x64_bf16 v[92:95], v[60:63], v[200:207], v22
  ds_read_b128 v[56:59], v4 offset:2048
  v_smfmac_f32_16x16x64_bf16 v[88:91], v[60:63], a[184:191], v22
  ds_read_b128 v[72:75], v4 offset:6144
  v_smfmac_f32_16x16x64_bf16 v[92:95], v[64:67], v[208:215], v22
  ds_read_b128 v[76:79], v4 offset:7168
  v_smfmac_f32_16x16x64_bf16 v[88:91], v[64:67], a[192:199], v22
  ds_read_b128 v[80:83], v4 offset:8192
  v_smfmac_f32_16x16x64_bf16 v[92:95], v[68:71], v[216:223], v22
  ds_read_b128 v[84:87], v4 offset:9216
  v_smfmac_f32_16x16x64_bf16 v[88:91], v[68:71], a[200:207], v22
  s_waitcnt lgkmcnt(6)
  v_smfmac_f32_16x16x64_bf16 v[92:95], v[48:51], a[240:247], v22
  v_smfmac_f32_16x16x64_bf16 v[88:91], v[48:51], a[160:167], v22
  s_waitcnt lgkmcnt(5)
  v_smfmac_f32_16x16x64_bf16 v[92:95], v[52:55], a[248:255], v22
  s_waitcnt lgkmcnt(4)
  v_smfmac_f32_16x16x64_bf16 v[92:95], v[56:59], v[192:199], v22
  s_waitcnt lgkmcnt(3)
  v_smfmac_f32_16x16x64_bf16 v[92:95], v[72:75], v[224:231], v22
  s_waitcnt lgkmcnt(2)
  v_smfmac_f32_16x16x64_bf16 v[92:95], v[76:79], v[232:239], v22
  s_waitcnt lgkmcnt(1)
  v_smfmac_f32_16x16x64_bf16 v[92:95], v[80:83], v[240:247], v22
  s_waitcnt lgkmcnt(0)
  v_smfmac_f32_16x16x64_bf16 v[92:95], v[84:87], v[248:255], v22
  v_smfmac_f32_16x16x64_bf16 v[88:91], v[52:55], a[168:175], v22
  v_smfmac_f32_16x16x64_bf16 v[88:91], v[56:59], a[176:183], v22
  v_smfmac_f32_16x16x64_bf16 v[88:91], v[72:75], a[208:215], v22
  v_permlane32_swap_b32 v92, v93
  v_smfmac_f32_16x16x64_bf16 v[88:91], v[76:79], a[216:223], v22
  v_permlane32_swap_b32 v94, v95
  v_smfmac_f32_16x16x64_bf16 v[88:91], v[80:83], a[224:231], v22
  v_permlane32_swap_b32 v93, v92
  v_smfmac_f32_16x16x64_bf16 v[88:91], v[84:87], a[232:239], v22
  v_permlane32_swap_b32 v95, v94
  v_pk_mul_f32 v[120:121], v[92:93], v[24:25] op_sel:[1,0] op_sel_hi:[0,1]
  v_pk_mul_f32 v[122:123], v[94:95], v[24:25] op_sel:[1,0] op_sel_hi:[0,1]
  s_nop 4
  v_pk_fma_f32 v[88:89], v[88:89], v[24:25], v[120:121]
  v_pk_fma_f32 v[90:91], v[90:91], v[24:25], v[122:123]
  v_cvt_pk_bf16_f32 v120, v88, v89
  v_cvt_pk_bf16_f32 v121, v90, v91
  ds_write_b64 v6, v[120:121]
  v_cmp_u_f32 vcc, v88, v89
  v_cmp_u_f32 s[22:23], v90, v91
  s_nop 1
  s_or_b64 vcc, vcc, s[22:23]
  s_cbranch_vccnz mn_140
mk_141:
  s_waitcnt lgkmcnt(0)
  s_barrier
  ds_read_b64_tr_b16 v[104:105], v7 offset:0
  ds_read_b64_tr_b16 v[106:107], v7 offset:768
  ds_read_b64_tr_b16 v[108:109], v7 offset:1536
  ds_read_b64 v[140:141], v11
  s_cmp_eq_u32 s52, 63
  s_cbranch_scc1 last_142
  s_waitcnt lgkmcnt(2)
  v_mfma_f32_16x16x32_bf16 v[120:123], v[112:115], v[104:107], 0
  s_waitcnt lgkmcnt(1)
  v_mfma_f32_16x16x32_bf16 v[120:123], v[116:119], v[108:111], v[120:123]
  s_mov_b64 exec, s[64:65]
  s_nop 6
  v_cvt_pk_f16_f32 v120, v120, v121
  v_cvt_pk_f16_f32 v121, v122, v123
  buffer_store_dwordx2 v[120:121], v8, s[8:11], s56 offen sc1
  s_mov_b64 exec, -1
  s_sleep 3
  s_nop 1
  v_smfmac_f32_16x16x64_bf16 v[96:99], v[48:51], a[0:7], v22
  v_smfmac_f32_16x16x64_bf16 v[100:103], v[48:51], a[80:87], v22
  v_smfmac_f32_16x16x64_bf16 v[96:99], v[52:55], a[8:15], v22
  v_smfmac_f32_16x16x64_bf16 v[100:103], v[52:55], a[88:95], v22
  v_smfmac_f32_16x16x64_bf16 v[96:99], v[56:59], a[16:23], v22
  v_smfmac_f32_16x16x64_bf16 v[100:103], v[56:59], a[96:103], v22
  v_smfmac_f32_16x16x64_bf16 v[96:99], v[60:63], a[24:31], v22
  v_smfmac_f32_16x16x64_bf16 v[96:99], v[64:67], a[32:39], v22
  v_smfmac_f32_16x16x64_bf16 v[96:99], v[68:71], a[40:47], v22
  v_smfmac_f32_16x16x64_bf16 v[96:99], v[72:75], a[48:55], v22
  v_smfmac_f32_16x16x64_bf16 v[96:99], v[76:79], a[56:63], v22
  buffer_load_dwordx4 v[124:127], v9, s[8:11], s56 offen sc1
  v_smfmac_f32_16x16x64_bf16 v[96:99], v[80:83], a[64:71], v22
  buffer_load_dwordx4 v[128:131], v9, s[8:11], s56 offen offset:1024 sc1
  v_smfmac_f32_16x16x64_bf16 v[96:99], v[84:87], a[72:79], v22
  buffer_load_dwordx4 v[132:135], v10, s[8:11], s56 offen sc1
  v_smfmac_f32_16x16x64_bf16 v[100:103], v[60:63], a[104:111], v22
  v_smfmac_f32_16x16x64_bf16 v[100:103], v[64:67], a[112:119], v22
  v_smfmac_f32_16x16x64_bf16 v[100:103], v[68:71], a[120:127], v22
  v_smfmac_f32_16x16x64_bf16 v[100:103], v[72:75], a[128:135], v22
  v_cvt_pk_bf16_f32 v136, v96, v97
  v_smfmac_f32_16x16x64_bf16 v[100:103], v[76:79], a[136:143], v22
  v_cvt_pk_bf16_f32 v137, v98, v99
  v_smfmac_f32_16x16x64_bf16 v[100:103], v[80:83], a[144:151], v22
  v_smfmac_f32_16x16x64_bf16 v[100:103], v[84:87], a[152:159], v22
  s_waitcnt vmcnt(2)
  v_pk_add_f16 v172, v124, v126
  v_pk_add_f16 v173, v125, v127
  s_waitcnt vmcnt(1)
  v_pk_add_f16 v174, v128, v130
  v_pk_add_f16 v175, v129, v131
  v_fma_mix_f32 v166, v172, 1.0, v174 op_sel:[0,0,0] op_sel_hi:[1,0,1]
  v_fma_mix_f32 v168, v173, 1.0, v175 op_sel:[0,0,0] op_sel_hi:[1,0,1]
  s_waitcnt vmcnt(0)
  v_pk_add_f16 v176, v132, v133
  v_pk_add_f16 v177, v134, v135
  v_fma_mix_f32 v170, v176, 1.0, v177 op_sel:[0,0,0] op_sel_hi:[1,0,1]
  v_fma_mix_f32 v167, v172, 1.0, v174 op_sel:[1,0,1] op_sel_hi:[1,0,1]
  v_cmp_u_f32 vcc, v166, v170
  v_fma_mix_f32 v169, v173, 1.0, v175 op_sel:[1,0,1] op_sel_hi:[1,0,1]
  v_fma_mix_f32 v171, v176, 1.0, v177 op_sel:[1,0,1] op_sel_hi:[1,0,1]
  v_cvt_pk_bf16_f32 v138, v100, v101
  s_cbranch_vccnz sr_144
sj_145:
ex_146:
  v_exp_f32 v172, v166
  v_exp_f32 v173, v167
  v_exp_f32 v174, v168
  v_cvt_pk_bf16_f32 v156, v172, v173
  v_exp_f32 v175, v169
  v_exp_f32 v176, v170
  v_cvt_pk_bf16_f32 v157, v174, v175
  v_mov_b32_dpp v158, v156 row_ror:8 row_mask:0xf bank_mask:0xf
  v_exp_f32 v177, v171
  v_mov_b32_dpp v159, v157 row_ror:8 row_mask:0xf bank_mask:0xf
  v_cvt_pk_bf16_f32 v160, v176, v177
  v_cvt_pk_bf16_f32 v139, v102, v103
  v_mfma_f32_16x16x32_bf16 v[178:181], v[152:155], v[156:159], 0
  s_waitcnt lgkmcnt(0)
  v_mov_b32_dpp v161, v160 row_ror:8 row_mask:0xf bank_mask:0xf
  v_mfma_f32_16x16x32_bf16 v[182:185], v[144:147], v[156:159], 0
  s_nop 0
  v_mfma_f32_16x16x32_bf16 v[178:181], v[140:143], v[160:163], v[178:181]
  v_mfma_f32_16x16x32_bf16 v[182:185], v[136:139], v[160:163], v[182:185]
  v_mfma_f32_16x16x32_bf16 v[186:189], v[148:151], v[156:159], 0
  v_mfma_f32_16x16x32_bf16 v[186:189], v[138:141], v[160:163], v[186:189]
  s_mov_b64 exec, s[62:63]
  v_rcp_f32 v164, v180
  s_nop 0
  v_pk_mul_f32 v[178:179], v[178:179], v[164:165] op_sel_hi:[1,0]
  v_pk_mul_f32 v[182:183], v[182:183], v[164:165] op_sel_hi:[1,0]
  v_pk_mul_f32 v[184:185], v[184:185], v[164:165] op_sel_hi:[1,0]
  v_cvt_pk_f16_f32 v64, v178, v179
  v_cvt_pk_f16_f32 v60, v182, v183
  v_pk_mul_f32 v[186:187], v[186:187], v[164:165] op_sel_hi:[1,0]
  v_pk_mul_f32 v[188:189], v[188:189], v[164:165] op_sel_hi:[1,0]
  v_cvt_pk_f16_f32 v61, v184, v185
  v_cvt_pk_f16_f32 v62, v186, v187
  v_cvt_pk_f16_f32 v63, v188, v189
  ds_write_b128 v13, v[60:63]
  ds_write_b32 v14, v64
  v_add_f32 v165, v164, v180
  v_cmp_ngt_f32 vcc, s80, v165
  s_mov_b64 exec, -1
  s_nop 0
  s_cbranch_vccnz fx_147
fk_148:
  s_waitcnt lgkmcnt(0)
  s_barrier
  s_add_u32 m0, s74, 6144
  s_add_u32 s21, s79, 196608
  buffer_load_dwordx4 v4, s[16:19], s21 offen offset:1024 sc1 lds
  s_add_u32 m0, s74, 4096
  s_mul_i32 s21, s91, 2
  s_add_u32 s21, s21, s71
  buffer_load_dwordx4 v4, s[16:19], s21 offen sc1 lds
  s_xor_b32 s74, s74, 16384
  s_add_u32 s73, s73, 2097152
  s_xor_b32 s73, s73, 8192
  s_add_u32 s79, s79, 2097152
  s_xor_b32 s79, s79, 8192
  s_add_u32 s21, s72, 524288
  s_xor_b32 s72, s72, s21
  s_lshr_b32 s72, s72, 8
  s_and_b32 s72, s72, 8192
  s_xor_b32 s72, s72, s21
  s_add_u32 s71, s73, 4096
  s_mov_b32 s91, 1024
  s_cmp_lt_u32 s73, 0
  s_cselect_b32 s71, s71, s79
  s_cselect_b32 s91, s91, 65536
  s_nop 15
  s_nop 3
  v_permlane32_swap_b32 v96, v100
  v_permlane32_swap_b32 v97, v101
  v_permlane32_swap_b32 v98, v102
  v_permlane32_swap_b32 v99, v103
  v_pk_add_f32 v[96:97], v[96:97], v[100:101]
  v_pk_add_f32 v[98:99], v[98:99], v[102:103]
  v_cvt_pk_bf16_f32 v182, v96, v97
  v_cvt_pk_bf16_f32 v183, v98, v99
  v_min_u32 v182, -2, v182
  ds_write_b64 v26, v[182:183]
  ds_read_b128 v[144:147], v18
  ds_read_b128 v[148:151], v18 offset:1024
  ds_read_b128 v[152:155], v19
  ds_read_b128 v[112:115], v20
  ds_read_b64 v[116:117], v21
  v_xor_b32 v18, 16384, v18
  v_xor_b32 v19, 16384, v19
  v_xor_b32 v20, 16384, v20
  v_xor_b32 v21, 16384, v21
  v_mov_b32 v88, 0
  v_mov_b32 v89, 0
  v_mov_b32 v90, 0
  v_mov_b32 v91, 0
  v_mov_b32 v92, 0
  v_mov_b32 v93, 0
  v_mov_b32 v94, 0
  v_mov_b32 v95, 0
  v_mov_b32 v96, 0
  v_mov_b32 v97, 0
  v_mov_b32 v98, 0
  v_mov_b32 v99, 0
  v_mov_b32 v100, 0
  v_mov_b32 v101, 0
  v_mov_b32 v102, 0
  v_mov_b32 v103, 0
  s_mov_b32 s81, 0
  s_waitcnt lgkmcnt(0)
  s_barrier
  s_mov_b64 exec, s[64:65]
  buffer_store_dwordx2 v[28:29], v8, s[8:11], s57 offen sc1
  s_mov_b64 exec, s[62:63]
  buffer_store_dword v28, v17, s[8:11], s59 offen sc1
  s_mov_b64 exec, -1
  s_sleep 6
  s_nop 3
  buffer_load_dwordx4 v[68:71], v16, s[4:7], s60 offen sc1
  s_sleep 3
  s_nop 1
  buffer_load_dwordx4 v[72:75], v16, s[4:7], s60 offen sc1
  s_waitcnt vmcnt(1)
  v_mfma_f32_16x16x32_f16 v[120:123], v[44:47], v[68:71], 0
  v_bitop3_b32 v27, v68, s61, 1 bitop3:0x28
  v_cmp_ne_u32 vcc, 0, v27
  s_nop 1
  s_cbranch_vccnz p2_153
  s_nop 2
pg_152:
  v_add_f32_dpp v120, v120, v120 row_ror:8 row_mask:0xf bank_mask:0xf
  v_add_f32_dpp v121, v121, v121 row_ror:8 row_mask:0xf bank_mask:0xf
  s_mov_b64 exec, s[62:63]
  v_cvt_pk_bf16_f32 v120, v120, v121
  v_min_u32 v120, -2, v120
  buffer_store_dword v120, v17, s[8:11], s55 offen sc1
  s_mov_b64 exec, -1
nt_149:
  s_barrier
  s_mov_b32 s58, s55
  s_add_u32 s52, s52, 1
  s_and_b32 s21, s52, 3
  s_mul_i32 s56, s21, 122880
  s_add_u32 s21, s52, 1
  s_and_b32 s21, s21, 3
  s_mul_i32 s55, s21, 122880
  s_add_u32 s55, s55, s75
  s_add_u32 s21, s52, 2
  s_and_b32 s21, s21, 3
  s_mul_i32 s57, s21, 122880
  s_add_u32 s21, s52, 3
  s_and_b32 s21, s21, 3
  s_mul_i32 s59, s21, 122880
  s_add_u32 s59, s59, s75
  s_bfe_u32 s61, s52, 0x10002
  s_and_b32 s21, s52, 3
  s_lshl_b32 s60, s21, 18
  s_mov_b32 s54, 0
  s_sleep 3
  s_nop 2
  buffer_load_dwordx4 v[60:63], v190, s[8:11], s58 offen offset:0 sc1
  buffer_load_dwordx4 v[64:67], v190, s[8:11], s58 offen offset:1024 sc1
  buffer_load_dwordx4 v[68:71], v190, s[8:11], s58 offen offset:2048 sc1
  s_branch top_138
mr_139:
  s_mov_b64 exec, s[22:23]
  s_cbranch_execz ms_154
  buffer_load_dwordx4 v[60:63], v190, s[8:11], s58 offen offset:0 sc1
ms_154:
  s_mov_b64 exec, s[98:99]
  s_cbranch_execz ms_155
  buffer_load_dwordx4 v[64:67], v190, s[8:11], s58 offen offset:1024 sc1
ms_155:
  s_mov_b64 exec, s[100:101]
  s_cbranch_execz ms_156
  buffer_load_dwordx4 v[68:71], v190, s[8:11], s58 offen offset:2048 sc1
ms_156:
  s_add_u32 s54, s54, 1
  s_cmp_gt_u32 s54, 131072
  s_cbranch_scc1 end0
  s_waitcnt vmcnt(0)
  s_mov_b64 exec, s[22:23]
  ds_write_b128 v190, v[60:63] offset:0
  v_cmp_eq_u32 s[22:23], -1, v60
  s_mov_b64 exec, s[98:99]
  ds_write_b128 v190, v[64:67] offset:1024
  v_cmp_eq_u32 s[98:99], -1, v64
  s_mov_b64 exec, s[100:101]
  ds_write_b128 v190, v[68:71] offset:2048
  v_cmp_eq_u32 s[100:101], -1, v68
  s_mov_b64 exec, -1
  s_or_b64 vcc, s[22:23], s[98:99]
  s_or_b64 vcc, vcc, s[100:101]
  s_cbranch_scc1 mr_139
  s_branch mo_143
mn_140:
  v_max3_u32 v27, v48, v49, v50
  v_max3_u32 v27, v27, v51, v52
  v_max3_u32 v27, v27, v53, v54
  v_max3_u32 v27, v27, v55, v56
  v_max3_u32 v27, v27, v57, v58
  v_max3_u32 v27, v27, v59, v60
  v_max3_u32 v27, v27, v61, v62
  v_max3_u32 v27, v27, v63, v64
  v_max3_u32 v27, v27, v65, v66
  v_max3_u32 v27, v27, v67, v68
  v_max3_u32 v27, v27, v69, v70
  v_max3_u32 v27, v27, v71, v72
  v_max3_u32 v27, v27, v73, v74
  v_max3_u32 v27, v27, v75, v76
  v_max3_u32 v27, v27, v77, v78
  v_max3_u32 v27, v27, v79, v80
  v_max3_u32 v27, v27, v81, v82
  v_max3_u32 v27, v27, v83, v84
  v_max3_u32 v27, v27, v85, v86
  v_max3_u32 v27, v27, v87, v87
  v_cmp_eq_u32 vcc, -1, v27
  s_cmp_eq_u32 s52, 0
  s_cbranch_scc1 mk_141
  s_cbranch_vccz mk_141
  s_waitcnt lgkmcnt(0)
  s_barrier
  s_nop 7
  v_mov_b32 v88, 0
  v_mov_b32 v89, 0
  v_mov_b32 v90, 0
  v_mov_b32 v91, 0
  v_mov_b32 v92, 0
  v_mov_b32 v93, 0
  v_mov_b32 v94, 0
  v_mov_b32 v95, 0
  v_mov_b32 v96, 0
  v_mov_b32 v97, 0
  v_mov_b32 v98, 0
  v_mov_b32 v99, 0
  v_mov_b32 v100, 0
  v_mov_b32 v101, 0
  v_mov_b32 v102, 0
  v_mov_b32 v103, 0
  s_mov_b64 s[22:23], -1
  s_mov_b64 s[98:99], -1
  s_mov_b64 s[100:101], -1
  s_branch mr_139
sr_144:
  s_mov_b32 s54, 0
sr_157:
  s_mov_b64 exec, vcc
  buffer_load_dwordx4 v[124:127], v9, s[8:11], s56 offen sc1
  buffer_load_dwordx4 v[128:131], v9, s[8:11], s56 offen offset:1024 sc1
  buffer_load_dwordx4 v[132:135], v10, s[8:11], s56 offen sc1
  s_mov_b64 exec, -1
  s_add_u32 s54, s54, 1
  s_cmp_gt_u32 s54, 131072
  s_cbranch_scc1 end0
  s_and_b32 s21, s54, 31
  s_cbranch_scc0 sr_158
  s_waitcnt vmcnt(0)
  v_pk_add_f16 v172, v124, v126
  v_pk_add_f16 v173, v125, v127
  v_pk_add_f16 v174, v128, v130
  v_pk_add_f16 v175, v129, v131
  v_fma_mix_f32 v166, v172, 1.0, v174 op_sel:[0,0,0] op_sel_hi:[1,0,1]
  v_fma_mix_f32 v168, v173, 1.0, v175 op_sel:[0,0,0] op_sel_hi:[1,0,1]
  v_pk_add_f16 v176, v132, v133
  v_pk_add_f16 v177, v134, v135
  v_add_f32 v27, v166, v168
  v_fma_mix_f32 v170, v176, 1.0, v177 op_sel:[0,0,0] op_sel_hi:[1,0,1]
  v_fma_mix_f32 v167, v172, 1.0, v174 op_sel:[1,0,1] op_sel_hi:[1,0,1]
  v_cmp_u_f32 vcc, v27, v170
  v_fma_mix_f32 v169, v173, 1.0, v175 op_sel:[1,0,1] op_sel_hi:[1,0,1]
  v_fma_mix_f32 v171, v176, 1.0, v177 op_sel:[1,0,1] op_sel_hi:[1,0,1]
  s_cbranch_vccnz sr_157
  s_branch sj_145
sr_158:
  s_waitcnt vmcnt(0)
  v_pk_add_f16 v172, v124, v126
  v_pk_add_f16 v173, v125, v127
  v_pk_add_f16 v174, v128, v130
  v_pk_add_f16 v175, v129, v131
  v_fma_mix_f32 v166, v172, 1.0, v174 op_sel:[0,0,0] op_sel_hi:[1,0,1]
  v_fma_mix_f32 v168, v173, 1.0, v175 op_sel:[0,0,0] op_sel_hi:[1,0,1]
  v_pk_add_f16 v176, v132, v133
  v_pk_add_f16 v177, v134, v135
  v_add_f32 v27, v166, v168
  v_fma_mix_f32 v170, v176, 1.0, v177 op_sel:[0,0,0] op_sel_hi:[1,0,1]
  v_fma_mix_f32 v167, v172, 1.0, v174 op_sel:[1,0,1] op_sel_hi:[1,0,1]
  v_cmp_u_f32 vcc, v27, v170
  v_fma_mix_f32 v169, v173, 1.0, v175 op_sel:[1,0,1] op_sel_hi:[1,0,1]
  v_fma_mix_f32 v171, v176, 1.0, v177 op_sel:[1,0,1] op_sel_hi:[1,0,1]
  v_max3_u32 v27, v124, v126, v128
  v_max3_u32 v27, v27, v130, v132
  v_max3_u32 v27, v27, v133, v134
  v_max3_u32 v27, v27, v135, v135
  v_cmp_eq_u32 vcc, -1, v27
  s_nop 1
  s_cbranch_vccnz sr_157
  s_branch sj_145
fx_147:
  s_cmp_eq_u32 s81, 1
  s_cbranch_scc1 fk_148
  s_mov_b32 s81, 1
  v_max3_f32 v164, v166, v167, v168
  v_max3_f32 v165, v169, v170, v171
  v_max_f32 v164, v164, v165
  s_nop 1
  v_max_f32_dpp v164, v164, v164 row_ror:8 row_mask:0xf bank_mask:0xf
  v_mov_b32 v165, v164
  s_nop 1
  v_permlane32_swap_b32 v164, v165
  v_max_f32 v164, v164, v165
  v_mov_b32 v165, v164
  s_nop 1
  v_permlane16_swap_b32 v164, v165
  v_max_f32 v164, v164, v165
  v_sub_f32 v166, v166, v164
  v_sub_f32 v167, v167, v164
  v_sub_f32 v168, v168, v164
  v_sub_f32 v169, v169, v164
  v_sub_f32 v170, v170, v164
  v_sub_f32 v171, v171, v164
  s_branch ex_146
p2_153:
  s_mov_b32 s54, 0
  buffer_load_dwordx4 v[68:71], v16, s[4:7], s60 offen sc1
  s_waitcnt vmcnt(1)
  v_mfma_f32_16x16x32_f16 v[120:123], v[44:47], v[72:75], 0
  v_bitop3_b32 v27, v72, s61, 1 bitop3:0x28
  v_cmp_ne_u32 vcc, 0, v27
  s_nop 1
  s_cbranch_vccz pg_152
  buffer_load_dwordx4 v[72:75], v16, s[4:7], s60 offen sc1
pp_151:
  s_waitcnt vmcnt(1)
  v_mfma_f32_16x16x32_f16 v[120:123], v[44:47], v[68:71], 0
  v_bitop3_b32 v27, v68, s61, 1 bitop3:0x28
  v_cmp_ne_u32 vcc, 0, v27
  s_nop 1
  s_cbranch_vccz pg_152
  buffer_load_dwordx4 v[68:71], v16, s[4:7], s60 offen sc1
  s_waitcnt vmcnt(1)
  v_mfma_f32_16x16x32_f16 v[120:123], v[44:47], v[72:75], 0
  v_bitop3_b32 v27, v72, s61, 1 bitop3:0x28
  v_cmp_ne_u32 vcc, 0, v27
  s_nop 1
  s_cbranch_vccz pg_152
  buffer_load_dwordx4 v[72:75], v16, s[4:7], s60 offen sc1
  s_add_u32 s54, s54, 1
  s_cmp_gt_u32 s54, 131072
  s_cbranch_scc1 end0
  s_branch pp_151
last_142:
  v_smfmac_f32_16x16x64_bf16 v[96:99], v[48:51], a[0:7], v22
  v_smfmac_f32_16x16x64_bf16 v[100:103], v[48:51], a[80:87], v22
  v_smfmac_f32_16x16x64_bf16 v[96:99], v[52:55], a[8:15], v22
  v_smfmac_f32_16x16x64_bf16 v[100:103], v[52:55], a[88:95], v22
  v_smfmac_f32_16x16x64_bf16 v[96:99], v[56:59], a[16:23], v22
  v_smfmac_f32_16x16x64_bf16 v[100:103], v[56:59], a[96:103], v22
  v_smfmac_f32_16x16x64_bf16 v[96:99], v[60:63], a[24:31], v22
  v_smfmac_f32_16x16x64_bf16 v[96:99], v[64:67], a[32:39], v22
  v_smfmac_f32_16x16x64_bf16 v[96:99], v[68:71], a[40:47], v22
  v_smfmac_f32_16x16x64_bf16 v[96:99], v[72:75], a[48:55], v22
  v_smfmac_f32_16x16x64_bf16 v[96:99], v[76:79], a[56:63], v22
  v_smfmac_f32_16x16x64_bf16 v[96:99], v[80:83], a[64:71], v22
  v_smfmac_f32_16x16x64_bf16 v[96:99], v[84:87], a[72:79], v22
  v_smfmac_f32_16x16x64_bf16 v[100:103], v[60:63], a[104:111], v22
  v_smfmac_f32_16x16x64_bf16 v[100:103], v[64:67], a[112:119], v22
  v_smfmac_f32_16x16x64_bf16 v[100:103], v[68:71], a[120:127], v22
  v_smfmac_f32_16x16x64_bf16 v[100:103], v[72:75], a[128:135], v22
  v_smfmac_f32_16x16x64_bf16 v[100:103], v[76:79], a[136:143], v22
  v_smfmac_f32_16x16x64_bf16 v[100:103], v[80:83], a[144:151], v22
  v_smfmac_f32_16x16x64_bf16 v[100:103], v[84:87], a[152:159], v22
  s_nop 7
  v_permlane32_swap_b32 v96, v100
  v_permlane32_swap_b32 v97, v101
  v_permlane32_swap_b32 v98, v102
  v_permlane32_swap_b32 v99, v103
  v_pk_add_f32 v[96:97], v[96:97], v[100:101]
  v_pk_add_f32 v[98:99], v[98:99], v[102:103]
  v_cvt_pk_bf16_f32 v182, v96, v97
  v_cvt_pk_bf16_f32 v183, v98, v99
  v_min_u32 v182, -2, v182
  ds_write_b64 v26, v[182:183]
  s_waitcnt lgkmcnt(0)
  s_barrier
  s_branch chain_done
E_29:
  v_add_u32 v190, 6144, v4
  s_waitcnt vmcnt(0)
  ds_write_b128 v190, v[72:75] offset:0
  ds_write_b128 v190, v[76:79] offset:1024
  ds_write_b128 v190, v[80:83] offset:2048
  s_add_u32 m0, s74, 0
  s_mul_i32 s21, s91, 0
  s_add_u32 s21, s21, s71
  buffer_load_dwordx4 v4, s[16:19], s21 offen sc1 lds
  s_add_u32 m0, s74, 6144
  s_mul_i32 s21, s91, 3
  s_add_u32 s21, s21, s71
  buffer_load_dwordx4 v4, s[16:19], s21 offen sc1 lds
  s_xor_b32 s74, s74, 16384
  s_add_u32 s73, s73, 2097152
  s_xor_b32 s73, s73, 8192
  s_add_u32 s79, s79, 2097152
  s_xor_b32 s79, s79, 8192
  s_add_u32 s21, s72, 524288
  s_xor_b32 s72, s72, s21
  s_lshr_b32 s72, s72, 8
  s_and_b32 s72, s72, 8192
  s_xor_b32 s72, s72, s21
  s_add_u32 s71, s73, 4096
  s_mov_b32 s91, 1024
  s_cmp_lt_u32 s73, 0
  s_cselect_b32 s71, s71, s79
  s_cselect_b32 s91, s91, 65536
  s_branch mo_164
  .p2align 3
top_159:
  s_waitcnt vmcnt(2)
  ds_write_b128 v190, v[72:75] offset:0
  v_cmp_eq_u32 s[22:23], -1, v72
  s_waitcnt vmcnt(1)
  ds_write_b128 v190, v[76:79] offset:1024
  v_cmp_eq_u32 s[98:99], -1, v76
  s_waitcnt vmcnt(0)
  ds_write_b128 v190, v[80:83] offset:2048
  v_cmp_eq_u32 s[100:101], -1, v80
  s_or_b64 vcc, s[22:23], s[98:99]
  s_or_b64 vcc, vcc, s[100:101]
  s_cbranch_scc1 mr_160
mo_164:
  s_waitcnt lgkmcnt(0)
  s_barrier
  ds_read_b128 v[48:51], v4 offset:0
  ds_read_b128 v[52:55], v4 offset:1024
  v_smfmac_f32_16x16x64_bf16 v[92:95], v[72:75], v[224:231], v22
  ds_read_b128 v[56:59], v4 offset:2048
  v_smfmac_f32_16x16x64_bf16 v[88:91], v[72:75], a[208:215], v22
  ds_read_b128 v[60:63], v4 offset:3072
  v_smfmac_f32_16x16x64_bf16 v[92:95], v[76:79], v[232:239], v22
  ds_read_b128 v[64:67], v4 offset:4096
  v_smfmac_f32_16x16x64_bf16 v[88:91], v[76:79], a[216:223], v22
  ds_read_b128 v[68:71], v4 offset:5120
  v_smfmac_f32_16x16x64_bf16 v[92:95], v[80:83], v[240:247], v22
  ds_read_b128 v[84:87], v4 offset:9216
  v_smfmac_f32_16x16x64_bf16 v[88:91], v[80:83], a[224:231], v22
  s_waitcnt lgkmcnt(6)
  v_smfmac_f32_16x16x64_bf16 v[92:95], v[48:51], a[240:247], v22
  v_smfmac_f32_16x16x64_bf16 v[88:91], v[48:51], a[160:167], v22
  s_waitcnt lgkmcnt(5)
  v_smfmac_f32_16x16x64_bf16 v[92:95], v[52:55], a[248:255], v22
  s_waitcnt lgkmcnt(4)
  v_smfmac_f32_16x16x64_bf16 v[92:95], v[56:59], v[192:199], v22
  s_waitcnt lgkmcnt(3)
  v_smfmac_f32_16x16x64_bf16 v[92:95], v[60:63], v[200:207], v22
  s_waitcnt lgkmcnt(2)
  v_smfmac_f32_16x16x64_bf16 v[92:95], v[64:67], v[208:215], v22
  s_waitcnt lgkmcnt(1)
  v_smfmac_f32_16x16x64_bf16 v[92:95], v[68:71], v[216:223], v22
  s_waitcnt lgkmcnt(0)
  v_smfmac_f32_16x16x64_bf16 v[92:95], v[84:87], v[248:255], v22
  v_smfmac_f32_16x16x64_bf16 v[88:91], v[52:55], a[168:175], v22
  v_smfmac_f32_16x16x64_bf16 v[88:91], v[56:59], a[176:183], v22
  v_smfmac_f32_16x16x64_bf16 v[88:91], v[60:63], a[184:191], v22
  v_permlane32_swap_b32 v92, v93
  v_smfmac_f32_16x16x64_bf16 v[88:91], v[64:67], a[192:199], v22
  v_permlane32_swap_b32 v94, v95
  v_smfmac_f32_16x16x64_bf16 v[88:91], v[68:71], a[200:207], v22
  v_permlane32_swap_b32 v93, v92
  v_smfmac_f32_16x16x64_bf16 v[88:91], v[84:87], a[232:239], v22
  v_permlane32_swap_b32 v95, v94
  v_pk_mul_f32 v[120:121], v[92:93], v[24:25] op_sel:[1,0] op_sel_hi:[0,1]
  v_pk_mul_f32 v[122:123], v[94:95], v[24:25] op_sel:[1,0] op_sel_hi:[0,1]
  s_nop 4
  v_pk_fma_f32 v[88:89], v[88:89], v[24:25], v[120:121]
  v_pk_fma_f32 v[90:91], v[90:91], v[24:25], v[122:123]
  v_cvt_pk_bf16_f32 v120, v88, v89
  v_cvt_pk_bf16_f32 v121, v90, v91
  ds_write_b64 v6, v[120:121]
  v_cmp_u_f32 vcc, v88, v89
  v_cmp_u_f32 s[22:23], v90, v91
  s_nop 1
  s_or_b64 vcc, vcc, s[22:23]
  s_cbranch_vccnz mn_161
mk_162:
  s_waitcnt lgkmcnt(0)
  s_barrier
  ds_read_b64_tr_b16 v[104:105], v7 offset:0
  ds_read_b64_tr_b16 v[106:107], v7 offset:768
  ds_read_b64_tr_b16 v[108:109], v7 offset:1536
  ds_read_b64 v[140:141], v11
  s_cmp_eq_u32 s52, 63
  s_cbranch_scc1 last_163
  s_waitcnt lgkmcnt(2)
  v_mfma_f32_16x16x32_bf16 v[120:123], v[104:107], v[104:107], 0
  s_waitcnt lgkmcnt(1)
  v_mfma_f32_16x16x32_bf16 v[120:123], v[108:111], v[108:111], v[120:123]
  s_mov_b64 exec, s[64:65]
  s_nop 6
  v_cvt_pk_f16_f32 v120, v120, v121
  buffer_store_dword v120, v8, s[8:11], s56 offen sc1
  v_cvt_pk_f16_f32 v121, v122, v123
  buffer_store_dword v121, v8, s[8:11], s56 offen offset:128 sc1
  s_mov_b64 exec, -1
  s_sleep 3
  s_nop 1
  v_smfmac_f32_16x16x64_bf16 v[96:99], v[48:51], a[0:7], v22
  v_smfmac_f32_16x16x64_bf16 v[100:103], v[48:51], a[80:87], v22
  v_smfmac_f32_16x16x64_bf16 v[96:99], v[52:55], a[8:15], v22
  v_smfmac_f32_16x16x64_bf16 v[100:103], v[52:55], a[88:95], v22
  v_smfmac_f32_16x16x64_bf16 v[96:99], v[56:59], a[16:23], v22
  v_smfmac_f32_16x16x64_bf16 v[100:103], v[56:59], a[96:103], v22
  v_smfmac_f32_16x16x64_bf16 v[96:99], v[60:63], a[24:31], v22
  v_smfmac_f32_16x16x64_bf16 v[96:99], v[64:67], a[32:39], v22
  v_smfmac_f32_16x16x64_bf16 v[96:99], v[68:71], a[40:47], v22
  v_smfmac_f32_16x16x64_bf16 v[96:99], v[72:75], a[48:55], v22
  v_smfmac_f32_16x16x64_bf16 v[96:99], v[76:79], a[56:63], v22
  buffer_load_dwordx4 v[124:127], v9, s[8:11], s56 offen sc1
  v_smfmac_f32_16x16x64_bf16 v[96:99], v[80:83], a[64:71], v22
  buffer_load_dwordx4 v[128:131], v9, s[8:11], s56 offen offset:1024 sc1
  v_smfmac_f32_16x16x64_bf16 v[96:99], v[84:87], a[72:79], v22
  buffer_load_dwordx4 v[132:135], v10, s[8:11], s56 offen sc1
  v_smfmac_f32_16x16x64_bf16 v[100:103], v[60:63], a[104:111], v22
  v_smfmac_f32_16x16x64_bf16 v[100:103], v[64:67], a[112:119], v22
  v_smfmac_f32_16x16x64_bf16 v[100:103], v[68:71], a[120:127], v22
  v_smfmac_f32_16x16x64_bf16 v[100:103], v[72:75], a[128:135], v22
  v_cvt_pk_bf16_f32 v136, v96, v97
  v_smfmac_f32_16x16x64_bf16 v[100:103], v[76:79], a[136:143], v22
  v_cvt_pk_bf16_f32 v137, v98, v99
  v_smfmac_f32_16x16x64_bf16 v[100:103], v[80:83], a[144:151], v22
  v_smfmac_f32_16x16x64_bf16 v[100:103], v[84:87], a[152:159], v22
  s_waitcnt vmcnt(2)
  v_pk_add_f16 v172, v124, v126
  v_pk_add_f16 v173, v125, v127
  s_waitcnt vmcnt(1)
  v_pk_add_f16 v174, v128, v130
  v_pk_add_f16 v175, v129, v131
  v_fma_mix_f32 v166, v172, 1.0, v174 op_sel:[0,0,0] op_sel_hi:[1,0,1]
  v_fma_mix_f32 v168, v173, 1.0, v175 op_sel:[0,0,0] op_sel_hi:[1,0,1]
  s_waitcnt vmcnt(0)
  v_pk_add_f16 v176, v132, v133
  v_pk_add_f16 v177, v134, v135
  v_fma_mix_f32 v170, v176, 1.0, v177 op_sel:[0,0,0] op_sel_hi:[1,0,1]
  v_fma_mix_f32 v167, v172, 1.0, v174 op_sel:[1,0,1] op_sel_hi:[1,0,1]
  v_cmp_u_f32 vcc, v166, v170
  v_fma_mix_f32 v169, v173, 1.0, v175 op_sel:[1,0,1] op_sel_hi:[1,0,1]
  v_fma_mix_f32 v171, v176, 1.0, v177 op_sel:[1,0,1] op_sel_hi:[1,0,1]
  v_cvt_pk_bf16_f32 v138, v100, v101
  s_cbranch_vccnz sr_165
sj_166:
ex_167:
  v_exp_f32 v172, v166
  v_exp_f32 v173, v167
  v_exp_f32 v174, v168
  v_cvt_pk_bf16_f32 v156, v172, v173
  v_exp_f32 v175, v169
  v_exp_f32 v176, v170
  v_cvt_pk_bf16_f32 v157, v174, v175
  v_mov_b32_dpp v158, v156 row_ror:8 row_mask:0xf bank_mask:0xf
  v_exp_f32 v177, v171
  v_mov_b32_dpp v159, v157 row_ror:8 row_mask:0xf bank_mask:0xf
  v_cvt_pk_bf16_f32 v160, v176, v177
  v_cvt_pk_bf16_f32 v139, v102, v103
  v_mfma_f32_16x16x32_bf16 v[178:181], v[152:155], v[156:159], 0
  s_waitcnt lgkmcnt(0)
  v_mov_b32_dpp v161, v160 row_ror:8 row_mask:0xf bank_mask:0xf
  v_mfma_f32_16x16x32_bf16 v[182:185], v[144:147], v[156:159], 0
  s_nop 0
  v_mfma_f32_16x16x32_bf16 v[178:181], v[140:143], v[160:163], v[178:181]
  v_mfma_f32_16x16x32_bf16 v[182:185], v[136:139], v[160:163], v[182:185]
  v_mfma_f32_16x16x32_bf16 v[186:189], v[148:151], v[156:159], 0
  v_mfma_f32_16x16x32_bf16 v[186:189], v[138:141], v[160:163], v[186:189]
  s_mov_b64 exec, s[62:63]
  v_rcp_f32 v164, v180
  s_nop 0
  v_pk_mul_f32 v[178:179], v[178:179], v[164:165] op_sel_hi:[1,0]
  v_pk_mul_f32 v[182:183], v[182:183], v[164:165] op_sel_hi:[1,0]
  v_pk_mul_f32 v[184:185], v[184:185], v[164:165] op_sel_hi:[1,0]
  v_cvt_pk_f16_f32 v64, v178, v179
  v_cvt_pk_f16_f32 v60, v182, v183
  v_pk_mul_f32 v[186:187], v[186:187], v[164:165] op_sel_hi:[1,0]
  v_pk_mul_f32 v[188:189], v[188:189], v[164:165] op_sel_hi:[1,0]
  v_cvt_pk_f16_f32 v61, v184, v185
  v_cvt_pk_f16_f32 v62, v186, v187
  v_cvt_pk_f16_f32 v63, v188, v189
  ds_write_b128 v13, v[60:63]
  ds_write_b32 v14, v64
  v_add_f32 v165, v164, v180
  v_cmp_ngt_f32 vcc, s80, v165
  s_mov_b64 exec, -1
  s_nop 0
  s_cbranch_vccnz fx_168
fk_169:
  s_waitcnt lgkmcnt(0)
  s_barrier
  s_add_u32 m0, s74, 0
  s_mul_i32 s21, s91, 0
  s_add_u32 s21, s21, s71
  buffer_load_dwordx4 v4, s[16:19], s21 offen sc1 lds
  s_add_u32 m0, s74, 6144
  s_mul_i32 s21, s91, 3
  s_add_u32 s21, s21, s71
  buffer_load_dwordx4 v4, s[16:19], s21 offen sc1 lds
  s_xor_b32 s74, s74, 16384
  s_add_u32 s73, s73, 2097152
  s_xor_b32 s73, s73, 8192
  s_add_u32 s79, s79, 2097152
  s_xor_b32 s79, s79, 8192
  s_add_u32 s21, s72, 524288
  s_xor_b32 s72, s72, s21
  s_lshr_b32 s72, s72, 8
  s_and_b32 s72, s72, 8192
  s_xor_b32 s72, s72, s21
  s_add_u32 s71, s73, 4096
  s_mov_b32 s91, 1024
  s_cmp_lt_u32 s73, 0
  s_cselect_b32 s71, s71, s79
  s_cselect_b32 s91, s91, 65536
  s_nop 15
  s_nop 3
  v_permlane32_swap_b32 v96, v100
  v_permlane32_swap_b32 v97, v101
  v_permlane32_swap_b32 v98, v102
  v_permlane32_swap_b32 v99, v103
  v_pk_add_f32 v[96:97], v[96:97], v[100:101]
  v_pk_add_f32 v[98:99], v[98:99], v[102:103]
  v_cvt_pk_bf16_f32 v182, v96, v97
  v_cvt_pk_bf16_f32 v183, v98, v99
  v_min_u32 v182, -2, v182
  ds_write_b64 v26, v[182:183]
  ds_read_b128 v[144:147], v18
  ds_read_b128 v[148:151], v18 offset:1024
  ds_read_b128 v[152:155], v19
  v_xor_b32 v18, 16384, v18
  v_xor_b32 v19, 16384, v19
  v_mov_b32 v88, 0
  v_mov_b32 v89, 0
  v_mov_b32 v90, 0
  v_mov_b32 v91, 0
  v_mov_b32 v92, 0
  v_mov_b32 v93, 0
  v_mov_b32 v94, 0
  v_mov_b32 v95, 0
  v_mov_b32 v96, 0
  v_mov_b32 v97, 0
  v_mov_b32 v98, 0
  v_mov_b32 v99, 0
  v_mov_b32 v100, 0
  v_mov_b32 v101, 0
  v_mov_b32 v102, 0
  v_mov_b32 v103, 0
  s_mov_b32 s81, 0
  s_waitcnt lgkmcnt(0)
  s_barrier
  s_mov_b64 exec, s[64:65]
  buffer_store_dword v28, v8, s[8:11], s57 offen sc1
  buffer_store_dword v28, v8, s[8:11], s57 offen offset:128 sc1
  s_mov_b64 exec, -1
  s_cmp_eq_u32 s78, 0
  s_cbranch_scc1 nt_171
  s_mov_b64 exec, s[62:63]
  buffer_store_dword v28, v17, s[8:11], s59 offen sc1
  s_mov_b64 exec, -1
  s_sleep 6
  s_nop 3
  buffer_load_dwordx4 v[68:71], v16, s[4:7], s60 offen sc1
  s_sleep 3
  s_nop 1
  buffer_load_dwordx4 v[72:75], v16, s[4:7], s60 offen sc1
  s_waitcnt vmcnt(1)
  v_mfma_f32_16x16x32_f16 v[120:123], v[44:47], v[68:71], 0
  v_bitop3_b32 v27, v68, s61, 1 bitop3:0x28
  v_cmp_ne_u32 vcc, 0, v27
  s_nop 1
  s_cbranch_vccnz p2_174
  s_nop 2
pg_173:
  v_add_f32_dpp v120, v120, v120 row_ror:8 row_mask:0xf bank_mask:0xf
  v_add_f32_dpp v121, v121, v121 row_ror:8 row_mask:0xf bank_mask:0xf
  s_mov_b64 exec, s[62:63]
  v_cvt_pk_bf16_f32 v120, v120, v121
  v_min_u32 v120, -2, v120
  buffer_store_dword v120, v17, s[8:11], s55 offen sc1
  s_mov_b64 exec, -1
nt_170:
  s_barrier
  s_mov_b32 s58, s55
  s_add_u32 s52, s52, 1
  s_and_b32 s21, s52, 3
  s_mul_i32 s56, s21, 122880
  s_add_u32 s21, s52, 1
  s_and_b32 s21, s21, 3
  s_mul_i32 s55, s21, 122880
  s_add_u32 s55, s55, s75
  s_add_u32 s21, s52, 2
  s_and_b32 s21, s21, 3
  s_mul_i32 s57, s21, 122880
  s_add_u32 s21, s52, 3
  s_and_b32 s21, s21, 3
  s_mul_i32 s59, s21, 122880
  s_add_u32 s59, s59, s75
  s_bfe_u32 s61, s52, 0x10002
  s_and_b32 s21, s52, 3
  s_lshl_b32 s60, s21, 18
  s_mov_b32 s54, 0
  s_sleep 3
  s_nop 2
  buffer_load_dwordx4 v[72:75], v190, s[8:11], s58 offen offset:0 sc1
  buffer_load_dwordx4 v[76:79], v190, s[8:11], s58 offen offset:1024 sc1
  buffer_load_dwordx4 v[80:83], v190, s[8:11], s58 offen offset:2048 sc1
  s_branch top_159
mr_160:
  s_mov_b64 exec, s[22:23]
  s_cbranch_execz ms_175
  buffer_load_dwordx4 v[72:75], v190, s[8:11], s58 offen offset:0 sc1
ms_175:
  s_mov_b64 exec, s[98:99]
  s_cbranch_execz ms_176
  buffer_load_dwordx4 v[76:79], v190, s[8:11], s58 offen offset:1024 sc1
ms_176:
  s_mov_b64 exec, s[100:101]
  s_cbranch_execz ms_177
  buffer_load_dwordx4 v[80:83], v190, s[8:11], s58 offen offset:2048 sc1
ms_177:
  s_add_u32 s54, s54, 1
  s_cmp_gt_u32 s54, 131072
  s_cbranch_scc1 end0
  s_waitcnt vmcnt(0)
  s_mov_b64 exec, s[22:23]
  ds_write_b128 v190, v[72:75] offset:0
  v_cmp_eq_u32 s[22:23], -1, v72
  s_mov_b64 exec, s[98:99]
  ds_write_b128 v190, v[76:79] offset:1024
  v_cmp_eq_u32 s[98:99], -1, v76
  s_mov_b64 exec, s[100:101]
  ds_write_b128 v190, v[80:83] offset:2048
  v_cmp_eq_u32 s[100:101], -1, v80
  s_mov_b64 exec, -1
  s_or_b64 vcc, s[22:23], s[98:99]
  s_or_b64 vcc, vcc, s[100:101]
  s_cbranch_scc1 mr_160
  s_branch mo_164
mn_161:
  v_max3_u32 v27, v48, v49, v50
  v_max3_u32 v27, v27, v51, v52
  v_max3_u32 v27, v27, v53, v54
  v_max3_u32 v27, v27, v55, v56
  v_max3_u32 v27, v27, v57, v58
  v_max3_u32 v27, v27, v59, v60
  v_max3_u32 v27, v27, v61, v62
  v_max3_u32 v27, v27, v63, v64
  v_max3_u32 v27, v27, v65, v66
  v_max3_u32 v27, v27, v67, v68
  v_max3_u32 v27, v27, v69, v70
  v_max3_u32 v27, v27, v71, v72
  v_max3_u32 v27, v27, v73, v74
  v_max3_u32 v27, v27, v75, v76
  v_max3_u32 v27, v27, v77, v78
  v_max3_u32 v27, v27, v79, v80
  v_max3_u32 v27, v27, v81, v82
  v_max3_u32 v27, v27, v83, v84
  v_max3_u32 v27, v27, v85, v86
  v_max3_u32 v27, v27, v87, v87
  v_cmp_eq_u32 vcc, -1, v27
  s_cmp_eq_u32 s52, 0
  s_cbranch_scc1 mk_162
  s_cbranch_vccz mk_162
  s_waitcnt lgkmcnt(0)
  s_barrier
  s_nop 7
  v_mov_b32 v88, 0
  v_mov_b32 v89, 0
  v_mov_b32 v90, 0
  v_mov_b32 v91, 0
  v_mov_b32 v92, 0
  v_mov_b32 v93, 0
  v_mov_b32 v94, 0
  v_mov_b32 v95, 0
  v_mov_b32 v96, 0
  v_mov_b32 v97, 0
  v_mov_b32 v98, 0
  v_mov_b32 v99, 0
  v_mov_b32 v100, 0
  v_mov_b32 v101, 0
  v_mov_b32 v102, 0
  v_mov_b32 v103, 0
  s_mov_b64 s[22:23], -1
  s_mov_b64 s[98:99], -1
  s_mov_b64 s[100:101], -1
  s_branch mr_160
sr_165:
  s_mov_b32 s54, 0
sr_178:
  s_mov_b64 exec, vcc
  buffer_load_dwordx4 v[124:127], v9, s[8:11], s56 offen sc1
  buffer_load_dwordx4 v[128:131], v9, s[8:11], s56 offen offset:1024 sc1
  buffer_load_dwordx4 v[132:135], v10, s[8:11], s56 offen sc1
  s_mov_b64 exec, -1
  s_add_u32 s54, s54, 1
  s_cmp_gt_u32 s54, 131072
  s_cbranch_scc1 end0
  s_and_b32 s21, s54, 31
  s_cbranch_scc0 sr_179
  s_waitcnt vmcnt(0)
  v_pk_add_f16 v172, v124, v126
  v_pk_add_f16 v173, v125, v127
  v_pk_add_f16 v174, v128, v130
  v_pk_add_f16 v175, v129, v131
  v_fma_mix_f32 v166, v172, 1.0, v174 op_sel:[0,0,0] op_sel_hi:[1,0,1]
  v_fma_mix_f32 v168, v173, 1.0, v175 op_sel:[0,0,0] op_sel_hi:[1,0,1]
  v_pk_add_f16 v176, v132, v133
  v_pk_add_f16 v177, v134, v135
  v_add_f32 v27, v166, v168
  v_fma_mix_f32 v170, v176, 1.0, v177 op_sel:[0,0,0] op_sel_hi:[1,0,1]
  v_fma_mix_f32 v167, v172, 1.0, v174 op_sel:[1,0,1] op_sel_hi:[1,0,1]
  v_cmp_u_f32 vcc, v27, v170
  v_fma_mix_f32 v169, v173, 1.0, v175 op_sel:[1,0,1] op_sel_hi:[1,0,1]
  v_fma_mix_f32 v171, v176, 1.0, v177 op_sel:[1,0,1] op_sel_hi:[1,0,1]
  s_cbranch_vccnz sr_178
  s_branch sj_166
sr_179:
  s_waitcnt vmcnt(0)
  v_pk_add_f16 v172, v124, v126
  v_pk_add_f16 v173, v125, v127
  v_pk_add_f16 v174, v128, v130
  v_pk_add_f16 v175, v129, v131
  v_fma_mix_f32 v166, v172, 1.0, v174 op_sel:[0,0,0] op_sel_hi:[1,0,1]
  v_fma_mix_f32 v168, v173, 1.0, v175 op_sel:[0,0,0] op_sel_hi:[1,0,1]
  v_pk_add_f16 v176, v132, v133
  v_pk_add_f16 v177, v134, v135
  v_add_f32 v27, v166, v168
  v_fma_mix_f32 v170, v176, 1.0, v177 op_sel:[0,0,0] op_sel_hi:[1,0,1]
  v_fma_mix_f32 v167, v172, 1.0, v174 op_sel:[1,0,1] op_sel_hi:[1,0,1]
  v_cmp_u_f32 vcc, v27, v170
  v_fma_mix_f32 v169, v173, 1.0, v175 op_sel:[1,0,1] op_sel_hi:[1,0,1]
  v_fma_mix_f32 v171, v176, 1.0, v177 op_sel:[1,0,1] op_sel_hi:[1,0,1]
  v_max3_u32 v27, v124, v126, v128
  v_max3_u32 v27, v27, v130, v132
  v_max3_u32 v27, v27, v133, v134
  v_max3_u32 v27, v27, v135, v135
  v_cmp_eq_u32 vcc, -1, v27
  s_nop 1
  s_cbranch_vccnz sr_178
  s_branch sj_166
fx_168:
  s_cmp_eq_u32 s81, 1
  s_cbranch_scc1 fk_169
  s_mov_b32 s81, 1
  v_max3_f32 v164, v166, v167, v168
  v_max3_f32 v165, v169, v170, v171
  v_max_f32 v164, v164, v165
  s_nop 1
  v_max_f32_dpp v164, v164, v164 row_ror:8 row_mask:0xf bank_mask:0xf
  v_mov_b32 v165, v164
  s_nop 1
  v_permlane32_swap_b32 v164, v165
  v_max_f32 v164, v164, v165
  v_mov_b32 v165, v164
  s_nop 1
  v_permlane16_swap_b32 v164, v165
  v_max_f32 v164, v164, v165
  v_sub_f32 v166, v166, v164
  v_sub_f32 v167, v167, v164
  v_sub_f32 v168, v168, v164
  v_sub_f32 v169, v169, v164
  v_sub_f32 v170, v170, v164
  v_sub_f32 v171, v171, v164
  s_branch ex_167
nt_171:
  s_branch nt_170
p2_174:
  s_mov_b32 s54, 0
  buffer_load_dwordx4 v[68:71], v16, s[4:7], s60 offen sc1
  s_waitcnt vmcnt(1)
  v_mfma_f32_16x16x32_f16 v[120:123], v[44:47], v[72:75], 0
  v_bitop3_b32 v27, v72, s61, 1 bitop3:0x28
  v_cmp_ne_u32 vcc, 0, v27
  s_nop 1
  s_cbranch_vccz pg_173
  buffer_load_dwordx4 v[72:75], v16, s[4:7], s60 offen sc1
pp_172:
  s_waitcnt vmcnt(1)
  v_mfma_f32_16x16x32_f16 v[120:123], v[44:47], v[68:71], 0
  v_bitop3_b32 v27, v68, s61, 1 bitop3:0x28
  v_cmp_ne_u32 vcc, 0, v27
  s_nop 1
  s_cbranch_vccz pg_173
  buffer_load_dwordx4 v[68:71], v16, s[4:7], s60 offen sc1
  s_waitcnt vmcnt(1)
  v_mfma_f32_16x16x32_f16 v[120:123], v[44:47], v[72:75], 0
  v_bitop3_b32 v27, v72, s61, 1 bitop3:0x28
  v_cmp_ne_u32 vcc, 0, v27
  s_nop 1
  s_cbranch_vccz pg_173
  buffer_load_dwordx4 v[72:75], v16, s[4:7], s60 offen sc1
  s_add_u32 s54, s54, 1
  s_cmp_gt_u32 s54, 131072
  s_cbranch_scc1 end0
  s_branch pp_172
last_163:
  v_smfmac_f32_16x16x64_bf16 v[96:99], v[48:51], a[0:7], v22
  v_smfmac_f32_16x16x64_bf16 v[100:103], v[48:51], a[80:87], v22
  v_smfmac_f32_16x16x64_bf16 v[96:99], v[52:55], a[8:15], v22
  v_smfmac_f32_16x16x64_bf16 v[100:103], v[52:55], a[88:95], v22
  v_smfmac_f32_16x16x64_bf16 v[96:99], v[56:59], a[16:23], v22
  v_smfmac_f32_16x16x64_bf16 v[100:103], v[56:59], a[96:103], v22
  v_smfmac_f32_16x16x64_bf16 v[96:99], v[60:63], a[24:31], v22
  v_smfmac_f32_16x16x64_bf16 v[96:99], v[64:67], a[32:39], v22
  v_smfmac_f32_16x16x64_bf16 v[96:99], v[68:71], a[40:47], v22
  v_smfmac_f32_16x16x64_bf16 v[96:99], v[72:75], a[48:55], v22
  v_smfmac_f32_16x16x64_bf16 v[96:99], v[76:79], a[56:63], v22
  v_smfmac_f32_16x16x64_bf16 v[96:99], v[80:83], a[64:71], v22
  v_smfmac_f32_16x16x64_bf16 v[96:99], v[84:87], a[72:79], v22
  v_smfmac_f32_16x16x64_bf16 v[100:103], v[60:63], a[104:111], v22
  v_smfmac_f32_16x16x64_bf16 v[100:103], v[64:67], a[112:119], v22
  v_smfmac_f32_16x16x64_bf16 v[100:103], v[68:71], a[120:127], v22
  v_smfmac_f32_16x16x64_bf16 v[100:103], v[72:75], a[128:135], v22
  v_smfmac_f32_16x16x64_bf16 v[100:103], v[76:79], a[136:143], v22
  v_smfmac_f32_16x16x64_bf16 v[100:103], v[80:83], a[144:151], v22
  v_smfmac_f32_16x16x64_bf16 v[100:103], v[84:87], a[152:159], v22
  s_nop 7
  v_permlane32_swap_b32 v96, v100
  v_permlane32_swap_b32 v97, v101
  v_permlane32_swap_b32 v98, v102
  v_permlane32_swap_b32 v99, v103
  v_pk_add_f32 v[96:97], v[96:97], v[100:101]
  v_pk_add_f32 v[98:99], v[98:99], v[102:103]
  v_cvt_pk_bf16_f32 v182, v96, v97
  v_cvt_pk_bf16_f32 v183, v98, v99
  v_min_u32 v182, -2, v182
  ds_write_b64 v26, v[182:183]
  s_waitcnt lgkmcnt(0)
  s_barrier
  s_branch chain_done
E_31:
  v_add_u32 v190, 9216, v4
  s_waitcnt vmcnt(0)
  ds_write_b128 v190, v[84:87] offset:0
  s_branch mo_185
  .p2align 3
top_180:
  s_waitcnt vmcnt(0)
  ds_write_b128 v190, v[84:87] offset:0
  v_cmp_eq_u32 s[22:23], -1, v84
  s_or_b64 vcc, s[22:23], s[22:23]
  s_cbranch_scc1 mr_181
mo_185:
  s_waitcnt lgkmcnt(0)
  s_barrier
  ds_read_b128 v[48:51], v4 offset:0
  ds_read_b128 v[52:55], v4 offset:1024
  v_smfmac_f32_16x16x64_bf16 v[92:95], v[84:87], v[248:255], v22
  ds_read_b128 v[56:59], v4 offset:2048
  ds_read_b128 v[60:63], v4 offset:3072
  v_smfmac_f32_16x16x64_bf16 v[88:91], v[84:87], a[232:239], v22
  s_waitcnt lgkmcnt(3)
  s_add_u32 m0, s74, 0
  s_add_u32 s21, s79, 0
  buffer_load_dwordx4 v4, s[16:19], s21 offen offset:1024 sc1 lds
  v_smfmac_f32_16x16x64_bf16 v[92:95], v[48:51], a[240:247], v22
  ds_read_b128 v[64:67], v4 offset:4096
  ds_read_b128 v[68:71], v4 offset:5120
  s_add_u32 s22, s52, 3
  s_min_u32 s22, s22, 64
  v_smfmac_f32_16x16x64_bf16 v[88:91], v[48:51], a[160:167], v22
  s_waitcnt lgkmcnt(4)
  s_add_u32 m0, s74, 2048
  s_add_u32 s21, s79, 65536
  buffer_load_dwordx4 v4, s[16:19], s21 offen offset:1024 sc1 lds
  v_cmp_gt_u32 vcc, s22, v42
  v_smfmac_f32_16x16x64_bf16 v[92:95], v[52:55], a[248:255], v22
  ds_read_b128 v[72:75], v4 offset:6144
  ds_read_b128 v[76:79], v4 offset:7168
  s_cbranch_vccnz kw_186
kv_187:
  v_smfmac_f32_16x16x64_bf16 v[88:91], v[52:55], a[168:175], v22
  s_waitcnt lgkmcnt(5)
  s_add_u32 m0, s74, 4096
  s_add_u32 s21, s79, 131072
  buffer_load_dwordx4 v4, s[16:19], s21 offen offset:1024 sc1 lds
  v_smfmac_f32_16x16x64_bf16 v[92:95], v[56:59], v[192:199], v22
  ds_read_b128 v[80:83], v4 offset:8192
  v_smfmac_f32_16x16x64_bf16 v[88:91], v[56:59], a[176:183], v22
  s_waitcnt lgkmcnt(5)
  s_add_u32 m0, s74, 10240
  s_nop 0
  buffer_load_dwordx4 v4, s[16:19], s73 offen offset:0 sc1 lds
  v_smfmac_f32_16x16x64_bf16 v[92:95], v[60:63], v[200:207], v22
  s_waitcnt lgkmcnt(4)
  v_smfmac_f32_16x16x64_bf16 v[92:95], v[64:67], v[208:215], v22
  s_waitcnt lgkmcnt(3)
  s_add_u32 m0, s74, 10240
  s_nop 0
  buffer_load_dwordx4 v4, s[16:19], s73 offen offset:1024 sc1 lds
  v_smfmac_f32_16x16x64_bf16 v[92:95], v[68:71], v[216:223], v22
  s_waitcnt lgkmcnt(2)
  v_smfmac_f32_16x16x64_bf16 v[92:95], v[72:75], v[224:231], v22
  s_waitcnt lgkmcnt(1)
  s_add_u32 m0, s74, 10240
  s_nop 0
  buffer_load_dwordx4 v4, s[16:19], s73 offen offset:2048 sc1 lds
  v_smfmac_f32_16x16x64_bf16 v[92:95], v[76:79], v[232:239], v22
  s_waitcnt lgkmcnt(0)
  v_smfmac_f32_16x16x64_bf16 v[92:95], v[80:83], v[240:247], v22
  s_add_u32 m0, s74, 8192
  s_add_u32 s21, s72, 0
  buffer_load_dwordx4 v32, s[16:19], s21 offen sc1 lds
  v_smfmac_f32_16x16x64_bf16 v[88:91], v[60:63], a[184:191], v22
  v_smfmac_f32_16x16x64_bf16 v[88:91], v[64:67], a[192:199], v22
  v_smfmac_f32_16x16x64_bf16 v[88:91], v[68:71], a[200:207], v22
  v_cvt_pk_bf16_f32 v122, v92, v93
  v_smfmac_f32_16x16x64_bf16 v[88:91], v[72:75], a[208:215], v22
  v_cvt_pk_bf16_f32 v123, v94, v95
  v_smfmac_f32_16x16x64_bf16 v[88:91], v[76:79], a[216:223], v22
  ds_write_b64 v12, v[122:123] offset:13056
  v_smfmac_f32_16x16x64_bf16 v[88:91], v[80:83], a[224:231], v22
  s_nop 7
  v_cvt_pk_bf16_f32 v120, v88, v89
  v_cvt_pk_bf16_f32 v121, v90, v91
  ds_write_b64 v12, v[120:121] offset:12544
  v_smfmac_f32_16x16x64_bf16 v[96:99], v[48:51], a[0:7], v22
  v_cmp_u_f32 vcc, v88, v89
  v_smfmac_f32_16x16x64_bf16 v[100:103], v[48:51], a[80:87], v22
  v_cmp_u_f32 s[22:23], v90, v91
  s_nop 0
  s_or_b64 vcc, vcc, s[22:23]
  s_cbranch_vccnz mn_182
mk_183:
  s_waitcnt lgkmcnt(0)
  s_barrier
  ds_read_b64_tr_b16 v[104:105], v7 offset:0
  ds_read_b64_tr_b16 v[106:107], v7 offset:768
  ds_read_b64_tr_b16 v[108:109], v7 offset:1536
  ds_read_b64 v[140:141], v11
  s_cmp_eq_u32 s52, 63
  s_cbranch_scc1 last_184
  v_smfmac_f32_16x16x64_bf16 v[96:99], v[52:55], a[8:15], v22
  v_smfmac_f32_16x16x64_bf16 v[100:103], v[52:55], a[88:95], v22
  v_smfmac_f32_16x16x64_bf16 v[96:99], v[56:59], a[16:23], v22
  v_smfmac_f32_16x16x64_bf16 v[100:103], v[56:59], a[96:103], v22
  v_smfmac_f32_16x16x64_bf16 v[96:99], v[60:63], a[24:31], v22
  v_smfmac_f32_16x16x64_bf16 v[96:99], v[64:67], a[32:39], v22
  v_smfmac_f32_16x16x64_bf16 v[96:99], v[68:71], a[40:47], v22
  v_smfmac_f32_16x16x64_bf16 v[96:99], v[72:75], a[48:55], v22
  v_smfmac_f32_16x16x64_bf16 v[96:99], v[76:79], a[56:63], v22
  v_smfmac_f32_16x16x64_bf16 v[96:99], v[80:83], a[64:71], v22
  v_smfmac_f32_16x16x64_bf16 v[96:99], v[84:87], a[72:79], v22
  v_smfmac_f32_16x16x64_bf16 v[100:103], v[60:63], a[104:111], v22
  v_smfmac_f32_16x16x64_bf16 v[100:103], v[64:67], a[112:119], v22
  v_smfmac_f32_16x16x64_bf16 v[100:103], v[68:71], a[120:127], v22
  v_smfmac_f32_16x16x64_bf16 v[100:103], v[72:75], a[128:135], v22
  v_cvt_pk_bf16_f32 v136, v96, v97
  v_smfmac_f32_16x16x64_bf16 v[100:103], v[76:79], a[136:143], v22
  v_cvt_pk_bf16_f32 v137, v98, v99
  v_smfmac_f32_16x16x64_bf16 v[100:103], v[80:83], a[144:151], v22
  v_smfmac_f32_16x16x64_bf16 v[100:103], v[84:87], a[152:159], v22
  s_sleep 2
  s_nop 7
  buffer_load_dwordx4 v[124:127], v9, s[8:11], s56 offen sc1
  buffer_load_dwordx4 v[128:131], v9, s[8:11], s56 offen offset:1024 sc1
  s_nop 5
  buffer_load_dwordx4 v[132:135], v10, s[8:11], s56 offen sc1
  s_waitcnt vmcnt(2)
  v_pk_add_f16 v172, v124, v126
  v_pk_add_f16 v173, v125, v127
  s_waitcnt vmcnt(1)
  v_pk_add_f16 v174, v128, v130
  v_pk_add_f16 v175, v129, v131
  v_fma_mix_f32 v166, v172, 1.0, v174 op_sel:[0,0,0] op_sel_hi:[1,0,1]
  v_fma_mix_f32 v168, v173, 1.0, v175 op_sel:[0,0,0] op_sel_hi:[1,0,1]
  s_waitcnt vmcnt(0)
  v_pk_add_f16 v176, v132, v133
  v_pk_add_f16 v177, v134, v135
  v_fma_mix_f32 v170, v176, 1.0, v177 op_sel:[0,0,0] op_sel_hi:[1,0,1]
  v_fma_mix_f32 v167, v172, 1.0, v174 op_sel:[1,0,1] op_sel_hi:[1,0,1]
  v_cmp_u_f32 vcc, v166, v170
  v_fma_mix_f32 v169, v173, 1.0, v175 op_sel:[1,0,1] op_sel_hi:[1,0,1]
  v_fma_mix_f32 v171, v176, 1.0, v177 op_sel:[1,0,1] op_sel_hi:[1,0,1]
  v_cvt_pk_bf16_f32 v138, v100, v101
  s_cbranch_vccnz sr_188
sj_189:
ex_190:
  v_exp_f32 v172, v166
  v_exp_f32 v173, v167
  v_exp_f32 v174, v168
  v_cvt_pk_bf16_f32 v156, v172, v173
  v_exp_f32 v175, v169
  v_exp_f32 v176, v170
  v_cvt_pk_bf16_f32 v157, v174, v175
  v_mov_b32_dpp v158, v156 row_ror:8 row_mask:0xf bank_mask:0xf
  v_exp_f32 v177, v171
  v_mov_b32_dpp v159, v157 row_ror:8 row_mask:0xf bank_mask:0xf
  v_cvt_pk_bf16_f32 v160, v176, v177
  v_cvt_pk_bf16_f32 v139, v102, v103
  v_mfma_f32_16x16x32_bf16 v[178:181], v[152:155], v[156:159], 0
  s_waitcnt lgkmcnt(0)
  v_mov_b32_dpp v161, v160 row_ror:8 row_mask:0xf bank_mask:0xf
  v_mfma_f32_16x16x32_bf16 v[182:185], v[144:147], v[156:159], 0
  s_nop 0
  v_mfma_f32_16x16x32_bf16 v[178:181], v[140:143], v[160:163], v[178:181]
  v_mfma_f32_16x16x32_bf16 v[182:185], v[136:139], v[160:163], v[182:185]
  v_mfma_f32_16x16x32_bf16 v[186:189], v[148:151], v[156:159], 0
  v_mfma_f32_16x16x32_bf16 v[186:189], v[138:141], v[160:163], v[186:189]
  s_mov_b64 exec, s[62:63]
  v_rcp_f32 v164, v180
  s_nop 0
  v_pk_mul_f32 v[178:179], v[178:179], v[164:165] op_sel_hi:[1,0]
  v_pk_mul_f32 v[182:183], v[182:183], v[164:165] op_sel_hi:[1,0]
  v_pk_mul_f32 v[184:185], v[184:185], v[164:165] op_sel_hi:[1,0]
  v_cvt_pk_f16_f32 v64, v178, v179
  v_cvt_pk_f16_f32 v60, v182, v183
  v_pk_mul_f32 v[186:187], v[186:187], v[164:165] op_sel_hi:[1,0]
  v_pk_mul_f32 v[188:189], v[188:189], v[164:165] op_sel_hi:[1,0]
  v_cvt_pk_f16_f32 v61, v184, v185
  v_cvt_pk_f16_f32 v62, v186, v187
  v_cvt_pk_f16_f32 v63, v188, v189
  ds_write_b128 v13, v[60:63]
  ds_write_b32 v14, v64
  v_add_f32 v165, v164, v180
  v_cmp_ngt_f32 vcc, s80, v165
  s_mov_b64 exec, -1
  s_nop 0
  s_cbranch_vccnz fx_191
fk_192:
  s_waitcnt lgkmcnt(0)
  s_barrier
  ds_read_b128 v[166:169], v4 offset:13824
  ds_read_b128 v[170:173], v4 offset:14464
  ds_read_b128 v[174:177], v4 offset:15104
  ds_read_b128 v[178:181], v4 offset:15744
  s_mov_b64 exec, s[66:67]
  s_waitcnt lgkmcnt(2)
  v_pk_add_f16 v166, v166, v170
  v_pk_add_f16 v167, v167, v171
  v_pk_add_f16 v168, v168, v172
  v_pk_add_f16 v169, v169, v173
  s_waitcnt lgkmcnt(1)
  v_pk_add_f16 v166, v166, v174
  v_pk_add_f16 v167, v167, v175
  v_pk_add_f16 v168, v168, v176
  v_pk_add_f16 v169, v169, v177
  s_waitcnt lgkmcnt(0)
  v_pk_add_f16 v166, v166, v178
  v_pk_add_f16 v167, v167, v179
  v_pk_add_f16 v168, v168, v180
  v_pk_add_f16 v169, v169, v181
  v_and_or_b32 v166, v166, -2, s61
  buffer_store_dwordx4 v[166:169], v15, s[4:7], s60 offen sc1
  s_mov_b64 exec, -1
  v_permlane32_swap_b32 v96, v100
  v_permlane32_swap_b32 v97, v101
  v_permlane32_swap_b32 v98, v102
  v_permlane32_swap_b32 v99, v103
  v_pk_add_f32 v[96:97], v[96:97], v[100:101]
  v_pk_add_f32 v[98:99], v[98:99], v[102:103]
  v_cvt_pk_bf16_f32 v182, v96, v97
  v_cvt_pk_bf16_f32 v183, v98, v99
  v_min_u32 v182, -2, v182
  ds_write_b64 v26, v[182:183]
  v_permlane32_swap_b32 v88, v92
  v_permlane32_swap_b32 v89, v93
  v_permlane32_swap_b32 v90, v94
  v_permlane32_swap_b32 v91, v95
  v_pk_add_f32 v[88:89], v[88:89], v[92:93]
  v_pk_add_f32 v[90:91], v[90:91], v[94:95]
  v_cvt_pk_bf16_f32 v184, v88, v89
  v_cvt_pk_bf16_f32 v185, v90, v91
  v_min_u32 v184, -2, v184
  ds_write_b64 v43, v[184:185]
  ds_read_b128 v[144:147], v18
  ds_read_b128 v[148:151], v18 offset:1024
  ds_read_b128 v[152:155], v19
  v_xor_b32 v18, 16384, v18
  v_xor_b32 v19, 16384, v19
  v_mov_b32 v88, 0
  v_mov_b32 v89, 0
  v_mov_b32 v90, 0
  v_mov_b32 v91, 0
  v_mov_b32 v92, 0
  v_mov_b32 v93, 0
  v_mov_b32 v94, 0
  v_mov_b32 v95, 0
  v_mov_b32 v96, 0
  v_mov_b32 v97, 0
  v_mov_b32 v98, 0
  v_mov_b32 v99, 0
  v_mov_b32 v100, 0
  v_mov_b32 v101, 0
  v_mov_b32 v102, 0
  v_mov_b32 v103, 0
  s_mov_b32 s81, 0
  s_waitcnt lgkmcnt(0)
  s_barrier
  s_xor_b32 s74, s74, 16384
  s_add_u32 s73, s73, 2097152
  s_xor_b32 s73, s73, 8192
  s_add_u32 s79, s79, 2097152
  s_xor_b32 s79, s79, 8192
  s_add_u32 s21, s72, 524288
  s_xor_b32 s72, s72, s21
  s_lshr_b32 s72, s72, 8
  s_and_b32 s72, s72, 8192
  s_xor_b32 s72, s72, s21
  s_add_u32 s71, s73, 4096
  s_mov_b32 s91, 1024
  s_cmp_lt_u32 s73, 0
  s_cselect_b32 s71, s71, s79
  s_cselect_b32 s91, s91, 65536
  s_add_u32 s21, s52, 7
  s_lshr_b32 s21, s21, 2
  v_mov_b32 v28, s21
  v_mov_b32 v166, s52
  s_and_b32 s21, s52, 3
  s_cmp_lt_u32 s52, 54
  s_cselect_b32 s21, s21, 0
  s_cmp_lg_u32 s21, 0
  s_cbranch_scc1 fs_194
  s_mov_b64 exec, 1
  buffer_store_dword v166, v23, s[12:15], s77 offen sc1
  s_mov_b64 exec, -1
fs_194:
  ds_read_b128 v[170:173], v4 offset:16384
  ds_read_b128 v[174:177], v4 offset:17408
  ds_read_b128 v[178:181], v4 offset:18432
  v_min_u32 v104, -2, v104
  v_min_u32 v108, -2, v108
  s_mov_b32 s90, s70
  s_add_u32 s70, s70, 2097152
  s_xor_b32 s70, s70, 8192
  buffer_store_dwordx4 v[104:107], v36, s[16:19], s90 offen offset:2560 sc1
  buffer_store_dwordx2 v[108:109], v37, s[16:19], s90 offen offset:3072 sc1
  s_waitcnt lgkmcnt(0)
  buffer_store_dwordx4 v[170:173], v4, s[16:19], s90 offen offset:0 sc1
  buffer_store_dwordx4 v[174:177], v4, s[16:19], s90 offen offset:1024 sc1
  buffer_store_dwordx4 v[178:181], v38, s[16:19], s90 offen offset:2048 sc1
  s_add_u32 s22, s52, 5
  s_min_u32 s22, s22, 64
  v_cmp_gt_u32 vcc, s22, v42
  s_cbranch_vccz fv_195
  buffer_load_dword v42, v41, s[12:15], s76 offen sc1
fv_195:
nt_193:
  s_barrier
  s_mov_b32 s58, s55
  s_add_u32 s52, s52, 1
  s_and_b32 s21, s52, 3
  s_mul_i32 s56, s21, 122880
  s_add_u32 s21, s52, 1
  s_and_b32 s21, s21, 3
  s_mul_i32 s55, s21, 122880
  s_add_u32 s55, s55, s75
  s_add_u32 s21, s52, 2
  s_and_b32 s21, s21, 3
  s_mul_i32 s57, s21, 122880
  s_add_u32 s21, s52, 3
  s_and_b32 s21, s21, 3
  s_mul_i32 s59, s21, 122880
  s_add_u32 s59, s59, s75
  s_bfe_u32 s61, s52, 0x10002
  s_and_b32 s21, s52, 3
  s_lshl_b32 s60, s21, 18
  s_mov_b32 s54, 0
  s_sleep 3
  s_nop 2
  buffer_load_dwordx4 v[84:87], v190, s[8:11], s58 offen offset:0 sc1
  s_branch top_180
mr_181:
  s_mov_b64 exec, s[22:23]
  s_cbranch_execz ms_196
  buffer_load_dwordx4 v[84:87], v190, s[8:11], s58 offen offset:0 sc1
ms_196:
  s_add_u32 s54, s54, 1
  s_cmp_gt_u32 s54, 131072
  s_cbranch_scc1 end0
  s_waitcnt vmcnt(0)
  s_mov_b64 exec, s[22:23]
  ds_write_b128 v190, v[84:87] offset:0
  v_cmp_eq_u32 s[22:23], -1, v84
  s_mov_b64 exec, -1
  s_or_b64 vcc, s[22:23], s[22:23]
  s_cbranch_scc1 mr_181
  s_branch mo_185
kw_186:
  s_mov_b32 s101, 0
wm_197:
  buffer_load_dword v42, v41, s[12:15], s76 offen sc1
  s_add_u32 s101, s101, 1
  s_cmp_gt_u32 s101, 131072
  s_cbranch_scc1 end0
  s_waitcnt vmcnt(0)
  v_cmp_gt_u32 vcc, s22, v42
  v_readfirstlane_b32 s100, v42
  s_nop 0
  s_cbranch_vccz wm_198
  s_sleep 1
  s_branch wm_197
wm_198:
  s_branch kv_187
mn_182:
  v_max3_u32 v27, v48, v49, v50
  v_max3_u32 v27, v27, v51, v52
  v_max3_u32 v27, v27, v53, v54
  v_max3_u32 v27, v27, v55, v56
  v_max3_u32 v27, v27, v57, v58
  v_max3_u32 v27, v27, v59, v60
  v_max3_u32 v27, v27, v61, v62
  v_max3_u32 v27, v27, v63, v64
  v_max3_u32 v27, v27, v65, v66
  v_max3_u32 v27, v27, v67, v68
  v_max3_u32 v27, v27, v69, v70
  v_max3_u32 v27, v27, v71, v72
  v_max3_u32 v27, v27, v73, v74
  v_max3_u32 v27, v27, v75, v76
  v_max3_u32 v27, v27, v77, v78
  v_max3_u32 v27, v27, v79, v80
  v_max3_u32 v27, v27, v81, v82
  v_max3_u32 v27, v27, v83, v84
  v_max3_u32 v27, v27, v85, v86
  v_max3_u32 v27, v27, v87, v87
  v_cmp_eq_u32 vcc, -1, v27
  s_cmp_eq_u32 s52, 0
  s_cbranch_scc1 mk_183
  s_cbranch_vccz mk_183
  s_waitcnt lgkmcnt(0)
  s_barrier
  s_nop 7
  v_mov_b32 v88, 0
  v_mov_b32 v89, 0
  v_mov_b32 v90, 0
  v_mov_b32 v91, 0
  v_mov_b32 v92, 0
  v_mov_b32 v93, 0
  v_mov_b32 v94, 0
  v_mov_b32 v95, 0
  v_mov_b32 v96, 0
  v_mov_b32 v97, 0
  v_mov_b32 v98, 0
  v_mov_b32 v99, 0
  v_mov_b32 v100, 0
  v_mov_b32 v101, 0
  v_mov_b32 v102, 0
  v_mov_b32 v103, 0
  s_mov_b64 s[22:23], -1
  s_branch mr_181
sr_188:
  s_mov_b32 s54, 0
sr_199:
  s_mov_b64 exec, vcc
  buffer_load_dwordx4 v[124:127], v9, s[8:11], s56 offen sc1
  buffer_load_dwordx4 v[128:131], v9, s[8:11], s56 offen offset:1024 sc1
  buffer_load_dwordx4 v[132:135], v10, s[8:11], s56 offen sc1
  s_mov_b64 exec, -1
  s_add_u32 s54, s54, 1
  s_cmp_gt_u32 s54, 131072
  s_cbranch_scc1 end0
  s_and_b32 s21, s54, 31
  s_cbranch_scc0 sr_200
  s_waitcnt vmcnt(0)
  v_pk_add_f16 v172, v124, v126
  v_pk_add_f16 v173, v125, v127
  v_pk_add_f16 v174, v128, v130
  v_pk_add_f16 v175, v129, v131
  v_fma_mix_f32 v166, v172, 1.0, v174 op_sel:[0,0,0] op_sel_hi:[1,0,1]
  v_fma_mix_f32 v168, v173, 1.0, v175 op_sel:[0,0,0] op_sel_hi:[1,0,1]
  v_pk_add_f16 v176, v132, v133
  v_pk_add_f16 v177, v134, v135
  v_add_f32 v27, v166, v168
  v_fma_mix_f32 v170, v176, 1.0, v177 op_sel:[0,0,0] op_sel_hi:[1,0,1]
  v_fma_mix_f32 v167, v172, 1.0, v174 op_sel:[1,0,1] op_sel_hi:[1,0,1]
  v_cmp_u_f32 vcc, v27, v170
  v_fma_mix_f32 v169, v173, 1.0, v175 op_sel:[1,0,1] op_sel_hi:[1,0,1]
  v_fma_mix_f32 v171, v176, 1.0, v177 op_sel:[1,0,1] op_sel_hi:[1,0,1]
  s_cbranch_vccnz sr_199
  s_branch sj_189
sr_200:
  s_waitcnt vmcnt(0)
  v_pk_add_f16 v172, v124, v126
  v_pk_add_f16 v173, v125, v127
  v_pk_add_f16 v174, v128, v130
  v_pk_add_f16 v175, v129, v131
  v_fma_mix_f32 v166, v172, 1.0, v174 op_sel:[0,0,0] op_sel_hi:[1,0,1]
  v_fma_mix_f32 v168, v173, 1.0, v175 op_sel:[0,0,0] op_sel_hi:[1,0,1]
  v_pk_add_f16 v176, v132, v133
  v_pk_add_f16 v177, v134, v135
  v_add_f32 v27, v166, v168
  v_fma_mix_f32 v170, v176, 1.0, v177 op_sel:[0,0,0] op_sel_hi:[1,0,1]
  v_fma_mix_f32 v167, v172, 1.0, v174 op_sel:[1,0,1] op_sel_hi:[1,0,1]
  v_cmp_u_f32 vcc, v27, v170
  v_fma_mix_f32 v169, v173, 1.0, v175 op_sel:[1,0,1] op_sel_hi:[1,0,1]
  v_fma_mix_f32 v171, v176, 1.0, v177 op_sel:[1,0,1] op_sel_hi:[1,0,1]
  v_max3_u32 v27, v124, v126, v128
  v_max3_u32 v27, v27, v130, v132
  v_max3_u32 v27, v27, v133, v134
  v_max3_u32 v27, v27, v135, v135
  v_cmp_eq_u32 vcc, -1, v27
  s_nop 1
  s_cbranch_vccnz sr_199
  s_branch sj_189
fx_191:
  s_cmp_eq_u32 s81, 1
  s_cbranch_scc1 fk_192
  s_mov_b32 s81, 1
  v_max3_f32 v164, v166, v167, v168
  v_max3_f32 v165, v169, v170, v171
  v_max_f32 v164, v164, v165
  s_nop 1
  v_max_f32_dpp v164, v164, v164 row_ror:8 row_mask:0xf bank_mask:0xf
  v_mov_b32 v165, v164
  s_nop 1
  v_permlane32_swap_b32 v164, v165
  v_max_f32 v164, v164, v165
  v_mov_b32 v165, v164
  s_nop 1
  v_permlane16_swap_b32 v164, v165
  v_max_f32 v164, v164, v165
  v_sub_f32 v166, v166, v164
  v_sub_f32 v167, v167, v164
  v_sub_f32 v168, v168, v164
  v_sub_f32 v169, v169, v164
  v_sub_f32 v170, v170, v164
  v_sub_f32 v171, v171, v164
  s_branch ex_190
last_184:
  s_waitcnt lgkmcnt(0)
  v_min_u32 v104, -2, v104
  v_min_u32 v108, -2, v108
  s_mov_b32 s90, s70
  buffer_store_dwordx4 v[104:107], v36, s[16:19], s90 offen offset:2560 sc1
  buffer_store_dwordx2 v[108:109], v37, s[16:19], s90 offen offset:3072 sc1
  v_smfmac_f32_16x16x64_bf16 v[96:99], v[52:55], a[8:15], v22
  v_smfmac_f32_16x16x64_bf16 v[100:103], v[52:55], a[88:95], v22
  v_smfmac_f32_16x16x64_bf16 v[96:99], v[56:59], a[16:23], v22
  v_smfmac_f32_16x16x64_bf16 v[100:103], v[56:59], a[96:103], v22
  v_smfmac_f32_16x16x64_bf16 v[96:99], v[60:63], a[24:31], v22
  v_smfmac_f32_16x16x64_bf16 v[96:99], v[64:67], a[32:39], v22
  v_smfmac_f32_16x16x64_bf16 v[96:99], v[68:71], a[40:47], v22
  v_smfmac_f32_16x16x64_bf16 v[96:99], v[72:75], a[48:55], v22
  v_smfmac_f32_16x16x64_bf16 v[96:99], v[76:79], a[56:63], v22
  v_smfmac_f32_16x16x64_bf16 v[96:99], v[80:83], a[64:71], v22
  v_smfmac_f32_16x16x64_bf16 v[96:99], v[84:87], a[72:79], v22
  v_smfmac_f32_16x16x64_bf16 v[100:103], v[60:63], a[104:111], v22
  v_smfmac_f32_16x16x64_bf16 v[100:103], v[64:67], a[112:119], v22
  v_smfmac_f32_16x16x64_bf16 v[100:103], v[68:71], a[120:127], v22
  v_smfmac_f32_16x16x64_bf16 v[100:103], v[72:75], a[128:135], v22
  v_smfmac_f32_16x16x64_bf16 v[100:103], v[76:79], a[136:143], v22
  v_smfmac_f32_16x16x64_bf16 v[100:103], v[80:83], a[144:151], v22
  v_smfmac_f32_16x16x64_bf16 v[100:103], v[84:87], a[152:159], v22
  s_nop 7
  v_permlane32_swap_b32 v96, v100
  v_permlane32_swap_b32 v97, v101
  v_permlane32_swap_b32 v98, v102
  v_permlane32_swap_b32 v99, v103
  v_pk_add_f32 v[96:97], v[96:97], v[100:101]
  v_pk_add_f32 v[98:99], v[98:99], v[102:103]
  v_cvt_pk_bf16_f32 v182, v96, v97
  v_cvt_pk_bf16_f32 v183, v98, v99
  v_min_u32 v182, -2, v182
  ds_write_b64 v26, v[182:183]
  v_permlane32_swap_b32 v88, v92
  v_permlane32_swap_b32 v89, v93
  v_permlane32_swap_b32 v90, v94
  v_permlane32_swap_b32 v91, v95
  v_pk_add_f32 v[88:89], v[88:89], v[92:93]
  v_pk_add_f32 v[90:91], v[90:91], v[94:95]
  v_cvt_pk_bf16_f32 v184, v88, v89
  v_cvt_pk_bf16_f32 v185, v90, v91
  v_min_u32 v184, -2, v184
  ds_write_b64 v43, v[184:185]
  s_waitcnt lgkmcnt(0)
  s_barrier
  ds_read_b128 v[170:173], v4 offset:16384
  ds_read_b128 v[174:177], v4 offset:17408
  ds_read_b128 v[178:181], v4 offset:18432
  v_min_u32 v104, -2, v104
  v_min_u32 v108, -2, v108
  s_mov_b32 s90, s70
  s_add_u32 s70, s70, 2097152
  s_xor_b32 s70, s70, 8192
  s_waitcnt lgkmcnt(0)
  buffer_store_dwordx4 v[170:173], v4, s[16:19], s90 offen offset:0 sc1
  buffer_store_dwordx4 v[174:177], v4, s[16:19], s90 offen offset:1024 sc1
  buffer_store_dwordx4 v[178:181], v38, s[16:19], s90 offen offset:2048 sc1
  s_waitcnt vmcnt(0)
  v_mov_b32 v166, 64
  s_mov_b64 exec, 1
  buffer_store_dword v166, v23, s[12:15], s77 offen sc1
  s_mov_b64 exec, -1
  s_branch chain_done
chain_done:
end0:
  s_endpgm
gemm_side:
  s_bfe_u32 s23, s22, 0x20005
  s_add_u32 s22, s22, 31
  s_and_b32 s22, s22, 31
  s_lshl_b32 s21, s23, 3
  s_add_u32 s2, s21, s22
  s_add_u32 s3, s2, 72
  s_add_u32 s24, s2, 48
  s_add_u32 s2, s2, s21
  s_cmp_lt_u32 s22, 24
  s_cselect_b32 s3, s24, s3
  s_cmp_lt_u32 s22, 16
  s_cselect_b32 s3, s2, s3
  s_mov_b32 s2, s3
  s_cmp_ge_u32 s3, 64
  s_cbranch_scc1 not_kv
  s_load_dwordx2 s[4:5], s[0:1], 0
  s_load_dwordx2 s[6:7], s[0:1], 24
  s_load_dwordx2 s[36:37], s[0:1], 32
  s_load_dwordx2 s[38:39], s[0:1], 104
  s_and_b32 s43, s3, 1
  s_bfe_u32 s42, s3, 0x50001
  s_lshr_b32 s40, s42, 2
  s_waitcnt lgkmcnt(0)
  s_cmp_eq_u32 s43, 1
  s_cselect_b32 s6, s36, s6
  s_cselect_b32 s7, s37, s7
  s_mov_b32 s8, s4
  s_mov_b32 s9, s5
  s_mov_b32 s10, 2621440
  s_mov_b32 s11, 0x00020000
  s_mov_b32 s12, s6
  s_mov_b32 s13, s7
  s_mov_b32 s14, 7864320
  s_mov_b32 s15, 0x00020000
  s_mov_b32 s16, s38
  s_mov_b32 s17, s39
  s_mov_b32 s18, 171966464
  s_mov_b32 s19, 0x00020000
  s_add_u32 s72, s38, 173080576
  s_addc_u32 s73, s39, 0
  s_mov_b32 s74, 49152
  s_mov_b32 s75, 0x00020000
  s_mul_i32 s44, s42, 384
  s_mov_b32 s30, 0
  s_mov_b32 s25, 80768
  v_lshrrev_b32 v4, 3, v1
  v_and_b32 v5, 7, v1
  v_xor_b32 v5, v5, v4
  s_mul_i32 s21, s20, 16
  v_add_u32 v4, s21, v4
  v_mul_u32_u24 v4, 1280, v4
  v_lshl_add_u32 v10, v5, 4, v4
  s_mul_i32 s31, s20, 2048
  v_add_u32 v11, 10240, v10
  v_mov_b32 v9, 2731
  v_add_u32 v8, 0, v1
  v_mul_u32_u24 v7, v8, v9
  v_lshrrev_b32 v7, 16, v7
  v_mul_u32_u24 v4, 24, v7
  v_sub_u32 v8, v8, v4
  s_mov_b32 s21, 12288
  v_mul_lo_u32 v7, v7, s21
  v_lshl_add_u32 v4, v8, 4, v7
  v_add_u32 v8, 64, v1
  v_mul_u32_u24 v7, v8, v9
  v_lshrrev_b32 v7, 16, v7
  v_mul_u32_u24 v5, 24, v7
  v_sub_u32 v8, v8, v5
  s_mov_b32 s21, 12288
  v_mul_lo_u32 v7, v7, s21
  v_lshl_add_u32 v5, v8, 4, v7
  v_add_u32 v8, 128, v1
  v_mul_u32_u24 v7, v8, v9
  v_lshrrev_b32 v7, 16, v7
  v_mul_u32_u24 v6, 24, v7
  v_sub_u32 v8, v8, v6
  s_mov_b32 s21, 12288
  v_mul_lo_u32 v7, v7, s21
  v_lshl_add_u32 v6, v8, 4, v7
  v_lshrrev_b32 v7, 2, v2
  v_lshl_add_u32 v7, v3, 3, v7
  v_mul_u32_u24 v7, 384, v7
  v_and_b32 v8, 3, v2
  v_lshlrev_b32 v8, 3, v8
  s_mul_i32 s21, s20, 96
  v_add3_u32 v7, v7, v8, s21
  v_add_u32 v8, 49152, v7
  s_mul_i32 s21, s20, 393216
  s_add_u32 s21, s21, 0
  s_add_u32 s21, s21, s44
  s_mul_i32 s22, s20, 12288
  s_add_u32 s22, s22, 0
  s_add_u32 m0, s22, 0
  s_nop 0
  buffer_load_dwordx4 v4, s[12:15], s21 offen lds
  s_add_u32 m0, s22, 1024
  s_nop 0
  buffer_load_dwordx4 v5, s[12:15], s21 offen lds
  s_add_u32 m0, s22, 2048
  s_nop 0
  buffer_load_dwordx4 v6, s[12:15], s21 offen lds
  s_mul_i32 s21, s20, 393216
  s_add_u32 s21, s21, 98304
  s_add_u32 s21, s21, s44
  s_mul_i32 s22, s20, 12288
  s_add_u32 s22, s22, 3072
  s_add_u32 m0, s22, 0
  s_nop 0
  buffer_load_dwordx4 v4, s[12:15], s21 offen lds
  s_add_u32 m0, s22, 1024
  s_nop 0
  buffer_load_dwordx4 v5, s[12:15], s21 offen lds
  s_add_u32 m0, s22, 2048
  s_nop 0
  buffer_load_dwordx4 v6, s[12:15], s21 offen lds
  s_mul_i32 s21, s20, 393216
  s_add_u32 s21, s21, 196608
  s_add_u32 s21, s21, s44
  s_mul_i32 s22, s20, 12288
  s_add_u32 s22, s22, 6144
  s_add_u32 m0, s22, 0
  s_nop 0
  buffer_load_dwordx4 v4, s[12:15], s21 offen lds
  s_add_u32 m0, s22, 1024
  s_nop 0
  buffer_load_dwordx4 v5, s[12:15], s21 offen lds
  s_add_u32 m0, s22, 2048
  s_nop 0
  buffer_load_dwordx4 v6, s[12:15], s21 offen lds
  s_mul_i32 s21, s20, 393216
  s_add_u32 s21, s21, 294912
  s_add_u32 s21, s21, s44
  s_mul_i32 s22, s20, 12288
  s_add_u32 s22, s22, 9216
  s_add_u32 m0, s22, 0
  s_nop 0
  buffer_load_dwordx4 v4, s[12:15], s21 offen lds
  s_add_u32 m0, s22, 1024
  s_nop 0
  buffer_load_dwordx4 v5, s[12:15], s21 offen lds
  s_add_u32 m0, s22, 2048
  s_nop 0
  buffer_load_dwordx4 v6, s[12:15], s21 offen lds
  s_add_u32 m0, s31, 98304
  s_nop 0
  buffer_load_dwordx4 v10, s[8:11], s30 offen lds
  s_add_u32 m0, s31, 99328
  s_nop 0
  buffer_load_dwordx4 v11, s[8:11], s30 offen lds
  s_add_u32 s30, s30, 128
  s_add_u32 m0, s31, 106496
  s_nop 0
  buffer_load_dwordx4 v10, s[8:11], s30 offen lds
  s_add_u32 m0, s31, 107520
  s_nop 0
  buffer_load_dwordx4 v11, s[8:11], s30 offen lds
  s_add_u32 s30, s30, 128
  s_add_u32 m0, s31, 114688
  s_nop 0
  buffer_load_dwordx4 v10, s[8:11], s30 offen lds
  s_add_u32 m0, s31, 115712
  s_nop 0
  buffer_load_dwordx4 v11, s[8:11], s30 offen lds
  s_add_u32 s30, s30, 128
  s_add_u32 m0, s31, 122880
  s_nop 0
  buffer_load_dwordx4 v10, s[8:11], s30 offen lds
  s_add_u32 m0, s31, 123904
  s_nop 0
  buffer_load_dwordx4 v11, s[8:11], s30 offen lds
  s_add_u32 s30, s30, 128
  s_add_u32 m0, s31, 131072
  s_nop 0
  buffer_load_dwordx4 v10, s[8:11], s30 offen lds
  s_add_u32 m0, s31, 132096
  s_nop 0
  buffer_load_dwordx4 v11, s[8:11], s30 offen lds
  s_add_u32 s30, s30, 128
  s_add_u32 m0, s31, 139264
  s_nop 0
  buffer_load_dwordx4 v10, s[8:11], s30 offen lds
  s_add_u32 m0, s31, 140288
  s_nop 0
  buffer_load_dwordx4 v11, s[8:11], s30 offen lds
  s_add_u32 s30, s30, 128
  s_add_u32 m0, s31, 147456
  s_nop 0
  buffer_load_dwordx4 v10, s[8:11], s30 offen lds
  s_add_u32 m0, s31, 148480
  s_nop 0
  buffer_load_dwordx4 v11, s[8:11], s30 offen lds
  s_add_u32 s30, s30, 128
  s_add_u32 m0, s31, 155648
  s_nop 0
  buffer_load_dwordx4 v10, s[8:11], s30 offen lds
  s_add_u32 m0, s31, 156672
  s_nop 0
  buffer_load_dwordx4 v11, s[8:11], s30 offen lds
  s_add_u32 s30, s30, 128
  s_mul_i32 s21, s20, 393216
  s_add_u32 s21, s21, 1572864
  s_add_u32 s21, s21, s44
  s_mul_i32 s22, s20, 12288
  s_add_u32 s22, s22, 49152
  s_add_u32 m0, s22, 0
  s_nop 0
  buffer_load_dwordx4 v4, s[12:15], s21 offen lds
  s_add_u32 m0, s22, 1024
  s_nop 0
  buffer_load_dwordx4 v5, s[12:15], s21 offen lds
  s_add_u32 m0, s22, 2048
  s_nop 0
  buffer_load_dwordx4 v6, s[12:15], s21 offen lds
  s_mul_i32 s21, s20, 393216
  s_add_u32 s21, s21, 1671168
  s_add_u32 s21, s21, s44
  s_mul_i32 s22, s20, 12288
  s_add_u32 s22, s22, 52224
  s_add_u32 m0, s22, 0
  s_nop 0
  buffer_load_dwordx4 v4, s[12:15], s21 offen lds
  s_add_u32 m0, s22, 1024
  s_nop 0
  buffer_load_dwordx4 v5, s[12:15], s21 offen lds
  s_add_u32 m0, s22, 2048
  s_nop 0
  buffer_load_dwordx4 v6, s[12:15], s21 offen lds
  s_mul_i32 s21, s20, 393216
  s_add_u32 s21, s21, 1769472
  s_add_u32 s21, s21, s44
  s_mul_i32 s22, s20, 12288
  s_add_u32 s22, s22, 55296
  s_add_u32 m0, s22, 0
  s_nop 0
  buffer_load_dwordx4 v4, s[12:15], s21 offen lds
  s_add_u32 m0, s22, 1024
  s_nop 0
  buffer_load_dwordx4 v5, s[12:15], s21 offen lds
  s_add_u32 m0, s22, 2048
  s_nop 0
  buffer_load_dwordx4 v6, s[12:15], s21 offen lds
  s_mul_i32 s21, s20, 393216
  s_add_u32 s21, s21, 1867776
  s_add_u32 s21, s21, s44
  s_mul_i32 s22, s20, 12288
  s_add_u32 s22, s22, 58368
  s_add_u32 m0, s22, 0
  s_nop 0
  buffer_load_dwordx4 v4, s[12:15], s21 offen lds
  s_add_u32 m0, s22, 1024
  s_nop 0
  buffer_load_dwordx4 v5, s[12:15], s21 offen lds
  s_add_u32 m0, s22, 2048
  s_nop 0
  buffer_load_dwordx4 v6, s[12:15], s21 offen lds
  s_waitcnt vmcnt(12)
  s_barrier
  ds_read_b64_tr_b16 a[0:1], v7 offset:0
  ds_read_b64_tr_b16 a[2:3], v7 offset:1536
  ds_read_b64_tr_b16 a[4:5], v7 offset:32
  ds_read_b64_tr_b16 a[6:7], v7 offset:1568
  ds_read_b64_tr_b16 a[8:9], v7 offset:64
  ds_read_b64_tr_b16 a[10:11], v7 offset:1600
  ds_read_b64_tr_b16 a[12:13], v7 offset:12288
  ds_read_b64_tr_b16 a[14:15], v7 offset:13824
  ds_read_b64_tr_b16 a[16:17], v7 offset:12320
  ds_read_b64_tr_b16 a[18:19], v7 offset:13856
  ds_read_b64_tr_b16 a[20:21], v7 offset:12352
  ds_read_b64_tr_b16 a[22:23], v7 offset:13888
  ds_read_b64_tr_b16 a[24:25], v7 offset:24576
  ds_read_b64_tr_b16 a[26:27], v7 offset:26112
  ds_read_b64_tr_b16 a[28:29], v7 offset:24608
  ds_read_b64_tr_b16 a[30:31], v7 offset:26144
  ds_read_b64_tr_b16 a[32:33], v7 offset:24640
  ds_read_b64_tr_b16 a[34:35], v7 offset:26176
  ds_read_b64_tr_b16 a[36:37], v7 offset:36864
  ds_read_b64_tr_b16 a[38:39], v7 offset:38400
  ds_read_b64_tr_b16 a[40:41], v7 offset:36896
  ds_read_b64_tr_b16 a[42:43], v7 offset:38432
  ds_read_b64_tr_b16 a[44:45], v7 offset:36928
  ds_read_b64_tr_b16 a[46:47], v7 offset:38464
  s_waitcnt lgkmcnt(0)
  s_barrier
  s_mul_i32 s21, s20, 393216
  s_add_u32 s21, s21, 3145728
  s_add_u32 s21, s21, s44
  s_mul_i32 s22, s20, 12288
  s_add_u32 s22, s22, 0
  s_add_u32 m0, s22, 0
  s_nop 0
  buffer_load_dwordx4 v4, s[12:15], s21 offen lds
  s_add_u32 m0, s22, 1024
  s_nop 0
  buffer_load_dwordx4 v5, s[12:15], s21 offen lds
  s_add_u32 m0, s22, 2048
  s_nop 0
  buffer_load_dwordx4 v6, s[12:15], s21 offen lds
  s_mul_i32 s21, s20, 393216
  s_add_u32 s21, s21, 3244032
  s_add_u32 s21, s21, s44
  s_mul_i32 s22, s20, 12288
  s_add_u32 s22, s22, 3072
  s_add_u32 m0, s22, 0
  s_nop 0
  buffer_load_dwordx4 v4, s[12:15], s21 offen lds
  s_add_u32 m0, s22, 1024
  s_nop 0
  buffer_load_dwordx4 v5, s[12:15], s21 offen lds
  s_add_u32 m0, s22, 2048
  s_nop 0
  buffer_load_dwordx4 v6, s[12:15], s21 offen lds
  s_mul_i32 s21, s20, 393216
  s_add_u32 s21, s21, 3342336
  s_add_u32 s21, s21, s44
  s_mul_i32 s22, s20, 12288
  s_add_u32 s22, s22, 6144
  s_add_u32 m0, s22, 0
  s_nop 0
  buffer_load_dwordx4 v4, s[12:15], s21 offen lds
  s_add_u32 m0, s22, 1024
  s_nop 0
  buffer_load_dwordx4 v5, s[12:15], s21 offen lds
  s_add_u32 m0, s22, 2048
  s_nop 0
  buffer_load_dwordx4 v6, s[12:15], s21 offen lds
  s_mul_i32 s21, s20, 393216
  s_add_u32 s21, s21, 3440640
  s_add_u32 s21, s21, s44
  s_mul_i32 s22, s20, 12288
  s_add_u32 s22, s22, 9216
  s_add_u32 m0, s22, 0
  s_nop 0
  buffer_load_dwordx4 v4, s[12:15], s21 offen lds
  s_add_u32 m0, s22, 1024
  s_nop 0
  buffer_load_dwordx4 v5, s[12:15], s21 offen lds
  s_add_u32 m0, s22, 2048
  s_nop 0
  buffer_load_dwordx4 v6, s[12:15], s21 offen lds
  s_waitcnt vmcnt(12)
  s_barrier
  ds_read_b64_tr_b16 a[48:49], v8 offset:0
  ds_read_b64_tr_b16 a[50:51], v8 offset:1536
  ds_read_b64_tr_b16 a[52:53], v8 offset:32
  ds_read_b64_tr_b16 a[54:55], v8 offset:1568
  ds_read_b64_tr_b16 a[56:57], v8 offset:64
  ds_read_b64_tr_b16 a[58:59], v8 offset:1600
  ds_read_b64_tr_b16 a[60:61], v8 offset:12288
  ds_read_b64_tr_b16 a[62:63], v8 offset:13824
  ds_read_b64_tr_b16 a[64:65], v8 offset:12320
  ds_read_b64_tr_b16 a[66:67], v8 offset:13856
  ds_read_b64_tr_b16 a[68:69], v8 offset:12352
  ds_read_b64_tr_b16 a[70:71], v8 offset:13888
  ds_read_b64_tr_b16 a[72:73], v8 offset:24576
  ds_read_b64_tr_b16 a[74:75], v8 offset:26112
  ds_read_b64_tr_b16 a[76:77], v8 offset:24608
  ds_read_b64_tr_b16 a[78:79], v8 offset:26144
  ds_read_b64_tr_b16 a[80:81], v8 offset:24640
  ds_read_b64_tr_b16 a[82:83], v8 offset:26176
  ds_read_b64_tr_b16 a[84:85], v8 offset:36864
  ds_read_b64_tr_b16 a[86:87], v8 offset:38400
  ds_read_b64_tr_b16 a[88:89], v8 offset:36896
  ds_read_b64_tr_b16 a[90:91], v8 offset:38432
  ds_read_b64_tr_b16 a[92:93], v8 offset:36928
  ds_read_b64_tr_b16 a[94:95], v8 offset:38464
  s_waitcnt lgkmcnt(0)
  s_barrier
  s_mul_i32 s21, s20, 393216
  s_add_u32 s21, s21, 4718592
  s_add_u32 s21, s21, s44
  s_mul_i32 s22, s20, 12288
  s_add_u32 s22, s22, 49152
  s_add_u32 m0, s22, 0
  s_nop 0
  buffer_load_dwordx4 v4, s[12:15], s21 offen lds
  s_add_u32 m0, s22, 1024
  s_nop 0
  buffer_load_dwordx4 v5, s[12:15], s21 offen lds
  s_add_u32 m0, s22, 2048
  s_nop 0
  buffer_load_dwordx4 v6, s[12:15], s21 offen lds
  s_mul_i32 s21, s20, 393216
  s_add_u32 s21, s21, 4816896
  s_add_u32 s21, s21, s44
  s_mul_i32 s22, s20, 12288
  s_add_u32 s22, s22, 52224
  s_add_u32 m0, s22, 0
  s_nop 0
  buffer_load_dwordx4 v4, s[12:15], s21 offen lds
  s_add_u32 m0, s22, 1024
  s_nop 0
  buffer_load_dwordx4 v5, s[12:15], s21 offen lds
  s_add_u32 m0, s22, 2048
  s_nop 0
  buffer_load_dwordx4 v6, s[12:15], s21 offen lds
  s_mul_i32 s21, s20, 393216
  s_add_u32 s21, s21, 4915200
  s_add_u32 s21, s21, s44
  s_mul_i32 s22, s20, 12288
  s_add_u32 s22, s22, 55296
  s_add_u32 m0, s22, 0
  s_nop 0
  buffer_load_dwordx4 v4, s[12:15], s21 offen lds
  s_add_u32 m0, s22, 1024
  s_nop 0
  buffer_load_dwordx4 v5, s[12:15], s21 offen lds
  s_add_u32 m0, s22, 2048
  s_nop 0
  buffer_load_dwordx4 v6, s[12:15], s21 offen lds
  s_mul_i32 s21, s20, 393216
  s_add_u32 s21, s21, 5013504
  s_add_u32 s21, s21, s44
  s_mul_i32 s22, s20, 12288
  s_add_u32 s22, s22, 58368
  s_add_u32 m0, s22, 0
  s_nop 0
  buffer_load_dwordx4 v4, s[12:15], s21 offen lds
  s_add_u32 m0, s22, 1024
  s_nop 0
  buffer_load_dwordx4 v5, s[12:15], s21 offen lds
  s_add_u32 m0, s22, 2048
  s_nop 0
  buffer_load_dwordx4 v6, s[12:15], s21 offen lds
  v_mov_b32 v29, 76
  buffer_load_dword v29, v29, s[32:35], 0 offen sc1
  s_waitcnt vmcnt(12)
  s_barrier
  ds_read_b64_tr_b16 a[96:97], v7 offset:0
  ds_read_b64_tr_b16 a[98:99], v7 offset:1536
  ds_read_b64_tr_b16 a[100:101], v7 offset:32
  ds_read_b64_tr_b16 a[102:103], v7 offset:1568
  ds_read_b64_tr_b16 a[104:105], v7 offset:64
  ds_read_b64_tr_b16 a[106:107], v7 offset:1600
  ds_read_b64_tr_b16 a[108:109], v7 offset:12288
  ds_read_b64_tr_b16 a[110:111], v7 offset:13824
  ds_read_b64_tr_b16 a[112:113], v7 offset:12320
  ds_read_b64_tr_b16 a[114:115], v7 offset:13856
  ds_read_b64_tr_b16 a[116:117], v7 offset:12352
  ds_read_b64_tr_b16 a[118:119], v7 offset:13888
  ds_read_b64_tr_b16 a[120:121], v7 offset:24576
  ds_read_b64_tr_b16 a[122:123], v7 offset:26112
  ds_read_b64_tr_b16 a[124:125], v7 offset:24608
  ds_read_b64_tr_b16 a[126:127], v7 offset:26144
  ds_read_b64_tr_b16 a[128:129], v7 offset:24640
  ds_read_b64_tr_b16 a[130:131], v7 offset:26176
  ds_read_b64_tr_b16 a[132:133], v7 offset:36864
  ds_read_b64_tr_b16 a[134:135], v7 offset:38400
  ds_read_b64_tr_b16 a[136:137], v7 offset:36896
  ds_read_b64_tr_b16 a[138:139], v7 offset:38432
  ds_read_b64_tr_b16 a[140:141], v7 offset:36928
  ds_read_b64_tr_b16 a[142:143], v7 offset:38464
  s_waitcnt lgkmcnt(0)
  s_barrier
  s_mul_i32 s21, s20, 393216
  s_add_u32 s21, s21, 6291456
  s_add_u32 s21, s21, s44
  s_mul_i32 s22, s20, 12288
  s_add_u32 s22, s22, 0
  s_add_u32 m0, s22, 0
  s_nop 0
  buffer_load_dwordx4 v4, s[12:15], s21 offen lds
  s_add_u32 m0, s22, 1024
  s_nop 0
  buffer_load_dwordx4 v5, s[12:15], s21 offen lds
  s_add_u32 m0, s22, 2048
  s_nop 0
  buffer_load_dwordx4 v6, s[12:15], s21 offen lds
  s_mul_i32 s21, s20, 393216
  s_add_u32 s21, s21, 6389760
  s_add_u32 s21, s21, s44
  s_mul_i32 s22, s20, 12288
  s_add_u32 s22, s22, 3072
  s_add_u32 m0, s22, 0
  s_nop 0
  buffer_load_dwordx4 v4, s[12:15], s21 offen lds
  s_add_u32 m0, s22, 1024
  s_nop 0
  buffer_load_dwordx4 v5, s[12:15], s21 offen lds
  s_add_u32 m0, s22, 2048
  s_nop 0
  buffer_load_dwordx4 v6, s[12:15], s21 offen lds
  s_mul_i32 s21, s20, 393216
  s_add_u32 s21, s21, 6488064
  s_add_u32 s21, s21, s44
  s_mul_i32 s22, s20, 12288
  s_add_u32 s22, s22, 6144
  s_add_u32 m0, s22, 0
  s_nop 0
  buffer_load_dwordx4 v4, s[12:15], s21 offen lds
  s_add_u32 m0, s22, 1024
  s_nop 0
  buffer_load_dwordx4 v5, s[12:15], s21 offen lds
  s_add_u32 m0, s22, 2048
  s_nop 0
  buffer_load_dwordx4 v6, s[12:15], s21 offen lds
  s_mul_i32 s21, s20, 393216
  s_add_u32 s21, s21, 6586368
  s_add_u32 s21, s21, s44
  s_mul_i32 s22, s20, 12288
  s_add_u32 s22, s22, 9216
  s_add_u32 m0, s22, 0
  s_nop 0
  buffer_load_dwordx4 v4, s[12:15], s21 offen lds
  s_add_u32 m0, s22, 1024
  s_nop 0
  buffer_load_dwordx4 v5, s[12:15], s21 offen lds
  s_add_u32 m0, s22, 2048
  s_nop 0
  buffer_load_dwordx4 v6, s[12:15], s21 offen lds
  s_waitcnt vmcnt(12)
  s_barrier
  ds_read_b64_tr_b16 a[144:145], v8 offset:0
  ds_read_b64_tr_b16 a[146:147], v8 offset:1536
  ds_read_b64_tr_b16 a[148:149], v8 offset:32
  ds_read_b64_tr_b16 a[150:151], v8 offset:1568
  ds_read_b64_tr_b16 a[152:153], v8 offset:64
  ds_read_b64_tr_b16 a[154:155], v8 offset:1600
  ds_read_b64_tr_b16 a[156:157], v8 offset:12288
  ds_read_b64_tr_b16 a[158:159], v8 offset:13824
  ds_read_b64_tr_b16 a[160:161], v8 offset:12320
  ds_read_b64_tr_b16 a[162:163], v8 offset:13856
  ds_read_b64_tr_b16 a[164:165], v8 offset:12352
  ds_read_b64_tr_b16 a[166:167], v8 offset:13888
  ds_read_b64_tr_b16 a[168:169], v8 offset:24576
  ds_read_b64_tr_b16 a[170:171], v8 offset:26112
  ds_read_b64_tr_b16 a[172:173], v8 offset:24608
  ds_read_b64_tr_b16 a[174:175], v8 offset:26144
  ds_read_b64_tr_b16 a[176:177], v8 offset:24640
  ds_read_b64_tr_b16 a[178:179], v8 offset:26176
  ds_read_b64_tr_b16 a[180:181], v8 offset:36864
  ds_read_b64_tr_b16 a[182:183], v8 offset:38400
  ds_read_b64_tr_b16 a[184:185], v8 offset:36896
  ds_read_b64_tr_b16 a[186:187], v8 offset:38432
  ds_read_b64_tr_b16 a[188:189], v8 offset:36928
  ds_read_b64_tr_b16 a[190:191], v8 offset:38464
  s_waitcnt lgkmcnt(0)
  s_barrier
  s_waitcnt vmcnt(0)
  s_barrier
  ds_read_b64_tr_b16 a[192:193], v7 offset:0
  ds_read_b64_tr_b16 a[194:195], v7 offset:1536
  ds_read_b64_tr_b16 a[196:197], v7 offset:32
  ds_read_b64_tr_b16 a[198:199], v7 offset:1568
  ds_read_b64_tr_b16 a[200:201], v7 offset:64
  ds_read_b64_tr_b16 a[202:203], v7 offset:1600
  ds_read_b64_tr_b16 a[204:205], v7 offset:12288
  ds_read_b64_tr_b16 a[206:207], v7 offset:13824
  ds_read_b64_tr_b16 a[208:209], v7 offset:12320
  ds_read_b64_tr_b16 a[210:211], v7 offset:13856
  ds_read_b64_tr_b16 a[212:213], v7 offset:12352
  ds_read_b64_tr_b16 a[214:215], v7 offset:13888
  ds_read_b64_tr_b16 a[216:217], v7 offset:24576
  ds_read_b64_tr_b16 a[218:219], v7 offset:26112
  ds_read_b64_tr_b16 a[220:221], v7 offset:24608
  ds_read_b64_tr_b16 a[222:223], v7 offset:26144
  ds_read_b64_tr_b16 a[224:225], v7 offset:24640
  ds_read_b64_tr_b16 a[226:227], v7 offset:26176
  ds_read_b64_tr_b16 a[228:229], v7 offset:36864
  ds_read_b64_tr_b16 a[230:231], v7 offset:38400
  ds_read_b64_tr_b16 a[232:233], v7 offset:36896
  ds_read_b64_tr_b16 a[234:235], v7 offset:38432
  ds_read_b64_tr_b16 a[236:237], v7 offset:36928
  ds_read_b64_tr_b16 a[238:239], v7 offset:38464
  s_waitcnt lgkmcnt(0)
  s_barrier
  v_and_b32 v6, 7, v2
  v_add_u32 v4, 0, v3
  v_xor_b32 v4, v4, v6
  v_lshlrev_b32 v4, 4, v4
  v_lshl_add_u32 v14, v2, 7, v4
  v_add_u32 v16, 65536, v14
  v_add_u32 v18, 131072, v14
  v_add_u32 v4, 4, v3
  v_xor_b32 v4, v4, v6
  v_lshlrev_b32 v4, 4, v4
  v_lshl_add_u32 v15, v2, 7, v4
  v_add_u32 v17, 65536, v15
  v_add_u32 v19, 131072, v15
  v_lshlrev_b32 v26, 4, v1
  v_mov_b32 v28, 1
  v_mov_b32 v4, 0x40000000
  v_cmp_eq_u32 vcc, 0, v0
  s_nop 1
  v_cndmask_b32 v27, v4, 0, vcc
  s_mov_b32 s26, 6
  s_lshl_b32 s27, s42, 2
  s_add_u32 s27, s27, s20
  s_lshl_b32 s27, s27, 14
  s_lshl_b32 s21, s43, 13
  s_xor_b32 s27, s27, s21
  v_readfirstlane_b32 s100, v29
  s_cmp_lg_u32 s100, 0
  s_cbranch_scc1 kvz_201
  s_mov_b32 s21, 76
  v_mov_b32 v4, 0
  s_mov_b32 s101, 0
wf_202:
  buffer_load_dword v5, v4, s[32:35], s21 offen sc1
  s_add_u32 s101, s101, 1
  s_cmp_gt_u32 s101, 131072
  s_cbranch_scc1 main_end
  s_waitcnt vmcnt(0)
  v_readfirstlane_b32 s100, v5
  s_cmp_ge_u32 s100, 1
  s_cbranch_scc1 wf_203
  s_sleep 8
  s_branch wf_202
wf_203:
kvz_201:
  s_sub_u32 s80, s100, 1
  s_lshl_b32 s80, s80, 13
  s_xor_b32 s27, s27, s80
  s_lshl_b32 s60, s40, 7
  s_add_u32 s60, s60, 28672
  s_xor_b32 s60, s60, s80
  s_mov_b32 s48, 0x40000000
  s_mov_b32 s61, 0x40000000
  s_waitcnt vmcnt(14)
  s_barrier
  ds_read_b128 v[160:163], v16 offset:32768
  ds_read_b128 v[164:167], v16 offset:34816
  ds_read_b128 v[168:171], v16 offset:36864
  ds_read_b128 v[172:175], v16 offset:38912
  s_waitcnt lgkmcnt(3)
  .p2align 3
kvm_204:
  v_mfma_f32_16x16x32_bf16 v[64:67], a[0:3], v[160:163], 0
  s_xor_b32 s29, s48, 0
  ds_read_b128 v[176:179], v17 offset:32768
  v_cvt_pk_bf16_f32 v204, v88, v89
  v_mfma_f32_16x16x32_bf16 v[68:71], a[4:7], v[160:163], 0
  v_cvt_pk_bf16_f32 v205, v90, v91
  v_cvt_pk_bf16_f32 v206, v92, v93
  v_mfma_f32_16x16x32_bf16 v[72:75], a[8:11], v[160:163], 0
  s_waitcnt lgkmcnt(3)
  v_cvt_pk_bf16_f32 v207, v94, v95
  v_cvt_pk_bf16_f32 v212, v96, v97
  v_mfma_f32_16x16x32_bf16 v[76:79], a[0:3], v[164:167], 0
  ds_read_b128 v[180:183], v17 offset:34816
  v_cvt_pk_bf16_f32 v213, v98, v99
  v_mfma_f32_16x16x32_bf16 v[80:83], a[4:7], v[164:167], 0
  v_cvt_pk_bf16_f32 v208, v100, v101
  v_cvt_pk_bf16_f32 v209, v102, v103
  v_mfma_f32_16x16x32_bf16 v[84:87], a[8:11], v[164:167], 0
  s_waitcnt lgkmcnt(3)
  v_cvt_pk_bf16_f32 v210, v104, v105
  v_cvt_pk_bf16_f32 v211, v106, v107
  v_mfma_f32_16x16x32_bf16 v[88:91], a[0:3], v[168:171], 0
  ds_read_b128 v[184:187], v17 offset:36864
  v_cvt_pk_bf16_f32 v214, v108, v109
  v_mfma_f32_16x16x32_bf16 v[92:95], a[4:7], v[168:171], 0
  s_add_u32 m0, s31, 81920
  v_cvt_pk_bf16_f32 v215, v110, v111
  buffer_store_dwordx4 v[192:195], v26, s[16:19], s29 offen offset:0 sc1
  v_mfma_f32_16x16x32_bf16 v[96:99], a[8:11], v[168:171], 0
  s_waitcnt lgkmcnt(3)
  buffer_load_dwordx4 v10, s[8:11], s30 offen lds
  v_mfma_f32_16x16x32_bf16 v[100:103], a[0:3], v[172:175], 0
  ds_read_b128 v[188:191], v17 offset:38912
  v_mfma_f32_16x16x32_bf16 v[104:107], a[4:7], v[172:175], 0
  v_mfma_f32_16x16x32_bf16 v[108:111], a[8:11], v[172:175], 0
  s_waitcnt lgkmcnt(3)
  buffer_store_dwordx4 v[196:199], v26, s[16:19], s29 offen offset:1024 sc1
  v_mfma_f32_16x16x32_bf16 v[64:67], a[12:15], v[176:179], v[64:67]
  s_waitcnt vmcnt(15)
  s_barrier
  ds_read_b128 v[160:163], v16 offset:40960
  v_mfma_f32_16x16x32_bf16 v[68:71], a[16:19], v[176:179], v[68:71]
  s_add_u32 m0, s31, 82944
  v_mfma_f32_16x16x32_bf16 v[72:75], a[20:23], v[176:179], v[72:75]
  s_waitcnt lgkmcnt(3)
  buffer_load_dwordx4 v11, s[8:11], s30 offen lds
  v_mfma_f32_16x16x32_bf16 v[76:79], a[12:15], v[180:183], v[76:79]
  s_add_u32 s30, s30, 128
  ds_read_b128 v[164:167], v16 offset:43008
  buffer_store_dwordx4 v[200:203], v26, s[16:19], s29 offen offset:2048 sc1
  v_mfma_f32_16x16x32_bf16 v[80:83], a[16:19], v[180:183], v[80:83]
  v_mfma_f32_16x16x32_bf16 v[84:87], a[20:23], v[180:183], v[84:87]
  s_waitcnt lgkmcnt(3)
  v_mfma_f32_16x16x32_bf16 v[88:91], a[12:15], v[184:187], v[88:91]
  s_xor_b32 s29, s48, 2105344
  ds_read_b128 v[168:171], v16 offset:45056
  v_mfma_f32_16x16x32_bf16 v[92:95], a[16:19], v[184:187], v[92:95]
  buffer_store_dwordx4 v[204:207], v26, s[16:19], s29 offen offset:0 sc1
  v_mfma_f32_16x16x32_bf16 v[96:99], a[20:23], v[184:187], v[96:99]
  s_waitcnt lgkmcnt(3)
  v_mfma_f32_16x16x32_bf16 v[100:103], a[12:15], v[188:191], v[100:103]
  ds_read_b128 v[172:175], v16 offset:47104
  v_mfma_f32_16x16x32_bf16 v[104:107], a[16:19], v[188:191], v[104:107]
  v_mfma_f32_16x16x32_bf16 v[108:111], a[20:23], v[188:191], v[108:111]
  s_waitcnt lgkmcnt(3)
  buffer_store_dwordx4 v[208:211], v26, s[16:19], s29 offen offset:1024 sc1
  v_mfma_f32_16x16x32_bf16 v[64:67], a[24:27], v[160:163], v[64:67]
  ds_read_b128 v[176:179], v17 offset:40960
  v_mfma_f32_16x16x32_bf16 v[68:71], a[28:31], v[160:163], v[68:71]
  s_add_u32 m0, s31, 90112
  v_mfma_f32_16x16x32_bf16 v[72:75], a[32:35], v[160:163], v[72:75]
  s_waitcnt lgkmcnt(3)
  buffer_load_dwordx4 v10, s[8:11], s30 offen lds
  v_mfma_f32_16x16x32_bf16 v[76:79], a[24:27], v[164:167], v[76:79]
  ds_read_b128 v[180:183], v17 offset:43008
  buffer_store_dwordx4 v[212:215], v26, s[16:19], s29 offen offset:2048 sc1
  v_mfma_f32_16x16x32_bf16 v[80:83], a[28:31], v[164:167], v[80:83]
  v_mfma_f32_16x16x32_bf16 v[84:87], a[32:35], v[164:167], v[84:87]
  s_waitcnt lgkmcnt(3)
  v_mfma_f32_16x16x32_bf16 v[88:91], a[24:27], v[168:171], v[88:91]
  ds_read_b128 v[184:187], v17 offset:45056
  v_mfma_f32_16x16x32_bf16 v[92:95], a[28:31], v[168:171], v[92:95]
  s_add_u32 m0, s31, 91136
  v_mfma_f32_16x16x32_bf16 v[96:99], a[32:35], v[168:171], v[96:99]
  s_waitcnt lgkmcnt(3)
  buffer_load_dwordx4 v11, s[8:11], s30 offen lds
  v_mfma_f32_16x16x32_bf16 v[100:103], a[24:27], v[172:175], v[100:103]
  s_add_u32 s30, s30, s25
  ds_read_b128 v[188:191], v17 offset:47104
  v_mfma_f32_16x16x32_bf16 v[104:107], a[28:31], v[172:175], v[104:107]
  v_mfma_f32_16x16x32_bf16 v[108:111], a[32:35], v[172:175], v[108:111]
  s_waitcnt lgkmcnt(3)
  v_mfma_f32_16x16x32_bf16 v[64:67], a[36:39], v[176:179], v[64:67]
  s_waitcnt vmcnt(20)
  s_barrier
  ds_read_b128 v[160:163], v16 offset:49152
  v_mfma_f32_16x16x32_bf16 v[68:71], a[40:43], v[176:179], v[68:71]
  v_mfma_f32_16x16x32_bf16 v[72:75], a[44:47], v[176:179], v[72:75]
  s_waitcnt lgkmcnt(3)
  v_mfma_f32_16x16x32_bf16 v[76:79], a[36:39], v[180:183], v[76:79]
  ds_read_b128 v[164:167], v16 offset:51200
  v_mfma_f32_16x16x32_bf16 v[80:83], a[40:43], v[180:183], v[80:83]
  v_mfma_f32_16x16x32_bf16 v[84:87], a[44:47], v[180:183], v[84:87]
  s_waitcnt lgkmcnt(3)
  v_mfma_f32_16x16x32_bf16 v[88:91], a[36:39], v[184:187], v[88:91]
  ds_read_b128 v[168:171], v16 offset:53248
  v_mfma_f32_16x16x32_bf16 v[92:95], a[40:43], v[184:187], v[92:95]
  v_mfma_f32_16x16x32_bf16 v[96:99], a[44:47], v[184:187], v[96:99]
  s_waitcnt lgkmcnt(3)
  v_mfma_f32_16x16x32_bf16 v[100:103], a[36:39], v[188:191], v[100:103]
  ds_read_b128 v[172:175], v16 offset:55296
  v_mfma_f32_16x16x32_bf16 v[104:107], a[40:43], v[188:191], v[104:107]
  v_mfma_f32_16x16x32_bf16 v[108:111], a[44:47], v[188:191], v[108:111]
  s_waitcnt lgkmcnt(3)
  v_mfma_f32_16x16x32_bf16 v[64:67], a[48:51], v[160:163], v[64:67]
  ds_read_b128 v[176:179], v17 offset:49152
  v_mfma_f32_16x16x32_bf16 v[68:71], a[52:55], v[160:163], v[68:71]
  s_add_u32 m0, s31, 98304
  v_mfma_f32_16x16x32_bf16 v[72:75], a[56:59], v[160:163], v[72:75]
  s_waitcnt lgkmcnt(3)
  buffer_load_dwordx4 v10, s[8:11], s30 offen lds
  v_mfma_f32_16x16x32_bf16 v[76:79], a[48:51], v[164:167], v[76:79]
  ds_read_b128 v[180:183], v17 offset:51200
  v_mfma_f32_16x16x32_bf16 v[80:83], a[52:55], v[164:167], v[80:83]
  v_mfma_f32_16x16x32_bf16 v[84:87], a[56:59], v[164:167], v[84:87]
  s_waitcnt lgkmcnt(3)
  v_mfma_f32_16x16x32_bf16 v[88:91], a[48:51], v[168:171], v[88:91]
  ds_read_b128 v[184:187], v17 offset:53248
  v_mfma_f32_16x16x32_bf16 v[92:95], a[52:55], v[168:171], v[92:95]
  s_add_u32 m0, s31, 99328
  v_mfma_f32_16x16x32_bf16 v[96:99], a[56:59], v[168:171], v[96:99]
  s_waitcnt lgkmcnt(3)
  buffer_load_dwordx4 v11, s[8:11], s30 offen lds
  v_mfma_f32_16x16x32_bf16 v[100:103], a[48:51], v[172:175], v[100:103]
  s_add_u32 s30, s30, 128
  ds_read_b128 v[188:191], v17 offset:55296
  v_mfma_f32_16x16x32_bf16 v[104:107], a[52:55], v[172:175], v[104:107]
  v_mfma_f32_16x16x32_bf16 v[108:111], a[56:59], v[172:175], v[108:111]
  s_waitcnt lgkmcnt(3)
  v_mfma_f32_16x16x32_bf16 v[64:67], a[60:63], v[176:179], v[64:67]
  s_waitcnt vmcnt(20)
  s_barrier
  ds_read_b128 v[160:163], v16 offset:57344
  v_mfma_f32_16x16x32_bf16 v[68:71], a[64:67], v[176:179], v[68:71]
  v_mfma_f32_16x16x32_bf16 v[72:75], a[68:71], v[176:179], v[72:75]
  s_waitcnt lgkmcnt(3)
  v_mfma_f32_16x16x32_bf16 v[76:79], a[60:63], v[180:183], v[76:79]
  ds_read_b128 v[164:167], v16 offset:59392
  v_mfma_f32_16x16x32_bf16 v[80:83], a[64:67], v[180:183], v[80:83]
  v_mfma_f32_16x16x32_bf16 v[84:87], a[68:71], v[180:183], v[84:87]
  s_waitcnt lgkmcnt(3)
  v_mfma_f32_16x16x32_bf16 v[88:91], a[60:63], v[184:187], v[88:91]
  ds_read_b128 v[168:171], v16 offset:61440
  v_mfma_f32_16x16x32_bf16 v[92:95], a[64:67], v[184:187], v[92:95]
  v_mfma_f32_16x16x32_bf16 v[96:99], a[68:71], v[184:187], v[96:99]
  s_waitcnt lgkmcnt(3)
  v_mfma_f32_16x16x32_bf16 v[100:103], a[60:63], v[188:191], v[100:103]
  ds_read_b128 v[172:175], v16 offset:63488
  v_mfma_f32_16x16x32_bf16 v[104:107], a[64:67], v[188:191], v[104:107]
  v_mfma_f32_16x16x32_bf16 v[108:111], a[68:71], v[188:191], v[108:111]
  s_waitcnt lgkmcnt(3)
  v_mfma_f32_16x16x32_bf16 v[64:67], a[72:75], v[160:163], v[64:67]
  ds_read_b128 v[176:179], v17 offset:57344
  v_mfma_f32_16x16x32_bf16 v[68:71], a[76:79], v[160:163], v[68:71]
  s_add_u32 m0, s31, 106496
  v_mfma_f32_16x16x32_bf16 v[72:75], a[80:83], v[160:163], v[72:75]
  s_waitcnt lgkmcnt(3)
  buffer_load_dwordx4 v10, s[8:11], s30 offen lds
  v_mfma_f32_16x16x32_bf16 v[76:79], a[72:75], v[164:167], v[76:79]
  ds_read_b128 v[180:183], v17 offset:59392
  v_mfma_f32_16x16x32_bf16 v[80:83], a[76:79], v[164:167], v[80:83]
  v_mfma_f32_16x16x32_bf16 v[84:87], a[80:83], v[164:167], v[84:87]
  s_waitcnt lgkmcnt(3)
  v_mfma_f32_16x16x32_bf16 v[88:91], a[72:75], v[168:171], v[88:91]
  ds_read_b128 v[184:187], v17 offset:61440
  v_mfma_f32_16x16x32_bf16 v[92:95], a[76:79], v[168:171], v[92:95]
  s_add_u32 m0, s31, 107520
  v_mfma_f32_16x16x32_bf16 v[96:99], a[80:83], v[168:171], v[96:99]
  s_waitcnt lgkmcnt(3)
  buffer_load_dwordx4 v11, s[8:11], s30 offen lds
  v_mfma_f32_16x16x32_bf16 v[100:103], a[72:75], v[172:175], v[100:103]
  s_add_u32 s30, s30, 128
  ds_read_b128 v[188:191], v17 offset:63488
  v_mfma_f32_16x16x32_bf16 v[104:107], a[76:79], v[172:175], v[104:107]
  v_mfma_f32_16x16x32_bf16 v[108:111], a[80:83], v[172:175], v[108:111]
  s_waitcnt lgkmcnt(3)
  v_mfma_f32_16x16x32_bf16 v[64:67], a[84:87], v[176:179], v[64:67]
  s_waitcnt vmcnt(5)
  s_barrier
  ds_read_b128 v[160:163], v18 offset:0
  v_mfma_f32_16x16x32_bf16 v[68:71], a[88:91], v[176:179], v[68:71]
  buffer_atomic_add v28, v27, s[72:75], s61 offen sc1
  v_mfma_f32_16x16x32_bf16 v[72:75], a[92:95], v[176:179], v[72:75]
  s_waitcnt lgkmcnt(3)
  s_mov_b32 s48, s27
  s_add_u32 s27, s27, 4194304
  v_mfma_f32_16x16x32_bf16 v[76:79], a[84:87], v[180:183], v[76:79]
  s_mov_b32 s61, s60
  ds_read_b128 v[164:167], v18 offset:2048
  s_add_u32 s60, s60, 4
  v_mfma_f32_16x16x32_bf16 v[80:83], a[88:91], v[180:183], v[80:83]
  v_mfma_f32_16x16x32_bf16 v[84:87], a[92:95], v[180:183], v[84:87]
  s_waitcnt lgkmcnt(3)
  v_mfma_f32_16x16x32_bf16 v[88:91], a[84:87], v[184:187], v[88:91]
  ds_read_b128 v[168:171], v18 offset:4096
  v_mfma_f32_16x16x32_bf16 v[92:95], a[88:91], v[184:187], v[92:95]
  v_mfma_f32_16x16x32_bf16 v[96:99], a[92:95], v[184:187], v[96:99]
  s_waitcnt lgkmcnt(3)
  v_mfma_f32_16x16x32_bf16 v[100:103], a[84:87], v[188:191], v[100:103]
  ds_read_b128 v[172:175], v18 offset:6144
  v_mfma_f32_16x16x32_bf16 v[104:107], a[88:91], v[188:191], v[104:107]
  v_mfma_f32_16x16x32_bf16 v[108:111], a[92:95], v[188:191], v[108:111]
  s_waitcnt lgkmcnt(3)
  v_mfma_f32_16x16x32_bf16 v[64:67], a[96:99], v[160:163], v[64:67]
  ds_read_b128 v[176:179], v19 offset:0
  v_mfma_f32_16x16x32_bf16 v[68:71], a[100:103], v[160:163], v[68:71]
  s_add_u32 m0, s31, 114688
  v_mfma_f32_16x16x32_bf16 v[72:75], a[104:107], v[160:163], v[72:75]
  s_waitcnt lgkmcnt(3)
  buffer_load_dwordx4 v10, s[8:11], s30 offen lds
  v_mfma_f32_16x16x32_bf16 v[76:79], a[96:99], v[164:167], v[76:79]
  ds_read_b128 v[180:183], v19 offset:2048
  v_mfma_f32_16x16x32_bf16 v[80:83], a[100:103], v[164:167], v[80:83]
  v_mfma_f32_16x16x32_bf16 v[84:87], a[104:107], v[164:167], v[84:87]
  s_waitcnt lgkmcnt(3)
  v_mfma_f32_16x16x32_bf16 v[88:91], a[96:99], v[168:171], v[88:91]
  ds_read_b128 v[184:187], v19 offset:4096
  v_mfma_f32_16x16x32_bf16 v[92:95], a[100:103], v[168:171], v[92:95]
  s_add_u32 m0, s31, 115712
  v_mfma_f32_16x16x32_bf16 v[96:99], a[104:107], v[168:171], v[96:99]
  s_waitcnt lgkmcnt(3)
  buffer_load_dwordx4 v11, s[8:11], s30 offen lds
  v_mfma_f32_16x16x32_bf16 v[100:103], a[96:99], v[172:175], v[100:103]
  s_add_u32 s30, s30, 128
  ds_read_b128 v[188:191], v19 offset:6144
  v_mfma_f32_16x16x32_bf16 v[104:107], a[100:103], v[172:175], v[104:107]
  v_mfma_f32_16x16x32_bf16 v[108:111], a[104:107], v[172:175], v[108:111]
  s_waitcnt lgkmcnt(3)
  v_mfma_f32_16x16x32_bf16 v[64:67], a[108:111], v[176:179], v[64:67]
  s_waitcnt vmcnt(21)
  s_barrier
  ds_read_b128 v[160:163], v18 offset:8192
  v_mfma_f32_16x16x32_bf16 v[68:71], a[112:115], v[176:179], v[68:71]
  v_mfma_f32_16x16x32_bf16 v[72:75], a[116:119], v[176:179], v[72:75]
  s_waitcnt lgkmcnt(3)
  v_mfma_f32_16x16x32_bf16 v[76:79], a[108:111], v[180:183], v[76:79]
  ds_read_b128 v[164:167], v18 offset:10240
  v_mfma_f32_16x16x32_bf16 v[80:83], a[112:115], v[180:183], v[80:83]
  v_mfma_f32_16x16x32_bf16 v[84:87], a[116:119], v[180:183], v[84:87]
  s_waitcnt lgkmcnt(3)
  v_mfma_f32_16x16x32_bf16 v[88:91], a[108:111], v[184:187], v[88:91]
  ds_read_b128 v[168:171], v18 offset:12288
  v_mfma_f32_16x16x32_bf16 v[92:95], a[112:115], v[184:187], v[92:95]
  v_mfma_f32_16x16x32_bf16 v[96:99], a[116:119], v[184:187], v[96:99]
  s_waitcnt lgkmcnt(3)
  v_mfma_f32_16x16x32_bf16 v[100:103], a[108:111], v[188:191], v[100:103]
  ds_read_b128 v[172:175], v18 offset:14336
  v_mfma_f32_16x16x32_bf16 v[104:107], a[112:115], v[188:191], v[104:107]
  v_mfma_f32_16x16x32_bf16 v[108:111], a[116:119], v[188:191], v[108:111]
  s_waitcnt lgkmcnt(3)
  v_mfma_f32_16x16x32_bf16 v[64:67], a[120:123], v[160:163], v[64:67]
  ds_read_b128 v[176:179], v19 offset:8192
  v_mfma_f32_16x16x32_bf16 v[68:71], a[124:127], v[160:163], v[68:71]
  s_add_u32 m0, s31, 122880
  v_mfma_f32_16x16x32_bf16 v[72:75], a[128:131], v[160:163], v[72:75]
  s_waitcnt lgkmcnt(3)
  buffer_load_dwordx4 v10, s[8:11], s30 offen lds
  v_mfma_f32_16x16x32_bf16 v[76:79], a[120:123], v[164:167], v[76:79]
  ds_read_b128 v[180:183], v19 offset:10240
  v_mfma_f32_16x16x32_bf16 v[80:83], a[124:127], v[164:167], v[80:83]
  v_mfma_f32_16x16x32_bf16 v[84:87], a[128:131], v[164:167], v[84:87]
  s_waitcnt lgkmcnt(3)
  v_mfma_f32_16x16x32_bf16 v[88:91], a[120:123], v[168:171], v[88:91]
  ds_read_b128 v[184:187], v19 offset:12288
  v_mfma_f32_16x16x32_bf16 v[92:95], a[124:127], v[168:171], v[92:95]
  s_add_u32 m0, s31, 123904
  v_mfma_f32_16x16x32_bf16 v[96:99], a[128:131], v[168:171], v[96:99]
  s_waitcnt lgkmcnt(3)
  buffer_load_dwordx4 v11, s[8:11], s30 offen lds
  v_mfma_f32_16x16x32_bf16 v[100:103], a[120:123], v[172:175], v[100:103]
  s_add_u32 s30, s30, 128
  ds_read_b128 v[188:191], v19 offset:14336
  v_mfma_f32_16x16x32_bf16 v[104:107], a[124:127], v[172:175], v[104:107]
  v_mfma_f32_16x16x32_bf16 v[108:111], a[128:131], v[172:175], v[108:111]
  s_waitcnt lgkmcnt(3)
  v_mfma_f32_16x16x32_bf16 v[64:67], a[132:135], v[176:179], v[64:67]
  s_waitcnt vmcnt(21)
  s_barrier
  ds_read_b128 v[160:163], v18 offset:16384
  v_mfma_f32_16x16x32_bf16 v[68:71], a[136:139], v[176:179], v[68:71]
  v_mfma_f32_16x16x32_bf16 v[72:75], a[140:143], v[176:179], v[72:75]
  s_waitcnt lgkmcnt(3)
  v_mfma_f32_16x16x32_bf16 v[76:79], a[132:135], v[180:183], v[76:79]
  ds_read_b128 v[164:167], v18 offset:18432
  v_mfma_f32_16x16x32_bf16 v[80:83], a[136:139], v[180:183], v[80:83]
  v_mfma_f32_16x16x32_bf16 v[84:87], a[140:143], v[180:183], v[84:87]
  s_waitcnt lgkmcnt(3)
  v_mfma_f32_16x16x32_bf16 v[88:91], a[132:135], v[184:187], v[88:91]
  ds_read_b128 v[168:171], v18 offset:20480
  v_mfma_f32_16x16x32_bf16 v[92:95], a[136:139], v[184:187], v[92:95]
  v_mfma_f32_16x16x32_bf16 v[96:99], a[140:143], v[184:187], v[96:99]
  s_waitcnt lgkmcnt(3)
  v_mfma_f32_16x16x32_bf16 v[100:103], a[132:135], v[188:191], v[100:103]
  ds_read_b128 v[172:175], v18 offset:22528
  v_mfma_f32_16x16x32_bf16 v[104:107], a[136:139], v[188:191], v[104:107]
  v_mfma_f32_16x16x32_bf16 v[108:111], a[140:143], v[188:191], v[108:111]
  s_waitcnt lgkmcnt(3)
  v_mfma_f32_16x16x32_bf16 v[64:67], a[144:147], v[160:163], v[64:67]
  ds_read_b128 v[176:179], v19 offset:16384
  v_mfma_f32_16x16x32_bf16 v[68:71], a[148:151], v[160:163], v[68:71]
  s_add_u32 m0, s31, 131072
  v_mfma_f32_16x16x32_bf16 v[72:75], a[152:155], v[160:163], v[72:75]
  s_waitcnt lgkmcnt(3)
  buffer_load_dwordx4 v10, s[8:11], s30 offen lds
  v_mfma_f32_16x16x32_bf16 v[76:79], a[144:147], v[164:167], v[76:79]
  ds_read_b128 v[180:183], v19 offset:18432
  v_mfma_f32_16x16x32_bf16 v[80:83], a[148:151], v[164:167], v[80:83]
  v_mfma_f32_16x16x32_bf16 v[84:87], a[152:155], v[164:167], v[84:87]
  s_waitcnt lgkmcnt(3)
  v_mfma_f32_16x16x32_bf16 v[88:91], a[144:147], v[168:171], v[88:91]
  ds_read_b128 v[184:187], v19 offset:20480
  v_mfma_f32_16x16x32_bf16 v[92:95], a[148:151], v[168:171], v[92:95]
  s_add_u32 m0, s31, 132096
  v_mfma_f32_16x16x32_bf16 v[96:99], a[152:155], v[168:171], v[96:99]
  s_waitcnt lgkmcnt(3)
  buffer_load_dwordx4 v11, s[8:11], s30 offen lds
  v_mfma_f32_16x16x32_bf16 v[100:103], a[144:147], v[172:175], v[100:103]
  s_add_u32 s30, s30, 128
  ds_read_b128 v[188:191], v19 offset:22528
  v_mfma_f32_16x16x32_bf16 v[104:107], a[148:151], v[172:175], v[104:107]
  v_mfma_f32_16x16x32_bf16 v[108:111], a[152:155], v[172:175], v[108:111]
  s_waitcnt lgkmcnt(3)
  v_mfma_f32_16x16x32_bf16 v[64:67], a[156:159], v[176:179], v[64:67]
  s_waitcnt vmcnt(21)
  s_barrier
  ds_read_b128 v[160:163], v18 offset:24576
  v_mfma_f32_16x16x32_bf16 v[68:71], a[160:163], v[176:179], v[68:71]
  v_mfma_f32_16x16x32_bf16 v[72:75], a[164:167], v[176:179], v[72:75]
  s_waitcnt lgkmcnt(3)
  v_mfma_f32_16x16x32_bf16 v[76:79], a[156:159], v[180:183], v[76:79]
  ds_read_b128 v[164:167], v18 offset:26624
  v_mfma_f32_16x16x32_bf16 v[80:83], a[160:163], v[180:183], v[80:83]
  v_mfma_f32_16x16x32_bf16 v[84:87], a[164:167], v[180:183], v[84:87]
  s_waitcnt lgkmcnt(3)
  v_mfma_f32_16x16x32_bf16 v[88:91], a[156:159], v[184:187], v[88:91]
  ds_read_b128 v[168:171], v18 offset:28672
  v_mfma_f32_16x16x32_bf16 v[92:95], a[160:163], v[184:187], v[92:95]
  v_mfma_f32_16x16x32_bf16 v[96:99], a[164:167], v[184:187], v[96:99]
  s_waitcnt lgkmcnt(3)
  v_mfma_f32_16x16x32_bf16 v[100:103], a[156:159], v[188:191], v[100:103]
  ds_read_b128 v[172:175], v18 offset:30720
  v_mfma_f32_16x16x32_bf16 v[104:107], a[160:163], v[188:191], v[104:107]
  v_mfma_f32_16x16x32_bf16 v[108:111], a[164:167], v[188:191], v[108:111]
  s_waitcnt lgkmcnt(3)
  v_mfma_f32_16x16x32_bf16 v[64:67], a[168:171], v[160:163], v[64:67]
  ds_read_b128 v[176:179], v19 offset:24576
  v_mfma_f32_16x16x32_bf16 v[68:71], a[172:175], v[160:163], v[68:71]
  s_add_u32 m0, s31, 139264
  v_mfma_f32_16x16x32_bf16 v[72:75], a[176:179], v[160:163], v[72:75]
  s_waitcnt lgkmcnt(3)
  buffer_load_dwordx4 v10, s[8:11], s30 offen lds
  v_mfma_f32_16x16x32_bf16 v[76:79], a[168:171], v[164:167], v[76:79]
  ds_read_b128 v[180:183], v19 offset:26624
  v_mfma_f32_16x16x32_bf16 v[80:83], a[172:175], v[164:167], v[80:83]
  v_mfma_f32_16x16x32_bf16 v[84:87], a[176:179], v[164:167], v[84:87]
  s_waitcnt lgkmcnt(3)
  v_mfma_f32_16x16x32_bf16 v[88:91], a[168:171], v[168:171], v[88:91]
  ds_read_b128 v[184:187], v19 offset:28672
  v_mfma_f32_16x16x32_bf16 v[92:95], a[172:175], v[168:171], v[92:95]
  s_add_u32 m0, s31, 140288
  v_mfma_f32_16x16x32_bf16 v[96:99], a[176:179], v[168:171], v[96:99]
  s_waitcnt lgkmcnt(3)
  buffer_load_dwordx4 v11, s[8:11], s30 offen lds
  v_mfma_f32_16x16x32_bf16 v[100:103], a[168:171], v[172:175], v[100:103]
  s_add_u32 s30, s30, 128
  ds_read_b128 v[188:191], v19 offset:30720
  v_mfma_f32_16x16x32_bf16 v[104:107], a[172:175], v[172:175], v[104:107]
  v_mfma_f32_16x16x32_bf16 v[108:111], a[176:179], v[172:175], v[108:111]
  s_waitcnt lgkmcnt(3)
  v_mfma_f32_16x16x32_bf16 v[64:67], a[180:183], v[176:179], v[64:67]
  s_waitcnt vmcnt(19)
  s_barrier
  ds_read_b128 v[160:163], v16 offset:16384
  v_mfma_f32_16x16x32_bf16 v[68:71], a[184:187], v[176:179], v[68:71]
  v_mfma_f32_16x16x32_bf16 v[72:75], a[188:191], v[176:179], v[72:75]
  s_waitcnt lgkmcnt(3)
  v_mfma_f32_16x16x32_bf16 v[76:79], a[180:183], v[180:183], v[76:79]
  ds_read_b128 v[164:167], v16 offset:18432
  v_mfma_f32_16x16x32_bf16 v[80:83], a[184:187], v[180:183], v[80:83]
  v_mfma_f32_16x16x32_bf16 v[84:87], a[188:191], v[180:183], v[84:87]
  s_waitcnt lgkmcnt(3)
  v_mfma_f32_16x16x32_bf16 v[88:91], a[180:183], v[184:187], v[88:91]
  ds_read_b128 v[168:171], v16 offset:20480
  v_mfma_f32_16x16x32_bf16 v[92:95], a[184:187], v[184:187], v[92:95]
  v_mfma_f32_16x16x32_bf16 v[96:99], a[188:191], v[184:187], v[96:99]
  s_waitcnt lgkmcnt(3)
  v_mfma_f32_16x16x32_bf16 v[100:103], a[180:183], v[188:191], v[100:103]
  ds_read_b128 v[172:175], v16 offset:22528
  v_mfma_f32_16x16x32_bf16 v[104:107], a[184:187], v[188:191], v[104:107]
  v_mfma_f32_16x16x32_bf16 v[108:111], a[188:191], v[188:191], v[108:111]
  s_waitcnt lgkmcnt(3)
  v_mfma_f32_16x16x32_bf16 v[64:67], a[192:195], v[160:163], v[64:67]
  ds_read_b128 v[176:179], v17 offset:16384
  v_mfma_f32_16x16x32_bf16 v[68:71], a[196:199], v[160:163], v[68:71]
  s_add_u32 m0, s31, 147456
  v_mfma_f32_16x16x32_bf16 v[72:75], a[200:203], v[160:163], v[72:75]
  s_waitcnt lgkmcnt(3)
  buffer_load_dwordx4 v10, s[8:11], s30 offen lds
  v_mfma_f32_16x16x32_bf16 v[76:79], a[192:195], v[164:167], v[76:79]
  ds_read_b128 v[180:183], v17 offset:18432
  v_mfma_f32_16x16x32_bf16 v[80:83], a[196:199], v[164:167], v[80:83]
  v_mfma_f32_16x16x32_bf16 v[84:87], a[200:203], v[164:167], v[84:87]
  s_waitcnt lgkmcnt(3)
  v_mfma_f32_16x16x32_bf16 v[88:91], a[192:195], v[168:171], v[88:91]
  ds_read_b128 v[184:187], v17 offset:20480
  v_mfma_f32_16x16x32_bf16 v[92:95], a[196:199], v[168:171], v[92:95]
  s_add_u32 m0, s31, 148480
  v_mfma_f32_16x16x32_bf16 v[96:99], a[200:203], v[168:171], v[96:99]
  s_waitcnt lgkmcnt(3)
  buffer_load_dwordx4 v11, s[8:11], s30 offen lds
  v_mfma_f32_16x16x32_bf16 v[100:103], a[192:195], v[172:175], v[100:103]
  s_add_u32 s30, s30, 128
  ds_read_b128 v[188:191], v17 offset:22528
  v_mfma_f32_16x16x32_bf16 v[104:107], a[196:199], v[172:175], v[104:107]
  v_mfma_f32_16x16x32_bf16 v[108:111], a[200:203], v[172:175], v[108:111]
  s_waitcnt lgkmcnt(3)
  v_mfma_f32_16x16x32_bf16 v[64:67], a[204:207], v[176:179], v[64:67]
  s_waitcnt vmcnt(15)
  s_barrier
  ds_read_b128 v[160:163], v16 offset:24576
  v_mfma_f32_16x16x32_bf16 v[68:71], a[208:211], v[176:179], v[68:71]
  v_mfma_f32_16x16x32_bf16 v[72:75], a[212:215], v[176:179], v[72:75]
  s_waitcnt lgkmcnt(3)
  v_mfma_f32_16x16x32_bf16 v[76:79], a[204:207], v[180:183], v[76:79]
  ds_read_b128 v[164:167], v16 offset:26624
  v_mfma_f32_16x16x32_bf16 v[80:83], a[208:211], v[180:183], v[80:83]
  v_mfma_f32_16x16x32_bf16 v[84:87], a[212:215], v[180:183], v[84:87]
  s_waitcnt lgkmcnt(3)
  v_mfma_f32_16x16x32_bf16 v[88:91], a[204:207], v[184:187], v[88:91]
  ds_read_b128 v[168:171], v16 offset:28672
  v_mfma_f32_16x16x32_bf16 v[92:95], a[208:211], v[184:187], v[92:95]
  v_mfma_f32_16x16x32_bf16 v[96:99], a[212:215], v[184:187], v[96:99]
  s_waitcnt lgkmcnt(3)
  v_mfma_f32_16x16x32_bf16 v[100:103], a[204:207], v[188:191], v[100:103]
  ds_read_b128 v[172:175], v16 offset:30720
  v_mfma_f32_16x16x32_bf16 v[104:107], a[208:211], v[188:191], v[104:107]
  v_mfma_f32_16x16x32_bf16 v[108:111], a[212:215], v[188:191], v[108:111]
  s_waitcnt lgkmcnt(3)
  v_mfma_f32_16x16x32_bf16 v[64:67], a[216:219], v[160:163], v[64:67]
  ds_read_b128 v[176:179], v17 offset:24576
  v_mfma_f32_16x16x32_bf16 v[68:71], a[220:223], v[160:163], v[68:71]
  s_add_u32 m0, s31, 155648
  v_mfma_f32_16x16x32_bf16 v[72:75], a[224:227], v[160:163], v[72:75]
  s_waitcnt lgkmcnt(3)
  buffer_load_dwordx4 v10, s[8:11], s30 offen lds
  v_mfma_f32_16x16x32_bf16 v[76:79], a[216:219], v[164:167], v[76:79]
  ds_read_b128 v[180:183], v17 offset:26624
  v_mfma_f32_16x16x32_bf16 v[80:83], a[220:223], v[164:167], v[80:83]
  v_mfma_f32_16x16x32_bf16 v[84:87], a[224:227], v[164:167], v[84:87]
  s_waitcnt lgkmcnt(3)
  v_mfma_f32_16x16x32_bf16 v[88:91], a[216:219], v[168:171], v[88:91]
  ds_read_b128 v[184:187], v17 offset:28672
  v_mfma_f32_16x16x32_bf16 v[92:95], a[220:223], v[168:171], v[92:95]
  s_add_u32 m0, s31, 156672
  v_mfma_f32_16x16x32_bf16 v[96:99], a[224:227], v[168:171], v[96:99]
  s_waitcnt lgkmcnt(3)
  buffer_load_dwordx4 v11, s[8:11], s30 offen lds
  v_mfma_f32_16x16x32_bf16 v[100:103], a[216:219], v[172:175], v[100:103]
  s_add_u32 s30, s30, 128
  ds_read_b128 v[188:191], v17 offset:30720
  v_mfma_f32_16x16x32_bf16 v[104:107], a[220:223], v[172:175], v[104:107]
  v_mfma_f32_16x16x32_bf16 v[108:111], a[224:227], v[172:175], v[108:111]
  s_waitcnt lgkmcnt(3)
  v_mfma_f32_16x16x32_bf16 v[64:67], a[228:231], v[176:179], v[64:67]
  s_waitcnt vmcnt(15)
  s_barrier
  ds_read_b128 v[160:163], v16 offset:32768
  v_mfma_f32_16x16x32_bf16 v[68:71], a[232:235], v[176:179], v[68:71]
  v_mfma_f32_16x16x32_bf16 v[72:75], a[236:239], v[176:179], v[72:75]
  s_waitcnt lgkmcnt(3)
  v_mfma_f32_16x16x32_bf16 v[76:79], a[228:231], v[180:183], v[76:79]
  ds_read_b128 v[164:167], v16 offset:34816
  v_cvt_pk_bf16_f32 v192, v64, v65
  v_mfma_f32_16x16x32_bf16 v[80:83], a[232:235], v[180:183], v[80:83]
  v_cvt_pk_bf16_f32 v193, v66, v67
  v_cvt_pk_bf16_f32 v194, v68, v69
  v_mfma_f32_16x16x32_bf16 v[84:87], a[236:239], v[180:183], v[84:87]
  s_waitcnt lgkmcnt(3)
  v_cvt_pk_bf16_f32 v195, v70, v71
  v_cvt_pk_bf16_f32 v200, v72, v73
  v_mfma_f32_16x16x32_bf16 v[88:91], a[228:231], v[184:187], v[88:91]
  ds_read_b128 v[168:171], v16 offset:36864
  v_cvt_pk_bf16_f32 v201, v74, v75
  v_mfma_f32_16x16x32_bf16 v[92:95], a[232:235], v[184:187], v[92:95]
  v_cvt_pk_bf16_f32 v196, v76, v77
  v_cvt_pk_bf16_f32 v197, v78, v79
  v_mfma_f32_16x16x32_bf16 v[96:99], a[236:239], v[184:187], v[96:99]
  s_waitcnt lgkmcnt(3)
  v_cvt_pk_bf16_f32 v198, v80, v81
  v_cvt_pk_bf16_f32 v199, v82, v83
  v_mfma_f32_16x16x32_bf16 v[100:103], a[228:231], v[188:191], v[100:103]
  ds_read_b128 v[172:175], v16 offset:38912
  v_cvt_pk_bf16_f32 v202, v84, v85
  v_mfma_f32_16x16x32_bf16 v[104:107], a[232:235], v[188:191], v[104:107]
  s_sub_u32 s26, s26, 1
  s_cmp_gt_u32 s26, 0
  v_cvt_pk_bf16_f32 v203, v86, v87
  v_mfma_f32_16x16x32_bf16 v[108:111], a[236:239], v[188:191], v[108:111]
  s_waitcnt lgkmcnt(3)
  s_cbranch_scc1 kvm_204
  s_nop 7
  v_cvt_pk_bf16_f32 v204, v88, v89
  v_cvt_pk_bf16_f32 v205, v90, v91
  v_cvt_pk_bf16_f32 v206, v92, v93
  v_cvt_pk_bf16_f32 v207, v94, v95
  v_cvt_pk_bf16_f32 v212, v96, v97
  v_cvt_pk_bf16_f32 v213, v98, v99
  v_cvt_pk_bf16_f32 v208, v100, v101
  v_cvt_pk_bf16_f32 v209, v102, v103
  v_cvt_pk_bf16_f32 v210, v104, v105
  v_cvt_pk_bf16_f32 v211, v106, v107
  v_cvt_pk_bf16_f32 v214, v108, v109
  v_cvt_pk_bf16_f32 v215, v110, v111
  s_xor_b32 s29, s48, 0
  buffer_store_dwordx4 v[192:195], v26, s[16:19], s29 offen offset:0 sc1
  buffer_store_dwordx4 v[196:199], v26, s[16:19], s29 offen offset:1024 sc1
  buffer_store_dwordx4 v[200:203], v26, s[16:19], s29 offen offset:2048 sc1
  s_xor_b32 s29, s48, 2105344
  buffer_store_dwordx4 v[204:207], v26, s[16:19], s29 offen offset:0 sc1
  buffer_store_dwordx4 v[208:211], v26, s[16:19], s29 offen offset:1024 sc1
  buffer_store_dwordx4 v[212:215], v26, s[16:19], s29 offen offset:2048 sc1
  s_mov_b32 s30, 491520
  s_mov_b32 s25, 162688
  v_lshrrev_b32 v4, 3, v1
  v_and_b32 v5, 7, v1
  v_xor_b32 v5, v5, v4
  s_mul_i32 s21, s20, 32
  v_add_u32 v4, s21, v4
  v_mul_u32_u24 v4, 1280, v4
  v_lshl_add_u32 v10, v5, 4, v4
  s_mul_i32 s31, s20, 4096
  v_add_u32 v11, 10240, v10
  v_add_u32 v12, 20480, v10
  v_add_u32 v13, 30720, v10
  s_add_u32 m0, s31, 0
  s_nop 0
  buffer_load_dwordx4 v10, s[8:11], s30 offen lds
  s_add_u32 m0, s31, 1024
  s_nop 0
  buffer_load_dwordx4 v11, s[8:11], s30 offen lds
  s_add_u32 m0, s31, 2048
  s_nop 0
  buffer_load_dwordx4 v12, s[8:11], s30 offen lds
  s_add_u32 m0, s31, 3072
  s_nop 0
  buffer_load_dwordx4 v13, s[8:11], s30 offen lds
  s_add_u32 s30, s30, 128
  s_add_u32 m0, s31, 16384
  s_nop 0
  buffer_load_dwordx4 v10, s[8:11], s30 offen lds
  s_add_u32 m0, s31, 17408
  s_nop 0
  buffer_load_dwordx4 v11, s[8:11], s30 offen lds
  s_add_u32 m0, s31, 18432
  s_nop 0
  buffer_load_dwordx4 v12, s[8:11], s30 offen lds
  s_add_u32 m0, s31, 19456
  s_nop 0
  buffer_load_dwordx4 v13, s[8:11], s30 offen lds
  s_add_u32 s30, s30, 128
  s_add_u32 m0, s31, 32768
  s_nop 0
  buffer_load_dwordx4 v10, s[8:11], s30 offen lds
  s_add_u32 m0, s31, 33792
  s_nop 0
  buffer_load_dwordx4 v11, s[8:11], s30 offen lds
  s_add_u32 m0, s31, 34816
  s_nop 0
  buffer_load_dwordx4 v12, s[8:11], s30 offen lds
  s_add_u32 m0, s31, 35840
  s_nop 0
  buffer_load_dwordx4 v13, s[8:11], s30 offen lds
  s_add_u32 s30, s30, 128
  s_add_u32 m0, s31, 49152
  s_nop 0
  buffer_load_dwordx4 v10, s[8:11], s30 offen lds
  s_add_u32 m0, s31, 50176
  s_nop 0
  buffer_load_dwordx4 v11, s[8:11], s30 offen lds
  s_add_u32 m0, s31, 51200
  s_nop 0
  buffer_load_dwordx4 v12, s[8:11], s30 offen lds
  s_add_u32 m0, s31, 52224
  s_nop 0
  buffer_load_dwordx4 v13, s[8:11], s30 offen lds
  s_add_u32 s30, s30, 128
  s_add_u32 m0, s31, 65536
  s_nop 0
  buffer_load_dwordx4 v10, s[8:11], s30 offen lds
  s_add_u32 m0, s31, 66560
  s_nop 0
  buffer_load_dwordx4 v11, s[8:11], s30 offen lds
  s_add_u32 m0, s31, 67584
  s_nop 0
  buffer_load_dwordx4 v12, s[8:11], s30 offen lds
  s_add_u32 m0, s31, 68608
  s_nop 0
  buffer_load_dwordx4 v13, s[8:11], s30 offen lds
  s_add_u32 s30, s30, 128
  s_waitcnt vmcnt(20) lgkmcnt(0)
  s_barrier
  buffer_atomic_add v28, v27, s[72:75], s61 offen sc1
  s_add_u32 m0, s31, 81920
  s_nop 0
  buffer_load_dwordx4 v10, s[8:11], s30 offen lds
  s_add_u32 m0, s31, 82944
  s_nop 0
  buffer_load_dwordx4 v11, s[8:11], s30 offen lds
  s_add_u32 m0, s31, 83968
  s_nop 0
  buffer_load_dwordx4 v12, s[8:11], s30 offen lds
  s_add_u32 m0, s31, 84992
  s_nop 0
  buffer_load_dwordx4 v13, s[8:11], s30 offen lds
  s_add_u32 s30, s30, 128
  s_mov_b32 s26, 13
  s_mov_b32 s48, 0x40000000
  s_mov_b32 s61, 0x40000000
  s_waitcnt vmcnt(16)
  s_barrier
  ds_read_b128 v[160:163], v14 offset:0
  ds_read_b128 v[164:167], v14 offset:2048
  ds_read_b128 v[168:171], v14 offset:4096
  ds_read_b128 v[172:175], v14 offset:6144
  s_waitcnt lgkmcnt(3)
  .p2align 3
kvs_205:
  v_mfma_f32_16x16x32_bf16 v[64:67], a[0:3], v[160:163], 0
  s_xor_b32 s29, s48, 0
  ds_read_b128 v[176:179], v14 offset:8192
  v_cvt_pk_bf16_f32 v221, v126, v127
  v_mfma_f32_16x16x32_bf16 v[68:71], a[4:7], v[160:163], 0
  v_cvt_pk_bf16_f32 v222, v128, v129
  v_cvt_pk_bf16_f32 v223, v130, v131
  v_mfma_f32_16x16x32_bf16 v[72:75], a[8:11], v[160:163], 0
  s_waitcnt lgkmcnt(3)
  v_cvt_pk_bf16_f32 v226, v132, v133
  v_cvt_pk_bf16_f32 v227, v134, v135
  v_mfma_f32_16x16x32_bf16 v[76:79], a[0:3], v[164:167], 0
  ds_read_b128 v[180:183], v14 offset:10240
  v_cvt_pk_bf16_f32 v228, v136, v137
  v_mfma_f32_16x16x32_bf16 v[80:83], a[4:7], v[164:167], 0
  v_cvt_pk_bf16_f32 v229, v138, v139
  v_cvt_pk_bf16_f32 v230, v140, v141
  v_mfma_f32_16x16x32_bf16 v[84:87], a[8:11], v[164:167], 0
  s_waitcnt lgkmcnt(3)
  v_cvt_pk_bf16_f32 v231, v142, v143
  v_cvt_pk_bf16_f32 v236, v144, v145
  v_mfma_f32_16x16x32_bf16 v[88:91], a[0:3], v[168:171], 0
  ds_read_b128 v[184:187], v14 offset:12288
  v_cvt_pk_bf16_f32 v237, v146, v147
  v_mfma_f32_16x16x32_bf16 v[92:95], a[4:7], v[168:171], 0
  v_cvt_pk_bf16_f32 v232, v148, v149
  v_cvt_pk_bf16_f32 v233, v150, v151
  v_mfma_f32_16x16x32_bf16 v[96:99], a[8:11], v[168:171], 0
  s_waitcnt lgkmcnt(3)
  v_cvt_pk_bf16_f32 v234, v152, v153
  v_cvt_pk_bf16_f32 v235, v154, v155
  v_mfma_f32_16x16x32_bf16 v[100:103], a[0:3], v[172:175], 0
  ds_read_b128 v[188:191], v14 offset:14336
  v_cvt_pk_bf16_f32 v238, v156, v157
  v_mfma_f32_16x16x32_bf16 v[104:107], a[4:7], v[172:175], 0
  v_cvt_pk_bf16_f32 v239, v158, v159
  v_mfma_f32_16x16x32_bf16 v[108:111], a[8:11], v[172:175], 0
  s_waitcnt lgkmcnt(3)
  v_mfma_f32_16x16x32_bf16 v[112:115], a[0:3], v[176:179], 0
  ds_read_b128 v[160:163], v15 offset:0
  v_mfma_f32_16x16x32_bf16 v[116:119], a[4:7], v[176:179], 0
  s_add_u32 m0, s31, 98304
  v_mfma_f32_16x16x32_bf16 v[120:123], a[8:11], v[176:179], 0
  s_waitcnt lgkmcnt(3)
  buffer_load_dwordx4 v10, s[8:11], s30 offen lds
  v_mfma_f32_16x16x32_bf16 v[124:127], a[0:3], v[180:183], 0
  ds_read_b128 v[164:167], v15 offset:2048
  v_mfma_f32_16x16x32_bf16 v[128:131], a[4:7], v[180:183], 0
  v_mfma_f32_16x16x32_bf16 v[132:135], a[8:11], v[180:183], 0
  s_waitcnt lgkmcnt(3)
  v_mfma_f32_16x16x32_bf16 v[136:139], a[0:3], v[184:187], 0
  ds_read_b128 v[168:171], v15 offset:4096
  v_mfma_f32_16x16x32_bf16 v[140:143], a[4:7], v[184:187], 0
  s_add_u32 m0, s31, 99328
  v_mfma_f32_16x16x32_bf16 v[144:147], a[8:11], v[184:187], 0
  s_waitcnt lgkmcnt(3)
  buffer_load_dwordx4 v11, s[8:11], s30 offen lds
  v_mfma_f32_16x16x32_bf16 v[148:151], a[0:3], v[188:191], 0
  ds_read_b128 v[172:175], v15 offset:6144
  v_mfma_f32_16x16x32_bf16 v[152:155], a[4:7], v[188:191], 0
  v_mfma_f32_16x16x32_bf16 v[156:159], a[8:11], v[188:191], 0
  s_waitcnt lgkmcnt(3)
  v_mfma_f32_16x16x32_bf16 v[64:67], a[12:15], v[160:163], v[64:67]
  ds_read_b128 v[176:179], v15 offset:8192
  v_mfma_f32_16x16x32_bf16 v[68:71], a[16:19], v[160:163], v[68:71]
  s_add_u32 m0, s31, 100352
  v_mfma_f32_16x16x32_bf16 v[72:75], a[20:23], v[160:163], v[72:75]
  s_waitcnt lgkmcnt(3)
  buffer_load_dwordx4 v12, s[8:11], s30 offen lds
  v_mfma_f32_16x16x32_bf16 v[76:79], a[12:15], v[164:167], v[76:79]
  ds_read_b128 v[180:183], v15 offset:10240
  v_mfma_f32_16x16x32_bf16 v[80:83], a[16:19], v[164:167], v[80:83]
  v_mfma_f32_16x16x32_bf16 v[84:87], a[20:23], v[164:167], v[84:87]
  s_waitcnt lgkmcnt(3)
  v_mfma_f32_16x16x32_bf16 v[88:91], a[12:15], v[168:171], v[88:91]
  ds_read_b128 v[184:187], v15 offset:12288
  v_mfma_f32_16x16x32_bf16 v[92:95], a[16:19], v[168:171], v[92:95]
  s_add_u32 m0, s31, 101376
  v_mfma_f32_16x16x32_bf16 v[96:99], a[20:23], v[168:171], v[96:99]
  s_waitcnt lgkmcnt(3)
  buffer_load_dwordx4 v13, s[8:11], s30 offen lds
  v_mfma_f32_16x16x32_bf16 v[100:103], a[12:15], v[172:175], v[100:103]
  s_add_u32 s30, s30, 128
  ds_read_b128 v[188:191], v15 offset:14336
  v_mfma_f32_16x16x32_bf16 v[104:107], a[16:19], v[172:175], v[104:107]
  v_mfma_f32_16x16x32_bf16 v[108:111], a[20:23], v[172:175], v[108:111]
  s_waitcnt lgkmcnt(3)
  v_mfma_f32_16x16x32_bf16 v[112:115], a[12:15], v[176:179], v[112:115]
  ds_read_b128 v[160:163], v14 offset:16384
  v_mfma_f32_16x16x32_bf16 v[116:119], a[16:19], v[176:179], v[116:119]
  buffer_store_dwordx4 v[192:195], v26, s[16:19], s29 offen offset:0 sc1
  v_mfma_f32_16x16x32_bf16 v[120:123], a[20:23], v[176:179], v[120:123]
  s_waitcnt lgkmcnt(3)
  v_mfma_f32_16x16x32_bf16 v[124:127], a[12:15], v[180:183], v[124:127]
  ds_read_b128 v[164:167], v14 offset:18432
  v_mfma_f32_16x16x32_bf16 v[128:131], a[16:19], v[180:183], v[128:131]
  v_mfma_f32_16x16x32_bf16 v[132:135], a[20:23], v[180:183], v[132:135]
  s_waitcnt lgkmcnt(3)
  v_mfma_f32_16x16x32_bf16 v[136:139], a[12:15], v[184:187], v[136:139]
  ds_read_b128 v[168:171], v14 offset:20480
  v_mfma_f32_16x16x32_bf16 v[140:143], a[16:19], v[184:187], v[140:143]
  v_mfma_f32_16x16x32_bf16 v[144:147], a[20:23], v[184:187], v[144:147]
  s_waitcnt lgkmcnt(3)
  buffer_store_dwordx4 v[196:199], v26, s[16:19], s29 offen offset:1024 sc1
  v_mfma_f32_16x16x32_bf16 v[148:151], a[12:15], v[188:191], v[148:151]
  ds_read_b128 v[172:175], v14 offset:22528
  v_mfma_f32_16x16x32_bf16 v[152:155], a[16:19], v[188:191], v[152:155]
  v_mfma_f32_16x16x32_bf16 v[156:159], a[20:23], v[188:191], v[156:159]
  s_waitcnt lgkmcnt(3)
  v_mfma_f32_16x16x32_bf16 v[64:67], a[24:27], v[160:163], v[64:67]
  ds_read_b128 v[176:179], v14 offset:24576
  v_mfma_f32_16x16x32_bf16 v[68:71], a[28:31], v[160:163], v[68:71]
  s_add_u32 m0, s31, 114688
  v_mfma_f32_16x16x32_bf16 v[72:75], a[32:35], v[160:163], v[72:75]
  s_waitcnt lgkmcnt(3)
  buffer_load_dwordx4 v10, s[8:11], s30 offen lds
  v_mfma_f32_16x16x32_bf16 v[76:79], a[24:27], v[164:167], v[76:79]
  ds_read_b128 v[180:183], v14 offset:26624
  v_mfma_f32_16x16x32_bf16 v[80:83], a[28:31], v[164:167], v[80:83]
  v_mfma_f32_16x16x32_bf16 v[84:87], a[32:35], v[164:167], v[84:87]
  s_waitcnt lgkmcnt(3)
  v_mfma_f32_16x16x32_bf16 v[88:91], a[24:27], v[168:171], v[88:91]
  ds_read_b128 v[184:187], v14 offset:28672
  v_mfma_f32_16x16x32_bf16 v[92:95], a[28:31], v[168:171], v[92:95]
  buffer_store_dwordx4 v[200:203], v26, s[16:19], s29 offen offset:2048 sc1
  v_mfma_f32_16x16x32_bf16 v[96:99], a[32:35], v[168:171], v[96:99]
  s_waitcnt lgkmcnt(3)
  v_mfma_f32_16x16x32_bf16 v[100:103], a[24:27], v[172:175], v[100:103]
  ds_read_b128 v[188:191], v14 offset:30720
  v_mfma_f32_16x16x32_bf16 v[104:107], a[28:31], v[172:175], v[104:107]
  v_mfma_f32_16x16x32_bf16 v[108:111], a[32:35], v[172:175], v[108:111]
  s_waitcnt lgkmcnt(3)
  v_mfma_f32_16x16x32_bf16 v[112:115], a[24:27], v[176:179], v[112:115]
  ds_read_b128 v[160:163], v15 offset:16384
  v_mfma_f32_16x16x32_bf16 v[116:119], a[28:31], v[176:179], v[116:119]
  s_xor_b32 s29, s48, 2105344
  s_add_u32 m0, s31, 115712
  v_mfma_f32_16x16x32_bf16 v[120:123], a[32:35], v[176:179], v[120:123]
  s_waitcnt lgkmcnt(3)
  buffer_load_dwordx4 v11, s[8:11], s30 offen lds
  v_mfma_f32_16x16x32_bf16 v[124:127], a[24:27], v[180:183], v[124:127]
  ds_read_b128 v[164:167], v15 offset:18432
  v_mfma_f32_16x16x32_bf16 v[128:131], a[28:31], v[180:183], v[128:131]
  v_mfma_f32_16x16x32_bf16 v[132:135], a[32:35], v[180:183], v[132:135]
  s_waitcnt lgkmcnt(3)
  v_mfma_f32_16x16x32_bf16 v[136:139], a[24:27], v[184:187], v[136:139]
  ds_read_b128 v[168:171], v15 offset:20480
  v_mfma_f32_16x16x32_bf16 v[140:143], a[28:31], v[184:187], v[140:143]
  buffer_store_dwordx4 v[204:207], v26, s[16:19], s29 offen offset:0 sc1
  v_mfma_f32_16x16x32_bf16 v[144:147], a[32:35], v[184:187], v[144:147]
  s_waitcnt lgkmcnt(3)
  v_mfma_f32_16x16x32_bf16 v[148:151], a[24:27], v[188:191], v[148:151]
  ds_read_b128 v[172:175], v15 offset:22528
  v_mfma_f32_16x16x32_bf16 v[152:155], a[28:31], v[188:191], v[152:155]
  v_mfma_f32_16x16x32_bf16 v[156:159], a[32:35], v[188:191], v[156:159]
  s_waitcnt lgkmcnt(3)
  v_mfma_f32_16x16x32_bf16 v[64:67], a[36:39], v[160:163], v[64:67]
  ds_read_b128 v[176:179], v15 offset:24576
  v_mfma_f32_16x16x32_bf16 v[68:71], a[40:43], v[160:163], v[68:71]
  s_add_u32 m0, s31, 116736
  v_mfma_f32_16x16x32_bf16 v[72:75], a[44:47], v[160:163], v[72:75]
  s_waitcnt lgkmcnt(3)
  buffer_load_dwordx4 v12, s[8:11], s30 offen lds
  v_mfma_f32_16x16x32_bf16 v[76:79], a[36:39], v[164:167], v[76:79]
  ds_read_b128 v[180:183], v15 offset:26624
  v_mfma_f32_16x16x32_bf16 v[80:83], a[40:43], v[164:167], v[80:83]
  v_mfma_f32_16x16x32_bf16 v[84:87], a[44:47], v[164:167], v[84:87]
  s_waitcnt lgkmcnt(3)
  v_mfma_f32_16x16x32_bf16 v[88:91], a[36:39], v[168:171], v[88:91]
  ds_read_b128 v[184:187], v15 offset:28672
  v_mfma_f32_16x16x32_bf16 v[92:95], a[40:43], v[168:171], v[92:95]
  buffer_store_dwordx4 v[208:211], v26, s[16:19], s29 offen offset:1024 sc1
  v_mfma_f32_16x16x32_bf16 v[96:99], a[44:47], v[168:171], v[96:99]
  s_waitcnt lgkmcnt(3)
  v_mfma_f32_16x16x32_bf16 v[100:103], a[36:39], v[172:175], v[100:103]
  ds_read_b128 v[188:191], v15 offset:30720
  v_mfma_f32_16x16x32_bf16 v[104:107], a[40:43], v[172:175], v[104:107]
  v_mfma_f32_16x16x32_bf16 v[108:111], a[44:47], v[172:175], v[108:111]
  s_waitcnt lgkmcnt(3)
  v_mfma_f32_16x16x32_bf16 v[112:115], a[36:39], v[176:179], v[112:115]
  s_waitcnt vmcnt(20)
  s_barrier
  ds_read_b128 v[160:163], v14 offset:32768
  v_mfma_f32_16x16x32_bf16 v[116:119], a[40:43], v[176:179], v[116:119]
  s_add_u32 m0, s31, 117760
  v_mfma_f32_16x16x32_bf16 v[120:123], a[44:47], v[176:179], v[120:123]
  s_waitcnt lgkmcnt(3)
  buffer_load_dwordx4 v13, s[8:11], s30 offen lds
  v_mfma_f32_16x16x32_bf16 v[124:127], a[36:39], v[180:183], v[124:127]
  s_add_u32 s30, s30, 128
  ds_read_b128 v[164:167], v14 offset:34816
  v_mfma_f32_16x16x32_bf16 v[128:131], a[40:43], v[180:183], v[128:131]
  v_mfma_f32_16x16x32_bf16 v[132:135], a[44:47], v[180:183], v[132:135]
  s_waitcnt lgkmcnt(3)
  v_mfma_f32_16x16x32_bf16 v[136:139], a[36:39], v[184:187], v[136:139]
  ds_read_b128 v[168:171], v14 offset:36864
  v_mfma_f32_16x16x32_bf16 v[140:143], a[40:43], v[184:187], v[140:143]
  buffer_store_dwordx4 v[212:215], v26, s[16:19], s29 offen offset:2048 sc1
  v_mfma_f32_16x16x32_bf16 v[144:147], a[44:47], v[184:187], v[144:147]
  s_waitcnt lgkmcnt(3)
  v_mfma_f32_16x16x32_bf16 v[148:151], a[36:39], v[188:191], v[148:151]
  ds_read_b128 v[172:175], v14 offset:38912
  v_mfma_f32_16x16x32_bf16 v[152:155], a[40:43], v[188:191], v[152:155]
  v_mfma_f32_16x16x32_bf16 v[156:159], a[44:47], v[188:191], v[156:159]
  s_waitcnt lgkmcnt(3)
  v_mfma_f32_16x16x32_bf16 v[64:67], a[48:51], v[160:163], v[64:67]
  ds_read_b128 v[176:179], v14 offset:40960
  v_mfma_f32_16x16x32_bf16 v[68:71], a[52:55], v[160:163], v[68:71]
  s_xor_b32 s29, s48, 4194304
  s_add_u32 m0, s31, 131072
  v_mfma_f32_16x16x32_bf16 v[72:75], a[56:59], v[160:163], v[72:75]
  s_waitcnt lgkmcnt(3)
  buffer_load_dwordx4 v10, s[8:11], s30 offen lds
  v_mfma_f32_16x16x32_bf16 v[76:79], a[48:51], v[164:167], v[76:79]
  ds_read_b128 v[180:183], v14 offset:43008
  v_mfma_f32_16x16x32_bf16 v[80:83], a[52:55], v[164:167], v[80:83]
  v_mfma_f32_16x16x32_bf16 v[84:87], a[56:59], v[164:167], v[84:87]
  s_waitcnt lgkmcnt(3)
  v_mfma_f32_16x16x32_bf16 v[88:91], a[48:51], v[168:171], v[88:91]
  ds_read_b128 v[184:187], v14 offset:45056
  v_mfma_f32_16x16x32_bf16 v[92:95], a[52:55], v[168:171], v[92:95]
  buffer_store_dwordx4 v[216:219], v26, s[16:19], s29 offen offset:0 sc1
  v_mfma_f32_16x16x32_bf16 v[96:99], a[56:59], v[168:171], v[96:99]
  s_waitcnt lgkmcnt(3)
  v_mfma_f32_16x16x32_bf16 v[100:103], a[48:51], v[172:175], v[100:103]
  ds_read_b128 v[188:191], v14 offset:47104
  v_mfma_f32_16x16x32_bf16 v[104:107], a[52:55], v[172:175], v[104:107]
  v_mfma_f32_16x16x32_bf16 v[108:111], a[56:59], v[172:175], v[108:111]
  s_waitcnt lgkmcnt(3)
  v_mfma_f32_16x16x32_bf16 v[112:115], a[48:51], v[176:179], v[112:115]
  ds_read_b128 v[160:163], v15 offset:32768
  v_mfma_f32_16x16x32_bf16 v[116:119], a[52:55], v[176:179], v[116:119]
  s_add_u32 m0, s31, 132096
  v_mfma_f32_16x16x32_bf16 v[120:123], a[56:59], v[176:179], v[120:123]
  s_waitcnt lgkmcnt(3)
  buffer_load_dwordx4 v11, s[8:11], s30 offen lds
  v_mfma_f32_16x16x32_bf16 v[124:127], a[48:51], v[180:183], v[124:127]
  ds_read_b128 v[164:167], v15 offset:34816
  v_mfma_f32_16x16x32_bf16 v[128:131], a[52:55], v[180:183], v[128:131]
  v_mfma_f32_16x16x32_bf16 v[132:135], a[56:59], v[180:183], v[132:135]
  s_waitcnt lgkmcnt(3)
  v_mfma_f32_16x16x32_bf16 v[136:139], a[48:51], v[184:187], v[136:139]
  ds_read_b128 v[168:171], v15 offset:36864
  v_mfma_f32_16x16x32_bf16 v[140:143], a[52:55], v[184:187], v[140:143]
  buffer_store_dwordx4 v[220:223], v26, s[16:19], s29 offen offset:1024 sc1
  v_mfma_f32_16x16x32_bf16 v[144:147], a[56:59], v[184:187], v[144:147]
  s_waitcnt lgkmcnt(3)
  v_mfma_f32_16x16x32_bf16 v[148:151], a[48:51], v[188:191], v[148:151]
  ds_read_b128 v[172:175], v15 offset:38912
  v_mfma_f32_16x16x32_bf16 v[152:155], a[52:55], v[188:191], v[152:155]
  v_mfma_f32_16x16x32_bf16 v[156:159], a[56:59], v[188:191], v[156:159]
  s_waitcnt lgkmcnt(3)
  v_mfma_f32_16x16x32_bf16 v[64:67], a[60:63], v[160:163], v[64:67]
  ds_read_b128 v[176:179], v15 offset:40960
  v_mfma_f32_16x16x32_bf16 v[68:71], a[64:67], v[160:163], v[68:71]
  s_add_u32 m0, s31, 133120
  v_mfma_f32_16x16x32_bf16 v[72:75], a[68:71], v[160:163], v[72:75]
  s_waitcnt lgkmcnt(3)
  buffer_load_dwordx4 v12, s[8:11], s30 offen lds
  v_mfma_f32_16x16x32_bf16 v[76:79], a[60:63], v[164:167], v[76:79]
  ds_read_b128 v[180:183], v15 offset:43008
  v_mfma_f32_16x16x32_bf16 v[80:83], a[64:67], v[164:167], v[80:83]
  v_mfma_f32_16x16x32_bf16 v[84:87], a[68:71], v[164:167], v[84:87]
  s_waitcnt lgkmcnt(3)
  v_mfma_f32_16x16x32_bf16 v[88:91], a[60:63], v[168:171], v[88:91]
  ds_read_b128 v[184:187], v15 offset:45056
  v_mfma_f32_16x16x32_bf16 v[92:95], a[64:67], v[168:171], v[92:95]
  buffer_store_dwordx4 v[224:227], v26, s[16:19], s29 offen offset:2048 sc1
  v_mfma_f32_16x16x32_bf16 v[96:99], a[68:71], v[168:171], v[96:99]
  s_waitcnt lgkmcnt(3)
  v_mfma_f32_16x16x32_bf16 v[100:103], a[60:63], v[172:175], v[100:103]
  ds_read_b128 v[188:191], v15 offset:47104
  v_mfma_f32_16x16x32_bf16 v[104:107], a[64:67], v[172:175], v[104:107]
  v_mfma_f32_16x16x32_bf16 v[108:111], a[68:71], v[172:175], v[108:111]
  s_waitcnt lgkmcnt(3)
  v_mfma_f32_16x16x32_bf16 v[112:115], a[60:63], v[176:179], v[112:115]
  ds_read_b128 v[160:163], v14 offset:49152
  v_mfma_f32_16x16x32_bf16 v[116:119], a[64:67], v[176:179], v[116:119]
  s_xor_b32 s29, s48, 6299648
  s_add_u32 m0, s31, 134144
  v_mfma_f32_16x16x32_bf16 v[120:123], a[68:71], v[176:179], v[120:123]
  s_waitcnt lgkmcnt(3)
  buffer_load_dwordx4 v13, s[8:11], s30 offen lds
  v_mfma_f32_16x16x32_bf16 v[124:127], a[60:63], v[180:183], v[124:127]
  s_add_u32 s30, s30, 128
  ds_read_b128 v[164:167], v14 offset:51200
  v_mfma_f32_16x16x32_bf16 v[128:131], a[64:67], v[180:183], v[128:131]
  v_mfma_f32_16x16x32_bf16 v[132:135], a[68:71], v[180:183], v[132:135]
  s_waitcnt lgkmcnt(3)
  v_mfma_f32_16x16x32_bf16 v[136:139], a[60:63], v[184:187], v[136:139]
  ds_read_b128 v[168:171], v14 offset:53248
  v_mfma_f32_16x16x32_bf16 v[140:143], a[64:67], v[184:187], v[140:143]
  buffer_store_dwordx4 v[228:231], v26, s[16:19], s29 offen offset:0 sc1
  v_mfma_f32_16x16x32_bf16 v[144:147], a[68:71], v[184:187], v[144:147]
  s_waitcnt lgkmcnt(3)
  v_mfma_f32_16x16x32_bf16 v[148:151], a[60:63], v[188:191], v[148:151]
  ds_read_b128 v[172:175], v14 offset:55296
  v_mfma_f32_16x16x32_bf16 v[152:155], a[64:67], v[188:191], v[152:155]
  v_mfma_f32_16x16x32_bf16 v[156:159], a[68:71], v[188:191], v[156:159]
  s_waitcnt lgkmcnt(3)
  v_mfma_f32_16x16x32_bf16 v[64:67], a[72:75], v[160:163], v[64:67]
  ds_read_b128 v[176:179], v14 offset:57344
  v_mfma_f32_16x16x32_bf16 v[68:71], a[76:79], v[160:163], v[68:71]
  s_add_u32 m0, s31, 147456
  v_mfma_f32_16x16x32_bf16 v[72:75], a[80:83], v[160:163], v[72:75]
  s_waitcnt lgkmcnt(3)
  buffer_load_dwordx4 v10, s[8:11], s30 offen lds
  v_mfma_f32_16x16x32_bf16 v[76:79], a[72:75], v[164:167], v[76:79]
  ds_read_b128 v[180:183], v14 offset:59392
  v_mfma_f32_16x16x32_bf16 v[80:83], a[76:79], v[164:167], v[80:83]
  v_mfma_f32_16x16x32_bf16 v[84:87], a[80:83], v[164:167], v[84:87]
  s_waitcnt lgkmcnt(3)
  v_mfma_f32_16x16x32_bf16 v[88:91], a[72:75], v[168:171], v[88:91]
  ds_read_b128 v[184:187], v14 offset:61440
  v_mfma_f32_16x16x32_bf16 v[92:95], a[76:79], v[168:171], v[92:95]
  buffer_store_dwordx4 v[232:235], v26, s[16:19], s29 offen offset:1024 sc1
  v_mfma_f32_16x16x32_bf16 v[96:99], a[80:83], v[168:171], v[96:99]
  s_waitcnt lgkmcnt(3)
  v_mfma_f32_16x16x32_bf16 v[100:103], a[72:75], v[172:175], v[100:103]
  ds_read_b128 v[188:191], v14 offset:63488
  v_mfma_f32_16x16x32_bf16 v[104:107], a[76:79], v[172:175], v[104:107]
  v_mfma_f32_16x16x32_bf16 v[108:111], a[80:83], v[172:175], v[108:111]
  s_waitcnt lgkmcnt(3)
  v_mfma_f32_16x16x32_bf16 v[112:115], a[72:75], v[176:179], v[112:115]
  ds_read_b128 v[160:163], v15 offset:49152
  v_mfma_f32_16x16x32_bf16 v[116:119], a[76:79], v[176:179], v[116:119]
  s_add_u32 m0, s31, 148480
  v_mfma_f32_16x16x32_bf16 v[120:123], a[80:83], v[176:179], v[120:123]
  s_waitcnt lgkmcnt(3)
  buffer_load_dwordx4 v11, s[8:11], s30 offen lds
  v_mfma_f32_16x16x32_bf16 v[124:127], a[72:75], v[180:183], v[124:127]
  ds_read_b128 v[164:167], v15 offset:51200
  v_mfma_f32_16x16x32_bf16 v[128:131], a[76:79], v[180:183], v[128:131]
  v_mfma_f32_16x16x32_bf16 v[132:135], a[80:83], v[180:183], v[132:135]
  s_waitcnt lgkmcnt(3)
  v_mfma_f32_16x16x32_bf16 v[136:139], a[72:75], v[184:187], v[136:139]
  ds_read_b128 v[168:171], v15 offset:53248
  v_mfma_f32_16x16x32_bf16 v[140:143], a[76:79], v[184:187], v[140:143]
  buffer_store_dwordx4 v[236:239], v26, s[16:19], s29 offen offset:2048 sc1
  v_mfma_f32_16x16x32_bf16 v[144:147], a[80:83], v[184:187], v[144:147]
  s_waitcnt lgkmcnt(3)
  v_mfma_f32_16x16x32_bf16 v[148:151], a[72:75], v[188:191], v[148:151]
  ds_read_b128 v[172:175], v15 offset:55296
  v_mfma_f32_16x16x32_bf16 v[152:155], a[76:79], v[188:191], v[152:155]
  v_mfma_f32_16x16x32_bf16 v[156:159], a[80:83], v[188:191], v[156:159]
  s_waitcnt lgkmcnt(3)
  v_mfma_f32_16x16x32_bf16 v[64:67], a[84:87], v[160:163], v[64:67]
  ds_read_b128 v[176:179], v15 offset:57344
  v_mfma_f32_16x16x32_bf16 v[68:71], a[88:91], v[160:163], v[68:71]
  s_add_u32 m0, s31, 149504
  v_mfma_f32_16x16x32_bf16 v[72:75], a[92:95], v[160:163], v[72:75]
  s_waitcnt lgkmcnt(3)
  buffer_load_dwordx4 v12, s[8:11], s30 offen lds
  v_mfma_f32_16x16x32_bf16 v[76:79], a[84:87], v[164:167], v[76:79]
  ds_read_b128 v[180:183], v15 offset:59392
  v_mfma_f32_16x16x32_bf16 v[80:83], a[88:91], v[164:167], v[80:83]
  v_mfma_f32_16x16x32_bf16 v[84:87], a[92:95], v[164:167], v[84:87]
  s_waitcnt lgkmcnt(3)
  v_mfma_f32_16x16x32_bf16 v[88:91], a[84:87], v[168:171], v[88:91]
  ds_read_b128 v[184:187], v15 offset:61440
  v_mfma_f32_16x16x32_bf16 v[92:95], a[88:91], v[168:171], v[92:95]
  v_mfma_f32_16x16x32_bf16 v[96:99], a[92:95], v[168:171], v[96:99]
  s_waitcnt lgkmcnt(3)
  v_mfma_f32_16x16x32_bf16 v[100:103], a[84:87], v[172:175], v[100:103]
  ds_read_b128 v[188:191], v15 offset:63488
  v_mfma_f32_16x16x32_bf16 v[104:107], a[88:91], v[172:175], v[104:107]
  v_mfma_f32_16x16x32_bf16 v[108:111], a[92:95], v[172:175], v[108:111]
  s_waitcnt lgkmcnt(3)
  v_mfma_f32_16x16x32_bf16 v[112:115], a[84:87], v[176:179], v[112:115]
  s_waitcnt vmcnt(27)
  s_barrier
  ds_read_b128 v[160:163], v16 offset:0
  v_mfma_f32_16x16x32_bf16 v[116:119], a[88:91], v[176:179], v[116:119]
  s_add_u32 m0, s31, 150528
  v_mfma_f32_16x16x32_bf16 v[120:123], a[92:95], v[176:179], v[120:123]
  s_waitcnt lgkmcnt(3)
  buffer_load_dwordx4 v13, s[8:11], s30 offen lds
  v_mfma_f32_16x16x32_bf16 v[124:127], a[84:87], v[180:183], v[124:127]
  s_add_u32 s30, s30, s25
  ds_read_b128 v[164:167], v16 offset:2048
  v_mfma_f32_16x16x32_bf16 v[128:131], a[88:91], v[180:183], v[128:131]
  v_mfma_f32_16x16x32_bf16 v[132:135], a[92:95], v[180:183], v[132:135]
  s_waitcnt lgkmcnt(3)
  v_mfma_f32_16x16x32_bf16 v[136:139], a[84:87], v[184:187], v[136:139]
  ds_read_b128 v[168:171], v16 offset:4096
  v_mfma_f32_16x16x32_bf16 v[140:143], a[88:91], v[184:187], v[140:143]
  v_mfma_f32_16x16x32_bf16 v[144:147], a[92:95], v[184:187], v[144:147]
  s_waitcnt lgkmcnt(3)
  v_mfma_f32_16x16x32_bf16 v[148:151], a[84:87], v[188:191], v[148:151]
  ds_read_b128 v[172:175], v16 offset:6144
  v_mfma_f32_16x16x32_bf16 v[152:155], a[88:91], v[188:191], v[152:155]
  v_mfma_f32_16x16x32_bf16 v[156:159], a[92:95], v[188:191], v[156:159]
  s_waitcnt lgkmcnt(3)
  v_mfma_f32_16x16x32_bf16 v[64:67], a[96:99], v[160:163], v[64:67]
  ds_read_b128 v[176:179], v16 offset:8192
  v_mfma_f32_16x16x32_bf16 v[68:71], a[100:103], v[160:163], v[68:71]
  s_add_u32 m0, s31, 0
  v_mfma_f32_16x16x32_bf16 v[72:75], a[104:107], v[160:163], v[72:75]
  s_waitcnt lgkmcnt(3)
  buffer_load_dwordx4 v10, s[8:11], s30 offen lds
  v_mfma_f32_16x16x32_bf16 v[76:79], a[96:99], v[164:167], v[76:79]
  ds_read_b128 v[180:183], v16 offset:10240
  v_mfma_f32_16x16x32_bf16 v[80:83], a[100:103], v[164:167], v[80:83]
  v_mfma_f32_16x16x32_bf16 v[84:87], a[104:107], v[164:167], v[84:87]
  s_waitcnt lgkmcnt(3)
  v_mfma_f32_16x16x32_bf16 v[88:91], a[96:99], v[168:171], v[88:91]
  ds_read_b128 v[184:187], v16 offset:12288
  v_mfma_f32_16x16x32_bf16 v[92:95], a[100:103], v[168:171], v[92:95]
  v_mfma_f32_16x16x32_bf16 v[96:99], a[104:107], v[168:171], v[96:99]
  s_waitcnt lgkmcnt(3)
  v_mfma_f32_16x16x32_bf16 v[100:103], a[96:99], v[172:175], v[100:103]
  ds_read_b128 v[188:191], v16 offset:14336
  v_mfma_f32_16x16x32_bf16 v[104:107], a[100:103], v[172:175], v[104:107]
  v_mfma_f32_16x16x32_bf16 v[108:111], a[104:107], v[172:175], v[108:111]
  s_waitcnt lgkmcnt(3)
  v_mfma_f32_16x16x32_bf16 v[112:115], a[96:99], v[176:179], v[112:115]
  ds_read_b128 v[160:163], v17 offset:0
  v_mfma_f32_16x16x32_bf16 v[116:119], a[100:103], v[176:179], v[116:119]
  s_add_u32 m0, s31, 1024
  v_mfma_f32_16x16x32_bf16 v[120:123], a[104:107], v[176:179], v[120:123]
  s_waitcnt lgkmcnt(3)
  buffer_load_dwordx4 v11, s[8:11], s30 offen lds
  v_mfma_f32_16x16x32_bf16 v[124:127], a[96:99], v[180:183], v[124:127]
  ds_read_b128 v[164:167], v17 offset:2048
  v_mfma_f32_16x16x32_bf16 v[128:131], a[100:103], v[180:183], v[128:131]
  v_mfma_f32_16x16x32_bf16 v[132:135], a[104:107], v[180:183], v[132:135]
  s_waitcnt lgkmcnt(3)
  v_mfma_f32_16x16x32_bf16 v[136:139], a[96:99], v[184:187], v[136:139]
  ds_read_b128 v[168:171], v17 offset:4096
  v_mfma_f32_16x16x32_bf16 v[140:143], a[100:103], v[184:187], v[140:143]
  v_mfma_f32_16x16x32_bf16 v[144:147], a[104:107], v[184:187], v[144:147]
  s_waitcnt lgkmcnt(3)
  v_mfma_f32_16x16x32_bf16 v[148:151], a[96:99], v[188:191], v[148:151]
  ds_read_b128 v[172:175], v17 offset:6144
  v_mfma_f32_16x16x32_bf16 v[152:155], a[100:103], v[188:191], v[152:155]
  v_mfma_f32_16x16x32_bf16 v[156:159], a[104:107], v[188:191], v[156:159]
  s_waitcnt lgkmcnt(3)
  v_mfma_f32_16x16x32_bf16 v[64:67], a[108:111], v[160:163], v[64:67]
  ds_read_b128 v[176:179], v17 offset:8192
  v_mfma_f32_16x16x32_bf16 v[68:71], a[112:115], v[160:163], v[68:71]
  s_add_u32 m0, s31, 2048
  v_mfma_f32_16x16x32_bf16 v[72:75], a[116:119], v[160:163], v[72:75]
  s_waitcnt lgkmcnt(3)
  buffer_load_dwordx4 v12, s[8:11], s30 offen lds
  v_mfma_f32_16x16x32_bf16 v[76:79], a[108:111], v[164:167], v[76:79]
  ds_read_b128 v[180:183], v17 offset:10240
  v_mfma_f32_16x16x32_bf16 v[80:83], a[112:115], v[164:167], v[80:83]
  v_mfma_f32_16x16x32_bf16 v[84:87], a[116:119], v[164:167], v[84:87]
  s_waitcnt lgkmcnt(3)
  v_mfma_f32_16x16x32_bf16 v[88:91], a[108:111], v[168:171], v[88:91]
  ds_read_b128 v[184:187], v17 offset:12288
  v_mfma_f32_16x16x32_bf16 v[92:95], a[112:115], v[168:171], v[92:95]
  v_mfma_f32_16x16x32_bf16 v[96:99], a[116:119], v[168:171], v[96:99]
  s_waitcnt lgkmcnt(3)
  v_mfma_f32_16x16x32_bf16 v[100:103], a[108:111], v[172:175], v[100:103]
  ds_read_b128 v[188:191], v17 offset:14336
  v_mfma_f32_16x16x32_bf16 v[104:107], a[112:115], v[172:175], v[104:107]
  v_mfma_f32_16x16x32_bf16 v[108:111], a[116:119], v[172:175], v[108:111]
  s_waitcnt lgkmcnt(3)
  v_mfma_f32_16x16x32_bf16 v[112:115], a[108:111], v[176:179], v[112:115]
  ds_read_b128 v[160:163], v16 offset:16384
  v_mfma_f32_16x16x32_bf16 v[116:119], a[112:115], v[176:179], v[116:119]
  s_add_u32 m0, s31, 3072
  v_mfma_f32_16x16x32_bf16 v[120:123], a[116:119], v[176:179], v[120:123]
  s_waitcnt lgkmcnt(3)
  buffer_load_dwordx4 v13, s[8:11], s30 offen lds
  v_mfma_f32_16x16x32_bf16 v[124:127], a[108:111], v[180:183], v[124:127]
  s_add_u32 s30, s30, 128
  ds_read_b128 v[164:167], v16 offset:18432
  v_mfma_f32_16x16x32_bf16 v[128:131], a[112:115], v[180:183], v[128:131]
  v_mfma_f32_16x16x32_bf16 v[132:135], a[116:119], v[180:183], v[132:135]
  s_waitcnt lgkmcnt(3)
  v_mfma_f32_16x16x32_bf16 v[136:139], a[108:111], v[184:187], v[136:139]
  ds_read_b128 v[168:171], v16 offset:20480
  v_mfma_f32_16x16x32_bf16 v[140:143], a[112:115], v[184:187], v[140:143]
  v_mfma_f32_16x16x32_bf16 v[144:147], a[116:119], v[184:187], v[144:147]
  s_waitcnt lgkmcnt(3)
  v_mfma_f32_16x16x32_bf16 v[148:151], a[108:111], v[188:191], v[148:151]
  ds_read_b128 v[172:175], v16 offset:22528
  v_mfma_f32_16x16x32_bf16 v[152:155], a[112:115], v[188:191], v[152:155]
  v_mfma_f32_16x16x32_bf16 v[156:159], a[116:119], v[188:191], v[156:159]
  s_waitcnt lgkmcnt(3)
  v_mfma_f32_16x16x32_bf16 v[64:67], a[120:123], v[160:163], v[64:67]
  ds_read_b128 v[176:179], v16 offset:24576
  v_mfma_f32_16x16x32_bf16 v[68:71], a[124:127], v[160:163], v[68:71]
  s_add_u32 m0, s31, 16384
  v_mfma_f32_16x16x32_bf16 v[72:75], a[128:131], v[160:163], v[72:75]
  s_waitcnt lgkmcnt(3)
  buffer_load_dwordx4 v10, s[8:11], s30 offen lds
  v_mfma_f32_16x16x32_bf16 v[76:79], a[120:123], v[164:167], v[76:79]
  ds_read_b128 v[180:183], v16 offset:26624
  v_mfma_f32_16x16x32_bf16 v[80:83], a[124:127], v[164:167], v[80:83]
  v_mfma_f32_16x16x32_bf16 v[84:87], a[128:131], v[164:167], v[84:87]
  s_waitcnt lgkmcnt(3)
  v_mfma_f32_16x16x32_bf16 v[88:91], a[120:123], v[168:171], v[88:91]
  ds_read_b128 v[184:187], v16 offset:28672
  v_mfma_f32_16x16x32_bf16 v[92:95], a[124:127], v[168:171], v[92:95]
  v_mfma_f32_16x16x32_bf16 v[96:99], a[128:131], v[168:171], v[96:99]
  s_waitcnt lgkmcnt(3)
  v_mfma_f32_16x16x32_bf16 v[100:103], a[120:123], v[172:175], v[100:103]
  ds_read_b128 v[188:191], v16 offset:30720
  v_mfma_f32_16x16x32_bf16 v[104:107], a[124:127], v[172:175], v[104:107]
  v_mfma_f32_16x16x32_bf16 v[108:111], a[128:131], v[172:175], v[108:111]
  s_waitcnt lgkmcnt(3)
  v_mfma_f32_16x16x32_bf16 v[112:115], a[120:123], v[176:179], v[112:115]
  ds_read_b128 v[160:163], v17 offset:16384
  v_mfma_f32_16x16x32_bf16 v[116:119], a[124:127], v[176:179], v[116:119]
  s_add_u32 m0, s31, 17408
  v_mfma_f32_16x16x32_bf16 v[120:123], a[128:131], v[176:179], v[120:123]
  s_waitcnt lgkmcnt(3)
  buffer_load_dwordx4 v11, s[8:11], s30 offen lds
  v_mfma_f32_16x16x32_bf16 v[124:127], a[120:123], v[180:183], v[124:127]
  ds_read_b128 v[164:167], v17 offset:18432
  v_mfma_f32_16x16x32_bf16 v[128:131], a[124:127], v[180:183], v[128:131]
  v_mfma_f32_16x16x32_bf16 v[132:135], a[128:131], v[180:183], v[132:135]
  s_waitcnt lgkmcnt(3)
  v_mfma_f32_16x16x32_bf16 v[136:139], a[120:123], v[184:187], v[136:139]
  ds_read_b128 v[168:171], v17 offset:20480
  v_mfma_f32_16x16x32_bf16 v[140:143], a[124:127], v[184:187], v[140:143]
  v_mfma_f32_16x16x32_bf16 v[144:147], a[128:131], v[184:187], v[144:147]
  s_waitcnt lgkmcnt(3)
  v_mfma_f32_16x16x32_bf16 v[148:151], a[120:123], v[188:191], v[148:151]
  ds_read_b128 v[172:175], v17 offset:22528
  v_mfma_f32_16x16x32_bf16 v[152:155], a[124:127], v[188:191], v[152:155]
  v_mfma_f32_16x16x32_bf16 v[156:159], a[128:131], v[188:191], v[156:159]
  s_waitcnt lgkmcnt(3)
  v_mfma_f32_16x16x32_bf16 v[64:67], a[132:135], v[160:163], v[64:67]
  ds_read_b128 v[176:179], v17 offset:24576
  v_mfma_f32_16x16x32_bf16 v[68:71], a[136:139], v[160:163], v[68:71]
  s_add_u32 m0, s31, 18432
  v_mfma_f32_16x16x32_bf16 v[72:75], a[140:143], v[160:163], v[72:75]
  s_waitcnt lgkmcnt(3)
  buffer_load_dwordx4 v12, s[8:11], s30 offen lds
  v_mfma_f32_16x16x32_bf16 v[76:79], a[132:135], v[164:167], v[76:79]
  ds_read_b128 v[180:183], v17 offset:26624
  v_mfma_f32_16x16x32_bf16 v[80:83], a[136:139], v[164:167], v[80:83]
  v_mfma_f32_16x16x32_bf16 v[84:87], a[140:143], v[164:167], v[84:87]
  s_waitcnt lgkmcnt(3)
  v_mfma_f32_16x16x32_bf16 v[88:91], a[132:135], v[168:171], v[88:91]
  ds_read_b128 v[184:187], v17 offset:28672
  v_mfma_f32_16x16x32_bf16 v[92:95], a[136:139], v[168:171], v[92:95]
  v_mfma_f32_16x16x32_bf16 v[96:99], a[140:143], v[168:171], v[96:99]
  s_waitcnt lgkmcnt(3)
  v_mfma_f32_16x16x32_bf16 v[100:103], a[132:135], v[172:175], v[100:103]
  ds_read_b128 v[188:191], v17 offset:30720
  v_mfma_f32_16x16x32_bf16 v[104:107], a[136:139], v[172:175], v[104:107]
  v_mfma_f32_16x16x32_bf16 v[108:111], a[140:143], v[172:175], v[108:111]
  s_waitcnt lgkmcnt(3)
  v_mfma_f32_16x16x32_bf16 v[112:115], a[132:135], v[176:179], v[112:115]
  s_waitcnt vmcnt(9)
  s_barrier
  ds_read_b128 v[160:163], v16 offset:32768
  v_mfma_f32_16x16x32_bf16 v[116:119], a[136:139], v[176:179], v[116:119]
  s_add_u32 m0, s31, 19456
  v_mfma_f32_16x16x32_bf16 v[120:123], a[140:143], v[176:179], v[120:123]
  s_waitcnt lgkmcnt(3)
  buffer_load_dwordx4 v13, s[8:11], s30 offen lds
  v_mfma_f32_16x16x32_bf16 v[124:127], a[132:135], v[180:183], v[124:127]
  s_add_u32 s30, s30, 128
  ds_read_b128 v[164:167], v16 offset:34816
  v_mfma_f32_16x16x32_bf16 v[128:131], a[136:139], v[180:183], v[128:131]
  v_mfma_f32_16x16x32_bf16 v[132:135], a[140:143], v[180:183], v[132:135]
  s_waitcnt lgkmcnt(3)
  v_mfma_f32_16x16x32_bf16 v[136:139], a[132:135], v[184:187], v[136:139]
  ds_read_b128 v[168:171], v16 offset:36864
  v_mfma_f32_16x16x32_bf16 v[140:143], a[136:139], v[184:187], v[140:143]
  buffer_atomic_add v28, v27, s[72:75], s61 offen sc1
  v_mfma_f32_16x16x32_bf16 v[144:147], a[140:143], v[184:187], v[144:147]
  s_waitcnt lgkmcnt(3)
  s_mov_b32 s48, s27
  s_add_u32 s27, s27, 8388608
  v_mfma_f32_16x16x32_bf16 v[148:151], a[132:135], v[188:191], v[148:151]
  s_mov_b32 s61, s60
  ds_read_b128 v[172:175], v16 offset:38912
  s_add_u32 s60, s60, 4
  v_mfma_f32_16x16x32_bf16 v[152:155], a[136:139], v[188:191], v[152:155]
  v_mfma_f32_16x16x32_bf16 v[156:159], a[140:143], v[188:191], v[156:159]
  s_waitcnt lgkmcnt(3)
  v_mfma_f32_16x16x32_bf16 v[64:67], a[144:147], v[160:163], v[64:67]
  ds_read_b128 v[176:179], v16 offset:40960
  v_mfma_f32_16x16x32_bf16 v[68:71], a[148:151], v[160:163], v[68:71]
  s_add_u32 m0, s31, 32768
  v_mfma_f32_16x16x32_bf16 v[72:75], a[152:155], v[160:163], v[72:75]
  s_waitcnt lgkmcnt(3)
  buffer_load_dwordx4 v10, s[8:11], s30 offen lds
  v_mfma_f32_16x16x32_bf16 v[76:79], a[144:147], v[164:167], v[76:79]
  ds_read_b128 v[180:183], v16 offset:43008
  v_mfma_f32_16x16x32_bf16 v[80:83], a[148:151], v[164:167], v[80:83]
  v_mfma_f32_16x16x32_bf16 v[84:87], a[152:155], v[164:167], v[84:87]
  s_waitcnt lgkmcnt(3)
  v_mfma_f32_16x16x32_bf16 v[88:91], a[144:147], v[168:171], v[88:91]
  ds_read_b128 v[184:187], v16 offset:45056
  v_mfma_f32_16x16x32_bf16 v[92:95], a[148:151], v[168:171], v[92:95]
  v_mfma_f32_16x16x32_bf16 v[96:99], a[152:155], v[168:171], v[96:99]
  s_waitcnt lgkmcnt(3)
  v_mfma_f32_16x16x32_bf16 v[100:103], a[144:147], v[172:175], v[100:103]
  ds_read_b128 v[188:191], v16 offset:47104
  v_mfma_f32_16x16x32_bf16 v[104:107], a[148:151], v[172:175], v[104:107]
  v_mfma_f32_16x16x32_bf16 v[108:111], a[152:155], v[172:175], v[108:111]
  s_waitcnt lgkmcnt(3)
  v_mfma_f32_16x16x32_bf16 v[112:115], a[144:147], v[176:179], v[112:115]
  ds_read_b128 v[160:163], v17 offset:32768
  v_mfma_f32_16x16x32_bf16 v[116:119], a[148:151], v[176:179], v[116:119]
  s_add_u32 m0, s31, 33792
  v_mfma_f32_16x16x32_bf16 v[120:123], a[152:155], v[176:179], v[120:123]
  s_waitcnt lgkmcnt(3)
  buffer_load_dwordx4 v11, s[8:11], s30 offen lds
  v_mfma_f32_16x16x32_bf16 v[124:127], a[144:147], v[180:183], v[124:127]
  ds_read_b128 v[164:167], v17 offset:34816
  v_mfma_f32_16x16x32_bf16 v[128:131], a[148:151], v[180:183], v[128:131]
  v_mfma_f32_16x16x32_bf16 v[132:135], a[152:155], v[180:183], v[132:135]
  s_waitcnt lgkmcnt(3)
  v_mfma_f32_16x16x32_bf16 v[136:139], a[144:147], v[184:187], v[136:139]
  ds_read_b128 v[168:171], v17 offset:36864
  v_mfma_f32_16x16x32_bf16 v[140:143], a[148:151], v[184:187], v[140:143]
  v_mfma_f32_16x16x32_bf16 v[144:147], a[152:155], v[184:187], v[144:147]
  s_waitcnt lgkmcnt(3)
  v_mfma_f32_16x16x32_bf16 v[148:151], a[144:147], v[188:191], v[148:151]
  ds_read_b128 v[172:175], v17 offset:38912
  v_mfma_f32_16x16x32_bf16 v[152:155], a[148:151], v[188:191], v[152:155]
  v_mfma_f32_16x16x32_bf16 v[156:159], a[152:155], v[188:191], v[156:159]
  s_waitcnt lgkmcnt(3)
  v_mfma_f32_16x16x32_bf16 v[64:67], a[156:159], v[160:163], v[64:67]
  ds_read_b128 v[176:179], v17 offset:40960
  v_mfma_f32_16x16x32_bf16 v[68:71], a[160:163], v[160:163], v[68:71]
  s_add_u32 m0, s31, 34816
  v_mfma_f32_16x16x32_bf16 v[72:75], a[164:167], v[160:163], v[72:75]
  s_waitcnt lgkmcnt(3)
  buffer_load_dwordx4 v12, s[8:11], s30 offen lds
  v_mfma_f32_16x16x32_bf16 v[76:79], a[156:159], v[164:167], v[76:79]
  ds_read_b128 v[180:183], v17 offset:43008
  v_mfma_f32_16x16x32_bf16 v[80:83], a[160:163], v[164:167], v[80:83]
  v_mfma_f32_16x16x32_bf16 v[84:87], a[164:167], v[164:167], v[84:87]
  s_waitcnt lgkmcnt(3)
  v_mfma_f32_16x16x32_bf16 v[88:91], a[156:159], v[168:171], v[88:91]
  ds_read_b128 v[184:187], v17 offset:45056
  v_mfma_f32_16x16x32_bf16 v[92:95], a[160:163], v[168:171], v[92:95]
  v_mfma_f32_16x16x32_bf16 v[96:99], a[164:167], v[168:171], v[96:99]
  s_waitcnt lgkmcnt(3)
  v_mfma_f32_16x16x32_bf16 v[100:103], a[156:159], v[172:175], v[100:103]
  ds_read_b128 v[188:191], v17 offset:47104
  v_mfma_f32_16x16x32_bf16 v[104:107], a[160:163], v[172:175], v[104:107]
  v_mfma_f32_16x16x32_bf16 v[108:111], a[164:167], v[172:175], v[108:111]
  s_waitcnt lgkmcnt(3)
  v_mfma_f32_16x16x32_bf16 v[112:115], a[156:159], v[176:179], v[112:115]
  ds_read_b128 v[160:163], v16 offset:49152
  v_mfma_f32_16x16x32_bf16 v[116:119], a[160:163], v[176:179], v[116:119]
  s_add_u32 m0, s31, 35840
  v_mfma_f32_16x16x32_bf16 v[120:123], a[164:167], v[176:179], v[120:123]
  s_waitcnt lgkmcnt(3)
  buffer_load_dwordx4 v13, s[8:11], s30 offen lds
  v_mfma_f32_16x16x32_bf16 v[124:127], a[156:159], v[180:183], v[124:127]
  s_add_u32 s30, s30, 128
  ds_read_b128 v[164:167], v16 offset:51200
  v_mfma_f32_16x16x32_bf16 v[128:131], a[160:163], v[180:183], v[128:131]
  v_mfma_f32_16x16x32_bf16 v[132:135], a[164:167], v[180:183], v[132:135]
  s_waitcnt lgkmcnt(3)
  v_mfma_f32_16x16x32_bf16 v[136:139], a[156:159], v[184:187], v[136:139]
  ds_read_b128 v[168:171], v16 offset:53248
  v_mfma_f32_16x16x32_bf16 v[140:143], a[160:163], v[184:187], v[140:143]
  v_mfma_f32_16x16x32_bf16 v[144:147], a[164:167], v[184:187], v[144:147]
  s_waitcnt lgkmcnt(3)
  v_mfma_f32_16x16x32_bf16 v[148:151], a[156:159], v[188:191], v[148:151]
  ds_read_b128 v[172:175], v16 offset:55296
  v_mfma_f32_16x16x32_bf16 v[152:155], a[160:163], v[188:191], v[152:155]
  v_mfma_f32_16x16x32_bf16 v[156:159], a[164:167], v[188:191], v[156:159]
  s_waitcnt lgkmcnt(3)
  v_mfma_f32_16x16x32_bf16 v[64:67], a[168:171], v[160:163], v[64:67]
  ds_read_b128 v[176:179], v16 offset:57344
  v_mfma_f32_16x16x32_bf16 v[68:71], a[172:175], v[160:163], v[68:71]
  s_add_u32 m0, s31, 49152
  v_mfma_f32_16x16x32_bf16 v[72:75], a[176:179], v[160:163], v[72:75]
  s_waitcnt lgkmcnt(3)
  buffer_load_dwordx4 v10, s[8:11], s30 offen lds
  v_mfma_f32_16x16x32_bf16 v[76:79], a[168:171], v[164:167], v[76:79]
  ds_read_b128 v[180:183], v16 offset:59392
  v_mfma_f32_16x16x32_bf16 v[80:83], a[172:175], v[164:167], v[80:83]
  v_mfma_f32_16x16x32_bf16 v[84:87], a[176:179], v[164:167], v[84:87]
  s_waitcnt lgkmcnt(3)
  v_mfma_f32_16x16x32_bf16 v[88:91], a[168:171], v[168:171], v[88:91]
  ds_read_b128 v[184:187], v16 offset:61440
  v_mfma_f32_16x16x32_bf16 v[92:95], a[172:175], v[168:171], v[92:95]
  v_mfma_f32_16x16x32_bf16 v[96:99], a[176:179], v[168:171], v[96:99]
  s_waitcnt lgkmcnt(3)
  v_mfma_f32_16x16x32_bf16 v[100:103], a[168:171], v[172:175], v[100:103]
  ds_read_b128 v[188:191], v16 offset:63488
  v_mfma_f32_16x16x32_bf16 v[104:107], a[172:175], v[172:175], v[104:107]
  v_mfma_f32_16x16x32_bf16 v[108:111], a[176:179], v[172:175], v[108:111]
  s_waitcnt lgkmcnt(3)
  v_mfma_f32_16x16x32_bf16 v[112:115], a[168:171], v[176:179], v[112:115]
  ds_read_b128 v[160:163], v17 offset:49152
  v_mfma_f32_16x16x32_bf16 v[116:119], a[172:175], v[176:179], v[116:119]
  s_add_u32 m0, s31, 50176
  v_mfma_f32_16x16x32_bf16 v[120:123], a[176:179], v[176:179], v[120:123]
  s_waitcnt lgkmcnt(3)
  buffer_load_dwordx4 v11, s[8:11], s30 offen lds
  v_mfma_f32_16x16x32_bf16 v[124:127], a[168:171], v[180:183], v[124:127]
  ds_read_b128 v[164:167], v17 offset:51200
  v_mfma_f32_16x16x32_bf16 v[128:131], a[172:175], v[180:183], v[128:131]
  v_mfma_f32_16x16x32_bf16 v[132:135], a[176:179], v[180:183], v[132:135]
  s_waitcnt lgkmcnt(3)
  v_mfma_f32_16x16x32_bf16 v[136:139], a[168:171], v[184:187], v[136:139]
  ds_read_b128 v[168:171], v17 offset:53248
  v_mfma_f32_16x16x32_bf16 v[140:143], a[172:175], v[184:187], v[140:143]
  v_mfma_f32_16x16x32_bf16 v[144:147], a[176:179], v[184:187], v[144:147]
  s_waitcnt lgkmcnt(3)
  v_mfma_f32_16x16x32_bf16 v[148:151], a[168:171], v[188:191], v[148:151]
  ds_read_b128 v[172:175], v17 offset:55296
  v_mfma_f32_16x16x32_bf16 v[152:155], a[172:175], v[188:191], v[152:155]
  v_mfma_f32_16x16x32_bf16 v[156:159], a[176:179], v[188:191], v[156:159]
  s_waitcnt lgkmcnt(3)
  v_mfma_f32_16x16x32_bf16 v[64:67], a[180:183], v[160:163], v[64:67]
  ds_read_b128 v[176:179], v17 offset:57344
  v_mfma_f32_16x16x32_bf16 v[68:71], a[184:187], v[160:163], v[68:71]
  s_add_u32 m0, s31, 51200
  v_mfma_f32_16x16x32_bf16 v[72:75], a[188:191], v[160:163], v[72:75]
  s_waitcnt lgkmcnt(3)
  buffer_load_dwordx4 v12, s[8:11], s30 offen lds
  v_mfma_f32_16x16x32_bf16 v[76:79], a[180:183], v[164:167], v[76:79]
  ds_read_b128 v[180:183], v17 offset:59392
  v_mfma_f32_16x16x32_bf16 v[80:83], a[184:187], v[164:167], v[80:83]
  v_mfma_f32_16x16x32_bf16 v[84:87], a[188:191], v[164:167], v[84:87]
  s_waitcnt lgkmcnt(3)
  v_mfma_f32_16x16x32_bf16 v[88:91], a[180:183], v[168:171], v[88:91]
  ds_read_b128 v[184:187], v17 offset:61440
  v_mfma_f32_16x16x32_bf16 v[92:95], a[184:187], v[168:171], v[92:95]
  v_mfma_f32_16x16x32_bf16 v[96:99], a[188:191], v[168:171], v[96:99]
  s_waitcnt lgkmcnt(3)
  v_mfma_f32_16x16x32_bf16 v[100:103], a[180:183], v[172:175], v[100:103]
  ds_read_b128 v[188:191], v17 offset:63488
  v_mfma_f32_16x16x32_bf16 v[104:107], a[184:187], v[172:175], v[104:107]
  v_mfma_f32_16x16x32_bf16 v[108:111], a[188:191], v[172:175], v[108:111]
  s_waitcnt lgkmcnt(3)
  v_mfma_f32_16x16x32_bf16 v[112:115], a[180:183], v[176:179], v[112:115]
  s_waitcnt vmcnt(16)
  s_barrier
  ds_read_b128 v[160:163], v18 offset:0
  v_mfma_f32_16x16x32_bf16 v[116:119], a[184:187], v[176:179], v[116:119]
  s_add_u32 m0, s31, 52224
  v_mfma_f32_16x16x32_bf16 v[120:123], a[188:191], v[176:179], v[120:123]
  s_waitcnt lgkmcnt(3)
  buffer_load_dwordx4 v13, s[8:11], s30 offen lds
  v_mfma_f32_16x16x32_bf16 v[124:127], a[180:183], v[180:183], v[124:127]
  s_add_u32 s30, s30, 128
  ds_read_b128 v[164:167], v18 offset:2048
  v_mfma_f32_16x16x32_bf16 v[128:131], a[184:187], v[180:183], v[128:131]
  v_mfma_f32_16x16x32_bf16 v[132:135], a[188:191], v[180:183], v[132:135]
  s_waitcnt lgkmcnt(3)
  v_mfma_f32_16x16x32_bf16 v[136:139], a[180:183], v[184:187], v[136:139]
  ds_read_b128 v[168:171], v18 offset:4096
  v_mfma_f32_16x16x32_bf16 v[140:143], a[184:187], v[184:187], v[140:143]
  v_mfma_f32_16x16x32_bf16 v[144:147], a[188:191], v[184:187], v[144:147]
  s_waitcnt lgkmcnt(3)
  v_mfma_f32_16x16x32_bf16 v[148:151], a[180:183], v[188:191], v[148:151]
  ds_read_b128 v[172:175], v18 offset:6144
  v_mfma_f32_16x16x32_bf16 v[152:155], a[184:187], v[188:191], v[152:155]
  v_mfma_f32_16x16x32_bf16 v[156:159], a[188:191], v[188:191], v[156:159]
  s_waitcnt lgkmcnt(3)
  v_mfma_f32_16x16x32_bf16 v[64:67], a[192:195], v[160:163], v[64:67]
  ds_read_b128 v[176:179], v18 offset:8192
  v_mfma_f32_16x16x32_bf16 v[68:71], a[196:199], v[160:163], v[68:71]
  s_add_u32 m0, s31, 65536
  v_mfma_f32_16x16x32_bf16 v[72:75], a[200:203], v[160:163], v[72:75]
  s_waitcnt lgkmcnt(3)
  buffer_load_dwordx4 v10, s[8:11], s30 offen lds
  v_mfma_f32_16x16x32_bf16 v[76:79], a[192:195], v[164:167], v[76:79]
  ds_read_b128 v[180:183], v18 offset:10240
  v_mfma_f32_16x16x32_bf16 v[80:83], a[196:199], v[164:167], v[80:83]
  v_mfma_f32_16x16x32_bf16 v[84:87], a[200:203], v[164:167], v[84:87]
  s_waitcnt lgkmcnt(3)
  v_mfma_f32_16x16x32_bf16 v[88:91], a[192:195], v[168:171], v[88:91]
  ds_read_b128 v[184:187], v18 offset:12288
  v_mfma_f32_16x16x32_bf16 v[92:95], a[196:199], v[168:171], v[92:95]
  v_mfma_f32_16x16x32_bf16 v[96:99], a[200:203], v[168:171], v[96:99]
  s_waitcnt lgkmcnt(3)
  v_mfma_f32_16x16x32_bf16 v[100:103], a[192:195], v[172:175], v[100:103]
  ds_read_b128 v[188:191], v18 offset:14336
  v_mfma_f32_16x16x32_bf16 v[104:107], a[196:199], v[172:175], v[104:107]
  v_mfma_f32_16x16x32_bf16 v[108:111], a[200:203], v[172:175], v[108:111]
  s_waitcnt lgkmcnt(3)
  v_mfma_f32_16x16x32_bf16 v[112:115], a[192:195], v[176:179], v[112:115]
  ds_read_b128 v[160:163], v19 offset:0
  v_mfma_f32_16x16x32_bf16 v[116:119], a[196:199], v[176:179], v[116:119]
  s_add_u32 m0, s31, 66560
  v_mfma_f32_16x16x32_bf16 v[120:123], a[200:203], v[176:179], v[120:123]
  s_waitcnt lgkmcnt(3)
  buffer_load_dwordx4 v11, s[8:11], s30 offen lds
  v_mfma_f32_16x16x32_bf16 v[124:127], a[192:195], v[180:183], v[124:127]
  ds_read_b128 v[164:167], v19 offset:2048
  v_mfma_f32_16x16x32_bf16 v[128:131], a[196:199], v[180:183], v[128:131]
  v_mfma_f32_16x16x32_bf16 v[132:135], a[200:203], v[180:183], v[132:135]
  s_waitcnt lgkmcnt(3)
  v_mfma_f32_16x16x32_bf16 v[136:139], a[192:195], v[184:187], v[136:139]
  ds_read_b128 v[168:171], v19 offset:4096
  v_mfma_f32_16x16x32_bf16 v[140:143], a[196:199], v[184:187], v[140:143]
  v_mfma_f32_16x16x32_bf16 v[144:147], a[200:203], v[184:187], v[144:147]
  s_waitcnt lgkmcnt(3)
  v_mfma_f32_16x16x32_bf16 v[148:151], a[192:195], v[188:191], v[148:151]
  ds_read_b128 v[172:175], v19 offset:6144
  v_mfma_f32_16x16x32_bf16 v[152:155], a[196:199], v[188:191], v[152:155]
  v_mfma_f32_16x16x32_bf16 v[156:159], a[200:203], v[188:191], v[156:159]
  s_waitcnt lgkmcnt(3)
  v_mfma_f32_16x16x32_bf16 v[64:67], a[204:207], v[160:163], v[64:67]
  ds_read_b128 v[176:179], v19 offset:8192
  v_mfma_f32_16x16x32_bf16 v[68:71], a[208:211], v[160:163], v[68:71]
  s_add_u32 m0, s31, 67584
  v_mfma_f32_16x16x32_bf16 v[72:75], a[212:215], v[160:163], v[72:75]
  s_waitcnt lgkmcnt(3)
  buffer_load_dwordx4 v12, s[8:11], s30 offen lds
  v_mfma_f32_16x16x32_bf16 v[76:79], a[204:207], v[164:167], v[76:79]
  ds_read_b128 v[180:183], v19 offset:10240
  v_mfma_f32_16x16x32_bf16 v[80:83], a[208:211], v[164:167], v[80:83]
  v_mfma_f32_16x16x32_bf16 v[84:87], a[212:215], v[164:167], v[84:87]
  s_waitcnt lgkmcnt(3)
  v_mfma_f32_16x16x32_bf16 v[88:91], a[204:207], v[168:171], v[88:91]
  ds_read_b128 v[184:187], v19 offset:12288
  v_mfma_f32_16x16x32_bf16 v[92:95], a[208:211], v[168:171], v[92:95]
  v_mfma_f32_16x16x32_bf16 v[96:99], a[212:215], v[168:171], v[96:99]
  s_waitcnt lgkmcnt(3)
  v_mfma_f32_16x16x32_bf16 v[100:103], a[204:207], v[172:175], v[100:103]
  ds_read_b128 v[188:191], v19 offset:14336
  v_mfma_f32_16x16x32_bf16 v[104:107], a[208:211], v[172:175], v[104:107]
  v_mfma_f32_16x16x32_bf16 v[108:111], a[212:215], v[172:175], v[108:111]
  s_waitcnt lgkmcnt(3)
  v_mfma_f32_16x16x32_bf16 v[112:115], a[204:207], v[176:179], v[112:115]
  ds_read_b128 v[160:163], v18 offset:16384
  v_mfma_f32_16x16x32_bf16 v[116:119], a[208:211], v[176:179], v[116:119]
  s_add_u32 m0, s31, 68608
  v_mfma_f32_16x16x32_bf16 v[120:123], a[212:215], v[176:179], v[120:123]
  s_waitcnt lgkmcnt(3)
  buffer_load_dwordx4 v13, s[8:11], s30 offen lds
  v_mfma_f32_16x16x32_bf16 v[124:127], a[204:207], v[180:183], v[124:127]
  s_add_u32 s30, s30, 128
  ds_read_b128 v[164:167], v18 offset:18432
  v_mfma_f32_16x16x32_bf16 v[128:131], a[208:211], v[180:183], v[128:131]
  v_mfma_f32_16x16x32_bf16 v[132:135], a[212:215], v[180:183], v[132:135]
  s_waitcnt lgkmcnt(3)
  v_mfma_f32_16x16x32_bf16 v[136:139], a[204:207], v[184:187], v[136:139]
  ds_read_b128 v[168:171], v18 offset:20480
  v_mfma_f32_16x16x32_bf16 v[140:143], a[208:211], v[184:187], v[140:143]
  v_mfma_f32_16x16x32_bf16 v[144:147], a[212:215], v[184:187], v[144:147]
  s_waitcnt lgkmcnt(3)
  v_mfma_f32_16x16x32_bf16 v[148:151], a[204:207], v[188:191], v[148:151]
  ds_read_b128 v[172:175], v18 offset:22528
  v_mfma_f32_16x16x32_bf16 v[152:155], a[208:211], v[188:191], v[152:155]
  v_mfma_f32_16x16x32_bf16 v[156:159], a[212:215], v[188:191], v[156:159]
  s_waitcnt lgkmcnt(3)
  v_mfma_f32_16x16x32_bf16 v[64:67], a[216:219], v[160:163], v[64:67]
  ds_read_b128 v[176:179], v18 offset:24576
  v_mfma_f32_16x16x32_bf16 v[68:71], a[220:223], v[160:163], v[68:71]
  s_add_u32 m0, s31, 81920
  v_mfma_f32_16x16x32_bf16 v[72:75], a[224:227], v[160:163], v[72:75]
  s_waitcnt lgkmcnt(3)
  buffer_load_dwordx4 v10, s[8:11], s30 offen lds
  v_mfma_f32_16x16x32_bf16 v[76:79], a[216:219], v[164:167], v[76:79]
  ds_read_b128 v[180:183], v18 offset:26624
  v_mfma_f32_16x16x32_bf16 v[80:83], a[220:223], v[164:167], v[80:83]
  v_mfma_f32_16x16x32_bf16 v[84:87], a[224:227], v[164:167], v[84:87]
  s_waitcnt lgkmcnt(3)
  v_mfma_f32_16x16x32_bf16 v[88:91], a[216:219], v[168:171], v[88:91]
  ds_read_b128 v[184:187], v18 offset:28672
  v_mfma_f32_16x16x32_bf16 v[92:95], a[220:223], v[168:171], v[92:95]
  s_add_u32 m0, s31, 82944
  v_mfma_f32_16x16x32_bf16 v[96:99], a[224:227], v[168:171], v[96:99]
  s_waitcnt lgkmcnt(3)
  buffer_load_dwordx4 v11, s[8:11], s30 offen lds
  v_mfma_f32_16x16x32_bf16 v[100:103], a[216:219], v[172:175], v[100:103]
  ds_read_b128 v[188:191], v18 offset:30720
  v_mfma_f32_16x16x32_bf16 v[104:107], a[220:223], v[172:175], v[104:107]
  v_mfma_f32_16x16x32_bf16 v[108:111], a[224:227], v[172:175], v[108:111]
  s_waitcnt lgkmcnt(3)
  v_mfma_f32_16x16x32_bf16 v[112:115], a[216:219], v[176:179], v[112:115]
  ds_read_b128 v[160:163], v19 offset:16384
  v_mfma_f32_16x16x32_bf16 v[116:119], a[220:223], v[176:179], v[116:119]
  s_add_u32 m0, s31, 83968
  v_mfma_f32_16x16x32_bf16 v[120:123], a[224:227], v[176:179], v[120:123]
  s_waitcnt lgkmcnt(3)
  buffer_load_dwordx4 v12, s[8:11], s30 offen lds
  v_mfma_f32_16x16x32_bf16 v[124:127], a[216:219], v[180:183], v[124:127]
  ds_read_b128 v[164:167], v19 offset:18432
  v_mfma_f32_16x16x32_bf16 v[128:131], a[220:223], v[180:183], v[128:131]
  v_mfma_f32_16x16x32_bf16 v[132:135], a[224:227], v[180:183], v[132:135]
  s_waitcnt lgkmcnt(3)
  v_mfma_f32_16x16x32_bf16 v[136:139], a[216:219], v[184:187], v[136:139]
  ds_read_b128 v[168:171], v19 offset:20480
  v_mfma_f32_16x16x32_bf16 v[140:143], a[220:223], v[184:187], v[140:143]
  s_add_u32 m0, s31, 84992
  v_mfma_f32_16x16x32_bf16 v[144:147], a[224:227], v[184:187], v[144:147]
  s_waitcnt lgkmcnt(3)
  buffer_load_dwordx4 v13, s[8:11], s30 offen lds
  v_mfma_f32_16x16x32_bf16 v[148:151], a[216:219], v[188:191], v[148:151]
  s_add_u32 s30, s30, 128
  ds_read_b128 v[172:175], v19 offset:22528
  v_mfma_f32_16x16x32_bf16 v[152:155], a[220:223], v[188:191], v[152:155]
  v_mfma_f32_16x16x32_bf16 v[156:159], a[224:227], v[188:191], v[156:159]
  s_waitcnt lgkmcnt(3)
  v_mfma_f32_16x16x32_bf16 v[64:67], a[228:231], v[160:163], v[64:67]
  ds_read_b128 v[176:179], v19 offset:24576
  v_mfma_f32_16x16x32_bf16 v[68:71], a[232:235], v[160:163], v[68:71]
  v_mfma_f32_16x16x32_bf16 v[72:75], a[236:239], v[160:163], v[72:75]
  s_waitcnt lgkmcnt(3)
  v_mfma_f32_16x16x32_bf16 v[76:79], a[228:231], v[164:167], v[76:79]
  ds_read_b128 v[180:183], v19 offset:26624
  v_cvt_pk_bf16_f32 v192, v64, v65
  v_mfma_f32_16x16x32_bf16 v[80:83], a[232:235], v[164:167], v[80:83]
  v_cvt_pk_bf16_f32 v193, v66, v67
  v_cvt_pk_bf16_f32 v194, v68, v69
  v_mfma_f32_16x16x32_bf16 v[84:87], a[236:239], v[164:167], v[84:87]
  s_waitcnt lgkmcnt(3)
  v_cvt_pk_bf16_f32 v195, v70, v71
  v_cvt_pk_bf16_f32 v200, v72, v73
  v_mfma_f32_16x16x32_bf16 v[88:91], a[228:231], v[168:171], v[88:91]
  ds_read_b128 v[184:187], v19 offset:28672
  v_cvt_pk_bf16_f32 v201, v74, v75
  v_mfma_f32_16x16x32_bf16 v[92:95], a[232:235], v[168:171], v[92:95]
  v_cvt_pk_bf16_f32 v196, v76, v77
  v_cvt_pk_bf16_f32 v197, v78, v79
  v_mfma_f32_16x16x32_bf16 v[96:99], a[236:239], v[168:171], v[96:99]
  s_waitcnt lgkmcnt(3)
  v_cvt_pk_bf16_f32 v198, v80, v81
  v_cvt_pk_bf16_f32 v199, v82, v83
  v_mfma_f32_16x16x32_bf16 v[100:103], a[228:231], v[172:175], v[100:103]
  ds_read_b128 v[188:191], v19 offset:30720
  v_cvt_pk_bf16_f32 v202, v84, v85
  v_mfma_f32_16x16x32_bf16 v[104:107], a[232:235], v[172:175], v[104:107]
  v_cvt_pk_bf16_f32 v203, v86, v87
  v_cvt_pk_bf16_f32 v204, v88, v89
  v_mfma_f32_16x16x32_bf16 v[108:111], a[236:239], v[172:175], v[108:111]
  s_waitcnt lgkmcnt(3)
  v_cvt_pk_bf16_f32 v205, v90, v91
  v_cvt_pk_bf16_f32 v206, v92, v93
  v_mfma_f32_16x16x32_bf16 v[112:115], a[228:231], v[176:179], v[112:115]
  s_waitcnt vmcnt(17)
  s_barrier
  ds_read_b128 v[160:163], v14 offset:0
  v_mfma_f32_16x16x32_bf16 v[116:119], a[232:235], v[176:179], v[116:119]
  v_cvt_pk_bf16_f32 v207, v94, v95
  v_cvt_pk_bf16_f32 v212, v96, v97
  v_mfma_f32_16x16x32_bf16 v[120:123], a[236:239], v[176:179], v[120:123]
  s_waitcnt lgkmcnt(3)
  v_cvt_pk_bf16_f32 v213, v98, v99
  v_cvt_pk_bf16_f32 v208, v100, v101
  v_mfma_f32_16x16x32_bf16 v[124:127], a[228:231], v[180:183], v[124:127]
  ds_read_b128 v[164:167], v14 offset:2048
  v_cvt_pk_bf16_f32 v209, v102, v103
  v_mfma_f32_16x16x32_bf16 v[128:131], a[232:235], v[180:183], v[128:131]
  v_cvt_pk_bf16_f32 v210, v104, v105
  v_cvt_pk_bf16_f32 v211, v106, v107
  v_mfma_f32_16x16x32_bf16 v[132:135], a[236:239], v[180:183], v[132:135]
  s_waitcnt lgkmcnt(3)
  v_cvt_pk_bf16_f32 v214, v108, v109
  v_cvt_pk_bf16_f32 v215, v110, v111
  v_mfma_f32_16x16x32_bf16 v[136:139], a[228:231], v[184:187], v[136:139]
  ds_read_b128 v[168:171], v14 offset:4096
  v_cvt_pk_bf16_f32 v216, v112, v113
  v_mfma_f32_16x16x32_bf16 v[140:143], a[232:235], v[184:187], v[140:143]
  v_cvt_pk_bf16_f32 v217, v114, v115
  v_cvt_pk_bf16_f32 v218, v116, v117
  v_mfma_f32_16x16x32_bf16 v[144:147], a[236:239], v[184:187], v[144:147]
  s_waitcnt lgkmcnt(3)
  v_cvt_pk_bf16_f32 v219, v118, v119
  v_cvt_pk_bf16_f32 v224, v120, v121
  v_mfma_f32_16x16x32_bf16 v[148:151], a[228:231], v[188:191], v[148:151]
  ds_read_b128 v[172:175], v14 offset:6144
  v_cvt_pk_bf16_f32 v225, v122, v123
  v_mfma_f32_16x16x32_bf16 v[152:155], a[232:235], v[188:191], v[152:155]
  s_sub_u32 s26, s26, 1
  s_cmp_gt_u32 s26, 0
  v_cvt_pk_bf16_f32 v220, v124, v125
  v_mfma_f32_16x16x32_bf16 v[156:159], a[236:239], v[188:191], v[156:159]
  s_waitcnt lgkmcnt(3)
  s_cbranch_scc1 kvs_205
  s_nop 7
  v_cvt_pk_bf16_f32 v221, v126, v127
  v_cvt_pk_bf16_f32 v222, v128, v129
  v_cvt_pk_bf16_f32 v223, v130, v131
  v_cvt_pk_bf16_f32 v226, v132, v133
  v_cvt_pk_bf16_f32 v227, v134, v135
  v_cvt_pk_bf16_f32 v228, v136, v137
  v_cvt_pk_bf16_f32 v229, v138, v139
  v_cvt_pk_bf16_f32 v230, v140, v141
  v_cvt_pk_bf16_f32 v231, v142, v143
  v_cvt_pk_bf16_f32 v236, v144, v145
  v_cvt_pk_bf16_f32 v237, v146, v147
  v_cvt_pk_bf16_f32 v232, v148, v149
  v_cvt_pk_bf16_f32 v233, v150, v151
  v_cvt_pk_bf16_f32 v234, v152, v153
  v_cvt_pk_bf16_f32 v235, v154, v155
  v_cvt_pk_bf16_f32 v238, v156, v157
  v_cvt_pk_bf16_f32 v239, v158, v159
  s_xor_b32 s29, s48, 0
  buffer_store_dwordx4 v[192:195], v26, s[16:19], s29 offen offset:0 sc1
  buffer_store_dwordx4 v[196:199], v26, s[16:19], s29 offen offset:1024 sc1
  buffer_store_dwordx4 v[200:203], v26, s[16:19], s29 offen offset:2048 sc1
  s_xor_b32 s29, s48, 2105344
  buffer_store_dwordx4 v[204:207], v26, s[16:19], s29 offen offset:0 sc1
  buffer_store_dwordx4 v[208:211], v26, s[16:19], s29 offen offset:1024 sc1
  buffer_store_dwordx4 v[212:215], v26, s[16:19], s29 offen offset:2048 sc1
  s_xor_b32 s29, s48, 4194304
  buffer_store_dwordx4 v[216:219], v26, s[16:19], s29 offen offset:0 sc1
  buffer_store_dwordx4 v[220:223], v26, s[16:19], s29 offen offset:1024 sc1
  buffer_store_dwordx4 v[224:227], v26, s[16:19], s29 offen offset:2048 sc1
  s_xor_b32 s29, s48, 6299648
  buffer_store_dwordx4 v[228:231], v26, s[16:19], s29 offen offset:0 sc1
  buffer_store_dwordx4 v[232:235], v26, s[16:19], s29 offen offset:1024 sc1
  buffer_store_dwordx4 v[236:239], v26, s[16:19], s29 offen offset:2048 sc1
  s_waitcnt vmcnt(0) lgkmcnt(0)
  s_barrier
  buffer_atomic_add v28, v27, s[72:75], s61 offen sc1
  s_bitcmp1_b32 s3, 0
  s_cbranch_scc1 queue
  s_lshr_b32 s2, s3, 1
  s_mov_b32 s40, 13
  s_mov_b32 s41, 3
  s_waitcnt vmcnt(0)
  s_barrier
  s_branch q_entry
  s_branch queue
not_kv:
  s_cmp_ge_u32 s3, 96
  s_cbranch_scc1 not_vw
  s_sub_u32 s2, s3, 64
  s_load_dwordx2 s[6:7], s[0:1], 40
  s_load_dwordx2 s[38:39], s[0:1], 104
  v_lshlrev_b32 v4, 4, v1
  s_waitcnt lgkmcnt(0)
  s_mov_b32 s12, s6
  s_mov_b32 s13, s7
  s_mov_b32 s14, 7864320
  s_mov_b32 s15, 0x00020000
  s_mov_b32 s16, s38
  s_mov_b32 s17, s39
  s_mov_b32 s18, 171966464
  s_mov_b32 s19, 0x00020000
  s_add_u32 s72, s38, 173080576
  s_addc_u32 s73, s39, 0
  s_mov_b32 s74, 49152
  s_mov_b32 s75, 0x00020000
  s_mul_i32 s40, s2, 245760
  s_mul_i32 s22, s20, 30720
  s_add_u32 s40, s40, s22
  s_add_u32 m0, s22, 0
  s_add_u32 s21, s40, 0
  buffer_load_dwordx4 v4, s[12:15], s21 offen offset:0 lds
  buffer_load_dwordx4 v4, s[12:15], s21 offen offset:1024 lds
  buffer_load_dwordx4 v4, s[12:15], s21 offen offset:2048 lds
  buffer_load_dwordx4 v4, s[12:15], s21 offen offset:3072 lds
  s_add_u32 m0, s22, 4096
  s_add_u32 s21, s40, 4096
  buffer_load_dwordx4 v4, s[12:15], s21 offen offset:0 lds
  buffer_load_dwordx4 v4, s[12:15], s21 offen offset:1024 lds
  buffer_load_dwordx4 v4, s[12:15], s21 offen offset:2048 lds
  buffer_load_dwordx4 v4, s[12:15], s21 offen offset:3072 lds
  s_add_u32 m0, s22, 8192
  s_add_u32 s21, s40, 8192
  buffer_load_dwordx4 v4, s[12:15], s21 offen offset:0 lds
  buffer_load_dwordx4 v4, s[12:15], s21 offen offset:1024 lds
  buffer_load_dwordx4 v4, s[12:15], s21 offen offset:2048 lds
  buffer_load_dwordx4 v4, s[12:15], s21 offen offset:3072 lds
  s_add_u32 m0, s22, 12288
  s_add_u32 s21, s40, 12288
  buffer_load_dwordx4 v4, s[12:15], s21 offen offset:0 lds
  buffer_load_dwordx4 v4, s[12:15], s21 offen offset:1024 lds
  buffer_load_dwordx4 v4, s[12:15], s21 offen offset:2048 lds
  buffer_load_dwordx4 v4, s[12:15], s21 offen offset:3072 lds
  s_add_u32 m0, s22, 16384
  s_add_u32 s21, s40, 16384
  buffer_load_dwordx4 v4, s[12:15], s21 offen offset:0 lds
  buffer_load_dwordx4 v4, s[12:15], s21 offen offset:1024 lds
  buffer_load_dwordx4 v4, s[12:15], s21 offen offset:2048 lds
  buffer_load_dwordx4 v4, s[12:15], s21 offen offset:3072 lds
  s_add_u32 m0, s22, 20480
  s_add_u32 s21, s40, 20480
  buffer_load_dwordx4 v4, s[12:15], s21 offen offset:0 lds
  buffer_load_dwordx4 v4, s[12:15], s21 offen offset:1024 lds
  buffer_load_dwordx4 v4, s[12:15], s21 offen offset:2048 lds
  buffer_load_dwordx4 v4, s[12:15], s21 offen offset:3072 lds
  s_add_u32 m0, s22, 24576
  s_add_u32 s21, s40, 24576
  buffer_load_dwordx4 v4, s[12:15], s21 offen offset:0 lds
  buffer_load_dwordx4 v4, s[12:15], s21 offen offset:1024 lds
  buffer_load_dwordx4 v4, s[12:15], s21 offen offset:2048 lds
  buffer_load_dwordx4 v4, s[12:15], s21 offen offset:3072 lds
  s_add_u32 m0, s22, 28672
  s_add_u32 s21, s40, 28672
  buffer_load_dwordx4 v4, s[12:15], s21 offen offset:0 lds
  buffer_load_dwordx4 v4, s[12:15], s21 offen offset:1024 lds
  s_add_u32 s21, s40, 122880
  buffer_load_dwordx4 v[64:67], v4, s[12:15], s21 offen offset:0
  buffer_load_dwordx4 v[68:71], v4, s[12:15], s21 offen offset:1024
  buffer_load_dwordx4 v[72:75], v4, s[12:15], s21 offen offset:2048
  buffer_load_dwordx4 v[76:79], v4, s[12:15], s21 offen offset:3072
  s_add_u32 s21, s40, 126976
  buffer_load_dwordx4 v[80:83], v4, s[12:15], s21 offen offset:0
  buffer_load_dwordx4 v[84:87], v4, s[12:15], s21 offen offset:1024
  buffer_load_dwordx4 v[88:91], v4, s[12:15], s21 offen offset:2048
  buffer_load_dwordx4 v[92:95], v4, s[12:15], s21 offen offset:3072
  s_add_u32 s21, s40, 131072
  buffer_load_dwordx4 v[96:99], v4, s[12:15], s21 offen offset:0
  buffer_load_dwordx4 v[100:103], v4, s[12:15], s21 offen offset:1024
  buffer_load_dwordx4 v[104:107], v4, s[12:15], s21 offen offset:2048
  buffer_load_dwordx4 v[108:111], v4, s[12:15], s21 offen offset:3072
  s_add_u32 s21, s40, 135168
  buffer_load_dwordx4 v[112:115], v4, s[12:15], s21 offen offset:0
  buffer_load_dwordx4 v[116:119], v4, s[12:15], s21 offen offset:1024
  buffer_load_dwordx4 v[120:123], v4, s[12:15], s21 offen offset:2048
  buffer_load_dwordx4 v[124:127], v4, s[12:15], s21 offen offset:3072
  s_add_u32 s21, s40, 139264
  buffer_load_dwordx4 v[128:131], v4, s[12:15], s21 offen offset:0
  buffer_load_dwordx4 v[132:135], v4, s[12:15], s21 offen offset:1024
  buffer_load_dwordx4 v[136:139], v4, s[12:15], s21 offen offset:2048
  buffer_load_dwordx4 v[140:143], v4, s[12:15], s21 offen offset:3072
  s_add_u32 s21, s40, 143360
  buffer_load_dwordx4 v[144:147], v4, s[12:15], s21 offen offset:0
  buffer_load_dwordx4 v[148:151], v4, s[12:15], s21 offen offset:1024
  buffer_load_dwordx4 v[152:155], v4, s[12:15], s21 offen offset:2048
  buffer_load_dwordx4 v[156:159], v4, s[12:15], s21 offen offset:3072
  s_add_u32 s21, s40, 147456
  buffer_load_dwordx4 v[160:163], v4, s[12:15], s21 offen offset:0
  buffer_load_dwordx4 v[164:167], v4, s[12:15], s21 offen offset:1024
  buffer_load_dwordx4 v[168:171], v4, s[12:15], s21 offen offset:2048
  buffer_load_dwordx4 v[172:175], v4, s[12:15], s21 offen offset:3072
  s_add_u32 s21, s40, 151552
  buffer_load_dwordx4 v[176:179], v4, s[12:15], s21 offen offset:0
  buffer_load_dwordx4 v[180:183], v4, s[12:15], s21 offen offset:1024
  v_lshrrev_b32 v6, 2, v2
  v_lshl_add_u32 v6, v3, 2, v6
  v_mul_u32_u24 v6, 1280, v6
  v_and_b32 v7, 3, v2
  v_lshlrev_b32 v7, 3, v7
  s_mul_i32 s21, s20, 320
  v_add3_u32 v6, v6, v7, s21
  v_add_u32 v8, v6, v7
  v_add_u32 v7, 61440, v6
  v_add_u32 v9, 61440, v8
  v_add_u32 v5, s22, v4
  s_waitcnt vmcnt(30)
  s_load_dwordx2 s[36:37], s[0:1], 16
  s_lshl_b32 s23, s2, 2
  s_add_u32 s23, s23, s20
  s_mul_i32 s23, s23, 61440
  s_add_u32 s23, s23, 0
  s_waitcnt lgkmcnt(0)
  s_mov_b32 s24, s36
  s_mov_b32 s25, s37
  s_mov_b32 s26, 7864320
  s_mov_b32 s27, 0x00020000
  buffer_load_dwordx4 v[200:203], v4, s[24:27], s23 offen offset:0
  buffer_load_dwordx4 v[200:203], v4, s[24:27], s23 offen offset:1024
  buffer_load_dwordx4 v[200:203], v4, s[24:27], s23 offen offset:2048
  buffer_load_dwordx4 v[200:203], v4, s[24:27], s23 offen offset:3072
  s_add_u32 s23, s23, 4096
  buffer_load_dwordx4 v[200:203], v4, s[24:27], s23 offen offset:0
  buffer_load_dwordx4 v[200:203], v4, s[24:27], s23 offen offset:1024
  buffer_load_dwordx4 v[200:203], v4, s[24:27], s23 offen offset:2048
  buffer_load_dwordx4 v[200:203], v4, s[24:27], s23 offen offset:3072
  s_add_u32 s23, s23, 4096
  buffer_load_dwordx4 v[200:203], v4, s[24:27], s23 offen offset:0
  buffer_load_dwordx4 v[200:203], v4, s[24:27], s23 offen offset:1024
  buffer_load_dwordx4 v[200:203], v4, s[24:27], s23 offen offset:2048
  buffer_load_dwordx4 v[200:203], v4, s[24:27], s23 offen offset:3072
  s_add_u32 s23, s23, 4096
  buffer_load_dwordx4 v[200:203], v4, s[24:27], s23 offen offset:0
  buffer_load_dwordx4 v[200:203], v4, s[24:27], s23 offen offset:1024
  buffer_load_dwordx4 v[200:203], v4, s[24:27], s23 offen offset:2048
  buffer_load_dwordx4 v[200:203], v4, s[24:27], s23 offen offset:3072
  s_add_u32 s23, s23, 4096
  buffer_load_dwordx4 v[200:203], v4, s[24:27], s23 offen offset:0
  buffer_load_dwordx4 v[200:203], v4, s[24:27], s23 offen offset:1024
  buffer_load_dwordx4 v[200:203], v4, s[24:27], s23 offen offset:2048
  buffer_load_dwordx4 v[200:203], v4, s[24:27], s23 offen offset:3072
  s_add_u32 s23, s23, 4096
  buffer_load_dwordx4 v[200:203], v4, s[24:27], s23 offen offset:0
  buffer_load_dwordx4 v[200:203], v4, s[24:27], s23 offen offset:1024
  buffer_load_dwordx4 v[200:203], v4, s[24:27], s23 offen offset:2048
  buffer_load_dwordx4 v[200:203], v4, s[24:27], s23 offen offset:3072
  s_add_u32 s23, s23, 4096
  buffer_load_dwordx4 v[200:203], v4, s[24:27], s23 offen offset:0
  buffer_load_dwordx4 v[200:203], v4, s[24:27], s23 offen offset:1024
  buffer_load_dwordx4 v[200:203], v4, s[24:27], s23 offen offset:2048
  buffer_load_dwordx4 v[200:203], v4, s[24:27], s23 offen offset:3072
  s_add_u32 s23, s23, 4096
  buffer_load_dwordx4 v[200:203], v4, s[24:27], s23 offen offset:0
  buffer_load_dwordx4 v[200:203], v4, s[24:27], s23 offen offset:1024
  s_barrier
  ds_read_b64_tr_b16 a[0:1], v8 offset:0
  ds_read_b64_tr_b16 a[2:3], v8 offset:20480
  ds_read_b64_tr_b16 a[24:25], v8 offset:8
  ds_read_b64_tr_b16 a[26:27], v8 offset:20488
  ds_read_b64_tr_b16 a[48:49], v6 offset:64
  ds_read_b64_tr_b16 a[50:51], v6 offset:20544
  ds_read_b64_tr_b16 a[72:73], v8 offset:96
  ds_read_b64_tr_b16 a[74:75], v8 offset:20576
  ds_read_b64_tr_b16 a[96:97], v8 offset:104
  ds_read_b64_tr_b16 a[98:99], v8 offset:20584
  ds_read_b64_tr_b16 a[120:121], v8 offset:160
  ds_read_b64_tr_b16 a[122:123], v8 offset:20640
  ds_read_b64_tr_b16 a[144:145], v8 offset:168
  ds_read_b64_tr_b16 a[146:147], v8 offset:20648
  ds_read_b64_tr_b16 a[168:169], v6 offset:224
  ds_read_b64_tr_b16 a[170:171], v6 offset:20704
  ds_read_b64_tr_b16 a[192:193], v8 offset:256
  ds_read_b64_tr_b16 a[194:195], v8 offset:20736
  ds_read_b64_tr_b16 a[216:217], v8 offset:264
  ds_read_b64_tr_b16 a[218:219], v8 offset:20744
  ds_read_b64_tr_b16 a[4:5], v9 offset:0
  ds_read_b64_tr_b16 a[6:7], v9 offset:20480
  ds_read_b64_tr_b16 a[28:29], v9 offset:8
  ds_read_b64_tr_b16 a[30:31], v9 offset:20488
  ds_read_b64_tr_b16 a[52:53], v7 offset:64
  ds_read_b64_tr_b16 a[54:55], v7 offset:20544
  ds_read_b64_tr_b16 a[76:77], v9 offset:96
  ds_read_b64_tr_b16 a[78:79], v9 offset:20576
  ds_read_b64_tr_b16 a[100:101], v9 offset:104
  ds_read_b64_tr_b16 a[102:103], v9 offset:20584
  ds_read_b64_tr_b16 a[124:125], v9 offset:160
  ds_read_b64_tr_b16 a[126:127], v9 offset:20640
  ds_read_b64_tr_b16 a[148:149], v9 offset:168
  ds_read_b64_tr_b16 a[150:151], v9 offset:20648
  ds_read_b64_tr_b16 a[172:173], v7 offset:224
  ds_read_b64_tr_b16 a[174:175], v7 offset:20704
  ds_read_b64_tr_b16 a[196:197], v9 offset:256
  ds_read_b64_tr_b16 a[198:199], v9 offset:20736
  ds_read_b64_tr_b16 a[220:221], v9 offset:264
  ds_read_b64_tr_b16 a[222:223], v9 offset:20744
  ds_read_b64_tr_b16 a[8:9], v8 offset:40960
  ds_read_b64_tr_b16 a[10:11], v9 offset:40960
  ds_read_b64_tr_b16 a[32:33], v8 offset:40968
  ds_read_b64_tr_b16 a[34:35], v9 offset:40968
  ds_read_b64_tr_b16 a[56:57], v6 offset:41024
  ds_read_b64_tr_b16 a[58:59], v7 offset:41024
  ds_read_b64_tr_b16 a[80:81], v8 offset:41056
  ds_read_b64_tr_b16 a[82:83], v9 offset:41056
  ds_read_b64_tr_b16 a[104:105], v8 offset:41064
  ds_read_b64_tr_b16 a[106:107], v9 offset:41064
  ds_read_b64_tr_b16 a[128:129], v8 offset:41120
  ds_read_b64_tr_b16 a[130:131], v9 offset:41120
  ds_read_b64_tr_b16 a[152:153], v8 offset:41128
  ds_read_b64_tr_b16 a[154:155], v9 offset:41128
  ds_read_b64_tr_b16 a[176:177], v6 offset:41184
  ds_read_b64_tr_b16 a[178:179], v7 offset:41184
  ds_read_b64_tr_b16 a[200:201], v8 offset:41216
  ds_read_b64_tr_b16 a[202:203], v9 offset:41216
  ds_read_b64_tr_b16 a[224:225], v8 offset:41224
  ds_read_b64_tr_b16 a[226:227], v9 offset:41224
  s_waitcnt lgkmcnt(0)
  s_barrier
  s_waitcnt vmcnt(30)
  ds_write_b128 v5, v[64:67] offset:0
  ds_write_b128 v5, v[68:71] offset:1024
  ds_write_b128 v5, v[72:75] offset:2048
  ds_write_b128 v5, v[76:79] offset:3072
  ds_write_b128 v5, v[80:83] offset:4096
  ds_write_b128 v5, v[84:87] offset:5120
  ds_write_b128 v5, v[88:91] offset:6144
  ds_write_b128 v5, v[92:95] offset:7168
  ds_write_b128 v5, v[96:99] offset:8192
  ds_write_b128 v5, v[100:103] offset:9216
  ds_write_b128 v5, v[104:107] offset:10240
  ds_write_b128 v5, v[108:111] offset:11264
  ds_write_b128 v5, v[112:115] offset:12288
  ds_write_b128 v5, v[116:119] offset:13312
  ds_write_b128 v5, v[120:123] offset:14336
  ds_write_b128 v5, v[124:127] offset:15360
  ds_write_b128 v5, v[128:131] offset:16384
  ds_write_b128 v5, v[132:135] offset:17408
  ds_write_b128 v5, v[136:139] offset:18432
  ds_write_b128 v5, v[140:143] offset:19456
  ds_write_b128 v5, v[144:147] offset:20480
  ds_write_b128 v5, v[148:151] offset:21504
  ds_write_b128 v5, v[152:155] offset:22528
  ds_write_b128 v5, v[156:159] offset:23552
  ds_write_b128 v5, v[160:163] offset:24576
  ds_write_b128 v5, v[164:167] offset:25600
  ds_write_b128 v5, v[168:171] offset:26624
  ds_write_b128 v5, v[172:175] offset:27648
  ds_write_b128 v5, v[176:179] offset:28672
  ds_write_b128 v5, v[180:183] offset:29696
  s_waitcnt lgkmcnt(0)
  s_barrier
  ds_read_b64_tr_b16 a[12:13], v8 offset:0
  ds_read_b64_tr_b16 a[14:15], v8 offset:20480
  ds_read_b64_tr_b16 a[36:37], v8 offset:8
  ds_read_b64_tr_b16 a[38:39], v8 offset:20488
  ds_read_b64_tr_b16 a[60:61], v6 offset:64
  ds_read_b64_tr_b16 a[62:63], v6 offset:20544
  ds_read_b64_tr_b16 a[84:85], v8 offset:96
  ds_read_b64_tr_b16 a[86:87], v8 offset:20576
  ds_read_b64_tr_b16 a[108:109], v8 offset:104
  ds_read_b64_tr_b16 a[110:111], v8 offset:20584
  ds_read_b64_tr_b16 a[132:133], v8 offset:160
  ds_read_b64_tr_b16 a[134:135], v8 offset:20640
  ds_read_b64_tr_b16 a[156:157], v8 offset:168
  ds_read_b64_tr_b16 a[158:159], v8 offset:20648
  ds_read_b64_tr_b16 a[180:181], v6 offset:224
  ds_read_b64_tr_b16 a[182:183], v6 offset:20704
  ds_read_b64_tr_b16 a[204:205], v8 offset:256
  ds_read_b64_tr_b16 a[206:207], v8 offset:20736
  ds_read_b64_tr_b16 a[228:229], v8 offset:264
  ds_read_b64_tr_b16 a[230:231], v8 offset:20744
  ds_read_b64_tr_b16 a[16:17], v9 offset:0
  ds_read_b64_tr_b16 a[18:19], v9 offset:20480
  ds_read_b64_tr_b16 a[40:41], v9 offset:8
  ds_read_b64_tr_b16 a[42:43], v9 offset:20488
  ds_read_b64_tr_b16 a[64:65], v7 offset:64
  ds_read_b64_tr_b16 a[66:67], v7 offset:20544
  ds_read_b64_tr_b16 a[88:89], v9 offset:96
  ds_read_b64_tr_b16 a[90:91], v9 offset:20576
  ds_read_b64_tr_b16 a[112:113], v9 offset:104
  ds_read_b64_tr_b16 a[114:115], v9 offset:20584
  ds_read_b64_tr_b16 a[136:137], v9 offset:160
  ds_read_b64_tr_b16 a[138:139], v9 offset:20640
  ds_read_b64_tr_b16 a[160:161], v9 offset:168
  ds_read_b64_tr_b16 a[162:163], v9 offset:20648
  ds_read_b64_tr_b16 a[184:185], v7 offset:224
  ds_read_b64_tr_b16 a[186:187], v7 offset:20704
  ds_read_b64_tr_b16 a[208:209], v9 offset:256
  ds_read_b64_tr_b16 a[210:211], v9 offset:20736
  ds_read_b64_tr_b16 a[232:233], v9 offset:264
  ds_read_b64_tr_b16 a[234:235], v9 offset:20744
  ds_read_b64_tr_b16 a[20:21], v8 offset:40960
  ds_read_b64_tr_b16 a[22:23], v9 offset:40960
  ds_read_b64_tr_b16 a[44:45], v8 offset:40968
  ds_read_b64_tr_b16 a[46:47], v9 offset:40968
  ds_read_b64_tr_b16 a[68:69], v6 offset:41024
  ds_read_b64_tr_b16 a[70:71], v7 offset:41024
  ds_read_b64_tr_b16 a[92:93], v8 offset:41056
  ds_read_b64_tr_b16 a[94:95], v9 offset:41056
  ds_read_b64_tr_b16 a[116:117], v8 offset:41064
  ds_read_b64_tr_b16 a[118:119], v9 offset:41064
  ds_read_b64_tr_b16 a[140:141], v8 offset:41120
  ds_read_b64_tr_b16 a[142:143], v9 offset:41120
  ds_read_b64_tr_b16 a[164:165], v8 offset:41128
  ds_read_b64_tr_b16 a[166:167], v9 offset:41128
  ds_read_b64_tr_b16 a[188:189], v6 offset:41184
  ds_read_b64_tr_b16 a[190:191], v7 offset:41184
  ds_read_b64_tr_b16 a[212:213], v8 offset:41216
  ds_read_b64_tr_b16 a[214:215], v9 offset:41216
  ds_read_b64_tr_b16 a[236:237], v8 offset:41224
  ds_read_b64_tr_b16 a[238:239], v9 offset:41224
  s_waitcnt lgkmcnt(0)
  s_barrier
  s_load_dwordx2 s[32:33], s[0:1], 96
  s_waitcnt lgkmcnt(0)
  s_mov_b32 s32, s32
  s_mov_b32 s33, s33
  s_mov_b32 s34, 256
  s_mov_b32 s35, 0x00020000
  s_mov_b32 s21, 76
  v_mov_b32 v4, 0
  s_mov_b32 s101, 0
wf_206:
  buffer_load_dword v5, v4, s[32:35], s21 offen sc1
  s_add_u32 s101, s101, 1
  s_cmp_gt_u32 s101, 131072
  s_cbranch_scc1 main_end
  s_waitcnt vmcnt(0)
  v_readfirstlane_b32 s100, v5
  s_cmp_ge_u32 s100, 1
  s_cbranch_scc1 wf_207
  s_sleep 8
  s_branch wf_206
wf_207:
  s_sub_u32 s80, s100, 1
  s_lshl_b32 s80, s80, 13
  s_lshl_b32 s40, s2, 2
  s_add_u32 s40, s40, s20
  s_lshl_b32 s40, s40, 14
  s_xor_b32 s40, s40, s80
  s_xor_b32 s40, s40, 8192
  s_mul_i32 s47, s20, 3072
  s_lshr_b32 s43, s2, 2
  s_lshl_b32 s43, s43, 7
  s_add_u32 s43, s43, 28672
  s_xor_b32 s43, s43, s80
  s_lshl_b32 s44, s2, 7
  s_lshl_b32 s21, s20, 2
  s_add_u32 s44, s44, s21
  s_add_u32 s44, s44, 4096
  s_xor_b32 s44, s44, s80
  s_lshl_b32 s49, s20, 8
  s_add_u32 s49, s49, 12288
  s_mov_b32 s45, 0
  v_lshlrev_b32 v4, 4, v1
  v_min_u32 v14, 18, v1
  v_lshlrev_b32 v14, 2, v14
  v_mov_b32 v17, 1073741824
  v_cmp_eq_u32 vcc, 0, v1
  s_nop 1
  v_cndmask_b32 v17, v17, 0, vcc
  v_mov_b32 v16, 0
  v_mov_b32 v18, 65536
vwr_208:
  s_cmp_lg_u32 s20, 0
  s_cbranch_scc1 vwr_211
  s_mov_b32 s101, 0
  s_branch vwr_210
vwr_209:
  s_cmp_lg_u32 s101, 1
  s_cbranch_scc1 vwr_212
  buffer_store_dword v16, v17, s[72:75], s44 offen sc1
vwr_212:
  s_sleep 4
vwr_210:
  buffer_load_dword v15, v14, s[72:75], s43 offen sc1
  s_add_u32 s101, s101, 1
  s_cmp_gt_u32 s101, 131072
  s_cbranch_scc1 main_end
  s_waitcnt vmcnt(0)
  v_cmp_le_u32 vcc, 8, v15
  s_nop 1
  s_ff0_i32_b32 s21, vcc_lo
  s_min_u32 s21, s21, 19
  s_lshl_b32 s22, s21, 1
  s_lshl_b32 s21, s21, 2
  s_sub_i32 s21, s21, 12
  s_max_i32 s46, s21, s22
  s_cmp_le_u32 s46, s45
  s_cbranch_scc1 vwr_209
  v_mov_b32 v15, s46
  ds_write_b32 v18, v15
  s_waitcnt lgkmcnt(0)
  s_barrier
  s_branch vwr_213
vwr_211:
  s_waitcnt vmcnt(0)
  buffer_store_dword v16, v17, s[72:75], s44 offen sc1
  s_barrier
  ds_read_b32 v15, v18
  s_waitcnt lgkmcnt(0)
  v_readfirstlane_b32 s46, v15
vwr_213:
  s_and_b32 s50, s45, 2
  s_lshl_b32 s50, s50, 14
  v_add_u32 v10, s50, v4
  v_add_u32 v11, 2048, v10
  v_add_u32 v12, 2056, v10
  v_lshl_add_u32 v13, v1, 2, s50
  s_lshl_b32 s41, s45, 21
  s_add_u32 s41, s41, s40
  s_mov_b32 s48, s45
  s_mov_b32 s56, s41
  s_add_u32 s57, s56, 4096
  s_lshl_b32 s58, s45, 19
  s_lshl_b32 s21, s45, 11
  s_and_b32 s21, s21, 8192
  s_xor_b32 s21, s21, s80
  s_add_u32 s58, s58, s21
  s_add_u32 s58, s58, 134217728
  s_lshl_b32 s21, s2, 14
  s_lshl_b32 s22, s20, 11
  s_add_u32 s21, s21, s22
  s_add_u32 s58, s58, s21
  s_and_b32 s21, s2, 28
  s_add_u32 s21, s21, s20
  s_lshl_b32 s21, s21, 16
  s_and_b32 s22, s2, 3
  s_lshl_b32 s22, s22, 10
  s_add_u32 s21, s21, s22
  s_lshl_b32 s60, s45, 21
  s_add_u32 s60, s60, s21
  s_add_u32 s60, s60, s80
  s_add_u32 s60, s60, -2093056
  s_xor_b32 s60, s60, 8192
  s_mov_b32 s51, 1073741824
  s_mov_b32 s59, 1073741824
  s_mov_b32 s52, s50
  s_cmp_lt_u32 s48, s46
  s_cselect_b32 s53, s41, 1073741824
  s_add_u32 s54, s52, 0
  s_add_u32 m0, s54, s47
  s_nop 0
  buffer_load_dwordx4 v4, s[16:19], s53 offen offset:0 sc1 lds
  buffer_load_dwordx4 v4, s[16:19], s53 offen offset:1024 sc1 lds
  buffer_load_dwordx4 v4, s[16:19], s53 offen offset:2048 sc1 lds
  s_nop 0
  s_add_u32 m0, s54, s49
  s_nop 0
  buffer_load_dword v14, s[72:75], s43 offen sc1 lds
  s_add_u32 s41, s41, 2097152
  s_xor_b32 s41, s41, 8192
  s_add_u32 s48, s48, 1
  s_cmp_lt_u32 s48, s46
  s_cselect_b32 s53, s41, 1073741824
  s_add_u32 s54, s52, 16384
  s_add_u32 m0, s54, s47
  s_nop 0
  buffer_load_dwordx4 v4, s[16:19], s53 offen offset:0 sc1 lds
  buffer_load_dwordx4 v4, s[16:19], s53 offen offset:1024 sc1 lds
  buffer_load_dwordx4 v4, s[16:19], s53 offen offset:2048 sc1 lds
  s_nop 0
  s_add_u32 m0, s54, s49
  s_nop 0
  buffer_load_dword v14, s[72:75], s43 offen sc1 lds
  s_add_u32 s41, s41, 2097152
  s_xor_b32 s41, s41, 8192
  s_add_u32 s48, s48, 1
  s_xor_b32 s52, s52, 32768
  s_cmp_lt_u32 s48, s46
  s_cselect_b32 s53, s41, 1073741824
  s_add_u32 s54, s52, 0
  s_add_u32 m0, s54, s47
  s_nop 0
  buffer_load_dwordx4 v4, s[16:19], s53 offen offset:0 sc1 lds
  buffer_load_dwordx4 v4, s[16:19], s53 offen offset:1024 sc1 lds
  buffer_load_dwordx4 v4, s[16:19], s53 offen offset:2048 sc1 lds
  s_nop 0
  s_add_u32 m0, s54, s49
  s_nop 0
  buffer_load_dword v14, s[72:75], s43 offen sc1 lds
  s_add_u32 s41, s41, 2097152
  s_xor_b32 s41, s41, 8192
  s_add_u32 s48, s48, 1
  s_waitcnt vmcnt(0)
  buffer_store_dword v16, v17, s[72:75], s44 offen sc1
  s_barrier
  ds_read_b128 v[64:67], v10 offset:0
  ds_read_b128 v[88:91], v10 offset:1024
  ds_read_b128 v[68:71], v10 offset:3072
  ds_read_b128 v[92:95], v10 offset:4096
  ds_read2st64_b64 v[72:75], v11 offset0:0 offset1:6
  ds_read2st64_b64 v[96:99], v12 offset0:0 offset1:6
  ds_read_b128 v[76:79], v10 offset:6144
  ds_read_b128 v[100:103], v10 offset:7168
  ds_read_b128 v[80:83], v10 offset:9216
  ds_read_b128 v[104:107], v10 offset:10240
  ds_read2st64_b64 v[84:87], v11 offset0:12 offset1:18
  ds_read2st64_b64 v[108:111], v12 offset0:12 offset1:18
  s_waitcnt lgkmcnt(0)
  .p2align 3
vwl_214:
  v_mfma_f32_16x16x32_bf16 v[160:163], v[64:67], a[0:3], 0
  v_mfma_f32_16x16x32_bf16 v[164:167], v[88:91], a[0:3], 0
  v_mfma_f32_16x16x32_bf16 v[160:163], v[68:71], a[4:7], v[160:163]
  v_cvt_pk_bf16_f32 v204, v184, v185
  v_cvt_pk_bf16_f32 v205, v186, v187
  v_mfma_f32_16x16x32_bf16 v[164:167], v[92:95], a[4:7], v[164:167]
  v_cvt_pk_bf16_f32 v206, v188, v189
  v_cvt_pk_bf16_f32 v207, v190, v191
  v_mfma_f32_16x16x32_bf16 v[160:163], v[72:75], a[8:11], v[160:163]
  buffer_store_dwordx4 v[204:207], v4, s[16:19], s51 offen offset:3072 sc1
  v_mfma_f32_16x16x32_bf16 v[164:167], v[96:99], a[8:11], v[164:167]
  v_mfma_f32_16x16x32_bf16 v[160:163], v[76:79], a[12:15], v[160:163]
  v_mfma_f32_16x16x32_bf16 v[164:167], v[100:103], a[12:15], v[164:167]
  s_waitcnt vmcnt(23)
  s_barrier
  ds_read_b32 v15, v13 offset:28672
  v_mfma_f32_16x16x32_bf16 v[160:163], v[80:83], a[16:19], v[160:163]
  ds_read_b128 v[112:115], v10 offset:16384
  v_mfma_f32_16x16x32_bf16 v[164:167], v[104:107], a[16:19], v[164:167]
  v_mfma_f32_16x16x32_bf16 v[160:163], v[84:87], a[20:23], v[160:163]
  ds_read_b128 v[136:139], v10 offset:17408
  v_mfma_f32_16x16x32_bf16 v[164:167], v[108:111], a[20:23], v[164:167]
  v_mfma_f32_16x16x32_bf16 v[168:171], v[64:67], a[24:27], 0
  ds_read_b128 v[116:119], v10 offset:19456
  v_mfma_f32_16x16x32_bf16 v[172:175], v[88:91], a[24:27], 0
  v_mfma_f32_16x16x32_bf16 v[168:171], v[68:71], a[28:31], v[168:171]
  v_cvt_pk_bf16_f32 v192, v160, v161
  v_cvt_pk_bf16_f32 v193, v162, v163
  v_mfma_f32_16x16x32_bf16 v[172:175], v[92:95], a[28:31], v[172:175]
  v_cvt_pk_bf16_f32 v194, v164, v165
  v_cvt_pk_bf16_f32 v195, v166, v167
  v_mfma_f32_16x16x32_bf16 v[168:171], v[72:75], a[32:35], v[168:171]
  buffer_store_dwordx4 v[192:195], v4, s[16:19], s56 offen offset:0 sc1
  ds_read_b128 v[140:143], v10 offset:20480
  v_mfma_f32_16x16x32_bf16 v[172:175], v[96:99], a[32:35], v[172:175]
  v_mfma_f32_16x16x32_bf16 v[168:171], v[76:79], a[36:39], v[168:171]
  ds_read2st64_b64 v[120:123], v11 offset0:32 offset1:38
  v_mfma_f32_16x16x32_bf16 v[172:175], v[100:103], a[36:39], v[172:175]
  v_mfma_f32_16x16x32_bf16 v[168:171], v[80:83], a[40:43], v[168:171]
  ds_read2st64_b64 v[144:147], v12 offset0:32 offset1:38
  v_mfma_f32_16x16x32_bf16 v[172:175], v[104:107], a[40:43], v[172:175]
  v_mfma_f32_16x16x32_bf16 v[168:171], v[84:87], a[44:47], v[168:171]
  ds_read_b128 v[124:127], v10 offset:22528
  v_mfma_f32_16x16x32_bf16 v[172:175], v[108:111], a[44:47], v[172:175]
  v_mfma_f32_16x16x32_bf16 v[176:179], v[64:67], a[48:51], 0
  ds_read_b128 v[148:151], v10 offset:23552
  v_mfma_f32_16x16x32_bf16 v[180:183], v[88:91], a[48:51], 0
  v_mfma_f32_16x16x32_bf16 v[176:179], v[68:71], a[52:55], v[176:179]
  v_cvt_pk_bf16_f32 v196, v168, v169
  v_cvt_pk_bf16_f32 v197, v170, v171
  v_mfma_f32_16x16x32_bf16 v[180:183], v[92:95], a[52:55], v[180:183]
  v_cvt_pk_bf16_f32 v198, v172, v173
  v_cvt_pk_bf16_f32 v199, v174, v175
  v_mfma_f32_16x16x32_bf16 v[176:179], v[72:75], a[56:59], v[176:179]
  buffer_store_dwordx4 v[196:199], v4, s[16:19], s56 offen offset:1024 sc1
  ds_read_b128 v[128:131], v10 offset:25600
  v_mfma_f32_16x16x32_bf16 v[180:183], v[96:99], a[56:59], v[180:183]
  v_mfma_f32_16x16x32_bf16 v[176:179], v[76:79], a[60:63], v[176:179]
  ds_read_b128 v[152:155], v10 offset:26624
  v_mfma_f32_16x16x32_bf16 v[180:183], v[100:103], a[60:63], v[180:183]
  v_mfma_f32_16x16x32_bf16 v[176:179], v[80:83], a[64:67], v[176:179]
  ds_read2st64_b64 v[132:135], v11 offset0:44 offset1:50
  v_mfma_f32_16x16x32_bf16 v[180:183], v[104:107], a[64:67], v[180:183]
  v_mfma_f32_16x16x32_bf16 v[176:179], v[84:87], a[68:71], v[176:179]
  ds_read2st64_b64 v[156:159], v12 offset0:44 offset1:50
  v_mfma_f32_16x16x32_bf16 v[180:183], v[108:111], a[68:71], v[180:183]
  v_mfma_f32_16x16x32_bf16 v[184:187], v[64:67], a[72:75], 0
  v_mfma_f32_16x16x32_bf16 v[188:191], v[88:91], a[72:75], 0
  s_waitcnt lgkmcnt(12)
  v_cmp_le_u32 vcc, 8, v15
  v_mfma_f32_16x16x32_bf16 v[184:187], v[68:71], a[76:79], v[184:187]
  v_cvt_pk_bf16_f32 v200, v176, v177
  v_cvt_pk_bf16_f32 v201, v178, v179
  v_mfma_f32_16x16x32_bf16 v[188:191], v[92:95], a[76:79], v[188:191]
  s_ff0_i32_b32 s21, vcc_lo
  v_cvt_pk_bf16_f32 v202, v180, v181
  v_cvt_pk_bf16_f32 v203, v182, v183
  v_mfma_f32_16x16x32_bf16 v[184:187], v[72:75], a[80:83], v[184:187]
  s_min_u32 s21, s21, 19
  buffer_store_dwordx4 v[200:203], v4, s[16:19], s58 offen offset:0 sc1
  s_lshl_b32 s22, s21, 1
  v_mfma_f32_16x16x32_bf16 v[188:191], v[96:99], a[80:83], v[188:191]
  s_lshl_b32 s21, s21, 2
  s_sub_i32 s21, s21, 12
  s_max_i32 s21, s21, s22
  v_mfma_f32_16x16x32_bf16 v[184:187], v[76:79], a[84:87], v[184:187]
  s_max_u32 s42, s21, s46
  s_cmp_ge_u32 s46, s48
  s_cselect_b32 s46, s42, s46
  v_mfma_f32_16x16x32_bf16 v[188:191], v[100:103], a[84:87], v[188:191]
  s_cmp_lt_u32 s48, s46
  s_cselect_b32 s53, s41, 1073741824
  s_add_u32 s54, s52, 16384
  v_mfma_f32_16x16x32_bf16 v[184:187], v[80:83], a[88:91], v[184:187]
  s_add_u32 m0, s54, s47
  v_mfma_f32_16x16x32_bf16 v[188:191], v[104:107], a[88:91], v[188:191]
  buffer_load_dwordx4 v4, s[16:19], s53 offen offset:0 sc1 lds
  buffer_load_dwordx4 v4, s[16:19], s53 offen offset:1024 sc1 lds
  v_mfma_f32_16x16x32_bf16 v[184:187], v[84:87], a[92:95], v[184:187]
  buffer_load_dwordx4 v4, s[16:19], s53 offen offset:2048 sc1 lds
  v_mfma_f32_16x16x32_bf16 v[188:191], v[108:111], a[92:95], v[188:191]
  s_add_u32 m0, s54, s49
  v_mfma_f32_16x16x32_bf16 v[160:163], v[64:67], a[96:99], 0
  buffer_load_dword v14, s[72:75], s43 offen sc1 lds
  s_add_u32 s41, s41, 2097152
  v_mfma_f32_16x16x32_bf16 v[164:167], v[88:91], a[96:99], 0
  s_xor_b32 s41, s41, 8192
  s_add_u32 s48, s48, 1
  v_mfma_f32_16x16x32_bf16 v[160:163], v[68:71], a[100:103], v[160:163]
  v_cvt_pk_bf16_f32 v204, v184, v185
  v_cvt_pk_bf16_f32 v205, v186, v187
  v_mfma_f32_16x16x32_bf16 v[164:167], v[92:95], a[100:103], v[164:167]
  v_cvt_pk_bf16_f32 v206, v188, v189
  v_cvt_pk_bf16_f32 v207, v190, v191
  v_mfma_f32_16x16x32_bf16 v[160:163], v[72:75], a[104:107], v[160:163]
  buffer_store_dwordx4 v[204:207], v4, s[16:19], s56 offen offset:2048 sc1
  v_mfma_f32_16x16x32_bf16 v[164:167], v[96:99], a[104:107], v[164:167]
  v_mfma_f32_16x16x32_bf16 v[160:163], v[76:79], a[108:111], v[160:163]
  v_mfma_f32_16x16x32_bf16 v[164:167], v[100:103], a[108:111], v[164:167]
  v_mfma_f32_16x16x32_bf16 v[160:163], v[80:83], a[112:115], v[160:163]
  v_mfma_f32_16x16x32_bf16 v[164:167], v[104:107], a[112:115], v[164:167]
  v_mfma_f32_16x16x32_bf16 v[160:163], v[84:87], a[116:119], v[160:163]
  v_mfma_f32_16x16x32_bf16 v[164:167], v[108:111], a[116:119], v[164:167]
  v_mfma_f32_16x16x32_bf16 v[168:171], v[64:67], a[120:123], 0
  v_mfma_f32_16x16x32_bf16 v[172:175], v[88:91], a[120:123], 0
  v_mfma_f32_16x16x32_bf16 v[168:171], v[68:71], a[124:127], v[168:171]
  v_cvt_pk_bf16_f32 v192, v160, v161
  v_cvt_pk_bf16_f32 v193, v162, v163
  v_mfma_f32_16x16x32_bf16 v[172:175], v[92:95], a[124:127], v[172:175]
  v_cvt_pk_bf16_f32 v194, v164, v165
  v_cvt_pk_bf16_f32 v195, v166, v167
  v_mfma_f32_16x16x32_bf16 v[168:171], v[72:75], a[128:131], v[168:171]
  buffer_store_dwordx4 v[192:195], v4, s[16:19], s56 offen offset:3072 sc1
  v_mfma_f32_16x16x32_bf16 v[172:175], v[96:99], a[128:131], v[172:175]
  v_mfma_f32_16x16x32_bf16 v[168:171], v[76:79], a[132:135], v[168:171]
  v_mfma_f32_16x16x32_bf16 v[172:175], v[100:103], a[132:135], v[172:175]
  v_mfma_f32_16x16x32_bf16 v[168:171], v[80:83], a[136:139], v[168:171]
  v_mfma_f32_16x16x32_bf16 v[172:175], v[104:107], a[136:139], v[172:175]
  v_mfma_f32_16x16x32_bf16 v[168:171], v[84:87], a[140:143], v[168:171]
  v_mfma_f32_16x16x32_bf16 v[172:175], v[108:111], a[140:143], v[172:175]
  v_mfma_f32_16x16x32_bf16 v[176:179], v[64:67], a[144:147], 0
  v_mfma_f32_16x16x32_bf16 v[180:183], v[88:91], a[144:147], 0
  v_mfma_f32_16x16x32_bf16 v[176:179], v[68:71], a[148:151], v[176:179]
  v_cvt_pk_bf16_f32 v196, v168, v169
  v_cvt_pk_bf16_f32 v197, v170, v171
  v_mfma_f32_16x16x32_bf16 v[180:183], v[92:95], a[148:151], v[180:183]
  v_cvt_pk_bf16_f32 v198, v172, v173
  v_cvt_pk_bf16_f32 v199, v174, v175
  v_mfma_f32_16x16x32_bf16 v[176:179], v[72:75], a[152:155], v[176:179]
  buffer_store_dwordx4 v[196:199], v4, s[16:19], s57 offen offset:0 sc1
  v_mfma_f32_16x16x32_bf16 v[180:183], v[96:99], a[152:155], v[180:183]
  v_mfma_f32_16x16x32_bf16 v[176:179], v[76:79], a[156:159], v[176:179]
  v_mfma_f32_16x16x32_bf16 v[180:183], v[100:103], a[156:159], v[180:183]
  v_mfma_f32_16x16x32_bf16 v[176:179], v[80:83], a[160:163], v[176:179]
  v_mfma_f32_16x16x32_bf16 v[180:183], v[104:107], a[160:163], v[180:183]
  v_mfma_f32_16x16x32_bf16 v[176:179], v[84:87], a[164:167], v[176:179]
  v_mfma_f32_16x16x32_bf16 v[180:183], v[108:111], a[164:167], v[180:183]
  v_mfma_f32_16x16x32_bf16 v[184:187], v[64:67], a[168:171], 0
  v_mfma_f32_16x16x32_bf16 v[188:191], v[88:91], a[168:171], 0
  v_mfma_f32_16x16x32_bf16 v[184:187], v[68:71], a[172:175], v[184:187]
  v_cvt_pk_bf16_f32 v200, v176, v177
  v_cvt_pk_bf16_f32 v201, v178, v179
  v_mfma_f32_16x16x32_bf16 v[188:191], v[92:95], a[172:175], v[188:191]
  v_cvt_pk_bf16_f32 v202, v180, v181
  v_cvt_pk_bf16_f32 v203, v182, v183
  v_mfma_f32_16x16x32_bf16 v[184:187], v[72:75], a[176:179], v[184:187]
  buffer_store_dwordx4 v[200:203], v4, s[16:19], s57 offen offset:1024 sc1
  v_mfma_f32_16x16x32_bf16 v[188:191], v[96:99], a[176:179], v[188:191]
  v_mfma_f32_16x16x32_bf16 v[184:187], v[76:79], a[180:183], v[184:187]
  v_mfma_f32_16x16x32_bf16 v[188:191], v[100:103], a[180:183], v[188:191]
  v_mfma_f32_16x16x32_bf16 v[184:187], v[80:83], a[184:187], v[184:187]
  v_mfma_f32_16x16x32_bf16 v[188:191], v[104:107], a[184:187], v[188:191]
  v_mfma_f32_16x16x32_bf16 v[184:187], v[84:87], a[188:191], v[184:187]
  v_mfma_f32_16x16x32_bf16 v[188:191], v[108:111], a[188:191], v[188:191]
  v_mfma_f32_16x16x32_bf16 v[160:163], v[64:67], a[192:195], 0
  s_min_u32 s21, s45, 52
  v_mov_b32 v16, s21
  s_waitcnt vmcnt(11)
  v_mfma_f32_16x16x32_bf16 v[164:167], v[88:91], a[192:195], 0
  buffer_store_dword v16, v17, s[72:75], s44 offen sc1
  v_mfma_f32_16x16x32_bf16 v[160:163], v[68:71], a[196:199], v[160:163]
  v_cvt_pk_bf16_f32 v204, v184, v185
  v_cvt_pk_bf16_f32 v205, v186, v187
  v_mfma_f32_16x16x32_bf16 v[164:167], v[92:95], a[196:199], v[164:167]
  v_cvt_pk_bf16_f32 v206, v188, v189
  v_cvt_pk_bf16_f32 v207, v190, v191
  v_mfma_f32_16x16x32_bf16 v[160:163], v[72:75], a[200:203], v[160:163]
  buffer_store_dwordx4 v[204:207], v4, s[16:19], s58 offen offset:1024 sc1
  v_mfma_f32_16x16x32_bf16 v[164:167], v[96:99], a[200:203], v[164:167]
  v_mfma_f32_16x16x32_bf16 v[160:163], v[76:79], a[204:207], v[160:163]
  s_add_u32 s56, s56, 2097152
  s_xor_b32 s56, s56, 8192
  s_add_u32 s59, s58, 524288
  v_mfma_f32_16x16x32_bf16 v[164:167], v[100:103], a[204:207], v[164:167]
  s_xor_b32 s58, s58, s59
  s_lshr_b32 s58, s58, 8
  s_and_b32 s58, s58, 8192
  v_mfma_f32_16x16x32_bf16 v[160:163], v[80:83], a[208:211], v[160:163]
  s_xor_b32 s58, s58, s59
  v_mfma_f32_16x16x32_bf16 v[164:167], v[104:107], a[208:211], v[164:167]
  v_mfma_f32_16x16x32_bf16 v[160:163], v[84:87], a[212:215], v[160:163]
  v_mfma_f32_16x16x32_bf16 v[164:167], v[108:111], a[212:215], v[164:167]
  v_mfma_f32_16x16x32_bf16 v[168:171], v[64:67], a[216:219], 0
  v_mfma_f32_16x16x32_bf16 v[172:175], v[88:91], a[216:219], 0
  v_mfma_f32_16x16x32_bf16 v[168:171], v[68:71], a[220:223], v[168:171]
  v_cvt_pk_bf16_f32 v192, v160, v161
  v_cvt_pk_bf16_f32 v193, v162, v163
  v_mfma_f32_16x16x32_bf16 v[172:175], v[92:95], a[220:223], v[172:175]
  v_cvt_pk_bf16_f32 v194, v164, v165
  v_cvt_pk_bf16_f32 v195, v166, v167
  v_mfma_f32_16x16x32_bf16 v[168:171], v[72:75], a[224:227], v[168:171]
  buffer_store_dwordx4 v[192:195], v4, s[16:19], s57 offen offset:2048 sc1
  v_mfma_f32_16x16x32_bf16 v[172:175], v[96:99], a[224:227], v[172:175]
  v_mfma_f32_16x16x32_bf16 v[168:171], v[76:79], a[228:231], v[168:171]
  s_mov_b32 s51, s57
  s_add_u32 s57, s56, 4096
  s_add_u32 s45, s45, 1
  v_mfma_f32_16x16x32_bf16 v[172:175], v[100:103], a[228:231], v[172:175]
  v_mfma_f32_16x16x32_bf16 v[168:171], v[80:83], a[232:235], v[168:171]
  v_mfma_f32_16x16x32_bf16 v[172:175], v[104:107], a[232:235], v[172:175]
  v_mfma_f32_16x16x32_bf16 v[168:171], v[84:87], a[236:239], v[168:171]
  v_mfma_f32_16x16x32_bf16 v[172:175], v[108:111], a[236:239], v[172:175]
  s_waitcnt lgkmcnt(0)
  v_mfma_f32_16x16x32_bf16 v[176:179], v[112:115], a[0:3], 0
  v_mfma_f32_16x16x32_bf16 v[180:183], v[136:139], a[0:3], 0
  v_mfma_f32_16x16x32_bf16 v[176:179], v[116:119], a[4:7], v[176:179]
  v_cvt_pk_bf16_f32 v196, v168, v169
  v_cvt_pk_bf16_f32 v197, v170, v171
  v_mfma_f32_16x16x32_bf16 v[180:183], v[140:143], a[4:7], v[180:183]
  v_cvt_pk_bf16_f32 v198, v172, v173
  v_cvt_pk_bf16_f32 v199, v174, v175
  v_mfma_f32_16x16x32_bf16 v[176:179], v[120:123], a[8:11], v[176:179]
  buffer_store_dwordx4 v[196:199], v4, s[16:19], s51 offen offset:3072 sc1
  v_mfma_f32_16x16x32_bf16 v[180:183], v[144:147], a[8:11], v[180:183]
  v_mfma_f32_16x16x32_bf16 v[176:179], v[124:127], a[12:15], v[176:179]
  v_mfma_f32_16x16x32_bf16 v[180:183], v[148:151], a[12:15], v[180:183]
  s_waitcnt vmcnt(22)
  s_barrier
  v_xor_b32 v10, 32768, v10
  v_mfma_f32_16x16x32_bf16 v[176:179], v[128:131], a[16:19], v[176:179]
  v_xor_b32 v11, 32768, v11
  v_xor_b32 v12, 32768, v12
  v_mfma_f32_16x16x32_bf16 v[180:183], v[152:155], a[16:19], v[180:183]
  v_xor_b32 v13, 32768, v13
  ds_read_b32 v15, v13 offset:12288
  v_mfma_f32_16x16x32_bf16 v[176:179], v[132:135], a[20:23], v[176:179]
  ds_read_b128 v[64:67], v10 offset:0
  v_mfma_f32_16x16x32_bf16 v[180:183], v[156:159], a[20:23], v[180:183]
  v_mfma_f32_16x16x32_bf16 v[184:187], v[112:115], a[24:27], 0
  ds_read_b128 v[88:91], v10 offset:1024
  v_mfma_f32_16x16x32_bf16 v[188:191], v[136:139], a[24:27], 0
  v_mfma_f32_16x16x32_bf16 v[184:187], v[116:119], a[28:31], v[184:187]
  v_cvt_pk_bf16_f32 v200, v176, v177
  v_cvt_pk_bf16_f32 v201, v178, v179
  v_mfma_f32_16x16x32_bf16 v[188:191], v[140:143], a[28:31], v[188:191]
  v_cvt_pk_bf16_f32 v202, v180, v181
  v_cvt_pk_bf16_f32 v203, v182, v183
  v_mfma_f32_16x16x32_bf16 v[184:187], v[120:123], a[32:35], v[184:187]
  buffer_store_dwordx4 v[200:203], v4, s[16:19], s56 offen offset:0 sc1
  ds_read_b128 v[68:71], v10 offset:3072
  v_mfma_f32_16x16x32_bf16 v[188:191], v[144:147], a[32:35], v[188:191]
  v_mfma_f32_16x16x32_bf16 v[184:187], v[124:127], a[36:39], v[184:187]
  ds_read_b128 v[92:95], v10 offset:4096
  v_mfma_f32_16x16x32_bf16 v[188:191], v[148:151], a[36:39], v[188:191]
  v_mfma_f32_16x16x32_bf16 v[184:187], v[128:131], a[40:43], v[184:187]
  ds_read2st64_b64 v[72:75], v11 offset0:0 offset1:6
  v_mfma_f32_16x16x32_bf16 v[188:191], v[152:155], a[40:43], v[188:191]
  v_mfma_f32_16x16x32_bf16 v[184:187], v[132:135], a[44:47], v[184:187]
  ds_read2st64_b64 v[96:99], v12 offset0:0 offset1:6
  v_mfma_f32_16x16x32_bf16 v[188:191], v[156:159], a[44:47], v[188:191]
  v_mfma_f32_16x16x32_bf16 v[160:163], v[112:115], a[48:51], 0
  ds_read_b128 v[76:79], v10 offset:6144
  v_mfma_f32_16x16x32_bf16 v[164:167], v[136:139], a[48:51], 0
  v_mfma_f32_16x16x32_bf16 v[160:163], v[116:119], a[52:55], v[160:163]
  v_cvt_pk_bf16_f32 v204, v184, v185
  v_cvt_pk_bf16_f32 v205, v186, v187
  v_mfma_f32_16x16x32_bf16 v[164:167], v[140:143], a[52:55], v[164:167]
  v_cvt_pk_bf16_f32 v206, v188, v189
  v_cvt_pk_bf16_f32 v207, v190, v191
  v_mfma_f32_16x16x32_bf16 v[160:163], v[120:123], a[56:59], v[160:163]
  buffer_store_dwordx4 v[204:207], v4, s[16:19], s56 offen offset:1024 sc1
  ds_read_b128 v[100:103], v10 offset:7168
  v_mfma_f32_16x16x32_bf16 v[164:167], v[144:147], a[56:59], v[164:167]
  v_mfma_f32_16x16x32_bf16 v[160:163], v[124:127], a[60:63], v[160:163]
  ds_read_b128 v[80:83], v10 offset:9216
  v_mfma_f32_16x16x32_bf16 v[164:167], v[148:151], a[60:63], v[164:167]
  v_mfma_f32_16x16x32_bf16 v[160:163], v[128:131], a[64:67], v[160:163]
  ds_read_b128 v[104:107], v10 offset:10240
  v_mfma_f32_16x16x32_bf16 v[164:167], v[152:155], a[64:67], v[164:167]
  v_mfma_f32_16x16x32_bf16 v[160:163], v[132:135], a[68:71], v[160:163]
  ds_read2st64_b64 v[84:87], v11 offset0:12 offset1:18
  v_mfma_f32_16x16x32_bf16 v[164:167], v[156:159], a[68:71], v[164:167]
  v_mfma_f32_16x16x32_bf16 v[168:171], v[112:115], a[72:75], 0
  ds_read2st64_b64 v[108:111], v12 offset0:12 offset1:18
  v_mfma_f32_16x16x32_bf16 v[172:175], v[136:139], a[72:75], 0
  v_mfma_f32_16x16x32_bf16 v[168:171], v[116:119], a[76:79], v[168:171]
  v_cvt_pk_bf16_f32 v192, v160, v161
  v_cvt_pk_bf16_f32 v193, v162, v163
  v_mfma_f32_16x16x32_bf16 v[172:175], v[140:143], a[76:79], v[172:175]
  v_cvt_pk_bf16_f32 v194, v164, v165
  v_cvt_pk_bf16_f32 v195, v166, v167
  v_mfma_f32_16x16x32_bf16 v[168:171], v[120:123], a[80:83], v[168:171]
  buffer_store_dwordx4 v[192:195], v4, s[16:19], s58 offen offset:0 sc1
  s_waitcnt lgkmcnt(12)
  v_mfma_f32_16x16x32_bf16 v[172:175], v[144:147], a[80:83], v[172:175]
  v_cmp_le_u32 vcc, 8, v15
  v_mfma_f32_16x16x32_bf16 v[168:171], v[124:127], a[84:87], v[168:171]
  s_ff0_i32_b32 s21, vcc_lo
  s_min_u32 s21, s21, 19
  s_lshl_b32 s22, s21, 1
  v_mfma_f32_16x16x32_bf16 v[172:175], v[148:151], a[84:87], v[172:175]
  s_lshl_b32 s21, s21, 2
  s_sub_i32 s21, s21, 12
  s_max_i32 s21, s21, s22
  v_mfma_f32_16x16x32_bf16 v[168:171], v[128:131], a[88:91], v[168:171]
  s_max_u32 s42, s21, s46
  s_cmp_ge_u32 s46, s48
  s_cselect_b32 s46, s42, s46
  v_mfma_f32_16x16x32_bf16 v[172:175], v[152:155], a[88:91], v[172:175]
  s_xor_b32 s52, s52, 32768
  s_cmp_lt_u32 s48, s46
  s_cselect_b32 s53, s41, 1073741824
  v_mfma_f32_16x16x32_bf16 v[168:171], v[132:135], a[92:95], v[168:171]
  s_add_u32 s54, s52, 0
  s_add_u32 m0, s54, s47
  v_mfma_f32_16x16x32_bf16 v[172:175], v[156:159], a[92:95], v[172:175]
  buffer_load_dwordx4 v4, s[16:19], s53 offen offset:0 sc1 lds
  buffer_load_dwordx4 v4, s[16:19], s53 offen offset:1024 sc1 lds
  v_mfma_f32_16x16x32_bf16 v[176:179], v[112:115], a[96:99], 0
  buffer_load_dwordx4 v4, s[16:19], s53 offen offset:2048 sc1 lds
  v_mfma_f32_16x16x32_bf16 v[180:183], v[136:139], a[96:99], 0
  s_add_u32 m0, s54, s49
  v_mfma_f32_16x16x32_bf16 v[176:179], v[116:119], a[100:103], v[176:179]
  v_cvt_pk_bf16_f32 v196, v168, v169
  v_cvt_pk_bf16_f32 v197, v170, v171
  v_mfma_f32_16x16x32_bf16 v[180:183], v[140:143], a[100:103], v[180:183]
  v_cvt_pk_bf16_f32 v198, v172, v173
  v_cvt_pk_bf16_f32 v199, v174, v175
  v_mfma_f32_16x16x32_bf16 v[176:179], v[120:123], a[104:107], v[176:179]
  buffer_store_dwordx4 v[196:199], v4, s[16:19], s56 offen offset:2048 sc1
  buffer_load_dword v14, s[72:75], s43 offen sc1 lds
  v_mfma_f32_16x16x32_bf16 v[180:183], v[144:147], a[104:107], v[180:183]
  s_add_u32 s41, s41, 2097152
  s_xor_b32 s41, s41, 8192
  s_add_u32 s48, s48, 1
  v_mfma_f32_16x16x32_bf16 v[176:179], v[124:127], a[108:111], v[176:179]
  v_mfma_f32_16x16x32_bf16 v[180:183], v[148:151], a[108:111], v[180:183]
  v_mfma_f32_16x16x32_bf16 v[176:179], v[128:131], a[112:115], v[176:179]
  v_mfma_f32_16x16x32_bf16 v[180:183], v[152:155], a[112:115], v[180:183]
  v_mfma_f32_16x16x32_bf16 v[176:179], v[132:135], a[116:119], v[176:179]
  v_mfma_f32_16x16x32_bf16 v[180:183], v[156:159], a[116:119], v[180:183]
  v_mfma_f32_16x16x32_bf16 v[184:187], v[112:115], a[120:123], 0
  v_mfma_f32_16x16x32_bf16 v[188:191], v[136:139], a[120:123], 0
  v_mfma_f32_16x16x32_bf16 v[184:187], v[116:119], a[124:127], v[184:187]
  v_cvt_pk_bf16_f32 v200, v176, v177
  v_cvt_pk_bf16_f32 v201, v178, v179
  v_mfma_f32_16x16x32_bf16 v[188:191], v[140:143], a[124:127], v[188:191]
  v_cvt_pk_bf16_f32 v202, v180, v181
  v_cvt_pk_bf16_f32 v203, v182, v183
  v_mfma_f32_16x16x32_bf16 v[184:187], v[120:123], a[128:131], v[184:187]
  buffer_store_dwordx4 v[200:203], v4, s[16:19], s56 offen offset:3072 sc1
  v_mfma_f32_16x16x32_bf16 v[188:191], v[144:147], a[128:131], v[188:191]
  v_mfma_f32_16x16x32_bf16 v[184:187], v[124:127], a[132:135], v[184:187]
  v_mfma_f32_16x16x32_bf16 v[188:191], v[148:151], a[132:135], v[188:191]
  v_mfma_f32_16x16x32_bf16 v[184:187], v[128:131], a[136:139], v[184:187]
  v_mfma_f32_16x16x32_bf16 v[188:191], v[152:155], a[136:139], v[188:191]
  v_mfma_f32_16x16x32_bf16 v[184:187], v[132:135], a[140:143], v[184:187]
  v_mfma_f32_16x16x32_bf16 v[188:191], v[156:159], a[140:143], v[188:191]
  v_mfma_f32_16x16x32_bf16 v[160:163], v[112:115], a[144:147], 0
  v_mfma_f32_16x16x32_bf16 v[164:167], v[136:139], a[144:147], 0
  v_mfma_f32_16x16x32_bf16 v[160:163], v[116:119], a[148:151], v[160:163]
  v_cvt_pk_bf16_f32 v204, v184, v185
  v_cvt_pk_bf16_f32 v205, v186, v187
  v_mfma_f32_16x16x32_bf16 v[164:167], v[140:143], a[148:151], v[164:167]
  v_cvt_pk_bf16_f32 v206, v188, v189
  v_cvt_pk_bf16_f32 v207, v190, v191
  v_mfma_f32_16x16x32_bf16 v[160:163], v[120:123], a[152:155], v[160:163]
  buffer_store_dwordx4 v[204:207], v4, s[16:19], s57 offen offset:0 sc1
  v_mfma_f32_16x16x32_bf16 v[164:167], v[144:147], a[152:155], v[164:167]
  v_mfma_f32_16x16x32_bf16 v[160:163], v[124:127], a[156:159], v[160:163]
  v_mfma_f32_16x16x32_bf16 v[164:167], v[148:151], a[156:159], v[164:167]
  v_mfma_f32_16x16x32_bf16 v[160:163], v[128:131], a[160:163], v[160:163]
  v_mfma_f32_16x16x32_bf16 v[164:167], v[152:155], a[160:163], v[164:167]
  v_mfma_f32_16x16x32_bf16 v[160:163], v[132:135], a[164:167], v[160:163]
  v_mfma_f32_16x16x32_bf16 v[164:167], v[156:159], a[164:167], v[164:167]
  v_mfma_f32_16x16x32_bf16 v[168:171], v[112:115], a[168:171], 0
  v_mfma_f32_16x16x32_bf16 v[172:175], v[136:139], a[168:171], 0
  v_mfma_f32_16x16x32_bf16 v[168:171], v[116:119], a[172:175], v[168:171]
  v_cvt_pk_bf16_f32 v192, v160, v161
  v_cvt_pk_bf16_f32 v193, v162, v163
  v_mfma_f32_16x16x32_bf16 v[172:175], v[140:143], a[172:175], v[172:175]
  v_cvt_pk_bf16_f32 v194, v164, v165
  v_cvt_pk_bf16_f32 v195, v166, v167
  v_mfma_f32_16x16x32_bf16 v[168:171], v[120:123], a[176:179], v[168:171]
  buffer_store_dwordx4 v[192:195], v4, s[16:19], s57 offen offset:1024 sc1
  v_mfma_f32_16x16x32_bf16 v[172:175], v[144:147], a[176:179], v[172:175]
  v_mfma_f32_16x16x32_bf16 v[168:171], v[124:127], a[180:183], v[168:171]
  v_mfma_f32_16x16x32_bf16 v[172:175], v[148:151], a[180:183], v[172:175]
  v_mfma_f32_16x16x32_bf16 v[168:171], v[128:131], a[184:187], v[168:171]
  v_mfma_f32_16x16x32_bf16 v[172:175], v[152:155], a[184:187], v[172:175]
  v_mfma_f32_16x16x32_bf16 v[168:171], v[132:135], a[188:191], v[168:171]
  v_mfma_f32_16x16x32_bf16 v[172:175], v[156:159], a[188:191], v[172:175]
  v_mfma_f32_16x16x32_bf16 v[176:179], v[112:115], a[192:195], 0
  s_min_u32 s21, s45, 52
  v_mov_b32 v16, s21
  s_waitcnt vmcnt(11)
  v_mfma_f32_16x16x32_bf16 v[180:183], v[136:139], a[192:195], 0
  buffer_store_dword v16, v17, s[72:75], s44 offen sc1
  v_mfma_f32_16x16x32_bf16 v[176:179], v[116:119], a[196:199], v[176:179]
  v_cvt_pk_bf16_f32 v196, v168, v169
  v_cvt_pk_bf16_f32 v197, v170, v171
  v_mfma_f32_16x16x32_bf16 v[180:183], v[140:143], a[196:199], v[180:183]
  v_cvt_pk_bf16_f32 v198, v172, v173
  v_cvt_pk_bf16_f32 v199, v174, v175
  v_mfma_f32_16x16x32_bf16 v[176:179], v[120:123], a[200:203], v[176:179]
  buffer_store_dwordx4 v[196:199], v4, s[16:19], s58 offen offset:1024 sc1
  v_mfma_f32_16x16x32_bf16 v[180:183], v[144:147], a[200:203], v[180:183]
  v_mfma_f32_16x16x32_bf16 v[176:179], v[124:127], a[204:207], v[176:179]
  s_add_u32 s56, s56, 2097152
  s_xor_b32 s56, s56, 8192
  s_add_u32 s59, s58, 524288
  v_mfma_f32_16x16x32_bf16 v[180:183], v[148:151], a[204:207], v[180:183]
  s_xor_b32 s58, s58, s59
  s_lshr_b32 s58, s58, 8
  s_and_b32 s58, s58, 8192
  v_mfma_f32_16x16x32_bf16 v[176:179], v[128:131], a[208:211], v[176:179]
  s_xor_b32 s58, s58, s59
  v_mfma_f32_16x16x32_bf16 v[180:183], v[152:155], a[208:211], v[180:183]
  v_mfma_f32_16x16x32_bf16 v[176:179], v[132:135], a[212:215], v[176:179]
  v_mfma_f32_16x16x32_bf16 v[180:183], v[156:159], a[212:215], v[180:183]
  v_mfma_f32_16x16x32_bf16 v[184:187], v[112:115], a[216:219], 0
  v_mfma_f32_16x16x32_bf16 v[188:191], v[136:139], a[216:219], 0
  v_mfma_f32_16x16x32_bf16 v[184:187], v[116:119], a[220:223], v[184:187]
  v_cvt_pk_bf16_f32 v200, v176, v177
  v_cvt_pk_bf16_f32 v201, v178, v179
  v_mfma_f32_16x16x32_bf16 v[188:191], v[140:143], a[220:223], v[188:191]
  v_cvt_pk_bf16_f32 v202, v180, v181
  v_cvt_pk_bf16_f32 v203, v182, v183
  v_mfma_f32_16x16x32_bf16 v[184:187], v[120:123], a[224:227], v[184:187]
  buffer_store_dwordx4 v[200:203], v4, s[16:19], s57 offen offset:2048 sc1
  v_mfma_f32_16x16x32_bf16 v[188:191], v[144:147], a[224:227], v[188:191]
  v_mfma_f32_16x16x32_bf16 v[184:187], v[124:127], a[228:231], v[184:187]
  s_mov_b32 s51, s57
  s_add_u32 s57, s56, 4096
  s_add_u32 s45, s45, 1
  v_mfma_f32_16x16x32_bf16 v[188:191], v[148:151], a[228:231], v[188:191]
  v_mfma_f32_16x16x32_bf16 v[184:187], v[128:131], a[232:235], v[184:187]
  v_mfma_f32_16x16x32_bf16 v[188:191], v[152:155], a[232:235], v[188:191]
  v_mfma_f32_16x16x32_bf16 v[184:187], v[132:135], a[236:239], v[184:187]
  s_cmp_lt_u32 s45, s46
  v_mfma_f32_16x16x32_bf16 v[188:191], v[156:159], a[236:239], v[188:191]
  s_waitcnt lgkmcnt(0)
  s_cbranch_scc1 vwl_214
  s_nop 7
  v_cvt_pk_bf16_f32 v204, v184, v185
  v_cvt_pk_bf16_f32 v205, v186, v187
  v_cvt_pk_bf16_f32 v206, v188, v189
  v_cvt_pk_bf16_f32 v207, v190, v191
  buffer_store_dwordx4 v[204:207], v4, s[16:19], s51 offen offset:3072 sc1
  s_min_u32 s21, s45, 52
  v_mov_b32 v16, s21
  s_barrier
  s_mov_b32 s46, s42
  s_cmp_gt_u32 s42, s45
  s_cbranch_scc1 vwr_213
  s_cmp_lt_u32 s45, 64
  s_cbranch_scc1 vwr_208
  v_mov_b32 v244, -1
  v_mov_b32 v245, -1
  v_mov_b32 v246, -1
  v_mov_b32 v247, -1
  v_lshlrev_b32 v21, 3, v1
  s_lshr_b32 s21, s2, 2
  s_lshl_b32 s21, s21, 2
  s_add_u32 s21, s21, s20
  s_lshl_b32 s21, s21, 2
  s_and_b32 s22, s2, 3
  s_add_u32 s21, s21, s22
  s_lshl_b32 s21, s21, 14
  s_xor_b32 s22, s21, s80
  s_xor_b32 s21, s22, 117444608
  buffer_store_dwordx4 v[244:247], v4, s[16:19], s21 offen offset:0 sc1
  buffer_store_dwordx4 v[244:247], v4, s[16:19], s21 offen offset:1024 sc1
  buffer_store_dwordx4 v[244:247], v4, s[16:19], s21 offen offset:2048 sc1
  buffer_store_dwordx4 v[244:247], v4, s[16:19], s21 offen offset:3072 sc1
  s_xor_b32 s21, s22, 119549952
  buffer_store_dwordx4 v[244:247], v4, s[16:19], s21 offen offset:0 sc1
  buffer_store_dwordx4 v[244:247], v4, s[16:19], s21 offen offset:1024 sc1
  buffer_store_dwordx4 v[244:247], v4, s[16:19], s21 offen offset:2048 sc1
  buffer_store_dwordx4 v[244:247], v4, s[16:19], s21 offen offset:3072 sc1
  s_xor_b32 s21, s22, 121638912
  buffer_store_dwordx4 v[244:247], v4, s[16:19], s21 offen offset:0 sc1
  buffer_store_dwordx4 v[244:247], v4, s[16:19], s21 offen offset:1024 sc1
  buffer_store_dwordx4 v[244:247], v4, s[16:19], s21 offen offset:2048 sc1
  buffer_store_dwordx4 v[244:247], v4, s[16:19], s21 offen offset:3072 sc1
  s_xor_b32 s21, s22, 123744256
  buffer_store_dwordx4 v[244:247], v4, s[16:19], s21 offen offset:0 sc1
  buffer_store_dwordx4 v[244:247], v4, s[16:19], s21 offen offset:1024 sc1
  buffer_store_dwordx4 v[244:247], v4, s[16:19], s21 offen offset:2048 sc1
  buffer_store_dwordx4 v[244:247], v4, s[16:19], s21 offen offset:3072 sc1
  s_xor_b32 s21, s22, 125833216
  buffer_store_dwordx4 v[244:247], v4, s[16:19], s21 offen offset:0 sc1
  buffer_store_dwordx4 v[244:247], v4, s[16:19], s21 offen offset:1024 sc1
  buffer_store_dwordx4 v[244:247], v4, s[16:19], s21 offen offset:2048 sc1
  buffer_store_dwordx4 v[244:247], v4, s[16:19], s21 offen offset:3072 sc1
  s_xor_b32 s21, s22, 127938560
  buffer_store_dwordx4 v[244:247], v4, s[16:19], s21 offen offset:0 sc1
  buffer_store_dwordx4 v[244:247], v4, s[16:19], s21 offen offset:1024 sc1
  buffer_store_dwordx4 v[244:247], v4, s[16:19], s21 offen offset:2048 sc1
  buffer_store_dwordx4 v[244:247], v4, s[16:19], s21 offen offset:3072 sc1
  s_xor_b32 s21, s22, 130027520
  buffer_store_dwordx4 v[244:247], v4, s[16:19], s21 offen offset:0 sc1
  buffer_store_dwordx4 v[244:247], v4, s[16:19], s21 offen offset:1024 sc1
  buffer_store_dwordx4 v[244:247], v4, s[16:19], s21 offen offset:2048 sc1
  buffer_store_dwordx4 v[244:247], v4, s[16:19], s21 offen offset:3072 sc1
  s_xor_b32 s21, s22, 132132864
  buffer_store_dwordx4 v[244:247], v4, s[16:19], s21 offen offset:0 sc1
  buffer_store_dwordx4 v[244:247], v4, s[16:19], s21 offen offset:1024 sc1
  buffer_store_dwordx4 v[244:247], v4, s[16:19], s21 offen offset:2048 sc1
  buffer_store_dwordx4 v[244:247], v4, s[16:19], s21 offen offset:3072 sc1
  s_and_b32 s21, s2, 3
  s_cmp_lg_u32 s21, s20
  s_cbranch_scc1 arm_215
  s_lshr_b32 s21, s2, 1
  s_lshl_b32 s21, s21, 14
  s_and_b32 s22, s2, 1
  s_mul_i32 s22, s22, 2560
  s_add_u32 s21, s21, s22
  s_xor_b32 s22, s21, s80
  s_xor_b32 s21, s22, 163586048
  buffer_store_dwordx4 v[244:247], v4, s[16:19], s21 offen sc1
  buffer_store_dwordx4 v[244:247], v4, s[16:19], s21 offen offset:1024 sc1
  buffer_store_dwordx2 v[244:245], v21, s[16:19], s21 offen offset:2048 sc1
  s_xor_b32 s21, s22, 164110336
  buffer_store_dwordx4 v[244:247], v4, s[16:19], s21 offen sc1
  buffer_store_dwordx4 v[244:247], v4, s[16:19], s21 offen offset:1024 sc1
  buffer_store_dwordx2 v[244:245], v21, s[16:19], s21 offen offset:2048 sc1
  s_xor_b32 s21, s22, 164634624
  buffer_store_dwordx4 v[244:247], v4, s[16:19], s21 offen sc1
  buffer_store_dwordx4 v[244:247], v4, s[16:19], s21 offen offset:1024 sc1
  buffer_store_dwordx2 v[244:245], v21, s[16:19], s21 offen offset:2048 sc1
  s_xor_b32 s21, s22, 165158912
  buffer_store_dwordx4 v[244:247], v4, s[16:19], s21 offen sc1
  buffer_store_dwordx4 v[244:247], v4, s[16:19], s21 offen offset:1024 sc1
  buffer_store_dwordx2 v[244:245], v21, s[16:19], s21 offen offset:2048 sc1
  s_xor_b32 s21, s22, 165675008
  buffer_store_dwordx4 v[244:247], v4, s[16:19], s21 offen sc1
  buffer_store_dwordx4 v[244:247], v4, s[16:19], s21 offen offset:1024 sc1
  buffer_store_dwordx2 v[244:245], v21, s[16:19], s21 offen offset:2048 sc1
  s_xor_b32 s21, s22, 166199296
  buffer_store_dwordx4 v[244:247], v4, s[16:19], s21 offen sc1
  buffer_store_dwordx4 v[244:247], v4, s[16:19], s21 offen offset:1024 sc1
  buffer_store_dwordx2 v[244:245], v21, s[16:19], s21 offen offset:2048 sc1
  s_xor_b32 s21, s22, 166723584
  buffer_store_dwordx4 v[244:247], v4, s[16:19], s21 offen sc1
  buffer_store_dwordx4 v[244:247], v4, s[16:19], s21 offen offset:1024 sc1
  buffer_store_dwordx2 v[244:245], v21, s[16:19], s21 offen offset:2048 sc1
  s_xor_b32 s21, s22, 167247872
  buffer_store_dwordx4 v[244:247], v4, s[16:19], s21 offen sc1
  buffer_store_dwordx4 v[244:247], v4, s[16:19], s21 offen offset:1024 sc1
  buffer_store_dwordx2 v[244:245], v21, s[16:19], s21 offen offset:2048 sc1
arm_215:
  v_mov_b32 v16, 64
  s_waitcnt vmcnt(0)
  buffer_store_dword v16, v17, s[72:75], s44 offen sc1
  s_branch queue
not_vw:
  s_sub_u32 s2, s3, 96
  s_cmp_lg_u32 s2, 31
  s_cbranch_scc1 not_cal
  s_load_dwordx2 s[72:73], s[0:1], 104
  s_waitcnt lgkmcnt(0)
  s_add_u32 s72, s72, 173080576
  s_addc_u32 s73, s73, 0
  s_mov_b32 s74, 49152
  s_mov_b32 s75, 0x00020000
  v_lshlrev_b32 v8, 4, v0
  v_mov_b32 v4, 0
  v_mov_b32 v5, 0
  v_mov_b32 v6, 0
  v_mov_b32 v7, 0
  s_mov_b32 s21, 0
  buffer_store_dwordx4 v[4:7], v8, s[72:75], s21 offen sc1
  s_mov_b32 s21, 4096
  buffer_store_dwordx4 v[4:7], v8, s[72:75], s21 offen sc1
  s_mov_b32 s21, 8192
  buffer_store_dwordx4 v[4:7], v8, s[72:75], s21 offen sc1
  s_mov_b32 s21, 12288
  buffer_store_dwordx4 v[4:7], v8, s[72:75], s21 offen sc1
  s_mov_b32 s21, 16384
  buffer_store_dwordx4 v[4:7], v8, s[72:75], s21 offen sc1
  s_mov_b32 s21, 20480
  buffer_store_dwordx4 v[4:7], v8, s[72:75], s21 offen sc1
  s_mov_b32 s21, 24576
  buffer_store_dwordx4 v[4:7], v8, s[72:75], s21 offen sc1
  s_mov_b32 s21, 28672
  buffer_store_dwordx4 v[4:7], v8, s[72:75], s21 offen sc1
  s_mov_b32 s21, 32768
  buffer_store_dwordx4 v[4:7], v8, s[72:75], s21 offen sc1
  s_mov_b32 s21, 36864
  buffer_store_dwordx4 v[4:7], v8, s[72:75], s21 offen sc1
  s_mov_b32 s21, 40960
  buffer_store_dwordx4 v[4:7], v8, s[72:75], s21 offen sc1
  s_mov_b32 s21, 45056
  buffer_store_dwordx4 v[4:7], v8, s[72:75], s21 offen sc1
  s_add_u32 s8, s38, 173015040
  s_addc_u32 s9, s39, 0
  s_mov_b32 s10, 131072
  s_mov_b32 s11, 0x00020000
  s_cmp_lg_u32 s20, 0
  s_cbranch_scc1 cal_216
  s_mov_b32 s40, -1
  s_mov_b32 s41, -1
  s_mov_b32 s43, 0
cal_217:
  s_mov_b32 s21, 0
  s_memtime s[98:99]
  s_waitcnt lgkmcnt(0)
  s_buffer_load_dword s22, s[8:11], s21 glc
  s_waitcnt lgkmcnt(0)
  s_memtime s[100:101]
  s_waitcnt lgkmcnt(0)
  s_sub_u32 s21, s100, s98
  s_min_u32 s40, s40, s21
  s_mov_b32 s21, 8192
  s_memtime s[98:99]
  s_waitcnt lgkmcnt(0)
  s_buffer_load_dword s22, s[8:11], s21 glc
  s_waitcnt lgkmcnt(0)
  s_memtime s[100:101]
  s_waitcnt lgkmcnt(0)
  s_sub_u32 s21, s100, s98
  s_min_u32 s41, s41, s21
  s_add_u32 s43, s43, 1
  s_cmp_lt_u32 s43, 6
  s_cbranch_scc1 cal_217
cal_216:
  s_waitcnt vmcnt(0)
  s_barrier
  s_cmp_lg_u32 s20, 0
  s_cbranch_scc1 cal_218
  s_cmp_lt_u32 s41, s40
  s_cselect_b32 s21, 1, 2
  v_mov_b32 v4, s21
  v_mov_b32 v5, s40
  v_mov_b32 v6, s41
  v_mov_b32 v8, 76
  s_mov_b64 exec, 1
  buffer_store_dwordx3 v[4:6], v8, s[32:35], 0 offen sc1
  s_mov_b64 exec, -1
cal_218:
not_cal:
  s_load_dwordx2 s[4:5], s[0:1], 0
  s_load_dwordx2 s[6:7], s[0:1], 64
  s_load_dwordx2 s[38:39], s[0:1], 104
  s_lshr_b32 s41, s2, 3
  s_lshl_b32 s41, s41, 1
  s_and_b32 s21, s2, 1
  s_add_u32 s41, s41, s21
  s_bfe_u32 s42, s2, 0x20001
  s_waitcnt lgkmcnt(0)
  s_mov_b32 s8, s4
  s_mov_b32 s9, s5
  s_mov_b32 s10, 2621440
  s_mov_b32 s11, 0x00020000
  s_mov_b32 s12, s6
  s_mov_b32 s13, s7
  s_mov_b32 s14, 2457600
  s_mov_b32 s15, 0x00020000
  s_mov_b32 s16, s38
  s_mov_b32 s17, s39
  s_mov_b32 s18, 171966464
  s_mov_b32 s19, 0x00020000
  s_add_u32 s72, s38, 173080576
  s_addc_u32 s73, s39, 0
  s_mov_b32 s74, 49152
  s_mov_b32 s75, 0x00020000
  v_lshrrev_b32 v8, 5, v1
  v_or_b32 v9, 0, v8
  v_and_b32 v10, 31, v1
  v_lshlrev_b32 v9, 1, v9
  v_xor_b32 v10, v10, v9
  v_mul_u32_u24 v9, 6554, v10
  v_lshrrev_b32 v9, 16, v9
  v_mul_u32_u24 v11, 1120, v9
  v_lshl_add_u32 v11, v10, 4, v11
  v_mul_u32_u24 v8, 3840, v8
  v_add_u32 v11, v11, v8
  v_mov_b32 v9, 1073741824
  v_cmp_gt_u32 vcc, 30, v10
  s_nop 1
  v_cndmask_b32 v4, v9, v11, vcc
  v_lshrrev_b32 v8, 5, v1
  v_or_b32 v9, 2, v8
  v_and_b32 v10, 31, v1
  v_lshlrev_b32 v9, 1, v9
  v_xor_b32 v10, v10, v9
  v_mul_u32_u24 v9, 6554, v10
  v_lshrrev_b32 v9, 16, v9
  v_mul_u32_u24 v11, 1120, v9
  v_lshl_add_u32 v11, v10, 4, v11
  v_mul_u32_u24 v8, 3840, v8
  v_add_u32 v11, v11, v8
  v_mov_b32 v9, 1073741824
  v_cmp_gt_u32 vcc, 30, v10
  s_nop 1
  v_cndmask_b32 v5, v9, v11, vcc
  v_lshrrev_b32 v8, 5, v1
  v_or_b32 v9, 4, v8
  v_and_b32 v10, 31, v1
  v_lshlrev_b32 v9, 1, v9
  v_xor_b32 v10, v10, v9
  v_mul_u32_u24 v9, 6554, v10
  v_lshrrev_b32 v9, 16, v9
  v_mul_u32_u24 v11, 1120, v9
  v_lshl_add_u32 v11, v10, 4, v11
  v_mul_u32_u24 v8, 3840, v8
  v_add_u32 v11, v11, v8
  v_mov_b32 v9, 1073741824
  v_cmp_gt_u32 vcc, 30, v10
  s_nop 1
  v_cndmask_b32 v6, v9, v11, vcc
  v_lshrrev_b32 v8, 5, v1
  v_or_b32 v9, 6, v8
  v_and_b32 v10, 31, v1
  v_lshlrev_b32 v9, 1, v9
  v_xor_b32 v10, v10, v9
  v_mul_u32_u24 v9, 6554, v10
  v_lshrrev_b32 v9, 16, v9
  v_mul_u32_u24 v11, 1120, v9
  v_lshl_add_u32 v11, v10, 4, v11
  v_mul_u32_u24 v8, 3840, v8
  v_add_u32 v11, v11, v8
  v_mov_b32 v9, 1073741824
  v_cmp_gt_u32 vcc, 30, v10
  s_nop 1
  v_cndmask_b32 v7, v9, v11, vcc
  s_mul_i32 s44, s41, 160
  s_mul_i32 s21, s20, 122880
  s_add_u32 s44, s44, s21
  s_lshl_b32 s45, s20, 14
  s_add_u32 s21, s44, 0
  s_add_u32 m0, s45, 0
  s_nop 0
  buffer_load_dwordx4 v4, s[12:15], s21 offen lds
  s_add_u32 s21, s44, 7680
  s_add_u32 m0, s45, 1024
  s_nop 0
  buffer_load_dwordx4 v5, s[12:15], s21 offen lds
  s_add_u32 s21, s44, 15360
  s_add_u32 m0, s45, 2048
  s_nop 0
  buffer_load_dwordx4 v4, s[12:15], s21 offen lds
  s_add_u32 s21, s44, 23040
  s_add_u32 m0, s45, 3072
  s_nop 0
  buffer_load_dwordx4 v5, s[12:15], s21 offen lds
  s_add_u32 s21, s44, 30720
  s_add_u32 m0, s45, 4096
  s_nop 0
  buffer_load_dwordx4 v6, s[12:15], s21 offen lds
  s_add_u32 s21, s44, 38400
  s_add_u32 m0, s45, 5120
  s_nop 0
  buffer_load_dwordx4 v7, s[12:15], s21 offen lds
  s_add_u32 s21, s44, 46080
  s_add_u32 m0, s45, 6144
  s_nop 0
  buffer_load_dwordx4 v6, s[12:15], s21 offen lds
  s_add_u32 s21, s44, 53760
  s_add_u32 m0, s45, 7168
  s_nop 0
  buffer_load_dwordx4 v7, s[12:15], s21 offen lds
  s_add_u32 s21, s44, 61440
  s_add_u32 m0, s45, 8192
  s_nop 0
  buffer_load_dwordx4 v4, s[12:15], s21 offen lds
  s_add_u32 s21, s44, 69120
  s_add_u32 m0, s45, 9216
  s_nop 0
  buffer_load_dwordx4 v5, s[12:15], s21 offen lds
  s_add_u32 s21, s44, 76800
  s_add_u32 m0, s45, 10240
  s_nop 0
  buffer_load_dwordx4 v4, s[12:15], s21 offen lds
  s_add_u32 s21, s44, 84480
  s_add_u32 m0, s45, 11264
  s_nop 0
  buffer_load_dwordx4 v5, s[12:15], s21 offen lds
  s_add_u32 s21, s44, 92160
  s_add_u32 m0, s45, 12288
  s_nop 0
  buffer_load_dwordx4 v6, s[12:15], s21 offen lds
  s_add_u32 s21, s44, 99840
  s_add_u32 m0, s45, 13312
  s_nop 0
  buffer_load_dwordx4 v7, s[12:15], s21 offen lds
  s_add_u32 s21, s44, 107520
  s_add_u32 m0, s45, 14336
  s_nop 0
  buffer_load_dwordx4 v6, s[12:15], s21 offen lds
  s_add_u32 s21, s44, 115200
  s_add_u32 m0, s45, 15360
  s_nop 0
  buffer_load_dwordx4 v7, s[12:15], s21 offen lds
  s_add_u32 s21, s44, 491520
  s_add_u32 m0, s45, 65536
  s_nop 0
  buffer_load_dwordx4 v4, s[12:15], s21 offen lds
  s_add_u32 s21, s44, 499200
  s_add_u32 m0, s45, 66560
  s_nop 0
  buffer_load_dwordx4 v5, s[12:15], s21 offen lds
  s_add_u32 s21, s44, 506880
  s_add_u32 m0, s45, 67584
  s_nop 0
  buffer_load_dwordx4 v4, s[12:15], s21 offen lds
  s_add_u32 s21, s44, 514560
  s_add_u32 m0, s45, 68608
  s_nop 0
  buffer_load_dwordx4 v5, s[12:15], s21 offen lds
  s_add_u32 s21, s44, 522240
  s_add_u32 m0, s45, 69632
  s_nop 0
  buffer_load_dwordx4 v6, s[12:15], s21 offen lds
  s_add_u32 s21, s44, 529920
  s_add_u32 m0, s45, 70656
  s_nop 0
  buffer_load_dwordx4 v7, s[12:15], s21 offen lds
  s_add_u32 s21, s44, 537600
  s_add_u32 m0, s45, 71680
  s_nop 0
  buffer_load_dwordx4 v6, s[12:15], s21 offen lds
  s_add_u32 s21, s44, 545280
  s_add_u32 m0, s45, 72704
  s_nop 0
  buffer_load_dwordx4 v7, s[12:15], s21 offen lds
  s_add_u32 s21, s44, 552960
  s_add_u32 m0, s45, 73728
  s_nop 0
  buffer_load_dwordx4 v4, s[12:15], s21 offen lds
  s_add_u32 s21, s44, 560640
  s_add_u32 m0, s45, 74752
  s_nop 0
  buffer_load_dwordx4 v5, s[12:15], s21 offen lds
  s_add_u32 s21, s44, 568320
  s_add_u32 m0, s45, 75776
  s_nop 0
  buffer_load_dwordx4 v4, s[12:15], s21 offen lds
  s_add_u32 s21, s44, 576000
  s_add_u32 m0, s45, 76800
  s_nop 0
  buffer_load_dwordx4 v5, s[12:15], s21 offen lds
  s_add_u32 s21, s44, 583680
  s_add_u32 m0, s45, 77824
  s_nop 0
  buffer_load_dwordx4 v6, s[12:15], s21 offen lds
  s_add_u32 s21, s44, 591360
  s_add_u32 m0, s45, 78848
  s_nop 0
  buffer_load_dwordx4 v7, s[12:15], s21 offen lds
  s_add_u32 s21, s44, 599040
  s_add_u32 m0, s45, 79872
  s_nop 0
  buffer_load_dwordx4 v6, s[12:15], s21 offen lds
  s_add_u32 s21, s44, 606720
  s_add_u32 m0, s45, 80896
  s_nop 0
  buffer_load_dwordx4 v7, s[12:15], s21 offen lds
  s_add_u32 s21, s44, 983040
  buffer_load_dwordx4 v[64:67], v4, s[12:15], s21 offen
  s_add_u32 s21, s44, 990720
  buffer_load_dwordx4 v[68:71], v5, s[12:15], s21 offen
  s_add_u32 s21, s44, 998400
  buffer_load_dwordx4 v[72:75], v4, s[12:15], s21 offen
  s_add_u32 s21, s44, 1006080
  buffer_load_dwordx4 v[76:79], v5, s[12:15], s21 offen
  s_add_u32 s21, s44, 1013760
  buffer_load_dwordx4 v[80:83], v6, s[12:15], s21 offen
  s_add_u32 s21, s44, 1021440
  buffer_load_dwordx4 v[84:87], v7, s[12:15], s21 offen
  s_add_u32 s21, s44, 1029120
  buffer_load_dwordx4 v[88:91], v6, s[12:15], s21 offen
  s_add_u32 s21, s44, 1036800
  buffer_load_dwordx4 v[92:95], v7, s[12:15], s21 offen
  s_add_u32 s21, s44, 1044480
  buffer_load_dwordx4 v[96:99], v4, s[12:15], s21 offen
  s_add_u32 s21, s44, 1052160
  buffer_load_dwordx4 v[100:103], v5, s[12:15], s21 offen
  s_add_u32 s21, s44, 1059840
  buffer_load_dwordx4 v[104:107], v4, s[12:15], s21 offen
  s_add_u32 s21, s44, 1067520
  buffer_load_dwordx4 v[108:111], v5, s[12:15], s21 offen
  s_add_u32 s21, s44, 1075200
  buffer_load_dwordx4 v[112:115], v6, s[12:15], s21 offen
  s_add_u32 s21, s44, 1082880
  buffer_load_dwordx4 v[116:119], v7, s[12:15], s21 offen
  s_add_u32 s21, s44, 1090560
  buffer_load_dwordx4 v[120:123], v6, s[12:15], s21 offen
  s_add_u32 s21, s44, 1098240
  buffer_load_dwordx4 v[124:127], v7, s[12:15], s21 offen
  v_lshrrev_b32 v8, 2, v2
  v_and_b32 v9, 1, v3
  v_lshl_add_u32 v9, v9, 2, v8
  v_lshlrev_b32 v9, 5, v9
  v_lshl_add_u32 v8, v3, 3, v8
  v_lshlrev_b32 v8, 9, v8
  v_and_b32 v10, 3, v2
  s_mul_i32 s21, s20, 40
  v_lshl_add_u32 v11, v10, 3, s21
  v_add_u32 v11, 0, v11
  v_xor_b32 v11, v11, v9
  v_add_u32 v12, v11, v8
  v_add_u32 v16, 65536, v12
  v_lshl_add_u32 v11, v10, 3, s21
  v_add_u32 v11, 160, v11
  v_xor_b32 v11, v11, v9
  v_add_u32 v13, v11, v8
  v_add_u32 v17, 65536, v13
  v_mul_u32_u24 v11, 160, v10
  v_add3_u32 v11, v11, 32, s21
  v_min_u32 v11, 480, v11
  v_xor_b32 v11, v11, v9
  v_add_u32 v14, v11, v8
  v_add_u32 v18, 65536, v14
  v_lshl_add_u32 v11, v10, 3, s21
  v_add_u32 v11, 320, v11
  v_xor_b32 v11, v11, v9
  v_add_u32 v15, v11, v8
  v_add_u32 v19, 65536, v15
  v_lshl_add_u32 v23, v1, 4, s45
  v_add_u32 v29, 65536, v23
  s_waitcnt vmcnt(32)
  s_add_u32 s21, s44, 1474560
  buffer_load_dwordx4 v[128:131], v4, s[12:15], s21 offen
  s_add_u32 s21, s44, 1482240
  buffer_load_dwordx4 v[132:135], v5, s[12:15], s21 offen
  s_add_u32 s21, s44, 1489920
  buffer_load_dwordx4 v[136:139], v4, s[12:15], s21 offen
  s_add_u32 s21, s44, 1497600
  buffer_load_dwordx4 v[140:143], v5, s[12:15], s21 offen
  s_add_u32 s21, s44, 1505280
  buffer_load_dwordx4 v[144:147], v6, s[12:15], s21 offen
  s_add_u32 s21, s44, 1512960
  buffer_load_dwordx4 v[148:151], v7, s[12:15], s21 offen
  s_add_u32 s21, s44, 1520640
  buffer_load_dwordx4 v[152:155], v6, s[12:15], s21 offen
  s_add_u32 s21, s44, 1528320
  buffer_load_dwordx4 v[156:159], v7, s[12:15], s21 offen
  s_add_u32 s21, s44, 1536000
  buffer_load_dwordx4 v[160:163], v4, s[12:15], s21 offen
  s_add_u32 s21, s44, 1543680
  buffer_load_dwordx4 v[164:167], v5, s[12:15], s21 offen
  s_add_u32 s21, s44, 1551360
  buffer_load_dwordx4 v[168:171], v4, s[12:15], s21 offen
  s_add_u32 s21, s44, 1559040
  buffer_load_dwordx4 v[172:175], v5, s[12:15], s21 offen
  s_add_u32 s21, s44, 1566720
  buffer_load_dwordx4 v[176:179], v6, s[12:15], s21 offen
  s_add_u32 s21, s44, 1574400
  buffer_load_dwordx4 v[180:183], v7, s[12:15], s21 offen
  s_add_u32 s21, s44, 1582080
  buffer_load_dwordx4 v[184:187], v6, s[12:15], s21 offen
  s_add_u32 s21, s44, 1589760
  buffer_load_dwordx4 v[188:191], v7, s[12:15], s21 offen
  s_barrier
  ds_read_b64_tr_b16 a[0:1], v12 offset:0
  ds_read_b64_tr_b16 a[2:3], v12 offset:2048
  ds_read_b64_tr_b16 a[4:5], v13 offset:0
  ds_read_b64_tr_b16 a[6:7], v13 offset:2048
  ds_read_b64_tr_b16 a[8:9], v14 offset:0
  ds_read_b64_tr_b16 a[10:11], v14 offset:2048
  ds_read_b64_tr_b16 a[12:13], v15 offset:0
  ds_read_b64_tr_b16 a[14:15], v15 offset:2048
  ds_read_b64_tr_b16 a[16:17], v12 offset:16384
  ds_read_b64_tr_b16 a[18:19], v12 offset:18432
  ds_read_b64_tr_b16 a[20:21], v13 offset:16384
  ds_read_b64_tr_b16 a[22:23], v13 offset:18432
  ds_read_b64_tr_b16 a[24:25], v14 offset:16384
  ds_read_b64_tr_b16 a[26:27], v14 offset:18432
  ds_read_b64_tr_b16 a[28:29], v15 offset:16384
  ds_read_b64_tr_b16 a[30:31], v15 offset:18432
  ds_read_b64_tr_b16 a[32:33], v12 offset:32768
  ds_read_b64_tr_b16 a[34:35], v12 offset:34816
  ds_read_b64_tr_b16 a[36:37], v13 offset:32768
  ds_read_b64_tr_b16 a[38:39], v13 offset:34816
  ds_read_b64_tr_b16 a[40:41], v14 offset:32768
  ds_read_b64_tr_b16 a[42:43], v14 offset:34816
  ds_read_b64_tr_b16 a[44:45], v15 offset:32768
  ds_read_b64_tr_b16 a[46:47], v15 offset:34816
  ds_read_b64_tr_b16 a[48:49], v12 offset:49152
  ds_read_b64_tr_b16 a[50:51], v12 offset:51200
  ds_read_b64_tr_b16 a[52:53], v13 offset:49152
  ds_read_b64_tr_b16 a[54:55], v13 offset:51200
  ds_read_b64_tr_b16 a[56:57], v14 offset:49152
  ds_read_b64_tr_b16 a[58:59], v14 offset:51200
  ds_read_b64_tr_b16 a[60:61], v15 offset:49152
  ds_read_b64_tr_b16 a[62:63], v15 offset:51200
  s_waitcnt lgkmcnt(0)
  s_barrier
  s_waitcnt vmcnt(32)
  s_add_u32 s21, s44, 1966080
  buffer_load_dwordx4 v[192:195], v4, s[12:15], s21 offen
  s_add_u32 s21, s44, 1973760
  buffer_load_dwordx4 v[196:199], v5, s[12:15], s21 offen
  s_add_u32 s21, s44, 1981440
  buffer_load_dwordx4 v[200:203], v4, s[12:15], s21 offen
  s_add_u32 s21, s44, 1989120
  buffer_load_dwordx4 v[204:207], v5, s[12:15], s21 offen
  s_add_u32 s21, s44, 1996800
  buffer_load_dwordx4 v[208:211], v6, s[12:15], s21 offen
  s_add_u32 s21, s44, 2004480
  buffer_load_dwordx4 v[212:215], v7, s[12:15], s21 offen
  s_add_u32 s21, s44, 2012160
  buffer_load_dwordx4 v[216:219], v6, s[12:15], s21 offen
  s_add_u32 s21, s44, 2019840
  buffer_load_dwordx4 v[220:223], v7, s[12:15], s21 offen
  s_add_u32 s21, s44, 2027520
  buffer_load_dwordx4 v[224:227], v4, s[12:15], s21 offen
  s_add_u32 s21, s44, 2035200
  buffer_load_dwordx4 v[228:231], v5, s[12:15], s21 offen
  s_add_u32 s21, s44, 2042880
  buffer_load_dwordx4 v[232:235], v4, s[12:15], s21 offen
  s_add_u32 s21, s44, 2050560
  buffer_load_dwordx4 v[236:239], v5, s[12:15], s21 offen
  s_add_u32 s21, s44, 2058240
  buffer_load_dwordx4 v[240:243], v6, s[12:15], s21 offen
  s_add_u32 s21, s44, 2065920
  buffer_load_dwordx4 v[244:247], v7, s[12:15], s21 offen
  s_add_u32 s21, s44, 2073600
  buffer_load_dwordx4 v[248:251], v6, s[12:15], s21 offen
  s_add_u32 s21, s44, 2081280
  buffer_load_dwordx4 v[252:255], v7, s[12:15], s21 offen
  s_barrier
  ds_read_b64_tr_b16 a[64:65], v16 offset:0
  ds_read_b64_tr_b16 a[66:67], v16 offset:2048
  ds_read_b64_tr_b16 a[68:69], v17 offset:0
  ds_read_b64_tr_b16 a[70:71], v17 offset:2048
  ds_read_b64_tr_b16 a[72:73], v18 offset:0
  ds_read_b64_tr_b16 a[74:75], v18 offset:2048
  ds_read_b64_tr_b16 a[76:77], v19 offset:0
  ds_read_b64_tr_b16 a[78:79], v19 offset:2048
  ds_read_b64_tr_b16 a[80:81], v16 offset:16384
  ds_read_b64_tr_b16 a[82:83], v16 offset:18432
  ds_read_b64_tr_b16 a[84:85], v17 offset:16384
  ds_read_b64_tr_b16 a[86:87], v17 offset:18432
  ds_read_b64_tr_b16 a[88:89], v18 offset:16384
  ds_read_b64_tr_b16 a[90:91], v18 offset:18432
  ds_read_b64_tr_b16 a[92:93], v19 offset:16384
  ds_read_b64_tr_b16 a[94:95], v19 offset:18432
  ds_read_b64_tr_b16 a[96:97], v16 offset:32768
  ds_read_b64_tr_b16 a[98:99], v16 offset:34816
  ds_read_b64_tr_b16 a[100:101], v17 offset:32768
  ds_read_b64_tr_b16 a[102:103], v17 offset:34816
  ds_read_b64_tr_b16 a[104:105], v18 offset:32768
  ds_read_b64_tr_b16 a[106:107], v18 offset:34816
  ds_read_b64_tr_b16 a[108:109], v19 offset:32768
  ds_read_b64_tr_b16 a[110:111], v19 offset:34816
  ds_read_b64_tr_b16 a[112:113], v16 offset:49152
  ds_read_b64_tr_b16 a[114:115], v16 offset:51200
  ds_read_b64_tr_b16 a[116:117], v17 offset:49152
  ds_read_b64_tr_b16 a[118:119], v17 offset:51200
  ds_read_b64_tr_b16 a[120:121], v18 offset:49152
  ds_read_b64_tr_b16 a[122:123], v18 offset:51200
  ds_read_b64_tr_b16 a[124:125], v19 offset:49152
  ds_read_b64_tr_b16 a[126:127], v19 offset:51200
  s_waitcnt lgkmcnt(0)
  s_barrier
  s_waitcnt vmcnt(32)
  v_lshlrev_b32 v30, 4, v1
  s_load_dwordx2 s[36:37], s[0:1], 16
  s_lshl_b32 s23, s2, 2
  s_add_u32 s23, s23, s20
  s_mul_i32 s23, s23, 61440
  s_add_u32 s23, s23, 30720
  s_waitcnt lgkmcnt(0)
  s_mov_b32 s24, s36
  s_mov_b32 s25, s37
  s_mov_b32 s26, 7864320
  s_mov_b32 s27, 0x00020000
  buffer_load_dwordx4 v[32:35], v30, s[24:27], s23 offen offset:0
  buffer_load_dwordx4 v[32:35], v30, s[24:27], s23 offen offset:1024
  buffer_load_dwordx4 v[32:35], v30, s[24:27], s23 offen offset:2048
  buffer_load_dwordx4 v[32:35], v30, s[24:27], s23 offen offset:3072
  s_add_u32 s23, s23, 4096
  buffer_load_dwordx4 v[32:35], v30, s[24:27], s23 offen offset:0
  buffer_load_dwordx4 v[32:35], v30, s[24:27], s23 offen offset:1024
  buffer_load_dwordx4 v[32:35], v30, s[24:27], s23 offen offset:2048
  buffer_load_dwordx4 v[32:35], v30, s[24:27], s23 offen offset:3072
  s_add_u32 s23, s23, 4096
  buffer_load_dwordx4 v[32:35], v30, s[24:27], s23 offen offset:0
  buffer_load_dwordx4 v[32:35], v30, s[24:27], s23 offen offset:1024
  buffer_load_dwordx4 v[32:35], v30, s[24:27], s23 offen offset:2048
  buffer_load_dwordx4 v[32:35], v30, s[24:27], s23 offen offset:3072
  s_add_u32 s23, s23, 4096
  buffer_load_dwordx4 v[32:35], v30, s[24:27], s23 offen offset:0
  buffer_load_dwordx4 v[32:35], v30, s[24:27], s23 offen offset:1024
  buffer_load_dwordx4 v[32:35], v30, s[24:27], s23 offen offset:2048
  buffer_load_dwordx4 v[32:35], v30, s[24:27], s23 offen offset:3072
  s_add_u32 s23, s23, 4096
  buffer_load_dwordx4 v[32:35], v30, s[24:27], s23 offen offset:0
  buffer_load_dwordx4 v[32:35], v30, s[24:27], s23 offen offset:1024
  buffer_load_dwordx4 v[32:35], v30, s[24:27], s23 offen offset:2048
  buffer_load_dwordx4 v[32:35], v30, s[24:27], s23 offen offset:3072
  s_add_u32 s23, s23, 4096
  buffer_load_dwordx4 v[32:35], v30, s[24:27], s23 offen offset:0
  buffer_load_dwordx4 v[32:35], v30, s[24:27], s23 offen offset:1024
  buffer_load_dwordx4 v[32:35], v30, s[24:27], s23 offen offset:2048
  buffer_load_dwordx4 v[32:35], v30, s[24:27], s23 offen offset:3072
  s_add_u32 s23, s23, 4096
  buffer_load_dwordx4 v[32:35], v30, s[24:27], s23 offen offset:0
  buffer_load_dwordx4 v[32:35], v30, s[24:27], s23 offen offset:1024
  buffer_load_dwordx4 v[32:35], v30, s[24:27], s23 offen offset:2048
  buffer_load_dwordx4 v[32:35], v30, s[24:27], s23 offen offset:3072
  s_add_u32 s23, s23, 4096
  buffer_load_dwordx4 v[32:35], v30, s[24:27], s23 offen offset:0
  buffer_load_dwordx4 v[32:35], v30, s[24:27], s23 offen offset:1024
  ds_write_b128 v23, v[64:67] offset:0
  ds_write_b128 v23, v[68:71] offset:1024
  ds_write_b128 v23, v[72:75] offset:2048
  ds_write_b128 v23, v[76:79] offset:3072
  ds_write_b128 v23, v[80:83] offset:4096
  ds_write_b128 v23, v[84:87] offset:5120
  ds_write_b128 v23, v[88:91] offset:6144
  ds_write_b128 v23, v[92:95] offset:7168
  ds_write_b128 v23, v[96:99] offset:8192
  ds_write_b128 v23, v[100:103] offset:9216
  ds_write_b128 v23, v[104:107] offset:10240
  ds_write_b128 v23, v[108:111] offset:11264
  ds_write_b128 v23, v[112:115] offset:12288
  ds_write_b128 v23, v[116:119] offset:13312
  ds_write_b128 v23, v[120:123] offset:14336
  ds_write_b128 v23, v[124:127] offset:15360
  s_waitcnt lgkmcnt(0)
  s_barrier
  ds_read_b64_tr_b16 a[128:129], v12 offset:0
  ds_read_b64_tr_b16 a[130:131], v12 offset:2048
  ds_read_b64_tr_b16 a[132:133], v13 offset:0
  ds_read_b64_tr_b16 a[134:135], v13 offset:2048
  ds_read_b64_tr_b16 a[136:137], v14 offset:0
  ds_read_b64_tr_b16 a[138:139], v14 offset:2048
  ds_read_b64_tr_b16 a[140:141], v15 offset:0
  ds_read_b64_tr_b16 a[142:143], v15 offset:2048
  ds_read_b64_tr_b16 a[144:145], v12 offset:16384
  ds_read_b64_tr_b16 a[146:147], v12 offset:18432
  ds_read_b64_tr_b16 a[148:149], v13 offset:16384
  ds_read_b64_tr_b16 a[150:151], v13 offset:18432
  ds_read_b64_tr_b16 a[152:153], v14 offset:16384
  ds_read_b64_tr_b16 a[154:155], v14 offset:18432
  ds_read_b64_tr_b16 a[156:157], v15 offset:16384
  ds_read_b64_tr_b16 a[158:159], v15 offset:18432
  ds_read_b64_tr_b16 a[160:161], v12 offset:32768
  ds_read_b64_tr_b16 a[162:163], v12 offset:34816
  ds_read_b64_tr_b16 a[164:165], v13 offset:32768
  ds_read_b64_tr_b16 a[166:167], v13 offset:34816
  ds_read_b64_tr_b16 a[168:169], v14 offset:32768
  ds_read_b64_tr_b16 a[170:171], v14 offset:34816
  ds_read_b64_tr_b16 a[172:173], v15 offset:32768
  ds_read_b64_tr_b16 a[174:175], v15 offset:34816
  ds_read_b64_tr_b16 a[176:177], v12 offset:49152
  ds_read_b64_tr_b16 a[178:179], v12 offset:51200
  ds_read_b64_tr_b16 a[180:181], v13 offset:49152
  ds_read_b64_tr_b16 a[182:183], v13 offset:51200
  ds_read_b64_tr_b16 a[184:185], v14 offset:49152
  ds_read_b64_tr_b16 a[186:187], v14 offset:51200
  ds_read_b64_tr_b16 a[188:189], v15 offset:49152
  ds_read_b64_tr_b16 a[190:191], v15 offset:51200
  s_waitcnt lgkmcnt(0)
  s_barrier
  s_waitcnt vmcnt(46)
  ds_write_b128 v29, v[128:131] offset:0
  ds_write_b128 v29, v[132:135] offset:1024
  ds_write_b128 v29, v[136:139] offset:2048
  ds_write_b128 v29, v[140:143] offset:3072
  ds_write_b128 v29, v[144:147] offset:4096
  ds_write_b128 v29, v[148:151] offset:5120
  ds_write_b128 v29, v[152:155] offset:6144
  ds_write_b128 v29, v[156:159] offset:7168
  ds_write_b128 v29, v[160:163] offset:8192
  ds_write_b128 v29, v[164:167] offset:9216
  ds_write_b128 v29, v[168:171] offset:10240
  ds_write_b128 v29, v[172:175] offset:11264
  ds_write_b128 v29, v[176:179] offset:12288
  ds_write_b128 v29, v[180:183] offset:13312
  ds_write_b128 v29, v[184:187] offset:14336
  ds_write_b128 v29, v[188:191] offset:15360
  s_waitcnt lgkmcnt(0)
  s_barrier
  ds_read_b64_tr_b16 a[192:193], v16 offset:0
  ds_read_b64_tr_b16 a[194:195], v16 offset:2048
  ds_read_b64_tr_b16 a[196:197], v17 offset:0
  ds_read_b64_tr_b16 a[198:199], v17 offset:2048
  ds_read_b64_tr_b16 a[200:201], v18 offset:0
  ds_read_b64_tr_b16 a[202:203], v18 offset:2048
  ds_read_b64_tr_b16 a[204:205], v19 offset:0
  ds_read_b64_tr_b16 a[206:207], v19 offset:2048
  ds_read_b64_tr_b16 a[208:209], v16 offset:16384
  ds_read_b64_tr_b16 a[210:211], v16 offset:18432
  ds_read_b64_tr_b16 a[212:213], v17 offset:16384
  ds_read_b64_tr_b16 a[214:215], v17 offset:18432
  ds_read_b64_tr_b16 a[216:217], v18 offset:16384
  ds_read_b64_tr_b16 a[218:219], v18 offset:18432
  ds_read_b64_tr_b16 a[220:221], v19 offset:16384
  ds_read_b64_tr_b16 a[222:223], v19 offset:18432
  ds_read_b64_tr_b16 a[224:225], v16 offset:32768
  ds_read_b64_tr_b16 a[226:227], v16 offset:34816
  ds_read_b64_tr_b16 a[228:229], v17 offset:32768
  ds_read_b64_tr_b16 a[230:231], v17 offset:34816
  ds_read_b64_tr_b16 a[232:233], v18 offset:32768
  ds_read_b64_tr_b16 a[234:235], v18 offset:34816
  ds_read_b64_tr_b16 a[236:237], v19 offset:32768
  ds_read_b64_tr_b16 a[238:239], v19 offset:34816
  ds_read_b64_tr_b16 a[240:241], v16 offset:49152
  ds_read_b64_tr_b16 a[242:243], v16 offset:51200
  ds_read_b64_tr_b16 a[244:245], v17 offset:49152
  ds_read_b64_tr_b16 a[246:247], v17 offset:51200
  ds_read_b64_tr_b16 a[248:249], v18 offset:49152
  ds_read_b64_tr_b16 a[250:251], v18 offset:51200
  ds_read_b64_tr_b16 a[252:253], v19 offset:49152
  ds_read_b64_tr_b16 a[254:255], v19 offset:51200
  s_waitcnt lgkmcnt(0)
  s_barrier
  s_waitcnt vmcnt(30)
  ds_write_b128 v23, v[192:195] offset:0
  ds_write_b128 v23, v[196:199] offset:1024
  ds_write_b128 v23, v[200:203] offset:2048
  ds_write_b128 v23, v[204:207] offset:3072
  ds_write_b128 v23, v[208:211] offset:4096
  ds_write_b128 v23, v[212:215] offset:5120
  ds_write_b128 v23, v[216:219] offset:6144
  ds_write_b128 v23, v[220:223] offset:7168
  ds_write_b128 v23, v[224:227] offset:8192
  ds_write_b128 v23, v[228:231] offset:9216
  ds_write_b128 v23, v[232:235] offset:10240
  ds_write_b128 v23, v[236:239] offset:11264
  ds_write_b128 v23, v[240:243] offset:12288
  ds_write_b128 v23, v[244:247] offset:13312
  ds_write_b128 v23, v[248:251] offset:14336
  ds_write_b128 v23, v[252:255] offset:15360
  s_waitcnt lgkmcnt(0)
  s_barrier
  ds_read_b64_tr_b16 v[192:193], v12 offset:0
  ds_read_b64_tr_b16 v[194:195], v12 offset:2048
  ds_read_b64_tr_b16 v[196:197], v13 offset:0
  ds_read_b64_tr_b16 v[198:199], v13 offset:2048
  ds_read_b64_tr_b16 v[200:201], v14 offset:0
  ds_read_b64_tr_b16 v[202:203], v14 offset:2048
  ds_read_b64_tr_b16 v[204:205], v15 offset:0
  ds_read_b64_tr_b16 v[206:207], v15 offset:2048
  ds_read_b64_tr_b16 v[208:209], v12 offset:16384
  ds_read_b64_tr_b16 v[210:211], v12 offset:18432
  ds_read_b64_tr_b16 v[212:213], v13 offset:16384
  ds_read_b64_tr_b16 v[214:215], v13 offset:18432
  ds_read_b64_tr_b16 v[216:217], v14 offset:16384
  ds_read_b64_tr_b16 v[218:219], v14 offset:18432
  ds_read_b64_tr_b16 v[220:221], v15 offset:16384
  ds_read_b64_tr_b16 v[222:223], v15 offset:18432
  ds_read_b64_tr_b16 v[224:225], v12 offset:32768
  ds_read_b64_tr_b16 v[226:227], v12 offset:34816
  ds_read_b64_tr_b16 v[228:229], v13 offset:32768
  ds_read_b64_tr_b16 v[230:231], v13 offset:34816
  ds_read_b64_tr_b16 v[232:233], v14 offset:32768
  ds_read_b64_tr_b16 v[234:235], v14 offset:34816
  ds_read_b64_tr_b16 v[236:237], v15 offset:32768
  ds_read_b64_tr_b16 v[238:239], v15 offset:34816
  ds_read_b64_tr_b16 v[240:241], v12 offset:49152
  ds_read_b64_tr_b16 v[242:243], v12 offset:51200
  ds_read_b64_tr_b16 v[244:245], v13 offset:49152
  ds_read_b64_tr_b16 v[246:247], v13 offset:51200
  ds_read_b64_tr_b16 v[248:249], v14 offset:49152
  ds_read_b64_tr_b16 v[250:251], v14 offset:51200
  ds_read_b64_tr_b16 v[252:253], v15 offset:49152
  ds_read_b64_tr_b16 v[254:255], v15 offset:51200
  s_waitcnt lgkmcnt(0)
  s_barrier
  s_load_dwordx2 s[32:33], s[0:1], 96
  s_waitcnt lgkmcnt(0)
  s_mov_b32 s32, s32
  s_mov_b32 s33, s33
  s_mov_b32 s34, 256
  s_mov_b32 s35, 0x00020000
  s_mov_b32 s21, 76
  v_mov_b32 v4, 0
  s_mov_b32 s101, 0
wf_219:
  buffer_load_dword v5, v4, s[32:35], s21 offen sc1
  s_add_u32 s101, s101, 1
  s_cmp_gt_u32 s101, 131072
  s_cbranch_scc1 main_end
  s_waitcnt vmcnt(0)
  v_readfirstlane_b32 s100, v5
  s_cmp_ge_u32 s100, 1
  s_cbranch_scc1 wf_220
  s_sleep 8
  s_branch wf_219
wf_220:
  s_sub_u32 s80, s100, 1
  s_lshl_b32 s80, s80, 13
  v_lshrrev_b32 v8, 3, v1
  v_and_b32 v9, 7, v1
  v_xor_b32 v9, v9, v8
  s_and_b32 s21, s20, 1
  s_lshl_b32 s21, s21, 4
  s_lshr_b32 s22, s20, 1
  s_add_u32 s21, s21, s22
  v_lshl_add_u32 v8, v8, 1, s21
  v_mul_u32_u24 v8, 1280, v8
  v_lshl_add_u32 v4, v9, 4, v8
  s_lshl_b32 s31, s20, 10
  s_mul_i32 s30, s42, 655360
  s_sub_u32 s46, s30, 40960
  s_cmp_eq_u32 s42, 0
  s_cselect_b32 s46, 1073741824, s46
  s_add_u32 m0, s31, 0
  s_nop 0
  buffer_load_dwordx4 v4, s[8:11], s46 offen offset:0 lds
  s_add_u32 m0, s31, 3968
  s_nop 0
  buffer_load_dwordx4 v4, s[8:11], s46 offen offset:128 lds
  s_add_u32 m0, s31, 7936
  s_nop 0
  buffer_load_dwordx4 v4, s[8:11], s46 offen offset:256 lds
  s_add_u32 m0, s31, 11904
  s_nop 0
  buffer_load_dwordx4 v4, s[8:11], s46 offen offset:384 lds
  s_add_u32 m0, s31, 15872
  s_nop 0
  buffer_load_dwordx4 v4, s[8:11], s46 offen offset:512 lds
  s_add_u32 m0, s31, 19840
  s_nop 0
  buffer_load_dwordx4 v4, s[8:11], s46 offen offset:640 lds
  s_add_u32 m0, s31, 23808
  s_nop 0
  buffer_load_dwordx4 v4, s[8:11], s46 offen offset:768 lds
  s_add_u32 m0, s31, 27776
  s_nop 0
  buffer_load_dwordx4 v4, s[8:11], s46 offen offset:896 lds
  s_add_u32 m0, s31, 31744
  s_nop 0
  buffer_load_dwordx4 v4, s[8:11], s46 offen offset:1024 lds
  s_add_u32 m0, s31, 35712
  s_nop 0
  buffer_load_dwordx4 v4, s[8:11], s46 offen offset:1152 lds
  s_add_u32 s31, s31, 40960
  s_add_u32 m0, s31, 0
  s_nop 0
  buffer_load_dwordx4 v4, s[8:11], s30 offen offset:0 lds
  s_add_u32 m0, s31, 3968
  s_nop 0
  buffer_load_dwordx4 v4, s[8:11], s30 offen offset:128 lds
  s_add_u32 m0, s31, 7936
  s_nop 0
  buffer_load_dwordx4 v4, s[8:11], s30 offen offset:256 lds
  s_add_u32 m0, s31, 11904
  s_nop 0
  buffer_load_dwordx4 v4, s[8:11], s30 offen offset:384 lds
  s_add_u32 m0, s31, 15872
  s_nop 0
  buffer_load_dwordx4 v4, s[8:11], s30 offen offset:512 lds
  s_add_u32 m0, s31, 19840
  s_nop 0
  buffer_load_dwordx4 v4, s[8:11], s30 offen offset:640 lds
  s_add_u32 m0, s31, 23808
  s_nop 0
  buffer_load_dwordx4 v4, s[8:11], s30 offen offset:768 lds
  s_add_u32 m0, s31, 27776
  s_nop 0
  buffer_load_dwordx4 v4, s[8:11], s30 offen offset:896 lds
  s_add_u32 m0, s31, 31744
  s_nop 0
  buffer_load_dwordx4 v4, s[8:11], s30 offen offset:1024 lds
  s_add_u32 m0, s31, 35712
  s_nop 0
  buffer_load_dwordx4 v4, s[8:11], s30 offen offset:1152 lds
  s_add_u32 s31, s31, 40960
  s_add_u32 s30, s30, 40960
  v_and_b32 v10, 7, v2
  v_add_u32 v8, 0, v3
  v_xor_b32 v8, v8, v10
  v_lshlrev_b32 v8, 4, v8
  v_lshl_add_u32 v5, v2, 7, v8
  v_add_u32 v8, 4, v3
  v_xor_b32 v8, v8, v10
  v_lshlrev_b32 v8, 4, v8
  v_lshl_add_u32 v6, v2, 7, v8
  v_mov_b32 v7, v5
  v_mov_b32 v8, v6
  s_mov_b32 s33, 0
  v_lshlrev_b32 v15, 4, v1
  v_mov_b32 v16, 0xf149f2ca
  v_lshrrev_b32 v17, 3, v2
  v_mul_u32_u24 v17, 2560, v17
  v_lshlrev_b32 v18, 1, v10
  s_lshr_b32 s21, s20, 1
  s_lshl_b32 s21, s21, 10
  s_and_b32 s22, s20, 1
  s_lshl_b32 s22, s22, 3
  s_add_u32 s21, s21, s22
  s_add_u32 s21, s21, 131072
  v_lshl_add_u32 v9, v3, 4, v18
  v_lshl_add_u32 v9, v9, 4, v17
  v_add_u32 v9, s21, v9
  s_lshl_b32 s21, s20, 7
  s_add_u32 s21, s21, 133120
  v_lshl_add_u32 v10, v18, 3, v17
  v_add_u32 v10, s21, v10
  v_cmp_eq_u32 vcc, 2, v3
  v_lshlrev_b32 v19, 4, v1
  v_add_u32 v19, 136192, v19
  v_cndmask_b32 v10, v19, v10, vcc
  s_lshr_b32 s21, s20, 1
  s_and_b32 s22, s20, 1
  s_mul_i32 s23, s21, 2560
  s_lshl_b32 s47, s22, 10
  s_add_u32 s47, s47, s23
  s_add_u32 s47, s47, 131072
  v_add_u32 v11, s47, v15
  s_lshl_b32 s47, s22, 8
  s_add_u32 s47, s47, s23
  s_add_u32 s47, s47, 133120
  v_add_u32 v12, s47, v15
  s_mul_i32 s23, s22, 768
  s_sub_u32 s23, 2048, s23
  v_add_u32 v14, s23, v15
  v_mov_b32 v19, 1073741824
  v_cmp_gt_u32 vcc, 16, v1
  s_lshl_b32 s47, s42, 23
  s_lshl_b32 s21, s21, 14
  v_cndmask_b32 v14, v19, v14, vcc
  s_add_u32 s47, s47, s21
  s_lshr_b32 s21, s41, 1
  s_lshl_b32 s21, s21, 15
  s_add_u32 s47, s47, s21
  s_and_b32 s21, s41, 1
  s_mul_i32 s21, s21, 2560
  s_add_u32 s47, s47, s21
  s_xor_b32 s21, s80, 134488064
  s_add_u32 s47, s47, s21
  s_lshl_b32 s22, s22, 10
  s_add_u32 s47, s47, s22
  s_mov_b32 s48, 1073741824
  s_mov_b32 s49, 1073741824
  v_cmp_eq_u32 s[62:63], 0, v3
  v_lshlrev_b32 v17, 2, v3
  v_sub_u32 v17, v17, v2
  s_mov_b32 s82, 0x3e64f92e
  s_mov_b32 s83, 0x3fb8aa3b
  v_mov_b32 v20, 0
  v_mov_b32 v21, 0
  v_mov_b32 v22, 0
  v_mov_b32 v23, 0
  v_add_u32 v18, 7, v17
  v_cmp_gt_u32 s[84:85], 8, v18
  v_cmp_le_i32 s[64:65], 16, v18
  v_mov_b32 v18, 65535
  v_cndmask_b32 v19, 0, v18, s[84:85]
  v_or_b32 v20, v20, v19
  v_cndmask_b32 v19, 0, v18, s[64:65]
  v_or_b32 v22, v22, v19
  s_mov_b64 s[54:55], s[84:85]
  s_or_b64 s[84:85], s[84:85], s[64:65]
  v_add_u32 v18, 8, v17
  v_cmp_gt_u32 s[86:87], 8, v18
  v_cmp_le_i32 s[66:67], 16, v18
  v_mov_b32 v18, 4294901760
  v_cndmask_b32 v19, 0, v18, s[86:87]
  v_or_b32 v20, v20, v19
  v_cndmask_b32 v19, 0, v18, s[66:67]
  v_or_b32 v22, v22, v19
  s_mov_b64 s[56:57], s[86:87]
  s_or_b64 s[86:87], s[86:87], s[66:67]
  v_add_u32 v18, 9, v17
  v_cmp_gt_u32 s[88:89], 8, v18
  v_cmp_le_i32 s[68:69], 16, v18
  v_mov_b32 v18, 65535
  v_cndmask_b32 v19, 0, v18, s[88:89]
  v_or_b32 v21, v21, v19
  v_cndmask_b32 v19, 0, v18, s[68:69]
  v_or_b32 v23, v23, v19
  s_mov_b64 s[58:59], s[88:89]
  s_or_b64 s[88:89], s[88:89], s[68:69]
  v_add_u32 v18, 10, v17
  v_cmp_gt_u32 s[90:91], 8, v18
  v_cmp_le_i32 s[70:71], 16, v18
  v_mov_b32 v18, 4294901760
  v_cndmask_b32 v19, 0, v18, s[90:91]
  v_or_b32 v21, v21, v19
  v_cndmask_b32 v19, 0, v18, s[70:71]
  v_or_b32 v23, v23, v19
  s_mov_b64 s[60:61], s[90:91]
  s_or_b64 s[90:91], s[90:91], s[70:71]
  v_mov_b32 v18, 0x3f80
  v_mov_b32 v19, 0x3f800000
  v_cmp_eq_i32 vcc, 0, v17
  v_cmp_eq_i32 s[22:23], -1, v17
  s_nop 1
  v_cndmask_b32 v24, 0, v18, vcc
  v_cndmask_b32 v24, v24, v19, s[22:23]
  v_cmp_eq_i32 vcc, -2, v17
  v_cmp_eq_i32 s[22:23], -3, v17
  s_nop 1
  v_cndmask_b32 v25, 0, v18, vcc
  v_cndmask_b32 v25, v25, v19, s[22:23]
  v_mov_b32 v26, 0
  v_mov_b32 v27, 0
  v_mov_b32 v60, 0
  v_mov_b32 v61, 0
  v_mov_b32 v62, 0
  v_mov_b32 v63, 0
  v_mov_b32 v64, 0
  v_mov_b32 v65, 0
  v_mov_b32 v66, 0
  v_mov_b32 v67, 0
  v_mov_b32 v68, 0
  v_mov_b32 v69, 0
  v_mov_b32 v70, 0
  v_mov_b32 v71, 0
  v_mov_b32 v72, 0
  v_mov_b32 v73, 0
  v_mov_b32 v74, 0
  v_mov_b32 v75, 0
  v_mov_b32 v76, 0
  v_mov_b32 v77, 0
  v_mov_b32 v78, 0
  v_mov_b32 v79, 0
  v_mov_b32 v80, 0
  v_mov_b32 v81, 0
  v_mov_b32 v82, 0
  v_mov_b32 v83, 0
  v_mov_b32 v84, 0
  v_mov_b32 v85, 0
  v_mov_b32 v86, 0
  v_mov_b32 v87, 0
  v_mov_b32 v88, 0
  v_mov_b32 v89, 0
  v_mov_b32 v90, 0
  v_mov_b32 v91, 0
  v_mov_b32 v92, 0
  v_mov_b32 v93, 0
  v_mov_b32 v94, 0
  v_mov_b32 v95, 0
  v_mov_b32 v96, 0
  v_mov_b32 v97, 0
  v_mov_b32 v98, 0
  v_mov_b32 v99, 0
  v_mov_b32 v100, 0
  v_mov_b32 v101, 0
  v_mov_b32 v102, 0
  v_mov_b32 v103, 0
  v_mov_b32 v104, 0
  v_mov_b32 v105, 0
  v_mov_b32 v106, 0
  v_mov_b32 v107, 0
  v_mov_b32 v108, 0
  v_mov_b32 v109, 0
  v_mov_b32 v110, 0
  v_mov_b32 v111, 0
  v_mov_b32 v112, 0
  v_mov_b32 v113, 0
  v_mov_b32 v114, 0
  v_mov_b32 v115, 0
  v_mov_b32 v116, 0
  v_mov_b32 v117, 0
  v_mov_b32 v118, 0
  v_mov_b32 v119, 0
  v_mov_b32 v120, 0
  v_mov_b32 v121, 0
  v_mov_b32 v122, 0
  v_mov_b32 v123, 0
  v_mov_b32 v124, 0
  v_mov_b32 v125, 0
  v_mov_b32 v126, 0
  v_mov_b32 v127, 0
  v_mov_b32 v128, 0
  v_mov_b32 v129, 0
  v_mov_b32 v130, 0
  v_mov_b32 v131, 0
  s_cmp_eq_u32 s42, 0
  s_cselect_b32 s53, 15, 99
  s_mov_b32 s26, 17
  s_waitcnt vmcnt(10)
  s_barrier
  ds_read_b128 v[28:31], v7 offset:0
  ds_read_b128 v[32:35], v8 offset:0
  ds_read_b128 v[36:39], v7 offset:4096
  ds_read_b128 v[40:43], v8 offset:4096
  s_waitcnt lgkmcnt(3)
  .p2align 3
bfl_221:
  v_mfma_f32_16x16x32_bf16 v[60:63], a[0:3], v[28:31], 0
  ds_read_b128 v[44:47], v7 offset:8192
  v_mfma_f32_16x16x32_bf16 v[64:67], a[4:7], v[28:31], 0
  v_mfma_f32_16x16x32_bf16 v[68:71], a[8:11], v[28:31], 0
  v_cvt_pk_bf16_f32 v128, v84, v85
  v_cvt_pk_bf16_f32 v129, v86, v87
  v_mfma_f32_16x16x32_bf16 v[72:75], v[28:31], a[12:15], 0
  s_waitcnt lgkmcnt(3)
  v_cvt_pk_bf16_f32 v124, v76, v77
  v_cvt_pk_bf16_f32 v125, v78, v79
  v_mfma_f32_16x16x32_bf16 v[60:63], a[16:19], v[32:35], v[60:63]
  ds_read_b128 v[48:51], v8 offset:8192
  v_cvt_pk_bf16_f32 v100, v80, v81
  v_mfma_f32_16x16x32_bf16 v[64:67], a[20:23], v[32:35], v[64:67]
  v_cvt_pk_bf16_f32 v101, v82, v83
  v_cvt_pk_bf16_f32 v116, v88, v89
  v_mfma_f32_16x16x32_bf16 v[68:71], a[24:27], v[32:35], v[68:71]
  s_add_u32 m0, s31, 0
  v_cvt_pk_bf16_f32 v117, v90, v91
  v_cndmask_b32 v126, 0, v128, s[62:63]
  v_mfma_f32_16x16x32_bf16 v[72:75], v[32:35], a[28:31], v[72:75]
  s_waitcnt lgkmcnt(3)
  v_cndmask_b32 v127, 0, v129, s[62:63]
  buffer_load_dwordx4 v4, s[8:11], s30 offen offset:0 lds
  v_mfma_f32_16x16x32_bf16 v[60:63], a[32:35], v[36:39], v[60:63]
  ds_read_b128 v[52:55], v7 offset:12288
  v_mfma_f32_16x16x32_bf16 v[64:67], a[36:39], v[36:39], v[64:67]
  v_mfma_f32_16x16x32_bf16 v[68:71], a[40:43], v[36:39], v[68:71]
  v_mfma_f32_16x16x32_bf16 v[72:75], v[36:39], a[44:47], v[72:75]
  v_mfma_f32_16x16x32_bf16 v[132:135], v[128:131], v[24:27], 0
  s_waitcnt lgkmcnt(3)
  v_permlane16_swap_b32 v128, v102
  v_permlane16_swap_b32 v129, v103
  v_mfma_f32_16x16x32_bf16 v[60:63], a[48:51], v[40:43], v[60:63]
  ds_read_b128 v[56:59], v8 offset:12288
  v_mfma_f32_16x16x32_bf16 v[64:67], a[52:55], v[40:43], v[64:67]
  v_mfma_f32_16x16x32_bf16 v[68:71], a[56:59], v[40:43], v[68:71]
  v_mfma_f32_16x16x32_bf16 v[72:75], v[40:43], a[60:63], v[72:75]
  v_mfma_f32_16x16x32_bf16 v[136:139], v[100:103], v[124:127], 0
  v_mfma_f32_16x16x32_bf16 v[140:143], v[104:107], v[124:127], 0
  s_add_u32 m0, s31, 3968
  s_waitcnt lgkmcnt(3)
  v_mfma_f32_16x16x32_bf16 v[60:63], a[64:67], v[44:47], v[60:63]
  ds_read_b128 v[28:31], v7 offset:16384
  buffer_load_dwordx4 v4, s[8:11], s30 offen offset:128 lds
  v_mfma_f32_16x16x32_bf16 v[64:67], a[68:71], v[44:47], v[64:67]
  v_mfma_f32_16x16x32_bf16 v[68:71], a[72:75], v[44:47], v[68:71]
  v_cvt_pk_bf16_f32 v120, v132, v133
  v_cvt_pk_bf16_f32 v121, v134, v135
  v_mfma_f32_16x16x32_bf16 v[72:75], v[44:47], a[76:79], v[72:75]
  s_waitcnt lgkmcnt(3)
  v_cndmask_b32 v136, v136, v140, s[64:65]
  v_cndmask_b32 v137, v137, v141, s[66:67]
  v_mfma_f32_16x16x32_bf16 v[60:63], a[80:83], v[48:51], v[60:63]
  ds_read_b128 v[32:35], v8 offset:16384
  v_cndmask_b32 v138, v138, v142, s[68:69]
  v_mfma_f32_16x16x32_bf16 v[64:67], a[84:87], v[48:51], v[64:67]
  v_cndmask_b32 v139, v139, v143, s[70:71]
  v_cvt_pk_bf16_f32 v17, v136, v137
  v_mfma_f32_16x16x32_bf16 v[68:71], a[88:91], v[48:51], v[68:71]
  v_lshlrev_b32 v136, 16, v17
  v_and_b32 v137, 0xffff0000, v17
  v_mfma_f32_16x16x32_bf16 v[72:75], v[48:51], a[92:95], v[72:75]
  s_waitcnt lgkmcnt(3)
  v_cvt_pk_bf16_f32 v17, v138, v139
  v_lshlrev_b32 v138, 16, v17
  v_mfma_f32_16x16x32_bf16 v[60:63], a[96:99], v[52:55], v[60:63]
  ds_read_b128 v[36:39], v7 offset:20480
  v_and_b32 v139, 0xffff0000, v17
  v_mfma_f32_16x16x32_bf16 v[64:67], a[100:103], v[52:55], v[64:67]
  v_mul_f32 v136, s82, v136
  v_mul_f32 v137, s82, v137
  v_mfma_f32_16x16x32_bf16 v[68:71], a[104:107], v[52:55], v[68:71]
  v_mul_f32 v138, s82, v138
  v_mul_f32 v139, s82, v139
  v_mfma_f32_16x16x32_bf16 v[72:75], v[52:55], a[108:111], v[72:75]
  s_waitcnt lgkmcnt(3)
  v_cvt_pk_bf16_f32 v17, v136, v137
  v_lshlrev_b32 v136, 16, v17
  v_mfma_f32_16x16x32_bf16 v[60:63], a[112:115], v[56:59], v[60:63]
  s_add_u32 m0, s31, 7936
  ds_read_b128 v[40:43], v8 offset:20480
  v_and_b32 v137, 0xffff0000, v17
  v_mfma_f32_16x16x32_bf16 v[64:67], a[116:119], v[56:59], v[64:67]
  v_cvt_pk_bf16_f32 v17, v138, v139
  v_lshlrev_b32 v138, 16, v17
  v_mfma_f32_16x16x32_bf16 v[68:71], a[120:123], v[56:59], v[68:71]
  v_and_b32 v139, 0xffff0000, v17
  v_cndmask_b32 v136, v16, v136, s[54:55]
  v_mfma_f32_16x16x32_bf16 v[72:75], v[56:59], a[124:127], v[72:75]
  s_waitcnt lgkmcnt(3)
  v_cndmask_b32 v137, v16, v137, s[56:57]
  v_cndmask_b32 v138, v16, v138, s[58:59]
  v_mfma_f32_16x16x32_bf16 v[60:63], a[128:131], v[28:31], v[60:63]
  ds_read_b128 v[44:47], v7 offset:24576
  v_cndmask_b32 v139, v16, v139, s[60:61]
  v_mfma_f32_16x16x32_bf16 v[64:67], a[132:135], v[28:31], v[64:67]
  v_max3_f32 v17, v136, v137, v138
  v_max_f32 v17, v17, v139
  v_mfma_f32_16x16x32_bf16 v[68:71], a[136:139], v[28:31], v[68:71]
  v_mov_b32 v18, v17
  buffer_load_dwordx4 v4, s[8:11], s30 offen offset:256 lds
  v_mfma_f32_16x16x32_bf16 v[72:75], v[28:31], a[140:143], v[72:75]
  s_waitcnt lgkmcnt(3)
  v_permlane32_swap_b32 v17, v18
  v_max_f32 v17, v17, v18
  v_mfma_f32_16x16x32_bf16 v[60:63], a[144:147], v[32:35], v[60:63]
  ds_read_b128 v[48:51], v8 offset:24576
  v_mov_b32 v18, v17
  v_mfma_f32_16x16x32_bf16 v[64:67], a[148:151], v[32:35], v[64:67]
  v_permlane16_swap_b32 v17, v18
  v_max_f32 v17, v17, v18
  v_mfma_f32_16x16x32_bf16 v[68:71], a[152:155], v[32:35], v[68:71]
  v_mul_f32 v17, s83, v17
  v_fma_f32 v136, v136, s83, -v17
  v_mfma_f32_16x16x32_bf16 v[72:75], v[32:35], a[156:159], v[72:75]
  s_waitcnt lgkmcnt(3)
  v_fma_f32 v137, v137, s83, -v17
  v_fma_f32 v138, v138, s83, -v17
  v_mfma_f32_16x16x32_bf16 v[60:63], a[160:163], v[36:39], v[60:63]
  s_add_u32 m0, s31, 11904
  ds_read_b128 v[52:55], v7 offset:28672
  v_fma_f32 v139, v139, s83, -v17
  v_mfma_f32_16x16x32_bf16 v[64:67], a[164:167], v[36:39], v[64:67]
  v_exp_f32 v136, v136
  v_mfma_f32_16x16x32_bf16 v[68:71], a[168:171], v[36:39], v[68:71]
  v_exp_f32 v137, v137
  v_mfma_f32_16x16x32_bf16 v[72:75], v[36:39], a[172:175], v[72:75]
  s_waitcnt lgkmcnt(3)
  v_exp_f32 v138, v138
  v_mfma_f32_16x16x32_bf16 v[60:63], a[176:179], v[40:43], v[60:63]
  ds_read_b128 v[56:59], v8 offset:28672
  buffer_load_dwordx4 v4, s[8:11], s30 offen offset:384 lds
  v_mfma_f32_16x16x32_bf16 v[64:67], a[180:183], v[40:43], v[64:67]
  v_exp_f32 v139, v139
  v_mfma_f32_16x16x32_bf16 v[68:71], a[184:187], v[40:43], v[68:71]
  v_add_f32 v17, v136, v137
  v_add_f32 v18, v138, v139
  v_mfma_f32_16x16x32_bf16 v[72:75], v[40:43], a[188:191], v[72:75]
  s_waitcnt lgkmcnt(3)
  v_add_f32 v17, v17, v18
  v_mov_b32 v18, v17
  v_mfma_f32_16x16x32_bf16 v[60:63], a[192:195], v[44:47], v[60:63]
  ds_read_b128 v[28:31], v7 offset:32768
  v_permlane32_swap_b32 v17, v18
  v_mfma_f32_16x16x32_bf16 v[64:67], a[196:199], v[44:47], v[64:67]
  v_add_f32 v17, v17, v18
  v_mov_b32 v18, v17
  v_mfma_f32_16x16x32_bf16 v[68:71], a[200:203], v[44:47], v[68:71]
  v_permlane16_swap_b32 v17, v18
  v_add_f32 v17, v17, v18
  v_mfma_f32_16x16x32_bf16 v[72:75], v[44:47], a[204:207], v[72:75]
  s_waitcnt lgkmcnt(3)
  v_rcp_f32 v17, v17
  v_mfma_f32_16x16x32_bf16 v[60:63], a[208:211], v[48:51], v[60:63]
  s_add_u32 m0, s31, 15872
  ds_read_b128 v[32:35], v8 offset:32768
  v_mul_f32 v136, v136, v17
  v_mfma_f32_16x16x32_bf16 v[64:67], a[212:215], v[48:51], v[64:67]
  v_mul_f32 v137, v137, v17
  v_mul_f32 v138, v138, v17
  v_mfma_f32_16x16x32_bf16 v[68:71], a[216:219], v[48:51], v[68:71]
  v_mul_f32 v139, v139, v17
  v_cvt_pk_bf16_f32 v144, v136, v137
  v_mfma_f32_16x16x32_bf16 v[72:75], v[48:51], a[220:223], v[72:75]
  s_waitcnt lgkmcnt(3)
  v_cvt_pk_bf16_f32 v145, v138, v139
  v_and_b32 v146, v144, v22
  v_mfma_f32_16x16x32_bf16 v[60:63], a[224:227], v[52:55], v[60:63]
  ds_read_b128 v[36:39], v7 offset:36864
  v_and_b32 v147, v145, v23
  v_mfma_f32_16x16x32_bf16 v[64:67], a[228:231], v[52:55], v[64:67]
  v_and_b32 v144, v144, v20
  v_and_b32 v145, v145, v21
  v_mfma_f32_16x16x32_bf16 v[68:71], a[232:235], v[52:55], v[68:71]
  buffer_load_dwordx4 v4, s[8:11], s30 offen offset:512 lds
  v_mfma_f32_16x16x32_bf16 v[72:75], v[52:55], a[236:239], v[72:75]
  s_waitcnt lgkmcnt(3)
  v_mfma_f32_16x16x32_bf16 v[60:63], a[240:243], v[56:59], v[60:63]
  ds_read_b128 v[40:43], v8 offset:36864
  v_mfma_f32_16x16x32_bf16 v[64:67], a[244:247], v[56:59], v[64:67]
  v_mfma_f32_16x16x32_bf16 v[68:71], a[248:251], v[56:59], v[68:71]
  v_mfma_f32_16x16x32_bf16 v[72:75], v[56:59], a[252:255], v[72:75]
  s_add_u32 m0, s31, 19840
  s_waitcnt lgkmcnt(3)
  v_mfma_f32_16x16x32_bf16 v[60:63], v[192:195], v[28:31], v[60:63]
  ds_read_b128 v[44:47], v7 offset:2048
  buffer_load_dwordx4 v4, s[8:11], s30 offen offset:640 lds
  v_mfma_f32_16x16x32_bf16 v[64:67], v[196:199], v[28:31], v[64:67]
  v_mfma_f32_16x16x32_bf16 v[68:71], v[200:203], v[28:31], v[68:71]
  v_mfma_f32_16x16x32_bf16 v[72:75], v[28:31], v[204:207], v[72:75]
  v_mfma_f32_16x16x32_bf16 v[148:151], v[116:119], v[144:147], 0
  s_cmp_le_u32 s26, s53
  s_cselect_b64 s[54:55], s[84:85], s[54:55]
  v_mfma_f32_16x16x32_bf16 v[152:155], v[120:123], v[144:147], 0
  s_waitcnt lgkmcnt(3)
  v_mov_b32 v104, v100
  v_mov_b32 v105, v101
  v_mfma_f32_16x16x32_bf16 v[60:63], v[208:211], v[32:35], v[60:63]
  ds_read_b128 v[48:51], v8 offset:2048
  v_mov_b32 v106, v102
  v_mfma_f32_16x16x32_bf16 v[64:67], v[212:215], v[32:35], v[64:67]
  v_mov_b32 v107, v103
  v_mov_b32 v118, v116
  v_mfma_f32_16x16x32_bf16 v[68:71], v[216:219], v[32:35], v[68:71]
  v_cvt_pk_bf16_f32 v156, v148, v149
  v_cvt_pk_bf16_f32 v157, v150, v151
  v_mfma_f32_16x16x32_bf16 v[72:75], v[32:35], v[220:223], v[72:75]
  s_waitcnt lgkmcnt(3)
  ds_write_b64 v9, v[156:157] offset:16
  v_cvt_pk_bf16_f32 v158, v152, v153
  v_mfma_f32_16x16x32_bf16 v[60:63], v[224:227], v[36:39], v[60:63]
  ds_read_b128 v[52:55], v7 offset:6144
  v_cvt_pk_bf16_f32 v159, v154, v155
  v_mfma_f32_16x16x32_bf16 v[64:67], v[228:231], v[36:39], v[64:67]
  s_add_u32 m0, s31, 23808
  ds_write_b64 v10, v[158:159] offset:8
  v_mov_b32 v119, v117
  v_mfma_f32_16x16x32_bf16 v[68:71], v[232:235], v[36:39], v[68:71]
  v_mov_b32 v122, v120
  v_mov_b32 v123, v121
  v_mfma_f32_16x16x32_bf16 v[72:75], v[36:39], v[236:239], v[72:75]
  s_waitcnt lgkmcnt(5)
  buffer_load_dwordx4 v4, s[8:11], s30 offen offset:768 lds
  v_mfma_f32_16x16x32_bf16 v[60:63], v[240:243], v[40:43], v[60:63]
  ds_read_b128 v[56:59], v8 offset:6144
  v_mfma_f32_16x16x32_bf16 v[64:67], v[244:247], v[40:43], v[64:67]
  s_cmp_le_u32 s26, s53
  s_cselect_b64 s[56:57], s[86:87], s[56:57]
  v_mfma_f32_16x16x32_bf16 v[68:71], v[248:251], v[40:43], v[68:71]
  s_cmp_le_u32 s26, s53
  s_cselect_b64 s[58:59], s[88:89], s[58:59]
  v_mfma_f32_16x16x32_bf16 v[72:75], v[40:43], v[252:255], v[72:75]
  s_waitcnt lgkmcnt(5)
  s_cmp_le_u32 s26, s53
  s_cselect_b64 s[60:61], s[90:91], s[60:61]
  v_mfma_f32_16x16x32_bf16 v[76:79], a[0:3], v[44:47], 0
  ds_read_b128 v[28:31], v7 offset:10240
  v_mfma_f32_16x16x32_bf16 v[80:83], a[4:7], v[44:47], 0
  s_waitcnt lgkmcnt(2)
  s_barrier
  v_mfma_f32_16x16x32_bf16 v[84:87], a[8:11], v[44:47], 0
  v_cvt_pk_bf16_f32 v128, v68, v69
  v_cvt_pk_bf16_f32 v129, v70, v71
  v_mfma_f32_16x16x32_bf16 v[88:91], v[44:47], a[12:15], 0
  s_waitcnt lgkmcnt(5)
  v_cvt_pk_bf16_f32 v124, v60, v61
  v_cvt_pk_bf16_f32 v125, v62, v63
  v_mfma_f32_16x16x32_bf16 v[76:79], a[16:19], v[48:51], v[76:79]
  ds_read_b128 v[32:35], v8 offset:10240
  v_cvt_pk_bf16_f32 v92, v64, v65
  v_mfma_f32_16x16x32_bf16 v[80:83], a[20:23], v[48:51], v[80:83]
  s_add_u32 m0, s31, 27776
  v_cvt_pk_bf16_f32 v93, v66, v67
  v_cvt_pk_bf16_f32 v108, v72, v73
  v_mfma_f32_16x16x32_bf16 v[84:87], a[24:27], v[48:51], v[84:87]
  v_cvt_pk_bf16_f32 v109, v74, v75
  v_cndmask_b32 v126, 0, v128, s[62:63]
  v_mfma_f32_16x16x32_bf16 v[88:91], v[48:51], a[28:31], v[88:91]
  s_waitcnt lgkmcnt(4)
  v_cndmask_b32 v127, 0, v129, s[62:63]
  v_xor_b32 v9, 8192, v9
  v_mfma_f32_16x16x32_bf16 v[76:79], a[32:35], v[52:55], v[76:79]
  ds_read_b128 v[36:39], v7 offset:14336
  v_xor_b32 v10, 8192, v10
  v_mfma_f32_16x16x32_bf16 v[80:83], a[36:39], v[52:55], v[80:83]
  ds_read_b128 v[160:163], v11
  ds_read_b128 v[164:167], v12
  v_mfma_f32_16x16x32_bf16 v[84:87], a[40:43], v[52:55], v[84:87]
  buffer_load_dwordx4 v4, s[8:11], s30 offen offset:896 lds
  v_mfma_f32_16x16x32_bf16 v[88:91], v[52:55], a[44:47], v[88:91]
  v_mfma_f32_16x16x32_bf16 v[132:135], v[128:131], v[24:27], 0
  s_waitcnt lgkmcnt(5)
  v_permlane16_swap_b32 v128, v94
  v_permlane16_swap_b32 v129, v95
  v_mfma_f32_16x16x32_bf16 v[76:79], a[48:51], v[56:59], v[76:79]
  ds_read_b128 v[40:43], v8 offset:14336
  v_mfma_f32_16x16x32_bf16 v[80:83], a[52:55], v[56:59], v[80:83]
  v_mfma_f32_16x16x32_bf16 v[84:87], a[56:59], v[56:59], v[84:87]
  s_waitcnt lgkmcnt(1)
  buffer_store_dwordx4 v[160:163], v15, s[16:19], s49 offen sc1
  buffer_store_dwordx4 v[164:167], v14, s[16:19], s49 offen sc1
  v_mfma_f32_16x16x32_bf16 v[88:91], v[56:59], a[60:63], v[88:91]
  v_xor_b32 v11, 8192, v11
  v_xor_b32 v12, 8192, v12
  v_mfma_f32_16x16x32_bf16 v[136:139], v[92:95], v[124:127], 0
  s_add_u32 m0, s31, 31744
  s_mov_b32 s49, s48
  s_mov_b32 s48, s47
  v_mfma_f32_16x16x32_bf16 v[140:143], v[96:99], v[124:127], 0
  s_add_u32 s22, s47, 524288
  s_waitcnt lgkmcnt(5)
  buffer_load_dwordx4 v4, s[8:11], s30 offen offset:1024 lds
  v_mfma_f32_16x16x32_bf16 v[76:79], a[64:67], v[28:31], v[76:79]
  s_xor_b32 s47, s47, s22
  ds_read_b128 v[44:47], v7 offset:18432
  s_lshr_b32 s47, s47, 8
  v_mfma_f32_16x16x32_bf16 v[80:83], a[68:71], v[28:31], v[80:83]
  s_and_b32 s47, s47, 8192
  s_xor_b32 s47, s47, s22
  s_sub_u32 s26, s26, 1
  v_mfma_f32_16x16x32_bf16 v[84:87], a[72:75], v[28:31], v[84:87]
  v_cvt_pk_bf16_f32 v112, v132, v133
  v_cvt_pk_bf16_f32 v113, v134, v135
  v_mfma_f32_16x16x32_bf16 v[88:91], v[28:31], a[76:79], v[88:91]
  s_waitcnt lgkmcnt(5)
  v_cndmask_b32 v136, v136, v140, s[64:65]
  v_cndmask_b32 v137, v137, v141, s[66:67]
  v_mfma_f32_16x16x32_bf16 v[76:79], a[80:83], v[32:35], v[76:79]
  ds_read_b128 v[48:51], v8 offset:18432
  v_cndmask_b32 v138, v138, v142, s[68:69]
  v_mfma_f32_16x16x32_bf16 v[80:83], a[84:87], v[32:35], v[80:83]
  v_cndmask_b32 v139, v139, v143, s[70:71]
  v_cvt_pk_bf16_f32 v17, v136, v137
  v_mfma_f32_16x16x32_bf16 v[84:87], a[88:91], v[32:35], v[84:87]
  v_lshlrev_b32 v136, 16, v17
  v_and_b32 v137, 0xffff0000, v17
  v_mfma_f32_16x16x32_bf16 v[88:91], v[32:35], a[92:95], v[88:91]
  s_waitcnt lgkmcnt(5)
  v_cvt_pk_bf16_f32 v17, v138, v139
  v_lshlrev_b32 v138, 16, v17
  v_mfma_f32_16x16x32_bf16 v[76:79], a[96:99], v[36:39], v[76:79]
  ds_read_b128 v[52:55], v7 offset:22528
  v_and_b32 v139, 0xffff0000, v17
  v_mfma_f32_16x16x32_bf16 v[80:83], a[100:103], v[36:39], v[80:83]
  v_mul_f32 v136, s82, v136
  v_mul_f32 v137, s82, v137
  v_mfma_f32_16x16x32_bf16 v[84:87], a[104:107], v[36:39], v[84:87]
  s_add_u32 m0, s31, 35712
  v_mul_f32 v138, s82, v138
  v_mul_f32 v139, s82, v139
  v_mfma_f32_16x16x32_bf16 v[88:91], v[36:39], a[108:111], v[88:91]
  s_waitcnt lgkmcnt(3)
  v_cvt_pk_bf16_f32 v17, v136, v137
  v_lshlrev_b32 v136, 16, v17
  v_mfma_f32_16x16x32_bf16 v[76:79], a[112:115], v[40:43], v[76:79]
  ds_read_b128 v[56:59], v8 offset:22528
  v_and_b32 v137, 0xffff0000, v17
  v_mfma_f32_16x16x32_bf16 v[80:83], a[116:119], v[40:43], v[80:83]
  v_cvt_pk_bf16_f32 v17, v138, v139
  v_lshlrev_b32 v138, 16, v17
  v_mfma_f32_16x16x32_bf16 v[84:87], a[120:123], v[40:43], v[84:87]
  v_and_b32 v139, 0xffff0000, v17
  v_cndmask_b32 v136, v16, v136, s[54:55]
  v_mfma_f32_16x16x32_bf16 v[88:91], v[40:43], a[124:127], v[88:91]
  s_waitcnt lgkmcnt(3)
  v_cndmask_b32 v137, v16, v137, s[56:57]
  v_cndmask_b32 v138, v16, v138, s[58:59]
  v_mfma_f32_16x16x32_bf16 v[76:79], a[128:131], v[44:47], v[76:79]
  ds_read_b128 v[28:31], v7 offset:26624
  v_cndmask_b32 v139, v16, v139, s[60:61]
  v_mfma_f32_16x16x32_bf16 v[80:83], a[132:135], v[44:47], v[80:83]
  v_max3_f32 v17, v136, v137, v138
  v_max_f32 v17, v17, v139
  v_mfma_f32_16x16x32_bf16 v[84:87], a[136:139], v[44:47], v[84:87]
  v_mov_b32 v18, v17
  buffer_load_dwordx4 v4, s[8:11], s30 offen offset:1152 lds
  v_mfma_f32_16x16x32_bf16 v[88:91], v[44:47], a[140:143], v[88:91]
  s_waitcnt lgkmcnt(3)
  v_permlane32_swap_b32 v17, v18
  v_max_f32 v17, v17, v18
  v_mfma_f32_16x16x32_bf16 v[76:79], a[144:147], v[48:51], v[76:79]
  s_add_u32 s30, s30, 40960
  ds_read_b128 v[32:35], v8 offset:26624
  v_mov_b32 v18, v17
  v_mfma_f32_16x16x32_bf16 v[80:83], a[148:151], v[48:51], v[80:83]
  s_add_u32 s31, s31, 40960
  v_permlane16_swap_b32 v17, v18
  v_max_f32 v17, v17, v18
  v_mfma_f32_16x16x32_bf16 v[84:87], a[152:155], v[48:51], v[84:87]
  v_mul_f32 v17, s83, v17
  v_fma_f32 v136, v136, s83, -v17
  v_mfma_f32_16x16x32_bf16 v[88:91], v[48:51], a[156:159], v[88:91]
  s_waitcnt lgkmcnt(3)
  v_fma_f32 v137, v137, s83, -v17
  v_fma_f32 v138, v138, s83, -v17
  v_mfma_f32_16x16x32_bf16 v[76:79], a[160:163], v[52:55], v[76:79]
  ds_read_b128 v[36:39], v7 offset:30720
  v_fma_f32 v139, v139, s83, -v17
  v_mfma_f32_16x16x32_bf16 v[80:83], a[164:167], v[52:55], v[80:83]
  v_exp_f32 v136, v136
  v_mfma_f32_16x16x32_bf16 v[84:87], a[168:171], v[52:55], v[84:87]
  v_exp_f32 v137, v137
  v_mfma_f32_16x16x32_bf16 v[88:91], v[52:55], a[172:175], v[88:91]
  s_waitcnt lgkmcnt(3)
  v_exp_f32 v138, v138
  v_mfma_f32_16x16x32_bf16 v[76:79], a[176:179], v[56:59], v[76:79]
  ds_read_b128 v[40:43], v8 offset:30720
  v_mfma_f32_16x16x32_bf16 v[80:83], a[180:183], v[56:59], v[80:83]
  v_exp_f32 v139, v139
  v_mfma_f32_16x16x32_bf16 v[84:87], a[184:187], v[56:59], v[84:87]
  v_add_f32 v17, v136, v137
  v_add_f32 v18, v138, v139
  v_mfma_f32_16x16x32_bf16 v[88:91], v[56:59], a[188:191], v[88:91]
  s_waitcnt lgkmcnt(3)
  v_add_f32 v17, v17, v18
  v_mov_b32 v18, v17
  v_mfma_f32_16x16x32_bf16 v[76:79], a[192:195], v[28:31], v[76:79]
  ds_read_b128 v[44:47], v7 offset:34816
  v_permlane32_swap_b32 v17, v18
  v_mfma_f32_16x16x32_bf16 v[80:83], a[196:199], v[28:31], v[80:83]
  v_add_f32 v17, v17, v18
  v_mov_b32 v18, v17
  v_mfma_f32_16x16x32_bf16 v[84:87], a[200:203], v[28:31], v[84:87]
  v_permlane16_swap_b32 v17, v18
  v_add_f32 v17, v17, v18
  v_mfma_f32_16x16x32_bf16 v[88:91], v[28:31], a[204:207], v[88:91]
  s_waitcnt lgkmcnt(3)
  v_rcp_f32 v17, v17
  v_mfma_f32_16x16x32_bf16 v[76:79], a[208:211], v[32:35], v[76:79]
  ds_read_b128 v[48:51], v8 offset:34816
  v_mul_f32 v136, v136, v17
  v_mfma_f32_16x16x32_bf16 v[80:83], a[212:215], v[32:35], v[80:83]
  v_mul_f32 v137, v137, v17
  v_mul_f32 v138, v138, v17
  v_mfma_f32_16x16x32_bf16 v[84:87], a[216:219], v[32:35], v[84:87]
  v_mul_f32 v139, v139, v17
  v_cvt_pk_bf16_f32 v144, v136, v137
  v_mfma_f32_16x16x32_bf16 v[88:91], v[32:35], a[220:223], v[88:91]
  s_waitcnt lgkmcnt(3)
  v_cvt_pk_bf16_f32 v145, v138, v139
  v_and_b32 v146, v144, v22
  v_mfma_f32_16x16x32_bf16 v[76:79], a[224:227], v[36:39], v[76:79]
  ds_read_b128 v[52:55], v7 offset:38912
  v_and_b32 v147, v145, v23
  v_mfma_f32_16x16x32_bf16 v[80:83], a[228:231], v[36:39], v[80:83]
  v_and_b32 v144, v144, v20
  v_and_b32 v145, v145, v21
  v_mfma_f32_16x16x32_bf16 v[84:87], a[232:235], v[36:39], v[84:87]
  s_cmp_ge_u32 s31, 122880
  s_cselect_b32 s21, 122880, 0
  s_sub_u32 s31, s31, s21
  v_mfma_f32_16x16x32_bf16 v[88:91], v[36:39], a[236:239], v[88:91]
  s_add_u32 s33, s33, 40960
  s_waitcnt lgkmcnt(3)
  v_mfma_f32_16x16x32_bf16 v[76:79], a[240:243], v[40:43], v[76:79]
  ds_read_b128 v[56:59], v8 offset:38912
  v_mfma_f32_16x16x32_bf16 v[80:83], a[244:247], v[40:43], v[80:83]
  s_cmp_ge_u32 s33, 122880
  s_cselect_b32 s33, 0, s33
  v_mfma_f32_16x16x32_bf16 v[84:87], a[248:251], v[40:43], v[84:87]
  v_add_u32 v7, s33, v5
  v_add_u32 v8, s33, v6
  v_mfma_f32_16x16x32_bf16 v[88:91], v[40:43], a[252:255], v[88:91]
  s_waitcnt lgkmcnt(3)
  v_mfma_f32_16x16x32_bf16 v[76:79], v[192:195], v[44:47], v[76:79]
  s_waitcnt vmcnt(12)
  s_barrier
  ds_read_b128 v[28:31], v7 offset:0
  v_mfma_f32_16x16x32_bf16 v[80:83], v[196:199], v[44:47], v[80:83]
  v_mfma_f32_16x16x32_bf16 v[84:87], v[200:203], v[44:47], v[84:87]
  v_mfma_f32_16x16x32_bf16 v[88:91], v[44:47], v[204:207], v[88:91]
  v_mfma_f32_16x16x32_bf16 v[148:151], v[108:111], v[144:147], 0
  v_mfma_f32_16x16x32_bf16 v[152:155], v[112:115], v[144:147], 0
  s_waitcnt lgkmcnt(3)
  v_mov_b32 v96, v92
  v_mov_b32 v97, v93
  v_mfma_f32_16x16x32_bf16 v[76:79], v[208:211], v[48:51], v[76:79]
  ds_read_b128 v[32:35], v8 offset:0
  v_mov_b32 v98, v94
  v_mfma_f32_16x16x32_bf16 v[80:83], v[212:215], v[48:51], v[80:83]
  v_mov_b32 v99, v95
  v_mov_b32 v110, v108
  v_mfma_f32_16x16x32_bf16 v[84:87], v[216:219], v[48:51], v[84:87]
  v_cvt_pk_bf16_f32 v156, v148, v149
  v_cvt_pk_bf16_f32 v157, v150, v151
  v_mfma_f32_16x16x32_bf16 v[88:91], v[48:51], v[220:223], v[88:91]
  s_waitcnt lgkmcnt(3)
  ds_write_b64 v9, v[156:157] offset:0
  v_cvt_pk_bf16_f32 v158, v152, v153
  v_mfma_f32_16x16x32_bf16 v[76:79], v[224:227], v[52:55], v[76:79]
  ds_read_b128 v[36:39], v7 offset:4096
  v_cvt_pk_bf16_f32 v159, v154, v155
  v_mfma_f32_16x16x32_bf16 v[80:83], v[228:231], v[52:55], v[80:83]
  ds_write_b64 v10, v[158:159] offset:0
  v_mov_b32 v111, v109
  v_mfma_f32_16x16x32_bf16 v[84:87], v[232:235], v[52:55], v[84:87]
  v_mov_b32 v114, v112
  v_mov_b32 v115, v113
  v_mfma_f32_16x16x32_bf16 v[88:91], v[52:55], v[236:239], v[88:91]
  s_waitcnt lgkmcnt(5)
  v_mfma_f32_16x16x32_bf16 v[76:79], v[240:243], v[56:59], v[76:79]
  ds_read_b128 v[40:43], v8 offset:4096
  v_mfma_f32_16x16x32_bf16 v[80:83], v[244:247], v[56:59], v[80:83]
  v_mfma_f32_16x16x32_bf16 v[84:87], v[248:251], v[56:59], v[84:87]
  s_cmp_gt_u32 s26, 0
  v_mfma_f32_16x16x32_bf16 v[88:91], v[56:59], v[252:255], v[88:91]
  s_waitcnt lgkmcnt(5)
  s_cbranch_scc1 bfl_221
  s_nop 7
  v_cvt_pk_bf16_f32 v128, v84, v85
  v_cvt_pk_bf16_f32 v129, v86, v87
  v_cvt_pk_bf16_f32 v124, v76, v77
  v_cvt_pk_bf16_f32 v125, v78, v79
  v_cvt_pk_bf16_f32 v100, v80, v81
  v_cvt_pk_bf16_f32 v101, v82, v83
  v_cvt_pk_bf16_f32 v116, v88, v89
  v_cvt_pk_bf16_f32 v117, v90, v91
  v_cndmask_b32 v126, 0, v128, s[62:63]
  v_cndmask_b32 v127, 0, v129, s[62:63]
  s_nop 1
  v_mfma_f32_16x16x32_bf16 v[132:135], v[128:131], v[24:27], 0
  s_nop 7
  v_permlane16_swap_b32 v128, v102
  v_permlane16_swap_b32 v129, v103
  s_nop 1
  v_mfma_f32_16x16x32_bf16 v[136:139], v[100:103], v[124:127], 0
  v_mfma_f32_16x16x32_bf16 v[140:143], v[104:107], v[124:127], 0
  s_nop 7
  v_cvt_pk_bf16_f32 v120, v132, v133
  v_cvt_pk_bf16_f32 v121, v134, v135
  v_cndmask_b32 v136, v136, v140, s[64:65]
  v_cndmask_b32 v137, v137, v141, s[66:67]
  v_cndmask_b32 v138, v138, v142, s[68:69]
  v_cndmask_b32 v139, v139, v143, s[70:71]
  v_cvt_pk_bf16_f32 v17, v136, v137
  v_lshlrev_b32 v136, 16, v17
  v_and_b32 v137, 0xffff0000, v17
  v_cvt_pk_bf16_f32 v17, v138, v139
  v_lshlrev_b32 v138, 16, v17
  v_and_b32 v139, 0xffff0000, v17
  v_mul_f32 v136, s82, v136
  v_mul_f32 v137, s82, v137
  v_mul_f32 v138, s82, v138
  v_mul_f32 v139, s82, v139
  v_cvt_pk_bf16_f32 v17, v136, v137
  v_lshlrev_b32 v136, 16, v17
  v_and_b32 v137, 0xffff0000, v17
  v_cvt_pk_bf16_f32 v17, v138, v139
  v_lshlrev_b32 v138, 16, v17
  v_and_b32 v139, 0xffff0000, v17
  v_cndmask_b32 v136, v16, v136, s[54:55]
  v_cndmask_b32 v137, v16, v137, s[56:57]
  v_cndmask_b32 v138, v16, v138, s[58:59]
  v_cndmask_b32 v139, v16, v139, s[60:61]
  v_max3_f32 v17, v136, v137, v138
  v_max_f32 v17, v17, v139
  v_mov_b32 v18, v17
  s_nop 1
  v_permlane32_swap_b32 v17, v18
  v_max_f32 v17, v17, v18
  v_mov_b32 v18, v17
  s_nop 1
  v_permlane16_swap_b32 v17, v18
  v_max_f32 v17, v17, v18
  v_mul_f32 v17, s83, v17
  v_fma_f32 v136, v136, s83, -v17
  v_fma_f32 v137, v137, s83, -v17
  v_fma_f32 v138, v138, s83, -v17
  v_fma_f32 v139, v139, s83, -v17
  v_exp_f32 v136, v136
  v_exp_f32 v137, v137
  v_exp_f32 v138, v138
  v_exp_f32 v139, v139
  s_nop 1
  v_add_f32 v17, v136, v137
  v_add_f32 v18, v138, v139
  v_add_f32 v17, v17, v18
  v_mov_b32 v18, v17
  s_nop 1
  v_permlane32_swap_b32 v17, v18
  v_add_f32 v17, v17, v18
  v_mov_b32 v18, v17
  s_nop 1
  v_permlane16_swap_b32 v17, v18
  v_add_f32 v17, v17, v18
  v_rcp_f32 v17, v17
  s_nop 1
  v_mul_f32 v136, v136, v17
  v_mul_f32 v137, v137, v17
  v_mul_f32 v138, v138, v17
  v_mul_f32 v139, v139, v17
  v_cvt_pk_bf16_f32 v144, v136, v137
  v_cvt_pk_bf16_f32 v145, v138, v139
  v_and_b32 v146, v144, v22
  v_and_b32 v147, v145, v23
  v_and_b32 v144, v144, v20
  v_and_b32 v145, v145, v21
  s_nop 1
  v_mfma_f32_16x16x32_bf16 v[148:151], v[116:119], v[144:147], 0
  v_mfma_f32_16x16x32_bf16 v[152:155], v[120:123], v[144:147], 0
  s_nop 7
  v_mov_b32 v104, v100
  v_mov_b32 v105, v101
  v_mov_b32 v106, v102
  v_mov_b32 v107, v103
  v_mov_b32 v118, v116
  v_mov_b32 v119, v117
  v_mov_b32 v122, v120
  v_mov_b32 v123, v121
  v_cvt_pk_bf16_f32 v156, v148, v149
  v_cvt_pk_bf16_f32 v157, v150, v151
  ds_write_b64 v9, v[156:157] offset:16
  v_cvt_pk_bf16_f32 v158, v152, v153
  v_cvt_pk_bf16_f32 v159, v154, v155
  ds_write_b64 v10, v[158:159] offset:8
  s_waitcnt lgkmcnt(0)
  s_barrier
  ds_read_b128 v[160:163], v11
  ds_read_b128 v[164:167], v12
  s_waitcnt lgkmcnt(0)
  buffer_store_dwordx4 v[160:163], v15, s[16:19], s49 offen sc1
  buffer_store_dwordx4 v[164:167], v14, s[16:19], s49 offen sc1
  s_waitcnt vmcnt(0)
  s_barrier
  s_lshl_b32 s21, s42, 7
  s_add_u32 s21, s21, 29696
  s_xor_b32 s21, s21, s80
  s_cmp_lg_u32 s20, 0
  s_cbranch_scc1 af_222
  v_mov_b32 v8, 0
  v_mov_b32 v9, 1
  s_mov_b64 exec, 1
  buffer_atomic_add v9, v8, s[72:75], s21 offen sc1
  s_mov_b64 exec, -1
  s_nop 1
af_222:
  s_barrier
  s_sub_u32 s2, s3, 96
  s_mov_b32 s40, 0
  s_mov_b32 s41, 13
q_entry:
  s_load_dwordx2 s[4:5], s[0:1], 0
  s_load_dwordx2 s[6:7], s[0:1], 16
  s_load_dwordx2 s[38:39], s[0:1], 104
  s_mov_b32 s42, s2
  s_waitcnt lgkmcnt(0)
  s_mov_b32 s8, s4
  s_mov_b32 s9, s5
  s_mov_b32 s10, 2621440
  s_mov_b32 s11, 0x00020000
  s_mov_b32 s12, s6
  s_mov_b32 s13, s7
  s_mov_b32 s14, 7864320
  s_mov_b32 s15, 0x00020000
  s_mov_b32 s16, s38
  s_mov_b32 s17, s39
  s_mov_b32 s18, 171966464
  s_mov_b32 s19, 0x00020000
  s_add_u32 s72, s38, 173080576
  s_addc_u32 s73, s39, 0
  s_mov_b32 s74, 49152
  s_mov_b32 s75, 0x00020000
  s_mul_i32 s44, s42, 384
  s_cmp_lg_u32 s40, 0
  s_cbranch_scc1 qg_223
  s_load_dwordx2 s[36:37], s[0:1], 80
  s_waitcnt lgkmcnt(0)
  s_mov_b32 s24, s36
  s_mov_b32 s25, s37
  s_mov_b32 s26, 1280
  s_mov_b32 s27, 0x00020000
  s_add_u32 s76, s38, 175112192
  s_addc_u32 s77, s39, 0
  s_mov_b32 s78, 8192
  s_mov_b32 s79, 0x00020000
  s_lshl_b32 s59, s2, 2
  s_add_u32 s59, s59, s20
  s_lshl_b32 s59, s59, 4
  v_lshlrev_b32 v10, 2, v1
  v_lshlrev_b32 v11, 4, v1
  s_mul_i32 s22, s59, 1280
  buffer_load_dwordx4 v[12:15], v11, s[24:27], 0 offen
  buffer_load_dword v16, v10, s[24:27], 0 offen offset:1024
  buffer_load_dwordx4 v[192:195], v11, s[8:11], s22 offen
  buffer_load_dword v48, v10, s[8:11], s22 offen offset:1024
  s_add_u32 s22, s22, 1280
  buffer_load_dwordx4 v[196:199], v11, s[8:11], s22 offen
  buffer_load_dword v49, v10, s[8:11], s22 offen offset:1024
  s_add_u32 s22, s22, 1280
  buffer_load_dwordx4 v[200:203], v11, s[8:11], s22 offen
  buffer_load_dword v50, v10, s[8:11], s22 offen offset:1024
  s_add_u32 s22, s22, 1280
  buffer_load_dwordx4 v[204:207], v11, s[8:11], s22 offen
  buffer_load_dword v51, v10, s[8:11], s22 offen offset:1024
  s_add_u32 s22, s22, 1280
  buffer_load_dwordx4 v[208:211], v11, s[8:11], s22 offen
  buffer_load_dword v52, v10, s[8:11], s22 offen offset:1024
  s_add_u32 s22, s22, 1280
  buffer_load_dwordx4 v[212:215], v11, s[8:11], s22 offen
  buffer_load_dword v53, v10, s[8:11], s22 offen offset:1024
  s_add_u32 s22, s22, 1280
  buffer_load_dwordx4 v[216:219], v11, s[8:11], s22 offen
  buffer_load_dword v54, v10, s[8:11], s22 offen offset:1024
  s_add_u32 s22, s22, 1280
  buffer_load_dwordx4 v[220:223], v11, s[8:11], s22 offen
  buffer_load_dword v55, v10, s[8:11], s22 offen offset:1024
  s_add_u32 s22, s22, 1280
  buffer_load_dwordx4 v[224:227], v11, s[8:11], s22 offen
  buffer_load_dword v56, v10, s[8:11], s22 offen offset:1024
  s_add_u32 s22, s22, 1280
  buffer_load_dwordx4 v[228:231], v11, s[8:11], s22 offen
  buffer_load_dword v57, v10, s[8:11], s22 offen offset:1024
  s_add_u32 s22, s22, 1280
  buffer_load_dwordx4 v[232:235], v11, s[8:11], s22 offen
  buffer_load_dword v58, v10, s[8:11], s22 offen offset:1024
  s_add_u32 s22, s22, 1280
  buffer_load_dwordx4 v[236:239], v11, s[8:11], s22 offen
  buffer_load_dword v59, v10, s[8:11], s22 offen offset:1024
  s_add_u32 s22, s22, 1280
  buffer_load_dwordx4 v[240:243], v11, s[8:11], s22 offen
  buffer_load_dword v60, v10, s[8:11], s22 offen offset:1024
  s_add_u32 s22, s22, 1280
  buffer_load_dwordx4 v[244:247], v11, s[8:11], s22 offen
  buffer_load_dword v61, v10, s[8:11], s22 offen offset:1024
  s_add_u32 s22, s22, 1280
  buffer_load_dwordx4 v[248:251], v11, s[8:11], s22 offen
  buffer_load_dword v62, v10, s[8:11], s22 offen offset:1024
  s_add_u32 s22, s22, 1280
  buffer_load_dwordx4 v[252:255], v11, s[8:11], s22 offen
  buffer_load_dword v63, v10, s[8:11], s22 offen offset:1024
  s_add_u32 s22, s22, 1280
qg_223:
  s_waitcnt vmcnt(30)
  v_mov_b32 v9, 2731
  v_add_u32 v8, 0, v1
  v_mul_u32_u24 v7, v8, v9
  v_lshrrev_b32 v7, 16, v7
  v_mul_u32_u24 v4, 24, v7
  v_sub_u32 v8, v8, v4
  s_mov_b32 s21, 12288
  v_mul_lo_u32 v7, v7, s21
  v_lshl_add_u32 v4, v8, 4, v7
  v_add_u32 v8, 64, v1
  v_mul_u32_u24 v7, v8, v9
  v_lshrrev_b32 v7, 16, v7
  v_mul_u32_u24 v5, 24, v7
  v_sub_u32 v8, v8, v5
  s_mov_b32 s21, 12288
  v_mul_lo_u32 v7, v7, s21
  v_lshl_add_u32 v5, v8, 4, v7
  v_add_u32 v8, 128, v1
  v_mul_u32_u24 v7, v8, v9
  v_lshrrev_b32 v7, 16, v7
  v_mul_u32_u24 v6, 24, v7
  v_sub_u32 v8, v8, v6
  s_mov_b32 s21, 12288
  v_mul_lo_u32 v7, v7, s21
  v_lshl_add_u32 v6, v8, 4, v7
  v_lshrrev_b32 v7, 2, v2
  v_lshl_add_u32 v7, v3, 3, v7
  v_mul_u32_u24 v7, 384, v7
  v_and_b32 v8, 3, v2
  v_lshlrev_b32 v8, 3, v8
  s_mul_i32 s21, s20, 96
  v_add3_u32 v7, v7, v8, s21
  v_add_u32 v8, 61440, v7
  s_mul_i32 s21, s20, 491520
  s_add_u32 s21, s21, 0
  s_add_u32 s21, s21, s44
  s_mul_i32 s22, s20, 15360
  s_add_u32 s22, s22, 0
  s_add_u32 m0, s22, 0
  s_nop 0
  buffer_load_dwordx4 v4, s[12:15], s21 offen lds
  s_add_u32 m0, s22, 1024
  s_nop 0
  buffer_load_dwordx4 v5, s[12:15], s21 offen lds
  s_add_u32 m0, s22, 2048
  s_nop 0
  buffer_load_dwordx4 v6, s[12:15], s21 offen lds
  s_mul_i32 s21, s20, 491520
  s_add_u32 s21, s21, 98304
  s_add_u32 s21, s21, s44
  s_mul_i32 s22, s20, 15360
  s_add_u32 s22, s22, 3072
  s_add_u32 m0, s22, 0
  s_nop 0
  buffer_load_dwordx4 v4, s[12:15], s21 offen lds
  s_add_u32 m0, s22, 1024
  s_nop 0
  buffer_load_dwordx4 v5, s[12:15], s21 offen lds
  s_add_u32 m0, s22, 2048
  s_nop 0
  buffer_load_dwordx4 v6, s[12:15], s21 offen lds
  s_mul_i32 s21, s20, 491520
  s_add_u32 s21, s21, 196608
  s_add_u32 s21, s21, s44
  s_mul_i32 s22, s20, 15360
  s_add_u32 s22, s22, 6144
  s_add_u32 m0, s22, 0
  s_nop 0
  buffer_load_dwordx4 v4, s[12:15], s21 offen lds
  s_add_u32 m0, s22, 1024
  s_nop 0
  buffer_load_dwordx4 v5, s[12:15], s21 offen lds
  s_add_u32 m0, s22, 2048
  s_nop 0
  buffer_load_dwordx4 v6, s[12:15], s21 offen lds
  s_mul_i32 s21, s20, 491520
  s_add_u32 s21, s21, 294912
  s_add_u32 s21, s21, s44
  s_mul_i32 s22, s20, 15360
  s_add_u32 s22, s22, 9216
  s_add_u32 m0, s22, 0
  s_nop 0
  buffer_load_dwordx4 v4, s[12:15], s21 offen lds
  s_add_u32 m0, s22, 1024
  s_nop 0
  buffer_load_dwordx4 v5, s[12:15], s21 offen lds
  s_add_u32 m0, s22, 2048
  s_nop 0
  buffer_load_dwordx4 v6, s[12:15], s21 offen lds
  s_mul_i32 s21, s20, 491520
  s_add_u32 s21, s21, 393216
  s_add_u32 s21, s21, s44
  s_mul_i32 s22, s20, 15360
  s_add_u32 s22, s22, 12288
  s_add_u32 m0, s22, 0
  s_nop 0
  buffer_load_dwordx4 v4, s[12:15], s21 offen lds
  s_add_u32 m0, s22, 1024
  s_nop 0
  buffer_load_dwordx4 v5, s[12:15], s21 offen lds
  s_add_u32 m0, s22, 2048
  s_nop 0
  buffer_load_dwordx4 v6, s[12:15], s21 offen lds
  s_mul_i32 s21, s20, 491520
  s_add_u32 s21, s21, 1966080
  s_add_u32 s21, s21, s44
  s_mul_i32 s22, s20, 15360
  s_add_u32 s22, s22, 61440
  s_add_u32 m0, s22, 0
  s_nop 0
  buffer_load_dwordx4 v4, s[12:15], s21 offen lds
  s_add_u32 m0, s22, 1024
  s_nop 0
  buffer_load_dwordx4 v5, s[12:15], s21 offen lds
  s_add_u32 m0, s22, 2048
  s_nop 0
  buffer_load_dwordx4 v6, s[12:15], s21 offen lds
  s_mul_i32 s21, s20, 491520
  s_add_u32 s21, s21, 2064384
  s_add_u32 s21, s21, s44
  s_mul_i32 s22, s20, 15360
  s_add_u32 s22, s22, 64512
  s_add_u32 m0, s22, 0
  s_nop 0
  buffer_load_dwordx4 v4, s[12:15], s21 offen lds
  s_add_u32 m0, s22, 1024
  s_nop 0
  buffer_load_dwordx4 v5, s[12:15], s21 offen lds
  s_add_u32 m0, s22, 2048
  s_nop 0
  buffer_load_dwordx4 v6, s[12:15], s21 offen lds
  s_mul_i32 s21, s20, 491520
  s_add_u32 s21, s21, 2162688
  s_add_u32 s21, s21, s44
  s_mul_i32 s22, s20, 15360
  s_add_u32 s22, s22, 67584
  s_add_u32 m0, s22, 0
  s_nop 0
  buffer_load_dwordx4 v4, s[12:15], s21 offen lds
  s_add_u32 m0, s22, 1024
  s_nop 0
  buffer_load_dwordx4 v5, s[12:15], s21 offen lds
  s_add_u32 m0, s22, 2048
  s_nop 0
  buffer_load_dwordx4 v6, s[12:15], s21 offen lds
  s_mul_i32 s21, s20, 491520
  s_add_u32 s21, s21, 2260992
  s_add_u32 s21, s21, s44
  s_mul_i32 s22, s20, 15360
  s_add_u32 s22, s22, 70656
  s_add_u32 m0, s22, 0
  s_nop 0
  buffer_load_dwordx4 v4, s[12:15], s21 offen lds
  s_add_u32 m0, s22, 1024
  s_nop 0
  buffer_load_dwordx4 v5, s[12:15], s21 offen lds
  s_add_u32 m0, s22, 2048
  s_nop 0
  buffer_load_dwordx4 v6, s[12:15], s21 offen lds
  s_mul_i32 s21, s20, 491520
  s_add_u32 s21, s21, 2359296
  s_add_u32 s21, s21, s44
  s_mul_i32 s22, s20, 15360
  s_add_u32 s22, s22, 73728
  s_add_u32 m0, s22, 0
  s_nop 0
  buffer_load_dwordx4 v4, s[12:15], s21 offen lds
  s_add_u32 m0, s22, 1024
  s_nop 0
  buffer_load_dwordx4 v5, s[12:15], s21 offen lds
  s_add_u32 m0, s22, 2048
  s_nop 0
  buffer_load_dwordx4 v6, s[12:15], s21 offen lds
  s_waitcnt vmcnt(30)
  s_mul_i32 s21, s20, 491520
  s_add_u32 s21, s21, 3932160
  s_add_u32 s21, s21, s44
  buffer_load_dwordx4 v[64:67], v4, s[12:15], s21 offen
  buffer_load_dwordx4 v[68:71], v5, s[12:15], s21 offen
  buffer_load_dwordx4 v[72:75], v6, s[12:15], s21 offen
  s_mul_i32 s21, s20, 491520
  s_add_u32 s21, s21, 4030464
  s_add_u32 s21, s21, s44
  buffer_load_dwordx4 v[76:79], v4, s[12:15], s21 offen
  buffer_load_dwordx4 v[80:83], v5, s[12:15], s21 offen
  buffer_load_dwordx4 v[84:87], v6, s[12:15], s21 offen
  s_mul_i32 s21, s20, 491520
  s_add_u32 s21, s21, 4128768
  s_add_u32 s21, s21, s44
  buffer_load_dwordx4 v[88:91], v4, s[12:15], s21 offen
  buffer_load_dwordx4 v[92:95], v5, s[12:15], s21 offen
  buffer_load_dwordx4 v[96:99], v6, s[12:15], s21 offen
  s_mul_i32 s21, s20, 491520
  s_add_u32 s21, s21, 4227072
  s_add_u32 s21, s21, s44
  buffer_load_dwordx4 v[100:103], v4, s[12:15], s21 offen
  buffer_load_dwordx4 v[104:107], v5, s[12:15], s21 offen
  buffer_load_dwordx4 v[108:111], v6, s[12:15], s21 offen
  s_mul_i32 s21, s20, 491520
  s_add_u32 s21, s21, 4325376
  s_add_u32 s21, s21, s44
  buffer_load_dwordx4 v[112:115], v4, s[12:15], s21 offen
  buffer_load_dwordx4 v[116:119], v5, s[12:15], s21 offen
  buffer_load_dwordx4 v[120:123], v6, s[12:15], s21 offen
  s_mul_i32 s21, s20, 491520
  s_add_u32 s21, s21, 5898240
  s_add_u32 s21, s21, s44
  buffer_load_dwordx4 v[124:127], v4, s[12:15], s21 offen
  buffer_load_dwordx4 v[128:131], v5, s[12:15], s21 offen
  buffer_load_dwordx4 v[132:135], v6, s[12:15], s21 offen
  s_mul_i32 s21, s20, 491520
  s_add_u32 s21, s21, 5996544
  s_add_u32 s21, s21, s44
  buffer_load_dwordx4 v[136:139], v4, s[12:15], s21 offen
  buffer_load_dwordx4 v[140:143], v5, s[12:15], s21 offen
  buffer_load_dwordx4 v[144:147], v6, s[12:15], s21 offen
  s_mul_i32 s21, s20, 491520
  s_add_u32 s21, s21, 6094848
  s_add_u32 s21, s21, s44
  buffer_load_dwordx4 v[148:151], v4, s[12:15], s21 offen
  buffer_load_dwordx4 v[152:155], v5, s[12:15], s21 offen
  buffer_load_dwordx4 v[156:159], v6, s[12:15], s21 offen
  s_mul_i32 s21, s20, 491520
  s_add_u32 s21, s21, 6193152
  s_add_u32 s21, s21, s44
  buffer_load_dwordx4 v[160:163], v4, s[12:15], s21 offen
  buffer_load_dwordx4 v[164:167], v5, s[12:15], s21 offen
  buffer_load_dwordx4 v[168:171], v6, s[12:15], s21 offen
  s_mul_i32 s21, s20, 491520
  s_add_u32 s21, s21, 6291456
  s_add_u32 s21, s21, s44
  buffer_load_dwordx4 v[172:175], v4, s[12:15], s21 offen
  buffer_load_dwordx4 v[176:179], v5, s[12:15], s21 offen
  buffer_load_dwordx4 v[180:183], v6, s[12:15], s21 offen
  s_mul_i32 s22, s20, 15360
  v_lshl_add_u32 v30, v1, 4, s22
  v_add_u32 v31, 61440, v30
  s_cmp_lg_u32 s40, 0
  s_cbranch_scc1 qg_224
  v_lshlrev_b32 v17, 16, v12
  v_and_b32 v12, 0xffff0000, v12
  v_lshlrev_b32 v18, 16, v13
  v_and_b32 v13, 0xffff0000, v13
  v_lshlrev_b32 v19, 16, v14
  v_and_b32 v14, 0xffff0000, v14
  v_lshlrev_b32 v20, 16, v15
  v_and_b32 v15, 0xffff0000, v15
  v_lshlrev_b32 v21, 16, v16
  v_and_b32 v16, 0xffff0000, v16
  v_mov_b32 v32, 0
  v_lshlrev_b32 v25, 16, v192
  v_and_b32 v26, 0xffff0000, v192
  v_mul_f32 v25, v25, v17
  v_mul_f32 v26, v26, v12
  v_cvt_pk_bf16_f32 v25, v25, v26
  v_lshlrev_b32 v26, 16, v25
  v_and_b32 v25, 0xffff0000, v25
  v_add_f32 v32, v32, v26
  v_add_f32 v32, v32, v25
  v_lshlrev_b32 v25, 16, v193
  v_and_b32 v26, 0xffff0000, v193
  v_mul_f32 v25, v25, v18
  v_mul_f32 v26, v26, v13
  v_cvt_pk_bf16_f32 v25, v25, v26
  v_lshlrev_b32 v26, 16, v25
  v_and_b32 v25, 0xffff0000, v25
  v_add_f32 v32, v32, v26
  v_add_f32 v32, v32, v25
  v_lshlrev_b32 v25, 16, v194
  v_and_b32 v26, 0xffff0000, v194
  v_mul_f32 v25, v25, v19
  v_mul_f32 v26, v26, v14
  v_cvt_pk_bf16_f32 v25, v25, v26
  v_lshlrev_b32 v26, 16, v25
  v_and_b32 v25, 0xffff0000, v25
  v_add_f32 v32, v32, v26
  v_add_f32 v32, v32, v25
  v_lshlrev_b32 v25, 16, v195
  v_and_b32 v26, 0xffff0000, v195
  v_mul_f32 v25, v25, v20
  v_mul_f32 v26, v26, v15
  v_cvt_pk_bf16_f32 v25, v25, v26
  v_lshlrev_b32 v26, 16, v25
  v_and_b32 v25, 0xffff0000, v25
  v_add_f32 v32, v32, v26
  v_add_f32 v32, v32, v25
  v_lshlrev_b32 v25, 16, v48
  v_and_b32 v26, 0xffff0000, v48
  v_mul_f32 v25, v25, v21
  v_mul_f32 v26, v26, v16
  v_cvt_pk_bf16_f32 v25, v25, v26
  v_lshlrev_b32 v26, 16, v25
  v_and_b32 v25, 0xffff0000, v25
  v_add_f32 v32, v32, v26
  v_add_f32 v32, v32, v25
  v_mov_b32 v33, 0
  v_lshlrev_b32 v25, 16, v196
  v_and_b32 v26, 0xffff0000, v196
  v_mul_f32 v25, v25, v17
  v_mul_f32 v26, v26, v12
  v_cvt_pk_bf16_f32 v25, v25, v26
  v_lshlrev_b32 v26, 16, v25
  v_and_b32 v25, 0xffff0000, v25
  v_add_f32 v33, v33, v26
  v_add_f32 v33, v33, v25
  v_lshlrev_b32 v25, 16, v197
  v_and_b32 v26, 0xffff0000, v197
  v_mul_f32 v25, v25, v18
  v_mul_f32 v26, v26, v13
  v_cvt_pk_bf16_f32 v25, v25, v26
  v_lshlrev_b32 v26, 16, v25
  v_and_b32 v25, 0xffff0000, v25
  v_add_f32 v33, v33, v26
  v_add_f32 v33, v33, v25
  v_lshlrev_b32 v25, 16, v198
  v_and_b32 v26, 0xffff0000, v198
  v_mul_f32 v25, v25, v19
  v_mul_f32 v26, v26, v14
  v_cvt_pk_bf16_f32 v25, v25, v26
  v_lshlrev_b32 v26, 16, v25
  v_and_b32 v25, 0xffff0000, v25
  v_add_f32 v33, v33, v26
  v_add_f32 v33, v33, v25
  v_lshlrev_b32 v25, 16, v199
  v_and_b32 v26, 0xffff0000, v199
  v_mul_f32 v25, v25, v20
  v_mul_f32 v26, v26, v15
  v_cvt_pk_bf16_f32 v25, v25, v26
  v_lshlrev_b32 v26, 16, v25
  v_and_b32 v25, 0xffff0000, v25
  v_add_f32 v33, v33, v26
  v_add_f32 v33, v33, v25
  v_lshlrev_b32 v25, 16, v49
  v_and_b32 v26, 0xffff0000, v49
  v_mul_f32 v25, v25, v21
  v_mul_f32 v26, v26, v16
  v_cvt_pk_bf16_f32 v25, v25, v26
  v_lshlrev_b32 v26, 16, v25
  v_and_b32 v25, 0xffff0000, v25
  v_add_f32 v33, v33, v26
  v_add_f32 v33, v33, v25
  v_mov_b32 v34, 0
  v_lshlrev_b32 v25, 16, v200
  v_and_b32 v26, 0xffff0000, v200
  v_mul_f32 v25, v25, v17
  v_mul_f32 v26, v26, v12
  v_cvt_pk_bf16_f32 v25, v25, v26
  v_lshlrev_b32 v26, 16, v25
  v_and_b32 v25, 0xffff0000, v25
  v_add_f32 v34, v34, v26
  v_add_f32 v34, v34, v25
  v_lshlrev_b32 v25, 16, v201
  v_and_b32 v26, 0xffff0000, v201
  v_mul_f32 v25, v25, v18
  v_mul_f32 v26, v26, v13
  v_cvt_pk_bf16_f32 v25, v25, v26
  v_lshlrev_b32 v26, 16, v25
  v_and_b32 v25, 0xffff0000, v25
  v_add_f32 v34, v34, v26
  v_add_f32 v34, v34, v25
  v_lshlrev_b32 v25, 16, v202
  v_and_b32 v26, 0xffff0000, v202
  v_mul_f32 v25, v25, v19
  v_mul_f32 v26, v26, v14
  v_cvt_pk_bf16_f32 v25, v25, v26
  v_lshlrev_b32 v26, 16, v25
  v_and_b32 v25, 0xffff0000, v25
  v_add_f32 v34, v34, v26
  v_add_f32 v34, v34, v25
  v_lshlrev_b32 v25, 16, v203
  v_and_b32 v26, 0xffff0000, v203
  v_mul_f32 v25, v25, v20
  v_mul_f32 v26, v26, v15
  v_cvt_pk_bf16_f32 v25, v25, v26
  v_lshlrev_b32 v26, 16, v25
  v_and_b32 v25, 0xffff0000, v25
  v_add_f32 v34, v34, v26
  v_add_f32 v34, v34, v25
  v_lshlrev_b32 v25, 16, v50
  v_and_b32 v26, 0xffff0000, v50
  v_mul_f32 v25, v25, v21
  v_mul_f32 v26, v26, v16
  v_cvt_pk_bf16_f32 v25, v25, v26
  v_lshlrev_b32 v26, 16, v25
  v_and_b32 v25, 0xffff0000, v25
  v_add_f32 v34, v34, v26
  v_add_f32 v34, v34, v25
  v_mov_b32 v35, 0
  v_lshlrev_b32 v25, 16, v204
  v_and_b32 v26, 0xffff0000, v204
  v_mul_f32 v25, v25, v17
  v_mul_f32 v26, v26, v12
  v_cvt_pk_bf16_f32 v25, v25, v26
  v_lshlrev_b32 v26, 16, v25
  v_and_b32 v25, 0xffff0000, v25
  v_add_f32 v35, v35, v26
  v_add_f32 v35, v35, v25
  v_lshlrev_b32 v25, 16, v205
  v_and_b32 v26, 0xffff0000, v205
  v_mul_f32 v25, v25, v18
  v_mul_f32 v26, v26, v13
  v_cvt_pk_bf16_f32 v25, v25, v26
  v_lshlrev_b32 v26, 16, v25
  v_and_b32 v25, 0xffff0000, v25
  v_add_f32 v35, v35, v26
  v_add_f32 v35, v35, v25
  v_lshlrev_b32 v25, 16, v206
  v_and_b32 v26, 0xffff0000, v206
  v_mul_f32 v25, v25, v19
  v_mul_f32 v26, v26, v14
  v_cvt_pk_bf16_f32 v25, v25, v26
  v_lshlrev_b32 v26, 16, v25
  v_and_b32 v25, 0xffff0000, v25
  v_add_f32 v35, v35, v26
  v_add_f32 v35, v35, v25
  v_lshlrev_b32 v25, 16, v207
  v_and_b32 v26, 0xffff0000, v207
  v_mul_f32 v25, v25, v20
  v_mul_f32 v26, v26, v15
  v_cvt_pk_bf16_f32 v25, v25, v26
  v_lshlrev_b32 v26, 16, v25
  v_and_b32 v25, 0xffff0000, v25
  v_add_f32 v35, v35, v26
  v_add_f32 v35, v35, v25
  v_lshlrev_b32 v25, 16, v51
  v_and_b32 v26, 0xffff0000, v51
  v_mul_f32 v25, v25, v21
  v_mul_f32 v26, v26, v16
  v_cvt_pk_bf16_f32 v25, v25, v26
  v_lshlrev_b32 v26, 16, v25
  v_and_b32 v25, 0xffff0000, v25
  v_add_f32 v35, v35, v26
  v_add_f32 v35, v35, v25
  v_mov_b32 v36, 0
  v_lshlrev_b32 v25, 16, v208
  v_and_b32 v26, 0xffff0000, v208
  v_mul_f32 v25, v25, v17
  v_mul_f32 v26, v26, v12
  v_cvt_pk_bf16_f32 v25, v25, v26
  v_lshlrev_b32 v26, 16, v25
  v_and_b32 v25, 0xffff0000, v25
  v_add_f32 v36, v36, v26
  v_add_f32 v36, v36, v25
  v_lshlrev_b32 v25, 16, v209
  v_and_b32 v26, 0xffff0000, v209
  v_mul_f32 v25, v25, v18
  v_mul_f32 v26, v26, v13
  v_cvt_pk_bf16_f32 v25, v25, v26
  v_lshlrev_b32 v26, 16, v25
  v_and_b32 v25, 0xffff0000, v25
  v_add_f32 v36, v36, v26
  v_add_f32 v36, v36, v25
  v_lshlrev_b32 v25, 16, v210
  v_and_b32 v26, 0xffff0000, v210
  v_mul_f32 v25, v25, v19
  v_mul_f32 v26, v26, v14
  v_cvt_pk_bf16_f32 v25, v25, v26
  v_lshlrev_b32 v26, 16, v25
  v_and_b32 v25, 0xffff0000, v25
  v_add_f32 v36, v36, v26
  v_add_f32 v36, v36, v25
  v_lshlrev_b32 v25, 16, v211
  v_and_b32 v26, 0xffff0000, v211
  v_mul_f32 v25, v25, v20
  v_mul_f32 v26, v26, v15
  v_cvt_pk_bf16_f32 v25, v25, v26
  v_lshlrev_b32 v26, 16, v25
  v_and_b32 v25, 0xffff0000, v25
  v_add_f32 v36, v36, v26
  v_add_f32 v36, v36, v25
  v_lshlrev_b32 v25, 16, v52
  v_and_b32 v26, 0xffff0000, v52
  v_mul_f32 v25, v25, v21
  v_mul_f32 v26, v26, v16
  v_cvt_pk_bf16_f32 v25, v25, v26
  v_lshlrev_b32 v26, 16, v25
  v_and_b32 v25, 0xffff0000, v25
  v_add_f32 v36, v36, v26
  v_add_f32 v36, v36, v25
  v_mov_b32 v37, 0
  v_lshlrev_b32 v25, 16, v212
  v_and_b32 v26, 0xffff0000, v212
  v_mul_f32 v25, v25, v17
  v_mul_f32 v26, v26, v12
  v_cvt_pk_bf16_f32 v25, v25, v26
  v_lshlrev_b32 v26, 16, v25
  v_and_b32 v25, 0xffff0000, v25
  v_add_f32 v37, v37, v26
  v_add_f32 v37, v37, v25
  v_lshlrev_b32 v25, 16, v213
  v_and_b32 v26, 0xffff0000, v213
  v_mul_f32 v25, v25, v18
  v_mul_f32 v26, v26, v13
  v_cvt_pk_bf16_f32 v25, v25, v26
  v_lshlrev_b32 v26, 16, v25
  v_and_b32 v25, 0xffff0000, v25
  v_add_f32 v37, v37, v26
  v_add_f32 v37, v37, v25
  v_lshlrev_b32 v25, 16, v214
  v_and_b32 v26, 0xffff0000, v214
  v_mul_f32 v25, v25, v19
  v_mul_f32 v26, v26, v14
  v_cvt_pk_bf16_f32 v25, v25, v26
  v_lshlrev_b32 v26, 16, v25
  v_and_b32 v25, 0xffff0000, v25
  v_add_f32 v37, v37, v26
  v_add_f32 v37, v37, v25
  v_lshlrev_b32 v25, 16, v215
  v_and_b32 v26, 0xffff0000, v215
  v_mul_f32 v25, v25, v20
  v_mul_f32 v26, v26, v15
  v_cvt_pk_bf16_f32 v25, v25, v26
  v_lshlrev_b32 v26, 16, v25
  v_and_b32 v25, 0xffff0000, v25
  v_add_f32 v37, v37, v26
  v_add_f32 v37, v37, v25
  v_lshlrev_b32 v25, 16, v53
  v_and_b32 v26, 0xffff0000, v53
  v_mul_f32 v25, v25, v21
  v_mul_f32 v26, v26, v16
  v_cvt_pk_bf16_f32 v25, v25, v26
  v_lshlrev_b32 v26, 16, v25
  v_and_b32 v25, 0xffff0000, v25
  v_add_f32 v37, v37, v26
  v_add_f32 v37, v37, v25
  v_mov_b32 v38, 0
  v_lshlrev_b32 v25, 16, v216
  v_and_b32 v26, 0xffff0000, v216
  v_mul_f32 v25, v25, v17
  v_mul_f32 v26, v26, v12
  v_cvt_pk_bf16_f32 v25, v25, v26
  v_lshlrev_b32 v26, 16, v25
  v_and_b32 v25, 0xffff0000, v25
  v_add_f32 v38, v38, v26
  v_add_f32 v38, v38, v25
  v_lshlrev_b32 v25, 16, v217
  v_and_b32 v26, 0xffff0000, v217
  v_mul_f32 v25, v25, v18
  v_mul_f32 v26, v26, v13
  v_cvt_pk_bf16_f32 v25, v25, v26
  v_lshlrev_b32 v26, 16, v25
  v_and_b32 v25, 0xffff0000, v25
  v_add_f32 v38, v38, v26
  v_add_f32 v38, v38, v25
  v_lshlrev_b32 v25, 16, v218
  v_and_b32 v26, 0xffff0000, v218
  v_mul_f32 v25, v25, v19
  v_mul_f32 v26, v26, v14
  v_cvt_pk_bf16_f32 v25, v25, v26
  v_lshlrev_b32 v26, 16, v25
  v_and_b32 v25, 0xffff0000, v25
  v_add_f32 v38, v38, v26
  v_add_f32 v38, v38, v25
  v_lshlrev_b32 v25, 16, v219
  v_and_b32 v26, 0xffff0000, v219
  v_mul_f32 v25, v25, v20
  v_mul_f32 v26, v26, v15
  v_cvt_pk_bf16_f32 v25, v25, v26
  v_lshlrev_b32 v26, 16, v25
  v_and_b32 v25, 0xffff0000, v25
  v_add_f32 v38, v38, v26
  v_add_f32 v38, v38, v25
  v_lshlrev_b32 v25, 16, v54
  v_and_b32 v26, 0xffff0000, v54
  v_mul_f32 v25, v25, v21
  v_mul_f32 v26, v26, v16
  v_cvt_pk_bf16_f32 v25, v25, v26
  v_lshlrev_b32 v26, 16, v25
  v_and_b32 v25, 0xffff0000, v25
  v_add_f32 v38, v38, v26
  v_add_f32 v38, v38, v25
  v_mov_b32 v39, 0
  v_lshlrev_b32 v25, 16, v220
  v_and_b32 v26, 0xffff0000, v220
  v_mul_f32 v25, v25, v17
  v_mul_f32 v26, v26, v12
  v_cvt_pk_bf16_f32 v25, v25, v26
  v_lshlrev_b32 v26, 16, v25
  v_and_b32 v25, 0xffff0000, v25
  v_add_f32 v39, v39, v26
  v_add_f32 v39, v39, v25
  v_lshlrev_b32 v25, 16, v221
  v_and_b32 v26, 0xffff0000, v221
  v_mul_f32 v25, v25, v18
  v_mul_f32 v26, v26, v13
  v_cvt_pk_bf16_f32 v25, v25, v26
  v_lshlrev_b32 v26, 16, v25
  v_and_b32 v25, 0xffff0000, v25
  v_add_f32 v39, v39, v26
  v_add_f32 v39, v39, v25
  v_lshlrev_b32 v25, 16, v222
  v_and_b32 v26, 0xffff0000, v222
  v_mul_f32 v25, v25, v19
  v_mul_f32 v26, v26, v14
  v_cvt_pk_bf16_f32 v25, v25, v26
  v_lshlrev_b32 v26, 16, v25
  v_and_b32 v25, 0xffff0000, v25
  v_add_f32 v39, v39, v26
  v_add_f32 v39, v39, v25
  v_lshlrev_b32 v25, 16, v223
  v_and_b32 v26, 0xffff0000, v223
  v_mul_f32 v25, v25, v20
  v_mul_f32 v26, v26, v15
  v_cvt_pk_bf16_f32 v25, v25, v26
  v_lshlrev_b32 v26, 16, v25
  v_and_b32 v25, 0xffff0000, v25
  v_add_f32 v39, v39, v26
  v_add_f32 v39, v39, v25
  v_lshlrev_b32 v25, 16, v55
  v_and_b32 v26, 0xffff0000, v55
  v_mul_f32 v25, v25, v21
  v_mul_f32 v26, v26, v16
  v_cvt_pk_bf16_f32 v25, v25, v26
  v_lshlrev_b32 v26, 16, v25
  v_and_b32 v25, 0xffff0000, v25
  v_add_f32 v39, v39, v26
  v_add_f32 v39, v39, v25
  v_mov_b32 v40, 0
  v_lshlrev_b32 v25, 16, v224
  v_and_b32 v26, 0xffff0000, v224
  v_mul_f32 v25, v25, v17
  v_mul_f32 v26, v26, v12
  v_cvt_pk_bf16_f32 v25, v25, v26
  v_lshlrev_b32 v26, 16, v25
  v_and_b32 v25, 0xffff0000, v25
  v_add_f32 v40, v40, v26
  v_add_f32 v40, v40, v25
  v_lshlrev_b32 v25, 16, v225
  v_and_b32 v26, 0xffff0000, v225
  v_mul_f32 v25, v25, v18
  v_mul_f32 v26, v26, v13
  v_cvt_pk_bf16_f32 v25, v25, v26
  v_lshlrev_b32 v26, 16, v25
  v_and_b32 v25, 0xffff0000, v25
  v_add_f32 v40, v40, v26
  v_add_f32 v40, v40, v25
  v_lshlrev_b32 v25, 16, v226
  v_and_b32 v26, 0xffff0000, v226
  v_mul_f32 v25, v25, v19
  v_mul_f32 v26, v26, v14
  v_cvt_pk_bf16_f32 v25, v25, v26
  v_lshlrev_b32 v26, 16, v25
  v_and_b32 v25, 0xffff0000, v25
  v_add_f32 v40, v40, v26
  v_add_f32 v40, v40, v25
  v_lshlrev_b32 v25, 16, v227
  v_and_b32 v26, 0xffff0000, v227
  v_mul_f32 v25, v25, v20
  v_mul_f32 v26, v26, v15
  v_cvt_pk_bf16_f32 v25, v25, v26
  v_lshlrev_b32 v26, 16, v25
  v_and_b32 v25, 0xffff0000, v25
  v_add_f32 v40, v40, v26
  v_add_f32 v40, v40, v25
  v_lshlrev_b32 v25, 16, v56
  v_and_b32 v26, 0xffff0000, v56
  v_mul_f32 v25, v25, v21
  v_mul_f32 v26, v26, v16
  v_cvt_pk_bf16_f32 v25, v25, v26
  v_lshlrev_b32 v26, 16, v25
  v_and_b32 v25, 0xffff0000, v25
  v_add_f32 v40, v40, v26
  v_add_f32 v40, v40, v25
  v_mov_b32 v41, 0
  v_lshlrev_b32 v25, 16, v228
  v_and_b32 v26, 0xffff0000, v228
  v_mul_f32 v25, v25, v17
  v_mul_f32 v26, v26, v12
  v_cvt_pk_bf16_f32 v25, v25, v26
  v_lshlrev_b32 v26, 16, v25
  v_and_b32 v25, 0xffff0000, v25
  v_add_f32 v41, v41, v26
  v_add_f32 v41, v41, v25
  v_lshlrev_b32 v25, 16, v229
  v_and_b32 v26, 0xffff0000, v229
  v_mul_f32 v25, v25, v18
  v_mul_f32 v26, v26, v13
  v_cvt_pk_bf16_f32 v25, v25, v26
  v_lshlrev_b32 v26, 16, v25
  v_and_b32 v25, 0xffff0000, v25
  v_add_f32 v41, v41, v26
  v_add_f32 v41, v41, v25
  v_lshlrev_b32 v25, 16, v230
  v_and_b32 v26, 0xffff0000, v230
  v_mul_f32 v25, v25, v19
  v_mul_f32 v26, v26, v14
  v_cvt_pk_bf16_f32 v25, v25, v26
  v_lshlrev_b32 v26, 16, v25
  v_and_b32 v25, 0xffff0000, v25
  v_add_f32 v41, v41, v26
  v_add_f32 v41, v41, v25
  v_lshlrev_b32 v25, 16, v231
  v_and_b32 v26, 0xffff0000, v231
  v_mul_f32 v25, v25, v20
  v_mul_f32 v26, v26, v15
  v_cvt_pk_bf16_f32 v25, v25, v26
  v_lshlrev_b32 v26, 16, v25
  v_and_b32 v25, 0xffff0000, v25
  v_add_f32 v41, v41, v26
  v_add_f32 v41, v41, v25
  v_lshlrev_b32 v25, 16, v57
  v_and_b32 v26, 0xffff0000, v57
  v_mul_f32 v25, v25, v21
  v_mul_f32 v26, v26, v16
  v_cvt_pk_bf16_f32 v25, v25, v26
  v_lshlrev_b32 v26, 16, v25
  v_and_b32 v25, 0xffff0000, v25
  v_add_f32 v41, v41, v26
  v_add_f32 v41, v41, v25
  v_mov_b32 v42, 0
  v_lshlrev_b32 v25, 16, v232
  v_and_b32 v26, 0xffff0000, v232
  v_mul_f32 v25, v25, v17
  v_mul_f32 v26, v26, v12
  v_cvt_pk_bf16_f32 v25, v25, v26
  v_lshlrev_b32 v26, 16, v25
  v_and_b32 v25, 0xffff0000, v25
  v_add_f32 v42, v42, v26
  v_add_f32 v42, v42, v25
  v_lshlrev_b32 v25, 16, v233
  v_and_b32 v26, 0xffff0000, v233
  v_mul_f32 v25, v25, v18
  v_mul_f32 v26, v26, v13
  v_cvt_pk_bf16_f32 v25, v25, v26
  v_lshlrev_b32 v26, 16, v25
  v_and_b32 v25, 0xffff0000, v25
  v_add_f32 v42, v42, v26
  v_add_f32 v42, v42, v25
  v_lshlrev_b32 v25, 16, v234
  v_and_b32 v26, 0xffff0000, v234
  v_mul_f32 v25, v25, v19
  v_mul_f32 v26, v26, v14
  v_cvt_pk_bf16_f32 v25, v25, v26
  v_lshlrev_b32 v26, 16, v25
  v_and_b32 v25, 0xffff0000, v25
  v_add_f32 v42, v42, v26
  v_add_f32 v42, v42, v25
  v_lshlrev_b32 v25, 16, v235
  v_and_b32 v26, 0xffff0000, v235
  v_mul_f32 v25, v25, v20
  v_mul_f32 v26, v26, v15
  v_cvt_pk_bf16_f32 v25, v25, v26
  v_lshlrev_b32 v26, 16, v25
  v_and_b32 v25, 0xffff0000, v25
  v_add_f32 v42, v42, v26
  v_add_f32 v42, v42, v25
  v_lshlrev_b32 v25, 16, v58
  v_and_b32 v26, 0xffff0000, v58
  v_mul_f32 v25, v25, v21
  v_mul_f32 v26, v26, v16
  v_cvt_pk_bf16_f32 v25, v25, v26
  v_lshlrev_b32 v26, 16, v25
  v_and_b32 v25, 0xffff0000, v25
  v_add_f32 v42, v42, v26
  v_add_f32 v42, v42, v25
  v_mov_b32 v43, 0
  v_lshlrev_b32 v25, 16, v236
  v_and_b32 v26, 0xffff0000, v236
  v_mul_f32 v25, v25, v17
  v_mul_f32 v26, v26, v12
  v_cvt_pk_bf16_f32 v25, v25, v26
  v_lshlrev_b32 v26, 16, v25
  v_and_b32 v25, 0xffff0000, v25
  v_add_f32 v43, v43, v26
  v_add_f32 v43, v43, v25
  v_lshlrev_b32 v25, 16, v237
  v_and_b32 v26, 0xffff0000, v237
  v_mul_f32 v25, v25, v18
  v_mul_f32 v26, v26, v13
  v_cvt_pk_bf16_f32 v25, v25, v26
  v_lshlrev_b32 v26, 16, v25
  v_and_b32 v25, 0xffff0000, v25
  v_add_f32 v43, v43, v26
  v_add_f32 v43, v43, v25
  v_lshlrev_b32 v25, 16, v238
  v_and_b32 v26, 0xffff0000, v238
  v_mul_f32 v25, v25, v19
  v_mul_f32 v26, v26, v14
  v_cvt_pk_bf16_f32 v25, v25, v26
  v_lshlrev_b32 v26, 16, v25
  v_and_b32 v25, 0xffff0000, v25
  v_add_f32 v43, v43, v26
  v_add_f32 v43, v43, v25
  v_lshlrev_b32 v25, 16, v239
  v_and_b32 v26, 0xffff0000, v239
  v_mul_f32 v25, v25, v20
  v_mul_f32 v26, v26, v15
  v_cvt_pk_bf16_f32 v25, v25, v26
  v_lshlrev_b32 v26, 16, v25
  v_and_b32 v25, 0xffff0000, v25
  v_add_f32 v43, v43, v26
  v_add_f32 v43, v43, v25
  v_lshlrev_b32 v25, 16, v59
  v_and_b32 v26, 0xffff0000, v59
  v_mul_f32 v25, v25, v21
  v_mul_f32 v26, v26, v16
  v_cvt_pk_bf16_f32 v25, v25, v26
  v_lshlrev_b32 v26, 16, v25
  v_and_b32 v25, 0xffff0000, v25
  v_add_f32 v43, v43, v26
  v_add_f32 v43, v43, v25
  v_mov_b32 v44, 0
  v_lshlrev_b32 v25, 16, v240
  v_and_b32 v26, 0xffff0000, v240
  v_mul_f32 v25, v25, v17
  v_mul_f32 v26, v26, v12
  v_cvt_pk_bf16_f32 v25, v25, v26
  v_lshlrev_b32 v26, 16, v25
  v_and_b32 v25, 0xffff0000, v25
  v_add_f32 v44, v44, v26
  v_add_f32 v44, v44, v25
  v_lshlrev_b32 v25, 16, v241
  v_and_b32 v26, 0xffff0000, v241
  v_mul_f32 v25, v25, v18
  v_mul_f32 v26, v26, v13
  v_cvt_pk_bf16_f32 v25, v25, v26
  v_lshlrev_b32 v26, 16, v25
  v_and_b32 v25, 0xffff0000, v25
  v_add_f32 v44, v44, v26
  v_add_f32 v44, v44, v25
  v_lshlrev_b32 v25, 16, v242
  v_and_b32 v26, 0xffff0000, v242
  v_mul_f32 v25, v25, v19
  v_mul_f32 v26, v26, v14
  v_cvt_pk_bf16_f32 v25, v25, v26
  v_lshlrev_b32 v26, 16, v25
  v_and_b32 v25, 0xffff0000, v25
  v_add_f32 v44, v44, v26
  v_add_f32 v44, v44, v25
  v_lshlrev_b32 v25, 16, v243
  v_and_b32 v26, 0xffff0000, v243
  v_mul_f32 v25, v25, v20
  v_mul_f32 v26, v26, v15
  v_cvt_pk_bf16_f32 v25, v25, v26
  v_lshlrev_b32 v26, 16, v25
  v_and_b32 v25, 0xffff0000, v25
  v_add_f32 v44, v44, v26
  v_add_f32 v44, v44, v25
  v_lshlrev_b32 v25, 16, v60
  v_and_b32 v26, 0xffff0000, v60
  v_mul_f32 v25, v25, v21
  v_mul_f32 v26, v26, v16
  v_cvt_pk_bf16_f32 v25, v25, v26
  v_lshlrev_b32 v26, 16, v25
  v_and_b32 v25, 0xffff0000, v25
  v_add_f32 v44, v44, v26
  v_add_f32 v44, v44, v25
  v_mov_b32 v45, 0
  v_lshlrev_b32 v25, 16, v244
  v_and_b32 v26, 0xffff0000, v244
  v_mul_f32 v25, v25, v17
  v_mul_f32 v26, v26, v12
  v_cvt_pk_bf16_f32 v25, v25, v26
  v_lshlrev_b32 v26, 16, v25
  v_and_b32 v25, 0xffff0000, v25
  v_add_f32 v45, v45, v26
  v_add_f32 v45, v45, v25
  v_lshlrev_b32 v25, 16, v245
  v_and_b32 v26, 0xffff0000, v245
  v_mul_f32 v25, v25, v18
  v_mul_f32 v26, v26, v13
  v_cvt_pk_bf16_f32 v25, v25, v26
  v_lshlrev_b32 v26, 16, v25
  v_and_b32 v25, 0xffff0000, v25
  v_add_f32 v45, v45, v26
  v_add_f32 v45, v45, v25
  v_lshlrev_b32 v25, 16, v246
  v_and_b32 v26, 0xffff0000, v246
  v_mul_f32 v25, v25, v19
  v_mul_f32 v26, v26, v14
  v_cvt_pk_bf16_f32 v25, v25, v26
  v_lshlrev_b32 v26, 16, v25
  v_and_b32 v25, 0xffff0000, v25
  v_add_f32 v45, v45, v26
  v_add_f32 v45, v45, v25
  v_lshlrev_b32 v25, 16, v247
  v_and_b32 v26, 0xffff0000, v247
  v_mul_f32 v25, v25, v20
  v_mul_f32 v26, v26, v15
  v_cvt_pk_bf16_f32 v25, v25, v26
  v_lshlrev_b32 v26, 16, v25
  v_and_b32 v25, 0xffff0000, v25
  v_add_f32 v45, v45, v26
  v_add_f32 v45, v45, v25
  v_lshlrev_b32 v25, 16, v61
  v_and_b32 v26, 0xffff0000, v61
  v_mul_f32 v25, v25, v21
  v_mul_f32 v26, v26, v16
  v_cvt_pk_bf16_f32 v25, v25, v26
  v_lshlrev_b32 v26, 16, v25
  v_and_b32 v25, 0xffff0000, v25
  v_add_f32 v45, v45, v26
  v_add_f32 v45, v45, v25
  v_mov_b32 v46, 0
  v_lshlrev_b32 v25, 16, v248
  v_and_b32 v26, 0xffff0000, v248
  v_mul_f32 v25, v25, v17
  v_mul_f32 v26, v26, v12
  v_cvt_pk_bf16_f32 v25, v25, v26
  v_lshlrev_b32 v26, 16, v25
  v_and_b32 v25, 0xffff0000, v25
  v_add_f32 v46, v46, v26
  v_add_f32 v46, v46, v25
  v_lshlrev_b32 v25, 16, v249
  v_and_b32 v26, 0xffff0000, v249
  v_mul_f32 v25, v25, v18
  v_mul_f32 v26, v26, v13
  v_cvt_pk_bf16_f32 v25, v25, v26
  v_lshlrev_b32 v26, 16, v25
  v_and_b32 v25, 0xffff0000, v25
  v_add_f32 v46, v46, v26
  v_add_f32 v46, v46, v25
  v_lshlrev_b32 v25, 16, v250
  v_and_b32 v26, 0xffff0000, v250
  v_mul_f32 v25, v25, v19
  v_mul_f32 v26, v26, v14
  v_cvt_pk_bf16_f32 v25, v25, v26
  v_lshlrev_b32 v26, 16, v25
  v_and_b32 v25, 0xffff0000, v25
  v_add_f32 v46, v46, v26
  v_add_f32 v46, v46, v25
  v_lshlrev_b32 v25, 16, v251
  v_and_b32 v26, 0xffff0000, v251
  v_mul_f32 v25, v25, v20
  v_mul_f32 v26, v26, v15
  v_cvt_pk_bf16_f32 v25, v25, v26
  v_lshlrev_b32 v26, 16, v25
  v_and_b32 v25, 0xffff0000, v25
  v_add_f32 v46, v46, v26
  v_add_f32 v46, v46, v25
  v_lshlrev_b32 v25, 16, v62
  v_and_b32 v26, 0xffff0000, v62
  v_mul_f32 v25, v25, v21
  v_mul_f32 v26, v26, v16
  v_cvt_pk_bf16_f32 v25, v25, v26
  v_lshlrev_b32 v26, 16, v25
  v_and_b32 v25, 0xffff0000, v25
  v_add_f32 v46, v46, v26
  v_add_f32 v46, v46, v25
  v_mov_b32 v47, 0
  v_lshlrev_b32 v25, 16, v252
  v_and_b32 v26, 0xffff0000, v252
  v_mul_f32 v25, v25, v17
  v_mul_f32 v26, v26, v12
  v_cvt_pk_bf16_f32 v25, v25, v26
  v_lshlrev_b32 v26, 16, v25
  v_and_b32 v25, 0xffff0000, v25
  v_add_f32 v47, v47, v26
  v_add_f32 v47, v47, v25
  v_lshlrev_b32 v25, 16, v253
  v_and_b32 v26, 0xffff0000, v253
  v_mul_f32 v25, v25, v18
  v_mul_f32 v26, v26, v13
  v_cvt_pk_bf16_f32 v25, v25, v26
  v_lshlrev_b32 v26, 16, v25
  v_and_b32 v25, 0xffff0000, v25
  v_add_f32 v47, v47, v26
  v_add_f32 v47, v47, v25
  v_lshlrev_b32 v25, 16, v254
  v_and_b32 v26, 0xffff0000, v254
  v_mul_f32 v25, v25, v19
  v_mul_f32 v26, v26, v14
  v_cvt_pk_bf16_f32 v25, v25, v26
  v_lshlrev_b32 v26, 16, v25
  v_and_b32 v25, 0xffff0000, v25
  v_add_f32 v47, v47, v26
  v_add_f32 v47, v47, v25
  v_lshlrev_b32 v25, 16, v255
  v_and_b32 v26, 0xffff0000, v255
  v_mul_f32 v25, v25, v20
  v_mul_f32 v26, v26, v15
  v_cvt_pk_bf16_f32 v25, v25, v26
  v_lshlrev_b32 v26, 16, v25
  v_and_b32 v25, 0xffff0000, v25
  v_add_f32 v47, v47, v26
  v_add_f32 v47, v47, v25
  v_lshlrev_b32 v25, 16, v63
  v_and_b32 v26, 0xffff0000, v63
  v_mul_f32 v25, v25, v21
  v_mul_f32 v26, v26, v16
  v_cvt_pk_bf16_f32 v25, v25, v26
  v_lshlrev_b32 v26, 16, v25
  v_and_b32 v25, 0xffff0000, v25
  v_add_f32 v47, v47, v26
  v_add_f32 v47, v47, v25
  v_add_f32_dpp v32, v32, v32 row_ror:8 row_mask:0xf bank_mask:0xf
  v_add_f32_dpp v33, v33, v33 row_ror:8 row_mask:0xf bank_mask:0xf
  v_add_f32_dpp v34, v34, v34 row_ror:8 row_mask:0xf bank_mask:0xf
  v_add_f32_dpp v35, v35, v35 row_ror:8 row_mask:0xf bank_mask:0xf
  v_add_f32_dpp v36, v36, v36 row_ror:8 row_mask:0xf bank_mask:0xf
  v_add_f32_dpp v37, v37, v37 row_ror:8 row_mask:0xf bank_mask:0xf
  v_add_f32_dpp v38, v38, v38 row_ror:8 row_mask:0xf bank_mask:0xf
  v_add_f32_dpp v39, v39, v39 row_ror:8 row_mask:0xf bank_mask:0xf
  v_add_f32_dpp v40, v40, v40 row_ror:8 row_mask:0xf bank_mask:0xf
  v_add_f32_dpp v41, v41, v41 row_ror:8 row_mask:0xf bank_mask:0xf
  v_add_f32_dpp v42, v42, v42 row_ror:8 row_mask:0xf bank_mask:0xf
  v_add_f32_dpp v43, v43, v43 row_ror:8 row_mask:0xf bank_mask:0xf
  v_add_f32_dpp v44, v44, v44 row_ror:8 row_mask:0xf bank_mask:0xf
  v_add_f32_dpp v45, v45, v45 row_ror:8 row_mask:0xf bank_mask:0xf
  v_add_f32_dpp v46, v46, v46 row_ror:8 row_mask:0xf bank_mask:0xf
  v_add_f32_dpp v47, v47, v47 row_ror:8 row_mask:0xf bank_mask:0xf
  v_add_f32_dpp v32, v32, v32 row_ror:4 row_mask:0xf bank_mask:0xf
  v_add_f32_dpp v33, v33, v33 row_ror:4 row_mask:0xf bank_mask:0xf
  v_add_f32_dpp v34, v34, v34 row_ror:4 row_mask:0xf bank_mask:0xf
  v_add_f32_dpp v35, v35, v35 row_ror:4 row_mask:0xf bank_mask:0xf
  v_add_f32_dpp v36, v36, v36 row_ror:4 row_mask:0xf bank_mask:0xf
  v_add_f32_dpp v37, v37, v37 row_ror:4 row_mask:0xf bank_mask:0xf
  v_add_f32_dpp v38, v38, v38 row_ror:4 row_mask:0xf bank_mask:0xf
  v_add_f32_dpp v39, v39, v39 row_ror:4 row_mask:0xf bank_mask:0xf
  v_add_f32_dpp v40, v40, v40 row_ror:4 row_mask:0xf bank_mask:0xf
  v_add_f32_dpp v41, v41, v41 row_ror:4 row_mask:0xf bank_mask:0xf
  v_add_f32_dpp v42, v42, v42 row_ror:4 row_mask:0xf bank_mask:0xf
  v_add_f32_dpp v43, v43, v43 row_ror:4 row_mask:0xf bank_mask:0xf
  v_add_f32_dpp v44, v44, v44 row_ror:4 row_mask:0xf bank_mask:0xf
  v_add_f32_dpp v45, v45, v45 row_ror:4 row_mask:0xf bank_mask:0xf
  v_add_f32_dpp v46, v46, v46 row_ror:4 row_mask:0xf bank_mask:0xf
  v_add_f32_dpp v47, v47, v47 row_ror:4 row_mask:0xf bank_mask:0xf
  v_add_f32_dpp v32, v32, v32 row_ror:2 row_mask:0xf bank_mask:0xf
  v_add_f32_dpp v33, v33, v33 row_ror:2 row_mask:0xf bank_mask:0xf
  v_add_f32_dpp v34, v34, v34 row_ror:2 row_mask:0xf bank_mask:0xf
  v_add_f32_dpp v35, v35, v35 row_ror:2 row_mask:0xf bank_mask:0xf
  v_add_f32_dpp v36, v36, v36 row_ror:2 row_mask:0xf bank_mask:0xf
  v_add_f32_dpp v37, v37, v37 row_ror:2 row_mask:0xf bank_mask:0xf
  v_add_f32_dpp v38, v38, v38 row_ror:2 row_mask:0xf bank_mask:0xf
  v_add_f32_dpp v39, v39, v39 row_ror:2 row_mask:0xf bank_mask:0xf
  v_add_f32_dpp v40, v40, v40 row_ror:2 row_mask:0xf bank_mask:0xf
  v_add_f32_dpp v41, v41, v41 row_ror:2 row_mask:0xf bank_mask:0xf
  v_add_f32_dpp v42, v42, v42 row_ror:2 row_mask:0xf bank_mask:0xf
  v_add_f32_dpp v43, v43, v43 row_ror:2 row_mask:0xf bank_mask:0xf
  v_add_f32_dpp v44, v44, v44 row_ror:2 row_mask:0xf bank_mask:0xf
  v_add_f32_dpp v45, v45, v45 row_ror:2 row_mask:0xf bank_mask:0xf
  v_add_f32_dpp v46, v46, v46 row_ror:2 row_mask:0xf bank_mask:0xf
  v_add_f32_dpp v47, v47, v47 row_ror:2 row_mask:0xf bank_mask:0xf
  v_add_f32_dpp v32, v32, v32 row_ror:1 row_mask:0xf bank_mask:0xf
  v_add_f32_dpp v33, v33, v33 row_ror:1 row_mask:0xf bank_mask:0xf
  v_add_f32_dpp v34, v34, v34 row_ror:1 row_mask:0xf bank_mask:0xf
  v_add_f32_dpp v35, v35, v35 row_ror:1 row_mask:0xf bank_mask:0xf
  v_add_f32_dpp v36, v36, v36 row_ror:1 row_mask:0xf bank_mask:0xf
  v_add_f32_dpp v37, v37, v37 row_ror:1 row_mask:0xf bank_mask:0xf
  v_add_f32_dpp v38, v38, v38 row_ror:1 row_mask:0xf bank_mask:0xf
  v_add_f32_dpp v39, v39, v39 row_ror:1 row_mask:0xf bank_mask:0xf
  v_add_f32_dpp v40, v40, v40 row_ror:1 row_mask:0xf bank_mask:0xf
  v_add_f32_dpp v41, v41, v41 row_ror:1 row_mask:0xf bank_mask:0xf
  v_add_f32_dpp v42, v42, v42 row_ror:1 row_mask:0xf bank_mask:0xf
  v_add_f32_dpp v43, v43, v43 row_ror:1 row_mask:0xf bank_mask:0xf
  v_add_f32_dpp v44, v44, v44 row_ror:1 row_mask:0xf bank_mask:0xf
  v_add_f32_dpp v45, v45, v45 row_ror:1 row_mask:0xf bank_mask:0xf
  v_add_f32_dpp v46, v46, v46 row_ror:1 row_mask:0xf bank_mask:0xf
  v_add_f32_dpp v47, v47, v47 row_ror:1 row_mask:0xf bank_mask:0xf
  v_mov_b32 v24, v32
  v_cmp_eq_u32 vcc, 1, v2
  s_nop 1
  v_cndmask_b32 v24, v24, v33, vcc
  v_cmp_eq_u32 vcc, 2, v2
  s_nop 1
  v_cndmask_b32 v24, v24, v34, vcc
  v_cmp_eq_u32 vcc, 3, v2
  s_nop 1
  v_cndmask_b32 v24, v24, v35, vcc
  v_cmp_eq_u32 vcc, 4, v2
  s_nop 1
  v_cndmask_b32 v24, v24, v36, vcc
  v_cmp_eq_u32 vcc, 5, v2
  s_nop 1
  v_cndmask_b32 v24, v24, v37, vcc
  v_cmp_eq_u32 vcc, 6, v2
  s_nop 1
  v_cndmask_b32 v24, v24, v38, vcc
  v_cmp_eq_u32 vcc, 7, v2
  s_nop 1
  v_cndmask_b32 v24, v24, v39, vcc
  v_cmp_eq_u32 vcc, 8, v2
  s_nop 1
  v_cndmask_b32 v24, v24, v40, vcc
  v_cmp_eq_u32 vcc, 9, v2
  s_nop 1
  v_cndmask_b32 v24, v24, v41, vcc
  v_cmp_eq_u32 vcc, 10, v2
  s_nop 1
  v_cndmask_b32 v24, v24, v42, vcc
  v_cmp_eq_u32 vcc, 11, v2
  s_nop 1
  v_cndmask_b32 v24, v24, v43, vcc
  v_cmp_eq_u32 vcc, 12, v2
  s_nop 1
  v_cndmask_b32 v24, v24, v44, vcc
  v_cmp_eq_u32 vcc, 13, v2
  s_nop 1
  v_cndmask_b32 v24, v24, v45, vcc
  v_cmp_eq_u32 vcc, 14, v2
  s_nop 1
  v_cndmask_b32 v24, v24, v46, vcc
  v_cmp_eq_u32 vcc, 15, v2
  s_nop 1
  v_cndmask_b32 v24, v24, v47, vcc
  v_mov_b32 v25, v24
  s_nop 1
  v_permlane32_swap_b32 v24, v25
  v_add_f32 v24, v24, v25
  v_mov_b32 v25, v24
  s_nop 1
  v_permlane16_swap_b32 v24, v25
  v_add_f32 v24, v24, v25
  v_cvt_pk_bf16_f32 v25, v24, v24
  v_lshlrev_b32 v24, 16, v25
  v_mul_f32 v24, 0xbfb8aa3b, v24
  v_exp_f32 v24, v24
  s_nop 0
  v_add_f32 v24, 1.0, v24
  v_rcp_f32 v24, v24
  s_nop 0
  v_cvt_pk_bf16_f32 v25, v24, v24
  v_lshlrev_b32 v24, 16, v25
  s_lshl_b32 s21, s59, 2
  s_mov_b64 exec, 0xffff
  buffer_store_dword v24, v10, s[76:79], s21 offen sc1
  s_mov_b64 exec, -1
qg_224:
  s_waitcnt vmcnt(45)
  s_barrier
  ds_read_b64_tr_b16 a[0:1], v7 offset:0
  ds_read_b64_tr_b16 a[2:3], v7 offset:1536
  ds_read_b64_tr_b16 a[4:5], v7 offset:32
  ds_read_b64_tr_b16 a[6:7], v7 offset:1568
  ds_read_b64_tr_b16 a[8:9], v7 offset:64
  ds_read_b64_tr_b16 a[10:11], v7 offset:1600
  ds_read_b64_tr_b16 a[12:13], v7 offset:12288
  ds_read_b64_tr_b16 a[14:15], v7 offset:13824
  ds_read_b64_tr_b16 a[16:17], v7 offset:12320
  ds_read_b64_tr_b16 a[18:19], v7 offset:13856
  ds_read_b64_tr_b16 a[20:21], v7 offset:12352
  ds_read_b64_tr_b16 a[22:23], v7 offset:13888
  ds_read_b64_tr_b16 a[24:25], v7 offset:24576
  ds_read_b64_tr_b16 a[26:27], v7 offset:26112
  ds_read_b64_tr_b16 a[28:29], v7 offset:24608
  ds_read_b64_tr_b16 a[30:31], v7 offset:26144
  ds_read_b64_tr_b16 a[32:33], v7 offset:24640
  ds_read_b64_tr_b16 a[34:35], v7 offset:26176
  ds_read_b64_tr_b16 a[36:37], v7 offset:36864
  ds_read_b64_tr_b16 a[38:39], v7 offset:38400
  ds_read_b64_tr_b16 a[40:41], v7 offset:36896
  ds_read_b64_tr_b16 a[42:43], v7 offset:38432
  ds_read_b64_tr_b16 a[44:45], v7 offset:36928
  ds_read_b64_tr_b16 a[46:47], v7 offset:38464
  ds_read_b64_tr_b16 a[48:49], v7 offset:49152
  ds_read_b64_tr_b16 a[50:51], v7 offset:50688
  ds_read_b64_tr_b16 a[52:53], v7 offset:49184
  ds_read_b64_tr_b16 a[54:55], v7 offset:50720
  ds_read_b64_tr_b16 a[56:57], v7 offset:49216
  ds_read_b64_tr_b16 a[58:59], v7 offset:50752
  s_waitcnt lgkmcnt(0)
  s_barrier
  s_waitcnt vmcnt(30)
  s_barrier
  ds_read_b64_tr_b16 a[60:61], v8 offset:0
  ds_read_b64_tr_b16 a[62:63], v8 offset:1536
  ds_read_b64_tr_b16 a[64:65], v8 offset:32
  ds_read_b64_tr_b16 a[66:67], v8 offset:1568
  ds_read_b64_tr_b16 a[68:69], v8 offset:64
  ds_read_b64_tr_b16 a[70:71], v8 offset:1600
  ds_read_b64_tr_b16 a[72:73], v8 offset:12288
  ds_read_b64_tr_b16 a[74:75], v8 offset:13824
  ds_read_b64_tr_b16 a[76:77], v8 offset:12320
  ds_read_b64_tr_b16 a[78:79], v8 offset:13856
  ds_read_b64_tr_b16 a[80:81], v8 offset:12352
  ds_read_b64_tr_b16 a[82:83], v8 offset:13888
  ds_read_b64_tr_b16 a[84:85], v8 offset:24576
  ds_read_b64_tr_b16 a[86:87], v8 offset:26112
  ds_read_b64_tr_b16 a[88:89], v8 offset:24608
  ds_read_b64_tr_b16 a[90:91], v8 offset:26144
  ds_read_b64_tr_b16 a[92:93], v8 offset:24640
  ds_read_b64_tr_b16 a[94:95], v8 offset:26176
  ds_read_b64_tr_b16 a[96:97], v8 offset:36864
  ds_read_b64_tr_b16 a[98:99], v8 offset:38400
  ds_read_b64_tr_b16 a[100:101], v8 offset:36896
  ds_read_b64_tr_b16 a[102:103], v8 offset:38432
  ds_read_b64_tr_b16 a[104:105], v8 offset:36928
  ds_read_b64_tr_b16 a[106:107], v8 offset:38464
  ds_read_b64_tr_b16 a[108:109], v8 offset:49152
  ds_read_b64_tr_b16 a[110:111], v8 offset:50688
  ds_read_b64_tr_b16 a[112:113], v8 offset:49184
  ds_read_b64_tr_b16 a[114:115], v8 offset:50720
  ds_read_b64_tr_b16 a[116:117], v8 offset:49216
  ds_read_b64_tr_b16 a[118:119], v8 offset:50752
  s_waitcnt lgkmcnt(0)
  s_barrier
  s_waitcnt vmcnt(15)
  ds_write_b128 v30, v[64:67] offset:0
  ds_write_b128 v30, v[68:71] offset:1024
  ds_write_b128 v30, v[72:75] offset:2048
  ds_write_b128 v30, v[76:79] offset:3072
  ds_write_b128 v30, v[80:83] offset:4096
  ds_write_b128 v30, v[84:87] offset:5120
  ds_write_b128 v30, v[88:91] offset:6144
  ds_write_b128 v30, v[92:95] offset:7168
  ds_write_b128 v30, v[96:99] offset:8192
  ds_write_b128 v30, v[100:103] offset:9216
  ds_write_b128 v30, v[104:107] offset:10240
  ds_write_b128 v30, v[108:111] offset:11264
  ds_write_b128 v30, v[112:115] offset:12288
  ds_write_b128 v30, v[116:119] offset:13312
  ds_write_b128 v30, v[120:123] offset:14336
  s_waitcnt lgkmcnt(0)
  s_barrier
  ds_read_b64_tr_b16 a[120:121], v7 offset:0
  ds_read_b64_tr_b16 a[122:123], v7 offset:1536
  ds_read_b64_tr_b16 a[124:125], v7 offset:32
  ds_read_b64_tr_b16 a[126:127], v7 offset:1568
  ds_read_b64_tr_b16 a[128:129], v7 offset:64
  ds_read_b64_tr_b16 a[130:131], v7 offset:1600
  ds_read_b64_tr_b16 a[132:133], v7 offset:12288
  ds_read_b64_tr_b16 a[134:135], v7 offset:13824
  ds_read_b64_tr_b16 a[136:137], v7 offset:12320
  ds_read_b64_tr_b16 a[138:139], v7 offset:13856
  ds_read_b64_tr_b16 a[140:141], v7 offset:12352
  ds_read_b64_tr_b16 a[142:143], v7 offset:13888
  ds_read_b64_tr_b16 a[144:145], v7 offset:24576
  ds_read_b64_tr_b16 a[146:147], v7 offset:26112
  ds_read_b64_tr_b16 a[148:149], v7 offset:24608
  ds_read_b64_tr_b16 a[150:151], v7 offset:26144
  ds_read_b64_tr_b16 a[152:153], v7 offset:24640
  ds_read_b64_tr_b16 a[154:155], v7 offset:26176
  ds_read_b64_tr_b16 a[156:157], v7 offset:36864
  ds_read_b64_tr_b16 a[158:159], v7 offset:38400
  ds_read_b64_tr_b16 a[160:161], v7 offset:36896
  ds_read_b64_tr_b16 a[162:163], v7 offset:38432
  ds_read_b64_tr_b16 a[164:165], v7 offset:36928
  ds_read_b64_tr_b16 a[166:167], v7 offset:38464
  ds_read_b64_tr_b16 a[168:169], v7 offset:49152
  ds_read_b64_tr_b16 a[170:171], v7 offset:50688
  ds_read_b64_tr_b16 a[172:173], v7 offset:49184
  ds_read_b64_tr_b16 a[174:175], v7 offset:50720
  ds_read_b64_tr_b16 a[176:177], v7 offset:49216
  ds_read_b64_tr_b16 a[178:179], v7 offset:50752
  s_waitcnt lgkmcnt(0)
  s_barrier
  s_waitcnt vmcnt(0)
  ds_write_b128 v31, v[124:127] offset:0
  ds_write_b128 v31, v[128:131] offset:1024
  ds_write_b128 v31, v[132:135] offset:2048
  ds_write_b128 v31, v[136:139] offset:3072
  ds_write_b128 v31, v[140:143] offset:4096
  ds_write_b128 v31, v[144:147] offset:5120
  ds_write_b128 v31, v[148:151] offset:6144
  ds_write_b128 v31, v[152:155] offset:7168
  ds_write_b128 v31, v[156:159] offset:8192
  ds_write_b128 v31, v[160:163] offset:9216
  ds_write_b128 v31, v[164:167] offset:10240
  ds_write_b128 v31, v[168:171] offset:11264
  ds_write_b128 v31, v[172:175] offset:12288
  ds_write_b128 v31, v[176:179] offset:13312
  ds_write_b128 v31, v[180:183] offset:14336
  s_waitcnt lgkmcnt(0)
  s_barrier
  ds_read_b64_tr_b16 a[180:181], v8 offset:0
  ds_read_b64_tr_b16 a[182:183], v8 offset:1536
  ds_read_b64_tr_b16 a[184:185], v8 offset:32
  ds_read_b64_tr_b16 a[186:187], v8 offset:1568
  ds_read_b64_tr_b16 a[188:189], v8 offset:64
  ds_read_b64_tr_b16 a[190:191], v8 offset:1600
  ds_read_b64_tr_b16 a[192:193], v8 offset:12288
  ds_read_b64_tr_b16 a[194:195], v8 offset:13824
  ds_read_b64_tr_b16 a[196:197], v8 offset:12320
  ds_read_b64_tr_b16 a[198:199], v8 offset:13856
  ds_read_b64_tr_b16 a[200:201], v8 offset:12352
  ds_read_b64_tr_b16 a[202:203], v8 offset:13888
  ds_read_b64_tr_b16 a[204:205], v8 offset:24576
  ds_read_b64_tr_b16 a[206:207], v8 offset:26112
  ds_read_b64_tr_b16 a[208:209], v8 offset:24608
  ds_read_b64_tr_b16 a[210:211], v8 offset:26144
  ds_read_b64_tr_b16 a[212:213], v8 offset:24640
  ds_read_b64_tr_b16 a[214:215], v8 offset:26176
  ds_read_b64_tr_b16 a[216:217], v8 offset:36864
  ds_read_b64_tr_b16 a[218:219], v8 offset:38400
  ds_read_b64_tr_b16 a[220:221], v8 offset:36896
  ds_read_b64_tr_b16 a[222:223], v8 offset:38432
  ds_read_b64_tr_b16 a[224:225], v8 offset:36928
  ds_read_b64_tr_b16 a[226:227], v8 offset:38464
  ds_read_b64_tr_b16 a[228:229], v8 offset:49152
  ds_read_b64_tr_b16 a[230:231], v8 offset:50688
  ds_read_b64_tr_b16 a[232:233], v8 offset:49184
  ds_read_b64_tr_b16 a[234:235], v8 offset:50720
  ds_read_b64_tr_b16 a[236:237], v8 offset:49216
  ds_read_b64_tr_b16 a[238:239], v8 offset:50752
  s_waitcnt lgkmcnt(0)
  s_barrier
  s_and_b32 s21, s2, 3
  s_lshl_b32 s21, s21, 7
  s_add_u32 s21, s21, 29696
  s_xor_b32 s21, s21, s80
  s_cmp_lg_u32 s40, 0
  s_cbranch_scc1 qg_225
  s_cmp_lg_u32 s20, 0
  s_cbranch_scc1 af_226
  v_mov_b32 v8, 0
  v_mov_b32 v9, 1
  s_mov_b64 exec, 1
  buffer_atomic_add v9, v8, s[72:75], s21 offen sc1
  s_mov_b64 exec, -1
  s_nop 1
af_226:
qg_225:
  s_add_u32 s56, s38, 178257920
  s_addc_u32 s57, s39, 0
  s_mov_b32 s58, 3145728
  s_mov_b32 s59, 0x00020000
  s_sub_u32 s85, s41, 1
  s_mul_i32 s21, s85, 163840
  s_mul_i32 s30, s40, 163840
  s_add_u32 s30, s30, s21
  s_sub_u32 s25, 4294966144, s21
  s_mov_b32 s26, s41
  s_min_u32 s86, s40, 1
  s_lshl_b32 s86, s86, 5
  s_add_u32 s86, s86, s42
  s_mul_i32 s86, s86, 49152
  s_lshl_b32 s46, s40, 2
  s_add_u32 s46, s46, s20
  v_lshrrev_b32 v4, 3, v1
  v_and_b32 v5, 7, v1
  v_xor_b32 v5, v5, v4
  s_mul_i32 s21, s20, 32
  v_add_u32 v4, s21, v4
  v_mul_u32_u24 v4, 1280, v4
  v_lshl_add_u32 v10, v5, 4, v4
  s_mul_i32 s31, s20, 4096
  v_add_u32 v11, 10240, v10
  v_add_u32 v12, 20480, v10
  v_add_u32 v13, 30720, v10
  s_add_u32 m0, s31, 0
  s_nop 0
  buffer_load_dwordx4 v10, s[8:11], s30 offen lds
  s_add_u32 m0, s31, 1024
  s_nop 0
  buffer_load_dwordx4 v11, s[8:11], s30 offen lds
  s_add_u32 m0, s31, 2048
  s_nop 0
  buffer_load_dwordx4 v12, s[8:11], s30 offen lds
  s_add_u32 m0, s31, 3072
  s_nop 0
  buffer_load_dwordx4 v13, s[8:11], s30 offen lds
  s_add_u32 s30, s30, 128
  s_add_u32 m0, s31, 16384
  s_nop 0
  buffer_load_dwordx4 v10, s[8:11], s30 offen lds
  s_add_u32 m0, s31, 17408
  s_nop 0
  buffer_load_dwordx4 v11, s[8:11], s30 offen lds
  s_add_u32 m0, s31, 18432
  s_nop 0
  buffer_load_dwordx4 v12, s[8:11], s30 offen lds
  s_add_u32 m0, s31, 19456
  s_nop 0
  buffer_load_dwordx4 v13, s[8:11], s30 offen lds
  s_add_u32 s30, s30, 128
  s_add_u32 m0, s31, 32768
  s_nop 0
  buffer_load_dwordx4 v10, s[8:11], s30 offen lds
  s_add_u32 m0, s31, 33792
  s_nop 0
  buffer_load_dwordx4 v11, s[8:11], s30 offen lds
  s_add_u32 m0, s31, 34816
  s_nop 0
  buffer_load_dwordx4 v12, s[8:11], s30 offen lds
  s_add_u32 m0, s31, 35840
  s_nop 0
  buffer_load_dwordx4 v13, s[8:11], s30 offen lds
  s_add_u32 s30, s30, 128
  v_and_b32 v6, 7, v2
  v_add_u32 v4, 0, v3
  v_xor_b32 v4, v4, v6
  v_lshlrev_b32 v4, 4, v4
  v_lshl_add_u32 v14, v2, 7, v4
  v_add_u32 v16, 65536, v14
  v_add_u32 v18, 131072, v14
  v_add_u32 v4, 4, v3
  v_xor_b32 v4, v4, v6
  v_lshlrev_b32 v4, 4, v4
  v_lshl_add_u32 v15, v2, 7, v4
  v_add_u32 v17, 65536, v15
  v_add_u32 v19, 131072, v15
  v_lshlrev_b32 v26, 4, v1
  v_mov_b32 v28, 1
  v_mov_b32 v4, 0x40000000
  v_cmp_eq_u32 vcc, 0, v0
  s_nop 1
  v_cndmask_b32 v27, v4, 0, vcc
  s_mul_i32 s21, s20, 3072
  s_add_u32 s21, s21, 81920
  v_add_u32 v20, s21, v26
  s_mul_i32 s21, s20, 12288
  s_add_u32 s21, s21, 81920
  v_add_u32 v21, s21, v26
  v_add_u32 v22, 2048, v21
  v_add_u32 v23, 2056, v21
  v_and_b32 v4, 7, v2
  v_lshlrev_b32 v4, 4, v4
  v_lshl_add_u32 v24, v3, 7, v4
  v_lshrrev_b32 v25, 1, v24
  v_lshlrev_b32 v29, 3, v1
  v_and_b32 v4, 3, v1
  v_lshlrev_b32 v30, 3, v4
  v_mov_b32 v31, 0xf149f2ca
  v_mov_b32 v32, 0
  v_mov_b32 v4, 1073741824
  v_cmp_eq_u32 vcc, 0, v1
  v_lshlrev_b32 v5, 2, v3
  v_sub_u32 v5, v2, v5
  v_cndmask_b32 v33, v4, 0, vcc
  v_cmp_gt_u32 s[62:63], 2, v3
  s_mov_b32 s83, 0x3dd53b95
  s_lshl_b32 s77, s42, 7
  s_add_u32 s77, s77, 0
  s_xor_b32 s77, s77, s80
  s_lshl_b32 s45, s46, 21
  s_lshl_b32 s21, s46, 13
  s_and_b32 s21, s21, 8192
  s_xor_b32 s21, s21, s80
  s_add_u32 s45, s45, s21
  s_lshl_b32 s21, s42, 16
  s_add_u32 s45, s45, s21
  s_lshr_b32 s47, s42, 1
  s_lshl_b32 s47, s47, 14
  s_and_b32 s22, s42, 1
  s_mul_i32 s22, s22, 2560
  s_add_u32 s47, s47, s22
  s_lshl_b32 s21, s46, 19
  s_lshl_b32 s22, s46, 11
  s_and_b32 s22, s22, 8192
  s_xor_b32 s22, s22, s80
  s_add_u32 s21, s21, s22
  s_add_u32 s21, s21, 134217728
  s_xor_b32 s21, s21, 8192
  s_add_u32 s47, s47, s21
  s_lshl_b32 s48, s46, 7
  s_add_u32 s48, s48, 8192
  s_xor_b32 s48, s48, s80
  s_add_u32 s43, s46, 1
  s_mov_b32 s49, 0
  s_mov_b32 s50, 1073741824
  s_mov_b32 s81, 1073741824
  s_mov_b32 s82, 1073741824
  s_mov_b32 s84, 1073741824
  v_cmp_le_i32 s[64:65], 0, v5
  v_cmp_le_i32 s[66:67], 1, v5
  v_cmp_le_i32 s[68:69], 2, v5
  v_cmp_le_i32 s[70:71], 3, v5
  s_waitcnt vmcnt(8)
  s_barrier
  ds_read_b128 v[160:163], v14 offset:0
  ds_read_b128 v[164:167], v14 offset:2048
  ds_read_b128 v[168:171], v14 offset:4096
  ds_read_b128 v[172:175], v14 offset:6144
  s_waitcnt lgkmcnt(3)
  .p2align 3
qa_231:
  v_mfma_f32_16x16x32_bf16 v[64:67], a[0:3], v[160:163], 0
  ds_read_b128 v[176:179], v14 offset:8192
  v_cvt_pk_bf16_f32 v221, v126, v127
  v_mfma_f32_16x16x32_bf16 v[68:71], a[4:7], v[160:163], 0
  v_cvt_pk_bf16_f32 v222, v128, v129
  v_cvt_pk_bf16_f32 v223, v130, v131
  v_mfma_f32_16x16x32_bf16 v[72:75], a[8:11], v[160:163], 0
  s_waitcnt lgkmcnt(3)
  v_cvt_pk_bf16_f32 v226, v132, v133
  v_cvt_pk_bf16_f32 v227, v134, v135
  v_mfma_f32_16x16x32_bf16 v[76:79], a[0:3], v[164:167], 0
  ds_read_b128 v[180:183], v14 offset:10240
  v_cvt_pk_bf16_f32 v228, v136, v137
  v_mfma_f32_16x16x32_bf16 v[80:83], a[4:7], v[164:167], 0
  v_cvt_pk_bf16_f32 v229, v138, v139
  v_cvt_pk_bf16_f32 v230, v140, v141
  v_mfma_f32_16x16x32_bf16 v[84:87], a[8:11], v[164:167], 0
  s_waitcnt lgkmcnt(3)
  v_cvt_pk_bf16_f32 v231, v142, v143
  v_cvt_pk_bf16_f32 v236, v144, v145
  v_mfma_f32_16x16x32_bf16 v[88:91], a[0:3], v[168:171], 0
  ds_read_b128 v[184:187], v14 offset:12288
  v_cvt_pk_bf16_f32 v237, v146, v147
  v_mfma_f32_16x16x32_bf16 v[92:95], a[4:7], v[168:171], 0
  v_cvt_pk_bf16_f32 v232, v148, v149
  v_cvt_pk_bf16_f32 v233, v150, v151
  v_mfma_f32_16x16x32_bf16 v[96:99], a[8:11], v[168:171], 0
  s_waitcnt lgkmcnt(3)
  v_cvt_pk_bf16_f32 v234, v152, v153
  v_cvt_pk_bf16_f32 v235, v154, v155
  v_mfma_f32_16x16x32_bf16 v[100:103], a[0:3], v[172:175], 0
  ds_read_b128 v[188:191], v14 offset:14336
  v_cvt_pk_bf16_f32 v238, v156, v157
  v_mfma_f32_16x16x32_bf16 v[104:107], a[4:7], v[172:175], 0
  v_cvt_pk_bf16_f32 v239, v158, v159
  ds_write_b128 v20, v[192:195] offset:0
  v_mfma_f32_16x16x32_bf16 v[108:111], a[8:11], v[172:175], 0
  s_waitcnt lgkmcnt(4)
  v_mfma_f32_16x16x32_bf16 v[112:115], a[0:3], v[176:179], 0
  ds_read_b128 v[160:163], v15 offset:0
  s_waitcnt vmcnt(4)
  v_mfma_f32_16x16x32_bf16 v[116:119], a[4:7], v[176:179], 0
  s_add_u32 m0, s31, 49152
  v_cmp_gt_u32 vcc, s49, v32
  v_mfma_f32_16x16x32_bf16 v[120:123], a[8:11], v[176:179], 0
  s_waitcnt lgkmcnt(4)
  buffer_load_dwordx4 v10, s[8:11], s30 offen lds
  s_cbranch_vccnz qw_232
qj_233:
  v_mfma_f32_16x16x32_bf16 v[124:127], a[0:3], v[180:183], 0
  s_add_u32 s29, s50, 4096
  ds_read_b128 v[164:167], v15 offset:2048
  ds_write_b128 v20, v[196:199] offset:1024
  v_mfma_f32_16x16x32_bf16 v[128:131], a[4:7], v[180:183], 0
  v_mfma_f32_16x16x32_bf16 v[132:135], a[8:11], v[180:183], 0
  s_waitcnt lgkmcnt(5)
  buffer_load_dwordx4 a[240:243], v24, s[16:19], s29 offen offset:2560 sc1
  v_mfma_f32_16x16x32_bf16 v[136:139], a[0:3], v[184:187], 0
  ds_read_b128 v[168:171], v15 offset:4096
  v_mfma_f32_16x16x32_bf16 v[140:143], a[4:7], v[184:187], 0
  s_add_u32 m0, s31, 50176
  v_mfma_f32_16x16x32_bf16 v[144:147], a[8:11], v[184:187], 0
  s_waitcnt lgkmcnt(5)
  buffer_load_dwordx4 v11, s[8:11], s30 offen lds
  ds_write_b128 v20, v[200:203] offset:2048
  v_mfma_f32_16x16x32_bf16 v[148:151], a[0:3], v[188:191], 0
  ds_read_b128 v[172:175], v15 offset:6144
  v_mfma_f32_16x16x32_bf16 v[152:155], a[4:7], v[188:191], 0
  v_mfma_f32_16x16x32_bf16 v[156:159], a[8:11], v[188:191], 0
  s_waitcnt lgkmcnt(5)
  buffer_load_dwordx2 v[240:241], v25, s[16:19], s29 offen offset:3072 sc1
  s_add_u32 s29, s50, 20480
  v_mfma_f32_16x16x32_bf16 v[64:67], a[12:15], v[160:163], v[64:67]
  ds_read_b128 v[176:179], v15 offset:8192
  v_mfma_f32_16x16x32_bf16 v[68:71], a[16:19], v[160:163], v[68:71]
  s_add_u32 m0, s31, 51200
  ds_write_b128 v20, v[204:207] offset:12288
  v_mfma_f32_16x16x32_bf16 v[72:75], a[20:23], v[160:163], v[72:75]
  s_waitcnt lgkmcnt(6)
  buffer_load_dwordx4 v12, s[8:11], s30 offen lds
  v_mfma_f32_16x16x32_bf16 v[76:79], a[12:15], v[164:167], v[76:79]
  ds_read_b128 v[180:183], v15 offset:10240
  v_mfma_f32_16x16x32_bf16 v[80:83], a[16:19], v[164:167], v[80:83]
  v_mfma_f32_16x16x32_bf16 v[84:87], a[20:23], v[164:167], v[84:87]
  s_waitcnt lgkmcnt(5)
  buffer_load_dwordx4 a[244:247], v24, s[16:19], s29 offen offset:2560 sc1
  v_mfma_f32_16x16x32_bf16 v[88:91], a[12:15], v[168:171], v[88:91]
  ds_read_b128 v[184:187], v15 offset:12288
  ds_write_b128 v20, v[208:211] offset:13312
  v_mfma_f32_16x16x32_bf16 v[92:95], a[16:19], v[168:171], v[92:95]
  s_add_u32 m0, s31, 52224
  v_mfma_f32_16x16x32_bf16 v[96:99], a[20:23], v[168:171], v[96:99]
  s_waitcnt lgkmcnt(5)
  buffer_load_dwordx4 v13, s[8:11], s30 offen lds
  v_mfma_f32_16x16x32_bf16 v[100:103], a[12:15], v[172:175], v[100:103]
  s_add_u32 s30, s30, 128
  ds_read_b128 v[188:191], v15 offset:14336
  v_mfma_f32_16x16x32_bf16 v[104:107], a[16:19], v[172:175], v[104:107]
  v_mfma_f32_16x16x32_bf16 v[108:111], a[20:23], v[172:175], v[108:111]
  s_waitcnt lgkmcnt(5)
  ds_write_b128 v20, v[212:215] offset:14336
  v_mfma_f32_16x16x32_bf16 v[112:115], a[12:15], v[176:179], v[112:115]
  s_waitcnt vmcnt(11)
  s_barrier
  ds_read_b128 v[160:163], v14 offset:16384
  v_mfma_f32_16x16x32_bf16 v[116:119], a[16:19], v[176:179], v[116:119]
  s_waitcnt vmcnt(13)
  buffer_atomic_add v28, v33, s[72:75], s84 offen sc1
  v_mfma_f32_16x16x32_bf16 v[120:123], a[20:23], v[176:179], v[120:123]
  s_waitcnt lgkmcnt(5)
  v_mfma_f32_16x16x32_bf16 v[124:127], a[12:15], v[180:183], v[124:127]
  ds_read_b128 v[164:167], v14 offset:18432
  v_mfma_f32_16x16x32_bf16 v[128:131], a[16:19], v[180:183], v[128:131]
  ds_write_b128 v20, v[216:219] offset:24576
  buffer_load_dwordx2 v[242:243], v25, s[16:19], s29 offen offset:3072 sc1
  v_mfma_f32_16x16x32_bf16 v[132:135], a[20:23], v[180:183], v[132:135]
  s_add_u32 s29, s50, 36864
  s_waitcnt lgkmcnt(6)
  v_mfma_f32_16x16x32_bf16 v[136:139], a[12:15], v[184:187], v[136:139]
  ds_read_b128 v[168:171], v14 offset:20480
  v_mfma_f32_16x16x32_bf16 v[140:143], a[16:19], v[184:187], v[140:143]
  buffer_load_dwordx4 a[248:251], v24, s[16:19], s29 offen offset:2560 sc1
  v_mfma_f32_16x16x32_bf16 v[144:147], a[20:23], v[184:187], v[144:147]
  s_waitcnt lgkmcnt(5)
  v_mfma_f32_16x16x32_bf16 v[148:151], a[12:15], v[188:191], v[148:151]
  ds_read_b128 v[172:175], v14 offset:22528
  ds_write_b128 v20, v[220:223] offset:25600
  v_mfma_f32_16x16x32_bf16 v[152:155], a[16:19], v[188:191], v[152:155]
  buffer_load_dwordx2 v[244:245], v25, s[16:19], s29 offen offset:3072 sc1
  s_add_u32 s29, s50, 53248
  v_mfma_f32_16x16x32_bf16 v[156:159], a[20:23], v[188:191], v[156:159]
  s_waitcnt lgkmcnt(5)
  v_mfma_f32_16x16x32_bf16 v[64:67], a[24:27], v[160:163], v[64:67]
  ds_read_b128 v[176:179], v14 offset:24576
  v_mfma_f32_16x16x32_bf16 v[68:71], a[28:31], v[160:163], v[68:71]
  s_add_u32 m0, s31, 65536
  v_mfma_f32_16x16x32_bf16 v[72:75], a[32:35], v[160:163], v[72:75]
  s_waitcnt lgkmcnt(5)
  buffer_load_dwordx4 v10, s[8:11], s30 offen lds
  ds_write_b128 v20, v[224:227] offset:26624
  v_mfma_f32_16x16x32_bf16 v[76:79], a[24:27], v[164:167], v[76:79]
  ds_read_b128 v[180:183], v14 offset:26624
  v_mfma_f32_16x16x32_bf16 v[80:83], a[28:31], v[164:167], v[80:83]
  v_mfma_f32_16x16x32_bf16 v[84:87], a[32:35], v[164:167], v[84:87]
  s_waitcnt lgkmcnt(5)
  buffer_load_dwordx4 a[252:255], v24, s[16:19], s29 offen offset:2560 sc1
  v_mfma_f32_16x16x32_bf16 v[88:91], a[24:27], v[168:171], v[88:91]
  ds_read_b128 v[184:187], v14 offset:28672
  v_mfma_f32_16x16x32_bf16 v[92:95], a[28:31], v[168:171], v[92:95]
  ds_write_b128 v20, v[228:231] offset:36864
  v_mfma_f32_16x16x32_bf16 v[96:99], a[32:35], v[168:171], v[96:99]
  s_waitcnt lgkmcnt(6)
  buffer_load_dwordx2 v[246:247], v25, s[16:19], s29 offen offset:3072 sc1
  v_mfma_f32_16x16x32_bf16 v[100:103], a[24:27], v[172:175], v[100:103]
  ds_read_b128 v[188:191], v14 offset:30720
  v_mfma_f32_16x16x32_bf16 v[104:107], a[28:31], v[172:175], v[104:107]
  s_add_u32 m0, s31, 66560
  v_mfma_f32_16x16x32_bf16 v[108:111], a[32:35], v[172:175], v[108:111]
  s_waitcnt lgkmcnt(5)
  buffer_load_dwordx4 v11, s[8:11], s30 offen lds
  v_mfma_f32_16x16x32_bf16 v[112:115], a[24:27], v[176:179], v[112:115]
  ds_read_b128 v[160:163], v15 offset:16384
  ds_write_b128 v20, v[232:235] offset:37888
  v_mfma_f32_16x16x32_bf16 v[116:119], a[28:31], v[176:179], v[116:119]
  v_mfma_f32_16x16x32_bf16 v[120:123], a[32:35], v[176:179], v[120:123]
  s_waitcnt lgkmcnt(5)
  v_mfma_f32_16x16x32_bf16 v[124:127], a[24:27], v[180:183], v[124:127]
  ds_read_b128 v[164:167], v15 offset:18432
  v_mfma_f32_16x16x32_bf16 v[128:131], a[28:31], v[180:183], v[128:131]
  v_mfma_f32_16x16x32_bf16 v[132:135], a[32:35], v[180:183], v[132:135]
  s_waitcnt lgkmcnt(5)
  ds_write_b128 v20, v[236:239] offset:38912
  v_mfma_f32_16x16x32_bf16 v[136:139], a[24:27], v[184:187], v[136:139]
  ds_read_b128 v[168:171], v15 offset:20480
  v_mfma_f32_16x16x32_bf16 v[140:143], a[28:31], v[184:187], v[140:143]
  s_add_u32 m0, s31, 67584
  s_cmp_eq_u32 s26, s85
  s_cbranch_scc1 qs_229
qs_230:
  v_mfma_f32_16x16x32_bf16 v[144:147], a[32:35], v[184:187], v[144:147]
  s_waitcnt lgkmcnt(5)
  buffer_load_dwordx4 v12, s[8:11], s30 offen lds
  s_waitcnt lgkmcnt(1)
  v_mfma_f32_16x16x32_bf16 v[148:151], a[24:27], v[188:191], v[148:151]
  s_add_u32 s29, s50, 0
  ds_read_b128 v[172:175], v15 offset:22528
  v_mfma_f32_16x16x32_bf16 v[152:155], a[28:31], v[188:191], v[152:155]
  v_mfma_f32_16x16x32_bf16 v[156:159], a[32:35], v[188:191], v[156:159]
  s_waitcnt lgkmcnt(5)
  buffer_load_dwordx4 v[192:195], v26, s[16:19], s29 offen offset:0 sc1
  v_mfma_f32_16x16x32_bf16 v[64:67], a[36:39], v[160:163], v[64:67]
  ds_read_b128 v[176:179], v15 offset:24576
  v_mfma_f32_16x16x32_bf16 v[68:71], a[40:43], v[160:163], v[68:71]
  v_mfma_f32_16x16x32_bf16 v[72:75], a[44:47], v[160:163], v[72:75]
  s_waitcnt lgkmcnt(4)
  buffer_load_dwordx4 v[196:199], v26, s[16:19], s29 offen offset:1024 sc1
  v_mfma_f32_16x16x32_bf16 v[76:79], a[36:39], v[164:167], v[76:79]
  ds_read_b128 v[180:183], v15 offset:26624
  v_mfma_f32_16x16x32_bf16 v[80:83], a[40:43], v[164:167], v[80:83]
  s_add_u32 m0, s31, 68608
  v_mfma_f32_16x16x32_bf16 v[84:87], a[44:47], v[164:167], v[84:87]
  s_waitcnt lgkmcnt(3)
  buffer_load_dwordx4 v13, s[8:11], s30 offen lds
  v_mfma_f32_16x16x32_bf16 v[88:91], a[36:39], v[168:171], v[88:91]
  s_add_u32 s30, s30, 128
  ds_read_b128 v[184:187], v15 offset:28672
  v_mfma_f32_16x16x32_bf16 v[92:95], a[40:43], v[168:171], v[92:95]
  v_mfma_f32_16x16x32_bf16 v[96:99], a[44:47], v[168:171], v[96:99]
  s_waitcnt lgkmcnt(3)
  buffer_load_dwordx4 v[224:227], v26, s[16:19], s29 offen offset:2048 sc1
  s_add_u32 s29, s50, 16384
  v_mfma_f32_16x16x32_bf16 v[100:103], a[36:39], v[172:175], v[100:103]
  ds_read_b128 v[188:191], v15 offset:30720
  v_mfma_f32_16x16x32_bf16 v[104:107], a[40:43], v[172:175], v[104:107]
  v_mfma_f32_16x16x32_bf16 v[108:111], a[44:47], v[172:175], v[108:111]
  s_waitcnt lgkmcnt(3)
  buffer_load_dwordx4 v[200:203], v26, s[16:19], s29 offen offset:0 sc1
  v_mfma_f32_16x16x32_bf16 v[112:115], a[36:39], v[176:179], v[112:115]
  s_waitcnt vmcnt(21)
  s_barrier
  ds_read_b128 v[160:163], v14 offset:32768
  v_mfma_f32_16x16x32_bf16 v[116:119], a[40:43], v[176:179], v[116:119]
  v_mfma_f32_16x16x32_bf16 v[120:123], a[44:47], v[176:179], v[120:123]
  s_waitcnt lgkmcnt(3)
  buffer_load_dwordx4 v[204:207], v26, s[16:19], s29 offen offset:1024 sc1
  v_mfma_f32_16x16x32_bf16 v[124:127], a[36:39], v[180:183], v[124:127]
  ds_read_b128 v[164:167], v14 offset:34816
  v_mfma_f32_16x16x32_bf16 v[128:131], a[40:43], v[180:183], v[128:131]
  v_mfma_f32_16x16x32_bf16 v[132:135], a[44:47], v[180:183], v[132:135]
  s_waitcnt lgkmcnt(3)
  buffer_load_dwordx4 v[228:231], v26, s[16:19], s29 offen offset:2048 sc1
  s_add_u32 s29, s50, 32768
  v_mfma_f32_16x16x32_bf16 v[136:139], a[36:39], v[184:187], v[136:139]
  ds_read_b128 v[168:171], v14 offset:36864
  v_mfma_f32_16x16x32_bf16 v[140:143], a[40:43], v[184:187], v[140:143]
  v_mfma_f32_16x16x32_bf16 v[144:147], a[44:47], v[184:187], v[144:147]
  s_waitcnt lgkmcnt(3)
  buffer_load_dwordx4 v[208:211], v26, s[16:19], s29 offen offset:0 sc1
  v_mfma_f32_16x16x32_bf16 v[148:151], a[36:39], v[188:191], v[148:151]
  ds_read_b128 v[172:175], v14 offset:38912
  v_mfma_f32_16x16x32_bf16 v[152:155], a[40:43], v[188:191], v[152:155]
  v_mfma_f32_16x16x32_bf16 v[156:159], a[44:47], v[188:191], v[156:159]
  s_waitcnt lgkmcnt(3)
  buffer_load_dwordx4 v[212:215], v26, s[16:19], s29 offen offset:1024 sc1
  v_mfma_f32_16x16x32_bf16 v[64:67], a[48:51], v[160:163], v[64:67]
  ds_read_b128 v[176:179], v14 offset:40960
  v_mfma_f32_16x16x32_bf16 v[68:71], a[52:55], v[160:163], v[68:71]
  s_add_u32 m0, s31, 0
  v_mfma_f32_16x16x32_bf16 v[72:75], a[56:59], v[160:163], v[72:75]
  s_waitcnt lgkmcnt(3)
  buffer_load_dwordx4 v10, s[8:11], s30 offen lds
  v_mfma_f32_16x16x32_bf16 v[76:79], a[48:51], v[164:167], v[76:79]
  ds_read_b128 v[180:183], v14 offset:43008
  v_mfma_f32_16x16x32_bf16 v[80:83], a[52:55], v[164:167], v[80:83]
  v_mfma_f32_16x16x32_bf16 v[84:87], a[56:59], v[164:167], v[84:87]
  s_waitcnt lgkmcnt(3)
  buffer_load_dwordx4 v[232:235], v26, s[16:19], s29 offen offset:2048 sc1
  s_add_u32 s29, s50, 49152
  v_mfma_f32_16x16x32_bf16 v[88:91], a[48:51], v[168:171], v[88:91]
  ds_read_b128 v[184:187], v14 offset:45056
  v_mfma_f32_16x16x32_bf16 v[92:95], a[52:55], v[168:171], v[92:95]
  v_mfma_f32_16x16x32_bf16 v[96:99], a[56:59], v[168:171], v[96:99]
  s_waitcnt lgkmcnt(3)
  buffer_load_dwordx4 v[216:219], v26, s[16:19], s29 offen offset:0 sc1
  v_mfma_f32_16x16x32_bf16 v[100:103], a[48:51], v[172:175], v[100:103]
  ds_read_b128 v[188:191], v14 offset:47104
  v_mfma_f32_16x16x32_bf16 v[104:107], a[52:55], v[172:175], v[104:107]
  s_add_u32 m0, s31, 1024
  v_mfma_f32_16x16x32_bf16 v[108:111], a[56:59], v[172:175], v[108:111]
  s_waitcnt lgkmcnt(3)
  buffer_load_dwordx4 v11, s[8:11], s30 offen lds
  v_mfma_f32_16x16x32_bf16 v[112:115], a[48:51], v[176:179], v[112:115]
  ds_read_b128 v[160:163], v15 offset:32768
  v_mfma_f32_16x16x32_bf16 v[116:119], a[52:55], v[176:179], v[116:119]
  v_mfma_f32_16x16x32_bf16 v[120:123], a[56:59], v[176:179], v[120:123]
  s_waitcnt lgkmcnt(3)
  buffer_load_dwordx4 v[220:223], v26, s[16:19], s29 offen offset:1024 sc1
  v_mfma_f32_16x16x32_bf16 v[124:127], a[48:51], v[180:183], v[124:127]
  ds_read_b128 v[164:167], v15 offset:34816
  v_mfma_f32_16x16x32_bf16 v[128:131], a[52:55], v[180:183], v[128:131]
  v_mfma_f32_16x16x32_bf16 v[132:135], a[56:59], v[180:183], v[132:135]
  s_waitcnt lgkmcnt(3)
  buffer_load_dwordx4 v[236:239], v26, s[16:19], s29 offen offset:2048 sc1
  v_mfma_f32_16x16x32_bf16 v[136:139], a[48:51], v[184:187], v[136:139]
  ds_read_b128 v[168:171], v15 offset:36864
  v_mfma_f32_16x16x32_bf16 v[140:143], a[52:55], v[184:187], v[140:143]
  s_add_u32 m0, s31, 2048
  v_mfma_f32_16x16x32_bf16 v[144:147], a[56:59], v[184:187], v[144:147]
  s_waitcnt lgkmcnt(3)
  buffer_load_dwordx4 v12, s[8:11], s30 offen lds
  v_mfma_f32_16x16x32_bf16 v[148:151], a[48:51], v[188:191], v[148:151]
  ds_read_b128 v[172:175], v15 offset:38912
  v_mfma_f32_16x16x32_bf16 v[152:155], a[52:55], v[188:191], v[152:155]
  v_mfma_f32_16x16x32_bf16 v[156:159], a[56:59], v[188:191], v[156:159]
  s_waitcnt lgkmcnt(3)
  v_mfma_f32_16x16x32_bf16 v[64:67], a[60:63], v[160:163], v[64:67]
  ds_read_b128 v[176:179], v15 offset:40960
  v_mfma_f32_16x16x32_bf16 v[68:71], a[64:67], v[160:163], v[68:71]
  v_mfma_f32_16x16x32_bf16 v[72:75], a[68:71], v[160:163], v[72:75]
  s_waitcnt lgkmcnt(3)
  v_mfma_f32_16x16x32_bf16 v[76:79], a[60:63], v[164:167], v[76:79]
  ds_read_b128 v[180:183], v15 offset:43008
  v_mfma_f32_16x16x32_bf16 v[80:83], a[64:67], v[164:167], v[80:83]
  s_add_u32 m0, s31, 3072
  v_mfma_f32_16x16x32_bf16 v[84:87], a[68:71], v[164:167], v[84:87]
  s_waitcnt lgkmcnt(3)
  buffer_load_dwordx4 v13, s[8:11], s30 offen lds
  v_mfma_f32_16x16x32_bf16 v[88:91], a[60:63], v[168:171], v[88:91]
  s_add_u32 s30, s30, 128
  ds_read_b128 v[184:187], v15 offset:45056
  v_mfma_f32_16x16x32_bf16 v[92:95], a[64:67], v[168:171], v[92:95]
  v_mfma_f32_16x16x32_bf16 v[96:99], a[68:71], v[168:171], v[96:99]
  s_waitcnt lgkmcnt(3)
  v_mfma_f32_16x16x32_bf16 v[100:103], a[60:63], v[172:175], v[100:103]
  ds_read_b128 v[188:191], v15 offset:47104
  v_mfma_f32_16x16x32_bf16 v[104:107], a[64:67], v[172:175], v[104:107]
  v_mfma_f32_16x16x32_bf16 v[108:111], a[68:71], v[172:175], v[108:111]
  s_waitcnt lgkmcnt(3)
  v_mfma_f32_16x16x32_bf16 v[112:115], a[60:63], v[176:179], v[112:115]
  s_waitcnt vmcnt(26)
  s_barrier
  ds_read_b128 v[160:163], v14 offset:49152
  v_mfma_f32_16x16x32_bf16 v[116:119], a[64:67], v[176:179], v[116:119]
  v_mfma_f32_16x16x32_bf16 v[120:123], a[68:71], v[176:179], v[120:123]
  s_waitcnt lgkmcnt(3)
  v_mfma_f32_16x16x32_bf16 v[124:127], a[60:63], v[180:183], v[124:127]
  ds_read_b128 v[164:167], v14 offset:51200
  v_mfma_f32_16x16x32_bf16 v[128:131], a[64:67], v[180:183], v[128:131]
  v_mfma_f32_16x16x32_bf16 v[132:135], a[68:71], v[180:183], v[132:135]
  s_waitcnt lgkmcnt(3)
  v_mfma_f32_16x16x32_bf16 v[136:139], a[60:63], v[184:187], v[136:139]
  ds_read_b128 v[168:171], v14 offset:53248
  v_mfma_f32_16x16x32_bf16 v[140:143], a[64:67], v[184:187], v[140:143]
  v_mfma_f32_16x16x32_bf16 v[144:147], a[68:71], v[184:187], v[144:147]
  s_waitcnt lgkmcnt(3)
  v_mfma_f32_16x16x32_bf16 v[148:151], a[60:63], v[188:191], v[148:151]
  ds_read_b128 v[172:175], v14 offset:55296
  v_mfma_f32_16x16x32_bf16 v[152:155], a[64:67], v[188:191], v[152:155]
  v_mfma_f32_16x16x32_bf16 v[156:159], a[68:71], v[188:191], v[156:159]
  s_waitcnt lgkmcnt(3)
  v_mfma_f32_16x16x32_bf16 v[64:67], a[72:75], v[160:163], v[64:67]
  ds_read_b128 v[176:179], v14 offset:57344
  v_mfma_f32_16x16x32_bf16 v[68:71], a[76:79], v[160:163], v[68:71]
  s_add_u32 m0, s31, 16384
  v_mfma_f32_16x16x32_bf16 v[72:75], a[80:83], v[160:163], v[72:75]
  s_waitcnt lgkmcnt(3)
  buffer_load_dwordx4 v10, s[8:11], s30 offen lds
  v_mfma_f32_16x16x32_bf16 v[76:79], a[72:75], v[164:167], v[76:79]
  ds_read_b128 v[180:183], v14 offset:59392
  v_mfma_f32_16x16x32_bf16 v[80:83], a[76:79], v[164:167], v[80:83]
  v_mfma_f32_16x16x32_bf16 v[84:87], a[80:83], v[164:167], v[84:87]
  s_waitcnt lgkmcnt(3)
  v_mfma_f32_16x16x32_bf16 v[88:91], a[72:75], v[168:171], v[88:91]
  ds_read_b128 v[184:187], v14 offset:61440
  v_mfma_f32_16x16x32_bf16 v[92:95], a[76:79], v[168:171], v[92:95]
  v_mfma_f32_16x16x32_bf16 v[96:99], a[80:83], v[168:171], v[96:99]
  s_waitcnt lgkmcnt(3)
  v_mfma_f32_16x16x32_bf16 v[100:103], a[72:75], v[172:175], v[100:103]
  ds_read_b128 v[188:191], v14 offset:63488
  v_mfma_f32_16x16x32_bf16 v[104:107], a[76:79], v[172:175], v[104:107]
  s_add_u32 m0, s31, 17408
  v_mfma_f32_16x16x32_bf16 v[108:111], a[80:83], v[172:175], v[108:111]
  s_waitcnt lgkmcnt(3)
  buffer_load_dwordx4 v11, s[8:11], s30 offen lds
  v_mfma_f32_16x16x32_bf16 v[112:115], a[72:75], v[176:179], v[112:115]
  ds_read_b128 v[160:163], v15 offset:49152
  v_mfma_f32_16x16x32_bf16 v[116:119], a[76:79], v[176:179], v[116:119]
  v_mfma_f32_16x16x32_bf16 v[120:123], a[80:83], v[176:179], v[120:123]
  s_waitcnt lgkmcnt(3)
  v_mfma_f32_16x16x32_bf16 v[124:127], a[72:75], v[180:183], v[124:127]
  ds_read_b128 v[164:167], v15 offset:51200
  v_mfma_f32_16x16x32_bf16 v[128:131], a[76:79], v[180:183], v[128:131]
  v_mfma_f32_16x16x32_bf16 v[132:135], a[80:83], v[180:183], v[132:135]
  s_waitcnt lgkmcnt(3)
  v_mfma_f32_16x16x32_bf16 v[136:139], a[72:75], v[184:187], v[136:139]
  ds_read_b128 v[168:171], v15 offset:53248
  v_mfma_f32_16x16x32_bf16 v[140:143], a[76:79], v[184:187], v[140:143]
  s_add_u32 m0, s31, 18432
  v_mfma_f32_16x16x32_bf16 v[144:147], a[80:83], v[184:187], v[144:147]
  s_waitcnt lgkmcnt(3)
  buffer_load_dwordx4 v12, s[8:11], s30 offen lds
  v_mfma_f32_16x16x32_bf16 v[148:151], a[72:75], v[188:191], v[148:151]
  ds_read_b128 v[172:175], v15 offset:55296
  v_mfma_f32_16x16x32_bf16 v[152:155], a[76:79], v[188:191], v[152:155]
  v_mfma_f32_16x16x32_bf16 v[156:159], a[80:83], v[188:191], v[156:159]
  s_waitcnt lgkmcnt(3)
  v_mfma_f32_16x16x32_bf16 v[64:67], a[84:87], v[160:163], v[64:67]
  ds_read_b128 v[176:179], v15 offset:57344
  v_mfma_f32_16x16x32_bf16 v[68:71], a[88:91], v[160:163], v[68:71]
  v_mfma_f32_16x16x32_bf16 v[72:75], a[92:95], v[160:163], v[72:75]
  s_waitcnt lgkmcnt(3)
  v_mfma_f32_16x16x32_bf16 v[76:79], a[84:87], v[164:167], v[76:79]
  ds_read_b128 v[180:183], v15 offset:59392
  v_mfma_f32_16x16x32_bf16 v[80:83], a[88:91], v[164:167], v[80:83]
  s_add_u32 m0, s31, 19456
  v_mfma_f32_16x16x32_bf16 v[84:87], a[92:95], v[164:167], v[84:87]
  s_waitcnt lgkmcnt(3)
  buffer_load_dwordx4 v13, s[8:11], s30 offen lds
  v_mfma_f32_16x16x32_bf16 v[88:91], a[84:87], v[168:171], v[88:91]
  s_add_u32 s30, s30, 128
  ds_read_b128 v[184:187], v15 offset:61440
  v_mfma_f32_16x16x32_bf16 v[92:95], a[88:91], v[168:171], v[92:95]
  v_mfma_f32_16x16x32_bf16 v[96:99], a[92:95], v[168:171], v[96:99]
  s_waitcnt lgkmcnt(3)
  v_mfma_f32_16x16x32_bf16 v[100:103], a[84:87], v[172:175], v[100:103]
  ds_read_b128 v[188:191], v15 offset:63488
  v_mfma_f32_16x16x32_bf16 v[104:107], a[88:91], v[172:175], v[104:107]
  v_mfma_f32_16x16x32_bf16 v[108:111], a[92:95], v[172:175], v[108:111]
  s_waitcnt lgkmcnt(3)
  v_mfma_f32_16x16x32_bf16 v[112:115], a[84:87], v[176:179], v[112:115]
  s_waitcnt vmcnt(18)
  s_barrier
  ds_read_b128 v[160:163], v16 offset:0
  v_mfma_f32_16x16x32_bf16 v[116:119], a[88:91], v[176:179], v[116:119]
  v_mfma_f32_16x16x32_bf16 v[120:123], a[92:95], v[176:179], v[120:123]
  s_waitcnt lgkmcnt(3)
  v_mfma_f32_16x16x32_bf16 v[124:127], a[84:87], v[180:183], v[124:127]
  ds_read_b128 v[164:167], v16 offset:2048
  v_mfma_f32_16x16x32_bf16 v[128:131], a[88:91], v[180:183], v[128:131]
  v_mfma_f32_16x16x32_bf16 v[132:135], a[92:95], v[180:183], v[132:135]
  s_waitcnt lgkmcnt(3)
  v_mfma_f32_16x16x32_bf16 v[136:139], a[84:87], v[184:187], v[136:139]
  ds_read_b128 v[168:171], v16 offset:4096
  v_mfma_f32_16x16x32_bf16 v[140:143], a[88:91], v[184:187], v[140:143]
  v_mfma_f32_16x16x32_bf16 v[144:147], a[92:95], v[184:187], v[144:147]
  s_waitcnt lgkmcnt(3)
  v_mfma_f32_16x16x32_bf16 v[148:151], a[84:87], v[188:191], v[148:151]
  ds_read_b128 v[172:175], v16 offset:6144
  v_mfma_f32_16x16x32_bf16 v[152:155], a[88:91], v[188:191], v[152:155]
  v_mfma_f32_16x16x32_bf16 v[156:159], a[92:95], v[188:191], v[156:159]
  s_waitcnt lgkmcnt(3)
  v_mfma_f32_16x16x32_bf16 v[64:67], a[96:99], v[160:163], v[64:67]
  ds_read_b128 v[176:179], v16 offset:8192
  v_mfma_f32_16x16x32_bf16 v[68:71], a[100:103], v[160:163], v[68:71]
  s_add_u32 m0, s31, 32768
  v_mfma_f32_16x16x32_bf16 v[72:75], a[104:107], v[160:163], v[72:75]
  s_waitcnt lgkmcnt(3)
  buffer_load_dwordx4 v10, s[8:11], s30 offen lds
  v_mfma_f32_16x16x32_bf16 v[76:79], a[96:99], v[164:167], v[76:79]
  ds_read_b128 v[180:183], v16 offset:10240
  v_mfma_f32_16x16x32_bf16 v[80:83], a[100:103], v[164:167], v[80:83]
  v_mfma_f32_16x16x32_bf16 v[84:87], a[104:107], v[164:167], v[84:87]
  s_waitcnt lgkmcnt(3)
  v_mfma_f32_16x16x32_bf16 v[88:91], a[96:99], v[168:171], v[88:91]
  ds_read_b128 v[184:187], v16 offset:12288
  v_mfma_f32_16x16x32_bf16 v[92:95], a[100:103], v[168:171], v[92:95]
  v_mfma_f32_16x16x32_bf16 v[96:99], a[104:107], v[168:171], v[96:99]
  s_waitcnt lgkmcnt(3)
  v_mfma_f32_16x16x32_bf16 v[100:103], a[96:99], v[172:175], v[100:103]
  ds_read_b128 v[188:191], v16 offset:14336
  v_mfma_f32_16x16x32_bf16 v[104:107], a[100:103], v[172:175], v[104:107]
  s_add_u32 m0, s31, 33792
  v_mfma_f32_16x16x32_bf16 v[108:111], a[104:107], v[172:175], v[108:111]
  s_waitcnt lgkmcnt(3)
  buffer_load_dwordx4 v11, s[8:11], s30 offen lds
  v_mfma_f32_16x16x32_bf16 v[112:115], a[96:99], v[176:179], v[112:115]
  ds_read_b128 v[160:163], v17 offset:0
  v_mfma_f32_16x16x32_bf16 v[116:119], a[100:103], v[176:179], v[116:119]
  v_mfma_f32_16x16x32_bf16 v[120:123], a[104:107], v[176:179], v[120:123]
  s_waitcnt lgkmcnt(3)
  v_mfma_f32_16x16x32_bf16 v[124:127], a[96:99], v[180:183], v[124:127]
  ds_read_b128 v[164:167], v17 offset:2048
  v_mfma_f32_16x16x32_bf16 v[128:131], a[100:103], v[180:183], v[128:131]
  v_mfma_f32_16x16x32_bf16 v[132:135], a[104:107], v[180:183], v[132:135]
  s_waitcnt lgkmcnt(3)
  v_mfma_f32_16x16x32_bf16 v[136:139], a[96:99], v[184:187], v[136:139]
  ds_read_b128 v[168:171], v17 offset:4096
  v_mfma_f32_16x16x32_bf16 v[140:143], a[100:103], v[184:187], v[140:143]
  s_add_u32 m0, s31, 34816
  v_mfma_f32_16x16x32_bf16 v[144:147], a[104:107], v[184:187], v[144:147]
  s_waitcnt lgkmcnt(3)
  buffer_load_dwordx4 v12, s[8:11], s30 offen lds
  v_mfma_f32_16x16x32_bf16 v[148:151], a[96:99], v[188:191], v[148:151]
  ds_read_b128 v[172:175], v17 offset:6144
  v_mfma_f32_16x16x32_bf16 v[152:155], a[100:103], v[188:191], v[152:155]
  v_mfma_f32_16x16x32_bf16 v[156:159], a[104:107], v[188:191], v[156:159]
  s_waitcnt lgkmcnt(3)
  v_mfma_f32_16x16x32_bf16 v[64:67], a[108:111], v[160:163], v[64:67]
  ds_read_b128 v[176:179], v17 offset:8192
  v_mfma_f32_16x16x32_bf16 v[68:71], a[112:115], v[160:163], v[68:71]
  v_mfma_f32_16x16x32_bf16 v[72:75], a[116:119], v[160:163], v[72:75]
  s_waitcnt lgkmcnt(3)
  v_mfma_f32_16x16x32_bf16 v[76:79], a[108:111], v[164:167], v[76:79]
  ds_read_b128 v[180:183], v17 offset:10240
  v_mfma_f32_16x16x32_bf16 v[80:83], a[112:115], v[164:167], v[80:83]
  s_add_u32 m0, s31, 35840
  v_mfma_f32_16x16x32_bf16 v[84:87], a[116:119], v[164:167], v[84:87]
  s_waitcnt lgkmcnt(3)
  buffer_load_dwordx4 v13, s[8:11], s30 offen lds
  v_mfma_f32_16x16x32_bf16 v[88:91], a[108:111], v[168:171], v[88:91]
  s_add_u32 s30, s30, 128
  ds_read_b128 v[184:187], v17 offset:12288
  v_mfma_f32_16x16x32_bf16 v[92:95], a[112:115], v[168:171], v[92:95]
  v_mfma_f32_16x16x32_bf16 v[96:99], a[116:119], v[168:171], v[96:99]
  s_waitcnt lgkmcnt(3)
  v_mfma_f32_16x16x32_bf16 v[100:103], a[108:111], v[172:175], v[100:103]
  ds_read_b128 v[188:191], v17 offset:14336
  v_mfma_f32_16x16x32_bf16 v[104:107], a[112:115], v[172:175], v[104:107]
  v_mfma_f32_16x16x32_bf16 v[108:111], a[116:119], v[172:175], v[108:111]
  s_waitcnt lgkmcnt(3)
  v_mfma_f32_16x16x32_bf16 v[112:115], a[108:111], v[176:179], v[112:115]
  s_waitcnt vmcnt(8)
  s_barrier
  ds_read_b128 v[160:163], v14 offset:0
  v_mfma_f32_16x16x32_bf16 v[116:119], a[112:115], v[176:179], v[116:119]
  v_mfma_f32_16x16x32_bf16 v[120:123], a[116:119], v[176:179], v[120:123]
  s_waitcnt lgkmcnt(3)
  v_mfma_f32_16x16x32_bf16 v[124:127], a[108:111], v[180:183], v[124:127]
  ds_read_b128 v[164:167], v14 offset:2048
  v_mfma_f32_16x16x32_bf16 v[128:131], a[112:115], v[180:183], v[128:131]
  v_mfma_f32_16x16x32_bf16 v[132:135], a[116:119], v[180:183], v[132:135]
  s_waitcnt lgkmcnt(3)
  v_mfma_f32_16x16x32_bf16 v[136:139], a[108:111], v[184:187], v[136:139]
  ds_read_b128 v[168:171], v14 offset:4096
  v_mfma_f32_16x16x32_bf16 v[140:143], a[112:115], v[184:187], v[140:143]
  v_mfma_f32_16x16x32_bf16 v[144:147], a[116:119], v[184:187], v[144:147]
  s_waitcnt lgkmcnt(3)
  v_mfma_f32_16x16x32_bf16 v[148:151], a[108:111], v[188:191], v[148:151]
  ds_read_b128 v[172:175], v14 offset:6144
  v_mfma_f32_16x16x32_bf16 v[152:155], a[112:115], v[188:191], v[152:155]
  v_mfma_f32_16x16x32_bf16 v[156:159], a[116:119], v[188:191], v[156:159]
  s_waitcnt lgkmcnt(3)
  v_mfma_f32_16x16x32_bf16 v[64:67], a[120:123], v[160:163], v[64:67]
  ds_read_b128 v[176:179], v14 offset:8192
  v_mfma_f32_16x16x32_bf16 v[68:71], a[124:127], v[160:163], v[68:71]
  s_add_u32 m0, s31, 49152
  v_mfma_f32_16x16x32_bf16 v[72:75], a[128:131], v[160:163], v[72:75]
  s_waitcnt lgkmcnt(3)
  buffer_load_dwordx4 v10, s[8:11], s30 offen lds
  v_mfma_f32_16x16x32_bf16 v[76:79], a[120:123], v[164:167], v[76:79]
  ds_read_b128 v[180:183], v14 offset:10240
  s_waitcnt vmcnt(11)
  v_mfma_f32_16x16x32_bf16 v[80:83], a[124:127], v[164:167], v[80:83]
  v_swap_b32 v226, v228
  v_swap_b32 v227, v229
  v_mfma_f32_16x16x32_bf16 v[84:87], a[128:131], v[164:167], v[84:87]
  s_waitcnt lgkmcnt(3)
  v_swap_b32 v234, v236
  v_swap_b32 v235, v237
  v_mfma_f32_16x16x32_bf16 v[88:91], a[120:123], v[168:171], v[88:91]
  ds_read_b128 v[184:187], v14 offset:12288
  v_mfma_f32_16x16x32_bf16 v[92:95], a[124:127], v[168:171], v[92:95]
  ds_read_b128 v[56:59], v21 offset:0
  ds_read_b128 v[60:63], v21 offset:1024
  v_mfma_f32_16x16x32_bf16 v[96:99], a[128:131], v[168:171], v[96:99]
  s_waitcnt lgkmcnt(5)
  v_mfma_f32_16x16x32_bf16 v[100:103], a[120:123], v[172:175], v[100:103]
  ds_read_b128 v[188:191], v14 offset:14336
  v_mfma_f32_16x16x32_bf16 v[104:107], a[124:127], v[172:175], v[104:107]
  s_add_u32 m0, s31, 50176
  v_mfma_f32_16x16x32_bf16 v[108:111], a[128:131], v[172:175], v[108:111]
  s_waitcnt lgkmcnt(5)
  buffer_load_dwordx4 v11, s[8:11], s30 offen lds
  v_mfma_f32_16x16x32_bf16 v[112:115], a[120:123], v[176:179], v[112:115]
  ds_read_b128 v[160:163], v15 offset:0
  v_mfma_f32_16x16x32_bf16 v[116:119], a[124:127], v[176:179], v[116:119]
  ds_read_b128 v[248:251], v21 offset:3072
  ds_read_b128 v[252:255], v21 offset:4096
  v_mfma_f32_16x16x32_bf16 v[120:123], a[128:131], v[176:179], v[120:123]
  s_waitcnt lgkmcnt(4)
  v_mfma_f32_16x16x32_bf16 v[36:39], v[192:195], v[56:59], 0
  v_mfma_f32_16x16x32_bf16 v[44:47], v[192:195], v[60:63], 0
  v_mfma_f32_16x16x32_bf16 v[48:51], v[196:199], v[60:63], 0
  v_mfma_f32_16x16x32_bf16 v[40:43], a[240:243], v[56:59], 0
  v_mfma_f32_16x16x32_bf16 v[52:55], a[240:243], v[60:63], 0
  s_waitcnt lgkmcnt(7)
  ds_read2st64_b64 v[56:59], v22 offset0:0 offset1:6
  ds_read2st64_b64 v[60:63], v23 offset0:0 offset1:6
  v_mfma_f32_16x16x32_bf16 v[124:127], a[120:123], v[180:183], v[124:127]
  ds_read_b128 v[164:167], v15 offset:2048
  v_mfma_f32_16x16x32_bf16 v[128:131], a[124:127], v[180:183], v[128:131]
  v_mfma_f32_16x16x32_bf16 v[132:135], a[128:131], v[180:183], v[132:135]
  s_waitcnt lgkmcnt(9)
  v_mfma_f32_16x16x32_bf16 v[136:139], a[120:123], v[184:187], v[136:139]
  ds_read_b128 v[168:171], v15 offset:4096
  v_mfma_f32_16x16x32_bf16 v[140:143], a[124:127], v[184:187], v[140:143]
  s_add_u32 m0, s31, 51200
  v_mfma_f32_16x16x32_bf16 v[144:147], a[128:131], v[184:187], v[144:147]
  s_waitcnt lgkmcnt(4)
  buffer_load_dwordx4 v12, s[8:11], s30 offen lds
  v_mfma_f32_16x16x32_bf16 v[36:39], v[200:203], v[248:251], v[36:39]
  v_mfma_f32_16x16x32_bf16 v[44:47], v[200:203], v[252:255], v[44:47]
  v_mfma_f32_16x16x32_bf16 v[48:51], v[204:207], v[252:255], v[48:51]
  v_mfma_f32_16x16x32_bf16 v[40:43], a[244:247], v[248:251], v[40:43]
  v_mfma_f32_16x16x32_bf16 v[52:55], a[244:247], v[252:255], v[52:55]
  s_waitcnt lgkmcnt(7)
  ds_read_b128 v[248:251], v21 offset:6144
  ds_read_b128 v[252:255], v21 offset:7168
  v_mfma_f32_16x16x32_bf16 v[148:151], a[120:123], v[188:191], v[148:151]
  ds_read_b128 v[172:175], v15 offset:6144
  v_mfma_f32_16x16x32_bf16 v[152:155], a[124:127], v[188:191], v[152:155]
  v_mfma_f32_16x16x32_bf16 v[156:159], a[128:131], v[188:191], v[156:159]
  s_waitcnt lgkmcnt(9)
  v_mfma_f32_16x16x32_bf16 v[64:67], a[132:135], v[160:163], v[64:67]
  ds_read_b128 v[176:179], v15 offset:8192
  v_mfma_f32_16x16x32_bf16 v[68:71], a[136:139], v[160:163], v[68:71]
  v_mfma_f32_16x16x32_bf16 v[72:75], a[140:143], v[160:163], v[72:75]
  s_waitcnt lgkmcnt(6)
  v_mfma_f32_16x16x32_bf16 v[36:39], v[224:227], v[56:59], v[36:39]
  v_mfma_f32_16x16x32_bf16 v[44:47], v[224:227], v[60:63], v[44:47]
  v_mfma_f32_16x16x32_bf16 v[48:51], v[228:231], v[60:63], v[48:51]
  v_mfma_f32_16x16x32_bf16 v[40:43], v[240:243], v[56:59], v[40:43]
  v_mfma_f32_16x16x32_bf16 v[52:55], v[240:243], v[60:63], v[52:55]
  s_waitcnt lgkmcnt(5)
  ds_read_b128 v[56:59], v21 offset:9216
  ds_read_b128 v[60:63], v21 offset:10240
  v_mfma_f32_16x16x32_bf16 v[76:79], a[132:135], v[164:167], v[76:79]
  ds_read_b128 v[180:183], v15 offset:10240
  v_mfma_f32_16x16x32_bf16 v[80:83], a[136:139], v[164:167], v[80:83]
  s_add_u32 m0, s31, 52224
  v_mfma_f32_16x16x32_bf16 v[84:87], a[140:143], v[164:167], v[84:87]
  s_waitcnt lgkmcnt(7)
  buffer_load_dwordx4 v13, s[8:11], s30 offen lds
  v_mfma_f32_16x16x32_bf16 v[88:91], a[132:135], v[168:171], v[88:91]
  s_add_u32 s30, s30, 128
  ds_read_b128 v[184:187], v15 offset:12288
  v_mfma_f32_16x16x32_bf16 v[92:95], a[136:139], v[168:171], v[92:95]
  v_mfma_f32_16x16x32_bf16 v[96:99], a[140:143], v[168:171], v[96:99]
  s_waitcnt lgkmcnt(6)
  v_mfma_f32_16x16x32_bf16 v[36:39], v[208:211], v[248:251], v[36:39]
  v_mfma_f32_16x16x32_bf16 v[44:47], v[208:211], v[252:255], v[44:47]
  v_mfma_f32_16x16x32_bf16 v[48:51], v[212:215], v[252:255], v[48:51]
  v_mfma_f32_16x16x32_bf16 v[40:43], a[248:251], v[248:251], v[40:43]
  v_mfma_f32_16x16x32_bf16 v[52:55], a[248:251], v[252:255], v[52:55]
  s_waitcnt lgkmcnt(5)
  ds_read2st64_b64 v[248:251], v22 offset0:12 offset1:18
  ds_read2st64_b64 v[252:255], v23 offset0:12 offset1:18
  v_mfma_f32_16x16x32_bf16 v[100:103], a[132:135], v[172:175], v[100:103]
  ds_read_b128 v[188:191], v15 offset:14336
  v_mfma_f32_16x16x32_bf16 v[104:107], a[136:139], v[172:175], v[104:107]
  v_mfma_f32_16x16x32_bf16 v[108:111], a[140:143], v[172:175], v[108:111]
  s_waitcnt lgkmcnt(7)
  v_mfma_f32_16x16x32_bf16 v[112:115], a[132:135], v[176:179], v[112:115]
  s_waitcnt vmcnt(8)
  s_barrier
  ds_read_b128 v[160:163], v14 offset:16384
  v_mfma_f32_16x16x32_bf16 v[116:119], a[136:139], v[176:179], v[116:119]
  v_mfma_f32_16x16x32_bf16 v[120:123], a[140:143], v[176:179], v[120:123]
  s_waitcnt lgkmcnt(6)
  v_mfma_f32_16x16x32_bf16 v[36:39], v[216:219], v[56:59], v[36:39]
  v_mfma_f32_16x16x32_bf16 v[44:47], v[216:219], v[60:63], v[44:47]
  v_mfma_f32_16x16x32_bf16 v[48:51], v[220:223], v[60:63], v[48:51]
  v_mfma_f32_16x16x32_bf16 v[40:43], a[252:255], v[56:59], v[40:43]
  v_mfma_f32_16x16x32_bf16 v[52:55], a[252:255], v[60:63], v[52:55]
  s_waitcnt lgkmcnt(5)
  v_mfma_f32_16x16x32_bf16 v[124:127], a[132:135], v[180:183], v[124:127]
  ds_read_b128 v[164:167], v14 offset:18432
  v_mfma_f32_16x16x32_bf16 v[128:131], a[136:139], v[180:183], v[128:131]
  v_mfma_f32_16x16x32_bf16 v[132:135], a[140:143], v[180:183], v[132:135]
  s_waitcnt lgkmcnt(5)
  v_mfma_f32_16x16x32_bf16 v[136:139], a[132:135], v[184:187], v[136:139]
  ds_read_b128 v[168:171], v14 offset:20480
  v_mfma_f32_16x16x32_bf16 v[140:143], a[136:139], v[184:187], v[140:143]
  v_mfma_f32_16x16x32_bf16 v[144:147], a[140:143], v[184:187], v[144:147]
  s_waitcnt lgkmcnt(4)
  v_mfma_f32_16x16x32_bf16 v[36:39], v[232:235], v[248:251], v[36:39]
  v_mfma_f32_16x16x32_bf16 v[44:47], v[232:235], v[252:255], v[44:47]
  v_mfma_f32_16x16x32_bf16 v[48:51], v[236:239], v[252:255], v[48:51]
  v_mfma_f32_16x16x32_bf16 v[40:43], v[244:247], v[248:251], v[40:43]
  v_mfma_f32_16x16x32_bf16 v[52:55], v[244:247], v[252:255], v[52:55]
  s_waitcnt lgkmcnt(3)
  v_mfma_f32_16x16x32_bf16 v[148:151], a[132:135], v[188:191], v[148:151]
  ds_read_b128 v[172:175], v14 offset:22528
  v_mfma_f32_16x16x32_bf16 v[152:155], a[136:139], v[188:191], v[152:155]
  v_mfma_f32_16x16x32_bf16 v[156:159], a[140:143], v[188:191], v[156:159]
  s_waitcnt lgkmcnt(3)
  v_cndmask_b32 v36, v31, v36, s[64:65]
  v_cndmask_b32 v48, v31, v48, s[64:65]
  v_mfma_f32_16x16x32_bf16 v[64:67], a[144:147], v[160:163], v[64:67]
  ds_read_b128 v[176:179], v14 offset:24576
  v_cndmask_b32 v37, v31, v37, s[66:67]
  v_mfma_f32_16x16x32_bf16 v[68:71], a[148:151], v[160:163], v[68:71]
  s_add_u32 m0, s31, 65536
  v_cndmask_b32 v49, v31, v49, s[66:67]
  v_cndmask_b32 v38, v31, v38, s[68:69]
  v_mfma_f32_16x16x32_bf16 v[72:75], a[152:155], v[160:163], v[72:75]
  s_waitcnt lgkmcnt(3)
  buffer_load_dwordx4 v10, s[8:11], s30 offen lds
  v_cndmask_b32 v50, v31, v50, s[68:69]
  v_mfma_f32_16x16x32_bf16 v[76:79], a[144:147], v[164:167], v[76:79]
  ds_read_b128 v[180:183], v14 offset:26624
  v_cndmask_b32 v39, v31, v39, s[70:71]
  v_mfma_f32_16x16x32_bf16 v[80:83], a[148:151], v[164:167], v[80:83]
  v_cndmask_b32 v51, v31, v51, s[70:71]
  v_max3_f32 v34, v36, v37, v38
  v_mfma_f32_16x16x32_bf16 v[84:87], a[152:155], v[164:167], v[84:87]
  s_waitcnt lgkmcnt(3)
  v_max3_f32 v34, v34, v39, v40
  v_max3_f32 v34, v34, v41, v42
  v_mfma_f32_16x16x32_bf16 v[88:91], a[144:147], v[168:171], v[88:91]
  ds_read_b128 v[184:187], v14 offset:28672
  v_max_f32 v34, v34, v43
  v_mfma_f32_16x16x32_bf16 v[92:95], a[148:151], v[168:171], v[92:95]
  v_mov_b32 v35, v34
  v_mfma_f32_16x16x32_bf16 v[96:99], a[152:155], v[168:171], v[96:99]
  s_waitcnt lgkmcnt(3)
  v_permlane32_swap_b32 v34, v35
  v_max_f32 v34, v34, v35
  v_mfma_f32_16x16x32_bf16 v[100:103], a[144:147], v[172:175], v[100:103]
  ds_read_b128 v[188:191], v14 offset:30720
  v_mov_b32 v35, v34
  v_mfma_f32_16x16x32_bf16 v[104:107], a[148:151], v[172:175], v[104:107]
  s_add_u32 m0, s31, 66560
  v_permlane16_swap_b32 v34, v35
  v_max_f32 v34, v34, v35
  v_mfma_f32_16x16x32_bf16 v[108:111], a[152:155], v[172:175], v[108:111]
  s_waitcnt lgkmcnt(3)
  buffer_load_dwordx4 v11, s[8:11], s30 offen lds
  v_mul_f32 v34, s83, v34
  v_mfma_f32_16x16x32_bf16 v[112:115], a[144:147], v[176:179], v[112:115]
  ds_read_b128 v[160:163], v15 offset:16384
  v_fma_f32 v36, v36, s83, -v34
  v_mfma_f32_16x16x32_bf16 v[116:119], a[148:151], v[176:179], v[116:119]
  v_fma_f32 v37, v37, s83, -v34
  v_fma_f32 v38, v38, s83, -v34
  v_mfma_f32_16x16x32_bf16 v[120:123], a[152:155], v[176:179], v[120:123]
  s_waitcnt lgkmcnt(3)
  v_fma_f32 v39, v39, s83, -v34
  v_fma_f32 v40, v40, s83, -v34
  v_mfma_f32_16x16x32_bf16 v[124:127], a[144:147], v[180:183], v[124:127]
  ds_read_b128 v[164:167], v15 offset:18432
  v_fma_f32 v41, v41, s83, -v34
  v_mfma_f32_16x16x32_bf16 v[128:131], a[148:151], v[180:183], v[128:131]
  v_fma_f32 v42, v42, s83, -v34
  v_fma_f32 v43, v43, s83, -v34
  v_mfma_f32_16x16x32_bf16 v[132:135], a[152:155], v[180:183], v[132:135]
  s_waitcnt lgkmcnt(3)
  v_exp_f32 v36, v36
  v_mfma_f32_16x16x32_bf16 v[136:139], a[144:147], v[184:187], v[136:139]
  ds_read_b128 v[168:171], v15 offset:20480
  v_mfma_f32_16x16x32_bf16 v[140:143], a[148:151], v[184:187], v[140:143]
  s_add_u32 m0, s31, 67584
  v_exp_f32 v37, v37
  v_mfma_f32_16x16x32_bf16 v[144:147], a[152:155], v[184:187], v[144:147]
  s_waitcnt lgkmcnt(3)
  buffer_load_dwordx4 v12, s[8:11], s30 offen lds
  v_mfma_f32_16x16x32_bf16 v[148:151], a[144:147], v[188:191], v[148:151]
  ds_read_b128 v[172:175], v15 offset:22528
  v_mfma_f32_16x16x32_bf16 v[152:155], a[148:151], v[188:191], v[152:155]
  v_exp_f32 v38, v38
  v_mfma_f32_16x16x32_bf16 v[156:159], a[152:155], v[188:191], v[156:159]
  s_waitcnt lgkmcnt(3)
  v_exp_f32 v39, v39
  v_mfma_f32_16x16x32_bf16 v[64:67], a[156:159], v[160:163], v[64:67]
  ds_read_b128 v[176:179], v15 offset:24576
  v_mfma_f32_16x16x32_bf16 v[68:71], a[160:163], v[160:163], v[68:71]
  v_exp_f32 v40, v40
  v_mfma_f32_16x16x32_bf16 v[72:75], a[164:167], v[160:163], v[72:75]
  s_waitcnt lgkmcnt(3)
  v_exp_f32 v41, v41
  v_mfma_f32_16x16x32_bf16 v[76:79], a[156:159], v[164:167], v[76:79]
  ds_read_b128 v[180:183], v15 offset:26624
  v_mfma_f32_16x16x32_bf16 v[80:83], a[160:163], v[164:167], v[80:83]
  s_add_u32 m0, s31, 68608
  v_exp_f32 v42, v42
  v_mfma_f32_16x16x32_bf16 v[84:87], a[164:167], v[164:167], v[84:87]
  s_waitcnt lgkmcnt(3)
  buffer_load_dwordx4 v13, s[8:11], s30 offen lds
  v_mfma_f32_16x16x32_bf16 v[88:91], a[156:159], v[168:171], v[88:91]
  s_add_u32 s30, s30, s25
  ds_read_b128 v[184:187], v15 offset:28672
  v_mfma_f32_16x16x32_bf16 v[92:95], a[160:163], v[168:171], v[92:95]
  v_exp_f32 v43, v43
  v_mfma_f32_16x16x32_bf16 v[96:99], a[164:167], v[168:171], v[96:99]
  s_waitcnt lgkmcnt(3)
  v_add_f32 v34, v40, v41
  v_add_f32 v34, v34, v42
  v_mfma_f32_16x16x32_bf16 v[100:103], a[156:159], v[172:175], v[100:103]
  ds_read_b128 v[188:191], v15 offset:30720
  v_add_f32 v34, v34, v43
  v_mfma_f32_16x16x32_bf16 v[104:107], a[160:163], v[172:175], v[104:107]
  v_cndmask_b32 v34, 0, v34, s[62:63]
  v_add_f32 v34, v34, v36
  v_mfma_f32_16x16x32_bf16 v[108:111], a[164:167], v[172:175], v[108:111]
  s_waitcnt lgkmcnt(3)
  v_add_f32 v34, v34, v37
  v_add_f32 v34, v34, v38
  v_mfma_f32_16x16x32_bf16 v[112:115], a[156:159], v[176:179], v[112:115]
  s_waitcnt vmcnt(8)
  s_barrier
  ds_read_b128 v[160:163], v14 offset:32768
  v_mfma_f32_16x16x32_bf16 v[116:119], a[160:163], v[176:179], v[116:119]
  v_add_f32 v34, v34, v39
  v_mov_b32 v35, v34
  v_mfma_f32_16x16x32_bf16 v[120:123], a[164:167], v[176:179], v[120:123]
  s_waitcnt lgkmcnt(3)
  v_permlane32_swap_b32 v34, v35
  v_add_f32 v34, v34, v35
  v_mfma_f32_16x16x32_bf16 v[124:127], a[156:159], v[180:183], v[124:127]
  ds_read_b128 v[164:167], v14 offset:34816
  v_mov_b32 v35, v34
  v_mfma_f32_16x16x32_bf16 v[128:131], a[160:163], v[180:183], v[128:131]
  v_permlane16_swap_b32 v34, v35
  v_add_f32 v34, v34, v35
  v_mfma_f32_16x16x32_bf16 v[132:135], a[164:167], v[180:183], v[132:135]
  s_waitcnt lgkmcnt(3)
  v_rcp_f32 v34, v34
  v_mfma_f32_16x16x32_bf16 v[136:139], a[156:159], v[184:187], v[136:139]
  ds_read_b128 v[168:171], v14 offset:36864
  v_mul_f32 v36, v36, v34
  v_mfma_f32_16x16x32_bf16 v[140:143], a[160:163], v[184:187], v[140:143]
  v_mul_f32 v37, v37, v34
  v_mul_f32 v38, v38, v34
  v_mfma_f32_16x16x32_bf16 v[144:147], a[164:167], v[184:187], v[144:147]
  s_waitcnt lgkmcnt(3)
  v_mul_f32 v39, v39, v34
  v_mul_f32 v40, v40, v34
  v_mfma_f32_16x16x32_bf16 v[148:151], a[156:159], v[188:191], v[148:151]
  ds_read_b128 v[172:175], v14 offset:38912
  v_mul_f32 v41, v41, v34
  v_mfma_f32_16x16x32_bf16 v[152:155], a[160:163], v[188:191], v[152:155]
  v_mul_f32 v42, v42, v34
  v_mul_f32 v43, v43, v34
  v_mfma_f32_16x16x32_bf16 v[156:159], a[164:167], v[188:191], v[156:159]
  s_waitcnt lgkmcnt(3)
  v_max3_f32 v34, v44, v45, v46
  v_max3_f32 v34, v34, v47, v48
  v_mfma_f32_16x16x32_bf16 v[64:67], a[168:171], v[160:163], v[64:67]
  ds_read_b128 v[176:179], v14 offset:40960
  v_max3_f32 v34, v34, v49, v50
  v_mfma_f32_16x16x32_bf16 v[68:71], a[172:175], v[160:163], v[68:71]
  s_add_u32 m0, s31, 0
  v_max3_f32 v34, v34, v51, v52
  v_max3_f32 v34, v34, v53, v54
  v_mfma_f32_16x16x32_bf16 v[72:75], a[176:179], v[160:163], v[72:75]
  s_waitcnt lgkmcnt(3)
  buffer_load_dwordx4 v10, s[8:11], s30 offen lds
  v_max_f32 v34, v34, v55
  v_mfma_f32_16x16x32_bf16 v[76:79], a[168:171], v[164:167], v[76:79]
  ds_read_b128 v[180:183], v14 offset:43008
  v_mov_b32 v35, v34
  v_mfma_f32_16x16x32_bf16 v[80:83], a[172:175], v[164:167], v[80:83]
  v_permlane32_swap_b32 v34, v35
  v_max_f32 v34, v34, v35
  v_mfma_f32_16x16x32_bf16 v[84:87], a[176:179], v[164:167], v[84:87]
  s_waitcnt lgkmcnt(3)
  v_mov_b32 v35, v34
  v_mfma_f32_16x16x32_bf16 v[88:91], a[168:171], v[168:171], v[88:91]
  ds_read_b128 v[184:187], v14 offset:45056
  v_permlane16_swap_b32 v34, v35
  v_mfma_f32_16x16x32_bf16 v[92:95], a[172:175], v[168:171], v[92:95]
  v_max_f32 v34, v34, v35
  v_mul_f32 v34, s83, v34
  v_mfma_f32_16x16x32_bf16 v[96:99], a[176:179], v[168:171], v[96:99]
  s_waitcnt lgkmcnt(3)
  v_fma_f32 v44, v44, s83, -v34
  v_fma_f32 v45, v45, s83, -v34
  v_mfma_f32_16x16x32_bf16 v[100:103], a[168:171], v[172:175], v[100:103]
  ds_read_b128 v[188:191], v14 offset:47104
  v_fma_f32 v46, v46, s83, -v34
  v_mfma_f32_16x16x32_bf16 v[104:107], a[172:175], v[172:175], v[104:107]
  s_add_u32 m0, s31, 1024
  v_fma_f32 v47, v47, s83, -v34
  v_fma_f32 v48, v48, s83, -v34
  v_mfma_f32_16x16x32_bf16 v[108:111], a[176:179], v[172:175], v[108:111]
  s_waitcnt lgkmcnt(3)
  buffer_load_dwordx4 v11, s[8:11], s30 offen lds
  v_fma_f32 v49, v49, s83, -v34
  v_mfma_f32_16x16x32_bf16 v[112:115], a[168:171], v[176:179], v[112:115]
  ds_read_b128 v[160:163], v15 offset:32768
  v_fma_f32 v50, v50, s83, -v34
  v_mfma_f32_16x16x32_bf16 v[116:119], a[172:175], v[176:179], v[116:119]
  v_fma_f32 v51, v51, s83, -v34
  v_fma_f32 v52, v52, s83, -v34
  v_mfma_f32_16x16x32_bf16 v[120:123], a[176:179], v[176:179], v[120:123]
  s_waitcnt lgkmcnt(3)
  v_fma_f32 v53, v53, s83, -v34
  v_fma_f32 v54, v54, s83, -v34
  v_mfma_f32_16x16x32_bf16 v[124:127], a[168:171], v[180:183], v[124:127]
  ds_read_b128 v[164:167], v15 offset:34816
  v_fma_f32 v55, v55, s83, -v34
  v_mfma_f32_16x16x32_bf16 v[128:131], a[172:175], v[180:183], v[128:131]
  v_exp_f32 v44, v44
  v_mfma_f32_16x16x32_bf16 v[132:135], a[176:179], v[180:183], v[132:135]
  s_waitcnt lgkmcnt(3)
  v_exp_f32 v45, v45
  v_mfma_f32_16x16x32_bf16 v[136:139], a[168:171], v[184:187], v[136:139]
  ds_read_b128 v[168:171], v15 offset:36864
  v_mfma_f32_16x16x32_bf16 v[140:143], a[172:175], v[184:187], v[140:143]
  s_add_u32 m0, s31, 2048
  v_exp_f32 v46, v46
  v_mfma_f32_16x16x32_bf16 v[144:147], a[176:179], v[184:187], v[144:147]
  s_waitcnt lgkmcnt(3)
  buffer_load_dwordx4 v12, s[8:11], s30 offen lds
  v_mfma_f32_16x16x32_bf16 v[148:151], a[168:171], v[188:191], v[148:151]
  ds_read_b128 v[172:175], v15 offset:38912
  v_mfma_f32_16x16x32_bf16 v[152:155], a[172:175], v[188:191], v[152:155]
  v_exp_f32 v47, v47
  v_mfma_f32_16x16x32_bf16 v[156:159], a[176:179], v[188:191], v[156:159]
  s_waitcnt lgkmcnt(3)
  v_exp_f32 v48, v48
  v_mfma_f32_16x16x32_bf16 v[64:67], a[180:183], v[160:163], v[64:67]
  ds_read_b128 v[176:179], v15 offset:40960
  v_mfma_f32_16x16x32_bf16 v[68:71], a[184:187], v[160:163], v[68:71]
  v_exp_f32 v49, v49
  v_mfma_f32_16x16x32_bf16 v[72:75], a[188:191], v[160:163], v[72:75]
  s_waitcnt lgkmcnt(3)
  v_exp_f32 v50, v50
  v_mfma_f32_16x16x32_bf16 v[76:79], a[180:183], v[164:167], v[76:79]
  ds_read_b128 v[180:183], v15 offset:43008
  v_mfma_f32_16x16x32_bf16 v[80:83], a[184:187], v[164:167], v[80:83]
  s_add_u32 m0, s31, 3072
  v_exp_f32 v51, v51
  v_mfma_f32_16x16x32_bf16 v[84:87], a[188:191], v[164:167], v[84:87]
  s_waitcnt lgkmcnt(3)
  buffer_load_dwordx4 v13, s[8:11], s30 offen lds
  v_mfma_f32_16x16x32_bf16 v[88:91], a[180:183], v[168:171], v[88:91]
  s_add_u32 s30, s30, 128
  ds_read_b128 v[184:187], v15 offset:45056
  v_mfma_f32_16x16x32_bf16 v[92:95], a[184:187], v[168:171], v[92:95]
  v_exp_f32 v52, v52
  v_mfma_f32_16x16x32_bf16 v[96:99], a[188:191], v[168:171], v[96:99]
  s_waitcnt lgkmcnt(3)
  v_exp_f32 v53, v53
  v_mfma_f32_16x16x32_bf16 v[100:103], a[180:183], v[172:175], v[100:103]
  ds_read_b128 v[188:191], v15 offset:47104
  v_mfma_f32_16x16x32_bf16 v[104:107], a[184:187], v[172:175], v[104:107]
  v_exp_f32 v54, v54
  v_mfma_f32_16x16x32_bf16 v[108:111], a[188:191], v[172:175], v[108:111]
  s_waitcnt lgkmcnt(3)
  v_exp_f32 v55, v55
  v_mfma_f32_16x16x32_bf16 v[112:115], a[180:183], v[176:179], v[112:115]
  s_waitcnt vmcnt(8)
  s_barrier
  ds_read_b128 v[160:163], v14 offset:49152
  v_mfma_f32_16x16x32_bf16 v[116:119], a[184:187], v[176:179], v[116:119]
  v_add_f32 v34, v52, v53
  v_add_f32 v34, v34, v54
  v_mfma_f32_16x16x32_bf16 v[120:123], a[188:191], v[176:179], v[120:123]
  s_waitcnt lgkmcnt(3)
  v_add_f32 v34, v34, v55
  v_cndmask_b32 v34, 0, v34, s[62:63]
  v_mfma_f32_16x16x32_bf16 v[124:127], a[180:183], v[180:183], v[124:127]
  ds_read_b128 v[164:167], v14 offset:51200
  v_add_f32 v34, v34, v44
  v_mfma_f32_16x16x32_bf16 v[128:131], a[184:187], v[180:183], v[128:131]
  v_add_f32 v34, v34, v45
  v_add_f32 v34, v34, v46
  v_mfma_f32_16x16x32_bf16 v[132:135], a[188:191], v[180:183], v[132:135]
  s_waitcnt lgkmcnt(3)
  v_add_f32 v34, v34, v47
  v_add_f32 v34, v34, v48
  v_mfma_f32_16x16x32_bf16 v[136:139], a[180:183], v[184:187], v[136:139]
  ds_read_b128 v[168:171], v14 offset:53248
  v_add_f32 v34, v34, v49
  v_mfma_f32_16x16x32_bf16 v[140:143], a[184:187], v[184:187], v[140:143]
  v_add_f32 v34, v34, v50
  v_add_f32 v34, v34, v51
  v_mfma_f32_16x16x32_bf16 v[144:147], a[188:191], v[184:187], v[144:147]
  s_waitcnt lgkmcnt(3)
  v_mov_b32 v35, v34
  v_mfma_f32_16x16x32_bf16 v[148:151], a[180:183], v[188:191], v[148:151]
  ds_read_b128 v[172:175], v14 offset:55296
  v_permlane32_swap_b32 v34, v35
  v_mfma_f32_16x16x32_bf16 v[152:155], a[184:187], v[188:191], v[152:155]
  v_add_f32 v34, v34, v35
  v_mov_b32 v35, v34
  v_mfma_f32_16x16x32_bf16 v[156:159], a[188:191], v[188:191], v[156:159]
  s_waitcnt lgkmcnt(3)
  v_permlane16_swap_b32 v34, v35
  v_add_f32 v34, v34, v35
  v_mfma_f32_16x16x32_bf16 v[64:67], a[192:195], v[160:163], v[64:67]
  ds_read_b128 v[176:179], v14 offset:57344
  v_mfma_f32_16x16x32_bf16 v[68:71], a[196:199], v[160:163], v[68:71]
  s_add_u32 m0, s31, 16384
  v_rcp_f32 v34, v34
  v_mfma_f32_16x16x32_bf16 v[72:75], a[200:203], v[160:163], v[72:75]
  s_waitcnt lgkmcnt(3)
  buffer_load_dwordx4 v10, s[8:11], s30 offen lds
  v_mul_f32 v44, v44, v34
  v_mfma_f32_16x16x32_bf16 v[76:79], a[192:195], v[164:167], v[76:79]
  ds_read_b128 v[180:183], v14 offset:59392
  v_mul_f32 v45, v45, v34
  v_mfma_f32_16x16x32_bf16 v[80:83], a[196:199], v[164:167], v[80:83]
  v_mul_f32 v46, v46, v34
  v_mul_f32 v47, v47, v34
  v_mfma_f32_16x16x32_bf16 v[84:87], a[200:203], v[164:167], v[84:87]
  s_waitcnt lgkmcnt(3)
  v_mul_f32 v48, v48, v34
  v_mul_f32 v49, v49, v34
  v_mfma_f32_16x16x32_bf16 v[88:91], a[192:195], v[168:171], v[88:91]
  ds_read_b128 v[184:187], v14 offset:61440
  v_mul_f32 v50, v50, v34
  v_mfma_f32_16x16x32_bf16 v[92:95], a[196:199], v[168:171], v[92:95]
  v_mul_f32 v51, v51, v34
  v_mul_f32 v52, v52, v34
  v_mfma_f32_16x16x32_bf16 v[96:99], a[200:203], v[168:171], v[96:99]
  s_waitcnt lgkmcnt(3)
  v_mul_f32 v53, v53, v34
  v_mul_f32 v54, v54, v34
  v_mfma_f32_16x16x32_bf16 v[100:103], a[192:195], v[172:175], v[100:103]
  ds_read_b128 v[188:191], v14 offset:63488
  v_mul_f32 v55, v55, v34
  v_mfma_f32_16x16x32_bf16 v[104:107], a[196:199], v[172:175], v[104:107]
  s_add_u32 m0, s31, 17408
  v_cvt_pk_bf16_f32 v56, v44, v45
  v_cvt_pk_bf16_f32 v57, v46, v47
  v_mfma_f32_16x16x32_bf16 v[108:111], a[200:203], v[172:175], v[108:111]
  s_waitcnt lgkmcnt(3)
  buffer_load_dwordx4 v11, s[8:11], s30 offen lds
  v_cvt_pk_bf16_f32 v58, v48, v49
  v_mfma_f32_16x16x32_bf16 v[112:115], a[192:195], v[176:179], v[112:115]
  ds_read_b128 v[160:163], v15 offset:49152
  v_cvt_pk_bf16_f32 v59, v50, v51
  v_mfma_f32_16x16x32_bf16 v[116:119], a[196:199], v[176:179], v[116:119]
  v_cvt_pk_bf16_f32 v60, v40, v41
  v_cvt_pk_bf16_f32 v61, v42, v43
  v_mfma_f32_16x16x32_bf16 v[120:123], a[200:203], v[176:179], v[120:123]
  s_waitcnt lgkmcnt(3)
  v_cvt_pk_bf16_f32 v62, v52, v53
  v_cvt_pk_bf16_f32 v63, v54, v55
  v_mfma_f32_16x16x32_bf16 v[124:127], a[192:195], v[180:183], v[124:127]
  ds_read_b128 v[164:167], v15 offset:51200
  v_cvt_pk_bf16_f32 v248, v36, v37
  v_mfma_f32_16x16x32_bf16 v[128:131], a[196:199], v[180:183], v[128:131]
  v_cvt_pk_bf16_f32 v249, v38, v39
  buffer_store_dwordx4 v[56:59], v26, s[16:19], s81 offen sc1
  v_mfma_f32_16x16x32_bf16 v[132:135], a[200:203], v[180:183], v[132:135]
  s_waitcnt lgkmcnt(3)
  v_mfma_f32_16x16x32_bf16 v[136:139], a[192:195], v[184:187], v[136:139]
  ds_read_b128 v[168:171], v15 offset:53248
  v_mfma_f32_16x16x32_bf16 v[140:143], a[196:199], v[184:187], v[140:143]
  s_add_u32 m0, s31, 18432
  v_mfma_f32_16x16x32_bf16 v[144:147], a[200:203], v[184:187], v[144:147]
  s_waitcnt lgkmcnt(3)
  buffer_load_dwordx4 v12, s[8:11], s30 offen lds
  v_mfma_f32_16x16x32_bf16 v[148:151], a[192:195], v[188:191], v[148:151]
  ds_read_b128 v[172:175], v15 offset:55296
  v_mfma_f32_16x16x32_bf16 v[152:155], a[196:199], v[188:191], v[152:155]
  v_mfma_f32_16x16x32_bf16 v[156:159], a[200:203], v[188:191], v[156:159]
  s_waitcnt lgkmcnt(3)
  buffer_store_dwordx4 v[60:63], v26, s[16:19], s81 offen offset:1024 sc1
  v_mfma_f32_16x16x32_bf16 v[64:67], a[204:207], v[160:163], v[64:67]
  ds_read_b128 v[176:179], v15 offset:57344
  v_mfma_f32_16x16x32_bf16 v[68:71], a[208:211], v[160:163], v[68:71]
  v_mfma_f32_16x16x32_bf16 v[72:75], a[212:215], v[160:163], v[72:75]
  s_waitcnt lgkmcnt(3)
  buffer_store_dwordx2 v[248:249], v29, s[16:19], s81 offen offset:2048 sc1
  v_mfma_f32_16x16x32_bf16 v[76:79], a[204:207], v[164:167], v[76:79]
  ds_read_b128 v[180:183], v15 offset:59392
  s_mov_b32 s84, s82
  v_mfma_f32_16x16x32_bf16 v[80:83], a[208:211], v[164:167], v[80:83]
  s_mov_b32 s25, 162688
  s_add_u32 m0, s31, 19456
  v_mfma_f32_16x16x32_bf16 v[84:87], a[212:215], v[164:167], v[84:87]
  s_waitcnt lgkmcnt(3)
  buffer_load_dwordx4 v13, s[8:11], s30 offen lds
  v_mfma_f32_16x16x32_bf16 v[88:91], a[204:207], v[168:171], v[88:91]
  s_add_u32 s30, s30, 128
  ds_read_b128 v[184:187], v15 offset:61440
  v_mfma_f32_16x16x32_bf16 v[92:95], a[208:211], v[168:171], v[92:95]
  s_cmp_gt_u32 s26, s85
  s_cselect_b32 s21, 0, s26
  v_mfma_f32_16x16x32_bf16 v[96:99], a[212:215], v[168:171], v[96:99]
  s_waitcnt lgkmcnt(3)
  v_mfma_f32_16x16x32_bf16 v[100:103], a[204:207], v[172:175], v[100:103]
  ds_read_b128 v[188:191], v15 offset:63488
  v_mfma_f32_16x16x32_bf16 v[104:107], a[208:211], v[172:175], v[104:107]
  s_cmp_le_u32 s21, 2
  s_cbranch_scc1 qa2_227
  s_mov_b32 s49, s43
  s_mov_b32 s50, s45
  s_mov_b32 s81, s47
  s_mov_b32 s82, s48
  s_add_u32 s43, s43, 4
  s_add_u32 s45, s45, 8388608
  s_add_u32 s47, s47, 2097152
  s_xor_b32 s47, s47, 8192
  s_add_u32 s48, s48, 512
qa3_228:
  v_mfma_f32_16x16x32_bf16 v[108:111], a[212:215], v[172:175], v[108:111]
  s_waitcnt lgkmcnt(3)
  v_mfma_f32_16x16x32_bf16 v[112:115], a[204:207], v[176:179], v[112:115]
  s_waitcnt vmcnt(11)
  s_barrier
  ds_read_b128 v[160:163], v16 offset:0
  v_mfma_f32_16x16x32_bf16 v[116:119], a[208:211], v[176:179], v[116:119]
  buffer_load_dword v32, v30, s[72:75], s77 offen sc1
  v_mfma_f32_16x16x32_bf16 v[120:123], a[212:215], v[176:179], v[120:123]
  s_waitcnt lgkmcnt(3)
  v_mfma_f32_16x16x32_bf16 v[124:127], a[204:207], v[180:183], v[124:127]
  ds_read_b128 v[164:167], v16 offset:2048
  v_mfma_f32_16x16x32_bf16 v[128:131], a[208:211], v[180:183], v[128:131]
  v_mfma_f32_16x16x32_bf16 v[132:135], a[212:215], v[180:183], v[132:135]
  s_waitcnt lgkmcnt(3)
  v_mfma_f32_16x16x32_bf16 v[136:139], a[204:207], v[184:187], v[136:139]
  ds_read_b128 v[168:171], v16 offset:4096
  v_mfma_f32_16x16x32_bf16 v[140:143], a[208:211], v[184:187], v[140:143]
  v_mfma_f32_16x16x32_bf16 v[144:147], a[212:215], v[184:187], v[144:147]
  s_waitcnt lgkmcnt(3)
  v_mfma_f32_16x16x32_bf16 v[148:151], a[204:207], v[188:191], v[148:151]
  ds_read_b128 v[172:175], v16 offset:6144
  v_mfma_f32_16x16x32_bf16 v[152:155], a[208:211], v[188:191], v[152:155]
  v_mfma_f32_16x16x32_bf16 v[156:159], a[212:215], v[188:191], v[156:159]
  s_waitcnt lgkmcnt(3)
  v_mfma_f32_16x16x32_bf16 v[64:67], a[216:219], v[160:163], v[64:67]
  ds_read_b128 v[176:179], v16 offset:8192
  v_mfma_f32_16x16x32_bf16 v[68:71], a[220:223], v[160:163], v[68:71]
  s_add_u32 m0, s31, 32768
  v_mfma_f32_16x16x32_bf16 v[72:75], a[224:227], v[160:163], v[72:75]
  s_waitcnt lgkmcnt(3)
  buffer_load_dwordx4 v10, s[8:11], s30 offen lds
  v_mfma_f32_16x16x32_bf16 v[76:79], a[216:219], v[164:167], v[76:79]
  ds_read_b128 v[180:183], v16 offset:10240
  v_mfma_f32_16x16x32_bf16 v[80:83], a[220:223], v[164:167], v[80:83]
  v_mfma_f32_16x16x32_bf16 v[84:87], a[224:227], v[164:167], v[84:87]
  s_waitcnt lgkmcnt(3)
  v_mfma_f32_16x16x32_bf16 v[88:91], a[216:219], v[168:171], v[88:91]
  ds_read_b128 v[184:187], v16 offset:12288
  v_mfma_f32_16x16x32_bf16 v[92:95], a[220:223], v[168:171], v[92:95]
  s_add_u32 m0, s31, 33792
  v_mfma_f32_16x16x32_bf16 v[96:99], a[224:227], v[168:171], v[96:99]
  s_waitcnt lgkmcnt(3)
  buffer_load_dwordx4 v11, s[8:11], s30 offen lds
  v_mfma_f32_16x16x32_bf16 v[100:103], a[216:219], v[172:175], v[100:103]
  ds_read_b128 v[188:191], v16 offset:14336
  v_mfma_f32_16x16x32_bf16 v[104:107], a[220:223], v[172:175], v[104:107]
  v_mfma_f32_16x16x32_bf16 v[108:111], a[224:227], v[172:175], v[108:111]
  s_waitcnt lgkmcnt(3)
  v_mfma_f32_16x16x32_bf16 v[112:115], a[216:219], v[176:179], v[112:115]
  ds_read_b128 v[160:163], v17 offset:0
  v_mfma_f32_16x16x32_bf16 v[116:119], a[220:223], v[176:179], v[116:119]
  s_add_u32 m0, s31, 34816
  v_mfma_f32_16x16x32_bf16 v[120:123], a[224:227], v[176:179], v[120:123]
  s_waitcnt lgkmcnt(3)
  buffer_load_dwordx4 v12, s[8:11], s30 offen lds
  v_mfma_f32_16x16x32_bf16 v[124:127], a[216:219], v[180:183], v[124:127]
  ds_read_b128 v[164:167], v17 offset:2048
  v_mfma_f32_16x16x32_bf16 v[128:131], a[220:223], v[180:183], v[128:131]
  v_mfma_f32_16x16x32_bf16 v[132:135], a[224:227], v[180:183], v[132:135]
  s_waitcnt lgkmcnt(3)
  v_mfma_f32_16x16x32_bf16 v[136:139], a[216:219], v[184:187], v[136:139]
  ds_read_b128 v[168:171], v17 offset:4096
  v_mfma_f32_16x16x32_bf16 v[140:143], a[220:223], v[184:187], v[140:143]
  s_add_u32 m0, s31, 35840
  v_mfma_f32_16x16x32_bf16 v[144:147], a[224:227], v[184:187], v[144:147]
  s_waitcnt lgkmcnt(3)
  buffer_load_dwordx4 v13, s[8:11], s30 offen lds
  v_mfma_f32_16x16x32_bf16 v[148:151], a[216:219], v[188:191], v[148:151]
  s_add_u32 s30, s30, 128
  ds_read_b128 v[172:175], v17 offset:6144
  v_mfma_f32_16x16x32_bf16 v[152:155], a[220:223], v[188:191], v[152:155]
  v_mfma_f32_16x16x32_bf16 v[156:159], a[224:227], v[188:191], v[156:159]
  s_waitcnt lgkmcnt(3)
  v_mfma_f32_16x16x32_bf16 v[64:67], a[228:231], v[160:163], v[64:67]
  ds_read_b128 v[176:179], v17 offset:8192
  v_mfma_f32_16x16x32_bf16 v[68:71], a[232:235], v[160:163], v[68:71]
  v_mfma_f32_16x16x32_bf16 v[72:75], a[236:239], v[160:163], v[72:75]
  s_waitcnt lgkmcnt(3)
  v_mfma_f32_16x16x32_bf16 v[76:79], a[228:231], v[164:167], v[76:79]
  ds_read_b128 v[180:183], v17 offset:10240
  v_cvt_pk_bf16_f32 v192, v64, v65
  v_mfma_f32_16x16x32_bf16 v[80:83], a[232:235], v[164:167], v[80:83]
  v_cvt_pk_bf16_f32 v193, v66, v67
  v_cvt_pk_bf16_f32 v194, v68, v69
  v_mfma_f32_16x16x32_bf16 v[84:87], a[236:239], v[164:167], v[84:87]
  s_waitcnt lgkmcnt(3)
  v_cvt_pk_bf16_f32 v195, v70, v71
  v_cvt_pk_bf16_f32 v200, v72, v73
  v_mfma_f32_16x16x32_bf16 v[88:91], a[228:231], v[168:171], v[88:91]
  ds_read_b128 v[184:187], v17 offset:12288
  v_cvt_pk_bf16_f32 v201, v74, v75
  v_mfma_f32_16x16x32_bf16 v[92:95], a[232:235], v[168:171], v[92:95]
  v_cvt_pk_bf16_f32 v196, v76, v77
  v_cvt_pk_bf16_f32 v197, v78, v79
  v_mfma_f32_16x16x32_bf16 v[96:99], a[236:239], v[168:171], v[96:99]
  s_waitcnt lgkmcnt(3)
  v_cvt_pk_bf16_f32 v198, v80, v81
  v_cvt_pk_bf16_f32 v199, v82, v83
  v_mfma_f32_16x16x32_bf16 v[100:103], a[228:231], v[172:175], v[100:103]
  ds_read_b128 v[188:191], v17 offset:14336
  v_cvt_pk_bf16_f32 v202, v84, v85
  v_mfma_f32_16x16x32_bf16 v[104:107], a[232:235], v[172:175], v[104:107]
  v_cvt_pk_bf16_f32 v203, v86, v87
  v_cvt_pk_bf16_f32 v204, v88, v89
  v_mfma_f32_16x16x32_bf16 v[108:111], a[236:239], v[172:175], v[108:111]
  s_waitcnt lgkmcnt(3)
  v_cvt_pk_bf16_f32 v205, v90, v91
  v_cvt_pk_bf16_f32 v206, v92, v93
  v_mfma_f32_16x16x32_bf16 v[112:115], a[228:231], v[176:179], v[112:115]
  s_waitcnt vmcnt(12)
  s_barrier
  ds_read_b128 v[160:163], v14 offset:0
  v_mfma_f32_16x16x32_bf16 v[116:119], a[232:235], v[176:179], v[116:119]
  v_cvt_pk_bf16_f32 v207, v94, v95
  v_cvt_pk_bf16_f32 v212, v96, v97
  v_mfma_f32_16x16x32_bf16 v[120:123], a[236:239], v[176:179], v[120:123]
  s_waitcnt lgkmcnt(3)
  v_cvt_pk_bf16_f32 v213, v98, v99
  v_cvt_pk_bf16_f32 v208, v100, v101
  v_mfma_f32_16x16x32_bf16 v[124:127], a[228:231], v[180:183], v[124:127]
  ds_read_b128 v[164:167], v14 offset:2048
  v_cvt_pk_bf16_f32 v209, v102, v103
  v_mfma_f32_16x16x32_bf16 v[128:131], a[232:235], v[180:183], v[128:131]
  v_cvt_pk_bf16_f32 v210, v104, v105
  v_cvt_pk_bf16_f32 v211, v106, v107
  v_mfma_f32_16x16x32_bf16 v[132:135], a[236:239], v[180:183], v[132:135]
  s_waitcnt lgkmcnt(3)
  v_cvt_pk_bf16_f32 v214, v108, v109
  v_cvt_pk_bf16_f32 v215, v110, v111
  v_mfma_f32_16x16x32_bf16 v[136:139], a[228:231], v[184:187], v[136:139]
  ds_read_b128 v[168:171], v14 offset:4096
  v_cvt_pk_bf16_f32 v216, v112, v113
  v_mfma_f32_16x16x32_bf16 v[140:143], a[232:235], v[184:187], v[140:143]
  v_cvt_pk_bf16_f32 v217, v114, v115
  v_cvt_pk_bf16_f32 v218, v116, v117
  v_mfma_f32_16x16x32_bf16 v[144:147], a[236:239], v[184:187], v[144:147]
  s_waitcnt lgkmcnt(3)
  v_cvt_pk_bf16_f32 v219, v118, v119
  v_cvt_pk_bf16_f32 v224, v120, v121
  v_mfma_f32_16x16x32_bf16 v[148:151], a[228:231], v[188:191], v[148:151]
  ds_read_b128 v[172:175], v14 offset:6144
  v_cvt_pk_bf16_f32 v225, v122, v123
  v_mfma_f32_16x16x32_bf16 v[152:155], a[232:235], v[188:191], v[152:155]
  s_sub_u32 s26, s26, 1
  s_cmp_gt_u32 s26, 0
  v_cvt_pk_bf16_f32 v220, v124, v125
  v_mfma_f32_16x16x32_bf16 v[156:159], a[236:239], v[188:191], v[156:159]
  s_waitcnt lgkmcnt(3)
  s_cbranch_scc1 qa_231
  s_nop 7
  v_cvt_pk_bf16_f32 v221, v126, v127
  v_cvt_pk_bf16_f32 v222, v128, v129
  v_cvt_pk_bf16_f32 v223, v130, v131
  v_cvt_pk_bf16_f32 v226, v132, v133
  v_cvt_pk_bf16_f32 v227, v134, v135
  v_cvt_pk_bf16_f32 v228, v136, v137
  v_cvt_pk_bf16_f32 v229, v138, v139
  v_cvt_pk_bf16_f32 v230, v140, v141
  v_cvt_pk_bf16_f32 v231, v142, v143
  v_cvt_pk_bf16_f32 v236, v144, v145
  v_cvt_pk_bf16_f32 v237, v146, v147
  v_cvt_pk_bf16_f32 v232, v148, v149
  v_cvt_pk_bf16_f32 v233, v150, v151
  v_cvt_pk_bf16_f32 v234, v152, v153
  v_cvt_pk_bf16_f32 v235, v154, v155
  v_cvt_pk_bf16_f32 v238, v156, v157
  v_cvt_pk_bf16_f32 v239, v158, v159
  s_waitcnt lgkmcnt(0)
  s_mov_b32 s49, s43
  s_mov_b32 s50, s45
  s_mov_b32 s81, s47
  s_mov_b32 s82, s48
  s_add_u32 s43, s43, 4
  s_add_u32 s45, s45, 8388608
  s_add_u32 s47, s47, 2097152
  s_xor_b32 s47, s47, 8192
  s_add_u32 s48, s48, 512
  ds_read_b128 v[64:67], v21 offset:0
  ds_read_b128 v[68:71], v21 offset:1024
  ds_read_b128 v[72:75], v21 offset:3072
  ds_read_b128 v[76:79], v21 offset:4096
  ds_read2st64_b64 v[80:83], v22 offset0:0 offset1:6
  ds_read2st64_b64 v[84:87], v23 offset0:0 offset1:6
  ds_read_b128 v[88:91], v21 offset:6144
  ds_read_b128 v[92:95], v21 offset:7168
  ds_read_b128 v[96:99], v21 offset:9216
  ds_read_b128 v[100:103], v21 offset:10240
  ds_read2st64_b64 v[104:107], v22 offset0:12 offset1:18
  ds_read2st64_b64 v[108:111], v23 offset0:12 offset1:18
  s_waitcnt lgkmcnt(0)
  s_barrier
  ds_write_b128 v20, v[192:195] offset:0
  ds_write_b128 v20, v[196:199] offset:1024
  ds_write_b128 v20, v[200:203] offset:2048
  ds_write_b128 v20, v[204:207] offset:12288
  ds_write_b128 v20, v[208:211] offset:13312
  ds_write_b128 v20, v[212:215] offset:14336
  ds_write_b128 v20, v[216:219] offset:24576
  ds_write_b128 v20, v[220:223] offset:25600
  ds_write_b128 v20, v[224:227] offset:26624
  ds_write_b128 v20, v[228:231] offset:36864
  ds_write_b128 v20, v[232:235] offset:37888
  ds_write_b128 v20, v[236:239] offset:38912
  s_waitcnt lgkmcnt(0)
  s_barrier
  s_cmp_gt_u32 s49, 56
  s_cselect_b32 s23, 54, s49
  s_mov_b32 s101, 0
wm_234:
  buffer_load_dword v34, v30, s[72:75], s77 offen sc1
  s_add_u32 s101, s101, 1
  s_cmp_gt_u32 s101, 131072
  s_cbranch_scc1 main_end
  s_waitcnt vmcnt(0)
  v_cmp_gt_u32 vcc, s23, v34
  v_readfirstlane_b32 s100, v34
  s_nop 0
  s_cbranch_vccz wm_235
  s_sleep 4
  s_add_u32 s100, s100, 2
  s_cmp_ge_u32 s100, s23
  s_cbranch_scc1 wm_234
  s_sleep 40
  s_branch wm_234
wm_235:
  s_add_u32 s29, s50, 0
  buffer_load_dwordx4 v[112:115], v26, s[16:19], s29 offen offset:0 sc1
  buffer_load_dwordx4 v[116:119], v26, s[16:19], s29 offen offset:1024 sc1
  buffer_load_dwordx4 v[144:147], v26, s[16:19], s29 offen offset:2048 sc1
  s_add_u32 s29, s50, 16384
  buffer_load_dwordx4 v[120:123], v26, s[16:19], s29 offen offset:0 sc1
  buffer_load_dwordx4 v[124:127], v26, s[16:19], s29 offen offset:1024 sc1
  buffer_load_dwordx4 v[148:151], v26, s[16:19], s29 offen offset:2048 sc1
  s_add_u32 s29, s50, 32768
  buffer_load_dwordx4 v[128:131], v26, s[16:19], s29 offen offset:0 sc1
  buffer_load_dwordx4 v[132:135], v26, s[16:19], s29 offen offset:1024 sc1
  buffer_load_dwordx4 v[152:155], v26, s[16:19], s29 offen offset:2048 sc1
  s_add_u32 s29, s50, 49152
  buffer_load_dwordx4 v[136:139], v26, s[16:19], s29 offen offset:0 sc1
  buffer_load_dwordx4 v[140:143], v26, s[16:19], s29 offen offset:1024 sc1
  buffer_load_dwordx4 v[156:159], v26, s[16:19], s29 offen offset:2048 sc1
  s_waitcnt vmcnt(0) lgkmcnt(0)
  v_swap_b32 v146, v148
  v_swap_b32 v147, v149
  v_swap_b32 v154, v156
  v_swap_b32 v155, v157
  s_nop 1
  v_mfma_f32_16x16x32_bf16 v[36:39], v[112:115], v[64:67], 0
  v_mfma_f32_16x16x32_bf16 v[44:47], v[112:115], v[68:71], 0
  v_mfma_f32_16x16x32_bf16 v[48:51], v[116:119], v[68:71], 0
  v_mfma_f32_16x16x32_bf16 v[36:39], v[120:123], v[72:75], v[36:39]
  v_mfma_f32_16x16x32_bf16 v[44:47], v[120:123], v[76:79], v[44:47]
  v_mfma_f32_16x16x32_bf16 v[48:51], v[124:127], v[76:79], v[48:51]
  v_mfma_f32_16x16x32_bf16 v[36:39], v[144:147], v[80:83], v[36:39]
  v_mfma_f32_16x16x32_bf16 v[44:47], v[144:147], v[84:87], v[44:47]
  v_mfma_f32_16x16x32_bf16 v[48:51], v[148:151], v[84:87], v[48:51]
  v_mfma_f32_16x16x32_bf16 v[36:39], v[128:131], v[88:91], v[36:39]
  v_mfma_f32_16x16x32_bf16 v[44:47], v[128:131], v[92:95], v[44:47]
  v_mfma_f32_16x16x32_bf16 v[48:51], v[132:135], v[92:95], v[48:51]
  v_mfma_f32_16x16x32_bf16 v[36:39], v[136:139], v[96:99], v[36:39]
  v_mfma_f32_16x16x32_bf16 v[44:47], v[136:139], v[100:103], v[44:47]
  v_mfma_f32_16x16x32_bf16 v[48:51], v[140:143], v[100:103], v[48:51]
  v_mfma_f32_16x16x32_bf16 v[36:39], v[152:155], v[104:107], v[36:39]
  v_mfma_f32_16x16x32_bf16 v[44:47], v[152:155], v[108:111], v[44:47]
  v_mfma_f32_16x16x32_bf16 v[48:51], v[156:159], v[108:111], v[48:51]
  s_cmp_le_u32 s49, 56
  s_cbranch_scc1 qtp_238
  s_sub_u32 s23, s49, 1
  s_min_u32 s23, s23, 62
  s_mov_b32 s101, 0
wm_239:
  buffer_load_dword v34, v30, s[72:75], s77 offen sc1
  s_add_u32 s101, s101, 1
  s_cmp_gt_u32 s101, 131072
  s_cbranch_scc1 main_end
  s_waitcnt vmcnt(0)
  v_cmp_gt_u32 vcc, s23, v34
  v_readfirstlane_b32 s100, v34
  s_nop 0
  s_cbranch_vccz wm_240
  s_sleep 4
  s_add_u32 s100, s100, 2
  s_cmp_ge_u32 s100, s23
  s_cbranch_scc1 wm_239
  s_sleep 40
  s_branch wm_239
wm_240:
qtp_238:
  s_mov_b32 s101, 0
  s_branch qtp_237
qtp_236:
  s_sleep 2
qtp_237:
  s_add_u32 s29, s50, 4096
  buffer_load_dwordx4 v[160:163], v24, s[16:19], s29 offen offset:2560 sc1
  buffer_load_dwordx2 v[240:241], v25, s[16:19], s29 offen offset:3072 sc1
  s_add_u32 s29, s50, 20480
  buffer_load_dwordx4 v[164:167], v24, s[16:19], s29 offen offset:2560 sc1
  buffer_load_dwordx2 v[242:243], v25, s[16:19], s29 offen offset:3072 sc1
  s_add_u32 s29, s50, 36864
  buffer_load_dwordx4 v[168:171], v24, s[16:19], s29 offen offset:2560 sc1
  buffer_load_dwordx2 v[244:245], v25, s[16:19], s29 offen offset:3072 sc1
  s_add_u32 s29, s50, 53248
  buffer_load_dwordx4 v[172:175], v24, s[16:19], s29 offen offset:2560 sc1
  buffer_load_dwordx2 v[246:247], v25, s[16:19], s29 offen offset:3072 sc1
  s_add_u32 s101, s101, 1
  s_cmp_gt_u32 s101, 131072
  s_cbranch_scc1 main_end
  s_waitcnt vmcnt(0)
  v_max3_u32 v34, v160, v164, v168
  v_max3_u32 v34, v34, v172, v240
  v_max3_u32 v34, v34, v242, v244
  v_max_u32 v34, v34, v246
  v_cmp_eq_u32 vcc, -1, v34
  s_nop 1
  s_cbranch_vccnz qtp_236
  v_mfma_f32_16x16x32_bf16 v[40:43], v[160:163], v[64:67], 0
  v_mfma_f32_16x16x32_bf16 v[52:55], v[160:163], v[68:71], 0
  v_mfma_f32_16x16x32_bf16 v[40:43], v[164:167], v[72:75], v[40:43]
  v_mfma_f32_16x16x32_bf16 v[52:55], v[164:167], v[76:79], v[52:55]
  v_mfma_f32_16x16x32_bf16 v[40:43], v[240:243], v[80:83], v[40:43]
  v_mfma_f32_16x16x32_bf16 v[52:55], v[240:243], v[84:87], v[52:55]
  v_mfma_f32_16x16x32_bf16 v[40:43], v[168:171], v[88:91], v[40:43]
  v_mfma_f32_16x16x32_bf16 v[52:55], v[168:171], v[92:95], v[52:55]
  v_mfma_f32_16x16x32_bf16 v[40:43], v[172:175], v[96:99], v[40:43]
  v_mfma_f32_16x16x32_bf16 v[52:55], v[172:175], v[100:103], v[52:55]
  v_mfma_f32_16x16x32_bf16 v[40:43], v[244:247], v[104:107], v[40:43]
  v_mfma_f32_16x16x32_bf16 v[52:55], v[244:247], v[108:111], v[52:55]
  s_nop 4
  v_cndmask_b32 v36, v31, v36, s[64:65]
  v_cndmask_b32 v48, v31, v48, s[64:65]
  v_cndmask_b32 v37, v31, v37, s[66:67]
  v_cndmask_b32 v49, v31, v49, s[66:67]
  v_cndmask_b32 v38, v31, v38, s[68:69]
  v_cndmask_b32 v50, v31, v50, s[68:69]
  v_cndmask_b32 v39, v31, v39, s[70:71]
  v_cndmask_b32 v51, v31, v51, s[70:71]
  v_max3_f32 v34, v36, v37, v38
  v_max3_f32 v34, v34, v39, v40
  v_max3_f32 v34, v34, v41, v42
  v_max_f32 v34, v34, v43
  v_mov_b32 v35, v34
  s_nop 1
  v_permlane32_swap_b32 v34, v35
  v_max_f32 v34, v34, v35
  v_mov_b32 v35, v34
  s_nop 1
  v_permlane16_swap_b32 v34, v35
  v_max_f32 v34, v34, v35
  v_mul_f32 v34, s83, v34
  v_fma_f32 v36, v36, s83, -v34
  v_fma_f32 v37, v37, s83, -v34
  v_fma_f32 v38, v38, s83, -v34
  v_fma_f32 v39, v39, s83, -v34
  v_fma_f32 v40, v40, s83, -v34
  v_fma_f32 v41, v41, s83, -v34
  v_fma_f32 v42, v42, s83, -v34
  v_fma_f32 v43, v43, s83, -v34
  v_exp_f32 v36, v36
  v_exp_f32 v37, v37
  v_exp_f32 v38, v38
  v_exp_f32 v39, v39
  v_exp_f32 v40, v40
  v_exp_f32 v41, v41
  v_exp_f32 v42, v42
  v_exp_f32 v43, v43
  s_nop 0
  v_add_f32 v34, v40, v41
  v_add_f32 v34, v34, v42
  v_add_f32 v34, v34, v43
  v_cndmask_b32 v34, 0, v34, s[62:63]
  v_add_f32 v34, v34, v36
  v_add_f32 v34, v34, v37
  v_add_f32 v34, v34, v38
  v_add_f32 v34, v34, v39
  v_mov_b32 v35, v34
  s_nop 1
  v_permlane32_swap_b32 v34, v35
  v_add_f32 v34, v34, v35
  v_mov_b32 v35, v34
  s_nop 1
  v_permlane16_swap_b32 v34, v35
  v_add_f32 v34, v34, v35
  v_rcp_f32 v34, v34
  s_nop 0
  v_mul_f32 v36, v36, v34
  v_mul_f32 v37, v37, v34
  v_mul_f32 v38, v38, v34
  v_mul_f32 v39, v39, v34
  v_mul_f32 v40, v40, v34
  v_mul_f32 v41, v41, v34
  v_mul_f32 v42, v42, v34
  v_mul_f32 v43, v43, v34
  v_max3_f32 v34, v44, v45, v46
  v_max3_f32 v34, v34, v47, v48
  v_max3_f32 v34, v34, v49, v50
  v_max3_f32 v34, v34, v51, v52
  v_max3_f32 v34, v34, v53, v54
  v_max_f32 v34, v34, v55
  v_mov_b32 v35, v34
  s_nop 1
  v_permlane32_swap_b32 v34, v35
  v_max_f32 v34, v34, v35
  v_mov_b32 v35, v34
  s_nop 1
  v_permlane16_swap_b32 v34, v35
  v_max_f32 v34, v34, v35
  v_mul_f32 v34, s83, v34
  v_fma_f32 v44, v44, s83, -v34
  v_fma_f32 v45, v45, s83, -v34
  v_fma_f32 v46, v46, s83, -v34
  v_fma_f32 v47, v47, s83, -v34
  v_fma_f32 v48, v48, s83, -v34
  v_fma_f32 v49, v49, s83, -v34
  v_fma_f32 v50, v50, s83, -v34
  v_fma_f32 v51, v51, s83, -v34
  v_fma_f32 v52, v52, s83, -v34
  v_fma_f32 v53, v53, s83, -v34
  v_fma_f32 v54, v54, s83, -v34
  v_fma_f32 v55, v55, s83, -v34
  v_exp_f32 v44, v44
  v_exp_f32 v45, v45
  v_exp_f32 v46, v46
  v_exp_f32 v47, v47
  v_exp_f32 v48, v48
  v_exp_f32 v49, v49
  v_exp_f32 v50, v50
  v_exp_f32 v51, v51
  v_exp_f32 v52, v52
  v_exp_f32 v53, v53
  v_exp_f32 v54, v54
  v_exp_f32 v55, v55
  s_nop 0
  v_add_f32 v34, v52, v53
  v_add_f32 v34, v34, v54
  v_add_f32 v34, v34, v55
  v_cndmask_b32 v34, 0, v34, s[62:63]
  v_add_f32 v34, v34, v44
  v_add_f32 v34, v34, v45
  v_add_f32 v34, v34, v46
  v_add_f32 v34, v34, v47
  v_add_f32 v34, v34, v48
  v_add_f32 v34, v34, v49
  v_add_f32 v34, v34, v50
  v_add_f32 v34, v34, v51
  v_mov_b32 v35, v34
  s_nop 1
  v_permlane32_swap_b32 v34, v35
  v_add_f32 v34, v34, v35
  v_mov_b32 v35, v34
  s_nop 1
  v_permlane16_swap_b32 v34, v35
  v_add_f32 v34, v34, v35
  v_rcp_f32 v34, v34
  s_nop 0
  v_mul_f32 v44, v44, v34
  v_mul_f32 v45, v45, v34
  v_mul_f32 v46, v46, v34
  v_mul_f32 v47, v47, v34
  v_mul_f32 v48, v48, v34
  v_mul_f32 v49, v49, v34
  v_mul_f32 v50, v50, v34
  v_mul_f32 v51, v51, v34
  v_mul_f32 v52, v52, v34
  v_mul_f32 v53, v53, v34
  v_mul_f32 v54, v54, v34
  v_mul_f32 v55, v55, v34
  v_cvt_pk_bf16_f32 v56, v44, v45
  v_cvt_pk_bf16_f32 v57, v46, v47
  v_cvt_pk_bf16_f32 v58, v48, v49
  v_cvt_pk_bf16_f32 v59, v50, v51
  v_cvt_pk_bf16_f32 v60, v40, v41
  v_cvt_pk_bf16_f32 v61, v42, v43
  v_cvt_pk_bf16_f32 v62, v52, v53
  v_cvt_pk_bf16_f32 v63, v54, v55
  v_cvt_pk_bf16_f32 v248, v36, v37
  v_cvt_pk_bf16_f32 v249, v38, v39
  buffer_store_dwordx4 v[56:59], v26, s[16:19], s81 offen sc1
  buffer_store_dwordx4 v[60:63], v26, s[16:19], s81 offen offset:1024 sc1
  buffer_store_dwordx2 v[248:249], v29, s[16:19], s81 offen offset:2048 sc1
  s_mov_b32 s84, s82
  s_mov_b32 s49, s43
  s_mov_b32 s50, s45
  s_mov_b32 s81, s47
  s_mov_b32 s82, s48
  s_add_u32 s43, s43, 4
  s_add_u32 s45, s45, 8388608
  s_add_u32 s47, s47, 2097152
  s_xor_b32 s47, s47, 8192
  s_add_u32 s48, s48, 512
  ds_read_b128 v[64:67], v21 offset:0
  ds_read_b128 v[68:71], v21 offset:1024
  ds_read_b128 v[72:75], v21 offset:3072
  ds_read_b128 v[76:79], v21 offset:4096
  ds_read2st64_b64 v[80:83], v22 offset0:0 offset1:6
  ds_read2st64_b64 v[84:87], v23 offset0:0 offset1:6
  ds_read_b128 v[88:91], v21 offset:6144
  ds_read_b128 v[92:95], v21 offset:7168
  ds_read_b128 v[96:99], v21 offset:9216
  ds_read_b128 v[100:103], v21 offset:10240
  ds_read2st64_b64 v[104:107], v22 offset0:12 offset1:18
  ds_read2st64_b64 v[108:111], v23 offset0:12 offset1:18
  s_cmp_gt_u32 s49, 56
  s_cselect_b32 s23, 54, s49
  s_mov_b32 s101, 0
wm_241:
  buffer_load_dword v34, v30, s[72:75], s77 offen sc1
  s_add_u32 s101, s101, 1
  s_cmp_gt_u32 s101, 131072
  s_cbranch_scc1 main_end
  s_waitcnt vmcnt(0)
  v_cmp_gt_u32 vcc, s23, v34
  v_readfirstlane_b32 s100, v34
  s_nop 0
  s_cbranch_vccz wm_242
  s_sleep 4
  s_add_u32 s100, s100, 2
  s_cmp_ge_u32 s100, s23
  s_cbranch_scc1 wm_241
  s_sleep 40
  s_branch wm_241
wm_242:
  s_add_u32 s29, s50, 0
  buffer_load_dwordx4 v[112:115], v26, s[16:19], s29 offen offset:0 sc1
  buffer_load_dwordx4 v[116:119], v26, s[16:19], s29 offen offset:1024 sc1
  buffer_load_dwordx4 v[144:147], v26, s[16:19], s29 offen offset:2048 sc1
  s_add_u32 s29, s50, 16384
  buffer_load_dwordx4 v[120:123], v26, s[16:19], s29 offen offset:0 sc1
  buffer_load_dwordx4 v[124:127], v26, s[16:19], s29 offen offset:1024 sc1
  buffer_load_dwordx4 v[148:151], v26, s[16:19], s29 offen offset:2048 sc1
  s_add_u32 s29, s50, 32768
  buffer_load_dwordx4 v[128:131], v26, s[16:19], s29 offen offset:0 sc1
  buffer_load_dwordx4 v[132:135], v26, s[16:19], s29 offen offset:1024 sc1
  buffer_load_dwordx4 v[152:155], v26, s[16:19], s29 offen offset:2048 sc1
  s_add_u32 s29, s50, 49152
  buffer_load_dwordx4 v[136:139], v26, s[16:19], s29 offen offset:0 sc1
  buffer_load_dwordx4 v[140:143], v26, s[16:19], s29 offen offset:1024 sc1
  buffer_load_dwordx4 v[156:159], v26, s[16:19], s29 offen offset:2048 sc1
  s_waitcnt vmcnt(0) lgkmcnt(0)
  buffer_atomic_add v28, v33, s[72:75], s84 offen sc1
  v_swap_b32 v146, v148
  v_swap_b32 v147, v149
  v_swap_b32 v154, v156
  v_swap_b32 v155, v157
  s_nop 1
  v_mfma_f32_16x16x32_bf16 v[36:39], v[112:115], v[64:67], 0
  v_mfma_f32_16x16x32_bf16 v[44:47], v[112:115], v[68:71], 0
  v_mfma_f32_16x16x32_bf16 v[48:51], v[116:119], v[68:71], 0
  v_mfma_f32_16x16x32_bf16 v[36:39], v[120:123], v[72:75], v[36:39]
  v_mfma_f32_16x16x32_bf16 v[44:47], v[120:123], v[76:79], v[44:47]
  v_mfma_f32_16x16x32_bf16 v[48:51], v[124:127], v[76:79], v[48:51]
  v_mfma_f32_16x16x32_bf16 v[36:39], v[144:147], v[80:83], v[36:39]
  v_mfma_f32_16x16x32_bf16 v[44:47], v[144:147], v[84:87], v[44:47]
  v_mfma_f32_16x16x32_bf16 v[48:51], v[148:151], v[84:87], v[48:51]
  v_mfma_f32_16x16x32_bf16 v[36:39], v[128:131], v[88:91], v[36:39]
  v_mfma_f32_16x16x32_bf16 v[44:47], v[128:131], v[92:95], v[44:47]
  v_mfma_f32_16x16x32_bf16 v[48:51], v[132:135], v[92:95], v[48:51]
  v_mfma_f32_16x16x32_bf16 v[36:39], v[136:139], v[96:99], v[36:39]
  v_mfma_f32_16x16x32_bf16 v[44:47], v[136:139], v[100:103], v[44:47]
  v_mfma_f32_16x16x32_bf16 v[48:51], v[140:143], v[100:103], v[48:51]
  v_mfma_f32_16x16x32_bf16 v[36:39], v[152:155], v[104:107], v[36:39]
  v_mfma_f32_16x16x32_bf16 v[44:47], v[152:155], v[108:111], v[44:47]
  v_mfma_f32_16x16x32_bf16 v[48:51], v[156:159], v[108:111], v[48:51]
  s_cmp_le_u32 s49, 56
  s_cbranch_scc1 qtp_245
  s_sub_u32 s23, s49, 1
  s_min_u32 s23, s23, 62
  s_mov_b32 s101, 0
wm_246:
  buffer_load_dword v34, v30, s[72:75], s77 offen sc1
  s_add_u32 s101, s101, 1
  s_cmp_gt_u32 s101, 131072
  s_cbranch_scc1 main_end
  s_waitcnt vmcnt(0)
  v_cmp_gt_u32 vcc, s23, v34
  v_readfirstlane_b32 s100, v34
  s_nop 0
  s_cbranch_vccz wm_247
  s_sleep 4
  s_add_u32 s100, s100, 2
  s_cmp_ge_u32 s100, s23
  s_cbranch_scc1 wm_246
  s_sleep 40
  s_branch wm_246
wm_247:
qtp_245:
  s_mov_b32 s101, 0
  s_branch qtp_244
qtp_243:
  s_sleep 2
qtp_244:
  s_add_u32 s29, s50, 4096
  buffer_load_dwordx4 v[160:163], v24, s[16:19], s29 offen offset:2560 sc1
  buffer_load_dwordx2 v[240:241], v25, s[16:19], s29 offen offset:3072 sc1
  s_add_u32 s29, s50, 20480
  buffer_load_dwordx4 v[164:167], v24, s[16:19], s29 offen offset:2560 sc1
  buffer_load_dwordx2 v[242:243], v25, s[16:19], s29 offen offset:3072 sc1
  s_add_u32 s29, s50, 36864
  buffer_load_dwordx4 v[168:171], v24, s[16:19], s29 offen offset:2560 sc1
  buffer_load_dwordx2 v[244:245], v25, s[16:19], s29 offen offset:3072 sc1
  s_add_u32 s29, s50, 53248
  buffer_load_dwordx4 v[172:175], v24, s[16:19], s29 offen offset:2560 sc1
  buffer_load_dwordx2 v[246:247], v25, s[16:19], s29 offen offset:3072 sc1
  s_add_u32 s101, s101, 1
  s_cmp_gt_u32 s101, 131072
  s_cbranch_scc1 main_end
  s_waitcnt vmcnt(0)
  v_max3_u32 v34, v160, v164, v168
  v_max3_u32 v34, v34, v172, v240
  v_max3_u32 v34, v34, v242, v244
  v_max_u32 v34, v34, v246
  v_cmp_eq_u32 vcc, -1, v34
  s_nop 1
  s_cbranch_vccnz qtp_243
  v_mfma_f32_16x16x32_bf16 v[40:43], v[160:163], v[64:67], 0
  v_mfma_f32_16x16x32_bf16 v[52:55], v[160:163], v[68:71], 0
  v_mfma_f32_16x16x32_bf16 v[40:43], v[164:167], v[72:75], v[40:43]
  v_mfma_f32_16x16x32_bf16 v[52:55], v[164:167], v[76:79], v[52:55]
  v_mfma_f32_16x16x32_bf16 v[40:43], v[240:243], v[80:83], v[40:43]
  v_mfma_f32_16x16x32_bf16 v[52:55], v[240:243], v[84:87], v[52:55]
  v_mfma_f32_16x16x32_bf16 v[40:43], v[168:171], v[88:91], v[40:43]
  v_mfma_f32_16x16x32_bf16 v[52:55], v[168:171], v[92:95], v[52:55]
  v_mfma_f32_16x16x32_bf16 v[40:43], v[172:175], v[96:99], v[40:43]
  v_mfma_f32_16x16x32_bf16 v[52:55], v[172:175], v[100:103], v[52:55]
  v_mfma_f32_16x16x32_bf16 v[40:43], v[244:247], v[104:107], v[40:43]
  v_mfma_f32_16x16x32_bf16 v[52:55], v[244:247], v[108:111], v[52:55]
  s_nop 4
  v_cndmask_b32 v36, v31, v36, s[64:65]
  v_cndmask_b32 v48, v31, v48, s[64:65]
  v_cndmask_b32 v37, v31, v37, s[66:67]
  v_cndmask_b32 v49, v31, v49, s[66:67]
  v_cndmask_b32 v38, v31, v38, s[68:69]
  v_cndmask_b32 v50, v31, v50, s[68:69]
  v_cndmask_b32 v39, v31, v39, s[70:71]
  v_cndmask_b32 v51, v31, v51, s[70:71]
  v_max3_f32 v34, v36, v37, v38
  v_max3_f32 v34, v34, v39, v40
  v_max3_f32 v34, v34, v41, v42
  v_max_f32 v34, v34, v43
  v_mov_b32 v35, v34
  s_nop 1
  v_permlane32_swap_b32 v34, v35
  v_max_f32 v34, v34, v35
  v_mov_b32 v35, v34
  s_nop 1
  v_permlane16_swap_b32 v34, v35
  v_max_f32 v34, v34, v35
  v_mul_f32 v34, s83, v34
  v_fma_f32 v36, v36, s83, -v34
  v_fma_f32 v37, v37, s83, -v34
  v_fma_f32 v38, v38, s83, -v34
  v_fma_f32 v39, v39, s83, -v34
  v_fma_f32 v40, v40, s83, -v34
  v_fma_f32 v41, v41, s83, -v34
  v_fma_f32 v42, v42, s83, -v34
  v_fma_f32 v43, v43, s83, -v34
  v_exp_f32 v36, v36
  v_exp_f32 v37, v37
  v_exp_f32 v38, v38
  v_exp_f32 v39, v39
  v_exp_f32 v40, v40
  v_exp_f32 v41, v41
  v_exp_f32 v42, v42
  v_exp_f32 v43, v43
  s_nop 0
  v_add_f32 v34, v40, v41
  v_add_f32 v34, v34, v42
  v_add_f32 v34, v34, v43
  v_cndmask_b32 v34, 0, v34, s[62:63]
  v_add_f32 v34, v34, v36
  v_add_f32 v34, v34, v37
  v_add_f32 v34, v34, v38
  v_add_f32 v34, v34, v39
  v_mov_b32 v35, v34
  s_nop 1
  v_permlane32_swap_b32 v34, v35
  v_add_f32 v34, v34, v35
  v_mov_b32 v35, v34
  s_nop 1
  v_permlane16_swap_b32 v34, v35
  v_add_f32 v34, v34, v35
  v_rcp_f32 v34, v34
  s_nop 0
  v_mul_f32 v36, v36, v34
  v_mul_f32 v37, v37, v34
  v_mul_f32 v38, v38, v34
  v_mul_f32 v39, v39, v34
  v_mul_f32 v40, v40, v34
  v_mul_f32 v41, v41, v34
  v_mul_f32 v42, v42, v34
  v_mul_f32 v43, v43, v34
  v_max3_f32 v34, v44, v45, v46
  v_max3_f32 v34, v34, v47, v48
  v_max3_f32 v34, v34, v49, v50
  v_max3_f32 v34, v34, v51, v52
  v_max3_f32 v34, v34, v53, v54
  v_max_f32 v34, v34, v55
  v_mov_b32 v35, v34
  s_nop 1
  v_permlane32_swap_b32 v34, v35
  v_max_f32 v34, v34, v35
  v_mov_b32 v35, v34
  s_nop 1
  v_permlane16_swap_b32 v34, v35
  v_max_f32 v34, v34, v35
  v_mul_f32 v34, s83, v34
  v_fma_f32 v44, v44, s83, -v34
  v_fma_f32 v45, v45, s83, -v34
  v_fma_f32 v46, v46, s83, -v34
  v_fma_f32 v47, v47, s83, -v34
  v_fma_f32 v48, v48, s83, -v34
  v_fma_f32 v49, v49, s83, -v34
  v_fma_f32 v50, v50, s83, -v34
  v_fma_f32 v51, v51, s83, -v34
  v_fma_f32 v52, v52, s83, -v34
  v_fma_f32 v53, v53, s83, -v34
  v_fma_f32 v54, v54, s83, -v34
  v_fma_f32 v55, v55, s83, -v34
  v_exp_f32 v44, v44
  v_exp_f32 v45, v45
  v_exp_f32 v46, v46
  v_exp_f32 v47, v47
  v_exp_f32 v48, v48
  v_exp_f32 v49, v49
  v_exp_f32 v50, v50
  v_exp_f32 v51, v51
  v_exp_f32 v52, v52
  v_exp_f32 v53, v53
  v_exp_f32 v54, v54
  v_exp_f32 v55, v55
  s_nop 0
  v_add_f32 v34, v52, v53
  v_add_f32 v34, v34, v54
  v_add_f32 v34, v34, v55
  v_cndmask_b32 v34, 0, v34, s[62:63]
  v_add_f32 v34, v34, v44
  v_add_f32 v34, v34, v45
  v_add_f32 v34, v34, v46
  v_add_f32 v34, v34, v47
  v_add_f32 v34, v34, v48
  v_add_f32 v34, v34, v49
  v_add_f32 v34, v34, v50
  v_add_f32 v34, v34, v51
  v_mov_b32 v35, v34
  s_nop 1
  v_permlane32_swap_b32 v34, v35
  v_add_f32 v34, v34, v35
  v_mov_b32 v35, v34
  s_nop 1
  v_permlane16_swap_b32 v34, v35
  v_add_f32 v34, v34, v35
  v_rcp_f32 v34, v34
  s_nop 0
  v_mul_f32 v44, v44, v34
  v_mul_f32 v45, v45, v34
  v_mul_f32 v46, v46, v34
  v_mul_f32 v47, v47, v34
  v_mul_f32 v48, v48, v34
  v_mul_f32 v49, v49, v34
  v_mul_f32 v50, v50, v34
  v_mul_f32 v51, v51, v34
  v_mul_f32 v52, v52, v34
  v_mul_f32 v53, v53, v34
  v_mul_f32 v54, v54, v34
  v_mul_f32 v55, v55, v34
  v_cvt_pk_bf16_f32 v56, v44, v45
  v_cvt_pk_bf16_f32 v57, v46, v47
  v_cvt_pk_bf16_f32 v58, v48, v49
  v_cvt_pk_bf16_f32 v59, v50, v51
  v_cvt_pk_bf16_f32 v60, v40, v41
  v_cvt_pk_bf16_f32 v61, v42, v43
  v_cvt_pk_bf16_f32 v62, v52, v53
  v_cvt_pk_bf16_f32 v63, v54, v55
  v_cvt_pk_bf16_f32 v248, v36, v37
  v_cvt_pk_bf16_f32 v249, v38, v39
  buffer_store_dwordx4 v[56:59], v26, s[16:19], s81 offen sc1
  buffer_store_dwordx4 v[60:63], v26, s[16:19], s81 offen offset:1024 sc1
  buffer_store_dwordx2 v[248:249], v29, s[16:19], s81 offen offset:2048 sc1
  s_mov_b32 s84, s82
  s_mov_b32 s49, s43
  s_mov_b32 s50, s45
  s_mov_b32 s81, s47
  s_mov_b32 s82, s48
  s_add_u32 s43, s43, 4
  s_add_u32 s45, s45, 8388608
  s_add_u32 s47, s47, 2097152
  s_xor_b32 s47, s47, 8192
  s_add_u32 s48, s48, 512
  s_mul_i32 s21, s20, 12288
  s_add_u32 s21, s21, s86
  buffer_load_dwordx4 v[64:67], v26, s[56:59], s21 offen offset:0 sc1
  buffer_load_dwordx4 v[68:71], v26, s[56:59], s21 offen offset:1024 sc1
  buffer_load_dwordx4 v[96:99], v26, s[56:59], s21 offen offset:2048 sc1
  s_add_u32 s21, s21, 3072
  buffer_load_dwordx4 v[72:75], v26, s[56:59], s21 offen offset:0 sc1
  buffer_load_dwordx4 v[76:79], v26, s[56:59], s21 offen offset:1024 sc1
  buffer_load_dwordx4 v[100:103], v26, s[56:59], s21 offen offset:2048 sc1
  s_add_u32 s21, s21, 3072
  buffer_load_dwordx4 v[80:83], v26, s[56:59], s21 offen offset:0 sc1
  buffer_load_dwordx4 v[84:87], v26, s[56:59], s21 offen offset:1024 sc1
  buffer_load_dwordx4 v[104:107], v26, s[56:59], s21 offen offset:2048 sc1
  s_add_u32 s21, s21, 3072
  buffer_load_dwordx4 v[88:91], v26, s[56:59], s21 offen offset:0 sc1
  buffer_load_dwordx4 v[92:95], v26, s[56:59], s21 offen offset:1024 sc1
  buffer_load_dwordx4 v[108:111], v26, s[56:59], s21 offen offset:2048 sc1
  s_add_u32 s21, s21, 3072
  s_cmp_gt_u32 s49, 56
  s_cselect_b32 s23, 54, s49
  s_mov_b32 s101, 0
wm_248:
  buffer_load_dword v34, v30, s[72:75], s77 offen sc1
  s_add_u32 s101, s101, 1
  s_cmp_gt_u32 s101, 131072
  s_cbranch_scc1 main_end
  s_waitcnt vmcnt(0)
  v_cmp_gt_u32 vcc, s23, v34
  v_readfirstlane_b32 s100, v34
  s_nop 0
  s_cbranch_vccz wm_249
  s_sleep 4
  s_add_u32 s100, s100, 2
  s_cmp_ge_u32 s100, s23
  s_cbranch_scc1 wm_248
  s_sleep 40
  s_branch wm_248
wm_249:
  s_add_u32 s29, s50, 0
  buffer_load_dwordx4 v[112:115], v26, s[16:19], s29 offen offset:0 sc1
  buffer_load_dwordx4 v[116:119], v26, s[16:19], s29 offen offset:1024 sc1
  buffer_load_dwordx4 v[144:147], v26, s[16:19], s29 offen offset:2048 sc1
  s_add_u32 s29, s50, 16384
  buffer_load_dwordx4 v[120:123], v26, s[16:19], s29 offen offset:0 sc1
  buffer_load_dwordx4 v[124:127], v26, s[16:19], s29 offen offset:1024 sc1
  buffer_load_dwordx4 v[148:151], v26, s[16:19], s29 offen offset:2048 sc1
  s_add_u32 s29, s50, 32768
  buffer_load_dwordx4 v[128:131], v26, s[16:19], s29 offen offset:0 sc1
  buffer_load_dwordx4 v[132:135], v26, s[16:19], s29 offen offset:1024 sc1
  buffer_load_dwordx4 v[152:155], v26, s[16:19], s29 offen offset:2048 sc1
  s_add_u32 s29, s50, 49152
  buffer_load_dwordx4 v[136:139], v26, s[16:19], s29 offen offset:0 sc1
  buffer_load_dwordx4 v[140:143], v26, s[16:19], s29 offen offset:1024 sc1
  buffer_load_dwordx4 v[156:159], v26, s[16:19], s29 offen offset:2048 sc1
  s_waitcnt vmcnt(0) lgkmcnt(0)
  buffer_atomic_add v28, v33, s[72:75], s84 offen sc1
  v_swap_b32 v98, v100
  v_swap_b32 v99, v101
  v_swap_b32 v106, v108
  v_swap_b32 v107, v109
  v_swap_b32 v146, v148
  v_swap_b32 v147, v149
  v_swap_b32 v154, v156
  v_swap_b32 v155, v157
  s_nop 1
  v_mfma_f32_16x16x32_bf16 v[36:39], v[112:115], v[64:67], 0
  v_mfma_f32_16x16x32_bf16 v[44:47], v[112:115], v[68:71], 0
  v_mfma_f32_16x16x32_bf16 v[48:51], v[116:119], v[68:71], 0
  v_mfma_f32_16x16x32_bf16 v[36:39], v[120:123], v[72:75], v[36:39]
  v_mfma_f32_16x16x32_bf16 v[44:47], v[120:123], v[76:79], v[44:47]
  v_mfma_f32_16x16x32_bf16 v[48:51], v[124:127], v[76:79], v[48:51]
  v_mfma_f32_16x16x32_bf16 v[36:39], v[144:147], v[96:99], v[36:39]
  v_mfma_f32_16x16x32_bf16 v[44:47], v[144:147], v[100:103], v[44:47]
  v_mfma_f32_16x16x32_bf16 v[48:51], v[148:151], v[100:103], v[48:51]
  v_mfma_f32_16x16x32_bf16 v[36:39], v[128:131], v[80:83], v[36:39]
  v_mfma_f32_16x16x32_bf16 v[44:47], v[128:131], v[84:87], v[44:47]
  v_mfma_f32_16x16x32_bf16 v[48:51], v[132:135], v[84:87], v[48:51]
  v_mfma_f32_16x16x32_bf16 v[36:39], v[136:139], v[88:91], v[36:39]
  v_mfma_f32_16x16x32_bf16 v[44:47], v[136:139], v[92:95], v[44:47]
  v_mfma_f32_16x16x32_bf16 v[48:51], v[140:143], v[92:95], v[48:51]
  v_mfma_f32_16x16x32_bf16 v[36:39], v[152:155], v[104:107], v[36:39]
  v_mfma_f32_16x16x32_bf16 v[44:47], v[152:155], v[108:111], v[44:47]
  v_mfma_f32_16x16x32_bf16 v[48:51], v[156:159], v[108:111], v[48:51]
  s_cmp_le_u32 s49, 56
  s_cbranch_scc1 qtp_252
  s_sub_u32 s23, s49, 1
  s_min_u32 s23, s23, 62
  s_mov_b32 s101, 0
wm_253:
  buffer_load_dword v34, v30, s[72:75], s77 offen sc1
  s_add_u32 s101, s101, 1
  s_cmp_gt_u32 s101, 131072
  s_cbranch_scc1 main_end
  s_waitcnt vmcnt(0)
  v_cmp_gt_u32 vcc, s23, v34
  v_readfirstlane_b32 s100, v34
  s_nop 0
  s_cbranch_vccz wm_254
  s_sleep 4
  s_add_u32 s100, s100, 2
  s_cmp_ge_u32 s100, s23
  s_cbranch_scc1 wm_253
  s_sleep 40
  s_branch wm_253
wm_254:
qtp_252:
  s_mov_b32 s101, 0
  s_branch qtp_251
qtp_250:
  s_sleep 2
qtp_251:
  s_add_u32 s29, s50, 4096
  buffer_load_dwordx4 v[160:163], v24, s[16:19], s29 offen offset:2560 sc1
  buffer_load_dwordx2 v[240:241], v25, s[16:19], s29 offen offset:3072 sc1
  s_add_u32 s29, s50, 20480
  buffer_load_dwordx4 v[164:167], v24, s[16:19], s29 offen offset:2560 sc1
  buffer_load_dwordx2 v[242:243], v25, s[16:19], s29 offen offset:3072 sc1
  s_add_u32 s29, s50, 36864
  buffer_load_dwordx4 v[168:171], v24, s[16:19], s29 offen offset:2560 sc1
  buffer_load_dwordx2 v[244:245], v25, s[16:19], s29 offen offset:3072 sc1
  s_add_u32 s29, s50, 53248
  buffer_load_dwordx4 v[172:175], v24, s[16:19], s29 offen offset:2560 sc1
  buffer_load_dwordx2 v[246:247], v25, s[16:19], s29 offen offset:3072 sc1
  s_add_u32 s101, s101, 1
  s_cmp_gt_u32 s101, 131072
  s_cbranch_scc1 main_end
  s_waitcnt vmcnt(0)
  v_max3_u32 v34, v160, v164, v168
  v_max3_u32 v34, v34, v172, v240
  v_max3_u32 v34, v34, v242, v244
  v_max_u32 v34, v34, v246
  v_cmp_eq_u32 vcc, -1, v34
  s_nop 1
  s_cbranch_vccnz qtp_250
  v_mfma_f32_16x16x32_bf16 v[40:43], v[160:163], v[64:67], 0
  v_mfma_f32_16x16x32_bf16 v[52:55], v[160:163], v[68:71], 0
  v_mfma_f32_16x16x32_bf16 v[40:43], v[164:167], v[72:75], v[40:43]
  v_mfma_f32_16x16x32_bf16 v[52:55], v[164:167], v[76:79], v[52:55]
  v_mfma_f32_16x16x32_bf16 v[40:43], v[240:243], v[96:99], v[40:43]
  v_mfma_f32_16x16x32_bf16 v[52:55], v[240:243], v[100:103], v[52:55]
  v_mfma_f32_16x16x32_bf16 v[40:43], v[168:171], v[80:83], v[40:43]
  v_mfma_f32_16x16x32_bf16 v[52:55], v[168:171], v[84:87], v[52:55]
  v_mfma_f32_16x16x32_bf16 v[40:43], v[172:175], v[88:91], v[40:43]
  v_mfma_f32_16x16x32_bf16 v[52:55], v[172:175], v[92:95], v[52:55]
  v_mfma_f32_16x16x32_bf16 v[40:43], v[244:247], v[104:107], v[40:43]
  v_mfma_f32_16x16x32_bf16 v[52:55], v[244:247], v[108:111], v[52:55]
  s_nop 4
  v_cndmask_b32 v36, v31, v36, s[64:65]
  v_cndmask_b32 v48, v31, v48, s[64:65]
  v_cndmask_b32 v37, v31, v37, s[66:67]
  v_cndmask_b32 v49, v31, v49, s[66:67]
  v_cndmask_b32 v38, v31, v38, s[68:69]
  v_cndmask_b32 v50, v31, v50, s[68:69]
  v_cndmask_b32 v39, v31, v39, s[70:71]
  v_cndmask_b32 v51, v31, v51, s[70:71]
  v_max3_f32 v34, v36, v37, v38
  v_max3_f32 v34, v34, v39, v40
  v_max3_f32 v34, v34, v41, v42
  v_max_f32 v34, v34, v43
  v_mov_b32 v35, v34
  s_nop 1
  v_permlane32_swap_b32 v34, v35
  v_max_f32 v34, v34, v35
  v_mov_b32 v35, v34
  s_nop 1
  v_permlane16_swap_b32 v34, v35
  v_max_f32 v34, v34, v35
  v_mul_f32 v34, s83, v34
  v_fma_f32 v36, v36, s83, -v34
  v_fma_f32 v37, v37, s83, -v34
  v_fma_f32 v38, v38, s83, -v34
  v_fma_f32 v39, v39, s83, -v34
  v_fma_f32 v40, v40, s83, -v34
  v_fma_f32 v41, v41, s83, -v34
  v_fma_f32 v42, v42, s83, -v34
  v_fma_f32 v43, v43, s83, -v34
  v_exp_f32 v36, v36
  v_exp_f32 v37, v37
  v_exp_f32 v38, v38
  v_exp_f32 v39, v39
  v_exp_f32 v40, v40
  v_exp_f32 v41, v41
  v_exp_f32 v42, v42
  v_exp_f32 v43, v43
  s_nop 0
  v_add_f32 v34, v40, v41
  v_add_f32 v34, v34, v42
  v_add_f32 v34, v34, v43
  v_cndmask_b32 v34, 0, v34, s[62:63]
  v_add_f32 v34, v34, v36
  v_add_f32 v34, v34, v37
  v_add_f32 v34, v34, v38
  v_add_f32 v34, v34, v39
  v_mov_b32 v35, v34
  s_nop 1
  v_permlane32_swap_b32 v34, v35
  v_add_f32 v34, v34, v35
  v_mov_b32 v35, v34
  s_nop 1
  v_permlane16_swap_b32 v34, v35
  v_add_f32 v34, v34, v35
  v_rcp_f32 v34, v34
  s_nop 0
  v_mul_f32 v36, v36, v34
  v_mul_f32 v37, v37, v34
  v_mul_f32 v38, v38, v34
  v_mul_f32 v39, v39, v34
  v_mul_f32 v40, v40, v34
  v_mul_f32 v41, v41, v34
  v_mul_f32 v42, v42, v34
  v_mul_f32 v43, v43, v34
  v_max3_f32 v34, v44, v45, v46
  v_max3_f32 v34, v34, v47, v48
  v_max3_f32 v34, v34, v49, v50
  v_max3_f32 v34, v34, v51, v52
  v_max3_f32 v34, v34, v53, v54
  v_max_f32 v34, v34, v55
  v_mov_b32 v35, v34
  s_nop 1
  v_permlane32_swap_b32 v34, v35
  v_max_f32 v34, v34, v35
  v_mov_b32 v35, v34
  s_nop 1
  v_permlane16_swap_b32 v34, v35
  v_max_f32 v34, v34, v35
  v_mul_f32 v34, s83, v34
  v_fma_f32 v44, v44, s83, -v34
  v_fma_f32 v45, v45, s83, -v34
  v_fma_f32 v46, v46, s83, -v34
  v_fma_f32 v47, v47, s83, -v34
  v_fma_f32 v48, v48, s83, -v34
  v_fma_f32 v49, v49, s83, -v34
  v_fma_f32 v50, v50, s83, -v34
  v_fma_f32 v51, v51, s83, -v34
  v_fma_f32 v52, v52, s83, -v34
  v_fma_f32 v53, v53, s83, -v34
  v_fma_f32 v54, v54, s83, -v34
  v_fma_f32 v55, v55, s83, -v34
  v_exp_f32 v44, v44
  v_exp_f32 v45, v45
  v_exp_f32 v46, v46
  v_exp_f32 v47, v47
  v_exp_f32 v48, v48
  v_exp_f32 v49, v49
  v_exp_f32 v50, v50
  v_exp_f32 v51, v51
  v_exp_f32 v52, v52
  v_exp_f32 v53, v53
  v_exp_f32 v54, v54
  v_exp_f32 v55, v55
  s_nop 0
  v_add_f32 v34, v52, v53
  v_add_f32 v34, v34, v54
  v_add_f32 v34, v34, v55
  v_cndmask_b32 v34, 0, v34, s[62:63]
  v_add_f32 v34, v34, v44
  v_add_f32 v34, v34, v45
  v_add_f32 v34, v34, v46
  v_add_f32 v34, v34, v47
  v_add_f32 v34, v34, v48
  v_add_f32 v34, v34, v49
  v_add_f32 v34, v34, v50
  v_add_f32 v34, v34, v51
  v_mov_b32 v35, v34
  s_nop 1
  v_permlane32_swap_b32 v34, v35
  v_add_f32 v34, v34, v35
  v_mov_b32 v35, v34
  s_nop 1
  v_permlane16_swap_b32 v34, v35
  v_add_f32 v34, v34, v35
  v_rcp_f32 v34, v34
  s_nop 0
  v_mul_f32 v44, v44, v34
  v_mul_f32 v45, v45, v34
  v_mul_f32 v46, v46, v34
  v_mul_f32 v47, v47, v34
  v_mul_f32 v48, v48, v34
  v_mul_f32 v49, v49, v34
  v_mul_f32 v50, v50, v34
  v_mul_f32 v51, v51, v34
  v_mul_f32 v52, v52, v34
  v_mul_f32 v53, v53, v34
  v_mul_f32 v54, v54, v34
  v_mul_f32 v55, v55, v34
  v_cvt_pk_bf16_f32 v56, v44, v45
  v_cvt_pk_bf16_f32 v57, v46, v47
  v_cvt_pk_bf16_f32 v58, v48, v49
  v_cvt_pk_bf16_f32 v59, v50, v51
  v_cvt_pk_bf16_f32 v60, v40, v41
  v_cvt_pk_bf16_f32 v61, v42, v43
  v_cvt_pk_bf16_f32 v62, v52, v53
  v_cvt_pk_bf16_f32 v63, v54, v55
  v_cvt_pk_bf16_f32 v248, v36, v37
  v_cvt_pk_bf16_f32 v249, v38, v39
  buffer_store_dwordx4 v[56:59], v26, s[16:19], s81 offen sc1
  buffer_store_dwordx4 v[60:63], v26, s[16:19], s81 offen offset:1024 sc1
  buffer_store_dwordx2 v[248:249], v29, s[16:19], s81 offen offset:2048 sc1
  s_mov_b32 s84, s82
  s_waitcnt vmcnt(0)
  buffer_atomic_add v28, v33, s[72:75], s82 offen sc1
  s_branch qe_255
qw_232:
  s_mov_b32 s101, 0
wm_256:
  buffer_load_dword v32, v30, s[72:75], s77 offen sc1
  s_add_u32 s101, s101, 1
  s_cmp_gt_u32 s101, 131072
  s_cbranch_scc1 main_end
  s_waitcnt vmcnt(0)
  v_cmp_gt_u32 vcc, s49, v32
  v_readfirstlane_b32 s100, v32
  s_nop 0
  s_cbranch_vccz wm_257
  s_sleep 4
  s_add_u32 s100, s100, 2
  s_cmp_ge_u32 s100, s49
  s_cbranch_scc1 wm_256
  s_sleep 60
  s_branch wm_256
wm_257:
  s_branch qj_233
qa2_227:
  s_mov_b32 s49, 0
  s_mov_b32 s50, 1073741824
  s_mov_b32 s81, 1073741824
  s_mov_b32 s82, 1073741824
  s_branch qa3_228
qs_229:
  s_mul_i32 s21, s20, 3072
  s_add_u32 s21, s21, s86
  buffer_store_dwordx4 v[192:195], v26, s[56:59], s21 offen offset:0 sc1
  buffer_store_dwordx4 v[196:199], v26, s[56:59], s21 offen offset:1024 sc1
  buffer_store_dwordx4 v[200:203], v26, s[56:59], s21 offen offset:2048 sc1
  s_add_u32 s21, s21, 12288
  buffer_store_dwordx4 v[204:207], v26, s[56:59], s21 offen offset:0 sc1
  buffer_store_dwordx4 v[208:211], v26, s[56:59], s21 offen offset:1024 sc1
  buffer_store_dwordx4 v[212:215], v26, s[56:59], s21 offen offset:2048 sc1
  s_add_u32 s21, s21, 12288
  buffer_store_dwordx4 v[216:219], v26, s[56:59], s21 offen offset:0 sc1
  buffer_store_dwordx4 v[220:223], v26, s[56:59], s21 offen offset:1024 sc1
  buffer_store_dwordx4 v[224:227], v26, s[56:59], s21 offen offset:2048 sc1
  s_add_u32 s21, s21, 12288
  buffer_store_dwordx4 v[228:231], v26, s[56:59], s21 offen offset:0 sc1
  buffer_store_dwordx4 v[232:235], v26, s[56:59], s21 offen offset:1024 sc1
  buffer_store_dwordx4 v[236:239], v26, s[56:59], s21 offen offset:2048 sc1
  s_add_u32 s21, s21, 12288
  s_branch qs_230
qe_255:
queue:
  s_load_dwordx2 s[4:5], s[0:1], 88
  s_load_dwordx2 s[6:7], s[0:1], 72
  s_load_dwordx2 s[38:39], s[0:1], 104
  s_lshr_b32 s58, s3, 4
  s_bfe_u32 s21, s3, 0x20003
  s_cmp_lt_u32 s3, 64
  s_cselect_b32 s58, s58, s21
  s_cselect_b32 s21, 1, 0
  s_lshr_b32 s41, s3, s21
  s_and_b32 s41, s41, 7
  s_lshl_b32 s59, s58, 3
  s_add_u32 s59, s59, s41
  s_lshl_b32 s59, s59, 7
  s_add_u32 s59, s59, 40960
  s_xor_b32 s59, s59, s80
  s_waitcnt vmcnt(0) lgkmcnt(0)
  s_barrier
  s_mov_b32 s8, s4
  s_mov_b32 s9, s5
  s_mov_b32 s10, 2621440
  s_mov_b32 s11, 0x00020000
  s_mov_b32 s12, s6
  s_mov_b32 s13, s7
  s_mov_b32 s14, 819200
  s_mov_b32 s15, 0x00020000
  s_mov_b32 s16, s38
  s_mov_b32 s17, s39
  s_mov_b32 s18, 171966464
  s_mov_b32 s19, 0x00020000
  s_add_u32 s28, s38, 175112192
  s_addc_u32 s29, s39, 0
  s_mov_b32 s30, 8192
  s_mov_b32 s31, 0x00020000
  s_add_u32 s72, s38, 173080576
  s_addc_u32 s73, s39, 0
  s_mov_b32 s74, 49152
  s_mov_b32 s75, 0x00020000
  v_mov_b32 v28, 0
  v_mov_b32 v30, 102400
  s_cmp_lg_u32 s20, 0
  s_cbranch_scc1 pvc_258
  v_mov_b32 v29, 1
  s_mov_b64 exec, 1
  buffer_atomic_add v29, v28, s[72:75], s59 offen sc0 sc1
  s_waitcnt vmcnt(0)
  ds_write_b32 v30, v29
  s_waitcnt lgkmcnt(0)
  s_mov_b64 exec, -1
pvc_258:
  s_barrier
  ds_read_b32 v23, v30
  s_waitcnt lgkmcnt(0)
  v_readfirstlane_b32 s2, v23
  s_cmp_ge_u32 s2, 16
  s_cbranch_scc1 main_fin
  s_mul_i32 s21, s20, 204800
  s_mul_i32 s22, s41, 160
  s_add_u32 s21, s21, s22
  s_mul_i32 s22, s20, 25600
  v_add_u32 v5, 0, v1
  v_mul_u32_u24 v6, 6554, v5
  v_lshrrev_b32 v6, 16, v6
  v_mul_u32_u24 v6, 1120, v6
  v_lshl_add_u32 v8, v5, 4, v6
  v_add_u32 v5, 64, v1
  v_mul_u32_u24 v6, 6554, v5
  v_lshrrev_b32 v6, 16, v6
  v_mul_u32_u24 v6, 1120, v6
  v_lshl_add_u32 v9, v5, 4, v6
  v_add_u32 v5, 128, v1
  v_mul_u32_u24 v6, 6554, v5
  v_lshrrev_b32 v6, 16, v6
  v_mul_u32_u24 v6, 1120, v6
  v_lshl_add_u32 v10, v5, 4, v6
  v_add_u32 v5, 192, v1
  v_mul_u32_u24 v6, 6554, v5
  v_lshrrev_b32 v6, 16, v6
  v_mul_u32_u24 v6, 1120, v6
  v_lshl_add_u32 v11, v5, 4, v6
  v_add_u32 v5, 256, v1
  v_mul_u32_u24 v6, 6554, v5
  v_lshrrev_b32 v6, 16, v6
  v_mul_u32_u24 v6, 1120, v6
  v_lshl_add_u32 v12, v5, 4, v6
  s_add_u32 m0, s22, 0
  s_nop 0
  buffer_load_dwordx4 v8, s[12:15], s21 offen lds
  s_add_u32 m0, s22, 1024
  s_nop 0
  buffer_load_dwordx4 v9, s[12:15], s21 offen lds
  s_add_u32 m0, s22, 2048
  s_nop 0
  buffer_load_dwordx4 v10, s[12:15], s21 offen lds
  s_add_u32 m0, s22, 3072
  s_nop 0
  buffer_load_dwordx4 v11, s[12:15], s21 offen lds
  s_add_u32 m0, s22, 4096
  s_nop 0
  buffer_load_dwordx4 v12, s[12:15], s21 offen lds
  s_add_u32 s21, s21, 40960
  s_add_u32 m0, s22, 5120
  s_nop 0
  buffer_load_dwordx4 v8, s[12:15], s21 offen lds
  s_add_u32 m0, s22, 6144
  s_nop 0
  buffer_load_dwordx4 v9, s[12:15], s21 offen lds
  s_add_u32 m0, s22, 7168
  s_nop 0
  buffer_load_dwordx4 v10, s[12:15], s21 offen lds
  s_add_u32 m0, s22, 8192
  s_nop 0
  buffer_load_dwordx4 v11, s[12:15], s21 offen lds
  s_add_u32 m0, s22, 9216
  s_nop 0
  buffer_load_dwordx4 v12, s[12:15], s21 offen lds
  s_add_u32 s21, s21, 40960
  s_add_u32 m0, s22, 10240
  s_nop 0
  buffer_load_dwordx4 v8, s[12:15], s21 offen lds
  s_add_u32 m0, s22, 11264
  s_nop 0
  buffer_load_dwordx4 v9, s[12:15], s21 offen lds
  s_add_u32 m0, s22, 12288
  s_nop 0
  buffer_load_dwordx4 v10, s[12:15], s21 offen lds
  s_add_u32 m0, s22, 13312
  s_nop 0
  buffer_load_dwordx4 v11, s[12:15], s21 offen lds
  s_add_u32 m0, s22, 14336
  s_nop 0
  buffer_load_dwordx4 v12, s[12:15], s21 offen lds
  s_add_u32 s21, s21, 40960
  s_add_u32 m0, s22, 15360
  s_nop 0
  buffer_load_dwordx4 v8, s[12:15], s21 offen lds
  s_add_u32 m0, s22, 16384
  s_nop 0
  buffer_load_dwordx4 v9, s[12:15], s21 offen lds
  s_add_u32 m0, s22, 17408
  s_nop 0
  buffer_load_dwordx4 v10, s[12:15], s21 offen lds
  s_add_u32 m0, s22, 18432
  s_nop 0
  buffer_load_dwordx4 v11, s[12:15], s21 offen lds
  s_add_u32 m0, s22, 19456
  s_nop 0
  buffer_load_dwordx4 v12, s[12:15], s21 offen lds
  s_add_u32 s21, s21, 40960
  s_add_u32 m0, s22, 20480
  s_nop 0
  buffer_load_dwordx4 v8, s[12:15], s21 offen lds
  s_add_u32 m0, s22, 21504
  s_nop 0
  buffer_load_dwordx4 v9, s[12:15], s21 offen lds
  s_add_u32 m0, s22, 22528
  s_nop 0
  buffer_load_dwordx4 v10, s[12:15], s21 offen lds
  s_add_u32 m0, s22, 23552
  s_nop 0
  buffer_load_dwordx4 v11, s[12:15], s21 offen lds
  s_add_u32 m0, s22, 24576
  s_nop 0
  buffer_load_dwordx4 v12, s[12:15], s21 offen lds
  s_add_u32 s21, s21, 40960
  v_and_b32 v25, 3, v1
  v_lshlrev_b32 v25, 7, v25
  s_mov_b32 s21, 29696
  s_xor_b32 s21, s21, s80
  v_lshrrev_b32 v5, 2, v2
  v_and_b32 v6, 3, v2
  v_lshlrev_b32 v6, 3, v6
  v_lshl_add_u32 v7, v3, 2, v5
  v_mul_u32_u24 v7, 160, v7
  v_add3_u32 v8, v7, v6, s22
  v_add_u32 v9, v8, v6
  v_mul_u32_u24 v7, 20, v3
  v_add_u32 v7, v7, v5
  v_mul_u32_u24 v7, 160, v7
  v_add3_u32 v10, v7, v6, s22
  v_add_u32 v11, v10, v6
  s_mov_b32 s101, 0
wm_259:
  buffer_load_dword v26, v25, s[72:75], s21 offen sc1
  s_add_u32 s101, s101, 1
  s_cmp_gt_u32 s101, 131072
  s_cbranch_scc1 main_end
  s_waitcnt vmcnt(0)
  v_cmp_gt_u32 vcc, 16, v26
  v_readfirstlane_b32 s100, v26
  s_nop 0
  s_cbranch_vccz wm_260
  s_sleep 16
  s_branch wm_259
wm_260:
  ds_read_b64_tr_b16 a[160:161], v9 offset:0
  ds_read_b64_tr_b16 a[162:163], v9 offset:3200
  ds_read_b64_tr_b16 a[164:165], v9 offset:8
  ds_read_b64_tr_b16 a[166:167], v9 offset:3208
  ds_read_b64_tr_b16 a[168:169], v8 offset:64
  ds_read_b64_tr_b16 a[170:171], v8 offset:3264
  ds_read_b64_tr_b16 a[172:173], v9 offset:96
  ds_read_b64_tr_b16 a[174:175], v9 offset:3296
  ds_read_b64_tr_b16 a[176:177], v9 offset:104
  ds_read_b64_tr_b16 a[178:179], v9 offset:3304
  ds_read_b64_tr_b16 a[180:181], v9 offset:6400
  ds_read_b64_tr_b16 a[182:183], v9 offset:9600
  ds_read_b64_tr_b16 a[184:185], v9 offset:6408
  ds_read_b64_tr_b16 a[186:187], v9 offset:9608
  ds_read_b64_tr_b16 a[188:189], v8 offset:6464
  ds_read_b64_tr_b16 a[190:191], v8 offset:9664
  ds_read_b64_tr_b16 a[192:193], v9 offset:6496
  ds_read_b64_tr_b16 a[194:195], v9 offset:9696
  ds_read_b64_tr_b16 a[196:197], v9 offset:6504
  ds_read_b64_tr_b16 a[198:199], v9 offset:9704
  ds_read_b64_tr_b16 a[200:201], v9 offset:12800
  ds_read_b64_tr_b16 a[202:203], v9 offset:16000
  ds_read_b64_tr_b16 a[204:205], v9 offset:12808
  ds_read_b64_tr_b16 a[206:207], v9 offset:16008
  ds_read_b64_tr_b16 a[208:209], v8 offset:12864
  ds_read_b64_tr_b16 a[210:211], v8 offset:16064
  ds_read_b64_tr_b16 a[212:213], v9 offset:12896
  ds_read_b64_tr_b16 a[214:215], v9 offset:16096
  ds_read_b64_tr_b16 a[216:217], v9 offset:12904
  ds_read_b64_tr_b16 a[218:219], v9 offset:16104
  ds_read_b64_tr_b16 a[220:221], v9 offset:19200
  ds_read_b64_tr_b16 a[222:223], v9 offset:22400
  ds_read_b64_tr_b16 a[224:225], v9 offset:19208
  ds_read_b64_tr_b16 a[226:227], v9 offset:22408
  ds_read_b64_tr_b16 a[228:229], v8 offset:19264
  ds_read_b64_tr_b16 a[230:231], v8 offset:22464
  ds_read_b64_tr_b16 a[232:233], v9 offset:19296
  ds_read_b64_tr_b16 a[234:235], v9 offset:22496
  ds_read_b64_tr_b16 a[236:237], v9 offset:19304
  ds_read_b64_tr_b16 a[238:239], v9 offset:22504
  ds_read_b64_tr_b16 a[240:241], v11 offset:2560
  ds_read_b64_tr_b16 a[242:243], v11 offset:15360
  ds_read_b64_tr_b16 a[244:245], v11 offset:2568
  ds_read_b64_tr_b16 a[246:247], v11 offset:15368
  ds_read_b64_tr_b16 a[248:249], v10 offset:2624
  ds_read_b64_tr_b16 a[250:251], v10 offset:15424
  ds_read_b64_tr_b16 a[252:253], v11 offset:2656
  ds_read_b64_tr_b16 a[254:255], v11 offset:15456
  ds_read_b64_tr_b16 v[252:253], v11 offset:2664
  ds_read_b64_tr_b16 v[254:255], v11 offset:15464
  s_waitcnt lgkmcnt(0)
  s_barrier
  v_lshlrev_b32 v4, 4, v1
  v_lshlrev_b32 v5, 3, v1
  v_lshlrev_b32 v6, 2, v2
  v_and_b32 v7, 7, v1
  v_lshlrev_b32 v7, 7, v7
  v_bfe_u32 v31, v1, 3, 2
  v_lshl_add_u32 v31, v31, 2, v7
  s_lshl_b32 s21, s20, 10
  s_add_u32 s21, s21, 4096
  s_xor_b32 s21, s21, s80
  buffer_load_dword v8, v31, s[72:75], s21 offen sc1
  s_mov_b32 s63, 1
  s_mov_b32 s60, 0
  v_mul_u32_u24 v9, 1280, v2
  v_lshl_add_u32 v13, v3, 3, v9
  v_lshl_add_u32 v9, v3, 4, v9
  s_mul_i32 s21, s20, 10240
  v_add_u32 v10, s21, v4
  s_and_b32 s43, s20, 1
  s_lshr_b32 s44, s20, 1
  s_mul_i32 s21, s44, 6
  s_add_u32 s21, s21, s43
  s_lshl_b32 s21, s21, 10
  v_add_u32 v11, s21, v4
  s_add_u32 s21, s43, 4
  s_lshl_b32 s21, s21, 10
  v_add_u32 v12, s21, v4
  v_lshrrev_b32 v20, 5, v1
  v_mul_u32_u24 v21, 2560, v20
  v_add_u32 v21, v21, v4
  v_and_b32 v22, 31, v1
  v_lshlrev_b32 v22, 4, v22
  v_mul_u32_u24 v14, 640, v20
  v_add_u32 v22, v22, v14
  v_and_b32 v15, 1, v3
  v_lshl_add_u32 v14, v15, 6, v14
  v_lshrrev_b32 v16, 3, v2
  v_mul_u32_u24 v16, 16320, v16
  v_lshl_add_u32 v16, v2, 3, v16
  v_add_u32 v14, v14, v16
  v_add_u32 v15, 40960, v11
  v_lshlrev_b32 v17, 2, v7
  v_bfe_u32 v16, v1, 3, 1
  v_lshl_add_u32 v17, v16, 3, v17
  v_cmp_gt_u32 s[66:67], 16, v1
  v_add_u32 v16, 40960, v12
  s_mov_b32 s50, 0
  s_lshr_b32 s52, s41, 1
  s_lshl_b32 s52, s52, 7
  s_and_b32 s21, s41, 1
  s_lshl_b32 s21, s21, 4
  s_add_u32 s52, s52, s21
  s_add_u32 s52, s52, 0
  s_xor_b32 s52, s52, s80
  v_mov_b32 v70, 0
  v_mov_b32 v71, 0
  v_mov_b32 v78, 0
  v_mov_b32 v79, 0
  v_mov_b32 v86, 0
  v_mov_b32 v87, 0
  v_mov_b32 v94, 0
  v_mov_b32 v95, 0
  v_mov_b32 v102, 0
  v_mov_b32 v103, 0
  v_mov_b32 v110, 0
  v_mov_b32 v111, 0
  v_mov_b32 v118, 0
  v_mov_b32 v119, 0
  v_mov_b32 v126, 0
  v_mov_b32 v127, 0
pv_loop:
  s_lshl_b32 s40, s2, 2
  s_add_u32 s40, s40, s58
  s_lshl_b32 s2, s40, 3
  s_add_u32 s2, s2, s41
  s_lshl_b32 s61, s40, 21
  s_lshl_b32 s21, s40, 13
  s_and_b32 s21, s21, 8192
  s_xor_b32 s21, s21, s80
  s_add_u32 s61, s61, s21
  s_lshl_b32 s55, s40, 19
  s_lshl_b32 s21, s40, 11
  s_and_b32 s21, s21, 8192
  s_xor_b32 s21, s21, s80
  s_add_u32 s55, s55, s21
  s_add_u32 s55, s55, 134217728
  s_lshl_b32 s21, s20, 15
  s_xor_b32 s54, s55, 270336
  s_add_u32 s54, s54, s21
  s_add_u32 s21, s54, 0
  buffer_load_dwordx4 v[192:195], v4, s[16:19], s21 offen offset:0 sc1
  buffer_load_dwordx4 v[196:199], v4, s[16:19], s21 offen offset:1024 sc1
  buffer_load_dwordx2 v[208:209], v5, s[16:19], s21 offen offset:2048 sc1
  s_add_u32 s21, s54, 2560
  buffer_load_dwordx4 v[200:203], v4, s[16:19], s21 offen offset:0 sc1
  buffer_load_dwordx4 v[204:207], v4, s[16:19], s21 offen offset:1024 sc1
  buffer_load_dwordx2 v[210:211], v5, s[16:19], s21 offen offset:2048 sc1
  s_add_u32 s21, s54, 16384
  buffer_load_dwordx4 v[212:215], v4, s[16:19], s21 offen offset:0 sc1
  buffer_load_dwordx4 v[216:219], v4, s[16:19], s21 offen offset:1024 sc1
  buffer_load_dwordx2 v[228:229], v5, s[16:19], s21 offen offset:2048 sc1
  s_add_u32 s21, s54, 18944
  buffer_load_dwordx4 v[220:223], v4, s[16:19], s21 offen offset:0 sc1
  buffer_load_dwordx4 v[224:227], v4, s[16:19], s21 offen offset:1024 sc1
  buffer_load_dwordx2 v[230:231], v5, s[16:19], s21 offen offset:2048 sc1
  s_lshl_b32 s21, s40, 7
  s_add_u32 s21, s21, 8192
  s_xor_b32 s21, s21, s80
  v_mov_b32 v18, s21
  v_add_u32 v19, s52, v17
  v_cndmask_b32 v18, v19, v18, s[66:67]
  s_add_u32 s21, s40, 1
  v_mov_b32 v19, s21
  v_cndmask_b32 v19, v19, 32, s[66:67]
  buffer_load_dword v27, v18, s[72:75], 0 offen sc1
  s_cmp_lg_u32 s20, 0
  s_cbranch_scc1 pv_261
  v_mov_b32 v29, 1
  s_mov_b64 exec, 1
  buffer_atomic_add v29, v28, s[72:75], s59 offen sc0 sc1
  s_mov_b64 exec, -1
pv_261:
  s_lshl_b32 s21, s20, 17
  s_lshl_b32 s22, s41, 10
  s_add_u32 s42, s21, s22
  s_lshl_b32 s53, s20, 19
  s_lshr_b32 s22, s41, 1
  s_lshl_b32 s22, s22, 14
  s_add_u32 s53, s53, s22
  s_and_b32 s22, s41, 1
  s_lshl_b32 s22, s22, 12
  s_add_u32 s53, s53, s22
  s_lshl_b32 s21, s40, 1
  s_add_u32 s21, s21, s43
  s_lshl_b32 s45, s21, 6
  s_mul_i32 s46, s21, 20480
  s_mul_i32 s22, s41, 160
  s_add_u32 s49, s46, s22
  s_mul_i32 s21, s44, 96
  s_add_u32 s46, s49, s21
  s_lshl_b32 s21, s20, 16
  s_xor_b32 s47, s55, 8192
  s_add_u32 s47, s47, s21
  s_lshl_b32 s21, s20, 19
  s_add_u32 s48, s61, s21
  s_lshl_b32 s21, s41, 15
  s_add_u32 s48, s48, s21
  s_add_u32 s48, s48, 4096
  s_add_u32 s23, s40, 1
  s_cmp_ge_u32 s50, s23
  s_cbranch_scc1 pv_262
  s_cmp_eq_u32 s63, 0
  s_cbranch_scc1 pv_265
  s_mov_b32 s63, 0
  s_waitcnt vmcnt(13)
  v_cmp_gt_u32 vcc, s23, v8
  s_nop 1
  s_cbranch_vccz pv_266
pv_265:
  s_lshl_b32 s21, s20, 10
  s_add_u32 s21, s21, 4096
  s_xor_b32 s21, s21, s80
  s_mov_b32 s101, 0
wm_269:
  buffer_load_dword v8, v31, s[72:75], s21 offen sc1
  s_add_u32 s101, s101, 1
  s_cmp_gt_u32 s101, 131072
  s_cbranch_scc1 main_end
  s_waitcnt vmcnt(0)
  v_cmp_gt_u32 vcc, s23, v8
  v_readfirstlane_b32 s100, v8
  s_nop 0
  s_cbranch_vccz wm_270
  s_sleep 8
  s_add_u32 s100, s100, 2
  s_cmp_ge_u32 s100, s23
  s_cbranch_scc1 wm_269
  s_sleep 60
  s_branch wm_269
wm_270:
pv_266:
  v_readlane_b32 s50, v8, 0
  v_readlane_b32 s21, v8, 1
  s_min_u32 s50, s50, s21
  v_readlane_b32 s21, v8, 2
  s_min_u32 s50, s50, s21
  v_readlane_b32 s21, v8, 3
  s_min_u32 s50, s50, s21
  v_readlane_b32 s21, v8, 4
  s_min_u32 s50, s50, s21
  v_readlane_b32 s21, v8, 5
  s_min_u32 s50, s50, s21
  v_readlane_b32 s21, v8, 6
  s_min_u32 s50, s50, s21
  v_readlane_b32 s21, v8, 7
  s_min_u32 s50, s50, s21
  v_readlane_b32 s21, v8, 8
  s_min_u32 s50, s50, s21
  v_readlane_b32 s21, v8, 9
  s_min_u32 s50, s50, s21
  v_readlane_b32 s21, v8, 10
  s_min_u32 s50, s50, s21
  v_readlane_b32 s21, v8, 11
  s_min_u32 s50, s50, s21
  v_readlane_b32 s21, v8, 12
  s_min_u32 s50, s50, s21
  v_readlane_b32 s21, v8, 13
  s_min_u32 s50, s50, s21
  v_readlane_b32 s21, v8, 14
  s_min_u32 s50, s50, s21
  v_readlane_b32 s21, v8, 15
  s_min_u32 s50, s50, s21
  v_readlane_b32 s21, v8, 16
  s_min_u32 s50, s50, s21
  v_readlane_b32 s21, v8, 17
  s_min_u32 s50, s50, s21
  v_readlane_b32 s21, v8, 18
  s_min_u32 s50, s50, s21
  v_readlane_b32 s21, v8, 19
  s_min_u32 s50, s50, s21
  v_readlane_b32 s21, v8, 20
  s_min_u32 s50, s50, s21
  v_readlane_b32 s21, v8, 21
  s_min_u32 s50, s50, s21
  v_readlane_b32 s21, v8, 22
  s_min_u32 s50, s50, s21
  v_readlane_b32 s21, v8, 23
  s_min_u32 s50, s50, s21
  v_readlane_b32 s21, v8, 24
  s_min_u32 s50, s50, s21
  v_readlane_b32 s21, v8, 25
  s_min_u32 s50, s50, s21
  v_readlane_b32 s21, v8, 26
  s_min_u32 s50, s50, s21
  v_readlane_b32 s21, v8, 27
  s_min_u32 s50, s50, s21
  v_readlane_b32 s21, v8, 28
  s_min_u32 s50, s50, s21
  v_readlane_b32 s21, v8, 29
  s_min_u32 s50, s50, s21
  v_readlane_b32 s21, v8, 30
  s_min_u32 s50, s50, s21
  v_readlane_b32 s21, v8, 31
  s_min_u32 s50, s50, s21
pv_262:
  buffer_load_dword v24, v6, s[28:31], s45 offen sc1
  s_xor_b32 s68, s61, 8192
  s_add_u32 s68, s68, s53
  s_add_u32 s70, s55, s42
  buffer_load_dwordx4 a[0:3], v4, s[16:19], s68 offen offset:0 sc1
  buffer_load_dwordx4 a[4:7], v4, s[16:19], s68 offen offset:1024 sc1
  buffer_load_dwordx4 a[8:11], v4, s[16:19], s70 offen sc1
  s_add_u32 s70, s70, 16384
  buffer_load_dwordx4 a[12:15], v4, s[16:19], s68 offen offset:2048 sc1
  buffer_load_dwordx4 a[16:19], v4, s[16:19], s68 offen offset:3072 sc1
  s_add_u32 s68, s68, 65536
  buffer_load_dwordx4 a[20:23], v4, s[16:19], s68 offen offset:0 sc1
  buffer_load_dwordx4 a[24:27], v4, s[16:19], s68 offen offset:1024 sc1
  buffer_load_dwordx4 a[28:31], v4, s[16:19], s70 offen sc1
  s_add_u32 s70, s70, 16384
  buffer_load_dwordx4 a[32:35], v4, s[16:19], s68 offen offset:2048 sc1
  buffer_load_dwordx4 a[36:39], v4, s[16:19], s68 offen offset:3072 sc1
  s_add_u32 s68, s68, 65536
  buffer_load_dwordx4 a[40:43], v4, s[16:19], s68 offen offset:0 sc1
  buffer_load_dwordx4 a[44:47], v4, s[16:19], s68 offen offset:1024 sc1
  buffer_load_dwordx4 a[48:51], v4, s[16:19], s70 offen sc1
  s_add_u32 s70, s70, 16384
  buffer_load_dwordx4 a[52:55], v4, s[16:19], s68 offen offset:2048 sc1
  buffer_load_dwordx4 a[56:59], v4, s[16:19], s68 offen offset:3072 sc1
  s_add_u32 s68, s68, 65536
  buffer_load_dwordx4 a[60:63], v4, s[16:19], s68 offen offset:0 sc1
  buffer_load_dwordx4 a[64:67], v4, s[16:19], s68 offen offset:1024 sc1
  buffer_load_dwordx4 a[68:71], v4, s[16:19], s70 offen sc1
  s_add_u32 s70, s70, 16384
  buffer_load_dwordx4 a[72:75], v4, s[16:19], s68 offen offset:2048 sc1
  buffer_load_dwordx4 a[76:79], v4, s[16:19], s68 offen offset:3072 sc1
  s_add_u32 s68, s68, 65536
  buffer_load_dwordx4 a[80:83], v4, s[16:19], s68 offen offset:0 sc1
  buffer_load_dwordx4 a[84:87], v4, s[16:19], s68 offen offset:1024 sc1
  buffer_load_dwordx4 a[88:91], v4, s[16:19], s70 offen sc1
  s_add_u32 s70, s70, 16384
  buffer_load_dwordx4 a[92:95], v4, s[16:19], s68 offen offset:2048 sc1
  buffer_load_dwordx4 a[96:99], v4, s[16:19], s68 offen offset:3072 sc1
  s_add_u32 s68, s68, 65536
  buffer_load_dwordx4 a[100:103], v4, s[16:19], s68 offen offset:0 sc1
  buffer_load_dwordx4 a[104:107], v4, s[16:19], s68 offen offset:1024 sc1
  buffer_load_dwordx4 a[108:111], v4, s[16:19], s70 offen sc1
  s_add_u32 s70, s70, 16384
  buffer_load_dwordx4 a[112:115], v4, s[16:19], s68 offen offset:2048 sc1
  buffer_load_dwordx4 a[116:119], v4, s[16:19], s68 offen offset:3072 sc1
  s_add_u32 s68, s68, 65536
  buffer_load_dwordx4 a[120:123], v4, s[16:19], s68 offen offset:0 sc1
  buffer_load_dwordx4 a[124:127], v4, s[16:19], s68 offen offset:1024 sc1
  buffer_load_dwordx4 a[128:131], v4, s[16:19], s70 offen sc1
  s_add_u32 s70, s70, 16384
  buffer_load_dwordx4 a[132:135], v4, s[16:19], s68 offen offset:2048 sc1
  buffer_load_dwordx4 a[136:139], v4, s[16:19], s68 offen offset:3072 sc1
  s_add_u32 s68, s68, 65536
  buffer_load_dwordx4 a[140:143], v4, s[16:19], s68 offen offset:0 sc1
  buffer_load_dwordx4 a[144:147], v4, s[16:19], s68 offen offset:1024 sc1
  buffer_load_dwordx4 a[148:151], v4, s[16:19], s70 offen sc1
  s_add_u32 s70, s70, 16384
  buffer_load_dwordx4 a[152:155], v4, s[16:19], s68 offen offset:2048 sc1
  buffer_load_dwordx4 a[156:159], v4, s[16:19], s68 offen offset:3072 sc1
  s_add_u32 s68, s68, 65536
  s_waitcnt vmcnt(40)
  v_cmp_gt_u32 vcc, v19, v27
  s_nop 1
  s_cbranch_vccnz pvw_267
  buffer_load_dwordx4 v[64:67], v4, s[16:19], s47 offen sc1
  buffer_load_dwordx2 v[68:69], v5, s[16:19], s47 offen offset:2048 sc1
  buffer_load_dwordx4 v[128:131], v21, s[16:19], s47 offen offset:1024 sc1
  s_add_u32 s47, s47, 2560
  buffer_load_dwordx4 v[72:75], v4, s[16:19], s47 offen sc1
  buffer_load_dwordx2 v[76:77], v5, s[16:19], s47 offen offset:2048 sc1
  s_add_u32 s47, s47, 13824
  buffer_load_dwordx4 v[80:83], v4, s[16:19], s47 offen sc1
  buffer_load_dwordx2 v[84:85], v5, s[16:19], s47 offen offset:2048 sc1
  buffer_load_dwordx4 v[132:135], v21, s[16:19], s47 offen offset:1024 sc1
  s_add_u32 s47, s47, 2560
  buffer_load_dwordx4 v[88:91], v4, s[16:19], s47 offen sc1
  buffer_load_dwordx2 v[92:93], v5, s[16:19], s47 offen offset:2048 sc1
  s_add_u32 s47, s47, 13824
  s_add_u32 s21, s48, 16384
  buffer_load_dwordx4 v[32:35], v22, s[16:19], s48 offen offset:0 sc1
  buffer_load_dwordx4 v[40:43], v22, s[16:19], s21 offen offset:0 sc1
  buffer_load_dwordx2 v[184:185], v14, s[16:19], s48 offen offset:512 sc1
  buffer_load_dwordx4 v[36:39], v22, s[16:19], s48 offen offset:1280 sc1
  buffer_load_dwordx4 v[44:47], v22, s[16:19], s21 offen offset:1280 sc1
  buffer_load_dwordx2 v[186:187], v14, s[16:19], s48 offen offset:1792 sc1
  s_add_u32 s48, s48, 262144
  v_mfma_f32_16x16x32_bf16 v[144:147], a[160:163], v[192:195], 0
  v_mfma_f32_16x16x32_bf16 v[148:151], a[160:163], v[212:215], 0
  v_mfma_f32_16x16x32_bf16 v[152:155], a[164:167], v[192:195], 0
  v_mfma_f32_16x16x32_bf16 v[156:159], a[164:167], v[212:215], 0
  v_mfma_f32_16x16x32_bf16 v[160:163], a[168:171], v[192:195], 0
  v_mfma_f32_16x16x32_bf16 v[164:167], a[168:171], v[212:215], 0
  v_mfma_f32_16x16x32_bf16 v[168:171], a[172:175], v[192:195], 0
  v_mfma_f32_16x16x32_bf16 v[172:175], a[172:175], v[212:215], 0
  v_mfma_f32_16x16x32_bf16 v[176:179], a[176:179], v[192:195], 0
  v_mfma_f32_16x16x32_bf16 v[180:183], a[176:179], v[212:215], 0
  v_mfma_f32_16x16x32_bf16 v[144:147], a[180:183], v[196:199], v[144:147]
  v_mfma_f32_16x16x32_bf16 v[148:151], a[180:183], v[216:219], v[148:151]
  v_mfma_f32_16x16x32_bf16 v[152:155], a[184:187], v[196:199], v[152:155]
  v_mfma_f32_16x16x32_bf16 v[156:159], a[184:187], v[216:219], v[156:159]
  v_mfma_f32_16x16x32_bf16 v[160:163], a[188:191], v[196:199], v[160:163]
  v_mfma_f32_16x16x32_bf16 v[164:167], a[188:191], v[216:219], v[164:167]
  v_mfma_f32_16x16x32_bf16 v[168:171], a[192:195], v[196:199], v[168:171]
  v_mfma_f32_16x16x32_bf16 v[172:175], a[192:195], v[216:219], v[172:175]
  v_mfma_f32_16x16x32_bf16 v[176:179], a[196:199], v[196:199], v[176:179]
  v_mfma_f32_16x16x32_bf16 v[180:183], a[196:199], v[216:219], v[180:183]
  v_mfma_f32_16x16x32_bf16 v[144:147], a[200:203], v[200:203], v[144:147]
  v_mfma_f32_16x16x32_bf16 v[148:151], a[200:203], v[220:223], v[148:151]
  v_mfma_f32_16x16x32_bf16 v[152:155], a[204:207], v[200:203], v[152:155]
  v_mfma_f32_16x16x32_bf16 v[156:159], a[204:207], v[220:223], v[156:159]
  v_mfma_f32_16x16x32_bf16 v[160:163], a[208:211], v[200:203], v[160:163]
  v_mfma_f32_16x16x32_bf16 v[164:167], a[208:211], v[220:223], v[164:167]
  v_mfma_f32_16x16x32_bf16 v[168:171], a[212:215], v[200:203], v[168:171]
  v_mfma_f32_16x16x32_bf16 v[172:175], a[212:215], v[220:223], v[172:175]
  v_mfma_f32_16x16x32_bf16 v[176:179], a[216:219], v[200:203], v[176:179]
  v_mfma_f32_16x16x32_bf16 v[180:183], a[216:219], v[220:223], v[180:183]
  v_mfma_f32_16x16x32_bf16 v[144:147], a[220:223], v[204:207], v[144:147]
  v_mfma_f32_16x16x32_bf16 v[148:151], a[220:223], v[224:227], v[148:151]
  v_mfma_f32_16x16x32_bf16 v[152:155], a[224:227], v[204:207], v[152:155]
  v_mfma_f32_16x16x32_bf16 v[156:159], a[224:227], v[224:227], v[156:159]
  v_mfma_f32_16x16x32_bf16 v[160:163], a[228:231], v[204:207], v[160:163]
  v_mfma_f32_16x16x32_bf16 v[164:167], a[228:231], v[224:227], v[164:167]
  v_mfma_f32_16x16x32_bf16 v[168:171], a[232:235], v[204:207], v[168:171]
  v_mfma_f32_16x16x32_bf16 v[172:175], a[232:235], v[224:227], v[172:175]
  v_mfma_f32_16x16x32_bf16 v[176:179], a[236:239], v[204:207], v[176:179]
  v_mfma_f32_16x16x32_bf16 v[180:183], a[236:239], v[224:227], v[180:183]
  v_mfma_f32_16x16x32_bf16 v[144:147], a[240:243], v[208:211], v[144:147]
  v_mfma_f32_16x16x32_bf16 v[148:151], a[240:243], v[228:231], v[148:151]
  v_mfma_f32_16x16x32_bf16 v[152:155], a[244:247], v[208:211], v[152:155]
  v_mfma_f32_16x16x32_bf16 v[156:159], a[244:247], v[228:231], v[156:159]
  v_mfma_f32_16x16x32_bf16 v[160:163], a[248:251], v[208:211], v[160:163]
  v_mfma_f32_16x16x32_bf16 v[164:167], a[248:251], v[228:231], v[164:167]
  v_mfma_f32_16x16x32_bf16 v[168:171], a[252:255], v[208:211], v[168:171]
  v_mfma_f32_16x16x32_bf16 v[172:175], a[252:255], v[228:231], v[172:175]
  v_mfma_f32_16x16x32_bf16 v[176:179], v[252:255], v[208:211], v[176:179]
  v_mfma_f32_16x16x32_bf16 v[180:183], v[252:255], v[228:231], v[180:183]
  ds_write_b128 v10, v[144:147] offset:40960
  ds_write_b128 v10, v[148:151] offset:41984
  ds_write_b128 v10, v[152:155] offset:43008
  ds_write_b128 v10, v[156:159] offset:44032
  ds_write_b128 v10, v[160:163] offset:45056
  ds_write_b128 v10, v[164:167] offset:46080
  ds_write_b128 v10, v[168:171] offset:47104
  ds_write_b128 v10, v[172:175] offset:48128
  s_nop 1
  ds_write_b128 v10, v[176:179] offset:49152
  ds_write_b128 v10, v[180:183] offset:50176
  s_waitcnt lgkmcnt(0)
  s_waitcnt vmcnt(40)
  buffer_load_dwordx4 v[96:99], v4, s[16:19], s47 offen sc1
  buffer_load_dwordx2 v[100:101], v5, s[16:19], s47 offen offset:2048 sc1
  buffer_load_dwordx4 v[136:139], v21, s[16:19], s47 offen offset:1024 sc1
  s_add_u32 s47, s47, 2560
  buffer_load_dwordx4 v[104:107], v4, s[16:19], s47 offen sc1
  buffer_load_dwordx2 v[108:109], v5, s[16:19], s47 offen offset:2048 sc1
  s_add_u32 s47, s47, 13824
  buffer_load_dwordx4 v[112:115], v4, s[16:19], s47 offen sc1
  buffer_load_dwordx2 v[116:117], v5, s[16:19], s47 offen offset:2048 sc1
  buffer_load_dwordx4 v[140:143], v21, s[16:19], s47 offen offset:1024 sc1
  s_add_u32 s47, s47, 2560
  buffer_load_dwordx4 v[120:123], v4, s[16:19], s47 offen sc1
  buffer_load_dwordx2 v[124:125], v5, s[16:19], s47 offen offset:2048 sc1
  s_add_u32 s47, s47, 13824
  s_add_u32 s21, s48, 16384
  buffer_load_dwordx4 v[48:51], v22, s[16:19], s48 offen offset:0 sc1
  buffer_load_dwordx4 v[56:59], v22, s[16:19], s21 offen offset:0 sc1
  buffer_load_dwordx2 v[188:189], v14, s[16:19], s48 offen offset:512 sc1
  buffer_load_dwordx4 v[52:55], v22, s[16:19], s48 offen offset:1280 sc1
  buffer_load_dwordx4 v[60:63], v22, s[16:19], s21 offen offset:1280 sc1
  buffer_load_dwordx2 v[190:191], v14, s[16:19], s48 offen offset:1792 sc1
  s_add_u32 s48, s48, 262144
  s_barrier
  ds_read_b128 v[192:195], v15 offset:0
  ds_read_b128 v[196:199], v15 offset:10240
  ds_read_b128 v[200:203], v15 offset:20480
  ds_read_b128 v[204:207], v15 offset:30720
  ds_read_b128 v[208:211], v15 offset:2048
  ds_read_b128 v[212:215], v15 offset:12288
  ds_read_b128 v[216:219], v15 offset:22528
  ds_read_b128 v[220:223], v15 offset:32768
  ds_read_b128 v[224:227], v16 offset:0
  ds_read_b128 v[228:231], v16 offset:10240
  ds_read_b128 v[232:235], v16 offset:20480
  ds_read_b128 v[236:239], v16 offset:30720
  v_sub_f32 v25, 1.0, v24
  v_cvt_pk_bf16_f32 v26, v25, v25
  v_lshlrev_b32 v25, 16, v26
  s_waitcnt lgkmcnt(8)
  v_pk_add_f32 v[192:193], v[192:193], v[196:197]
  v_pk_add_f32 v[200:201], v[200:201], v[204:205]
  v_pk_add_f32 v[194:195], v[194:195], v[198:199]
  v_pk_add_f32 v[202:203], v[202:203], v[206:207]
  v_pk_add_f32 v[240:241], v[192:193], v[200:201]
  v_cvt_pk_bf16_f32 v26, v240, v241
  v_lshlrev_b32 v240, 16, v26
  v_and_b32 v241, 0xffff0000, v26
  v_mul_f32 v240, v240, v25
  v_mul_f32 v241, v241, v25
  v_cvt_pk_bf16_f32 v26, v240, v241
  v_lshlrev_b32 v240, 16, v26
  v_and_b32 v241, 0xffff0000, v26
  v_pk_add_f32 v[242:243], v[194:195], v[202:203]
  v_cvt_pk_bf16_f32 v26, v242, v243
  v_lshlrev_b32 v242, 16, v26
  v_and_b32 v243, 0xffff0000, v26
  v_mul_f32 v242, v242, v25
  v_mul_f32 v243, v243, v25
  v_cvt_pk_bf16_f32 v26, v242, v243
  v_lshlrev_b32 v242, 16, v26
  v_and_b32 v243, 0xffff0000, v26
  s_waitcnt lgkmcnt(4)
  v_pk_add_f32 v[208:209], v[208:209], v[212:213]
  v_pk_add_f32 v[216:217], v[216:217], v[220:221]
  v_pk_add_f32 v[210:211], v[210:211], v[214:215]
  v_pk_add_f32 v[218:219], v[218:219], v[222:223]
  v_pk_add_f32 v[244:245], v[208:209], v[216:217]
  v_cvt_pk_bf16_f32 v26, v244, v245
  v_lshlrev_b32 v244, 16, v26
  v_and_b32 v245, 0xffff0000, v26
  v_mul_f32 v244, v244, v25
  v_mul_f32 v245, v245, v25
  v_cvt_pk_bf16_f32 v26, v244, v245
  v_lshlrev_b32 v244, 16, v26
  v_and_b32 v245, 0xffff0000, v26
  v_pk_add_f32 v[246:247], v[210:211], v[218:219]
  v_cvt_pk_bf16_f32 v26, v246, v247
  v_lshlrev_b32 v246, 16, v26
  v_and_b32 v247, 0xffff0000, v26
  v_mul_f32 v246, v246, v25
  v_mul_f32 v247, v247, v25
  v_cvt_pk_bf16_f32 v26, v246, v247
  v_lshlrev_b32 v246, 16, v26
  v_and_b32 v247, 0xffff0000, v26
  s_waitcnt lgkmcnt(0)
  v_pk_add_f32 v[224:225], v[224:225], v[228:229]
  v_pk_add_f32 v[232:233], v[232:233], v[236:237]
  v_pk_add_f32 v[226:227], v[226:227], v[230:231]
  v_pk_add_f32 v[234:235], v[234:235], v[238:239]
  v_pk_add_f32 v[248:249], v[224:225], v[232:233]
  v_cvt_pk_bf16_f32 v26, v248, v249
  v_lshlrev_b32 v248, 16, v26
  v_and_b32 v249, 0xffff0000, v26
  v_mul_f32 v248, v248, v25
  v_mul_f32 v249, v249, v25
  v_cvt_pk_bf16_f32 v26, v248, v249
  v_lshlrev_b32 v248, 16, v26
  v_and_b32 v249, 0xffff0000, v26
  v_pk_add_f32 v[250:251], v[226:227], v[234:235]
  v_cvt_pk_bf16_f32 v26, v250, v251
  v_lshlrev_b32 v250, 16, v26
  v_and_b32 v251, 0xffff0000, v26
  v_mul_f32 v250, v250, v25
  v_mul_f32 v251, v251, v25
  v_cvt_pk_bf16_f32 v26, v250, v251
  v_lshlrev_b32 v250, 16, v26
  v_and_b32 v251, 0xffff0000, v26
  s_barrier
  s_branch pvg_271
pvw_267:
  v_mfma_f32_16x16x32_bf16 v[144:147], a[160:163], v[192:195], 0
  v_mfma_f32_16x16x32_bf16 v[148:151], a[160:163], v[212:215], 0
  v_mfma_f32_16x16x32_bf16 v[152:155], a[164:167], v[192:195], 0
  v_mfma_f32_16x16x32_bf16 v[156:159], a[164:167], v[212:215], 0
  v_mfma_f32_16x16x32_bf16 v[160:163], a[168:171], v[192:195], 0
  v_mfma_f32_16x16x32_bf16 v[164:167], a[168:171], v[212:215], 0
  v_mfma_f32_16x16x32_bf16 v[168:171], a[172:175], v[192:195], 0
  v_mfma_f32_16x16x32_bf16 v[172:175], a[172:175], v[212:215], 0
  v_mfma_f32_16x16x32_bf16 v[176:179], a[176:179], v[192:195], 0
  v_mfma_f32_16x16x32_bf16 v[180:183], a[176:179], v[212:215], 0
  v_mfma_f32_16x16x32_bf16 v[144:147], a[180:183], v[196:199], v[144:147]
  v_mfma_f32_16x16x32_bf16 v[148:151], a[180:183], v[216:219], v[148:151]
  v_mfma_f32_16x16x32_bf16 v[152:155], a[184:187], v[196:199], v[152:155]
  v_mfma_f32_16x16x32_bf16 v[156:159], a[184:187], v[216:219], v[156:159]
  v_mfma_f32_16x16x32_bf16 v[160:163], a[188:191], v[196:199], v[160:163]
  v_mfma_f32_16x16x32_bf16 v[164:167], a[188:191], v[216:219], v[164:167]
  v_mfma_f32_16x16x32_bf16 v[168:171], a[192:195], v[196:199], v[168:171]
  v_mfma_f32_16x16x32_bf16 v[172:175], a[192:195], v[216:219], v[172:175]
  v_mfma_f32_16x16x32_bf16 v[176:179], a[196:199], v[196:199], v[176:179]
  v_mfma_f32_16x16x32_bf16 v[180:183], a[196:199], v[216:219], v[180:183]
  v_mfma_f32_16x16x32_bf16 v[144:147], a[200:203], v[200:203], v[144:147]
  v_mfma_f32_16x16x32_bf16 v[148:151], a[200:203], v[220:223], v[148:151]
  v_mfma_f32_16x16x32_bf16 v[152:155], a[204:207], v[200:203], v[152:155]
  v_mfma_f32_16x16x32_bf16 v[156:159], a[204:207], v[220:223], v[156:159]
  v_mfma_f32_16x16x32_bf16 v[160:163], a[208:211], v[200:203], v[160:163]
  v_mfma_f32_16x16x32_bf16 v[164:167], a[208:211], v[220:223], v[164:167]
  v_mfma_f32_16x16x32_bf16 v[168:171], a[212:215], v[200:203], v[168:171]
  v_mfma_f32_16x16x32_bf16 v[172:175], a[212:215], v[220:223], v[172:175]
  v_mfma_f32_16x16x32_bf16 v[176:179], a[216:219], v[200:203], v[176:179]
  v_mfma_f32_16x16x32_bf16 v[180:183], a[216:219], v[220:223], v[180:183]
  v_mfma_f32_16x16x32_bf16 v[144:147], a[220:223], v[204:207], v[144:147]
  v_mfma_f32_16x16x32_bf16 v[148:151], a[220:223], v[224:227], v[148:151]
  v_mfma_f32_16x16x32_bf16 v[152:155], a[224:227], v[204:207], v[152:155]
  v_mfma_f32_16x16x32_bf16 v[156:159], a[224:227], v[224:227], v[156:159]
  v_mfma_f32_16x16x32_bf16 v[160:163], a[228:231], v[204:207], v[160:163]
  v_mfma_f32_16x16x32_bf16 v[164:167], a[228:231], v[224:227], v[164:167]
  v_mfma_f32_16x16x32_bf16 v[168:171], a[232:235], v[204:207], v[168:171]
  v_mfma_f32_16x16x32_bf16 v[172:175], a[232:235], v[224:227], v[172:175]
  v_mfma_f32_16x16x32_bf16 v[176:179], a[236:239], v[204:207], v[176:179]
  v_mfma_f32_16x16x32_bf16 v[180:183], a[236:239], v[224:227], v[180:183]
  v_mfma_f32_16x16x32_bf16 v[144:147], a[240:243], v[208:211], v[144:147]
  v_mfma_f32_16x16x32_bf16 v[148:151], a[240:243], v[228:231], v[148:151]
  v_mfma_f32_16x16x32_bf16 v[152:155], a[244:247], v[208:211], v[152:155]
  v_mfma_f32_16x16x32_bf16 v[156:159], a[244:247], v[228:231], v[156:159]
  v_mfma_f32_16x16x32_bf16 v[160:163], a[248:251], v[208:211], v[160:163]
  v_mfma_f32_16x16x32_bf16 v[164:167], a[248:251], v[228:231], v[164:167]
  v_mfma_f32_16x16x32_bf16 v[168:171], a[252:255], v[208:211], v[168:171]
  v_mfma_f32_16x16x32_bf16 v[172:175], a[252:255], v[228:231], v[172:175]
  v_mfma_f32_16x16x32_bf16 v[176:179], v[252:255], v[208:211], v[176:179]
  v_mfma_f32_16x16x32_bf16 v[180:183], v[252:255], v[228:231], v[180:183]
  ds_write_b128 v10, v[144:147] offset:40960
  ds_write_b128 v10, v[148:151] offset:41984
  ds_write_b128 v10, v[152:155] offset:43008
  ds_write_b128 v10, v[156:159] offset:44032
  ds_write_b128 v10, v[160:163] offset:45056
  ds_write_b128 v10, v[164:167] offset:46080
  ds_write_b128 v10, v[168:171] offset:47104
  ds_write_b128 v10, v[172:175] offset:48128
  s_nop 1
  ds_write_b128 v10, v[176:179] offset:49152
  ds_write_b128 v10, v[180:183] offset:50176
  s_waitcnt lgkmcnt(0)
  s_barrier
  ds_read_b128 v[192:195], v15 offset:0
  ds_read_b128 v[196:199], v15 offset:10240
  ds_read_b128 v[200:203], v15 offset:20480
  ds_read_b128 v[204:207], v15 offset:30720
  ds_read_b128 v[208:211], v15 offset:2048
  ds_read_b128 v[212:215], v15 offset:12288
  ds_read_b128 v[216:219], v15 offset:22528
  ds_read_b128 v[220:223], v15 offset:32768
  ds_read_b128 v[224:227], v16 offset:0
  ds_read_b128 v[228:231], v16 offset:10240
  ds_read_b128 v[232:235], v16 offset:20480
  ds_read_b128 v[236:239], v16 offset:30720
  v_sub_f32 v25, 1.0, v24
  v_cvt_pk_bf16_f32 v26, v25, v25
  v_lshlrev_b32 v25, 16, v26
  s_waitcnt lgkmcnt(8)
  v_pk_add_f32 v[192:193], v[192:193], v[196:197]
  v_pk_add_f32 v[200:201], v[200:201], v[204:205]
  v_pk_add_f32 v[194:195], v[194:195], v[198:199]
  v_pk_add_f32 v[202:203], v[202:203], v[206:207]
  v_pk_add_f32 v[240:241], v[192:193], v[200:201]
  v_cvt_pk_bf16_f32 v26, v240, v241
  v_lshlrev_b32 v240, 16, v26
  v_and_b32 v241, 0xffff0000, v26
  v_mul_f32 v240, v240, v25
  v_mul_f32 v241, v241, v25
  v_cvt_pk_bf16_f32 v26, v240, v241
  v_lshlrev_b32 v240, 16, v26
  v_and_b32 v241, 0xffff0000, v26
  v_pk_add_f32 v[242:243], v[194:195], v[202:203]
  v_cvt_pk_bf16_f32 v26, v242, v243
  v_lshlrev_b32 v242, 16, v26
  v_and_b32 v243, 0xffff0000, v26
  v_mul_f32 v242, v242, v25
  v_mul_f32 v243, v243, v25
  v_cvt_pk_bf16_f32 v26, v242, v243
  v_lshlrev_b32 v242, 16, v26
  v_and_b32 v243, 0xffff0000, v26
  s_waitcnt lgkmcnt(4)
  v_pk_add_f32 v[208:209], v[208:209], v[212:213]
  v_pk_add_f32 v[216:217], v[216:217], v[220:221]
  v_pk_add_f32 v[210:211], v[210:211], v[214:215]
  v_pk_add_f32 v[218:219], v[218:219], v[222:223]
  v_pk_add_f32 v[244:245], v[208:209], v[216:217]
  v_cvt_pk_bf16_f32 v26, v244, v245
  v_lshlrev_b32 v244, 16, v26
  v_and_b32 v245, 0xffff0000, v26
  v_mul_f32 v244, v244, v25
  v_mul_f32 v245, v245, v25
  v_cvt_pk_bf16_f32 v26, v244, v245
  v_lshlrev_b32 v244, 16, v26
  v_and_b32 v245, 0xffff0000, v26
  v_pk_add_f32 v[246:247], v[210:211], v[218:219]
  v_cvt_pk_bf16_f32 v26, v246, v247
  v_lshlrev_b32 v246, 16, v26
  v_and_b32 v247, 0xffff0000, v26
  v_mul_f32 v246, v246, v25
  v_mul_f32 v247, v247, v25
  v_cvt_pk_bf16_f32 v26, v246, v247
  v_lshlrev_b32 v246, 16, v26
  v_and_b32 v247, 0xffff0000, v26
  s_waitcnt lgkmcnt(0)
  v_pk_add_f32 v[224:225], v[224:225], v[228:229]
  v_pk_add_f32 v[232:233], v[232:233], v[236:237]
  v_pk_add_f32 v[226:227], v[226:227], v[230:231]
  v_pk_add_f32 v[234:235], v[234:235], v[238:239]
  v_pk_add_f32 v[248:249], v[224:225], v[232:233]
  v_cvt_pk_bf16_f32 v26, v248, v249
  v_lshlrev_b32 v248, 16, v26
  v_and_b32 v249, 0xffff0000, v26
  v_mul_f32 v248, v248, v25
  v_mul_f32 v249, v249, v25
  v_cvt_pk_bf16_f32 v26, v248, v249
  v_lshlrev_b32 v248, 16, v26
  v_and_b32 v249, 0xffff0000, v26
  v_pk_add_f32 v[250:251], v[226:227], v[234:235]
  v_cvt_pk_bf16_f32 v26, v250, v251
  v_lshlrev_b32 v250, 16, v26
  v_and_b32 v251, 0xffff0000, v26
  v_mul_f32 v250, v250, v25
  v_mul_f32 v251, v251, v25
  v_cvt_pk_bf16_f32 v26, v250, v251
  v_lshlrev_b32 v250, 16, v26
  v_and_b32 v251, 0xffff0000, v26
  s_cmp_ge_u32 s40, 56
  s_cbranch_scc1 pvt_272
  s_cmp_lg_u32 s20, 0
  s_cbranch_scc1 wr_274
  s_mov_b32 s101, 0
wr_273:
  buffer_load_dword v26, v18, s[72:75], 0 offen sc1
  s_add_u32 s101, s101, 1
  s_cmp_gt_u32 s101, 131072
  s_cbranch_scc1 main_end
  s_waitcnt vmcnt(0)
  v_cmp_gt_u32 vcc, v19, v26
  v_readfirstlane_b32 s100, v26
  s_nop 0
  s_cbranch_vccz wr_274
  s_sleep 2
  s_cmp_lg_u32 s100, 0
  s_cbranch_scc1 wr_273
  s_sleep 24
  s_branch wr_273
wr_274:
  s_barrier
  buffer_load_dwordx4 v[64:67], v4, s[16:19], s47 offen sc1
  buffer_load_dwordx2 v[68:69], v5, s[16:19], s47 offen offset:2048 sc1
  buffer_load_dwordx4 v[128:131], v21, s[16:19], s47 offen offset:1024 sc1
  s_add_u32 s47, s47, 2560
  buffer_load_dwordx4 v[72:75], v4, s[16:19], s47 offen sc1
  buffer_load_dwordx2 v[76:77], v5, s[16:19], s47 offen offset:2048 sc1
  s_add_u32 s47, s47, 13824
  buffer_load_dwordx4 v[80:83], v4, s[16:19], s47 offen sc1
  buffer_load_dwordx2 v[84:85], v5, s[16:19], s47 offen offset:2048 sc1
  buffer_load_dwordx4 v[132:135], v21, s[16:19], s47 offen offset:1024 sc1
  s_add_u32 s47, s47, 2560
  buffer_load_dwordx4 v[88:91], v4, s[16:19], s47 offen sc1
  buffer_load_dwordx2 v[92:93], v5, s[16:19], s47 offen offset:2048 sc1
  s_add_u32 s47, s47, 13824
  s_add_u32 s21, s48, 16384
  buffer_load_dwordx4 v[32:35], v22, s[16:19], s48 offen offset:0 sc1
  buffer_load_dwordx4 v[40:43], v22, s[16:19], s21 offen offset:0 sc1
  buffer_load_dwordx2 v[184:185], v14, s[16:19], s48 offen offset:512 sc1
  buffer_load_dwordx4 v[36:39], v22, s[16:19], s48 offen offset:1280 sc1
  buffer_load_dwordx4 v[44:47], v22, s[16:19], s21 offen offset:1280 sc1
  buffer_load_dwordx2 v[186:187], v14, s[16:19], s48 offen offset:1792 sc1
  s_add_u32 s48, s48, 262144
  s_waitcnt vmcnt(40)
  buffer_load_dwordx4 v[96:99], v4, s[16:19], s47 offen sc1
  buffer_load_dwordx2 v[100:101], v5, s[16:19], s47 offen offset:2048 sc1
  buffer_load_dwordx4 v[136:139], v21, s[16:19], s47 offen offset:1024 sc1
  s_add_u32 s47, s47, 2560
  buffer_load_dwordx4 v[104:107], v4, s[16:19], s47 offen sc1
  buffer_load_dwordx2 v[108:109], v5, s[16:19], s47 offen offset:2048 sc1
  s_add_u32 s47, s47, 13824
  buffer_load_dwordx4 v[112:115], v4, s[16:19], s47 offen sc1
  buffer_load_dwordx2 v[116:117], v5, s[16:19], s47 offen offset:2048 sc1
  buffer_load_dwordx4 v[140:143], v21, s[16:19], s47 offen offset:1024 sc1
  s_add_u32 s47, s47, 2560
  buffer_load_dwordx4 v[120:123], v4, s[16:19], s47 offen sc1
  buffer_load_dwordx2 v[124:125], v5, s[16:19], s47 offen offset:2048 sc1
  s_add_u32 s47, s47, 13824
  s_add_u32 s21, s48, 16384
  buffer_load_dwordx4 v[48:51], v22, s[16:19], s48 offen offset:0 sc1
  buffer_load_dwordx4 v[56:59], v22, s[16:19], s21 offen offset:0 sc1
  buffer_load_dwordx2 v[188:189], v14, s[16:19], s48 offen offset:512 sc1
  buffer_load_dwordx4 v[52:55], v22, s[16:19], s48 offen offset:1280 sc1
  buffer_load_dwordx4 v[60:63], v22, s[16:19], s21 offen offset:1280 sc1
  buffer_load_dwordx2 v[190:191], v14, s[16:19], s48 offen offset:1792 sc1
  s_add_u32 s48, s48, 262144
pvg_271:
  s_waitcnt vmcnt(30)
  v_mfma_f32_16x16x32_bf16 v[148:151], a[0:3], v[64:67], 0
  v_mfma_f32_16x16x32_bf16 v[144:147], a[0:3], v[68:71], 0
  v_mfma_f32_16x16x32_bf16 v[156:159], a[4:7], v[64:67], 0
  v_mfma_f32_16x16x32_bf16 v[152:155], a[4:7], v[68:71], 0
  v_mfma_f32_16x16x32_bf16 v[164:167], a[8:11], v[64:67], 0
  v_mfma_f32_16x16x32_bf16 v[160:163], a[8:11], v[68:71], 0
  v_mfma_f32_16x16x32_bf16 v[172:175], a[12:15], v[64:67], 0
  v_mfma_f32_16x16x32_bf16 v[168:171], a[12:15], v[68:71], 0
  v_mfma_f32_16x16x32_bf16 v[180:183], a[16:19], v[64:67], 0
  v_mfma_f32_16x16x32_bf16 v[176:179], a[16:19], v[68:71], 0
  s_waitcnt vmcnt(27)
  v_mfma_f32_16x16x32_bf16 v[148:151], a[20:23], v[72:75], v[148:151]
  v_mfma_f32_16x16x32_bf16 v[144:147], a[20:23], v[76:79], v[144:147]
  v_mfma_f32_16x16x32_bf16 v[156:159], a[24:27], v[72:75], v[156:159]
  v_mfma_f32_16x16x32_bf16 v[152:155], a[24:27], v[76:79], v[152:155]
  v_mfma_f32_16x16x32_bf16 v[164:167], a[28:31], v[72:75], v[164:167]
  v_mfma_f32_16x16x32_bf16 v[160:163], a[28:31], v[76:79], v[160:163]
  v_mfma_f32_16x16x32_bf16 v[172:175], a[32:35], v[72:75], v[172:175]
  v_mfma_f32_16x16x32_bf16 v[168:171], a[32:35], v[76:79], v[168:171]
  v_mfma_f32_16x16x32_bf16 v[180:183], a[36:39], v[72:75], v[180:183]
  v_mfma_f32_16x16x32_bf16 v[176:179], a[36:39], v[76:79], v[176:179]
  s_waitcnt vmcnt(25)
  v_mfma_f32_16x16x32_bf16 v[148:151], a[40:43], v[80:83], v[148:151]
  v_mfma_f32_16x16x32_bf16 v[144:147], a[40:43], v[84:87], v[144:147]
  v_mfma_f32_16x16x32_bf16 v[156:159], a[44:47], v[80:83], v[156:159]
  v_mfma_f32_16x16x32_bf16 v[152:155], a[44:47], v[84:87], v[152:155]
  v_mfma_f32_16x16x32_bf16 v[164:167], a[48:51], v[80:83], v[164:167]
  v_mfma_f32_16x16x32_bf16 v[160:163], a[48:51], v[84:87], v[160:163]
  v_mfma_f32_16x16x32_bf16 v[172:175], a[52:55], v[80:83], v[172:175]
  v_mfma_f32_16x16x32_bf16 v[168:171], a[52:55], v[84:87], v[168:171]
  v_mfma_f32_16x16x32_bf16 v[180:183], a[56:59], v[80:83], v[180:183]
  v_mfma_f32_16x16x32_bf16 v[176:179], a[56:59], v[84:87], v[176:179]
  s_waitcnt vmcnt(22)
  v_mfma_f32_16x16x32_bf16 v[148:151], a[60:63], v[88:91], v[148:151]
  v_mfma_f32_16x16x32_bf16 v[144:147], a[60:63], v[92:95], v[144:147]
  v_mfma_f32_16x16x32_bf16 v[156:159], a[64:67], v[88:91], v[156:159]
  v_mfma_f32_16x16x32_bf16 v[152:155], a[64:67], v[92:95], v[152:155]
  v_mfma_f32_16x16x32_bf16 v[164:167], a[68:71], v[88:91], v[164:167]
  v_mfma_f32_16x16x32_bf16 v[160:163], a[68:71], v[92:95], v[160:163]
  v_mfma_f32_16x16x32_bf16 v[172:175], a[72:75], v[88:91], v[172:175]
  v_mfma_f32_16x16x32_bf16 v[168:171], a[72:75], v[92:95], v[168:171]
  v_mfma_f32_16x16x32_bf16 v[180:183], a[76:79], v[88:91], v[180:183]
  v_mfma_f32_16x16x32_bf16 v[176:179], a[76:79], v[92:95], v[176:179]
  s_waitcnt vmcnt(16)
  v_swap_b32 v130, v132
  v_swap_b32 v131, v133
  v_swap_b32 v34, v36
  v_swap_b32 v35, v37
  v_swap_b32 v42, v44
  v_swap_b32 v43, v45
  s_nop 1
  v_mfma_f32_16x16x32_bf16 v[144:147], v[32:35], v[128:131], v[144:147]
  v_mfma_f32_16x16x32_bf16 v[148:151], v[32:35], v[132:135], v[148:151]
  v_mfma_f32_16x16x32_bf16 v[152:155], v[36:39], v[128:131], v[152:155]
  v_mfma_f32_16x16x32_bf16 v[156:159], v[36:39], v[132:135], v[156:159]
  v_mfma_f32_16x16x32_bf16 v[160:163], v[184:187], v[128:131], v[160:163]
  v_mfma_f32_16x16x32_bf16 v[164:167], v[184:187], v[132:135], v[164:167]
  v_mfma_f32_16x16x32_bf16 v[168:171], v[40:43], v[128:131], v[168:171]
  v_mfma_f32_16x16x32_bf16 v[172:175], v[40:43], v[132:135], v[172:175]
  v_mfma_f32_16x16x32_bf16 v[176:179], v[44:47], v[128:131], v[176:179]
  v_mfma_f32_16x16x32_bf16 v[180:183], v[44:47], v[132:135], v[180:183]
  s_waitcnt vmcnt(14)
  v_mfma_f32_16x16x32_bf16 v[148:151], a[80:83], v[96:99], v[148:151]
  v_mfma_f32_16x16x32_bf16 v[144:147], a[80:83], v[100:103], v[144:147]
  v_mfma_f32_16x16x32_bf16 v[156:159], a[84:87], v[96:99], v[156:159]
  v_mfma_f32_16x16x32_bf16 v[152:155], a[84:87], v[100:103], v[152:155]
  v_mfma_f32_16x16x32_bf16 v[164:167], a[88:91], v[96:99], v[164:167]
  v_mfma_f32_16x16x32_bf16 v[160:163], a[88:91], v[100:103], v[160:163]
  v_mfma_f32_16x16x32_bf16 v[172:175], a[92:95], v[96:99], v[172:175]
  v_mfma_f32_16x16x32_bf16 v[168:171], a[92:95], v[100:103], v[168:171]
  v_mfma_f32_16x16x32_bf16 v[180:183], a[96:99], v[96:99], v[180:183]
  v_mfma_f32_16x16x32_bf16 v[176:179], a[96:99], v[100:103], v[176:179]
  s_waitcnt vmcnt(11)
  v_mfma_f32_16x16x32_bf16 v[148:151], a[100:103], v[104:107], v[148:151]
  v_mfma_f32_16x16x32_bf16 v[144:147], a[100:103], v[108:111], v[144:147]
  v_mfma_f32_16x16x32_bf16 v[156:159], a[104:107], v[104:107], v[156:159]
  v_mfma_f32_16x16x32_bf16 v[152:155], a[104:107], v[108:111], v[152:155]
  v_mfma_f32_16x16x32_bf16 v[164:167], a[108:111], v[104:107], v[164:167]
  v_mfma_f32_16x16x32_bf16 v[160:163], a[108:111], v[108:111], v[160:163]
  v_mfma_f32_16x16x32_bf16 v[172:175], a[112:115], v[104:107], v[172:175]
  v_mfma_f32_16x16x32_bf16 v[168:171], a[112:115], v[108:111], v[168:171]
  v_mfma_f32_16x16x32_bf16 v[180:183], a[116:119], v[104:107], v[180:183]
  v_mfma_f32_16x16x32_bf16 v[176:179], a[116:119], v[108:111], v[176:179]
  s_waitcnt vmcnt(9)
  v_mfma_f32_16x16x32_bf16 v[148:151], a[120:123], v[112:115], v[148:151]
  v_mfma_f32_16x16x32_bf16 v[144:147], a[120:123], v[116:119], v[144:147]
  v_mfma_f32_16x16x32_bf16 v[156:159], a[124:127], v[112:115], v[156:159]
  v_mfma_f32_16x16x32_bf16 v[152:155], a[124:127], v[116:119], v[152:155]
  v_mfma_f32_16x16x32_bf16 v[164:167], a[128:131], v[112:115], v[164:167]
  v_mfma_f32_16x16x32_bf16 v[160:163], a[128:131], v[116:119], v[160:163]
  v_mfma_f32_16x16x32_bf16 v[172:175], a[132:135], v[112:115], v[172:175]
  v_mfma_f32_16x16x32_bf16 v[168:171], a[132:135], v[116:119], v[168:171]
  v_mfma_f32_16x16x32_bf16 v[180:183], a[136:139], v[112:115], v[180:183]
  v_mfma_f32_16x16x32_bf16 v[176:179], a[136:139], v[116:119], v[176:179]
  s_waitcnt vmcnt(6)
  v_mfma_f32_16x16x32_bf16 v[148:151], a[140:143], v[120:123], v[148:151]
  v_mfma_f32_16x16x32_bf16 v[144:147], a[140:143], v[124:127], v[144:147]
  v_mfma_f32_16x16x32_bf16 v[156:159], a[144:147], v[120:123], v[156:159]
  v_mfma_f32_16x16x32_bf16 v[152:155], a[144:147], v[124:127], v[152:155]
  v_mfma_f32_16x16x32_bf16 v[164:167], a[148:151], v[120:123], v[164:167]
  v_mfma_f32_16x16x32_bf16 v[160:163], a[148:151], v[124:127], v[160:163]
  v_mfma_f32_16x16x32_bf16 v[172:175], a[152:155], v[120:123], v[172:175]
  v_mfma_f32_16x16x32_bf16 v[168:171], a[152:155], v[124:127], v[168:171]
  v_mfma_f32_16x16x32_bf16 v[180:183], a[156:159], v[120:123], v[180:183]
  v_mfma_f32_16x16x32_bf16 v[176:179], a[156:159], v[124:127], v[176:179]
  s_waitcnt vmcnt(0)
  v_swap_b32 v138, v140
  v_swap_b32 v139, v141
  v_swap_b32 v50, v52
  v_swap_b32 v51, v53
  v_swap_b32 v58, v60
  v_swap_b32 v59, v61
  s_nop 1
  v_mfma_f32_16x16x32_bf16 v[144:147], v[48:51], v[136:139], v[144:147]
  v_mfma_f32_16x16x32_bf16 v[148:151], v[48:51], v[140:143], v[148:151]
  v_mfma_f32_16x16x32_bf16 v[152:155], v[52:55], v[136:139], v[152:155]
  v_mfma_f32_16x16x32_bf16 v[156:159], v[52:55], v[140:143], v[156:159]
  v_mfma_f32_16x16x32_bf16 v[160:163], v[188:191], v[136:139], v[160:163]
  v_mfma_f32_16x16x32_bf16 v[164:167], v[188:191], v[140:143], v[164:167]
  v_mfma_f32_16x16x32_bf16 v[168:171], v[56:59], v[136:139], v[168:171]
  v_mfma_f32_16x16x32_bf16 v[172:175], v[56:59], v[140:143], v[172:175]
  v_mfma_f32_16x16x32_bf16 v[176:179], v[60:63], v[136:139], v[176:179]
  v_mfma_f32_16x16x32_bf16 v[180:183], v[60:63], v[140:143], v[180:183]
  s_branch pve_268
pvt_272:
  s_min_u32 s21, s40, 62
  v_mov_b32 v19, s21
  v_add_u32 v18, s52, v17
  s_cmp_lg_u32 s20, 0
  s_cbranch_scc1 wr_276
  s_mov_b32 s101, 0
wr_275:
  buffer_load_dword v26, v18, s[72:75], 0 offen sc1
  s_add_u32 s101, s101, 1
  s_cmp_gt_u32 s101, 131072
  s_cbranch_scc1 main_end
  s_waitcnt vmcnt(0)
  v_cmp_gt_u32 vcc, v19, v26
  v_readfirstlane_b32 s100, v26
  s_nop 0
  s_cbranch_vccz wr_276
  s_sleep 6
  s_cmp_lg_u32 s100, 0
  s_cbranch_scc1 wr_275
  s_sleep 0
  s_branch wr_275
wr_276:
  s_barrier
  s_mov_b32 s57, s48
  s_add_u32 s21, s57, 16384
  buffer_load_dwordx4 v[32:35], v22, s[16:19], s57 offen offset:0 sc1
  buffer_load_dwordx4 v[40:43], v22, s[16:19], s21 offen offset:0 sc1
  buffer_load_dwordx2 v[184:185], v14, s[16:19], s57 offen offset:512 sc1
  buffer_load_dwordx4 v[36:39], v22, s[16:19], s57 offen offset:1280 sc1
  buffer_load_dwordx4 v[44:47], v22, s[16:19], s21 offen offset:1280 sc1
  buffer_load_dwordx2 v[186:187], v14, s[16:19], s57 offen offset:1792 sc1
  s_add_u32 s57, s57, 262144
  s_add_u32 s21, s57, 16384
  buffer_load_dwordx4 v[48:51], v22, s[16:19], s57 offen offset:0 sc1
  buffer_load_dwordx4 v[56:59], v22, s[16:19], s21 offen offset:0 sc1
  buffer_load_dwordx2 v[188:189], v14, s[16:19], s57 offen offset:512 sc1
  buffer_load_dwordx4 v[52:55], v22, s[16:19], s57 offen offset:1280 sc1
  buffer_load_dwordx4 v[60:63], v22, s[16:19], s21 offen offset:1280 sc1
  buffer_load_dwordx2 v[190:191], v14, s[16:19], s57 offen offset:1792 sc1
  s_add_u32 s57, s57, 262144
  s_mov_b32 s101, 0
  s_waitcnt vmcnt(0)
  s_branch pvr_278
pvr_277:
  s_sleep 6
  s_mov_b32 s57, s48
  s_add_u32 s21, s57, 16384
  buffer_load_dwordx4 v[32:35], v22, s[16:19], s57 offen offset:0 sc1
  buffer_load_dwordx4 v[40:43], v22, s[16:19], s21 offen offset:0 sc1
  buffer_load_dwordx2 v[184:185], v14, s[16:19], s57 offen offset:512 sc1
  buffer_load_dwordx4 v[36:39], v22, s[16:19], s57 offen offset:1280 sc1
  buffer_load_dwordx4 v[44:47], v22, s[16:19], s21 offen offset:1280 sc1
  buffer_load_dwordx2 v[186:187], v14, s[16:19], s57 offen offset:1792 sc1
  s_add_u32 s57, s57, 262144
  s_add_u32 s21, s57, 16384
  buffer_load_dwordx4 v[48:51], v22, s[16:19], s57 offen offset:0 sc1
  buffer_load_dwordx4 v[56:59], v22, s[16:19], s21 offen offset:0 sc1
  buffer_load_dwordx2 v[188:189], v14, s[16:19], s57 offen offset:512 sc1
  buffer_load_dwordx4 v[52:55], v22, s[16:19], s57 offen offset:1280 sc1
  buffer_load_dwordx4 v[60:63], v22, s[16:19], s21 offen offset:1280 sc1
  buffer_load_dwordx2 v[190:191], v14, s[16:19], s57 offen offset:1792 sc1
  s_add_u32 s57, s57, 262144
  s_add_u32 s101, s101, 1
  s_cmp_gt_u32 s101, 131072
  s_cbranch_scc1 main_end
  s_waitcnt vmcnt(0)
pvr_278:
  v_max3_u32 v26, v32, v36, v40
  v_max3_u32 v26, v26, v44, v184
  v_max3_u32 v26, v26, v186, v48
  v_max3_u32 v26, v26, v52, v56
  v_max3_u32 v26, v26, v60, v188
  v_max3_u32 v26, v26, v190, v190
  v_cmp_eq_u32 vcc, -1, v26
  s_nop 1
  s_cbranch_vccnz pvr_277
  s_add_u32 s56, s47, 0
  buffer_load_dwordx4 v[64:67], v4, s[16:19], s56 offen sc1
  buffer_load_dwordx2 v[68:69], v5, s[16:19], s56 offen offset:2048 sc1
  buffer_load_dwordx4 v[128:131], v21, s[16:19], s56 offen offset:1024 sc1
  s_add_u32 s56, s56, 2560
  buffer_load_dwordx4 v[72:75], v4, s[16:19], s56 offen sc1
  buffer_load_dwordx2 v[76:77], v5, s[16:19], s56 offen offset:2048 sc1
  s_add_u32 s56, s56, 13824
  buffer_load_dwordx4 v[80:83], v4, s[16:19], s56 offen sc1
  buffer_load_dwordx2 v[84:85], v5, s[16:19], s56 offen offset:2048 sc1
  buffer_load_dwordx4 v[132:135], v21, s[16:19], s56 offen offset:1024 sc1
  s_add_u32 s56, s56, 2560
  buffer_load_dwordx4 v[88:91], v4, s[16:19], s56 offen sc1
  buffer_load_dwordx2 v[92:93], v5, s[16:19], s56 offen offset:2048 sc1
  s_add_u32 s56, s56, 13824
  s_mov_b32 s101, 0
  s_waitcnt vmcnt(0)
  s_branch pvr_280
pvr_279:
  s_sleep 2
  s_add_u32 s56, s47, 0
  buffer_load_dwordx4 v[64:67], v4, s[16:19], s56 offen sc1
  buffer_load_dwordx2 v[68:69], v5, s[16:19], s56 offen offset:2048 sc1
  buffer_load_dwordx4 v[128:131], v21, s[16:19], s56 offen offset:1024 sc1
  s_add_u32 s56, s56, 2560
  buffer_load_dwordx4 v[72:75], v4, s[16:19], s56 offen sc1
  buffer_load_dwordx2 v[76:77], v5, s[16:19], s56 offen offset:2048 sc1
  s_add_u32 s56, s56, 13824
  buffer_load_dwordx4 v[80:83], v4, s[16:19], s56 offen sc1
  buffer_load_dwordx2 v[84:85], v5, s[16:19], s56 offen offset:2048 sc1
  buffer_load_dwordx4 v[132:135], v21, s[16:19], s56 offen offset:1024 sc1
  s_add_u32 s56, s56, 2560
  buffer_load_dwordx4 v[88:91], v4, s[16:19], s56 offen sc1
  buffer_load_dwordx2 v[92:93], v5, s[16:19], s56 offen offset:2048 sc1
  s_add_u32 s56, s56, 13824
  s_add_u32 s101, s101, 1
  s_cmp_gt_u32 s101, 131072
  s_cbranch_scc1 main_end
  s_waitcnt vmcnt(0)
pvr_280:
  v_max3_u32 v26, v64, v68, v72
  v_max3_u32 v26, v26, v76, v80
  v_max3_u32 v26, v26, v84, v88
  v_max3_u32 v26, v26, v92, v128
  v_max3_u32 v26, v26, v132, v132
  v_cmp_eq_u32 vcc, -1, v26
  s_nop 1
  s_cbranch_vccnz pvr_279
  s_add_u32 s56, s47, 32768
  buffer_load_dwordx4 v[96:99], v4, s[16:19], s56 offen sc1
  buffer_load_dwordx2 v[100:101], v5, s[16:19], s56 offen offset:2048 sc1
  buffer_load_dwordx4 v[136:139], v21, s[16:19], s56 offen offset:1024 sc1
  s_add_u32 s56, s56, 2560
  buffer_load_dwordx4 v[104:107], v4, s[16:19], s56 offen sc1
  buffer_load_dwordx2 v[108:109], v5, s[16:19], s56 offen offset:2048 sc1
  s_add_u32 s56, s56, 13824
  buffer_load_dwordx4 v[112:115], v4, s[16:19], s56 offen sc1
  buffer_load_dwordx2 v[116:117], v5, s[16:19], s56 offen offset:2048 sc1
  buffer_load_dwordx4 v[140:143], v21, s[16:19], s56 offen offset:1024 sc1
  s_add_u32 s56, s56, 2560
  buffer_load_dwordx4 v[120:123], v4, s[16:19], s56 offen sc1
  buffer_load_dwordx2 v[124:125], v5, s[16:19], s56 offen offset:2048 sc1
  s_add_u32 s56, s56, 13824
  v_mfma_f32_16x16x32_bf16 v[148:151], a[0:3], v[64:67], 0
  v_mfma_f32_16x16x32_bf16 v[144:147], a[0:3], v[68:71], 0
  v_mfma_f32_16x16x32_bf16 v[156:159], a[4:7], v[64:67], 0
  v_mfma_f32_16x16x32_bf16 v[152:155], a[4:7], v[68:71], 0
  v_mfma_f32_16x16x32_bf16 v[164:167], a[8:11], v[64:67], 0
  v_mfma_f32_16x16x32_bf16 v[160:163], a[8:11], v[68:71], 0
  v_mfma_f32_16x16x32_bf16 v[172:175], a[12:15], v[64:67], 0
  v_mfma_f32_16x16x32_bf16 v[168:171], a[12:15], v[68:71], 0
  v_mfma_f32_16x16x32_bf16 v[180:183], a[16:19], v[64:67], 0
  v_mfma_f32_16x16x32_bf16 v[176:179], a[16:19], v[68:71], 0
  v_mfma_f32_16x16x32_bf16 v[148:151], a[20:23], v[72:75], v[148:151]
  v_mfma_f32_16x16x32_bf16 v[144:147], a[20:23], v[76:79], v[144:147]
  v_mfma_f32_16x16x32_bf16 v[156:159], a[24:27], v[72:75], v[156:159]
  v_mfma_f32_16x16x32_bf16 v[152:155], a[24:27], v[76:79], v[152:155]
  v_mfma_f32_16x16x32_bf16 v[164:167], a[28:31], v[72:75], v[164:167]
  v_mfma_f32_16x16x32_bf16 v[160:163], a[28:31], v[76:79], v[160:163]
  v_mfma_f32_16x16x32_bf16 v[172:175], a[32:35], v[72:75], v[172:175]
  v_mfma_f32_16x16x32_bf16 v[168:171], a[32:35], v[76:79], v[168:171]
  v_mfma_f32_16x16x32_bf16 v[180:183], a[36:39], v[72:75], v[180:183]
  v_mfma_f32_16x16x32_bf16 v[176:179], a[36:39], v[76:79], v[176:179]
  v_mfma_f32_16x16x32_bf16 v[148:151], a[40:43], v[80:83], v[148:151]
  v_mfma_f32_16x16x32_bf16 v[144:147], a[40:43], v[84:87], v[144:147]
  v_mfma_f32_16x16x32_bf16 v[156:159], a[44:47], v[80:83], v[156:159]
  v_mfma_f32_16x16x32_bf16 v[152:155], a[44:47], v[84:87], v[152:155]
  v_mfma_f32_16x16x32_bf16 v[164:167], a[48:51], v[80:83], v[164:167]
  v_mfma_f32_16x16x32_bf16 v[160:163], a[48:51], v[84:87], v[160:163]
  v_mfma_f32_16x16x32_bf16 v[172:175], a[52:55], v[80:83], v[172:175]
  v_mfma_f32_16x16x32_bf16 v[168:171], a[52:55], v[84:87], v[168:171]
  v_mfma_f32_16x16x32_bf16 v[180:183], a[56:59], v[80:83], v[180:183]
  v_mfma_f32_16x16x32_bf16 v[176:179], a[56:59], v[84:87], v[176:179]
  v_mfma_f32_16x16x32_bf16 v[148:151], a[60:63], v[88:91], v[148:151]
  v_mfma_f32_16x16x32_bf16 v[144:147], a[60:63], v[92:95], v[144:147]
  v_mfma_f32_16x16x32_bf16 v[156:159], a[64:67], v[88:91], v[156:159]
  v_mfma_f32_16x16x32_bf16 v[152:155], a[64:67], v[92:95], v[152:155]
  v_mfma_f32_16x16x32_bf16 v[164:167], a[68:71], v[88:91], v[164:167]
  v_mfma_f32_16x16x32_bf16 v[160:163], a[68:71], v[92:95], v[160:163]
  v_mfma_f32_16x16x32_bf16 v[172:175], a[72:75], v[88:91], v[172:175]
  v_mfma_f32_16x16x32_bf16 v[168:171], a[72:75], v[92:95], v[168:171]
  v_mfma_f32_16x16x32_bf16 v[180:183], a[76:79], v[88:91], v[180:183]
  v_mfma_f32_16x16x32_bf16 v[176:179], a[76:79], v[92:95], v[176:179]
  v_swap_b32 v130, v132
  v_swap_b32 v131, v133
  v_swap_b32 v34, v36
  v_swap_b32 v35, v37
  v_swap_b32 v42, v44
  v_swap_b32 v43, v45
  s_nop 1
  v_mfma_f32_16x16x32_bf16 v[144:147], v[32:35], v[128:131], v[144:147]
  v_mfma_f32_16x16x32_bf16 v[148:151], v[32:35], v[132:135], v[148:151]
  v_mfma_f32_16x16x32_bf16 v[152:155], v[36:39], v[128:131], v[152:155]
  v_mfma_f32_16x16x32_bf16 v[156:159], v[36:39], v[132:135], v[156:159]
  v_mfma_f32_16x16x32_bf16 v[160:163], v[184:187], v[128:131], v[160:163]
  v_mfma_f32_16x16x32_bf16 v[164:167], v[184:187], v[132:135], v[164:167]
  v_mfma_f32_16x16x32_bf16 v[168:171], v[40:43], v[128:131], v[168:171]
  v_mfma_f32_16x16x32_bf16 v[172:175], v[40:43], v[132:135], v[172:175]
  v_mfma_f32_16x16x32_bf16 v[176:179], v[44:47], v[128:131], v[176:179]
  v_mfma_f32_16x16x32_bf16 v[180:183], v[44:47], v[132:135], v[180:183]
  s_mov_b32 s101, 0
  s_waitcnt vmcnt(0)
  s_branch pvr_282
pvr_281:
  s_sleep 1
  s_add_u32 s56, s47, 32768
  buffer_load_dwordx4 v[96:99], v4, s[16:19], s56 offen sc1
  buffer_load_dwordx2 v[100:101], v5, s[16:19], s56 offen offset:2048 sc1
  buffer_load_dwordx4 v[136:139], v21, s[16:19], s56 offen offset:1024 sc1
  s_add_u32 s56, s56, 2560
  buffer_load_dwordx4 v[104:107], v4, s[16:19], s56 offen sc1
  buffer_load_dwordx2 v[108:109], v5, s[16:19], s56 offen offset:2048 sc1
  s_add_u32 s56, s56, 13824
  buffer_load_dwordx4 v[112:115], v4, s[16:19], s56 offen sc1
  buffer_load_dwordx2 v[116:117], v5, s[16:19], s56 offen offset:2048 sc1
  buffer_load_dwordx4 v[140:143], v21, s[16:19], s56 offen offset:1024 sc1
  s_add_u32 s56, s56, 2560
  buffer_load_dwordx4 v[120:123], v4, s[16:19], s56 offen sc1
  buffer_load_dwordx2 v[124:125], v5, s[16:19], s56 offen offset:2048 sc1
  s_add_u32 s56, s56, 13824
  s_add_u32 s101, s101, 1
  s_cmp_gt_u32 s101, 131072
  s_cbranch_scc1 main_end
  s_waitcnt vmcnt(0)
pvr_282:
  v_max3_u32 v26, v96, v100, v104
  v_max3_u32 v26, v26, v108, v112
  v_max3_u32 v26, v26, v116, v120
  v_max3_u32 v26, v26, v124, v136
  v_max3_u32 v26, v26, v140, v140
  v_cmp_eq_u32 vcc, -1, v26
  s_nop 1
  s_cbranch_vccnz pvr_281
  v_mfma_f32_16x16x32_bf16 v[148:151], a[80:83], v[96:99], v[148:151]
  v_mfma_f32_16x16x32_bf16 v[144:147], a[80:83], v[100:103], v[144:147]
  v_mfma_f32_16x16x32_bf16 v[156:159], a[84:87], v[96:99], v[156:159]
  v_mfma_f32_16x16x32_bf16 v[152:155], a[84:87], v[100:103], v[152:155]
  v_mfma_f32_16x16x32_bf16 v[164:167], a[88:91], v[96:99], v[164:167]
  v_mfma_f32_16x16x32_bf16 v[160:163], a[88:91], v[100:103], v[160:163]
  v_mfma_f32_16x16x32_bf16 v[172:175], a[92:95], v[96:99], v[172:175]
  v_mfma_f32_16x16x32_bf16 v[168:171], a[92:95], v[100:103], v[168:171]
  v_mfma_f32_16x16x32_bf16 v[180:183], a[96:99], v[96:99], v[180:183]
  v_mfma_f32_16x16x32_bf16 v[176:179], a[96:99], v[100:103], v[176:179]
  v_mfma_f32_16x16x32_bf16 v[148:151], a[100:103], v[104:107], v[148:151]
  v_mfma_f32_16x16x32_bf16 v[144:147], a[100:103], v[108:111], v[144:147]
  v_mfma_f32_16x16x32_bf16 v[156:159], a[104:107], v[104:107], v[156:159]
  v_mfma_f32_16x16x32_bf16 v[152:155], a[104:107], v[108:111], v[152:155]
  v_mfma_f32_16x16x32_bf16 v[164:167], a[108:111], v[104:107], v[164:167]
  v_mfma_f32_16x16x32_bf16 v[160:163], a[108:111], v[108:111], v[160:163]
  v_mfma_f32_16x16x32_bf16 v[172:175], a[112:115], v[104:107], v[172:175]
  v_mfma_f32_16x16x32_bf16 v[168:171], a[112:115], v[108:111], v[168:171]
  v_mfma_f32_16x16x32_bf16 v[180:183], a[116:119], v[104:107], v[180:183]
  v_mfma_f32_16x16x32_bf16 v[176:179], a[116:119], v[108:111], v[176:179]
  v_mfma_f32_16x16x32_bf16 v[148:151], a[120:123], v[112:115], v[148:151]
  v_mfma_f32_16x16x32_bf16 v[144:147], a[120:123], v[116:119], v[144:147]
  v_mfma_f32_16x16x32_bf16 v[156:159], a[124:127], v[112:115], v[156:159]
  v_mfma_f32_16x16x32_bf16 v[152:155], a[124:127], v[116:119], v[152:155]
  v_mfma_f32_16x16x32_bf16 v[164:167], a[128:131], v[112:115], v[164:167]
  v_mfma_f32_16x16x32_bf16 v[160:163], a[128:131], v[116:119], v[160:163]
  v_mfma_f32_16x16x32_bf16 v[172:175], a[132:135], v[112:115], v[172:175]
  v_mfma_f32_16x16x32_bf16 v[168:171], a[132:135], v[116:119], v[168:171]
  v_mfma_f32_16x16x32_bf16 v[180:183], a[136:139], v[112:115], v[180:183]
  v_mfma_f32_16x16x32_bf16 v[176:179], a[136:139], v[116:119], v[176:179]
  v_mfma_f32_16x16x32_bf16 v[148:151], a[140:143], v[120:123], v[148:151]
  v_mfma_f32_16x16x32_bf16 v[144:147], a[140:143], v[124:127], v[144:147]
  v_mfma_f32_16x16x32_bf16 v[156:159], a[144:147], v[120:123], v[156:159]
  v_mfma_f32_16x16x32_bf16 v[152:155], a[144:147], v[124:127], v[152:155]
  v_mfma_f32_16x16x32_bf16 v[164:167], a[148:151], v[120:123], v[164:167]
  v_mfma_f32_16x16x32_bf16 v[160:163], a[148:151], v[124:127], v[160:163]
  v_mfma_f32_16x16x32_bf16 v[172:175], a[152:155], v[120:123], v[172:175]
  v_mfma_f32_16x16x32_bf16 v[168:171], a[152:155], v[124:127], v[168:171]
  v_mfma_f32_16x16x32_bf16 v[180:183], a[156:159], v[120:123], v[180:183]
  v_mfma_f32_16x16x32_bf16 v[176:179], a[156:159], v[124:127], v[176:179]
  v_swap_b32 v138, v140
  v_swap_b32 v139, v141
  v_swap_b32 v50, v52
  v_swap_b32 v51, v53
  v_swap_b32 v58, v60
  v_swap_b32 v59, v61
  s_nop 1
  v_mfma_f32_16x16x32_bf16 v[144:147], v[48:51], v[136:139], v[144:147]
  v_mfma_f32_16x16x32_bf16 v[148:151], v[48:51], v[140:143], v[148:151]
  v_mfma_f32_16x16x32_bf16 v[152:155], v[52:55], v[136:139], v[152:155]
  v_mfma_f32_16x16x32_bf16 v[156:159], v[52:55], v[140:143], v[156:159]
  v_mfma_f32_16x16x32_bf16 v[160:163], v[188:191], v[136:139], v[160:163]
  v_mfma_f32_16x16x32_bf16 v[164:167], v[188:191], v[140:143], v[164:167]
  v_mfma_f32_16x16x32_bf16 v[168:171], v[56:59], v[136:139], v[168:171]
  v_mfma_f32_16x16x32_bf16 v[172:175], v[56:59], v[140:143], v[172:175]
  v_mfma_f32_16x16x32_bf16 v[176:179], v[60:63], v[136:139], v[176:179]
  v_mfma_f32_16x16x32_bf16 v[180:183], v[60:63], v[140:143], v[180:183]
pve_268:
  s_nop 0
  ds_write_b128 v10, v[144:147] offset:0
  ds_write_b128 v10, v[148:151] offset:1024
  ds_write_b128 v10, v[152:155] offset:2048
  ds_write_b128 v10, v[156:159] offset:3072
  ds_write_b128 v10, v[160:163] offset:4096
  ds_write_b128 v10, v[164:167] offset:5120
  ds_write_b128 v10, v[168:171] offset:6144
  ds_write_b128 v10, v[172:175] offset:7168
  s_nop 1
  ds_write_b128 v10, v[176:179] offset:8192
  ds_write_b128 v10, v[180:183] offset:9216
  s_cmp_lg_u32 s20, 0
  s_cbranch_scc1 pvq_283
  s_mov_b64 exec, 1
  ds_write_b32 v30, v29
  s_mov_b64 exec, -1
pvq_283:
  s_waitcnt lgkmcnt(0)
  s_barrier
  ds_read_b32 v23, v30
  ds_read_b128 v[192:195], v11 offset:0
  ds_read_b128 v[196:199], v11 offset:10240
  ds_read_b128 v[200:203], v11 offset:20480
  ds_read_b128 v[204:207], v11 offset:30720
  ds_read_b128 v[208:211], v11 offset:2048
  ds_read_b128 v[212:215], v11 offset:12288
  ds_read_b128 v[216:219], v11 offset:22528
  ds_read_b128 v[220:223], v11 offset:32768
  ds_read_b128 v[224:227], v12 offset:0
  ds_read_b128 v[228:231], v12 offset:10240
  ds_read_b128 v[232:235], v12 offset:20480
  ds_read_b128 v[236:239], v12 offset:30720
  s_waitcnt lgkmcnt(8)
  v_pk_add_f32 v[192:193], v[192:193], v[196:197]
  v_pk_add_f32 v[200:201], v[200:201], v[204:205]
  v_pk_add_f32 v[194:195], v[194:195], v[198:199]
  v_pk_add_f32 v[202:203], v[202:203], v[206:207]
  v_pk_add_f32 v[192:193], v[192:193], v[200:201]
  v_pk_add_f32 v[194:195], v[194:195], v[202:203]
  v_cvt_pk_bf16_f32 v26, v192, v193
  v_lshlrev_b32 v192, 16, v26
  v_and_b32 v193, 0xffff0000, v26
  v_mul_f32 v192, v192, v24
  v_mul_f32 v193, v193, v24
  v_cvt_pk_bf16_f32 v26, v192, v193
  v_lshlrev_b32 v192, 16, v26
  v_and_b32 v193, 0xffff0000, v26
  v_add_f32 v192, v192, v240
  v_add_f32 v193, v193, v241
  v_cvt_pk_bf16_f32 v196, v192, v193
  v_cvt_pk_bf16_f32 v26, v194, v195
  v_lshlrev_b32 v194, 16, v26
  v_and_b32 v195, 0xffff0000, v26
  v_mul_f32 v194, v194, v24
  v_mul_f32 v195, v195, v24
  v_cvt_pk_bf16_f32 v26, v194, v195
  v_lshlrev_b32 v194, 16, v26
  v_and_b32 v195, 0xffff0000, v26
  v_add_f32 v194, v194, v242
  v_add_f32 v195, v195, v243
  v_cvt_pk_bf16_f32 v197, v194, v195
  s_waitcnt lgkmcnt(4)
  v_pk_add_f32 v[208:209], v[208:209], v[212:213]
  v_pk_add_f32 v[216:217], v[216:217], v[220:221]
  v_pk_add_f32 v[210:211], v[210:211], v[214:215]
  v_pk_add_f32 v[218:219], v[218:219], v[222:223]
  v_pk_add_f32 v[208:209], v[208:209], v[216:217]
  v_pk_add_f32 v[210:211], v[210:211], v[218:219]
  v_cvt_pk_bf16_f32 v26, v208, v209
  v_lshlrev_b32 v208, 16, v26
  v_and_b32 v209, 0xffff0000, v26
  v_mul_f32 v208, v208, v24
  v_mul_f32 v209, v209, v24
  v_cvt_pk_bf16_f32 v26, v208, v209
  v_lshlrev_b32 v208, 16, v26
  v_and_b32 v209, 0xffff0000, v26
  v_add_f32 v208, v208, v244
  v_add_f32 v209, v209, v245
  v_cvt_pk_bf16_f32 v198, v208, v209
  v_cvt_pk_bf16_f32 v26, v210, v211
  v_lshlrev_b32 v210, 16, v26
  v_and_b32 v211, 0xffff0000, v26
  v_mul_f32 v210, v210, v24
  v_mul_f32 v211, v211, v24
  v_cvt_pk_bf16_f32 v26, v210, v211
  v_lshlrev_b32 v210, 16, v26
  v_and_b32 v211, 0xffff0000, v26
  v_add_f32 v210, v210, v246
  v_add_f32 v211, v211, v247
  v_cvt_pk_bf16_f32 v199, v210, v211
  buffer_store_dwordx4 v[196:199], v9, s[8:11], s46 offen
  s_cmp_ge_u32 s20, 2
  s_cbranch_scc1 pvm_284
  s_waitcnt lgkmcnt(0)
  v_pk_add_f32 v[224:225], v[224:225], v[228:229]
  v_pk_add_f32 v[232:233], v[232:233], v[236:237]
  v_pk_add_f32 v[226:227], v[226:227], v[230:231]
  v_pk_add_f32 v[234:235], v[234:235], v[238:239]
  v_pk_add_f32 v[224:225], v[224:225], v[232:233]
  v_pk_add_f32 v[226:227], v[226:227], v[234:235]
  v_cvt_pk_bf16_f32 v26, v224, v225
  v_lshlrev_b32 v224, 16, v26
  v_and_b32 v225, 0xffff0000, v26
  v_mul_f32 v224, v224, v24
  v_mul_f32 v225, v225, v24
  v_cvt_pk_bf16_f32 v26, v224, v225
  v_lshlrev_b32 v224, 16, v26
  v_and_b32 v225, 0xffff0000, v26
  v_add_f32 v224, v224, v248
  v_add_f32 v225, v225, v249
  v_cvt_pk_bf16_f32 v228, v224, v225
  v_cvt_pk_bf16_f32 v26, v226, v227
  v_lshlrev_b32 v226, 16, v26
  v_and_b32 v227, 0xffff0000, v26
  v_mul_f32 v226, v226, v24
  v_mul_f32 v227, v227, v24
  v_cvt_pk_bf16_f32 v26, v226, v227
  v_lshlrev_b32 v226, 16, v26
  v_and_b32 v227, 0xffff0000, v26
  v_add_f32 v226, v226, v250
  v_add_f32 v227, v227, v251
  v_cvt_pk_bf16_f32 v229, v226, v227
  buffer_store_dwordx2 v[228:229], v13, s[8:11], s49 offen offset:64
pvm_284:
  s_waitcnt lgkmcnt(0)
  v_readfirstlane_b32 s2, v23
  s_barrier
  s_add_u32 s60, s60, 1
  s_max_u32 s21, s2, s60
  s_cmp_lt_u32 s21, 16
  s_cbranch_scc1 pv_loop
main_fin:
  s_waitcnt vmcnt(0)
main_end:
  s_endpgm
.section .rodata,"a"
.p2align 6
.amdhsa_kernel gated_mix__memory_aug_recurrent_mem_tr__sliding_local_dilated__prompt_kernel
  .amdhsa_next_free_vgpr 512
  .amdhsa_next_free_sgpr 102
  .amdhsa_accum_offset 256
  .amdhsa_group_segment_fixed_size 0
  .amdhsa_kernarg_size 112
  .amdhsa_user_sgpr_count 2
  .amdhsa_user_sgpr_kernarg_segment_ptr 1
  .amdhsa_system_sgpr_workgroup_id_x 1
.end_amdhsa_kernel
.text
```

```asm
; @launch kernel=gated_mix__memory_aug_recurrent_mem_tr__sliding_local_dilated__prompt_kernel grid=(256,1,1) block=(256,1,1) lds=163840
.amdgcn_target "amdgcn-amd-amdhsa--gfx950"
.text
.globl gated_mix__memory_aug_recurrent_mem_tr__sliding_local_dilated__prompt_kernel
.p2align 8
.type gated_mix__memory_aug_recurrent_mem_tr__sliding_local_dilated__prompt_kernel,@function
gated_mix__memory_aug_recurrent_mem_tr__sliding_local_dilated__prompt_kernel:
  s_cmp_ge_u32 s2, 256
  s_cbranch_scc1 end0
  s_load_dwordx2 s[4:5], s[0:1], 96
  s_load_dwordx2 s[38:39], s[0:1], 104
  s_load_dwordx2 s[64:65], s[0:1], 0
  v_lshrrev_b32 v1, 6, v0
  v_and_b32 v2, 15, v0
  v_readfirstlane_b32 s20, v1
  v_and_b32 v1, 63, v0
  v_lshrrev_b32 v3, 4, v1
  s_getreg_b32 s50, hwreg(HW_REG_XCC_ID)
  s_and_b32 s50, s50, 7
  s_waitcnt lgkmcnt(0)
  s_mov_b32 s32, s4
  s_mov_b32 s33, s5
  s_mov_b32 s34, 256
  s_mov_b32 s35, 0x00020000
  v_mov_b32 v21, 0
  s_cmp_lg_u32 s20, 0
  s_cbranch_scc1 rk_1
  s_and_b32 s21, s50, 1
  s_lshl_b32 s21, s21, 7
  s_lshl_b32 s22, s50, 1
  s_and_b32 s22, s22, 12
  s_add_u32 s21, s21, s22
  v_mov_b32 v22, s21
  v_mov_b32 v23, 1
  s_mov_b64 exec, 1
  buffer_atomic_add v23, v22, s[32:35], 0 offen sc0 sc1
  s_waitcnt vmcnt(0)
  v_readfirstlane_b32 s51, v23
  s_lshl_b32 s22, s50, 5
  s_add_u32 s22, s22, s51
  s_cmp_lt_u32 s51, 32
  s_cbranch_scc1 rk_2
  v_mov_b32 v24, 72
  v_mov_b32 v25, 1
  buffer_atomic_add v25, v24, s[32:35], 0 offen sc0 sc1
  s_waitcnt vmcnt(0)
  v_readfirstlane_b32 s23, v25
  s_mov_b32 s101, 0
  s_mov_b64 exec, -1
  v_lshlrev_b32 v24, 2, v1
rk_3:
  s_sleep 8
  buffer_load_dword v25, v24, s[32:35], 0 offen sc1
  s_add_u32 s101, s101, 1
  s_cmp_gt_u32 s101, 131072
  s_cbranch_scc1 end0
  s_waitcnt vmcnt(0)
  v_readlane_b32 s21, v25, 0
  v_readlane_b32 s22, v25, 32
  s_add_u32 s21, s21, s22
  v_readlane_b32 s22, v25, 1
  s_add_u32 s21, s21, s22
  v_readlane_b32 s22, v25, 33
  s_add_u32 s21, s21, s22
  v_readlane_b32 s22, v25, 2
  s_add_u32 s21, s21, s22
  v_readlane_b32 s22, v25, 34
  s_add_u32 s21, s21, s22
  v_readlane_b32 s22, v25, 3
  s_add_u32 s21, s21, s22
  v_readlane_b32 s22, v25, 35
  s_add_u32 s21, s21, s22
  s_cmp_lt_u32 s21, 256
  s_cbranch_scc1 rk_3
  s_mov_b64 exec, 1
  s_mov_b32 s24, 0
rk_5:
  s_and_b32 s21, s24, 1
  s_lshl_b32 s21, s21, 5
  s_lshr_b32 s22, s24, 1
  s_add_u32 s21, s21, s22
  v_readlane_b32 s21, v25, s21
  s_min_u32 s21, s21, 32
  s_sub_u32 s25, 32, s21
  s_cmp_lt_u32 s23, s25
  s_cbranch_scc1 rk_4
  s_sub_u32 s23, s23, s25
  s_add_u32 s24, s24, 1
  s_cmp_lt_u32 s24, 8
  s_cbranch_scc1 rk_5
  s_branch end0
rk_4:
  s_lshl_b32 s22, s24, 5
  s_add_u32 s22, s22, s21
  s_add_u32 s22, s22, s23
  s_or_b32 s22, s22, 0x100
rk_2:
  v_mov_b32 v23, s22
  ds_write_b32 v21, v23
  s_waitcnt lgkmcnt(0)
  s_mov_b64 exec, -1
rk_1:
  s_waitcnt vmcnt(0)
  s_barrier
  ds_read_b32 v23, v21
  s_waitcnt lgkmcnt(0)
  v_readfirstlane_b32 s22, v23
  s_barrier
  s_lshr_b32 s53, s22, 8
  s_and_b32 s22, s22, 255
  s_cmp_ge_u32 s22, 128
  s_cbranch_scc1 gemm_side
  s_lshr_b32 s50, s22, 4
  s_and_b32 s51, s22, 15
  s_load_dwordx2 s[4:5], s[0:1], 8
  s_load_dwordx4 s[40:43], s[0:1], 16
  s_load_dwordx4 s[44:47], s[0:1], 32
  s_load_dwordx2 s[48:49], s[0:1], 104
  s_lshr_b32 s55, s51, 2
  s_and_b32 s56, s51, 3
  s_lshl_b32 s57, s50, 2
  s_add_u32 s58, s57, s55
  s_add_u32 s59, s57, s20
  s_lshr_b32 s60, s51, 1
  s_and_b32 s61, s51, 1
  s_mul_i32 s81, s20, 40960
  v_lshlrev_b32 v4, 4, v1
  s_waitcnt lgkmcnt(0)
  s_mov_b32 s12, s44
  s_mov_b32 s13, s45
  s_mov_b32 s14, 7864320
  s_mov_b32 s15, 0x00020000
  s_mov_b32 s16, s46
  s_mov_b32 s17, s47
  s_mov_b32 s18, 7864320
  s_mov_b32 s19, 0x00020000
  s_mov_b32 s24, s40
  s_mov_b32 s25, s41
  s_mov_b32 s26, 7864320
  s_mov_b32 s27, 0x00020000
  s_mov_b32 s28, s42
  s_mov_b32 s29, s43
  s_mov_b32 s30, 7864320
  s_mov_b32 s31, 0x00020000
  s_mov_b32 s36, s4
  s_mov_b32 s37, s5
  s_mov_b32 s38, 10240
  s_mov_b32 s39, 0x00020000
  s_add_u32 s8, s48, 174063616
  s_addc_u32 s9, s49, 0
  s_mov_b32 s10, 495616
  s_mov_b32 s11, 0x00020000
  s_add_u32 s4, s48, 171966464
  s_addc_u32 s5, s49, 0
  s_mov_b32 s6, 1048576
  s_mov_b32 s7, 0x00020000
  v_add_u32 v66, 0, v1
  v_mul_u32_u24 v67, 2731, v66
  v_lshrrev_b32 v67, 16, v67
  v_mul_u32_u24 v48, 24, v67
  v_sub_u32 v66, v66, v48
  v_mul_u32_u24 v67, 12288, v67
  v_lshl_add_u32 v48, v66, 4, v67
  v_add_u32 v66, 64, v1
  v_mul_u32_u24 v67, 2731, v66
  v_lshrrev_b32 v67, 16, v67
  v_mul_u32_u24 v49, 24, v67
  v_sub_u32 v66, v66, v49
  v_mul_u32_u24 v67, 12288, v67
  v_lshl_add_u32 v49, v66, 4, v67
  v_add_u32 v66, 128, v1
  v_mul_u32_u24 v67, 2731, v66
  v_lshrrev_b32 v67, 16, v67
  v_mul_u32_u24 v50, 24, v67
  v_sub_u32 v66, v66, v50
  v_mul_u32_u24 v67, 12288, v67
  v_lshl_add_u32 v50, v66, 4, v67
  s_mul_i32 s21, s51, 491520
  s_mul_i32 s80, s59, 384
  s_add_u32 s21, s21, s80
  s_mov_b32 s23, s21
  v_add_u32 v66, 0, v1
  v_mul_u32_u24 v67, 10923, v66
  v_lshrrev_b32 v67, 16, v67
  v_mul_u32_u24 v60, 6, v67
  v_sub_u32 v66, v66, v60
  v_mul_u32_u24 v67, 1280, v67
  v_lshl_add_u32 v60, v66, 4, v67
  v_add_u32 v66, 64, v1
  v_mul_u32_u24 v67, 10923, v66
  v_lshrrev_b32 v67, 16, v67
  v_mul_u32_u24 v61, 6, v67
  v_sub_u32 v66, v66, v61
  v_mul_u32_u24 v67, 1280, v67
  v_lshl_add_u32 v61, v66, 4, v67
  v_add_u32 v66, 128, v1
  v_mul_u32_u24 v67, 10923, v66
  v_lshrrev_b32 v67, 16, v67
  v_mul_u32_u24 v62, 6, v67
  v_sub_u32 v66, v66, v62
  v_mul_u32_u24 v67, 1280, v67
  v_lshl_add_u32 v62, v66, 4, v67
  s_mul_i32 s21, s59, 245760
  s_mul_i32 s22, s60, 160
  s_add_u32 s21, s21, s22
  s_lshl_b32 s22, s61, 6
  s_add_u32 s21, s21, s22
  s_add_u32 m0, s81, 0
  s_nop 0
  buffer_load_dwordx4 v60, s[16:19], s21 offen lds
  s_add_u32 m0, s81, 1024
  s_nop 0
  buffer_load_dwordx4 v61, s[16:19], s21 offen lds
  s_add_u32 m0, s81, 2048
  s_nop 0
  buffer_load_dwordx4 v62, s[16:19], s21 offen lds
  s_add_u32 s21, s21, 40960
  s_add_u32 m0, s81, 3072
  s_nop 0
  buffer_load_dwordx4 v60, s[16:19], s21 offen lds
  s_add_u32 m0, s81, 4096
  s_nop 0
  buffer_load_dwordx4 v61, s[16:19], s21 offen lds
  s_add_u32 m0, s81, 5120
  s_nop 0
  buffer_load_dwordx4 v62, s[16:19], s21 offen lds
  s_add_u32 s21, s21, 40960
  s_add_u32 m0, s81, 6144
  s_nop 0
  buffer_load_dwordx4 v60, s[16:19], s21 offen lds
  s_add_u32 m0, s81, 7168
  s_nop 0
  buffer_load_dwordx4 v61, s[16:19], s21 offen lds
  s_add_u32 m0, s81, 8192
  s_nop 0
  buffer_load_dwordx4 v62, s[16:19], s21 offen lds
  s_add_u32 s21, s21, 40960
  s_add_u32 m0, s81, 9216
  s_nop 0
  buffer_load_dwordx4 v60, s[16:19], s21 offen lds
  s_add_u32 m0, s81, 10240
  s_nop 0
  buffer_load_dwordx4 v61, s[16:19], s21 offen lds
  s_add_u32 m0, s81, 11264
  s_nop 0
  buffer_load_dwordx4 v62, s[16:19], s21 offen lds
  s_add_u32 s21, s21, 40960
  s_add_u32 m0, s81, 12288
  s_nop 0
  buffer_load_dwordx4 v60, s[16:19], s21 offen lds
  s_add_u32 m0, s81, 13312
  s_nop 0
  buffer_load_dwordx4 v61, s[16:19], s21 offen lds
  s_add_u32 m0, s81, 14336
  s_nop 0
  buffer_load_dwordx4 v62, s[16:19], s21 offen lds
  s_add_u32 s21, s21, 40960
  s_add_u32 m0, s81, 15360
  s_nop 0
  buffer_load_dwordx4 v60, s[16:19], s21 offen lds
  s_add_u32 m0, s81, 16384
  s_nop 0
  buffer_load_dwordx4 v61, s[16:19], s21 offen lds
  s_add_u32 m0, s81, 17408
  s_nop 0
  buffer_load_dwordx4 v62, s[16:19], s21 offen lds
  s_add_u32 s21, s21, 40960
  v_add_u32 v66, 0, v1
  v_mul_u32_u24 v67, 2731, v66
  v_lshrrev_b32 v67, 16, v67
  v_mul_u32_u24 v48, 24, v67
  v_sub_u32 v66, v66, v48
  v_lshrrev_b32 v48, 2, v67
  v_lshlrev_b32 v48, 1, v48
  v_or_b32 v48, 0, v48
  v_xor_b32 v66, v66, v48
  v_add_u32 v67, 0, v67
  v_mul_u32_u24 v67, 12288, v67
  v_lshl_add_u32 v48, v66, 4, v67
  v_add_u32 v66, 64, v1
  v_mul_u32_u24 v67, 2731, v66
  v_lshrrev_b32 v67, 16, v67
  v_mul_u32_u24 v49, 24, v67
  v_sub_u32 v66, v66, v49
  v_lshrrev_b32 v49, 2, v67
  v_lshlrev_b32 v49, 1, v49
  v_or_b32 v49, 0, v49
  v_xor_b32 v66, v66, v49
  v_add_u32 v67, 0, v67
  v_mul_u32_u24 v67, 12288, v67
  v_lshl_add_u32 v49, v66, 4, v67
  v_add_u32 v66, 128, v1
  v_mul_u32_u24 v67, 2731, v66
  v_lshrrev_b32 v67, 16, v67
  v_mul_u32_u24 v50, 24, v67
  v_sub_u32 v66, v66, v50
  v_lshrrev_b32 v50, 2, v67
  v_lshlrev_b32 v50, 1, v50
  v_or_b32 v50, 0, v50
  v_xor_b32 v66, v66, v50
  v_add_u32 v67, 0, v67
  v_mul_u32_u24 v67, 12288, v67
  v_lshl_add_u32 v50, v66, 4, v67
  v_add_u32 v66, 0, v1
  v_mul_u32_u24 v67, 2731, v66
  v_lshrrev_b32 v67, 16, v67
  v_mul_u32_u24 v51, 24, v67
  v_sub_u32 v66, v66, v51
  v_lshrrev_b32 v51, 2, v67
  v_lshlrev_b32 v51, 1, v51
  v_or_b32 v51, 1, v51
  v_xor_b32 v66, v66, v51
  v_add_u32 v67, 8, v67
  v_mul_u32_u24 v67, 12288, v67
  v_lshl_add_u32 v51, v66, 4, v67
  v_add_u32 v66, 64, v1
  v_mul_u32_u24 v67, 2731, v66
  v_lshrrev_b32 v67, 16, v67
  v_mul_u32_u24 v52, 24, v67
  v_sub_u32 v66, v66, v52
  v_lshrrev_b32 v52, 2, v67
  v_lshlrev_b32 v52, 1, v52
  v_or_b32 v52, 1, v52
  v_xor_b32 v66, v66, v52
  v_add_u32 v67, 8, v67
  v_mul_u32_u24 v67, 12288, v67
  v_lshl_add_u32 v52, v66, 4, v67
  v_add_u32 v66, 128, v1
  v_mul_u32_u24 v67, 2731, v66
  v_lshrrev_b32 v67, 16, v67
  v_mul_u32_u24 v53, 24, v67
  v_sub_u32 v66, v66, v53
  v_lshrrev_b32 v53, 2, v67
  v_lshlrev_b32 v53, 1, v53
  v_or_b32 v53, 1, v53
  v_xor_b32 v66, v66, v53
  v_add_u32 v67, 8, v67
  v_mul_u32_u24 v67, 12288, v67
  v_lshl_add_u32 v53, v66, 4, v67
  v_add_u32 v66, 0, v1
  v_mul_u32_u24 v67, 2731, v66
  v_lshrrev_b32 v67, 16, v67
  v_mul_u32_u24 v54, 24, v67
  v_sub_u32 v66, v66, v54
  v_lshrrev_b32 v54, 2, v67
  v_lshlrev_b32 v54, 1, v54
  v_or_b32 v54, 4, v54
  v_xor_b32 v66, v66, v54
  v_add_u32 v67, 16, v67
  v_mul_u32_u24 v67, 12288, v67
  v_lshl_add_u32 v54, v66, 4, v67
  v_add_u32 v66, 64, v1
  v_mul_u32_u24 v67, 2731, v66
  v_lshrrev_b32 v67, 16, v67
  v_mul_u32_u24 v55, 24, v67
  v_sub_u32 v66, v66, v55
  v_lshrrev_b32 v55, 2, v67
  v_lshlrev_b32 v55, 1, v55
  v_or_b32 v55, 4, v55
  v_xor_b32 v66, v66, v55
  v_add_u32 v67, 16, v67
  v_mul_u32_u24 v67, 12288, v67
  v_lshl_add_u32 v55, v66, 4, v67
  v_add_u32 v66, 128, v1
  v_mul_u32_u24 v67, 2731, v66
  v_lshrrev_b32 v67, 16, v67
  v_mul_u32_u24 v56, 24, v67
  v_sub_u32 v66, v66, v56
  v_lshrrev_b32 v56, 2, v67
  v_lshlrev_b32 v56, 1, v56
  v_or_b32 v56, 4, v56
  v_xor_b32 v66, v66, v56
  v_add_u32 v67, 16, v67
  v_mul_u32_u24 v67, 12288, v67
  v_lshl_add_u32 v56, v66, 4, v67
  v_add_u32 v66, 0, v1
  v_mul_u32_u24 v67, 2731, v66
  v_lshrrev_b32 v67, 16, v67
  v_mul_u32_u24 v57, 24, v67
  v_sub_u32 v66, v66, v57
  v_lshrrev_b32 v57, 2, v67
  v_lshlrev_b32 v57, 1, v57
  v_or_b32 v57, 5, v57
  v_xor_b32 v66, v66, v57
  v_add_u32 v67, 24, v67
  v_mul_u32_u24 v67, 12288, v67
  v_lshl_add_u32 v57, v66, 4, v67
  v_add_u32 v66, 64, v1
  v_mul_u32_u24 v67, 2731, v66
  v_lshrrev_b32 v67, 16, v67
  v_mul_u32_u24 v58, 24, v67
  v_sub_u32 v66, v66, v58
  v_lshrrev_b32 v58, 2, v67
  v_lshlrev_b32 v58, 1, v58
  v_or_b32 v58, 5, v58
  v_xor_b32 v66, v66, v58
  v_add_u32 v67, 24, v67
  v_mul_u32_u24 v67, 12288, v67
  v_lshl_add_u32 v58, v66, 4, v67
  v_add_u32 v66, 128, v1
  v_mul_u32_u24 v67, 2731, v66
  v_lshrrev_b32 v67, 16, v67
  v_mul_u32_u24 v59, 24, v67
  v_sub_u32 v66, v66, v59
  v_lshrrev_b32 v59, 2, v67
  v_lshlrev_b32 v59, 1, v59
  v_or_b32 v59, 5, v59
  v_xor_b32 v66, v66, v59
  v_add_u32 v67, 24, v67
  v_mul_u32_u24 v67, 12288, v67
  v_lshl_add_u32 v59, v66, 4, v67
  s_add_u32 m0, s81, 24576
  s_nop 0
  buffer_load_dwordx4 v48, s[12:15], s80 offen lds
  s_add_u32 m0, s81, 25600
  s_nop 0
  buffer_load_dwordx4 v49, s[12:15], s80 offen lds
  s_add_u32 m0, s81, 26624
  s_nop 0
  buffer_load_dwordx4 v50, s[12:15], s80 offen lds
  s_add_u32 m0, s81, 27648
  s_nop 0
  buffer_load_dwordx4 v51, s[12:15], s80 offen lds
  s_add_u32 m0, s81, 28672
  s_nop 0
  buffer_load_dwordx4 v52, s[12:15], s80 offen lds
  s_add_u32 m0, s81, 29696
  s_nop 0
  buffer_load_dwordx4 v53, s[12:15], s80 offen lds
  s_add_u32 m0, s81, 30720
  s_nop 0
  buffer_load_dwordx4 v54, s[12:15], s80 offen lds
  s_add_u32 m0, s81, 31744
  s_nop 0
  buffer_load_dwordx4 v55, s[12:15], s80 offen lds
  s_add_u32 m0, s81, 32768
  s_nop 0
  buffer_load_dwordx4 v56, s[12:15], s80 offen lds
  s_add_u32 m0, s81, 33792
  s_nop 0
  buffer_load_dwordx4 v57, s[12:15], s80 offen lds
  s_add_u32 m0, s81, 34816
  s_nop 0
  buffer_load_dwordx4 v58, s[12:15], s80 offen lds
  s_add_u32 m0, s81, 35840
  s_nop 0
  buffer_load_dwordx4 v59, s[12:15], s80 offen lds
  s_add_u32 s80, s80, 393216
  v_add_u32 v66, 0, v1
  v_mul_u32_u24 v67, 10923, v66
  v_lshrrev_b32 v67, 16, v67
  v_mul_u32_u24 v63, 6, v67
  v_sub_u32 v66, v66, v63
  v_mul_u32_u24 v67, 12288, v67
  v_lshl_add_u32 v63, v66, 4, v67
  v_add_u32 v66, 64, v1
  v_mul_u32_u24 v67, 10923, v66
  v_lshrrev_b32 v67, 16, v67
  v_mul_u32_u24 v64, 6, v67
  v_sub_u32 v66, v66, v64
  v_mul_u32_u24 v67, 12288, v67
  v_lshl_add_u32 v64, v66, 4, v67
  v_add_u32 v66, 128, v1
  v_mul_u32_u24 v67, 10923, v66
  v_lshrrev_b32 v67, 16, v67
  v_mul_u32_u24 v65, 6, v67
  v_sub_u32 v66, v66, v65
  v_mul_u32_u24 v67, 12288, v67
  v_lshl_add_u32 v65, v66, 4, v67
  s_mul_i32 s79, s58, 384
  s_mul_i32 s22, s56, 96
  s_add_u32 s79, s79, s22
  s_mul_i32 s22, s20, 1966080
  s_add_u32 s79, s79, s22
  v_and_b32 v224, 7, v2
  v_lshrrev_b32 v225, 3, v2
  v_lshlrev_b32 v12, 3, v1
  v_mov_b32 v23, 0
  v_mov_b32 v226, 0x4444
  v_mov_b32 v227, 0xeeee
  v_cmp_eq_u32 vcc, 1, v225
  v_cmp_gt_u32 s[62:63], 8, v2
  v_cmp_le_u32 s[68:69], 8, v2
  v_cndmask_b32 v22, v226, v227, vcc
  v_cmp_gt_u32 vcc, 32, v1
  v_mov_b32 v226, 0x3dd53b95
  v_cmp_gt_u32 s[66:67], 40, v1
  v_cndmask_b32 v24, 1.0, v226, vcc
  v_cndmask_b32 v25, 1.0, v226, vcc
  v_min_u32 v226, 39, v1
  v_and_b32 v227, 31, v1
  v_lshlrev_b32 v227, 2, v227
  v_lshl_add_u32 v5, v226, 7, v227
  v_mul_u32_u24 v226, 192, v3
  v_lshl_add_u32 v226, v2, 3, v226
  s_mul_i32 s21, s20, 768
  s_add_u32 s21, s21, 10240
  v_add_u32 v6, s21, v226
  v_and_b32 v226, 3, v2
  v_mul_u32_u24 v226, 192, v226
  v_lshrrev_b32 v227, 2, v2
  v_lshl_add_u32 v227, v3, 2, v227
  v_lshl_add_u32 v226, v227, 3, v226
  v_add_u32 v7, 10240, v226
  s_mul_i32 s21, s58, 2560
  s_add_u32 s21, s21, 40960
  s_lshr_b32 s22, s56, 1
  s_lshl_b32 s22, s22, 10
  s_and_b32 s23, s56, 1
  s_lshl_b32 s23, s23, 3
  s_add_u32 s22, s22, s23
  s_lshl_b32 s23, s20, 7
  s_add_u32 s22, s22, s23
  s_add_u32 s22, s22, s21
  v_lshlrev_b32 v226, 8, v3
  v_lshl_add_u32 v226, v224, 4, v226
  v_add_u32 v8, s22, v226
  s_lshl_b32 s22, s56, 2
  s_add_u32 s22, s22, s21
  s_add_u32 s22, s22, 2048
  v_and_b32 v226, 0x1ff, v226
  v_add_u32 v226, s22, v226
  s_cmp_eq_u32 s20, 2
  s_cselect_b64 vcc, -1, 0
  v_cmp_le_u32 s[64:65], 32, v1
  v_cndmask_b32 v8, v8, v226, vcc
  s_cselect_b64 s[64:65], s[64:65], -1
  s_and_b64 s[64:65], s[64:65], s[62:63]
  s_mul_i32 s21, s59, 2560
  s_add_u32 s21, s21, 40960
  v_add_u32 v9, s21, v4
  v_and_b32 v226, 0x1ff, v4
  s_add_u32 s21, s21, 2048
  v_add_u32 v10, s21, v226
  v_lshrrev_b32 v226, 2, v2
  v_and_b32 v227, 1, v2
  v_lshl_add_u32 v228, v226, 1, v227
  v_and_b32 v227, 2, v2
  v_cmp_eq_u32 vcc, 0, v227
  s_lshr_b32 s21, s20, 1
  s_lshl_b32 s21, s21, 9
  s_and_b32 s22, s20, 1
  s_lshl_b32 s22, s22, 6
  s_add_u32 s21, s21, s22
  s_add_u32 s21, s21, 12544
  v_lshlrev_b32 v226, 7, v3
  v_lshl_add_u32 v226, v228, 3, v226
  v_add_u32 v226, s21, v226
  v_mov_b32 v227, 13568
  v_cndmask_b32 v11, v227, v226, vcc
  s_lshl_b32 s21, s20, 9
  s_add_u32 s21, s21, 40960
  v_lshlrev_b32 v226, 7, v3
  v_lshl_add_u32 v226, v228, 4, v226
  v_add_u32 v226, s21, v226
  v_mov_b32 v227, 46080
  v_cndmask_b32 v19, v227, v226, vcc
  s_lshl_b32 s21, s20, 11
  s_add_u32 s21, s21, 32768
  v_add_u32 v18, s21, v4
  s_and_b32 s21, s20, 1
  s_lshl_b32 s22, s21, 10
  s_add_u32 s22, s22, 43008
  v_add_u32 v20, s22, v4
  s_lshl_b32 s22, s21, 3
  s_add_u32 s22, s22, 45056
  v_add_u32 v21, s22, v4
  s_mul_i32 s21, s20, 640
  s_add_u32 s22, s21, 13824
  v_lshlrev_b32 v226, 4, v224
  v_lshl_add_u32 v227, v3, 7, v226
  v_add_u32 v13, s22, v227
  v_lshl_add_u32 v227, v3, 2, v226
  s_add_u32 s22, s22, 512
  v_add_u32 v14, s22, v227
  v_lshrrev_b32 v228, 5, v1
  v_add_u32 v26, s21, v4
  v_lshl_add_u32 v228, v228, 1, v225
  v_mul_u32_u24 v228, 640, v228
  v_and_b32 v226, 1, v3
  v_lshl_add_u32 v228, v226, 6, v228
  v_lshl_add_u32 v228, v224, 3, v228
  v_add_u32 v43, 512, v228
  s_and_b32 s21, s50, 1
  s_lshl_b32 s21, s21, 4
  s_add_u32 s21, s21, s51
  s_lshl_b32 s22, s20, 5
  s_add_u32 s21, s21, s22
  s_cmp_lt_u32 s21, 80
  s_cselect_b32 s78, 1, 0
  s_cselect_b32 s21, s21, 0
  s_lshl_b32 s22, s21, 7
  v_add_u32 v17, s22, v227
  s_lshr_b32 s22, s21, 3
  s_lshl_b32 s22, s22, 14
  s_and_b32 s21, s21, 7
  s_lshl_b32 s21, s21, 10
  s_add_u32 s21, s21, s22
  v_add_u32 v16, s21, v4
  s_mul_i32 s21, s60, 10
  s_mul_i32 s22, s61, 6
  s_add_u32 s22, s22, s21
  s_add_u32 s21, s21, s61
  s_add_u32 s21, s21, 4
  v_lshrrev_b32 v226, 3, v1
  v_cmp_gt_u32 vcc, 4, v226
  v_add_u32 v226, s22, v226
  v_mov_b32 v227, s21
  v_cndmask_b32 v226, v227, v226, vcc
  v_lshrrev_b32 v227, 3, v226
  v_lshlrev_b32 v227, 14, v227
  v_and_b32 v226, 7, v226
  v_lshl_add_u32 v226, v226, 10, v227
  v_lshl_add_u32 v226, v224, 4, v226
  s_lshl_b32 s21, s50, 7
  v_add_u32 v15, s21, v226
  v_and_b32 v226, 1, v2
  v_lshlrev_b32 v226, 4, v226
  v_mov_b32 v227, 0x3c00
  v_lshlrev_b32 v226, v226, v227
  v_lshrrev_b32 v227, 1, v2
  v_cmp_eq_u32 vcc, 0, v227
  s_nop 1
  v_cndmask_b32 v44, 0, v226, vcc
  v_cmp_eq_u32 vcc, 2, v227
  s_nop 1
  v_cndmask_b32 v45, 0, v226, vcc
  v_cmp_eq_u32 vcc, 4, v227
  s_nop 1
  v_cndmask_b32 v46, 0, v226, vcc
  v_cmp_eq_u32 vcc, 6, v227
  s_nop 1
  v_cndmask_b32 v47, 0, v226, vcc
  v_lshrrev_b32 v226, 5, v1
  v_lshlrev_b32 v226, 14, v226
  v_bfe_u32 v227, v1, 3, 2
  v_lshl_add_u32 v226, v227, 8, v226
  v_lshl_add_u32 v226, v224, 4, v226
  s_lshl_b32 s21, s61, 7
  v_add_u32 v32, s21, v226
  v_lshlrev_b32 v226, 4, v224
  v_lshl_add_u32 v36, v3, 7, v226
  v_lshrrev_b32 v37, 1, v36
  v_and_b32 v41, 3, v1
  v_lshlrev_b32 v41, 7, v41
  v_mov_b32 v226, 0x40000000
  v_cmp_gt_u32 vcc, 32, v1
  v_cndmask_b32 v36, v226, v36, s[68:69]
  v_cndmask_b32 v37, v226, v37, s[68:69]
  v_cndmask_b32 v26, v226, v26, vcc
  s_lshr_b32 s21, s50, 1
  s_lshl_b32 s21, s21, 8
  s_add_u32 s21, s21, 491520
  v_and_b32 v227, 31, v1
  v_lshl_add_u32 v33, v227, 2, s21
  s_and_b32 s22, s50, 1
  s_lshl_b32 s22, s22, 4
  s_add_u32 s22, s22, s51
  v_cmp_eq_u32 vcc, s22, v1
  s_nop 1
  v_cndmask_b32 v34, v226, v33, vcc
  v_mov_b32 v28, -1
  v_mov_b32 v29, -1
  v_mov_b32 v30, -1
  v_mov_b32 v31, -1
  s_lshr_b32 s21, s50, 1
  s_mul_i32 s77, s21, 10240
  s_cmp_eq_u32 s20, 3
  s_cbranch_scc1 ar_8
  s_mov_b64 exec, s[64:65]
  s_cmp_eq_u32 s20, 2
  s_cbranch_scc1 ar_7
  s_mov_b32 s21, 0
  buffer_store_dwordx2 v[28:29], v8, s[8:11], s21 offen
  s_mov_b32 s21, 122880
  buffer_store_dwordx2 v[28:29], v8, s[8:11], s21 offen
  s_mov_b32 s21, 245760
  buffer_store_dwordx2 v[28:29], v8, s[8:11], s21 offen
  s_mov_b32 s21, 368640
  buffer_store_dwordx2 v[28:29], v8, s[8:11], s21 offen
  s_branch ar_9
ar_7:
  s_mov_b32 s21, 0
  buffer_store_dword v28, v8, s[8:11], s21 offen
  buffer_store_dword v28, v8, s[8:11], s21 offen offset:128
  s_mov_b32 s21, 122880
  buffer_store_dword v28, v8, s[8:11], s21 offen
  buffer_store_dword v28, v8, s[8:11], s21 offen offset:128
  s_mov_b32 s21, 245760
  buffer_store_dword v28, v8, s[8:11], s21 offen
  buffer_store_dword v28, v8, s[8:11], s21 offen offset:128
  s_mov_b32 s21, 368640
  buffer_store_dword v28, v8, s[8:11], s21 offen
  buffer_store_dword v28, v8, s[8:11], s21 offen offset:128
ar_9:
  s_cmp_eq_u32 s78, 0
  s_cbranch_scc1 ar_10
  s_mov_b64 exec, s[62:63]
  s_add_u32 s21, s77, 0
  buffer_store_dword v28, v17, s[8:11], s21 offen
  s_add_u32 s21, s77, 122880
  buffer_store_dword v28, v17, s[8:11], s21 offen
  s_add_u32 s21, s77, 245760
  buffer_store_dword v28, v17, s[8:11], s21 offen
  s_add_u32 s21, s77, 368640
  buffer_store_dword v28, v17, s[8:11], s21 offen
  s_branch ar_10
ar_8:
  buffer_store_dword v28, v34, s[8:11], 0 offen
  s_mov_b64 exec, s[66:67]
  s_mov_b32 s21, 0
  buffer_store_dwordx4 v[28:31], v15, s[4:7], s21 offen sc1
  s_mov_b32 s21, 262144
  buffer_store_dwordx4 v[28:31], v15, s[4:7], s21 offen sc1
  s_mov_b32 s21, 524288
  buffer_store_dwordx4 v[28:31], v15, s[4:7], s21 offen sc1
  s_mov_b32 s21, 786432
  buffer_store_dwordx4 v[28:31], v15, s[4:7], s21 offen sc1
  s_mov_b32 s21, 8192
  buffer_store_dwordx4 v[28:31], v15, s[4:7], s21 offen sc1
  s_mov_b32 s21, 270336
  buffer_store_dwordx4 v[28:31], v15, s[4:7], s21 offen sc1
  s_mov_b32 s21, 532480
  buffer_store_dwordx4 v[28:31], v15, s[4:7], s21 offen sc1
  s_mov_b32 s21, 794624
  buffer_store_dwordx4 v[28:31], v15, s[4:7], s21 offen sc1
ar_10:
  s_mov_b64 exec, -1
  v_lshrrev_b32 v66, 2, v2
  v_lshl_add_u32 v66, v3, 3, v66
  v_mul_u32_u24 v66, 96, v66
  v_add_u32 v66, s81, v66
  v_and_b32 v67, 3, v2
  s_lshl_b32 s21, s61, 5
  v_lshl_add_u32 v68, v67, 4, v66
  v_add_u32 v68, s21, v68
  s_mul_i32 s21, s61, 48
  s_sub_u32 s21, 64, s21
  v_and_b32 v67, 1, v2
  v_lshl_add_u32 v69, v67, 3, v66
  v_add_u32 v69, s21, v69
  v_lshrrev_b32 v226, 3, v2
  v_lshlrev_b32 v226, 4, v226
  v_bfe_u32 v227, v2, 1, 1
  v_lshl_add_u32 v226, v227, 3, v226
  v_and_b32 v227, 5, v2
  v_add_u32 v226, v226, v227
  v_mul_u32_u24 v226, 384, v226
  v_add_u32 v226, s81, v226
  v_lshrrev_b32 v227, 1, v2
  v_xor_b32 v227, v227, v3
  v_lshl_add_u32 v70, v227, 4, v226
  v_xor_b32 v227, 4, v227
  v_lshl_add_u32 v71, v227, 4, v226
  s_waitcnt vmcnt(0)
  ds_read_b64_tr_b16 v[72:73], v68 offset:0
  ds_read_b64_tr_b16 v[74:75], v68 offset:384
  ds_read_b64_tr_b16 v[76:77], v68 offset:8
  ds_read_b64_tr_b16 v[78:79], v68 offset:392
  ds_read_b64_tr_b16 v[80:81], v69 offset:0
  ds_read_b64_tr_b16 v[82:83], v69 offset:384
  ds_read_b64_tr_b16 v[84:85], v68 offset:3072
  ds_read_b64_tr_b16 v[86:87], v68 offset:3456
  ds_read_b64_tr_b16 v[88:89], v68 offset:3080
  ds_read_b64_tr_b16 v[90:91], v68 offset:3464
  ds_read_b64_tr_b16 v[92:93], v69 offset:3072
  ds_read_b64_tr_b16 v[94:95], v69 offset:3456
  ds_read_b64_tr_b16 v[96:97], v68 offset:6144
  ds_read_b64_tr_b16 v[98:99], v68 offset:6528
  ds_read_b64_tr_b16 v[100:101], v68 offset:6152
  ds_read_b64_tr_b16 v[102:103], v68 offset:6536
  ds_read_b64_tr_b16 v[104:105], v69 offset:6144
  ds_read_b64_tr_b16 v[106:107], v69 offset:6528
  ds_read_b64_tr_b16 v[108:109], v68 offset:9216
  ds_read_b64_tr_b16 v[110:111], v68 offset:9600
  ds_read_b64_tr_b16 v[112:113], v68 offset:9224
  ds_read_b64_tr_b16 v[114:115], v68 offset:9608
  ds_read_b64_tr_b16 v[116:117], v69 offset:9216
  ds_read_b64_tr_b16 v[118:119], v69 offset:9600
  ds_read_b64_tr_b16 v[120:121], v68 offset:12288
  ds_read_b64_tr_b16 v[122:123], v68 offset:12672
  ds_read_b64_tr_b16 v[124:125], v68 offset:12296
  ds_read_b64_tr_b16 v[126:127], v68 offset:12680
  ds_read_b64_tr_b16 v[128:129], v69 offset:12288
  ds_read_b64_tr_b16 v[130:131], v69 offset:12672
  ds_read_b64_tr_b16 v[132:133], v68 offset:15360
  ds_read_b64_tr_b16 v[134:135], v68 offset:15744
  ds_read_b64_tr_b16 v[136:137], v68 offset:15368
  ds_read_b64_tr_b16 v[138:139], v68 offset:15752
  ds_read_b64_tr_b16 v[140:141], v69 offset:15360
  ds_read_b64_tr_b16 v[142:143], v69 offset:15744
  s_waitcnt lgkmcnt(0)
  s_barrier
  s_cmp_lg_u32 s20, 0
  s_cbranch_scc1 ic_11
  v_mov_b32 v68, 64
  v_mov_b32 v69, 1
  s_mov_b64 exec, 1
  buffer_atomic_add v69, v68, s[32:35], 0 offen sc1
  s_mov_b64 exec, -1
ic_11:
  s_add_u32 m0, s81, 0
  s_nop 0
  buffer_load_dwordx4 v48, s[12:15], s80 offen lds
  s_add_u32 m0, s81, 1024
  s_nop 0
  buffer_load_dwordx4 v49, s[12:15], s80 offen lds
  s_add_u32 m0, s81, 2048
  s_nop 0
  buffer_load_dwordx4 v50, s[12:15], s80 offen lds
  s_add_u32 m0, s81, 3072
  s_nop 0
  buffer_load_dwordx4 v51, s[12:15], s80 offen lds
  s_add_u32 m0, s81, 4096
  s_nop 0
  buffer_load_dwordx4 v52, s[12:15], s80 offen lds
  s_add_u32 m0, s81, 5120
  s_nop 0
  buffer_load_dwordx4 v53, s[12:15], s80 offen lds
  s_add_u32 m0, s81, 6144
  s_nop 0
  buffer_load_dwordx4 v54, s[12:15], s80 offen lds
  s_add_u32 m0, s81, 7168
  s_nop 0
  buffer_load_dwordx4 v55, s[12:15], s80 offen lds
  s_add_u32 m0, s81, 8192
  s_nop 0
  buffer_load_dwordx4 v56, s[12:15], s80 offen lds
  s_add_u32 m0, s81, 9216
  s_nop 0
  buffer_load_dwordx4 v57, s[12:15], s80 offen lds
  s_add_u32 m0, s81, 10240
  s_nop 0
  buffer_load_dwordx4 v58, s[12:15], s80 offen lds
  s_add_u32 m0, s81, 11264
  s_nop 0
  buffer_load_dwordx4 v59, s[12:15], s80 offen lds
  s_add_u32 s80, s80, 393216
  s_add_u32 s16, s48, 173080576
  s_addc_u32 s17, s49, 0
  s_mov_b32 s18, 49152
  s_mov_b32 s19, 0x00020000
  v_add_u32 v68, s81, v4
  v_and_b32 v69, 7, v2
  v_lshl_add_u32 v69, v3, 3, v69
  v_and_b32 v67, 8, v2
  v_lshl_add_u32 v69, v69, 4, v67
  v_add_u32 v69, s81, v69
  v_lshlrev_b32 v67, 2, v1
  s_lshl_b32 s90, s50, 9
  s_and_b32 s21, s51, 12
  s_add_u32 s90, s90, s21
  s_add_u32 s90, s90, 4096
  ds_read_b128 v[208:211], v70 offset:24576
  ds_read_b128 v[212:215], v71 offset:24576
  ds_read_b128 v[216:219], v70 offset:24704
  s_waitcnt lgkmcnt(2)
  v_mfma_f32_16x16x32_bf16 v[184:187], v[208:211], v[72:75], 0
  ds_read_b128 v[220:223], v71 offset:24704
  v_mfma_f32_16x16x32_bf16 v[188:191], v[208:211], v[76:79], 0
  s_add_u32 m0, s81, 12288
  s_nop 0
  buffer_load_dwordx4 v48, s[12:15], s80 offen lds
  v_mfma_f32_16x16x32_bf16 v[192:195], v[208:211], v[80:83], 0
  s_waitcnt lgkmcnt(2)
  v_mfma_f32_16x16x32_bf16 v[184:187], v[212:215], v[84:87], v[184:187]
  ds_read_b128 v[208:211], v70 offset:24832
  v_mfma_f32_16x16x32_bf16 v[188:191], v[212:215], v[88:91], v[188:191]
  s_add_u32 m0, s81, 13312
  s_nop 0
  buffer_load_dwordx4 v49, s[12:15], s80 offen lds
  v_mfma_f32_16x16x32_bf16 v[192:195], v[212:215], v[92:95], v[192:195]
  s_waitcnt lgkmcnt(2)
  v_mfma_f32_16x16x32_bf16 v[184:187], v[216:219], v[96:99], v[184:187]
  ds_read_b128 v[212:215], v71 offset:24832
  v_mfma_f32_16x16x32_bf16 v[188:191], v[216:219], v[100:103], v[188:191]
  s_add_u32 m0, s81, 14336
  s_nop 0
  buffer_load_dwordx4 v50, s[12:15], s80 offen lds
  v_mfma_f32_16x16x32_bf16 v[192:195], v[216:219], v[104:107], v[192:195]
  s_waitcnt lgkmcnt(2)
  v_mfma_f32_16x16x32_bf16 v[184:187], v[220:223], v[108:111], v[184:187]
  ds_read_b128 v[216:219], v70 offset:25344
  v_mfma_f32_16x16x32_bf16 v[188:191], v[220:223], v[112:115], v[188:191]
  s_add_u32 m0, s81, 15360
  s_nop 0
  buffer_load_dwordx4 v51, s[12:15], s80 offen lds
  v_mfma_f32_16x16x32_bf16 v[192:195], v[220:223], v[116:119], v[192:195]
  s_waitcnt lgkmcnt(2)
  v_mfma_f32_16x16x32_bf16 v[184:187], v[208:211], v[120:123], v[184:187]
  ds_read_b128 v[220:223], v71 offset:25344
  v_mfma_f32_16x16x32_bf16 v[188:191], v[208:211], v[124:127], v[188:191]
  s_add_u32 m0, s81, 16384
  s_nop 0
  buffer_load_dwordx4 v52, s[12:15], s80 offen lds
  v_mfma_f32_16x16x32_bf16 v[192:195], v[208:211], v[128:131], v[192:195]
  s_waitcnt lgkmcnt(2)
  v_mfma_f32_16x16x32_bf16 v[184:187], v[212:215], v[132:135], v[184:187]
  ds_read_b128 v[208:211], v70 offset:25472
  v_mfma_f32_16x16x32_bf16 v[188:191], v[212:215], v[136:139], v[188:191]
  s_add_u32 m0, s81, 17408
  s_nop 0
  buffer_load_dwordx4 v53, s[12:15], s80 offen lds
  v_mfma_f32_16x16x32_bf16 v[192:195], v[212:215], v[140:143], v[192:195]
  s_waitcnt lgkmcnt(2)
  v_mfma_f32_16x16x32_bf16 v[196:199], v[216:219], v[72:75], 0
  ds_read_b128 v[212:215], v71 offset:25472
  v_mfma_f32_16x16x32_bf16 v[200:203], v[216:219], v[76:79], 0
  s_add_u32 m0, s81, 18432
  s_nop 0
  buffer_load_dwordx4 v54, s[12:15], s80 offen lds
  v_mfma_f32_16x16x32_bf16 v[204:207], v[216:219], v[80:83], 0
  s_waitcnt lgkmcnt(2)
  v_mfma_f32_16x16x32_bf16 v[196:199], v[220:223], v[84:87], v[196:199]
  ds_read_b128 v[216:219], v70 offset:25600
  v_cvt_pk_bf16_f32 v248, v184, v185
  v_mfma_f32_16x16x32_bf16 v[200:203], v[220:223], v[88:91], v[200:203]
  s_add_u32 m0, s81, 19456
  s_nop 0
  buffer_load_dwordx4 v55, s[12:15], s80 offen lds
  v_mfma_f32_16x16x32_bf16 v[204:207], v[220:223], v[92:95], v[204:207]
  v_cvt_pk_bf16_f32 v249, v186, v187
  s_waitcnt lgkmcnt(2)
  v_mfma_f32_16x16x32_bf16 v[196:199], v[208:211], v[96:99], v[196:199]
  ds_read_b128 v[220:223], v71 offset:25600
  v_cvt_pk_bf16_f32 v250, v188, v189
  v_mfma_f32_16x16x32_bf16 v[200:203], v[208:211], v[100:103], v[200:203]
  s_add_u32 m0, s81, 20480
  s_nop 0
  buffer_load_dwordx4 v56, s[12:15], s80 offen lds
  v_mfma_f32_16x16x32_bf16 v[204:207], v[208:211], v[104:107], v[204:207]
  v_cvt_pk_bf16_f32 v251, v190, v191
  s_waitcnt lgkmcnt(2)
  v_mfma_f32_16x16x32_bf16 v[196:199], v[212:215], v[108:111], v[196:199]
  v_accvgpr_write_b32 a0, v248
  v_mfma_f32_16x16x32_bf16 v[200:203], v[212:215], v[112:115], v[200:203]
  s_add_u32 m0, s81, 21504
  s_nop 0
  buffer_load_dwordx4 v57, s[12:15], s80 offen lds
  v_mfma_f32_16x16x32_bf16 v[204:207], v[212:215], v[116:119], v[204:207]
  v_accvgpr_write_b32 a1, v249
  s_waitcnt lgkmcnt(1)
  v_mfma_f32_16x16x32_bf16 v[196:199], v[216:219], v[120:123], v[196:199]
  v_accvgpr_write_b32 a80, v250
  v_mfma_f32_16x16x32_bf16 v[200:203], v[216:219], v[124:127], v[200:203]
  s_add_u32 m0, s81, 22528
  s_nop 0
  buffer_load_dwordx4 v58, s[12:15], s80 offen lds
  v_mfma_f32_16x16x32_bf16 v[204:207], v[216:219], v[128:131], v[204:207]
  v_accvgpr_write_b32 a81, v251
  s_waitcnt lgkmcnt(0)
  v_mfma_f32_16x16x32_bf16 v[196:199], v[220:223], v[132:135], v[196:199]
  v_cvt_pk_bf16_f32 v144, v192, v193
  v_cvt_pk_bf16_f32 v145, v194, v195
  v_mfma_f32_16x16x32_bf16 v[200:203], v[220:223], v[136:139], v[200:203]
  s_add_u32 m0, s81, 23552
  s_nop 0
  buffer_load_dwordx4 v59, s[12:15], s80 offen lds
  s_add_u32 s80, s80, 393216
  v_mfma_f32_16x16x32_bf16 v[204:207], v[220:223], v[140:143], v[204:207]
  s_waitcnt vmcnt(12)
  ds_read_b128 v[208:211], v70 offset:0
  ds_read_b128 v[212:215], v71 offset:0
  ds_read_b128 v[216:219], v70 offset:128
  s_waitcnt lgkmcnt(2)
  v_mfma_f32_16x16x32_bf16 v[184:187], v[208:211], v[72:75], 0
  ds_read_b128 v[220:223], v71 offset:128
  v_mfma_f32_16x16x32_bf16 v[188:191], v[208:211], v[76:79], 0
  s_add_u32 m0, s81, 24576
  s_nop 0
  buffer_load_dwordx4 v48, s[12:15], s80 offen lds
  v_mfma_f32_16x16x32_bf16 v[192:195], v[208:211], v[80:83], 0
  s_waitcnt lgkmcnt(2)
  v_mfma_f32_16x16x32_bf16 v[184:187], v[212:215], v[84:87], v[184:187]
  ds_read_b128 v[208:211], v70 offset:256
  v_cvt_pk_bf16_f32 v248, v196, v197
  v_mfma_f32_16x16x32_bf16 v[188:191], v[212:215], v[88:91], v[188:191]
  s_add_u32 m0, s81, 25600
  s_nop 0
  buffer_load_dwordx4 v49, s[12:15], s80 offen lds
  v_mfma_f32_16x16x32_bf16 v[192:195], v[212:215], v[92:95], v[192:195]
  v_cvt_pk_bf16_f32 v249, v198, v199
  s_waitcnt lgkmcnt(2)
  v_mfma_f32_16x16x32_bf16 v[184:187], v[216:219], v[96:99], v[184:187]
  ds_read_b128 v[212:215], v71 offset:256
  v_cvt_pk_bf16_f32 v250, v200, v201
  v_mfma_f32_16x16x32_bf16 v[188:191], v[216:219], v[100:103], v[188:191]
  s_add_u32 m0, s81, 26624
  s_nop 0
  buffer_load_dwordx4 v50, s[12:15], s80 offen lds
  v_mfma_f32_16x16x32_bf16 v[192:195], v[216:219], v[104:107], v[192:195]
  v_cvt_pk_bf16_f32 v251, v202, v203
  s_waitcnt lgkmcnt(2)
  v_mfma_f32_16x16x32_bf16 v[184:187], v[220:223], v[108:111], v[184:187]
  ds_read_b128 v[216:219], v70 offset:768
  v_accvgpr_write_b32 a2, v248
  v_mfma_f32_16x16x32_bf16 v[188:191], v[220:223], v[112:115], v[188:191]
  s_add_u32 m0, s81, 27648
  s_nop 0
  buffer_load_dwordx4 v51, s[12:15], s80 offen lds
  v_mfma_f32_16x16x32_bf16 v[192:195], v[220:223], v[116:119], v[192:195]
  v_accvgpr_write_b32 a3, v249
  s_waitcnt lgkmcnt(2)
  v_mfma_f32_16x16x32_bf16 v[184:187], v[208:211], v[120:123], v[184:187]
  ds_read_b128 v[220:223], v71 offset:768
  v_accvgpr_write_b32 a82, v250
  v_mfma_f32_16x16x32_bf16 v[188:191], v[208:211], v[124:127], v[188:191]
  s_add_u32 m0, s81, 28672
  s_nop 0
  buffer_load_dwordx4 v52, s[12:15], s80 offen lds
  v_mfma_f32_16x16x32_bf16 v[192:195], v[208:211], v[128:131], v[192:195]
  v_accvgpr_write_b32 a83, v251
  s_waitcnt lgkmcnt(2)
  v_mfma_f32_16x16x32_bf16 v[184:187], v[212:215], v[132:135], v[184:187]
  ds_read_b128 v[208:211], v70 offset:896
  s_mov_b64 exec, s[68:69]
  v_cvt_pk_bf16_f32 v144, v204, v205
  v_cvt_pk_bf16_f32 v145, v206, v207
  s_mov_b64 exec, -1
  v_mfma_f32_16x16x32_bf16 v[188:191], v[212:215], v[136:139], v[188:191]
  s_add_u32 m0, s81, 29696
  s_nop 0
  buffer_load_dwordx4 v53, s[12:15], s80 offen lds
  v_mfma_f32_16x16x32_bf16 v[192:195], v[212:215], v[140:143], v[192:195]
  s_waitcnt lgkmcnt(2)
  v_mfma_f32_16x16x32_bf16 v[196:199], v[216:219], v[72:75], 0
  ds_read_b128 v[212:215], v71 offset:896
  v_mfma_f32_16x16x32_bf16 v[200:203], v[216:219], v[76:79], 0
  s_add_u32 m0, s81, 30720
  s_nop 0
  buffer_load_dwordx4 v54, s[12:15], s80 offen lds
  v_mfma_f32_16x16x32_bf16 v[204:207], v[216:219], v[80:83], 0
  s_waitcnt lgkmcnt(2)
  v_mfma_f32_16x16x32_bf16 v[196:199], v[220:223], v[84:87], v[196:199]
  ds_read_b128 v[216:219], v70 offset:1024
  v_cvt_pk_bf16_f32 v248, v184, v185
  v_mfma_f32_16x16x32_bf16 v[200:203], v[220:223], v[88:91], v[200:203]
  s_add_u32 m0, s81, 31744
  s_nop 0
  buffer_load_dwordx4 v55, s[12:15], s80 offen lds
  v_mfma_f32_16x16x32_bf16 v[204:207], v[220:223], v[92:95], v[204:207]
  v_cvt_pk_bf16_f32 v249, v186, v187
  s_waitcnt lgkmcnt(2)
  v_mfma_f32_16x16x32_bf16 v[196:199], v[208:211], v[96:99], v[196:199]
  ds_read_b128 v[220:223], v71 offset:1024
  v_cvt_pk_bf16_f32 v250, v188, v189
  v_mfma_f32_16x16x32_bf16 v[200:203], v[208:211], v[100:103], v[200:203]
  s_add_u32 m0, s81, 32768
  s_nop 0
  buffer_load_dwordx4 v56, s[12:15], s80 offen lds
  v_mfma_f32_16x16x32_bf16 v[204:207], v[208:211], v[104:107], v[204:207]
  v_cvt_pk_bf16_f32 v251, v190, v191
  s_waitcnt lgkmcnt(2)
  v_mfma_f32_16x16x32_bf16 v[196:199], v[212:215], v[108:111], v[196:199]
  v_accvgpr_write_b32 a4, v248
  v_mfma_f32_16x16x32_bf16 v[200:203], v[212:215], v[112:115], v[200:203]
  s_add_u32 m0, s81, 33792
  s_nop 0
  buffer_load_dwordx4 v57, s[12:15], s80 offen lds
  v_mfma_f32_16x16x32_bf16 v[204:207], v[212:215], v[116:119], v[204:207]
  v_accvgpr_write_b32 a5, v249
  s_waitcnt lgkmcnt(1)
  v_mfma_f32_16x16x32_bf16 v[196:199], v[216:219], v[120:123], v[196:199]
  v_accvgpr_write_b32 a84, v250
  v_mfma_f32_16x16x32_bf16 v[200:203], v[216:219], v[124:127], v[200:203]
  s_add_u32 m0, s81, 34816
  s_nop 0
  buffer_load_dwordx4 v58, s[12:15], s80 offen lds
  v_mfma_f32_16x16x32_bf16 v[204:207], v[216:219], v[128:131], v[204:207]
  v_accvgpr_write_b32 a85, v251
  s_waitcnt lgkmcnt(0)
  v_mfma_f32_16x16x32_bf16 v[196:199], v[220:223], v[132:135], v[196:199]
  v_cvt_pk_bf16_f32 v146, v192, v193
  v_cvt_pk_bf16_f32 v147, v194, v195
  v_mfma_f32_16x16x32_bf16 v[200:203], v[220:223], v[136:139], v[200:203]
  s_add_u32 m0, s81, 35840
  s_nop 0
  buffer_load_dwordx4 v59, s[12:15], s80 offen lds
  s_add_u32 s80, s80, 393216
  v_mfma_f32_16x16x32_bf16 v[204:207], v[220:223], v[140:143], v[204:207]
  s_waitcnt vmcnt(12)
  ds_read_b128 v[208:211], v70 offset:12288
  ds_read_b128 v[212:215], v71 offset:12288
  ds_read_b128 v[216:219], v70 offset:12416
  s_waitcnt lgkmcnt(2)
  v_mfma_f32_16x16x32_bf16 v[184:187], v[208:211], v[72:75], 0
  ds_read_b128 v[220:223], v71 offset:12416
  v_mfma_f32_16x16x32_bf16 v[188:191], v[208:211], v[76:79], 0
  s_add_u32 m0, s81, 0
  s_nop 0
  buffer_load_dwordx4 v48, s[12:15], s80 offen lds
  v_mfma_f32_16x16x32_bf16 v[192:195], v[208:211], v[80:83], 0
  s_waitcnt lgkmcnt(2)
  v_mfma_f32_16x16x32_bf16 v[184:187], v[212:215], v[84:87], v[184:187]
  ds_read_b128 v[208:211], v70 offset:12544
  v_cvt_pk_bf16_f32 v248, v196, v197
  v_mfma_f32_16x16x32_bf16 v[188:191], v[212:215], v[88:91], v[188:191]
  s_add_u32 m0, s81, 1024
  s_nop 0
  buffer_load_dwordx4 v49, s[12:15], s80 offen lds
  v_mfma_f32_16x16x32_bf16 v[192:195], v[212:215], v[92:95], v[192:195]
  v_cvt_pk_bf16_f32 v249, v198, v199
  s_waitcnt lgkmcnt(2)
  v_mfma_f32_16x16x32_bf16 v[184:187], v[216:219], v[96:99], v[184:187]
  ds_read_b128 v[212:215], v71 offset:12544
  v_cvt_pk_bf16_f32 v250, v200, v201
  v_mfma_f32_16x16x32_bf16 v[188:191], v[216:219], v[100:103], v[188:191]
  s_add_u32 m0, s81, 2048
  s_nop 0
  buffer_load_dwordx4 v50, s[12:15], s80 offen lds
  v_mfma_f32_16x16x32_bf16 v[192:195], v[216:219], v[104:107], v[192:195]
  v_cvt_pk_bf16_f32 v251, v202, v203
  s_waitcnt lgkmcnt(2)
  v_mfma_f32_16x16x32_bf16 v[184:187], v[220:223], v[108:111], v[184:187]
  ds_read_b128 v[216:219], v70 offset:13056
  v_accvgpr_write_b32 a6, v248
  v_mfma_f32_16x16x32_bf16 v[188:191], v[220:223], v[112:115], v[188:191]
  s_add_u32 m0, s81, 3072
  s_nop 0
  buffer_load_dwordx4 v51, s[12:15], s80 offen lds
  v_mfma_f32_16x16x32_bf16 v[192:195], v[220:223], v[116:119], v[192:195]
  v_accvgpr_write_b32 a7, v249
  s_waitcnt lgkmcnt(2)
  v_mfma_f32_16x16x32_bf16 v[184:187], v[208:211], v[120:123], v[184:187]
  ds_read_b128 v[220:223], v71 offset:13056
  v_accvgpr_write_b32 a86, v250
  v_mfma_f32_16x16x32_bf16 v[188:191], v[208:211], v[124:127], v[188:191]
  s_add_u32 m0, s81, 4096
  s_nop 0
  buffer_load_dwordx4 v52, s[12:15], s80 offen lds
  v_mfma_f32_16x16x32_bf16 v[192:195], v[208:211], v[128:131], v[192:195]
  v_accvgpr_write_b32 a87, v251
  s_waitcnt lgkmcnt(2)
  v_mfma_f32_16x16x32_bf16 v[184:187], v[212:215], v[132:135], v[184:187]
  ds_read_b128 v[208:211], v70 offset:13184
  s_mov_b64 exec, s[68:69]
  v_cvt_pk_bf16_f32 v146, v204, v205
  v_cvt_pk_bf16_f32 v147, v206, v207
  s_mov_b64 exec, -1
  v_mfma_f32_16x16x32_bf16 v[188:191], v[212:215], v[136:139], v[188:191]
  s_add_u32 m0, s81, 5120
  s_nop 0
  buffer_load_dwordx4 v53, s[12:15], s80 offen lds
  v_mfma_f32_16x16x32_bf16 v[192:195], v[212:215], v[140:143], v[192:195]
  s_waitcnt lgkmcnt(2)
  v_mfma_f32_16x16x32_bf16 v[196:199], v[216:219], v[72:75], 0
  ds_read_b128 v[212:215], v71 offset:13184
  v_mfma_f32_16x16x32_bf16 v[200:203], v[216:219], v[76:79], 0
  s_add_u32 m0, s81, 6144
  s_nop 0
  buffer_load_dwordx4 v54, s[12:15], s80 offen lds
  v_mfma_f32_16x16x32_bf16 v[204:207], v[216:219], v[80:83], 0
  s_waitcnt lgkmcnt(2)
  v_mfma_f32_16x16x32_bf16 v[196:199], v[220:223], v[84:87], v[196:199]
  ds_read_b128 v[216:219], v70 offset:13312
  v_cvt_pk_bf16_f32 v248, v184, v185
  v_mfma_f32_16x16x32_bf16 v[200:203], v[220:223], v[88:91], v[200:203]
  s_add_u32 m0, s81, 7168
  s_nop 0
  buffer_load_dwordx4 v55, s[12:15], s80 offen lds
  v_mfma_f32_16x16x32_bf16 v[204:207], v[220:223], v[92:95], v[204:207]
  v_cvt_pk_bf16_f32 v249, v186, v187
  s_waitcnt lgkmcnt(2)
  v_mfma_f32_16x16x32_bf16 v[196:199], v[208:211], v[96:99], v[196:199]
  ds_read_b128 v[220:223], v71 offset:13312
  v_cvt_pk_bf16_f32 v250, v188, v189
  v_mfma_f32_16x16x32_bf16 v[200:203], v[208:211], v[100:103], v[200:203]
  s_add_u32 m0, s81, 8192
  s_nop 0
  buffer_load_dwordx4 v56, s[12:15], s80 offen lds
  v_mfma_f32_16x16x32_bf16 v[204:207], v[208:211], v[104:107], v[204:207]
  v_cvt_pk_bf16_f32 v251, v190, v191
  s_waitcnt lgkmcnt(2)
  v_mfma_f32_16x16x32_bf16 v[196:199], v[212:215], v[108:111], v[196:199]
  v_accvgpr_write_b32 a8, v248
  v_mfma_f32_16x16x32_bf16 v[200:203], v[212:215], v[112:115], v[200:203]
  s_add_u32 m0, s81, 9216
  s_nop 0
  buffer_load_dwordx4 v57, s[12:15], s80 offen lds
  v_mfma_f32_16x16x32_bf16 v[204:207], v[212:215], v[116:119], v[204:207]
  v_accvgpr_write_b32 a9, v249
  s_waitcnt lgkmcnt(1)
  v_mfma_f32_16x16x32_bf16 v[196:199], v[216:219], v[120:123], v[196:199]
  v_accvgpr_write_b32 a88, v250
  v_mfma_f32_16x16x32_bf16 v[200:203], v[216:219], v[124:127], v[200:203]
  s_add_u32 m0, s81, 10240
  s_nop 0
  buffer_load_dwordx4 v58, s[12:15], s80 offen lds
  v_mfma_f32_16x16x32_bf16 v[204:207], v[216:219], v[128:131], v[204:207]
  v_accvgpr_write_b32 a89, v251
  s_waitcnt lgkmcnt(0)
  v_mfma_f32_16x16x32_bf16 v[196:199], v[220:223], v[132:135], v[196:199]
  v_cvt_pk_bf16_f32 v148, v192, v193
  v_cvt_pk_bf16_f32 v149, v194, v195
  v_mfma_f32_16x16x32_bf16 v[200:203], v[220:223], v[136:139], v[200:203]
  s_add_u32 m0, s81, 11264
  s_nop 0
  buffer_load_dwordx4 v59, s[12:15], s80 offen lds
  s_add_u32 s80, s80, 393216
  v_mfma_f32_16x16x32_bf16 v[204:207], v[220:223], v[140:143], v[204:207]
  s_waitcnt vmcnt(12)
  ds_read_b128 v[208:211], v70 offset:24576
  ds_read_b128 v[212:215], v71 offset:24576
  ds_read_b128 v[216:219], v70 offset:24704
  s_waitcnt lgkmcnt(2)
  v_mfma_f32_16x16x32_bf16 v[184:187], v[208:211], v[72:75], 0
  ds_read_b128 v[220:223], v71 offset:24704
  v_mfma_f32_16x16x32_bf16 v[188:191], v[208:211], v[76:79], 0
  s_add_u32 m0, s81, 12288
  s_nop 0
  buffer_load_dwordx4 v48, s[12:15], s80 offen lds
  v_mfma_f32_16x16x32_bf16 v[192:195], v[208:211], v[80:83], 0
  s_waitcnt lgkmcnt(2)
  v_mfma_f32_16x16x32_bf16 v[184:187], v[212:215], v[84:87], v[184:187]
  ds_read_b128 v[208:211], v70 offset:24832
  v_cvt_pk_bf16_f32 v248, v196, v197
  v_mfma_f32_16x16x32_bf16 v[188:191], v[212:215], v[88:91], v[188:191]
  s_add_u32 m0, s81, 13312
  s_nop 0
  buffer_load_dwordx4 v49, s[12:15], s80 offen lds
  v_mfma_f32_16x16x32_bf16 v[192:195], v[212:215], v[92:95], v[192:195]
  v_cvt_pk_bf16_f32 v249, v198, v199
  s_waitcnt lgkmcnt(2)
  v_mfma_f32_16x16x32_bf16 v[184:187], v[216:219], v[96:99], v[184:187]
  ds_read_b128 v[212:215], v71 offset:24832
  v_cvt_pk_bf16_f32 v250, v200, v201
  v_mfma_f32_16x16x32_bf16 v[188:191], v[216:219], v[100:103], v[188:191]
  s_add_u32 m0, s81, 14336
  s_nop 0
  buffer_load_dwordx4 v50, s[12:15], s80 offen lds
  v_mfma_f32_16x16x32_bf16 v[192:195], v[216:219], v[104:107], v[192:195]
  v_cvt_pk_bf16_f32 v251, v202, v203
  s_waitcnt lgkmcnt(2)
  v_mfma_f32_16x16x32_bf16 v[184:187], v[220:223], v[108:111], v[184:187]
  ds_read_b128 v[216:219], v70 offset:25344
  v_accvgpr_write_b32 a10, v248
  v_mfma_f32_16x16x32_bf16 v[188:191], v[220:223], v[112:115], v[188:191]
  s_add_u32 m0, s81, 15360
  s_nop 0
  buffer_load_dwordx4 v51, s[12:15], s80 offen lds
  v_mfma_f32_16x16x32_bf16 v[192:195], v[220:223], v[116:119], v[192:195]
  v_accvgpr_write_b32 a11, v249
  s_waitcnt lgkmcnt(2)
  v_mfma_f32_16x16x32_bf16 v[184:187], v[208:211], v[120:123], v[184:187]
  ds_read_b128 v[220:223], v71 offset:25344
  v_accvgpr_write_b32 a90, v250
  v_mfma_f32_16x16x32_bf16 v[188:191], v[208:211], v[124:127], v[188:191]
  s_add_u32 m0, s81, 16384
  s_nop 0
  buffer_load_dwordx4 v52, s[12:15], s80 offen lds
  v_mfma_f32_16x16x32_bf16 v[192:195], v[208:211], v[128:131], v[192:195]
  v_accvgpr_write_b32 a91, v251
  s_waitcnt lgkmcnt(2)
  v_mfma_f32_16x16x32_bf16 v[184:187], v[212:215], v[132:135], v[184:187]
  ds_read_b128 v[208:211], v70 offset:25472
  s_mov_b64 exec, s[68:69]
  v_cvt_pk_bf16_f32 v148, v204, v205
  v_cvt_pk_bf16_f32 v149, v206, v207
  s_mov_b64 exec, -1
  v_mfma_f32_16x16x32_bf16 v[188:191], v[212:215], v[136:139], v[188:191]
  s_add_u32 m0, s81, 17408
  s_nop 0
  buffer_load_dwordx4 v53, s[12:15], s80 offen lds
  v_mfma_f32_16x16x32_bf16 v[192:195], v[212:215], v[140:143], v[192:195]
  s_waitcnt lgkmcnt(2)
  v_mfma_f32_16x16x32_bf16 v[196:199], v[216:219], v[72:75], 0
  ds_read_b128 v[212:215], v71 offset:25472
  v_mfma_f32_16x16x32_bf16 v[200:203], v[216:219], v[76:79], 0
  s_add_u32 m0, s81, 18432
  s_nop 0
  buffer_load_dwordx4 v54, s[12:15], s80 offen lds
  v_mfma_f32_16x16x32_bf16 v[204:207], v[216:219], v[80:83], 0
  s_waitcnt lgkmcnt(2)
  v_mfma_f32_16x16x32_bf16 v[196:199], v[220:223], v[84:87], v[196:199]
  ds_read_b128 v[216:219], v70 offset:25600
  v_cvt_pk_bf16_f32 v248, v184, v185
  v_mfma_f32_16x16x32_bf16 v[200:203], v[220:223], v[88:91], v[200:203]
  s_add_u32 m0, s81, 19456
  s_nop 0
  buffer_load_dwordx4 v55, s[12:15], s80 offen lds
  v_mfma_f32_16x16x32_bf16 v[204:207], v[220:223], v[92:95], v[204:207]
  v_cvt_pk_bf16_f32 v249, v186, v187
  s_waitcnt lgkmcnt(2)
  v_mfma_f32_16x16x32_bf16 v[196:199], v[208:211], v[96:99], v[196:199]
  ds_read_b128 v[220:223], v71 offset:25600
  v_cvt_pk_bf16_f32 v250, v188, v189
  v_mfma_f32_16x16x32_bf16 v[200:203], v[208:211], v[100:103], v[200:203]
  s_add_u32 m0, s81, 20480
  s_nop 0
  buffer_load_dwordx4 v56, s[12:15], s80 offen lds
  v_mfma_f32_16x16x32_bf16 v[204:207], v[208:211], v[104:107], v[204:207]
  v_cvt_pk_bf16_f32 v251, v190, v191
  s_waitcnt lgkmcnt(2)
  v_mfma_f32_16x16x32_bf16 v[196:199], v[212:215], v[108:111], v[196:199]
  v_accvgpr_write_b32 a12, v248
  v_mfma_f32_16x16x32_bf16 v[200:203], v[212:215], v[112:115], v[200:203]
  s_add_u32 m0, s81, 21504
  s_nop 0
  buffer_load_dwordx4 v57, s[12:15], s80 offen lds
  v_mfma_f32_16x16x32_bf16 v[204:207], v[212:215], v[116:119], v[204:207]
  v_accvgpr_write_b32 a13, v249
  s_waitcnt lgkmcnt(1)
  v_mfma_f32_16x16x32_bf16 v[196:199], v[216:219], v[120:123], v[196:199]
  v_accvgpr_write_b32 a92, v250
  v_mfma_f32_16x16x32_bf16 v[200:203], v[216:219], v[124:127], v[200:203]
  s_add_u32 m0, s81, 22528
  s_nop 0
  buffer_load_dwordx4 v58, s[12:15], s80 offen lds
  v_mfma_f32_16x16x32_bf16 v[204:207], v[216:219], v[128:131], v[204:207]
  v_accvgpr_write_b32 a93, v251
  s_waitcnt lgkmcnt(0)
  v_mfma_f32_16x16x32_bf16 v[196:199], v[220:223], v[132:135], v[196:199]
  v_cvt_pk_bf16_f32 v150, v192, v193
  v_cvt_pk_bf16_f32 v151, v194, v195
  v_mfma_f32_16x16x32_bf16 v[200:203], v[220:223], v[136:139], v[200:203]
  s_add_u32 m0, s81, 23552
  s_nop 0
  buffer_load_dwordx4 v59, s[12:15], s80 offen lds
  s_add_u32 s80, s80, 393216
  v_mfma_f32_16x16x32_bf16 v[204:207], v[220:223], v[140:143], v[204:207]
  s_waitcnt vmcnt(12)
  ds_read_b128 v[208:211], v70 offset:0
  ds_read_b128 v[212:215], v71 offset:0
  ds_read_b128 v[216:219], v70 offset:128
  s_waitcnt lgkmcnt(2)
  v_mfma_f32_16x16x32_bf16 v[184:187], v[208:211], v[72:75], 0
  ds_read_b128 v[220:223], v71 offset:128
  v_mfma_f32_16x16x32_bf16 v[188:191], v[208:211], v[76:79], 0
  s_add_u32 m0, s81, 24576
  s_nop 0
  buffer_load_dwordx4 v48, s[12:15], s80 offen lds
  v_mfma_f32_16x16x32_bf16 v[192:195], v[208:211], v[80:83], 0
  s_waitcnt lgkmcnt(2)
  v_mfma_f32_16x16x32_bf16 v[184:187], v[212:215], v[84:87], v[184:187]
  ds_read_b128 v[208:211], v70 offset:256
  v_cvt_pk_bf16_f32 v248, v196, v197
  v_mfma_f32_16x16x32_bf16 v[188:191], v[212:215], v[88:91], v[188:191]
  s_add_u32 m0, s81, 25600
  s_nop 0
  buffer_load_dwordx4 v49, s[12:15], s80 offen lds
  v_mfma_f32_16x16x32_bf16 v[192:195], v[212:215], v[92:95], v[192:195]
  v_cvt_pk_bf16_f32 v249, v198, v199
  s_waitcnt lgkmcnt(2)
  v_mfma_f32_16x16x32_bf16 v[184:187], v[216:219], v[96:99], v[184:187]
  ds_read_b128 v[212:215], v71 offset:256
  v_cvt_pk_bf16_f32 v250, v200, v201
  v_mfma_f32_16x16x32_bf16 v[188:191], v[216:219], v[100:103], v[188:191]
  s_add_u32 m0, s81, 26624
  s_nop 0
  buffer_load_dwordx4 v50, s[12:15], s80 offen lds
  v_mfma_f32_16x16x32_bf16 v[192:195], v[216:219], v[104:107], v[192:195]
  v_cvt_pk_bf16_f32 v251, v202, v203
  s_waitcnt lgkmcnt(2)
  v_mfma_f32_16x16x32_bf16 v[184:187], v[220:223], v[108:111], v[184:187]
  ds_read_b128 v[216:219], v70 offset:768
  v_accvgpr_write_b32 a14, v248
  v_mfma_f32_16x16x32_bf16 v[188:191], v[220:223], v[112:115], v[188:191]
  s_add_u32 m0, s81, 27648
  s_nop 0
  buffer_load_dwordx4 v51, s[12:15], s80 offen lds
  v_mfma_f32_16x16x32_bf16 v[192:195], v[220:223], v[116:119], v[192:195]
  v_accvgpr_write_b32 a15, v249
  s_waitcnt lgkmcnt(2)
  v_mfma_f32_16x16x32_bf16 v[184:187], v[208:211], v[120:123], v[184:187]
  ds_read_b128 v[220:223], v71 offset:768
  v_accvgpr_write_b32 a94, v250
  v_mfma_f32_16x16x32_bf16 v[188:191], v[208:211], v[124:127], v[188:191]
  s_add_u32 m0, s81, 28672
  s_nop 0
  buffer_load_dwordx4 v52, s[12:15], s80 offen lds
  v_mfma_f32_16x16x32_bf16 v[192:195], v[208:211], v[128:131], v[192:195]
  v_accvgpr_write_b32 a95, v251
  s_waitcnt lgkmcnt(2)
  v_mfma_f32_16x16x32_bf16 v[184:187], v[212:215], v[132:135], v[184:187]
  ds_read_b128 v[208:211], v70 offset:896
  s_mov_b64 exec, s[68:69]
  v_cvt_pk_bf16_f32 v150, v204, v205
  v_cvt_pk_bf16_f32 v151, v206, v207
  s_mov_b64 exec, -1
  v_mfma_f32_16x16x32_bf16 v[188:191], v[212:215], v[136:139], v[188:191]
  s_add_u32 m0, s81, 29696
  s_nop 0
  buffer_load_dwordx4 v53, s[12:15], s80 offen lds
  v_mfma_f32_16x16x32_bf16 v[192:195], v[212:215], v[140:143], v[192:195]
  s_waitcnt lgkmcnt(2)
  v_mfma_f32_16x16x32_bf16 v[196:199], v[216:219], v[72:75], 0
  ds_read_b128 v[212:215], v71 offset:896
  v_mfma_f32_16x16x32_bf16 v[200:203], v[216:219], v[76:79], 0
  s_add_u32 m0, s81, 30720
  s_nop 0
  buffer_load_dwordx4 v54, s[12:15], s80 offen lds
  v_mfma_f32_16x16x32_bf16 v[204:207], v[216:219], v[80:83], 0
  s_waitcnt lgkmcnt(2)
  v_mfma_f32_16x16x32_bf16 v[196:199], v[220:223], v[84:87], v[196:199]
  ds_read_b128 v[216:219], v70 offset:1024
  v_cvt_pk_bf16_f32 v248, v184, v185
  v_mfma_f32_16x16x32_bf16 v[200:203], v[220:223], v[88:91], v[200:203]
  s_add_u32 m0, s81, 31744
  s_nop 0
  buffer_load_dwordx4 v55, s[12:15], s80 offen lds
  v_mfma_f32_16x16x32_bf16 v[204:207], v[220:223], v[92:95], v[204:207]
  v_cvt_pk_bf16_f32 v249, v186, v187
  s_waitcnt lgkmcnt(2)
  v_mfma_f32_16x16x32_bf16 v[196:199], v[208:211], v[96:99], v[196:199]
  ds_read_b128 v[220:223], v71 offset:1024
  v_cvt_pk_bf16_f32 v250, v188, v189
  v_mfma_f32_16x16x32_bf16 v[200:203], v[208:211], v[100:103], v[200:203]
  s_add_u32 m0, s81, 32768
  s_nop 0
  buffer_load_dwordx4 v56, s[12:15], s80 offen lds
  v_mfma_f32_16x16x32_bf16 v[204:207], v[208:211], v[104:107], v[204:207]
  v_cvt_pk_bf16_f32 v251, v190, v191
  s_waitcnt lgkmcnt(2)
  v_mfma_f32_16x16x32_bf16 v[196:199], v[212:215], v[108:111], v[196:199]
  v_accvgpr_write_b32 a16, v248
  v_mfma_f32_16x16x32_bf16 v[200:203], v[212:215], v[112:115], v[200:203]
  s_add_u32 m0, s81, 33792
  s_nop 0
  buffer_load_dwordx4 v57, s[12:15], s80 offen lds
  v_mfma_f32_16x16x32_bf16 v[204:207], v[212:215], v[116:119], v[204:207]
  v_accvgpr_write_b32 a17, v249
  s_waitcnt lgkmcnt(1)
  v_mfma_f32_16x16x32_bf16 v[196:199], v[216:219], v[120:123], v[196:199]
  v_accvgpr_write_b32 a96, v250
  v_mfma_f32_16x16x32_bf16 v[200:203], v[216:219], v[124:127], v[200:203]
  s_add_u32 m0, s81, 34816
  s_nop 0
  buffer_load_dwordx4 v58, s[12:15], s80 offen lds
  v_mfma_f32_16x16x32_bf16 v[204:207], v[216:219], v[128:131], v[204:207]
  v_accvgpr_write_b32 a97, v251
  s_waitcnt lgkmcnt(0)
  v_mfma_f32_16x16x32_bf16 v[196:199], v[220:223], v[132:135], v[196:199]
  v_cvt_pk_bf16_f32 v152, v192, v193
  v_cvt_pk_bf16_f32 v153, v194, v195
  v_mfma_f32_16x16x32_bf16 v[200:203], v[220:223], v[136:139], v[200:203]
  s_add_u32 m0, s81, 35840
  s_nop 0
  buffer_load_dwordx4 v59, s[12:15], s80 offen lds
  s_add_u32 s80, s80, 393216
  v_mfma_f32_16x16x32_bf16 v[204:207], v[220:223], v[140:143], v[204:207]
  s_waitcnt vmcnt(12)
  ds_read_b128 v[208:211], v70 offset:12288
  ds_read_b128 v[212:215], v71 offset:12288
  ds_read_b128 v[216:219], v70 offset:12416
  s_waitcnt lgkmcnt(2)
  v_mfma_f32_16x16x32_bf16 v[184:187], v[208:211], v[72:75], 0
  ds_read_b128 v[220:223], v71 offset:12416
  v_mfma_f32_16x16x32_bf16 v[188:191], v[208:211], v[76:79], 0
  s_add_u32 m0, s81, 0
  s_nop 0
  buffer_load_dwordx4 v48, s[12:15], s80 offen lds
  v_mfma_f32_16x16x32_bf16 v[192:195], v[208:211], v[80:83], 0
  s_waitcnt lgkmcnt(2)
  v_mfma_f32_16x16x32_bf16 v[184:187], v[212:215], v[84:87], v[184:187]
  ds_read_b128 v[208:211], v70 offset:12544
  v_cvt_pk_bf16_f32 v248, v196, v197
  v_mfma_f32_16x16x32_bf16 v[188:191], v[212:215], v[88:91], v[188:191]
  s_add_u32 m0, s81, 1024
  s_nop 0
  buffer_load_dwordx4 v49, s[12:15], s80 offen lds
  v_mfma_f32_16x16x32_bf16 v[192:195], v[212:215], v[92:95], v[192:195]
  v_cvt_pk_bf16_f32 v249, v198, v199
  s_waitcnt lgkmcnt(2)
  v_mfma_f32_16x16x32_bf16 v[184:187], v[216:219], v[96:99], v[184:187]
  ds_read_b128 v[212:215], v71 offset:12544
  v_cvt_pk_bf16_f32 v250, v200, v201
  v_mfma_f32_16x16x32_bf16 v[188:191], v[216:219], v[100:103], v[188:191]
  s_add_u32 m0, s81, 2048
  s_nop 0
  buffer_load_dwordx4 v50, s[12:15], s80 offen lds
  v_mfma_f32_16x16x32_bf16 v[192:195], v[216:219], v[104:107], v[192:195]
  v_cvt_pk_bf16_f32 v251, v202, v203
  s_waitcnt lgkmcnt(2)
  v_mfma_f32_16x16x32_bf16 v[184:187], v[220:223], v[108:111], v[184:187]
  ds_read_b128 v[216:219], v70 offset:13056
  v_accvgpr_write_b32 a18, v248
  v_mfma_f32_16x16x32_bf16 v[188:191], v[220:223], v[112:115], v[188:191]
  s_add_u32 m0, s81, 3072
  s_nop 0
  buffer_load_dwordx4 v51, s[12:15], s80 offen lds
  v_mfma_f32_16x16x32_bf16 v[192:195], v[220:223], v[116:119], v[192:195]
  v_accvgpr_write_b32 a19, v249
  s_waitcnt lgkmcnt(2)
  v_mfma_f32_16x16x32_bf16 v[184:187], v[208:211], v[120:123], v[184:187]
  ds_read_b128 v[220:223], v71 offset:13056
  v_accvgpr_write_b32 a98, v250
  v_mfma_f32_16x16x32_bf16 v[188:191], v[208:211], v[124:127], v[188:191]
  s_add_u32 m0, s81, 4096
  s_nop 0
  buffer_load_dwordx4 v52, s[12:15], s80 offen lds
  v_mfma_f32_16x16x32_bf16 v[192:195], v[208:211], v[128:131], v[192:195]
  v_accvgpr_write_b32 a99, v251
  s_waitcnt lgkmcnt(2)
  v_mfma_f32_16x16x32_bf16 v[184:187], v[212:215], v[132:135], v[184:187]
  ds_read_b128 v[208:211], v70 offset:13184
  s_mov_b64 exec, s[68:69]
  v_cvt_pk_bf16_f32 v152, v204, v205
  v_cvt_pk_bf16_f32 v153, v206, v207
  s_mov_b64 exec, -1
  v_mfma_f32_16x16x32_bf16 v[188:191], v[212:215], v[136:139], v[188:191]
  s_add_u32 m0, s81, 5120
  s_nop 0
  buffer_load_dwordx4 v53, s[12:15], s80 offen lds
  v_mfma_f32_16x16x32_bf16 v[192:195], v[212:215], v[140:143], v[192:195]
  s_waitcnt lgkmcnt(2)
  v_mfma_f32_16x16x32_bf16 v[196:199], v[216:219], v[72:75], 0
  ds_read_b128 v[212:215], v71 offset:13184
  v_mfma_f32_16x16x32_bf16 v[200:203], v[216:219], v[76:79], 0
  s_add_u32 m0, s81, 6144
  s_nop 0
  buffer_load_dwordx4 v54, s[12:15], s80 offen lds
  v_mfma_f32_16x16x32_bf16 v[204:207], v[216:219], v[80:83], 0
  s_waitcnt lgkmcnt(2)
  v_mfma_f32_16x16x32_bf16 v[196:199], v[220:223], v[84:87], v[196:199]
  ds_read_b128 v[216:219], v70 offset:13312
  v_cvt_pk_bf16_f32 v248, v184, v185
  v_mfma_f32_16x16x32_bf16 v[200:203], v[220:223], v[88:91], v[200:203]
  s_add_u32 m0, s81, 7168
  s_nop 0
  buffer_load_dwordx4 v55, s[12:15], s80 offen lds
  v_mfma_f32_16x16x32_bf16 v[204:207], v[220:223], v[92:95], v[204:207]
  v_cvt_pk_bf16_f32 v249, v186, v187
  s_waitcnt lgkmcnt(2)
  v_mfma_f32_16x16x32_bf16 v[196:199], v[208:211], v[96:99], v[196:199]
  ds_read_b128 v[220:223], v71 offset:13312
  v_cvt_pk_bf16_f32 v250, v188, v189
  v_mfma_f32_16x16x32_bf16 v[200:203], v[208:211], v[100:103], v[200:203]
  s_add_u32 m0, s81, 8192
  s_nop 0
  buffer_load_dwordx4 v56, s[12:15], s80 offen lds
  v_mfma_f32_16x16x32_bf16 v[204:207], v[208:211], v[104:107], v[204:207]
  v_cvt_pk_bf16_f32 v251, v190, v191
  s_waitcnt lgkmcnt(2)
  v_mfma_f32_16x16x32_bf16 v[196:199], v[212:215], v[108:111], v[196:199]
  v_accvgpr_write_b32 a20, v248
  v_mfma_f32_16x16x32_bf16 v[200:203], v[212:215], v[112:115], v[200:203]
  s_add_u32 m0, s81, 9216
  s_nop 0
  buffer_load_dwordx4 v57, s[12:15], s80 offen lds
  v_mfma_f32_16x16x32_bf16 v[204:207], v[212:215], v[116:119], v[204:207]
  v_accvgpr_write_b32 a21, v249
  s_waitcnt lgkmcnt(1)
  v_mfma_f32_16x16x32_bf16 v[196:199], v[216:219], v[120:123], v[196:199]
  v_accvgpr_write_b32 a100, v250
  v_mfma_f32_16x16x32_bf16 v[200:203], v[216:219], v[124:127], v[200:203]
  s_add_u32 m0, s81, 10240
  s_nop 0
  buffer_load_dwordx4 v58, s[12:15], s80 offen lds
  v_mfma_f32_16x16x32_bf16 v[204:207], v[216:219], v[128:131], v[204:207]
  v_accvgpr_write_b32 a101, v251
  s_waitcnt lgkmcnt(0)
  v_mfma_f32_16x16x32_bf16 v[196:199], v[220:223], v[132:135], v[196:199]
  v_cvt_pk_bf16_f32 v154, v192, v193
  v_cvt_pk_bf16_f32 v155, v194, v195
  v_mfma_f32_16x16x32_bf16 v[200:203], v[220:223], v[136:139], v[200:203]
  s_add_u32 m0, s81, 11264
  s_nop 0
  buffer_load_dwordx4 v59, s[12:15], s80 offen lds
  s_add_u32 s80, s80, 393216
  v_mfma_f32_16x16x32_bf16 v[204:207], v[220:223], v[140:143], v[204:207]
  s_add_u32 s21, s79, 0
  buffer_load_dwordx4 a[172:175], v63, s[28:31], s21 offen
  s_add_u32 s21, s79, 0
  buffer_load_dwordx4 a[176:179], v64, s[28:31], s21 offen
  s_add_u32 s21, s79, 0
  buffer_load_dwordx4 a[180:183], v65, s[28:31], s21 offen
  s_waitcnt vmcnt(15)
  ds_read_b128 v[208:211], v70 offset:24576
  ds_read_b128 v[212:215], v71 offset:24576
  ds_read_b128 v[216:219], v70 offset:24704
  s_waitcnt lgkmcnt(2)
  v_mfma_f32_16x16x32_bf16 v[184:187], v[208:211], v[72:75], 0
  ds_read_b128 v[220:223], v71 offset:24704
  v_mfma_f32_16x16x32_bf16 v[188:191], v[208:211], v[76:79], 0
  s_add_u32 m0, s81, 12288
  s_nop 0
  buffer_load_dwordx4 v48, s[12:15], s80 offen lds
  v_mfma_f32_16x16x32_bf16 v[192:195], v[208:211], v[80:83], 0
  s_waitcnt lgkmcnt(2)
  v_mfma_f32_16x16x32_bf16 v[184:187], v[212:215], v[84:87], v[184:187]
  ds_read_b128 v[208:211], v70 offset:24832
  v_cvt_pk_bf16_f32 v248, v196, v197
  v_mfma_f32_16x16x32_bf16 v[188:191], v[212:215], v[88:91], v[188:191]
  s_add_u32 m0, s81, 13312
  s_nop 0
  buffer_load_dwordx4 v49, s[12:15], s80 offen lds
  v_mfma_f32_16x16x32_bf16 v[192:195], v[212:215], v[92:95], v[192:195]
  v_cvt_pk_bf16_f32 v249, v198, v199
  s_waitcnt lgkmcnt(2)
  v_mfma_f32_16x16x32_bf16 v[184:187], v[216:219], v[96:99], v[184:187]
  ds_read_b128 v[212:215], v71 offset:24832
  v_cvt_pk_bf16_f32 v250, v200, v201
  v_mfma_f32_16x16x32_bf16 v[188:191], v[216:219], v[100:103], v[188:191]
  s_add_u32 m0, s81, 14336
  s_nop 0
  buffer_load_dwordx4 v50, s[12:15], s80 offen lds
  v_mfma_f32_16x16x32_bf16 v[192:195], v[216:219], v[104:107], v[192:195]
  v_cvt_pk_bf16_f32 v251, v202, v203
  s_waitcnt lgkmcnt(2)
  v_mfma_f32_16x16x32_bf16 v[184:187], v[220:223], v[108:111], v[184:187]
  ds_read_b128 v[216:219], v70 offset:25344
  v_accvgpr_write_b32 a22, v248
  v_mfma_f32_16x16x32_bf16 v[188:191], v[220:223], v[112:115], v[188:191]
  s_add_u32 m0, s81, 15360
  s_nop 0
  buffer_load_dwordx4 v51, s[12:15], s80 offen lds
  v_mfma_f32_16x16x32_bf16 v[192:195], v[220:223], v[116:119], v[192:195]
  v_accvgpr_write_b32 a23, v249
  s_waitcnt lgkmcnt(2)
  v_mfma_f32_16x16x32_bf16 v[184:187], v[208:211], v[120:123], v[184:187]
  ds_read_b128 v[220:223], v71 offset:25344
  v_accvgpr_write_b32 a102, v250
  v_mfma_f32_16x16x32_bf16 v[188:191], v[208:211], v[124:127], v[188:191]
  s_add_u32 m0, s81, 16384
  s_nop 0
  buffer_load_dwordx4 v52, s[12:15], s80 offen lds
  v_mfma_f32_16x16x32_bf16 v[192:195], v[208:211], v[128:131], v[192:195]
  v_accvgpr_write_b32 a103, v251
  s_waitcnt lgkmcnt(2)
  v_mfma_f32_16x16x32_bf16 v[184:187], v[212:215], v[132:135], v[184:187]
  ds_read_b128 v[208:211], v70 offset:25472
  s_mov_b64 exec, s[68:69]
  v_cvt_pk_bf16_f32 v154, v204, v205
  v_cvt_pk_bf16_f32 v155, v206, v207
  s_mov_b64 exec, -1
  v_mfma_f32_16x16x32_bf16 v[188:191], v[212:215], v[136:139], v[188:191]
  s_add_u32 m0, s81, 17408
  s_nop 0
  buffer_load_dwordx4 v53, s[12:15], s80 offen lds
  v_mfma_f32_16x16x32_bf16 v[192:195], v[212:215], v[140:143], v[192:195]
  s_waitcnt lgkmcnt(2)
  v_mfma_f32_16x16x32_bf16 v[196:199], v[216:219], v[72:75], 0
  ds_read_b128 v[212:215], v71 offset:25472
  v_mfma_f32_16x16x32_bf16 v[200:203], v[216:219], v[76:79], 0
  s_add_u32 m0, s81, 18432
  s_nop 0
  buffer_load_dwordx4 v54, s[12:15], s80 offen lds
  v_mfma_f32_16x16x32_bf16 v[204:207], v[216:219], v[80:83], 0
  s_waitcnt lgkmcnt(2)
  v_mfma_f32_16x16x32_bf16 v[196:199], v[220:223], v[84:87], v[196:199]
  ds_read_b128 v[216:219], v70 offset:25600
  v_cvt_pk_bf16_f32 v248, v184, v185
  v_mfma_f32_16x16x32_bf16 v[200:203], v[220:223], v[88:91], v[200:203]
  s_add_u32 m0, s81, 19456
  s_nop 0
  buffer_load_dwordx4 v55, s[12:15], s80 offen lds
  v_mfma_f32_16x16x32_bf16 v[204:207], v[220:223], v[92:95], v[204:207]
  v_cvt_pk_bf16_f32 v249, v186, v187
  s_waitcnt lgkmcnt(2)
  v_mfma_f32_16x16x32_bf16 v[196:199], v[208:211], v[96:99], v[196:199]
  ds_read_b128 v[220:223], v71 offset:25600
  v_cvt_pk_bf16_f32 v250, v188, v189
  v_mfma_f32_16x16x32_bf16 v[200:203], v[208:211], v[100:103], v[200:203]
  s_add_u32 m0, s81, 20480
  s_nop 0
  buffer_load_dwordx4 v56, s[12:15], s80 offen lds
  v_mfma_f32_16x16x32_bf16 v[204:207], v[208:211], v[104:107], v[204:207]
  v_cvt_pk_bf16_f32 v251, v190, v191
  s_waitcnt lgkmcnt(2)
  v_mfma_f32_16x16x32_bf16 v[196:199], v[212:215], v[108:111], v[196:199]
  v_accvgpr_write_b32 a24, v248
  v_mfma_f32_16x16x32_bf16 v[200:203], v[212:215], v[112:115], v[200:203]
  s_add_u32 m0, s81, 21504
  s_nop 0
  buffer_load_dwordx4 v57, s[12:15], s80 offen lds
  v_mfma_f32_16x16x32_bf16 v[204:207], v[212:215], v[116:119], v[204:207]
  v_accvgpr_write_b32 a25, v249
  s_waitcnt lgkmcnt(1)
  v_mfma_f32_16x16x32_bf16 v[196:199], v[216:219], v[120:123], v[196:199]
  v_accvgpr_write_b32 a104, v250
  v_mfma_f32_16x16x32_bf16 v[200:203], v[216:219], v[124:127], v[200:203]
  s_add_u32 m0, s81, 22528
  s_nop 0
  buffer_load_dwordx4 v58, s[12:15], s80 offen lds
  v_mfma_f32_16x16x32_bf16 v[204:207], v[216:219], v[128:131], v[204:207]
  v_accvgpr_write_b32 a105, v251
  s_waitcnt lgkmcnt(0)
  v_mfma_f32_16x16x32_bf16 v[196:199], v[220:223], v[132:135], v[196:199]
  v_cvt_pk_bf16_f32 v156, v192, v193
  v_cvt_pk_bf16_f32 v157, v194, v195
  v_mfma_f32_16x16x32_bf16 v[200:203], v[220:223], v[136:139], v[200:203]
  s_add_u32 m0, s81, 23552
  s_nop 0
  buffer_load_dwordx4 v59, s[12:15], s80 offen lds
  s_add_u32 s80, s80, 393216
  v_mfma_f32_16x16x32_bf16 v[204:207], v[220:223], v[140:143], v[204:207]
  s_add_u32 s21, s79, 393216
  buffer_load_dwordx4 a[196:199], v63, s[28:31], s21 offen
  s_add_u32 s21, s79, 393216
  buffer_load_dwordx4 a[200:203], v64, s[28:31], s21 offen
  s_add_u32 s21, s79, 393216
  buffer_load_dwordx4 a[204:207], v65, s[28:31], s21 offen
  s_waitcnt vmcnt(18)
  ds_read_b128 v[208:211], v70 offset:0
  ds_read_b128 v[212:215], v71 offset:0
  ds_read_b128 v[216:219], v70 offset:128
  s_waitcnt lgkmcnt(2)
  v_mfma_f32_16x16x32_bf16 v[184:187], v[208:211], v[72:75], 0
  ds_read_b128 v[220:223], v71 offset:128
  v_mfma_f32_16x16x32_bf16 v[188:191], v[208:211], v[76:79], 0
  s_add_u32 m0, s81, 24576
  s_nop 0
  buffer_load_dwordx4 v48, s[12:15], s80 offen lds
  v_mfma_f32_16x16x32_bf16 v[192:195], v[208:211], v[80:83], 0
  s_waitcnt lgkmcnt(2)
  v_mfma_f32_16x16x32_bf16 v[184:187], v[212:215], v[84:87], v[184:187]
  ds_read_b128 v[208:211], v70 offset:256
  v_cvt_pk_bf16_f32 v248, v196, v197
  v_mfma_f32_16x16x32_bf16 v[188:191], v[212:215], v[88:91], v[188:191]
  s_add_u32 m0, s81, 25600
  s_nop 0
  buffer_load_dwordx4 v49, s[12:15], s80 offen lds
  v_mfma_f32_16x16x32_bf16 v[192:195], v[212:215], v[92:95], v[192:195]
  v_cvt_pk_bf16_f32 v249, v198, v199
  s_waitcnt lgkmcnt(2)
  v_mfma_f32_16x16x32_bf16 v[184:187], v[216:219], v[96:99], v[184:187]
  ds_read_b128 v[212:215], v71 offset:256
  v_cvt_pk_bf16_f32 v250, v200, v201
  v_mfma_f32_16x16x32_bf16 v[188:191], v[216:219], v[100:103], v[188:191]
  s_add_u32 m0, s81, 26624
  s_nop 0
  buffer_load_dwordx4 v50, s[12:15], s80 offen lds
  v_mfma_f32_16x16x32_bf16 v[192:195], v[216:219], v[104:107], v[192:195]
  v_cvt_pk_bf16_f32 v251, v202, v203
  s_waitcnt lgkmcnt(2)
  v_mfma_f32_16x16x32_bf16 v[184:187], v[220:223], v[108:111], v[184:187]
  ds_read_b128 v[216:219], v70 offset:768
  v_accvgpr_write_b32 a26, v248
  v_mfma_f32_16x16x32_bf16 v[188:191], v[220:223], v[112:115], v[188:191]
  s_add_u32 m0, s81, 27648
  s_nop 0
  buffer_load_dwordx4 v51, s[12:15], s80 offen lds
  v_mfma_f32_16x16x32_bf16 v[192:195], v[220:223], v[116:119], v[192:195]
  v_accvgpr_write_b32 a27, v249
  s_waitcnt lgkmcnt(2)
  v_mfma_f32_16x16x32_bf16 v[184:187], v[208:211], v[120:123], v[184:187]
  ds_read_b128 v[220:223], v71 offset:768
  v_accvgpr_write_b32 a106, v250
  v_mfma_f32_16x16x32_bf16 v[188:191], v[208:211], v[124:127], v[188:191]
  s_add_u32 m0, s81, 28672
  s_nop 0
  buffer_load_dwordx4 v52, s[12:15], s80 offen lds
  v_mfma_f32_16x16x32_bf16 v[192:195], v[208:211], v[128:131], v[192:195]
  v_accvgpr_write_b32 a107, v251
  s_waitcnt lgkmcnt(2)
  v_mfma_f32_16x16x32_bf16 v[184:187], v[212:215], v[132:135], v[184:187]
  ds_read_b128 v[208:211], v70 offset:896
  s_mov_b64 exec, s[68:69]
  v_cvt_pk_bf16_f32 v156, v204, v205
  v_cvt_pk_bf16_f32 v157, v206, v207
  s_mov_b64 exec, -1
  v_mfma_f32_16x16x32_bf16 v[188:191], v[212:215], v[136:139], v[188:191]
  s_add_u32 m0, s81, 29696
  s_nop 0
  buffer_load_dwordx4 v53, s[12:15], s80 offen lds
  v_mfma_f32_16x16x32_bf16 v[192:195], v[212:215], v[140:143], v[192:195]
  s_waitcnt lgkmcnt(2)
  v_mfma_f32_16x16x32_bf16 v[196:199], v[216:219], v[72:75], 0
  ds_read_b128 v[212:215], v71 offset:896
  v_mfma_f32_16x16x32_bf16 v[200:203], v[216:219], v[76:79], 0
  s_add_u32 m0, s81, 30720
  s_nop 0
  buffer_load_dwordx4 v54, s[12:15], s80 offen lds
  v_mfma_f32_16x16x32_bf16 v[204:207], v[216:219], v[80:83], 0
  s_waitcnt lgkmcnt(2)
  v_mfma_f32_16x16x32_bf16 v[196:199], v[220:223], v[84:87], v[196:199]
  ds_read_b128 v[216:219], v70 offset:1024
  v_cvt_pk_bf16_f32 v248, v184, v185
  v_mfma_f32_16x16x32_bf16 v[200:203], v[220:223], v[88:91], v[200:203]
  s_add_u32 m0, s81, 31744
  s_nop 0
  buffer_load_dwordx4 v55, s[12:15], s80 offen lds
  v_mfma_f32_16x16x32_bf16 v[204:207], v[220:223], v[92:95], v[204:207]
  v_cvt_pk_bf16_f32 v249, v186, v187
  s_waitcnt lgkmcnt(2)
  v_mfma_f32_16x16x32_bf16 v[196:199], v[208:211], v[96:99], v[196:199]
  ds_read_b128 v[220:223], v71 offset:1024
  v_cvt_pk_bf16_f32 v250, v188, v189
  v_mfma_f32_16x16x32_bf16 v[200:203], v[208:211], v[100:103], v[200:203]
  s_add_u32 m0, s81, 32768
  s_nop 0
  buffer_load_dwordx4 v56, s[12:15], s80 offen lds
  v_mfma_f32_16x16x32_bf16 v[204:207], v[208:211], v[104:107], v[204:207]
  v_cvt_pk_bf16_f32 v251, v190, v191
  s_waitcnt lgkmcnt(2)
  v_mfma_f32_16x16x32_bf16 v[196:199], v[212:215], v[108:111], v[196:199]
  v_accvgpr_write_b32 a28, v248
  v_mfma_f32_16x16x32_bf16 v[200:203], v[212:215], v[112:115], v[200:203]
  s_add_u32 m0, s81, 33792
  s_nop 0
  buffer_load_dwordx4 v57, s[12:15], s80 offen lds
  v_mfma_f32_16x16x32_bf16 v[204:207], v[212:215], v[116:119], v[204:207]
  v_accvgpr_write_b32 a29, v249
  s_waitcnt lgkmcnt(1)
  v_mfma_f32_16x16x32_bf16 v[196:199], v[216:219], v[120:123], v[196:199]
  v_accvgpr_write_b32 a108, v250
  v_mfma_f32_16x16x32_bf16 v[200:203], v[216:219], v[124:127], v[200:203]
  s_add_u32 m0, s81, 34816
  s_nop 0
  buffer_load_dwordx4 v58, s[12:15], s80 offen lds
  v_mfma_f32_16x16x32_bf16 v[204:207], v[216:219], v[128:131], v[204:207]
  v_accvgpr_write_b32 a109, v251
  s_waitcnt lgkmcnt(0)
  v_mfma_f32_16x16x32_bf16 v[196:199], v[220:223], v[132:135], v[196:199]
  v_cvt_pk_bf16_f32 v158, v192, v193
  v_cvt_pk_bf16_f32 v159, v194, v195
  v_mfma_f32_16x16x32_bf16 v[200:203], v[220:223], v[136:139], v[200:203]
  s_add_u32 m0, s81, 35840
  s_nop 0
  buffer_load_dwordx4 v59, s[12:15], s80 offen lds
  s_add_u32 s80, s80, 393216
  v_mfma_f32_16x16x32_bf16 v[204:207], v[220:223], v[140:143], v[204:207]
  s_add_u32 s21, s79, 786432
  buffer_load_dwordx4 a[220:223], v63, s[28:31], s21 offen
  s_add_u32 s21, s79, 786432
  buffer_load_dwordx4 a[224:227], v64, s[28:31], s21 offen
  s_add_u32 s21, s79, 786432
  buffer_load_dwordx4 a[228:231], v65, s[28:31], s21 offen
  s_waitcnt vmcnt(18)
  ds_read_b128 v[208:211], v70 offset:12288
  ds_read_b128 v[212:215], v71 offset:12288
  ds_read_b128 v[216:219], v70 offset:12416
  s_waitcnt lgkmcnt(2)
  v_mfma_f32_16x16x32_bf16 v[184:187], v[208:211], v[72:75], 0
  ds_read_b128 v[220:223], v71 offset:12416
  v_mfma_f32_16x16x32_bf16 v[188:191], v[208:211], v[76:79], 0
  s_add_u32 m0, s81, 0
  s_nop 0
  buffer_load_dwordx4 v48, s[12:15], s80 offen lds
  v_mfma_f32_16x16x32_bf16 v[192:195], v[208:211], v[80:83], 0
  s_waitcnt lgkmcnt(2)
  v_mfma_f32_16x16x32_bf16 v[184:187], v[212:215], v[84:87], v[184:187]
  ds_read_b128 v[208:211], v70 offset:12544
  v_cvt_pk_bf16_f32 v248, v196, v197
  v_mfma_f32_16x16x32_bf16 v[188:191], v[212:215], v[88:91], v[188:191]
  s_add_u32 m0, s81, 1024
  s_nop 0
  buffer_load_dwordx4 v49, s[12:15], s80 offen lds
  v_mfma_f32_16x16x32_bf16 v[192:195], v[212:215], v[92:95], v[192:195]
  v_cvt_pk_bf16_f32 v249, v198, v199
  s_waitcnt lgkmcnt(2)
  v_mfma_f32_16x16x32_bf16 v[184:187], v[216:219], v[96:99], v[184:187]
  ds_read_b128 v[212:215], v71 offset:12544
  v_cvt_pk_bf16_f32 v250, v200, v201
  v_mfma_f32_16x16x32_bf16 v[188:191], v[216:219], v[100:103], v[188:191]
  s_add_u32 m0, s81, 2048
  s_nop 0
  buffer_load_dwordx4 v50, s[12:15], s80 offen lds
  v_mfma_f32_16x16x32_bf16 v[192:195], v[216:219], v[104:107], v[192:195]
  v_cvt_pk_bf16_f32 v251, v202, v203
  s_waitcnt lgkmcnt(2)
  v_mfma_f32_16x16x32_bf16 v[184:187], v[220:223], v[108:111], v[184:187]
  ds_read_b128 v[216:219], v70 offset:13056
  v_accvgpr_write_b32 a30, v248
  v_mfma_f32_16x16x32_bf16 v[188:191], v[220:223], v[112:115], v[188:191]
  s_add_u32 m0, s81, 3072
  s_nop 0
  buffer_load_dwordx4 v51, s[12:15], s80 offen lds
  v_mfma_f32_16x16x32_bf16 v[192:195], v[220:223], v[116:119], v[192:195]
  v_accvgpr_write_b32 a31, v249
  s_waitcnt lgkmcnt(2)
  v_mfma_f32_16x16x32_bf16 v[184:187], v[208:211], v[120:123], v[184:187]
  ds_read_b128 v[220:223], v71 offset:13056
  v_accvgpr_write_b32 a110, v250
  v_mfma_f32_16x16x32_bf16 v[188:191], v[208:211], v[124:127], v[188:191]
  s_add_u32 m0, s81, 4096
  s_nop 0
  buffer_load_dwordx4 v52, s[12:15], s80 offen lds
  v_mfma_f32_16x16x32_bf16 v[192:195], v[208:211], v[128:131], v[192:195]
  v_accvgpr_write_b32 a111, v251
  s_waitcnt lgkmcnt(2)
  v_mfma_f32_16x16x32_bf16 v[184:187], v[212:215], v[132:135], v[184:187]
  ds_read_b128 v[208:211], v70 offset:13184
  s_mov_b64 exec, s[68:69]
  v_cvt_pk_bf16_f32 v158, v204, v205
  v_cvt_pk_bf16_f32 v159, v206, v207
  s_mov_b64 exec, -1
  v_mfma_f32_16x16x32_bf16 v[188:191], v[212:215], v[136:139], v[188:191]
  s_add_u32 m0, s81, 5120
  s_nop 0
  buffer_load_dwordx4 v53, s[12:15], s80 offen lds
  v_mfma_f32_16x16x32_bf16 v[192:195], v[212:215], v[140:143], v[192:195]
  s_waitcnt lgkmcnt(2)
  v_mfma_f32_16x16x32_bf16 v[196:199], v[216:219], v[72:75], 0
  ds_read_b128 v[212:215], v71 offset:13184
  v_mfma_f32_16x16x32_bf16 v[200:203], v[216:219], v[76:79], 0
  s_add_u32 m0, s81, 6144
  s_nop 0
  buffer_load_dwordx4 v54, s[12:15], s80 offen lds
  v_mfma_f32_16x16x32_bf16 v[204:207], v[216:219], v[80:83], 0
  s_waitcnt lgkmcnt(2)
  v_mfma_f32_16x16x32_bf16 v[196:199], v[220:223], v[84:87], v[196:199]
  ds_read_b128 v[216:219], v70 offset:13312
  v_cvt_pk_bf16_f32 v248, v184, v185
  v_mfma_f32_16x16x32_bf16 v[200:203], v[220:223], v[88:91], v[200:203]
  s_add_u32 m0, s81, 7168
  s_nop 0
  buffer_load_dwordx4 v55, s[12:15], s80 offen lds
  v_mfma_f32_16x16x32_bf16 v[204:207], v[220:223], v[92:95], v[204:207]
  v_cvt_pk_bf16_f32 v249, v186, v187
  s_waitcnt lgkmcnt(2)
  v_mfma_f32_16x16x32_bf16 v[196:199], v[208:211], v[96:99], v[196:199]
  ds_read_b128 v[220:223], v71 offset:13312
  v_cvt_pk_bf16_f32 v250, v188, v189
  v_mfma_f32_16x16x32_bf16 v[200:203], v[208:211], v[100:103], v[200:203]
  s_add_u32 m0, s81, 8192
  s_nop 0
  buffer_load_dwordx4 v56, s[12:15], s80 offen lds
  v_mfma_f32_16x16x32_bf16 v[204:207], v[208:211], v[104:107], v[204:207]
  v_cvt_pk_bf16_f32 v251, v190, v191
  s_waitcnt lgkmcnt(2)
  v_mfma_f32_16x16x32_bf16 v[196:199], v[212:215], v[108:111], v[196:199]
  v_accvgpr_write_b32 a32, v248
  v_mfma_f32_16x16x32_bf16 v[200:203], v[212:215], v[112:115], v[200:203]
  s_add_u32 m0, s81, 9216
  s_nop 0
  buffer_load_dwordx4 v57, s[12:15], s80 offen lds
  v_mfma_f32_16x16x32_bf16 v[204:207], v[212:215], v[116:119], v[204:207]
  v_accvgpr_write_b32 a33, v249
  s_waitcnt lgkmcnt(1)
  v_mfma_f32_16x16x32_bf16 v[196:199], v[216:219], v[120:123], v[196:199]
  v_accvgpr_write_b32 a112, v250
  v_mfma_f32_16x16x32_bf16 v[200:203], v[216:219], v[124:127], v[200:203]
  s_add_u32 m0, s81, 10240
  s_nop 0
  buffer_load_dwordx4 v58, s[12:15], s80 offen lds
  v_mfma_f32_16x16x32_bf16 v[204:207], v[216:219], v[128:131], v[204:207]
  v_accvgpr_write_b32 a113, v251
  s_waitcnt lgkmcnt(0)
  v_mfma_f32_16x16x32_bf16 v[196:199], v[220:223], v[132:135], v[196:199]
  v_cvt_pk_bf16_f32 v160, v192, v193
  v_cvt_pk_bf16_f32 v161, v194, v195
  v_mfma_f32_16x16x32_bf16 v[200:203], v[220:223], v[136:139], v[200:203]
  s_add_u32 m0, s81, 11264
  s_nop 0
  buffer_load_dwordx4 v59, s[12:15], s80 offen lds
  s_add_u32 s80, s80, 393216
  v_mfma_f32_16x16x32_bf16 v[204:207], v[220:223], v[140:143], v[204:207]
  s_add_u32 s21, s79, 1179648
  buffer_load_dwordx4 a[244:247], v63, s[28:31], s21 offen
  s_add_u32 s21, s79, 1179648
  buffer_load_dwordx4 a[248:251], v64, s[28:31], s21 offen
  s_add_u32 s21, s79, 1179648
  buffer_load_dwordx4 a[252:255], v65, s[28:31], s21 offen
  s_waitcnt vmcnt(18)
  ds_read_b128 v[208:211], v70 offset:24576
  ds_read_b128 v[212:215], v71 offset:24576
  ds_read_b128 v[216:219], v70 offset:24704
  s_waitcnt lgkmcnt(2)
  v_mfma_f32_16x16x32_bf16 v[184:187], v[208:211], v[72:75], 0
  ds_read_b128 v[220:223], v71 offset:24704
  v_mfma_f32_16x16x32_bf16 v[188:191], v[208:211], v[76:79], 0
  s_add_u32 m0, s81, 12288
  s_nop 0
  buffer_load_dwordx4 v48, s[12:15], s80 offen lds
  v_mfma_f32_16x16x32_bf16 v[192:195], v[208:211], v[80:83], 0
  s_waitcnt lgkmcnt(2)
  v_mfma_f32_16x16x32_bf16 v[184:187], v[212:215], v[84:87], v[184:187]
  ds_read_b128 v[208:211], v70 offset:24832
  v_cvt_pk_bf16_f32 v248, v196, v197
  v_mfma_f32_16x16x32_bf16 v[188:191], v[212:215], v[88:91], v[188:191]
  s_add_u32 m0, s81, 13312
  s_nop 0
  buffer_load_dwordx4 v49, s[12:15], s80 offen lds
  v_mfma_f32_16x16x32_bf16 v[192:195], v[212:215], v[92:95], v[192:195]
  v_cvt_pk_bf16_f32 v249, v198, v199
  s_waitcnt lgkmcnt(2)
  v_mfma_f32_16x16x32_bf16 v[184:187], v[216:219], v[96:99], v[184:187]
  ds_read_b128 v[212:215], v71 offset:24832
  v_cvt_pk_bf16_f32 v250, v200, v201
  v_mfma_f32_16x16x32_bf16 v[188:191], v[216:219], v[100:103], v[188:191]
  s_add_u32 m0, s81, 14336
  s_nop 0
  buffer_load_dwordx4 v50, s[12:15], s80 offen lds
  v_mfma_f32_16x16x32_bf16 v[192:195], v[216:219], v[104:107], v[192:195]
  v_cvt_pk_bf16_f32 v251, v202, v203
  s_waitcnt lgkmcnt(2)
  v_mfma_f32_16x16x32_bf16 v[184:187], v[220:223], v[108:111], v[184:187]
  ds_read_b128 v[216:219], v70 offset:25344
  v_accvgpr_write_b32 a34, v248
  v_mfma_f32_16x16x32_bf16 v[188:191], v[220:223], v[112:115], v[188:191]
  s_add_u32 m0, s81, 15360
  s_nop 0
  buffer_load_dwordx4 v51, s[12:15], s80 offen lds
  v_mfma_f32_16x16x32_bf16 v[192:195], v[220:223], v[116:119], v[192:195]
  v_accvgpr_write_b32 a35, v249
  s_waitcnt lgkmcnt(2)
  v_mfma_f32_16x16x32_bf16 v[184:187], v[208:211], v[120:123], v[184:187]
  ds_read_b128 v[220:223], v71 offset:25344
  v_accvgpr_write_b32 a114, v250
  v_mfma_f32_16x16x32_bf16 v[188:191], v[208:211], v[124:127], v[188:191]
  s_add_u32 m0, s81, 16384
  s_nop 0
  buffer_load_dwordx4 v52, s[12:15], s80 offen lds
  v_mfma_f32_16x16x32_bf16 v[192:195], v[208:211], v[128:131], v[192:195]
  v_accvgpr_write_b32 a115, v251
  s_waitcnt lgkmcnt(2)
  v_mfma_f32_16x16x32_bf16 v[184:187], v[212:215], v[132:135], v[184:187]
  ds_read_b128 v[208:211], v70 offset:25472
  s_mov_b64 exec, s[68:69]
  v_cvt_pk_bf16_f32 v160, v204, v205
  v_cvt_pk_bf16_f32 v161, v206, v207
  s_mov_b64 exec, -1
  v_mfma_f32_16x16x32_bf16 v[188:191], v[212:215], v[136:139], v[188:191]
  s_add_u32 m0, s81, 17408
  s_nop 0
  buffer_load_dwordx4 v53, s[12:15], s80 offen lds
  v_mfma_f32_16x16x32_bf16 v[192:195], v[212:215], v[140:143], v[192:195]
  s_waitcnt lgkmcnt(2)
  v_mfma_f32_16x16x32_bf16 v[196:199], v[216:219], v[72:75], 0
  ds_read_b128 v[212:215], v71 offset:25472
  v_mfma_f32_16x16x32_bf16 v[200:203], v[216:219], v[76:79], 0
  s_add_u32 m0, s81, 18432
  s_nop 0
  buffer_load_dwordx4 v54, s[12:15], s80 offen lds
  v_mfma_f32_16x16x32_bf16 v[204:207], v[216:219], v[80:83], 0
  s_waitcnt lgkmcnt(2)
  v_mfma_f32_16x16x32_bf16 v[196:199], v[220:223], v[84:87], v[196:199]
  ds_read_b128 v[216:219], v70 offset:25600
  v_cvt_pk_bf16_f32 v248, v184, v185
  v_mfma_f32_16x16x32_bf16 v[200:203], v[220:223], v[88:91], v[200:203]
  s_add_u32 m0, s81, 19456
  s_nop 0
  buffer_load_dwordx4 v55, s[12:15], s80 offen lds
  v_mfma_f32_16x16x32_bf16 v[204:207], v[220:223], v[92:95], v[204:207]
  v_cvt_pk_bf16_f32 v249, v186, v187
  s_waitcnt lgkmcnt(2)
  v_mfma_f32_16x16x32_bf16 v[196:199], v[208:211], v[96:99], v[196:199]
  ds_read_b128 v[220:223], v71 offset:25600
  v_cvt_pk_bf16_f32 v250, v188, v189
  v_mfma_f32_16x16x32_bf16 v[200:203], v[208:211], v[100:103], v[200:203]
  s_add_u32 m0, s81, 20480
  s_nop 0
  buffer_load_dwordx4 v56, s[12:15], s80 offen lds
  v_mfma_f32_16x16x32_bf16 v[204:207], v[208:211], v[104:107], v[204:207]
  v_cvt_pk_bf16_f32 v251, v190, v191
  s_waitcnt lgkmcnt(2)
  v_mfma_f32_16x16x32_bf16 v[196:199], v[212:215], v[108:111], v[196:199]
  v_accvgpr_write_b32 a36, v248
  v_mfma_f32_16x16x32_bf16 v[200:203], v[212:215], v[112:115], v[200:203]
  s_add_u32 m0, s81, 21504
  s_nop 0
  buffer_load_dwordx4 v57, s[12:15], s80 offen lds
  v_mfma_f32_16x16x32_bf16 v[204:207], v[212:215], v[116:119], v[204:207]
  v_accvgpr_write_b32 a37, v249
  s_waitcnt lgkmcnt(1)
  v_mfma_f32_16x16x32_bf16 v[196:199], v[216:219], v[120:123], v[196:199]
  v_accvgpr_write_b32 a116, v250
  v_mfma_f32_16x16x32_bf16 v[200:203], v[216:219], v[124:127], v[200:203]
  s_add_u32 m0, s81, 22528
  s_nop 0
  buffer_load_dwordx4 v58, s[12:15], s80 offen lds
  v_mfma_f32_16x16x32_bf16 v[204:207], v[216:219], v[128:131], v[204:207]
  v_accvgpr_write_b32 a117, v251
  s_waitcnt lgkmcnt(0)
  v_mfma_f32_16x16x32_bf16 v[196:199], v[220:223], v[132:135], v[196:199]
  v_cvt_pk_bf16_f32 v162, v192, v193
  v_cvt_pk_bf16_f32 v163, v194, v195
  v_mfma_f32_16x16x32_bf16 v[200:203], v[220:223], v[136:139], v[200:203]
  s_add_u32 m0, s81, 23552
  s_nop 0
  buffer_load_dwordx4 v59, s[12:15], s80 offen lds
  s_add_u32 s80, s80, 393216
  v_mfma_f32_16x16x32_bf16 v[204:207], v[220:223], v[140:143], v[204:207]
  s_add_u32 s21, s79, 1572864
  buffer_load_dwordx4 v[236:239], v63, s[28:31], s21 offen
  s_add_u32 s21, s79, 1572864
  buffer_load_dwordx4 v[240:243], v64, s[28:31], s21 offen
  s_add_u32 s21, s79, 1572864
  buffer_load_dwordx4 v[244:247], v65, s[28:31], s21 offen
  s_waitcnt vmcnt(18)
  ds_read_b128 v[208:211], v70 offset:0
  ds_read_b128 v[212:215], v71 offset:0
  ds_read_b128 v[216:219], v70 offset:128
  s_waitcnt lgkmcnt(2)
  v_mfma_f32_16x16x32_bf16 v[184:187], v[208:211], v[72:75], 0
  ds_read_b128 v[220:223], v71 offset:128
  v_mfma_f32_16x16x32_bf16 v[188:191], v[208:211], v[76:79], 0
  s_add_u32 m0, s81, 24576
  s_nop 0
  buffer_load_dwordx4 v48, s[12:15], s80 offen lds
  ds_write_b64 v69, v[144:145] offset:36864
  v_mfma_f32_16x16x32_bf16 v[192:195], v[208:211], v[80:83], 0
  s_waitcnt lgkmcnt(3)
  v_mfma_f32_16x16x32_bf16 v[184:187], v[212:215], v[84:87], v[184:187]
  ds_read_b128 v[208:211], v70 offset:256
  v_cvt_pk_bf16_f32 v248, v196, v197
  v_mfma_f32_16x16x32_bf16 v[188:191], v[212:215], v[88:91], v[188:191]
  s_add_u32 m0, s81, 25600
  s_nop 0
  buffer_load_dwordx4 v49, s[12:15], s80 offen lds
  ds_write_b64 v69, v[146:147] offset:37376
  v_mfma_f32_16x16x32_bf16 v[192:195], v[212:215], v[92:95], v[192:195]
  v_cvt_pk_bf16_f32 v249, v198, v199
  s_waitcnt lgkmcnt(4)
  v_mfma_f32_16x16x32_bf16 v[184:187], v[216:219], v[96:99], v[184:187]
  ds_read_b128 v[212:215], v71 offset:256
  v_cvt_pk_bf16_f32 v250, v200, v201
  v_mfma_f32_16x16x32_bf16 v[188:191], v[216:219], v[100:103], v[188:191]
  s_add_u32 m0, s81, 26624
  s_nop 0
  buffer_load_dwordx4 v50, s[12:15], s80 offen lds
  ds_write_b64 v69, v[148:149] offset:37888
  v_mfma_f32_16x16x32_bf16 v[192:195], v[216:219], v[104:107], v[192:195]
  v_cvt_pk_bf16_f32 v251, v202, v203
  s_waitcnt lgkmcnt(5)
  v_mfma_f32_16x16x32_bf16 v[184:187], v[220:223], v[108:111], v[184:187]
  ds_read_b128 v[216:219], v70 offset:768
  v_accvgpr_write_b32 a38, v248
  v_mfma_f32_16x16x32_bf16 v[188:191], v[220:223], v[112:115], v[188:191]
  s_add_u32 m0, s81, 27648
  s_nop 0
  buffer_load_dwordx4 v51, s[12:15], s80 offen lds
  ds_write_b64 v69, v[150:151] offset:38400
  v_mfma_f32_16x16x32_bf16 v[192:195], v[220:223], v[116:119], v[192:195]
  v_accvgpr_write_b32 a39, v249
  s_waitcnt lgkmcnt(5)
  v_mfma_f32_16x16x32_bf16 v[184:187], v[208:211], v[120:123], v[184:187]
  ds_read_b128 v[220:223], v71 offset:768
  v_accvgpr_write_b32 a118, v250
  v_mfma_f32_16x16x32_bf16 v[188:191], v[208:211], v[124:127], v[188:191]
  s_add_u32 m0, s81, 28672
  s_nop 0
  buffer_load_dwordx4 v52, s[12:15], s80 offen lds
  ds_write_b64 v69, v[152:153] offset:38912
  v_mfma_f32_16x16x32_bf16 v[192:195], v[208:211], v[128:131], v[192:195]
  v_accvgpr_write_b32 a119, v251
  s_waitcnt lgkmcnt(5)
  v_mfma_f32_16x16x32_bf16 v[184:187], v[212:215], v[132:135], v[184:187]
  ds_read_b128 v[208:211], v70 offset:896
  s_mov_b64 exec, s[68:69]
  v_cvt_pk_bf16_f32 v162, v204, v205
  v_cvt_pk_bf16_f32 v163, v206, v207
  s_mov_b64 exec, -1
  v_mfma_f32_16x16x32_bf16 v[188:191], v[212:215], v[136:139], v[188:191]
  s_add_u32 m0, s81, 29696
  s_nop 0
  buffer_load_dwordx4 v53, s[12:15], s80 offen lds
  ds_write_b64 v69, v[154:155] offset:39424
  v_mfma_f32_16x16x32_bf16 v[192:195], v[212:215], v[140:143], v[192:195]
  s_waitcnt lgkmcnt(5)
  v_mfma_f32_16x16x32_bf16 v[196:199], v[216:219], v[72:75], 0
  ds_read_b128 v[212:215], v71 offset:896
  v_mfma_f32_16x16x32_bf16 v[200:203], v[216:219], v[76:79], 0
  s_add_u32 m0, s81, 30720
  s_nop 0
  buffer_load_dwordx4 v54, s[12:15], s80 offen lds
  ds_write_b64 v69, v[156:157] offset:39936
  v_mfma_f32_16x16x32_bf16 v[204:207], v[216:219], v[80:83], 0
  s_waitcnt lgkmcnt(5)
  v_mfma_f32_16x16x32_bf16 v[196:199], v[220:223], v[84:87], v[196:199]
  ds_read_b128 v[216:219], v70 offset:1024
  v_cvt_pk_bf16_f32 v248, v184, v185
  v_mfma_f32_16x16x32_bf16 v[200:203], v[220:223], v[88:91], v[200:203]
  s_add_u32 m0, s81, 31744
  s_nop 0
  buffer_load_dwordx4 v55, s[12:15], s80 offen lds
  ds_write_b64 v69, v[158:159] offset:40448
  v_mfma_f32_16x16x32_bf16 v[204:207], v[220:223], v[92:95], v[204:207]
  v_cvt_pk_bf16_f32 v249, v186, v187
  s_waitcnt lgkmcnt(5)
  v_mfma_f32_16x16x32_bf16 v[196:199], v[208:211], v[96:99], v[196:199]
  ds_read_b128 v[220:223], v71 offset:1024
  v_cvt_pk_bf16_f32 v250, v188, v189
  v_mfma_f32_16x16x32_bf16 v[200:203], v[208:211], v[100:103], v[200:203]
  s_add_u32 m0, s81, 32768
  s_nop 0
  buffer_load_dwordx4 v56, s[12:15], s80 offen lds
  v_mfma_f32_16x16x32_bf16 v[204:207], v[208:211], v[104:107], v[204:207]
  v_cvt_pk_bf16_f32 v251, v190, v191
  s_waitcnt lgkmcnt(4)
  v_mfma_f32_16x16x32_bf16 v[196:199], v[212:215], v[108:111], v[196:199]
  v_accvgpr_write_b32 a40, v248
  v_mfma_f32_16x16x32_bf16 v[200:203], v[212:215], v[112:115], v[200:203]
  s_add_u32 m0, s81, 33792
  s_nop 0
  buffer_load_dwordx4 v57, s[12:15], s80 offen lds
  v_mfma_f32_16x16x32_bf16 v[204:207], v[212:215], v[116:119], v[204:207]
  v_accvgpr_write_b32 a41, v249
  s_waitcnt lgkmcnt(2)
  v_mfma_f32_16x16x32_bf16 v[196:199], v[216:219], v[120:123], v[196:199]
  v_accvgpr_write_b32 a120, v250
  v_mfma_f32_16x16x32_bf16 v[200:203], v[216:219], v[124:127], v[200:203]
  s_add_u32 m0, s81, 34816
  s_nop 0
  buffer_load_dwordx4 v58, s[12:15], s80 offen lds
  v_mfma_f32_16x16x32_bf16 v[204:207], v[216:219], v[128:131], v[204:207]
  v_accvgpr_write_b32 a121, v251
  s_waitcnt lgkmcnt(0)
  v_mfma_f32_16x16x32_bf16 v[196:199], v[220:223], v[132:135], v[196:199]
  v_cvt_pk_bf16_f32 v164, v192, v193
  v_cvt_pk_bf16_f32 v165, v194, v195
  v_mfma_f32_16x16x32_bf16 v[200:203], v[220:223], v[136:139], v[200:203]
  s_add_u32 m0, s81, 35840
  s_nop 0
  buffer_load_dwordx4 v59, s[12:15], s80 offen lds
  s_add_u32 s80, s80, 393216
  v_mfma_f32_16x16x32_bf16 v[204:207], v[220:223], v[140:143], v[204:207]
  s_add_u32 s21, s79, 0
  buffer_load_dwordx4 a[160:163], v63, s[24:27], s21 offen
  s_add_u32 s21, s79, 0
  buffer_load_dwordx4 a[164:167], v64, s[24:27], s21 offen
  s_add_u32 s21, s79, 0
  buffer_load_dwordx4 a[168:171], v65, s[24:27], s21 offen
  s_waitcnt vmcnt(18)
  ds_read_b128 v[208:211], v70 offset:12288
  ds_read_b128 v[212:215], v71 offset:12288
  ds_read_b128 v[216:219], v70 offset:12416
  s_waitcnt lgkmcnt(2)
  v_mfma_f32_16x16x32_bf16 v[184:187], v[208:211], v[72:75], 0
  ds_read_b128 v[220:223], v71 offset:12416
  v_mfma_f32_16x16x32_bf16 v[188:191], v[208:211], v[76:79], 0
  s_add_u32 m0, s81, 0
  s_nop 0
  buffer_load_dwordx4 v48, s[12:15], s80 offen lds
  v_mfma_f32_16x16x32_bf16 v[192:195], v[208:211], v[80:83], 0
  s_waitcnt lgkmcnt(2)
  v_mfma_f32_16x16x32_bf16 v[184:187], v[212:215], v[84:87], v[184:187]
  ds_read_b128 v[208:211], v70 offset:12544
  v_cvt_pk_bf16_f32 v248, v196, v197
  v_mfma_f32_16x16x32_bf16 v[188:191], v[212:215], v[88:91], v[188:191]
  s_add_u32 m0, s81, 1024
  s_nop 0
  buffer_load_dwordx4 v49, s[12:15], s80 offen lds
  v_mfma_f32_16x16x32_bf16 v[192:195], v[212:215], v[92:95], v[192:195]
  v_cvt_pk_bf16_f32 v249, v198, v199
  s_waitcnt lgkmcnt(2)
  v_mfma_f32_16x16x32_bf16 v[184:187], v[216:219], v[96:99], v[184:187]
  ds_read_b128 v[212:215], v71 offset:12544
  v_cvt_pk_bf16_f32 v250, v200, v201
  v_mfma_f32_16x16x32_bf16 v[188:191], v[216:219], v[100:103], v[188:191]
  s_add_u32 m0, s81, 2048
  s_nop 0
  buffer_load_dwordx4 v50, s[12:15], s80 offen lds
  v_mfma_f32_16x16x32_bf16 v[192:195], v[216:219], v[104:107], v[192:195]
  v_cvt_pk_bf16_f32 v251, v202, v203
  s_waitcnt lgkmcnt(2)
  v_mfma_f32_16x16x32_bf16 v[184:187], v[220:223], v[108:111], v[184:187]
  ds_read_b128 v[216:219], v70 offset:13056
  v_accvgpr_write_b32 a42, v248
  v_mfma_f32_16x16x32_bf16 v[188:191], v[220:223], v[112:115], v[188:191]
  s_add_u32 m0, s81, 3072
  s_nop 0
  buffer_load_dwordx4 v51, s[12:15], s80 offen lds
  v_mfma_f32_16x16x32_bf16 v[192:195], v[220:223], v[116:119], v[192:195]
  v_accvgpr_write_b32 a43, v249
  s_waitcnt lgkmcnt(2)
  v_mfma_f32_16x16x32_bf16 v[184:187], v[208:211], v[120:123], v[184:187]
  ds_read_b128 v[220:223], v71 offset:13056
  v_accvgpr_write_b32 a122, v250
  v_mfma_f32_16x16x32_bf16 v[188:191], v[208:211], v[124:127], v[188:191]
  s_add_u32 m0, s81, 4096
  s_nop 0
  buffer_load_dwordx4 v52, s[12:15], s80 offen lds
  v_mfma_f32_16x16x32_bf16 v[192:195], v[208:211], v[128:131], v[192:195]
  v_accvgpr_write_b32 a123, v251
  s_waitcnt lgkmcnt(2)
  v_mfma_f32_16x16x32_bf16 v[184:187], v[212:215], v[132:135], v[184:187]
  ds_read_b128 v[208:211], v70 offset:13184
  s_mov_b64 exec, s[68:69]
  v_cvt_pk_bf16_f32 v164, v204, v205
  v_cvt_pk_bf16_f32 v165, v206, v207
  s_mov_b64 exec, -1
  v_mfma_f32_16x16x32_bf16 v[188:191], v[212:215], v[136:139], v[188:191]
  s_add_u32 m0, s81, 5120
  s_nop 0
  buffer_load_dwordx4 v53, s[12:15], s80 offen lds
  v_mfma_f32_16x16x32_bf16 v[192:195], v[212:215], v[140:143], v[192:195]
  s_waitcnt lgkmcnt(2)
  v_mfma_f32_16x16x32_bf16 v[196:199], v[216:219], v[72:75], 0
  ds_read_b128 v[212:215], v71 offset:13184
  v_mfma_f32_16x16x32_bf16 v[200:203], v[216:219], v[76:79], 0
  s_add_u32 m0, s81, 6144
  s_nop 0
  buffer_load_dwordx4 v54, s[12:15], s80 offen lds
  v_mfma_f32_16x16x32_bf16 v[204:207], v[216:219], v[80:83], 0
  s_waitcnt lgkmcnt(2)
  v_mfma_f32_16x16x32_bf16 v[196:199], v[220:223], v[84:87], v[196:199]
  ds_read_b128 v[216:219], v70 offset:13312
  v_cvt_pk_bf16_f32 v248, v184, v185
  v_mfma_f32_16x16x32_bf16 v[200:203], v[220:223], v[88:91], v[200:203]
  s_add_u32 m0, s81, 7168
  s_nop 0
  buffer_load_dwordx4 v55, s[12:15], s80 offen lds
  v_mfma_f32_16x16x32_bf16 v[204:207], v[220:223], v[92:95], v[204:207]
  v_cvt_pk_bf16_f32 v249, v186, v187
  s_waitcnt lgkmcnt(2)
  v_mfma_f32_16x16x32_bf16 v[196:199], v[208:211], v[96:99], v[196:199]
  ds_read_b128 v[220:223], v71 offset:13312
  v_cvt_pk_bf16_f32 v250, v188, v189
  v_mfma_f32_16x16x32_bf16 v[200:203], v[208:211], v[100:103], v[200:203]
  s_add_u32 m0, s81, 8192
  s_nop 0
  buffer_load_dwordx4 v56, s[12:15], s80 offen lds
  v_mfma_f32_16x16x32_bf16 v[204:207], v[208:211], v[104:107], v[204:207]
  v_cvt_pk_bf16_f32 v251, v190, v191
  s_waitcnt lgkmcnt(2)
  v_mfma_f32_16x16x32_bf16 v[196:199], v[212:215], v[108:111], v[196:199]
  v_accvgpr_write_b32 a44, v248
  v_mfma_f32_16x16x32_bf16 v[200:203], v[212:215], v[112:115], v[200:203]
  s_add_u32 m0, s81, 9216
  s_nop 0
  buffer_load_dwordx4 v57, s[12:15], s80 offen lds
  v_mfma_f32_16x16x32_bf16 v[204:207], v[212:215], v[116:119], v[204:207]
  v_accvgpr_write_b32 a45, v249
  s_waitcnt lgkmcnt(1)
  v_mfma_f32_16x16x32_bf16 v[196:199], v[216:219], v[120:123], v[196:199]
  v_accvgpr_write_b32 a124, v250
  v_mfma_f32_16x16x32_bf16 v[200:203], v[216:219], v[124:127], v[200:203]
  s_add_u32 m0, s81, 10240
  s_nop 0
  buffer_load_dwordx4 v58, s[12:15], s80 offen lds
  v_mfma_f32_16x16x32_bf16 v[204:207], v[216:219], v[128:131], v[204:207]
  v_accvgpr_write_b32 a125, v251
  s_waitcnt lgkmcnt(0)
  v_mfma_f32_16x16x32_bf16 v[196:199], v[220:223], v[132:135], v[196:199]
  v_cvt_pk_bf16_f32 v166, v192, v193
  v_cvt_pk_bf16_f32 v167, v194, v195
  v_mfma_f32_16x16x32_bf16 v[200:203], v[220:223], v[136:139], v[200:203]
  s_add_u32 m0, s81, 11264
  s_nop 0
  buffer_load_dwordx4 v59, s[12:15], s80 offen lds
  s_add_u32 s80, s80, 393216
  v_mfma_f32_16x16x32_bf16 v[204:207], v[220:223], v[140:143], v[204:207]
  s_add_u32 s21, s79, 393216
  buffer_load_dwordx4 a[184:187], v63, s[24:27], s21 offen
  s_add_u32 s21, s79, 393216
  buffer_load_dwordx4 a[188:191], v64, s[24:27], s21 offen
  s_add_u32 s21, s79, 393216
  buffer_load_dwordx4 a[192:195], v65, s[24:27], s21 offen
  s_waitcnt vmcnt(18)
  ds_read_b128 v[208:211], v70 offset:24576
  ds_read_b128 v[212:215], v71 offset:24576
  ds_read_b128 v[216:219], v70 offset:24704
  s_waitcnt lgkmcnt(2)
  v_mfma_f32_16x16x32_bf16 v[184:187], v[208:211], v[72:75], 0
  ds_read_b128 v[220:223], v71 offset:24704
  v_mfma_f32_16x16x32_bf16 v[188:191], v[208:211], v[76:79], 0
  s_add_u32 m0, s81, 12288
  s_nop 0
  buffer_load_dwordx4 v48, s[12:15], s80 offen lds
  v_mfma_f32_16x16x32_bf16 v[192:195], v[208:211], v[80:83], 0
  s_waitcnt lgkmcnt(2)
  v_mfma_f32_16x16x32_bf16 v[184:187], v[212:215], v[84:87], v[184:187]
  ds_read_b128 v[208:211], v70 offset:24832
  v_cvt_pk_bf16_f32 v248, v196, v197
  v_mfma_f32_16x16x32_bf16 v[188:191], v[212:215], v[88:91], v[188:191]
  s_add_u32 m0, s81, 13312
  s_nop 0
  buffer_load_dwordx4 v49, s[12:15], s80 offen lds
  v_mfma_f32_16x16x32_bf16 v[192:195], v[212:215], v[92:95], v[192:195]
  v_cvt_pk_bf16_f32 v249, v198, v199
  s_waitcnt lgkmcnt(2)
  v_mfma_f32_16x16x32_bf16 v[184:187], v[216:219], v[96:99], v[184:187]
  ds_read_b128 v[212:215], v71 offset:24832
  v_cvt_pk_bf16_f32 v250, v200, v201
  v_mfma_f32_16x16x32_bf16 v[188:191], v[216:219], v[100:103], v[188:191]
  s_add_u32 m0, s81, 14336
  s_nop 0
  buffer_load_dwordx4 v50, s[12:15], s80 offen lds
  v_mfma_f32_16x16x32_bf16 v[192:195], v[216:219], v[104:107], v[192:195]
  v_cvt_pk_bf16_f32 v251, v202, v203
  s_waitcnt lgkmcnt(2)
  v_mfma_f32_16x16x32_bf16 v[184:187], v[220:223], v[108:111], v[184:187]
  ds_read_b128 v[216:219], v70 offset:25344
  v_accvgpr_write_b32 a46, v248
  v_mfma_f32_16x16x32_bf16 v[188:191], v[220:223], v[112:115], v[188:191]
  s_add_u32 m0, s81, 15360
  s_nop 0
  buffer_load_dwordx4 v51, s[12:15], s80 offen lds
  v_mfma_f32_16x16x32_bf16 v[192:195], v[220:223], v[116:119], v[192:195]
  v_accvgpr_write_b32 a47, v249
  s_waitcnt lgkmcnt(2)
  v_mfma_f32_16x16x32_bf16 v[184:187], v[208:211], v[120:123], v[184:187]
  ds_read_b128 v[220:223], v71 offset:25344
  v_accvgpr_write_b32 a126, v250
  v_mfma_f32_16x16x32_bf16 v[188:191], v[208:211], v[124:127], v[188:191]
  s_add_u32 m0, s81, 16384
  s_nop 0
  buffer_load_dwordx4 v52, s[12:15], s80 offen lds
  v_mfma_f32_16x16x32_bf16 v[192:195], v[208:211], v[128:131], v[192:195]
  v_accvgpr_write_b32 a127, v251
  s_waitcnt lgkmcnt(2)
  v_mfma_f32_16x16x32_bf16 v[184:187], v[212:215], v[132:135], v[184:187]
  ds_read_b128 v[208:211], v70 offset:25472
  s_mov_b64 exec, s[68:69]
  v_cvt_pk_bf16_f32 v166, v204, v205
  v_cvt_pk_bf16_f32 v167, v206, v207
  s_mov_b64 exec, -1
  v_mfma_f32_16x16x32_bf16 v[188:191], v[212:215], v[136:139], v[188:191]
  s_add_u32 m0, s81, 17408
  s_nop 0
  buffer_load_dwordx4 v53, s[12:15], s80 offen lds
  v_mfma_f32_16x16x32_bf16 v[192:195], v[212:215], v[140:143], v[192:195]
  s_waitcnt lgkmcnt(2)
  v_mfma_f32_16x16x32_bf16 v[196:199], v[216:219], v[72:75], 0
  ds_read_b128 v[212:215], v71 offset:25472
  v_mfma_f32_16x16x32_bf16 v[200:203], v[216:219], v[76:79], 0
  s_add_u32 m0, s81, 18432
  s_nop 0
  buffer_load_dwordx4 v54, s[12:15], s80 offen lds
  v_mfma_f32_16x16x32_bf16 v[204:207], v[216:219], v[80:83], 0
  s_waitcnt lgkmcnt(2)
  v_mfma_f32_16x16x32_bf16 v[196:199], v[220:223], v[84:87], v[196:199]
  ds_read_b128 v[216:219], v70 offset:25600
  v_cvt_pk_bf16_f32 v248, v184, v185
  v_mfma_f32_16x16x32_bf16 v[200:203], v[220:223], v[88:91], v[200:203]
  s_add_u32 m0, s81, 19456
  s_nop 0
  buffer_load_dwordx4 v55, s[12:15], s80 offen lds
  v_mfma_f32_16x16x32_bf16 v[204:207], v[220:223], v[92:95], v[204:207]
  v_cvt_pk_bf16_f32 v249, v186, v187
  s_waitcnt lgkmcnt(2)
  v_mfma_f32_16x16x32_bf16 v[196:199], v[208:211], v[96:99], v[196:199]
  ds_read_b128 v[220:223], v71 offset:25600
  v_cvt_pk_bf16_f32 v250, v188, v189
  v_mfma_f32_16x16x32_bf16 v[200:203], v[208:211], v[100:103], v[200:203]
  s_add_u32 m0, s81, 20480
  s_nop 0
  buffer_load_dwordx4 v56, s[12:15], s80 offen lds
  v_mfma_f32_16x16x32_bf16 v[204:207], v[208:211], v[104:107], v[204:207]
  v_cvt_pk_bf16_f32 v251, v190, v191
  s_waitcnt lgkmcnt(2)
  v_mfma_f32_16x16x32_bf16 v[196:199], v[212:215], v[108:111], v[196:199]
  v_accvgpr_write_b32 a48, v248
  v_mfma_f32_16x16x32_bf16 v[200:203], v[212:215], v[112:115], v[200:203]
  s_add_u32 m0, s81, 21504
  s_nop 0
  buffer_load_dwordx4 v57, s[12:15], s80 offen lds
  v_mfma_f32_16x16x32_bf16 v[204:207], v[212:215], v[116:119], v[204:207]
  v_accvgpr_write_b32 a49, v249
  s_waitcnt lgkmcnt(1)
  v_mfma_f32_16x16x32_bf16 v[196:199], v[216:219], v[120:123], v[196:199]
  v_accvgpr_write_b32 a128, v250
  v_mfma_f32_16x16x32_bf16 v[200:203], v[216:219], v[124:127], v[200:203]
  s_add_u32 m0, s81, 22528
  s_nop 0
  buffer_load_dwordx4 v58, s[12:15], s80 offen lds
  v_mfma_f32_16x16x32_bf16 v[204:207], v[216:219], v[128:131], v[204:207]
  v_accvgpr_write_b32 a129, v251
  s_waitcnt lgkmcnt(0)
  v_mfma_f32_16x16x32_bf16 v[196:199], v[220:223], v[132:135], v[196:199]
  v_cvt_pk_bf16_f32 v168, v192, v193
  v_cvt_pk_bf16_f32 v169, v194, v195
  v_mfma_f32_16x16x32_bf16 v[200:203], v[220:223], v[136:139], v[200:203]
  s_add_u32 m0, s81, 23552
  s_nop 0
  buffer_load_dwordx4 v59, s[12:15], s80 offen lds
  s_add_u32 s80, s80, 393216
  v_mfma_f32_16x16x32_bf16 v[204:207], v[220:223], v[140:143], v[204:207]
  s_add_u32 s21, s79, 786432
  buffer_load_dwordx4 a[208:211], v63, s[24:27], s21 offen
  s_add_u32 s21, s79, 786432
  buffer_load_dwordx4 a[212:215], v64, s[24:27], s21 offen
  s_add_u32 s21, s79, 786432
  buffer_load_dwordx4 a[216:219], v65, s[24:27], s21 offen
  s_waitcnt vmcnt(18)
  buffer_load_dword v66, v67, s[32:35], 0 offen sc1
  ds_read_b128 v[208:211], v70 offset:0
  ds_read_b128 v[212:215], v71 offset:0
  ds_read_b128 v[216:219], v70 offset:128
  s_waitcnt lgkmcnt(2)
  v_mfma_f32_16x16x32_bf16 v[184:187], v[208:211], v[72:75], 0
  ds_read_b128 v[220:223], v71 offset:128
  v_mfma_f32_16x16x32_bf16 v[188:191], v[208:211], v[76:79], 0
  s_add_u32 m0, s81, 24576
  s_nop 0
  buffer_load_dwordx4 v48, s[12:15], s80 offen lds
  v_mfma_f32_16x16x32_bf16 v[192:195], v[208:211], v[80:83], 0
  s_waitcnt lgkmcnt(2)
  v_mfma_f32_16x16x32_bf16 v[184:187], v[212:215], v[84:87], v[184:187]
  ds_read_b128 v[208:211], v70 offset:256
  v_cvt_pk_bf16_f32 v248, v196, v197
  v_mfma_f32_16x16x32_bf16 v[188:191], v[212:215], v[88:91], v[188:191]
  s_add_u32 m0, s81, 25600
  s_nop 0
  buffer_load_dwordx4 v49, s[12:15], s80 offen lds
  v_mfma_f32_16x16x32_bf16 v[192:195], v[212:215], v[92:95], v[192:195]
  v_cvt_pk_bf16_f32 v249, v198, v199
  s_waitcnt lgkmcnt(2)
  v_mfma_f32_16x16x32_bf16 v[184:187], v[216:219], v[96:99], v[184:187]
  ds_read_b128 v[212:215], v71 offset:256
  v_cvt_pk_bf16_f32 v250, v200, v201
  v_mfma_f32_16x16x32_bf16 v[188:191], v[216:219], v[100:103], v[188:191]
  s_add_u32 m0, s81, 26624
  s_nop 0
  buffer_load_dwordx4 v50, s[12:15], s80 offen lds
  v_mfma_f32_16x16x32_bf16 v[192:195], v[216:219], v[104:107], v[192:195]
  v_cvt_pk_bf16_f32 v251, v202, v203
  s_waitcnt lgkmcnt(2)
  v_mfma_f32_16x16x32_bf16 v[184:187], v[220:223], v[108:111], v[184:187]
  ds_read_b128 v[216:219], v70 offset:768
  v_accvgpr_write_b32 a50, v248
  v_mfma_f32_16x16x32_bf16 v[188:191], v[220:223], v[112:115], v[188:191]
  s_add_u32 m0, s81, 27648
  s_nop 0
  buffer_load_dwordx4 v51, s[12:15], s80 offen lds
  v_mfma_f32_16x16x32_bf16 v[192:195], v[220:223], v[116:119], v[192:195]
  v_accvgpr_write_b32 a51, v249
  s_waitcnt lgkmcnt(2)
  v_mfma_f32_16x16x32_bf16 v[184:187], v[208:211], v[120:123], v[184:187]
  ds_read_b128 v[220:223], v71 offset:768
  v_accvgpr_write_b32 a130, v250
  v_mfma_f32_16x16x32_bf16 v[188:191], v[208:211], v[124:127], v[188:191]
  s_add_u32 m0, s81, 28672
  s_nop 0
  buffer_load_dwordx4 v52, s[12:15], s80 offen lds
  v_mfma_f32_16x16x32_bf16 v[192:195], v[208:211], v[128:131], v[192:195]
  v_accvgpr_write_b32 a131, v251
  s_waitcnt lgkmcnt(2)
  v_mfma_f32_16x16x32_bf16 v[184:187], v[212:215], v[132:135], v[184:187]
  ds_read_b128 v[208:211], v70 offset:896
  s_mov_b64 exec, s[68:69]
  v_cvt_pk_bf16_f32 v168, v204, v205
  v_cvt_pk_bf16_f32 v169, v206, v207
  s_mov_b64 exec, -1
  v_mfma_f32_16x16x32_bf16 v[188:191], v[212:215], v[136:139], v[188:191]
  s_add_u32 m0, s81, 29696
  s_nop 0
  buffer_load_dwordx4 v53, s[12:15], s80 offen lds
  v_mfma_f32_16x16x32_bf16 v[192:195], v[212:215], v[140:143], v[192:195]
  s_waitcnt lgkmcnt(2)
  v_mfma_f32_16x16x32_bf16 v[196:199], v[216:219], v[72:75], 0
  ds_read_b128 v[212:215], v71 offset:896
  v_mfma_f32_16x16x32_bf16 v[200:203], v[216:219], v[76:79], 0
  s_add_u32 m0, s81, 30720
  s_nop 0
  buffer_load_dwordx4 v54, s[12:15], s80 offen lds
  v_mfma_f32_16x16x32_bf16 v[204:207], v[216:219], v[80:83], 0
  s_waitcnt lgkmcnt(2)
  v_mfma_f32_16x16x32_bf16 v[196:199], v[220:223], v[84:87], v[196:199]
  ds_read_b128 v[216:219], v70 offset:1024
  v_cvt_pk_bf16_f32 v248, v184, v185
  v_mfma_f32_16x16x32_bf16 v[200:203], v[220:223], v[88:91], v[200:203]
  s_add_u32 m0, s81, 31744
  s_nop 0
  buffer_load_dwordx4 v55, s[12:15], s80 offen lds
  v_mfma_f32_16x16x32_bf16 v[204:207], v[220:223], v[92:95], v[204:207]
  v_cvt_pk_bf16_f32 v249, v186, v187
  s_waitcnt lgkmcnt(2)
  v_mfma_f32_16x16x32_bf16 v[196:199], v[208:211], v[96:99], v[196:199]
  ds_read_b128 v[220:223], v71 offset:1024
  v_cvt_pk_bf16_f32 v250, v188, v189
  v_mfma_f32_16x16x32_bf16 v[200:203], v[208:211], v[100:103], v[200:203]
  s_add_u32 m0, s81, 32768
  s_nop 0
  buffer_load_dwordx4 v56, s[12:15], s80 offen lds
  v_mfma_f32_16x16x32_bf16 v[204:207], v[208:211], v[104:107], v[204:207]
  v_cvt_pk_bf16_f32 v251, v190, v191
  s_waitcnt lgkmcnt(2)
  v_mfma_f32_16x16x32_bf16 v[196:199], v[212:215], v[108:111], v[196:199]
  v_accvgpr_write_b32 a52, v248
  v_mfma_f32_16x16x32_bf16 v[200:203], v[212:215], v[112:115], v[200:203]
  s_add_u32 m0, s81, 33792
  s_nop 0
  buffer_load_dwordx4 v57, s[12:15], s80 offen lds
  v_mfma_f32_16x16x32_bf16 v[204:207], v[212:215], v[116:119], v[204:207]
  v_accvgpr_write_b32 a53, v249
  s_waitcnt lgkmcnt(1)
  v_mfma_f32_16x16x32_bf16 v[196:199], v[216:219], v[120:123], v[196:199]
  v_accvgpr_write_b32 a132, v250
  v_mfma_f32_16x16x32_bf16 v[200:203], v[216:219], v[124:127], v[200:203]
  s_add_u32 m0, s81, 34816
  s_nop 0
  buffer_load_dwordx4 v58, s[12:15], s80 offen lds
  v_mfma_f32_16x16x32_bf16 v[204:207], v[216:219], v[128:131], v[204:207]
  v_accvgpr_write_b32 a133, v251
  s_waitcnt lgkmcnt(0)
  v_mfma_f32_16x16x32_bf16 v[196:199], v[220:223], v[132:135], v[196:199]
  v_cvt_pk_bf16_f32 v170, v192, v193
  v_cvt_pk_bf16_f32 v171, v194, v195
  v_mfma_f32_16x16x32_bf16 v[200:203], v[220:223], v[136:139], v[200:203]
  s_add_u32 m0, s81, 35840
  s_nop 0
  buffer_load_dwordx4 v59, s[12:15], s80 offen lds
  s_add_u32 s80, s80, 393216
  v_mfma_f32_16x16x32_bf16 v[204:207], v[220:223], v[140:143], v[204:207]
  s_add_u32 s21, s79, 1179648
  buffer_load_dwordx4 a[232:235], v63, s[24:27], s21 offen
  s_add_u32 s21, s79, 1179648
  buffer_load_dwordx4 a[236:239], v64, s[24:27], s21 offen
  s_add_u32 s21, s79, 1179648
  buffer_load_dwordx4 a[240:243], v65, s[24:27], s21 offen
  s_waitcnt vmcnt(19)
  ds_read_b128 v[208:211], v70 offset:12288
  ds_read_b128 v[212:215], v71 offset:12288
  ds_read_b128 v[216:219], v70 offset:12416
  s_waitcnt lgkmcnt(2)
  v_mfma_f32_16x16x32_bf16 v[184:187], v[208:211], v[72:75], 0
  ds_read_b128 v[220:223], v71 offset:12416
  v_mfma_f32_16x16x32_bf16 v[188:191], v[208:211], v[76:79], 0
  s_add_u32 m0, s81, 0
  s_nop 0
  buffer_load_dwordx4 v48, s[12:15], s80 offen lds
  v_mfma_f32_16x16x32_bf16 v[192:195], v[208:211], v[80:83], 0
  s_waitcnt lgkmcnt(2)
  v_mfma_f32_16x16x32_bf16 v[184:187], v[212:215], v[84:87], v[184:187]
  ds_read_b128 v[208:211], v70 offset:12544
  v_cvt_pk_bf16_f32 v248, v196, v197
  v_mfma_f32_16x16x32_bf16 v[188:191], v[212:215], v[88:91], v[188:191]
  s_add_u32 m0, s81, 1024
  s_nop 0
  buffer_load_dwordx4 v49, s[12:15], s80 offen lds
  v_mfma_f32_16x16x32_bf16 v[192:195], v[212:215], v[92:95], v[192:195]
  v_cvt_pk_bf16_f32 v249, v198, v199
  s_waitcnt lgkmcnt(2)
  v_mfma_f32_16x16x32_bf16 v[184:187], v[216:219], v[96:99], v[184:187]
  ds_read_b128 v[212:215], v71 offset:12544
  v_cvt_pk_bf16_f32 v250, v200, v201
  v_mfma_f32_16x16x32_bf16 v[188:191], v[216:219], v[100:103], v[188:191]
  s_add_u32 m0, s81, 2048
  s_nop 0
  buffer_load_dwordx4 v50, s[12:15], s80 offen lds
  v_mfma_f32_16x16x32_bf16 v[192:195], v[216:219], v[104:107], v[192:195]
  v_cvt_pk_bf16_f32 v251, v202, v203
  s_waitcnt lgkmcnt(2)
  v_mfma_f32_16x16x32_bf16 v[184:187], v[220:223], v[108:111], v[184:187]
  ds_read_b128 v[216:219], v70 offset:13056
  v_accvgpr_write_b32 a54, v248
  v_mfma_f32_16x16x32_bf16 v[188:191], v[220:223], v[112:115], v[188:191]
  s_add_u32 m0, s81, 3072
  s_nop 0
  buffer_load_dwordx4 v51, s[12:15], s80 offen lds
  v_mfma_f32_16x16x32_bf16 v[192:195], v[220:223], v[116:119], v[192:195]
  v_accvgpr_write_b32 a55, v249
  s_waitcnt lgkmcnt(2)
  v_mfma_f32_16x16x32_bf16 v[184:187], v[208:211], v[120:123], v[184:187]
  ds_read_b128 v[220:223], v71 offset:13056
  v_accvgpr_write_b32 a134, v250
  v_mfma_f32_16x16x32_bf16 v[188:191], v[208:211], v[124:127], v[188:191]
  s_add_u32 m0, s81, 4096
  s_nop 0
  buffer_load_dwordx4 v52, s[12:15], s80 offen lds
  v_mfma_f32_16x16x32_bf16 v[192:195], v[208:211], v[128:131], v[192:195]
  v_accvgpr_write_b32 a135, v251
  s_waitcnt lgkmcnt(2)
  v_mfma_f32_16x16x32_bf16 v[184:187], v[212:215], v[132:135], v[184:187]
  ds_read_b128 v[208:211], v70 offset:13184
  s_mov_b64 exec, s[68:69]
  v_cvt_pk_bf16_f32 v170, v204, v205
  v_cvt_pk_bf16_f32 v171, v206, v207
  s_mov_b64 exec, -1
  v_mfma_f32_16x16x32_bf16 v[188:191], v[212:215], v[136:139], v[188:191]
  s_add_u32 m0, s81, 5120
  s_nop 0
  buffer_load_dwordx4 v53, s[12:15], s80 offen lds
  v_mfma_f32_16x16x32_bf16 v[192:195], v[212:215], v[140:143], v[192:195]
  s_waitcnt lgkmcnt(2)
  v_mfma_f32_16x16x32_bf16 v[196:199], v[216:219], v[72:75], 0
  ds_read_b128 v[212:215], v71 offset:13184
  v_mfma_f32_16x16x32_bf16 v[200:203], v[216:219], v[76:79], 0
  s_add_u32 m0, s81, 6144
  s_nop 0
  buffer_load_dwordx4 v54, s[12:15], s80 offen lds
  v_mfma_f32_16x16x32_bf16 v[204:207], v[216:219], v[80:83], 0
  s_waitcnt lgkmcnt(2)
  v_mfma_f32_16x16x32_bf16 v[196:199], v[220:223], v[84:87], v[196:199]
  ds_read_b128 v[216:219], v70 offset:13312
  v_cvt_pk_bf16_f32 v248, v184, v185
  v_mfma_f32_16x16x32_bf16 v[200:203], v[220:223], v[88:91], v[200:203]
  s_add_u32 m0, s81, 7168
  s_nop 0
  buffer_load_dwordx4 v55, s[12:15], s80 offen lds
  v_mfma_f32_16x16x32_bf16 v[204:207], v[220:223], v[92:95], v[204:207]
  v_cvt_pk_bf16_f32 v249, v186, v187
  s_waitcnt lgkmcnt(2)
  v_mfma_f32_16x16x32_bf16 v[196:199], v[208:211], v[96:99], v[196:199]
  ds_read_b128 v[220:223], v71 offset:13312
  v_cvt_pk_bf16_f32 v250, v188, v189
  v_mfma_f32_16x16x32_bf16 v[200:203], v[208:211], v[100:103], v[200:203]
  s_add_u32 m0, s81, 8192
  s_nop 0
  buffer_load_dwordx4 v56, s[12:15], s80 offen lds
  v_mfma_f32_16x16x32_bf16 v[204:207], v[208:211], v[104:107], v[204:207]
  v_cvt_pk_bf16_f32 v251, v190, v191
  s_waitcnt lgkmcnt(2)
  v_mfma_f32_16x16x32_bf16 v[196:199], v[212:215], v[108:111], v[196:199]
  v_accvgpr_write_b32 a56, v248
  v_mfma_f32_16x16x32_bf16 v[200:203], v[212:215], v[112:115], v[200:203]
  s_add_u32 m0, s81, 9216
  s_nop 0
  buffer_load_dwordx4 v57, s[12:15], s80 offen lds
  v_mfma_f32_16x16x32_bf16 v[204:207], v[212:215], v[116:119], v[204:207]
  v_accvgpr_write_b32 a57, v249
  s_waitcnt lgkmcnt(1)
  v_mfma_f32_16x16x32_bf16 v[196:199], v[216:219], v[120:123], v[196:199]
  v_accvgpr_write_b32 a136, v250
  v_mfma_f32_16x16x32_bf16 v[200:203], v[216:219], v[124:127], v[200:203]
  s_add_u32 m0, s81, 10240
  s_nop 0
  buffer_load_dwordx4 v58, s[12:15], s80 offen lds
  v_mfma_f32_16x16x32_bf16 v[204:207], v[216:219], v[128:131], v[204:207]
  v_accvgpr_write_b32 a137, v251
  s_waitcnt lgkmcnt(0)
  v_mfma_f32_16x16x32_bf16 v[196:199], v[220:223], v[132:135], v[196:199]
  v_cvt_pk_bf16_f32 v172, v192, v193
  v_cvt_pk_bf16_f32 v173, v194, v195
  v_mfma_f32_16x16x32_bf16 v[200:203], v[220:223], v[136:139], v[200:203]
  s_add_u32 m0, s81, 11264
  s_nop 0
  buffer_load_dwordx4 v59, s[12:15], s80 offen lds
  s_add_u32 s80, s80, 393216
  v_mfma_f32_16x16x32_bf16 v[204:207], v[220:223], v[140:143], v[204:207]
  s_add_u32 s21, s79, 1572864
  buffer_load_dwordx4 v[224:227], v63, s[24:27], s21 offen
  s_add_u32 s21, s79, 1572864
  buffer_load_dwordx4 v[228:231], v64, s[24:27], s21 offen
  s_add_u32 s21, s79, 1572864
  buffer_load_dwordx4 v[232:235], v65, s[24:27], s21 offen
  s_waitcnt vmcnt(18)
  ds_read_b128 v[208:211], v70 offset:24576
  ds_read_b128 v[212:215], v71 offset:24576
  ds_read_b128 v[216:219], v70 offset:24704
  s_waitcnt lgkmcnt(2)
  v_mfma_f32_16x16x32_bf16 v[184:187], v[208:211], v[72:75], 0
  ds_read_b128 v[220:223], v71 offset:24704
  v_mfma_f32_16x16x32_bf16 v[188:191], v[208:211], v[76:79], 0
  s_add_u32 m0, s81, 12288
  s_nop 0
  buffer_load_dwordx4 v48, s[12:15], s80 offen lds
  v_mfma_f32_16x16x32_bf16 v[192:195], v[208:211], v[80:83], 0
  s_waitcnt lgkmcnt(2)
  v_mfma_f32_16x16x32_bf16 v[184:187], v[212:215], v[84:87], v[184:187]
  ds_read_b128 v[208:211], v70 offset:24832
  v_cvt_pk_bf16_f32 v248, v196, v197
  v_mfma_f32_16x16x32_bf16 v[188:191], v[212:215], v[88:91], v[188:191]
  s_add_u32 m0, s81, 13312
  s_nop 0
  buffer_load_dwordx4 v49, s[12:15], s80 offen lds
  v_mfma_f32_16x16x32_bf16 v[192:195], v[212:215], v[92:95], v[192:195]
  v_cvt_pk_bf16_f32 v249, v198, v199
  s_waitcnt lgkmcnt(2)
  v_mfma_f32_16x16x32_bf16 v[184:187], v[216:219], v[96:99], v[184:187]
  ds_read_b128 v[212:215], v71 offset:24832
  v_cvt_pk_bf16_f32 v250, v200, v201
  v_mfma_f32_16x16x32_bf16 v[188:191], v[216:219], v[100:103], v[188:191]
  s_add_u32 m0, s81, 14336
  s_nop 0
  buffer_load_dwordx4 v50, s[12:15], s80 offen lds
  v_mfma_f32_16x16x32_bf16 v[192:195], v[216:219], v[104:107], v[192:195]
  v_cvt_pk_bf16_f32 v251, v202, v203
  s_waitcnt lgkmcnt(2)
  v_mfma_f32_16x16x32_bf16 v[184:187], v[220:223], v[108:111], v[184:187]
  ds_read_b128 v[216:219], v70 offset:25344
  v_accvgpr_write_b32 a58, v248
  v_mfma_f32_16x16x32_bf16 v[188:191], v[220:223], v[112:115], v[188:191]
  s_add_u32 m0, s81, 15360
  s_nop 0
  buffer_load_dwordx4 v51, s[12:15], s80 offen lds
  v_mfma_f32_16x16x32_bf16 v[192:195], v[220:223], v[116:119], v[192:195]
  v_accvgpr_write_b32 a59, v249
  s_waitcnt lgkmcnt(2)
  v_mfma_f32_16x16x32_bf16 v[184:187], v[208:211], v[120:123], v[184:187]
  ds_read_b128 v[220:223], v71 offset:25344
  v_accvgpr_write_b32 a138, v250
  v_mfma_f32_16x16x32_bf16 v[188:191], v[208:211], v[124:127], v[188:191]
  s_add_u32 m0, s81, 16384
  s_nop 0
  buffer_load_dwordx4 v52, s[12:15], s80 offen lds
  v_mfma_f32_16x16x32_bf16 v[192:195], v[208:211], v[128:131], v[192:195]
  v_accvgpr_write_b32 a139, v251
  s_waitcnt lgkmcnt(2)
  v_mfma_f32_16x16x32_bf16 v[184:187], v[212:215], v[132:135], v[184:187]
  ds_read_b128 v[208:211], v70 offset:25472
  s_mov_b64 exec, s[68:69]
  v_cvt_pk_bf16_f32 v172, v204, v205
  v_cvt_pk_bf16_f32 v173, v206, v207
  s_mov_b64 exec, -1
  v_mfma_f32_16x16x32_bf16 v[188:191], v[212:215], v[136:139], v[188:191]
  s_add_u32 m0, s81, 17408
  s_nop 0
  buffer_load_dwordx4 v53, s[12:15], s80 offen lds
  v_mfma_f32_16x16x32_bf16 v[192:195], v[212:215], v[140:143], v[192:195]
  s_waitcnt lgkmcnt(2)
  v_mfma_f32_16x16x32_bf16 v[196:199], v[216:219], v[72:75], 0
  ds_read_b128 v[212:215], v71 offset:25472
  v_mfma_f32_16x16x32_bf16 v[200:203], v[216:219], v[76:79], 0
  s_add_u32 m0, s81, 18432
  s_nop 0
  buffer_load_dwordx4 v54, s[12:15], s80 offen lds
  v_mfma_f32_16x16x32_bf16 v[204:207], v[216:219], v[80:83], 0
  s_waitcnt lgkmcnt(2)
  v_mfma_f32_16x16x32_bf16 v[196:199], v[220:223], v[84:87], v[196:199]
  ds_read_b128 v[216:219], v70 offset:25600
  v_cvt_pk_bf16_f32 v248, v184, v185
  v_mfma_f32_16x16x32_bf16 v[200:203], v[220:223], v[88:91], v[200:203]
  s_add_u32 m0, s81, 19456
  s_nop 0
  buffer_load_dwordx4 v55, s[12:15], s80 offen lds
  v_mfma_f32_16x16x32_bf16 v[204:207], v[220:223], v[92:95], v[204:207]
  v_cvt_pk_bf16_f32 v249, v186, v187
  s_waitcnt lgkmcnt(2)
  v_mfma_f32_16x16x32_bf16 v[196:199], v[208:211], v[96:99], v[196:199]
  ds_read_b128 v[220:223], v71 offset:25600
  v_cvt_pk_bf16_f32 v250, v188, v189
  v_mfma_f32_16x16x32_bf16 v[200:203], v[208:211], v[100:103], v[200:203]
  s_add_u32 m0, s81, 20480
  s_nop 0
  buffer_load_dwordx4 v56, s[12:15], s80 offen lds
  v_mfma_f32_16x16x32_bf16 v[204:207], v[208:211], v[104:107], v[204:207]
  v_cvt_pk_bf16_f32 v251, v190, v191
  s_waitcnt lgkmcnt(2)
  v_mfma_f32_16x16x32_bf16 v[196:199], v[212:215], v[108:111], v[196:199]
  v_accvgpr_write_b32 a60, v248
  v_mfma_f32_16x16x32_bf16 v[200:203], v[212:215], v[112:115], v[200:203]
  s_add_u32 m0, s81, 21504
  s_nop 0
  buffer_load_dwordx4 v57, s[12:15], s80 offen lds
  v_mfma_f32_16x16x32_bf16 v[204:207], v[212:215], v[116:119], v[204:207]
  v_accvgpr_write_b32 a61, v249
  s_waitcnt lgkmcnt(1)
  v_mfma_f32_16x16x32_bf16 v[196:199], v[216:219], v[120:123], v[196:199]
  v_accvgpr_write_b32 a140, v250
  v_mfma_f32_16x16x32_bf16 v[200:203], v[216:219], v[124:127], v[200:203]
  s_add_u32 m0, s81, 22528
  s_nop 0
  buffer_load_dwordx4 v58, s[12:15], s80 offen lds
  v_mfma_f32_16x16x32_bf16 v[204:207], v[216:219], v[128:131], v[204:207]
  v_accvgpr_write_b32 a141, v251
  s_waitcnt lgkmcnt(0)
  v_mfma_f32_16x16x32_bf16 v[196:199], v[220:223], v[132:135], v[196:199]
  v_cvt_pk_bf16_f32 v174, v192, v193
  v_cvt_pk_bf16_f32 v175, v194, v195
  v_mfma_f32_16x16x32_bf16 v[200:203], v[220:223], v[136:139], v[200:203]
  s_add_u32 m0, s81, 23552
  s_nop 0
  buffer_load_dwordx4 v59, s[12:15], s80 offen lds
  s_add_u32 s80, s80, 393216
  v_mfma_f32_16x16x32_bf16 v[204:207], v[220:223], v[140:143], v[204:207]
  s_waitcnt vmcnt(15)
  s_and_b32 s21, s50, 1
  s_lshl_b32 s21, s21, 4
  s_add_u32 s21, s21, s51
  s_lshl_b32 s22, s21, 10
  s_add_u32 s22, s22, s77
  s_add_u32 s23, s77, 30720
  s_cmp_lt_u32 s21, 10
  s_cselect_b32 s23, 0, s23
  s_add_u32 s22, s22, s23
  s_mul_i32 s23, s20, 122880
  s_add_u32 s22, s22, s23
  buffer_load_dwordx4 v[252:255], v4, s[8:11], s22 offen sc1
  ds_read_b128 v[208:211], v70 offset:0
  ds_read_b128 v[212:215], v71 offset:0
  ds_read_b128 v[216:219], v70 offset:128
  s_waitcnt lgkmcnt(2)
  v_mfma_f32_16x16x32_bf16 v[184:187], v[208:211], v[72:75], 0
  ds_read_b128 v[220:223], v71 offset:128
  v_mfma_f32_16x16x32_bf16 v[188:191], v[208:211], v[76:79], 0
  s_add_u32 m0, s81, 24576
  s_nop 0
  buffer_load_dwordx4 v48, s[12:15], s80 offen lds
  v_mfma_f32_16x16x32_bf16 v[192:195], v[208:211], v[80:83], 0
  s_waitcnt lgkmcnt(2)
  v_mfma_f32_16x16x32_bf16 v[184:187], v[212:215], v[84:87], v[184:187]
  ds_read_b128 v[208:211], v70 offset:256
  v_cvt_pk_bf16_f32 v248, v196, v197
  v_mfma_f32_16x16x32_bf16 v[188:191], v[212:215], v[88:91], v[188:191]
  s_add_u32 m0, s81, 25600
  s_nop 0
  buffer_load_dwordx4 v49, s[12:15], s80 offen lds
  v_mfma_f32_16x16x32_bf16 v[192:195], v[212:215], v[92:95], v[192:195]
  v_cvt_pk_bf16_f32 v249, v198, v199
  s_waitcnt lgkmcnt(2)
  v_mfma_f32_16x16x32_bf16 v[184:187], v[216:219], v[96:99], v[184:187]
  ds_read_b128 v[212:215], v71 offset:256
  v_cvt_pk_bf16_f32 v250, v200, v201
  v_mfma_f32_16x16x32_bf16 v[188:191], v[216:219], v[100:103], v[188:191]
  s_add_u32 m0, s81, 26624
  s_nop 0
  buffer_load_dwordx4 v50, s[12:15], s80 offen lds
  v_mfma_f32_16x16x32_bf16 v[192:195], v[216:219], v[104:107], v[192:195]
  v_cvt_pk_bf16_f32 v251, v202, v203
  s_waitcnt lgkmcnt(2)
  v_mfma_f32_16x16x32_bf16 v[184:187], v[220:223], v[108:111], v[184:187]
  ds_read_b128 v[216:219], v70 offset:768
  v_accvgpr_write_b32 a62, v248
  v_mfma_f32_16x16x32_bf16 v[188:191], v[220:223], v[112:115], v[188:191]
  s_add_u32 m0, s81, 27648
  s_nop 0
  buffer_load_dwordx4 v51, s[12:15], s80 offen lds
  v_mfma_f32_16x16x32_bf16 v[192:195], v[220:223], v[116:119], v[192:195]
  v_accvgpr_write_b32 a63, v249
  s_waitcnt lgkmcnt(2)
  v_mfma_f32_16x16x32_bf16 v[184:187], v[208:211], v[120:123], v[184:187]
  ds_read_b128 v[220:223], v71 offset:768
  v_accvgpr_write_b32 a142, v250
  v_mfma_f32_16x16x32_bf16 v[188:191], v[208:211], v[124:127], v[188:191]
  s_add_u32 m0, s81, 28672
  s_nop 0
  buffer_load_dwordx4 v52, s[12:15], s80 offen lds
  v_mfma_f32_16x16x32_bf16 v[192:195], v[208:211], v[128:131], v[192:195]
  v_accvgpr_write_b32 a143, v251
  s_waitcnt lgkmcnt(2)
  v_mfma_f32_16x16x32_bf16 v[184:187], v[212:215], v[132:135], v[184:187]
  ds_read_b128 v[208:211], v70 offset:896
  s_mov_b64 exec, s[68:69]
  v_cvt_pk_bf16_f32 v174, v204, v205
  v_cvt_pk_bf16_f32 v175, v206, v207
  s_mov_b64 exec, -1
  v_mfma_f32_16x16x32_bf16 v[188:191], v[212:215], v[136:139], v[188:191]
  s_add_u32 m0, s81, 29696
  s_nop 0
  buffer_load_dwordx4 v53, s[12:15], s80 offen lds
  v_mfma_f32_16x16x32_bf16 v[192:195], v[212:215], v[140:143], v[192:195]
  s_waitcnt lgkmcnt(2)
  v_mfma_f32_16x16x32_bf16 v[196:199], v[216:219], v[72:75], 0
  ds_read_b128 v[212:215], v71 offset:896
  v_mfma_f32_16x16x32_bf16 v[200:203], v[216:219], v[76:79], 0
  s_add_u32 m0, s81, 30720
  s_nop 0
  buffer_load_dwordx4 v54, s[12:15], s80 offen lds
  v_mfma_f32_16x16x32_bf16 v[204:207], v[216:219], v[80:83], 0
  s_waitcnt lgkmcnt(2)
  v_mfma_f32_16x16x32_bf16 v[196:199], v[220:223], v[84:87], v[196:199]
  ds_read_b128 v[216:219], v70 offset:1024
  v_cvt_pk_bf16_f32 v248, v184, v185
  v_mfma_f32_16x16x32_bf16 v[200:203], v[220:223], v[88:91], v[200:203]
  s_add_u32 m0, s81, 31744
  s_nop 0
  buffer_load_dwordx4 v55, s[12:15], s80 offen lds
  v_mfma_f32_16x16x32_bf16 v[204:207], v[220:223], v[92:95], v[204:207]
  v_cvt_pk_bf16_f32 v249, v186, v187
  s_waitcnt lgkmcnt(2)
  v_mfma_f32_16x16x32_bf16 v[196:199], v[208:211], v[96:99], v[196:199]
  ds_read_b128 v[220:223], v71 offset:1024
  v_cvt_pk_bf16_f32 v250, v188, v189
  v_mfma_f32_16x16x32_bf16 v[200:203], v[208:211], v[100:103], v[200:203]
  s_add_u32 m0, s81, 32768
  s_nop 0
  buffer_load_dwordx4 v56, s[12:15], s80 offen lds
  v_mfma_f32_16x16x32_bf16 v[204:207], v[208:211], v[104:107], v[204:207]
  v_cvt_pk_bf16_f32 v251, v190, v191
  s_waitcnt lgkmcnt(2)
  v_mfma_f32_16x16x32_bf16 v[196:199], v[212:215], v[108:111], v[196:199]
  v_accvgpr_write_b32 a64, v248
  v_mfma_f32_16x16x32_bf16 v[200:203], v[212:215], v[112:115], v[200:203]
  s_add_u32 m0, s81, 33792
  s_nop 0
  buffer_load_dwordx4 v57, s[12:15], s80 offen lds
  v_mfma_f32_16x16x32_bf16 v[204:207], v[212:215], v[116:119], v[204:207]
  v_accvgpr_write_b32 a65, v249
  s_waitcnt lgkmcnt(1)
  v_mfma_f32_16x16x32_bf16 v[196:199], v[216:219], v[120:123], v[196:199]
  v_accvgpr_write_b32 a144, v250
  v_mfma_f32_16x16x32_bf16 v[200:203], v[216:219], v[124:127], v[200:203]
  s_add_u32 m0, s81, 34816
  s_nop 0
  buffer_load_dwordx4 v58, s[12:15], s80 offen lds
  v_mfma_f32_16x16x32_bf16 v[204:207], v[216:219], v[128:131], v[204:207]
  v_accvgpr_write_b32 a145, v251
  s_waitcnt lgkmcnt(0)
  v_mfma_f32_16x16x32_bf16 v[196:199], v[220:223], v[132:135], v[196:199]
  v_cvt_pk_bf16_f32 v176, v192, v193
  v_cvt_pk_bf16_f32 v177, v194, v195
  v_mfma_f32_16x16x32_bf16 v[200:203], v[220:223], v[136:139], v[200:203]
  s_add_u32 m0, s81, 35840
  s_nop 0
  buffer_load_dwordx4 v59, s[12:15], s80 offen lds
  s_add_u32 s80, s80, 393216
  v_mfma_f32_16x16x32_bf16 v[204:207], v[220:223], v[140:143], v[204:207]
  s_waitcnt vmcnt(13)
  ds_read_b128 v[208:211], v70 offset:12288
  ds_read_b128 v[212:215], v71 offset:12288
  ds_read_b128 v[216:219], v70 offset:12416
  s_waitcnt lgkmcnt(2)
  v_mfma_f32_16x16x32_bf16 v[184:187], v[208:211], v[72:75], 0
  ds_read_b128 v[220:223], v71 offset:12416
  v_mfma_f32_16x16x32_bf16 v[188:191], v[208:211], v[76:79], 0
  s_add_u32 m0, s81, 0
  s_nop 0
  buffer_load_dwordx4 v48, s[12:15], s80 offen lds
  v_mfma_f32_16x16x32_bf16 v[192:195], v[208:211], v[80:83], 0
  s_waitcnt lgkmcnt(2)
  v_mfma_f32_16x16x32_bf16 v[184:187], v[212:215], v[84:87], v[184:187]
  ds_read_b128 v[208:211], v70 offset:12544
  v_cvt_pk_bf16_f32 v248, v196, v197
  v_mfma_f32_16x16x32_bf16 v[188:191], v[212:215], v[88:91], v[188:191]
  s_add_u32 m0, s81, 1024
  s_nop 0
  buffer_load_dwordx4 v49, s[12:15], s80 offen lds
  v_mfma_f32_16x16x32_bf16 v[192:195], v[212:215], v[92:95], v[192:195]
  v_cvt_pk_bf16_f32 v249, v198, v199
  s_waitcnt lgkmcnt(2)
  v_mfma_f32_16x16x32_bf16 v[184:187], v[216:219], v[96:99], v[184:187]
  ds_read_b128 v[212:215], v71 offset:12544
  v_cvt_pk_bf16_f32 v250, v200, v201
  v_mfma_f32_16x16x32_bf16 v[188:191], v[216:219], v[100:103], v[188:191]
  s_add_u32 m0, s81, 2048
  s_nop 0
  buffer_load_dwordx4 v50, s[12:15], s80 offen lds
  v_mfma_f32_16x16x32_bf16 v[192:195], v[216:219], v[104:107], v[192:195]
  v_cvt_pk_bf16_f32 v251, v202, v203
  s_waitcnt lgkmcnt(2)
  v_mfma_f32_16x16x32_bf16 v[184:187], v[220:223], v[108:111], v[184:187]
  ds_read_b128 v[216:219], v70 offset:13056
  v_accvgpr_write_b32 a66, v248
  v_mfma_f32_16x16x32_bf16 v[188:191], v[220:223], v[112:115], v[188:191]
  s_add_u32 m0, s81, 3072
  s_nop 0
  buffer_load_dwordx4 v51, s[12:15], s80 offen lds
  v_mfma_f32_16x16x32_bf16 v[192:195], v[220:223], v[116:119], v[192:195]
  v_accvgpr_write_b32 a67, v249
  s_waitcnt lgkmcnt(2)
  v_mfma_f32_16x16x32_bf16 v[184:187], v[208:211], v[120:123], v[184:187]
  ds_read_b128 v[220:223], v71 offset:13056
  v_accvgpr_write_b32 a146, v250
  v_mfma_f32_16x16x32_bf16 v[188:191], v[208:211], v[124:127], v[188:191]
  s_add_u32 m0, s81, 4096
  s_nop 0
  buffer_load_dwordx4 v52, s[12:15], s80 offen lds
  v_mfma_f32_16x16x32_bf16 v[192:195], v[208:211], v[128:131], v[192:195]
  v_accvgpr_write_b32 a147, v251
  s_waitcnt lgkmcnt(2)
  v_mfma_f32_16x16x32_bf16 v[184:187], v[212:215], v[132:135], v[184:187]
  ds_read_b128 v[208:211], v70 offset:13184
  s_mov_b64 exec, s[68:69]
  v_cvt_pk_bf16_f32 v176, v204, v205
  v_cvt_pk_bf16_f32 v177, v206, v207
  s_mov_b64 exec, -1
  v_mfma_f32_16x16x32_bf16 v[188:191], v[212:215], v[136:139], v[188:191]
  s_add_u32 m0, s81, 5120
  s_nop 0
  buffer_load_dwordx4 v53, s[12:15], s80 offen lds
  v_mfma_f32_16x16x32_bf16 v[192:195], v[212:215], v[140:143], v[192:195]
  s_waitcnt lgkmcnt(2)
  v_mfma_f32_16x16x32_bf16 v[196:199], v[216:219], v[72:75], 0
  ds_read_b128 v[212:215], v71 offset:13184
  v_mfma_f32_16x16x32_bf16 v[200:203], v[216:219], v[76:79], 0
  s_add_u32 m0, s81, 6144
  s_nop 0
  buffer_load_dwordx4 v54, s[12:15], s80 offen lds
  v_mfma_f32_16x16x32_bf16 v[204:207], v[216:219], v[80:83], 0
  s_waitcnt lgkmcnt(2)
  v_mfma_f32_16x16x32_bf16 v[196:199], v[220:223], v[84:87], v[196:199]
  ds_read_b128 v[216:219], v70 offset:13312
  v_cvt_pk_bf16_f32 v248, v184, v185
  v_mfma_f32_16x16x32_bf16 v[200:203], v[220:223], v[88:91], v[200:203]
  s_add_u32 m0, s81, 7168
  s_nop 0
  buffer_load_dwordx4 v55, s[12:15], s80 offen lds
  v_mfma_f32_16x16x32_bf16 v[204:207], v[220:223], v[92:95], v[204:207]
  v_cvt_pk_bf16_f32 v249, v186, v187
  s_waitcnt lgkmcnt(2)
  v_mfma_f32_16x16x32_bf16 v[196:199], v[208:211], v[96:99], v[196:199]
  ds_read_b128 v[220:223], v71 offset:13312
  v_cvt_pk_bf16_f32 v250, v188, v189
  v_mfma_f32_16x16x32_bf16 v[200:203], v[208:211], v[100:103], v[200:203]
  s_add_u32 m0, s81, 8192
  s_nop 0
  buffer_load_dwordx4 v56, s[12:15], s80 offen lds
  v_mfma_f32_16x16x32_bf16 v[204:207], v[208:211], v[104:107], v[204:207]
  v_cvt_pk_bf16_f32 v251, v190, v191
  s_waitcnt lgkmcnt(2)
  v_mfma_f32_16x16x32_bf16 v[196:199], v[212:215], v[108:111], v[196:199]
  v_accvgpr_write_b32 a68, v248
  v_mfma_f32_16x16x32_bf16 v[200:203], v[212:215], v[112:115], v[200:203]
  s_add_u32 m0, s81, 9216
  s_nop 0
  buffer_load_dwordx4 v57, s[12:15], s80 offen lds
  v_mfma_f32_16x16x32_bf16 v[204:207], v[212:215], v[116:119], v[204:207]
  v_accvgpr_write_b32 a69, v249
  s_waitcnt lgkmcnt(1)
  v_mfma_f32_16x16x32_bf16 v[196:199], v[216:219], v[120:123], v[196:199]
  v_accvgpr_write_b32 a148, v250
  v_mfma_f32_16x16x32_bf16 v[200:203], v[216:219], v[124:127], v[200:203]
  s_add_u32 m0, s81, 10240
  s_nop 0
  buffer_load_dwordx4 v58, s[12:15], s80 offen lds
  v_mfma_f32_16x16x32_bf16 v[204:207], v[216:219], v[128:131], v[204:207]
  v_accvgpr_write_b32 a149, v251
  s_waitcnt lgkmcnt(0)
  v_mfma_f32_16x16x32_bf16 v[196:199], v[220:223], v[132:135], v[196:199]
  v_cvt_pk_bf16_f32 v178, v192, v193
  v_cvt_pk_bf16_f32 v179, v194, v195
  v_mfma_f32_16x16x32_bf16 v[200:203], v[220:223], v[136:139], v[200:203]
  s_add_u32 m0, s81, 11264
  s_nop 0
  buffer_load_dwordx4 v59, s[12:15], s80 offen lds
  s_add_u32 s80, s80, 393216
  v_mfma_f32_16x16x32_bf16 v[204:207], v[220:223], v[140:143], v[204:207]
  s_waitcnt vmcnt(12)
  v_readlane_b32 s83, v66, 19
  s_sub_u32 s21, s83, 1
  s_lshl_b32 s21, s21, 13
  s_and_b32 s21, s21, 8192
  s_xor_b32 s76, s90, s21
  buffer_load_dword v66, v67, s[32:35], 0 offen sc1
  buffer_load_dword v42, v41, s[16:19], s76 offen sc1
  ds_read_b128 v[208:211], v70 offset:24576
  ds_read_b128 v[212:215], v71 offset:24576
  ds_read_b128 v[216:219], v70 offset:24704
  s_waitcnt lgkmcnt(2)
  v_mfma_f32_16x16x32_bf16 v[184:187], v[208:211], v[72:75], 0
  ds_read_b128 v[220:223], v71 offset:24704
  v_mfma_f32_16x16x32_bf16 v[188:191], v[208:211], v[76:79], 0
  ds_write_b128 v68, a[160:163] offset:12288
  v_mfma_f32_16x16x32_bf16 v[192:195], v[208:211], v[80:83], 0
  s_waitcnt lgkmcnt(3)
  v_mfma_f32_16x16x32_bf16 v[184:187], v[212:215], v[84:87], v[184:187]
  ds_read_b128 v[208:211], v70 offset:24832
  v_cvt_pk_bf16_f32 v248, v196, v197
  v_mfma_f32_16x16x32_bf16 v[188:191], v[212:215], v[88:91], v[188:191]
  ds_write_b128 v68, a[164:167] offset:13312
  v_mfma_f32_16x16x32_bf16 v[192:195], v[212:215], v[92:95], v[192:195]
  v_cvt_pk_bf16_f32 v249, v198, v199
  s_waitcnt lgkmcnt(4)
  v_mfma_f32_16x16x32_bf16 v[184:187], v[216:219], v[96:99], v[184:187]
  ds_read_b128 v[212:215], v71 offset:24832
  v_cvt_pk_bf16_f32 v250, v200, v201
  v_mfma_f32_16x16x32_bf16 v[188:191], v[216:219], v[100:103], v[188:191]
  ds_write_b128 v68, a[168:171] offset:14336
  v_mfma_f32_16x16x32_bf16 v[192:195], v[216:219], v[104:107], v[192:195]
  v_cvt_pk_bf16_f32 v251, v202, v203
  s_waitcnt lgkmcnt(5)
  v_mfma_f32_16x16x32_bf16 v[184:187], v[220:223], v[108:111], v[184:187]
  ds_read_b128 v[216:219], v70 offset:25344
  v_accvgpr_write_b32 a70, v248
  v_mfma_f32_16x16x32_bf16 v[188:191], v[220:223], v[112:115], v[188:191]
  ds_write_b128 v68, a[172:175] offset:15360
  v_mfma_f32_16x16x32_bf16 v[192:195], v[220:223], v[116:119], v[192:195]
  v_accvgpr_write_b32 a71, v249
  s_waitcnt lgkmcnt(5)
  v_mfma_f32_16x16x32_bf16 v[184:187], v[208:211], v[120:123], v[184:187]
  ds_read_b128 v[220:223], v71 offset:25344
  v_accvgpr_write_b32 a150, v250
  v_mfma_f32_16x16x32_bf16 v[188:191], v[208:211], v[124:127], v[188:191]
  ds_write_b128 v68, a[176:179] offset:16384
  v_mfma_f32_16x16x32_bf16 v[192:195], v[208:211], v[128:131], v[192:195]
  v_accvgpr_write_b32 a151, v251
  s_waitcnt lgkmcnt(5)
  v_mfma_f32_16x16x32_bf16 v[184:187], v[212:215], v[132:135], v[184:187]
  ds_read_b128 v[208:211], v70 offset:25472
  s_mov_b64 exec, s[68:69]
  v_cvt_pk_bf16_f32 v178, v204, v205
  v_cvt_pk_bf16_f32 v179, v206, v207
  s_mov_b64 exec, -1
  v_mfma_f32_16x16x32_bf16 v[188:191], v[212:215], v[136:139], v[188:191]
  ds_write_b128 v68, a[180:183] offset:17408
  v_mfma_f32_16x16x32_bf16 v[192:195], v[212:215], v[140:143], v[192:195]
  s_waitcnt lgkmcnt(5)
  v_mfma_f32_16x16x32_bf16 v[196:199], v[216:219], v[72:75], 0
  ds_read_b128 v[212:215], v71 offset:25472
  v_mfma_f32_16x16x32_bf16 v[200:203], v[216:219], v[76:79], 0
  ds_write_b128 v68, a[184:187] offset:18432
  v_mfma_f32_16x16x32_bf16 v[204:207], v[216:219], v[80:83], 0
  s_waitcnt lgkmcnt(5)
  v_mfma_f32_16x16x32_bf16 v[196:199], v[220:223], v[84:87], v[196:199]
  ds_read_b128 v[216:219], v70 offset:25600
  v_cvt_pk_bf16_f32 v248, v184, v185
  v_mfma_f32_16x16x32_bf16 v[200:203], v[220:223], v[88:91], v[200:203]
  ds_write_b128 v68, a[188:191] offset:19456
  v_mfma_f32_16x16x32_bf16 v[204:207], v[220:223], v[92:95], v[204:207]
  v_cvt_pk_bf16_f32 v249, v186, v187
  s_waitcnt lgkmcnt(5)
  v_mfma_f32_16x16x32_bf16 v[196:199], v[208:211], v[96:99], v[196:199]
  ds_read_b128 v[220:223], v71 offset:25600
  v_cvt_pk_bf16_f32 v250, v188, v189
  v_mfma_f32_16x16x32_bf16 v[200:203], v[208:211], v[100:103], v[200:203]
  ds_write_b128 v68, a[192:195] offset:20480
  v_mfma_f32_16x16x32_bf16 v[204:207], v[208:211], v[104:107], v[204:207]
  v_cvt_pk_bf16_f32 v251, v190, v191
  s_waitcnt lgkmcnt(5)
  v_mfma_f32_16x16x32_bf16 v[196:199], v[212:215], v[108:111], v[196:199]
  v_accvgpr_write_b32 a72, v248
  v_mfma_f32_16x16x32_bf16 v[200:203], v[212:215], v[112:115], v[200:203]
  ds_write_b128 v68, a[196:199] offset:21504
  v_mfma_f32_16x16x32_bf16 v[204:207], v[212:215], v[116:119], v[204:207]
  v_accvgpr_write_b32 a73, v249
  s_waitcnt lgkmcnt(4)
  v_mfma_f32_16x16x32_bf16 v[196:199], v[216:219], v[120:123], v[196:199]
  v_accvgpr_write_b32 a152, v250
  v_mfma_f32_16x16x32_bf16 v[200:203], v[216:219], v[124:127], v[200:203]
  ds_write_b128 v68, a[200:203] offset:22528
  v_mfma_f32_16x16x32_bf16 v[204:207], v[216:219], v[128:131], v[204:207]
  v_accvgpr_write_b32 a153, v251
  s_waitcnt lgkmcnt(3)
  v_mfma_f32_16x16x32_bf16 v[196:199], v[220:223], v[132:135], v[196:199]
  v_cvt_pk_bf16_f32 v180, v192, v193
  v_cvt_pk_bf16_f32 v181, v194, v195
  v_mfma_f32_16x16x32_bf16 v[200:203], v[220:223], v[136:139], v[200:203]
  ds_write_b128 v68, a[204:207] offset:23552
  v_mfma_f32_16x16x32_bf16 v[204:207], v[220:223], v[140:143], v[204:207]
  s_waitcnt vmcnt(2)
  ds_read_b128 v[208:211], v70 offset:0
  ds_read_b128 v[212:215], v71 offset:0
  ds_read_b128 v[216:219], v70 offset:128
  s_waitcnt lgkmcnt(2)
  v_mfma_f32_16x16x32_bf16 v[184:187], v[208:211], v[72:75], 0
  ds_read_b128 v[220:223], v71 offset:128
  v_mfma_f32_16x16x32_bf16 v[188:191], v[208:211], v[76:79], 0
  ds_write_b128 v68, a[208:211] offset:24576
  v_mfma_f32_16x16x32_bf16 v[192:195], v[208:211], v[80:83], 0
  s_waitcnt lgkmcnt(3)
  v_mfma_f32_16x16x32_bf16 v[184:187], v[212:215], v[84:87], v[184:187]
  ds_read_b128 v[208:211], v70 offset:256
  v_cvt_pk_bf16_f32 v248, v196, v197
  v_mfma_f32_16x16x32_bf16 v[188:191], v[212:215], v[88:91], v[188:191]
  ds_write_b128 v68, a[212:215] offset:25600
  v_mfma_f32_16x16x32_bf16 v[192:195], v[212:215], v[92:95], v[192:195]
  v_cvt_pk_bf16_f32 v249, v198, v199
  s_waitcnt lgkmcnt(4)
  v_mfma_f32_16x16x32_bf16 v[184:187], v[216:219], v[96:99], v[184:187]
  ds_read_b128 v[212:215], v71 offset:256
  v_cvt_pk_bf16_f32 v250, v200, v201
  v_mfma_f32_16x16x32_bf16 v[188:191], v[216:219], v[100:103], v[188:191]
  ds_write_b128 v68, a[216:219] offset:26624
  v_mfma_f32_16x16x32_bf16 v[192:195], v[216:219], v[104:107], v[192:195]
  v_cvt_pk_bf16_f32 v251, v202, v203
  s_waitcnt lgkmcnt(5)
  v_mfma_f32_16x16x32_bf16 v[184:187], v[220:223], v[108:111], v[184:187]
  ds_read_b128 v[216:219], v70 offset:768
  v_accvgpr_write_b32 a74, v248
  v_mfma_f32_16x16x32_bf16 v[188:191], v[220:223], v[112:115], v[188:191]
  ds_write_b128 v68, a[220:223] offset:27648
  v_mfma_f32_16x16x32_bf16 v[192:195], v[220:223], v[116:119], v[192:195]
  v_accvgpr_write_b32 a75, v249
  s_waitcnt lgkmcnt(5)
  v_mfma_f32_16x16x32_bf16 v[184:187], v[208:211], v[120:123], v[184:187]
  ds_read_b128 v[220:223], v71 offset:768
  v_accvgpr_write_b32 a154, v250
  v_mfma_f32_16x16x32_bf16 v[188:191], v[208:211], v[124:127], v[188:191]
  ds_write_b128 v68, a[224:227] offset:28672
  v_mfma_f32_16x16x32_bf16 v[192:195], v[208:211], v[128:131], v[192:195]
  v_accvgpr_write_b32 a155, v251
  s_waitcnt lgkmcnt(5)
  v_mfma_f32_16x16x32_bf16 v[184:187], v[212:215], v[132:135], v[184:187]
  ds_read_b128 v[208:211], v70 offset:896
  s_mov_b64 exec, s[68:69]
  v_cvt_pk_bf16_f32 v180, v204, v205
  v_cvt_pk_bf16_f32 v181, v206, v207
  s_mov_b64 exec, -1
  v_mfma_f32_16x16x32_bf16 v[188:191], v[212:215], v[136:139], v[188:191]
  ds_write_b128 v68, a[228:231] offset:29696
  v_mfma_f32_16x16x32_bf16 v[192:195], v[212:215], v[140:143], v[192:195]
  s_waitcnt lgkmcnt(5)
  v_mfma_f32_16x16x32_bf16 v[196:199], v[216:219], v[72:75], 0
  ds_read_b128 v[212:215], v71 offset:896
  v_mfma_f32_16x16x32_bf16 v[200:203], v[216:219], v[76:79], 0
  ds_write_b128 v68, a[232:235] offset:30720
  v_mfma_f32_16x16x32_bf16 v[204:207], v[216:219], v[80:83], 0
  s_waitcnt lgkmcnt(5)
  v_mfma_f32_16x16x32_bf16 v[196:199], v[220:223], v[84:87], v[196:199]
  ds_read_b128 v[216:219], v70 offset:1024
  v_cvt_pk_bf16_f32 v248, v184, v185
  v_mfma_f32_16x16x32_bf16 v[200:203], v[220:223], v[88:91], v[200:203]
  ds_write_b128 v68, a[236:239] offset:31744
  v_mfma_f32_16x16x32_bf16 v[204:207], v[220:223], v[92:95], v[204:207]
  v_cvt_pk_bf16_f32 v249, v186, v187
  s_waitcnt lgkmcnt(5)
  v_mfma_f32_16x16x32_bf16 v[196:199], v[208:211], v[96:99], v[196:199]
  ds_read_b128 v[220:223], v71 offset:1024
  v_cvt_pk_bf16_f32 v250, v188, v189
  v_mfma_f32_16x16x32_bf16 v[200:203], v[208:211], v[100:103], v[200:203]
  ds_write_b128 v68, a[240:243] offset:32768
  v_mfma_f32_16x16x32_bf16 v[204:207], v[208:211], v[104:107], v[204:207]
  v_cvt_pk_bf16_f32 v251, v190, v191
  s_waitcnt lgkmcnt(5)
  v_mfma_f32_16x16x32_bf16 v[196:199], v[212:215], v[108:111], v[196:199]
  v_accvgpr_write_b32 a76, v248
  v_mfma_f32_16x16x32_bf16 v[200:203], v[212:215], v[112:115], v[200:203]
  ds_write_b128 v68, a[244:247] offset:33792
  v_mfma_f32_16x16x32_bf16 v[204:207], v[212:215], v[116:119], v[204:207]
  v_accvgpr_write_b32 a77, v249
  s_waitcnt lgkmcnt(4)
  v_mfma_f32_16x16x32_bf16 v[196:199], v[216:219], v[120:123], v[196:199]
  v_accvgpr_write_b32 a156, v250
  v_mfma_f32_16x16x32_bf16 v[200:203], v[216:219], v[124:127], v[200:203]
  ds_write_b128 v68, a[248:251] offset:34816
  v_mfma_f32_16x16x32_bf16 v[204:207], v[216:219], v[128:131], v[204:207]
  v_accvgpr_write_b32 a157, v251
  s_waitcnt lgkmcnt(3)
  v_mfma_f32_16x16x32_bf16 v[196:199], v[220:223], v[132:135], v[196:199]
  v_cvt_pk_bf16_f32 v182, v192, v193
  v_cvt_pk_bf16_f32 v183, v194, v195
  v_mfma_f32_16x16x32_bf16 v[200:203], v[220:223], v[136:139], v[200:203]
  ds_write_b128 v68, a[252:255] offset:35840
  v_mfma_f32_16x16x32_bf16 v[204:207], v[220:223], v[140:143], v[204:207]
  s_nop 7
  v_cvt_pk_bf16_f32 v248, v196, v197
  v_cvt_pk_bf16_f32 v249, v198, v199
  v_cvt_pk_bf16_f32 v250, v200, v201
  v_cvt_pk_bf16_f32 v251, v202, v203
  v_accvgpr_write_b32 a78, v248
  v_accvgpr_write_b32 a79, v249
  v_accvgpr_write_b32 a158, v250
  v_accvgpr_write_b32 a159, v251
  s_mov_b64 exec, s[68:69]
  v_cvt_pk_bf16_f32 v182, v204, v205
  v_cvt_pk_bf16_f32 v183, v206, v207
  s_mov_b64 exec, -1
  ds_write_b128 v68, v[224:227] offset:0
  ds_write_b128 v68, v[228:231] offset:1024
  ds_write_b128 v68, v[232:235] offset:2048
  ds_write_b128 v68, v[236:239] offset:3072
  ds_write_b128 v68, v[240:243] offset:4096
  ds_write_b128 v68, v[244:247] offset:5120
  ds_write_b64 v69, v[160:161] offset:6144
  ds_write_b64 v69, v[162:163] offset:6656
  ds_write_b64 v69, v[164:165] offset:7168
  ds_write_b64 v69, v[166:167] offset:7680
  ds_write_b64 v69, v[168:169] offset:8192
  ds_write_b64 v69, v[170:171] offset:8704
  ds_write_b64 v69, v[172:173] offset:9216
  ds_write_b64 v69, v[174:175] offset:9728
  ds_write_b64 v69, v[176:177] offset:10240
  ds_write_b64 v69, v[178:179] offset:10752
  ds_write_b64 v69, v[180:181] offset:11264
  ds_write_b64 v69, v[182:183] offset:11776
  v_lshrrev_b32 v100, 1, v3
  v_lshlrev_b32 v100, 4, v100
  v_and_b32 v101, 8, v2
  v_add_u32 v100, v100, v101
  v_and_b32 v101, 1, v3
  v_lshl_add_u32 v100, v101, 2, v100
  v_bfe_u32 v101, v2, 2, 1
  v_add_u32 v100, v100, v101
  v_mul_u32_u24 v100, 96, v100
  v_and_b32 v101, 3, v2
  v_lshl_add_u32 v100, v101, 3, v100
  s_lshl_b32 s21, s20, 5
  v_add_u32 v100, s21, v100
  v_add_u32 v101, 3072, v100
  v_cndmask_b32 v88, v100, v101, s[68:69]
  v_cndmask_b32 v92, v101, v100, s[68:69]
  v_add_u32 v89, 40960, v88
  v_add_u32 v93, 40960, v92
  v_add_u32 v90, 81920, v88
  v_add_u32 v94, 81920, v92
  v_add_u32 v91, 122880, v88
  v_add_u32 v95, 122880, v92
  v_and_b32 v100, 7, v2
  v_lshl_add_u32 v100, v3, 3, v100
  v_lshrrev_b32 v101, 3, v2
  v_mul_u32_u24 v101, 40960, v101
  v_lshl_add_u32 v96, v100, 4, v101
  v_add_u32 v97, 81920, v96
  s_bfe_u32 s82, s50, 0x10001
  s_lshl_b32 s82, s82, 5
  s_lshr_b32 s21, s50, 2
  s_add_u32 s82, s82, s21
  s_mov_b32 s101, 0
  s_branch fm_13
fm_12:
  s_sleep 8
fm_14:
  buffer_load_dword v66, v67, s[32:35], 0 offen sc1
  buffer_load_dword v42, v41, s[16:19], s76 offen sc1
  s_add_u32 s101, s101, 1
  s_cmp_gt_u32 s101, 131072
  s_cbranch_scc1 end0
fm_13:
  s_waitcnt vmcnt(0)
  s_mov_b32 s84, s83
  v_readlane_b32 s83, v66, 19
  s_sub_u32 s21, s83, 1
  s_lshl_b32 s21, s21, 13
  s_and_b32 s21, s21, 8192
  s_xor_b32 s76, s90, s21
  s_cmp_eq_u32 s83, 0
  s_cbranch_scc1 fm_12
  s_cmp_eq_u32 s84, 0
  s_cbranch_scc1 fm_14
  v_readlane_b32 s22, v66, 0
  v_readlane_b32 s23, v66, 32
  s_add_u32 s22, s22, s23
  v_readlane_b32 s23, v66, 1
  s_add_u32 s22, s22, s23
  v_readlane_b32 s23, v66, 33
  s_add_u32 s22, s22, s23
  v_readlane_b32 s23, v66, 2
  s_add_u32 s22, s22, s23
  v_readlane_b32 s23, v66, 34
  s_add_u32 s22, s22, s23
  v_readlane_b32 s23, v66, 3
  s_add_u32 s22, s22, s23
  v_readlane_b32 s23, v66, 35
  s_add_u32 s22, s22, s23
  v_readlane_b32 s21, v66, 16
  v_cmp_gt_u32 vcc, 2, v42
  s_cmp_lt_u32 s22, 256
  s_cbranch_scc1 fm_12
  s_cmp_lt_u32 s21, 128
  s_cbranch_scc1 fm_12
  s_cbranch_vccnz fm_12
  v_readlane_b32 s21, v66, s82
  v_cmp_ne_u32 vcc, 32, v66
  s_cmp_ge_u32 s21, 32
  s_cselect_b32 s84, 1, 0
  s_andn2_b32 s53, s84, s53
  s_and_b32 s21, vcc_lo, 15
  s_and_b32 s22, vcc_hi, 15
  s_or_b32 s85, s21, s22
  s_xor_b32 s83, s76, s90
  s_lshl_b32 s70, s50, 4
  s_add_u32 s79, s70, s55
  s_add_u32 s70, s70, s51
  s_lshl_b32 s70, s70, 14
  s_lshl_b32 s79, s79, 14
  s_lshl_b32 s21, s56, 11
  s_add_u32 s79, s79, s21
  s_lshl_b32 s72, s50, 16
  s_lshl_b32 s21, s60, 10
  s_add_u32 s72, s72, s21
  s_add_u32 s72, s72, 136314880
  s_mov_b32 s74, 32768
  s_add_u32 s73, s70, s83
  s_add_u32 s70, s73, 4096
  s_add_u32 s72, s72, s83
  s_xor_b32 s21, s83, 8192
  s_add_u32 s79, s79, s21
  s_add_u32 s12, s48, 173080576
  s_addc_u32 s13, s49, 0
  s_mov_b32 s14, 49152
  s_mov_b32 s15, 0x00020000
  s_mov_b32 s16, s48
  s_mov_b32 s17, s49
  s_mov_b32 s18, 218103808
  s_mov_b32 s19, 0x00020000
  s_waitcnt lgkmcnt(0)
  s_lshl_b32 s21, s20, 16
  s_add_u32 s21, s21, s79
  buffer_load_dwordx4 v[144:147], v4, s[16:19], s21 offen sc1
  buffer_load_dwordx4 v[148:151], v4, s[16:19], s21 offen offset:1024 sc1
  v_subrev_u32 v100, 43008, v20
  v_subrev_u32 v101, 43008, v21
  buffer_load_dwordx4 v[112:115], v100, s[16:19], s73 offen sc1
  buffer_load_dwordx2 v[116:117], v101, s[16:19], s73 offen sc1
  v_and_b32 v100, 127, v19
  v_lshl_add_u32 v100, v3, 8, v100
  v_and_b32 v101, 2, v2
  v_cmp_eq_u32 vcc, 0, v101
  s_lshl_b32 s21, s20, 14
  s_lshl_b32 s22, s61, 7
  s_add_u32 s21, s21, s22
  s_add_u32 s21, s21, s72
  v_mov_b32 v152, 0x3f803f80
  v_mov_b32 v153, 0x3f803f80
  v_mov_b32 v154, 0x3f803f80
  v_mov_b32 v155, 0x3f803f80
  s_mov_b64 exec, vcc
  buffer_load_dwordx4 v[152:155], v100, s[16:19], s21 offen sc1
  s_mov_b64 exec, -1
  v_and_b32 v100, 7, v1
  v_mul_u32_u24 v100, 1280, v100
  v_lshrrev_b32 v101, 3, v1
  v_lshl_add_u32 v100, v101, 4, v100
  buffer_load_dwordx4 v[48:51], v100, s[36:39], 0 offen offset:0
  buffer_load_dwordx4 v[52:55], v100, s[36:39], 0 offen offset:128
  buffer_load_dwordx4 v[56:59], v100, s[36:39], 0 offen offset:256
  buffer_load_dwordx4 v[60:63], v100, s[36:39], 0 offen offset:384
  buffer_load_dwordx4 v[64:67], v100, s[36:39], 0 offen offset:512
  buffer_load_dwordx4 v[68:71], v100, s[36:39], 0 offen offset:640
  buffer_load_dwordx4 v[72:75], v100, s[36:39], 0 offen offset:768
  buffer_load_dwordx4 v[76:79], v100, s[36:39], 0 offen offset:896
  buffer_load_dwordx4 v[80:83], v100, s[36:39], 0 offen offset:1024
  buffer_load_dwordx4 v[84:87], v100, s[36:39], 0 offen offset:1152
  s_barrier
  s_cmp_eq_u32 s20, 3
  s_cbranch_scc1 w3_16
  ds_read_b64_tr_b16 a[160:161], v88 offset:12288
  ds_read_b64_tr_b16 a[162:163], v88 offset:12480
  ds_read_b64_tr_b16 a[164:165], v88 offset:18432
  ds_read_b64_tr_b16 a[166:167], v88 offset:18624
  ds_read_b64_tr_b16 a[168:169], v88 offset:24576
  ds_read_b64_tr_b16 a[170:171], v88 offset:24768
  ds_read_b64_tr_b16 a[172:173], v88 offset:30720
  ds_read_b64_tr_b16 a[174:175], v88 offset:30912
  ds_read_b64_tr_b16 a[176:177], v88 offset:0
  ds_read_b64_tr_b16 a[178:179], v88 offset:192
  ds_read_b64_tr_b16 a[180:181], v89 offset:12288
  ds_read_b64_tr_b16 a[182:183], v89 offset:12480
  ds_read_b64_tr_b16 a[184:185], v89 offset:18432
  ds_read_b64_tr_b16 a[186:187], v89 offset:18624
  ds_read_b64_tr_b16 a[188:189], v89 offset:24576
  ds_read_b64_tr_b16 a[190:191], v89 offset:24768
  ds_read_b64_tr_b16 a[192:193], v89 offset:30720
  ds_read_b64_tr_b16 a[194:195], v89 offset:30912
  ds_read_b64_tr_b16 a[196:197], v89 offset:0
  ds_read_b64_tr_b16 a[198:199], v89 offset:192
  ds_read_b64_tr_b16 a[200:201], v90 offset:12288
  ds_read_b64_tr_b16 a[202:203], v90 offset:12480
  ds_read_b64_tr_b16 a[204:205], v90 offset:18432
  ds_read_b64_tr_b16 a[206:207], v90 offset:18624
  ds_read_b64_tr_b16 a[208:209], v90 offset:24576
  ds_read_b64_tr_b16 a[210:211], v90 offset:24768
  ds_read_b64_tr_b16 a[212:213], v90 offset:30720
  ds_read_b64_tr_b16 a[214:215], v90 offset:30912
  ds_read_b64_tr_b16 a[216:217], v90 offset:0
  ds_read_b64_tr_b16 a[218:219], v90 offset:192
  ds_read_b64_tr_b16 a[220:221], v91 offset:12288
  ds_read_b64_tr_b16 a[222:223], v91 offset:12480
  ds_read_b64_tr_b16 a[224:225], v91 offset:18432
  ds_read_b64_tr_b16 a[226:227], v91 offset:18624
  ds_read_b64_tr_b16 a[228:229], v91 offset:24576
  ds_read_b64_tr_b16 a[230:231], v91 offset:24768
  ds_read_b64_tr_b16 a[232:233], v91 offset:30720
  ds_read_b64_tr_b16 a[234:235], v91 offset:30912
  ds_read_b64_tr_b16 a[236:237], v91 offset:0
  ds_read_b64_tr_b16 a[238:239], v91 offset:192
  ds_read_b64_tr_b16 a[240:241], v92 offset:12288
  ds_read_b64_tr_b16 a[242:243], v92 offset:12480
  ds_read_b64_tr_b16 a[244:245], v92 offset:18432
  ds_read_b64_tr_b16 a[246:247], v92 offset:18624
  ds_read_b64_tr_b16 a[248:249], v92 offset:24576
  ds_read_b64_tr_b16 a[250:251], v92 offset:24768
  ds_read_b64_tr_b16 a[252:253], v92 offset:30720
  ds_read_b64_tr_b16 a[254:255], v92 offset:30912
  ds_read_b64_tr_b16 v[192:193], v92 offset:0
  ds_read_b64_tr_b16 v[194:195], v92 offset:192
  ds_read_b64_tr_b16 v[196:197], v93 offset:12288
  ds_read_b64_tr_b16 v[198:199], v93 offset:12480
  ds_read_b64_tr_b16 v[200:201], v93 offset:18432
  ds_read_b64_tr_b16 v[202:203], v93 offset:18624
  ds_read_b64_tr_b16 v[204:205], v93 offset:24576
  ds_read_b64_tr_b16 v[206:207], v93 offset:24768
  ds_read_b64_tr_b16 v[208:209], v93 offset:30720
  ds_read_b64_tr_b16 v[210:211], v93 offset:30912
  ds_read_b64_tr_b16 v[212:213], v93 offset:0
  ds_read_b64_tr_b16 v[214:215], v93 offset:192
  ds_read_b64_tr_b16 v[216:217], v94 offset:12288
  ds_read_b64_tr_b16 v[218:219], v94 offset:12480
  ds_read_b64_tr_b16 v[220:221], v94 offset:18432
  ds_read_b64_tr_b16 v[222:223], v94 offset:18624
  ds_read_b64_tr_b16 v[224:225], v94 offset:24576
  ds_read_b64_tr_b16 v[226:227], v94 offset:24768
  ds_read_b64_tr_b16 v[228:229], v94 offset:30720
  ds_read_b64_tr_b16 v[230:231], v94 offset:30912
  ds_read_b64_tr_b16 v[232:233], v94 offset:0
  ds_read_b64_tr_b16 v[234:235], v94 offset:192
  ds_read_b64_tr_b16 v[236:237], v95 offset:12288
  ds_read_b64_tr_b16 v[238:239], v95 offset:12480
  ds_read_b64_tr_b16 v[240:241], v95 offset:18432
  ds_read_b64_tr_b16 v[242:243], v95 offset:18624
  ds_read_b64_tr_b16 v[244:245], v95 offset:24576
  ds_read_b64_tr_b16 v[246:247], v95 offset:24768
  ds_read_b64_tr_b16 v[248:249], v95 offset:30720
  ds_read_b64_tr_b16 v[250:251], v95 offset:30912
  ds_read_b64_tr_b16 v[252:253], v95 offset:0
  ds_read_b64_tr_b16 v[254:255], v95 offset:192
  s_branch w3_17
w3_16:
  ds_read_b128 a[160:163], v96 offset:36864
  ds_read_b128 a[164:167], v96 offset:37376
  ds_read_b128 a[168:171], v96 offset:37888
  ds_read_b128 a[172:175], v96 offset:38400
  ds_read_b128 a[176:179], v96 offset:38912
  ds_read_b128 a[180:183], v96 offset:39424
  ds_read_b128 a[184:187], v96 offset:39936
  ds_read_b128 a[188:191], v96 offset:40448
  ds_read_b128 a[192:195], v96 offset:6144
  ds_read_b128 a[196:199], v96 offset:6656
  ds_read_b128 a[200:203], v96 offset:7168
  ds_read_b128 a[204:207], v96 offset:7680
  ds_read_b128 a[208:211], v96 offset:8192
  ds_read_b128 a[212:215], v96 offset:8704
  ds_read_b128 a[216:219], v96 offset:9216
  ds_read_b128 a[220:223], v96 offset:9728
  ds_read_b128 a[224:227], v96 offset:10240
  ds_read_b128 a[228:231], v96 offset:10752
  ds_read_b128 a[232:235], v96 offset:11264
  ds_read_b128 a[236:239], v96 offset:11776
  ds_read_b128 a[240:243], v97 offset:36864
  ds_read_b128 a[244:247], v97 offset:37376
  ds_read_b128 a[248:251], v97 offset:37888
  ds_read_b128 a[252:255], v97 offset:38400
  ds_read_b128 v[192:195], v97 offset:38912
  ds_read_b128 v[196:199], v97 offset:39424
  ds_read_b128 v[200:203], v97 offset:39936
  ds_read_b128 v[204:207], v97 offset:40448
  ds_read_b128 v[208:211], v97 offset:6144
  ds_read_b128 v[212:215], v97 offset:6656
  ds_read_b128 v[216:219], v97 offset:7168
  ds_read_b128 v[220:223], v97 offset:7680
  ds_read_b128 v[224:227], v97 offset:8192
  ds_read_b128 v[228:231], v97 offset:8704
  ds_read_b128 v[232:235], v97 offset:9216
  ds_read_b128 v[236:239], v97 offset:9728
  ds_read_b128 v[240:243], v97 offset:10240
  ds_read_b128 v[244:247], v97 offset:10752
  ds_read_b128 v[248:251], v97 offset:11264
  ds_read_b128 v[252:255], v97 offset:11776
w3_17:
  s_cmp_eq_u32 s85, 0
  s_cbranch_scc1 fm_15
  s_cmp_eq_u32 s20, 3
  s_cbranch_scc1 ar_19
  s_mov_b64 exec, s[64:65]
  s_cmp_eq_u32 s20, 2
  s_cbranch_scc1 ar_18
  s_mov_b32 s21, 0
  buffer_store_dwordx2 v[28:29], v8, s[8:11], s21 offen sc1
  s_mov_b32 s21, 122880
  buffer_store_dwordx2 v[28:29], v8, s[8:11], s21 offen sc1
  s_mov_b32 s21, 245760
  buffer_store_dwordx2 v[28:29], v8, s[8:11], s21 offen sc1
  s_mov_b32 s21, 368640
  buffer_store_dwordx2 v[28:29], v8, s[8:11], s21 offen sc1
  s_branch ar_20
ar_18:
  s_mov_b32 s21, 0
  buffer_store_dword v28, v8, s[8:11], s21 offen sc1
  buffer_store_dword v28, v8, s[8:11], s21 offen offset:128 sc1
  s_mov_b32 s21, 122880
  buffer_store_dword v28, v8, s[8:11], s21 offen sc1
  buffer_store_dword v28, v8, s[8:11], s21 offen offset:128 sc1
  s_mov_b32 s21, 245760
  buffer_store_dword v28, v8, s[8:11], s21 offen sc1
  buffer_store_dword v28, v8, s[8:11], s21 offen offset:128 sc1
  s_mov_b32 s21, 368640
  buffer_store_dword v28, v8, s[8:11], s21 offen sc1
  buffer_store_dword v28, v8, s[8:11], s21 offen offset:128 sc1
ar_20:
  s_cmp_eq_u32 s78, 0
  s_cbranch_scc1 ar_21
  s_mov_b64 exec, s[62:63]
  s_add_u32 s21, s77, 0
  buffer_store_dword v28, v17, s[8:11], s21 offen sc1
  s_add_u32 s21, s77, 122880
  buffer_store_dword v28, v17, s[8:11], s21 offen sc1
  s_add_u32 s21, s77, 245760
  buffer_store_dword v28, v17, s[8:11], s21 offen sc1
  s_add_u32 s21, s77, 368640
  buffer_store_dword v28, v17, s[8:11], s21 offen sc1
  s_branch ar_21
ar_19:
  buffer_store_dword v28, v34, s[8:11], 0 offen sc1
  s_mov_b64 exec, s[66:67]
  s_mov_b32 s21, 0
  buffer_store_dwordx4 v[28:31], v15, s[4:7], s21 offen sc1
  s_mov_b32 s21, 262144
  buffer_store_dwordx4 v[28:31], v15, s[4:7], s21 offen sc1
  s_mov_b32 s21, 524288
  buffer_store_dwordx4 v[28:31], v15, s[4:7], s21 offen sc1
  s_mov_b32 s21, 786432
  buffer_store_dwordx4 v[28:31], v15, s[4:7], s21 offen sc1
  s_mov_b32 s21, 8192
  buffer_store_dwordx4 v[28:31], v15, s[4:7], s21 offen sc1
  s_mov_b32 s21, 270336
  buffer_store_dwordx4 v[28:31], v15, s[4:7], s21 offen sc1
  s_mov_b32 s21, 532480
  buffer_store_dwordx4 v[28:31], v15, s[4:7], s21 offen sc1
  s_mov_b32 s21, 794624
  buffer_store_dwordx4 v[28:31], v15, s[4:7], s21 offen sc1
ar_21:
  s_mov_b64 exec, -1
  s_waitcnt vmcnt(0)
  s_barrier
  s_mov_b32 s21, 100
  s_cmp_lg_u32 s20, 0
  s_cbranch_scc1 af_22
  v_mov_b32 v166, 0
  v_mov_b32 v167, 1
  s_mov_b64 exec, 1
  buffer_atomic_add v167, v166, s[32:35], s21 offen sc1
  s_mov_b64 exec, -1
  s_nop 1
af_22:
  s_cmp_lg_u32 s20, 0
  s_cbranch_scc1 wf_24
  v_mov_b32 v166, 0
  s_mov_b32 s101, 0
wf_23:
  buffer_load_dword v167, v166, s[32:35], s21 offen sc1
  s_add_u32 s101, s101, 1
  s_cmp_gt_u32 s101, 131072
  s_cbranch_scc1 end0
  s_waitcnt vmcnt(0)
  v_readfirstlane_b32 s100, v167
  s_cmp_ge_u32 s100, 128
  s_cbranch_scc1 wf_24
  s_sleep 8
  s_branch wf_23
wf_24:
  s_barrier
fm_15:
  s_xor_b32 s74, s74, 16384
  s_add_u32 s73, s73, 2097152
  s_xor_b32 s73, s73, 8192
  s_add_u32 s79, s79, 2097152
  s_xor_b32 s79, s79, 8192
  s_add_u32 s21, s72, 524288
  s_xor_b32 s72, s72, s21
  s_lshr_b32 s72, s72, 8
  s_and_b32 s72, s72, 8192
  s_xor_b32 s72, s72, s21
  s_add_u32 s71, s73, 4096
  s_mov_b32 s91, 1024
  s_sub_u32 s21, s73, 0
  s_cmp_lt_u32 s21, 125829120
  s_cselect_b32 s71, s71, s79
  s_cselect_b32 s91, s91, 65536
  v_add_u32 v15, s83, v15
  v_add_u32 v16, s83, v16
  s_mov_b32 s75, s77
  s_lshl_b32 s77, s58, 7
  s_lshl_b32 s21, s56, 3
  s_add_u32 s77, s77, s21
  s_add_u32 s77, s77, 0
  s_xor_b32 s77, s77, s83
  s_mov_b32 s80, 0x53800000
  s_mov_b32 s52, 0
  s_mov_b32 s81, 0
  v_xor_b32 v18, 16384, v18
  v_xor_b32 v19, 16384, v19
  v_xor_b32 v20, 16384, v20
  v_xor_b32 v21, 16384, v21
  v_mov_b32 v168, 0x3f803f80
  v_mov_b32 v169, 0x3f803f80
  v_mov_b32 v170, 0x3f803f80
  v_mov_b32 v171, 0x3f803f80
  v_mov_b32 v166, 0x3f003f00
  v_mov_b32 v167, 0x3f003f00
  s_waitcnt lgkmcnt(0)
  s_barrier
  ds_write_b128 v23, v[168:171] offset:46080
  ds_write_b128 v23, v[168:171] offset:62464
  ds_write_b64 v23, v[166:167] offset:13568
  v_mov_b32 v88, 0
  v_mov_b32 v89, 0
  v_mov_b32 v90, 0
  v_mov_b32 v91, 0
  v_mov_b32 v92, 0
  v_mov_b32 v93, 0
  v_mov_b32 v94, 0
  v_mov_b32 v95, 0
  v_mov_b32 v96, 0
  v_mov_b32 v97, 0
  v_mov_b32 v98, 0
  v_mov_b32 v99, 0
  v_mov_b32 v100, 0
  v_mov_b32 v101, 0
  v_mov_b32 v102, 0
  v_mov_b32 v103, 0
  v_mov_b32 v110, 0
  v_mov_b32 v111, 0
  v_mov_b32 v118, 0
  v_mov_b32 v119, 0
  v_mov_b32 v142, 0
  v_mov_b32 v143, 0
  v_mov_b32 v162, 0
  v_mov_b32 v163, 0
  s_and_b32 s21, s52, 3
  s_mul_i32 s56, s21, 122880
  s_add_u32 s21, s52, 1
  s_and_b32 s21, s21, 3
  s_mul_i32 s55, s21, 122880
  s_add_u32 s55, s55, s75
  s_add_u32 s21, s52, 2
  s_and_b32 s21, s21, 3
  s_mul_i32 s57, s21, 122880
  s_add_u32 s21, s52, 3
  s_and_b32 s21, s21, 3
  s_mul_i32 s59, s21, 122880
  s_add_u32 s59, s59, s75
  s_bfe_u32 s61, s52, 0x10002
  s_and_b32 s21, s52, 3
  s_lshl_b32 s60, s21, 18
  s_mov_b32 s58, s55
  s_waitcnt lgkmcnt(0)
  s_lshl_b32 s21, s53, 2
  s_add_u32 s21, s21, s20
  s_cmp_eq_u32 s21, 0
  s_cbranch_scc1 E_25
  s_cmp_eq_u32 s21, 4
  s_cbranch_scc1 E_26
  s_cmp_eq_u32 s21, 1
  s_cbranch_scc1 E_27
  s_cmp_eq_u32 s21, 5
  s_cbranch_scc1 E_28
  s_cmp_eq_u32 s21, 2
  s_cbranch_scc1 E_29
  s_cmp_eq_u32 s21, 6
  s_cbranch_scc1 E_30
  s_cmp_eq_u32 s21, 3
  s_cbranch_scc1 E_31
  s_cmp_eq_u32 s21, 7
  s_cbranch_scc1 E_32
  s_branch end0
E_26:
  v_add_u32 v190, 0, v4
  ds_write_b64 v6, v[28:29]
  ds_write_b32 v13, v28
  ds_write_b32 v14, v28
  s_waitcnt vmcnt(0)
  ds_write_b128 v190, v[48:51] offset:0
  ds_write_b128 v190, v[52:55] offset:1024
  s_waitcnt lgkmcnt(0)
  s_add_u32 m0, s74, 4096
  s_add_u32 s21, s79, 131072
  buffer_load_dwordx4 v4, s[16:19], s21 offen offset:1024 sc1 lds
  s_add_u32 m0, s74, 9216
  s_add_u32 s21, s72, 32768
  buffer_load_dwordx4 v32, s[16:19], s21 offen sc1 lds
  s_xor_b32 s74, s74, 16384
  s_add_u32 s73, s73, 2097152
  s_xor_b32 s73, s73, 8192
  s_add_u32 s79, s79, 2097152
  s_xor_b32 s79, s79, 8192
  s_add_u32 s21, s72, 524288
  s_xor_b32 s72, s72, s21
  s_lshr_b32 s72, s72, 8
  s_and_b32 s72, s72, 8192
  s_xor_b32 s72, s72, s21
  s_add_u32 s71, s73, 4096
  s_mov_b32 s91, 1024
  s_sub_u32 s21, s73, 0
  s_cmp_lt_u32 s21, 125829120
  s_cselect_b32 s71, s71, s79
  s_cselect_b32 s91, s91, 65536
  s_branch mo_38
  .p2align 3
top_33:
  s_waitcnt vmcnt(1)
  ds_write_b128 v190, v[48:51] offset:0
  v_cmp_eq_u32 s[22:23], -1, v48
  s_waitcnt vmcnt(0)
  ds_write_b128 v190, v[52:55] offset:1024
  v_cmp_eq_u32 s[98:99], -1, v52
  s_or_b64 vcc, s[22:23], s[98:99]
  s_cbranch_scc1 mr_34
mo_38:
  s_barrier
  ds_read_b128 v[56:59], v4 offset:2048
  ds_read_b128 v[60:63], v4 offset:3072
  v_smfmac_f32_16x16x64_bf16 v[92:95], v[48:51], a[240:247], v22
  ds_read_b128 v[64:67], v4 offset:4096
  v_smfmac_f32_16x16x64_bf16 v[88:91], v[48:51], a[160:167], v22
  ds_read_b128 v[68:71], v4 offset:5120
  v_smfmac_f32_16x16x64_bf16 v[92:95], v[52:55], a[248:255], v22
  ds_read_b128 v[72:75], v4 offset:6144
  v_smfmac_f32_16x16x64_bf16 v[88:91], v[52:55], a[168:175], v22
  s_waitcnt lgkmcnt(4)
  ds_read_b128 v[76:79], v4 offset:7168
  v_smfmac_f32_16x16x64_bf16 v[92:95], v[56:59], v[192:199], v22
  ds_read_b128 v[80:83], v4 offset:8192
  v_smfmac_f32_16x16x64_bf16 v[88:91], v[56:59], a[176:183], v22
  s_waitcnt lgkmcnt(5)
  ds_read_b128 v[84:87], v4 offset:9216
  v_smfmac_f32_16x16x64_bf16 v[92:95], v[60:63], v[200:207], v22
  v_smfmac_f32_16x16x64_bf16 v[88:91], v[60:63], a[184:191], v22
  s_waitcnt lgkmcnt(5)
  v_smfmac_f32_16x16x64_bf16 v[92:95], v[64:67], v[208:215], v22
  s_waitcnt lgkmcnt(4)
  v_smfmac_f32_16x16x64_bf16 v[92:95], v[68:71], v[216:223], v22
  s_waitcnt lgkmcnt(3)
  v_smfmac_f32_16x16x64_bf16 v[92:95], v[72:75], v[224:231], v22
  s_waitcnt lgkmcnt(2)
  v_smfmac_f32_16x16x64_bf16 v[92:95], v[76:79], v[232:239], v22
  s_waitcnt lgkmcnt(1)
  v_smfmac_f32_16x16x64_bf16 v[92:95], v[80:83], v[240:247], v22
  s_waitcnt lgkmcnt(0)
  v_smfmac_f32_16x16x64_bf16 v[92:95], v[84:87], v[248:255], v22
  v_smfmac_f32_16x16x64_bf16 v[88:91], v[64:67], a[192:199], v22
  v_smfmac_f32_16x16x64_bf16 v[88:91], v[68:71], a[200:207], v22
  v_smfmac_f32_16x16x64_bf16 v[88:91], v[72:75], a[208:215], v22
  v_permlane32_swap_b32 v92, v93
  v_smfmac_f32_16x16x64_bf16 v[88:91], v[76:79], a[216:223], v22
  v_permlane32_swap_b32 v94, v95
  v_smfmac_f32_16x16x64_bf16 v[88:91], v[80:83], a[224:231], v22
  v_permlane32_swap_b32 v93, v92
  v_smfmac_f32_16x16x64_bf16 v[88:91], v[84:87], a[232:239], v22
  v_permlane32_swap_b32 v95, v94
  v_pk_mul_f32 v[120:121], v[92:93], v[24:25] op_sel:[1,0] op_sel_hi:[0,1]
  v_pk_mul_f32 v[122:123], v[94:95], v[24:25] op_sel:[1,0] op_sel_hi:[0,1]
  s_nop 4
  v_pk_fma_f32 v[88:89], v[88:89], v[24:25], v[120:121]
  v_pk_fma_f32 v[90:91], v[90:91], v[24:25], v[122:123]
  v_cvt_pk_bf16_f32 v120, v88, v89
  v_cvt_pk_bf16_f32 v121, v90, v91
  ds_write_b64 v6, v[120:121]
  s_barrier
  ds_read_b64_tr_b16 v[104:105], v7 offset:0
  ds_read_b64_tr_b16 v[106:107], v7 offset:768
  ds_read_b64_tr_b16 v[108:109], v7 offset:1536
  s_waitcnt lgkmcnt(1)
  v_mfma_f32_16x16x32_bf16 v[120:123], v[112:115], v[104:107], 0
  s_waitcnt lgkmcnt(0)
  v_mfma_f32_16x16x32_bf16 v[120:123], v[116:119], v[108:111], v[120:123]
  s_mov_b64 exec, s[64:65]
  s_nop 6
  v_cmpx_o_f32 vcc, v120, v121
  v_cvt_pk_f16_f32 v120, v120, v121
  v_cvt_pk_f16_f32 v121, v122, v123
  buffer_store_dwordx2 v[120:121], v8, s[8:11], s56 offen
  s_xor_b64 s[98:99], exec, s[64:65]
  s_mov_b64 exec, -1
  s_waitcnt lgkmcnt(0)
  s_barrier
  ds_read_b64_tr_b16 v[104:105], v7 offset:0
  ds_read_b64_tr_b16 v[106:107], v7 offset:768
  ds_read_b64_tr_b16 v[108:109], v7 offset:1536
  ds_read_b32 v27, v12 offset:12544
  ds_read_b64 v[140:141], v11
  s_waitcnt lgkmcnt(1)
  v_cmp_u_f32 vcc, v104, v106
  v_cmp_u_f32 s[22:23], v108, v27
  s_nop 1
  s_or_b64 vcc, vcc, s[22:23]
  s_cbranch_vccnz mn_35
mk_36:
  s_cmp_eq_u32 s52, 63
  s_cbranch_scc1 last_37
  s_cmp_lg_u64 s[98:99], 0
  s_cbranch_scc1 sf_39
sf_40:
  s_nop 15
  s_nop 10
  v_smfmac_f32_16x16x64_bf16 v[96:99], v[48:51], a[0:7], v22
  v_smfmac_f32_16x16x64_bf16 v[100:103], v[48:51], a[80:87], v22
  v_smfmac_f32_16x16x64_bf16 v[96:99], v[52:55], a[8:15], v22
  v_smfmac_f32_16x16x64_bf16 v[100:103], v[52:55], a[88:95], v22
  v_smfmac_f32_16x16x64_bf16 v[96:99], v[56:59], a[16:23], v22
  v_smfmac_f32_16x16x64_bf16 v[100:103], v[56:59], a[96:103], v22
  buffer_load_dwordx4 v[132:135], v10, s[8:11], s56 offen sc1
  v_smfmac_f32_16x16x64_bf16 v[96:99], v[60:63], a[24:31], v22
  buffer_load_dwordx4 v[124:127], v9, s[8:11], s56 offen sc1
  v_smfmac_f32_16x16x64_bf16 v[96:99], v[64:67], a[32:39], v22
  buffer_load_dwordx4 v[128:131], v9, s[8:11], s56 offen offset:1024 sc1
  v_smfmac_f32_16x16x64_bf16 v[96:99], v[68:71], a[40:47], v22
  v_smfmac_f32_16x16x64_bf16 v[96:99], v[72:75], a[48:55], v22
  v_smfmac_f32_16x16x64_bf16 v[96:99], v[76:79], a[56:63], v22
  v_smfmac_f32_16x16x64_bf16 v[96:99], v[80:83], a[64:71], v22
  v_smfmac_f32_16x16x64_bf16 v[96:99], v[84:87], a[72:79], v22
  v_smfmac_f32_16x16x64_bf16 v[100:103], v[60:63], a[104:111], v22
  v_smfmac_f32_16x16x64_bf16 v[100:103], v[64:67], a[112:119], v22
  v_smfmac_f32_16x16x64_bf16 v[100:103], v[68:71], a[120:127], v22
  v_smfmac_f32_16x16x64_bf16 v[100:103], v[72:75], a[128:135], v22
  v_cvt_pk_bf16_f32 v136, v96, v97
  v_smfmac_f32_16x16x64_bf16 v[100:103], v[76:79], a[136:143], v22
  v_cvt_pk_bf16_f32 v137, v98, v99
  v_smfmac_f32_16x16x64_bf16 v[100:103], v[80:83], a[144:151], v22
  v_smfmac_f32_16x16x64_bf16 v[100:103], v[84:87], a[152:159], v22
  s_nop 7
  v_cvt_pk_bf16_f32 v138, v100, v101
  v_cvt_pk_bf16_f32 v139, v102, v103
  s_waitcnt vmcnt(2) lgkmcnt(0)
  v_pk_add_f16 v164, v132, v133
  v_pk_add_f16 v165, v134, v135
  v_fma_mix_f32 v170, v164, 1.0, v165 op_sel:[0,0,0] op_sel_hi:[1,0,1]
  v_fma_mix_f32 v171, v164, 1.0, v165 op_sel:[1,0,1] op_sel_hi:[1,0,1]
  v_exp_f32 v176, v170
  v_exp_f32 v177, v171
  s_waitcnt vmcnt(1)
  v_cvt_pk_bf16_f32 v160, v176, v177
  v_pk_add_f16 v120, v124, v126
  v_pk_add_f16 v121, v125, v127
  v_mov_b32_dpp v161, v160 row_ror:8 row_mask:0xf bank_mask:0xf
  s_waitcnt vmcnt(0)
  v_pk_add_f16 v122, v128, v130
  v_mfma_f32_16x16x32_bf16 v[178:181], v[140:143], v[160:163], 0
  v_fma_mix_f32 v166, v120, 1.0, v122 op_sel:[0,0,0] op_sel_hi:[1,0,1]
  v_fma_mix_f32 v167, v120, 1.0, v122 op_sel:[1,0,1] op_sel_hi:[1,0,1]
  v_cmp_u_f32 vcc, v166, v170
  v_pk_add_f16 v123, v129, v131
  v_exp_f32 v172, v166
  v_mfma_f32_16x16x32_bf16 v[182:185], v[136:139], v[160:163], 0
  s_cbranch_vccnz sr_41
  v_exp_f32 v173, v167
  v_fma_mix_f32 v168, v121, 1.0, v123 op_sel:[0,0,0] op_sel_hi:[1,0,1]
  v_fma_mix_f32 v169, v121, 1.0, v123 op_sel:[1,0,1] op_sel_hi:[1,0,1]
  v_cvt_pk_bf16_f32 v156, v172, v173
  v_exp_f32 v174, v168
  v_exp_f32 v175, v169
  v_mov_b32_dpp v158, v156 row_ror:8 row_mask:0xf bank_mask:0xf
  v_cvt_pk_bf16_f32 v157, v174, v175
  v_mfma_f32_16x16x32_bf16 v[186:189], v[138:141], v[160:163], 0
  s_nop 0
  v_mov_b32_dpp v159, v157 row_ror:8 row_mask:0xf bank_mask:0xf
  s_nop 1
pv_42:
  v_mfma_f32_16x16x32_bf16 v[178:181], v[152:155], v[156:159], v[178:181]
  v_mfma_f32_16x16x32_bf16 v[182:185], v[144:147], v[156:159], v[182:185]
  v_mfma_f32_16x16x32_bf16 v[186:189], v[148:151], v[156:159], v[186:189]
  s_mov_b64 exec, s[62:63]
  s_nop 0
  v_rcp_f32 v164, v180
  v_cmp_ngt_f32 s[22:23], s80, v180
  v_cmp_ngt_f32 vcc, s80, v164
  v_pk_mul_f32 v[182:183], v[182:183], v[164:165] op_sel_hi:[1,0]
  v_pk_mul_f32 v[184:185], v[184:185], v[164:165] op_sel_hi:[1,0]
  v_pk_mul_f32 v[178:179], v[178:179], v[164:165] op_sel_hi:[1,0]
  v_pk_mul_f32 v[186:187], v[186:187], v[164:165] op_sel_hi:[1,0]
  v_pk_mul_f32 v[188:189], v[188:189], v[164:165] op_sel_hi:[1,0]
  v_cvt_pk_f16_f32 v64, v178, v179
  s_or_b64 vcc, vcc, s[22:23]
  s_cbranch_scc1 fx_44
fk_45:
  ds_write_b32 v14, v64
  v_cvt_pk_f16_f32 v60, v182, v183
  v_cvt_pk_f16_f32 v61, v184, v185
  v_cvt_pk_f16_f32 v62, v186, v187
  v_cvt_pk_f16_f32 v63, v188, v189
  ds_write_b128 v13, v[60:63]
  s_barrier
  s_mov_b64 exec, -1
  s_add_u32 m0, s74, 4096
  s_add_u32 s21, s79, 131072
  buffer_load_dwordx4 v4, s[16:19], s21 offen offset:1024 sc1 lds
  s_add_u32 m0, s74, 9216
  s_add_u32 s21, s72, 32768
  buffer_load_dwordx4 v32, s[16:19], s21 offen sc1 lds
  s_xor_b32 s74, s74, 16384
  s_add_u32 s73, s73, 2097152
  s_xor_b32 s73, s73, 8192
  s_add_u32 s79, s79, 2097152
  s_xor_b32 s79, s79, 8192
  s_add_u32 s21, s72, 524288
  s_xor_b32 s72, s72, s21
  s_lshr_b32 s72, s72, 8
  s_and_b32 s72, s72, 8192
  s_xor_b32 s72, s72, s21
  s_add_u32 s71, s73, 4096
  s_mov_b32 s91, 1024
  s_sub_u32 s21, s73, 0
  s_cmp_lt_u32 s21, 125829120
  s_cselect_b32 s71, s71, s79
  s_cselect_b32 s91, s91, 65536
  v_permlane32_swap_b32 v96, v100
  v_permlane32_swap_b32 v97, v101
  v_permlane32_swap_b32 v98, v102
  v_permlane32_swap_b32 v99, v103
  v_pk_add_f32 v[96:97], v[96:97], v[100:101]
  v_pk_add_f32 v[98:99], v[98:99], v[102:103]
  v_cvt_pk_bf16_f32 v100, v96, v97
  v_cvt_pk_bf16_f32 v101, v98, v99
  s_nop 0
  v_permlane32_swap_b32 v100, v102
  v_permlane32_swap_b32 v101, v103
  v_min_u32 v100, -2, v100
  s_nop 6
  buffer_store_dwordx4 v[100:103], v26, s[16:19], s70 offen sc1
  v_min_u32 v104, -2, v104
  buffer_store_dwordx4 v[104:107], v36, s[16:19], s70 offen offset:2560 sc1
  s_add_u32 s70, s70, 2097152
  s_xor_b32 s70, s70, 8192
  ds_read_b128 v[144:147], v18
  ds_read_b128 v[148:151], v18 offset:1024
  ds_read_b128 v[152:155], v19
  ds_read_b128 v[112:115], v20
  ds_read_b64 v[116:117], v21
  v_xor_b32 v18, 16384, v18
  v_xor_b32 v19, 16384, v19
  v_xor_b32 v20, 16384, v20
  v_xor_b32 v21, 16384, v21
  v_mov_b32 v88, 0
  v_mov_b32 v89, 0
  v_mov_b32 v90, 0
  v_mov_b32 v91, 0
  v_mov_b32 v92, 0
  v_mov_b32 v93, 0
  v_mov_b32 v94, 0
  v_mov_b32 v95, 0
  v_mov_b32 v96, 0
  v_mov_b32 v97, 0
  v_mov_b32 v98, 0
  v_mov_b32 v99, 0
  v_mov_b32 v100, 0
  v_mov_b32 v101, 0
  v_mov_b32 v102, 0
  v_mov_b32 v103, 0
  s_mov_b32 s81, 0
  s_waitcnt lgkmcnt(0)
  s_barrier
  s_mov_b64 exec, s[64:65]
  buffer_store_dwordx2 v[28:29], v8, s[8:11], s57 offen
  s_mov_b64 exec, -1
  ds_write_b128 v190, v[28:31] offset:0
  ds_write_b128 v190, v[28:31] offset:1024
  ds_write_b64 v6, v[28:29]
  s_mov_b64 exec, s[62:63]
  buffer_store_dword v28, v17, s[8:11], s59 offen
  s_mov_b64 exec, -1
  s_sleep 3
  s_nop 1
  buffer_load_dwordx4 v[68:71], v16, s[4:7], s60 offen sc1
  s_sleep 3
  s_nop 1
  buffer_load_dwordx4 v[72:75], v16, s[4:7], s60 offen sc1
  s_waitcnt vmcnt(1)
  v_mfma_f32_16x16x32_f16 v[120:123], v[44:47], v[68:71], 0
  v_bitop3_b32 v27, v68, s61, 1 bitop3:0x28
  v_cmp_ne_u32 vcc, 0, v27
  s_nop 1
  s_cbranch_vccnz p2_50
  s_nop 2
pg_49:
  v_add_f32_dpp v120, v120, v120 row_ror:8 row_mask:0xf bank_mask:0xf
  v_add_f32_dpp v121, v121, v121 row_ror:8 row_mask:0xf bank_mask:0xf
  s_mov_b64 exec, s[62:63]
  v_cvt_pk_bf16_f32 v120, v120, v121
  v_min_u32 v120, -2, v120
  buffer_store_dword v120, v17, s[8:11], s55 offen
  s_mov_b64 exec, -1
nt_46:
  s_barrier
  s_mov_b32 s58, s55
  s_add_u32 s52, s52, 1
  ds_write_b32 v13, v28
  ds_write_b32 v14, v28
  s_and_b32 s21, s52, 3
  s_mul_i32 s56, s21, 122880
  s_add_u32 s21, s52, 1
  s_and_b32 s21, s21, 3
  s_mul_i32 s55, s21, 122880
  s_add_u32 s55, s55, s75
  s_add_u32 s21, s52, 2
  s_and_b32 s21, s21, 3
  s_mul_i32 s57, s21, 122880
  s_add_u32 s21, s52, 3
  s_and_b32 s21, s21, 3
  s_mul_i32 s59, s21, 122880
  s_add_u32 s59, s59, s75
  s_bfe_u32 s61, s52, 0x10002
  s_and_b32 s21, s52, 3
  s_lshl_b32 s60, s21, 18
  s_mov_b32 s54, 0
  s_sleep 3
  s_waitcnt lgkmcnt(0)
  buffer_load_dwordx4 v[48:51], v190, s[8:11], s58 offen offset:0 sc1
  buffer_load_dwordx4 v[52:55], v190, s[8:11], s58 offen offset:1024 sc1
  s_branch top_33
mr_34:
  s_mov_b64 exec, s[22:23]
  s_cbranch_execz ms_51
  buffer_load_dwordx4 v[48:51], v190, s[8:11], s58 offen offset:0 sc1
ms_51:
  s_mov_b64 exec, s[98:99]
  s_cbranch_execz ms_52
  buffer_load_dwordx4 v[52:55], v190, s[8:11], s58 offen offset:1024 sc1
ms_52:
  s_add_u32 s54, s54, 1
  s_cmp_gt_u32 s54, 131072
  s_cbranch_scc1 end0
  s_waitcnt vmcnt(0)
  s_mov_b64 exec, s[22:23]
  ds_write_b128 v190, v[48:51] offset:0
  v_cmp_eq_u32 s[22:23], -1, v48
  s_mov_b64 exec, s[98:99]
  ds_write_b128 v190, v[52:55] offset:1024
  v_cmp_eq_u32 s[98:99], -1, v52
  s_mov_b64 exec, -1
  s_or_b64 vcc, s[22:23], s[98:99]
  s_cbranch_scc1 mr_34
  s_branch mo_38
sf_39:
  s_waitcnt lgkmcnt(1)
  v_mfma_f32_16x16x32_bf16 v[120:123], v[112:115], v[104:107], 0
  s_waitcnt lgkmcnt(0)
  v_mfma_f32_16x16x32_bf16 v[120:123], v[116:119], v[108:111], v[120:123]
  s_mov_b64 exec, s[64:65]
  s_nop 6
  v_cvt_pk_f16_f32 v120, v120, v121
  v_cvt_pk_f16_f32 v121, v122, v123
  buffer_store_dwordx2 v[120:121], v8, s[8:11], s56 offen
  s_mov_b64 exec, -1
  s_branch sf_40
mn_35:
  s_bitcmp1_b32 s81, 1
  s_cbranch_scc1 mk_36
  s_or_b32 s81, s81, 2
  s_nop 7
  v_mov_b32 v88, 0
  v_mov_b32 v89, 0
  v_mov_b32 v90, 0
  v_mov_b32 v91, 0
  v_mov_b32 v92, 0
  v_mov_b32 v93, 0
  v_mov_b32 v94, 0
  v_mov_b32 v95, 0
  v_mov_b32 v96, 0
  v_mov_b32 v97, 0
  v_mov_b32 v98, 0
  v_mov_b32 v99, 0
  v_mov_b32 v100, 0
  v_mov_b32 v101, 0
  v_mov_b32 v102, 0
  v_mov_b32 v103, 0
  s_cmp_eq_u32 s52, 0
  s_cbranch_scc1 mx_54
mx_53:
  buffer_load_dwordx4 v[48:51], v190, s[8:11], s58 offen offset:0 sc1
  buffer_load_dwordx4 v[52:55], v190, s[8:11], s58 offen offset:1024 sc1
  s_add_u32 s54, s54, 1
  s_cmp_gt_u32 s54, 131072
  s_cbranch_scc1 end0
  s_waitcnt vmcnt(0)
  v_max3_u32 v27, v48, v49, v50
  v_max3_u32 v27, v27, v51, v52
  v_max3_u32 v27, v27, v53, v54
  v_max3_u32 v27, v27, v55, v55
  v_cmp_eq_u32 vcc, -1, v27
  s_nop 1
  s_cbranch_vccnz mx_53
  ds_write_b128 v190, v[48:51] offset:0
  ds_write_b128 v190, v[52:55] offset:1024
mx_54:
  s_waitcnt lgkmcnt(0)
  s_branch mo_38
sr_41:
  s_mov_b32 s54, 0
sr_55:
  s_mov_b64 exec, vcc
  buffer_load_dwordx4 v[124:127], v9, s[8:11], s56 offen sc1
  buffer_load_dwordx4 v[128:131], v9, s[8:11], s56 offen offset:1024 sc1
  buffer_load_dwordx4 v[132:135], v10, s[8:11], s56 offen sc1
  s_mov_b64 exec, -1
  s_add_u32 s54, s54, 1
  s_cmp_gt_u32 s54, 131072
  s_cbranch_scc1 end0
  s_waitcnt vmcnt(0)
  v_pk_add_f16 v164, v132, v133
  v_pk_add_f16 v165, v134, v135
  v_pk_add_f16 v120, v124, v126
  v_pk_add_f16 v122, v128, v130
  v_fma_mix_f32 v170, v164, 1.0, v165 op_sel:[0,0,0] op_sel_hi:[1,0,1]
  v_fma_mix_f32 v166, v120, 1.0, v122 op_sel:[0,0,0] op_sel_hi:[1,0,1]
  v_pk_add_f16 v121, v125, v127
  v_cmp_u_f32 vcc, v166, v170
  v_pk_add_f16 v123, v129, v131
  v_fma_mix_f32 v171, v164, 1.0, v165 op_sel:[1,0,1] op_sel_hi:[1,0,1]
  v_fma_mix_f32 v167, v120, 1.0, v122 op_sel:[1,0,1] op_sel_hi:[1,0,1]
  v_fma_mix_f32 v168, v121, 1.0, v123 op_sel:[0,0,0] op_sel_hi:[1,0,1]
  v_fma_mix_f32 v169, v121, 1.0, v123 op_sel:[1,0,1] op_sel_hi:[1,0,1]
  s_cbranch_vccz ex_43
  s_and_b32 s21, s54, 31
  s_cbranch_scc1 sr_55
  v_max3_u32 v27, v124, v126, v128
  v_max3_u32 v27, v27, v130, v132
  v_max3_u32 v27, v27, v133, v134
  v_max3_u32 v27, v27, v135, v135
  v_cmp_eq_u32 vcc, -1, v27
  s_nop 1
  s_cbranch_vccnz sr_55
ex_43:
  v_exp_f32 v176, v170
  v_exp_f32 v177, v171
  v_exp_f32 v172, v166
  v_cvt_pk_bf16_f32 v160, v176, v177
  v_exp_f32 v173, v167
  v_exp_f32 v174, v168
  v_mov_b32_dpp v161, v160 row_ror:8 row_mask:0xf bank_mask:0xf
  v_cvt_pk_bf16_f32 v156, v172, v173
  v_exp_f32 v175, v169
  v_mfma_f32_16x16x32_bf16 v[178:181], v[140:143], v[160:163], 0
  v_mov_b32_dpp v158, v156 row_ror:8 row_mask:0xf bank_mask:0xf
  v_cvt_pk_bf16_f32 v157, v174, v175
  v_mfma_f32_16x16x32_bf16 v[182:185], v[136:139], v[160:163], 0
  s_nop 0
  v_mov_b32_dpp v159, v157 row_ror:8 row_mask:0xf bank_mask:0xf
  v_mfma_f32_16x16x32_bf16 v[186:189], v[138:141], v[160:163], 0
  s_branch pv_42
fx_44:
  s_bitcmp1_b32 s81, 0
  s_cbranch_scc1 fk_45
  s_or_b32 s81, s81, 1
  s_mov_b64 exec, -1
  v_max3_f32 v164, v166, v167, v168
  v_max3_f32 v165, v169, v170, v171
  v_max_f32 v164, v164, v165
  s_nop 1
  v_max_f32_dpp v164, v164, v164 row_ror:8 row_mask:0xf bank_mask:0xf
  v_mov_b32 v165, v164
  s_nop 1
  v_permlane32_swap_b32 v164, v165
  v_max_f32 v164, v164, v165
  v_mov_b32 v165, v164
  s_nop 1
  v_permlane16_swap_b32 v164, v165
  v_max_f32 v164, v164, v165
  v_sub_f32 v166, v166, v164
  v_sub_f32 v167, v167, v164
  v_sub_f32 v168, v168, v164
  v_sub_f32 v169, v169, v164
  v_sub_f32 v170, v170, v164
  v_sub_f32 v171, v171, v164
  s_branch ex_43
p2_50:
  s_mov_b32 s54, 0
  buffer_load_dwordx4 v[68:71], v16, s[4:7], s60 offen sc1
  s_waitcnt vmcnt(1)
  v_mfma_f32_16x16x32_f16 v[120:123], v[44:47], v[72:75], 0
  v_bitop3_b32 v27, v72, s61, 1 bitop3:0x28
  v_cmp_ne_u32 vcc, 0, v27
  s_nop 1
  s_cbranch_vccz pg_49
  buffer_load_dwordx4 v[72:75], v16, s[4:7], s60 offen sc1
pp_48:
  s_waitcnt vmcnt(1)
  v_mfma_f32_16x16x32_f16 v[120:123], v[44:47], v[68:71], 0
  v_bitop3_b32 v27, v68, s61, 1 bitop3:0x28
  v_cmp_ne_u32 vcc, 0, v27
  s_nop 1
  s_cbranch_vccz pg_49
  buffer_load_dwordx4 v[68:71], v16, s[4:7], s60 offen sc1
  s_waitcnt vmcnt(1)
  v_mfma_f32_16x16x32_f16 v[120:123], v[44:47], v[72:75], 0
  v_bitop3_b32 v27, v72, s61, 1 bitop3:0x28
  v_cmp_ne_u32 vcc, 0, v27
  s_nop 1
  s_cbranch_vccz pg_49
  buffer_load_dwordx4 v[72:75], v16, s[4:7], s60 offen sc1
  s_add_u32 s54, s54, 1
  s_cmp_gt_u32 s54, 131072
  s_cbranch_scc1 end0
  s_branch pp_48
last_37:
  v_min_u32 v104, -2, v104
  buffer_store_dwordx4 v[104:107], v36, s[16:19], s70 offen offset:2560 sc1
  v_smfmac_f32_16x16x64_bf16 v[96:99], v[48:51], a[0:7], v22
  v_smfmac_f32_16x16x64_bf16 v[100:103], v[48:51], a[80:87], v22
  v_smfmac_f32_16x16x64_bf16 v[96:99], v[52:55], a[8:15], v22
  v_smfmac_f32_16x16x64_bf16 v[100:103], v[52:55], a[88:95], v22
  v_smfmac_f32_16x16x64_bf16 v[96:99], v[56:59], a[16:23], v22
  v_smfmac_f32_16x16x64_bf16 v[100:103], v[56:59], a[96:103], v22
  v_smfmac_f32_16x16x64_bf16 v[96:99], v[60:63], a[24:31], v22
  v_smfmac_f32_16x16x64_bf16 v[96:99], v[64:67], a[32:39], v22
  v_smfmac_f32_16x16x64_bf16 v[96:99], v[68:71], a[40:47], v22
  v_smfmac_f32_16x16x64_bf16 v[96:99], v[72:75], a[48:55], v22
  v_smfmac_f32_16x16x64_bf16 v[96:99], v[76:79], a[56:63], v22
  v_smfmac_f32_16x16x64_bf16 v[96:99], v[80:83], a[64:71], v22
  v_smfmac_f32_16x16x64_bf16 v[96:99], v[84:87], a[72:79], v22
  v_smfmac_f32_16x16x64_bf16 v[100:103], v[60:63], a[104:111], v22
  v_smfmac_f32_16x16x64_bf16 v[100:103], v[64:67], a[112:119], v22
  v_smfmac_f32_16x16x64_bf16 v[100:103], v[68:71], a[120:127], v22
  v_smfmac_f32_16x16x64_bf16 v[100:103], v[72:75], a[128:135], v22
  v_smfmac_f32_16x16x64_bf16 v[100:103], v[76:79], a[136:143], v22
  v_smfmac_f32_16x16x64_bf16 v[100:103], v[80:83], a[144:151], v22
  v_smfmac_f32_16x16x64_bf16 v[100:103], v[84:87], a[152:159], v22
  s_nop 7
  v_permlane32_swap_b32 v96, v100
  v_permlane32_swap_b32 v97, v101
  v_permlane32_swap_b32 v98, v102
  v_permlane32_swap_b32 v99, v103
  v_pk_add_f32 v[96:97], v[96:97], v[100:101]
  v_pk_add_f32 v[98:99], v[98:99], v[102:103]
  v_cvt_pk_bf16_f32 v100, v96, v97
  v_cvt_pk_bf16_f32 v101, v98, v99
  s_nop 0
  v_permlane32_swap_b32 v100, v102
  v_permlane32_swap_b32 v101, v103
  v_min_u32 v100, -2, v100
  buffer_store_dwordx4 v[100:103], v26, s[16:19], s70 offen sc1
  s_waitcnt vmcnt(0)
  s_barrier
  s_branch chain_done
E_28:
  v_add_u32 v190, 2048, v4
  ds_write_b64 v6, v[28:29]
  ds_write_b32 v13, v28
  ds_write_b32 v14, v28
  s_waitcnt vmcnt(0)
  ds_write_b128 v190, v[56:59] offset:0
  ds_write_b128 v190, v[60:63] offset:1024
  ds_write_b128 v190, v[64:67] offset:2048
  s_waitcnt lgkmcnt(0)
  s_add_u32 m0, s74, 6144
  s_add_u32 s21, s79, 196608
  buffer_load_dwordx4 v4, s[16:19], s21 offen offset:1024 sc1 lds
  s_add_u32 m0, s74, 4096
  s_mul_i32 s21, s91, 2
  s_add_u32 s21, s21, s71
  buffer_load_dwordx4 v4, s[16:19], s21 offen sc1 lds
  s_xor_b32 s74, s74, 16384
  s_add_u32 s73, s73, 2097152
  s_xor_b32 s73, s73, 8192
  s_add_u32 s79, s79, 2097152
  s_xor_b32 s79, s79, 8192
  s_add_u32 s21, s72, 524288
  s_xor_b32 s72, s72, s21
  s_lshr_b32 s72, s72, 8
  s_and_b32 s72, s72, 8192
  s_xor_b32 s72, s72, s21
  s_add_u32 s71, s73, 4096
  s_mov_b32 s91, 1024
  s_sub_u32 s21, s73, 0
  s_cmp_lt_u32 s21, 125829120
  s_cselect_b32 s71, s71, s79
  s_cselect_b32 s91, s91, 65536
  s_branch mo_62
  .p2align 3
top_57:
  s_waitcnt vmcnt(2)
  ds_write_b128 v190, v[56:59] offset:0
  v_cmp_eq_u32 s[22:23], -1, v56
  s_waitcnt vmcnt(1)
  ds_write_b128 v190, v[60:63] offset:1024
  v_cmp_eq_u32 s[98:99], -1, v60
  s_waitcnt vmcnt(0)
  ds_write_b128 v190, v[64:67] offset:2048
  v_cmp_eq_u32 s[100:101], -1, v64
  s_or_b64 vcc, s[22:23], s[98:99]
  s_or_b64 vcc, vcc, s[100:101]
  s_cbranch_scc1 mr_58
mo_62:
  s_barrier
  ds_read_b128 v[48:51], v4 offset:0
  ds_read_b128 v[52:55], v4 offset:1024
  v_smfmac_f32_16x16x64_bf16 v[92:95], v[56:59], v[192:199], v22
  ds_read_b128 v[68:71], v4 offset:5120
  v_smfmac_f32_16x16x64_bf16 v[88:91], v[56:59], a[176:183], v22
  ds_read_b128 v[72:75], v4 offset:6144
  v_smfmac_f32_16x16x64_bf16 v[92:95], v[60:63], v[200:207], v22
  ds_read_b128 v[76:79], v4 offset:7168
  v_smfmac_f32_16x16x64_bf16 v[88:91], v[60:63], a[184:191], v22
  ds_read_b128 v[80:83], v4 offset:8192
  v_smfmac_f32_16x16x64_bf16 v[92:95], v[64:67], v[208:215], v22
  ds_read_b128 v[84:87], v4 offset:9216
  v_smfmac_f32_16x16x64_bf16 v[88:91], v[64:67], a[192:199], v22
  s_waitcnt lgkmcnt(6)
  v_smfmac_f32_16x16x64_bf16 v[92:95], v[48:51], a[240:247], v22
  v_smfmac_f32_16x16x64_bf16 v[88:91], v[48:51], a[160:167], v22
  s_waitcnt lgkmcnt(5)
  v_smfmac_f32_16x16x64_bf16 v[92:95], v[52:55], a[248:255], v22
  s_waitcnt lgkmcnt(4)
  v_smfmac_f32_16x16x64_bf16 v[92:95], v[68:71], v[216:223], v22
  s_waitcnt lgkmcnt(3)
  v_smfmac_f32_16x16x64_bf16 v[92:95], v[72:75], v[224:231], v22
  s_waitcnt lgkmcnt(2)
  v_smfmac_f32_16x16x64_bf16 v[92:95], v[76:79], v[232:239], v22
  s_waitcnt lgkmcnt(1)
  v_smfmac_f32_16x16x64_bf16 v[92:95], v[80:83], v[240:247], v22
  s_waitcnt lgkmcnt(0)
  v_smfmac_f32_16x16x64_bf16 v[92:95], v[84:87], v[248:255], v22
  v_smfmac_f32_16x16x64_bf16 v[88:91], v[52:55], a[168:175], v22
  v_smfmac_f32_16x16x64_bf16 v[88:91], v[68:71], a[200:207], v22
  v_smfmac_f32_16x16x64_bf16 v[88:91], v[72:75], a[208:215], v22
  v_permlane32_swap_b32 v92, v93
  v_smfmac_f32_16x16x64_bf16 v[88:91], v[76:79], a[216:223], v22
  v_permlane32_swap_b32 v94, v95
  v_smfmac_f32_16x16x64_bf16 v[88:91], v[80:83], a[224:231], v22
  v_permlane32_swap_b32 v93, v92
  v_smfmac_f32_16x16x64_bf16 v[88:91], v[84:87], a[232:239], v22
  v_permlane32_swap_b32 v95, v94
  v_pk_mul_f32 v[120:121], v[92:93], v[24:25] op_sel:[1,0] op_sel_hi:[0,1]
  v_pk_mul_f32 v[122:123], v[94:95], v[24:25] op_sel:[1,0] op_sel_hi:[0,1]
  s_nop 4
  v_pk_fma_f32 v[88:89], v[88:89], v[24:25], v[120:121]
  v_pk_fma_f32 v[90:91], v[90:91], v[24:25], v[122:123]
  v_cvt_pk_bf16_f32 v120, v88, v89
  v_cvt_pk_bf16_f32 v121, v90, v91
  ds_write_b64 v6, v[120:121]
  s_barrier
  ds_read_b64_tr_b16 v[104:105], v7 offset:0
  ds_read_b64_tr_b16 v[106:107], v7 offset:768
  ds_read_b64_tr_b16 v[108:109], v7 offset:1536
  s_waitcnt lgkmcnt(1)
  v_mfma_f32_16x16x32_bf16 v[120:123], v[112:115], v[104:107], 0
  s_waitcnt lgkmcnt(0)
  v_mfma_f32_16x16x32_bf16 v[120:123], v[116:119], v[108:111], v[120:123]
  s_mov_b64 exec, s[64:65]
  s_nop 6
  v_cmpx_o_f32 vcc, v120, v121
  v_cvt_pk_f16_f32 v120, v120, v121
  v_cvt_pk_f16_f32 v121, v122, v123
  buffer_store_dwordx2 v[120:121], v8, s[8:11], s56 offen
  s_xor_b64 s[98:99], exec, s[64:65]
  s_mov_b64 exec, -1
  s_waitcnt lgkmcnt(0)
  s_barrier
  ds_read_b64_tr_b16 v[104:105], v7 offset:0
  ds_read_b64_tr_b16 v[106:107], v7 offset:768
  ds_read_b64_tr_b16 v[108:109], v7 offset:1536
  ds_read_b32 v27, v12 offset:12544
  ds_read_b64 v[140:141], v11
  s_waitcnt lgkmcnt(1)
  v_cmp_u_f32 vcc, v104, v106
  v_cmp_u_f32 s[22:23], v108, v27
  s_nop 1
  s_or_b64 vcc, vcc, s[22:23]
  s_cbranch_vccnz mn_59
mk_60:
  s_cmp_eq_u32 s52, 63
  s_cbranch_scc1 last_61
  s_cmp_lg_u64 s[98:99], 0
  s_cbranch_scc1 sf_63
sf_64:
  s_nop 15
  s_nop 10
  v_smfmac_f32_16x16x64_bf16 v[96:99], v[48:51], a[0:7], v22
  v_smfmac_f32_16x16x64_bf16 v[100:103], v[48:51], a[80:87], v22
  v_smfmac_f32_16x16x64_bf16 v[96:99], v[52:55], a[8:15], v22
  v_smfmac_f32_16x16x64_bf16 v[100:103], v[52:55], a[88:95], v22
  v_smfmac_f32_16x16x64_bf16 v[96:99], v[56:59], a[16:23], v22
  v_smfmac_f32_16x16x64_bf16 v[100:103], v[56:59], a[96:103], v22
  buffer_load_dwordx4 v[132:135], v10, s[8:11], s56 offen sc1
  v_smfmac_f32_16x16x64_bf16 v[96:99], v[60:63], a[24:31], v22
  buffer_load_dwordx4 v[124:127], v9, s[8:11], s56 offen sc1
  v_smfmac_f32_16x16x64_bf16 v[96:99], v[64:67], a[32:39], v22
  buffer_load_dwordx4 v[128:131], v9, s[8:11], s56 offen offset:1024 sc1
  v_smfmac_f32_16x16x64_bf16 v[96:99], v[68:71], a[40:47], v22
  v_smfmac_f32_16x16x64_bf16 v[96:99], v[72:75], a[48:55], v22
  v_smfmac_f32_16x16x64_bf16 v[96:99], v[76:79], a[56:63], v22
  v_smfmac_f32_16x16x64_bf16 v[96:99], v[80:83], a[64:71], v22
  v_smfmac_f32_16x16x64_bf16 v[96:99], v[84:87], a[72:79], v22
  v_smfmac_f32_16x16x64_bf16 v[100:103], v[60:63], a[104:111], v22
  v_smfmac_f32_16x16x64_bf16 v[100:103], v[64:67], a[112:119], v22
  v_smfmac_f32_16x16x64_bf16 v[100:103], v[68:71], a[120:127], v22
  v_smfmac_f32_16x16x64_bf16 v[100:103], v[72:75], a[128:135], v22
  v_cvt_pk_bf16_f32 v136, v96, v97
  v_smfmac_f32_16x16x64_bf16 v[100:103], v[76:79], a[136:143], v22
  v_cvt_pk_bf16_f32 v137, v98, v99
  v_smfmac_f32_16x16x64_bf16 v[100:103], v[80:83], a[144:151], v22
  v_smfmac_f32_16x16x64_bf16 v[100:103], v[84:87], a[152:159], v22
  s_nop 7
  v_cvt_pk_bf16_f32 v138, v100, v101
  v_cvt_pk_bf16_f32 v139, v102, v103
  s_waitcnt vmcnt(2) lgkmcnt(0)
  v_pk_add_f16 v164, v132, v133
  v_pk_add_f16 v165, v134, v135
  v_fma_mix_f32 v170, v164, 1.0, v165 op_sel:[0,0,0] op_sel_hi:[1,0,1]
  v_fma_mix_f32 v171, v164, 1.0, v165 op_sel:[1,0,1] op_sel_hi:[1,0,1]
  v_exp_f32 v176, v170
  v_exp_f32 v177, v171
  s_waitcnt vmcnt(1)
  v_cvt_pk_bf16_f32 v160, v176, v177
  v_pk_add_f16 v120, v124, v126
  v_pk_add_f16 v121, v125, v127
  v_mov_b32_dpp v161, v160 row_ror:8 row_mask:0xf bank_mask:0xf
  s_waitcnt vmcnt(0)
  v_pk_add_f16 v122, v128, v130
  v_mfma_f32_16x16x32_bf16 v[178:181], v[140:143], v[160:163], 0
  v_fma_mix_f32 v166, v120, 1.0, v122 op_sel:[0,0,0] op_sel_hi:[1,0,1]
  v_fma_mix_f32 v167, v120, 1.0, v122 op_sel:[1,0,1] op_sel_hi:[1,0,1]
  v_cmp_u_f32 vcc, v166, v170
  v_pk_add_f16 v123, v129, v131
  v_exp_f32 v172, v166
  v_mfma_f32_16x16x32_bf16 v[182:185], v[136:139], v[160:163], 0
  s_cbranch_vccnz sr_65
  v_exp_f32 v173, v167
  v_fma_mix_f32 v168, v121, 1.0, v123 op_sel:[0,0,0] op_sel_hi:[1,0,1]
  v_fma_mix_f32 v169, v121, 1.0, v123 op_sel:[1,0,1] op_sel_hi:[1,0,1]
  v_cvt_pk_bf16_f32 v156, v172, v173
  v_exp_f32 v174, v168
  v_exp_f32 v175, v169
  v_mov_b32_dpp v158, v156 row_ror:8 row_mask:0xf bank_mask:0xf
  v_cvt_pk_bf16_f32 v157, v174, v175
  v_mfma_f32_16x16x32_bf16 v[186:189], v[138:141], v[160:163], 0
  s_nop 0
  v_mov_b32_dpp v159, v157 row_ror:8 row_mask:0xf bank_mask:0xf
  s_nop 1
pv_66:
  v_mfma_f32_16x16x32_bf16 v[178:181], v[152:155], v[156:159], v[178:181]
  v_mfma_f32_16x16x32_bf16 v[182:185], v[144:147], v[156:159], v[182:185]
  v_mfma_f32_16x16x32_bf16 v[186:189], v[148:151], v[156:159], v[186:189]
  s_mov_b64 exec, s[62:63]
  s_nop 0
  v_rcp_f32 v164, v180
  v_cmp_ngt_f32 s[22:23], s80, v180
  v_cmp_ngt_f32 vcc, s80, v164
  v_pk_mul_f32 v[182:183], v[182:183], v[164:165] op_sel_hi:[1,0]
  v_pk_mul_f32 v[184:185], v[184:185], v[164:165] op_sel_hi:[1,0]
  v_pk_mul_f32 v[178:179], v[178:179], v[164:165] op_sel_hi:[1,0]
  v_pk_mul_f32 v[186:187], v[186:187], v[164:165] op_sel_hi:[1,0]
  v_pk_mul_f32 v[188:189], v[188:189], v[164:165] op_sel_hi:[1,0]
  v_cvt_pk_f16_f32 v64, v178, v179
  s_or_b64 vcc, vcc, s[22:23]
  s_cbranch_scc1 fx_68
fk_69:
  ds_write_b32 v14, v64
  v_cvt_pk_f16_f32 v60, v182, v183
  v_cvt_pk_f16_f32 v61, v184, v185
  v_cvt_pk_f16_f32 v62, v186, v187
  v_cvt_pk_f16_f32 v63, v188, v189
  ds_write_b128 v13, v[60:63]
  s_barrier
  s_mov_b64 exec, -1
  s_add_u32 m0, s74, 6144
  s_add_u32 s21, s79, 196608
  buffer_load_dwordx4 v4, s[16:19], s21 offen offset:1024 sc1 lds
  s_add_u32 m0, s74, 4096
  s_mul_i32 s21, s91, 2
  s_add_u32 s21, s21, s71
  buffer_load_dwordx4 v4, s[16:19], s21 offen sc1 lds
  s_xor_b32 s74, s74, 16384
  s_add_u32 s73, s73, 2097152
  s_xor_b32 s73, s73, 8192
  s_add_u32 s79, s79, 2097152
  s_xor_b32 s79, s79, 8192
  s_add_u32 s21, s72, 524288
  s_xor_b32 s72, s72, s21
  s_lshr_b32 s72, s72, 8
  s_and_b32 s72, s72, 8192
  s_xor_b32 s72, s72, s21
  s_add_u32 s71, s73, 4096
  s_mov_b32 s91, 1024
  s_sub_u32 s21, s73, 0
  s_cmp_lt_u32 s21, 125829120
  s_cselect_b32 s71, s71, s79
  s_cselect_b32 s91, s91, 65536
  v_permlane32_swap_b32 v96, v100
  v_permlane32_swap_b32 v97, v101
  v_permlane32_swap_b32 v98, v102
  v_permlane32_swap_b32 v99, v103
  v_pk_add_f32 v[96:97], v[96:97], v[100:101]
  v_pk_add_f32 v[98:99], v[98:99], v[102:103]
  v_cvt_pk_bf16_f32 v100, v96, v97
  v_cvt_pk_bf16_f32 v101, v98, v99
  s_nop 0
  v_permlane32_swap_b32 v100, v102
  v_permlane32_swap_b32 v101, v103
  v_min_u32 v100, -2, v100
  s_nop 6
  buffer_store_dwordx4 v[100:103], v26, s[16:19], s70 offen sc1
  v_min_u32 v108, -2, v108
  buffer_store_dwordx2 v[108:109], v37, s[16:19], s70 offen offset:3072 sc1
  s_add_u32 s70, s70, 2097152
  s_xor_b32 s70, s70, 8192
  ds_read_b128 v[144:147], v18
  ds_read_b128 v[148:151], v18 offset:1024
  ds_read_b128 v[152:155], v19
  ds_read_b128 v[112:115], v20
  ds_read_b64 v[116:117], v21
  v_xor_b32 v18, 16384, v18
  v_xor_b32 v19, 16384, v19
  v_xor_b32 v20, 16384, v20
  v_xor_b32 v21, 16384, v21
  v_mov_b32 v88, 0
  v_mov_b32 v89, 0
  v_mov_b32 v90, 0
  v_mov_b32 v91, 0
  v_mov_b32 v92, 0
  v_mov_b32 v93, 0
  v_mov_b32 v94, 0
  v_mov_b32 v95, 0
  v_mov_b32 v96, 0
  v_mov_b32 v97, 0
  v_mov_b32 v98, 0
  v_mov_b32 v99, 0
  v_mov_b32 v100, 0
  v_mov_b32 v101, 0
  v_mov_b32 v102, 0
  v_mov_b32 v103, 0
  s_mov_b32 s81, 0
  s_waitcnt lgkmcnt(0)
  s_barrier
  s_mov_b64 exec, s[64:65]
  buffer_store_dwordx2 v[28:29], v8, s[8:11], s57 offen
  s_mov_b64 exec, -1
  ds_write_b128 v190, v[28:31] offset:0
  ds_write_b128 v190, v[28:31] offset:1024
  ds_write_b128 v190, v[28:31] offset:2048
  ds_write_b64 v6, v[28:29]
  s_mov_b64 exec, s[62:63]
  buffer_store_dword v28, v17, s[8:11], s59 offen
  s_mov_b64 exec, -1
  s_sleep 3
  s_nop 1
  buffer_load_dwordx4 v[68:71], v16, s[4:7], s60 offen sc1
  s_sleep 3
  s_nop 1
  buffer_load_dwordx4 v[72:75], v16, s[4:7], s60 offen sc1
  s_waitcnt vmcnt(1)
  v_mfma_f32_16x16x32_f16 v[120:123], v[44:47], v[68:71], 0
  v_bitop3_b32 v27, v68, s61, 1 bitop3:0x28
  v_cmp_ne_u32 vcc, 0, v27
  s_nop 1
  s_cbranch_vccnz p2_74
  s_nop 2
pg_73:
  v_add_f32_dpp v120, v120, v120 row_ror:8 row_mask:0xf bank_mask:0xf
  v_add_f32_dpp v121, v121, v121 row_ror:8 row_mask:0xf bank_mask:0xf
  s_mov_b64 exec, s[62:63]
  v_cvt_pk_bf16_f32 v120, v120, v121
  v_min_u32 v120, -2, v120
  buffer_store_dword v120, v17, s[8:11], s55 offen
  s_mov_b64 exec, -1
nt_70:
  s_barrier
  s_mov_b32 s58, s55
  s_add_u32 s52, s52, 1
  ds_write_b32 v13, v28
  ds_write_b32 v14, v28
  s_and_b32 s21, s52, 3
  s_mul_i32 s56, s21, 122880
  s_add_u32 s21, s52, 1
  s_and_b32 s21, s21, 3
  s_mul_i32 s55, s21, 122880
  s_add_u32 s55, s55, s75
  s_add_u32 s21, s52, 2
  s_and_b32 s21, s21, 3
  s_mul_i32 s57, s21, 122880
  s_add_u32 s21, s52, 3
  s_and_b32 s21, s21, 3
  s_mul_i32 s59, s21, 122880
  s_add_u32 s59, s59, s75
  s_bfe_u32 s61, s52, 0x10002
  s_and_b32 s21, s52, 3
  s_lshl_b32 s60, s21, 18
  s_mov_b32 s54, 0
  s_sleep 3
  s_waitcnt lgkmcnt(0)
  buffer_load_dwordx4 v[56:59], v190, s[8:11], s58 offen offset:0 sc1
  buffer_load_dwordx4 v[60:63], v190, s[8:11], s58 offen offset:1024 sc1
  buffer_load_dwordx4 v[64:67], v190, s[8:11], s58 offen offset:2048 sc1
  s_branch top_57
mr_58:
  s_mov_b64 exec, s[22:23]
  s_cbranch_execz ms_75
  buffer_load_dwordx4 v[56:59], v190, s[8:11], s58 offen offset:0 sc1
ms_75:
  s_mov_b64 exec, s[98:99]
  s_cbranch_execz ms_76
  buffer_load_dwordx4 v[60:63], v190, s[8:11], s58 offen offset:1024 sc1
ms_76:
  s_mov_b64 exec, s[100:101]
  s_cbranch_execz ms_77
  buffer_load_dwordx4 v[64:67], v190, s[8:11], s58 offen offset:2048 sc1
ms_77:
  s_add_u32 s54, s54, 1
  s_cmp_gt_u32 s54, 131072
  s_cbranch_scc1 end0
  s_waitcnt vmcnt(0)
  s_mov_b64 exec, s[22:23]
  ds_write_b128 v190, v[56:59] offset:0
  v_cmp_eq_u32 s[22:23], -1, v56
  s_mov_b64 exec, s[98:99]
  ds_write_b128 v190, v[60:63] offset:1024
  v_cmp_eq_u32 s[98:99], -1, v60
  s_mov_b64 exec, s[100:101]
  ds_write_b128 v190, v[64:67] offset:2048
  v_cmp_eq_u32 s[100:101], -1, v64
  s_mov_b64 exec, -1
  s_or_b64 vcc, s[22:23], s[98:99]
  s_or_b64 vcc, vcc, s[100:101]
  s_cbranch_scc1 mr_58
  s_branch mo_62
sf_63:
  s_waitcnt lgkmcnt(1)
  v_mfma_f32_16x16x32_bf16 v[120:123], v[112:115], v[104:107], 0
  s_waitcnt lgkmcnt(0)
  v_mfma_f32_16x16x32_bf16 v[120:123], v[116:119], v[108:111], v[120:123]
  s_mov_b64 exec, s[64:65]
  s_nop 6
  v_cvt_pk_f16_f32 v120, v120, v121
  v_cvt_pk_f16_f32 v121, v122, v123
  buffer_store_dwordx2 v[120:121], v8, s[8:11], s56 offen
  s_mov_b64 exec, -1
  s_branch sf_64
mn_59:
  s_bitcmp1_b32 s81, 1
  s_cbranch_scc1 mk_60
  s_or_b32 s81, s81, 2
  s_nop 7
  v_mov_b32 v88, 0
  v_mov_b32 v89, 0
  v_mov_b32 v90, 0
  v_mov_b32 v91, 0
  v_mov_b32 v92, 0
  v_mov_b32 v93, 0
  v_mov_b32 v94, 0
  v_mov_b32 v95, 0
  v_mov_b32 v96, 0
  v_mov_b32 v97, 0
  v_mov_b32 v98, 0
  v_mov_b32 v99, 0
  v_mov_b32 v100, 0
  v_mov_b32 v101, 0
  v_mov_b32 v102, 0
  v_mov_b32 v103, 0
  s_cmp_eq_u32 s52, 0
  s_cbranch_scc1 mx_79
mx_78:
  buffer_load_dwordx4 v[56:59], v190, s[8:11], s58 offen offset:0 sc1
  buffer_load_dwordx4 v[60:63], v190, s[8:11], s58 offen offset:1024 sc1
  buffer_load_dwordx4 v[64:67], v190, s[8:11], s58 offen offset:2048 sc1
  s_add_u32 s54, s54, 1
  s_cmp_gt_u32 s54, 131072
  s_cbranch_scc1 end0
  s_waitcnt vmcnt(0)
  v_max3_u32 v27, v56, v57, v58
  v_max3_u32 v27, v27, v59, v60
  v_max3_u32 v27, v27, v61, v62
  v_max3_u32 v27, v27, v63, v64
  v_max3_u32 v27, v27, v65, v66
  v_max3_u32 v27, v27, v67, v67
  v_cmp_eq_u32 vcc, -1, v27
  s_nop 1
  s_cbranch_vccnz mx_78
  ds_write_b128 v190, v[56:59] offset:0
  ds_write_b128 v190, v[60:63] offset:1024
  ds_write_b128 v190, v[64:67] offset:2048
mx_79:
  s_waitcnt lgkmcnt(0)
  s_branch mo_62
sr_65:
  s_mov_b32 s54, 0
sr_80:
  s_mov_b64 exec, vcc
  buffer_load_dwordx4 v[124:127], v9, s[8:11], s56 offen sc1
  buffer_load_dwordx4 v[128:131], v9, s[8:11], s56 offen offset:1024 sc1
  buffer_load_dwordx4 v[132:135], v10, s[8:11], s56 offen sc1
  s_mov_b64 exec, -1
  s_add_u32 s54, s54, 1
  s_cmp_gt_u32 s54, 131072
  s_cbranch_scc1 end0
  s_waitcnt vmcnt(0)
  v_pk_add_f16 v164, v132, v133
  v_pk_add_f16 v165, v134, v135
  v_pk_add_f16 v120, v124, v126
  v_pk_add_f16 v122, v128, v130
  v_fma_mix_f32 v170, v164, 1.0, v165 op_sel:[0,0,0] op_sel_hi:[1,0,1]
  v_fma_mix_f32 v166, v120, 1.0, v122 op_sel:[0,0,0] op_sel_hi:[1,0,1]
  v_pk_add_f16 v121, v125, v127
  v_cmp_u_f32 vcc, v166, v170
  v_pk_add_f16 v123, v129, v131
  v_fma_mix_f32 v171, v164, 1.0, v165 op_sel:[1,0,1] op_sel_hi:[1,0,1]
  v_fma_mix_f32 v167, v120, 1.0, v122 op_sel:[1,0,1] op_sel_hi:[1,0,1]
  v_fma_mix_f32 v168, v121, 1.0, v123 op_sel:[0,0,0] op_sel_hi:[1,0,1]
  v_fma_mix_f32 v169, v121, 1.0, v123 op_sel:[1,0,1] op_sel_hi:[1,0,1]
  s_cbranch_vccz ex_67
  s_and_b32 s21, s54, 31
  s_cbranch_scc1 sr_80
  v_max3_u32 v27, v124, v126, v128
  v_max3_u32 v27, v27, v130, v132
  v_max3_u32 v27, v27, v133, v134
  v_max3_u32 v27, v27, v135, v135
  v_cmp_eq_u32 vcc, -1, v27
  s_nop 1
  s_cbranch_vccnz sr_80
ex_67:
  v_exp_f32 v176, v170
  v_exp_f32 v177, v171
  v_exp_f32 v172, v166
  v_cvt_pk_bf16_f32 v160, v176, v177
  v_exp_f32 v173, v167
  v_exp_f32 v174, v168
  v_mov_b32_dpp v161, v160 row_ror:8 row_mask:0xf bank_mask:0xf
  v_cvt_pk_bf16_f32 v156, v172, v173
  v_exp_f32 v175, v169
  v_mfma_f32_16x16x32_bf16 v[178:181], v[140:143], v[160:163], 0
  v_mov_b32_dpp v158, v156 row_ror:8 row_mask:0xf bank_mask:0xf
  v_cvt_pk_bf16_f32 v157, v174, v175
  v_mfma_f32_16x16x32_bf16 v[182:185], v[136:139], v[160:163], 0
  s_nop 0
  v_mov_b32_dpp v159, v157 row_ror:8 row_mask:0xf bank_mask:0xf
  v_mfma_f32_16x16x32_bf16 v[186:189], v[138:141], v[160:163], 0
  s_branch pv_66
fx_68:
  s_bitcmp1_b32 s81, 0
  s_cbranch_scc1 fk_69
  s_or_b32 s81, s81, 1
  s_mov_b64 exec, -1
  v_max3_f32 v164, v166, v167, v168
  v_max3_f32 v165, v169, v170, v171
  v_max_f32 v164, v164, v165
  s_nop 1
  v_max_f32_dpp v164, v164, v164 row_ror:8 row_mask:0xf bank_mask:0xf
  v_mov_b32 v165, v164
  s_nop 1
  v_permlane32_swap_b32 v164, v165
  v_max_f32 v164, v164, v165
  v_mov_b32 v165, v164
  s_nop 1
  v_permlane16_swap_b32 v164, v165
  v_max_f32 v164, v164, v165
  v_sub_f32 v166, v166, v164
  v_sub_f32 v167, v167, v164
  v_sub_f32 v168, v168, v164
  v_sub_f32 v169, v169, v164
  v_sub_f32 v170, v170, v164
  v_sub_f32 v171, v171, v164
  s_branch ex_67
p2_74:
  s_mov_b32 s54, 0
  buffer_load_dwordx4 v[68:71], v16, s[4:7], s60 offen sc1
  s_waitcnt vmcnt(1)
  v_mfma_f32_16x16x32_f16 v[120:123], v[44:47], v[72:75], 0
  v_bitop3_b32 v27, v72, s61, 1 bitop3:0x28
  v_cmp_ne_u32 vcc, 0, v27
  s_nop 1
  s_cbranch_vccz pg_73
  buffer_load_dwordx4 v[72:75], v16, s[4:7], s60 offen sc1
pp_72:
  s_waitcnt vmcnt(1)
  v_mfma_f32_16x16x32_f16 v[120:123], v[44:47], v[68:71], 0
  v_bitop3_b32 v27, v68, s61, 1 bitop3:0x28
  v_cmp_ne_u32 vcc, 0, v27
  s_nop 1
  s_cbranch_vccz pg_73
  buffer_load_dwordx4 v[68:71], v16, s[4:7], s60 offen sc1
  s_waitcnt vmcnt(1)
  v_mfma_f32_16x16x32_f16 v[120:123], v[44:47], v[72:75], 0
  v_bitop3_b32 v27, v72, s61, 1 bitop3:0x28
  v_cmp_ne_u32 vcc, 0, v27
  s_nop 1
  s_cbranch_vccz pg_73
  buffer_load_dwordx4 v[72:75], v16, s[4:7], s60 offen sc1
  s_add_u32 s54, s54, 1
  s_cmp_gt_u32 s54, 131072
  s_cbranch_scc1 end0
  s_branch pp_72
last_61:
  v_min_u32 v108, -2, v108
  buffer_store_dwordx2 v[108:109], v37, s[16:19], s70 offen offset:3072 sc1
  v_smfmac_f32_16x16x64_bf16 v[96:99], v[48:51], a[0:7], v22
  v_smfmac_f32_16x16x64_bf16 v[100:103], v[48:51], a[80:87], v22
  v_smfmac_f32_16x16x64_bf16 v[96:99], v[52:55], a[8:15], v22
  v_smfmac_f32_16x16x64_bf16 v[100:103], v[52:55], a[88:95], v22
  v_smfmac_f32_16x16x64_bf16 v[96:99], v[56:59], a[16:23], v22
  v_smfmac_f32_16x16x64_bf16 v[100:103], v[56:59], a[96:103], v22
  v_smfmac_f32_16x16x64_bf16 v[96:99], v[60:63], a[24:31], v22
  v_smfmac_f32_16x16x64_bf16 v[96:99], v[64:67], a[32:39], v22
  v_smfmac_f32_16x16x64_bf16 v[96:99], v[68:71], a[40:47], v22
  v_smfmac_f32_16x16x64_bf16 v[96:99], v[72:75], a[48:55], v22
  v_smfmac_f32_16x16x64_bf16 v[96:99], v[76:79], a[56:63], v22
  v_smfmac_f32_16x16x64_bf16 v[96:99], v[80:83], a[64:71], v22
  v_smfmac_f32_16x16x64_bf16 v[96:99], v[84:87], a[72:79], v22
  v_smfmac_f32_16x16x64_bf16 v[100:103], v[60:63], a[104:111], v22
  v_smfmac_f32_16x16x64_bf16 v[100:103], v[64:67], a[112:119], v22
  v_smfmac_f32_16x16x64_bf16 v[100:103], v[68:71], a[120:127], v22
  v_smfmac_f32_16x16x64_bf16 v[100:103], v[72:75], a[128:135], v22
  v_smfmac_f32_16x16x64_bf16 v[100:103], v[76:79], a[136:143], v22
  v_smfmac_f32_16x16x64_bf16 v[100:103], v[80:83], a[144:151], v22
  v_smfmac_f32_16x16x64_bf16 v[100:103], v[84:87], a[152:159], v22
  s_nop 7
  v_permlane32_swap_b32 v96, v100
  v_permlane32_swap_b32 v97, v101
  v_permlane32_swap_b32 v98, v102
  v_permlane32_swap_b32 v99, v103
  v_pk_add_f32 v[96:97], v[96:97], v[100:101]
  v_pk_add_f32 v[98:99], v[98:99], v[102:103]
  v_cvt_pk_bf16_f32 v100, v96, v97
  v_cvt_pk_bf16_f32 v101, v98, v99
  s_nop 0
  v_permlane32_swap_b32 v100, v102
  v_permlane32_swap_b32 v101, v103
  v_min_u32 v100, -2, v100
  buffer_store_dwordx4 v[100:103], v26, s[16:19], s70 offen sc1
  s_waitcnt vmcnt(0)
  s_barrier
  s_branch chain_done
E_30:
  v_add_u32 v190, 5120, v4
  ds_write_b64 v6, v[28:29]
  ds_write_b32 v13, v28
  ds_write_b32 v14, v28
  s_waitcnt vmcnt(0)
  ds_write_b128 v190, v[68:71] offset:0
  ds_write_b128 v190, v[72:75] offset:1024
  s_waitcnt lgkmcnt(0)
  s_add_u32 m0, s74, 8192
  s_add_u32 s21, s72, 0
  buffer_load_dwordx4 v32, s[16:19], s21 offen sc1 lds
  s_add_u32 m0, s74, 6144
  s_mul_i32 s21, s91, 3
  s_add_u32 s21, s21, s71
  buffer_load_dwordx4 v4, s[16:19], s21 offen sc1 lds
  s_xor_b32 s74, s74, 16384
  s_add_u32 s73, s73, 2097152
  s_xor_b32 s73, s73, 8192
  s_add_u32 s79, s79, 2097152
  s_xor_b32 s79, s79, 8192
  s_add_u32 s21, s72, 524288
  s_xor_b32 s72, s72, s21
  s_lshr_b32 s72, s72, 8
  s_and_b32 s72, s72, 8192
  s_xor_b32 s72, s72, s21
  s_add_u32 s71, s73, 4096
  s_mov_b32 s91, 1024
  s_sub_u32 s21, s73, 0
  s_cmp_lt_u32 s21, 125829120
  s_cselect_b32 s71, s71, s79
  s_cselect_b32 s91, s91, 65536
  s_branch mo_87
  .p2align 3
top_82:
  s_waitcnt vmcnt(1)
  ds_write_b128 v190, v[68:71] offset:0
  v_cmp_eq_u32 s[22:23], -1, v68
  s_waitcnt vmcnt(0)
  ds_write_b128 v190, v[72:75] offset:1024
  v_cmp_eq_u32 s[98:99], -1, v72
  s_or_b64 vcc, s[22:23], s[98:99]
  s_cbranch_scc1 mr_83
mo_87:
  s_barrier
  ds_read_b128 v[48:51], v4 offset:0
  ds_read_b128 v[52:55], v4 offset:1024
  v_smfmac_f32_16x16x64_bf16 v[92:95], v[68:71], v[216:223], v22
  ds_read_b128 v[56:59], v4 offset:2048
  v_smfmac_f32_16x16x64_bf16 v[88:91], v[68:71], a[200:207], v22
  ds_read_b128 v[60:63], v4 offset:3072
  v_smfmac_f32_16x16x64_bf16 v[92:95], v[72:75], v[224:231], v22
  ds_read_b128 v[64:67], v4 offset:4096
  v_smfmac_f32_16x16x64_bf16 v[88:91], v[72:75], a[208:215], v22
  s_waitcnt lgkmcnt(4)
  ds_read_b128 v[76:79], v4 offset:7168
  v_smfmac_f32_16x16x64_bf16 v[92:95], v[48:51], a[240:247], v22
  ds_read_b128 v[80:83], v4 offset:8192
  v_smfmac_f32_16x16x64_bf16 v[88:91], v[48:51], a[160:167], v22
  s_waitcnt lgkmcnt(5)
  ds_read_b128 v[84:87], v4 offset:9216
  v_smfmac_f32_16x16x64_bf16 v[92:95], v[52:55], a[248:255], v22
  v_smfmac_f32_16x16x64_bf16 v[88:91], v[52:55], a[168:175], v22
  s_waitcnt lgkmcnt(5)
  v_smfmac_f32_16x16x64_bf16 v[92:95], v[56:59], v[192:199], v22
  s_waitcnt lgkmcnt(4)
  v_smfmac_f32_16x16x64_bf16 v[92:95], v[60:63], v[200:207], v22
  s_waitcnt lgkmcnt(3)
  v_smfmac_f32_16x16x64_bf16 v[92:95], v[64:67], v[208:215], v22
  s_waitcnt lgkmcnt(2)
  v_smfmac_f32_16x16x64_bf16 v[92:95], v[76:79], v[232:239], v22
  s_waitcnt lgkmcnt(1)
  v_smfmac_f32_16x16x64_bf16 v[92:95], v[80:83], v[240:247], v22
  s_waitcnt lgkmcnt(0)
  v_smfmac_f32_16x16x64_bf16 v[92:95], v[84:87], v[248:255], v22
  v_smfmac_f32_16x16x64_bf16 v[88:91], v[56:59], a[176:183], v22
  v_smfmac_f32_16x16x64_bf16 v[88:91], v[60:63], a[184:191], v22
  v_smfmac_f32_16x16x64_bf16 v[88:91], v[64:67], a[192:199], v22
  v_permlane32_swap_b32 v92, v93
  v_smfmac_f32_16x16x64_bf16 v[88:91], v[76:79], a[216:223], v22
  v_permlane32_swap_b32 v94, v95
  v_smfmac_f32_16x16x64_bf16 v[88:91], v[80:83], a[224:231], v22
  v_permlane32_swap_b32 v93, v92
  v_smfmac_f32_16x16x64_bf16 v[88:91], v[84:87], a[232:239], v22
  v_permlane32_swap_b32 v95, v94
  v_pk_mul_f32 v[120:121], v[92:93], v[24:25] op_sel:[1,0] op_sel_hi:[0,1]
  v_pk_mul_f32 v[122:123], v[94:95], v[24:25] op_sel:[1,0] op_sel_hi:[0,1]
  s_nop 4
  v_pk_fma_f32 v[88:89], v[88:89], v[24:25], v[120:121]
  v_pk_fma_f32 v[90:91], v[90:91], v[24:25], v[122:123]
  v_cvt_pk_bf16_f32 v120, v88, v89
  v_cvt_pk_bf16_f32 v121, v90, v91
  ds_write_b64 v6, v[120:121]
  s_barrier
  ds_read_b64_tr_b16 v[104:105], v7 offset:0
  ds_read_b64_tr_b16 v[106:107], v7 offset:768
  ds_read_b64_tr_b16 v[108:109], v7 offset:1536
  s_waitcnt lgkmcnt(1)
  v_mfma_f32_16x16x32_bf16 v[120:123], v[104:107], v[104:107], 0
  s_waitcnt lgkmcnt(0)
  v_mfma_f32_16x16x32_bf16 v[120:123], v[108:111], v[108:111], v[120:123]
  s_mov_b64 exec, s[64:65]
  s_nop 6
  v_cmpx_o_f32 vcc, v120, v121
  v_cvt_pk_f16_f32 v120, v120, v121
  buffer_store_dword v120, v8, s[8:11], s56 offen
  v_cmpx_o_f32 vcc, v122, v123
  v_cvt_pk_f16_f32 v121, v122, v123
  buffer_store_dword v121, v8, s[8:11], s56 offen offset:128
  s_xor_b64 s[98:99], exec, s[64:65]
  s_mov_b64 exec, -1
  s_waitcnt lgkmcnt(0)
  s_barrier
  ds_read_b64_tr_b16 v[104:105], v7 offset:0
  ds_read_b64_tr_b16 v[106:107], v7 offset:768
  ds_read_b64_tr_b16 v[108:109], v7 offset:1536
  ds_read_b32 v27, v12 offset:12544
  ds_read_b64 v[140:141], v11
  s_waitcnt lgkmcnt(1)
  v_cmp_u_f32 vcc, v104, v106
  v_cmp_u_f32 s[22:23], v108, v27
  s_nop 1
  s_or_b64 vcc, vcc, s[22:23]
  s_cbranch_vccnz mn_84
mk_85:
  s_cmp_eq_u32 s52, 63
  s_cbranch_scc1 last_86
  s_cmp_lg_u64 s[98:99], 0
  s_cbranch_scc1 sf_88
sf_89:
  s_nop 15
  s_nop 10
  v_smfmac_f32_16x16x64_bf16 v[96:99], v[48:51], a[0:7], v22
  v_smfmac_f32_16x16x64_bf16 v[100:103], v[48:51], a[80:87], v22
  v_smfmac_f32_16x16x64_bf16 v[96:99], v[52:55], a[8:15], v22
  v_smfmac_f32_16x16x64_bf16 v[100:103], v[52:55], a[88:95], v22
  v_smfmac_f32_16x16x64_bf16 v[96:99], v[56:59], a[16:23], v22
  v_smfmac_f32_16x16x64_bf16 v[100:103], v[56:59], a[96:103], v22
  buffer_load_dwordx4 v[132:135], v10, s[8:11], s56 offen sc1
  v_smfmac_f32_16x16x64_bf16 v[96:99], v[60:63], a[24:31], v22
  buffer_load_dwordx4 v[124:127], v9, s[8:11], s56 offen sc1
  v_smfmac_f32_16x16x64_bf16 v[96:99], v[64:67], a[32:39], v22
  buffer_load_dwordx4 v[128:131], v9, s[8:11], s56 offen offset:1024 sc1
  v_smfmac_f32_16x16x64_bf16 v[96:99], v[68:71], a[40:47], v22
  v_smfmac_f32_16x16x64_bf16 v[96:99], v[72:75], a[48:55], v22
  v_smfmac_f32_16x16x64_bf16 v[96:99], v[76:79], a[56:63], v22
  v_smfmac_f32_16x16x64_bf16 v[96:99], v[80:83], a[64:71], v22
  v_smfmac_f32_16x16x64_bf16 v[96:99], v[84:87], a[72:79], v22
  v_smfmac_f32_16x16x64_bf16 v[100:103], v[60:63], a[104:111], v22
  v_smfmac_f32_16x16x64_bf16 v[100:103], v[64:67], a[112:119], v22
  v_smfmac_f32_16x16x64_bf16 v[100:103], v[68:71], a[120:127], v22
  v_smfmac_f32_16x16x64_bf16 v[100:103], v[72:75], a[128:135], v22
  v_cvt_pk_bf16_f32 v136, v96, v97
  v_smfmac_f32_16x16x64_bf16 v[100:103], v[76:79], a[136:143], v22
  v_cvt_pk_bf16_f32 v137, v98, v99
  v_smfmac_f32_16x16x64_bf16 v[100:103], v[80:83], a[144:151], v22
  v_smfmac_f32_16x16x64_bf16 v[100:103], v[84:87], a[152:159], v22
  s_nop 7
  v_cvt_pk_bf16_f32 v138, v100, v101
  v_cvt_pk_bf16_f32 v139, v102, v103
  s_waitcnt vmcnt(2) lgkmcnt(0)
  v_pk_add_f16 v164, v132, v133
  v_pk_add_f16 v165, v134, v135
  v_fma_mix_f32 v170, v164, 1.0, v165 op_sel:[0,0,0] op_sel_hi:[1,0,1]
  v_fma_mix_f32 v171, v164, 1.0, v165 op_sel:[1,0,1] op_sel_hi:[1,0,1]
  v_exp_f32 v176, v170
  v_exp_f32 v177, v171
  s_waitcnt vmcnt(1)
  v_cvt_pk_bf16_f32 v160, v176, v177
  v_pk_add_f16 v120, v124, v126
  v_pk_add_f16 v121, v125, v127
  v_mov_b32_dpp v161, v160 row_ror:8 row_mask:0xf bank_mask:0xf
  s_waitcnt vmcnt(0)
  v_pk_add_f16 v122, v128, v130
  v_mfma_f32_16x16x32_bf16 v[178:181], v[140:143], v[160:163], 0
  v_fma_mix_f32 v166, v120, 1.0, v122 op_sel:[0,0,0] op_sel_hi:[1,0,1]
  v_fma_mix_f32 v167, v120, 1.0, v122 op_sel:[1,0,1] op_sel_hi:[1,0,1]
  v_cmp_u_f32 vcc, v166, v170
  v_pk_add_f16 v123, v129, v131
  v_exp_f32 v172, v166
  v_mfma_f32_16x16x32_bf16 v[182:185], v[136:139], v[160:163], 0
  s_cbranch_vccnz sr_90
  v_exp_f32 v173, v167
  v_fma_mix_f32 v168, v121, 1.0, v123 op_sel:[0,0,0] op_sel_hi:[1,0,1]
  v_fma_mix_f32 v169, v121, 1.0, v123 op_sel:[1,0,1] op_sel_hi:[1,0,1]
  v_cvt_pk_bf16_f32 v156, v172, v173
  v_exp_f32 v174, v168
  v_exp_f32 v175, v169
  v_mov_b32_dpp v158, v156 row_ror:8 row_mask:0xf bank_mask:0xf
  v_cvt_pk_bf16_f32 v157, v174, v175
  v_mfma_f32_16x16x32_bf16 v[186:189], v[138:141], v[160:163], 0
  s_nop 0
  v_mov_b32_dpp v159, v157 row_ror:8 row_mask:0xf bank_mask:0xf
  s_nop 1
pv_91:
  v_mfma_f32_16x16x32_bf16 v[178:181], v[152:155], v[156:159], v[178:181]
  v_mfma_f32_16x16x32_bf16 v[182:185], v[144:147], v[156:159], v[182:185]
  v_mfma_f32_16x16x32_bf16 v[186:189], v[148:151], v[156:159], v[186:189]
  s_mov_b64 exec, s[62:63]
  s_nop 0
  v_rcp_f32 v164, v180
  v_cmp_ngt_f32 s[22:23], s80, v180
  v_cmp_ngt_f32 vcc, s80, v164
  v_pk_mul_f32 v[182:183], v[182:183], v[164:165] op_sel_hi:[1,0]
  v_pk_mul_f32 v[184:185], v[184:185], v[164:165] op_sel_hi:[1,0]
  v_pk_mul_f32 v[178:179], v[178:179], v[164:165] op_sel_hi:[1,0]
  v_pk_mul_f32 v[186:187], v[186:187], v[164:165] op_sel_hi:[1,0]
  v_pk_mul_f32 v[188:189], v[188:189], v[164:165] op_sel_hi:[1,0]
  v_cvt_pk_f16_f32 v64, v178, v179
  s_or_b64 vcc, vcc, s[22:23]
  s_cbranch_scc1 fx_93
fk_94:
  ds_write_b32 v14, v64
  v_cvt_pk_f16_f32 v60, v182, v183
  v_cvt_pk_f16_f32 v61, v184, v185
  v_cvt_pk_f16_f32 v62, v186, v187
  v_cvt_pk_f16_f32 v63, v188, v189
  ds_write_b128 v13, v[60:63]
  s_barrier
  s_mov_b64 exec, -1
  s_add_u32 m0, s74, 8192
  s_add_u32 s21, s72, 0
  buffer_load_dwordx4 v32, s[16:19], s21 offen sc1 lds
  s_add_u32 m0, s74, 6144
  s_mul_i32 s21, s91, 3
  s_add_u32 s21, s21, s71
  buffer_load_dwordx4 v4, s[16:19], s21 offen sc1 lds
  s_xor_b32 s74, s74, 16384
  s_add_u32 s73, s73, 2097152
  s_xor_b32 s73, s73, 8192
  s_add_u32 s79, s79, 2097152
  s_xor_b32 s79, s79, 8192
  s_add_u32 s21, s72, 524288
  s_xor_b32 s72, s72, s21
  s_lshr_b32 s72, s72, 8
  s_and_b32 s72, s72, 8192
  s_xor_b32 s72, s72, s21
  s_add_u32 s71, s73, 4096
  s_mov_b32 s91, 1024
  s_sub_u32 s21, s73, 0
  s_cmp_lt_u32 s21, 125829120
  s_cselect_b32 s71, s71, s79
  s_cselect_b32 s91, s91, 65536
  v_permlane32_swap_b32 v96, v100
  v_permlane32_swap_b32 v97, v101
  v_permlane32_swap_b32 v98, v102
  v_permlane32_swap_b32 v99, v103
  v_pk_add_f32 v[96:97], v[96:97], v[100:101]
  v_pk_add_f32 v[98:99], v[98:99], v[102:103]
  v_cvt_pk_bf16_f32 v100, v96, v97
  v_cvt_pk_bf16_f32 v101, v98, v99
  s_nop 0
  v_permlane32_swap_b32 v100, v102
  v_permlane32_swap_b32 v101, v103
  v_min_u32 v100, -2, v100
  s_nop 6
  buffer_store_dwordx4 v[100:103], v26, s[16:19], s70 offen sc1
  s_add_u32 s70, s70, 2097152
  s_xor_b32 s70, s70, 8192
  ds_read_b128 v[144:147], v18
  ds_read_b128 v[148:151], v18 offset:1024
  ds_read_b128 v[152:155], v19
  v_xor_b32 v18, 16384, v18
  v_xor_b32 v19, 16384, v19
  v_mov_b32 v88, 0
  v_mov_b32 v89, 0
  v_mov_b32 v90, 0
  v_mov_b32 v91, 0
  v_mov_b32 v92, 0
  v_mov_b32 v93, 0
  v_mov_b32 v94, 0
  v_mov_b32 v95, 0
  v_mov_b32 v96, 0
  v_mov_b32 v97, 0
  v_mov_b32 v98, 0
  v_mov_b32 v99, 0
  v_mov_b32 v100, 0
  v_mov_b32 v101, 0
  v_mov_b32 v102, 0
  v_mov_b32 v103, 0
  s_mov_b32 s81, 0
  s_waitcnt lgkmcnt(0)
  s_barrier
  s_mov_b64 exec, s[64:65]
  buffer_store_dword v28, v8, s[8:11], s57 offen
  buffer_store_dword v28, v8, s[8:11], s57 offen offset:128
  s_mov_b64 exec, -1
  ds_write_b128 v190, v[28:31] offset:0
  ds_write_b128 v190, v[28:31] offset:1024
  ds_write_b64 v6, v[28:29]
  s_mov_b64 exec, -1
  s_cmp_eq_u32 s78, 0
  s_cbranch_scc1 nt_96
  s_mov_b64 exec, s[62:63]
  buffer_store_dword v28, v17, s[8:11], s59 offen
  s_mov_b64 exec, -1
  s_sleep 3
  s_nop 1
  buffer_load_dwordx4 v[68:71], v16, s[4:7], s60 offen sc1
  s_sleep 3
  s_nop 1
  buffer_load_dwordx4 v[72:75], v16, s[4:7], s60 offen sc1
  s_waitcnt vmcnt(1)
  v_mfma_f32_16x16x32_f16 v[120:123], v[44:47], v[68:71], 0
  v_bitop3_b32 v27, v68, s61, 1 bitop3:0x28
  v_cmp_ne_u32 vcc, 0, v27
  s_nop 1
  s_cbranch_vccnz p2_99
  s_nop 2
pg_98:
  v_add_f32_dpp v120, v120, v120 row_ror:8 row_mask:0xf bank_mask:0xf
  v_add_f32_dpp v121, v121, v121 row_ror:8 row_mask:0xf bank_mask:0xf
  s_mov_b64 exec, s[62:63]
  v_cvt_pk_bf16_f32 v120, v120, v121
  v_min_u32 v120, -2, v120
  buffer_store_dword v120, v17, s[8:11], s55 offen
  s_mov_b64 exec, -1
nt_95:
  s_barrier
  s_mov_b32 s58, s55
  s_add_u32 s52, s52, 1
  ds_write_b32 v13, v28
  ds_write_b32 v14, v28
  s_and_b32 s21, s52, 3
  s_mul_i32 s56, s21, 122880
  s_add_u32 s21, s52, 1
  s_and_b32 s21, s21, 3
  s_mul_i32 s55, s21, 122880
  s_add_u32 s55, s55, s75
  s_add_u32 s21, s52, 2
  s_and_b32 s21, s21, 3
  s_mul_i32 s57, s21, 122880
  s_add_u32 s21, s52, 3
  s_and_b32 s21, s21, 3
  s_mul_i32 s59, s21, 122880
  s_add_u32 s59, s59, s75
  s_bfe_u32 s61, s52, 0x10002
  s_and_b32 s21, s52, 3
  s_lshl_b32 s60, s21, 18
  s_mov_b32 s54, 0
  s_sleep 3
  s_waitcnt lgkmcnt(0)
  buffer_load_dwordx4 v[68:71], v190, s[8:11], s58 offen offset:0 sc1
  buffer_load_dwordx4 v[72:75], v190, s[8:11], s58 offen offset:1024 sc1
  s_branch top_82
mr_83:
  s_mov_b64 exec, s[22:23]
  s_cbranch_execz ms_100
  buffer_load_dwordx4 v[68:71], v190, s[8:11], s58 offen offset:0 sc1
ms_100:
  s_mov_b64 exec, s[98:99]
  s_cbranch_execz ms_101
  buffer_load_dwordx4 v[72:75], v190, s[8:11], s58 offen offset:1024 sc1
ms_101:
  s_add_u32 s54, s54, 1
  s_cmp_gt_u32 s54, 131072
  s_cbranch_scc1 end0
  s_waitcnt vmcnt(0)
  s_mov_b64 exec, s[22:23]
  ds_write_b128 v190, v[68:71] offset:0
  v_cmp_eq_u32 s[22:23], -1, v68
  s_mov_b64 exec, s[98:99]
  ds_write_b128 v190, v[72:75] offset:1024
  v_cmp_eq_u32 s[98:99], -1, v72
  s_mov_b64 exec, -1
  s_or_b64 vcc, s[22:23], s[98:99]
  s_cbranch_scc1 mr_83
  s_branch mo_87
sf_88:
  s_waitcnt lgkmcnt(1)
  v_mfma_f32_16x16x32_bf16 v[120:123], v[104:107], v[104:107], 0
  s_waitcnt lgkmcnt(0)
  v_mfma_f32_16x16x32_bf16 v[120:123], v[108:111], v[108:111], v[120:123]
  s_mov_b64 exec, s[64:65]
  s_nop 6
  v_cvt_pk_f16_f32 v120, v120, v121
  buffer_store_dword v120, v8, s[8:11], s56 offen
  v_cvt_pk_f16_f32 v121, v122, v123
  buffer_store_dword v121, v8, s[8:11], s56 offen offset:128
  s_mov_b64 exec, -1
  s_branch sf_89
mn_84:
  s_bitcmp1_b32 s81, 1
  s_cbranch_scc1 mk_85
  s_or_b32 s81, s81, 2
  s_nop 7
  v_mov_b32 v88, 0
  v_mov_b32 v89, 0
  v_mov_b32 v90, 0
  v_mov_b32 v91, 0
  v_mov_b32 v92, 0
  v_mov_b32 v93, 0
  v_mov_b32 v94, 0
  v_mov_b32 v95, 0
  v_mov_b32 v96, 0
  v_mov_b32 v97, 0
  v_mov_b32 v98, 0
  v_mov_b32 v99, 0
  v_mov_b32 v100, 0
  v_mov_b32 v101, 0
  v_mov_b32 v102, 0
  v_mov_b32 v103, 0
  s_cmp_eq_u32 s52, 0
  s_cbranch_scc1 mx_103
mx_102:
  buffer_load_dwordx4 v[68:71], v190, s[8:11], s58 offen offset:0 sc1
  buffer_load_dwordx4 v[72:75], v190, s[8:11], s58 offen offset:1024 sc1
  s_add_u32 s54, s54, 1
  s_cmp_gt_u32 s54, 131072
  s_cbranch_scc1 end0
  s_waitcnt vmcnt(0)
  v_max3_u32 v27, v68, v69, v70
  v_max3_u32 v27, v27, v71, v72
  v_max3_u32 v27, v27, v73, v74
  v_max3_u32 v27, v27, v75, v75
  v_cmp_eq_u32 vcc, -1, v27
  s_nop 1
  s_cbranch_vccnz mx_102
  ds_write_b128 v190, v[68:71] offset:0
  ds_write_b128 v190, v[72:75] offset:1024
mx_103:
  s_waitcnt lgkmcnt(0)
  s_branch mo_87
sr_90:
  s_mov_b32 s54, 0
sr_104:
  s_mov_b64 exec, vcc
  buffer_load_dwordx4 v[124:127], v9, s[8:11], s56 offen sc1
  buffer_load_dwordx4 v[128:131], v9, s[8:11], s56 offen offset:1024 sc1
  buffer_load_dwordx4 v[132:135], v10, s[8:11], s56 offen sc1
  s_mov_b64 exec, -1
  s_add_u32 s54, s54, 1
  s_cmp_gt_u32 s54, 131072
  s_cbranch_scc1 end0
  s_waitcnt vmcnt(0)
  v_pk_add_f16 v164, v132, v133
  v_pk_add_f16 v165, v134, v135
  v_pk_add_f16 v120, v124, v126
  v_pk_add_f16 v122, v128, v130
  v_fma_mix_f32 v170, v164, 1.0, v165 op_sel:[0,0,0] op_sel_hi:[1,0,1]
  v_fma_mix_f32 v166, v120, 1.0, v122 op_sel:[0,0,0] op_sel_hi:[1,0,1]
  v_pk_add_f16 v121, v125, v127
  v_cmp_u_f32 vcc, v166, v170
  v_pk_add_f16 v123, v129, v131
  v_fma_mix_f32 v171, v164, 1.0, v165 op_sel:[1,0,1] op_sel_hi:[1,0,1]
  v_fma_mix_f32 v167, v120, 1.0, v122 op_sel:[1,0,1] op_sel_hi:[1,0,1]
  v_fma_mix_f32 v168, v121, 1.0, v123 op_sel:[0,0,0] op_sel_hi:[1,0,1]
  v_fma_mix_f32 v169, v121, 1.0, v123 op_sel:[1,0,1] op_sel_hi:[1,0,1]
  s_cbranch_vccz ex_92
  s_and_b32 s21, s54, 31
  s_cbranch_scc1 sr_104
  v_max3_u32 v27, v124, v126, v128
  v_max3_u32 v27, v27, v130, v132
  v_max3_u32 v27, v27, v133, v134
  v_max3_u32 v27, v27, v135, v135
  v_cmp_eq_u32 vcc, -1, v27
  s_nop 1
  s_cbranch_vccnz sr_104
ex_92:
  v_exp_f32 v176, v170
  v_exp_f32 v177, v171
  v_exp_f32 v172, v166
  v_cvt_pk_bf16_f32 v160, v176, v177
  v_exp_f32 v173, v167
  v_exp_f32 v174, v168
  v_mov_b32_dpp v161, v160 row_ror:8 row_mask:0xf bank_mask:0xf
  v_cvt_pk_bf16_f32 v156, v172, v173
  v_exp_f32 v175, v169
  v_mfma_f32_16x16x32_bf16 v[178:181], v[140:143], v[160:163], 0
  v_mov_b32_dpp v158, v156 row_ror:8 row_mask:0xf bank_mask:0xf
  v_cvt_pk_bf16_f32 v157, v174, v175
  v_mfma_f32_16x16x32_bf16 v[182:185], v[136:139], v[160:163], 0
  s_nop 0
  v_mov_b32_dpp v159, v157 row_ror:8 row_mask:0xf bank_mask:0xf
  v_mfma_f32_16x16x32_bf16 v[186:189], v[138:141], v[160:163], 0
  s_branch pv_91
fx_93:
  s_bitcmp1_b32 s81, 0
  s_cbranch_scc1 fk_94
  s_or_b32 s81, s81, 1
  s_mov_b64 exec, -1
  v_max3_f32 v164, v166, v167, v168
  v_max3_f32 v165, v169, v170, v171
  v_max_f32 v164, v164, v165
  s_nop 1
  v_max_f32_dpp v164, v164, v164 row_ror:8 row_mask:0xf bank_mask:0xf
  v_mov_b32 v165, v164
  s_nop 1
  v_permlane32_swap_b32 v164, v165
  v_max_f32 v164, v164, v165
  v_mov_b32 v165, v164
  s_nop 1
  v_permlane16_swap_b32 v164, v165
  v_max_f32 v164, v164, v165
  v_sub_f32 v166, v166, v164
  v_sub_f32 v167, v167, v164
  v_sub_f32 v168, v168, v164
  v_sub_f32 v169, v169, v164
  v_sub_f32 v170, v170, v164
  v_sub_f32 v171, v171, v164
  s_branch ex_92
nt_96:
  s_branch nt_95
p2_99:
  s_mov_b32 s54, 0
  buffer_load_dwordx4 v[68:71], v16, s[4:7], s60 offen sc1
  s_waitcnt vmcnt(1)
  v_mfma_f32_16x16x32_f16 v[120:123], v[44:47], v[72:75], 0
  v_bitop3_b32 v27, v72, s61, 1 bitop3:0x28
  v_cmp_ne_u32 vcc, 0, v27
  s_nop 1
  s_cbranch_vccz pg_98
  buffer_load_dwordx4 v[72:75], v16, s[4:7], s60 offen sc1
pp_97:
  s_waitcnt vmcnt(1)
  v_mfma_f32_16x16x32_f16 v[120:123], v[44:47], v[68:71], 0
  v_bitop3_b32 v27, v68, s61, 1 bitop3:0x28
  v_cmp_ne_u32 vcc, 0, v27
  s_nop 1
  s_cbranch_vccz pg_98
  buffer_load_dwordx4 v[68:71], v16, s[4:7], s60 offen sc1
  s_waitcnt vmcnt(1)
  v_mfma_f32_16x16x32_f16 v[120:123], v[44:47], v[72:75], 0
  v_bitop3_b32 v27, v72, s61, 1 bitop3:0x28
  v_cmp_ne_u32 vcc, 0, v27
  s_nop 1
  s_cbranch_vccz pg_98
  buffer_load_dwordx4 v[72:75], v16, s[4:7], s60 offen sc1
  s_add_u32 s54, s54, 1
  s_cmp_gt_u32 s54, 131072
  s_cbranch_scc1 end0
  s_branch pp_97
last_86:
  v_smfmac_f32_16x16x64_bf16 v[96:99], v[48:51], a[0:7], v22
  v_smfmac_f32_16x16x64_bf16 v[100:103], v[48:51], a[80:87], v22
  v_smfmac_f32_16x16x64_bf16 v[96:99], v[52:55], a[8:15], v22
  v_smfmac_f32_16x16x64_bf16 v[100:103], v[52:55], a[88:95], v22
  v_smfmac_f32_16x16x64_bf16 v[96:99], v[56:59], a[16:23], v22
  v_smfmac_f32_16x16x64_bf16 v[100:103], v[56:59], a[96:103], v22
  v_smfmac_f32_16x16x64_bf16 v[96:99], v[60:63], a[24:31], v22
  v_smfmac_f32_16x16x64_bf16 v[96:99], v[64:67], a[32:39], v22
  v_smfmac_f32_16x16x64_bf16 v[96:99], v[68:71], a[40:47], v22
  v_smfmac_f32_16x16x64_bf16 v[96:99], v[72:75], a[48:55], v22
  v_smfmac_f32_16x16x64_bf16 v[96:99], v[76:79], a[56:63], v22
  v_smfmac_f32_16x16x64_bf16 v[96:99], v[80:83], a[64:71], v22
  v_smfmac_f32_16x16x64_bf16 v[96:99], v[84:87], a[72:79], v22
  v_smfmac_f32_16x16x64_bf16 v[100:103], v[60:63], a[104:111], v22
  v_smfmac_f32_16x16x64_bf16 v[100:103], v[64:67], a[112:119], v22
  v_smfmac_f32_16x16x64_bf16 v[100:103], v[68:71], a[120:127], v22
  v_smfmac_f32_16x16x64_bf16 v[100:103], v[72:75], a[128:135], v22
  v_smfmac_f32_16x16x64_bf16 v[100:103], v[76:79], a[136:143], v22
  v_smfmac_f32_16x16x64_bf16 v[100:103], v[80:83], a[144:151], v22
  v_smfmac_f32_16x16x64_bf16 v[100:103], v[84:87], a[152:159], v22
  s_nop 7
  v_permlane32_swap_b32 v96, v100
  v_permlane32_swap_b32 v97, v101
  v_permlane32_swap_b32 v98, v102
  v_permlane32_swap_b32 v99, v103
  v_pk_add_f32 v[96:97], v[96:97], v[100:101]
  v_pk_add_f32 v[98:99], v[98:99], v[102:103]
  v_cvt_pk_bf16_f32 v100, v96, v97
  v_cvt_pk_bf16_f32 v101, v98, v99
  s_nop 0
  v_permlane32_swap_b32 v100, v102
  v_permlane32_swap_b32 v101, v103
  v_min_u32 v100, -2, v100
  buffer_store_dwordx4 v[100:103], v26, s[16:19], s70 offen sc1
  s_waitcnt vmcnt(0)
  s_barrier
  s_branch chain_done
E_32:
  v_add_u32 v190, 7168, v4
  ds_write_b32 v13, v28
  ds_write_b32 v14, v28
  s_waitcnt vmcnt(0)
  ds_write_b128 v190, v[76:79] offset:0
  ds_write_b128 v190, v[80:83] offset:1024
  ds_write_b128 v190, v[84:87] offset:2048
  s_waitcnt lgkmcnt(0)
  s_branch mo_111
  .p2align 3
top_106:
  s_waitcnt vmcnt(2)
  ds_write_b128 v190, v[76:79] offset:0
  v_cmp_eq_u32 s[22:23], -1, v76
  s_waitcnt vmcnt(1)
  ds_write_b128 v190, v[80:83] offset:1024
  v_cmp_eq_u32 s[98:99], -1, v80
  s_waitcnt vmcnt(0)
  ds_write_b128 v190, v[84:87] offset:2048
  v_cmp_eq_u32 s[100:101], -1, v84
  s_or_b64 vcc, s[22:23], s[98:99]
  s_or_b64 vcc, vcc, s[100:101]
  s_cbranch_scc1 mr_107
mo_111:
  s_barrier
  ds_read_b128 v[48:51], v4 offset:0
  ds_read_b128 v[52:55], v4 offset:1024
  v_smfmac_f32_16x16x64_bf16 v[92:95], v[76:79], v[232:239], v22
  ds_read_b128 v[56:59], v4 offset:2048
  ds_read_b128 v[60:63], v4 offset:3072
  v_smfmac_f32_16x16x64_bf16 v[88:91], v[76:79], a[216:223], v22
  s_add_u32 m0, s74, 0
  s_add_u32 s21, s79, 0
  buffer_load_dwordx4 v4, s[16:19], s21 offen offset:1024 sc1 lds
  v_smfmac_f32_16x16x64_bf16 v[92:95], v[80:83], v[240:247], v22
  ds_read_b128 v[64:67], v4 offset:4096
  ds_read_b128 v[68:71], v4 offset:5120
  s_add_u32 s22, s52, 3
  s_min_u32 s22, s22, 64
  v_smfmac_f32_16x16x64_bf16 v[88:91], v[80:83], a[224:231], v22
  s_add_u32 m0, s74, 2048
  s_add_u32 s21, s79, 65536
  buffer_load_dwordx4 v4, s[16:19], s21 offen offset:1024 sc1 lds
  v_cmp_gt_u32 vcc, s22, v42
  v_smfmac_f32_16x16x64_bf16 v[92:95], v[84:87], v[248:255], v22
  ds_read_b128 v[72:75], v4 offset:6144
  s_cbranch_vccnz kw_112
kv_113:
  v_smfmac_f32_16x16x64_bf16 v[88:91], v[84:87], a[232:239], v22
  s_waitcnt lgkmcnt(6)
  s_add_u32 m0, s74, 10240
  s_nop 0
  buffer_load_dwordx4 v4, s[16:19], s73 offen offset:0 sc1 lds
  v_smfmac_f32_16x16x64_bf16 v[92:95], v[48:51], a[240:247], v22
  v_smfmac_f32_16x16x64_bf16 v[88:91], v[48:51], a[160:167], v22
  s_waitcnt lgkmcnt(5)
  s_add_u32 m0, s74, 10240
  s_nop 0
  buffer_load_dwordx4 v4, s[16:19], s73 offen offset:1024 sc1 lds
  v_smfmac_f32_16x16x64_bf16 v[92:95], v[52:55], a[248:255], v22
  s_waitcnt lgkmcnt(4)
  v_smfmac_f32_16x16x64_bf16 v[92:95], v[56:59], v[192:199], v22
  s_waitcnt lgkmcnt(3)
  s_add_u32 m0, s74, 10240
  s_nop 0
  buffer_load_dwordx4 v4, s[16:19], s73 offen offset:2048 sc1 lds
  v_smfmac_f32_16x16x64_bf16 v[92:95], v[60:63], v[200:207], v22
  s_waitcnt lgkmcnt(2)
  v_smfmac_f32_16x16x64_bf16 v[92:95], v[64:67], v[208:215], v22
  s_waitcnt lgkmcnt(1)
  s_add_u32 m0, s74, 0
  s_mul_i32 s21, s91, 0
  s_add_u32 s21, s21, s71
  buffer_load_dwordx4 v4, s[16:19], s21 offen sc1 lds
  v_smfmac_f32_16x16x64_bf16 v[92:95], v[68:71], v[216:223], v22
  s_waitcnt lgkmcnt(0)
  v_smfmac_f32_16x16x64_bf16 v[92:95], v[72:75], v[224:231], v22
  s_add_u32 m0, s74, 2048
  s_mul_i32 s21, s91, 1
  s_add_u32 s21, s21, s71
  buffer_load_dwordx4 v4, s[16:19], s21 offen sc1 lds
  v_smfmac_f32_16x16x64_bf16 v[88:91], v[52:55], a[168:175], v22
  v_smfmac_f32_16x16x64_bf16 v[88:91], v[56:59], a[176:183], v22
  v_smfmac_f32_16x16x64_bf16 v[88:91], v[60:63], a[184:191], v22
  v_cvt_pk_bf16_f32 v122, v92, v93
  v_smfmac_f32_16x16x64_bf16 v[88:91], v[64:67], a[192:199], v22
  v_cvt_pk_bf16_f32 v123, v94, v95
  s_barrier
  v_smfmac_f32_16x16x64_bf16 v[88:91], v[68:71], a[200:207], v22
  ds_write_b64 v12, v[122:123] offset:13056
  v_smfmac_f32_16x16x64_bf16 v[88:91], v[72:75], a[208:215], v22
  v_smfmac_f32_16x16x64_bf16 v[96:99], v[48:51], a[0:7], v22
  v_smfmac_f32_16x16x64_bf16 v[100:103], v[48:51], a[80:87], v22
  v_smfmac_f32_16x16x64_bf16 v[96:99], v[52:55], a[8:15], v22
  v_cvt_pk_bf16_f32 v120, v88, v89
  v_cvt_pk_bf16_f32 v121, v90, v91
  ds_write_b64 v12, v[120:121] offset:12544
  v_smfmac_f32_16x16x64_bf16 v[100:103], v[52:55], a[88:95], v22
  s_waitcnt lgkmcnt(0)
  s_barrier
  ds_read_b64_tr_b16 v[104:105], v7 offset:0
  ds_read_b64_tr_b16 v[106:107], v7 offset:768
  ds_read_b64_tr_b16 v[108:109], v7 offset:1536
  ds_read_b32 v27, v12 offset:12544
  ds_read_b64 v[140:141], v11
  s_waitcnt lgkmcnt(1)
  v_cmp_u_f32 vcc, v104, v106
  v_cmp_u_f32 s[22:23], v108, v27
  s_nop 1
  s_or_b64 vcc, vcc, s[22:23]
  s_cbranch_vccnz mn_108
mk_109:
  s_cmp_eq_u32 s52, 63
  s_cbranch_scc1 last_110
  v_permlane32_swap_b32 v88, v92
  v_permlane32_swap_b32 v89, v93
  v_permlane32_swap_b32 v90, v94
  v_permlane32_swap_b32 v91, v95
  v_pk_add_f32 v[88:89], v[88:89], v[92:93]
  v_pk_add_f32 v[90:91], v[90:91], v[94:95]
  v_cvt_pk_bf16_f32 v92, v88, v89
  v_cvt_pk_bf16_f32 v93, v90, v91
  v_min_u32 v92, -2, v92
  s_nop 0
  v_smfmac_f32_16x16x64_bf16 v[96:99], v[56:59], a[16:23], v22
  v_smfmac_f32_16x16x64_bf16 v[100:103], v[56:59], a[96:103], v22
  v_smfmac_f32_16x16x64_bf16 v[96:99], v[60:63], a[24:31], v22
  v_smfmac_f32_16x16x64_bf16 v[96:99], v[64:67], a[32:39], v22
  v_smfmac_f32_16x16x64_bf16 v[96:99], v[68:71], a[40:47], v22
  v_smfmac_f32_16x16x64_bf16 v[96:99], v[72:75], a[48:55], v22
  v_smfmac_f32_16x16x64_bf16 v[96:99], v[76:79], a[56:63], v22
  v_smfmac_f32_16x16x64_bf16 v[96:99], v[80:83], a[64:71], v22
  v_smfmac_f32_16x16x64_bf16 v[96:99], v[84:87], a[72:79], v22
  v_smfmac_f32_16x16x64_bf16 v[100:103], v[60:63], a[104:111], v22
  buffer_load_dwordx4 v[132:135], v10, s[8:11], s56 offen sc1
  v_smfmac_f32_16x16x64_bf16 v[100:103], v[64:67], a[112:119], v22
  buffer_load_dwordx4 v[124:127], v9, s[8:11], s56 offen sc1
  v_smfmac_f32_16x16x64_bf16 v[100:103], v[68:71], a[120:127], v22
  buffer_load_dwordx4 v[128:131], v9, s[8:11], s56 offen offset:1024 sc1
  v_smfmac_f32_16x16x64_bf16 v[100:103], v[72:75], a[128:135], v22
  v_cvt_pk_bf16_f32 v136, v96, v97
  v_smfmac_f32_16x16x64_bf16 v[100:103], v[76:79], a[136:143], v22
  v_cvt_pk_bf16_f32 v137, v98, v99
  v_smfmac_f32_16x16x64_bf16 v[100:103], v[80:83], a[144:151], v22
  v_smfmac_f32_16x16x64_bf16 v[100:103], v[84:87], a[152:159], v22
  s_nop 7
  v_cvt_pk_bf16_f32 v138, v100, v101
  v_cvt_pk_bf16_f32 v139, v102, v103
  v_permlane32_swap_b32 v96, v100
  v_permlane32_swap_b32 v97, v101
  v_permlane32_swap_b32 v98, v102
  v_permlane32_swap_b32 v99, v103
  v_pk_add_f32 v[96:97], v[96:97], v[100:101]
  v_pk_add_f32 v[98:99], v[98:99], v[102:103]
  v_cvt_pk_bf16_f32 v100, v96, v97
  v_cvt_pk_bf16_f32 v101, v98, v99
  s_nop 0
  v_permlane32_swap_b32 v100, v102
  v_permlane32_swap_b32 v101, v103
  v_min_u32 v100, -2, v100
  s_waitcnt vmcnt(2) lgkmcnt(0)
  v_pk_add_f16 v164, v132, v133
  v_pk_add_f16 v165, v134, v135
  v_fma_mix_f32 v170, v164, 1.0, v165 op_sel:[0,0,0] op_sel_hi:[1,0,1]
  v_fma_mix_f32 v171, v164, 1.0, v165 op_sel:[1,0,1] op_sel_hi:[1,0,1]
  v_exp_f32 v176, v170
  v_exp_f32 v177, v171
  s_waitcnt vmcnt(1)
  v_cvt_pk_bf16_f32 v160, v176, v177
  v_pk_add_f16 v120, v124, v126
  v_pk_add_f16 v121, v125, v127
  v_mov_b32_dpp v161, v160 row_ror:8 row_mask:0xf bank_mask:0xf
  s_waitcnt vmcnt(0)
  v_pk_add_f16 v122, v128, v130
  v_mfma_f32_16x16x32_bf16 v[178:181], v[140:143], v[160:163], 0
  v_fma_mix_f32 v166, v120, 1.0, v122 op_sel:[0,0,0] op_sel_hi:[1,0,1]
  v_fma_mix_f32 v167, v120, 1.0, v122 op_sel:[1,0,1] op_sel_hi:[1,0,1]
  v_cmp_u_f32 vcc, v166, v170
  v_pk_add_f16 v123, v129, v131
  v_exp_f32 v172, v166
  v_mfma_f32_16x16x32_bf16 v[182:185], v[136:139], v[160:163], 0
  s_cbranch_vccnz sr_116
  v_exp_f32 v173, v167
  v_fma_mix_f32 v168, v121, 1.0, v123 op_sel:[0,0,0] op_sel_hi:[1,0,1]
  v_fma_mix_f32 v169, v121, 1.0, v123 op_sel:[1,0,1] op_sel_hi:[1,0,1]
  v_cvt_pk_bf16_f32 v156, v172, v173
  v_exp_f32 v174, v168
  v_exp_f32 v175, v169
  v_mov_b32_dpp v158, v156 row_ror:8 row_mask:0xf bank_mask:0xf
  v_cvt_pk_bf16_f32 v157, v174, v175
  v_mfma_f32_16x16x32_bf16 v[186:189], v[138:141], v[160:163], 0
  s_nop 0
  v_mov_b32_dpp v159, v157 row_ror:8 row_mask:0xf bank_mask:0xf
  s_nop 1
pv_117:
  v_mfma_f32_16x16x32_bf16 v[178:181], v[152:155], v[156:159], v[178:181]
  v_mfma_f32_16x16x32_bf16 v[182:185], v[144:147], v[156:159], v[182:185]
  v_mfma_f32_16x16x32_bf16 v[186:189], v[148:151], v[156:159], v[186:189]
  s_mov_b64 exec, s[62:63]
  s_nop 0
  v_rcp_f32 v164, v180
  v_cmp_ngt_f32 s[22:23], s80, v180
  v_cmp_ngt_f32 vcc, s80, v164
  v_pk_mul_f32 v[182:183], v[182:183], v[164:165] op_sel_hi:[1,0]
  v_pk_mul_f32 v[184:185], v[184:185], v[164:165] op_sel_hi:[1,0]
  v_pk_mul_f32 v[178:179], v[178:179], v[164:165] op_sel_hi:[1,0]
  v_pk_mul_f32 v[186:187], v[186:187], v[164:165] op_sel_hi:[1,0]
  v_pk_mul_f32 v[188:189], v[188:189], v[164:165] op_sel_hi:[1,0]
  v_cvt_pk_f16_f32 v64, v178, v179
  s_or_b64 vcc, vcc, s[22:23]
  s_cbranch_scc1 fx_119
fk_120:
  ds_write_b32 v14, v64
  v_cvt_pk_f16_f32 v60, v182, v183
  v_cvt_pk_f16_f32 v61, v184, v185
  v_cvt_pk_f16_f32 v62, v186, v187
  v_cvt_pk_f16_f32 v63, v188, v189
  ds_write_b128 v13, v[60:63]
  s_mov_b64 exec, s[66:67]
  s_barrier
  ds_read_b128 v[166:169], v4 offset:13824
  ds_read_b128 v[170:173], v4 offset:14464
  ds_read_b128 v[174:177], v4 offset:15104
  ds_read_b128 v[178:181], v4 offset:15744
  s_waitcnt lgkmcnt(2)
  v_pk_add_f16 v166, v166, v170
  v_pk_add_f16 v167, v167, v171
  v_pk_add_f16 v168, v168, v172
  v_pk_add_f16 v169, v169, v173
  s_waitcnt lgkmcnt(1)
  v_pk_add_f16 v166, v166, v174
  v_pk_add_f16 v167, v167, v175
  v_pk_add_f16 v168, v168, v176
  v_pk_add_f16 v169, v169, v177
  s_waitcnt lgkmcnt(0)
  v_pk_add_f16 v166, v166, v178
  v_cmpx_o_f16 vcc, v166, v166
  v_pk_add_f16 v167, v167, v179
  v_pk_add_f16 v168, v168, v180
  v_pk_add_f16 v169, v169, v181
  v_and_or_b32 v166, v166, -2, s61
  buffer_store_dwordx4 v[166:169], v15, s[4:7], s60 offen sc1
  s_xor_b64 s[98:99], exec, s[66:67]
  s_mov_b64 exec, -1
  buffer_store_dwordx4 v[100:103], v26, s[16:19], s70 offen sc1
  buffer_store_dwordx2 v[92:93], v43, s[16:19], s70 offen sc1
  s_add_u32 s70, s70, 2097152
  s_xor_b32 s70, s70, 8192
  ds_read_b128 v[144:147], v18
  ds_read_b128 v[148:151], v18 offset:1024
  ds_read_b128 v[152:155], v19
  v_xor_b32 v18, 16384, v18
  v_xor_b32 v19, 16384, v19
  v_mov_b32 v88, 0
  v_mov_b32 v89, 0
  v_mov_b32 v90, 0
  v_mov_b32 v91, 0
  v_mov_b32 v92, 0
  v_mov_b32 v93, 0
  v_mov_b32 v94, 0
  v_mov_b32 v95, 0
  v_mov_b32 v96, 0
  v_mov_b32 v97, 0
  v_mov_b32 v98, 0
  v_mov_b32 v99, 0
  v_mov_b32 v100, 0
  v_mov_b32 v101, 0
  v_mov_b32 v102, 0
  v_mov_b32 v103, 0
  s_mov_b32 s81, 0
  s_waitcnt lgkmcnt(0)
  s_barrier
  s_cmp_lg_u64 s[98:99], 0
  s_cbranch_scc1 pf_121
pf_122:
  s_xor_b32 s74, s74, 16384
  s_add_u32 s73, s73, 2097152
  s_xor_b32 s73, s73, 8192
  s_add_u32 s79, s79, 2097152
  s_xor_b32 s79, s79, 8192
  s_add_u32 s21, s72, 524288
  s_xor_b32 s72, s72, s21
  s_lshr_b32 s72, s72, 8
  s_and_b32 s72, s72, 8192
  s_xor_b32 s72, s72, s21
  s_add_u32 s71, s73, 4096
  s_mov_b32 s91, 1024
  s_sub_u32 s21, s73, 0
  s_cmp_lt_u32 s21, 125829120
  s_cselect_b32 s71, s71, s79
  s_cselect_b32 s91, s91, 65536
  v_mov_b32 v166, s52
  s_and_b32 s21, s52, 3
  s_cmp_lt_u32 s52, 54
  s_cselect_b32 s21, s21, 0
  s_cmp_lg_u32 s21, 0
  s_cbranch_scc1 fs_124
  s_mov_b64 exec, 1
  buffer_store_dword v166, v23, s[12:15], s77 offen sc1
  s_mov_b64 exec, -1
fs_124:
  s_add_u32 s22, s52, 5
  s_min_u32 s22, s22, 64
  v_cmp_gt_u32 vcc, s22, v42
  s_cbranch_vccz fv_125
  buffer_load_dword v42, v41, s[12:15], s76 offen sc1
fv_125:
  ds_write_b128 v190, v[28:31] offset:0
  ds_write_b128 v190, v[28:31] offset:1024
  ds_write_b128 v190, v[28:31] offset:2048
nt_123:
  s_barrier
  s_mov_b32 s58, s55
  s_add_u32 s52, s52, 1
  ds_write_b32 v13, v28
  ds_write_b32 v14, v28
  s_and_b32 s21, s52, 3
  s_mul_i32 s56, s21, 122880
  s_add_u32 s21, s52, 1
  s_and_b32 s21, s21, 3
  s_mul_i32 s55, s21, 122880
  s_add_u32 s55, s55, s75
  s_add_u32 s21, s52, 2
  s_and_b32 s21, s21, 3
  s_mul_i32 s57, s21, 122880
  s_add_u32 s21, s52, 3
  s_and_b32 s21, s21, 3
  s_mul_i32 s59, s21, 122880
  s_add_u32 s59, s59, s75
  s_bfe_u32 s61, s52, 0x10002
  s_and_b32 s21, s52, 3
  s_lshl_b32 s60, s21, 18
  s_mov_b32 s54, 0
  s_sleep 3
  s_waitcnt lgkmcnt(0)
  buffer_load_dwordx4 v[76:79], v190, s[8:11], s58 offen offset:0 sc1
  buffer_load_dwordx4 v[80:83], v190, s[8:11], s58 offen offset:1024 sc1
  buffer_load_dwordx4 v[84:87], v190, s[8:11], s58 offen offset:2048 sc1
  s_branch top_106
mr_107:
  s_mov_b64 exec, s[22:23]
  s_cbranch_execz ms_126
  buffer_load_dwordx4 v[76:79], v190, s[8:11], s58 offen offset:0 sc1
ms_126:
  s_mov_b64 exec, s[98:99]
  s_cbranch_execz ms_127
  buffer_load_dwordx4 v[80:83], v190, s[8:11], s58 offen offset:1024 sc1
ms_127:
  s_mov_b64 exec, s[100:101]
  s_cbranch_execz ms_128
  buffer_load_dwordx4 v[84:87], v190, s[8:11], s58 offen offset:2048 sc1
ms_128:
  s_add_u32 s54, s54, 1
  s_cmp_gt_u32 s54, 131072
  s_cbranch_scc1 end0
  s_waitcnt vmcnt(0)
  s_mov_b64 exec, s[22:23]
  ds_write_b128 v190, v[76:79] offset:0
  v_cmp_eq_u32 s[22:23], -1, v76
  s_mov_b64 exec, s[98:99]
  ds_write_b128 v190, v[80:83] offset:1024
  v_cmp_eq_u32 s[98:99], -1, v80
  s_mov_b64 exec, s[100:101]
  ds_write_b128 v190, v[84:87] offset:2048
  v_cmp_eq_u32 s[100:101], -1, v84
  s_mov_b64 exec, -1
  s_or_b64 vcc, s[22:23], s[98:99]
  s_or_b64 vcc, vcc, s[100:101]
  s_cbranch_scc1 mr_107
  s_branch mo_111
kw_112:
  s_mov_b32 s101, 0
wm_129:
  buffer_load_dword v42, v41, s[12:15], s76 offen sc1
  s_add_u32 s101, s101, 1
  s_cmp_gt_u32 s101, 131072
  s_cbranch_scc1 end0
  s_waitcnt vmcnt(0)
  v_cmp_gt_u32 vcc, s22, v42
  v_readfirstlane_b32 s100, v42
  s_nop 0
  s_cbranch_vccz wm_130
  s_sleep 1
  s_branch wm_129
wm_130:
  s_branch kv_113
mn_108:
  s_bitcmp1_b32 s81, 1
  s_cbranch_scc1 mk_109
  s_or_b32 s81, s81, 2
  s_nop 7
  v_mov_b32 v88, 0
  v_mov_b32 v89, 0
  v_mov_b32 v90, 0
  v_mov_b32 v91, 0
  v_mov_b32 v92, 0
  v_mov_b32 v93, 0
  v_mov_b32 v94, 0
  v_mov_b32 v95, 0
  v_mov_b32 v96, 0
  v_mov_b32 v97, 0
  v_mov_b32 v98, 0
  v_mov_b32 v99, 0
  v_mov_b32 v100, 0
  v_mov_b32 v101, 0
  v_mov_b32 v102, 0
  v_mov_b32 v103, 0
  s_cmp_eq_u32 s52, 0
  s_cbranch_scc1 mx_132
mx_131:
  buffer_load_dwordx4 v[76:79], v190, s[8:11], s58 offen offset:0 sc1
  buffer_load_dwordx4 v[80:83], v190, s[8:11], s58 offen offset:1024 sc1
  buffer_load_dwordx4 v[84:87], v190, s[8:11], s58 offen offset:2048 sc1
  s_add_u32 s54, s54, 1
  s_cmp_gt_u32 s54, 131072
  s_cbranch_scc1 end0
  s_waitcnt vmcnt(0)
  v_max3_u32 v27, v76, v77, v78
  v_max3_u32 v27, v27, v79, v80
  v_max3_u32 v27, v27, v81, v82
  v_max3_u32 v27, v27, v83, v84
  v_max3_u32 v27, v27, v85, v86
  v_max3_u32 v27, v27, v87, v87
  v_cmp_eq_u32 vcc, -1, v27
  s_nop 1
  s_cbranch_vccnz mx_131
  ds_write_b128 v190, v[76:79] offset:0
  ds_write_b128 v190, v[80:83] offset:1024
  ds_write_b128 v190, v[84:87] offset:2048
mx_132:
  s_waitcnt lgkmcnt(0)
  s_branch mo_111
sr_116:
  s_mov_b32 s54, 0
sr_133:
  s_mov_b64 exec, vcc
  buffer_load_dwordx4 v[124:127], v9, s[8:11], s56 offen sc1
  buffer_load_dwordx4 v[128:131], v9, s[8:11], s56 offen offset:1024 sc1
  buffer_load_dwordx4 v[132:135], v10, s[8:11], s56 offen sc1
  s_mov_b64 exec, -1
  s_add_u32 s54, s54, 1
  s_cmp_gt_u32 s54, 131072
  s_cbranch_scc1 end0
  s_waitcnt vmcnt(0)
  v_pk_add_f16 v164, v132, v133
  v_pk_add_f16 v165, v134, v135
  v_pk_add_f16 v120, v124, v126
  v_pk_add_f16 v122, v128, v130
  v_fma_mix_f32 v170, v164, 1.0, v165 op_sel:[0,0,0] op_sel_hi:[1,0,1]
  v_fma_mix_f32 v166, v120, 1.0, v122 op_sel:[0,0,0] op_sel_hi:[1,0,1]
  v_pk_add_f16 v121, v125, v127
  v_cmp_u_f32 vcc, v166, v170
  v_pk_add_f16 v123, v129, v131
  v_fma_mix_f32 v171, v164, 1.0, v165 op_sel:[1,0,1] op_sel_hi:[1,0,1]
  v_fma_mix_f32 v167, v120, 1.0, v122 op_sel:[1,0,1] op_sel_hi:[1,0,1]
  v_fma_mix_f32 v168, v121, 1.0, v123 op_sel:[0,0,0] op_sel_hi:[1,0,1]
  v_fma_mix_f32 v169, v121, 1.0, v123 op_sel:[1,0,1] op_sel_hi:[1,0,1]
  s_cbranch_vccz ex_118
  s_and_b32 s21, s54, 31
  s_cbranch_scc1 sr_133
  v_max3_u32 v27, v124, v126, v128
  v_max3_u32 v27, v27, v130, v132
  v_max3_u32 v27, v27, v133, v134
  v_max3_u32 v27, v27, v135, v135
  v_cmp_eq_u32 vcc, -1, v27
  s_nop 1
  s_cbranch_vccnz sr_133
ex_118:
  v_exp_f32 v176, v170
  v_exp_f32 v177, v171
  v_exp_f32 v172, v166
  v_cvt_pk_bf16_f32 v160, v176, v177
  v_exp_f32 v173, v167
  v_exp_f32 v174, v168
  v_mov_b32_dpp v161, v160 row_ror:8 row_mask:0xf bank_mask:0xf
  v_cvt_pk_bf16_f32 v156, v172, v173
  v_exp_f32 v175, v169
  v_mfma_f32_16x16x32_bf16 v[178:181], v[140:143], v[160:163], 0
  v_mov_b32_dpp v158, v156 row_ror:8 row_mask:0xf bank_mask:0xf
  v_cvt_pk_bf16_f32 v157, v174, v175
  v_mfma_f32_16x16x32_bf16 v[182:185], v[136:139], v[160:163], 0
  s_nop 0
  v_mov_b32_dpp v159, v157 row_ror:8 row_mask:0xf bank_mask:0xf
  v_mfma_f32_16x16x32_bf16 v[186:189], v[138:141], v[160:163], 0
  s_branch pv_117
fx_119:
  s_bitcmp1_b32 s81, 0
  s_cbranch_scc1 fk_120
  s_or_b32 s81, s81, 1
  s_mov_b64 exec, -1
  v_max3_f32 v164, v166, v167, v168
  v_max3_f32 v165, v169, v170, v171
  v_max_f32 v164, v164, v165
  s_nop 1
  v_max_f32_dpp v164, v164, v164 row_ror:8 row_mask:0xf bank_mask:0xf
  v_mov_b32 v165, v164
  s_nop 1
  v_permlane32_swap_b32 v164, v165
  v_max_f32 v164, v164, v165
  v_mov_b32 v165, v164
  s_nop 1
  v_permlane16_swap_b32 v164, v165
  v_max_f32 v164, v164, v165
  v_sub_f32 v166, v166, v164
  v_sub_f32 v167, v167, v164
  v_sub_f32 v168, v168, v164
  v_sub_f32 v169, v169, v164
  v_sub_f32 v170, v170, v164
  v_sub_f32 v171, v171, v164
  s_branch ex_118
pf_121:
  s_mov_b64 exec, s[66:67]
  ds_read_b128 v[166:169], v4 offset:13824
  ds_read_b128 v[170:173], v4 offset:14464
  ds_read_b128 v[174:177], v4 offset:15104
  ds_read_b128 v[178:181], v4 offset:15744
  s_waitcnt lgkmcnt(2)
  v_pk_add_f16 v166, v166, v170
  v_pk_add_f16 v167, v167, v171
  v_pk_add_f16 v168, v168, v172
  v_pk_add_f16 v169, v169, v173
  s_waitcnt lgkmcnt(1)
  v_pk_add_f16 v166, v166, v174
  v_pk_add_f16 v167, v167, v175
  v_pk_add_f16 v168, v168, v176
  v_pk_add_f16 v169, v169, v177
  s_waitcnt lgkmcnt(0)
  v_pk_add_f16 v166, v166, v178
  v_pk_add_f16 v167, v167, v179
  v_pk_add_f16 v168, v168, v180
  v_pk_add_f16 v169, v169, v181
  v_and_or_b32 v166, v166, -2, s61
  buffer_store_dwordx4 v[166:169], v15, s[4:7], s60 offen sc1
  s_mov_b64 exec, -1
  s_nop 1
  s_branch pf_122
last_110:
  v_permlane32_swap_b32 v88, v92
  v_permlane32_swap_b32 v89, v93
  v_permlane32_swap_b32 v90, v94
  v_permlane32_swap_b32 v91, v95
  v_pk_add_f32 v[88:89], v[88:89], v[92:93]
  v_pk_add_f32 v[90:91], v[90:91], v[94:95]
  v_cvt_pk_bf16_f32 v92, v88, v89
  v_cvt_pk_bf16_f32 v93, v90, v91
  v_min_u32 v92, -2, v92
  buffer_store_dwordx2 v[92:93], v43, s[16:19], s70 offen sc1
  v_smfmac_f32_16x16x64_bf16 v[96:99], v[56:59], a[16:23], v22
  v_smfmac_f32_16x16x64_bf16 v[100:103], v[56:59], a[96:103], v22
  v_smfmac_f32_16x16x64_bf16 v[96:99], v[60:63], a[24:31], v22
  v_smfmac_f32_16x16x64_bf16 v[96:99], v[64:67], a[32:39], v22
  v_smfmac_f32_16x16x64_bf16 v[96:99], v[68:71], a[40:47], v22
  v_smfmac_f32_16x16x64_bf16 v[96:99], v[72:75], a[48:55], v22
  v_smfmac_f32_16x16x64_bf16 v[96:99], v[76:79], a[56:63], v22
  v_smfmac_f32_16x16x64_bf16 v[96:99], v[80:83], a[64:71], v22
  v_smfmac_f32_16x16x64_bf16 v[96:99], v[84:87], a[72:79], v22
  v_smfmac_f32_16x16x64_bf16 v[100:103], v[60:63], a[104:111], v22
  v_smfmac_f32_16x16x64_bf16 v[100:103], v[64:67], a[112:119], v22
  v_smfmac_f32_16x16x64_bf16 v[100:103], v[68:71], a[120:127], v22
  v_smfmac_f32_16x16x64_bf16 v[100:103], v[72:75], a[128:135], v22
  v_smfmac_f32_16x16x64_bf16 v[100:103], v[76:79], a[136:143], v22
  v_smfmac_f32_16x16x64_bf16 v[100:103], v[80:83], a[144:151], v22
  v_smfmac_f32_16x16x64_bf16 v[100:103], v[84:87], a[152:159], v22
  s_nop 7
  v_permlane32_swap_b32 v96, v100
  v_permlane32_swap_b32 v97, v101
  v_permlane32_swap_b32 v98, v102
  v_permlane32_swap_b32 v99, v103
  v_pk_add_f32 v[96:97], v[96:97], v[100:101]
  v_pk_add_f32 v[98:99], v[98:99], v[102:103]
  v_cvt_pk_bf16_f32 v100, v96, v97
  v_cvt_pk_bf16_f32 v101, v98, v99
  s_nop 0
  v_permlane32_swap_b32 v100, v102
  v_permlane32_swap_b32 v101, v103
  v_min_u32 v100, -2, v100
  buffer_store_dwordx4 v[100:103], v26, s[16:19], s70 offen sc1
  s_waitcnt vmcnt(0)
  s_barrier
  v_mov_b32 v166, 64
  s_mov_b64 exec, 1
  buffer_store_dword v166, v23, s[12:15], s77 offen sc1
  s_mov_b64 exec, -1
  s_branch chain_done
E_25:
  v_add_u32 v190, 0, v4
  ds_write_b64 v6, v[28:29]
  ds_write_b32 v13, v28
  ds_write_b32 v14, v28
  s_waitcnt vmcnt(0)
  ds_write_b128 v190, v[48:51] offset:0
  ds_write_b128 v190, v[52:55] offset:1024
  s_waitcnt lgkmcnt(0)
  s_add_u32 m0, s74, 4096
  s_add_u32 s21, s79, 131072
  buffer_load_dwordx4 v4, s[16:19], s21 offen offset:1024 sc1 lds
  s_add_u32 m0, s74, 9216
  s_add_u32 s21, s72, 32768
  buffer_load_dwordx4 v32, s[16:19], s21 offen sc1 lds
  s_xor_b32 s74, s74, 16384
  s_add_u32 s73, s73, 2097152
  s_xor_b32 s73, s73, 8192
  s_add_u32 s79, s79, 2097152
  s_xor_b32 s79, s79, 8192
  s_add_u32 s21, s72, 524288
  s_xor_b32 s72, s72, s21
  s_lshr_b32 s72, s72, 8
  s_and_b32 s72, s72, 8192
  s_xor_b32 s72, s72, s21
  s_add_u32 s71, s73, 4096
  s_mov_b32 s91, 1024
  s_sub_u32 s21, s73, 0
  s_cmp_lt_u32 s21, 125829120
  s_cselect_b32 s71, s71, s79
  s_cselect_b32 s91, s91, 65536
  s_branch mo_140
  .p2align 3
top_135:
  s_waitcnt vmcnt(1)
  ds_write_b128 v190, v[48:51] offset:0
  v_cmp_eq_u32 s[22:23], -1, v48
  s_waitcnt vmcnt(0)
  ds_write_b128 v190, v[52:55] offset:1024
  v_cmp_eq_u32 s[98:99], -1, v52
  s_or_b64 vcc, s[22:23], s[98:99]
  s_cbranch_scc1 mr_136
mo_140:
  s_barrier
  ds_read_b128 v[56:59], v4 offset:2048
  ds_read_b128 v[60:63], v4 offset:3072
  v_smfmac_f32_16x16x64_bf16 v[92:95], v[48:51], a[240:247], v22
  ds_read_b128 v[64:67], v4 offset:4096
  v_smfmac_f32_16x16x64_bf16 v[88:91], v[48:51], a[160:167], v22
  ds_read_b128 v[68:71], v4 offset:5120
  v_smfmac_f32_16x16x64_bf16 v[92:95], v[52:55], a[248:255], v22
  ds_read_b128 v[72:75], v4 offset:6144
  v_smfmac_f32_16x16x64_bf16 v[88:91], v[52:55], a[168:175], v22
  s_waitcnt lgkmcnt(4)
  ds_read_b128 v[76:79], v4 offset:7168
  v_smfmac_f32_16x16x64_bf16 v[92:95], v[56:59], v[192:199], v22
  ds_read_b128 v[80:83], v4 offset:8192
  v_smfmac_f32_16x16x64_bf16 v[88:91], v[56:59], a[176:183], v22
  s_waitcnt lgkmcnt(5)
  ds_read_b128 v[84:87], v4 offset:9216
  v_smfmac_f32_16x16x64_bf16 v[92:95], v[60:63], v[200:207], v22
  v_smfmac_f32_16x16x64_bf16 v[88:91], v[60:63], a[184:191], v22
  s_waitcnt lgkmcnt(5)
  v_smfmac_f32_16x16x64_bf16 v[92:95], v[64:67], v[208:215], v22
  s_waitcnt lgkmcnt(4)
  v_smfmac_f32_16x16x64_bf16 v[92:95], v[68:71], v[216:223], v22
  s_waitcnt lgkmcnt(3)
  v_smfmac_f32_16x16x64_bf16 v[92:95], v[72:75], v[224:231], v22
  s_waitcnt lgkmcnt(2)
  v_smfmac_f32_16x16x64_bf16 v[92:95], v[76:79], v[232:239], v22
  s_waitcnt lgkmcnt(1)
  v_smfmac_f32_16x16x64_bf16 v[92:95], v[80:83], v[240:247], v22
  s_waitcnt lgkmcnt(0)
  v_smfmac_f32_16x16x64_bf16 v[92:95], v[84:87], v[248:255], v22
  v_smfmac_f32_16x16x64_bf16 v[88:91], v[64:67], a[192:199], v22
  v_smfmac_f32_16x16x64_bf16 v[88:91], v[68:71], a[200:207], v22
  v_smfmac_f32_16x16x64_bf16 v[88:91], v[72:75], a[208:215], v22
  v_permlane32_swap_b32 v92, v93
  v_smfmac_f32_16x16x64_bf16 v[88:91], v[76:79], a[216:223], v22
  v_permlane32_swap_b32 v94, v95
  v_smfmac_f32_16x16x64_bf16 v[88:91], v[80:83], a[224:231], v22
  v_permlane32_swap_b32 v93, v92
  v_smfmac_f32_16x16x64_bf16 v[88:91], v[84:87], a[232:239], v22
  v_permlane32_swap_b32 v95, v94
  v_pk_mul_f32 v[120:121], v[92:93], v[24:25] op_sel:[1,0] op_sel_hi:[0,1]
  v_pk_mul_f32 v[122:123], v[94:95], v[24:25] op_sel:[1,0] op_sel_hi:[0,1]
  s_nop 4
  v_pk_fma_f32 v[88:89], v[88:89], v[24:25], v[120:121]
  v_pk_fma_f32 v[90:91], v[90:91], v[24:25], v[122:123]
  v_cvt_pk_bf16_f32 v120, v88, v89
  v_cvt_pk_bf16_f32 v121, v90, v91
  ds_write_b64 v6, v[120:121]
  s_barrier
  ds_read_b64_tr_b16 v[104:105], v7 offset:0
  ds_read_b64_tr_b16 v[106:107], v7 offset:768
  ds_read_b64_tr_b16 v[108:109], v7 offset:1536
  s_waitcnt lgkmcnt(1)
  v_mfma_f32_16x16x32_bf16 v[120:123], v[112:115], v[104:107], 0
  s_waitcnt lgkmcnt(0)
  v_mfma_f32_16x16x32_bf16 v[120:123], v[116:119], v[108:111], v[120:123]
  s_mov_b64 exec, s[64:65]
  s_nop 6
  v_cmpx_o_f32 vcc, v120, v121
  v_cvt_pk_f16_f32 v120, v120, v121
  v_cvt_pk_f16_f32 v121, v122, v123
  buffer_store_dwordx2 v[120:121], v8, s[8:11], s56 offen sc1
  s_xor_b64 s[98:99], exec, s[64:65]
  s_mov_b64 exec, -1
  s_waitcnt lgkmcnt(0)
  s_barrier
  ds_read_b64_tr_b16 v[104:105], v7 offset:0
  ds_read_b64_tr_b16 v[106:107], v7 offset:768
  ds_read_b64_tr_b16 v[108:109], v7 offset:1536
  ds_read_b32 v27, v12 offset:12544
  ds_read_b64 v[140:141], v11
  s_waitcnt lgkmcnt(1)
  v_cmp_u_f32 vcc, v104, v106
  v_cmp_u_f32 s[22:23], v108, v27
  s_nop 1
  s_or_b64 vcc, vcc, s[22:23]
  s_cbranch_vccnz mn_137
mk_138:
  s_cmp_eq_u32 s52, 63
  s_cbranch_scc1 last_139
  s_cmp_lg_u64 s[98:99], 0
  s_cbranch_scc1 sf_141
sf_142:
  s_nop 15
  s_nop 10
  v_smfmac_f32_16x16x64_bf16 v[96:99], v[48:51], a[0:7], v22
  v_smfmac_f32_16x16x64_bf16 v[100:103], v[48:51], a[80:87], v22
  v_smfmac_f32_16x16x64_bf16 v[96:99], v[52:55], a[8:15], v22
  v_smfmac_f32_16x16x64_bf16 v[100:103], v[52:55], a[88:95], v22
  v_smfmac_f32_16x16x64_bf16 v[96:99], v[56:59], a[16:23], v22
  v_smfmac_f32_16x16x64_bf16 v[100:103], v[56:59], a[96:103], v22
  buffer_load_dwordx4 v[132:135], v10, s[8:11], s56 offen sc1
  v_smfmac_f32_16x16x64_bf16 v[96:99], v[60:63], a[24:31], v22
  buffer_load_dwordx4 v[124:127], v9, s[8:11], s56 offen sc1
  v_smfmac_f32_16x16x64_bf16 v[96:99], v[64:67], a[32:39], v22
  buffer_load_dwordx4 v[128:131], v9, s[8:11], s56 offen offset:1024 sc1
  v_smfmac_f32_16x16x64_bf16 v[96:99], v[68:71], a[40:47], v22
  v_smfmac_f32_16x16x64_bf16 v[96:99], v[72:75], a[48:55], v22
  v_smfmac_f32_16x16x64_bf16 v[96:99], v[76:79], a[56:63], v22
  v_smfmac_f32_16x16x64_bf16 v[96:99], v[80:83], a[64:71], v22
  v_smfmac_f32_16x16x64_bf16 v[96:99], v[84:87], a[72:79], v22
  v_smfmac_f32_16x16x64_bf16 v[100:103], v[60:63], a[104:111], v22
  v_smfmac_f32_16x16x64_bf16 v[100:103], v[64:67], a[112:119], v22
  v_smfmac_f32_16x16x64_bf16 v[100:103], v[68:71], a[120:127], v22
  v_smfmac_f32_16x16x64_bf16 v[100:103], v[72:75], a[128:135], v22
  v_cvt_pk_bf16_f32 v136, v96, v97
  v_smfmac_f32_16x16x64_bf16 v[100:103], v[76:79], a[136:143], v22
  v_cvt_pk_bf16_f32 v137, v98, v99
  v_smfmac_f32_16x16x64_bf16 v[100:103], v[80:83], a[144:151], v22
  v_smfmac_f32_16x16x64_bf16 v[100:103], v[84:87], a[152:159], v22
  s_nop 7
  v_cvt_pk_bf16_f32 v138, v100, v101
  v_cvt_pk_bf16_f32 v139, v102, v103
  s_waitcnt vmcnt(2) lgkmcnt(0)
  v_pk_add_f16 v164, v132, v133
  v_pk_add_f16 v165, v134, v135
  v_fma_mix_f32 v170, v164, 1.0, v165 op_sel:[0,0,0] op_sel_hi:[1,0,1]
  v_fma_mix_f32 v171, v164, 1.0, v165 op_sel:[1,0,1] op_sel_hi:[1,0,1]
  v_exp_f32 v176, v170
  v_exp_f32 v177, v171
  s_waitcnt vmcnt(1)
  v_cvt_pk_bf16_f32 v160, v176, v177
  v_pk_add_f16 v120, v124, v126
  v_pk_add_f16 v121, v125, v127
  v_mov_b32_dpp v161, v160 row_ror:8 row_mask:0xf bank_mask:0xf
  s_waitcnt vmcnt(0)
  v_pk_add_f16 v122, v128, v130
  v_mfma_f32_16x16x32_bf16 v[178:181], v[140:143], v[160:163], 0
  v_fma_mix_f32 v166, v120, 1.0, v122 op_sel:[0,0,0] op_sel_hi:[1,0,1]
  v_fma_mix_f32 v167, v120, 1.0, v122 op_sel:[1,0,1] op_sel_hi:[1,0,1]
  v_cmp_u_f32 vcc, v166, v170
  v_pk_add_f16 v123, v129, v131
  v_exp_f32 v172, v166
  v_mfma_f32_16x16x32_bf16 v[182:185], v[136:139], v[160:163], 0
  s_cbranch_vccnz sr_143
  v_exp_f32 v173, v167
  v_fma_mix_f32 v168, v121, 1.0, v123 op_sel:[0,0,0] op_sel_hi:[1,0,1]
  v_fma_mix_f32 v169, v121, 1.0, v123 op_sel:[1,0,1] op_sel_hi:[1,0,1]
  v_cvt_pk_bf16_f32 v156, v172, v173
  v_exp_f32 v174, v168
  v_exp_f32 v175, v169
  v_mov_b32_dpp v158, v156 row_ror:8 row_mask:0xf bank_mask:0xf
  v_cvt_pk_bf16_f32 v157, v174, v175
  v_mfma_f32_16x16x32_bf16 v[186:189], v[138:141], v[160:163], 0
  s_nop 0
  v_mov_b32_dpp v159, v157 row_ror:8 row_mask:0xf bank_mask:0xf
  s_nop 1
pv_144:
  v_mfma_f32_16x16x32_bf16 v[178:181], v[152:155], v[156:159], v[178:181]
  v_mfma_f32_16x16x32_bf16 v[182:185], v[144:147], v[156:159], v[182:185]
  v_mfma_f32_16x16x32_bf16 v[186:189], v[148:151], v[156:159], v[186:189]
  s_mov_b64 exec, s[62:63]
  s_nop 0
  v_rcp_f32 v164, v180
  v_cmp_ngt_f32 s[22:23], s80, v180
  v_cmp_ngt_f32 vcc, s80, v164
  v_pk_mul_f32 v[182:183], v[182:183], v[164:165] op_sel_hi:[1,0]
  v_pk_mul_f32 v[184:185], v[184:185], v[164:165] op_sel_hi:[1,0]
  v_pk_mul_f32 v[178:179], v[178:179], v[164:165] op_sel_hi:[1,0]
  v_pk_mul_f32 v[186:187], v[186:187], v[164:165] op_sel_hi:[1,0]
  v_pk_mul_f32 v[188:189], v[188:189], v[164:165] op_sel_hi:[1,0]
  v_cvt_pk_f16_f32 v64, v178, v179
  s_or_b64 vcc, vcc, s[22:23]
  s_cbranch_scc1 fx_146
fk_147:
  ds_write_b32 v14, v64
  v_cvt_pk_f16_f32 v60, v182, v183
  v_cvt_pk_f16_f32 v61, v184, v185
  v_cvt_pk_f16_f32 v62, v186, v187
  v_cvt_pk_f16_f32 v63, v188, v189
  ds_write_b128 v13, v[60:63]
  s_barrier
  s_mov_b64 exec, -1
  s_add_u32 m0, s74, 4096
  s_add_u32 s21, s79, 131072
  buffer_load_dwordx4 v4, s[16:19], s21 offen offset:1024 sc1 lds
  s_add_u32 m0, s74, 9216
  s_add_u32 s21, s72, 32768
  buffer_load_dwordx4 v32, s[16:19], s21 offen sc1 lds
  s_xor_b32 s74, s74, 16384
  s_add_u32 s73, s73, 2097152
  s_xor_b32 s73, s73, 8192
  s_add_u32 s79, s79, 2097152
  s_xor_b32 s79, s79, 8192
  s_add_u32 s21, s72, 524288
  s_xor_b32 s72, s72, s21
  s_lshr_b32 s72, s72, 8
  s_and_b32 s72, s72, 8192
  s_xor_b32 s72, s72, s21
  s_add_u32 s71, s73, 4096
  s_mov_b32 s91, 1024
  s_sub_u32 s21, s73, 0
  s_cmp_lt_u32 s21, 125829120
  s_cselect_b32 s71, s71, s79
  s_cselect_b32 s91, s91, 65536
  v_permlane32_swap_b32 v96, v100
  v_permlane32_swap_b32 v97, v101
  v_permlane32_swap_b32 v98, v102
  v_permlane32_swap_b32 v99, v103
  v_pk_add_f32 v[96:97], v[96:97], v[100:101]
  v_pk_add_f32 v[98:99], v[98:99], v[102:103]
  v_cvt_pk_bf16_f32 v100, v96, v97
  v_cvt_pk_bf16_f32 v101, v98, v99
  s_nop 0
  v_permlane32_swap_b32 v100, v102
  v_permlane32_swap_b32 v101, v103
  v_min_u32 v100, -2, v100
  s_nop 6
  buffer_store_dwordx4 v[100:103], v26, s[16:19], s70 offen sc1
  v_min_u32 v104, -2, v104
  buffer_store_dwordx4 v[104:107], v36, s[16:19], s70 offen offset:2560 sc1
  s_add_u32 s70, s70, 2097152
  s_xor_b32 s70, s70, 8192
  ds_read_b128 v[144:147], v18
  ds_read_b128 v[148:151], v18 offset:1024
  ds_read_b128 v[152:155], v19
  ds_read_b128 v[112:115], v20
  ds_read_b64 v[116:117], v21
  v_xor_b32 v18, 16384, v18
  v_xor_b32 v19, 16384, v19
  v_xor_b32 v20, 16384, v20
  v_xor_b32 v21, 16384, v21
  v_mov_b32 v88, 0
  v_mov_b32 v89, 0
  v_mov_b32 v90, 0
  v_mov_b32 v91, 0
  v_mov_b32 v92, 0
  v_mov_b32 v93, 0
  v_mov_b32 v94, 0
  v_mov_b32 v95, 0
  v_mov_b32 v96, 0
  v_mov_b32 v97, 0
  v_mov_b32 v98, 0
  v_mov_b32 v99, 0
  v_mov_b32 v100, 0
  v_mov_b32 v101, 0
  v_mov_b32 v102, 0
  v_mov_b32 v103, 0
  s_mov_b32 s81, 0
  s_waitcnt lgkmcnt(0)
  s_barrier
  s_mov_b64 exec, s[64:65]
  buffer_store_dwordx2 v[28:29], v8, s[8:11], s57 offen sc1
  s_mov_b64 exec, -1
  ds_write_b128 v190, v[28:31] offset:0
  ds_write_b128 v190, v[28:31] offset:1024
  ds_write_b64 v6, v[28:29]
  s_mov_b64 exec, s[62:63]
  buffer_store_dword v28, v17, s[8:11], s59 offen sc1
  s_mov_b64 exec, -1
  s_sleep 3
  s_nop 1
  buffer_load_dwordx4 v[68:71], v16, s[4:7], s60 offen sc1
  s_sleep 3
  s_nop 1
  buffer_load_dwordx4 v[72:75], v16, s[4:7], s60 offen sc1
  s_waitcnt vmcnt(1)
  v_mfma_f32_16x16x32_f16 v[120:123], v[44:47], v[68:71], 0
  v_bitop3_b32 v27, v68, s61, 1 bitop3:0x28
  v_cmp_ne_u32 vcc, 0, v27
  s_nop 1
  s_cbranch_vccnz p2_152
  s_nop 2
pg_151:
  v_add_f32_dpp v120, v120, v120 row_ror:8 row_mask:0xf bank_mask:0xf
  v_add_f32_dpp v121, v121, v121 row_ror:8 row_mask:0xf bank_mask:0xf
  s_mov_b64 exec, s[62:63]
  v_cvt_pk_bf16_f32 v120, v120, v121
  v_min_u32 v120, -2, v120
  buffer_store_dword v120, v17, s[8:11], s55 offen sc1
  s_mov_b64 exec, -1
nt_148:
  s_barrier
  s_mov_b32 s58, s55
  s_add_u32 s52, s52, 1
  ds_write_b32 v13, v28
  ds_write_b32 v14, v28
  s_and_b32 s21, s52, 3
  s_mul_i32 s56, s21, 122880
  s_add_u32 s21, s52, 1
  s_and_b32 s21, s21, 3
  s_mul_i32 s55, s21, 122880
  s_add_u32 s55, s55, s75
  s_add_u32 s21, s52, 2
  s_and_b32 s21, s21, 3
  s_mul_i32 s57, s21, 122880
  s_add_u32 s21, s52, 3
  s_and_b32 s21, s21, 3
  s_mul_i32 s59, s21, 122880
  s_add_u32 s59, s59, s75
  s_bfe_u32 s61, s52, 0x10002
  s_and_b32 s21, s52, 3
  s_lshl_b32 s60, s21, 18
  s_mov_b32 s54, 0
  s_sleep 3
  s_waitcnt lgkmcnt(0)
  buffer_load_dwordx4 v[48:51], v190, s[8:11], s58 offen offset:0 sc1
  buffer_load_dwordx4 v[52:55], v190, s[8:11], s58 offen offset:1024 sc1
  s_branch top_135
mr_136:
  s_mov_b64 exec, s[22:23]
  s_cbranch_execz ms_153
  buffer_load_dwordx4 v[48:51], v190, s[8:11], s58 offen offset:0 sc1
ms_153:
  s_mov_b64 exec, s[98:99]
  s_cbranch_execz ms_154
  buffer_load_dwordx4 v[52:55], v190, s[8:11], s58 offen offset:1024 sc1
ms_154:
  s_add_u32 s54, s54, 1
  s_cmp_gt_u32 s54, 131072
  s_cbranch_scc1 end0
  s_waitcnt vmcnt(0)
  s_mov_b64 exec, s[22:23]
  ds_write_b128 v190, v[48:51] offset:0
  v_cmp_eq_u32 s[22:23], -1, v48
  s_mov_b64 exec, s[98:99]
  ds_write_b128 v190, v[52:55] offset:1024
  v_cmp_eq_u32 s[98:99], -1, v52
  s_mov_b64 exec, -1
  s_or_b64 vcc, s[22:23], s[98:99]
  s_cbranch_scc1 mr_136
  s_branch mo_140
sf_141:
  s_waitcnt lgkmcnt(1)
  v_mfma_f32_16x16x32_bf16 v[120:123], v[112:115], v[104:107], 0
  s_waitcnt lgkmcnt(0)
  v_mfma_f32_16x16x32_bf16 v[120:123], v[116:119], v[108:111], v[120:123]
  s_mov_b64 exec, s[64:65]
  s_nop 6
  v_cvt_pk_f16_f32 v120, v120, v121
  v_cvt_pk_f16_f32 v121, v122, v123
  buffer_store_dwordx2 v[120:121], v8, s[8:11], s56 offen sc1
  s_mov_b64 exec, -1
  s_branch sf_142
mn_137:
  s_bitcmp1_b32 s81, 1
  s_cbranch_scc1 mk_138
  s_or_b32 s81, s81, 2
  s_nop 7
  v_mov_b32 v88, 0
  v_mov_b32 v89, 0
  v_mov_b32 v90, 0
  v_mov_b32 v91, 0
  v_mov_b32 v92, 0
  v_mov_b32 v93, 0
  v_mov_b32 v94, 0
  v_mov_b32 v95, 0
  v_mov_b32 v96, 0
  v_mov_b32 v97, 0
  v_mov_b32 v98, 0
  v_mov_b32 v99, 0
  v_mov_b32 v100, 0
  v_mov_b32 v101, 0
  v_mov_b32 v102, 0
  v_mov_b32 v103, 0
  s_cmp_eq_u32 s52, 0
  s_cbranch_scc1 mx_156
mx_155:
  buffer_load_dwordx4 v[48:51], v190, s[8:11], s58 offen offset:0 sc1
  buffer_load_dwordx4 v[52:55], v190, s[8:11], s58 offen offset:1024 sc1
  s_add_u32 s54, s54, 1
  s_cmp_gt_u32 s54, 131072
  s_cbranch_scc1 end0
  s_waitcnt vmcnt(0)
  v_max3_u32 v27, v48, v49, v50
  v_max3_u32 v27, v27, v51, v52
  v_max3_u32 v27, v27, v53, v54
  v_max3_u32 v27, v27, v55, v55
  v_cmp_eq_u32 vcc, -1, v27
  s_nop 1
  s_cbranch_vccnz mx_155
  ds_write_b128 v190, v[48:51] offset:0
  ds_write_b128 v190, v[52:55] offset:1024
mx_156:
  s_waitcnt lgkmcnt(0)
  s_branch mo_140
sr_143:
  s_mov_b32 s54, 0
sr_157:
  s_mov_b64 exec, vcc
  buffer_load_dwordx4 v[124:127], v9, s[8:11], s56 offen sc1
  buffer_load_dwordx4 v[128:131], v9, s[8:11], s56 offen offset:1024 sc1
  buffer_load_dwordx4 v[132:135], v10, s[8:11], s56 offen sc1
  s_mov_b64 exec, -1
  s_add_u32 s54, s54, 1
  s_cmp_gt_u32 s54, 131072
  s_cbranch_scc1 end0
  s_waitcnt vmcnt(0)
  v_pk_add_f16 v164, v132, v133
  v_pk_add_f16 v165, v134, v135
  v_pk_add_f16 v120, v124, v126
  v_pk_add_f16 v122, v128, v130
  v_fma_mix_f32 v170, v164, 1.0, v165 op_sel:[0,0,0] op_sel_hi:[1,0,1]
  v_fma_mix_f32 v166, v120, 1.0, v122 op_sel:[0,0,0] op_sel_hi:[1,0,1]
  v_pk_add_f16 v121, v125, v127
  v_cmp_u_f32 vcc, v166, v170
  v_pk_add_f16 v123, v129, v131
  v_fma_mix_f32 v171, v164, 1.0, v165 op_sel:[1,0,1] op_sel_hi:[1,0,1]
  v_fma_mix_f32 v167, v120, 1.0, v122 op_sel:[1,0,1] op_sel_hi:[1,0,1]
  v_fma_mix_f32 v168, v121, 1.0, v123 op_sel:[0,0,0] op_sel_hi:[1,0,1]
  v_fma_mix_f32 v169, v121, 1.0, v123 op_sel:[1,0,1] op_sel_hi:[1,0,1]
  s_cbranch_vccz ex_145
  s_and_b32 s21, s54, 31
  s_cbranch_scc1 sr_157
  v_max3_u32 v27, v124, v126, v128
  v_max3_u32 v27, v27, v130, v132
  v_max3_u32 v27, v27, v133, v134
  v_max3_u32 v27, v27, v135, v135
  v_cmp_eq_u32 vcc, -1, v27
  s_nop 1
  s_cbranch_vccnz sr_157
ex_145:
  v_exp_f32 v176, v170
  v_exp_f32 v177, v171
  v_exp_f32 v172, v166
  v_cvt_pk_bf16_f32 v160, v176, v177
  v_exp_f32 v173, v167
  v_exp_f32 v174, v168
  v_mov_b32_dpp v161, v160 row_ror:8 row_mask:0xf bank_mask:0xf
  v_cvt_pk_bf16_f32 v156, v172, v173
  v_exp_f32 v175, v169
  v_mfma_f32_16x16x32_bf16 v[178:181], v[140:143], v[160:163], 0
  v_mov_b32_dpp v158, v156 row_ror:8 row_mask:0xf bank_mask:0xf
  v_cvt_pk_bf16_f32 v157, v174, v175
  v_mfma_f32_16x16x32_bf16 v[182:185], v[136:139], v[160:163], 0
  s_nop 0
  v_mov_b32_dpp v159, v157 row_ror:8 row_mask:0xf bank_mask:0xf
  v_mfma_f32_16x16x32_bf16 v[186:189], v[138:141], v[160:163], 0
  s_branch pv_144
fx_146:
  s_bitcmp1_b32 s81, 0
  s_cbranch_scc1 fk_147
  s_or_b32 s81, s81, 1
  s_mov_b64 exec, -1
  v_max3_f32 v164, v166, v167, v168
  v_max3_f32 v165, v169, v170, v171
  v_max_f32 v164, v164, v165
  s_nop 1
  v_max_f32_dpp v164, v164, v164 row_ror:8 row_mask:0xf bank_mask:0xf
  v_mov_b32 v165, v164
  s_nop 1
  v_permlane32_swap_b32 v164, v165
  v_max_f32 v164, v164, v165
  v_mov_b32 v165, v164
  s_nop 1
  v_permlane16_swap_b32 v164, v165
  v_max_f32 v164, v164, v165
  v_sub_f32 v166, v166, v164
  v_sub_f32 v167, v167, v164
  v_sub_f32 v168, v168, v164
  v_sub_f32 v169, v169, v164
  v_sub_f32 v170, v170, v164
  v_sub_f32 v171, v171, v164
  s_branch ex_145
p2_152:
  s_mov_b32 s54, 0
  buffer_load_dwordx4 v[68:71], v16, s[4:7], s60 offen sc1
  s_waitcnt vmcnt(1)
  v_mfma_f32_16x16x32_f16 v[120:123], v[44:47], v[72:75], 0
  v_bitop3_b32 v27, v72, s61, 1 bitop3:0x28
  v_cmp_ne_u32 vcc, 0, v27
  s_nop 1
  s_cbranch_vccz pg_151
  buffer_load_dwordx4 v[72:75], v16, s[4:7], s60 offen sc1
pp_150:
  s_waitcnt vmcnt(1)
  v_mfma_f32_16x16x32_f16 v[120:123], v[44:47], v[68:71], 0
  v_bitop3_b32 v27, v68, s61, 1 bitop3:0x28
  v_cmp_ne_u32 vcc, 0, v27
  s_nop 1
  s_cbranch_vccz pg_151
  buffer_load_dwordx4 v[68:71], v16, s[4:7], s60 offen sc1
  s_waitcnt vmcnt(1)
  v_mfma_f32_16x16x32_f16 v[120:123], v[44:47], v[72:75], 0
  v_bitop3_b32 v27, v72, s61, 1 bitop3:0x28
  v_cmp_ne_u32 vcc, 0, v27
  s_nop 1
  s_cbranch_vccz pg_151
  buffer_load_dwordx4 v[72:75], v16, s[4:7], s60 offen sc1
  s_add_u32 s54, s54, 1
  s_cmp_gt_u32 s54, 131072
  s_cbranch_scc1 end0
  s_branch pp_150
last_139:
  v_min_u32 v104, -2, v104
  buffer_store_dwordx4 v[104:107], v36, s[16:19], s70 offen offset:2560 sc1
  v_smfmac_f32_16x16x64_bf16 v[96:99], v[48:51], a[0:7], v22
  v_smfmac_f32_16x16x64_bf16 v[100:103], v[48:51], a[80:87], v22
  v_smfmac_f32_16x16x64_bf16 v[96:99], v[52:55], a[8:15], v22
  v_smfmac_f32_16x16x64_bf16 v[100:103], v[52:55], a[88:95], v22
  v_smfmac_f32_16x16x64_bf16 v[96:99], v[56:59], a[16:23], v22
  v_smfmac_f32_16x16x64_bf16 v[100:103], v[56:59], a[96:103], v22
  v_smfmac_f32_16x16x64_bf16 v[96:99], v[60:63], a[24:31], v22
  v_smfmac_f32_16x16x64_bf16 v[96:99], v[64:67], a[32:39], v22
  v_smfmac_f32_16x16x64_bf16 v[96:99], v[68:71], a[40:47], v22
  v_smfmac_f32_16x16x64_bf16 v[96:99], v[72:75], a[48:55], v22
  v_smfmac_f32_16x16x64_bf16 v[96:99], v[76:79], a[56:63], v22
  v_smfmac_f32_16x16x64_bf16 v[96:99], v[80:83], a[64:71], v22
  v_smfmac_f32_16x16x64_bf16 v[96:99], v[84:87], a[72:79], v22
  v_smfmac_f32_16x16x64_bf16 v[100:103], v[60:63], a[104:111], v22
  v_smfmac_f32_16x16x64_bf16 v[100:103], v[64:67], a[112:119], v22
  v_smfmac_f32_16x16x64_bf16 v[100:103], v[68:71], a[120:127], v22
  v_smfmac_f32_16x16x64_bf16 v[100:103], v[72:75], a[128:135], v22
  v_smfmac_f32_16x16x64_bf16 v[100:103], v[76:79], a[136:143], v22
  v_smfmac_f32_16x16x64_bf16 v[100:103], v[80:83], a[144:151], v22
  v_smfmac_f32_16x16x64_bf16 v[100:103], v[84:87], a[152:159], v22
  s_nop 7
  v_permlane32_swap_b32 v96, v100
  v_permlane32_swap_b32 v97, v101
  v_permlane32_swap_b32 v98, v102
  v_permlane32_swap_b32 v99, v103
  v_pk_add_f32 v[96:97], v[96:97], v[100:101]
  v_pk_add_f32 v[98:99], v[98:99], v[102:103]
  v_cvt_pk_bf16_f32 v100, v96, v97
  v_cvt_pk_bf16_f32 v101, v98, v99
  s_nop 0
  v_permlane32_swap_b32 v100, v102
  v_permlane32_swap_b32 v101, v103
  v_min_u32 v100, -2, v100
  buffer_store_dwordx4 v[100:103], v26, s[16:19], s70 offen sc1
  s_waitcnt vmcnt(0)
  s_barrier
  s_branch chain_done
E_27:
  v_add_u32 v190, 2048, v4
  ds_write_b64 v6, v[28:29]
  ds_write_b32 v13, v28
  ds_write_b32 v14, v28
  s_waitcnt vmcnt(0)
  ds_write_b128 v190, v[56:59] offset:0
  ds_write_b128 v190, v[60:63] offset:1024
  ds_write_b128 v190, v[64:67] offset:2048
  s_waitcnt lgkmcnt(0)
  s_add_u32 m0, s74, 6144
  s_add_u32 s21, s79, 196608
  buffer_load_dwordx4 v4, s[16:19], s21 offen offset:1024 sc1 lds
  s_add_u32 m0, s74, 4096
  s_mul_i32 s21, s91, 2
  s_add_u32 s21, s21, s71
  buffer_load_dwordx4 v4, s[16:19], s21 offen sc1 lds
  s_xor_b32 s74, s74, 16384
  s_add_u32 s73, s73, 2097152
  s_xor_b32 s73, s73, 8192
  s_add_u32 s79, s79, 2097152
  s_xor_b32 s79, s79, 8192
  s_add_u32 s21, s72, 524288
  s_xor_b32 s72, s72, s21
  s_lshr_b32 s72, s72, 8
  s_and_b32 s72, s72, 8192
  s_xor_b32 s72, s72, s21
  s_add_u32 s71, s73, 4096
  s_mov_b32 s91, 1024
  s_sub_u32 s21, s73, 0
  s_cmp_lt_u32 s21, 125829120
  s_cselect_b32 s71, s71, s79
  s_cselect_b32 s91, s91, 65536
  s_branch mo_164
  .p2align 3
top_159:
  s_waitcnt vmcnt(2)
  ds_write_b128 v190, v[56:59] offset:0
  v_cmp_eq_u32 s[22:23], -1, v56
  s_waitcnt vmcnt(1)
  ds_write_b128 v190, v[60:63] offset:1024
  v_cmp_eq_u32 s[98:99], -1, v60
  s_waitcnt vmcnt(0)
  ds_write_b128 v190, v[64:67] offset:2048
  v_cmp_eq_u32 s[100:101], -1, v64
  s_or_b64 vcc, s[22:23], s[98:99]
  s_or_b64 vcc, vcc, s[100:101]
  s_cbranch_scc1 mr_160
mo_164:
  s_barrier
  ds_read_b128 v[48:51], v4 offset:0
  ds_read_b128 v[52:55], v4 offset:1024
  v_smfmac_f32_16x16x64_bf16 v[92:95], v[56:59], v[192:199], v22
  ds_read_b128 v[68:71], v4 offset:5120
  v_smfmac_f32_16x16x64_bf16 v[88:91], v[56:59], a[176:183], v22
  ds_read_b128 v[72:75], v4 offset:6144
  v_smfmac_f32_16x16x64_bf16 v[92:95], v[60:63], v[200:207], v22
  ds_read_b128 v[76:79], v4 offset:7168
  v_smfmac_f32_16x16x64_bf16 v[88:91], v[60:63], a[184:191], v22
  ds_read_b128 v[80:83], v4 offset:8192
  v_smfmac_f32_16x16x64_bf16 v[92:95], v[64:67], v[208:215], v22
  ds_read_b128 v[84:87], v4 offset:9216
  v_smfmac_f32_16x16x64_bf16 v[88:91], v[64:67], a[192:199], v22
  s_waitcnt lgkmcnt(6)
  v_smfmac_f32_16x16x64_bf16 v[92:95], v[48:51], a[240:247], v22
  v_smfmac_f32_16x16x64_bf16 v[88:91], v[48:51], a[160:167], v22
  s_waitcnt lgkmcnt(5)
  v_smfmac_f32_16x16x64_bf16 v[92:95], v[52:55], a[248:255], v22
  s_waitcnt lgkmcnt(4)
  v_smfmac_f32_16x16x64_bf16 v[92:95], v[68:71], v[216:223], v22
  s_waitcnt lgkmcnt(3)
  v_smfmac_f32_16x16x64_bf16 v[92:95], v[72:75], v[224:231], v22
  s_waitcnt lgkmcnt(2)
  v_smfmac_f32_16x16x64_bf16 v[92:95], v[76:79], v[232:239], v22
  s_waitcnt lgkmcnt(1)
  v_smfmac_f32_16x16x64_bf16 v[92:95], v[80:83], v[240:247], v22
  s_waitcnt lgkmcnt(0)
  v_smfmac_f32_16x16x64_bf16 v[92:95], v[84:87], v[248:255], v22
  v_smfmac_f32_16x16x64_bf16 v[88:91], v[52:55], a[168:175], v22
  v_smfmac_f32_16x16x64_bf16 v[88:91], v[68:71], a[200:207], v22
  v_smfmac_f32_16x16x64_bf16 v[88:91], v[72:75], a[208:215], v22
  v_permlane32_swap_b32 v92, v93
  v_smfmac_f32_16x16x64_bf16 v[88:91], v[76:79], a[216:223], v22
  v_permlane32_swap_b32 v94, v95
  v_smfmac_f32_16x16x64_bf16 v[88:91], v[80:83], a[224:231], v22
  v_permlane32_swap_b32 v93, v92
  v_smfmac_f32_16x16x64_bf16 v[88:91], v[84:87], a[232:239], v22
  v_permlane32_swap_b32 v95, v94
  v_pk_mul_f32 v[120:121], v[92:93], v[24:25] op_sel:[1,0] op_sel_hi:[0,1]
  v_pk_mul_f32 v[122:123], v[94:95], v[24:25] op_sel:[1,0] op_sel_hi:[0,1]
  s_nop 4
  v_pk_fma_f32 v[88:89], v[88:89], v[24:25], v[120:121]
  v_pk_fma_f32 v[90:91], v[90:91], v[24:25], v[122:123]
  v_cvt_pk_bf16_f32 v120, v88, v89
  v_cvt_pk_bf16_f32 v121, v90, v91
  ds_write_b64 v6, v[120:121]
  s_barrier
  ds_read_b64_tr_b16 v[104:105], v7 offset:0
  ds_read_b64_tr_b16 v[106:107], v7 offset:768
  ds_read_b64_tr_b16 v[108:109], v7 offset:1536
  s_waitcnt lgkmcnt(1)
  v_mfma_f32_16x16x32_bf16 v[120:123], v[112:115], v[104:107], 0
  s_waitcnt lgkmcnt(0)
  v_mfma_f32_16x16x32_bf16 v[120:123], v[116:119], v[108:111], v[120:123]
  s_mov_b64 exec, s[64:65]
  s_nop 6
  v_cmpx_o_f32 vcc, v120, v121
  v_cvt_pk_f16_f32 v120, v120, v121
  v_cvt_pk_f16_f32 v121, v122, v123
  buffer_store_dwordx2 v[120:121], v8, s[8:11], s56 offen sc1
  s_xor_b64 s[98:99], exec, s[64:65]
  s_mov_b64 exec, -1
  s_waitcnt lgkmcnt(0)
  s_barrier
  ds_read_b64_tr_b16 v[104:105], v7 offset:0
  ds_read_b64_tr_b16 v[106:107], v7 offset:768
  ds_read_b64_tr_b16 v[108:109], v7 offset:1536
  ds_read_b32 v27, v12 offset:12544
  ds_read_b64 v[140:141], v11
  s_waitcnt lgkmcnt(1)
  v_cmp_u_f32 vcc, v104, v106
  v_cmp_u_f32 s[22:23], v108, v27
  s_nop 1
  s_or_b64 vcc, vcc, s[22:23]
  s_cbranch_vccnz mn_161
mk_162:
  s_cmp_eq_u32 s52, 63
  s_cbranch_scc1 last_163
  s_cmp_lg_u64 s[98:99], 0
  s_cbranch_scc1 sf_165
sf_166:
  s_nop 15
  s_nop 10
  v_smfmac_f32_16x16x64_bf16 v[96:99], v[48:51], a[0:7], v22
  v_smfmac_f32_16x16x64_bf16 v[100:103], v[48:51], a[80:87], v22
  v_smfmac_f32_16x16x64_bf16 v[96:99], v[52:55], a[8:15], v22
  v_smfmac_f32_16x16x64_bf16 v[100:103], v[52:55], a[88:95], v22
  v_smfmac_f32_16x16x64_bf16 v[96:99], v[56:59], a[16:23], v22
  v_smfmac_f32_16x16x64_bf16 v[100:103], v[56:59], a[96:103], v22
  buffer_load_dwordx4 v[132:135], v10, s[8:11], s56 offen sc1
  v_smfmac_f32_16x16x64_bf16 v[96:99], v[60:63], a[24:31], v22
  buffer_load_dwordx4 v[124:127], v9, s[8:11], s56 offen sc1
  v_smfmac_f32_16x16x64_bf16 v[96:99], v[64:67], a[32:39], v22
  buffer_load_dwordx4 v[128:131], v9, s[8:11], s56 offen offset:1024 sc1
  v_smfmac_f32_16x16x64_bf16 v[96:99], v[68:71], a[40:47], v22
  v_smfmac_f32_16x16x64_bf16 v[96:99], v[72:75], a[48:55], v22
  v_smfmac_f32_16x16x64_bf16 v[96:99], v[76:79], a[56:63], v22
  v_smfmac_f32_16x16x64_bf16 v[96:99], v[80:83], a[64:71], v22
  v_smfmac_f32_16x16x64_bf16 v[96:99], v[84:87], a[72:79], v22
  v_smfmac_f32_16x16x64_bf16 v[100:103], v[60:63], a[104:111], v22
  v_smfmac_f32_16x16x64_bf16 v[100:103], v[64:67], a[112:119], v22
  v_smfmac_f32_16x16x64_bf16 v[100:103], v[68:71], a[120:127], v22
  v_smfmac_f32_16x16x64_bf16 v[100:103], v[72:75], a[128:135], v22
  v_cvt_pk_bf16_f32 v136, v96, v97
  v_smfmac_f32_16x16x64_bf16 v[100:103], v[76:79], a[136:143], v22
  v_cvt_pk_bf16_f32 v137, v98, v99
  v_smfmac_f32_16x16x64_bf16 v[100:103], v[80:83], a[144:151], v22
  v_smfmac_f32_16x16x64_bf16 v[100:103], v[84:87], a[152:159], v22
  s_nop 7
  v_cvt_pk_bf16_f32 v138, v100, v101
  v_cvt_pk_bf16_f32 v139, v102, v103
  s_waitcnt vmcnt(2) lgkmcnt(0)
  v_pk_add_f16 v164, v132, v133
  v_pk_add_f16 v165, v134, v135
  v_fma_mix_f32 v170, v164, 1.0, v165 op_sel:[0,0,0] op_sel_hi:[1,0,1]
  v_fma_mix_f32 v171, v164, 1.0, v165 op_sel:[1,0,1] op_sel_hi:[1,0,1]
  v_exp_f32 v176, v170
  v_exp_f32 v177, v171
  s_waitcnt vmcnt(1)
  v_cvt_pk_bf16_f32 v160, v176, v177
  v_pk_add_f16 v120, v124, v126
  v_pk_add_f16 v121, v125, v127
  v_mov_b32_dpp v161, v160 row_ror:8 row_mask:0xf bank_mask:0xf
  s_waitcnt vmcnt(0)
  v_pk_add_f16 v122, v128, v130
  v_mfma_f32_16x16x32_bf16 v[178:181], v[140:143], v[160:163], 0
  v_fma_mix_f32 v166, v120, 1.0, v122 op_sel:[0,0,0] op_sel_hi:[1,0,1]
  v_fma_mix_f32 v167, v120, 1.0, v122 op_sel:[1,0,1] op_sel_hi:[1,0,1]
  v_cmp_u_f32 vcc, v166, v170
  v_pk_add_f16 v123, v129, v131
  v_exp_f32 v172, v166
  v_mfma_f32_16x16x32_bf16 v[182:185], v[136:139], v[160:163], 0
  s_cbranch_vccnz sr_167
  v_exp_f32 v173, v167
  v_fma_mix_f32 v168, v121, 1.0, v123 op_sel:[0,0,0] op_sel_hi:[1,0,1]
  v_fma_mix_f32 v169, v121, 1.0, v123 op_sel:[1,0,1] op_sel_hi:[1,0,1]
  v_cvt_pk_bf16_f32 v156, v172, v173
  v_exp_f32 v174, v168
  v_exp_f32 v175, v169
  v_mov_b32_dpp v158, v156 row_ror:8 row_mask:0xf bank_mask:0xf
  v_cvt_pk_bf16_f32 v157, v174, v175
  v_mfma_f32_16x16x32_bf16 v[186:189], v[138:141], v[160:163], 0
  s_nop 0
  v_mov_b32_dpp v159, v157 row_ror:8 row_mask:0xf bank_mask:0xf
  s_nop 1
pv_168:
  v_mfma_f32_16x16x32_bf16 v[178:181], v[152:155], v[156:159], v[178:181]
  v_mfma_f32_16x16x32_bf16 v[182:185], v[144:147], v[156:159], v[182:185]
  v_mfma_f32_16x16x32_bf16 v[186:189], v[148:151], v[156:159], v[186:189]
  s_mov_b64 exec, s[62:63]
  s_nop 0
  v_rcp_f32 v164, v180
  v_cmp_ngt_f32 s[22:23], s80, v180
  v_cmp_ngt_f32 vcc, s80, v164
  v_pk_mul_f32 v[182:183], v[182:183], v[164:165] op_sel_hi:[1,0]
  v_pk_mul_f32 v[184:185], v[184:185], v[164:165] op_sel_hi:[1,0]
  v_pk_mul_f32 v[178:179], v[178:179], v[164:165] op_sel_hi:[1,0]
  v_pk_mul_f32 v[186:187], v[186:187], v[164:165] op_sel_hi:[1,0]
  v_pk_mul_f32 v[188:189], v[188:189], v[164:165] op_sel_hi:[1,0]
  v_cvt_pk_f16_f32 v64, v178, v179
  s_or_b64 vcc, vcc, s[22:23]
  s_cbranch_scc1 fx_170
fk_171:
  ds_write_b32 v14, v64
  v_cvt_pk_f16_f32 v60, v182, v183
  v_cvt_pk_f16_f32 v61, v184, v185
  v_cvt_pk_f16_f32 v62, v186, v187
  v_cvt_pk_f16_f32 v63, v188, v189
  ds_write_b128 v13, v[60:63]
  s_barrier
  s_mov_b64 exec, -1
  s_add_u32 m0, s74, 6144
  s_add_u32 s21, s79, 196608
  buffer_load_dwordx4 v4, s[16:19], s21 offen offset:1024 sc1 lds
  s_add_u32 m0, s74, 4096
  s_mul_i32 s21, s91, 2
  s_add_u32 s21, s21, s71
  buffer_load_dwordx4 v4, s[16:19], s21 offen sc1 lds
  s_xor_b32 s74, s74, 16384
  s_add_u32 s73, s73, 2097152
  s_xor_b32 s73, s73, 8192
  s_add_u32 s79, s79, 2097152
  s_xor_b32 s79, s79, 8192
  s_add_u32 s21, s72, 524288
  s_xor_b32 s72, s72, s21
  s_lshr_b32 s72, s72, 8
  s_and_b32 s72, s72, 8192
  s_xor_b32 s72, s72, s21
  s_add_u32 s71, s73, 4096
  s_mov_b32 s91, 1024
  s_sub_u32 s21, s73, 0
  s_cmp_lt_u32 s21, 125829120
  s_cselect_b32 s71, s71, s79
  s_cselect_b32 s91, s91, 65536
  v_permlane32_swap_b32 v96, v100
  v_permlane32_swap_b32 v97, v101
  v_permlane32_swap_b32 v98, v102
  v_permlane32_swap_b32 v99, v103
  v_pk_add_f32 v[96:97], v[96:97], v[100:101]
  v_pk_add_f32 v[98:99], v[98:99], v[102:103]
  v_cvt_pk_bf16_f32 v100, v96, v97
  v_cvt_pk_bf16_f32 v101, v98, v99
  s_nop 0
  v_permlane32_swap_b32 v100, v102
  v_permlane32_swap_b32 v101, v103
  v_min_u32 v100, -2, v100
  s_nop 6
  buffer_store_dwordx4 v[100:103], v26, s[16:19], s70 offen sc1
  v_min_u32 v108, -2, v108
  buffer_store_dwordx2 v[108:109], v37, s[16:19], s70 offen offset:3072 sc1
  s_add_u32 s70, s70, 2097152
  s_xor_b32 s70, s70, 8192
  ds_read_b128 v[144:147], v18
  ds_read_b128 v[148:151], v18 offset:1024
  ds_read_b128 v[152:155], v19
  ds_read_b128 v[112:115], v20
  ds_read_b64 v[116:117], v21
  v_xor_b32 v18, 16384, v18
  v_xor_b32 v19, 16384, v19
  v_xor_b32 v20, 16384, v20
  v_xor_b32 v21, 16384, v21
  v_mov_b32 v88, 0
  v_mov_b32 v89, 0
  v_mov_b32 v90, 0
  v_mov_b32 v91, 0
  v_mov_b32 v92, 0
  v_mov_b32 v93, 0
  v_mov_b32 v94, 0
  v_mov_b32 v95, 0
  v_mov_b32 v96, 0
  v_mov_b32 v97, 0
  v_mov_b32 v98, 0
  v_mov_b32 v99, 0
  v_mov_b32 v100, 0
  v_mov_b32 v101, 0
  v_mov_b32 v102, 0
  v_mov_b32 v103, 0
  s_mov_b32 s81, 0
  s_waitcnt lgkmcnt(0)
  s_barrier
  s_mov_b64 exec, s[64:65]
  buffer_store_dwordx2 v[28:29], v8, s[8:11], s57 offen sc1
  s_mov_b64 exec, -1
  ds_write_b128 v190, v[28:31] offset:0
  ds_write_b128 v190, v[28:31] offset:1024
  ds_write_b128 v190, v[28:31] offset:2048
  ds_write_b64 v6, v[28:29]
  s_mov_b64 exec, s[62:63]
  buffer_store_dword v28, v17, s[8:11], s59 offen sc1
  s_mov_b64 exec, -1
  s_sleep 3
  s_nop 1
  buffer_load_dwordx4 v[68:71], v16, s[4:7], s60 offen sc1
  s_sleep 3
  s_nop 1
  buffer_load_dwordx4 v[72:75], v16, s[4:7], s60 offen sc1
  s_waitcnt vmcnt(1)
  v_mfma_f32_16x16x32_f16 v[120:123], v[44:47], v[68:71], 0
  v_bitop3_b32 v27, v68, s61, 1 bitop3:0x28
  v_cmp_ne_u32 vcc, 0, v27
  s_nop 1
  s_cbranch_vccnz p2_176
  s_nop 2
pg_175:
  v_add_f32_dpp v120, v120, v120 row_ror:8 row_mask:0xf bank_mask:0xf
  v_add_f32_dpp v121, v121, v121 row_ror:8 row_mask:0xf bank_mask:0xf
  s_mov_b64 exec, s[62:63]
  v_cvt_pk_bf16_f32 v120, v120, v121
  v_min_u32 v120, -2, v120
  buffer_store_dword v120, v17, s[8:11], s55 offen sc1
  s_mov_b64 exec, -1
nt_172:
  s_barrier
  s_mov_b32 s58, s55
  s_add_u32 s52, s52, 1
  ds_write_b32 v13, v28
  ds_write_b32 v14, v28
  s_and_b32 s21, s52, 3
  s_mul_i32 s56, s21, 122880
  s_add_u32 s21, s52, 1
  s_and_b32 s21, s21, 3
  s_mul_i32 s55, s21, 122880
  s_add_u32 s55, s55, s75
  s_add_u32 s21, s52, 2
  s_and_b32 s21, s21, 3
  s_mul_i32 s57, s21, 122880
  s_add_u32 s21, s52, 3
  s_and_b32 s21, s21, 3
  s_mul_i32 s59, s21, 122880
  s_add_u32 s59, s59, s75
  s_bfe_u32 s61, s52, 0x10002
  s_and_b32 s21, s52, 3
  s_lshl_b32 s60, s21, 18
  s_mov_b32 s54, 0
  s_sleep 3
  s_waitcnt lgkmcnt(0)
  buffer_load_dwordx4 v[56:59], v190, s[8:11], s58 offen offset:0 sc1
  buffer_load_dwordx4 v[60:63], v190, s[8:11], s58 offen offset:1024 sc1
  buffer_load_dwordx4 v[64:67], v190, s[8:11], s58 offen offset:2048 sc1
  s_branch top_159
mr_160:
  s_mov_b64 exec, s[22:23]
  s_cbranch_execz ms_177
  buffer_load_dwordx4 v[56:59], v190, s[8:11], s58 offen offset:0 sc1
ms_177:
  s_mov_b64 exec, s[98:99]
  s_cbranch_execz ms_178
  buffer_load_dwordx4 v[60:63], v190, s[8:11], s58 offen offset:1024 sc1
ms_178:
  s_mov_b64 exec, s[100:101]
  s_cbranch_execz ms_179
  buffer_load_dwordx4 v[64:67], v190, s[8:11], s58 offen offset:2048 sc1
ms_179:
  s_add_u32 s54, s54, 1
  s_cmp_gt_u32 s54, 131072
  s_cbranch_scc1 end0
  s_waitcnt vmcnt(0)
  s_mov_b64 exec, s[22:23]
  ds_write_b128 v190, v[56:59] offset:0
  v_cmp_eq_u32 s[22:23], -1, v56
  s_mov_b64 exec, s[98:99]
  ds_write_b128 v190, v[60:63] offset:1024
  v_cmp_eq_u32 s[98:99], -1, v60
  s_mov_b64 exec, s[100:101]
  ds_write_b128 v190, v[64:67] offset:2048
  v_cmp_eq_u32 s[100:101], -1, v64
  s_mov_b64 exec, -1
  s_or_b64 vcc, s[22:23], s[98:99]
  s_or_b64 vcc, vcc, s[100:101]
  s_cbranch_scc1 mr_160
  s_branch mo_164
sf_165:
  s_waitcnt lgkmcnt(1)
  v_mfma_f32_16x16x32_bf16 v[120:123], v[112:115], v[104:107], 0
  s_waitcnt lgkmcnt(0)
  v_mfma_f32_16x16x32_bf16 v[120:123], v[116:119], v[108:111], v[120:123]
  s_mov_b64 exec, s[64:65]
  s_nop 6
  v_cvt_pk_f16_f32 v120, v120, v121
  v_cvt_pk_f16_f32 v121, v122, v123
  buffer_store_dwordx2 v[120:121], v8, s[8:11], s56 offen sc1
  s_mov_b64 exec, -1
  s_branch sf_166
mn_161:
  s_bitcmp1_b32 s81, 1
  s_cbranch_scc1 mk_162
  s_or_b32 s81, s81, 2
  s_nop 7
  v_mov_b32 v88, 0
  v_mov_b32 v89, 0
  v_mov_b32 v90, 0
  v_mov_b32 v91, 0
  v_mov_b32 v92, 0
  v_mov_b32 v93, 0
  v_mov_b32 v94, 0
  v_mov_b32 v95, 0
  v_mov_b32 v96, 0
  v_mov_b32 v97, 0
  v_mov_b32 v98, 0
  v_mov_b32 v99, 0
  v_mov_b32 v100, 0
  v_mov_b32 v101, 0
  v_mov_b32 v102, 0
  v_mov_b32 v103, 0
  s_cmp_eq_u32 s52, 0
  s_cbranch_scc1 mx_181
mx_180:
  buffer_load_dwordx4 v[56:59], v190, s[8:11], s58 offen offset:0 sc1
  buffer_load_dwordx4 v[60:63], v190, s[8:11], s58 offen offset:1024 sc1
  buffer_load_dwordx4 v[64:67], v190, s[8:11], s58 offen offset:2048 sc1
  s_add_u32 s54, s54, 1
  s_cmp_gt_u32 s54, 131072
  s_cbranch_scc1 end0
  s_waitcnt vmcnt(0)
  v_max3_u32 v27, v56, v57, v58
  v_max3_u32 v27, v27, v59, v60
  v_max3_u32 v27, v27, v61, v62
  v_max3_u32 v27, v27, v63, v64
  v_max3_u32 v27, v27, v65, v66
  v_max3_u32 v27, v27, v67, v67
  v_cmp_eq_u32 vcc, -1, v27
  s_nop 1
  s_cbranch_vccnz mx_180
  ds_write_b128 v190, v[56:59] offset:0
  ds_write_b128 v190, v[60:63] offset:1024
  ds_write_b128 v190, v[64:67] offset:2048
mx_181:
  s_waitcnt lgkmcnt(0)
  s_branch mo_164
sr_167:
  s_mov_b32 s54, 0
sr_182:
  s_mov_b64 exec, vcc
  buffer_load_dwordx4 v[124:127], v9, s[8:11], s56 offen sc1
  buffer_load_dwordx4 v[128:131], v9, s[8:11], s56 offen offset:1024 sc1
  buffer_load_dwordx4 v[132:135], v10, s[8:11], s56 offen sc1
  s_mov_b64 exec, -1
  s_add_u32 s54, s54, 1
  s_cmp_gt_u32 s54, 131072
  s_cbranch_scc1 end0
  s_waitcnt vmcnt(0)
  v_pk_add_f16 v164, v132, v133
  v_pk_add_f16 v165, v134, v135
  v_pk_add_f16 v120, v124, v126
  v_pk_add_f16 v122, v128, v130
  v_fma_mix_f32 v170, v164, 1.0, v165 op_sel:[0,0,0] op_sel_hi:[1,0,1]
  v_fma_mix_f32 v166, v120, 1.0, v122 op_sel:[0,0,0] op_sel_hi:[1,0,1]
  v_pk_add_f16 v121, v125, v127
  v_cmp_u_f32 vcc, v166, v170
  v_pk_add_f16 v123, v129, v131
  v_fma_mix_f32 v171, v164, 1.0, v165 op_sel:[1,0,1] op_sel_hi:[1,0,1]
  v_fma_mix_f32 v167, v120, 1.0, v122 op_sel:[1,0,1] op_sel_hi:[1,0,1]
  v_fma_mix_f32 v168, v121, 1.0, v123 op_sel:[0,0,0] op_sel_hi:[1,0,1]
  v_fma_mix_f32 v169, v121, 1.0, v123 op_sel:[1,0,1] op_sel_hi:[1,0,1]
  s_cbranch_vccz ex_169
  s_and_b32 s21, s54, 31
  s_cbranch_scc1 sr_182
  v_max3_u32 v27, v124, v126, v128
  v_max3_u32 v27, v27, v130, v132
  v_max3_u32 v27, v27, v133, v134
  v_max3_u32 v27, v27, v135, v135
  v_cmp_eq_u32 vcc, -1, v27
  s_nop 1
  s_cbranch_vccnz sr_182
ex_169:
  v_exp_f32 v176, v170
  v_exp_f32 v177, v171
  v_exp_f32 v172, v166
  v_cvt_pk_bf16_f32 v160, v176, v177
  v_exp_f32 v173, v167
  v_exp_f32 v174, v168
  v_mov_b32_dpp v161, v160 row_ror:8 row_mask:0xf bank_mask:0xf
  v_cvt_pk_bf16_f32 v156, v172, v173
  v_exp_f32 v175, v169
  v_mfma_f32_16x16x32_bf16 v[178:181], v[140:143], v[160:163], 0
  v_mov_b32_dpp v158, v156 row_ror:8 row_mask:0xf bank_mask:0xf
  v_cvt_pk_bf16_f32 v157, v174, v175
  v_mfma_f32_16x16x32_bf16 v[182:185], v[136:139], v[160:163], 0
  s_nop 0
  v_mov_b32_dpp v159, v157 row_ror:8 row_mask:0xf bank_mask:0xf
  v_mfma_f32_16x16x32_bf16 v[186:189], v[138:141], v[160:163], 0
  s_branch pv_168
fx_170:
  s_bitcmp1_b32 s81, 0
  s_cbranch_scc1 fk_171
  s_or_b32 s81, s81, 1
  s_mov_b64 exec, -1
  v_max3_f32 v164, v166, v167, v168
  v_max3_f32 v165, v169, v170, v171
  v_max_f32 v164, v164, v165
  s_nop 1
  v_max_f32_dpp v164, v164, v164 row_ror:8 row_mask:0xf bank_mask:0xf
  v_mov_b32 v165, v164
  s_nop 1
  v_permlane32_swap_b32 v164, v165
  v_max_f32 v164, v164, v165
  v_mov_b32 v165, v164
  s_nop 1
  v_permlane16_swap_b32 v164, v165
  v_max_f32 v164, v164, v165
  v_sub_f32 v166, v166, v164
  v_sub_f32 v167, v167, v164
  v_sub_f32 v168, v168, v164
  v_sub_f32 v169, v169, v164
  v_sub_f32 v170, v170, v164
  v_sub_f32 v171, v171, v164
  s_branch ex_169
p2_176:
  s_mov_b32 s54, 0
  buffer_load_dwordx4 v[68:71], v16, s[4:7], s60 offen sc1
  s_waitcnt vmcnt(1)
  v_mfma_f32_16x16x32_f16 v[120:123], v[44:47], v[72:75], 0
  v_bitop3_b32 v27, v72, s61, 1 bitop3:0x28
  v_cmp_ne_u32 vcc, 0, v27
  s_nop 1
  s_cbranch_vccz pg_175
  buffer_load_dwordx4 v[72:75], v16, s[4:7], s60 offen sc1
pp_174:
  s_waitcnt vmcnt(1)
  v_mfma_f32_16x16x32_f16 v[120:123], v[44:47], v[68:71], 0
  v_bitop3_b32 v27, v68, s61, 1 bitop3:0x28
  v_cmp_ne_u32 vcc, 0, v27
  s_nop 1
  s_cbranch_vccz pg_175
  buffer_load_dwordx4 v[68:71], v16, s[4:7], s60 offen sc1
  s_waitcnt vmcnt(1)
  v_mfma_f32_16x16x32_f16 v[120:123], v[44:47], v[72:75], 0
  v_bitop3_b32 v27, v72, s61, 1 bitop3:0x28
  v_cmp_ne_u32 vcc, 0, v27
  s_nop 1
  s_cbranch_vccz pg_175
  buffer_load_dwordx4 v[72:75], v16, s[4:7], s60 offen sc1
  s_add_u32 s54, s54, 1
  s_cmp_gt_u32 s54, 131072
  s_cbranch_scc1 end0
  s_branch pp_174
last_163:
  v_min_u32 v108, -2, v108
  buffer_store_dwordx2 v[108:109], v37, s[16:19], s70 offen offset:3072 sc1
  v_smfmac_f32_16x16x64_bf16 v[96:99], v[48:51], a[0:7], v22
  v_smfmac_f32_16x16x64_bf16 v[100:103], v[48:51], a[80:87], v22
  v_smfmac_f32_16x16x64_bf16 v[96:99], v[52:55], a[8:15], v22
  v_smfmac_f32_16x16x64_bf16 v[100:103], v[52:55], a[88:95], v22
  v_smfmac_f32_16x16x64_bf16 v[96:99], v[56:59], a[16:23], v22
  v_smfmac_f32_16x16x64_bf16 v[100:103], v[56:59], a[96:103], v22
  v_smfmac_f32_16x16x64_bf16 v[96:99], v[60:63], a[24:31], v22
  v_smfmac_f32_16x16x64_bf16 v[96:99], v[64:67], a[32:39], v22
  v_smfmac_f32_16x16x64_bf16 v[96:99], v[68:71], a[40:47], v22
  v_smfmac_f32_16x16x64_bf16 v[96:99], v[72:75], a[48:55], v22
  v_smfmac_f32_16x16x64_bf16 v[96:99], v[76:79], a[56:63], v22
  v_smfmac_f32_16x16x64_bf16 v[96:99], v[80:83], a[64:71], v22
  v_smfmac_f32_16x16x64_bf16 v[96:99], v[84:87], a[72:79], v22
  v_smfmac_f32_16x16x64_bf16 v[100:103], v[60:63], a[104:111], v22
  v_smfmac_f32_16x16x64_bf16 v[100:103], v[64:67], a[112:119], v22
  v_smfmac_f32_16x16x64_bf16 v[100:103], v[68:71], a[120:127], v22
  v_smfmac_f32_16x16x64_bf16 v[100:103], v[72:75], a[128:135], v22
  v_smfmac_f32_16x16x64_bf16 v[100:103], v[76:79], a[136:143], v22
  v_smfmac_f32_16x16x64_bf16 v[100:103], v[80:83], a[144:151], v22
  v_smfmac_f32_16x16x64_bf16 v[100:103], v[84:87], a[152:159], v22
  s_nop 7
  v_permlane32_swap_b32 v96, v100
  v_permlane32_swap_b32 v97, v101
  v_permlane32_swap_b32 v98, v102
  v_permlane32_swap_b32 v99, v103
  v_pk_add_f32 v[96:97], v[96:97], v[100:101]
  v_pk_add_f32 v[98:99], v[98:99], v[102:103]
  v_cvt_pk_bf16_f32 v100, v96, v97
  v_cvt_pk_bf16_f32 v101, v98, v99
  s_nop 0
  v_permlane32_swap_b32 v100, v102
  v_permlane32_swap_b32 v101, v103
  v_min_u32 v100, -2, v100
  buffer_store_dwordx4 v[100:103], v26, s[16:19], s70 offen sc1
  s_waitcnt vmcnt(0)
  s_barrier
  s_branch chain_done
E_29:
  v_add_u32 v190, 5120, v4
  ds_write_b64 v6, v[28:29]
  ds_write_b32 v13, v28
  ds_write_b32 v14, v28
  s_waitcnt vmcnt(0)
  ds_write_b128 v190, v[68:71] offset:0
  ds_write_b128 v190, v[72:75] offset:1024
  s_waitcnt lgkmcnt(0)
  s_add_u32 m0, s74, 8192
  s_add_u32 s21, s72, 0
  buffer_load_dwordx4 v32, s[16:19], s21 offen sc1 lds
  s_add_u32 m0, s74, 6144
  s_mul_i32 s21, s91, 3
  s_add_u32 s21, s21, s71
  buffer_load_dwordx4 v4, s[16:19], s21 offen sc1 lds
  s_xor_b32 s74, s74, 16384
  s_add_u32 s73, s73, 2097152
  s_xor_b32 s73, s73, 8192
  s_add_u32 s79, s79, 2097152
  s_xor_b32 s79, s79, 8192
  s_add_u32 s21, s72, 524288
  s_xor_b32 s72, s72, s21
  s_lshr_b32 s72, s72, 8
  s_and_b32 s72, s72, 8192
  s_xor_b32 s72, s72, s21
  s_add_u32 s71, s73, 4096
  s_mov_b32 s91, 1024
  s_sub_u32 s21, s73, 0
  s_cmp_lt_u32 s21, 125829120
  s_cselect_b32 s71, s71, s79
  s_cselect_b32 s91, s91, 65536
  s_branch mo_189
  .p2align 3
top_184:
  s_waitcnt vmcnt(1)
  ds_write_b128 v190, v[68:71] offset:0
  v_cmp_eq_u32 s[22:23], -1, v68
  s_waitcnt vmcnt(0)
  ds_write_b128 v190, v[72:75] offset:1024
  v_cmp_eq_u32 s[98:99], -1, v72
  s_or_b64 vcc, s[22:23], s[98:99]
  s_cbranch_scc1 mr_185
mo_189:
  s_barrier
  ds_read_b128 v[48:51], v4 offset:0
  ds_read_b128 v[52:55], v4 offset:1024
  v_smfmac_f32_16x16x64_bf16 v[92:95], v[68:71], v[216:223], v22
  ds_read_b128 v[56:59], v4 offset:2048
  v_smfmac_f32_16x16x64_bf16 v[88:91], v[68:71], a[200:207], v22
  ds_read_b128 v[60:63], v4 offset:3072
  v_smfmac_f32_16x16x64_bf16 v[92:95], v[72:75], v[224:231], v22
  ds_read_b128 v[64:67], v4 offset:4096
  v_smfmac_f32_16x16x64_bf16 v[88:91], v[72:75], a[208:215], v22
  s_waitcnt lgkmcnt(4)
  ds_read_b128 v[76:79], v4 offset:7168
  v_smfmac_f32_16x16x64_bf16 v[92:95], v[48:51], a[240:247], v22
  ds_read_b128 v[80:83], v4 offset:8192
  v_smfmac_f32_16x16x64_bf16 v[88:91], v[48:51], a[160:167], v22
  s_waitcnt lgkmcnt(5)
  ds_read_b128 v[84:87], v4 offset:9216
  v_smfmac_f32_16x16x64_bf16 v[92:95], v[52:55], a[248:255], v22
  v_smfmac_f32_16x16x64_bf16 v[88:91], v[52:55], a[168:175], v22
  s_waitcnt lgkmcnt(5)
  v_smfmac_f32_16x16x64_bf16 v[92:95], v[56:59], v[192:199], v22
  s_waitcnt lgkmcnt(4)
  v_smfmac_f32_16x16x64_bf16 v[92:95], v[60:63], v[200:207], v22
  s_waitcnt lgkmcnt(3)
  v_smfmac_f32_16x16x64_bf16 v[92:95], v[64:67], v[208:215], v22
  s_waitcnt lgkmcnt(2)
  v_smfmac_f32_16x16x64_bf16 v[92:95], v[76:79], v[232:239], v22
  s_waitcnt lgkmcnt(1)
  v_smfmac_f32_16x16x64_bf16 v[92:95], v[80:83], v[240:247], v22
  s_waitcnt lgkmcnt(0)
  v_smfmac_f32_16x16x64_bf16 v[92:95], v[84:87], v[248:255], v22
  v_smfmac_f32_16x16x64_bf16 v[88:91], v[56:59], a[176:183], v22
  v_smfmac_f32_16x16x64_bf16 v[88:91], v[60:63], a[184:191], v22
  v_smfmac_f32_16x16x64_bf16 v[88:91], v[64:67], a[192:199], v22
  v_permlane32_swap_b32 v92, v93
  v_smfmac_f32_16x16x64_bf16 v[88:91], v[76:79], a[216:223], v22
  v_permlane32_swap_b32 v94, v95
  v_smfmac_f32_16x16x64_bf16 v[88:91], v[80:83], a[224:231], v22
  v_permlane32_swap_b32 v93, v92
  v_smfmac_f32_16x16x64_bf16 v[88:91], v[84:87], a[232:239], v22
  v_permlane32_swap_b32 v95, v94
  v_pk_mul_f32 v[120:121], v[92:93], v[24:25] op_sel:[1,0] op_sel_hi:[0,1]
  v_pk_mul_f32 v[122:123], v[94:95], v[24:25] op_sel:[1,0] op_sel_hi:[0,1]
  s_nop 4
  v_pk_fma_f32 v[88:89], v[88:89], v[24:25], v[120:121]
  v_pk_fma_f32 v[90:91], v[90:91], v[24:25], v[122:123]
  v_cvt_pk_bf16_f32 v120, v88, v89
  v_cvt_pk_bf16_f32 v121, v90, v91
  ds_write_b64 v6, v[120:121]
  s_barrier
  ds_read_b64_tr_b16 v[104:105], v7 offset:0
  ds_read_b64_tr_b16 v[106:107], v7 offset:768
  ds_read_b64_tr_b16 v[108:109], v7 offset:1536
  s_waitcnt lgkmcnt(1)
  v_mfma_f32_16x16x32_bf16 v[120:123], v[104:107], v[104:107], 0
  s_waitcnt lgkmcnt(0)
  v_mfma_f32_16x16x32_bf16 v[120:123], v[108:111], v[108:111], v[120:123]
  s_mov_b64 exec, s[64:65]
  s_nop 6
  v_cmpx_o_f32 vcc, v120, v121
  v_cvt_pk_f16_f32 v120, v120, v121
  buffer_store_dword v120, v8, s[8:11], s56 offen sc1
  v_cmpx_o_f32 vcc, v122, v123
  v_cvt_pk_f16_f32 v121, v122, v123
  buffer_store_dword v121, v8, s[8:11], s56 offen offset:128 sc1
  s_xor_b64 s[98:99], exec, s[64:65]
  s_mov_b64 exec, -1
  s_waitcnt lgkmcnt(0)
  s_barrier
  ds_read_b64_tr_b16 v[104:105], v7 offset:0
  ds_read_b64_tr_b16 v[106:107], v7 offset:768
  ds_read_b64_tr_b16 v[108:109], v7 offset:1536
  ds_read_b32 v27, v12 offset:12544
  ds_read_b64 v[140:141], v11
  s_waitcnt lgkmcnt(1)
  v_cmp_u_f32 vcc, v104, v106
  v_cmp_u_f32 s[22:23], v108, v27
  s_nop 1
  s_or_b64 vcc, vcc, s[22:23]
  s_cbranch_vccnz mn_186
mk_187:
  s_cmp_eq_u32 s52, 63
  s_cbranch_scc1 last_188
  s_cmp_lg_u64 s[98:99], 0
  s_cbranch_scc1 sf_190
sf_191:
  s_nop 15
  s_nop 10
  v_smfmac_f32_16x16x64_bf16 v[96:99], v[48:51], a[0:7], v22
  v_smfmac_f32_16x16x64_bf16 v[100:103], v[48:51], a[80:87], v22
  v_smfmac_f32_16x16x64_bf16 v[96:99], v[52:55], a[8:15], v22
  v_smfmac_f32_16x16x64_bf16 v[100:103], v[52:55], a[88:95], v22
  v_smfmac_f32_16x16x64_bf16 v[96:99], v[56:59], a[16:23], v22
  v_smfmac_f32_16x16x64_bf16 v[100:103], v[56:59], a[96:103], v22
  buffer_load_dwordx4 v[132:135], v10, s[8:11], s56 offen sc1
  v_smfmac_f32_16x16x64_bf16 v[96:99], v[60:63], a[24:31], v22
  buffer_load_dwordx4 v[124:127], v9, s[8:11], s56 offen sc1
  v_smfmac_f32_16x16x64_bf16 v[96:99], v[64:67], a[32:39], v22
  buffer_load_dwordx4 v[128:131], v9, s[8:11], s56 offen offset:1024 sc1
  v_smfmac_f32_16x16x64_bf16 v[96:99], v[68:71], a[40:47], v22
  v_smfmac_f32_16x16x64_bf16 v[96:99], v[72:75], a[48:55], v22
  v_smfmac_f32_16x16x64_bf16 v[96:99], v[76:79], a[56:63], v22
  v_smfmac_f32_16x16x64_bf16 v[96:99], v[80:83], a[64:71], v22
  v_smfmac_f32_16x16x64_bf16 v[96:99], v[84:87], a[72:79], v22
  v_smfmac_f32_16x16x64_bf16 v[100:103], v[60:63], a[104:111], v22
  v_smfmac_f32_16x16x64_bf16 v[100:103], v[64:67], a[112:119], v22
  v_smfmac_f32_16x16x64_bf16 v[100:103], v[68:71], a[120:127], v22
  v_smfmac_f32_16x16x64_bf16 v[100:103], v[72:75], a[128:135], v22
  v_cvt_pk_bf16_f32 v136, v96, v97
  v_smfmac_f32_16x16x64_bf16 v[100:103], v[76:79], a[136:143], v22
  v_cvt_pk_bf16_f32 v137, v98, v99
  v_smfmac_f32_16x16x64_bf16 v[100:103], v[80:83], a[144:151], v22
  v_smfmac_f32_16x16x64_bf16 v[100:103], v[84:87], a[152:159], v22
  s_nop 7
  v_cvt_pk_bf16_f32 v138, v100, v101
  v_cvt_pk_bf16_f32 v139, v102, v103
  s_waitcnt vmcnt(2) lgkmcnt(0)
  v_pk_add_f16 v164, v132, v133
  v_pk_add_f16 v165, v134, v135
  v_fma_mix_f32 v170, v164, 1.0, v165 op_sel:[0,0,0] op_sel_hi:[1,0,1]
  v_fma_mix_f32 v171, v164, 1.0, v165 op_sel:[1,0,1] op_sel_hi:[1,0,1]
  v_exp_f32 v176, v170
  v_exp_f32 v177, v171
  s_waitcnt vmcnt(1)
  v_cvt_pk_bf16_f32 v160, v176, v177
  v_pk_add_f16 v120, v124, v126
  v_pk_add_f16 v121, v125, v127
  v_mov_b32_dpp v161, v160 row_ror:8 row_mask:0xf bank_mask:0xf
  s_waitcnt vmcnt(0)
  v_pk_add_f16 v122, v128, v130
  v_mfma_f32_16x16x32_bf16 v[178:181], v[140:143], v[160:163], 0
  v_fma_mix_f32 v166, v120, 1.0, v122 op_sel:[0,0,0] op_sel_hi:[1,0,1]
  v_fma_mix_f32 v167, v120, 1.0, v122 op_sel:[1,0,1] op_sel_hi:[1,0,1]
  v_cmp_u_f32 vcc, v166, v170
  v_pk_add_f16 v123, v129, v131
  v_exp_f32 v172, v166
  v_mfma_f32_16x16x32_bf16 v[182:185], v[136:139], v[160:163], 0
  s_cbranch_vccnz sr_192
  v_exp_f32 v173, v167
  v_fma_mix_f32 v168, v121, 1.0, v123 op_sel:[0,0,0] op_sel_hi:[1,0,1]
  v_fma_mix_f32 v169, v121, 1.0, v123 op_sel:[1,0,1] op_sel_hi:[1,0,1]
  v_cvt_pk_bf16_f32 v156, v172, v173
  v_exp_f32 v174, v168
  v_exp_f32 v175, v169
  v_mov_b32_dpp v158, v156 row_ror:8 row_mask:0xf bank_mask:0xf
  v_cvt_pk_bf16_f32 v157, v174, v175
  v_mfma_f32_16x16x32_bf16 v[186:189], v[138:141], v[160:163], 0
  s_nop 0
  v_mov_b32_dpp v159, v157 row_ror:8 row_mask:0xf bank_mask:0xf
  s_nop 1
pv_193:
  v_mfma_f32_16x16x32_bf16 v[178:181], v[152:155], v[156:159], v[178:181]
  v_mfma_f32_16x16x32_bf16 v[182:185], v[144:147], v[156:159], v[182:185]
  v_mfma_f32_16x16x32_bf16 v[186:189], v[148:151], v[156:159], v[186:189]
  s_mov_b64 exec, s[62:63]
  s_nop 0
  v_rcp_f32 v164, v180
  v_cmp_ngt_f32 s[22:23], s80, v180
  v_cmp_ngt_f32 vcc, s80, v164
  v_pk_mul_f32 v[182:183], v[182:183], v[164:165] op_sel_hi:[1,0]
  v_pk_mul_f32 v[184:185], v[184:185], v[164:165] op_sel_hi:[1,0]
  v_pk_mul_f32 v[178:179], v[178:179], v[164:165] op_sel_hi:[1,0]
  v_pk_mul_f32 v[186:187], v[186:187], v[164:165] op_sel_hi:[1,0]
  v_pk_mul_f32 v[188:189], v[188:189], v[164:165] op_sel_hi:[1,0]
  v_cvt_pk_f16_f32 v64, v178, v179
  s_or_b64 vcc, vcc, s[22:23]
  s_cbranch_scc1 fx_195
fk_196:
  ds_write_b32 v14, v64
  v_cvt_pk_f16_f32 v60, v182, v183
  v_cvt_pk_f16_f32 v61, v184, v185
  v_cvt_pk_f16_f32 v62, v186, v187
  v_cvt_pk_f16_f32 v63, v188, v189
  ds_write_b128 v13, v[60:63]
  s_barrier
  s_mov_b64 exec, -1
  s_add_u32 m0, s74, 8192
  s_add_u32 s21, s72, 0
  buffer_load_dwordx4 v32, s[16:19], s21 offen sc1 lds
  s_add_u32 m0, s74, 6144
  s_mul_i32 s21, s91, 3
  s_add_u32 s21, s21, s71
  buffer_load_dwordx4 v4, s[16:19], s21 offen sc1 lds
  s_xor_b32 s74, s74, 16384
  s_add_u32 s73, s73, 2097152
  s_xor_b32 s73, s73, 8192
  s_add_u32 s79, s79, 2097152
  s_xor_b32 s79, s79, 8192
  s_add_u32 s21, s72, 524288
  s_xor_b32 s72, s72, s21
  s_lshr_b32 s72, s72, 8
  s_and_b32 s72, s72, 8192
  s_xor_b32 s72, s72, s21
  s_add_u32 s71, s73, 4096
  s_mov_b32 s91, 1024
  s_sub_u32 s21, s73, 0
  s_cmp_lt_u32 s21, 125829120
  s_cselect_b32 s71, s71, s79
  s_cselect_b32 s91, s91, 65536
  v_permlane32_swap_b32 v96, v100
  v_permlane32_swap_b32 v97, v101
  v_permlane32_swap_b32 v98, v102
  v_permlane32_swap_b32 v99, v103
  v_pk_add_f32 v[96:97], v[96:97], v[100:101]
  v_pk_add_f32 v[98:99], v[98:99], v[102:103]
  v_cvt_pk_bf16_f32 v100, v96, v97
  v_cvt_pk_bf16_f32 v101, v98, v99
  s_nop 0
  v_permlane32_swap_b32 v100, v102
  v_permlane32_swap_b32 v101, v103
  v_min_u32 v100, -2, v100
  s_nop 6
  buffer_store_dwordx4 v[100:103], v26, s[16:19], s70 offen sc1
  s_add_u32 s70, s70, 2097152
  s_xor_b32 s70, s70, 8192
  ds_read_b128 v[144:147], v18
  ds_read_b128 v[148:151], v18 offset:1024
  ds_read_b128 v[152:155], v19
  v_xor_b32 v18, 16384, v18
  v_xor_b32 v19, 16384, v19
  v_mov_b32 v88, 0
  v_mov_b32 v89, 0
  v_mov_b32 v90, 0
  v_mov_b32 v91, 0
  v_mov_b32 v92, 0
  v_mov_b32 v93, 0
  v_mov_b32 v94, 0
  v_mov_b32 v95, 0
  v_mov_b32 v96, 0
  v_mov_b32 v97, 0
  v_mov_b32 v98, 0
  v_mov_b32 v99, 0
  v_mov_b32 v100, 0
  v_mov_b32 v101, 0
  v_mov_b32 v102, 0
  v_mov_b32 v103, 0
  s_mov_b32 s81, 0
  s_waitcnt lgkmcnt(0)
  s_barrier
  s_mov_b64 exec, s[64:65]
  buffer_store_dword v28, v8, s[8:11], s57 offen sc1
  buffer_store_dword v28, v8, s[8:11], s57 offen offset:128 sc1
  s_mov_b64 exec, -1
  ds_write_b128 v190, v[28:31] offset:0
  ds_write_b128 v190, v[28:31] offset:1024
  ds_write_b64 v6, v[28:29]
  s_mov_b64 exec, -1
  s_cmp_eq_u32 s78, 0
  s_cbranch_scc1 nt_198
  s_mov_b64 exec, s[62:63]
  buffer_store_dword v28, v17, s[8:11], s59 offen sc1
  s_mov_b64 exec, -1
  s_sleep 3
  s_nop 1
  buffer_load_dwordx4 v[68:71], v16, s[4:7], s60 offen sc1
  s_sleep 3
  s_nop 1
  buffer_load_dwordx4 v[72:75], v16, s[4:7], s60 offen sc1
  s_waitcnt vmcnt(1)
  v_mfma_f32_16x16x32_f16 v[120:123], v[44:47], v[68:71], 0
  v_bitop3_b32 v27, v68, s61, 1 bitop3:0x28
  v_cmp_ne_u32 vcc, 0, v27
  s_nop 1
  s_cbranch_vccnz p2_201
  s_nop 2
pg_200:
  v_add_f32_dpp v120, v120, v120 row_ror:8 row_mask:0xf bank_mask:0xf
  v_add_f32_dpp v121, v121, v121 row_ror:8 row_mask:0xf bank_mask:0xf
  s_mov_b64 exec, s[62:63]
  v_cvt_pk_bf16_f32 v120, v120, v121
  v_min_u32 v120, -2, v120
  buffer_store_dword v120, v17, s[8:11], s55 offen sc1
  s_mov_b64 exec, -1
nt_197:
  s_barrier
  s_mov_b32 s58, s55
  s_add_u32 s52, s52, 1
  ds_write_b32 v13, v28
  ds_write_b32 v14, v28
  s_and_b32 s21, s52, 3
  s_mul_i32 s56, s21, 122880
  s_add_u32 s21, s52, 1
  s_and_b32 s21, s21, 3
  s_mul_i32 s55, s21, 122880
  s_add_u32 s55, s55, s75
  s_add_u32 s21, s52, 2
  s_and_b32 s21, s21, 3
  s_mul_i32 s57, s21, 122880
  s_add_u32 s21, s52, 3
  s_and_b32 s21, s21, 3
  s_mul_i32 s59, s21, 122880
  s_add_u32 s59, s59, s75
  s_bfe_u32 s61, s52, 0x10002
  s_and_b32 s21, s52, 3
  s_lshl_b32 s60, s21, 18
  s_mov_b32 s54, 0
  s_sleep 3
  s_waitcnt lgkmcnt(0)
  buffer_load_dwordx4 v[68:71], v190, s[8:11], s58 offen offset:0 sc1
  buffer_load_dwordx4 v[72:75], v190, s[8:11], s58 offen offset:1024 sc1
  s_branch top_184
mr_185:
  s_mov_b64 exec, s[22:23]
  s_cbranch_execz ms_202
  buffer_load_dwordx4 v[68:71], v190, s[8:11], s58 offen offset:0 sc1
ms_202:
  s_mov_b64 exec, s[98:99]
  s_cbranch_execz ms_203
  buffer_load_dwordx4 v[72:75], v190, s[8:11], s58 offen offset:1024 sc1
ms_203:
  s_add_u32 s54, s54, 1
  s_cmp_gt_u32 s54, 131072
  s_cbranch_scc1 end0
  s_waitcnt vmcnt(0)
  s_mov_b64 exec, s[22:23]
  ds_write_b128 v190, v[68:71] offset:0
  v_cmp_eq_u32 s[22:23], -1, v68
  s_mov_b64 exec, s[98:99]
  ds_write_b128 v190, v[72:75] offset:1024
  v_cmp_eq_u32 s[98:99], -1, v72
  s_mov_b64 exec, -1
  s_or_b64 vcc, s[22:23], s[98:99]
  s_cbranch_scc1 mr_185
  s_branch mo_189
sf_190:
  s_waitcnt lgkmcnt(1)
  v_mfma_f32_16x16x32_bf16 v[120:123], v[104:107], v[104:107], 0
  s_waitcnt lgkmcnt(0)
  v_mfma_f32_16x16x32_bf16 v[120:123], v[108:111], v[108:111], v[120:123]
  s_mov_b64 exec, s[64:65]
  s_nop 6
  v_cvt_pk_f16_f32 v120, v120, v121
  buffer_store_dword v120, v8, s[8:11], s56 offen sc1
  v_cvt_pk_f16_f32 v121, v122, v123
  buffer_store_dword v121, v8, s[8:11], s56 offen offset:128 sc1
  s_mov_b64 exec, -1
  s_branch sf_191
mn_186:
  s_bitcmp1_b32 s81, 1
  s_cbranch_scc1 mk_187
  s_or_b32 s81, s81, 2
  s_nop 7
  v_mov_b32 v88, 0
  v_mov_b32 v89, 0
  v_mov_b32 v90, 0
  v_mov_b32 v91, 0
  v_mov_b32 v92, 0
  v_mov_b32 v93, 0
  v_mov_b32 v94, 0
  v_mov_b32 v95, 0
  v_mov_b32 v96, 0
  v_mov_b32 v97, 0
  v_mov_b32 v98, 0
  v_mov_b32 v99, 0
  v_mov_b32 v100, 0
  v_mov_b32 v101, 0
  v_mov_b32 v102, 0
  v_mov_b32 v103, 0
  s_cmp_eq_u32 s52, 0
  s_cbranch_scc1 mx_205
mx_204:
  buffer_load_dwordx4 v[68:71], v190, s[8:11], s58 offen offset:0 sc1
  buffer_load_dwordx4 v[72:75], v190, s[8:11], s58 offen offset:1024 sc1
  s_add_u32 s54, s54, 1
  s_cmp_gt_u32 s54, 131072
  s_cbranch_scc1 end0
  s_waitcnt vmcnt(0)
  v_max3_u32 v27, v68, v69, v70
  v_max3_u32 v27, v27, v71, v72
  v_max3_u32 v27, v27, v73, v74
  v_max3_u32 v27, v27, v75, v75
  v_cmp_eq_u32 vcc, -1, v27
  s_nop 1
  s_cbranch_vccnz mx_204
  ds_write_b128 v190, v[68:71] offset:0
  ds_write_b128 v190, v[72:75] offset:1024
mx_205:
  s_waitcnt lgkmcnt(0)
  s_branch mo_189
sr_192:
  s_mov_b32 s54, 0
sr_206:
  s_mov_b64 exec, vcc
  buffer_load_dwordx4 v[124:127], v9, s[8:11], s56 offen sc1
  buffer_load_dwordx4 v[128:131], v9, s[8:11], s56 offen offset:1024 sc1
  buffer_load_dwordx4 v[132:135], v10, s[8:11], s56 offen sc1
  s_mov_b64 exec, -1
  s_add_u32 s54, s54, 1
  s_cmp_gt_u32 s54, 131072
  s_cbranch_scc1 end0
  s_waitcnt vmcnt(0)
  v_pk_add_f16 v164, v132, v133
  v_pk_add_f16 v165, v134, v135
  v_pk_add_f16 v120, v124, v126
  v_pk_add_f16 v122, v128, v130
  v_fma_mix_f32 v170, v164, 1.0, v165 op_sel:[0,0,0] op_sel_hi:[1,0,1]
  v_fma_mix_f32 v166, v120, 1.0, v122 op_sel:[0,0,0] op_sel_hi:[1,0,1]
  v_pk_add_f16 v121, v125, v127
  v_cmp_u_f32 vcc, v166, v170
  v_pk_add_f16 v123, v129, v131
  v_fma_mix_f32 v171, v164, 1.0, v165 op_sel:[1,0,1] op_sel_hi:[1,0,1]
  v_fma_mix_f32 v167, v120, 1.0, v122 op_sel:[1,0,1] op_sel_hi:[1,0,1]
  v_fma_mix_f32 v168, v121, 1.0, v123 op_sel:[0,0,0] op_sel_hi:[1,0,1]
  v_fma_mix_f32 v169, v121, 1.0, v123 op_sel:[1,0,1] op_sel_hi:[1,0,1]
  s_cbranch_vccz ex_194
  s_and_b32 s21, s54, 31
  s_cbranch_scc1 sr_206
  v_max3_u32 v27, v124, v126, v128
  v_max3_u32 v27, v27, v130, v132
  v_max3_u32 v27, v27, v133, v134
  v_max3_u32 v27, v27, v135, v135
  v_cmp_eq_u32 vcc, -1, v27
  s_nop 1
  s_cbranch_vccnz sr_206
ex_194:
  v_exp_f32 v176, v170
  v_exp_f32 v177, v171
  v_exp_f32 v172, v166
  v_cvt_pk_bf16_f32 v160, v176, v177
  v_exp_f32 v173, v167
  v_exp_f32 v174, v168
  v_mov_b32_dpp v161, v160 row_ror:8 row_mask:0xf bank_mask:0xf
  v_cvt_pk_bf16_f32 v156, v172, v173
  v_exp_f32 v175, v169
  v_mfma_f32_16x16x32_bf16 v[178:181], v[140:143], v[160:163], 0
  v_mov_b32_dpp v158, v156 row_ror:8 row_mask:0xf bank_mask:0xf
  v_cvt_pk_bf16_f32 v157, v174, v175
  v_mfma_f32_16x16x32_bf16 v[182:185], v[136:139], v[160:163], 0
  s_nop 0
  v_mov_b32_dpp v159, v157 row_ror:8 row_mask:0xf bank_mask:0xf
  v_mfma_f32_16x16x32_bf16 v[186:189], v[138:141], v[160:163], 0
  s_branch pv_193
fx_195:
  s_bitcmp1_b32 s81, 0
  s_cbranch_scc1 fk_196
  s_or_b32 s81, s81, 1
  s_mov_b64 exec, -1
  v_max3_f32 v164, v166, v167, v168
  v_max3_f32 v165, v169, v170, v171
  v_max_f32 v164, v164, v165
  s_nop 1
  v_max_f32_dpp v164, v164, v164 row_ror:8 row_mask:0xf bank_mask:0xf
  v_mov_b32 v165, v164
  s_nop 1
  v_permlane32_swap_b32 v164, v165
  v_max_f32 v164, v164, v165
  v_mov_b32 v165, v164
  s_nop 1
  v_permlane16_swap_b32 v164, v165
  v_max_f32 v164, v164, v165
  v_sub_f32 v166, v166, v164
  v_sub_f32 v167, v167, v164
  v_sub_f32 v168, v168, v164
  v_sub_f32 v169, v169, v164
  v_sub_f32 v170, v170, v164
  v_sub_f32 v171, v171, v164
  s_branch ex_194
nt_198:
  s_branch nt_197
p2_201:
  s_mov_b32 s54, 0
  buffer_load_dwordx4 v[68:71], v16, s[4:7], s60 offen sc1
  s_waitcnt vmcnt(1)
  v_mfma_f32_16x16x32_f16 v[120:123], v[44:47], v[72:75], 0
  v_bitop3_b32 v27, v72, s61, 1 bitop3:0x28
  v_cmp_ne_u32 vcc, 0, v27
  s_nop 1
  s_cbranch_vccz pg_200
  buffer_load_dwordx4 v[72:75], v16, s[4:7], s60 offen sc1
pp_199:
  s_waitcnt vmcnt(1)
  v_mfma_f32_16x16x32_f16 v[120:123], v[44:47], v[68:71], 0
  v_bitop3_b32 v27, v68, s61, 1 bitop3:0x28
  v_cmp_ne_u32 vcc, 0, v27
  s_nop 1
  s_cbranch_vccz pg_200
  buffer_load_dwordx4 v[68:71], v16, s[4:7], s60 offen sc1
  s_waitcnt vmcnt(1)
  v_mfma_f32_16x16x32_f16 v[120:123], v[44:47], v[72:75], 0
  v_bitop3_b32 v27, v72, s61, 1 bitop3:0x28
  v_cmp_ne_u32 vcc, 0, v27
  s_nop 1
  s_cbranch_vccz pg_200
  buffer_load_dwordx4 v[72:75], v16, s[4:7], s60 offen sc1
  s_add_u32 s54, s54, 1
  s_cmp_gt_u32 s54, 131072
  s_cbranch_scc1 end0
  s_branch pp_199
last_188:
  v_smfmac_f32_16x16x64_bf16 v[96:99], v[48:51], a[0:7], v22
  v_smfmac_f32_16x16x64_bf16 v[100:103], v[48:51], a[80:87], v22
  v_smfmac_f32_16x16x64_bf16 v[96:99], v[52:55], a[8:15], v22
  v_smfmac_f32_16x16x64_bf16 v[100:103], v[52:55], a[88:95], v22
  v_smfmac_f32_16x16x64_bf16 v[96:99], v[56:59], a[16:23], v22
  v_smfmac_f32_16x16x64_bf16 v[100:103], v[56:59], a[96:103], v22
  v_smfmac_f32_16x16x64_bf16 v[96:99], v[60:63], a[24:31], v22
  v_smfmac_f32_16x16x64_bf16 v[96:99], v[64:67], a[32:39], v22
  v_smfmac_f32_16x16x64_bf16 v[96:99], v[68:71], a[40:47], v22
  v_smfmac_f32_16x16x64_bf16 v[96:99], v[72:75], a[48:55], v22
  v_smfmac_f32_16x16x64_bf16 v[96:99], v[76:79], a[56:63], v22
  v_smfmac_f32_16x16x64_bf16 v[96:99], v[80:83], a[64:71], v22
  v_smfmac_f32_16x16x64_bf16 v[96:99], v[84:87], a[72:79], v22
  v_smfmac_f32_16x16x64_bf16 v[100:103], v[60:63], a[104:111], v22
  v_smfmac_f32_16x16x64_bf16 v[100:103], v[64:67], a[112:119], v22
  v_smfmac_f32_16x16x64_bf16 v[100:103], v[68:71], a[120:127], v22
  v_smfmac_f32_16x16x64_bf16 v[100:103], v[72:75], a[128:135], v22
  v_smfmac_f32_16x16x64_bf16 v[100:103], v[76:79], a[136:143], v22
  v_smfmac_f32_16x16x64_bf16 v[100:103], v[80:83], a[144:151], v22
  v_smfmac_f32_16x16x64_bf16 v[100:103], v[84:87], a[152:159], v22
  s_nop 7
  v_permlane32_swap_b32 v96, v100
  v_permlane32_swap_b32 v97, v101
  v_permlane32_swap_b32 v98, v102
  v_permlane32_swap_b32 v99, v103
  v_pk_add_f32 v[96:97], v[96:97], v[100:101]
  v_pk_add_f32 v[98:99], v[98:99], v[102:103]
  v_cvt_pk_bf16_f32 v100, v96, v97
  v_cvt_pk_bf16_f32 v101, v98, v99
  s_nop 0
  v_permlane32_swap_b32 v100, v102
  v_permlane32_swap_b32 v101, v103
  v_min_u32 v100, -2, v100
  buffer_store_dwordx4 v[100:103], v26, s[16:19], s70 offen sc1
  s_waitcnt vmcnt(0)
  s_barrier
  s_branch chain_done
E_31:
  v_add_u32 v190, 7168, v4
  ds_write_b32 v13, v28
  ds_write_b32 v14, v28
  s_waitcnt vmcnt(0)
  ds_write_b128 v190, v[76:79] offset:0
  ds_write_b128 v190, v[80:83] offset:1024
  ds_write_b128 v190, v[84:87] offset:2048
  s_waitcnt lgkmcnt(0)
  s_branch mo_213
  .p2align 3
top_208:
  s_waitcnt vmcnt(2)
  ds_write_b128 v190, v[76:79] offset:0
  v_cmp_eq_u32 s[22:23], -1, v76
  s_waitcnt vmcnt(1)
  ds_write_b128 v190, v[80:83] offset:1024
  v_cmp_eq_u32 s[98:99], -1, v80
  s_waitcnt vmcnt(0)
  ds_write_b128 v190, v[84:87] offset:2048
  v_cmp_eq_u32 s[100:101], -1, v84
  s_or_b64 vcc, s[22:23], s[98:99]
  s_or_b64 vcc, vcc, s[100:101]
  s_cbranch_scc1 mr_209
mo_213:
  s_barrier
  ds_read_b128 v[48:51], v4 offset:0
  ds_read_b128 v[52:55], v4 offset:1024
  v_smfmac_f32_16x16x64_bf16 v[92:95], v[76:79], v[232:239], v22
  ds_read_b128 v[56:59], v4 offset:2048
  ds_read_b128 v[60:63], v4 offset:3072
  v_smfmac_f32_16x16x64_bf16 v[88:91], v[76:79], a[216:223], v22
  s_add_u32 m0, s74, 0
  s_add_u32 s21, s79, 0
  buffer_load_dwordx4 v4, s[16:19], s21 offen offset:1024 sc1 lds
  v_smfmac_f32_16x16x64_bf16 v[92:95], v[80:83], v[240:247], v22
  ds_read_b128 v[64:67], v4 offset:4096
  ds_read_b128 v[68:71], v4 offset:5120
  s_add_u32 s22, s52, 3
  s_min_u32 s22, s22, 64
  v_smfmac_f32_16x16x64_bf16 v[88:91], v[80:83], a[224:231], v22
  s_add_u32 m0, s74, 2048
  s_add_u32 s21, s79, 65536
  buffer_load_dwordx4 v4, s[16:19], s21 offen offset:1024 sc1 lds
  v_cmp_gt_u32 vcc, s22, v42
  v_smfmac_f32_16x16x64_bf16 v[92:95], v[84:87], v[248:255], v22
  ds_read_b128 v[72:75], v4 offset:6144
  s_cbranch_vccnz kw_214
kv_215:
  v_smfmac_f32_16x16x64_bf16 v[88:91], v[84:87], a[232:239], v22
  s_waitcnt lgkmcnt(6)
  s_add_u32 m0, s74, 10240
  s_nop 0
  buffer_load_dwordx4 v4, s[16:19], s73 offen offset:0 sc1 lds
  v_smfmac_f32_16x16x64_bf16 v[92:95], v[48:51], a[240:247], v22
  v_smfmac_f32_16x16x64_bf16 v[88:91], v[48:51], a[160:167], v22
  s_waitcnt lgkmcnt(5)
  s_add_u32 m0, s74, 10240
  s_nop 0
  buffer_load_dwordx4 v4, s[16:19], s73 offen offset:1024 sc1 lds
  v_smfmac_f32_16x16x64_bf16 v[92:95], v[52:55], a[248:255], v22
  s_waitcnt lgkmcnt(4)
  v_smfmac_f32_16x16x64_bf16 v[92:95], v[56:59], v[192:199], v22
  s_waitcnt lgkmcnt(3)
  s_add_u32 m0, s74, 10240
  s_nop 0
  buffer_load_dwordx4 v4, s[16:19], s73 offen offset:2048 sc1 lds
  v_smfmac_f32_16x16x64_bf16 v[92:95], v[60:63], v[200:207], v22
  s_waitcnt lgkmcnt(2)
  v_smfmac_f32_16x16x64_bf16 v[92:95], v[64:67], v[208:215], v22
  s_waitcnt lgkmcnt(1)
  s_add_u32 m0, s74, 0
  s_mul_i32 s21, s91, 0
  s_add_u32 s21, s21, s71
  buffer_load_dwordx4 v4, s[16:19], s21 offen sc1 lds
  v_smfmac_f32_16x16x64_bf16 v[92:95], v[68:71], v[216:223], v22
  s_waitcnt lgkmcnt(0)
  v_smfmac_f32_16x16x64_bf16 v[92:95], v[72:75], v[224:231], v22
  s_add_u32 m0, s74, 2048
  s_mul_i32 s21, s91, 1
  s_add_u32 s21, s21, s71
  buffer_load_dwordx4 v4, s[16:19], s21 offen sc1 lds
  v_smfmac_f32_16x16x64_bf16 v[88:91], v[52:55], a[168:175], v22
  v_smfmac_f32_16x16x64_bf16 v[88:91], v[56:59], a[176:183], v22
  v_smfmac_f32_16x16x64_bf16 v[88:91], v[60:63], a[184:191], v22
  v_cvt_pk_bf16_f32 v122, v92, v93
  v_smfmac_f32_16x16x64_bf16 v[88:91], v[64:67], a[192:199], v22
  v_cvt_pk_bf16_f32 v123, v94, v95
  s_barrier
  v_smfmac_f32_16x16x64_bf16 v[88:91], v[68:71], a[200:207], v22
  ds_write_b64 v12, v[122:123] offset:13056
  v_smfmac_f32_16x16x64_bf16 v[88:91], v[72:75], a[208:215], v22
  v_smfmac_f32_16x16x64_bf16 v[96:99], v[48:51], a[0:7], v22
  v_smfmac_f32_16x16x64_bf16 v[100:103], v[48:51], a[80:87], v22
  v_smfmac_f32_16x16x64_bf16 v[96:99], v[52:55], a[8:15], v22
  v_cvt_pk_bf16_f32 v120, v88, v89
  v_cvt_pk_bf16_f32 v121, v90, v91
  ds_write_b64 v12, v[120:121] offset:12544
  v_smfmac_f32_16x16x64_bf16 v[100:103], v[52:55], a[88:95], v22
  s_waitcnt lgkmcnt(0)
  s_barrier
  ds_read_b64_tr_b16 v[104:105], v7 offset:0
  ds_read_b64_tr_b16 v[106:107], v7 offset:768
  ds_read_b64_tr_b16 v[108:109], v7 offset:1536
  ds_read_b32 v27, v12 offset:12544
  ds_read_b64 v[140:141], v11
  s_waitcnt lgkmcnt(1)
  v_cmp_u_f32 vcc, v104, v106
  v_cmp_u_f32 s[22:23], v108, v27
  s_nop 1
  s_or_b64 vcc, vcc, s[22:23]
  s_cbranch_vccnz mn_210
mk_211:
  s_cmp_eq_u32 s52, 63
  s_cbranch_scc1 last_212
  v_permlane32_swap_b32 v88, v92
  v_permlane32_swap_b32 v89, v93
  v_permlane32_swap_b32 v90, v94
  v_permlane32_swap_b32 v91, v95
  v_pk_add_f32 v[88:89], v[88:89], v[92:93]
  v_pk_add_f32 v[90:91], v[90:91], v[94:95]
  v_cvt_pk_bf16_f32 v92, v88, v89
  v_cvt_pk_bf16_f32 v93, v90, v91
  v_min_u32 v92, -2, v92
  s_nop 0
  v_smfmac_f32_16x16x64_bf16 v[96:99], v[56:59], a[16:23], v22
  v_smfmac_f32_16x16x64_bf16 v[100:103], v[56:59], a[96:103], v22
  v_smfmac_f32_16x16x64_bf16 v[96:99], v[60:63], a[24:31], v22
  v_smfmac_f32_16x16x64_bf16 v[96:99], v[64:67], a[32:39], v22
  v_smfmac_f32_16x16x64_bf16 v[96:99], v[68:71], a[40:47], v22
  v_smfmac_f32_16x16x64_bf16 v[96:99], v[72:75], a[48:55], v22
  v_smfmac_f32_16x16x64_bf16 v[96:99], v[76:79], a[56:63], v22
  v_smfmac_f32_16x16x64_bf16 v[96:99], v[80:83], a[64:71], v22
  v_smfmac_f32_16x16x64_bf16 v[96:99], v[84:87], a[72:79], v22
  v_smfmac_f32_16x16x64_bf16 v[100:103], v[60:63], a[104:111], v22
  buffer_load_dwordx4 v[132:135], v10, s[8:11], s56 offen sc1
  v_smfmac_f32_16x16x64_bf16 v[100:103], v[64:67], a[112:119], v22
  buffer_load_dwordx4 v[124:127], v9, s[8:11], s56 offen sc1
  v_smfmac_f32_16x16x64_bf16 v[100:103], v[68:71], a[120:127], v22
  buffer_load_dwordx4 v[128:131], v9, s[8:11], s56 offen offset:1024 sc1
  v_smfmac_f32_16x16x64_bf16 v[100:103], v[72:75], a[128:135], v22
  v_cvt_pk_bf16_f32 v136, v96, v97
  v_smfmac_f32_16x16x64_bf16 v[100:103], v[76:79], a[136:143], v22
  v_cvt_pk_bf16_f32 v137, v98, v99
  v_smfmac_f32_16x16x64_bf16 v[100:103], v[80:83], a[144:151], v22
  v_smfmac_f32_16x16x64_bf16 v[100:103], v[84:87], a[152:159], v22
  s_nop 7
  v_cvt_pk_bf16_f32 v138, v100, v101
  v_cvt_pk_bf16_f32 v139, v102, v103
  v_permlane32_swap_b32 v96, v100
  v_permlane32_swap_b32 v97, v101
  v_permlane32_swap_b32 v98, v102
  v_permlane32_swap_b32 v99, v103
  v_pk_add_f32 v[96:97], v[96:97], v[100:101]
  v_pk_add_f32 v[98:99], v[98:99], v[102:103]
  v_cvt_pk_bf16_f32 v100, v96, v97
  v_cvt_pk_bf16_f32 v101, v98, v99
  s_nop 0
  v_permlane32_swap_b32 v100, v102
  v_permlane32_swap_b32 v101, v103
  v_min_u32 v100, -2, v100
  s_waitcnt vmcnt(2) lgkmcnt(0)
  v_pk_add_f16 v164, v132, v133
  v_pk_add_f16 v165, v134, v135
  v_fma_mix_f32 v170, v164, 1.0, v165 op_sel:[0,0,0] op_sel_hi:[1,0,1]
  v_fma_mix_f32 v171, v164, 1.0, v165 op_sel:[1,0,1] op_sel_hi:[1,0,1]
  v_exp_f32 v176, v170
  v_exp_f32 v177, v171
  s_waitcnt vmcnt(1)
  v_cvt_pk_bf16_f32 v160, v176, v177
  v_pk_add_f16 v120, v124, v126
  v_pk_add_f16 v121, v125, v127
  v_mov_b32_dpp v161, v160 row_ror:8 row_mask:0xf bank_mask:0xf
  s_waitcnt vmcnt(0)
  v_pk_add_f16 v122, v128, v130
  v_mfma_f32_16x16x32_bf16 v[178:181], v[140:143], v[160:163], 0
  v_fma_mix_f32 v166, v120, 1.0, v122 op_sel:[0,0,0] op_sel_hi:[1,0,1]
  v_fma_mix_f32 v167, v120, 1.0, v122 op_sel:[1,0,1] op_sel_hi:[1,0,1]
  v_cmp_u_f32 vcc, v166, v170
  v_pk_add_f16 v123, v129, v131
  v_exp_f32 v172, v166
  v_mfma_f32_16x16x32_bf16 v[182:185], v[136:139], v[160:163], 0
  s_cbranch_vccnz sr_218
  v_exp_f32 v173, v167
  v_fma_mix_f32 v168, v121, 1.0, v123 op_sel:[0,0,0] op_sel_hi:[1,0,1]
  v_fma_mix_f32 v169, v121, 1.0, v123 op_sel:[1,0,1] op_sel_hi:[1,0,1]
  v_cvt_pk_bf16_f32 v156, v172, v173
  v_exp_f32 v174, v168
  v_exp_f32 v175, v169
  v_mov_b32_dpp v158, v156 row_ror:8 row_mask:0xf bank_mask:0xf
  v_cvt_pk_bf16_f32 v157, v174, v175
  v_mfma_f32_16x16x32_bf16 v[186:189], v[138:141], v[160:163], 0
  s_nop 0
  v_mov_b32_dpp v159, v157 row_ror:8 row_mask:0xf bank_mask:0xf
  s_nop 1
pv_219:
  v_mfma_f32_16x16x32_bf16 v[178:181], v[152:155], v[156:159], v[178:181]
  v_mfma_f32_16x16x32_bf16 v[182:185], v[144:147], v[156:159], v[182:185]
  v_mfma_f32_16x16x32_bf16 v[186:189], v[148:151], v[156:159], v[186:189]
  s_mov_b64 exec, s[62:63]
  s_nop 0
  v_rcp_f32 v164, v180
  v_cmp_ngt_f32 s[22:23], s80, v180
  v_cmp_ngt_f32 vcc, s80, v164
  v_pk_mul_f32 v[182:183], v[182:183], v[164:165] op_sel_hi:[1,0]
  v_pk_mul_f32 v[184:185], v[184:185], v[164:165] op_sel_hi:[1,0]
  v_pk_mul_f32 v[178:179], v[178:179], v[164:165] op_sel_hi:[1,0]
  v_pk_mul_f32 v[186:187], v[186:187], v[164:165] op_sel_hi:[1,0]
  v_pk_mul_f32 v[188:189], v[188:189], v[164:165] op_sel_hi:[1,0]
  v_cvt_pk_f16_f32 v64, v178, v179
  s_or_b64 vcc, vcc, s[22:23]
  s_cbranch_scc1 fx_221
fk_222:
  ds_write_b32 v14, v64
  v_cvt_pk_f16_f32 v60, v182, v183
  v_cvt_pk_f16_f32 v61, v184, v185
  v_cvt_pk_f16_f32 v62, v186, v187
  v_cvt_pk_f16_f32 v63, v188, v189
  ds_write_b128 v13, v[60:63]
  s_mov_b64 exec, s[66:67]
  s_barrier
  ds_read_b128 v[166:169], v4 offset:13824
  ds_read_b128 v[170:173], v4 offset:14464
  ds_read_b128 v[174:177], v4 offset:15104
  ds_read_b128 v[178:181], v4 offset:15744
  s_waitcnt lgkmcnt(2)
  v_pk_add_f16 v166, v166, v170
  v_pk_add_f16 v167, v167, v171
  v_pk_add_f16 v168, v168, v172
  v_pk_add_f16 v169, v169, v173
  s_waitcnt lgkmcnt(1)
  v_pk_add_f16 v166, v166, v174
  v_pk_add_f16 v167, v167, v175
  v_pk_add_f16 v168, v168, v176
  v_pk_add_f16 v169, v169, v177
  s_waitcnt lgkmcnt(0)
  v_pk_add_f16 v166, v166, v178
  v_cmpx_o_f16 vcc, v166, v166
  v_pk_add_f16 v167, v167, v179
  v_pk_add_f16 v168, v168, v180
  v_pk_add_f16 v169, v169, v181
  v_and_or_b32 v166, v166, -2, s61
  buffer_store_dwordx4 v[166:169], v15, s[4:7], s60 offen sc1
  s_xor_b64 s[98:99], exec, s[66:67]
  s_mov_b64 exec, -1
  buffer_store_dwordx4 v[100:103], v26, s[16:19], s70 offen sc1
  buffer_store_dwordx2 v[92:93], v43, s[16:19], s70 offen sc1
  s_add_u32 s70, s70, 2097152
  s_xor_b32 s70, s70, 8192
  ds_read_b128 v[144:147], v18
  ds_read_b128 v[148:151], v18 offset:1024
  ds_read_b128 v[152:155], v19
  v_xor_b32 v18, 16384, v18
  v_xor_b32 v19, 16384, v19
  v_mov_b32 v88, 0
  v_mov_b32 v89, 0
  v_mov_b32 v90, 0
  v_mov_b32 v91, 0
  v_mov_b32 v92, 0
  v_mov_b32 v93, 0
  v_mov_b32 v94, 0
  v_mov_b32 v95, 0
  v_mov_b32 v96, 0
  v_mov_b32 v97, 0
  v_mov_b32 v98, 0
  v_mov_b32 v99, 0
  v_mov_b32 v100, 0
  v_mov_b32 v101, 0
  v_mov_b32 v102, 0
  v_mov_b32 v103, 0
  s_mov_b32 s81, 0
  s_waitcnt lgkmcnt(0)
  s_barrier
  s_cmp_lg_u64 s[98:99], 0
  s_cbranch_scc1 pf_223
pf_224:
  s_xor_b32 s74, s74, 16384
  s_add_u32 s73, s73, 2097152
  s_xor_b32 s73, s73, 8192
  s_add_u32 s79, s79, 2097152
  s_xor_b32 s79, s79, 8192
  s_add_u32 s21, s72, 524288
  s_xor_b32 s72, s72, s21
  s_lshr_b32 s72, s72, 8
  s_and_b32 s72, s72, 8192
  s_xor_b32 s72, s72, s21
  s_add_u32 s71, s73, 4096
  s_mov_b32 s91, 1024
  s_sub_u32 s21, s73, 0
  s_cmp_lt_u32 s21, 125829120
  s_cselect_b32 s71, s71, s79
  s_cselect_b32 s91, s91, 65536
  v_mov_b32 v166, s52
  s_and_b32 s21, s52, 3
  s_cmp_lt_u32 s52, 54
  s_cselect_b32 s21, s21, 0
  s_cmp_lg_u32 s21, 0
  s_cbranch_scc1 fs_226
  s_mov_b64 exec, 1
  buffer_store_dword v166, v23, s[12:15], s77 offen sc1
  s_mov_b64 exec, -1
fs_226:
  s_add_u32 s22, s52, 5
  s_min_u32 s22, s22, 64
  v_cmp_gt_u32 vcc, s22, v42
  s_cbranch_vccz fv_227
  buffer_load_dword v42, v41, s[12:15], s76 offen sc1
fv_227:
  ds_write_b128 v190, v[28:31] offset:0
  ds_write_b128 v190, v[28:31] offset:1024
  ds_write_b128 v190, v[28:31] offset:2048
nt_225:
  s_barrier
  s_mov_b32 s58, s55
  s_add_u32 s52, s52, 1
  ds_write_b32 v13, v28
  ds_write_b32 v14, v28
  s_and_b32 s21, s52, 3
  s_mul_i32 s56, s21, 122880
  s_add_u32 s21, s52, 1
  s_and_b32 s21, s21, 3
  s_mul_i32 s55, s21, 122880
  s_add_u32 s55, s55, s75
  s_add_u32 s21, s52, 2
  s_and_b32 s21, s21, 3
  s_mul_i32 s57, s21, 122880
  s_add_u32 s21, s52, 3
  s_and_b32 s21, s21, 3
  s_mul_i32 s59, s21, 122880
  s_add_u32 s59, s59, s75
  s_bfe_u32 s61, s52, 0x10002
  s_and_b32 s21, s52, 3
  s_lshl_b32 s60, s21, 18
  s_mov_b32 s54, 0
  s_sleep 3
  s_waitcnt lgkmcnt(0)
  buffer_load_dwordx4 v[76:79], v190, s[8:11], s58 offen offset:0 sc1
  buffer_load_dwordx4 v[80:83], v190, s[8:11], s58 offen offset:1024 sc1
  buffer_load_dwordx4 v[84:87], v190, s[8:11], s58 offen offset:2048 sc1
  s_branch top_208
mr_209:
  s_mov_b64 exec, s[22:23]
  s_cbranch_execz ms_228
  buffer_load_dwordx4 v[76:79], v190, s[8:11], s58 offen offset:0 sc1
ms_228:
  s_mov_b64 exec, s[98:99]
  s_cbranch_execz ms_229
  buffer_load_dwordx4 v[80:83], v190, s[8:11], s58 offen offset:1024 sc1
ms_229:
  s_mov_b64 exec, s[100:101]
  s_cbranch_execz ms_230
  buffer_load_dwordx4 v[84:87], v190, s[8:11], s58 offen offset:2048 sc1
ms_230:
  s_add_u32 s54, s54, 1
  s_cmp_gt_u32 s54, 131072
  s_cbranch_scc1 end0
  s_waitcnt vmcnt(0)
  s_mov_b64 exec, s[22:23]
  ds_write_b128 v190, v[76:79] offset:0
  v_cmp_eq_u32 s[22:23], -1, v76
  s_mov_b64 exec, s[98:99]
  ds_write_b128 v190, v[80:83] offset:1024
  v_cmp_eq_u32 s[98:99], -1, v80
  s_mov_b64 exec, s[100:101]
  ds_write_b128 v190, v[84:87] offset:2048
  v_cmp_eq_u32 s[100:101], -1, v84
  s_mov_b64 exec, -1
  s_or_b64 vcc, s[22:23], s[98:99]
  s_or_b64 vcc, vcc, s[100:101]
  s_cbranch_scc1 mr_209
  s_branch mo_213
kw_214:
  s_mov_b32 s101, 0
wm_231:
  buffer_load_dword v42, v41, s[12:15], s76 offen sc1
  s_add_u32 s101, s101, 1
  s_cmp_gt_u32 s101, 131072
  s_cbranch_scc1 end0
  s_waitcnt vmcnt(0)
  v_cmp_gt_u32 vcc, s22, v42
  v_readfirstlane_b32 s100, v42
  s_nop 0
  s_cbranch_vccz wm_232
  s_sleep 1
  s_branch wm_231
wm_232:
  s_branch kv_215
mn_210:
  s_bitcmp1_b32 s81, 1
  s_cbranch_scc1 mk_211
  s_or_b32 s81, s81, 2
  s_nop 7
  v_mov_b32 v88, 0
  v_mov_b32 v89, 0
  v_mov_b32 v90, 0
  v_mov_b32 v91, 0
  v_mov_b32 v92, 0
  v_mov_b32 v93, 0
  v_mov_b32 v94, 0
  v_mov_b32 v95, 0
  v_mov_b32 v96, 0
  v_mov_b32 v97, 0
  v_mov_b32 v98, 0
  v_mov_b32 v99, 0
  v_mov_b32 v100, 0
  v_mov_b32 v101, 0
  v_mov_b32 v102, 0
  v_mov_b32 v103, 0
  s_cmp_eq_u32 s52, 0
  s_cbranch_scc1 mx_234
mx_233:
  buffer_load_dwordx4 v[76:79], v190, s[8:11], s58 offen offset:0 sc1
  buffer_load_dwordx4 v[80:83], v190, s[8:11], s58 offen offset:1024 sc1
  buffer_load_dwordx4 v[84:87], v190, s[8:11], s58 offen offset:2048 sc1
  s_add_u32 s54, s54, 1
  s_cmp_gt_u32 s54, 131072
  s_cbranch_scc1 end0
  s_waitcnt vmcnt(0)
  v_max3_u32 v27, v76, v77, v78
  v_max3_u32 v27, v27, v79, v80
  v_max3_u32 v27, v27, v81, v82
  v_max3_u32 v27, v27, v83, v84
  v_max3_u32 v27, v27, v85, v86
  v_max3_u32 v27, v27, v87, v87
  v_cmp_eq_u32 vcc, -1, v27
  s_nop 1
  s_cbranch_vccnz mx_233
  ds_write_b128 v190, v[76:79] offset:0
  ds_write_b128 v190, v[80:83] offset:1024
  ds_write_b128 v190, v[84:87] offset:2048
mx_234:
  s_waitcnt lgkmcnt(0)
  s_branch mo_213
sr_218:
  s_mov_b32 s54, 0
sr_235:
  s_mov_b64 exec, vcc
  buffer_load_dwordx4 v[124:127], v9, s[8:11], s56 offen sc1
  buffer_load_dwordx4 v[128:131], v9, s[8:11], s56 offen offset:1024 sc1
  buffer_load_dwordx4 v[132:135], v10, s[8:11], s56 offen sc1
  s_mov_b64 exec, -1
  s_add_u32 s54, s54, 1
  s_cmp_gt_u32 s54, 131072
  s_cbranch_scc1 end0
  s_waitcnt vmcnt(0)
  v_pk_add_f16 v164, v132, v133
  v_pk_add_f16 v165, v134, v135
  v_pk_add_f16 v120, v124, v126
  v_pk_add_f16 v122, v128, v130
  v_fma_mix_f32 v170, v164, 1.0, v165 op_sel:[0,0,0] op_sel_hi:[1,0,1]
  v_fma_mix_f32 v166, v120, 1.0, v122 op_sel:[0,0,0] op_sel_hi:[1,0,1]
  v_pk_add_f16 v121, v125, v127
  v_cmp_u_f32 vcc, v166, v170
  v_pk_add_f16 v123, v129, v131
  v_fma_mix_f32 v171, v164, 1.0, v165 op_sel:[1,0,1] op_sel_hi:[1,0,1]
  v_fma_mix_f32 v167, v120, 1.0, v122 op_sel:[1,0,1] op_sel_hi:[1,0,1]
  v_fma_mix_f32 v168, v121, 1.0, v123 op_sel:[0,0,0] op_sel_hi:[1,0,1]
  v_fma_mix_f32 v169, v121, 1.0, v123 op_sel:[1,0,1] op_sel_hi:[1,0,1]
  s_cbranch_vccz ex_220
  s_and_b32 s21, s54, 31
  s_cbranch_scc1 sr_235
  v_max3_u32 v27, v124, v126, v128
  v_max3_u32 v27, v27, v130, v132
  v_max3_u32 v27, v27, v133, v134
  v_max3_u32 v27, v27, v135, v135
  v_cmp_eq_u32 vcc, -1, v27
  s_nop 1
  s_cbranch_vccnz sr_235
ex_220:
  v_exp_f32 v176, v170
  v_exp_f32 v177, v171
  v_exp_f32 v172, v166
  v_cvt_pk_bf16_f32 v160, v176, v177
  v_exp_f32 v173, v167
  v_exp_f32 v174, v168
  v_mov_b32_dpp v161, v160 row_ror:8 row_mask:0xf bank_mask:0xf
  v_cvt_pk_bf16_f32 v156, v172, v173
  v_exp_f32 v175, v169
  v_mfma_f32_16x16x32_bf16 v[178:181], v[140:143], v[160:163], 0
  v_mov_b32_dpp v158, v156 row_ror:8 row_mask:0xf bank_mask:0xf
  v_cvt_pk_bf16_f32 v157, v174, v175
  v_mfma_f32_16x16x32_bf16 v[182:185], v[136:139], v[160:163], 0
  s_nop 0
  v_mov_b32_dpp v159, v157 row_ror:8 row_mask:0xf bank_mask:0xf
  v_mfma_f32_16x16x32_bf16 v[186:189], v[138:141], v[160:163], 0
  s_branch pv_219
fx_221:
  s_bitcmp1_b32 s81, 0
  s_cbranch_scc1 fk_222
  s_or_b32 s81, s81, 1
  s_mov_b64 exec, -1
  v_max3_f32 v164, v166, v167, v168
  v_max3_f32 v165, v169, v170, v171
  v_max_f32 v164, v164, v165
  s_nop 1
  v_max_f32_dpp v164, v164, v164 row_ror:8 row_mask:0xf bank_mask:0xf
  v_mov_b32 v165, v164
  s_nop 1
  v_permlane32_swap_b32 v164, v165
  v_max_f32 v164, v164, v165
  v_mov_b32 v165, v164
  s_nop 1
  v_permlane16_swap_b32 v164, v165
  v_max_f32 v164, v164, v165
  v_sub_f32 v166, v166, v164
  v_sub_f32 v167, v167, v164
  v_sub_f32 v168, v168, v164
  v_sub_f32 v169, v169, v164
  v_sub_f32 v170, v170, v164
  v_sub_f32 v171, v171, v164
  s_branch ex_220
pf_223:
  s_mov_b64 exec, s[66:67]
  ds_read_b128 v[166:169], v4 offset:13824
  ds_read_b128 v[170:173], v4 offset:14464
  ds_read_b128 v[174:177], v4 offset:15104
  ds_read_b128 v[178:181], v4 offset:15744
  s_waitcnt lgkmcnt(2)
  v_pk_add_f16 v166, v166, v170
  v_pk_add_f16 v167, v167, v171
  v_pk_add_f16 v168, v168, v172
  v_pk_add_f16 v169, v169, v173
  s_waitcnt lgkmcnt(1)
  v_pk_add_f16 v166, v166, v174
  v_pk_add_f16 v167, v167, v175
  v_pk_add_f16 v168, v168, v176
  v_pk_add_f16 v169, v169, v177
  s_waitcnt lgkmcnt(0)
  v_pk_add_f16 v166, v166, v178
  v_pk_add_f16 v167, v167, v179
  v_pk_add_f16 v168, v168, v180
  v_pk_add_f16 v169, v169, v181
  v_and_or_b32 v166, v166, -2, s61
  buffer_store_dwordx4 v[166:169], v15, s[4:7], s60 offen sc1
  s_mov_b64 exec, -1
  s_nop 1
  s_branch pf_224
last_212:
  v_permlane32_swap_b32 v88, v92
  v_permlane32_swap_b32 v89, v93
  v_permlane32_swap_b32 v90, v94
  v_permlane32_swap_b32 v91, v95
  v_pk_add_f32 v[88:89], v[88:89], v[92:93]
  v_pk_add_f32 v[90:91], v[90:91], v[94:95]
  v_cvt_pk_bf16_f32 v92, v88, v89
  v_cvt_pk_bf16_f32 v93, v90, v91
  v_min_u32 v92, -2, v92
  buffer_store_dwordx2 v[92:93], v43, s[16:19], s70 offen sc1
  v_smfmac_f32_16x16x64_bf16 v[96:99], v[56:59], a[16:23], v22
  v_smfmac_f32_16x16x64_bf16 v[100:103], v[56:59], a[96:103], v22
  v_smfmac_f32_16x16x64_bf16 v[96:99], v[60:63], a[24:31], v22
  v_smfmac_f32_16x16x64_bf16 v[96:99], v[64:67], a[32:39], v22
  v_smfmac_f32_16x16x64_bf16 v[96:99], v[68:71], a[40:47], v22
  v_smfmac_f32_16x16x64_bf16 v[96:99], v[72:75], a[48:55], v22
  v_smfmac_f32_16x16x64_bf16 v[96:99], v[76:79], a[56:63], v22
  v_smfmac_f32_16x16x64_bf16 v[96:99], v[80:83], a[64:71], v22
  v_smfmac_f32_16x16x64_bf16 v[96:99], v[84:87], a[72:79], v22
  v_smfmac_f32_16x16x64_bf16 v[100:103], v[60:63], a[104:111], v22
  v_smfmac_f32_16x16x64_bf16 v[100:103], v[64:67], a[112:119], v22
  v_smfmac_f32_16x16x64_bf16 v[100:103], v[68:71], a[120:127], v22
  v_smfmac_f32_16x16x64_bf16 v[100:103], v[72:75], a[128:135], v22
  v_smfmac_f32_16x16x64_bf16 v[100:103], v[76:79], a[136:143], v22
  v_smfmac_f32_16x16x64_bf16 v[100:103], v[80:83], a[144:151], v22
  v_smfmac_f32_16x16x64_bf16 v[100:103], v[84:87], a[152:159], v22
  s_nop 7
  v_permlane32_swap_b32 v96, v100
  v_permlane32_swap_b32 v97, v101
  v_permlane32_swap_b32 v98, v102
  v_permlane32_swap_b32 v99, v103
  v_pk_add_f32 v[96:97], v[96:97], v[100:101]
  v_pk_add_f32 v[98:99], v[98:99], v[102:103]
  v_cvt_pk_bf16_f32 v100, v96, v97
  v_cvt_pk_bf16_f32 v101, v98, v99
  s_nop 0
  v_permlane32_swap_b32 v100, v102
  v_permlane32_swap_b32 v101, v103
  v_min_u32 v100, -2, v100
  buffer_store_dwordx4 v[100:103], v26, s[16:19], s70 offen sc1
  s_waitcnt vmcnt(0)
  s_barrier
  v_mov_b32 v166, 64
  s_mov_b64 exec, 1
  buffer_store_dword v166, v23, s[12:15], s77 offen sc1
  s_mov_b64 exec, -1
  s_branch chain_done
chain_done:
end0:
  s_endpgm
gemm_side:
  s_bfe_u32 s23, s22, 0x20005
  s_add_u32 s22, s22, 31
  s_and_b32 s22, s22, 31
  s_lshl_b32 s21, s23, 3
  s_add_u32 s2, s21, s22
  s_add_u32 s3, s2, 72
  s_add_u32 s24, s2, 48
  s_add_u32 s2, s2, s21
  s_cmp_lt_u32 s22, 24
  s_cselect_b32 s3, s24, s3
  s_cmp_lt_u32 s22, 16
  s_cselect_b32 s3, s2, s3
  s_mov_b32 s2, s3
  s_cmp_ge_u32 s3, 64
  s_cbranch_scc1 not_kv
  s_load_dwordx2 s[4:5], s[0:1], 0
  s_load_dwordx2 s[6:7], s[0:1], 24
  s_load_dwordx2 s[36:37], s[0:1], 32
  s_load_dwordx2 s[38:39], s[0:1], 104
  s_and_b32 s43, s3, 1
  s_bfe_u32 s42, s3, 0x50001
  s_lshr_b32 s40, s42, 2
  s_waitcnt lgkmcnt(0)
  s_cmp_eq_u32 s43, 1
  s_cselect_b32 s6, s36, s6
  s_cselect_b32 s7, s37, s7
  s_mov_b32 s8, s4
  s_mov_b32 s9, s5
  s_mov_b32 s10, 2621440
  s_mov_b32 s11, 0x00020000
  s_mov_b32 s12, s6
  s_mov_b32 s13, s7
  s_mov_b32 s14, 7864320
  s_mov_b32 s15, 0x00020000
  s_mov_b32 s16, s38
  s_mov_b32 s17, s39
  s_mov_b32 s18, 218103808
  s_mov_b32 s19, 0x00020000
  s_add_u32 s72, s38, 173080576
  s_addc_u32 s73, s39, 0
  s_mov_b32 s74, 49152
  s_mov_b32 s75, 0x00020000
  s_mul_i32 s44, s42, 384
  s_mov_b32 s30, 0
  s_mov_b32 s25, 80768
  v_lshrrev_b32 v4, 3, v1
  v_and_b32 v5, 7, v1
  v_xor_b32 v5, v5, v4
  s_mul_i32 s21, s20, 16
  v_add_u32 v4, s21, v4
  v_mul_u32_u24 v4, 1280, v4
  v_lshl_add_u32 v10, v5, 4, v4
  s_mul_i32 s31, s20, 2048
  v_add_u32 v11, 10240, v10
  v_mov_b32 v9, 2731
  v_add_u32 v8, 0, v1
  v_mul_u32_u24 v7, v8, v9
  v_lshrrev_b32 v7, 16, v7
  v_mul_u32_u24 v4, 24, v7
  v_sub_u32 v8, v8, v4
  s_mov_b32 s21, 12288
  v_mul_lo_u32 v7, v7, s21
  v_lshl_add_u32 v4, v8, 4, v7
  v_add_u32 v8, 64, v1
  v_mul_u32_u24 v7, v8, v9
  v_lshrrev_b32 v7, 16, v7
  v_mul_u32_u24 v5, 24, v7
  v_sub_u32 v8, v8, v5
  s_mov_b32 s21, 12288
  v_mul_lo_u32 v7, v7, s21
  v_lshl_add_u32 v5, v8, 4, v7
  v_add_u32 v8, 128, v1
  v_mul_u32_u24 v7, v8, v9
  v_lshrrev_b32 v7, 16, v7
  v_mul_u32_u24 v6, 24, v7
  v_sub_u32 v8, v8, v6
  s_mov_b32 s21, 12288
  v_mul_lo_u32 v7, v7, s21
  v_lshl_add_u32 v6, v8, 4, v7
  v_lshrrev_b32 v7, 2, v2
  v_lshl_add_u32 v7, v3, 3, v7
  v_mul_u32_u24 v7, 384, v7
  v_and_b32 v8, 3, v2
  v_lshlrev_b32 v8, 3, v8
  s_mul_i32 s21, s20, 96
  v_add3_u32 v7, v7, v8, s21
  v_add_u32 v8, 49152, v7
  s_mul_i32 s21, s20, 393216
  s_add_u32 s21, s21, 0
  s_add_u32 s21, s21, s44
  s_mul_i32 s22, s20, 12288
  s_add_u32 s22, s22, 0
  s_add_u32 m0, s22, 0
  s_nop 0
  buffer_load_dwordx4 v4, s[12:15], s21 offen lds
  s_add_u32 m0, s22, 1024
  s_nop 0
  buffer_load_dwordx4 v5, s[12:15], s21 offen lds
  s_add_u32 m0, s22, 2048
  s_nop 0
  buffer_load_dwordx4 v6, s[12:15], s21 offen lds
  s_mul_i32 s21, s20, 393216
  s_add_u32 s21, s21, 98304
  s_add_u32 s21, s21, s44
  s_mul_i32 s22, s20, 12288
  s_add_u32 s22, s22, 3072
  s_add_u32 m0, s22, 0
  s_nop 0
  buffer_load_dwordx4 v4, s[12:15], s21 offen lds
  s_add_u32 m0, s22, 1024
  s_nop 0
  buffer_load_dwordx4 v5, s[12:15], s21 offen lds
  s_add_u32 m0, s22, 2048
  s_nop 0
  buffer_load_dwordx4 v6, s[12:15], s21 offen lds
  s_mul_i32 s21, s20, 393216
  s_add_u32 s21, s21, 196608
  s_add_u32 s21, s21, s44
  s_mul_i32 s22, s20, 12288
  s_add_u32 s22, s22, 6144
  s_add_u32 m0, s22, 0
  s_nop 0
  buffer_load_dwordx4 v4, s[12:15], s21 offen lds
  s_add_u32 m0, s22, 1024
  s_nop 0
  buffer_load_dwordx4 v5, s[12:15], s21 offen lds
  s_add_u32 m0, s22, 2048
  s_nop 0
  buffer_load_dwordx4 v6, s[12:15], s21 offen lds
  s_mul_i32 s21, s20, 393216
  s_add_u32 s21, s21, 294912
  s_add_u32 s21, s21, s44
  s_mul_i32 s22, s20, 12288
  s_add_u32 s22, s22, 9216
  s_add_u32 m0, s22, 0
  s_nop 0
  buffer_load_dwordx4 v4, s[12:15], s21 offen lds
  s_add_u32 m0, s22, 1024
  s_nop 0
  buffer_load_dwordx4 v5, s[12:15], s21 offen lds
  s_add_u32 m0, s22, 2048
  s_nop 0
  buffer_load_dwordx4 v6, s[12:15], s21 offen lds
  s_add_u32 m0, s31, 98304
  s_nop 0
  buffer_load_dwordx4 v10, s[8:11], s30 offen lds
  s_add_u32 m0, s31, 99328
  s_nop 0
  buffer_load_dwordx4 v11, s[8:11], s30 offen lds
  s_add_u32 s30, s30, 128
  s_add_u32 m0, s31, 106496
  s_nop 0
  buffer_load_dwordx4 v10, s[8:11], s30 offen lds
  s_add_u32 m0, s31, 107520
  s_nop 0
  buffer_load_dwordx4 v11, s[8:11], s30 offen lds
  s_add_u32 s30, s30, 128
  s_add_u32 m0, s31, 114688
  s_nop 0
  buffer_load_dwordx4 v10, s[8:11], s30 offen lds
  s_add_u32 m0, s31, 115712
  s_nop 0
  buffer_load_dwordx4 v11, s[8:11], s30 offen lds
  s_add_u32 s30, s30, 128
  s_add_u32 m0, s31, 122880
  s_nop 0
  buffer_load_dwordx4 v10, s[8:11], s30 offen lds
  s_add_u32 m0, s31, 123904
  s_nop 0
  buffer_load_dwordx4 v11, s[8:11], s30 offen lds
  s_add_u32 s30, s30, 128
  s_add_u32 m0, s31, 131072
  s_nop 0
  buffer_load_dwordx4 v10, s[8:11], s30 offen lds
  s_add_u32 m0, s31, 132096
  s_nop 0
  buffer_load_dwordx4 v11, s[8:11], s30 offen lds
  s_add_u32 s30, s30, 128
  s_add_u32 m0, s31, 139264
  s_nop 0
  buffer_load_dwordx4 v10, s[8:11], s30 offen lds
  s_add_u32 m0, s31, 140288
  s_nop 0
  buffer_load_dwordx4 v11, s[8:11], s30 offen lds
  s_add_u32 s30, s30, 128
  s_add_u32 m0, s31, 147456
  s_nop 0
  buffer_load_dwordx4 v10, s[8:11], s30 offen lds
  s_add_u32 m0, s31, 148480
  s_nop 0
  buffer_load_dwordx4 v11, s[8:11], s30 offen lds
  s_add_u32 s30, s30, 128
  s_add_u32 m0, s31, 155648
  s_nop 0
  buffer_load_dwordx4 v10, s[8:11], s30 offen lds
  s_add_u32 m0, s31, 156672
  s_nop 0
  buffer_load_dwordx4 v11, s[8:11], s30 offen lds
  s_add_u32 s30, s30, 128
  s_mul_i32 s21, s20, 393216
  s_add_u32 s21, s21, 1572864
  s_add_u32 s21, s21, s44
  s_mul_i32 s22, s20, 12288
  s_add_u32 s22, s22, 49152
  s_add_u32 m0, s22, 0
  s_nop 0
  buffer_load_dwordx4 v4, s[12:15], s21 offen lds
  s_add_u32 m0, s22, 1024
  s_nop 0
  buffer_load_dwordx4 v5, s[12:15], s21 offen lds
  s_add_u32 m0, s22, 2048
  s_nop 0
  buffer_load_dwordx4 v6, s[12:15], s21 offen lds
  s_mul_i32 s21, s20, 393216
  s_add_u32 s21, s21, 1671168
  s_add_u32 s21, s21, s44
  s_mul_i32 s22, s20, 12288
  s_add_u32 s22, s22, 52224
  s_add_u32 m0, s22, 0
  s_nop 0
  buffer_load_dwordx4 v4, s[12:15], s21 offen lds
  s_add_u32 m0, s22, 1024
  s_nop 0
  buffer_load_dwordx4 v5, s[12:15], s21 offen lds
  s_add_u32 m0, s22, 2048
  s_nop 0
  buffer_load_dwordx4 v6, s[12:15], s21 offen lds
  s_mul_i32 s21, s20, 393216
  s_add_u32 s21, s21, 1769472
  s_add_u32 s21, s21, s44
  s_mul_i32 s22, s20, 12288
  s_add_u32 s22, s22, 55296
  s_add_u32 m0, s22, 0
  s_nop 0
  buffer_load_dwordx4 v4, s[12:15], s21 offen lds
  s_add_u32 m0, s22, 1024
  s_nop 0
  buffer_load_dwordx4 v5, s[12:15], s21 offen lds
  s_add_u32 m0, s22, 2048
  s_nop 0
  buffer_load_dwordx4 v6, s[12:15], s21 offen lds
  s_mul_i32 s21, s20, 393216
  s_add_u32 s21, s21, 1867776
  s_add_u32 s21, s21, s44
  s_mul_i32 s22, s20, 12288
  s_add_u32 s22, s22, 58368
  s_add_u32 m0, s22, 0
  s_nop 0
  buffer_load_dwordx4 v4, s[12:15], s21 offen lds
  s_add_u32 m0, s22, 1024
  s_nop 0
  buffer_load_dwordx4 v5, s[12:15], s21 offen lds
  s_add_u32 m0, s22, 2048
  s_nop 0
  buffer_load_dwordx4 v6, s[12:15], s21 offen lds
  s_waitcnt vmcnt(12)
  s_barrier
  ds_read_b64_tr_b16 a[0:1], v7 offset:0
  ds_read_b64_tr_b16 a[2:3], v7 offset:1536
  ds_read_b64_tr_b16 a[4:5], v7 offset:32
  ds_read_b64_tr_b16 a[6:7], v7 offset:1568
  ds_read_b64_tr_b16 a[8:9], v7 offset:64
  ds_read_b64_tr_b16 a[10:11], v7 offset:1600
  ds_read_b64_tr_b16 a[12:13], v7 offset:12288
  ds_read_b64_tr_b16 a[14:15], v7 offset:13824
  ds_read_b64_tr_b16 a[16:17], v7 offset:12320
  ds_read_b64_tr_b16 a[18:19], v7 offset:13856
  ds_read_b64_tr_b16 a[20:21], v7 offset:12352
  ds_read_b64_tr_b16 a[22:23], v7 offset:13888
  ds_read_b64_tr_b16 a[24:25], v7 offset:24576
  ds_read_b64_tr_b16 a[26:27], v7 offset:26112
  ds_read_b64_tr_b16 a[28:29], v7 offset:24608
  ds_read_b64_tr_b16 a[30:31], v7 offset:26144
  ds_read_b64_tr_b16 a[32:33], v7 offset:24640
  ds_read_b64_tr_b16 a[34:35], v7 offset:26176
  ds_read_b64_tr_b16 a[36:37], v7 offset:36864
  ds_read_b64_tr_b16 a[38:39], v7 offset:38400
  ds_read_b64_tr_b16 a[40:41], v7 offset:36896
  ds_read_b64_tr_b16 a[42:43], v7 offset:38432
  ds_read_b64_tr_b16 a[44:45], v7 offset:36928
  ds_read_b64_tr_b16 a[46:47], v7 offset:38464
  s_waitcnt lgkmcnt(0)
  s_barrier
  s_mul_i32 s21, s20, 393216
  s_add_u32 s21, s21, 3145728
  s_add_u32 s21, s21, s44
  s_mul_i32 s22, s20, 12288
  s_add_u32 s22, s22, 0
  s_add_u32 m0, s22, 0
  s_nop 0
  buffer_load_dwordx4 v4, s[12:15], s21 offen lds
  s_add_u32 m0, s22, 1024
  s_nop 0
  buffer_load_dwordx4 v5, s[12:15], s21 offen lds
  s_add_u32 m0, s22, 2048
  s_nop 0
  buffer_load_dwordx4 v6, s[12:15], s21 offen lds
  s_mul_i32 s21, s20, 393216
  s_add_u32 s21, s21, 3244032
  s_add_u32 s21, s21, s44
  s_mul_i32 s22, s20, 12288
  s_add_u32 s22, s22, 3072
  s_add_u32 m0, s22, 0
  s_nop 0
  buffer_load_dwordx4 v4, s[12:15], s21 offen lds
  s_add_u32 m0, s22, 1024
  s_nop 0
  buffer_load_dwordx4 v5, s[12:15], s21 offen lds
  s_add_u32 m0, s22, 2048
  s_nop 0
  buffer_load_dwordx4 v6, s[12:15], s21 offen lds
  s_mul_i32 s21, s20, 393216
  s_add_u32 s21, s21, 3342336
  s_add_u32 s21, s21, s44
  s_mul_i32 s22, s20, 12288
  s_add_u32 s22, s22, 6144
  s_add_u32 m0, s22, 0
  s_nop 0
  buffer_load_dwordx4 v4, s[12:15], s21 offen lds
  s_add_u32 m0, s22, 1024
  s_nop 0
  buffer_load_dwordx4 v5, s[12:15], s21 offen lds
  s_add_u32 m0, s22, 2048
  s_nop 0
  buffer_load_dwordx4 v6, s[12:15], s21 offen lds
  s_mul_i32 s21, s20, 393216
  s_add_u32 s21, s21, 3440640
  s_add_u32 s21, s21, s44
  s_mul_i32 s22, s20, 12288
  s_add_u32 s22, s22, 9216
  s_add_u32 m0, s22, 0
  s_nop 0
  buffer_load_dwordx4 v4, s[12:15], s21 offen lds
  s_add_u32 m0, s22, 1024
  s_nop 0
  buffer_load_dwordx4 v5, s[12:15], s21 offen lds
  s_add_u32 m0, s22, 2048
  s_nop 0
  buffer_load_dwordx4 v6, s[12:15], s21 offen lds
  s_waitcnt vmcnt(12)
  s_barrier
  ds_read_b64_tr_b16 a[48:49], v8 offset:0
  ds_read_b64_tr_b16 a[50:51], v8 offset:1536
  ds_read_b64_tr_b16 a[52:53], v8 offset:32
  ds_read_b64_tr_b16 a[54:55], v8 offset:1568
  ds_read_b64_tr_b16 a[56:57], v8 offset:64
  ds_read_b64_tr_b16 a[58:59], v8 offset:1600
  ds_read_b64_tr_b16 a[60:61], v8 offset:12288
  ds_read_b64_tr_b16 a[62:63], v8 offset:13824
  ds_read_b64_tr_b16 a[64:65], v8 offset:12320
  ds_read_b64_tr_b16 a[66:67], v8 offset:13856
  ds_read_b64_tr_b16 a[68:69], v8 offset:12352
  ds_read_b64_tr_b16 a[70:71], v8 offset:13888
  ds_read_b64_tr_b16 a[72:73], v8 offset:24576
  ds_read_b64_tr_b16 a[74:75], v8 offset:26112
  ds_read_b64_tr_b16 a[76:77], v8 offset:24608
  ds_read_b64_tr_b16 a[78:79], v8 offset:26144
  ds_read_b64_tr_b16 a[80:81], v8 offset:24640
  ds_read_b64_tr_b16 a[82:83], v8 offset:26176
  ds_read_b64_tr_b16 a[84:85], v8 offset:36864
  ds_read_b64_tr_b16 a[86:87], v8 offset:38400
  ds_read_b64_tr_b16 a[88:89], v8 offset:36896
  ds_read_b64_tr_b16 a[90:91], v8 offset:38432
  ds_read_b64_tr_b16 a[92:93], v8 offset:36928
  ds_read_b64_tr_b16 a[94:95], v8 offset:38464
  s_waitcnt lgkmcnt(0)
  s_barrier
  s_mul_i32 s21, s20, 393216
  s_add_u32 s21, s21, 4718592
  s_add_u32 s21, s21, s44
  s_mul_i32 s22, s20, 12288
  s_add_u32 s22, s22, 49152
  s_add_u32 m0, s22, 0
  s_nop 0
  buffer_load_dwordx4 v4, s[12:15], s21 offen lds
  s_add_u32 m0, s22, 1024
  s_nop 0
  buffer_load_dwordx4 v5, s[12:15], s21 offen lds
  s_add_u32 m0, s22, 2048
  s_nop 0
  buffer_load_dwordx4 v6, s[12:15], s21 offen lds
  s_mul_i32 s21, s20, 393216
  s_add_u32 s21, s21, 4816896
  s_add_u32 s21, s21, s44
  s_mul_i32 s22, s20, 12288
  s_add_u32 s22, s22, 52224
  s_add_u32 m0, s22, 0
  s_nop 0
  buffer_load_dwordx4 v4, s[12:15], s21 offen lds
  s_add_u32 m0, s22, 1024
  s_nop 0
  buffer_load_dwordx4 v5, s[12:15], s21 offen lds
  s_add_u32 m0, s22, 2048
  s_nop 0
  buffer_load_dwordx4 v6, s[12:15], s21 offen lds
  s_mul_i32 s21, s20, 393216
  s_add_u32 s21, s21, 4915200
  s_add_u32 s21, s21, s44
  s_mul_i32 s22, s20, 12288
  s_add_u32 s22, s22, 55296
  s_add_u32 m0, s22, 0
  s_nop 0
  buffer_load_dwordx4 v4, s[12:15], s21 offen lds
  s_add_u32 m0, s22, 1024
  s_nop 0
  buffer_load_dwordx4 v5, s[12:15], s21 offen lds
  s_add_u32 m0, s22, 2048
  s_nop 0
  buffer_load_dwordx4 v6, s[12:15], s21 offen lds
  s_mul_i32 s21, s20, 393216
  s_add_u32 s21, s21, 5013504
  s_add_u32 s21, s21, s44
  s_mul_i32 s22, s20, 12288
  s_add_u32 s22, s22, 58368
  s_add_u32 m0, s22, 0
  s_nop 0
  buffer_load_dwordx4 v4, s[12:15], s21 offen lds
  s_add_u32 m0, s22, 1024
  s_nop 0
  buffer_load_dwordx4 v5, s[12:15], s21 offen lds
  s_add_u32 m0, s22, 2048
  s_nop 0
  buffer_load_dwordx4 v6, s[12:15], s21 offen lds
  v_mov_b32 v29, 76
  buffer_load_dword v29, v29, s[32:35], 0 offen sc1
  v_lshlrev_b32 v28, 4, v1
  s_and_b32 s21, s3, 15
  s_lshl_b32 s21, s21, 2
  s_add_u32 s21, s21, s20
  s_lshl_b32 s21, s21, 10
  s_add_u32 s21, s21, 81920
  buffer_load_dwordx4 v[32:35], v28, s[8:11], s21 offen
  s_add_u32 s21, s21, 65536
  buffer_load_dwordx4 v[32:35], v28, s[8:11], s21 offen
  s_add_u32 s21, s21, 65536
  buffer_load_dwordx4 v[32:35], v28, s[8:11], s21 offen
  s_add_u32 s21, s21, 65536
  buffer_load_dwordx4 v[32:35], v28, s[8:11], s21 offen
  s_add_u32 s21, s21, 65536
  buffer_load_dwordx4 v[32:35], v28, s[8:11], s21 offen
  s_add_u32 s21, s21, 65536
  buffer_load_dwordx4 v[32:35], v28, s[8:11], s21 offen
  s_add_u32 s21, s21, 65536
  buffer_load_dwordx4 v[32:35], v28, s[8:11], s21 offen
  s_add_u32 s21, s21, 65536
  buffer_load_dwordx4 v[32:35], v28, s[8:11], s21 offen
  s_add_u32 s21, s21, 65536
  buffer_load_dwordx4 v[32:35], v28, s[8:11], s21 offen
  s_add_u32 s21, s21, 65536
  buffer_load_dwordx4 v[32:35], v28, s[8:11], s21 offen
  s_add_u32 s21, s21, 65536
  s_waitcnt vmcnt(12)
  s_barrier
  ds_read_b64_tr_b16 a[96:97], v7 offset:0
  ds_read_b64_tr_b16 a[98:99], v7 offset:1536
  ds_read_b64_tr_b16 a[100:101], v7 offset:32
  ds_read_b64_tr_b16 a[102:103], v7 offset:1568
  ds_read_b64_tr_b16 a[104:105], v7 offset:64
  ds_read_b64_tr_b16 a[106:107], v7 offset:1600
  ds_read_b64_tr_b16 a[108:109], v7 offset:12288
  ds_read_b64_tr_b16 a[110:111], v7 offset:13824
  ds_read_b64_tr_b16 a[112:113], v7 offset:12320
  ds_read_b64_tr_b16 a[114:115], v7 offset:13856
  ds_read_b64_tr_b16 a[116:117], v7 offset:12352
  ds_read_b64_tr_b16 a[118:119], v7 offset:13888
  ds_read_b64_tr_b16 a[120:121], v7 offset:24576
  ds_read_b64_tr_b16 a[122:123], v7 offset:26112
  ds_read_b64_tr_b16 a[124:125], v7 offset:24608
  ds_read_b64_tr_b16 a[126:127], v7 offset:26144
  ds_read_b64_tr_b16 a[128:129], v7 offset:24640
  ds_read_b64_tr_b16 a[130:131], v7 offset:26176
  ds_read_b64_tr_b16 a[132:133], v7 offset:36864
  ds_read_b64_tr_b16 a[134:135], v7 offset:38400
  ds_read_b64_tr_b16 a[136:137], v7 offset:36896
  ds_read_b64_tr_b16 a[138:139], v7 offset:38432
  ds_read_b64_tr_b16 a[140:141], v7 offset:36928
  ds_read_b64_tr_b16 a[142:143], v7 offset:38464
  s_waitcnt lgkmcnt(0)
  s_barrier
  s_mul_i32 s21, s20, 393216
  s_add_u32 s21, s21, 6291456
  s_add_u32 s21, s21, s44
  s_mul_i32 s22, s20, 12288
  s_add_u32 s22, s22, 0
  s_add_u32 m0, s22, 0
  s_nop 0
  buffer_load_dwordx4 v4, s[12:15], s21 offen lds
  s_add_u32 m0, s22, 1024
  s_nop 0
  buffer_load_dwordx4 v5, s[12:15], s21 offen lds
  s_add_u32 m0, s22, 2048
  s_nop 0
  buffer_load_dwordx4 v6, s[12:15], s21 offen lds
  s_mul_i32 s21, s20, 393216
  s_add_u32 s21, s21, 6389760
  s_add_u32 s21, s21, s44
  s_mul_i32 s22, s20, 12288
  s_add_u32 s22, s22, 3072
  s_add_u32 m0, s22, 0
  s_nop 0
  buffer_load_dwordx4 v4, s[12:15], s21 offen lds
  s_add_u32 m0, s22, 1024
  s_nop 0
  buffer_load_dwordx4 v5, s[12:15], s21 offen lds
  s_add_u32 m0, s22, 2048
  s_nop 0
  buffer_load_dwordx4 v6, s[12:15], s21 offen lds
  s_mul_i32 s21, s20, 393216
  s_add_u32 s21, s21, 6488064
  s_add_u32 s21, s21, s44
  s_mul_i32 s22, s20, 12288
  s_add_u32 s22, s22, 6144
  s_add_u32 m0, s22, 0
  s_nop 0
  buffer_load_dwordx4 v4, s[12:15], s21 offen lds
  s_add_u32 m0, s22, 1024
  s_nop 0
  buffer_load_dwordx4 v5, s[12:15], s21 offen lds
  s_add_u32 m0, s22, 2048
  s_nop 0
  buffer_load_dwordx4 v6, s[12:15], s21 offen lds
  s_mul_i32 s21, s20, 393216
  s_add_u32 s21, s21, 6586368
  s_add_u32 s21, s21, s44
  s_mul_i32 s22, s20, 12288
  s_add_u32 s22, s22, 9216
  s_add_u32 m0, s22, 0
  s_nop 0
  buffer_load_dwordx4 v4, s[12:15], s21 offen lds
  s_add_u32 m0, s22, 1024
  s_nop 0
  buffer_load_dwordx4 v5, s[12:15], s21 offen lds
  s_add_u32 m0, s22, 2048
  s_nop 0
  buffer_load_dwordx4 v6, s[12:15], s21 offen lds
  s_waitcnt vmcnt(12)
  s_barrier
  ds_read_b64_tr_b16 a[144:145], v8 offset:0
  ds_read_b64_tr_b16 a[146:147], v8 offset:1536
  ds_read_b64_tr_b16 a[148:149], v8 offset:32
  ds_read_b64_tr_b16 a[150:151], v8 offset:1568
  ds_read_b64_tr_b16 a[152:153], v8 offset:64
  ds_read_b64_tr_b16 a[154:155], v8 offset:1600
  ds_read_b64_tr_b16 a[156:157], v8 offset:12288
  ds_read_b64_tr_b16 a[158:159], v8 offset:13824
  ds_read_b64_tr_b16 a[160:161], v8 offset:12320
  ds_read_b64_tr_b16 a[162:163], v8 offset:13856
  ds_read_b64_tr_b16 a[164:165], v8 offset:12352
  ds_read_b64_tr_b16 a[166:167], v8 offset:13888
  ds_read_b64_tr_b16 a[168:169], v8 offset:24576
  ds_read_b64_tr_b16 a[170:171], v8 offset:26112
  ds_read_b64_tr_b16 a[172:173], v8 offset:24608
  ds_read_b64_tr_b16 a[174:175], v8 offset:26144
  ds_read_b64_tr_b16 a[176:177], v8 offset:24640
  ds_read_b64_tr_b16 a[178:179], v8 offset:26176
  ds_read_b64_tr_b16 a[180:181], v8 offset:36864
  ds_read_b64_tr_b16 a[182:183], v8 offset:38400
  ds_read_b64_tr_b16 a[184:185], v8 offset:36896
  ds_read_b64_tr_b16 a[186:187], v8 offset:38432
  ds_read_b64_tr_b16 a[188:189], v8 offset:36928
  ds_read_b64_tr_b16 a[190:191], v8 offset:38464
  s_waitcnt lgkmcnt(0)
  s_barrier
  s_waitcnt vmcnt(0)
  s_barrier
  ds_read_b64_tr_b16 a[192:193], v7 offset:0
  ds_read_b64_tr_b16 a[194:195], v7 offset:1536
  ds_read_b64_tr_b16 a[196:197], v7 offset:32
  ds_read_b64_tr_b16 a[198:199], v7 offset:1568
  ds_read_b64_tr_b16 a[200:201], v7 offset:64
  ds_read_b64_tr_b16 a[202:203], v7 offset:1600
  ds_read_b64_tr_b16 a[204:205], v7 offset:12288
  ds_read_b64_tr_b16 a[206:207], v7 offset:13824
  ds_read_b64_tr_b16 a[208:209], v7 offset:12320
  ds_read_b64_tr_b16 a[210:211], v7 offset:13856
  ds_read_b64_tr_b16 a[212:213], v7 offset:12352
  ds_read_b64_tr_b16 a[214:215], v7 offset:13888
  ds_read_b64_tr_b16 a[216:217], v7 offset:24576
  ds_read_b64_tr_b16 a[218:219], v7 offset:26112
  ds_read_b64_tr_b16 a[220:221], v7 offset:24608
  ds_read_b64_tr_b16 a[222:223], v7 offset:26144
  ds_read_b64_tr_b16 a[224:225], v7 offset:24640
  ds_read_b64_tr_b16 a[226:227], v7 offset:26176
  ds_read_b64_tr_b16 a[228:229], v7 offset:36864
  ds_read_b64_tr_b16 a[230:231], v7 offset:38400
  ds_read_b64_tr_b16 a[232:233], v7 offset:36896
  ds_read_b64_tr_b16 a[234:235], v7 offset:38432
  ds_read_b64_tr_b16 a[236:237], v7 offset:36928
  ds_read_b64_tr_b16 a[238:239], v7 offset:38464
  s_waitcnt lgkmcnt(0)
  s_barrier
  v_and_b32 v6, 7, v2
  v_add_u32 v4, 0, v3
  v_xor_b32 v4, v4, v6
  v_lshlrev_b32 v4, 4, v4
  v_lshl_add_u32 v14, v2, 7, v4
  v_add_u32 v16, 65536, v14
  v_add_u32 v18, 131072, v14
  v_add_u32 v4, 4, v3
  v_xor_b32 v4, v4, v6
  v_lshlrev_b32 v4, 4, v4
  v_lshl_add_u32 v15, v2, 7, v4
  v_add_u32 v17, 65536, v15
  v_add_u32 v19, 131072, v15
  v_lshlrev_b32 v26, 4, v1
  v_mov_b32 v28, 1
  v_mov_b32 v4, 0x40000000
  v_cmp_eq_u32 vcc, 0, v0
  s_nop 1
  v_cndmask_b32 v27, v4, 0, vcc
  s_mov_b32 s26, 6
  s_lshl_b32 s27, s42, 2
  s_add_u32 s27, s27, s20
  s_lshl_b32 s27, s27, 14
  s_lshl_b32 s21, s43, 13
  s_xor_b32 s27, s27, s21
  v_readfirstlane_b32 s100, v29
  s_cmp_lg_u32 s100, 0
  s_cbranch_scc1 kvz_237
  s_mov_b32 s21, 76
  v_mov_b32 v4, 0
  s_mov_b32 s101, 0
wf_238:
  buffer_load_dword v5, v4, s[32:35], s21 offen sc1
  s_add_u32 s101, s101, 1
  s_cmp_gt_u32 s101, 131072
  s_cbranch_scc1 main_end
  s_waitcnt vmcnt(0)
  v_readfirstlane_b32 s100, v5
  s_cmp_ge_u32 s100, 1
  s_cbranch_scc1 wf_239
  s_sleep 8
  s_branch wf_238
wf_239:
kvz_237:
  s_sub_u32 s80, s100, 1
  s_lshl_b32 s80, s80, 13
  s_xor_b32 s27, s27, s80
  s_lshl_b32 s60, s40, 7
  s_add_u32 s60, s60, 28672
  s_xor_b32 s60, s60, s80
  s_mov_b32 s48, 0x40000000
  s_mov_b32 s61, 0x40000000
  s_waitcnt vmcnt(14)
  s_barrier
  ds_read_b128 v[160:163], v16 offset:32768
  ds_read_b128 v[164:167], v16 offset:34816
  ds_read_b128 v[168:171], v16 offset:36864
  ds_read_b128 v[172:175], v16 offset:38912
  s_waitcnt lgkmcnt(3)
  .p2align 3
kvm_240:
  v_mfma_f32_16x16x32_bf16 v[64:67], a[0:3], v[160:163], 0
  s_xor_b32 s29, s48, 0
  ds_read_b128 v[176:179], v17 offset:32768
  v_cvt_pk_bf16_f32 v204, v88, v89
  v_mfma_f32_16x16x32_bf16 v[68:71], a[4:7], v[160:163], 0
  v_cvt_pk_bf16_f32 v205, v90, v91
  v_cvt_pk_bf16_f32 v206, v92, v93
  v_mfma_f32_16x16x32_bf16 v[72:75], a[8:11], v[160:163], 0
  s_waitcnt lgkmcnt(3)
  v_cvt_pk_bf16_f32 v207, v94, v95
  v_cvt_pk_bf16_f32 v212, v96, v97
  v_mfma_f32_16x16x32_bf16 v[76:79], a[0:3], v[164:167], 0
  ds_read_b128 v[180:183], v17 offset:34816
  v_cvt_pk_bf16_f32 v213, v98, v99
  v_mfma_f32_16x16x32_bf16 v[80:83], a[4:7], v[164:167], 0
  v_cvt_pk_bf16_f32 v208, v100, v101
  v_cvt_pk_bf16_f32 v209, v102, v103
  v_mfma_f32_16x16x32_bf16 v[84:87], a[8:11], v[164:167], 0
  s_waitcnt lgkmcnt(3)
  v_cvt_pk_bf16_f32 v210, v104, v105
  v_cvt_pk_bf16_f32 v211, v106, v107
  v_mfma_f32_16x16x32_bf16 v[88:91], a[0:3], v[168:171], 0
  ds_read_b128 v[184:187], v17 offset:36864
  v_cvt_pk_bf16_f32 v214, v108, v109
  v_mfma_f32_16x16x32_bf16 v[92:95], a[4:7], v[168:171], 0
  s_add_u32 m0, s31, 81920
  v_cvt_pk_bf16_f32 v215, v110, v111
  buffer_store_dwordx4 v[192:195], v26, s[16:19], s29 offen offset:0 sc1
  v_mfma_f32_16x16x32_bf16 v[96:99], a[8:11], v[168:171], 0
  s_waitcnt lgkmcnt(3)
  buffer_load_dwordx4 v10, s[8:11], s30 offen lds
  v_mfma_f32_16x16x32_bf16 v[100:103], a[0:3], v[172:175], 0
  ds_read_b128 v[188:191], v17 offset:38912
  v_mfma_f32_16x16x32_bf16 v[104:107], a[4:7], v[172:175], 0
  v_mfma_f32_16x16x32_bf16 v[108:111], a[8:11], v[172:175], 0
  s_waitcnt lgkmcnt(3)
  buffer_store_dwordx4 v[196:199], v26, s[16:19], s29 offen offset:1024 sc1
  v_mfma_f32_16x16x32_bf16 v[64:67], a[12:15], v[176:179], v[64:67]
  s_waitcnt vmcnt(15)
  s_barrier
  ds_read_b128 v[160:163], v16 offset:40960
  v_mfma_f32_16x16x32_bf16 v[68:71], a[16:19], v[176:179], v[68:71]
  s_add_u32 m0, s31, 82944
  v_mfma_f32_16x16x32_bf16 v[72:75], a[20:23], v[176:179], v[72:75]
  s_waitcnt lgkmcnt(3)
  buffer_load_dwordx4 v11, s[8:11], s30 offen lds
  v_mfma_f32_16x16x32_bf16 v[76:79], a[12:15], v[180:183], v[76:79]
  s_add_u32 s30, s30, 128
  ds_read_b128 v[164:167], v16 offset:43008
  buffer_store_dwordx4 v[200:203], v26, s[16:19], s29 offen offset:2048 sc1
  v_mfma_f32_16x16x32_bf16 v[80:83], a[16:19], v[180:183], v[80:83]
  v_mfma_f32_16x16x32_bf16 v[84:87], a[20:23], v[180:183], v[84:87]
  s_waitcnt lgkmcnt(3)
  v_mfma_f32_16x16x32_bf16 v[88:91], a[12:15], v[184:187], v[88:91]
  s_xor_b32 s29, s48, 2105344
  ds_read_b128 v[168:171], v16 offset:45056
  v_mfma_f32_16x16x32_bf16 v[92:95], a[16:19], v[184:187], v[92:95]
  buffer_store_dwordx4 v[204:207], v26, s[16:19], s29 offen offset:0 sc1
  v_mfma_f32_16x16x32_bf16 v[96:99], a[20:23], v[184:187], v[96:99]
  s_waitcnt lgkmcnt(3)
  v_mfma_f32_16x16x32_bf16 v[100:103], a[12:15], v[188:191], v[100:103]
  ds_read_b128 v[172:175], v16 offset:47104
  v_mfma_f32_16x16x32_bf16 v[104:107], a[16:19], v[188:191], v[104:107]
  v_mfma_f32_16x16x32_bf16 v[108:111], a[20:23], v[188:191], v[108:111]
  s_waitcnt lgkmcnt(3)
  buffer_store_dwordx4 v[208:211], v26, s[16:19], s29 offen offset:1024 sc1
  v_mfma_f32_16x16x32_bf16 v[64:67], a[24:27], v[160:163], v[64:67]
  ds_read_b128 v[176:179], v17 offset:40960
  v_mfma_f32_16x16x32_bf16 v[68:71], a[28:31], v[160:163], v[68:71]
  s_add_u32 m0, s31, 90112
  v_mfma_f32_16x16x32_bf16 v[72:75], a[32:35], v[160:163], v[72:75]
  s_waitcnt lgkmcnt(3)
  buffer_load_dwordx4 v10, s[8:11], s30 offen lds
  v_mfma_f32_16x16x32_bf16 v[76:79], a[24:27], v[164:167], v[76:79]
  ds_read_b128 v[180:183], v17 offset:43008
  buffer_store_dwordx4 v[212:215], v26, s[16:19], s29 offen offset:2048 sc1
  v_mfma_f32_16x16x32_bf16 v[80:83], a[28:31], v[164:167], v[80:83]
  v_mfma_f32_16x16x32_bf16 v[84:87], a[32:35], v[164:167], v[84:87]
  s_waitcnt lgkmcnt(3)
  v_mfma_f32_16x16x32_bf16 v[88:91], a[24:27], v[168:171], v[88:91]
  ds_read_b128 v[184:187], v17 offset:45056
  v_mfma_f32_16x16x32_bf16 v[92:95], a[28:31], v[168:171], v[92:95]
  s_add_u32 m0, s31, 91136
  v_mfma_f32_16x16x32_bf16 v[96:99], a[32:35], v[168:171], v[96:99]
  s_waitcnt lgkmcnt(3)
  buffer_load_dwordx4 v11, s[8:11], s30 offen lds
  v_mfma_f32_16x16x32_bf16 v[100:103], a[24:27], v[172:175], v[100:103]
  s_add_u32 s30, s30, s25
  ds_read_b128 v[188:191], v17 offset:47104
  v_mfma_f32_16x16x32_bf16 v[104:107], a[28:31], v[172:175], v[104:107]
  v_mfma_f32_16x16x32_bf16 v[108:111], a[32:35], v[172:175], v[108:111]
  s_waitcnt lgkmcnt(3)
  v_mfma_f32_16x16x32_bf16 v[64:67], a[36:39], v[176:179], v[64:67]
  s_waitcnt vmcnt(20)
  s_barrier
  ds_read_b128 v[160:163], v16 offset:49152
  v_mfma_f32_16x16x32_bf16 v[68:71], a[40:43], v[176:179], v[68:71]
  v_mfma_f32_16x16x32_bf16 v[72:75], a[44:47], v[176:179], v[72:75]
  s_waitcnt lgkmcnt(3)
  v_mfma_f32_16x16x32_bf16 v[76:79], a[36:39], v[180:183], v[76:79]
  ds_read_b128 v[164:167], v16 offset:51200
  v_mfma_f32_16x16x32_bf16 v[80:83], a[40:43], v[180:183], v[80:83]
  v_mfma_f32_16x16x32_bf16 v[84:87], a[44:47], v[180:183], v[84:87]
  s_waitcnt lgkmcnt(3)
  v_mfma_f32_16x16x32_bf16 v[88:91], a[36:39], v[184:187], v[88:91]
  ds_read_b128 v[168:171], v16 offset:53248
  v_mfma_f32_16x16x32_bf16 v[92:95], a[40:43], v[184:187], v[92:95]
  v_mfma_f32_16x16x32_bf16 v[96:99], a[44:47], v[184:187], v[96:99]
  s_waitcnt lgkmcnt(3)
  v_mfma_f32_16x16x32_bf16 v[100:103], a[36:39], v[188:191], v[100:103]
  ds_read_b128 v[172:175], v16 offset:55296
  v_mfma_f32_16x16x32_bf16 v[104:107], a[40:43], v[188:191], v[104:107]
  v_mfma_f32_16x16x32_bf16 v[108:111], a[44:47], v[188:191], v[108:111]
  s_waitcnt lgkmcnt(3)
  v_mfma_f32_16x16x32_bf16 v[64:67], a[48:51], v[160:163], v[64:67]
  ds_read_b128 v[176:179], v17 offset:49152
  v_mfma_f32_16x16x32_bf16 v[68:71], a[52:55], v[160:163], v[68:71]
  s_add_u32 m0, s31, 98304
  v_mfma_f32_16x16x32_bf16 v[72:75], a[56:59], v[160:163], v[72:75]
  s_waitcnt lgkmcnt(3)
  buffer_load_dwordx4 v10, s[8:11], s30 offen lds
  v_mfma_f32_16x16x32_bf16 v[76:79], a[48:51], v[164:167], v[76:79]
  ds_read_b128 v[180:183], v17 offset:51200
  v_mfma_f32_16x16x32_bf16 v[80:83], a[52:55], v[164:167], v[80:83]
  v_mfma_f32_16x16x32_bf16 v[84:87], a[56:59], v[164:167], v[84:87]
  s_waitcnt lgkmcnt(3)
  v_mfma_f32_16x16x32_bf16 v[88:91], a[48:51], v[168:171], v[88:91]
  ds_read_b128 v[184:187], v17 offset:53248
  v_mfma_f32_16x16x32_bf16 v[92:95], a[52:55], v[168:171], v[92:95]
  s_add_u32 m0, s31, 99328
  v_mfma_f32_16x16x32_bf16 v[96:99], a[56:59], v[168:171], v[96:99]
  s_waitcnt lgkmcnt(3)
  buffer_load_dwordx4 v11, s[8:11], s30 offen lds
  v_mfma_f32_16x16x32_bf16 v[100:103], a[48:51], v[172:175], v[100:103]
  s_add_u32 s30, s30, 128
  ds_read_b128 v[188:191], v17 offset:55296
  v_mfma_f32_16x16x32_bf16 v[104:107], a[52:55], v[172:175], v[104:107]
  v_mfma_f32_16x16x32_bf16 v[108:111], a[56:59], v[172:175], v[108:111]
  s_waitcnt lgkmcnt(3)
  v_mfma_f32_16x16x32_bf16 v[64:67], a[60:63], v[176:179], v[64:67]
  s_waitcnt vmcnt(20)
  s_barrier
  ds_read_b128 v[160:163], v16 offset:57344
  v_mfma_f32_16x16x32_bf16 v[68:71], a[64:67], v[176:179], v[68:71]
  v_mfma_f32_16x16x32_bf16 v[72:75], a[68:71], v[176:179], v[72:75]
  s_waitcnt lgkmcnt(3)
  v_mfma_f32_16x16x32_bf16 v[76:79], a[60:63], v[180:183], v[76:79]
  ds_read_b128 v[164:167], v16 offset:59392
  v_mfma_f32_16x16x32_bf16 v[80:83], a[64:67], v[180:183], v[80:83]
  v_mfma_f32_16x16x32_bf16 v[84:87], a[68:71], v[180:183], v[84:87]
  s_waitcnt lgkmcnt(3)
  v_mfma_f32_16x16x32_bf16 v[88:91], a[60:63], v[184:187], v[88:91]
  ds_read_b128 v[168:171], v16 offset:61440
  v_mfma_f32_16x16x32_bf16 v[92:95], a[64:67], v[184:187], v[92:95]
  v_mfma_f32_16x16x32_bf16 v[96:99], a[68:71], v[184:187], v[96:99]
  s_waitcnt lgkmcnt(3)
  v_mfma_f32_16x16x32_bf16 v[100:103], a[60:63], v[188:191], v[100:103]
  ds_read_b128 v[172:175], v16 offset:63488
  v_mfma_f32_16x16x32_bf16 v[104:107], a[64:67], v[188:191], v[104:107]
  v_mfma_f32_16x16x32_bf16 v[108:111], a[68:71], v[188:191], v[108:111]
  s_waitcnt lgkmcnt(3)
  v_mfma_f32_16x16x32_bf16 v[64:67], a[72:75], v[160:163], v[64:67]
  ds_read_b128 v[176:179], v17 offset:57344
  v_mfma_f32_16x16x32_bf16 v[68:71], a[76:79], v[160:163], v[68:71]
  s_add_u32 m0, s31, 106496
  v_mfma_f32_16x16x32_bf16 v[72:75], a[80:83], v[160:163], v[72:75]
  s_waitcnt lgkmcnt(3)
  buffer_load_dwordx4 v10, s[8:11], s30 offen lds
  v_mfma_f32_16x16x32_bf16 v[76:79], a[72:75], v[164:167], v[76:79]
  ds_read_b128 v[180:183], v17 offset:59392
  v_mfma_f32_16x16x32_bf16 v[80:83], a[76:79], v[164:167], v[80:83]
  v_mfma_f32_16x16x32_bf16 v[84:87], a[80:83], v[164:167], v[84:87]
  s_waitcnt lgkmcnt(3)
  v_mfma_f32_16x16x32_bf16 v[88:91], a[72:75], v[168:171], v[88:91]
  ds_read_b128 v[184:187], v17 offset:61440
  v_mfma_f32_16x16x32_bf16 v[92:95], a[76:79], v[168:171], v[92:95]
  s_add_u32 m0, s31, 107520
  v_mfma_f32_16x16x32_bf16 v[96:99], a[80:83], v[168:171], v[96:99]
  s_waitcnt lgkmcnt(3)
  buffer_load_dwordx4 v11, s[8:11], s30 offen lds
  v_mfma_f32_16x16x32_bf16 v[100:103], a[72:75], v[172:175], v[100:103]
  s_add_u32 s30, s30, 128
  ds_read_b128 v[188:191], v17 offset:63488
  v_mfma_f32_16x16x32_bf16 v[104:107], a[76:79], v[172:175], v[104:107]
  v_mfma_f32_16x16x32_bf16 v[108:111], a[80:83], v[172:175], v[108:111]
  s_waitcnt lgkmcnt(3)
  v_mfma_f32_16x16x32_bf16 v[64:67], a[84:87], v[176:179], v[64:67]
  s_waitcnt vmcnt(5)
  s_barrier
  ds_read_b128 v[160:163], v18 offset:0
  v_mfma_f32_16x16x32_bf16 v[68:71], a[88:91], v[176:179], v[68:71]
  buffer_atomic_add v28, v27, s[72:75], s61 offen sc1
  v_mfma_f32_16x16x32_bf16 v[72:75], a[92:95], v[176:179], v[72:75]
  s_waitcnt lgkmcnt(3)
  s_mov_b32 s48, s27
  s_add_u32 s27, s27, 4194304
  v_mfma_f32_16x16x32_bf16 v[76:79], a[84:87], v[180:183], v[76:79]
  s_mov_b32 s61, s60
  ds_read_b128 v[164:167], v18 offset:2048
  s_add_u32 s60, s60, 4
  v_mfma_f32_16x16x32_bf16 v[80:83], a[88:91], v[180:183], v[80:83]
  v_mfma_f32_16x16x32_bf16 v[84:87], a[92:95], v[180:183], v[84:87]
  s_waitcnt lgkmcnt(3)
  v_mfma_f32_16x16x32_bf16 v[88:91], a[84:87], v[184:187], v[88:91]
  ds_read_b128 v[168:171], v18 offset:4096
  v_mfma_f32_16x16x32_bf16 v[92:95], a[88:91], v[184:187], v[92:95]
  v_mfma_f32_16x16x32_bf16 v[96:99], a[92:95], v[184:187], v[96:99]
  s_waitcnt lgkmcnt(3)
  v_mfma_f32_16x16x32_bf16 v[100:103], a[84:87], v[188:191], v[100:103]
  ds_read_b128 v[172:175], v18 offset:6144
  v_mfma_f32_16x16x32_bf16 v[104:107], a[88:91], v[188:191], v[104:107]
  v_mfma_f32_16x16x32_bf16 v[108:111], a[92:95], v[188:191], v[108:111]
  s_waitcnt lgkmcnt(3)
  v_mfma_f32_16x16x32_bf16 v[64:67], a[96:99], v[160:163], v[64:67]
  ds_read_b128 v[176:179], v19 offset:0
  v_mfma_f32_16x16x32_bf16 v[68:71], a[100:103], v[160:163], v[68:71]
  s_add_u32 m0, s31, 114688
  v_mfma_f32_16x16x32_bf16 v[72:75], a[104:107], v[160:163], v[72:75]
  s_waitcnt lgkmcnt(3)
  buffer_load_dwordx4 v10, s[8:11], s30 offen lds
  v_mfma_f32_16x16x32_bf16 v[76:79], a[96:99], v[164:167], v[76:79]
  ds_read_b128 v[180:183], v19 offset:2048
  v_mfma_f32_16x16x32_bf16 v[80:83], a[100:103], v[164:167], v[80:83]
  v_mfma_f32_16x16x32_bf16 v[84:87], a[104:107], v[164:167], v[84:87]
  s_waitcnt lgkmcnt(3)
  v_mfma_f32_16x16x32_bf16 v[88:91], a[96:99], v[168:171], v[88:91]
  ds_read_b128 v[184:187], v19 offset:4096
  v_mfma_f32_16x16x32_bf16 v[92:95], a[100:103], v[168:171], v[92:95]
  s_add_u32 m0, s31, 115712
  v_mfma_f32_16x16x32_bf16 v[96:99], a[104:107], v[168:171], v[96:99]
  s_waitcnt lgkmcnt(3)
  buffer_load_dwordx4 v11, s[8:11], s30 offen lds
  v_mfma_f32_16x16x32_bf16 v[100:103], a[96:99], v[172:175], v[100:103]
  s_add_u32 s30, s30, 128
  ds_read_b128 v[188:191], v19 offset:6144
  v_mfma_f32_16x16x32_bf16 v[104:107], a[100:103], v[172:175], v[104:107]
  v_mfma_f32_16x16x32_bf16 v[108:111], a[104:107], v[172:175], v[108:111]
  s_waitcnt lgkmcnt(3)
  v_mfma_f32_16x16x32_bf16 v[64:67], a[108:111], v[176:179], v[64:67]
  s_waitcnt vmcnt(21)
  s_barrier
  ds_read_b128 v[160:163], v18 offset:8192
  v_mfma_f32_16x16x32_bf16 v[68:71], a[112:115], v[176:179], v[68:71]
  v_mfma_f32_16x16x32_bf16 v[72:75], a[116:119], v[176:179], v[72:75]
  s_waitcnt lgkmcnt(3)
  v_mfma_f32_16x16x32_bf16 v[76:79], a[108:111], v[180:183], v[76:79]
  ds_read_b128 v[164:167], v18 offset:10240
  v_mfma_f32_16x16x32_bf16 v[80:83], a[112:115], v[180:183], v[80:83]
  v_mfma_f32_16x16x32_bf16 v[84:87], a[116:119], v[180:183], v[84:87]
  s_waitcnt lgkmcnt(3)
  v_mfma_f32_16x16x32_bf16 v[88:91], a[108:111], v[184:187], v[88:91]
  ds_read_b128 v[168:171], v18 offset:12288
  v_mfma_f32_16x16x32_bf16 v[92:95], a[112:115], v[184:187], v[92:95]
  v_mfma_f32_16x16x32_bf16 v[96:99], a[116:119], v[184:187], v[96:99]
  s_waitcnt lgkmcnt(3)
  v_mfma_f32_16x16x32_bf16 v[100:103], a[108:111], v[188:191], v[100:103]
  ds_read_b128 v[172:175], v18 offset:14336
  v_mfma_f32_16x16x32_bf16 v[104:107], a[112:115], v[188:191], v[104:107]
  v_mfma_f32_16x16x32_bf16 v[108:111], a[116:119], v[188:191], v[108:111]
  s_waitcnt lgkmcnt(3)
  v_mfma_f32_16x16x32_bf16 v[64:67], a[120:123], v[160:163], v[64:67]
  ds_read_b128 v[176:179], v19 offset:8192
  v_mfma_f32_16x16x32_bf16 v[68:71], a[124:127], v[160:163], v[68:71]
  s_add_u32 m0, s31, 122880
  v_mfma_f32_16x16x32_bf16 v[72:75], a[128:131], v[160:163], v[72:75]
  s_waitcnt lgkmcnt(3)
  buffer_load_dwordx4 v10, s[8:11], s30 offen lds
  v_mfma_f32_16x16x32_bf16 v[76:79], a[120:123], v[164:167], v[76:79]
  ds_read_b128 v[180:183], v19 offset:10240
  v_mfma_f32_16x16x32_bf16 v[80:83], a[124:127], v[164:167], v[80:83]
  v_mfma_f32_16x16x32_bf16 v[84:87], a[128:131], v[164:167], v[84:87]
  s_waitcnt lgkmcnt(3)
  v_mfma_f32_16x16x32_bf16 v[88:91], a[120:123], v[168:171], v[88:91]
  ds_read_b128 v[184:187], v19 offset:12288
  v_mfma_f32_16x16x32_bf16 v[92:95], a[124:127], v[168:171], v[92:95]
  s_add_u32 m0, s31, 123904
  v_mfma_f32_16x16x32_bf16 v[96:99], a[128:131], v[168:171], v[96:99]
  s_waitcnt lgkmcnt(3)
  buffer_load_dwordx4 v11, s[8:11], s30 offen lds
  v_mfma_f32_16x16x32_bf16 v[100:103], a[120:123], v[172:175], v[100:103]
  s_add_u32 s30, s30, 128
  ds_read_b128 v[188:191], v19 offset:14336
  v_mfma_f32_16x16x32_bf16 v[104:107], a[124:127], v[172:175], v[104:107]
  v_mfma_f32_16x16x32_bf16 v[108:111], a[128:131], v[172:175], v[108:111]
  s_waitcnt lgkmcnt(3)
  v_mfma_f32_16x16x32_bf16 v[64:67], a[132:135], v[176:179], v[64:67]
  s_waitcnt vmcnt(21)
  s_barrier
  ds_read_b128 v[160:163], v18 offset:16384
  v_mfma_f32_16x16x32_bf16 v[68:71], a[136:139], v[176:179], v[68:71]
  v_mfma_f32_16x16x32_bf16 v[72:75], a[140:143], v[176:179], v[72:75]
  s_waitcnt lgkmcnt(3)
  v_mfma_f32_16x16x32_bf16 v[76:79], a[132:135], v[180:183], v[76:79]
  ds_read_b128 v[164:167], v18 offset:18432
  v_mfma_f32_16x16x32_bf16 v[80:83], a[136:139], v[180:183], v[80:83]
  v_mfma_f32_16x16x32_bf16 v[84:87], a[140:143], v[180:183], v[84:87]
  s_waitcnt lgkmcnt(3)
  v_mfma_f32_16x16x32_bf16 v[88:91], a[132:135], v[184:187], v[88:91]
  ds_read_b128 v[168:171], v18 offset:20480
  v_mfma_f32_16x16x32_bf16 v[92:95], a[136:139], v[184:187], v[92:95]
  v_mfma_f32_16x16x32_bf16 v[96:99], a[140:143], v[184:187], v[96:99]
  s_waitcnt lgkmcnt(3)
  v_mfma_f32_16x16x32_bf16 v[100:103], a[132:135], v[188:191], v[100:103]
  ds_read_b128 v[172:175], v18 offset:22528
  v_mfma_f32_16x16x32_bf16 v[104:107], a[136:139], v[188:191], v[104:107]
  v_mfma_f32_16x16x32_bf16 v[108:111], a[140:143], v[188:191], v[108:111]
  s_waitcnt lgkmcnt(3)
  v_mfma_f32_16x16x32_bf16 v[64:67], a[144:147], v[160:163], v[64:67]
  ds_read_b128 v[176:179], v19 offset:16384
  v_mfma_f32_16x16x32_bf16 v[68:71], a[148:151], v[160:163], v[68:71]
  s_add_u32 m0, s31, 131072
  v_mfma_f32_16x16x32_bf16 v[72:75], a[152:155], v[160:163], v[72:75]
  s_waitcnt lgkmcnt(3)
  buffer_load_dwordx4 v10, s[8:11], s30 offen lds
  v_mfma_f32_16x16x32_bf16 v[76:79], a[144:147], v[164:167], v[76:79]
  ds_read_b128 v[180:183], v19 offset:18432
  v_mfma_f32_16x16x32_bf16 v[80:83], a[148:151], v[164:167], v[80:83]
  v_mfma_f32_16x16x32_bf16 v[84:87], a[152:155], v[164:167], v[84:87]
  s_waitcnt lgkmcnt(3)
  v_mfma_f32_16x16x32_bf16 v[88:91], a[144:147], v[168:171], v[88:91]
  ds_read_b128 v[184:187], v19 offset:20480
  v_mfma_f32_16x16x32_bf16 v[92:95], a[148:151], v[168:171], v[92:95]
  s_add_u32 m0, s31, 132096
  v_mfma_f32_16x16x32_bf16 v[96:99], a[152:155], v[168:171], v[96:99]
  s_waitcnt lgkmcnt(3)
  buffer_load_dwordx4 v11, s[8:11], s30 offen lds
  v_mfma_f32_16x16x32_bf16 v[100:103], a[144:147], v[172:175], v[100:103]
  s_add_u32 s30, s30, 128
  ds_read_b128 v[188:191], v19 offset:22528
  v_mfma_f32_16x16x32_bf16 v[104:107], a[148:151], v[172:175], v[104:107]
  v_mfma_f32_16x16x32_bf16 v[108:111], a[152:155], v[172:175], v[108:111]
  s_waitcnt lgkmcnt(3)
  v_mfma_f32_16x16x32_bf16 v[64:67], a[156:159], v[176:179], v[64:67]
  s_waitcnt vmcnt(21)
  s_barrier
  ds_read_b128 v[160:163], v18 offset:24576
  v_mfma_f32_16x16x32_bf16 v[68:71], a[160:163], v[176:179], v[68:71]
  v_mfma_f32_16x16x32_bf16 v[72:75], a[164:167], v[176:179], v[72:75]
  s_waitcnt lgkmcnt(3)
  v_mfma_f32_16x16x32_bf16 v[76:79], a[156:159], v[180:183], v[76:79]
  ds_read_b128 v[164:167], v18 offset:26624
  v_mfma_f32_16x16x32_bf16 v[80:83], a[160:163], v[180:183], v[80:83]
  v_mfma_f32_16x16x32_bf16 v[84:87], a[164:167], v[180:183], v[84:87]
  s_waitcnt lgkmcnt(3)
  v_mfma_f32_16x16x32_bf16 v[88:91], a[156:159], v[184:187], v[88:91]
  ds_read_b128 v[168:171], v18 offset:28672
  v_mfma_f32_16x16x32_bf16 v[92:95], a[160:163], v[184:187], v[92:95]
  v_mfma_f32_16x16x32_bf16 v[96:99], a[164:167], v[184:187], v[96:99]
  s_waitcnt lgkmcnt(3)
  v_mfma_f32_16x16x32_bf16 v[100:103], a[156:159], v[188:191], v[100:103]
  ds_read_b128 v[172:175], v18 offset:30720
  v_mfma_f32_16x16x32_bf16 v[104:107], a[160:163], v[188:191], v[104:107]
  v_mfma_f32_16x16x32_bf16 v[108:111], a[164:167], v[188:191], v[108:111]
  s_waitcnt lgkmcnt(3)
  v_mfma_f32_16x16x32_bf16 v[64:67], a[168:171], v[160:163], v[64:67]
  ds_read_b128 v[176:179], v19 offset:24576
  v_mfma_f32_16x16x32_bf16 v[68:71], a[172:175], v[160:163], v[68:71]
  s_add_u32 m0, s31, 139264
  v_mfma_f32_16x16x32_bf16 v[72:75], a[176:179], v[160:163], v[72:75]
  s_waitcnt lgkmcnt(3)
  buffer_load_dwordx4 v10, s[8:11], s30 offen lds
  v_mfma_f32_16x16x32_bf16 v[76:79], a[168:171], v[164:167], v[76:79]
  ds_read_b128 v[180:183], v19 offset:26624
  v_mfma_f32_16x16x32_bf16 v[80:83], a[172:175], v[164:167], v[80:83]
  v_mfma_f32_16x16x32_bf16 v[84:87], a[176:179], v[164:167], v[84:87]
  s_waitcnt lgkmcnt(3)
  v_mfma_f32_16x16x32_bf16 v[88:91], a[168:171], v[168:171], v[88:91]
  ds_read_b128 v[184:187], v19 offset:28672
  v_mfma_f32_16x16x32_bf16 v[92:95], a[172:175], v[168:171], v[92:95]
  s_add_u32 m0, s31, 140288
  v_mfma_f32_16x16x32_bf16 v[96:99], a[176:179], v[168:171], v[96:99]
  s_waitcnt lgkmcnt(3)
  buffer_load_dwordx4 v11, s[8:11], s30 offen lds
  v_mfma_f32_16x16x32_bf16 v[100:103], a[168:171], v[172:175], v[100:103]
  s_add_u32 s30, s30, 128
  ds_read_b128 v[188:191], v19 offset:30720
  v_mfma_f32_16x16x32_bf16 v[104:107], a[172:175], v[172:175], v[104:107]
  v_mfma_f32_16x16x32_bf16 v[108:111], a[176:179], v[172:175], v[108:111]
  s_waitcnt lgkmcnt(3)
  v_mfma_f32_16x16x32_bf16 v[64:67], a[180:183], v[176:179], v[64:67]
  s_waitcnt vmcnt(19)
  s_barrier
  ds_read_b128 v[160:163], v16 offset:16384
  v_mfma_f32_16x16x32_bf16 v[68:71], a[184:187], v[176:179], v[68:71]
  v_mfma_f32_16x16x32_bf16 v[72:75], a[188:191], v[176:179], v[72:75]
  s_waitcnt lgkmcnt(3)
  v_mfma_f32_16x16x32_bf16 v[76:79], a[180:183], v[180:183], v[76:79]
  ds_read_b128 v[164:167], v16 offset:18432
  v_mfma_f32_16x16x32_bf16 v[80:83], a[184:187], v[180:183], v[80:83]
  v_mfma_f32_16x16x32_bf16 v[84:87], a[188:191], v[180:183], v[84:87]
  s_waitcnt lgkmcnt(3)
  v_mfma_f32_16x16x32_bf16 v[88:91], a[180:183], v[184:187], v[88:91]
  ds_read_b128 v[168:171], v16 offset:20480
  v_mfma_f32_16x16x32_bf16 v[92:95], a[184:187], v[184:187], v[92:95]
  v_mfma_f32_16x16x32_bf16 v[96:99], a[188:191], v[184:187], v[96:99]
  s_waitcnt lgkmcnt(3)
  v_mfma_f32_16x16x32_bf16 v[100:103], a[180:183], v[188:191], v[100:103]
  ds_read_b128 v[172:175], v16 offset:22528
  v_mfma_f32_16x16x32_bf16 v[104:107], a[184:187], v[188:191], v[104:107]
  v_mfma_f32_16x16x32_bf16 v[108:111], a[188:191], v[188:191], v[108:111]
  s_waitcnt lgkmcnt(3)
  v_mfma_f32_16x16x32_bf16 v[64:67], a[192:195], v[160:163], v[64:67]
  ds_read_b128 v[176:179], v17 offset:16384
  v_mfma_f32_16x16x32_bf16 v[68:71], a[196:199], v[160:163], v[68:71]
  s_add_u32 m0, s31, 147456
  v_mfma_f32_16x16x32_bf16 v[72:75], a[200:203], v[160:163], v[72:75]
  s_waitcnt lgkmcnt(3)
  buffer_load_dwordx4 v10, s[8:11], s30 offen lds
  v_mfma_f32_16x16x32_bf16 v[76:79], a[192:195], v[164:167], v[76:79]
  ds_read_b128 v[180:183], v17 offset:18432
  v_mfma_f32_16x16x32_bf16 v[80:83], a[196:199], v[164:167], v[80:83]
  v_mfma_f32_16x16x32_bf16 v[84:87], a[200:203], v[164:167], v[84:87]
  s_waitcnt lgkmcnt(3)
  v_mfma_f32_16x16x32_bf16 v[88:91], a[192:195], v[168:171], v[88:91]
  ds_read_b128 v[184:187], v17 offset:20480
  v_mfma_f32_16x16x32_bf16 v[92:95], a[196:199], v[168:171], v[92:95]
  s_add_u32 m0, s31, 148480
  v_mfma_f32_16x16x32_bf16 v[96:99], a[200:203], v[168:171], v[96:99]
  s_waitcnt lgkmcnt(3)
  buffer_load_dwordx4 v11, s[8:11], s30 offen lds
  v_mfma_f32_16x16x32_bf16 v[100:103], a[192:195], v[172:175], v[100:103]
  s_add_u32 s30, s30, 128
  ds_read_b128 v[188:191], v17 offset:22528
  v_mfma_f32_16x16x32_bf16 v[104:107], a[196:199], v[172:175], v[104:107]
  v_mfma_f32_16x16x32_bf16 v[108:111], a[200:203], v[172:175], v[108:111]
  s_waitcnt lgkmcnt(3)
  v_mfma_f32_16x16x32_bf16 v[64:67], a[204:207], v[176:179], v[64:67]
  s_waitcnt vmcnt(15)
  s_barrier
  ds_read_b128 v[160:163], v16 offset:24576
  v_mfma_f32_16x16x32_bf16 v[68:71], a[208:211], v[176:179], v[68:71]
  v_mfma_f32_16x16x32_bf16 v[72:75], a[212:215], v[176:179], v[72:75]
  s_waitcnt lgkmcnt(3)
  v_mfma_f32_16x16x32_bf16 v[76:79], a[204:207], v[180:183], v[76:79]
  ds_read_b128 v[164:167], v16 offset:26624
  v_mfma_f32_16x16x32_bf16 v[80:83], a[208:211], v[180:183], v[80:83]
  v_mfma_f32_16x16x32_bf16 v[84:87], a[212:215], v[180:183], v[84:87]
  s_waitcnt lgkmcnt(3)
  v_mfma_f32_16x16x32_bf16 v[88:91], a[204:207], v[184:187], v[88:91]
  ds_read_b128 v[168:171], v16 offset:28672
  v_mfma_f32_16x16x32_bf16 v[92:95], a[208:211], v[184:187], v[92:95]
  v_mfma_f32_16x16x32_bf16 v[96:99], a[212:215], v[184:187], v[96:99]
  s_waitcnt lgkmcnt(3)
  v_mfma_f32_16x16x32_bf16 v[100:103], a[204:207], v[188:191], v[100:103]
  ds_read_b128 v[172:175], v16 offset:30720
  v_mfma_f32_16x16x32_bf16 v[104:107], a[208:211], v[188:191], v[104:107]
  v_mfma_f32_16x16x32_bf16 v[108:111], a[212:215], v[188:191], v[108:111]
  s_waitcnt lgkmcnt(3)
  v_mfma_f32_16x16x32_bf16 v[64:67], a[216:219], v[160:163], v[64:67]
  ds_read_b128 v[176:179], v17 offset:24576
  v_mfma_f32_16x16x32_bf16 v[68:71], a[220:223], v[160:163], v[68:71]
  s_add_u32 m0, s31, 155648
  v_mfma_f32_16x16x32_bf16 v[72:75], a[224:227], v[160:163], v[72:75]
  s_waitcnt lgkmcnt(3)
  buffer_load_dwordx4 v10, s[8:11], s30 offen lds
  v_mfma_f32_16x16x32_bf16 v[76:79], a[216:219], v[164:167], v[76:79]
  ds_read_b128 v[180:183], v17 offset:26624
  v_mfma_f32_16x16x32_bf16 v[80:83], a[220:223], v[164:167], v[80:83]
  v_mfma_f32_16x16x32_bf16 v[84:87], a[224:227], v[164:167], v[84:87]
  s_waitcnt lgkmcnt(3)
  v_mfma_f32_16x16x32_bf16 v[88:91], a[216:219], v[168:171], v[88:91]
  ds_read_b128 v[184:187], v17 offset:28672
  v_mfma_f32_16x16x32_bf16 v[92:95], a[220:223], v[168:171], v[92:95]
  s_add_u32 m0, s31, 156672
  v_mfma_f32_16x16x32_bf16 v[96:99], a[224:227], v[168:171], v[96:99]
  s_waitcnt lgkmcnt(3)
  buffer_load_dwordx4 v11, s[8:11], s30 offen lds
  v_mfma_f32_16x16x32_bf16 v[100:103], a[216:219], v[172:175], v[100:103]
  s_add_u32 s30, s30, 128
  ds_read_b128 v[188:191], v17 offset:30720
  v_mfma_f32_16x16x32_bf16 v[104:107], a[220:223], v[172:175], v[104:107]
  v_mfma_f32_16x16x32_bf16 v[108:111], a[224:227], v[172:175], v[108:111]
  s_waitcnt lgkmcnt(3)
  v_mfma_f32_16x16x32_bf16 v[64:67], a[228:231], v[176:179], v[64:67]
  s_waitcnt vmcnt(15)
  s_barrier
  ds_read_b128 v[160:163], v16 offset:32768
  v_mfma_f32_16x16x32_bf16 v[68:71], a[232:235], v[176:179], v[68:71]
  v_mfma_f32_16x16x32_bf16 v[72:75], a[236:239], v[176:179], v[72:75]
  s_waitcnt lgkmcnt(3)
  v_mfma_f32_16x16x32_bf16 v[76:79], a[228:231], v[180:183], v[76:79]
  ds_read_b128 v[164:167], v16 offset:34816
  v_cvt_pk_bf16_f32 v192, v64, v65
  v_mfma_f32_16x16x32_bf16 v[80:83], a[232:235], v[180:183], v[80:83]
  v_cvt_pk_bf16_f32 v193, v66, v67
  v_cvt_pk_bf16_f32 v194, v68, v69
  v_mfma_f32_16x16x32_bf16 v[84:87], a[236:239], v[180:183], v[84:87]
  s_waitcnt lgkmcnt(3)
  v_cvt_pk_bf16_f32 v195, v70, v71
  v_cvt_pk_bf16_f32 v200, v72, v73
  v_mfma_f32_16x16x32_bf16 v[88:91], a[228:231], v[184:187], v[88:91]
  ds_read_b128 v[168:171], v16 offset:36864
  v_cvt_pk_bf16_f32 v201, v74, v75
  v_mfma_f32_16x16x32_bf16 v[92:95], a[232:235], v[184:187], v[92:95]
  v_cvt_pk_bf16_f32 v196, v76, v77
  v_cvt_pk_bf16_f32 v197, v78, v79
  v_mfma_f32_16x16x32_bf16 v[96:99], a[236:239], v[184:187], v[96:99]
  s_waitcnt lgkmcnt(3)
  v_cvt_pk_bf16_f32 v198, v80, v81
  v_cvt_pk_bf16_f32 v199, v82, v83
  v_mfma_f32_16x16x32_bf16 v[100:103], a[228:231], v[188:191], v[100:103]
  ds_read_b128 v[172:175], v16 offset:38912
  v_cvt_pk_bf16_f32 v202, v84, v85
  v_mfma_f32_16x16x32_bf16 v[104:107], a[232:235], v[188:191], v[104:107]
  s_sub_u32 s26, s26, 1
  s_cmp_gt_u32 s26, 0
  v_cvt_pk_bf16_f32 v203, v86, v87
  v_mfma_f32_16x16x32_bf16 v[108:111], a[236:239], v[188:191], v[108:111]
  s_waitcnt lgkmcnt(3)
  s_cbranch_scc1 kvm_240
  s_nop 7
  v_cvt_pk_bf16_f32 v204, v88, v89
  v_cvt_pk_bf16_f32 v205, v90, v91
  v_cvt_pk_bf16_f32 v206, v92, v93
  v_cvt_pk_bf16_f32 v207, v94, v95
  v_cvt_pk_bf16_f32 v212, v96, v97
  v_cvt_pk_bf16_f32 v213, v98, v99
  v_cvt_pk_bf16_f32 v208, v100, v101
  v_cvt_pk_bf16_f32 v209, v102, v103
  v_cvt_pk_bf16_f32 v210, v104, v105
  v_cvt_pk_bf16_f32 v211, v106, v107
  v_cvt_pk_bf16_f32 v214, v108, v109
  v_cvt_pk_bf16_f32 v215, v110, v111
  s_xor_b32 s29, s48, 0
  buffer_store_dwordx4 v[192:195], v26, s[16:19], s29 offen offset:0 sc1
  buffer_store_dwordx4 v[196:199], v26, s[16:19], s29 offen offset:1024 sc1
  buffer_store_dwordx4 v[200:203], v26, s[16:19], s29 offen offset:2048 sc1
  s_xor_b32 s29, s48, 2105344
  buffer_store_dwordx4 v[204:207], v26, s[16:19], s29 offen offset:0 sc1
  buffer_store_dwordx4 v[208:211], v26, s[16:19], s29 offen offset:1024 sc1
  buffer_store_dwordx4 v[212:215], v26, s[16:19], s29 offen offset:2048 sc1
  s_mov_b32 s30, 491520
  s_mov_b32 s25, 162688
  v_lshrrev_b32 v4, 3, v1
  v_and_b32 v5, 7, v1
  v_xor_b32 v5, v5, v4
  s_mul_i32 s21, s20, 32
  v_add_u32 v4, s21, v4
  v_mul_u32_u24 v4, 1280, v4
  v_lshl_add_u32 v10, v5, 4, v4
  s_mul_i32 s31, s20, 4096
  v_add_u32 v11, 10240, v10
  v_add_u32 v12, 20480, v10
  v_add_u32 v13, 30720, v10
  s_add_u32 m0, s31, 0
  s_nop 0
  buffer_load_dwordx4 v10, s[8:11], s30 offen lds
  s_add_u32 m0, s31, 1024
  s_nop 0
  buffer_load_dwordx4 v11, s[8:11], s30 offen lds
  s_add_u32 m0, s31, 2048
  s_nop 0
  buffer_load_dwordx4 v12, s[8:11], s30 offen lds
  s_add_u32 m0, s31, 3072
  s_nop 0
  buffer_load_dwordx4 v13, s[8:11], s30 offen lds
  s_add_u32 s30, s30, 128
  s_add_u32 m0, s31, 16384
  s_nop 0
  buffer_load_dwordx4 v10, s[8:11], s30 offen lds
  s_add_u32 m0, s31, 17408
  s_nop 0
  buffer_load_dwordx4 v11, s[8:11], s30 offen lds
  s_add_u32 m0, s31, 18432
  s_nop 0
  buffer_load_dwordx4 v12, s[8:11], s30 offen lds
  s_add_u32 m0, s31, 19456
  s_nop 0
  buffer_load_dwordx4 v13, s[8:11], s30 offen lds
  s_add_u32 s30, s30, 128
  s_add_u32 m0, s31, 32768
  s_nop 0
  buffer_load_dwordx4 v10, s[8:11], s30 offen lds
  s_add_u32 m0, s31, 33792
  s_nop 0
  buffer_load_dwordx4 v11, s[8:11], s30 offen lds
  s_add_u32 m0, s31, 34816
  s_nop 0
  buffer_load_dwordx4 v12, s[8:11], s30 offen lds
  s_add_u32 m0, s31, 35840
  s_nop 0
  buffer_load_dwordx4 v13, s[8:11], s30 offen lds
  s_add_u32 s30, s30, 128
  s_add_u32 m0, s31, 49152
  s_nop 0
  buffer_load_dwordx4 v10, s[8:11], s30 offen lds
  s_add_u32 m0, s31, 50176
  s_nop 0
  buffer_load_dwordx4 v11, s[8:11], s30 offen lds
  s_add_u32 m0, s31, 51200
  s_nop 0
  buffer_load_dwordx4 v12, s[8:11], s30 offen lds
  s_add_u32 m0, s31, 52224
  s_nop 0
  buffer_load_dwordx4 v13, s[8:11], s30 offen lds
  s_add_u32 s30, s30, 128
  s_add_u32 m0, s31, 65536
  s_nop 0
  buffer_load_dwordx4 v10, s[8:11], s30 offen lds
  s_add_u32 m0, s31, 66560
  s_nop 0
  buffer_load_dwordx4 v11, s[8:11], s30 offen lds
  s_add_u32 m0, s31, 67584
  s_nop 0
  buffer_load_dwordx4 v12, s[8:11], s30 offen lds
  s_add_u32 m0, s31, 68608
  s_nop 0
  buffer_load_dwordx4 v13, s[8:11], s30 offen lds
  s_add_u32 s30, s30, 128
  s_waitcnt vmcnt(20) lgkmcnt(0)
  s_barrier
  buffer_atomic_add v28, v27, s[72:75], s61 offen sc1
  s_add_u32 m0, s31, 81920
  s_nop 0
  buffer_load_dwordx4 v10, s[8:11], s30 offen lds
  s_add_u32 m0, s31, 82944
  s_nop 0
  buffer_load_dwordx4 v11, s[8:11], s30 offen lds
  s_add_u32 m0, s31, 83968
  s_nop 0
  buffer_load_dwordx4 v12, s[8:11], s30 offen lds
  s_add_u32 m0, s31, 84992
  s_nop 0
  buffer_load_dwordx4 v13, s[8:11], s30 offen lds
  s_add_u32 s30, s30, 128
  s_mov_b32 s26, 13
  s_mov_b32 s48, 0x40000000
  s_mov_b32 s61, 0x40000000
  s_waitcnt vmcnt(16)
  s_barrier
  ds_read_b128 v[160:163], v14 offset:0
  ds_read_b128 v[164:167], v14 offset:2048
  ds_read_b128 v[168:171], v14 offset:4096
  ds_read_b128 v[172:175], v14 offset:6144
  s_waitcnt lgkmcnt(3)
  .p2align 3
kvs_241:
  v_mfma_f32_16x16x32_bf16 v[64:67], a[0:3], v[160:163], 0
  s_xor_b32 s29, s48, 0
  ds_read_b128 v[176:179], v14 offset:8192
  v_cvt_pk_bf16_f32 v221, v126, v127
  v_mfma_f32_16x16x32_bf16 v[68:71], a[4:7], v[160:163], 0
  v_cvt_pk_bf16_f32 v222, v128, v129
  v_cvt_pk_bf16_f32 v223, v130, v131
  v_mfma_f32_16x16x32_bf16 v[72:75], a[8:11], v[160:163], 0
  s_waitcnt lgkmcnt(3)
  v_cvt_pk_bf16_f32 v226, v132, v133
  v_cvt_pk_bf16_f32 v227, v134, v135
  v_mfma_f32_16x16x32_bf16 v[76:79], a[0:3], v[164:167], 0
  ds_read_b128 v[180:183], v14 offset:10240
  v_cvt_pk_bf16_f32 v228, v136, v137
  v_mfma_f32_16x16x32_bf16 v[80:83], a[4:7], v[164:167], 0
  v_cvt_pk_bf16_f32 v229, v138, v139
  v_cvt_pk_bf16_f32 v230, v140, v141
  v_mfma_f32_16x16x32_bf16 v[84:87], a[8:11], v[164:167], 0
  s_waitcnt lgkmcnt(3)
  v_cvt_pk_bf16_f32 v231, v142, v143
  v_cvt_pk_bf16_f32 v236, v144, v145
  v_mfma_f32_16x16x32_bf16 v[88:91], a[0:3], v[168:171], 0
  ds_read_b128 v[184:187], v14 offset:12288
  v_cvt_pk_bf16_f32 v237, v146, v147
  v_mfma_f32_16x16x32_bf16 v[92:95], a[4:7], v[168:171], 0
  v_cvt_pk_bf16_f32 v232, v148, v149
  v_cvt_pk_bf16_f32 v233, v150, v151
  v_mfma_f32_16x16x32_bf16 v[96:99], a[8:11], v[168:171], 0
  s_waitcnt lgkmcnt(3)
  v_cvt_pk_bf16_f32 v234, v152, v153
  v_cvt_pk_bf16_f32 v235, v154, v155
  v_mfma_f32_16x16x32_bf16 v[100:103], a[0:3], v[172:175], 0
  ds_read_b128 v[188:191], v14 offset:14336
  v_cvt_pk_bf16_f32 v238, v156, v157
  v_mfma_f32_16x16x32_bf16 v[104:107], a[4:7], v[172:175], 0
  v_cvt_pk_bf16_f32 v239, v158, v159
  v_mfma_f32_16x16x32_bf16 v[108:111], a[8:11], v[172:175], 0
  s_waitcnt lgkmcnt(3)
  v_mfma_f32_16x16x32_bf16 v[112:115], a[0:3], v[176:179], 0
  ds_read_b128 v[160:163], v15 offset:0
  v_mfma_f32_16x16x32_bf16 v[116:119], a[4:7], v[176:179], 0
  s_add_u32 m0, s31, 98304
  v_mfma_f32_16x16x32_bf16 v[120:123], a[8:11], v[176:179], 0
  s_waitcnt lgkmcnt(3)
  buffer_load_dwordx4 v10, s[8:11], s30 offen lds
  v_mfma_f32_16x16x32_bf16 v[124:127], a[0:3], v[180:183], 0
  ds_read_b128 v[164:167], v15 offset:2048
  v_mfma_f32_16x16x32_bf16 v[128:131], a[4:7], v[180:183], 0
  v_mfma_f32_16x16x32_bf16 v[132:135], a[8:11], v[180:183], 0
  s_waitcnt lgkmcnt(3)
  v_mfma_f32_16x16x32_bf16 v[136:139], a[0:3], v[184:187], 0
  ds_read_b128 v[168:171], v15 offset:4096
  v_mfma_f32_16x16x32_bf16 v[140:143], a[4:7], v[184:187], 0
  s_add_u32 m0, s31, 99328
  v_mfma_f32_16x16x32_bf16 v[144:147], a[8:11], v[184:187], 0
  s_waitcnt lgkmcnt(3)
  buffer_load_dwordx4 v11, s[8:11], s30 offen lds
  v_mfma_f32_16x16x32_bf16 v[148:151], a[0:3], v[188:191], 0
  ds_read_b128 v[172:175], v15 offset:6144
  v_mfma_f32_16x16x32_bf16 v[152:155], a[4:7], v[188:191], 0
  v_mfma_f32_16x16x32_bf16 v[156:159], a[8:11], v[188:191], 0
  s_waitcnt lgkmcnt(3)
  v_mfma_f32_16x16x32_bf16 v[64:67], a[12:15], v[160:163], v[64:67]
  ds_read_b128 v[176:179], v15 offset:8192
  v_mfma_f32_16x16x32_bf16 v[68:71], a[16:19], v[160:163], v[68:71]
  s_add_u32 m0, s31, 100352
  v_mfma_f32_16x16x32_bf16 v[72:75], a[20:23], v[160:163], v[72:75]
  s_waitcnt lgkmcnt(3)
  buffer_load_dwordx4 v12, s[8:11], s30 offen lds
  v_mfma_f32_16x16x32_bf16 v[76:79], a[12:15], v[164:167], v[76:79]
  ds_read_b128 v[180:183], v15 offset:10240
  v_mfma_f32_16x16x32_bf16 v[80:83], a[16:19], v[164:167], v[80:83]
  v_mfma_f32_16x16x32_bf16 v[84:87], a[20:23], v[164:167], v[84:87]
  s_waitcnt lgkmcnt(3)
  v_mfma_f32_16x16x32_bf16 v[88:91], a[12:15], v[168:171], v[88:91]
  ds_read_b128 v[184:187], v15 offset:12288
  v_mfma_f32_16x16x32_bf16 v[92:95], a[16:19], v[168:171], v[92:95]
  s_add_u32 m0, s31, 101376
  v_mfma_f32_16x16x32_bf16 v[96:99], a[20:23], v[168:171], v[96:99]
  s_waitcnt lgkmcnt(3)
  buffer_load_dwordx4 v13, s[8:11], s30 offen lds
  v_mfma_f32_16x16x32_bf16 v[100:103], a[12:15], v[172:175], v[100:103]
  s_add_u32 s30, s30, 128
  ds_read_b128 v[188:191], v15 offset:14336
  v_mfma_f32_16x16x32_bf16 v[104:107], a[16:19], v[172:175], v[104:107]
  v_mfma_f32_16x16x32_bf16 v[108:111], a[20:23], v[172:175], v[108:111]
  s_waitcnt lgkmcnt(3)
  v_mfma_f32_16x16x32_bf16 v[112:115], a[12:15], v[176:179], v[112:115]
  ds_read_b128 v[160:163], v14 offset:16384
  v_mfma_f32_16x16x32_bf16 v[116:119], a[16:19], v[176:179], v[116:119]
  buffer_store_dwordx4 v[192:195], v26, s[16:19], s29 offen offset:0 sc1
  v_mfma_f32_16x16x32_bf16 v[120:123], a[20:23], v[176:179], v[120:123]
  s_waitcnt lgkmcnt(3)
  v_mfma_f32_16x16x32_bf16 v[124:127], a[12:15], v[180:183], v[124:127]
  ds_read_b128 v[164:167], v14 offset:18432
  v_mfma_f32_16x16x32_bf16 v[128:131], a[16:19], v[180:183], v[128:131]
  v_mfma_f32_16x16x32_bf16 v[132:135], a[20:23], v[180:183], v[132:135]
  s_waitcnt lgkmcnt(3)
  v_mfma_f32_16x16x32_bf16 v[136:139], a[12:15], v[184:187], v[136:139]
  ds_read_b128 v[168:171], v14 offset:20480
  buffer_store_dwordx4 v[196:199], v26, s[16:19], s29 offen offset:1024 sc1
  v_mfma_f32_16x16x32_bf16 v[140:143], a[16:19], v[184:187], v[140:143]
  v_mfma_f32_16x16x32_bf16 v[144:147], a[20:23], v[184:187], v[144:147]
  s_waitcnt lgkmcnt(3)
  v_mfma_f32_16x16x32_bf16 v[148:151], a[12:15], v[188:191], v[148:151]
  ds_read_b128 v[172:175], v14 offset:22528
  v_mfma_f32_16x16x32_bf16 v[152:155], a[16:19], v[188:191], v[152:155]
  v_mfma_f32_16x16x32_bf16 v[156:159], a[20:23], v[188:191], v[156:159]
  s_waitcnt lgkmcnt(3)
  v_mfma_f32_16x16x32_bf16 v[64:67], a[24:27], v[160:163], v[64:67]
  ds_read_b128 v[176:179], v14 offset:24576
  v_mfma_f32_16x16x32_bf16 v[68:71], a[28:31], v[160:163], v[68:71]
  s_add_u32 m0, s31, 114688
  v_mfma_f32_16x16x32_bf16 v[72:75], a[32:35], v[160:163], v[72:75]
  s_waitcnt lgkmcnt(3)
  buffer_load_dwordx4 v10, s[8:11], s30 offen lds
  v_mfma_f32_16x16x32_bf16 v[76:79], a[24:27], v[164:167], v[76:79]
  ds_read_b128 v[180:183], v14 offset:26624
  v_mfma_f32_16x16x32_bf16 v[80:83], a[28:31], v[164:167], v[80:83]
  v_mfma_f32_16x16x32_bf16 v[84:87], a[32:35], v[164:167], v[84:87]
  s_waitcnt lgkmcnt(3)
  v_mfma_f32_16x16x32_bf16 v[88:91], a[24:27], v[168:171], v[88:91]
  ds_read_b128 v[184:187], v14 offset:28672
  v_mfma_f32_16x16x32_bf16 v[92:95], a[28:31], v[168:171], v[92:95]
  buffer_store_dwordx4 v[200:203], v26, s[16:19], s29 offen offset:2048 sc1
  v_mfma_f32_16x16x32_bf16 v[96:99], a[32:35], v[168:171], v[96:99]
  s_waitcnt lgkmcnt(3)
  v_mfma_f32_16x16x32_bf16 v[100:103], a[24:27], v[172:175], v[100:103]
  ds_read_b128 v[188:191], v14 offset:30720
  v_mfma_f32_16x16x32_bf16 v[104:107], a[28:31], v[172:175], v[104:107]
  v_mfma_f32_16x16x32_bf16 v[108:111], a[32:35], v[172:175], v[108:111]
  s_xor_b32 s29, s48, 2105344
  s_waitcnt lgkmcnt(3)
  v_mfma_f32_16x16x32_bf16 v[112:115], a[24:27], v[176:179], v[112:115]
  ds_read_b128 v[160:163], v15 offset:16384
  v_mfma_f32_16x16x32_bf16 v[116:119], a[28:31], v[176:179], v[116:119]
  s_add_u32 m0, s31, 115712
  v_mfma_f32_16x16x32_bf16 v[120:123], a[32:35], v[176:179], v[120:123]
  s_waitcnt lgkmcnt(3)
  buffer_load_dwordx4 v11, s[8:11], s30 offen lds
  v_mfma_f32_16x16x32_bf16 v[124:127], a[24:27], v[180:183], v[124:127]
  ds_read_b128 v[164:167], v15 offset:18432
  v_mfma_f32_16x16x32_bf16 v[128:131], a[28:31], v[180:183], v[128:131]
  v_mfma_f32_16x16x32_bf16 v[132:135], a[32:35], v[180:183], v[132:135]
  s_waitcnt lgkmcnt(3)
  v_mfma_f32_16x16x32_bf16 v[136:139], a[24:27], v[184:187], v[136:139]
  ds_read_b128 v[168:171], v15 offset:20480
  v_mfma_f32_16x16x32_bf16 v[140:143], a[28:31], v[184:187], v[140:143]
  buffer_store_dwordx4 v[204:207], v26, s[16:19], s29 offen offset:0 sc1
  v_mfma_f32_16x16x32_bf16 v[144:147], a[32:35], v[184:187], v[144:147]
  s_waitcnt lgkmcnt(3)
  v_mfma_f32_16x16x32_bf16 v[148:151], a[24:27], v[188:191], v[148:151]
  ds_read_b128 v[172:175], v15 offset:22528
  v_mfma_f32_16x16x32_bf16 v[152:155], a[28:31], v[188:191], v[152:155]
  v_mfma_f32_16x16x32_bf16 v[156:159], a[32:35], v[188:191], v[156:159]
  s_waitcnt lgkmcnt(3)
  v_mfma_f32_16x16x32_bf16 v[64:67], a[36:39], v[160:163], v[64:67]
  ds_read_b128 v[176:179], v15 offset:24576
  v_mfma_f32_16x16x32_bf16 v[68:71], a[40:43], v[160:163], v[68:71]
  s_add_u32 m0, s31, 116736
  v_mfma_f32_16x16x32_bf16 v[72:75], a[44:47], v[160:163], v[72:75]
  s_waitcnt lgkmcnt(3)
  buffer_load_dwordx4 v12, s[8:11], s30 offen lds
  v_mfma_f32_16x16x32_bf16 v[76:79], a[36:39], v[164:167], v[76:79]
  ds_read_b128 v[180:183], v15 offset:26624
  v_mfma_f32_16x16x32_bf16 v[80:83], a[40:43], v[164:167], v[80:83]
  v_mfma_f32_16x16x32_bf16 v[84:87], a[44:47], v[164:167], v[84:87]
  s_waitcnt lgkmcnt(3)
  v_mfma_f32_16x16x32_bf16 v[88:91], a[36:39], v[168:171], v[88:91]
  ds_read_b128 v[184:187], v15 offset:28672
  v_mfma_f32_16x16x32_bf16 v[92:95], a[40:43], v[168:171], v[92:95]
  buffer_store_dwordx4 v[208:211], v26, s[16:19], s29 offen offset:1024 sc1
  v_mfma_f32_16x16x32_bf16 v[96:99], a[44:47], v[168:171], v[96:99]
  s_waitcnt lgkmcnt(3)
  v_mfma_f32_16x16x32_bf16 v[100:103], a[36:39], v[172:175], v[100:103]
  ds_read_b128 v[188:191], v15 offset:30720
  v_mfma_f32_16x16x32_bf16 v[104:107], a[40:43], v[172:175], v[104:107]
  v_mfma_f32_16x16x32_bf16 v[108:111], a[44:47], v[172:175], v[108:111]
  s_waitcnt lgkmcnt(3)
  v_mfma_f32_16x16x32_bf16 v[112:115], a[36:39], v[176:179], v[112:115]
  s_waitcnt vmcnt(20)
  s_barrier
  ds_read_b128 v[160:163], v14 offset:32768
  v_mfma_f32_16x16x32_bf16 v[116:119], a[40:43], v[176:179], v[116:119]
  s_add_u32 m0, s31, 117760
  v_mfma_f32_16x16x32_bf16 v[120:123], a[44:47], v[176:179], v[120:123]
  s_waitcnt lgkmcnt(3)
  buffer_load_dwordx4 v13, s[8:11], s30 offen lds
  v_mfma_f32_16x16x32_bf16 v[124:127], a[36:39], v[180:183], v[124:127]
  s_add_u32 s30, s30, 128
  ds_read_b128 v[164:167], v14 offset:34816
  v_mfma_f32_16x16x32_bf16 v[128:131], a[40:43], v[180:183], v[128:131]
  v_mfma_f32_16x16x32_bf16 v[132:135], a[44:47], v[180:183], v[132:135]
  s_waitcnt lgkmcnt(3)
  v_mfma_f32_16x16x32_bf16 v[136:139], a[36:39], v[184:187], v[136:139]
  ds_read_b128 v[168:171], v14 offset:36864
  v_mfma_f32_16x16x32_bf16 v[140:143], a[40:43], v[184:187], v[140:143]
  buffer_store_dwordx4 v[212:215], v26, s[16:19], s29 offen offset:2048 sc1
  v_mfma_f32_16x16x32_bf16 v[144:147], a[44:47], v[184:187], v[144:147]
  s_waitcnt lgkmcnt(3)
  v_mfma_f32_16x16x32_bf16 v[148:151], a[36:39], v[188:191], v[148:151]
  ds_read_b128 v[172:175], v14 offset:38912
  v_mfma_f32_16x16x32_bf16 v[152:155], a[40:43], v[188:191], v[152:155]
  v_mfma_f32_16x16x32_bf16 v[156:159], a[44:47], v[188:191], v[156:159]
  s_xor_b32 s29, s48, 4194304
  s_waitcnt lgkmcnt(3)
  v_mfma_f32_16x16x32_bf16 v[64:67], a[48:51], v[160:163], v[64:67]
  ds_read_b128 v[176:179], v14 offset:40960
  v_mfma_f32_16x16x32_bf16 v[68:71], a[52:55], v[160:163], v[68:71]
  s_add_u32 m0, s31, 131072
  v_mfma_f32_16x16x32_bf16 v[72:75], a[56:59], v[160:163], v[72:75]
  s_waitcnt lgkmcnt(3)
  buffer_load_dwordx4 v10, s[8:11], s30 offen lds
  v_mfma_f32_16x16x32_bf16 v[76:79], a[48:51], v[164:167], v[76:79]
  ds_read_b128 v[180:183], v14 offset:43008
  v_mfma_f32_16x16x32_bf16 v[80:83], a[52:55], v[164:167], v[80:83]
  v_mfma_f32_16x16x32_bf16 v[84:87], a[56:59], v[164:167], v[84:87]
  s_waitcnt lgkmcnt(3)
  v_mfma_f32_16x16x32_bf16 v[88:91], a[48:51], v[168:171], v[88:91]
  ds_read_b128 v[184:187], v14 offset:45056
  v_mfma_f32_16x16x32_bf16 v[92:95], a[52:55], v[168:171], v[92:95]
  buffer_store_dwordx4 v[216:219], v26, s[16:19], s29 offen offset:0 sc1
  v_mfma_f32_16x16x32_bf16 v[96:99], a[56:59], v[168:171], v[96:99]
  s_waitcnt lgkmcnt(3)
  v_mfma_f32_16x16x32_bf16 v[100:103], a[48:51], v[172:175], v[100:103]
  ds_read_b128 v[188:191], v14 offset:47104
  v_mfma_f32_16x16x32_bf16 v[104:107], a[52:55], v[172:175], v[104:107]
  v_mfma_f32_16x16x32_bf16 v[108:111], a[56:59], v[172:175], v[108:111]
  s_waitcnt lgkmcnt(3)
  v_mfma_f32_16x16x32_bf16 v[112:115], a[48:51], v[176:179], v[112:115]
  ds_read_b128 v[160:163], v15 offset:32768
  v_mfma_f32_16x16x32_bf16 v[116:119], a[52:55], v[176:179], v[116:119]
  s_add_u32 m0, s31, 132096
  v_mfma_f32_16x16x32_bf16 v[120:123], a[56:59], v[176:179], v[120:123]
  s_waitcnt lgkmcnt(3)
  buffer_load_dwordx4 v11, s[8:11], s30 offen lds
  v_mfma_f32_16x16x32_bf16 v[124:127], a[48:51], v[180:183], v[124:127]
  ds_read_b128 v[164:167], v15 offset:34816
  v_mfma_f32_16x16x32_bf16 v[128:131], a[52:55], v[180:183], v[128:131]
  v_mfma_f32_16x16x32_bf16 v[132:135], a[56:59], v[180:183], v[132:135]
  s_waitcnt lgkmcnt(3)
  v_mfma_f32_16x16x32_bf16 v[136:139], a[48:51], v[184:187], v[136:139]
  ds_read_b128 v[168:171], v15 offset:36864
  v_mfma_f32_16x16x32_bf16 v[140:143], a[52:55], v[184:187], v[140:143]
  buffer_store_dwordx4 v[220:223], v26, s[16:19], s29 offen offset:1024 sc1
  v_mfma_f32_16x16x32_bf16 v[144:147], a[56:59], v[184:187], v[144:147]
  s_waitcnt lgkmcnt(3)
  v_mfma_f32_16x16x32_bf16 v[148:151], a[48:51], v[188:191], v[148:151]
  ds_read_b128 v[172:175], v15 offset:38912
  v_mfma_f32_16x16x32_bf16 v[152:155], a[52:55], v[188:191], v[152:155]
  v_mfma_f32_16x16x32_bf16 v[156:159], a[56:59], v[188:191], v[156:159]
  s_waitcnt lgkmcnt(3)
  v_mfma_f32_16x16x32_bf16 v[64:67], a[60:63], v[160:163], v[64:67]
  ds_read_b128 v[176:179], v15 offset:40960
  v_mfma_f32_16x16x32_bf16 v[68:71], a[64:67], v[160:163], v[68:71]
  s_add_u32 m0, s31, 133120
  v_mfma_f32_16x16x32_bf16 v[72:75], a[68:71], v[160:163], v[72:75]
  s_waitcnt lgkmcnt(3)
  buffer_load_dwordx4 v12, s[8:11], s30 offen lds
  v_mfma_f32_16x16x32_bf16 v[76:79], a[60:63], v[164:167], v[76:79]
  ds_read_b128 v[180:183], v15 offset:43008
  v_mfma_f32_16x16x32_bf16 v[80:83], a[64:67], v[164:167], v[80:83]
  v_mfma_f32_16x16x32_bf16 v[84:87], a[68:71], v[164:167], v[84:87]
  s_waitcnt lgkmcnt(3)
  v_mfma_f32_16x16x32_bf16 v[88:91], a[60:63], v[168:171], v[88:91]
  ds_read_b128 v[184:187], v15 offset:45056
  v_mfma_f32_16x16x32_bf16 v[92:95], a[64:67], v[168:171], v[92:95]
  buffer_store_dwordx4 v[224:227], v26, s[16:19], s29 offen offset:2048 sc1
  v_mfma_f32_16x16x32_bf16 v[96:99], a[68:71], v[168:171], v[96:99]
  s_waitcnt lgkmcnt(3)
  v_mfma_f32_16x16x32_bf16 v[100:103], a[60:63], v[172:175], v[100:103]
  ds_read_b128 v[188:191], v15 offset:47104
  v_mfma_f32_16x16x32_bf16 v[104:107], a[64:67], v[172:175], v[104:107]
  v_mfma_f32_16x16x32_bf16 v[108:111], a[68:71], v[172:175], v[108:111]
  s_xor_b32 s29, s48, 6299648
  s_waitcnt lgkmcnt(3)
  v_mfma_f32_16x16x32_bf16 v[112:115], a[60:63], v[176:179], v[112:115]
  ds_read_b128 v[160:163], v14 offset:49152
  v_mfma_f32_16x16x32_bf16 v[116:119], a[64:67], v[176:179], v[116:119]
  s_add_u32 m0, s31, 134144
  v_mfma_f32_16x16x32_bf16 v[120:123], a[68:71], v[176:179], v[120:123]
  s_waitcnt lgkmcnt(3)
  buffer_load_dwordx4 v13, s[8:11], s30 offen lds
  v_mfma_f32_16x16x32_bf16 v[124:127], a[60:63], v[180:183], v[124:127]
  s_add_u32 s30, s30, 128
  ds_read_b128 v[164:167], v14 offset:51200
  v_mfma_f32_16x16x32_bf16 v[128:131], a[64:67], v[180:183], v[128:131]
  v_mfma_f32_16x16x32_bf16 v[132:135], a[68:71], v[180:183], v[132:135]
  s_waitcnt lgkmcnt(3)
  v_mfma_f32_16x16x32_bf16 v[136:139], a[60:63], v[184:187], v[136:139]
  ds_read_b128 v[168:171], v14 offset:53248
  v_mfma_f32_16x16x32_bf16 v[140:143], a[64:67], v[184:187], v[140:143]
  buffer_store_dwordx4 v[228:231], v26, s[16:19], s29 offen offset:0 sc1
  v_mfma_f32_16x16x32_bf16 v[144:147], a[68:71], v[184:187], v[144:147]
  s_waitcnt lgkmcnt(3)
  v_mfma_f32_16x16x32_bf16 v[148:151], a[60:63], v[188:191], v[148:151]
  ds_read_b128 v[172:175], v14 offset:55296
  v_mfma_f32_16x16x32_bf16 v[152:155], a[64:67], v[188:191], v[152:155]
  v_mfma_f32_16x16x32_bf16 v[156:159], a[68:71], v[188:191], v[156:159]
  s_waitcnt lgkmcnt(3)
  v_mfma_f32_16x16x32_bf16 v[64:67], a[72:75], v[160:163], v[64:67]
  ds_read_b128 v[176:179], v14 offset:57344
  v_mfma_f32_16x16x32_bf16 v[68:71], a[76:79], v[160:163], v[68:71]
  s_add_u32 m0, s31, 147456
  v_mfma_f32_16x16x32_bf16 v[72:75], a[80:83], v[160:163], v[72:75]
  s_waitcnt lgkmcnt(3)
  buffer_load_dwordx4 v10, s[8:11], s30 offen lds
  v_mfma_f32_16x16x32_bf16 v[76:79], a[72:75], v[164:167], v[76:79]
  ds_read_b128 v[180:183], v14 offset:59392
  v_mfma_f32_16x16x32_bf16 v[80:83], a[76:79], v[164:167], v[80:83]
  v_mfma_f32_16x16x32_bf16 v[84:87], a[80:83], v[164:167], v[84:87]
  s_waitcnt lgkmcnt(3)
  v_mfma_f32_16x16x32_bf16 v[88:91], a[72:75], v[168:171], v[88:91]
  ds_read_b128 v[184:187], v14 offset:61440
  v_mfma_f32_16x16x32_bf16 v[92:95], a[76:79], v[168:171], v[92:95]
  buffer_store_dwordx4 v[232:235], v26, s[16:19], s29 offen offset:1024 sc1
  v_mfma_f32_16x16x32_bf16 v[96:99], a[80:83], v[168:171], v[96:99]
  s_waitcnt lgkmcnt(3)
  v_mfma_f32_16x16x32_bf16 v[100:103], a[72:75], v[172:175], v[100:103]
  ds_read_b128 v[188:191], v14 offset:63488
  v_mfma_f32_16x16x32_bf16 v[104:107], a[76:79], v[172:175], v[104:107]
  v_mfma_f32_16x16x32_bf16 v[108:111], a[80:83], v[172:175], v[108:111]
  s_waitcnt lgkmcnt(3)
  v_mfma_f32_16x16x32_bf16 v[112:115], a[72:75], v[176:179], v[112:115]
  ds_read_b128 v[160:163], v15 offset:49152
  v_mfma_f32_16x16x32_bf16 v[116:119], a[76:79], v[176:179], v[116:119]
  s_add_u32 m0, s31, 148480
  v_mfma_f32_16x16x32_bf16 v[120:123], a[80:83], v[176:179], v[120:123]
  s_waitcnt lgkmcnt(3)
  buffer_load_dwordx4 v11, s[8:11], s30 offen lds
  v_mfma_f32_16x16x32_bf16 v[124:127], a[72:75], v[180:183], v[124:127]
  ds_read_b128 v[164:167], v15 offset:51200
  v_mfma_f32_16x16x32_bf16 v[128:131], a[76:79], v[180:183], v[128:131]
  v_mfma_f32_16x16x32_bf16 v[132:135], a[80:83], v[180:183], v[132:135]
  s_waitcnt lgkmcnt(3)
  v_mfma_f32_16x16x32_bf16 v[136:139], a[72:75], v[184:187], v[136:139]
  ds_read_b128 v[168:171], v15 offset:53248
  v_mfma_f32_16x16x32_bf16 v[140:143], a[76:79], v[184:187], v[140:143]
  buffer_store_dwordx4 v[236:239], v26, s[16:19], s29 offen offset:2048 sc1
  v_mfma_f32_16x16x32_bf16 v[144:147], a[80:83], v[184:187], v[144:147]
  s_waitcnt lgkmcnt(3)
  v_mfma_f32_16x16x32_bf16 v[148:151], a[72:75], v[188:191], v[148:151]
  ds_read_b128 v[172:175], v15 offset:55296
  v_mfma_f32_16x16x32_bf16 v[152:155], a[76:79], v[188:191], v[152:155]
  v_mfma_f32_16x16x32_bf16 v[156:159], a[80:83], v[188:191], v[156:159]
  s_waitcnt lgkmcnt(3)
  v_mfma_f32_16x16x32_bf16 v[64:67], a[84:87], v[160:163], v[64:67]
  ds_read_b128 v[176:179], v15 offset:57344
  v_mfma_f32_16x16x32_bf16 v[68:71], a[88:91], v[160:163], v[68:71]
  s_add_u32 m0, s31, 149504
  v_mfma_f32_16x16x32_bf16 v[72:75], a[92:95], v[160:163], v[72:75]
  s_waitcnt lgkmcnt(3)
  buffer_load_dwordx4 v12, s[8:11], s30 offen lds
  v_mfma_f32_16x16x32_bf16 v[76:79], a[84:87], v[164:167], v[76:79]
  ds_read_b128 v[180:183], v15 offset:59392
  v_mfma_f32_16x16x32_bf16 v[80:83], a[88:91], v[164:167], v[80:83]
  v_mfma_f32_16x16x32_bf16 v[84:87], a[92:95], v[164:167], v[84:87]
  s_waitcnt lgkmcnt(3)
  v_mfma_f32_16x16x32_bf16 v[88:91], a[84:87], v[168:171], v[88:91]
  ds_read_b128 v[184:187], v15 offset:61440
  v_mfma_f32_16x16x32_bf16 v[92:95], a[88:91], v[168:171], v[92:95]
  v_mfma_f32_16x16x32_bf16 v[96:99], a[92:95], v[168:171], v[96:99]
  s_waitcnt lgkmcnt(3)
  v_mfma_f32_16x16x32_bf16 v[100:103], a[84:87], v[172:175], v[100:103]
  ds_read_b128 v[188:191], v15 offset:63488
  v_mfma_f32_16x16x32_bf16 v[104:107], a[88:91], v[172:175], v[104:107]
  v_mfma_f32_16x16x32_bf16 v[108:111], a[92:95], v[172:175], v[108:111]
  s_waitcnt lgkmcnt(3)
  v_mfma_f32_16x16x32_bf16 v[112:115], a[84:87], v[176:179], v[112:115]
  s_waitcnt vmcnt(1)
  s_barrier
  ds_read_b128 v[160:163], v16 offset:0
  v_mfma_f32_16x16x32_bf16 v[116:119], a[88:91], v[176:179], v[116:119]
  s_add_u32 m0, s31, 150528
  v_mfma_f32_16x16x32_bf16 v[120:123], a[92:95], v[176:179], v[120:123]
  s_waitcnt lgkmcnt(3)
  buffer_load_dwordx4 v13, s[8:11], s30 offen lds
  v_mfma_f32_16x16x32_bf16 v[124:127], a[84:87], v[180:183], v[124:127]
  s_add_u32 s30, s30, s25
  ds_read_b128 v[164:167], v16 offset:2048
  v_mfma_f32_16x16x32_bf16 v[128:131], a[88:91], v[180:183], v[128:131]
  v_mfma_f32_16x16x32_bf16 v[132:135], a[92:95], v[180:183], v[132:135]
  s_waitcnt lgkmcnt(3)
  v_mfma_f32_16x16x32_bf16 v[136:139], a[84:87], v[184:187], v[136:139]
  ds_read_b128 v[168:171], v16 offset:4096
  v_mfma_f32_16x16x32_bf16 v[140:143], a[88:91], v[184:187], v[140:143]
  buffer_atomic_add v28, v27, s[72:75], s61 offen sc1
  v_mfma_f32_16x16x32_bf16 v[144:147], a[92:95], v[184:187], v[144:147]
  s_waitcnt lgkmcnt(3)
  s_mov_b32 s48, s27
  s_add_u32 s27, s27, 8388608
  v_mfma_f32_16x16x32_bf16 v[148:151], a[84:87], v[188:191], v[148:151]
  s_mov_b32 s61, s60
  ds_read_b128 v[172:175], v16 offset:6144
  s_add_u32 s60, s60, 4
  v_mfma_f32_16x16x32_bf16 v[152:155], a[88:91], v[188:191], v[152:155]
  v_mfma_f32_16x16x32_bf16 v[156:159], a[92:95], v[188:191], v[156:159]
  s_waitcnt lgkmcnt(3)
  v_mfma_f32_16x16x32_bf16 v[64:67], a[96:99], v[160:163], v[64:67]
  ds_read_b128 v[176:179], v16 offset:8192
  v_mfma_f32_16x16x32_bf16 v[68:71], a[100:103], v[160:163], v[68:71]
  s_add_u32 m0, s31, 0
  v_mfma_f32_16x16x32_bf16 v[72:75], a[104:107], v[160:163], v[72:75]
  s_waitcnt lgkmcnt(3)
  buffer_load_dwordx4 v10, s[8:11], s30 offen lds
  v_mfma_f32_16x16x32_bf16 v[76:79], a[96:99], v[164:167], v[76:79]
  ds_read_b128 v[180:183], v16 offset:10240
  v_mfma_f32_16x16x32_bf16 v[80:83], a[100:103], v[164:167], v[80:83]
  v_mfma_f32_16x16x32_bf16 v[84:87], a[104:107], v[164:167], v[84:87]
  s_waitcnt lgkmcnt(3)
  v_mfma_f32_16x16x32_bf16 v[88:91], a[96:99], v[168:171], v[88:91]
  ds_read_b128 v[184:187], v16 offset:12288
  v_mfma_f32_16x16x32_bf16 v[92:95], a[100:103], v[168:171], v[92:95]
  v_mfma_f32_16x16x32_bf16 v[96:99], a[104:107], v[168:171], v[96:99]
  s_waitcnt lgkmcnt(3)
  v_mfma_f32_16x16x32_bf16 v[100:103], a[96:99], v[172:175], v[100:103]
  ds_read_b128 v[188:191], v16 offset:14336
  v_mfma_f32_16x16x32_bf16 v[104:107], a[100:103], v[172:175], v[104:107]
  v_mfma_f32_16x16x32_bf16 v[108:111], a[104:107], v[172:175], v[108:111]
  s_waitcnt lgkmcnt(3)
  v_mfma_f32_16x16x32_bf16 v[112:115], a[96:99], v[176:179], v[112:115]
  ds_read_b128 v[160:163], v17 offset:0
  v_mfma_f32_16x16x32_bf16 v[116:119], a[100:103], v[176:179], v[116:119]
  s_add_u32 m0, s31, 1024
  v_mfma_f32_16x16x32_bf16 v[120:123], a[104:107], v[176:179], v[120:123]
  s_waitcnt lgkmcnt(3)
  buffer_load_dwordx4 v11, s[8:11], s30 offen lds
  v_mfma_f32_16x16x32_bf16 v[124:127], a[96:99], v[180:183], v[124:127]
  ds_read_b128 v[164:167], v17 offset:2048
  v_mfma_f32_16x16x32_bf16 v[128:131], a[100:103], v[180:183], v[128:131]
  v_mfma_f32_16x16x32_bf16 v[132:135], a[104:107], v[180:183], v[132:135]
  s_waitcnt lgkmcnt(3)
  v_mfma_f32_16x16x32_bf16 v[136:139], a[96:99], v[184:187], v[136:139]
  ds_read_b128 v[168:171], v17 offset:4096
  v_mfma_f32_16x16x32_bf16 v[140:143], a[100:103], v[184:187], v[140:143]
  v_mfma_f32_16x16x32_bf16 v[144:147], a[104:107], v[184:187], v[144:147]
  s_waitcnt lgkmcnt(3)
  v_mfma_f32_16x16x32_bf16 v[148:151], a[96:99], v[188:191], v[148:151]
  ds_read_b128 v[172:175], v17 offset:6144
  v_mfma_f32_16x16x32_bf16 v[152:155], a[100:103], v[188:191], v[152:155]
  v_mfma_f32_16x16x32_bf16 v[156:159], a[104:107], v[188:191], v[156:159]
  s_waitcnt lgkmcnt(3)
  v_mfma_f32_16x16x32_bf16 v[64:67], a[108:111], v[160:163], v[64:67]
  ds_read_b128 v[176:179], v17 offset:8192
  v_mfma_f32_16x16x32_bf16 v[68:71], a[112:115], v[160:163], v[68:71]
  s_add_u32 m0, s31, 2048
  v_mfma_f32_16x16x32_bf16 v[72:75], a[116:119], v[160:163], v[72:75]
  s_waitcnt lgkmcnt(3)
  buffer_load_dwordx4 v12, s[8:11], s30 offen lds
  v_mfma_f32_16x16x32_bf16 v[76:79], a[108:111], v[164:167], v[76:79]
  ds_read_b128 v[180:183], v17 offset:10240
  v_mfma_f32_16x16x32_bf16 v[80:83], a[112:115], v[164:167], v[80:83]
  v_mfma_f32_16x16x32_bf16 v[84:87], a[116:119], v[164:167], v[84:87]
  s_waitcnt lgkmcnt(3)
  v_mfma_f32_16x16x32_bf16 v[88:91], a[108:111], v[168:171], v[88:91]
  ds_read_b128 v[184:187], v17 offset:12288
  v_mfma_f32_16x16x32_bf16 v[92:95], a[112:115], v[168:171], v[92:95]
  v_mfma_f32_16x16x32_bf16 v[96:99], a[116:119], v[168:171], v[96:99]
  s_waitcnt lgkmcnt(3)
  v_mfma_f32_16x16x32_bf16 v[100:103], a[108:111], v[172:175], v[100:103]
  ds_read_b128 v[188:191], v17 offset:14336
  v_mfma_f32_16x16x32_bf16 v[104:107], a[112:115], v[172:175], v[104:107]
  v_mfma_f32_16x16x32_bf16 v[108:111], a[116:119], v[172:175], v[108:111]
  s_waitcnt lgkmcnt(3)
  v_mfma_f32_16x16x32_bf16 v[112:115], a[108:111], v[176:179], v[112:115]
  ds_read_b128 v[160:163], v16 offset:16384
  v_mfma_f32_16x16x32_bf16 v[116:119], a[112:115], v[176:179], v[116:119]
  s_add_u32 m0, s31, 3072
  v_mfma_f32_16x16x32_bf16 v[120:123], a[116:119], v[176:179], v[120:123]
  s_waitcnt lgkmcnt(3)
  buffer_load_dwordx4 v13, s[8:11], s30 offen lds
  v_mfma_f32_16x16x32_bf16 v[124:127], a[108:111], v[180:183], v[124:127]
  s_add_u32 s30, s30, 128
  ds_read_b128 v[164:167], v16 offset:18432
  v_mfma_f32_16x16x32_bf16 v[128:131], a[112:115], v[180:183], v[128:131]
  v_mfma_f32_16x16x32_bf16 v[132:135], a[116:119], v[180:183], v[132:135]
  s_waitcnt lgkmcnt(3)
  v_mfma_f32_16x16x32_bf16 v[136:139], a[108:111], v[184:187], v[136:139]
  ds_read_b128 v[168:171], v16 offset:20480
  v_mfma_f32_16x16x32_bf16 v[140:143], a[112:115], v[184:187], v[140:143]
  v_mfma_f32_16x16x32_bf16 v[144:147], a[116:119], v[184:187], v[144:147]
  s_waitcnt lgkmcnt(3)
  v_mfma_f32_16x16x32_bf16 v[148:151], a[108:111], v[188:191], v[148:151]
  ds_read_b128 v[172:175], v16 offset:22528
  v_mfma_f32_16x16x32_bf16 v[152:155], a[112:115], v[188:191], v[152:155]
  v_mfma_f32_16x16x32_bf16 v[156:159], a[116:119], v[188:191], v[156:159]
  s_waitcnt lgkmcnt(3)
  v_mfma_f32_16x16x32_bf16 v[64:67], a[120:123], v[160:163], v[64:67]
  ds_read_b128 v[176:179], v16 offset:24576
  v_mfma_f32_16x16x32_bf16 v[68:71], a[124:127], v[160:163], v[68:71]
  s_add_u32 m0, s31, 16384
  v_mfma_f32_16x16x32_bf16 v[72:75], a[128:131], v[160:163], v[72:75]
  s_waitcnt lgkmcnt(3)
  buffer_load_dwordx4 v10, s[8:11], s30 offen lds
  v_mfma_f32_16x16x32_bf16 v[76:79], a[120:123], v[164:167], v[76:79]
  ds_read_b128 v[180:183], v16 offset:26624
  v_mfma_f32_16x16x32_bf16 v[80:83], a[124:127], v[164:167], v[80:83]
  v_mfma_f32_16x16x32_bf16 v[84:87], a[128:131], v[164:167], v[84:87]
  s_waitcnt lgkmcnt(3)
  v_mfma_f32_16x16x32_bf16 v[88:91], a[120:123], v[168:171], v[88:91]
  ds_read_b128 v[184:187], v16 offset:28672
  v_mfma_f32_16x16x32_bf16 v[92:95], a[124:127], v[168:171], v[92:95]
  v_mfma_f32_16x16x32_bf16 v[96:99], a[128:131], v[168:171], v[96:99]
  s_waitcnt lgkmcnt(3)
  v_mfma_f32_16x16x32_bf16 v[100:103], a[120:123], v[172:175], v[100:103]
  ds_read_b128 v[188:191], v16 offset:30720
  v_mfma_f32_16x16x32_bf16 v[104:107], a[124:127], v[172:175], v[104:107]
  v_mfma_f32_16x16x32_bf16 v[108:111], a[128:131], v[172:175], v[108:111]
  s_waitcnt lgkmcnt(3)
  v_mfma_f32_16x16x32_bf16 v[112:115], a[120:123], v[176:179], v[112:115]
  ds_read_b128 v[160:163], v17 offset:16384
  v_mfma_f32_16x16x32_bf16 v[116:119], a[124:127], v[176:179], v[116:119]
  s_add_u32 m0, s31, 17408
  v_mfma_f32_16x16x32_bf16 v[120:123], a[128:131], v[176:179], v[120:123]
  s_waitcnt lgkmcnt(3)
  buffer_load_dwordx4 v11, s[8:11], s30 offen lds
  v_mfma_f32_16x16x32_bf16 v[124:127], a[120:123], v[180:183], v[124:127]
  ds_read_b128 v[164:167], v17 offset:18432
  v_mfma_f32_16x16x32_bf16 v[128:131], a[124:127], v[180:183], v[128:131]
  v_mfma_f32_16x16x32_bf16 v[132:135], a[128:131], v[180:183], v[132:135]
  s_waitcnt lgkmcnt(3)
  v_mfma_f32_16x16x32_bf16 v[136:139], a[120:123], v[184:187], v[136:139]
  ds_read_b128 v[168:171], v17 offset:20480
  v_mfma_f32_16x16x32_bf16 v[140:143], a[124:127], v[184:187], v[140:143]
  v_mfma_f32_16x16x32_bf16 v[144:147], a[128:131], v[184:187], v[144:147]
  s_waitcnt lgkmcnt(3)
  v_mfma_f32_16x16x32_bf16 v[148:151], a[120:123], v[188:191], v[148:151]
  ds_read_b128 v[172:175], v17 offset:22528
  v_mfma_f32_16x16x32_bf16 v[152:155], a[124:127], v[188:191], v[152:155]
  v_mfma_f32_16x16x32_bf16 v[156:159], a[128:131], v[188:191], v[156:159]
  s_waitcnt lgkmcnt(3)
  v_mfma_f32_16x16x32_bf16 v[64:67], a[132:135], v[160:163], v[64:67]
  ds_read_b128 v[176:179], v17 offset:24576
  v_mfma_f32_16x16x32_bf16 v[68:71], a[136:139], v[160:163], v[68:71]
  s_add_u32 m0, s31, 18432
  v_mfma_f32_16x16x32_bf16 v[72:75], a[140:143], v[160:163], v[72:75]
  s_waitcnt lgkmcnt(3)
  buffer_load_dwordx4 v12, s[8:11], s30 offen lds
  v_mfma_f32_16x16x32_bf16 v[76:79], a[132:135], v[164:167], v[76:79]
  ds_read_b128 v[180:183], v17 offset:26624
  v_mfma_f32_16x16x32_bf16 v[80:83], a[136:139], v[164:167], v[80:83]
  v_mfma_f32_16x16x32_bf16 v[84:87], a[140:143], v[164:167], v[84:87]
  s_waitcnt lgkmcnt(3)
  v_mfma_f32_16x16x32_bf16 v[88:91], a[132:135], v[168:171], v[88:91]
  ds_read_b128 v[184:187], v17 offset:28672
  v_mfma_f32_16x16x32_bf16 v[92:95], a[136:139], v[168:171], v[92:95]
  v_mfma_f32_16x16x32_bf16 v[96:99], a[140:143], v[168:171], v[96:99]
  s_waitcnt lgkmcnt(3)
  v_mfma_f32_16x16x32_bf16 v[100:103], a[132:135], v[172:175], v[100:103]
  ds_read_b128 v[188:191], v17 offset:30720
  v_mfma_f32_16x16x32_bf16 v[104:107], a[136:139], v[172:175], v[104:107]
  v_mfma_f32_16x16x32_bf16 v[108:111], a[140:143], v[172:175], v[108:111]
  s_waitcnt lgkmcnt(3)
  v_mfma_f32_16x16x32_bf16 v[112:115], a[132:135], v[176:179], v[112:115]
  s_waitcnt vmcnt(23)
  s_barrier
  ds_read_b128 v[160:163], v16 offset:32768
  v_mfma_f32_16x16x32_bf16 v[116:119], a[136:139], v[176:179], v[116:119]
  s_add_u32 m0, s31, 19456
  v_mfma_f32_16x16x32_bf16 v[120:123], a[140:143], v[176:179], v[120:123]
  s_waitcnt lgkmcnt(3)
  buffer_load_dwordx4 v13, s[8:11], s30 offen lds
  v_mfma_f32_16x16x32_bf16 v[124:127], a[132:135], v[180:183], v[124:127]
  s_add_u32 s30, s30, 128
  ds_read_b128 v[164:167], v16 offset:34816
  v_mfma_f32_16x16x32_bf16 v[128:131], a[136:139], v[180:183], v[128:131]
  v_mfma_f32_16x16x32_bf16 v[132:135], a[140:143], v[180:183], v[132:135]
  s_waitcnt lgkmcnt(3)
  v_mfma_f32_16x16x32_bf16 v[136:139], a[132:135], v[184:187], v[136:139]
  ds_read_b128 v[168:171], v16 offset:36864
  v_mfma_f32_16x16x32_bf16 v[140:143], a[136:139], v[184:187], v[140:143]
  v_mfma_f32_16x16x32_bf16 v[144:147], a[140:143], v[184:187], v[144:147]
  s_waitcnt lgkmcnt(3)
  v_mfma_f32_16x16x32_bf16 v[148:151], a[132:135], v[188:191], v[148:151]
  ds_read_b128 v[172:175], v16 offset:38912
  v_mfma_f32_16x16x32_bf16 v[152:155], a[136:139], v[188:191], v[152:155]
  v_mfma_f32_16x16x32_bf16 v[156:159], a[140:143], v[188:191], v[156:159]
  s_waitcnt lgkmcnt(3)
  v_mfma_f32_16x16x32_bf16 v[64:67], a[144:147], v[160:163], v[64:67]
  ds_read_b128 v[176:179], v16 offset:40960
  v_mfma_f32_16x16x32_bf16 v[68:71], a[148:151], v[160:163], v[68:71]
  s_add_u32 m0, s31, 32768
  v_mfma_f32_16x16x32_bf16 v[72:75], a[152:155], v[160:163], v[72:75]
  s_waitcnt lgkmcnt(3)
  buffer_load_dwordx4 v10, s[8:11], s30 offen lds
  v_mfma_f32_16x16x32_bf16 v[76:79], a[144:147], v[164:167], v[76:79]
  ds_read_b128 v[180:183], v16 offset:43008
  v_mfma_f32_16x16x32_bf16 v[80:83], a[148:151], v[164:167], v[80:83]
  v_mfma_f32_16x16x32_bf16 v[84:87], a[152:155], v[164:167], v[84:87]
  s_waitcnt lgkmcnt(3)
  v_mfma_f32_16x16x32_bf16 v[88:91], a[144:147], v[168:171], v[88:91]
  ds_read_b128 v[184:187], v16 offset:45056
  v_mfma_f32_16x16x32_bf16 v[92:95], a[148:151], v[168:171], v[92:95]
  v_mfma_f32_16x16x32_bf16 v[96:99], a[152:155], v[168:171], v[96:99]
  s_waitcnt lgkmcnt(3)
  v_mfma_f32_16x16x32_bf16 v[100:103], a[144:147], v[172:175], v[100:103]
  ds_read_b128 v[188:191], v16 offset:47104
  v_mfma_f32_16x16x32_bf16 v[104:107], a[148:151], v[172:175], v[104:107]
  v_mfma_f32_16x16x32_bf16 v[108:111], a[152:155], v[172:175], v[108:111]
  s_waitcnt lgkmcnt(3)
  v_mfma_f32_16x16x32_bf16 v[112:115], a[144:147], v[176:179], v[112:115]
  ds_read_b128 v[160:163], v17 offset:32768
  v_mfma_f32_16x16x32_bf16 v[116:119], a[148:151], v[176:179], v[116:119]
  s_add_u32 m0, s31, 33792
  v_mfma_f32_16x16x32_bf16 v[120:123], a[152:155], v[176:179], v[120:123]
  s_waitcnt lgkmcnt(3)
  buffer_load_dwordx4 v11, s[8:11], s30 offen lds
  v_mfma_f32_16x16x32_bf16 v[124:127], a[144:147], v[180:183], v[124:127]
  ds_read_b128 v[164:167], v17 offset:34816
  v_mfma_f32_16x16x32_bf16 v[128:131], a[148:151], v[180:183], v[128:131]
  v_mfma_f32_16x16x32_bf16 v[132:135], a[152:155], v[180:183], v[132:135]
  s_waitcnt lgkmcnt(3)
  v_mfma_f32_16x16x32_bf16 v[136:139], a[144:147], v[184:187], v[136:139]
  ds_read_b128 v[168:171], v17 offset:36864
  v_mfma_f32_16x16x32_bf16 v[140:143], a[148:151], v[184:187], v[140:143]
  v_mfma_f32_16x16x32_bf16 v[144:147], a[152:155], v[184:187], v[144:147]
  s_waitcnt lgkmcnt(3)
  v_mfma_f32_16x16x32_bf16 v[148:151], a[144:147], v[188:191], v[148:151]
  ds_read_b128 v[172:175], v17 offset:38912
  v_mfma_f32_16x16x32_bf16 v[152:155], a[148:151], v[188:191], v[152:155]
  v_mfma_f32_16x16x32_bf16 v[156:159], a[152:155], v[188:191], v[156:159]
  s_waitcnt lgkmcnt(3)
  v_mfma_f32_16x16x32_bf16 v[64:67], a[156:159], v[160:163], v[64:67]
  ds_read_b128 v[176:179], v17 offset:40960
  v_mfma_f32_16x16x32_bf16 v[68:71], a[160:163], v[160:163], v[68:71]
  s_add_u32 m0, s31, 34816
  v_mfma_f32_16x16x32_bf16 v[72:75], a[164:167], v[160:163], v[72:75]
  s_waitcnt lgkmcnt(3)
  buffer_load_dwordx4 v12, s[8:11], s30 offen lds
  v_mfma_f32_16x16x32_bf16 v[76:79], a[156:159], v[164:167], v[76:79]
  ds_read_b128 v[180:183], v17 offset:43008
  v_mfma_f32_16x16x32_bf16 v[80:83], a[160:163], v[164:167], v[80:83]
  v_mfma_f32_16x16x32_bf16 v[84:87], a[164:167], v[164:167], v[84:87]
  s_waitcnt lgkmcnt(3)
  v_mfma_f32_16x16x32_bf16 v[88:91], a[156:159], v[168:171], v[88:91]
  ds_read_b128 v[184:187], v17 offset:45056
  v_mfma_f32_16x16x32_bf16 v[92:95], a[160:163], v[168:171], v[92:95]
  v_mfma_f32_16x16x32_bf16 v[96:99], a[164:167], v[168:171], v[96:99]
  s_waitcnt lgkmcnt(3)
  v_mfma_f32_16x16x32_bf16 v[100:103], a[156:159], v[172:175], v[100:103]
  ds_read_b128 v[188:191], v17 offset:47104
  v_mfma_f32_16x16x32_bf16 v[104:107], a[160:163], v[172:175], v[104:107]
  v_mfma_f32_16x16x32_bf16 v[108:111], a[164:167], v[172:175], v[108:111]
  s_waitcnt lgkmcnt(3)
  v_mfma_f32_16x16x32_bf16 v[112:115], a[156:159], v[176:179], v[112:115]
  ds_read_b128 v[160:163], v16 offset:49152
  v_mfma_f32_16x16x32_bf16 v[116:119], a[160:163], v[176:179], v[116:119]
  s_add_u32 m0, s31, 35840
  v_mfma_f32_16x16x32_bf16 v[120:123], a[164:167], v[176:179], v[120:123]
  s_waitcnt lgkmcnt(3)
  buffer_load_dwordx4 v13, s[8:11], s30 offen lds
  v_mfma_f32_16x16x32_bf16 v[124:127], a[156:159], v[180:183], v[124:127]
  s_add_u32 s30, s30, 128
  ds_read_b128 v[164:167], v16 offset:51200
  v_mfma_f32_16x16x32_bf16 v[128:131], a[160:163], v[180:183], v[128:131]
  v_mfma_f32_16x16x32_bf16 v[132:135], a[164:167], v[180:183], v[132:135]
  s_waitcnt lgkmcnt(3)
  v_mfma_f32_16x16x32_bf16 v[136:139], a[156:159], v[184:187], v[136:139]
  ds_read_b128 v[168:171], v16 offset:53248
  v_mfma_f32_16x16x32_bf16 v[140:143], a[160:163], v[184:187], v[140:143]
  v_mfma_f32_16x16x32_bf16 v[144:147], a[164:167], v[184:187], v[144:147]
  s_waitcnt lgkmcnt(3)
  v_mfma_f32_16x16x32_bf16 v[148:151], a[156:159], v[188:191], v[148:151]
  ds_read_b128 v[172:175], v16 offset:55296
  v_mfma_f32_16x16x32_bf16 v[152:155], a[160:163], v[188:191], v[152:155]
  v_mfma_f32_16x16x32_bf16 v[156:159], a[164:167], v[188:191], v[156:159]
  s_waitcnt lgkmcnt(3)
  v_mfma_f32_16x16x32_bf16 v[64:67], a[168:171], v[160:163], v[64:67]
  ds_read_b128 v[176:179], v16 offset:57344
  v_mfma_f32_16x16x32_bf16 v[68:71], a[172:175], v[160:163], v[68:71]
  s_add_u32 m0, s31, 49152
  v_mfma_f32_16x16x32_bf16 v[72:75], a[176:179], v[160:163], v[72:75]
  s_waitcnt lgkmcnt(3)
  buffer_load_dwordx4 v10, s[8:11], s30 offen lds
  v_mfma_f32_16x16x32_bf16 v[76:79], a[168:171], v[164:167], v[76:79]
  ds_read_b128 v[180:183], v16 offset:59392
  v_mfma_f32_16x16x32_bf16 v[80:83], a[172:175], v[164:167], v[80:83]
  v_mfma_f32_16x16x32_bf16 v[84:87], a[176:179], v[164:167], v[84:87]
  s_waitcnt lgkmcnt(3)
  v_mfma_f32_16x16x32_bf16 v[88:91], a[168:171], v[168:171], v[88:91]
  ds_read_b128 v[184:187], v16 offset:61440
  v_mfma_f32_16x16x32_bf16 v[92:95], a[172:175], v[168:171], v[92:95]
  v_mfma_f32_16x16x32_bf16 v[96:99], a[176:179], v[168:171], v[96:99]
  s_waitcnt lgkmcnt(3)
  v_mfma_f32_16x16x32_bf16 v[100:103], a[168:171], v[172:175], v[100:103]
  ds_read_b128 v[188:191], v16 offset:63488
  v_mfma_f32_16x16x32_bf16 v[104:107], a[172:175], v[172:175], v[104:107]
  v_mfma_f32_16x16x32_bf16 v[108:111], a[176:179], v[172:175], v[108:111]
  s_waitcnt lgkmcnt(3)
  v_mfma_f32_16x16x32_bf16 v[112:115], a[168:171], v[176:179], v[112:115]
  ds_read_b128 v[160:163], v17 offset:49152
  v_mfma_f32_16x16x32_bf16 v[116:119], a[172:175], v[176:179], v[116:119]
  s_add_u32 m0, s31, 50176
  v_mfma_f32_16x16x32_bf16 v[120:123], a[176:179], v[176:179], v[120:123]
  s_waitcnt lgkmcnt(3)
  buffer_load_dwordx4 v11, s[8:11], s30 offen lds
  v_mfma_f32_16x16x32_bf16 v[124:127], a[168:171], v[180:183], v[124:127]
  ds_read_b128 v[164:167], v17 offset:51200
  v_mfma_f32_16x16x32_bf16 v[128:131], a[172:175], v[180:183], v[128:131]
  v_mfma_f32_16x16x32_bf16 v[132:135], a[176:179], v[180:183], v[132:135]
  s_waitcnt lgkmcnt(3)
  v_mfma_f32_16x16x32_bf16 v[136:139], a[168:171], v[184:187], v[136:139]
  ds_read_b128 v[168:171], v17 offset:53248
  v_mfma_f32_16x16x32_bf16 v[140:143], a[172:175], v[184:187], v[140:143]
  v_mfma_f32_16x16x32_bf16 v[144:147], a[176:179], v[184:187], v[144:147]
  s_waitcnt lgkmcnt(3)
  v_mfma_f32_16x16x32_bf16 v[148:151], a[168:171], v[188:191], v[148:151]
  ds_read_b128 v[172:175], v17 offset:55296
  v_mfma_f32_16x16x32_bf16 v[152:155], a[172:175], v[188:191], v[152:155]
  v_mfma_f32_16x16x32_bf16 v[156:159], a[176:179], v[188:191], v[156:159]
  s_waitcnt lgkmcnt(3)
  v_mfma_f32_16x16x32_bf16 v[64:67], a[180:183], v[160:163], v[64:67]
  ds_read_b128 v[176:179], v17 offset:57344
  v_mfma_f32_16x16x32_bf16 v[68:71], a[184:187], v[160:163], v[68:71]
  s_add_u32 m0, s31, 51200
  v_mfma_f32_16x16x32_bf16 v[72:75], a[188:191], v[160:163], v[72:75]
  s_waitcnt lgkmcnt(3)
  buffer_load_dwordx4 v12, s[8:11], s30 offen lds
  v_mfma_f32_16x16x32_bf16 v[76:79], a[180:183], v[164:167], v[76:79]
  ds_read_b128 v[180:183], v17 offset:59392
  v_mfma_f32_16x16x32_bf16 v[80:83], a[184:187], v[164:167], v[80:83]
  v_mfma_f32_16x16x32_bf16 v[84:87], a[188:191], v[164:167], v[84:87]
  s_waitcnt lgkmcnt(3)
  v_mfma_f32_16x16x32_bf16 v[88:91], a[180:183], v[168:171], v[88:91]
  ds_read_b128 v[184:187], v17 offset:61440
  v_mfma_f32_16x16x32_bf16 v[92:95], a[184:187], v[168:171], v[92:95]
  v_mfma_f32_16x16x32_bf16 v[96:99], a[188:191], v[168:171], v[96:99]
  s_waitcnt lgkmcnt(3)
  v_mfma_f32_16x16x32_bf16 v[100:103], a[180:183], v[172:175], v[100:103]
  ds_read_b128 v[188:191], v17 offset:63488
  v_mfma_f32_16x16x32_bf16 v[104:107], a[184:187], v[172:175], v[104:107]
  v_mfma_f32_16x16x32_bf16 v[108:111], a[188:191], v[172:175], v[108:111]
  s_waitcnt lgkmcnt(3)
  v_mfma_f32_16x16x32_bf16 v[112:115], a[180:183], v[176:179], v[112:115]
  s_waitcnt vmcnt(16)
  s_barrier
  ds_read_b128 v[160:163], v18 offset:0
  v_mfma_f32_16x16x32_bf16 v[116:119], a[184:187], v[176:179], v[116:119]
  s_add_u32 m0, s31, 52224
  v_mfma_f32_16x16x32_bf16 v[120:123], a[188:191], v[176:179], v[120:123]
  s_waitcnt lgkmcnt(3)
  buffer_load_dwordx4 v13, s[8:11], s30 offen lds
  v_mfma_f32_16x16x32_bf16 v[124:127], a[180:183], v[180:183], v[124:127]
  s_add_u32 s30, s30, 128
  ds_read_b128 v[164:167], v18 offset:2048
  v_mfma_f32_16x16x32_bf16 v[128:131], a[184:187], v[180:183], v[128:131]
  v_mfma_f32_16x16x32_bf16 v[132:135], a[188:191], v[180:183], v[132:135]
  s_waitcnt lgkmcnt(3)
  v_mfma_f32_16x16x32_bf16 v[136:139], a[180:183], v[184:187], v[136:139]
  ds_read_b128 v[168:171], v18 offset:4096
  v_mfma_f32_16x16x32_bf16 v[140:143], a[184:187], v[184:187], v[140:143]
  v_mfma_f32_16x16x32_bf16 v[144:147], a[188:191], v[184:187], v[144:147]
  s_waitcnt lgkmcnt(3)
  v_mfma_f32_16x16x32_bf16 v[148:151], a[180:183], v[188:191], v[148:151]
  ds_read_b128 v[172:175], v18 offset:6144
  v_mfma_f32_16x16x32_bf16 v[152:155], a[184:187], v[188:191], v[152:155]
  v_mfma_f32_16x16x32_bf16 v[156:159], a[188:191], v[188:191], v[156:159]
  s_waitcnt lgkmcnt(3)
  v_mfma_f32_16x16x32_bf16 v[64:67], a[192:195], v[160:163], v[64:67]
  ds_read_b128 v[176:179], v18 offset:8192
  v_mfma_f32_16x16x32_bf16 v[68:71], a[196:199], v[160:163], v[68:71]
  s_add_u32 m0, s31, 65536
  v_mfma_f32_16x16x32_bf16 v[72:75], a[200:203], v[160:163], v[72:75]
  s_waitcnt lgkmcnt(3)
  buffer_load_dwordx4 v10, s[8:11], s30 offen lds
  v_mfma_f32_16x16x32_bf16 v[76:79], a[192:195], v[164:167], v[76:79]
  ds_read_b128 v[180:183], v18 offset:10240
  v_mfma_f32_16x16x32_bf16 v[80:83], a[196:199], v[164:167], v[80:83]
  v_mfma_f32_16x16x32_bf16 v[84:87], a[200:203], v[164:167], v[84:87]
  s_waitcnt lgkmcnt(3)
  v_mfma_f32_16x16x32_bf16 v[88:91], a[192:195], v[168:171], v[88:91]
  ds_read_b128 v[184:187], v18 offset:12288
  v_mfma_f32_16x16x32_bf16 v[92:95], a[196:199], v[168:171], v[92:95]
  v_mfma_f32_16x16x32_bf16 v[96:99], a[200:203], v[168:171], v[96:99]
  s_waitcnt lgkmcnt(3)
  v_mfma_f32_16x16x32_bf16 v[100:103], a[192:195], v[172:175], v[100:103]
  ds_read_b128 v[188:191], v18 offset:14336
  v_mfma_f32_16x16x32_bf16 v[104:107], a[196:199], v[172:175], v[104:107]
  v_mfma_f32_16x16x32_bf16 v[108:111], a[200:203], v[172:175], v[108:111]
  s_waitcnt lgkmcnt(3)
  v_mfma_f32_16x16x32_bf16 v[112:115], a[192:195], v[176:179], v[112:115]
  ds_read_b128 v[160:163], v19 offset:0
  v_mfma_f32_16x16x32_bf16 v[116:119], a[196:199], v[176:179], v[116:119]
  s_add_u32 m0, s31, 66560
  v_mfma_f32_16x16x32_bf16 v[120:123], a[200:203], v[176:179], v[120:123]
  s_waitcnt lgkmcnt(3)
  buffer_load_dwordx4 v11, s[8:11], s30 offen lds
  v_mfma_f32_16x16x32_bf16 v[124:127], a[192:195], v[180:183], v[124:127]
  ds_read_b128 v[164:167], v19 offset:2048
  v_mfma_f32_16x16x32_bf16 v[128:131], a[196:199], v[180:183], v[128:131]
  v_mfma_f32_16x16x32_bf16 v[132:135], a[200:203], v[180:183], v[132:135]
  s_waitcnt lgkmcnt(3)
  v_mfma_f32_16x16x32_bf16 v[136:139], a[192:195], v[184:187], v[136:139]
  ds_read_b128 v[168:171], v19 offset:4096
  v_mfma_f32_16x16x32_bf16 v[140:143], a[196:199], v[184:187], v[140:143]
  v_mfma_f32_16x16x32_bf16 v[144:147], a[200:203], v[184:187], v[144:147]
  s_waitcnt lgkmcnt(3)
  v_mfma_f32_16x16x32_bf16 v[148:151], a[192:195], v[188:191], v[148:151]
  ds_read_b128 v[172:175], v19 offset:6144
  v_mfma_f32_16x16x32_bf16 v[152:155], a[196:199], v[188:191], v[152:155]
  v_mfma_f32_16x16x32_bf16 v[156:159], a[200:203], v[188:191], v[156:159]
  s_waitcnt lgkmcnt(3)
  v_mfma_f32_16x16x32_bf16 v[64:67], a[204:207], v[160:163], v[64:67]
  ds_read_b128 v[176:179], v19 offset:8192
  v_mfma_f32_16x16x32_bf16 v[68:71], a[208:211], v[160:163], v[68:71]
  s_add_u32 m0, s31, 67584
  v_mfma_f32_16x16x32_bf16 v[72:75], a[212:215], v[160:163], v[72:75]
  s_waitcnt lgkmcnt(3)
  buffer_load_dwordx4 v12, s[8:11], s30 offen lds
  v_mfma_f32_16x16x32_bf16 v[76:79], a[204:207], v[164:167], v[76:79]
  ds_read_b128 v[180:183], v19 offset:10240
  v_mfma_f32_16x16x32_bf16 v[80:83], a[208:211], v[164:167], v[80:83]
  v_mfma_f32_16x16x32_bf16 v[84:87], a[212:215], v[164:167], v[84:87]
  s_waitcnt lgkmcnt(3)
  v_mfma_f32_16x16x32_bf16 v[88:91], a[204:207], v[168:171], v[88:91]
  ds_read_b128 v[184:187], v19 offset:12288
  v_mfma_f32_16x16x32_bf16 v[92:95], a[208:211], v[168:171], v[92:95]
  v_mfma_f32_16x16x32_bf16 v[96:99], a[212:215], v[168:171], v[96:99]
  s_waitcnt lgkmcnt(3)
  v_mfma_f32_16x16x32_bf16 v[100:103], a[204:207], v[172:175], v[100:103]
  ds_read_b128 v[188:191], v19 offset:14336
  v_mfma_f32_16x16x32_bf16 v[104:107], a[208:211], v[172:175], v[104:107]
  v_mfma_f32_16x16x32_bf16 v[108:111], a[212:215], v[172:175], v[108:111]
  s_waitcnt lgkmcnt(3)
  v_mfma_f32_16x16x32_bf16 v[112:115], a[204:207], v[176:179], v[112:115]
  ds_read_b128 v[160:163], v18 offset:16384
  v_mfma_f32_16x16x32_bf16 v[116:119], a[208:211], v[176:179], v[116:119]
  s_add_u32 m0, s31, 68608
  v_mfma_f32_16x16x32_bf16 v[120:123], a[212:215], v[176:179], v[120:123]
  s_waitcnt lgkmcnt(3)
  buffer_load_dwordx4 v13, s[8:11], s30 offen lds
  v_mfma_f32_16x16x32_bf16 v[124:127], a[204:207], v[180:183], v[124:127]
  s_add_u32 s30, s30, 128
  ds_read_b128 v[164:167], v18 offset:18432
  v_mfma_f32_16x16x32_bf16 v[128:131], a[208:211], v[180:183], v[128:131]
  v_mfma_f32_16x16x32_bf16 v[132:135], a[212:215], v[180:183], v[132:135]
  s_waitcnt lgkmcnt(3)
  v_mfma_f32_16x16x32_bf16 v[136:139], a[204:207], v[184:187], v[136:139]
  ds_read_b128 v[168:171], v18 offset:20480
  v_mfma_f32_16x16x32_bf16 v[140:143], a[208:211], v[184:187], v[140:143]
  v_mfma_f32_16x16x32_bf16 v[144:147], a[212:215], v[184:187], v[144:147]
  s_waitcnt lgkmcnt(3)
  v_mfma_f32_16x16x32_bf16 v[148:151], a[204:207], v[188:191], v[148:151]
  ds_read_b128 v[172:175], v18 offset:22528
  v_mfma_f32_16x16x32_bf16 v[152:155], a[208:211], v[188:191], v[152:155]
  v_mfma_f32_16x16x32_bf16 v[156:159], a[212:215], v[188:191], v[156:159]
  s_waitcnt lgkmcnt(3)
  v_mfma_f32_16x16x32_bf16 v[64:67], a[216:219], v[160:163], v[64:67]
  ds_read_b128 v[176:179], v18 offset:24576
  v_mfma_f32_16x16x32_bf16 v[68:71], a[220:223], v[160:163], v[68:71]
  s_add_u32 m0, s31, 81920
  v_mfma_f32_16x16x32_bf16 v[72:75], a[224:227], v[160:163], v[72:75]
  s_waitcnt lgkmcnt(3)
  buffer_load_dwordx4 v10, s[8:11], s30 offen lds
  v_mfma_f32_16x16x32_bf16 v[76:79], a[216:219], v[164:167], v[76:79]
  ds_read_b128 v[180:183], v18 offset:26624
  v_mfma_f32_16x16x32_bf16 v[80:83], a[220:223], v[164:167], v[80:83]
  v_mfma_f32_16x16x32_bf16 v[84:87], a[224:227], v[164:167], v[84:87]
  s_waitcnt lgkmcnt(3)
  v_mfma_f32_16x16x32_bf16 v[88:91], a[216:219], v[168:171], v[88:91]
  ds_read_b128 v[184:187], v18 offset:28672
  v_mfma_f32_16x16x32_bf16 v[92:95], a[220:223], v[168:171], v[92:95]
  s_add_u32 m0, s31, 82944
  v_mfma_f32_16x16x32_bf16 v[96:99], a[224:227], v[168:171], v[96:99]
  s_waitcnt lgkmcnt(3)
  buffer_load_dwordx4 v11, s[8:11], s30 offen lds
  v_mfma_f32_16x16x32_bf16 v[100:103], a[216:219], v[172:175], v[100:103]
  ds_read_b128 v[188:191], v18 offset:30720
  v_mfma_f32_16x16x32_bf16 v[104:107], a[220:223], v[172:175], v[104:107]
  v_mfma_f32_16x16x32_bf16 v[108:111], a[224:227], v[172:175], v[108:111]
  s_waitcnt lgkmcnt(3)
  v_mfma_f32_16x16x32_bf16 v[112:115], a[216:219], v[176:179], v[112:115]
  ds_read_b128 v[160:163], v19 offset:16384
  v_mfma_f32_16x16x32_bf16 v[116:119], a[220:223], v[176:179], v[116:119]
  s_add_u32 m0, s31, 83968
  v_mfma_f32_16x16x32_bf16 v[120:123], a[224:227], v[176:179], v[120:123]
  s_waitcnt lgkmcnt(3)
  buffer_load_dwordx4 v12, s[8:11], s30 offen lds
  v_mfma_f32_16x16x32_bf16 v[124:127], a[216:219], v[180:183], v[124:127]
  ds_read_b128 v[164:167], v19 offset:18432
  v_mfma_f32_16x16x32_bf16 v[128:131], a[220:223], v[180:183], v[128:131]
  v_mfma_f32_16x16x32_bf16 v[132:135], a[224:227], v[180:183], v[132:135]
  s_waitcnt lgkmcnt(3)
  v_mfma_f32_16x16x32_bf16 v[136:139], a[216:219], v[184:187], v[136:139]
  ds_read_b128 v[168:171], v19 offset:20480
  v_mfma_f32_16x16x32_bf16 v[140:143], a[220:223], v[184:187], v[140:143]
  s_add_u32 m0, s31, 84992
  v_mfma_f32_16x16x32_bf16 v[144:147], a[224:227], v[184:187], v[144:147]
  s_waitcnt lgkmcnt(3)
  buffer_load_dwordx4 v13, s[8:11], s30 offen lds
  v_mfma_f32_16x16x32_bf16 v[148:151], a[216:219], v[188:191], v[148:151]
  s_add_u32 s30, s30, 128
  ds_read_b128 v[172:175], v19 offset:22528
  v_mfma_f32_16x16x32_bf16 v[152:155], a[220:223], v[188:191], v[152:155]
  v_mfma_f32_16x16x32_bf16 v[156:159], a[224:227], v[188:191], v[156:159]
  s_waitcnt lgkmcnt(3)
  v_mfma_f32_16x16x32_bf16 v[64:67], a[228:231], v[160:163], v[64:67]
  ds_read_b128 v[176:179], v19 offset:24576
  v_mfma_f32_16x16x32_bf16 v[68:71], a[232:235], v[160:163], v[68:71]
  v_mfma_f32_16x16x32_bf16 v[72:75], a[236:239], v[160:163], v[72:75]
  s_waitcnt lgkmcnt(3)
  v_mfma_f32_16x16x32_bf16 v[76:79], a[228:231], v[164:167], v[76:79]
  ds_read_b128 v[180:183], v19 offset:26624
  v_cvt_pk_bf16_f32 v192, v64, v65
  v_mfma_f32_16x16x32_bf16 v[80:83], a[232:235], v[164:167], v[80:83]
  v_cvt_pk_bf16_f32 v193, v66, v67
  v_cvt_pk_bf16_f32 v194, v68, v69
  v_mfma_f32_16x16x32_bf16 v[84:87], a[236:239], v[164:167], v[84:87]
  s_waitcnt lgkmcnt(3)
  v_cvt_pk_bf16_f32 v195, v70, v71
  v_cvt_pk_bf16_f32 v200, v72, v73
  v_mfma_f32_16x16x32_bf16 v[88:91], a[228:231], v[168:171], v[88:91]
  ds_read_b128 v[184:187], v19 offset:28672
  v_cvt_pk_bf16_f32 v201, v74, v75
  v_mfma_f32_16x16x32_bf16 v[92:95], a[232:235], v[168:171], v[92:95]
  v_cvt_pk_bf16_f32 v196, v76, v77
  v_cvt_pk_bf16_f32 v197, v78, v79
  v_mfma_f32_16x16x32_bf16 v[96:99], a[236:239], v[168:171], v[96:99]
  s_waitcnt lgkmcnt(3)
  v_cvt_pk_bf16_f32 v198, v80, v81
  v_cvt_pk_bf16_f32 v199, v82, v83
  v_mfma_f32_16x16x32_bf16 v[100:103], a[228:231], v[172:175], v[100:103]
  ds_read_b128 v[188:191], v19 offset:30720
  v_cvt_pk_bf16_f32 v202, v84, v85
  v_mfma_f32_16x16x32_bf16 v[104:107], a[232:235], v[172:175], v[104:107]
  v_cvt_pk_bf16_f32 v203, v86, v87
  v_cvt_pk_bf16_f32 v204, v88, v89
  v_mfma_f32_16x16x32_bf16 v[108:111], a[236:239], v[172:175], v[108:111]
  s_waitcnt lgkmcnt(3)
  v_cvt_pk_bf16_f32 v205, v90, v91
  v_cvt_pk_bf16_f32 v206, v92, v93
  v_mfma_f32_16x16x32_bf16 v[112:115], a[228:231], v[176:179], v[112:115]
  s_waitcnt vmcnt(16)
  s_barrier
  ds_read_b128 v[160:163], v14 offset:0
  v_mfma_f32_16x16x32_bf16 v[116:119], a[232:235], v[176:179], v[116:119]
  v_cvt_pk_bf16_f32 v207, v94, v95
  v_cvt_pk_bf16_f32 v212, v96, v97
  v_mfma_f32_16x16x32_bf16 v[120:123], a[236:239], v[176:179], v[120:123]
  s_waitcnt lgkmcnt(3)
  v_cvt_pk_bf16_f32 v213, v98, v99
  v_cvt_pk_bf16_f32 v208, v100, v101
  v_mfma_f32_16x16x32_bf16 v[124:127], a[228:231], v[180:183], v[124:127]
  ds_read_b128 v[164:167], v14 offset:2048
  v_cvt_pk_bf16_f32 v209, v102, v103
  v_mfma_f32_16x16x32_bf16 v[128:131], a[232:235], v[180:183], v[128:131]
  v_cvt_pk_bf16_f32 v210, v104, v105
  v_cvt_pk_bf16_f32 v211, v106, v107
  v_mfma_f32_16x16x32_bf16 v[132:135], a[236:239], v[180:183], v[132:135]
  s_waitcnt lgkmcnt(3)
  v_cvt_pk_bf16_f32 v214, v108, v109
  v_cvt_pk_bf16_f32 v215, v110, v111
  v_mfma_f32_16x16x32_bf16 v[136:139], a[228:231], v[184:187], v[136:139]
  ds_read_b128 v[168:171], v14 offset:4096
  v_cvt_pk_bf16_f32 v216, v112, v113
  v_mfma_f32_16x16x32_bf16 v[140:143], a[232:235], v[184:187], v[140:143]
  v_cvt_pk_bf16_f32 v217, v114, v115
  v_cvt_pk_bf16_f32 v218, v116, v117
  v_mfma_f32_16x16x32_bf16 v[144:147], a[236:239], v[184:187], v[144:147]
  s_waitcnt lgkmcnt(3)
  v_cvt_pk_bf16_f32 v219, v118, v119
  v_cvt_pk_bf16_f32 v224, v120, v121
  v_mfma_f32_16x16x32_bf16 v[148:151], a[228:231], v[188:191], v[148:151]
  ds_read_b128 v[172:175], v14 offset:6144
  v_cvt_pk_bf16_f32 v225, v122, v123
  v_mfma_f32_16x16x32_bf16 v[152:155], a[232:235], v[188:191], v[152:155]
  s_sub_u32 s26, s26, 1
  s_cmp_gt_u32 s26, 0
  v_cvt_pk_bf16_f32 v220, v124, v125
  v_mfma_f32_16x16x32_bf16 v[156:159], a[236:239], v[188:191], v[156:159]
  s_waitcnt lgkmcnt(3)
  s_cbranch_scc1 kvs_241
  s_nop 7
  v_cvt_pk_bf16_f32 v221, v126, v127
  v_cvt_pk_bf16_f32 v222, v128, v129
  v_cvt_pk_bf16_f32 v223, v130, v131
  v_cvt_pk_bf16_f32 v226, v132, v133
  v_cvt_pk_bf16_f32 v227, v134, v135
  v_cvt_pk_bf16_f32 v228, v136, v137
  v_cvt_pk_bf16_f32 v229, v138, v139
  v_cvt_pk_bf16_f32 v230, v140, v141
  v_cvt_pk_bf16_f32 v231, v142, v143
  v_cvt_pk_bf16_f32 v236, v144, v145
  v_cvt_pk_bf16_f32 v237, v146, v147
  v_cvt_pk_bf16_f32 v232, v148, v149
  v_cvt_pk_bf16_f32 v233, v150, v151
  v_cvt_pk_bf16_f32 v234, v152, v153
  v_cvt_pk_bf16_f32 v235, v154, v155
  v_cvt_pk_bf16_f32 v238, v156, v157
  v_cvt_pk_bf16_f32 v239, v158, v159
  s_xor_b32 s29, s48, 0
  buffer_store_dwordx4 v[192:195], v26, s[16:19], s29 offen offset:0 sc1
  buffer_store_dwordx4 v[196:199], v26, s[16:19], s29 offen offset:1024 sc1
  buffer_store_dwordx4 v[200:203], v26, s[16:19], s29 offen offset:2048 sc1
  s_xor_b32 s29, s48, 2105344
  buffer_store_dwordx4 v[204:207], v26, s[16:19], s29 offen offset:0 sc1
  buffer_store_dwordx4 v[208:211], v26, s[16:19], s29 offen offset:1024 sc1
  buffer_store_dwordx4 v[212:215], v26, s[16:19], s29 offen offset:2048 sc1
  s_xor_b32 s29, s48, 4194304
  buffer_store_dwordx4 v[216:219], v26, s[16:19], s29 offen offset:0 sc1
  buffer_store_dwordx4 v[220:223], v26, s[16:19], s29 offen offset:1024 sc1
  buffer_store_dwordx4 v[224:227], v26, s[16:19], s29 offen offset:2048 sc1
  s_xor_b32 s29, s48, 6299648
  buffer_store_dwordx4 v[228:231], v26, s[16:19], s29 offen offset:0 sc1
  buffer_store_dwordx4 v[232:235], v26, s[16:19], s29 offen offset:1024 sc1
  buffer_store_dwordx4 v[236:239], v26, s[16:19], s29 offen offset:2048 sc1
  s_waitcnt vmcnt(0) lgkmcnt(0)
  s_barrier
  buffer_atomic_add v28, v27, s[72:75], s61 offen sc1
  s_bitcmp1_b32 s3, 0
  s_cbranch_scc1 queue
  s_lshr_b32 s2, s3, 1
  s_mov_b32 s40, 12
  s_mov_b32 s41, 4
  s_waitcnt vmcnt(0)
  s_barrier
  s_branch q_entry
  s_branch queue
not_kv:
  s_cmp_ge_u32 s3, 96
  s_cbranch_scc1 not_vw
  s_sub_u32 s2, s3, 64
  s_load_dwordx2 s[6:7], s[0:1], 40
  s_load_dwordx2 s[38:39], s[0:1], 104
  v_lshlrev_b32 v4, 4, v1
  s_waitcnt lgkmcnt(0)
  s_mov_b32 s12, s6
  s_mov_b32 s13, s7
  s_mov_b32 s14, 7864320
  s_mov_b32 s15, 0x00020000
  s_mov_b32 s16, s38
  s_mov_b32 s17, s39
  s_mov_b32 s18, 218103808
  s_mov_b32 s19, 0x00020000
  s_add_u32 s72, s38, 173080576
  s_addc_u32 s73, s39, 0
  s_mov_b32 s74, 49152
  s_mov_b32 s75, 0x00020000
  s_mul_i32 s40, s2, 245760
  s_mul_i32 s22, s20, 30720
  s_add_u32 s40, s40, s22
  s_add_u32 m0, s22, 0
  s_add_u32 s21, s40, 0
  buffer_load_dwordx4 v4, s[12:15], s21 offen offset:0 lds
  buffer_load_dwordx4 v4, s[12:15], s21 offen offset:1024 lds
  buffer_load_dwordx4 v4, s[12:15], s21 offen offset:2048 lds
  buffer_load_dwordx4 v4, s[12:15], s21 offen offset:3072 lds
  s_add_u32 m0, s22, 4096
  s_add_u32 s21, s40, 4096
  buffer_load_dwordx4 v4, s[12:15], s21 offen offset:0 lds
  buffer_load_dwordx4 v4, s[12:15], s21 offen offset:1024 lds
  buffer_load_dwordx4 v4, s[12:15], s21 offen offset:2048 lds
  buffer_load_dwordx4 v4, s[12:15], s21 offen offset:3072 lds
  s_add_u32 m0, s22, 8192
  s_add_u32 s21, s40, 8192
  buffer_load_dwordx4 v4, s[12:15], s21 offen offset:0 lds
  buffer_load_dwordx4 v4, s[12:15], s21 offen offset:1024 lds
  buffer_load_dwordx4 v4, s[12:15], s21 offen offset:2048 lds
  buffer_load_dwordx4 v4, s[12:15], s21 offen offset:3072 lds
  s_add_u32 m0, s22, 12288
  s_add_u32 s21, s40, 12288
  buffer_load_dwordx4 v4, s[12:15], s21 offen offset:0 lds
  buffer_load_dwordx4 v4, s[12:15], s21 offen offset:1024 lds
  buffer_load_dwordx4 v4, s[12:15], s21 offen offset:2048 lds
  buffer_load_dwordx4 v4, s[12:15], s21 offen offset:3072 lds
  s_add_u32 m0, s22, 16384
  s_add_u32 s21, s40, 16384
  buffer_load_dwordx4 v4, s[12:15], s21 offen offset:0 lds
  buffer_load_dwordx4 v4, s[12:15], s21 offen offset:1024 lds
  buffer_load_dwordx4 v4, s[12:15], s21 offen offset:2048 lds
  buffer_load_dwordx4 v4, s[12:15], s21 offen offset:3072 lds
  s_add_u32 m0, s22, 20480
  s_add_u32 s21, s40, 20480
  buffer_load_dwordx4 v4, s[12:15], s21 offen offset:0 lds
  buffer_load_dwordx4 v4, s[12:15], s21 offen offset:1024 lds
  buffer_load_dwordx4 v4, s[12:15], s21 offen offset:2048 lds
  buffer_load_dwordx4 v4, s[12:15], s21 offen offset:3072 lds
  s_add_u32 m0, s22, 24576
  s_add_u32 s21, s40, 24576
  buffer_load_dwordx4 v4, s[12:15], s21 offen offset:0 lds
  buffer_load_dwordx4 v4, s[12:15], s21 offen offset:1024 lds
  buffer_load_dwordx4 v4, s[12:15], s21 offen offset:2048 lds
  buffer_load_dwordx4 v4, s[12:15], s21 offen offset:3072 lds
  s_add_u32 m0, s22, 28672
  s_add_u32 s21, s40, 28672
  buffer_load_dwordx4 v4, s[12:15], s21 offen offset:0 lds
  buffer_load_dwordx4 v4, s[12:15], s21 offen offset:1024 lds
  s_add_u32 s21, s40, 122880
  buffer_load_dwordx4 v[64:67], v4, s[12:15], s21 offen offset:0
  buffer_load_dwordx4 v[68:71], v4, s[12:15], s21 offen offset:1024
  buffer_load_dwordx4 v[72:75], v4, s[12:15], s21 offen offset:2048
  buffer_load_dwordx4 v[76:79], v4, s[12:15], s21 offen offset:3072
  s_add_u32 s21, s40, 126976
  buffer_load_dwordx4 v[80:83], v4, s[12:15], s21 offen offset:0
  buffer_load_dwordx4 v[84:87], v4, s[12:15], s21 offen offset:1024
  buffer_load_dwordx4 v[88:91], v4, s[12:15], s21 offen offset:2048
  buffer_load_dwordx4 v[92:95], v4, s[12:15], s21 offen offset:3072
  s_add_u32 s21, s40, 131072
  buffer_load_dwordx4 v[96:99], v4, s[12:15], s21 offen offset:0
  buffer_load_dwordx4 v[100:103], v4, s[12:15], s21 offen offset:1024
  buffer_load_dwordx4 v[104:107], v4, s[12:15], s21 offen offset:2048
  buffer_load_dwordx4 v[108:111], v4, s[12:15], s21 offen offset:3072
  s_add_u32 s21, s40, 135168
  buffer_load_dwordx4 v[112:115], v4, s[12:15], s21 offen offset:0
  buffer_load_dwordx4 v[116:119], v4, s[12:15], s21 offen offset:1024
  buffer_load_dwordx4 v[120:123], v4, s[12:15], s21 offen offset:2048
  buffer_load_dwordx4 v[124:127], v4, s[12:15], s21 offen offset:3072
  s_add_u32 s21, s40, 139264
  buffer_load_dwordx4 v[128:131], v4, s[12:15], s21 offen offset:0
  buffer_load_dwordx4 v[132:135], v4, s[12:15], s21 offen offset:1024
  buffer_load_dwordx4 v[136:139], v4, s[12:15], s21 offen offset:2048
  buffer_load_dwordx4 v[140:143], v4, s[12:15], s21 offen offset:3072
  s_add_u32 s21, s40, 143360
  buffer_load_dwordx4 v[144:147], v4, s[12:15], s21 offen offset:0
  buffer_load_dwordx4 v[148:151], v4, s[12:15], s21 offen offset:1024
  buffer_load_dwordx4 v[152:155], v4, s[12:15], s21 offen offset:2048
  buffer_load_dwordx4 v[156:159], v4, s[12:15], s21 offen offset:3072
  s_add_u32 s21, s40, 147456
  buffer_load_dwordx4 v[160:163], v4, s[12:15], s21 offen offset:0
  buffer_load_dwordx4 v[164:167], v4, s[12:15], s21 offen offset:1024
  buffer_load_dwordx4 v[168:171], v4, s[12:15], s21 offen offset:2048
  buffer_load_dwordx4 v[172:175], v4, s[12:15], s21 offen offset:3072
  s_add_u32 s21, s40, 151552
  buffer_load_dwordx4 v[176:179], v4, s[12:15], s21 offen offset:0
  buffer_load_dwordx4 v[180:183], v4, s[12:15], s21 offen offset:1024
  v_lshrrev_b32 v6, 2, v2
  v_lshl_add_u32 v6, v3, 2, v6
  v_mul_u32_u24 v6, 1280, v6
  v_and_b32 v7, 3, v2
  v_lshlrev_b32 v7, 3, v7
  s_mul_i32 s21, s20, 320
  v_add3_u32 v6, v6, v7, s21
  v_add_u32 v8, v6, v7
  v_add_u32 v7, 61440, v6
  v_add_u32 v9, 61440, v8
  v_add_u32 v5, s22, v4
  s_waitcnt vmcnt(30)
  s_load_dwordx2 s[36:37], s[0:1], 16
  s_lshl_b32 s23, s2, 2
  s_add_u32 s23, s23, s20
  s_mul_i32 s23, s23, 61440
  s_add_u32 s23, s23, 0
  s_waitcnt lgkmcnt(0)
  s_mov_b32 s24, s36
  s_mov_b32 s25, s37
  s_mov_b32 s26, 7864320
  s_mov_b32 s27, 0x00020000
  buffer_load_dwordx4 v[200:203], v4, s[24:27], s23 offen offset:0
  buffer_load_dwordx4 v[200:203], v4, s[24:27], s23 offen offset:1024
  buffer_load_dwordx4 v[200:203], v4, s[24:27], s23 offen offset:2048
  buffer_load_dwordx4 v[200:203], v4, s[24:27], s23 offen offset:3072
  s_add_u32 s23, s23, 4096
  buffer_load_dwordx4 v[200:203], v4, s[24:27], s23 offen offset:0
  buffer_load_dwordx4 v[200:203], v4, s[24:27], s23 offen offset:1024
  buffer_load_dwordx4 v[200:203], v4, s[24:27], s23 offen offset:2048
  buffer_load_dwordx4 v[200:203], v4, s[24:27], s23 offen offset:3072
  s_add_u32 s23, s23, 4096
  buffer_load_dwordx4 v[200:203], v4, s[24:27], s23 offen offset:0
  buffer_load_dwordx4 v[200:203], v4, s[24:27], s23 offen offset:1024
  buffer_load_dwordx4 v[200:203], v4, s[24:27], s23 offen offset:2048
  buffer_load_dwordx4 v[200:203], v4, s[24:27], s23 offen offset:3072
  s_add_u32 s23, s23, 4096
  buffer_load_dwordx4 v[200:203], v4, s[24:27], s23 offen offset:0
  buffer_load_dwordx4 v[200:203], v4, s[24:27], s23 offen offset:1024
  buffer_load_dwordx4 v[200:203], v4, s[24:27], s23 offen offset:2048
  buffer_load_dwordx4 v[200:203], v4, s[24:27], s23 offen offset:3072
  s_add_u32 s23, s23, 4096
  buffer_load_dwordx4 v[200:203], v4, s[24:27], s23 offen offset:0
  buffer_load_dwordx4 v[200:203], v4, s[24:27], s23 offen offset:1024
  buffer_load_dwordx4 v[200:203], v4, s[24:27], s23 offen offset:2048
  buffer_load_dwordx4 v[200:203], v4, s[24:27], s23 offen offset:3072
  s_add_u32 s23, s23, 4096
  buffer_load_dwordx4 v[200:203], v4, s[24:27], s23 offen offset:0
  buffer_load_dwordx4 v[200:203], v4, s[24:27], s23 offen offset:1024
  buffer_load_dwordx4 v[200:203], v4, s[24:27], s23 offen offset:2048
  buffer_load_dwordx4 v[200:203], v4, s[24:27], s23 offen offset:3072
  s_add_u32 s23, s23, 4096
  buffer_load_dwordx4 v[200:203], v4, s[24:27], s23 offen offset:0
  buffer_load_dwordx4 v[200:203], v4, s[24:27], s23 offen offset:1024
  buffer_load_dwordx4 v[200:203], v4, s[24:27], s23 offen offset:2048
  buffer_load_dwordx4 v[200:203], v4, s[24:27], s23 offen offset:3072
  s_add_u32 s23, s23, 4096
  buffer_load_dwordx4 v[200:203], v4, s[24:27], s23 offen offset:0
  buffer_load_dwordx4 v[200:203], v4, s[24:27], s23 offen offset:1024
  s_barrier
  ds_read_b64_tr_b16 a[0:1], v8 offset:0
  ds_read_b64_tr_b16 a[2:3], v8 offset:20480
  ds_read_b64_tr_b16 a[24:25], v8 offset:8
  ds_read_b64_tr_b16 a[26:27], v8 offset:20488
  ds_read_b64_tr_b16 a[48:49], v6 offset:64
  ds_read_b64_tr_b16 a[50:51], v6 offset:20544
  ds_read_b64_tr_b16 a[72:73], v8 offset:96
  ds_read_b64_tr_b16 a[74:75], v8 offset:20576
  ds_read_b64_tr_b16 a[96:97], v8 offset:104
  ds_read_b64_tr_b16 a[98:99], v8 offset:20584
  ds_read_b64_tr_b16 a[120:121], v8 offset:160
  ds_read_b64_tr_b16 a[122:123], v8 offset:20640
  ds_read_b64_tr_b16 a[144:145], v8 offset:168
  ds_read_b64_tr_b16 a[146:147], v8 offset:20648
  ds_read_b64_tr_b16 a[168:169], v6 offset:224
  ds_read_b64_tr_b16 a[170:171], v6 offset:20704
  ds_read_b64_tr_b16 a[192:193], v8 offset:256
  ds_read_b64_tr_b16 a[194:195], v8 offset:20736
  ds_read_b64_tr_b16 a[216:217], v8 offset:264
  ds_read_b64_tr_b16 a[218:219], v8 offset:20744
  ds_read_b64_tr_b16 a[4:5], v9 offset:0
  ds_read_b64_tr_b16 a[6:7], v9 offset:20480
  ds_read_b64_tr_b16 a[28:29], v9 offset:8
  ds_read_b64_tr_b16 a[30:31], v9 offset:20488
  ds_read_b64_tr_b16 a[52:53], v7 offset:64
  ds_read_b64_tr_b16 a[54:55], v7 offset:20544
  ds_read_b64_tr_b16 a[76:77], v9 offset:96
  ds_read_b64_tr_b16 a[78:79], v9 offset:20576
  ds_read_b64_tr_b16 a[100:101], v9 offset:104
  ds_read_b64_tr_b16 a[102:103], v9 offset:20584
  ds_read_b64_tr_b16 a[124:125], v9 offset:160
  ds_read_b64_tr_b16 a[126:127], v9 offset:20640
  ds_read_b64_tr_b16 a[148:149], v9 offset:168
  ds_read_b64_tr_b16 a[150:151], v9 offset:20648
  ds_read_b64_tr_b16 a[172:173], v7 offset:224
  ds_read_b64_tr_b16 a[174:175], v7 offset:20704
  ds_read_b64_tr_b16 a[196:197], v9 offset:256
  ds_read_b64_tr_b16 a[198:199], v9 offset:20736
  ds_read_b64_tr_b16 a[220:221], v9 offset:264
  ds_read_b64_tr_b16 a[222:223], v9 offset:20744
  ds_read_b64_tr_b16 a[8:9], v8 offset:40960
  ds_read_b64_tr_b16 a[10:11], v9 offset:40960
  ds_read_b64_tr_b16 a[32:33], v8 offset:40968
  ds_read_b64_tr_b16 a[34:35], v9 offset:40968
  ds_read_b64_tr_b16 a[56:57], v6 offset:41024
  ds_read_b64_tr_b16 a[58:59], v7 offset:41024
  ds_read_b64_tr_b16 a[80:81], v8 offset:41056
  ds_read_b64_tr_b16 a[82:83], v9 offset:41056
  ds_read_b64_tr_b16 a[104:105], v8 offset:41064
  ds_read_b64_tr_b16 a[106:107], v9 offset:41064
  ds_read_b64_tr_b16 a[128:129], v8 offset:41120
  ds_read_b64_tr_b16 a[130:131], v9 offset:41120
  ds_read_b64_tr_b16 a[152:153], v8 offset:41128
  ds_read_b64_tr_b16 a[154:155], v9 offset:41128
  ds_read_b64_tr_b16 a[176:177], v6 offset:41184
  ds_read_b64_tr_b16 a[178:179], v7 offset:41184
  ds_read_b64_tr_b16 a[200:201], v8 offset:41216
  ds_read_b64_tr_b16 a[202:203], v9 offset:41216
  ds_read_b64_tr_b16 a[224:225], v8 offset:41224
  ds_read_b64_tr_b16 a[226:227], v9 offset:41224
  s_waitcnt lgkmcnt(0)
  s_barrier
  s_waitcnt vmcnt(30)
  ds_write_b128 v5, v[64:67] offset:0
  ds_write_b128 v5, v[68:71] offset:1024
  ds_write_b128 v5, v[72:75] offset:2048
  ds_write_b128 v5, v[76:79] offset:3072
  ds_write_b128 v5, v[80:83] offset:4096
  ds_write_b128 v5, v[84:87] offset:5120
  ds_write_b128 v5, v[88:91] offset:6144
  ds_write_b128 v5, v[92:95] offset:7168
  ds_write_b128 v5, v[96:99] offset:8192
  ds_write_b128 v5, v[100:103] offset:9216
  ds_write_b128 v5, v[104:107] offset:10240
  ds_write_b128 v5, v[108:111] offset:11264
  ds_write_b128 v5, v[112:115] offset:12288
  ds_write_b128 v5, v[116:119] offset:13312
  ds_write_b128 v5, v[120:123] offset:14336
  ds_write_b128 v5, v[124:127] offset:15360
  ds_write_b128 v5, v[128:131] offset:16384
  ds_write_b128 v5, v[132:135] offset:17408
  ds_write_b128 v5, v[136:139] offset:18432
  ds_write_b128 v5, v[140:143] offset:19456
  ds_write_b128 v5, v[144:147] offset:20480
  ds_write_b128 v5, v[148:151] offset:21504
  ds_write_b128 v5, v[152:155] offset:22528
  ds_write_b128 v5, v[156:159] offset:23552
  ds_write_b128 v5, v[160:163] offset:24576
  ds_write_b128 v5, v[164:167] offset:25600
  ds_write_b128 v5, v[168:171] offset:26624
  ds_write_b128 v5, v[172:175] offset:27648
  ds_write_b128 v5, v[176:179] offset:28672
  ds_write_b128 v5, v[180:183] offset:29696
  s_waitcnt lgkmcnt(0)
  s_barrier
  ds_read_b64_tr_b16 a[12:13], v8 offset:0
  ds_read_b64_tr_b16 a[14:15], v8 offset:20480
  ds_read_b64_tr_b16 a[36:37], v8 offset:8
  ds_read_b64_tr_b16 a[38:39], v8 offset:20488
  ds_read_b64_tr_b16 a[60:61], v6 offset:64
  ds_read_b64_tr_b16 a[62:63], v6 offset:20544
  ds_read_b64_tr_b16 a[84:85], v8 offset:96
  ds_read_b64_tr_b16 a[86:87], v8 offset:20576
  ds_read_b64_tr_b16 a[108:109], v8 offset:104
  ds_read_b64_tr_b16 a[110:111], v8 offset:20584
  ds_read_b64_tr_b16 a[132:133], v8 offset:160
  ds_read_b64_tr_b16 a[134:135], v8 offset:20640
  ds_read_b64_tr_b16 a[156:157], v8 offset:168
  ds_read_b64_tr_b16 a[158:159], v8 offset:20648
  ds_read_b64_tr_b16 a[180:181], v6 offset:224
  ds_read_b64_tr_b16 a[182:183], v6 offset:20704
  ds_read_b64_tr_b16 a[204:205], v8 offset:256
  ds_read_b64_tr_b16 a[206:207], v8 offset:20736
  ds_read_b64_tr_b16 a[228:229], v8 offset:264
  ds_read_b64_tr_b16 a[230:231], v8 offset:20744
  ds_read_b64_tr_b16 a[16:17], v9 offset:0
  ds_read_b64_tr_b16 a[18:19], v9 offset:20480
  ds_read_b64_tr_b16 a[40:41], v9 offset:8
  ds_read_b64_tr_b16 a[42:43], v9 offset:20488
  ds_read_b64_tr_b16 a[64:65], v7 offset:64
  ds_read_b64_tr_b16 a[66:67], v7 offset:20544
  ds_read_b64_tr_b16 a[88:89], v9 offset:96
  ds_read_b64_tr_b16 a[90:91], v9 offset:20576
  ds_read_b64_tr_b16 a[112:113], v9 offset:104
  ds_read_b64_tr_b16 a[114:115], v9 offset:20584
  ds_read_b64_tr_b16 a[136:137], v9 offset:160
  ds_read_b64_tr_b16 a[138:139], v9 offset:20640
  ds_read_b64_tr_b16 a[160:161], v9 offset:168
  ds_read_b64_tr_b16 a[162:163], v9 offset:20648
  ds_read_b64_tr_b16 a[184:185], v7 offset:224
  ds_read_b64_tr_b16 a[186:187], v7 offset:20704
  ds_read_b64_tr_b16 a[208:209], v9 offset:256
  ds_read_b64_tr_b16 a[210:211], v9 offset:20736
  ds_read_b64_tr_b16 a[232:233], v9 offset:264
  ds_read_b64_tr_b16 a[234:235], v9 offset:20744
  ds_read_b64_tr_b16 a[20:21], v8 offset:40960
  ds_read_b64_tr_b16 a[22:23], v9 offset:40960
  ds_read_b64_tr_b16 a[44:45], v8 offset:40968
  ds_read_b64_tr_b16 a[46:47], v9 offset:40968
  ds_read_b64_tr_b16 a[68:69], v6 offset:41024
  ds_read_b64_tr_b16 a[70:71], v7 offset:41024
  ds_read_b64_tr_b16 a[92:93], v8 offset:41056
  ds_read_b64_tr_b16 a[94:95], v9 offset:41056
  ds_read_b64_tr_b16 a[116:117], v8 offset:41064
  ds_read_b64_tr_b16 a[118:119], v9 offset:41064
  ds_read_b64_tr_b16 a[140:141], v8 offset:41120
  ds_read_b64_tr_b16 a[142:143], v9 offset:41120
  ds_read_b64_tr_b16 a[164:165], v8 offset:41128
  ds_read_b64_tr_b16 a[166:167], v9 offset:41128
  ds_read_b64_tr_b16 a[188:189], v6 offset:41184
  ds_read_b64_tr_b16 a[190:191], v7 offset:41184
  ds_read_b64_tr_b16 a[212:213], v8 offset:41216
  ds_read_b64_tr_b16 a[214:215], v9 offset:41216
  ds_read_b64_tr_b16 a[236:237], v8 offset:41224
  ds_read_b64_tr_b16 a[238:239], v9 offset:41224
  s_waitcnt lgkmcnt(0)
  s_barrier
  s_load_dwordx2 s[32:33], s[0:1], 96
  s_waitcnt lgkmcnt(0)
  s_mov_b32 s32, s32
  s_mov_b32 s33, s33
  s_mov_b32 s34, 256
  s_mov_b32 s35, 0x00020000
  s_mov_b32 s21, 76
  v_mov_b32 v4, 0
  s_mov_b32 s101, 0
wf_242:
  buffer_load_dword v5, v4, s[32:35], s21 offen sc1
  s_add_u32 s101, s101, 1
  s_cmp_gt_u32 s101, 131072
  s_cbranch_scc1 main_end
  s_waitcnt vmcnt(0)
  v_readfirstlane_b32 s100, v5
  s_cmp_ge_u32 s100, 1
  s_cbranch_scc1 wf_243
  s_sleep 8
  s_branch wf_242
wf_243:
  s_sub_u32 s80, s100, 1
  s_lshl_b32 s80, s80, 13
  s_lshl_b32 s40, s2, 2
  s_add_u32 s40, s40, s20
  s_lshl_b32 s40, s40, 14
  s_xor_b32 s40, s40, s80
  s_xor_b32 s40, s40, 8192
  s_mul_i32 s47, s20, 3072
  s_lshr_b32 s43, s2, 2
  s_lshl_b32 s43, s43, 7
  s_add_u32 s43, s43, 28672
  s_xor_b32 s43, s43, s80
  s_lshl_b32 s44, s2, 7
  s_lshl_b32 s21, s20, 2
  s_add_u32 s44, s44, s21
  s_add_u32 s44, s44, 4096
  s_xor_b32 s44, s44, s80
  s_lshl_b32 s49, s20, 8
  s_add_u32 s49, s49, 12288
  s_mov_b32 s45, 0
  v_lshlrev_b32 v4, 4, v1
  v_min_u32 v14, 18, v1
  v_lshlrev_b32 v14, 2, v14
  v_mov_b32 v17, 1073741824
  v_cmp_eq_u32 vcc, 0, v1
  s_nop 1
  v_cndmask_b32 v17, v17, 0, vcc
  v_mov_b32 v16, 0
  v_mov_b32 v18, 65536
vwr_244:
  s_cmp_lg_u32 s20, 0
  s_cbranch_scc1 vwr_247
  s_mov_b32 s101, 0
  s_branch vwr_246
vwr_245:
  s_cmp_lg_u32 s101, 1
  s_cbranch_scc1 vwr_248
  buffer_store_dword v16, v17, s[72:75], s44 offen sc1
vwr_248:
  s_sleep 4
vwr_246:
  buffer_load_dword v15, v14, s[72:75], s43 offen sc1
  s_add_u32 s101, s101, 1
  s_cmp_gt_u32 s101, 131072
  s_cbranch_scc1 main_end
  s_waitcnt vmcnt(0)
  v_cmp_le_u32 vcc, 8, v15
  s_nop 1
  s_ff0_i32_b32 s21, vcc_lo
  s_min_u32 s21, s21, 19
  s_lshl_b32 s22, s21, 1
  s_lshl_b32 s21, s21, 2
  s_sub_i32 s21, s21, 12
  s_max_i32 s46, s21, s22
  s_cmp_le_u32 s46, s45
  s_cbranch_scc1 vwr_245
  v_mov_b32 v15, s46
  ds_write_b32 v18, v15
  s_waitcnt lgkmcnt(0)
  s_barrier
  s_branch vwr_249
vwr_247:
  s_waitcnt vmcnt(0)
  buffer_store_dword v16, v17, s[72:75], s44 offen sc1
  s_barrier
  ds_read_b32 v15, v18
  s_waitcnt lgkmcnt(0)
  v_readfirstlane_b32 s46, v15
vwr_249:
  s_and_b32 s50, s45, 2
  s_lshl_b32 s50, s50, 14
  v_add_u32 v10, s50, v4
  v_add_u32 v11, 2048, v10
  v_add_u32 v12, 2056, v10
  v_lshl_add_u32 v13, v1, 2, s50
  s_lshl_b32 s41, s45, 21
  s_add_u32 s41, s41, s40
  s_mov_b32 s48, s45
  s_mov_b32 s56, s41
  s_add_u32 s57, s56, 4096
  s_lshl_b32 s58, s45, 19
  s_lshl_b32 s21, s45, 11
  s_and_b32 s21, s21, 8192
  s_xor_b32 s21, s21, s80
  s_add_u32 s58, s58, s21
  s_add_u32 s58, s58, 136314880
  s_lshl_b32 s21, s2, 14
  s_lshl_b32 s22, s20, 11
  s_add_u32 s21, s21, s22
  s_add_u32 s58, s58, s21
  s_and_b32 s21, s2, 28
  s_add_u32 s21, s21, s20
  s_lshl_b32 s21, s21, 16
  s_and_b32 s22, s2, 3
  s_lshl_b32 s22, s22, 10
  s_add_u32 s21, s21, s22
  s_lshl_b32 s60, s45, 21
  s_add_u32 s60, s60, s21
  s_add_u32 s60, s60, s80
  s_add_u32 s60, s60, -2093056
  s_xor_b32 s60, s60, 8192
  s_mov_b32 s51, 1073741824
  s_mov_b32 s59, 1073741824
  s_mov_b32 s52, s50
  s_cmp_lt_u32 s48, s46
  s_cselect_b32 s53, s41, 1073741824
  s_add_u32 s54, s52, 0
  s_add_u32 m0, s54, s47
  s_nop 0
  buffer_load_dwordx4 v4, s[16:19], s53 offen offset:0 sc1 lds
  buffer_load_dwordx4 v4, s[16:19], s53 offen offset:1024 sc1 lds
  buffer_load_dwordx4 v4, s[16:19], s53 offen offset:2048 sc1 lds
  s_nop 0
  s_add_u32 m0, s54, s49
  s_nop 0
  buffer_load_dword v14, s[72:75], s43 offen sc1 lds
  s_add_u32 s41, s41, 2097152
  s_xor_b32 s41, s41, 8192
  s_add_u32 s48, s48, 1
  s_cmp_lt_u32 s48, s46
  s_cselect_b32 s53, s41, 1073741824
  s_add_u32 s54, s52, 16384
  s_add_u32 m0, s54, s47
  s_nop 0
  buffer_load_dwordx4 v4, s[16:19], s53 offen offset:0 sc1 lds
  buffer_load_dwordx4 v4, s[16:19], s53 offen offset:1024 sc1 lds
  buffer_load_dwordx4 v4, s[16:19], s53 offen offset:2048 sc1 lds
  s_nop 0
  s_add_u32 m0, s54, s49
  s_nop 0
  buffer_load_dword v14, s[72:75], s43 offen sc1 lds
  s_add_u32 s41, s41, 2097152
  s_xor_b32 s41, s41, 8192
  s_add_u32 s48, s48, 1
  s_xor_b32 s52, s52, 32768
  s_waitcnt vmcnt(0)
  s_barrier
  ds_read_b32 v15, v13 offset:28672
  ds_read_b128 v[64:67], v10 offset:0
  ds_read_b128 v[88:91], v10 offset:1024
  ds_read_b128 v[68:71], v10 offset:3072
  ds_read_b128 v[92:95], v10 offset:4096
  ds_read2st64_b64 v[72:75], v11 offset0:0 offset1:6
  ds_read2st64_b64 v[96:99], v12 offset0:0 offset1:6
  ds_read_b128 v[76:79], v10 offset:6144
  ds_read_b128 v[100:103], v10 offset:7168
  ds_read_b128 v[80:83], v10 offset:9216
  ds_read_b128 v[104:107], v10 offset:10240
  ds_read2st64_b64 v[84:87], v11 offset0:12 offset1:18
  ds_read2st64_b64 v[108:111], v12 offset0:12 offset1:18
  s_waitcnt lgkmcnt(12)
  v_cmp_le_u32 vcc, 8, v15
  s_nop 1
  s_ff0_i32_b32 s21, vcc_lo
  s_min_u32 s21, s21, 19
  s_lshl_b32 s22, s21, 1
  s_lshl_b32 s21, s21, 2
  s_sub_i32 s21, s21, 12
  s_max_i32 s21, s21, s22
  s_max_u32 s46, s21, s46
  s_cmp_lt_u32 s48, s46
  s_cselect_b32 s53, s41, 1073741824
  s_add_u32 s54, s52, 0
  s_add_u32 m0, s54, s47
  s_nop 0
  buffer_load_dwordx4 v4, s[16:19], s53 offen offset:0 sc1 lds
  buffer_load_dwordx4 v4, s[16:19], s53 offen offset:1024 sc1 lds
  buffer_load_dwordx4 v4, s[16:19], s53 offen offset:2048 sc1 lds
  s_nop 0
  s_add_u32 m0, s54, s49
  s_nop 0
  buffer_load_dword v14, s[72:75], s43 offen sc1 lds
  s_add_u32 s41, s41, 2097152
  s_xor_b32 s41, s41, 8192
  s_add_u32 s48, s48, 1
  buffer_store_dword v16, v17, s[72:75], s44 offen sc1
  s_waitcnt lgkmcnt(0)
  .p2align 3
vwl_250:
  v_mfma_f32_16x16x32_bf16 v[160:163], v[64:67], a[0:3], 0
  v_mfma_f32_16x16x32_bf16 v[164:167], v[88:91], a[0:3], 0
  v_mfma_f32_16x16x32_bf16 v[160:163], v[68:71], a[4:7], v[160:163]
  s_add_u32 s60, s60, 2097152
  s_xor_b32 s60, s60, 8192
  s_sub_u32 s62, s60, 0
  v_mfma_f32_16x16x32_bf16 v[164:167], v[92:95], a[4:7], v[164:167]
  s_cmp_ge_u32 s62, 125829120
  s_cselect_b32 s62, 1073741824, s60
  v_cvt_pk_bf16_f32 v204, v184, v185
  v_mfma_f32_16x16x32_bf16 v[160:163], v[72:75], a[8:11], v[160:163]
  v_cvt_pk_bf16_f32 v205, v186, v187
  v_cvt_pk_bf16_f32 v206, v188, v189
  v_mfma_f32_16x16x32_bf16 v[164:167], v[96:99], a[8:11], v[164:167]
  v_cvt_pk_bf16_f32 v207, v190, v191
  buffer_store_dwordx4 v[204:207], v4, s[16:19], s51 offen offset:3072 sc1
  v_mfma_f32_16x16x32_bf16 v[160:163], v[76:79], a[12:15], v[160:163]
  v_mfma_f32_16x16x32_bf16 v[164:167], v[100:103], a[12:15], v[164:167]
  s_waitcnt vmcnt(30)
  s_barrier
  ds_read_b32 v15, v13 offset:28672
  v_mfma_f32_16x16x32_bf16 v[160:163], v[80:83], a[16:19], v[160:163]
  ds_read_b128 v[112:115], v10 offset:16384
  v_mfma_f32_16x16x32_bf16 v[164:167], v[104:107], a[16:19], v[164:167]
  v_mfma_f32_16x16x32_bf16 v[160:163], v[84:87], a[20:23], v[160:163]
  ds_read_b128 v[136:139], v10 offset:17408
  v_mfma_f32_16x16x32_bf16 v[164:167], v[108:111], a[20:23], v[164:167]
  v_mfma_f32_16x16x32_bf16 v[168:171], v[64:67], a[24:27], 0
  ds_read_b128 v[116:119], v10 offset:19456
  v_mfma_f32_16x16x32_bf16 v[172:175], v[88:91], a[24:27], 0
  v_mfma_f32_16x16x32_bf16 v[168:171], v[68:71], a[28:31], v[168:171]
  v_cvt_pk_bf16_f32 v192, v160, v161
  v_cvt_pk_bf16_f32 v193, v162, v163
  v_mfma_f32_16x16x32_bf16 v[172:175], v[92:95], a[28:31], v[172:175]
  v_cvt_pk_bf16_f32 v194, v164, v165
  v_cvt_pk_bf16_f32 v195, v166, v167
  v_mfma_f32_16x16x32_bf16 v[168:171], v[72:75], a[32:35], v[168:171]
  buffer_store_dwordx4 v[192:195], v4, s[16:19], s56 offen offset:0 sc1
  ds_read_b128 v[140:143], v10 offset:20480
  v_mfma_f32_16x16x32_bf16 v[172:175], v[96:99], a[32:35], v[172:175]
  v_mfma_f32_16x16x32_bf16 v[168:171], v[76:79], a[36:39], v[168:171]
  ds_read2st64_b64 v[120:123], v11 offset0:32 offset1:38
  v_mfma_f32_16x16x32_bf16 v[172:175], v[100:103], a[36:39], v[172:175]
  v_mfma_f32_16x16x32_bf16 v[168:171], v[80:83], a[40:43], v[168:171]
  s_add_u32 s55, s62, 0
  ds_read2st64_b64 v[144:147], v12 offset0:32 offset1:38
  v_mfma_f32_16x16x32_bf16 v[172:175], v[104:107], a[40:43], v[172:175]
  buffer_store_dwordx4 v[192:195], v4, s[16:19], s55 offen sc1
  v_mfma_f32_16x16x32_bf16 v[168:171], v[84:87], a[44:47], v[168:171]
  ds_read_b128 v[124:127], v10 offset:22528
  v_mfma_f32_16x16x32_bf16 v[172:175], v[108:111], a[44:47], v[172:175]
  v_mfma_f32_16x16x32_bf16 v[176:179], v[64:67], a[48:51], 0
  ds_read_b128 v[148:151], v10 offset:23552
  v_mfma_f32_16x16x32_bf16 v[180:183], v[88:91], a[48:51], 0
  v_mfma_f32_16x16x32_bf16 v[176:179], v[68:71], a[52:55], v[176:179]
  v_cvt_pk_bf16_f32 v196, v168, v169
  v_cvt_pk_bf16_f32 v197, v170, v171
  v_mfma_f32_16x16x32_bf16 v[180:183], v[92:95], a[52:55], v[180:183]
  v_cvt_pk_bf16_f32 v198, v172, v173
  v_cvt_pk_bf16_f32 v199, v174, v175
  v_mfma_f32_16x16x32_bf16 v[176:179], v[72:75], a[56:59], v[176:179]
  buffer_store_dwordx4 v[196:199], v4, s[16:19], s56 offen offset:1024 sc1
  ds_read_b128 v[128:131], v10 offset:25600
  v_mfma_f32_16x16x32_bf16 v[180:183], v[96:99], a[56:59], v[180:183]
  v_mfma_f32_16x16x32_bf16 v[176:179], v[76:79], a[60:63], v[176:179]
  ds_read_b128 v[152:155], v10 offset:26624
  v_mfma_f32_16x16x32_bf16 v[180:183], v[100:103], a[60:63], v[180:183]
  v_mfma_f32_16x16x32_bf16 v[176:179], v[80:83], a[64:67], v[176:179]
  ds_read2st64_b64 v[132:135], v11 offset0:44 offset1:50
  v_mfma_f32_16x16x32_bf16 v[180:183], v[104:107], a[64:67], v[180:183]
  v_mfma_f32_16x16x32_bf16 v[176:179], v[84:87], a[68:71], v[176:179]
  ds_read2st64_b64 v[156:159], v12 offset0:44 offset1:50
  v_mfma_f32_16x16x32_bf16 v[180:183], v[108:111], a[68:71], v[180:183]
  v_mfma_f32_16x16x32_bf16 v[184:187], v[64:67], a[72:75], 0
  v_mfma_f32_16x16x32_bf16 v[188:191], v[88:91], a[72:75], 0
  s_waitcnt lgkmcnt(12)
  v_cmp_le_u32 vcc, 8, v15
  v_mfma_f32_16x16x32_bf16 v[184:187], v[68:71], a[76:79], v[184:187]
  v_cvt_pk_bf16_f32 v200, v176, v177
  v_cvt_pk_bf16_f32 v201, v178, v179
  v_mfma_f32_16x16x32_bf16 v[188:191], v[92:95], a[76:79], v[188:191]
  s_ff0_i32_b32 s21, vcc_lo
  v_cvt_pk_bf16_f32 v202, v180, v181
  v_cvt_pk_bf16_f32 v203, v182, v183
  v_mfma_f32_16x16x32_bf16 v[184:187], v[72:75], a[80:83], v[184:187]
  s_min_u32 s21, s21, 19
  buffer_store_dwordx4 v[200:203], v4, s[16:19], s58 offen offset:0 sc1
  s_lshl_b32 s22, s21, 1
  v_mfma_f32_16x16x32_bf16 v[188:191], v[96:99], a[80:83], v[188:191]
  s_lshl_b32 s21, s21, 2
  s_sub_i32 s21, s21, 12
  s_max_i32 s21, s21, s22
  v_mfma_f32_16x16x32_bf16 v[184:187], v[76:79], a[84:87], v[184:187]
  s_max_u32 s42, s21, s46
  s_cmp_ge_u32 s46, s48
  s_cselect_b32 s46, s42, s46
  v_mfma_f32_16x16x32_bf16 v[188:191], v[100:103], a[84:87], v[188:191]
  s_cmp_lt_u32 s48, s46
  s_cselect_b32 s53, s41, 1073741824
  s_add_u32 s54, s52, 16384
  v_mfma_f32_16x16x32_bf16 v[184:187], v[80:83], a[88:91], v[184:187]
  s_add_u32 m0, s54, s47
  v_mfma_f32_16x16x32_bf16 v[188:191], v[104:107], a[88:91], v[188:191]
  buffer_load_dwordx4 v4, s[16:19], s53 offen offset:0 sc1 lds
  buffer_load_dwordx4 v4, s[16:19], s53 offen offset:1024 sc1 lds
  v_mfma_f32_16x16x32_bf16 v[184:187], v[84:87], a[92:95], v[184:187]
  buffer_load_dwordx4 v4, s[16:19], s53 offen offset:2048 sc1 lds
  v_mfma_f32_16x16x32_bf16 v[188:191], v[108:111], a[92:95], v[188:191]
  s_add_u32 m0, s54, s49
  v_mfma_f32_16x16x32_bf16 v[160:163], v[64:67], a[96:99], 0
  buffer_load_dword v14, s[72:75], s43 offen sc1 lds
  s_add_u32 s41, s41, 2097152
  v_mfma_f32_16x16x32_bf16 v[164:167], v[88:91], a[96:99], 0
  s_xor_b32 s41, s41, 8192
  s_add_u32 s48, s48, 1
  v_mfma_f32_16x16x32_bf16 v[160:163], v[68:71], a[100:103], v[160:163]
  v_cvt_pk_bf16_f32 v204, v184, v185
  v_cvt_pk_bf16_f32 v205, v186, v187
  v_mfma_f32_16x16x32_bf16 v[164:167], v[92:95], a[100:103], v[164:167]
  v_cvt_pk_bf16_f32 v206, v188, v189
  v_cvt_pk_bf16_f32 v207, v190, v191
  v_mfma_f32_16x16x32_bf16 v[160:163], v[72:75], a[104:107], v[160:163]
  buffer_store_dwordx4 v[204:207], v4, s[16:19], s56 offen offset:2048 sc1
  v_mfma_f32_16x16x32_bf16 v[164:167], v[96:99], a[104:107], v[164:167]
  v_mfma_f32_16x16x32_bf16 v[160:163], v[76:79], a[108:111], v[160:163]
  v_mfma_f32_16x16x32_bf16 v[164:167], v[100:103], a[108:111], v[164:167]
  v_mfma_f32_16x16x32_bf16 v[160:163], v[80:83], a[112:115], v[160:163]
  s_add_u32 s55, s62, 16384
  v_mfma_f32_16x16x32_bf16 v[164:167], v[104:107], a[112:115], v[164:167]
  buffer_store_dwordx4 v[204:207], v4, s[16:19], s55 offen sc1
  v_mfma_f32_16x16x32_bf16 v[160:163], v[84:87], a[116:119], v[160:163]
  v_mfma_f32_16x16x32_bf16 v[164:167], v[108:111], a[116:119], v[164:167]
  v_mfma_f32_16x16x32_bf16 v[168:171], v[64:67], a[120:123], 0
  v_mfma_f32_16x16x32_bf16 v[172:175], v[88:91], a[120:123], 0
  v_mfma_f32_16x16x32_bf16 v[168:171], v[68:71], a[124:127], v[168:171]
  v_cvt_pk_bf16_f32 v192, v160, v161
  v_cvt_pk_bf16_f32 v193, v162, v163
  v_mfma_f32_16x16x32_bf16 v[172:175], v[92:95], a[124:127], v[172:175]
  v_cvt_pk_bf16_f32 v194, v164, v165
  v_cvt_pk_bf16_f32 v195, v166, v167
  v_mfma_f32_16x16x32_bf16 v[168:171], v[72:75], a[128:131], v[168:171]
  buffer_store_dwordx4 v[192:195], v4, s[16:19], s56 offen offset:3072 sc1
  v_mfma_f32_16x16x32_bf16 v[172:175], v[96:99], a[128:131], v[172:175]
  v_mfma_f32_16x16x32_bf16 v[168:171], v[76:79], a[132:135], v[168:171]
  v_mfma_f32_16x16x32_bf16 v[172:175], v[100:103], a[132:135], v[172:175]
  v_mfma_f32_16x16x32_bf16 v[168:171], v[80:83], a[136:139], v[168:171]
  v_mfma_f32_16x16x32_bf16 v[172:175], v[104:107], a[136:139], v[172:175]
  v_mfma_f32_16x16x32_bf16 v[168:171], v[84:87], a[140:143], v[168:171]
  v_mfma_f32_16x16x32_bf16 v[172:175], v[108:111], a[140:143], v[172:175]
  v_mfma_f32_16x16x32_bf16 v[176:179], v[64:67], a[144:147], 0
  v_mfma_f32_16x16x32_bf16 v[180:183], v[88:91], a[144:147], 0
  v_mfma_f32_16x16x32_bf16 v[176:179], v[68:71], a[148:151], v[176:179]
  v_cvt_pk_bf16_f32 v196, v168, v169
  v_cvt_pk_bf16_f32 v197, v170, v171
  v_mfma_f32_16x16x32_bf16 v[180:183], v[92:95], a[148:151], v[180:183]
  v_cvt_pk_bf16_f32 v198, v172, v173
  v_cvt_pk_bf16_f32 v199, v174, v175
  v_mfma_f32_16x16x32_bf16 v[176:179], v[72:75], a[152:155], v[176:179]
  buffer_store_dwordx4 v[196:199], v4, s[16:19], s57 offen offset:0 sc1
  v_mfma_f32_16x16x32_bf16 v[180:183], v[96:99], a[152:155], v[180:183]
  v_mfma_f32_16x16x32_bf16 v[176:179], v[76:79], a[156:159], v[176:179]
  v_mfma_f32_16x16x32_bf16 v[180:183], v[100:103], a[156:159], v[180:183]
  v_mfma_f32_16x16x32_bf16 v[176:179], v[80:83], a[160:163], v[176:179]
  s_add_u32 s55, s62, 32768
  v_mfma_f32_16x16x32_bf16 v[180:183], v[104:107], a[160:163], v[180:183]
  buffer_store_dwordx4 v[196:199], v4, s[16:19], s55 offen sc1
  v_mfma_f32_16x16x32_bf16 v[176:179], v[84:87], a[164:167], v[176:179]
  v_mfma_f32_16x16x32_bf16 v[180:183], v[108:111], a[164:167], v[180:183]
  v_mfma_f32_16x16x32_bf16 v[184:187], v[64:67], a[168:171], 0
  v_mfma_f32_16x16x32_bf16 v[188:191], v[88:91], a[168:171], 0
  v_mfma_f32_16x16x32_bf16 v[184:187], v[68:71], a[172:175], v[184:187]
  v_cvt_pk_bf16_f32 v200, v176, v177
  v_cvt_pk_bf16_f32 v201, v178, v179
  v_mfma_f32_16x16x32_bf16 v[188:191], v[92:95], a[172:175], v[188:191]
  v_cvt_pk_bf16_f32 v202, v180, v181
  v_cvt_pk_bf16_f32 v203, v182, v183
  v_mfma_f32_16x16x32_bf16 v[184:187], v[72:75], a[176:179], v[184:187]
  buffer_store_dwordx4 v[200:203], v4, s[16:19], s57 offen offset:1024 sc1
  v_mfma_f32_16x16x32_bf16 v[188:191], v[96:99], a[176:179], v[188:191]
  v_mfma_f32_16x16x32_bf16 v[184:187], v[76:79], a[180:183], v[184:187]
  v_mfma_f32_16x16x32_bf16 v[188:191], v[100:103], a[180:183], v[188:191]
  v_mfma_f32_16x16x32_bf16 v[184:187], v[80:83], a[184:187], v[184:187]
  v_mfma_f32_16x16x32_bf16 v[188:191], v[104:107], a[184:187], v[188:191]
  v_mfma_f32_16x16x32_bf16 v[184:187], v[84:87], a[188:191], v[184:187]
  v_mfma_f32_16x16x32_bf16 v[188:191], v[108:111], a[188:191], v[188:191]
  v_mfma_f32_16x16x32_bf16 v[160:163], v[64:67], a[192:195], 0
  s_min_u32 s21, s45, 56
  v_mov_b32 v16, s21
  s_waitcnt vmcnt(14)
  v_mfma_f32_16x16x32_bf16 v[164:167], v[88:91], a[192:195], 0
  buffer_store_dword v16, v17, s[72:75], s44 offen sc1
  v_mfma_f32_16x16x32_bf16 v[160:163], v[68:71], a[196:199], v[160:163]
  v_cvt_pk_bf16_f32 v204, v184, v185
  v_cvt_pk_bf16_f32 v205, v186, v187
  v_mfma_f32_16x16x32_bf16 v[164:167], v[92:95], a[196:199], v[164:167]
  v_cvt_pk_bf16_f32 v206, v188, v189
  v_cvt_pk_bf16_f32 v207, v190, v191
  v_mfma_f32_16x16x32_bf16 v[160:163], v[72:75], a[200:203], v[160:163]
  buffer_store_dwordx4 v[204:207], v4, s[16:19], s58 offen offset:1024 sc1
  v_mfma_f32_16x16x32_bf16 v[164:167], v[96:99], a[200:203], v[164:167]
  v_mfma_f32_16x16x32_bf16 v[160:163], v[76:79], a[204:207], v[160:163]
  s_add_u32 s56, s56, 2097152
  s_xor_b32 s56, s56, 8192
  s_add_u32 s59, s58, 524288
  v_mfma_f32_16x16x32_bf16 v[164:167], v[100:103], a[204:207], v[164:167]
  s_xor_b32 s58, s58, s59
  s_lshr_b32 s58, s58, 8
  s_and_b32 s58, s58, 8192
  v_mfma_f32_16x16x32_bf16 v[160:163], v[80:83], a[208:211], v[160:163]
  s_xor_b32 s58, s58, s59
  v_mfma_f32_16x16x32_bf16 v[164:167], v[104:107], a[208:211], v[164:167]
  v_mfma_f32_16x16x32_bf16 v[160:163], v[84:87], a[212:215], v[160:163]
  v_mfma_f32_16x16x32_bf16 v[164:167], v[108:111], a[212:215], v[164:167]
  v_mfma_f32_16x16x32_bf16 v[168:171], v[64:67], a[216:219], 0
  v_mfma_f32_16x16x32_bf16 v[172:175], v[88:91], a[216:219], 0
  v_mfma_f32_16x16x32_bf16 v[168:171], v[68:71], a[220:223], v[168:171]
  v_cvt_pk_bf16_f32 v192, v160, v161
  v_cvt_pk_bf16_f32 v193, v162, v163
  v_mfma_f32_16x16x32_bf16 v[172:175], v[92:95], a[220:223], v[172:175]
  v_cvt_pk_bf16_f32 v194, v164, v165
  v_cvt_pk_bf16_f32 v195, v166, v167
  v_mfma_f32_16x16x32_bf16 v[168:171], v[72:75], a[224:227], v[168:171]
  buffer_store_dwordx4 v[192:195], v4, s[16:19], s57 offen offset:2048 sc1
  v_mfma_f32_16x16x32_bf16 v[172:175], v[96:99], a[224:227], v[172:175]
  s_add_u32 s55, s62, 49152
  v_mfma_f32_16x16x32_bf16 v[168:171], v[76:79], a[228:231], v[168:171]
  buffer_store_dwordx4 v[192:195], v4, s[16:19], s55 offen sc1
  s_mov_b32 s51, s57
  v_mfma_f32_16x16x32_bf16 v[172:175], v[100:103], a[228:231], v[172:175]
  s_add_u32 s57, s56, 4096
  s_add_u32 s45, s45, 1
  v_mfma_f32_16x16x32_bf16 v[168:171], v[80:83], a[232:235], v[168:171]
  v_mfma_f32_16x16x32_bf16 v[172:175], v[104:107], a[232:235], v[172:175]
  v_mfma_f32_16x16x32_bf16 v[168:171], v[84:87], a[236:239], v[168:171]
  v_mfma_f32_16x16x32_bf16 v[172:175], v[108:111], a[236:239], v[172:175]
  s_waitcnt lgkmcnt(0)
  v_mfma_f32_16x16x32_bf16 v[176:179], v[112:115], a[0:3], 0
  v_mfma_f32_16x16x32_bf16 v[180:183], v[136:139], a[0:3], 0
  v_mfma_f32_16x16x32_bf16 v[176:179], v[116:119], a[4:7], v[176:179]
  v_cvt_pk_bf16_f32 v196, v168, v169
  v_cvt_pk_bf16_f32 v197, v170, v171
  v_mfma_f32_16x16x32_bf16 v[180:183], v[140:143], a[4:7], v[180:183]
  s_add_u32 s60, s60, 2097152
  v_cvt_pk_bf16_f32 v198, v172, v173
  v_cvt_pk_bf16_f32 v199, v174, v175
  v_mfma_f32_16x16x32_bf16 v[176:179], v[120:123], a[8:11], v[176:179]
  s_xor_b32 s60, s60, 8192
  buffer_store_dwordx4 v[196:199], v4, s[16:19], s51 offen offset:3072 sc1
  s_sub_u32 s62, s60, 0
  v_mfma_f32_16x16x32_bf16 v[180:183], v[144:147], a[8:11], v[180:183]
  s_cmp_ge_u32 s62, 125829120
  s_cselect_b32 s62, 1073741824, s60
  v_mfma_f32_16x16x32_bf16 v[176:179], v[124:127], a[12:15], v[176:179]
  v_mfma_f32_16x16x32_bf16 v[180:183], v[148:151], a[12:15], v[180:183]
  s_waitcnt vmcnt(20)
  s_barrier
  v_xor_b32 v10, 32768, v10
  v_mfma_f32_16x16x32_bf16 v[176:179], v[128:131], a[16:19], v[176:179]
  v_xor_b32 v11, 32768, v11
  v_xor_b32 v12, 32768, v12
  v_mfma_f32_16x16x32_bf16 v[180:183], v[152:155], a[16:19], v[180:183]
  v_xor_b32 v13, 32768, v13
  ds_read_b32 v15, v13 offset:12288
  v_mfma_f32_16x16x32_bf16 v[176:179], v[132:135], a[20:23], v[176:179]
  ds_read_b128 v[64:67], v10 offset:0
  v_mfma_f32_16x16x32_bf16 v[180:183], v[156:159], a[20:23], v[180:183]
  v_mfma_f32_16x16x32_bf16 v[184:187], v[112:115], a[24:27], 0
  ds_read_b128 v[88:91], v10 offset:1024
  v_mfma_f32_16x16x32_bf16 v[188:191], v[136:139], a[24:27], 0
  v_mfma_f32_16x16x32_bf16 v[184:187], v[116:119], a[28:31], v[184:187]
  v_cvt_pk_bf16_f32 v200, v176, v177
  v_cvt_pk_bf16_f32 v201, v178, v179
  v_mfma_f32_16x16x32_bf16 v[188:191], v[140:143], a[28:31], v[188:191]
  v_cvt_pk_bf16_f32 v202, v180, v181
  v_cvt_pk_bf16_f32 v203, v182, v183
  v_mfma_f32_16x16x32_bf16 v[184:187], v[120:123], a[32:35], v[184:187]
  buffer_store_dwordx4 v[200:203], v4, s[16:19], s56 offen offset:0 sc1
  ds_read_b128 v[68:71], v10 offset:3072
  v_mfma_f32_16x16x32_bf16 v[188:191], v[144:147], a[32:35], v[188:191]
  v_mfma_f32_16x16x32_bf16 v[184:187], v[124:127], a[36:39], v[184:187]
  ds_read_b128 v[92:95], v10 offset:4096
  v_mfma_f32_16x16x32_bf16 v[188:191], v[148:151], a[36:39], v[188:191]
  v_mfma_f32_16x16x32_bf16 v[184:187], v[128:131], a[40:43], v[184:187]
  s_add_u32 s55, s62, 0
  ds_read2st64_b64 v[72:75], v11 offset0:0 offset1:6
  v_mfma_f32_16x16x32_bf16 v[188:191], v[152:155], a[40:43], v[188:191]
  buffer_store_dwordx4 v[200:203], v4, s[16:19], s55 offen sc1
  v_mfma_f32_16x16x32_bf16 v[184:187], v[132:135], a[44:47], v[184:187]
  ds_read2st64_b64 v[96:99], v12 offset0:0 offset1:6
  v_mfma_f32_16x16x32_bf16 v[188:191], v[156:159], a[44:47], v[188:191]
  v_mfma_f32_16x16x32_bf16 v[160:163], v[112:115], a[48:51], 0
  ds_read_b128 v[76:79], v10 offset:6144
  v_mfma_f32_16x16x32_bf16 v[164:167], v[136:139], a[48:51], 0
  v_mfma_f32_16x16x32_bf16 v[160:163], v[116:119], a[52:55], v[160:163]
  v_cvt_pk_bf16_f32 v204, v184, v185
  v_cvt_pk_bf16_f32 v205, v186, v187
  v_mfma_f32_16x16x32_bf16 v[164:167], v[140:143], a[52:55], v[164:167]
  v_cvt_pk_bf16_f32 v206, v188, v189
  v_cvt_pk_bf16_f32 v207, v190, v191
  v_mfma_f32_16x16x32_bf16 v[160:163], v[120:123], a[56:59], v[160:163]
  buffer_store_dwordx4 v[204:207], v4, s[16:19], s56 offen offset:1024 sc1
  ds_read_b128 v[100:103], v10 offset:7168
  v_mfma_f32_16x16x32_bf16 v[164:167], v[144:147], a[56:59], v[164:167]
  v_mfma_f32_16x16x32_bf16 v[160:163], v[124:127], a[60:63], v[160:163]
  ds_read_b128 v[80:83], v10 offset:9216
  v_mfma_f32_16x16x32_bf16 v[164:167], v[148:151], a[60:63], v[164:167]
  v_mfma_f32_16x16x32_bf16 v[160:163], v[128:131], a[64:67], v[160:163]
  ds_read_b128 v[104:107], v10 offset:10240
  v_mfma_f32_16x16x32_bf16 v[164:167], v[152:155], a[64:67], v[164:167]
  v_mfma_f32_16x16x32_bf16 v[160:163], v[132:135], a[68:71], v[160:163]
  ds_read2st64_b64 v[84:87], v11 offset0:12 offset1:18
  v_mfma_f32_16x16x32_bf16 v[164:167], v[156:159], a[68:71], v[164:167]
  v_mfma_f32_16x16x32_bf16 v[168:171], v[112:115], a[72:75], 0
  ds_read2st64_b64 v[108:111], v12 offset0:12 offset1:18
  v_mfma_f32_16x16x32_bf16 v[172:175], v[136:139], a[72:75], 0
  v_mfma_f32_16x16x32_bf16 v[168:171], v[116:119], a[76:79], v[168:171]
  v_cvt_pk_bf16_f32 v192, v160, v161
  v_cvt_pk_bf16_f32 v193, v162, v163
  v_mfma_f32_16x16x32_bf16 v[172:175], v[140:143], a[76:79], v[172:175]
  v_cvt_pk_bf16_f32 v194, v164, v165
  v_cvt_pk_bf16_f32 v195, v166, v167
  v_mfma_f32_16x16x32_bf16 v[168:171], v[120:123], a[80:83], v[168:171]
  buffer_store_dwordx4 v[192:195], v4, s[16:19], s58 offen offset:0 sc1
  s_waitcnt lgkmcnt(12)
  v_mfma_f32_16x16x32_bf16 v[172:175], v[144:147], a[80:83], v[172:175]
  v_cmp_le_u32 vcc, 8, v15
  v_mfma_f32_16x16x32_bf16 v[168:171], v[124:127], a[84:87], v[168:171]
  s_ff0_i32_b32 s21, vcc_lo
  s_min_u32 s21, s21, 19
  s_lshl_b32 s22, s21, 1
  v_mfma_f32_16x16x32_bf16 v[172:175], v[148:151], a[84:87], v[172:175]
  s_lshl_b32 s21, s21, 2
  s_sub_i32 s21, s21, 12
  s_max_i32 s21, s21, s22
  v_mfma_f32_16x16x32_bf16 v[168:171], v[128:131], a[88:91], v[168:171]
  s_max_u32 s42, s21, s46
  s_cmp_ge_u32 s46, s48
  s_cselect_b32 s46, s42, s46
  v_mfma_f32_16x16x32_bf16 v[172:175], v[152:155], a[88:91], v[172:175]
  s_xor_b32 s52, s52, 32768
  s_cmp_lt_u32 s48, s46
  s_cselect_b32 s53, s41, 1073741824
  v_mfma_f32_16x16x32_bf16 v[168:171], v[132:135], a[92:95], v[168:171]
  s_add_u32 s54, s52, 0
  s_add_u32 m0, s54, s47
  v_mfma_f32_16x16x32_bf16 v[172:175], v[156:159], a[92:95], v[172:175]
  buffer_load_dwordx4 v4, s[16:19], s53 offen offset:0 sc1 lds
  buffer_load_dwordx4 v4, s[16:19], s53 offen offset:1024 sc1 lds
  v_mfma_f32_16x16x32_bf16 v[176:179], v[112:115], a[96:99], 0
  buffer_load_dwordx4 v4, s[16:19], s53 offen offset:2048 sc1 lds
  v_mfma_f32_16x16x32_bf16 v[180:183], v[136:139], a[96:99], 0
  s_add_u32 m0, s54, s49
  v_mfma_f32_16x16x32_bf16 v[176:179], v[116:119], a[100:103], v[176:179]
  v_cvt_pk_bf16_f32 v196, v168, v169
  v_cvt_pk_bf16_f32 v197, v170, v171
  v_mfma_f32_16x16x32_bf16 v[180:183], v[140:143], a[100:103], v[180:183]
  v_cvt_pk_bf16_f32 v198, v172, v173
  v_cvt_pk_bf16_f32 v199, v174, v175
  v_mfma_f32_16x16x32_bf16 v[176:179], v[120:123], a[104:107], v[176:179]
  buffer_store_dwordx4 v[196:199], v4, s[16:19], s56 offen offset:2048 sc1
  buffer_load_dword v14, s[72:75], s43 offen sc1 lds
  v_mfma_f32_16x16x32_bf16 v[180:183], v[144:147], a[104:107], v[180:183]
  s_add_u32 s41, s41, 2097152
  s_xor_b32 s41, s41, 8192
  s_add_u32 s48, s48, 1
  v_mfma_f32_16x16x32_bf16 v[176:179], v[124:127], a[108:111], v[176:179]
  v_mfma_f32_16x16x32_bf16 v[180:183], v[148:151], a[108:111], v[180:183]
  v_mfma_f32_16x16x32_bf16 v[176:179], v[128:131], a[112:115], v[176:179]
  s_add_u32 s55, s62, 16384
  v_mfma_f32_16x16x32_bf16 v[180:183], v[152:155], a[112:115], v[180:183]
  buffer_store_dwordx4 v[196:199], v4, s[16:19], s55 offen sc1
  v_mfma_f32_16x16x32_bf16 v[176:179], v[132:135], a[116:119], v[176:179]
  v_mfma_f32_16x16x32_bf16 v[180:183], v[156:159], a[116:119], v[180:183]
  v_mfma_f32_16x16x32_bf16 v[184:187], v[112:115], a[120:123], 0
  v_mfma_f32_16x16x32_bf16 v[188:191], v[136:139], a[120:123], 0
  v_mfma_f32_16x16x32_bf16 v[184:187], v[116:119], a[124:127], v[184:187]
  v_cvt_pk_bf16_f32 v200, v176, v177
  v_cvt_pk_bf16_f32 v201, v178, v179
  v_mfma_f32_16x16x32_bf16 v[188:191], v[140:143], a[124:127], v[188:191]
  v_cvt_pk_bf16_f32 v202, v180, v181
  v_cvt_pk_bf16_f32 v203, v182, v183
  v_mfma_f32_16x16x32_bf16 v[184:187], v[120:123], a[128:131], v[184:187]
  buffer_store_dwordx4 v[200:203], v4, s[16:19], s56 offen offset:3072 sc1
  v_mfma_f32_16x16x32_bf16 v[188:191], v[144:147], a[128:131], v[188:191]
  v_mfma_f32_16x16x32_bf16 v[184:187], v[124:127], a[132:135], v[184:187]
  v_mfma_f32_16x16x32_bf16 v[188:191], v[148:151], a[132:135], v[188:191]
  v_mfma_f32_16x16x32_bf16 v[184:187], v[128:131], a[136:139], v[184:187]
  v_mfma_f32_16x16x32_bf16 v[188:191], v[152:155], a[136:139], v[188:191]
  v_mfma_f32_16x16x32_bf16 v[184:187], v[132:135], a[140:143], v[184:187]
  v_mfma_f32_16x16x32_bf16 v[188:191], v[156:159], a[140:143], v[188:191]
  v_mfma_f32_16x16x32_bf16 v[160:163], v[112:115], a[144:147], 0
  v_mfma_f32_16x16x32_bf16 v[164:167], v[136:139], a[144:147], 0
  v_mfma_f32_16x16x32_bf16 v[160:163], v[116:119], a[148:151], v[160:163]
  v_cvt_pk_bf16_f32 v204, v184, v185
  v_cvt_pk_bf16_f32 v205, v186, v187
  v_mfma_f32_16x16x32_bf16 v[164:167], v[140:143], a[148:151], v[164:167]
  v_cvt_pk_bf16_f32 v206, v188, v189
  v_cvt_pk_bf16_f32 v207, v190, v191
  v_mfma_f32_16x16x32_bf16 v[160:163], v[120:123], a[152:155], v[160:163]
  buffer_store_dwordx4 v[204:207], v4, s[16:19], s57 offen offset:0 sc1
  v_mfma_f32_16x16x32_bf16 v[164:167], v[144:147], a[152:155], v[164:167]
  v_mfma_f32_16x16x32_bf16 v[160:163], v[124:127], a[156:159], v[160:163]
  v_mfma_f32_16x16x32_bf16 v[164:167], v[148:151], a[156:159], v[164:167]
  v_mfma_f32_16x16x32_bf16 v[160:163], v[128:131], a[160:163], v[160:163]
  s_add_u32 s55, s62, 32768
  v_mfma_f32_16x16x32_bf16 v[164:167], v[152:155], a[160:163], v[164:167]
  buffer_store_dwordx4 v[204:207], v4, s[16:19], s55 offen sc1
  v_mfma_f32_16x16x32_bf16 v[160:163], v[132:135], a[164:167], v[160:163]
  v_mfma_f32_16x16x32_bf16 v[164:167], v[156:159], a[164:167], v[164:167]
  v_mfma_f32_16x16x32_bf16 v[168:171], v[112:115], a[168:171], 0
  v_mfma_f32_16x16x32_bf16 v[172:175], v[136:139], a[168:171], 0
  v_mfma_f32_16x16x32_bf16 v[168:171], v[116:119], a[172:175], v[168:171]
  v_cvt_pk_bf16_f32 v192, v160, v161
  v_cvt_pk_bf16_f32 v193, v162, v163
  v_mfma_f32_16x16x32_bf16 v[172:175], v[140:143], a[172:175], v[172:175]
  v_cvt_pk_bf16_f32 v194, v164, v165
  v_cvt_pk_bf16_f32 v195, v166, v167
  v_mfma_f32_16x16x32_bf16 v[168:171], v[120:123], a[176:179], v[168:171]
  buffer_store_dwordx4 v[192:195], v4, s[16:19], s57 offen offset:1024 sc1
  v_mfma_f32_16x16x32_bf16 v[172:175], v[144:147], a[176:179], v[172:175]
  v_mfma_f32_16x16x32_bf16 v[168:171], v[124:127], a[180:183], v[168:171]
  v_mfma_f32_16x16x32_bf16 v[172:175], v[148:151], a[180:183], v[172:175]
  v_mfma_f32_16x16x32_bf16 v[168:171], v[128:131], a[184:187], v[168:171]
  v_mfma_f32_16x16x32_bf16 v[172:175], v[152:155], a[184:187], v[172:175]
  v_mfma_f32_16x16x32_bf16 v[168:171], v[132:135], a[188:191], v[168:171]
  v_mfma_f32_16x16x32_bf16 v[172:175], v[156:159], a[188:191], v[172:175]
  v_mfma_f32_16x16x32_bf16 v[176:179], v[112:115], a[192:195], 0
  s_min_u32 s21, s45, 56
  v_mov_b32 v16, s21
  s_waitcnt vmcnt(14)
  v_mfma_f32_16x16x32_bf16 v[180:183], v[136:139], a[192:195], 0
  buffer_store_dword v16, v17, s[72:75], s44 offen sc1
  v_mfma_f32_16x16x32_bf16 v[176:179], v[116:119], a[196:199], v[176:179]
  v_cvt_pk_bf16_f32 v196, v168, v169
  v_cvt_pk_bf16_f32 v197, v170, v171
  v_mfma_f32_16x16x32_bf16 v[180:183], v[140:143], a[196:199], v[180:183]
  v_cvt_pk_bf16_f32 v198, v172, v173
  v_cvt_pk_bf16_f32 v199, v174, v175
  v_mfma_f32_16x16x32_bf16 v[176:179], v[120:123], a[200:203], v[176:179]
  buffer_store_dwordx4 v[196:199], v4, s[16:19], s58 offen offset:1024 sc1
  v_mfma_f32_16x16x32_bf16 v[180:183], v[144:147], a[200:203], v[180:183]
  v_mfma_f32_16x16x32_bf16 v[176:179], v[124:127], a[204:207], v[176:179]
  s_add_u32 s56, s56, 2097152
  s_xor_b32 s56, s56, 8192
  s_add_u32 s59, s58, 524288
  v_mfma_f32_16x16x32_bf16 v[180:183], v[148:151], a[204:207], v[180:183]
  s_xor_b32 s58, s58, s59
  s_lshr_b32 s58, s58, 8
  s_and_b32 s58, s58, 8192
  v_mfma_f32_16x16x32_bf16 v[176:179], v[128:131], a[208:211], v[176:179]
  s_xor_b32 s58, s58, s59
  v_mfma_f32_16x16x32_bf16 v[180:183], v[152:155], a[208:211], v[180:183]
  v_mfma_f32_16x16x32_bf16 v[176:179], v[132:135], a[212:215], v[176:179]
  v_mfma_f32_16x16x32_bf16 v[180:183], v[156:159], a[212:215], v[180:183]
  v_mfma_f32_16x16x32_bf16 v[184:187], v[112:115], a[216:219], 0
  v_mfma_f32_16x16x32_bf16 v[188:191], v[136:139], a[216:219], 0
  v_mfma_f32_16x16x32_bf16 v[184:187], v[116:119], a[220:223], v[184:187]
  v_cvt_pk_bf16_f32 v200, v176, v177
  v_cvt_pk_bf16_f32 v201, v178, v179
  v_mfma_f32_16x16x32_bf16 v[188:191], v[140:143], a[220:223], v[188:191]
  v_cvt_pk_bf16_f32 v202, v180, v181
  v_cvt_pk_bf16_f32 v203, v182, v183
  v_mfma_f32_16x16x32_bf16 v[184:187], v[120:123], a[224:227], v[184:187]
  buffer_store_dwordx4 v[200:203], v4, s[16:19], s57 offen offset:2048 sc1
  v_mfma_f32_16x16x32_bf16 v[188:191], v[144:147], a[224:227], v[188:191]
  s_add_u32 s55, s62, 49152
  v_mfma_f32_16x16x32_bf16 v[184:187], v[124:127], a[228:231], v[184:187]
  buffer_store_dwordx4 v[200:203], v4, s[16:19], s55 offen sc1
  s_mov_b32 s51, s57
  v_mfma_f32_16x16x32_bf16 v[188:191], v[148:151], a[228:231], v[188:191]
  s_add_u32 s57, s56, 4096
  s_add_u32 s45, s45, 1
  v_mfma_f32_16x16x32_bf16 v[184:187], v[128:131], a[232:235], v[184:187]
  v_mfma_f32_16x16x32_bf16 v[188:191], v[152:155], a[232:235], v[188:191]
  v_mfma_f32_16x16x32_bf16 v[184:187], v[132:135], a[236:239], v[184:187]
  s_cmp_lt_u32 s45, s46
  v_mfma_f32_16x16x32_bf16 v[188:191], v[156:159], a[236:239], v[188:191]
  s_waitcnt lgkmcnt(0)
  s_cbranch_scc1 vwl_250
  s_nop 7
  v_cvt_pk_bf16_f32 v204, v184, v185
  v_cvt_pk_bf16_f32 v205, v186, v187
  v_cvt_pk_bf16_f32 v206, v188, v189
  v_cvt_pk_bf16_f32 v207, v190, v191
  buffer_store_dwordx4 v[204:207], v4, s[16:19], s51 offen offset:3072 sc1
  s_min_u32 s21, s45, 56
  v_mov_b32 v16, s21
  s_barrier
  s_mov_b32 s46, s42
  s_cmp_gt_u32 s42, s45
  s_cbranch_scc1 vwr_249
  s_cmp_lt_u32 s45, 64
  s_cbranch_scc1 vwr_244
  v_mov_b32 v244, -1
  v_mov_b32 v245, -1
  v_mov_b32 v246, -1
  v_mov_b32 v247, -1
  v_lshlrev_b32 v21, 3, v1
  s_lshr_b32 s21, s2, 2
  s_lshl_b32 s21, s21, 2
  s_add_u32 s21, s21, s20
  s_lshl_b32 s21, s21, 2
  s_and_b32 s22, s2, 3
  s_add_u32 s21, s21, s22
  s_lshl_b32 s21, s21, 14
  s_xor_b32 s22, s21, s80
  s_xor_b32 s21, s22, 125833216
  buffer_store_dwordx4 v[244:247], v4, s[16:19], s21 offen offset:0 sc1
  buffer_store_dwordx4 v[244:247], v4, s[16:19], s21 offen offset:1024 sc1
  buffer_store_dwordx4 v[244:247], v4, s[16:19], s21 offen offset:2048 sc1
  buffer_store_dwordx4 v[244:247], v4, s[16:19], s21 offen offset:3072 sc1
  s_xor_b32 s21, s22, 127938560
  buffer_store_dwordx4 v[244:247], v4, s[16:19], s21 offen offset:0 sc1
  buffer_store_dwordx4 v[244:247], v4, s[16:19], s21 offen offset:1024 sc1
  buffer_store_dwordx4 v[244:247], v4, s[16:19], s21 offen offset:2048 sc1
  buffer_store_dwordx4 v[244:247], v4, s[16:19], s21 offen offset:3072 sc1
  s_xor_b32 s21, s22, 130027520
  buffer_store_dwordx4 v[244:247], v4, s[16:19], s21 offen offset:0 sc1
  buffer_store_dwordx4 v[244:247], v4, s[16:19], s21 offen offset:1024 sc1
  buffer_store_dwordx4 v[244:247], v4, s[16:19], s21 offen offset:2048 sc1
  buffer_store_dwordx4 v[244:247], v4, s[16:19], s21 offen offset:3072 sc1
  s_xor_b32 s21, s22, 132132864
  buffer_store_dwordx4 v[244:247], v4, s[16:19], s21 offen offset:0 sc1
  buffer_store_dwordx4 v[244:247], v4, s[16:19], s21 offen offset:1024 sc1
  buffer_store_dwordx4 v[244:247], v4, s[16:19], s21 offen offset:2048 sc1
  buffer_store_dwordx4 v[244:247], v4, s[16:19], s21 offen offset:3072 sc1
  s_and_b32 s21, s2, 3
  s_cmp_lg_u32 s21, s20
  s_cbranch_scc1 arm_251
  s_lshr_b32 s21, s2, 1
  s_lshl_b32 s21, s21, 14
  s_and_b32 s22, s2, 1
  s_mul_i32 s22, s22, 2560
  s_add_u32 s21, s21, s22
  s_xor_b32 s22, s21, s80
  s_xor_b32 s21, s22, 216006656
  buffer_store_dwordx4 v[244:247], v4, s[16:19], s21 offen sc1
  buffer_store_dwordx4 v[244:247], v4, s[16:19], s21 offen offset:1024 sc1
  buffer_store_dwordx2 v[244:245], v21, s[16:19], s21 offen offset:2048 sc1
  s_xor_b32 s21, s22, 216530944
  buffer_store_dwordx4 v[244:247], v4, s[16:19], s21 offen sc1
  buffer_store_dwordx4 v[244:247], v4, s[16:19], s21 offen offset:1024 sc1
  buffer_store_dwordx2 v[244:245], v21, s[16:19], s21 offen offset:2048 sc1
  s_xor_b32 s21, s22, 217055232
  buffer_store_dwordx4 v[244:247], v4, s[16:19], s21 offen sc1
  buffer_store_dwordx4 v[244:247], v4, s[16:19], s21 offen offset:1024 sc1
  buffer_store_dwordx2 v[244:245], v21, s[16:19], s21 offen offset:2048 sc1
  s_xor_b32 s21, s22, 217579520
  buffer_store_dwordx4 v[244:247], v4, s[16:19], s21 offen sc1
  buffer_store_dwordx4 v[244:247], v4, s[16:19], s21 offen offset:1024 sc1
  buffer_store_dwordx2 v[244:245], v21, s[16:19], s21 offen offset:2048 sc1
arm_251:
  v_mov_b32 v16, 64
  s_waitcnt vmcnt(0)
  buffer_store_dword v16, v17, s[72:75], s44 offen sc1
  s_branch queue
not_vw:
  s_sub_u32 s2, s3, 96
  s_cmp_lg_u32 s2, 31
  s_cbranch_scc1 not_cal
  s_load_dwordx2 s[72:73], s[0:1], 104
  s_waitcnt lgkmcnt(0)
  s_add_u32 s72, s72, 173080576
  s_addc_u32 s73, s73, 0
  s_mov_b32 s74, 49152
  s_mov_b32 s75, 0x00020000
  v_lshlrev_b32 v8, 4, v0
  v_mov_b32 v4, 0
  v_mov_b32 v5, 0
  v_mov_b32 v6, 0
  v_mov_b32 v7, 0
  s_mov_b32 s21, 0
  buffer_store_dwordx4 v[4:7], v8, s[72:75], s21 offen sc1
  s_mov_b32 s21, 4096
  buffer_store_dwordx4 v[4:7], v8, s[72:75], s21 offen sc1
  s_mov_b32 s21, 8192
  buffer_store_dwordx4 v[4:7], v8, s[72:75], s21 offen sc1
  s_mov_b32 s21, 12288
  buffer_store_dwordx4 v[4:7], v8, s[72:75], s21 offen sc1
  s_mov_b32 s21, 16384
  buffer_store_dwordx4 v[4:7], v8, s[72:75], s21 offen sc1
  s_mov_b32 s21, 20480
  buffer_store_dwordx4 v[4:7], v8, s[72:75], s21 offen sc1
  s_mov_b32 s21, 24576
  buffer_store_dwordx4 v[4:7], v8, s[72:75], s21 offen sc1
  s_mov_b32 s21, 28672
  buffer_store_dwordx4 v[4:7], v8, s[72:75], s21 offen sc1
  s_mov_b32 s21, 32768
  buffer_store_dwordx4 v[4:7], v8, s[72:75], s21 offen sc1
  s_mov_b32 s21, 36864
  buffer_store_dwordx4 v[4:7], v8, s[72:75], s21 offen sc1
  s_mov_b32 s21, 40960
  buffer_store_dwordx4 v[4:7], v8, s[72:75], s21 offen sc1
  s_mov_b32 s21, 45056
  buffer_store_dwordx4 v[4:7], v8, s[72:75], s21 offen sc1
  s_add_u32 s8, s38, 173015040
  s_addc_u32 s9, s39, 0
  s_mov_b32 s10, 131072
  s_mov_b32 s11, 0x00020000
  s_cmp_lg_u32 s20, 0
  s_cbranch_scc1 cal_252
  s_mov_b32 s40, -1
  s_mov_b32 s41, -1
  s_mov_b32 s43, 0
cal_253:
  s_mov_b32 s21, 0
  s_memtime s[98:99]
  s_waitcnt lgkmcnt(0)
  s_buffer_load_dword s22, s[8:11], s21 glc
  s_waitcnt lgkmcnt(0)
  s_memtime s[100:101]
  s_waitcnt lgkmcnt(0)
  s_sub_u32 s21, s100, s98
  s_min_u32 s40, s40, s21
  s_mov_b32 s21, 8192
  s_memtime s[98:99]
  s_waitcnt lgkmcnt(0)
  s_buffer_load_dword s22, s[8:11], s21 glc
  s_waitcnt lgkmcnt(0)
  s_memtime s[100:101]
  s_waitcnt lgkmcnt(0)
  s_sub_u32 s21, s100, s98
  s_min_u32 s41, s41, s21
  s_add_u32 s43, s43, 1
  s_cmp_lt_u32 s43, 6
  s_cbranch_scc1 cal_253
cal_252:
  s_waitcnt vmcnt(0)
  s_barrier
  s_cmp_lg_u32 s20, 0
  s_cbranch_scc1 cal_254
  s_cmp_lt_u32 s41, s40
  s_cselect_b32 s21, 1, 2
  v_mov_b32 v4, s21
  v_mov_b32 v5, s40
  v_mov_b32 v6, s41
  v_mov_b32 v8, 76
  s_mov_b64 exec, 1
  buffer_store_dwordx3 v[4:6], v8, s[32:35], 0 offen sc1
  s_mov_b64 exec, -1
cal_254:
not_cal:
  s_load_dwordx2 s[4:5], s[0:1], 0
  s_load_dwordx2 s[6:7], s[0:1], 64
  s_load_dwordx2 s[38:39], s[0:1], 104
  s_lshr_b32 s41, s2, 3
  s_lshl_b32 s41, s41, 1
  s_and_b32 s21, s2, 1
  s_add_u32 s41, s41, s21
  s_bfe_u32 s42, s2, 0x20001
  s_waitcnt lgkmcnt(0)
  s_mov_b32 s8, s4
  s_mov_b32 s9, s5
  s_mov_b32 s10, 2621440
  s_mov_b32 s11, 0x00020000
  s_mov_b32 s12, s6
  s_mov_b32 s13, s7
  s_mov_b32 s14, 2457600
  s_mov_b32 s15, 0x00020000
  s_mov_b32 s16, s38
  s_mov_b32 s17, s39
  s_mov_b32 s18, 218103808
  s_mov_b32 s19, 0x00020000
  s_add_u32 s72, s38, 173080576
  s_addc_u32 s73, s39, 0
  s_mov_b32 s74, 49152
  s_mov_b32 s75, 0x00020000
  v_lshrrev_b32 v8, 5, v1
  v_or_b32 v9, 0, v8
  v_and_b32 v10, 31, v1
  v_lshlrev_b32 v9, 1, v9
  v_xor_b32 v10, v10, v9
  v_mul_u32_u24 v9, 6554, v10
  v_lshrrev_b32 v9, 16, v9
  v_mul_u32_u24 v11, 1120, v9
  v_lshl_add_u32 v11, v10, 4, v11
  v_mul_u32_u24 v8, 3840, v8
  v_add_u32 v11, v11, v8
  v_mov_b32 v9, 1073741824
  v_cmp_gt_u32 vcc, 30, v10
  s_nop 1
  v_cndmask_b32 v4, v9, v11, vcc
  v_lshrrev_b32 v8, 5, v1
  v_or_b32 v9, 2, v8
  v_and_b32 v10, 31, v1
  v_lshlrev_b32 v9, 1, v9
  v_xor_b32 v10, v10, v9
  v_mul_u32_u24 v9, 6554, v10
  v_lshrrev_b32 v9, 16, v9
  v_mul_u32_u24 v11, 1120, v9
  v_lshl_add_u32 v11, v10, 4, v11
  v_mul_u32_u24 v8, 3840, v8
  v_add_u32 v11, v11, v8
  v_mov_b32 v9, 1073741824
  v_cmp_gt_u32 vcc, 30, v10
  s_nop 1
  v_cndmask_b32 v5, v9, v11, vcc
  v_lshrrev_b32 v8, 5, v1
  v_or_b32 v9, 4, v8
  v_and_b32 v10, 31, v1
  v_lshlrev_b32 v9, 1, v9
  v_xor_b32 v10, v10, v9
  v_mul_u32_u24 v9, 6554, v10
  v_lshrrev_b32 v9, 16, v9
  v_mul_u32_u24 v11, 1120, v9
  v_lshl_add_u32 v11, v10, 4, v11
  v_mul_u32_u24 v8, 3840, v8
  v_add_u32 v11, v11, v8
  v_mov_b32 v9, 1073741824
  v_cmp_gt_u32 vcc, 30, v10
  s_nop 1
  v_cndmask_b32 v6, v9, v11, vcc
  v_lshrrev_b32 v8, 5, v1
  v_or_b32 v9, 6, v8
  v_and_b32 v10, 31, v1
  v_lshlrev_b32 v9, 1, v9
  v_xor_b32 v10, v10, v9
  v_mul_u32_u24 v9, 6554, v10
  v_lshrrev_b32 v9, 16, v9
  v_mul_u32_u24 v11, 1120, v9
  v_lshl_add_u32 v11, v10, 4, v11
  v_mul_u32_u24 v8, 3840, v8
  v_add_u32 v11, v11, v8
  v_mov_b32 v9, 1073741824
  v_cmp_gt_u32 vcc, 30, v10
  s_nop 1
  v_cndmask_b32 v7, v9, v11, vcc
  s_mul_i32 s44, s41, 160
  s_mul_i32 s21, s20, 122880
  s_add_u32 s44, s44, s21
  s_lshl_b32 s45, s20, 14
  s_add_u32 s21, s44, 0
  s_add_u32 m0, s45, 0
  s_nop 0
  buffer_load_dwordx4 v4, s[12:15], s21 offen lds
  s_add_u32 s21, s44, 7680
  s_add_u32 m0, s45, 1024
  s_nop 0
  buffer_load_dwordx4 v5, s[12:15], s21 offen lds
  s_add_u32 s21, s44, 15360
  s_add_u32 m0, s45, 2048
  s_nop 0
  buffer_load_dwordx4 v4, s[12:15], s21 offen lds
  s_add_u32 s21, s44, 23040
  s_add_u32 m0, s45, 3072
  s_nop 0
  buffer_load_dwordx4 v5, s[12:15], s21 offen lds
  s_add_u32 s21, s44, 30720
  s_add_u32 m0, s45, 4096
  s_nop 0
  buffer_load_dwordx4 v6, s[12:15], s21 offen lds
  s_add_u32 s21, s44, 38400
  s_add_u32 m0, s45, 5120
  s_nop 0
  buffer_load_dwordx4 v7, s[12:15], s21 offen lds
  s_add_u32 s21, s44, 46080
  s_add_u32 m0, s45, 6144
  s_nop 0
  buffer_load_dwordx4 v6, s[12:15], s21 offen lds
  s_add_u32 s21, s44, 53760
  s_add_u32 m0, s45, 7168
  s_nop 0
  buffer_load_dwordx4 v7, s[12:15], s21 offen lds
  s_add_u32 s21, s44, 61440
  s_add_u32 m0, s45, 8192
  s_nop 0
  buffer_load_dwordx4 v4, s[12:15], s21 offen lds
  s_add_u32 s21, s44, 69120
  s_add_u32 m0, s45, 9216
  s_nop 0
  buffer_load_dwordx4 v5, s[12:15], s21 offen lds
  s_add_u32 s21, s44, 76800
  s_add_u32 m0, s45, 10240
  s_nop 0
  buffer_load_dwordx4 v4, s[12:15], s21 offen lds
  s_add_u32 s21, s44, 84480
  s_add_u32 m0, s45, 11264
  s_nop 0
  buffer_load_dwordx4 v5, s[12:15], s21 offen lds
  s_add_u32 s21, s44, 92160
  s_add_u32 m0, s45, 12288
  s_nop 0
  buffer_load_dwordx4 v6, s[12:15], s21 offen lds
  s_add_u32 s21, s44, 99840
  s_add_u32 m0, s45, 13312
  s_nop 0
  buffer_load_dwordx4 v7, s[12:15], s21 offen lds
  s_add_u32 s21, s44, 107520
  s_add_u32 m0, s45, 14336
  s_nop 0
  buffer_load_dwordx4 v6, s[12:15], s21 offen lds
  s_add_u32 s21, s44, 115200
  s_add_u32 m0, s45, 15360
  s_nop 0
  buffer_load_dwordx4 v7, s[12:15], s21 offen lds
  s_add_u32 s21, s44, 491520
  s_add_u32 m0, s45, 65536
  s_nop 0
  buffer_load_dwordx4 v4, s[12:15], s21 offen lds
  s_add_u32 s21, s44, 499200
  s_add_u32 m0, s45, 66560
  s_nop 0
  buffer_load_dwordx4 v5, s[12:15], s21 offen lds
  s_add_u32 s21, s44, 506880
  s_add_u32 m0, s45, 67584
  s_nop 0
  buffer_load_dwordx4 v4, s[12:15], s21 offen lds
  s_add_u32 s21, s44, 514560
  s_add_u32 m0, s45, 68608
  s_nop 0
  buffer_load_dwordx4 v5, s[12:15], s21 offen lds
  s_add_u32 s21, s44, 522240
  s_add_u32 m0, s45, 69632
  s_nop 0
  buffer_load_dwordx4 v6, s[12:15], s21 offen lds
  s_add_u32 s21, s44, 529920
  s_add_u32 m0, s45, 70656
  s_nop 0
  buffer_load_dwordx4 v7, s[12:15], s21 offen lds
  s_add_u32 s21, s44, 537600
  s_add_u32 m0, s45, 71680
  s_nop 0
  buffer_load_dwordx4 v6, s[12:15], s21 offen lds
  s_add_u32 s21, s44, 545280
  s_add_u32 m0, s45, 72704
  s_nop 0
  buffer_load_dwordx4 v7, s[12:15], s21 offen lds
  s_add_u32 s21, s44, 552960
  s_add_u32 m0, s45, 73728
  s_nop 0
  buffer_load_dwordx4 v4, s[12:15], s21 offen lds
  s_add_u32 s21, s44, 560640
  s_add_u32 m0, s45, 74752
  s_nop 0
  buffer_load_dwordx4 v5, s[12:15], s21 offen lds
  s_add_u32 s21, s44, 568320
  s_add_u32 m0, s45, 75776
  s_nop 0
  buffer_load_dwordx4 v4, s[12:15], s21 offen lds
  s_add_u32 s21, s44, 576000
  s_add_u32 m0, s45, 76800
  s_nop 0
  buffer_load_dwordx4 v5, s[12:15], s21 offen lds
  s_add_u32 s21, s44, 583680
  s_add_u32 m0, s45, 77824
  s_nop 0
  buffer_load_dwordx4 v6, s[12:15], s21 offen lds
  s_add_u32 s21, s44, 591360
  s_add_u32 m0, s45, 78848
  s_nop 0
  buffer_load_dwordx4 v7, s[12:15], s21 offen lds
  s_add_u32 s21, s44, 599040
  s_add_u32 m0, s45, 79872
  s_nop 0
  buffer_load_dwordx4 v6, s[12:15], s21 offen lds
  s_add_u32 s21, s44, 606720
  s_add_u32 m0, s45, 80896
  s_nop 0
  buffer_load_dwordx4 v7, s[12:15], s21 offen lds
  s_add_u32 s21, s44, 983040
  buffer_load_dwordx4 v[64:67], v4, s[12:15], s21 offen
  s_add_u32 s21, s44, 990720
  buffer_load_dwordx4 v[68:71], v5, s[12:15], s21 offen
  s_add_u32 s21, s44, 998400
  buffer_load_dwordx4 v[72:75], v4, s[12:15], s21 offen
  s_add_u32 s21, s44, 1006080
  buffer_load_dwordx4 v[76:79], v5, s[12:15], s21 offen
  s_add_u32 s21, s44, 1013760
  buffer_load_dwordx4 v[80:83], v6, s[12:15], s21 offen
  s_add_u32 s21, s44, 1021440
  buffer_load_dwordx4 v[84:87], v7, s[12:15], s21 offen
  s_add_u32 s21, s44, 1029120
  buffer_load_dwordx4 v[88:91], v6, s[12:15], s21 offen
  s_add_u32 s21, s44, 1036800
  buffer_load_dwordx4 v[92:95], v7, s[12:15], s21 offen
  s_add_u32 s21, s44, 1044480
  buffer_load_dwordx4 v[96:99], v4, s[12:15], s21 offen
  s_add_u32 s21, s44, 1052160
  buffer_load_dwordx4 v[100:103], v5, s[12:15], s21 offen
  s_add_u32 s21, s44, 1059840
  buffer_load_dwordx4 v[104:107], v4, s[12:15], s21 offen
  s_add_u32 s21, s44, 1067520
  buffer_load_dwordx4 v[108:111], v5, s[12:15], s21 offen
  s_add_u32 s21, s44, 1075200
  buffer_load_dwordx4 v[112:115], v6, s[12:15], s21 offen
  s_add_u32 s21, s44, 1082880
  buffer_load_dwordx4 v[116:119], v7, s[12:15], s21 offen
  s_add_u32 s21, s44, 1090560
  buffer_load_dwordx4 v[120:123], v6, s[12:15], s21 offen
  s_add_u32 s21, s44, 1098240
  buffer_load_dwordx4 v[124:127], v7, s[12:15], s21 offen
  v_lshrrev_b32 v8, 2, v2
  v_and_b32 v9, 1, v3
  v_lshl_add_u32 v9, v9, 2, v8
  v_lshlrev_b32 v9, 5, v9
  v_lshl_add_u32 v8, v3, 3, v8
  v_lshlrev_b32 v8, 9, v8
  v_and_b32 v10, 3, v2
  s_mul_i32 s21, s20, 40
  v_lshl_add_u32 v11, v10, 3, s21
  v_add_u32 v11, 0, v11
  v_xor_b32 v11, v11, v9
  v_add_u32 v12, v11, v8
  v_add_u32 v16, 65536, v12
  v_lshl_add_u32 v11, v10, 3, s21
  v_add_u32 v11, 160, v11
  v_xor_b32 v11, v11, v9
  v_add_u32 v13, v11, v8
  v_add_u32 v17, 65536, v13
  v_mul_u32_u24 v11, 160, v10
  v_add3_u32 v11, v11, 32, s21
  v_min_u32 v11, 480, v11
  v_xor_b32 v11, v11, v9
  v_add_u32 v14, v11, v8
  v_add_u32 v18, 65536, v14
  v_lshl_add_u32 v11, v10, 3, s21
  v_add_u32 v11, 320, v11
  v_xor_b32 v11, v11, v9
  v_add_u32 v15, v11, v8
  v_add_u32 v19, 65536, v15
  v_lshl_add_u32 v23, v1, 4, s45
  v_add_u32 v29, 65536, v23
  s_waitcnt vmcnt(32)
  s_add_u32 s21, s44, 1474560
  buffer_load_dwordx4 v[128:131], v4, s[12:15], s21 offen
  s_add_u32 s21, s44, 1482240
  buffer_load_dwordx4 v[132:135], v5, s[12:15], s21 offen
  s_add_u32 s21, s44, 1489920
  buffer_load_dwordx4 v[136:139], v4, s[12:15], s21 offen
  s_add_u32 s21, s44, 1497600
  buffer_load_dwordx4 v[140:143], v5, s[12:15], s21 offen
  s_add_u32 s21, s44, 1505280
  buffer_load_dwordx4 v[144:147], v6, s[12:15], s21 offen
  s_add_u32 s21, s44, 1512960
  buffer_load_dwordx4 v[148:151], v7, s[12:15], s21 offen
  s_add_u32 s21, s44, 1520640
  buffer_load_dwordx4 v[152:155], v6, s[12:15], s21 offen
  s_add_u32 s21, s44, 1528320
  buffer_load_dwordx4 v[156:159], v7, s[12:15], s21 offen
  s_add_u32 s21, s44, 1536000
  buffer_load_dwordx4 v[160:163], v4, s[12:15], s21 offen
  s_add_u32 s21, s44, 1543680
  buffer_load_dwordx4 v[164:167], v5, s[12:15], s21 offen
  s_add_u32 s21, s44, 1551360
  buffer_load_dwordx4 v[168:171], v4, s[12:15], s21 offen
  s_add_u32 s21, s44, 1559040
  buffer_load_dwordx4 v[172:175], v5, s[12:15], s21 offen
  s_add_u32 s21, s44, 1566720
  buffer_load_dwordx4 v[176:179], v6, s[12:15], s21 offen
  s_add_u32 s21, s44, 1574400
  buffer_load_dwordx4 v[180:183], v7, s[12:15], s21 offen
  s_add_u32 s21, s44, 1582080
  buffer_load_dwordx4 v[184:187], v6, s[12:15], s21 offen
  s_add_u32 s21, s44, 1589760
  buffer_load_dwordx4 v[188:191], v7, s[12:15], s21 offen
  s_barrier
  ds_read_b64_tr_b16 a[0:1], v12 offset:0
  ds_read_b64_tr_b16 a[2:3], v12 offset:2048
  ds_read_b64_tr_b16 a[4:5], v13 offset:0
  ds_read_b64_tr_b16 a[6:7], v13 offset:2048
  ds_read_b64_tr_b16 a[8:9], v14 offset:0
  ds_read_b64_tr_b16 a[10:11], v14 offset:2048
  ds_read_b64_tr_b16 a[12:13], v15 offset:0
  ds_read_b64_tr_b16 a[14:15], v15 offset:2048
  ds_read_b64_tr_b16 a[16:17], v12 offset:16384
  ds_read_b64_tr_b16 a[18:19], v12 offset:18432
  ds_read_b64_tr_b16 a[20:21], v13 offset:16384
  ds_read_b64_tr_b16 a[22:23], v13 offset:18432
  ds_read_b64_tr_b16 a[24:25], v14 offset:16384
  ds_read_b64_tr_b16 a[26:27], v14 offset:18432
  ds_read_b64_tr_b16 a[28:29], v15 offset:16384
  ds_read_b64_tr_b16 a[30:31], v15 offset:18432
  ds_read_b64_tr_b16 a[32:33], v12 offset:32768
  ds_read_b64_tr_b16 a[34:35], v12 offset:34816
  ds_read_b64_tr_b16 a[36:37], v13 offset:32768
  ds_read_b64_tr_b16 a[38:39], v13 offset:34816
  ds_read_b64_tr_b16 a[40:41], v14 offset:32768
  ds_read_b64_tr_b16 a[42:43], v14 offset:34816
  ds_read_b64_tr_b16 a[44:45], v15 offset:32768
  ds_read_b64_tr_b16 a[46:47], v15 offset:34816
  ds_read_b64_tr_b16 a[48:49], v12 offset:49152
  ds_read_b64_tr_b16 a[50:51], v12 offset:51200
  ds_read_b64_tr_b16 a[52:53], v13 offset:49152
  ds_read_b64_tr_b16 a[54:55], v13 offset:51200
  ds_read_b64_tr_b16 a[56:57], v14 offset:49152
  ds_read_b64_tr_b16 a[58:59], v14 offset:51200
  ds_read_b64_tr_b16 a[60:61], v15 offset:49152
  ds_read_b64_tr_b16 a[62:63], v15 offset:51200
  s_waitcnt lgkmcnt(0)
  s_barrier
  s_waitcnt vmcnt(32)
  s_add_u32 s21, s44, 1966080
  buffer_load_dwordx4 v[192:195], v4, s[12:15], s21 offen
  s_add_u32 s21, s44, 1973760
  buffer_load_dwordx4 v[196:199], v5, s[12:15], s21 offen
  s_add_u32 s21, s44, 1981440
  buffer_load_dwordx4 v[200:203], v4, s[12:15], s21 offen
  s_add_u32 s21, s44, 1989120
  buffer_load_dwordx4 v[204:207], v5, s[12:15], s21 offen
  s_add_u32 s21, s44, 1996800
  buffer_load_dwordx4 v[208:211], v6, s[12:15], s21 offen
  s_add_u32 s21, s44, 2004480
  buffer_load_dwordx4 v[212:215], v7, s[12:15], s21 offen
  s_add_u32 s21, s44, 2012160
  buffer_load_dwordx4 v[216:219], v6, s[12:15], s21 offen
  s_add_u32 s21, s44, 2019840
  buffer_load_dwordx4 v[220:223], v7, s[12:15], s21 offen
  s_add_u32 s21, s44, 2027520
  buffer_load_dwordx4 v[224:227], v4, s[12:15], s21 offen
  s_add_u32 s21, s44, 2035200
  buffer_load_dwordx4 v[228:231], v5, s[12:15], s21 offen
  s_add_u32 s21, s44, 2042880
  buffer_load_dwordx4 v[232:235], v4, s[12:15], s21 offen
  s_add_u32 s21, s44, 2050560
  buffer_load_dwordx4 v[236:239], v5, s[12:15], s21 offen
  s_add_u32 s21, s44, 2058240
  buffer_load_dwordx4 v[240:243], v6, s[12:15], s21 offen
  s_add_u32 s21, s44, 2065920
  buffer_load_dwordx4 v[244:247], v7, s[12:15], s21 offen
  s_add_u32 s21, s44, 2073600
  buffer_load_dwordx4 v[248:251], v6, s[12:15], s21 offen
  s_add_u32 s21, s44, 2081280
  buffer_load_dwordx4 v[252:255], v7, s[12:15], s21 offen
  s_barrier
  ds_read_b64_tr_b16 a[64:65], v16 offset:0
  ds_read_b64_tr_b16 a[66:67], v16 offset:2048
  ds_read_b64_tr_b16 a[68:69], v17 offset:0
  ds_read_b64_tr_b16 a[70:71], v17 offset:2048
  ds_read_b64_tr_b16 a[72:73], v18 offset:0
  ds_read_b64_tr_b16 a[74:75], v18 offset:2048
  ds_read_b64_tr_b16 a[76:77], v19 offset:0
  ds_read_b64_tr_b16 a[78:79], v19 offset:2048
  ds_read_b64_tr_b16 a[80:81], v16 offset:16384
  ds_read_b64_tr_b16 a[82:83], v16 offset:18432
  ds_read_b64_tr_b16 a[84:85], v17 offset:16384
  ds_read_b64_tr_b16 a[86:87], v17 offset:18432
  ds_read_b64_tr_b16 a[88:89], v18 offset:16384
  ds_read_b64_tr_b16 a[90:91], v18 offset:18432
  ds_read_b64_tr_b16 a[92:93], v19 offset:16384
  ds_read_b64_tr_b16 a[94:95], v19 offset:18432
  ds_read_b64_tr_b16 a[96:97], v16 offset:32768
  ds_read_b64_tr_b16 a[98:99], v16 offset:34816
  ds_read_b64_tr_b16 a[100:101], v17 offset:32768
  ds_read_b64_tr_b16 a[102:103], v17 offset:34816
  ds_read_b64_tr_b16 a[104:105], v18 offset:32768
  ds_read_b64_tr_b16 a[106:107], v18 offset:34816
  ds_read_b64_tr_b16 a[108:109], v19 offset:32768
  ds_read_b64_tr_b16 a[110:111], v19 offset:34816
  ds_read_b64_tr_b16 a[112:113], v16 offset:49152
  ds_read_b64_tr_b16 a[114:115], v16 offset:51200
  ds_read_b64_tr_b16 a[116:117], v17 offset:49152
  ds_read_b64_tr_b16 a[118:119], v17 offset:51200
  ds_read_b64_tr_b16 a[120:121], v18 offset:49152
  ds_read_b64_tr_b16 a[122:123], v18 offset:51200
  ds_read_b64_tr_b16 a[124:125], v19 offset:49152
  ds_read_b64_tr_b16 a[126:127], v19 offset:51200
  s_waitcnt lgkmcnt(0)
  s_barrier
  s_waitcnt vmcnt(32)
  v_lshlrev_b32 v30, 4, v1
  s_load_dwordx2 s[36:37], s[0:1], 16
  s_lshl_b32 s23, s2, 2
  s_add_u32 s23, s23, s20
  s_mul_i32 s23, s23, 61440
  s_add_u32 s23, s23, 30720
  s_waitcnt lgkmcnt(0)
  s_mov_b32 s24, s36
  s_mov_b32 s25, s37
  s_mov_b32 s26, 7864320
  s_mov_b32 s27, 0x00020000
  buffer_load_dwordx4 v[32:35], v30, s[24:27], s23 offen offset:0
  buffer_load_dwordx4 v[32:35], v30, s[24:27], s23 offen offset:1024
  buffer_load_dwordx4 v[32:35], v30, s[24:27], s23 offen offset:2048
  buffer_load_dwordx4 v[32:35], v30, s[24:27], s23 offen offset:3072
  s_add_u32 s23, s23, 4096
  buffer_load_dwordx4 v[32:35], v30, s[24:27], s23 offen offset:0
  buffer_load_dwordx4 v[32:35], v30, s[24:27], s23 offen offset:1024
  buffer_load_dwordx4 v[32:35], v30, s[24:27], s23 offen offset:2048
  buffer_load_dwordx4 v[32:35], v30, s[24:27], s23 offen offset:3072
  s_add_u32 s23, s23, 4096
  buffer_load_dwordx4 v[32:35], v30, s[24:27], s23 offen offset:0
  buffer_load_dwordx4 v[32:35], v30, s[24:27], s23 offen offset:1024
  buffer_load_dwordx4 v[32:35], v30, s[24:27], s23 offen offset:2048
  buffer_load_dwordx4 v[32:35], v30, s[24:27], s23 offen offset:3072
  s_add_u32 s23, s23, 4096
  buffer_load_dwordx4 v[32:35], v30, s[24:27], s23 offen offset:0
  buffer_load_dwordx4 v[32:35], v30, s[24:27], s23 offen offset:1024
  buffer_load_dwordx4 v[32:35], v30, s[24:27], s23 offen offset:2048
  buffer_load_dwordx4 v[32:35], v30, s[24:27], s23 offen offset:3072
  s_add_u32 s23, s23, 4096
  buffer_load_dwordx4 v[32:35], v30, s[24:27], s23 offen offset:0
  buffer_load_dwordx4 v[32:35], v30, s[24:27], s23 offen offset:1024
  buffer_load_dwordx4 v[32:35], v30, s[24:27], s23 offen offset:2048
  buffer_load_dwordx4 v[32:35], v30, s[24:27], s23 offen offset:3072
  s_add_u32 s23, s23, 4096
  buffer_load_dwordx4 v[32:35], v30, s[24:27], s23 offen offset:0
  buffer_load_dwordx4 v[32:35], v30, s[24:27], s23 offen offset:1024
  buffer_load_dwordx4 v[32:35], v30, s[24:27], s23 offen offset:2048
  buffer_load_dwordx4 v[32:35], v30, s[24:27], s23 offen offset:3072
  s_add_u32 s23, s23, 4096
  buffer_load_dwordx4 v[32:35], v30, s[24:27], s23 offen offset:0
  buffer_load_dwordx4 v[32:35], v30, s[24:27], s23 offen offset:1024
  buffer_load_dwordx4 v[32:35], v30, s[24:27], s23 offen offset:2048
  buffer_load_dwordx4 v[32:35], v30, s[24:27], s23 offen offset:3072
  s_add_u32 s23, s23, 4096
  buffer_load_dwordx4 v[32:35], v30, s[24:27], s23 offen offset:0
  buffer_load_dwordx4 v[32:35], v30, s[24:27], s23 offen offset:1024
  ds_write_b128 v23, v[64:67] offset:0
  ds_write_b128 v23, v[68:71] offset:1024
  ds_write_b128 v23, v[72:75] offset:2048
  ds_write_b128 v23, v[76:79] offset:3072
  ds_write_b128 v23, v[80:83] offset:4096
  ds_write_b128 v23, v[84:87] offset:5120
  ds_write_b128 v23, v[88:91] offset:6144
  ds_write_b128 v23, v[92:95] offset:7168
  ds_write_b128 v23, v[96:99] offset:8192
  ds_write_b128 v23, v[100:103] offset:9216
  ds_write_b128 v23, v[104:107] offset:10240
  ds_write_b128 v23, v[108:111] offset:11264
  ds_write_b128 v23, v[112:115] offset:12288
  ds_write_b128 v23, v[116:119] offset:13312
  ds_write_b128 v23, v[120:123] offset:14336
  ds_write_b128 v23, v[124:127] offset:15360
  s_waitcnt lgkmcnt(0)
  s_barrier
  ds_read_b64_tr_b16 a[128:129], v12 offset:0
  ds_read_b64_tr_b16 a[130:131], v12 offset:2048
  ds_read_b64_tr_b16 a[132:133], v13 offset:0
  ds_read_b64_tr_b16 a[134:135], v13 offset:2048
  ds_read_b64_tr_b16 a[136:137], v14 offset:0
  ds_read_b64_tr_b16 a[138:139], v14 offset:2048
  ds_read_b64_tr_b16 a[140:141], v15 offset:0
  ds_read_b64_tr_b16 a[142:143], v15 offset:2048
  ds_read_b64_tr_b16 a[144:145], v12 offset:16384
  ds_read_b64_tr_b16 a[146:147], v12 offset:18432
  ds_read_b64_tr_b16 a[148:149], v13 offset:16384
  ds_read_b64_tr_b16 a[150:151], v13 offset:18432
  ds_read_b64_tr_b16 a[152:153], v14 offset:16384
  ds_read_b64_tr_b16 a[154:155], v14 offset:18432
  ds_read_b64_tr_b16 a[156:157], v15 offset:16384
  ds_read_b64_tr_b16 a[158:159], v15 offset:18432
  ds_read_b64_tr_b16 a[160:161], v12 offset:32768
  ds_read_b64_tr_b16 a[162:163], v12 offset:34816
  ds_read_b64_tr_b16 a[164:165], v13 offset:32768
  ds_read_b64_tr_b16 a[166:167], v13 offset:34816
  ds_read_b64_tr_b16 a[168:169], v14 offset:32768
  ds_read_b64_tr_b16 a[170:171], v14 offset:34816
  ds_read_b64_tr_b16 a[172:173], v15 offset:32768
  ds_read_b64_tr_b16 a[174:175], v15 offset:34816
  ds_read_b64_tr_b16 a[176:177], v12 offset:49152
  ds_read_b64_tr_b16 a[178:179], v12 offset:51200
  ds_read_b64_tr_b16 a[180:181], v13 offset:49152
  ds_read_b64_tr_b16 a[182:183], v13 offset:51200
  ds_read_b64_tr_b16 a[184:185], v14 offset:49152
  ds_read_b64_tr_b16 a[186:187], v14 offset:51200
  ds_read_b64_tr_b16 a[188:189], v15 offset:49152
  ds_read_b64_tr_b16 a[190:191], v15 offset:51200
  s_waitcnt lgkmcnt(0)
  s_barrier
  s_waitcnt vmcnt(46)
  ds_write_b128 v29, v[128:131] offset:0
  ds_write_b128 v29, v[132:135] offset:1024
  ds_write_b128 v29, v[136:139] offset:2048
  ds_write_b128 v29, v[140:143] offset:3072
  ds_write_b128 v29, v[144:147] offset:4096
  ds_write_b128 v29, v[148:151] offset:5120
  ds_write_b128 v29, v[152:155] offset:6144
  ds_write_b128 v29, v[156:159] offset:7168
  ds_write_b128 v29, v[160:163] offset:8192
  ds_write_b128 v29, v[164:167] offset:9216
  ds_write_b128 v29, v[168:171] offset:10240
  ds_write_b128 v29, v[172:175] offset:11264
  ds_write_b128 v29, v[176:179] offset:12288
  ds_write_b128 v29, v[180:183] offset:13312
  ds_write_b128 v29, v[184:187] offset:14336
  ds_write_b128 v29, v[188:191] offset:15360
  s_waitcnt lgkmcnt(0)
  s_barrier
  ds_read_b64_tr_b16 a[192:193], v16 offset:0
  ds_read_b64_tr_b16 a[194:195], v16 offset:2048
  ds_read_b64_tr_b16 a[196:197], v17 offset:0
  ds_read_b64_tr_b16 a[198:199], v17 offset:2048
  ds_read_b64_tr_b16 a[200:201], v18 offset:0
  ds_read_b64_tr_b16 a[202:203], v18 offset:2048
  ds_read_b64_tr_b16 a[204:205], v19 offset:0
  ds_read_b64_tr_b16 a[206:207], v19 offset:2048
  ds_read_b64_tr_b16 a[208:209], v16 offset:16384
  ds_read_b64_tr_b16 a[210:211], v16 offset:18432
  ds_read_b64_tr_b16 a[212:213], v17 offset:16384
  ds_read_b64_tr_b16 a[214:215], v17 offset:18432
  ds_read_b64_tr_b16 a[216:217], v18 offset:16384
  ds_read_b64_tr_b16 a[218:219], v18 offset:18432
  ds_read_b64_tr_b16 a[220:221], v19 offset:16384
  ds_read_b64_tr_b16 a[222:223], v19 offset:18432
  ds_read_b64_tr_b16 a[224:225], v16 offset:32768
  ds_read_b64_tr_b16 a[226:227], v16 offset:34816
  ds_read_b64_tr_b16 a[228:229], v17 offset:32768
  ds_read_b64_tr_b16 a[230:231], v17 offset:34816
  ds_read_b64_tr_b16 a[232:233], v18 offset:32768
  ds_read_b64_tr_b16 a[234:235], v18 offset:34816
  ds_read_b64_tr_b16 a[236:237], v19 offset:32768
  ds_read_b64_tr_b16 a[238:239], v19 offset:34816
  ds_read_b64_tr_b16 a[240:241], v16 offset:49152
  ds_read_b64_tr_b16 a[242:243], v16 offset:51200
  ds_read_b64_tr_b16 a[244:245], v17 offset:49152
  ds_read_b64_tr_b16 a[246:247], v17 offset:51200
  ds_read_b64_tr_b16 a[248:249], v18 offset:49152
  ds_read_b64_tr_b16 a[250:251], v18 offset:51200
  ds_read_b64_tr_b16 a[252:253], v19 offset:49152
  ds_read_b64_tr_b16 a[254:255], v19 offset:51200
  s_waitcnt lgkmcnt(0)
  s_barrier
  s_waitcnt vmcnt(30)
  ds_write_b128 v23, v[192:195] offset:0
  ds_write_b128 v23, v[196:199] offset:1024
  ds_write_b128 v23, v[200:203] offset:2048
  ds_write_b128 v23, v[204:207] offset:3072
  ds_write_b128 v23, v[208:211] offset:4096
  ds_write_b128 v23, v[212:215] offset:5120
  ds_write_b128 v23, v[216:219] offset:6144
  ds_write_b128 v23, v[220:223] offset:7168
  ds_write_b128 v23, v[224:227] offset:8192
  ds_write_b128 v23, v[228:231] offset:9216
  ds_write_b128 v23, v[232:235] offset:10240
  ds_write_b128 v23, v[236:239] offset:11264
  ds_write_b128 v23, v[240:243] offset:12288
  ds_write_b128 v23, v[244:247] offset:13312
  ds_write_b128 v23, v[248:251] offset:14336
  ds_write_b128 v23, v[252:255] offset:15360
  s_waitcnt lgkmcnt(0)
  s_barrier
  ds_read_b64_tr_b16 v[192:193], v12 offset:0
  ds_read_b64_tr_b16 v[194:195], v12 offset:2048
  ds_read_b64_tr_b16 v[196:197], v13 offset:0
  ds_read_b64_tr_b16 v[198:199], v13 offset:2048
  ds_read_b64_tr_b16 v[200:201], v14 offset:0
  ds_read_b64_tr_b16 v[202:203], v14 offset:2048
  ds_read_b64_tr_b16 v[204:205], v15 offset:0
  ds_read_b64_tr_b16 v[206:207], v15 offset:2048
  ds_read_b64_tr_b16 v[208:209], v12 offset:16384
  ds_read_b64_tr_b16 v[210:211], v12 offset:18432
  ds_read_b64_tr_b16 v[212:213], v13 offset:16384
  ds_read_b64_tr_b16 v[214:215], v13 offset:18432
  ds_read_b64_tr_b16 v[216:217], v14 offset:16384
  ds_read_b64_tr_b16 v[218:219], v14 offset:18432
  ds_read_b64_tr_b16 v[220:221], v15 offset:16384
  ds_read_b64_tr_b16 v[222:223], v15 offset:18432
  ds_read_b64_tr_b16 v[224:225], v12 offset:32768
  ds_read_b64_tr_b16 v[226:227], v12 offset:34816
  ds_read_b64_tr_b16 v[228:229], v13 offset:32768
  ds_read_b64_tr_b16 v[230:231], v13 offset:34816
  ds_read_b64_tr_b16 v[232:233], v14 offset:32768
  ds_read_b64_tr_b16 v[234:235], v14 offset:34816
  ds_read_b64_tr_b16 v[236:237], v15 offset:32768
  ds_read_b64_tr_b16 v[238:239], v15 offset:34816
  ds_read_b64_tr_b16 v[240:241], v12 offset:49152
  ds_read_b64_tr_b16 v[242:243], v12 offset:51200
  ds_read_b64_tr_b16 v[244:245], v13 offset:49152
  ds_read_b64_tr_b16 v[246:247], v13 offset:51200
  ds_read_b64_tr_b16 v[248:249], v14 offset:49152
  ds_read_b64_tr_b16 v[250:251], v14 offset:51200
  ds_read_b64_tr_b16 v[252:253], v15 offset:49152
  ds_read_b64_tr_b16 v[254:255], v15 offset:51200
  s_waitcnt lgkmcnt(0)
  s_barrier
  s_load_dwordx2 s[32:33], s[0:1], 96
  s_waitcnt lgkmcnt(0)
  s_mov_b32 s32, s32
  s_mov_b32 s33, s33
  s_mov_b32 s34, 256
  s_mov_b32 s35, 0x00020000
  s_mov_b32 s21, 76
  v_mov_b32 v4, 0
  s_mov_b32 s101, 0
wf_255:
  buffer_load_dword v5, v4, s[32:35], s21 offen sc1
  s_add_u32 s101, s101, 1
  s_cmp_gt_u32 s101, 131072
  s_cbranch_scc1 main_end
  s_waitcnt vmcnt(0)
  v_readfirstlane_b32 s100, v5
  s_cmp_ge_u32 s100, 1
  s_cbranch_scc1 wf_256
  s_sleep 8
  s_branch wf_255
wf_256:
  s_sub_u32 s80, s100, 1
  s_lshl_b32 s80, s80, 13
  v_lshrrev_b32 v8, 3, v1
  v_and_b32 v9, 7, v1
  v_xor_b32 v9, v9, v8
  s_and_b32 s21, s20, 1
  s_lshl_b32 s21, s21, 4
  s_lshr_b32 s22, s20, 1
  s_add_u32 s21, s21, s22
  v_lshl_add_u32 v8, v8, 1, s21
  v_mul_u32_u24 v8, 1280, v8
  v_lshl_add_u32 v4, v9, 4, v8
  s_lshl_b32 s31, s20, 10
  s_mul_i32 s30, s42, 655360
  s_sub_u32 s46, s30, 40960
  s_cmp_eq_u32 s42, 0
  s_cselect_b32 s46, 1073741824, s46
  s_add_u32 m0, s31, 0
  s_nop 0
  buffer_load_dwordx4 v4, s[8:11], s46 offen offset:0 lds
  s_add_u32 m0, s31, 3968
  s_nop 0
  buffer_load_dwordx4 v4, s[8:11], s46 offen offset:128 lds
  s_add_u32 m0, s31, 7936
  s_nop 0
  buffer_load_dwordx4 v4, s[8:11], s46 offen offset:256 lds
  s_add_u32 m0, s31, 11904
  s_nop 0
  buffer_load_dwordx4 v4, s[8:11], s46 offen offset:384 lds
  s_add_u32 m0, s31, 15872
  s_nop 0
  buffer_load_dwordx4 v4, s[8:11], s46 offen offset:512 lds
  s_add_u32 m0, s31, 19840
  s_nop 0
  buffer_load_dwordx4 v4, s[8:11], s46 offen offset:640 lds
  s_add_u32 m0, s31, 23808
  s_nop 0
  buffer_load_dwordx4 v4, s[8:11], s46 offen offset:768 lds
  s_add_u32 m0, s31, 27776
  s_nop 0
  buffer_load_dwordx4 v4, s[8:11], s46 offen offset:896 lds
  s_add_u32 m0, s31, 31744
  s_nop 0
  buffer_load_dwordx4 v4, s[8:11], s46 offen offset:1024 lds
  s_add_u32 m0, s31, 35712
  s_nop 0
  buffer_load_dwordx4 v4, s[8:11], s46 offen offset:1152 lds
  s_add_u32 s31, s31, 40960
  s_add_u32 m0, s31, 0
  s_nop 0
  buffer_load_dwordx4 v4, s[8:11], s30 offen offset:0 lds
  s_add_u32 m0, s31, 3968
  s_nop 0
  buffer_load_dwordx4 v4, s[8:11], s30 offen offset:128 lds
  s_add_u32 m0, s31, 7936
  s_nop 0
  buffer_load_dwordx4 v4, s[8:11], s30 offen offset:256 lds
  s_add_u32 m0, s31, 11904
  s_nop 0
  buffer_load_dwordx4 v4, s[8:11], s30 offen offset:384 lds
  s_add_u32 m0, s31, 15872
  s_nop 0
  buffer_load_dwordx4 v4, s[8:11], s30 offen offset:512 lds
  s_add_u32 m0, s31, 19840
  s_nop 0
  buffer_load_dwordx4 v4, s[8:11], s30 offen offset:640 lds
  s_add_u32 m0, s31, 23808
  s_nop 0
  buffer_load_dwordx4 v4, s[8:11], s30 offen offset:768 lds
  s_add_u32 m0, s31, 27776
  s_nop 0
  buffer_load_dwordx4 v4, s[8:11], s30 offen offset:896 lds
  s_add_u32 m0, s31, 31744
  s_nop 0
  buffer_load_dwordx4 v4, s[8:11], s30 offen offset:1024 lds
  s_add_u32 m0, s31, 35712
  s_nop 0
  buffer_load_dwordx4 v4, s[8:11], s30 offen offset:1152 lds
  s_add_u32 s31, s31, 40960
  s_add_u32 s30, s30, 40960
  v_and_b32 v10, 7, v2
  v_add_u32 v8, 0, v3
  v_xor_b32 v8, v8, v10
  v_lshlrev_b32 v8, 4, v8
  v_lshl_add_u32 v5, v2, 7, v8
  v_add_u32 v8, 4, v3
  v_xor_b32 v8, v8, v10
  v_lshlrev_b32 v8, 4, v8
  v_lshl_add_u32 v6, v2, 7, v8
  v_mov_b32 v7, v5
  v_mov_b32 v8, v6
  s_mov_b32 s33, 0
  v_lshlrev_b32 v15, 4, v1
  v_mov_b32 v16, 0xf149f2ca
  v_lshrrev_b32 v17, 3, v2
  v_mul_u32_u24 v17, 2560, v17
  v_lshlrev_b32 v18, 1, v10
  s_lshr_b32 s21, s20, 1
  s_lshl_b32 s21, s21, 10
  s_and_b32 s22, s20, 1
  s_lshl_b32 s22, s22, 3
  s_add_u32 s21, s21, s22
  s_add_u32 s21, s21, 131072
  v_lshl_add_u32 v9, v3, 4, v18
  v_lshl_add_u32 v9, v9, 4, v17
  v_add_u32 v9, s21, v9
  s_lshl_b32 s21, s20, 7
  s_add_u32 s21, s21, 133120
  v_lshl_add_u32 v10, v18, 3, v17
  v_add_u32 v10, s21, v10
  v_cmp_eq_u32 vcc, 2, v3
  v_lshlrev_b32 v19, 4, v1
  v_add_u32 v19, 136192, v19
  v_cndmask_b32 v10, v19, v10, vcc
  s_lshr_b32 s21, s20, 1
  s_and_b32 s22, s20, 1
  s_mul_i32 s23, s21, 2560
  s_lshl_b32 s47, s22, 10
  s_add_u32 s47, s47, s23
  s_add_u32 s47, s47, 131072
  v_add_u32 v11, s47, v15
  s_lshl_b32 s47, s22, 8
  s_add_u32 s47, s47, s23
  s_add_u32 s47, s47, 133120
  v_add_u32 v12, s47, v15
  s_mul_i32 s23, s22, 768
  s_sub_u32 s23, 2048, s23
  v_add_u32 v14, s23, v15
  v_mov_b32 v19, 1073741824
  v_cmp_gt_u32 vcc, 16, v1
  s_lshl_b32 s47, s42, 23
  s_lshl_b32 s21, s21, 14
  v_cndmask_b32 v14, v19, v14, vcc
  s_add_u32 s47, s47, s21
  s_lshr_b32 s21, s41, 1
  s_lshl_b32 s21, s21, 15
  s_add_u32 s47, s47, s21
  s_and_b32 s21, s41, 1
  s_mul_i32 s21, s21, 2560
  s_add_u32 s47, s47, s21
  s_xor_b32 s21, s80, 184819712
  s_add_u32 s47, s47, s21
  s_lshl_b32 s22, s22, 10
  s_add_u32 s47, s47, s22
  s_mov_b32 s48, 1073741824
  s_mov_b32 s49, 1073741824
  v_cmp_eq_u32 s[62:63], 0, v3
  v_lshlrev_b32 v17, 2, v3
  v_sub_u32 v17, v17, v2
  s_mov_b32 s82, 0x3e64f92e
  s_mov_b32 s83, 0x3fb8aa3b
  v_mov_b32 v20, 0
  v_mov_b32 v21, 0
  v_mov_b32 v22, 0
  v_mov_b32 v23, 0
  v_add_u32 v18, 7, v17
  v_cmp_gt_u32 s[84:85], 8, v18
  v_cmp_le_i32 s[64:65], 16, v18
  v_mov_b32 v18, 65535
  v_cndmask_b32 v19, 0, v18, s[84:85]
  v_or_b32 v20, v20, v19
  v_cndmask_b32 v19, 0, v18, s[64:65]
  v_or_b32 v22, v22, v19
  s_mov_b64 s[54:55], s[84:85]
  s_or_b64 s[84:85], s[84:85], s[64:65]
  v_add_u32 v18, 8, v17
  v_cmp_gt_u32 s[86:87], 8, v18
  v_cmp_le_i32 s[66:67], 16, v18
  v_mov_b32 v18, 4294901760
  v_cndmask_b32 v19, 0, v18, s[86:87]
  v_or_b32 v20, v20, v19
  v_cndmask_b32 v19, 0, v18, s[66:67]
  v_or_b32 v22, v22, v19
  s_mov_b64 s[56:57], s[86:87]
  s_or_b64 s[86:87], s[86:87], s[66:67]
  v_add_u32 v18, 9, v17
  v_cmp_gt_u32 s[88:89], 8, v18
  v_cmp_le_i32 s[68:69], 16, v18
  v_mov_b32 v18, 65535
  v_cndmask_b32 v19, 0, v18, s[88:89]
  v_or_b32 v21, v21, v19
  v_cndmask_b32 v19, 0, v18, s[68:69]
  v_or_b32 v23, v23, v19
  s_mov_b64 s[58:59], s[88:89]
  s_or_b64 s[88:89], s[88:89], s[68:69]
  v_add_u32 v18, 10, v17
  v_cmp_gt_u32 s[90:91], 8, v18
  v_cmp_le_i32 s[70:71], 16, v18
  v_mov_b32 v18, 4294901760
  v_cndmask_b32 v19, 0, v18, s[90:91]
  v_or_b32 v21, v21, v19
  v_cndmask_b32 v19, 0, v18, s[70:71]
  v_or_b32 v23, v23, v19
  s_mov_b64 s[60:61], s[90:91]
  s_or_b64 s[90:91], s[90:91], s[70:71]
  v_mov_b32 v18, 0x3f80
  v_mov_b32 v19, 0x3f800000
  v_cmp_eq_i32 vcc, 0, v17
  v_cmp_eq_i32 s[22:23], -1, v17
  s_nop 1
  v_cndmask_b32 v24, 0, v18, vcc
  v_cndmask_b32 v24, v24, v19, s[22:23]
  v_cmp_eq_i32 vcc, -2, v17
  v_cmp_eq_i32 s[22:23], -3, v17
  s_nop 1
  v_cndmask_b32 v25, 0, v18, vcc
  v_cndmask_b32 v25, v25, v19, s[22:23]
  v_mov_b32 v26, 0
  v_mov_b32 v27, 0
  v_mov_b32 v60, 0
  v_mov_b32 v61, 0
  v_mov_b32 v62, 0
  v_mov_b32 v63, 0
  v_mov_b32 v64, 0
  v_mov_b32 v65, 0
  v_mov_b32 v66, 0
  v_mov_b32 v67, 0
  v_mov_b32 v68, 0
  v_mov_b32 v69, 0
  v_mov_b32 v70, 0
  v_mov_b32 v71, 0
  v_mov_b32 v72, 0
  v_mov_b32 v73, 0
  v_mov_b32 v74, 0
  v_mov_b32 v75, 0
  v_mov_b32 v76, 0
  v_mov_b32 v77, 0
  v_mov_b32 v78, 0
  v_mov_b32 v79, 0
  v_mov_b32 v80, 0
  v_mov_b32 v81, 0
  v_mov_b32 v82, 0
  v_mov_b32 v83, 0
  v_mov_b32 v84, 0
  v_mov_b32 v85, 0
  v_mov_b32 v86, 0
  v_mov_b32 v87, 0
  v_mov_b32 v88, 0
  v_mov_b32 v89, 0
  v_mov_b32 v90, 0
  v_mov_b32 v91, 0
  v_mov_b32 v92, 0
  v_mov_b32 v93, 0
  v_mov_b32 v94, 0
  v_mov_b32 v95, 0
  v_mov_b32 v96, 0
  v_mov_b32 v97, 0
  v_mov_b32 v98, 0
  v_mov_b32 v99, 0
  v_mov_b32 v100, 0
  v_mov_b32 v101, 0
  v_mov_b32 v102, 0
  v_mov_b32 v103, 0
  v_mov_b32 v104, 0
  v_mov_b32 v105, 0
  v_mov_b32 v106, 0
  v_mov_b32 v107, 0
  v_mov_b32 v108, 0
  v_mov_b32 v109, 0
  v_mov_b32 v110, 0
  v_mov_b32 v111, 0
  v_mov_b32 v112, 0
  v_mov_b32 v113, 0
  v_mov_b32 v114, 0
  v_mov_b32 v115, 0
  v_mov_b32 v116, 0
  v_mov_b32 v117, 0
  v_mov_b32 v118, 0
  v_mov_b32 v119, 0
  v_mov_b32 v120, 0
  v_mov_b32 v121, 0
  v_mov_b32 v122, 0
  v_mov_b32 v123, 0
  v_mov_b32 v124, 0
  v_mov_b32 v125, 0
  v_mov_b32 v126, 0
  v_mov_b32 v127, 0
  v_mov_b32 v128, 0
  v_mov_b32 v129, 0
  v_mov_b32 v130, 0
  v_mov_b32 v131, 0
  s_cmp_eq_u32 s42, 0
  s_cselect_b32 s53, 15, 99
  s_mov_b32 s26, 17
  s_waitcnt vmcnt(10)
  s_barrier
  ds_read_b128 v[28:31], v7 offset:0
  ds_read_b128 v[32:35], v8 offset:0
  ds_read_b128 v[36:39], v7 offset:4096
  ds_read_b128 v[40:43], v8 offset:4096
  s_waitcnt lgkmcnt(3)
  .p2align 3
bfl_257:
  v_mfma_f32_16x16x32_bf16 v[60:63], a[0:3], v[28:31], 0
  ds_read_b128 v[44:47], v7 offset:8192
  v_mfma_f32_16x16x32_bf16 v[64:67], a[4:7], v[28:31], 0
  v_mfma_f32_16x16x32_bf16 v[68:71], a[8:11], v[28:31], 0
  v_cvt_pk_bf16_f32 v128, v84, v85
  v_cvt_pk_bf16_f32 v129, v86, v87
  v_mfma_f32_16x16x32_bf16 v[72:75], v[28:31], a[12:15], 0
  s_waitcnt lgkmcnt(3)
  v_cvt_pk_bf16_f32 v124, v76, v77
  v_cvt_pk_bf16_f32 v125, v78, v79
  v_mfma_f32_16x16x32_bf16 v[60:63], a[16:19], v[32:35], v[60:63]
  ds_read_b128 v[48:51], v8 offset:8192
  v_cvt_pk_bf16_f32 v100, v80, v81
  v_mfma_f32_16x16x32_bf16 v[64:67], a[20:23], v[32:35], v[64:67]
  v_cvt_pk_bf16_f32 v101, v82, v83
  v_cvt_pk_bf16_f32 v116, v88, v89
  v_mfma_f32_16x16x32_bf16 v[68:71], a[24:27], v[32:35], v[68:71]
  s_add_u32 m0, s31, 0
  v_cvt_pk_bf16_f32 v117, v90, v91
  v_cndmask_b32 v126, 0, v128, s[62:63]
  v_mfma_f32_16x16x32_bf16 v[72:75], v[32:35], a[28:31], v[72:75]
  s_waitcnt lgkmcnt(3)
  v_cndmask_b32 v127, 0, v129, s[62:63]
  buffer_load_dwordx4 v4, s[8:11], s30 offen offset:0 lds
  v_mfma_f32_16x16x32_bf16 v[60:63], a[32:35], v[36:39], v[60:63]
  ds_read_b128 v[52:55], v7 offset:12288
  v_mfma_f32_16x16x32_bf16 v[64:67], a[36:39], v[36:39], v[64:67]
  v_mfma_f32_16x16x32_bf16 v[68:71], a[40:43], v[36:39], v[68:71]
  v_mfma_f32_16x16x32_bf16 v[72:75], v[36:39], a[44:47], v[72:75]
  v_mfma_f32_16x16x32_bf16 v[132:135], v[128:131], v[24:27], 0
  s_waitcnt lgkmcnt(3)
  v_permlane16_swap_b32 v128, v102
  v_permlane16_swap_b32 v129, v103
  v_mfma_f32_16x16x32_bf16 v[60:63], a[48:51], v[40:43], v[60:63]
  ds_read_b128 v[56:59], v8 offset:12288
  v_mfma_f32_16x16x32_bf16 v[64:67], a[52:55], v[40:43], v[64:67]
  v_mfma_f32_16x16x32_bf16 v[68:71], a[56:59], v[40:43], v[68:71]
  v_mfma_f32_16x16x32_bf16 v[72:75], v[40:43], a[60:63], v[72:75]
  v_mfma_f32_16x16x32_bf16 v[136:139], v[100:103], v[124:127], 0
  v_mfma_f32_16x16x32_bf16 v[140:143], v[104:107], v[124:127], 0
  s_add_u32 m0, s31, 3968
  s_waitcnt lgkmcnt(3)
  v_mfma_f32_16x16x32_bf16 v[60:63], a[64:67], v[44:47], v[60:63]
  ds_read_b128 v[28:31], v7 offset:16384
  buffer_load_dwordx4 v4, s[8:11], s30 offen offset:128 lds
  v_mfma_f32_16x16x32_bf16 v[64:67], a[68:71], v[44:47], v[64:67]
  v_mfma_f32_16x16x32_bf16 v[68:71], a[72:75], v[44:47], v[68:71]
  v_cvt_pk_bf16_f32 v120, v132, v133
  v_cvt_pk_bf16_f32 v121, v134, v135
  v_mfma_f32_16x16x32_bf16 v[72:75], v[44:47], a[76:79], v[72:75]
  s_waitcnt lgkmcnt(3)
  v_cndmask_b32 v136, v136, v140, s[64:65]
  v_cndmask_b32 v137, v137, v141, s[66:67]
  v_mfma_f32_16x16x32_bf16 v[60:63], a[80:83], v[48:51], v[60:63]
  ds_read_b128 v[32:35], v8 offset:16384
  v_cndmask_b32 v138, v138, v142, s[68:69]
  v_mfma_f32_16x16x32_bf16 v[64:67], a[84:87], v[48:51], v[64:67]
  v_cndmask_b32 v139, v139, v143, s[70:71]
  v_cvt_pk_bf16_f32 v17, v136, v137
  v_mfma_f32_16x16x32_bf16 v[68:71], a[88:91], v[48:51], v[68:71]
  v_lshlrev_b32 v136, 16, v17
  v_and_b32 v137, 0xffff0000, v17
  v_mfma_f32_16x16x32_bf16 v[72:75], v[48:51], a[92:95], v[72:75]
  s_waitcnt lgkmcnt(3)
  v_cvt_pk_bf16_f32 v17, v138, v139
  v_lshlrev_b32 v138, 16, v17
  v_mfma_f32_16x16x32_bf16 v[60:63], a[96:99], v[52:55], v[60:63]
  ds_read_b128 v[36:39], v7 offset:20480
  v_and_b32 v139, 0xffff0000, v17
  v_mfma_f32_16x16x32_bf16 v[64:67], a[100:103], v[52:55], v[64:67]
  v_mul_f32 v136, s82, v136
  v_mul_f32 v137, s82, v137
  v_mfma_f32_16x16x32_bf16 v[68:71], a[104:107], v[52:55], v[68:71]
  v_mul_f32 v138, s82, v138
  v_mul_f32 v139, s82, v139
  v_mfma_f32_16x16x32_bf16 v[72:75], v[52:55], a[108:111], v[72:75]
  s_waitcnt lgkmcnt(3)
  v_cvt_pk_bf16_f32 v17, v136, v137
  v_lshlrev_b32 v136, 16, v17
  v_mfma_f32_16x16x32_bf16 v[60:63], a[112:115], v[56:59], v[60:63]
  s_add_u32 m0, s31, 7936
  ds_read_b128 v[40:43], v8 offset:20480
  v_and_b32 v137, 0xffff0000, v17
  v_mfma_f32_16x16x32_bf16 v[64:67], a[116:119], v[56:59], v[64:67]
  v_cvt_pk_bf16_f32 v17, v138, v139
  v_lshlrev_b32 v138, 16, v17
  v_mfma_f32_16x16x32_bf16 v[68:71], a[120:123], v[56:59], v[68:71]
  v_and_b32 v139, 0xffff0000, v17
  v_cndmask_b32 v136, v16, v136, s[54:55]
  v_mfma_f32_16x16x32_bf16 v[72:75], v[56:59], a[124:127], v[72:75]
  s_waitcnt lgkmcnt(3)
  v_cndmask_b32 v137, v16, v137, s[56:57]
  v_cndmask_b32 v138, v16, v138, s[58:59]
  v_mfma_f32_16x16x32_bf16 v[60:63], a[128:131], v[28:31], v[60:63]
  ds_read_b128 v[44:47], v7 offset:24576
  v_cndmask_b32 v139, v16, v139, s[60:61]
  v_mfma_f32_16x16x32_bf16 v[64:67], a[132:135], v[28:31], v[64:67]
  v_max3_f32 v17, v136, v137, v138
  v_max_f32 v17, v17, v139
  v_mfma_f32_16x16x32_bf16 v[68:71], a[136:139], v[28:31], v[68:71]
  v_mov_b32 v18, v17
  buffer_load_dwordx4 v4, s[8:11], s30 offen offset:256 lds
  v_mfma_f32_16x16x32_bf16 v[72:75], v[28:31], a[140:143], v[72:75]
  s_waitcnt lgkmcnt(3)
  v_permlane32_swap_b32 v17, v18
  v_max_f32 v17, v17, v18
  v_mfma_f32_16x16x32_bf16 v[60:63], a[144:147], v[32:35], v[60:63]
  ds_read_b128 v[48:51], v8 offset:24576
  v_mov_b32 v18, v17
  v_mfma_f32_16x16x32_bf16 v[64:67], a[148:151], v[32:35], v[64:67]
  v_permlane16_swap_b32 v17, v18
  v_max_f32 v17, v17, v18
  v_mfma_f32_16x16x32_bf16 v[68:71], a[152:155], v[32:35], v[68:71]
  v_mul_f32 v17, s83, v17
  v_fma_f32 v136, v136, s83, -v17
  v_mfma_f32_16x16x32_bf16 v[72:75], v[32:35], a[156:159], v[72:75]
  s_waitcnt lgkmcnt(3)
  v_fma_f32 v137, v137, s83, -v17
  v_fma_f32 v138, v138, s83, -v17
  v_mfma_f32_16x16x32_bf16 v[60:63], a[160:163], v[36:39], v[60:63]
  s_add_u32 m0, s31, 11904
  ds_read_b128 v[52:55], v7 offset:28672
  v_fma_f32 v139, v139, s83, -v17
  v_mfma_f32_16x16x32_bf16 v[64:67], a[164:167], v[36:39], v[64:67]
  v_exp_f32 v136, v136
  v_mfma_f32_16x16x32_bf16 v[68:71], a[168:171], v[36:39], v[68:71]
  v_exp_f32 v137, v137
  v_mfma_f32_16x16x32_bf16 v[72:75], v[36:39], a[172:175], v[72:75]
  s_waitcnt lgkmcnt(3)
  v_exp_f32 v138, v138
  v_mfma_f32_16x16x32_bf16 v[60:63], a[176:179], v[40:43], v[60:63]
  ds_read_b128 v[56:59], v8 offset:28672
  buffer_load_dwordx4 v4, s[8:11], s30 offen offset:384 lds
  v_mfma_f32_16x16x32_bf16 v[64:67], a[180:183], v[40:43], v[64:67]
  v_exp_f32 v139, v139
  v_mfma_f32_16x16x32_bf16 v[68:71], a[184:187], v[40:43], v[68:71]
  v_add_f32 v17, v136, v137
  v_add_f32 v18, v138, v139
  v_mfma_f32_16x16x32_bf16 v[72:75], v[40:43], a[188:191], v[72:75]
  s_waitcnt lgkmcnt(3)
  v_add_f32 v17, v17, v18
  v_mov_b32 v18, v17
  v_mfma_f32_16x16x32_bf16 v[60:63], a[192:195], v[44:47], v[60:63]
  ds_read_b128 v[28:31], v7 offset:32768
  v_permlane32_swap_b32 v17, v18
  v_mfma_f32_16x16x32_bf16 v[64:67], a[196:199], v[44:47], v[64:67]
  v_add_f32 v17, v17, v18
  v_mov_b32 v18, v17
  v_mfma_f32_16x16x32_bf16 v[68:71], a[200:203], v[44:47], v[68:71]
  v_permlane16_swap_b32 v17, v18
  v_add_f32 v17, v17, v18
  v_mfma_f32_16x16x32_bf16 v[72:75], v[44:47], a[204:207], v[72:75]
  s_waitcnt lgkmcnt(3)
  v_rcp_f32 v17, v17
  v_mfma_f32_16x16x32_bf16 v[60:63], a[208:211], v[48:51], v[60:63]
  s_add_u32 m0, s31, 15872
  ds_read_b128 v[32:35], v8 offset:32768
  v_mul_f32 v136, v136, v17
  v_mfma_f32_16x16x32_bf16 v[64:67], a[212:215], v[48:51], v[64:67]
  v_mul_f32 v137, v137, v17
  v_mul_f32 v138, v138, v17
  v_mfma_f32_16x16x32_bf16 v[68:71], a[216:219], v[48:51], v[68:71]
  v_mul_f32 v139, v139, v17
  v_cvt_pk_bf16_f32 v144, v136, v137
  v_mfma_f32_16x16x32_bf16 v[72:75], v[48:51], a[220:223], v[72:75]
  s_waitcnt lgkmcnt(3)
  v_cvt_pk_bf16_f32 v145, v138, v139
  v_and_b32 v146, v144, v22
  v_mfma_f32_16x16x32_bf16 v[60:63], a[224:227], v[52:55], v[60:63]
  ds_read_b128 v[36:39], v7 offset:36864
  v_and_b32 v147, v145, v23
  v_mfma_f32_16x16x32_bf16 v[64:67], a[228:231], v[52:55], v[64:67]
  v_and_b32 v144, v144, v20
  v_and_b32 v145, v145, v21
  v_mfma_f32_16x16x32_bf16 v[68:71], a[232:235], v[52:55], v[68:71]
  buffer_load_dwordx4 v4, s[8:11], s30 offen offset:512 lds
  v_mfma_f32_16x16x32_bf16 v[72:75], v[52:55], a[236:239], v[72:75]
  s_waitcnt lgkmcnt(3)
  v_mfma_f32_16x16x32_bf16 v[60:63], a[240:243], v[56:59], v[60:63]
  ds_read_b128 v[40:43], v8 offset:36864
  v_mfma_f32_16x16x32_bf16 v[64:67], a[244:247], v[56:59], v[64:67]
  v_mfma_f32_16x16x32_bf16 v[68:71], a[248:251], v[56:59], v[68:71]
  v_mfma_f32_16x16x32_bf16 v[72:75], v[56:59], a[252:255], v[72:75]
  s_add_u32 m0, s31, 19840
  s_waitcnt lgkmcnt(3)
  v_mfma_f32_16x16x32_bf16 v[60:63], v[192:195], v[28:31], v[60:63]
  ds_read_b128 v[44:47], v7 offset:2048
  buffer_load_dwordx4 v4, s[8:11], s30 offen offset:640 lds
  v_mfma_f32_16x16x32_bf16 v[64:67], v[196:199], v[28:31], v[64:67]
  v_mfma_f32_16x16x32_bf16 v[68:71], v[200:203], v[28:31], v[68:71]
  v_mfma_f32_16x16x32_bf16 v[72:75], v[28:31], v[204:207], v[72:75]
  v_mfma_f32_16x16x32_bf16 v[148:151], v[116:119], v[144:147], 0
  s_cmp_le_u32 s26, s53
  s_cselect_b64 s[54:55], s[84:85], s[54:55]
  v_mfma_f32_16x16x32_bf16 v[152:155], v[120:123], v[144:147], 0
  s_waitcnt lgkmcnt(3)
  v_mov_b32 v104, v100
  v_mov_b32 v105, v101
  v_mfma_f32_16x16x32_bf16 v[60:63], v[208:211], v[32:35], v[60:63]
  ds_read_b128 v[48:51], v8 offset:2048
  v_mov_b32 v106, v102
  v_mfma_f32_16x16x32_bf16 v[64:67], v[212:215], v[32:35], v[64:67]
  v_mov_b32 v107, v103
  v_mov_b32 v118, v116
  v_mfma_f32_16x16x32_bf16 v[68:71], v[216:219], v[32:35], v[68:71]
  v_cvt_pk_bf16_f32 v156, v148, v149
  v_cvt_pk_bf16_f32 v157, v150, v151
  v_mfma_f32_16x16x32_bf16 v[72:75], v[32:35], v[220:223], v[72:75]
  s_waitcnt lgkmcnt(3)
  ds_write_b64 v9, v[156:157] offset:16
  v_cvt_pk_bf16_f32 v158, v152, v153
  v_mfma_f32_16x16x32_bf16 v[60:63], v[224:227], v[36:39], v[60:63]
  ds_read_b128 v[52:55], v7 offset:6144
  v_cvt_pk_bf16_f32 v159, v154, v155
  v_mfma_f32_16x16x32_bf16 v[64:67], v[228:231], v[36:39], v[64:67]
  s_add_u32 m0, s31, 23808
  ds_write_b64 v10, v[158:159] offset:8
  v_mov_b32 v119, v117
  v_mfma_f32_16x16x32_bf16 v[68:71], v[232:235], v[36:39], v[68:71]
  v_mov_b32 v122, v120
  v_mov_b32 v123, v121
  v_mfma_f32_16x16x32_bf16 v[72:75], v[36:39], v[236:239], v[72:75]
  s_waitcnt lgkmcnt(5)
  buffer_load_dwordx4 v4, s[8:11], s30 offen offset:768 lds
  v_mfma_f32_16x16x32_bf16 v[60:63], v[240:243], v[40:43], v[60:63]
  ds_read_b128 v[56:59], v8 offset:6144
  v_mfma_f32_16x16x32_bf16 v[64:67], v[244:247], v[40:43], v[64:67]
  s_cmp_le_u32 s26, s53
  s_cselect_b64 s[56:57], s[86:87], s[56:57]
  v_mfma_f32_16x16x32_bf16 v[68:71], v[248:251], v[40:43], v[68:71]
  s_cmp_le_u32 s26, s53
  s_cselect_b64 s[58:59], s[88:89], s[58:59]
  v_mfma_f32_16x16x32_bf16 v[72:75], v[40:43], v[252:255], v[72:75]
  s_waitcnt lgkmcnt(5)
  s_cmp_le_u32 s26, s53
  s_cselect_b64 s[60:61], s[90:91], s[60:61]
  v_mfma_f32_16x16x32_bf16 v[76:79], a[0:3], v[44:47], 0
  ds_read_b128 v[28:31], v7 offset:10240
  v_mfma_f32_16x16x32_bf16 v[80:83], a[4:7], v[44:47], 0
  s_waitcnt lgkmcnt(2)
  s_barrier
  v_mfma_f32_16x16x32_bf16 v[84:87], a[8:11], v[44:47], 0
  v_cvt_pk_bf16_f32 v128, v68, v69
  v_cvt_pk_bf16_f32 v129, v70, v71
  v_mfma_f32_16x16x32_bf16 v[88:91], v[44:47], a[12:15], 0
  s_waitcnt lgkmcnt(5)
  v_cvt_pk_bf16_f32 v124, v60, v61
  v_cvt_pk_bf16_f32 v125, v62, v63
  v_mfma_f32_16x16x32_bf16 v[76:79], a[16:19], v[48:51], v[76:79]
  ds_read_b128 v[32:35], v8 offset:10240
  v_cvt_pk_bf16_f32 v92, v64, v65
  v_mfma_f32_16x16x32_bf16 v[80:83], a[20:23], v[48:51], v[80:83]
  s_add_u32 m0, s31, 27776
  v_cvt_pk_bf16_f32 v93, v66, v67
  v_cvt_pk_bf16_f32 v108, v72, v73
  v_mfma_f32_16x16x32_bf16 v[84:87], a[24:27], v[48:51], v[84:87]
  v_cvt_pk_bf16_f32 v109, v74, v75
  v_cndmask_b32 v126, 0, v128, s[62:63]
  v_mfma_f32_16x16x32_bf16 v[88:91], v[48:51], a[28:31], v[88:91]
  s_waitcnt lgkmcnt(4)
  v_cndmask_b32 v127, 0, v129, s[62:63]
  v_xor_b32 v9, 8192, v9
  v_mfma_f32_16x16x32_bf16 v[76:79], a[32:35], v[52:55], v[76:79]
  ds_read_b128 v[36:39], v7 offset:14336
  v_xor_b32 v10, 8192, v10
  v_mfma_f32_16x16x32_bf16 v[80:83], a[36:39], v[52:55], v[80:83]
  ds_read_b128 v[160:163], v11
  ds_read_b128 v[164:167], v12
  v_mfma_f32_16x16x32_bf16 v[84:87], a[40:43], v[52:55], v[84:87]
  buffer_load_dwordx4 v4, s[8:11], s30 offen offset:896 lds
  v_mfma_f32_16x16x32_bf16 v[88:91], v[52:55], a[44:47], v[88:91]
  v_mfma_f32_16x16x32_bf16 v[132:135], v[128:131], v[24:27], 0
  s_waitcnt lgkmcnt(5)
  v_permlane16_swap_b32 v128, v94
  v_permlane16_swap_b32 v129, v95
  v_mfma_f32_16x16x32_bf16 v[76:79], a[48:51], v[56:59], v[76:79]
  ds_read_b128 v[40:43], v8 offset:14336
  v_mfma_f32_16x16x32_bf16 v[80:83], a[52:55], v[56:59], v[80:83]
  v_mfma_f32_16x16x32_bf16 v[84:87], a[56:59], v[56:59], v[84:87]
  s_waitcnt lgkmcnt(1)
  buffer_store_dwordx4 v[160:163], v15, s[16:19], s49 offen sc1
  buffer_store_dwordx4 v[164:167], v14, s[16:19], s49 offen sc1
  v_mfma_f32_16x16x32_bf16 v[88:91], v[56:59], a[60:63], v[88:91]
  v_xor_b32 v11, 8192, v11
  v_xor_b32 v12, 8192, v12
  v_mfma_f32_16x16x32_bf16 v[136:139], v[92:95], v[124:127], 0
  s_add_u32 m0, s31, 31744
  s_mov_b32 s49, s48
  s_mov_b32 s48, s47
  v_mfma_f32_16x16x32_bf16 v[140:143], v[96:99], v[124:127], 0
  s_add_u32 s22, s47, 524288
  s_waitcnt lgkmcnt(5)
  buffer_load_dwordx4 v4, s[8:11], s30 offen offset:1024 lds
  v_mfma_f32_16x16x32_bf16 v[76:79], a[64:67], v[28:31], v[76:79]
  s_xor_b32 s47, s47, s22
  ds_read_b128 v[44:47], v7 offset:18432
  s_lshr_b32 s47, s47, 8
  v_mfma_f32_16x16x32_bf16 v[80:83], a[68:71], v[28:31], v[80:83]
  s_and_b32 s47, s47, 8192
  s_xor_b32 s47, s47, s22
  s_sub_u32 s26, s26, 1
  v_mfma_f32_16x16x32_bf16 v[84:87], a[72:75], v[28:31], v[84:87]
  v_cvt_pk_bf16_f32 v112, v132, v133
  v_cvt_pk_bf16_f32 v113, v134, v135
  v_mfma_f32_16x16x32_bf16 v[88:91], v[28:31], a[76:79], v[88:91]
  s_waitcnt lgkmcnt(5)
  v_cndmask_b32 v136, v136, v140, s[64:65]
  v_cndmask_b32 v137, v137, v141, s[66:67]
  v_mfma_f32_16x16x32_bf16 v[76:79], a[80:83], v[32:35], v[76:79]
  ds_read_b128 v[48:51], v8 offset:18432
  v_cndmask_b32 v138, v138, v142, s[68:69]
  v_mfma_f32_16x16x32_bf16 v[80:83], a[84:87], v[32:35], v[80:83]
  v_cndmask_b32 v139, v139, v143, s[70:71]
  v_cvt_pk_bf16_f32 v17, v136, v137
  v_mfma_f32_16x16x32_bf16 v[84:87], a[88:91], v[32:35], v[84:87]
  v_lshlrev_b32 v136, 16, v17
  v_and_b32 v137, 0xffff0000, v17
  v_mfma_f32_16x16x32_bf16 v[88:91], v[32:35], a[92:95], v[88:91]
  s_waitcnt lgkmcnt(5)
  v_cvt_pk_bf16_f32 v17, v138, v139
  v_lshlrev_b32 v138, 16, v17
  v_mfma_f32_16x16x32_bf16 v[76:79], a[96:99], v[36:39], v[76:79]
  ds_read_b128 v[52:55], v7 offset:22528
  v_and_b32 v139, 0xffff0000, v17
  v_mfma_f32_16x16x32_bf16 v[80:83], a[100:103], v[36:39], v[80:83]
  v_mul_f32 v136, s82, v136
  v_mul_f32 v137, s82, v137
  v_mfma_f32_16x16x32_bf16 v[84:87], a[104:107], v[36:39], v[84:87]
  s_add_u32 m0, s31, 35712
  v_mul_f32 v138, s82, v138
  v_mul_f32 v139, s82, v139
  v_mfma_f32_16x16x32_bf16 v[88:91], v[36:39], a[108:111], v[88:91]
  s_waitcnt lgkmcnt(3)
  v_cvt_pk_bf16_f32 v17, v136, v137
  v_lshlrev_b32 v136, 16, v17
  v_mfma_f32_16x16x32_bf16 v[76:79], a[112:115], v[40:43], v[76:79]
  ds_read_b128 v[56:59], v8 offset:22528
  v_and_b32 v137, 0xffff0000, v17
  v_mfma_f32_16x16x32_bf16 v[80:83], a[116:119], v[40:43], v[80:83]
  v_cvt_pk_bf16_f32 v17, v138, v139
  v_lshlrev_b32 v138, 16, v17
  v_mfma_f32_16x16x32_bf16 v[84:87], a[120:123], v[40:43], v[84:87]
  v_and_b32 v139, 0xffff0000, v17
  v_cndmask_b32 v136, v16, v136, s[54:55]
  v_mfma_f32_16x16x32_bf16 v[88:91], v[40:43], a[124:127], v[88:91]
  s_waitcnt lgkmcnt(3)
  v_cndmask_b32 v137, v16, v137, s[56:57]
  v_cndmask_b32 v138, v16, v138, s[58:59]
  v_mfma_f32_16x16x32_bf16 v[76:79], a[128:131], v[44:47], v[76:79]
  ds_read_b128 v[28:31], v7 offset:26624
  v_cndmask_b32 v139, v16, v139, s[60:61]
  v_mfma_f32_16x16x32_bf16 v[80:83], a[132:135], v[44:47], v[80:83]
  v_max3_f32 v17, v136, v137, v138
  v_max_f32 v17, v17, v139
  v_mfma_f32_16x16x32_bf16 v[84:87], a[136:139], v[44:47], v[84:87]
  v_mov_b32 v18, v17
  buffer_load_dwordx4 v4, s[8:11], s30 offen offset:1152 lds
  v_mfma_f32_16x16x32_bf16 v[88:91], v[44:47], a[140:143], v[88:91]
  s_waitcnt lgkmcnt(3)
  v_permlane32_swap_b32 v17, v18
  v_max_f32 v17, v17, v18
  v_mfma_f32_16x16x32_bf16 v[76:79], a[144:147], v[48:51], v[76:79]
  s_add_u32 s30, s30, 40960
  ds_read_b128 v[32:35], v8 offset:26624
  v_mov_b32 v18, v17
  v_mfma_f32_16x16x32_bf16 v[80:83], a[148:151], v[48:51], v[80:83]
  s_add_u32 s31, s31, 40960
  v_permlane16_swap_b32 v17, v18
  v_max_f32 v17, v17, v18
  v_mfma_f32_16x16x32_bf16 v[84:87], a[152:155], v[48:51], v[84:87]
  v_mul_f32 v17, s83, v17
  v_fma_f32 v136, v136, s83, -v17
  v_mfma_f32_16x16x32_bf16 v[88:91], v[48:51], a[156:159], v[88:91]
  s_waitcnt lgkmcnt(3)
  v_fma_f32 v137, v137, s83, -v17
  v_fma_f32 v138, v138, s83, -v17
  v_mfma_f32_16x16x32_bf16 v[76:79], a[160:163], v[52:55], v[76:79]
  ds_read_b128 v[36:39], v7 offset:30720
  v_fma_f32 v139, v139, s83, -v17
  v_mfma_f32_16x16x32_bf16 v[80:83], a[164:167], v[52:55], v[80:83]
  v_exp_f32 v136, v136
  v_mfma_f32_16x16x32_bf16 v[84:87], a[168:171], v[52:55], v[84:87]
  v_exp_f32 v137, v137
  v_mfma_f32_16x16x32_bf16 v[88:91], v[52:55], a[172:175], v[88:91]
  s_waitcnt lgkmcnt(3)
  v_exp_f32 v138, v138
  v_mfma_f32_16x16x32_bf16 v[76:79], a[176:179], v[56:59], v[76:79]
  ds_read_b128 v[40:43], v8 offset:30720
  v_mfma_f32_16x16x32_bf16 v[80:83], a[180:183], v[56:59], v[80:83]
  v_exp_f32 v139, v139
  v_mfma_f32_16x16x32_bf16 v[84:87], a[184:187], v[56:59], v[84:87]
  v_add_f32 v17, v136, v137
  v_add_f32 v18, v138, v139
  v_mfma_f32_16x16x32_bf16 v[88:91], v[56:59], a[188:191], v[88:91]
  s_waitcnt lgkmcnt(3)
  v_add_f32 v17, v17, v18
  v_mov_b32 v18, v17
  v_mfma_f32_16x16x32_bf16 v[76:79], a[192:195], v[28:31], v[76:79]
  ds_read_b128 v[44:47], v7 offset:34816
  v_permlane32_swap_b32 v17, v18
  v_mfma_f32_16x16x32_bf16 v[80:83], a[196:199], v[28:31], v[80:83]
  v_add_f32 v17, v17, v18
  v_mov_b32 v18, v17
  v_mfma_f32_16x16x32_bf16 v[84:87], a[200:203], v[28:31], v[84:87]
  v_permlane16_swap_b32 v17, v18
  v_add_f32 v17, v17, v18
  v_mfma_f32_16x16x32_bf16 v[88:91], v[28:31], a[204:207], v[88:91]
  s_waitcnt lgkmcnt(3)
  v_rcp_f32 v17, v17
  v_mfma_f32_16x16x32_bf16 v[76:79], a[208:211], v[32:35], v[76:79]
  ds_read_b128 v[48:51], v8 offset:34816
  v_mul_f32 v136, v136, v17
  v_mfma_f32_16x16x32_bf16 v[80:83], a[212:215], v[32:35], v[80:83]
  v_mul_f32 v137, v137, v17
  v_mul_f32 v138, v138, v17
  v_mfma_f32_16x16x32_bf16 v[84:87], a[216:219], v[32:35], v[84:87]
  v_mul_f32 v139, v139, v17
  v_cvt_pk_bf16_f32 v144, v136, v137
  v_mfma_f32_16x16x32_bf16 v[88:91], v[32:35], a[220:223], v[88:91]
  s_waitcnt lgkmcnt(3)
  v_cvt_pk_bf16_f32 v145, v138, v139
  v_and_b32 v146, v144, v22
  v_mfma_f32_16x16x32_bf16 v[76:79], a[224:227], v[36:39], v[76:79]
  ds_read_b128 v[52:55], v7 offset:38912
  v_and_b32 v147, v145, v23
  v_mfma_f32_16x16x32_bf16 v[80:83], a[228:231], v[36:39], v[80:83]
  v_and_b32 v144, v144, v20
  v_and_b32 v145, v145, v21
  v_mfma_f32_16x16x32_bf16 v[84:87], a[232:235], v[36:39], v[84:87]
  s_cmp_ge_u32 s31, 122880
  s_cselect_b32 s21, 122880, 0
  s_sub_u32 s31, s31, s21
  v_mfma_f32_16x16x32_bf16 v[88:91], v[36:39], a[236:239], v[88:91]
  s_add_u32 s33, s33, 40960
  s_waitcnt lgkmcnt(3)
  v_mfma_f32_16x16x32_bf16 v[76:79], a[240:243], v[40:43], v[76:79]
  ds_read_b128 v[56:59], v8 offset:38912
  v_mfma_f32_16x16x32_bf16 v[80:83], a[244:247], v[40:43], v[80:83]
  s_cmp_ge_u32 s33, 122880
  s_cselect_b32 s33, 0, s33
  v_mfma_f32_16x16x32_bf16 v[84:87], a[248:251], v[40:43], v[84:87]
  v_add_u32 v7, s33, v5
  v_add_u32 v8, s33, v6
  v_mfma_f32_16x16x32_bf16 v[88:91], v[40:43], a[252:255], v[88:91]
  s_waitcnt lgkmcnt(3)
  v_mfma_f32_16x16x32_bf16 v[76:79], v[192:195], v[44:47], v[76:79]
  s_waitcnt vmcnt(12)
  s_barrier
  ds_read_b128 v[28:31], v7 offset:0
  v_mfma_f32_16x16x32_bf16 v[80:83], v[196:199], v[44:47], v[80:83]
  v_mfma_f32_16x16x32_bf16 v[84:87], v[200:203], v[44:47], v[84:87]
  v_mfma_f32_16x16x32_bf16 v[88:91], v[44:47], v[204:207], v[88:91]
  v_mfma_f32_16x16x32_bf16 v[148:151], v[108:111], v[144:147], 0
  v_mfma_f32_16x16x32_bf16 v[152:155], v[112:115], v[144:147], 0
  s_waitcnt lgkmcnt(3)
  v_mov_b32 v96, v92
  v_mov_b32 v97, v93
  v_mfma_f32_16x16x32_bf16 v[76:79], v[208:211], v[48:51], v[76:79]
  ds_read_b128 v[32:35], v8 offset:0
  v_mov_b32 v98, v94
  v_mfma_f32_16x16x32_bf16 v[80:83], v[212:215], v[48:51], v[80:83]
  v_mov_b32 v99, v95
  v_mov_b32 v110, v108
  v_mfma_f32_16x16x32_bf16 v[84:87], v[216:219], v[48:51], v[84:87]
  v_cvt_pk_bf16_f32 v156, v148, v149
  v_cvt_pk_bf16_f32 v157, v150, v151
  v_mfma_f32_16x16x32_bf16 v[88:91], v[48:51], v[220:223], v[88:91]
  s_waitcnt lgkmcnt(3)
  ds_write_b64 v9, v[156:157] offset:0
  v_cvt_pk_bf16_f32 v158, v152, v153
  v_mfma_f32_16x16x32_bf16 v[76:79], v[224:227], v[52:55], v[76:79]
  ds_read_b128 v[36:39], v7 offset:4096
  v_cvt_pk_bf16_f32 v159, v154, v155
  v_mfma_f32_16x16x32_bf16 v[80:83], v[228:231], v[52:55], v[80:83]
  ds_write_b64 v10, v[158:159] offset:0
  v_mov_b32 v111, v109
  v_mfma_f32_16x16x32_bf16 v[84:87], v[232:235], v[52:55], v[84:87]
  v_mov_b32 v114, v112
  v_mov_b32 v115, v113
  v_mfma_f32_16x16x32_bf16 v[88:91], v[52:55], v[236:239], v[88:91]
  s_waitcnt lgkmcnt(5)
  v_mfma_f32_16x16x32_bf16 v[76:79], v[240:243], v[56:59], v[76:79]
  ds_read_b128 v[40:43], v8 offset:4096
  v_mfma_f32_16x16x32_bf16 v[80:83], v[244:247], v[56:59], v[80:83]
  v_mfma_f32_16x16x32_bf16 v[84:87], v[248:251], v[56:59], v[84:87]
  s_cmp_gt_u32 s26, 0
  v_mfma_f32_16x16x32_bf16 v[88:91], v[56:59], v[252:255], v[88:91]
  s_waitcnt lgkmcnt(5)
  s_cbranch_scc1 bfl_257
  s_nop 7
  v_cvt_pk_bf16_f32 v128, v84, v85
  v_cvt_pk_bf16_f32 v129, v86, v87
  v_cvt_pk_bf16_f32 v124, v76, v77
  v_cvt_pk_bf16_f32 v125, v78, v79
  v_cvt_pk_bf16_f32 v100, v80, v81
  v_cvt_pk_bf16_f32 v101, v82, v83
  v_cvt_pk_bf16_f32 v116, v88, v89
  v_cvt_pk_bf16_f32 v117, v90, v91
  v_cndmask_b32 v126, 0, v128, s[62:63]
  v_cndmask_b32 v127, 0, v129, s[62:63]
  s_nop 1
  v_mfma_f32_16x16x32_bf16 v[132:135], v[128:131], v[24:27], 0
  s_nop 7
  v_permlane16_swap_b32 v128, v102
  v_permlane16_swap_b32 v129, v103
  s_nop 1
  v_mfma_f32_16x16x32_bf16 v[136:139], v[100:103], v[124:127], 0
  v_mfma_f32_16x16x32_bf16 v[140:143], v[104:107], v[124:127], 0
  s_nop 7
  v_cvt_pk_bf16_f32 v120, v132, v133
  v_cvt_pk_bf16_f32 v121, v134, v135
  v_cndmask_b32 v136, v136, v140, s[64:65]
  v_cndmask_b32 v137, v137, v141, s[66:67]
  v_cndmask_b32 v138, v138, v142, s[68:69]
  v_cndmask_b32 v139, v139, v143, s[70:71]
  v_cvt_pk_bf16_f32 v17, v136, v137
  v_lshlrev_b32 v136, 16, v17
  v_and_b32 v137, 0xffff0000, v17
  v_cvt_pk_bf16_f32 v17, v138, v139
  v_lshlrev_b32 v138, 16, v17
  v_and_b32 v139, 0xffff0000, v17
  v_mul_f32 v136, s82, v136
  v_mul_f32 v137, s82, v137
  v_mul_f32 v138, s82, v138
  v_mul_f32 v139, s82, v139
  v_cvt_pk_bf16_f32 v17, v136, v137
  v_lshlrev_b32 v136, 16, v17
  v_and_b32 v137, 0xffff0000, v17
  v_cvt_pk_bf16_f32 v17, v138, v139
  v_lshlrev_b32 v138, 16, v17
  v_and_b32 v139, 0xffff0000, v17
  v_cndmask_b32 v136, v16, v136, s[54:55]
  v_cndmask_b32 v137, v16, v137, s[56:57]
  v_cndmask_b32 v138, v16, v138, s[58:59]
  v_cndmask_b32 v139, v16, v139, s[60:61]
  v_max3_f32 v17, v136, v137, v138
  v_max_f32 v17, v17, v139
  v_mov_b32 v18, v17
  s_nop 1
  v_permlane32_swap_b32 v17, v18
  v_max_f32 v17, v17, v18
  v_mov_b32 v18, v17
  s_nop 1
  v_permlane16_swap_b32 v17, v18
  v_max_f32 v17, v17, v18
  v_mul_f32 v17, s83, v17
  v_fma_f32 v136, v136, s83, -v17
  v_fma_f32 v137, v137, s83, -v17
  v_fma_f32 v138, v138, s83, -v17
  v_fma_f32 v139, v139, s83, -v17
  v_exp_f32 v136, v136
  v_exp_f32 v137, v137
  v_exp_f32 v138, v138
  v_exp_f32 v139, v139
  s_nop 1
  v_add_f32 v17, v136, v137
  v_add_f32 v18, v138, v139
  v_add_f32 v17, v17, v18
  v_mov_b32 v18, v17
  s_nop 1
  v_permlane32_swap_b32 v17, v18
  v_add_f32 v17, v17, v18
  v_mov_b32 v18, v17
  s_nop 1
  v_permlane16_swap_b32 v17, v18
  v_add_f32 v17, v17, v18
  v_rcp_f32 v17, v17
  s_nop 1
  v_mul_f32 v136, v136, v17
  v_mul_f32 v137, v137, v17
  v_mul_f32 v138, v138, v17
  v_mul_f32 v139, v139, v17
  v_cvt_pk_bf16_f32 v144, v136, v137
  v_cvt_pk_bf16_f32 v145, v138, v139
  v_and_b32 v146, v144, v22
  v_and_b32 v147, v145, v23
  v_and_b32 v144, v144, v20
  v_and_b32 v145, v145, v21
  s_nop 1
  v_mfma_f32_16x16x32_bf16 v[148:151], v[116:119], v[144:147], 0
  v_mfma_f32_16x16x32_bf16 v[152:155], v[120:123], v[144:147], 0
  s_nop 7
  v_mov_b32 v104, v100
  v_mov_b32 v105, v101
  v_mov_b32 v106, v102
  v_mov_b32 v107, v103
  v_mov_b32 v118, v116
  v_mov_b32 v119, v117
  v_mov_b32 v122, v120
  v_mov_b32 v123, v121
  v_cvt_pk_bf16_f32 v156, v148, v149
  v_cvt_pk_bf16_f32 v157, v150, v151
  ds_write_b64 v9, v[156:157] offset:16
  v_cvt_pk_bf16_f32 v158, v152, v153
  v_cvt_pk_bf16_f32 v159, v154, v155
  ds_write_b64 v10, v[158:159] offset:8
  s_waitcnt lgkmcnt(0)
  s_barrier
  ds_read_b128 v[160:163], v11
  ds_read_b128 v[164:167], v12
  s_waitcnt lgkmcnt(0)
  buffer_store_dwordx4 v[160:163], v15, s[16:19], s49 offen sc1
  buffer_store_dwordx4 v[164:167], v14, s[16:19], s49 offen sc1
  s_waitcnt vmcnt(0)
  s_barrier
  s_lshl_b32 s21, s42, 7
  s_add_u32 s21, s21, 29696
  s_xor_b32 s21, s21, s80
  s_cmp_lg_u32 s20, 0
  s_cbranch_scc1 af_258
  v_mov_b32 v8, 0
  v_mov_b32 v9, 1
  s_mov_b64 exec, 1
  buffer_atomic_add v9, v8, s[72:75], s21 offen sc1
  s_mov_b64 exec, -1
  s_nop 1
af_258:
  s_barrier
  s_sub_u32 s2, s3, 96
  s_mov_b32 s40, 0
  s_mov_b32 s41, 12
q_entry:
  s_load_dwordx2 s[4:5], s[0:1], 0
  s_load_dwordx2 s[6:7], s[0:1], 16
  s_load_dwordx2 s[38:39], s[0:1], 104
  s_mov_b32 s42, s2
  s_waitcnt lgkmcnt(0)
  s_mov_b32 s8, s4
  s_mov_b32 s9, s5
  s_mov_b32 s10, 2621440
  s_mov_b32 s11, 0x00020000
  s_mov_b32 s12, s6
  s_mov_b32 s13, s7
  s_mov_b32 s14, 7864320
  s_mov_b32 s15, 0x00020000
  s_mov_b32 s16, s38
  s_mov_b32 s17, s39
  s_mov_b32 s18, 218103808
  s_mov_b32 s19, 0x00020000
  s_add_u32 s72, s38, 173080576
  s_addc_u32 s73, s39, 0
  s_mov_b32 s74, 49152
  s_mov_b32 s75, 0x00020000
  s_mul_i32 s44, s42, 384
  s_cmp_lg_u32 s40, 0
  s_cbranch_scc1 qg_259
  s_load_dwordx2 s[36:37], s[0:1], 80
  s_waitcnt lgkmcnt(0)
  s_mov_b32 s24, s36
  s_mov_b32 s25, s37
  s_mov_b32 s26, 1280
  s_mov_b32 s27, 0x00020000
  s_add_u32 s76, s38, 175112192
  s_addc_u32 s77, s39, 0
  s_mov_b32 s78, 8192
  s_mov_b32 s79, 0x00020000
  s_lshl_b32 s59, s2, 2
  s_add_u32 s59, s59, s20
  s_lshl_b32 s59, s59, 4
  v_lshlrev_b32 v10, 2, v1
  v_lshlrev_b32 v11, 4, v1
  s_mul_i32 s22, s59, 1280
  buffer_load_dwordx4 v[12:15], v11, s[24:27], 0 offen
  buffer_load_dword v16, v10, s[24:27], 0 offen offset:1024
  buffer_load_dwordx4 v[192:195], v11, s[8:11], s22 offen
  buffer_load_dword v48, v10, s[8:11], s22 offen offset:1024
  s_add_u32 s22, s22, 1280
  buffer_load_dwordx4 v[196:199], v11, s[8:11], s22 offen
  buffer_load_dword v49, v10, s[8:11], s22 offen offset:1024
  s_add_u32 s22, s22, 1280
  buffer_load_dwordx4 v[200:203], v11, s[8:11], s22 offen
  buffer_load_dword v50, v10, s[8:11], s22 offen offset:1024
  s_add_u32 s22, s22, 1280
  buffer_load_dwordx4 v[204:207], v11, s[8:11], s22 offen
  buffer_load_dword v51, v10, s[8:11], s22 offen offset:1024
  s_add_u32 s22, s22, 1280
  buffer_load_dwordx4 v[208:211], v11, s[8:11], s22 offen
  buffer_load_dword v52, v10, s[8:11], s22 offen offset:1024
  s_add_u32 s22, s22, 1280
  buffer_load_dwordx4 v[212:215], v11, s[8:11], s22 offen
  buffer_load_dword v53, v10, s[8:11], s22 offen offset:1024
  s_add_u32 s22, s22, 1280
  buffer_load_dwordx4 v[216:219], v11, s[8:11], s22 offen
  buffer_load_dword v54, v10, s[8:11], s22 offen offset:1024
  s_add_u32 s22, s22, 1280
  buffer_load_dwordx4 v[220:223], v11, s[8:11], s22 offen
  buffer_load_dword v55, v10, s[8:11], s22 offen offset:1024
  s_add_u32 s22, s22, 1280
  buffer_load_dwordx4 v[224:227], v11, s[8:11], s22 offen
  buffer_load_dword v56, v10, s[8:11], s22 offen offset:1024
  s_add_u32 s22, s22, 1280
  buffer_load_dwordx4 v[228:231], v11, s[8:11], s22 offen
  buffer_load_dword v57, v10, s[8:11], s22 offen offset:1024
  s_add_u32 s22, s22, 1280
  buffer_load_dwordx4 v[232:235], v11, s[8:11], s22 offen
  buffer_load_dword v58, v10, s[8:11], s22 offen offset:1024
  s_add_u32 s22, s22, 1280
  buffer_load_dwordx4 v[236:239], v11, s[8:11], s22 offen
  buffer_load_dword v59, v10, s[8:11], s22 offen offset:1024
  s_add_u32 s22, s22, 1280
  buffer_load_dwordx4 v[240:243], v11, s[8:11], s22 offen
  buffer_load_dword v60, v10, s[8:11], s22 offen offset:1024
  s_add_u32 s22, s22, 1280
  buffer_load_dwordx4 v[244:247], v11, s[8:11], s22 offen
  buffer_load_dword v61, v10, s[8:11], s22 offen offset:1024
  s_add_u32 s22, s22, 1280
  buffer_load_dwordx4 v[248:251], v11, s[8:11], s22 offen
  buffer_load_dword v62, v10, s[8:11], s22 offen offset:1024
  s_add_u32 s22, s22, 1280
  buffer_load_dwordx4 v[252:255], v11, s[8:11], s22 offen
  buffer_load_dword v63, v10, s[8:11], s22 offen offset:1024
  s_add_u32 s22, s22, 1280
qg_259:
  s_waitcnt vmcnt(30)
  v_mov_b32 v9, 2731
  v_add_u32 v8, 0, v1
  v_mul_u32_u24 v7, v8, v9
  v_lshrrev_b32 v7, 16, v7
  v_mul_u32_u24 v4, 24, v7
  v_sub_u32 v8, v8, v4
  s_mov_b32 s21, 12288
  v_mul_lo_u32 v7, v7, s21
  v_lshl_add_u32 v4, v8, 4, v7
  v_add_u32 v8, 64, v1
  v_mul_u32_u24 v7, v8, v9
  v_lshrrev_b32 v7, 16, v7
  v_mul_u32_u24 v5, 24, v7
  v_sub_u32 v8, v8, v5
  s_mov_b32 s21, 12288
  v_mul_lo_u32 v7, v7, s21
  v_lshl_add_u32 v5, v8, 4, v7
  v_add_u32 v8, 128, v1
  v_mul_u32_u24 v7, v8, v9
  v_lshrrev_b32 v7, 16, v7
  v_mul_u32_u24 v6, 24, v7
  v_sub_u32 v8, v8, v6
  s_mov_b32 s21, 12288
  v_mul_lo_u32 v7, v7, s21
  v_lshl_add_u32 v6, v8, 4, v7
  v_lshrrev_b32 v7, 2, v2
  v_lshl_add_u32 v7, v3, 3, v7
  v_mul_u32_u24 v7, 384, v7
  v_and_b32 v8, 3, v2
  v_lshlrev_b32 v8, 3, v8
  s_mul_i32 s21, s20, 96
  v_add3_u32 v7, v7, v8, s21
  v_add_u32 v8, 61440, v7
  s_mul_i32 s21, s20, 491520
  s_add_u32 s21, s21, 0
  s_add_u32 s21, s21, s44
  s_mul_i32 s22, s20, 15360
  s_add_u32 s22, s22, 0
  s_add_u32 m0, s22, 0
  s_nop 0
  buffer_load_dwordx4 v4, s[12:15], s21 offen lds
  s_add_u32 m0, s22, 1024
  s_nop 0
  buffer_load_dwordx4 v5, s[12:15], s21 offen lds
  s_add_u32 m0, s22, 2048
  s_nop 0
  buffer_load_dwordx4 v6, s[12:15], s21 offen lds
  s_mul_i32 s21, s20, 491520
  s_add_u32 s21, s21, 98304
  s_add_u32 s21, s21, s44
  s_mul_i32 s22, s20, 15360
  s_add_u32 s22, s22, 3072
  s_add_u32 m0, s22, 0
  s_nop 0
  buffer_load_dwordx4 v4, s[12:15], s21 offen lds
  s_add_u32 m0, s22, 1024
  s_nop 0
  buffer_load_dwordx4 v5, s[12:15], s21 offen lds
  s_add_u32 m0, s22, 2048
  s_nop 0
  buffer_load_dwordx4 v6, s[12:15], s21 offen lds
  s_mul_i32 s21, s20, 491520
  s_add_u32 s21, s21, 196608
  s_add_u32 s21, s21, s44
  s_mul_i32 s22, s20, 15360
  s_add_u32 s22, s22, 6144
  s_add_u32 m0, s22, 0
  s_nop 0
  buffer_load_dwordx4 v4, s[12:15], s21 offen lds
  s_add_u32 m0, s22, 1024
  s_nop 0
  buffer_load_dwordx4 v5, s[12:15], s21 offen lds
  s_add_u32 m0, s22, 2048
  s_nop 0
  buffer_load_dwordx4 v6, s[12:15], s21 offen lds
  s_mul_i32 s21, s20, 491520
  s_add_u32 s21, s21, 294912
  s_add_u32 s21, s21, s44
  s_mul_i32 s22, s20, 15360
  s_add_u32 s22, s22, 9216
  s_add_u32 m0, s22, 0
  s_nop 0
  buffer_load_dwordx4 v4, s[12:15], s21 offen lds
  s_add_u32 m0, s22, 1024
  s_nop 0
  buffer_load_dwordx4 v5, s[12:15], s21 offen lds
  s_add_u32 m0, s22, 2048
  s_nop 0
  buffer_load_dwordx4 v6, s[12:15], s21 offen lds
  s_mul_i32 s21, s20, 491520
  s_add_u32 s21, s21, 393216
  s_add_u32 s21, s21, s44
  s_mul_i32 s22, s20, 15360
  s_add_u32 s22, s22, 12288
  s_add_u32 m0, s22, 0
  s_nop 0
  buffer_load_dwordx4 v4, s[12:15], s21 offen lds
  s_add_u32 m0, s22, 1024
  s_nop 0
  buffer_load_dwordx4 v5, s[12:15], s21 offen lds
  s_add_u32 m0, s22, 2048
  s_nop 0
  buffer_load_dwordx4 v6, s[12:15], s21 offen lds
  s_mul_i32 s21, s20, 491520
  s_add_u32 s21, s21, 1966080
  s_add_u32 s21, s21, s44
  s_mul_i32 s22, s20, 15360
  s_add_u32 s22, s22, 61440
  s_add_u32 m0, s22, 0
  s_nop 0
  buffer_load_dwordx4 v4, s[12:15], s21 offen lds
  s_add_u32 m0, s22, 1024
  s_nop 0
  buffer_load_dwordx4 v5, s[12:15], s21 offen lds
  s_add_u32 m0, s22, 2048
  s_nop 0
  buffer_load_dwordx4 v6, s[12:15], s21 offen lds
  s_mul_i32 s21, s20, 491520
  s_add_u32 s21, s21, 2064384
  s_add_u32 s21, s21, s44
  s_mul_i32 s22, s20, 15360
  s_add_u32 s22, s22, 64512
  s_add_u32 m0, s22, 0
  s_nop 0
  buffer_load_dwordx4 v4, s[12:15], s21 offen lds
  s_add_u32 m0, s22, 1024
  s_nop 0
  buffer_load_dwordx4 v5, s[12:15], s21 offen lds
  s_add_u32 m0, s22, 2048
  s_nop 0
  buffer_load_dwordx4 v6, s[12:15], s21 offen lds
  s_mul_i32 s21, s20, 491520
  s_add_u32 s21, s21, 2162688
  s_add_u32 s21, s21, s44
  s_mul_i32 s22, s20, 15360
  s_add_u32 s22, s22, 67584
  s_add_u32 m0, s22, 0
  s_nop 0
  buffer_load_dwordx4 v4, s[12:15], s21 offen lds
  s_add_u32 m0, s22, 1024
  s_nop 0
  buffer_load_dwordx4 v5, s[12:15], s21 offen lds
  s_add_u32 m0, s22, 2048
  s_nop 0
  buffer_load_dwordx4 v6, s[12:15], s21 offen lds
  s_mul_i32 s21, s20, 491520
  s_add_u32 s21, s21, 2260992
  s_add_u32 s21, s21, s44
  s_mul_i32 s22, s20, 15360
  s_add_u32 s22, s22, 70656
  s_add_u32 m0, s22, 0
  s_nop 0
  buffer_load_dwordx4 v4, s[12:15], s21 offen lds
  s_add_u32 m0, s22, 1024
  s_nop 0
  buffer_load_dwordx4 v5, s[12:15], s21 offen lds
  s_add_u32 m0, s22, 2048
  s_nop 0
  buffer_load_dwordx4 v6, s[12:15], s21 offen lds
  s_mul_i32 s21, s20, 491520
  s_add_u32 s21, s21, 2359296
  s_add_u32 s21, s21, s44
  s_mul_i32 s22, s20, 15360
  s_add_u32 s22, s22, 73728
  s_add_u32 m0, s22, 0
  s_nop 0
  buffer_load_dwordx4 v4, s[12:15], s21 offen lds
  s_add_u32 m0, s22, 1024
  s_nop 0
  buffer_load_dwordx4 v5, s[12:15], s21 offen lds
  s_add_u32 m0, s22, 2048
  s_nop 0
  buffer_load_dwordx4 v6, s[12:15], s21 offen lds
  s_waitcnt vmcnt(30)
  s_mul_i32 s21, s20, 491520
  s_add_u32 s21, s21, 3932160
  s_add_u32 s21, s21, s44
  buffer_load_dwordx4 v[64:67], v4, s[12:15], s21 offen
  buffer_load_dwordx4 v[68:71], v5, s[12:15], s21 offen
  buffer_load_dwordx4 v[72:75], v6, s[12:15], s21 offen
  s_mul_i32 s21, s20, 491520
  s_add_u32 s21, s21, 4030464
  s_add_u32 s21, s21, s44
  buffer_load_dwordx4 v[76:79], v4, s[12:15], s21 offen
  buffer_load_dwordx4 v[80:83], v5, s[12:15], s21 offen
  buffer_load_dwordx4 v[84:87], v6, s[12:15], s21 offen
  s_mul_i32 s21, s20, 491520
  s_add_u32 s21, s21, 4128768
  s_add_u32 s21, s21, s44
  buffer_load_dwordx4 v[88:91], v4, s[12:15], s21 offen
  buffer_load_dwordx4 v[92:95], v5, s[12:15], s21 offen
  buffer_load_dwordx4 v[96:99], v6, s[12:15], s21 offen
  s_mul_i32 s21, s20, 491520
  s_add_u32 s21, s21, 4227072
  s_add_u32 s21, s21, s44
  buffer_load_dwordx4 v[100:103], v4, s[12:15], s21 offen
  buffer_load_dwordx4 v[104:107], v5, s[12:15], s21 offen
  buffer_load_dwordx4 v[108:111], v6, s[12:15], s21 offen
  s_mul_i32 s21, s20, 491520
  s_add_u32 s21, s21, 4325376
  s_add_u32 s21, s21, s44
  buffer_load_dwordx4 v[112:115], v4, s[12:15], s21 offen
  buffer_load_dwordx4 v[116:119], v5, s[12:15], s21 offen
  buffer_load_dwordx4 v[120:123], v6, s[12:15], s21 offen
  s_mul_i32 s21, s20, 491520
  s_add_u32 s21, s21, 5898240
  s_add_u32 s21, s21, s44
  buffer_load_dwordx4 v[124:127], v4, s[12:15], s21 offen
  buffer_load_dwordx4 v[128:131], v5, s[12:15], s21 offen
  buffer_load_dwordx4 v[132:135], v6, s[12:15], s21 offen
  s_mul_i32 s21, s20, 491520
  s_add_u32 s21, s21, 5996544
  s_add_u32 s21, s21, s44
  buffer_load_dwordx4 v[136:139], v4, s[12:15], s21 offen
  buffer_load_dwordx4 v[140:143], v5, s[12:15], s21 offen
  buffer_load_dwordx4 v[144:147], v6, s[12:15], s21 offen
  s_mul_i32 s21, s20, 491520
  s_add_u32 s21, s21, 6094848
  s_add_u32 s21, s21, s44
  buffer_load_dwordx4 v[148:151], v4, s[12:15], s21 offen
  buffer_load_dwordx4 v[152:155], v5, s[12:15], s21 offen
  buffer_load_dwordx4 v[156:159], v6, s[12:15], s21 offen
  s_mul_i32 s21, s20, 491520
  s_add_u32 s21, s21, 6193152
  s_add_u32 s21, s21, s44
  buffer_load_dwordx4 v[160:163], v4, s[12:15], s21 offen
  buffer_load_dwordx4 v[164:167], v5, s[12:15], s21 offen
  buffer_load_dwordx4 v[168:171], v6, s[12:15], s21 offen
  s_mul_i32 s21, s20, 491520
  s_add_u32 s21, s21, 6291456
  s_add_u32 s21, s21, s44
  buffer_load_dwordx4 v[172:175], v4, s[12:15], s21 offen
  buffer_load_dwordx4 v[176:179], v5, s[12:15], s21 offen
  buffer_load_dwordx4 v[180:183], v6, s[12:15], s21 offen
  s_mul_i32 s22, s20, 15360
  v_lshl_add_u32 v30, v1, 4, s22
  v_add_u32 v31, 61440, v30
  s_cmp_lg_u32 s40, 0
  s_cbranch_scc1 qg_260
  v_lshlrev_b32 v17, 16, v12
  v_and_b32 v12, 0xffff0000, v12
  v_lshlrev_b32 v18, 16, v13
  v_and_b32 v13, 0xffff0000, v13
  v_lshlrev_b32 v19, 16, v14
  v_and_b32 v14, 0xffff0000, v14
  v_lshlrev_b32 v20, 16, v15
  v_and_b32 v15, 0xffff0000, v15
  v_lshlrev_b32 v21, 16, v16
  v_and_b32 v16, 0xffff0000, v16
  v_mov_b32 v32, 0
  v_lshlrev_b32 v25, 16, v192
  v_and_b32 v26, 0xffff0000, v192
  v_mul_f32 v25, v25, v17
  v_mul_f32 v26, v26, v12
  v_cvt_pk_bf16_f32 v25, v25, v26
  v_lshlrev_b32 v26, 16, v25
  v_and_b32 v25, 0xffff0000, v25
  v_add_f32 v32, v32, v26
  v_add_f32 v32, v32, v25
  v_lshlrev_b32 v25, 16, v193
  v_and_b32 v26, 0xffff0000, v193
  v_mul_f32 v25, v25, v18
  v_mul_f32 v26, v26, v13
  v_cvt_pk_bf16_f32 v25, v25, v26
  v_lshlrev_b32 v26, 16, v25
  v_and_b32 v25, 0xffff0000, v25
  v_add_f32 v32, v32, v26
  v_add_f32 v32, v32, v25
  v_lshlrev_b32 v25, 16, v194
  v_and_b32 v26, 0xffff0000, v194
  v_mul_f32 v25, v25, v19
  v_mul_f32 v26, v26, v14
  v_cvt_pk_bf16_f32 v25, v25, v26
  v_lshlrev_b32 v26, 16, v25
  v_and_b32 v25, 0xffff0000, v25
  v_add_f32 v32, v32, v26
  v_add_f32 v32, v32, v25
  v_lshlrev_b32 v25, 16, v195
  v_and_b32 v26, 0xffff0000, v195
  v_mul_f32 v25, v25, v20
  v_mul_f32 v26, v26, v15
  v_cvt_pk_bf16_f32 v25, v25, v26
  v_lshlrev_b32 v26, 16, v25
  v_and_b32 v25, 0xffff0000, v25
  v_add_f32 v32, v32, v26
  v_add_f32 v32, v32, v25
  v_lshlrev_b32 v25, 16, v48
  v_and_b32 v26, 0xffff0000, v48
  v_mul_f32 v25, v25, v21
  v_mul_f32 v26, v26, v16
  v_cvt_pk_bf16_f32 v25, v25, v26
  v_lshlrev_b32 v26, 16, v25
  v_and_b32 v25, 0xffff0000, v25
  v_add_f32 v32, v32, v26
  v_add_f32 v32, v32, v25
  v_mov_b32 v33, 0
  v_lshlrev_b32 v25, 16, v196
  v_and_b32 v26, 0xffff0000, v196
  v_mul_f32 v25, v25, v17
  v_mul_f32 v26, v26, v12
  v_cvt_pk_bf16_f32 v25, v25, v26
  v_lshlrev_b32 v26, 16, v25
  v_and_b32 v25, 0xffff0000, v25
  v_add_f32 v33, v33, v26
  v_add_f32 v33, v33, v25
  v_lshlrev_b32 v25, 16, v197
  v_and_b32 v26, 0xffff0000, v197
  v_mul_f32 v25, v25, v18
  v_mul_f32 v26, v26, v13
  v_cvt_pk_bf16_f32 v25, v25, v26
  v_lshlrev_b32 v26, 16, v25
  v_and_b32 v25, 0xffff0000, v25
  v_add_f32 v33, v33, v26
  v_add_f32 v33, v33, v25
  v_lshlrev_b32 v25, 16, v198
  v_and_b32 v26, 0xffff0000, v198
  v_mul_f32 v25, v25, v19
  v_mul_f32 v26, v26, v14
  v_cvt_pk_bf16_f32 v25, v25, v26
  v_lshlrev_b32 v26, 16, v25
  v_and_b32 v25, 0xffff0000, v25
  v_add_f32 v33, v33, v26
  v_add_f32 v33, v33, v25
  v_lshlrev_b32 v25, 16, v199
  v_and_b32 v26, 0xffff0000, v199
  v_mul_f32 v25, v25, v20
  v_mul_f32 v26, v26, v15
  v_cvt_pk_bf16_f32 v25, v25, v26
  v_lshlrev_b32 v26, 16, v25
  v_and_b32 v25, 0xffff0000, v25
  v_add_f32 v33, v33, v26
  v_add_f32 v33, v33, v25
  v_lshlrev_b32 v25, 16, v49
  v_and_b32 v26, 0xffff0000, v49
  v_mul_f32 v25, v25, v21
  v_mul_f32 v26, v26, v16
  v_cvt_pk_bf16_f32 v25, v25, v26
  v_lshlrev_b32 v26, 16, v25
  v_and_b32 v25, 0xffff0000, v25
  v_add_f32 v33, v33, v26
  v_add_f32 v33, v33, v25
  v_mov_b32 v34, 0
  v_lshlrev_b32 v25, 16, v200
  v_and_b32 v26, 0xffff0000, v200
  v_mul_f32 v25, v25, v17
  v_mul_f32 v26, v26, v12
  v_cvt_pk_bf16_f32 v25, v25, v26
  v_lshlrev_b32 v26, 16, v25
  v_and_b32 v25, 0xffff0000, v25
  v_add_f32 v34, v34, v26
  v_add_f32 v34, v34, v25
  v_lshlrev_b32 v25, 16, v201
  v_and_b32 v26, 0xffff0000, v201
  v_mul_f32 v25, v25, v18
  v_mul_f32 v26, v26, v13
  v_cvt_pk_bf16_f32 v25, v25, v26
  v_lshlrev_b32 v26, 16, v25
  v_and_b32 v25, 0xffff0000, v25
  v_add_f32 v34, v34, v26
  v_add_f32 v34, v34, v25
  v_lshlrev_b32 v25, 16, v202
  v_and_b32 v26, 0xffff0000, v202
  v_mul_f32 v25, v25, v19
  v_mul_f32 v26, v26, v14
  v_cvt_pk_bf16_f32 v25, v25, v26
  v_lshlrev_b32 v26, 16, v25
  v_and_b32 v25, 0xffff0000, v25
  v_add_f32 v34, v34, v26
  v_add_f32 v34, v34, v25
  v_lshlrev_b32 v25, 16, v203
  v_and_b32 v26, 0xffff0000, v203
  v_mul_f32 v25, v25, v20
  v_mul_f32 v26, v26, v15
  v_cvt_pk_bf16_f32 v25, v25, v26
  v_lshlrev_b32 v26, 16, v25
  v_and_b32 v25, 0xffff0000, v25
  v_add_f32 v34, v34, v26
  v_add_f32 v34, v34, v25
  v_lshlrev_b32 v25, 16, v50
  v_and_b32 v26, 0xffff0000, v50
  v_mul_f32 v25, v25, v21
  v_mul_f32 v26, v26, v16
  v_cvt_pk_bf16_f32 v25, v25, v26
  v_lshlrev_b32 v26, 16, v25
  v_and_b32 v25, 0xffff0000, v25
  v_add_f32 v34, v34, v26
  v_add_f32 v34, v34, v25
  v_mov_b32 v35, 0
  v_lshlrev_b32 v25, 16, v204
  v_and_b32 v26, 0xffff0000, v204
  v_mul_f32 v25, v25, v17
  v_mul_f32 v26, v26, v12
  v_cvt_pk_bf16_f32 v25, v25, v26
  v_lshlrev_b32 v26, 16, v25
  v_and_b32 v25, 0xffff0000, v25
  v_add_f32 v35, v35, v26
  v_add_f32 v35, v35, v25
  v_lshlrev_b32 v25, 16, v205
  v_and_b32 v26, 0xffff0000, v205
  v_mul_f32 v25, v25, v18
  v_mul_f32 v26, v26, v13
  v_cvt_pk_bf16_f32 v25, v25, v26
  v_lshlrev_b32 v26, 16, v25
  v_and_b32 v25, 0xffff0000, v25
  v_add_f32 v35, v35, v26
  v_add_f32 v35, v35, v25
  v_lshlrev_b32 v25, 16, v206
  v_and_b32 v26, 0xffff0000, v206
  v_mul_f32 v25, v25, v19
  v_mul_f32 v26, v26, v14
  v_cvt_pk_bf16_f32 v25, v25, v26
  v_lshlrev_b32 v26, 16, v25
  v_and_b32 v25, 0xffff0000, v25
  v_add_f32 v35, v35, v26
  v_add_f32 v35, v35, v25
  v_lshlrev_b32 v25, 16, v207
  v_and_b32 v26, 0xffff0000, v207
  v_mul_f32 v25, v25, v20
  v_mul_f32 v26, v26, v15
  v_cvt_pk_bf16_f32 v25, v25, v26
  v_lshlrev_b32 v26, 16, v25
  v_and_b32 v25, 0xffff0000, v25
  v_add_f32 v35, v35, v26
  v_add_f32 v35, v35, v25
  v_lshlrev_b32 v25, 16, v51
  v_and_b32 v26, 0xffff0000, v51
  v_mul_f32 v25, v25, v21
  v_mul_f32 v26, v26, v16
  v_cvt_pk_bf16_f32 v25, v25, v26
  v_lshlrev_b32 v26, 16, v25
  v_and_b32 v25, 0xffff0000, v25
  v_add_f32 v35, v35, v26
  v_add_f32 v35, v35, v25
  v_mov_b32 v36, 0
  v_lshlrev_b32 v25, 16, v208
  v_and_b32 v26, 0xffff0000, v208
  v_mul_f32 v25, v25, v17
  v_mul_f32 v26, v26, v12
  v_cvt_pk_bf16_f32 v25, v25, v26
  v_lshlrev_b32 v26, 16, v25
  v_and_b32 v25, 0xffff0000, v25
  v_add_f32 v36, v36, v26
  v_add_f32 v36, v36, v25
  v_lshlrev_b32 v25, 16, v209
  v_and_b32 v26, 0xffff0000, v209
  v_mul_f32 v25, v25, v18
  v_mul_f32 v26, v26, v13
  v_cvt_pk_bf16_f32 v25, v25, v26
  v_lshlrev_b32 v26, 16, v25
  v_and_b32 v25, 0xffff0000, v25
  v_add_f32 v36, v36, v26
  v_add_f32 v36, v36, v25
  v_lshlrev_b32 v25, 16, v210
  v_and_b32 v26, 0xffff0000, v210
  v_mul_f32 v25, v25, v19
  v_mul_f32 v26, v26, v14
  v_cvt_pk_bf16_f32 v25, v25, v26
  v_lshlrev_b32 v26, 16, v25
  v_and_b32 v25, 0xffff0000, v25
  v_add_f32 v36, v36, v26
  v_add_f32 v36, v36, v25
  v_lshlrev_b32 v25, 16, v211
  v_and_b32 v26, 0xffff0000, v211
  v_mul_f32 v25, v25, v20
  v_mul_f32 v26, v26, v15
  v_cvt_pk_bf16_f32 v25, v25, v26
  v_lshlrev_b32 v26, 16, v25
  v_and_b32 v25, 0xffff0000, v25
  v_add_f32 v36, v36, v26
  v_add_f32 v36, v36, v25
  v_lshlrev_b32 v25, 16, v52
  v_and_b32 v26, 0xffff0000, v52
  v_mul_f32 v25, v25, v21
  v_mul_f32 v26, v26, v16
  v_cvt_pk_bf16_f32 v25, v25, v26
  v_lshlrev_b32 v26, 16, v25
  v_and_b32 v25, 0xffff0000, v25
  v_add_f32 v36, v36, v26
  v_add_f32 v36, v36, v25
  v_mov_b32 v37, 0
  v_lshlrev_b32 v25, 16, v212
  v_and_b32 v26, 0xffff0000, v212
  v_mul_f32 v25, v25, v17
  v_mul_f32 v26, v26, v12
  v_cvt_pk_bf16_f32 v25, v25, v26
  v_lshlrev_b32 v26, 16, v25
  v_and_b32 v25, 0xffff0000, v25
  v_add_f32 v37, v37, v26
  v_add_f32 v37, v37, v25
  v_lshlrev_b32 v25, 16, v213
  v_and_b32 v26, 0xffff0000, v213
  v_mul_f32 v25, v25, v18
  v_mul_f32 v26, v26, v13
  v_cvt_pk_bf16_f32 v25, v25, v26
  v_lshlrev_b32 v26, 16, v25
  v_and_b32 v25, 0xffff0000, v25
  v_add_f32 v37, v37, v26
  v_add_f32 v37, v37, v25
  v_lshlrev_b32 v25, 16, v214
  v_and_b32 v26, 0xffff0000, v214
  v_mul_f32 v25, v25, v19
  v_mul_f32 v26, v26, v14
  v_cvt_pk_bf16_f32 v25, v25, v26
  v_lshlrev_b32 v26, 16, v25
  v_and_b32 v25, 0xffff0000, v25
  v_add_f32 v37, v37, v26
  v_add_f32 v37, v37, v25
  v_lshlrev_b32 v25, 16, v215
  v_and_b32 v26, 0xffff0000, v215
  v_mul_f32 v25, v25, v20
  v_mul_f32 v26, v26, v15
  v_cvt_pk_bf16_f32 v25, v25, v26
  v_lshlrev_b32 v26, 16, v25
  v_and_b32 v25, 0xffff0000, v25
  v_add_f32 v37, v37, v26
  v_add_f32 v37, v37, v25
  v_lshlrev_b32 v25, 16, v53
  v_and_b32 v26, 0xffff0000, v53
  v_mul_f32 v25, v25, v21
  v_mul_f32 v26, v26, v16
  v_cvt_pk_bf16_f32 v25, v25, v26
  v_lshlrev_b32 v26, 16, v25
  v_and_b32 v25, 0xffff0000, v25
  v_add_f32 v37, v37, v26
  v_add_f32 v37, v37, v25
  v_mov_b32 v38, 0
  v_lshlrev_b32 v25, 16, v216
  v_and_b32 v26, 0xffff0000, v216
  v_mul_f32 v25, v25, v17
  v_mul_f32 v26, v26, v12
  v_cvt_pk_bf16_f32 v25, v25, v26
  v_lshlrev_b32 v26, 16, v25
  v_and_b32 v25, 0xffff0000, v25
  v_add_f32 v38, v38, v26
  v_add_f32 v38, v38, v25
  v_lshlrev_b32 v25, 16, v217
  v_and_b32 v26, 0xffff0000, v217
  v_mul_f32 v25, v25, v18
  v_mul_f32 v26, v26, v13
  v_cvt_pk_bf16_f32 v25, v25, v26
  v_lshlrev_b32 v26, 16, v25
  v_and_b32 v25, 0xffff0000, v25
  v_add_f32 v38, v38, v26
  v_add_f32 v38, v38, v25
  v_lshlrev_b32 v25, 16, v218
  v_and_b32 v26, 0xffff0000, v218
  v_mul_f32 v25, v25, v19
  v_mul_f32 v26, v26, v14
  v_cvt_pk_bf16_f32 v25, v25, v26
  v_lshlrev_b32 v26, 16, v25
  v_and_b32 v25, 0xffff0000, v25
  v_add_f32 v38, v38, v26
  v_add_f32 v38, v38, v25
  v_lshlrev_b32 v25, 16, v219
  v_and_b32 v26, 0xffff0000, v219
  v_mul_f32 v25, v25, v20
  v_mul_f32 v26, v26, v15
  v_cvt_pk_bf16_f32 v25, v25, v26
  v_lshlrev_b32 v26, 16, v25
  v_and_b32 v25, 0xffff0000, v25
  v_add_f32 v38, v38, v26
  v_add_f32 v38, v38, v25
  v_lshlrev_b32 v25, 16, v54
  v_and_b32 v26, 0xffff0000, v54
  v_mul_f32 v25, v25, v21
  v_mul_f32 v26, v26, v16
  v_cvt_pk_bf16_f32 v25, v25, v26
  v_lshlrev_b32 v26, 16, v25
  v_and_b32 v25, 0xffff0000, v25
  v_add_f32 v38, v38, v26
  v_add_f32 v38, v38, v25
  v_mov_b32 v39, 0
  v_lshlrev_b32 v25, 16, v220
  v_and_b32 v26, 0xffff0000, v220
  v_mul_f32 v25, v25, v17
  v_mul_f32 v26, v26, v12
  v_cvt_pk_bf16_f32 v25, v25, v26
  v_lshlrev_b32 v26, 16, v25
  v_and_b32 v25, 0xffff0000, v25
  v_add_f32 v39, v39, v26
  v_add_f32 v39, v39, v25
  v_lshlrev_b32 v25, 16, v221
  v_and_b32 v26, 0xffff0000, v221
  v_mul_f32 v25, v25, v18
  v_mul_f32 v26, v26, v13
  v_cvt_pk_bf16_f32 v25, v25, v26
  v_lshlrev_b32 v26, 16, v25
  v_and_b32 v25, 0xffff0000, v25
  v_add_f32 v39, v39, v26
  v_add_f32 v39, v39, v25
  v_lshlrev_b32 v25, 16, v222
  v_and_b32 v26, 0xffff0000, v222
  v_mul_f32 v25, v25, v19
  v_mul_f32 v26, v26, v14
  v_cvt_pk_bf16_f32 v25, v25, v26
  v_lshlrev_b32 v26, 16, v25
  v_and_b32 v25, 0xffff0000, v25
  v_add_f32 v39, v39, v26
  v_add_f32 v39, v39, v25
  v_lshlrev_b32 v25, 16, v223
  v_and_b32 v26, 0xffff0000, v223
  v_mul_f32 v25, v25, v20
  v_mul_f32 v26, v26, v15
  v_cvt_pk_bf16_f32 v25, v25, v26
  v_lshlrev_b32 v26, 16, v25
  v_and_b32 v25, 0xffff0000, v25
  v_add_f32 v39, v39, v26
  v_add_f32 v39, v39, v25
  v_lshlrev_b32 v25, 16, v55
  v_and_b32 v26, 0xffff0000, v55
  v_mul_f32 v25, v25, v21
  v_mul_f32 v26, v26, v16
  v_cvt_pk_bf16_f32 v25, v25, v26
  v_lshlrev_b32 v26, 16, v25
  v_and_b32 v25, 0xffff0000, v25
  v_add_f32 v39, v39, v26
  v_add_f32 v39, v39, v25
  v_mov_b32 v40, 0
  v_lshlrev_b32 v25, 16, v224
  v_and_b32 v26, 0xffff0000, v224
  v_mul_f32 v25, v25, v17
  v_mul_f32 v26, v26, v12
  v_cvt_pk_bf16_f32 v25, v25, v26
  v_lshlrev_b32 v26, 16, v25
  v_and_b32 v25, 0xffff0000, v25
  v_add_f32 v40, v40, v26
  v_add_f32 v40, v40, v25
  v_lshlrev_b32 v25, 16, v225
  v_and_b32 v26, 0xffff0000, v225
  v_mul_f32 v25, v25, v18
  v_mul_f32 v26, v26, v13
  v_cvt_pk_bf16_f32 v25, v25, v26
  v_lshlrev_b32 v26, 16, v25
  v_and_b32 v25, 0xffff0000, v25
  v_add_f32 v40, v40, v26
  v_add_f32 v40, v40, v25
  v_lshlrev_b32 v25, 16, v226
  v_and_b32 v26, 0xffff0000, v226
  v_mul_f32 v25, v25, v19
  v_mul_f32 v26, v26, v14
  v_cvt_pk_bf16_f32 v25, v25, v26
  v_lshlrev_b32 v26, 16, v25
  v_and_b32 v25, 0xffff0000, v25
  v_add_f32 v40, v40, v26
  v_add_f32 v40, v40, v25
  v_lshlrev_b32 v25, 16, v227
  v_and_b32 v26, 0xffff0000, v227
  v_mul_f32 v25, v25, v20
  v_mul_f32 v26, v26, v15
  v_cvt_pk_bf16_f32 v25, v25, v26
  v_lshlrev_b32 v26, 16, v25
  v_and_b32 v25, 0xffff0000, v25
  v_add_f32 v40, v40, v26
  v_add_f32 v40, v40, v25
  v_lshlrev_b32 v25, 16, v56
  v_and_b32 v26, 0xffff0000, v56
  v_mul_f32 v25, v25, v21
  v_mul_f32 v26, v26, v16
  v_cvt_pk_bf16_f32 v25, v25, v26
  v_lshlrev_b32 v26, 16, v25
  v_and_b32 v25, 0xffff0000, v25
  v_add_f32 v40, v40, v26
  v_add_f32 v40, v40, v25
  v_mov_b32 v41, 0
  v_lshlrev_b32 v25, 16, v228
  v_and_b32 v26, 0xffff0000, v228
  v_mul_f32 v25, v25, v17
  v_mul_f32 v26, v26, v12
  v_cvt_pk_bf16_f32 v25, v25, v26
  v_lshlrev_b32 v26, 16, v25
  v_and_b32 v25, 0xffff0000, v25
  v_add_f32 v41, v41, v26
  v_add_f32 v41, v41, v25
  v_lshlrev_b32 v25, 16, v229
  v_and_b32 v26, 0xffff0000, v229
  v_mul_f32 v25, v25, v18
  v_mul_f32 v26, v26, v13
  v_cvt_pk_bf16_f32 v25, v25, v26
  v_lshlrev_b32 v26, 16, v25
  v_and_b32 v25, 0xffff0000, v25
  v_add_f32 v41, v41, v26
  v_add_f32 v41, v41, v25
  v_lshlrev_b32 v25, 16, v230
  v_and_b32 v26, 0xffff0000, v230
  v_mul_f32 v25, v25, v19
  v_mul_f32 v26, v26, v14
  v_cvt_pk_bf16_f32 v25, v25, v26
  v_lshlrev_b32 v26, 16, v25
  v_and_b32 v25, 0xffff0000, v25
  v_add_f32 v41, v41, v26
  v_add_f32 v41, v41, v25
  v_lshlrev_b32 v25, 16, v231
  v_and_b32 v26, 0xffff0000, v231
  v_mul_f32 v25, v25, v20
  v_mul_f32 v26, v26, v15
  v_cvt_pk_bf16_f32 v25, v25, v26
  v_lshlrev_b32 v26, 16, v25
  v_and_b32 v25, 0xffff0000, v25
  v_add_f32 v41, v41, v26
  v_add_f32 v41, v41, v25
  v_lshlrev_b32 v25, 16, v57
  v_and_b32 v26, 0xffff0000, v57
  v_mul_f32 v25, v25, v21
  v_mul_f32 v26, v26, v16
  v_cvt_pk_bf16_f32 v25, v25, v26
  v_lshlrev_b32 v26, 16, v25
  v_and_b32 v25, 0xffff0000, v25
  v_add_f32 v41, v41, v26
  v_add_f32 v41, v41, v25
  v_mov_b32 v42, 0
  v_lshlrev_b32 v25, 16, v232
  v_and_b32 v26, 0xffff0000, v232
  v_mul_f32 v25, v25, v17
  v_mul_f32 v26, v26, v12
  v_cvt_pk_bf16_f32 v25, v25, v26
  v_lshlrev_b32 v26, 16, v25
  v_and_b32 v25, 0xffff0000, v25
  v_add_f32 v42, v42, v26
  v_add_f32 v42, v42, v25
  v_lshlrev_b32 v25, 16, v233
  v_and_b32 v26, 0xffff0000, v233
  v_mul_f32 v25, v25, v18
  v_mul_f32 v26, v26, v13
  v_cvt_pk_bf16_f32 v25, v25, v26
  v_lshlrev_b32 v26, 16, v25
  v_and_b32 v25, 0xffff0000, v25
  v_add_f32 v42, v42, v26
  v_add_f32 v42, v42, v25
  v_lshlrev_b32 v25, 16, v234
  v_and_b32 v26, 0xffff0000, v234
  v_mul_f32 v25, v25, v19
  v_mul_f32 v26, v26, v14
  v_cvt_pk_bf16_f32 v25, v25, v26
  v_lshlrev_b32 v26, 16, v25
  v_and_b32 v25, 0xffff0000, v25
  v_add_f32 v42, v42, v26
  v_add_f32 v42, v42, v25
  v_lshlrev_b32 v25, 16, v235
  v_and_b32 v26, 0xffff0000, v235
  v_mul_f32 v25, v25, v20
  v_mul_f32 v26, v26, v15
  v_cvt_pk_bf16_f32 v25, v25, v26
  v_lshlrev_b32 v26, 16, v25
  v_and_b32 v25, 0xffff0000, v25
  v_add_f32 v42, v42, v26
  v_add_f32 v42, v42, v25
  v_lshlrev_b32 v25, 16, v58
  v_and_b32 v26, 0xffff0000, v58
  v_mul_f32 v25, v25, v21
  v_mul_f32 v26, v26, v16
  v_cvt_pk_bf16_f32 v25, v25, v26
  v_lshlrev_b32 v26, 16, v25
  v_and_b32 v25, 0xffff0000, v25
  v_add_f32 v42, v42, v26
  v_add_f32 v42, v42, v25
  v_mov_b32 v43, 0
  v_lshlrev_b32 v25, 16, v236
  v_and_b32 v26, 0xffff0000, v236
  v_mul_f32 v25, v25, v17
  v_mul_f32 v26, v26, v12
  v_cvt_pk_bf16_f32 v25, v25, v26
  v_lshlrev_b32 v26, 16, v25
  v_and_b32 v25, 0xffff0000, v25
  v_add_f32 v43, v43, v26
  v_add_f32 v43, v43, v25
  v_lshlrev_b32 v25, 16, v237
  v_and_b32 v26, 0xffff0000, v237
  v_mul_f32 v25, v25, v18
  v_mul_f32 v26, v26, v13
  v_cvt_pk_bf16_f32 v25, v25, v26
  v_lshlrev_b32 v26, 16, v25
  v_and_b32 v25, 0xffff0000, v25
  v_add_f32 v43, v43, v26
  v_add_f32 v43, v43, v25
  v_lshlrev_b32 v25, 16, v238
  v_and_b32 v26, 0xffff0000, v238
  v_mul_f32 v25, v25, v19
  v_mul_f32 v26, v26, v14
  v_cvt_pk_bf16_f32 v25, v25, v26
  v_lshlrev_b32 v26, 16, v25
  v_and_b32 v25, 0xffff0000, v25
  v_add_f32 v43, v43, v26
  v_add_f32 v43, v43, v25
  v_lshlrev_b32 v25, 16, v239
  v_and_b32 v26, 0xffff0000, v239
  v_mul_f32 v25, v25, v20
  v_mul_f32 v26, v26, v15
  v_cvt_pk_bf16_f32 v25, v25, v26
  v_lshlrev_b32 v26, 16, v25
  v_and_b32 v25, 0xffff0000, v25
  v_add_f32 v43, v43, v26
  v_add_f32 v43, v43, v25
  v_lshlrev_b32 v25, 16, v59
  v_and_b32 v26, 0xffff0000, v59
  v_mul_f32 v25, v25, v21
  v_mul_f32 v26, v26, v16
  v_cvt_pk_bf16_f32 v25, v25, v26
  v_lshlrev_b32 v26, 16, v25
  v_and_b32 v25, 0xffff0000, v25
  v_add_f32 v43, v43, v26
  v_add_f32 v43, v43, v25
  v_mov_b32 v44, 0
  v_lshlrev_b32 v25, 16, v240
  v_and_b32 v26, 0xffff0000, v240
  v_mul_f32 v25, v25, v17
  v_mul_f32 v26, v26, v12
  v_cvt_pk_bf16_f32 v25, v25, v26
  v_lshlrev_b32 v26, 16, v25
  v_and_b32 v25, 0xffff0000, v25
  v_add_f32 v44, v44, v26
  v_add_f32 v44, v44, v25
  v_lshlrev_b32 v25, 16, v241
  v_and_b32 v26, 0xffff0000, v241
  v_mul_f32 v25, v25, v18
  v_mul_f32 v26, v26, v13
  v_cvt_pk_bf16_f32 v25, v25, v26
  v_lshlrev_b32 v26, 16, v25
  v_and_b32 v25, 0xffff0000, v25
  v_add_f32 v44, v44, v26
  v_add_f32 v44, v44, v25
  v_lshlrev_b32 v25, 16, v242
  v_and_b32 v26, 0xffff0000, v242
  v_mul_f32 v25, v25, v19
  v_mul_f32 v26, v26, v14
  v_cvt_pk_bf16_f32 v25, v25, v26
  v_lshlrev_b32 v26, 16, v25
  v_and_b32 v25, 0xffff0000, v25
  v_add_f32 v44, v44, v26
  v_add_f32 v44, v44, v25
  v_lshlrev_b32 v25, 16, v243
  v_and_b32 v26, 0xffff0000, v243
  v_mul_f32 v25, v25, v20
  v_mul_f32 v26, v26, v15
  v_cvt_pk_bf16_f32 v25, v25, v26
  v_lshlrev_b32 v26, 16, v25
  v_and_b32 v25, 0xffff0000, v25
  v_add_f32 v44, v44, v26
  v_add_f32 v44, v44, v25
  v_lshlrev_b32 v25, 16, v60
  v_and_b32 v26, 0xffff0000, v60
  v_mul_f32 v25, v25, v21
  v_mul_f32 v26, v26, v16
  v_cvt_pk_bf16_f32 v25, v25, v26
  v_lshlrev_b32 v26, 16, v25
  v_and_b32 v25, 0xffff0000, v25
  v_add_f32 v44, v44, v26
  v_add_f32 v44, v44, v25
  v_mov_b32 v45, 0
  v_lshlrev_b32 v25, 16, v244
  v_and_b32 v26, 0xffff0000, v244
  v_mul_f32 v25, v25, v17
  v_mul_f32 v26, v26, v12
  v_cvt_pk_bf16_f32 v25, v25, v26
  v_lshlrev_b32 v26, 16, v25
  v_and_b32 v25, 0xffff0000, v25
  v_add_f32 v45, v45, v26
  v_add_f32 v45, v45, v25
  v_lshlrev_b32 v25, 16, v245
  v_and_b32 v26, 0xffff0000, v245
  v_mul_f32 v25, v25, v18
  v_mul_f32 v26, v26, v13
  v_cvt_pk_bf16_f32 v25, v25, v26
  v_lshlrev_b32 v26, 16, v25
  v_and_b32 v25, 0xffff0000, v25
  v_add_f32 v45, v45, v26
  v_add_f32 v45, v45, v25
  v_lshlrev_b32 v25, 16, v246
  v_and_b32 v26, 0xffff0000, v246
  v_mul_f32 v25, v25, v19
  v_mul_f32 v26, v26, v14
  v_cvt_pk_bf16_f32 v25, v25, v26
  v_lshlrev_b32 v26, 16, v25
  v_and_b32 v25, 0xffff0000, v25
  v_add_f32 v45, v45, v26
  v_add_f32 v45, v45, v25
  v_lshlrev_b32 v25, 16, v247
  v_and_b32 v26, 0xffff0000, v247
  v_mul_f32 v25, v25, v20
  v_mul_f32 v26, v26, v15
  v_cvt_pk_bf16_f32 v25, v25, v26
  v_lshlrev_b32 v26, 16, v25
  v_and_b32 v25, 0xffff0000, v25
  v_add_f32 v45, v45, v26
  v_add_f32 v45, v45, v25
  v_lshlrev_b32 v25, 16, v61
  v_and_b32 v26, 0xffff0000, v61
  v_mul_f32 v25, v25, v21
  v_mul_f32 v26, v26, v16
  v_cvt_pk_bf16_f32 v25, v25, v26
  v_lshlrev_b32 v26, 16, v25
  v_and_b32 v25, 0xffff0000, v25
  v_add_f32 v45, v45, v26
  v_add_f32 v45, v45, v25
  v_mov_b32 v46, 0
  v_lshlrev_b32 v25, 16, v248
  v_and_b32 v26, 0xffff0000, v248
  v_mul_f32 v25, v25, v17
  v_mul_f32 v26, v26, v12
  v_cvt_pk_bf16_f32 v25, v25, v26
  v_lshlrev_b32 v26, 16, v25
  v_and_b32 v25, 0xffff0000, v25
  v_add_f32 v46, v46, v26
  v_add_f32 v46, v46, v25
  v_lshlrev_b32 v25, 16, v249
  v_and_b32 v26, 0xffff0000, v249
  v_mul_f32 v25, v25, v18
  v_mul_f32 v26, v26, v13
  v_cvt_pk_bf16_f32 v25, v25, v26
  v_lshlrev_b32 v26, 16, v25
  v_and_b32 v25, 0xffff0000, v25
  v_add_f32 v46, v46, v26
  v_add_f32 v46, v46, v25
  v_lshlrev_b32 v25, 16, v250
  v_and_b32 v26, 0xffff0000, v250
  v_mul_f32 v25, v25, v19
  v_mul_f32 v26, v26, v14
  v_cvt_pk_bf16_f32 v25, v25, v26
  v_lshlrev_b32 v26, 16, v25
  v_and_b32 v25, 0xffff0000, v25
  v_add_f32 v46, v46, v26
  v_add_f32 v46, v46, v25
  v_lshlrev_b32 v25, 16, v251
  v_and_b32 v26, 0xffff0000, v251
  v_mul_f32 v25, v25, v20
  v_mul_f32 v26, v26, v15
  v_cvt_pk_bf16_f32 v25, v25, v26
  v_lshlrev_b32 v26, 16, v25
  v_and_b32 v25, 0xffff0000, v25
  v_add_f32 v46, v46, v26
  v_add_f32 v46, v46, v25
  v_lshlrev_b32 v25, 16, v62
  v_and_b32 v26, 0xffff0000, v62
  v_mul_f32 v25, v25, v21
  v_mul_f32 v26, v26, v16
  v_cvt_pk_bf16_f32 v25, v25, v26
  v_lshlrev_b32 v26, 16, v25
  v_and_b32 v25, 0xffff0000, v25
  v_add_f32 v46, v46, v26
  v_add_f32 v46, v46, v25
  v_mov_b32 v47, 0
  v_lshlrev_b32 v25, 16, v252
  v_and_b32 v26, 0xffff0000, v252
  v_mul_f32 v25, v25, v17
  v_mul_f32 v26, v26, v12
  v_cvt_pk_bf16_f32 v25, v25, v26
  v_lshlrev_b32 v26, 16, v25
  v_and_b32 v25, 0xffff0000, v25
  v_add_f32 v47, v47, v26
  v_add_f32 v47, v47, v25
  v_lshlrev_b32 v25, 16, v253
  v_and_b32 v26, 0xffff0000, v253
  v_mul_f32 v25, v25, v18
  v_mul_f32 v26, v26, v13
  v_cvt_pk_bf16_f32 v25, v25, v26
  v_lshlrev_b32 v26, 16, v25
  v_and_b32 v25, 0xffff0000, v25
  v_add_f32 v47, v47, v26
  v_add_f32 v47, v47, v25
  v_lshlrev_b32 v25, 16, v254
  v_and_b32 v26, 0xffff0000, v254
  v_mul_f32 v25, v25, v19
  v_mul_f32 v26, v26, v14
  v_cvt_pk_bf16_f32 v25, v25, v26
  v_lshlrev_b32 v26, 16, v25
  v_and_b32 v25, 0xffff0000, v25
  v_add_f32 v47, v47, v26
  v_add_f32 v47, v47, v25
  v_lshlrev_b32 v25, 16, v255
  v_and_b32 v26, 0xffff0000, v255
  v_mul_f32 v25, v25, v20
  v_mul_f32 v26, v26, v15
  v_cvt_pk_bf16_f32 v25, v25, v26
  v_lshlrev_b32 v26, 16, v25
  v_and_b32 v25, 0xffff0000, v25
  v_add_f32 v47, v47, v26
  v_add_f32 v47, v47, v25
  v_lshlrev_b32 v25, 16, v63
  v_and_b32 v26, 0xffff0000, v63
  v_mul_f32 v25, v25, v21
  v_mul_f32 v26, v26, v16
  v_cvt_pk_bf16_f32 v25, v25, v26
  v_lshlrev_b32 v26, 16, v25
  v_and_b32 v25, 0xffff0000, v25
  v_add_f32 v47, v47, v26
  v_add_f32 v47, v47, v25
  v_add_f32_dpp v32, v32, v32 row_ror:8 row_mask:0xf bank_mask:0xf
  v_add_f32_dpp v33, v33, v33 row_ror:8 row_mask:0xf bank_mask:0xf
  v_add_f32_dpp v34, v34, v34 row_ror:8 row_mask:0xf bank_mask:0xf
  v_add_f32_dpp v35, v35, v35 row_ror:8 row_mask:0xf bank_mask:0xf
  v_add_f32_dpp v36, v36, v36 row_ror:8 row_mask:0xf bank_mask:0xf
  v_add_f32_dpp v37, v37, v37 row_ror:8 row_mask:0xf bank_mask:0xf
  v_add_f32_dpp v38, v38, v38 row_ror:8 row_mask:0xf bank_mask:0xf
  v_add_f32_dpp v39, v39, v39 row_ror:8 row_mask:0xf bank_mask:0xf
  v_add_f32_dpp v40, v40, v40 row_ror:8 row_mask:0xf bank_mask:0xf
  v_add_f32_dpp v41, v41, v41 row_ror:8 row_mask:0xf bank_mask:0xf
  v_add_f32_dpp v42, v42, v42 row_ror:8 row_mask:0xf bank_mask:0xf
  v_add_f32_dpp v43, v43, v43 row_ror:8 row_mask:0xf bank_mask:0xf
  v_add_f32_dpp v44, v44, v44 row_ror:8 row_mask:0xf bank_mask:0xf
  v_add_f32_dpp v45, v45, v45 row_ror:8 row_mask:0xf bank_mask:0xf
  v_add_f32_dpp v46, v46, v46 row_ror:8 row_mask:0xf bank_mask:0xf
  v_add_f32_dpp v47, v47, v47 row_ror:8 row_mask:0xf bank_mask:0xf
  v_add_f32_dpp v32, v32, v32 row_ror:4 row_mask:0xf bank_mask:0xf
  v_add_f32_dpp v33, v33, v33 row_ror:4 row_mask:0xf bank_mask:0xf
  v_add_f32_dpp v34, v34, v34 row_ror:4 row_mask:0xf bank_mask:0xf
  v_add_f32_dpp v35, v35, v35 row_ror:4 row_mask:0xf bank_mask:0xf
  v_add_f32_dpp v36, v36, v36 row_ror:4 row_mask:0xf bank_mask:0xf
  v_add_f32_dpp v37, v37, v37 row_ror:4 row_mask:0xf bank_mask:0xf
  v_add_f32_dpp v38, v38, v38 row_ror:4 row_mask:0xf bank_mask:0xf
  v_add_f32_dpp v39, v39, v39 row_ror:4 row_mask:0xf bank_mask:0xf
  v_add_f32_dpp v40, v40, v40 row_ror:4 row_mask:0xf bank_mask:0xf
  v_add_f32_dpp v41, v41, v41 row_ror:4 row_mask:0xf bank_mask:0xf
  v_add_f32_dpp v42, v42, v42 row_ror:4 row_mask:0xf bank_mask:0xf
  v_add_f32_dpp v43, v43, v43 row_ror:4 row_mask:0xf bank_mask:0xf
  v_add_f32_dpp v44, v44, v44 row_ror:4 row_mask:0xf bank_mask:0xf
  v_add_f32_dpp v45, v45, v45 row_ror:4 row_mask:0xf bank_mask:0xf
  v_add_f32_dpp v46, v46, v46 row_ror:4 row_mask:0xf bank_mask:0xf
  v_add_f32_dpp v47, v47, v47 row_ror:4 row_mask:0xf bank_mask:0xf
  v_add_f32_dpp v32, v32, v32 row_ror:2 row_mask:0xf bank_mask:0xf
  v_add_f32_dpp v33, v33, v33 row_ror:2 row_mask:0xf bank_mask:0xf
  v_add_f32_dpp v34, v34, v34 row_ror:2 row_mask:0xf bank_mask:0xf
  v_add_f32_dpp v35, v35, v35 row_ror:2 row_mask:0xf bank_mask:0xf
  v_add_f32_dpp v36, v36, v36 row_ror:2 row_mask:0xf bank_mask:0xf
  v_add_f32_dpp v37, v37, v37 row_ror:2 row_mask:0xf bank_mask:0xf
  v_add_f32_dpp v38, v38, v38 row_ror:2 row_mask:0xf bank_mask:0xf
  v_add_f32_dpp v39, v39, v39 row_ror:2 row_mask:0xf bank_mask:0xf
  v_add_f32_dpp v40, v40, v40 row_ror:2 row_mask:0xf bank_mask:0xf
  v_add_f32_dpp v41, v41, v41 row_ror:2 row_mask:0xf bank_mask:0xf
  v_add_f32_dpp v42, v42, v42 row_ror:2 row_mask:0xf bank_mask:0xf
  v_add_f32_dpp v43, v43, v43 row_ror:2 row_mask:0xf bank_mask:0xf
  v_add_f32_dpp v44, v44, v44 row_ror:2 row_mask:0xf bank_mask:0xf
  v_add_f32_dpp v45, v45, v45 row_ror:2 row_mask:0xf bank_mask:0xf
  v_add_f32_dpp v46, v46, v46 row_ror:2 row_mask:0xf bank_mask:0xf
  v_add_f32_dpp v47, v47, v47 row_ror:2 row_mask:0xf bank_mask:0xf
  v_add_f32_dpp v32, v32, v32 row_ror:1 row_mask:0xf bank_mask:0xf
  v_add_f32_dpp v33, v33, v33 row_ror:1 row_mask:0xf bank_mask:0xf
  v_add_f32_dpp v34, v34, v34 row_ror:1 row_mask:0xf bank_mask:0xf
  v_add_f32_dpp v35, v35, v35 row_ror:1 row_mask:0xf bank_mask:0xf
  v_add_f32_dpp v36, v36, v36 row_ror:1 row_mask:0xf bank_mask:0xf
  v_add_f32_dpp v37, v37, v37 row_ror:1 row_mask:0xf bank_mask:0xf
  v_add_f32_dpp v38, v38, v38 row_ror:1 row_mask:0xf bank_mask:0xf
  v_add_f32_dpp v39, v39, v39 row_ror:1 row_mask:0xf bank_mask:0xf
  v_add_f32_dpp v40, v40, v40 row_ror:1 row_mask:0xf bank_mask:0xf
  v_add_f32_dpp v41, v41, v41 row_ror:1 row_mask:0xf bank_mask:0xf
  v_add_f32_dpp v42, v42, v42 row_ror:1 row_mask:0xf bank_mask:0xf
  v_add_f32_dpp v43, v43, v43 row_ror:1 row_mask:0xf bank_mask:0xf
  v_add_f32_dpp v44, v44, v44 row_ror:1 row_mask:0xf bank_mask:0xf
  v_add_f32_dpp v45, v45, v45 row_ror:1 row_mask:0xf bank_mask:0xf
  v_add_f32_dpp v46, v46, v46 row_ror:1 row_mask:0xf bank_mask:0xf
  v_add_f32_dpp v47, v47, v47 row_ror:1 row_mask:0xf bank_mask:0xf
  v_mov_b32 v24, v32
  v_cmp_eq_u32 vcc, 1, v2
  s_nop 1
  v_cndmask_b32 v24, v24, v33, vcc
  v_cmp_eq_u32 vcc, 2, v2
  s_nop 1
  v_cndmask_b32 v24, v24, v34, vcc
  v_cmp_eq_u32 vcc, 3, v2
  s_nop 1
  v_cndmask_b32 v24, v24, v35, vcc
  v_cmp_eq_u32 vcc, 4, v2
  s_nop 1
  v_cndmask_b32 v24, v24, v36, vcc
  v_cmp_eq_u32 vcc, 5, v2
  s_nop 1
  v_cndmask_b32 v24, v24, v37, vcc
  v_cmp_eq_u32 vcc, 6, v2
  s_nop 1
  v_cndmask_b32 v24, v24, v38, vcc
  v_cmp_eq_u32 vcc, 7, v2
  s_nop 1
  v_cndmask_b32 v24, v24, v39, vcc
  v_cmp_eq_u32 vcc, 8, v2
  s_nop 1
  v_cndmask_b32 v24, v24, v40, vcc
  v_cmp_eq_u32 vcc, 9, v2
  s_nop 1
  v_cndmask_b32 v24, v24, v41, vcc
  v_cmp_eq_u32 vcc, 10, v2
  s_nop 1
  v_cndmask_b32 v24, v24, v42, vcc
  v_cmp_eq_u32 vcc, 11, v2
  s_nop 1
  v_cndmask_b32 v24, v24, v43, vcc
  v_cmp_eq_u32 vcc, 12, v2
  s_nop 1
  v_cndmask_b32 v24, v24, v44, vcc
  v_cmp_eq_u32 vcc, 13, v2
  s_nop 1
  v_cndmask_b32 v24, v24, v45, vcc
  v_cmp_eq_u32 vcc, 14, v2
  s_nop 1
  v_cndmask_b32 v24, v24, v46, vcc
  v_cmp_eq_u32 vcc, 15, v2
  s_nop 1
  v_cndmask_b32 v24, v24, v47, vcc
  v_mov_b32 v25, v24
  s_nop 1
  v_permlane32_swap_b32 v24, v25
  v_add_f32 v24, v24, v25
  v_mov_b32 v25, v24
  s_nop 1
  v_permlane16_swap_b32 v24, v25
  v_add_f32 v24, v24, v25
  v_cvt_pk_bf16_f32 v25, v24, v24
  v_lshlrev_b32 v24, 16, v25
  v_mul_f32 v24, 0xbfb8aa3b, v24
  v_exp_f32 v24, v24
  s_nop 0
  v_add_f32 v24, 1.0, v24
  v_rcp_f32 v24, v24
  s_nop 0
  v_cvt_pk_bf16_f32 v25, v24, v24
  v_lshlrev_b32 v24, 16, v25
  s_lshl_b32 s21, s59, 2
  s_mov_b64 exec, 0xffff
  buffer_store_dword v24, v10, s[76:79], s21 offen sc1
  s_mov_b64 exec, -1
qg_260:
  s_waitcnt vmcnt(45)
  s_barrier
  ds_read_b64_tr_b16 a[0:1], v7 offset:0
  ds_read_b64_tr_b16 a[2:3], v7 offset:1536
  ds_read_b64_tr_b16 a[4:5], v7 offset:32
  ds_read_b64_tr_b16 a[6:7], v7 offset:1568
  ds_read_b64_tr_b16 a[8:9], v7 offset:64
  ds_read_b64_tr_b16 a[10:11], v7 offset:1600
  ds_read_b64_tr_b16 a[12:13], v7 offset:12288
  ds_read_b64_tr_b16 a[14:15], v7 offset:13824
  ds_read_b64_tr_b16 a[16:17], v7 offset:12320
  ds_read_b64_tr_b16 a[18:19], v7 offset:13856
  ds_read_b64_tr_b16 a[20:21], v7 offset:12352
  ds_read_b64_tr_b16 a[22:23], v7 offset:13888
  ds_read_b64_tr_b16 a[24:25], v7 offset:24576
  ds_read_b64_tr_b16 a[26:27], v7 offset:26112
  ds_read_b64_tr_b16 a[28:29], v7 offset:24608
  ds_read_b64_tr_b16 a[30:31], v7 offset:26144
  ds_read_b64_tr_b16 a[32:33], v7 offset:24640
  ds_read_b64_tr_b16 a[34:35], v7 offset:26176
  ds_read_b64_tr_b16 a[36:37], v7 offset:36864
  ds_read_b64_tr_b16 a[38:39], v7 offset:38400
  ds_read_b64_tr_b16 a[40:41], v7 offset:36896
  ds_read_b64_tr_b16 a[42:43], v7 offset:38432
  ds_read_b64_tr_b16 a[44:45], v7 offset:36928
  ds_read_b64_tr_b16 a[46:47], v7 offset:38464
  ds_read_b64_tr_b16 a[48:49], v7 offset:49152
  ds_read_b64_tr_b16 a[50:51], v7 offset:50688
  ds_read_b64_tr_b16 a[52:53], v7 offset:49184
  ds_read_b64_tr_b16 a[54:55], v7 offset:50720
  ds_read_b64_tr_b16 a[56:57], v7 offset:49216
  ds_read_b64_tr_b16 a[58:59], v7 offset:50752
  s_waitcnt lgkmcnt(0)
  s_barrier
  s_waitcnt vmcnt(30)
  s_barrier
  ds_read_b64_tr_b16 a[60:61], v8 offset:0
  ds_read_b64_tr_b16 a[62:63], v8 offset:1536
  ds_read_b64_tr_b16 a[64:65], v8 offset:32
  ds_read_b64_tr_b16 a[66:67], v8 offset:1568
  ds_read_b64_tr_b16 a[68:69], v8 offset:64
  ds_read_b64_tr_b16 a[70:71], v8 offset:1600
  ds_read_b64_tr_b16 a[72:73], v8 offset:12288
  ds_read_b64_tr_b16 a[74:75], v8 offset:13824
  ds_read_b64_tr_b16 a[76:77], v8 offset:12320
  ds_read_b64_tr_b16 a[78:79], v8 offset:13856
  ds_read_b64_tr_b16 a[80:81], v8 offset:12352
  ds_read_b64_tr_b16 a[82:83], v8 offset:13888
  ds_read_b64_tr_b16 a[84:85], v8 offset:24576
  ds_read_b64_tr_b16 a[86:87], v8 offset:26112
  ds_read_b64_tr_b16 a[88:89], v8 offset:24608
  ds_read_b64_tr_b16 a[90:91], v8 offset:26144
  ds_read_b64_tr_b16 a[92:93], v8 offset:24640
  ds_read_b64_tr_b16 a[94:95], v8 offset:26176
  ds_read_b64_tr_b16 a[96:97], v8 offset:36864
  ds_read_b64_tr_b16 a[98:99], v8 offset:38400
  ds_read_b64_tr_b16 a[100:101], v8 offset:36896
  ds_read_b64_tr_b16 a[102:103], v8 offset:38432
  ds_read_b64_tr_b16 a[104:105], v8 offset:36928
  ds_read_b64_tr_b16 a[106:107], v8 offset:38464
  ds_read_b64_tr_b16 a[108:109], v8 offset:49152
  ds_read_b64_tr_b16 a[110:111], v8 offset:50688
  ds_read_b64_tr_b16 a[112:113], v8 offset:49184
  ds_read_b64_tr_b16 a[114:115], v8 offset:50720
  ds_read_b64_tr_b16 a[116:117], v8 offset:49216
  ds_read_b64_tr_b16 a[118:119], v8 offset:50752
  s_waitcnt lgkmcnt(0)
  s_barrier
  s_waitcnt vmcnt(15)
  ds_write_b128 v30, v[64:67] offset:0
  ds_write_b128 v30, v[68:71] offset:1024
  ds_write_b128 v30, v[72:75] offset:2048
  ds_write_b128 v30, v[76:79] offset:3072
  ds_write_b128 v30, v[80:83] offset:4096
  ds_write_b128 v30, v[84:87] offset:5120
  ds_write_b128 v30, v[88:91] offset:6144
  ds_write_b128 v30, v[92:95] offset:7168
  ds_write_b128 v30, v[96:99] offset:8192
  ds_write_b128 v30, v[100:103] offset:9216
  ds_write_b128 v30, v[104:107] offset:10240
  ds_write_b128 v30, v[108:111] offset:11264
  ds_write_b128 v30, v[112:115] offset:12288
  ds_write_b128 v30, v[116:119] offset:13312
  ds_write_b128 v30, v[120:123] offset:14336
  s_waitcnt lgkmcnt(0)
  s_barrier
  ds_read_b64_tr_b16 a[120:121], v7 offset:0
  ds_read_b64_tr_b16 a[122:123], v7 offset:1536
  ds_read_b64_tr_b16 a[124:125], v7 offset:32
  ds_read_b64_tr_b16 a[126:127], v7 offset:1568
  ds_read_b64_tr_b16 a[128:129], v7 offset:64
  ds_read_b64_tr_b16 a[130:131], v7 offset:1600
  ds_read_b64_tr_b16 a[132:133], v7 offset:12288
  ds_read_b64_tr_b16 a[134:135], v7 offset:13824
  ds_read_b64_tr_b16 a[136:137], v7 offset:12320
  ds_read_b64_tr_b16 a[138:139], v7 offset:13856
  ds_read_b64_tr_b16 a[140:141], v7 offset:12352
  ds_read_b64_tr_b16 a[142:143], v7 offset:13888
  ds_read_b64_tr_b16 a[144:145], v7 offset:24576
  ds_read_b64_tr_b16 a[146:147], v7 offset:26112
  ds_read_b64_tr_b16 a[148:149], v7 offset:24608
  ds_read_b64_tr_b16 a[150:151], v7 offset:26144
  ds_read_b64_tr_b16 a[152:153], v7 offset:24640
  ds_read_b64_tr_b16 a[154:155], v7 offset:26176
  ds_read_b64_tr_b16 a[156:157], v7 offset:36864
  ds_read_b64_tr_b16 a[158:159], v7 offset:38400
  ds_read_b64_tr_b16 a[160:161], v7 offset:36896
  ds_read_b64_tr_b16 a[162:163], v7 offset:38432
  ds_read_b64_tr_b16 a[164:165], v7 offset:36928
  ds_read_b64_tr_b16 a[166:167], v7 offset:38464
  ds_read_b64_tr_b16 a[168:169], v7 offset:49152
  ds_read_b64_tr_b16 a[170:171], v7 offset:50688
  ds_read_b64_tr_b16 a[172:173], v7 offset:49184
  ds_read_b64_tr_b16 a[174:175], v7 offset:50720
  ds_read_b64_tr_b16 a[176:177], v7 offset:49216
  ds_read_b64_tr_b16 a[178:179], v7 offset:50752
  s_waitcnt lgkmcnt(0)
  s_barrier
  s_waitcnt vmcnt(0)
  ds_write_b128 v31, v[124:127] offset:0
  ds_write_b128 v31, v[128:131] offset:1024
  ds_write_b128 v31, v[132:135] offset:2048
  ds_write_b128 v31, v[136:139] offset:3072
  ds_write_b128 v31, v[140:143] offset:4096
  ds_write_b128 v31, v[144:147] offset:5120
  ds_write_b128 v31, v[148:151] offset:6144
  ds_write_b128 v31, v[152:155] offset:7168
  ds_write_b128 v31, v[156:159] offset:8192
  ds_write_b128 v31, v[160:163] offset:9216
  ds_write_b128 v31, v[164:167] offset:10240
  ds_write_b128 v31, v[168:171] offset:11264
  ds_write_b128 v31, v[172:175] offset:12288
  ds_write_b128 v31, v[176:179] offset:13312
  ds_write_b128 v31, v[180:183] offset:14336
  s_waitcnt lgkmcnt(0)
  s_barrier
  ds_read_b64_tr_b16 a[180:181], v8 offset:0
  ds_read_b64_tr_b16 a[182:183], v8 offset:1536
  ds_read_b64_tr_b16 a[184:185], v8 offset:32
  ds_read_b64_tr_b16 a[186:187], v8 offset:1568
  ds_read_b64_tr_b16 a[188:189], v8 offset:64
  ds_read_b64_tr_b16 a[190:191], v8 offset:1600
  ds_read_b64_tr_b16 a[192:193], v8 offset:12288
  ds_read_b64_tr_b16 a[194:195], v8 offset:13824
  ds_read_b64_tr_b16 a[196:197], v8 offset:12320
  ds_read_b64_tr_b16 a[198:199], v8 offset:13856
  ds_read_b64_tr_b16 a[200:201], v8 offset:12352
  ds_read_b64_tr_b16 a[202:203], v8 offset:13888
  ds_read_b64_tr_b16 a[204:205], v8 offset:24576
  ds_read_b64_tr_b16 a[206:207], v8 offset:26112
  ds_read_b64_tr_b16 a[208:209], v8 offset:24608
  ds_read_b64_tr_b16 a[210:211], v8 offset:26144
  ds_read_b64_tr_b16 a[212:213], v8 offset:24640
  ds_read_b64_tr_b16 a[214:215], v8 offset:26176
  ds_read_b64_tr_b16 a[216:217], v8 offset:36864
  ds_read_b64_tr_b16 a[218:219], v8 offset:38400
  ds_read_b64_tr_b16 a[220:221], v8 offset:36896
  ds_read_b64_tr_b16 a[222:223], v8 offset:38432
  ds_read_b64_tr_b16 a[224:225], v8 offset:36928
  ds_read_b64_tr_b16 a[226:227], v8 offset:38464
  ds_read_b64_tr_b16 a[228:229], v8 offset:49152
  ds_read_b64_tr_b16 a[230:231], v8 offset:50688
  ds_read_b64_tr_b16 a[232:233], v8 offset:49184
  ds_read_b64_tr_b16 a[234:235], v8 offset:50720
  ds_read_b64_tr_b16 a[236:237], v8 offset:49216
  ds_read_b64_tr_b16 a[238:239], v8 offset:50752
  s_waitcnt lgkmcnt(0)
  s_barrier
  s_and_b32 s21, s2, 3
  s_lshl_b32 s21, s21, 7
  s_add_u32 s21, s21, 29696
  s_xor_b32 s21, s21, s80
  s_cmp_lg_u32 s40, 0
  s_cbranch_scc1 qg_261
  s_cmp_lg_u32 s20, 0
  s_cbranch_scc1 af_262
  v_mov_b32 v8, 0
  v_mov_b32 v9, 1
  s_mov_b64 exec, 1
  buffer_atomic_add v9, v8, s[72:75], s21 offen sc1
  s_mov_b64 exec, -1
  s_nop 1
af_262:
qg_261:
  s_add_u32 s56, s38, 178257920
  s_addc_u32 s57, s39, 0
  s_mov_b32 s58, 3145728
  s_mov_b32 s59, 0x00020000
  s_sub_u32 s85, s41, 1
  s_mul_i32 s21, s85, 163840
  s_mul_i32 s30, s40, 163840
  s_add_u32 s30, s30, s21
  s_sub_u32 s25, 4294966144, s21
  s_mov_b32 s26, s41
  s_min_u32 s86, s40, 1
  s_lshl_b32 s86, s86, 5
  s_add_u32 s86, s86, s42
  s_mul_i32 s86, s86, 49152
  s_lshl_b32 s46, s40, 2
  s_add_u32 s46, s46, s20
  v_lshrrev_b32 v4, 3, v1
  v_and_b32 v5, 7, v1
  v_xor_b32 v5, v5, v4
  s_mul_i32 s21, s20, 32
  v_add_u32 v4, s21, v4
  v_mul_u32_u24 v4, 1280, v4
  v_lshl_add_u32 v10, v5, 4, v4
  s_mul_i32 s31, s20, 4096
  v_add_u32 v11, 10240, v10
  v_add_u32 v12, 20480, v10
  v_add_u32 v13, 30720, v10
  s_add_u32 m0, s31, 0
  s_nop 0
  buffer_load_dwordx4 v10, s[8:11], s30 offen lds
  s_add_u32 m0, s31, 1024
  s_nop 0
  buffer_load_dwordx4 v11, s[8:11], s30 offen lds
  s_add_u32 m0, s31, 2048
  s_nop 0
  buffer_load_dwordx4 v12, s[8:11], s30 offen lds
  s_add_u32 m0, s31, 3072
  s_nop 0
  buffer_load_dwordx4 v13, s[8:11], s30 offen lds
  s_add_u32 s30, s30, 128
  s_add_u32 m0, s31, 16384
  s_nop 0
  buffer_load_dwordx4 v10, s[8:11], s30 offen lds
  s_add_u32 m0, s31, 17408
  s_nop 0
  buffer_load_dwordx4 v11, s[8:11], s30 offen lds
  s_add_u32 m0, s31, 18432
  s_nop 0
  buffer_load_dwordx4 v12, s[8:11], s30 offen lds
  s_add_u32 m0, s31, 19456
  s_nop 0
  buffer_load_dwordx4 v13, s[8:11], s30 offen lds
  s_add_u32 s30, s30, 128
  s_add_u32 m0, s31, 32768
  s_nop 0
  buffer_load_dwordx4 v10, s[8:11], s30 offen lds
  s_add_u32 m0, s31, 33792
  s_nop 0
  buffer_load_dwordx4 v11, s[8:11], s30 offen lds
  s_add_u32 m0, s31, 34816
  s_nop 0
  buffer_load_dwordx4 v12, s[8:11], s30 offen lds
  s_add_u32 m0, s31, 35840
  s_nop 0
  buffer_load_dwordx4 v13, s[8:11], s30 offen lds
  s_add_u32 s30, s30, 128
  v_and_b32 v6, 7, v2
  v_add_u32 v4, 0, v3
  v_xor_b32 v4, v4, v6
  v_lshlrev_b32 v4, 4, v4
  v_lshl_add_u32 v14, v2, 7, v4
  v_add_u32 v16, 65536, v14
  v_add_u32 v18, 131072, v14
  v_add_u32 v4, 4, v3
  v_xor_b32 v4, v4, v6
  v_lshlrev_b32 v4, 4, v4
  v_lshl_add_u32 v15, v2, 7, v4
  v_add_u32 v17, 65536, v15
  v_add_u32 v19, 131072, v15
  v_lshlrev_b32 v26, 4, v1
  v_mov_b32 v28, 1
  v_mov_b32 v4, 0x40000000
  v_cmp_eq_u32 vcc, 0, v0
  s_nop 1
  v_cndmask_b32 v27, v4, 0, vcc
  s_mul_i32 s21, s20, 3072
  s_add_u32 s21, s21, 81920
  v_add_u32 v20, s21, v26
  s_mul_i32 s21, s20, 12288
  s_add_u32 s21, s21, 81920
  v_add_u32 v21, s21, v26
  v_add_u32 v22, 2048, v21
  v_add_u32 v23, 2056, v21
  v_and_b32 v4, 7, v2
  v_lshlrev_b32 v4, 4, v4
  v_lshl_add_u32 v24, v3, 7, v4
  v_lshrrev_b32 v25, 1, v24
  v_lshlrev_b32 v29, 3, v1
  v_and_b32 v4, 3, v1
  v_lshlrev_b32 v30, 3, v4
  v_mov_b32 v31, 0xf149f2ca
  v_mov_b32 v32, 0
  v_mov_b32 v4, 1073741824
  v_cmp_eq_u32 vcc, 0, v1
  v_lshlrev_b32 v5, 2, v3
  v_sub_u32 v5, v2, v5
  v_cndmask_b32 v33, v4, 0, vcc
  v_cmp_gt_u32 s[62:63], 2, v3
  s_mov_b32 s83, 0x3dd53b95
  s_lshl_b32 s77, s42, 7
  s_add_u32 s77, s77, 0
  s_xor_b32 s77, s77, s80
  s_lshl_b32 s45, s46, 21
  s_lshl_b32 s21, s46, 13
  s_and_b32 s21, s21, 8192
  s_xor_b32 s21, s21, s80
  s_add_u32 s45, s45, s21
  s_lshl_b32 s21, s42, 16
  s_add_u32 s45, s45, s21
  s_lshr_b32 s47, s42, 1
  s_lshl_b32 s47, s47, 14
  s_and_b32 s22, s42, 1
  s_mul_i32 s22, s22, 2560
  s_add_u32 s47, s47, s22
  s_lshl_b32 s21, s46, 19
  s_lshl_b32 s22, s46, 11
  s_and_b32 s22, s22, 8192
  s_xor_b32 s22, s22, s80
  s_add_u32 s21, s21, s22
  s_add_u32 s21, s21, 136314880
  s_xor_b32 s21, s21, 8192
  s_add_u32 s47, s47, s21
  s_add_u32 s47, s47, 48234496
  s_lshl_b32 s48, s46, 7
  s_add_u32 s48, s48, 8192
  s_xor_b32 s48, s48, s80
  s_add_u32 s43, s46, 1
  s_mov_b32 s49, 0
  s_mov_b32 s50, 1073741824
  s_mov_b32 s81, 1073741824
  s_mov_b32 s82, 1073741824
  s_mov_b32 s84, 1073741824
  v_cmp_le_i32 s[64:65], 0, v5
  v_cmp_le_i32 s[66:67], 1, v5
  v_cmp_le_i32 s[68:69], 2, v5
  v_cmp_le_i32 s[70:71], 3, v5
  s_waitcnt vmcnt(8)
  s_barrier
  ds_read_b128 v[160:163], v14 offset:0
  ds_read_b128 v[164:167], v14 offset:2048
  ds_read_b128 v[168:171], v14 offset:4096
  ds_read_b128 v[172:175], v14 offset:6144
  s_waitcnt lgkmcnt(3)
  .p2align 3
qa_267:
  v_mfma_f32_16x16x32_bf16 v[64:67], a[0:3], v[160:163], 0
  ds_read_b128 v[176:179], v14 offset:8192
  v_cvt_pk_bf16_f32 v221, v126, v127
  v_mfma_f32_16x16x32_bf16 v[68:71], a[4:7], v[160:163], 0
  v_cvt_pk_bf16_f32 v222, v128, v129
  v_cvt_pk_bf16_f32 v223, v130, v131
  v_mfma_f32_16x16x32_bf16 v[72:75], a[8:11], v[160:163], 0
  s_waitcnt lgkmcnt(3)
  v_cvt_pk_bf16_f32 v226, v132, v133
  v_cvt_pk_bf16_f32 v227, v134, v135
  v_mfma_f32_16x16x32_bf16 v[76:79], a[0:3], v[164:167], 0
  ds_read_b128 v[180:183], v14 offset:10240
  v_cvt_pk_bf16_f32 v228, v136, v137
  v_mfma_f32_16x16x32_bf16 v[80:83], a[4:7], v[164:167], 0
  v_cvt_pk_bf16_f32 v229, v138, v139
  v_cvt_pk_bf16_f32 v230, v140, v141
  v_mfma_f32_16x16x32_bf16 v[84:87], a[8:11], v[164:167], 0
  s_waitcnt lgkmcnt(3)
  v_cvt_pk_bf16_f32 v231, v142, v143
  v_cvt_pk_bf16_f32 v236, v144, v145
  v_mfma_f32_16x16x32_bf16 v[88:91], a[0:3], v[168:171], 0
  ds_read_b128 v[184:187], v14 offset:12288
  v_cvt_pk_bf16_f32 v237, v146, v147
  v_mfma_f32_16x16x32_bf16 v[92:95], a[4:7], v[168:171], 0
  v_cvt_pk_bf16_f32 v232, v148, v149
  v_cvt_pk_bf16_f32 v233, v150, v151
  v_mfma_f32_16x16x32_bf16 v[96:99], a[8:11], v[168:171], 0
  s_waitcnt lgkmcnt(3)
  v_cvt_pk_bf16_f32 v234, v152, v153
  v_cvt_pk_bf16_f32 v235, v154, v155
  v_mfma_f32_16x16x32_bf16 v[100:103], a[0:3], v[172:175], 0
  ds_read_b128 v[188:191], v14 offset:14336
  v_cvt_pk_bf16_f32 v238, v156, v157
  v_mfma_f32_16x16x32_bf16 v[104:107], a[4:7], v[172:175], 0
  v_cvt_pk_bf16_f32 v239, v158, v159
  ds_write_b128 v20, v[192:195] offset:0
  v_mfma_f32_16x16x32_bf16 v[108:111], a[8:11], v[172:175], 0
  s_waitcnt lgkmcnt(4)
  v_mfma_f32_16x16x32_bf16 v[112:115], a[0:3], v[176:179], 0
  ds_read_b128 v[160:163], v15 offset:0
  s_waitcnt vmcnt(4)
  v_mfma_f32_16x16x32_bf16 v[116:119], a[4:7], v[176:179], 0
  s_add_u32 m0, s31, 49152
  v_cmp_gt_u32 vcc, s49, v32
  v_mfma_f32_16x16x32_bf16 v[120:123], a[8:11], v[176:179], 0
  s_waitcnt lgkmcnt(4)
  buffer_load_dwordx4 v10, s[8:11], s30 offen lds
  s_cbranch_vccnz qw_268
qj_269:
  v_mfma_f32_16x16x32_bf16 v[124:127], a[0:3], v[180:183], 0
  s_add_u32 s29, s50, 4096
  ds_read_b128 v[164:167], v15 offset:2048
  ds_write_b128 v20, v[196:199] offset:1024
  v_mfma_f32_16x16x32_bf16 v[128:131], a[4:7], v[180:183], 0
  v_mfma_f32_16x16x32_bf16 v[132:135], a[8:11], v[180:183], 0
  s_waitcnt lgkmcnt(5)
  buffer_load_dwordx4 a[240:243], v24, s[16:19], s29 offen offset:2560 sc1
  v_mfma_f32_16x16x32_bf16 v[136:139], a[0:3], v[184:187], 0
  ds_read_b128 v[168:171], v15 offset:4096
  v_mfma_f32_16x16x32_bf16 v[140:143], a[4:7], v[184:187], 0
  s_add_u32 m0, s31, 50176
  v_mfma_f32_16x16x32_bf16 v[144:147], a[8:11], v[184:187], 0
  s_waitcnt lgkmcnt(5)
  buffer_load_dwordx4 v11, s[8:11], s30 offen lds
  ds_write_b128 v20, v[200:203] offset:2048
  v_mfma_f32_16x16x32_bf16 v[148:151], a[0:3], v[188:191], 0
  ds_read_b128 v[172:175], v15 offset:6144
  v_mfma_f32_16x16x32_bf16 v[152:155], a[4:7], v[188:191], 0
  v_mfma_f32_16x16x32_bf16 v[156:159], a[8:11], v[188:191], 0
  s_waitcnt lgkmcnt(5)
  buffer_load_dwordx2 v[240:241], v25, s[16:19], s29 offen offset:3072 sc1
  s_add_u32 s29, s50, 20480
  v_mfma_f32_16x16x32_bf16 v[64:67], a[12:15], v[160:163], v[64:67]
  ds_read_b128 v[176:179], v15 offset:8192
  v_mfma_f32_16x16x32_bf16 v[68:71], a[16:19], v[160:163], v[68:71]
  s_add_u32 m0, s31, 51200
  ds_write_b128 v20, v[204:207] offset:12288
  v_mfma_f32_16x16x32_bf16 v[72:75], a[20:23], v[160:163], v[72:75]
  s_waitcnt lgkmcnt(6)
  buffer_load_dwordx4 v12, s[8:11], s30 offen lds
  v_mfma_f32_16x16x32_bf16 v[76:79], a[12:15], v[164:167], v[76:79]
  ds_read_b128 v[180:183], v15 offset:10240
  v_mfma_f32_16x16x32_bf16 v[80:83], a[16:19], v[164:167], v[80:83]
  v_mfma_f32_16x16x32_bf16 v[84:87], a[20:23], v[164:167], v[84:87]
  s_waitcnt lgkmcnt(5)
  buffer_load_dwordx4 a[244:247], v24, s[16:19], s29 offen offset:2560 sc1
  v_mfma_f32_16x16x32_bf16 v[88:91], a[12:15], v[168:171], v[88:91]
  ds_read_b128 v[184:187], v15 offset:12288
  ds_write_b128 v20, v[208:211] offset:13312
  v_mfma_f32_16x16x32_bf16 v[92:95], a[16:19], v[168:171], v[92:95]
  s_add_u32 m0, s31, 52224
  v_mfma_f32_16x16x32_bf16 v[96:99], a[20:23], v[168:171], v[96:99]
  s_waitcnt lgkmcnt(5)
  buffer_load_dwordx4 v13, s[8:11], s30 offen lds
  v_mfma_f32_16x16x32_bf16 v[100:103], a[12:15], v[172:175], v[100:103]
  s_add_u32 s30, s30, 128
  ds_read_b128 v[188:191], v15 offset:14336
  v_mfma_f32_16x16x32_bf16 v[104:107], a[16:19], v[172:175], v[104:107]
  v_mfma_f32_16x16x32_bf16 v[108:111], a[20:23], v[172:175], v[108:111]
  s_waitcnt lgkmcnt(5)
  ds_write_b128 v20, v[212:215] offset:14336
  v_mfma_f32_16x16x32_bf16 v[112:115], a[12:15], v[176:179], v[112:115]
  s_waitcnt vmcnt(11)
  s_barrier
  ds_read_b128 v[160:163], v14 offset:16384
  v_mfma_f32_16x16x32_bf16 v[116:119], a[16:19], v[176:179], v[116:119]
  s_waitcnt vmcnt(13)
  buffer_atomic_add v28, v33, s[72:75], s84 offen sc1
  v_mfma_f32_16x16x32_bf16 v[120:123], a[20:23], v[176:179], v[120:123]
  s_waitcnt lgkmcnt(5)
  v_mfma_f32_16x16x32_bf16 v[124:127], a[12:15], v[180:183], v[124:127]
  ds_read_b128 v[164:167], v14 offset:18432
  v_mfma_f32_16x16x32_bf16 v[128:131], a[16:19], v[180:183], v[128:131]
  ds_write_b128 v20, v[216:219] offset:24576
  buffer_load_dwordx2 v[242:243], v25, s[16:19], s29 offen offset:3072 sc1
  v_mfma_f32_16x16x32_bf16 v[132:135], a[20:23], v[180:183], v[132:135]
  s_add_u32 s29, s50, 36864
  s_waitcnt lgkmcnt(6)
  v_mfma_f32_16x16x32_bf16 v[136:139], a[12:15], v[184:187], v[136:139]
  ds_read_b128 v[168:171], v14 offset:20480
  v_mfma_f32_16x16x32_bf16 v[140:143], a[16:19], v[184:187], v[140:143]
  buffer_load_dwordx4 a[248:251], v24, s[16:19], s29 offen offset:2560 sc1
  v_mfma_f32_16x16x32_bf16 v[144:147], a[20:23], v[184:187], v[144:147]
  s_waitcnt lgkmcnt(5)
  v_mfma_f32_16x16x32_bf16 v[148:151], a[12:15], v[188:191], v[148:151]
  ds_read_b128 v[172:175], v14 offset:22528
  ds_write_b128 v20, v[220:223] offset:25600
  v_mfma_f32_16x16x32_bf16 v[152:155], a[16:19], v[188:191], v[152:155]
  buffer_load_dwordx2 v[244:245], v25, s[16:19], s29 offen offset:3072 sc1
  s_add_u32 s29, s50, 53248
  v_mfma_f32_16x16x32_bf16 v[156:159], a[20:23], v[188:191], v[156:159]
  s_waitcnt lgkmcnt(5)
  v_mfma_f32_16x16x32_bf16 v[64:67], a[24:27], v[160:163], v[64:67]
  ds_read_b128 v[176:179], v14 offset:24576
  v_mfma_f32_16x16x32_bf16 v[68:71], a[28:31], v[160:163], v[68:71]
  s_add_u32 m0, s31, 65536
  v_mfma_f32_16x16x32_bf16 v[72:75], a[32:35], v[160:163], v[72:75]
  s_waitcnt lgkmcnt(5)
  buffer_load_dwordx4 v10, s[8:11], s30 offen lds
  ds_write_b128 v20, v[224:227] offset:26624
  v_mfma_f32_16x16x32_bf16 v[76:79], a[24:27], v[164:167], v[76:79]
  ds_read_b128 v[180:183], v14 offset:26624
  v_mfma_f32_16x16x32_bf16 v[80:83], a[28:31], v[164:167], v[80:83]
  v_mfma_f32_16x16x32_bf16 v[84:87], a[32:35], v[164:167], v[84:87]
  s_waitcnt lgkmcnt(5)
  buffer_load_dwordx4 a[252:255], v24, s[16:19], s29 offen offset:2560 sc1
  v_mfma_f32_16x16x32_bf16 v[88:91], a[24:27], v[168:171], v[88:91]
  ds_read_b128 v[184:187], v14 offset:28672
  v_mfma_f32_16x16x32_bf16 v[92:95], a[28:31], v[168:171], v[92:95]
  ds_write_b128 v20, v[228:231] offset:36864
  v_mfma_f32_16x16x32_bf16 v[96:99], a[32:35], v[168:171], v[96:99]
  s_waitcnt lgkmcnt(6)
  buffer_load_dwordx2 v[246:247], v25, s[16:19], s29 offen offset:3072 sc1
  v_mfma_f32_16x16x32_bf16 v[100:103], a[24:27], v[172:175], v[100:103]
  ds_read_b128 v[188:191], v14 offset:30720
  v_mfma_f32_16x16x32_bf16 v[104:107], a[28:31], v[172:175], v[104:107]
  s_add_u32 m0, s31, 66560
  v_mfma_f32_16x16x32_bf16 v[108:111], a[32:35], v[172:175], v[108:111]
  s_waitcnt lgkmcnt(5)
  buffer_load_dwordx4 v11, s[8:11], s30 offen lds
  v_mfma_f32_16x16x32_bf16 v[112:115], a[24:27], v[176:179], v[112:115]
  ds_read_b128 v[160:163], v15 offset:16384
  ds_write_b128 v20, v[232:235] offset:37888
  v_mfma_f32_16x16x32_bf16 v[116:119], a[28:31], v[176:179], v[116:119]
  v_mfma_f32_16x16x32_bf16 v[120:123], a[32:35], v[176:179], v[120:123]
  s_waitcnt lgkmcnt(5)
  v_mfma_f32_16x16x32_bf16 v[124:127], a[24:27], v[180:183], v[124:127]
  ds_read_b128 v[164:167], v15 offset:18432
  v_mfma_f32_16x16x32_bf16 v[128:131], a[28:31], v[180:183], v[128:131]
  v_mfma_f32_16x16x32_bf16 v[132:135], a[32:35], v[180:183], v[132:135]
  s_waitcnt lgkmcnt(5)
  ds_write_b128 v20, v[236:239] offset:38912
  v_mfma_f32_16x16x32_bf16 v[136:139], a[24:27], v[184:187], v[136:139]
  ds_read_b128 v[168:171], v15 offset:20480
  v_mfma_f32_16x16x32_bf16 v[140:143], a[28:31], v[184:187], v[140:143]
  s_add_u32 m0, s31, 67584
  s_cmp_eq_u32 s26, s85
  s_cbranch_scc1 qs_265
qs_266:
  v_mfma_f32_16x16x32_bf16 v[144:147], a[32:35], v[184:187], v[144:147]
  s_waitcnt lgkmcnt(5)
  buffer_load_dwordx4 v12, s[8:11], s30 offen lds
  s_waitcnt lgkmcnt(1)
  v_mfma_f32_16x16x32_bf16 v[148:151], a[24:27], v[188:191], v[148:151]
  s_add_u32 s29, s50, 0
  ds_read_b128 v[172:175], v15 offset:22528
  v_mfma_f32_16x16x32_bf16 v[152:155], a[28:31], v[188:191], v[152:155]
  v_mfma_f32_16x16x32_bf16 v[156:159], a[32:35], v[188:191], v[156:159]
  s_waitcnt lgkmcnt(5)
  buffer_load_dwordx4 v[192:195], v26, s[16:19], s29 offen offset:0 sc1
  v_mfma_f32_16x16x32_bf16 v[64:67], a[36:39], v[160:163], v[64:67]
  ds_read_b128 v[176:179], v15 offset:24576
  v_mfma_f32_16x16x32_bf16 v[68:71], a[40:43], v[160:163], v[68:71]
  v_mfma_f32_16x16x32_bf16 v[72:75], a[44:47], v[160:163], v[72:75]
  s_waitcnt lgkmcnt(4)
  buffer_load_dwordx4 v[196:199], v26, s[16:19], s29 offen offset:1024 sc1
  v_mfma_f32_16x16x32_bf16 v[76:79], a[36:39], v[164:167], v[76:79]
  ds_read_b128 v[180:183], v15 offset:26624
  v_mfma_f32_16x16x32_bf16 v[80:83], a[40:43], v[164:167], v[80:83]
  s_add_u32 m0, s31, 68608
  v_mfma_f32_16x16x32_bf16 v[84:87], a[44:47], v[164:167], v[84:87]
  s_waitcnt lgkmcnt(3)
  buffer_load_dwordx4 v13, s[8:11], s30 offen lds
  v_mfma_f32_16x16x32_bf16 v[88:91], a[36:39], v[168:171], v[88:91]
  s_add_u32 s30, s30, 128
  ds_read_b128 v[184:187], v15 offset:28672
  v_mfma_f32_16x16x32_bf16 v[92:95], a[40:43], v[168:171], v[92:95]
  v_mfma_f32_16x16x32_bf16 v[96:99], a[44:47], v[168:171], v[96:99]
  s_waitcnt lgkmcnt(3)
  buffer_load_dwordx4 v[224:227], v26, s[16:19], s29 offen offset:2048 sc1
  s_add_u32 s29, s50, 16384
  v_mfma_f32_16x16x32_bf16 v[100:103], a[36:39], v[172:175], v[100:103]
  ds_read_b128 v[188:191], v15 offset:30720
  v_mfma_f32_16x16x32_bf16 v[104:107], a[40:43], v[172:175], v[104:107]
  v_mfma_f32_16x16x32_bf16 v[108:111], a[44:47], v[172:175], v[108:111]
  s_waitcnt lgkmcnt(3)
  buffer_load_dwordx4 v[200:203], v26, s[16:19], s29 offen offset:0 sc1
  v_mfma_f32_16x16x32_bf16 v[112:115], a[36:39], v[176:179], v[112:115]
  s_waitcnt vmcnt(21)
  s_barrier
  ds_read_b128 v[160:163], v14 offset:32768
  v_mfma_f32_16x16x32_bf16 v[116:119], a[40:43], v[176:179], v[116:119]
  v_mfma_f32_16x16x32_bf16 v[120:123], a[44:47], v[176:179], v[120:123]
  s_waitcnt lgkmcnt(3)
  buffer_load_dwordx4 v[204:207], v26, s[16:19], s29 offen offset:1024 sc1
  v_mfma_f32_16x16x32_bf16 v[124:127], a[36:39], v[180:183], v[124:127]
  ds_read_b128 v[164:167], v14 offset:34816
  v_mfma_f32_16x16x32_bf16 v[128:131], a[40:43], v[180:183], v[128:131]
  v_mfma_f32_16x16x32_bf16 v[132:135], a[44:47], v[180:183], v[132:135]
  s_waitcnt lgkmcnt(3)
  buffer_load_dwordx4 v[228:231], v26, s[16:19], s29 offen offset:2048 sc1
  s_add_u32 s29, s50, 32768
  v_mfma_f32_16x16x32_bf16 v[136:139], a[36:39], v[184:187], v[136:139]
  ds_read_b128 v[168:171], v14 offset:36864
  v_mfma_f32_16x16x32_bf16 v[140:143], a[40:43], v[184:187], v[140:143]
  v_mfma_f32_16x16x32_bf16 v[144:147], a[44:47], v[184:187], v[144:147]
  s_waitcnt lgkmcnt(3)
  buffer_load_dwordx4 v[208:211], v26, s[16:19], s29 offen offset:0 sc1
  v_mfma_f32_16x16x32_bf16 v[148:151], a[36:39], v[188:191], v[148:151]
  ds_read_b128 v[172:175], v14 offset:38912
  v_mfma_f32_16x16x32_bf16 v[152:155], a[40:43], v[188:191], v[152:155]
  v_mfma_f32_16x16x32_bf16 v[156:159], a[44:47], v[188:191], v[156:159]
  s_waitcnt lgkmcnt(3)
  buffer_load_dwordx4 v[212:215], v26, s[16:19], s29 offen offset:1024 sc1
  v_mfma_f32_16x16x32_bf16 v[64:67], a[48:51], v[160:163], v[64:67]
  ds_read_b128 v[176:179], v14 offset:40960
  v_mfma_f32_16x16x32_bf16 v[68:71], a[52:55], v[160:163], v[68:71]
  s_add_u32 m0, s31, 0
  v_mfma_f32_16x16x32_bf16 v[72:75], a[56:59], v[160:163], v[72:75]
  s_waitcnt lgkmcnt(3)
  buffer_load_dwordx4 v10, s[8:11], s30 offen lds
  v_mfma_f32_16x16x32_bf16 v[76:79], a[48:51], v[164:167], v[76:79]
  ds_read_b128 v[180:183], v14 offset:43008
  v_mfma_f32_16x16x32_bf16 v[80:83], a[52:55], v[164:167], v[80:83]
  v_mfma_f32_16x16x32_bf16 v[84:87], a[56:59], v[164:167], v[84:87]
  s_waitcnt lgkmcnt(3)
  buffer_load_dwordx4 v[232:235], v26, s[16:19], s29 offen offset:2048 sc1
  s_add_u32 s29, s50, 49152
  v_mfma_f32_16x16x32_bf16 v[88:91], a[48:51], v[168:171], v[88:91]
  ds_read_b128 v[184:187], v14 offset:45056
  v_mfma_f32_16x16x32_bf16 v[92:95], a[52:55], v[168:171], v[92:95]
  v_mfma_f32_16x16x32_bf16 v[96:99], a[56:59], v[168:171], v[96:99]
  s_waitcnt lgkmcnt(3)
  buffer_load_dwordx4 v[216:219], v26, s[16:19], s29 offen offset:0 sc1
  v_mfma_f32_16x16x32_bf16 v[100:103], a[48:51], v[172:175], v[100:103]
  ds_read_b128 v[188:191], v14 offset:47104
  v_mfma_f32_16x16x32_bf16 v[104:107], a[52:55], v[172:175], v[104:107]
  s_add_u32 m0, s31, 1024
  v_mfma_f32_16x16x32_bf16 v[108:111], a[56:59], v[172:175], v[108:111]
  s_waitcnt lgkmcnt(3)
  buffer_load_dwordx4 v11, s[8:11], s30 offen lds
  v_mfma_f32_16x16x32_bf16 v[112:115], a[48:51], v[176:179], v[112:115]
  ds_read_b128 v[160:163], v15 offset:32768
  v_mfma_f32_16x16x32_bf16 v[116:119], a[52:55], v[176:179], v[116:119]
  v_mfma_f32_16x16x32_bf16 v[120:123], a[56:59], v[176:179], v[120:123]
  s_waitcnt lgkmcnt(3)
  buffer_load_dwordx4 v[220:223], v26, s[16:19], s29 offen offset:1024 sc1
  v_mfma_f32_16x16x32_bf16 v[124:127], a[48:51], v[180:183], v[124:127]
  ds_read_b128 v[164:167], v15 offset:34816
  v_mfma_f32_16x16x32_bf16 v[128:131], a[52:55], v[180:183], v[128:131]
  v_mfma_f32_16x16x32_bf16 v[132:135], a[56:59], v[180:183], v[132:135]
  s_waitcnt lgkmcnt(3)
  buffer_load_dwordx4 v[236:239], v26, s[16:19], s29 offen offset:2048 sc1
  v_mfma_f32_16x16x32_bf16 v[136:139], a[48:51], v[184:187], v[136:139]
  ds_read_b128 v[168:171], v15 offset:36864
  v_mfma_f32_16x16x32_bf16 v[140:143], a[52:55], v[184:187], v[140:143]
  s_add_u32 m0, s31, 2048
  v_mfma_f32_16x16x32_bf16 v[144:147], a[56:59], v[184:187], v[144:147]
  s_waitcnt lgkmcnt(3)
  buffer_load_dwordx4 v12, s[8:11], s30 offen lds
  v_mfma_f32_16x16x32_bf16 v[148:151], a[48:51], v[188:191], v[148:151]
  ds_read_b128 v[172:175], v15 offset:38912
  v_mfma_f32_16x16x32_bf16 v[152:155], a[52:55], v[188:191], v[152:155]
  v_mfma_f32_16x16x32_bf16 v[156:159], a[56:59], v[188:191], v[156:159]
  s_waitcnt lgkmcnt(3)
  v_mfma_f32_16x16x32_bf16 v[64:67], a[60:63], v[160:163], v[64:67]
  ds_read_b128 v[176:179], v15 offset:40960
  v_mfma_f32_16x16x32_bf16 v[68:71], a[64:67], v[160:163], v[68:71]
  v_mfma_f32_16x16x32_bf16 v[72:75], a[68:71], v[160:163], v[72:75]
  s_waitcnt lgkmcnt(3)
  v_mfma_f32_16x16x32_bf16 v[76:79], a[60:63], v[164:167], v[76:79]
  ds_read_b128 v[180:183], v15 offset:43008
  v_mfma_f32_16x16x32_bf16 v[80:83], a[64:67], v[164:167], v[80:83]
  s_add_u32 m0, s31, 3072
  v_mfma_f32_16x16x32_bf16 v[84:87], a[68:71], v[164:167], v[84:87]
  s_waitcnt lgkmcnt(3)
  buffer_load_dwordx4 v13, s[8:11], s30 offen lds
  v_mfma_f32_16x16x32_bf16 v[88:91], a[60:63], v[168:171], v[88:91]
  s_add_u32 s30, s30, 128
  ds_read_b128 v[184:187], v15 offset:45056
  v_mfma_f32_16x16x32_bf16 v[92:95], a[64:67], v[168:171], v[92:95]
  v_mfma_f32_16x16x32_bf16 v[96:99], a[68:71], v[168:171], v[96:99]
  s_waitcnt lgkmcnt(3)
  v_mfma_f32_16x16x32_bf16 v[100:103], a[60:63], v[172:175], v[100:103]
  ds_read_b128 v[188:191], v15 offset:47104
  v_mfma_f32_16x16x32_bf16 v[104:107], a[64:67], v[172:175], v[104:107]
  v_mfma_f32_16x16x32_bf16 v[108:111], a[68:71], v[172:175], v[108:111]
  s_waitcnt lgkmcnt(3)
  v_mfma_f32_16x16x32_bf16 v[112:115], a[60:63], v[176:179], v[112:115]
  s_waitcnt vmcnt(26)
  s_barrier
  ds_read_b128 v[160:163], v14 offset:49152
  v_mfma_f32_16x16x32_bf16 v[116:119], a[64:67], v[176:179], v[116:119]
  v_mfma_f32_16x16x32_bf16 v[120:123], a[68:71], v[176:179], v[120:123]
  s_waitcnt lgkmcnt(3)
  v_mfma_f32_16x16x32_bf16 v[124:127], a[60:63], v[180:183], v[124:127]
  ds_read_b128 v[164:167], v14 offset:51200
  v_mfma_f32_16x16x32_bf16 v[128:131], a[64:67], v[180:183], v[128:131]
  v_mfma_f32_16x16x32_bf16 v[132:135], a[68:71], v[180:183], v[132:135]
  s_waitcnt lgkmcnt(3)
  v_mfma_f32_16x16x32_bf16 v[136:139], a[60:63], v[184:187], v[136:139]
  ds_read_b128 v[168:171], v14 offset:53248
  v_mfma_f32_16x16x32_bf16 v[140:143], a[64:67], v[184:187], v[140:143]
  v_mfma_f32_16x16x32_bf16 v[144:147], a[68:71], v[184:187], v[144:147]
  s_waitcnt lgkmcnt(3)
  v_mfma_f32_16x16x32_bf16 v[148:151], a[60:63], v[188:191], v[148:151]
  ds_read_b128 v[172:175], v14 offset:55296
  v_mfma_f32_16x16x32_bf16 v[152:155], a[64:67], v[188:191], v[152:155]
  v_mfma_f32_16x16x32_bf16 v[156:159], a[68:71], v[188:191], v[156:159]
  s_waitcnt lgkmcnt(3)
  v_mfma_f32_16x16x32_bf16 v[64:67], a[72:75], v[160:163], v[64:67]
  ds_read_b128 v[176:179], v14 offset:57344
  v_mfma_f32_16x16x32_bf16 v[68:71], a[76:79], v[160:163], v[68:71]
  s_add_u32 m0, s31, 16384
  v_mfma_f32_16x16x32_bf16 v[72:75], a[80:83], v[160:163], v[72:75]
  s_waitcnt lgkmcnt(3)
  buffer_load_dwordx4 v10, s[8:11], s30 offen lds
  v_mfma_f32_16x16x32_bf16 v[76:79], a[72:75], v[164:167], v[76:79]
  ds_read_b128 v[180:183], v14 offset:59392
  v_mfma_f32_16x16x32_bf16 v[80:83], a[76:79], v[164:167], v[80:83]
  v_mfma_f32_16x16x32_bf16 v[84:87], a[80:83], v[164:167], v[84:87]
  s_waitcnt lgkmcnt(3)
  v_mfma_f32_16x16x32_bf16 v[88:91], a[72:75], v[168:171], v[88:91]
  ds_read_b128 v[184:187], v14 offset:61440
  v_mfma_f32_16x16x32_bf16 v[92:95], a[76:79], v[168:171], v[92:95]
  v_mfma_f32_16x16x32_bf16 v[96:99], a[80:83], v[168:171], v[96:99]
  s_waitcnt lgkmcnt(3)
  v_mfma_f32_16x16x32_bf16 v[100:103], a[72:75], v[172:175], v[100:103]
  ds_read_b128 v[188:191], v14 offset:63488
  v_mfma_f32_16x16x32_bf16 v[104:107], a[76:79], v[172:175], v[104:107]
  s_add_u32 m0, s31, 17408
  v_mfma_f32_16x16x32_bf16 v[108:111], a[80:83], v[172:175], v[108:111]
  s_waitcnt lgkmcnt(3)
  buffer_load_dwordx4 v11, s[8:11], s30 offen lds
  v_mfma_f32_16x16x32_bf16 v[112:115], a[72:75], v[176:179], v[112:115]
  ds_read_b128 v[160:163], v15 offset:49152
  v_mfma_f32_16x16x32_bf16 v[116:119], a[76:79], v[176:179], v[116:119]
  v_mfma_f32_16x16x32_bf16 v[120:123], a[80:83], v[176:179], v[120:123]
  s_waitcnt lgkmcnt(3)
  v_mfma_f32_16x16x32_bf16 v[124:127], a[72:75], v[180:183], v[124:127]
  ds_read_b128 v[164:167], v15 offset:51200
  v_mfma_f32_16x16x32_bf16 v[128:131], a[76:79], v[180:183], v[128:131]
  v_mfma_f32_16x16x32_bf16 v[132:135], a[80:83], v[180:183], v[132:135]
  s_waitcnt lgkmcnt(3)
  v_mfma_f32_16x16x32_bf16 v[136:139], a[72:75], v[184:187], v[136:139]
  ds_read_b128 v[168:171], v15 offset:53248
  v_mfma_f32_16x16x32_bf16 v[140:143], a[76:79], v[184:187], v[140:143]
  s_add_u32 m0, s31, 18432
  v_mfma_f32_16x16x32_bf16 v[144:147], a[80:83], v[184:187], v[144:147]
  s_waitcnt lgkmcnt(3)
  buffer_load_dwordx4 v12, s[8:11], s30 offen lds
  v_mfma_f32_16x16x32_bf16 v[148:151], a[72:75], v[188:191], v[148:151]
  ds_read_b128 v[172:175], v15 offset:55296
  v_mfma_f32_16x16x32_bf16 v[152:155], a[76:79], v[188:191], v[152:155]
  v_mfma_f32_16x16x32_bf16 v[156:159], a[80:83], v[188:191], v[156:159]
  s_waitcnt lgkmcnt(3)
  v_mfma_f32_16x16x32_bf16 v[64:67], a[84:87], v[160:163], v[64:67]
  ds_read_b128 v[176:179], v15 offset:57344
  v_mfma_f32_16x16x32_bf16 v[68:71], a[88:91], v[160:163], v[68:71]
  v_mfma_f32_16x16x32_bf16 v[72:75], a[92:95], v[160:163], v[72:75]
  s_waitcnt lgkmcnt(3)
  v_mfma_f32_16x16x32_bf16 v[76:79], a[84:87], v[164:167], v[76:79]
  ds_read_b128 v[180:183], v15 offset:59392
  v_mfma_f32_16x16x32_bf16 v[80:83], a[88:91], v[164:167], v[80:83]
  s_add_u32 m0, s31, 19456
  v_mfma_f32_16x16x32_bf16 v[84:87], a[92:95], v[164:167], v[84:87]
  s_waitcnt lgkmcnt(3)
  buffer_load_dwordx4 v13, s[8:11], s30 offen lds
  v_mfma_f32_16x16x32_bf16 v[88:91], a[84:87], v[168:171], v[88:91]
  s_add_u32 s30, s30, 128
  ds_read_b128 v[184:187], v15 offset:61440
  v_mfma_f32_16x16x32_bf16 v[92:95], a[88:91], v[168:171], v[92:95]
  v_mfma_f32_16x16x32_bf16 v[96:99], a[92:95], v[168:171], v[96:99]
  s_waitcnt lgkmcnt(3)
  v_mfma_f32_16x16x32_bf16 v[100:103], a[84:87], v[172:175], v[100:103]
  ds_read_b128 v[188:191], v15 offset:63488
  v_mfma_f32_16x16x32_bf16 v[104:107], a[88:91], v[172:175], v[104:107]
  v_mfma_f32_16x16x32_bf16 v[108:111], a[92:95], v[172:175], v[108:111]
  s_waitcnt lgkmcnt(3)
  v_mfma_f32_16x16x32_bf16 v[112:115], a[84:87], v[176:179], v[112:115]
  s_waitcnt vmcnt(18)
  s_barrier
  ds_read_b128 v[160:163], v16 offset:0
  v_mfma_f32_16x16x32_bf16 v[116:119], a[88:91], v[176:179], v[116:119]
  v_mfma_f32_16x16x32_bf16 v[120:123], a[92:95], v[176:179], v[120:123]
  s_waitcnt lgkmcnt(3)
  v_mfma_f32_16x16x32_bf16 v[124:127], a[84:87], v[180:183], v[124:127]
  ds_read_b128 v[164:167], v16 offset:2048
  v_mfma_f32_16x16x32_bf16 v[128:131], a[88:91], v[180:183], v[128:131]
  v_mfma_f32_16x16x32_bf16 v[132:135], a[92:95], v[180:183], v[132:135]
  s_waitcnt lgkmcnt(3)
  v_mfma_f32_16x16x32_bf16 v[136:139], a[84:87], v[184:187], v[136:139]
  ds_read_b128 v[168:171], v16 offset:4096
  v_mfma_f32_16x16x32_bf16 v[140:143], a[88:91], v[184:187], v[140:143]
  v_mfma_f32_16x16x32_bf16 v[144:147], a[92:95], v[184:187], v[144:147]
  s_waitcnt lgkmcnt(3)
  v_mfma_f32_16x16x32_bf16 v[148:151], a[84:87], v[188:191], v[148:151]
  ds_read_b128 v[172:175], v16 offset:6144
  v_mfma_f32_16x16x32_bf16 v[152:155], a[88:91], v[188:191], v[152:155]
  v_mfma_f32_16x16x32_bf16 v[156:159], a[92:95], v[188:191], v[156:159]
  s_waitcnt lgkmcnt(3)
  v_mfma_f32_16x16x32_bf16 v[64:67], a[96:99], v[160:163], v[64:67]
  ds_read_b128 v[176:179], v16 offset:8192
  v_mfma_f32_16x16x32_bf16 v[68:71], a[100:103], v[160:163], v[68:71]
  s_add_u32 m0, s31, 32768
  v_mfma_f32_16x16x32_bf16 v[72:75], a[104:107], v[160:163], v[72:75]
  s_waitcnt lgkmcnt(3)
  buffer_load_dwordx4 v10, s[8:11], s30 offen lds
  v_mfma_f32_16x16x32_bf16 v[76:79], a[96:99], v[164:167], v[76:79]
  ds_read_b128 v[180:183], v16 offset:10240
  v_mfma_f32_16x16x32_bf16 v[80:83], a[100:103], v[164:167], v[80:83]
  v_mfma_f32_16x16x32_bf16 v[84:87], a[104:107], v[164:167], v[84:87]
  s_waitcnt lgkmcnt(3)
  v_mfma_f32_16x16x32_bf16 v[88:91], a[96:99], v[168:171], v[88:91]
  ds_read_b128 v[184:187], v16 offset:12288
  v_mfma_f32_16x16x32_bf16 v[92:95], a[100:103], v[168:171], v[92:95]
  v_mfma_f32_16x16x32_bf16 v[96:99], a[104:107], v[168:171], v[96:99]
  s_waitcnt lgkmcnt(3)
  v_mfma_f32_16x16x32_bf16 v[100:103], a[96:99], v[172:175], v[100:103]
  ds_read_b128 v[188:191], v16 offset:14336
  v_mfma_f32_16x16x32_bf16 v[104:107], a[100:103], v[172:175], v[104:107]
  s_add_u32 m0, s31, 33792
  v_mfma_f32_16x16x32_bf16 v[108:111], a[104:107], v[172:175], v[108:111]
  s_waitcnt lgkmcnt(3)
  buffer_load_dwordx4 v11, s[8:11], s30 offen lds
  v_mfma_f32_16x16x32_bf16 v[112:115], a[96:99], v[176:179], v[112:115]
  ds_read_b128 v[160:163], v17 offset:0
  v_mfma_f32_16x16x32_bf16 v[116:119], a[100:103], v[176:179], v[116:119]
  v_mfma_f32_16x16x32_bf16 v[120:123], a[104:107], v[176:179], v[120:123]
  s_waitcnt lgkmcnt(3)
  v_mfma_f32_16x16x32_bf16 v[124:127], a[96:99], v[180:183], v[124:127]
  ds_read_b128 v[164:167], v17 offset:2048
  v_mfma_f32_16x16x32_bf16 v[128:131], a[100:103], v[180:183], v[128:131]
  v_mfma_f32_16x16x32_bf16 v[132:135], a[104:107], v[180:183], v[132:135]
  s_waitcnt lgkmcnt(3)
  v_mfma_f32_16x16x32_bf16 v[136:139], a[96:99], v[184:187], v[136:139]
  ds_read_b128 v[168:171], v17 offset:4096
  v_mfma_f32_16x16x32_bf16 v[140:143], a[100:103], v[184:187], v[140:143]
  s_add_u32 m0, s31, 34816
  v_mfma_f32_16x16x32_bf16 v[144:147], a[104:107], v[184:187], v[144:147]
  s_waitcnt lgkmcnt(3)
  buffer_load_dwordx4 v12, s[8:11], s30 offen lds
  v_mfma_f32_16x16x32_bf16 v[148:151], a[96:99], v[188:191], v[148:151]
  ds_read_b128 v[172:175], v17 offset:6144
  v_mfma_f32_16x16x32_bf16 v[152:155], a[100:103], v[188:191], v[152:155]
  v_mfma_f32_16x16x32_bf16 v[156:159], a[104:107], v[188:191], v[156:159]
  s_waitcnt lgkmcnt(3)
  v_mfma_f32_16x16x32_bf16 v[64:67], a[108:111], v[160:163], v[64:67]
  ds_read_b128 v[176:179], v17 offset:8192
  v_mfma_f32_16x16x32_bf16 v[68:71], a[112:115], v[160:163], v[68:71]
  v_mfma_f32_16x16x32_bf16 v[72:75], a[116:119], v[160:163], v[72:75]
  s_waitcnt lgkmcnt(3)
  v_mfma_f32_16x16x32_bf16 v[76:79], a[108:111], v[164:167], v[76:79]
  ds_read_b128 v[180:183], v17 offset:10240
  v_mfma_f32_16x16x32_bf16 v[80:83], a[112:115], v[164:167], v[80:83]
  s_add_u32 m0, s31, 35840
  v_mfma_f32_16x16x32_bf16 v[84:87], a[116:119], v[164:167], v[84:87]
  s_waitcnt lgkmcnt(3)
  buffer_load_dwordx4 v13, s[8:11], s30 offen lds
  v_mfma_f32_16x16x32_bf16 v[88:91], a[108:111], v[168:171], v[88:91]
  s_add_u32 s30, s30, 128
  ds_read_b128 v[184:187], v17 offset:12288
  v_mfma_f32_16x16x32_bf16 v[92:95], a[112:115], v[168:171], v[92:95]
  v_mfma_f32_16x16x32_bf16 v[96:99], a[116:119], v[168:171], v[96:99]
  s_waitcnt lgkmcnt(3)
  v_mfma_f32_16x16x32_bf16 v[100:103], a[108:111], v[172:175], v[100:103]
  ds_read_b128 v[188:191], v17 offset:14336
  v_mfma_f32_16x16x32_bf16 v[104:107], a[112:115], v[172:175], v[104:107]
  v_mfma_f32_16x16x32_bf16 v[108:111], a[116:119], v[172:175], v[108:111]
  s_waitcnt lgkmcnt(3)
  v_mfma_f32_16x16x32_bf16 v[112:115], a[108:111], v[176:179], v[112:115]
  s_waitcnt vmcnt(8)
  s_barrier
  ds_read_b128 v[160:163], v14 offset:0
  v_mfma_f32_16x16x32_bf16 v[116:119], a[112:115], v[176:179], v[116:119]
  v_mfma_f32_16x16x32_bf16 v[120:123], a[116:119], v[176:179], v[120:123]
  s_waitcnt lgkmcnt(3)
  v_mfma_f32_16x16x32_bf16 v[124:127], a[108:111], v[180:183], v[124:127]
  ds_read_b128 v[164:167], v14 offset:2048
  v_mfma_f32_16x16x32_bf16 v[128:131], a[112:115], v[180:183], v[128:131]
  v_mfma_f32_16x16x32_bf16 v[132:135], a[116:119], v[180:183], v[132:135]
  s_waitcnt lgkmcnt(3)
  v_mfma_f32_16x16x32_bf16 v[136:139], a[108:111], v[184:187], v[136:139]
  ds_read_b128 v[168:171], v14 offset:4096
  v_mfma_f32_16x16x32_bf16 v[140:143], a[112:115], v[184:187], v[140:143]
  v_mfma_f32_16x16x32_bf16 v[144:147], a[116:119], v[184:187], v[144:147]
  s_waitcnt lgkmcnt(3)
  v_mfma_f32_16x16x32_bf16 v[148:151], a[108:111], v[188:191], v[148:151]
  ds_read_b128 v[172:175], v14 offset:6144
  v_mfma_f32_16x16x32_bf16 v[152:155], a[112:115], v[188:191], v[152:155]
  v_mfma_f32_16x16x32_bf16 v[156:159], a[116:119], v[188:191], v[156:159]
  s_waitcnt lgkmcnt(3)
  v_mfma_f32_16x16x32_bf16 v[64:67], a[120:123], v[160:163], v[64:67]
  ds_read_b128 v[176:179], v14 offset:8192
  v_mfma_f32_16x16x32_bf16 v[68:71], a[124:127], v[160:163], v[68:71]
  s_add_u32 m0, s31, 49152
  v_mfma_f32_16x16x32_bf16 v[72:75], a[128:131], v[160:163], v[72:75]
  s_waitcnt lgkmcnt(3)
  buffer_load_dwordx4 v10, s[8:11], s30 offen lds
  v_mfma_f32_16x16x32_bf16 v[76:79], a[120:123], v[164:167], v[76:79]
  ds_read_b128 v[180:183], v14 offset:10240
  s_waitcnt vmcnt(11)
  v_mfma_f32_16x16x32_bf16 v[80:83], a[124:127], v[164:167], v[80:83]
  v_swap_b32 v226, v228
  v_swap_b32 v227, v229
  v_mfma_f32_16x16x32_bf16 v[84:87], a[128:131], v[164:167], v[84:87]
  s_waitcnt lgkmcnt(3)
  v_swap_b32 v234, v236
  v_swap_b32 v235, v237
  v_mfma_f32_16x16x32_bf16 v[88:91], a[120:123], v[168:171], v[88:91]
  ds_read_b128 v[184:187], v14 offset:12288
  v_mfma_f32_16x16x32_bf16 v[92:95], a[124:127], v[168:171], v[92:95]
  ds_read_b128 v[56:59], v21 offset:0
  ds_read_b128 v[60:63], v21 offset:1024
  v_mfma_f32_16x16x32_bf16 v[96:99], a[128:131], v[168:171], v[96:99]
  s_waitcnt lgkmcnt(5)
  v_mfma_f32_16x16x32_bf16 v[100:103], a[120:123], v[172:175], v[100:103]
  ds_read_b128 v[188:191], v14 offset:14336
  v_mfma_f32_16x16x32_bf16 v[104:107], a[124:127], v[172:175], v[104:107]
  s_add_u32 m0, s31, 50176
  v_mfma_f32_16x16x32_bf16 v[108:111], a[128:131], v[172:175], v[108:111]
  s_waitcnt lgkmcnt(5)
  buffer_load_dwordx4 v11, s[8:11], s30 offen lds
  v_mfma_f32_16x16x32_bf16 v[112:115], a[120:123], v[176:179], v[112:115]
  ds_read_b128 v[160:163], v15 offset:0
  v_mfma_f32_16x16x32_bf16 v[116:119], a[124:127], v[176:179], v[116:119]
  ds_read_b128 v[248:251], v21 offset:3072
  ds_read_b128 v[252:255], v21 offset:4096
  v_mfma_f32_16x16x32_bf16 v[120:123], a[128:131], v[176:179], v[120:123]
  s_waitcnt lgkmcnt(4)
  v_mfma_f32_16x16x32_bf16 v[36:39], v[192:195], v[56:59], 0
  v_mfma_f32_16x16x32_bf16 v[44:47], v[192:195], v[60:63], 0
  v_mfma_f32_16x16x32_bf16 v[48:51], v[196:199], v[60:63], 0
  v_mfma_f32_16x16x32_bf16 v[40:43], a[240:243], v[56:59], 0
  v_mfma_f32_16x16x32_bf16 v[52:55], a[240:243], v[60:63], 0
  s_waitcnt lgkmcnt(7)
  ds_read2st64_b64 v[56:59], v22 offset0:0 offset1:6
  ds_read2st64_b64 v[60:63], v23 offset0:0 offset1:6
  v_mfma_f32_16x16x32_bf16 v[124:127], a[120:123], v[180:183], v[124:127]
  ds_read_b128 v[164:167], v15 offset:2048
  v_mfma_f32_16x16x32_bf16 v[128:131], a[124:127], v[180:183], v[128:131]
  v_mfma_f32_16x16x32_bf16 v[132:135], a[128:131], v[180:183], v[132:135]
  s_waitcnt lgkmcnt(9)
  v_mfma_f32_16x16x32_bf16 v[136:139], a[120:123], v[184:187], v[136:139]
  ds_read_b128 v[168:171], v15 offset:4096
  v_mfma_f32_16x16x32_bf16 v[140:143], a[124:127], v[184:187], v[140:143]
  s_add_u32 m0, s31, 51200
  v_mfma_f32_16x16x32_bf16 v[144:147], a[128:131], v[184:187], v[144:147]
  s_waitcnt lgkmcnt(4)
  buffer_load_dwordx4 v12, s[8:11], s30 offen lds
  v_mfma_f32_16x16x32_bf16 v[36:39], v[200:203], v[248:251], v[36:39]
  v_mfma_f32_16x16x32_bf16 v[44:47], v[200:203], v[252:255], v[44:47]
  v_mfma_f32_16x16x32_bf16 v[48:51], v[204:207], v[252:255], v[48:51]
  v_mfma_f32_16x16x32_bf16 v[40:43], a[244:247], v[248:251], v[40:43]
  v_mfma_f32_16x16x32_bf16 v[52:55], a[244:247], v[252:255], v[52:55]
  s_waitcnt lgkmcnt(7)
  ds_read_b128 v[248:251], v21 offset:6144
  ds_read_b128 v[252:255], v21 offset:7168
  v_mfma_f32_16x16x32_bf16 v[148:151], a[120:123], v[188:191], v[148:151]
  ds_read_b128 v[172:175], v15 offset:6144
  v_mfma_f32_16x16x32_bf16 v[152:155], a[124:127], v[188:191], v[152:155]
  v_mfma_f32_16x16x32_bf16 v[156:159], a[128:131], v[188:191], v[156:159]
  s_waitcnt lgkmcnt(9)
  v_mfma_f32_16x16x32_bf16 v[64:67], a[132:135], v[160:163], v[64:67]
  ds_read_b128 v[176:179], v15 offset:8192
  v_mfma_f32_16x16x32_bf16 v[68:71], a[136:139], v[160:163], v[68:71]
  v_mfma_f32_16x16x32_bf16 v[72:75], a[140:143], v[160:163], v[72:75]
  s_waitcnt lgkmcnt(6)
  v_mfma_f32_16x16x32_bf16 v[36:39], v[224:227], v[56:59], v[36:39]
  v_mfma_f32_16x16x32_bf16 v[44:47], v[224:227], v[60:63], v[44:47]
  v_mfma_f32_16x16x32_bf16 v[48:51], v[228:231], v[60:63], v[48:51]
  v_mfma_f32_16x16x32_bf16 v[40:43], v[240:243], v[56:59], v[40:43]
  v_mfma_f32_16x16x32_bf16 v[52:55], v[240:243], v[60:63], v[52:55]
  s_waitcnt lgkmcnt(5)
  ds_read_b128 v[56:59], v21 offset:9216
  ds_read_b128 v[60:63], v21 offset:10240
  v_mfma_f32_16x16x32_bf16 v[76:79], a[132:135], v[164:167], v[76:79]
  ds_read_b128 v[180:183], v15 offset:10240
  v_mfma_f32_16x16x32_bf16 v[80:83], a[136:139], v[164:167], v[80:83]
  s_add_u32 m0, s31, 52224
  v_mfma_f32_16x16x32_bf16 v[84:87], a[140:143], v[164:167], v[84:87]
  s_waitcnt lgkmcnt(7)
  buffer_load_dwordx4 v13, s[8:11], s30 offen lds
  v_mfma_f32_16x16x32_bf16 v[88:91], a[132:135], v[168:171], v[88:91]
  s_add_u32 s30, s30, 128
  ds_read_b128 v[184:187], v15 offset:12288
  v_mfma_f32_16x16x32_bf16 v[92:95], a[136:139], v[168:171], v[92:95]
  v_mfma_f32_16x16x32_bf16 v[96:99], a[140:143], v[168:171], v[96:99]
  s_waitcnt lgkmcnt(6)
  v_mfma_f32_16x16x32_bf16 v[36:39], v[208:211], v[248:251], v[36:39]
  v_mfma_f32_16x16x32_bf16 v[44:47], v[208:211], v[252:255], v[44:47]
  v_mfma_f32_16x16x32_bf16 v[48:51], v[212:215], v[252:255], v[48:51]
  v_mfma_f32_16x16x32_bf16 v[40:43], a[248:251], v[248:251], v[40:43]
  v_mfma_f32_16x16x32_bf16 v[52:55], a[248:251], v[252:255], v[52:55]
  s_waitcnt lgkmcnt(5)
  ds_read2st64_b64 v[248:251], v22 offset0:12 offset1:18
  ds_read2st64_b64 v[252:255], v23 offset0:12 offset1:18
  v_mfma_f32_16x16x32_bf16 v[100:103], a[132:135], v[172:175], v[100:103]
  ds_read_b128 v[188:191], v15 offset:14336
  v_mfma_f32_16x16x32_bf16 v[104:107], a[136:139], v[172:175], v[104:107]
  v_mfma_f32_16x16x32_bf16 v[108:111], a[140:143], v[172:175], v[108:111]
  s_waitcnt lgkmcnt(7)
  v_mfma_f32_16x16x32_bf16 v[112:115], a[132:135], v[176:179], v[112:115]
  s_waitcnt vmcnt(8)
  s_barrier
  ds_read_b128 v[160:163], v14 offset:16384
  v_mfma_f32_16x16x32_bf16 v[116:119], a[136:139], v[176:179], v[116:119]
  v_mfma_f32_16x16x32_bf16 v[120:123], a[140:143], v[176:179], v[120:123]
  s_waitcnt lgkmcnt(6)
  v_mfma_f32_16x16x32_bf16 v[36:39], v[216:219], v[56:59], v[36:39]
  v_mfma_f32_16x16x32_bf16 v[44:47], v[216:219], v[60:63], v[44:47]
  v_mfma_f32_16x16x32_bf16 v[48:51], v[220:223], v[60:63], v[48:51]
  v_mfma_f32_16x16x32_bf16 v[40:43], a[252:255], v[56:59], v[40:43]
  v_mfma_f32_16x16x32_bf16 v[52:55], a[252:255], v[60:63], v[52:55]
  s_waitcnt lgkmcnt(5)
  v_mfma_f32_16x16x32_bf16 v[124:127], a[132:135], v[180:183], v[124:127]
  ds_read_b128 v[164:167], v14 offset:18432
  v_mfma_f32_16x16x32_bf16 v[128:131], a[136:139], v[180:183], v[128:131]
  v_mfma_f32_16x16x32_bf16 v[132:135], a[140:143], v[180:183], v[132:135]
  s_waitcnt lgkmcnt(5)
  v_mfma_f32_16x16x32_bf16 v[136:139], a[132:135], v[184:187], v[136:139]
  ds_read_b128 v[168:171], v14 offset:20480
  v_mfma_f32_16x16x32_bf16 v[140:143], a[136:139], v[184:187], v[140:143]
  v_mfma_f32_16x16x32_bf16 v[144:147], a[140:143], v[184:187], v[144:147]
  s_waitcnt lgkmcnt(4)
  v_mfma_f32_16x16x32_bf16 v[36:39], v[232:235], v[248:251], v[36:39]
  v_mfma_f32_16x16x32_bf16 v[44:47], v[232:235], v[252:255], v[44:47]
  v_mfma_f32_16x16x32_bf16 v[48:51], v[236:239], v[252:255], v[48:51]
  v_mfma_f32_16x16x32_bf16 v[40:43], v[244:247], v[248:251], v[40:43]
  v_mfma_f32_16x16x32_bf16 v[52:55], v[244:247], v[252:255], v[52:55]
  s_waitcnt lgkmcnt(3)
  v_mfma_f32_16x16x32_bf16 v[148:151], a[132:135], v[188:191], v[148:151]
  ds_read_b128 v[172:175], v14 offset:22528
  v_mfma_f32_16x16x32_bf16 v[152:155], a[136:139], v[188:191], v[152:155]
  v_mfma_f32_16x16x32_bf16 v[156:159], a[140:143], v[188:191], v[156:159]
  s_waitcnt lgkmcnt(3)
  v_cndmask_b32 v36, v31, v36, s[64:65]
  v_cndmask_b32 v48, v31, v48, s[64:65]
  v_mfma_f32_16x16x32_bf16 v[64:67], a[144:147], v[160:163], v[64:67]
  ds_read_b128 v[176:179], v14 offset:24576
  v_cndmask_b32 v37, v31, v37, s[66:67]
  v_mfma_f32_16x16x32_bf16 v[68:71], a[148:151], v[160:163], v[68:71]
  s_add_u32 m0, s31, 65536
  v_cndmask_b32 v49, v31, v49, s[66:67]
  v_cndmask_b32 v38, v31, v38, s[68:69]
  v_mfma_f32_16x16x32_bf16 v[72:75], a[152:155], v[160:163], v[72:75]
  s_waitcnt lgkmcnt(3)
  buffer_load_dwordx4 v10, s[8:11], s30 offen lds
  v_cndmask_b32 v50, v31, v50, s[68:69]
  v_mfma_f32_16x16x32_bf16 v[76:79], a[144:147], v[164:167], v[76:79]
  ds_read_b128 v[180:183], v14 offset:26624
  v_cndmask_b32 v39, v31, v39, s[70:71]
  v_mfma_f32_16x16x32_bf16 v[80:83], a[148:151], v[164:167], v[80:83]
  v_cndmask_b32 v51, v31, v51, s[70:71]
  v_max3_f32 v34, v36, v37, v38
  v_mfma_f32_16x16x32_bf16 v[84:87], a[152:155], v[164:167], v[84:87]
  s_waitcnt lgkmcnt(3)
  v_max3_f32 v34, v34, v39, v40
  v_max3_f32 v34, v34, v41, v42
  v_mfma_f32_16x16x32_bf16 v[88:91], a[144:147], v[168:171], v[88:91]
  ds_read_b128 v[184:187], v14 offset:28672
  v_max_f32 v34, v34, v43
  v_mfma_f32_16x16x32_bf16 v[92:95], a[148:151], v[168:171], v[92:95]
  v_mov_b32 v35, v34
  v_mfma_f32_16x16x32_bf16 v[96:99], a[152:155], v[168:171], v[96:99]
  s_waitcnt lgkmcnt(3)
  v_permlane32_swap_b32 v34, v35
  v_max_f32 v34, v34, v35
  v_mfma_f32_16x16x32_bf16 v[100:103], a[144:147], v[172:175], v[100:103]
  ds_read_b128 v[188:191], v14 offset:30720
  v_mov_b32 v35, v34
  v_mfma_f32_16x16x32_bf16 v[104:107], a[148:151], v[172:175], v[104:107]
  s_add_u32 m0, s31, 66560
  v_permlane16_swap_b32 v34, v35
  v_max_f32 v34, v34, v35
  v_mfma_f32_16x16x32_bf16 v[108:111], a[152:155], v[172:175], v[108:111]
  s_waitcnt lgkmcnt(3)
  buffer_load_dwordx4 v11, s[8:11], s30 offen lds
  v_mul_f32 v34, s83, v34
  v_mfma_f32_16x16x32_bf16 v[112:115], a[144:147], v[176:179], v[112:115]
  ds_read_b128 v[160:163], v15 offset:16384
  v_fma_f32 v36, v36, s83, -v34
  v_mfma_f32_16x16x32_bf16 v[116:119], a[148:151], v[176:179], v[116:119]
  v_fma_f32 v37, v37, s83, -v34
  v_fma_f32 v38, v38, s83, -v34
  v_mfma_f32_16x16x32_bf16 v[120:123], a[152:155], v[176:179], v[120:123]
  s_waitcnt lgkmcnt(3)
  v_fma_f32 v39, v39, s83, -v34
  v_fma_f32 v40, v40, s83, -v34
  v_mfma_f32_16x16x32_bf16 v[124:127], a[144:147], v[180:183], v[124:127]
  ds_read_b128 v[164:167], v15 offset:18432
  v_fma_f32 v41, v41, s83, -v34
  v_mfma_f32_16x16x32_bf16 v[128:131], a[148:151], v[180:183], v[128:131]
  v_fma_f32 v42, v42, s83, -v34
  v_fma_f32 v43, v43, s83, -v34
  v_mfma_f32_16x16x32_bf16 v[132:135], a[152:155], v[180:183], v[132:135]
  s_waitcnt lgkmcnt(3)
  v_exp_f32 v36, v36
  v_mfma_f32_16x16x32_bf16 v[136:139], a[144:147], v[184:187], v[136:139]
  ds_read_b128 v[168:171], v15 offset:20480
  v_mfma_f32_16x16x32_bf16 v[140:143], a[148:151], v[184:187], v[140:143]
  s_add_u32 m0, s31, 67584
  v_exp_f32 v37, v37
  v_mfma_f32_16x16x32_bf16 v[144:147], a[152:155], v[184:187], v[144:147]
  s_waitcnt lgkmcnt(3)
  buffer_load_dwordx4 v12, s[8:11], s30 offen lds
  v_mfma_f32_16x16x32_bf16 v[148:151], a[144:147], v[188:191], v[148:151]
  ds_read_b128 v[172:175], v15 offset:22528
  v_mfma_f32_16x16x32_bf16 v[152:155], a[148:151], v[188:191], v[152:155]
  v_exp_f32 v38, v38
  v_mfma_f32_16x16x32_bf16 v[156:159], a[152:155], v[188:191], v[156:159]
  s_waitcnt lgkmcnt(3)
  v_exp_f32 v39, v39
  v_mfma_f32_16x16x32_bf16 v[64:67], a[156:159], v[160:163], v[64:67]
  ds_read_b128 v[176:179], v15 offset:24576
  v_mfma_f32_16x16x32_bf16 v[68:71], a[160:163], v[160:163], v[68:71]
  v_exp_f32 v40, v40
  v_mfma_f32_16x16x32_bf16 v[72:75], a[164:167], v[160:163], v[72:75]
  s_waitcnt lgkmcnt(3)
  v_exp_f32 v41, v41
  v_mfma_f32_16x16x32_bf16 v[76:79], a[156:159], v[164:167], v[76:79]
  ds_read_b128 v[180:183], v15 offset:26624
  v_mfma_f32_16x16x32_bf16 v[80:83], a[160:163], v[164:167], v[80:83]
  s_add_u32 m0, s31, 68608
  v_exp_f32 v42, v42
  v_mfma_f32_16x16x32_bf16 v[84:87], a[164:167], v[164:167], v[84:87]
  s_waitcnt lgkmcnt(3)
  buffer_load_dwordx4 v13, s[8:11], s30 offen lds
  v_mfma_f32_16x16x32_bf16 v[88:91], a[156:159], v[168:171], v[88:91]
  s_add_u32 s30, s30, s25
  ds_read_b128 v[184:187], v15 offset:28672
  v_mfma_f32_16x16x32_bf16 v[92:95], a[160:163], v[168:171], v[92:95]
  v_exp_f32 v43, v43
  v_mfma_f32_16x16x32_bf16 v[96:99], a[164:167], v[168:171], v[96:99]
  s_waitcnt lgkmcnt(3)
  v_add_f32 v34, v40, v41
  v_add_f32 v34, v34, v42
  v_mfma_f32_16x16x32_bf16 v[100:103], a[156:159], v[172:175], v[100:103]
  ds_read_b128 v[188:191], v15 offset:30720
  v_add_f32 v34, v34, v43
  v_mfma_f32_16x16x32_bf16 v[104:107], a[160:163], v[172:175], v[104:107]
  v_cndmask_b32 v34, 0, v34, s[62:63]
  v_add_f32 v34, v34, v36
  v_mfma_f32_16x16x32_bf16 v[108:111], a[164:167], v[172:175], v[108:111]
  s_waitcnt lgkmcnt(3)
  v_add_f32 v34, v34, v37
  v_add_f32 v34, v34, v38
  v_mfma_f32_16x16x32_bf16 v[112:115], a[156:159], v[176:179], v[112:115]
  s_waitcnt vmcnt(8)
  s_barrier
  ds_read_b128 v[160:163], v14 offset:32768
  v_mfma_f32_16x16x32_bf16 v[116:119], a[160:163], v[176:179], v[116:119]
  v_add_f32 v34, v34, v39
  v_mov_b32 v35, v34
  v_mfma_f32_16x16x32_bf16 v[120:123], a[164:167], v[176:179], v[120:123]
  s_waitcnt lgkmcnt(3)
  v_permlane32_swap_b32 v34, v35
  v_add_f32 v34, v34, v35
  v_mfma_f32_16x16x32_bf16 v[124:127], a[156:159], v[180:183], v[124:127]
  ds_read_b128 v[164:167], v14 offset:34816
  v_mov_b32 v35, v34
  v_mfma_f32_16x16x32_bf16 v[128:131], a[160:163], v[180:183], v[128:131]
  v_permlane16_swap_b32 v34, v35
  v_add_f32 v34, v34, v35
  v_mfma_f32_16x16x32_bf16 v[132:135], a[164:167], v[180:183], v[132:135]
  s_waitcnt lgkmcnt(3)
  v_rcp_f32 v34, v34
  v_mfma_f32_16x16x32_bf16 v[136:139], a[156:159], v[184:187], v[136:139]
  ds_read_b128 v[168:171], v14 offset:36864
  v_mul_f32 v36, v36, v34
  v_mfma_f32_16x16x32_bf16 v[140:143], a[160:163], v[184:187], v[140:143]
  v_mul_f32 v37, v37, v34
  v_mul_f32 v38, v38, v34
  v_mfma_f32_16x16x32_bf16 v[144:147], a[164:167], v[184:187], v[144:147]
  s_waitcnt lgkmcnt(3)
  v_mul_f32 v39, v39, v34
  v_mul_f32 v40, v40, v34
  v_mfma_f32_16x16x32_bf16 v[148:151], a[156:159], v[188:191], v[148:151]
  ds_read_b128 v[172:175], v14 offset:38912
  v_mul_f32 v41, v41, v34
  v_mfma_f32_16x16x32_bf16 v[152:155], a[160:163], v[188:191], v[152:155]
  v_mul_f32 v42, v42, v34
  v_mul_f32 v43, v43, v34
  v_mfma_f32_16x16x32_bf16 v[156:159], a[164:167], v[188:191], v[156:159]
  s_waitcnt lgkmcnt(3)
  v_max3_f32 v34, v44, v45, v46
  v_max3_f32 v34, v34, v47, v48
  v_mfma_f32_16x16x32_bf16 v[64:67], a[168:171], v[160:163], v[64:67]
  ds_read_b128 v[176:179], v14 offset:40960
  v_max3_f32 v34, v34, v49, v50
  v_mfma_f32_16x16x32_bf16 v[68:71], a[172:175], v[160:163], v[68:71]
  s_add_u32 m0, s31, 0
  v_max3_f32 v34, v34, v51, v52
  v_max3_f32 v34, v34, v53, v54
  v_mfma_f32_16x16x32_bf16 v[72:75], a[176:179], v[160:163], v[72:75]
  s_waitcnt lgkmcnt(3)
  buffer_load_dwordx4 v10, s[8:11], s30 offen lds
  v_max_f32 v34, v34, v55
  v_mfma_f32_16x16x32_bf16 v[76:79], a[168:171], v[164:167], v[76:79]
  ds_read_b128 v[180:183], v14 offset:43008
  v_mov_b32 v35, v34
  v_mfma_f32_16x16x32_bf16 v[80:83], a[172:175], v[164:167], v[80:83]
  v_permlane32_swap_b32 v34, v35
  v_max_f32 v34, v34, v35
  v_mfma_f32_16x16x32_bf16 v[84:87], a[176:179], v[164:167], v[84:87]
  s_waitcnt lgkmcnt(3)
  v_mov_b32 v35, v34
  v_mfma_f32_16x16x32_bf16 v[88:91], a[168:171], v[168:171], v[88:91]
  ds_read_b128 v[184:187], v14 offset:45056
  v_permlane16_swap_b32 v34, v35
  v_mfma_f32_16x16x32_bf16 v[92:95], a[172:175], v[168:171], v[92:95]
  v_max_f32 v34, v34, v35
  v_mul_f32 v34, s83, v34
  v_mfma_f32_16x16x32_bf16 v[96:99], a[176:179], v[168:171], v[96:99]
  s_waitcnt lgkmcnt(3)
  v_fma_f32 v44, v44, s83, -v34
  v_fma_f32 v45, v45, s83, -v34
  v_mfma_f32_16x16x32_bf16 v[100:103], a[168:171], v[172:175], v[100:103]
  ds_read_b128 v[188:191], v14 offset:47104
  v_fma_f32 v46, v46, s83, -v34
  v_mfma_f32_16x16x32_bf16 v[104:107], a[172:175], v[172:175], v[104:107]
  s_add_u32 m0, s31, 1024
  v_fma_f32 v47, v47, s83, -v34
  v_fma_f32 v48, v48, s83, -v34
  v_mfma_f32_16x16x32_bf16 v[108:111], a[176:179], v[172:175], v[108:111]
  s_waitcnt lgkmcnt(3)
  buffer_load_dwordx4 v11, s[8:11], s30 offen lds
  v_fma_f32 v49, v49, s83, -v34
  v_mfma_f32_16x16x32_bf16 v[112:115], a[168:171], v[176:179], v[112:115]
  ds_read_b128 v[160:163], v15 offset:32768
  v_fma_f32 v50, v50, s83, -v34
  v_mfma_f32_16x16x32_bf16 v[116:119], a[172:175], v[176:179], v[116:119]
  v_fma_f32 v51, v51, s83, -v34
  v_fma_f32 v52, v52, s83, -v34
  v_mfma_f32_16x16x32_bf16 v[120:123], a[176:179], v[176:179], v[120:123]
  s_waitcnt lgkmcnt(3)
  v_fma_f32 v53, v53, s83, -v34
  v_fma_f32 v54, v54, s83, -v34
  v_mfma_f32_16x16x32_bf16 v[124:127], a[168:171], v[180:183], v[124:127]
  ds_read_b128 v[164:167], v15 offset:34816
  v_fma_f32 v55, v55, s83, -v34
  v_mfma_f32_16x16x32_bf16 v[128:131], a[172:175], v[180:183], v[128:131]
  v_exp_f32 v44, v44
  v_mfma_f32_16x16x32_bf16 v[132:135], a[176:179], v[180:183], v[132:135]
  s_waitcnt lgkmcnt(3)
  v_exp_f32 v45, v45
  v_mfma_f32_16x16x32_bf16 v[136:139], a[168:171], v[184:187], v[136:139]
  ds_read_b128 v[168:171], v15 offset:36864
  v_mfma_f32_16x16x32_bf16 v[140:143], a[172:175], v[184:187], v[140:143]
  s_add_u32 m0, s31, 2048
  v_exp_f32 v46, v46
  v_mfma_f32_16x16x32_bf16 v[144:147], a[176:179], v[184:187], v[144:147]
  s_waitcnt lgkmcnt(3)
  buffer_load_dwordx4 v12, s[8:11], s30 offen lds
  v_mfma_f32_16x16x32_bf16 v[148:151], a[168:171], v[188:191], v[148:151]
  ds_read_b128 v[172:175], v15 offset:38912
  v_mfma_f32_16x16x32_bf16 v[152:155], a[172:175], v[188:191], v[152:155]
  v_exp_f32 v47, v47
  v_mfma_f32_16x16x32_bf16 v[156:159], a[176:179], v[188:191], v[156:159]
  s_waitcnt lgkmcnt(3)
  v_exp_f32 v48, v48
  v_mfma_f32_16x16x32_bf16 v[64:67], a[180:183], v[160:163], v[64:67]
  ds_read_b128 v[176:179], v15 offset:40960
  v_mfma_f32_16x16x32_bf16 v[68:71], a[184:187], v[160:163], v[68:71]
  v_exp_f32 v49, v49
  v_mfma_f32_16x16x32_bf16 v[72:75], a[188:191], v[160:163], v[72:75]
  s_waitcnt lgkmcnt(3)
  v_exp_f32 v50, v50
  v_mfma_f32_16x16x32_bf16 v[76:79], a[180:183], v[164:167], v[76:79]
  ds_read_b128 v[180:183], v15 offset:43008
  v_mfma_f32_16x16x32_bf16 v[80:83], a[184:187], v[164:167], v[80:83]
  s_add_u32 m0, s31, 3072
  v_exp_f32 v51, v51
  v_mfma_f32_16x16x32_bf16 v[84:87], a[188:191], v[164:167], v[84:87]
  s_waitcnt lgkmcnt(3)
  buffer_load_dwordx4 v13, s[8:11], s30 offen lds
  v_mfma_f32_16x16x32_bf16 v[88:91], a[180:183], v[168:171], v[88:91]
  s_add_u32 s30, s30, 128
  ds_read_b128 v[184:187], v15 offset:45056
  v_mfma_f32_16x16x32_bf16 v[92:95], a[184:187], v[168:171], v[92:95]
  v_exp_f32 v52, v52
  v_mfma_f32_16x16x32_bf16 v[96:99], a[188:191], v[168:171], v[96:99]
  s_waitcnt lgkmcnt(3)
  v_exp_f32 v53, v53
  v_mfma_f32_16x16x32_bf16 v[100:103], a[180:183], v[172:175], v[100:103]
  ds_read_b128 v[188:191], v15 offset:47104
  v_mfma_f32_16x16x32_bf16 v[104:107], a[184:187], v[172:175], v[104:107]
  v_exp_f32 v54, v54
  v_mfma_f32_16x16x32_bf16 v[108:111], a[188:191], v[172:175], v[108:111]
  s_waitcnt lgkmcnt(3)
  v_exp_f32 v55, v55
  v_mfma_f32_16x16x32_bf16 v[112:115], a[180:183], v[176:179], v[112:115]
  s_waitcnt vmcnt(8)
  s_barrier
  ds_read_b128 v[160:163], v14 offset:49152
  v_mfma_f32_16x16x32_bf16 v[116:119], a[184:187], v[176:179], v[116:119]
  v_add_f32 v34, v52, v53
  v_add_f32 v34, v34, v54
  v_mfma_f32_16x16x32_bf16 v[120:123], a[188:191], v[176:179], v[120:123]
  s_waitcnt lgkmcnt(3)
  v_add_f32 v34, v34, v55
  v_cndmask_b32 v34, 0, v34, s[62:63]
  v_mfma_f32_16x16x32_bf16 v[124:127], a[180:183], v[180:183], v[124:127]
  ds_read_b128 v[164:167], v14 offset:51200
  v_add_f32 v34, v34, v44
  v_mfma_f32_16x16x32_bf16 v[128:131], a[184:187], v[180:183], v[128:131]
  v_add_f32 v34, v34, v45
  v_add_f32 v34, v34, v46
  v_mfma_f32_16x16x32_bf16 v[132:135], a[188:191], v[180:183], v[132:135]
  s_waitcnt lgkmcnt(3)
  v_add_f32 v34, v34, v47
  v_add_f32 v34, v34, v48
  v_mfma_f32_16x16x32_bf16 v[136:139], a[180:183], v[184:187], v[136:139]
  ds_read_b128 v[168:171], v14 offset:53248
  v_add_f32 v34, v34, v49
  v_mfma_f32_16x16x32_bf16 v[140:143], a[184:187], v[184:187], v[140:143]
  v_add_f32 v34, v34, v50
  v_add_f32 v34, v34, v51
  v_mfma_f32_16x16x32_bf16 v[144:147], a[188:191], v[184:187], v[144:147]
  s_waitcnt lgkmcnt(3)
  v_mov_b32 v35, v34
  v_mfma_f32_16x16x32_bf16 v[148:151], a[180:183], v[188:191], v[148:151]
  ds_read_b128 v[172:175], v14 offset:55296
  v_permlane32_swap_b32 v34, v35
  v_mfma_f32_16x16x32_bf16 v[152:155], a[184:187], v[188:191], v[152:155]
  v_add_f32 v34, v34, v35
  v_mov_b32 v35, v34
  v_mfma_f32_16x16x32_bf16 v[156:159], a[188:191], v[188:191], v[156:159]
  s_waitcnt lgkmcnt(3)
  v_permlane16_swap_b32 v34, v35
  v_add_f32 v34, v34, v35
  v_mfma_f32_16x16x32_bf16 v[64:67], a[192:195], v[160:163], v[64:67]
  ds_read_b128 v[176:179], v14 offset:57344
  v_mfma_f32_16x16x32_bf16 v[68:71], a[196:199], v[160:163], v[68:71]
  s_add_u32 m0, s31, 16384
  v_rcp_f32 v34, v34
  v_mfma_f32_16x16x32_bf16 v[72:75], a[200:203], v[160:163], v[72:75]
  s_waitcnt lgkmcnt(3)
  buffer_load_dwordx4 v10, s[8:11], s30 offen lds
  v_mul_f32 v44, v44, v34
  v_mfma_f32_16x16x32_bf16 v[76:79], a[192:195], v[164:167], v[76:79]
  ds_read_b128 v[180:183], v14 offset:59392
  v_mul_f32 v45, v45, v34
  v_mfma_f32_16x16x32_bf16 v[80:83], a[196:199], v[164:167], v[80:83]
  v_mul_f32 v46, v46, v34
  v_mul_f32 v47, v47, v34
  v_mfma_f32_16x16x32_bf16 v[84:87], a[200:203], v[164:167], v[84:87]
  s_waitcnt lgkmcnt(3)
  v_mul_f32 v48, v48, v34
  v_mul_f32 v49, v49, v34
  v_mfma_f32_16x16x32_bf16 v[88:91], a[192:195], v[168:171], v[88:91]
  ds_read_b128 v[184:187], v14 offset:61440
  v_mul_f32 v50, v50, v34
  v_mfma_f32_16x16x32_bf16 v[92:95], a[196:199], v[168:171], v[92:95]
  v_mul_f32 v51, v51, v34
  v_mul_f32 v52, v52, v34
  v_mfma_f32_16x16x32_bf16 v[96:99], a[200:203], v[168:171], v[96:99]
  s_waitcnt lgkmcnt(3)
  v_mul_f32 v53, v53, v34
  v_mul_f32 v54, v54, v34
  v_mfma_f32_16x16x32_bf16 v[100:103], a[192:195], v[172:175], v[100:103]
  ds_read_b128 v[188:191], v14 offset:63488
  v_mul_f32 v55, v55, v34
  v_mfma_f32_16x16x32_bf16 v[104:107], a[196:199], v[172:175], v[104:107]
  s_add_u32 m0, s31, 17408
  v_cvt_pk_bf16_f32 v56, v44, v45
  v_cvt_pk_bf16_f32 v57, v46, v47
  v_mfma_f32_16x16x32_bf16 v[108:111], a[200:203], v[172:175], v[108:111]
  s_waitcnt lgkmcnt(3)
  buffer_load_dwordx4 v11, s[8:11], s30 offen lds
  v_cvt_pk_bf16_f32 v58, v48, v49
  v_mfma_f32_16x16x32_bf16 v[112:115], a[192:195], v[176:179], v[112:115]
  ds_read_b128 v[160:163], v15 offset:49152
  v_cvt_pk_bf16_f32 v59, v50, v51
  v_mfma_f32_16x16x32_bf16 v[116:119], a[196:199], v[176:179], v[116:119]
  v_cvt_pk_bf16_f32 v60, v40, v41
  v_cvt_pk_bf16_f32 v61, v42, v43
  v_mfma_f32_16x16x32_bf16 v[120:123], a[200:203], v[176:179], v[120:123]
  s_waitcnt lgkmcnt(3)
  v_cvt_pk_bf16_f32 v62, v52, v53
  v_cvt_pk_bf16_f32 v63, v54, v55
  v_mfma_f32_16x16x32_bf16 v[124:127], a[192:195], v[180:183], v[124:127]
  ds_read_b128 v[164:167], v15 offset:51200
  v_cvt_pk_bf16_f32 v248, v36, v37
  v_mfma_f32_16x16x32_bf16 v[128:131], a[196:199], v[180:183], v[128:131]
  v_cvt_pk_bf16_f32 v249, v38, v39
  buffer_store_dwordx4 v[56:59], v26, s[16:19], s81 offen sc1
  v_mfma_f32_16x16x32_bf16 v[132:135], a[200:203], v[180:183], v[132:135]
  s_waitcnt lgkmcnt(3)
  v_mfma_f32_16x16x32_bf16 v[136:139], a[192:195], v[184:187], v[136:139]
  ds_read_b128 v[168:171], v15 offset:53248
  v_mfma_f32_16x16x32_bf16 v[140:143], a[196:199], v[184:187], v[140:143]
  s_add_u32 m0, s31, 18432
  v_mfma_f32_16x16x32_bf16 v[144:147], a[200:203], v[184:187], v[144:147]
  s_waitcnt lgkmcnt(3)
  buffer_load_dwordx4 v12, s[8:11], s30 offen lds
  v_mfma_f32_16x16x32_bf16 v[148:151], a[192:195], v[188:191], v[148:151]
  ds_read_b128 v[172:175], v15 offset:55296
  v_mfma_f32_16x16x32_bf16 v[152:155], a[196:199], v[188:191], v[152:155]
  v_mfma_f32_16x16x32_bf16 v[156:159], a[200:203], v[188:191], v[156:159]
  s_waitcnt lgkmcnt(3)
  buffer_store_dwordx4 v[60:63], v26, s[16:19], s81 offen offset:1024 sc1
  v_mfma_f32_16x16x32_bf16 v[64:67], a[204:207], v[160:163], v[64:67]
  ds_read_b128 v[176:179], v15 offset:57344
  v_mfma_f32_16x16x32_bf16 v[68:71], a[208:211], v[160:163], v[68:71]
  v_mfma_f32_16x16x32_bf16 v[72:75], a[212:215], v[160:163], v[72:75]
  s_waitcnt lgkmcnt(3)
  buffer_store_dwordx2 v[248:249], v29, s[16:19], s81 offen offset:2048 sc1
  v_mfma_f32_16x16x32_bf16 v[76:79], a[204:207], v[164:167], v[76:79]
  ds_read_b128 v[180:183], v15 offset:59392
  s_mov_b32 s84, s82
  v_mfma_f32_16x16x32_bf16 v[80:83], a[208:211], v[164:167], v[80:83]
  s_mov_b32 s25, 162688
  s_add_u32 m0, s31, 19456
  v_mfma_f32_16x16x32_bf16 v[84:87], a[212:215], v[164:167], v[84:87]
  s_waitcnt lgkmcnt(3)
  buffer_load_dwordx4 v13, s[8:11], s30 offen lds
  v_mfma_f32_16x16x32_bf16 v[88:91], a[204:207], v[168:171], v[88:91]
  s_add_u32 s30, s30, 128
  ds_read_b128 v[184:187], v15 offset:61440
  v_mfma_f32_16x16x32_bf16 v[92:95], a[208:211], v[168:171], v[92:95]
  s_cmp_gt_u32 s26, s85
  s_cselect_b32 s21, 0, s26
  v_mfma_f32_16x16x32_bf16 v[96:99], a[212:215], v[168:171], v[96:99]
  s_waitcnt lgkmcnt(3)
  v_mfma_f32_16x16x32_bf16 v[100:103], a[204:207], v[172:175], v[100:103]
  ds_read_b128 v[188:191], v15 offset:63488
  v_mfma_f32_16x16x32_bf16 v[104:107], a[208:211], v[172:175], v[104:107]
  s_cmp_le_u32 s21, 2
  s_cbranch_scc1 qa2_263
  s_mov_b32 s49, s43
  s_mov_b32 s50, s45
  s_mov_b32 s81, s47
  s_mov_b32 s82, s48
  s_add_u32 s43, s43, 4
  s_add_u32 s45, s45, 8388608
  s_add_u32 s47, s47, 2097152
  s_xor_b32 s47, s47, 8192
  s_add_u32 s48, s48, 512
qa3_264:
  v_mfma_f32_16x16x32_bf16 v[108:111], a[212:215], v[172:175], v[108:111]
  s_waitcnt lgkmcnt(3)
  v_mfma_f32_16x16x32_bf16 v[112:115], a[204:207], v[176:179], v[112:115]
  s_waitcnt vmcnt(11)
  s_barrier
  ds_read_b128 v[160:163], v16 offset:0
  v_mfma_f32_16x16x32_bf16 v[116:119], a[208:211], v[176:179], v[116:119]
  buffer_load_dword v32, v30, s[72:75], s77 offen sc1
  v_mfma_f32_16x16x32_bf16 v[120:123], a[212:215], v[176:179], v[120:123]
  s_waitcnt lgkmcnt(3)
  v_mfma_f32_16x16x32_bf16 v[124:127], a[204:207], v[180:183], v[124:127]
  ds_read_b128 v[164:167], v16 offset:2048
  v_mfma_f32_16x16x32_bf16 v[128:131], a[208:211], v[180:183], v[128:131]
  v_mfma_f32_16x16x32_bf16 v[132:135], a[212:215], v[180:183], v[132:135]
  s_waitcnt lgkmcnt(3)
  v_mfma_f32_16x16x32_bf16 v[136:139], a[204:207], v[184:187], v[136:139]
  ds_read_b128 v[168:171], v16 offset:4096
  v_mfma_f32_16x16x32_bf16 v[140:143], a[208:211], v[184:187], v[140:143]
  v_mfma_f32_16x16x32_bf16 v[144:147], a[212:215], v[184:187], v[144:147]
  s_waitcnt lgkmcnt(3)
  v_mfma_f32_16x16x32_bf16 v[148:151], a[204:207], v[188:191], v[148:151]
  ds_read_b128 v[172:175], v16 offset:6144
  v_mfma_f32_16x16x32_bf16 v[152:155], a[208:211], v[188:191], v[152:155]
  v_mfma_f32_16x16x32_bf16 v[156:159], a[212:215], v[188:191], v[156:159]
  s_waitcnt lgkmcnt(3)
  v_mfma_f32_16x16x32_bf16 v[64:67], a[216:219], v[160:163], v[64:67]
  ds_read_b128 v[176:179], v16 offset:8192
  v_mfma_f32_16x16x32_bf16 v[68:71], a[220:223], v[160:163], v[68:71]
  s_add_u32 m0, s31, 32768
  v_mfma_f32_16x16x32_bf16 v[72:75], a[224:227], v[160:163], v[72:75]
  s_waitcnt lgkmcnt(3)
  buffer_load_dwordx4 v10, s[8:11], s30 offen lds
  v_mfma_f32_16x16x32_bf16 v[76:79], a[216:219], v[164:167], v[76:79]
  ds_read_b128 v[180:183], v16 offset:10240
  v_mfma_f32_16x16x32_bf16 v[80:83], a[220:223], v[164:167], v[80:83]
  v_mfma_f32_16x16x32_bf16 v[84:87], a[224:227], v[164:167], v[84:87]
  s_waitcnt lgkmcnt(3)
  v_mfma_f32_16x16x32_bf16 v[88:91], a[216:219], v[168:171], v[88:91]
  ds_read_b128 v[184:187], v16 offset:12288
  v_mfma_f32_16x16x32_bf16 v[92:95], a[220:223], v[168:171], v[92:95]
  s_add_u32 m0, s31, 33792
  v_mfma_f32_16x16x32_bf16 v[96:99], a[224:227], v[168:171], v[96:99]
  s_waitcnt lgkmcnt(3)
  buffer_load_dwordx4 v11, s[8:11], s30 offen lds
  v_mfma_f32_16x16x32_bf16 v[100:103], a[216:219], v[172:175], v[100:103]
  ds_read_b128 v[188:191], v16 offset:14336
  v_mfma_f32_16x16x32_bf16 v[104:107], a[220:223], v[172:175], v[104:107]
  v_mfma_f32_16x16x32_bf16 v[108:111], a[224:227], v[172:175], v[108:111]
  s_waitcnt lgkmcnt(3)
  v_mfma_f32_16x16x32_bf16 v[112:115], a[216:219], v[176:179], v[112:115]
  ds_read_b128 v[160:163], v17 offset:0
  v_mfma_f32_16x16x32_bf16 v[116:119], a[220:223], v[176:179], v[116:119]
  s_add_u32 m0, s31, 34816
  v_mfma_f32_16x16x32_bf16 v[120:123], a[224:227], v[176:179], v[120:123]
  s_waitcnt lgkmcnt(3)
  buffer_load_dwordx4 v12, s[8:11], s30 offen lds
  v_mfma_f32_16x16x32_bf16 v[124:127], a[216:219], v[180:183], v[124:127]
  ds_read_b128 v[164:167], v17 offset:2048
  v_mfma_f32_16x16x32_bf16 v[128:131], a[220:223], v[180:183], v[128:131]
  v_mfma_f32_16x16x32_bf16 v[132:135], a[224:227], v[180:183], v[132:135]
  s_waitcnt lgkmcnt(3)
  v_mfma_f32_16x16x32_bf16 v[136:139], a[216:219], v[184:187], v[136:139]
  ds_read_b128 v[168:171], v17 offset:4096
  v_mfma_f32_16x16x32_bf16 v[140:143], a[220:223], v[184:187], v[140:143]
  s_add_u32 m0, s31, 35840
  v_mfma_f32_16x16x32_bf16 v[144:147], a[224:227], v[184:187], v[144:147]
  s_waitcnt lgkmcnt(3)
  buffer_load_dwordx4 v13, s[8:11], s30 offen lds
  v_mfma_f32_16x16x32_bf16 v[148:151], a[216:219], v[188:191], v[148:151]
  s_add_u32 s30, s30, 128
  ds_read_b128 v[172:175], v17 offset:6144
  v_mfma_f32_16x16x32_bf16 v[152:155], a[220:223], v[188:191], v[152:155]
  v_mfma_f32_16x16x32_bf16 v[156:159], a[224:227], v[188:191], v[156:159]
  s_waitcnt lgkmcnt(3)
  v_mfma_f32_16x16x32_bf16 v[64:67], a[228:231], v[160:163], v[64:67]
  ds_read_b128 v[176:179], v17 offset:8192
  v_mfma_f32_16x16x32_bf16 v[68:71], a[232:235], v[160:163], v[68:71]
  v_mfma_f32_16x16x32_bf16 v[72:75], a[236:239], v[160:163], v[72:75]
  s_waitcnt lgkmcnt(3)
  v_mfma_f32_16x16x32_bf16 v[76:79], a[228:231], v[164:167], v[76:79]
  ds_read_b128 v[180:183], v17 offset:10240
  v_cvt_pk_bf16_f32 v192, v64, v65
  v_mfma_f32_16x16x32_bf16 v[80:83], a[232:235], v[164:167], v[80:83]
  v_cvt_pk_bf16_f32 v193, v66, v67
  v_cvt_pk_bf16_f32 v194, v68, v69
  v_mfma_f32_16x16x32_bf16 v[84:87], a[236:239], v[164:167], v[84:87]
  s_waitcnt lgkmcnt(3)
  v_cvt_pk_bf16_f32 v195, v70, v71
  v_cvt_pk_bf16_f32 v200, v72, v73
  v_mfma_f32_16x16x32_bf16 v[88:91], a[228:231], v[168:171], v[88:91]
  ds_read_b128 v[184:187], v17 offset:12288
  v_cvt_pk_bf16_f32 v201, v74, v75
  v_mfma_f32_16x16x32_bf16 v[92:95], a[232:235], v[168:171], v[92:95]
  v_cvt_pk_bf16_f32 v196, v76, v77
  v_cvt_pk_bf16_f32 v197, v78, v79
  v_mfma_f32_16x16x32_bf16 v[96:99], a[236:239], v[168:171], v[96:99]
  s_waitcnt lgkmcnt(3)
  v_cvt_pk_bf16_f32 v198, v80, v81
  v_cvt_pk_bf16_f32 v199, v82, v83
  v_mfma_f32_16x16x32_bf16 v[100:103], a[228:231], v[172:175], v[100:103]
  ds_read_b128 v[188:191], v17 offset:14336
  v_cvt_pk_bf16_f32 v202, v84, v85
  v_mfma_f32_16x16x32_bf16 v[104:107], a[232:235], v[172:175], v[104:107]
  v_cvt_pk_bf16_f32 v203, v86, v87
  v_cvt_pk_bf16_f32 v204, v88, v89
  v_mfma_f32_16x16x32_bf16 v[108:111], a[236:239], v[172:175], v[108:111]
  s_waitcnt lgkmcnt(3)
  v_cvt_pk_bf16_f32 v205, v90, v91
  v_cvt_pk_bf16_f32 v206, v92, v93
  v_mfma_f32_16x16x32_bf16 v[112:115], a[228:231], v[176:179], v[112:115]
  s_waitcnt vmcnt(12)
  s_barrier
  ds_read_b128 v[160:163], v14 offset:0
  v_mfma_f32_16x16x32_bf16 v[116:119], a[232:235], v[176:179], v[116:119]
  v_cvt_pk_bf16_f32 v207, v94, v95
  v_cvt_pk_bf16_f32 v212, v96, v97
  v_mfma_f32_16x16x32_bf16 v[120:123], a[236:239], v[176:179], v[120:123]
  s_waitcnt lgkmcnt(3)
  v_cvt_pk_bf16_f32 v213, v98, v99
  v_cvt_pk_bf16_f32 v208, v100, v101
  v_mfma_f32_16x16x32_bf16 v[124:127], a[228:231], v[180:183], v[124:127]
  ds_read_b128 v[164:167], v14 offset:2048
  v_cvt_pk_bf16_f32 v209, v102, v103
  v_mfma_f32_16x16x32_bf16 v[128:131], a[232:235], v[180:183], v[128:131]
  v_cvt_pk_bf16_f32 v210, v104, v105
  v_cvt_pk_bf16_f32 v211, v106, v107
  v_mfma_f32_16x16x32_bf16 v[132:135], a[236:239], v[180:183], v[132:135]
  s_waitcnt lgkmcnt(3)
  v_cvt_pk_bf16_f32 v214, v108, v109
  v_cvt_pk_bf16_f32 v215, v110, v111
  v_mfma_f32_16x16x32_bf16 v[136:139], a[228:231], v[184:187], v[136:139]
  ds_read_b128 v[168:171], v14 offset:4096
  v_cvt_pk_bf16_f32 v216, v112, v113
  v_mfma_f32_16x16x32_bf16 v[140:143], a[232:235], v[184:187], v[140:143]
  v_cvt_pk_bf16_f32 v217, v114, v115
  v_cvt_pk_bf16_f32 v218, v116, v117
  v_mfma_f32_16x16x32_bf16 v[144:147], a[236:239], v[184:187], v[144:147]
  s_waitcnt lgkmcnt(3)
  v_cvt_pk_bf16_f32 v219, v118, v119
  v_cvt_pk_bf16_f32 v224, v120, v121
  v_mfma_f32_16x16x32_bf16 v[148:151], a[228:231], v[188:191], v[148:151]
  ds_read_b128 v[172:175], v14 offset:6144
  v_cvt_pk_bf16_f32 v225, v122, v123
  v_mfma_f32_16x16x32_bf16 v[152:155], a[232:235], v[188:191], v[152:155]
  s_sub_u32 s26, s26, 1
  s_cmp_gt_u32 s26, 0
  v_cvt_pk_bf16_f32 v220, v124, v125
  v_mfma_f32_16x16x32_bf16 v[156:159], a[236:239], v[188:191], v[156:159]
  s_waitcnt lgkmcnt(3)
  s_cbranch_scc1 qa_267
  s_nop 7
  v_cvt_pk_bf16_f32 v221, v126, v127
  v_cvt_pk_bf16_f32 v222, v128, v129
  v_cvt_pk_bf16_f32 v223, v130, v131
  v_cvt_pk_bf16_f32 v226, v132, v133
  v_cvt_pk_bf16_f32 v227, v134, v135
  v_cvt_pk_bf16_f32 v228, v136, v137
  v_cvt_pk_bf16_f32 v229, v138, v139
  v_cvt_pk_bf16_f32 v230, v140, v141
  v_cvt_pk_bf16_f32 v231, v142, v143
  v_cvt_pk_bf16_f32 v236, v144, v145
  v_cvt_pk_bf16_f32 v237, v146, v147
  v_cvt_pk_bf16_f32 v232, v148, v149
  v_cvt_pk_bf16_f32 v233, v150, v151
  v_cvt_pk_bf16_f32 v234, v152, v153
  v_cvt_pk_bf16_f32 v235, v154, v155
  v_cvt_pk_bf16_f32 v238, v156, v157
  v_cvt_pk_bf16_f32 v239, v158, v159
  s_waitcnt lgkmcnt(0)
  s_mov_b32 s49, s43
  s_mov_b32 s50, s45
  s_mov_b32 s81, s47
  s_mov_b32 s82, s48
  s_add_u32 s43, s43, 4
  s_add_u32 s45, s45, 8388608
  s_add_u32 s47, s47, 2097152
  s_xor_b32 s47, s47, 8192
  s_add_u32 s48, s48, 512
  ds_read_b128 v[64:67], v21 offset:0
  ds_read_b128 v[68:71], v21 offset:1024
  ds_read_b128 v[72:75], v21 offset:3072
  ds_read_b128 v[76:79], v21 offset:4096
  ds_read2st64_b64 v[80:83], v22 offset0:0 offset1:6
  ds_read2st64_b64 v[84:87], v23 offset0:0 offset1:6
  ds_read_b128 v[88:91], v21 offset:6144
  ds_read_b128 v[92:95], v21 offset:7168
  ds_read_b128 v[96:99], v21 offset:9216
  ds_read_b128 v[100:103], v21 offset:10240
  ds_read2st64_b64 v[104:107], v22 offset0:12 offset1:18
  ds_read2st64_b64 v[108:111], v23 offset0:12 offset1:18
  s_waitcnt lgkmcnt(0)
  s_barrier
  ds_write_b128 v20, v[192:195] offset:0
  ds_write_b128 v20, v[196:199] offset:1024
  ds_write_b128 v20, v[200:203] offset:2048
  ds_write_b128 v20, v[204:207] offset:12288
  ds_write_b128 v20, v[208:211] offset:13312
  ds_write_b128 v20, v[212:215] offset:14336
  ds_write_b128 v20, v[216:219] offset:24576
  ds_write_b128 v20, v[220:223] offset:25600
  ds_write_b128 v20, v[224:227] offset:26624
  ds_write_b128 v20, v[228:231] offset:36864
  ds_write_b128 v20, v[232:235] offset:37888
  ds_write_b128 v20, v[236:239] offset:38912
  s_waitcnt lgkmcnt(0)
  s_barrier
  s_cmp_gt_u32 s49, 60
  s_cselect_b32 s23, 58, s49
  s_mov_b32 s101, 0
wm_270:
  buffer_load_dword v34, v30, s[72:75], s77 offen sc1
  s_add_u32 s101, s101, 1
  s_cmp_gt_u32 s101, 131072
  s_cbranch_scc1 main_end
  s_waitcnt vmcnt(0)
  v_cmp_gt_u32 vcc, s23, v34
  v_readfirstlane_b32 s100, v34
  s_nop 0
  s_cbranch_vccz wm_271
  s_sleep 4
  s_add_u32 s100, s100, 2
  s_cmp_ge_u32 s100, s23
  s_cbranch_scc1 wm_270
  s_sleep 40
  s_branch wm_270
wm_271:
  s_add_u32 s29, s50, 0
  buffer_load_dwordx4 v[112:115], v26, s[16:19], s29 offen offset:0 sc1
  buffer_load_dwordx4 v[116:119], v26, s[16:19], s29 offen offset:1024 sc1
  buffer_load_dwordx4 v[144:147], v26, s[16:19], s29 offen offset:2048 sc1
  s_add_u32 s29, s50, 16384
  buffer_load_dwordx4 v[120:123], v26, s[16:19], s29 offen offset:0 sc1
  buffer_load_dwordx4 v[124:127], v26, s[16:19], s29 offen offset:1024 sc1
  buffer_load_dwordx4 v[148:151], v26, s[16:19], s29 offen offset:2048 sc1
  s_add_u32 s29, s50, 32768
  buffer_load_dwordx4 v[128:131], v26, s[16:19], s29 offen offset:0 sc1
  buffer_load_dwordx4 v[132:135], v26, s[16:19], s29 offen offset:1024 sc1
  buffer_load_dwordx4 v[152:155], v26, s[16:19], s29 offen offset:2048 sc1
  s_add_u32 s29, s50, 49152
  buffer_load_dwordx4 v[136:139], v26, s[16:19], s29 offen offset:0 sc1
  buffer_load_dwordx4 v[140:143], v26, s[16:19], s29 offen offset:1024 sc1
  buffer_load_dwordx4 v[156:159], v26, s[16:19], s29 offen offset:2048 sc1
  s_waitcnt vmcnt(0) lgkmcnt(0)
  v_swap_b32 v146, v148
  v_swap_b32 v147, v149
  v_swap_b32 v154, v156
  v_swap_b32 v155, v157
  s_nop 1
  v_mfma_f32_16x16x32_bf16 v[36:39], v[112:115], v[64:67], 0
  v_mfma_f32_16x16x32_bf16 v[44:47], v[112:115], v[68:71], 0
  v_mfma_f32_16x16x32_bf16 v[48:51], v[116:119], v[68:71], 0
  v_mfma_f32_16x16x32_bf16 v[36:39], v[120:123], v[72:75], v[36:39]
  v_mfma_f32_16x16x32_bf16 v[44:47], v[120:123], v[76:79], v[44:47]
  v_mfma_f32_16x16x32_bf16 v[48:51], v[124:127], v[76:79], v[48:51]
  v_mfma_f32_16x16x32_bf16 v[36:39], v[144:147], v[80:83], v[36:39]
  v_mfma_f32_16x16x32_bf16 v[44:47], v[144:147], v[84:87], v[44:47]
  v_mfma_f32_16x16x32_bf16 v[48:51], v[148:151], v[84:87], v[48:51]
  v_mfma_f32_16x16x32_bf16 v[36:39], v[128:131], v[88:91], v[36:39]
  v_mfma_f32_16x16x32_bf16 v[44:47], v[128:131], v[92:95], v[44:47]
  v_mfma_f32_16x16x32_bf16 v[48:51], v[132:135], v[92:95], v[48:51]
  v_mfma_f32_16x16x32_bf16 v[36:39], v[136:139], v[96:99], v[36:39]
  v_mfma_f32_16x16x32_bf16 v[44:47], v[136:139], v[100:103], v[44:47]
  v_mfma_f32_16x16x32_bf16 v[48:51], v[140:143], v[100:103], v[48:51]
  v_mfma_f32_16x16x32_bf16 v[36:39], v[152:155], v[104:107], v[36:39]
  v_mfma_f32_16x16x32_bf16 v[44:47], v[152:155], v[108:111], v[44:47]
  v_mfma_f32_16x16x32_bf16 v[48:51], v[156:159], v[108:111], v[48:51]
  s_cmp_le_u32 s49, 60
  s_cbranch_scc1 qtp_274
  s_sub_u32 s23, s49, 1
  s_min_u32 s23, s23, 62
  s_mov_b32 s101, 0
wm_275:
  buffer_load_dword v34, v30, s[72:75], s77 offen sc1
  s_add_u32 s101, s101, 1
  s_cmp_gt_u32 s101, 131072
  s_cbranch_scc1 main_end
  s_waitcnt vmcnt(0)
  v_cmp_gt_u32 vcc, s23, v34
  v_readfirstlane_b32 s100, v34
  s_nop 0
  s_cbranch_vccz wm_276
  s_sleep 4
  s_add_u32 s100, s100, 2
  s_cmp_ge_u32 s100, s23
  s_cbranch_scc1 wm_275
  s_sleep 40
  s_branch wm_275
wm_276:
qtp_274:
  s_mov_b32 s101, 0
  s_branch qtp_273
qtp_272:
  s_sleep 2
qtp_273:
  s_add_u32 s29, s50, 4096
  buffer_load_dwordx4 v[160:163], v24, s[16:19], s29 offen offset:2560 sc1
  buffer_load_dwordx2 v[240:241], v25, s[16:19], s29 offen offset:3072 sc1
  s_add_u32 s29, s50, 20480
  buffer_load_dwordx4 v[164:167], v24, s[16:19], s29 offen offset:2560 sc1
  buffer_load_dwordx2 v[242:243], v25, s[16:19], s29 offen offset:3072 sc1
  s_add_u32 s29, s50, 36864
  buffer_load_dwordx4 v[168:171], v24, s[16:19], s29 offen offset:2560 sc1
  buffer_load_dwordx2 v[244:245], v25, s[16:19], s29 offen offset:3072 sc1
  s_add_u32 s29, s50, 53248
  buffer_load_dwordx4 v[172:175], v24, s[16:19], s29 offen offset:2560 sc1
  buffer_load_dwordx2 v[246:247], v25, s[16:19], s29 offen offset:3072 sc1
  s_add_u32 s101, s101, 1
  s_cmp_gt_u32 s101, 131072
  s_cbranch_scc1 main_end
  s_waitcnt vmcnt(0)
  v_max3_u32 v34, v160, v164, v168
  v_max3_u32 v34, v34, v172, v240
  v_max3_u32 v34, v34, v242, v244
  v_max_u32 v34, v34, v246
  v_cmp_eq_u32 vcc, -1, v34
  s_nop 1
  s_cbranch_vccnz qtp_272
  v_mfma_f32_16x16x32_bf16 v[40:43], v[160:163], v[64:67], 0
  v_mfma_f32_16x16x32_bf16 v[52:55], v[160:163], v[68:71], 0
  v_mfma_f32_16x16x32_bf16 v[40:43], v[164:167], v[72:75], v[40:43]
  v_mfma_f32_16x16x32_bf16 v[52:55], v[164:167], v[76:79], v[52:55]
  v_mfma_f32_16x16x32_bf16 v[40:43], v[240:243], v[80:83], v[40:43]
  v_mfma_f32_16x16x32_bf16 v[52:55], v[240:243], v[84:87], v[52:55]
  v_mfma_f32_16x16x32_bf16 v[40:43], v[168:171], v[88:91], v[40:43]
  v_mfma_f32_16x16x32_bf16 v[52:55], v[168:171], v[92:95], v[52:55]
  v_mfma_f32_16x16x32_bf16 v[40:43], v[172:175], v[96:99], v[40:43]
  v_mfma_f32_16x16x32_bf16 v[52:55], v[172:175], v[100:103], v[52:55]
  v_mfma_f32_16x16x32_bf16 v[40:43], v[244:247], v[104:107], v[40:43]
  v_mfma_f32_16x16x32_bf16 v[52:55], v[244:247], v[108:111], v[52:55]
  s_nop 4
  v_cndmask_b32 v36, v31, v36, s[64:65]
  v_cndmask_b32 v48, v31, v48, s[64:65]
  v_cndmask_b32 v37, v31, v37, s[66:67]
  v_cndmask_b32 v49, v31, v49, s[66:67]
  v_cndmask_b32 v38, v31, v38, s[68:69]
  v_cndmask_b32 v50, v31, v50, s[68:69]
  v_cndmask_b32 v39, v31, v39, s[70:71]
  v_cndmask_b32 v51, v31, v51, s[70:71]
  v_max3_f32 v34, v36, v37, v38
  v_max3_f32 v34, v34, v39, v40
  v_max3_f32 v34, v34, v41, v42
  v_max_f32 v34, v34, v43
  v_mov_b32 v35, v34
  s_nop 1
  v_permlane32_swap_b32 v34, v35
  v_max_f32 v34, v34, v35
  v_mov_b32 v35, v34
  s_nop 1
  v_permlane16_swap_b32 v34, v35
  v_max_f32 v34, v34, v35
  v_mul_f32 v34, s83, v34
  v_fma_f32 v36, v36, s83, -v34
  v_fma_f32 v37, v37, s83, -v34
  v_fma_f32 v38, v38, s83, -v34
  v_fma_f32 v39, v39, s83, -v34
  v_fma_f32 v40, v40, s83, -v34
  v_fma_f32 v41, v41, s83, -v34
  v_fma_f32 v42, v42, s83, -v34
  v_fma_f32 v43, v43, s83, -v34
  v_exp_f32 v36, v36
  v_exp_f32 v37, v37
  v_exp_f32 v38, v38
  v_exp_f32 v39, v39
  v_exp_f32 v40, v40
  v_exp_f32 v41, v41
  v_exp_f32 v42, v42
  v_exp_f32 v43, v43
  s_nop 0
  v_add_f32 v34, v40, v41
  v_add_f32 v34, v34, v42
  v_add_f32 v34, v34, v43
  v_cndmask_b32 v34, 0, v34, s[62:63]
  v_add_f32 v34, v34, v36
  v_add_f32 v34, v34, v37
  v_add_f32 v34, v34, v38
  v_add_f32 v34, v34, v39
  v_mov_b32 v35, v34
  s_nop 1
  v_permlane32_swap_b32 v34, v35
  v_add_f32 v34, v34, v35
  v_mov_b32 v35, v34
  s_nop 1
  v_permlane16_swap_b32 v34, v35
  v_add_f32 v34, v34, v35
  v_rcp_f32 v34, v34
  s_nop 0
  v_mul_f32 v36, v36, v34
  v_mul_f32 v37, v37, v34
  v_mul_f32 v38, v38, v34
  v_mul_f32 v39, v39, v34
  v_mul_f32 v40, v40, v34
  v_mul_f32 v41, v41, v34
  v_mul_f32 v42, v42, v34
  v_mul_f32 v43, v43, v34
  v_max3_f32 v34, v44, v45, v46
  v_max3_f32 v34, v34, v47, v48
  v_max3_f32 v34, v34, v49, v50
  v_max3_f32 v34, v34, v51, v52
  v_max3_f32 v34, v34, v53, v54
  v_max_f32 v34, v34, v55
  v_mov_b32 v35, v34
  s_nop 1
  v_permlane32_swap_b32 v34, v35
  v_max_f32 v34, v34, v35
  v_mov_b32 v35, v34
  s_nop 1
  v_permlane16_swap_b32 v34, v35
  v_max_f32 v34, v34, v35
  v_mul_f32 v34, s83, v34
  v_fma_f32 v44, v44, s83, -v34
  v_fma_f32 v45, v45, s83, -v34
  v_fma_f32 v46, v46, s83, -v34
  v_fma_f32 v47, v47, s83, -v34
  v_fma_f32 v48, v48, s83, -v34
  v_fma_f32 v49, v49, s83, -v34
  v_fma_f32 v50, v50, s83, -v34
  v_fma_f32 v51, v51, s83, -v34
  v_fma_f32 v52, v52, s83, -v34
  v_fma_f32 v53, v53, s83, -v34
  v_fma_f32 v54, v54, s83, -v34
  v_fma_f32 v55, v55, s83, -v34
  v_exp_f32 v44, v44
  v_exp_f32 v45, v45
  v_exp_f32 v46, v46
  v_exp_f32 v47, v47
  v_exp_f32 v48, v48
  v_exp_f32 v49, v49
  v_exp_f32 v50, v50
  v_exp_f32 v51, v51
  v_exp_f32 v52, v52
  v_exp_f32 v53, v53
  v_exp_f32 v54, v54
  v_exp_f32 v55, v55
  s_nop 0
  v_add_f32 v34, v52, v53
  v_add_f32 v34, v34, v54
  v_add_f32 v34, v34, v55
  v_cndmask_b32 v34, 0, v34, s[62:63]
  v_add_f32 v34, v34, v44
  v_add_f32 v34, v34, v45
  v_add_f32 v34, v34, v46
  v_add_f32 v34, v34, v47
  v_add_f32 v34, v34, v48
  v_add_f32 v34, v34, v49
  v_add_f32 v34, v34, v50
  v_add_f32 v34, v34, v51
  v_mov_b32 v35, v34
  s_nop 1
  v_permlane32_swap_b32 v34, v35
  v_add_f32 v34, v34, v35
  v_mov_b32 v35, v34
  s_nop 1
  v_permlane16_swap_b32 v34, v35
  v_add_f32 v34, v34, v35
  v_rcp_f32 v34, v34
  s_nop 0
  v_mul_f32 v44, v44, v34
  v_mul_f32 v45, v45, v34
  v_mul_f32 v46, v46, v34
  v_mul_f32 v47, v47, v34
  v_mul_f32 v48, v48, v34
  v_mul_f32 v49, v49, v34
  v_mul_f32 v50, v50, v34
  v_mul_f32 v51, v51, v34
  v_mul_f32 v52, v52, v34
  v_mul_f32 v53, v53, v34
  v_mul_f32 v54, v54, v34
  v_mul_f32 v55, v55, v34
  v_cvt_pk_bf16_f32 v56, v44, v45
  v_cvt_pk_bf16_f32 v57, v46, v47
  v_cvt_pk_bf16_f32 v58, v48, v49
  v_cvt_pk_bf16_f32 v59, v50, v51
  v_cvt_pk_bf16_f32 v60, v40, v41
  v_cvt_pk_bf16_f32 v61, v42, v43
  v_cvt_pk_bf16_f32 v62, v52, v53
  v_cvt_pk_bf16_f32 v63, v54, v55
  v_cvt_pk_bf16_f32 v248, v36, v37
  v_cvt_pk_bf16_f32 v249, v38, v39
  buffer_store_dwordx4 v[56:59], v26, s[16:19], s81 offen sc1
  buffer_store_dwordx4 v[60:63], v26, s[16:19], s81 offen offset:1024 sc1
  buffer_store_dwordx2 v[248:249], v29, s[16:19], s81 offen offset:2048 sc1
  s_mov_b32 s84, s82
  s_mov_b32 s49, s43
  s_mov_b32 s50, s45
  s_mov_b32 s81, s47
  s_mov_b32 s82, s48
  s_add_u32 s43, s43, 4
  s_add_u32 s45, s45, 8388608
  s_add_u32 s47, s47, 2097152
  s_xor_b32 s47, s47, 8192
  s_add_u32 s48, s48, 512
  ds_read_b128 v[64:67], v21 offset:0
  ds_read_b128 v[68:71], v21 offset:1024
  ds_read_b128 v[72:75], v21 offset:3072
  ds_read_b128 v[76:79], v21 offset:4096
  ds_read2st64_b64 v[80:83], v22 offset0:0 offset1:6
  ds_read2st64_b64 v[84:87], v23 offset0:0 offset1:6
  ds_read_b128 v[88:91], v21 offset:6144
  ds_read_b128 v[92:95], v21 offset:7168
  ds_read_b128 v[96:99], v21 offset:9216
  ds_read_b128 v[100:103], v21 offset:10240
  ds_read2st64_b64 v[104:107], v22 offset0:12 offset1:18
  ds_read2st64_b64 v[108:111], v23 offset0:12 offset1:18
  s_cmp_gt_u32 s49, 60
  s_cselect_b32 s23, 58, s49
  s_mov_b32 s101, 0
wm_277:
  buffer_load_dword v34, v30, s[72:75], s77 offen sc1
  s_add_u32 s101, s101, 1
  s_cmp_gt_u32 s101, 131072
  s_cbranch_scc1 main_end
  s_waitcnt vmcnt(0)
  v_cmp_gt_u32 vcc, s23, v34
  v_readfirstlane_b32 s100, v34
  s_nop 0
  s_cbranch_vccz wm_278
  s_sleep 4
  s_add_u32 s100, s100, 2
  s_cmp_ge_u32 s100, s23
  s_cbranch_scc1 wm_277
  s_sleep 40
  s_branch wm_277
wm_278:
  s_add_u32 s29, s50, 0
  buffer_load_dwordx4 v[112:115], v26, s[16:19], s29 offen offset:0 sc1
  buffer_load_dwordx4 v[116:119], v26, s[16:19], s29 offen offset:1024 sc1
  buffer_load_dwordx4 v[144:147], v26, s[16:19], s29 offen offset:2048 sc1
  s_add_u32 s29, s50, 16384
  buffer_load_dwordx4 v[120:123], v26, s[16:19], s29 offen offset:0 sc1
  buffer_load_dwordx4 v[124:127], v26, s[16:19], s29 offen offset:1024 sc1
  buffer_load_dwordx4 v[148:151], v26, s[16:19], s29 offen offset:2048 sc1
  s_add_u32 s29, s50, 32768
  buffer_load_dwordx4 v[128:131], v26, s[16:19], s29 offen offset:0 sc1
  buffer_load_dwordx4 v[132:135], v26, s[16:19], s29 offen offset:1024 sc1
  buffer_load_dwordx4 v[152:155], v26, s[16:19], s29 offen offset:2048 sc1
  s_add_u32 s29, s50, 49152
  buffer_load_dwordx4 v[136:139], v26, s[16:19], s29 offen offset:0 sc1
  buffer_load_dwordx4 v[140:143], v26, s[16:19], s29 offen offset:1024 sc1
  buffer_load_dwordx4 v[156:159], v26, s[16:19], s29 offen offset:2048 sc1
  s_waitcnt vmcnt(0) lgkmcnt(0)
  buffer_atomic_add v28, v33, s[72:75], s84 offen sc1
  v_swap_b32 v146, v148
  v_swap_b32 v147, v149
  v_swap_b32 v154, v156
  v_swap_b32 v155, v157
  s_nop 1
  v_mfma_f32_16x16x32_bf16 v[36:39], v[112:115], v[64:67], 0
  v_mfma_f32_16x16x32_bf16 v[44:47], v[112:115], v[68:71], 0
  v_mfma_f32_16x16x32_bf16 v[48:51], v[116:119], v[68:71], 0
  v_mfma_f32_16x16x32_bf16 v[36:39], v[120:123], v[72:75], v[36:39]
  v_mfma_f32_16x16x32_bf16 v[44:47], v[120:123], v[76:79], v[44:47]
  v_mfma_f32_16x16x32_bf16 v[48:51], v[124:127], v[76:79], v[48:51]
  v_mfma_f32_16x16x32_bf16 v[36:39], v[144:147], v[80:83], v[36:39]
  v_mfma_f32_16x16x32_bf16 v[44:47], v[144:147], v[84:87], v[44:47]
  v_mfma_f32_16x16x32_bf16 v[48:51], v[148:151], v[84:87], v[48:51]
  v_mfma_f32_16x16x32_bf16 v[36:39], v[128:131], v[88:91], v[36:39]
  v_mfma_f32_16x16x32_bf16 v[44:47], v[128:131], v[92:95], v[44:47]
  v_mfma_f32_16x16x32_bf16 v[48:51], v[132:135], v[92:95], v[48:51]
  v_mfma_f32_16x16x32_bf16 v[36:39], v[136:139], v[96:99], v[36:39]
  v_mfma_f32_16x16x32_bf16 v[44:47], v[136:139], v[100:103], v[44:47]
  v_mfma_f32_16x16x32_bf16 v[48:51], v[140:143], v[100:103], v[48:51]
  v_mfma_f32_16x16x32_bf16 v[36:39], v[152:155], v[104:107], v[36:39]
  v_mfma_f32_16x16x32_bf16 v[44:47], v[152:155], v[108:111], v[44:47]
  v_mfma_f32_16x16x32_bf16 v[48:51], v[156:159], v[108:111], v[48:51]
  s_cmp_le_u32 s49, 60
  s_cbranch_scc1 qtp_281
  s_sub_u32 s23, s49, 1
  s_min_u32 s23, s23, 62
  s_mov_b32 s101, 0
wm_282:
  buffer_load_dword v34, v30, s[72:75], s77 offen sc1
  s_add_u32 s101, s101, 1
  s_cmp_gt_u32 s101, 131072
  s_cbranch_scc1 main_end
  s_waitcnt vmcnt(0)
  v_cmp_gt_u32 vcc, s23, v34
  v_readfirstlane_b32 s100, v34
  s_nop 0
  s_cbranch_vccz wm_283
  s_sleep 4
  s_add_u32 s100, s100, 2
  s_cmp_ge_u32 s100, s23
  s_cbranch_scc1 wm_282
  s_sleep 40
  s_branch wm_282
wm_283:
qtp_281:
  s_mov_b32 s101, 0
  s_branch qtp_280
qtp_279:
  s_sleep 2
qtp_280:
  s_add_u32 s29, s50, 4096
  buffer_load_dwordx4 v[160:163], v24, s[16:19], s29 offen offset:2560 sc1
  buffer_load_dwordx2 v[240:241], v25, s[16:19], s29 offen offset:3072 sc1
  s_add_u32 s29, s50, 20480
  buffer_load_dwordx4 v[164:167], v24, s[16:19], s29 offen offset:2560 sc1
  buffer_load_dwordx2 v[242:243], v25, s[16:19], s29 offen offset:3072 sc1
  s_add_u32 s29, s50, 36864
  buffer_load_dwordx4 v[168:171], v24, s[16:19], s29 offen offset:2560 sc1
  buffer_load_dwordx2 v[244:245], v25, s[16:19], s29 offen offset:3072 sc1
  s_add_u32 s29, s50, 53248
  buffer_load_dwordx4 v[172:175], v24, s[16:19], s29 offen offset:2560 sc1
  buffer_load_dwordx2 v[246:247], v25, s[16:19], s29 offen offset:3072 sc1
  s_add_u32 s101, s101, 1
  s_cmp_gt_u32 s101, 131072
  s_cbranch_scc1 main_end
  s_waitcnt vmcnt(0)
  v_max3_u32 v34, v160, v164, v168
  v_max3_u32 v34, v34, v172, v240
  v_max3_u32 v34, v34, v242, v244
  v_max_u32 v34, v34, v246
  v_cmp_eq_u32 vcc, -1, v34
  s_nop 1
  s_cbranch_vccnz qtp_279
  v_mfma_f32_16x16x32_bf16 v[40:43], v[160:163], v[64:67], 0
  v_mfma_f32_16x16x32_bf16 v[52:55], v[160:163], v[68:71], 0
  v_mfma_f32_16x16x32_bf16 v[40:43], v[164:167], v[72:75], v[40:43]
  v_mfma_f32_16x16x32_bf16 v[52:55], v[164:167], v[76:79], v[52:55]
  v_mfma_f32_16x16x32_bf16 v[40:43], v[240:243], v[80:83], v[40:43]
  v_mfma_f32_16x16x32_bf16 v[52:55], v[240:243], v[84:87], v[52:55]
  v_mfma_f32_16x16x32_bf16 v[40:43], v[168:171], v[88:91], v[40:43]
  v_mfma_f32_16x16x32_bf16 v[52:55], v[168:171], v[92:95], v[52:55]
  v_mfma_f32_16x16x32_bf16 v[40:43], v[172:175], v[96:99], v[40:43]
  v_mfma_f32_16x16x32_bf16 v[52:55], v[172:175], v[100:103], v[52:55]
  v_mfma_f32_16x16x32_bf16 v[40:43], v[244:247], v[104:107], v[40:43]
  v_mfma_f32_16x16x32_bf16 v[52:55], v[244:247], v[108:111], v[52:55]
  s_nop 4
  v_cndmask_b32 v36, v31, v36, s[64:65]
  v_cndmask_b32 v48, v31, v48, s[64:65]
  v_cndmask_b32 v37, v31, v37, s[66:67]
  v_cndmask_b32 v49, v31, v49, s[66:67]
  v_cndmask_b32 v38, v31, v38, s[68:69]
  v_cndmask_b32 v50, v31, v50, s[68:69]
  v_cndmask_b32 v39, v31, v39, s[70:71]
  v_cndmask_b32 v51, v31, v51, s[70:71]
  v_max3_f32 v34, v36, v37, v38
  v_max3_f32 v34, v34, v39, v40
  v_max3_f32 v34, v34, v41, v42
  v_max_f32 v34, v34, v43
  v_mov_b32 v35, v34
  s_nop 1
  v_permlane32_swap_b32 v34, v35
  v_max_f32 v34, v34, v35
  v_mov_b32 v35, v34
  s_nop 1
  v_permlane16_swap_b32 v34, v35
  v_max_f32 v34, v34, v35
  v_mul_f32 v34, s83, v34
  v_fma_f32 v36, v36, s83, -v34
  v_fma_f32 v37, v37, s83, -v34
  v_fma_f32 v38, v38, s83, -v34
  v_fma_f32 v39, v39, s83, -v34
  v_fma_f32 v40, v40, s83, -v34
  v_fma_f32 v41, v41, s83, -v34
  v_fma_f32 v42, v42, s83, -v34
  v_fma_f32 v43, v43, s83, -v34
  v_exp_f32 v36, v36
  v_exp_f32 v37, v37
  v_exp_f32 v38, v38
  v_exp_f32 v39, v39
  v_exp_f32 v40, v40
  v_exp_f32 v41, v41
  v_exp_f32 v42, v42
  v_exp_f32 v43, v43
  s_nop 0
  v_add_f32 v34, v40, v41
  v_add_f32 v34, v34, v42
  v_add_f32 v34, v34, v43
  v_cndmask_b32 v34, 0, v34, s[62:63]
  v_add_f32 v34, v34, v36
  v_add_f32 v34, v34, v37
  v_add_f32 v34, v34, v38
  v_add_f32 v34, v34, v39
  v_mov_b32 v35, v34
  s_nop 1
  v_permlane32_swap_b32 v34, v35
  v_add_f32 v34, v34, v35
  v_mov_b32 v35, v34
  s_nop 1
  v_permlane16_swap_b32 v34, v35
  v_add_f32 v34, v34, v35
  v_rcp_f32 v34, v34
  s_nop 0
  v_mul_f32 v36, v36, v34
  v_mul_f32 v37, v37, v34
  v_mul_f32 v38, v38, v34
  v_mul_f32 v39, v39, v34
  v_mul_f32 v40, v40, v34
  v_mul_f32 v41, v41, v34
  v_mul_f32 v42, v42, v34
  v_mul_f32 v43, v43, v34
  v_max3_f32 v34, v44, v45, v46
  v_max3_f32 v34, v34, v47, v48
  v_max3_f32 v34, v34, v49, v50
  v_max3_f32 v34, v34, v51, v52
  v_max3_f32 v34, v34, v53, v54
  v_max_f32 v34, v34, v55
  v_mov_b32 v35, v34
  s_nop 1
  v_permlane32_swap_b32 v34, v35
  v_max_f32 v34, v34, v35
  v_mov_b32 v35, v34
  s_nop 1
  v_permlane16_swap_b32 v34, v35
  v_max_f32 v34, v34, v35
  v_mul_f32 v34, s83, v34
  v_fma_f32 v44, v44, s83, -v34
  v_fma_f32 v45, v45, s83, -v34
  v_fma_f32 v46, v46, s83, -v34
  v_fma_f32 v47, v47, s83, -v34
  v_fma_f32 v48, v48, s83, -v34
  v_fma_f32 v49, v49, s83, -v34
  v_fma_f32 v50, v50, s83, -v34
  v_fma_f32 v51, v51, s83, -v34
  v_fma_f32 v52, v52, s83, -v34
  v_fma_f32 v53, v53, s83, -v34
  v_fma_f32 v54, v54, s83, -v34
  v_fma_f32 v55, v55, s83, -v34
  v_exp_f32 v44, v44
  v_exp_f32 v45, v45
  v_exp_f32 v46, v46
  v_exp_f32 v47, v47
  v_exp_f32 v48, v48
  v_exp_f32 v49, v49
  v_exp_f32 v50, v50
  v_exp_f32 v51, v51
  v_exp_f32 v52, v52
  v_exp_f32 v53, v53
  v_exp_f32 v54, v54
  v_exp_f32 v55, v55
  s_nop 0
  v_add_f32 v34, v52, v53
  v_add_f32 v34, v34, v54
  v_add_f32 v34, v34, v55
  v_cndmask_b32 v34, 0, v34, s[62:63]
  v_add_f32 v34, v34, v44
  v_add_f32 v34, v34, v45
  v_add_f32 v34, v34, v46
  v_add_f32 v34, v34, v47
  v_add_f32 v34, v34, v48
  v_add_f32 v34, v34, v49
  v_add_f32 v34, v34, v50
  v_add_f32 v34, v34, v51
  v_mov_b32 v35, v34
  s_nop 1
  v_permlane32_swap_b32 v34, v35
  v_add_f32 v34, v34, v35
  v_mov_b32 v35, v34
  s_nop 1
  v_permlane16_swap_b32 v34, v35
  v_add_f32 v34, v34, v35
  v_rcp_f32 v34, v34
  s_nop 0
  v_mul_f32 v44, v44, v34
  v_mul_f32 v45, v45, v34
  v_mul_f32 v46, v46, v34
  v_mul_f32 v47, v47, v34
  v_mul_f32 v48, v48, v34
  v_mul_f32 v49, v49, v34
  v_mul_f32 v50, v50, v34
  v_mul_f32 v51, v51, v34
  v_mul_f32 v52, v52, v34
  v_mul_f32 v53, v53, v34
  v_mul_f32 v54, v54, v34
  v_mul_f32 v55, v55, v34
  v_cvt_pk_bf16_f32 v56, v44, v45
  v_cvt_pk_bf16_f32 v57, v46, v47
  v_cvt_pk_bf16_f32 v58, v48, v49
  v_cvt_pk_bf16_f32 v59, v50, v51
  v_cvt_pk_bf16_f32 v60, v40, v41
  v_cvt_pk_bf16_f32 v61, v42, v43
  v_cvt_pk_bf16_f32 v62, v52, v53
  v_cvt_pk_bf16_f32 v63, v54, v55
  v_cvt_pk_bf16_f32 v248, v36, v37
  v_cvt_pk_bf16_f32 v249, v38, v39
  buffer_store_dwordx4 v[56:59], v26, s[16:19], s81 offen sc1
  buffer_store_dwordx4 v[60:63], v26, s[16:19], s81 offen offset:1024 sc1
  buffer_store_dwordx2 v[248:249], v29, s[16:19], s81 offen offset:2048 sc1
  s_mov_b32 s84, s82
  s_mov_b32 s49, s43
  s_mov_b32 s50, s45
  s_mov_b32 s81, s47
  s_mov_b32 s82, s48
  s_add_u32 s43, s43, 4
  s_add_u32 s45, s45, 8388608
  s_add_u32 s47, s47, 2097152
  s_xor_b32 s47, s47, 8192
  s_add_u32 s48, s48, 512
  s_mul_i32 s21, s20, 12288
  s_add_u32 s21, s21, s86
  buffer_load_dwordx4 v[64:67], v26, s[56:59], s21 offen offset:0 sc1
  buffer_load_dwordx4 v[68:71], v26, s[56:59], s21 offen offset:1024 sc1
  buffer_load_dwordx4 v[96:99], v26, s[56:59], s21 offen offset:2048 sc1
  s_add_u32 s21, s21, 3072
  buffer_load_dwordx4 v[72:75], v26, s[56:59], s21 offen offset:0 sc1
  buffer_load_dwordx4 v[76:79], v26, s[56:59], s21 offen offset:1024 sc1
  buffer_load_dwordx4 v[100:103], v26, s[56:59], s21 offen offset:2048 sc1
  s_add_u32 s21, s21, 3072
  buffer_load_dwordx4 v[80:83], v26, s[56:59], s21 offen offset:0 sc1
  buffer_load_dwordx4 v[84:87], v26, s[56:59], s21 offen offset:1024 sc1
  buffer_load_dwordx4 v[104:107], v26, s[56:59], s21 offen offset:2048 sc1
  s_add_u32 s21, s21, 3072
  buffer_load_dwordx4 v[88:91], v26, s[56:59], s21 offen offset:0 sc1
  buffer_load_dwordx4 v[92:95], v26, s[56:59], s21 offen offset:1024 sc1
  buffer_load_dwordx4 v[108:111], v26, s[56:59], s21 offen offset:2048 sc1
  s_add_u32 s21, s21, 3072
  s_cmp_gt_u32 s49, 60
  s_cselect_b32 s23, 58, s49
  s_mov_b32 s101, 0
wm_284:
  buffer_load_dword v34, v30, s[72:75], s77 offen sc1
  s_add_u32 s101, s101, 1
  s_cmp_gt_u32 s101, 131072
  s_cbranch_scc1 main_end
  s_waitcnt vmcnt(0)
  v_cmp_gt_u32 vcc, s23, v34
  v_readfirstlane_b32 s100, v34
  s_nop 0
  s_cbranch_vccz wm_285
  s_sleep 4
  s_add_u32 s100, s100, 2
  s_cmp_ge_u32 s100, s23
  s_cbranch_scc1 wm_284
  s_sleep 40
  s_branch wm_284
wm_285:
  s_add_u32 s29, s50, 0
  buffer_load_dwordx4 v[112:115], v26, s[16:19], s29 offen offset:0 sc1
  buffer_load_dwordx4 v[116:119], v26, s[16:19], s29 offen offset:1024 sc1
  buffer_load_dwordx4 v[144:147], v26, s[16:19], s29 offen offset:2048 sc1
  s_add_u32 s29, s50, 16384
  buffer_load_dwordx4 v[120:123], v26, s[16:19], s29 offen offset:0 sc1
  buffer_load_dwordx4 v[124:127], v26, s[16:19], s29 offen offset:1024 sc1
  buffer_load_dwordx4 v[148:151], v26, s[16:19], s29 offen offset:2048 sc1
  s_add_u32 s29, s50, 32768
  buffer_load_dwordx4 v[128:131], v26, s[16:19], s29 offen offset:0 sc1
  buffer_load_dwordx4 v[132:135], v26, s[16:19], s29 offen offset:1024 sc1
  buffer_load_dwordx4 v[152:155], v26, s[16:19], s29 offen offset:2048 sc1
  s_add_u32 s29, s50, 49152
  buffer_load_dwordx4 v[136:139], v26, s[16:19], s29 offen offset:0 sc1
  buffer_load_dwordx4 v[140:143], v26, s[16:19], s29 offen offset:1024 sc1
  buffer_load_dwordx4 v[156:159], v26, s[16:19], s29 offen offset:2048 sc1
  s_waitcnt vmcnt(0) lgkmcnt(0)
  buffer_atomic_add v28, v33, s[72:75], s84 offen sc1
  v_swap_b32 v98, v100
  v_swap_b32 v99, v101
  v_swap_b32 v106, v108
  v_swap_b32 v107, v109
  v_swap_b32 v146, v148
  v_swap_b32 v147, v149
  v_swap_b32 v154, v156
  v_swap_b32 v155, v157
  s_nop 1
  v_mfma_f32_16x16x32_bf16 v[36:39], v[112:115], v[64:67], 0
  v_mfma_f32_16x16x32_bf16 v[44:47], v[112:115], v[68:71], 0
  v_mfma_f32_16x16x32_bf16 v[48:51], v[116:119], v[68:71], 0
  v_mfma_f32_16x16x32_bf16 v[36:39], v[120:123], v[72:75], v[36:39]
  v_mfma_f32_16x16x32_bf16 v[44:47], v[120:123], v[76:79], v[44:47]
  v_mfma_f32_16x16x32_bf16 v[48:51], v[124:127], v[76:79], v[48:51]
  v_mfma_f32_16x16x32_bf16 v[36:39], v[144:147], v[96:99], v[36:39]
  v_mfma_f32_16x16x32_bf16 v[44:47], v[144:147], v[100:103], v[44:47]
  v_mfma_f32_16x16x32_bf16 v[48:51], v[148:151], v[100:103], v[48:51]
  v_mfma_f32_16x16x32_bf16 v[36:39], v[128:131], v[80:83], v[36:39]
  v_mfma_f32_16x16x32_bf16 v[44:47], v[128:131], v[84:87], v[44:47]
  v_mfma_f32_16x16x32_bf16 v[48:51], v[132:135], v[84:87], v[48:51]
  v_mfma_f32_16x16x32_bf16 v[36:39], v[136:139], v[88:91], v[36:39]
  v_mfma_f32_16x16x32_bf16 v[44:47], v[136:139], v[92:95], v[44:47]
  v_mfma_f32_16x16x32_bf16 v[48:51], v[140:143], v[92:95], v[48:51]
  v_mfma_f32_16x16x32_bf16 v[36:39], v[152:155], v[104:107], v[36:39]
  v_mfma_f32_16x16x32_bf16 v[44:47], v[152:155], v[108:111], v[44:47]
  v_mfma_f32_16x16x32_bf16 v[48:51], v[156:159], v[108:111], v[48:51]
  s_cmp_le_u32 s49, 60
  s_cbranch_scc1 qtp_288
  s_sub_u32 s23, s49, 1
  s_min_u32 s23, s23, 62
  s_mov_b32 s101, 0
wm_289:
  buffer_load_dword v34, v30, s[72:75], s77 offen sc1
  s_add_u32 s101, s101, 1
  s_cmp_gt_u32 s101, 131072
  s_cbranch_scc1 main_end
  s_waitcnt vmcnt(0)
  v_cmp_gt_u32 vcc, s23, v34
  v_readfirstlane_b32 s100, v34
  s_nop 0
  s_cbranch_vccz wm_290
  s_sleep 4
  s_add_u32 s100, s100, 2
  s_cmp_ge_u32 s100, s23
  s_cbranch_scc1 wm_289
  s_sleep 40
  s_branch wm_289
wm_290:
qtp_288:
  s_mov_b32 s101, 0
  s_branch qtp_287
qtp_286:
  s_sleep 2
qtp_287:
  s_add_u32 s29, s50, 4096
  buffer_load_dwordx4 v[160:163], v24, s[16:19], s29 offen offset:2560 sc1
  buffer_load_dwordx2 v[240:241], v25, s[16:19], s29 offen offset:3072 sc1
  s_add_u32 s29, s50, 20480
  buffer_load_dwordx4 v[164:167], v24, s[16:19], s29 offen offset:2560 sc1
  buffer_load_dwordx2 v[242:243], v25, s[16:19], s29 offen offset:3072 sc1
  s_add_u32 s29, s50, 36864
  buffer_load_dwordx4 v[168:171], v24, s[16:19], s29 offen offset:2560 sc1
  buffer_load_dwordx2 v[244:245], v25, s[16:19], s29 offen offset:3072 sc1
  s_add_u32 s29, s50, 53248
  buffer_load_dwordx4 v[172:175], v24, s[16:19], s29 offen offset:2560 sc1
  buffer_load_dwordx2 v[246:247], v25, s[16:19], s29 offen offset:3072 sc1
  s_add_u32 s101, s101, 1
  s_cmp_gt_u32 s101, 131072
  s_cbranch_scc1 main_end
  s_waitcnt vmcnt(0)
  v_max3_u32 v34, v160, v164, v168
  v_max3_u32 v34, v34, v172, v240
  v_max3_u32 v34, v34, v242, v244
  v_max_u32 v34, v34, v246
  v_cmp_eq_u32 vcc, -1, v34
  s_nop 1
  s_cbranch_vccnz qtp_286
  v_mfma_f32_16x16x32_bf16 v[40:43], v[160:163], v[64:67], 0
  v_mfma_f32_16x16x32_bf16 v[52:55], v[160:163], v[68:71], 0
  v_mfma_f32_16x16x32_bf16 v[40:43], v[164:167], v[72:75], v[40:43]
  v_mfma_f32_16x16x32_bf16 v[52:55], v[164:167], v[76:79], v[52:55]
  v_mfma_f32_16x16x32_bf16 v[40:43], v[240:243], v[96:99], v[40:43]
  v_mfma_f32_16x16x32_bf16 v[52:55], v[240:243], v[100:103], v[52:55]
  v_mfma_f32_16x16x32_bf16 v[40:43], v[168:171], v[80:83], v[40:43]
  v_mfma_f32_16x16x32_bf16 v[52:55], v[168:171], v[84:87], v[52:55]
  v_mfma_f32_16x16x32_bf16 v[40:43], v[172:175], v[88:91], v[40:43]
  v_mfma_f32_16x16x32_bf16 v[52:55], v[172:175], v[92:95], v[52:55]
  v_mfma_f32_16x16x32_bf16 v[40:43], v[244:247], v[104:107], v[40:43]
  v_mfma_f32_16x16x32_bf16 v[52:55], v[244:247], v[108:111], v[52:55]
  s_nop 4
  v_cndmask_b32 v36, v31, v36, s[64:65]
  v_cndmask_b32 v48, v31, v48, s[64:65]
  v_cndmask_b32 v37, v31, v37, s[66:67]
  v_cndmask_b32 v49, v31, v49, s[66:67]
  v_cndmask_b32 v38, v31, v38, s[68:69]
  v_cndmask_b32 v50, v31, v50, s[68:69]
  v_cndmask_b32 v39, v31, v39, s[70:71]
  v_cndmask_b32 v51, v31, v51, s[70:71]
  v_max3_f32 v34, v36, v37, v38
  v_max3_f32 v34, v34, v39, v40
  v_max3_f32 v34, v34, v41, v42
  v_max_f32 v34, v34, v43
  v_mov_b32 v35, v34
  s_nop 1
  v_permlane32_swap_b32 v34, v35
  v_max_f32 v34, v34, v35
  v_mov_b32 v35, v34
  s_nop 1
  v_permlane16_swap_b32 v34, v35
  v_max_f32 v34, v34, v35
  v_mul_f32 v34, s83, v34
  v_fma_f32 v36, v36, s83, -v34
  v_fma_f32 v37, v37, s83, -v34
  v_fma_f32 v38, v38, s83, -v34
  v_fma_f32 v39, v39, s83, -v34
  v_fma_f32 v40, v40, s83, -v34
  v_fma_f32 v41, v41, s83, -v34
  v_fma_f32 v42, v42, s83, -v34
  v_fma_f32 v43, v43, s83, -v34
  v_exp_f32 v36, v36
  v_exp_f32 v37, v37
  v_exp_f32 v38, v38
  v_exp_f32 v39, v39
  v_exp_f32 v40, v40
  v_exp_f32 v41, v41
  v_exp_f32 v42, v42
  v_exp_f32 v43, v43
  s_nop 0
  v_add_f32 v34, v40, v41
  v_add_f32 v34, v34, v42
  v_add_f32 v34, v34, v43
  v_cndmask_b32 v34, 0, v34, s[62:63]
  v_add_f32 v34, v34, v36
  v_add_f32 v34, v34, v37
  v_add_f32 v34, v34, v38
  v_add_f32 v34, v34, v39
  v_mov_b32 v35, v34
  s_nop 1
  v_permlane32_swap_b32 v34, v35
  v_add_f32 v34, v34, v35
  v_mov_b32 v35, v34
  s_nop 1
  v_permlane16_swap_b32 v34, v35
  v_add_f32 v34, v34, v35
  v_rcp_f32 v34, v34
  s_nop 0
  v_mul_f32 v36, v36, v34
  v_mul_f32 v37, v37, v34
  v_mul_f32 v38, v38, v34
  v_mul_f32 v39, v39, v34
  v_mul_f32 v40, v40, v34
  v_mul_f32 v41, v41, v34
  v_mul_f32 v42, v42, v34
  v_mul_f32 v43, v43, v34
  v_max3_f32 v34, v44, v45, v46
  v_max3_f32 v34, v34, v47, v48
  v_max3_f32 v34, v34, v49, v50
  v_max3_f32 v34, v34, v51, v52
  v_max3_f32 v34, v34, v53, v54
  v_max_f32 v34, v34, v55
  v_mov_b32 v35, v34
  s_nop 1
  v_permlane32_swap_b32 v34, v35
  v_max_f32 v34, v34, v35
  v_mov_b32 v35, v34
  s_nop 1
  v_permlane16_swap_b32 v34, v35
  v_max_f32 v34, v34, v35
  v_mul_f32 v34, s83, v34
  v_fma_f32 v44, v44, s83, -v34
  v_fma_f32 v45, v45, s83, -v34
  v_fma_f32 v46, v46, s83, -v34
  v_fma_f32 v47, v47, s83, -v34
  v_fma_f32 v48, v48, s83, -v34
  v_fma_f32 v49, v49, s83, -v34
  v_fma_f32 v50, v50, s83, -v34
  v_fma_f32 v51, v51, s83, -v34
  v_fma_f32 v52, v52, s83, -v34
  v_fma_f32 v53, v53, s83, -v34
  v_fma_f32 v54, v54, s83, -v34
  v_fma_f32 v55, v55, s83, -v34
  v_exp_f32 v44, v44
  v_exp_f32 v45, v45
  v_exp_f32 v46, v46
  v_exp_f32 v47, v47
  v_exp_f32 v48, v48
  v_exp_f32 v49, v49
  v_exp_f32 v50, v50
  v_exp_f32 v51, v51
  v_exp_f32 v52, v52
  v_exp_f32 v53, v53
  v_exp_f32 v54, v54
  v_exp_f32 v55, v55
  s_nop 0
  v_add_f32 v34, v52, v53
  v_add_f32 v34, v34, v54
  v_add_f32 v34, v34, v55
  v_cndmask_b32 v34, 0, v34, s[62:63]
  v_add_f32 v34, v34, v44
  v_add_f32 v34, v34, v45
  v_add_f32 v34, v34, v46
  v_add_f32 v34, v34, v47
  v_add_f32 v34, v34, v48
  v_add_f32 v34, v34, v49
  v_add_f32 v34, v34, v50
  v_add_f32 v34, v34, v51
  v_mov_b32 v35, v34
  s_nop 1
  v_permlane32_swap_b32 v34, v35
  v_add_f32 v34, v34, v35
  v_mov_b32 v35, v34
  s_nop 1
  v_permlane16_swap_b32 v34, v35
  v_add_f32 v34, v34, v35
  v_rcp_f32 v34, v34
  s_nop 0
  v_mul_f32 v44, v44, v34
  v_mul_f32 v45, v45, v34
  v_mul_f32 v46, v46, v34
  v_mul_f32 v47, v47, v34
  v_mul_f32 v48, v48, v34
  v_mul_f32 v49, v49, v34
  v_mul_f32 v50, v50, v34
  v_mul_f32 v51, v51, v34
  v_mul_f32 v52, v52, v34
  v_mul_f32 v53, v53, v34
  v_mul_f32 v54, v54, v34
  v_mul_f32 v55, v55, v34
  v_cvt_pk_bf16_f32 v56, v44, v45
  v_cvt_pk_bf16_f32 v57, v46, v47
  v_cvt_pk_bf16_f32 v58, v48, v49
  v_cvt_pk_bf16_f32 v59, v50, v51
  v_cvt_pk_bf16_f32 v60, v40, v41
  v_cvt_pk_bf16_f32 v61, v42, v43
  v_cvt_pk_bf16_f32 v62, v52, v53
  v_cvt_pk_bf16_f32 v63, v54, v55
  v_cvt_pk_bf16_f32 v248, v36, v37
  v_cvt_pk_bf16_f32 v249, v38, v39
  buffer_store_dwordx4 v[56:59], v26, s[16:19], s81 offen sc1
  buffer_store_dwordx4 v[60:63], v26, s[16:19], s81 offen offset:1024 sc1
  buffer_store_dwordx2 v[248:249], v29, s[16:19], s81 offen offset:2048 sc1
  s_mov_b32 s84, s82
  s_waitcnt vmcnt(0)
  buffer_atomic_add v28, v33, s[72:75], s82 offen sc1
  s_branch qe_291
qw_268:
  s_mov_b32 s101, 0
wm_292:
  buffer_load_dword v32, v30, s[72:75], s77 offen sc1
  s_add_u32 s101, s101, 1
  s_cmp_gt_u32 s101, 131072
  s_cbranch_scc1 main_end
  s_waitcnt vmcnt(0)
  v_cmp_gt_u32 vcc, s49, v32
  v_readfirstlane_b32 s100, v32
  s_nop 0
  s_cbranch_vccz wm_293
  s_sleep 4
  s_add_u32 s100, s100, 2
  s_cmp_ge_u32 s100, s49
  s_cbranch_scc1 wm_292
  s_sleep 60
  s_branch wm_292
wm_293:
  s_branch qj_269
qa2_263:
  s_mov_b32 s49, 0
  s_mov_b32 s50, 1073741824
  s_mov_b32 s81, 1073741824
  s_mov_b32 s82, 1073741824
  s_branch qa3_264
qs_265:
  s_mul_i32 s21, s20, 3072
  s_add_u32 s21, s21, s86
  buffer_store_dwordx4 v[192:195], v26, s[56:59], s21 offen offset:0 sc1
  buffer_store_dwordx4 v[196:199], v26, s[56:59], s21 offen offset:1024 sc1
  buffer_store_dwordx4 v[200:203], v26, s[56:59], s21 offen offset:2048 sc1
  s_add_u32 s21, s21, 12288
  buffer_store_dwordx4 v[204:207], v26, s[56:59], s21 offen offset:0 sc1
  buffer_store_dwordx4 v[208:211], v26, s[56:59], s21 offen offset:1024 sc1
  buffer_store_dwordx4 v[212:215], v26, s[56:59], s21 offen offset:2048 sc1
  s_add_u32 s21, s21, 12288
  buffer_store_dwordx4 v[216:219], v26, s[56:59], s21 offen offset:0 sc1
  buffer_store_dwordx4 v[220:223], v26, s[56:59], s21 offen offset:1024 sc1
  buffer_store_dwordx4 v[224:227], v26, s[56:59], s21 offen offset:2048 sc1
  s_add_u32 s21, s21, 12288
  buffer_store_dwordx4 v[228:231], v26, s[56:59], s21 offen offset:0 sc1
  buffer_store_dwordx4 v[232:235], v26, s[56:59], s21 offen offset:1024 sc1
  buffer_store_dwordx4 v[236:239], v26, s[56:59], s21 offen offset:2048 sc1
  s_add_u32 s21, s21, 12288
  s_branch qs_266
qe_291:
queue:
  s_mov_b32 s87, 16
  s_mov_b32 s88, 0
queue2:
  s_load_dwordx2 s[4:5], s[0:1], 88
  s_load_dwordx2 s[6:7], s[0:1], 72
  s_load_dwordx2 s[38:39], s[0:1], 104
  s_lshr_b32 s58, s3, 4
  s_bfe_u32 s21, s3, 0x20003
  s_cmp_lt_u32 s3, 64
  s_cselect_b32 s58, s58, s21
  s_cselect_b32 s21, 1, 0
  s_lshr_b32 s41, s3, s21
  s_and_b32 s41, s41, 7
  s_lshl_b32 s59, s58, 3
  s_add_u32 s59, s59, s41
  s_lshl_b32 s59, s59, 7
  s_add_u32 s59, s59, 40960
  s_xor_b32 s59, s59, s80
  s_waitcnt vmcnt(0) lgkmcnt(0)
  s_barrier
  s_mov_b32 s8, s4
  s_mov_b32 s9, s5
  s_mov_b32 s10, 2621440
  s_mov_b32 s11, 0x00020000
  s_mov_b32 s12, s6
  s_mov_b32 s13, s7
  s_mov_b32 s14, 819200
  s_mov_b32 s15, 0x00020000
  s_mov_b32 s16, s38
  s_mov_b32 s17, s39
  s_mov_b32 s18, 218103808
  s_mov_b32 s19, 0x00020000
  s_add_u32 s28, s38, 175112192
  s_addc_u32 s29, s39, 0
  s_mov_b32 s30, 8192
  s_mov_b32 s31, 0x00020000
  s_add_u32 s72, s38, 173080576
  s_addc_u32 s73, s39, 0
  s_mov_b32 s74, 49152
  s_mov_b32 s75, 0x00020000
  v_mov_b32 v30, 102400
  v_mov_b32 v233, 0x40000000
  v_cmp_eq_u32 vcc, 0, v0
  v_and_b32 v7, 7, v1
  v_lshlrev_b32 v7, 7, v7
  v_cndmask_b32 v233, v233, 0, vcc
  v_mov_b32 v29, 1
  buffer_atomic_add v29, v233, s[72:75], s59 offen sc0 sc1
  v_bfe_u32 v31, v1, 3, 2
  v_lshl_add_u32 v31, v31, 2, v7
  s_lshl_b32 s51, s20, 10
  s_add_u32 s51, s51, 4096
  s_xor_b32 s51, s51, s80
  buffer_load_dword v8, v31, s[72:75], s51 offen sc1
  v_and_b32 v25, 3, v1
  v_lshlrev_b32 v25, 7, v25
  s_xor_b32 s56, s80, 29696
  buffer_load_dword v26, v25, s[72:75], s56 offen sc1
  s_mul_i32 s21, s20, 204800
  s_mul_i32 s22, s41, 160
  s_add_u32 s21, s21, s22
  s_mul_i32 s22, s20, 25600
  v_add_u32 v5, 0, v1
  v_mul_u32_u24 v6, 6554, v5
  v_lshrrev_b32 v6, 16, v6
  v_mul_u32_u24 v6, 1120, v6
  v_lshl_add_u32 v144, v5, 4, v6
  v_add_u32 v5, 64, v1
  v_mul_u32_u24 v6, 6554, v5
  v_lshrrev_b32 v6, 16, v6
  v_mul_u32_u24 v6, 1120, v6
  v_lshl_add_u32 v145, v5, 4, v6
  v_add_u32 v5, 128, v1
  v_mul_u32_u24 v6, 6554, v5
  v_lshrrev_b32 v6, 16, v6
  v_mul_u32_u24 v6, 1120, v6
  v_lshl_add_u32 v146, v5, 4, v6
  v_add_u32 v5, 192, v1
  v_mul_u32_u24 v6, 6554, v5
  v_lshrrev_b32 v6, 16, v6
  v_mul_u32_u24 v6, 1120, v6
  v_lshl_add_u32 v147, v5, 4, v6
  v_add_u32 v5, 256, v1
  v_mul_u32_u24 v6, 6554, v5
  v_lshrrev_b32 v6, 16, v6
  v_mul_u32_u24 v6, 1120, v6
  v_lshl_add_u32 v148, v5, 4, v6
  s_add_u32 m0, s22, 0
  s_nop 0
  buffer_load_dwordx4 v144, s[12:15], s21 offen lds
  s_add_u32 m0, s22, 1024
  s_nop 0
  buffer_load_dwordx4 v145, s[12:15], s21 offen lds
  s_add_u32 m0, s22, 2048
  s_nop 0
  buffer_load_dwordx4 v146, s[12:15], s21 offen lds
  s_add_u32 m0, s22, 3072
  s_nop 0
  buffer_load_dwordx4 v147, s[12:15], s21 offen lds
  s_add_u32 m0, s22, 4096
  s_nop 0
  buffer_load_dwordx4 v148, s[12:15], s21 offen lds
  s_add_u32 s21, s21, 40960
  s_add_u32 m0, s22, 5120
  s_nop 0
  buffer_load_dwordx4 v144, s[12:15], s21 offen lds
  s_add_u32 m0, s22, 6144
  s_nop 0
  buffer_load_dwordx4 v145, s[12:15], s21 offen lds
  s_add_u32 m0, s22, 7168
  s_nop 0
  buffer_load_dwordx4 v146, s[12:15], s21 offen lds
  s_add_u32 m0, s22, 8192
  s_nop 0
  buffer_load_dwordx4 v147, s[12:15], s21 offen lds
  s_add_u32 m0, s22, 9216
  s_nop 0
  buffer_load_dwordx4 v148, s[12:15], s21 offen lds
  s_add_u32 s21, s21, 40960
  s_add_u32 m0, s22, 10240
  s_nop 0
  buffer_load_dwordx4 v144, s[12:15], s21 offen lds
  s_add_u32 m0, s22, 11264
  s_nop 0
  buffer_load_dwordx4 v145, s[12:15], s21 offen lds
  s_add_u32 m0, s22, 12288
  s_nop 0
  buffer_load_dwordx4 v146, s[12:15], s21 offen lds
  s_add_u32 m0, s22, 13312
  s_nop 0
  buffer_load_dwordx4 v147, s[12:15], s21 offen lds
  s_add_u32 m0, s22, 14336
  s_nop 0
  buffer_load_dwordx4 v148, s[12:15], s21 offen lds
  s_add_u32 s21, s21, 40960
  s_add_u32 m0, s22, 15360
  s_nop 0
  buffer_load_dwordx4 v144, s[12:15], s21 offen lds
  s_add_u32 m0, s22, 16384
  s_nop 0
  buffer_load_dwordx4 v145, s[12:15], s21 offen lds
  s_add_u32 m0, s22, 17408
  s_nop 0
  buffer_load_dwordx4 v146, s[12:15], s21 offen lds
  s_add_u32 m0, s22, 18432
  s_nop 0
  buffer_load_dwordx4 v147, s[12:15], s21 offen lds
  s_add_u32 m0, s22, 19456
  s_nop 0
  buffer_load_dwordx4 v148, s[12:15], s21 offen lds
  s_add_u32 s21, s21, 40960
  s_add_u32 m0, s22, 20480
  s_nop 0
  buffer_load_dwordx4 v144, s[12:15], s21 offen lds
  s_add_u32 m0, s22, 21504
  s_nop 0
  buffer_load_dwordx4 v145, s[12:15], s21 offen lds
  s_add_u32 m0, s22, 22528
  s_nop 0
  buffer_load_dwordx4 v146, s[12:15], s21 offen lds
  s_add_u32 m0, s22, 23552
  s_nop 0
  buffer_load_dwordx4 v147, s[12:15], s21 offen lds
  s_add_u32 m0, s22, 24576
  s_nop 0
  buffer_load_dwordx4 v148, s[12:15], s21 offen lds
  s_add_u32 s21, s21, 40960
  v_lshrrev_b32 v5, 2, v2
  v_and_b32 v6, 3, v2
  v_lshlrev_b32 v6, 3, v6
  v_lshl_add_u32 v9, v3, 2, v5
  v_mul_u32_u24 v9, 160, v9
  v_add3_u32 v152, v9, v6, s22
  v_add_u32 v153, v152, v6
  v_mul_u32_u24 v9, 20, v3
  v_add_u32 v9, v9, v5
  v_mul_u32_u24 v9, 160, v9
  v_add3_u32 v154, v9, v6, s22
  v_add_u32 v155, v154, v6
  v_lshlrev_b32 v4, 4, v1
  v_lshlrev_b32 v5, 3, v1
  v_lshlrev_b32 v6, 2, v2
  v_mul_u32_u24 v9, 1280, v2
  v_lshl_add_u32 v13, v3, 3, v9
  v_lshl_add_u32 v9, v3, 4, v9
  s_mul_i32 s21, s20, 10240
  v_add_u32 v10, s21, v4
  s_and_b32 s43, s20, 1
  s_lshr_b32 s44, s20, 1
  s_mul_i32 s21, s44, 6
  s_add_u32 s21, s21, s43
  s_lshl_b32 s21, s21, 10
  v_add_u32 v11, s21, v4
  s_add_u32 s21, s43, 4
  s_lshl_b32 s21, s21, 10
  v_add_u32 v12, s21, v4
  v_lshrrev_b32 v20, 5, v1
  v_mul_u32_u24 v21, 2560, v20
  v_add_u32 v21, v21, v4
  v_and_b32 v22, 31, v1
  v_lshlrev_b32 v22, 4, v22
  v_mul_u32_u24 v14, 640, v20
  v_add_u32 v22, v22, v14
  v_add_u32 v28, 16384, v22
  v_and_b32 v15, 1, v3
  v_lshl_add_u32 v14, v15, 6, v14
  v_lshrrev_b32 v16, 3, v2
  v_mul_u32_u24 v16, 16320, v16
  v_lshl_add_u32 v16, v2, 3, v16
  v_add_u32 v14, v14, v16
  v_add_u32 v15, 40960, v11
  v_lshlrev_b32 v17, 2, v7
  v_bfe_u32 v16, v1, 3, 1
  v_lshl_add_u32 v17, v16, 3, v17
  v_add_u32 v16, 40960, v12
  v_cmp_gt_u32 s[66:67], 16, v1
  s_lshr_b32 s52, s41, 1
  s_lshl_b32 s52, s52, 7
  s_and_b32 s21, s41, 1
  s_lshl_b32 s21, s21, 4
  s_add_u32 s52, s52, s21
  s_add_u32 s52, s52, 0
  s_xor_b32 s52, s52, s80
  v_add_u32 v17, s52, v17
  s_lshl_b32 s21, s20, 17
  s_lshl_b32 s22, s41, 10
  s_add_u32 s42, s21, s22
  s_lshl_b32 s53, s20, 19
  s_lshl_b32 s60, s41, 15
  s_add_u32 s60, s60, s53
  s_add_u32 s60, s60, 4096
  s_lshr_b32 s22, s41, 1
  s_lshl_b32 s22, s22, 14
  s_add_u32 s53, s53, s22
  s_and_b32 s22, s41, 1
  s_lshl_b32 s22, s22, 12
  s_add_u32 s53, s53, s22
  v_mov_b32 v70, 0
  v_mov_b32 v71, 0
  v_mov_b32 v78, 0
  v_mov_b32 v79, 0
  v_mov_b32 v86, 0
  v_mov_b32 v87, 0
  v_mov_b32 v94, 0
  v_mov_b32 v95, 0
  v_mov_b32 v102, 0
  v_mov_b32 v103, 0
  v_mov_b32 v110, 0
  v_mov_b32 v111, 0
  v_mov_b32 v118, 0
  v_mov_b32 v119, 0
  v_mov_b32 v126, 0
  v_mov_b32 v127, 0
  s_waitcnt vmcnt(25)
  s_cmp_lg_u32 s20, 0
  s_cbranch_scc1 pvq_295
  s_mov_b64 exec, 1
  ds_write_b32 v30, v29
  s_mov_b64 exec, -1
pvq_295:
  v_readlane_b32 s50, v8, 0
  v_readlane_b32 s21, v8, 1
  s_min_u32 s50, s50, s21
  v_readlane_b32 s21, v8, 2
  s_min_u32 s50, s50, s21
  v_readlane_b32 s21, v8, 3
  s_min_u32 s50, s50, s21
  v_readlane_b32 s21, v8, 4
  s_min_u32 s50, s50, s21
  v_readlane_b32 s21, v8, 5
  s_min_u32 s50, s50, s21
  v_readlane_b32 s21, v8, 6
  s_min_u32 s50, s50, s21
  v_readlane_b32 s21, v8, 7
  s_min_u32 s50, s50, s21
  v_readlane_b32 s21, v8, 8
  s_min_u32 s50, s50, s21
  v_readlane_b32 s21, v8, 9
  s_min_u32 s50, s50, s21
  v_readlane_b32 s21, v8, 10
  s_min_u32 s50, s50, s21
  v_readlane_b32 s21, v8, 11
  s_min_u32 s50, s50, s21
  v_readlane_b32 s21, v8, 12
  s_min_u32 s50, s50, s21
  v_readlane_b32 s21, v8, 13
  s_min_u32 s50, s50, s21
  v_readlane_b32 s21, v8, 14
  s_min_u32 s50, s50, s21
  v_readlane_b32 s21, v8, 15
  s_min_u32 s50, s50, s21
  v_readlane_b32 s21, v8, 16
  s_min_u32 s50, s50, s21
  v_readlane_b32 s21, v8, 17
  s_min_u32 s50, s50, s21
  v_readlane_b32 s21, v8, 18
  s_min_u32 s50, s50, s21
  v_readlane_b32 s21, v8, 19
  s_min_u32 s50, s50, s21
  v_readlane_b32 s21, v8, 20
  s_min_u32 s50, s50, s21
  v_readlane_b32 s21, v8, 21
  s_min_u32 s50, s50, s21
  v_readlane_b32 s21, v8, 22
  s_min_u32 s50, s50, s21
  v_readlane_b32 s21, v8, 23
  s_min_u32 s50, s50, s21
  v_readlane_b32 s21, v8, 24
  s_min_u32 s50, s50, s21
  v_readlane_b32 s21, v8, 25
  s_min_u32 s50, s50, s21
  v_readlane_b32 s21, v8, 26
  s_min_u32 s50, s50, s21
  v_readlane_b32 s21, v8, 27
  s_min_u32 s50, s50, s21
  v_readlane_b32 s21, v8, 28
  s_min_u32 s50, s50, s21
  v_readlane_b32 s21, v8, 29
  s_min_u32 s50, s50, s21
  v_readlane_b32 s21, v8, 30
  s_min_u32 s50, s50, s21
  v_readlane_b32 s21, v8, 31
  s_min_u32 s50, s50, s21
  v_cmp_gt_u32 vcc, 16, v26
  s_waitcnt lgkmcnt(0)
  s_barrier
  ds_read_b32 v23, v30
  s_cbranch_vccz pv_294
  s_mov_b32 s101, 0
wm_296:
  buffer_load_dword v26, v25, s[72:75], s56 offen sc1
  s_add_u32 s101, s101, 1
  s_cmp_gt_u32 s101, 131072
  s_cbranch_scc1 main_end
  s_waitcnt vmcnt(0)
  v_cmp_gt_u32 vcc, 16, v26
  v_readfirstlane_b32 s100, v26
  s_nop 0
  s_cbranch_vccz wm_297
  s_sleep 16
  s_branch wm_296
wm_297:
pv_294:
  s_waitcnt lgkmcnt(0)
  v_readfirstlane_b32 s2, v23
  s_cmp_ge_u32 s2, 16
  s_cbranch_scc1 pv_done
  s_lshl_b32 s40, s2, 2
  s_add_u32 s40, s40, s58
  s_lshl_b32 s21, s40, 7
  s_add_u32 s21, s21, 8192
  s_xor_b32 s21, s21, s80
  v_mov_b32 v18, s21
  v_cndmask_b32 v18, v17, v18, s[66:67]
  s_add_u32 s21, s40, 1
  v_mov_b32 v19, s21
  v_cndmask_b32 v19, v19, 32, s[66:67]
  buffer_load_dword v27, v18, s[72:75], 0 offen sc1
  s_lshl_b32 s55, s40, 19
  s_lshl_b32 s21, s40, 11
  s_and_b32 s21, s21, 8192
  s_xor_b32 s21, s21, s80
  s_add_u32 s55, s55, s21
  s_add_u32 s55, s55, 136314880
  s_lshl_b32 s21, s20, 15
  s_xor_b32 s54, s55, 8192
  s_add_u32 s54, s54, 48234496
  s_add_u32 s54, s54, s21
  s_lshl_b32 s57, s40, 1
  s_add_u32 s57, s57, s43
  s_lshl_b32 s45, s57, 6
  s_add_u32 s69, s54, 262144
  s_cmp_lt_u32 s2, 16
  s_cselect_b32 s69, s69, 0x40000000
  s_cselect_b32 s64, s87, 0
  s_cmp_gt_u32 s64, 1
  s_cselect_b32 s64, s59, 0x40000000
  v_mov_b32 v29, 1
  buffer_atomic_add v29, v233, s[72:75], s64 offen sc0 sc1
  buffer_load_dword v232, v6, s[28:31], s45 offen sc1
  buffer_load_dwordx4 v[192:195], v4, s[16:19], s69 offen offset:0 sc1
  buffer_load_dwordx4 v[196:199], v4, s[16:19], s69 offen offset:1024 sc1
  buffer_load_dwordx2 v[208:209], v5, s[16:19], s69 offen offset:2048 sc1
  s_add_u32 s69, s69, 2560
  buffer_load_dwordx4 v[200:203], v4, s[16:19], s69 offen offset:0 sc1
  buffer_load_dwordx4 v[204:207], v4, s[16:19], s69 offen offset:1024 sc1
  buffer_load_dwordx2 v[210:211], v5, s[16:19], s69 offen offset:2048 sc1
  s_add_u32 s69, s69, 13824
  buffer_load_dwordx4 v[212:215], v4, s[16:19], s69 offen offset:0 sc1
  buffer_load_dwordx4 v[216:219], v4, s[16:19], s69 offen offset:1024 sc1
  buffer_load_dwordx2 v[228:229], v5, s[16:19], s69 offen offset:2048 sc1
  s_add_u32 s69, s69, 2560
  buffer_load_dwordx4 v[220:223], v4, s[16:19], s69 offen offset:0 sc1
  buffer_load_dwordx4 v[224:227], v4, s[16:19], s69 offen offset:1024 sc1
  buffer_load_dwordx2 v[230:231], v5, s[16:19], s69 offen offset:2048 sc1
  s_add_u32 s69, s69, 13824
  s_waitcnt vmcnt(14)
  s_add_u32 s23, s40, 1
  s_cmp_ge_u32 s50, s23
  s_cbranch_scc1 pv_298
  s_mov_b32 s101, 0
wm_301:
  buffer_load_dword v8, v31, s[72:75], s51 offen sc1
  s_add_u32 s101, s101, 1
  s_cmp_gt_u32 s101, 131072
  s_cbranch_scc1 main_end
  s_waitcnt vmcnt(0)
  v_cmp_gt_u32 vcc, s23, v8
  v_readfirstlane_b32 s100, v8
  s_nop 0
  s_cbranch_vccz wm_302
  s_sleep 8
  s_add_u32 s100, s100, 2
  s_cmp_ge_u32 s100, s23
  s_cbranch_scc1 wm_301
  s_sleep 60
  s_branch wm_301
wm_302:
  v_readlane_b32 s50, v8, 0
  v_readlane_b32 s21, v8, 1
  s_min_u32 s50, s50, s21
  v_readlane_b32 s21, v8, 2
  s_min_u32 s50, s50, s21
  v_readlane_b32 s21, v8, 3
  s_min_u32 s50, s50, s21
  v_readlane_b32 s21, v8, 4
  s_min_u32 s50, s50, s21
  v_readlane_b32 s21, v8, 5
  s_min_u32 s50, s50, s21
  v_readlane_b32 s21, v8, 6
  s_min_u32 s50, s50, s21
  v_readlane_b32 s21, v8, 7
  s_min_u32 s50, s50, s21
  v_readlane_b32 s21, v8, 8
  s_min_u32 s50, s50, s21
  v_readlane_b32 s21, v8, 9
  s_min_u32 s50, s50, s21
  v_readlane_b32 s21, v8, 10
  s_min_u32 s50, s50, s21
  v_readlane_b32 s21, v8, 11
  s_min_u32 s50, s50, s21
  v_readlane_b32 s21, v8, 12
  s_min_u32 s50, s50, s21
  v_readlane_b32 s21, v8, 13
  s_min_u32 s50, s50, s21
  v_readlane_b32 s21, v8, 14
  s_min_u32 s50, s50, s21
  v_readlane_b32 s21, v8, 15
  s_min_u32 s50, s50, s21
  v_readlane_b32 s21, v8, 16
  s_min_u32 s50, s50, s21
  v_readlane_b32 s21, v8, 17
  s_min_u32 s50, s50, s21
  v_readlane_b32 s21, v8, 18
  s_min_u32 s50, s50, s21
  v_readlane_b32 s21, v8, 19
  s_min_u32 s50, s50, s21
  v_readlane_b32 s21, v8, 20
  s_min_u32 s50, s50, s21
  v_readlane_b32 s21, v8, 21
  s_min_u32 s50, s50, s21
  v_readlane_b32 s21, v8, 22
  s_min_u32 s50, s50, s21
  v_readlane_b32 s21, v8, 23
  s_min_u32 s50, s50, s21
  v_readlane_b32 s21, v8, 24
  s_min_u32 s50, s50, s21
  v_readlane_b32 s21, v8, 25
  s_min_u32 s50, s50, s21
  v_readlane_b32 s21, v8, 26
  s_min_u32 s50, s50, s21
  v_readlane_b32 s21, v8, 27
  s_min_u32 s50, s50, s21
  v_readlane_b32 s21, v8, 28
  s_min_u32 s50, s50, s21
  v_readlane_b32 s21, v8, 29
  s_min_u32 s50, s50, s21
  v_readlane_b32 s21, v8, 30
  s_min_u32 s50, s50, s21
  v_readlane_b32 s21, v8, 31
  s_min_u32 s50, s50, s21
pv_298:
  v_cmp_gt_u32 vcc, v19, v27
  s_lshl_b32 s61, s40, 21
  s_lshl_b32 s21, s40, 13
  s_and_b32 s21, s21, 8192
  s_xor_b32 s21, s21, s80
  s_add_u32 s61, s61, s21
  s_lshl_b32 s21, s20, 15
  s_add_u32 s47, s54, s21
  s_add_u32 s48, s61, s60
  s_xor_b32 s68, s61, 8192
  s_add_u32 s68, s68, s53
  s_add_u32 s70, s55, s42
  s_xor_b32 s70, s70, 0
  s_mov_b32 s62, 0
  s_cbranch_vccnz pv_299
  s_mov_b32 s62, 1
  buffer_load_dwordx4 a[0:3], v4, s[16:19], s68 offen offset:0 sc1
  buffer_load_dwordx4 a[4:7], v4, s[16:19], s68 offen offset:1024 sc1
  buffer_load_dwordx4 v[32:35], v22, s[16:19], s48 offen offset:0 sc1
  buffer_load_dwordx4 a[8:11], v4, s[16:19], s70 offen sc1
  s_add_u32 s70, s70, 16384
  buffer_load_dwordx4 a[12:15], v4, s[16:19], s68 offen offset:2048 sc1
  buffer_load_dwordx4 a[16:19], v4, s[16:19], s68 offen offset:3072 sc1
  s_add_u32 s68, s68, 65536
  buffer_load_dwordx4 v[64:67], v4, s[16:19], s47 offen sc1
  buffer_load_dwordx2 v[68:69], v5, s[16:19], s47 offen offset:2048 sc1
  buffer_load_dwordx4 v[128:131], v21, s[16:19], s47 offen offset:1024 sc1
  s_add_u32 s47, s47, 2560
  buffer_load_dwordx4 a[20:23], v4, s[16:19], s68 offen offset:0 sc1
  buffer_load_dwordx4 a[24:27], v4, s[16:19], s68 offen offset:1024 sc1
  buffer_load_dwordx4 v[40:43], v28, s[16:19], s48 offen offset:0 sc1
  buffer_load_dwordx4 a[28:31], v4, s[16:19], s70 offen sc1
  s_add_u32 s70, s70, 16384
  buffer_load_dwordx4 a[32:35], v4, s[16:19], s68 offen offset:2048 sc1
  buffer_load_dwordx4 a[36:39], v4, s[16:19], s68 offen offset:3072 sc1
  s_add_u32 s68, s68, 65536
  buffer_load_dwordx2 v[184:185], v14, s[16:19], s48 offen offset:512 sc1
  buffer_load_dwordx4 v[72:75], v4, s[16:19], s47 offen sc1
  buffer_load_dwordx2 v[76:77], v5, s[16:19], s47 offen offset:2048 sc1
  s_add_u32 s47, s47, 13824
  buffer_load_dwordx4 a[40:43], v4, s[16:19], s68 offen offset:0 sc1
  buffer_load_dwordx4 a[44:47], v4, s[16:19], s68 offen offset:1024 sc1
  buffer_load_dwordx4 v[36:39], v22, s[16:19], s48 offen offset:1280 sc1
  buffer_load_dwordx4 a[48:51], v4, s[16:19], s70 offen sc1
  s_add_u32 s70, s70, 16384
  buffer_load_dwordx4 a[52:55], v4, s[16:19], s68 offen offset:2048 sc1
  buffer_load_dwordx4 a[56:59], v4, s[16:19], s68 offen offset:3072 sc1
  s_add_u32 s68, s68, 65536
  buffer_load_dwordx4 v[80:83], v4, s[16:19], s47 offen sc1
  buffer_load_dwordx2 v[84:85], v5, s[16:19], s47 offen offset:2048 sc1
  buffer_load_dwordx4 v[132:135], v21, s[16:19], s47 offen offset:1024 sc1
  s_add_u32 s47, s47, 2560
  buffer_load_dwordx4 a[60:63], v4, s[16:19], s68 offen offset:0 sc1
  buffer_load_dwordx4 a[64:67], v4, s[16:19], s68 offen offset:1024 sc1
  buffer_load_dwordx4 v[44:47], v28, s[16:19], s48 offen offset:1280 sc1
  buffer_load_dwordx4 a[68:71], v4, s[16:19], s70 offen sc1
  s_add_u32 s70, s70, 16384
  buffer_load_dwordx4 a[72:75], v4, s[16:19], s68 offen offset:2048 sc1
  buffer_load_dwordx4 a[76:79], v4, s[16:19], s68 offen offset:3072 sc1
  s_add_u32 s68, s68, 65536
  buffer_load_dwordx2 v[186:187], v14, s[16:19], s48 offen offset:1792 sc1
  s_add_u32 s48, s48, 262144
  buffer_load_dwordx4 v[88:91], v4, s[16:19], s47 offen sc1
  buffer_load_dwordx2 v[92:93], v5, s[16:19], s47 offen offset:2048 sc1
  s_add_u32 s47, s47, 13824
  s_branch pv_300
pv_299:
  buffer_load_dwordx4 a[0:3], v4, s[16:19], s68 offen offset:0 sc1
  buffer_load_dwordx4 a[4:7], v4, s[16:19], s68 offen offset:1024 sc1
  buffer_load_dwordx4 a[8:11], v4, s[16:19], s70 offen sc1
  s_add_u32 s70, s70, 16384
  buffer_load_dwordx4 a[12:15], v4, s[16:19], s68 offen offset:2048 sc1
  buffer_load_dwordx4 a[16:19], v4, s[16:19], s68 offen offset:3072 sc1
  s_add_u32 s68, s68, 65536
  buffer_load_dwordx4 a[20:23], v4, s[16:19], s68 offen offset:0 sc1
  buffer_load_dwordx4 a[24:27], v4, s[16:19], s68 offen offset:1024 sc1
  buffer_load_dwordx4 a[28:31], v4, s[16:19], s70 offen sc1
  s_add_u32 s70, s70, 16384
  buffer_load_dwordx4 a[32:35], v4, s[16:19], s68 offen offset:2048 sc1
  buffer_load_dwordx4 a[36:39], v4, s[16:19], s68 offen offset:3072 sc1
  s_add_u32 s68, s68, 65536
  buffer_load_dwordx4 a[40:43], v4, s[16:19], s68 offen offset:0 sc1
  buffer_load_dwordx4 a[44:47], v4, s[16:19], s68 offen offset:1024 sc1
  buffer_load_dwordx4 a[48:51], v4, s[16:19], s70 offen sc1
  s_add_u32 s70, s70, 16384
  buffer_load_dwordx4 a[52:55], v4, s[16:19], s68 offen offset:2048 sc1
  buffer_load_dwordx4 a[56:59], v4, s[16:19], s68 offen offset:3072 sc1
  s_add_u32 s68, s68, 65536
  buffer_load_dwordx4 a[60:63], v4, s[16:19], s68 offen offset:0 sc1
  buffer_load_dwordx4 a[64:67], v4, s[16:19], s68 offen offset:1024 sc1
  buffer_load_dwordx4 a[68:71], v4, s[16:19], s70 offen sc1
  s_add_u32 s70, s70, 16384
  buffer_load_dwordx4 a[72:75], v4, s[16:19], s68 offen offset:2048 sc1
  buffer_load_dwordx4 a[76:79], v4, s[16:19], s68 offen offset:3072 sc1
  s_add_u32 s68, s68, 65536
  buffer_load_dwordx4 a[80:83], v4, s[16:19], s68 offen offset:0 sc1
  buffer_load_dwordx4 a[84:87], v4, s[16:19], s68 offen offset:1024 sc1
  buffer_load_dwordx4 a[88:91], v4, s[16:19], s70 offen sc1
  s_add_u32 s70, s70, 16384
  buffer_load_dwordx4 a[92:95], v4, s[16:19], s68 offen offset:2048 sc1
  buffer_load_dwordx4 a[96:99], v4, s[16:19], s68 offen offset:3072 sc1
  s_add_u32 s68, s68, 65536
  buffer_load_dwordx4 a[100:103], v4, s[16:19], s68 offen offset:0 sc1
  buffer_load_dwordx4 a[104:107], v4, s[16:19], s68 offen offset:1024 sc1
  buffer_load_dwordx4 a[108:111], v4, s[16:19], s70 offen sc1
  s_add_u32 s70, s70, 16384
  buffer_load_dwordx4 a[112:115], v4, s[16:19], s68 offen offset:2048 sc1
  buffer_load_dwordx4 a[116:119], v4, s[16:19], s68 offen offset:3072 sc1
  s_add_u32 s68, s68, 65536
  buffer_load_dwordx4 a[120:123], v4, s[16:19], s68 offen offset:0 sc1
  buffer_load_dwordx4 a[124:127], v4, s[16:19], s68 offen offset:1024 sc1
  buffer_load_dwordx4 a[128:131], v4, s[16:19], s70 offen sc1
  s_add_u32 s70, s70, 16384
  buffer_load_dwordx4 a[132:135], v4, s[16:19], s68 offen offset:2048 sc1
  buffer_load_dwordx4 a[136:139], v4, s[16:19], s68 offen offset:3072 sc1
  s_add_u32 s68, s68, 65536
  buffer_load_dwordx4 a[140:143], v4, s[16:19], s68 offen offset:0 sc1
  buffer_load_dwordx4 a[144:147], v4, s[16:19], s68 offen offset:1024 sc1
  buffer_load_dwordx4 a[148:151], v4, s[16:19], s70 offen sc1
  s_add_u32 s70, s70, 16384
  buffer_load_dwordx4 a[152:155], v4, s[16:19], s68 offen offset:2048 sc1
  buffer_load_dwordx4 a[156:159], v4, s[16:19], s68 offen offset:3072 sc1
  s_add_u32 s68, s68, 65536
pv_300:
  ds_read_b64_tr_b16 a[160:161], v153 offset:0
  ds_read_b64_tr_b16 a[162:163], v153 offset:3200
  ds_read_b64_tr_b16 a[164:165], v153 offset:8
  ds_read_b64_tr_b16 a[166:167], v153 offset:3208
  ds_read_b64_tr_b16 a[168:169], v152 offset:64
  ds_read_b64_tr_b16 a[170:171], v152 offset:3264
  ds_read_b64_tr_b16 a[172:173], v153 offset:96
  ds_read_b64_tr_b16 a[174:175], v153 offset:3296
  ds_read_b64_tr_b16 a[176:177], v153 offset:104
  ds_read_b64_tr_b16 a[178:179], v153 offset:3304
  ds_read_b64_tr_b16 a[180:181], v153 offset:6400
  ds_read_b64_tr_b16 a[182:183], v153 offset:9600
  ds_read_b64_tr_b16 a[184:185], v153 offset:6408
  ds_read_b64_tr_b16 a[186:187], v153 offset:9608
  ds_read_b64_tr_b16 a[188:189], v152 offset:6464
  ds_read_b64_tr_b16 a[190:191], v152 offset:9664
  ds_read_b64_tr_b16 a[192:193], v153 offset:6496
  ds_read_b64_tr_b16 a[194:195], v153 offset:9696
  ds_read_b64_tr_b16 a[196:197], v153 offset:6504
  ds_read_b64_tr_b16 a[198:199], v153 offset:9704
  ds_read_b64_tr_b16 a[200:201], v153 offset:12800
  ds_read_b64_tr_b16 a[202:203], v153 offset:16000
  ds_read_b64_tr_b16 a[204:205], v153 offset:12808
  ds_read_b64_tr_b16 a[206:207], v153 offset:16008
  ds_read_b64_tr_b16 a[208:209], v152 offset:12864
  ds_read_b64_tr_b16 a[210:211], v152 offset:16064
  ds_read_b64_tr_b16 a[212:213], v153 offset:12896
  ds_read_b64_tr_b16 a[214:215], v153 offset:16096
  ds_read_b64_tr_b16 a[216:217], v153 offset:12904
  ds_read_b64_tr_b16 a[218:219], v153 offset:16104
  ds_read_b64_tr_b16 a[220:221], v153 offset:19200
  ds_read_b64_tr_b16 a[222:223], v153 offset:22400
  ds_read_b64_tr_b16 a[224:225], v153 offset:19208
  ds_read_b64_tr_b16 a[226:227], v153 offset:22408
  ds_read_b64_tr_b16 a[228:229], v152 offset:19264
  ds_read_b64_tr_b16 a[230:231], v152 offset:22464
  ds_read_b64_tr_b16 a[232:233], v153 offset:19296
  ds_read_b64_tr_b16 a[234:235], v153 offset:22496
  ds_read_b64_tr_b16 a[236:237], v153 offset:19304
  ds_read_b64_tr_b16 a[238:239], v153 offset:22504
  ds_read_b64_tr_b16 a[240:241], v155 offset:2560
  ds_read_b64_tr_b16 a[242:243], v155 offset:15360
  ds_read_b64_tr_b16 a[244:245], v155 offset:2568
  ds_read_b64_tr_b16 a[246:247], v155 offset:15368
  ds_read_b64_tr_b16 a[248:249], v154 offset:2624
  ds_read_b64_tr_b16 a[250:251], v154 offset:15424
  ds_read_b64_tr_b16 a[252:253], v155 offset:2656
  ds_read_b64_tr_b16 a[254:255], v155 offset:15456
  ds_read_b64_tr_b16 v[252:253], v155 offset:2664
  ds_read_b64_tr_b16 v[254:255], v155 offset:15464
  s_waitcnt lgkmcnt(0)
  s_barrier
pv_loop:
  s_mov_b32 s63, s40
  s_mul_i32 s46, s57, 20480
  s_mul_i32 s22, s41, 160
  s_add_u32 s49, s46, s22
  s_mul_i32 s21, s44, 96
  s_add_u32 s46, s49, s21
  s_sub_u32 s87, s87, 1
  s_waitcnt vmcnt(36)
  v_mov_b32 v24, v232
  s_cmp_lg_u32 s20, 0
  s_cbranch_scc1 pvq_308
  s_mov_b64 exec, 1
  ds_write_b32 v30, v29
  s_mov_b64 exec, -1
pvq_308:
  s_cmp_eq_u32 s62, 0
  s_cbranch_scc1 pvw_303
  v_mfma_f32_16x16x32_bf16 v[144:147], a[160:163], v[192:195], 0
  v_mfma_f32_16x16x32_bf16 v[148:151], a[160:163], v[212:215], 0
  buffer_load_dwordx4 a[80:83], v4, s[16:19], s68 offen offset:0 sc1
  v_mfma_f32_16x16x32_bf16 v[152:155], a[164:167], v[192:195], 0
  v_mfma_f32_16x16x32_bf16 v[156:159], a[164:167], v[212:215], 0
  v_mfma_f32_16x16x32_bf16 v[160:163], a[168:171], v[192:195], 0
  buffer_load_dwordx4 a[84:87], v4, s[16:19], s68 offen offset:1024 sc1
  v_mfma_f32_16x16x32_bf16 v[164:167], a[168:171], v[212:215], 0
  v_mfma_f32_16x16x32_bf16 v[168:171], a[172:175], v[192:195], 0
  v_mfma_f32_16x16x32_bf16 v[172:175], a[172:175], v[212:215], 0
  buffer_load_dwordx4 v[48:51], v22, s[16:19], s48 offen offset:0 sc1
  v_mfma_f32_16x16x32_bf16 v[176:179], a[176:179], v[192:195], 0
  v_mfma_f32_16x16x32_bf16 v[180:183], a[176:179], v[212:215], 0
  buffer_load_dwordx4 a[88:91], v4, s[16:19], s70 offen sc1
  s_add_u32 s70, s70, 16384
  v_mfma_f32_16x16x32_bf16 v[144:147], a[180:183], v[196:199], v[144:147]
  v_mfma_f32_16x16x32_bf16 v[148:151], a[180:183], v[216:219], v[148:151]
  v_mfma_f32_16x16x32_bf16 v[152:155], a[184:187], v[196:199], v[152:155]
  buffer_load_dwordx4 a[92:95], v4, s[16:19], s68 offen offset:2048 sc1
  v_mfma_f32_16x16x32_bf16 v[156:159], a[184:187], v[216:219], v[156:159]
  v_mfma_f32_16x16x32_bf16 v[160:163], a[188:191], v[196:199], v[160:163]
  v_mfma_f32_16x16x32_bf16 v[164:167], a[188:191], v[216:219], v[164:167]
  buffer_load_dwordx4 a[96:99], v4, s[16:19], s68 offen offset:3072 sc1
  s_add_u32 s68, s68, 65536
  v_mfma_f32_16x16x32_bf16 v[168:171], a[192:195], v[196:199], v[168:171]
  v_mfma_f32_16x16x32_bf16 v[172:175], a[192:195], v[216:219], v[172:175]
  v_mfma_f32_16x16x32_bf16 v[176:179], a[196:199], v[196:199], v[176:179]
  buffer_load_dwordx4 v[96:99], v4, s[16:19], s47 offen sc1
  v_mfma_f32_16x16x32_bf16 v[180:183], a[196:199], v[216:219], v[180:183]
  v_mfma_f32_16x16x32_bf16 v[144:147], a[200:203], v[200:203], v[144:147]
  v_mfma_f32_16x16x32_bf16 v[148:151], a[200:203], v[220:223], v[148:151]
  buffer_load_dwordx2 v[100:101], v5, s[16:19], s47 offen offset:2048 sc1
  v_mfma_f32_16x16x32_bf16 v[152:155], a[204:207], v[200:203], v[152:155]
  v_mfma_f32_16x16x32_bf16 v[156:159], a[204:207], v[220:223], v[156:159]
  buffer_load_dwordx4 v[136:139], v21, s[16:19], s47 offen offset:1024 sc1
  s_add_u32 s47, s47, 2560
  v_mfma_f32_16x16x32_bf16 v[160:163], a[208:211], v[200:203], v[160:163]
  v_mfma_f32_16x16x32_bf16 v[164:167], a[208:211], v[220:223], v[164:167]
  v_mfma_f32_16x16x32_bf16 v[168:171], a[212:215], v[200:203], v[168:171]
  buffer_load_dwordx4 a[100:103], v4, s[16:19], s68 offen offset:0 sc1
  v_mfma_f32_16x16x32_bf16 v[172:175], a[212:215], v[220:223], v[172:175]
  v_mfma_f32_16x16x32_bf16 v[176:179], a[216:219], v[200:203], v[176:179]
  v_mfma_f32_16x16x32_bf16 v[180:183], a[216:219], v[220:223], v[180:183]
  buffer_load_dwordx4 a[104:107], v4, s[16:19], s68 offen offset:1024 sc1
  v_mfma_f32_16x16x32_bf16 v[144:147], a[220:223], v[204:207], v[144:147]
  v_mfma_f32_16x16x32_bf16 v[148:151], a[220:223], v[224:227], v[148:151]
  v_mfma_f32_16x16x32_bf16 v[152:155], a[224:227], v[204:207], v[152:155]
  buffer_load_dwordx4 v[56:59], v28, s[16:19], s48 offen offset:0 sc1
  v_mfma_f32_16x16x32_bf16 v[156:159], a[224:227], v[224:227], v[156:159]
  v_mfma_f32_16x16x32_bf16 v[160:163], a[228:231], v[204:207], v[160:163]
  v_mfma_f32_16x16x32_bf16 v[164:167], a[228:231], v[224:227], v[164:167]
  buffer_load_dwordx4 a[108:111], v4, s[16:19], s70 offen sc1
  s_add_u32 s70, s70, 16384
  v_mfma_f32_16x16x32_bf16 v[168:171], a[232:235], v[204:207], v[168:171]
  v_mfma_f32_16x16x32_bf16 v[172:175], a[232:235], v[224:227], v[172:175]
  buffer_load_dwordx4 a[112:115], v4, s[16:19], s68 offen offset:2048 sc1
  v_mfma_f32_16x16x32_bf16 v[176:179], a[236:239], v[204:207], v[176:179]
  v_mfma_f32_16x16x32_bf16 v[180:183], a[236:239], v[224:227], v[180:183]
  v_mfma_f32_16x16x32_bf16 v[144:147], a[240:243], v[208:211], v[144:147]
  buffer_load_dwordx4 a[116:119], v4, s[16:19], s68 offen offset:3072 sc1
  s_add_u32 s68, s68, 65536
  v_mfma_f32_16x16x32_bf16 v[148:151], a[240:243], v[228:231], v[148:151]
  v_mfma_f32_16x16x32_bf16 v[152:155], a[244:247], v[208:211], v[152:155]
  v_mfma_f32_16x16x32_bf16 v[156:159], a[244:247], v[228:231], v[156:159]
  buffer_load_dwordx2 v[188:189], v14, s[16:19], s48 offen offset:512 sc1
  v_mfma_f32_16x16x32_bf16 v[160:163], a[248:251], v[208:211], v[160:163]
  v_mfma_f32_16x16x32_bf16 v[164:167], a[248:251], v[228:231], v[164:167]
  v_mfma_f32_16x16x32_bf16 v[168:171], a[252:255], v[208:211], v[168:171]
  buffer_load_dwordx4 v[104:107], v4, s[16:19], s47 offen sc1
  v_mfma_f32_16x16x32_bf16 v[172:175], a[252:255], v[228:231], v[172:175]
  v_mfma_f32_16x16x32_bf16 v[176:179], v[252:255], v[208:211], v[176:179]
  v_mfma_f32_16x16x32_bf16 v[180:183], v[252:255], v[228:231], v[180:183]
  buffer_load_dwordx2 v[108:109], v5, s[16:19], s47 offen offset:2048 sc1
  s_add_u32 s47, s47, 13824
  ds_write_b128 v10, v[144:147] offset:40960
  buffer_load_dwordx4 a[120:123], v4, s[16:19], s68 offen offset:0 sc1
  ds_write_b128 v10, v[148:151] offset:41984
  buffer_load_dwordx4 a[124:127], v4, s[16:19], s68 offen offset:1024 sc1
  ds_write_b128 v10, v[152:155] offset:43008
  ds_write_b128 v10, v[156:159] offset:44032
  s_waitcnt vmcnt(40)
  buffer_load_dwordx4 v[52:55], v22, s[16:19], s48 offen offset:1280 sc1
  ds_write_b128 v10, v[160:163] offset:45056
  buffer_load_dwordx4 a[128:131], v4, s[16:19], s70 offen sc1
  s_add_u32 s70, s70, 16384
  ds_write_b128 v10, v[164:167] offset:46080
  buffer_load_dwordx4 a[132:135], v4, s[16:19], s68 offen offset:2048 sc1
  ds_write_b128 v10, v[168:171] offset:47104
  buffer_load_dwordx4 a[136:139], v4, s[16:19], s68 offen offset:3072 sc1
  s_add_u32 s68, s68, 65536
  ds_write_b128 v10, v[172:175] offset:48128
  buffer_load_dwordx4 v[112:115], v4, s[16:19], s47 offen sc1
  s_nop 1
  ds_write_b128 v10, v[176:179] offset:49152
  buffer_load_dwordx2 v[116:117], v5, s[16:19], s47 offen offset:2048 sc1
  ds_write_b128 v10, v[180:183] offset:50176
  buffer_load_dwordx4 v[140:143], v21, s[16:19], s47 offen offset:1024 sc1
  s_add_u32 s47, s47, 2560
  s_waitcnt lgkmcnt(0)
  s_barrier
  ds_read_b32 v23, v30
  s_waitcnt lgkmcnt(0)
  v_readfirstlane_b32 s2, v23
  s_min_u32 s2, s2, 16
  s_cmp_eq_u32 s87, 0
  s_cselect_b32 s2, 16, s2
  buffer_load_dwordx4 a[140:143], v4, s[16:19], s68 offen offset:0 sc1
  s_lshl_b32 s40, s2, 2
  s_add_u32 s40, s40, s58
  s_lshl_b32 s21, s40, 7
  s_add_u32 s21, s21, 8192
  s_xor_b32 s21, s21, s80
  v_mov_b32 v18, s21
  v_cndmask_b32 v18, v17, v18, s[66:67]
  s_add_u32 s21, s40, 1
  v_mov_b32 v19, s21
  v_cndmask_b32 v19, v19, 32, s[66:67]
  buffer_load_dword v27, v18, s[72:75], 0 offen sc1
  buffer_load_dwordx4 a[144:147], v4, s[16:19], s68 offen offset:1024 sc1
  v_sub_f32 v25, 1.0, v24
  v_cvt_pk_bf16_f32 v26, v25, v25
  v_lshlrev_b32 v25, 16, v26
  ds_read_b128 v[144:147], v15 offset:0
  ds_read_b128 v[148:151], v15 offset:10240
  ds_read_b128 v[152:155], v15 offset:20480
  ds_read_b128 v[156:159], v15 offset:30720
  ds_read_b128 v[160:163], v15 offset:2048
  ds_read_b128 v[164:167], v15 offset:12288
  ds_read_b128 v[168:171], v15 offset:22528
  ds_read_b128 v[172:175], v15 offset:32768
  s_waitcnt lgkmcnt(4)
  buffer_load_dwordx4 v[60:63], v28, s[16:19], s48 offen offset:1280 sc1
  v_pk_add_f32 v[144:145], v[144:145], v[148:149]
  v_pk_add_f32 v[152:153], v[152:153], v[156:157]
  v_pk_add_f32 v[146:147], v[146:147], v[150:151]
  v_pk_add_f32 v[154:155], v[154:155], v[158:159]
  v_pk_add_f32 v[176:177], v[144:145], v[152:153]
  v_pk_add_f32 v[178:179], v[146:147], v[154:155]
  ds_read_b128 v[144:147], v16 offset:0
  ds_read_b128 v[148:151], v16 offset:10240
  ds_read_b128 v[152:155], v16 offset:20480
  ds_read_b128 v[156:159], v16 offset:30720
  v_cvt_pk_bf16_f32 v26, v176, v177
  buffer_load_dwordx4 a[148:151], v4, s[16:19], s70 offen sc1
  s_add_u32 s70, s70, 16384
  v_lshlrev_b32 v240, 16, v26
  v_and_b32 v241, 0xffff0000, v26
  v_mul_f32 v240, v240, v25
  v_mul_f32 v241, v241, v25
  v_cvt_pk_bf16_f32 v26, v240, v241
  v_lshlrev_b32 v240, 16, v26
  v_and_b32 v241, 0xffff0000, v26
  v_cvt_pk_bf16_f32 v26, v178, v179
  v_lshlrev_b32 v242, 16, v26
  v_and_b32 v243, 0xffff0000, v26
  v_mul_f32 v242, v242, v25
  buffer_load_dwordx4 a[152:155], v4, s[16:19], s68 offen offset:2048 sc1
  v_mul_f32 v243, v243, v25
  v_cvt_pk_bf16_f32 v26, v242, v243
  v_lshlrev_b32 v242, 16, v26
  v_and_b32 v243, 0xffff0000, v26
  s_waitcnt lgkmcnt(4)
  v_pk_add_f32 v[160:161], v[160:161], v[164:165]
  v_pk_add_f32 v[168:169], v[168:169], v[172:173]
  v_pk_add_f32 v[162:163], v[162:163], v[166:167]
  v_pk_add_f32 v[170:171], v[170:171], v[174:175]
  v_pk_add_f32 v[176:177], v[160:161], v[168:169]
  v_pk_add_f32 v[178:179], v[162:163], v[170:171]
  buffer_load_dwordx4 a[156:159], v4, s[16:19], s68 offen offset:3072 sc1
  s_add_u32 s68, s68, 65536
  v_cvt_pk_bf16_f32 v26, v176, v177
  v_lshlrev_b32 v244, 16, v26
  v_and_b32 v245, 0xffff0000, v26
  v_mul_f32 v244, v244, v25
  v_mul_f32 v245, v245, v25
  v_cvt_pk_bf16_f32 v26, v244, v245
  v_lshlrev_b32 v244, 16, v26
  v_and_b32 v245, 0xffff0000, v26
  v_cvt_pk_bf16_f32 v26, v178, v179
  v_lshlrev_b32 v246, 16, v26
  v_and_b32 v247, 0xffff0000, v26
  buffer_load_dwordx2 v[190:191], v14, s[16:19], s48 offen offset:1792 sc1
  s_add_u32 s48, s48, 262144
  v_mul_f32 v246, v246, v25
  v_mul_f32 v247, v247, v25
  v_cvt_pk_bf16_f32 v26, v246, v247
  v_lshlrev_b32 v246, 16, v26
  v_and_b32 v247, 0xffff0000, v26
  s_waitcnt lgkmcnt(0)
  v_pk_add_f32 v[144:145], v[144:145], v[148:149]
  v_pk_add_f32 v[152:153], v[152:153], v[156:157]
  v_pk_add_f32 v[146:147], v[146:147], v[150:151]
  v_pk_add_f32 v[154:155], v[154:155], v[158:159]
  v_pk_add_f32 v[176:177], v[144:145], v[152:153]
  v_pk_add_f32 v[178:179], v[146:147], v[154:155]
  buffer_load_dwordx4 v[120:123], v4, s[16:19], s47 offen sc1
  v_cvt_pk_bf16_f32 v26, v176, v177
  v_lshlrev_b32 v248, 16, v26
  v_and_b32 v249, 0xffff0000, v26
  v_mul_f32 v248, v248, v25
  v_mul_f32 v249, v249, v25
  v_cvt_pk_bf16_f32 v26, v248, v249
  v_lshlrev_b32 v248, 16, v26
  v_and_b32 v249, 0xffff0000, v26
  v_cvt_pk_bf16_f32 v26, v178, v179
  v_lshlrev_b32 v250, 16, v26
  v_and_b32 v251, 0xffff0000, v26
  buffer_load_dwordx2 v[124:125], v5, s[16:19], s47 offen offset:2048 sc1
  s_add_u32 s47, s47, 13824
  v_mul_f32 v250, v250, v25
  v_mul_f32 v251, v251, v25
  v_cvt_pk_bf16_f32 v26, v250, v251
  v_lshlrev_b32 v250, 16, v26
  v_and_b32 v251, 0xffff0000, v26
  s_barrier
  s_lshl_b32 s55, s40, 19
  s_lshl_b32 s21, s40, 11
  s_and_b32 s21, s21, 8192
  s_xor_b32 s21, s21, s80
  s_add_u32 s55, s55, s21
  s_add_u32 s55, s55, 136314880
  s_lshl_b32 s21, s20, 15
  s_xor_b32 s54, s55, 8192
  s_add_u32 s54, s54, 48234496
  s_add_u32 s54, s54, s21
  s_lshl_b32 s57, s40, 1
  s_add_u32 s57, s57, s43
  s_lshl_b32 s45, s57, 6
  s_add_u32 s69, s54, 262144
  s_cmp_lt_u32 s2, 16
  s_cselect_b32 s69, s69, 0x40000000
  s_cselect_b32 s64, s87, 0
  s_cmp_gt_u32 s64, 1
  s_cselect_b32 s64, s59, 0x40000000
  s_waitcnt vmcnt(37)
  v_mfma_f32_16x16x32_bf16 v[148:151], a[0:3], v[64:67], 0
  v_mfma_f32_16x16x32_bf16 v[144:147], a[0:3], v[68:71], 0
  v_mov_b32 v29, 1
  buffer_atomic_add v29, v233, s[72:75], s64 offen sc0 sc1
  v_mfma_f32_16x16x32_bf16 v[156:159], a[4:7], v[64:67], 0
  v_mfma_f32_16x16x32_bf16 v[152:155], a[4:7], v[68:71], 0
  v_mfma_f32_16x16x32_bf16 v[164:167], a[8:11], v[64:67], 0
  v_mfma_f32_16x16x32_bf16 v[160:163], a[8:11], v[68:71], 0
  buffer_load_dword v232, v6, s[28:31], s45 offen sc1
  v_mfma_f32_16x16x32_bf16 v[172:175], a[12:15], v[64:67], 0
  v_mfma_f32_16x16x32_bf16 v[168:171], a[12:15], v[68:71], 0
  v_mfma_f32_16x16x32_bf16 v[180:183], a[16:19], v[64:67], 0
  v_mfma_f32_16x16x32_bf16 v[176:179], a[16:19], v[68:71], 0
  buffer_load_dwordx4 v[192:195], v4, s[16:19], s69 offen offset:0 sc1
  v_mfma_f32_16x16x32_bf16 v[148:151], a[20:23], v[72:75], v[148:151]
  v_mfma_f32_16x16x32_bf16 v[144:147], a[20:23], v[76:79], v[144:147]
  v_mfma_f32_16x16x32_bf16 v[156:159], a[24:27], v[72:75], v[156:159]
  v_mfma_f32_16x16x32_bf16 v[152:155], a[24:27], v[76:79], v[152:155]
  buffer_load_dwordx4 v[196:199], v4, s[16:19], s69 offen offset:1024 sc1
  v_mfma_f32_16x16x32_bf16 v[164:167], a[28:31], v[72:75], v[164:167]
  v_mfma_f32_16x16x32_bf16 v[160:163], a[28:31], v[76:79], v[160:163]
  v_mfma_f32_16x16x32_bf16 v[172:175], a[32:35], v[72:75], v[172:175]
  buffer_load_dwordx2 v[208:209], v5, s[16:19], s69 offen offset:2048 sc1
  s_add_u32 s69, s69, 2560
  v_mfma_f32_16x16x32_bf16 v[168:171], a[32:35], v[76:79], v[168:171]
  v_mfma_f32_16x16x32_bf16 v[180:183], a[36:39], v[72:75], v[180:183]
  v_mfma_f32_16x16x32_bf16 v[176:179], a[36:39], v[76:79], v[176:179]
  v_mfma_f32_16x16x32_bf16 v[148:151], a[40:43], v[80:83], v[148:151]
  buffer_load_dwordx4 v[200:203], v4, s[16:19], s69 offen offset:0 sc1
  v_mfma_f32_16x16x32_bf16 v[144:147], a[40:43], v[84:87], v[144:147]
  v_mfma_f32_16x16x32_bf16 v[156:159], a[44:47], v[80:83], v[156:159]
  v_mfma_f32_16x16x32_bf16 v[152:155], a[44:47], v[84:87], v[152:155]
  v_mfma_f32_16x16x32_bf16 v[164:167], a[48:51], v[80:83], v[164:167]
  buffer_load_dwordx4 v[204:207], v4, s[16:19], s69 offen offset:1024 sc1
  v_mfma_f32_16x16x32_bf16 v[160:163], a[48:51], v[84:87], v[160:163]
  v_mfma_f32_16x16x32_bf16 v[172:175], a[52:55], v[80:83], v[172:175]
  v_mfma_f32_16x16x32_bf16 v[168:171], a[52:55], v[84:87], v[168:171]
  buffer_load_dwordx2 v[210:211], v5, s[16:19], s69 offen offset:2048 sc1
  s_add_u32 s69, s69, 13824
  v_mfma_f32_16x16x32_bf16 v[180:183], a[56:59], v[80:83], v[180:183]
  v_mfma_f32_16x16x32_bf16 v[176:179], a[56:59], v[84:87], v[176:179]
  v_mfma_f32_16x16x32_bf16 v[148:151], a[60:63], v[88:91], v[148:151]
  v_mfma_f32_16x16x32_bf16 v[144:147], a[60:63], v[92:95], v[144:147]
  buffer_load_dwordx4 v[212:215], v4, s[16:19], s69 offen offset:0 sc1
  v_mfma_f32_16x16x32_bf16 v[156:159], a[64:67], v[88:91], v[156:159]
  v_mfma_f32_16x16x32_bf16 v[152:155], a[64:67], v[92:95], v[152:155]
  v_mfma_f32_16x16x32_bf16 v[164:167], a[68:71], v[88:91], v[164:167]
  v_mfma_f32_16x16x32_bf16 v[160:163], a[68:71], v[92:95], v[160:163]
  buffer_load_dwordx4 v[216:219], v4, s[16:19], s69 offen offset:1024 sc1
  v_mfma_f32_16x16x32_bf16 v[172:175], a[72:75], v[88:91], v[172:175]
  v_mfma_f32_16x16x32_bf16 v[168:171], a[72:75], v[92:95], v[168:171]
  v_mfma_f32_16x16x32_bf16 v[180:183], a[76:79], v[88:91], v[180:183]
  v_mfma_f32_16x16x32_bf16 v[176:179], a[76:79], v[92:95], v[176:179]
  buffer_load_dwordx2 v[228:229], v5, s[16:19], s69 offen offset:2048 sc1
  s_add_u32 s69, s69, 2560
  v_swap_b32 v130, v132
  v_swap_b32 v131, v133
  v_swap_b32 v34, v36
  v_swap_b32 v35, v37
  v_swap_b32 v42, v44
  v_swap_b32 v43, v45
  s_nop 1
  v_mfma_f32_16x16x32_bf16 v[144:147], v[32:35], v[128:131], v[144:147]
  v_mfma_f32_16x16x32_bf16 v[148:151], v[32:35], v[132:135], v[148:151]
  buffer_load_dwordx4 v[220:223], v4, s[16:19], s69 offen offset:0 sc1
  v_mfma_f32_16x16x32_bf16 v[152:155], v[36:39], v[128:131], v[152:155]
  v_mfma_f32_16x16x32_bf16 v[156:159], v[36:39], v[132:135], v[156:159]
  v_mfma_f32_16x16x32_bf16 v[160:163], v[184:187], v[128:131], v[160:163]
  buffer_load_dwordx4 v[224:227], v4, s[16:19], s69 offen offset:1024 sc1
  v_mfma_f32_16x16x32_bf16 v[164:167], v[184:187], v[132:135], v[164:167]
  v_mfma_f32_16x16x32_bf16 v[168:171], v[40:43], v[128:131], v[168:171]
  v_mfma_f32_16x16x32_bf16 v[172:175], v[40:43], v[132:135], v[172:175]
  v_mfma_f32_16x16x32_bf16 v[176:179], v[44:47], v[128:131], v[176:179]
  buffer_load_dwordx2 v[230:231], v5, s[16:19], s69 offen offset:2048 sc1
  s_add_u32 s69, s69, 13824
  v_mfma_f32_16x16x32_bf16 v[180:183], v[44:47], v[132:135], v[180:183]
  s_waitcnt vmcnt(22)
  v_cmp_gt_u32 vcc, v19, v27
  s_cmp_le_u32 s50, s40
  s_cbranch_scc1 pv_309
  s_cbranch_vccnz pv_309
  s_lshl_b32 s61, s40, 21
  s_lshl_b32 s21, s40, 13
  s_and_b32 s21, s21, 8192
  s_xor_b32 s21, s21, s80
  s_add_u32 s61, s61, s21
  s_lshl_b32 s21, s20, 15
  s_add_u32 s47, s54, s21
  s_add_u32 s48, s61, s60
  s_xor_b32 s68, s61, 8192
  s_add_u32 s68, s68, s53
  s_add_u32 s70, s55, s42
  s_xor_b32 s70, s70, 0
  s_waitcnt vmcnt(42)
  v_mfma_f32_16x16x32_bf16 v[148:151], a[80:83], v[96:99], v[148:151]
  v_mfma_f32_16x16x32_bf16 v[144:147], a[80:83], v[100:103], v[144:147]
  buffer_load_dwordx4 a[0:3], v4, s[16:19], s68 offen offset:0 sc1
  v_mfma_f32_16x16x32_bf16 v[156:159], a[84:87], v[96:99], v[156:159]
  v_mfma_f32_16x16x32_bf16 v[152:155], a[84:87], v[100:103], v[152:155]
  v_mfma_f32_16x16x32_bf16 v[164:167], a[88:91], v[96:99], v[164:167]
  buffer_load_dwordx4 a[4:7], v4, s[16:19], s68 offen offset:1024 sc1
  v_mfma_f32_16x16x32_bf16 v[160:163], a[88:91], v[100:103], v[160:163]
  v_mfma_f32_16x16x32_bf16 v[172:175], a[92:95], v[96:99], v[172:175]
  v_mfma_f32_16x16x32_bf16 v[168:171], a[92:95], v[100:103], v[168:171]
  buffer_load_dwordx4 v[32:35], v22, s[16:19], s48 offen offset:0 sc1
  v_mfma_f32_16x16x32_bf16 v[180:183], a[96:99], v[96:99], v[180:183]
  v_mfma_f32_16x16x32_bf16 v[176:179], a[96:99], v[100:103], v[176:179]
  s_waitcnt vmcnt(36)
  v_mfma_f32_16x16x32_bf16 v[148:151], a[100:103], v[104:107], v[148:151]
  buffer_load_dwordx4 a[8:11], v4, s[16:19], s70 offen sc1
  s_add_u32 s70, s70, 16384
  v_mfma_f32_16x16x32_bf16 v[144:147], a[100:103], v[108:111], v[144:147]
  v_mfma_f32_16x16x32_bf16 v[156:159], a[104:107], v[104:107], v[156:159]
  v_mfma_f32_16x16x32_bf16 v[152:155], a[104:107], v[108:111], v[152:155]
  buffer_load_dwordx4 a[12:15], v4, s[16:19], s68 offen offset:2048 sc1
  v_mfma_f32_16x16x32_bf16 v[164:167], a[108:111], v[104:107], v[164:167]
  v_mfma_f32_16x16x32_bf16 v[160:163], a[108:111], v[108:111], v[160:163]
  buffer_load_dwordx4 a[16:19], v4, s[16:19], s68 offen offset:3072 sc1
  s_add_u32 s68, s68, 65536
  v_mfma_f32_16x16x32_bf16 v[172:175], a[112:115], v[104:107], v[172:175]
  v_mfma_f32_16x16x32_bf16 v[168:171], a[112:115], v[108:111], v[168:171]
  v_mfma_f32_16x16x32_bf16 v[180:183], a[116:119], v[104:107], v[180:183]
  buffer_load_dwordx4 v[64:67], v4, s[16:19], s47 offen sc1
  v_mfma_f32_16x16x32_bf16 v[176:179], a[116:119], v[108:111], v[176:179]
  s_waitcnt vmcnt(31)
  v_mfma_f32_16x16x32_bf16 v[148:151], a[120:123], v[112:115], v[148:151]
  v_mfma_f32_16x16x32_bf16 v[144:147], a[120:123], v[116:119], v[144:147]
  buffer_load_dwordx2 v[68:69], v5, s[16:19], s47 offen offset:2048 sc1
  v_mfma_f32_16x16x32_bf16 v[156:159], a[124:127], v[112:115], v[156:159]
  v_mfma_f32_16x16x32_bf16 v[152:155], a[124:127], v[116:119], v[152:155]
  v_mfma_f32_16x16x32_bf16 v[164:167], a[128:131], v[112:115], v[164:167]
  buffer_load_dwordx4 v[128:131], v21, s[16:19], s47 offen offset:1024 sc1
  s_add_u32 s47, s47, 2560
  v_mfma_f32_16x16x32_bf16 v[160:163], a[128:131], v[116:119], v[160:163]
  v_mfma_f32_16x16x32_bf16 v[172:175], a[132:135], v[112:115], v[172:175]
  v_mfma_f32_16x16x32_bf16 v[168:171], a[132:135], v[116:119], v[168:171]
  buffer_load_dwordx4 a[20:23], v4, s[16:19], s68 offen offset:0 sc1
  v_mfma_f32_16x16x32_bf16 v[180:183], a[136:139], v[112:115], v[180:183]
  v_mfma_f32_16x16x32_bf16 v[176:179], a[136:139], v[116:119], v[176:179]
  s_waitcnt vmcnt(24)
  v_mfma_f32_16x16x32_bf16 v[148:151], a[140:143], v[120:123], v[148:151]
  buffer_load_dwordx4 a[24:27], v4, s[16:19], s68 offen offset:1024 sc1
  v_mfma_f32_16x16x32_bf16 v[144:147], a[140:143], v[124:127], v[144:147]
  v_mfma_f32_16x16x32_bf16 v[156:159], a[144:147], v[120:123], v[156:159]
  v_mfma_f32_16x16x32_bf16 v[152:155], a[144:147], v[124:127], v[152:155]
  buffer_load_dwordx4 v[40:43], v28, s[16:19], s48 offen offset:0 sc1
  v_mfma_f32_16x16x32_bf16 v[164:167], a[148:151], v[120:123], v[164:167]
  v_mfma_f32_16x16x32_bf16 v[160:163], a[148:151], v[124:127], v[160:163]
  v_mfma_f32_16x16x32_bf16 v[172:175], a[152:155], v[120:123], v[172:175]
  buffer_load_dwordx4 a[28:31], v4, s[16:19], s70 offen sc1
  s_add_u32 s70, s70, 16384
  v_mfma_f32_16x16x32_bf16 v[168:171], a[152:155], v[124:127], v[168:171]
  v_mfma_f32_16x16x32_bf16 v[180:183], a[156:159], v[120:123], v[180:183]
  v_mfma_f32_16x16x32_bf16 v[176:179], a[156:159], v[124:127], v[176:179]
  buffer_load_dwordx4 a[32:35], v4, s[16:19], s68 offen offset:2048 sc1
  v_swap_b32 v138, v140
  v_swap_b32 v139, v141
  v_swap_b32 v50, v52
  v_swap_b32 v51, v53
  v_swap_b32 v58, v60
  v_swap_b32 v59, v61
  s_nop 1
  v_mfma_f32_16x16x32_bf16 v[144:147], v[48:51], v[136:139], v[144:147]
  buffer_load_dwordx4 a[36:39], v4, s[16:19], s68 offen offset:3072 sc1
  s_add_u32 s68, s68, 65536
  v_mfma_f32_16x16x32_bf16 v[148:151], v[48:51], v[140:143], v[148:151]
  v_mfma_f32_16x16x32_bf16 v[152:155], v[52:55], v[136:139], v[152:155]
  v_mfma_f32_16x16x32_bf16 v[156:159], v[52:55], v[140:143], v[156:159]
  buffer_load_dwordx2 v[184:185], v14, s[16:19], s48 offen offset:512 sc1
  v_mfma_f32_16x16x32_bf16 v[160:163], v[188:191], v[136:139], v[160:163]
  v_mfma_f32_16x16x32_bf16 v[164:167], v[188:191], v[140:143], v[164:167]
  v_mfma_f32_16x16x32_bf16 v[168:171], v[56:59], v[136:139], v[168:171]
  buffer_load_dwordx4 v[72:75], v4, s[16:19], s47 offen sc1
  v_mfma_f32_16x16x32_bf16 v[172:175], v[56:59], v[140:143], v[172:175]
  v_mfma_f32_16x16x32_bf16 v[176:179], v[60:63], v[136:139], v[176:179]
  v_mfma_f32_16x16x32_bf16 v[180:183], v[60:63], v[140:143], v[180:183]
  buffer_load_dwordx2 v[76:77], v5, s[16:19], s47 offen offset:2048 sc1
  s_add_u32 s47, s47, 13824
  s_nop 0
  ds_write_b128 v10, v[144:147] offset:0
  buffer_load_dwordx4 a[40:43], v4, s[16:19], s68 offen offset:0 sc1
  ds_write_b128 v10, v[148:151] offset:1024
  buffer_load_dwordx4 a[44:47], v4, s[16:19], s68 offen offset:1024 sc1
  ds_write_b128 v10, v[152:155] offset:2048
  ds_write_b128 v10, v[156:159] offset:3072
  buffer_load_dwordx4 v[36:39], v22, s[16:19], s48 offen offset:1280 sc1
  ds_write_b128 v10, v[160:163] offset:4096
  buffer_load_dwordx4 a[48:51], v4, s[16:19], s70 offen sc1
  s_add_u32 s70, s70, 16384
  ds_write_b128 v10, v[164:167] offset:5120
  buffer_load_dwordx4 a[52:55], v4, s[16:19], s68 offen offset:2048 sc1
  ds_write_b128 v10, v[168:171] offset:6144
  buffer_load_dwordx4 a[56:59], v4, s[16:19], s68 offen offset:3072 sc1
  s_add_u32 s68, s68, 65536
  ds_write_b128 v10, v[172:175] offset:7168
  buffer_load_dwordx4 v[80:83], v4, s[16:19], s47 offen sc1
  s_nop 1
  ds_write_b128 v10, v[176:179] offset:8192
  buffer_load_dwordx2 v[84:85], v5, s[16:19], s47 offen offset:2048 sc1
  ds_write_b128 v10, v[180:183] offset:9216
  buffer_load_dwordx4 v[132:135], v21, s[16:19], s47 offen offset:1024 sc1
  s_add_u32 s47, s47, 2560
  s_waitcnt lgkmcnt(0)
  s_barrier
  ds_read_b128 v[144:147], v11 offset:0
  ds_read_b128 v[148:151], v11 offset:10240
  ds_read_b128 v[152:155], v11 offset:20480
  ds_read_b128 v[156:159], v11 offset:30720
  ds_read_b128 v[160:163], v11 offset:2048
  ds_read_b128 v[164:167], v11 offset:12288
  ds_read_b128 v[168:171], v11 offset:22528
  ds_read_b128 v[172:175], v11 offset:32768
  s_waitcnt lgkmcnt(4)
  buffer_load_dwordx4 a[60:63], v4, s[16:19], s68 offen offset:0 sc1
  v_pk_add_f32 v[144:145], v[144:145], v[148:149]
  v_pk_add_f32 v[152:153], v[152:153], v[156:157]
  v_pk_add_f32 v[146:147], v[146:147], v[150:151]
  v_pk_add_f32 v[154:155], v[154:155], v[158:159]
  v_pk_add_f32 v[176:177], v[144:145], v[152:153]
  v_pk_add_f32 v[178:179], v[146:147], v[154:155]
  ds_read_b128 v[144:147], v12 offset:0
  ds_read_b128 v[148:151], v12 offset:10240
  ds_read_b128 v[152:155], v12 offset:20480
  ds_read_b128 v[156:159], v12 offset:30720
  v_cvt_pk_bf16_f32 v26, v176, v177
  buffer_load_dwordx4 a[64:67], v4, s[16:19], s68 offen offset:1024 sc1
  v_lshlrev_b32 v176, 16, v26
  v_and_b32 v177, 0xffff0000, v26
  v_mul_f32 v176, v176, v24
  v_mul_f32 v177, v177, v24
  v_cvt_pk_bf16_f32 v26, v176, v177
  v_lshlrev_b32 v176, 16, v26
  v_and_b32 v177, 0xffff0000, v26
  v_add_f32 v176, v176, v240
  v_add_f32 v177, v177, v241
  v_cvt_pk_bf16_f32 v236, v176, v177
  v_cvt_pk_bf16_f32 v26, v178, v179
  v_lshlrev_b32 v178, 16, v26
  buffer_load_dwordx4 v[44:47], v28, s[16:19], s48 offen offset:1280 sc1
  v_and_b32 v179, 0xffff0000, v26
  v_mul_f32 v178, v178, v24
  v_mul_f32 v179, v179, v24
  v_cvt_pk_bf16_f32 v26, v178, v179
  v_lshlrev_b32 v178, 16, v26
  v_and_b32 v179, 0xffff0000, v26
  v_add_f32 v178, v178, v242
  v_add_f32 v179, v179, v243
  v_cvt_pk_bf16_f32 v237, v178, v179
  s_waitcnt lgkmcnt(4)
  v_pk_add_f32 v[160:161], v[160:161], v[164:165]
  v_pk_add_f32 v[168:169], v[168:169], v[172:173]
  buffer_load_dwordx4 a[68:71], v4, s[16:19], s70 offen sc1
  s_add_u32 s70, s70, 16384
  v_pk_add_f32 v[162:163], v[162:163], v[166:167]
  v_pk_add_f32 v[170:171], v[170:171], v[174:175]
  v_pk_add_f32 v[176:177], v[160:161], v[168:169]
  v_pk_add_f32 v[178:179], v[162:163], v[170:171]
  v_cvt_pk_bf16_f32 v26, v176, v177
  v_lshlrev_b32 v176, 16, v26
  v_and_b32 v177, 0xffff0000, v26
  v_mul_f32 v176, v176, v24
  v_mul_f32 v177, v177, v24
  v_cvt_pk_bf16_f32 v26, v176, v177
  v_lshlrev_b32 v176, 16, v26
  buffer_load_dwordx4 a[72:75], v4, s[16:19], s68 offen offset:2048 sc1
  v_and_b32 v177, 0xffff0000, v26
  v_add_f32 v176, v176, v244
  v_add_f32 v177, v177, v245
  v_cvt_pk_bf16_f32 v238, v176, v177
  v_cvt_pk_bf16_f32 v26, v178, v179
  v_lshlrev_b32 v178, 16, v26
  v_and_b32 v179, 0xffff0000, v26
  v_mul_f32 v178, v178, v24
  v_mul_f32 v179, v179, v24
  v_cvt_pk_bf16_f32 v26, v178, v179
  v_lshlrev_b32 v178, 16, v26
  v_and_b32 v179, 0xffff0000, v26
  buffer_load_dwordx4 a[76:79], v4, s[16:19], s68 offen offset:3072 sc1
  s_add_u32 s68, s68, 65536
  v_add_f32 v178, v178, v246
  v_add_f32 v179, v179, v247
  v_cvt_pk_bf16_f32 v239, v178, v179
  buffer_store_dwordx4 v[236:239], v9, s[8:11], s46 offen
  s_cmp_lt_u32 s20, 2
  s_cselect_b32 s49, s49, 0x40000000
  s_waitcnt lgkmcnt(0)
  v_pk_add_f32 v[144:145], v[144:145], v[148:149]
  v_pk_add_f32 v[152:153], v[152:153], v[156:157]
  v_pk_add_f32 v[146:147], v[146:147], v[150:151]
  v_pk_add_f32 v[154:155], v[154:155], v[158:159]
  buffer_load_dwordx2 v[186:187], v14, s[16:19], s48 offen offset:1792 sc1
  s_add_u32 s48, s48, 262144
  v_pk_add_f32 v[176:177], v[144:145], v[152:153]
  v_pk_add_f32 v[178:179], v[146:147], v[154:155]
  v_cvt_pk_bf16_f32 v26, v176, v177
  v_lshlrev_b32 v176, 16, v26
  v_and_b32 v177, 0xffff0000, v26
  v_mul_f32 v176, v176, v24
  v_mul_f32 v177, v177, v24
  v_cvt_pk_bf16_f32 v26, v176, v177
  v_lshlrev_b32 v176, 16, v26
  v_and_b32 v177, 0xffff0000, v26
  v_add_f32 v176, v176, v248
  v_add_f32 v177, v177, v249
  buffer_load_dwordx4 v[88:91], v4, s[16:19], s47 offen sc1
  v_cvt_pk_bf16_f32 v234, v176, v177
  v_cvt_pk_bf16_f32 v26, v178, v179
  v_lshlrev_b32 v178, 16, v26
  v_and_b32 v179, 0xffff0000, v26
  v_mul_f32 v178, v178, v24
  v_mul_f32 v179, v179, v24
  v_cvt_pk_bf16_f32 v26, v178, v179
  v_lshlrev_b32 v178, 16, v26
  v_and_b32 v179, 0xffff0000, v26
  v_add_f32 v178, v178, v250
  v_add_f32 v179, v179, v251
  v_cvt_pk_bf16_f32 v235, v178, v179
  buffer_load_dwordx2 v[92:93], v5, s[16:19], s47 offen offset:2048 sc1
  s_add_u32 s47, s47, 13824
  buffer_store_dwordx2 v[234:235], v13, s[8:11], s49 offen offset:64
  s_branch pv_loop
pv_309:
  s_waitcnt vmcnt(42)
  v_mfma_f32_16x16x32_bf16 v[148:151], a[80:83], v[96:99], v[148:151]
  v_mfma_f32_16x16x32_bf16 v[144:147], a[80:83], v[100:103], v[144:147]
  v_mfma_f32_16x16x32_bf16 v[156:159], a[84:87], v[96:99], v[156:159]
  v_mfma_f32_16x16x32_bf16 v[152:155], a[84:87], v[100:103], v[152:155]
  v_mfma_f32_16x16x32_bf16 v[164:167], a[88:91], v[96:99], v[164:167]
  v_mfma_f32_16x16x32_bf16 v[160:163], a[88:91], v[100:103], v[160:163]
  v_mfma_f32_16x16x32_bf16 v[172:175], a[92:95], v[96:99], v[172:175]
  v_mfma_f32_16x16x32_bf16 v[168:171], a[92:95], v[100:103], v[168:171]
  v_mfma_f32_16x16x32_bf16 v[180:183], a[96:99], v[96:99], v[180:183]
  v_mfma_f32_16x16x32_bf16 v[176:179], a[96:99], v[100:103], v[176:179]
  s_waitcnt vmcnt(33)
  v_mfma_f32_16x16x32_bf16 v[148:151], a[100:103], v[104:107], v[148:151]
  v_mfma_f32_16x16x32_bf16 v[144:147], a[100:103], v[108:111], v[144:147]
  v_mfma_f32_16x16x32_bf16 v[156:159], a[104:107], v[104:107], v[156:159]
  v_mfma_f32_16x16x32_bf16 v[152:155], a[104:107], v[108:111], v[152:155]
  v_mfma_f32_16x16x32_bf16 v[164:167], a[108:111], v[104:107], v[164:167]
  v_mfma_f32_16x16x32_bf16 v[160:163], a[108:111], v[108:111], v[160:163]
  v_mfma_f32_16x16x32_bf16 v[172:175], a[112:115], v[104:107], v[172:175]
  v_mfma_f32_16x16x32_bf16 v[168:171], a[112:115], v[108:111], v[168:171]
  v_mfma_f32_16x16x32_bf16 v[180:183], a[116:119], v[104:107], v[180:183]
  v_mfma_f32_16x16x32_bf16 v[176:179], a[116:119], v[108:111], v[176:179]
  s_waitcnt vmcnt(24)
  v_mfma_f32_16x16x32_bf16 v[148:151], a[120:123], v[112:115], v[148:151]
  v_mfma_f32_16x16x32_bf16 v[144:147], a[120:123], v[116:119], v[144:147]
  v_mfma_f32_16x16x32_bf16 v[156:159], a[124:127], v[112:115], v[156:159]
  v_mfma_f32_16x16x32_bf16 v[152:155], a[124:127], v[116:119], v[152:155]
  v_mfma_f32_16x16x32_bf16 v[164:167], a[128:131], v[112:115], v[164:167]
  v_mfma_f32_16x16x32_bf16 v[160:163], a[128:131], v[116:119], v[160:163]
  v_mfma_f32_16x16x32_bf16 v[172:175], a[132:135], v[112:115], v[172:175]
  v_mfma_f32_16x16x32_bf16 v[168:171], a[132:135], v[116:119], v[168:171]
  v_mfma_f32_16x16x32_bf16 v[180:183], a[136:139], v[112:115], v[180:183]
  v_mfma_f32_16x16x32_bf16 v[176:179], a[136:139], v[116:119], v[176:179]
  s_waitcnt vmcnt(14)
  v_mfma_f32_16x16x32_bf16 v[148:151], a[140:143], v[120:123], v[148:151]
  v_mfma_f32_16x16x32_bf16 v[144:147], a[140:143], v[124:127], v[144:147]
  v_mfma_f32_16x16x32_bf16 v[156:159], a[144:147], v[120:123], v[156:159]
  v_mfma_f32_16x16x32_bf16 v[152:155], a[144:147], v[124:127], v[152:155]
  v_mfma_f32_16x16x32_bf16 v[164:167], a[148:151], v[120:123], v[164:167]
  v_mfma_f32_16x16x32_bf16 v[160:163], a[148:151], v[124:127], v[160:163]
  v_mfma_f32_16x16x32_bf16 v[172:175], a[152:155], v[120:123], v[172:175]
  v_mfma_f32_16x16x32_bf16 v[168:171], a[152:155], v[124:127], v[168:171]
  v_mfma_f32_16x16x32_bf16 v[180:183], a[156:159], v[120:123], v[180:183]
  v_mfma_f32_16x16x32_bf16 v[176:179], a[156:159], v[124:127], v[176:179]
  v_swap_b32 v138, v140
  v_swap_b32 v139, v141
  v_swap_b32 v50, v52
  v_swap_b32 v51, v53
  v_swap_b32 v58, v60
  v_swap_b32 v59, v61
  s_nop 1
  v_mfma_f32_16x16x32_bf16 v[144:147], v[48:51], v[136:139], v[144:147]
  v_mfma_f32_16x16x32_bf16 v[148:151], v[48:51], v[140:143], v[148:151]
  v_mfma_f32_16x16x32_bf16 v[152:155], v[52:55], v[136:139], v[152:155]
  v_mfma_f32_16x16x32_bf16 v[156:159], v[52:55], v[140:143], v[156:159]
  v_mfma_f32_16x16x32_bf16 v[160:163], v[188:191], v[136:139], v[160:163]
  v_mfma_f32_16x16x32_bf16 v[164:167], v[188:191], v[140:143], v[164:167]
  v_mfma_f32_16x16x32_bf16 v[168:171], v[56:59], v[136:139], v[168:171]
  v_mfma_f32_16x16x32_bf16 v[172:175], v[56:59], v[140:143], v[172:175]
  v_mfma_f32_16x16x32_bf16 v[176:179], v[60:63], v[136:139], v[176:179]
  v_mfma_f32_16x16x32_bf16 v[180:183], v[60:63], v[140:143], v[180:183]
  s_branch pve_304
pvw_303:
  v_mfma_f32_16x16x32_bf16 v[144:147], a[160:163], v[192:195], 0
  v_mfma_f32_16x16x32_bf16 v[148:151], a[160:163], v[212:215], 0
  v_mfma_f32_16x16x32_bf16 v[152:155], a[164:167], v[192:195], 0
  v_mfma_f32_16x16x32_bf16 v[156:159], a[164:167], v[212:215], 0
  v_mfma_f32_16x16x32_bf16 v[160:163], a[168:171], v[192:195], 0
  v_mfma_f32_16x16x32_bf16 v[164:167], a[168:171], v[212:215], 0
  v_mfma_f32_16x16x32_bf16 v[168:171], a[172:175], v[192:195], 0
  v_mfma_f32_16x16x32_bf16 v[172:175], a[172:175], v[212:215], 0
  v_mfma_f32_16x16x32_bf16 v[176:179], a[176:179], v[192:195], 0
  v_mfma_f32_16x16x32_bf16 v[180:183], a[176:179], v[212:215], 0
  v_mfma_f32_16x16x32_bf16 v[144:147], a[180:183], v[196:199], v[144:147]
  v_mfma_f32_16x16x32_bf16 v[148:151], a[180:183], v[216:219], v[148:151]
  v_mfma_f32_16x16x32_bf16 v[152:155], a[184:187], v[196:199], v[152:155]
  v_mfma_f32_16x16x32_bf16 v[156:159], a[184:187], v[216:219], v[156:159]
  v_mfma_f32_16x16x32_bf16 v[160:163], a[188:191], v[196:199], v[160:163]
  v_mfma_f32_16x16x32_bf16 v[164:167], a[188:191], v[216:219], v[164:167]
  v_mfma_f32_16x16x32_bf16 v[168:171], a[192:195], v[196:199], v[168:171]
  v_mfma_f32_16x16x32_bf16 v[172:175], a[192:195], v[216:219], v[172:175]
  v_mfma_f32_16x16x32_bf16 v[176:179], a[196:199], v[196:199], v[176:179]
  v_mfma_f32_16x16x32_bf16 v[180:183], a[196:199], v[216:219], v[180:183]
  v_mfma_f32_16x16x32_bf16 v[144:147], a[200:203], v[200:203], v[144:147]
  v_mfma_f32_16x16x32_bf16 v[148:151], a[200:203], v[220:223], v[148:151]
  v_mfma_f32_16x16x32_bf16 v[152:155], a[204:207], v[200:203], v[152:155]
  v_mfma_f32_16x16x32_bf16 v[156:159], a[204:207], v[220:223], v[156:159]
  v_mfma_f32_16x16x32_bf16 v[160:163], a[208:211], v[200:203], v[160:163]
  v_mfma_f32_16x16x32_bf16 v[164:167], a[208:211], v[220:223], v[164:167]
  v_mfma_f32_16x16x32_bf16 v[168:171], a[212:215], v[200:203], v[168:171]
  v_mfma_f32_16x16x32_bf16 v[172:175], a[212:215], v[220:223], v[172:175]
  v_mfma_f32_16x16x32_bf16 v[176:179], a[216:219], v[200:203], v[176:179]
  v_mfma_f32_16x16x32_bf16 v[180:183], a[216:219], v[220:223], v[180:183]
  v_mfma_f32_16x16x32_bf16 v[144:147], a[220:223], v[204:207], v[144:147]
  v_mfma_f32_16x16x32_bf16 v[148:151], a[220:223], v[224:227], v[148:151]
  v_mfma_f32_16x16x32_bf16 v[152:155], a[224:227], v[204:207], v[152:155]
  v_mfma_f32_16x16x32_bf16 v[156:159], a[224:227], v[224:227], v[156:159]
  v_mfma_f32_16x16x32_bf16 v[160:163], a[228:231], v[204:207], v[160:163]
  v_mfma_f32_16x16x32_bf16 v[164:167], a[228:231], v[224:227], v[164:167]
  v_mfma_f32_16x16x32_bf16 v[168:171], a[232:235], v[204:207], v[168:171]
  v_mfma_f32_16x16x32_bf16 v[172:175], a[232:235], v[224:227], v[172:175]
  v_mfma_f32_16x16x32_bf16 v[176:179], a[236:239], v[204:207], v[176:179]
  v_mfma_f32_16x16x32_bf16 v[180:183], a[236:239], v[224:227], v[180:183]
  v_mfma_f32_16x16x32_bf16 v[144:147], a[240:243], v[208:211], v[144:147]
  v_mfma_f32_16x16x32_bf16 v[148:151], a[240:243], v[228:231], v[148:151]
  v_mfma_f32_16x16x32_bf16 v[152:155], a[244:247], v[208:211], v[152:155]
  v_mfma_f32_16x16x32_bf16 v[156:159], a[244:247], v[228:231], v[156:159]
  v_mfma_f32_16x16x32_bf16 v[160:163], a[248:251], v[208:211], v[160:163]
  v_mfma_f32_16x16x32_bf16 v[164:167], a[248:251], v[228:231], v[164:167]
  v_mfma_f32_16x16x32_bf16 v[168:171], a[252:255], v[208:211], v[168:171]
  v_mfma_f32_16x16x32_bf16 v[172:175], a[252:255], v[228:231], v[172:175]
  v_mfma_f32_16x16x32_bf16 v[176:179], v[252:255], v[208:211], v[176:179]
  v_mfma_f32_16x16x32_bf16 v[180:183], v[252:255], v[228:231], v[180:183]
  ds_write_b128 v10, v[144:147] offset:40960
  ds_write_b128 v10, v[148:151] offset:41984
  ds_write_b128 v10, v[152:155] offset:43008
  ds_write_b128 v10, v[156:159] offset:44032
  ds_write_b128 v10, v[160:163] offset:45056
  ds_write_b128 v10, v[164:167] offset:46080
  ds_write_b128 v10, v[168:171] offset:47104
  ds_write_b128 v10, v[172:175] offset:48128
  s_nop 1
  ds_write_b128 v10, v[176:179] offset:49152
  ds_write_b128 v10, v[180:183] offset:50176
  s_waitcnt lgkmcnt(0)
  s_barrier
  ds_read_b32 v23, v30
  s_waitcnt lgkmcnt(0)
  v_readfirstlane_b32 s2, v23
  s_min_u32 s2, s2, 16
  s_cmp_eq_u32 s87, 0
  s_cselect_b32 s2, 16, s2
  v_sub_f32 v25, 1.0, v24
  v_cvt_pk_bf16_f32 v26, v25, v25
  v_lshlrev_b32 v25, 16, v26
  ds_read_b128 v[144:147], v15 offset:0
  ds_read_b128 v[148:151], v15 offset:10240
  ds_read_b128 v[152:155], v15 offset:20480
  ds_read_b128 v[156:159], v15 offset:30720
  ds_read_b128 v[160:163], v15 offset:2048
  ds_read_b128 v[164:167], v15 offset:12288
  ds_read_b128 v[168:171], v15 offset:22528
  ds_read_b128 v[172:175], v15 offset:32768
  s_waitcnt lgkmcnt(4)
  v_pk_add_f32 v[144:145], v[144:145], v[148:149]
  v_pk_add_f32 v[152:153], v[152:153], v[156:157]
  v_pk_add_f32 v[146:147], v[146:147], v[150:151]
  v_pk_add_f32 v[154:155], v[154:155], v[158:159]
  v_pk_add_f32 v[176:177], v[144:145], v[152:153]
  v_pk_add_f32 v[178:179], v[146:147], v[154:155]
  ds_read_b128 v[144:147], v16 offset:0
  ds_read_b128 v[148:151], v16 offset:10240
  ds_read_b128 v[152:155], v16 offset:20480
  ds_read_b128 v[156:159], v16 offset:30720
  v_cvt_pk_bf16_f32 v26, v176, v177
  v_lshlrev_b32 v240, 16, v26
  v_and_b32 v241, 0xffff0000, v26
  v_mul_f32 v240, v240, v25
  v_mul_f32 v241, v241, v25
  v_cvt_pk_bf16_f32 v26, v240, v241
  v_lshlrev_b32 v240, 16, v26
  v_and_b32 v241, 0xffff0000, v26
  v_cvt_pk_bf16_f32 v26, v178, v179
  v_lshlrev_b32 v242, 16, v26
  v_and_b32 v243, 0xffff0000, v26
  v_mul_f32 v242, v242, v25
  v_mul_f32 v243, v243, v25
  v_cvt_pk_bf16_f32 v26, v242, v243
  v_lshlrev_b32 v242, 16, v26
  v_and_b32 v243, 0xffff0000, v26
  s_waitcnt lgkmcnt(4)
  v_pk_add_f32 v[160:161], v[160:161], v[164:165]
  v_pk_add_f32 v[168:169], v[168:169], v[172:173]
  v_pk_add_f32 v[162:163], v[162:163], v[166:167]
  v_pk_add_f32 v[170:171], v[170:171], v[174:175]
  v_pk_add_f32 v[176:177], v[160:161], v[168:169]
  v_pk_add_f32 v[178:179], v[162:163], v[170:171]
  v_cvt_pk_bf16_f32 v26, v176, v177
  v_lshlrev_b32 v244, 16, v26
  v_and_b32 v245, 0xffff0000, v26
  v_mul_f32 v244, v244, v25
  v_mul_f32 v245, v245, v25
  v_cvt_pk_bf16_f32 v26, v244, v245
  v_lshlrev_b32 v244, 16, v26
  v_and_b32 v245, 0xffff0000, v26
  v_cvt_pk_bf16_f32 v26, v178, v179
  v_lshlrev_b32 v246, 16, v26
  v_and_b32 v247, 0xffff0000, v26
  v_mul_f32 v246, v246, v25
  v_mul_f32 v247, v247, v25
  v_cvt_pk_bf16_f32 v26, v246, v247
  v_lshlrev_b32 v246, 16, v26
  v_and_b32 v247, 0xffff0000, v26
  s_waitcnt lgkmcnt(0)
  v_pk_add_f32 v[144:145], v[144:145], v[148:149]
  v_pk_add_f32 v[152:153], v[152:153], v[156:157]
  v_pk_add_f32 v[146:147], v[146:147], v[150:151]
  v_pk_add_f32 v[154:155], v[154:155], v[158:159]
  v_pk_add_f32 v[176:177], v[144:145], v[152:153]
  v_pk_add_f32 v[178:179], v[146:147], v[154:155]
  v_cvt_pk_bf16_f32 v26, v176, v177
  v_lshlrev_b32 v248, 16, v26
  v_and_b32 v249, 0xffff0000, v26
  v_mul_f32 v248, v248, v25
  v_mul_f32 v249, v249, v25
  v_cvt_pk_bf16_f32 v26, v248, v249
  v_lshlrev_b32 v248, 16, v26
  v_and_b32 v249, 0xffff0000, v26
  v_cvt_pk_bf16_f32 v26, v178, v179
  v_lshlrev_b32 v250, 16, v26
  v_and_b32 v251, 0xffff0000, v26
  v_mul_f32 v250, v250, v25
  v_mul_f32 v251, v251, v25
  v_cvt_pk_bf16_f32 v26, v250, v251
  v_lshlrev_b32 v250, 16, v26
  v_and_b32 v251, 0xffff0000, v26
  s_cmp_ge_u32 s40, 60
  s_cbranch_scc1 pvt_310
  s_cmp_lg_u32 s20, 0
  s_cbranch_scc1 wr_312
  s_mov_b32 s101, 0
wr_311:
  buffer_load_dword v26, v18, s[72:75], 0 offen sc1
  s_add_u32 s101, s101, 1
  s_cmp_gt_u32 s101, 131072
  s_cbranch_scc1 main_end
  s_waitcnt vmcnt(0)
  v_cmp_gt_u32 vcc, v19, v26
  v_readfirstlane_b32 s100, v26
  s_nop 0
  s_cbranch_vccz wr_312
  s_sleep 2
  s_cmp_lg_u32 s100, 0
  s_cbranch_scc1 wr_311
  s_sleep 24
  s_branch wr_311
wr_312:
  s_barrier
  s_waitcnt vmcnt(10)
  buffer_load_dwordx4 v[64:67], v4, s[16:19], s47 offen sc1
  buffer_load_dwordx2 v[68:69], v5, s[16:19], s47 offen offset:2048 sc1
  buffer_load_dwordx4 v[128:131], v21, s[16:19], s47 offen offset:1024 sc1
  s_add_u32 s47, s47, 2560
  buffer_load_dwordx4 v[72:75], v4, s[16:19], s47 offen sc1
  buffer_load_dwordx2 v[76:77], v5, s[16:19], s47 offen offset:2048 sc1
  s_add_u32 s47, s47, 13824
  buffer_load_dwordx4 v[80:83], v4, s[16:19], s47 offen sc1
  buffer_load_dwordx2 v[84:85], v5, s[16:19], s47 offen offset:2048 sc1
  buffer_load_dwordx4 v[132:135], v21, s[16:19], s47 offen offset:1024 sc1
  s_add_u32 s47, s47, 2560
  buffer_load_dwordx4 v[88:91], v4, s[16:19], s47 offen sc1
  buffer_load_dwordx2 v[92:93], v5, s[16:19], s47 offen offset:2048 sc1
  s_add_u32 s47, s47, 13824
  buffer_load_dwordx4 v[32:35], v22, s[16:19], s48 offen offset:0 sc1
  buffer_load_dwordx4 v[40:43], v28, s[16:19], s48 offen offset:0 sc1
  buffer_load_dwordx2 v[184:185], v14, s[16:19], s48 offen offset:512 sc1
  buffer_load_dwordx4 v[36:39], v22, s[16:19], s48 offen offset:1280 sc1
  buffer_load_dwordx4 v[44:47], v28, s[16:19], s48 offen offset:1280 sc1
  buffer_load_dwordx2 v[186:187], v14, s[16:19], s48 offen offset:1792 sc1
  s_add_u32 s48, s48, 262144
  buffer_load_dwordx4 v[96:99], v4, s[16:19], s47 offen sc1
  buffer_load_dwordx2 v[100:101], v5, s[16:19], s47 offen offset:2048 sc1
  buffer_load_dwordx4 v[136:139], v21, s[16:19], s47 offen offset:1024 sc1
  s_add_u32 s47, s47, 2560
  buffer_load_dwordx4 v[104:107], v4, s[16:19], s47 offen sc1
  buffer_load_dwordx2 v[108:109], v5, s[16:19], s47 offen offset:2048 sc1
  s_add_u32 s47, s47, 13824
  buffer_load_dwordx4 v[112:115], v4, s[16:19], s47 offen sc1
  buffer_load_dwordx2 v[116:117], v5, s[16:19], s47 offen offset:2048 sc1
  buffer_load_dwordx4 v[140:143], v21, s[16:19], s47 offen offset:1024 sc1
  s_add_u32 s47, s47, 2560
  buffer_load_dwordx4 v[120:123], v4, s[16:19], s47 offen sc1
  buffer_load_dwordx2 v[124:125], v5, s[16:19], s47 offen offset:2048 sc1
  s_add_u32 s47, s47, 13824
  buffer_load_dwordx4 v[48:51], v22, s[16:19], s48 offen offset:0 sc1
  buffer_load_dwordx4 v[56:59], v28, s[16:19], s48 offen offset:0 sc1
  buffer_load_dwordx2 v[188:189], v14, s[16:19], s48 offen offset:512 sc1
  buffer_load_dwordx4 v[52:55], v22, s[16:19], s48 offen offset:1280 sc1
  buffer_load_dwordx4 v[60:63], v28, s[16:19], s48 offen offset:1280 sc1
  buffer_load_dwordx2 v[190:191], v14, s[16:19], s48 offen offset:1792 sc1
  s_add_u32 s48, s48, 262144
  s_lshl_b32 s40, s2, 2
  s_add_u32 s40, s40, s58
  s_lshl_b32 s21, s40, 7
  s_add_u32 s21, s21, 8192
  s_xor_b32 s21, s21, s80
  v_mov_b32 v18, s21
  v_cndmask_b32 v18, v17, v18, s[66:67]
  s_add_u32 s21, s40, 1
  v_mov_b32 v19, s21
  v_cndmask_b32 v19, v19, 32, s[66:67]
  buffer_load_dword v27, v18, s[72:75], 0 offen sc1
  s_lshl_b32 s55, s40, 19
  s_lshl_b32 s21, s40, 11
  s_and_b32 s21, s21, 8192
  s_xor_b32 s21, s21, s80
  s_add_u32 s55, s55, s21
  s_add_u32 s55, s55, 136314880
  s_lshl_b32 s21, s20, 15
  s_xor_b32 s54, s55, 8192
  s_add_u32 s54, s54, 48234496
  s_add_u32 s54, s54, s21
  s_lshl_b32 s57, s40, 1
  s_add_u32 s57, s57, s43
  s_lshl_b32 s45, s57, 6
  s_add_u32 s69, s54, 262144
  s_cmp_lt_u32 s2, 16
  s_cselect_b32 s69, s69, 0x40000000
  s_cselect_b32 s64, s87, 0
  s_cmp_gt_u32 s64, 1
  s_cselect_b32 s64, s59, 0x40000000
  v_mov_b32 v29, 1
  buffer_atomic_add v29, v233, s[72:75], s64 offen sc0 sc1
  buffer_load_dword v232, v6, s[28:31], s45 offen sc1
  buffer_load_dwordx4 v[192:195], v4, s[16:19], s69 offen offset:0 sc1
  buffer_load_dwordx4 v[196:199], v4, s[16:19], s69 offen offset:1024 sc1
  buffer_load_dwordx2 v[208:209], v5, s[16:19], s69 offen offset:2048 sc1
  s_add_u32 s69, s69, 2560
  buffer_load_dwordx4 v[200:203], v4, s[16:19], s69 offen offset:0 sc1
  buffer_load_dwordx4 v[204:207], v4, s[16:19], s69 offen offset:1024 sc1
  buffer_load_dwordx2 v[210:211], v5, s[16:19], s69 offen offset:2048 sc1
  s_add_u32 s69, s69, 13824
  buffer_load_dwordx4 v[212:215], v4, s[16:19], s69 offen offset:0 sc1
  buffer_load_dwordx4 v[216:219], v4, s[16:19], s69 offen offset:1024 sc1
  buffer_load_dwordx2 v[228:229], v5, s[16:19], s69 offen offset:2048 sc1
  s_add_u32 s69, s69, 2560
  buffer_load_dwordx4 v[220:223], v4, s[16:19], s69 offen offset:0 sc1
  buffer_load_dwordx4 v[224:227], v4, s[16:19], s69 offen offset:1024 sc1
  buffer_load_dwordx2 v[230:231], v5, s[16:19], s69 offen offset:2048 sc1
  s_add_u32 s69, s69, 13824
  s_waitcnt vmcnt(45)
  v_mfma_f32_16x16x32_bf16 v[148:151], a[0:3], v[64:67], 0
  v_mfma_f32_16x16x32_bf16 v[144:147], a[0:3], v[68:71], 0
  v_mfma_f32_16x16x32_bf16 v[156:159], a[4:7], v[64:67], 0
  v_mfma_f32_16x16x32_bf16 v[152:155], a[4:7], v[68:71], 0
  v_mfma_f32_16x16x32_bf16 v[164:167], a[8:11], v[64:67], 0
  v_mfma_f32_16x16x32_bf16 v[160:163], a[8:11], v[68:71], 0
  v_mfma_f32_16x16x32_bf16 v[172:175], a[12:15], v[64:67], 0
  v_mfma_f32_16x16x32_bf16 v[168:171], a[12:15], v[68:71], 0
  v_mfma_f32_16x16x32_bf16 v[180:183], a[16:19], v[64:67], 0
  v_mfma_f32_16x16x32_bf16 v[176:179], a[16:19], v[68:71], 0
  s_waitcnt vmcnt(42)
  v_mfma_f32_16x16x32_bf16 v[148:151], a[20:23], v[72:75], v[148:151]
  v_mfma_f32_16x16x32_bf16 v[144:147], a[20:23], v[76:79], v[144:147]
  v_mfma_f32_16x16x32_bf16 v[156:159], a[24:27], v[72:75], v[156:159]
  v_mfma_f32_16x16x32_bf16 v[152:155], a[24:27], v[76:79], v[152:155]
  v_mfma_f32_16x16x32_bf16 v[164:167], a[28:31], v[72:75], v[164:167]
  v_mfma_f32_16x16x32_bf16 v[160:163], a[28:31], v[76:79], v[160:163]
  v_mfma_f32_16x16x32_bf16 v[172:175], a[32:35], v[72:75], v[172:175]
  v_mfma_f32_16x16x32_bf16 v[168:171], a[32:35], v[76:79], v[168:171]
  v_mfma_f32_16x16x32_bf16 v[180:183], a[36:39], v[72:75], v[180:183]
  v_mfma_f32_16x16x32_bf16 v[176:179], a[36:39], v[76:79], v[176:179]
  s_waitcnt vmcnt(40)
  v_mfma_f32_16x16x32_bf16 v[148:151], a[40:43], v[80:83], v[148:151]
  v_mfma_f32_16x16x32_bf16 v[144:147], a[40:43], v[84:87], v[144:147]
  v_mfma_f32_16x16x32_bf16 v[156:159], a[44:47], v[80:83], v[156:159]
  v_mfma_f32_16x16x32_bf16 v[152:155], a[44:47], v[84:87], v[152:155]
  v_mfma_f32_16x16x32_bf16 v[164:167], a[48:51], v[80:83], v[164:167]
  v_mfma_f32_16x16x32_bf16 v[160:163], a[48:51], v[84:87], v[160:163]
  v_mfma_f32_16x16x32_bf16 v[172:175], a[52:55], v[80:83], v[172:175]
  v_mfma_f32_16x16x32_bf16 v[168:171], a[52:55], v[84:87], v[168:171]
  v_mfma_f32_16x16x32_bf16 v[180:183], a[56:59], v[80:83], v[180:183]
  v_mfma_f32_16x16x32_bf16 v[176:179], a[56:59], v[84:87], v[176:179]
  s_waitcnt vmcnt(37)
  v_mfma_f32_16x16x32_bf16 v[148:151], a[60:63], v[88:91], v[148:151]
  v_mfma_f32_16x16x32_bf16 v[144:147], a[60:63], v[92:95], v[144:147]
  v_mfma_f32_16x16x32_bf16 v[156:159], a[64:67], v[88:91], v[156:159]
  v_mfma_f32_16x16x32_bf16 v[152:155], a[64:67], v[92:95], v[152:155]
  v_mfma_f32_16x16x32_bf16 v[164:167], a[68:71], v[88:91], v[164:167]
  v_mfma_f32_16x16x32_bf16 v[160:163], a[68:71], v[92:95], v[160:163]
  v_mfma_f32_16x16x32_bf16 v[172:175], a[72:75], v[88:91], v[172:175]
  v_mfma_f32_16x16x32_bf16 v[168:171], a[72:75], v[92:95], v[168:171]
  v_mfma_f32_16x16x32_bf16 v[180:183], a[76:79], v[88:91], v[180:183]
  v_mfma_f32_16x16x32_bf16 v[176:179], a[76:79], v[92:95], v[176:179]
  s_waitcnt vmcnt(31)
  v_swap_b32 v130, v132
  v_swap_b32 v131, v133
  v_swap_b32 v34, v36
  v_swap_b32 v35, v37
  v_swap_b32 v42, v44
  v_swap_b32 v43, v45
  s_nop 1
  v_mfma_f32_16x16x32_bf16 v[144:147], v[32:35], v[128:131], v[144:147]
  v_mfma_f32_16x16x32_bf16 v[148:151], v[32:35], v[132:135], v[148:151]
  v_mfma_f32_16x16x32_bf16 v[152:155], v[36:39], v[128:131], v[152:155]
  v_mfma_f32_16x16x32_bf16 v[156:159], v[36:39], v[132:135], v[156:159]
  v_mfma_f32_16x16x32_bf16 v[160:163], v[184:187], v[128:131], v[160:163]
  v_mfma_f32_16x16x32_bf16 v[164:167], v[184:187], v[132:135], v[164:167]
  v_mfma_f32_16x16x32_bf16 v[168:171], v[40:43], v[128:131], v[168:171]
  v_mfma_f32_16x16x32_bf16 v[172:175], v[40:43], v[132:135], v[172:175]
  v_mfma_f32_16x16x32_bf16 v[176:179], v[44:47], v[128:131], v[176:179]
  v_mfma_f32_16x16x32_bf16 v[180:183], v[44:47], v[132:135], v[180:183]
  s_waitcnt vmcnt(29)
  v_mfma_f32_16x16x32_bf16 v[148:151], a[80:83], v[96:99], v[148:151]
  v_mfma_f32_16x16x32_bf16 v[144:147], a[80:83], v[100:103], v[144:147]
  v_mfma_f32_16x16x32_bf16 v[156:159], a[84:87], v[96:99], v[156:159]
  v_mfma_f32_16x16x32_bf16 v[152:155], a[84:87], v[100:103], v[152:155]
  v_mfma_f32_16x16x32_bf16 v[164:167], a[88:91], v[96:99], v[164:167]
  v_mfma_f32_16x16x32_bf16 v[160:163], a[88:91], v[100:103], v[160:163]
  v_mfma_f32_16x16x32_bf16 v[172:175], a[92:95], v[96:99], v[172:175]
  v_mfma_f32_16x16x32_bf16 v[168:171], a[92:95], v[100:103], v[168:171]
  v_mfma_f32_16x16x32_bf16 v[180:183], a[96:99], v[96:99], v[180:183]
  v_mfma_f32_16x16x32_bf16 v[176:179], a[96:99], v[100:103], v[176:179]
  s_waitcnt vmcnt(26)
  v_mfma_f32_16x16x32_bf16 v[148:151], a[100:103], v[104:107], v[148:151]
  v_mfma_f32_16x16x32_bf16 v[144:147], a[100:103], v[108:111], v[144:147]
  v_mfma_f32_16x16x32_bf16 v[156:159], a[104:107], v[104:107], v[156:159]
  v_mfma_f32_16x16x32_bf16 v[152:155], a[104:107], v[108:111], v[152:155]
  v_mfma_f32_16x16x32_bf16 v[164:167], a[108:111], v[104:107], v[164:167]
  v_mfma_f32_16x16x32_bf16 v[160:163], a[108:111], v[108:111], v[160:163]
  v_mfma_f32_16x16x32_bf16 v[172:175], a[112:115], v[104:107], v[172:175]
  v_mfma_f32_16x16x32_bf16 v[168:171], a[112:115], v[108:111], v[168:171]
  v_mfma_f32_16x16x32_bf16 v[180:183], a[116:119], v[104:107], v[180:183]
  v_mfma_f32_16x16x32_bf16 v[176:179], a[116:119], v[108:111], v[176:179]
  s_waitcnt vmcnt(24)
  v_mfma_f32_16x16x32_bf16 v[148:151], a[120:123], v[112:115], v[148:151]
  v_mfma_f32_16x16x32_bf16 v[144:147], a[120:123], v[116:119], v[144:147]
  v_mfma_f32_16x16x32_bf16 v[156:159], a[124:127], v[112:115], v[156:159]
  v_mfma_f32_16x16x32_bf16 v[152:155], a[124:127], v[116:119], v[152:155]
  v_mfma_f32_16x16x32_bf16 v[164:167], a[128:131], v[112:115], v[164:167]
  v_mfma_f32_16x16x32_bf16 v[160:163], a[128:131], v[116:119], v[160:163]
  v_mfma_f32_16x16x32_bf16 v[172:175], a[132:135], v[112:115], v[172:175]
  v_mfma_f32_16x16x32_bf16 v[168:171], a[132:135], v[116:119], v[168:171]
  v_mfma_f32_16x16x32_bf16 v[180:183], a[136:139], v[112:115], v[180:183]
  v_mfma_f32_16x16x32_bf16 v[176:179], a[136:139], v[116:119], v[176:179]
  s_waitcnt vmcnt(21)
  v_mfma_f32_16x16x32_bf16 v[148:151], a[140:143], v[120:123], v[148:151]
  v_mfma_f32_16x16x32_bf16 v[144:147], a[140:143], v[124:127], v[144:147]
  v_mfma_f32_16x16x32_bf16 v[156:159], a[144:147], v[120:123], v[156:159]
  v_mfma_f32_16x16x32_bf16 v[152:155], a[144:147], v[124:127], v[152:155]
  v_mfma_f32_16x16x32_bf16 v[164:167], a[148:151], v[120:123], v[164:167]
  v_mfma_f32_16x16x32_bf16 v[160:163], a[148:151], v[124:127], v[160:163]
  v_mfma_f32_16x16x32_bf16 v[172:175], a[152:155], v[120:123], v[172:175]
  v_mfma_f32_16x16x32_bf16 v[168:171], a[152:155], v[124:127], v[168:171]
  v_mfma_f32_16x16x32_bf16 v[180:183], a[156:159], v[120:123], v[180:183]
  v_mfma_f32_16x16x32_bf16 v[176:179], a[156:159], v[124:127], v[176:179]
  s_waitcnt vmcnt(15)
  v_swap_b32 v138, v140
  v_swap_b32 v139, v141
  v_swap_b32 v50, v52
  v_swap_b32 v51, v53
  v_swap_b32 v58, v60
  v_swap_b32 v59, v61
  s_nop 1
  v_mfma_f32_16x16x32_bf16 v[144:147], v[48:51], v[136:139], v[144:147]
  v_mfma_f32_16x16x32_bf16 v[148:151], v[48:51], v[140:143], v[148:151]
  v_mfma_f32_16x16x32_bf16 v[152:155], v[52:55], v[136:139], v[152:155]
  v_mfma_f32_16x16x32_bf16 v[156:159], v[52:55], v[140:143], v[156:159]
  v_mfma_f32_16x16x32_bf16 v[160:163], v[188:191], v[136:139], v[160:163]
  v_mfma_f32_16x16x32_bf16 v[164:167], v[188:191], v[140:143], v[164:167]
  v_mfma_f32_16x16x32_bf16 v[168:171], v[56:59], v[136:139], v[168:171]
  v_mfma_f32_16x16x32_bf16 v[172:175], v[56:59], v[140:143], v[172:175]
  v_mfma_f32_16x16x32_bf16 v[176:179], v[60:63], v[136:139], v[176:179]
  v_mfma_f32_16x16x32_bf16 v[180:183], v[60:63], v[140:143], v[180:183]
  s_branch pve_304
pvt_310:
  s_min_u32 s21, s40, 62
  v_mov_b32 v19, s21
  v_mov_b32 v18, v17
  s_cmp_lg_u32 s20, 0
  s_cbranch_scc1 wr_314
  s_mov_b32 s101, 0
wr_313:
  buffer_load_dword v26, v18, s[72:75], 0 offen sc1
  s_add_u32 s101, s101, 1
  s_cmp_gt_u32 s101, 131072
  s_cbranch_scc1 main_end
  s_waitcnt vmcnt(0)
  v_cmp_gt_u32 vcc, v19, v26
  v_readfirstlane_b32 s100, v26
  s_nop 0
  s_cbranch_vccz wr_314
  s_sleep 6
  s_cmp_lg_u32 s100, 0
  s_cbranch_scc1 wr_313
  s_sleep 0
  s_branch wr_313
wr_314:
  s_barrier
  s_lshl_b32 s40, s2, 2
  s_add_u32 s40, s40, s58
  s_lshl_b32 s21, s40, 7
  s_add_u32 s21, s21, 8192
  s_xor_b32 s21, s21, s80
  v_mov_b32 v18, s21
  v_cndmask_b32 v18, v17, v18, s[66:67]
  s_add_u32 s21, s40, 1
  v_mov_b32 v19, s21
  v_cndmask_b32 v19, v19, 32, s[66:67]
  buffer_load_dword v27, v18, s[72:75], 0 offen sc1
  s_lshl_b32 s55, s40, 19
  s_lshl_b32 s21, s40, 11
  s_and_b32 s21, s21, 8192
  s_xor_b32 s21, s21, s80
  s_add_u32 s55, s55, s21
  s_add_u32 s55, s55, 136314880
  s_lshl_b32 s21, s20, 15
  s_xor_b32 s54, s55, 8192
  s_add_u32 s54, s54, 48234496
  s_add_u32 s54, s54, s21
  s_lshl_b32 s57, s40, 1
  s_add_u32 s57, s57, s43
  s_lshl_b32 s45, s57, 6
  s_add_u32 s69, s54, 262144
  s_cmp_lt_u32 s2, 16
  s_cselect_b32 s69, s69, 0x40000000
  s_cselect_b32 s64, s87, 0
  s_cmp_gt_u32 s64, 1
  s_cselect_b32 s64, s59, 0x40000000
  v_mov_b32 v29, 1
  buffer_atomic_add v29, v233, s[72:75], s64 offen sc0 sc1
  buffer_load_dword v232, v6, s[28:31], s45 offen sc1
  buffer_load_dwordx4 v[192:195], v4, s[16:19], s69 offen offset:0 sc1
  buffer_load_dwordx4 v[196:199], v4, s[16:19], s69 offen offset:1024 sc1
  buffer_load_dwordx2 v[208:209], v5, s[16:19], s69 offen offset:2048 sc1
  s_add_u32 s69, s69, 2560
  buffer_load_dwordx4 v[200:203], v4, s[16:19], s69 offen offset:0 sc1
  buffer_load_dwordx4 v[204:207], v4, s[16:19], s69 offen offset:1024 sc1
  buffer_load_dwordx2 v[210:211], v5, s[16:19], s69 offen offset:2048 sc1
  s_add_u32 s69, s69, 13824
  buffer_load_dwordx4 v[212:215], v4, s[16:19], s69 offen offset:0 sc1
  buffer_load_dwordx4 v[216:219], v4, s[16:19], s69 offen offset:1024 sc1
  buffer_load_dwordx2 v[228:229], v5, s[16:19], s69 offen offset:2048 sc1
  s_add_u32 s69, s69, 2560
  buffer_load_dwordx4 v[220:223], v4, s[16:19], s69 offen offset:0 sc1
  buffer_load_dwordx4 v[224:227], v4, s[16:19], s69 offen offset:1024 sc1
  buffer_load_dwordx2 v[230:231], v5, s[16:19], s69 offen offset:2048 sc1
  s_add_u32 s69, s69, 13824
  s_mov_b32 s56, s48
  buffer_load_dwordx4 v[32:35], v22, s[16:19], s56 offen offset:0 sc1
  buffer_load_dwordx4 v[40:43], v28, s[16:19], s56 offen offset:0 sc1
  buffer_load_dwordx2 v[184:185], v14, s[16:19], s56 offen offset:512 sc1
  buffer_load_dwordx4 v[36:39], v22, s[16:19], s56 offen offset:1280 sc1
  buffer_load_dwordx4 v[44:47], v28, s[16:19], s56 offen offset:1280 sc1
  buffer_load_dwordx2 v[186:187], v14, s[16:19], s56 offen offset:1792 sc1
  s_add_u32 s56, s56, 262144
  buffer_load_dwordx4 v[48:51], v22, s[16:19], s56 offen offset:0 sc1
  buffer_load_dwordx4 v[56:59], v28, s[16:19], s56 offen offset:0 sc1
  buffer_load_dwordx2 v[188:189], v14, s[16:19], s56 offen offset:512 sc1
  buffer_load_dwordx4 v[52:55], v22, s[16:19], s56 offen offset:1280 sc1
  buffer_load_dwordx4 v[60:63], v28, s[16:19], s56 offen offset:1280 sc1
  buffer_load_dwordx2 v[190:191], v14, s[16:19], s56 offen offset:1792 sc1
  s_add_u32 s56, s56, 262144
  s_mov_b32 s101, 0
  s_branch pvr_316
pvr_315:
  s_sleep 6
  s_mov_b32 s56, s48
  buffer_load_dwordx4 v[32:35], v22, s[16:19], s56 offen offset:0 sc1
  buffer_load_dwordx4 v[40:43], v28, s[16:19], s56 offen offset:0 sc1
  buffer_load_dwordx2 v[184:185], v14, s[16:19], s56 offen offset:512 sc1
  buffer_load_dwordx4 v[36:39], v22, s[16:19], s56 offen offset:1280 sc1
  buffer_load_dwordx4 v[44:47], v28, s[16:19], s56 offen offset:1280 sc1
  buffer_load_dwordx2 v[186:187], v14, s[16:19], s56 offen offset:1792 sc1
  s_add_u32 s56, s56, 262144
  buffer_load_dwordx4 v[48:51], v22, s[16:19], s56 offen offset:0 sc1
  buffer_load_dwordx4 v[56:59], v28, s[16:19], s56 offen offset:0 sc1
  buffer_load_dwordx2 v[188:189], v14, s[16:19], s56 offen offset:512 sc1
  buffer_load_dwordx4 v[52:55], v22, s[16:19], s56 offen offset:1280 sc1
  buffer_load_dwordx4 v[60:63], v28, s[16:19], s56 offen offset:1280 sc1
  buffer_load_dwordx2 v[190:191], v14, s[16:19], s56 offen offset:1792 sc1
  s_add_u32 s56, s56, 262144
  s_add_u32 s101, s101, 1
  s_cmp_gt_u32 s101, 131072
  s_cbranch_scc1 main_end
pvr_316:
  s_waitcnt vmcnt(0)
  v_max3_u32 v26, v32, v36, v40
  v_max3_u32 v26, v26, v44, v184
  v_max3_u32 v26, v26, v186, v48
  v_max3_u32 v26, v26, v52, v56
  v_max3_u32 v26, v26, v60, v188
  v_max3_u32 v26, v26, v190, v190
  v_cmp_eq_u32 vcc, -1, v26
  s_nop 1
  s_cbranch_vccnz pvr_315
  s_add_u32 s56, s47, 0
  buffer_load_dwordx4 v[64:67], v4, s[16:19], s56 offen sc1
  buffer_load_dwordx2 v[68:69], v5, s[16:19], s56 offen offset:2048 sc1
  buffer_load_dwordx4 v[128:131], v21, s[16:19], s56 offen offset:1024 sc1
  s_add_u32 s56, s56, 2560
  buffer_load_dwordx4 v[72:75], v4, s[16:19], s56 offen sc1
  buffer_load_dwordx2 v[76:77], v5, s[16:19], s56 offen offset:2048 sc1
  s_add_u32 s56, s56, 13824
  buffer_load_dwordx4 v[80:83], v4, s[16:19], s56 offen sc1
  buffer_load_dwordx2 v[84:85], v5, s[16:19], s56 offen offset:2048 sc1
  buffer_load_dwordx4 v[132:135], v21, s[16:19], s56 offen offset:1024 sc1
  s_add_u32 s56, s56, 2560
  buffer_load_dwordx4 v[88:91], v4, s[16:19], s56 offen sc1
  buffer_load_dwordx2 v[92:93], v5, s[16:19], s56 offen offset:2048 sc1
  s_add_u32 s56, s56, 13824
  s_mov_b32 s101, 0
  s_branch pvr_318
pvr_317:
  s_sleep 2
  s_add_u32 s56, s47, 0
  buffer_load_dwordx4 v[64:67], v4, s[16:19], s56 offen sc1
  buffer_load_dwordx2 v[68:69], v5, s[16:19], s56 offen offset:2048 sc1
  buffer_load_dwordx4 v[128:131], v21, s[16:19], s56 offen offset:1024 sc1
  s_add_u32 s56, s56, 2560
  buffer_load_dwordx4 v[72:75], v4, s[16:19], s56 offen sc1
  buffer_load_dwordx2 v[76:77], v5, s[16:19], s56 offen offset:2048 sc1
  s_add_u32 s56, s56, 13824
  buffer_load_dwordx4 v[80:83], v4, s[16:19], s56 offen sc1
  buffer_load_dwordx2 v[84:85], v5, s[16:19], s56 offen offset:2048 sc1
  buffer_load_dwordx4 v[132:135], v21, s[16:19], s56 offen offset:1024 sc1
  s_add_u32 s56, s56, 2560
  buffer_load_dwordx4 v[88:91], v4, s[16:19], s56 offen sc1
  buffer_load_dwordx2 v[92:93], v5, s[16:19], s56 offen offset:2048 sc1
  s_add_u32 s56, s56, 13824
  s_add_u32 s101, s101, 1
  s_cmp_gt_u32 s101, 131072
  s_cbranch_scc1 main_end
pvr_318:
  s_waitcnt vmcnt(0)
  v_max3_u32 v26, v64, v68, v72
  v_max3_u32 v26, v26, v76, v80
  v_max3_u32 v26, v26, v84, v88
  v_max3_u32 v26, v26, v92, v128
  v_max3_u32 v26, v26, v132, v132
  v_cmp_eq_u32 vcc, -1, v26
  s_nop 1
  s_cbranch_vccnz pvr_317
  s_add_u32 s56, s47, 32768
  buffer_load_dwordx4 v[96:99], v4, s[16:19], s56 offen sc1
  buffer_load_dwordx2 v[100:101], v5, s[16:19], s56 offen offset:2048 sc1
  buffer_load_dwordx4 v[136:139], v21, s[16:19], s56 offen offset:1024 sc1
  s_add_u32 s56, s56, 2560
  buffer_load_dwordx4 v[104:107], v4, s[16:19], s56 offen sc1
  buffer_load_dwordx2 v[108:109], v5, s[16:19], s56 offen offset:2048 sc1
  s_add_u32 s56, s56, 13824
  buffer_load_dwordx4 v[112:115], v4, s[16:19], s56 offen sc1
  buffer_load_dwordx2 v[116:117], v5, s[16:19], s56 offen offset:2048 sc1
  buffer_load_dwordx4 v[140:143], v21, s[16:19], s56 offen offset:1024 sc1
  s_add_u32 s56, s56, 2560
  buffer_load_dwordx4 v[120:123], v4, s[16:19], s56 offen sc1
  buffer_load_dwordx2 v[124:125], v5, s[16:19], s56 offen offset:2048 sc1
  s_add_u32 s56, s56, 13824
  v_mfma_f32_16x16x32_bf16 v[148:151], a[0:3], v[64:67], 0
  v_mfma_f32_16x16x32_bf16 v[144:147], a[0:3], v[68:71], 0
  v_mfma_f32_16x16x32_bf16 v[156:159], a[4:7], v[64:67], 0
  v_mfma_f32_16x16x32_bf16 v[152:155], a[4:7], v[68:71], 0
  v_mfma_f32_16x16x32_bf16 v[164:167], a[8:11], v[64:67], 0
  v_mfma_f32_16x16x32_bf16 v[160:163], a[8:11], v[68:71], 0
  v_mfma_f32_16x16x32_bf16 v[172:175], a[12:15], v[64:67], 0
  v_mfma_f32_16x16x32_bf16 v[168:171], a[12:15], v[68:71], 0
  v_mfma_f32_16x16x32_bf16 v[180:183], a[16:19], v[64:67], 0
  v_mfma_f32_16x16x32_bf16 v[176:179], a[16:19], v[68:71], 0
  v_mfma_f32_16x16x32_bf16 v[148:151], a[20:23], v[72:75], v[148:151]
  v_mfma_f32_16x16x32_bf16 v[144:147], a[20:23], v[76:79], v[144:147]
  v_mfma_f32_16x16x32_bf16 v[156:159], a[24:27], v[72:75], v[156:159]
  v_mfma_f32_16x16x32_bf16 v[152:155], a[24:27], v[76:79], v[152:155]
  v_mfma_f32_16x16x32_bf16 v[164:167], a[28:31], v[72:75], v[164:167]
  v_mfma_f32_16x16x32_bf16 v[160:163], a[28:31], v[76:79], v[160:163]
  v_mfma_f32_16x16x32_bf16 v[172:175], a[32:35], v[72:75], v[172:175]
  v_mfma_f32_16x16x32_bf16 v[168:171], a[32:35], v[76:79], v[168:171]
  v_mfma_f32_16x16x32_bf16 v[180:183], a[36:39], v[72:75], v[180:183]
  v_mfma_f32_16x16x32_bf16 v[176:179], a[36:39], v[76:79], v[176:179]
  v_mfma_f32_16x16x32_bf16 v[148:151], a[40:43], v[80:83], v[148:151]
  v_mfma_f32_16x16x32_bf16 v[144:147], a[40:43], v[84:87], v[144:147]
  v_mfma_f32_16x16x32_bf16 v[156:159], a[44:47], v[80:83], v[156:159]
  v_mfma_f32_16x16x32_bf16 v[152:155], a[44:47], v[84:87], v[152:155]
  v_mfma_f32_16x16x32_bf16 v[164:167], a[48:51], v[80:83], v[164:167]
  v_mfma_f32_16x16x32_bf16 v[160:163], a[48:51], v[84:87], v[160:163]
  v_mfma_f32_16x16x32_bf16 v[172:175], a[52:55], v[80:83], v[172:175]
  v_mfma_f32_16x16x32_bf16 v[168:171], a[52:55], v[84:87], v[168:171]
  v_mfma_f32_16x16x32_bf16 v[180:183], a[56:59], v[80:83], v[180:183]
  v_mfma_f32_16x16x32_bf16 v[176:179], a[56:59], v[84:87], v[176:179]
  v_mfma_f32_16x16x32_bf16 v[148:151], a[60:63], v[88:91], v[148:151]
  v_mfma_f32_16x16x32_bf16 v[144:147], a[60:63], v[92:95], v[144:147]
  v_mfma_f32_16x16x32_bf16 v[156:159], a[64:67], v[88:91], v[156:159]
  v_mfma_f32_16x16x32_bf16 v[152:155], a[64:67], v[92:95], v[152:155]
  v_mfma_f32_16x16x32_bf16 v[164:167], a[68:71], v[88:91], v[164:167]
  v_mfma_f32_16x16x32_bf16 v[160:163], a[68:71], v[92:95], v[160:163]
  v_mfma_f32_16x16x32_bf16 v[172:175], a[72:75], v[88:91], v[172:175]
  v_mfma_f32_16x16x32_bf16 v[168:171], a[72:75], v[92:95], v[168:171]
  v_mfma_f32_16x16x32_bf16 v[180:183], a[76:79], v[88:91], v[180:183]
  v_mfma_f32_16x16x32_bf16 v[176:179], a[76:79], v[92:95], v[176:179]
  v_swap_b32 v130, v132
  v_swap_b32 v131, v133
  v_swap_b32 v34, v36
  v_swap_b32 v35, v37
  v_swap_b32 v42, v44
  v_swap_b32 v43, v45
  s_nop 1
  v_mfma_f32_16x16x32_bf16 v[144:147], v[32:35], v[128:131], v[144:147]
  v_mfma_f32_16x16x32_bf16 v[148:151], v[32:35], v[132:135], v[148:151]
  v_mfma_f32_16x16x32_bf16 v[152:155], v[36:39], v[128:131], v[152:155]
  v_mfma_f32_16x16x32_bf16 v[156:159], v[36:39], v[132:135], v[156:159]
  v_mfma_f32_16x16x32_bf16 v[160:163], v[184:187], v[128:131], v[160:163]
  v_mfma_f32_16x16x32_bf16 v[164:167], v[184:187], v[132:135], v[164:167]
  v_mfma_f32_16x16x32_bf16 v[168:171], v[40:43], v[128:131], v[168:171]
  v_mfma_f32_16x16x32_bf16 v[172:175], v[40:43], v[132:135], v[172:175]
  v_mfma_f32_16x16x32_bf16 v[176:179], v[44:47], v[128:131], v[176:179]
  v_mfma_f32_16x16x32_bf16 v[180:183], v[44:47], v[132:135], v[180:183]
  s_mov_b32 s101, 0
  s_branch pvr_320
pvr_319:
  s_sleep 1
  s_add_u32 s56, s47, 32768
  buffer_load_dwordx4 v[96:99], v4, s[16:19], s56 offen sc1
  buffer_load_dwordx2 v[100:101], v5, s[16:19], s56 offen offset:2048 sc1
  buffer_load_dwordx4 v[136:139], v21, s[16:19], s56 offen offset:1024 sc1
  s_add_u32 s56, s56, 2560
  buffer_load_dwordx4 v[104:107], v4, s[16:19], s56 offen sc1
  buffer_load_dwordx2 v[108:109], v5, s[16:19], s56 offen offset:2048 sc1
  s_add_u32 s56, s56, 13824
  buffer_load_dwordx4 v[112:115], v4, s[16:19], s56 offen sc1
  buffer_load_dwordx2 v[116:117], v5, s[16:19], s56 offen offset:2048 sc1
  buffer_load_dwordx4 v[140:143], v21, s[16:19], s56 offen offset:1024 sc1
  s_add_u32 s56, s56, 2560
  buffer_load_dwordx4 v[120:123], v4, s[16:19], s56 offen sc1
  buffer_load_dwordx2 v[124:125], v5, s[16:19], s56 offen offset:2048 sc1
  s_add_u32 s56, s56, 13824
  s_add_u32 s101, s101, 1
  s_cmp_gt_u32 s101, 131072
  s_cbranch_scc1 main_end
pvr_320:
  s_waitcnt vmcnt(0)
  v_max3_u32 v26, v96, v100, v104
  v_max3_u32 v26, v26, v108, v112
  v_max3_u32 v26, v26, v116, v120
  v_max3_u32 v26, v26, v124, v136
  v_max3_u32 v26, v26, v140, v140
  v_cmp_eq_u32 vcc, -1, v26
  s_nop 1
  s_cbranch_vccnz pvr_319
  v_mfma_f32_16x16x32_bf16 v[148:151], a[80:83], v[96:99], v[148:151]
  v_mfma_f32_16x16x32_bf16 v[144:147], a[80:83], v[100:103], v[144:147]
  v_mfma_f32_16x16x32_bf16 v[156:159], a[84:87], v[96:99], v[156:159]
  v_mfma_f32_16x16x32_bf16 v[152:155], a[84:87], v[100:103], v[152:155]
  v_mfma_f32_16x16x32_bf16 v[164:167], a[88:91], v[96:99], v[164:167]
  v_mfma_f32_16x16x32_bf16 v[160:163], a[88:91], v[100:103], v[160:163]
  v_mfma_f32_16x16x32_bf16 v[172:175], a[92:95], v[96:99], v[172:175]
  v_mfma_f32_16x16x32_bf16 v[168:171], a[92:95], v[100:103], v[168:171]
  v_mfma_f32_16x16x32_bf16 v[180:183], a[96:99], v[96:99], v[180:183]
  v_mfma_f32_16x16x32_bf16 v[176:179], a[96:99], v[100:103], v[176:179]
  v_mfma_f32_16x16x32_bf16 v[148:151], a[100:103], v[104:107], v[148:151]
  v_mfma_f32_16x16x32_bf16 v[144:147], a[100:103], v[108:111], v[144:147]
  v_mfma_f32_16x16x32_bf16 v[156:159], a[104:107], v[104:107], v[156:159]
  v_mfma_f32_16x16x32_bf16 v[152:155], a[104:107], v[108:111], v[152:155]
  v_mfma_f32_16x16x32_bf16 v[164:167], a[108:111], v[104:107], v[164:167]
  v_mfma_f32_16x16x32_bf16 v[160:163], a[108:111], v[108:111], v[160:163]
  v_mfma_f32_16x16x32_bf16 v[172:175], a[112:115], v[104:107], v[172:175]
  v_mfma_f32_16x16x32_bf16 v[168:171], a[112:115], v[108:111], v[168:171]
  v_mfma_f32_16x16x32_bf16 v[180:183], a[116:119], v[104:107], v[180:183]
  v_mfma_f32_16x16x32_bf16 v[176:179], a[116:119], v[108:111], v[176:179]
  v_mfma_f32_16x16x32_bf16 v[148:151], a[120:123], v[112:115], v[148:151]
  v_mfma_f32_16x16x32_bf16 v[144:147], a[120:123], v[116:119], v[144:147]
  v_mfma_f32_16x16x32_bf16 v[156:159], a[124:127], v[112:115], v[156:159]
  v_mfma_f32_16x16x32_bf16 v[152:155], a[124:127], v[116:119], v[152:155]
  v_mfma_f32_16x16x32_bf16 v[164:167], a[128:131], v[112:115], v[164:167]
  v_mfma_f32_16x16x32_bf16 v[160:163], a[128:131], v[116:119], v[160:163]
  v_mfma_f32_16x16x32_bf16 v[172:175], a[132:135], v[112:115], v[172:175]
  v_mfma_f32_16x16x32_bf16 v[168:171], a[132:135], v[116:119], v[168:171]
  v_mfma_f32_16x16x32_bf16 v[180:183], a[136:139], v[112:115], v[180:183]
  v_mfma_f32_16x16x32_bf16 v[176:179], a[136:139], v[116:119], v[176:179]
  v_mfma_f32_16x16x32_bf16 v[148:151], a[140:143], v[120:123], v[148:151]
  v_mfma_f32_16x16x32_bf16 v[144:147], a[140:143], v[124:127], v[144:147]
  v_mfma_f32_16x16x32_bf16 v[156:159], a[144:147], v[120:123], v[156:159]
  v_mfma_f32_16x16x32_bf16 v[152:155], a[144:147], v[124:127], v[152:155]
  v_mfma_f32_16x16x32_bf16 v[164:167], a[148:151], v[120:123], v[164:167]
  v_mfma_f32_16x16x32_bf16 v[160:163], a[148:151], v[124:127], v[160:163]
  v_mfma_f32_16x16x32_bf16 v[172:175], a[152:155], v[120:123], v[172:175]
  v_mfma_f32_16x16x32_bf16 v[168:171], a[152:155], v[124:127], v[168:171]
  v_mfma_f32_16x16x32_bf16 v[180:183], a[156:159], v[120:123], v[180:183]
  v_mfma_f32_16x16x32_bf16 v[176:179], a[156:159], v[124:127], v[176:179]
  v_swap_b32 v138, v140
  v_swap_b32 v139, v141
  v_swap_b32 v50, v52
  v_swap_b32 v51, v53
  v_swap_b32 v58, v60
  v_swap_b32 v59, v61
  s_nop 1
  v_mfma_f32_16x16x32_bf16 v[144:147], v[48:51], v[136:139], v[144:147]
  v_mfma_f32_16x16x32_bf16 v[148:151], v[48:51], v[140:143], v[148:151]
  v_mfma_f32_16x16x32_bf16 v[152:155], v[52:55], v[136:139], v[152:155]
  v_mfma_f32_16x16x32_bf16 v[156:159], v[52:55], v[140:143], v[156:159]
  v_mfma_f32_16x16x32_bf16 v[160:163], v[188:191], v[136:139], v[160:163]
  v_mfma_f32_16x16x32_bf16 v[164:167], v[188:191], v[140:143], v[164:167]
  v_mfma_f32_16x16x32_bf16 v[168:171], v[56:59], v[136:139], v[168:171]
  v_mfma_f32_16x16x32_bf16 v[172:175], v[56:59], v[140:143], v[172:175]
  v_mfma_f32_16x16x32_bf16 v[176:179], v[60:63], v[136:139], v[176:179]
  v_mfma_f32_16x16x32_bf16 v[180:183], v[60:63], v[140:143], v[180:183]
pve_304:
  s_nop 0
  ds_write_b128 v10, v[144:147] offset:0
  ds_write_b128 v10, v[148:151] offset:1024
  ds_write_b128 v10, v[152:155] offset:2048
  ds_write_b128 v10, v[156:159] offset:3072
  ds_write_b128 v10, v[160:163] offset:4096
  ds_write_b128 v10, v[164:167] offset:5120
  ds_write_b128 v10, v[168:171] offset:6144
  ds_write_b128 v10, v[172:175] offset:7168
  s_nop 1
  ds_write_b128 v10, v[176:179] offset:8192
  ds_write_b128 v10, v[180:183] offset:9216
  s_cmp_ge_u32 s2, 16
  s_cbranch_scc1 pv_307
  s_waitcnt vmcnt(14)
  s_add_u32 s23, s40, 1
  s_cmp_ge_u32 s50, s23
  s_cbranch_scc1 pv_321
  s_mov_b32 s101, 0
wm_324:
  buffer_load_dword v8, v31, s[72:75], s51 offen sc1
  s_add_u32 s101, s101, 1
  s_cmp_gt_u32 s101, 131072
  s_cbranch_scc1 main_end
  s_waitcnt vmcnt(0)
  v_cmp_gt_u32 vcc, s23, v8
  v_readfirstlane_b32 s100, v8
  s_nop 0
  s_cbranch_vccz wm_325
  s_sleep 8
  s_add_u32 s100, s100, 2
  s_cmp_ge_u32 s100, s23
  s_cbranch_scc1 wm_324
  s_sleep 60
  s_branch wm_324
wm_325:
  v_readlane_b32 s50, v8, 0
  v_readlane_b32 s21, v8, 1
  s_min_u32 s50, s50, s21
  v_readlane_b32 s21, v8, 2
  s_min_u32 s50, s50, s21
  v_readlane_b32 s21, v8, 3
  s_min_u32 s50, s50, s21
  v_readlane_b32 s21, v8, 4
  s_min_u32 s50, s50, s21
  v_readlane_b32 s21, v8, 5
  s_min_u32 s50, s50, s21
  v_readlane_b32 s21, v8, 6
  s_min_u32 s50, s50, s21
  v_readlane_b32 s21, v8, 7
  s_min_u32 s50, s50, s21
  v_readlane_b32 s21, v8, 8
  s_min_u32 s50, s50, s21
  v_readlane_b32 s21, v8, 9
  s_min_u32 s50, s50, s21
  v_readlane_b32 s21, v8, 10
  s_min_u32 s50, s50, s21
  v_readlane_b32 s21, v8, 11
  s_min_u32 s50, s50, s21
  v_readlane_b32 s21, v8, 12
  s_min_u32 s50, s50, s21
  v_readlane_b32 s21, v8, 13
  s_min_u32 s50, s50, s21
  v_readlane_b32 s21, v8, 14
  s_min_u32 s50, s50, s21
  v_readlane_b32 s21, v8, 15
  s_min_u32 s50, s50, s21
  v_readlane_b32 s21, v8, 16
  s_min_u32 s50, s50, s21
  v_readlane_b32 s21, v8, 17
  s_min_u32 s50, s50, s21
  v_readlane_b32 s21, v8, 18
  s_min_u32 s50, s50, s21
  v_readlane_b32 s21, v8, 19
  s_min_u32 s50, s50, s21
  v_readlane_b32 s21, v8, 20
  s_min_u32 s50, s50, s21
  v_readlane_b32 s21, v8, 21
  s_min_u32 s50, s50, s21
  v_readlane_b32 s21, v8, 22
  s_min_u32 s50, s50, s21
  v_readlane_b32 s21, v8, 23
  s_min_u32 s50, s50, s21
  v_readlane_b32 s21, v8, 24
  s_min_u32 s50, s50, s21
  v_readlane_b32 s21, v8, 25
  s_min_u32 s50, s50, s21
  v_readlane_b32 s21, v8, 26
  s_min_u32 s50, s50, s21
  v_readlane_b32 s21, v8, 27
  s_min_u32 s50, s50, s21
  v_readlane_b32 s21, v8, 28
  s_min_u32 s50, s50, s21
  v_readlane_b32 s21, v8, 29
  s_min_u32 s50, s50, s21
  v_readlane_b32 s21, v8, 30
  s_min_u32 s50, s50, s21
  v_readlane_b32 s21, v8, 31
  s_min_u32 s50, s50, s21
pv_321:
  v_cmp_gt_u32 vcc, v19, v27
  s_lshl_b32 s61, s40, 21
  s_lshl_b32 s21, s40, 13
  s_and_b32 s21, s21, 8192
  s_xor_b32 s21, s21, s80
  s_add_u32 s61, s61, s21
  s_lshl_b32 s21, s20, 15
  s_add_u32 s47, s54, s21
  s_add_u32 s48, s61, s60
  s_xor_b32 s68, s61, 8192
  s_add_u32 s68, s68, s53
  s_add_u32 s70, s55, s42
  s_xor_b32 s70, s70, 0
  s_mov_b32 s62, 0
  s_cbranch_vccnz pv_322
  s_mov_b32 s62, 1
  buffer_load_dwordx4 a[0:3], v4, s[16:19], s68 offen offset:0 sc1
  buffer_load_dwordx4 a[4:7], v4, s[16:19], s68 offen offset:1024 sc1
  buffer_load_dwordx4 v[32:35], v22, s[16:19], s48 offen offset:0 sc1
  buffer_load_dwordx4 a[8:11], v4, s[16:19], s70 offen sc1
  s_add_u32 s70, s70, 16384
  buffer_load_dwordx4 a[12:15], v4, s[16:19], s68 offen offset:2048 sc1
  buffer_load_dwordx4 a[16:19], v4, s[16:19], s68 offen offset:3072 sc1
  s_add_u32 s68, s68, 65536
  buffer_load_dwordx4 v[64:67], v4, s[16:19], s47 offen sc1
  buffer_load_dwordx2 v[68:69], v5, s[16:19], s47 offen offset:2048 sc1
  buffer_load_dwordx4 v[128:131], v21, s[16:19], s47 offen offset:1024 sc1
  s_add_u32 s47, s47, 2560
  buffer_load_dwordx4 a[20:23], v4, s[16:19], s68 offen offset:0 sc1
  buffer_load_dwordx4 a[24:27], v4, s[16:19], s68 offen offset:1024 sc1
  buffer_load_dwordx4 v[40:43], v28, s[16:19], s48 offen offset:0 sc1
  buffer_load_dwordx4 a[28:31], v4, s[16:19], s70 offen sc1
  s_add_u32 s70, s70, 16384
  buffer_load_dwordx4 a[32:35], v4, s[16:19], s68 offen offset:2048 sc1
  buffer_load_dwordx4 a[36:39], v4, s[16:19], s68 offen offset:3072 sc1
  s_add_u32 s68, s68, 65536
  buffer_load_dwordx2 v[184:185], v14, s[16:19], s48 offen offset:512 sc1
  buffer_load_dwordx4 v[72:75], v4, s[16:19], s47 offen sc1
  buffer_load_dwordx2 v[76:77], v5, s[16:19], s47 offen offset:2048 sc1
  s_add_u32 s47, s47, 13824
  buffer_load_dwordx4 a[40:43], v4, s[16:19], s68 offen offset:0 sc1
  buffer_load_dwordx4 a[44:47], v4, s[16:19], s68 offen offset:1024 sc1
  buffer_load_dwordx4 v[36:39], v22, s[16:19], s48 offen offset:1280 sc1
  buffer_load_dwordx4 a[48:51], v4, s[16:19], s70 offen sc1
  s_add_u32 s70, s70, 16384
  buffer_load_dwordx4 a[52:55], v4, s[16:19], s68 offen offset:2048 sc1
  buffer_load_dwordx4 a[56:59], v4, s[16:19], s68 offen offset:3072 sc1
  s_add_u32 s68, s68, 65536
  buffer_load_dwordx4 v[80:83], v4, s[16:19], s47 offen sc1
  buffer_load_dwordx2 v[84:85], v5, s[16:19], s47 offen offset:2048 sc1
  buffer_load_dwordx4 v[132:135], v21, s[16:19], s47 offen offset:1024 sc1
  s_add_u32 s47, s47, 2560
  buffer_load_dwordx4 a[60:63], v4, s[16:19], s68 offen offset:0 sc1
  buffer_load_dwordx4 a[64:67], v4, s[16:19], s68 offen offset:1024 sc1
  buffer_load_dwordx4 v[44:47], v28, s[16:19], s48 offen offset:1280 sc1
  buffer_load_dwordx4 a[68:71], v4, s[16:19], s70 offen sc1
  s_add_u32 s70, s70, 16384
  buffer_load_dwordx4 a[72:75], v4, s[16:19], s68 offen offset:2048 sc1
  buffer_load_dwordx4 a[76:79], v4, s[16:19], s68 offen offset:3072 sc1
  s_add_u32 s68, s68, 65536
  buffer_load_dwordx2 v[186:187], v14, s[16:19], s48 offen offset:1792 sc1
  s_add_u32 s48, s48, 262144
  buffer_load_dwordx4 v[88:91], v4, s[16:19], s47 offen sc1
  buffer_load_dwordx2 v[92:93], v5, s[16:19], s47 offen offset:2048 sc1
  s_add_u32 s47, s47, 13824
  s_branch pv_323
pv_322:
  buffer_load_dwordx4 a[0:3], v4, s[16:19], s68 offen offset:0 sc1
  buffer_load_dwordx4 a[4:7], v4, s[16:19], s68 offen offset:1024 sc1
  buffer_load_dwordx4 a[8:11], v4, s[16:19], s70 offen sc1
  s_add_u32 s70, s70, 16384
  buffer_load_dwordx4 a[12:15], v4, s[16:19], s68 offen offset:2048 sc1
  buffer_load_dwordx4 a[16:19], v4, s[16:19], s68 offen offset:3072 sc1
  s_add_u32 s68, s68, 65536
  buffer_load_dwordx4 a[20:23], v4, s[16:19], s68 offen offset:0 sc1
  buffer_load_dwordx4 a[24:27], v4, s[16:19], s68 offen offset:1024 sc1
  buffer_load_dwordx4 a[28:31], v4, s[16:19], s70 offen sc1
  s_add_u32 s70, s70, 16384
  buffer_load_dwordx4 a[32:35], v4, s[16:19], s68 offen offset:2048 sc1
  buffer_load_dwordx4 a[36:39], v4, s[16:19], s68 offen offset:3072 sc1
  s_add_u32 s68, s68, 65536
  buffer_load_dwordx4 a[40:43], v4, s[16:19], s68 offen offset:0 sc1
  buffer_load_dwordx4 a[44:47], v4, s[16:19], s68 offen offset:1024 sc1
  buffer_load_dwordx4 a[48:51], v4, s[16:19], s70 offen sc1
  s_add_u32 s70, s70, 16384
  buffer_load_dwordx4 a[52:55], v4, s[16:19], s68 offen offset:2048 sc1
  buffer_load_dwordx4 a[56:59], v4, s[16:19], s68 offen offset:3072 sc1
  s_add_u32 s68, s68, 65536
  buffer_load_dwordx4 a[60:63], v4, s[16:19], s68 offen offset:0 sc1
  buffer_load_dwordx4 a[64:67], v4, s[16:19], s68 offen offset:1024 sc1
  buffer_load_dwordx4 a[68:71], v4, s[16:19], s70 offen sc1
  s_add_u32 s70, s70, 16384
  buffer_load_dwordx4 a[72:75], v4, s[16:19], s68 offen offset:2048 sc1
  buffer_load_dwordx4 a[76:79], v4, s[16:19], s68 offen offset:3072 sc1
  s_add_u32 s68, s68, 65536
  buffer_load_dwordx4 a[80:83], v4, s[16:19], s68 offen offset:0 sc1
  buffer_load_dwordx4 a[84:87], v4, s[16:19], s68 offen offset:1024 sc1
  buffer_load_dwordx4 a[88:91], v4, s[16:19], s70 offen sc1
  s_add_u32 s70, s70, 16384
  buffer_load_dwordx4 a[92:95], v4, s[16:19], s68 offen offset:2048 sc1
  buffer_load_dwordx4 a[96:99], v4, s[16:19], s68 offen offset:3072 sc1
  s_add_u32 s68, s68, 65536
  buffer_load_dwordx4 a[100:103], v4, s[16:19], s68 offen offset:0 sc1
  buffer_load_dwordx4 a[104:107], v4, s[16:19], s68 offen offset:1024 sc1
  buffer_load_dwordx4 a[108:111], v4, s[16:19], s70 offen sc1
  s_add_u32 s70, s70, 16384
  buffer_load_dwordx4 a[112:115], v4, s[16:19], s68 offen offset:2048 sc1
  buffer_load_dwordx4 a[116:119], v4, s[16:19], s68 offen offset:3072 sc1
  s_add_u32 s68, s68, 65536
  buffer_load_dwordx4 a[120:123], v4, s[16:19], s68 offen offset:0 sc1
  buffer_load_dwordx4 a[124:127], v4, s[16:19], s68 offen offset:1024 sc1
  buffer_load_dwordx4 a[128:131], v4, s[16:19], s70 offen sc1
  s_add_u32 s70, s70, 16384
  buffer_load_dwordx4 a[132:135], v4, s[16:19], s68 offen offset:2048 sc1
  buffer_load_dwordx4 a[136:139], v4, s[16:19], s68 offen offset:3072 sc1
  s_add_u32 s68, s68, 65536
  buffer_load_dwordx4 a[140:143], v4, s[16:19], s68 offen offset:0 sc1
  buffer_load_dwordx4 a[144:147], v4, s[16:19], s68 offen offset:1024 sc1
  buffer_load_dwordx4 a[148:151], v4, s[16:19], s70 offen sc1
  s_add_u32 s70, s70, 16384
  buffer_load_dwordx4 a[152:155], v4, s[16:19], s68 offen offset:2048 sc1
  buffer_load_dwordx4 a[156:159], v4, s[16:19], s68 offen offset:3072 sc1
  s_add_u32 s68, s68, 65536
pv_323:
pv_307:
  s_waitcnt lgkmcnt(0)
  s_barrier
  ds_read_b128 v[144:147], v11 offset:0
  ds_read_b128 v[148:151], v11 offset:10240
  ds_read_b128 v[152:155], v11 offset:20480
  ds_read_b128 v[156:159], v11 offset:30720
  ds_read_b128 v[160:163], v11 offset:2048
  ds_read_b128 v[164:167], v11 offset:12288
  ds_read_b128 v[168:171], v11 offset:22528
  ds_read_b128 v[172:175], v11 offset:32768
  s_waitcnt lgkmcnt(4)
  v_pk_add_f32 v[144:145], v[144:145], v[148:149]
  v_pk_add_f32 v[152:153], v[152:153], v[156:157]
  v_pk_add_f32 v[146:147], v[146:147], v[150:151]
  v_pk_add_f32 v[154:155], v[154:155], v[158:159]
  v_pk_add_f32 v[176:177], v[144:145], v[152:153]
  v_pk_add_f32 v[178:179], v[146:147], v[154:155]
  ds_read_b128 v[144:147], v12 offset:0
  ds_read_b128 v[148:151], v12 offset:10240
  ds_read_b128 v[152:155], v12 offset:20480
  ds_read_b128 v[156:159], v12 offset:30720
  v_cvt_pk_bf16_f32 v26, v176, v177
  v_lshlrev_b32 v176, 16, v26
  v_and_b32 v177, 0xffff0000, v26
  v_mul_f32 v176, v176, v24
  v_mul_f32 v177, v177, v24
  v_cvt_pk_bf16_f32 v26, v176, v177
  v_lshlrev_b32 v176, 16, v26
  v_and_b32 v177, 0xffff0000, v26
  v_add_f32 v176, v176, v240
  v_add_f32 v177, v177, v241
  v_cvt_pk_bf16_f32 v236, v176, v177
  v_cvt_pk_bf16_f32 v26, v178, v179
  v_lshlrev_b32 v178, 16, v26
  v_and_b32 v179, 0xffff0000, v26
  v_mul_f32 v178, v178, v24
  v_mul_f32 v179, v179, v24
  v_cvt_pk_bf16_f32 v26, v178, v179
  v_lshlrev_b32 v178, 16, v26
  v_and_b32 v179, 0xffff0000, v26
  v_add_f32 v178, v178, v242
  v_add_f32 v179, v179, v243
  v_cvt_pk_bf16_f32 v237, v178, v179
  s_waitcnt lgkmcnt(4)
  v_pk_add_f32 v[160:161], v[160:161], v[164:165]
  v_pk_add_f32 v[168:169], v[168:169], v[172:173]
  v_pk_add_f32 v[162:163], v[162:163], v[166:167]
  v_pk_add_f32 v[170:171], v[170:171], v[174:175]
  v_pk_add_f32 v[176:177], v[160:161], v[168:169]
  v_pk_add_f32 v[178:179], v[162:163], v[170:171]
  v_cvt_pk_bf16_f32 v26, v176, v177
  v_lshlrev_b32 v176, 16, v26
  v_and_b32 v177, 0xffff0000, v26
  v_mul_f32 v176, v176, v24
  v_mul_f32 v177, v177, v24
  v_cvt_pk_bf16_f32 v26, v176, v177
  v_lshlrev_b32 v176, 16, v26
  v_and_b32 v177, 0xffff0000, v26
  v_add_f32 v176, v176, v244
  v_add_f32 v177, v177, v245
  v_cvt_pk_bf16_f32 v238, v176, v177
  v_cvt_pk_bf16_f32 v26, v178, v179
  v_lshlrev_b32 v178, 16, v26
  v_and_b32 v179, 0xffff0000, v26
  v_mul_f32 v178, v178, v24
  v_mul_f32 v179, v179, v24
  v_cvt_pk_bf16_f32 v26, v178, v179
  v_lshlrev_b32 v178, 16, v26
  v_and_b32 v179, 0xffff0000, v26
  v_add_f32 v178, v178, v246
  v_add_f32 v179, v179, v247
  v_cvt_pk_bf16_f32 v239, v178, v179
  buffer_store_dwordx4 v[236:239], v9, s[8:11], s46 offen
  s_cmp_lt_u32 s20, 2
  s_cselect_b32 s49, s49, 0x40000000
  s_waitcnt lgkmcnt(0)
  v_pk_add_f32 v[144:145], v[144:145], v[148:149]
  v_pk_add_f32 v[152:153], v[152:153], v[156:157]
  v_pk_add_f32 v[146:147], v[146:147], v[150:151]
  v_pk_add_f32 v[154:155], v[154:155], v[158:159]
  v_pk_add_f32 v[176:177], v[144:145], v[152:153]
  v_pk_add_f32 v[178:179], v[146:147], v[154:155]
  v_cvt_pk_bf16_f32 v26, v176, v177
  v_lshlrev_b32 v176, 16, v26
  v_and_b32 v177, 0xffff0000, v26
  v_mul_f32 v176, v176, v24
  v_mul_f32 v177, v177, v24
  v_cvt_pk_bf16_f32 v26, v176, v177
  v_lshlrev_b32 v176, 16, v26
  v_and_b32 v177, 0xffff0000, v26
  v_add_f32 v176, v176, v248
  v_add_f32 v177, v177, v249
  v_cvt_pk_bf16_f32 v234, v176, v177
  v_cvt_pk_bf16_f32 v26, v178, v179
  v_lshlrev_b32 v178, 16, v26
  v_and_b32 v179, 0xffff0000, v26
  v_mul_f32 v178, v178, v24
  v_mul_f32 v179, v179, v24
  v_cvt_pk_bf16_f32 v26, v178, v179
  v_lshlrev_b32 v178, 16, v26
  v_and_b32 v179, 0xffff0000, v26
  v_add_f32 v178, v178, v250
  v_add_f32 v179, v179, v251
  v_cvt_pk_bf16_f32 v235, v178, v179
  buffer_store_dwordx2 v[234:235], v13, s[8:11], s49 offen offset:64
  s_cmp_lt_u32 s2, 16
  s_cbranch_scc1 pv_loop
pv_done:
main_fin:
  s_waitcnt vmcnt(0)
main_end:
  s_endpgm
.section .rodata,"a"
.p2align 6
.amdhsa_kernel gated_mix__memory_aug_recurrent_mem_tr__sliding_local_dilated__prompt_kernel
  .amdhsa_next_free_vgpr 512
  .amdhsa_next_free_sgpr 102
  .amdhsa_accum_offset 256
  .amdhsa_group_segment_fixed_size 0
  .amdhsa_kernarg_size 112
  .amdhsa_user_sgpr_count 2
  .amdhsa_user_sgpr_kernarg_segment_ptr 1
  .amdhsa_system_sgpr_workgroup_id_x 1
.end_amdhsa_kernel
.text
```

```asm
; @launch kernel=gated_mix__memory_aug_recurrent_mem_tr__sliding_local_dilated__prompt_kernel grid=(256,1,1) block=(256,1,1) lds=163840
.amdgcn_target "amdgcn-amd-amdhsa--gfx950"
.text
.globl gated_mix__memory_aug_recurrent_mem_tr__sliding_local_dilated__prompt_kernel
.p2align 8
.type gated_mix__memory_aug_recurrent_mem_tr__sliding_local_dilated__prompt_kernel,@function
gated_mix__memory_aug_recurrent_mem_tr__sliding_local_dilated__prompt_kernel:
  s_cmp_ge_u32 s2, 256
  s_cbranch_scc1 end0
  s_load_dwordx2 s[4:5], s[0:1], 96
  s_load_dwordx2 s[38:39], s[0:1], 104
  s_load_dwordx2 s[64:65], s[0:1], 0
  v_lshrrev_b32 v1, 6, v0
  v_and_b32 v2, 15, v0
  v_readfirstlane_b32 s20, v1
  v_and_b32 v1, 63, v0
  v_lshrrev_b32 v3, 4, v1
  s_getreg_b32 s50, hwreg(HW_REG_XCC_ID)
  s_and_b32 s50, s50, 7
  s_waitcnt lgkmcnt(0)
  s_mov_b32 s32, s4
  s_mov_b32 s33, s5
  s_mov_b32 s34, 256
  s_mov_b32 s35, 0x00020000
  v_mov_b32 v21, 0
  s_cmp_lg_u32 s20, 0
  s_cbranch_scc1 rk_1
  s_and_b32 s21, s50, 1
  s_lshl_b32 s21, s21, 7
  s_lshl_b32 s22, s50, 1
  s_and_b32 s22, s22, 12
  s_add_u32 s21, s21, s22
  v_mov_b32 v22, s21
  v_mov_b32 v23, 1
  s_mov_b64 exec, 1
  buffer_atomic_add v23, v22, s[32:35], 0 offen sc0 sc1
  s_waitcnt vmcnt(0)
  v_readfirstlane_b32 s51, v23
  s_lshl_b32 s22, s50, 5
  s_add_u32 s22, s22, s51
  s_cmp_lt_u32 s51, 32
  s_cbranch_scc1 rk_2
  v_mov_b32 v24, 72
  v_mov_b32 v25, 1
  buffer_atomic_add v25, v24, s[32:35], 0 offen sc0 sc1
  s_waitcnt vmcnt(0)
  v_readfirstlane_b32 s23, v25
  s_mov_b32 s101, 0
  s_mov_b64 exec, -1
  v_lshlrev_b32 v24, 2, v1
rk_3:
  s_sleep 8
  buffer_load_dword v25, v24, s[32:35], 0 offen sc1
  s_add_u32 s101, s101, 1
  s_cmp_gt_u32 s101, 131072
  s_cbranch_scc1 end0
  s_waitcnt vmcnt(0)
  v_readlane_b32 s21, v25, 0
  v_readlane_b32 s22, v25, 32
  s_add_u32 s21, s21, s22
  v_readlane_b32 s22, v25, 1
  s_add_u32 s21, s21, s22
  v_readlane_b32 s22, v25, 33
  s_add_u32 s21, s21, s22
  v_readlane_b32 s22, v25, 2
  s_add_u32 s21, s21, s22
  v_readlane_b32 s22, v25, 34
  s_add_u32 s21, s21, s22
  v_readlane_b32 s22, v25, 3
  s_add_u32 s21, s21, s22
  v_readlane_b32 s22, v25, 35
  s_add_u32 s21, s21, s22
  s_cmp_lt_u32 s21, 256
  s_cbranch_scc1 rk_3
  s_mov_b64 exec, 1
  s_mov_b32 s24, 0
rk_5:
  s_and_b32 s21, s24, 1
  s_lshl_b32 s21, s21, 5
  s_lshr_b32 s22, s24, 1
  s_add_u32 s21, s21, s22
  v_readlane_b32 s21, v25, s21
  s_min_u32 s21, s21, 32
  s_sub_u32 s25, 32, s21
  s_cmp_lt_u32 s23, s25
  s_cbranch_scc1 rk_4
  s_sub_u32 s23, s23, s25
  s_add_u32 s24, s24, 1
  s_cmp_lt_u32 s24, 8
  s_cbranch_scc1 rk_5
  s_branch end0
rk_4:
  s_lshl_b32 s22, s24, 5
  s_add_u32 s22, s22, s21
  s_add_u32 s22, s22, s23
  s_or_b32 s22, s22, 0x100
rk_2:
  v_mov_b32 v23, s22
  ds_write_b32 v21, v23
  s_waitcnt lgkmcnt(0)
  s_mov_b64 exec, -1
rk_1:
  s_waitcnt vmcnt(0)
  s_barrier
  ds_read_b32 v23, v21
  s_waitcnt lgkmcnt(0)
  v_readfirstlane_b32 s22, v23
  s_barrier
  s_lshr_b32 s53, s22, 8
  s_and_b32 s22, s22, 255
  s_cmp_ge_u32 s22, 128
  s_cbranch_scc1 gemm_side
  s_lshr_b32 s50, s22, 4
  s_and_b32 s51, s22, 15
  s_load_dwordx2 s[4:5], s[0:1], 8
  s_load_dwordx4 s[40:43], s[0:1], 16
  s_load_dwordx4 s[44:47], s[0:1], 32
  s_load_dwordx2 s[48:49], s[0:1], 104
  s_lshr_b32 s55, s51, 2
  s_and_b32 s56, s51, 3
  s_lshl_b32 s57, s50, 2
  s_add_u32 s58, s57, s55
  s_add_u32 s59, s57, s20
  s_lshr_b32 s60, s51, 1
  s_and_b32 s61, s51, 1
  s_mul_i32 s81, s20, 40960
  v_lshlrev_b32 v4, 4, v1
  s_waitcnt lgkmcnt(0)
  s_mov_b32 s12, s44
  s_mov_b32 s13, s45
  s_mov_b32 s14, 7864320
  s_mov_b32 s15, 0x00020000
  s_mov_b32 s16, s46
  s_mov_b32 s17, s47
  s_mov_b32 s18, 7864320
  s_mov_b32 s19, 0x00020000
  s_mov_b32 s24, s40
  s_mov_b32 s25, s41
  s_mov_b32 s26, 7864320
  s_mov_b32 s27, 0x00020000
  s_mov_b32 s28, s42
  s_mov_b32 s29, s43
  s_mov_b32 s30, 7864320
  s_mov_b32 s31, 0x00020000
  s_mov_b32 s36, s4
  s_mov_b32 s37, s5
  s_mov_b32 s38, 10240
  s_mov_b32 s39, 0x00020000
  s_add_u32 s8, s48, 174063616
  s_addc_u32 s9, s49, 0
  s_mov_b32 s10, 495616
  s_mov_b32 s11, 0x00020000
  s_add_u32 s4, s48, 171966464
  s_addc_u32 s5, s49, 0
  s_mov_b32 s6, 1048576
  s_mov_b32 s7, 0x00020000
  v_add_u32 v66, 0, v1
  v_mul_u32_u24 v67, 2731, v66
  v_lshrrev_b32 v67, 16, v67
  v_mul_u32_u24 v48, 24, v67
  v_sub_u32 v66, v66, v48
  v_mul_u32_u24 v67, 12288, v67
  v_lshl_add_u32 v48, v66, 4, v67
  v_add_u32 v66, 64, v1
  v_mul_u32_u24 v67, 2731, v66
  v_lshrrev_b32 v67, 16, v67
  v_mul_u32_u24 v49, 24, v67
  v_sub_u32 v66, v66, v49
  v_mul_u32_u24 v67, 12288, v67
  v_lshl_add_u32 v49, v66, 4, v67
  v_add_u32 v66, 128, v1
  v_mul_u32_u24 v67, 2731, v66
  v_lshrrev_b32 v67, 16, v67
  v_mul_u32_u24 v50, 24, v67
  v_sub_u32 v66, v66, v50
  v_mul_u32_u24 v67, 12288, v67
  v_lshl_add_u32 v50, v66, 4, v67
  s_mul_i32 s21, s51, 491520
  s_mul_i32 s80, s59, 384
  s_add_u32 s21, s21, s80
  s_mov_b32 s23, s21
  v_add_u32 v66, 0, v1
  v_mul_u32_u24 v67, 10923, v66
  v_lshrrev_b32 v67, 16, v67
  v_mul_u32_u24 v60, 6, v67
  v_sub_u32 v66, v66, v60
  v_mul_u32_u24 v67, 1280, v67
  v_lshl_add_u32 v60, v66, 4, v67
  v_add_u32 v66, 64, v1
  v_mul_u32_u24 v67, 10923, v66
  v_lshrrev_b32 v67, 16, v67
  v_mul_u32_u24 v61, 6, v67
  v_sub_u32 v66, v66, v61
  v_mul_u32_u24 v67, 1280, v67
  v_lshl_add_u32 v61, v66, 4, v67
  v_add_u32 v66, 128, v1
  v_mul_u32_u24 v67, 10923, v66
  v_lshrrev_b32 v67, 16, v67
  v_mul_u32_u24 v62, 6, v67
  v_sub_u32 v66, v66, v62
  v_mul_u32_u24 v67, 1280, v67
  v_lshl_add_u32 v62, v66, 4, v67
  s_mul_i32 s21, s59, 245760
  s_mul_i32 s22, s60, 160
  s_add_u32 s21, s21, s22
  s_lshl_b32 s22, s61, 6
  s_add_u32 s21, s21, s22
  s_add_u32 m0, s81, 0
  s_nop 0
  buffer_load_dwordx4 v60, s[16:19], s21 offen lds
  s_add_u32 m0, s81, 1024
  s_nop 0
  buffer_load_dwordx4 v61, s[16:19], s21 offen lds
  s_add_u32 m0, s81, 2048
  s_nop 0
  buffer_load_dwordx4 v62, s[16:19], s21 offen lds
  s_add_u32 s21, s21, 40960
  s_add_u32 m0, s81, 3072
  s_nop 0
  buffer_load_dwordx4 v60, s[16:19], s21 offen lds
  s_add_u32 m0, s81, 4096
  s_nop 0
  buffer_load_dwordx4 v61, s[16:19], s21 offen lds
  s_add_u32 m0, s81, 5120
  s_nop 0
  buffer_load_dwordx4 v62, s[16:19], s21 offen lds
  s_add_u32 s21, s21, 40960
  s_add_u32 m0, s81, 6144
  s_nop 0
  buffer_load_dwordx4 v60, s[16:19], s21 offen lds
  s_add_u32 m0, s81, 7168
  s_nop 0
  buffer_load_dwordx4 v61, s[16:19], s21 offen lds
  s_add_u32 m0, s81, 8192
  s_nop 0
  buffer_load_dwordx4 v62, s[16:19], s21 offen lds
  s_add_u32 s21, s21, 40960
  s_add_u32 m0, s81, 9216
  s_nop 0
  buffer_load_dwordx4 v60, s[16:19], s21 offen lds
  s_add_u32 m0, s81, 10240
  s_nop 0
  buffer_load_dwordx4 v61, s[16:19], s21 offen lds
  s_add_u32 m0, s81, 11264
  s_nop 0
  buffer_load_dwordx4 v62, s[16:19], s21 offen lds
  s_add_u32 s21, s21, 40960
  s_add_u32 m0, s81, 12288
  s_nop 0
  buffer_load_dwordx4 v60, s[16:19], s21 offen lds
  s_add_u32 m0, s81, 13312
  s_nop 0
  buffer_load_dwordx4 v61, s[16:19], s21 offen lds
  s_add_u32 m0, s81, 14336
  s_nop 0
  buffer_load_dwordx4 v62, s[16:19], s21 offen lds
  s_add_u32 s21, s21, 40960
  s_add_u32 m0, s81, 15360
  s_nop 0
  buffer_load_dwordx4 v60, s[16:19], s21 offen lds
  s_add_u32 m0, s81, 16384
  s_nop 0
  buffer_load_dwordx4 v61, s[16:19], s21 offen lds
  s_add_u32 m0, s81, 17408
  s_nop 0
  buffer_load_dwordx4 v62, s[16:19], s21 offen lds
  s_add_u32 s21, s21, 40960
  v_add_u32 v66, 0, v1
  v_mul_u32_u24 v67, 2731, v66
  v_lshrrev_b32 v67, 16, v67
  v_mul_u32_u24 v48, 24, v67
  v_sub_u32 v66, v66, v48
  v_lshrrev_b32 v48, 2, v67
  v_lshlrev_b32 v48, 1, v48
  v_or_b32 v48, 0, v48
  v_xor_b32 v66, v66, v48
  v_add_u32 v67, 0, v67
  v_mul_u32_u24 v67, 12288, v67
  v_lshl_add_u32 v48, v66, 4, v67
  v_add_u32 v66, 64, v1
  v_mul_u32_u24 v67, 2731, v66
  v_lshrrev_b32 v67, 16, v67
  v_mul_u32_u24 v49, 24, v67
  v_sub_u32 v66, v66, v49
  v_lshrrev_b32 v49, 2, v67
  v_lshlrev_b32 v49, 1, v49
  v_or_b32 v49, 0, v49
  v_xor_b32 v66, v66, v49
  v_add_u32 v67, 0, v67
  v_mul_u32_u24 v67, 12288, v67
  v_lshl_add_u32 v49, v66, 4, v67
  v_add_u32 v66, 128, v1
  v_mul_u32_u24 v67, 2731, v66
  v_lshrrev_b32 v67, 16, v67
  v_mul_u32_u24 v50, 24, v67
  v_sub_u32 v66, v66, v50
  v_lshrrev_b32 v50, 2, v67
  v_lshlrev_b32 v50, 1, v50
  v_or_b32 v50, 0, v50
  v_xor_b32 v66, v66, v50
  v_add_u32 v67, 0, v67
  v_mul_u32_u24 v67, 12288, v67
  v_lshl_add_u32 v50, v66, 4, v67
  v_add_u32 v66, 0, v1
  v_mul_u32_u24 v67, 2731, v66
  v_lshrrev_b32 v67, 16, v67
  v_mul_u32_u24 v51, 24, v67
  v_sub_u32 v66, v66, v51
  v_lshrrev_b32 v51, 2, v67
  v_lshlrev_b32 v51, 1, v51
  v_or_b32 v51, 1, v51
  v_xor_b32 v66, v66, v51
  v_add_u32 v67, 8, v67
  v_mul_u32_u24 v67, 12288, v67
  v_lshl_add_u32 v51, v66, 4, v67
  v_add_u32 v66, 64, v1
  v_mul_u32_u24 v67, 2731, v66
  v_lshrrev_b32 v67, 16, v67
  v_mul_u32_u24 v52, 24, v67
  v_sub_u32 v66, v66, v52
  v_lshrrev_b32 v52, 2, v67
  v_lshlrev_b32 v52, 1, v52
  v_or_b32 v52, 1, v52
  v_xor_b32 v66, v66, v52
  v_add_u32 v67, 8, v67
  v_mul_u32_u24 v67, 12288, v67
  v_lshl_add_u32 v52, v66, 4, v67
  v_add_u32 v66, 128, v1
  v_mul_u32_u24 v67, 2731, v66
  v_lshrrev_b32 v67, 16, v67
  v_mul_u32_u24 v53, 24, v67
  v_sub_u32 v66, v66, v53
  v_lshrrev_b32 v53, 2, v67
  v_lshlrev_b32 v53, 1, v53
  v_or_b32 v53, 1, v53
  v_xor_b32 v66, v66, v53
  v_add_u32 v67, 8, v67
  v_mul_u32_u24 v67, 12288, v67
  v_lshl_add_u32 v53, v66, 4, v67
  v_add_u32 v66, 0, v1
  v_mul_u32_u24 v67, 2731, v66
  v_lshrrev_b32 v67, 16, v67
  v_mul_u32_u24 v54, 24, v67
  v_sub_u32 v66, v66, v54
  v_lshrrev_b32 v54, 2, v67
  v_lshlrev_b32 v54, 1, v54
  v_or_b32 v54, 4, v54
  v_xor_b32 v66, v66, v54
  v_add_u32 v67, 16, v67
  v_mul_u32_u24 v67, 12288, v67
  v_lshl_add_u32 v54, v66, 4, v67
  v_add_u32 v66, 64, v1
  v_mul_u32_u24 v67, 2731, v66
  v_lshrrev_b32 v67, 16, v67
  v_mul_u32_u24 v55, 24, v67
  v_sub_u32 v66, v66, v55
  v_lshrrev_b32 v55, 2, v67
  v_lshlrev_b32 v55, 1, v55
  v_or_b32 v55, 4, v55
  v_xor_b32 v66, v66, v55
  v_add_u32 v67, 16, v67
  v_mul_u32_u24 v67, 12288, v67
  v_lshl_add_u32 v55, v66, 4, v67
  v_add_u32 v66, 128, v1
  v_mul_u32_u24 v67, 2731, v66
  v_lshrrev_b32 v67, 16, v67
  v_mul_u32_u24 v56, 24, v67
  v_sub_u32 v66, v66, v56
  v_lshrrev_b32 v56, 2, v67
  v_lshlrev_b32 v56, 1, v56
  v_or_b32 v56, 4, v56
  v_xor_b32 v66, v66, v56
  v_add_u32 v67, 16, v67
  v_mul_u32_u24 v67, 12288, v67
  v_lshl_add_u32 v56, v66, 4, v67
  v_add_u32 v66, 0, v1
  v_mul_u32_u24 v67, 2731, v66
  v_lshrrev_b32 v67, 16, v67
  v_mul_u32_u24 v57, 24, v67
  v_sub_u32 v66, v66, v57
  v_lshrrev_b32 v57, 2, v67
  v_lshlrev_b32 v57, 1, v57
  v_or_b32 v57, 5, v57
  v_xor_b32 v66, v66, v57
  v_add_u32 v67, 24, v67
  v_mul_u32_u24 v67, 12288, v67
  v_lshl_add_u32 v57, v66, 4, v67
  v_add_u32 v66, 64, v1
  v_mul_u32_u24 v67, 2731, v66
  v_lshrrev_b32 v67, 16, v67
  v_mul_u32_u24 v58, 24, v67
  v_sub_u32 v66, v66, v58
  v_lshrrev_b32 v58, 2, v67
  v_lshlrev_b32 v58, 1, v58
  v_or_b32 v58, 5, v58
  v_xor_b32 v66, v66, v58
  v_add_u32 v67, 24, v67
  v_mul_u32_u24 v67, 12288, v67
  v_lshl_add_u32 v58, v66, 4, v67
  v_add_u32 v66, 128, v1
  v_mul_u32_u24 v67, 2731, v66
  v_lshrrev_b32 v67, 16, v67
  v_mul_u32_u24 v59, 24, v67
  v_sub_u32 v66, v66, v59
  v_lshrrev_b32 v59, 2, v67
  v_lshlrev_b32 v59, 1, v59
  v_or_b32 v59, 5, v59
  v_xor_b32 v66, v66, v59
  v_add_u32 v67, 24, v67
  v_mul_u32_u24 v67, 12288, v67
  v_lshl_add_u32 v59, v66, 4, v67
  s_add_u32 m0, s81, 24576
  s_nop 0
  buffer_load_dwordx4 v48, s[12:15], s80 offen lds
  s_add_u32 m0, s81, 25600
  s_nop 0
  buffer_load_dwordx4 v49, s[12:15], s80 offen lds
  s_add_u32 m0, s81, 26624
  s_nop 0
  buffer_load_dwordx4 v50, s[12:15], s80 offen lds
  s_add_u32 m0, s81, 27648
  s_nop 0
  buffer_load_dwordx4 v51, s[12:15], s80 offen lds
  s_add_u32 m0, s81, 28672
  s_nop 0
  buffer_load_dwordx4 v52, s[12:15], s80 offen lds
  s_add_u32 m0, s81, 29696
  s_nop 0
  buffer_load_dwordx4 v53, s[12:15], s80 offen lds
  s_add_u32 m0, s81, 30720
  s_nop 0
  buffer_load_dwordx4 v54, s[12:15], s80 offen lds
  s_add_u32 m0, s81, 31744
  s_nop 0
  buffer_load_dwordx4 v55, s[12:15], s80 offen lds
  s_add_u32 m0, s81, 32768
  s_nop 0
  buffer_load_dwordx4 v56, s[12:15], s80 offen lds
  s_add_u32 m0, s81, 33792
  s_nop 0
  buffer_load_dwordx4 v57, s[12:15], s80 offen lds
  s_add_u32 m0, s81, 34816
  s_nop 0
  buffer_load_dwordx4 v58, s[12:15], s80 offen lds
  s_add_u32 m0, s81, 35840
  s_nop 0
  buffer_load_dwordx4 v59, s[12:15], s80 offen lds
  s_add_u32 s80, s80, 393216
  v_add_u32 v66, 0, v1
  v_mul_u32_u24 v67, 10923, v66
  v_lshrrev_b32 v67, 16, v67
  v_mul_u32_u24 v63, 6, v67
  v_sub_u32 v66, v66, v63
  v_mul_u32_u24 v67, 12288, v67
  v_lshl_add_u32 v63, v66, 4, v67
  v_add_u32 v66, 64, v1
  v_mul_u32_u24 v67, 10923, v66
  v_lshrrev_b32 v67, 16, v67
  v_mul_u32_u24 v64, 6, v67
  v_sub_u32 v66, v66, v64
  v_mul_u32_u24 v67, 12288, v67
  v_lshl_add_u32 v64, v66, 4, v67
  v_add_u32 v66, 128, v1
  v_mul_u32_u24 v67, 10923, v66
  v_lshrrev_b32 v67, 16, v67
  v_mul_u32_u24 v65, 6, v67
  v_sub_u32 v66, v66, v65
  v_mul_u32_u24 v67, 12288, v67
  v_lshl_add_u32 v65, v66, 4, v67
  s_mul_i32 s79, s58, 384
  s_mul_i32 s22, s56, 96
  s_add_u32 s79, s79, s22
  s_mul_i32 s22, s20, 1966080
  s_add_u32 s79, s79, s22
  v_and_b32 v224, 7, v2
  v_lshrrev_b32 v225, 3, v2
  v_lshlrev_b32 v12, 3, v1
  v_mov_b32 v23, 0
  v_mov_b32 v226, 0x4444
  v_mov_b32 v227, 0xeeee
  v_cmp_eq_u32 vcc, 1, v225
  v_cmp_gt_u32 s[62:63], 8, v2
  v_cmp_le_u32 s[68:69], 8, v2
  v_cndmask_b32 v22, v226, v227, vcc
  v_cmp_gt_u32 vcc, 32, v1
  v_mov_b32 v226, 0x3dd53b95
  v_cmp_gt_u32 s[66:67], 40, v1
  v_cndmask_b32 v24, 1.0, v226, vcc
  v_cndmask_b32 v25, 1.0, v226, vcc
  v_min_u32 v226, 39, v1
  v_and_b32 v227, 31, v1
  v_lshlrev_b32 v227, 2, v227
  v_lshl_add_u32 v5, v226, 7, v227
  v_mul_u32_u24 v226, 192, v3
  v_lshl_add_u32 v226, v2, 3, v226
  s_mul_i32 s21, s20, 768
  s_add_u32 s21, s21, 10240
  v_add_u32 v6, s21, v226
  v_and_b32 v226, 3, v2
  v_mul_u32_u24 v226, 192, v226
  v_lshrrev_b32 v227, 2, v2
  v_lshl_add_u32 v227, v3, 2, v227
  v_lshl_add_u32 v226, v227, 3, v226
  v_add_u32 v7, 10240, v226
  s_mul_i32 s21, s58, 2560
  s_add_u32 s21, s21, 40960
  s_lshr_b32 s22, s56, 1
  s_lshl_b32 s22, s22, 10
  s_and_b32 s23, s56, 1
  s_lshl_b32 s23, s23, 3
  s_add_u32 s22, s22, s23
  s_lshl_b32 s23, s20, 7
  s_add_u32 s22, s22, s23
  s_add_u32 s22, s22, s21
  v_lshlrev_b32 v226, 8, v3
  v_lshl_add_u32 v226, v224, 4, v226
  v_add_u32 v8, s22, v226
  s_lshl_b32 s22, s56, 2
  s_add_u32 s22, s22, s21
  s_add_u32 s22, s22, 2048
  v_and_b32 v226, 0x1ff, v226
  v_add_u32 v226, s22, v226
  s_cmp_eq_u32 s20, 2
  s_cselect_b64 vcc, -1, 0
  v_cmp_le_u32 s[64:65], 32, v1
  v_cndmask_b32 v8, v8, v226, vcc
  s_cselect_b64 s[64:65], s[64:65], -1
  s_and_b64 s[64:65], s[64:65], s[62:63]
  s_mul_i32 s21, s59, 2560
  s_add_u32 s21, s21, 40960
  v_add_u32 v9, s21, v4
  v_and_b32 v226, 0x1ff, v4
  s_add_u32 s21, s21, 2048
  v_add_u32 v10, s21, v226
  v_lshrrev_b32 v226, 2, v2
  v_and_b32 v227, 1, v2
  v_lshl_add_u32 v228, v226, 1, v227
  v_and_b32 v227, 2, v2
  v_cmp_eq_u32 vcc, 0, v227
  s_lshr_b32 s21, s20, 1
  s_lshl_b32 s21, s21, 9
  s_and_b32 s22, s20, 1
  s_lshl_b32 s22, s22, 6
  s_add_u32 s21, s21, s22
  s_add_u32 s21, s21, 12544
  v_lshlrev_b32 v226, 7, v3
  v_lshl_add_u32 v226, v228, 3, v226
  v_add_u32 v226, s21, v226
  v_mov_b32 v227, 13568
  v_cndmask_b32 v11, v227, v226, vcc
  s_lshl_b32 s21, s20, 9
  s_add_u32 s21, s21, 40960
  v_lshlrev_b32 v226, 7, v3
  v_lshl_add_u32 v226, v228, 4, v226
  v_add_u32 v226, s21, v226
  v_mov_b32 v227, 46080
  v_cndmask_b32 v19, v227, v226, vcc
  s_lshl_b32 s21, s20, 11
  s_add_u32 s21, s21, 32768
  v_add_u32 v18, s21, v4
  s_and_b32 s21, s20, 1
  s_lshl_b32 s22, s21, 10
  s_add_u32 s22, s22, 43008
  v_add_u32 v20, s22, v4
  s_lshl_b32 s22, s21, 3
  s_add_u32 s22, s22, 45056
  v_add_u32 v21, s22, v4
  s_mul_i32 s21, s20, 640
  s_add_u32 s22, s21, 13824
  v_lshlrev_b32 v226, 4, v224
  v_lshl_add_u32 v227, v3, 7, v226
  v_add_u32 v13, s22, v227
  v_lshl_add_u32 v227, v3, 2, v226
  s_add_u32 s22, s22, 512
  v_add_u32 v14, s22, v227
  v_lshrrev_b32 v228, 5, v1
  v_add_u32 v26, s21, v4
  v_lshl_add_u32 v228, v228, 1, v225
  v_mul_u32_u24 v228, 640, v228
  v_and_b32 v226, 1, v3
  v_lshl_add_u32 v228, v226, 6, v228
  v_lshl_add_u32 v228, v224, 3, v228
  v_add_u32 v43, 512, v228
  s_and_b32 s21, s50, 1
  s_lshl_b32 s21, s21, 4
  s_add_u32 s21, s21, s51
  s_lshl_b32 s22, s20, 5
  s_add_u32 s21, s21, s22
  s_cmp_lt_u32 s21, 80
  s_cselect_b32 s78, 1, 0
  s_cselect_b32 s21, s21, 0
  s_lshl_b32 s22, s21, 7
  v_add_u32 v17, s22, v227
  s_lshr_b32 s22, s21, 3
  s_lshl_b32 s22, s22, 14
  s_and_b32 s21, s21, 7
  s_lshl_b32 s21, s21, 10
  s_add_u32 s21, s21, s22
  v_add_u32 v16, s21, v4
  s_mul_i32 s21, s60, 10
  s_mul_i32 s22, s61, 6
  s_add_u32 s22, s22, s21
  s_add_u32 s21, s21, s61
  s_add_u32 s21, s21, 4
  v_lshrrev_b32 v226, 3, v1
  v_cmp_gt_u32 vcc, 4, v226
  v_add_u32 v226, s22, v226
  v_mov_b32 v227, s21
  v_cndmask_b32 v226, v227, v226, vcc
  v_lshrrev_b32 v227, 3, v226
  v_lshlrev_b32 v227, 14, v227
  v_and_b32 v226, 7, v226
  v_lshl_add_u32 v226, v226, 10, v227
  v_lshl_add_u32 v226, v224, 4, v226
  s_lshl_b32 s21, s50, 7
  v_add_u32 v15, s21, v226
  v_and_b32 v226, 1, v2
  v_lshlrev_b32 v226, 4, v226
  v_mov_b32 v227, 0x3c00
  v_lshlrev_b32 v226, v226, v227
  v_lshrrev_b32 v227, 1, v2
  v_cmp_eq_u32 vcc, 0, v227
  s_nop 1
  v_cndmask_b32 v44, 0, v226, vcc
  v_cmp_eq_u32 vcc, 2, v227
  s_nop 1
  v_cndmask_b32 v45, 0, v226, vcc
  v_cmp_eq_u32 vcc, 4, v227
  s_nop 1
  v_cndmask_b32 v46, 0, v226, vcc
  v_cmp_eq_u32 vcc, 6, v227
  s_nop 1
  v_cndmask_b32 v47, 0, v226, vcc
  v_lshrrev_b32 v226, 5, v1
  v_lshlrev_b32 v226, 14, v226
  v_bfe_u32 v227, v1, 3, 2
  v_lshl_add_u32 v226, v227, 8, v226
  v_lshl_add_u32 v226, v224, 4, v226
  s_lshl_b32 s21, s61, 7
  v_add_u32 v32, s21, v226
  v_lshlrev_b32 v226, 4, v224
  v_lshl_add_u32 v36, v3, 7, v226
  v_lshrrev_b32 v37, 1, v36
  v_and_b32 v41, 3, v1
  v_lshlrev_b32 v41, 7, v41
  v_mov_b32 v226, 0x40000000
  v_cmp_gt_u32 vcc, 32, v1
  v_cndmask_b32 v36, v226, v36, s[68:69]
  v_cndmask_b32 v37, v226, v37, s[68:69]
  v_cndmask_b32 v26, v226, v26, vcc
  s_lshr_b32 s21, s50, 1
  s_lshl_b32 s21, s21, 8
  s_add_u32 s21, s21, 491520
  v_and_b32 v227, 31, v1
  v_lshl_add_u32 v33, v227, 2, s21
  s_and_b32 s22, s50, 1
  s_lshl_b32 s22, s22, 4
  s_add_u32 s22, s22, s51
  v_cmp_eq_u32 vcc, s22, v1
  s_nop 1
  v_cndmask_b32 v34, v226, v33, vcc
  v_mov_b32 v28, -1
  v_mov_b32 v29, -1
  v_mov_b32 v30, -1
  v_mov_b32 v31, -1
  s_lshr_b32 s21, s50, 1
  s_mul_i32 s77, s21, 10240
  s_cmp_eq_u32 s20, 3
  s_cbranch_scc1 ar_8
  s_mov_b64 exec, s[64:65]
  s_cmp_eq_u32 s20, 2
  s_cbranch_scc1 ar_7
  s_mov_b32 s21, 0
  buffer_store_dwordx2 v[28:29], v8, s[8:11], s21 offen
  s_mov_b32 s21, 122880
  buffer_store_dwordx2 v[28:29], v8, s[8:11], s21 offen
  s_mov_b32 s21, 245760
  buffer_store_dwordx2 v[28:29], v8, s[8:11], s21 offen
  s_mov_b32 s21, 368640
  buffer_store_dwordx2 v[28:29], v8, s[8:11], s21 offen
  s_branch ar_9
ar_7:
  s_mov_b32 s21, 0
  buffer_store_dword v28, v8, s[8:11], s21 offen
  buffer_store_dword v28, v8, s[8:11], s21 offen offset:128
  s_mov_b32 s21, 122880
  buffer_store_dword v28, v8, s[8:11], s21 offen
  buffer_store_dword v28, v8, s[8:11], s21 offen offset:128
  s_mov_b32 s21, 245760
  buffer_store_dword v28, v8, s[8:11], s21 offen
  buffer_store_dword v28, v8, s[8:11], s21 offen offset:128
  s_mov_b32 s21, 368640
  buffer_store_dword v28, v8, s[8:11], s21 offen
  buffer_store_dword v28, v8, s[8:11], s21 offen offset:128
ar_9:
  s_cmp_eq_u32 s78, 0
  s_cbranch_scc1 ar_10
  s_mov_b64 exec, s[62:63]
  s_add_u32 s21, s77, 0
  buffer_store_dword v28, v17, s[8:11], s21 offen
  s_add_u32 s21, s77, 122880
  buffer_store_dword v28, v17, s[8:11], s21 offen
  s_add_u32 s21, s77, 245760
  buffer_store_dword v28, v17, s[8:11], s21 offen
  s_add_u32 s21, s77, 368640
  buffer_store_dword v28, v17, s[8:11], s21 offen
  s_branch ar_10
ar_8:
  buffer_store_dword v28, v34, s[8:11], 0 offen
  s_mov_b64 exec, s[66:67]
  s_mov_b32 s21, 0
  buffer_store_dwordx4 v[28:31], v15, s[4:7], s21 offen sc1
  s_mov_b32 s21, 262144
  buffer_store_dwordx4 v[28:31], v15, s[4:7], s21 offen sc1
  s_mov_b32 s21, 524288
  buffer_store_dwordx4 v[28:31], v15, s[4:7], s21 offen sc1
  s_mov_b32 s21, 786432
  buffer_store_dwordx4 v[28:31], v15, s[4:7], s21 offen sc1
  s_mov_b32 s21, 8192
  buffer_store_dwordx4 v[28:31], v15, s[4:7], s21 offen sc1
  s_mov_b32 s21, 270336
  buffer_store_dwordx4 v[28:31], v15, s[4:7], s21 offen sc1
  s_mov_b32 s21, 532480
  buffer_store_dwordx4 v[28:31], v15, s[4:7], s21 offen sc1
  s_mov_b32 s21, 794624
  buffer_store_dwordx4 v[28:31], v15, s[4:7], s21 offen sc1
ar_10:
  s_mov_b64 exec, -1
  v_lshrrev_b32 v66, 2, v2
  v_lshl_add_u32 v66, v3, 3, v66
  v_mul_u32_u24 v66, 96, v66
  v_add_u32 v66, s81, v66
  v_and_b32 v67, 3, v2
  s_lshl_b32 s21, s61, 5
  v_lshl_add_u32 v68, v67, 4, v66
  v_add_u32 v68, s21, v68
  s_mul_i32 s21, s61, 48
  s_sub_u32 s21, 64, s21
  v_and_b32 v67, 1, v2
  v_lshl_add_u32 v69, v67, 3, v66
  v_add_u32 v69, s21, v69
  v_lshrrev_b32 v226, 3, v2
  v_lshlrev_b32 v226, 4, v226
  v_bfe_u32 v227, v2, 1, 1
  v_lshl_add_u32 v226, v227, 3, v226
  v_and_b32 v227, 5, v2
  v_add_u32 v226, v226, v227
  v_mul_u32_u24 v226, 384, v226
  v_add_u32 v226, s81, v226
  v_lshrrev_b32 v227, 1, v2
  v_xor_b32 v227, v227, v3
  v_lshl_add_u32 v70, v227, 4, v226
  v_xor_b32 v227, 4, v227
  v_lshl_add_u32 v71, v227, 4, v226
  s_waitcnt vmcnt(0)
  ds_read_b64_tr_b16 v[72:73], v68 offset:0
  ds_read_b64_tr_b16 v[74:75], v68 offset:384
  ds_read_b64_tr_b16 v[76:77], v68 offset:8
  ds_read_b64_tr_b16 v[78:79], v68 offset:392
  ds_read_b64_tr_b16 v[80:81], v69 offset:0
  ds_read_b64_tr_b16 v[82:83], v69 offset:384
  ds_read_b64_tr_b16 v[84:85], v68 offset:3072
  ds_read_b64_tr_b16 v[86:87], v68 offset:3456
  ds_read_b64_tr_b16 v[88:89], v68 offset:3080
  ds_read_b64_tr_b16 v[90:91], v68 offset:3464
  ds_read_b64_tr_b16 v[92:93], v69 offset:3072
  ds_read_b64_tr_b16 v[94:95], v69 offset:3456
  ds_read_b64_tr_b16 v[96:97], v68 offset:6144
  ds_read_b64_tr_b16 v[98:99], v68 offset:6528
  ds_read_b64_tr_b16 v[100:101], v68 offset:6152
  ds_read_b64_tr_b16 v[102:103], v68 offset:6536
  ds_read_b64_tr_b16 v[104:105], v69 offset:6144
  ds_read_b64_tr_b16 v[106:107], v69 offset:6528
  ds_read_b64_tr_b16 v[108:109], v68 offset:9216
  ds_read_b64_tr_b16 v[110:111], v68 offset:9600
  ds_read_b64_tr_b16 v[112:113], v68 offset:9224
  ds_read_b64_tr_b16 v[114:115], v68 offset:9608
  ds_read_b64_tr_b16 v[116:117], v69 offset:9216
  ds_read_b64_tr_b16 v[118:119], v69 offset:9600
  ds_read_b64_tr_b16 v[120:121], v68 offset:12288
  ds_read_b64_tr_b16 v[122:123], v68 offset:12672
  ds_read_b64_tr_b16 v[124:125], v68 offset:12296
  ds_read_b64_tr_b16 v[126:127], v68 offset:12680
  ds_read_b64_tr_b16 v[128:129], v69 offset:12288
  ds_read_b64_tr_b16 v[130:131], v69 offset:12672
  ds_read_b64_tr_b16 v[132:133], v68 offset:15360
  ds_read_b64_tr_b16 v[134:135], v68 offset:15744
  ds_read_b64_tr_b16 v[136:137], v68 offset:15368
  ds_read_b64_tr_b16 v[138:139], v68 offset:15752
  ds_read_b64_tr_b16 v[140:141], v69 offset:15360
  ds_read_b64_tr_b16 v[142:143], v69 offset:15744
  s_waitcnt lgkmcnt(0)
  s_barrier
  s_cmp_lg_u32 s20, 0
  s_cbranch_scc1 ic_11
  v_mov_b32 v68, 64
  v_mov_b32 v69, 1
  s_mov_b64 exec, 1
  buffer_atomic_add v69, v68, s[32:35], 0 offen sc1
  s_mov_b64 exec, -1
ic_11:
  s_add_u32 m0, s81, 0
  s_nop 0
  buffer_load_dwordx4 v48, s[12:15], s80 offen lds
  s_add_u32 m0, s81, 1024
  s_nop 0
  buffer_load_dwordx4 v49, s[12:15], s80 offen lds
  s_add_u32 m0, s81, 2048
  s_nop 0
  buffer_load_dwordx4 v50, s[12:15], s80 offen lds
  s_add_u32 m0, s81, 3072
  s_nop 0
  buffer_load_dwordx4 v51, s[12:15], s80 offen lds
  s_add_u32 m0, s81, 4096
  s_nop 0
  buffer_load_dwordx4 v52, s[12:15], s80 offen lds
  s_add_u32 m0, s81, 5120
  s_nop 0
  buffer_load_dwordx4 v53, s[12:15], s80 offen lds
  s_add_u32 m0, s81, 6144
  s_nop 0
  buffer_load_dwordx4 v54, s[12:15], s80 offen lds
  s_add_u32 m0, s81, 7168
  s_nop 0
  buffer_load_dwordx4 v55, s[12:15], s80 offen lds
  s_add_u32 m0, s81, 8192
  s_nop 0
  buffer_load_dwordx4 v56, s[12:15], s80 offen lds
  s_add_u32 m0, s81, 9216
  s_nop 0
  buffer_load_dwordx4 v57, s[12:15], s80 offen lds
  s_add_u32 m0, s81, 10240
  s_nop 0
  buffer_load_dwordx4 v58, s[12:15], s80 offen lds
  s_add_u32 m0, s81, 11264
  s_nop 0
  buffer_load_dwordx4 v59, s[12:15], s80 offen lds
  s_add_u32 s80, s80, 393216
  s_add_u32 s16, s48, 173080576
  s_addc_u32 s17, s49, 0
  s_mov_b32 s18, 49152
  s_mov_b32 s19, 0x00020000
  v_add_u32 v68, s81, v4
  v_and_b32 v69, 7, v2
  v_lshl_add_u32 v69, v3, 3, v69
  v_and_b32 v67, 8, v2
  v_lshl_add_u32 v69, v69, 4, v67
  v_add_u32 v69, s81, v69
  v_lshlrev_b32 v67, 2, v1
  s_lshl_b32 s90, s50, 9
  s_and_b32 s21, s51, 12
  s_add_u32 s90, s90, s21
  s_add_u32 s90, s90, 4096
  ds_read_b128 v[208:211], v70 offset:24576
  ds_read_b128 v[212:215], v71 offset:24576
  ds_read_b128 v[216:219], v70 offset:24704
  s_waitcnt lgkmcnt(2)
  v_mfma_f32_16x16x32_bf16 v[184:187], v[208:211], v[72:75], 0
  ds_read_b128 v[220:223], v71 offset:24704
  v_mfma_f32_16x16x32_bf16 v[188:191], v[208:211], v[76:79], 0
  s_add_u32 m0, s81, 12288
  s_nop 0
  buffer_load_dwordx4 v48, s[12:15], s80 offen lds
  v_mfma_f32_16x16x32_bf16 v[192:195], v[208:211], v[80:83], 0
  s_waitcnt lgkmcnt(2)
  v_mfma_f32_16x16x32_bf16 v[184:187], v[212:215], v[84:87], v[184:187]
  ds_read_b128 v[208:211], v70 offset:24832
  v_mfma_f32_16x16x32_bf16 v[188:191], v[212:215], v[88:91], v[188:191]
  s_add_u32 m0, s81, 13312
  s_nop 0
  buffer_load_dwordx4 v49, s[12:15], s80 offen lds
  v_mfma_f32_16x16x32_bf16 v[192:195], v[212:215], v[92:95], v[192:195]
  s_waitcnt lgkmcnt(2)
  v_mfma_f32_16x16x32_bf16 v[184:187], v[216:219], v[96:99], v[184:187]
  ds_read_b128 v[212:215], v71 offset:24832
  v_mfma_f32_16x16x32_bf16 v[188:191], v[216:219], v[100:103], v[188:191]
  s_add_u32 m0, s81, 14336
  s_nop 0
  buffer_load_dwordx4 v50, s[12:15], s80 offen lds
  v_mfma_f32_16x16x32_bf16 v[192:195], v[216:219], v[104:107], v[192:195]
  s_waitcnt lgkmcnt(2)
  v_mfma_f32_16x16x32_bf16 v[184:187], v[220:223], v[108:111], v[184:187]
  ds_read_b128 v[216:219], v70 offset:25344
  v_mfma_f32_16x16x32_bf16 v[188:191], v[220:223], v[112:115], v[188:191]
  s_add_u32 m0, s81, 15360
  s_nop 0
  buffer_load_dwordx4 v51, s[12:15], s80 offen lds
  v_mfma_f32_16x16x32_bf16 v[192:195], v[220:223], v[116:119], v[192:195]
  s_waitcnt lgkmcnt(2)
  v_mfma_f32_16x16x32_bf16 v[184:187], v[208:211], v[120:123], v[184:187]
  ds_read_b128 v[220:223], v71 offset:25344
  v_mfma_f32_16x16x32_bf16 v[188:191], v[208:211], v[124:127], v[188:191]
  s_add_u32 m0, s81, 16384
  s_nop 0
  buffer_load_dwordx4 v52, s[12:15], s80 offen lds
  v_mfma_f32_16x16x32_bf16 v[192:195], v[208:211], v[128:131], v[192:195]
  s_waitcnt lgkmcnt(2)
  v_mfma_f32_16x16x32_bf16 v[184:187], v[212:215], v[132:135], v[184:187]
  ds_read_b128 v[208:211], v70 offset:25472
  v_mfma_f32_16x16x32_bf16 v[188:191], v[212:215], v[136:139], v[188:191]
  s_add_u32 m0, s81, 17408
  s_nop 0
  buffer_load_dwordx4 v53, s[12:15], s80 offen lds
  v_mfma_f32_16x16x32_bf16 v[192:195], v[212:215], v[140:143], v[192:195]
  s_waitcnt lgkmcnt(2)
  v_mfma_f32_16x16x32_bf16 v[196:199], v[216:219], v[72:75], 0
  ds_read_b128 v[212:215], v71 offset:25472
  v_mfma_f32_16x16x32_bf16 v[200:203], v[216:219], v[76:79], 0
  s_add_u32 m0, s81, 18432
  s_nop 0
  buffer_load_dwordx4 v54, s[12:15], s80 offen lds
  v_mfma_f32_16x16x32_bf16 v[204:207], v[216:219], v[80:83], 0
  s_waitcnt lgkmcnt(2)
  v_mfma_f32_16x16x32_bf16 v[196:199], v[220:223], v[84:87], v[196:199]
  ds_read_b128 v[216:219], v70 offset:25600
  v_cvt_pk_bf16_f32 v248, v184, v185
  v_mfma_f32_16x16x32_bf16 v[200:203], v[220:223], v[88:91], v[200:203]
  s_add_u32 m0, s81, 19456
  s_nop 0
  buffer_load_dwordx4 v55, s[12:15], s80 offen lds
  v_mfma_f32_16x16x32_bf16 v[204:207], v[220:223], v[92:95], v[204:207]
  v_cvt_pk_bf16_f32 v249, v186, v187
  s_waitcnt lgkmcnt(2)
  v_mfma_f32_16x16x32_bf16 v[196:199], v[208:211], v[96:99], v[196:199]
  ds_read_b128 v[220:223], v71 offset:25600
  v_cvt_pk_bf16_f32 v250, v188, v189
  v_mfma_f32_16x16x32_bf16 v[200:203], v[208:211], v[100:103], v[200:203]
  s_add_u32 m0, s81, 20480
  s_nop 0
  buffer_load_dwordx4 v56, s[12:15], s80 offen lds
  v_mfma_f32_16x16x32_bf16 v[204:207], v[208:211], v[104:107], v[204:207]
  v_cvt_pk_bf16_f32 v251, v190, v191
  s_waitcnt lgkmcnt(2)
  v_mfma_f32_16x16x32_bf16 v[196:199], v[212:215], v[108:111], v[196:199]
  v_accvgpr_write_b32 a0, v248
  v_mfma_f32_16x16x32_bf16 v[200:203], v[212:215], v[112:115], v[200:203]
  s_add_u32 m0, s81, 21504
  s_nop 0
  buffer_load_dwordx4 v57, s[12:15], s80 offen lds
  v_mfma_f32_16x16x32_bf16 v[204:207], v[212:215], v[116:119], v[204:207]
  v_accvgpr_write_b32 a1, v249
  s_waitcnt lgkmcnt(1)
  v_mfma_f32_16x16x32_bf16 v[196:199], v[216:219], v[120:123], v[196:199]
  v_accvgpr_write_b32 a80, v250
  v_mfma_f32_16x16x32_bf16 v[200:203], v[216:219], v[124:127], v[200:203]
  s_add_u32 m0, s81, 22528
  s_nop 0
  buffer_load_dwordx4 v58, s[12:15], s80 offen lds
  v_mfma_f32_16x16x32_bf16 v[204:207], v[216:219], v[128:131], v[204:207]
  v_accvgpr_write_b32 a81, v251
  s_waitcnt lgkmcnt(0)
  v_mfma_f32_16x16x32_bf16 v[196:199], v[220:223], v[132:135], v[196:199]
  v_cvt_pk_bf16_f32 v144, v192, v193
  v_cvt_pk_bf16_f32 v145, v194, v195
  v_mfma_f32_16x16x32_bf16 v[200:203], v[220:223], v[136:139], v[200:203]
  s_add_u32 m0, s81, 23552
  s_nop 0
  buffer_load_dwordx4 v59, s[12:15], s80 offen lds
  s_add_u32 s80, s80, 393216
  v_mfma_f32_16x16x32_bf16 v[204:207], v[220:223], v[140:143], v[204:207]
  s_waitcnt vmcnt(12)
  ds_read_b128 v[208:211], v70 offset:0
  ds_read_b128 v[212:215], v71 offset:0
  ds_read_b128 v[216:219], v70 offset:128
  s_waitcnt lgkmcnt(2)
  v_mfma_f32_16x16x32_bf16 v[184:187], v[208:211], v[72:75], 0
  ds_read_b128 v[220:223], v71 offset:128
  v_mfma_f32_16x16x32_bf16 v[188:191], v[208:211], v[76:79], 0
  s_add_u32 m0, s81, 24576
  s_nop 0
  buffer_load_dwordx4 v48, s[12:15], s80 offen lds
  v_mfma_f32_16x16x32_bf16 v[192:195], v[208:211], v[80:83], 0
  s_waitcnt lgkmcnt(2)
  v_mfma_f32_16x16x32_bf16 v[184:187], v[212:215], v[84:87], v[184:187]
  ds_read_b128 v[208:211], v70 offset:256
  v_cvt_pk_bf16_f32 v248, v196, v197
  v_mfma_f32_16x16x32_bf16 v[188:191], v[212:215], v[88:91], v[188:191]
  s_add_u32 m0, s81, 25600
  s_nop 0
  buffer_load_dwordx4 v49, s[12:15], s80 offen lds
  v_mfma_f32_16x16x32_bf16 v[192:195], v[212:215], v[92:95], v[192:195]
  v_cvt_pk_bf16_f32 v249, v198, v199
  s_waitcnt lgkmcnt(2)
  v_mfma_f32_16x16x32_bf16 v[184:187], v[216:219], v[96:99], v[184:187]
  ds_read_b128 v[212:215], v71 offset:256
  v_cvt_pk_bf16_f32 v250, v200, v201
  v_mfma_f32_16x16x32_bf16 v[188:191], v[216:219], v[100:103], v[188:191]
  s_add_u32 m0, s81, 26624
  s_nop 0
  buffer_load_dwordx4 v50, s[12:15], s80 offen lds
  v_mfma_f32_16x16x32_bf16 v[192:195], v[216:219], v[104:107], v[192:195]
  v_cvt_pk_bf16_f32 v251, v202, v203
  s_waitcnt lgkmcnt(2)
  v_mfma_f32_16x16x32_bf16 v[184:187], v[220:223], v[108:111], v[184:187]
  ds_read_b128 v[216:219], v70 offset:768
  v_accvgpr_write_b32 a2, v248
  v_mfma_f32_16x16x32_bf16 v[188:191], v[220:223], v[112:115], v[188:191]
  s_add_u32 m0, s81, 27648
  s_nop 0
  buffer_load_dwordx4 v51, s[12:15], s80 offen lds
  v_mfma_f32_16x16x32_bf16 v[192:195], v[220:223], v[116:119], v[192:195]
  v_accvgpr_write_b32 a3, v249
  s_waitcnt lgkmcnt(2)
  v_mfma_f32_16x16x32_bf16 v[184:187], v[208:211], v[120:123], v[184:187]
  ds_read_b128 v[220:223], v71 offset:768
  v_accvgpr_write_b32 a82, v250
  v_mfma_f32_16x16x32_bf16 v[188:191], v[208:211], v[124:127], v[188:191]
  s_add_u32 m0, s81, 28672
  s_nop 0
  buffer_load_dwordx4 v52, s[12:15], s80 offen lds
  v_mfma_f32_16x16x32_bf16 v[192:195], v[208:211], v[128:131], v[192:195]
  v_accvgpr_write_b32 a83, v251
  s_waitcnt lgkmcnt(2)
  v_mfma_f32_16x16x32_bf16 v[184:187], v[212:215], v[132:135], v[184:187]
  ds_read_b128 v[208:211], v70 offset:896
  s_mov_b64 exec, s[68:69]
  v_cvt_pk_bf16_f32 v144, v204, v205
  v_cvt_pk_bf16_f32 v145, v206, v207
  s_mov_b64 exec, -1
  v_mfma_f32_16x16x32_bf16 v[188:191], v[212:215], v[136:139], v[188:191]
  s_add_u32 m0, s81, 29696
  s_nop 0
  buffer_load_dwordx4 v53, s[12:15], s80 offen lds
  v_mfma_f32_16x16x32_bf16 v[192:195], v[212:215], v[140:143], v[192:195]
  s_waitcnt lgkmcnt(2)
  v_mfma_f32_16x16x32_bf16 v[196:199], v[216:219], v[72:75], 0
  ds_read_b128 v[212:215], v71 offset:896
  v_mfma_f32_16x16x32_bf16 v[200:203], v[216:219], v[76:79], 0
  s_add_u32 m0, s81, 30720
  s_nop 0
  buffer_load_dwordx4 v54, s[12:15], s80 offen lds
  v_mfma_f32_16x16x32_bf16 v[204:207], v[216:219], v[80:83], 0
  s_waitcnt lgkmcnt(2)
  v_mfma_f32_16x16x32_bf16 v[196:199], v[220:223], v[84:87], v[196:199]
  ds_read_b128 v[216:219], v70 offset:1024
  v_cvt_pk_bf16_f32 v248, v184, v185
  v_mfma_f32_16x16x32_bf16 v[200:203], v[220:223], v[88:91], v[200:203]
  s_add_u32 m0, s81, 31744
  s_nop 0
  buffer_load_dwordx4 v55, s[12:15], s80 offen lds
  v_mfma_f32_16x16x32_bf16 v[204:207], v[220:223], v[92:95], v[204:207]
  v_cvt_pk_bf16_f32 v249, v186, v187
  s_waitcnt lgkmcnt(2)
  v_mfma_f32_16x16x32_bf16 v[196:199], v[208:211], v[96:99], v[196:199]
  ds_read_b128 v[220:223], v71 offset:1024
  v_cvt_pk_bf16_f32 v250, v188, v189
  v_mfma_f32_16x16x32_bf16 v[200:203], v[208:211], v[100:103], v[200:203]
  s_add_u32 m0, s81, 32768
  s_nop 0
  buffer_load_dwordx4 v56, s[12:15], s80 offen lds
  v_mfma_f32_16x16x32_bf16 v[204:207], v[208:211], v[104:107], v[204:207]
  v_cvt_pk_bf16_f32 v251, v190, v191
  s_waitcnt lgkmcnt(2)
  v_mfma_f32_16x16x32_bf16 v[196:199], v[212:215], v[108:111], v[196:199]
  v_accvgpr_write_b32 a4, v248
  v_mfma_f32_16x16x32_bf16 v[200:203], v[212:215], v[112:115], v[200:203]
  s_add_u32 m0, s81, 33792
  s_nop 0
  buffer_load_dwordx4 v57, s[12:15], s80 offen lds
  v_mfma_f32_16x16x32_bf16 v[204:207], v[212:215], v[116:119], v[204:207]
  v_accvgpr_write_b32 a5, v249
  s_waitcnt lgkmcnt(1)
  v_mfma_f32_16x16x32_bf16 v[196:199], v[216:219], v[120:123], v[196:199]
  v_accvgpr_write_b32 a84, v250
  v_mfma_f32_16x16x32_bf16 v[200:203], v[216:219], v[124:127], v[200:203]
  s_add_u32 m0, s81, 34816
  s_nop 0
  buffer_load_dwordx4 v58, s[12:15], s80 offen lds
  v_mfma_f32_16x16x32_bf16 v[204:207], v[216:219], v[128:131], v[204:207]
  v_accvgpr_write_b32 a85, v251
  s_waitcnt lgkmcnt(0)
  v_mfma_f32_16x16x32_bf16 v[196:199], v[220:223], v[132:135], v[196:199]
  v_cvt_pk_bf16_f32 v146, v192, v193
  v_cvt_pk_bf16_f32 v147, v194, v195
  v_mfma_f32_16x16x32_bf16 v[200:203], v[220:223], v[136:139], v[200:203]
  s_add_u32 m0, s81, 35840
  s_nop 0
  buffer_load_dwordx4 v59, s[12:15], s80 offen lds
  s_add_u32 s80, s80, 393216
  v_mfma_f32_16x16x32_bf16 v[204:207], v[220:223], v[140:143], v[204:207]
  s_waitcnt vmcnt(12)
  ds_read_b128 v[208:211], v70 offset:12288
  ds_read_b128 v[212:215], v71 offset:12288
  ds_read_b128 v[216:219], v70 offset:12416
  s_waitcnt lgkmcnt(2)
  v_mfma_f32_16x16x32_bf16 v[184:187], v[208:211], v[72:75], 0
  ds_read_b128 v[220:223], v71 offset:12416
  v_mfma_f32_16x16x32_bf16 v[188:191], v[208:211], v[76:79], 0
  s_add_u32 m0, s81, 0
  s_nop 0
  buffer_load_dwordx4 v48, s[12:15], s80 offen lds
  v_mfma_f32_16x16x32_bf16 v[192:195], v[208:211], v[80:83], 0
  s_waitcnt lgkmcnt(2)
  v_mfma_f32_16x16x32_bf16 v[184:187], v[212:215], v[84:87], v[184:187]
  ds_read_b128 v[208:211], v70 offset:12544
  v_cvt_pk_bf16_f32 v248, v196, v197
  v_mfma_f32_16x16x32_bf16 v[188:191], v[212:215], v[88:91], v[188:191]
  s_add_u32 m0, s81, 1024
  s_nop 0
  buffer_load_dwordx4 v49, s[12:15], s80 offen lds
  v_mfma_f32_16x16x32_bf16 v[192:195], v[212:215], v[92:95], v[192:195]
  v_cvt_pk_bf16_f32 v249, v198, v199
  s_waitcnt lgkmcnt(2)
  v_mfma_f32_16x16x32_bf16 v[184:187], v[216:219], v[96:99], v[184:187]
  ds_read_b128 v[212:215], v71 offset:12544
  v_cvt_pk_bf16_f32 v250, v200, v201
  v_mfma_f32_16x16x32_bf16 v[188:191], v[216:219], v[100:103], v[188:191]
  s_add_u32 m0, s81, 2048
  s_nop 0
  buffer_load_dwordx4 v50, s[12:15], s80 offen lds
  v_mfma_f32_16x16x32_bf16 v[192:195], v[216:219], v[104:107], v[192:195]
  v_cvt_pk_bf16_f32 v251, v202, v203
  s_waitcnt lgkmcnt(2)
  v_mfma_f32_16x16x32_bf16 v[184:187], v[220:223], v[108:111], v[184:187]
  ds_read_b128 v[216:219], v70 offset:13056
  v_accvgpr_write_b32 a6, v248
  v_mfma_f32_16x16x32_bf16 v[188:191], v[220:223], v[112:115], v[188:191]
  s_add_u32 m0, s81, 3072
  s_nop 0
  buffer_load_dwordx4 v51, s[12:15], s80 offen lds
  v_mfma_f32_16x16x32_bf16 v[192:195], v[220:223], v[116:119], v[192:195]
  v_accvgpr_write_b32 a7, v249
  s_waitcnt lgkmcnt(2)
  v_mfma_f32_16x16x32_bf16 v[184:187], v[208:211], v[120:123], v[184:187]
  ds_read_b128 v[220:223], v71 offset:13056
  v_accvgpr_write_b32 a86, v250
  v_mfma_f32_16x16x32_bf16 v[188:191], v[208:211], v[124:127], v[188:191]
  s_add_u32 m0, s81, 4096
  s_nop 0
  buffer_load_dwordx4 v52, s[12:15], s80 offen lds
  v_mfma_f32_16x16x32_bf16 v[192:195], v[208:211], v[128:131], v[192:195]
  v_accvgpr_write_b32 a87, v251
  s_waitcnt lgkmcnt(2)
  v_mfma_f32_16x16x32_bf16 v[184:187], v[212:215], v[132:135], v[184:187]
  ds_read_b128 v[208:211], v70 offset:13184
  s_mov_b64 exec, s[68:69]
  v_cvt_pk_bf16_f32 v146, v204, v205
  v_cvt_pk_bf16_f32 v147, v206, v207
  s_mov_b64 exec, -1
  v_mfma_f32_16x16x32_bf16 v[188:191], v[212:215], v[136:139], v[188:191]
  s_add_u32 m0, s81, 5120
  s_nop 0
  buffer_load_dwordx4 v53, s[12:15], s80 offen lds
  v_mfma_f32_16x16x32_bf16 v[192:195], v[212:215], v[140:143], v[192:195]
  s_waitcnt lgkmcnt(2)
  v_mfma_f32_16x16x32_bf16 v[196:199], v[216:219], v[72:75], 0
  ds_read_b128 v[212:215], v71 offset:13184
  v_mfma_f32_16x16x32_bf16 v[200:203], v[216:219], v[76:79], 0
  s_add_u32 m0, s81, 6144
  s_nop 0
  buffer_load_dwordx4 v54, s[12:15], s80 offen lds
  v_mfma_f32_16x16x32_bf16 v[204:207], v[216:219], v[80:83], 0
  s_waitcnt lgkmcnt(2)
  v_mfma_f32_16x16x32_bf16 v[196:199], v[220:223], v[84:87], v[196:199]
  ds_read_b128 v[216:219], v70 offset:13312
  v_cvt_pk_bf16_f32 v248, v184, v185
  v_mfma_f32_16x16x32_bf16 v[200:203], v[220:223], v[88:91], v[200:203]
  s_add_u32 m0, s81, 7168
  s_nop 0
  buffer_load_dwordx4 v55, s[12:15], s80 offen lds
  v_mfma_f32_16x16x32_bf16 v[204:207], v[220:223], v[92:95], v[204:207]
  v_cvt_pk_bf16_f32 v249, v186, v187
  s_waitcnt lgkmcnt(2)
  v_mfma_f32_16x16x32_bf16 v[196:199], v[208:211], v[96:99], v[196:199]
  ds_read_b128 v[220:223], v71 offset:13312
  v_cvt_pk_bf16_f32 v250, v188, v189
  v_mfma_f32_16x16x32_bf16 v[200:203], v[208:211], v[100:103], v[200:203]
  s_add_u32 m0, s81, 8192
  s_nop 0
  buffer_load_dwordx4 v56, s[12:15], s80 offen lds
  v_mfma_f32_16x16x32_bf16 v[204:207], v[208:211], v[104:107], v[204:207]
  v_cvt_pk_bf16_f32 v251, v190, v191
  s_waitcnt lgkmcnt(2)
  v_mfma_f32_16x16x32_bf16 v[196:199], v[212:215], v[108:111], v[196:199]
  v_accvgpr_write_b32 a8, v248
  v_mfma_f32_16x16x32_bf16 v[200:203], v[212:215], v[112:115], v[200:203]
  s_add_u32 m0, s81, 9216
  s_nop 0
  buffer_load_dwordx4 v57, s[12:15], s80 offen lds
  v_mfma_f32_16x16x32_bf16 v[204:207], v[212:215], v[116:119], v[204:207]
  v_accvgpr_write_b32 a9, v249
  s_waitcnt lgkmcnt(1)
  v_mfma_f32_16x16x32_bf16 v[196:199], v[216:219], v[120:123], v[196:199]
  v_accvgpr_write_b32 a88, v250
  v_mfma_f32_16x16x32_bf16 v[200:203], v[216:219], v[124:127], v[200:203]
  s_add_u32 m0, s81, 10240
  s_nop 0
  buffer_load_dwordx4 v58, s[12:15], s80 offen lds
  v_mfma_f32_16x16x32_bf16 v[204:207], v[216:219], v[128:131], v[204:207]
  v_accvgpr_write_b32 a89, v251
  s_waitcnt lgkmcnt(0)
  v_mfma_f32_16x16x32_bf16 v[196:199], v[220:223], v[132:135], v[196:199]
  v_cvt_pk_bf16_f32 v148, v192, v193
  v_cvt_pk_bf16_f32 v149, v194, v195
  v_mfma_f32_16x16x32_bf16 v[200:203], v[220:223], v[136:139], v[200:203]
  s_add_u32 m0, s81, 11264
  s_nop 0
  buffer_load_dwordx4 v59, s[12:15], s80 offen lds
  s_add_u32 s80, s80, 393216
  v_mfma_f32_16x16x32_bf16 v[204:207], v[220:223], v[140:143], v[204:207]
  s_waitcnt vmcnt(12)
  ds_read_b128 v[208:211], v70 offset:24576
  ds_read_b128 v[212:215], v71 offset:24576
  ds_read_b128 v[216:219], v70 offset:24704
  s_waitcnt lgkmcnt(2)
  v_mfma_f32_16x16x32_bf16 v[184:187], v[208:211], v[72:75], 0
  ds_read_b128 v[220:223], v71 offset:24704
  v_mfma_f32_16x16x32_bf16 v[188:191], v[208:211], v[76:79], 0
  s_add_u32 m0, s81, 12288
  s_nop 0
  buffer_load_dwordx4 v48, s[12:15], s80 offen lds
  v_mfma_f32_16x16x32_bf16 v[192:195], v[208:211], v[80:83], 0
  s_waitcnt lgkmcnt(2)
  v_mfma_f32_16x16x32_bf16 v[184:187], v[212:215], v[84:87], v[184:187]
  ds_read_b128 v[208:211], v70 offset:24832
  v_cvt_pk_bf16_f32 v248, v196, v197
  v_mfma_f32_16x16x32_bf16 v[188:191], v[212:215], v[88:91], v[188:191]
  s_add_u32 m0, s81, 13312
  s_nop 0
  buffer_load_dwordx4 v49, s[12:15], s80 offen lds
  v_mfma_f32_16x16x32_bf16 v[192:195], v[212:215], v[92:95], v[192:195]
  v_cvt_pk_bf16_f32 v249, v198, v199
  s_waitcnt lgkmcnt(2)
  v_mfma_f32_16x16x32_bf16 v[184:187], v[216:219], v[96:99], v[184:187]
  ds_read_b128 v[212:215], v71 offset:24832
  v_cvt_pk_bf16_f32 v250, v200, v201
  v_mfma_f32_16x16x32_bf16 v[188:191], v[216:219], v[100:103], v[188:191]
  s_add_u32 m0, s81, 14336
  s_nop 0
  buffer_load_dwordx4 v50, s[12:15], s80 offen lds
  v_mfma_f32_16x16x32_bf16 v[192:195], v[216:219], v[104:107], v[192:195]
  v_cvt_pk_bf16_f32 v251, v202, v203
  s_waitcnt lgkmcnt(2)
  v_mfma_f32_16x16x32_bf16 v[184:187], v[220:223], v[108:111], v[184:187]
  ds_read_b128 v[216:219], v70 offset:25344
  v_accvgpr_write_b32 a10, v248
  v_mfma_f32_16x16x32_bf16 v[188:191], v[220:223], v[112:115], v[188:191]
  s_add_u32 m0, s81, 15360
  s_nop 0
  buffer_load_dwordx4 v51, s[12:15], s80 offen lds
  v_mfma_f32_16x16x32_bf16 v[192:195], v[220:223], v[116:119], v[192:195]
  v_accvgpr_write_b32 a11, v249
  s_waitcnt lgkmcnt(2)
  v_mfma_f32_16x16x32_bf16 v[184:187], v[208:211], v[120:123], v[184:187]
  ds_read_b128 v[220:223], v71 offset:25344
  v_accvgpr_write_b32 a90, v250
  v_mfma_f32_16x16x32_bf16 v[188:191], v[208:211], v[124:127], v[188:191]
  s_add_u32 m0, s81, 16384
  s_nop 0
  buffer_load_dwordx4 v52, s[12:15], s80 offen lds
  v_mfma_f32_16x16x32_bf16 v[192:195], v[208:211], v[128:131], v[192:195]
  v_accvgpr_write_b32 a91, v251
  s_waitcnt lgkmcnt(2)
  v_mfma_f32_16x16x32_bf16 v[184:187], v[212:215], v[132:135], v[184:187]
  ds_read_b128 v[208:211], v70 offset:25472
  s_mov_b64 exec, s[68:69]
  v_cvt_pk_bf16_f32 v148, v204, v205
  v_cvt_pk_bf16_f32 v149, v206, v207
  s_mov_b64 exec, -1
  v_mfma_f32_16x16x32_bf16 v[188:191], v[212:215], v[136:139], v[188:191]
  s_add_u32 m0, s81, 17408
  s_nop 0
  buffer_load_dwordx4 v53, s[12:15], s80 offen lds
  v_mfma_f32_16x16x32_bf16 v[192:195], v[212:215], v[140:143], v[192:195]
  s_waitcnt lgkmcnt(2)
  v_mfma_f32_16x16x32_bf16 v[196:199], v[216:219], v[72:75], 0
  ds_read_b128 v[212:215], v71 offset:25472
  v_mfma_f32_16x16x32_bf16 v[200:203], v[216:219], v[76:79], 0
  s_add_u32 m0, s81, 18432
  s_nop 0
  buffer_load_dwordx4 v54, s[12:15], s80 offen lds
  v_mfma_f32_16x16x32_bf16 v[204:207], v[216:219], v[80:83], 0
  s_waitcnt lgkmcnt(2)
  v_mfma_f32_16x16x32_bf16 v[196:199], v[220:223], v[84:87], v[196:199]
  ds_read_b128 v[216:219], v70 offset:25600
  v_cvt_pk_bf16_f32 v248, v184, v185
  v_mfma_f32_16x16x32_bf16 v[200:203], v[220:223], v[88:91], v[200:203]
  s_add_u32 m0, s81, 19456
  s_nop 0
  buffer_load_dwordx4 v55, s[12:15], s80 offen lds
  v_mfma_f32_16x16x32_bf16 v[204:207], v[220:223], v[92:95], v[204:207]
  v_cvt_pk_bf16_f32 v249, v186, v187
  s_waitcnt lgkmcnt(2)
  v_mfma_f32_16x16x32_bf16 v[196:199], v[208:211], v[96:99], v[196:199]
  ds_read_b128 v[220:223], v71 offset:25600
  v_cvt_pk_bf16_f32 v250, v188, v189
  v_mfma_f32_16x16x32_bf16 v[200:203], v[208:211], v[100:103], v[200:203]
  s_add_u32 m0, s81, 20480
  s_nop 0
  buffer_load_dwordx4 v56, s[12:15], s80 offen lds
  v_mfma_f32_16x16x32_bf16 v[204:207], v[208:211], v[104:107], v[204:207]
  v_cvt_pk_bf16_f32 v251, v190, v191
  s_waitcnt lgkmcnt(2)
  v_mfma_f32_16x16x32_bf16 v[196:199], v[212:215], v[108:111], v[196:199]
  v_accvgpr_write_b32 a12, v248
  v_mfma_f32_16x16x32_bf16 v[200:203], v[212:215], v[112:115], v[200:203]
  s_add_u32 m0, s81, 21504
  s_nop 0
  buffer_load_dwordx4 v57, s[12:15], s80 offen lds
  v_mfma_f32_16x16x32_bf16 v[204:207], v[212:215], v[116:119], v[204:207]
  v_accvgpr_write_b32 a13, v249
  s_waitcnt lgkmcnt(1)
  v_mfma_f32_16x16x32_bf16 v[196:199], v[216:219], v[120:123], v[196:199]
  v_accvgpr_write_b32 a92, v250
  v_mfma_f32_16x16x32_bf16 v[200:203], v[216:219], v[124:127], v[200:203]
  s_add_u32 m0, s81, 22528
  s_nop 0
  buffer_load_dwordx4 v58, s[12:15], s80 offen lds
  v_mfma_f32_16x16x32_bf16 v[204:207], v[216:219], v[128:131], v[204:207]
  v_accvgpr_write_b32 a93, v251
  s_waitcnt lgkmcnt(0)
  v_mfma_f32_16x16x32_bf16 v[196:199], v[220:223], v[132:135], v[196:199]
  v_cvt_pk_bf16_f32 v150, v192, v193
  v_cvt_pk_bf16_f32 v151, v194, v195
  v_mfma_f32_16x16x32_bf16 v[200:203], v[220:223], v[136:139], v[200:203]
  s_add_u32 m0, s81, 23552
  s_nop 0
  buffer_load_dwordx4 v59, s[12:15], s80 offen lds
  s_add_u32 s80, s80, 393216
  v_mfma_f32_16x16x32_bf16 v[204:207], v[220:223], v[140:143], v[204:207]
  s_waitcnt vmcnt(12)
  ds_read_b128 v[208:211], v70 offset:0
  ds_read_b128 v[212:215], v71 offset:0
  ds_read_b128 v[216:219], v70 offset:128
  s_waitcnt lgkmcnt(2)
  v_mfma_f32_16x16x32_bf16 v[184:187], v[208:211], v[72:75], 0
  ds_read_b128 v[220:223], v71 offset:128
  v_mfma_f32_16x16x32_bf16 v[188:191], v[208:211], v[76:79], 0
  s_add_u32 m0, s81, 24576
  s_nop 0
  buffer_load_dwordx4 v48, s[12:15], s80 offen lds
  v_mfma_f32_16x16x32_bf16 v[192:195], v[208:211], v[80:83], 0
  s_waitcnt lgkmcnt(2)
  v_mfma_f32_16x16x32_bf16 v[184:187], v[212:215], v[84:87], v[184:187]
  ds_read_b128 v[208:211], v70 offset:256
  v_cvt_pk_bf16_f32 v248, v196, v197
  v_mfma_f32_16x16x32_bf16 v[188:191], v[212:215], v[88:91], v[188:191]
  s_add_u32 m0, s81, 25600
  s_nop 0
  buffer_load_dwordx4 v49, s[12:15], s80 offen lds
  v_mfma_f32_16x16x32_bf16 v[192:195], v[212:215], v[92:95], v[192:195]
  v_cvt_pk_bf16_f32 v249, v198, v199
  s_waitcnt lgkmcnt(2)
  v_mfma_f32_16x16x32_bf16 v[184:187], v[216:219], v[96:99], v[184:187]
  ds_read_b128 v[212:215], v71 offset:256
  v_cvt_pk_bf16_f32 v250, v200, v201
  v_mfma_f32_16x16x32_bf16 v[188:191], v[216:219], v[100:103], v[188:191]
  s_add_u32 m0, s81, 26624
  s_nop 0
  buffer_load_dwordx4 v50, s[12:15], s80 offen lds
  v_mfma_f32_16x16x32_bf16 v[192:195], v[216:219], v[104:107], v[192:195]
  v_cvt_pk_bf16_f32 v251, v202, v203
  s_waitcnt lgkmcnt(2)
  v_mfma_f32_16x16x32_bf16 v[184:187], v[220:223], v[108:111], v[184:187]
  ds_read_b128 v[216:219], v70 offset:768
  v_accvgpr_write_b32 a14, v248
  v_mfma_f32_16x16x32_bf16 v[188:191], v[220:223], v[112:115], v[188:191]
  s_add_u32 m0, s81, 27648
  s_nop 0
  buffer_load_dwordx4 v51, s[12:15], s80 offen lds
  v_mfma_f32_16x16x32_bf16 v[192:195], v[220:223], v[116:119], v[192:195]
  v_accvgpr_write_b32 a15, v249
  s_waitcnt lgkmcnt(2)
  v_mfma_f32_16x16x32_bf16 v[184:187], v[208:211], v[120:123], v[184:187]
  ds_read_b128 v[220:223], v71 offset:768
  v_accvgpr_write_b32 a94, v250
  v_mfma_f32_16x16x32_bf16 v[188:191], v[208:211], v[124:127], v[188:191]
  s_add_u32 m0, s81, 28672
  s_nop 0
  buffer_load_dwordx4 v52, s[12:15], s80 offen lds
  v_mfma_f32_16x16x32_bf16 v[192:195], v[208:211], v[128:131], v[192:195]
  v_accvgpr_write_b32 a95, v251
  s_waitcnt lgkmcnt(2)
  v_mfma_f32_16x16x32_bf16 v[184:187], v[212:215], v[132:135], v[184:187]
  ds_read_b128 v[208:211], v70 offset:896
  s_mov_b64 exec, s[68:69]
  v_cvt_pk_bf16_f32 v150, v204, v205
  v_cvt_pk_bf16_f32 v151, v206, v207
  s_mov_b64 exec, -1
  v_mfma_f32_16x16x32_bf16 v[188:191], v[212:215], v[136:139], v[188:191]
  s_add_u32 m0, s81, 29696
  s_nop 0
  buffer_load_dwordx4 v53, s[12:15], s80 offen lds
  v_mfma_f32_16x16x32_bf16 v[192:195], v[212:215], v[140:143], v[192:195]
  s_waitcnt lgkmcnt(2)
  v_mfma_f32_16x16x32_bf16 v[196:199], v[216:219], v[72:75], 0
  ds_read_b128 v[212:215], v71 offset:896
  v_mfma_f32_16x16x32_bf16 v[200:203], v[216:219], v[76:79], 0
  s_add_u32 m0, s81, 30720
  s_nop 0
  buffer_load_dwordx4 v54, s[12:15], s80 offen lds
  v_mfma_f32_16x16x32_bf16 v[204:207], v[216:219], v[80:83], 0
  s_waitcnt lgkmcnt(2)
  v_mfma_f32_16x16x32_bf16 v[196:199], v[220:223], v[84:87], v[196:199]
  ds_read_b128 v[216:219], v70 offset:1024
  v_cvt_pk_bf16_f32 v248, v184, v185
  v_mfma_f32_16x16x32_bf16 v[200:203], v[220:223], v[88:91], v[200:203]
  s_add_u32 m0, s81, 31744
  s_nop 0
  buffer_load_dwordx4 v55, s[12:15], s80 offen lds
  v_mfma_f32_16x16x32_bf16 v[204:207], v[220:223], v[92:95], v[204:207]
  v_cvt_pk_bf16_f32 v249, v186, v187
  s_waitcnt lgkmcnt(2)
  v_mfma_f32_16x16x32_bf16 v[196:199], v[208:211], v[96:99], v[196:199]
  ds_read_b128 v[220:223], v71 offset:1024
  v_cvt_pk_bf16_f32 v250, v188, v189
  v_mfma_f32_16x16x32_bf16 v[200:203], v[208:211], v[100:103], v[200:203]
  s_add_u32 m0, s81, 32768
  s_nop 0
  buffer_load_dwordx4 v56, s[12:15], s80 offen lds
  v_mfma_f32_16x16x32_bf16 v[204:207], v[208:211], v[104:107], v[204:207]
  v_cvt_pk_bf16_f32 v251, v190, v191
  s_waitcnt lgkmcnt(2)
  v_mfma_f32_16x16x32_bf16 v[196:199], v[212:215], v[108:111], v[196:199]
  v_accvgpr_write_b32 a16, v248
  v_mfma_f32_16x16x32_bf16 v[200:203], v[212:215], v[112:115], v[200:203]
  s_add_u32 m0, s81, 33792
  s_nop 0
  buffer_load_dwordx4 v57, s[12:15], s80 offen lds
  v_mfma_f32_16x16x32_bf16 v[204:207], v[212:215], v[116:119], v[204:207]
  v_accvgpr_write_b32 a17, v249
  s_waitcnt lgkmcnt(1)
  v_mfma_f32_16x16x32_bf16 v[196:199], v[216:219], v[120:123], v[196:199]
  v_accvgpr_write_b32 a96, v250
  v_mfma_f32_16x16x32_bf16 v[200:203], v[216:219], v[124:127], v[200:203]
  s_add_u32 m0, s81, 34816
  s_nop 0
  buffer_load_dwordx4 v58, s[12:15], s80 offen lds
  v_mfma_f32_16x16x32_bf16 v[204:207], v[216:219], v[128:131], v[204:207]
  v_accvgpr_write_b32 a97, v251
  s_waitcnt lgkmcnt(0)
  v_mfma_f32_16x16x32_bf16 v[196:199], v[220:223], v[132:135], v[196:199]
  v_cvt_pk_bf16_f32 v152, v192, v193
  v_cvt_pk_bf16_f32 v153, v194, v195
  v_mfma_f32_16x16x32_bf16 v[200:203], v[220:223], v[136:139], v[200:203]
  s_add_u32 m0, s81, 35840
  s_nop 0
  buffer_load_dwordx4 v59, s[12:15], s80 offen lds
  s_add_u32 s80, s80, 393216
  v_mfma_f32_16x16x32_bf16 v[204:207], v[220:223], v[140:143], v[204:207]
  s_waitcnt vmcnt(12)
  ds_read_b128 v[208:211], v70 offset:12288
  ds_read_b128 v[212:215], v71 offset:12288
  ds_read_b128 v[216:219], v70 offset:12416
  s_waitcnt lgkmcnt(2)
  v_mfma_f32_16x16x32_bf16 v[184:187], v[208:211], v[72:75], 0
  ds_read_b128 v[220:223], v71 offset:12416
  v_mfma_f32_16x16x32_bf16 v[188:191], v[208:211], v[76:79], 0
  s_add_u32 m0, s81, 0
  s_nop 0
  buffer_load_dwordx4 v48, s[12:15], s80 offen lds
  v_mfma_f32_16x16x32_bf16 v[192:195], v[208:211], v[80:83], 0
  s_waitcnt lgkmcnt(2)
  v_mfma_f32_16x16x32_bf16 v[184:187], v[212:215], v[84:87], v[184:187]
  ds_read_b128 v[208:211], v70 offset:12544
  v_cvt_pk_bf16_f32 v248, v196, v197
  v_mfma_f32_16x16x32_bf16 v[188:191], v[212:215], v[88:91], v[188:191]
  s_add_u32 m0, s81, 1024
  s_nop 0
  buffer_load_dwordx4 v49, s[12:15], s80 offen lds
  v_mfma_f32_16x16x32_bf16 v[192:195], v[212:215], v[92:95], v[192:195]
  v_cvt_pk_bf16_f32 v249, v198, v199
  s_waitcnt lgkmcnt(2)
  v_mfma_f32_16x16x32_bf16 v[184:187], v[216:219], v[96:99], v[184:187]
  ds_read_b128 v[212:215], v71 offset:12544
  v_cvt_pk_bf16_f32 v250, v200, v201
  v_mfma_f32_16x16x32_bf16 v[188:191], v[216:219], v[100:103], v[188:191]
  s_add_u32 m0, s81, 2048
  s_nop 0
  buffer_load_dwordx4 v50, s[12:15], s80 offen lds
  v_mfma_f32_16x16x32_bf16 v[192:195], v[216:219], v[104:107], v[192:195]
  v_cvt_pk_bf16_f32 v251, v202, v203
  s_waitcnt lgkmcnt(2)
  v_mfma_f32_16x16x32_bf16 v[184:187], v[220:223], v[108:111], v[184:187]
  ds_read_b128 v[216:219], v70 offset:13056
  v_accvgpr_write_b32 a18, v248
  v_mfma_f32_16x16x32_bf16 v[188:191], v[220:223], v[112:115], v[188:191]
  s_add_u32 m0, s81, 3072
  s_nop 0
  buffer_load_dwordx4 v51, s[12:15], s80 offen lds
  v_mfma_f32_16x16x32_bf16 v[192:195], v[220:223], v[116:119], v[192:195]
  v_accvgpr_write_b32 a19, v249
  s_waitcnt lgkmcnt(2)
  v_mfma_f32_16x16x32_bf16 v[184:187], v[208:211], v[120:123], v[184:187]
  ds_read_b128 v[220:223], v71 offset:13056
  v_accvgpr_write_b32 a98, v250
  v_mfma_f32_16x16x32_bf16 v[188:191], v[208:211], v[124:127], v[188:191]
  s_add_u32 m0, s81, 4096
  s_nop 0
  buffer_load_dwordx4 v52, s[12:15], s80 offen lds
  v_mfma_f32_16x16x32_bf16 v[192:195], v[208:211], v[128:131], v[192:195]
  v_accvgpr_write_b32 a99, v251
  s_waitcnt lgkmcnt(2)
  v_mfma_f32_16x16x32_bf16 v[184:187], v[212:215], v[132:135], v[184:187]
  ds_read_b128 v[208:211], v70 offset:13184
  s_mov_b64 exec, s[68:69]
  v_cvt_pk_bf16_f32 v152, v204, v205
  v_cvt_pk_bf16_f32 v153, v206, v207
  s_mov_b64 exec, -1
  v_mfma_f32_16x16x32_bf16 v[188:191], v[212:215], v[136:139], v[188:191]
  s_add_u32 m0, s81, 5120
  s_nop 0
  buffer_load_dwordx4 v53, s[12:15], s80 offen lds
  v_mfma_f32_16x16x32_bf16 v[192:195], v[212:215], v[140:143], v[192:195]
  s_waitcnt lgkmcnt(2)
  v_mfma_f32_16x16x32_bf16 v[196:199], v[216:219], v[72:75], 0
  ds_read_b128 v[212:215], v71 offset:13184
  v_mfma_f32_16x16x32_bf16 v[200:203], v[216:219], v[76:79], 0
  s_add_u32 m0, s81, 6144
  s_nop 0
  buffer_load_dwordx4 v54, s[12:15], s80 offen lds
  v_mfma_f32_16x16x32_bf16 v[204:207], v[216:219], v[80:83], 0
  s_waitcnt lgkmcnt(2)
  v_mfma_f32_16x16x32_bf16 v[196:199], v[220:223], v[84:87], v[196:199]
  ds_read_b128 v[216:219], v70 offset:13312
  v_cvt_pk_bf16_f32 v248, v184, v185
  v_mfma_f32_16x16x32_bf16 v[200:203], v[220:223], v[88:91], v[200:203]
  s_add_u32 m0, s81, 7168
  s_nop 0
  buffer_load_dwordx4 v55, s[12:15], s80 offen lds
  v_mfma_f32_16x16x32_bf16 v[204:207], v[220:223], v[92:95], v[204:207]
  v_cvt_pk_bf16_f32 v249, v186, v187
  s_waitcnt lgkmcnt(2)
  v_mfma_f32_16x16x32_bf16 v[196:199], v[208:211], v[96:99], v[196:199]
  ds_read_b128 v[220:223], v71 offset:13312
  v_cvt_pk_bf16_f32 v250, v188, v189
  v_mfma_f32_16x16x32_bf16 v[200:203], v[208:211], v[100:103], v[200:203]
  s_add_u32 m0, s81, 8192
  s_nop 0
  buffer_load_dwordx4 v56, s[12:15], s80 offen lds
  v_mfma_f32_16x16x32_bf16 v[204:207], v[208:211], v[104:107], v[204:207]
  v_cvt_pk_bf16_f32 v251, v190, v191
  s_waitcnt lgkmcnt(2)
  v_mfma_f32_16x16x32_bf16 v[196:199], v[212:215], v[108:111], v[196:199]
  v_accvgpr_write_b32 a20, v248
  v_mfma_f32_16x16x32_bf16 v[200:203], v[212:215], v[112:115], v[200:203]
  s_add_u32 m0, s81, 9216
  s_nop 0
  buffer_load_dwordx4 v57, s[12:15], s80 offen lds
  v_mfma_f32_16x16x32_bf16 v[204:207], v[212:215], v[116:119], v[204:207]
  v_accvgpr_write_b32 a21, v249
  s_waitcnt lgkmcnt(1)
  v_mfma_f32_16x16x32_bf16 v[196:199], v[216:219], v[120:123], v[196:199]
  v_accvgpr_write_b32 a100, v250
  v_mfma_f32_16x16x32_bf16 v[200:203], v[216:219], v[124:127], v[200:203]
  s_add_u32 m0, s81, 10240
  s_nop 0
  buffer_load_dwordx4 v58, s[12:15], s80 offen lds
  v_mfma_f32_16x16x32_bf16 v[204:207], v[216:219], v[128:131], v[204:207]
  v_accvgpr_write_b32 a101, v251
  s_waitcnt lgkmcnt(0)
  v_mfma_f32_16x16x32_bf16 v[196:199], v[220:223], v[132:135], v[196:199]
  v_cvt_pk_bf16_f32 v154, v192, v193
  v_cvt_pk_bf16_f32 v155, v194, v195
  v_mfma_f32_16x16x32_bf16 v[200:203], v[220:223], v[136:139], v[200:203]
  s_add_u32 m0, s81, 11264
  s_nop 0
  buffer_load_dwordx4 v59, s[12:15], s80 offen lds
  s_add_u32 s80, s80, 393216
  v_mfma_f32_16x16x32_bf16 v[204:207], v[220:223], v[140:143], v[204:207]
  s_add_u32 s21, s79, 0
  buffer_load_dwordx4 a[172:175], v63, s[28:31], s21 offen
  s_add_u32 s21, s79, 0
  buffer_load_dwordx4 a[176:179], v64, s[28:31], s21 offen
  s_add_u32 s21, s79, 0
  buffer_load_dwordx4 a[180:183], v65, s[28:31], s21 offen
  s_waitcnt vmcnt(15)
  ds_read_b128 v[208:211], v70 offset:24576
  ds_read_b128 v[212:215], v71 offset:24576
  ds_read_b128 v[216:219], v70 offset:24704
  s_waitcnt lgkmcnt(2)
  v_mfma_f32_16x16x32_bf16 v[184:187], v[208:211], v[72:75], 0
  ds_read_b128 v[220:223], v71 offset:24704
  v_mfma_f32_16x16x32_bf16 v[188:191], v[208:211], v[76:79], 0
  s_add_u32 m0, s81, 12288
  s_nop 0
  buffer_load_dwordx4 v48, s[12:15], s80 offen lds
  v_mfma_f32_16x16x32_bf16 v[192:195], v[208:211], v[80:83], 0
  s_waitcnt lgkmcnt(2)
  v_mfma_f32_16x16x32_bf16 v[184:187], v[212:215], v[84:87], v[184:187]
  ds_read_b128 v[208:211], v70 offset:24832
  v_cvt_pk_bf16_f32 v248, v196, v197
  v_mfma_f32_16x16x32_bf16 v[188:191], v[212:215], v[88:91], v[188:191]
  s_add_u32 m0, s81, 13312
  s_nop 0
  buffer_load_dwordx4 v49, s[12:15], s80 offen lds
  v_mfma_f32_16x16x32_bf16 v[192:195], v[212:215], v[92:95], v[192:195]
  v_cvt_pk_bf16_f32 v249, v198, v199
  s_waitcnt lgkmcnt(2)
  v_mfma_f32_16x16x32_bf16 v[184:187], v[216:219], v[96:99], v[184:187]
  ds_read_b128 v[212:215], v71 offset:24832
  v_cvt_pk_bf16_f32 v250, v200, v201
  v_mfma_f32_16x16x32_bf16 v[188:191], v[216:219], v[100:103], v[188:191]
  s_add_u32 m0, s81, 14336
  s_nop 0
  buffer_load_dwordx4 v50, s[12:15], s80 offen lds
  v_mfma_f32_16x16x32_bf16 v[192:195], v[216:219], v[104:107], v[192:195]
  v_cvt_pk_bf16_f32 v251, v202, v203
  s_waitcnt lgkmcnt(2)
  v_mfma_f32_16x16x32_bf16 v[184:187], v[220:223], v[108:111], v[184:187]
  ds_read_b128 v[216:219], v70 offset:25344
  v_accvgpr_write_b32 a22, v248
  v_mfma_f32_16x16x32_bf16 v[188:191], v[220:223], v[112:115], v[188:191]
  s_add_u32 m0, s81, 15360
  s_nop 0
  buffer_load_dwordx4 v51, s[12:15], s80 offen lds
  v_mfma_f32_16x16x32_bf16 v[192:195], v[220:223], v[116:119], v[192:195]
  v_accvgpr_write_b32 a23, v249
  s_waitcnt lgkmcnt(2)
  v_mfma_f32_16x16x32_bf16 v[184:187], v[208:211], v[120:123], v[184:187]
  ds_read_b128 v[220:223], v71 offset:25344
  v_accvgpr_write_b32 a102, v250
  v_mfma_f32_16x16x32_bf16 v[188:191], v[208:211], v[124:127], v[188:191]
  s_add_u32 m0, s81, 16384
  s_nop 0
  buffer_load_dwordx4 v52, s[12:15], s80 offen lds
  v_mfma_f32_16x16x32_bf16 v[192:195], v[208:211], v[128:131], v[192:195]
  v_accvgpr_write_b32 a103, v251
  s_waitcnt lgkmcnt(2)
  v_mfma_f32_16x16x32_bf16 v[184:187], v[212:215], v[132:135], v[184:187]
  ds_read_b128 v[208:211], v70 offset:25472
  s_mov_b64 exec, s[68:69]
  v_cvt_pk_bf16_f32 v154, v204, v205
  v_cvt_pk_bf16_f32 v155, v206, v207
  s_mov_b64 exec, -1
  v_mfma_f32_16x16x32_bf16 v[188:191], v[212:215], v[136:139], v[188:191]
  s_add_u32 m0, s81, 17408
  s_nop 0
  buffer_load_dwordx4 v53, s[12:15], s80 offen lds
  v_mfma_f32_16x16x32_bf16 v[192:195], v[212:215], v[140:143], v[192:195]
  s_waitcnt lgkmcnt(2)
  v_mfma_f32_16x16x32_bf16 v[196:199], v[216:219], v[72:75], 0
  ds_read_b128 v[212:215], v71 offset:25472
  v_mfma_f32_16x16x32_bf16 v[200:203], v[216:219], v[76:79], 0
  s_add_u32 m0, s81, 18432
  s_nop 0
  buffer_load_dwordx4 v54, s[12:15], s80 offen lds
  v_mfma_f32_16x16x32_bf16 v[204:207], v[216:219], v[80:83], 0
  s_waitcnt lgkmcnt(2)
  v_mfma_f32_16x16x32_bf16 v[196:199], v[220:223], v[84:87], v[196:199]
  ds_read_b128 v[216:219], v70 offset:25600
  v_cvt_pk_bf16_f32 v248, v184, v185
  v_mfma_f32_16x16x32_bf16 v[200:203], v[220:223], v[88:91], v[200:203]
  s_add_u32 m0, s81, 19456
  s_nop 0
  buffer_load_dwordx4 v55, s[12:15], s80 offen lds
  v_mfma_f32_16x16x32_bf16 v[204:207], v[220:223], v[92:95], v[204:207]
  v_cvt_pk_bf16_f32 v249, v186, v187
  s_waitcnt lgkmcnt(2)
  v_mfma_f32_16x16x32_bf16 v[196:199], v[208:211], v[96:99], v[196:199]
  ds_read_b128 v[220:223], v71 offset:25600
  v_cvt_pk_bf16_f32 v250, v188, v189
  v_mfma_f32_16x16x32_bf16 v[200:203], v[208:211], v[100:103], v[200:203]
  s_add_u32 m0, s81, 20480
  s_nop 0
  buffer_load_dwordx4 v56, s[12:15], s80 offen lds
  v_mfma_f32_16x16x32_bf16 v[204:207], v[208:211], v[104:107], v[204:207]
  v_cvt_pk_bf16_f32 v251, v190, v191
  s_waitcnt lgkmcnt(2)
  v_mfma_f32_16x16x32_bf16 v[196:199], v[212:215], v[108:111], v[196:199]
  v_accvgpr_write_b32 a24, v248
  v_mfma_f32_16x16x32_bf16 v[200:203], v[212:215], v[112:115], v[200:203]
  s_add_u32 m0, s81, 21504
  s_nop 0
  buffer_load_dwordx4 v57, s[12:15], s80 offen lds
  v_mfma_f32_16x16x32_bf16 v[204:207], v[212:215], v[116:119], v[204:207]
  v_accvgpr_write_b32 a25, v249
  s_waitcnt lgkmcnt(1)
  v_mfma_f32_16x16x32_bf16 v[196:199], v[216:219], v[120:123], v[196:199]
  v_accvgpr_write_b32 a104, v250
  v_mfma_f32_16x16x32_bf16 v[200:203], v[216:219], v[124:127], v[200:203]
  s_add_u32 m0, s81, 22528
  s_nop 0
  buffer_load_dwordx4 v58, s[12:15], s80 offen lds
  v_mfma_f32_16x16x32_bf16 v[204:207], v[216:219], v[128:131], v[204:207]
  v_accvgpr_write_b32 a105, v251
  s_waitcnt lgkmcnt(0)
  v_mfma_f32_16x16x32_bf16 v[196:199], v[220:223], v[132:135], v[196:199]
  v_cvt_pk_bf16_f32 v156, v192, v193
  v_cvt_pk_bf16_f32 v157, v194, v195
  v_mfma_f32_16x16x32_bf16 v[200:203], v[220:223], v[136:139], v[200:203]
  s_add_u32 m0, s81, 23552
  s_nop 0
  buffer_load_dwordx4 v59, s[12:15], s80 offen lds
  s_add_u32 s80, s80, 393216
  v_mfma_f32_16x16x32_bf16 v[204:207], v[220:223], v[140:143], v[204:207]
  s_add_u32 s21, s79, 393216
  buffer_load_dwordx4 a[196:199], v63, s[28:31], s21 offen
  s_add_u32 s21, s79, 393216
  buffer_load_dwordx4 a[200:203], v64, s[28:31], s21 offen
  s_add_u32 s21, s79, 393216
  buffer_load_dwordx4 a[204:207], v65, s[28:31], s21 offen
  s_waitcnt vmcnt(18)
  ds_read_b128 v[208:211], v70 offset:0
  ds_read_b128 v[212:215], v71 offset:0
  ds_read_b128 v[216:219], v70 offset:128
  s_waitcnt lgkmcnt(2)
  v_mfma_f32_16x16x32_bf16 v[184:187], v[208:211], v[72:75], 0
  ds_read_b128 v[220:223], v71 offset:128
  v_mfma_f32_16x16x32_bf16 v[188:191], v[208:211], v[76:79], 0
  s_add_u32 m0, s81, 24576
  s_nop 0
  buffer_load_dwordx4 v48, s[12:15], s80 offen lds
  v_mfma_f32_16x16x32_bf16 v[192:195], v[208:211], v[80:83], 0
  s_waitcnt lgkmcnt(2)
  v_mfma_f32_16x16x32_bf16 v[184:187], v[212:215], v[84:87], v[184:187]
  ds_read_b128 v[208:211], v70 offset:256
  v_cvt_pk_bf16_f32 v248, v196, v197
  v_mfma_f32_16x16x32_bf16 v[188:191], v[212:215], v[88:91], v[188:191]
  s_add_u32 m0, s81, 25600
  s_nop 0
  buffer_load_dwordx4 v49, s[12:15], s80 offen lds
  v_mfma_f32_16x16x32_bf16 v[192:195], v[212:215], v[92:95], v[192:195]
  v_cvt_pk_bf16_f32 v249, v198, v199
  s_waitcnt lgkmcnt(2)
  v_mfma_f32_16x16x32_bf16 v[184:187], v[216:219], v[96:99], v[184:187]
  ds_read_b128 v[212:215], v71 offset:256
  v_cvt_pk_bf16_f32 v250, v200, v201
  v_mfma_f32_16x16x32_bf16 v[188:191], v[216:219], v[100:103], v[188:191]
  s_add_u32 m0, s81, 26624
  s_nop 0
  buffer_load_dwordx4 v50, s[12:15], s80 offen lds
  v_mfma_f32_16x16x32_bf16 v[192:195], v[216:219], v[104:107], v[192:195]
  v_cvt_pk_bf16_f32 v251, v202, v203
  s_waitcnt lgkmcnt(2)
  v_mfma_f32_16x16x32_bf16 v[184:187], v[220:223], v[108:111], v[184:187]
  ds_read_b128 v[216:219], v70 offset:768
  v_accvgpr_write_b32 a26, v248
  v_mfma_f32_16x16x32_bf16 v[188:191], v[220:223], v[112:115], v[188:191]
  s_add_u32 m0, s81, 27648
  s_nop 0
  buffer_load_dwordx4 v51, s[12:15], s80 offen lds
  v_mfma_f32_16x16x32_bf16 v[192:195], v[220:223], v[116:119], v[192:195]
  v_accvgpr_write_b32 a27, v249
  s_waitcnt lgkmcnt(2)
  v_mfma_f32_16x16x32_bf16 v[184:187], v[208:211], v[120:123], v[184:187]
  ds_read_b128 v[220:223], v71 offset:768
  v_accvgpr_write_b32 a106, v250
  v_mfma_f32_16x16x32_bf16 v[188:191], v[208:211], v[124:127], v[188:191]
  s_add_u32 m0, s81, 28672
  s_nop 0
  buffer_load_dwordx4 v52, s[12:15], s80 offen lds
  v_mfma_f32_16x16x32_bf16 v[192:195], v[208:211], v[128:131], v[192:195]
  v_accvgpr_write_b32 a107, v251
  s_waitcnt lgkmcnt(2)
  v_mfma_f32_16x16x32_bf16 v[184:187], v[212:215], v[132:135], v[184:187]
  ds_read_b128 v[208:211], v70 offset:896
  s_mov_b64 exec, s[68:69]
  v_cvt_pk_bf16_f32 v156, v204, v205
  v_cvt_pk_bf16_f32 v157, v206, v207
  s_mov_b64 exec, -1
  v_mfma_f32_16x16x32_bf16 v[188:191], v[212:215], v[136:139], v[188:191]
  s_add_u32 m0, s81, 29696
  s_nop 0
  buffer_load_dwordx4 v53, s[12:15], s80 offen lds
  v_mfma_f32_16x16x32_bf16 v[192:195], v[212:215], v[140:143], v[192:195]
  s_waitcnt lgkmcnt(2)
  v_mfma_f32_16x16x32_bf16 v[196:199], v[216:219], v[72:75], 0
  ds_read_b128 v[212:215], v71 offset:896
  v_mfma_f32_16x16x32_bf16 v[200:203], v[216:219], v[76:79], 0
  s_add_u32 m0, s81, 30720
  s_nop 0
  buffer_load_dwordx4 v54, s[12:15], s80 offen lds
  v_mfma_f32_16x16x32_bf16 v[204:207], v[216:219], v[80:83], 0
  s_waitcnt lgkmcnt(2)
  v_mfma_f32_16x16x32_bf16 v[196:199], v[220:223], v[84:87], v[196:199]
  ds_read_b128 v[216:219], v70 offset:1024
  v_cvt_pk_bf16_f32 v248, v184, v185
  v_mfma_f32_16x16x32_bf16 v[200:203], v[220:223], v[88:91], v[200:203]
  s_add_u32 m0, s81, 31744
  s_nop 0
  buffer_load_dwordx4 v55, s[12:15], s80 offen lds
  v_mfma_f32_16x16x32_bf16 v[204:207], v[220:223], v[92:95], v[204:207]
  v_cvt_pk_bf16_f32 v249, v186, v187
  s_waitcnt lgkmcnt(2)
  v_mfma_f32_16x16x32_bf16 v[196:199], v[208:211], v[96:99], v[196:199]
  ds_read_b128 v[220:223], v71 offset:1024
  v_cvt_pk_bf16_f32 v250, v188, v189
  v_mfma_f32_16x16x32_bf16 v[200:203], v[208:211], v[100:103], v[200:203]
  s_add_u32 m0, s81, 32768
  s_nop 0
  buffer_load_dwordx4 v56, s[12:15], s80 offen lds
  v_mfma_f32_16x16x32_bf16 v[204:207], v[208:211], v[104:107], v[204:207]
  v_cvt_pk_bf16_f32 v251, v190, v191
  s_waitcnt lgkmcnt(2)
  v_mfma_f32_16x16x32_bf16 v[196:199], v[212:215], v[108:111], v[196:199]
  v_accvgpr_write_b32 a28, v248
  v_mfma_f32_16x16x32_bf16 v[200:203], v[212:215], v[112:115], v[200:203]
  s_add_u32 m0, s81, 33792
  s_nop 0
  buffer_load_dwordx4 v57, s[12:15], s80 offen lds
  v_mfma_f32_16x16x32_bf16 v[204:207], v[212:215], v[116:119], v[204:207]
  v_accvgpr_write_b32 a29, v249
  s_waitcnt lgkmcnt(1)
  v_mfma_f32_16x16x32_bf16 v[196:199], v[216:219], v[120:123], v[196:199]
  v_accvgpr_write_b32 a108, v250
  v_mfma_f32_16x16x32_bf16 v[200:203], v[216:219], v[124:127], v[200:203]
  s_add_u32 m0, s81, 34816
  s_nop 0
  buffer_load_dwordx4 v58, s[12:15], s80 offen lds
  v_mfma_f32_16x16x32_bf16 v[204:207], v[216:219], v[128:131], v[204:207]
  v_accvgpr_write_b32 a109, v251
  s_waitcnt lgkmcnt(0)
  v_mfma_f32_16x16x32_bf16 v[196:199], v[220:223], v[132:135], v[196:199]
  v_cvt_pk_bf16_f32 v158, v192, v193
  v_cvt_pk_bf16_f32 v159, v194, v195
  v_mfma_f32_16x16x32_bf16 v[200:203], v[220:223], v[136:139], v[200:203]
  s_add_u32 m0, s81, 35840
  s_nop 0
  buffer_load_dwordx4 v59, s[12:15], s80 offen lds
  s_add_u32 s80, s80, 393216
  v_mfma_f32_16x16x32_bf16 v[204:207], v[220:223], v[140:143], v[204:207]
  s_add_u32 s21, s79, 786432
  buffer_load_dwordx4 a[220:223], v63, s[28:31], s21 offen
  s_add_u32 s21, s79, 786432
  buffer_load_dwordx4 a[224:227], v64, s[28:31], s21 offen
  s_add_u32 s21, s79, 786432
  buffer_load_dwordx4 a[228:231], v65, s[28:31], s21 offen
  s_waitcnt vmcnt(18)
  ds_read_b128 v[208:211], v70 offset:12288
  ds_read_b128 v[212:215], v71 offset:12288
  ds_read_b128 v[216:219], v70 offset:12416
  s_waitcnt lgkmcnt(2)
  v_mfma_f32_16x16x32_bf16 v[184:187], v[208:211], v[72:75], 0
  ds_read_b128 v[220:223], v71 offset:12416
  v_mfma_f32_16x16x32_bf16 v[188:191], v[208:211], v[76:79], 0
  s_add_u32 m0, s81, 0
  s_nop 0
  buffer_load_dwordx4 v48, s[12:15], s80 offen lds
  v_mfma_f32_16x16x32_bf16 v[192:195], v[208:211], v[80:83], 0
  s_waitcnt lgkmcnt(2)
  v_mfma_f32_16x16x32_bf16 v[184:187], v[212:215], v[84:87], v[184:187]
  ds_read_b128 v[208:211], v70 offset:12544
  v_cvt_pk_bf16_f32 v248, v196, v197
  v_mfma_f32_16x16x32_bf16 v[188:191], v[212:215], v[88:91], v[188:191]
  s_add_u32 m0, s81, 1024
  s_nop 0
  buffer_load_dwordx4 v49, s[12:15], s80 offen lds
  v_mfma_f32_16x16x32_bf16 v[192:195], v[212:215], v[92:95], v[192:195]
  v_cvt_pk_bf16_f32 v249, v198, v199
  s_waitcnt lgkmcnt(2)
  v_mfma_f32_16x16x32_bf16 v[184:187], v[216:219], v[96:99], v[184:187]
  ds_read_b128 v[212:215], v71 offset:12544
  v_cvt_pk_bf16_f32 v250, v200, v201
  v_mfma_f32_16x16x32_bf16 v[188:191], v[216:219], v[100:103], v[188:191]
  s_add_u32 m0, s81, 2048
  s_nop 0
  buffer_load_dwordx4 v50, s[12:15], s80 offen lds
  v_mfma_f32_16x16x32_bf16 v[192:195], v[216:219], v[104:107], v[192:195]
  v_cvt_pk_bf16_f32 v251, v202, v203
  s_waitcnt lgkmcnt(2)
  v_mfma_f32_16x16x32_bf16 v[184:187], v[220:223], v[108:111], v[184:187]
  ds_read_b128 v[216:219], v70 offset:13056
  v_accvgpr_write_b32 a30, v248
  v_mfma_f32_16x16x32_bf16 v[188:191], v[220:223], v[112:115], v[188:191]
  s_add_u32 m0, s81, 3072
  s_nop 0
  buffer_load_dwordx4 v51, s[12:15], s80 offen lds
  v_mfma_f32_16x16x32_bf16 v[192:195], v[220:223], v[116:119], v[192:195]
  v_accvgpr_write_b32 a31, v249
  s_waitcnt lgkmcnt(2)
  v_mfma_f32_16x16x32_bf16 v[184:187], v[208:211], v[120:123], v[184:187]
  ds_read_b128 v[220:223], v71 offset:13056
  v_accvgpr_write_b32 a110, v250
  v_mfma_f32_16x16x32_bf16 v[188:191], v[208:211], v[124:127], v[188:191]
  s_add_u32 m0, s81, 4096
  s_nop 0
  buffer_load_dwordx4 v52, s[12:15], s80 offen lds
  v_mfma_f32_16x16x32_bf16 v[192:195], v[208:211], v[128:131], v[192:195]
  v_accvgpr_write_b32 a111, v251
  s_waitcnt lgkmcnt(2)
  v_mfma_f32_16x16x32_bf16 v[184:187], v[212:215], v[132:135], v[184:187]
  ds_read_b128 v[208:211], v70 offset:13184
  s_mov_b64 exec, s[68:69]
  v_cvt_pk_bf16_f32 v158, v204, v205
  v_cvt_pk_bf16_f32 v159, v206, v207
  s_mov_b64 exec, -1
  v_mfma_f32_16x16x32_bf16 v[188:191], v[212:215], v[136:139], v[188:191]
  s_add_u32 m0, s81, 5120
  s_nop 0
  buffer_load_dwordx4 v53, s[12:15], s80 offen lds
  v_mfma_f32_16x16x32_bf16 v[192:195], v[212:215], v[140:143], v[192:195]
  s_waitcnt lgkmcnt(2)
  v_mfma_f32_16x16x32_bf16 v[196:199], v[216:219], v[72:75], 0
  ds_read_b128 v[212:215], v71 offset:13184
  v_mfma_f32_16x16x32_bf16 v[200:203], v[216:219], v[76:79], 0
  s_add_u32 m0, s81, 6144
  s_nop 0
  buffer_load_dwordx4 v54, s[12:15], s80 offen lds
  v_mfma_f32_16x16x32_bf16 v[204:207], v[216:219], v[80:83], 0
  s_waitcnt lgkmcnt(2)
  v_mfma_f32_16x16x32_bf16 v[196:199], v[220:223], v[84:87], v[196:199]
  ds_read_b128 v[216:219], v70 offset:13312
  v_cvt_pk_bf16_f32 v248, v184, v185
  v_mfma_f32_16x16x32_bf16 v[200:203], v[220:223], v[88:91], v[200:203]
  s_add_u32 m0, s81, 7168
  s_nop 0
  buffer_load_dwordx4 v55, s[12:15], s80 offen lds
  v_mfma_f32_16x16x32_bf16 v[204:207], v[220:223], v[92:95], v[204:207]
  v_cvt_pk_bf16_f32 v249, v186, v187
  s_waitcnt lgkmcnt(2)
  v_mfma_f32_16x16x32_bf16 v[196:199], v[208:211], v[96:99], v[196:199]
  ds_read_b128 v[220:223], v71 offset:13312
  v_cvt_pk_bf16_f32 v250, v188, v189
  v_mfma_f32_16x16x32_bf16 v[200:203], v[208:211], v[100:103], v[200:203]
  s_add_u32 m0, s81, 8192
  s_nop 0
  buffer_load_dwordx4 v56, s[12:15], s80 offen lds
  v_mfma_f32_16x16x32_bf16 v[204:207], v[208:211], v[104:107], v[204:207]
  v_cvt_pk_bf16_f32 v251, v190, v191
  s_waitcnt lgkmcnt(2)
  v_mfma_f32_16x16x32_bf16 v[196:199], v[212:215], v[108:111], v[196:199]
  v_accvgpr_write_b32 a32, v248
  v_mfma_f32_16x16x32_bf16 v[200:203], v[212:215], v[112:115], v[200:203]
  s_add_u32 m0, s81, 9216
  s_nop 0
  buffer_load_dwordx4 v57, s[12:15], s80 offen lds
  v_mfma_f32_16x16x32_bf16 v[204:207], v[212:215], v[116:119], v[204:207]
  v_accvgpr_write_b32 a33, v249
  s_waitcnt lgkmcnt(1)
  v_mfma_f32_16x16x32_bf16 v[196:199], v[216:219], v[120:123], v[196:199]
  v_accvgpr_write_b32 a112, v250
  v_mfma_f32_16x16x32_bf16 v[200:203], v[216:219], v[124:127], v[200:203]
  s_add_u32 m0, s81, 10240
  s_nop 0
  buffer_load_dwordx4 v58, s[12:15], s80 offen lds
  v_mfma_f32_16x16x32_bf16 v[204:207], v[216:219], v[128:131], v[204:207]
  v_accvgpr_write_b32 a113, v251
  s_waitcnt lgkmcnt(0)
  v_mfma_f32_16x16x32_bf16 v[196:199], v[220:223], v[132:135], v[196:199]
  v_cvt_pk_bf16_f32 v160, v192, v193
  v_cvt_pk_bf16_f32 v161, v194, v195
  v_mfma_f32_16x16x32_bf16 v[200:203], v[220:223], v[136:139], v[200:203]
  s_add_u32 m0, s81, 11264
  s_nop 0
  buffer_load_dwordx4 v59, s[12:15], s80 offen lds
  s_add_u32 s80, s80, 393216
  v_mfma_f32_16x16x32_bf16 v[204:207], v[220:223], v[140:143], v[204:207]
  s_add_u32 s21, s79, 1179648
  buffer_load_dwordx4 a[244:247], v63, s[28:31], s21 offen
  s_add_u32 s21, s79, 1179648
  buffer_load_dwordx4 a[248:251], v64, s[28:31], s21 offen
  s_add_u32 s21, s79, 1179648
  buffer_load_dwordx4 a[252:255], v65, s[28:31], s21 offen
  s_waitcnt vmcnt(18)
  ds_read_b128 v[208:211], v70 offset:24576
  ds_read_b128 v[212:215], v71 offset:24576
  ds_read_b128 v[216:219], v70 offset:24704
  s_waitcnt lgkmcnt(2)
  v_mfma_f32_16x16x32_bf16 v[184:187], v[208:211], v[72:75], 0
  ds_read_b128 v[220:223], v71 offset:24704
  v_mfma_f32_16x16x32_bf16 v[188:191], v[208:211], v[76:79], 0
  s_add_u32 m0, s81, 12288
  s_nop 0
  buffer_load_dwordx4 v48, s[12:15], s80 offen lds
  v_mfma_f32_16x16x32_bf16 v[192:195], v[208:211], v[80:83], 0
  s_waitcnt lgkmcnt(2)
  v_mfma_f32_16x16x32_bf16 v[184:187], v[212:215], v[84:87], v[184:187]
  ds_read_b128 v[208:211], v70 offset:24832
  v_cvt_pk_bf16_f32 v248, v196, v197
  v_mfma_f32_16x16x32_bf16 v[188:191], v[212:215], v[88:91], v[188:191]
  s_add_u32 m0, s81, 13312
  s_nop 0
  buffer_load_dwordx4 v49, s[12:15], s80 offen lds
  v_mfma_f32_16x16x32_bf16 v[192:195], v[212:215], v[92:95], v[192:195]
  v_cvt_pk_bf16_f32 v249, v198, v199
  s_waitcnt lgkmcnt(2)
  v_mfma_f32_16x16x32_bf16 v[184:187], v[216:219], v[96:99], v[184:187]
  ds_read_b128 v[212:215], v71 offset:24832
  v_cvt_pk_bf16_f32 v250, v200, v201
  v_mfma_f32_16x16x32_bf16 v[188:191], v[216:219], v[100:103], v[188:191]
  s_add_u32 m0, s81, 14336
  s_nop 0
  buffer_load_dwordx4 v50, s[12:15], s80 offen lds
  v_mfma_f32_16x16x32_bf16 v[192:195], v[216:219], v[104:107], v[192:195]
  v_cvt_pk_bf16_f32 v251, v202, v203
  s_waitcnt lgkmcnt(2)
  v_mfma_f32_16x16x32_bf16 v[184:187], v[220:223], v[108:111], v[184:187]
  ds_read_b128 v[216:219], v70 offset:25344
  v_accvgpr_write_b32 a34, v248
  v_mfma_f32_16x16x32_bf16 v[188:191], v[220:223], v[112:115], v[188:191]
  s_add_u32 m0, s81, 15360
  s_nop 0
  buffer_load_dwordx4 v51, s[12:15], s80 offen lds
  v_mfma_f32_16x16x32_bf16 v[192:195], v[220:223], v[116:119], v[192:195]
  v_accvgpr_write_b32 a35, v249
  s_waitcnt lgkmcnt(2)
  v_mfma_f32_16x16x32_bf16 v[184:187], v[208:211], v[120:123], v[184:187]
  ds_read_b128 v[220:223], v71 offset:25344
  v_accvgpr_write_b32 a114, v250
  v_mfma_f32_16x16x32_bf16 v[188:191], v[208:211], v[124:127], v[188:191]
  s_add_u32 m0, s81, 16384
  s_nop 0
  buffer_load_dwordx4 v52, s[12:15], s80 offen lds
  v_mfma_f32_16x16x32_bf16 v[192:195], v[208:211], v[128:131], v[192:195]
  v_accvgpr_write_b32 a115, v251
  s_waitcnt lgkmcnt(2)
  v_mfma_f32_16x16x32_bf16 v[184:187], v[212:215], v[132:135], v[184:187]
  ds_read_b128 v[208:211], v70 offset:25472
  s_mov_b64 exec, s[68:69]
  v_cvt_pk_bf16_f32 v160, v204, v205
  v_cvt_pk_bf16_f32 v161, v206, v207
  s_mov_b64 exec, -1
  v_mfma_f32_16x16x32_bf16 v[188:191], v[212:215], v[136:139], v[188:191]
  s_add_u32 m0, s81, 17408
  s_nop 0
  buffer_load_dwordx4 v53, s[12:15], s80 offen lds
  v_mfma_f32_16x16x32_bf16 v[192:195], v[212:215], v[140:143], v[192:195]
  s_waitcnt lgkmcnt(2)
  v_mfma_f32_16x16x32_bf16 v[196:199], v[216:219], v[72:75], 0
  ds_read_b128 v[212:215], v71 offset:25472
  v_mfma_f32_16x16x32_bf16 v[200:203], v[216:219], v[76:79], 0
  s_add_u32 m0, s81, 18432
  s_nop 0
  buffer_load_dwordx4 v54, s[12:15], s80 offen lds
  v_mfma_f32_16x16x32_bf16 v[204:207], v[216:219], v[80:83], 0
  s_waitcnt lgkmcnt(2)
  v_mfma_f32_16x16x32_bf16 v[196:199], v[220:223], v[84:87], v[196:199]
  ds_read_b128 v[216:219], v70 offset:25600
  v_cvt_pk_bf16_f32 v248, v184, v185
  v_mfma_f32_16x16x32_bf16 v[200:203], v[220:223], v[88:91], v[200:203]
  s_add_u32 m0, s81, 19456
  s_nop 0
  buffer_load_dwordx4 v55, s[12:15], s80 offen lds
  v_mfma_f32_16x16x32_bf16 v[204:207], v[220:223], v[92:95], v[204:207]
  v_cvt_pk_bf16_f32 v249, v186, v187
  s_waitcnt lgkmcnt(2)
  v_mfma_f32_16x16x32_bf16 v[196:199], v[208:211], v[96:99], v[196:199]
  ds_read_b128 v[220:223], v71 offset:25600
  v_cvt_pk_bf16_f32 v250, v188, v189
  v_mfma_f32_16x16x32_bf16 v[200:203], v[208:211], v[100:103], v[200:203]
  s_add_u32 m0, s81, 20480
  s_nop 0
  buffer_load_dwordx4 v56, s[12:15], s80 offen lds
  v_mfma_f32_16x16x32_bf16 v[204:207], v[208:211], v[104:107], v[204:207]
  v_cvt_pk_bf16_f32 v251, v190, v191
  s_waitcnt lgkmcnt(2)
  v_mfma_f32_16x16x32_bf16 v[196:199], v[212:215], v[108:111], v[196:199]
  v_accvgpr_write_b32 a36, v248
  v_mfma_f32_16x16x32_bf16 v[200:203], v[212:215], v[112:115], v[200:203]
  s_add_u32 m0, s81, 21504
  s_nop 0
  buffer_load_dwordx4 v57, s[12:15], s80 offen lds
  v_mfma_f32_16x16x32_bf16 v[204:207], v[212:215], v[116:119], v[204:207]
  v_accvgpr_write_b32 a37, v249
  s_waitcnt lgkmcnt(1)
  v_mfma_f32_16x16x32_bf16 v[196:199], v[216:219], v[120:123], v[196:199]
  v_accvgpr_write_b32 a116, v250
  v_mfma_f32_16x16x32_bf16 v[200:203], v[216:219], v[124:127], v[200:203]
  s_add_u32 m0, s81, 22528
  s_nop 0
  buffer_load_dwordx4 v58, s[12:15], s80 offen lds
  v_mfma_f32_16x16x32_bf16 v[204:207], v[216:219], v[128:131], v[204:207]
  v_accvgpr_write_b32 a117, v251
  s_waitcnt lgkmcnt(0)
  v_mfma_f32_16x16x32_bf16 v[196:199], v[220:223], v[132:135], v[196:199]
  v_cvt_pk_bf16_f32 v162, v192, v193
  v_cvt_pk_bf16_f32 v163, v194, v195
  v_mfma_f32_16x16x32_bf16 v[200:203], v[220:223], v[136:139], v[200:203]
  s_add_u32 m0, s81, 23552
  s_nop 0
  buffer_load_dwordx4 v59, s[12:15], s80 offen lds
  s_add_u32 s80, s80, 393216
  v_mfma_f32_16x16x32_bf16 v[204:207], v[220:223], v[140:143], v[204:207]
  s_add_u32 s21, s79, 1572864
  buffer_load_dwordx4 v[236:239], v63, s[28:31], s21 offen
  s_add_u32 s21, s79, 1572864
  buffer_load_dwordx4 v[240:243], v64, s[28:31], s21 offen
  s_add_u32 s21, s79, 1572864
  buffer_load_dwordx4 v[244:247], v65, s[28:31], s21 offen
  s_waitcnt vmcnt(18)
  ds_read_b128 v[208:211], v70 offset:0
  ds_read_b128 v[212:215], v71 offset:0
  ds_read_b128 v[216:219], v70 offset:128
  s_waitcnt lgkmcnt(2)
  v_mfma_f32_16x16x32_bf16 v[184:187], v[208:211], v[72:75], 0
  ds_read_b128 v[220:223], v71 offset:128
  v_mfma_f32_16x16x32_bf16 v[188:191], v[208:211], v[76:79], 0
  s_add_u32 m0, s81, 24576
  s_nop 0
  buffer_load_dwordx4 v48, s[12:15], s80 offen lds
  ds_write_b64 v69, v[144:145] offset:36864
  v_mfma_f32_16x16x32_bf16 v[192:195], v[208:211], v[80:83], 0
  s_waitcnt lgkmcnt(3)
  v_mfma_f32_16x16x32_bf16 v[184:187], v[212:215], v[84:87], v[184:187]
  ds_read_b128 v[208:211], v70 offset:256
  v_cvt_pk_bf16_f32 v248, v196, v197
  v_mfma_f32_16x16x32_bf16 v[188:191], v[212:215], v[88:91], v[188:191]
  s_add_u32 m0, s81, 25600
  s_nop 0
  buffer_load_dwordx4 v49, s[12:15], s80 offen lds
  ds_write_b64 v69, v[146:147] offset:37376
  v_mfma_f32_16x16x32_bf16 v[192:195], v[212:215], v[92:95], v[192:195]
  v_cvt_pk_bf16_f32 v249, v198, v199
  s_waitcnt lgkmcnt(4)
  v_mfma_f32_16x16x32_bf16 v[184:187], v[216:219], v[96:99], v[184:187]
  ds_read_b128 v[212:215], v71 offset:256
  v_cvt_pk_bf16_f32 v250, v200, v201
  v_mfma_f32_16x16x32_bf16 v[188:191], v[216:219], v[100:103], v[188:191]
  s_add_u32 m0, s81, 26624
  s_nop 0
  buffer_load_dwordx4 v50, s[12:15], s80 offen lds
  ds_write_b64 v69, v[148:149] offset:37888
  v_mfma_f32_16x16x32_bf16 v[192:195], v[216:219], v[104:107], v[192:195]
  v_cvt_pk_bf16_f32 v251, v202, v203
  s_waitcnt lgkmcnt(5)
  v_mfma_f32_16x16x32_bf16 v[184:187], v[220:223], v[108:111], v[184:187]
  ds_read_b128 v[216:219], v70 offset:768
  v_accvgpr_write_b32 a38, v248
  v_mfma_f32_16x16x32_bf16 v[188:191], v[220:223], v[112:115], v[188:191]
  s_add_u32 m0, s81, 27648
  s_nop 0
  buffer_load_dwordx4 v51, s[12:15], s80 offen lds
  ds_write_b64 v69, v[150:151] offset:38400
  v_mfma_f32_16x16x32_bf16 v[192:195], v[220:223], v[116:119], v[192:195]
  v_accvgpr_write_b32 a39, v249
  s_waitcnt lgkmcnt(5)
  v_mfma_f32_16x16x32_bf16 v[184:187], v[208:211], v[120:123], v[184:187]
  ds_read_b128 v[220:223], v71 offset:768
  v_accvgpr_write_b32 a118, v250
  v_mfma_f32_16x16x32_bf16 v[188:191], v[208:211], v[124:127], v[188:191]
  s_add_u32 m0, s81, 28672
  s_nop 0
  buffer_load_dwordx4 v52, s[12:15], s80 offen lds
  ds_write_b64 v69, v[152:153] offset:38912
  v_mfma_f32_16x16x32_bf16 v[192:195], v[208:211], v[128:131], v[192:195]
  v_accvgpr_write_b32 a119, v251
  s_waitcnt lgkmcnt(5)
  v_mfma_f32_16x16x32_bf16 v[184:187], v[212:215], v[132:135], v[184:187]
  ds_read_b128 v[208:211], v70 offset:896
  s_mov_b64 exec, s[68:69]
  v_cvt_pk_bf16_f32 v162, v204, v205
  v_cvt_pk_bf16_f32 v163, v206, v207
  s_mov_b64 exec, -1
  v_mfma_f32_16x16x32_bf16 v[188:191], v[212:215], v[136:139], v[188:191]
  s_add_u32 m0, s81, 29696
  s_nop 0
  buffer_load_dwordx4 v53, s[12:15], s80 offen lds
  ds_write_b64 v69, v[154:155] offset:39424
  v_mfma_f32_16x16x32_bf16 v[192:195], v[212:215], v[140:143], v[192:195]
  s_waitcnt lgkmcnt(5)
  v_mfma_f32_16x16x32_bf16 v[196:199], v[216:219], v[72:75], 0
  ds_read_b128 v[212:215], v71 offset:896
  v_mfma_f32_16x16x32_bf16 v[200:203], v[216:219], v[76:79], 0
  s_add_u32 m0, s81, 30720
  s_nop 0
  buffer_load_dwordx4 v54, s[12:15], s80 offen lds
  ds_write_b64 v69, v[156:157] offset:39936
  v_mfma_f32_16x16x32_bf16 v[204:207], v[216:219], v[80:83], 0
  s_waitcnt lgkmcnt(5)
  v_mfma_f32_16x16x32_bf16 v[196:199], v[220:223], v[84:87], v[196:199]
  ds_read_b128 v[216:219], v70 offset:1024
  v_cvt_pk_bf16_f32 v248, v184, v185
  v_mfma_f32_16x16x32_bf16 v[200:203], v[220:223], v[88:91], v[200:203]
  s_add_u32 m0, s81, 31744
  s_nop 0
  buffer_load_dwordx4 v55, s[12:15], s80 offen lds
  ds_write_b64 v69, v[158:159] offset:40448
  v_mfma_f32_16x16x32_bf16 v[204:207], v[220:223], v[92:95], v[204:207]
  v_cvt_pk_bf16_f32 v249, v186, v187
  s_waitcnt lgkmcnt(5)
  v_mfma_f32_16x16x32_bf16 v[196:199], v[208:211], v[96:99], v[196:199]
  ds_read_b128 v[220:223], v71 offset:1024
  v_cvt_pk_bf16_f32 v250, v188, v189
  v_mfma_f32_16x16x32_bf16 v[200:203], v[208:211], v[100:103], v[200:203]
  s_add_u32 m0, s81, 32768
  s_nop 0
  buffer_load_dwordx4 v56, s[12:15], s80 offen lds
  v_mfma_f32_16x16x32_bf16 v[204:207], v[208:211], v[104:107], v[204:207]
  v_cvt_pk_bf16_f32 v251, v190, v191
  s_waitcnt lgkmcnt(4)
  v_mfma_f32_16x16x32_bf16 v[196:199], v[212:215], v[108:111], v[196:199]
  v_accvgpr_write_b32 a40, v248
  v_mfma_f32_16x16x32_bf16 v[200:203], v[212:215], v[112:115], v[200:203]
  s_add_u32 m0, s81, 33792
  s_nop 0
  buffer_load_dwordx4 v57, s[12:15], s80 offen lds
  v_mfma_f32_16x16x32_bf16 v[204:207], v[212:215], v[116:119], v[204:207]
  v_accvgpr_write_b32 a41, v249
  s_waitcnt lgkmcnt(2)
  v_mfma_f32_16x16x32_bf16 v[196:199], v[216:219], v[120:123], v[196:199]
  v_accvgpr_write_b32 a120, v250
  v_mfma_f32_16x16x32_bf16 v[200:203], v[216:219], v[124:127], v[200:203]
  s_add_u32 m0, s81, 34816
  s_nop 0
  buffer_load_dwordx4 v58, s[12:15], s80 offen lds
  v_mfma_f32_16x16x32_bf16 v[204:207], v[216:219], v[128:131], v[204:207]
  v_accvgpr_write_b32 a121, v251
  s_waitcnt lgkmcnt(0)
  v_mfma_f32_16x16x32_bf16 v[196:199], v[220:223], v[132:135], v[196:199]
  v_cvt_pk_bf16_f32 v164, v192, v193
  v_cvt_pk_bf16_f32 v165, v194, v195
  v_mfma_f32_16x16x32_bf16 v[200:203], v[220:223], v[136:139], v[200:203]
  s_add_u32 m0, s81, 35840
  s_nop 0
  buffer_load_dwordx4 v59, s[12:15], s80 offen lds
  s_add_u32 s80, s80, 393216
  v_mfma_f32_16x16x32_bf16 v[204:207], v[220:223], v[140:143], v[204:207]
  s_add_u32 s21, s79, 0
  buffer_load_dwordx4 a[160:163], v63, s[24:27], s21 offen
  s_add_u32 s21, s79, 0
  buffer_load_dwordx4 a[164:167], v64, s[24:27], s21 offen
  s_add_u32 s21, s79, 0
  buffer_load_dwordx4 a[168:171], v65, s[24:27], s21 offen
  s_waitcnt vmcnt(18)
  ds_read_b128 v[208:211], v70 offset:12288
  ds_read_b128 v[212:215], v71 offset:12288
  ds_read_b128 v[216:219], v70 offset:12416
  s_waitcnt lgkmcnt(2)
  v_mfma_f32_16x16x32_bf16 v[184:187], v[208:211], v[72:75], 0
  ds_read_b128 v[220:223], v71 offset:12416
  v_mfma_f32_16x16x32_bf16 v[188:191], v[208:211], v[76:79], 0
  s_add_u32 m0, s81, 0
  s_nop 0
  buffer_load_dwordx4 v48, s[12:15], s80 offen lds
  v_mfma_f32_16x16x32_bf16 v[192:195], v[208:211], v[80:83], 0
  s_waitcnt lgkmcnt(2)
  v_mfma_f32_16x16x32_bf16 v[184:187], v[212:215], v[84:87], v[184:187]
  ds_read_b128 v[208:211], v70 offset:12544
  v_cvt_pk_bf16_f32 v248, v196, v197
  v_mfma_f32_16x16x32_bf16 v[188:191], v[212:215], v[88:91], v[188:191]
  s_add_u32 m0, s81, 1024
  s_nop 0
  buffer_load_dwordx4 v49, s[12:15], s80 offen lds
  v_mfma_f32_16x16x32_bf16 v[192:195], v[212:215], v[92:95], v[192:195]
  v_cvt_pk_bf16_f32 v249, v198, v199
  s_waitcnt lgkmcnt(2)
  v_mfma_f32_16x16x32_bf16 v[184:187], v[216:219], v[96:99], v[184:187]
  ds_read_b128 v[212:215], v71 offset:12544
  v_cvt_pk_bf16_f32 v250, v200, v201
  v_mfma_f32_16x16x32_bf16 v[188:191], v[216:219], v[100:103], v[188:191]
  s_add_u32 m0, s81, 2048
  s_nop 0
  buffer_load_dwordx4 v50, s[12:15], s80 offen lds
  v_mfma_f32_16x16x32_bf16 v[192:195], v[216:219], v[104:107], v[192:195]
  v_cvt_pk_bf16_f32 v251, v202, v203
  s_waitcnt lgkmcnt(2)
  v_mfma_f32_16x16x32_bf16 v[184:187], v[220:223], v[108:111], v[184:187]
  ds_read_b128 v[216:219], v70 offset:13056
  v_accvgpr_write_b32 a42, v248
  v_mfma_f32_16x16x32_bf16 v[188:191], v[220:223], v[112:115], v[188:191]
  s_add_u32 m0, s81, 3072
  s_nop 0
  buffer_load_dwordx4 v51, s[12:15], s80 offen lds
  v_mfma_f32_16x16x32_bf16 v[192:195], v[220:223], v[116:119], v[192:195]
  v_accvgpr_write_b32 a43, v249
  s_waitcnt lgkmcnt(2)
  v_mfma_f32_16x16x32_bf16 v[184:187], v[208:211], v[120:123], v[184:187]
  ds_read_b128 v[220:223], v71 offset:13056
  v_accvgpr_write_b32 a122, v250
  v_mfma_f32_16x16x32_bf16 v[188:191], v[208:211], v[124:127], v[188:191]
  s_add_u32 m0, s81, 4096
  s_nop 0
  buffer_load_dwordx4 v52, s[12:15], s80 offen lds
  v_mfma_f32_16x16x32_bf16 v[192:195], v[208:211], v[128:131], v[192:195]
  v_accvgpr_write_b32 a123, v251
  s_waitcnt lgkmcnt(2)
  v_mfma_f32_16x16x32_bf16 v[184:187], v[212:215], v[132:135], v[184:187]
  ds_read_b128 v[208:211], v70 offset:13184
  s_mov_b64 exec, s[68:69]
  v_cvt_pk_bf16_f32 v164, v204, v205
  v_cvt_pk_bf16_f32 v165, v206, v207
  s_mov_b64 exec, -1
  v_mfma_f32_16x16x32_bf16 v[188:191], v[212:215], v[136:139], v[188:191]
  s_add_u32 m0, s81, 5120
  s_nop 0
  buffer_load_dwordx4 v53, s[12:15], s80 offen lds
  v_mfma_f32_16x16x32_bf16 v[192:195], v[212:215], v[140:143], v[192:195]
  s_waitcnt lgkmcnt(2)
  v_mfma_f32_16x16x32_bf16 v[196:199], v[216:219], v[72:75], 0
  ds_read_b128 v[212:215], v71 offset:13184
  v_mfma_f32_16x16x32_bf16 v[200:203], v[216:219], v[76:79], 0
  s_add_u32 m0, s81, 6144
  s_nop 0
  buffer_load_dwordx4 v54, s[12:15], s80 offen lds
  v_mfma_f32_16x16x32_bf16 v[204:207], v[216:219], v[80:83], 0
  s_waitcnt lgkmcnt(2)
  v_mfma_f32_16x16x32_bf16 v[196:199], v[220:223], v[84:87], v[196:199]
  ds_read_b128 v[216:219], v70 offset:13312
  v_cvt_pk_bf16_f32 v248, v184, v185
  v_mfma_f32_16x16x32_bf16 v[200:203], v[220:223], v[88:91], v[200:203]
  s_add_u32 m0, s81, 7168
  s_nop 0
  buffer_load_dwordx4 v55, s[12:15], s80 offen lds
  v_mfma_f32_16x16x32_bf16 v[204:207], v[220:223], v[92:95], v[204:207]
  v_cvt_pk_bf16_f32 v249, v186, v187
  s_waitcnt lgkmcnt(2)
  v_mfma_f32_16x16x32_bf16 v[196:199], v[208:211], v[96:99], v[196:199]
  ds_read_b128 v[220:223], v71 offset:13312
  v_cvt_pk_bf16_f32 v250, v188, v189
  v_mfma_f32_16x16x32_bf16 v[200:203], v[208:211], v[100:103], v[200:203]
  s_add_u32 m0, s81, 8192
  s_nop 0
  buffer_load_dwordx4 v56, s[12:15], s80 offen lds
  v_mfma_f32_16x16x32_bf16 v[204:207], v[208:211], v[104:107], v[204:207]
  v_cvt_pk_bf16_f32 v251, v190, v191
  s_waitcnt lgkmcnt(2)
  v_mfma_f32_16x16x32_bf16 v[196:199], v[212:215], v[108:111], v[196:199]
  v_accvgpr_write_b32 a44, v248
  v_mfma_f32_16x16x32_bf16 v[200:203], v[212:215], v[112:115], v[200:203]
  s_add_u32 m0, s81, 9216
  s_nop 0
  buffer_load_dwordx4 v57, s[12:15], s80 offen lds
  v_mfma_f32_16x16x32_bf16 v[204:207], v[212:215], v[116:119], v[204:207]
  v_accvgpr_write_b32 a45, v249
  s_waitcnt lgkmcnt(1)
  v_mfma_f32_16x16x32_bf16 v[196:199], v[216:219], v[120:123], v[196:199]
  v_accvgpr_write_b32 a124, v250
  v_mfma_f32_16x16x32_bf16 v[200:203], v[216:219], v[124:127], v[200:203]
  s_add_u32 m0, s81, 10240
  s_nop 0
  buffer_load_dwordx4 v58, s[12:15], s80 offen lds
  v_mfma_f32_16x16x32_bf16 v[204:207], v[216:219], v[128:131], v[204:207]
  v_accvgpr_write_b32 a125, v251
  s_waitcnt lgkmcnt(0)
  v_mfma_f32_16x16x32_bf16 v[196:199], v[220:223], v[132:135], v[196:199]
  v_cvt_pk_bf16_f32 v166, v192, v193
  v_cvt_pk_bf16_f32 v167, v194, v195
  v_mfma_f32_16x16x32_bf16 v[200:203], v[220:223], v[136:139], v[200:203]
  s_add_u32 m0, s81, 11264
  s_nop 0
  buffer_load_dwordx4 v59, s[12:15], s80 offen lds
  s_add_u32 s80, s80, 393216
  v_mfma_f32_16x16x32_bf16 v[204:207], v[220:223], v[140:143], v[204:207]
  s_add_u32 s21, s79, 393216
  buffer_load_dwordx4 a[184:187], v63, s[24:27], s21 offen
  s_add_u32 s21, s79, 393216
  buffer_load_dwordx4 a[188:191], v64, s[24:27], s21 offen
  s_add_u32 s21, s79, 393216
  buffer_load_dwordx4 a[192:195], v65, s[24:27], s21 offen
  s_waitcnt vmcnt(18)
  ds_read_b128 v[208:211], v70 offset:24576
  ds_read_b128 v[212:215], v71 offset:24576
  ds_read_b128 v[216:219], v70 offset:24704
  s_waitcnt lgkmcnt(2)
  v_mfma_f32_16x16x32_bf16 v[184:187], v[208:211], v[72:75], 0
  ds_read_b128 v[220:223], v71 offset:24704
  v_mfma_f32_16x16x32_bf16 v[188:191], v[208:211], v[76:79], 0
  s_add_u32 m0, s81, 12288
  s_nop 0
  buffer_load_dwordx4 v48, s[12:15], s80 offen lds
  v_mfma_f32_16x16x32_bf16 v[192:195], v[208:211], v[80:83], 0
  s_waitcnt lgkmcnt(2)
  v_mfma_f32_16x16x32_bf16 v[184:187], v[212:215], v[84:87], v[184:187]
  ds_read_b128 v[208:211], v70 offset:24832
  v_cvt_pk_bf16_f32 v248, v196, v197
  v_mfma_f32_16x16x32_bf16 v[188:191], v[212:215], v[88:91], v[188:191]
  s_add_u32 m0, s81, 13312
  s_nop 0
  buffer_load_dwordx4 v49, s[12:15], s80 offen lds
  v_mfma_f32_16x16x32_bf16 v[192:195], v[212:215], v[92:95], v[192:195]
  v_cvt_pk_bf16_f32 v249, v198, v199
  s_waitcnt lgkmcnt(2)
  v_mfma_f32_16x16x32_bf16 v[184:187], v[216:219], v[96:99], v[184:187]
  ds_read_b128 v[212:215], v71 offset:24832
  v_cvt_pk_bf16_f32 v250, v200, v201
  v_mfma_f32_16x16x32_bf16 v[188:191], v[216:219], v[100:103], v[188:191]
  s_add_u32 m0, s81, 14336
  s_nop 0
  buffer_load_dwordx4 v50, s[12:15], s80 offen lds
  v_mfma_f32_16x16x32_bf16 v[192:195], v[216:219], v[104:107], v[192:195]
  v_cvt_pk_bf16_f32 v251, v202, v203
  s_waitcnt lgkmcnt(2)
  v_mfma_f32_16x16x32_bf16 v[184:187], v[220:223], v[108:111], v[184:187]
  ds_read_b128 v[216:219], v70 offset:25344
  v_accvgpr_write_b32 a46, v248
  v_mfma_f32_16x16x32_bf16 v[188:191], v[220:223], v[112:115], v[188:191]
  s_add_u32 m0, s81, 15360
  s_nop 0
  buffer_load_dwordx4 v51, s[12:15], s80 offen lds
  v_mfma_f32_16x16x32_bf16 v[192:195], v[220:223], v[116:119], v[192:195]
  v_accvgpr_write_b32 a47, v249
  s_waitcnt lgkmcnt(2)
  v_mfma_f32_16x16x32_bf16 v[184:187], v[208:211], v[120:123], v[184:187]
  ds_read_b128 v[220:223], v71 offset:25344
  v_accvgpr_write_b32 a126, v250
  v_mfma_f32_16x16x32_bf16 v[188:191], v[208:211], v[124:127], v[188:191]
  s_add_u32 m0, s81, 16384
  s_nop 0
  buffer_load_dwordx4 v52, s[12:15], s80 offen lds
  v_mfma_f32_16x16x32_bf16 v[192:195], v[208:211], v[128:131], v[192:195]
  v_accvgpr_write_b32 a127, v251
  s_waitcnt lgkmcnt(2)
  v_mfma_f32_16x16x32_bf16 v[184:187], v[212:215], v[132:135], v[184:187]
  ds_read_b128 v[208:211], v70 offset:25472
  s_mov_b64 exec, s[68:69]
  v_cvt_pk_bf16_f32 v166, v204, v205
  v_cvt_pk_bf16_f32 v167, v206, v207
  s_mov_b64 exec, -1
  v_mfma_f32_16x16x32_bf16 v[188:191], v[212:215], v[136:139], v[188:191]
  s_add_u32 m0, s81, 17408
  s_nop 0
  buffer_load_dwordx4 v53, s[12:15], s80 offen lds
  v_mfma_f32_16x16x32_bf16 v[192:195], v[212:215], v[140:143], v[192:195]
  s_waitcnt lgkmcnt(2)
  v_mfma_f32_16x16x32_bf16 v[196:199], v[216:219], v[72:75], 0
  ds_read_b128 v[212:215], v71 offset:25472
  v_mfma_f32_16x16x32_bf16 v[200:203], v[216:219], v[76:79], 0
  s_add_u32 m0, s81, 18432
  s_nop 0
  buffer_load_dwordx4 v54, s[12:15], s80 offen lds
  v_mfma_f32_16x16x32_bf16 v[204:207], v[216:219], v[80:83], 0
  s_waitcnt lgkmcnt(2)
  v_mfma_f32_16x16x32_bf16 v[196:199], v[220:223], v[84:87], v[196:199]
  ds_read_b128 v[216:219], v70 offset:25600
  v_cvt_pk_bf16_f32 v248, v184, v185
  v_mfma_f32_16x16x32_bf16 v[200:203], v[220:223], v[88:91], v[200:203]
  s_add_u32 m0, s81, 19456
  s_nop 0
  buffer_load_dwordx4 v55, s[12:15], s80 offen lds
  v_mfma_f32_16x16x32_bf16 v[204:207], v[220:223], v[92:95], v[204:207]
  v_cvt_pk_bf16_f32 v249, v186, v187
  s_waitcnt lgkmcnt(2)
  v_mfma_f32_16x16x32_bf16 v[196:199], v[208:211], v[96:99], v[196:199]
  ds_read_b128 v[220:223], v71 offset:25600
  v_cvt_pk_bf16_f32 v250, v188, v189
  v_mfma_f32_16x16x32_bf16 v[200:203], v[208:211], v[100:103], v[200:203]
  s_add_u32 m0, s81, 20480
  s_nop 0
  buffer_load_dwordx4 v56, s[12:15], s80 offen lds
  v_mfma_f32_16x16x32_bf16 v[204:207], v[208:211], v[104:107], v[204:207]
  v_cvt_pk_bf16_f32 v251, v190, v191
  s_waitcnt lgkmcnt(2)
  v_mfma_f32_16x16x32_bf16 v[196:199], v[212:215], v[108:111], v[196:199]
  v_accvgpr_write_b32 a48, v248
  v_mfma_f32_16x16x32_bf16 v[200:203], v[212:215], v[112:115], v[200:203]
  s_add_u32 m0, s81, 21504
  s_nop 0
  buffer_load_dwordx4 v57, s[12:15], s80 offen lds
  v_mfma_f32_16x16x32_bf16 v[204:207], v[212:215], v[116:119], v[204:207]
  v_accvgpr_write_b32 a49, v249
  s_waitcnt lgkmcnt(1)
  v_mfma_f32_16x16x32_bf16 v[196:199], v[216:219], v[120:123], v[196:199]
  v_accvgpr_write_b32 a128, v250
  v_mfma_f32_16x16x32_bf16 v[200:203], v[216:219], v[124:127], v[200:203]
  s_add_u32 m0, s81, 22528
  s_nop 0
  buffer_load_dwordx4 v58, s[12:15], s80 offen lds
  v_mfma_f32_16x16x32_bf16 v[204:207], v[216:219], v[128:131], v[204:207]
  v_accvgpr_write_b32 a129, v251
  s_waitcnt lgkmcnt(0)
  v_mfma_f32_16x16x32_bf16 v[196:199], v[220:223], v[132:135], v[196:199]
  v_cvt_pk_bf16_f32 v168, v192, v193
  v_cvt_pk_bf16_f32 v169, v194, v195
  v_mfma_f32_16x16x32_bf16 v[200:203], v[220:223], v[136:139], v[200:203]
  s_add_u32 m0, s81, 23552
  s_nop 0
  buffer_load_dwordx4 v59, s[12:15], s80 offen lds
  s_add_u32 s80, s80, 393216
  v_mfma_f32_16x16x32_bf16 v[204:207], v[220:223], v[140:143], v[204:207]
  s_add_u32 s21, s79, 786432
  buffer_load_dwordx4 a[208:211], v63, s[24:27], s21 offen
  s_add_u32 s21, s79, 786432
  buffer_load_dwordx4 a[212:215], v64, s[24:27], s21 offen
  s_add_u32 s21, s79, 786432
  buffer_load_dwordx4 a[216:219], v65, s[24:27], s21 offen
  s_waitcnt vmcnt(18)
  buffer_load_dword v66, v67, s[32:35], 0 offen sc1
  ds_read_b128 v[208:211], v70 offset:0
  ds_read_b128 v[212:215], v71 offset:0
  ds_read_b128 v[216:219], v70 offset:128
  s_waitcnt lgkmcnt(2)
  v_mfma_f32_16x16x32_bf16 v[184:187], v[208:211], v[72:75], 0
  ds_read_b128 v[220:223], v71 offset:128
  v_mfma_f32_16x16x32_bf16 v[188:191], v[208:211], v[76:79], 0
  s_add_u32 m0, s81, 24576
  s_nop 0
  buffer_load_dwordx4 v48, s[12:15], s80 offen lds
  v_mfma_f32_16x16x32_bf16 v[192:195], v[208:211], v[80:83], 0
  s_waitcnt lgkmcnt(2)
  v_mfma_f32_16x16x32_bf16 v[184:187], v[212:215], v[84:87], v[184:187]
  ds_read_b128 v[208:211], v70 offset:256
  v_cvt_pk_bf16_f32 v248, v196, v197
  v_mfma_f32_16x16x32_bf16 v[188:191], v[212:215], v[88:91], v[188:191]
  s_add_u32 m0, s81, 25600
  s_nop 0
  buffer_load_dwordx4 v49, s[12:15], s80 offen lds
  v_mfma_f32_16x16x32_bf16 v[192:195], v[212:215], v[92:95], v[192:195]
  v_cvt_pk_bf16_f32 v249, v198, v199
  s_waitcnt lgkmcnt(2)
  v_mfma_f32_16x16x32_bf16 v[184:187], v[216:219], v[96:99], v[184:187]
  ds_read_b128 v[212:215], v71 offset:256
  v_cvt_pk_bf16_f32 v250, v200, v201
  v_mfma_f32_16x16x32_bf16 v[188:191], v[216:219], v[100:103], v[188:191]
  s_add_u32 m0, s81, 26624
  s_nop 0
  buffer_load_dwordx4 v50, s[12:15], s80 offen lds
  v_mfma_f32_16x16x32_bf16 v[192:195], v[216:219], v[104:107], v[192:195]
  v_cvt_pk_bf16_f32 v251, v202, v203
  s_waitcnt lgkmcnt(2)
  v_mfma_f32_16x16x32_bf16 v[184:187], v[220:223], v[108:111], v[184:187]
  ds_read_b128 v[216:219], v70 offset:768
  v_accvgpr_write_b32 a50, v248
  v_mfma_f32_16x16x32_bf16 v[188:191], v[220:223], v[112:115], v[188:191]
  s_add_u32 m0, s81, 27648
  s_nop 0
  buffer_load_dwordx4 v51, s[12:15], s80 offen lds
  v_mfma_f32_16x16x32_bf16 v[192:195], v[220:223], v[116:119], v[192:195]
  v_accvgpr_write_b32 a51, v249
  s_waitcnt lgkmcnt(2)
  v_mfma_f32_16x16x32_bf16 v[184:187], v[208:211], v[120:123], v[184:187]
  ds_read_b128 v[220:223], v71 offset:768
  v_accvgpr_write_b32 a130, v250
  v_mfma_f32_16x16x32_bf16 v[188:191], v[208:211], v[124:127], v[188:191]
  s_add_u32 m0, s81, 28672
  s_nop 0
  buffer_load_dwordx4 v52, s[12:15], s80 offen lds
  v_mfma_f32_16x16x32_bf16 v[192:195], v[208:211], v[128:131], v[192:195]
  v_accvgpr_write_b32 a131, v251
  s_waitcnt lgkmcnt(2)
  v_mfma_f32_16x16x32_bf16 v[184:187], v[212:215], v[132:135], v[184:187]
  ds_read_b128 v[208:211], v70 offset:896
  s_mov_b64 exec, s[68:69]
  v_cvt_pk_bf16_f32 v168, v204, v205
  v_cvt_pk_bf16_f32 v169, v206, v207
  s_mov_b64 exec, -1
  v_mfma_f32_16x16x32_bf16 v[188:191], v[212:215], v[136:139], v[188:191]
  s_add_u32 m0, s81, 29696
  s_nop 0
  buffer_load_dwordx4 v53, s[12:15], s80 offen lds
  v_mfma_f32_16x16x32_bf16 v[192:195], v[212:215], v[140:143], v[192:195]
  s_waitcnt lgkmcnt(2)
  v_mfma_f32_16x16x32_bf16 v[196:199], v[216:219], v[72:75], 0
  ds_read_b128 v[212:215], v71 offset:896
  v_mfma_f32_16x16x32_bf16 v[200:203], v[216:219], v[76:79], 0
  s_add_u32 m0, s81, 30720
  s_nop 0
  buffer_load_dwordx4 v54, s[12:15], s80 offen lds
  v_mfma_f32_16x16x32_bf16 v[204:207], v[216:219], v[80:83], 0
  s_waitcnt lgkmcnt(2)
  v_mfma_f32_16x16x32_bf16 v[196:199], v[220:223], v[84:87], v[196:199]
  ds_read_b128 v[216:219], v70 offset:1024
  v_cvt_pk_bf16_f32 v248, v184, v185
  v_mfma_f32_16x16x32_bf16 v[200:203], v[220:223], v[88:91], v[200:203]
  s_add_u32 m0, s81, 31744
  s_nop 0
  buffer_load_dwordx4 v55, s[12:15], s80 offen lds
  v_mfma_f32_16x16x32_bf16 v[204:207], v[220:223], v[92:95], v[204:207]
  v_cvt_pk_bf16_f32 v249, v186, v187
  s_waitcnt lgkmcnt(2)
  v_mfma_f32_16x16x32_bf16 v[196:199], v[208:211], v[96:99], v[196:199]
  ds_read_b128 v[220:223], v71 offset:1024
  v_cvt_pk_bf16_f32 v250, v188, v189
  v_mfma_f32_16x16x32_bf16 v[200:203], v[208:211], v[100:103], v[200:203]
  s_add_u32 m0, s81, 32768
  s_nop 0
  buffer_load_dwordx4 v56, s[12:15], s80 offen lds
  v_mfma_f32_16x16x32_bf16 v[204:207], v[208:211], v[104:107], v[204:207]
  v_cvt_pk_bf16_f32 v251, v190, v191
  s_waitcnt lgkmcnt(2)
  v_mfma_f32_16x16x32_bf16 v[196:199], v[212:215], v[108:111], v[196:199]
  v_accvgpr_write_b32 a52, v248
  v_mfma_f32_16x16x32_bf16 v[200:203], v[212:215], v[112:115], v[200:203]
  s_add_u32 m0, s81, 33792
  s_nop 0
  buffer_load_dwordx4 v57, s[12:15], s80 offen lds
  v_mfma_f32_16x16x32_bf16 v[204:207], v[212:215], v[116:119], v[204:207]
  v_accvgpr_write_b32 a53, v249
  s_waitcnt lgkmcnt(1)
  v_mfma_f32_16x16x32_bf16 v[196:199], v[216:219], v[120:123], v[196:199]
  v_accvgpr_write_b32 a132, v250
  v_mfma_f32_16x16x32_bf16 v[200:203], v[216:219], v[124:127], v[200:203]
  s_add_u32 m0, s81, 34816
  s_nop 0
  buffer_load_dwordx4 v58, s[12:15], s80 offen lds
  v_mfma_f32_16x16x32_bf16 v[204:207], v[216:219], v[128:131], v[204:207]
  v_accvgpr_write_b32 a133, v251
  s_waitcnt lgkmcnt(0)
  v_mfma_f32_16x16x32_bf16 v[196:199], v[220:223], v[132:135], v[196:199]
  v_cvt_pk_bf16_f32 v170, v192, v193
  v_cvt_pk_bf16_f32 v171, v194, v195
  v_mfma_f32_16x16x32_bf16 v[200:203], v[220:223], v[136:139], v[200:203]
  s_add_u32 m0, s81, 35840
  s_nop 0
  buffer_load_dwordx4 v59, s[12:15], s80 offen lds
  s_add_u32 s80, s80, 393216
  v_mfma_f32_16x16x32_bf16 v[204:207], v[220:223], v[140:143], v[204:207]
  s_add_u32 s21, s79, 1179648
  buffer_load_dwordx4 a[232:235], v63, s[24:27], s21 offen
  s_add_u32 s21, s79, 1179648
  buffer_load_dwordx4 a[236:239], v64, s[24:27], s21 offen
  s_add_u32 s21, s79, 1179648
  buffer_load_dwordx4 a[240:243], v65, s[24:27], s21 offen
  s_waitcnt vmcnt(19)
  ds_read_b128 v[208:211], v70 offset:12288
  ds_read_b128 v[212:215], v71 offset:12288
  ds_read_b128 v[216:219], v70 offset:12416
  s_waitcnt lgkmcnt(2)
  v_mfma_f32_16x16x32_bf16 v[184:187], v[208:211], v[72:75], 0
  ds_read_b128 v[220:223], v71 offset:12416
  v_mfma_f32_16x16x32_bf16 v[188:191], v[208:211], v[76:79], 0
  s_add_u32 m0, s81, 0
  s_nop 0
  buffer_load_dwordx4 v48, s[12:15], s80 offen lds
  v_mfma_f32_16x16x32_bf16 v[192:195], v[208:211], v[80:83], 0
  s_waitcnt lgkmcnt(2)
  v_mfma_f32_16x16x32_bf16 v[184:187], v[212:215], v[84:87], v[184:187]
  ds_read_b128 v[208:211], v70 offset:12544
  v_cvt_pk_bf16_f32 v248, v196, v197
  v_mfma_f32_16x16x32_bf16 v[188:191], v[212:215], v[88:91], v[188:191]
  s_add_u32 m0, s81, 1024
  s_nop 0
  buffer_load_dwordx4 v49, s[12:15], s80 offen lds
  v_mfma_f32_16x16x32_bf16 v[192:195], v[212:215], v[92:95], v[192:195]
  v_cvt_pk_bf16_f32 v249, v198, v199
  s_waitcnt lgkmcnt(2)
  v_mfma_f32_16x16x32_bf16 v[184:187], v[216:219], v[96:99], v[184:187]
  ds_read_b128 v[212:215], v71 offset:12544
  v_cvt_pk_bf16_f32 v250, v200, v201
  v_mfma_f32_16x16x32_bf16 v[188:191], v[216:219], v[100:103], v[188:191]
  s_add_u32 m0, s81, 2048
  s_nop 0
  buffer_load_dwordx4 v50, s[12:15], s80 offen lds
  v_mfma_f32_16x16x32_bf16 v[192:195], v[216:219], v[104:107], v[192:195]
  v_cvt_pk_bf16_f32 v251, v202, v203
  s_waitcnt lgkmcnt(2)
  v_mfma_f32_16x16x32_bf16 v[184:187], v[220:223], v[108:111], v[184:187]
  ds_read_b128 v[216:219], v70 offset:13056
  v_accvgpr_write_b32 a54, v248
  v_mfma_f32_16x16x32_bf16 v[188:191], v[220:223], v[112:115], v[188:191]
  s_add_u32 m0, s81, 3072
  s_nop 0
  buffer_load_dwordx4 v51, s[12:15], s80 offen lds
  v_mfma_f32_16x16x32_bf16 v[192:195], v[220:223], v[116:119], v[192:195]
  v_accvgpr_write_b32 a55, v249
  s_waitcnt lgkmcnt(2)
  v_mfma_f32_16x16x32_bf16 v[184:187], v[208:211], v[120:123], v[184:187]
  ds_read_b128 v[220:223], v71 offset:13056
  v_accvgpr_write_b32 a134, v250
  v_mfma_f32_16x16x32_bf16 v[188:191], v[208:211], v[124:127], v[188:191]
  s_add_u32 m0, s81, 4096
  s_nop 0
  buffer_load_dwordx4 v52, s[12:15], s80 offen lds
  v_mfma_f32_16x16x32_bf16 v[192:195], v[208:211], v[128:131], v[192:195]
  v_accvgpr_write_b32 a135, v251
  s_waitcnt lgkmcnt(2)
  v_mfma_f32_16x16x32_bf16 v[184:187], v[212:215], v[132:135], v[184:187]
  ds_read_b128 v[208:211], v70 offset:13184
  s_mov_b64 exec, s[68:69]
  v_cvt_pk_bf16_f32 v170, v204, v205
  v_cvt_pk_bf16_f32 v171, v206, v207
  s_mov_b64 exec, -1
  v_mfma_f32_16x16x32_bf16 v[188:191], v[212:215], v[136:139], v[188:191]
  s_add_u32 m0, s81, 5120
  s_nop 0
  buffer_load_dwordx4 v53, s[12:15], s80 offen lds
  v_mfma_f32_16x16x32_bf16 v[192:195], v[212:215], v[140:143], v[192:195]
  s_waitcnt lgkmcnt(2)
  v_mfma_f32_16x16x32_bf16 v[196:199], v[216:219], v[72:75], 0
  ds_read_b128 v[212:215], v71 offset:13184
  v_mfma_f32_16x16x32_bf16 v[200:203], v[216:219], v[76:79], 0
  s_add_u32 m0, s81, 6144
  s_nop 0
  buffer_load_dwordx4 v54, s[12:15], s80 offen lds
  v_mfma_f32_16x16x32_bf16 v[204:207], v[216:219], v[80:83], 0
  s_waitcnt lgkmcnt(2)
  v_mfma_f32_16x16x32_bf16 v[196:199], v[220:223], v[84:87], v[196:199]
  ds_read_b128 v[216:219], v70 offset:13312
  v_cvt_pk_bf16_f32 v248, v184, v185
  v_mfma_f32_16x16x32_bf16 v[200:203], v[220:223], v[88:91], v[200:203]
  s_add_u32 m0, s81, 7168
  s_nop 0
  buffer_load_dwordx4 v55, s[12:15], s80 offen lds
  v_mfma_f32_16x16x32_bf16 v[204:207], v[220:223], v[92:95], v[204:207]
  v_cvt_pk_bf16_f32 v249, v186, v187
  s_waitcnt lgkmcnt(2)
  v_mfma_f32_16x16x32_bf16 v[196:199], v[208:211], v[96:99], v[196:199]
  ds_read_b128 v[220:223], v71 offset:13312
  v_cvt_pk_bf16_f32 v250, v188, v189
  v_mfma_f32_16x16x32_bf16 v[200:203], v[208:211], v[100:103], v[200:203]
  s_add_u32 m0, s81, 8192
  s_nop 0
  buffer_load_dwordx4 v56, s[12:15], s80 offen lds
  v_mfma_f32_16x16x32_bf16 v[204:207], v[208:211], v[104:107], v[204:207]
  v_cvt_pk_bf16_f32 v251, v190, v191
  s_waitcnt lgkmcnt(2)
  v_mfma_f32_16x16x32_bf16 v[196:199], v[212:215], v[108:111], v[196:199]
  v_accvgpr_write_b32 a56, v248
  v_mfma_f32_16x16x32_bf16 v[200:203], v[212:215], v[112:115], v[200:203]
  s_add_u32 m0, s81, 9216
  s_nop 0
  buffer_load_dwordx4 v57, s[12:15], s80 offen lds
  v_mfma_f32_16x16x32_bf16 v[204:207], v[212:215], v[116:119], v[204:207]
  v_accvgpr_write_b32 a57, v249
  s_waitcnt lgkmcnt(1)
  v_mfma_f32_16x16x32_bf16 v[196:199], v[216:219], v[120:123], v[196:199]
  v_accvgpr_write_b32 a136, v250
  v_mfma_f32_16x16x32_bf16 v[200:203], v[216:219], v[124:127], v[200:203]
  s_add_u32 m0, s81, 10240
  s_nop 0
  buffer_load_dwordx4 v58, s[12:15], s80 offen lds
  v_mfma_f32_16x16x32_bf16 v[204:207], v[216:219], v[128:131], v[204:207]
  v_accvgpr_write_b32 a137, v251
  s_waitcnt lgkmcnt(0)
  v_mfma_f32_16x16x32_bf16 v[196:199], v[220:223], v[132:135], v[196:199]
  v_cvt_pk_bf16_f32 v172, v192, v193
  v_cvt_pk_bf16_f32 v173, v194, v195
  v_mfma_f32_16x16x32_bf16 v[200:203], v[220:223], v[136:139], v[200:203]
  s_add_u32 m0, s81, 11264
  s_nop 0
  buffer_load_dwordx4 v59, s[12:15], s80 offen lds
  s_add_u32 s80, s80, 393216
  v_mfma_f32_16x16x32_bf16 v[204:207], v[220:223], v[140:143], v[204:207]
  s_add_u32 s21, s79, 1572864
  buffer_load_dwordx4 v[224:227], v63, s[24:27], s21 offen
  s_add_u32 s21, s79, 1572864
  buffer_load_dwordx4 v[228:231], v64, s[24:27], s21 offen
  s_add_u32 s21, s79, 1572864
  buffer_load_dwordx4 v[232:235], v65, s[24:27], s21 offen
  s_waitcnt vmcnt(18)
  ds_read_b128 v[208:211], v70 offset:24576
  ds_read_b128 v[212:215], v71 offset:24576
  ds_read_b128 v[216:219], v70 offset:24704
  s_waitcnt lgkmcnt(2)
  v_mfma_f32_16x16x32_bf16 v[184:187], v[208:211], v[72:75], 0
  ds_read_b128 v[220:223], v71 offset:24704
  v_mfma_f32_16x16x32_bf16 v[188:191], v[208:211], v[76:79], 0
  s_add_u32 m0, s81, 12288
  s_nop 0
  buffer_load_dwordx4 v48, s[12:15], s80 offen lds
  v_mfma_f32_16x16x32_bf16 v[192:195], v[208:211], v[80:83], 0
  s_waitcnt lgkmcnt(2)
  v_mfma_f32_16x16x32_bf16 v[184:187], v[212:215], v[84:87], v[184:187]
  ds_read_b128 v[208:211], v70 offset:24832
  v_cvt_pk_bf16_f32 v248, v196, v197
  v_mfma_f32_16x16x32_bf16 v[188:191], v[212:215], v[88:91], v[188:191]
  s_add_u32 m0, s81, 13312
  s_nop 0
  buffer_load_dwordx4 v49, s[12:15], s80 offen lds
  v_mfma_f32_16x16x32_bf16 v[192:195], v[212:215], v[92:95], v[192:195]
  v_cvt_pk_bf16_f32 v249, v198, v199
  s_waitcnt lgkmcnt(2)
  v_mfma_f32_16x16x32_bf16 v[184:187], v[216:219], v[96:99], v[184:187]
  ds_read_b128 v[212:215], v71 offset:24832
  v_cvt_pk_bf16_f32 v250, v200, v201
  v_mfma_f32_16x16x32_bf16 v[188:191], v[216:219], v[100:103], v[188:191]
  s_add_u32 m0, s81, 14336
  s_nop 0
  buffer_load_dwordx4 v50, s[12:15], s80 offen lds
  v_mfma_f32_16x16x32_bf16 v[192:195], v[216:219], v[104:107], v[192:195]
  v_cvt_pk_bf16_f32 v251, v202, v203
  s_waitcnt lgkmcnt(2)
  v_mfma_f32_16x16x32_bf16 v[184:187], v[220:223], v[108:111], v[184:187]
  ds_read_b128 v[216:219], v70 offset:25344
  v_accvgpr_write_b32 a58, v248
  v_mfma_f32_16x16x32_bf16 v[188:191], v[220:223], v[112:115], v[188:191]
  s_add_u32 m0, s81, 15360
  s_nop 0
  buffer_load_dwordx4 v51, s[12:15], s80 offen lds
  v_mfma_f32_16x16x32_bf16 v[192:195], v[220:223], v[116:119], v[192:195]
  v_accvgpr_write_b32 a59, v249
  s_waitcnt lgkmcnt(2)
  v_mfma_f32_16x16x32_bf16 v[184:187], v[208:211], v[120:123], v[184:187]
  ds_read_b128 v[220:223], v71 offset:25344
  v_accvgpr_write_b32 a138, v250
  v_mfma_f32_16x16x32_bf16 v[188:191], v[208:211], v[124:127], v[188:191]
  s_add_u32 m0, s81, 16384
  s_nop 0
  buffer_load_dwordx4 v52, s[12:15], s80 offen lds
  v_mfma_f32_16x16x32_bf16 v[192:195], v[208:211], v[128:131], v[192:195]
  v_accvgpr_write_b32 a139, v251
  s_waitcnt lgkmcnt(2)
  v_mfma_f32_16x16x32_bf16 v[184:187], v[212:215], v[132:135], v[184:187]
  ds_read_b128 v[208:211], v70 offset:25472
  s_mov_b64 exec, s[68:69]
  v_cvt_pk_bf16_f32 v172, v204, v205
  v_cvt_pk_bf16_f32 v173, v206, v207
  s_mov_b64 exec, -1
  v_mfma_f32_16x16x32_bf16 v[188:191], v[212:215], v[136:139], v[188:191]
  s_add_u32 m0, s81, 17408
  s_nop 0
  buffer_load_dwordx4 v53, s[12:15], s80 offen lds
  v_mfma_f32_16x16x32_bf16 v[192:195], v[212:215], v[140:143], v[192:195]
  s_waitcnt lgkmcnt(2)
  v_mfma_f32_16x16x32_bf16 v[196:199], v[216:219], v[72:75], 0
  ds_read_b128 v[212:215], v71 offset:25472
  v_mfma_f32_16x16x32_bf16 v[200:203], v[216:219], v[76:79], 0
  s_add_u32 m0, s81, 18432
  s_nop 0
  buffer_load_dwordx4 v54, s[12:15], s80 offen lds
  v_mfma_f32_16x16x32_bf16 v[204:207], v[216:219], v[80:83], 0
  s_waitcnt lgkmcnt(2)
  v_mfma_f32_16x16x32_bf16 v[196:199], v[220:223], v[84:87], v[196:199]
  ds_read_b128 v[216:219], v70 offset:25600
  v_cvt_pk_bf16_f32 v248, v184, v185
  v_mfma_f32_16x16x32_bf16 v[200:203], v[220:223], v[88:91], v[200:203]
  s_add_u32 m0, s81, 19456
  s_nop 0
  buffer_load_dwordx4 v55, s[12:15], s80 offen lds
  v_mfma_f32_16x16x32_bf16 v[204:207], v[220:223], v[92:95], v[204:207]
  v_cvt_pk_bf16_f32 v249, v186, v187
  s_waitcnt lgkmcnt(2)
  v_mfma_f32_16x16x32_bf16 v[196:199], v[208:211], v[96:99], v[196:199]
  ds_read_b128 v[220:223], v71 offset:25600
  v_cvt_pk_bf16_f32 v250, v188, v189
  v_mfma_f32_16x16x32_bf16 v[200:203], v[208:211], v[100:103], v[200:203]
  s_add_u32 m0, s81, 20480
  s_nop 0
  buffer_load_dwordx4 v56, s[12:15], s80 offen lds
  v_mfma_f32_16x16x32_bf16 v[204:207], v[208:211], v[104:107], v[204:207]
  v_cvt_pk_bf16_f32 v251, v190, v191
  s_waitcnt lgkmcnt(2)
  v_mfma_f32_16x16x32_bf16 v[196:199], v[212:215], v[108:111], v[196:199]
  v_accvgpr_write_b32 a60, v248
  v_mfma_f32_16x16x32_bf16 v[200:203], v[212:215], v[112:115], v[200:203]
  s_add_u32 m0, s81, 21504
  s_nop 0
  buffer_load_dwordx4 v57, s[12:15], s80 offen lds
  v_mfma_f32_16x16x32_bf16 v[204:207], v[212:215], v[116:119], v[204:207]
  v_accvgpr_write_b32 a61, v249
  s_waitcnt lgkmcnt(1)
  v_mfma_f32_16x16x32_bf16 v[196:199], v[216:219], v[120:123], v[196:199]
  v_accvgpr_write_b32 a140, v250
  v_mfma_f32_16x16x32_bf16 v[200:203], v[216:219], v[124:127], v[200:203]
  s_add_u32 m0, s81, 22528
  s_nop 0
  buffer_load_dwordx4 v58, s[12:15], s80 offen lds
  v_mfma_f32_16x16x32_bf16 v[204:207], v[216:219], v[128:131], v[204:207]
  v_accvgpr_write_b32 a141, v251
  s_waitcnt lgkmcnt(0)
  v_mfma_f32_16x16x32_bf16 v[196:199], v[220:223], v[132:135], v[196:199]
  v_cvt_pk_bf16_f32 v174, v192, v193
  v_cvt_pk_bf16_f32 v175, v194, v195
  v_mfma_f32_16x16x32_bf16 v[200:203], v[220:223], v[136:139], v[200:203]
  s_add_u32 m0, s81, 23552
  s_nop 0
  buffer_load_dwordx4 v59, s[12:15], s80 offen lds
  s_add_u32 s80, s80, 393216
  v_mfma_f32_16x16x32_bf16 v[204:207], v[220:223], v[140:143], v[204:207]
  s_waitcnt vmcnt(15)
  s_and_b32 s21, s50, 1
  s_lshl_b32 s21, s21, 4
  s_add_u32 s21, s21, s51
  s_lshl_b32 s22, s21, 10
  s_add_u32 s22, s22, s77
  s_add_u32 s23, s77, 30720
  s_cmp_lt_u32 s21, 10
  s_cselect_b32 s23, 0, s23
  s_add_u32 s22, s22, s23
  s_mul_i32 s23, s20, 122880
  s_add_u32 s22, s22, s23
  buffer_load_dwordx4 v[252:255], v4, s[8:11], s22 offen sc1
  ds_read_b128 v[208:211], v70 offset:0
  ds_read_b128 v[212:215], v71 offset:0
  ds_read_b128 v[216:219], v70 offset:128
  s_waitcnt lgkmcnt(2)
  v_mfma_f32_16x16x32_bf16 v[184:187], v[208:211], v[72:75], 0
  ds_read_b128 v[220:223], v71 offset:128
  v_mfma_f32_16x16x32_bf16 v[188:191], v[208:211], v[76:79], 0
  s_add_u32 m0, s81, 24576
  s_nop 0
  buffer_load_dwordx4 v48, s[12:15], s80 offen lds
  v_mfma_f32_16x16x32_bf16 v[192:195], v[208:211], v[80:83], 0
  s_waitcnt lgkmcnt(2)
  v_mfma_f32_16x16x32_bf16 v[184:187], v[212:215], v[84:87], v[184:187]
  ds_read_b128 v[208:211], v70 offset:256
  v_cvt_pk_bf16_f32 v248, v196, v197
  v_mfma_f32_16x16x32_bf16 v[188:191], v[212:215], v[88:91], v[188:191]
  s_add_u32 m0, s81, 25600
  s_nop 0
  buffer_load_dwordx4 v49, s[12:15], s80 offen lds
  v_mfma_f32_16x16x32_bf16 v[192:195], v[212:215], v[92:95], v[192:195]
  v_cvt_pk_bf16_f32 v249, v198, v199
  s_waitcnt lgkmcnt(2)
  v_mfma_f32_16x16x32_bf16 v[184:187], v[216:219], v[96:99], v[184:187]
  ds_read_b128 v[212:215], v71 offset:256
  v_cvt_pk_bf16_f32 v250, v200, v201
  v_mfma_f32_16x16x32_bf16 v[188:191], v[216:219], v[100:103], v[188:191]
  s_add_u32 m0, s81, 26624
  s_nop 0
  buffer_load_dwordx4 v50, s[12:15], s80 offen lds
  v_mfma_f32_16x16x32_bf16 v[192:195], v[216:219], v[104:107], v[192:195]
  v_cvt_pk_bf16_f32 v251, v202, v203
  s_waitcnt lgkmcnt(2)
  v_mfma_f32_16x16x32_bf16 v[184:187], v[220:223], v[108:111], v[184:187]
  ds_read_b128 v[216:219], v70 offset:768
  v_accvgpr_write_b32 a62, v248
  v_mfma_f32_16x16x32_bf16 v[188:191], v[220:223], v[112:115], v[188:191]
  s_add_u32 m0, s81, 27648
  s_nop 0
  buffer_load_dwordx4 v51, s[12:15], s80 offen lds
  v_mfma_f32_16x16x32_bf16 v[192:195], v[220:223], v[116:119], v[192:195]
  v_accvgpr_write_b32 a63, v249
  s_waitcnt lgkmcnt(2)
  v_mfma_f32_16x16x32_bf16 v[184:187], v[208:211], v[120:123], v[184:187]
  ds_read_b128 v[220:223], v71 offset:768
  v_accvgpr_write_b32 a142, v250
  v_mfma_f32_16x16x32_bf16 v[188:191], v[208:211], v[124:127], v[188:191]
  s_add_u32 m0, s81, 28672
  s_nop 0
  buffer_load_dwordx4 v52, s[12:15], s80 offen lds
  v_mfma_f32_16x16x32_bf16 v[192:195], v[208:211], v[128:131], v[192:195]
  v_accvgpr_write_b32 a143, v251
  s_waitcnt lgkmcnt(2)
  v_mfma_f32_16x16x32_bf16 v[184:187], v[212:215], v[132:135], v[184:187]
  ds_read_b128 v[208:211], v70 offset:896
  s_mov_b64 exec, s[68:69]
  v_cvt_pk_bf16_f32 v174, v204, v205
  v_cvt_pk_bf16_f32 v175, v206, v207
  s_mov_b64 exec, -1
  v_mfma_f32_16x16x32_bf16 v[188:191], v[212:215], v[136:139], v[188:191]
  s_add_u32 m0, s81, 29696
  s_nop 0
  buffer_load_dwordx4 v53, s[12:15], s80 offen lds
  v_mfma_f32_16x16x32_bf16 v[192:195], v[212:215], v[140:143], v[192:195]
  s_waitcnt lgkmcnt(2)
  v_mfma_f32_16x16x32_bf16 v[196:199], v[216:219], v[72:75], 0
  ds_read_b128 v[212:215], v71 offset:896
  v_mfma_f32_16x16x32_bf16 v[200:203], v[216:219], v[76:79], 0
  s_add_u32 m0, s81, 30720
  s_nop 0
  buffer_load_dwordx4 v54, s[12:15], s80 offen lds
  v_mfma_f32_16x16x32_bf16 v[204:207], v[216:219], v[80:83], 0
  s_waitcnt lgkmcnt(2)
  v_mfma_f32_16x16x32_bf16 v[196:199], v[220:223], v[84:87], v[196:199]
  ds_read_b128 v[216:219], v70 offset:1024
  v_cvt_pk_bf16_f32 v248, v184, v185
  v_mfma_f32_16x16x32_bf16 v[200:203], v[220:223], v[88:91], v[200:203]
  s_add_u32 m0, s81, 31744
  s_nop 0
  buffer_load_dwordx4 v55, s[12:15], s80 offen lds
  v_mfma_f32_16x16x32_bf16 v[204:207], v[220:223], v[92:95], v[204:207]
  v_cvt_pk_bf16_f32 v249, v186, v187
  s_waitcnt lgkmcnt(2)
  v_mfma_f32_16x16x32_bf16 v[196:199], v[208:211], v[96:99], v[196:199]
  ds_read_b128 v[220:223], v71 offset:1024
  v_cvt_pk_bf16_f32 v250, v188, v189
  v_mfma_f32_16x16x32_bf16 v[200:203], v[208:211], v[100:103], v[200:203]
  s_add_u32 m0, s81, 32768
  s_nop 0
  buffer_load_dwordx4 v56, s[12:15], s80 offen lds
  v_mfma_f32_16x16x32_bf16 v[204:207], v[208:211], v[104:107], v[204:207]
  v_cvt_pk_bf16_f32 v251, v190, v191
  s_waitcnt lgkmcnt(2)
  v_mfma_f32_16x16x32_bf16 v[196:199], v[212:215], v[108:111], v[196:199]
  v_accvgpr_write_b32 a64, v248
  v_mfma_f32_16x16x32_bf16 v[200:203], v[212:215], v[112:115], v[200:203]
  s_add_u32 m0, s81, 33792
  s_nop 0
  buffer_load_dwordx4 v57, s[12:15], s80 offen lds
  v_mfma_f32_16x16x32_bf16 v[204:207], v[212:215], v[116:119], v[204:207]
  v_accvgpr_write_b32 a65, v249
  s_waitcnt lgkmcnt(1)
  v_mfma_f32_16x16x32_bf16 v[196:199], v[216:219], v[120:123], v[196:199]
  v_accvgpr_write_b32 a144, v250
  v_mfma_f32_16x16x32_bf16 v[200:203], v[216:219], v[124:127], v[200:203]
  s_add_u32 m0, s81, 34816
  s_nop 0
  buffer_load_dwordx4 v58, s[12:15], s80 offen lds
  v_mfma_f32_16x16x32_bf16 v[204:207], v[216:219], v[128:131], v[204:207]
  v_accvgpr_write_b32 a145, v251
  s_waitcnt lgkmcnt(0)
  v_mfma_f32_16x16x32_bf16 v[196:199], v[220:223], v[132:135], v[196:199]
  v_cvt_pk_bf16_f32 v176, v192, v193
  v_cvt_pk_bf16_f32 v177, v194, v195
  v_mfma_f32_16x16x32_bf16 v[200:203], v[220:223], v[136:139], v[200:203]
  s_add_u32 m0, s81, 35840
  s_nop 0
  buffer_load_dwordx4 v59, s[12:15], s80 offen lds
  s_add_u32 s80, s80, 393216
  v_mfma_f32_16x16x32_bf16 v[204:207], v[220:223], v[140:143], v[204:207]
  s_waitcnt vmcnt(13)
  ds_read_b128 v[208:211], v70 offset:12288
  ds_read_b128 v[212:215], v71 offset:12288
  ds_read_b128 v[216:219], v70 offset:12416
  s_waitcnt lgkmcnt(2)
  v_mfma_f32_16x16x32_bf16 v[184:187], v[208:211], v[72:75], 0
  ds_read_b128 v[220:223], v71 offset:12416
  v_mfma_f32_16x16x32_bf16 v[188:191], v[208:211], v[76:79], 0
  s_add_u32 m0, s81, 0
  s_nop 0
  buffer_load_dwordx4 v48, s[12:15], s80 offen lds
  v_mfma_f32_16x16x32_bf16 v[192:195], v[208:211], v[80:83], 0
  s_waitcnt lgkmcnt(2)
  v_mfma_f32_16x16x32_bf16 v[184:187], v[212:215], v[84:87], v[184:187]
  ds_read_b128 v[208:211], v70 offset:12544
  v_cvt_pk_bf16_f32 v248, v196, v197
  v_mfma_f32_16x16x32_bf16 v[188:191], v[212:215], v[88:91], v[188:191]
  s_add_u32 m0, s81, 1024
  s_nop 0
  buffer_load_dwordx4 v49, s[12:15], s80 offen lds
  v_mfma_f32_16x16x32_bf16 v[192:195], v[212:215], v[92:95], v[192:195]
  v_cvt_pk_bf16_f32 v249, v198, v199
  s_waitcnt lgkmcnt(2)
  v_mfma_f32_16x16x32_bf16 v[184:187], v[216:219], v[96:99], v[184:187]
  ds_read_b128 v[212:215], v71 offset:12544
  v_cvt_pk_bf16_f32 v250, v200, v201
  v_mfma_f32_16x16x32_bf16 v[188:191], v[216:219], v[100:103], v[188:191]
  s_add_u32 m0, s81, 2048
  s_nop 0
  buffer_load_dwordx4 v50, s[12:15], s80 offen lds
  v_mfma_f32_16x16x32_bf16 v[192:195], v[216:219], v[104:107], v[192:195]
  v_cvt_pk_bf16_f32 v251, v202, v203
  s_waitcnt lgkmcnt(2)
  v_mfma_f32_16x16x32_bf16 v[184:187], v[220:223], v[108:111], v[184:187]
  ds_read_b128 v[216:219], v70 offset:13056
  v_accvgpr_write_b32 a66, v248
  v_mfma_f32_16x16x32_bf16 v[188:191], v[220:223], v[112:115], v[188:191]
  s_add_u32 m0, s81, 3072
  s_nop 0
  buffer_load_dwordx4 v51, s[12:15], s80 offen lds
  v_mfma_f32_16x16x32_bf16 v[192:195], v[220:223], v[116:119], v[192:195]
  v_accvgpr_write_b32 a67, v249
  s_waitcnt lgkmcnt(2)
  v_mfma_f32_16x16x32_bf16 v[184:187], v[208:211], v[120:123], v[184:187]
  ds_read_b128 v[220:223], v71 offset:13056
  v_accvgpr_write_b32 a146, v250
  v_mfma_f32_16x16x32_bf16 v[188:191], v[208:211], v[124:127], v[188:191]
  s_add_u32 m0, s81, 4096
  s_nop 0
  buffer_load_dwordx4 v52, s[12:15], s80 offen lds
  v_mfma_f32_16x16x32_bf16 v[192:195], v[208:211], v[128:131], v[192:195]
  v_accvgpr_write_b32 a147, v251
  s_waitcnt lgkmcnt(2)
  v_mfma_f32_16x16x32_bf16 v[184:187], v[212:215], v[132:135], v[184:187]
  ds_read_b128 v[208:211], v70 offset:13184
  s_mov_b64 exec, s[68:69]
  v_cvt_pk_bf16_f32 v176, v204, v205
  v_cvt_pk_bf16_f32 v177, v206, v207
  s_mov_b64 exec, -1
  v_mfma_f32_16x16x32_bf16 v[188:191], v[212:215], v[136:139], v[188:191]
  s_add_u32 m0, s81, 5120
  s_nop 0
  buffer_load_dwordx4 v53, s[12:15], s80 offen lds
  v_mfma_f32_16x16x32_bf16 v[192:195], v[212:215], v[140:143], v[192:195]
  s_waitcnt lgkmcnt(2)
  v_mfma_f32_16x16x32_bf16 v[196:199], v[216:219], v[72:75], 0
  ds_read_b128 v[212:215], v71 offset:13184
  v_mfma_f32_16x16x32_bf16 v[200:203], v[216:219], v[76:79], 0
  s_add_u32 m0, s81, 6144
  s_nop 0
  buffer_load_dwordx4 v54, s[12:15], s80 offen lds
  v_mfma_f32_16x16x32_bf16 v[204:207], v[216:219], v[80:83], 0
  s_waitcnt lgkmcnt(2)
  v_mfma_f32_16x16x32_bf16 v[196:199], v[220:223], v[84:87], v[196:199]
  ds_read_b128 v[216:219], v70 offset:13312
  v_cvt_pk_bf16_f32 v248, v184, v185
  v_mfma_f32_16x16x32_bf16 v[200:203], v[220:223], v[88:91], v[200:203]
  s_add_u32 m0, s81, 7168
  s_nop 0
  buffer_load_dwordx4 v55, s[12:15], s80 offen lds
  v_mfma_f32_16x16x32_bf16 v[204:207], v[220:223], v[92:95], v[204:207]
  v_cvt_pk_bf16_f32 v249, v186, v187
  s_waitcnt lgkmcnt(2)
  v_mfma_f32_16x16x32_bf16 v[196:199], v[208:211], v[96:99], v[196:199]
  ds_read_b128 v[220:223], v71 offset:13312
  v_cvt_pk_bf16_f32 v250, v188, v189
  v_mfma_f32_16x16x32_bf16 v[200:203], v[208:211], v[100:103], v[200:203]
  s_add_u32 m0, s81, 8192
  s_nop 0
  buffer_load_dwordx4 v56, s[12:15], s80 offen lds
  v_mfma_f32_16x16x32_bf16 v[204:207], v[208:211], v[104:107], v[204:207]
  v_cvt_pk_bf16_f32 v251, v190, v191
  s_waitcnt lgkmcnt(2)
  v_mfma_f32_16x16x32_bf16 v[196:199], v[212:215], v[108:111], v[196:199]
  v_accvgpr_write_b32 a68, v248
  v_mfma_f32_16x16x32_bf16 v[200:203], v[212:215], v[112:115], v[200:203]
  s_add_u32 m0, s81, 9216
  s_nop 0
  buffer_load_dwordx4 v57, s[12:15], s80 offen lds
  v_mfma_f32_16x16x32_bf16 v[204:207], v[212:215], v[116:119], v[204:207]
  v_accvgpr_write_b32 a69, v249
  s_waitcnt lgkmcnt(1)
  v_mfma_f32_16x16x32_bf16 v[196:199], v[216:219], v[120:123], v[196:199]
  v_accvgpr_write_b32 a148, v250
  v_mfma_f32_16x16x32_bf16 v[200:203], v[216:219], v[124:127], v[200:203]
  s_add_u32 m0, s81, 10240
  s_nop 0
  buffer_load_dwordx4 v58, s[12:15], s80 offen lds
  v_mfma_f32_16x16x32_bf16 v[204:207], v[216:219], v[128:131], v[204:207]
  v_accvgpr_write_b32 a149, v251
  s_waitcnt lgkmcnt(0)
  v_mfma_f32_16x16x32_bf16 v[196:199], v[220:223], v[132:135], v[196:199]
  v_cvt_pk_bf16_f32 v178, v192, v193
  v_cvt_pk_bf16_f32 v179, v194, v195
  v_mfma_f32_16x16x32_bf16 v[200:203], v[220:223], v[136:139], v[200:203]
  s_add_u32 m0, s81, 11264
  s_nop 0
  buffer_load_dwordx4 v59, s[12:15], s80 offen lds
  s_add_u32 s80, s80, 393216
  v_mfma_f32_16x16x32_bf16 v[204:207], v[220:223], v[140:143], v[204:207]
  s_waitcnt vmcnt(12)
  v_readlane_b32 s83, v66, 19
  s_sub_u32 s21, s83, 1
  s_lshl_b32 s21, s21, 13
  s_and_b32 s21, s21, 8192
  s_xor_b32 s76, s90, s21
  buffer_load_dword v66, v67, s[32:35], 0 offen sc1
  buffer_load_dword v42, v41, s[16:19], s76 offen sc1
  ds_read_b128 v[208:211], v70 offset:24576
  ds_read_b128 v[212:215], v71 offset:24576
  ds_read_b128 v[216:219], v70 offset:24704
  s_waitcnt lgkmcnt(2)
  v_mfma_f32_16x16x32_bf16 v[184:187], v[208:211], v[72:75], 0
  ds_read_b128 v[220:223], v71 offset:24704
  v_mfma_f32_16x16x32_bf16 v[188:191], v[208:211], v[76:79], 0
  ds_write_b128 v68, a[160:163] offset:12288
  v_mfma_f32_16x16x32_bf16 v[192:195], v[208:211], v[80:83], 0
  s_waitcnt lgkmcnt(3)
  v_mfma_f32_16x16x32_bf16 v[184:187], v[212:215], v[84:87], v[184:187]
  ds_read_b128 v[208:211], v70 offset:24832
  v_cvt_pk_bf16_f32 v248, v196, v197
  v_mfma_f32_16x16x32_bf16 v[188:191], v[212:215], v[88:91], v[188:191]
  ds_write_b128 v68, a[164:167] offset:13312
  v_mfma_f32_16x16x32_bf16 v[192:195], v[212:215], v[92:95], v[192:195]
  v_cvt_pk_bf16_f32 v249, v198, v199
  s_waitcnt lgkmcnt(4)
  v_mfma_f32_16x16x32_bf16 v[184:187], v[216:219], v[96:99], v[184:187]
  ds_read_b128 v[212:215], v71 offset:24832
  v_cvt_pk_bf16_f32 v250, v200, v201
  v_mfma_f32_16x16x32_bf16 v[188:191], v[216:219], v[100:103], v[188:191]
  ds_write_b128 v68, a[168:171] offset:14336
  v_mfma_f32_16x16x32_bf16 v[192:195], v[216:219], v[104:107], v[192:195]
  v_cvt_pk_bf16_f32 v251, v202, v203
  s_waitcnt lgkmcnt(5)
  v_mfma_f32_16x16x32_bf16 v[184:187], v[220:223], v[108:111], v[184:187]
  ds_read_b128 v[216:219], v70 offset:25344
  v_accvgpr_write_b32 a70, v248
  v_mfma_f32_16x16x32_bf16 v[188:191], v[220:223], v[112:115], v[188:191]
  ds_write_b128 v68, a[172:175] offset:15360
  v_mfma_f32_16x16x32_bf16 v[192:195], v[220:223], v[116:119], v[192:195]
  v_accvgpr_write_b32 a71, v249
  s_waitcnt lgkmcnt(5)
  v_mfma_f32_16x16x32_bf16 v[184:187], v[208:211], v[120:123], v[184:187]
  ds_read_b128 v[220:223], v71 offset:25344
  v_accvgpr_write_b32 a150, v250
  v_mfma_f32_16x16x32_bf16 v[188:191], v[208:211], v[124:127], v[188:191]
  ds_write_b128 v68, a[176:179] offset:16384
  v_mfma_f32_16x16x32_bf16 v[192:195], v[208:211], v[128:131], v[192:195]
  v_accvgpr_write_b32 a151, v251
  s_waitcnt lgkmcnt(5)
  v_mfma_f32_16x16x32_bf16 v[184:187], v[212:215], v[132:135], v[184:187]
  ds_read_b128 v[208:211], v70 offset:25472
  s_mov_b64 exec, s[68:69]
  v_cvt_pk_bf16_f32 v178, v204, v205
  v_cvt_pk_bf16_f32 v179, v206, v207
  s_mov_b64 exec, -1
  v_mfma_f32_16x16x32_bf16 v[188:191], v[212:215], v[136:139], v[188:191]
  ds_write_b128 v68, a[180:183] offset:17408
  v_mfma_f32_16x16x32_bf16 v[192:195], v[212:215], v[140:143], v[192:195]
  s_waitcnt lgkmcnt(5)
  v_mfma_f32_16x16x32_bf16 v[196:199], v[216:219], v[72:75], 0
  ds_read_b128 v[212:215], v71 offset:25472
  v_mfma_f32_16x16x32_bf16 v[200:203], v[216:219], v[76:79], 0
  ds_write_b128 v68, a[184:187] offset:18432
  v_mfma_f32_16x16x32_bf16 v[204:207], v[216:219], v[80:83], 0
  s_waitcnt lgkmcnt(5)
  v_mfma_f32_16x16x32_bf16 v[196:199], v[220:223], v[84:87], v[196:199]
  ds_read_b128 v[216:219], v70 offset:25600
  v_cvt_pk_bf16_f32 v248, v184, v185
  v_mfma_f32_16x16x32_bf16 v[200:203], v[220:223], v[88:91], v[200:203]
  ds_write_b128 v68, a[188:191] offset:19456
  v_mfma_f32_16x16x32_bf16 v[204:207], v[220:223], v[92:95], v[204:207]
  v_cvt_pk_bf16_f32 v249, v186, v187
  s_waitcnt lgkmcnt(5)
  v_mfma_f32_16x16x32_bf16 v[196:199], v[208:211], v[96:99], v[196:199]
  ds_read_b128 v[220:223], v71 offset:25600
  v_cvt_pk_bf16_f32 v250, v188, v189
  v_mfma_f32_16x16x32_bf16 v[200:203], v[208:211], v[100:103], v[200:203]
  ds_write_b128 v68, a[192:195] offset:20480
  v_mfma_f32_16x16x32_bf16 v[204:207], v[208:211], v[104:107], v[204:207]
  v_cvt_pk_bf16_f32 v251, v190, v191
  s_waitcnt lgkmcnt(5)
  v_mfma_f32_16x16x32_bf16 v[196:199], v[212:215], v[108:111], v[196:199]
  v_accvgpr_write_b32 a72, v248
  v_mfma_f32_16x16x32_bf16 v[200:203], v[212:215], v[112:115], v[200:203]
  ds_write_b128 v68, a[196:199] offset:21504
  v_mfma_f32_16x16x32_bf16 v[204:207], v[212:215], v[116:119], v[204:207]
  v_accvgpr_write_b32 a73, v249
  s_waitcnt lgkmcnt(4)
  v_mfma_f32_16x16x32_bf16 v[196:199], v[216:219], v[120:123], v[196:199]
  v_accvgpr_write_b32 a152, v250
  v_mfma_f32_16x16x32_bf16 v[200:203], v[216:219], v[124:127], v[200:203]
  ds_write_b128 v68, a[200:203] offset:22528
  v_mfma_f32_16x16x32_bf16 v[204:207], v[216:219], v[128:131], v[204:207]
  v_accvgpr_write_b32 a153, v251
  s_waitcnt lgkmcnt(3)
  v_mfma_f32_16x16x32_bf16 v[196:199], v[220:223], v[132:135], v[196:199]
  v_cvt_pk_bf16_f32 v180, v192, v193
  v_cvt_pk_bf16_f32 v181, v194, v195
  v_mfma_f32_16x16x32_bf16 v[200:203], v[220:223], v[136:139], v[200:203]
  ds_write_b128 v68, a[204:207] offset:23552
  v_mfma_f32_16x16x32_bf16 v[204:207], v[220:223], v[140:143], v[204:207]
  s_waitcnt vmcnt(2)
  ds_read_b128 v[208:211], v70 offset:0
  ds_read_b128 v[212:215], v71 offset:0
  ds_read_b128 v[216:219], v70 offset:128
  s_waitcnt lgkmcnt(2)
  v_mfma_f32_16x16x32_bf16 v[184:187], v[208:211], v[72:75], 0
  ds_read_b128 v[220:223], v71 offset:128
  v_mfma_f32_16x16x32_bf16 v[188:191], v[208:211], v[76:79], 0
  ds_write_b128 v68, a[208:211] offset:24576
  v_mfma_f32_16x16x32_bf16 v[192:195], v[208:211], v[80:83], 0
  s_waitcnt lgkmcnt(3)
  v_mfma_f32_16x16x32_bf16 v[184:187], v[212:215], v[84:87], v[184:187]
  ds_read_b128 v[208:211], v70 offset:256
  v_cvt_pk_bf16_f32 v248, v196, v197
  v_mfma_f32_16x16x32_bf16 v[188:191], v[212:215], v[88:91], v[188:191]
  ds_write_b128 v68, a[212:215] offset:25600
  v_mfma_f32_16x16x32_bf16 v[192:195], v[212:215], v[92:95], v[192:195]
  v_cvt_pk_bf16_f32 v249, v198, v199
  s_waitcnt lgkmcnt(4)
  v_mfma_f32_16x16x32_bf16 v[184:187], v[216:219], v[96:99], v[184:187]
  ds_read_b128 v[212:215], v71 offset:256
  v_cvt_pk_bf16_f32 v250, v200, v201
  v_mfma_f32_16x16x32_bf16 v[188:191], v[216:219], v[100:103], v[188:191]
  ds_write_b128 v68, a[216:219] offset:26624
  v_mfma_f32_16x16x32_bf16 v[192:195], v[216:219], v[104:107], v[192:195]
  v_cvt_pk_bf16_f32 v251, v202, v203
  s_waitcnt lgkmcnt(5)
  v_mfma_f32_16x16x32_bf16 v[184:187], v[220:223], v[108:111], v[184:187]
  ds_read_b128 v[216:219], v70 offset:768
  v_accvgpr_write_b32 a74, v248
  v_mfma_f32_16x16x32_bf16 v[188:191], v[220:223], v[112:115], v[188:191]
  ds_write_b128 v68, a[220:223] offset:27648
  v_mfma_f32_16x16x32_bf16 v[192:195], v[220:223], v[116:119], v[192:195]
  v_accvgpr_write_b32 a75, v249
  s_waitcnt lgkmcnt(5)
  v_mfma_f32_16x16x32_bf16 v[184:187], v[208:211], v[120:123], v[184:187]
  ds_read_b128 v[220:223], v71 offset:768
  v_accvgpr_write_b32 a154, v250
  v_mfma_f32_16x16x32_bf16 v[188:191], v[208:211], v[124:127], v[188:191]
  ds_write_b128 v68, a[224:227] offset:28672
  v_mfma_f32_16x16x32_bf16 v[192:195], v[208:211], v[128:131], v[192:195]
  v_accvgpr_write_b32 a155, v251
  s_waitcnt lgkmcnt(5)
  v_mfma_f32_16x16x32_bf16 v[184:187], v[212:215], v[132:135], v[184:187]
  ds_read_b128 v[208:211], v70 offset:896
  s_mov_b64 exec, s[68:69]
  v_cvt_pk_bf16_f32 v180, v204, v205
  v_cvt_pk_bf16_f32 v181, v206, v207
  s_mov_b64 exec, -1
  v_mfma_f32_16x16x32_bf16 v[188:191], v[212:215], v[136:139], v[188:191]
  ds_write_b128 v68, a[228:231] offset:29696
  v_mfma_f32_16x16x32_bf16 v[192:195], v[212:215], v[140:143], v[192:195]
  s_waitcnt lgkmcnt(5)
  v_mfma_f32_16x16x32_bf16 v[196:199], v[216:219], v[72:75], 0
  ds_read_b128 v[212:215], v71 offset:896
  v_mfma_f32_16x16x32_bf16 v[200:203], v[216:219], v[76:79], 0
  ds_write_b128 v68, a[232:235] offset:30720
  v_mfma_f32_16x16x32_bf16 v[204:207], v[216:219], v[80:83], 0
  s_waitcnt lgkmcnt(5)
  v_mfma_f32_16x16x32_bf16 v[196:199], v[220:223], v[84:87], v[196:199]
  ds_read_b128 v[216:219], v70 offset:1024
  v_cvt_pk_bf16_f32 v248, v184, v185
  v_mfma_f32_16x16x32_bf16 v[200:203], v[220:223], v[88:91], v[200:203]
  ds_write_b128 v68, a[236:239] offset:31744
  v_mfma_f32_16x16x32_bf16 v[204:207], v[220:223], v[92:95], v[204:207]
  v_cvt_pk_bf16_f32 v249, v186, v187
  s_waitcnt lgkmcnt(5)
  v_mfma_f32_16x16x32_bf16 v[196:199], v[208:211], v[96:99], v[196:199]
  ds_read_b128 v[220:223], v71 offset:1024
  v_cvt_pk_bf16_f32 v250, v188, v189
  v_mfma_f32_16x16x32_bf16 v[200:203], v[208:211], v[100:103], v[200:203]
  ds_write_b128 v68, a[240:243] offset:32768
  v_mfma_f32_16x16x32_bf16 v[204:207], v[208:211], v[104:107], v[204:207]
  v_cvt_pk_bf16_f32 v251, v190, v191
  s_waitcnt lgkmcnt(5)
  v_mfma_f32_16x16x32_bf16 v[196:199], v[212:215], v[108:111], v[196:199]
  v_accvgpr_write_b32 a76, v248
  v_mfma_f32_16x16x32_bf16 v[200:203], v[212:215], v[112:115], v[200:203]
  ds_write_b128 v68, a[244:247] offset:33792
  v_mfma_f32_16x16x32_bf16 v[204:207], v[212:215], v[116:119], v[204:207]
  v_accvgpr_write_b32 a77, v249
  s_waitcnt lgkmcnt(4)
  v_mfma_f32_16x16x32_bf16 v[196:199], v[216:219], v[120:123], v[196:199]
  v_accvgpr_write_b32 a156, v250
  v_mfma_f32_16x16x32_bf16 v[200:203], v[216:219], v[124:127], v[200:203]
  ds_write_b128 v68, a[248:251] offset:34816
  v_mfma_f32_16x16x32_bf16 v[204:207], v[216:219], v[128:131], v[204:207]
  v_accvgpr_write_b32 a157, v251
  s_waitcnt lgkmcnt(3)
  v_mfma_f32_16x16x32_bf16 v[196:199], v[220:223], v[132:135], v[196:199]
  v_cvt_pk_bf16_f32 v182, v192, v193
  v_cvt_pk_bf16_f32 v183, v194, v195
  v_mfma_f32_16x16x32_bf16 v[200:203], v[220:223], v[136:139], v[200:203]
  ds_write_b128 v68, a[252:255] offset:35840
  v_mfma_f32_16x16x32_bf16 v[204:207], v[220:223], v[140:143], v[204:207]
  s_nop 7
  v_cvt_pk_bf16_f32 v248, v196, v197
  v_cvt_pk_bf16_f32 v249, v198, v199
  v_cvt_pk_bf16_f32 v250, v200, v201
  v_cvt_pk_bf16_f32 v251, v202, v203
  v_accvgpr_write_b32 a78, v248
  v_accvgpr_write_b32 a79, v249
  v_accvgpr_write_b32 a158, v250
  v_accvgpr_write_b32 a159, v251
  s_mov_b64 exec, s[68:69]
  v_cvt_pk_bf16_f32 v182, v204, v205
  v_cvt_pk_bf16_f32 v183, v206, v207
  s_mov_b64 exec, -1
  ds_write_b128 v68, v[224:227] offset:0
  ds_write_b128 v68, v[228:231] offset:1024
  ds_write_b128 v68, v[232:235] offset:2048
  ds_write_b128 v68, v[236:239] offset:3072
  ds_write_b128 v68, v[240:243] offset:4096
  ds_write_b128 v68, v[244:247] offset:5120
  ds_write_b64 v69, v[160:161] offset:6144
  ds_write_b64 v69, v[162:163] offset:6656
  ds_write_b64 v69, v[164:165] offset:7168
  ds_write_b64 v69, v[166:167] offset:7680
  ds_write_b64 v69, v[168:169] offset:8192
  ds_write_b64 v69, v[170:171] offset:8704
  ds_write_b64 v69, v[172:173] offset:9216
  ds_write_b64 v69, v[174:175] offset:9728
  ds_write_b64 v69, v[176:177] offset:10240
  ds_write_b64 v69, v[178:179] offset:10752
  ds_write_b64 v69, v[180:181] offset:11264
  ds_write_b64 v69, v[182:183] offset:11776
  v_lshrrev_b32 v100, 1, v3
  v_lshlrev_b32 v100, 4, v100
  v_and_b32 v101, 8, v2
  v_add_u32 v100, v100, v101
  v_and_b32 v101, 1, v3
  v_lshl_add_u32 v100, v101, 2, v100
  v_bfe_u32 v101, v2, 2, 1
  v_add_u32 v100, v100, v101
  v_mul_u32_u24 v100, 96, v100
  v_and_b32 v101, 3, v2
  v_lshl_add_u32 v100, v101, 3, v100
  s_lshl_b32 s21, s20, 5
  v_add_u32 v100, s21, v100
  v_add_u32 v101, 3072, v100
  v_cndmask_b32 v88, v100, v101, s[68:69]
  v_cndmask_b32 v92, v101, v100, s[68:69]
  v_add_u32 v89, 40960, v88
  v_add_u32 v93, 40960, v92
  v_add_u32 v90, 81920, v88
  v_add_u32 v94, 81920, v92
  v_add_u32 v91, 122880, v88
  v_add_u32 v95, 122880, v92
  v_and_b32 v100, 7, v2
  v_lshl_add_u32 v100, v3, 3, v100
  v_lshrrev_b32 v101, 3, v2
  v_mul_u32_u24 v101, 40960, v101
  v_lshl_add_u32 v96, v100, 4, v101
  v_add_u32 v97, 81920, v96
  s_bfe_u32 s82, s50, 0x10001
  s_lshl_b32 s82, s82, 5
  s_lshr_b32 s21, s50, 2
  s_add_u32 s82, s82, s21
  s_mov_b32 s101, 0
  s_branch fm_13
fm_12:
  s_sleep 8
fm_14:
  buffer_load_dword v66, v67, s[32:35], 0 offen sc1
  buffer_load_dword v42, v41, s[16:19], s76 offen sc1
  s_add_u32 s101, s101, 1
  s_cmp_gt_u32 s101, 131072
  s_cbranch_scc1 end0
fm_13:
  s_waitcnt vmcnt(0)
  s_mov_b32 s84, s83
  v_readlane_b32 s83, v66, 19
  s_sub_u32 s21, s83, 1
  s_lshl_b32 s21, s21, 13
  s_and_b32 s21, s21, 8192
  s_xor_b32 s76, s90, s21
  s_cmp_eq_u32 s83, 0
  s_cbranch_scc1 fm_12
  s_cmp_eq_u32 s84, 0
  s_cbranch_scc1 fm_14
  v_readlane_b32 s22, v66, 0
  v_readlane_b32 s23, v66, 32
  s_add_u32 s22, s22, s23
  v_readlane_b32 s23, v66, 1
  s_add_u32 s22, s22, s23
  v_readlane_b32 s23, v66, 33
  s_add_u32 s22, s22, s23
  v_readlane_b32 s23, v66, 2
  s_add_u32 s22, s22, s23
  v_readlane_b32 s23, v66, 34
  s_add_u32 s22, s22, s23
  v_readlane_b32 s23, v66, 3
  s_add_u32 s22, s22, s23
  v_readlane_b32 s23, v66, 35
  s_add_u32 s22, s22, s23
  v_readlane_b32 s21, v66, 16
  v_cmp_gt_u32 vcc, 2, v42
  s_cmp_lt_u32 s22, 256
  s_cbranch_scc1 fm_12
  s_cmp_lt_u32 s21, 128
  s_cbranch_scc1 fm_12
  s_cbranch_vccnz fm_12
  v_readlane_b32 s21, v66, s82
  v_cmp_ne_u32 vcc, 32, v66
  s_cmp_ge_u32 s21, 32
  s_cselect_b32 s84, 1, 0
  s_andn2_b32 s53, s84, s53
  s_and_b32 s21, vcc_lo, 15
  s_and_b32 s22, vcc_hi, 15
  s_or_b32 s85, s21, s22
  s_xor_b32 s83, s76, s90
  s_lshl_b32 s70, s50, 4
  s_add_u32 s79, s70, s55
  s_add_u32 s70, s70, s51
  s_lshl_b32 s70, s70, 14
  s_lshl_b32 s79, s79, 14
  s_lshl_b32 s21, s56, 11
  s_add_u32 s79, s79, s21
  s_lshl_b32 s72, s50, 16
  s_lshl_b32 s21, s60, 10
  s_add_u32 s72, s72, s21
  s_add_u32 s72, s72, 136314880
  s_mov_b32 s74, 32768
  s_add_u32 s73, s70, s83
  s_add_u32 s70, s73, 4096
  s_add_u32 s72, s72, s83
  s_xor_b32 s21, s83, 8192
  s_add_u32 s79, s79, s21
  s_add_u32 s12, s48, 173080576
  s_addc_u32 s13, s49, 0
  s_mov_b32 s14, 49152
  s_mov_b32 s15, 0x00020000
  s_mov_b32 s16, s48
  s_mov_b32 s17, s49
  s_mov_b32 s18, 218103808
  s_mov_b32 s19, 0x00020000
  s_waitcnt lgkmcnt(0)
  s_lshl_b32 s21, s20, 16
  s_add_u32 s21, s21, s79
  buffer_load_dwordx4 v[144:147], v4, s[16:19], s21 offen sc1
  buffer_load_dwordx4 v[148:151], v4, s[16:19], s21 offen offset:1024 sc1
  v_subrev_u32 v100, 43008, v20
  v_subrev_u32 v101, 43008, v21
  buffer_load_dwordx4 v[112:115], v100, s[16:19], s73 offen sc1
  buffer_load_dwordx2 v[116:117], v101, s[16:19], s73 offen sc1
  v_and_b32 v100, 127, v19
  v_lshl_add_u32 v100, v3, 8, v100
  v_and_b32 v101, 2, v2
  v_cmp_eq_u32 vcc, 0, v101
  s_lshl_b32 s21, s20, 14
  s_lshl_b32 s22, s61, 7
  s_add_u32 s21, s21, s22
  s_add_u32 s21, s21, s72
  v_mov_b32 v152, 0x3f803f80
  v_mov_b32 v153, 0x3f803f80
  v_mov_b32 v154, 0x3f803f80
  v_mov_b32 v155, 0x3f803f80
  s_mov_b64 exec, vcc
  buffer_load_dwordx4 v[152:155], v100, s[16:19], s21 offen sc1
  s_mov_b64 exec, -1
  v_and_b32 v100, 7, v1
  v_mul_u32_u24 v100, 1280, v100
  v_lshrrev_b32 v101, 3, v1
  v_lshl_add_u32 v100, v101, 4, v100
  buffer_load_dwordx4 v[48:51], v100, s[36:39], 0 offen offset:0
  buffer_load_dwordx4 v[52:55], v100, s[36:39], 0 offen offset:128
  buffer_load_dwordx4 v[56:59], v100, s[36:39], 0 offen offset:256
  buffer_load_dwordx4 v[60:63], v100, s[36:39], 0 offen offset:384
  buffer_load_dwordx4 v[64:67], v100, s[36:39], 0 offen offset:512
  buffer_load_dwordx4 v[68:71], v100, s[36:39], 0 offen offset:640
  buffer_load_dwordx4 v[72:75], v100, s[36:39], 0 offen offset:768
  buffer_load_dwordx4 v[76:79], v100, s[36:39], 0 offen offset:896
  buffer_load_dwordx4 v[80:83], v100, s[36:39], 0 offen offset:1024
  buffer_load_dwordx4 v[84:87], v100, s[36:39], 0 offen offset:1152
  s_barrier
  s_cmp_eq_u32 s20, 3
  s_cbranch_scc1 w3_16
  ds_read_b64_tr_b16 a[160:161], v88 offset:12288
  ds_read_b64_tr_b16 a[162:163], v88 offset:12480
  ds_read_b64_tr_b16 a[164:165], v88 offset:18432
  ds_read_b64_tr_b16 a[166:167], v88 offset:18624
  ds_read_b64_tr_b16 a[168:169], v88 offset:24576
  ds_read_b64_tr_b16 a[170:171], v88 offset:24768
  ds_read_b64_tr_b16 a[172:173], v88 offset:30720
  ds_read_b64_tr_b16 a[174:175], v88 offset:30912
  ds_read_b64_tr_b16 a[176:177], v88 offset:0
  ds_read_b64_tr_b16 a[178:179], v88 offset:192
  ds_read_b64_tr_b16 a[180:181], v89 offset:12288
  ds_read_b64_tr_b16 a[182:183], v89 offset:12480
  ds_read_b64_tr_b16 a[184:185], v89 offset:18432
  ds_read_b64_tr_b16 a[186:187], v89 offset:18624
  ds_read_b64_tr_b16 a[188:189], v89 offset:24576
  ds_read_b64_tr_b16 a[190:191], v89 offset:24768
  ds_read_b64_tr_b16 a[192:193], v89 offset:30720
  ds_read_b64_tr_b16 a[194:195], v89 offset:30912
  ds_read_b64_tr_b16 a[196:197], v89 offset:0
  ds_read_b64_tr_b16 a[198:199], v89 offset:192
  ds_read_b64_tr_b16 a[200:201], v90 offset:12288
  ds_read_b64_tr_b16 a[202:203], v90 offset:12480
  ds_read_b64_tr_b16 a[204:205], v90 offset:18432
  ds_read_b64_tr_b16 a[206:207], v90 offset:18624
  ds_read_b64_tr_b16 a[208:209], v90 offset:24576
  ds_read_b64_tr_b16 a[210:211], v90 offset:24768
  ds_read_b64_tr_b16 a[212:213], v90 offset:30720
  ds_read_b64_tr_b16 a[214:215], v90 offset:30912
  ds_read_b64_tr_b16 a[216:217], v90 offset:0
  ds_read_b64_tr_b16 a[218:219], v90 offset:192
  ds_read_b64_tr_b16 a[220:221], v91 offset:12288
  ds_read_b64_tr_b16 a[222:223], v91 offset:12480
  ds_read_b64_tr_b16 a[224:225], v91 offset:18432
  ds_read_b64_tr_b16 a[226:227], v91 offset:18624
  ds_read_b64_tr_b16 a[228:229], v91 offset:24576
  ds_read_b64_tr_b16 a[230:231], v91 offset:24768
  ds_read_b64_tr_b16 a[232:233], v91 offset:30720
  ds_read_b64_tr_b16 a[234:235], v91 offset:30912
  ds_read_b64_tr_b16 a[236:237], v91 offset:0
  ds_read_b64_tr_b16 a[238:239], v91 offset:192
  ds_read_b64_tr_b16 a[240:241], v92 offset:12288
  ds_read_b64_tr_b16 a[242:243], v92 offset:12480
  ds_read_b64_tr_b16 a[244:245], v92 offset:18432
  ds_read_b64_tr_b16 a[246:247], v92 offset:18624
  ds_read_b64_tr_b16 a[248:249], v92 offset:24576
  ds_read_b64_tr_b16 a[250:251], v92 offset:24768
  ds_read_b64_tr_b16 a[252:253], v92 offset:30720
  ds_read_b64_tr_b16 a[254:255], v92 offset:30912
  ds_read_b64_tr_b16 v[192:193], v92 offset:0
  ds_read_b64_tr_b16 v[194:195], v92 offset:192
  ds_read_b64_tr_b16 v[196:197], v93 offset:12288
  ds_read_b64_tr_b16 v[198:199], v93 offset:12480
  ds_read_b64_tr_b16 v[200:201], v93 offset:18432
  ds_read_b64_tr_b16 v[202:203], v93 offset:18624
  ds_read_b64_tr_b16 v[204:205], v93 offset:24576
  ds_read_b64_tr_b16 v[206:207], v93 offset:24768
  ds_read_b64_tr_b16 v[208:209], v93 offset:30720
  ds_read_b64_tr_b16 v[210:211], v93 offset:30912
  ds_read_b64_tr_b16 v[212:213], v93 offset:0
  ds_read_b64_tr_b16 v[214:215], v93 offset:192
  ds_read_b64_tr_b16 v[216:217], v94 offset:12288
  ds_read_b64_tr_b16 v[218:219], v94 offset:12480
  ds_read_b64_tr_b16 v[220:221], v94 offset:18432
  ds_read_b64_tr_b16 v[222:223], v94 offset:18624
  ds_read_b64_tr_b16 v[224:225], v94 offset:24576
  ds_read_b64_tr_b16 v[226:227], v94 offset:24768
  ds_read_b64_tr_b16 v[228:229], v94 offset:30720
  ds_read_b64_tr_b16 v[230:231], v94 offset:30912
  ds_read_b64_tr_b16 v[232:233], v94 offset:0
  ds_read_b64_tr_b16 v[234:235], v94 offset:192
  ds_read_b64_tr_b16 v[236:237], v95 offset:12288
  ds_read_b64_tr_b16 v[238:239], v95 offset:12480
  ds_read_b64_tr_b16 v[240:241], v95 offset:18432
  ds_read_b64_tr_b16 v[242:243], v95 offset:18624
  ds_read_b64_tr_b16 v[244:245], v95 offset:24576
  ds_read_b64_tr_b16 v[246:247], v95 offset:24768
  ds_read_b64_tr_b16 v[248:249], v95 offset:30720
  ds_read_b64_tr_b16 v[250:251], v95 offset:30912
  ds_read_b64_tr_b16 v[252:253], v95 offset:0
  ds_read_b64_tr_b16 v[254:255], v95 offset:192
  s_branch w3_17
w3_16:
  ds_read_b128 a[160:163], v96 offset:36864
  ds_read_b128 a[164:167], v96 offset:37376
  ds_read_b128 a[168:171], v96 offset:37888
  ds_read_b128 a[172:175], v96 offset:38400
  ds_read_b128 a[176:179], v96 offset:38912
  ds_read_b128 a[180:183], v96 offset:39424
  ds_read_b128 a[184:187], v96 offset:39936
  ds_read_b128 a[188:191], v96 offset:40448
  ds_read_b128 a[192:195], v96 offset:6144
  ds_read_b128 a[196:199], v96 offset:6656
  ds_read_b128 a[200:203], v96 offset:7168
  ds_read_b128 a[204:207], v96 offset:7680
  ds_read_b128 a[208:211], v96 offset:8192
  ds_read_b128 a[212:215], v96 offset:8704
  ds_read_b128 a[216:219], v96 offset:9216
  ds_read_b128 a[220:223], v96 offset:9728
  ds_read_b128 a[224:227], v96 offset:10240
  ds_read_b128 a[228:231], v96 offset:10752
  ds_read_b128 a[232:235], v96 offset:11264
  ds_read_b128 a[236:239], v96 offset:11776
  ds_read_b128 a[240:243], v97 offset:36864
  ds_read_b128 a[244:247], v97 offset:37376
  ds_read_b128 a[248:251], v97 offset:37888
  ds_read_b128 a[252:255], v97 offset:38400
  ds_read_b128 v[192:195], v97 offset:38912
  ds_read_b128 v[196:199], v97 offset:39424
  ds_read_b128 v[200:203], v97 offset:39936
  ds_read_b128 v[204:207], v97 offset:40448
  ds_read_b128 v[208:211], v97 offset:6144
  ds_read_b128 v[212:215], v97 offset:6656
  ds_read_b128 v[216:219], v97 offset:7168
  ds_read_b128 v[220:223], v97 offset:7680
  ds_read_b128 v[224:227], v97 offset:8192
  ds_read_b128 v[228:231], v97 offset:8704
  ds_read_b128 v[232:235], v97 offset:9216
  ds_read_b128 v[236:239], v97 offset:9728
  ds_read_b128 v[240:243], v97 offset:10240
  ds_read_b128 v[244:247], v97 offset:10752
  ds_read_b128 v[248:251], v97 offset:11264
  ds_read_b128 v[252:255], v97 offset:11776
w3_17:
  s_cmp_eq_u32 s85, 0
  s_cbranch_scc1 fm_15
  s_cmp_eq_u32 s20, 3
  s_cbranch_scc1 ar_19
  s_mov_b64 exec, s[64:65]
  s_cmp_eq_u32 s20, 2
  s_cbranch_scc1 ar_18
  s_mov_b32 s21, 0
  buffer_store_dwordx2 v[28:29], v8, s[8:11], s21 offen sc1
  s_mov_b32 s21, 122880
  buffer_store_dwordx2 v[28:29], v8, s[8:11], s21 offen sc1
  s_mov_b32 s21, 245760
  buffer_store_dwordx2 v[28:29], v8, s[8:11], s21 offen sc1
  s_mov_b32 s21, 368640
  buffer_store_dwordx2 v[28:29], v8, s[8:11], s21 offen sc1
  s_branch ar_20
ar_18:
  s_mov_b32 s21, 0
  buffer_store_dword v28, v8, s[8:11], s21 offen sc1
  buffer_store_dword v28, v8, s[8:11], s21 offen offset:128 sc1
  s_mov_b32 s21, 122880
  buffer_store_dword v28, v8, s[8:11], s21 offen sc1
  buffer_store_dword v28, v8, s[8:11], s21 offen offset:128 sc1
  s_mov_b32 s21, 245760
  buffer_store_dword v28, v8, s[8:11], s21 offen sc1
  buffer_store_dword v28, v8, s[8:11], s21 offen offset:128 sc1
  s_mov_b32 s21, 368640
  buffer_store_dword v28, v8, s[8:11], s21 offen sc1
  buffer_store_dword v28, v8, s[8:11], s21 offen offset:128 sc1
ar_20:
  s_cmp_eq_u32 s78, 0
  s_cbranch_scc1 ar_21
  s_mov_b64 exec, s[62:63]
  s_add_u32 s21, s77, 0
  buffer_store_dword v28, v17, s[8:11], s21 offen sc1
  s_add_u32 s21, s77, 122880
  buffer_store_dword v28, v17, s[8:11], s21 offen sc1
  s_add_u32 s21, s77, 245760
  buffer_store_dword v28, v17, s[8:11], s21 offen sc1
  s_add_u32 s21, s77, 368640
  buffer_store_dword v28, v17, s[8:11], s21 offen sc1
  s_branch ar_21
ar_19:
  buffer_store_dword v28, v34, s[8:11], 0 offen sc1
  s_mov_b64 exec, s[66:67]
  s_mov_b32 s21, 0
  buffer_store_dwordx4 v[28:31], v15, s[4:7], s21 offen sc1
  s_mov_b32 s21, 262144
  buffer_store_dwordx4 v[28:31], v15, s[4:7], s21 offen sc1
  s_mov_b32 s21, 524288
  buffer_store_dwordx4 v[28:31], v15, s[4:7], s21 offen sc1
  s_mov_b32 s21, 786432
  buffer_store_dwordx4 v[28:31], v15, s[4:7], s21 offen sc1
  s_mov_b32 s21, 8192
  buffer_store_dwordx4 v[28:31], v15, s[4:7], s21 offen sc1
  s_mov_b32 s21, 270336
  buffer_store_dwordx4 v[28:31], v15, s[4:7], s21 offen sc1
  s_mov_b32 s21, 532480
  buffer_store_dwordx4 v[28:31], v15, s[4:7], s21 offen sc1
  s_mov_b32 s21, 794624
  buffer_store_dwordx4 v[28:31], v15, s[4:7], s21 offen sc1
ar_21:
  s_mov_b64 exec, -1
  s_waitcnt vmcnt(0)
  s_barrier
  s_mov_b32 s21, 100
  s_cmp_lg_u32 s20, 0
  s_cbranch_scc1 af_22
  v_mov_b32 v166, 0
  v_mov_b32 v167, 1
  s_mov_b64 exec, 1
  buffer_atomic_add v167, v166, s[32:35], s21 offen sc1
  s_mov_b64 exec, -1
  s_nop 1
af_22:
  s_cmp_lg_u32 s20, 0
  s_cbranch_scc1 wf_24
  v_mov_b32 v166, 0
  s_mov_b32 s101, 0
wf_23:
  buffer_load_dword v167, v166, s[32:35], s21 offen sc1
  s_add_u32 s101, s101, 1
  s_cmp_gt_u32 s101, 131072
  s_cbranch_scc1 end0
  s_waitcnt vmcnt(0)
  v_readfirstlane_b32 s100, v167
  s_cmp_ge_u32 s100, 128
  s_cbranch_scc1 wf_24
  s_sleep 8
  s_branch wf_23
wf_24:
  s_barrier
fm_15:
  s_xor_b32 s74, s74, 16384
  s_add_u32 s73, s73, 2097152
  s_xor_b32 s73, s73, 8192
  s_add_u32 s79, s79, 2097152
  s_xor_b32 s79, s79, 8192
  s_add_u32 s21, s72, 524288
  s_xor_b32 s72, s72, s21
  s_lshr_b32 s72, s72, 8
  s_and_b32 s72, s72, 8192
  s_xor_b32 s72, s72, s21
  s_add_u32 s71, s73, 4096
  s_mov_b32 s91, 1024
  s_sub_u32 s21, s73, 0
  s_cmp_lt_u32 s21, 125829120
  s_cselect_b32 s71, s71, s79
  s_cselect_b32 s91, s91, 65536
  v_add_u32 v15, s83, v15
  v_add_u32 v16, s83, v16
  s_mov_b32 s75, s77
  s_lshl_b32 s77, s58, 7
  s_lshl_b32 s21, s56, 3
  s_add_u32 s77, s77, s21
  s_add_u32 s77, s77, 0
  s_xor_b32 s77, s77, s83
  s_mov_b32 s80, 1400897536
  s_mov_b32 s52, 0
  s_mov_b32 s81, 0
  v_xor_b32 v18, 16384, v18
  v_xor_b32 v19, 16384, v19
  v_xor_b32 v20, 16384, v20
  v_xor_b32 v21, 16384, v21
  v_mov_b32 v168, 0x3f803f80
  v_mov_b32 v169, 0x3f803f80
  v_mov_b32 v170, 0x3f803f80
  v_mov_b32 v171, 0x3f803f80
  v_mov_b32 v166, 0x3f003f00
  v_mov_b32 v167, 0x3f003f00
  s_waitcnt lgkmcnt(0)
  s_barrier
  ds_write_b128 v23, v[168:171] offset:46080
  ds_write_b128 v23, v[168:171] offset:62464
  ds_write_b64 v23, v[166:167] offset:13568
  v_mov_b32 v88, 0
  v_mov_b32 v89, 0
  v_mov_b32 v90, 0
  v_mov_b32 v91, 0
  v_mov_b32 v92, 0
  v_mov_b32 v93, 0
  v_mov_b32 v94, 0
  v_mov_b32 v95, 0
  v_mov_b32 v96, 0
  v_mov_b32 v97, 0
  v_mov_b32 v98, 0
  v_mov_b32 v99, 0
  v_mov_b32 v100, 0
  v_mov_b32 v101, 0
  v_mov_b32 v102, 0
  v_mov_b32 v103, 0
  v_mov_b32 v110, 0
  v_mov_b32 v111, 0
  v_mov_b32 v118, 0
  v_mov_b32 v119, 0
  v_mov_b32 v142, 0
  v_mov_b32 v143, 0
  v_mov_b32 v162, 0
  v_mov_b32 v163, 0
  s_and_b32 s21, s52, 3
  s_mul_i32 s56, s21, 122880
  s_add_u32 s21, s52, 1
  s_and_b32 s21, s21, 3
  s_mul_i32 s55, s21, 122880
  s_add_u32 s55, s55, s75
  s_add_u32 s21, s52, 2
  s_and_b32 s21, s21, 3
  s_mul_i32 s57, s21, 122880
  s_add_u32 s21, s52, 3
  s_and_b32 s21, s21, 3
  s_mul_i32 s59, s21, 122880
  s_add_u32 s59, s59, s75
  s_bfe_u32 s61, s52, 0x10002
  s_and_b32 s21, s52, 3
  s_lshl_b32 s60, s21, 18
  s_mov_b32 s58, s55
  s_waitcnt lgkmcnt(0)
  s_lshl_b32 s21, s53, 2
  s_add_u32 s21, s21, s20
  s_cmp_eq_u32 s21, 0
  s_cbranch_scc1 E_25
  s_cmp_eq_u32 s21, 4
  s_cbranch_scc1 E_26
  s_cmp_eq_u32 s21, 1
  s_cbranch_scc1 E_27
  s_cmp_eq_u32 s21, 5
  s_cbranch_scc1 E_28
  s_cmp_eq_u32 s21, 2
  s_cbranch_scc1 E_29
  s_cmp_eq_u32 s21, 6
  s_cbranch_scc1 E_30
  s_cmp_eq_u32 s21, 3
  s_cbranch_scc1 E_31
  s_cmp_eq_u32 s21, 7
  s_cbranch_scc1 E_32
  s_branch end0
E_26:
  v_add_u32 v190, 0, v4
  ds_write_b64 v6, v[28:29]
  ds_write_b32 v13, v28
  ds_write_b32 v14, v28
  s_waitcnt vmcnt(0)
  ds_write_b128 v190, v[48:51] offset:0
  ds_write_b128 v190, v[52:55] offset:1024
  s_waitcnt lgkmcnt(0)
  s_add_u32 m0, s74, 4096
  s_add_u32 s21, s79, 131072
  buffer_load_dwordx4 v4, s[16:19], s21 offen offset:1024 sc1 lds
  s_add_u32 m0, s74, 9216
  s_add_u32 s21, s72, 32768
  buffer_load_dwordx4 v32, s[16:19], s21 offen sc1 lds
  s_xor_b32 s74, s74, 16384
  s_add_u32 s73, s73, 2097152
  s_xor_b32 s73, s73, 8192
  s_add_u32 s79, s79, 2097152
  s_xor_b32 s79, s79, 8192
  s_add_u32 s21, s72, 524288
  s_xor_b32 s72, s72, s21
  s_lshr_b32 s72, s72, 8
  s_and_b32 s72, s72, 8192
  s_xor_b32 s72, s72, s21
  s_add_u32 s71, s73, 4096
  s_mov_b32 s91, 1024
  s_sub_u32 s21, s73, 0
  s_cmp_lt_u32 s21, 125829120
  s_cselect_b32 s71, s71, s79
  s_cselect_b32 s91, s91, 65536
  s_branch mo_38
  .p2align 3
top_33:
  s_waitcnt vmcnt(1)
  ds_write_b128 v190, v[48:51] offset:0
  v_cmp_eq_u32 s[22:23], -1, v48
  s_waitcnt vmcnt(0)
  ds_write_b128 v190, v[52:55] offset:1024
  v_cmp_eq_u32 s[98:99], -1, v52
  s_or_b64 vcc, s[22:23], s[98:99]
  s_cbranch_scc1 mr_34
mo_38:
  s_barrier
  ds_read_b128 v[56:59], v4 offset:2048
  ds_read_b128 v[60:63], v4 offset:3072
  v_smfmac_f32_16x16x64_bf16 v[92:95], v[48:51], a[240:247], v22
  ds_read_b128 v[64:67], v4 offset:4096
  v_smfmac_f32_16x16x64_bf16 v[88:91], v[48:51], a[160:167], v22
  ds_read_b128 v[68:71], v4 offset:5120
  v_smfmac_f32_16x16x64_bf16 v[92:95], v[52:55], a[248:255], v22
  ds_read_b128 v[72:75], v4 offset:6144
  v_smfmac_f32_16x16x64_bf16 v[88:91], v[52:55], a[168:175], v22
  s_waitcnt lgkmcnt(4)
  ds_read_b128 v[76:79], v4 offset:7168
  v_smfmac_f32_16x16x64_bf16 v[92:95], v[56:59], v[192:199], v22
  ds_read_b128 v[80:83], v4 offset:8192
  v_smfmac_f32_16x16x64_bf16 v[88:91], v[56:59], a[176:183], v22
  s_waitcnt lgkmcnt(5)
  ds_read_b128 v[84:87], v4 offset:9216
  v_smfmac_f32_16x16x64_bf16 v[92:95], v[60:63], v[200:207], v22
  v_smfmac_f32_16x16x64_bf16 v[88:91], v[60:63], a[184:191], v22
  s_waitcnt lgkmcnt(5)
  v_smfmac_f32_16x16x64_bf16 v[92:95], v[64:67], v[208:215], v22
  s_waitcnt lgkmcnt(4)
  v_smfmac_f32_16x16x64_bf16 v[92:95], v[68:71], v[216:223], v22
  s_waitcnt lgkmcnt(3)
  v_smfmac_f32_16x16x64_bf16 v[92:95], v[72:75], v[224:231], v22
  s_waitcnt lgkmcnt(2)
  v_smfmac_f32_16x16x64_bf16 v[92:95], v[76:79], v[232:239], v22
  s_waitcnt lgkmcnt(1)
  v_smfmac_f32_16x16x64_bf16 v[92:95], v[80:83], v[240:247], v22
  s_waitcnt lgkmcnt(0)
  v_smfmac_f32_16x16x64_bf16 v[92:95], v[84:87], v[248:255], v22
  v_smfmac_f32_16x16x64_bf16 v[88:91], v[64:67], a[192:199], v22
  v_smfmac_f32_16x16x64_bf16 v[88:91], v[68:71], a[200:207], v22
  v_smfmac_f32_16x16x64_bf16 v[88:91], v[72:75], a[208:215], v22
  v_permlane32_swap_b32 v92, v93
  v_smfmac_f32_16x16x64_bf16 v[88:91], v[76:79], a[216:223], v22
  v_permlane32_swap_b32 v94, v95
  v_smfmac_f32_16x16x64_bf16 v[88:91], v[80:83], a[224:231], v22
  v_permlane32_swap_b32 v93, v92
  v_smfmac_f32_16x16x64_bf16 v[88:91], v[84:87], a[232:239], v22
  v_permlane32_swap_b32 v95, v94
  v_pk_mul_f32 v[120:121], v[92:93], v[24:25] op_sel:[1,0] op_sel_hi:[0,1]
  v_pk_mul_f32 v[122:123], v[94:95], v[24:25] op_sel:[1,0] op_sel_hi:[0,1]
  s_nop 4
  v_pk_fma_f32 v[88:89], v[88:89], v[24:25], v[120:121]
  v_pk_fma_f32 v[90:91], v[90:91], v[24:25], v[122:123]
  v_cvt_pk_bf16_f32 v120, v88, v89
  v_cvt_pk_bf16_f32 v121, v90, v91
  ds_write_b64 v6, v[120:121]
  s_barrier
  ds_read_b64_tr_b16 v[104:105], v7 offset:0
  ds_read_b64_tr_b16 v[106:107], v7 offset:768
  ds_read_b64_tr_b16 v[108:109], v7 offset:1536
  s_waitcnt lgkmcnt(1)
  v_mfma_f32_16x16x32_bf16 v[120:123], v[112:115], v[104:107], 0
  s_waitcnt lgkmcnt(0)
  v_mfma_f32_16x16x32_bf16 v[120:123], v[116:119], v[108:111], v[120:123]
  s_mov_b64 exec, s[64:65]
  s_nop 6
  v_cmpx_o_f32 vcc, v120, v121
  v_cvt_pk_f16_f32 v120, v120, v121
  v_cvt_pk_f16_f32 v121, v122, v123
  buffer_store_dwordx2 v[120:121], v8, s[8:11], s56 offen
  s_xor_b64 s[98:99], exec, s[64:65]
  s_mov_b64 exec, -1
  s_waitcnt lgkmcnt(0)
  s_barrier
  ds_read_b64_tr_b16 v[104:105], v7 offset:0
  ds_read_b64_tr_b16 v[106:107], v7 offset:768
  ds_read_b64_tr_b16 v[108:109], v7 offset:1536
  ds_read_b32 v27, v12 offset:12544
  ds_read_b64 v[140:141], v11
  s_waitcnt lgkmcnt(1)
  v_cmp_u_f32 vcc, v104, v106
  v_cmp_u_f32 s[22:23], v108, v27
  s_nop 1
  s_or_b64 vcc, vcc, s[22:23]
  s_cbranch_vccnz mn_35
mk_36:
  s_cmp_eq_u32 s52, 63
  s_cbranch_scc1 last_37
  s_cmp_lg_u64 s[98:99], 0
  s_cbranch_scc1 sf_39
sf_40:
  s_nop 15
  s_nop 10
  v_smfmac_f32_16x16x64_bf16 v[96:99], v[48:51], a[0:7], v22
  v_smfmac_f32_16x16x64_bf16 v[100:103], v[48:51], a[80:87], v22
  v_smfmac_f32_16x16x64_bf16 v[96:99], v[52:55], a[8:15], v22
  v_smfmac_f32_16x16x64_bf16 v[100:103], v[52:55], a[88:95], v22
  v_smfmac_f32_16x16x64_bf16 v[96:99], v[56:59], a[16:23], v22
  v_smfmac_f32_16x16x64_bf16 v[100:103], v[56:59], a[96:103], v22
  buffer_load_dwordx4 v[132:135], v10, s[8:11], s56 offen sc1
  v_smfmac_f32_16x16x64_bf16 v[96:99], v[60:63], a[24:31], v22
  buffer_load_dwordx4 v[124:127], v9, s[8:11], s56 offen sc1
  v_smfmac_f32_16x16x64_bf16 v[96:99], v[64:67], a[32:39], v22
  buffer_load_dwordx4 v[128:131], v9, s[8:11], s56 offen offset:1024 sc1
  v_smfmac_f32_16x16x64_bf16 v[96:99], v[68:71], a[40:47], v22
  v_smfmac_f32_16x16x64_bf16 v[96:99], v[72:75], a[48:55], v22
  v_smfmac_f32_16x16x64_bf16 v[96:99], v[76:79], a[56:63], v22
  v_smfmac_f32_16x16x64_bf16 v[96:99], v[80:83], a[64:71], v22
  v_smfmac_f32_16x16x64_bf16 v[96:99], v[84:87], a[72:79], v22
  v_smfmac_f32_16x16x64_bf16 v[100:103], v[60:63], a[104:111], v22
  v_smfmac_f32_16x16x64_bf16 v[100:103], v[64:67], a[112:119], v22
  v_smfmac_f32_16x16x64_bf16 v[100:103], v[68:71], a[120:127], v22
  v_smfmac_f32_16x16x64_bf16 v[100:103], v[72:75], a[128:135], v22
  v_cvt_pk_bf16_f32 v136, v96, v97
  v_smfmac_f32_16x16x64_bf16 v[100:103], v[76:79], a[136:143], v22
  v_cvt_pk_bf16_f32 v137, v98, v99
  v_smfmac_f32_16x16x64_bf16 v[100:103], v[80:83], a[144:151], v22
  v_smfmac_f32_16x16x64_bf16 v[100:103], v[84:87], a[152:159], v22
  s_nop 7
  v_cvt_pk_bf16_f32 v138, v100, v101
  v_cvt_pk_bf16_f32 v139, v102, v103
  s_waitcnt vmcnt(2) lgkmcnt(0)
  v_pk_add_f16 v164, v132, v133
  v_pk_add_f16 v165, v134, v135
  v_fma_mix_f32 v170, v164, 1.0, v165 op_sel:[0,0,0] op_sel_hi:[1,0,1]
  v_fma_mix_f32 v171, v164, 1.0, v165 op_sel:[1,0,1] op_sel_hi:[1,0,1]
  v_exp_f32 v176, v170
  v_exp_f32 v177, v171
  s_waitcnt vmcnt(1)
  v_cvt_pk_bf16_f32 v160, v176, v177
  v_pk_add_f16 v120, v124, v126
  v_pk_add_f16 v121, v125, v127
  v_mov_b32_dpp v161, v160 row_ror:8 row_mask:0xf bank_mask:0xf
  s_waitcnt vmcnt(0)
  v_pk_add_f16 v122, v128, v130
  v_mfma_f32_16x16x32_bf16 v[178:181], v[140:143], v[160:163], 0
  v_fma_mix_f32 v166, v120, 1.0, v122 op_sel:[0,0,0] op_sel_hi:[1,0,1]
  v_fma_mix_f32 v167, v120, 1.0, v122 op_sel:[1,0,1] op_sel_hi:[1,0,1]
  v_cmp_u_f32 vcc, v166, v170
  v_pk_add_f16 v123, v129, v131
  v_exp_f32 v172, v166
  v_mfma_f32_16x16x32_bf16 v[182:185], v[136:139], v[160:163], 0
  s_cbranch_vccnz sr_41
  v_exp_f32 v173, v167
  v_fma_mix_f32 v168, v121, 1.0, v123 op_sel:[0,0,0] op_sel_hi:[1,0,1]
  v_fma_mix_f32 v169, v121, 1.0, v123 op_sel:[1,0,1] op_sel_hi:[1,0,1]
  v_cvt_pk_bf16_f32 v156, v172, v173
  v_exp_f32 v174, v168
  v_exp_f32 v175, v169
  v_mov_b32_dpp v158, v156 row_ror:8 row_mask:0xf bank_mask:0xf
  v_cvt_pk_bf16_f32 v157, v174, v175
  v_mfma_f32_16x16x32_bf16 v[186:189], v[138:141], v[160:163], 0
  s_nop 0
  v_mov_b32_dpp v159, v157 row_ror:8 row_mask:0xf bank_mask:0xf
  s_nop 1
pv_42:
  v_mfma_f32_16x16x32_bf16 v[178:181], v[152:155], v[156:159], v[178:181]
  v_mfma_f32_16x16x32_bf16 v[182:185], v[144:147], v[156:159], v[182:185]
  v_mfma_f32_16x16x32_bf16 v[186:189], v[148:151], v[156:159], v[186:189]
  s_mov_b64 exec, s[62:63]
  s_nop 0
  v_rcp_f32 v164, v180
  v_cmp_ngt_f32 s[22:23], s80, v180
  v_cmp_ngt_f32 vcc, s80, v164
  v_pk_mul_f32 v[182:183], v[182:183], v[164:165] op_sel_hi:[1,0]
  v_pk_mul_f32 v[184:185], v[184:185], v[164:165] op_sel_hi:[1,0]
  v_pk_mul_f32 v[178:179], v[178:179], v[164:165] op_sel_hi:[1,0]
  v_pk_mul_f32 v[186:187], v[186:187], v[164:165] op_sel_hi:[1,0]
  v_pk_mul_f32 v[188:189], v[188:189], v[164:165] op_sel_hi:[1,0]
  v_cvt_pk_f16_f32 v64, v178, v179
  s_or_b64 vcc, vcc, s[22:23]
  s_cbranch_scc1 fx_44
fk_45:
  ds_write_b32 v14, v64
  v_cvt_pk_f16_f32 v60, v182, v183
  v_cvt_pk_f16_f32 v61, v184, v185
  v_cvt_pk_f16_f32 v62, v186, v187
  v_cvt_pk_f16_f32 v63, v188, v189
  ds_write_b128 v13, v[60:63]
  s_barrier
  s_mov_b64 exec, -1
  s_add_u32 m0, s74, 4096
  s_add_u32 s21, s79, 131072
  buffer_load_dwordx4 v4, s[16:19], s21 offen offset:1024 sc1 lds
  s_add_u32 m0, s74, 9216
  s_add_u32 s21, s72, 32768
  buffer_load_dwordx4 v32, s[16:19], s21 offen sc1 lds
  s_xor_b32 s74, s74, 16384
  s_add_u32 s73, s73, 2097152
  s_xor_b32 s73, s73, 8192
  s_add_u32 s79, s79, 2097152
  s_xor_b32 s79, s79, 8192
  s_add_u32 s21, s72, 524288
  s_xor_b32 s72, s72, s21
  s_lshr_b32 s72, s72, 8
  s_and_b32 s72, s72, 8192
  s_xor_b32 s72, s72, s21
  s_add_u32 s71, s73, 4096
  s_mov_b32 s91, 1024
  s_sub_u32 s21, s73, 0
  s_cmp_lt_u32 s21, 125829120
  s_cselect_b32 s71, s71, s79
  s_cselect_b32 s91, s91, 65536
  v_permlane32_swap_b32 v96, v100
  v_permlane32_swap_b32 v97, v101
  v_permlane32_swap_b32 v98, v102
  v_permlane32_swap_b32 v99, v103
  v_pk_add_f32 v[96:97], v[96:97], v[100:101]
  v_pk_add_f32 v[98:99], v[98:99], v[102:103]
  v_cvt_pk_bf16_f32 v100, v96, v97
  v_cvt_pk_bf16_f32 v101, v98, v99
  s_nop 0
  v_permlane32_swap_b32 v100, v102
  v_permlane32_swap_b32 v101, v103
  v_min_u32 v100, -2, v100
  s_nop 6
  buffer_store_dwordx4 v[100:103], v26, s[16:19], s70 offen sc1
  v_min_u32 v104, -2, v104
  buffer_store_dwordx4 v[104:107], v36, s[16:19], s70 offen offset:2560 sc1
  s_add_u32 s70, s70, 2097152
  s_xor_b32 s70, s70, 8192
  ds_read_b128 v[144:147], v18
  ds_read_b128 v[148:151], v18 offset:1024
  ds_read_b128 v[152:155], v19
  ds_read_b128 v[112:115], v20
  ds_read_b64 v[116:117], v21
  v_xor_b32 v18, 16384, v18
  v_xor_b32 v19, 16384, v19
  v_xor_b32 v20, 16384, v20
  v_xor_b32 v21, 16384, v21
  v_mov_b32 v88, 0
  v_mov_b32 v89, 0
  v_mov_b32 v90, 0
  v_mov_b32 v91, 0
  v_mov_b32 v92, 0
  v_mov_b32 v93, 0
  v_mov_b32 v94, 0
  v_mov_b32 v95, 0
  v_mov_b32 v96, 0
  v_mov_b32 v97, 0
  v_mov_b32 v98, 0
  v_mov_b32 v99, 0
  v_mov_b32 v100, 0
  v_mov_b32 v101, 0
  v_mov_b32 v102, 0
  v_mov_b32 v103, 0
  s_mov_b32 s81, 0
  s_waitcnt lgkmcnt(0)
  s_barrier
  s_mov_b64 exec, s[64:65]
  buffer_store_dwordx2 v[28:29], v8, s[8:11], s57 offen
  s_mov_b64 exec, -1
  ds_write_b128 v190, v[28:31] offset:0
  ds_write_b128 v190, v[28:31] offset:1024
  ds_write_b64 v6, v[28:29]
  s_mov_b64 exec, s[62:63]
  buffer_store_dword v28, v17, s[8:11], s59 offen
  s_mov_b64 exec, -1
  s_sleep 3
  s_nop 1
  buffer_load_dwordx4 v[68:71], v16, s[4:7], s60 offen sc1
  s_sleep 3
  s_nop 1
  buffer_load_dwordx4 v[72:75], v16, s[4:7], s60 offen sc1
  s_waitcnt vmcnt(1)
  v_mfma_f32_16x16x32_f16 v[120:123], v[44:47], v[68:71], 0
  v_bitop3_b32 v27, v68, s61, 1 bitop3:0x28
  v_cmp_ne_u32 vcc, 0, v27
  s_nop 1
  s_cbranch_vccnz p2_50
  s_nop 2
pg_49:
  v_add_f32_dpp v120, v120, v120 row_ror:8 row_mask:0xf bank_mask:0xf
  v_add_f32_dpp v121, v121, v121 row_ror:8 row_mask:0xf bank_mask:0xf
  s_mov_b64 exec, s[62:63]
  v_cvt_pk_bf16_f32 v120, v120, v121
  v_min_u32 v120, -2, v120
  buffer_store_dword v120, v17, s[8:11], s55 offen
  s_mov_b64 exec, -1
nt_46:
  s_barrier
  s_mov_b32 s58, s55
  s_add_u32 s52, s52, 1
  ds_write_b32 v13, v28
  ds_write_b32 v14, v28
  s_and_b32 s21, s52, 3
  s_mul_i32 s56, s21, 122880
  s_add_u32 s21, s52, 1
  s_and_b32 s21, s21, 3
  s_mul_i32 s55, s21, 122880
  s_add_u32 s55, s55, s75
  s_add_u32 s21, s52, 2
  s_and_b32 s21, s21, 3
  s_mul_i32 s57, s21, 122880
  s_add_u32 s21, s52, 3
  s_and_b32 s21, s21, 3
  s_mul_i32 s59, s21, 122880
  s_add_u32 s59, s59, s75
  s_bfe_u32 s61, s52, 0x10002
  s_and_b32 s21, s52, 3
  s_lshl_b32 s60, s21, 18
  s_mov_b32 s54, 0
  s_sleep 2
  s_nop 10
  s_waitcnt lgkmcnt(0)
  buffer_load_dwordx4 v[48:51], v190, s[8:11], s58 offen offset:0 sc1
  buffer_load_dwordx4 v[52:55], v190, s[8:11], s58 offen offset:1024 sc1
  s_branch top_33
mr_34:
  s_mov_b64 exec, s[22:23]
  s_cbranch_execz ms_51
  buffer_load_dwordx4 v[48:51], v190, s[8:11], s58 offen offset:0 sc1
ms_51:
  s_mov_b64 exec, s[98:99]
  s_cbranch_execz ms_52
  buffer_load_dwordx4 v[52:55], v190, s[8:11], s58 offen offset:1024 sc1
ms_52:
  s_add_u32 s54, s54, 1
  s_cmp_gt_u32 s54, 131072
  s_cbranch_scc1 end0
  s_waitcnt vmcnt(0)
  s_mov_b64 exec, s[22:23]
  ds_write_b128 v190, v[48:51] offset:0
  v_cmp_eq_u32 s[22:23], -1, v48
  s_mov_b64 exec, s[98:99]
  ds_write_b128 v190, v[52:55] offset:1024
  v_cmp_eq_u32 s[98:99], -1, v52
  s_mov_b64 exec, -1
  s_or_b64 vcc, s[22:23], s[98:99]
  s_cbranch_scc1 mr_34
  s_branch mo_38
sf_39:
  s_waitcnt lgkmcnt(1)
  v_mfma_f32_16x16x32_bf16 v[120:123], v[112:115], v[104:107], 0
  s_waitcnt lgkmcnt(0)
  v_mfma_f32_16x16x32_bf16 v[120:123], v[116:119], v[108:111], v[120:123]
  s_mov_b64 exec, s[64:65]
  s_nop 6
  v_cvt_pk_f16_f32 v120, v120, v121
  v_cvt_pk_f16_f32 v121, v122, v123
  buffer_store_dwordx2 v[120:121], v8, s[8:11], s56 offen
  s_mov_b64 exec, -1
  s_branch sf_40
mn_35:
  s_bitcmp1_b32 s81, 1
  s_cbranch_scc1 mk_36
  s_or_b32 s81, s81, 2
  s_nop 7
  v_mov_b32 v88, 0
  v_mov_b32 v89, 0
  v_mov_b32 v90, 0
  v_mov_b32 v91, 0
  v_mov_b32 v92, 0
  v_mov_b32 v93, 0
  v_mov_b32 v94, 0
  v_mov_b32 v95, 0
  v_mov_b32 v96, 0
  v_mov_b32 v97, 0
  v_mov_b32 v98, 0
  v_mov_b32 v99, 0
  v_mov_b32 v100, 0
  v_mov_b32 v101, 0
  v_mov_b32 v102, 0
  v_mov_b32 v103, 0
  s_cmp_eq_u32 s52, 0
  s_cbranch_scc1 mx_54
mx_53:
  buffer_load_dwordx4 v[48:51], v190, s[8:11], s58 offen offset:0 sc1
  buffer_load_dwordx4 v[52:55], v190, s[8:11], s58 offen offset:1024 sc1
  s_add_u32 s54, s54, 1
  s_cmp_gt_u32 s54, 131072
  s_cbranch_scc1 end0
  s_waitcnt vmcnt(0)
  v_max3_u32 v27, v48, v49, v50
  v_max3_u32 v27, v27, v51, v52
  v_max3_u32 v27, v27, v53, v54
  v_max3_u32 v27, v27, v55, v55
  v_cmp_eq_u32 vcc, -1, v27
  s_nop 1
  s_cbranch_vccnz mx_53
  ds_write_b128 v190, v[48:51] offset:0
  ds_write_b128 v190, v[52:55] offset:1024
mx_54:
  s_waitcnt lgkmcnt(0)
  s_branch mo_38
sr_41:
  s_mov_b32 s54, 0
sr_55:
  s_mov_b64 exec, vcc
  buffer_load_dwordx4 v[124:127], v9, s[8:11], s56 offen sc1
  buffer_load_dwordx4 v[128:131], v9, s[8:11], s56 offen offset:1024 sc1
  buffer_load_dwordx4 v[132:135], v10, s[8:11], s56 offen sc1
  s_mov_b64 exec, -1
  s_add_u32 s54, s54, 1
  s_cmp_gt_u32 s54, 131072
  s_cbranch_scc1 end0
  s_waitcnt vmcnt(0)
  v_pk_add_f16 v164, v132, v133
  v_pk_add_f16 v165, v134, v135
  v_pk_add_f16 v120, v124, v126
  v_pk_add_f16 v122, v128, v130
  v_fma_mix_f32 v170, v164, 1.0, v165 op_sel:[0,0,0] op_sel_hi:[1,0,1]
  v_fma_mix_f32 v166, v120, 1.0, v122 op_sel:[0,0,0] op_sel_hi:[1,0,1]
  v_pk_add_f16 v121, v125, v127
  v_cmp_u_f32 vcc, v166, v170
  v_pk_add_f16 v123, v129, v131
  v_fma_mix_f32 v171, v164, 1.0, v165 op_sel:[1,0,1] op_sel_hi:[1,0,1]
  v_fma_mix_f32 v167, v120, 1.0, v122 op_sel:[1,0,1] op_sel_hi:[1,0,1]
  v_fma_mix_f32 v168, v121, 1.0, v123 op_sel:[0,0,0] op_sel_hi:[1,0,1]
  v_fma_mix_f32 v169, v121, 1.0, v123 op_sel:[1,0,1] op_sel_hi:[1,0,1]
  s_cbranch_vccz ex_43
  s_and_b32 s21, s54, 31
  s_cbranch_scc1 sr_55
  v_max3_u32 v27, v124, v126, v128
  v_max3_u32 v27, v27, v130, v132
  v_max3_u32 v27, v27, v133, v134
  v_max3_u32 v27, v27, v135, v135
  v_cmp_eq_u32 vcc, -1, v27
  s_nop 1
  s_cbranch_vccnz sr_55
ex_43:
  v_exp_f32 v176, v170
  v_exp_f32 v177, v171
  v_exp_f32 v172, v166
  v_cvt_pk_bf16_f32 v160, v176, v177
  v_exp_f32 v173, v167
  v_exp_f32 v174, v168
  v_mov_b32_dpp v161, v160 row_ror:8 row_mask:0xf bank_mask:0xf
  v_cvt_pk_bf16_f32 v156, v172, v173
  v_exp_f32 v175, v169
  v_mfma_f32_16x16x32_bf16 v[178:181], v[140:143], v[160:163], 0
  v_mov_b32_dpp v158, v156 row_ror:8 row_mask:0xf bank_mask:0xf
  v_cvt_pk_bf16_f32 v157, v174, v175
  v_mfma_f32_16x16x32_bf16 v[182:185], v[136:139], v[160:163], 0
  s_nop 0
  v_mov_b32_dpp v159, v157 row_ror:8 row_mask:0xf bank_mask:0xf
  v_mfma_f32_16x16x32_bf16 v[186:189], v[138:141], v[160:163], 0
  s_branch pv_42
fx_44:
  s_bitcmp1_b32 s81, 0
  s_cbranch_scc1 fk_45
  s_or_b32 s81, s81, 1
  s_mov_b64 exec, -1
  v_max3_f32 v164, v166, v167, v168
  v_max3_f32 v165, v169, v170, v171
  v_max_f32 v164, v164, v165
  s_nop 1
  v_max_f32_dpp v164, v164, v164 row_ror:8 row_mask:0xf bank_mask:0xf
  v_mov_b32 v165, v164
  s_nop 1
  v_permlane32_swap_b32 v164, v165
  v_max_f32 v164, v164, v165
  v_mov_b32 v165, v164
  s_nop 1
  v_permlane16_swap_b32 v164, v165
  v_max_f32 v164, v164, v165
  v_sub_f32 v166, v166, v164
  v_sub_f32 v167, v167, v164
  v_sub_f32 v168, v168, v164
  v_sub_f32 v169, v169, v164
  v_sub_f32 v170, v170, v164
  v_sub_f32 v171, v171, v164
  s_branch ex_43
p2_50:
  s_mov_b32 s54, 0
  buffer_load_dwordx4 v[68:71], v16, s[4:7], s60 offen sc1
  s_waitcnt vmcnt(1)
  v_mfma_f32_16x16x32_f16 v[120:123], v[44:47], v[72:75], 0
  v_bitop3_b32 v27, v72, s61, 1 bitop3:0x28
  v_cmp_ne_u32 vcc, 0, v27
  s_nop 1
  s_cbranch_vccz pg_49
  buffer_load_dwordx4 v[72:75], v16, s[4:7], s60 offen sc1
pp_48:
  s_waitcnt vmcnt(1)
  v_mfma_f32_16x16x32_f16 v[120:123], v[44:47], v[68:71], 0
  v_bitop3_b32 v27, v68, s61, 1 bitop3:0x28
  v_cmp_ne_u32 vcc, 0, v27
  s_nop 1
  s_cbranch_vccz pg_49
  buffer_load_dwordx4 v[68:71], v16, s[4:7], s60 offen sc1
  s_waitcnt vmcnt(1)
  v_mfma_f32_16x16x32_f16 v[120:123], v[44:47], v[72:75], 0
  v_bitop3_b32 v27, v72, s61, 1 bitop3:0x28
  v_cmp_ne_u32 vcc, 0, v27
  s_nop 1
  s_cbranch_vccz pg_49
  buffer_load_dwordx4 v[72:75], v16, s[4:7], s60 offen sc1
  s_add_u32 s54, s54, 1
  s_cmp_gt_u32 s54, 131072
  s_cbranch_scc1 end0
  s_branch pp_48
last_37:
  v_min_u32 v104, -2, v104
  buffer_store_dwordx4 v[104:107], v36, s[16:19], s70 offen offset:2560 sc1
  v_smfmac_f32_16x16x64_bf16 v[96:99], v[48:51], a[0:7], v22
  v_smfmac_f32_16x16x64_bf16 v[100:103], v[48:51], a[80:87], v22
  v_smfmac_f32_16x16x64_bf16 v[96:99], v[52:55], a[8:15], v22
  v_smfmac_f32_16x16x64_bf16 v[100:103], v[52:55], a[88:95], v22
  v_smfmac_f32_16x16x64_bf16 v[96:99], v[56:59], a[16:23], v22
  v_smfmac_f32_16x16x64_bf16 v[100:103], v[56:59], a[96:103], v22
  v_smfmac_f32_16x16x64_bf16 v[96:99], v[60:63], a[24:31], v22
  v_smfmac_f32_16x16x64_bf16 v[96:99], v[64:67], a[32:39], v22
  v_smfmac_f32_16x16x64_bf16 v[96:99], v[68:71], a[40:47], v22
  v_smfmac_f32_16x16x64_bf16 v[96:99], v[72:75], a[48:55], v22
  v_smfmac_f32_16x16x64_bf16 v[96:99], v[76:79], a[56:63], v22
  v_smfmac_f32_16x16x64_bf16 v[96:99], v[80:83], a[64:71], v22
  v_smfmac_f32_16x16x64_bf16 v[96:99], v[84:87], a[72:79], v22
  v_smfmac_f32_16x16x64_bf16 v[100:103], v[60:63], a[104:111], v22
  v_smfmac_f32_16x16x64_bf16 v[100:103], v[64:67], a[112:119], v22
  v_smfmac_f32_16x16x64_bf16 v[100:103], v[68:71], a[120:127], v22
  v_smfmac_f32_16x16x64_bf16 v[100:103], v[72:75], a[128:135], v22
  v_smfmac_f32_16x16x64_bf16 v[100:103], v[76:79], a[136:143], v22
  v_smfmac_f32_16x16x64_bf16 v[100:103], v[80:83], a[144:151], v22
  v_smfmac_f32_16x16x64_bf16 v[100:103], v[84:87], a[152:159], v22
  s_nop 7
  v_permlane32_swap_b32 v96, v100
  v_permlane32_swap_b32 v97, v101
  v_permlane32_swap_b32 v98, v102
  v_permlane32_swap_b32 v99, v103
  v_pk_add_f32 v[96:97], v[96:97], v[100:101]
  v_pk_add_f32 v[98:99], v[98:99], v[102:103]
  v_cvt_pk_bf16_f32 v100, v96, v97
  v_cvt_pk_bf16_f32 v101, v98, v99
  s_nop 0
  v_permlane32_swap_b32 v100, v102
  v_permlane32_swap_b32 v101, v103
  v_min_u32 v100, -2, v100
  buffer_store_dwordx4 v[100:103], v26, s[16:19], s70 offen sc1
  s_waitcnt vmcnt(0)
  s_barrier
  s_branch chain_done
E_28:
  v_add_u32 v190, 2048, v4
  ds_write_b64 v6, v[28:29]
  ds_write_b32 v13, v28
  ds_write_b32 v14, v28
  s_waitcnt vmcnt(0)
  ds_write_b128 v190, v[56:59] offset:0
  ds_write_b128 v190, v[60:63] offset:1024
  ds_write_b128 v190, v[64:67] offset:2048
  s_waitcnt lgkmcnt(0)
  s_add_u32 m0, s74, 6144
  s_add_u32 s21, s79, 196608
  buffer_load_dwordx4 v4, s[16:19], s21 offen offset:1024 sc1 lds
  s_add_u32 m0, s74, 4096
  s_mul_i32 s21, s91, 2
  s_add_u32 s21, s21, s71
  buffer_load_dwordx4 v4, s[16:19], s21 offen sc1 lds
  s_xor_b32 s74, s74, 16384
  s_add_u32 s73, s73, 2097152
  s_xor_b32 s73, s73, 8192
  s_add_u32 s79, s79, 2097152
  s_xor_b32 s79, s79, 8192
  s_add_u32 s21, s72, 524288
  s_xor_b32 s72, s72, s21
  s_lshr_b32 s72, s72, 8
  s_and_b32 s72, s72, 8192
  s_xor_b32 s72, s72, s21
  s_add_u32 s71, s73, 4096
  s_mov_b32 s91, 1024
  s_sub_u32 s21, s73, 0
  s_cmp_lt_u32 s21, 125829120
  s_cselect_b32 s71, s71, s79
  s_cselect_b32 s91, s91, 65536
  s_branch mo_62
  .p2align 3
top_57:
  s_waitcnt vmcnt(2)
  ds_write_b128 v190, v[56:59] offset:0
  v_cmp_eq_u32 s[22:23], -1, v56
  s_waitcnt vmcnt(1)
  ds_write_b128 v190, v[60:63] offset:1024
  v_cmp_eq_u32 s[98:99], -1, v60
  s_waitcnt vmcnt(0)
  ds_write_b128 v190, v[64:67] offset:2048
  v_cmp_eq_u32 s[100:101], -1, v64
  s_or_b64 vcc, s[22:23], s[98:99]
  s_or_b64 vcc, vcc, s[100:101]
  s_cbranch_scc1 mr_58
mo_62:
  s_barrier
  ds_read_b128 v[48:51], v4 offset:0
  ds_read_b128 v[52:55], v4 offset:1024
  v_smfmac_f32_16x16x64_bf16 v[92:95], v[56:59], v[192:199], v22
  ds_read_b128 v[68:71], v4 offset:5120
  v_smfmac_f32_16x16x64_bf16 v[88:91], v[56:59], a[176:183], v22
  ds_read_b128 v[72:75], v4 offset:6144
  v_smfmac_f32_16x16x64_bf16 v[92:95], v[60:63], v[200:207], v22
  ds_read_b128 v[76:79], v4 offset:7168
  v_smfmac_f32_16x16x64_bf16 v[88:91], v[60:63], a[184:191], v22
  ds_read_b128 v[80:83], v4 offset:8192
  v_smfmac_f32_16x16x64_bf16 v[92:95], v[64:67], v[208:215], v22
  ds_read_b128 v[84:87], v4 offset:9216
  v_smfmac_f32_16x16x64_bf16 v[88:91], v[64:67], a[192:199], v22
  s_waitcnt lgkmcnt(6)
  v_smfmac_f32_16x16x64_bf16 v[92:95], v[48:51], a[240:247], v22
  v_smfmac_f32_16x16x64_bf16 v[88:91], v[48:51], a[160:167], v22
  s_waitcnt lgkmcnt(5)
  v_smfmac_f32_16x16x64_bf16 v[92:95], v[52:55], a[248:255], v22
  s_waitcnt lgkmcnt(4)
  v_smfmac_f32_16x16x64_bf16 v[92:95], v[68:71], v[216:223], v22
  s_waitcnt lgkmcnt(3)
  v_smfmac_f32_16x16x64_bf16 v[92:95], v[72:75], v[224:231], v22
  s_waitcnt lgkmcnt(2)
  v_smfmac_f32_16x16x64_bf16 v[92:95], v[76:79], v[232:239], v22
  s_waitcnt lgkmcnt(1)
  v_smfmac_f32_16x16x64_bf16 v[92:95], v[80:83], v[240:247], v22
  s_waitcnt lgkmcnt(0)
  v_smfmac_f32_16x16x64_bf16 v[92:95], v[84:87], v[248:255], v22
  v_smfmac_f32_16x16x64_bf16 v[88:91], v[52:55], a[168:175], v22
  v_smfmac_f32_16x16x64_bf16 v[88:91], v[68:71], a[200:207], v22
  v_smfmac_f32_16x16x64_bf16 v[88:91], v[72:75], a[208:215], v22
  v_permlane32_swap_b32 v92, v93
  v_smfmac_f32_16x16x64_bf16 v[88:91], v[76:79], a[216:223], v22
  v_permlane32_swap_b32 v94, v95
  v_smfmac_f32_16x16x64_bf16 v[88:91], v[80:83], a[224:231], v22
  v_permlane32_swap_b32 v93, v92
  v_smfmac_f32_16x16x64_bf16 v[88:91], v[84:87], a[232:239], v22
  v_permlane32_swap_b32 v95, v94
  v_pk_mul_f32 v[120:121], v[92:93], v[24:25] op_sel:[1,0] op_sel_hi:[0,1]
  v_pk_mul_f32 v[122:123], v[94:95], v[24:25] op_sel:[1,0] op_sel_hi:[0,1]
  s_nop 4
  v_pk_fma_f32 v[88:89], v[88:89], v[24:25], v[120:121]
  v_pk_fma_f32 v[90:91], v[90:91], v[24:25], v[122:123]
  v_cvt_pk_bf16_f32 v120, v88, v89
  v_cvt_pk_bf16_f32 v121, v90, v91
  ds_write_b64 v6, v[120:121]
  s_barrier
  ds_read_b64_tr_b16 v[104:105], v7 offset:0
  ds_read_b64_tr_b16 v[106:107], v7 offset:768
  ds_read_b64_tr_b16 v[108:109], v7 offset:1536
  s_waitcnt lgkmcnt(1)
  v_mfma_f32_16x16x32_bf16 v[120:123], v[112:115], v[104:107], 0
  s_waitcnt lgkmcnt(0)
  v_mfma_f32_16x16x32_bf16 v[120:123], v[116:119], v[108:111], v[120:123]
  s_mov_b64 exec, s[64:65]
  s_nop 6
  v_cmpx_o_f32 vcc, v120, v121
  v_cvt_pk_f16_f32 v120, v120, v121
  v_cvt_pk_f16_f32 v121, v122, v123
  buffer_store_dwordx2 v[120:121], v8, s[8:11], s56 offen
  s_xor_b64 s[98:99], exec, s[64:65]
  s_mov_b64 exec, -1
  s_waitcnt lgkmcnt(0)
  s_barrier
  ds_read_b64_tr_b16 v[104:105], v7 offset:0
  ds_read_b64_tr_b16 v[106:107], v7 offset:768
  ds_read_b64_tr_b16 v[108:109], v7 offset:1536
  ds_read_b32 v27, v12 offset:12544
  ds_read_b64 v[140:141], v11
  s_waitcnt lgkmcnt(1)
  v_cmp_u_f32 vcc, v104, v106
  v_cmp_u_f32 s[22:23], v108, v27
  s_nop 1
  s_or_b64 vcc, vcc, s[22:23]
  s_cbranch_vccnz mn_59
mk_60:
  s_cmp_eq_u32 s52, 63
  s_cbranch_scc1 last_61
  s_cmp_lg_u64 s[98:99], 0
  s_cbranch_scc1 sf_63
sf_64:
  s_nop 15
  s_nop 10
  v_smfmac_f32_16x16x64_bf16 v[96:99], v[48:51], a[0:7], v22
  v_smfmac_f32_16x16x64_bf16 v[100:103], v[48:51], a[80:87], v22
  v_smfmac_f32_16x16x64_bf16 v[96:99], v[52:55], a[8:15], v22
  v_smfmac_f32_16x16x64_bf16 v[100:103], v[52:55], a[88:95], v22
  v_smfmac_f32_16x16x64_bf16 v[96:99], v[56:59], a[16:23], v22
  v_smfmac_f32_16x16x64_bf16 v[100:103], v[56:59], a[96:103], v22
  buffer_load_dwordx4 v[132:135], v10, s[8:11], s56 offen sc1
  v_smfmac_f32_16x16x64_bf16 v[96:99], v[60:63], a[24:31], v22
  buffer_load_dwordx4 v[124:127], v9, s[8:11], s56 offen sc1
  v_smfmac_f32_16x16x64_bf16 v[96:99], v[64:67], a[32:39], v22
  buffer_load_dwordx4 v[128:131], v9, s[8:11], s56 offen offset:1024 sc1
  v_smfmac_f32_16x16x64_bf16 v[96:99], v[68:71], a[40:47], v22
  v_smfmac_f32_16x16x64_bf16 v[96:99], v[72:75], a[48:55], v22
  v_smfmac_f32_16x16x64_bf16 v[96:99], v[76:79], a[56:63], v22
  v_smfmac_f32_16x16x64_bf16 v[96:99], v[80:83], a[64:71], v22
  v_smfmac_f32_16x16x64_bf16 v[96:99], v[84:87], a[72:79], v22
  v_smfmac_f32_16x16x64_bf16 v[100:103], v[60:63], a[104:111], v22
  v_smfmac_f32_16x16x64_bf16 v[100:103], v[64:67], a[112:119], v22
  v_smfmac_f32_16x16x64_bf16 v[100:103], v[68:71], a[120:127], v22
  v_smfmac_f32_16x16x64_bf16 v[100:103], v[72:75], a[128:135], v22
  v_cvt_pk_bf16_f32 v136, v96, v97
  v_smfmac_f32_16x16x64_bf16 v[100:103], v[76:79], a[136:143], v22
  v_cvt_pk_bf16_f32 v137, v98, v99
  v_smfmac_f32_16x16x64_bf16 v[100:103], v[80:83], a[144:151], v22
  v_smfmac_f32_16x16x64_bf16 v[100:103], v[84:87], a[152:159], v22
  s_nop 7
  v_cvt_pk_bf16_f32 v138, v100, v101
  v_cvt_pk_bf16_f32 v139, v102, v103
  s_waitcnt vmcnt(2) lgkmcnt(0)
  v_pk_add_f16 v164, v132, v133
  v_pk_add_f16 v165, v134, v135
  v_fma_mix_f32 v170, v164, 1.0, v165 op_sel:[0,0,0] op_sel_hi:[1,0,1]
  v_fma_mix_f32 v171, v164, 1.0, v165 op_sel:[1,0,1] op_sel_hi:[1,0,1]
  v_exp_f32 v176, v170
  v_exp_f32 v177, v171
  s_waitcnt vmcnt(1)
  v_cvt_pk_bf16_f32 v160, v176, v177
  v_pk_add_f16 v120, v124, v126
  v_pk_add_f16 v121, v125, v127
  v_mov_b32_dpp v161, v160 row_ror:8 row_mask:0xf bank_mask:0xf
  s_waitcnt vmcnt(0)
  v_pk_add_f16 v122, v128, v130
  v_mfma_f32_16x16x32_bf16 v[178:181], v[140:143], v[160:163], 0
  v_fma_mix_f32 v166, v120, 1.0, v122 op_sel:[0,0,0] op_sel_hi:[1,0,1]
  v_fma_mix_f32 v167, v120, 1.0, v122 op_sel:[1,0,1] op_sel_hi:[1,0,1]
  v_cmp_u_f32 vcc, v166, v170
  v_pk_add_f16 v123, v129, v131
  v_exp_f32 v172, v166
  v_mfma_f32_16x16x32_bf16 v[182:185], v[136:139], v[160:163], 0
  s_cbranch_vccnz sr_65
  v_exp_f32 v173, v167
  v_fma_mix_f32 v168, v121, 1.0, v123 op_sel:[0,0,0] op_sel_hi:[1,0,1]
  v_fma_mix_f32 v169, v121, 1.0, v123 op_sel:[1,0,1] op_sel_hi:[1,0,1]
  v_cvt_pk_bf16_f32 v156, v172, v173
  v_exp_f32 v174, v168
  v_exp_f32 v175, v169
  v_mov_b32_dpp v158, v156 row_ror:8 row_mask:0xf bank_mask:0xf
  v_cvt_pk_bf16_f32 v157, v174, v175
  v_mfma_f32_16x16x32_bf16 v[186:189], v[138:141], v[160:163], 0
  s_nop 0
  v_mov_b32_dpp v159, v157 row_ror:8 row_mask:0xf bank_mask:0xf
  s_nop 1
pv_66:
  v_mfma_f32_16x16x32_bf16 v[178:181], v[152:155], v[156:159], v[178:181]
  v_mfma_f32_16x16x32_bf16 v[182:185], v[144:147], v[156:159], v[182:185]
  v_mfma_f32_16x16x32_bf16 v[186:189], v[148:151], v[156:159], v[186:189]
  s_mov_b64 exec, s[62:63]
  s_nop 0
  v_rcp_f32 v164, v180
  v_cmp_ngt_f32 s[22:23], s80, v180
  v_cmp_ngt_f32 vcc, s80, v164
  v_pk_mul_f32 v[182:183], v[182:183], v[164:165] op_sel_hi:[1,0]
  v_pk_mul_f32 v[184:185], v[184:185], v[164:165] op_sel_hi:[1,0]
  v_pk_mul_f32 v[178:179], v[178:179], v[164:165] op_sel_hi:[1,0]
  v_pk_mul_f32 v[186:187], v[186:187], v[164:165] op_sel_hi:[1,0]
  v_pk_mul_f32 v[188:189], v[188:189], v[164:165] op_sel_hi:[1,0]
  v_cvt_pk_f16_f32 v64, v178, v179
  s_or_b64 vcc, vcc, s[22:23]
  s_cbranch_scc1 fx_68
fk_69:
  ds_write_b32 v14, v64
  v_cvt_pk_f16_f32 v60, v182, v183
  v_cvt_pk_f16_f32 v61, v184, v185
  v_cvt_pk_f16_f32 v62, v186, v187
  v_cvt_pk_f16_f32 v63, v188, v189
  ds_write_b128 v13, v[60:63]
  s_barrier
  s_mov_b64 exec, -1
  s_add_u32 m0, s74, 6144
  s_add_u32 s21, s79, 196608
  buffer_load_dwordx4 v4, s[16:19], s21 offen offset:1024 sc1 lds
  s_add_u32 m0, s74, 4096
  s_mul_i32 s21, s91, 2
  s_add_u32 s21, s21, s71
  buffer_load_dwordx4 v4, s[16:19], s21 offen sc1 lds
  s_xor_b32 s74, s74, 16384
  s_add_u32 s73, s73, 2097152
  s_xor_b32 s73, s73, 8192
  s_add_u32 s79, s79, 2097152
  s_xor_b32 s79, s79, 8192
  s_add_u32 s21, s72, 524288
  s_xor_b32 s72, s72, s21
  s_lshr_b32 s72, s72, 8
  s_and_b32 s72, s72, 8192
  s_xor_b32 s72, s72, s21
  s_add_u32 s71, s73, 4096
  s_mov_b32 s91, 1024
  s_sub_u32 s21, s73, 0
  s_cmp_lt_u32 s21, 125829120
  s_cselect_b32 s71, s71, s79
  s_cselect_b32 s91, s91, 65536
  v_permlane32_swap_b32 v96, v100
  v_permlane32_swap_b32 v97, v101
  v_permlane32_swap_b32 v98, v102
  v_permlane32_swap_b32 v99, v103
  v_pk_add_f32 v[96:97], v[96:97], v[100:101]
  v_pk_add_f32 v[98:99], v[98:99], v[102:103]
  v_cvt_pk_bf16_f32 v100, v96, v97
  v_cvt_pk_bf16_f32 v101, v98, v99
  s_nop 0
  v_permlane32_swap_b32 v100, v102
  v_permlane32_swap_b32 v101, v103
  v_min_u32 v100, -2, v100
  s_nop 6
  buffer_store_dwordx4 v[100:103], v26, s[16:19], s70 offen sc1
  v_min_u32 v108, -2, v108
  buffer_store_dwordx2 v[108:109], v37, s[16:19], s70 offen offset:3072 sc1
  s_add_u32 s70, s70, 2097152
  s_xor_b32 s70, s70, 8192
  ds_read_b128 v[144:147], v18
  ds_read_b128 v[148:151], v18 offset:1024
  ds_read_b128 v[152:155], v19
  ds_read_b128 v[112:115], v20
  ds_read_b64 v[116:117], v21
  v_xor_b32 v18, 16384, v18
  v_xor_b32 v19, 16384, v19
  v_xor_b32 v20, 16384, v20
  v_xor_b32 v21, 16384, v21
  v_mov_b32 v88, 0
  v_mov_b32 v89, 0
  v_mov_b32 v90, 0
  v_mov_b32 v91, 0
  v_mov_b32 v92, 0
  v_mov_b32 v93, 0
  v_mov_b32 v94, 0
  v_mov_b32 v95, 0
  v_mov_b32 v96, 0
  v_mov_b32 v97, 0
  v_mov_b32 v98, 0
  v_mov_b32 v99, 0
  v_mov_b32 v100, 0
  v_mov_b32 v101, 0
  v_mov_b32 v102, 0
  v_mov_b32 v103, 0
  s_mov_b32 s81, 0
  s_waitcnt lgkmcnt(0)
  s_barrier
  s_mov_b64 exec, s[64:65]
  buffer_store_dwordx2 v[28:29], v8, s[8:11], s57 offen
  s_mov_b64 exec, -1
  ds_write_b128 v190, v[28:31] offset:0
  ds_write_b128 v190, v[28:31] offset:1024
  ds_write_b128 v190, v[28:31] offset:2048
  ds_write_b64 v6, v[28:29]
  s_mov_b64 exec, s[62:63]
  buffer_store_dword v28, v17, s[8:11], s59 offen
  s_mov_b64 exec, -1
  s_sleep 3
  s_nop 1
  buffer_load_dwordx4 v[68:71], v16, s[4:7], s60 offen sc1
  s_sleep 3
  s_nop 1
  buffer_load_dwordx4 v[72:75], v16, s[4:7], s60 offen sc1
  s_waitcnt vmcnt(1)
  v_mfma_f32_16x16x32_f16 v[120:123], v[44:47], v[68:71], 0
  v_bitop3_b32 v27, v68, s61, 1 bitop3:0x28
  v_cmp_ne_u32 vcc, 0, v27
  s_nop 1
  s_cbranch_vccnz p2_74
  s_nop 2
pg_73:
  v_add_f32_dpp v120, v120, v120 row_ror:8 row_mask:0xf bank_mask:0xf
  v_add_f32_dpp v121, v121, v121 row_ror:8 row_mask:0xf bank_mask:0xf
  s_mov_b64 exec, s[62:63]
  v_cvt_pk_bf16_f32 v120, v120, v121
  v_min_u32 v120, -2, v120
  buffer_store_dword v120, v17, s[8:11], s55 offen
  s_mov_b64 exec, -1
nt_70:
  s_barrier
  s_mov_b32 s58, s55
  s_add_u32 s52, s52, 1
  ds_write_b32 v13, v28
  ds_write_b32 v14, v28
  s_and_b32 s21, s52, 3
  s_mul_i32 s56, s21, 122880
  s_add_u32 s21, s52, 1
  s_and_b32 s21, s21, 3
  s_mul_i32 s55, s21, 122880
  s_add_u32 s55, s55, s75
  s_add_u32 s21, s52, 2
  s_and_b32 s21, s21, 3
  s_mul_i32 s57, s21, 122880
  s_add_u32 s21, s52, 3
  s_and_b32 s21, s21, 3
  s_mul_i32 s59, s21, 122880
  s_add_u32 s59, s59, s75
  s_bfe_u32 s61, s52, 0x10002
  s_and_b32 s21, s52, 3
  s_lshl_b32 s60, s21, 18
  s_mov_b32 s54, 0
  s_sleep 2
  s_nop 10
  s_waitcnt lgkmcnt(0)
  buffer_load_dwordx4 v[56:59], v190, s[8:11], s58 offen offset:0 sc1
  buffer_load_dwordx4 v[60:63], v190, s[8:11], s58 offen offset:1024 sc1
  buffer_load_dwordx4 v[64:67], v190, s[8:11], s58 offen offset:2048 sc1
  s_branch top_57
mr_58:
  s_mov_b64 exec, s[22:23]
  s_cbranch_execz ms_75
  buffer_load_dwordx4 v[56:59], v190, s[8:11], s58 offen offset:0 sc1
ms_75:
  s_mov_b64 exec, s[98:99]
  s_cbranch_execz ms_76
  buffer_load_dwordx4 v[60:63], v190, s[8:11], s58 offen offset:1024 sc1
ms_76:
  s_mov_b64 exec, s[100:101]
  s_cbranch_execz ms_77
  buffer_load_dwordx4 v[64:67], v190, s[8:11], s58 offen offset:2048 sc1
ms_77:
  s_add_u32 s54, s54, 1
  s_cmp_gt_u32 s54, 131072
  s_cbranch_scc1 end0
  s_waitcnt vmcnt(0)
  s_mov_b64 exec, s[22:23]
  ds_write_b128 v190, v[56:59] offset:0
  v_cmp_eq_u32 s[22:23], -1, v56
  s_mov_b64 exec, s[98:99]
  ds_write_b128 v190, v[60:63] offset:1024
  v_cmp_eq_u32 s[98:99], -1, v60
  s_mov_b64 exec, s[100:101]
  ds_write_b128 v190, v[64:67] offset:2048
  v_cmp_eq_u32 s[100:101], -1, v64
  s_mov_b64 exec, -1
  s_or_b64 vcc, s[22:23], s[98:99]
  s_or_b64 vcc, vcc, s[100:101]
  s_cbranch_scc1 mr_58
  s_branch mo_62
sf_63:
  s_waitcnt lgkmcnt(1)
  v_mfma_f32_16x16x32_bf16 v[120:123], v[112:115], v[104:107], 0
  s_waitcnt lgkmcnt(0)
  v_mfma_f32_16x16x32_bf16 v[120:123], v[116:119], v[108:111], v[120:123]
  s_mov_b64 exec, s[64:65]
  s_nop 6
  v_cvt_pk_f16_f32 v120, v120, v121
  v_cvt_pk_f16_f32 v121, v122, v123
  buffer_store_dwordx2 v[120:121], v8, s[8:11], s56 offen
  s_mov_b64 exec, -1
  s_branch sf_64
mn_59:
  s_bitcmp1_b32 s81, 1
  s_cbranch_scc1 mk_60
  s_or_b32 s81, s81, 2
  s_nop 7
  v_mov_b32 v88, 0
  v_mov_b32 v89, 0
  v_mov_b32 v90, 0
  v_mov_b32 v91, 0
  v_mov_b32 v92, 0
  v_mov_b32 v93, 0
  v_mov_b32 v94, 0
  v_mov_b32 v95, 0
  v_mov_b32 v96, 0
  v_mov_b32 v97, 0
  v_mov_b32 v98, 0
  v_mov_b32 v99, 0
  v_mov_b32 v100, 0
  v_mov_b32 v101, 0
  v_mov_b32 v102, 0
  v_mov_b32 v103, 0
  s_cmp_eq_u32 s52, 0
  s_cbranch_scc1 mx_79
mx_78:
  buffer_load_dwordx4 v[56:59], v190, s[8:11], s58 offen offset:0 sc1
  buffer_load_dwordx4 v[60:63], v190, s[8:11], s58 offen offset:1024 sc1
  buffer_load_dwordx4 v[64:67], v190, s[8:11], s58 offen offset:2048 sc1
  s_add_u32 s54, s54, 1
  s_cmp_gt_u32 s54, 131072
  s_cbranch_scc1 end0
  s_waitcnt vmcnt(0)
  v_max3_u32 v27, v56, v57, v58
  v_max3_u32 v27, v27, v59, v60
  v_max3_u32 v27, v27, v61, v62
  v_max3_u32 v27, v27, v63, v64
  v_max3_u32 v27, v27, v65, v66
  v_max3_u32 v27, v27, v67, v67
  v_cmp_eq_u32 vcc, -1, v27
  s_nop 1
  s_cbranch_vccnz mx_78
  ds_write_b128 v190, v[56:59] offset:0
  ds_write_b128 v190, v[60:63] offset:1024
  ds_write_b128 v190, v[64:67] offset:2048
mx_79:
  s_waitcnt lgkmcnt(0)
  s_branch mo_62
sr_65:
  s_mov_b32 s54, 0
sr_80:
  s_mov_b64 exec, vcc
  buffer_load_dwordx4 v[124:127], v9, s[8:11], s56 offen sc1
  buffer_load_dwordx4 v[128:131], v9, s[8:11], s56 offen offset:1024 sc1
  buffer_load_dwordx4 v[132:135], v10, s[8:11], s56 offen sc1
  s_mov_b64 exec, -1
  s_add_u32 s54, s54, 1
  s_cmp_gt_u32 s54, 131072
  s_cbranch_scc1 end0
  s_waitcnt vmcnt(0)
  v_pk_add_f16 v164, v132, v133
  v_pk_add_f16 v165, v134, v135
  v_pk_add_f16 v120, v124, v126
  v_pk_add_f16 v122, v128, v130
  v_fma_mix_f32 v170, v164, 1.0, v165 op_sel:[0,0,0] op_sel_hi:[1,0,1]
  v_fma_mix_f32 v166, v120, 1.0, v122 op_sel:[0,0,0] op_sel_hi:[1,0,1]
  v_pk_add_f16 v121, v125, v127
  v_cmp_u_f32 vcc, v166, v170
  v_pk_add_f16 v123, v129, v131
  v_fma_mix_f32 v171, v164, 1.0, v165 op_sel:[1,0,1] op_sel_hi:[1,0,1]
  v_fma_mix_f32 v167, v120, 1.0, v122 op_sel:[1,0,1] op_sel_hi:[1,0,1]
  v_fma_mix_f32 v168, v121, 1.0, v123 op_sel:[0,0,0] op_sel_hi:[1,0,1]
  v_fma_mix_f32 v169, v121, 1.0, v123 op_sel:[1,0,1] op_sel_hi:[1,0,1]
  s_cbranch_vccz ex_67
  s_and_b32 s21, s54, 31
  s_cbranch_scc1 sr_80
  v_max3_u32 v27, v124, v126, v128
  v_max3_u32 v27, v27, v130, v132
  v_max3_u32 v27, v27, v133, v134
  v_max3_u32 v27, v27, v135, v135
  v_cmp_eq_u32 vcc, -1, v27
  s_nop 1
  s_cbranch_vccnz sr_80
ex_67:
  v_exp_f32 v176, v170
  v_exp_f32 v177, v171
  v_exp_f32 v172, v166
  v_cvt_pk_bf16_f32 v160, v176, v177
  v_exp_f32 v173, v167
  v_exp_f32 v174, v168
  v_mov_b32_dpp v161, v160 row_ror:8 row_mask:0xf bank_mask:0xf
  v_cvt_pk_bf16_f32 v156, v172, v173
  v_exp_f32 v175, v169
  v_mfma_f32_16x16x32_bf16 v[178:181], v[140:143], v[160:163], 0
  v_mov_b32_dpp v158, v156 row_ror:8 row_mask:0xf bank_mask:0xf
  v_cvt_pk_bf16_f32 v157, v174, v175
  v_mfma_f32_16x16x32_bf16 v[182:185], v[136:139], v[160:163], 0
  s_nop 0
  v_mov_b32_dpp v159, v157 row_ror:8 row_mask:0xf bank_mask:0xf
  v_mfma_f32_16x16x32_bf16 v[186:189], v[138:141], v[160:163], 0
  s_branch pv_66
fx_68:
  s_bitcmp1_b32 s81, 0
  s_cbranch_scc1 fk_69
  s_or_b32 s81, s81, 1
  s_mov_b64 exec, -1
  v_max3_f32 v164, v166, v167, v168
  v_max3_f32 v165, v169, v170, v171
  v_max_f32 v164, v164, v165
  s_nop 1
  v_max_f32_dpp v164, v164, v164 row_ror:8 row_mask:0xf bank_mask:0xf
  v_mov_b32 v165, v164
  s_nop 1
  v_permlane32_swap_b32 v164, v165
  v_max_f32 v164, v164, v165
  v_mov_b32 v165, v164
  s_nop 1
  v_permlane16_swap_b32 v164, v165
  v_max_f32 v164, v164, v165
  v_sub_f32 v166, v166, v164
  v_sub_f32 v167, v167, v164
  v_sub_f32 v168, v168, v164
  v_sub_f32 v169, v169, v164
  v_sub_f32 v170, v170, v164
  v_sub_f32 v171, v171, v164
  s_branch ex_67
p2_74:
  s_mov_b32 s54, 0
  buffer_load_dwordx4 v[68:71], v16, s[4:7], s60 offen sc1
  s_waitcnt vmcnt(1)
  v_mfma_f32_16x16x32_f16 v[120:123], v[44:47], v[72:75], 0
  v_bitop3_b32 v27, v72, s61, 1 bitop3:0x28
  v_cmp_ne_u32 vcc, 0, v27
  s_nop 1
  s_cbranch_vccz pg_73
  buffer_load_dwordx4 v[72:75], v16, s[4:7], s60 offen sc1
pp_72:
  s_waitcnt vmcnt(1)
  v_mfma_f32_16x16x32_f16 v[120:123], v[44:47], v[68:71], 0
  v_bitop3_b32 v27, v68, s61, 1 bitop3:0x28
  v_cmp_ne_u32 vcc, 0, v27
  s_nop 1
  s_cbranch_vccz pg_73
  buffer_load_dwordx4 v[68:71], v16, s[4:7], s60 offen sc1
  s_waitcnt vmcnt(1)
  v_mfma_f32_16x16x32_f16 v[120:123], v[44:47], v[72:75], 0
  v_bitop3_b32 v27, v72, s61, 1 bitop3:0x28
  v_cmp_ne_u32 vcc, 0, v27
  s_nop 1
  s_cbranch_vccz pg_73
  buffer_load_dwordx4 v[72:75], v16, s[4:7], s60 offen sc1
  s_add_u32 s54, s54, 1
  s_cmp_gt_u32 s54, 131072
  s_cbranch_scc1 end0
  s_branch pp_72
last_61:
  v_min_u32 v108, -2, v108
  buffer_store_dwordx2 v[108:109], v37, s[16:19], s70 offen offset:3072 sc1
  v_smfmac_f32_16x16x64_bf16 v[96:99], v[48:51], a[0:7], v22
  v_smfmac_f32_16x16x64_bf16 v[100:103], v[48:51], a[80:87], v22
  v_smfmac_f32_16x16x64_bf16 v[96:99], v[52:55], a[8:15], v22
  v_smfmac_f32_16x16x64_bf16 v[100:103], v[52:55], a[88:95], v22
  v_smfmac_f32_16x16x64_bf16 v[96:99], v[56:59], a[16:23], v22
  v_smfmac_f32_16x16x64_bf16 v[100:103], v[56:59], a[96:103], v22
  v_smfmac_f32_16x16x64_bf16 v[96:99], v[60:63], a[24:31], v22
  v_smfmac_f32_16x16x64_bf16 v[96:99], v[64:67], a[32:39], v22
  v_smfmac_f32_16x16x64_bf16 v[96:99], v[68:71], a[40:47], v22
  v_smfmac_f32_16x16x64_bf16 v[96:99], v[72:75], a[48:55], v22
  v_smfmac_f32_16x16x64_bf16 v[96:99], v[76:79], a[56:63], v22
  v_smfmac_f32_16x16x64_bf16 v[96:99], v[80:83], a[64:71], v22
  v_smfmac_f32_16x16x64_bf16 v[96:99], v[84:87], a[72:79], v22
  v_smfmac_f32_16x16x64_bf16 v[100:103], v[60:63], a[104:111], v22
  v_smfmac_f32_16x16x64_bf16 v[100:103], v[64:67], a[112:119], v22
  v_smfmac_f32_16x16x64_bf16 v[100:103], v[68:71], a[120:127], v22
  v_smfmac_f32_16x16x64_bf16 v[100:103], v[72:75], a[128:135], v22
  v_smfmac_f32_16x16x64_bf16 v[100:103], v[76:79], a[136:143], v22
  v_smfmac_f32_16x16x64_bf16 v[100:103], v[80:83], a[144:151], v22
  v_smfmac_f32_16x16x64_bf16 v[100:103], v[84:87], a[152:159], v22
  s_nop 7
  v_permlane32_swap_b32 v96, v100
  v_permlane32_swap_b32 v97, v101
  v_permlane32_swap_b32 v98, v102
  v_permlane32_swap_b32 v99, v103
  v_pk_add_f32 v[96:97], v[96:97], v[100:101]
  v_pk_add_f32 v[98:99], v[98:99], v[102:103]
  v_cvt_pk_bf16_f32 v100, v96, v97
  v_cvt_pk_bf16_f32 v101, v98, v99
  s_nop 0
  v_permlane32_swap_b32 v100, v102
  v_permlane32_swap_b32 v101, v103
  v_min_u32 v100, -2, v100
  buffer_store_dwordx4 v[100:103], v26, s[16:19], s70 offen sc1
  s_waitcnt vmcnt(0)
  s_barrier
  s_branch chain_done
E_30:
  v_add_u32 v190, 5120, v4
  ds_write_b64 v6, v[28:29]
  ds_write_b32 v13, v28
  ds_write_b32 v14, v28
  s_waitcnt vmcnt(0)
  ds_write_b128 v190, v[68:71] offset:0
  ds_write_b128 v190, v[72:75] offset:1024
  s_waitcnt lgkmcnt(0)
  s_add_u32 m0, s74, 8192
  s_add_u32 s21, s72, 0
  buffer_load_dwordx4 v32, s[16:19], s21 offen sc1 lds
  s_add_u32 m0, s74, 6144
  s_mul_i32 s21, s91, 3
  s_add_u32 s21, s21, s71
  buffer_load_dwordx4 v4, s[16:19], s21 offen sc1 lds
  s_xor_b32 s74, s74, 16384
  s_add_u32 s73, s73, 2097152
  s_xor_b32 s73, s73, 8192
  s_add_u32 s79, s79, 2097152
  s_xor_b32 s79, s79, 8192
  s_add_u32 s21, s72, 524288
  s_xor_b32 s72, s72, s21
  s_lshr_b32 s72, s72, 8
  s_and_b32 s72, s72, 8192
  s_xor_b32 s72, s72, s21
  s_add_u32 s71, s73, 4096
  s_mov_b32 s91, 1024
  s_sub_u32 s21, s73, 0
  s_cmp_lt_u32 s21, 125829120
  s_cselect_b32 s71, s71, s79
  s_cselect_b32 s91, s91, 65536
  s_branch mo_87
  .p2align 3
top_82:
  s_waitcnt vmcnt(1)
  ds_write_b128 v190, v[68:71] offset:0
  v_cmp_eq_u32 s[22:23], -1, v68
  s_waitcnt vmcnt(0)
  ds_write_b128 v190, v[72:75] offset:1024
  v_cmp_eq_u32 s[98:99], -1, v72
  s_or_b64 vcc, s[22:23], s[98:99]
  s_cbranch_scc1 mr_83
mo_87:
  s_barrier
  ds_read_b128 v[48:51], v4 offset:0
  ds_read_b128 v[52:55], v4 offset:1024
  v_smfmac_f32_16x16x64_bf16 v[92:95], v[68:71], v[216:223], v22
  ds_read_b128 v[56:59], v4 offset:2048
  v_smfmac_f32_16x16x64_bf16 v[88:91], v[68:71], a[200:207], v22
  ds_read_b128 v[60:63], v4 offset:3072
  v_smfmac_f32_16x16x64_bf16 v[92:95], v[72:75], v[224:231], v22
  ds_read_b128 v[64:67], v4 offset:4096
  v_smfmac_f32_16x16x64_bf16 v[88:91], v[72:75], a[208:215], v22
  s_waitcnt lgkmcnt(4)
  ds_read_b128 v[76:79], v4 offset:7168
  v_smfmac_f32_16x16x64_bf16 v[92:95], v[48:51], a[240:247], v22
  ds_read_b128 v[80:83], v4 offset:8192
  v_smfmac_f32_16x16x64_bf16 v[88:91], v[48:51], a[160:167], v22
  s_waitcnt lgkmcnt(5)
  ds_read_b128 v[84:87], v4 offset:9216
  v_smfmac_f32_16x16x64_bf16 v[92:95], v[52:55], a[248:255], v22
  v_smfmac_f32_16x16x64_bf16 v[88:91], v[52:55], a[168:175], v22
  s_waitcnt lgkmcnt(5)
  v_smfmac_f32_16x16x64_bf16 v[92:95], v[56:59], v[192:199], v22
  s_waitcnt lgkmcnt(4)
  v_smfmac_f32_16x16x64_bf16 v[92:95], v[60:63], v[200:207], v22
  s_waitcnt lgkmcnt(3)
  v_smfmac_f32_16x16x64_bf16 v[92:95], v[64:67], v[208:215], v22
  s_waitcnt lgkmcnt(2)
  v_smfmac_f32_16x16x64_bf16 v[92:95], v[76:79], v[232:239], v22
  s_waitcnt lgkmcnt(1)
  v_smfmac_f32_16x16x64_bf16 v[92:95], v[80:83], v[240:247], v22
  s_waitcnt lgkmcnt(0)
  v_smfmac_f32_16x16x64_bf16 v[92:95], v[84:87], v[248:255], v22
  v_smfmac_f32_16x16x64_bf16 v[88:91], v[56:59], a[176:183], v22
  v_smfmac_f32_16x16x64_bf16 v[88:91], v[60:63], a[184:191], v22
  v_smfmac_f32_16x16x64_bf16 v[88:91], v[64:67], a[192:199], v22
  v_permlane32_swap_b32 v92, v93
  v_smfmac_f32_16x16x64_bf16 v[88:91], v[76:79], a[216:223], v22
  v_permlane32_swap_b32 v94, v95
  v_smfmac_f32_16x16x64_bf16 v[88:91], v[80:83], a[224:231], v22
  v_permlane32_swap_b32 v93, v92
  v_smfmac_f32_16x16x64_bf16 v[88:91], v[84:87], a[232:239], v22
  v_permlane32_swap_b32 v95, v94
  v_pk_mul_f32 v[120:121], v[92:93], v[24:25] op_sel:[1,0] op_sel_hi:[0,1]
  v_pk_mul_f32 v[122:123], v[94:95], v[24:25] op_sel:[1,0] op_sel_hi:[0,1]
  s_nop 4
  v_pk_fma_f32 v[88:89], v[88:89], v[24:25], v[120:121]
  v_pk_fma_f32 v[90:91], v[90:91], v[24:25], v[122:123]
  v_cvt_pk_bf16_f32 v120, v88, v89
  v_cvt_pk_bf16_f32 v121, v90, v91
  ds_write_b64 v6, v[120:121]
  s_barrier
  ds_read_b64_tr_b16 v[104:105], v7 offset:0
  ds_read_b64_tr_b16 v[106:107], v7 offset:768
  ds_read_b64_tr_b16 v[108:109], v7 offset:1536
  s_waitcnt lgkmcnt(1)
  v_mfma_f32_16x16x32_bf16 v[120:123], v[104:107], v[104:107], 0
  s_waitcnt lgkmcnt(0)
  v_mfma_f32_16x16x32_bf16 v[120:123], v[108:111], v[108:111], v[120:123]
  s_mov_b64 exec, s[64:65]
  s_nop 6
  v_cmpx_o_f32 vcc, v120, v121
  v_cvt_pk_f16_f32 v120, v120, v121
  buffer_store_dword v120, v8, s[8:11], s56 offen
  v_cmpx_o_f32 vcc, v122, v123
  v_cvt_pk_f16_f32 v121, v122, v123
  buffer_store_dword v121, v8, s[8:11], s56 offen offset:128
  s_xor_b64 s[98:99], exec, s[64:65]
  s_mov_b64 exec, -1
  s_waitcnt lgkmcnt(0)
  s_barrier
  ds_read_b64_tr_b16 v[104:105], v7 offset:0
  ds_read_b64_tr_b16 v[106:107], v7 offset:768
  ds_read_b64_tr_b16 v[108:109], v7 offset:1536
  ds_read_b32 v27, v12 offset:12544
  ds_read_b64 v[140:141], v11
  s_waitcnt lgkmcnt(1)
  v_cmp_u_f32 vcc, v104, v106
  v_cmp_u_f32 s[22:23], v108, v27
  s_nop 1
  s_or_b64 vcc, vcc, s[22:23]
  s_cbranch_vccnz mn_84
mk_85:
  s_cmp_eq_u32 s52, 63
  s_cbranch_scc1 last_86
  s_cmp_lg_u64 s[98:99], 0
  s_cbranch_scc1 sf_88
sf_89:
  s_nop 15
  s_nop 10
  v_smfmac_f32_16x16x64_bf16 v[96:99], v[48:51], a[0:7], v22
  v_smfmac_f32_16x16x64_bf16 v[100:103], v[48:51], a[80:87], v22
  v_smfmac_f32_16x16x64_bf16 v[96:99], v[52:55], a[8:15], v22
  v_smfmac_f32_16x16x64_bf16 v[100:103], v[52:55], a[88:95], v22
  v_smfmac_f32_16x16x64_bf16 v[96:99], v[56:59], a[16:23], v22
  v_smfmac_f32_16x16x64_bf16 v[100:103], v[56:59], a[96:103], v22
  buffer_load_dwordx4 v[132:135], v10, s[8:11], s56 offen sc1
  v_smfmac_f32_16x16x64_bf16 v[96:99], v[60:63], a[24:31], v22
  buffer_load_dwordx4 v[124:127], v9, s[8:11], s56 offen sc1
  v_smfmac_f32_16x16x64_bf16 v[96:99], v[64:67], a[32:39], v22
  buffer_load_dwordx4 v[128:131], v9, s[8:11], s56 offen offset:1024 sc1
  v_smfmac_f32_16x16x64_bf16 v[96:99], v[68:71], a[40:47], v22
  v_smfmac_f32_16x16x64_bf16 v[96:99], v[72:75], a[48:55], v22
  v_smfmac_f32_16x16x64_bf16 v[96:99], v[76:79], a[56:63], v22
  v_smfmac_f32_16x16x64_bf16 v[96:99], v[80:83], a[64:71], v22
  v_smfmac_f32_16x16x64_bf16 v[96:99], v[84:87], a[72:79], v22
  v_smfmac_f32_16x16x64_bf16 v[100:103], v[60:63], a[104:111], v22
  v_smfmac_f32_16x16x64_bf16 v[100:103], v[64:67], a[112:119], v22
  v_smfmac_f32_16x16x64_bf16 v[100:103], v[68:71], a[120:127], v22
  v_smfmac_f32_16x16x64_bf16 v[100:103], v[72:75], a[128:135], v22
  v_cvt_pk_bf16_f32 v136, v96, v97
  v_smfmac_f32_16x16x64_bf16 v[100:103], v[76:79], a[136:143], v22
  v_cvt_pk_bf16_f32 v137, v98, v99
  v_smfmac_f32_16x16x64_bf16 v[100:103], v[80:83], a[144:151], v22
  v_smfmac_f32_16x16x64_bf16 v[100:103], v[84:87], a[152:159], v22
  s_nop 7
  v_cvt_pk_bf16_f32 v138, v100, v101
  v_cvt_pk_bf16_f32 v139, v102, v103
  s_waitcnt vmcnt(2) lgkmcnt(0)
  v_pk_add_f16 v164, v132, v133
  v_pk_add_f16 v165, v134, v135
  v_fma_mix_f32 v170, v164, 1.0, v165 op_sel:[0,0,0] op_sel_hi:[1,0,1]
  v_fma_mix_f32 v171, v164, 1.0, v165 op_sel:[1,0,1] op_sel_hi:[1,0,1]
  v_exp_f32 v176, v170
  v_exp_f32 v177, v171
  s_waitcnt vmcnt(1)
  v_cvt_pk_bf16_f32 v160, v176, v177
  v_pk_add_f16 v120, v124, v126
  v_pk_add_f16 v121, v125, v127
  v_mov_b32_dpp v161, v160 row_ror:8 row_mask:0xf bank_mask:0xf
  s_waitcnt vmcnt(0)
  v_pk_add_f16 v122, v128, v130
  v_mfma_f32_16x16x32_bf16 v[178:181], v[140:143], v[160:163], 0
  v_fma_mix_f32 v166, v120, 1.0, v122 op_sel:[0,0,0] op_sel_hi:[1,0,1]
  v_fma_mix_f32 v167, v120, 1.0, v122 op_sel:[1,0,1] op_sel_hi:[1,0,1]
  v_cmp_u_f32 vcc, v166, v170
  v_pk_add_f16 v123, v129, v131
  v_exp_f32 v172, v166
  v_mfma_f32_16x16x32_bf16 v[182:185], v[136:139], v[160:163], 0
  s_cbranch_vccnz sr_90
  v_exp_f32 v173, v167
  v_fma_mix_f32 v168, v121, 1.0, v123 op_sel:[0,0,0] op_sel_hi:[1,0,1]
  v_fma_mix_f32 v169, v121, 1.0, v123 op_sel:[1,0,1] op_sel_hi:[1,0,1]
  v_cvt_pk_bf16_f32 v156, v172, v173
  v_exp_f32 v174, v168
  v_exp_f32 v175, v169
  v_mov_b32_dpp v158, v156 row_ror:8 row_mask:0xf bank_mask:0xf
  v_cvt_pk_bf16_f32 v157, v174, v175
  v_mfma_f32_16x16x32_bf16 v[186:189], v[138:141], v[160:163], 0
  s_nop 0
  v_mov_b32_dpp v159, v157 row_ror:8 row_mask:0xf bank_mask:0xf
  s_nop 1
pv_91:
  v_mfma_f32_16x16x32_bf16 v[178:181], v[152:155], v[156:159], v[178:181]
  v_mfma_f32_16x16x32_bf16 v[182:185], v[144:147], v[156:159], v[182:185]
  v_mfma_f32_16x16x32_bf16 v[186:189], v[148:151], v[156:159], v[186:189]
  s_mov_b64 exec, s[62:63]
  s_nop 0
  v_rcp_f32 v164, v180
  v_cmp_ngt_f32 s[22:23], s80, v180
  v_cmp_ngt_f32 vcc, s80, v164
  v_pk_mul_f32 v[182:183], v[182:183], v[164:165] op_sel_hi:[1,0]
  v_pk_mul_f32 v[184:185], v[184:185], v[164:165] op_sel_hi:[1,0]
  v_pk_mul_f32 v[178:179], v[178:179], v[164:165] op_sel_hi:[1,0]
  v_pk_mul_f32 v[186:187], v[186:187], v[164:165] op_sel_hi:[1,0]
  v_pk_mul_f32 v[188:189], v[188:189], v[164:165] op_sel_hi:[1,0]
  v_cvt_pk_f16_f32 v64, v178, v179
  s_or_b64 vcc, vcc, s[22:23]
  s_cbranch_scc1 fx_93
fk_94:
  ds_write_b32 v14, v64
  v_cvt_pk_f16_f32 v60, v182, v183
  v_cvt_pk_f16_f32 v61, v184, v185
  v_cvt_pk_f16_f32 v62, v186, v187
  v_cvt_pk_f16_f32 v63, v188, v189
  ds_write_b128 v13, v[60:63]
  s_barrier
  s_mov_b64 exec, -1
  s_and_b32 s21, s52, 3
  s_cmp_lt_u32 s52, 58
  s_cselect_b32 s21, s21, 0
  s_cmp_lg_u32 s21, 0
  s_cbranch_scc1 fs_95
  v_mov_b32 v27, s52
  s_mov_b64 exec, 1
  buffer_store_dword v27, v23, s[12:15], s77 offen sc1
  s_mov_b64 exec, -1
fs_95:
  s_add_u32 m0, s74, 8192
  s_add_u32 s21, s72, 0
  buffer_load_dwordx4 v32, s[16:19], s21 offen sc1 lds
  s_add_u32 m0, s74, 6144
  s_mul_i32 s21, s91, 3
  s_add_u32 s21, s21, s71
  buffer_load_dwordx4 v4, s[16:19], s21 offen sc1 lds
  s_xor_b32 s74, s74, 16384
  s_add_u32 s73, s73, 2097152
  s_xor_b32 s73, s73, 8192
  s_add_u32 s79, s79, 2097152
  s_xor_b32 s79, s79, 8192
  s_add_u32 s21, s72, 524288
  s_xor_b32 s72, s72, s21
  s_lshr_b32 s72, s72, 8
  s_and_b32 s72, s72, 8192
  s_xor_b32 s72, s72, s21
  s_add_u32 s71, s73, 4096
  s_mov_b32 s91, 1024
  s_sub_u32 s21, s73, 0
  s_cmp_lt_u32 s21, 125829120
  s_cselect_b32 s71, s71, s79
  s_cselect_b32 s91, s91, 65536
  v_permlane32_swap_b32 v96, v100
  v_permlane32_swap_b32 v97, v101
  v_permlane32_swap_b32 v98, v102
  v_permlane32_swap_b32 v99, v103
  v_pk_add_f32 v[96:97], v[96:97], v[100:101]
  v_pk_add_f32 v[98:99], v[98:99], v[102:103]
  v_cvt_pk_bf16_f32 v100, v96, v97
  v_cvt_pk_bf16_f32 v101, v98, v99
  s_nop 0
  v_permlane32_swap_b32 v100, v102
  v_permlane32_swap_b32 v101, v103
  v_min_u32 v100, -2, v100
  s_nop 6
  buffer_store_dwordx4 v[100:103], v26, s[16:19], s70 offen sc1
  s_add_u32 s70, s70, 2097152
  s_xor_b32 s70, s70, 8192
  ds_read_b128 v[144:147], v18
  ds_read_b128 v[148:151], v18 offset:1024
  ds_read_b128 v[152:155], v19
  v_xor_b32 v18, 16384, v18
  v_xor_b32 v19, 16384, v19
  v_mov_b32 v88, 0
  v_mov_b32 v89, 0
  v_mov_b32 v90, 0
  v_mov_b32 v91, 0
  v_mov_b32 v92, 0
  v_mov_b32 v93, 0
  v_mov_b32 v94, 0
  v_mov_b32 v95, 0
  v_mov_b32 v96, 0
  v_mov_b32 v97, 0
  v_mov_b32 v98, 0
  v_mov_b32 v99, 0
  v_mov_b32 v100, 0
  v_mov_b32 v101, 0
  v_mov_b32 v102, 0
  v_mov_b32 v103, 0
  s_mov_b32 s81, 0
  s_waitcnt lgkmcnt(0)
  s_barrier
  s_mov_b64 exec, s[64:65]
  buffer_store_dword v28, v8, s[8:11], s57 offen
  buffer_store_dword v28, v8, s[8:11], s57 offen offset:128
  s_mov_b64 exec, -1
  ds_write_b128 v190, v[28:31] offset:0
  ds_write_b128 v190, v[28:31] offset:1024
  ds_write_b64 v6, v[28:29]
  s_mov_b64 exec, -1
  s_cmp_eq_u32 s78, 0
  s_cbranch_scc1 nt_97
  s_mov_b64 exec, s[62:63]
  buffer_store_dword v28, v17, s[8:11], s59 offen
  s_mov_b64 exec, -1
  s_sleep 3
  s_nop 1
  buffer_load_dwordx4 v[68:71], v16, s[4:7], s60 offen sc1
  s_sleep 3
  s_nop 1
  buffer_load_dwordx4 v[72:75], v16, s[4:7], s60 offen sc1
  s_waitcnt vmcnt(1)
  v_mfma_f32_16x16x32_f16 v[120:123], v[44:47], v[68:71], 0
  v_bitop3_b32 v27, v68, s61, 1 bitop3:0x28
  v_cmp_ne_u32 vcc, 0, v27
  s_nop 1
  s_cbranch_vccnz p2_100
  s_nop 2
pg_99:
  v_add_f32_dpp v120, v120, v120 row_ror:8 row_mask:0xf bank_mask:0xf
  v_add_f32_dpp v121, v121, v121 row_ror:8 row_mask:0xf bank_mask:0xf
  s_mov_b64 exec, s[62:63]
  v_cvt_pk_bf16_f32 v120, v120, v121
  v_min_u32 v120, -2, v120
  buffer_store_dword v120, v17, s[8:11], s55 offen
  s_mov_b64 exec, -1
nt_96:
  s_barrier
  s_mov_b32 s58, s55
  s_add_u32 s52, s52, 1
  ds_write_b32 v13, v28
  ds_write_b32 v14, v28
  s_and_b32 s21, s52, 3
  s_mul_i32 s56, s21, 122880
  s_add_u32 s21, s52, 1
  s_and_b32 s21, s21, 3
  s_mul_i32 s55, s21, 122880
  s_add_u32 s55, s55, s75
  s_add_u32 s21, s52, 2
  s_and_b32 s21, s21, 3
  s_mul_i32 s57, s21, 122880
  s_add_u32 s21, s52, 3
  s_and_b32 s21, s21, 3
  s_mul_i32 s59, s21, 122880
  s_add_u32 s59, s59, s75
  s_bfe_u32 s61, s52, 0x10002
  s_and_b32 s21, s52, 3
  s_lshl_b32 s60, s21, 18
  s_mov_b32 s54, 0
  s_sleep 2
  s_nop 10
  s_waitcnt lgkmcnt(0)
  buffer_load_dwordx4 v[68:71], v190, s[8:11], s58 offen offset:0 sc1
  buffer_load_dwordx4 v[72:75], v190, s[8:11], s58 offen offset:1024 sc1
  s_branch top_82
mr_83:
  s_mov_b64 exec, s[22:23]
  s_cbranch_execz ms_101
  buffer_load_dwordx4 v[68:71], v190, s[8:11], s58 offen offset:0 sc1
ms_101:
  s_mov_b64 exec, s[98:99]
  s_cbranch_execz ms_102
  buffer_load_dwordx4 v[72:75], v190, s[8:11], s58 offen offset:1024 sc1
ms_102:
  s_add_u32 s54, s54, 1
  s_cmp_gt_u32 s54, 131072
  s_cbranch_scc1 end0
  s_waitcnt vmcnt(0)
  s_mov_b64 exec, s[22:23]
  ds_write_b128 v190, v[68:71] offset:0
  v_cmp_eq_u32 s[22:23], -1, v68
  s_mov_b64 exec, s[98:99]
  ds_write_b128 v190, v[72:75] offset:1024
  v_cmp_eq_u32 s[98:99], -1, v72
  s_mov_b64 exec, -1
  s_or_b64 vcc, s[22:23], s[98:99]
  s_cbranch_scc1 mr_83
  s_branch mo_87
sf_88:
  s_waitcnt lgkmcnt(1)
  v_mfma_f32_16x16x32_bf16 v[120:123], v[104:107], v[104:107], 0
  s_waitcnt lgkmcnt(0)
  v_mfma_f32_16x16x32_bf16 v[120:123], v[108:111], v[108:111], v[120:123]
  s_mov_b64 exec, s[64:65]
  s_nop 6
  v_cvt_pk_f16_f32 v120, v120, v121
  buffer_store_dword v120, v8, s[8:11], s56 offen
  v_cvt_pk_f16_f32 v121, v122, v123
  buffer_store_dword v121, v8, s[8:11], s56 offen offset:128
  s_mov_b64 exec, -1
  s_branch sf_89
mn_84:
  s_bitcmp1_b32 s81, 1
  s_cbranch_scc1 mk_85
  s_or_b32 s81, s81, 2
  s_nop 7
  v_mov_b32 v88, 0
  v_mov_b32 v89, 0
  v_mov_b32 v90, 0
  v_mov_b32 v91, 0
  v_mov_b32 v92, 0
  v_mov_b32 v93, 0
  v_mov_b32 v94, 0
  v_mov_b32 v95, 0
  v_mov_b32 v96, 0
  v_mov_b32 v97, 0
  v_mov_b32 v98, 0
  v_mov_b32 v99, 0
  v_mov_b32 v100, 0
  v_mov_b32 v101, 0
  v_mov_b32 v102, 0
  v_mov_b32 v103, 0
  s_cmp_eq_u32 s52, 0
  s_cbranch_scc1 mx_104
mx_103:
  buffer_load_dwordx4 v[68:71], v190, s[8:11], s58 offen offset:0 sc1
  buffer_load_dwordx4 v[72:75], v190, s[8:11], s58 offen offset:1024 sc1
  s_add_u32 s54, s54, 1
  s_cmp_gt_u32 s54, 131072
  s_cbranch_scc1 end0
  s_waitcnt vmcnt(0)
  v_max3_u32 v27, v68, v69, v70
  v_max3_u32 v27, v27, v71, v72
  v_max3_u32 v27, v27, v73, v74
  v_max3_u32 v27, v27, v75, v75
  v_cmp_eq_u32 vcc, -1, v27
  s_nop 1
  s_cbranch_vccnz mx_103
  ds_write_b128 v190, v[68:71] offset:0
  ds_write_b128 v190, v[72:75] offset:1024
mx_104:
  s_waitcnt lgkmcnt(0)
  s_branch mo_87
sr_90:
  s_mov_b32 s54, 0
sr_105:
  s_mov_b64 exec, vcc
  buffer_load_dwordx4 v[124:127], v9, s[8:11], s56 offen sc1
  buffer_load_dwordx4 v[128:131], v9, s[8:11], s56 offen offset:1024 sc1
  buffer_load_dwordx4 v[132:135], v10, s[8:11], s56 offen sc1
  s_mov_b64 exec, -1
  s_add_u32 s54, s54, 1
  s_cmp_gt_u32 s54, 131072
  s_cbranch_scc1 end0
  s_waitcnt vmcnt(0)
  v_pk_add_f16 v164, v132, v133
  v_pk_add_f16 v165, v134, v135
  v_pk_add_f16 v120, v124, v126
  v_pk_add_f16 v122, v128, v130
  v_fma_mix_f32 v170, v164, 1.0, v165 op_sel:[0,0,0] op_sel_hi:[1,0,1]
  v_fma_mix_f32 v166, v120, 1.0, v122 op_sel:[0,0,0] op_sel_hi:[1,0,1]
  v_pk_add_f16 v121, v125, v127
  v_cmp_u_f32 vcc, v166, v170
  v_pk_add_f16 v123, v129, v131
  v_fma_mix_f32 v171, v164, 1.0, v165 op_sel:[1,0,1] op_sel_hi:[1,0,1]
  v_fma_mix_f32 v167, v120, 1.0, v122 op_sel:[1,0,1] op_sel_hi:[1,0,1]
  v_fma_mix_f32 v168, v121, 1.0, v123 op_sel:[0,0,0] op_sel_hi:[1,0,1]
  v_fma_mix_f32 v169, v121, 1.0, v123 op_sel:[1,0,1] op_sel_hi:[1,0,1]
  s_cbranch_vccz ex_92
  s_and_b32 s21, s54, 31
  s_cbranch_scc1 sr_105
  v_max3_u32 v27, v124, v126, v128
  v_max3_u32 v27, v27, v130, v132
  v_max3_u32 v27, v27, v133, v134
  v_max3_u32 v27, v27, v135, v135
  v_cmp_eq_u32 vcc, -1, v27
  s_nop 1
  s_cbranch_vccnz sr_105
ex_92:
  v_exp_f32 v176, v170
  v_exp_f32 v177, v171
  v_exp_f32 v172, v166
  v_cvt_pk_bf16_f32 v160, v176, v177
  v_exp_f32 v173, v167
  v_exp_f32 v174, v168
  v_mov_b32_dpp v161, v160 row_ror:8 row_mask:0xf bank_mask:0xf
  v_cvt_pk_bf16_f32 v156, v172, v173
  v_exp_f32 v175, v169
  v_mfma_f32_16x16x32_bf16 v[178:181], v[140:143], v[160:163], 0
  v_mov_b32_dpp v158, v156 row_ror:8 row_mask:0xf bank_mask:0xf
  v_cvt_pk_bf16_f32 v157, v174, v175
  v_mfma_f32_16x16x32_bf16 v[182:185], v[136:139], v[160:163], 0
  s_nop 0
  v_mov_b32_dpp v159, v157 row_ror:8 row_mask:0xf bank_mask:0xf
  v_mfma_f32_16x16x32_bf16 v[186:189], v[138:141], v[160:163], 0
  s_branch pv_91
fx_93:
  s_bitcmp1_b32 s81, 0
  s_cbranch_scc1 fk_94
  s_or_b32 s81, s81, 1
  s_mov_b64 exec, -1
  v_max3_f32 v164, v166, v167, v168
  v_max3_f32 v165, v169, v170, v171
  v_max_f32 v164, v164, v165
  s_nop 1
  v_max_f32_dpp v164, v164, v164 row_ror:8 row_mask:0xf bank_mask:0xf
  v_mov_b32 v165, v164
  s_nop 1
  v_permlane32_swap_b32 v164, v165
  v_max_f32 v164, v164, v165
  v_mov_b32 v165, v164
  s_nop 1
  v_permlane16_swap_b32 v164, v165
  v_max_f32 v164, v164, v165
  v_sub_f32 v166, v166, v164
  v_sub_f32 v167, v167, v164
  v_sub_f32 v168, v168, v164
  v_sub_f32 v169, v169, v164
  v_sub_f32 v170, v170, v164
  v_sub_f32 v171, v171, v164
  s_branch ex_92
nt_97:
  s_branch nt_96
p2_100:
  s_mov_b32 s54, 0
  buffer_load_dwordx4 v[68:71], v16, s[4:7], s60 offen sc1
  s_waitcnt vmcnt(1)
  v_mfma_f32_16x16x32_f16 v[120:123], v[44:47], v[72:75], 0
  v_bitop3_b32 v27, v72, s61, 1 bitop3:0x28
  v_cmp_ne_u32 vcc, 0, v27
  s_nop 1
  s_cbranch_vccz pg_99
  buffer_load_dwordx4 v[72:75], v16, s[4:7], s60 offen sc1
pp_98:
  s_waitcnt vmcnt(1)
  v_mfma_f32_16x16x32_f16 v[120:123], v[44:47], v[68:71], 0
  v_bitop3_b32 v27, v68, s61, 1 bitop3:0x28
  v_cmp_ne_u32 vcc, 0, v27
  s_nop 1
  s_cbranch_vccz pg_99
  buffer_load_dwordx4 v[68:71], v16, s[4:7], s60 offen sc1
  s_waitcnt vmcnt(1)
  v_mfma_f32_16x16x32_f16 v[120:123], v[44:47], v[72:75], 0
  v_bitop3_b32 v27, v72, s61, 1 bitop3:0x28
  v_cmp_ne_u32 vcc, 0, v27
  s_nop 1
  s_cbranch_vccz pg_99
  buffer_load_dwordx4 v[72:75], v16, s[4:7], s60 offen sc1
  s_add_u32 s54, s54, 1
  s_cmp_gt_u32 s54, 131072
  s_cbranch_scc1 end0
  s_branch pp_98
last_86:
  v_smfmac_f32_16x16x64_bf16 v[96:99], v[48:51], a[0:7], v22
  v_smfmac_f32_16x16x64_bf16 v[100:103], v[48:51], a[80:87], v22
  v_smfmac_f32_16x16x64_bf16 v[96:99], v[52:55], a[8:15], v22
  v_smfmac_f32_16x16x64_bf16 v[100:103], v[52:55], a[88:95], v22
  v_smfmac_f32_16x16x64_bf16 v[96:99], v[56:59], a[16:23], v22
  v_smfmac_f32_16x16x64_bf16 v[100:103], v[56:59], a[96:103], v22
  v_smfmac_f32_16x16x64_bf16 v[96:99], v[60:63], a[24:31], v22
  v_smfmac_f32_16x16x64_bf16 v[96:99], v[64:67], a[32:39], v22
  v_smfmac_f32_16x16x64_bf16 v[96:99], v[68:71], a[40:47], v22
  v_smfmac_f32_16x16x64_bf16 v[96:99], v[72:75], a[48:55], v22
  v_smfmac_f32_16x16x64_bf16 v[96:99], v[76:79], a[56:63], v22
  v_smfmac_f32_16x16x64_bf16 v[96:99], v[80:83], a[64:71], v22
  v_smfmac_f32_16x16x64_bf16 v[96:99], v[84:87], a[72:79], v22
  v_smfmac_f32_16x16x64_bf16 v[100:103], v[60:63], a[104:111], v22
  v_smfmac_f32_16x16x64_bf16 v[100:103], v[64:67], a[112:119], v22
  v_smfmac_f32_16x16x64_bf16 v[100:103], v[68:71], a[120:127], v22
  v_smfmac_f32_16x16x64_bf16 v[100:103], v[72:75], a[128:135], v22
  v_smfmac_f32_16x16x64_bf16 v[100:103], v[76:79], a[136:143], v22
  v_smfmac_f32_16x16x64_bf16 v[100:103], v[80:83], a[144:151], v22
  v_smfmac_f32_16x16x64_bf16 v[100:103], v[84:87], a[152:159], v22
  s_nop 7
  v_permlane32_swap_b32 v96, v100
  v_permlane32_swap_b32 v97, v101
  v_permlane32_swap_b32 v98, v102
  v_permlane32_swap_b32 v99, v103
  v_pk_add_f32 v[96:97], v[96:97], v[100:101]
  v_pk_add_f32 v[98:99], v[98:99], v[102:103]
  v_cvt_pk_bf16_f32 v100, v96, v97
  v_cvt_pk_bf16_f32 v101, v98, v99
  s_nop 0
  v_permlane32_swap_b32 v100, v102
  v_permlane32_swap_b32 v101, v103
  v_min_u32 v100, -2, v100
  buffer_store_dwordx4 v[100:103], v26, s[16:19], s70 offen sc1
  s_waitcnt vmcnt(0)
  s_barrier
  s_branch chain_done
E_32:
  v_add_u32 v190, 7168, v4
  ds_write_b32 v13, v28
  ds_write_b32 v14, v28
  s_waitcnt vmcnt(0)
  ds_write_b128 v190, v[76:79] offset:0
  ds_write_b128 v190, v[80:83] offset:1024
  ds_write_b128 v190, v[84:87] offset:2048
  s_waitcnt lgkmcnt(0)
  s_branch mo_112
  .p2align 3
top_107:
  s_waitcnt vmcnt(2)
  ds_write_b128 v190, v[76:79] offset:0
  v_cmp_eq_u32 s[22:23], -1, v76
  s_waitcnt vmcnt(1)
  ds_write_b128 v190, v[80:83] offset:1024
  v_cmp_eq_u32 s[98:99], -1, v80
  s_waitcnt vmcnt(0)
  ds_write_b128 v190, v[84:87] offset:2048
  v_cmp_eq_u32 s[100:101], -1, v84
  s_or_b64 vcc, s[22:23], s[98:99]
  s_or_b64 vcc, vcc, s[100:101]
  s_cbranch_scc1 mr_108
mo_112:
  s_barrier
  ds_read_b128 v[48:51], v4 offset:0
  ds_read_b128 v[52:55], v4 offset:1024
  v_smfmac_f32_16x16x64_bf16 v[92:95], v[76:79], v[232:239], v22
  ds_read_b128 v[56:59], v4 offset:2048
  ds_read_b128 v[60:63], v4 offset:3072
  v_smfmac_f32_16x16x64_bf16 v[88:91], v[76:79], a[216:223], v22
  s_add_u32 m0, s74, 0
  s_add_u32 s21, s79, 0
  buffer_load_dwordx4 v4, s[16:19], s21 offen offset:1024 sc1 lds
  v_smfmac_f32_16x16x64_bf16 v[92:95], v[80:83], v[240:247], v22
  ds_read_b128 v[64:67], v4 offset:4096
  ds_read_b128 v[68:71], v4 offset:5120
  s_add_u32 s22, s52, 3
  s_min_u32 s22, s22, 64
  v_smfmac_f32_16x16x64_bf16 v[88:91], v[80:83], a[224:231], v22
  s_add_u32 m0, s74, 2048
  s_add_u32 s21, s79, 65536
  buffer_load_dwordx4 v4, s[16:19], s21 offen offset:1024 sc1 lds
  v_cmp_gt_u32 vcc, s22, v42
  v_smfmac_f32_16x16x64_bf16 v[92:95], v[84:87], v[248:255], v22
  ds_read_b128 v[72:75], v4 offset:6144
  s_cbranch_vccnz kw_113
kv_114:
  v_smfmac_f32_16x16x64_bf16 v[88:91], v[84:87], a[232:239], v22
  s_waitcnt lgkmcnt(6)
  s_add_u32 m0, s74, 10240
  s_nop 0
  buffer_load_dwordx4 v4, s[16:19], s73 offen offset:0 sc1 lds
  v_smfmac_f32_16x16x64_bf16 v[92:95], v[48:51], a[240:247], v22
  v_smfmac_f32_16x16x64_bf16 v[88:91], v[48:51], a[160:167], v22
  s_waitcnt lgkmcnt(5)
  s_add_u32 m0, s74, 10240
  s_nop 0
  buffer_load_dwordx4 v4, s[16:19], s73 offen offset:1024 sc1 lds
  v_smfmac_f32_16x16x64_bf16 v[92:95], v[52:55], a[248:255], v22
  s_waitcnt lgkmcnt(4)
  v_smfmac_f32_16x16x64_bf16 v[92:95], v[56:59], v[192:199], v22
  s_waitcnt lgkmcnt(3)
  s_add_u32 m0, s74, 10240
  s_nop 0
  buffer_load_dwordx4 v4, s[16:19], s73 offen offset:2048 sc1 lds
  v_smfmac_f32_16x16x64_bf16 v[92:95], v[60:63], v[200:207], v22
  s_waitcnt lgkmcnt(2)
  v_smfmac_f32_16x16x64_bf16 v[92:95], v[64:67], v[208:215], v22
  s_waitcnt lgkmcnt(1)
  s_add_u32 m0, s74, 0
  s_mul_i32 s21, s91, 0
  s_add_u32 s21, s21, s71
  buffer_load_dwordx4 v4, s[16:19], s21 offen sc1 lds
  v_smfmac_f32_16x16x64_bf16 v[92:95], v[68:71], v[216:223], v22
  s_waitcnt lgkmcnt(0)
  v_smfmac_f32_16x16x64_bf16 v[92:95], v[72:75], v[224:231], v22
  s_add_u32 m0, s74, 2048
  s_mul_i32 s21, s91, 1
  s_add_u32 s21, s21, s71
  buffer_load_dwordx4 v4, s[16:19], s21 offen sc1 lds
  v_smfmac_f32_16x16x64_bf16 v[88:91], v[52:55], a[168:175], v22
  v_smfmac_f32_16x16x64_bf16 v[88:91], v[56:59], a[176:183], v22
  v_smfmac_f32_16x16x64_bf16 v[88:91], v[60:63], a[184:191], v22
  v_cvt_pk_bf16_f32 v122, v92, v93
  v_smfmac_f32_16x16x64_bf16 v[88:91], v[64:67], a[192:199], v22
  v_cvt_pk_bf16_f32 v123, v94, v95
  s_barrier
  v_smfmac_f32_16x16x64_bf16 v[88:91], v[68:71], a[200:207], v22
  ds_write_b64 v12, v[122:123] offset:13056
  v_smfmac_f32_16x16x64_bf16 v[88:91], v[72:75], a[208:215], v22
  v_smfmac_f32_16x16x64_bf16 v[96:99], v[48:51], a[0:7], v22
  v_smfmac_f32_16x16x64_bf16 v[100:103], v[48:51], a[80:87], v22
  v_smfmac_f32_16x16x64_bf16 v[96:99], v[52:55], a[8:15], v22
  v_cvt_pk_bf16_f32 v120, v88, v89
  v_cvt_pk_bf16_f32 v121, v90, v91
  ds_write_b64 v12, v[120:121] offset:12544
  v_smfmac_f32_16x16x64_bf16 v[100:103], v[52:55], a[88:95], v22
  s_waitcnt lgkmcnt(0)
  s_barrier
  ds_read_b64_tr_b16 v[104:105], v7 offset:0
  ds_read_b64_tr_b16 v[106:107], v7 offset:768
  ds_read_b64_tr_b16 v[108:109], v7 offset:1536
  ds_read_b32 v27, v12 offset:12544
  ds_read_b64 v[140:141], v11
  s_waitcnt lgkmcnt(1)
  v_cmp_u_f32 vcc, v104, v106
  v_cmp_u_f32 s[22:23], v108, v27
  s_nop 1
  s_or_b64 vcc, vcc, s[22:23]
  s_cbranch_vccnz mn_109
mk_110:
  s_cmp_eq_u32 s52, 63
  s_cbranch_scc1 last_111
  v_permlane32_swap_b32 v88, v92
  v_permlane32_swap_b32 v89, v93
  v_permlane32_swap_b32 v90, v94
  v_permlane32_swap_b32 v91, v95
  v_pk_add_f32 v[88:89], v[88:89], v[92:93]
  v_pk_add_f32 v[90:91], v[90:91], v[94:95]
  v_cvt_pk_bf16_f32 v92, v88, v89
  v_cvt_pk_bf16_f32 v93, v90, v91
  v_min_u32 v92, -2, v92
  s_nop 0
  v_smfmac_f32_16x16x64_bf16 v[96:99], v[56:59], a[16:23], v22
  v_smfmac_f32_16x16x64_bf16 v[100:103], v[56:59], a[96:103], v22
  v_smfmac_f32_16x16x64_bf16 v[96:99], v[60:63], a[24:31], v22
  v_smfmac_f32_16x16x64_bf16 v[96:99], v[64:67], a[32:39], v22
  v_smfmac_f32_16x16x64_bf16 v[96:99], v[68:71], a[40:47], v22
  v_smfmac_f32_16x16x64_bf16 v[96:99], v[72:75], a[48:55], v22
  v_smfmac_f32_16x16x64_bf16 v[96:99], v[76:79], a[56:63], v22
  v_smfmac_f32_16x16x64_bf16 v[96:99], v[80:83], a[64:71], v22
  v_smfmac_f32_16x16x64_bf16 v[96:99], v[84:87], a[72:79], v22
  v_smfmac_f32_16x16x64_bf16 v[100:103], v[60:63], a[104:111], v22
  v_smfmac_f32_16x16x64_bf16 v[100:103], v[64:67], a[112:119], v22
  buffer_load_dwordx4 v[132:135], v10, s[8:11], s56 offen sc1
  v_smfmac_f32_16x16x64_bf16 v[100:103], v[68:71], a[120:127], v22
  buffer_load_dwordx4 v[124:127], v9, s[8:11], s56 offen sc1
  v_smfmac_f32_16x16x64_bf16 v[100:103], v[72:75], a[128:135], v22
  buffer_load_dwordx4 v[128:131], v9, s[8:11], s56 offen offset:1024 sc1
  v_cvt_pk_bf16_f32 v136, v96, v97
  v_smfmac_f32_16x16x64_bf16 v[100:103], v[76:79], a[136:143], v22
  v_cvt_pk_bf16_f32 v137, v98, v99
  v_smfmac_f32_16x16x64_bf16 v[100:103], v[80:83], a[144:151], v22
  v_smfmac_f32_16x16x64_bf16 v[100:103], v[84:87], a[152:159], v22
  s_nop 7
  v_cvt_pk_bf16_f32 v138, v100, v101
  v_cvt_pk_bf16_f32 v139, v102, v103
  v_permlane32_swap_b32 v96, v100
  v_permlane32_swap_b32 v97, v101
  v_permlane32_swap_b32 v98, v102
  v_permlane32_swap_b32 v99, v103
  v_pk_add_f32 v[96:97], v[96:97], v[100:101]
  v_pk_add_f32 v[98:99], v[98:99], v[102:103]
  v_cvt_pk_bf16_f32 v100, v96, v97
  v_cvt_pk_bf16_f32 v101, v98, v99
  s_nop 0
  v_permlane32_swap_b32 v100, v102
  v_permlane32_swap_b32 v101, v103
  v_min_u32 v100, -2, v100
  s_waitcnt vmcnt(2) lgkmcnt(0)
  v_pk_add_f16 v164, v132, v133
  v_pk_add_f16 v165, v134, v135
  v_fma_mix_f32 v170, v164, 1.0, v165 op_sel:[0,0,0] op_sel_hi:[1,0,1]
  v_fma_mix_f32 v171, v164, 1.0, v165 op_sel:[1,0,1] op_sel_hi:[1,0,1]
  v_exp_f32 v176, v170
  v_exp_f32 v177, v171
  s_waitcnt vmcnt(1)
  v_cvt_pk_bf16_f32 v160, v176, v177
  v_pk_add_f16 v120, v124, v126
  v_pk_add_f16 v121, v125, v127
  v_mov_b32_dpp v161, v160 row_ror:8 row_mask:0xf bank_mask:0xf
  s_waitcnt vmcnt(0)
  v_pk_add_f16 v122, v128, v130
  v_mfma_f32_16x16x32_bf16 v[178:181], v[140:143], v[160:163], 0
  v_fma_mix_f32 v166, v120, 1.0, v122 op_sel:[0,0,0] op_sel_hi:[1,0,1]
  v_fma_mix_f32 v167, v120, 1.0, v122 op_sel:[1,0,1] op_sel_hi:[1,0,1]
  v_cmp_u_f32 vcc, v166, v170
  v_pk_add_f16 v123, v129, v131
  v_exp_f32 v172, v166
  v_mfma_f32_16x16x32_bf16 v[182:185], v[136:139], v[160:163], 0
  s_cbranch_vccnz sr_117
  v_exp_f32 v173, v167
  v_fma_mix_f32 v168, v121, 1.0, v123 op_sel:[0,0,0] op_sel_hi:[1,0,1]
  v_fma_mix_f32 v169, v121, 1.0, v123 op_sel:[1,0,1] op_sel_hi:[1,0,1]
  v_cvt_pk_bf16_f32 v156, v172, v173
  v_exp_f32 v174, v168
  v_exp_f32 v175, v169
  v_mov_b32_dpp v158, v156 row_ror:8 row_mask:0xf bank_mask:0xf
  v_cvt_pk_bf16_f32 v157, v174, v175
  v_mfma_f32_16x16x32_bf16 v[186:189], v[138:141], v[160:163], 0
  s_nop 0
  v_mov_b32_dpp v159, v157 row_ror:8 row_mask:0xf bank_mask:0xf
  s_nop 1
pv_118:
  v_mfma_f32_16x16x32_bf16 v[178:181], v[152:155], v[156:159], v[178:181]
  v_mfma_f32_16x16x32_bf16 v[182:185], v[144:147], v[156:159], v[182:185]
  v_mfma_f32_16x16x32_bf16 v[186:189], v[148:151], v[156:159], v[186:189]
  s_mov_b64 exec, s[62:63]
  s_nop 0
  v_rcp_f32 v164, v180
  v_cmp_ngt_f32 s[22:23], s80, v180
  v_cmp_ngt_f32 vcc, s80, v164
  v_pk_mul_f32 v[182:183], v[182:183], v[164:165] op_sel_hi:[1,0]
  v_pk_mul_f32 v[184:185], v[184:185], v[164:165] op_sel_hi:[1,0]
  v_pk_mul_f32 v[178:179], v[178:179], v[164:165] op_sel_hi:[1,0]
  v_pk_mul_f32 v[186:187], v[186:187], v[164:165] op_sel_hi:[1,0]
  v_pk_mul_f32 v[188:189], v[188:189], v[164:165] op_sel_hi:[1,0]
  v_cvt_pk_f16_f32 v64, v178, v179
  s_or_b64 vcc, vcc, s[22:23]
  s_cbranch_scc1 fx_120
fk_121:
  ds_write_b32 v14, v64
  v_cvt_pk_f16_f32 v60, v182, v183
  v_cvt_pk_f16_f32 v61, v184, v185
  v_cvt_pk_f16_f32 v62, v186, v187
  v_cvt_pk_f16_f32 v63, v188, v189
  ds_write_b128 v13, v[60:63]
  s_mov_b64 exec, s[66:67]
  s_barrier
  ds_read_b128 v[166:169], v4 offset:13824
  ds_read_b128 v[170:173], v4 offset:14464
  ds_read_b128 v[174:177], v4 offset:15104
  ds_read_b128 v[178:181], v4 offset:15744
  s_waitcnt lgkmcnt(2)
  v_pk_add_f16 v166, v166, v170
  v_pk_add_f16 v167, v167, v171
  v_pk_add_f16 v168, v168, v172
  v_pk_add_f16 v169, v169, v173
  s_waitcnt lgkmcnt(1)
  v_pk_add_f16 v166, v166, v174
  v_pk_add_f16 v167, v167, v175
  v_pk_add_f16 v168, v168, v176
  v_pk_add_f16 v169, v169, v177
  s_waitcnt lgkmcnt(0)
  v_pk_add_f16 v166, v166, v178
  v_cmpx_o_f16 vcc, v166, v166
  v_pk_add_f16 v167, v167, v179
  v_pk_add_f16 v168, v168, v180
  v_pk_add_f16 v169, v169, v181
  v_and_or_b32 v166, v166, -2, s61
  buffer_store_dwordx4 v[166:169], v15, s[4:7], s60 offen sc1
  s_xor_b64 s[98:99], exec, s[66:67]
  s_mov_b64 exec, -1
  buffer_store_dwordx4 v[100:103], v26, s[16:19], s70 offen sc1
  buffer_store_dwordx2 v[92:93], v43, s[16:19], s70 offen sc1
  s_add_u32 s70, s70, 2097152
  s_xor_b32 s70, s70, 8192
  ds_read_b128 v[144:147], v18
  ds_read_b128 v[148:151], v18 offset:1024
  ds_read_b128 v[152:155], v19
  v_xor_b32 v18, 16384, v18
  v_xor_b32 v19, 16384, v19
  v_mov_b32 v88, 0
  v_mov_b32 v89, 0
  v_mov_b32 v90, 0
  v_mov_b32 v91, 0
  v_mov_b32 v92, 0
  v_mov_b32 v93, 0
  v_mov_b32 v94, 0
  v_mov_b32 v95, 0
  v_mov_b32 v96, 0
  v_mov_b32 v97, 0
  v_mov_b32 v98, 0
  v_mov_b32 v99, 0
  v_mov_b32 v100, 0
  v_mov_b32 v101, 0
  v_mov_b32 v102, 0
  v_mov_b32 v103, 0
  s_mov_b32 s81, 0
  s_waitcnt lgkmcnt(0)
  s_barrier
  s_cmp_lg_u64 s[98:99], 0
  s_cbranch_scc1 pf_122
pf_123:
  s_xor_b32 s74, s74, 16384
  s_add_u32 s73, s73, 2097152
  s_xor_b32 s73, s73, 8192
  s_add_u32 s79, s79, 2097152
  s_xor_b32 s79, s79, 8192
  s_add_u32 s21, s72, 524288
  s_xor_b32 s72, s72, s21
  s_lshr_b32 s72, s72, 8
  s_and_b32 s72, s72, 8192
  s_xor_b32 s72, s72, s21
  s_add_u32 s71, s73, 4096
  s_mov_b32 s91, 1024
  s_sub_u32 s21, s73, 0
  s_cmp_lt_u32 s21, 125829120
  s_cselect_b32 s71, s71, s79
  s_cselect_b32 s91, s91, 65536
  v_mov_b32 v166, s52
  s_add_u32 s22, s52, 5
  s_min_u32 s22, s22, 64
  v_cmp_gt_u32 vcc, s22, v42
  s_cbranch_vccz fv_125
  buffer_load_dword v42, v41, s[12:15], s76 offen sc1
fv_125:
  ds_write_b128 v190, v[28:31] offset:0
  ds_write_b128 v190, v[28:31] offset:1024
  ds_write_b128 v190, v[28:31] offset:2048
nt_124:
  s_barrier
  s_mov_b32 s58, s55
  s_add_u32 s52, s52, 1
  ds_write_b32 v13, v28
  ds_write_b32 v14, v28
  s_and_b32 s21, s52, 3
  s_mul_i32 s56, s21, 122880
  s_add_u32 s21, s52, 1
  s_and_b32 s21, s21, 3
  s_mul_i32 s55, s21, 122880
  s_add_u32 s55, s55, s75
  s_add_u32 s21, s52, 2
  s_and_b32 s21, s21, 3
  s_mul_i32 s57, s21, 122880
  s_add_u32 s21, s52, 3
  s_and_b32 s21, s21, 3
  s_mul_i32 s59, s21, 122880
  s_add_u32 s59, s59, s75
  s_bfe_u32 s61, s52, 0x10002
  s_and_b32 s21, s52, 3
  s_lshl_b32 s60, s21, 18
  s_mov_b32 s54, 0
  s_sleep 2
  s_nop 10
  s_waitcnt lgkmcnt(0)
  buffer_load_dwordx4 v[76:79], v190, s[8:11], s58 offen offset:0 sc1
  buffer_load_dwordx4 v[80:83], v190, s[8:11], s58 offen offset:1024 sc1
  buffer_load_dwordx4 v[84:87], v190, s[8:11], s58 offen offset:2048 sc1
  s_branch top_107
mr_108:
  s_mov_b64 exec, s[22:23]
  s_cbranch_execz ms_126
  buffer_load_dwordx4 v[76:79], v190, s[8:11], s58 offen offset:0 sc1
ms_126:
  s_mov_b64 exec, s[98:99]
  s_cbranch_execz ms_127
  buffer_load_dwordx4 v[80:83], v190, s[8:11], s58 offen offset:1024 sc1
ms_127:
  s_mov_b64 exec, s[100:101]
  s_cbranch_execz ms_128
  buffer_load_dwordx4 v[84:87], v190, s[8:11], s58 offen offset:2048 sc1
ms_128:
  s_add_u32 s54, s54, 1
  s_cmp_gt_u32 s54, 131072
  s_cbranch_scc1 end0
  s_waitcnt vmcnt(0)
  s_mov_b64 exec, s[22:23]
  ds_write_b128 v190, v[76:79] offset:0
  v_cmp_eq_u32 s[22:23], -1, v76
  s_mov_b64 exec, s[98:99]
  ds_write_b128 v190, v[80:83] offset:1024
  v_cmp_eq_u32 s[98:99], -1, v80
  s_mov_b64 exec, s[100:101]
  ds_write_b128 v190, v[84:87] offset:2048
  v_cmp_eq_u32 s[100:101], -1, v84
  s_mov_b64 exec, -1
  s_or_b64 vcc, s[22:23], s[98:99]
  s_or_b64 vcc, vcc, s[100:101]
  s_cbranch_scc1 mr_108
  s_branch mo_112
kw_113:
  s_mov_b32 s101, 0
wm_129:
  buffer_load_dword v42, v41, s[12:15], s76 offen sc1
  s_add_u32 s101, s101, 1
  s_cmp_gt_u32 s101, 131072
  s_cbranch_scc1 end0
  s_waitcnt vmcnt(0)
  v_cmp_gt_u32 vcc, s22, v42
  v_readfirstlane_b32 s100, v42
  s_nop 0
  s_cbranch_vccz wm_130
  s_sleep 1
  s_branch wm_129
wm_130:
  s_branch kv_114
mn_109:
  s_bitcmp1_b32 s81, 1
  s_cbranch_scc1 mk_110
  s_or_b32 s81, s81, 2
  s_nop 7
  v_mov_b32 v88, 0
  v_mov_b32 v89, 0
  v_mov_b32 v90, 0
  v_mov_b32 v91, 0
  v_mov_b32 v92, 0
  v_mov_b32 v93, 0
  v_mov_b32 v94, 0
  v_mov_b32 v95, 0
  v_mov_b32 v96, 0
  v_mov_b32 v97, 0
  v_mov_b32 v98, 0
  v_mov_b32 v99, 0
  v_mov_b32 v100, 0
  v_mov_b32 v101, 0
  v_mov_b32 v102, 0
  v_mov_b32 v103, 0
  s_cmp_eq_u32 s52, 0
  s_cbranch_scc1 mx_132
mx_131:
  buffer_load_dwordx4 v[76:79], v190, s[8:11], s58 offen offset:0 sc1
  buffer_load_dwordx4 v[80:83], v190, s[8:11], s58 offen offset:1024 sc1
  buffer_load_dwordx4 v[84:87], v190, s[8:11], s58 offen offset:2048 sc1
  s_add_u32 s54, s54, 1
  s_cmp_gt_u32 s54, 131072
  s_cbranch_scc1 end0
  s_waitcnt vmcnt(0)
  v_max3_u32 v27, v76, v77, v78
  v_max3_u32 v27, v27, v79, v80
  v_max3_u32 v27, v27, v81, v82
  v_max3_u32 v27, v27, v83, v84
  v_max3_u32 v27, v27, v85, v86
  v_max3_u32 v27, v27, v87, v87
  v_cmp_eq_u32 vcc, -1, v27
  s_nop 1
  s_cbranch_vccnz mx_131
  ds_write_b128 v190, v[76:79] offset:0
  ds_write_b128 v190, v[80:83] offset:1024
  ds_write_b128 v190, v[84:87] offset:2048
mx_132:
  s_waitcnt lgkmcnt(0)
  s_branch mo_112
sr_117:
  s_mov_b32 s54, 0
sr_133:
  s_mov_b64 exec, vcc
  buffer_load_dwordx4 v[124:127], v9, s[8:11], s56 offen sc1
  buffer_load_dwordx4 v[128:131], v9, s[8:11], s56 offen offset:1024 sc1
  buffer_load_dwordx4 v[132:135], v10, s[8:11], s56 offen sc1
  s_mov_b64 exec, -1
  s_add_u32 s54, s54, 1
  s_cmp_gt_u32 s54, 131072
  s_cbranch_scc1 end0
  s_waitcnt vmcnt(0)
  v_pk_add_f16 v164, v132, v133
  v_pk_add_f16 v165, v134, v135
  v_pk_add_f16 v120, v124, v126
  v_pk_add_f16 v122, v128, v130
  v_fma_mix_f32 v170, v164, 1.0, v165 op_sel:[0,0,0] op_sel_hi:[1,0,1]
  v_fma_mix_f32 v166, v120, 1.0, v122 op_sel:[0,0,0] op_sel_hi:[1,0,1]
  v_pk_add_f16 v121, v125, v127
  v_cmp_u_f32 vcc, v166, v170
  v_pk_add_f16 v123, v129, v131
  v_fma_mix_f32 v171, v164, 1.0, v165 op_sel:[1,0,1] op_sel_hi:[1,0,1]
  v_fma_mix_f32 v167, v120, 1.0, v122 op_sel:[1,0,1] op_sel_hi:[1,0,1]
  v_fma_mix_f32 v168, v121, 1.0, v123 op_sel:[0,0,0] op_sel_hi:[1,0,1]
  v_fma_mix_f32 v169, v121, 1.0, v123 op_sel:[1,0,1] op_sel_hi:[1,0,1]
  s_cbranch_vccz ex_119
  s_and_b32 s21, s54, 31
  s_cbranch_scc1 sr_133
  v_max3_u32 v27, v124, v126, v128
  v_max3_u32 v27, v27, v130, v132
  v_max3_u32 v27, v27, v133, v134
  v_max3_u32 v27, v27, v135, v135
  v_cmp_eq_u32 vcc, -1, v27
  s_nop 1
  s_cbranch_vccnz sr_133
ex_119:
  v_exp_f32 v176, v170
  v_exp_f32 v177, v171
  v_exp_f32 v172, v166
  v_cvt_pk_bf16_f32 v160, v176, v177
  v_exp_f32 v173, v167
  v_exp_f32 v174, v168
  v_mov_b32_dpp v161, v160 row_ror:8 row_mask:0xf bank_mask:0xf
  v_cvt_pk_bf16_f32 v156, v172, v173
  v_exp_f32 v175, v169
  v_mfma_f32_16x16x32_bf16 v[178:181], v[140:143], v[160:163], 0
  v_mov_b32_dpp v158, v156 row_ror:8 row_mask:0xf bank_mask:0xf
  v_cvt_pk_bf16_f32 v157, v174, v175
  v_mfma_f32_16x16x32_bf16 v[182:185], v[136:139], v[160:163], 0
  s_nop 0
  v_mov_b32_dpp v159, v157 row_ror:8 row_mask:0xf bank_mask:0xf
  v_mfma_f32_16x16x32_bf16 v[186:189], v[138:141], v[160:163], 0
  s_branch pv_118
fx_120:
  s_bitcmp1_b32 s81, 0
  s_cbranch_scc1 fk_121
  s_or_b32 s81, s81, 1
  s_mov_b64 exec, -1
  v_max3_f32 v164, v166, v167, v168
  v_max3_f32 v165, v169, v170, v171
  v_max_f32 v164, v164, v165
  s_nop 1
  v_max_f32_dpp v164, v164, v164 row_ror:8 row_mask:0xf bank_mask:0xf
  v_mov_b32 v165, v164
  s_nop 1
  v_permlane32_swap_b32 v164, v165
  v_max_f32 v164, v164, v165
  v_mov_b32 v165, v164
  s_nop 1
  v_permlane16_swap_b32 v164, v165
  v_max_f32 v164, v164, v165
  v_sub_f32 v166, v166, v164
  v_sub_f32 v167, v167, v164
  v_sub_f32 v168, v168, v164
  v_sub_f32 v169, v169, v164
  v_sub_f32 v170, v170, v164
  v_sub_f32 v171, v171, v164
  s_branch ex_119
pf_122:
  s_mov_b64 exec, s[66:67]
  ds_read_b128 v[166:169], v4 offset:13824
  ds_read_b128 v[170:173], v4 offset:14464
  ds_read_b128 v[174:177], v4 offset:15104
  ds_read_b128 v[178:181], v4 offset:15744
  s_waitcnt lgkmcnt(2)
  v_pk_add_f16 v166, v166, v170
  v_pk_add_f16 v167, v167, v171
  v_pk_add_f16 v168, v168, v172
  v_pk_add_f16 v169, v169, v173
  s_waitcnt lgkmcnt(1)
  v_pk_add_f16 v166, v166, v174
  v_pk_add_f16 v167, v167, v175
  v_pk_add_f16 v168, v168, v176
  v_pk_add_f16 v169, v169, v177
  s_waitcnt lgkmcnt(0)
  v_pk_add_f16 v166, v166, v178
  v_pk_add_f16 v167, v167, v179
  v_pk_add_f16 v168, v168, v180
  v_pk_add_f16 v169, v169, v181
  v_and_or_b32 v166, v166, -2, s61
  buffer_store_dwordx4 v[166:169], v15, s[4:7], s60 offen sc1
  s_mov_b64 exec, -1
  s_nop 1
  s_branch pf_123
last_111:
  v_permlane32_swap_b32 v88, v92
  v_permlane32_swap_b32 v89, v93
  v_permlane32_swap_b32 v90, v94
  v_permlane32_swap_b32 v91, v95
  v_pk_add_f32 v[88:89], v[88:89], v[92:93]
  v_pk_add_f32 v[90:91], v[90:91], v[94:95]
  v_cvt_pk_bf16_f32 v92, v88, v89
  v_cvt_pk_bf16_f32 v93, v90, v91
  v_min_u32 v92, -2, v92
  buffer_store_dwordx2 v[92:93], v43, s[16:19], s70 offen sc1
  v_smfmac_f32_16x16x64_bf16 v[96:99], v[56:59], a[16:23], v22
  v_smfmac_f32_16x16x64_bf16 v[100:103], v[56:59], a[96:103], v22
  v_smfmac_f32_16x16x64_bf16 v[96:99], v[60:63], a[24:31], v22
  v_smfmac_f32_16x16x64_bf16 v[96:99], v[64:67], a[32:39], v22
  v_smfmac_f32_16x16x64_bf16 v[96:99], v[68:71], a[40:47], v22
  v_smfmac_f32_16x16x64_bf16 v[96:99], v[72:75], a[48:55], v22
  v_smfmac_f32_16x16x64_bf16 v[96:99], v[76:79], a[56:63], v22
  v_smfmac_f32_16x16x64_bf16 v[96:99], v[80:83], a[64:71], v22
  v_smfmac_f32_16x16x64_bf16 v[96:99], v[84:87], a[72:79], v22
  v_smfmac_f32_16x16x64_bf16 v[100:103], v[60:63], a[104:111], v22
  v_smfmac_f32_16x16x64_bf16 v[100:103], v[64:67], a[112:119], v22
  v_smfmac_f32_16x16x64_bf16 v[100:103], v[68:71], a[120:127], v22
  v_smfmac_f32_16x16x64_bf16 v[100:103], v[72:75], a[128:135], v22
  v_smfmac_f32_16x16x64_bf16 v[100:103], v[76:79], a[136:143], v22
  v_smfmac_f32_16x16x64_bf16 v[100:103], v[80:83], a[144:151], v22
  v_smfmac_f32_16x16x64_bf16 v[100:103], v[84:87], a[152:159], v22
  s_nop 7
  v_permlane32_swap_b32 v96, v100
  v_permlane32_swap_b32 v97, v101
  v_permlane32_swap_b32 v98, v102
  v_permlane32_swap_b32 v99, v103
  v_pk_add_f32 v[96:97], v[96:97], v[100:101]
  v_pk_add_f32 v[98:99], v[98:99], v[102:103]
  v_cvt_pk_bf16_f32 v100, v96, v97
  v_cvt_pk_bf16_f32 v101, v98, v99
  s_nop 0
  v_permlane32_swap_b32 v100, v102
  v_permlane32_swap_b32 v101, v103
  v_min_u32 v100, -2, v100
  buffer_store_dwordx4 v[100:103], v26, s[16:19], s70 offen sc1
  s_waitcnt vmcnt(0)
  s_barrier
  v_mov_b32 v166, 64
  s_mov_b64 exec, 1
  buffer_store_dword v166, v23, s[12:15], s77 offen sc1
  s_mov_b64 exec, -1
  s_branch chain_done
E_25:
  v_add_u32 v190, 0, v4
  ds_write_b64 v6, v[28:29]
  ds_write_b32 v13, v28
  ds_write_b32 v14, v28
  s_waitcnt vmcnt(0)
  ds_write_b128 v190, v[48:51] offset:0
  ds_write_b128 v190, v[52:55] offset:1024
  s_waitcnt lgkmcnt(0)
  s_add_u32 m0, s74, 4096
  s_add_u32 s21, s79, 131072
  buffer_load_dwordx4 v4, s[16:19], s21 offen offset:1024 sc1 lds
  s_add_u32 m0, s74, 9216
  s_add_u32 s21, s72, 32768
  buffer_load_dwordx4 v32, s[16:19], s21 offen sc1 lds
  s_xor_b32 s74, s74, 16384
  s_add_u32 s73, s73, 2097152
  s_xor_b32 s73, s73, 8192
  s_add_u32 s79, s79, 2097152
  s_xor_b32 s79, s79, 8192
  s_add_u32 s21, s72, 524288
  s_xor_b32 s72, s72, s21
  s_lshr_b32 s72, s72, 8
  s_and_b32 s72, s72, 8192
  s_xor_b32 s72, s72, s21
  s_add_u32 s71, s73, 4096
  s_mov_b32 s91, 1024
  s_sub_u32 s21, s73, 0
  s_cmp_lt_u32 s21, 125829120
  s_cselect_b32 s71, s71, s79
  s_cselect_b32 s91, s91, 65536
  s_branch mo_140
  .p2align 3
top_135:
  s_waitcnt vmcnt(1)
  ds_write_b128 v190, v[48:51] offset:0
  v_cmp_eq_u32 s[22:23], -1, v48
  s_waitcnt vmcnt(0)
  ds_write_b128 v190, v[52:55] offset:1024
  v_cmp_eq_u32 s[98:99], -1, v52
  s_or_b64 vcc, s[22:23], s[98:99]
  s_cbranch_scc1 mr_136
mo_140:
  s_barrier
  ds_read_b128 v[56:59], v4 offset:2048
  ds_read_b128 v[60:63], v4 offset:3072
  v_smfmac_f32_16x16x64_bf16 v[92:95], v[48:51], a[240:247], v22
  ds_read_b128 v[64:67], v4 offset:4096
  v_smfmac_f32_16x16x64_bf16 v[88:91], v[48:51], a[160:167], v22
  ds_read_b128 v[68:71], v4 offset:5120
  v_smfmac_f32_16x16x64_bf16 v[92:95], v[52:55], a[248:255], v22
  ds_read_b128 v[72:75], v4 offset:6144
  v_smfmac_f32_16x16x64_bf16 v[88:91], v[52:55], a[168:175], v22
  s_waitcnt lgkmcnt(4)
  ds_read_b128 v[76:79], v4 offset:7168
  v_smfmac_f32_16x16x64_bf16 v[92:95], v[56:59], v[192:199], v22
  ds_read_b128 v[80:83], v4 offset:8192
  v_smfmac_f32_16x16x64_bf16 v[88:91], v[56:59], a[176:183], v22
  s_waitcnt lgkmcnt(5)
  ds_read_b128 v[84:87], v4 offset:9216
  v_smfmac_f32_16x16x64_bf16 v[92:95], v[60:63], v[200:207], v22
  v_smfmac_f32_16x16x64_bf16 v[88:91], v[60:63], a[184:191], v22
  s_waitcnt lgkmcnt(5)
  v_smfmac_f32_16x16x64_bf16 v[92:95], v[64:67], v[208:215], v22
  s_waitcnt lgkmcnt(4)
  v_smfmac_f32_16x16x64_bf16 v[92:95], v[68:71], v[216:223], v22
  s_waitcnt lgkmcnt(3)
  v_smfmac_f32_16x16x64_bf16 v[92:95], v[72:75], v[224:231], v22
  s_waitcnt lgkmcnt(2)
  v_smfmac_f32_16x16x64_bf16 v[92:95], v[76:79], v[232:239], v22
  s_waitcnt lgkmcnt(1)
  v_smfmac_f32_16x16x64_bf16 v[92:95], v[80:83], v[240:247], v22
  s_waitcnt lgkmcnt(0)
  v_smfmac_f32_16x16x64_bf16 v[92:95], v[84:87], v[248:255], v22
  v_smfmac_f32_16x16x64_bf16 v[88:91], v[64:67], a[192:199], v22
  v_smfmac_f32_16x16x64_bf16 v[88:91], v[68:71], a[200:207], v22
  v_smfmac_f32_16x16x64_bf16 v[88:91], v[72:75], a[208:215], v22
  v_permlane32_swap_b32 v92, v93
  v_smfmac_f32_16x16x64_bf16 v[88:91], v[76:79], a[216:223], v22
  v_permlane32_swap_b32 v94, v95
  v_smfmac_f32_16x16x64_bf16 v[88:91], v[80:83], a[224:231], v22
  v_permlane32_swap_b32 v93, v92
  v_smfmac_f32_16x16x64_bf16 v[88:91], v[84:87], a[232:239], v22
  v_permlane32_swap_b32 v95, v94
  v_pk_mul_f32 v[120:121], v[92:93], v[24:25] op_sel:[1,0] op_sel_hi:[0,1]
  v_pk_mul_f32 v[122:123], v[94:95], v[24:25] op_sel:[1,0] op_sel_hi:[0,1]
  s_nop 4
  v_pk_fma_f32 v[88:89], v[88:89], v[24:25], v[120:121]
  v_pk_fma_f32 v[90:91], v[90:91], v[24:25], v[122:123]
  v_cvt_pk_bf16_f32 v120, v88, v89
  v_cvt_pk_bf16_f32 v121, v90, v91
  ds_write_b64 v6, v[120:121]
  s_barrier
  ds_read_b64_tr_b16 v[104:105], v7 offset:0
  ds_read_b64_tr_b16 v[106:107], v7 offset:768
  ds_read_b64_tr_b16 v[108:109], v7 offset:1536
  s_waitcnt lgkmcnt(1)
  v_mfma_f32_16x16x32_bf16 v[120:123], v[112:115], v[104:107], 0
  s_waitcnt lgkmcnt(0)
  v_mfma_f32_16x16x32_bf16 v[120:123], v[116:119], v[108:111], v[120:123]
  s_mov_b64 exec, s[64:65]
  s_nop 6
  v_cmpx_o_f32 vcc, v120, v121
  v_cvt_pk_f16_f32 v120, v120, v121
  v_cvt_pk_f16_f32 v121, v122, v123
  buffer_store_dwordx2 v[120:121], v8, s[8:11], s56 offen sc1
  s_xor_b64 s[98:99], exec, s[64:65]
  s_mov_b64 exec, -1
  s_waitcnt lgkmcnt(0)
  s_barrier
  ds_read_b64_tr_b16 v[104:105], v7 offset:0
  ds_read_b64_tr_b16 v[106:107], v7 offset:768
  ds_read_b64_tr_b16 v[108:109], v7 offset:1536
  ds_read_b32 v27, v12 offset:12544
  ds_read_b64 v[140:141], v11
  s_waitcnt lgkmcnt(1)
  v_cmp_u_f32 vcc, v104, v106
  v_cmp_u_f32 s[22:23], v108, v27
  s_nop 1
  s_or_b64 vcc, vcc, s[22:23]
  s_cbranch_vccnz mn_137
mk_138:
  s_cmp_eq_u32 s52, 63
  s_cbranch_scc1 last_139
  s_cmp_lg_u64 s[98:99], 0
  s_cbranch_scc1 sf_141
sf_142:
  s_nop 15
  s_nop 10
  v_smfmac_f32_16x16x64_bf16 v[96:99], v[48:51], a[0:7], v22
  v_smfmac_f32_16x16x64_bf16 v[100:103], v[48:51], a[80:87], v22
  v_smfmac_f32_16x16x64_bf16 v[96:99], v[52:55], a[8:15], v22
  v_smfmac_f32_16x16x64_bf16 v[100:103], v[52:55], a[88:95], v22
  v_smfmac_f32_16x16x64_bf16 v[96:99], v[56:59], a[16:23], v22
  v_smfmac_f32_16x16x64_bf16 v[100:103], v[56:59], a[96:103], v22
  buffer_load_dwordx4 v[132:135], v10, s[8:11], s56 offen sc1
  v_smfmac_f32_16x16x64_bf16 v[96:99], v[60:63], a[24:31], v22
  buffer_load_dwordx4 v[124:127], v9, s[8:11], s56 offen sc1
  v_smfmac_f32_16x16x64_bf16 v[96:99], v[64:67], a[32:39], v22
  buffer_load_dwordx4 v[128:131], v9, s[8:11], s56 offen offset:1024 sc1
  v_smfmac_f32_16x16x64_bf16 v[96:99], v[68:71], a[40:47], v22
  v_smfmac_f32_16x16x64_bf16 v[96:99], v[72:75], a[48:55], v22
  v_smfmac_f32_16x16x64_bf16 v[96:99], v[76:79], a[56:63], v22
  v_smfmac_f32_16x16x64_bf16 v[96:99], v[80:83], a[64:71], v22
  v_smfmac_f32_16x16x64_bf16 v[96:99], v[84:87], a[72:79], v22
  v_smfmac_f32_16x16x64_bf16 v[100:103], v[60:63], a[104:111], v22
  v_smfmac_f32_16x16x64_bf16 v[100:103], v[64:67], a[112:119], v22
  v_smfmac_f32_16x16x64_bf16 v[100:103], v[68:71], a[120:127], v22
  v_smfmac_f32_16x16x64_bf16 v[100:103], v[72:75], a[128:135], v22
  v_cvt_pk_bf16_f32 v136, v96, v97
  v_smfmac_f32_16x16x64_bf16 v[100:103], v[76:79], a[136:143], v22
  v_cvt_pk_bf16_f32 v137, v98, v99
  v_smfmac_f32_16x16x64_bf16 v[100:103], v[80:83], a[144:151], v22
  v_smfmac_f32_16x16x64_bf16 v[100:103], v[84:87], a[152:159], v22
  s_nop 7
  v_cvt_pk_bf16_f32 v138, v100, v101
  v_cvt_pk_bf16_f32 v139, v102, v103
  s_waitcnt vmcnt(2) lgkmcnt(0)
  v_pk_add_f16 v164, v132, v133
  v_pk_add_f16 v165, v134, v135
  v_fma_mix_f32 v170, v164, 1.0, v165 op_sel:[0,0,0] op_sel_hi:[1,0,1]
  v_fma_mix_f32 v171, v164, 1.0, v165 op_sel:[1,0,1] op_sel_hi:[1,0,1]
  v_exp_f32 v176, v170
  v_exp_f32 v177, v171
  s_waitcnt vmcnt(1)
  v_cvt_pk_bf16_f32 v160, v176, v177
  v_pk_add_f16 v120, v124, v126
  v_pk_add_f16 v121, v125, v127
  v_mov_b32_dpp v161, v160 row_ror:8 row_mask:0xf bank_mask:0xf
  s_waitcnt vmcnt(0)
  v_pk_add_f16 v122, v128, v130
  v_mfma_f32_16x16x32_bf16 v[178:181], v[140:143], v[160:163], 0
  v_fma_mix_f32 v166, v120, 1.0, v122 op_sel:[0,0,0] op_sel_hi:[1,0,1]
  v_fma_mix_f32 v167, v120, 1.0, v122 op_sel:[1,0,1] op_sel_hi:[1,0,1]
  v_cmp_u_f32 vcc, v166, v170
  v_pk_add_f16 v123, v129, v131
  v_exp_f32 v172, v166
  v_mfma_f32_16x16x32_bf16 v[182:185], v[136:139], v[160:163], 0
  s_cbranch_vccnz sr_143
  v_exp_f32 v173, v167
  v_fma_mix_f32 v168, v121, 1.0, v123 op_sel:[0,0,0] op_sel_hi:[1,0,1]
  v_fma_mix_f32 v169, v121, 1.0, v123 op_sel:[1,0,1] op_sel_hi:[1,0,1]
  v_cvt_pk_bf16_f32 v156, v172, v173
  v_exp_f32 v174, v168
  v_exp_f32 v175, v169
  v_mov_b32_dpp v158, v156 row_ror:8 row_mask:0xf bank_mask:0xf
  v_cvt_pk_bf16_f32 v157, v174, v175
  v_mfma_f32_16x16x32_bf16 v[186:189], v[138:141], v[160:163], 0
  s_nop 0
  v_mov_b32_dpp v159, v157 row_ror:8 row_mask:0xf bank_mask:0xf
  s_nop 1
pv_144:
  v_mfma_f32_16x16x32_bf16 v[178:181], v[152:155], v[156:159], v[178:181]
  v_mfma_f32_16x16x32_bf16 v[182:185], v[144:147], v[156:159], v[182:185]
  v_mfma_f32_16x16x32_bf16 v[186:189], v[148:151], v[156:159], v[186:189]
  s_mov_b64 exec, s[62:63]
  s_nop 0
  v_rcp_f32 v164, v180
  v_cmp_ngt_f32 s[22:23], s80, v180
  v_cmp_ngt_f32 vcc, s80, v164
  v_pk_mul_f32 v[182:183], v[182:183], v[164:165] op_sel_hi:[1,0]
  v_pk_mul_f32 v[184:185], v[184:185], v[164:165] op_sel_hi:[1,0]
  v_pk_mul_f32 v[178:179], v[178:179], v[164:165] op_sel_hi:[1,0]
  v_pk_mul_f32 v[186:187], v[186:187], v[164:165] op_sel_hi:[1,0]
  v_pk_mul_f32 v[188:189], v[188:189], v[164:165] op_sel_hi:[1,0]
  v_cvt_pk_f16_f32 v64, v178, v179
  s_or_b64 vcc, vcc, s[22:23]
  s_cbranch_scc1 fx_146
fk_147:
  ds_write_b32 v14, v64
  v_cvt_pk_f16_f32 v60, v182, v183
  v_cvt_pk_f16_f32 v61, v184, v185
  v_cvt_pk_f16_f32 v62, v186, v187
  v_cvt_pk_f16_f32 v63, v188, v189
  ds_write_b128 v13, v[60:63]
  s_barrier
  s_mov_b64 exec, -1
  s_add_u32 m0, s74, 4096
  s_add_u32 s21, s79, 131072
  buffer_load_dwordx4 v4, s[16:19], s21 offen offset:1024 sc1 lds
  s_add_u32 m0, s74, 9216
  s_add_u32 s21, s72, 32768
  buffer_load_dwordx4 v32, s[16:19], s21 offen sc1 lds
  s_xor_b32 s74, s74, 16384
  s_add_u32 s73, s73, 2097152
  s_xor_b32 s73, s73, 8192
  s_add_u32 s79, s79, 2097152
  s_xor_b32 s79, s79, 8192
  s_add_u32 s21, s72, 524288
  s_xor_b32 s72, s72, s21
  s_lshr_b32 s72, s72, 8
  s_and_b32 s72, s72, 8192
  s_xor_b32 s72, s72, s21
  s_add_u32 s71, s73, 4096
  s_mov_b32 s91, 1024
  s_sub_u32 s21, s73, 0
  s_cmp_lt_u32 s21, 125829120
  s_cselect_b32 s71, s71, s79
  s_cselect_b32 s91, s91, 65536
  v_permlane32_swap_b32 v96, v100
  v_permlane32_swap_b32 v97, v101
  v_permlane32_swap_b32 v98, v102
  v_permlane32_swap_b32 v99, v103
  v_pk_add_f32 v[96:97], v[96:97], v[100:101]
  v_pk_add_f32 v[98:99], v[98:99], v[102:103]
  v_cvt_pk_bf16_f32 v100, v96, v97
  v_cvt_pk_bf16_f32 v101, v98, v99
  s_nop 0
  v_permlane32_swap_b32 v100, v102
  v_permlane32_swap_b32 v101, v103
  v_min_u32 v100, -2, v100
  s_nop 6
  buffer_store_dwordx4 v[100:103], v26, s[16:19], s70 offen sc1
  v_min_u32 v104, -2, v104
  buffer_store_dwordx4 v[104:107], v36, s[16:19], s70 offen offset:2560 sc1
  s_add_u32 s70, s70, 2097152
  s_xor_b32 s70, s70, 8192
  ds_read_b128 v[144:147], v18
  ds_read_b128 v[148:151], v18 offset:1024
  ds_read_b128 v[152:155], v19
  ds_read_b128 v[112:115], v20
  ds_read_b64 v[116:117], v21
  v_xor_b32 v18, 16384, v18
  v_xor_b32 v19, 16384, v19
  v_xor_b32 v20, 16384, v20
  v_xor_b32 v21, 16384, v21
  v_mov_b32 v88, 0
  v_mov_b32 v89, 0
  v_mov_b32 v90, 0
  v_mov_b32 v91, 0
  v_mov_b32 v92, 0
  v_mov_b32 v93, 0
  v_mov_b32 v94, 0
  v_mov_b32 v95, 0
  v_mov_b32 v96, 0
  v_mov_b32 v97, 0
  v_mov_b32 v98, 0
  v_mov_b32 v99, 0
  v_mov_b32 v100, 0
  v_mov_b32 v101, 0
  v_mov_b32 v102, 0
  v_mov_b32 v103, 0
  s_mov_b32 s81, 0
  s_waitcnt lgkmcnt(0)
  s_barrier
  s_mov_b64 exec, s[64:65]
  buffer_store_dwordx2 v[28:29], v8, s[8:11], s57 offen sc1
  s_mov_b64 exec, -1
  ds_write_b128 v190, v[28:31] offset:0
  ds_write_b128 v190, v[28:31] offset:1024
  ds_write_b64 v6, v[28:29]
  s_mov_b64 exec, s[62:63]
  buffer_store_dword v28, v17, s[8:11], s59 offen sc1
  s_mov_b64 exec, -1
  s_sleep 3
  s_nop 1
  buffer_load_dwordx4 v[68:71], v16, s[4:7], s60 offen sc1
  s_sleep 3
  s_nop 1
  buffer_load_dwordx4 v[72:75], v16, s[4:7], s60 offen sc1
  s_waitcnt vmcnt(1)
  v_mfma_f32_16x16x32_f16 v[120:123], v[44:47], v[68:71], 0
  v_bitop3_b32 v27, v68, s61, 1 bitop3:0x28
  v_cmp_ne_u32 vcc, 0, v27
  s_nop 1
  s_cbranch_vccnz p2_152
  s_nop 2
pg_151:
  v_add_f32_dpp v120, v120, v120 row_ror:8 row_mask:0xf bank_mask:0xf
  v_add_f32_dpp v121, v121, v121 row_ror:8 row_mask:0xf bank_mask:0xf
  s_mov_b64 exec, s[62:63]
  v_cvt_pk_bf16_f32 v120, v120, v121
  v_min_u32 v120, -2, v120
  buffer_store_dword v120, v17, s[8:11], s55 offen sc1
  s_mov_b64 exec, -1
nt_148:
  s_barrier
  s_mov_b32 s58, s55
  s_add_u32 s52, s52, 1
  ds_write_b32 v13, v28
  ds_write_b32 v14, v28
  s_and_b32 s21, s52, 3
  s_mul_i32 s56, s21, 122880
  s_add_u32 s21, s52, 1
  s_and_b32 s21, s21, 3
  s_mul_i32 s55, s21, 122880
  s_add_u32 s55, s55, s75
  s_add_u32 s21, s52, 2
  s_and_b32 s21, s21, 3
  s_mul_i32 s57, s21, 122880
  s_add_u32 s21, s52, 3
  s_and_b32 s21, s21, 3
  s_mul_i32 s59, s21, 122880
  s_add_u32 s59, s59, s75
  s_bfe_u32 s61, s52, 0x10002
  s_and_b32 s21, s52, 3
  s_lshl_b32 s60, s21, 18
  s_mov_b32 s54, 0
  s_sleep 2
  s_nop 10
  s_waitcnt lgkmcnt(0)
  buffer_load_dwordx4 v[48:51], v190, s[8:11], s58 offen offset:0 sc1
  buffer_load_dwordx4 v[52:55], v190, s[8:11], s58 offen offset:1024 sc1
  s_branch top_135
mr_136:
  s_mov_b64 exec, s[22:23]
  s_cbranch_execz ms_153
  buffer_load_dwordx4 v[48:51], v190, s[8:11], s58 offen offset:0 sc1
ms_153:
  s_mov_b64 exec, s[98:99]
  s_cbranch_execz ms_154
  buffer_load_dwordx4 v[52:55], v190, s[8:11], s58 offen offset:1024 sc1
ms_154:
  s_add_u32 s54, s54, 1
  s_cmp_gt_u32 s54, 131072
  s_cbranch_scc1 end0
  s_waitcnt vmcnt(0)
  s_mov_b64 exec, s[22:23]
  ds_write_b128 v190, v[48:51] offset:0
  v_cmp_eq_u32 s[22:23], -1, v48
  s_mov_b64 exec, s[98:99]
  ds_write_b128 v190, v[52:55] offset:1024
  v_cmp_eq_u32 s[98:99], -1, v52
  s_mov_b64 exec, -1
  s_or_b64 vcc, s[22:23], s[98:99]
  s_cbranch_scc1 mr_136
  s_branch mo_140
sf_141:
  s_waitcnt lgkmcnt(1)
  v_mfma_f32_16x16x32_bf16 v[120:123], v[112:115], v[104:107], 0
  s_waitcnt lgkmcnt(0)
  v_mfma_f32_16x16x32_bf16 v[120:123], v[116:119], v[108:111], v[120:123]
  s_mov_b64 exec, s[64:65]
  s_nop 6
  v_cvt_pk_f16_f32 v120, v120, v121
  v_cvt_pk_f16_f32 v121, v122, v123
  buffer_store_dwordx2 v[120:121], v8, s[8:11], s56 offen sc1
  s_mov_b64 exec, -1
  s_branch sf_142
mn_137:
  s_bitcmp1_b32 s81, 1
  s_cbranch_scc1 mk_138
  s_or_b32 s81, s81, 2
  s_nop 7
  v_mov_b32 v88, 0
  v_mov_b32 v89, 0
  v_mov_b32 v90, 0
  v_mov_b32 v91, 0
  v_mov_b32 v92, 0
  v_mov_b32 v93, 0
  v_mov_b32 v94, 0
  v_mov_b32 v95, 0
  v_mov_b32 v96, 0
  v_mov_b32 v97, 0
  v_mov_b32 v98, 0
  v_mov_b32 v99, 0
  v_mov_b32 v100, 0
  v_mov_b32 v101, 0
  v_mov_b32 v102, 0
  v_mov_b32 v103, 0
  s_cmp_eq_u32 s52, 0
  s_cbranch_scc1 mx_156
mx_155:
  buffer_load_dwordx4 v[48:51], v190, s[8:11], s58 offen offset:0 sc1
  buffer_load_dwordx4 v[52:55], v190, s[8:11], s58 offen offset:1024 sc1
  s_add_u32 s54, s54, 1
  s_cmp_gt_u32 s54, 131072
  s_cbranch_scc1 end0
  s_waitcnt vmcnt(0)
  v_max3_u32 v27, v48, v49, v50
  v_max3_u32 v27, v27, v51, v52
  v_max3_u32 v27, v27, v53, v54
  v_max3_u32 v27, v27, v55, v55
  v_cmp_eq_u32 vcc, -1, v27
  s_nop 1
  s_cbranch_vccnz mx_155
  ds_write_b128 v190, v[48:51] offset:0
  ds_write_b128 v190, v[52:55] offset:1024
mx_156:
  s_waitcnt lgkmcnt(0)
  s_branch mo_140
sr_143:
  s_mov_b32 s54, 0
sr_157:
  s_mov_b64 exec, vcc
  buffer_load_dwordx4 v[124:127], v9, s[8:11], s56 offen sc1
  buffer_load_dwordx4 v[128:131], v9, s[8:11], s56 offen offset:1024 sc1
  buffer_load_dwordx4 v[132:135], v10, s[8:11], s56 offen sc1
  s_mov_b64 exec, -1
  s_add_u32 s54, s54, 1
  s_cmp_gt_u32 s54, 131072
  s_cbranch_scc1 end0
  s_waitcnt vmcnt(0)
  v_pk_add_f16 v164, v132, v133
  v_pk_add_f16 v165, v134, v135
  v_pk_add_f16 v120, v124, v126
  v_pk_add_f16 v122, v128, v130
  v_fma_mix_f32 v170, v164, 1.0, v165 op_sel:[0,0,0] op_sel_hi:[1,0,1]
  v_fma_mix_f32 v166, v120, 1.0, v122 op_sel:[0,0,0] op_sel_hi:[1,0,1]
  v_pk_add_f16 v121, v125, v127
  v_cmp_u_f32 vcc, v166, v170
  v_pk_add_f16 v123, v129, v131
  v_fma_mix_f32 v171, v164, 1.0, v165 op_sel:[1,0,1] op_sel_hi:[1,0,1]
  v_fma_mix_f32 v167, v120, 1.0, v122 op_sel:[1,0,1] op_sel_hi:[1,0,1]
  v_fma_mix_f32 v168, v121, 1.0, v123 op_sel:[0,0,0] op_sel_hi:[1,0,1]
  v_fma_mix_f32 v169, v121, 1.0, v123 op_sel:[1,0,1] op_sel_hi:[1,0,1]
  s_cbranch_vccz ex_145
  s_and_b32 s21, s54, 31
  s_cbranch_scc1 sr_157
  v_max3_u32 v27, v124, v126, v128
  v_max3_u32 v27, v27, v130, v132
  v_max3_u32 v27, v27, v133, v134
  v_max3_u32 v27, v27, v135, v135
  v_cmp_eq_u32 vcc, -1, v27
  s_nop 1
  s_cbranch_vccnz sr_157
ex_145:
  v_exp_f32 v176, v170
  v_exp_f32 v177, v171
  v_exp_f32 v172, v166
  v_cvt_pk_bf16_f32 v160, v176, v177
  v_exp_f32 v173, v167
  v_exp_f32 v174, v168
  v_mov_b32_dpp v161, v160 row_ror:8 row_mask:0xf bank_mask:0xf
  v_cvt_pk_bf16_f32 v156, v172, v173
  v_exp_f32 v175, v169
  v_mfma_f32_16x16x32_bf16 v[178:181], v[140:143], v[160:163], 0
  v_mov_b32_dpp v158, v156 row_ror:8 row_mask:0xf bank_mask:0xf
  v_cvt_pk_bf16_f32 v157, v174, v175
  v_mfma_f32_16x16x32_bf16 v[182:185], v[136:139], v[160:163], 0
  s_nop 0
  v_mov_b32_dpp v159, v157 row_ror:8 row_mask:0xf bank_mask:0xf
  v_mfma_f32_16x16x32_bf16 v[186:189], v[138:141], v[160:163], 0
  s_branch pv_144
fx_146:
  s_bitcmp1_b32 s81, 0
  s_cbranch_scc1 fk_147
  s_or_b32 s81, s81, 1
  s_mov_b64 exec, -1
  v_max3_f32 v164, v166, v167, v168
  v_max3_f32 v165, v169, v170, v171
  v_max_f32 v164, v164, v165
  s_nop 1
  v_max_f32_dpp v164, v164, v164 row_ror:8 row_mask:0xf bank_mask:0xf
  v_mov_b32 v165, v164
  s_nop 1
  v_permlane32_swap_b32 v164, v165
  v_max_f32 v164, v164, v165
  v_mov_b32 v165, v164
  s_nop 1
  v_permlane16_swap_b32 v164, v165
  v_max_f32 v164, v164, v165
  v_sub_f32 v166, v166, v164
  v_sub_f32 v167, v167, v164
  v_sub_f32 v168, v168, v164
  v_sub_f32 v169, v169, v164
  v_sub_f32 v170, v170, v164
  v_sub_f32 v171, v171, v164
  s_branch ex_145
p2_152:
  s_mov_b32 s54, 0
  buffer_load_dwordx4 v[68:71], v16, s[4:7], s60 offen sc1
  s_waitcnt vmcnt(1)
  v_mfma_f32_16x16x32_f16 v[120:123], v[44:47], v[72:75], 0
  v_bitop3_b32 v27, v72, s61, 1 bitop3:0x28
  v_cmp_ne_u32 vcc, 0, v27
  s_nop 1
  s_cbranch_vccz pg_151
  buffer_load_dwordx4 v[72:75], v16, s[4:7], s60 offen sc1
pp_150:
  s_waitcnt vmcnt(1)
  v_mfma_f32_16x16x32_f16 v[120:123], v[44:47], v[68:71], 0
  v_bitop3_b32 v27, v68, s61, 1 bitop3:0x28
  v_cmp_ne_u32 vcc, 0, v27
  s_nop 1
  s_cbranch_vccz pg_151
  buffer_load_dwordx4 v[68:71], v16, s[4:7], s60 offen sc1
  s_waitcnt vmcnt(1)
  v_mfma_f32_16x16x32_f16 v[120:123], v[44:47], v[72:75], 0
  v_bitop3_b32 v27, v72, s61, 1 bitop3:0x28
  v_cmp_ne_u32 vcc, 0, v27
  s_nop 1
  s_cbranch_vccz pg_151
  buffer_load_dwordx4 v[72:75], v16, s[4:7], s60 offen sc1
  s_add_u32 s54, s54, 1
  s_cmp_gt_u32 s54, 131072
  s_cbranch_scc1 end0
  s_branch pp_150
last_139:
  v_min_u32 v104, -2, v104
  buffer_store_dwordx4 v[104:107], v36, s[16:19], s70 offen offset:2560 sc1
  v_smfmac_f32_16x16x64_bf16 v[96:99], v[48:51], a[0:7], v22
  v_smfmac_f32_16x16x64_bf16 v[100:103], v[48:51], a[80:87], v22
  v_smfmac_f32_16x16x64_bf16 v[96:99], v[52:55], a[8:15], v22
  v_smfmac_f32_16x16x64_bf16 v[100:103], v[52:55], a[88:95], v22
  v_smfmac_f32_16x16x64_bf16 v[96:99], v[56:59], a[16:23], v22
  v_smfmac_f32_16x16x64_bf16 v[100:103], v[56:59], a[96:103], v22
  v_smfmac_f32_16x16x64_bf16 v[96:99], v[60:63], a[24:31], v22
  v_smfmac_f32_16x16x64_bf16 v[96:99], v[64:67], a[32:39], v22
  v_smfmac_f32_16x16x64_bf16 v[96:99], v[68:71], a[40:47], v22
  v_smfmac_f32_16x16x64_bf16 v[96:99], v[72:75], a[48:55], v22
  v_smfmac_f32_16x16x64_bf16 v[96:99], v[76:79], a[56:63], v22
  v_smfmac_f32_16x16x64_bf16 v[96:99], v[80:83], a[64:71], v22
  v_smfmac_f32_16x16x64_bf16 v[96:99], v[84:87], a[72:79], v22
  v_smfmac_f32_16x16x64_bf16 v[100:103], v[60:63], a[104:111], v22
  v_smfmac_f32_16x16x64_bf16 v[100:103], v[64:67], a[112:119], v22
  v_smfmac_f32_16x16x64_bf16 v[100:103], v[68:71], a[120:127], v22
  v_smfmac_f32_16x16x64_bf16 v[100:103], v[72:75], a[128:135], v22
  v_smfmac_f32_16x16x64_bf16 v[100:103], v[76:79], a[136:143], v22
  v_smfmac_f32_16x16x64_bf16 v[100:103], v[80:83], a[144:151], v22
  v_smfmac_f32_16x16x64_bf16 v[100:103], v[84:87], a[152:159], v22
  s_nop 7
  v_permlane32_swap_b32 v96, v100
  v_permlane32_swap_b32 v97, v101
  v_permlane32_swap_b32 v98, v102
  v_permlane32_swap_b32 v99, v103
  v_pk_add_f32 v[96:97], v[96:97], v[100:101]
  v_pk_add_f32 v[98:99], v[98:99], v[102:103]
  v_cvt_pk_bf16_f32 v100, v96, v97
  v_cvt_pk_bf16_f32 v101, v98, v99
  s_nop 0
  v_permlane32_swap_b32 v100, v102
  v_permlane32_swap_b32 v101, v103
  v_min_u32 v100, -2, v100
  buffer_store_dwordx4 v[100:103], v26, s[16:19], s70 offen sc1
  s_waitcnt vmcnt(0)
  s_barrier
  s_branch chain_done
E_27:
  v_add_u32 v190, 2048, v4
  ds_write_b64 v6, v[28:29]
  ds_write_b32 v13, v28
  ds_write_b32 v14, v28
  s_waitcnt vmcnt(0)
  ds_write_b128 v190, v[56:59] offset:0
  ds_write_b128 v190, v[60:63] offset:1024
  ds_write_b128 v190, v[64:67] offset:2048
  s_waitcnt lgkmcnt(0)
  s_add_u32 m0, s74, 6144
  s_add_u32 s21, s79, 196608
  buffer_load_dwordx4 v4, s[16:19], s21 offen offset:1024 sc1 lds
  s_add_u32 m0, s74, 4096
  s_mul_i32 s21, s91, 2
  s_add_u32 s21, s21, s71
  buffer_load_dwordx4 v4, s[16:19], s21 offen sc1 lds
  s_xor_b32 s74, s74, 16384
  s_add_u32 s73, s73, 2097152
  s_xor_b32 s73, s73, 8192
  s_add_u32 s79, s79, 2097152
  s_xor_b32 s79, s79, 8192
  s_add_u32 s21, s72, 524288
  s_xor_b32 s72, s72, s21
  s_lshr_b32 s72, s72, 8
  s_and_b32 s72, s72, 8192
  s_xor_b32 s72, s72, s21
  s_add_u32 s71, s73, 4096
  s_mov_b32 s91, 1024
  s_sub_u32 s21, s73, 0
  s_cmp_lt_u32 s21, 125829120
  s_cselect_b32 s71, s71, s79
  s_cselect_b32 s91, s91, 65536
  s_branch mo_164
  .p2align 3
top_159:
  s_waitcnt vmcnt(2)
  ds_write_b128 v190, v[56:59] offset:0
  v_cmp_eq_u32 s[22:23], -1, v56
  s_waitcnt vmcnt(1)
  ds_write_b128 v190, v[60:63] offset:1024
  v_cmp_eq_u32 s[98:99], -1, v60
  s_waitcnt vmcnt(0)
  ds_write_b128 v190, v[64:67] offset:2048
  v_cmp_eq_u32 s[100:101], -1, v64
  s_or_b64 vcc, s[22:23], s[98:99]
  s_or_b64 vcc, vcc, s[100:101]
  s_cbranch_scc1 mr_160
mo_164:
  s_barrier
  ds_read_b128 v[48:51], v4 offset:0
  ds_read_b128 v[52:55], v4 offset:1024
  v_smfmac_f32_16x16x64_bf16 v[92:95], v[56:59], v[192:199], v22
  ds_read_b128 v[68:71], v4 offset:5120
  v_smfmac_f32_16x16x64_bf16 v[88:91], v[56:59], a[176:183], v22
  ds_read_b128 v[72:75], v4 offset:6144
  v_smfmac_f32_16x16x64_bf16 v[92:95], v[60:63], v[200:207], v22
  ds_read_b128 v[76:79], v4 offset:7168
  v_smfmac_f32_16x16x64_bf16 v[88:91], v[60:63], a[184:191], v22
  ds_read_b128 v[80:83], v4 offset:8192
  v_smfmac_f32_16x16x64_bf16 v[92:95], v[64:67], v[208:215], v22
  ds_read_b128 v[84:87], v4 offset:9216
  v_smfmac_f32_16x16x64_bf16 v[88:91], v[64:67], a[192:199], v22
  s_waitcnt lgkmcnt(6)
  v_smfmac_f32_16x16x64_bf16 v[92:95], v[48:51], a[240:247], v22
  v_smfmac_f32_16x16x64_bf16 v[88:91], v[48:51], a[160:167], v22
  s_waitcnt lgkmcnt(5)
  v_smfmac_f32_16x16x64_bf16 v[92:95], v[52:55], a[248:255], v22
  s_waitcnt lgkmcnt(4)
  v_smfmac_f32_16x16x64_bf16 v[92:95], v[68:71], v[216:223], v22
  s_waitcnt lgkmcnt(3)
  v_smfmac_f32_16x16x64_bf16 v[92:95], v[72:75], v[224:231], v22
  s_waitcnt lgkmcnt(2)
  v_smfmac_f32_16x16x64_bf16 v[92:95], v[76:79], v[232:239], v22
  s_waitcnt lgkmcnt(1)
  v_smfmac_f32_16x16x64_bf16 v[92:95], v[80:83], v[240:247], v22
  s_waitcnt lgkmcnt(0)
  v_smfmac_f32_16x16x64_bf16 v[92:95], v[84:87], v[248:255], v22
  v_smfmac_f32_16x16x64_bf16 v[88:91], v[52:55], a[168:175], v22
  v_smfmac_f32_16x16x64_bf16 v[88:91], v[68:71], a[200:207], v22
  v_smfmac_f32_16x16x64_bf16 v[88:91], v[72:75], a[208:215], v22
  v_permlane32_swap_b32 v92, v93
  v_smfmac_f32_16x16x64_bf16 v[88:91], v[76:79], a[216:223], v22
  v_permlane32_swap_b32 v94, v95
  v_smfmac_f32_16x16x64_bf16 v[88:91], v[80:83], a[224:231], v22
  v_permlane32_swap_b32 v93, v92
  v_smfmac_f32_16x16x64_bf16 v[88:91], v[84:87], a[232:239], v22
  v_permlane32_swap_b32 v95, v94
  v_pk_mul_f32 v[120:121], v[92:93], v[24:25] op_sel:[1,0] op_sel_hi:[0,1]
  v_pk_mul_f32 v[122:123], v[94:95], v[24:25] op_sel:[1,0] op_sel_hi:[0,1]
  s_nop 4
  v_pk_fma_f32 v[88:89], v[88:89], v[24:25], v[120:121]
  v_pk_fma_f32 v[90:91], v[90:91], v[24:25], v[122:123]
  v_cvt_pk_bf16_f32 v120, v88, v89
  v_cvt_pk_bf16_f32 v121, v90, v91
  ds_write_b64 v6, v[120:121]
  s_barrier
  ds_read_b64_tr_b16 v[104:105], v7 offset:0
  ds_read_b64_tr_b16 v[106:107], v7 offset:768
  ds_read_b64_tr_b16 v[108:109], v7 offset:1536
  s_waitcnt lgkmcnt(1)
  v_mfma_f32_16x16x32_bf16 v[120:123], v[112:115], v[104:107], 0
  s_waitcnt lgkmcnt(0)
  v_mfma_f32_16x16x32_bf16 v[120:123], v[116:119], v[108:111], v[120:123]
  s_mov_b64 exec, s[64:65]
  s_nop 6
  v_cmpx_o_f32 vcc, v120, v121
  v_cvt_pk_f16_f32 v120, v120, v121
  v_cvt_pk_f16_f32 v121, v122, v123
  buffer_store_dwordx2 v[120:121], v8, s[8:11], s56 offen sc1
  s_xor_b64 s[98:99], exec, s[64:65]
  s_mov_b64 exec, -1
  s_waitcnt lgkmcnt(0)
  s_barrier
  ds_read_b64_tr_b16 v[104:105], v7 offset:0
  ds_read_b64_tr_b16 v[106:107], v7 offset:768
  ds_read_b64_tr_b16 v[108:109], v7 offset:1536
  ds_read_b32 v27, v12 offset:12544
  ds_read_b64 v[140:141], v11
  s_waitcnt lgkmcnt(1)
  v_cmp_u_f32 vcc, v104, v106
  v_cmp_u_f32 s[22:23], v108, v27
  s_nop 1
  s_or_b64 vcc, vcc, s[22:23]
  s_cbranch_vccnz mn_161
mk_162:
  s_cmp_eq_u32 s52, 63
  s_cbranch_scc1 last_163
  s_cmp_lg_u64 s[98:99], 0
  s_cbranch_scc1 sf_165
sf_166:
  s_nop 15
  s_nop 10
  v_smfmac_f32_16x16x64_bf16 v[96:99], v[48:51], a[0:7], v22
  v_smfmac_f32_16x16x64_bf16 v[100:103], v[48:51], a[80:87], v22
  v_smfmac_f32_16x16x64_bf16 v[96:99], v[52:55], a[8:15], v22
  v_smfmac_f32_16x16x64_bf16 v[100:103], v[52:55], a[88:95], v22
  v_smfmac_f32_16x16x64_bf16 v[96:99], v[56:59], a[16:23], v22
  v_smfmac_f32_16x16x64_bf16 v[100:103], v[56:59], a[96:103], v22
  buffer_load_dwordx4 v[132:135], v10, s[8:11], s56 offen sc1
  v_smfmac_f32_16x16x64_bf16 v[96:99], v[60:63], a[24:31], v22
  buffer_load_dwordx4 v[124:127], v9, s[8:11], s56 offen sc1
  v_smfmac_f32_16x16x64_bf16 v[96:99], v[64:67], a[32:39], v22
  buffer_load_dwordx4 v[128:131], v9, s[8:11], s56 offen offset:1024 sc1
  v_smfmac_f32_16x16x64_bf16 v[96:99], v[68:71], a[40:47], v22
  v_smfmac_f32_16x16x64_bf16 v[96:99], v[72:75], a[48:55], v22
  v_smfmac_f32_16x16x64_bf16 v[96:99], v[76:79], a[56:63], v22
  v_smfmac_f32_16x16x64_bf16 v[96:99], v[80:83], a[64:71], v22
  v_smfmac_f32_16x16x64_bf16 v[96:99], v[84:87], a[72:79], v22
  v_smfmac_f32_16x16x64_bf16 v[100:103], v[60:63], a[104:111], v22
  v_smfmac_f32_16x16x64_bf16 v[100:103], v[64:67], a[112:119], v22
  v_smfmac_f32_16x16x64_bf16 v[100:103], v[68:71], a[120:127], v22
  v_smfmac_f32_16x16x64_bf16 v[100:103], v[72:75], a[128:135], v22
  v_cvt_pk_bf16_f32 v136, v96, v97
  v_smfmac_f32_16x16x64_bf16 v[100:103], v[76:79], a[136:143], v22
  v_cvt_pk_bf16_f32 v137, v98, v99
  v_smfmac_f32_16x16x64_bf16 v[100:103], v[80:83], a[144:151], v22
  v_smfmac_f32_16x16x64_bf16 v[100:103], v[84:87], a[152:159], v22
  s_nop 7
  v_cvt_pk_bf16_f32 v138, v100, v101
  v_cvt_pk_bf16_f32 v139, v102, v103
  s_waitcnt vmcnt(2) lgkmcnt(0)
  v_pk_add_f16 v164, v132, v133
  v_pk_add_f16 v165, v134, v135
  v_fma_mix_f32 v170, v164, 1.0, v165 op_sel:[0,0,0] op_sel_hi:[1,0,1]
  v_fma_mix_f32 v171, v164, 1.0, v165 op_sel:[1,0,1] op_sel_hi:[1,0,1]
  v_exp_f32 v176, v170
  v_exp_f32 v177, v171
  s_waitcnt vmcnt(1)
  v_cvt_pk_bf16_f32 v160, v176, v177
  v_pk_add_f16 v120, v124, v126
  v_pk_add_f16 v121, v125, v127
  v_mov_b32_dpp v161, v160 row_ror:8 row_mask:0xf bank_mask:0xf
  s_waitcnt vmcnt(0)
  v_pk_add_f16 v122, v128, v130
  v_mfma_f32_16x16x32_bf16 v[178:181], v[140:143], v[160:163], 0
  v_fma_mix_f32 v166, v120, 1.0, v122 op_sel:[0,0,0] op_sel_hi:[1,0,1]
  v_fma_mix_f32 v167, v120, 1.0, v122 op_sel:[1,0,1] op_sel_hi:[1,0,1]
  v_cmp_u_f32 vcc, v166, v170
  v_pk_add_f16 v123, v129, v131
  v_exp_f32 v172, v166
  v_mfma_f32_16x16x32_bf16 v[182:185], v[136:139], v[160:163], 0
  s_cbranch_vccnz sr_167
  v_exp_f32 v173, v167
  v_fma_mix_f32 v168, v121, 1.0, v123 op_sel:[0,0,0] op_sel_hi:[1,0,1]
  v_fma_mix_f32 v169, v121, 1.0, v123 op_sel:[1,0,1] op_sel_hi:[1,0,1]
  v_cvt_pk_bf16_f32 v156, v172, v173
  v_exp_f32 v174, v168
  v_exp_f32 v175, v169
  v_mov_b32_dpp v158, v156 row_ror:8 row_mask:0xf bank_mask:0xf
  v_cvt_pk_bf16_f32 v157, v174, v175
  v_mfma_f32_16x16x32_bf16 v[186:189], v[138:141], v[160:163], 0
  s_nop 0
  v_mov_b32_dpp v159, v157 row_ror:8 row_mask:0xf bank_mask:0xf
  s_nop 1
pv_168:
  v_mfma_f32_16x16x32_bf16 v[178:181], v[152:155], v[156:159], v[178:181]
  v_mfma_f32_16x16x32_bf16 v[182:185], v[144:147], v[156:159], v[182:185]
  v_mfma_f32_16x16x32_bf16 v[186:189], v[148:151], v[156:159], v[186:189]
  s_mov_b64 exec, s[62:63]
  s_nop 0
  v_rcp_f32 v164, v180
  v_cmp_ngt_f32 s[22:23], s80, v180
  v_cmp_ngt_f32 vcc, s80, v164
  v_pk_mul_f32 v[182:183], v[182:183], v[164:165] op_sel_hi:[1,0]
  v_pk_mul_f32 v[184:185], v[184:185], v[164:165] op_sel_hi:[1,0]
  v_pk_mul_f32 v[178:179], v[178:179], v[164:165] op_sel_hi:[1,0]
  v_pk_mul_f32 v[186:187], v[186:187], v[164:165] op_sel_hi:[1,0]
  v_pk_mul_f32 v[188:189], v[188:189], v[164:165] op_sel_hi:[1,0]
  v_cvt_pk_f16_f32 v64, v178, v179
  s_or_b64 vcc, vcc, s[22:23]
  s_cbranch_scc1 fx_170
fk_171:
  ds_write_b32 v14, v64
  v_cvt_pk_f16_f32 v60, v182, v183
  v_cvt_pk_f16_f32 v61, v184, v185
  v_cvt_pk_f16_f32 v62, v186, v187
  v_cvt_pk_f16_f32 v63, v188, v189
  ds_write_b128 v13, v[60:63]
  s_barrier
  s_mov_b64 exec, -1
  s_add_u32 m0, s74, 6144
  s_add_u32 s21, s79, 196608
  buffer_load_dwordx4 v4, s[16:19], s21 offen offset:1024 sc1 lds
  s_add_u32 m0, s74, 4096
  s_mul_i32 s21, s91, 2
  s_add_u32 s21, s21, s71
  buffer_load_dwordx4 v4, s[16:19], s21 offen sc1 lds
  s_xor_b32 s74, s74, 16384
  s_add_u32 s73, s73, 2097152
  s_xor_b32 s73, s73, 8192
  s_add_u32 s79, s79, 2097152
  s_xor_b32 s79, s79, 8192
  s_add_u32 s21, s72, 524288
  s_xor_b32 s72, s72, s21
  s_lshr_b32 s72, s72, 8
  s_and_b32 s72, s72, 8192
  s_xor_b32 s72, s72, s21
  s_add_u32 s71, s73, 4096
  s_mov_b32 s91, 1024
  s_sub_u32 s21, s73, 0
  s_cmp_lt_u32 s21, 125829120
  s_cselect_b32 s71, s71, s79
  s_cselect_b32 s91, s91, 65536
  v_permlane32_swap_b32 v96, v100
  v_permlane32_swap_b32 v97, v101
  v_permlane32_swap_b32 v98, v102
  v_permlane32_swap_b32 v99, v103
  v_pk_add_f32 v[96:97], v[96:97], v[100:101]
  v_pk_add_f32 v[98:99], v[98:99], v[102:103]
  v_cvt_pk_bf16_f32 v100, v96, v97
  v_cvt_pk_bf16_f32 v101, v98, v99
  s_nop 0
  v_permlane32_swap_b32 v100, v102
  v_permlane32_swap_b32 v101, v103
  v_min_u32 v100, -2, v100
  s_nop 6
  buffer_store_dwordx4 v[100:103], v26, s[16:19], s70 offen sc1
  v_min_u32 v108, -2, v108
  buffer_store_dwordx2 v[108:109], v37, s[16:19], s70 offen offset:3072 sc1
  s_add_u32 s70, s70, 2097152
  s_xor_b32 s70, s70, 8192
  ds_read_b128 v[144:147], v18
  ds_read_b128 v[148:151], v18 offset:1024
  ds_read_b128 v[152:155], v19
  ds_read_b128 v[112:115], v20
  ds_read_b64 v[116:117], v21
  v_xor_b32 v18, 16384, v18
  v_xor_b32 v19, 16384, v19
  v_xor_b32 v20, 16384, v20
  v_xor_b32 v21, 16384, v21
  v_mov_b32 v88, 0
  v_mov_b32 v89, 0
  v_mov_b32 v90, 0
  v_mov_b32 v91, 0
  v_mov_b32 v92, 0
  v_mov_b32 v93, 0
  v_mov_b32 v94, 0
  v_mov_b32 v95, 0
  v_mov_b32 v96, 0
  v_mov_b32 v97, 0
  v_mov_b32 v98, 0
  v_mov_b32 v99, 0
  v_mov_b32 v100, 0
  v_mov_b32 v101, 0
  v_mov_b32 v102, 0
  v_mov_b32 v103, 0
  s_mov_b32 s81, 0
  s_waitcnt lgkmcnt(0)
  s_barrier
  s_mov_b64 exec, s[64:65]
  buffer_store_dwordx2 v[28:29], v8, s[8:11], s57 offen sc1
  s_mov_b64 exec, -1
  ds_write_b128 v190, v[28:31] offset:0
  ds_write_b128 v190, v[28:31] offset:1024
  ds_write_b128 v190, v[28:31] offset:2048
  ds_write_b64 v6, v[28:29]
  s_mov_b64 exec, s[62:63]
  buffer_store_dword v28, v17, s[8:11], s59 offen sc1
  s_mov_b64 exec, -1
  s_sleep 3
  s_nop 1
  buffer_load_dwordx4 v[68:71], v16, s[4:7], s60 offen sc1
  s_sleep 3
  s_nop 1
  buffer_load_dwordx4 v[72:75], v16, s[4:7], s60 offen sc1
  s_waitcnt vmcnt(1)
  v_mfma_f32_16x16x32_f16 v[120:123], v[44:47], v[68:71], 0
  v_bitop3_b32 v27, v68, s61, 1 bitop3:0x28
  v_cmp_ne_u32 vcc, 0, v27
  s_nop 1
  s_cbranch_vccnz p2_176
  s_nop 2
pg_175:
  v_add_f32_dpp v120, v120, v120 row_ror:8 row_mask:0xf bank_mask:0xf
  v_add_f32_dpp v121, v121, v121 row_ror:8 row_mask:0xf bank_mask:0xf
  s_mov_b64 exec, s[62:63]
  v_cvt_pk_bf16_f32 v120, v120, v121
  v_min_u32 v120, -2, v120
  buffer_store_dword v120, v17, s[8:11], s55 offen sc1
  s_mov_b64 exec, -1
nt_172:
  s_barrier
  s_mov_b32 s58, s55
  s_add_u32 s52, s52, 1
  ds_write_b32 v13, v28
  ds_write_b32 v14, v28
  s_and_b32 s21, s52, 3
  s_mul_i32 s56, s21, 122880
  s_add_u32 s21, s52, 1
  s_and_b32 s21, s21, 3
  s_mul_i32 s55, s21, 122880
  s_add_u32 s55, s55, s75
  s_add_u32 s21, s52, 2
  s_and_b32 s21, s21, 3
  s_mul_i32 s57, s21, 122880
  s_add_u32 s21, s52, 3
  s_and_b32 s21, s21, 3
  s_mul_i32 s59, s21, 122880
  s_add_u32 s59, s59, s75
  s_bfe_u32 s61, s52, 0x10002
  s_and_b32 s21, s52, 3
  s_lshl_b32 s60, s21, 18
  s_mov_b32 s54, 0
  s_sleep 2
  s_nop 10
  s_waitcnt lgkmcnt(0)
  buffer_load_dwordx4 v[56:59], v190, s[8:11], s58 offen offset:0 sc1
  buffer_load_dwordx4 v[60:63], v190, s[8:11], s58 offen offset:1024 sc1
  buffer_load_dwordx4 v[64:67], v190, s[8:11], s58 offen offset:2048 sc1
  s_branch top_159
mr_160:
  s_mov_b64 exec, s[22:23]
  s_cbranch_execz ms_177
  buffer_load_dwordx4 v[56:59], v190, s[8:11], s58 offen offset:0 sc1
ms_177:
  s_mov_b64 exec, s[98:99]
  s_cbranch_execz ms_178
  buffer_load_dwordx4 v[60:63], v190, s[8:11], s58 offen offset:1024 sc1
ms_178:
  s_mov_b64 exec, s[100:101]
  s_cbranch_execz ms_179
  buffer_load_dwordx4 v[64:67], v190, s[8:11], s58 offen offset:2048 sc1
ms_179:
  s_add_u32 s54, s54, 1
  s_cmp_gt_u32 s54, 131072
  s_cbranch_scc1 end0
  s_waitcnt vmcnt(0)
  s_mov_b64 exec, s[22:23]
  ds_write_b128 v190, v[56:59] offset:0
  v_cmp_eq_u32 s[22:23], -1, v56
  s_mov_b64 exec, s[98:99]
  ds_write_b128 v190, v[60:63] offset:1024
  v_cmp_eq_u32 s[98:99], -1, v60
  s_mov_b64 exec, s[100:101]
  ds_write_b128 v190, v[64:67] offset:2048
  v_cmp_eq_u32 s[100:101], -1, v64
  s_mov_b64 exec, -1
  s_or_b64 vcc, s[22:23], s[98:99]
  s_or_b64 vcc, vcc, s[100:101]
  s_cbranch_scc1 mr_160
  s_branch mo_164
sf_165:
  s_waitcnt lgkmcnt(1)
  v_mfma_f32_16x16x32_bf16 v[120:123], v[112:115], v[104:107], 0
  s_waitcnt lgkmcnt(0)
  v_mfma_f32_16x16x32_bf16 v[120:123], v[116:119], v[108:111], v[120:123]
  s_mov_b64 exec, s[64:65]
  s_nop 6
  v_cvt_pk_f16_f32 v120, v120, v121
  v_cvt_pk_f16_f32 v121, v122, v123
  buffer_store_dwordx2 v[120:121], v8, s[8:11], s56 offen sc1
  s_mov_b64 exec, -1
  s_branch sf_166
mn_161:
  s_bitcmp1_b32 s81, 1
  s_cbranch_scc1 mk_162
  s_or_b32 s81, s81, 2
  s_nop 7
  v_mov_b32 v88, 0
  v_mov_b32 v89, 0
  v_mov_b32 v90, 0
  v_mov_b32 v91, 0
  v_mov_b32 v92, 0
  v_mov_b32 v93, 0
  v_mov_b32 v94, 0
  v_mov_b32 v95, 0
  v_mov_b32 v96, 0
  v_mov_b32 v97, 0
  v_mov_b32 v98, 0
  v_mov_b32 v99, 0
  v_mov_b32 v100, 0
  v_mov_b32 v101, 0
  v_mov_b32 v102, 0
  v_mov_b32 v103, 0
  s_cmp_eq_u32 s52, 0
  s_cbranch_scc1 mx_181
mx_180:
  buffer_load_dwordx4 v[56:59], v190, s[8:11], s58 offen offset:0 sc1
  buffer_load_dwordx4 v[60:63], v190, s[8:11], s58 offen offset:1024 sc1
  buffer_load_dwordx4 v[64:67], v190, s[8:11], s58 offen offset:2048 sc1
  s_add_u32 s54, s54, 1
  s_cmp_gt_u32 s54, 131072
  s_cbranch_scc1 end0
  s_waitcnt vmcnt(0)
  v_max3_u32 v27, v56, v57, v58
  v_max3_u32 v27, v27, v59, v60
  v_max3_u32 v27, v27, v61, v62
  v_max3_u32 v27, v27, v63, v64
  v_max3_u32 v27, v27, v65, v66
  v_max3_u32 v27, v27, v67, v67
  v_cmp_eq_u32 vcc, -1, v27
  s_nop 1
  s_cbranch_vccnz mx_180
  ds_write_b128 v190, v[56:59] offset:0
  ds_write_b128 v190, v[60:63] offset:1024
  ds_write_b128 v190, v[64:67] offset:2048
mx_181:
  s_waitcnt lgkmcnt(0)
  s_branch mo_164
sr_167:
  s_mov_b32 s54, 0
sr_182:
  s_mov_b64 exec, vcc
  buffer_load_dwordx4 v[124:127], v9, s[8:11], s56 offen sc1
  buffer_load_dwordx4 v[128:131], v9, s[8:11], s56 offen offset:1024 sc1
  buffer_load_dwordx4 v[132:135], v10, s[8:11], s56 offen sc1
  s_mov_b64 exec, -1
  s_add_u32 s54, s54, 1
  s_cmp_gt_u32 s54, 131072
  s_cbranch_scc1 end0
  s_waitcnt vmcnt(0)
  v_pk_add_f16 v164, v132, v133
  v_pk_add_f16 v165, v134, v135
  v_pk_add_f16 v120, v124, v126
  v_pk_add_f16 v122, v128, v130
  v_fma_mix_f32 v170, v164, 1.0, v165 op_sel:[0,0,0] op_sel_hi:[1,0,1]
  v_fma_mix_f32 v166, v120, 1.0, v122 op_sel:[0,0,0] op_sel_hi:[1,0,1]
  v_pk_add_f16 v121, v125, v127
  v_cmp_u_f32 vcc, v166, v170
  v_pk_add_f16 v123, v129, v131
  v_fma_mix_f32 v171, v164, 1.0, v165 op_sel:[1,0,1] op_sel_hi:[1,0,1]
  v_fma_mix_f32 v167, v120, 1.0, v122 op_sel:[1,0,1] op_sel_hi:[1,0,1]
  v_fma_mix_f32 v168, v121, 1.0, v123 op_sel:[0,0,0] op_sel_hi:[1,0,1]
  v_fma_mix_f32 v169, v121, 1.0, v123 op_sel:[1,0,1] op_sel_hi:[1,0,1]
  s_cbranch_vccz ex_169
  s_and_b32 s21, s54, 31
  s_cbranch_scc1 sr_182
  v_max3_u32 v27, v124, v126, v128
  v_max3_u32 v27, v27, v130, v132
  v_max3_u32 v27, v27, v133, v134
  v_max3_u32 v27, v27, v135, v135
  v_cmp_eq_u32 vcc, -1, v27
  s_nop 1
  s_cbranch_vccnz sr_182
ex_169:
  v_exp_f32 v176, v170
  v_exp_f32 v177, v171
  v_exp_f32 v172, v166
  v_cvt_pk_bf16_f32 v160, v176, v177
  v_exp_f32 v173, v167
  v_exp_f32 v174, v168
  v_mov_b32_dpp v161, v160 row_ror:8 row_mask:0xf bank_mask:0xf
  v_cvt_pk_bf16_f32 v156, v172, v173
  v_exp_f32 v175, v169
  v_mfma_f32_16x16x32_bf16 v[178:181], v[140:143], v[160:163], 0
  v_mov_b32_dpp v158, v156 row_ror:8 row_mask:0xf bank_mask:0xf
  v_cvt_pk_bf16_f32 v157, v174, v175
  v_mfma_f32_16x16x32_bf16 v[182:185], v[136:139], v[160:163], 0
  s_nop 0
  v_mov_b32_dpp v159, v157 row_ror:8 row_mask:0xf bank_mask:0xf
  v_mfma_f32_16x16x32_bf16 v[186:189], v[138:141], v[160:163], 0
  s_branch pv_168
fx_170:
  s_bitcmp1_b32 s81, 0
  s_cbranch_scc1 fk_171
  s_or_b32 s81, s81, 1
  s_mov_b64 exec, -1
  v_max3_f32 v164, v166, v167, v168
  v_max3_f32 v165, v169, v170, v171
  v_max_f32 v164, v164, v165
  s_nop 1
  v_max_f32_dpp v164, v164, v164 row_ror:8 row_mask:0xf bank_mask:0xf
  v_mov_b32 v165, v164
  s_nop 1
  v_permlane32_swap_b32 v164, v165
  v_max_f32 v164, v164, v165
  v_mov_b32 v165, v164
  s_nop 1
  v_permlane16_swap_b32 v164, v165
  v_max_f32 v164, v164, v165
  v_sub_f32 v166, v166, v164
  v_sub_f32 v167, v167, v164
  v_sub_f32 v168, v168, v164
  v_sub_f32 v169, v169, v164
  v_sub_f32 v170, v170, v164
  v_sub_f32 v171, v171, v164
  s_branch ex_169
p2_176:
  s_mov_b32 s54, 0
  buffer_load_dwordx4 v[68:71], v16, s[4:7], s60 offen sc1
  s_waitcnt vmcnt(1)
  v_mfma_f32_16x16x32_f16 v[120:123], v[44:47], v[72:75], 0
  v_bitop3_b32 v27, v72, s61, 1 bitop3:0x28
  v_cmp_ne_u32 vcc, 0, v27
  s_nop 1
  s_cbranch_vccz pg_175
  buffer_load_dwordx4 v[72:75], v16, s[4:7], s60 offen sc1
pp_174:
  s_waitcnt vmcnt(1)
  v_mfma_f32_16x16x32_f16 v[120:123], v[44:47], v[68:71], 0
  v_bitop3_b32 v27, v68, s61, 1 bitop3:0x28
  v_cmp_ne_u32 vcc, 0, v27
  s_nop 1
  s_cbranch_vccz pg_175
  buffer_load_dwordx4 v[68:71], v16, s[4:7], s60 offen sc1
  s_waitcnt vmcnt(1)
  v_mfma_f32_16x16x32_f16 v[120:123], v[44:47], v[72:75], 0
  v_bitop3_b32 v27, v72, s61, 1 bitop3:0x28
  v_cmp_ne_u32 vcc, 0, v27
  s_nop 1
  s_cbranch_vccz pg_175
  buffer_load_dwordx4 v[72:75], v16, s[4:7], s60 offen sc1
  s_add_u32 s54, s54, 1
  s_cmp_gt_u32 s54, 131072
  s_cbranch_scc1 end0
  s_branch pp_174
last_163:
  v_min_u32 v108, -2, v108
  buffer_store_dwordx2 v[108:109], v37, s[16:19], s70 offen offset:3072 sc1
  v_smfmac_f32_16x16x64_bf16 v[96:99], v[48:51], a[0:7], v22
  v_smfmac_f32_16x16x64_bf16 v[100:103], v[48:51], a[80:87], v22
  v_smfmac_f32_16x16x64_bf16 v[96:99], v[52:55], a[8:15], v22
  v_smfmac_f32_16x16x64_bf16 v[100:103], v[52:55], a[88:95], v22
  v_smfmac_f32_16x16x64_bf16 v[96:99], v[56:59], a[16:23], v22
  v_smfmac_f32_16x16x64_bf16 v[100:103], v[56:59], a[96:103], v22
  v_smfmac_f32_16x16x64_bf16 v[96:99], v[60:63], a[24:31], v22
  v_smfmac_f32_16x16x64_bf16 v[96:99], v[64:67], a[32:39], v22
  v_smfmac_f32_16x16x64_bf16 v[96:99], v[68:71], a[40:47], v22
  v_smfmac_f32_16x16x64_bf16 v[96:99], v[72:75], a[48:55], v22
  v_smfmac_f32_16x16x64_bf16 v[96:99], v[76:79], a[56:63], v22
  v_smfmac_f32_16x16x64_bf16 v[96:99], v[80:83], a[64:71], v22
  v_smfmac_f32_16x16x64_bf16 v[96:99], v[84:87], a[72:79], v22
  v_smfmac_f32_16x16x64_bf16 v[100:103], v[60:63], a[104:111], v22
  v_smfmac_f32_16x16x64_bf16 v[100:103], v[64:67], a[112:119], v22
  v_smfmac_f32_16x16x64_bf16 v[100:103], v[68:71], a[120:127], v22
  v_smfmac_f32_16x16x64_bf16 v[100:103], v[72:75], a[128:135], v22
  v_smfmac_f32_16x16x64_bf16 v[100:103], v[76:79], a[136:143], v22
  v_smfmac_f32_16x16x64_bf16 v[100:103], v[80:83], a[144:151], v22
  v_smfmac_f32_16x16x64_bf16 v[100:103], v[84:87], a[152:159], v22
  s_nop 7
  v_permlane32_swap_b32 v96, v100
  v_permlane32_swap_b32 v97, v101
  v_permlane32_swap_b32 v98, v102
  v_permlane32_swap_b32 v99, v103
  v_pk_add_f32 v[96:97], v[96:97], v[100:101]
  v_pk_add_f32 v[98:99], v[98:99], v[102:103]
  v_cvt_pk_bf16_f32 v100, v96, v97
  v_cvt_pk_bf16_f32 v101, v98, v99
  s_nop 0
  v_permlane32_swap_b32 v100, v102
  v_permlane32_swap_b32 v101, v103
  v_min_u32 v100, -2, v100
  buffer_store_dwordx4 v[100:103], v26, s[16:19], s70 offen sc1
  s_waitcnt vmcnt(0)
  s_barrier
  s_branch chain_done
E_29:
  v_add_u32 v190, 5120, v4
  ds_write_b64 v6, v[28:29]
  ds_write_b32 v13, v28
  ds_write_b32 v14, v28
  s_waitcnt vmcnt(0)
  ds_write_b128 v190, v[68:71] offset:0
  ds_write_b128 v190, v[72:75] offset:1024
  s_waitcnt lgkmcnt(0)
  s_add_u32 m0, s74, 8192
  s_add_u32 s21, s72, 0
  buffer_load_dwordx4 v32, s[16:19], s21 offen sc1 lds
  s_add_u32 m0, s74, 6144
  s_mul_i32 s21, s91, 3
  s_add_u32 s21, s21, s71
  buffer_load_dwordx4 v4, s[16:19], s21 offen sc1 lds
  s_xor_b32 s74, s74, 16384
  s_add_u32 s73, s73, 2097152
  s_xor_b32 s73, s73, 8192
  s_add_u32 s79, s79, 2097152
  s_xor_b32 s79, s79, 8192
  s_add_u32 s21, s72, 524288
  s_xor_b32 s72, s72, s21
  s_lshr_b32 s72, s72, 8
  s_and_b32 s72, s72, 8192
  s_xor_b32 s72, s72, s21
  s_add_u32 s71, s73, 4096
  s_mov_b32 s91, 1024
  s_sub_u32 s21, s73, 0
  s_cmp_lt_u32 s21, 125829120
  s_cselect_b32 s71, s71, s79
  s_cselect_b32 s91, s91, 65536
  s_branch mo_189
  .p2align 3
top_184:
  s_waitcnt vmcnt(1)
  ds_write_b128 v190, v[68:71] offset:0
  v_cmp_eq_u32 s[22:23], -1, v68
  s_waitcnt vmcnt(0)
  ds_write_b128 v190, v[72:75] offset:1024
  v_cmp_eq_u32 s[98:99], -1, v72
  s_or_b64 vcc, s[22:23], s[98:99]
  s_cbranch_scc1 mr_185
mo_189:
  s_barrier
  ds_read_b128 v[48:51], v4 offset:0
  ds_read_b128 v[52:55], v4 offset:1024
  v_smfmac_f32_16x16x64_bf16 v[92:95], v[68:71], v[216:223], v22
  ds_read_b128 v[56:59], v4 offset:2048
  v_smfmac_f32_16x16x64_bf16 v[88:91], v[68:71], a[200:207], v22
  ds_read_b128 v[60:63], v4 offset:3072
  v_smfmac_f32_16x16x64_bf16 v[92:95], v[72:75], v[224:231], v22
  ds_read_b128 v[64:67], v4 offset:4096
  v_smfmac_f32_16x16x64_bf16 v[88:91], v[72:75], a[208:215], v22
  s_waitcnt lgkmcnt(4)
  ds_read_b128 v[76:79], v4 offset:7168
  v_smfmac_f32_16x16x64_bf16 v[92:95], v[48:51], a[240:247], v22
  ds_read_b128 v[80:83], v4 offset:8192
  v_smfmac_f32_16x16x64_bf16 v[88:91], v[48:51], a[160:167], v22
  s_waitcnt lgkmcnt(5)
  ds_read_b128 v[84:87], v4 offset:9216
  v_smfmac_f32_16x16x64_bf16 v[92:95], v[52:55], a[248:255], v22
  v_smfmac_f32_16x16x64_bf16 v[88:91], v[52:55], a[168:175], v22
  s_waitcnt lgkmcnt(5)
  v_smfmac_f32_16x16x64_bf16 v[92:95], v[56:59], v[192:199], v22
  s_waitcnt lgkmcnt(4)
  v_smfmac_f32_16x16x64_bf16 v[92:95], v[60:63], v[200:207], v22
  s_waitcnt lgkmcnt(3)
  v_smfmac_f32_16x16x64_bf16 v[92:95], v[64:67], v[208:215], v22
  s_waitcnt lgkmcnt(2)
  v_smfmac_f32_16x16x64_bf16 v[92:95], v[76:79], v[232:239], v22
  s_waitcnt lgkmcnt(1)
  v_smfmac_f32_16x16x64_bf16 v[92:95], v[80:83], v[240:247], v22
  s_waitcnt lgkmcnt(0)
  v_smfmac_f32_16x16x64_bf16 v[92:95], v[84:87], v[248:255], v22
  v_smfmac_f32_16x16x64_bf16 v[88:91], v[56:59], a[176:183], v22
  v_smfmac_f32_16x16x64_bf16 v[88:91], v[60:63], a[184:191], v22
  v_smfmac_f32_16x16x64_bf16 v[88:91], v[64:67], a[192:199], v22
  v_permlane32_swap_b32 v92, v93
  v_smfmac_f32_16x16x64_bf16 v[88:91], v[76:79], a[216:223], v22
  v_permlane32_swap_b32 v94, v95
  v_smfmac_f32_16x16x64_bf16 v[88:91], v[80:83], a[224:231], v22
  v_permlane32_swap_b32 v93, v92
  v_smfmac_f32_16x16x64_bf16 v[88:91], v[84:87], a[232:239], v22
  v_permlane32_swap_b32 v95, v94
  v_pk_mul_f32 v[120:121], v[92:93], v[24:25] op_sel:[1,0] op_sel_hi:[0,1]
  v_pk_mul_f32 v[122:123], v[94:95], v[24:25] op_sel:[1,0] op_sel_hi:[0,1]
  s_nop 4
  v_pk_fma_f32 v[88:89], v[88:89], v[24:25], v[120:121]
  v_pk_fma_f32 v[90:91], v[90:91], v[24:25], v[122:123]
  v_cvt_pk_bf16_f32 v120, v88, v89
  v_cvt_pk_bf16_f32 v121, v90, v91
  ds_write_b64 v6, v[120:121]
  s_barrier
  ds_read_b64_tr_b16 v[104:105], v7 offset:0
  ds_read_b64_tr_b16 v[106:107], v7 offset:768
  ds_read_b64_tr_b16 v[108:109], v7 offset:1536
  s_waitcnt lgkmcnt(1)
  v_mfma_f32_16x16x32_bf16 v[120:123], v[104:107], v[104:107], 0
  s_waitcnt lgkmcnt(0)
  v_mfma_f32_16x16x32_bf16 v[120:123], v[108:111], v[108:111], v[120:123]
  s_mov_b64 exec, s[64:65]
  s_nop 6
  v_cmpx_o_f32 vcc, v120, v121
  v_cvt_pk_f16_f32 v120, v120, v121
  buffer_store_dword v120, v8, s[8:11], s56 offen sc1
  v_cmpx_o_f32 vcc, v122, v123
  v_cvt_pk_f16_f32 v121, v122, v123
  buffer_store_dword v121, v8, s[8:11], s56 offen offset:128 sc1
  s_xor_b64 s[98:99], exec, s[64:65]
  s_mov_b64 exec, -1
  s_waitcnt lgkmcnt(0)
  s_barrier
  ds_read_b64_tr_b16 v[104:105], v7 offset:0
  ds_read_b64_tr_b16 v[106:107], v7 offset:768
  ds_read_b64_tr_b16 v[108:109], v7 offset:1536
  ds_read_b32 v27, v12 offset:12544
  ds_read_b64 v[140:141], v11
  s_waitcnt lgkmcnt(1)
  v_cmp_u_f32 vcc, v104, v106
  v_cmp_u_f32 s[22:23], v108, v27
  s_nop 1
  s_or_b64 vcc, vcc, s[22:23]
  s_cbranch_vccnz mn_186
mk_187:
  s_cmp_eq_u32 s52, 63
  s_cbranch_scc1 last_188
  s_cmp_lg_u64 s[98:99], 0
  s_cbranch_scc1 sf_190
sf_191:
  s_nop 15
  s_nop 10
  v_smfmac_f32_16x16x64_bf16 v[96:99], v[48:51], a[0:7], v22
  v_smfmac_f32_16x16x64_bf16 v[100:103], v[48:51], a[80:87], v22
  v_smfmac_f32_16x16x64_bf16 v[96:99], v[52:55], a[8:15], v22
  v_smfmac_f32_16x16x64_bf16 v[100:103], v[52:55], a[88:95], v22
  v_smfmac_f32_16x16x64_bf16 v[96:99], v[56:59], a[16:23], v22
  v_smfmac_f32_16x16x64_bf16 v[100:103], v[56:59], a[96:103], v22
  buffer_load_dwordx4 v[132:135], v10, s[8:11], s56 offen sc1
  v_smfmac_f32_16x16x64_bf16 v[96:99], v[60:63], a[24:31], v22
  buffer_load_dwordx4 v[124:127], v9, s[8:11], s56 offen sc1
  v_smfmac_f32_16x16x64_bf16 v[96:99], v[64:67], a[32:39], v22
  buffer_load_dwordx4 v[128:131], v9, s[8:11], s56 offen offset:1024 sc1
  v_smfmac_f32_16x16x64_bf16 v[96:99], v[68:71], a[40:47], v22
  v_smfmac_f32_16x16x64_bf16 v[96:99], v[72:75], a[48:55], v22
  v_smfmac_f32_16x16x64_bf16 v[96:99], v[76:79], a[56:63], v22
  v_smfmac_f32_16x16x64_bf16 v[96:99], v[80:83], a[64:71], v22
  v_smfmac_f32_16x16x64_bf16 v[96:99], v[84:87], a[72:79], v22
  v_smfmac_f32_16x16x64_bf16 v[100:103], v[60:63], a[104:111], v22
  v_smfmac_f32_16x16x64_bf16 v[100:103], v[64:67], a[112:119], v22
  v_smfmac_f32_16x16x64_bf16 v[100:103], v[68:71], a[120:127], v22
  v_smfmac_f32_16x16x64_bf16 v[100:103], v[72:75], a[128:135], v22
  v_cvt_pk_bf16_f32 v136, v96, v97
  v_smfmac_f32_16x16x64_bf16 v[100:103], v[76:79], a[136:143], v22
  v_cvt_pk_bf16_f32 v137, v98, v99
  v_smfmac_f32_16x16x64_bf16 v[100:103], v[80:83], a[144:151], v22
  v_smfmac_f32_16x16x64_bf16 v[100:103], v[84:87], a[152:159], v22
  s_nop 7
  v_cvt_pk_bf16_f32 v138, v100, v101
  v_cvt_pk_bf16_f32 v139, v102, v103
  s_waitcnt vmcnt(2) lgkmcnt(0)
  v_pk_add_f16 v164, v132, v133
  v_pk_add_f16 v165, v134, v135
  v_fma_mix_f32 v170, v164, 1.0, v165 op_sel:[0,0,0] op_sel_hi:[1,0,1]
  v_fma_mix_f32 v171, v164, 1.0, v165 op_sel:[1,0,1] op_sel_hi:[1,0,1]
  v_exp_f32 v176, v170
  v_exp_f32 v177, v171
  s_waitcnt vmcnt(1)
  v_cvt_pk_bf16_f32 v160, v176, v177
  v_pk_add_f16 v120, v124, v126
  v_pk_add_f16 v121, v125, v127
  v_mov_b32_dpp v161, v160 row_ror:8 row_mask:0xf bank_mask:0xf
  s_waitcnt vmcnt(0)
  v_pk_add_f16 v122, v128, v130
  v_mfma_f32_16x16x32_bf16 v[178:181], v[140:143], v[160:163], 0
  v_fma_mix_f32 v166, v120, 1.0, v122 op_sel:[0,0,0] op_sel_hi:[1,0,1]
  v_fma_mix_f32 v167, v120, 1.0, v122 op_sel:[1,0,1] op_sel_hi:[1,0,1]
  v_cmp_u_f32 vcc, v166, v170
  v_pk_add_f16 v123, v129, v131
  v_exp_f32 v172, v166
  v_mfma_f32_16x16x32_bf16 v[182:185], v[136:139], v[160:163], 0
  s_cbranch_vccnz sr_192
  v_exp_f32 v173, v167
  v_fma_mix_f32 v168, v121, 1.0, v123 op_sel:[0,0,0] op_sel_hi:[1,0,1]
  v_fma_mix_f32 v169, v121, 1.0, v123 op_sel:[1,0,1] op_sel_hi:[1,0,1]
  v_cvt_pk_bf16_f32 v156, v172, v173
  v_exp_f32 v174, v168
  v_exp_f32 v175, v169
  v_mov_b32_dpp v158, v156 row_ror:8 row_mask:0xf bank_mask:0xf
  v_cvt_pk_bf16_f32 v157, v174, v175
  v_mfma_f32_16x16x32_bf16 v[186:189], v[138:141], v[160:163], 0
  s_nop 0
  v_mov_b32_dpp v159, v157 row_ror:8 row_mask:0xf bank_mask:0xf
  s_nop 1
pv_193:
  v_mfma_f32_16x16x32_bf16 v[178:181], v[152:155], v[156:159], v[178:181]
  v_mfma_f32_16x16x32_bf16 v[182:185], v[144:147], v[156:159], v[182:185]
  v_mfma_f32_16x16x32_bf16 v[186:189], v[148:151], v[156:159], v[186:189]
  s_mov_b64 exec, s[62:63]
  s_nop 0
  v_rcp_f32 v164, v180
  v_cmp_ngt_f32 s[22:23], s80, v180
  v_cmp_ngt_f32 vcc, s80, v164
  v_pk_mul_f32 v[182:183], v[182:183], v[164:165] op_sel_hi:[1,0]
  v_pk_mul_f32 v[184:185], v[184:185], v[164:165] op_sel_hi:[1,0]
  v_pk_mul_f32 v[178:179], v[178:179], v[164:165] op_sel_hi:[1,0]
  v_pk_mul_f32 v[186:187], v[186:187], v[164:165] op_sel_hi:[1,0]
  v_pk_mul_f32 v[188:189], v[188:189], v[164:165] op_sel_hi:[1,0]
  v_cvt_pk_f16_f32 v64, v178, v179
  s_or_b64 vcc, vcc, s[22:23]
  s_cbranch_scc1 fx_195
fk_196:
  ds_write_b32 v14, v64
  v_cvt_pk_f16_f32 v60, v182, v183
  v_cvt_pk_f16_f32 v61, v184, v185
  v_cvt_pk_f16_f32 v62, v186, v187
  v_cvt_pk_f16_f32 v63, v188, v189
  ds_write_b128 v13, v[60:63]
  s_barrier
  s_mov_b64 exec, -1
  s_and_b32 s21, s52, 3
  s_cmp_lt_u32 s52, 58
  s_cselect_b32 s21, s21, 0
  s_cmp_lg_u32 s21, 0
  s_cbranch_scc1 fs_197
  v_mov_b32 v27, s52
  s_mov_b64 exec, 1
  buffer_store_dword v27, v23, s[12:15], s77 offen sc1
  s_mov_b64 exec, -1
fs_197:
  s_add_u32 m0, s74, 8192
  s_add_u32 s21, s72, 0
  buffer_load_dwordx4 v32, s[16:19], s21 offen sc1 lds
  s_add_u32 m0, s74, 6144
  s_mul_i32 s21, s91, 3
  s_add_u32 s21, s21, s71
  buffer_load_dwordx4 v4, s[16:19], s21 offen sc1 lds
  s_xor_b32 s74, s74, 16384
  s_add_u32 s73, s73, 2097152
  s_xor_b32 s73, s73, 8192
  s_add_u32 s79, s79, 2097152
  s_xor_b32 s79, s79, 8192
  s_add_u32 s21, s72, 524288
  s_xor_b32 s72, s72, s21
  s_lshr_b32 s72, s72, 8
  s_and_b32 s72, s72, 8192
  s_xor_b32 s72, s72, s21
  s_add_u32 s71, s73, 4096
  s_mov_b32 s91, 1024
  s_sub_u32 s21, s73, 0
  s_cmp_lt_u32 s21, 125829120
  s_cselect_b32 s71, s71, s79
  s_cselect_b32 s91, s91, 65536
  v_permlane32_swap_b32 v96, v100
  v_permlane32_swap_b32 v97, v101
  v_permlane32_swap_b32 v98, v102
  v_permlane32_swap_b32 v99, v103
  v_pk_add_f32 v[96:97], v[96:97], v[100:101]
  v_pk_add_f32 v[98:99], v[98:99], v[102:103]
  v_cvt_pk_bf16_f32 v100, v96, v97
  v_cvt_pk_bf16_f32 v101, v98, v99
  s_nop 0
  v_permlane32_swap_b32 v100, v102
  v_permlane32_swap_b32 v101, v103
  v_min_u32 v100, -2, v100
  s_nop 6
  buffer_store_dwordx4 v[100:103], v26, s[16:19], s70 offen sc1
  s_add_u32 s70, s70, 2097152
  s_xor_b32 s70, s70, 8192
  ds_read_b128 v[144:147], v18
  ds_read_b128 v[148:151], v18 offset:1024
  ds_read_b128 v[152:155], v19
  v_xor_b32 v18, 16384, v18
  v_xor_b32 v19, 16384, v19
  v_mov_b32 v88, 0
  v_mov_b32 v89, 0
  v_mov_b32 v90, 0
  v_mov_b32 v91, 0
  v_mov_b32 v92, 0
  v_mov_b32 v93, 0
  v_mov_b32 v94, 0
  v_mov_b32 v95, 0
  v_mov_b32 v96, 0
  v_mov_b32 v97, 0
  v_mov_b32 v98, 0
  v_mov_b32 v99, 0
  v_mov_b32 v100, 0
  v_mov_b32 v101, 0
  v_mov_b32 v102, 0
  v_mov_b32 v103, 0
  s_mov_b32 s81, 0
  s_waitcnt lgkmcnt(0)
  s_barrier
  s_mov_b64 exec, s[64:65]
  buffer_store_dword v28, v8, s[8:11], s57 offen sc1
  buffer_store_dword v28, v8, s[8:11], s57 offen offset:128 sc1
  s_mov_b64 exec, -1
  ds_write_b128 v190, v[28:31] offset:0
  ds_write_b128 v190, v[28:31] offset:1024
  ds_write_b64 v6, v[28:29]
  s_mov_b64 exec, -1
  s_cmp_eq_u32 s78, 0
  s_cbranch_scc1 nt_199
  s_mov_b64 exec, s[62:63]
  buffer_store_dword v28, v17, s[8:11], s59 offen sc1
  s_mov_b64 exec, -1
  s_sleep 3
  s_nop 1
  buffer_load_dwordx4 v[68:71], v16, s[4:7], s60 offen sc1
  s_sleep 3
  s_nop 1
  buffer_load_dwordx4 v[72:75], v16, s[4:7], s60 offen sc1
  s_waitcnt vmcnt(1)
  v_mfma_f32_16x16x32_f16 v[120:123], v[44:47], v[68:71], 0
  v_bitop3_b32 v27, v68, s61, 1 bitop3:0x28
  v_cmp_ne_u32 vcc, 0, v27
  s_nop 1
  s_cbranch_vccnz p2_202
  s_nop 2
pg_201:
  v_add_f32_dpp v120, v120, v120 row_ror:8 row_mask:0xf bank_mask:0xf
  v_add_f32_dpp v121, v121, v121 row_ror:8 row_mask:0xf bank_mask:0xf
  s_mov_b64 exec, s[62:63]
  v_cvt_pk_bf16_f32 v120, v120, v121
  v_min_u32 v120, -2, v120
  buffer_store_dword v120, v17, s[8:11], s55 offen sc1
  s_mov_b64 exec, -1
nt_198:
  s_barrier
  s_mov_b32 s58, s55
  s_add_u32 s52, s52, 1
  ds_write_b32 v13, v28
  ds_write_b32 v14, v28
  s_and_b32 s21, s52, 3
  s_mul_i32 s56, s21, 122880
  s_add_u32 s21, s52, 1
  s_and_b32 s21, s21, 3
  s_mul_i32 s55, s21, 122880
  s_add_u32 s55, s55, s75
  s_add_u32 s21, s52, 2
  s_and_b32 s21, s21, 3
  s_mul_i32 s57, s21, 122880
  s_add_u32 s21, s52, 3
  s_and_b32 s21, s21, 3
  s_mul_i32 s59, s21, 122880
  s_add_u32 s59, s59, s75
  s_bfe_u32 s61, s52, 0x10002
  s_and_b32 s21, s52, 3
  s_lshl_b32 s60, s21, 18
  s_mov_b32 s54, 0
  s_sleep 2
  s_nop 10
  s_waitcnt lgkmcnt(0)
  buffer_load_dwordx4 v[68:71], v190, s[8:11], s58 offen offset:0 sc1
  buffer_load_dwordx4 v[72:75], v190, s[8:11], s58 offen offset:1024 sc1
  s_branch top_184
mr_185:
  s_mov_b64 exec, s[22:23]
  s_cbranch_execz ms_203
  buffer_load_dwordx4 v[68:71], v190, s[8:11], s58 offen offset:0 sc1
ms_203:
  s_mov_b64 exec, s[98:99]
  s_cbranch_execz ms_204
  buffer_load_dwordx4 v[72:75], v190, s[8:11], s58 offen offset:1024 sc1
ms_204:
  s_add_u32 s54, s54, 1
  s_cmp_gt_u32 s54, 131072
  s_cbranch_scc1 end0
  s_waitcnt vmcnt(0)
  s_mov_b64 exec, s[22:23]
  ds_write_b128 v190, v[68:71] offset:0
  v_cmp_eq_u32 s[22:23], -1, v68
  s_mov_b64 exec, s[98:99]
  ds_write_b128 v190, v[72:75] offset:1024
  v_cmp_eq_u32 s[98:99], -1, v72
  s_mov_b64 exec, -1
  s_or_b64 vcc, s[22:23], s[98:99]
  s_cbranch_scc1 mr_185
  s_branch mo_189
sf_190:
  s_waitcnt lgkmcnt(1)
  v_mfma_f32_16x16x32_bf16 v[120:123], v[104:107], v[104:107], 0
  s_waitcnt lgkmcnt(0)
  v_mfma_f32_16x16x32_bf16 v[120:123], v[108:111], v[108:111], v[120:123]
  s_mov_b64 exec, s[64:65]
  s_nop 6
  v_cvt_pk_f16_f32 v120, v120, v121
  buffer_store_dword v120, v8, s[8:11], s56 offen sc1
  v_cvt_pk_f16_f32 v121, v122, v123
  buffer_store_dword v121, v8, s[8:11], s56 offen offset:128 sc1
  s_mov_b64 exec, -1
  s_branch sf_191
mn_186:
  s_bitcmp1_b32 s81, 1
  s_cbranch_scc1 mk_187
  s_or_b32 s81, s81, 2
  s_nop 7
  v_mov_b32 v88, 0
  v_mov_b32 v89, 0
  v_mov_b32 v90, 0
  v_mov_b32 v91, 0
  v_mov_b32 v92, 0
  v_mov_b32 v93, 0
  v_mov_b32 v94, 0
  v_mov_b32 v95, 0
  v_mov_b32 v96, 0
  v_mov_b32 v97, 0
  v_mov_b32 v98, 0
  v_mov_b32 v99, 0
  v_mov_b32 v100, 0
  v_mov_b32 v101, 0
  v_mov_b32 v102, 0
  v_mov_b32 v103, 0
  s_cmp_eq_u32 s52, 0
  s_cbranch_scc1 mx_206
mx_205:
  buffer_load_dwordx4 v[68:71], v190, s[8:11], s58 offen offset:0 sc1
  buffer_load_dwordx4 v[72:75], v190, s[8:11], s58 offen offset:1024 sc1
  s_add_u32 s54, s54, 1
  s_cmp_gt_u32 s54, 131072
  s_cbranch_scc1 end0
  s_waitcnt vmcnt(0)
  v_max3_u32 v27, v68, v69, v70
  v_max3_u32 v27, v27, v71, v72
  v_max3_u32 v27, v27, v73, v74
  v_max3_u32 v27, v27, v75, v75
  v_cmp_eq_u32 vcc, -1, v27
  s_nop 1
  s_cbranch_vccnz mx_205
  ds_write_b128 v190, v[68:71] offset:0
  ds_write_b128 v190, v[72:75] offset:1024
mx_206:
  s_waitcnt lgkmcnt(0)
  s_branch mo_189
sr_192:
  s_mov_b32 s54, 0
sr_207:
  s_mov_b64 exec, vcc
  buffer_load_dwordx4 v[124:127], v9, s[8:11], s56 offen sc1
  buffer_load_dwordx4 v[128:131], v9, s[8:11], s56 offen offset:1024 sc1
  buffer_load_dwordx4 v[132:135], v10, s[8:11], s56 offen sc1
  s_mov_b64 exec, -1
  s_add_u32 s54, s54, 1
  s_cmp_gt_u32 s54, 131072
  s_cbranch_scc1 end0
  s_waitcnt vmcnt(0)
  v_pk_add_f16 v164, v132, v133
  v_pk_add_f16 v165, v134, v135
  v_pk_add_f16 v120, v124, v126
  v_pk_add_f16 v122, v128, v130
  v_fma_mix_f32 v170, v164, 1.0, v165 op_sel:[0,0,0] op_sel_hi:[1,0,1]
  v_fma_mix_f32 v166, v120, 1.0, v122 op_sel:[0,0,0] op_sel_hi:[1,0,1]
  v_pk_add_f16 v121, v125, v127
  v_cmp_u_f32 vcc, v166, v170
  v_pk_add_f16 v123, v129, v131
  v_fma_mix_f32 v171, v164, 1.0, v165 op_sel:[1,0,1] op_sel_hi:[1,0,1]
  v_fma_mix_f32 v167, v120, 1.0, v122 op_sel:[1,0,1] op_sel_hi:[1,0,1]
  v_fma_mix_f32 v168, v121, 1.0, v123 op_sel:[0,0,0] op_sel_hi:[1,0,1]
  v_fma_mix_f32 v169, v121, 1.0, v123 op_sel:[1,0,1] op_sel_hi:[1,0,1]
  s_cbranch_vccz ex_194
  s_and_b32 s21, s54, 31
  s_cbranch_scc1 sr_207
  v_max3_u32 v27, v124, v126, v128
  v_max3_u32 v27, v27, v130, v132
  v_max3_u32 v27, v27, v133, v134
  v_max3_u32 v27, v27, v135, v135
  v_cmp_eq_u32 vcc, -1, v27
  s_nop 1
  s_cbranch_vccnz sr_207
ex_194:
  v_exp_f32 v176, v170
  v_exp_f32 v177, v171
  v_exp_f32 v172, v166
  v_cvt_pk_bf16_f32 v160, v176, v177
  v_exp_f32 v173, v167
  v_exp_f32 v174, v168
  v_mov_b32_dpp v161, v160 row_ror:8 row_mask:0xf bank_mask:0xf
  v_cvt_pk_bf16_f32 v156, v172, v173
  v_exp_f32 v175, v169
  v_mfma_f32_16x16x32_bf16 v[178:181], v[140:143], v[160:163], 0
  v_mov_b32_dpp v158, v156 row_ror:8 row_mask:0xf bank_mask:0xf
  v_cvt_pk_bf16_f32 v157, v174, v175
  v_mfma_f32_16x16x32_bf16 v[182:185], v[136:139], v[160:163], 0
  s_nop 0
  v_mov_b32_dpp v159, v157 row_ror:8 row_mask:0xf bank_mask:0xf
  v_mfma_f32_16x16x32_bf16 v[186:189], v[138:141], v[160:163], 0
  s_branch pv_193
fx_195:
  s_bitcmp1_b32 s81, 0
  s_cbranch_scc1 fk_196
  s_or_b32 s81, s81, 1
  s_mov_b64 exec, -1
  v_max3_f32 v164, v166, v167, v168
  v_max3_f32 v165, v169, v170, v171
  v_max_f32 v164, v164, v165
  s_nop 1
  v_max_f32_dpp v164, v164, v164 row_ror:8 row_mask:0xf bank_mask:0xf
  v_mov_b32 v165, v164
  s_nop 1
  v_permlane32_swap_b32 v164, v165
  v_max_f32 v164, v164, v165
  v_mov_b32 v165, v164
  s_nop 1
  v_permlane16_swap_b32 v164, v165
  v_max_f32 v164, v164, v165
  v_sub_f32 v166, v166, v164
  v_sub_f32 v167, v167, v164
  v_sub_f32 v168, v168, v164
  v_sub_f32 v169, v169, v164
  v_sub_f32 v170, v170, v164
  v_sub_f32 v171, v171, v164
  s_branch ex_194
nt_199:
  s_branch nt_198
p2_202:
  s_mov_b32 s54, 0
  buffer_load_dwordx4 v[68:71], v16, s[4:7], s60 offen sc1
  s_waitcnt vmcnt(1)
  v_mfma_f32_16x16x32_f16 v[120:123], v[44:47], v[72:75], 0
  v_bitop3_b32 v27, v72, s61, 1 bitop3:0x28
  v_cmp_ne_u32 vcc, 0, v27
  s_nop 1
  s_cbranch_vccz pg_201
  buffer_load_dwordx4 v[72:75], v16, s[4:7], s60 offen sc1
pp_200:
  s_waitcnt vmcnt(1)
  v_mfma_f32_16x16x32_f16 v[120:123], v[44:47], v[68:71], 0
  v_bitop3_b32 v27, v68, s61, 1 bitop3:0x28
  v_cmp_ne_u32 vcc, 0, v27
  s_nop 1
  s_cbranch_vccz pg_201
  buffer_load_dwordx4 v[68:71], v16, s[4:7], s60 offen sc1
  s_waitcnt vmcnt(1)
  v_mfma_f32_16x16x32_f16 v[120:123], v[44:47], v[72:75], 0
  v_bitop3_b32 v27, v72, s61, 1 bitop3:0x28
  v_cmp_ne_u32 vcc, 0, v27
  s_nop 1
  s_cbranch_vccz pg_201
  buffer_load_dwordx4 v[72:75], v16, s[4:7], s60 offen sc1
  s_add_u32 s54, s54, 1
  s_cmp_gt_u32 s54, 131072
  s_cbranch_scc1 end0
  s_branch pp_200
last_188:
  v_smfmac_f32_16x16x64_bf16 v[96:99], v[48:51], a[0:7], v22
  v_smfmac_f32_16x16x64_bf16 v[100:103], v[48:51], a[80:87], v22
  v_smfmac_f32_16x16x64_bf16 v[96:99], v[52:55], a[8:15], v22
  v_smfmac_f32_16x16x64_bf16 v[100:103], v[52:55], a[88:95], v22
  v_smfmac_f32_16x16x64_bf16 v[96:99], v[56:59], a[16:23], v22
  v_smfmac_f32_16x16x64_bf16 v[100:103], v[56:59], a[96:103], v22
  v_smfmac_f32_16x16x64_bf16 v[96:99], v[60:63], a[24:31], v22
  v_smfmac_f32_16x16x64_bf16 v[96:99], v[64:67], a[32:39], v22
  v_smfmac_f32_16x16x64_bf16 v[96:99], v[68:71], a[40:47], v22
  v_smfmac_f32_16x16x64_bf16 v[96:99], v[72:75], a[48:55], v22
  v_smfmac_f32_16x16x64_bf16 v[96:99], v[76:79], a[56:63], v22
  v_smfmac_f32_16x16x64_bf16 v[96:99], v[80:83], a[64:71], v22
  v_smfmac_f32_16x16x64_bf16 v[96:99], v[84:87], a[72:79], v22
  v_smfmac_f32_16x16x64_bf16 v[100:103], v[60:63], a[104:111], v22
  v_smfmac_f32_16x16x64_bf16 v[100:103], v[64:67], a[112:119], v22
  v_smfmac_f32_16x16x64_bf16 v[100:103], v[68:71], a[120:127], v22
  v_smfmac_f32_16x16x64_bf16 v[100:103], v[72:75], a[128:135], v22
  v_smfmac_f32_16x16x64_bf16 v[100:103], v[76:79], a[136:143], v22
  v_smfmac_f32_16x16x64_bf16 v[100:103], v[80:83], a[144:151], v22
  v_smfmac_f32_16x16x64_bf16 v[100:103], v[84:87], a[152:159], v22
  s_nop 7
  v_permlane32_swap_b32 v96, v100
  v_permlane32_swap_b32 v97, v101
  v_permlane32_swap_b32 v98, v102
  v_permlane32_swap_b32 v99, v103
  v_pk_add_f32 v[96:97], v[96:97], v[100:101]
  v_pk_add_f32 v[98:99], v[98:99], v[102:103]
  v_cvt_pk_bf16_f32 v100, v96, v97
  v_cvt_pk_bf16_f32 v101, v98, v99
  s_nop 0
  v_permlane32_swap_b32 v100, v102
  v_permlane32_swap_b32 v101, v103
  v_min_u32 v100, -2, v100
  buffer_store_dwordx4 v[100:103], v26, s[16:19], s70 offen sc1
  s_waitcnt vmcnt(0)
  s_barrier
  s_branch chain_done
E_31:
  v_add_u32 v190, 7168, v4
  ds_write_b32 v13, v28
  ds_write_b32 v14, v28
  s_waitcnt vmcnt(0)
  ds_write_b128 v190, v[76:79] offset:0
  ds_write_b128 v190, v[80:83] offset:1024
  ds_write_b128 v190, v[84:87] offset:2048
  s_waitcnt lgkmcnt(0)
  s_branch mo_214
  .p2align 3
top_209:
  s_waitcnt vmcnt(2)
  ds_write_b128 v190, v[76:79] offset:0
  v_cmp_eq_u32 s[22:23], -1, v76
  s_waitcnt vmcnt(1)
  ds_write_b128 v190, v[80:83] offset:1024
  v_cmp_eq_u32 s[98:99], -1, v80
  s_waitcnt vmcnt(0)
  ds_write_b128 v190, v[84:87] offset:2048
  v_cmp_eq_u32 s[100:101], -1, v84
  s_or_b64 vcc, s[22:23], s[98:99]
  s_or_b64 vcc, vcc, s[100:101]
  s_cbranch_scc1 mr_210
mo_214:
  s_barrier
  ds_read_b128 v[48:51], v4 offset:0
  ds_read_b128 v[52:55], v4 offset:1024
  v_smfmac_f32_16x16x64_bf16 v[92:95], v[76:79], v[232:239], v22
  ds_read_b128 v[56:59], v4 offset:2048
  ds_read_b128 v[60:63], v4 offset:3072
  v_smfmac_f32_16x16x64_bf16 v[88:91], v[76:79], a[216:223], v22
  s_add_u32 m0, s74, 0
  s_add_u32 s21, s79, 0
  buffer_load_dwordx4 v4, s[16:19], s21 offen offset:1024 sc1 lds
  v_smfmac_f32_16x16x64_bf16 v[92:95], v[80:83], v[240:247], v22
  ds_read_b128 v[64:67], v4 offset:4096
  ds_read_b128 v[68:71], v4 offset:5120
  s_add_u32 s22, s52, 3
  s_min_u32 s22, s22, 64
  v_smfmac_f32_16x16x64_bf16 v[88:91], v[80:83], a[224:231], v22
  s_add_u32 m0, s74, 2048
  s_add_u32 s21, s79, 65536
  buffer_load_dwordx4 v4, s[16:19], s21 offen offset:1024 sc1 lds
  v_cmp_gt_u32 vcc, s22, v42
  v_smfmac_f32_16x16x64_bf16 v[92:95], v[84:87], v[248:255], v22
  ds_read_b128 v[72:75], v4 offset:6144
  s_cbranch_vccnz kw_215
kv_216:
  v_smfmac_f32_16x16x64_bf16 v[88:91], v[84:87], a[232:239], v22
  s_waitcnt lgkmcnt(6)
  s_add_u32 m0, s74, 10240
  s_nop 0
  buffer_load_dwordx4 v4, s[16:19], s73 offen offset:0 sc1 lds
  v_smfmac_f32_16x16x64_bf16 v[92:95], v[48:51], a[240:247], v22
  v_smfmac_f32_16x16x64_bf16 v[88:91], v[48:51], a[160:167], v22
  s_waitcnt lgkmcnt(5)
  s_add_u32 m0, s74, 10240
  s_nop 0
  buffer_load_dwordx4 v4, s[16:19], s73 offen offset:1024 sc1 lds
  v_smfmac_f32_16x16x64_bf16 v[92:95], v[52:55], a[248:255], v22
  s_waitcnt lgkmcnt(4)
  v_smfmac_f32_16x16x64_bf16 v[92:95], v[56:59], v[192:199], v22
  s_waitcnt lgkmcnt(3)
  s_add_u32 m0, s74, 10240
  s_nop 0
  buffer_load_dwordx4 v4, s[16:19], s73 offen offset:2048 sc1 lds
  v_smfmac_f32_16x16x64_bf16 v[92:95], v[60:63], v[200:207], v22
  s_waitcnt lgkmcnt(2)
  v_smfmac_f32_16x16x64_bf16 v[92:95], v[64:67], v[208:215], v22
  s_waitcnt lgkmcnt(1)
  s_add_u32 m0, s74, 0
  s_mul_i32 s21, s91, 0
  s_add_u32 s21, s21, s71
  buffer_load_dwordx4 v4, s[16:19], s21 offen sc1 lds
  v_smfmac_f32_16x16x64_bf16 v[92:95], v[68:71], v[216:223], v22
  s_waitcnt lgkmcnt(0)
  v_smfmac_f32_16x16x64_bf16 v[92:95], v[72:75], v[224:231], v22
  s_add_u32 m0, s74, 2048
  s_mul_i32 s21, s91, 1
  s_add_u32 s21, s21, s71
  buffer_load_dwordx4 v4, s[16:19], s21 offen sc1 lds
  v_smfmac_f32_16x16x64_bf16 v[88:91], v[52:55], a[168:175], v22
  v_smfmac_f32_16x16x64_bf16 v[88:91], v[56:59], a[176:183], v22
  v_smfmac_f32_16x16x64_bf16 v[88:91], v[60:63], a[184:191], v22
  v_cvt_pk_bf16_f32 v122, v92, v93
  v_smfmac_f32_16x16x64_bf16 v[88:91], v[64:67], a[192:199], v22
  v_cvt_pk_bf16_f32 v123, v94, v95
  s_barrier
  v_smfmac_f32_16x16x64_bf16 v[88:91], v[68:71], a[200:207], v22
  ds_write_b64 v12, v[122:123] offset:13056
  v_smfmac_f32_16x16x64_bf16 v[88:91], v[72:75], a[208:215], v22
  v_smfmac_f32_16x16x64_bf16 v[96:99], v[48:51], a[0:7], v22
  v_smfmac_f32_16x16x64_bf16 v[100:103], v[48:51], a[80:87], v22
  v_smfmac_f32_16x16x64_bf16 v[96:99], v[52:55], a[8:15], v22
  v_cvt_pk_bf16_f32 v120, v88, v89
  v_cvt_pk_bf16_f32 v121, v90, v91
  ds_write_b64 v12, v[120:121] offset:12544
  v_smfmac_f32_16x16x64_bf16 v[100:103], v[52:55], a[88:95], v22
  s_waitcnt lgkmcnt(0)
  s_barrier
  ds_read_b64_tr_b16 v[104:105], v7 offset:0
  ds_read_b64_tr_b16 v[106:107], v7 offset:768
  ds_read_b64_tr_b16 v[108:109], v7 offset:1536
  ds_read_b32 v27, v12 offset:12544
  ds_read_b64 v[140:141], v11
  s_waitcnt lgkmcnt(1)
  v_cmp_u_f32 vcc, v104, v106
  v_cmp_u_f32 s[22:23], v108, v27
  s_nop 1
  s_or_b64 vcc, vcc, s[22:23]
  s_cbranch_vccnz mn_211
mk_212:
  s_cmp_eq_u32 s52, 63
  s_cbranch_scc1 last_213
  v_permlane32_swap_b32 v88, v92
  v_permlane32_swap_b32 v89, v93
  v_permlane32_swap_b32 v90, v94
  v_permlane32_swap_b32 v91, v95
  v_pk_add_f32 v[88:89], v[88:89], v[92:93]
  v_pk_add_f32 v[90:91], v[90:91], v[94:95]
  v_cvt_pk_bf16_f32 v92, v88, v89
  v_cvt_pk_bf16_f32 v93, v90, v91
  v_min_u32 v92, -2, v92
  s_nop 0
  v_smfmac_f32_16x16x64_bf16 v[96:99], v[56:59], a[16:23], v22
  v_smfmac_f32_16x16x64_bf16 v[100:103], v[56:59], a[96:103], v22
  v_smfmac_f32_16x16x64_bf16 v[96:99], v[60:63], a[24:31], v22
  v_smfmac_f32_16x16x64_bf16 v[96:99], v[64:67], a[32:39], v22
  v_smfmac_f32_16x16x64_bf16 v[96:99], v[68:71], a[40:47], v22
  v_smfmac_f32_16x16x64_bf16 v[96:99], v[72:75], a[48:55], v22
  v_smfmac_f32_16x16x64_bf16 v[96:99], v[76:79], a[56:63], v22
  v_smfmac_f32_16x16x64_bf16 v[96:99], v[80:83], a[64:71], v22
  v_smfmac_f32_16x16x64_bf16 v[96:99], v[84:87], a[72:79], v22
  v_smfmac_f32_16x16x64_bf16 v[100:103], v[60:63], a[104:111], v22
  v_smfmac_f32_16x16x64_bf16 v[100:103], v[64:67], a[112:119], v22
  buffer_load_dwordx4 v[132:135], v10, s[8:11], s56 offen sc1
  v_smfmac_f32_16x16x64_bf16 v[100:103], v[68:71], a[120:127], v22
  buffer_load_dwordx4 v[124:127], v9, s[8:11], s56 offen sc1
  v_smfmac_f32_16x16x64_bf16 v[100:103], v[72:75], a[128:135], v22
  buffer_load_dwordx4 v[128:131], v9, s[8:11], s56 offen offset:1024 sc1
  v_cvt_pk_bf16_f32 v136, v96, v97
  v_smfmac_f32_16x16x64_bf16 v[100:103], v[76:79], a[136:143], v22
  v_cvt_pk_bf16_f32 v137, v98, v99
  v_smfmac_f32_16x16x64_bf16 v[100:103], v[80:83], a[144:151], v22
  v_smfmac_f32_16x16x64_bf16 v[100:103], v[84:87], a[152:159], v22
  s_nop 7
  v_cvt_pk_bf16_f32 v138, v100, v101
  v_cvt_pk_bf16_f32 v139, v102, v103
  v_permlane32_swap_b32 v96, v100
  v_permlane32_swap_b32 v97, v101
  v_permlane32_swap_b32 v98, v102
  v_permlane32_swap_b32 v99, v103
  v_pk_add_f32 v[96:97], v[96:97], v[100:101]
  v_pk_add_f32 v[98:99], v[98:99], v[102:103]
  v_cvt_pk_bf16_f32 v100, v96, v97
  v_cvt_pk_bf16_f32 v101, v98, v99
  s_nop 0
  v_permlane32_swap_b32 v100, v102
  v_permlane32_swap_b32 v101, v103
  v_min_u32 v100, -2, v100
  s_waitcnt vmcnt(2) lgkmcnt(0)
  v_pk_add_f16 v164, v132, v133
  v_pk_add_f16 v165, v134, v135
  v_fma_mix_f32 v170, v164, 1.0, v165 op_sel:[0,0,0] op_sel_hi:[1,0,1]
  v_fma_mix_f32 v171, v164, 1.0, v165 op_sel:[1,0,1] op_sel_hi:[1,0,1]
  v_exp_f32 v176, v170
  v_exp_f32 v177, v171
  s_waitcnt vmcnt(1)
  v_cvt_pk_bf16_f32 v160, v176, v177
  v_pk_add_f16 v120, v124, v126
  v_pk_add_f16 v121, v125, v127
  v_mov_b32_dpp v161, v160 row_ror:8 row_mask:0xf bank_mask:0xf
  s_waitcnt vmcnt(0)
  v_pk_add_f16 v122, v128, v130
  v_mfma_f32_16x16x32_bf16 v[178:181], v[140:143], v[160:163], 0
  v_fma_mix_f32 v166, v120, 1.0, v122 op_sel:[0,0,0] op_sel_hi:[1,0,1]
  v_fma_mix_f32 v167, v120, 1.0, v122 op_sel:[1,0,1] op_sel_hi:[1,0,1]
  v_cmp_u_f32 vcc, v166, v170
  v_pk_add_f16 v123, v129, v131
  v_exp_f32 v172, v166
  v_mfma_f32_16x16x32_bf16 v[182:185], v[136:139], v[160:163], 0
  s_cbranch_vccnz sr_219
  v_exp_f32 v173, v167
  v_fma_mix_f32 v168, v121, 1.0, v123 op_sel:[0,0,0] op_sel_hi:[1,0,1]
  v_fma_mix_f32 v169, v121, 1.0, v123 op_sel:[1,0,1] op_sel_hi:[1,0,1]
  v_cvt_pk_bf16_f32 v156, v172, v173
  v_exp_f32 v174, v168
  v_exp_f32 v175, v169
  v_mov_b32_dpp v158, v156 row_ror:8 row_mask:0xf bank_mask:0xf
  v_cvt_pk_bf16_f32 v157, v174, v175
  v_mfma_f32_16x16x32_bf16 v[186:189], v[138:141], v[160:163], 0
  s_nop 0
  v_mov_b32_dpp v159, v157 row_ror:8 row_mask:0xf bank_mask:0xf
  s_nop 1
pv_220:
  v_mfma_f32_16x16x32_bf16 v[178:181], v[152:155], v[156:159], v[178:181]
  v_mfma_f32_16x16x32_bf16 v[182:185], v[144:147], v[156:159], v[182:185]
  v_mfma_f32_16x16x32_bf16 v[186:189], v[148:151], v[156:159], v[186:189]
  s_mov_b64 exec, s[62:63]
  s_nop 0
  v_rcp_f32 v164, v180
  v_cmp_ngt_f32 s[22:23], s80, v180
  v_cmp_ngt_f32 vcc, s80, v164
  v_pk_mul_f32 v[182:183], v[182:183], v[164:165] op_sel_hi:[1,0]
  v_pk_mul_f32 v[184:185], v[184:185], v[164:165] op_sel_hi:[1,0]
  v_pk_mul_f32 v[178:179], v[178:179], v[164:165] op_sel_hi:[1,0]
  v_pk_mul_f32 v[186:187], v[186:187], v[164:165] op_sel_hi:[1,0]
  v_pk_mul_f32 v[188:189], v[188:189], v[164:165] op_sel_hi:[1,0]
  v_cvt_pk_f16_f32 v64, v178, v179
  s_or_b64 vcc, vcc, s[22:23]
  s_cbranch_scc1 fx_222
fk_223:
  ds_write_b32 v14, v64
  v_cvt_pk_f16_f32 v60, v182, v183
  v_cvt_pk_f16_f32 v61, v184, v185
  v_cvt_pk_f16_f32 v62, v186, v187
  v_cvt_pk_f16_f32 v63, v188, v189
  ds_write_b128 v13, v[60:63]
  s_mov_b64 exec, s[66:67]
  s_barrier
  ds_read_b128 v[166:169], v4 offset:13824
  ds_read_b128 v[170:173], v4 offset:14464
  ds_read_b128 v[174:177], v4 offset:15104
  ds_read_b128 v[178:181], v4 offset:15744
  s_waitcnt lgkmcnt(2)
  v_pk_add_f16 v166, v166, v170
  v_pk_add_f16 v167, v167, v171
  v_pk_add_f16 v168, v168, v172
  v_pk_add_f16 v169, v169, v173
  s_waitcnt lgkmcnt(1)
  v_pk_add_f16 v166, v166, v174
  v_pk_add_f16 v167, v167, v175
  v_pk_add_f16 v168, v168, v176
  v_pk_add_f16 v169, v169, v177
  s_waitcnt lgkmcnt(0)
  v_pk_add_f16 v166, v166, v178
  v_cmpx_o_f16 vcc, v166, v166
  v_pk_add_f16 v167, v167, v179
  v_pk_add_f16 v168, v168, v180
  v_pk_add_f16 v169, v169, v181
  v_and_or_b32 v166, v166, -2, s61
  buffer_store_dwordx4 v[166:169], v15, s[4:7], s60 offen sc1
  s_xor_b64 s[98:99], exec, s[66:67]
  s_mov_b64 exec, -1
  buffer_store_dwordx4 v[100:103], v26, s[16:19], s70 offen sc1
  buffer_store_dwordx2 v[92:93], v43, s[16:19], s70 offen sc1
  s_add_u32 s70, s70, 2097152
  s_xor_b32 s70, s70, 8192
  ds_read_b128 v[144:147], v18
  ds_read_b128 v[148:151], v18 offset:1024
  ds_read_b128 v[152:155], v19
  v_xor_b32 v18, 16384, v18
  v_xor_b32 v19, 16384, v19
  v_mov_b32 v88, 0
  v_mov_b32 v89, 0
  v_mov_b32 v90, 0
  v_mov_b32 v91, 0
  v_mov_b32 v92, 0
  v_mov_b32 v93, 0
  v_mov_b32 v94, 0
  v_mov_b32 v95, 0
  v_mov_b32 v96, 0
  v_mov_b32 v97, 0
  v_mov_b32 v98, 0
  v_mov_b32 v99, 0
  v_mov_b32 v100, 0
  v_mov_b32 v101, 0
  v_mov_b32 v102, 0
  v_mov_b32 v103, 0
  s_mov_b32 s81, 0
  s_waitcnt lgkmcnt(0)
  s_barrier
  s_cmp_lg_u64 s[98:99], 0
  s_cbranch_scc1 pf_224
pf_225:
  s_xor_b32 s74, s74, 16384
  s_add_u32 s73, s73, 2097152
  s_xor_b32 s73, s73, 8192
  s_add_u32 s79, s79, 2097152
  s_xor_b32 s79, s79, 8192
  s_add_u32 s21, s72, 524288
  s_xor_b32 s72, s72, s21
  s_lshr_b32 s72, s72, 8
  s_and_b32 s72, s72, 8192
  s_xor_b32 s72, s72, s21
  s_add_u32 s71, s73, 4096
  s_mov_b32 s91, 1024
  s_sub_u32 s21, s73, 0
  s_cmp_lt_u32 s21, 125829120
  s_cselect_b32 s71, s71, s79
  s_cselect_b32 s91, s91, 65536
  v_mov_b32 v166, s52
  s_add_u32 s22, s52, 5
  s_min_u32 s22, s22, 64
  v_cmp_gt_u32 vcc, s22, v42
  s_cbranch_vccz fv_227
  buffer_load_dword v42, v41, s[12:15], s76 offen sc1
fv_227:
  ds_write_b128 v190, v[28:31] offset:0
  ds_write_b128 v190, v[28:31] offset:1024
  ds_write_b128 v190, v[28:31] offset:2048
nt_226:
  s_barrier
  s_mov_b32 s58, s55
  s_add_u32 s52, s52, 1
  ds_write_b32 v13, v28
  ds_write_b32 v14, v28
  s_and_b32 s21, s52, 3
  s_mul_i32 s56, s21, 122880
  s_add_u32 s21, s52, 1
  s_and_b32 s21, s21, 3
  s_mul_i32 s55, s21, 122880
  s_add_u32 s55, s55, s75
  s_add_u32 s21, s52, 2
  s_and_b32 s21, s21, 3
  s_mul_i32 s57, s21, 122880
  s_add_u32 s21, s52, 3
  s_and_b32 s21, s21, 3
  s_mul_i32 s59, s21, 122880
  s_add_u32 s59, s59, s75
  s_bfe_u32 s61, s52, 0x10002
  s_and_b32 s21, s52, 3
  s_lshl_b32 s60, s21, 18
  s_mov_b32 s54, 0
  s_sleep 2
  s_nop 10
  s_waitcnt lgkmcnt(0)
  buffer_load_dwordx4 v[76:79], v190, s[8:11], s58 offen offset:0 sc1
  buffer_load_dwordx4 v[80:83], v190, s[8:11], s58 offen offset:1024 sc1
  buffer_load_dwordx4 v[84:87], v190, s[8:11], s58 offen offset:2048 sc1
  s_branch top_209
mr_210:
  s_mov_b64 exec, s[22:23]
  s_cbranch_execz ms_228
  buffer_load_dwordx4 v[76:79], v190, s[8:11], s58 offen offset:0 sc1
ms_228:
  s_mov_b64 exec, s[98:99]
  s_cbranch_execz ms_229
  buffer_load_dwordx4 v[80:83], v190, s[8:11], s58 offen offset:1024 sc1
ms_229:
  s_mov_b64 exec, s[100:101]
  s_cbranch_execz ms_230
  buffer_load_dwordx4 v[84:87], v190, s[8:11], s58 offen offset:2048 sc1
ms_230:
  s_add_u32 s54, s54, 1
  s_cmp_gt_u32 s54, 131072
  s_cbranch_scc1 end0
  s_waitcnt vmcnt(0)
  s_mov_b64 exec, s[22:23]
  ds_write_b128 v190, v[76:79] offset:0
  v_cmp_eq_u32 s[22:23], -1, v76
  s_mov_b64 exec, s[98:99]
  ds_write_b128 v190, v[80:83] offset:1024
  v_cmp_eq_u32 s[98:99], -1, v80
  s_mov_b64 exec, s[100:101]
  ds_write_b128 v190, v[84:87] offset:2048
  v_cmp_eq_u32 s[100:101], -1, v84
  s_mov_b64 exec, -1
  s_or_b64 vcc, s[22:23], s[98:99]
  s_or_b64 vcc, vcc, s[100:101]
  s_cbranch_scc1 mr_210
  s_branch mo_214
kw_215:
  s_mov_b32 s101, 0
wm_231:
  buffer_load_dword v42, v41, s[12:15], s76 offen sc1
  s_add_u32 s101, s101, 1
  s_cmp_gt_u32 s101, 131072
  s_cbranch_scc1 end0
  s_waitcnt vmcnt(0)
  v_cmp_gt_u32 vcc, s22, v42
  v_readfirstlane_b32 s100, v42
  s_nop 0
  s_cbranch_vccz wm_232
  s_sleep 1
  s_branch wm_231
wm_232:
  s_branch kv_216
mn_211:
  s_bitcmp1_b32 s81, 1
  s_cbranch_scc1 mk_212
  s_or_b32 s81, s81, 2
  s_nop 7
  v_mov_b32 v88, 0
  v_mov_b32 v89, 0
  v_mov_b32 v90, 0
  v_mov_b32 v91, 0
  v_mov_b32 v92, 0
  v_mov_b32 v93, 0
  v_mov_b32 v94, 0
  v_mov_b32 v95, 0
  v_mov_b32 v96, 0
  v_mov_b32 v97, 0
  v_mov_b32 v98, 0
  v_mov_b32 v99, 0
  v_mov_b32 v100, 0
  v_mov_b32 v101, 0
  v_mov_b32 v102, 0
  v_mov_b32 v103, 0
  s_cmp_eq_u32 s52, 0
  s_cbranch_scc1 mx_234
mx_233:
  buffer_load_dwordx4 v[76:79], v190, s[8:11], s58 offen offset:0 sc1
  buffer_load_dwordx4 v[80:83], v190, s[8:11], s58 offen offset:1024 sc1
  buffer_load_dwordx4 v[84:87], v190, s[8:11], s58 offen offset:2048 sc1
  s_add_u32 s54, s54, 1
  s_cmp_gt_u32 s54, 131072
  s_cbranch_scc1 end0
  s_waitcnt vmcnt(0)
  v_max3_u32 v27, v76, v77, v78
  v_max3_u32 v27, v27, v79, v80
  v_max3_u32 v27, v27, v81, v82
  v_max3_u32 v27, v27, v83, v84
  v_max3_u32 v27, v27, v85, v86
  v_max3_u32 v27, v27, v87, v87
  v_cmp_eq_u32 vcc, -1, v27
  s_nop 1
  s_cbranch_vccnz mx_233
  ds_write_b128 v190, v[76:79] offset:0
  ds_write_b128 v190, v[80:83] offset:1024
  ds_write_b128 v190, v[84:87] offset:2048
mx_234:
  s_waitcnt lgkmcnt(0)
  s_branch mo_214
sr_219:
  s_mov_b32 s54, 0
sr_235:
  s_mov_b64 exec, vcc
  buffer_load_dwordx4 v[124:127], v9, s[8:11], s56 offen sc1
  buffer_load_dwordx4 v[128:131], v9, s[8:11], s56 offen offset:1024 sc1
  buffer_load_dwordx4 v[132:135], v10, s[8:11], s56 offen sc1
  s_mov_b64 exec, -1
  s_add_u32 s54, s54, 1
  s_cmp_gt_u32 s54, 131072
  s_cbranch_scc1 end0
  s_waitcnt vmcnt(0)
  v_pk_add_f16 v164, v132, v133
  v_pk_add_f16 v165, v134, v135
  v_pk_add_f16 v120, v124, v126
  v_pk_add_f16 v122, v128, v130
  v_fma_mix_f32 v170, v164, 1.0, v165 op_sel:[0,0,0] op_sel_hi:[1,0,1]
  v_fma_mix_f32 v166, v120, 1.0, v122 op_sel:[0,0,0] op_sel_hi:[1,0,1]
  v_pk_add_f16 v121, v125, v127
  v_cmp_u_f32 vcc, v166, v170
  v_pk_add_f16 v123, v129, v131
  v_fma_mix_f32 v171, v164, 1.0, v165 op_sel:[1,0,1] op_sel_hi:[1,0,1]
  v_fma_mix_f32 v167, v120, 1.0, v122 op_sel:[1,0,1] op_sel_hi:[1,0,1]
  v_fma_mix_f32 v168, v121, 1.0, v123 op_sel:[0,0,0] op_sel_hi:[1,0,1]
  v_fma_mix_f32 v169, v121, 1.0, v123 op_sel:[1,0,1] op_sel_hi:[1,0,1]
  s_cbranch_vccz ex_221
  s_and_b32 s21, s54, 31
  s_cbranch_scc1 sr_235
  v_max3_u32 v27, v124, v126, v128
  v_max3_u32 v27, v27, v130, v132
  v_max3_u32 v27, v27, v133, v134
  v_max3_u32 v27, v27, v135, v135
  v_cmp_eq_u32 vcc, -1, v27
  s_nop 1
  s_cbranch_vccnz sr_235
ex_221:
  v_exp_f32 v176, v170
  v_exp_f32 v177, v171
  v_exp_f32 v172, v166
  v_cvt_pk_bf16_f32 v160, v176, v177
  v_exp_f32 v173, v167
  v_exp_f32 v174, v168
  v_mov_b32_dpp v161, v160 row_ror:8 row_mask:0xf bank_mask:0xf
  v_cvt_pk_bf16_f32 v156, v172, v173
  v_exp_f32 v175, v169
  v_mfma_f32_16x16x32_bf16 v[178:181], v[140:143], v[160:163], 0
  v_mov_b32_dpp v158, v156 row_ror:8 row_mask:0xf bank_mask:0xf
  v_cvt_pk_bf16_f32 v157, v174, v175
  v_mfma_f32_16x16x32_bf16 v[182:185], v[136:139], v[160:163], 0
  s_nop 0
  v_mov_b32_dpp v159, v157 row_ror:8 row_mask:0xf bank_mask:0xf
  v_mfma_f32_16x16x32_bf16 v[186:189], v[138:141], v[160:163], 0
  s_branch pv_220
fx_222:
  s_bitcmp1_b32 s81, 0
  s_cbranch_scc1 fk_223
  s_or_b32 s81, s81, 1
  s_mov_b64 exec, -1
  v_max3_f32 v164, v166, v167, v168
  v_max3_f32 v165, v169, v170, v171
  v_max_f32 v164, v164, v165
  s_nop 1
  v_max_f32_dpp v164, v164, v164 row_ror:8 row_mask:0xf bank_mask:0xf
  v_mov_b32 v165, v164
  s_nop 1
  v_permlane32_swap_b32 v164, v165
  v_max_f32 v164, v164, v165
  v_mov_b32 v165, v164
  s_nop 1
  v_permlane16_swap_b32 v164, v165
  v_max_f32 v164, v164, v165
  v_sub_f32 v166, v166, v164
  v_sub_f32 v167, v167, v164
  v_sub_f32 v168, v168, v164
  v_sub_f32 v169, v169, v164
  v_sub_f32 v170, v170, v164
  v_sub_f32 v171, v171, v164
  s_branch ex_221
pf_224:
  s_mov_b64 exec, s[66:67]
  ds_read_b128 v[166:169], v4 offset:13824
  ds_read_b128 v[170:173], v4 offset:14464
  ds_read_b128 v[174:177], v4 offset:15104
  ds_read_b128 v[178:181], v4 offset:15744
  s_waitcnt lgkmcnt(2)
  v_pk_add_f16 v166, v166, v170
  v_pk_add_f16 v167, v167, v171
  v_pk_add_f16 v168, v168, v172
  v_pk_add_f16 v169, v169, v173
  s_waitcnt lgkmcnt(1)
  v_pk_add_f16 v166, v166, v174
  v_pk_add_f16 v167, v167, v175
  v_pk_add_f16 v168, v168, v176
  v_pk_add_f16 v169, v169, v177
  s_waitcnt lgkmcnt(0)
  v_pk_add_f16 v166, v166, v178
  v_pk_add_f16 v167, v167, v179
  v_pk_add_f16 v168, v168, v180
  v_pk_add_f16 v169, v169, v181
  v_and_or_b32 v166, v166, -2, s61
  buffer_store_dwordx4 v[166:169], v15, s[4:7], s60 offen sc1
  s_mov_b64 exec, -1
  s_nop 1
  s_branch pf_225
last_213:
  v_permlane32_swap_b32 v88, v92
  v_permlane32_swap_b32 v89, v93
  v_permlane32_swap_b32 v90, v94
  v_permlane32_swap_b32 v91, v95
  v_pk_add_f32 v[88:89], v[88:89], v[92:93]
  v_pk_add_f32 v[90:91], v[90:91], v[94:95]
  v_cvt_pk_bf16_f32 v92, v88, v89
  v_cvt_pk_bf16_f32 v93, v90, v91
  v_min_u32 v92, -2, v92
  buffer_store_dwordx2 v[92:93], v43, s[16:19], s70 offen sc1
  v_smfmac_f32_16x16x64_bf16 v[96:99], v[56:59], a[16:23], v22
  v_smfmac_f32_16x16x64_bf16 v[100:103], v[56:59], a[96:103], v22
  v_smfmac_f32_16x16x64_bf16 v[96:99], v[60:63], a[24:31], v22
  v_smfmac_f32_16x16x64_bf16 v[96:99], v[64:67], a[32:39], v22
  v_smfmac_f32_16x16x64_bf16 v[96:99], v[68:71], a[40:47], v22
  v_smfmac_f32_16x16x64_bf16 v[96:99], v[72:75], a[48:55], v22
  v_smfmac_f32_16x16x64_bf16 v[96:99], v[76:79], a[56:63], v22
  v_smfmac_f32_16x16x64_bf16 v[96:99], v[80:83], a[64:71], v22
  v_smfmac_f32_16x16x64_bf16 v[96:99], v[84:87], a[72:79], v22
  v_smfmac_f32_16x16x64_bf16 v[100:103], v[60:63], a[104:111], v22
  v_smfmac_f32_16x16x64_bf16 v[100:103], v[64:67], a[112:119], v22
  v_smfmac_f32_16x16x64_bf16 v[100:103], v[68:71], a[120:127], v22
  v_smfmac_f32_16x16x64_bf16 v[100:103], v[72:75], a[128:135], v22
  v_smfmac_f32_16x16x64_bf16 v[100:103], v[76:79], a[136:143], v22
  v_smfmac_f32_16x16x64_bf16 v[100:103], v[80:83], a[144:151], v22
  v_smfmac_f32_16x16x64_bf16 v[100:103], v[84:87], a[152:159], v22
  s_nop 7
  v_permlane32_swap_b32 v96, v100
  v_permlane32_swap_b32 v97, v101
  v_permlane32_swap_b32 v98, v102
  v_permlane32_swap_b32 v99, v103
  v_pk_add_f32 v[96:97], v[96:97], v[100:101]
  v_pk_add_f32 v[98:99], v[98:99], v[102:103]
  v_cvt_pk_bf16_f32 v100, v96, v97
  v_cvt_pk_bf16_f32 v101, v98, v99
  s_nop 0
  v_permlane32_swap_b32 v100, v102
  v_permlane32_swap_b32 v101, v103
  v_min_u32 v100, -2, v100
  buffer_store_dwordx4 v[100:103], v26, s[16:19], s70 offen sc1
  s_waitcnt vmcnt(0)
  s_barrier
  v_mov_b32 v166, 64
  s_mov_b64 exec, 1
  buffer_store_dword v166, v23, s[12:15], s77 offen sc1
  s_mov_b64 exec, -1
  s_branch chain_done
chain_done:
end0:
  s_endpgm
gemm_side:
  s_bfe_u32 s23, s22, 0x20005
  s_add_u32 s22, s22, 31
  s_and_b32 s22, s22, 31
  s_lshl_b32 s21, s23, 3
  s_add_u32 s2, s21, s22
  s_add_u32 s3, s2, 72
  s_add_u32 s24, s2, 48
  s_add_u32 s2, s2, s21
  s_cmp_lt_u32 s22, 24
  s_cselect_b32 s3, s24, s3
  s_cmp_lt_u32 s22, 16
  s_cselect_b32 s3, s2, s3
  s_mov_b32 s2, s3
  s_cmp_ge_u32 s3, 64
  s_cbranch_scc1 not_kv
  s_load_dwordx2 s[4:5], s[0:1], 0
  s_load_dwordx2 s[6:7], s[0:1], 24
  s_load_dwordx2 s[36:37], s[0:1], 32
  s_load_dwordx2 s[38:39], s[0:1], 104
  s_and_b32 s43, s3, 1
  s_bfe_u32 s42, s3, 0x50001
  s_lshr_b32 s40, s42, 2
  s_waitcnt lgkmcnt(0)
  s_cmp_eq_u32 s43, 1
  s_cselect_b32 s6, s36, s6
  s_cselect_b32 s7, s37, s7
  s_mov_b32 s8, s4
  s_mov_b32 s9, s5
  s_mov_b32 s10, 2621440
  s_mov_b32 s11, 0x00020000
  s_mov_b32 s12, s6
  s_mov_b32 s13, s7
  s_mov_b32 s14, 7864320
  s_mov_b32 s15, 0x00020000
  s_mov_b32 s16, s38
  s_mov_b32 s17, s39
  s_mov_b32 s18, 218103808
  s_mov_b32 s19, 0x00020000
  s_add_u32 s72, s38, 173080576
  s_addc_u32 s73, s39, 0
  s_mov_b32 s74, 49152
  s_mov_b32 s75, 0x00020000
  s_mul_i32 s44, s42, 384
  s_mov_b32 s30, 0
  s_mov_b32 s25, 80768
  v_lshrrev_b32 v4, 3, v1
  v_and_b32 v5, 7, v1
  v_xor_b32 v5, v5, v4
  s_mul_i32 s21, s20, 16
  v_add_u32 v4, s21, v4
  v_mul_u32_u24 v4, 1280, v4
  v_lshl_add_u32 v10, v5, 4, v4
  s_mul_i32 s31, s20, 2048
  v_add_u32 v11, 10240, v10
  v_mov_b32 v9, 2731
  v_add_u32 v8, 0, v1
  v_mul_u32_u24 v7, v8, v9
  v_lshrrev_b32 v7, 16, v7
  v_mul_u32_u24 v4, 24, v7
  v_sub_u32 v8, v8, v4
  s_mov_b32 s21, 12288
  v_mul_lo_u32 v7, v7, s21
  v_lshl_add_u32 v4, v8, 4, v7
  v_add_u32 v8, 64, v1
  v_mul_u32_u24 v7, v8, v9
  v_lshrrev_b32 v7, 16, v7
  v_mul_u32_u24 v5, 24, v7
  v_sub_u32 v8, v8, v5
  s_mov_b32 s21, 12288
  v_mul_lo_u32 v7, v7, s21
  v_lshl_add_u32 v5, v8, 4, v7
  v_add_u32 v8, 128, v1
  v_mul_u32_u24 v7, v8, v9
  v_lshrrev_b32 v7, 16, v7
  v_mul_u32_u24 v6, 24, v7
  v_sub_u32 v8, v8, v6
  s_mov_b32 s21, 12288
  v_mul_lo_u32 v7, v7, s21
  v_lshl_add_u32 v6, v8, 4, v7
  v_lshrrev_b32 v7, 2, v2
  v_lshl_add_u32 v7, v3, 3, v7
  v_mul_u32_u24 v7, 384, v7
  v_and_b32 v8, 3, v2
  v_lshlrev_b32 v8, 3, v8
  s_mul_i32 s21, s20, 96
  v_add3_u32 v7, v7, v8, s21
  v_add_u32 v8, 49152, v7
  s_mul_i32 s21, s20, 393216
  s_add_u32 s21, s21, 0
  s_add_u32 s21, s21, s44
  s_mul_i32 s22, s20, 12288
  s_add_u32 s22, s22, 0
  s_add_u32 m0, s22, 0
  s_nop 0
  buffer_load_dwordx4 v4, s[12:15], s21 offen lds
  s_add_u32 m0, s22, 1024
  s_nop 0
  buffer_load_dwordx4 v5, s[12:15], s21 offen lds
  s_add_u32 m0, s22, 2048
  s_nop 0
  buffer_load_dwordx4 v6, s[12:15], s21 offen lds
  s_mul_i32 s21, s20, 393216
  s_add_u32 s21, s21, 98304
  s_add_u32 s21, s21, s44
  s_mul_i32 s22, s20, 12288
  s_add_u32 s22, s22, 3072
  s_add_u32 m0, s22, 0
  s_nop 0
  buffer_load_dwordx4 v4, s[12:15], s21 offen lds
  s_add_u32 m0, s22, 1024
  s_nop 0
  buffer_load_dwordx4 v5, s[12:15], s21 offen lds
  s_add_u32 m0, s22, 2048
  s_nop 0
  buffer_load_dwordx4 v6, s[12:15], s21 offen lds
  s_mul_i32 s21, s20, 393216
  s_add_u32 s21, s21, 196608
  s_add_u32 s21, s21, s44
  s_mul_i32 s22, s20, 12288
  s_add_u32 s22, s22, 6144
  s_add_u32 m0, s22, 0
  s_nop 0
  buffer_load_dwordx4 v4, s[12:15], s21 offen lds
  s_add_u32 m0, s22, 1024
  s_nop 0
  buffer_load_dwordx4 v5, s[12:15], s21 offen lds
  s_add_u32 m0, s22, 2048
  s_nop 0
  buffer_load_dwordx4 v6, s[12:15], s21 offen lds
  s_mul_i32 s21, s20, 393216
  s_add_u32 s21, s21, 294912
  s_add_u32 s21, s21, s44
  s_mul_i32 s22, s20, 12288
  s_add_u32 s22, s22, 9216
  s_add_u32 m0, s22, 0
  s_nop 0
  buffer_load_dwordx4 v4, s[12:15], s21 offen lds
  s_add_u32 m0, s22, 1024
  s_nop 0
  buffer_load_dwordx4 v5, s[12:15], s21 offen lds
  s_add_u32 m0, s22, 2048
  s_nop 0
  buffer_load_dwordx4 v6, s[12:15], s21 offen lds
  s_add_u32 m0, s31, 98304
  s_nop 0
  buffer_load_dwordx4 v10, s[8:11], s30 offen lds
  s_add_u32 m0, s31, 99328
  s_nop 0
  buffer_load_dwordx4 v11, s[8:11], s30 offen lds
  s_add_u32 s30, s30, 128
  s_add_u32 m0, s31, 106496
  s_nop 0
  buffer_load_dwordx4 v10, s[8:11], s30 offen lds
  s_add_u32 m0, s31, 107520
  s_nop 0
  buffer_load_dwordx4 v11, s[8:11], s30 offen lds
  s_add_u32 s30, s30, 128
  s_add_u32 m0, s31, 114688
  s_nop 0
  buffer_load_dwordx4 v10, s[8:11], s30 offen lds
  s_add_u32 m0, s31, 115712
  s_nop 0
  buffer_load_dwordx4 v11, s[8:11], s30 offen lds
  s_add_u32 s30, s30, 128
  s_add_u32 m0, s31, 122880
  s_nop 0
  buffer_load_dwordx4 v10, s[8:11], s30 offen lds
  s_add_u32 m0, s31, 123904
  s_nop 0
  buffer_load_dwordx4 v11, s[8:11], s30 offen lds
  s_add_u32 s30, s30, 128
  s_add_u32 m0, s31, 131072
  s_nop 0
  buffer_load_dwordx4 v10, s[8:11], s30 offen lds
  s_add_u32 m0, s31, 132096
  s_nop 0
  buffer_load_dwordx4 v11, s[8:11], s30 offen lds
  s_add_u32 s30, s30, 128
  s_add_u32 m0, s31, 139264
  s_nop 0
  buffer_load_dwordx4 v10, s[8:11], s30 offen lds
  s_add_u32 m0, s31, 140288
  s_nop 0
  buffer_load_dwordx4 v11, s[8:11], s30 offen lds
  s_add_u32 s30, s30, 128
  s_add_u32 m0, s31, 147456
  s_nop 0
  buffer_load_dwordx4 v10, s[8:11], s30 offen lds
  s_add_u32 m0, s31, 148480
  s_nop 0
  buffer_load_dwordx4 v11, s[8:11], s30 offen lds
  s_add_u32 s30, s30, 128
  s_add_u32 m0, s31, 155648
  s_nop 0
  buffer_load_dwordx4 v10, s[8:11], s30 offen lds
  s_add_u32 m0, s31, 156672
  s_nop 0
  buffer_load_dwordx4 v11, s[8:11], s30 offen lds
  s_add_u32 s30, s30, 128
  s_mul_i32 s21, s20, 393216
  s_add_u32 s21, s21, 1572864
  s_add_u32 s21, s21, s44
  s_mul_i32 s22, s20, 12288
  s_add_u32 s22, s22, 49152
  s_add_u32 m0, s22, 0
  s_nop 0
  buffer_load_dwordx4 v4, s[12:15], s21 offen lds
  s_add_u32 m0, s22, 1024
  s_nop 0
  buffer_load_dwordx4 v5, s[12:15], s21 offen lds
  s_add_u32 m0, s22, 2048
  s_nop 0
  buffer_load_dwordx4 v6, s[12:15], s21 offen lds
  s_mul_i32 s21, s20, 393216
  s_add_u32 s21, s21, 1671168
  s_add_u32 s21, s21, s44
  s_mul_i32 s22, s20, 12288
  s_add_u32 s22, s22, 52224
  s_add_u32 m0, s22, 0
  s_nop 0
  buffer_load_dwordx4 v4, s[12:15], s21 offen lds
  s_add_u32 m0, s22, 1024
  s_nop 0
  buffer_load_dwordx4 v5, s[12:15], s21 offen lds
  s_add_u32 m0, s22, 2048
  s_nop 0
  buffer_load_dwordx4 v6, s[12:15], s21 offen lds
  s_mul_i32 s21, s20, 393216
  s_add_u32 s21, s21, 1769472
  s_add_u32 s21, s21, s44
  s_mul_i32 s22, s20, 12288
  s_add_u32 s22, s22, 55296
  s_add_u32 m0, s22, 0
  s_nop 0
  buffer_load_dwordx4 v4, s[12:15], s21 offen lds
  s_add_u32 m0, s22, 1024
  s_nop 0
  buffer_load_dwordx4 v5, s[12:15], s21 offen lds
  s_add_u32 m0, s22, 2048
  s_nop 0
  buffer_load_dwordx4 v6, s[12:15], s21 offen lds
  s_mul_i32 s21, s20, 393216
  s_add_u32 s21, s21, 1867776
  s_add_u32 s21, s21, s44
  s_mul_i32 s22, s20, 12288
  s_add_u32 s22, s22, 58368
  s_add_u32 m0, s22, 0
  s_nop 0
  buffer_load_dwordx4 v4, s[12:15], s21 offen lds
  s_add_u32 m0, s22, 1024
  s_nop 0
  buffer_load_dwordx4 v5, s[12:15], s21 offen lds
  s_add_u32 m0, s22, 2048
  s_nop 0
  buffer_load_dwordx4 v6, s[12:15], s21 offen lds
  s_waitcnt vmcnt(12)
  s_barrier
  ds_read_b64_tr_b16 a[0:1], v7 offset:0
  ds_read_b64_tr_b16 a[2:3], v7 offset:1536
  ds_read_b64_tr_b16 a[4:5], v7 offset:32
  ds_read_b64_tr_b16 a[6:7], v7 offset:1568
  ds_read_b64_tr_b16 a[8:9], v7 offset:64
  ds_read_b64_tr_b16 a[10:11], v7 offset:1600
  ds_read_b64_tr_b16 a[12:13], v7 offset:12288
  ds_read_b64_tr_b16 a[14:15], v7 offset:13824
  ds_read_b64_tr_b16 a[16:17], v7 offset:12320
  ds_read_b64_tr_b16 a[18:19], v7 offset:13856
  ds_read_b64_tr_b16 a[20:21], v7 offset:12352
  ds_read_b64_tr_b16 a[22:23], v7 offset:13888
  ds_read_b64_tr_b16 a[24:25], v7 offset:24576
  ds_read_b64_tr_b16 a[26:27], v7 offset:26112
  ds_read_b64_tr_b16 a[28:29], v7 offset:24608
  ds_read_b64_tr_b16 a[30:31], v7 offset:26144
  ds_read_b64_tr_b16 a[32:33], v7 offset:24640
  ds_read_b64_tr_b16 a[34:35], v7 offset:26176
  ds_read_b64_tr_b16 a[36:37], v7 offset:36864
  ds_read_b64_tr_b16 a[38:39], v7 offset:38400
  ds_read_b64_tr_b16 a[40:41], v7 offset:36896
  ds_read_b64_tr_b16 a[42:43], v7 offset:38432
  ds_read_b64_tr_b16 a[44:45], v7 offset:36928
  ds_read_b64_tr_b16 a[46:47], v7 offset:38464
  s_waitcnt lgkmcnt(0)
  s_barrier
  s_mul_i32 s21, s20, 393216
  s_add_u32 s21, s21, 3145728
  s_add_u32 s21, s21, s44
  s_mul_i32 s22, s20, 12288
  s_add_u32 s22, s22, 0
  s_add_u32 m0, s22, 0
  s_nop 0
  buffer_load_dwordx4 v4, s[12:15], s21 offen lds
  s_add_u32 m0, s22, 1024
  s_nop 0
  buffer_load_dwordx4 v5, s[12:15], s21 offen lds
  s_add_u32 m0, s22, 2048
  s_nop 0
  buffer_load_dwordx4 v6, s[12:15], s21 offen lds
  s_mul_i32 s21, s20, 393216
  s_add_u32 s21, s21, 3244032
  s_add_u32 s21, s21, s44
  s_mul_i32 s22, s20, 12288
  s_add_u32 s22, s22, 3072
  s_add_u32 m0, s22, 0
  s_nop 0
  buffer_load_dwordx4 v4, s[12:15], s21 offen lds
  s_add_u32 m0, s22, 1024
  s_nop 0
  buffer_load_dwordx4 v5, s[12:15], s21 offen lds
  s_add_u32 m0, s22, 2048
  s_nop 0
  buffer_load_dwordx4 v6, s[12:15], s21 offen lds
  s_mul_i32 s21, s20, 393216
  s_add_u32 s21, s21, 3342336
  s_add_u32 s21, s21, s44
  s_mul_i32 s22, s20, 12288
  s_add_u32 s22, s22, 6144
  s_add_u32 m0, s22, 0
  s_nop 0
  buffer_load_dwordx4 v4, s[12:15], s21 offen lds
  s_add_u32 m0, s22, 1024
  s_nop 0
  buffer_load_dwordx4 v5, s[12:15], s21 offen lds
  s_add_u32 m0, s22, 2048
  s_nop 0
  buffer_load_dwordx4 v6, s[12:15], s21 offen lds
  s_mul_i32 s21, s20, 393216
  s_add_u32 s21, s21, 3440640
  s_add_u32 s21, s21, s44
  s_mul_i32 s22, s20, 12288
  s_add_u32 s22, s22, 9216
  s_add_u32 m0, s22, 0
  s_nop 0
  buffer_load_dwordx4 v4, s[12:15], s21 offen lds
  s_add_u32 m0, s22, 1024
  s_nop 0
  buffer_load_dwordx4 v5, s[12:15], s21 offen lds
  s_add_u32 m0, s22, 2048
  s_nop 0
  buffer_load_dwordx4 v6, s[12:15], s21 offen lds
  s_waitcnt vmcnt(12)
  s_barrier
  ds_read_b64_tr_b16 a[48:49], v8 offset:0
  ds_read_b64_tr_b16 a[50:51], v8 offset:1536
  ds_read_b64_tr_b16 a[52:53], v8 offset:32
  ds_read_b64_tr_b16 a[54:55], v8 offset:1568
  ds_read_b64_tr_b16 a[56:57], v8 offset:64
  ds_read_b64_tr_b16 a[58:59], v8 offset:1600
  ds_read_b64_tr_b16 a[60:61], v8 offset:12288
  ds_read_b64_tr_b16 a[62:63], v8 offset:13824
  ds_read_b64_tr_b16 a[64:65], v8 offset:12320
  ds_read_b64_tr_b16 a[66:67], v8 offset:13856
  ds_read_b64_tr_b16 a[68:69], v8 offset:12352
  ds_read_b64_tr_b16 a[70:71], v8 offset:13888
  ds_read_b64_tr_b16 a[72:73], v8 offset:24576
  ds_read_b64_tr_b16 a[74:75], v8 offset:26112
  ds_read_b64_tr_b16 a[76:77], v8 offset:24608
  ds_read_b64_tr_b16 a[78:79], v8 offset:26144
  ds_read_b64_tr_b16 a[80:81], v8 offset:24640
  ds_read_b64_tr_b16 a[82:83], v8 offset:26176
  ds_read_b64_tr_b16 a[84:85], v8 offset:36864
  ds_read_b64_tr_b16 a[86:87], v8 offset:38400
  ds_read_b64_tr_b16 a[88:89], v8 offset:36896
  ds_read_b64_tr_b16 a[90:91], v8 offset:38432
  ds_read_b64_tr_b16 a[92:93], v8 offset:36928
  ds_read_b64_tr_b16 a[94:95], v8 offset:38464
  s_waitcnt lgkmcnt(0)
  s_barrier
  s_mul_i32 s21, s20, 393216
  s_add_u32 s21, s21, 4718592
  s_add_u32 s21, s21, s44
  s_mul_i32 s22, s20, 12288
  s_add_u32 s22, s22, 49152
  s_add_u32 m0, s22, 0
  s_nop 0
  buffer_load_dwordx4 v4, s[12:15], s21 offen lds
  s_add_u32 m0, s22, 1024
  s_nop 0
  buffer_load_dwordx4 v5, s[12:15], s21 offen lds
  s_add_u32 m0, s22, 2048
  s_nop 0
  buffer_load_dwordx4 v6, s[12:15], s21 offen lds
  s_mul_i32 s21, s20, 393216
  s_add_u32 s21, s21, 4816896
  s_add_u32 s21, s21, s44
  s_mul_i32 s22, s20, 12288
  s_add_u32 s22, s22, 52224
  s_add_u32 m0, s22, 0
  s_nop 0
  buffer_load_dwordx4 v4, s[12:15], s21 offen lds
  s_add_u32 m0, s22, 1024
  s_nop 0
  buffer_load_dwordx4 v5, s[12:15], s21 offen lds
  s_add_u32 m0, s22, 2048
  s_nop 0
  buffer_load_dwordx4 v6, s[12:15], s21 offen lds
  s_mul_i32 s21, s20, 393216
  s_add_u32 s21, s21, 4915200
  s_add_u32 s21, s21, s44
  s_mul_i32 s22, s20, 12288
  s_add_u32 s22, s22, 55296
  s_add_u32 m0, s22, 0
  s_nop 0
  buffer_load_dwordx4 v4, s[12:15], s21 offen lds
  s_add_u32 m0, s22, 1024
  s_nop 0
  buffer_load_dwordx4 v5, s[12:15], s21 offen lds
  s_add_u32 m0, s22, 2048
  s_nop 0
  buffer_load_dwordx4 v6, s[12:15], s21 offen lds
  s_mul_i32 s21, s20, 393216
  s_add_u32 s21, s21, 5013504
  s_add_u32 s21, s21, s44
  s_mul_i32 s22, s20, 12288
  s_add_u32 s22, s22, 58368
  s_add_u32 m0, s22, 0
  s_nop 0
  buffer_load_dwordx4 v4, s[12:15], s21 offen lds
  s_add_u32 m0, s22, 1024
  s_nop 0
  buffer_load_dwordx4 v5, s[12:15], s21 offen lds
  s_add_u32 m0, s22, 2048
  s_nop 0
  buffer_load_dwordx4 v6, s[12:15], s21 offen lds
  v_mov_b32 v29, 76
  buffer_load_dword v29, v29, s[32:35], 0 offen sc1
  v_lshlrev_b32 v28, 4, v1
  s_and_b32 s21, s3, 15
  s_lshl_b32 s21, s21, 2
  s_add_u32 s21, s21, s20
  s_lshl_b32 s21, s21, 10
  s_add_u32 s21, s21, 81920
  buffer_load_dwordx4 v[32:35], v28, s[8:11], s21 offen
  s_add_u32 s21, s21, 65536
  buffer_load_dwordx4 v[32:35], v28, s[8:11], s21 offen
  s_add_u32 s21, s21, 65536
  buffer_load_dwordx4 v[32:35], v28, s[8:11], s21 offen
  s_add_u32 s21, s21, 65536
  buffer_load_dwordx4 v[32:35], v28, s[8:11], s21 offen
  s_add_u32 s21, s21, 65536
  s_waitcnt vmcnt(12)
  s_barrier
  ds_read_b64_tr_b16 a[96:97], v7 offset:0
  ds_read_b64_tr_b16 a[98:99], v7 offset:1536
  ds_read_b64_tr_b16 a[100:101], v7 offset:32
  ds_read_b64_tr_b16 a[102:103], v7 offset:1568
  ds_read_b64_tr_b16 a[104:105], v7 offset:64
  ds_read_b64_tr_b16 a[106:107], v7 offset:1600
  ds_read_b64_tr_b16 a[108:109], v7 offset:12288
  ds_read_b64_tr_b16 a[110:111], v7 offset:13824
  ds_read_b64_tr_b16 a[112:113], v7 offset:12320
  ds_read_b64_tr_b16 a[114:115], v7 offset:13856
  ds_read_b64_tr_b16 a[116:117], v7 offset:12352
  ds_read_b64_tr_b16 a[118:119], v7 offset:13888
  ds_read_b64_tr_b16 a[120:121], v7 offset:24576
  ds_read_b64_tr_b16 a[122:123], v7 offset:26112
  ds_read_b64_tr_b16 a[124:125], v7 offset:24608
  ds_read_b64_tr_b16 a[126:127], v7 offset:26144
  ds_read_b64_tr_b16 a[128:129], v7 offset:24640
  ds_read_b64_tr_b16 a[130:131], v7 offset:26176
  ds_read_b64_tr_b16 a[132:133], v7 offset:36864
  ds_read_b64_tr_b16 a[134:135], v7 offset:38400
  ds_read_b64_tr_b16 a[136:137], v7 offset:36896
  ds_read_b64_tr_b16 a[138:139], v7 offset:38432
  ds_read_b64_tr_b16 a[140:141], v7 offset:36928
  ds_read_b64_tr_b16 a[142:143], v7 offset:38464
  s_waitcnt lgkmcnt(0)
  s_barrier
  s_mul_i32 s21, s20, 393216
  s_add_u32 s21, s21, 6291456
  s_add_u32 s21, s21, s44
  s_mul_i32 s22, s20, 12288
  s_add_u32 s22, s22, 0
  s_add_u32 m0, s22, 0
  s_nop 0
  buffer_load_dwordx4 v4, s[12:15], s21 offen lds
  s_add_u32 m0, s22, 1024
  s_nop 0
  buffer_load_dwordx4 v5, s[12:15], s21 offen lds
  s_add_u32 m0, s22, 2048
  s_nop 0
  buffer_load_dwordx4 v6, s[12:15], s21 offen lds
  s_mul_i32 s21, s20, 393216
  s_add_u32 s21, s21, 6389760
  s_add_u32 s21, s21, s44
  s_mul_i32 s22, s20, 12288
  s_add_u32 s22, s22, 3072
  s_add_u32 m0, s22, 0
  s_nop 0
  buffer_load_dwordx4 v4, s[12:15], s21 offen lds
  s_add_u32 m0, s22, 1024
  s_nop 0
  buffer_load_dwordx4 v5, s[12:15], s21 offen lds
  s_add_u32 m0, s22, 2048
  s_nop 0
  buffer_load_dwordx4 v6, s[12:15], s21 offen lds
  s_mul_i32 s21, s20, 393216
  s_add_u32 s21, s21, 6488064
  s_add_u32 s21, s21, s44
  s_mul_i32 s22, s20, 12288
  s_add_u32 s22, s22, 6144
  s_add_u32 m0, s22, 0
  s_nop 0
  buffer_load_dwordx4 v4, s[12:15], s21 offen lds
  s_add_u32 m0, s22, 1024
  s_nop 0
  buffer_load_dwordx4 v5, s[12:15], s21 offen lds
  s_add_u32 m0, s22, 2048
  s_nop 0
  buffer_load_dwordx4 v6, s[12:15], s21 offen lds
  s_mul_i32 s21, s20, 393216
  s_add_u32 s21, s21, 6586368
  s_add_u32 s21, s21, s44
  s_mul_i32 s22, s20, 12288
  s_add_u32 s22, s22, 9216
  s_add_u32 m0, s22, 0
  s_nop 0
  buffer_load_dwordx4 v4, s[12:15], s21 offen lds
  s_add_u32 m0, s22, 1024
  s_nop 0
  buffer_load_dwordx4 v5, s[12:15], s21 offen lds
  s_add_u32 m0, s22, 2048
  s_nop 0
  buffer_load_dwordx4 v6, s[12:15], s21 offen lds
  s_waitcnt vmcnt(12)
  s_barrier
  ds_read_b64_tr_b16 a[144:145], v8 offset:0
  ds_read_b64_tr_b16 a[146:147], v8 offset:1536
  ds_read_b64_tr_b16 a[148:149], v8 offset:32
  ds_read_b64_tr_b16 a[150:151], v8 offset:1568
  ds_read_b64_tr_b16 a[152:153], v8 offset:64
  ds_read_b64_tr_b16 a[154:155], v8 offset:1600
  ds_read_b64_tr_b16 a[156:157], v8 offset:12288
  ds_read_b64_tr_b16 a[158:159], v8 offset:13824
  ds_read_b64_tr_b16 a[160:161], v8 offset:12320
  ds_read_b64_tr_b16 a[162:163], v8 offset:13856
  ds_read_b64_tr_b16 a[164:165], v8 offset:12352
  ds_read_b64_tr_b16 a[166:167], v8 offset:13888
  ds_read_b64_tr_b16 a[168:169], v8 offset:24576
  ds_read_b64_tr_b16 a[170:171], v8 offset:26112
  ds_read_b64_tr_b16 a[172:173], v8 offset:24608
  ds_read_b64_tr_b16 a[174:175], v8 offset:26144
  ds_read_b64_tr_b16 a[176:177], v8 offset:24640
  ds_read_b64_tr_b16 a[178:179], v8 offset:26176
  ds_read_b64_tr_b16 a[180:181], v8 offset:36864
  ds_read_b64_tr_b16 a[182:183], v8 offset:38400
  ds_read_b64_tr_b16 a[184:185], v8 offset:36896
  ds_read_b64_tr_b16 a[186:187], v8 offset:38432
  ds_read_b64_tr_b16 a[188:189], v8 offset:36928
  ds_read_b64_tr_b16 a[190:191], v8 offset:38464
  s_waitcnt lgkmcnt(0)
  s_barrier
  s_waitcnt vmcnt(0)
  s_barrier
  ds_read_b64_tr_b16 a[192:193], v7 offset:0
  ds_read_b64_tr_b16 a[194:195], v7 offset:1536
  ds_read_b64_tr_b16 a[196:197], v7 offset:32
  ds_read_b64_tr_b16 a[198:199], v7 offset:1568
  ds_read_b64_tr_b16 a[200:201], v7 offset:64
  ds_read_b64_tr_b16 a[202:203], v7 offset:1600
  ds_read_b64_tr_b16 a[204:205], v7 offset:12288
  ds_read_b64_tr_b16 a[206:207], v7 offset:13824
  ds_read_b64_tr_b16 a[208:209], v7 offset:12320
  ds_read_b64_tr_b16 a[210:211], v7 offset:13856
  ds_read_b64_tr_b16 a[212:213], v7 offset:12352
  ds_read_b64_tr_b16 a[214:215], v7 offset:13888
  ds_read_b64_tr_b16 a[216:217], v7 offset:24576
  ds_read_b64_tr_b16 a[218:219], v7 offset:26112
  ds_read_b64_tr_b16 a[220:221], v7 offset:24608
  ds_read_b64_tr_b16 a[222:223], v7 offset:26144
  ds_read_b64_tr_b16 a[224:225], v7 offset:24640
  ds_read_b64_tr_b16 a[226:227], v7 offset:26176
  ds_read_b64_tr_b16 a[228:229], v7 offset:36864
  ds_read_b64_tr_b16 a[230:231], v7 offset:38400
  ds_read_b64_tr_b16 a[232:233], v7 offset:36896
  ds_read_b64_tr_b16 a[234:235], v7 offset:38432
  ds_read_b64_tr_b16 a[236:237], v7 offset:36928
  ds_read_b64_tr_b16 a[238:239], v7 offset:38464
  s_waitcnt lgkmcnt(0)
  s_barrier
  v_and_b32 v6, 7, v2
  v_add_u32 v4, 0, v3
  v_xor_b32 v4, v4, v6
  v_lshlrev_b32 v4, 4, v4
  v_lshl_add_u32 v14, v2, 7, v4
  v_add_u32 v16, 65536, v14
  v_add_u32 v18, 131072, v14
  v_add_u32 v4, 4, v3
  v_xor_b32 v4, v4, v6
  v_lshlrev_b32 v4, 4, v4
  v_lshl_add_u32 v15, v2, 7, v4
  v_add_u32 v17, 65536, v15
  v_add_u32 v19, 131072, v15
  v_lshlrev_b32 v26, 4, v1
  v_mov_b32 v28, 1
  v_mov_b32 v4, 0x40000000
  v_cmp_eq_u32 vcc, 0, v0
  s_nop 1
  v_cndmask_b32 v27, v4, 0, vcc
  s_mov_b32 s26, 6
  s_lshl_b32 s27, s42, 2
  s_add_u32 s27, s27, s20
  s_lshl_b32 s27, s27, 14
  s_lshl_b32 s21, s43, 13
  s_xor_b32 s27, s27, s21
  v_readfirstlane_b32 s100, v29
  s_cmp_lg_u32 s100, 0
  s_cbranch_scc1 kvz_237
  s_mov_b32 s21, 76
  v_mov_b32 v4, 0
  s_mov_b32 s101, 0
wf_238:
  buffer_load_dword v5, v4, s[32:35], s21 offen sc1
  s_add_u32 s101, s101, 1
  s_cmp_gt_u32 s101, 131072
  s_cbranch_scc1 main_end
  s_waitcnt vmcnt(0)
  v_readfirstlane_b32 s100, v5
  s_cmp_ge_u32 s100, 1
  s_cbranch_scc1 wf_239
  s_sleep 8
  s_branch wf_238
wf_239:
kvz_237:
  s_sub_u32 s80, s100, 1
  s_lshl_b32 s80, s80, 13
  s_xor_b32 s27, s27, s80
  s_lshl_b32 s60, s40, 7
  s_add_u32 s60, s60, 28672
  s_xor_b32 s60, s60, s80
  s_mov_b32 s48, 0x40000000
  s_mov_b32 s61, 0x40000000
  s_waitcnt vmcnt(14)
  s_barrier
  ds_read_b128 v[160:163], v16 offset:32768
  ds_read_b128 v[164:167], v16 offset:34816
  ds_read_b128 v[168:171], v16 offset:36864
  ds_read_b128 v[172:175], v16 offset:38912
  s_waitcnt lgkmcnt(3)
  .p2align 3
kvm_240:
  v_mfma_f32_16x16x32_bf16 v[64:67], a[0:3], v[160:163], 0
  s_xor_b32 s29, s48, 0
  ds_read_b128 v[176:179], v17 offset:32768
  v_cvt_pk_bf16_f32 v204, v88, v89
  v_mfma_f32_16x16x32_bf16 v[68:71], a[4:7], v[160:163], 0
  v_cvt_pk_bf16_f32 v205, v90, v91
  v_cvt_pk_bf16_f32 v206, v92, v93
  v_mfma_f32_16x16x32_bf16 v[72:75], a[8:11], v[160:163], 0
  s_waitcnt lgkmcnt(3)
  v_cvt_pk_bf16_f32 v207, v94, v95
  v_cvt_pk_bf16_f32 v212, v96, v97
  v_mfma_f32_16x16x32_bf16 v[76:79], a[0:3], v[164:167], 0
  ds_read_b128 v[180:183], v17 offset:34816
  v_cvt_pk_bf16_f32 v213, v98, v99
  v_mfma_f32_16x16x32_bf16 v[80:83], a[4:7], v[164:167], 0
  v_cvt_pk_bf16_f32 v208, v100, v101
  v_cvt_pk_bf16_f32 v209, v102, v103
  v_mfma_f32_16x16x32_bf16 v[84:87], a[8:11], v[164:167], 0
  s_waitcnt lgkmcnt(3)
  v_cvt_pk_bf16_f32 v210, v104, v105
  v_cvt_pk_bf16_f32 v211, v106, v107
  v_mfma_f32_16x16x32_bf16 v[88:91], a[0:3], v[168:171], 0
  ds_read_b128 v[184:187], v17 offset:36864
  v_cvt_pk_bf16_f32 v214, v108, v109
  v_mfma_f32_16x16x32_bf16 v[92:95], a[4:7], v[168:171], 0
  s_add_u32 m0, s31, 81920
  v_cvt_pk_bf16_f32 v215, v110, v111
  buffer_store_dwordx4 v[192:195], v26, s[16:19], s29 offen offset:0 sc1
  v_mfma_f32_16x16x32_bf16 v[96:99], a[8:11], v[168:171], 0
  s_waitcnt lgkmcnt(3)
  buffer_load_dwordx4 v10, s[8:11], s30 offen lds
  v_mfma_f32_16x16x32_bf16 v[100:103], a[0:3], v[172:175], 0
  ds_read_b128 v[188:191], v17 offset:38912
  v_mfma_f32_16x16x32_bf16 v[104:107], a[4:7], v[172:175], 0
  v_mfma_f32_16x16x32_bf16 v[108:111], a[8:11], v[172:175], 0
  s_waitcnt lgkmcnt(3)
  buffer_store_dwordx4 v[196:199], v26, s[16:19], s29 offen offset:1024 sc1
  v_mfma_f32_16x16x32_bf16 v[64:67], a[12:15], v[176:179], v[64:67]
  s_waitcnt vmcnt(15)
  s_barrier
  ds_read_b128 v[160:163], v16 offset:40960
  v_mfma_f32_16x16x32_bf16 v[68:71], a[16:19], v[176:179], v[68:71]
  s_add_u32 m0, s31, 82944
  v_mfma_f32_16x16x32_bf16 v[72:75], a[20:23], v[176:179], v[72:75]
  s_waitcnt lgkmcnt(3)
  buffer_load_dwordx4 v11, s[8:11], s30 offen lds
  v_mfma_f32_16x16x32_bf16 v[76:79], a[12:15], v[180:183], v[76:79]
  s_add_u32 s30, s30, 128
  ds_read_b128 v[164:167], v16 offset:43008
  buffer_store_dwordx4 v[200:203], v26, s[16:19], s29 offen offset:2048 sc1
  v_mfma_f32_16x16x32_bf16 v[80:83], a[16:19], v[180:183], v[80:83]
  v_mfma_f32_16x16x32_bf16 v[84:87], a[20:23], v[180:183], v[84:87]
  s_waitcnt lgkmcnt(3)
  v_mfma_f32_16x16x32_bf16 v[88:91], a[12:15], v[184:187], v[88:91]
  s_xor_b32 s29, s48, 2105344
  ds_read_b128 v[168:171], v16 offset:45056
  v_mfma_f32_16x16x32_bf16 v[92:95], a[16:19], v[184:187], v[92:95]
  buffer_store_dwordx4 v[204:207], v26, s[16:19], s29 offen offset:0 sc1
  v_mfma_f32_16x16x32_bf16 v[96:99], a[20:23], v[184:187], v[96:99]
  s_waitcnt lgkmcnt(3)
  v_mfma_f32_16x16x32_bf16 v[100:103], a[12:15], v[188:191], v[100:103]
  ds_read_b128 v[172:175], v16 offset:47104
  v_mfma_f32_16x16x32_bf16 v[104:107], a[16:19], v[188:191], v[104:107]
  v_mfma_f32_16x16x32_bf16 v[108:111], a[20:23], v[188:191], v[108:111]
  s_waitcnt lgkmcnt(3)
  buffer_store_dwordx4 v[208:211], v26, s[16:19], s29 offen offset:1024 sc1
  v_mfma_f32_16x16x32_bf16 v[64:67], a[24:27], v[160:163], v[64:67]
  ds_read_b128 v[176:179], v17 offset:40960
  v_mfma_f32_16x16x32_bf16 v[68:71], a[28:31], v[160:163], v[68:71]
  s_add_u32 m0, s31, 90112
  v_mfma_f32_16x16x32_bf16 v[72:75], a[32:35], v[160:163], v[72:75]
  s_waitcnt lgkmcnt(3)
  buffer_load_dwordx4 v10, s[8:11], s30 offen lds
  v_mfma_f32_16x16x32_bf16 v[76:79], a[24:27], v[164:167], v[76:79]
  ds_read_b128 v[180:183], v17 offset:43008
  buffer_store_dwordx4 v[212:215], v26, s[16:19], s29 offen offset:2048 sc1
  v_mfma_f32_16x16x32_bf16 v[80:83], a[28:31], v[164:167], v[80:83]
  v_mfma_f32_16x16x32_bf16 v[84:87], a[32:35], v[164:167], v[84:87]
  s_waitcnt lgkmcnt(3)
  v_mfma_f32_16x16x32_bf16 v[88:91], a[24:27], v[168:171], v[88:91]
  ds_read_b128 v[184:187], v17 offset:45056
  v_mfma_f32_16x16x32_bf16 v[92:95], a[28:31], v[168:171], v[92:95]
  s_add_u32 m0, s31, 91136
  v_mfma_f32_16x16x32_bf16 v[96:99], a[32:35], v[168:171], v[96:99]
  s_waitcnt lgkmcnt(3)
  buffer_load_dwordx4 v11, s[8:11], s30 offen lds
  v_mfma_f32_16x16x32_bf16 v[100:103], a[24:27], v[172:175], v[100:103]
  s_add_u32 s30, s30, s25
  ds_read_b128 v[188:191], v17 offset:47104
  v_mfma_f32_16x16x32_bf16 v[104:107], a[28:31], v[172:175], v[104:107]
  v_mfma_f32_16x16x32_bf16 v[108:111], a[32:35], v[172:175], v[108:111]
  s_waitcnt lgkmcnt(3)
  v_mfma_f32_16x16x32_bf16 v[64:67], a[36:39], v[176:179], v[64:67]
  s_waitcnt vmcnt(20)
  s_barrier
  ds_read_b128 v[160:163], v16 offset:49152
  v_mfma_f32_16x16x32_bf16 v[68:71], a[40:43], v[176:179], v[68:71]
  v_mfma_f32_16x16x32_bf16 v[72:75], a[44:47], v[176:179], v[72:75]
  s_waitcnt lgkmcnt(3)
  v_mfma_f32_16x16x32_bf16 v[76:79], a[36:39], v[180:183], v[76:79]
  ds_read_b128 v[164:167], v16 offset:51200
  v_mfma_f32_16x16x32_bf16 v[80:83], a[40:43], v[180:183], v[80:83]
  v_mfma_f32_16x16x32_bf16 v[84:87], a[44:47], v[180:183], v[84:87]
  s_waitcnt lgkmcnt(3)
  v_mfma_f32_16x16x32_bf16 v[88:91], a[36:39], v[184:187], v[88:91]
  ds_read_b128 v[168:171], v16 offset:53248
  v_mfma_f32_16x16x32_bf16 v[92:95], a[40:43], v[184:187], v[92:95]
  v_mfma_f32_16x16x32_bf16 v[96:99], a[44:47], v[184:187], v[96:99]
  s_waitcnt lgkmcnt(3)
  v_mfma_f32_16x16x32_bf16 v[100:103], a[36:39], v[188:191], v[100:103]
  ds_read_b128 v[172:175], v16 offset:55296
  v_mfma_f32_16x16x32_bf16 v[104:107], a[40:43], v[188:191], v[104:107]
  v_mfma_f32_16x16x32_bf16 v[108:111], a[44:47], v[188:191], v[108:111]
  s_waitcnt lgkmcnt(3)
  v_mfma_f32_16x16x32_bf16 v[64:67], a[48:51], v[160:163], v[64:67]
  ds_read_b128 v[176:179], v17 offset:49152
  v_mfma_f32_16x16x32_bf16 v[68:71], a[52:55], v[160:163], v[68:71]
  s_add_u32 m0, s31, 98304
  v_mfma_f32_16x16x32_bf16 v[72:75], a[56:59], v[160:163], v[72:75]
  s_waitcnt lgkmcnt(3)
  buffer_load_dwordx4 v10, s[8:11], s30 offen lds
  v_mfma_f32_16x16x32_bf16 v[76:79], a[48:51], v[164:167], v[76:79]
  ds_read_b128 v[180:183], v17 offset:51200
  v_mfma_f32_16x16x32_bf16 v[80:83], a[52:55], v[164:167], v[80:83]
  v_mfma_f32_16x16x32_bf16 v[84:87], a[56:59], v[164:167], v[84:87]
  s_waitcnt lgkmcnt(3)
  v_mfma_f32_16x16x32_bf16 v[88:91], a[48:51], v[168:171], v[88:91]
  ds_read_b128 v[184:187], v17 offset:53248
  v_mfma_f32_16x16x32_bf16 v[92:95], a[52:55], v[168:171], v[92:95]
  s_add_u32 m0, s31, 99328
  v_mfma_f32_16x16x32_bf16 v[96:99], a[56:59], v[168:171], v[96:99]
  s_waitcnt lgkmcnt(3)
  buffer_load_dwordx4 v11, s[8:11], s30 offen lds
  v_mfma_f32_16x16x32_bf16 v[100:103], a[48:51], v[172:175], v[100:103]
  s_add_u32 s30, s30, 128
  ds_read_b128 v[188:191], v17 offset:55296
  v_mfma_f32_16x16x32_bf16 v[104:107], a[52:55], v[172:175], v[104:107]
  v_mfma_f32_16x16x32_bf16 v[108:111], a[56:59], v[172:175], v[108:111]
  s_waitcnt lgkmcnt(3)
  v_mfma_f32_16x16x32_bf16 v[64:67], a[60:63], v[176:179], v[64:67]
  s_waitcnt vmcnt(20)
  s_barrier
  ds_read_b128 v[160:163], v16 offset:57344
  v_mfma_f32_16x16x32_bf16 v[68:71], a[64:67], v[176:179], v[68:71]
  v_mfma_f32_16x16x32_bf16 v[72:75], a[68:71], v[176:179], v[72:75]
  s_waitcnt lgkmcnt(3)
  v_mfma_f32_16x16x32_bf16 v[76:79], a[60:63], v[180:183], v[76:79]
  ds_read_b128 v[164:167], v16 offset:59392
  v_mfma_f32_16x16x32_bf16 v[80:83], a[64:67], v[180:183], v[80:83]
  v_mfma_f32_16x16x32_bf16 v[84:87], a[68:71], v[180:183], v[84:87]
  s_waitcnt lgkmcnt(3)
  v_mfma_f32_16x16x32_bf16 v[88:91], a[60:63], v[184:187], v[88:91]
  ds_read_b128 v[168:171], v16 offset:61440
  v_mfma_f32_16x16x32_bf16 v[92:95], a[64:67], v[184:187], v[92:95]
  v_mfma_f32_16x16x32_bf16 v[96:99], a[68:71], v[184:187], v[96:99]
  s_waitcnt lgkmcnt(3)
  v_mfma_f32_16x16x32_bf16 v[100:103], a[60:63], v[188:191], v[100:103]
  ds_read_b128 v[172:175], v16 offset:63488
  v_mfma_f32_16x16x32_bf16 v[104:107], a[64:67], v[188:191], v[104:107]
  v_mfma_f32_16x16x32_bf16 v[108:111], a[68:71], v[188:191], v[108:111]
  s_waitcnt lgkmcnt(3)
  v_mfma_f32_16x16x32_bf16 v[64:67], a[72:75], v[160:163], v[64:67]
  ds_read_b128 v[176:179], v17 offset:57344
  v_mfma_f32_16x16x32_bf16 v[68:71], a[76:79], v[160:163], v[68:71]
  s_add_u32 m0, s31, 106496
  v_mfma_f32_16x16x32_bf16 v[72:75], a[80:83], v[160:163], v[72:75]
  s_waitcnt lgkmcnt(3)
  buffer_load_dwordx4 v10, s[8:11], s30 offen lds
  v_mfma_f32_16x16x32_bf16 v[76:79], a[72:75], v[164:167], v[76:79]
  ds_read_b128 v[180:183], v17 offset:59392
  v_mfma_f32_16x16x32_bf16 v[80:83], a[76:79], v[164:167], v[80:83]
  v_mfma_f32_16x16x32_bf16 v[84:87], a[80:83], v[164:167], v[84:87]
  s_waitcnt lgkmcnt(3)
  v_mfma_f32_16x16x32_bf16 v[88:91], a[72:75], v[168:171], v[88:91]
  ds_read_b128 v[184:187], v17 offset:61440
  v_mfma_f32_16x16x32_bf16 v[92:95], a[76:79], v[168:171], v[92:95]
  s_add_u32 m0, s31, 107520
  v_mfma_f32_16x16x32_bf16 v[96:99], a[80:83], v[168:171], v[96:99]
  s_waitcnt lgkmcnt(3)
  buffer_load_dwordx4 v11, s[8:11], s30 offen lds
  v_mfma_f32_16x16x32_bf16 v[100:103], a[72:75], v[172:175], v[100:103]
  s_add_u32 s30, s30, 128
  ds_read_b128 v[188:191], v17 offset:63488
  v_mfma_f32_16x16x32_bf16 v[104:107], a[76:79], v[172:175], v[104:107]
  v_mfma_f32_16x16x32_bf16 v[108:111], a[80:83], v[172:175], v[108:111]
  s_waitcnt lgkmcnt(3)
  v_mfma_f32_16x16x32_bf16 v[64:67], a[84:87], v[176:179], v[64:67]
  s_waitcnt vmcnt(5)
  s_barrier
  ds_read_b128 v[160:163], v18 offset:0
  v_mfma_f32_16x16x32_bf16 v[68:71], a[88:91], v[176:179], v[68:71]
  buffer_atomic_add v28, v27, s[72:75], s61 offen sc1
  v_mfma_f32_16x16x32_bf16 v[72:75], a[92:95], v[176:179], v[72:75]
  s_waitcnt lgkmcnt(3)
  s_mov_b32 s48, s27
  s_add_u32 s27, s27, 4194304
  v_mfma_f32_16x16x32_bf16 v[76:79], a[84:87], v[180:183], v[76:79]
  s_mov_b32 s61, s60
  ds_read_b128 v[164:167], v18 offset:2048
  s_add_u32 s60, s60, 4
  v_mfma_f32_16x16x32_bf16 v[80:83], a[88:91], v[180:183], v[80:83]
  v_mfma_f32_16x16x32_bf16 v[84:87], a[92:95], v[180:183], v[84:87]
  s_waitcnt lgkmcnt(3)
  v_mfma_f32_16x16x32_bf16 v[88:91], a[84:87], v[184:187], v[88:91]
  ds_read_b128 v[168:171], v18 offset:4096
  v_mfma_f32_16x16x32_bf16 v[92:95], a[88:91], v[184:187], v[92:95]
  v_mfma_f32_16x16x32_bf16 v[96:99], a[92:95], v[184:187], v[96:99]
  s_waitcnt lgkmcnt(3)
  v_mfma_f32_16x16x32_bf16 v[100:103], a[84:87], v[188:191], v[100:103]
  ds_read_b128 v[172:175], v18 offset:6144
  v_mfma_f32_16x16x32_bf16 v[104:107], a[88:91], v[188:191], v[104:107]
  v_mfma_f32_16x16x32_bf16 v[108:111], a[92:95], v[188:191], v[108:111]
  s_waitcnt lgkmcnt(3)
  v_mfma_f32_16x16x32_bf16 v[64:67], a[96:99], v[160:163], v[64:67]
  ds_read_b128 v[176:179], v19 offset:0
  v_mfma_f32_16x16x32_bf16 v[68:71], a[100:103], v[160:163], v[68:71]
  s_add_u32 m0, s31, 114688
  v_mfma_f32_16x16x32_bf16 v[72:75], a[104:107], v[160:163], v[72:75]
  s_waitcnt lgkmcnt(3)
  buffer_load_dwordx4 v10, s[8:11], s30 offen lds
  v_mfma_f32_16x16x32_bf16 v[76:79], a[96:99], v[164:167], v[76:79]
  ds_read_b128 v[180:183], v19 offset:2048
  v_mfma_f32_16x16x32_bf16 v[80:83], a[100:103], v[164:167], v[80:83]
  v_mfma_f32_16x16x32_bf16 v[84:87], a[104:107], v[164:167], v[84:87]
  s_waitcnt lgkmcnt(3)
  v_mfma_f32_16x16x32_bf16 v[88:91], a[96:99], v[168:171], v[88:91]
  ds_read_b128 v[184:187], v19 offset:4096
  v_mfma_f32_16x16x32_bf16 v[92:95], a[100:103], v[168:171], v[92:95]
  s_add_u32 m0, s31, 115712
  v_mfma_f32_16x16x32_bf16 v[96:99], a[104:107], v[168:171], v[96:99]
  s_waitcnt lgkmcnt(3)
  buffer_load_dwordx4 v11, s[8:11], s30 offen lds
  v_mfma_f32_16x16x32_bf16 v[100:103], a[96:99], v[172:175], v[100:103]
  s_add_u32 s30, s30, 128
  ds_read_b128 v[188:191], v19 offset:6144
  v_mfma_f32_16x16x32_bf16 v[104:107], a[100:103], v[172:175], v[104:107]
  v_mfma_f32_16x16x32_bf16 v[108:111], a[104:107], v[172:175], v[108:111]
  s_waitcnt lgkmcnt(3)
  v_mfma_f32_16x16x32_bf16 v[64:67], a[108:111], v[176:179], v[64:67]
  s_waitcnt vmcnt(21)
  s_barrier
  ds_read_b128 v[160:163], v18 offset:8192
  v_mfma_f32_16x16x32_bf16 v[68:71], a[112:115], v[176:179], v[68:71]
  v_mfma_f32_16x16x32_bf16 v[72:75], a[116:119], v[176:179], v[72:75]
  s_waitcnt lgkmcnt(3)
  v_mfma_f32_16x16x32_bf16 v[76:79], a[108:111], v[180:183], v[76:79]
  ds_read_b128 v[164:167], v18 offset:10240
  v_mfma_f32_16x16x32_bf16 v[80:83], a[112:115], v[180:183], v[80:83]
  v_mfma_f32_16x16x32_bf16 v[84:87], a[116:119], v[180:183], v[84:87]
  s_waitcnt lgkmcnt(3)
  v_mfma_f32_16x16x32_bf16 v[88:91], a[108:111], v[184:187], v[88:91]
  ds_read_b128 v[168:171], v18 offset:12288
  v_mfma_f32_16x16x32_bf16 v[92:95], a[112:115], v[184:187], v[92:95]
  v_mfma_f32_16x16x32_bf16 v[96:99], a[116:119], v[184:187], v[96:99]
  s_waitcnt lgkmcnt(3)
  v_mfma_f32_16x16x32_bf16 v[100:103], a[108:111], v[188:191], v[100:103]
  ds_read_b128 v[172:175], v18 offset:14336
  v_mfma_f32_16x16x32_bf16 v[104:107], a[112:115], v[188:191], v[104:107]
  v_mfma_f32_16x16x32_bf16 v[108:111], a[116:119], v[188:191], v[108:111]
  s_waitcnt lgkmcnt(3)
  v_mfma_f32_16x16x32_bf16 v[64:67], a[120:123], v[160:163], v[64:67]
  ds_read_b128 v[176:179], v19 offset:8192
  v_mfma_f32_16x16x32_bf16 v[68:71], a[124:127], v[160:163], v[68:71]
  s_add_u32 m0, s31, 122880
  v_mfma_f32_16x16x32_bf16 v[72:75], a[128:131], v[160:163], v[72:75]
  s_waitcnt lgkmcnt(3)
  buffer_load_dwordx4 v10, s[8:11], s30 offen lds
  v_mfma_f32_16x16x32_bf16 v[76:79], a[120:123], v[164:167], v[76:79]
  ds_read_b128 v[180:183], v19 offset:10240
  v_mfma_f32_16x16x32_bf16 v[80:83], a[124:127], v[164:167], v[80:83]
  v_mfma_f32_16x16x32_bf16 v[84:87], a[128:131], v[164:167], v[84:87]
  s_waitcnt lgkmcnt(3)
  v_mfma_f32_16x16x32_bf16 v[88:91], a[120:123], v[168:171], v[88:91]
  ds_read_b128 v[184:187], v19 offset:12288
  v_mfma_f32_16x16x32_bf16 v[92:95], a[124:127], v[168:171], v[92:95]
  s_add_u32 m0, s31, 123904
  v_mfma_f32_16x16x32_bf16 v[96:99], a[128:131], v[168:171], v[96:99]
  s_waitcnt lgkmcnt(3)
  buffer_load_dwordx4 v11, s[8:11], s30 offen lds
  v_mfma_f32_16x16x32_bf16 v[100:103], a[120:123], v[172:175], v[100:103]
  s_add_u32 s30, s30, 128
  ds_read_b128 v[188:191], v19 offset:14336
  v_mfma_f32_16x16x32_bf16 v[104:107], a[124:127], v[172:175], v[104:107]
  v_mfma_f32_16x16x32_bf16 v[108:111], a[128:131], v[172:175], v[108:111]
  s_waitcnt lgkmcnt(3)
  v_mfma_f32_16x16x32_bf16 v[64:67], a[132:135], v[176:179], v[64:67]
  s_waitcnt vmcnt(21)
  s_barrier
  ds_read_b128 v[160:163], v18 offset:16384
  v_mfma_f32_16x16x32_bf16 v[68:71], a[136:139], v[176:179], v[68:71]
  v_mfma_f32_16x16x32_bf16 v[72:75], a[140:143], v[176:179], v[72:75]
  s_waitcnt lgkmcnt(3)
  v_mfma_f32_16x16x32_bf16 v[76:79], a[132:135], v[180:183], v[76:79]
  ds_read_b128 v[164:167], v18 offset:18432
  v_mfma_f32_16x16x32_bf16 v[80:83], a[136:139], v[180:183], v[80:83]
  v_mfma_f32_16x16x32_bf16 v[84:87], a[140:143], v[180:183], v[84:87]
  s_waitcnt lgkmcnt(3)
  v_mfma_f32_16x16x32_bf16 v[88:91], a[132:135], v[184:187], v[88:91]
  ds_read_b128 v[168:171], v18 offset:20480
  v_mfma_f32_16x16x32_bf16 v[92:95], a[136:139], v[184:187], v[92:95]
  v_mfma_f32_16x16x32_bf16 v[96:99], a[140:143], v[184:187], v[96:99]
  s_waitcnt lgkmcnt(3)
  v_mfma_f32_16x16x32_bf16 v[100:103], a[132:135], v[188:191], v[100:103]
  ds_read_b128 v[172:175], v18 offset:22528
  v_mfma_f32_16x16x32_bf16 v[104:107], a[136:139], v[188:191], v[104:107]
  v_mfma_f32_16x16x32_bf16 v[108:111], a[140:143], v[188:191], v[108:111]
  s_waitcnt lgkmcnt(3)
  v_mfma_f32_16x16x32_bf16 v[64:67], a[144:147], v[160:163], v[64:67]
  ds_read_b128 v[176:179], v19 offset:16384
  v_mfma_f32_16x16x32_bf16 v[68:71], a[148:151], v[160:163], v[68:71]
  s_add_u32 m0, s31, 131072
  v_mfma_f32_16x16x32_bf16 v[72:75], a[152:155], v[160:163], v[72:75]
  s_waitcnt lgkmcnt(3)
  buffer_load_dwordx4 v10, s[8:11], s30 offen lds
  v_mfma_f32_16x16x32_bf16 v[76:79], a[144:147], v[164:167], v[76:79]
  ds_read_b128 v[180:183], v19 offset:18432
  v_mfma_f32_16x16x32_bf16 v[80:83], a[148:151], v[164:167], v[80:83]
  v_mfma_f32_16x16x32_bf16 v[84:87], a[152:155], v[164:167], v[84:87]
  s_waitcnt lgkmcnt(3)
  v_mfma_f32_16x16x32_bf16 v[88:91], a[144:147], v[168:171], v[88:91]
  ds_read_b128 v[184:187], v19 offset:20480
  v_mfma_f32_16x16x32_bf16 v[92:95], a[148:151], v[168:171], v[92:95]
  s_add_u32 m0, s31, 132096
  v_mfma_f32_16x16x32_bf16 v[96:99], a[152:155], v[168:171], v[96:99]
  s_waitcnt lgkmcnt(3)
  buffer_load_dwordx4 v11, s[8:11], s30 offen lds
  v_mfma_f32_16x16x32_bf16 v[100:103], a[144:147], v[172:175], v[100:103]
  s_add_u32 s30, s30, 128
  ds_read_b128 v[188:191], v19 offset:22528
  v_mfma_f32_16x16x32_bf16 v[104:107], a[148:151], v[172:175], v[104:107]
  v_mfma_f32_16x16x32_bf16 v[108:111], a[152:155], v[172:175], v[108:111]
  s_waitcnt lgkmcnt(3)
  v_mfma_f32_16x16x32_bf16 v[64:67], a[156:159], v[176:179], v[64:67]
  s_waitcnt vmcnt(21)
  s_barrier
  ds_read_b128 v[160:163], v18 offset:24576
  v_mfma_f32_16x16x32_bf16 v[68:71], a[160:163], v[176:179], v[68:71]
  v_mfma_f32_16x16x32_bf16 v[72:75], a[164:167], v[176:179], v[72:75]
  s_waitcnt lgkmcnt(3)
  v_mfma_f32_16x16x32_bf16 v[76:79], a[156:159], v[180:183], v[76:79]
  ds_read_b128 v[164:167], v18 offset:26624
  v_mfma_f32_16x16x32_bf16 v[80:83], a[160:163], v[180:183], v[80:83]
  v_mfma_f32_16x16x32_bf16 v[84:87], a[164:167], v[180:183], v[84:87]
  s_waitcnt lgkmcnt(3)
  v_mfma_f32_16x16x32_bf16 v[88:91], a[156:159], v[184:187], v[88:91]
  ds_read_b128 v[168:171], v18 offset:28672
  v_mfma_f32_16x16x32_bf16 v[92:95], a[160:163], v[184:187], v[92:95]
  v_mfma_f32_16x16x32_bf16 v[96:99], a[164:167], v[184:187], v[96:99]
  s_waitcnt lgkmcnt(3)
  v_mfma_f32_16x16x32_bf16 v[100:103], a[156:159], v[188:191], v[100:103]
  ds_read_b128 v[172:175], v18 offset:30720
  v_mfma_f32_16x16x32_bf16 v[104:107], a[160:163], v[188:191], v[104:107]
  v_mfma_f32_16x16x32_bf16 v[108:111], a[164:167], v[188:191], v[108:111]
  s_waitcnt lgkmcnt(3)
  v_mfma_f32_16x16x32_bf16 v[64:67], a[168:171], v[160:163], v[64:67]
  ds_read_b128 v[176:179], v19 offset:24576
  v_mfma_f32_16x16x32_bf16 v[68:71], a[172:175], v[160:163], v[68:71]
  s_add_u32 m0, s31, 139264
  v_mfma_f32_16x16x32_bf16 v[72:75], a[176:179], v[160:163], v[72:75]
  s_waitcnt lgkmcnt(3)
  buffer_load_dwordx4 v10, s[8:11], s30 offen lds
  v_mfma_f32_16x16x32_bf16 v[76:79], a[168:171], v[164:167], v[76:79]
  ds_read_b128 v[180:183], v19 offset:26624
  v_mfma_f32_16x16x32_bf16 v[80:83], a[172:175], v[164:167], v[80:83]
  v_mfma_f32_16x16x32_bf16 v[84:87], a[176:179], v[164:167], v[84:87]
  s_waitcnt lgkmcnt(3)
  v_mfma_f32_16x16x32_bf16 v[88:91], a[168:171], v[168:171], v[88:91]
  ds_read_b128 v[184:187], v19 offset:28672
  v_mfma_f32_16x16x32_bf16 v[92:95], a[172:175], v[168:171], v[92:95]
  s_add_u32 m0, s31, 140288
  v_mfma_f32_16x16x32_bf16 v[96:99], a[176:179], v[168:171], v[96:99]
  s_waitcnt lgkmcnt(3)
  buffer_load_dwordx4 v11, s[8:11], s30 offen lds
  v_mfma_f32_16x16x32_bf16 v[100:103], a[168:171], v[172:175], v[100:103]
  s_add_u32 s30, s30, 128
  ds_read_b128 v[188:191], v19 offset:30720
  v_mfma_f32_16x16x32_bf16 v[104:107], a[172:175], v[172:175], v[104:107]
  v_mfma_f32_16x16x32_bf16 v[108:111], a[176:179], v[172:175], v[108:111]
  s_waitcnt lgkmcnt(3)
  v_mfma_f32_16x16x32_bf16 v[64:67], a[180:183], v[176:179], v[64:67]
  s_waitcnt vmcnt(19)
  s_barrier
  ds_read_b128 v[160:163], v16 offset:16384
  v_mfma_f32_16x16x32_bf16 v[68:71], a[184:187], v[176:179], v[68:71]
  v_mfma_f32_16x16x32_bf16 v[72:75], a[188:191], v[176:179], v[72:75]
  s_waitcnt lgkmcnt(3)
  v_mfma_f32_16x16x32_bf16 v[76:79], a[180:183], v[180:183], v[76:79]
  ds_read_b128 v[164:167], v16 offset:18432
  v_mfma_f32_16x16x32_bf16 v[80:83], a[184:187], v[180:183], v[80:83]
  v_mfma_f32_16x16x32_bf16 v[84:87], a[188:191], v[180:183], v[84:87]
  s_waitcnt lgkmcnt(3)
  v_mfma_f32_16x16x32_bf16 v[88:91], a[180:183], v[184:187], v[88:91]
  ds_read_b128 v[168:171], v16 offset:20480
  v_mfma_f32_16x16x32_bf16 v[92:95], a[184:187], v[184:187], v[92:95]
  v_mfma_f32_16x16x32_bf16 v[96:99], a[188:191], v[184:187], v[96:99]
  s_waitcnt lgkmcnt(3)
  v_mfma_f32_16x16x32_bf16 v[100:103], a[180:183], v[188:191], v[100:103]
  ds_read_b128 v[172:175], v16 offset:22528
  v_mfma_f32_16x16x32_bf16 v[104:107], a[184:187], v[188:191], v[104:107]
  v_mfma_f32_16x16x32_bf16 v[108:111], a[188:191], v[188:191], v[108:111]
  s_waitcnt lgkmcnt(3)
  v_mfma_f32_16x16x32_bf16 v[64:67], a[192:195], v[160:163], v[64:67]
  ds_read_b128 v[176:179], v17 offset:16384
  v_mfma_f32_16x16x32_bf16 v[68:71], a[196:199], v[160:163], v[68:71]
  s_add_u32 m0, s31, 147456
  v_mfma_f32_16x16x32_bf16 v[72:75], a[200:203], v[160:163], v[72:75]
  s_waitcnt lgkmcnt(3)
  buffer_load_dwordx4 v10, s[8:11], s30 offen lds
  v_mfma_f32_16x16x32_bf16 v[76:79], a[192:195], v[164:167], v[76:79]
  ds_read_b128 v[180:183], v17 offset:18432
  v_mfma_f32_16x16x32_bf16 v[80:83], a[196:199], v[164:167], v[80:83]
  v_mfma_f32_16x16x32_bf16 v[84:87], a[200:203], v[164:167], v[84:87]
  s_waitcnt lgkmcnt(3)
  v_mfma_f32_16x16x32_bf16 v[88:91], a[192:195], v[168:171], v[88:91]
  ds_read_b128 v[184:187], v17 offset:20480
  v_mfma_f32_16x16x32_bf16 v[92:95], a[196:199], v[168:171], v[92:95]
  s_add_u32 m0, s31, 148480
  v_mfma_f32_16x16x32_bf16 v[96:99], a[200:203], v[168:171], v[96:99]
  s_waitcnt lgkmcnt(3)
  buffer_load_dwordx4 v11, s[8:11], s30 offen lds
  v_mfma_f32_16x16x32_bf16 v[100:103], a[192:195], v[172:175], v[100:103]
  s_add_u32 s30, s30, 128
  ds_read_b128 v[188:191], v17 offset:22528
  v_mfma_f32_16x16x32_bf16 v[104:107], a[196:199], v[172:175], v[104:107]
  v_mfma_f32_16x16x32_bf16 v[108:111], a[200:203], v[172:175], v[108:111]
  s_waitcnt lgkmcnt(3)
  v_mfma_f32_16x16x32_bf16 v[64:67], a[204:207], v[176:179], v[64:67]
  s_waitcnt vmcnt(15)
  s_barrier
  ds_read_b128 v[160:163], v16 offset:24576
  v_mfma_f32_16x16x32_bf16 v[68:71], a[208:211], v[176:179], v[68:71]
  v_mfma_f32_16x16x32_bf16 v[72:75], a[212:215], v[176:179], v[72:75]
  s_waitcnt lgkmcnt(3)
  v_mfma_f32_16x16x32_bf16 v[76:79], a[204:207], v[180:183], v[76:79]
  ds_read_b128 v[164:167], v16 offset:26624
  v_mfma_f32_16x16x32_bf16 v[80:83], a[208:211], v[180:183], v[80:83]
  v_mfma_f32_16x16x32_bf16 v[84:87], a[212:215], v[180:183], v[84:87]
  s_waitcnt lgkmcnt(3)
  v_mfma_f32_16x16x32_bf16 v[88:91], a[204:207], v[184:187], v[88:91]
  ds_read_b128 v[168:171], v16 offset:28672
  v_mfma_f32_16x16x32_bf16 v[92:95], a[208:211], v[184:187], v[92:95]
  v_mfma_f32_16x16x32_bf16 v[96:99], a[212:215], v[184:187], v[96:99]
  s_waitcnt lgkmcnt(3)
  v_mfma_f32_16x16x32_bf16 v[100:103], a[204:207], v[188:191], v[100:103]
  ds_read_b128 v[172:175], v16 offset:30720
  v_mfma_f32_16x16x32_bf16 v[104:107], a[208:211], v[188:191], v[104:107]
  v_mfma_f32_16x16x32_bf16 v[108:111], a[212:215], v[188:191], v[108:111]
  s_waitcnt lgkmcnt(3)
  v_mfma_f32_16x16x32_bf16 v[64:67], a[216:219], v[160:163], v[64:67]
  ds_read_b128 v[176:179], v17 offset:24576
  v_mfma_f32_16x16x32_bf16 v[68:71], a[220:223], v[160:163], v[68:71]
  s_add_u32 m0, s31, 155648
  v_mfma_f32_16x16x32_bf16 v[72:75], a[224:227], v[160:163], v[72:75]
  s_waitcnt lgkmcnt(3)
  buffer_load_dwordx4 v10, s[8:11], s30 offen lds
  v_mfma_f32_16x16x32_bf16 v[76:79], a[216:219], v[164:167], v[76:79]
  ds_read_b128 v[180:183], v17 offset:26624
  v_mfma_f32_16x16x32_bf16 v[80:83], a[220:223], v[164:167], v[80:83]
  v_mfma_f32_16x16x32_bf16 v[84:87], a[224:227], v[164:167], v[84:87]
  s_waitcnt lgkmcnt(3)
  v_mfma_f32_16x16x32_bf16 v[88:91], a[216:219], v[168:171], v[88:91]
  ds_read_b128 v[184:187], v17 offset:28672
  v_mfma_f32_16x16x32_bf16 v[92:95], a[220:223], v[168:171], v[92:95]
  s_add_u32 m0, s31, 156672
  v_mfma_f32_16x16x32_bf16 v[96:99], a[224:227], v[168:171], v[96:99]
  s_waitcnt lgkmcnt(3)
  buffer_load_dwordx4 v11, s[8:11], s30 offen lds
  v_mfma_f32_16x16x32_bf16 v[100:103], a[216:219], v[172:175], v[100:103]
  s_add_u32 s30, s30, 128
  ds_read_b128 v[188:191], v17 offset:30720
  v_mfma_f32_16x16x32_bf16 v[104:107], a[220:223], v[172:175], v[104:107]
  v_mfma_f32_16x16x32_bf16 v[108:111], a[224:227], v[172:175], v[108:111]
  s_waitcnt lgkmcnt(3)
  v_mfma_f32_16x16x32_bf16 v[64:67], a[228:231], v[176:179], v[64:67]
  s_waitcnt vmcnt(15)
  s_barrier
  ds_read_b128 v[160:163], v16 offset:32768
  v_mfma_f32_16x16x32_bf16 v[68:71], a[232:235], v[176:179], v[68:71]
  v_mfma_f32_16x16x32_bf16 v[72:75], a[236:239], v[176:179], v[72:75]
  s_waitcnt lgkmcnt(3)
  v_mfma_f32_16x16x32_bf16 v[76:79], a[228:231], v[180:183], v[76:79]
  ds_read_b128 v[164:167], v16 offset:34816
  v_cvt_pk_bf16_f32 v192, v64, v65
  v_mfma_f32_16x16x32_bf16 v[80:83], a[232:235], v[180:183], v[80:83]
  v_cvt_pk_bf16_f32 v193, v66, v67
  v_cvt_pk_bf16_f32 v194, v68, v69
  v_mfma_f32_16x16x32_bf16 v[84:87], a[236:239], v[180:183], v[84:87]
  s_waitcnt lgkmcnt(3)
  v_cvt_pk_bf16_f32 v195, v70, v71
  v_cvt_pk_bf16_f32 v200, v72, v73
  v_mfma_f32_16x16x32_bf16 v[88:91], a[228:231], v[184:187], v[88:91]
  ds_read_b128 v[168:171], v16 offset:36864
  v_cvt_pk_bf16_f32 v201, v74, v75
  v_mfma_f32_16x16x32_bf16 v[92:95], a[232:235], v[184:187], v[92:95]
  v_cvt_pk_bf16_f32 v196, v76, v77
  v_cvt_pk_bf16_f32 v197, v78, v79
  v_mfma_f32_16x16x32_bf16 v[96:99], a[236:239], v[184:187], v[96:99]
  s_waitcnt lgkmcnt(3)
  v_cvt_pk_bf16_f32 v198, v80, v81
  v_cvt_pk_bf16_f32 v199, v82, v83
  v_mfma_f32_16x16x32_bf16 v[100:103], a[228:231], v[188:191], v[100:103]
  ds_read_b128 v[172:175], v16 offset:38912
  v_cvt_pk_bf16_f32 v202, v84, v85
  v_mfma_f32_16x16x32_bf16 v[104:107], a[232:235], v[188:191], v[104:107]
  s_sub_u32 s26, s26, 1
  s_cmp_gt_u32 s26, 0
  v_cvt_pk_bf16_f32 v203, v86, v87
  v_mfma_f32_16x16x32_bf16 v[108:111], a[236:239], v[188:191], v[108:111]
  s_waitcnt lgkmcnt(3)
  s_cbranch_scc1 kvm_240
  s_nop 7
  v_cvt_pk_bf16_f32 v204, v88, v89
  v_cvt_pk_bf16_f32 v205, v90, v91
  v_cvt_pk_bf16_f32 v206, v92, v93
  v_cvt_pk_bf16_f32 v207, v94, v95
  v_cvt_pk_bf16_f32 v212, v96, v97
  v_cvt_pk_bf16_f32 v213, v98, v99
  v_cvt_pk_bf16_f32 v208, v100, v101
  v_cvt_pk_bf16_f32 v209, v102, v103
  v_cvt_pk_bf16_f32 v210, v104, v105
  v_cvt_pk_bf16_f32 v211, v106, v107
  v_cvt_pk_bf16_f32 v214, v108, v109
  v_cvt_pk_bf16_f32 v215, v110, v111
  s_xor_b32 s29, s48, 0
  buffer_store_dwordx4 v[192:195], v26, s[16:19], s29 offen offset:0 sc1
  buffer_store_dwordx4 v[196:199], v26, s[16:19], s29 offen offset:1024 sc1
  buffer_store_dwordx4 v[200:203], v26, s[16:19], s29 offen offset:2048 sc1
  s_xor_b32 s29, s48, 2105344
  buffer_store_dwordx4 v[204:207], v26, s[16:19], s29 offen offset:0 sc1
  buffer_store_dwordx4 v[208:211], v26, s[16:19], s29 offen offset:1024 sc1
  buffer_store_dwordx4 v[212:215], v26, s[16:19], s29 offen offset:2048 sc1
  s_mov_b32 s30, 491520
  s_mov_b32 s25, 162688
  v_lshrrev_b32 v4, 3, v1
  v_and_b32 v5, 7, v1
  v_xor_b32 v5, v5, v4
  s_mul_i32 s21, s20, 32
  v_add_u32 v4, s21, v4
  v_mul_u32_u24 v4, 1280, v4
  v_lshl_add_u32 v10, v5, 4, v4
  s_mul_i32 s31, s20, 4096
  v_add_u32 v11, 10240, v10
  v_add_u32 v12, 20480, v10
  v_add_u32 v13, 30720, v10
  s_add_u32 m0, s31, 0
  s_nop 0
  buffer_load_dwordx4 v10, s[8:11], s30 offen lds
  s_add_u32 m0, s31, 1024
  s_nop 0
  buffer_load_dwordx4 v11, s[8:11], s30 offen lds
  s_add_u32 m0, s31, 2048
  s_nop 0
  buffer_load_dwordx4 v12, s[8:11], s30 offen lds
  s_add_u32 m0, s31, 3072
  s_nop 0
  buffer_load_dwordx4 v13, s[8:11], s30 offen lds
  s_add_u32 s30, s30, 128
  s_add_u32 m0, s31, 16384
  s_nop 0
  buffer_load_dwordx4 v10, s[8:11], s30 offen lds
  s_add_u32 m0, s31, 17408
  s_nop 0
  buffer_load_dwordx4 v11, s[8:11], s30 offen lds
  s_add_u32 m0, s31, 18432
  s_nop 0
  buffer_load_dwordx4 v12, s[8:11], s30 offen lds
  s_add_u32 m0, s31, 19456
  s_nop 0
  buffer_load_dwordx4 v13, s[8:11], s30 offen lds
  s_add_u32 s30, s30, 128
  s_add_u32 m0, s31, 32768
  s_nop 0
  buffer_load_dwordx4 v10, s[8:11], s30 offen lds
  s_add_u32 m0, s31, 33792
  s_nop 0
  buffer_load_dwordx4 v11, s[8:11], s30 offen lds
  s_add_u32 m0, s31, 34816
  s_nop 0
  buffer_load_dwordx4 v12, s[8:11], s30 offen lds
  s_add_u32 m0, s31, 35840
  s_nop 0
  buffer_load_dwordx4 v13, s[8:11], s30 offen lds
  s_add_u32 s30, s30, 128
  s_add_u32 m0, s31, 49152
  s_nop 0
  buffer_load_dwordx4 v10, s[8:11], s30 offen lds
  s_add_u32 m0, s31, 50176
  s_nop 0
  buffer_load_dwordx4 v11, s[8:11], s30 offen lds
  s_add_u32 m0, s31, 51200
  s_nop 0
  buffer_load_dwordx4 v12, s[8:11], s30 offen lds
  s_add_u32 m0, s31, 52224
  s_nop 0
  buffer_load_dwordx4 v13, s[8:11], s30 offen lds
  s_add_u32 s30, s30, 128
  s_add_u32 m0, s31, 65536
  s_nop 0
  buffer_load_dwordx4 v10, s[8:11], s30 offen lds
  s_add_u32 m0, s31, 66560
  s_nop 0
  buffer_load_dwordx4 v11, s[8:11], s30 offen lds
  s_add_u32 m0, s31, 67584
  s_nop 0
  buffer_load_dwordx4 v12, s[8:11], s30 offen lds
  s_add_u32 m0, s31, 68608
  s_nop 0
  buffer_load_dwordx4 v13, s[8:11], s30 offen lds
  s_add_u32 s30, s30, 128
  s_waitcnt vmcnt(20) lgkmcnt(0)
  s_barrier
  buffer_atomic_add v28, v27, s[72:75], s61 offen sc1
  s_add_u32 m0, s31, 81920
  s_nop 0
  buffer_load_dwordx4 v10, s[8:11], s30 offen lds
  s_add_u32 m0, s31, 82944
  s_nop 0
  buffer_load_dwordx4 v11, s[8:11], s30 offen lds
  s_add_u32 m0, s31, 83968
  s_nop 0
  buffer_load_dwordx4 v12, s[8:11], s30 offen lds
  s_add_u32 m0, s31, 84992
  s_nop 0
  buffer_load_dwordx4 v13, s[8:11], s30 offen lds
  s_add_u32 s30, s30, 128
  s_mov_b32 s26, 13
  s_mov_b32 s48, 0x40000000
  s_mov_b32 s61, 0x40000000
  s_waitcnt vmcnt(16)
  s_barrier
  ds_read_b128 v[160:163], v14 offset:0
  ds_read_b128 v[164:167], v14 offset:2048
  ds_read_b128 v[168:171], v14 offset:4096
  ds_read_b128 v[172:175], v14 offset:6144
  s_waitcnt lgkmcnt(3)
  .p2align 3
kvs_241:
  v_mfma_f32_16x16x32_bf16 v[64:67], a[0:3], v[160:163], 0
  s_xor_b32 s29, s48, 0
  ds_read_b128 v[176:179], v14 offset:8192
  v_cvt_pk_bf16_f32 v221, v126, v127
  v_mfma_f32_16x16x32_bf16 v[68:71], a[4:7], v[160:163], 0
  v_cvt_pk_bf16_f32 v222, v128, v129
  v_cvt_pk_bf16_f32 v223, v130, v131
  v_mfma_f32_16x16x32_bf16 v[72:75], a[8:11], v[160:163], 0
  s_waitcnt lgkmcnt(3)
  v_cvt_pk_bf16_f32 v226, v132, v133
  v_cvt_pk_bf16_f32 v227, v134, v135
  v_mfma_f32_16x16x32_bf16 v[76:79], a[0:3], v[164:167], 0
  ds_read_b128 v[180:183], v14 offset:10240
  v_cvt_pk_bf16_f32 v228, v136, v137
  v_mfma_f32_16x16x32_bf16 v[80:83], a[4:7], v[164:167], 0
  v_cvt_pk_bf16_f32 v229, v138, v139
  v_cvt_pk_bf16_f32 v230, v140, v141
  v_mfma_f32_16x16x32_bf16 v[84:87], a[8:11], v[164:167], 0
  s_waitcnt lgkmcnt(3)
  v_cvt_pk_bf16_f32 v231, v142, v143
  v_cvt_pk_bf16_f32 v236, v144, v145
  v_mfma_f32_16x16x32_bf16 v[88:91], a[0:3], v[168:171], 0
  ds_read_b128 v[184:187], v14 offset:12288
  v_cvt_pk_bf16_f32 v237, v146, v147
  v_mfma_f32_16x16x32_bf16 v[92:95], a[4:7], v[168:171], 0
  v_cvt_pk_bf16_f32 v232, v148, v149
  v_cvt_pk_bf16_f32 v233, v150, v151
  v_mfma_f32_16x16x32_bf16 v[96:99], a[8:11], v[168:171], 0
  s_waitcnt lgkmcnt(3)
  v_cvt_pk_bf16_f32 v234, v152, v153
  v_cvt_pk_bf16_f32 v235, v154, v155
  v_mfma_f32_16x16x32_bf16 v[100:103], a[0:3], v[172:175], 0
  ds_read_b128 v[188:191], v14 offset:14336
  v_cvt_pk_bf16_f32 v238, v156, v157
  v_mfma_f32_16x16x32_bf16 v[104:107], a[4:7], v[172:175], 0
  v_cvt_pk_bf16_f32 v239, v158, v159
  v_mfma_f32_16x16x32_bf16 v[108:111], a[8:11], v[172:175], 0
  s_waitcnt lgkmcnt(3)
  v_mfma_f32_16x16x32_bf16 v[112:115], a[0:3], v[176:179], 0
  ds_read_b128 v[160:163], v15 offset:0
  v_mfma_f32_16x16x32_bf16 v[116:119], a[4:7], v[176:179], 0
  s_add_u32 m0, s31, 98304
  v_mfma_f32_16x16x32_bf16 v[120:123], a[8:11], v[176:179], 0
  s_waitcnt lgkmcnt(3)
  buffer_load_dwordx4 v10, s[8:11], s30 offen lds
  v_mfma_f32_16x16x32_bf16 v[124:127], a[0:3], v[180:183], 0
  ds_read_b128 v[164:167], v15 offset:2048
  v_mfma_f32_16x16x32_bf16 v[128:131], a[4:7], v[180:183], 0
  v_mfma_f32_16x16x32_bf16 v[132:135], a[8:11], v[180:183], 0
  s_waitcnt lgkmcnt(3)
  v_mfma_f32_16x16x32_bf16 v[136:139], a[0:3], v[184:187], 0
  ds_read_b128 v[168:171], v15 offset:4096
  v_mfma_f32_16x16x32_bf16 v[140:143], a[4:7], v[184:187], 0
  s_add_u32 m0, s31, 99328
  v_mfma_f32_16x16x32_bf16 v[144:147], a[8:11], v[184:187], 0
  s_waitcnt lgkmcnt(3)
  buffer_load_dwordx4 v11, s[8:11], s30 offen lds
  v_mfma_f32_16x16x32_bf16 v[148:151], a[0:3], v[188:191], 0
  ds_read_b128 v[172:175], v15 offset:6144
  v_mfma_f32_16x16x32_bf16 v[152:155], a[4:7], v[188:191], 0
  v_mfma_f32_16x16x32_bf16 v[156:159], a[8:11], v[188:191], 0
  s_waitcnt lgkmcnt(3)
  v_mfma_f32_16x16x32_bf16 v[64:67], a[12:15], v[160:163], v[64:67]
  ds_read_b128 v[176:179], v15 offset:8192
  v_mfma_f32_16x16x32_bf16 v[68:71], a[16:19], v[160:163], v[68:71]
  s_add_u32 m0, s31, 100352
  v_mfma_f32_16x16x32_bf16 v[72:75], a[20:23], v[160:163], v[72:75]
  s_waitcnt lgkmcnt(3)
  buffer_load_dwordx4 v12, s[8:11], s30 offen lds
  v_mfma_f32_16x16x32_bf16 v[76:79], a[12:15], v[164:167], v[76:79]
  ds_read_b128 v[180:183], v15 offset:10240
  v_mfma_f32_16x16x32_bf16 v[80:83], a[16:19], v[164:167], v[80:83]
  v_mfma_f32_16x16x32_bf16 v[84:87], a[20:23], v[164:167], v[84:87]
  s_waitcnt lgkmcnt(3)
  v_mfma_f32_16x16x32_bf16 v[88:91], a[12:15], v[168:171], v[88:91]
  ds_read_b128 v[184:187], v15 offset:12288
  v_mfma_f32_16x16x32_bf16 v[92:95], a[16:19], v[168:171], v[92:95]
  s_add_u32 m0, s31, 101376
  v_mfma_f32_16x16x32_bf16 v[96:99], a[20:23], v[168:171], v[96:99]
  s_waitcnt lgkmcnt(3)
  buffer_load_dwordx4 v13, s[8:11], s30 offen lds
  v_mfma_f32_16x16x32_bf16 v[100:103], a[12:15], v[172:175], v[100:103]
  s_add_u32 s30, s30, 128
  ds_read_b128 v[188:191], v15 offset:14336
  v_mfma_f32_16x16x32_bf16 v[104:107], a[16:19], v[172:175], v[104:107]
  v_mfma_f32_16x16x32_bf16 v[108:111], a[20:23], v[172:175], v[108:111]
  s_waitcnt lgkmcnt(3)
  v_mfma_f32_16x16x32_bf16 v[112:115], a[12:15], v[176:179], v[112:115]
  ds_read_b128 v[160:163], v14 offset:16384
  v_mfma_f32_16x16x32_bf16 v[116:119], a[16:19], v[176:179], v[116:119]
  buffer_store_dwordx4 v[192:195], v26, s[16:19], s29 offen offset:0 sc1
  v_mfma_f32_16x16x32_bf16 v[120:123], a[20:23], v[176:179], v[120:123]
  s_waitcnt lgkmcnt(3)
  v_mfma_f32_16x16x32_bf16 v[124:127], a[12:15], v[180:183], v[124:127]
  ds_read_b128 v[164:167], v14 offset:18432
  v_mfma_f32_16x16x32_bf16 v[128:131], a[16:19], v[180:183], v[128:131]
  v_mfma_f32_16x16x32_bf16 v[132:135], a[20:23], v[180:183], v[132:135]
  s_waitcnt lgkmcnt(3)
  v_mfma_f32_16x16x32_bf16 v[136:139], a[12:15], v[184:187], v[136:139]
  ds_read_b128 v[168:171], v14 offset:20480
  buffer_store_dwordx4 v[196:199], v26, s[16:19], s29 offen offset:1024 sc1
  v_mfma_f32_16x16x32_bf16 v[140:143], a[16:19], v[184:187], v[140:143]
  v_mfma_f32_16x16x32_bf16 v[144:147], a[20:23], v[184:187], v[144:147]
  s_waitcnt lgkmcnt(3)
  v_mfma_f32_16x16x32_bf16 v[148:151], a[12:15], v[188:191], v[148:151]
  ds_read_b128 v[172:175], v14 offset:22528
  v_mfma_f32_16x16x32_bf16 v[152:155], a[16:19], v[188:191], v[152:155]
  v_mfma_f32_16x16x32_bf16 v[156:159], a[20:23], v[188:191], v[156:159]
  s_waitcnt lgkmcnt(3)
  v_mfma_f32_16x16x32_bf16 v[64:67], a[24:27], v[160:163], v[64:67]
  ds_read_b128 v[176:179], v14 offset:24576
  v_mfma_f32_16x16x32_bf16 v[68:71], a[28:31], v[160:163], v[68:71]
  s_add_u32 m0, s31, 114688
  v_mfma_f32_16x16x32_bf16 v[72:75], a[32:35], v[160:163], v[72:75]
  s_waitcnt lgkmcnt(3)
  buffer_load_dwordx4 v10, s[8:11], s30 offen lds
  v_mfma_f32_16x16x32_bf16 v[76:79], a[24:27], v[164:167], v[76:79]
  ds_read_b128 v[180:183], v14 offset:26624
  v_mfma_f32_16x16x32_bf16 v[80:83], a[28:31], v[164:167], v[80:83]
  v_mfma_f32_16x16x32_bf16 v[84:87], a[32:35], v[164:167], v[84:87]
  s_waitcnt lgkmcnt(3)
  v_mfma_f32_16x16x32_bf16 v[88:91], a[24:27], v[168:171], v[88:91]
  ds_read_b128 v[184:187], v14 offset:28672
  v_mfma_f32_16x16x32_bf16 v[92:95], a[28:31], v[168:171], v[92:95]
  buffer_store_dwordx4 v[200:203], v26, s[16:19], s29 offen offset:2048 sc1
  v_mfma_f32_16x16x32_bf16 v[96:99], a[32:35], v[168:171], v[96:99]
  s_waitcnt lgkmcnt(3)
  v_mfma_f32_16x16x32_bf16 v[100:103], a[24:27], v[172:175], v[100:103]
  ds_read_b128 v[188:191], v14 offset:30720
  v_mfma_f32_16x16x32_bf16 v[104:107], a[28:31], v[172:175], v[104:107]
  v_mfma_f32_16x16x32_bf16 v[108:111], a[32:35], v[172:175], v[108:111]
  s_xor_b32 s29, s48, 2105344
  s_waitcnt lgkmcnt(3)
  v_mfma_f32_16x16x32_bf16 v[112:115], a[24:27], v[176:179], v[112:115]
  ds_read_b128 v[160:163], v15 offset:16384
  v_mfma_f32_16x16x32_bf16 v[116:119], a[28:31], v[176:179], v[116:119]
  s_add_u32 m0, s31, 115712
  v_mfma_f32_16x16x32_bf16 v[120:123], a[32:35], v[176:179], v[120:123]
  s_waitcnt lgkmcnt(3)
  buffer_load_dwordx4 v11, s[8:11], s30 offen lds
  v_mfma_f32_16x16x32_bf16 v[124:127], a[24:27], v[180:183], v[124:127]
  ds_read_b128 v[164:167], v15 offset:18432
  v_mfma_f32_16x16x32_bf16 v[128:131], a[28:31], v[180:183], v[128:131]
  v_mfma_f32_16x16x32_bf16 v[132:135], a[32:35], v[180:183], v[132:135]
  s_waitcnt lgkmcnt(3)
  v_mfma_f32_16x16x32_bf16 v[136:139], a[24:27], v[184:187], v[136:139]
  ds_read_b128 v[168:171], v15 offset:20480
  v_mfma_f32_16x16x32_bf16 v[140:143], a[28:31], v[184:187], v[140:143]
  buffer_store_dwordx4 v[204:207], v26, s[16:19], s29 offen offset:0 sc1
  v_mfma_f32_16x16x32_bf16 v[144:147], a[32:35], v[184:187], v[144:147]
  s_waitcnt lgkmcnt(3)
  v_mfma_f32_16x16x32_bf16 v[148:151], a[24:27], v[188:191], v[148:151]
  ds_read_b128 v[172:175], v15 offset:22528
  v_mfma_f32_16x16x32_bf16 v[152:155], a[28:31], v[188:191], v[152:155]
  v_mfma_f32_16x16x32_bf16 v[156:159], a[32:35], v[188:191], v[156:159]
  s_waitcnt lgkmcnt(3)
  v_mfma_f32_16x16x32_bf16 v[64:67], a[36:39], v[160:163], v[64:67]
  ds_read_b128 v[176:179], v15 offset:24576
  v_mfma_f32_16x16x32_bf16 v[68:71], a[40:43], v[160:163], v[68:71]
  s_add_u32 m0, s31, 116736
  v_mfma_f32_16x16x32_bf16 v[72:75], a[44:47], v[160:163], v[72:75]
  s_waitcnt lgkmcnt(3)
  buffer_load_dwordx4 v12, s[8:11], s30 offen lds
  v_mfma_f32_16x16x32_bf16 v[76:79], a[36:39], v[164:167], v[76:79]
  ds_read_b128 v[180:183], v15 offset:26624
  v_mfma_f32_16x16x32_bf16 v[80:83], a[40:43], v[164:167], v[80:83]
  v_mfma_f32_16x16x32_bf16 v[84:87], a[44:47], v[164:167], v[84:87]
  s_waitcnt lgkmcnt(3)
  v_mfma_f32_16x16x32_bf16 v[88:91], a[36:39], v[168:171], v[88:91]
  ds_read_b128 v[184:187], v15 offset:28672
  v_mfma_f32_16x16x32_bf16 v[92:95], a[40:43], v[168:171], v[92:95]
  buffer_store_dwordx4 v[208:211], v26, s[16:19], s29 offen offset:1024 sc1
  v_mfma_f32_16x16x32_bf16 v[96:99], a[44:47], v[168:171], v[96:99]
  s_waitcnt lgkmcnt(3)
  v_mfma_f32_16x16x32_bf16 v[100:103], a[36:39], v[172:175], v[100:103]
  ds_read_b128 v[188:191], v15 offset:30720
  v_mfma_f32_16x16x32_bf16 v[104:107], a[40:43], v[172:175], v[104:107]
  v_mfma_f32_16x16x32_bf16 v[108:111], a[44:47], v[172:175], v[108:111]
  s_waitcnt lgkmcnt(3)
  v_mfma_f32_16x16x32_bf16 v[112:115], a[36:39], v[176:179], v[112:115]
  s_waitcnt vmcnt(20)
  s_barrier
  ds_read_b128 v[160:163], v14 offset:32768
  v_mfma_f32_16x16x32_bf16 v[116:119], a[40:43], v[176:179], v[116:119]
  s_add_u32 m0, s31, 117760
  v_mfma_f32_16x16x32_bf16 v[120:123], a[44:47], v[176:179], v[120:123]
  s_waitcnt lgkmcnt(3)
  buffer_load_dwordx4 v13, s[8:11], s30 offen lds
  v_mfma_f32_16x16x32_bf16 v[124:127], a[36:39], v[180:183], v[124:127]
  s_add_u32 s30, s30, 128
  ds_read_b128 v[164:167], v14 offset:34816
  v_mfma_f32_16x16x32_bf16 v[128:131], a[40:43], v[180:183], v[128:131]
  v_mfma_f32_16x16x32_bf16 v[132:135], a[44:47], v[180:183], v[132:135]
  s_waitcnt lgkmcnt(3)
  v_mfma_f32_16x16x32_bf16 v[136:139], a[36:39], v[184:187], v[136:139]
  ds_read_b128 v[168:171], v14 offset:36864
  v_mfma_f32_16x16x32_bf16 v[140:143], a[40:43], v[184:187], v[140:143]
  buffer_store_dwordx4 v[212:215], v26, s[16:19], s29 offen offset:2048 sc1
  v_mfma_f32_16x16x32_bf16 v[144:147], a[44:47], v[184:187], v[144:147]
  s_waitcnt lgkmcnt(3)
  v_mfma_f32_16x16x32_bf16 v[148:151], a[36:39], v[188:191], v[148:151]
  ds_read_b128 v[172:175], v14 offset:38912
  v_mfma_f32_16x16x32_bf16 v[152:155], a[40:43], v[188:191], v[152:155]
  v_mfma_f32_16x16x32_bf16 v[156:159], a[44:47], v[188:191], v[156:159]
  s_xor_b32 s29, s48, 4194304
  s_waitcnt lgkmcnt(3)
  v_mfma_f32_16x16x32_bf16 v[64:67], a[48:51], v[160:163], v[64:67]
  ds_read_b128 v[176:179], v14 offset:40960
  v_mfma_f32_16x16x32_bf16 v[68:71], a[52:55], v[160:163], v[68:71]
  s_add_u32 m0, s31, 131072
  v_mfma_f32_16x16x32_bf16 v[72:75], a[56:59], v[160:163], v[72:75]
  s_waitcnt lgkmcnt(3)
  buffer_load_dwordx4 v10, s[8:11], s30 offen lds
  v_mfma_f32_16x16x32_bf16 v[76:79], a[48:51], v[164:167], v[76:79]
  ds_read_b128 v[180:183], v14 offset:43008
  v_mfma_f32_16x16x32_bf16 v[80:83], a[52:55], v[164:167], v[80:83]
  v_mfma_f32_16x16x32_bf16 v[84:87], a[56:59], v[164:167], v[84:87]
  s_waitcnt lgkmcnt(3)
  v_mfma_f32_16x16x32_bf16 v[88:91], a[48:51], v[168:171], v[88:91]
  ds_read_b128 v[184:187], v14 offset:45056
  v_mfma_f32_16x16x32_bf16 v[92:95], a[52:55], v[168:171], v[92:95]
  buffer_store_dwordx4 v[216:219], v26, s[16:19], s29 offen offset:0 sc1
  v_mfma_f32_16x16x32_bf16 v[96:99], a[56:59], v[168:171], v[96:99]
  s_waitcnt lgkmcnt(3)
  v_mfma_f32_16x16x32_bf16 v[100:103], a[48:51], v[172:175], v[100:103]
  ds_read_b128 v[188:191], v14 offset:47104
  v_mfma_f32_16x16x32_bf16 v[104:107], a[52:55], v[172:175], v[104:107]
  v_mfma_f32_16x16x32_bf16 v[108:111], a[56:59], v[172:175], v[108:111]
  s_waitcnt lgkmcnt(3)
  v_mfma_f32_16x16x32_bf16 v[112:115], a[48:51], v[176:179], v[112:115]
  ds_read_b128 v[160:163], v15 offset:32768
  v_mfma_f32_16x16x32_bf16 v[116:119], a[52:55], v[176:179], v[116:119]
  s_add_u32 m0, s31, 132096
  v_mfma_f32_16x16x32_bf16 v[120:123], a[56:59], v[176:179], v[120:123]
  s_waitcnt lgkmcnt(3)
  buffer_load_dwordx4 v11, s[8:11], s30 offen lds
  v_mfma_f32_16x16x32_bf16 v[124:127], a[48:51], v[180:183], v[124:127]
  ds_read_b128 v[164:167], v15 offset:34816
  v_mfma_f32_16x16x32_bf16 v[128:131], a[52:55], v[180:183], v[128:131]
  v_mfma_f32_16x16x32_bf16 v[132:135], a[56:59], v[180:183], v[132:135]
  s_waitcnt lgkmcnt(3)
  v_mfma_f32_16x16x32_bf16 v[136:139], a[48:51], v[184:187], v[136:139]
  ds_read_b128 v[168:171], v15 offset:36864
  v_mfma_f32_16x16x32_bf16 v[140:143], a[52:55], v[184:187], v[140:143]
  buffer_store_dwordx4 v[220:223], v26, s[16:19], s29 offen offset:1024 sc1
  v_mfma_f32_16x16x32_bf16 v[144:147], a[56:59], v[184:187], v[144:147]
  s_waitcnt lgkmcnt(3)
  v_mfma_f32_16x16x32_bf16 v[148:151], a[48:51], v[188:191], v[148:151]
  ds_read_b128 v[172:175], v15 offset:38912
  v_mfma_f32_16x16x32_bf16 v[152:155], a[52:55], v[188:191], v[152:155]
  v_mfma_f32_16x16x32_bf16 v[156:159], a[56:59], v[188:191], v[156:159]
  s_waitcnt lgkmcnt(3)
  v_mfma_f32_16x16x32_bf16 v[64:67], a[60:63], v[160:163], v[64:67]
  ds_read_b128 v[176:179], v15 offset:40960
  v_mfma_f32_16x16x32_bf16 v[68:71], a[64:67], v[160:163], v[68:71]
  s_add_u32 m0, s31, 133120
  v_mfma_f32_16x16x32_bf16 v[72:75], a[68:71], v[160:163], v[72:75]
  s_waitcnt lgkmcnt(3)
  buffer_load_dwordx4 v12, s[8:11], s30 offen lds
  v_mfma_f32_16x16x32_bf16 v[76:79], a[60:63], v[164:167], v[76:79]
  ds_read_b128 v[180:183], v15 offset:43008
  v_mfma_f32_16x16x32_bf16 v[80:83], a[64:67], v[164:167], v[80:83]
  v_mfma_f32_16x16x32_bf16 v[84:87], a[68:71], v[164:167], v[84:87]
  s_waitcnt lgkmcnt(3)
  v_mfma_f32_16x16x32_bf16 v[88:91], a[60:63], v[168:171], v[88:91]
  ds_read_b128 v[184:187], v15 offset:45056
  v_mfma_f32_16x16x32_bf16 v[92:95], a[64:67], v[168:171], v[92:95]
  buffer_store_dwordx4 v[224:227], v26, s[16:19], s29 offen offset:2048 sc1
  v_mfma_f32_16x16x32_bf16 v[96:99], a[68:71], v[168:171], v[96:99]
  s_waitcnt lgkmcnt(3)
  v_mfma_f32_16x16x32_bf16 v[100:103], a[60:63], v[172:175], v[100:103]
  ds_read_b128 v[188:191], v15 offset:47104
  v_mfma_f32_16x16x32_bf16 v[104:107], a[64:67], v[172:175], v[104:107]
  v_mfma_f32_16x16x32_bf16 v[108:111], a[68:71], v[172:175], v[108:111]
  s_xor_b32 s29, s48, 6299648
  s_waitcnt lgkmcnt(3)
  v_mfma_f32_16x16x32_bf16 v[112:115], a[60:63], v[176:179], v[112:115]
  ds_read_b128 v[160:163], v14 offset:49152
  v_mfma_f32_16x16x32_bf16 v[116:119], a[64:67], v[176:179], v[116:119]
  s_add_u32 m0, s31, 134144
  v_mfma_f32_16x16x32_bf16 v[120:123], a[68:71], v[176:179], v[120:123]
  s_waitcnt lgkmcnt(3)
  buffer_load_dwordx4 v13, s[8:11], s30 offen lds
  v_mfma_f32_16x16x32_bf16 v[124:127], a[60:63], v[180:183], v[124:127]
  s_add_u32 s30, s30, 128
  ds_read_b128 v[164:167], v14 offset:51200
  v_mfma_f32_16x16x32_bf16 v[128:131], a[64:67], v[180:183], v[128:131]
  v_mfma_f32_16x16x32_bf16 v[132:135], a[68:71], v[180:183], v[132:135]
  s_waitcnt lgkmcnt(3)
  v_mfma_f32_16x16x32_bf16 v[136:139], a[60:63], v[184:187], v[136:139]
  ds_read_b128 v[168:171], v14 offset:53248
  v_mfma_f32_16x16x32_bf16 v[140:143], a[64:67], v[184:187], v[140:143]
  buffer_store_dwordx4 v[228:231], v26, s[16:19], s29 offen offset:0 sc1
  v_mfma_f32_16x16x32_bf16 v[144:147], a[68:71], v[184:187], v[144:147]
  s_waitcnt lgkmcnt(3)
  v_mfma_f32_16x16x32_bf16 v[148:151], a[60:63], v[188:191], v[148:151]
  ds_read_b128 v[172:175], v14 offset:55296
  v_mfma_f32_16x16x32_bf16 v[152:155], a[64:67], v[188:191], v[152:155]
  v_mfma_f32_16x16x32_bf16 v[156:159], a[68:71], v[188:191], v[156:159]
  s_waitcnt lgkmcnt(3)
  v_mfma_f32_16x16x32_bf16 v[64:67], a[72:75], v[160:163], v[64:67]
  ds_read_b128 v[176:179], v14 offset:57344
  v_mfma_f32_16x16x32_bf16 v[68:71], a[76:79], v[160:163], v[68:71]
  s_add_u32 m0, s31, 147456
  v_mfma_f32_16x16x32_bf16 v[72:75], a[80:83], v[160:163], v[72:75]
  s_waitcnt lgkmcnt(3)
  buffer_load_dwordx4 v10, s[8:11], s30 offen lds
  v_mfma_f32_16x16x32_bf16 v[76:79], a[72:75], v[164:167], v[76:79]
  ds_read_b128 v[180:183], v14 offset:59392
  v_mfma_f32_16x16x32_bf16 v[80:83], a[76:79], v[164:167], v[80:83]
  v_mfma_f32_16x16x32_bf16 v[84:87], a[80:83], v[164:167], v[84:87]
  s_waitcnt lgkmcnt(3)
  v_mfma_f32_16x16x32_bf16 v[88:91], a[72:75], v[168:171], v[88:91]
  ds_read_b128 v[184:187], v14 offset:61440
  v_mfma_f32_16x16x32_bf16 v[92:95], a[76:79], v[168:171], v[92:95]
  buffer_store_dwordx4 v[232:235], v26, s[16:19], s29 offen offset:1024 sc1
  v_mfma_f32_16x16x32_bf16 v[96:99], a[80:83], v[168:171], v[96:99]
  s_waitcnt lgkmcnt(3)
  v_mfma_f32_16x16x32_bf16 v[100:103], a[72:75], v[172:175], v[100:103]
  ds_read_b128 v[188:191], v14 offset:63488
  v_mfma_f32_16x16x32_bf16 v[104:107], a[76:79], v[172:175], v[104:107]
  v_mfma_f32_16x16x32_bf16 v[108:111], a[80:83], v[172:175], v[108:111]
  s_waitcnt lgkmcnt(3)
  v_mfma_f32_16x16x32_bf16 v[112:115], a[72:75], v[176:179], v[112:115]
  ds_read_b128 v[160:163], v15 offset:49152
  v_mfma_f32_16x16x32_bf16 v[116:119], a[76:79], v[176:179], v[116:119]
  s_add_u32 m0, s31, 148480
  v_mfma_f32_16x16x32_bf16 v[120:123], a[80:83], v[176:179], v[120:123]
  s_waitcnt lgkmcnt(3)
  buffer_load_dwordx4 v11, s[8:11], s30 offen lds
  v_mfma_f32_16x16x32_bf16 v[124:127], a[72:75], v[180:183], v[124:127]
  ds_read_b128 v[164:167], v15 offset:51200
  v_mfma_f32_16x16x32_bf16 v[128:131], a[76:79], v[180:183], v[128:131]
  v_mfma_f32_16x16x32_bf16 v[132:135], a[80:83], v[180:183], v[132:135]
  s_waitcnt lgkmcnt(3)
  v_mfma_f32_16x16x32_bf16 v[136:139], a[72:75], v[184:187], v[136:139]
  ds_read_b128 v[168:171], v15 offset:53248
  v_mfma_f32_16x16x32_bf16 v[140:143], a[76:79], v[184:187], v[140:143]
  buffer_store_dwordx4 v[236:239], v26, s[16:19], s29 offen offset:2048 sc1
  v_mfma_f32_16x16x32_bf16 v[144:147], a[80:83], v[184:187], v[144:147]
  s_waitcnt lgkmcnt(3)
  v_mfma_f32_16x16x32_bf16 v[148:151], a[72:75], v[188:191], v[148:151]
  ds_read_b128 v[172:175], v15 offset:55296
  v_mfma_f32_16x16x32_bf16 v[152:155], a[76:79], v[188:191], v[152:155]
  v_mfma_f32_16x16x32_bf16 v[156:159], a[80:83], v[188:191], v[156:159]
  s_waitcnt lgkmcnt(3)
  v_mfma_f32_16x16x32_bf16 v[64:67], a[84:87], v[160:163], v[64:67]
  ds_read_b128 v[176:179], v15 offset:57344
  v_mfma_f32_16x16x32_bf16 v[68:71], a[88:91], v[160:163], v[68:71]
  s_add_u32 m0, s31, 149504
  v_mfma_f32_16x16x32_bf16 v[72:75], a[92:95], v[160:163], v[72:75]
  s_waitcnt lgkmcnt(3)
  buffer_load_dwordx4 v12, s[8:11], s30 offen lds
  v_mfma_f32_16x16x32_bf16 v[76:79], a[84:87], v[164:167], v[76:79]
  ds_read_b128 v[180:183], v15 offset:59392
  v_mfma_f32_16x16x32_bf16 v[80:83], a[88:91], v[164:167], v[80:83]
  v_mfma_f32_16x16x32_bf16 v[84:87], a[92:95], v[164:167], v[84:87]
  s_waitcnt lgkmcnt(3)
  v_mfma_f32_16x16x32_bf16 v[88:91], a[84:87], v[168:171], v[88:91]
  ds_read_b128 v[184:187], v15 offset:61440
  v_mfma_f32_16x16x32_bf16 v[92:95], a[88:91], v[168:171], v[92:95]
  v_mfma_f32_16x16x32_bf16 v[96:99], a[92:95], v[168:171], v[96:99]
  s_waitcnt lgkmcnt(3)
  v_mfma_f32_16x16x32_bf16 v[100:103], a[84:87], v[172:175], v[100:103]
  ds_read_b128 v[188:191], v15 offset:63488
  v_mfma_f32_16x16x32_bf16 v[104:107], a[88:91], v[172:175], v[104:107]
  v_mfma_f32_16x16x32_bf16 v[108:111], a[92:95], v[172:175], v[108:111]
  s_waitcnt lgkmcnt(3)
  v_mfma_f32_16x16x32_bf16 v[112:115], a[84:87], v[176:179], v[112:115]
  s_waitcnt vmcnt(1)
  s_barrier
  ds_read_b128 v[160:163], v16 offset:0
  v_mfma_f32_16x16x32_bf16 v[116:119], a[88:91], v[176:179], v[116:119]
  s_add_u32 m0, s31, 150528
  v_mfma_f32_16x16x32_bf16 v[120:123], a[92:95], v[176:179], v[120:123]
  s_waitcnt lgkmcnt(3)
  buffer_load_dwordx4 v13, s[8:11], s30 offen lds
  v_mfma_f32_16x16x32_bf16 v[124:127], a[84:87], v[180:183], v[124:127]
  s_add_u32 s30, s30, s25
  ds_read_b128 v[164:167], v16 offset:2048
  v_mfma_f32_16x16x32_bf16 v[128:131], a[88:91], v[180:183], v[128:131]
  v_mfma_f32_16x16x32_bf16 v[132:135], a[92:95], v[180:183], v[132:135]
  s_waitcnt lgkmcnt(3)
  v_mfma_f32_16x16x32_bf16 v[136:139], a[84:87], v[184:187], v[136:139]
  ds_read_b128 v[168:171], v16 offset:4096
  v_mfma_f32_16x16x32_bf16 v[140:143], a[88:91], v[184:187], v[140:143]
  buffer_atomic_add v28, v27, s[72:75], s61 offen sc1
  v_mfma_f32_16x16x32_bf16 v[144:147], a[92:95], v[184:187], v[144:147]
  s_waitcnt lgkmcnt(3)
  s_mov_b32 s48, s27
  s_add_u32 s27, s27, 8388608
  v_mfma_f32_16x16x32_bf16 v[148:151], a[84:87], v[188:191], v[148:151]
  s_mov_b32 s61, s60
  ds_read_b128 v[172:175], v16 offset:6144
  s_add_u32 s60, s60, 4
  v_mfma_f32_16x16x32_bf16 v[152:155], a[88:91], v[188:191], v[152:155]
  v_mfma_f32_16x16x32_bf16 v[156:159], a[92:95], v[188:191], v[156:159]
  s_waitcnt lgkmcnt(3)
  v_mfma_f32_16x16x32_bf16 v[64:67], a[96:99], v[160:163], v[64:67]
  ds_read_b128 v[176:179], v16 offset:8192
  v_mfma_f32_16x16x32_bf16 v[68:71], a[100:103], v[160:163], v[68:71]
  s_add_u32 m0, s31, 0
  v_mfma_f32_16x16x32_bf16 v[72:75], a[104:107], v[160:163], v[72:75]
  s_waitcnt lgkmcnt(3)
  buffer_load_dwordx4 v10, s[8:11], s30 offen lds
  v_mfma_f32_16x16x32_bf16 v[76:79], a[96:99], v[164:167], v[76:79]
  ds_read_b128 v[180:183], v16 offset:10240
  v_mfma_f32_16x16x32_bf16 v[80:83], a[100:103], v[164:167], v[80:83]
  v_mfma_f32_16x16x32_bf16 v[84:87], a[104:107], v[164:167], v[84:87]
  s_waitcnt lgkmcnt(3)
  v_mfma_f32_16x16x32_bf16 v[88:91], a[96:99], v[168:171], v[88:91]
  ds_read_b128 v[184:187], v16 offset:12288
  v_mfma_f32_16x16x32_bf16 v[92:95], a[100:103], v[168:171], v[92:95]
  v_mfma_f32_16x16x32_bf16 v[96:99], a[104:107], v[168:171], v[96:99]
  s_waitcnt lgkmcnt(3)
  v_mfma_f32_16x16x32_bf16 v[100:103], a[96:99], v[172:175], v[100:103]
  ds_read_b128 v[188:191], v16 offset:14336
  v_mfma_f32_16x16x32_bf16 v[104:107], a[100:103], v[172:175], v[104:107]
  v_mfma_f32_16x16x32_bf16 v[108:111], a[104:107], v[172:175], v[108:111]
  s_waitcnt lgkmcnt(3)
  v_mfma_f32_16x16x32_bf16 v[112:115], a[96:99], v[176:179], v[112:115]
  ds_read_b128 v[160:163], v17 offset:0
  v_mfma_f32_16x16x32_bf16 v[116:119], a[100:103], v[176:179], v[116:119]
  s_add_u32 m0, s31, 1024
  v_mfma_f32_16x16x32_bf16 v[120:123], a[104:107], v[176:179], v[120:123]
  s_waitcnt lgkmcnt(3)
  buffer_load_dwordx4 v11, s[8:11], s30 offen lds
  v_mfma_f32_16x16x32_bf16 v[124:127], a[96:99], v[180:183], v[124:127]
  ds_read_b128 v[164:167], v17 offset:2048
  v_mfma_f32_16x16x32_bf16 v[128:131], a[100:103], v[180:183], v[128:131]
  v_mfma_f32_16x16x32_bf16 v[132:135], a[104:107], v[180:183], v[132:135]
  s_waitcnt lgkmcnt(3)
  v_mfma_f32_16x16x32_bf16 v[136:139], a[96:99], v[184:187], v[136:139]
  ds_read_b128 v[168:171], v17 offset:4096
  v_mfma_f32_16x16x32_bf16 v[140:143], a[100:103], v[184:187], v[140:143]
  v_mfma_f32_16x16x32_bf16 v[144:147], a[104:107], v[184:187], v[144:147]
  s_waitcnt lgkmcnt(3)
  v_mfma_f32_16x16x32_bf16 v[148:151], a[96:99], v[188:191], v[148:151]
  ds_read_b128 v[172:175], v17 offset:6144
  v_mfma_f32_16x16x32_bf16 v[152:155], a[100:103], v[188:191], v[152:155]
  v_mfma_f32_16x16x32_bf16 v[156:159], a[104:107], v[188:191], v[156:159]
  s_waitcnt lgkmcnt(3)
  v_mfma_f32_16x16x32_bf16 v[64:67], a[108:111], v[160:163], v[64:67]
  ds_read_b128 v[176:179], v17 offset:8192
  v_mfma_f32_16x16x32_bf16 v[68:71], a[112:115], v[160:163], v[68:71]
  s_add_u32 m0, s31, 2048
  v_mfma_f32_16x16x32_bf16 v[72:75], a[116:119], v[160:163], v[72:75]
  s_waitcnt lgkmcnt(3)
  buffer_load_dwordx4 v12, s[8:11], s30 offen lds
  v_mfma_f32_16x16x32_bf16 v[76:79], a[108:111], v[164:167], v[76:79]
  ds_read_b128 v[180:183], v17 offset:10240
  v_mfma_f32_16x16x32_bf16 v[80:83], a[112:115], v[164:167], v[80:83]
  v_mfma_f32_16x16x32_bf16 v[84:87], a[116:119], v[164:167], v[84:87]
  s_waitcnt lgkmcnt(3)
  v_mfma_f32_16x16x32_bf16 v[88:91], a[108:111], v[168:171], v[88:91]
  ds_read_b128 v[184:187], v17 offset:12288
  v_mfma_f32_16x16x32_bf16 v[92:95], a[112:115], v[168:171], v[92:95]
  v_mfma_f32_16x16x32_bf16 v[96:99], a[116:119], v[168:171], v[96:99]
  s_waitcnt lgkmcnt(3)
  v_mfma_f32_16x16x32_bf16 v[100:103], a[108:111], v[172:175], v[100:103]
  ds_read_b128 v[188:191], v17 offset:14336
  v_mfma_f32_16x16x32_bf16 v[104:107], a[112:115], v[172:175], v[104:107]
  v_mfma_f32_16x16x32_bf16 v[108:111], a[116:119], v[172:175], v[108:111]
  s_waitcnt lgkmcnt(3)
  v_mfma_f32_16x16x32_bf16 v[112:115], a[108:111], v[176:179], v[112:115]
  ds_read_b128 v[160:163], v16 offset:16384
  v_mfma_f32_16x16x32_bf16 v[116:119], a[112:115], v[176:179], v[116:119]
  s_add_u32 m0, s31, 3072
  v_mfma_f32_16x16x32_bf16 v[120:123], a[116:119], v[176:179], v[120:123]
  s_waitcnt lgkmcnt(3)
  buffer_load_dwordx4 v13, s[8:11], s30 offen lds
  v_mfma_f32_16x16x32_bf16 v[124:127], a[108:111], v[180:183], v[124:127]
  s_add_u32 s30, s30, 128
  ds_read_b128 v[164:167], v16 offset:18432
  v_mfma_f32_16x16x32_bf16 v[128:131], a[112:115], v[180:183], v[128:131]
  v_mfma_f32_16x16x32_bf16 v[132:135], a[116:119], v[180:183], v[132:135]
  s_waitcnt lgkmcnt(3)
  v_mfma_f32_16x16x32_bf16 v[136:139], a[108:111], v[184:187], v[136:139]
  ds_read_b128 v[168:171], v16 offset:20480
  v_mfma_f32_16x16x32_bf16 v[140:143], a[112:115], v[184:187], v[140:143]
  v_mfma_f32_16x16x32_bf16 v[144:147], a[116:119], v[184:187], v[144:147]
  s_waitcnt lgkmcnt(3)
  v_mfma_f32_16x16x32_bf16 v[148:151], a[108:111], v[188:191], v[148:151]
  ds_read_b128 v[172:175], v16 offset:22528
  v_mfma_f32_16x16x32_bf16 v[152:155], a[112:115], v[188:191], v[152:155]
  v_mfma_f32_16x16x32_bf16 v[156:159], a[116:119], v[188:191], v[156:159]
  s_waitcnt lgkmcnt(3)
  v_mfma_f32_16x16x32_bf16 v[64:67], a[120:123], v[160:163], v[64:67]
  ds_read_b128 v[176:179], v16 offset:24576
  v_mfma_f32_16x16x32_bf16 v[68:71], a[124:127], v[160:163], v[68:71]
  s_add_u32 m0, s31, 16384
  v_mfma_f32_16x16x32_bf16 v[72:75], a[128:131], v[160:163], v[72:75]
  s_waitcnt lgkmcnt(3)
  buffer_load_dwordx4 v10, s[8:11], s30 offen lds
  v_mfma_f32_16x16x32_bf16 v[76:79], a[120:123], v[164:167], v[76:79]
  ds_read_b128 v[180:183], v16 offset:26624
  v_mfma_f32_16x16x32_bf16 v[80:83], a[124:127], v[164:167], v[80:83]
  v_mfma_f32_16x16x32_bf16 v[84:87], a[128:131], v[164:167], v[84:87]
  s_waitcnt lgkmcnt(3)
  v_mfma_f32_16x16x32_bf16 v[88:91], a[120:123], v[168:171], v[88:91]
  ds_read_b128 v[184:187], v16 offset:28672
  v_mfma_f32_16x16x32_bf16 v[92:95], a[124:127], v[168:171], v[92:95]
  v_mfma_f32_16x16x32_bf16 v[96:99], a[128:131], v[168:171], v[96:99]
  s_waitcnt lgkmcnt(3)
  v_mfma_f32_16x16x32_bf16 v[100:103], a[120:123], v[172:175], v[100:103]
  ds_read_b128 v[188:191], v16 offset:30720
  v_mfma_f32_16x16x32_bf16 v[104:107], a[124:127], v[172:175], v[104:107]
  v_mfma_f32_16x16x32_bf16 v[108:111], a[128:131], v[172:175], v[108:111]
  s_waitcnt lgkmcnt(3)
  v_mfma_f32_16x16x32_bf16 v[112:115], a[120:123], v[176:179], v[112:115]
  ds_read_b128 v[160:163], v17 offset:16384
  v_mfma_f32_16x16x32_bf16 v[116:119], a[124:127], v[176:179], v[116:119]
  s_add_u32 m0, s31, 17408
  v_mfma_f32_16x16x32_bf16 v[120:123], a[128:131], v[176:179], v[120:123]
  s_waitcnt lgkmcnt(3)
  buffer_load_dwordx4 v11, s[8:11], s30 offen lds
  v_mfma_f32_16x16x32_bf16 v[124:127], a[120:123], v[180:183], v[124:127]
  ds_read_b128 v[164:167], v17 offset:18432
  v_mfma_f32_16x16x32_bf16 v[128:131], a[124:127], v[180:183], v[128:131]
  v_mfma_f32_16x16x32_bf16 v[132:135], a[128:131], v[180:183], v[132:135]
  s_waitcnt lgkmcnt(3)
  v_mfma_f32_16x16x32_bf16 v[136:139], a[120:123], v[184:187], v[136:139]
  ds_read_b128 v[168:171], v17 offset:20480
  v_mfma_f32_16x16x32_bf16 v[140:143], a[124:127], v[184:187], v[140:143]
  v_mfma_f32_16x16x32_bf16 v[144:147], a[128:131], v[184:187], v[144:147]
  s_waitcnt lgkmcnt(3)
  v_mfma_f32_16x16x32_bf16 v[148:151], a[120:123], v[188:191], v[148:151]
  ds_read_b128 v[172:175], v17 offset:22528
  v_mfma_f32_16x16x32_bf16 v[152:155], a[124:127], v[188:191], v[152:155]
  v_mfma_f32_16x16x32_bf16 v[156:159], a[128:131], v[188:191], v[156:159]
  s_waitcnt lgkmcnt(3)
  v_mfma_f32_16x16x32_bf16 v[64:67], a[132:135], v[160:163], v[64:67]
  ds_read_b128 v[176:179], v17 offset:24576
  v_mfma_f32_16x16x32_bf16 v[68:71], a[136:139], v[160:163], v[68:71]
  s_add_u32 m0, s31, 18432
  v_mfma_f32_16x16x32_bf16 v[72:75], a[140:143], v[160:163], v[72:75]
  s_waitcnt lgkmcnt(3)
  buffer_load_dwordx4 v12, s[8:11], s30 offen lds
  v_mfma_f32_16x16x32_bf16 v[76:79], a[132:135], v[164:167], v[76:79]
  ds_read_b128 v[180:183], v17 offset:26624
  v_mfma_f32_16x16x32_bf16 v[80:83], a[136:139], v[164:167], v[80:83]
  v_mfma_f32_16x16x32_bf16 v[84:87], a[140:143], v[164:167], v[84:87]
  s_waitcnt lgkmcnt(3)
  v_mfma_f32_16x16x32_bf16 v[88:91], a[132:135], v[168:171], v[88:91]
  ds_read_b128 v[184:187], v17 offset:28672
  v_mfma_f32_16x16x32_bf16 v[92:95], a[136:139], v[168:171], v[92:95]
  v_mfma_f32_16x16x32_bf16 v[96:99], a[140:143], v[168:171], v[96:99]
  s_waitcnt lgkmcnt(3)
  v_mfma_f32_16x16x32_bf16 v[100:103], a[132:135], v[172:175], v[100:103]
  ds_read_b128 v[188:191], v17 offset:30720
  v_mfma_f32_16x16x32_bf16 v[104:107], a[136:139], v[172:175], v[104:107]
  v_mfma_f32_16x16x32_bf16 v[108:111], a[140:143], v[172:175], v[108:111]
  s_waitcnt lgkmcnt(3)
  v_mfma_f32_16x16x32_bf16 v[112:115], a[132:135], v[176:179], v[112:115]
  s_waitcnt vmcnt(23)
  s_barrier
  ds_read_b128 v[160:163], v16 offset:32768
  v_mfma_f32_16x16x32_bf16 v[116:119], a[136:139], v[176:179], v[116:119]
  s_add_u32 m0, s31, 19456
  v_mfma_f32_16x16x32_bf16 v[120:123], a[140:143], v[176:179], v[120:123]
  s_waitcnt lgkmcnt(3)
  buffer_load_dwordx4 v13, s[8:11], s30 offen lds
  v_mfma_f32_16x16x32_bf16 v[124:127], a[132:135], v[180:183], v[124:127]
  s_add_u32 s30, s30, 128
  ds_read_b128 v[164:167], v16 offset:34816
  v_mfma_f32_16x16x32_bf16 v[128:131], a[136:139], v[180:183], v[128:131]
  v_mfma_f32_16x16x32_bf16 v[132:135], a[140:143], v[180:183], v[132:135]
  s_waitcnt lgkmcnt(3)
  v_mfma_f32_16x16x32_bf16 v[136:139], a[132:135], v[184:187], v[136:139]
  ds_read_b128 v[168:171], v16 offset:36864
  v_mfma_f32_16x16x32_bf16 v[140:143], a[136:139], v[184:187], v[140:143]
  v_mfma_f32_16x16x32_bf16 v[144:147], a[140:143], v[184:187], v[144:147]
  s_waitcnt lgkmcnt(3)
  v_mfma_f32_16x16x32_bf16 v[148:151], a[132:135], v[188:191], v[148:151]
  ds_read_b128 v[172:175], v16 offset:38912
  v_mfma_f32_16x16x32_bf16 v[152:155], a[136:139], v[188:191], v[152:155]
  v_mfma_f32_16x16x32_bf16 v[156:159], a[140:143], v[188:191], v[156:159]
  s_waitcnt lgkmcnt(3)
  v_mfma_f32_16x16x32_bf16 v[64:67], a[144:147], v[160:163], v[64:67]
  ds_read_b128 v[176:179], v16 offset:40960
  v_mfma_f32_16x16x32_bf16 v[68:71], a[148:151], v[160:163], v[68:71]
  s_add_u32 m0, s31, 32768
  v_mfma_f32_16x16x32_bf16 v[72:75], a[152:155], v[160:163], v[72:75]
  s_waitcnt lgkmcnt(3)
  buffer_load_dwordx4 v10, s[8:11], s30 offen lds
  v_mfma_f32_16x16x32_bf16 v[76:79], a[144:147], v[164:167], v[76:79]
  ds_read_b128 v[180:183], v16 offset:43008
  v_mfma_f32_16x16x32_bf16 v[80:83], a[148:151], v[164:167], v[80:83]
  v_mfma_f32_16x16x32_bf16 v[84:87], a[152:155], v[164:167], v[84:87]
  s_waitcnt lgkmcnt(3)
  v_mfma_f32_16x16x32_bf16 v[88:91], a[144:147], v[168:171], v[88:91]
  ds_read_b128 v[184:187], v16 offset:45056
  v_mfma_f32_16x16x32_bf16 v[92:95], a[148:151], v[168:171], v[92:95]
  v_mfma_f32_16x16x32_bf16 v[96:99], a[152:155], v[168:171], v[96:99]
  s_waitcnt lgkmcnt(3)
  v_mfma_f32_16x16x32_bf16 v[100:103], a[144:147], v[172:175], v[100:103]
  ds_read_b128 v[188:191], v16 offset:47104
  v_mfma_f32_16x16x32_bf16 v[104:107], a[148:151], v[172:175], v[104:107]
  v_mfma_f32_16x16x32_bf16 v[108:111], a[152:155], v[172:175], v[108:111]
  s_waitcnt lgkmcnt(3)
  v_mfma_f32_16x16x32_bf16 v[112:115], a[144:147], v[176:179], v[112:115]
  ds_read_b128 v[160:163], v17 offset:32768
  v_mfma_f32_16x16x32_bf16 v[116:119], a[148:151], v[176:179], v[116:119]
  s_add_u32 m0, s31, 33792
  v_mfma_f32_16x16x32_bf16 v[120:123], a[152:155], v[176:179], v[120:123]
  s_waitcnt lgkmcnt(3)
  buffer_load_dwordx4 v11, s[8:11], s30 offen lds
  v_mfma_f32_16x16x32_bf16 v[124:127], a[144:147], v[180:183], v[124:127]
  ds_read_b128 v[164:167], v17 offset:34816
  v_mfma_f32_16x16x32_bf16 v[128:131], a[148:151], v[180:183], v[128:131]
  v_mfma_f32_16x16x32_bf16 v[132:135], a[152:155], v[180:183], v[132:135]
  s_waitcnt lgkmcnt(3)
  v_mfma_f32_16x16x32_bf16 v[136:139], a[144:147], v[184:187], v[136:139]
  ds_read_b128 v[168:171], v17 offset:36864
  v_mfma_f32_16x16x32_bf16 v[140:143], a[148:151], v[184:187], v[140:143]
  v_mfma_f32_16x16x32_bf16 v[144:147], a[152:155], v[184:187], v[144:147]
  s_waitcnt lgkmcnt(3)
  v_mfma_f32_16x16x32_bf16 v[148:151], a[144:147], v[188:191], v[148:151]
  ds_read_b128 v[172:175], v17 offset:38912
  v_mfma_f32_16x16x32_bf16 v[152:155], a[148:151], v[188:191], v[152:155]
  v_mfma_f32_16x16x32_bf16 v[156:159], a[152:155], v[188:191], v[156:159]
  s_waitcnt lgkmcnt(3)
  v_mfma_f32_16x16x32_bf16 v[64:67], a[156:159], v[160:163], v[64:67]
  ds_read_b128 v[176:179], v17 offset:40960
  v_mfma_f32_16x16x32_bf16 v[68:71], a[160:163], v[160:163], v[68:71]
  s_add_u32 m0, s31, 34816
  v_mfma_f32_16x16x32_bf16 v[72:75], a[164:167], v[160:163], v[72:75]
  s_waitcnt lgkmcnt(3)
  buffer_load_dwordx4 v12, s[8:11], s30 offen lds
  v_mfma_f32_16x16x32_bf16 v[76:79], a[156:159], v[164:167], v[76:79]
  ds_read_b128 v[180:183], v17 offset:43008
  v_mfma_f32_16x16x32_bf16 v[80:83], a[160:163], v[164:167], v[80:83]
  v_mfma_f32_16x16x32_bf16 v[84:87], a[164:167], v[164:167], v[84:87]
  s_waitcnt lgkmcnt(3)
  v_mfma_f32_16x16x32_bf16 v[88:91], a[156:159], v[168:171], v[88:91]
  ds_read_b128 v[184:187], v17 offset:45056
  v_mfma_f32_16x16x32_bf16 v[92:95], a[160:163], v[168:171], v[92:95]
  v_mfma_f32_16x16x32_bf16 v[96:99], a[164:167], v[168:171], v[96:99]
  s_waitcnt lgkmcnt(3)
  v_mfma_f32_16x16x32_bf16 v[100:103], a[156:159], v[172:175], v[100:103]
  ds_read_b128 v[188:191], v17 offset:47104
  v_mfma_f32_16x16x32_bf16 v[104:107], a[160:163], v[172:175], v[104:107]
  v_mfma_f32_16x16x32_bf16 v[108:111], a[164:167], v[172:175], v[108:111]
  s_waitcnt lgkmcnt(3)
  v_mfma_f32_16x16x32_bf16 v[112:115], a[156:159], v[176:179], v[112:115]
  ds_read_b128 v[160:163], v16 offset:49152
  v_mfma_f32_16x16x32_bf16 v[116:119], a[160:163], v[176:179], v[116:119]
  s_add_u32 m0, s31, 35840
  v_mfma_f32_16x16x32_bf16 v[120:123], a[164:167], v[176:179], v[120:123]
  s_waitcnt lgkmcnt(3)
  buffer_load_dwordx4 v13, s[8:11], s30 offen lds
  v_mfma_f32_16x16x32_bf16 v[124:127], a[156:159], v[180:183], v[124:127]
  s_add_u32 s30, s30, 128
  ds_read_b128 v[164:167], v16 offset:51200
  v_mfma_f32_16x16x32_bf16 v[128:131], a[160:163], v[180:183], v[128:131]
  v_mfma_f32_16x16x32_bf16 v[132:135], a[164:167], v[180:183], v[132:135]
  s_waitcnt lgkmcnt(3)
  v_mfma_f32_16x16x32_bf16 v[136:139], a[156:159], v[184:187], v[136:139]
  ds_read_b128 v[168:171], v16 offset:53248
  v_mfma_f32_16x16x32_bf16 v[140:143], a[160:163], v[184:187], v[140:143]
  v_mfma_f32_16x16x32_bf16 v[144:147], a[164:167], v[184:187], v[144:147]
  s_waitcnt lgkmcnt(3)
  v_mfma_f32_16x16x32_bf16 v[148:151], a[156:159], v[188:191], v[148:151]
  ds_read_b128 v[172:175], v16 offset:55296
  v_mfma_f32_16x16x32_bf16 v[152:155], a[160:163], v[188:191], v[152:155]
  v_mfma_f32_16x16x32_bf16 v[156:159], a[164:167], v[188:191], v[156:159]
  s_waitcnt lgkmcnt(3)
  v_mfma_f32_16x16x32_bf16 v[64:67], a[168:171], v[160:163], v[64:67]
  ds_read_b128 v[176:179], v16 offset:57344
  v_mfma_f32_16x16x32_bf16 v[68:71], a[172:175], v[160:163], v[68:71]
  s_add_u32 m0, s31, 49152
  v_mfma_f32_16x16x32_bf16 v[72:75], a[176:179], v[160:163], v[72:75]
  s_waitcnt lgkmcnt(3)
  buffer_load_dwordx4 v10, s[8:11], s30 offen lds
  v_mfma_f32_16x16x32_bf16 v[76:79], a[168:171], v[164:167], v[76:79]
  ds_read_b128 v[180:183], v16 offset:59392
  v_mfma_f32_16x16x32_bf16 v[80:83], a[172:175], v[164:167], v[80:83]
  v_mfma_f32_16x16x32_bf16 v[84:87], a[176:179], v[164:167], v[84:87]
  s_waitcnt lgkmcnt(3)
  v_mfma_f32_16x16x32_bf16 v[88:91], a[168:171], v[168:171], v[88:91]
  ds_read_b128 v[184:187], v16 offset:61440
  v_mfma_f32_16x16x32_bf16 v[92:95], a[172:175], v[168:171], v[92:95]
  v_mfma_f32_16x16x32_bf16 v[96:99], a[176:179], v[168:171], v[96:99]
  s_waitcnt lgkmcnt(3)
  v_mfma_f32_16x16x32_bf16 v[100:103], a[168:171], v[172:175], v[100:103]
  ds_read_b128 v[188:191], v16 offset:63488
  v_mfma_f32_16x16x32_bf16 v[104:107], a[172:175], v[172:175], v[104:107]
  v_mfma_f32_16x16x32_bf16 v[108:111], a[176:179], v[172:175], v[108:111]
  s_waitcnt lgkmcnt(3)
  v_mfma_f32_16x16x32_bf16 v[112:115], a[168:171], v[176:179], v[112:115]
  ds_read_b128 v[160:163], v17 offset:49152
  v_mfma_f32_16x16x32_bf16 v[116:119], a[172:175], v[176:179], v[116:119]
  s_add_u32 m0, s31, 50176
  v_mfma_f32_16x16x32_bf16 v[120:123], a[176:179], v[176:179], v[120:123]
  s_waitcnt lgkmcnt(3)
  buffer_load_dwordx4 v11, s[8:11], s30 offen lds
  v_mfma_f32_16x16x32_bf16 v[124:127], a[168:171], v[180:183], v[124:127]
  ds_read_b128 v[164:167], v17 offset:51200
  v_mfma_f32_16x16x32_bf16 v[128:131], a[172:175], v[180:183], v[128:131]
  v_mfma_f32_16x16x32_bf16 v[132:135], a[176:179], v[180:183], v[132:135]
  s_waitcnt lgkmcnt(3)
  v_mfma_f32_16x16x32_bf16 v[136:139], a[168:171], v[184:187], v[136:139]
  ds_read_b128 v[168:171], v17 offset:53248
  v_mfma_f32_16x16x32_bf16 v[140:143], a[172:175], v[184:187], v[140:143]
  v_mfma_f32_16x16x32_bf16 v[144:147], a[176:179], v[184:187], v[144:147]
  s_waitcnt lgkmcnt(3)
  v_mfma_f32_16x16x32_bf16 v[148:151], a[168:171], v[188:191], v[148:151]
  ds_read_b128 v[172:175], v17 offset:55296
  v_mfma_f32_16x16x32_bf16 v[152:155], a[172:175], v[188:191], v[152:155]
  v_mfma_f32_16x16x32_bf16 v[156:159], a[176:179], v[188:191], v[156:159]
  s_waitcnt lgkmcnt(3)
  v_mfma_f32_16x16x32_bf16 v[64:67], a[180:183], v[160:163], v[64:67]
  ds_read_b128 v[176:179], v17 offset:57344
  v_mfma_f32_16x16x32_bf16 v[68:71], a[184:187], v[160:163], v[68:71]
  s_add_u32 m0, s31, 51200
  v_mfma_f32_16x16x32_bf16 v[72:75], a[188:191], v[160:163], v[72:75]
  s_waitcnt lgkmcnt(3)
  buffer_load_dwordx4 v12, s[8:11], s30 offen lds
  v_mfma_f32_16x16x32_bf16 v[76:79], a[180:183], v[164:167], v[76:79]
  ds_read_b128 v[180:183], v17 offset:59392
  v_mfma_f32_16x16x32_bf16 v[80:83], a[184:187], v[164:167], v[80:83]
  v_mfma_f32_16x16x32_bf16 v[84:87], a[188:191], v[164:167], v[84:87]
  s_waitcnt lgkmcnt(3)
  v_mfma_f32_16x16x32_bf16 v[88:91], a[180:183], v[168:171], v[88:91]
  ds_read_b128 v[184:187], v17 offset:61440
  v_mfma_f32_16x16x32_bf16 v[92:95], a[184:187], v[168:171], v[92:95]
  v_mfma_f32_16x16x32_bf16 v[96:99], a[188:191], v[168:171], v[96:99]
  s_waitcnt lgkmcnt(3)
  v_mfma_f32_16x16x32_bf16 v[100:103], a[180:183], v[172:175], v[100:103]
  ds_read_b128 v[188:191], v17 offset:63488
  v_mfma_f32_16x16x32_bf16 v[104:107], a[184:187], v[172:175], v[104:107]
  v_mfma_f32_16x16x32_bf16 v[108:111], a[188:191], v[172:175], v[108:111]
  s_waitcnt lgkmcnt(3)
  v_mfma_f32_16x16x32_bf16 v[112:115], a[180:183], v[176:179], v[112:115]
  s_waitcnt vmcnt(16)
  s_barrier
  ds_read_b128 v[160:163], v18 offset:0
  v_mfma_f32_16x16x32_bf16 v[116:119], a[184:187], v[176:179], v[116:119]
  s_add_u32 m0, s31, 52224
  v_mfma_f32_16x16x32_bf16 v[120:123], a[188:191], v[176:179], v[120:123]
  s_waitcnt lgkmcnt(3)
  buffer_load_dwordx4 v13, s[8:11], s30 offen lds
  v_mfma_f32_16x16x32_bf16 v[124:127], a[180:183], v[180:183], v[124:127]
  s_add_u32 s30, s30, 128
  ds_read_b128 v[164:167], v18 offset:2048
  v_mfma_f32_16x16x32_bf16 v[128:131], a[184:187], v[180:183], v[128:131]
  v_mfma_f32_16x16x32_bf16 v[132:135], a[188:191], v[180:183], v[132:135]
  s_waitcnt lgkmcnt(3)
  v_mfma_f32_16x16x32_bf16 v[136:139], a[180:183], v[184:187], v[136:139]
  ds_read_b128 v[168:171], v18 offset:4096
  v_mfma_f32_16x16x32_bf16 v[140:143], a[184:187], v[184:187], v[140:143]
  v_mfma_f32_16x16x32_bf16 v[144:147], a[188:191], v[184:187], v[144:147]
  s_waitcnt lgkmcnt(3)
  v_mfma_f32_16x16x32_bf16 v[148:151], a[180:183], v[188:191], v[148:151]
  ds_read_b128 v[172:175], v18 offset:6144
  v_mfma_f32_16x16x32_bf16 v[152:155], a[184:187], v[188:191], v[152:155]
  v_mfma_f32_16x16x32_bf16 v[156:159], a[188:191], v[188:191], v[156:159]
  s_waitcnt lgkmcnt(3)
  v_mfma_f32_16x16x32_bf16 v[64:67], a[192:195], v[160:163], v[64:67]
  ds_read_b128 v[176:179], v18 offset:8192
  v_mfma_f32_16x16x32_bf16 v[68:71], a[196:199], v[160:163], v[68:71]
  s_add_u32 m0, s31, 65536
  v_mfma_f32_16x16x32_bf16 v[72:75], a[200:203], v[160:163], v[72:75]
  s_waitcnt lgkmcnt(3)
  buffer_load_dwordx4 v10, s[8:11], s30 offen lds
  v_mfma_f32_16x16x32_bf16 v[76:79], a[192:195], v[164:167], v[76:79]
  ds_read_b128 v[180:183], v18 offset:10240
  v_mfma_f32_16x16x32_bf16 v[80:83], a[196:199], v[164:167], v[80:83]
  v_mfma_f32_16x16x32_bf16 v[84:87], a[200:203], v[164:167], v[84:87]
  s_waitcnt lgkmcnt(3)
  v_mfma_f32_16x16x32_bf16 v[88:91], a[192:195], v[168:171], v[88:91]
  ds_read_b128 v[184:187], v18 offset:12288
  v_mfma_f32_16x16x32_bf16 v[92:95], a[196:199], v[168:171], v[92:95]
  v_mfma_f32_16x16x32_bf16 v[96:99], a[200:203], v[168:171], v[96:99]
  s_waitcnt lgkmcnt(3)
  v_mfma_f32_16x16x32_bf16 v[100:103], a[192:195], v[172:175], v[100:103]
  ds_read_b128 v[188:191], v18 offset:14336
  v_mfma_f32_16x16x32_bf16 v[104:107], a[196:199], v[172:175], v[104:107]
  v_mfma_f32_16x16x32_bf16 v[108:111], a[200:203], v[172:175], v[108:111]
  s_waitcnt lgkmcnt(3)
  v_mfma_f32_16x16x32_bf16 v[112:115], a[192:195], v[176:179], v[112:115]
  ds_read_b128 v[160:163], v19 offset:0
  v_mfma_f32_16x16x32_bf16 v[116:119], a[196:199], v[176:179], v[116:119]
  s_add_u32 m0, s31, 66560
  v_mfma_f32_16x16x32_bf16 v[120:123], a[200:203], v[176:179], v[120:123]
  s_waitcnt lgkmcnt(3)
  buffer_load_dwordx4 v11, s[8:11], s30 offen lds
  v_mfma_f32_16x16x32_bf16 v[124:127], a[192:195], v[180:183], v[124:127]
  ds_read_b128 v[164:167], v19 offset:2048
  v_mfma_f32_16x16x32_bf16 v[128:131], a[196:199], v[180:183], v[128:131]
  v_mfma_f32_16x16x32_bf16 v[132:135], a[200:203], v[180:183], v[132:135]
  s_waitcnt lgkmcnt(3)
  v_mfma_f32_16x16x32_bf16 v[136:139], a[192:195], v[184:187], v[136:139]
  ds_read_b128 v[168:171], v19 offset:4096
  v_mfma_f32_16x16x32_bf16 v[140:143], a[196:199], v[184:187], v[140:143]
  v_mfma_f32_16x16x32_bf16 v[144:147], a[200:203], v[184:187], v[144:147]
  s_waitcnt lgkmcnt(3)
  v_mfma_f32_16x16x32_bf16 v[148:151], a[192:195], v[188:191], v[148:151]
  ds_read_b128 v[172:175], v19 offset:6144
  v_mfma_f32_16x16x32_bf16 v[152:155], a[196:199], v[188:191], v[152:155]
  v_mfma_f32_16x16x32_bf16 v[156:159], a[200:203], v[188:191], v[156:159]
  s_waitcnt lgkmcnt(3)
  v_mfma_f32_16x16x32_bf16 v[64:67], a[204:207], v[160:163], v[64:67]
  ds_read_b128 v[176:179], v19 offset:8192
  v_mfma_f32_16x16x32_bf16 v[68:71], a[208:211], v[160:163], v[68:71]
  s_add_u32 m0, s31, 67584
  v_mfma_f32_16x16x32_bf16 v[72:75], a[212:215], v[160:163], v[72:75]
  s_waitcnt lgkmcnt(3)
  buffer_load_dwordx4 v12, s[8:11], s30 offen lds
  v_mfma_f32_16x16x32_bf16 v[76:79], a[204:207], v[164:167], v[76:79]
  ds_read_b128 v[180:183], v19 offset:10240
  v_mfma_f32_16x16x32_bf16 v[80:83], a[208:211], v[164:167], v[80:83]
  v_mfma_f32_16x16x32_bf16 v[84:87], a[212:215], v[164:167], v[84:87]
  s_waitcnt lgkmcnt(3)
  v_mfma_f32_16x16x32_bf16 v[88:91], a[204:207], v[168:171], v[88:91]
  ds_read_b128 v[184:187], v19 offset:12288
  v_mfma_f32_16x16x32_bf16 v[92:95], a[208:211], v[168:171], v[92:95]
  v_mfma_f32_16x16x32_bf16 v[96:99], a[212:215], v[168:171], v[96:99]
  s_waitcnt lgkmcnt(3)
  v_mfma_f32_16x16x32_bf16 v[100:103], a[204:207], v[172:175], v[100:103]
  ds_read_b128 v[188:191], v19 offset:14336
  v_mfma_f32_16x16x32_bf16 v[104:107], a[208:211], v[172:175], v[104:107]
  v_mfma_f32_16x16x32_bf16 v[108:111], a[212:215], v[172:175], v[108:111]
  s_waitcnt lgkmcnt(3)
  v_mfma_f32_16x16x32_bf16 v[112:115], a[204:207], v[176:179], v[112:115]
  ds_read_b128 v[160:163], v18 offset:16384
  v_mfma_f32_16x16x32_bf16 v[116:119], a[208:211], v[176:179], v[116:119]
  s_add_u32 m0, s31, 68608
  v_mfma_f32_16x16x32_bf16 v[120:123], a[212:215], v[176:179], v[120:123]
  s_waitcnt lgkmcnt(3)
  buffer_load_dwordx4 v13, s[8:11], s30 offen lds
  v_mfma_f32_16x16x32_bf16 v[124:127], a[204:207], v[180:183], v[124:127]
  s_add_u32 s30, s30, 128
  ds_read_b128 v[164:167], v18 offset:18432
  v_mfma_f32_16x16x32_bf16 v[128:131], a[208:211], v[180:183], v[128:131]
  v_mfma_f32_16x16x32_bf16 v[132:135], a[212:215], v[180:183], v[132:135]
  s_waitcnt lgkmcnt(3)
  v_mfma_f32_16x16x32_bf16 v[136:139], a[204:207], v[184:187], v[136:139]
  ds_read_b128 v[168:171], v18 offset:20480
  v_mfma_f32_16x16x32_bf16 v[140:143], a[208:211], v[184:187], v[140:143]
  v_mfma_f32_16x16x32_bf16 v[144:147], a[212:215], v[184:187], v[144:147]
  s_waitcnt lgkmcnt(3)
  v_mfma_f32_16x16x32_bf16 v[148:151], a[204:207], v[188:191], v[148:151]
  ds_read_b128 v[172:175], v18 offset:22528
  v_mfma_f32_16x16x32_bf16 v[152:155], a[208:211], v[188:191], v[152:155]
  v_mfma_f32_16x16x32_bf16 v[156:159], a[212:215], v[188:191], v[156:159]
  s_waitcnt lgkmcnt(3)
  v_mfma_f32_16x16x32_bf16 v[64:67], a[216:219], v[160:163], v[64:67]
  ds_read_b128 v[176:179], v18 offset:24576
  v_mfma_f32_16x16x32_bf16 v[68:71], a[220:223], v[160:163], v[68:71]
  s_add_u32 m0, s31, 81920
  v_mfma_f32_16x16x32_bf16 v[72:75], a[224:227], v[160:163], v[72:75]
  s_waitcnt lgkmcnt(3)
  buffer_load_dwordx4 v10, s[8:11], s30 offen lds
  v_mfma_f32_16x16x32_bf16 v[76:79], a[216:219], v[164:167], v[76:79]
  ds_read_b128 v[180:183], v18 offset:26624
  v_mfma_f32_16x16x32_bf16 v[80:83], a[220:223], v[164:167], v[80:83]
  v_mfma_f32_16x16x32_bf16 v[84:87], a[224:227], v[164:167], v[84:87]
  s_waitcnt lgkmcnt(3)
  v_mfma_f32_16x16x32_bf16 v[88:91], a[216:219], v[168:171], v[88:91]
  ds_read_b128 v[184:187], v18 offset:28672
  v_mfma_f32_16x16x32_bf16 v[92:95], a[220:223], v[168:171], v[92:95]
  s_add_u32 m0, s31, 82944
  v_mfma_f32_16x16x32_bf16 v[96:99], a[224:227], v[168:171], v[96:99]
  s_waitcnt lgkmcnt(3)
  buffer_load_dwordx4 v11, s[8:11], s30 offen lds
  v_mfma_f32_16x16x32_bf16 v[100:103], a[216:219], v[172:175], v[100:103]
  ds_read_b128 v[188:191], v18 offset:30720
  v_mfma_f32_16x16x32_bf16 v[104:107], a[220:223], v[172:175], v[104:107]
  v_mfma_f32_16x16x32_bf16 v[108:111], a[224:227], v[172:175], v[108:111]
  s_waitcnt lgkmcnt(3)
  v_mfma_f32_16x16x32_bf16 v[112:115], a[216:219], v[176:179], v[112:115]
  ds_read_b128 v[160:163], v19 offset:16384
  v_mfma_f32_16x16x32_bf16 v[116:119], a[220:223], v[176:179], v[116:119]
  s_add_u32 m0, s31, 83968
  v_mfma_f32_16x16x32_bf16 v[120:123], a[224:227], v[176:179], v[120:123]
  s_waitcnt lgkmcnt(3)
  buffer_load_dwordx4 v12, s[8:11], s30 offen lds
  v_mfma_f32_16x16x32_bf16 v[124:127], a[216:219], v[180:183], v[124:127]
  ds_read_b128 v[164:167], v19 offset:18432
  v_mfma_f32_16x16x32_bf16 v[128:131], a[220:223], v[180:183], v[128:131]
  v_mfma_f32_16x16x32_bf16 v[132:135], a[224:227], v[180:183], v[132:135]
  s_waitcnt lgkmcnt(3)
  v_mfma_f32_16x16x32_bf16 v[136:139], a[216:219], v[184:187], v[136:139]
  ds_read_b128 v[168:171], v19 offset:20480
  v_mfma_f32_16x16x32_bf16 v[140:143], a[220:223], v[184:187], v[140:143]
  s_add_u32 m0, s31, 84992
  v_mfma_f32_16x16x32_bf16 v[144:147], a[224:227], v[184:187], v[144:147]
  s_waitcnt lgkmcnt(3)
  buffer_load_dwordx4 v13, s[8:11], s30 offen lds
  v_mfma_f32_16x16x32_bf16 v[148:151], a[216:219], v[188:191], v[148:151]
  s_add_u32 s30, s30, 128
  ds_read_b128 v[172:175], v19 offset:22528
  v_mfma_f32_16x16x32_bf16 v[152:155], a[220:223], v[188:191], v[152:155]
  v_mfma_f32_16x16x32_bf16 v[156:159], a[224:227], v[188:191], v[156:159]
  s_waitcnt lgkmcnt(3)
  v_mfma_f32_16x16x32_bf16 v[64:67], a[228:231], v[160:163], v[64:67]
  ds_read_b128 v[176:179], v19 offset:24576
  v_mfma_f32_16x16x32_bf16 v[68:71], a[232:235], v[160:163], v[68:71]
  v_mfma_f32_16x16x32_bf16 v[72:75], a[236:239], v[160:163], v[72:75]
  s_waitcnt lgkmcnt(3)
  v_mfma_f32_16x16x32_bf16 v[76:79], a[228:231], v[164:167], v[76:79]
  ds_read_b128 v[180:183], v19 offset:26624
  v_cvt_pk_bf16_f32 v192, v64, v65
  v_mfma_f32_16x16x32_bf16 v[80:83], a[232:235], v[164:167], v[80:83]
  v_cvt_pk_bf16_f32 v193, v66, v67
  v_cvt_pk_bf16_f32 v194, v68, v69
  v_mfma_f32_16x16x32_bf16 v[84:87], a[236:239], v[164:167], v[84:87]
  s_waitcnt lgkmcnt(3)
  v_cvt_pk_bf16_f32 v195, v70, v71
  v_cvt_pk_bf16_f32 v200, v72, v73
  v_mfma_f32_16x16x32_bf16 v[88:91], a[228:231], v[168:171], v[88:91]
  ds_read_b128 v[184:187], v19 offset:28672
  v_cvt_pk_bf16_f32 v201, v74, v75
  v_mfma_f32_16x16x32_bf16 v[92:95], a[232:235], v[168:171], v[92:95]
  v_cvt_pk_bf16_f32 v196, v76, v77
  v_cvt_pk_bf16_f32 v197, v78, v79
  v_mfma_f32_16x16x32_bf16 v[96:99], a[236:239], v[168:171], v[96:99]
  s_waitcnt lgkmcnt(3)
  v_cvt_pk_bf16_f32 v198, v80, v81
  v_cvt_pk_bf16_f32 v199, v82, v83
  v_mfma_f32_16x16x32_bf16 v[100:103], a[228:231], v[172:175], v[100:103]
  ds_read_b128 v[188:191], v19 offset:30720
  v_cvt_pk_bf16_f32 v202, v84, v85
  v_mfma_f32_16x16x32_bf16 v[104:107], a[232:235], v[172:175], v[104:107]
  v_cvt_pk_bf16_f32 v203, v86, v87
  v_cvt_pk_bf16_f32 v204, v88, v89
  v_mfma_f32_16x16x32_bf16 v[108:111], a[236:239], v[172:175], v[108:111]
  s_waitcnt lgkmcnt(3)
  v_cvt_pk_bf16_f32 v205, v90, v91
  v_cvt_pk_bf16_f32 v206, v92, v93
  v_mfma_f32_16x16x32_bf16 v[112:115], a[228:231], v[176:179], v[112:115]
  s_waitcnt vmcnt(16)
  s_barrier
  ds_read_b128 v[160:163], v14 offset:0
  v_mfma_f32_16x16x32_bf16 v[116:119], a[232:235], v[176:179], v[116:119]
  v_cvt_pk_bf16_f32 v207, v94, v95
  v_cvt_pk_bf16_f32 v212, v96, v97
  v_mfma_f32_16x16x32_bf16 v[120:123], a[236:239], v[176:179], v[120:123]
  s_waitcnt lgkmcnt(3)
  v_cvt_pk_bf16_f32 v213, v98, v99
  v_cvt_pk_bf16_f32 v208, v100, v101
  v_mfma_f32_16x16x32_bf16 v[124:127], a[228:231], v[180:183], v[124:127]
  ds_read_b128 v[164:167], v14 offset:2048
  v_cvt_pk_bf16_f32 v209, v102, v103
  v_mfma_f32_16x16x32_bf16 v[128:131], a[232:235], v[180:183], v[128:131]
  v_cvt_pk_bf16_f32 v210, v104, v105
  v_cvt_pk_bf16_f32 v211, v106, v107
  v_mfma_f32_16x16x32_bf16 v[132:135], a[236:239], v[180:183], v[132:135]
  s_waitcnt lgkmcnt(3)
  v_cvt_pk_bf16_f32 v214, v108, v109
  v_cvt_pk_bf16_f32 v215, v110, v111
  v_mfma_f32_16x16x32_bf16 v[136:139], a[228:231], v[184:187], v[136:139]
  ds_read_b128 v[168:171], v14 offset:4096
  v_cvt_pk_bf16_f32 v216, v112, v113
  v_mfma_f32_16x16x32_bf16 v[140:143], a[232:235], v[184:187], v[140:143]
  v_cvt_pk_bf16_f32 v217, v114, v115
  v_cvt_pk_bf16_f32 v218, v116, v117
  v_mfma_f32_16x16x32_bf16 v[144:147], a[236:239], v[184:187], v[144:147]
  s_waitcnt lgkmcnt(3)
  v_cvt_pk_bf16_f32 v219, v118, v119
  v_cvt_pk_bf16_f32 v224, v120, v121
  v_mfma_f32_16x16x32_bf16 v[148:151], a[228:231], v[188:191], v[148:151]
  ds_read_b128 v[172:175], v14 offset:6144
  v_cvt_pk_bf16_f32 v225, v122, v123
  v_mfma_f32_16x16x32_bf16 v[152:155], a[232:235], v[188:191], v[152:155]
  s_sub_u32 s26, s26, 1
  s_cmp_gt_u32 s26, 0
  v_cvt_pk_bf16_f32 v220, v124, v125
  v_mfma_f32_16x16x32_bf16 v[156:159], a[236:239], v[188:191], v[156:159]
  s_waitcnt lgkmcnt(3)
  s_cbranch_scc1 kvs_241
  s_nop 7
  v_cvt_pk_bf16_f32 v221, v126, v127
  v_cvt_pk_bf16_f32 v222, v128, v129
  v_cvt_pk_bf16_f32 v223, v130, v131
  v_cvt_pk_bf16_f32 v226, v132, v133
  v_cvt_pk_bf16_f32 v227, v134, v135
  v_cvt_pk_bf16_f32 v228, v136, v137
  v_cvt_pk_bf16_f32 v229, v138, v139
  v_cvt_pk_bf16_f32 v230, v140, v141
  v_cvt_pk_bf16_f32 v231, v142, v143
  v_cvt_pk_bf16_f32 v236, v144, v145
  v_cvt_pk_bf16_f32 v237, v146, v147
  v_cvt_pk_bf16_f32 v232, v148, v149
  v_cvt_pk_bf16_f32 v233, v150, v151
  v_cvt_pk_bf16_f32 v234, v152, v153
  v_cvt_pk_bf16_f32 v235, v154, v155
  v_cvt_pk_bf16_f32 v238, v156, v157
  v_cvt_pk_bf16_f32 v239, v158, v159
  s_xor_b32 s29, s48, 0
  buffer_store_dwordx4 v[192:195], v26, s[16:19], s29 offen offset:0 sc1
  buffer_store_dwordx4 v[196:199], v26, s[16:19], s29 offen offset:1024 sc1
  buffer_store_dwordx4 v[200:203], v26, s[16:19], s29 offen offset:2048 sc1
  s_xor_b32 s29, s48, 2105344
  buffer_store_dwordx4 v[204:207], v26, s[16:19], s29 offen offset:0 sc1
  buffer_store_dwordx4 v[208:211], v26, s[16:19], s29 offen offset:1024 sc1
  buffer_store_dwordx4 v[212:215], v26, s[16:19], s29 offen offset:2048 sc1
  s_xor_b32 s29, s48, 4194304
  buffer_store_dwordx4 v[216:219], v26, s[16:19], s29 offen offset:0 sc1
  buffer_store_dwordx4 v[220:223], v26, s[16:19], s29 offen offset:1024 sc1
  buffer_store_dwordx4 v[224:227], v26, s[16:19], s29 offen offset:2048 sc1
  s_xor_b32 s29, s48, 6299648
  buffer_store_dwordx4 v[228:231], v26, s[16:19], s29 offen offset:0 sc1
  buffer_store_dwordx4 v[232:235], v26, s[16:19], s29 offen offset:1024 sc1
  buffer_store_dwordx4 v[236:239], v26, s[16:19], s29 offen offset:2048 sc1
  s_waitcnt vmcnt(0) lgkmcnt(0)
  s_barrier
  buffer_atomic_add v28, v27, s[72:75], s61 offen sc1
  s_bitcmp1_b32 s3, 0
  s_cbranch_scc1 queue
  s_lshr_b32 s2, s3, 1
  s_mov_b32 s40, 13
  s_mov_b32 s41, 3
  s_waitcnt vmcnt(0)
  s_barrier
  s_branch q_entry
  s_branch queue
not_kv:
  s_cmp_ge_u32 s3, 96
  s_cbranch_scc1 not_vw
  s_sub_u32 s2, s3, 64
  s_load_dwordx2 s[6:7], s[0:1], 40
  s_load_dwordx2 s[38:39], s[0:1], 104
  v_lshlrev_b32 v4, 4, v1
  s_waitcnt lgkmcnt(0)
  s_mov_b32 s12, s6
  s_mov_b32 s13, s7
  s_mov_b32 s14, 7864320
  s_mov_b32 s15, 0x00020000
  s_mov_b32 s16, s38
  s_mov_b32 s17, s39
  s_mov_b32 s18, 218103808
  s_mov_b32 s19, 0x00020000
  s_add_u32 s72, s38, 173080576
  s_addc_u32 s73, s39, 0
  s_mov_b32 s74, 49152
  s_mov_b32 s75, 0x00020000
  s_mul_i32 s40, s2, 245760
  s_mul_i32 s22, s20, 30720
  s_add_u32 s40, s40, s22
  s_add_u32 m0, s22, 0
  s_add_u32 s21, s40, 0
  buffer_load_dwordx4 v4, s[12:15], s21 offen offset:0 lds
  buffer_load_dwordx4 v4, s[12:15], s21 offen offset:1024 lds
  buffer_load_dwordx4 v4, s[12:15], s21 offen offset:2048 lds
  buffer_load_dwordx4 v4, s[12:15], s21 offen offset:3072 lds
  s_add_u32 m0, s22, 4096
  s_add_u32 s21, s40, 4096
  buffer_load_dwordx4 v4, s[12:15], s21 offen offset:0 lds
  buffer_load_dwordx4 v4, s[12:15], s21 offen offset:1024 lds
  buffer_load_dwordx4 v4, s[12:15], s21 offen offset:2048 lds
  buffer_load_dwordx4 v4, s[12:15], s21 offen offset:3072 lds
  s_add_u32 m0, s22, 8192
  s_add_u32 s21, s40, 8192
  buffer_load_dwordx4 v4, s[12:15], s21 offen offset:0 lds
  buffer_load_dwordx4 v4, s[12:15], s21 offen offset:1024 lds
  buffer_load_dwordx4 v4, s[12:15], s21 offen offset:2048 lds
  buffer_load_dwordx4 v4, s[12:15], s21 offen offset:3072 lds
  s_add_u32 m0, s22, 12288
  s_add_u32 s21, s40, 12288
  buffer_load_dwordx4 v4, s[12:15], s21 offen offset:0 lds
  buffer_load_dwordx4 v4, s[12:15], s21 offen offset:1024 lds
  buffer_load_dwordx4 v4, s[12:15], s21 offen offset:2048 lds
  buffer_load_dwordx4 v4, s[12:15], s21 offen offset:3072 lds
  s_add_u32 m0, s22, 16384
  s_add_u32 s21, s40, 16384
  buffer_load_dwordx4 v4, s[12:15], s21 offen offset:0 lds
  buffer_load_dwordx4 v4, s[12:15], s21 offen offset:1024 lds
  buffer_load_dwordx4 v4, s[12:15], s21 offen offset:2048 lds
  buffer_load_dwordx4 v4, s[12:15], s21 offen offset:3072 lds
  s_add_u32 m0, s22, 20480
  s_add_u32 s21, s40, 20480
  buffer_load_dwordx4 v4, s[12:15], s21 offen offset:0 lds
  buffer_load_dwordx4 v4, s[12:15], s21 offen offset:1024 lds
  buffer_load_dwordx4 v4, s[12:15], s21 offen offset:2048 lds
  buffer_load_dwordx4 v4, s[12:15], s21 offen offset:3072 lds
  s_add_u32 m0, s22, 24576
  s_add_u32 s21, s40, 24576
  buffer_load_dwordx4 v4, s[12:15], s21 offen offset:0 lds
  buffer_load_dwordx4 v4, s[12:15], s21 offen offset:1024 lds
  buffer_load_dwordx4 v4, s[12:15], s21 offen offset:2048 lds
  buffer_load_dwordx4 v4, s[12:15], s21 offen offset:3072 lds
  s_add_u32 m0, s22, 28672
  s_add_u32 s21, s40, 28672
  buffer_load_dwordx4 v4, s[12:15], s21 offen offset:0 lds
  buffer_load_dwordx4 v4, s[12:15], s21 offen offset:1024 lds
  s_add_u32 s21, s40, 122880
  buffer_load_dwordx4 v[64:67], v4, s[12:15], s21 offen offset:0
  buffer_load_dwordx4 v[68:71], v4, s[12:15], s21 offen offset:1024
  buffer_load_dwordx4 v[72:75], v4, s[12:15], s21 offen offset:2048
  buffer_load_dwordx4 v[76:79], v4, s[12:15], s21 offen offset:3072
  s_add_u32 s21, s40, 126976
  buffer_load_dwordx4 v[80:83], v4, s[12:15], s21 offen offset:0
  buffer_load_dwordx4 v[84:87], v4, s[12:15], s21 offen offset:1024
  buffer_load_dwordx4 v[88:91], v4, s[12:15], s21 offen offset:2048
  buffer_load_dwordx4 v[92:95], v4, s[12:15], s21 offen offset:3072
  s_add_u32 s21, s40, 131072
  buffer_load_dwordx4 v[96:99], v4, s[12:15], s21 offen offset:0
  buffer_load_dwordx4 v[100:103], v4, s[12:15], s21 offen offset:1024
  buffer_load_dwordx4 v[104:107], v4, s[12:15], s21 offen offset:2048
  buffer_load_dwordx4 v[108:111], v4, s[12:15], s21 offen offset:3072
  s_add_u32 s21, s40, 135168
  buffer_load_dwordx4 v[112:115], v4, s[12:15], s21 offen offset:0
  buffer_load_dwordx4 v[116:119], v4, s[12:15], s21 offen offset:1024
  buffer_load_dwordx4 v[120:123], v4, s[12:15], s21 offen offset:2048
  buffer_load_dwordx4 v[124:127], v4, s[12:15], s21 offen offset:3072
  s_add_u32 s21, s40, 139264
  buffer_load_dwordx4 v[128:131], v4, s[12:15], s21 offen offset:0
  buffer_load_dwordx4 v[132:135], v4, s[12:15], s21 offen offset:1024
  buffer_load_dwordx4 v[136:139], v4, s[12:15], s21 offen offset:2048
  buffer_load_dwordx4 v[140:143], v4, s[12:15], s21 offen offset:3072
  s_add_u32 s21, s40, 143360
  buffer_load_dwordx4 v[144:147], v4, s[12:15], s21 offen offset:0
  buffer_load_dwordx4 v[148:151], v4, s[12:15], s21 offen offset:1024
  buffer_load_dwordx4 v[152:155], v4, s[12:15], s21 offen offset:2048
  buffer_load_dwordx4 v[156:159], v4, s[12:15], s21 offen offset:3072
  s_add_u32 s21, s40, 147456
  buffer_load_dwordx4 v[160:163], v4, s[12:15], s21 offen offset:0
  buffer_load_dwordx4 v[164:167], v4, s[12:15], s21 offen offset:1024
  buffer_load_dwordx4 v[168:171], v4, s[12:15], s21 offen offset:2048
  buffer_load_dwordx4 v[172:175], v4, s[12:15], s21 offen offset:3072
  s_add_u32 s21, s40, 151552
  buffer_load_dwordx4 v[176:179], v4, s[12:15], s21 offen offset:0
  buffer_load_dwordx4 v[180:183], v4, s[12:15], s21 offen offset:1024
  v_lshrrev_b32 v6, 2, v2
  v_lshl_add_u32 v6, v3, 2, v6
  v_mul_u32_u24 v6, 1280, v6
  v_and_b32 v7, 3, v2
  v_lshlrev_b32 v7, 3, v7
  s_mul_i32 s21, s20, 320
  v_add3_u32 v6, v6, v7, s21
  v_add_u32 v8, v6, v7
  v_add_u32 v7, 61440, v6
  v_add_u32 v9, 61440, v8
  v_add_u32 v5, s22, v4
  s_waitcnt vmcnt(30)
  s_load_dwordx2 s[36:37], s[0:1], 16
  s_lshl_b32 s23, s2, 2
  s_add_u32 s23, s23, s20
  s_mul_i32 s23, s23, 61440
  s_add_u32 s23, s23, 0
  s_waitcnt lgkmcnt(0)
  s_mov_b32 s24, s36
  s_mov_b32 s25, s37
  s_mov_b32 s26, 7864320
  s_mov_b32 s27, 0x00020000
  buffer_load_dwordx4 v[200:203], v4, s[24:27], s23 offen offset:0
  buffer_load_dwordx4 v[200:203], v4, s[24:27], s23 offen offset:1024
  buffer_load_dwordx4 v[200:203], v4, s[24:27], s23 offen offset:2048
  buffer_load_dwordx4 v[200:203], v4, s[24:27], s23 offen offset:3072
  s_add_u32 s23, s23, 4096
  buffer_load_dwordx4 v[200:203], v4, s[24:27], s23 offen offset:0
  buffer_load_dwordx4 v[200:203], v4, s[24:27], s23 offen offset:1024
  buffer_load_dwordx4 v[200:203], v4, s[24:27], s23 offen offset:2048
  buffer_load_dwordx4 v[200:203], v4, s[24:27], s23 offen offset:3072
  s_add_u32 s23, s23, 4096
  buffer_load_dwordx4 v[200:203], v4, s[24:27], s23 offen offset:0
  buffer_load_dwordx4 v[200:203], v4, s[24:27], s23 offen offset:1024
  buffer_load_dwordx4 v[200:203], v4, s[24:27], s23 offen offset:2048
  buffer_load_dwordx4 v[200:203], v4, s[24:27], s23 offen offset:3072
  s_add_u32 s23, s23, 4096
  buffer_load_dwordx4 v[200:203], v4, s[24:27], s23 offen offset:0
  buffer_load_dwordx4 v[200:203], v4, s[24:27], s23 offen offset:1024
  buffer_load_dwordx4 v[200:203], v4, s[24:27], s23 offen offset:2048
  buffer_load_dwordx4 v[200:203], v4, s[24:27], s23 offen offset:3072
  s_add_u32 s23, s23, 4096
  buffer_load_dwordx4 v[200:203], v4, s[24:27], s23 offen offset:0
  buffer_load_dwordx4 v[200:203], v4, s[24:27], s23 offen offset:1024
  buffer_load_dwordx4 v[200:203], v4, s[24:27], s23 offen offset:2048
  buffer_load_dwordx4 v[200:203], v4, s[24:27], s23 offen offset:3072
  s_add_u32 s23, s23, 4096
  buffer_load_dwordx4 v[200:203], v4, s[24:27], s23 offen offset:0
  buffer_load_dwordx4 v[200:203], v4, s[24:27], s23 offen offset:1024
  buffer_load_dwordx4 v[200:203], v4, s[24:27], s23 offen offset:2048
  buffer_load_dwordx4 v[200:203], v4, s[24:27], s23 offen offset:3072
  s_add_u32 s23, s23, 4096
  buffer_load_dwordx4 v[200:203], v4, s[24:27], s23 offen offset:0
  buffer_load_dwordx4 v[200:203], v4, s[24:27], s23 offen offset:1024
  buffer_load_dwordx4 v[200:203], v4, s[24:27], s23 offen offset:2048
  buffer_load_dwordx4 v[200:203], v4, s[24:27], s23 offen offset:3072
  s_add_u32 s23, s23, 4096
  buffer_load_dwordx4 v[200:203], v4, s[24:27], s23 offen offset:0
  buffer_load_dwordx4 v[200:203], v4, s[24:27], s23 offen offset:1024
  s_barrier
  ds_read_b64_tr_b16 a[0:1], v8 offset:0
  ds_read_b64_tr_b16 a[2:3], v8 offset:20480
  ds_read_b64_tr_b16 a[24:25], v8 offset:8
  ds_read_b64_tr_b16 a[26:27], v8 offset:20488
  ds_read_b64_tr_b16 a[48:49], v6 offset:64
  ds_read_b64_tr_b16 a[50:51], v6 offset:20544
  ds_read_b64_tr_b16 a[72:73], v8 offset:96
  ds_read_b64_tr_b16 a[74:75], v8 offset:20576
  ds_read_b64_tr_b16 a[96:97], v8 offset:104
  ds_read_b64_tr_b16 a[98:99], v8 offset:20584
  ds_read_b64_tr_b16 a[120:121], v8 offset:160
  ds_read_b64_tr_b16 a[122:123], v8 offset:20640
  ds_read_b64_tr_b16 a[144:145], v8 offset:168
  ds_read_b64_tr_b16 a[146:147], v8 offset:20648
  ds_read_b64_tr_b16 a[168:169], v6 offset:224
  ds_read_b64_tr_b16 a[170:171], v6 offset:20704
  ds_read_b64_tr_b16 a[192:193], v8 offset:256
  ds_read_b64_tr_b16 a[194:195], v8 offset:20736
  ds_read_b64_tr_b16 a[216:217], v8 offset:264
  ds_read_b64_tr_b16 a[218:219], v8 offset:20744
  ds_read_b64_tr_b16 a[4:5], v9 offset:0
  ds_read_b64_tr_b16 a[6:7], v9 offset:20480
  ds_read_b64_tr_b16 a[28:29], v9 offset:8
  ds_read_b64_tr_b16 a[30:31], v9 offset:20488
  ds_read_b64_tr_b16 a[52:53], v7 offset:64
  ds_read_b64_tr_b16 a[54:55], v7 offset:20544
  ds_read_b64_tr_b16 a[76:77], v9 offset:96
  ds_read_b64_tr_b16 a[78:79], v9 offset:20576
  ds_read_b64_tr_b16 a[100:101], v9 offset:104
  ds_read_b64_tr_b16 a[102:103], v9 offset:20584
  ds_read_b64_tr_b16 a[124:125], v9 offset:160
  ds_read_b64_tr_b16 a[126:127], v9 offset:20640
  ds_read_b64_tr_b16 a[148:149], v9 offset:168
  ds_read_b64_tr_b16 a[150:151], v9 offset:20648
  ds_read_b64_tr_b16 a[172:173], v7 offset:224
  ds_read_b64_tr_b16 a[174:175], v7 offset:20704
  ds_read_b64_tr_b16 a[196:197], v9 offset:256
  ds_read_b64_tr_b16 a[198:199], v9 offset:20736
  ds_read_b64_tr_b16 a[220:221], v9 offset:264
  ds_read_b64_tr_b16 a[222:223], v9 offset:20744
  ds_read_b64_tr_b16 a[8:9], v8 offset:40960
  ds_read_b64_tr_b16 a[10:11], v9 offset:40960
  ds_read_b64_tr_b16 a[32:33], v8 offset:40968
  ds_read_b64_tr_b16 a[34:35], v9 offset:40968
  ds_read_b64_tr_b16 a[56:57], v6 offset:41024
  ds_read_b64_tr_b16 a[58:59], v7 offset:41024
  ds_read_b64_tr_b16 a[80:81], v8 offset:41056
  ds_read_b64_tr_b16 a[82:83], v9 offset:41056
  ds_read_b64_tr_b16 a[104:105], v8 offset:41064
  ds_read_b64_tr_b16 a[106:107], v9 offset:41064
  ds_read_b64_tr_b16 a[128:129], v8 offset:41120
  ds_read_b64_tr_b16 a[130:131], v9 offset:41120
  ds_read_b64_tr_b16 a[152:153], v8 offset:41128
  ds_read_b64_tr_b16 a[154:155], v9 offset:41128
  ds_read_b64_tr_b16 a[176:177], v6 offset:41184
  ds_read_b64_tr_b16 a[178:179], v7 offset:41184
  ds_read_b64_tr_b16 a[200:201], v8 offset:41216
  ds_read_b64_tr_b16 a[202:203], v9 offset:41216
  ds_read_b64_tr_b16 a[224:225], v8 offset:41224
  ds_read_b64_tr_b16 a[226:227], v9 offset:41224
  s_waitcnt lgkmcnt(0)
  s_barrier
  s_waitcnt vmcnt(30)
  ds_write_b128 v5, v[64:67] offset:0
  ds_write_b128 v5, v[68:71] offset:1024
  ds_write_b128 v5, v[72:75] offset:2048
  ds_write_b128 v5, v[76:79] offset:3072
  ds_write_b128 v5, v[80:83] offset:4096
  ds_write_b128 v5, v[84:87] offset:5120
  ds_write_b128 v5, v[88:91] offset:6144
  ds_write_b128 v5, v[92:95] offset:7168
  ds_write_b128 v5, v[96:99] offset:8192
  ds_write_b128 v5, v[100:103] offset:9216
  ds_write_b128 v5, v[104:107] offset:10240
  ds_write_b128 v5, v[108:111] offset:11264
  ds_write_b128 v5, v[112:115] offset:12288
  ds_write_b128 v5, v[116:119] offset:13312
  ds_write_b128 v5, v[120:123] offset:14336
  ds_write_b128 v5, v[124:127] offset:15360
  ds_write_b128 v5, v[128:131] offset:16384
  ds_write_b128 v5, v[132:135] offset:17408
  ds_write_b128 v5, v[136:139] offset:18432
  ds_write_b128 v5, v[140:143] offset:19456
  ds_write_b128 v5, v[144:147] offset:20480
  ds_write_b128 v5, v[148:151] offset:21504
  ds_write_b128 v5, v[152:155] offset:22528
  ds_write_b128 v5, v[156:159] offset:23552
  ds_write_b128 v5, v[160:163] offset:24576
  ds_write_b128 v5, v[164:167] offset:25600
  ds_write_b128 v5, v[168:171] offset:26624
  ds_write_b128 v5, v[172:175] offset:27648
  ds_write_b128 v5, v[176:179] offset:28672
  ds_write_b128 v5, v[180:183] offset:29696
  s_waitcnt lgkmcnt(0)
  s_barrier
  ds_read_b64_tr_b16 a[12:13], v8 offset:0
  ds_read_b64_tr_b16 a[14:15], v8 offset:20480
  ds_read_b64_tr_b16 a[36:37], v8 offset:8
  ds_read_b64_tr_b16 a[38:39], v8 offset:20488
  ds_read_b64_tr_b16 a[60:61], v6 offset:64
  ds_read_b64_tr_b16 a[62:63], v6 offset:20544
  ds_read_b64_tr_b16 a[84:85], v8 offset:96
  ds_read_b64_tr_b16 a[86:87], v8 offset:20576
  ds_read_b64_tr_b16 a[108:109], v8 offset:104
  ds_read_b64_tr_b16 a[110:111], v8 offset:20584
  ds_read_b64_tr_b16 a[132:133], v8 offset:160
  ds_read_b64_tr_b16 a[134:135], v8 offset:20640
  ds_read_b64_tr_b16 a[156:157], v8 offset:168
  ds_read_b64_tr_b16 a[158:159], v8 offset:20648
  ds_read_b64_tr_b16 a[180:181], v6 offset:224
  ds_read_b64_tr_b16 a[182:183], v6 offset:20704
  ds_read_b64_tr_b16 a[204:205], v8 offset:256
  ds_read_b64_tr_b16 a[206:207], v8 offset:20736
  ds_read_b64_tr_b16 a[228:229], v8 offset:264
  ds_read_b64_tr_b16 a[230:231], v8 offset:20744
  ds_read_b64_tr_b16 a[16:17], v9 offset:0
  ds_read_b64_tr_b16 a[18:19], v9 offset:20480
  ds_read_b64_tr_b16 a[40:41], v9 offset:8
  ds_read_b64_tr_b16 a[42:43], v9 offset:20488
  ds_read_b64_tr_b16 a[64:65], v7 offset:64
  ds_read_b64_tr_b16 a[66:67], v7 offset:20544
  ds_read_b64_tr_b16 a[88:89], v9 offset:96
  ds_read_b64_tr_b16 a[90:91], v9 offset:20576
  ds_read_b64_tr_b16 a[112:113], v9 offset:104
  ds_read_b64_tr_b16 a[114:115], v9 offset:20584
  ds_read_b64_tr_b16 a[136:137], v9 offset:160
  ds_read_b64_tr_b16 a[138:139], v9 offset:20640
  ds_read_b64_tr_b16 a[160:161], v9 offset:168
  ds_read_b64_tr_b16 a[162:163], v9 offset:20648
  ds_read_b64_tr_b16 a[184:185], v7 offset:224
  ds_read_b64_tr_b16 a[186:187], v7 offset:20704
  ds_read_b64_tr_b16 a[208:209], v9 offset:256
  ds_read_b64_tr_b16 a[210:211], v9 offset:20736
  ds_read_b64_tr_b16 a[232:233], v9 offset:264
  ds_read_b64_tr_b16 a[234:235], v9 offset:20744
  ds_read_b64_tr_b16 a[20:21], v8 offset:40960
  ds_read_b64_tr_b16 a[22:23], v9 offset:40960
  ds_read_b64_tr_b16 a[44:45], v8 offset:40968
  ds_read_b64_tr_b16 a[46:47], v9 offset:40968
  ds_read_b64_tr_b16 a[68:69], v6 offset:41024
  ds_read_b64_tr_b16 a[70:71], v7 offset:41024
  ds_read_b64_tr_b16 a[92:93], v8 offset:41056
  ds_read_b64_tr_b16 a[94:95], v9 offset:41056
  ds_read_b64_tr_b16 a[116:117], v8 offset:41064
  ds_read_b64_tr_b16 a[118:119], v9 offset:41064
  ds_read_b64_tr_b16 a[140:141], v8 offset:41120
  ds_read_b64_tr_b16 a[142:143], v9 offset:41120
  ds_read_b64_tr_b16 a[164:165], v8 offset:41128
  ds_read_b64_tr_b16 a[166:167], v9 offset:41128
  ds_read_b64_tr_b16 a[188:189], v6 offset:41184
  ds_read_b64_tr_b16 a[190:191], v7 offset:41184
  ds_read_b64_tr_b16 a[212:213], v8 offset:41216
  ds_read_b64_tr_b16 a[214:215], v9 offset:41216
  ds_read_b64_tr_b16 a[236:237], v8 offset:41224
  ds_read_b64_tr_b16 a[238:239], v9 offset:41224
  s_waitcnt lgkmcnt(0)
  s_barrier
  s_load_dwordx2 s[32:33], s[0:1], 96
  s_waitcnt lgkmcnt(0)
  s_mov_b32 s32, s32
  s_mov_b32 s33, s33
  s_mov_b32 s34, 256
  s_mov_b32 s35, 0x00020000
  s_mov_b32 s21, 76
  v_mov_b32 v4, 0
  s_mov_b32 s101, 0
wf_242:
  buffer_load_dword v5, v4, s[32:35], s21 offen sc1
  s_add_u32 s101, s101, 1
  s_cmp_gt_u32 s101, 131072
  s_cbranch_scc1 main_end
  s_waitcnt vmcnt(0)
  v_readfirstlane_b32 s100, v5
  s_cmp_ge_u32 s100, 1
  s_cbranch_scc1 wf_243
  s_sleep 8
  s_branch wf_242
wf_243:
  s_sub_u32 s80, s100, 1
  s_lshl_b32 s80, s80, 13
  s_lshl_b32 s40, s2, 2
  s_add_u32 s40, s40, s20
  s_lshl_b32 s40, s40, 14
  s_xor_b32 s40, s40, s80
  s_xor_b32 s40, s40, 8192
  s_mul_i32 s47, s20, 3072
  s_lshr_b32 s43, s2, 2
  s_lshl_b32 s43, s43, 7
  s_add_u32 s43, s43, 28672
  s_xor_b32 s43, s43, s80
  s_lshl_b32 s44, s2, 7
  s_lshl_b32 s21, s20, 2
  s_add_u32 s44, s44, s21
  s_add_u32 s44, s44, 4096
  s_xor_b32 s44, s44, s80
  s_lshl_b32 s49, s20, 8
  s_add_u32 s49, s49, 12288
  s_mov_b32 s45, 0
  v_lshlrev_b32 v4, 4, v1
  v_min_u32 v14, 18, v1
  v_lshlrev_b32 v14, 2, v14
  v_mov_b32 v17, 1073741824
  v_cmp_eq_u32 vcc, 0, v1
  s_nop 1
  v_cndmask_b32 v17, v17, 0, vcc
  v_mov_b32 v16, 0
  v_mov_b32 v18, 65536
vwr_244:
  s_cmp_lg_u32 s20, 0
  s_cbranch_scc1 vwr_247
  s_mov_b32 s101, 0
  s_branch vwr_246
vwr_245:
  s_cmp_lg_u32 s101, 1
  s_cbranch_scc1 vwr_248
  buffer_store_dword v16, v17, s[72:75], s44 offen sc1
vwr_248:
  s_sleep 4
vwr_246:
  buffer_load_dword v15, v14, s[72:75], s43 offen sc1
  s_add_u32 s101, s101, 1
  s_cmp_gt_u32 s101, 131072
  s_cbranch_scc1 main_end
  s_waitcnt vmcnt(0)
  v_cmp_le_u32 vcc, 8, v15
  s_nop 1
  s_ff0_i32_b32 s21, vcc_lo
  s_min_u32 s21, s21, 19
  s_lshl_b32 s22, s21, 1
  s_lshl_b32 s21, s21, 2
  s_sub_i32 s21, s21, 12
  s_max_i32 s46, s21, s22
  s_cmp_le_u32 s46, s45
  s_cbranch_scc1 vwr_245
  v_mov_b32 v15, s46
  ds_write_b32 v18, v15
  s_waitcnt lgkmcnt(0)
  s_barrier
  s_branch vwr_249
vwr_247:
  s_waitcnt vmcnt(0)
  buffer_store_dword v16, v17, s[72:75], s44 offen sc1
  s_barrier
  ds_read_b32 v15, v18
  s_waitcnt lgkmcnt(0)
  v_readfirstlane_b32 s46, v15
vwr_249:
  s_and_b32 s50, s45, 2
  s_lshl_b32 s50, s50, 14
  v_add_u32 v10, s50, v4
  v_add_u32 v11, 2048, v10
  v_add_u32 v12, 2056, v10
  v_lshl_add_u32 v13, v1, 2, s50
  s_lshl_b32 s41, s45, 21
  s_add_u32 s41, s41, s40
  s_mov_b32 s48, s45
  s_mov_b32 s56, s41
  s_add_u32 s57, s56, 4096
  s_lshl_b32 s58, s45, 19
  s_lshl_b32 s21, s45, 11
  s_and_b32 s21, s21, 8192
  s_xor_b32 s21, s21, s80
  s_add_u32 s58, s58, s21
  s_add_u32 s58, s58, 136314880
  s_lshl_b32 s21, s2, 14
  s_lshl_b32 s22, s20, 11
  s_add_u32 s21, s21, s22
  s_add_u32 s58, s58, s21
  s_and_b32 s21, s2, 28
  s_add_u32 s21, s21, s20
  s_lshl_b32 s21, s21, 16
  s_and_b32 s22, s2, 3
  s_lshl_b32 s22, s22, 10
  s_add_u32 s21, s21, s22
  s_lshl_b32 s60, s45, 21
  s_add_u32 s60, s60, s21
  s_add_u32 s60, s60, s80
  s_add_u32 s60, s60, -2093056
  s_xor_b32 s60, s60, 8192
  s_mov_b32 s51, 1073741824
  s_mov_b32 s59, 1073741824
  s_mov_b32 s52, s50
  s_cmp_lt_u32 s48, s46
  s_cselect_b32 s53, s41, 1073741824
  s_add_u32 s54, s52, 0
  s_add_u32 m0, s54, s47
  s_nop 0
  buffer_load_dwordx4 v4, s[16:19], s53 offen offset:0 sc1 lds
  buffer_load_dwordx4 v4, s[16:19], s53 offen offset:1024 sc1 lds
  buffer_load_dwordx4 v4, s[16:19], s53 offen offset:2048 sc1 lds
  s_nop 0
  s_add_u32 m0, s54, s49
  s_nop 0
  buffer_load_dword v14, s[72:75], s43 offen sc1 lds
  s_add_u32 s41, s41, 2097152
  s_xor_b32 s41, s41, 8192
  s_add_u32 s48, s48, 1
  s_cmp_lt_u32 s48, s46
  s_cselect_b32 s53, s41, 1073741824
  s_add_u32 s54, s52, 16384
  s_add_u32 m0, s54, s47
  s_nop 0
  buffer_load_dwordx4 v4, s[16:19], s53 offen offset:0 sc1 lds
  buffer_load_dwordx4 v4, s[16:19], s53 offen offset:1024 sc1 lds
  buffer_load_dwordx4 v4, s[16:19], s53 offen offset:2048 sc1 lds
  s_nop 0
  s_add_u32 m0, s54, s49
  s_nop 0
  buffer_load_dword v14, s[72:75], s43 offen sc1 lds
  s_add_u32 s41, s41, 2097152
  s_xor_b32 s41, s41, 8192
  s_add_u32 s48, s48, 1
  s_xor_b32 s52, s52, 32768
  s_waitcnt vmcnt(0)
  s_barrier
  ds_read_b32 v15, v13 offset:28672
  ds_read_b128 v[64:67], v10 offset:0
  ds_read_b128 v[88:91], v10 offset:1024
  ds_read_b128 v[68:71], v10 offset:3072
  ds_read_b128 v[92:95], v10 offset:4096
  ds_read2st64_b64 v[72:75], v11 offset0:0 offset1:6
  ds_read2st64_b64 v[96:99], v12 offset0:0 offset1:6
  ds_read_b128 v[76:79], v10 offset:6144
  ds_read_b128 v[100:103], v10 offset:7168
  ds_read_b128 v[80:83], v10 offset:9216
  ds_read_b128 v[104:107], v10 offset:10240
  ds_read2st64_b64 v[84:87], v11 offset0:12 offset1:18
  ds_read2st64_b64 v[108:111], v12 offset0:12 offset1:18
  s_waitcnt lgkmcnt(12)
  v_cmp_le_u32 vcc, 8, v15
  s_nop 1
  s_ff0_i32_b32 s21, vcc_lo
  s_min_u32 s21, s21, 19
  s_lshl_b32 s22, s21, 1
  s_lshl_b32 s21, s21, 2
  s_sub_i32 s21, s21, 12
  s_max_i32 s21, s21, s22
  s_max_u32 s46, s21, s46
  s_cmp_lt_u32 s48, s46
  s_cselect_b32 s53, s41, 1073741824
  s_add_u32 s54, s52, 0
  s_add_u32 m0, s54, s47
  s_nop 0
  buffer_load_dwordx4 v4, s[16:19], s53 offen offset:0 sc1 lds
  buffer_load_dwordx4 v4, s[16:19], s53 offen offset:1024 sc1 lds
  buffer_load_dwordx4 v4, s[16:19], s53 offen offset:2048 sc1 lds
  s_nop 0
  s_add_u32 m0, s54, s49
  s_nop 0
  buffer_load_dword v14, s[72:75], s43 offen sc1 lds
  s_add_u32 s41, s41, 2097152
  s_xor_b32 s41, s41, 8192
  s_add_u32 s48, s48, 1
  buffer_store_dword v16, v17, s[72:75], s44 offen sc1
  s_waitcnt lgkmcnt(0)
  .p2align 3
vwl_250:
  v_mfma_f32_16x16x32_bf16 v[160:163], v[64:67], a[0:3], 0
  v_mfma_f32_16x16x32_bf16 v[164:167], v[88:91], a[0:3], 0
  v_mfma_f32_16x16x32_bf16 v[160:163], v[68:71], a[4:7], v[160:163]
  s_add_u32 s60, s60, 2097152
  s_xor_b32 s60, s60, 8192
  s_sub_u32 s62, s60, 0
  v_mfma_f32_16x16x32_bf16 v[164:167], v[92:95], a[4:7], v[164:167]
  s_cmp_ge_u32 s62, 125829120
  s_cselect_b32 s62, 1073741824, s60
  v_cvt_pk_bf16_f32 v204, v184, v185
  v_mfma_f32_16x16x32_bf16 v[160:163], v[72:75], a[8:11], v[160:163]
  v_cvt_pk_bf16_f32 v205, v186, v187
  v_cvt_pk_bf16_f32 v206, v188, v189
  v_mfma_f32_16x16x32_bf16 v[164:167], v[96:99], a[8:11], v[164:167]
  v_cvt_pk_bf16_f32 v207, v190, v191
  buffer_store_dwordx4 v[204:207], v4, s[16:19], s51 offen offset:3072 sc1
  v_mfma_f32_16x16x32_bf16 v[160:163], v[76:79], a[12:15], v[160:163]
  v_mfma_f32_16x16x32_bf16 v[164:167], v[100:103], a[12:15], v[164:167]
  s_waitcnt vmcnt(30)
  s_barrier
  ds_read_b32 v15, v13 offset:28672
  v_mfma_f32_16x16x32_bf16 v[160:163], v[80:83], a[16:19], v[160:163]
  ds_read_b128 v[112:115], v10 offset:16384
  v_mfma_f32_16x16x32_bf16 v[164:167], v[104:107], a[16:19], v[164:167]
  v_mfma_f32_16x16x32_bf16 v[160:163], v[84:87], a[20:23], v[160:163]
  ds_read_b128 v[136:139], v10 offset:17408
  v_mfma_f32_16x16x32_bf16 v[164:167], v[108:111], a[20:23], v[164:167]
  v_mfma_f32_16x16x32_bf16 v[168:171], v[64:67], a[24:27], 0
  ds_read_b128 v[116:119], v10 offset:19456
  v_mfma_f32_16x16x32_bf16 v[172:175], v[88:91], a[24:27], 0
  v_mfma_f32_16x16x32_bf16 v[168:171], v[68:71], a[28:31], v[168:171]
  v_cvt_pk_bf16_f32 v192, v160, v161
  v_cvt_pk_bf16_f32 v193, v162, v163
  v_mfma_f32_16x16x32_bf16 v[172:175], v[92:95], a[28:31], v[172:175]
  v_cvt_pk_bf16_f32 v194, v164, v165
  v_cvt_pk_bf16_f32 v195, v166, v167
  v_mfma_f32_16x16x32_bf16 v[168:171], v[72:75], a[32:35], v[168:171]
  buffer_store_dwordx4 v[192:195], v4, s[16:19], s56 offen offset:0 sc1
  ds_read_b128 v[140:143], v10 offset:20480
  v_mfma_f32_16x16x32_bf16 v[172:175], v[96:99], a[32:35], v[172:175]
  v_mfma_f32_16x16x32_bf16 v[168:171], v[76:79], a[36:39], v[168:171]
  ds_read2st64_b64 v[120:123], v11 offset0:32 offset1:38
  v_mfma_f32_16x16x32_bf16 v[172:175], v[100:103], a[36:39], v[172:175]
  v_mfma_f32_16x16x32_bf16 v[168:171], v[80:83], a[40:43], v[168:171]
  s_add_u32 s55, s62, 0
  ds_read2st64_b64 v[144:147], v12 offset0:32 offset1:38
  v_mfma_f32_16x16x32_bf16 v[172:175], v[104:107], a[40:43], v[172:175]
  buffer_store_dwordx4 v[192:195], v4, s[16:19], s55 offen sc1
  v_mfma_f32_16x16x32_bf16 v[168:171], v[84:87], a[44:47], v[168:171]
  ds_read_b128 v[124:127], v10 offset:22528
  v_mfma_f32_16x16x32_bf16 v[172:175], v[108:111], a[44:47], v[172:175]
  v_mfma_f32_16x16x32_bf16 v[176:179], v[64:67], a[48:51], 0
  ds_read_b128 v[148:151], v10 offset:23552
  v_mfma_f32_16x16x32_bf16 v[180:183], v[88:91], a[48:51], 0
  v_mfma_f32_16x16x32_bf16 v[176:179], v[68:71], a[52:55], v[176:179]
  v_cvt_pk_bf16_f32 v196, v168, v169
  v_cvt_pk_bf16_f32 v197, v170, v171
  v_mfma_f32_16x16x32_bf16 v[180:183], v[92:95], a[52:55], v[180:183]
  v_cvt_pk_bf16_f32 v198, v172, v173
  v_cvt_pk_bf16_f32 v199, v174, v175
  v_mfma_f32_16x16x32_bf16 v[176:179], v[72:75], a[56:59], v[176:179]
  buffer_store_dwordx4 v[196:199], v4, s[16:19], s56 offen offset:1024 sc1
  ds_read_b128 v[128:131], v10 offset:25600
  v_mfma_f32_16x16x32_bf16 v[180:183], v[96:99], a[56:59], v[180:183]
  v_mfma_f32_16x16x32_bf16 v[176:179], v[76:79], a[60:63], v[176:179]
  ds_read_b128 v[152:155], v10 offset:26624
  v_mfma_f32_16x16x32_bf16 v[180:183], v[100:103], a[60:63], v[180:183]
  v_mfma_f32_16x16x32_bf16 v[176:179], v[80:83], a[64:67], v[176:179]
  ds_read2st64_b64 v[132:135], v11 offset0:44 offset1:50
  v_mfma_f32_16x16x32_bf16 v[180:183], v[104:107], a[64:67], v[180:183]
  v_mfma_f32_16x16x32_bf16 v[176:179], v[84:87], a[68:71], v[176:179]
  ds_read2st64_b64 v[156:159], v12 offset0:44 offset1:50
  v_mfma_f32_16x16x32_bf16 v[180:183], v[108:111], a[68:71], v[180:183]
  v_mfma_f32_16x16x32_bf16 v[184:187], v[64:67], a[72:75], 0
  v_mfma_f32_16x16x32_bf16 v[188:191], v[88:91], a[72:75], 0
  s_waitcnt lgkmcnt(12)
  v_cmp_le_u32 vcc, 8, v15
  v_mfma_f32_16x16x32_bf16 v[184:187], v[68:71], a[76:79], v[184:187]
  v_cvt_pk_bf16_f32 v200, v176, v177
  v_cvt_pk_bf16_f32 v201, v178, v179
  v_mfma_f32_16x16x32_bf16 v[188:191], v[92:95], a[76:79], v[188:191]
  s_ff0_i32_b32 s21, vcc_lo
  v_cvt_pk_bf16_f32 v202, v180, v181
  v_cvt_pk_bf16_f32 v203, v182, v183
  v_mfma_f32_16x16x32_bf16 v[184:187], v[72:75], a[80:83], v[184:187]
  s_min_u32 s21, s21, 19
  buffer_store_dwordx4 v[200:203], v4, s[16:19], s58 offen offset:0 sc1
  s_lshl_b32 s22, s21, 1
  v_mfma_f32_16x16x32_bf16 v[188:191], v[96:99], a[80:83], v[188:191]
  s_lshl_b32 s21, s21, 2
  s_sub_i32 s21, s21, 12
  s_max_i32 s21, s21, s22
  v_mfma_f32_16x16x32_bf16 v[184:187], v[76:79], a[84:87], v[184:187]
  s_max_u32 s42, s21, s46
  s_cmp_ge_u32 s46, s48
  s_cselect_b32 s46, s42, s46
  v_mfma_f32_16x16x32_bf16 v[188:191], v[100:103], a[84:87], v[188:191]
  s_cmp_lt_u32 s48, s46
  s_cselect_b32 s53, s41, 1073741824
  s_add_u32 s54, s52, 16384
  v_mfma_f32_16x16x32_bf16 v[184:187], v[80:83], a[88:91], v[184:187]
  s_add_u32 m0, s54, s47
  v_mfma_f32_16x16x32_bf16 v[188:191], v[104:107], a[88:91], v[188:191]
  buffer_load_dwordx4 v4, s[16:19], s53 offen offset:0 sc1 lds
  buffer_load_dwordx4 v4, s[16:19], s53 offen offset:1024 sc1 lds
  v_mfma_f32_16x16x32_bf16 v[184:187], v[84:87], a[92:95], v[184:187]
  buffer_load_dwordx4 v4, s[16:19], s53 offen offset:2048 sc1 lds
  v_mfma_f32_16x16x32_bf16 v[188:191], v[108:111], a[92:95], v[188:191]
  s_add_u32 m0, s54, s49
  v_mfma_f32_16x16x32_bf16 v[160:163], v[64:67], a[96:99], 0
  buffer_load_dword v14, s[72:75], s43 offen sc1 lds
  s_add_u32 s41, s41, 2097152
  v_mfma_f32_16x16x32_bf16 v[164:167], v[88:91], a[96:99], 0
  s_xor_b32 s41, s41, 8192
  s_add_u32 s48, s48, 1
  v_mfma_f32_16x16x32_bf16 v[160:163], v[68:71], a[100:103], v[160:163]
  v_cvt_pk_bf16_f32 v204, v184, v185
  v_cvt_pk_bf16_f32 v205, v186, v187
  v_mfma_f32_16x16x32_bf16 v[164:167], v[92:95], a[100:103], v[164:167]
  v_cvt_pk_bf16_f32 v206, v188, v189
  v_cvt_pk_bf16_f32 v207, v190, v191
  v_mfma_f32_16x16x32_bf16 v[160:163], v[72:75], a[104:107], v[160:163]
  buffer_store_dwordx4 v[204:207], v4, s[16:19], s56 offen offset:2048 sc1
  v_mfma_f32_16x16x32_bf16 v[164:167], v[96:99], a[104:107], v[164:167]
  v_mfma_f32_16x16x32_bf16 v[160:163], v[76:79], a[108:111], v[160:163]
  v_mfma_f32_16x16x32_bf16 v[164:167], v[100:103], a[108:111], v[164:167]
  v_mfma_f32_16x16x32_bf16 v[160:163], v[80:83], a[112:115], v[160:163]
  s_add_u32 s55, s62, 16384
  v_mfma_f32_16x16x32_bf16 v[164:167], v[104:107], a[112:115], v[164:167]
  buffer_store_dwordx4 v[204:207], v4, s[16:19], s55 offen sc1
  v_mfma_f32_16x16x32_bf16 v[160:163], v[84:87], a[116:119], v[160:163]
  v_mfma_f32_16x16x32_bf16 v[164:167], v[108:111], a[116:119], v[164:167]
  v_mfma_f32_16x16x32_bf16 v[168:171], v[64:67], a[120:123], 0
  v_mfma_f32_16x16x32_bf16 v[172:175], v[88:91], a[120:123], 0
  v_mfma_f32_16x16x32_bf16 v[168:171], v[68:71], a[124:127], v[168:171]
  v_cvt_pk_bf16_f32 v192, v160, v161
  v_cvt_pk_bf16_f32 v193, v162, v163
  v_mfma_f32_16x16x32_bf16 v[172:175], v[92:95], a[124:127], v[172:175]
  v_cvt_pk_bf16_f32 v194, v164, v165
  v_cvt_pk_bf16_f32 v195, v166, v167
  v_mfma_f32_16x16x32_bf16 v[168:171], v[72:75], a[128:131], v[168:171]
  buffer_store_dwordx4 v[192:195], v4, s[16:19], s56 offen offset:3072 sc1
  v_mfma_f32_16x16x32_bf16 v[172:175], v[96:99], a[128:131], v[172:175]
  v_mfma_f32_16x16x32_bf16 v[168:171], v[76:79], a[132:135], v[168:171]
  v_mfma_f32_16x16x32_bf16 v[172:175], v[100:103], a[132:135], v[172:175]
  v_mfma_f32_16x16x32_bf16 v[168:171], v[80:83], a[136:139], v[168:171]
  v_mfma_f32_16x16x32_bf16 v[172:175], v[104:107], a[136:139], v[172:175]
  v_mfma_f32_16x16x32_bf16 v[168:171], v[84:87], a[140:143], v[168:171]
  v_mfma_f32_16x16x32_bf16 v[172:175], v[108:111], a[140:143], v[172:175]
  v_mfma_f32_16x16x32_bf16 v[176:179], v[64:67], a[144:147], 0
  v_mfma_f32_16x16x32_bf16 v[180:183], v[88:91], a[144:147], 0
  v_mfma_f32_16x16x32_bf16 v[176:179], v[68:71], a[148:151], v[176:179]
  v_cvt_pk_bf16_f32 v196, v168, v169
  v_cvt_pk_bf16_f32 v197, v170, v171
  v_mfma_f32_16x16x32_bf16 v[180:183], v[92:95], a[148:151], v[180:183]
  v_cvt_pk_bf16_f32 v198, v172, v173
  v_cvt_pk_bf16_f32 v199, v174, v175
  v_mfma_f32_16x16x32_bf16 v[176:179], v[72:75], a[152:155], v[176:179]
  buffer_store_dwordx4 v[196:199], v4, s[16:19], s57 offen offset:0 sc1
  v_mfma_f32_16x16x32_bf16 v[180:183], v[96:99], a[152:155], v[180:183]
  v_mfma_f32_16x16x32_bf16 v[176:179], v[76:79], a[156:159], v[176:179]
  v_mfma_f32_16x16x32_bf16 v[180:183], v[100:103], a[156:159], v[180:183]
  v_mfma_f32_16x16x32_bf16 v[176:179], v[80:83], a[160:163], v[176:179]
  s_add_u32 s55, s62, 32768
  v_mfma_f32_16x16x32_bf16 v[180:183], v[104:107], a[160:163], v[180:183]
  buffer_store_dwordx4 v[196:199], v4, s[16:19], s55 offen sc1
  v_mfma_f32_16x16x32_bf16 v[176:179], v[84:87], a[164:167], v[176:179]
  v_mfma_f32_16x16x32_bf16 v[180:183], v[108:111], a[164:167], v[180:183]
  v_mfma_f32_16x16x32_bf16 v[184:187], v[64:67], a[168:171], 0
  v_mfma_f32_16x16x32_bf16 v[188:191], v[88:91], a[168:171], 0
  v_mfma_f32_16x16x32_bf16 v[184:187], v[68:71], a[172:175], v[184:187]
  v_cvt_pk_bf16_f32 v200, v176, v177
  v_cvt_pk_bf16_f32 v201, v178, v179
  v_mfma_f32_16x16x32_bf16 v[188:191], v[92:95], a[172:175], v[188:191]
  v_cvt_pk_bf16_f32 v202, v180, v181
  v_cvt_pk_bf16_f32 v203, v182, v183
  v_mfma_f32_16x16x32_bf16 v[184:187], v[72:75], a[176:179], v[184:187]
  buffer_store_dwordx4 v[200:203], v4, s[16:19], s57 offen offset:1024 sc1
  v_mfma_f32_16x16x32_bf16 v[188:191], v[96:99], a[176:179], v[188:191]
  v_mfma_f32_16x16x32_bf16 v[184:187], v[76:79], a[180:183], v[184:187]
  v_mfma_f32_16x16x32_bf16 v[188:191], v[100:103], a[180:183], v[188:191]
  v_mfma_f32_16x16x32_bf16 v[184:187], v[80:83], a[184:187], v[184:187]
  v_mfma_f32_16x16x32_bf16 v[188:191], v[104:107], a[184:187], v[188:191]
  v_mfma_f32_16x16x32_bf16 v[184:187], v[84:87], a[188:191], v[184:187]
  v_mfma_f32_16x16x32_bf16 v[188:191], v[108:111], a[188:191], v[188:191]
  v_mfma_f32_16x16x32_bf16 v[160:163], v[64:67], a[192:195], 0
  s_min_u32 s21, s45, 56
  v_mov_b32 v16, s21
  s_waitcnt vmcnt(14)
  v_mfma_f32_16x16x32_bf16 v[164:167], v[88:91], a[192:195], 0
  buffer_store_dword v16, v17, s[72:75], s44 offen sc1
  v_mfma_f32_16x16x32_bf16 v[160:163], v[68:71], a[196:199], v[160:163]
  v_cvt_pk_bf16_f32 v204, v184, v185
  v_cvt_pk_bf16_f32 v205, v186, v187
  v_mfma_f32_16x16x32_bf16 v[164:167], v[92:95], a[196:199], v[164:167]
  v_cvt_pk_bf16_f32 v206, v188, v189
  v_cvt_pk_bf16_f32 v207, v190, v191
  v_mfma_f32_16x16x32_bf16 v[160:163], v[72:75], a[200:203], v[160:163]
  buffer_store_dwordx4 v[204:207], v4, s[16:19], s58 offen offset:1024 sc1
  v_mfma_f32_16x16x32_bf16 v[164:167], v[96:99], a[200:203], v[164:167]
  v_mfma_f32_16x16x32_bf16 v[160:163], v[76:79], a[204:207], v[160:163]
  s_add_u32 s56, s56, 2097152
  s_xor_b32 s56, s56, 8192
  s_add_u32 s59, s58, 524288
  v_mfma_f32_16x16x32_bf16 v[164:167], v[100:103], a[204:207], v[164:167]
  s_xor_b32 s58, s58, s59
  s_lshr_b32 s58, s58, 8
  s_and_b32 s58, s58, 8192
  v_mfma_f32_16x16x32_bf16 v[160:163], v[80:83], a[208:211], v[160:163]
  s_xor_b32 s58, s58, s59
  v_mfma_f32_16x16x32_bf16 v[164:167], v[104:107], a[208:211], v[164:167]
  v_mfma_f32_16x16x32_bf16 v[160:163], v[84:87], a[212:215], v[160:163]
  v_mfma_f32_16x16x32_bf16 v[164:167], v[108:111], a[212:215], v[164:167]
  v_mfma_f32_16x16x32_bf16 v[168:171], v[64:67], a[216:219], 0
  v_mfma_f32_16x16x32_bf16 v[172:175], v[88:91], a[216:219], 0
  v_mfma_f32_16x16x32_bf16 v[168:171], v[68:71], a[220:223], v[168:171]
  v_cvt_pk_bf16_f32 v192, v160, v161
  v_cvt_pk_bf16_f32 v193, v162, v163
  v_mfma_f32_16x16x32_bf16 v[172:175], v[92:95], a[220:223], v[172:175]
  v_cvt_pk_bf16_f32 v194, v164, v165
  v_cvt_pk_bf16_f32 v195, v166, v167
  v_mfma_f32_16x16x32_bf16 v[168:171], v[72:75], a[224:227], v[168:171]
  buffer_store_dwordx4 v[192:195], v4, s[16:19], s57 offen offset:2048 sc1
  v_mfma_f32_16x16x32_bf16 v[172:175], v[96:99], a[224:227], v[172:175]
  s_add_u32 s55, s62, 49152
  v_mfma_f32_16x16x32_bf16 v[168:171], v[76:79], a[228:231], v[168:171]
  buffer_store_dwordx4 v[192:195], v4, s[16:19], s55 offen sc1
  s_mov_b32 s51, s57
  v_mfma_f32_16x16x32_bf16 v[172:175], v[100:103], a[228:231], v[172:175]
  s_add_u32 s57, s56, 4096
  s_add_u32 s45, s45, 1
  v_mfma_f32_16x16x32_bf16 v[168:171], v[80:83], a[232:235], v[168:171]
  v_mfma_f32_16x16x32_bf16 v[172:175], v[104:107], a[232:235], v[172:175]
  v_mfma_f32_16x16x32_bf16 v[168:171], v[84:87], a[236:239], v[168:171]
  v_mfma_f32_16x16x32_bf16 v[172:175], v[108:111], a[236:239], v[172:175]
  s_waitcnt lgkmcnt(0)
  v_mfma_f32_16x16x32_bf16 v[176:179], v[112:115], a[0:3], 0
  v_mfma_f32_16x16x32_bf16 v[180:183], v[136:139], a[0:3], 0
  v_mfma_f32_16x16x32_bf16 v[176:179], v[116:119], a[4:7], v[176:179]
  v_cvt_pk_bf16_f32 v196, v168, v169
  v_cvt_pk_bf16_f32 v197, v170, v171
  v_mfma_f32_16x16x32_bf16 v[180:183], v[140:143], a[4:7], v[180:183]
  s_add_u32 s60, s60, 2097152
  v_cvt_pk_bf16_f32 v198, v172, v173
  v_cvt_pk_bf16_f32 v199, v174, v175
  v_mfma_f32_16x16x32_bf16 v[176:179], v[120:123], a[8:11], v[176:179]
  s_xor_b32 s60, s60, 8192
  buffer_store_dwordx4 v[196:199], v4, s[16:19], s51 offen offset:3072 sc1
  s_sub_u32 s62, s60, 0
  v_mfma_f32_16x16x32_bf16 v[180:183], v[144:147], a[8:11], v[180:183]
  s_cmp_ge_u32 s62, 125829120
  s_cselect_b32 s62, 1073741824, s60
  v_mfma_f32_16x16x32_bf16 v[176:179], v[124:127], a[12:15], v[176:179]
  v_mfma_f32_16x16x32_bf16 v[180:183], v[148:151], a[12:15], v[180:183]
  s_waitcnt vmcnt(20)
  s_barrier
  v_xor_b32 v10, 32768, v10
  v_mfma_f32_16x16x32_bf16 v[176:179], v[128:131], a[16:19], v[176:179]
  v_xor_b32 v11, 32768, v11
  v_xor_b32 v12, 32768, v12
  v_mfma_f32_16x16x32_bf16 v[180:183], v[152:155], a[16:19], v[180:183]
  v_xor_b32 v13, 32768, v13
  ds_read_b32 v15, v13 offset:12288
  v_mfma_f32_16x16x32_bf16 v[176:179], v[132:135], a[20:23], v[176:179]
  ds_read_b128 v[64:67], v10 offset:0
  v_mfma_f32_16x16x32_bf16 v[180:183], v[156:159], a[20:23], v[180:183]
  v_mfma_f32_16x16x32_bf16 v[184:187], v[112:115], a[24:27], 0
  ds_read_b128 v[88:91], v10 offset:1024
  v_mfma_f32_16x16x32_bf16 v[188:191], v[136:139], a[24:27], 0
  v_mfma_f32_16x16x32_bf16 v[184:187], v[116:119], a[28:31], v[184:187]
  v_cvt_pk_bf16_f32 v200, v176, v177
  v_cvt_pk_bf16_f32 v201, v178, v179
  v_mfma_f32_16x16x32_bf16 v[188:191], v[140:143], a[28:31], v[188:191]
  v_cvt_pk_bf16_f32 v202, v180, v181
  v_cvt_pk_bf16_f32 v203, v182, v183
  v_mfma_f32_16x16x32_bf16 v[184:187], v[120:123], a[32:35], v[184:187]
  buffer_store_dwordx4 v[200:203], v4, s[16:19], s56 offen offset:0 sc1
  ds_read_b128 v[68:71], v10 offset:3072
  v_mfma_f32_16x16x32_bf16 v[188:191], v[144:147], a[32:35], v[188:191]
  v_mfma_f32_16x16x32_bf16 v[184:187], v[124:127], a[36:39], v[184:187]
  ds_read_b128 v[92:95], v10 offset:4096
  v_mfma_f32_16x16x32_bf16 v[188:191], v[148:151], a[36:39], v[188:191]
  v_mfma_f32_16x16x32_bf16 v[184:187], v[128:131], a[40:43], v[184:187]
  s_add_u32 s55, s62, 0
  ds_read2st64_b64 v[72:75], v11 offset0:0 offset1:6
  v_mfma_f32_16x16x32_bf16 v[188:191], v[152:155], a[40:43], v[188:191]
  buffer_store_dwordx4 v[200:203], v4, s[16:19], s55 offen sc1
  v_mfma_f32_16x16x32_bf16 v[184:187], v[132:135], a[44:47], v[184:187]
  ds_read2st64_b64 v[96:99], v12 offset0:0 offset1:6
  v_mfma_f32_16x16x32_bf16 v[188:191], v[156:159], a[44:47], v[188:191]
  v_mfma_f32_16x16x32_bf16 v[160:163], v[112:115], a[48:51], 0
  ds_read_b128 v[76:79], v10 offset:6144
  v_mfma_f32_16x16x32_bf16 v[164:167], v[136:139], a[48:51], 0
  v_mfma_f32_16x16x32_bf16 v[160:163], v[116:119], a[52:55], v[160:163]
  v_cvt_pk_bf16_f32 v204, v184, v185
  v_cvt_pk_bf16_f32 v205, v186, v187
  v_mfma_f32_16x16x32_bf16 v[164:167], v[140:143], a[52:55], v[164:167]
  v_cvt_pk_bf16_f32 v206, v188, v189
  v_cvt_pk_bf16_f32 v207, v190, v191
  v_mfma_f32_16x16x32_bf16 v[160:163], v[120:123], a[56:59], v[160:163]
  buffer_store_dwordx4 v[204:207], v4, s[16:19], s56 offen offset:1024 sc1
  ds_read_b128 v[100:103], v10 offset:7168
  v_mfma_f32_16x16x32_bf16 v[164:167], v[144:147], a[56:59], v[164:167]
  v_mfma_f32_16x16x32_bf16 v[160:163], v[124:127], a[60:63], v[160:163]
  ds_read_b128 v[80:83], v10 offset:9216
  v_mfma_f32_16x16x32_bf16 v[164:167], v[148:151], a[60:63], v[164:167]
  v_mfma_f32_16x16x32_bf16 v[160:163], v[128:131], a[64:67], v[160:163]
  ds_read_b128 v[104:107], v10 offset:10240
  v_mfma_f32_16x16x32_bf16 v[164:167], v[152:155], a[64:67], v[164:167]
  v_mfma_f32_16x16x32_bf16 v[160:163], v[132:135], a[68:71], v[160:163]
  ds_read2st64_b64 v[84:87], v11 offset0:12 offset1:18
  v_mfma_f32_16x16x32_bf16 v[164:167], v[156:159], a[68:71], v[164:167]
  v_mfma_f32_16x16x32_bf16 v[168:171], v[112:115], a[72:75], 0
  ds_read2st64_b64 v[108:111], v12 offset0:12 offset1:18
  v_mfma_f32_16x16x32_bf16 v[172:175], v[136:139], a[72:75], 0
  v_mfma_f32_16x16x32_bf16 v[168:171], v[116:119], a[76:79], v[168:171]
  v_cvt_pk_bf16_f32 v192, v160, v161
  v_cvt_pk_bf16_f32 v193, v162, v163
  v_mfma_f32_16x16x32_bf16 v[172:175], v[140:143], a[76:79], v[172:175]
  v_cvt_pk_bf16_f32 v194, v164, v165
  v_cvt_pk_bf16_f32 v195, v166, v167
  v_mfma_f32_16x16x32_bf16 v[168:171], v[120:123], a[80:83], v[168:171]
  buffer_store_dwordx4 v[192:195], v4, s[16:19], s58 offen offset:0 sc1
  s_waitcnt lgkmcnt(12)
  v_mfma_f32_16x16x32_bf16 v[172:175], v[144:147], a[80:83], v[172:175]
  v_cmp_le_u32 vcc, 8, v15
  v_mfma_f32_16x16x32_bf16 v[168:171], v[124:127], a[84:87], v[168:171]
  s_ff0_i32_b32 s21, vcc_lo
  s_min_u32 s21, s21, 19
  s_lshl_b32 s22, s21, 1
  v_mfma_f32_16x16x32_bf16 v[172:175], v[148:151], a[84:87], v[172:175]
  s_lshl_b32 s21, s21, 2
  s_sub_i32 s21, s21, 12
  s_max_i32 s21, s21, s22
  v_mfma_f32_16x16x32_bf16 v[168:171], v[128:131], a[88:91], v[168:171]
  s_max_u32 s42, s21, s46
  s_cmp_ge_u32 s46, s48
  s_cselect_b32 s46, s42, s46
  v_mfma_f32_16x16x32_bf16 v[172:175], v[152:155], a[88:91], v[172:175]
  s_xor_b32 s52, s52, 32768
  s_cmp_lt_u32 s48, s46
  s_cselect_b32 s53, s41, 1073741824
  v_mfma_f32_16x16x32_bf16 v[168:171], v[132:135], a[92:95], v[168:171]
  s_add_u32 s54, s52, 0
  s_add_u32 m0, s54, s47
  v_mfma_f32_16x16x32_bf16 v[172:175], v[156:159], a[92:95], v[172:175]
  buffer_load_dwordx4 v4, s[16:19], s53 offen offset:0 sc1 lds
  buffer_load_dwordx4 v4, s[16:19], s53 offen offset:1024 sc1 lds
  v_mfma_f32_16x16x32_bf16 v[176:179], v[112:115], a[96:99], 0
  buffer_load_dwordx4 v4, s[16:19], s53 offen offset:2048 sc1 lds
  v_mfma_f32_16x16x32_bf16 v[180:183], v[136:139], a[96:99], 0
  s_add_u32 m0, s54, s49
  v_mfma_f32_16x16x32_bf16 v[176:179], v[116:119], a[100:103], v[176:179]
  v_cvt_pk_bf16_f32 v196, v168, v169
  v_cvt_pk_bf16_f32 v197, v170, v171
  v_mfma_f32_16x16x32_bf16 v[180:183], v[140:143], a[100:103], v[180:183]
  v_cvt_pk_bf16_f32 v198, v172, v173
  v_cvt_pk_bf16_f32 v199, v174, v175
  v_mfma_f32_16x16x32_bf16 v[176:179], v[120:123], a[104:107], v[176:179]
  buffer_store_dwordx4 v[196:199], v4, s[16:19], s56 offen offset:2048 sc1
  buffer_load_dword v14, s[72:75], s43 offen sc1 lds
  v_mfma_f32_16x16x32_bf16 v[180:183], v[144:147], a[104:107], v[180:183]
  s_add_u32 s41, s41, 2097152
  s_xor_b32 s41, s41, 8192
  s_add_u32 s48, s48, 1
  v_mfma_f32_16x16x32_bf16 v[176:179], v[124:127], a[108:111], v[176:179]
  v_mfma_f32_16x16x32_bf16 v[180:183], v[148:151], a[108:111], v[180:183]
  v_mfma_f32_16x16x32_bf16 v[176:179], v[128:131], a[112:115], v[176:179]
  s_add_u32 s55, s62, 16384
  v_mfma_f32_16x16x32_bf16 v[180:183], v[152:155], a[112:115], v[180:183]
  buffer_store_dwordx4 v[196:199], v4, s[16:19], s55 offen sc1
  v_mfma_f32_16x16x32_bf16 v[176:179], v[132:135], a[116:119], v[176:179]
  v_mfma_f32_16x16x32_bf16 v[180:183], v[156:159], a[116:119], v[180:183]
  v_mfma_f32_16x16x32_bf16 v[184:187], v[112:115], a[120:123], 0
  v_mfma_f32_16x16x32_bf16 v[188:191], v[136:139], a[120:123], 0
  v_mfma_f32_16x16x32_bf16 v[184:187], v[116:119], a[124:127], v[184:187]
  v_cvt_pk_bf16_f32 v200, v176, v177
  v_cvt_pk_bf16_f32 v201, v178, v179
  v_mfma_f32_16x16x32_bf16 v[188:191], v[140:143], a[124:127], v[188:191]
  v_cvt_pk_bf16_f32 v202, v180, v181
  v_cvt_pk_bf16_f32 v203, v182, v183
  v_mfma_f32_16x16x32_bf16 v[184:187], v[120:123], a[128:131], v[184:187]
  buffer_store_dwordx4 v[200:203], v4, s[16:19], s56 offen offset:3072 sc1
  v_mfma_f32_16x16x32_bf16 v[188:191], v[144:147], a[128:131], v[188:191]
  v_mfma_f32_16x16x32_bf16 v[184:187], v[124:127], a[132:135], v[184:187]
  v_mfma_f32_16x16x32_bf16 v[188:191], v[148:151], a[132:135], v[188:191]
  v_mfma_f32_16x16x32_bf16 v[184:187], v[128:131], a[136:139], v[184:187]
  v_mfma_f32_16x16x32_bf16 v[188:191], v[152:155], a[136:139], v[188:191]
  v_mfma_f32_16x16x32_bf16 v[184:187], v[132:135], a[140:143], v[184:187]
  v_mfma_f32_16x16x32_bf16 v[188:191], v[156:159], a[140:143], v[188:191]
  v_mfma_f32_16x16x32_bf16 v[160:163], v[112:115], a[144:147], 0
  v_mfma_f32_16x16x32_bf16 v[164:167], v[136:139], a[144:147], 0
  v_mfma_f32_16x16x32_bf16 v[160:163], v[116:119], a[148:151], v[160:163]
  v_cvt_pk_bf16_f32 v204, v184, v185
  v_cvt_pk_bf16_f32 v205, v186, v187
  v_mfma_f32_16x16x32_bf16 v[164:167], v[140:143], a[148:151], v[164:167]
  v_cvt_pk_bf16_f32 v206, v188, v189
  v_cvt_pk_bf16_f32 v207, v190, v191
  v_mfma_f32_16x16x32_bf16 v[160:163], v[120:123], a[152:155], v[160:163]
  buffer_store_dwordx4 v[204:207], v4, s[16:19], s57 offen offset:0 sc1
  v_mfma_f32_16x16x32_bf16 v[164:167], v[144:147], a[152:155], v[164:167]
  v_mfma_f32_16x16x32_bf16 v[160:163], v[124:127], a[156:159], v[160:163]
  v_mfma_f32_16x16x32_bf16 v[164:167], v[148:151], a[156:159], v[164:167]
  v_mfma_f32_16x16x32_bf16 v[160:163], v[128:131], a[160:163], v[160:163]
  s_add_u32 s55, s62, 32768
  v_mfma_f32_16x16x32_bf16 v[164:167], v[152:155], a[160:163], v[164:167]
  buffer_store_dwordx4 v[204:207], v4, s[16:19], s55 offen sc1
  v_mfma_f32_16x16x32_bf16 v[160:163], v[132:135], a[164:167], v[160:163]
  v_mfma_f32_16x16x32_bf16 v[164:167], v[156:159], a[164:167], v[164:167]
  v_mfma_f32_16x16x32_bf16 v[168:171], v[112:115], a[168:171], 0
  v_mfma_f32_16x16x32_bf16 v[172:175], v[136:139], a[168:171], 0
  v_mfma_f32_16x16x32_bf16 v[168:171], v[116:119], a[172:175], v[168:171]
  v_cvt_pk_bf16_f32 v192, v160, v161
  v_cvt_pk_bf16_f32 v193, v162, v163
  v_mfma_f32_16x16x32_bf16 v[172:175], v[140:143], a[172:175], v[172:175]
  v_cvt_pk_bf16_f32 v194, v164, v165
  v_cvt_pk_bf16_f32 v195, v166, v167
  v_mfma_f32_16x16x32_bf16 v[168:171], v[120:123], a[176:179], v[168:171]
  buffer_store_dwordx4 v[192:195], v4, s[16:19], s57 offen offset:1024 sc1
  v_mfma_f32_16x16x32_bf16 v[172:175], v[144:147], a[176:179], v[172:175]
  v_mfma_f32_16x16x32_bf16 v[168:171], v[124:127], a[180:183], v[168:171]
  v_mfma_f32_16x16x32_bf16 v[172:175], v[148:151], a[180:183], v[172:175]
  v_mfma_f32_16x16x32_bf16 v[168:171], v[128:131], a[184:187], v[168:171]
  v_mfma_f32_16x16x32_bf16 v[172:175], v[152:155], a[184:187], v[172:175]
  v_mfma_f32_16x16x32_bf16 v[168:171], v[132:135], a[188:191], v[168:171]
  v_mfma_f32_16x16x32_bf16 v[172:175], v[156:159], a[188:191], v[172:175]
  v_mfma_f32_16x16x32_bf16 v[176:179], v[112:115], a[192:195], 0
  s_min_u32 s21, s45, 56
  v_mov_b32 v16, s21
  s_waitcnt vmcnt(14)
  v_mfma_f32_16x16x32_bf16 v[180:183], v[136:139], a[192:195], 0
  buffer_store_dword v16, v17, s[72:75], s44 offen sc1
  v_mfma_f32_16x16x32_bf16 v[176:179], v[116:119], a[196:199], v[176:179]
  v_cvt_pk_bf16_f32 v196, v168, v169
  v_cvt_pk_bf16_f32 v197, v170, v171
  v_mfma_f32_16x16x32_bf16 v[180:183], v[140:143], a[196:199], v[180:183]
  v_cvt_pk_bf16_f32 v198, v172, v173
  v_cvt_pk_bf16_f32 v199, v174, v175
  v_mfma_f32_16x16x32_bf16 v[176:179], v[120:123], a[200:203], v[176:179]
  buffer_store_dwordx4 v[196:199], v4, s[16:19], s58 offen offset:1024 sc1
  v_mfma_f32_16x16x32_bf16 v[180:183], v[144:147], a[200:203], v[180:183]
  v_mfma_f32_16x16x32_bf16 v[176:179], v[124:127], a[204:207], v[176:179]
  s_add_u32 s56, s56, 2097152
  s_xor_b32 s56, s56, 8192
  s_add_u32 s59, s58, 524288
  v_mfma_f32_16x16x32_bf16 v[180:183], v[148:151], a[204:207], v[180:183]
  s_xor_b32 s58, s58, s59
  s_lshr_b32 s58, s58, 8
  s_and_b32 s58, s58, 8192
  v_mfma_f32_16x16x32_bf16 v[176:179], v[128:131], a[208:211], v[176:179]
  s_xor_b32 s58, s58, s59
  v_mfma_f32_16x16x32_bf16 v[180:183], v[152:155], a[208:211], v[180:183]
  v_mfma_f32_16x16x32_bf16 v[176:179], v[132:135], a[212:215], v[176:179]
  v_mfma_f32_16x16x32_bf16 v[180:183], v[156:159], a[212:215], v[180:183]
  v_mfma_f32_16x16x32_bf16 v[184:187], v[112:115], a[216:219], 0
  v_mfma_f32_16x16x32_bf16 v[188:191], v[136:139], a[216:219], 0
  v_mfma_f32_16x16x32_bf16 v[184:187], v[116:119], a[220:223], v[184:187]
  v_cvt_pk_bf16_f32 v200, v176, v177
  v_cvt_pk_bf16_f32 v201, v178, v179
  v_mfma_f32_16x16x32_bf16 v[188:191], v[140:143], a[220:223], v[188:191]
  v_cvt_pk_bf16_f32 v202, v180, v181
  v_cvt_pk_bf16_f32 v203, v182, v183
  v_mfma_f32_16x16x32_bf16 v[184:187], v[120:123], a[224:227], v[184:187]
  buffer_store_dwordx4 v[200:203], v4, s[16:19], s57 offen offset:2048 sc1
  v_mfma_f32_16x16x32_bf16 v[188:191], v[144:147], a[224:227], v[188:191]
  s_add_u32 s55, s62, 49152
  v_mfma_f32_16x16x32_bf16 v[184:187], v[124:127], a[228:231], v[184:187]
  buffer_store_dwordx4 v[200:203], v4, s[16:19], s55 offen sc1
  s_mov_b32 s51, s57
  v_mfma_f32_16x16x32_bf16 v[188:191], v[148:151], a[228:231], v[188:191]
  s_add_u32 s57, s56, 4096
  s_add_u32 s45, s45, 1
  v_mfma_f32_16x16x32_bf16 v[184:187], v[128:131], a[232:235], v[184:187]
  v_mfma_f32_16x16x32_bf16 v[188:191], v[152:155], a[232:235], v[188:191]
  v_mfma_f32_16x16x32_bf16 v[184:187], v[132:135], a[236:239], v[184:187]
  s_cmp_lt_u32 s45, s46
  v_mfma_f32_16x16x32_bf16 v[188:191], v[156:159], a[236:239], v[188:191]
  s_waitcnt lgkmcnt(0)
  s_cbranch_scc1 vwl_250
  s_nop 7
  v_cvt_pk_bf16_f32 v204, v184, v185
  v_cvt_pk_bf16_f32 v205, v186, v187
  v_cvt_pk_bf16_f32 v206, v188, v189
  v_cvt_pk_bf16_f32 v207, v190, v191
  buffer_store_dwordx4 v[204:207], v4, s[16:19], s51 offen offset:3072 sc1
  s_min_u32 s21, s45, 56
  v_mov_b32 v16, s21
  s_barrier
  s_mov_b32 s46, s42
  s_cmp_gt_u32 s42, s45
  s_cbranch_scc1 vwr_249
  s_cmp_lt_u32 s45, 64
  s_cbranch_scc1 vwr_244
  v_mov_b32 v244, -1
  v_mov_b32 v245, -1
  v_mov_b32 v246, -1
  v_mov_b32 v247, -1
  v_lshlrev_b32 v21, 3, v1
  s_lshr_b32 s21, s2, 2
  s_lshl_b32 s21, s21, 2
  s_add_u32 s21, s21, s20
  s_lshl_b32 s21, s21, 2
  s_and_b32 s22, s2, 3
  s_add_u32 s21, s21, s22
  s_lshl_b32 s21, s21, 14
  s_xor_b32 s22, s21, s80
  s_xor_b32 s21, s22, 125833216
  buffer_store_dwordx4 v[244:247], v4, s[16:19], s21 offen offset:0 sc1
  buffer_store_dwordx4 v[244:247], v4, s[16:19], s21 offen offset:1024 sc1
  buffer_store_dwordx4 v[244:247], v4, s[16:19], s21 offen offset:2048 sc1
  buffer_store_dwordx4 v[244:247], v4, s[16:19], s21 offen offset:3072 sc1
  s_xor_b32 s21, s22, 127938560
  buffer_store_dwordx4 v[244:247], v4, s[16:19], s21 offen offset:0 sc1
  buffer_store_dwordx4 v[244:247], v4, s[16:19], s21 offen offset:1024 sc1
  buffer_store_dwordx4 v[244:247], v4, s[16:19], s21 offen offset:2048 sc1
  buffer_store_dwordx4 v[244:247], v4, s[16:19], s21 offen offset:3072 sc1
  s_xor_b32 s21, s22, 130027520
  buffer_store_dwordx4 v[244:247], v4, s[16:19], s21 offen offset:0 sc1
  buffer_store_dwordx4 v[244:247], v4, s[16:19], s21 offen offset:1024 sc1
  buffer_store_dwordx4 v[244:247], v4, s[16:19], s21 offen offset:2048 sc1
  buffer_store_dwordx4 v[244:247], v4, s[16:19], s21 offen offset:3072 sc1
  s_xor_b32 s21, s22, 132132864
  buffer_store_dwordx4 v[244:247], v4, s[16:19], s21 offen offset:0 sc1
  buffer_store_dwordx4 v[244:247], v4, s[16:19], s21 offen offset:1024 sc1
  buffer_store_dwordx4 v[244:247], v4, s[16:19], s21 offen offset:2048 sc1
  buffer_store_dwordx4 v[244:247], v4, s[16:19], s21 offen offset:3072 sc1
  s_and_b32 s21, s2, 3
  s_cmp_lg_u32 s21, s20
  s_cbranch_scc1 arm_251
  s_lshr_b32 s21, s2, 1
  s_lshl_b32 s21, s21, 14
  s_and_b32 s22, s2, 1
  s_mul_i32 s22, s22, 2560
  s_add_u32 s21, s21, s22
  s_xor_b32 s22, s21, s80
  s_xor_b32 s21, s22, 216006656
  buffer_store_dwordx4 v[244:247], v4, s[16:19], s21 offen sc1
  buffer_store_dwordx4 v[244:247], v4, s[16:19], s21 offen offset:1024 sc1
  buffer_store_dwordx2 v[244:245], v21, s[16:19], s21 offen offset:2048 sc1
  s_xor_b32 s21, s22, 216530944
  buffer_store_dwordx4 v[244:247], v4, s[16:19], s21 offen sc1
  buffer_store_dwordx4 v[244:247], v4, s[16:19], s21 offen offset:1024 sc1
  buffer_store_dwordx2 v[244:245], v21, s[16:19], s21 offen offset:2048 sc1
  s_xor_b32 s21, s22, 217055232
  buffer_store_dwordx4 v[244:247], v4, s[16:19], s21 offen sc1
  buffer_store_dwordx4 v[244:247], v4, s[16:19], s21 offen offset:1024 sc1
  buffer_store_dwordx2 v[244:245], v21, s[16:19], s21 offen offset:2048 sc1
  s_xor_b32 s21, s22, 217579520
  buffer_store_dwordx4 v[244:247], v4, s[16:19], s21 offen sc1
  buffer_store_dwordx4 v[244:247], v4, s[16:19], s21 offen offset:1024 sc1
  buffer_store_dwordx2 v[244:245], v21, s[16:19], s21 offen offset:2048 sc1
arm_251:
  v_mov_b32 v16, 64
  s_waitcnt vmcnt(0)
  buffer_store_dword v16, v17, s[72:75], s44 offen sc1
  s_branch queue
not_vw:
  s_sub_u32 s2, s3, 96
  s_cmp_lg_u32 s2, 31
  s_cbranch_scc1 not_cal
  s_load_dwordx2 s[72:73], s[0:1], 104
  s_waitcnt lgkmcnt(0)
  s_add_u32 s72, s72, 173080576
  s_addc_u32 s73, s73, 0
  s_mov_b32 s74, 49152
  s_mov_b32 s75, 0x00020000
  v_lshlrev_b32 v8, 4, v0
  v_mov_b32 v4, 0
  v_mov_b32 v5, 0
  v_mov_b32 v6, 0
  v_mov_b32 v7, 0
  s_mov_b32 s21, 0
  buffer_store_dwordx4 v[4:7], v8, s[72:75], s21 offen sc1
  s_mov_b32 s21, 4096
  buffer_store_dwordx4 v[4:7], v8, s[72:75], s21 offen sc1
  s_mov_b32 s21, 8192
  buffer_store_dwordx4 v[4:7], v8, s[72:75], s21 offen sc1
  s_mov_b32 s21, 12288
  buffer_store_dwordx4 v[4:7], v8, s[72:75], s21 offen sc1
  s_mov_b32 s21, 16384
  buffer_store_dwordx4 v[4:7], v8, s[72:75], s21 offen sc1
  s_mov_b32 s21, 20480
  buffer_store_dwordx4 v[4:7], v8, s[72:75], s21 offen sc1
  s_mov_b32 s21, 24576
  buffer_store_dwordx4 v[4:7], v8, s[72:75], s21 offen sc1
  s_mov_b32 s21, 28672
  buffer_store_dwordx4 v[4:7], v8, s[72:75], s21 offen sc1
  s_mov_b32 s21, 32768
  buffer_store_dwordx4 v[4:7], v8, s[72:75], s21 offen sc1
  s_mov_b32 s21, 36864
  buffer_store_dwordx4 v[4:7], v8, s[72:75], s21 offen sc1
  s_mov_b32 s21, 40960
  buffer_store_dwordx4 v[4:7], v8, s[72:75], s21 offen sc1
  s_mov_b32 s21, 45056
  buffer_store_dwordx4 v[4:7], v8, s[72:75], s21 offen sc1
  s_add_u32 s8, s38, 173015040
  s_addc_u32 s9, s39, 0
  s_mov_b32 s10, 131072
  s_mov_b32 s11, 0x00020000
  s_cmp_lg_u32 s20, 0
  s_cbranch_scc1 cal_252
  s_mov_b32 s40, -1
  s_mov_b32 s41, -1
  s_mov_b32 s43, 0
cal_253:
  s_mov_b32 s21, 0
  s_memtime s[98:99]
  s_waitcnt lgkmcnt(0)
  s_buffer_load_dword s22, s[8:11], s21 glc
  s_waitcnt lgkmcnt(0)
  s_memtime s[100:101]
  s_waitcnt lgkmcnt(0)
  s_sub_u32 s21, s100, s98
  s_min_u32 s40, s40, s21
  s_mov_b32 s21, 8192
  s_memtime s[98:99]
  s_waitcnt lgkmcnt(0)
  s_buffer_load_dword s22, s[8:11], s21 glc
  s_waitcnt lgkmcnt(0)
  s_memtime s[100:101]
  s_waitcnt lgkmcnt(0)
  s_sub_u32 s21, s100, s98
  s_min_u32 s41, s41, s21
  s_add_u32 s43, s43, 1
  s_cmp_lt_u32 s43, 6
  s_cbranch_scc1 cal_253
cal_252:
  s_waitcnt vmcnt(0)
  s_barrier
  s_cmp_lg_u32 s20, 0
  s_cbranch_scc1 cal_254
  s_cmp_lt_u32 s41, s40
  s_cselect_b32 s21, 1, 2
  v_mov_b32 v4, s21
  v_mov_b32 v5, s40
  v_mov_b32 v6, s41
  v_mov_b32 v8, 76
  s_mov_b64 exec, 1
  buffer_store_dwordx3 v[4:6], v8, s[32:35], 0 offen sc1
  s_mov_b64 exec, -1
cal_254:
not_cal:
  s_load_dwordx2 s[4:5], s[0:1], 0
  s_load_dwordx2 s[6:7], s[0:1], 64
  s_load_dwordx2 s[38:39], s[0:1], 104
  s_lshr_b32 s41, s2, 3
  s_lshl_b32 s41, s41, 1
  s_and_b32 s21, s2, 1
  s_add_u32 s41, s41, s21
  s_bfe_u32 s42, s2, 0x20001
  s_waitcnt lgkmcnt(0)
  s_mov_b32 s8, s4
  s_mov_b32 s9, s5
  s_mov_b32 s10, 2621440
  s_mov_b32 s11, 0x00020000
  s_mov_b32 s12, s6
  s_mov_b32 s13, s7
  s_mov_b32 s14, 2457600
  s_mov_b32 s15, 0x00020000
  s_mov_b32 s16, s38
  s_mov_b32 s17, s39
  s_mov_b32 s18, 218103808
  s_mov_b32 s19, 0x00020000
  s_add_u32 s72, s38, 173080576
  s_addc_u32 s73, s39, 0
  s_mov_b32 s74, 49152
  s_mov_b32 s75, 0x00020000
  v_lshrrev_b32 v8, 5, v1
  v_or_b32 v9, 0, v8
  v_and_b32 v10, 31, v1
  v_lshlrev_b32 v9, 1, v9
  v_xor_b32 v10, v10, v9
  v_mul_u32_u24 v9, 6554, v10
  v_lshrrev_b32 v9, 16, v9
  v_mul_u32_u24 v11, 1120, v9
  v_lshl_add_u32 v11, v10, 4, v11
  v_mul_u32_u24 v8, 3840, v8
  v_add_u32 v11, v11, v8
  v_mov_b32 v9, 1073741824
  v_cmp_gt_u32 vcc, 30, v10
  s_nop 1
  v_cndmask_b32 v4, v9, v11, vcc
  v_lshrrev_b32 v8, 5, v1
  v_or_b32 v9, 2, v8
  v_and_b32 v10, 31, v1
  v_lshlrev_b32 v9, 1, v9
  v_xor_b32 v10, v10, v9
  v_mul_u32_u24 v9, 6554, v10
  v_lshrrev_b32 v9, 16, v9
  v_mul_u32_u24 v11, 1120, v9
  v_lshl_add_u32 v11, v10, 4, v11
  v_mul_u32_u24 v8, 3840, v8
  v_add_u32 v11, v11, v8
  v_mov_b32 v9, 1073741824
  v_cmp_gt_u32 vcc, 30, v10
  s_nop 1
  v_cndmask_b32 v5, v9, v11, vcc
  v_lshrrev_b32 v8, 5, v1
  v_or_b32 v9, 4, v8
  v_and_b32 v10, 31, v1
  v_lshlrev_b32 v9, 1, v9
  v_xor_b32 v10, v10, v9
  v_mul_u32_u24 v9, 6554, v10
  v_lshrrev_b32 v9, 16, v9
  v_mul_u32_u24 v11, 1120, v9
  v_lshl_add_u32 v11, v10, 4, v11
  v_mul_u32_u24 v8, 3840, v8
  v_add_u32 v11, v11, v8
  v_mov_b32 v9, 1073741824
  v_cmp_gt_u32 vcc, 30, v10
  s_nop 1
  v_cndmask_b32 v6, v9, v11, vcc
  v_lshrrev_b32 v8, 5, v1
  v_or_b32 v9, 6, v8
  v_and_b32 v10, 31, v1
  v_lshlrev_b32 v9, 1, v9
  v_xor_b32 v10, v10, v9
  v_mul_u32_u24 v9, 6554, v10
  v_lshrrev_b32 v9, 16, v9
  v_mul_u32_u24 v11, 1120, v9
  v_lshl_add_u32 v11, v10, 4, v11
  v_mul_u32_u24 v8, 3840, v8
  v_add_u32 v11, v11, v8
  v_mov_b32 v9, 1073741824
  v_cmp_gt_u32 vcc, 30, v10
  s_nop 1
  v_cndmask_b32 v7, v9, v11, vcc
  s_mul_i32 s44, s41, 160
  s_mul_i32 s21, s20, 122880
  s_add_u32 s44, s44, s21
  s_lshl_b32 s45, s20, 14
  s_add_u32 s21, s44, 0
  s_add_u32 m0, s45, 0
  s_nop 0
  buffer_load_dwordx4 v4, s[12:15], s21 offen lds
  s_add_u32 s21, s44, 7680
  s_add_u32 m0, s45, 1024
  s_nop 0
  buffer_load_dwordx4 v5, s[12:15], s21 offen lds
  s_add_u32 s21, s44, 15360
  s_add_u32 m0, s45, 2048
  s_nop 0
  buffer_load_dwordx4 v4, s[12:15], s21 offen lds
  s_add_u32 s21, s44, 23040
  s_add_u32 m0, s45, 3072
  s_nop 0
  buffer_load_dwordx4 v5, s[12:15], s21 offen lds
  s_add_u32 s21, s44, 30720
  s_add_u32 m0, s45, 4096
  s_nop 0
  buffer_load_dwordx4 v6, s[12:15], s21 offen lds
  s_add_u32 s21, s44, 38400
  s_add_u32 m0, s45, 5120
  s_nop 0
  buffer_load_dwordx4 v7, s[12:15], s21 offen lds
  s_add_u32 s21, s44, 46080
  s_add_u32 m0, s45, 6144
  s_nop 0
  buffer_load_dwordx4 v6, s[12:15], s21 offen lds
  s_add_u32 s21, s44, 53760
  s_add_u32 m0, s45, 7168
  s_nop 0
  buffer_load_dwordx4 v7, s[12:15], s21 offen lds
  s_add_u32 s21, s44, 61440
  s_add_u32 m0, s45, 8192
  s_nop 0
  buffer_load_dwordx4 v4, s[12:15], s21 offen lds
  s_add_u32 s21, s44, 69120
  s_add_u32 m0, s45, 9216
  s_nop 0
  buffer_load_dwordx4 v5, s[12:15], s21 offen lds
  s_add_u32 s21, s44, 76800
  s_add_u32 m0, s45, 10240
  s_nop 0
  buffer_load_dwordx4 v4, s[12:15], s21 offen lds
  s_add_u32 s21, s44, 84480
  s_add_u32 m0, s45, 11264
  s_nop 0
  buffer_load_dwordx4 v5, s[12:15], s21 offen lds
  s_add_u32 s21, s44, 92160
  s_add_u32 m0, s45, 12288
  s_nop 0
  buffer_load_dwordx4 v6, s[12:15], s21 offen lds
  s_add_u32 s21, s44, 99840
  s_add_u32 m0, s45, 13312
  s_nop 0
  buffer_load_dwordx4 v7, s[12:15], s21 offen lds
  s_add_u32 s21, s44, 107520
  s_add_u32 m0, s45, 14336
  s_nop 0
  buffer_load_dwordx4 v6, s[12:15], s21 offen lds
  s_add_u32 s21, s44, 115200
  s_add_u32 m0, s45, 15360
  s_nop 0
  buffer_load_dwordx4 v7, s[12:15], s21 offen lds
  s_add_u32 s21, s44, 491520
  s_add_u32 m0, s45, 65536
  s_nop 0
  buffer_load_dwordx4 v4, s[12:15], s21 offen lds
  s_add_u32 s21, s44, 499200
  s_add_u32 m0, s45, 66560
  s_nop 0
  buffer_load_dwordx4 v5, s[12:15], s21 offen lds
  s_add_u32 s21, s44, 506880
  s_add_u32 m0, s45, 67584
  s_nop 0
  buffer_load_dwordx4 v4, s[12:15], s21 offen lds
  s_add_u32 s21, s44, 514560
  s_add_u32 m0, s45, 68608
  s_nop 0
  buffer_load_dwordx4 v5, s[12:15], s21 offen lds
  s_add_u32 s21, s44, 522240
  s_add_u32 m0, s45, 69632
  s_nop 0
  buffer_load_dwordx4 v6, s[12:15], s21 offen lds
  s_add_u32 s21, s44, 529920
  s_add_u32 m0, s45, 70656
  s_nop 0
  buffer_load_dwordx4 v7, s[12:15], s21 offen lds
  s_add_u32 s21, s44, 537600
  s_add_u32 m0, s45, 71680
  s_nop 0
  buffer_load_dwordx4 v6, s[12:15], s21 offen lds
  s_add_u32 s21, s44, 545280
  s_add_u32 m0, s45, 72704
  s_nop 0
  buffer_load_dwordx4 v7, s[12:15], s21 offen lds
  s_add_u32 s21, s44, 552960
  s_add_u32 m0, s45, 73728
  s_nop 0
  buffer_load_dwordx4 v4, s[12:15], s21 offen lds
  s_add_u32 s21, s44, 560640
  s_add_u32 m0, s45, 74752
  s_nop 0
  buffer_load_dwordx4 v5, s[12:15], s21 offen lds
  s_add_u32 s21, s44, 568320
  s_add_u32 m0, s45, 75776
  s_nop 0
  buffer_load_dwordx4 v4, s[12:15], s21 offen lds
  s_add_u32 s21, s44, 576000
  s_add_u32 m0, s45, 76800
  s_nop 0
  buffer_load_dwordx4 v5, s[12:15], s21 offen lds
  s_add_u32 s21, s44, 583680
  s_add_u32 m0, s45, 77824
  s_nop 0
  buffer_load_dwordx4 v6, s[12:15], s21 offen lds
  s_add_u32 s21, s44, 591360
  s_add_u32 m0, s45, 78848
  s_nop 0
  buffer_load_dwordx4 v7, s[12:15], s21 offen lds
  s_add_u32 s21, s44, 599040
  s_add_u32 m0, s45, 79872
  s_nop 0
  buffer_load_dwordx4 v6, s[12:15], s21 offen lds
  s_add_u32 s21, s44, 606720
  s_add_u32 m0, s45, 80896
  s_nop 0
  buffer_load_dwordx4 v7, s[12:15], s21 offen lds
  s_add_u32 s21, s44, 983040
  buffer_load_dwordx4 v[64:67], v4, s[12:15], s21 offen
  s_add_u32 s21, s44, 990720
  buffer_load_dwordx4 v[68:71], v5, s[12:15], s21 offen
  s_add_u32 s21, s44, 998400
  buffer_load_dwordx4 v[72:75], v4, s[12:15], s21 offen
  s_add_u32 s21, s44, 1006080
  buffer_load_dwordx4 v[76:79], v5, s[12:15], s21 offen
  s_add_u32 s21, s44, 1013760
  buffer_load_dwordx4 v[80:83], v6, s[12:15], s21 offen
  s_add_u32 s21, s44, 1021440
  buffer_load_dwordx4 v[84:87], v7, s[12:15], s21 offen
  s_add_u32 s21, s44, 1029120
  buffer_load_dwordx4 v[88:91], v6, s[12:15], s21 offen
  s_add_u32 s21, s44, 1036800
  buffer_load_dwordx4 v[92:95], v7, s[12:15], s21 offen
  s_add_u32 s21, s44, 1044480
  buffer_load_dwordx4 v[96:99], v4, s[12:15], s21 offen
  s_add_u32 s21, s44, 1052160
  buffer_load_dwordx4 v[100:103], v5, s[12:15], s21 offen
  s_add_u32 s21, s44, 1059840
  buffer_load_dwordx4 v[104:107], v4, s[12:15], s21 offen
  s_add_u32 s21, s44, 1067520
  buffer_load_dwordx4 v[108:111], v5, s[12:15], s21 offen
  s_add_u32 s21, s44, 1075200
  buffer_load_dwordx4 v[112:115], v6, s[12:15], s21 offen
  s_add_u32 s21, s44, 1082880
  buffer_load_dwordx4 v[116:119], v7, s[12:15], s21 offen
  s_add_u32 s21, s44, 1090560
  buffer_load_dwordx4 v[120:123], v6, s[12:15], s21 offen
  s_add_u32 s21, s44, 1098240
  buffer_load_dwordx4 v[124:127], v7, s[12:15], s21 offen
  v_lshrrev_b32 v8, 2, v2
  v_and_b32 v9, 1, v3
  v_lshl_add_u32 v9, v9, 2, v8
  v_lshlrev_b32 v9, 5, v9
  v_lshl_add_u32 v8, v3, 3, v8
  v_lshlrev_b32 v8, 9, v8
  v_and_b32 v10, 3, v2
  s_mul_i32 s21, s20, 40
  v_lshl_add_u32 v11, v10, 3, s21
  v_add_u32 v11, 0, v11
  v_xor_b32 v11, v11, v9
  v_add_u32 v12, v11, v8
  v_add_u32 v16, 65536, v12
  v_lshl_add_u32 v11, v10, 3, s21
  v_add_u32 v11, 160, v11
  v_xor_b32 v11, v11, v9
  v_add_u32 v13, v11, v8
  v_add_u32 v17, 65536, v13
  v_mul_u32_u24 v11, 160, v10
  v_add3_u32 v11, v11, 32, s21
  v_min_u32 v11, 480, v11
  v_xor_b32 v11, v11, v9
  v_add_u32 v14, v11, v8
  v_add_u32 v18, 65536, v14
  v_lshl_add_u32 v11, v10, 3, s21
  v_add_u32 v11, 320, v11
  v_xor_b32 v11, v11, v9
  v_add_u32 v15, v11, v8
  v_add_u32 v19, 65536, v15
  v_lshl_add_u32 v23, v1, 4, s45
  v_add_u32 v29, 65536, v23
  s_waitcnt vmcnt(32)
  s_add_u32 s21, s44, 1474560
  buffer_load_dwordx4 v[128:131], v4, s[12:15], s21 offen
  s_add_u32 s21, s44, 1482240
  buffer_load_dwordx4 v[132:135], v5, s[12:15], s21 offen
  s_add_u32 s21, s44, 1489920
  buffer_load_dwordx4 v[136:139], v4, s[12:15], s21 offen
  s_add_u32 s21, s44, 1497600
  buffer_load_dwordx4 v[140:143], v5, s[12:15], s21 offen
  s_add_u32 s21, s44, 1505280
  buffer_load_dwordx4 v[144:147], v6, s[12:15], s21 offen
  s_add_u32 s21, s44, 1512960
  buffer_load_dwordx4 v[148:151], v7, s[12:15], s21 offen
  s_add_u32 s21, s44, 1520640
  buffer_load_dwordx4 v[152:155], v6, s[12:15], s21 offen
  s_add_u32 s21, s44, 1528320
  buffer_load_dwordx4 v[156:159], v7, s[12:15], s21 offen
  s_add_u32 s21, s44, 1536000
  buffer_load_dwordx4 v[160:163], v4, s[12:15], s21 offen
  s_add_u32 s21, s44, 1543680
  buffer_load_dwordx4 v[164:167], v5, s[12:15], s21 offen
  s_add_u32 s21, s44, 1551360
  buffer_load_dwordx4 v[168:171], v4, s[12:15], s21 offen
  s_add_u32 s21, s44, 1559040
  buffer_load_dwordx4 v[172:175], v5, s[12:15], s21 offen
  s_add_u32 s21, s44, 1566720
  buffer_load_dwordx4 v[176:179], v6, s[12:15], s21 offen
  s_add_u32 s21, s44, 1574400
  buffer_load_dwordx4 v[180:183], v7, s[12:15], s21 offen
  s_add_u32 s21, s44, 1582080
  buffer_load_dwordx4 v[184:187], v6, s[12:15], s21 offen
  s_add_u32 s21, s44, 1589760
  buffer_load_dwordx4 v[188:191], v7, s[12:15], s21 offen
  s_barrier
  ds_read_b64_tr_b16 a[0:1], v12 offset:0
  ds_read_b64_tr_b16 a[2:3], v12 offset:2048
  ds_read_b64_tr_b16 a[4:5], v13 offset:0
  ds_read_b64_tr_b16 a[6:7], v13 offset:2048
  ds_read_b64_tr_b16 a[8:9], v14 offset:0
  ds_read_b64_tr_b16 a[10:11], v14 offset:2048
  ds_read_b64_tr_b16 a[12:13], v15 offset:0
  ds_read_b64_tr_b16 a[14:15], v15 offset:2048
  ds_read_b64_tr_b16 a[16:17], v12 offset:16384
  ds_read_b64_tr_b16 a[18:19], v12 offset:18432
  ds_read_b64_tr_b16 a[20:21], v13 offset:16384
  ds_read_b64_tr_b16 a[22:23], v13 offset:18432
  ds_read_b64_tr_b16 a[24:25], v14 offset:16384
  ds_read_b64_tr_b16 a[26:27], v14 offset:18432
  ds_read_b64_tr_b16 a[28:29], v15 offset:16384
  ds_read_b64_tr_b16 a[30:31], v15 offset:18432
  ds_read_b64_tr_b16 a[32:33], v12 offset:32768
  ds_read_b64_tr_b16 a[34:35], v12 offset:34816
  ds_read_b64_tr_b16 a[36:37], v13 offset:32768
  ds_read_b64_tr_b16 a[38:39], v13 offset:34816
  ds_read_b64_tr_b16 a[40:41], v14 offset:32768
  ds_read_b64_tr_b16 a[42:43], v14 offset:34816
  ds_read_b64_tr_b16 a[44:45], v15 offset:32768
  ds_read_b64_tr_b16 a[46:47], v15 offset:34816
  ds_read_b64_tr_b16 a[48:49], v12 offset:49152
  ds_read_b64_tr_b16 a[50:51], v12 offset:51200
  ds_read_b64_tr_b16 a[52:53], v13 offset:49152
  ds_read_b64_tr_b16 a[54:55], v13 offset:51200
  ds_read_b64_tr_b16 a[56:57], v14 offset:49152
  ds_read_b64_tr_b16 a[58:59], v14 offset:51200
  ds_read_b64_tr_b16 a[60:61], v15 offset:49152
  ds_read_b64_tr_b16 a[62:63], v15 offset:51200
  s_waitcnt lgkmcnt(0)
  s_barrier
  s_waitcnt vmcnt(32)
  s_add_u32 s21, s44, 1966080
  buffer_load_dwordx4 v[192:195], v4, s[12:15], s21 offen
  s_add_u32 s21, s44, 1973760
  buffer_load_dwordx4 v[196:199], v5, s[12:15], s21 offen
  s_add_u32 s21, s44, 1981440
  buffer_load_dwordx4 v[200:203], v4, s[12:15], s21 offen
  s_add_u32 s21, s44, 1989120
  buffer_load_dwordx4 v[204:207], v5, s[12:15], s21 offen
  s_add_u32 s21, s44, 1996800
  buffer_load_dwordx4 v[208:211], v6, s[12:15], s21 offen
  s_add_u32 s21, s44, 2004480
  buffer_load_dwordx4 v[212:215], v7, s[12:15], s21 offen
  s_add_u32 s21, s44, 2012160
  buffer_load_dwordx4 v[216:219], v6, s[12:15], s21 offen
  s_add_u32 s21, s44, 2019840
  buffer_load_dwordx4 v[220:223], v7, s[12:15], s21 offen
  s_add_u32 s21, s44, 2027520
  buffer_load_dwordx4 v[224:227], v4, s[12:15], s21 offen
  s_add_u32 s21, s44, 2035200
  buffer_load_dwordx4 v[228:231], v5, s[12:15], s21 offen
  s_add_u32 s21, s44, 2042880
  buffer_load_dwordx4 v[232:235], v4, s[12:15], s21 offen
  s_add_u32 s21, s44, 2050560
  buffer_load_dwordx4 v[236:239], v5, s[12:15], s21 offen
  s_add_u32 s21, s44, 2058240
  buffer_load_dwordx4 v[240:243], v6, s[12:15], s21 offen
  s_add_u32 s21, s44, 2065920
  buffer_load_dwordx4 v[244:247], v7, s[12:15], s21 offen
  s_add_u32 s21, s44, 2073600
  buffer_load_dwordx4 v[248:251], v6, s[12:15], s21 offen
  s_add_u32 s21, s44, 2081280
  buffer_load_dwordx4 v[252:255], v7, s[12:15], s21 offen
  s_barrier
  ds_read_b64_tr_b16 a[64:65], v16 offset:0
  ds_read_b64_tr_b16 a[66:67], v16 offset:2048
  ds_read_b64_tr_b16 a[68:69], v17 offset:0
  ds_read_b64_tr_b16 a[70:71], v17 offset:2048
  ds_read_b64_tr_b16 a[72:73], v18 offset:0
  ds_read_b64_tr_b16 a[74:75], v18 offset:2048
  ds_read_b64_tr_b16 a[76:77], v19 offset:0
  ds_read_b64_tr_b16 a[78:79], v19 offset:2048
  ds_read_b64_tr_b16 a[80:81], v16 offset:16384
  ds_read_b64_tr_b16 a[82:83], v16 offset:18432
  ds_read_b64_tr_b16 a[84:85], v17 offset:16384
  ds_read_b64_tr_b16 a[86:87], v17 offset:18432
  ds_read_b64_tr_b16 a[88:89], v18 offset:16384
  ds_read_b64_tr_b16 a[90:91], v18 offset:18432
  ds_read_b64_tr_b16 a[92:93], v19 offset:16384
  ds_read_b64_tr_b16 a[94:95], v19 offset:18432
  ds_read_b64_tr_b16 a[96:97], v16 offset:32768
  ds_read_b64_tr_b16 a[98:99], v16 offset:34816
  ds_read_b64_tr_b16 a[100:101], v17 offset:32768
  ds_read_b64_tr_b16 a[102:103], v17 offset:34816
  ds_read_b64_tr_b16 a[104:105], v18 offset:32768
  ds_read_b64_tr_b16 a[106:107], v18 offset:34816
  ds_read_b64_tr_b16 a[108:109], v19 offset:32768
  ds_read_b64_tr_b16 a[110:111], v19 offset:34816
  ds_read_b64_tr_b16 a[112:113], v16 offset:49152
  ds_read_b64_tr_b16 a[114:115], v16 offset:51200
  ds_read_b64_tr_b16 a[116:117], v17 offset:49152
  ds_read_b64_tr_b16 a[118:119], v17 offset:51200
  ds_read_b64_tr_b16 a[120:121], v18 offset:49152
  ds_read_b64_tr_b16 a[122:123], v18 offset:51200
  ds_read_b64_tr_b16 a[124:125], v19 offset:49152
  ds_read_b64_tr_b16 a[126:127], v19 offset:51200
  s_waitcnt lgkmcnt(0)
  s_barrier
  s_waitcnt vmcnt(32)
  v_lshlrev_b32 v30, 4, v1
  s_load_dwordx2 s[36:37], s[0:1], 16
  s_lshl_b32 s23, s2, 2
  s_add_u32 s23, s23, s20
  s_mul_i32 s23, s23, 61440
  s_add_u32 s23, s23, 30720
  s_waitcnt lgkmcnt(0)
  s_mov_b32 s24, s36
  s_mov_b32 s25, s37
  s_mov_b32 s26, 7864320
  s_mov_b32 s27, 0x00020000
  buffer_load_dwordx4 v[32:35], v30, s[24:27], s23 offen offset:0
  buffer_load_dwordx4 v[32:35], v30, s[24:27], s23 offen offset:1024
  buffer_load_dwordx4 v[32:35], v30, s[24:27], s23 offen offset:2048
  buffer_load_dwordx4 v[32:35], v30, s[24:27], s23 offen offset:3072
  s_add_u32 s23, s23, 4096
  buffer_load_dwordx4 v[32:35], v30, s[24:27], s23 offen offset:0
  buffer_load_dwordx4 v[32:35], v30, s[24:27], s23 offen offset:1024
  buffer_load_dwordx4 v[32:35], v30, s[24:27], s23 offen offset:2048
  buffer_load_dwordx4 v[32:35], v30, s[24:27], s23 offen offset:3072
  s_add_u32 s23, s23, 4096
  buffer_load_dwordx4 v[32:35], v30, s[24:27], s23 offen offset:0
  buffer_load_dwordx4 v[32:35], v30, s[24:27], s23 offen offset:1024
  buffer_load_dwordx4 v[32:35], v30, s[24:27], s23 offen offset:2048
  buffer_load_dwordx4 v[32:35], v30, s[24:27], s23 offen offset:3072
  s_add_u32 s23, s23, 4096
  buffer_load_dwordx4 v[32:35], v30, s[24:27], s23 offen offset:0
  buffer_load_dwordx4 v[32:35], v30, s[24:27], s23 offen offset:1024
  buffer_load_dwordx4 v[32:35], v30, s[24:27], s23 offen offset:2048
  buffer_load_dwordx4 v[32:35], v30, s[24:27], s23 offen offset:3072
  s_add_u32 s23, s23, 4096
  buffer_load_dwordx4 v[32:35], v30, s[24:27], s23 offen offset:0
  buffer_load_dwordx4 v[32:35], v30, s[24:27], s23 offen offset:1024
  buffer_load_dwordx4 v[32:35], v30, s[24:27], s23 offen offset:2048
  buffer_load_dwordx4 v[32:35], v30, s[24:27], s23 offen offset:3072
  s_add_u32 s23, s23, 4096
  buffer_load_dwordx4 v[32:35], v30, s[24:27], s23 offen offset:0
  buffer_load_dwordx4 v[32:35], v30, s[24:27], s23 offen offset:1024
  buffer_load_dwordx4 v[32:35], v30, s[24:27], s23 offen offset:2048
  buffer_load_dwordx4 v[32:35], v30, s[24:27], s23 offen offset:3072
  s_add_u32 s23, s23, 4096
  buffer_load_dwordx4 v[32:35], v30, s[24:27], s23 offen offset:0
  buffer_load_dwordx4 v[32:35], v30, s[24:27], s23 offen offset:1024
  buffer_load_dwordx4 v[32:35], v30, s[24:27], s23 offen offset:2048
  buffer_load_dwordx4 v[32:35], v30, s[24:27], s23 offen offset:3072
  s_add_u32 s23, s23, 4096
  buffer_load_dwordx4 v[32:35], v30, s[24:27], s23 offen offset:0
  buffer_load_dwordx4 v[32:35], v30, s[24:27], s23 offen offset:1024
  ds_write_b128 v23, v[64:67] offset:0
  ds_write_b128 v23, v[68:71] offset:1024
  ds_write_b128 v23, v[72:75] offset:2048
  ds_write_b128 v23, v[76:79] offset:3072
  ds_write_b128 v23, v[80:83] offset:4096
  ds_write_b128 v23, v[84:87] offset:5120
  ds_write_b128 v23, v[88:91] offset:6144
  ds_write_b128 v23, v[92:95] offset:7168
  ds_write_b128 v23, v[96:99] offset:8192
  ds_write_b128 v23, v[100:103] offset:9216
  ds_write_b128 v23, v[104:107] offset:10240
  ds_write_b128 v23, v[108:111] offset:11264
  ds_write_b128 v23, v[112:115] offset:12288
  ds_write_b128 v23, v[116:119] offset:13312
  ds_write_b128 v23, v[120:123] offset:14336
  ds_write_b128 v23, v[124:127] offset:15360
  s_waitcnt lgkmcnt(0)
  s_barrier
  ds_read_b64_tr_b16 a[128:129], v12 offset:0
  ds_read_b64_tr_b16 a[130:131], v12 offset:2048
  ds_read_b64_tr_b16 a[132:133], v13 offset:0
  ds_read_b64_tr_b16 a[134:135], v13 offset:2048
  ds_read_b64_tr_b16 a[136:137], v14 offset:0
  ds_read_b64_tr_b16 a[138:139], v14 offset:2048
  ds_read_b64_tr_b16 a[140:141], v15 offset:0
  ds_read_b64_tr_b16 a[142:143], v15 offset:2048
  ds_read_b64_tr_b16 a[144:145], v12 offset:16384
  ds_read_b64_tr_b16 a[146:147], v12 offset:18432
  ds_read_b64_tr_b16 a[148:149], v13 offset:16384
  ds_read_b64_tr_b16 a[150:151], v13 offset:18432
  ds_read_b64_tr_b16 a[152:153], v14 offset:16384
  ds_read_b64_tr_b16 a[154:155], v14 offset:18432
  ds_read_b64_tr_b16 a[156:157], v15 offset:16384
  ds_read_b64_tr_b16 a[158:159], v15 offset:18432
  ds_read_b64_tr_b16 a[160:161], v12 offset:32768
  ds_read_b64_tr_b16 a[162:163], v12 offset:34816
  ds_read_b64_tr_b16 a[164:165], v13 offset:32768
  ds_read_b64_tr_b16 a[166:167], v13 offset:34816
  ds_read_b64_tr_b16 a[168:169], v14 offset:32768
  ds_read_b64_tr_b16 a[170:171], v14 offset:34816
  ds_read_b64_tr_b16 a[172:173], v15 offset:32768
  ds_read_b64_tr_b16 a[174:175], v15 offset:34816
  ds_read_b64_tr_b16 a[176:177], v12 offset:49152
  ds_read_b64_tr_b16 a[178:179], v12 offset:51200
  ds_read_b64_tr_b16 a[180:181], v13 offset:49152
  ds_read_b64_tr_b16 a[182:183], v13 offset:51200
  ds_read_b64_tr_b16 a[184:185], v14 offset:49152
  ds_read_b64_tr_b16 a[186:187], v14 offset:51200
  ds_read_b64_tr_b16 a[188:189], v15 offset:49152
  ds_read_b64_tr_b16 a[190:191], v15 offset:51200
  s_waitcnt lgkmcnt(0)
  s_barrier
  s_waitcnt vmcnt(46)
  ds_write_b128 v29, v[128:131] offset:0
  ds_write_b128 v29, v[132:135] offset:1024
  ds_write_b128 v29, v[136:139] offset:2048
  ds_write_b128 v29, v[140:143] offset:3072
  ds_write_b128 v29, v[144:147] offset:4096
  ds_write_b128 v29, v[148:151] offset:5120
  ds_write_b128 v29, v[152:155] offset:6144
  ds_write_b128 v29, v[156:159] offset:7168
  ds_write_b128 v29, v[160:163] offset:8192
  ds_write_b128 v29, v[164:167] offset:9216
  ds_write_b128 v29, v[168:171] offset:10240
  ds_write_b128 v29, v[172:175] offset:11264
  ds_write_b128 v29, v[176:179] offset:12288
  ds_write_b128 v29, v[180:183] offset:13312
  ds_write_b128 v29, v[184:187] offset:14336
  ds_write_b128 v29, v[188:191] offset:15360
  s_waitcnt lgkmcnt(0)
  s_barrier
  ds_read_b64_tr_b16 a[192:193], v16 offset:0
  ds_read_b64_tr_b16 a[194:195], v16 offset:2048
  ds_read_b64_tr_b16 a[196:197], v17 offset:0
  ds_read_b64_tr_b16 a[198:199], v17 offset:2048
  ds_read_b64_tr_b16 a[200:201], v18 offset:0
  ds_read_b64_tr_b16 a[202:203], v18 offset:2048
  ds_read_b64_tr_b16 a[204:205], v19 offset:0
  ds_read_b64_tr_b16 a[206:207], v19 offset:2048
  ds_read_b64_tr_b16 a[208:209], v16 offset:16384
  ds_read_b64_tr_b16 a[210:211], v16 offset:18432
  ds_read_b64_tr_b16 a[212:213], v17 offset:16384
  ds_read_b64_tr_b16 a[214:215], v17 offset:18432
  ds_read_b64_tr_b16 a[216:217], v18 offset:16384
  ds_read_b64_tr_b16 a[218:219], v18 offset:18432
  ds_read_b64_tr_b16 a[220:221], v19 offset:16384
  ds_read_b64_tr_b16 a[222:223], v19 offset:18432
  ds_read_b64_tr_b16 a[224:225], v16 offset:32768
  ds_read_b64_tr_b16 a[226:227], v16 offset:34816
  ds_read_b64_tr_b16 a[228:229], v17 offset:32768
  ds_read_b64_tr_b16 a[230:231], v17 offset:34816
  ds_read_b64_tr_b16 a[232:233], v18 offset:32768
  ds_read_b64_tr_b16 a[234:235], v18 offset:34816
  ds_read_b64_tr_b16 a[236:237], v19 offset:32768
  ds_read_b64_tr_b16 a[238:239], v19 offset:34816
  ds_read_b64_tr_b16 a[240:241], v16 offset:49152
  ds_read_b64_tr_b16 a[242:243], v16 offset:51200
  ds_read_b64_tr_b16 a[244:245], v17 offset:49152
  ds_read_b64_tr_b16 a[246:247], v17 offset:51200
  ds_read_b64_tr_b16 a[248:249], v18 offset:49152
  ds_read_b64_tr_b16 a[250:251], v18 offset:51200
  ds_read_b64_tr_b16 a[252:253], v19 offset:49152
  ds_read_b64_tr_b16 a[254:255], v19 offset:51200
  s_waitcnt lgkmcnt(0)
  s_barrier
  s_waitcnt vmcnt(30)
  ds_write_b128 v23, v[192:195] offset:0
  ds_write_b128 v23, v[196:199] offset:1024
  ds_write_b128 v23, v[200:203] offset:2048
  ds_write_b128 v23, v[204:207] offset:3072
  ds_write_b128 v23, v[208:211] offset:4096
  ds_write_b128 v23, v[212:215] offset:5120
  ds_write_b128 v23, v[216:219] offset:6144
  ds_write_b128 v23, v[220:223] offset:7168
  ds_write_b128 v23, v[224:227] offset:8192
  ds_write_b128 v23, v[228:231] offset:9216
  ds_write_b128 v23, v[232:235] offset:10240
  ds_write_b128 v23, v[236:239] offset:11264
  ds_write_b128 v23, v[240:243] offset:12288
  ds_write_b128 v23, v[244:247] offset:13312
  ds_write_b128 v23, v[248:251] offset:14336
  ds_write_b128 v23, v[252:255] offset:15360
  s_waitcnt lgkmcnt(0)
  s_barrier
  ds_read_b64_tr_b16 v[192:193], v12 offset:0
  ds_read_b64_tr_b16 v[194:195], v12 offset:2048
  ds_read_b64_tr_b16 v[196:197], v13 offset:0
  ds_read_b64_tr_b16 v[198:199], v13 offset:2048
  ds_read_b64_tr_b16 v[200:201], v14 offset:0
  ds_read_b64_tr_b16 v[202:203], v14 offset:2048
  ds_read_b64_tr_b16 v[204:205], v15 offset:0
  ds_read_b64_tr_b16 v[206:207], v15 offset:2048
  ds_read_b64_tr_b16 v[208:209], v12 offset:16384
  ds_read_b64_tr_b16 v[210:211], v12 offset:18432
  ds_read_b64_tr_b16 v[212:213], v13 offset:16384
  ds_read_b64_tr_b16 v[214:215], v13 offset:18432
  ds_read_b64_tr_b16 v[216:217], v14 offset:16384
  ds_read_b64_tr_b16 v[218:219], v14 offset:18432
  ds_read_b64_tr_b16 v[220:221], v15 offset:16384
  ds_read_b64_tr_b16 v[222:223], v15 offset:18432
  ds_read_b64_tr_b16 v[224:225], v12 offset:32768
  ds_read_b64_tr_b16 v[226:227], v12 offset:34816
  ds_read_b64_tr_b16 v[228:229], v13 offset:32768
  ds_read_b64_tr_b16 v[230:231], v13 offset:34816
  ds_read_b64_tr_b16 v[232:233], v14 offset:32768
  ds_read_b64_tr_b16 v[234:235], v14 offset:34816
  ds_read_b64_tr_b16 v[236:237], v15 offset:32768
  ds_read_b64_tr_b16 v[238:239], v15 offset:34816
  ds_read_b64_tr_b16 v[240:241], v12 offset:49152
  ds_read_b64_tr_b16 v[242:243], v12 offset:51200
  ds_read_b64_tr_b16 v[244:245], v13 offset:49152
  ds_read_b64_tr_b16 v[246:247], v13 offset:51200
  ds_read_b64_tr_b16 v[248:249], v14 offset:49152
  ds_read_b64_tr_b16 v[250:251], v14 offset:51200
  ds_read_b64_tr_b16 v[252:253], v15 offset:49152
  ds_read_b64_tr_b16 v[254:255], v15 offset:51200
  s_waitcnt lgkmcnt(0)
  s_barrier
  s_load_dwordx2 s[32:33], s[0:1], 96
  s_waitcnt lgkmcnt(0)
  s_mov_b32 s32, s32
  s_mov_b32 s33, s33
  s_mov_b32 s34, 256
  s_mov_b32 s35, 0x00020000
  s_mov_b32 s21, 76
  v_mov_b32 v4, 0
  s_mov_b32 s101, 0
wf_255:
  buffer_load_dword v5, v4, s[32:35], s21 offen sc1
  s_add_u32 s101, s101, 1
  s_cmp_gt_u32 s101, 131072
  s_cbranch_scc1 main_end
  s_waitcnt vmcnt(0)
  v_readfirstlane_b32 s100, v5
  s_cmp_ge_u32 s100, 1
  s_cbranch_scc1 wf_256
  s_sleep 8
  s_branch wf_255
wf_256:
  s_sub_u32 s80, s100, 1
  s_lshl_b32 s80, s80, 13
  v_lshrrev_b32 v8, 3, v1
  v_and_b32 v9, 7, v1
  v_xor_b32 v9, v9, v8
  s_and_b32 s21, s20, 1
  s_lshl_b32 s21, s21, 4
  s_lshr_b32 s22, s20, 1
  s_add_u32 s21, s21, s22
  v_lshl_add_u32 v8, v8, 1, s21
  v_mul_u32_u24 v8, 1280, v8
  v_lshl_add_u32 v4, v9, 4, v8
  s_lshl_b32 s31, s20, 10
  s_mul_i32 s30, s42, 655360
  s_sub_u32 s46, s30, 40960
  s_cmp_eq_u32 s42, 0
  s_cselect_b32 s46, 1073741824, s46
  s_add_u32 m0, s31, 0
  s_nop 0
  buffer_load_dwordx4 v4, s[8:11], s46 offen offset:0 lds
  s_add_u32 m0, s31, 3968
  s_nop 0
  buffer_load_dwordx4 v4, s[8:11], s46 offen offset:128 lds
  s_add_u32 m0, s31, 7936
  s_nop 0
  buffer_load_dwordx4 v4, s[8:11], s46 offen offset:256 lds
  s_add_u32 m0, s31, 11904
  s_nop 0
  buffer_load_dwordx4 v4, s[8:11], s46 offen offset:384 lds
  s_add_u32 m0, s31, 15872
  s_nop 0
  buffer_load_dwordx4 v4, s[8:11], s46 offen offset:512 lds
  s_add_u32 m0, s31, 19840
  s_nop 0
  buffer_load_dwordx4 v4, s[8:11], s46 offen offset:640 lds
  s_add_u32 m0, s31, 23808
  s_nop 0
  buffer_load_dwordx4 v4, s[8:11], s46 offen offset:768 lds
  s_add_u32 m0, s31, 27776
  s_nop 0
  buffer_load_dwordx4 v4, s[8:11], s46 offen offset:896 lds
  s_add_u32 m0, s31, 31744
  s_nop 0
  buffer_load_dwordx4 v4, s[8:11], s46 offen offset:1024 lds
  s_add_u32 m0, s31, 35712
  s_nop 0
  buffer_load_dwordx4 v4, s[8:11], s46 offen offset:1152 lds
  s_add_u32 s31, s31, 40960
  s_add_u32 m0, s31, 0
  s_nop 0
  buffer_load_dwordx4 v4, s[8:11], s30 offen offset:0 lds
  s_add_u32 m0, s31, 3968
  s_nop 0
  buffer_load_dwordx4 v4, s[8:11], s30 offen offset:128 lds
  s_add_u32 m0, s31, 7936
  s_nop 0
  buffer_load_dwordx4 v4, s[8:11], s30 offen offset:256 lds
  s_add_u32 m0, s31, 11904
  s_nop 0
  buffer_load_dwordx4 v4, s[8:11], s30 offen offset:384 lds
  s_add_u32 m0, s31, 15872
  s_nop 0
  buffer_load_dwordx4 v4, s[8:11], s30 offen offset:512 lds
  s_add_u32 m0, s31, 19840
  s_nop 0
  buffer_load_dwordx4 v4, s[8:11], s30 offen offset:640 lds
  s_add_u32 m0, s31, 23808
  s_nop 0
  buffer_load_dwordx4 v4, s[8:11], s30 offen offset:768 lds
  s_add_u32 m0, s31, 27776
  s_nop 0
  buffer_load_dwordx4 v4, s[8:11], s30 offen offset:896 lds
  s_add_u32 m0, s31, 31744
  s_nop 0
  buffer_load_dwordx4 v4, s[8:11], s30 offen offset:1024 lds
  s_add_u32 m0, s31, 35712
  s_nop 0
  buffer_load_dwordx4 v4, s[8:11], s30 offen offset:1152 lds
  s_add_u32 s31, s31, 40960
  s_add_u32 s30, s30, 40960
  v_and_b32 v10, 7, v2
  v_add_u32 v8, 0, v3
  v_xor_b32 v8, v8, v10
  v_lshlrev_b32 v8, 4, v8
  v_lshl_add_u32 v5, v2, 7, v8
  v_add_u32 v8, 4, v3
  v_xor_b32 v8, v8, v10
  v_lshlrev_b32 v8, 4, v8
  v_lshl_add_u32 v6, v2, 7, v8
  v_mov_b32 v7, v5
  v_mov_b32 v8, v6
  s_mov_b32 s33, 0
  v_lshlrev_b32 v15, 4, v1
  v_mov_b32 v16, 0xf149f2ca
  v_lshrrev_b32 v17, 3, v2
  v_mul_u32_u24 v17, 2560, v17
  v_lshlrev_b32 v18, 1, v10
  s_lshr_b32 s21, s20, 1
  s_lshl_b32 s21, s21, 10
  s_and_b32 s22, s20, 1
  s_lshl_b32 s22, s22, 3
  s_add_u32 s21, s21, s22
  s_add_u32 s21, s21, 131072
  v_lshl_add_u32 v9, v3, 4, v18
  v_lshl_add_u32 v9, v9, 4, v17
  v_add_u32 v9, s21, v9
  s_lshl_b32 s21, s20, 7
  s_add_u32 s21, s21, 133120
  v_lshl_add_u32 v10, v18, 3, v17
  v_add_u32 v10, s21, v10
  v_cmp_eq_u32 vcc, 2, v3
  v_lshlrev_b32 v19, 4, v1
  v_add_u32 v19, 136192, v19
  v_cndmask_b32 v10, v19, v10, vcc
  s_lshr_b32 s21, s20, 1
  s_and_b32 s22, s20, 1
  s_mul_i32 s23, s21, 2560
  s_lshl_b32 s47, s22, 10
  s_add_u32 s47, s47, s23
  s_add_u32 s47, s47, 131072
  v_add_u32 v11, s47, v15
  s_lshl_b32 s47, s22, 8
  s_add_u32 s47, s47, s23
  s_add_u32 s47, s47, 133120
  v_add_u32 v12, s47, v15
  s_mul_i32 s23, s22, 768
  s_sub_u32 s23, 2048, s23
  v_add_u32 v14, s23, v15
  v_mov_b32 v19, 1073741824
  v_cmp_gt_u32 vcc, 16, v1
  s_lshl_b32 s47, s42, 23
  s_lshl_b32 s21, s21, 14
  v_cndmask_b32 v14, v19, v14, vcc
  s_add_u32 s47, s47, s21
  s_lshr_b32 s21, s41, 1
  s_lshl_b32 s21, s21, 15
  s_add_u32 s47, s47, s21
  s_and_b32 s21, s41, 1
  s_mul_i32 s21, s21, 2560
  s_add_u32 s47, s47, s21
  s_xor_b32 s21, s80, 184819712
  s_add_u32 s47, s47, s21
  s_lshl_b32 s22, s22, 10
  s_add_u32 s47, s47, s22
  s_mov_b32 s48, 1073741824
  s_mov_b32 s49, 1073741824
  v_cmp_eq_u32 s[62:63], 0, v3
  v_lshlrev_b32 v17, 2, v3
  v_sub_u32 v17, v17, v2
  s_mov_b32 s82, 0x3e64f92e
  s_mov_b32 s83, 0x3fb8aa3b
  v_mov_b32 v20, 0
  v_mov_b32 v21, 0
  v_mov_b32 v22, 0
  v_mov_b32 v23, 0
  v_add_u32 v18, 7, v17
  v_cmp_gt_u32 s[84:85], 8, v18
  v_cmp_le_i32 s[64:65], 16, v18
  v_mov_b32 v18, 65535
  v_cndmask_b32 v19, 0, v18, s[84:85]
  v_or_b32 v20, v20, v19
  v_cndmask_b32 v19, 0, v18, s[64:65]
  v_or_b32 v22, v22, v19
  s_mov_b64 s[54:55], s[84:85]
  s_or_b64 s[84:85], s[84:85], s[64:65]
  v_add_u32 v18, 8, v17
  v_cmp_gt_u32 s[86:87], 8, v18
  v_cmp_le_i32 s[66:67], 16, v18
  v_mov_b32 v18, 4294901760
  v_cndmask_b32 v19, 0, v18, s[86:87]
  v_or_b32 v20, v20, v19
  v_cndmask_b32 v19, 0, v18, s[66:67]
  v_or_b32 v22, v22, v19
  s_mov_b64 s[56:57], s[86:87]
  s_or_b64 s[86:87], s[86:87], s[66:67]
  v_add_u32 v18, 9, v17
  v_cmp_gt_u32 s[88:89], 8, v18
  v_cmp_le_i32 s[68:69], 16, v18
  v_mov_b32 v18, 65535
  v_cndmask_b32 v19, 0, v18, s[88:89]
  v_or_b32 v21, v21, v19
  v_cndmask_b32 v19, 0, v18, s[68:69]
  v_or_b32 v23, v23, v19
  s_mov_b64 s[58:59], s[88:89]
  s_or_b64 s[88:89], s[88:89], s[68:69]
  v_add_u32 v18, 10, v17
  v_cmp_gt_u32 s[90:91], 8, v18
  v_cmp_le_i32 s[70:71], 16, v18
  v_mov_b32 v18, 4294901760
  v_cndmask_b32 v19, 0, v18, s[90:91]
  v_or_b32 v21, v21, v19
  v_cndmask_b32 v19, 0, v18, s[70:71]
  v_or_b32 v23, v23, v19
  s_mov_b64 s[60:61], s[90:91]
  s_or_b64 s[90:91], s[90:91], s[70:71]
  v_mov_b32 v18, 0x3f80
  v_mov_b32 v19, 0x3f800000
  v_cmp_eq_i32 vcc, 0, v17
  v_cmp_eq_i32 s[22:23], -1, v17
  s_nop 1
  v_cndmask_b32 v24, 0, v18, vcc
  v_cndmask_b32 v24, v24, v19, s[22:23]
  v_cmp_eq_i32 vcc, -2, v17
  v_cmp_eq_i32 s[22:23], -3, v17
  s_nop 1
  v_cndmask_b32 v25, 0, v18, vcc
  v_cndmask_b32 v25, v25, v19, s[22:23]
  v_mov_b32 v26, 0
  v_mov_b32 v27, 0
  v_mov_b32 v60, 0
  v_mov_b32 v61, 0
  v_mov_b32 v62, 0
  v_mov_b32 v63, 0
  v_mov_b32 v64, 0
  v_mov_b32 v65, 0
  v_mov_b32 v66, 0
  v_mov_b32 v67, 0
  v_mov_b32 v68, 0
  v_mov_b32 v69, 0
  v_mov_b32 v70, 0
  v_mov_b32 v71, 0
  v_mov_b32 v72, 0
  v_mov_b32 v73, 0
  v_mov_b32 v74, 0
  v_mov_b32 v75, 0
  v_mov_b32 v76, 0
  v_mov_b32 v77, 0
  v_mov_b32 v78, 0
  v_mov_b32 v79, 0
  v_mov_b32 v80, 0
  v_mov_b32 v81, 0
  v_mov_b32 v82, 0
  v_mov_b32 v83, 0
  v_mov_b32 v84, 0
  v_mov_b32 v85, 0
  v_mov_b32 v86, 0
  v_mov_b32 v87, 0
  v_mov_b32 v88, 0
  v_mov_b32 v89, 0
  v_mov_b32 v90, 0
  v_mov_b32 v91, 0
  v_mov_b32 v92, 0
  v_mov_b32 v93, 0
  v_mov_b32 v94, 0
  v_mov_b32 v95, 0
  v_mov_b32 v96, 0
  v_mov_b32 v97, 0
  v_mov_b32 v98, 0
  v_mov_b32 v99, 0
  v_mov_b32 v100, 0
  v_mov_b32 v101, 0
  v_mov_b32 v102, 0
  v_mov_b32 v103, 0
  v_mov_b32 v104, 0
  v_mov_b32 v105, 0
  v_mov_b32 v106, 0
  v_mov_b32 v107, 0
  v_mov_b32 v108, 0
  v_mov_b32 v109, 0
  v_mov_b32 v110, 0
  v_mov_b32 v111, 0
  v_mov_b32 v112, 0
  v_mov_b32 v113, 0
  v_mov_b32 v114, 0
  v_mov_b32 v115, 0
  v_mov_b32 v116, 0
  v_mov_b32 v117, 0
  v_mov_b32 v118, 0
  v_mov_b32 v119, 0
  v_mov_b32 v120, 0
  v_mov_b32 v121, 0
  v_mov_b32 v122, 0
  v_mov_b32 v123, 0
  v_mov_b32 v124, 0
  v_mov_b32 v125, 0
  v_mov_b32 v126, 0
  v_mov_b32 v127, 0
  v_mov_b32 v128, 0
  v_mov_b32 v129, 0
  v_mov_b32 v130, 0
  v_mov_b32 v131, 0
  s_cmp_eq_u32 s42, 0
  s_cselect_b32 s53, 15, 99
  s_mov_b32 s26, 17
  s_waitcnt vmcnt(10)
  s_barrier
  ds_read_b128 v[28:31], v7 offset:0
  ds_read_b128 v[32:35], v8 offset:0
  ds_read_b128 v[36:39], v7 offset:4096
  ds_read_b128 v[40:43], v8 offset:4096
  s_waitcnt lgkmcnt(3)
  .p2align 3
bfl_257:
  v_mfma_f32_16x16x32_bf16 v[60:63], a[0:3], v[28:31], 0
  ds_read_b128 v[44:47], v7 offset:8192
  v_mfma_f32_16x16x32_bf16 v[64:67], a[4:7], v[28:31], 0
  v_mfma_f32_16x16x32_bf16 v[68:71], a[8:11], v[28:31], 0
  v_cvt_pk_bf16_f32 v128, v84, v85
  v_cvt_pk_bf16_f32 v129, v86, v87
  v_mfma_f32_16x16x32_bf16 v[72:75], v[28:31], a[12:15], 0
  s_waitcnt lgkmcnt(3)
  v_cvt_pk_bf16_f32 v124, v76, v77
  v_cvt_pk_bf16_f32 v125, v78, v79
  v_mfma_f32_16x16x32_bf16 v[60:63], a[16:19], v[32:35], v[60:63]
  ds_read_b128 v[48:51], v8 offset:8192
  v_cvt_pk_bf16_f32 v100, v80, v81
  v_mfma_f32_16x16x32_bf16 v[64:67], a[20:23], v[32:35], v[64:67]
  v_cvt_pk_bf16_f32 v101, v82, v83
  v_cvt_pk_bf16_f32 v116, v88, v89
  v_mfma_f32_16x16x32_bf16 v[68:71], a[24:27], v[32:35], v[68:71]
  s_add_u32 m0, s31, 0
  v_cvt_pk_bf16_f32 v117, v90, v91
  v_cndmask_b32 v126, 0, v128, s[62:63]
  v_mfma_f32_16x16x32_bf16 v[72:75], v[32:35], a[28:31], v[72:75]
  s_waitcnt lgkmcnt(3)
  v_cndmask_b32 v127, 0, v129, s[62:63]
  buffer_load_dwordx4 v4, s[8:11], s30 offen offset:0 lds
  v_mfma_f32_16x16x32_bf16 v[60:63], a[32:35], v[36:39], v[60:63]
  ds_read_b128 v[52:55], v7 offset:12288
  v_mfma_f32_16x16x32_bf16 v[64:67], a[36:39], v[36:39], v[64:67]
  v_mfma_f32_16x16x32_bf16 v[68:71], a[40:43], v[36:39], v[68:71]
  v_mfma_f32_16x16x32_bf16 v[72:75], v[36:39], a[44:47], v[72:75]
  v_mfma_f32_16x16x32_bf16 v[132:135], v[128:131], v[24:27], 0
  s_waitcnt lgkmcnt(3)
  v_permlane16_swap_b32 v128, v102
  v_permlane16_swap_b32 v129, v103
  v_mfma_f32_16x16x32_bf16 v[60:63], a[48:51], v[40:43], v[60:63]
  ds_read_b128 v[56:59], v8 offset:12288
  v_mfma_f32_16x16x32_bf16 v[64:67], a[52:55], v[40:43], v[64:67]
  v_mfma_f32_16x16x32_bf16 v[68:71], a[56:59], v[40:43], v[68:71]
  v_mfma_f32_16x16x32_bf16 v[72:75], v[40:43], a[60:63], v[72:75]
  v_mfma_f32_16x16x32_bf16 v[136:139], v[100:103], v[124:127], 0
  v_mfma_f32_16x16x32_bf16 v[140:143], v[104:107], v[124:127], 0
  s_add_u32 m0, s31, 3968
  s_waitcnt lgkmcnt(3)
  v_mfma_f32_16x16x32_bf16 v[60:63], a[64:67], v[44:47], v[60:63]
  ds_read_b128 v[28:31], v7 offset:16384
  buffer_load_dwordx4 v4, s[8:11], s30 offen offset:128 lds
  v_mfma_f32_16x16x32_bf16 v[64:67], a[68:71], v[44:47], v[64:67]
  v_mfma_f32_16x16x32_bf16 v[68:71], a[72:75], v[44:47], v[68:71]
  v_cvt_pk_bf16_f32 v120, v132, v133
  v_cvt_pk_bf16_f32 v121, v134, v135
  v_mfma_f32_16x16x32_bf16 v[72:75], v[44:47], a[76:79], v[72:75]
  s_waitcnt lgkmcnt(3)
  v_cndmask_b32 v136, v136, v140, s[64:65]
  v_cndmask_b32 v137, v137, v141, s[66:67]
  v_mfma_f32_16x16x32_bf16 v[60:63], a[80:83], v[48:51], v[60:63]
  ds_read_b128 v[32:35], v8 offset:16384
  v_cndmask_b32 v138, v138, v142, s[68:69]
  v_mfma_f32_16x16x32_bf16 v[64:67], a[84:87], v[48:51], v[64:67]
  v_cndmask_b32 v139, v139, v143, s[70:71]
  v_cvt_pk_bf16_f32 v17, v136, v137
  v_mfma_f32_16x16x32_bf16 v[68:71], a[88:91], v[48:51], v[68:71]
  v_lshlrev_b32 v136, 16, v17
  v_and_b32 v137, 0xffff0000, v17
  v_mfma_f32_16x16x32_bf16 v[72:75], v[48:51], a[92:95], v[72:75]
  s_waitcnt lgkmcnt(3)
  v_cvt_pk_bf16_f32 v17, v138, v139
  v_lshlrev_b32 v138, 16, v17
  v_mfma_f32_16x16x32_bf16 v[60:63], a[96:99], v[52:55], v[60:63]
  ds_read_b128 v[36:39], v7 offset:20480
  v_and_b32 v139, 0xffff0000, v17
  v_mfma_f32_16x16x32_bf16 v[64:67], a[100:103], v[52:55], v[64:67]
  v_mul_f32 v136, s82, v136
  v_mul_f32 v137, s82, v137
  v_mfma_f32_16x16x32_bf16 v[68:71], a[104:107], v[52:55], v[68:71]
  v_mul_f32 v138, s82, v138
  v_mul_f32 v139, s82, v139
  v_mfma_f32_16x16x32_bf16 v[72:75], v[52:55], a[108:111], v[72:75]
  s_waitcnt lgkmcnt(3)
  v_cvt_pk_bf16_f32 v17, v136, v137
  v_lshlrev_b32 v136, 16, v17
  v_mfma_f32_16x16x32_bf16 v[60:63], a[112:115], v[56:59], v[60:63]
  s_add_u32 m0, s31, 7936
  ds_read_b128 v[40:43], v8 offset:20480
  v_and_b32 v137, 0xffff0000, v17
  v_mfma_f32_16x16x32_bf16 v[64:67], a[116:119], v[56:59], v[64:67]
  v_cvt_pk_bf16_f32 v17, v138, v139
  v_lshlrev_b32 v138, 16, v17
  v_mfma_f32_16x16x32_bf16 v[68:71], a[120:123], v[56:59], v[68:71]
  v_and_b32 v139, 0xffff0000, v17
  v_cndmask_b32 v136, v16, v136, s[54:55]
  v_mfma_f32_16x16x32_bf16 v[72:75], v[56:59], a[124:127], v[72:75]
  s_waitcnt lgkmcnt(3)
  v_cndmask_b32 v137, v16, v137, s[56:57]
  v_cndmask_b32 v138, v16, v138, s[58:59]
  v_mfma_f32_16x16x32_bf16 v[60:63], a[128:131], v[28:31], v[60:63]
  ds_read_b128 v[44:47], v7 offset:24576
  v_cndmask_b32 v139, v16, v139, s[60:61]
  v_mfma_f32_16x16x32_bf16 v[64:67], a[132:135], v[28:31], v[64:67]
  v_max3_f32 v17, v136, v137, v138
  v_max_f32 v17, v17, v139
  v_mfma_f32_16x16x32_bf16 v[68:71], a[136:139], v[28:31], v[68:71]
  v_mov_b32 v18, v17
  buffer_load_dwordx4 v4, s[8:11], s30 offen offset:256 lds
  v_mfma_f32_16x16x32_bf16 v[72:75], v[28:31], a[140:143], v[72:75]
  s_waitcnt lgkmcnt(3)
  v_permlane32_swap_b32 v17, v18
  v_max_f32 v17, v17, v18
  v_mfma_f32_16x16x32_bf16 v[60:63], a[144:147], v[32:35], v[60:63]
  ds_read_b128 v[48:51], v8 offset:24576
  v_mov_b32 v18, v17
  v_mfma_f32_16x16x32_bf16 v[64:67], a[148:151], v[32:35], v[64:67]
  v_permlane16_swap_b32 v17, v18
  v_max_f32 v17, v17, v18
  v_mfma_f32_16x16x32_bf16 v[68:71], a[152:155], v[32:35], v[68:71]
  v_mul_f32 v17, s83, v17
  v_fma_f32 v136, v136, s83, -v17
  v_mfma_f32_16x16x32_bf16 v[72:75], v[32:35], a[156:159], v[72:75]
  s_waitcnt lgkmcnt(3)
  v_fma_f32 v137, v137, s83, -v17
  v_fma_f32 v138, v138, s83, -v17
  v_mfma_f32_16x16x32_bf16 v[60:63], a[160:163], v[36:39], v[60:63]
  s_add_u32 m0, s31, 11904
  ds_read_b128 v[52:55], v7 offset:28672
  v_fma_f32 v139, v139, s83, -v17
  v_mfma_f32_16x16x32_bf16 v[64:67], a[164:167], v[36:39], v[64:67]
  v_exp_f32 v136, v136
  v_mfma_f32_16x16x32_bf16 v[68:71], a[168:171], v[36:39], v[68:71]
  v_exp_f32 v137, v137
  v_mfma_f32_16x16x32_bf16 v[72:75], v[36:39], a[172:175], v[72:75]
  s_waitcnt lgkmcnt(3)
  v_exp_f32 v138, v138
  v_mfma_f32_16x16x32_bf16 v[60:63], a[176:179], v[40:43], v[60:63]
  ds_read_b128 v[56:59], v8 offset:28672
  buffer_load_dwordx4 v4, s[8:11], s30 offen offset:384 lds
  v_mfma_f32_16x16x32_bf16 v[64:67], a[180:183], v[40:43], v[64:67]
  v_exp_f32 v139, v139
  v_mfma_f32_16x16x32_bf16 v[68:71], a[184:187], v[40:43], v[68:71]
  v_add_f32 v17, v136, v137
  v_add_f32 v18, v138, v139
  v_mfma_f32_16x16x32_bf16 v[72:75], v[40:43], a[188:191], v[72:75]
  s_waitcnt lgkmcnt(3)
  v_add_f32 v17, v17, v18
  v_mov_b32 v18, v17
  v_mfma_f32_16x16x32_bf16 v[60:63], a[192:195], v[44:47], v[60:63]
  ds_read_b128 v[28:31], v7 offset:32768
  v_permlane32_swap_b32 v17, v18
  v_mfma_f32_16x16x32_bf16 v[64:67], a[196:199], v[44:47], v[64:67]
  v_add_f32 v17, v17, v18
  v_mov_b32 v18, v17
  v_mfma_f32_16x16x32_bf16 v[68:71], a[200:203], v[44:47], v[68:71]
  v_permlane16_swap_b32 v17, v18
  v_add_f32 v17, v17, v18
  v_mfma_f32_16x16x32_bf16 v[72:75], v[44:47], a[204:207], v[72:75]
  s_waitcnt lgkmcnt(3)
  v_rcp_f32 v17, v17
  v_mfma_f32_16x16x32_bf16 v[60:63], a[208:211], v[48:51], v[60:63]
  s_add_u32 m0, s31, 15872
  ds_read_b128 v[32:35], v8 offset:32768
  v_mul_f32 v136, v136, v17
  v_mfma_f32_16x16x32_bf16 v[64:67], a[212:215], v[48:51], v[64:67]
  v_mul_f32 v137, v137, v17
  v_mul_f32 v138, v138, v17
  v_mfma_f32_16x16x32_bf16 v[68:71], a[216:219], v[48:51], v[68:71]
  v_mul_f32 v139, v139, v17
  v_cvt_pk_bf16_f32 v144, v136, v137
  v_mfma_f32_16x16x32_bf16 v[72:75], v[48:51], a[220:223], v[72:75]
  s_waitcnt lgkmcnt(3)
  v_cvt_pk_bf16_f32 v145, v138, v139
  v_and_b32 v146, v144, v22
  v_mfma_f32_16x16x32_bf16 v[60:63], a[224:227], v[52:55], v[60:63]
  ds_read_b128 v[36:39], v7 offset:36864
  v_and_b32 v147, v145, v23
  v_mfma_f32_16x16x32_bf16 v[64:67], a[228:231], v[52:55], v[64:67]
  v_and_b32 v144, v144, v20
  v_and_b32 v145, v145, v21
  v_mfma_f32_16x16x32_bf16 v[68:71], a[232:235], v[52:55], v[68:71]
  buffer_load_dwordx4 v4, s[8:11], s30 offen offset:512 lds
  v_mfma_f32_16x16x32_bf16 v[72:75], v[52:55], a[236:239], v[72:75]
  s_waitcnt lgkmcnt(3)
  v_mfma_f32_16x16x32_bf16 v[60:63], a[240:243], v[56:59], v[60:63]
  ds_read_b128 v[40:43], v8 offset:36864
  v_mfma_f32_16x16x32_bf16 v[64:67], a[244:247], v[56:59], v[64:67]
  v_mfma_f32_16x16x32_bf16 v[68:71], a[248:251], v[56:59], v[68:71]
  v_mfma_f32_16x16x32_bf16 v[72:75], v[56:59], a[252:255], v[72:75]
  s_add_u32 m0, s31, 19840
  s_waitcnt lgkmcnt(3)
  v_mfma_f32_16x16x32_bf16 v[60:63], v[192:195], v[28:31], v[60:63]
  ds_read_b128 v[44:47], v7 offset:2048
  buffer_load_dwordx4 v4, s[8:11], s30 offen offset:640 lds
  v_mfma_f32_16x16x32_bf16 v[64:67], v[196:199], v[28:31], v[64:67]
  v_mfma_f32_16x16x32_bf16 v[68:71], v[200:203], v[28:31], v[68:71]
  v_mfma_f32_16x16x32_bf16 v[72:75], v[28:31], v[204:207], v[72:75]
  v_mfma_f32_16x16x32_bf16 v[148:151], v[116:119], v[144:147], 0
  s_cmp_le_u32 s26, s53
  s_cselect_b64 s[54:55], s[84:85], s[54:55]
  v_mfma_f32_16x16x32_bf16 v[152:155], v[120:123], v[144:147], 0
  s_waitcnt lgkmcnt(3)
  v_mov_b32 v104, v100
  v_mov_b32 v105, v101
  v_mfma_f32_16x16x32_bf16 v[60:63], v[208:211], v[32:35], v[60:63]
  ds_read_b128 v[48:51], v8 offset:2048
  v_mov_b32 v106, v102
  v_mfma_f32_16x16x32_bf16 v[64:67], v[212:215], v[32:35], v[64:67]
  v_mov_b32 v107, v103
  v_mov_b32 v118, v116
  v_mfma_f32_16x16x32_bf16 v[68:71], v[216:219], v[32:35], v[68:71]
  v_cvt_pk_bf16_f32 v156, v148, v149
  v_cvt_pk_bf16_f32 v157, v150, v151
  v_mfma_f32_16x16x32_bf16 v[72:75], v[32:35], v[220:223], v[72:75]
  s_waitcnt lgkmcnt(3)
  ds_write_b64 v9, v[156:157] offset:16
  v_cvt_pk_bf16_f32 v158, v152, v153
  v_mfma_f32_16x16x32_bf16 v[60:63], v[224:227], v[36:39], v[60:63]
  ds_read_b128 v[52:55], v7 offset:6144
  v_cvt_pk_bf16_f32 v159, v154, v155
  v_mfma_f32_16x16x32_bf16 v[64:67], v[228:231], v[36:39], v[64:67]
  s_add_u32 m0, s31, 23808
  ds_write_b64 v10, v[158:159] offset:8
  v_mov_b32 v119, v117
  v_mfma_f32_16x16x32_bf16 v[68:71], v[232:235], v[36:39], v[68:71]
  v_mov_b32 v122, v120
  v_mov_b32 v123, v121
  v_mfma_f32_16x16x32_bf16 v[72:75], v[36:39], v[236:239], v[72:75]
  s_waitcnt lgkmcnt(5)
  buffer_load_dwordx4 v4, s[8:11], s30 offen offset:768 lds
  v_mfma_f32_16x16x32_bf16 v[60:63], v[240:243], v[40:43], v[60:63]
  ds_read_b128 v[56:59], v8 offset:6144
  v_mfma_f32_16x16x32_bf16 v[64:67], v[244:247], v[40:43], v[64:67]
  s_cmp_le_u32 s26, s53
  s_cselect_b64 s[56:57], s[86:87], s[56:57]
  v_mfma_f32_16x16x32_bf16 v[68:71], v[248:251], v[40:43], v[68:71]
  s_cmp_le_u32 s26, s53
  s_cselect_b64 s[58:59], s[88:89], s[58:59]
  v_mfma_f32_16x16x32_bf16 v[72:75], v[40:43], v[252:255], v[72:75]
  s_waitcnt lgkmcnt(5)
  s_cmp_le_u32 s26, s53
  s_cselect_b64 s[60:61], s[90:91], s[60:61]
  v_mfma_f32_16x16x32_bf16 v[76:79], a[0:3], v[44:47], 0
  ds_read_b128 v[28:31], v7 offset:10240
  v_mfma_f32_16x16x32_bf16 v[80:83], a[4:7], v[44:47], 0
  s_waitcnt lgkmcnt(2)
  s_barrier
  v_mfma_f32_16x16x32_bf16 v[84:87], a[8:11], v[44:47], 0
  v_cvt_pk_bf16_f32 v128, v68, v69
  v_cvt_pk_bf16_f32 v129, v70, v71
  v_mfma_f32_16x16x32_bf16 v[88:91], v[44:47], a[12:15], 0
  s_waitcnt lgkmcnt(5)
  v_cvt_pk_bf16_f32 v124, v60, v61
  v_cvt_pk_bf16_f32 v125, v62, v63
  v_mfma_f32_16x16x32_bf16 v[76:79], a[16:19], v[48:51], v[76:79]
  ds_read_b128 v[32:35], v8 offset:10240
  v_cvt_pk_bf16_f32 v92, v64, v65
  v_mfma_f32_16x16x32_bf16 v[80:83], a[20:23], v[48:51], v[80:83]
  s_add_u32 m0, s31, 27776
  v_cvt_pk_bf16_f32 v93, v66, v67
  v_cvt_pk_bf16_f32 v108, v72, v73
  v_mfma_f32_16x16x32_bf16 v[84:87], a[24:27], v[48:51], v[84:87]
  v_cvt_pk_bf16_f32 v109, v74, v75
  v_cndmask_b32 v126, 0, v128, s[62:63]
  v_mfma_f32_16x16x32_bf16 v[88:91], v[48:51], a[28:31], v[88:91]
  s_waitcnt lgkmcnt(4)
  v_cndmask_b32 v127, 0, v129, s[62:63]
  v_xor_b32 v9, 8192, v9
  v_mfma_f32_16x16x32_bf16 v[76:79], a[32:35], v[52:55], v[76:79]
  ds_read_b128 v[36:39], v7 offset:14336
  v_xor_b32 v10, 8192, v10
  v_mfma_f32_16x16x32_bf16 v[80:83], a[36:39], v[52:55], v[80:83]
  ds_read_b128 v[160:163], v11
  ds_read_b128 v[164:167], v12
  v_mfma_f32_16x16x32_bf16 v[84:87], a[40:43], v[52:55], v[84:87]
  buffer_load_dwordx4 v4, s[8:11], s30 offen offset:896 lds
  v_mfma_f32_16x16x32_bf16 v[88:91], v[52:55], a[44:47], v[88:91]
  v_mfma_f32_16x16x32_bf16 v[132:135], v[128:131], v[24:27], 0
  s_waitcnt lgkmcnt(5)
  v_permlane16_swap_b32 v128, v94
  v_permlane16_swap_b32 v129, v95
  v_mfma_f32_16x16x32_bf16 v[76:79], a[48:51], v[56:59], v[76:79]
  ds_read_b128 v[40:43], v8 offset:14336
  v_mfma_f32_16x16x32_bf16 v[80:83], a[52:55], v[56:59], v[80:83]
  v_mfma_f32_16x16x32_bf16 v[84:87], a[56:59], v[56:59], v[84:87]
  s_waitcnt lgkmcnt(1)
  buffer_store_dwordx4 v[160:163], v15, s[16:19], s49 offen sc1
  buffer_store_dwordx4 v[164:167], v14, s[16:19], s49 offen sc1
  v_mfma_f32_16x16x32_bf16 v[88:91], v[56:59], a[60:63], v[88:91]
  v_xor_b32 v11, 8192, v11
  v_xor_b32 v12, 8192, v12
  v_mfma_f32_16x16x32_bf16 v[136:139], v[92:95], v[124:127], 0
  s_add_u32 m0, s31, 31744
  s_mov_b32 s49, s48
  s_mov_b32 s48, s47
  v_mfma_f32_16x16x32_bf16 v[140:143], v[96:99], v[124:127], 0
  s_add_u32 s22, s47, 524288
  s_waitcnt lgkmcnt(5)
  buffer_load_dwordx4 v4, s[8:11], s30 offen offset:1024 lds
  v_mfma_f32_16x16x32_bf16 v[76:79], a[64:67], v[28:31], v[76:79]
  s_xor_b32 s47, s47, s22
  ds_read_b128 v[44:47], v7 offset:18432
  s_lshr_b32 s47, s47, 8
  v_mfma_f32_16x16x32_bf16 v[80:83], a[68:71], v[28:31], v[80:83]
  s_and_b32 s47, s47, 8192
  s_xor_b32 s47, s47, s22
  s_sub_u32 s26, s26, 1
  v_mfma_f32_16x16x32_bf16 v[84:87], a[72:75], v[28:31], v[84:87]
  v_cvt_pk_bf16_f32 v112, v132, v133
  v_cvt_pk_bf16_f32 v113, v134, v135
  v_mfma_f32_16x16x32_bf16 v[88:91], v[28:31], a[76:79], v[88:91]
  s_waitcnt lgkmcnt(5)
  v_cndmask_b32 v136, v136, v140, s[64:65]
  v_cndmask_b32 v137, v137, v141, s[66:67]
  v_mfma_f32_16x16x32_bf16 v[76:79], a[80:83], v[32:35], v[76:79]
  ds_read_b128 v[48:51], v8 offset:18432
  v_cndmask_b32 v138, v138, v142, s[68:69]
  v_mfma_f32_16x16x32_bf16 v[80:83], a[84:87], v[32:35], v[80:83]
  v_cndmask_b32 v139, v139, v143, s[70:71]
  v_cvt_pk_bf16_f32 v17, v136, v137
  v_mfma_f32_16x16x32_bf16 v[84:87], a[88:91], v[32:35], v[84:87]
  v_lshlrev_b32 v136, 16, v17
  v_and_b32 v137, 0xffff0000, v17
  v_mfma_f32_16x16x32_bf16 v[88:91], v[32:35], a[92:95], v[88:91]
  s_waitcnt lgkmcnt(5)
  v_cvt_pk_bf16_f32 v17, v138, v139
  v_lshlrev_b32 v138, 16, v17
  v_mfma_f32_16x16x32_bf16 v[76:79], a[96:99], v[36:39], v[76:79]
  ds_read_b128 v[52:55], v7 offset:22528
  v_and_b32 v139, 0xffff0000, v17
  v_mfma_f32_16x16x32_bf16 v[80:83], a[100:103], v[36:39], v[80:83]
  v_mul_f32 v136, s82, v136
  v_mul_f32 v137, s82, v137
  v_mfma_f32_16x16x32_bf16 v[84:87], a[104:107], v[36:39], v[84:87]
  s_add_u32 m0, s31, 35712
  v_mul_f32 v138, s82, v138
  v_mul_f32 v139, s82, v139
  v_mfma_f32_16x16x32_bf16 v[88:91], v[36:39], a[108:111], v[88:91]
  s_waitcnt lgkmcnt(3)
  v_cvt_pk_bf16_f32 v17, v136, v137
  v_lshlrev_b32 v136, 16, v17
  v_mfma_f32_16x16x32_bf16 v[76:79], a[112:115], v[40:43], v[76:79]
  ds_read_b128 v[56:59], v8 offset:22528
  v_and_b32 v137, 0xffff0000, v17
  v_mfma_f32_16x16x32_bf16 v[80:83], a[116:119], v[40:43], v[80:83]
  v_cvt_pk_bf16_f32 v17, v138, v139
  v_lshlrev_b32 v138, 16, v17
  v_mfma_f32_16x16x32_bf16 v[84:87], a[120:123], v[40:43], v[84:87]
  v_and_b32 v139, 0xffff0000, v17
  v_cndmask_b32 v136, v16, v136, s[54:55]
  v_mfma_f32_16x16x32_bf16 v[88:91], v[40:43], a[124:127], v[88:91]
  s_waitcnt lgkmcnt(3)
  v_cndmask_b32 v137, v16, v137, s[56:57]
  v_cndmask_b32 v138, v16, v138, s[58:59]
  v_mfma_f32_16x16x32_bf16 v[76:79], a[128:131], v[44:47], v[76:79]
  ds_read_b128 v[28:31], v7 offset:26624
  v_cndmask_b32 v139, v16, v139, s[60:61]
  v_mfma_f32_16x16x32_bf16 v[80:83], a[132:135], v[44:47], v[80:83]
  v_max3_f32 v17, v136, v137, v138
  v_max_f32 v17, v17, v139
  v_mfma_f32_16x16x32_bf16 v[84:87], a[136:139], v[44:47], v[84:87]
  v_mov_b32 v18, v17
  buffer_load_dwordx4 v4, s[8:11], s30 offen offset:1152 lds
  v_mfma_f32_16x16x32_bf16 v[88:91], v[44:47], a[140:143], v[88:91]
  s_waitcnt lgkmcnt(3)
  v_permlane32_swap_b32 v17, v18
  v_max_f32 v17, v17, v18
  v_mfma_f32_16x16x32_bf16 v[76:79], a[144:147], v[48:51], v[76:79]
  s_add_u32 s30, s30, 40960
  ds_read_b128 v[32:35], v8 offset:26624
  v_mov_b32 v18, v17
  v_mfma_f32_16x16x32_bf16 v[80:83], a[148:151], v[48:51], v[80:83]
  s_add_u32 s31, s31, 40960
  v_permlane16_swap_b32 v17, v18
  v_max_f32 v17, v17, v18
  v_mfma_f32_16x16x32_bf16 v[84:87], a[152:155], v[48:51], v[84:87]
  v_mul_f32 v17, s83, v17
  v_fma_f32 v136, v136, s83, -v17
  v_mfma_f32_16x16x32_bf16 v[88:91], v[48:51], a[156:159], v[88:91]
  s_waitcnt lgkmcnt(3)
  v_fma_f32 v137, v137, s83, -v17
  v_fma_f32 v138, v138, s83, -v17
  v_mfma_f32_16x16x32_bf16 v[76:79], a[160:163], v[52:55], v[76:79]
  ds_read_b128 v[36:39], v7 offset:30720
  v_fma_f32 v139, v139, s83, -v17
  v_mfma_f32_16x16x32_bf16 v[80:83], a[164:167], v[52:55], v[80:83]
  v_exp_f32 v136, v136
  v_mfma_f32_16x16x32_bf16 v[84:87], a[168:171], v[52:55], v[84:87]
  v_exp_f32 v137, v137
  v_mfma_f32_16x16x32_bf16 v[88:91], v[52:55], a[172:175], v[88:91]
  s_waitcnt lgkmcnt(3)
  v_exp_f32 v138, v138
  v_mfma_f32_16x16x32_bf16 v[76:79], a[176:179], v[56:59], v[76:79]
  ds_read_b128 v[40:43], v8 offset:30720
  v_mfma_f32_16x16x32_bf16 v[80:83], a[180:183], v[56:59], v[80:83]
  v_exp_f32 v139, v139
  v_mfma_f32_16x16x32_bf16 v[84:87], a[184:187], v[56:59], v[84:87]
  v_add_f32 v17, v136, v137
  v_add_f32 v18, v138, v139
  v_mfma_f32_16x16x32_bf16 v[88:91], v[56:59], a[188:191], v[88:91]
  s_waitcnt lgkmcnt(3)
  v_add_f32 v17, v17, v18
  v_mov_b32 v18, v17
  v_mfma_f32_16x16x32_bf16 v[76:79], a[192:195], v[28:31], v[76:79]
  ds_read_b128 v[44:47], v7 offset:34816
  v_permlane32_swap_b32 v17, v18
  v_mfma_f32_16x16x32_bf16 v[80:83], a[196:199], v[28:31], v[80:83]
  v_add_f32 v17, v17, v18
  v_mov_b32 v18, v17
  v_mfma_f32_16x16x32_bf16 v[84:87], a[200:203], v[28:31], v[84:87]
  v_permlane16_swap_b32 v17, v18
  v_add_f32 v17, v17, v18
  v_mfma_f32_16x16x32_bf16 v[88:91], v[28:31], a[204:207], v[88:91]
  s_waitcnt lgkmcnt(3)
  v_rcp_f32 v17, v17
  v_mfma_f32_16x16x32_bf16 v[76:79], a[208:211], v[32:35], v[76:79]
  ds_read_b128 v[48:51], v8 offset:34816
  v_mul_f32 v136, v136, v17
  v_mfma_f32_16x16x32_bf16 v[80:83], a[212:215], v[32:35], v[80:83]
  v_mul_f32 v137, v137, v17
  v_mul_f32 v138, v138, v17
  v_mfma_f32_16x16x32_bf16 v[84:87], a[216:219], v[32:35], v[84:87]
  v_mul_f32 v139, v139, v17
  v_cvt_pk_bf16_f32 v144, v136, v137
  v_mfma_f32_16x16x32_bf16 v[88:91], v[32:35], a[220:223], v[88:91]
  s_waitcnt lgkmcnt(3)
  v_cvt_pk_bf16_f32 v145, v138, v139
  v_and_b32 v146, v144, v22
  v_mfma_f32_16x16x32_bf16 v[76:79], a[224:227], v[36:39], v[76:79]
  ds_read_b128 v[52:55], v7 offset:38912
  v_and_b32 v147, v145, v23
  v_mfma_f32_16x16x32_bf16 v[80:83], a[228:231], v[36:39], v[80:83]
  v_and_b32 v144, v144, v20
  v_and_b32 v145, v145, v21
  v_mfma_f32_16x16x32_bf16 v[84:87], a[232:235], v[36:39], v[84:87]
  s_cmp_ge_u32 s31, 122880
  s_cselect_b32 s21, 122880, 0
  s_sub_u32 s31, s31, s21
  v_mfma_f32_16x16x32_bf16 v[88:91], v[36:39], a[236:239], v[88:91]
  s_add_u32 s33, s33, 40960
  s_waitcnt lgkmcnt(3)
  v_mfma_f32_16x16x32_bf16 v[76:79], a[240:243], v[40:43], v[76:79]
  ds_read_b128 v[56:59], v8 offset:38912
  v_mfma_f32_16x16x32_bf16 v[80:83], a[244:247], v[40:43], v[80:83]
  s_cmp_ge_u32 s33, 122880
  s_cselect_b32 s33, 0, s33
  v_mfma_f32_16x16x32_bf16 v[84:87], a[248:251], v[40:43], v[84:87]
  v_add_u32 v7, s33, v5
  v_add_u32 v8, s33, v6
  v_mfma_f32_16x16x32_bf16 v[88:91], v[40:43], a[252:255], v[88:91]
  s_waitcnt lgkmcnt(3)
  v_mfma_f32_16x16x32_bf16 v[76:79], v[192:195], v[44:47], v[76:79]
  s_waitcnt vmcnt(12)
  s_barrier
  ds_read_b128 v[28:31], v7 offset:0
  v_mfma_f32_16x16x32_bf16 v[80:83], v[196:199], v[44:47], v[80:83]
  v_mfma_f32_16x16x32_bf16 v[84:87], v[200:203], v[44:47], v[84:87]
  v_mfma_f32_16x16x32_bf16 v[88:91], v[44:47], v[204:207], v[88:91]
  v_mfma_f32_16x16x32_bf16 v[148:151], v[108:111], v[144:147], 0
  v_mfma_f32_16x16x32_bf16 v[152:155], v[112:115], v[144:147], 0
  s_waitcnt lgkmcnt(3)
  v_mov_b32 v96, v92
  v_mov_b32 v97, v93
  v_mfma_f32_16x16x32_bf16 v[76:79], v[208:211], v[48:51], v[76:79]
  ds_read_b128 v[32:35], v8 offset:0
  v_mov_b32 v98, v94
  v_mfma_f32_16x16x32_bf16 v[80:83], v[212:215], v[48:51], v[80:83]
  v_mov_b32 v99, v95
  v_mov_b32 v110, v108
  v_mfma_f32_16x16x32_bf16 v[84:87], v[216:219], v[48:51], v[84:87]
  v_cvt_pk_bf16_f32 v156, v148, v149
  v_cvt_pk_bf16_f32 v157, v150, v151
  v_mfma_f32_16x16x32_bf16 v[88:91], v[48:51], v[220:223], v[88:91]
  s_waitcnt lgkmcnt(3)
  ds_write_b64 v9, v[156:157] offset:0
  v_cvt_pk_bf16_f32 v158, v152, v153
  v_mfma_f32_16x16x32_bf16 v[76:79], v[224:227], v[52:55], v[76:79]
  ds_read_b128 v[36:39], v7 offset:4096
  v_cvt_pk_bf16_f32 v159, v154, v155
  v_mfma_f32_16x16x32_bf16 v[80:83], v[228:231], v[52:55], v[80:83]
  ds_write_b64 v10, v[158:159] offset:0
  v_mov_b32 v111, v109
  v_mfma_f32_16x16x32_bf16 v[84:87], v[232:235], v[52:55], v[84:87]
  v_mov_b32 v114, v112
  v_mov_b32 v115, v113
  v_mfma_f32_16x16x32_bf16 v[88:91], v[52:55], v[236:239], v[88:91]
  s_waitcnt lgkmcnt(5)
  v_mfma_f32_16x16x32_bf16 v[76:79], v[240:243], v[56:59], v[76:79]
  ds_read_b128 v[40:43], v8 offset:4096
  v_mfma_f32_16x16x32_bf16 v[80:83], v[244:247], v[56:59], v[80:83]
  v_mfma_f32_16x16x32_bf16 v[84:87], v[248:251], v[56:59], v[84:87]
  s_cmp_gt_u32 s26, 0
  v_mfma_f32_16x16x32_bf16 v[88:91], v[56:59], v[252:255], v[88:91]
  s_waitcnt lgkmcnt(5)
  s_cbranch_scc1 bfl_257
  s_nop 7
  v_cvt_pk_bf16_f32 v128, v84, v85
  v_cvt_pk_bf16_f32 v129, v86, v87
  v_cvt_pk_bf16_f32 v124, v76, v77
  v_cvt_pk_bf16_f32 v125, v78, v79
  v_cvt_pk_bf16_f32 v100, v80, v81
  v_cvt_pk_bf16_f32 v101, v82, v83
  v_cvt_pk_bf16_f32 v116, v88, v89
  v_cvt_pk_bf16_f32 v117, v90, v91
  v_cndmask_b32 v126, 0, v128, s[62:63]
  v_cndmask_b32 v127, 0, v129, s[62:63]
  s_nop 1
  v_mfma_f32_16x16x32_bf16 v[132:135], v[128:131], v[24:27], 0
  s_nop 7
  v_permlane16_swap_b32 v128, v102
  v_permlane16_swap_b32 v129, v103
  s_nop 1
  v_mfma_f32_16x16x32_bf16 v[136:139], v[100:103], v[124:127], 0
  v_mfma_f32_16x16x32_bf16 v[140:143], v[104:107], v[124:127], 0
  s_nop 7
  v_cvt_pk_bf16_f32 v120, v132, v133
  v_cvt_pk_bf16_f32 v121, v134, v135
  v_cndmask_b32 v136, v136, v140, s[64:65]
  v_cndmask_b32 v137, v137, v141, s[66:67]
  v_cndmask_b32 v138, v138, v142, s[68:69]
  v_cndmask_b32 v139, v139, v143, s[70:71]
  v_cvt_pk_bf16_f32 v17, v136, v137
  v_lshlrev_b32 v136, 16, v17
  v_and_b32 v137, 0xffff0000, v17
  v_cvt_pk_bf16_f32 v17, v138, v139
  v_lshlrev_b32 v138, 16, v17
  v_and_b32 v139, 0xffff0000, v17
  v_mul_f32 v136, s82, v136
  v_mul_f32 v137, s82, v137
  v_mul_f32 v138, s82, v138
  v_mul_f32 v139, s82, v139
  v_cvt_pk_bf16_f32 v17, v136, v137
  v_lshlrev_b32 v136, 16, v17
  v_and_b32 v137, 0xffff0000, v17
  v_cvt_pk_bf16_f32 v17, v138, v139
  v_lshlrev_b32 v138, 16, v17
  v_and_b32 v139, 0xffff0000, v17
  v_cndmask_b32 v136, v16, v136, s[54:55]
  v_cndmask_b32 v137, v16, v137, s[56:57]
  v_cndmask_b32 v138, v16, v138, s[58:59]
  v_cndmask_b32 v139, v16, v139, s[60:61]
  v_max3_f32 v17, v136, v137, v138
  v_max_f32 v17, v17, v139
  v_mov_b32 v18, v17
  s_nop 1
  v_permlane32_swap_b32 v17, v18
  v_max_f32 v17, v17, v18
  v_mov_b32 v18, v17
  s_nop 1
  v_permlane16_swap_b32 v17, v18
  v_max_f32 v17, v17, v18
  v_mul_f32 v17, s83, v17
  v_fma_f32 v136, v136, s83, -v17
  v_fma_f32 v137, v137, s83, -v17
  v_fma_f32 v138, v138, s83, -v17
  v_fma_f32 v139, v139, s83, -v17
  v_exp_f32 v136, v136
  v_exp_f32 v137, v137
  v_exp_f32 v138, v138
  v_exp_f32 v139, v139
  s_nop 1
  v_add_f32 v17, v136, v137
  v_add_f32 v18, v138, v139
  v_add_f32 v17, v17, v18
  v_mov_b32 v18, v17
  s_nop 1
  v_permlane32_swap_b32 v17, v18
  v_add_f32 v17, v17, v18
  v_mov_b32 v18, v17
  s_nop 1
  v_permlane16_swap_b32 v17, v18
  v_add_f32 v17, v17, v18
  v_rcp_f32 v17, v17
  s_nop 1
  v_mul_f32 v136, v136, v17
  v_mul_f32 v137, v137, v17
  v_mul_f32 v138, v138, v17
  v_mul_f32 v139, v139, v17
  v_cvt_pk_bf16_f32 v144, v136, v137
  v_cvt_pk_bf16_f32 v145, v138, v139
  v_and_b32 v146, v144, v22
  v_and_b32 v147, v145, v23
  v_and_b32 v144, v144, v20
  v_and_b32 v145, v145, v21
  s_nop 1
  v_mfma_f32_16x16x32_bf16 v[148:151], v[116:119], v[144:147], 0
  v_mfma_f32_16x16x32_bf16 v[152:155], v[120:123], v[144:147], 0
  s_nop 7
  v_mov_b32 v104, v100
  v_mov_b32 v105, v101
  v_mov_b32 v106, v102
  v_mov_b32 v107, v103
  v_mov_b32 v118, v116
  v_mov_b32 v119, v117
  v_mov_b32 v122, v120
  v_mov_b32 v123, v121
  v_cvt_pk_bf16_f32 v156, v148, v149
  v_cvt_pk_bf16_f32 v157, v150, v151
  ds_write_b64 v9, v[156:157] offset:16
  v_cvt_pk_bf16_f32 v158, v152, v153
  v_cvt_pk_bf16_f32 v159, v154, v155
  ds_write_b64 v10, v[158:159] offset:8
  s_waitcnt lgkmcnt(0)
  s_barrier
  ds_read_b128 v[160:163], v11
  ds_read_b128 v[164:167], v12
  s_waitcnt lgkmcnt(0)
  buffer_store_dwordx4 v[160:163], v15, s[16:19], s49 offen sc1
  buffer_store_dwordx4 v[164:167], v14, s[16:19], s49 offen sc1
  s_waitcnt vmcnt(0)
  s_barrier
  s_lshl_b32 s21, s42, 7
  s_add_u32 s21, s21, 29696
  s_xor_b32 s21, s21, s80
  s_cmp_lg_u32 s20, 0
  s_cbranch_scc1 af_258
  v_mov_b32 v8, 0
  v_mov_b32 v9, 1
  s_mov_b64 exec, 1
  buffer_atomic_add v9, v8, s[72:75], s21 offen sc1
  s_mov_b64 exec, -1
  s_nop 1
af_258:
  s_barrier
  s_sub_u32 s2, s3, 96
  s_mov_b32 s40, 0
  s_mov_b32 s41, 13
q_entry:
  s_load_dwordx2 s[4:5], s[0:1], 0
  s_load_dwordx2 s[6:7], s[0:1], 16
  s_load_dwordx2 s[38:39], s[0:1], 104
  s_mov_b32 s42, s2
  s_waitcnt lgkmcnt(0)
  s_mov_b32 s8, s4
  s_mov_b32 s9, s5
  s_mov_b32 s10, 2621440
  s_mov_b32 s11, 0x00020000
  s_mov_b32 s12, s6
  s_mov_b32 s13, s7
  s_mov_b32 s14, 7864320
  s_mov_b32 s15, 0x00020000
  s_mov_b32 s16, s38
  s_mov_b32 s17, s39
  s_mov_b32 s18, 218103808
  s_mov_b32 s19, 0x00020000
  s_add_u32 s72, s38, 173080576
  s_addc_u32 s73, s39, 0
  s_mov_b32 s74, 49152
  s_mov_b32 s75, 0x00020000
  s_mul_i32 s44, s42, 384
  s_cmp_lg_u32 s40, 0
  s_cbranch_scc1 qg_259
  s_load_dwordx2 s[36:37], s[0:1], 80
  s_waitcnt lgkmcnt(0)
  s_mov_b32 s24, s36
  s_mov_b32 s25, s37
  s_mov_b32 s26, 1280
  s_mov_b32 s27, 0x00020000
  s_add_u32 s76, s38, 175112192
  s_addc_u32 s77, s39, 0
  s_mov_b32 s78, 8192
  s_mov_b32 s79, 0x00020000
  s_lshl_b32 s59, s2, 2
  s_add_u32 s59, s59, s20
  s_lshl_b32 s59, s59, 4
  v_lshlrev_b32 v10, 2, v1
  v_lshlrev_b32 v11, 4, v1
  s_mul_i32 s22, s59, 1280
  buffer_load_dwordx4 v[12:15], v11, s[24:27], 0 offen
  buffer_load_dword v16, v10, s[24:27], 0 offen offset:1024
  buffer_load_dwordx4 v[192:195], v11, s[8:11], s22 offen
  buffer_load_dword v48, v10, s[8:11], s22 offen offset:1024
  s_add_u32 s22, s22, 1280
  buffer_load_dwordx4 v[196:199], v11, s[8:11], s22 offen
  buffer_load_dword v49, v10, s[8:11], s22 offen offset:1024
  s_add_u32 s22, s22, 1280
  buffer_load_dwordx4 v[200:203], v11, s[8:11], s22 offen
  buffer_load_dword v50, v10, s[8:11], s22 offen offset:1024
  s_add_u32 s22, s22, 1280
  buffer_load_dwordx4 v[204:207], v11, s[8:11], s22 offen
  buffer_load_dword v51, v10, s[8:11], s22 offen offset:1024
  s_add_u32 s22, s22, 1280
  buffer_load_dwordx4 v[208:211], v11, s[8:11], s22 offen
  buffer_load_dword v52, v10, s[8:11], s22 offen offset:1024
  s_add_u32 s22, s22, 1280
  buffer_load_dwordx4 v[212:215], v11, s[8:11], s22 offen
  buffer_load_dword v53, v10, s[8:11], s22 offen offset:1024
  s_add_u32 s22, s22, 1280
  buffer_load_dwordx4 v[216:219], v11, s[8:11], s22 offen
  buffer_load_dword v54, v10, s[8:11], s22 offen offset:1024
  s_add_u32 s22, s22, 1280
  buffer_load_dwordx4 v[220:223], v11, s[8:11], s22 offen
  buffer_load_dword v55, v10, s[8:11], s22 offen offset:1024
  s_add_u32 s22, s22, 1280
  buffer_load_dwordx4 v[224:227], v11, s[8:11], s22 offen
  buffer_load_dword v56, v10, s[8:11], s22 offen offset:1024
  s_add_u32 s22, s22, 1280
  buffer_load_dwordx4 v[228:231], v11, s[8:11], s22 offen
  buffer_load_dword v57, v10, s[8:11], s22 offen offset:1024
  s_add_u32 s22, s22, 1280
  buffer_load_dwordx4 v[232:235], v11, s[8:11], s22 offen
  buffer_load_dword v58, v10, s[8:11], s22 offen offset:1024
  s_add_u32 s22, s22, 1280
  buffer_load_dwordx4 v[236:239], v11, s[8:11], s22 offen
  buffer_load_dword v59, v10, s[8:11], s22 offen offset:1024
  s_add_u32 s22, s22, 1280
  buffer_load_dwordx4 v[240:243], v11, s[8:11], s22 offen
  buffer_load_dword v60, v10, s[8:11], s22 offen offset:1024
  s_add_u32 s22, s22, 1280
  buffer_load_dwordx4 v[244:247], v11, s[8:11], s22 offen
  buffer_load_dword v61, v10, s[8:11], s22 offen offset:1024
  s_add_u32 s22, s22, 1280
  buffer_load_dwordx4 v[248:251], v11, s[8:11], s22 offen
  buffer_load_dword v62, v10, s[8:11], s22 offen offset:1024
  s_add_u32 s22, s22, 1280
  buffer_load_dwordx4 v[252:255], v11, s[8:11], s22 offen
  buffer_load_dword v63, v10, s[8:11], s22 offen offset:1024
  s_add_u32 s22, s22, 1280
  s_load_dwordx2 s[36:37], s[0:1], 72
  s_mul_i32 s22, s59, 400
  s_waitcnt lgkmcnt(0)
  s_mov_b32 s28, s36
  s_mov_b32 s29, s37
  s_mov_b32 s30, 819200
  s_mov_b32 s31, 0x00020000
  buffer_load_dwordx4 v[184:187], v11, s[28:31], s22 offen offset:0
  buffer_load_dwordx4 v[184:187], v11, s[28:31], s22 offen offset:1024
  buffer_load_dwordx4 v[184:187], v11, s[28:31], s22 offen offset:2048
  buffer_load_dwordx4 v[184:187], v11, s[28:31], s22 offen offset:3072
  s_add_u32 s22, s22, 4096
  buffer_load_dwordx4 v[184:187], v11, s[28:31], s22 offen offset:0
  buffer_load_dwordx4 v[184:187], v11, s[28:31], s22 offen offset:1024
  buffer_load_dwordx4 v[184:187], v11, s[28:31], s22 offen offset:2048
qg_259:
  s_waitcnt vmcnt(30)
  v_mov_b32 v9, 2731
  v_add_u32 v8, 0, v1
  v_mul_u32_u24 v7, v8, v9
  v_lshrrev_b32 v7, 16, v7
  v_mul_u32_u24 v4, 24, v7
  v_sub_u32 v8, v8, v4
  s_mov_b32 s21, 12288
  v_mul_lo_u32 v7, v7, s21
  v_lshl_add_u32 v4, v8, 4, v7
  v_add_u32 v8, 64, v1
  v_mul_u32_u24 v7, v8, v9
  v_lshrrev_b32 v7, 16, v7
  v_mul_u32_u24 v5, 24, v7
  v_sub_u32 v8, v8, v5
  s_mov_b32 s21, 12288
  v_mul_lo_u32 v7, v7, s21
  v_lshl_add_u32 v5, v8, 4, v7
  v_add_u32 v8, 128, v1
  v_mul_u32_u24 v7, v8, v9
  v_lshrrev_b32 v7, 16, v7
  v_mul_u32_u24 v6, 24, v7
  v_sub_u32 v8, v8, v6
  s_mov_b32 s21, 12288
  v_mul_lo_u32 v7, v7, s21
  v_lshl_add_u32 v6, v8, 4, v7
  v_lshrrev_b32 v7, 2, v2
  v_lshl_add_u32 v7, v3, 3, v7
  v_mul_u32_u24 v7, 384, v7
  v_and_b32 v8, 3, v2
  v_lshlrev_b32 v8, 3, v8
  s_mul_i32 s21, s20, 96
  v_add3_u32 v7, v7, v8, s21
  v_add_u32 v8, 61440, v7
  s_mul_i32 s21, s20, 491520
  s_add_u32 s21, s21, 0
  s_add_u32 s21, s21, s44
  s_mul_i32 s22, s20, 15360
  s_add_u32 s22, s22, 0
  s_add_u32 m0, s22, 0
  s_nop 0
  buffer_load_dwordx4 v4, s[12:15], s21 offen lds
  s_add_u32 m0, s22, 1024
  s_nop 0
  buffer_load_dwordx4 v5, s[12:15], s21 offen lds
  s_add_u32 m0, s22, 2048
  s_nop 0
  buffer_load_dwordx4 v6, s[12:15], s21 offen lds
  s_mul_i32 s21, s20, 491520
  s_add_u32 s21, s21, 98304
  s_add_u32 s21, s21, s44
  s_mul_i32 s22, s20, 15360
  s_add_u32 s22, s22, 3072
  s_add_u32 m0, s22, 0
  s_nop 0
  buffer_load_dwordx4 v4, s[12:15], s21 offen lds
  s_add_u32 m0, s22, 1024
  s_nop 0
  buffer_load_dwordx4 v5, s[12:15], s21 offen lds
  s_add_u32 m0, s22, 2048
  s_nop 0
  buffer_load_dwordx4 v6, s[12:15], s21 offen lds
  s_mul_i32 s21, s20, 491520
  s_add_u32 s21, s21, 196608
  s_add_u32 s21, s21, s44
  s_mul_i32 s22, s20, 15360
  s_add_u32 s22, s22, 6144
  s_add_u32 m0, s22, 0
  s_nop 0
  buffer_load_dwordx4 v4, s[12:15], s21 offen lds
  s_add_u32 m0, s22, 1024
  s_nop 0
  buffer_load_dwordx4 v5, s[12:15], s21 offen lds
  s_add_u32 m0, s22, 2048
  s_nop 0
  buffer_load_dwordx4 v6, s[12:15], s21 offen lds
  s_mul_i32 s21, s20, 491520
  s_add_u32 s21, s21, 294912
  s_add_u32 s21, s21, s44
  s_mul_i32 s22, s20, 15360
  s_add_u32 s22, s22, 9216
  s_add_u32 m0, s22, 0
  s_nop 0
  buffer_load_dwordx4 v4, s[12:15], s21 offen lds
  s_add_u32 m0, s22, 1024
  s_nop 0
  buffer_load_dwordx4 v5, s[12:15], s21 offen lds
  s_add_u32 m0, s22, 2048
  s_nop 0
  buffer_load_dwordx4 v6, s[12:15], s21 offen lds
  s_mul_i32 s21, s20, 491520
  s_add_u32 s21, s21, 393216
  s_add_u32 s21, s21, s44
  s_mul_i32 s22, s20, 15360
  s_add_u32 s22, s22, 12288
  s_add_u32 m0, s22, 0
  s_nop 0
  buffer_load_dwordx4 v4, s[12:15], s21 offen lds
  s_add_u32 m0, s22, 1024
  s_nop 0
  buffer_load_dwordx4 v5, s[12:15], s21 offen lds
  s_add_u32 m0, s22, 2048
  s_nop 0
  buffer_load_dwordx4 v6, s[12:15], s21 offen lds
  s_mul_i32 s21, s20, 491520
  s_add_u32 s21, s21, 1966080
  s_add_u32 s21, s21, s44
  s_mul_i32 s22, s20, 15360
  s_add_u32 s22, s22, 61440
  s_add_u32 m0, s22, 0
  s_nop 0
  buffer_load_dwordx4 v4, s[12:15], s21 offen lds
  s_add_u32 m0, s22, 1024
  s_nop 0
  buffer_load_dwordx4 v5, s[12:15], s21 offen lds
  s_add_u32 m0, s22, 2048
  s_nop 0
  buffer_load_dwordx4 v6, s[12:15], s21 offen lds
  s_mul_i32 s21, s20, 491520
  s_add_u32 s21, s21, 2064384
  s_add_u32 s21, s21, s44
  s_mul_i32 s22, s20, 15360
  s_add_u32 s22, s22, 64512
  s_add_u32 m0, s22, 0
  s_nop 0
  buffer_load_dwordx4 v4, s[12:15], s21 offen lds
  s_add_u32 m0, s22, 1024
  s_nop 0
  buffer_load_dwordx4 v5, s[12:15], s21 offen lds
  s_add_u32 m0, s22, 2048
  s_nop 0
  buffer_load_dwordx4 v6, s[12:15], s21 offen lds
  s_mul_i32 s21, s20, 491520
  s_add_u32 s21, s21, 2162688
  s_add_u32 s21, s21, s44
  s_mul_i32 s22, s20, 15360
  s_add_u32 s22, s22, 67584
  s_add_u32 m0, s22, 0
  s_nop 0
  buffer_load_dwordx4 v4, s[12:15], s21 offen lds
  s_add_u32 m0, s22, 1024
  s_nop 0
  buffer_load_dwordx4 v5, s[12:15], s21 offen lds
  s_add_u32 m0, s22, 2048
  s_nop 0
  buffer_load_dwordx4 v6, s[12:15], s21 offen lds
  s_mul_i32 s21, s20, 491520
  s_add_u32 s21, s21, 2260992
  s_add_u32 s21, s21, s44
  s_mul_i32 s22, s20, 15360
  s_add_u32 s22, s22, 70656
  s_add_u32 m0, s22, 0
  s_nop 0
  buffer_load_dwordx4 v4, s[12:15], s21 offen lds
  s_add_u32 m0, s22, 1024
  s_nop 0
  buffer_load_dwordx4 v5, s[12:15], s21 offen lds
  s_add_u32 m0, s22, 2048
  s_nop 0
  buffer_load_dwordx4 v6, s[12:15], s21 offen lds
  s_mul_i32 s21, s20, 491520
  s_add_u32 s21, s21, 2359296
  s_add_u32 s21, s21, s44
  s_mul_i32 s22, s20, 15360
  s_add_u32 s22, s22, 73728
  s_add_u32 m0, s22, 0
  s_nop 0
  buffer_load_dwordx4 v4, s[12:15], s21 offen lds
  s_add_u32 m0, s22, 1024
  s_nop 0
  buffer_load_dwordx4 v5, s[12:15], s21 offen lds
  s_add_u32 m0, s22, 2048
  s_nop 0
  buffer_load_dwordx4 v6, s[12:15], s21 offen lds
  s_waitcnt vmcnt(30)
  s_mul_i32 s21, s20, 491520
  s_add_u32 s21, s21, 3932160
  s_add_u32 s21, s21, s44
  buffer_load_dwordx4 v[64:67], v4, s[12:15], s21 offen
  buffer_load_dwordx4 v[68:71], v5, s[12:15], s21 offen
  buffer_load_dwordx4 v[72:75], v6, s[12:15], s21 offen
  s_mul_i32 s21, s20, 491520
  s_add_u32 s21, s21, 4030464
  s_add_u32 s21, s21, s44
  buffer_load_dwordx4 v[76:79], v4, s[12:15], s21 offen
  buffer_load_dwordx4 v[80:83], v5, s[12:15], s21 offen
  buffer_load_dwordx4 v[84:87], v6, s[12:15], s21 offen
  s_mul_i32 s21, s20, 491520
  s_add_u32 s21, s21, 4128768
  s_add_u32 s21, s21, s44
  buffer_load_dwordx4 v[88:91], v4, s[12:15], s21 offen
  buffer_load_dwordx4 v[92:95], v5, s[12:15], s21 offen
  buffer_load_dwordx4 v[96:99], v6, s[12:15], s21 offen
  s_mul_i32 s21, s20, 491520
  s_add_u32 s21, s21, 4227072
  s_add_u32 s21, s21, s44
  buffer_load_dwordx4 v[100:103], v4, s[12:15], s21 offen
  buffer_load_dwordx4 v[104:107], v5, s[12:15], s21 offen
  buffer_load_dwordx4 v[108:111], v6, s[12:15], s21 offen
  s_mul_i32 s21, s20, 491520
  s_add_u32 s21, s21, 4325376
  s_add_u32 s21, s21, s44
  buffer_load_dwordx4 v[112:115], v4, s[12:15], s21 offen
  buffer_load_dwordx4 v[116:119], v5, s[12:15], s21 offen
  buffer_load_dwordx4 v[120:123], v6, s[12:15], s21 offen
  s_mul_i32 s21, s20, 491520
  s_add_u32 s21, s21, 5898240
  s_add_u32 s21, s21, s44
  buffer_load_dwordx4 v[124:127], v4, s[12:15], s21 offen
  buffer_load_dwordx4 v[128:131], v5, s[12:15], s21 offen
  buffer_load_dwordx4 v[132:135], v6, s[12:15], s21 offen
  s_mul_i32 s21, s20, 491520
  s_add_u32 s21, s21, 5996544
  s_add_u32 s21, s21, s44
  buffer_load_dwordx4 v[136:139], v4, s[12:15], s21 offen
  buffer_load_dwordx4 v[140:143], v5, s[12:15], s21 offen
  buffer_load_dwordx4 v[144:147], v6, s[12:15], s21 offen
  s_mul_i32 s21, s20, 491520
  s_add_u32 s21, s21, 6094848
  s_add_u32 s21, s21, s44
  buffer_load_dwordx4 v[148:151], v4, s[12:15], s21 offen
  buffer_load_dwordx4 v[152:155], v5, s[12:15], s21 offen
  buffer_load_dwordx4 v[156:159], v6, s[12:15], s21 offen
  s_mul_i32 s21, s20, 491520
  s_add_u32 s21, s21, 6193152
  s_add_u32 s21, s21, s44
  buffer_load_dwordx4 v[160:163], v4, s[12:15], s21 offen
  buffer_load_dwordx4 v[164:167], v5, s[12:15], s21 offen
  buffer_load_dwordx4 v[168:171], v6, s[12:15], s21 offen
  s_mul_i32 s21, s20, 491520
  s_add_u32 s21, s21, 6291456
  s_add_u32 s21, s21, s44
  buffer_load_dwordx4 v[172:175], v4, s[12:15], s21 offen
  buffer_load_dwordx4 v[176:179], v5, s[12:15], s21 offen
  buffer_load_dwordx4 v[180:183], v6, s[12:15], s21 offen
  s_mul_i32 s22, s20, 15360
  v_lshl_add_u32 v30, v1, 4, s22
  v_add_u32 v31, 61440, v30
  s_cmp_lg_u32 s40, 0
  s_cbranch_scc1 qg_260
  v_lshlrev_b32 v17, 16, v12
  v_and_b32 v12, 0xffff0000, v12
  v_lshlrev_b32 v18, 16, v13
  v_and_b32 v13, 0xffff0000, v13
  v_lshlrev_b32 v19, 16, v14
  v_and_b32 v14, 0xffff0000, v14
  v_lshlrev_b32 v20, 16, v15
  v_and_b32 v15, 0xffff0000, v15
  v_lshlrev_b32 v21, 16, v16
  v_and_b32 v16, 0xffff0000, v16
  v_mov_b32 v32, 0
  v_lshlrev_b32 v25, 16, v192
  v_and_b32 v26, 0xffff0000, v192
  v_mul_f32 v25, v25, v17
  v_mul_f32 v26, v26, v12
  v_cvt_pk_bf16_f32 v25, v25, v26
  v_lshlrev_b32 v26, 16, v25
  v_and_b32 v25, 0xffff0000, v25
  v_add_f32 v32, v32, v26
  v_add_f32 v32, v32, v25
  v_lshlrev_b32 v25, 16, v193
  v_and_b32 v26, 0xffff0000, v193
  v_mul_f32 v25, v25, v18
  v_mul_f32 v26, v26, v13
  v_cvt_pk_bf16_f32 v25, v25, v26
  v_lshlrev_b32 v26, 16, v25
  v_and_b32 v25, 0xffff0000, v25
  v_add_f32 v32, v32, v26
  v_add_f32 v32, v32, v25
  v_lshlrev_b32 v25, 16, v194
  v_and_b32 v26, 0xffff0000, v194
  v_mul_f32 v25, v25, v19
  v_mul_f32 v26, v26, v14
  v_cvt_pk_bf16_f32 v25, v25, v26
  v_lshlrev_b32 v26, 16, v25
  v_and_b32 v25, 0xffff0000, v25
  v_add_f32 v32, v32, v26
  v_add_f32 v32, v32, v25
  v_lshlrev_b32 v25, 16, v195
  v_and_b32 v26, 0xffff0000, v195
  v_mul_f32 v25, v25, v20
  v_mul_f32 v26, v26, v15
  v_cvt_pk_bf16_f32 v25, v25, v26
  v_lshlrev_b32 v26, 16, v25
  v_and_b32 v25, 0xffff0000, v25
  v_add_f32 v32, v32, v26
  v_add_f32 v32, v32, v25
  v_lshlrev_b32 v25, 16, v48
  v_and_b32 v26, 0xffff0000, v48
  v_mul_f32 v25, v25, v21
  v_mul_f32 v26, v26, v16
  v_cvt_pk_bf16_f32 v25, v25, v26
  v_lshlrev_b32 v26, 16, v25
  v_and_b32 v25, 0xffff0000, v25
  v_add_f32 v32, v32, v26
  v_add_f32 v32, v32, v25
  v_mov_b32 v33, 0
  v_lshlrev_b32 v25, 16, v196
  v_and_b32 v26, 0xffff0000, v196
  v_mul_f32 v25, v25, v17
  v_mul_f32 v26, v26, v12
  v_cvt_pk_bf16_f32 v25, v25, v26
  v_lshlrev_b32 v26, 16, v25
  v_and_b32 v25, 0xffff0000, v25
  v_add_f32 v33, v33, v26
  v_add_f32 v33, v33, v25
  v_lshlrev_b32 v25, 16, v197
  v_and_b32 v26, 0xffff0000, v197
  v_mul_f32 v25, v25, v18
  v_mul_f32 v26, v26, v13
  v_cvt_pk_bf16_f32 v25, v25, v26
  v_lshlrev_b32 v26, 16, v25
  v_and_b32 v25, 0xffff0000, v25
  v_add_f32 v33, v33, v26
  v_add_f32 v33, v33, v25
  v_lshlrev_b32 v25, 16, v198
  v_and_b32 v26, 0xffff0000, v198
  v_mul_f32 v25, v25, v19
  v_mul_f32 v26, v26, v14
  v_cvt_pk_bf16_f32 v25, v25, v26
  v_lshlrev_b32 v26, 16, v25
  v_and_b32 v25, 0xffff0000, v25
  v_add_f32 v33, v33, v26
  v_add_f32 v33, v33, v25
  v_lshlrev_b32 v25, 16, v199
  v_and_b32 v26, 0xffff0000, v199
  v_mul_f32 v25, v25, v20
  v_mul_f32 v26, v26, v15
  v_cvt_pk_bf16_f32 v25, v25, v26
  v_lshlrev_b32 v26, 16, v25
  v_and_b32 v25, 0xffff0000, v25
  v_add_f32 v33, v33, v26
  v_add_f32 v33, v33, v25
  v_lshlrev_b32 v25, 16, v49
  v_and_b32 v26, 0xffff0000, v49
  v_mul_f32 v25, v25, v21
  v_mul_f32 v26, v26, v16
  v_cvt_pk_bf16_f32 v25, v25, v26
  v_lshlrev_b32 v26, 16, v25
  v_and_b32 v25, 0xffff0000, v25
  v_add_f32 v33, v33, v26
  v_add_f32 v33, v33, v25
  v_mov_b32 v34, 0
  v_lshlrev_b32 v25, 16, v200
  v_and_b32 v26, 0xffff0000, v200
  v_mul_f32 v25, v25, v17
  v_mul_f32 v26, v26, v12
  v_cvt_pk_bf16_f32 v25, v25, v26
  v_lshlrev_b32 v26, 16, v25
  v_and_b32 v25, 0xffff0000, v25
  v_add_f32 v34, v34, v26
  v_add_f32 v34, v34, v25
  v_lshlrev_b32 v25, 16, v201
  v_and_b32 v26, 0xffff0000, v201
  v_mul_f32 v25, v25, v18
  v_mul_f32 v26, v26, v13
  v_cvt_pk_bf16_f32 v25, v25, v26
  v_lshlrev_b32 v26, 16, v25
  v_and_b32 v25, 0xffff0000, v25
  v_add_f32 v34, v34, v26
  v_add_f32 v34, v34, v25
  v_lshlrev_b32 v25, 16, v202
  v_and_b32 v26, 0xffff0000, v202
  v_mul_f32 v25, v25, v19
  v_mul_f32 v26, v26, v14
  v_cvt_pk_bf16_f32 v25, v25, v26
  v_lshlrev_b32 v26, 16, v25
  v_and_b32 v25, 0xffff0000, v25
  v_add_f32 v34, v34, v26
  v_add_f32 v34, v34, v25
  v_lshlrev_b32 v25, 16, v203
  v_and_b32 v26, 0xffff0000, v203
  v_mul_f32 v25, v25, v20
  v_mul_f32 v26, v26, v15
  v_cvt_pk_bf16_f32 v25, v25, v26
  v_lshlrev_b32 v26, 16, v25
  v_and_b32 v25, 0xffff0000, v25
  v_add_f32 v34, v34, v26
  v_add_f32 v34, v34, v25
  v_lshlrev_b32 v25, 16, v50
  v_and_b32 v26, 0xffff0000, v50
  v_mul_f32 v25, v25, v21
  v_mul_f32 v26, v26, v16
  v_cvt_pk_bf16_f32 v25, v25, v26
  v_lshlrev_b32 v26, 16, v25
  v_and_b32 v25, 0xffff0000, v25
  v_add_f32 v34, v34, v26
  v_add_f32 v34, v34, v25
  v_mov_b32 v35, 0
  v_lshlrev_b32 v25, 16, v204
  v_and_b32 v26, 0xffff0000, v204
  v_mul_f32 v25, v25, v17
  v_mul_f32 v26, v26, v12
  v_cvt_pk_bf16_f32 v25, v25, v26
  v_lshlrev_b32 v26, 16, v25
  v_and_b32 v25, 0xffff0000, v25
  v_add_f32 v35, v35, v26
  v_add_f32 v35, v35, v25
  v_lshlrev_b32 v25, 16, v205
  v_and_b32 v26, 0xffff0000, v205
  v_mul_f32 v25, v25, v18
  v_mul_f32 v26, v26, v13
  v_cvt_pk_bf16_f32 v25, v25, v26
  v_lshlrev_b32 v26, 16, v25
  v_and_b32 v25, 0xffff0000, v25
  v_add_f32 v35, v35, v26
  v_add_f32 v35, v35, v25
  v_lshlrev_b32 v25, 16, v206
  v_and_b32 v26, 0xffff0000, v206
  v_mul_f32 v25, v25, v19
  v_mul_f32 v26, v26, v14
  v_cvt_pk_bf16_f32 v25, v25, v26
  v_lshlrev_b32 v26, 16, v25
  v_and_b32 v25, 0xffff0000, v25
  v_add_f32 v35, v35, v26
  v_add_f32 v35, v35, v25
  v_lshlrev_b32 v25, 16, v207
  v_and_b32 v26, 0xffff0000, v207
  v_mul_f32 v25, v25, v20
  v_mul_f32 v26, v26, v15
  v_cvt_pk_bf16_f32 v25, v25, v26
  v_lshlrev_b32 v26, 16, v25
  v_and_b32 v25, 0xffff0000, v25
  v_add_f32 v35, v35, v26
  v_add_f32 v35, v35, v25
  v_lshlrev_b32 v25, 16, v51
  v_and_b32 v26, 0xffff0000, v51
  v_mul_f32 v25, v25, v21
  v_mul_f32 v26, v26, v16
  v_cvt_pk_bf16_f32 v25, v25, v26
  v_lshlrev_b32 v26, 16, v25
  v_and_b32 v25, 0xffff0000, v25
  v_add_f32 v35, v35, v26
  v_add_f32 v35, v35, v25
  v_mov_b32 v36, 0
  v_lshlrev_b32 v25, 16, v208
  v_and_b32 v26, 0xffff0000, v208
  v_mul_f32 v25, v25, v17
  v_mul_f32 v26, v26, v12
  v_cvt_pk_bf16_f32 v25, v25, v26
  v_lshlrev_b32 v26, 16, v25
  v_and_b32 v25, 0xffff0000, v25
  v_add_f32 v36, v36, v26
  v_add_f32 v36, v36, v25
  v_lshlrev_b32 v25, 16, v209
  v_and_b32 v26, 0xffff0000, v209
  v_mul_f32 v25, v25, v18
  v_mul_f32 v26, v26, v13
  v_cvt_pk_bf16_f32 v25, v25, v26
  v_lshlrev_b32 v26, 16, v25
  v_and_b32 v25, 0xffff0000, v25
  v_add_f32 v36, v36, v26
  v_add_f32 v36, v36, v25
  v_lshlrev_b32 v25, 16, v210
  v_and_b32 v26, 0xffff0000, v210
  v_mul_f32 v25, v25, v19
  v_mul_f32 v26, v26, v14
  v_cvt_pk_bf16_f32 v25, v25, v26
  v_lshlrev_b32 v26, 16, v25
  v_and_b32 v25, 0xffff0000, v25
  v_add_f32 v36, v36, v26
  v_add_f32 v36, v36, v25
  v_lshlrev_b32 v25, 16, v211
  v_and_b32 v26, 0xffff0000, v211
  v_mul_f32 v25, v25, v20
  v_mul_f32 v26, v26, v15
  v_cvt_pk_bf16_f32 v25, v25, v26
  v_lshlrev_b32 v26, 16, v25
  v_and_b32 v25, 0xffff0000, v25
  v_add_f32 v36, v36, v26
  v_add_f32 v36, v36, v25
  v_lshlrev_b32 v25, 16, v52
  v_and_b32 v26, 0xffff0000, v52
  v_mul_f32 v25, v25, v21
  v_mul_f32 v26, v26, v16
  v_cvt_pk_bf16_f32 v25, v25, v26
  v_lshlrev_b32 v26, 16, v25
  v_and_b32 v25, 0xffff0000, v25
  v_add_f32 v36, v36, v26
  v_add_f32 v36, v36, v25
  v_mov_b32 v37, 0
  v_lshlrev_b32 v25, 16, v212
  v_and_b32 v26, 0xffff0000, v212
  v_mul_f32 v25, v25, v17
  v_mul_f32 v26, v26, v12
  v_cvt_pk_bf16_f32 v25, v25, v26
  v_lshlrev_b32 v26, 16, v25
  v_and_b32 v25, 0xffff0000, v25
  v_add_f32 v37, v37, v26
  v_add_f32 v37, v37, v25
  v_lshlrev_b32 v25, 16, v213
  v_and_b32 v26, 0xffff0000, v213
  v_mul_f32 v25, v25, v18
  v_mul_f32 v26, v26, v13
  v_cvt_pk_bf16_f32 v25, v25, v26
  v_lshlrev_b32 v26, 16, v25
  v_and_b32 v25, 0xffff0000, v25
  v_add_f32 v37, v37, v26
  v_add_f32 v37, v37, v25
  v_lshlrev_b32 v25, 16, v214
  v_and_b32 v26, 0xffff0000, v214
  v_mul_f32 v25, v25, v19
  v_mul_f32 v26, v26, v14
  v_cvt_pk_bf16_f32 v25, v25, v26
  v_lshlrev_b32 v26, 16, v25
  v_and_b32 v25, 0xffff0000, v25
  v_add_f32 v37, v37, v26
  v_add_f32 v37, v37, v25
  v_lshlrev_b32 v25, 16, v215
  v_and_b32 v26, 0xffff0000, v215
  v_mul_f32 v25, v25, v20
  v_mul_f32 v26, v26, v15
  v_cvt_pk_bf16_f32 v25, v25, v26
  v_lshlrev_b32 v26, 16, v25
  v_and_b32 v25, 0xffff0000, v25
  v_add_f32 v37, v37, v26
  v_add_f32 v37, v37, v25
  v_lshlrev_b32 v25, 16, v53
  v_and_b32 v26, 0xffff0000, v53
  v_mul_f32 v25, v25, v21
  v_mul_f32 v26, v26, v16
  v_cvt_pk_bf16_f32 v25, v25, v26
  v_lshlrev_b32 v26, 16, v25
  v_and_b32 v25, 0xffff0000, v25
  v_add_f32 v37, v37, v26
  v_add_f32 v37, v37, v25
  v_mov_b32 v38, 0
  v_lshlrev_b32 v25, 16, v216
  v_and_b32 v26, 0xffff0000, v216
  v_mul_f32 v25, v25, v17
  v_mul_f32 v26, v26, v12
  v_cvt_pk_bf16_f32 v25, v25, v26
  v_lshlrev_b32 v26, 16, v25
  v_and_b32 v25, 0xffff0000, v25
  v_add_f32 v38, v38, v26
  v_add_f32 v38, v38, v25
  v_lshlrev_b32 v25, 16, v217
  v_and_b32 v26, 0xffff0000, v217
  v_mul_f32 v25, v25, v18
  v_mul_f32 v26, v26, v13
  v_cvt_pk_bf16_f32 v25, v25, v26
  v_lshlrev_b32 v26, 16, v25
  v_and_b32 v25, 0xffff0000, v25
  v_add_f32 v38, v38, v26
  v_add_f32 v38, v38, v25
  v_lshlrev_b32 v25, 16, v218
  v_and_b32 v26, 0xffff0000, v218
  v_mul_f32 v25, v25, v19
  v_mul_f32 v26, v26, v14
  v_cvt_pk_bf16_f32 v25, v25, v26
  v_lshlrev_b32 v26, 16, v25
  v_and_b32 v25, 0xffff0000, v25
  v_add_f32 v38, v38, v26
  v_add_f32 v38, v38, v25
  v_lshlrev_b32 v25, 16, v219
  v_and_b32 v26, 0xffff0000, v219
  v_mul_f32 v25, v25, v20
  v_mul_f32 v26, v26, v15
  v_cvt_pk_bf16_f32 v25, v25, v26
  v_lshlrev_b32 v26, 16, v25
  v_and_b32 v25, 0xffff0000, v25
  v_add_f32 v38, v38, v26
  v_add_f32 v38, v38, v25
  v_lshlrev_b32 v25, 16, v54
  v_and_b32 v26, 0xffff0000, v54
  v_mul_f32 v25, v25, v21
  v_mul_f32 v26, v26, v16
  v_cvt_pk_bf16_f32 v25, v25, v26
  v_lshlrev_b32 v26, 16, v25
  v_and_b32 v25, 0xffff0000, v25
  v_add_f32 v38, v38, v26
  v_add_f32 v38, v38, v25
  v_mov_b32 v39, 0
  v_lshlrev_b32 v25, 16, v220
  v_and_b32 v26, 0xffff0000, v220
  v_mul_f32 v25, v25, v17
  v_mul_f32 v26, v26, v12
  v_cvt_pk_bf16_f32 v25, v25, v26
  v_lshlrev_b32 v26, 16, v25
  v_and_b32 v25, 0xffff0000, v25
  v_add_f32 v39, v39, v26
  v_add_f32 v39, v39, v25
  v_lshlrev_b32 v25, 16, v221
  v_and_b32 v26, 0xffff0000, v221
  v_mul_f32 v25, v25, v18
  v_mul_f32 v26, v26, v13
  v_cvt_pk_bf16_f32 v25, v25, v26
  v_lshlrev_b32 v26, 16, v25
  v_and_b32 v25, 0xffff0000, v25
  v_add_f32 v39, v39, v26
  v_add_f32 v39, v39, v25
  v_lshlrev_b32 v25, 16, v222
  v_and_b32 v26, 0xffff0000, v222
  v_mul_f32 v25, v25, v19
  v_mul_f32 v26, v26, v14
  v_cvt_pk_bf16_f32 v25, v25, v26
  v_lshlrev_b32 v26, 16, v25
  v_and_b32 v25, 0xffff0000, v25
  v_add_f32 v39, v39, v26
  v_add_f32 v39, v39, v25
  v_lshlrev_b32 v25, 16, v223
  v_and_b32 v26, 0xffff0000, v223
  v_mul_f32 v25, v25, v20
  v_mul_f32 v26, v26, v15
  v_cvt_pk_bf16_f32 v25, v25, v26
  v_lshlrev_b32 v26, 16, v25
  v_and_b32 v25, 0xffff0000, v25
  v_add_f32 v39, v39, v26
  v_add_f32 v39, v39, v25
  v_lshlrev_b32 v25, 16, v55
  v_and_b32 v26, 0xffff0000, v55
  v_mul_f32 v25, v25, v21
  v_mul_f32 v26, v26, v16
  v_cvt_pk_bf16_f32 v25, v25, v26
  v_lshlrev_b32 v26, 16, v25
  v_and_b32 v25, 0xffff0000, v25
  v_add_f32 v39, v39, v26
  v_add_f32 v39, v39, v25
  v_mov_b32 v40, 0
  v_lshlrev_b32 v25, 16, v224
  v_and_b32 v26, 0xffff0000, v224
  v_mul_f32 v25, v25, v17
  v_mul_f32 v26, v26, v12
  v_cvt_pk_bf16_f32 v25, v25, v26
  v_lshlrev_b32 v26, 16, v25
  v_and_b32 v25, 0xffff0000, v25
  v_add_f32 v40, v40, v26
  v_add_f32 v40, v40, v25
  v_lshlrev_b32 v25, 16, v225
  v_and_b32 v26, 0xffff0000, v225
  v_mul_f32 v25, v25, v18
  v_mul_f32 v26, v26, v13
  v_cvt_pk_bf16_f32 v25, v25, v26
  v_lshlrev_b32 v26, 16, v25
  v_and_b32 v25, 0xffff0000, v25
  v_add_f32 v40, v40, v26
  v_add_f32 v40, v40, v25
  v_lshlrev_b32 v25, 16, v226
  v_and_b32 v26, 0xffff0000, v226
  v_mul_f32 v25, v25, v19
  v_mul_f32 v26, v26, v14
  v_cvt_pk_bf16_f32 v25, v25, v26
  v_lshlrev_b32 v26, 16, v25
  v_and_b32 v25, 0xffff0000, v25
  v_add_f32 v40, v40, v26
  v_add_f32 v40, v40, v25
  v_lshlrev_b32 v25, 16, v227
  v_and_b32 v26, 0xffff0000, v227
  v_mul_f32 v25, v25, v20
  v_mul_f32 v26, v26, v15
  v_cvt_pk_bf16_f32 v25, v25, v26
  v_lshlrev_b32 v26, 16, v25
  v_and_b32 v25, 0xffff0000, v25
  v_add_f32 v40, v40, v26
  v_add_f32 v40, v40, v25
  v_lshlrev_b32 v25, 16, v56
  v_and_b32 v26, 0xffff0000, v56
  v_mul_f32 v25, v25, v21
  v_mul_f32 v26, v26, v16
  v_cvt_pk_bf16_f32 v25, v25, v26
  v_lshlrev_b32 v26, 16, v25
  v_and_b32 v25, 0xffff0000, v25
  v_add_f32 v40, v40, v26
  v_add_f32 v40, v40, v25
  v_mov_b32 v41, 0
  v_lshlrev_b32 v25, 16, v228
  v_and_b32 v26, 0xffff0000, v228
  v_mul_f32 v25, v25, v17
  v_mul_f32 v26, v26, v12
  v_cvt_pk_bf16_f32 v25, v25, v26
  v_lshlrev_b32 v26, 16, v25
  v_and_b32 v25, 0xffff0000, v25
  v_add_f32 v41, v41, v26
  v_add_f32 v41, v41, v25
  v_lshlrev_b32 v25, 16, v229
  v_and_b32 v26, 0xffff0000, v229
  v_mul_f32 v25, v25, v18
  v_mul_f32 v26, v26, v13
  v_cvt_pk_bf16_f32 v25, v25, v26
  v_lshlrev_b32 v26, 16, v25
  v_and_b32 v25, 0xffff0000, v25
  v_add_f32 v41, v41, v26
  v_add_f32 v41, v41, v25
  v_lshlrev_b32 v25, 16, v230
  v_and_b32 v26, 0xffff0000, v230
  v_mul_f32 v25, v25, v19
  v_mul_f32 v26, v26, v14
  v_cvt_pk_bf16_f32 v25, v25, v26
  v_lshlrev_b32 v26, 16, v25
  v_and_b32 v25, 0xffff0000, v25
  v_add_f32 v41, v41, v26
  v_add_f32 v41, v41, v25
  v_lshlrev_b32 v25, 16, v231
  v_and_b32 v26, 0xffff0000, v231
  v_mul_f32 v25, v25, v20
  v_mul_f32 v26, v26, v15
  v_cvt_pk_bf16_f32 v25, v25, v26
  v_lshlrev_b32 v26, 16, v25
  v_and_b32 v25, 0xffff0000, v25
  v_add_f32 v41, v41, v26
  v_add_f32 v41, v41, v25
  v_lshlrev_b32 v25, 16, v57
  v_and_b32 v26, 0xffff0000, v57
  v_mul_f32 v25, v25, v21
  v_mul_f32 v26, v26, v16
  v_cvt_pk_bf16_f32 v25, v25, v26
  v_lshlrev_b32 v26, 16, v25
  v_and_b32 v25, 0xffff0000, v25
  v_add_f32 v41, v41, v26
  v_add_f32 v41, v41, v25
  v_mov_b32 v42, 0
  v_lshlrev_b32 v25, 16, v232
  v_and_b32 v26, 0xffff0000, v232
  v_mul_f32 v25, v25, v17
  v_mul_f32 v26, v26, v12
  v_cvt_pk_bf16_f32 v25, v25, v26
  v_lshlrev_b32 v26, 16, v25
  v_and_b32 v25, 0xffff0000, v25
  v_add_f32 v42, v42, v26
  v_add_f32 v42, v42, v25
  v_lshlrev_b32 v25, 16, v233
  v_and_b32 v26, 0xffff0000, v233
  v_mul_f32 v25, v25, v18
  v_mul_f32 v26, v26, v13
  v_cvt_pk_bf16_f32 v25, v25, v26
  v_lshlrev_b32 v26, 16, v25
  v_and_b32 v25, 0xffff0000, v25
  v_add_f32 v42, v42, v26
  v_add_f32 v42, v42, v25
  v_lshlrev_b32 v25, 16, v234
  v_and_b32 v26, 0xffff0000, v234
  v_mul_f32 v25, v25, v19
  v_mul_f32 v26, v26, v14
  v_cvt_pk_bf16_f32 v25, v25, v26
  v_lshlrev_b32 v26, 16, v25
  v_and_b32 v25, 0xffff0000, v25
  v_add_f32 v42, v42, v26
  v_add_f32 v42, v42, v25
  v_lshlrev_b32 v25, 16, v235
  v_and_b32 v26, 0xffff0000, v235
  v_mul_f32 v25, v25, v20
  v_mul_f32 v26, v26, v15
  v_cvt_pk_bf16_f32 v25, v25, v26
  v_lshlrev_b32 v26, 16, v25
  v_and_b32 v25, 0xffff0000, v25
  v_add_f32 v42, v42, v26
  v_add_f32 v42, v42, v25
  v_lshlrev_b32 v25, 16, v58
  v_and_b32 v26, 0xffff0000, v58
  v_mul_f32 v25, v25, v21
  v_mul_f32 v26, v26, v16
  v_cvt_pk_bf16_f32 v25, v25, v26
  v_lshlrev_b32 v26, 16, v25
  v_and_b32 v25, 0xffff0000, v25
  v_add_f32 v42, v42, v26
  v_add_f32 v42, v42, v25
  v_mov_b32 v43, 0
  v_lshlrev_b32 v25, 16, v236
  v_and_b32 v26, 0xffff0000, v236
  v_mul_f32 v25, v25, v17
  v_mul_f32 v26, v26, v12
  v_cvt_pk_bf16_f32 v25, v25, v26
  v_lshlrev_b32 v26, 16, v25
  v_and_b32 v25, 0xffff0000, v25
  v_add_f32 v43, v43, v26
  v_add_f32 v43, v43, v25
  v_lshlrev_b32 v25, 16, v237
  v_and_b32 v26, 0xffff0000, v237
  v_mul_f32 v25, v25, v18
  v_mul_f32 v26, v26, v13
  v_cvt_pk_bf16_f32 v25, v25, v26
  v_lshlrev_b32 v26, 16, v25
  v_and_b32 v25, 0xffff0000, v25
  v_add_f32 v43, v43, v26
  v_add_f32 v43, v43, v25
  v_lshlrev_b32 v25, 16, v238
  v_and_b32 v26, 0xffff0000, v238
  v_mul_f32 v25, v25, v19
  v_mul_f32 v26, v26, v14
  v_cvt_pk_bf16_f32 v25, v25, v26
  v_lshlrev_b32 v26, 16, v25
  v_and_b32 v25, 0xffff0000, v25
  v_add_f32 v43, v43, v26
  v_add_f32 v43, v43, v25
  v_lshlrev_b32 v25, 16, v239
  v_and_b32 v26, 0xffff0000, v239
  v_mul_f32 v25, v25, v20
  v_mul_f32 v26, v26, v15
  v_cvt_pk_bf16_f32 v25, v25, v26
  v_lshlrev_b32 v26, 16, v25
  v_and_b32 v25, 0xffff0000, v25
  v_add_f32 v43, v43, v26
  v_add_f32 v43, v43, v25
  v_lshlrev_b32 v25, 16, v59
  v_and_b32 v26, 0xffff0000, v59
  v_mul_f32 v25, v25, v21
  v_mul_f32 v26, v26, v16
  v_cvt_pk_bf16_f32 v25, v25, v26
  v_lshlrev_b32 v26, 16, v25
  v_and_b32 v25, 0xffff0000, v25
  v_add_f32 v43, v43, v26
  v_add_f32 v43, v43, v25
  v_mov_b32 v44, 0
  v_lshlrev_b32 v25, 16, v240
  v_and_b32 v26, 0xffff0000, v240
  v_mul_f32 v25, v25, v17
  v_mul_f32 v26, v26, v12
  v_cvt_pk_bf16_f32 v25, v25, v26
  v_lshlrev_b32 v26, 16, v25
  v_and_b32 v25, 0xffff0000, v25
  v_add_f32 v44, v44, v26
  v_add_f32 v44, v44, v25
  v_lshlrev_b32 v25, 16, v241
  v_and_b32 v26, 0xffff0000, v241
  v_mul_f32 v25, v25, v18
  v_mul_f32 v26, v26, v13
  v_cvt_pk_bf16_f32 v25, v25, v26
  v_lshlrev_b32 v26, 16, v25
  v_and_b32 v25, 0xffff0000, v25
  v_add_f32 v44, v44, v26
  v_add_f32 v44, v44, v25
  v_lshlrev_b32 v25, 16, v242
  v_and_b32 v26, 0xffff0000, v242
  v_mul_f32 v25, v25, v19
  v_mul_f32 v26, v26, v14
  v_cvt_pk_bf16_f32 v25, v25, v26
  v_lshlrev_b32 v26, 16, v25
  v_and_b32 v25, 0xffff0000, v25
  v_add_f32 v44, v44, v26
  v_add_f32 v44, v44, v25
  v_lshlrev_b32 v25, 16, v243
  v_and_b32 v26, 0xffff0000, v243
  v_mul_f32 v25, v25, v20
  v_mul_f32 v26, v26, v15
  v_cvt_pk_bf16_f32 v25, v25, v26
  v_lshlrev_b32 v26, 16, v25
  v_and_b32 v25, 0xffff0000, v25
  v_add_f32 v44, v44, v26
  v_add_f32 v44, v44, v25
  v_lshlrev_b32 v25, 16, v60
  v_and_b32 v26, 0xffff0000, v60
  v_mul_f32 v25, v25, v21
  v_mul_f32 v26, v26, v16
  v_cvt_pk_bf16_f32 v25, v25, v26
  v_lshlrev_b32 v26, 16, v25
  v_and_b32 v25, 0xffff0000, v25
  v_add_f32 v44, v44, v26
  v_add_f32 v44, v44, v25
  v_mov_b32 v45, 0
  v_lshlrev_b32 v25, 16, v244
  v_and_b32 v26, 0xffff0000, v244
  v_mul_f32 v25, v25, v17
  v_mul_f32 v26, v26, v12
  v_cvt_pk_bf16_f32 v25, v25, v26
  v_lshlrev_b32 v26, 16, v25
  v_and_b32 v25, 0xffff0000, v25
  v_add_f32 v45, v45, v26
  v_add_f32 v45, v45, v25
  v_lshlrev_b32 v25, 16, v245
  v_and_b32 v26, 0xffff0000, v245
  v_mul_f32 v25, v25, v18
  v_mul_f32 v26, v26, v13
  v_cvt_pk_bf16_f32 v25, v25, v26
  v_lshlrev_b32 v26, 16, v25
  v_and_b32 v25, 0xffff0000, v25
  v_add_f32 v45, v45, v26
  v_add_f32 v45, v45, v25
  v_lshlrev_b32 v25, 16, v246
  v_and_b32 v26, 0xffff0000, v246
  v_mul_f32 v25, v25, v19
  v_mul_f32 v26, v26, v14
  v_cvt_pk_bf16_f32 v25, v25, v26
  v_lshlrev_b32 v26, 16, v25
  v_and_b32 v25, 0xffff0000, v25
  v_add_f32 v45, v45, v26
  v_add_f32 v45, v45, v25
  v_lshlrev_b32 v25, 16, v247
  v_and_b32 v26, 0xffff0000, v247
  v_mul_f32 v25, v25, v20
  v_mul_f32 v26, v26, v15
  v_cvt_pk_bf16_f32 v25, v25, v26
  v_lshlrev_b32 v26, 16, v25
  v_and_b32 v25, 0xffff0000, v25
  v_add_f32 v45, v45, v26
  v_add_f32 v45, v45, v25
  v_lshlrev_b32 v25, 16, v61
  v_and_b32 v26, 0xffff0000, v61
  v_mul_f32 v25, v25, v21
  v_mul_f32 v26, v26, v16
  v_cvt_pk_bf16_f32 v25, v25, v26
  v_lshlrev_b32 v26, 16, v25
  v_and_b32 v25, 0xffff0000, v25
  v_add_f32 v45, v45, v26
  v_add_f32 v45, v45, v25
  v_mov_b32 v46, 0
  v_lshlrev_b32 v25, 16, v248
  v_and_b32 v26, 0xffff0000, v248
  v_mul_f32 v25, v25, v17
  v_mul_f32 v26, v26, v12
  v_cvt_pk_bf16_f32 v25, v25, v26
  v_lshlrev_b32 v26, 16, v25
  v_and_b32 v25, 0xffff0000, v25
  v_add_f32 v46, v46, v26
  v_add_f32 v46, v46, v25
  v_lshlrev_b32 v25, 16, v249
  v_and_b32 v26, 0xffff0000, v249
  v_mul_f32 v25, v25, v18
  v_mul_f32 v26, v26, v13
  v_cvt_pk_bf16_f32 v25, v25, v26
  v_lshlrev_b32 v26, 16, v25
  v_and_b32 v25, 0xffff0000, v25
  v_add_f32 v46, v46, v26
  v_add_f32 v46, v46, v25
  v_lshlrev_b32 v25, 16, v250
  v_and_b32 v26, 0xffff0000, v250
  v_mul_f32 v25, v25, v19
  v_mul_f32 v26, v26, v14
  v_cvt_pk_bf16_f32 v25, v25, v26
  v_lshlrev_b32 v26, 16, v25
  v_and_b32 v25, 0xffff0000, v25
  v_add_f32 v46, v46, v26
  v_add_f32 v46, v46, v25
  v_lshlrev_b32 v25, 16, v251
  v_and_b32 v26, 0xffff0000, v251
  v_mul_f32 v25, v25, v20
  v_mul_f32 v26, v26, v15
  v_cvt_pk_bf16_f32 v25, v25, v26
  v_lshlrev_b32 v26, 16, v25
  v_and_b32 v25, 0xffff0000, v25
  v_add_f32 v46, v46, v26
  v_add_f32 v46, v46, v25
  v_lshlrev_b32 v25, 16, v62
  v_and_b32 v26, 0xffff0000, v62
  v_mul_f32 v25, v25, v21
  v_mul_f32 v26, v26, v16
  v_cvt_pk_bf16_f32 v25, v25, v26
  v_lshlrev_b32 v26, 16, v25
  v_and_b32 v25, 0xffff0000, v25
  v_add_f32 v46, v46, v26
  v_add_f32 v46, v46, v25
  v_mov_b32 v47, 0
  v_lshlrev_b32 v25, 16, v252
  v_and_b32 v26, 0xffff0000, v252
  v_mul_f32 v25, v25, v17
  v_mul_f32 v26, v26, v12
  v_cvt_pk_bf16_f32 v25, v25, v26
  v_lshlrev_b32 v26, 16, v25
  v_and_b32 v25, 0xffff0000, v25
  v_add_f32 v47, v47, v26
  v_add_f32 v47, v47, v25
  v_lshlrev_b32 v25, 16, v253
  v_and_b32 v26, 0xffff0000, v253
  v_mul_f32 v25, v25, v18
  v_mul_f32 v26, v26, v13
  v_cvt_pk_bf16_f32 v25, v25, v26
  v_lshlrev_b32 v26, 16, v25
  v_and_b32 v25, 0xffff0000, v25
  v_add_f32 v47, v47, v26
  v_add_f32 v47, v47, v25
  v_lshlrev_b32 v25, 16, v254
  v_and_b32 v26, 0xffff0000, v254
  v_mul_f32 v25, v25, v19
  v_mul_f32 v26, v26, v14
  v_cvt_pk_bf16_f32 v25, v25, v26
  v_lshlrev_b32 v26, 16, v25
  v_and_b32 v25, 0xffff0000, v25
  v_add_f32 v47, v47, v26
  v_add_f32 v47, v47, v25
  v_lshlrev_b32 v25, 16, v255
  v_and_b32 v26, 0xffff0000, v255
  v_mul_f32 v25, v25, v20
  v_mul_f32 v26, v26, v15
  v_cvt_pk_bf16_f32 v25, v25, v26
  v_lshlrev_b32 v26, 16, v25
  v_and_b32 v25, 0xffff0000, v25
  v_add_f32 v47, v47, v26
  v_add_f32 v47, v47, v25
  v_lshlrev_b32 v25, 16, v63
  v_and_b32 v26, 0xffff0000, v63
  v_mul_f32 v25, v25, v21
  v_mul_f32 v26, v26, v16
  v_cvt_pk_bf16_f32 v25, v25, v26
  v_lshlrev_b32 v26, 16, v25
  v_and_b32 v25, 0xffff0000, v25
  v_add_f32 v47, v47, v26
  v_add_f32 v47, v47, v25
  v_add_f32_dpp v32, v32, v32 row_ror:8 row_mask:0xf bank_mask:0xf
  v_add_f32_dpp v33, v33, v33 row_ror:8 row_mask:0xf bank_mask:0xf
  v_add_f32_dpp v34, v34, v34 row_ror:8 row_mask:0xf bank_mask:0xf
  v_add_f32_dpp v35, v35, v35 row_ror:8 row_mask:0xf bank_mask:0xf
  v_add_f32_dpp v36, v36, v36 row_ror:8 row_mask:0xf bank_mask:0xf
  v_add_f32_dpp v37, v37, v37 row_ror:8 row_mask:0xf bank_mask:0xf
  v_add_f32_dpp v38, v38, v38 row_ror:8 row_mask:0xf bank_mask:0xf
  v_add_f32_dpp v39, v39, v39 row_ror:8 row_mask:0xf bank_mask:0xf
  v_add_f32_dpp v40, v40, v40 row_ror:8 row_mask:0xf bank_mask:0xf
  v_add_f32_dpp v41, v41, v41 row_ror:8 row_mask:0xf bank_mask:0xf
  v_add_f32_dpp v42, v42, v42 row_ror:8 row_mask:0xf bank_mask:0xf
  v_add_f32_dpp v43, v43, v43 row_ror:8 row_mask:0xf bank_mask:0xf
  v_add_f32_dpp v44, v44, v44 row_ror:8 row_mask:0xf bank_mask:0xf
  v_add_f32_dpp v45, v45, v45 row_ror:8 row_mask:0xf bank_mask:0xf
  v_add_f32_dpp v46, v46, v46 row_ror:8 row_mask:0xf bank_mask:0xf
  v_add_f32_dpp v47, v47, v47 row_ror:8 row_mask:0xf bank_mask:0xf
  v_add_f32_dpp v32, v32, v32 row_ror:4 row_mask:0xf bank_mask:0xf
  v_add_f32_dpp v33, v33, v33 row_ror:4 row_mask:0xf bank_mask:0xf
  v_add_f32_dpp v34, v34, v34 row_ror:4 row_mask:0xf bank_mask:0xf
  v_add_f32_dpp v35, v35, v35 row_ror:4 row_mask:0xf bank_mask:0xf
  v_add_f32_dpp v36, v36, v36 row_ror:4 row_mask:0xf bank_mask:0xf
  v_add_f32_dpp v37, v37, v37 row_ror:4 row_mask:0xf bank_mask:0xf
  v_add_f32_dpp v38, v38, v38 row_ror:4 row_mask:0xf bank_mask:0xf
  v_add_f32_dpp v39, v39, v39 row_ror:4 row_mask:0xf bank_mask:0xf
  v_add_f32_dpp v40, v40, v40 row_ror:4 row_mask:0xf bank_mask:0xf
  v_add_f32_dpp v41, v41, v41 row_ror:4 row_mask:0xf bank_mask:0xf
  v_add_f32_dpp v42, v42, v42 row_ror:4 row_mask:0xf bank_mask:0xf
  v_add_f32_dpp v43, v43, v43 row_ror:4 row_mask:0xf bank_mask:0xf
  v_add_f32_dpp v44, v44, v44 row_ror:4 row_mask:0xf bank_mask:0xf
  v_add_f32_dpp v45, v45, v45 row_ror:4 row_mask:0xf bank_mask:0xf
  v_add_f32_dpp v46, v46, v46 row_ror:4 row_mask:0xf bank_mask:0xf
  v_add_f32_dpp v47, v47, v47 row_ror:4 row_mask:0xf bank_mask:0xf
  v_add_f32_dpp v32, v32, v32 row_ror:2 row_mask:0xf bank_mask:0xf
  v_add_f32_dpp v33, v33, v33 row_ror:2 row_mask:0xf bank_mask:0xf
  v_add_f32_dpp v34, v34, v34 row_ror:2 row_mask:0xf bank_mask:0xf
  v_add_f32_dpp v35, v35, v35 row_ror:2 row_mask:0xf bank_mask:0xf
  v_add_f32_dpp v36, v36, v36 row_ror:2 row_mask:0xf bank_mask:0xf
  v_add_f32_dpp v37, v37, v37 row_ror:2 row_mask:0xf bank_mask:0xf
  v_add_f32_dpp v38, v38, v38 row_ror:2 row_mask:0xf bank_mask:0xf
  v_add_f32_dpp v39, v39, v39 row_ror:2 row_mask:0xf bank_mask:0xf
  v_add_f32_dpp v40, v40, v40 row_ror:2 row_mask:0xf bank_mask:0xf
  v_add_f32_dpp v41, v41, v41 row_ror:2 row_mask:0xf bank_mask:0xf
  v_add_f32_dpp v42, v42, v42 row_ror:2 row_mask:0xf bank_mask:0xf
  v_add_f32_dpp v43, v43, v43 row_ror:2 row_mask:0xf bank_mask:0xf
  v_add_f32_dpp v44, v44, v44 row_ror:2 row_mask:0xf bank_mask:0xf
  v_add_f32_dpp v45, v45, v45 row_ror:2 row_mask:0xf bank_mask:0xf
  v_add_f32_dpp v46, v46, v46 row_ror:2 row_mask:0xf bank_mask:0xf
  v_add_f32_dpp v47, v47, v47 row_ror:2 row_mask:0xf bank_mask:0xf
  v_add_f32_dpp v32, v32, v32 row_ror:1 row_mask:0xf bank_mask:0xf
  v_add_f32_dpp v33, v33, v33 row_ror:1 row_mask:0xf bank_mask:0xf
  v_add_f32_dpp v34, v34, v34 row_ror:1 row_mask:0xf bank_mask:0xf
  v_add_f32_dpp v35, v35, v35 row_ror:1 row_mask:0xf bank_mask:0xf
  v_add_f32_dpp v36, v36, v36 row_ror:1 row_mask:0xf bank_mask:0xf
  v_add_f32_dpp v37, v37, v37 row_ror:1 row_mask:0xf bank_mask:0xf
  v_add_f32_dpp v38, v38, v38 row_ror:1 row_mask:0xf bank_mask:0xf
  v_add_f32_dpp v39, v39, v39 row_ror:1 row_mask:0xf bank_mask:0xf
  v_add_f32_dpp v40, v40, v40 row_ror:1 row_mask:0xf bank_mask:0xf
  v_add_f32_dpp v41, v41, v41 row_ror:1 row_mask:0xf bank_mask:0xf
  v_add_f32_dpp v42, v42, v42 row_ror:1 row_mask:0xf bank_mask:0xf
  v_add_f32_dpp v43, v43, v43 row_ror:1 row_mask:0xf bank_mask:0xf
  v_add_f32_dpp v44, v44, v44 row_ror:1 row_mask:0xf bank_mask:0xf
  v_add_f32_dpp v45, v45, v45 row_ror:1 row_mask:0xf bank_mask:0xf
  v_add_f32_dpp v46, v46, v46 row_ror:1 row_mask:0xf bank_mask:0xf
  v_add_f32_dpp v47, v47, v47 row_ror:1 row_mask:0xf bank_mask:0xf
  v_mov_b32 v24, v32
  v_cmp_eq_u32 vcc, 1, v2
  s_nop 1
  v_cndmask_b32 v24, v24, v33, vcc
  v_cmp_eq_u32 vcc, 2, v2
  s_nop 1
  v_cndmask_b32 v24, v24, v34, vcc
  v_cmp_eq_u32 vcc, 3, v2
  s_nop 1
  v_cndmask_b32 v24, v24, v35, vcc
  v_cmp_eq_u32 vcc, 4, v2
  s_nop 1
  v_cndmask_b32 v24, v24, v36, vcc
  v_cmp_eq_u32 vcc, 5, v2
  s_nop 1
  v_cndmask_b32 v24, v24, v37, vcc
  v_cmp_eq_u32 vcc, 6, v2
  s_nop 1
  v_cndmask_b32 v24, v24, v38, vcc
  v_cmp_eq_u32 vcc, 7, v2
  s_nop 1
  v_cndmask_b32 v24, v24, v39, vcc
  v_cmp_eq_u32 vcc, 8, v2
  s_nop 1
  v_cndmask_b32 v24, v24, v40, vcc
  v_cmp_eq_u32 vcc, 9, v2
  s_nop 1
  v_cndmask_b32 v24, v24, v41, vcc
  v_cmp_eq_u32 vcc, 10, v2
  s_nop 1
  v_cndmask_b32 v24, v24, v42, vcc
  v_cmp_eq_u32 vcc, 11, v2
  s_nop 1
  v_cndmask_b32 v24, v24, v43, vcc
  v_cmp_eq_u32 vcc, 12, v2
  s_nop 1
  v_cndmask_b32 v24, v24, v44, vcc
  v_cmp_eq_u32 vcc, 13, v2
  s_nop 1
  v_cndmask_b32 v24, v24, v45, vcc
  v_cmp_eq_u32 vcc, 14, v2
  s_nop 1
  v_cndmask_b32 v24, v24, v46, vcc
  v_cmp_eq_u32 vcc, 15, v2
  s_nop 1
  v_cndmask_b32 v24, v24, v47, vcc
  v_mov_b32 v25, v24
  s_nop 1
  v_permlane32_swap_b32 v24, v25
  v_add_f32 v24, v24, v25
  v_mov_b32 v25, v24
  s_nop 1
  v_permlane16_swap_b32 v24, v25
  v_add_f32 v24, v24, v25
  v_cvt_pk_bf16_f32 v25, v24, v24
  v_lshlrev_b32 v24, 16, v25
  v_mul_f32 v24, 0xbfb8aa3b, v24
  v_exp_f32 v24, v24
  s_nop 0
  v_add_f32 v24, 1.0, v24
  v_rcp_f32 v24, v24
  s_nop 0
  v_cvt_pk_bf16_f32 v25, v24, v24
  v_lshlrev_b32 v24, 16, v25
  s_lshl_b32 s21, s59, 2
  s_mov_b64 exec, 0xffff
  buffer_store_dword v24, v10, s[76:79], s21 offen sc1
  s_mov_b64 exec, -1
qg_260:
  s_waitcnt vmcnt(45)
  s_barrier
  ds_read_b64_tr_b16 a[0:1], v7 offset:0
  ds_read_b64_tr_b16 a[2:3], v7 offset:1536
  ds_read_b64_tr_b16 a[4:5], v7 offset:32
  ds_read_b64_tr_b16 a[6:7], v7 offset:1568
  ds_read_b64_tr_b16 a[8:9], v7 offset:64
  ds_read_b64_tr_b16 a[10:11], v7 offset:1600
  ds_read_b64_tr_b16 a[12:13], v7 offset:12288
  ds_read_b64_tr_b16 a[14:15], v7 offset:13824
  ds_read_b64_tr_b16 a[16:17], v7 offset:12320
  ds_read_b64_tr_b16 a[18:19], v7 offset:13856
  ds_read_b64_tr_b16 a[20:21], v7 offset:12352
  ds_read_b64_tr_b16 a[22:23], v7 offset:13888
  ds_read_b64_tr_b16 a[24:25], v7 offset:24576
  ds_read_b64_tr_b16 a[26:27], v7 offset:26112
  ds_read_b64_tr_b16 a[28:29], v7 offset:24608
  ds_read_b64_tr_b16 a[30:31], v7 offset:26144
  ds_read_b64_tr_b16 a[32:33], v7 offset:24640
  ds_read_b64_tr_b16 a[34:35], v7 offset:26176
  ds_read_b64_tr_b16 a[36:37], v7 offset:36864
  ds_read_b64_tr_b16 a[38:39], v7 offset:38400
  ds_read_b64_tr_b16 a[40:41], v7 offset:36896
  ds_read_b64_tr_b16 a[42:43], v7 offset:38432
  ds_read_b64_tr_b16 a[44:45], v7 offset:36928
  ds_read_b64_tr_b16 a[46:47], v7 offset:38464
  ds_read_b64_tr_b16 a[48:49], v7 offset:49152
  ds_read_b64_tr_b16 a[50:51], v7 offset:50688
  ds_read_b64_tr_b16 a[52:53], v7 offset:49184
  ds_read_b64_tr_b16 a[54:55], v7 offset:50720
  ds_read_b64_tr_b16 a[56:57], v7 offset:49216
  ds_read_b64_tr_b16 a[58:59], v7 offset:50752
  s_waitcnt lgkmcnt(0)
  s_barrier
  s_waitcnt vmcnt(30)
  s_barrier
  ds_read_b64_tr_b16 a[60:61], v8 offset:0
  ds_read_b64_tr_b16 a[62:63], v8 offset:1536
  ds_read_b64_tr_b16 a[64:65], v8 offset:32
  ds_read_b64_tr_b16 a[66:67], v8 offset:1568
  ds_read_b64_tr_b16 a[68:69], v8 offset:64
  ds_read_b64_tr_b16 a[70:71], v8 offset:1600
  ds_read_b64_tr_b16 a[72:73], v8 offset:12288
  ds_read_b64_tr_b16 a[74:75], v8 offset:13824
  ds_read_b64_tr_b16 a[76:77], v8 offset:12320
  ds_read_b64_tr_b16 a[78:79], v8 offset:13856
  ds_read_b64_tr_b16 a[80:81], v8 offset:12352
  ds_read_b64_tr_b16 a[82:83], v8 offset:13888
  ds_read_b64_tr_b16 a[84:85], v8 offset:24576
  ds_read_b64_tr_b16 a[86:87], v8 offset:26112
  ds_read_b64_tr_b16 a[88:89], v8 offset:24608
  ds_read_b64_tr_b16 a[90:91], v8 offset:26144
  ds_read_b64_tr_b16 a[92:93], v8 offset:24640
  ds_read_b64_tr_b16 a[94:95], v8 offset:26176
  ds_read_b64_tr_b16 a[96:97], v8 offset:36864
  ds_read_b64_tr_b16 a[98:99], v8 offset:38400
  ds_read_b64_tr_b16 a[100:101], v8 offset:36896
  ds_read_b64_tr_b16 a[102:103], v8 offset:38432
  ds_read_b64_tr_b16 a[104:105], v8 offset:36928
  ds_read_b64_tr_b16 a[106:107], v8 offset:38464
  ds_read_b64_tr_b16 a[108:109], v8 offset:49152
  ds_read_b64_tr_b16 a[110:111], v8 offset:50688
  ds_read_b64_tr_b16 a[112:113], v8 offset:49184
  ds_read_b64_tr_b16 a[114:115], v8 offset:50720
  ds_read_b64_tr_b16 a[116:117], v8 offset:49216
  ds_read_b64_tr_b16 a[118:119], v8 offset:50752
  s_waitcnt lgkmcnt(0)
  s_barrier
  s_waitcnt vmcnt(15)
  ds_write_b128 v30, v[64:67] offset:0
  ds_write_b128 v30, v[68:71] offset:1024
  ds_write_b128 v30, v[72:75] offset:2048
  ds_write_b128 v30, v[76:79] offset:3072
  ds_write_b128 v30, v[80:83] offset:4096
  ds_write_b128 v30, v[84:87] offset:5120
  ds_write_b128 v30, v[88:91] offset:6144
  ds_write_b128 v30, v[92:95] offset:7168
  ds_write_b128 v30, v[96:99] offset:8192
  ds_write_b128 v30, v[100:103] offset:9216
  ds_write_b128 v30, v[104:107] offset:10240
  ds_write_b128 v30, v[108:111] offset:11264
  ds_write_b128 v30, v[112:115] offset:12288
  ds_write_b128 v30, v[116:119] offset:13312
  ds_write_b128 v30, v[120:123] offset:14336
  s_waitcnt lgkmcnt(0)
  s_barrier
  ds_read_b64_tr_b16 a[120:121], v7 offset:0
  ds_read_b64_tr_b16 a[122:123], v7 offset:1536
  ds_read_b64_tr_b16 a[124:125], v7 offset:32
  ds_read_b64_tr_b16 a[126:127], v7 offset:1568
  ds_read_b64_tr_b16 a[128:129], v7 offset:64
  ds_read_b64_tr_b16 a[130:131], v7 offset:1600
  ds_read_b64_tr_b16 a[132:133], v7 offset:12288
  ds_read_b64_tr_b16 a[134:135], v7 offset:13824
  ds_read_b64_tr_b16 a[136:137], v7 offset:12320
  ds_read_b64_tr_b16 a[138:139], v7 offset:13856
  ds_read_b64_tr_b16 a[140:141], v7 offset:12352
  ds_read_b64_tr_b16 a[142:143], v7 offset:13888
  ds_read_b64_tr_b16 a[144:145], v7 offset:24576
  ds_read_b64_tr_b16 a[146:147], v7 offset:26112
  ds_read_b64_tr_b16 a[148:149], v7 offset:24608
  ds_read_b64_tr_b16 a[150:151], v7 offset:26144
  ds_read_b64_tr_b16 a[152:153], v7 offset:24640
  ds_read_b64_tr_b16 a[154:155], v7 offset:26176
  ds_read_b64_tr_b16 a[156:157], v7 offset:36864
  ds_read_b64_tr_b16 a[158:159], v7 offset:38400
  ds_read_b64_tr_b16 a[160:161], v7 offset:36896
  ds_read_b64_tr_b16 a[162:163], v7 offset:38432
  ds_read_b64_tr_b16 a[164:165], v7 offset:36928
  ds_read_b64_tr_b16 a[166:167], v7 offset:38464
  ds_read_b64_tr_b16 a[168:169], v7 offset:49152
  ds_read_b64_tr_b16 a[170:171], v7 offset:50688
  ds_read_b64_tr_b16 a[172:173], v7 offset:49184
  ds_read_b64_tr_b16 a[174:175], v7 offset:50720
  ds_read_b64_tr_b16 a[176:177], v7 offset:49216
  ds_read_b64_tr_b16 a[178:179], v7 offset:50752
  s_waitcnt lgkmcnt(0)
  s_barrier
  s_waitcnt vmcnt(0)
  ds_write_b128 v31, v[124:127] offset:0
  ds_write_b128 v31, v[128:131] offset:1024
  ds_write_b128 v31, v[132:135] offset:2048
  ds_write_b128 v31, v[136:139] offset:3072
  ds_write_b128 v31, v[140:143] offset:4096
  ds_write_b128 v31, v[144:147] offset:5120
  ds_write_b128 v31, v[148:151] offset:6144
  ds_write_b128 v31, v[152:155] offset:7168
  ds_write_b128 v31, v[156:159] offset:8192
  ds_write_b128 v31, v[160:163] offset:9216
  ds_write_b128 v31, v[164:167] offset:10240
  ds_write_b128 v31, v[168:171] offset:11264
  ds_write_b128 v31, v[172:175] offset:12288
  ds_write_b128 v31, v[176:179] offset:13312
  ds_write_b128 v31, v[180:183] offset:14336
  s_waitcnt lgkmcnt(0)
  s_barrier
  ds_read_b64_tr_b16 a[180:181], v8 offset:0
  ds_read_b64_tr_b16 a[182:183], v8 offset:1536
  ds_read_b64_tr_b16 a[184:185], v8 offset:32
  ds_read_b64_tr_b16 a[186:187], v8 offset:1568
  ds_read_b64_tr_b16 a[188:189], v8 offset:64
  ds_read_b64_tr_b16 a[190:191], v8 offset:1600
  ds_read_b64_tr_b16 a[192:193], v8 offset:12288
  ds_read_b64_tr_b16 a[194:195], v8 offset:13824
  ds_read_b64_tr_b16 a[196:197], v8 offset:12320
  ds_read_b64_tr_b16 a[198:199], v8 offset:13856
  ds_read_b64_tr_b16 a[200:201], v8 offset:12352
  ds_read_b64_tr_b16 a[202:203], v8 offset:13888
  ds_read_b64_tr_b16 a[204:205], v8 offset:24576
  ds_read_b64_tr_b16 a[206:207], v8 offset:26112
  ds_read_b64_tr_b16 a[208:209], v8 offset:24608
  ds_read_b64_tr_b16 a[210:211], v8 offset:26144
  ds_read_b64_tr_b16 a[212:213], v8 offset:24640
  ds_read_b64_tr_b16 a[214:215], v8 offset:26176
  ds_read_b64_tr_b16 a[216:217], v8 offset:36864
  ds_read_b64_tr_b16 a[218:219], v8 offset:38400
  ds_read_b64_tr_b16 a[220:221], v8 offset:36896
  ds_read_b64_tr_b16 a[222:223], v8 offset:38432
  ds_read_b64_tr_b16 a[224:225], v8 offset:36928
  ds_read_b64_tr_b16 a[226:227], v8 offset:38464
  ds_read_b64_tr_b16 a[228:229], v8 offset:49152
  ds_read_b64_tr_b16 a[230:231], v8 offset:50688
  ds_read_b64_tr_b16 a[232:233], v8 offset:49184
  ds_read_b64_tr_b16 a[234:235], v8 offset:50720
  ds_read_b64_tr_b16 a[236:237], v8 offset:49216
  ds_read_b64_tr_b16 a[238:239], v8 offset:50752
  s_waitcnt lgkmcnt(0)
  s_barrier
  s_and_b32 s21, s2, 3
  s_lshl_b32 s21, s21, 7
  s_add_u32 s21, s21, 29696
  s_xor_b32 s21, s21, s80
  s_cmp_lg_u32 s40, 0
  s_cbranch_scc1 qg_261
  s_cmp_lg_u32 s20, 0
  s_cbranch_scc1 af_262
  v_mov_b32 v8, 0
  v_mov_b32 v9, 1
  s_mov_b64 exec, 1
  buffer_atomic_add v9, v8, s[72:75], s21 offen sc1
  s_mov_b64 exec, -1
  s_nop 1
af_262:
qg_261:
  s_add_u32 s56, s38, 218103808
  s_addc_u32 s57, s39, 0
  s_mov_b32 s58, 12582912
  s_mov_b32 s59, 0x00020000
  s_cmp_eq_u32 s40, 0
  s_cselect_b32 s85, 1, 99
  s_cselect_b32 s89, 99, 3
  s_cselect_b32 s21, 0, 2
  s_add_u32 s21, s21, s40
  s_mul_i32 s30, s21, 163840
  s_mul_i32 s90, s41, 163840
  s_sub_u32 s90, 162688, s90
  s_mov_b32 s26, s41
  s_mul_i32 s86, s42, 393216
  s_sub_u32 s91, s41, 2
  s_cmp_eq_u32 s40, 0
  s_cselect_b32 s91, 0, s91
  s_lshl_b32 s46, s40, 2
  s_add_u32 s46, s46, s20
  v_lshrrev_b32 v4, 3, v1
  v_and_b32 v5, 7, v1
  v_xor_b32 v5, v5, v4
  s_mul_i32 s21, s20, 32
  v_add_u32 v4, s21, v4
  v_mul_u32_u24 v4, 1280, v4
  v_lshl_add_u32 v10, v5, 4, v4
  s_mul_i32 s31, s20, 4096
  v_add_u32 v11, 10240, v10
  v_add_u32 v12, 20480, v10
  v_add_u32 v13, 30720, v10
  s_add_u32 m0, s31, 0
  s_nop 0
  buffer_load_dwordx4 v10, s[8:11], s30 offen lds
  s_add_u32 m0, s31, 1024
  s_nop 0
  buffer_load_dwordx4 v11, s[8:11], s30 offen lds
  s_add_u32 m0, s31, 2048
  s_nop 0
  buffer_load_dwordx4 v12, s[8:11], s30 offen lds
  s_add_u32 m0, s31, 3072
  s_nop 0
  buffer_load_dwordx4 v13, s[8:11], s30 offen lds
  s_add_u32 s30, s30, 128
  s_add_u32 m0, s31, 16384
  s_nop 0
  buffer_load_dwordx4 v10, s[8:11], s30 offen lds
  s_add_u32 m0, s31, 17408
  s_nop 0
  buffer_load_dwordx4 v11, s[8:11], s30 offen lds
  s_add_u32 m0, s31, 18432
  s_nop 0
  buffer_load_dwordx4 v12, s[8:11], s30 offen lds
  s_add_u32 m0, s31, 19456
  s_nop 0
  buffer_load_dwordx4 v13, s[8:11], s30 offen lds
  s_add_u32 s30, s30, 128
  s_add_u32 m0, s31, 32768
  s_nop 0
  buffer_load_dwordx4 v10, s[8:11], s30 offen lds
  s_add_u32 m0, s31, 33792
  s_nop 0
  buffer_load_dwordx4 v11, s[8:11], s30 offen lds
  s_add_u32 m0, s31, 34816
  s_nop 0
  buffer_load_dwordx4 v12, s[8:11], s30 offen lds
  s_add_u32 m0, s31, 35840
  s_nop 0
  buffer_load_dwordx4 v13, s[8:11], s30 offen lds
  s_add_u32 s30, s30, 128
  v_and_b32 v6, 7, v2
  v_add_u32 v4, 0, v3
  v_xor_b32 v4, v4, v6
  v_lshlrev_b32 v4, 4, v4
  v_lshl_add_u32 v14, v2, 7, v4
  v_add_u32 v16, 65536, v14
  v_add_u32 v18, 131072, v14
  v_add_u32 v4, 4, v3
  v_xor_b32 v4, v4, v6
  v_lshlrev_b32 v4, 4, v4
  v_lshl_add_u32 v15, v2, 7, v4
  v_add_u32 v17, 65536, v15
  v_add_u32 v19, 131072, v15
  v_lshlrev_b32 v26, 4, v1
  v_mov_b32 v28, 1
  v_mov_b32 v4, 0x40000000
  v_cmp_eq_u32 vcc, 0, v0
  s_nop 1
  v_cndmask_b32 v27, v4, 0, vcc
  s_mul_i32 s21, s20, 3072
  s_add_u32 s21, s21, 81920
  v_add_u32 v20, s21, v26
  s_mul_i32 s21, s20, 12288
  s_add_u32 s21, s21, 81920
  v_add_u32 v21, s21, v26
  v_add_u32 v22, 2048, v21
  v_add_u32 v23, 2056, v21
  v_and_b32 v4, 7, v2
  v_lshlrev_b32 v4, 4, v4
  v_lshl_add_u32 v24, v3, 7, v4
  v_lshrrev_b32 v25, 1, v24
  v_lshlrev_b32 v29, 3, v1
  v_and_b32 v4, 3, v1
  v_lshlrev_b32 v30, 3, v4
  v_mov_b32 v31, 0xf149f2ca
  v_mov_b32 v32, 0
  v_mov_b32 v4, 1073741824
  v_cmp_eq_u32 vcc, 0, v1
  v_lshlrev_b32 v5, 2, v3
  v_sub_u32 v5, v2, v5
  v_cndmask_b32 v33, v4, 0, vcc
  v_cmp_gt_u32 s[62:63], 2, v3
  s_mov_b32 s83, 0x3dd53b95
  s_lshl_b32 s77, s42, 7
  s_add_u32 s77, s77, 0
  s_xor_b32 s77, s77, s80
  s_lshl_b32 s45, s46, 21
  s_lshl_b32 s21, s46, 13
  s_and_b32 s21, s21, 8192
  s_xor_b32 s21, s21, s80
  s_add_u32 s45, s45, s21
  s_lshl_b32 s21, s42, 16
  s_add_u32 s45, s45, s21
  s_lshr_b32 s47, s42, 1
  s_lshl_b32 s47, s47, 14
  s_and_b32 s22, s42, 1
  s_mul_i32 s22, s22, 2560
  s_add_u32 s47, s47, s22
  s_lshl_b32 s21, s46, 19
  s_lshl_b32 s22, s46, 11
  s_and_b32 s22, s22, 8192
  s_xor_b32 s22, s22, s80
  s_add_u32 s21, s21, s22
  s_add_u32 s21, s21, 136314880
  s_xor_b32 s21, s21, 8192
  s_add_u32 s47, s47, s21
  s_add_u32 s47, s47, 48234496
  s_lshl_b32 s48, s46, 7
  s_add_u32 s48, s48, 8192
  s_xor_b32 s48, s48, s80
  s_add_u32 s43, s46, 1
  s_mov_b32 s49, 0
  s_mov_b32 s50, 1073741824
  s_mov_b32 s81, 1073741824
  s_mov_b32 s82, 1073741824
  s_mov_b32 s84, 1073741824
  v_cmp_le_i32 s[64:65], 0, v5
  v_cmp_le_i32 s[66:67], 1, v5
  v_cmp_le_i32 s[68:69], 2, v5
  v_cmp_le_i32 s[70:71], 3, v5
  s_waitcnt vmcnt(8)
  s_barrier
  ds_read_b128 v[160:163], v14 offset:0
  ds_read_b128 v[164:167], v14 offset:2048
  ds_read_b128 v[168:171], v14 offset:4096
  ds_read_b128 v[172:175], v14 offset:6144
  s_waitcnt lgkmcnt(3)
  .p2align 3
qa_267:
  v_mfma_f32_16x16x32_bf16 v[64:67], a[0:3], v[160:163], 0
  ds_read_b128 v[176:179], v14 offset:8192
  v_cvt_pk_bf16_f32 v221, v126, v127
  v_mfma_f32_16x16x32_bf16 v[68:71], a[4:7], v[160:163], 0
  v_cvt_pk_bf16_f32 v222, v128, v129
  v_cvt_pk_bf16_f32 v223, v130, v131
  v_mfma_f32_16x16x32_bf16 v[72:75], a[8:11], v[160:163], 0
  s_waitcnt lgkmcnt(3)
  v_cvt_pk_bf16_f32 v226, v132, v133
  v_cvt_pk_bf16_f32 v227, v134, v135
  v_mfma_f32_16x16x32_bf16 v[76:79], a[0:3], v[164:167], 0
  ds_read_b128 v[180:183], v14 offset:10240
  v_cvt_pk_bf16_f32 v228, v136, v137
  v_mfma_f32_16x16x32_bf16 v[80:83], a[4:7], v[164:167], 0
  v_cvt_pk_bf16_f32 v229, v138, v139
  v_cvt_pk_bf16_f32 v230, v140, v141
  v_mfma_f32_16x16x32_bf16 v[84:87], a[8:11], v[164:167], 0
  s_waitcnt lgkmcnt(3)
  v_cvt_pk_bf16_f32 v231, v142, v143
  v_cvt_pk_bf16_f32 v236, v144, v145
  v_mfma_f32_16x16x32_bf16 v[88:91], a[0:3], v[168:171], 0
  ds_read_b128 v[184:187], v14 offset:12288
  v_cvt_pk_bf16_f32 v237, v146, v147
  v_mfma_f32_16x16x32_bf16 v[92:95], a[4:7], v[168:171], 0
  v_cvt_pk_bf16_f32 v232, v148, v149
  v_cvt_pk_bf16_f32 v233, v150, v151
  v_mfma_f32_16x16x32_bf16 v[96:99], a[8:11], v[168:171], 0
  s_waitcnt lgkmcnt(3)
  v_cvt_pk_bf16_f32 v234, v152, v153
  v_cvt_pk_bf16_f32 v235, v154, v155
  v_mfma_f32_16x16x32_bf16 v[100:103], a[0:3], v[172:175], 0
  ds_read_b128 v[188:191], v14 offset:14336
  v_cvt_pk_bf16_f32 v238, v156, v157
  v_mfma_f32_16x16x32_bf16 v[104:107], a[4:7], v[172:175], 0
  v_cvt_pk_bf16_f32 v239, v158, v159
  ds_write_b128 v20, v[192:195] offset:0
  v_mfma_f32_16x16x32_bf16 v[108:111], a[8:11], v[172:175], 0
  s_waitcnt lgkmcnt(4)
  v_mfma_f32_16x16x32_bf16 v[112:115], a[0:3], v[176:179], 0
  ds_read_b128 v[160:163], v15 offset:0
  s_waitcnt vmcnt(4)
  v_mfma_f32_16x16x32_bf16 v[116:119], a[4:7], v[176:179], 0
  s_add_u32 m0, s31, 49152
  v_cmp_gt_u32 vcc, s49, v32
  v_mfma_f32_16x16x32_bf16 v[120:123], a[8:11], v[176:179], 0
  s_waitcnt lgkmcnt(4)
  buffer_load_dwordx4 v10, s[8:11], s30 offen lds
  s_cbranch_vccnz qw_268
qj_269:
  v_mfma_f32_16x16x32_bf16 v[124:127], a[0:3], v[180:183], 0
  s_add_u32 s29, s50, 4096
  ds_read_b128 v[164:167], v15 offset:2048
  ds_write_b128 v20, v[196:199] offset:1024
  v_mfma_f32_16x16x32_bf16 v[128:131], a[4:7], v[180:183], 0
  v_mfma_f32_16x16x32_bf16 v[132:135], a[8:11], v[180:183], 0
  s_waitcnt lgkmcnt(5)
  buffer_load_dwordx4 a[240:243], v24, s[16:19], s29 offen offset:2560 sc1
  v_mfma_f32_16x16x32_bf16 v[136:139], a[0:3], v[184:187], 0
  ds_read_b128 v[168:171], v15 offset:4096
  v_mfma_f32_16x16x32_bf16 v[140:143], a[4:7], v[184:187], 0
  s_add_u32 m0, s31, 50176
  v_mfma_f32_16x16x32_bf16 v[144:147], a[8:11], v[184:187], 0
  s_waitcnt lgkmcnt(5)
  buffer_load_dwordx4 v11, s[8:11], s30 offen lds
  ds_write_b128 v20, v[200:203] offset:2048
  v_mfma_f32_16x16x32_bf16 v[148:151], a[0:3], v[188:191], 0
  ds_read_b128 v[172:175], v15 offset:6144
  v_mfma_f32_16x16x32_bf16 v[152:155], a[4:7], v[188:191], 0
  v_mfma_f32_16x16x32_bf16 v[156:159], a[8:11], v[188:191], 0
  s_waitcnt lgkmcnt(5)
  buffer_load_dwordx2 v[240:241], v25, s[16:19], s29 offen offset:3072 sc1
  s_add_u32 s29, s50, 20480
  v_mfma_f32_16x16x32_bf16 v[64:67], a[12:15], v[160:163], v[64:67]
  ds_read_b128 v[176:179], v15 offset:8192
  v_mfma_f32_16x16x32_bf16 v[68:71], a[16:19], v[160:163], v[68:71]
  s_add_u32 m0, s31, 51200
  ds_write_b128 v20, v[204:207] offset:12288
  v_mfma_f32_16x16x32_bf16 v[72:75], a[20:23], v[160:163], v[72:75]
  s_waitcnt lgkmcnt(6)
  buffer_load_dwordx4 v12, s[8:11], s30 offen lds
  v_mfma_f32_16x16x32_bf16 v[76:79], a[12:15], v[164:167], v[76:79]
  ds_read_b128 v[180:183], v15 offset:10240
  v_mfma_f32_16x16x32_bf16 v[80:83], a[16:19], v[164:167], v[80:83]
  v_mfma_f32_16x16x32_bf16 v[84:87], a[20:23], v[164:167], v[84:87]
  s_waitcnt lgkmcnt(5)
  buffer_load_dwordx4 a[244:247], v24, s[16:19], s29 offen offset:2560 sc1
  v_mfma_f32_16x16x32_bf16 v[88:91], a[12:15], v[168:171], v[88:91]
  ds_read_b128 v[184:187], v15 offset:12288
  ds_write_b128 v20, v[208:211] offset:13312
  v_mfma_f32_16x16x32_bf16 v[92:95], a[16:19], v[168:171], v[92:95]
  s_add_u32 m0, s31, 52224
  v_mfma_f32_16x16x32_bf16 v[96:99], a[20:23], v[168:171], v[96:99]
  s_waitcnt lgkmcnt(5)
  buffer_load_dwordx4 v13, s[8:11], s30 offen lds
  v_mfma_f32_16x16x32_bf16 v[100:103], a[12:15], v[172:175], v[100:103]
  s_add_u32 s30, s30, 128
  ds_read_b128 v[188:191], v15 offset:14336
  v_mfma_f32_16x16x32_bf16 v[104:107], a[16:19], v[172:175], v[104:107]
  v_mfma_f32_16x16x32_bf16 v[108:111], a[20:23], v[172:175], v[108:111]
  s_waitcnt lgkmcnt(5)
  ds_write_b128 v20, v[212:215] offset:14336
  v_mfma_f32_16x16x32_bf16 v[112:115], a[12:15], v[176:179], v[112:115]
  s_waitcnt vmcnt(11)
  s_barrier
  ds_read_b128 v[160:163], v14 offset:16384
  v_mfma_f32_16x16x32_bf16 v[116:119], a[16:19], v[176:179], v[116:119]
  s_waitcnt vmcnt(13)
  buffer_atomic_add v28, v33, s[72:75], s84 offen sc1
  v_mfma_f32_16x16x32_bf16 v[120:123], a[20:23], v[176:179], v[120:123]
  s_waitcnt lgkmcnt(5)
  v_mfma_f32_16x16x32_bf16 v[124:127], a[12:15], v[180:183], v[124:127]
  ds_read_b128 v[164:167], v14 offset:18432
  v_mfma_f32_16x16x32_bf16 v[128:131], a[16:19], v[180:183], v[128:131]
  ds_write_b128 v20, v[216:219] offset:24576
  buffer_load_dwordx2 v[242:243], v25, s[16:19], s29 offen offset:3072 sc1
  v_mfma_f32_16x16x32_bf16 v[132:135], a[20:23], v[180:183], v[132:135]
  s_add_u32 s29, s50, 36864
  s_waitcnt lgkmcnt(6)
  v_mfma_f32_16x16x32_bf16 v[136:139], a[12:15], v[184:187], v[136:139]
  ds_read_b128 v[168:171], v14 offset:20480
  v_mfma_f32_16x16x32_bf16 v[140:143], a[16:19], v[184:187], v[140:143]
  buffer_load_dwordx4 a[248:251], v24, s[16:19], s29 offen offset:2560 sc1
  v_mfma_f32_16x16x32_bf16 v[144:147], a[20:23], v[184:187], v[144:147]
  s_waitcnt lgkmcnt(5)
  v_mfma_f32_16x16x32_bf16 v[148:151], a[12:15], v[188:191], v[148:151]
  ds_read_b128 v[172:175], v14 offset:22528
  ds_write_b128 v20, v[220:223] offset:25600
  v_mfma_f32_16x16x32_bf16 v[152:155], a[16:19], v[188:191], v[152:155]
  buffer_load_dwordx2 v[244:245], v25, s[16:19], s29 offen offset:3072 sc1
  s_add_u32 s29, s50, 53248
  v_mfma_f32_16x16x32_bf16 v[156:159], a[20:23], v[188:191], v[156:159]
  s_waitcnt lgkmcnt(5)
  v_mfma_f32_16x16x32_bf16 v[64:67], a[24:27], v[160:163], v[64:67]
  ds_read_b128 v[176:179], v14 offset:24576
  v_mfma_f32_16x16x32_bf16 v[68:71], a[28:31], v[160:163], v[68:71]
  s_add_u32 m0, s31, 65536
  v_mfma_f32_16x16x32_bf16 v[72:75], a[32:35], v[160:163], v[72:75]
  s_waitcnt lgkmcnt(5)
  buffer_load_dwordx4 v10, s[8:11], s30 offen lds
  ds_write_b128 v20, v[224:227] offset:26624
  v_mfma_f32_16x16x32_bf16 v[76:79], a[24:27], v[164:167], v[76:79]
  ds_read_b128 v[180:183], v14 offset:26624
  v_mfma_f32_16x16x32_bf16 v[80:83], a[28:31], v[164:167], v[80:83]
  v_mfma_f32_16x16x32_bf16 v[84:87], a[32:35], v[164:167], v[84:87]
  s_waitcnt lgkmcnt(5)
  buffer_load_dwordx4 a[252:255], v24, s[16:19], s29 offen offset:2560 sc1
  v_mfma_f32_16x16x32_bf16 v[88:91], a[24:27], v[168:171], v[88:91]
  ds_read_b128 v[184:187], v14 offset:28672
  v_mfma_f32_16x16x32_bf16 v[92:95], a[28:31], v[168:171], v[92:95]
  ds_write_b128 v20, v[228:231] offset:36864
  v_mfma_f32_16x16x32_bf16 v[96:99], a[32:35], v[168:171], v[96:99]
  s_waitcnt lgkmcnt(6)
  buffer_load_dwordx2 v[246:247], v25, s[16:19], s29 offen offset:3072 sc1
  v_mfma_f32_16x16x32_bf16 v[100:103], a[24:27], v[172:175], v[100:103]
  ds_read_b128 v[188:191], v14 offset:30720
  v_mfma_f32_16x16x32_bf16 v[104:107], a[28:31], v[172:175], v[104:107]
  s_add_u32 m0, s31, 66560
  v_mfma_f32_16x16x32_bf16 v[108:111], a[32:35], v[172:175], v[108:111]
  s_waitcnt lgkmcnt(5)
  buffer_load_dwordx4 v11, s[8:11], s30 offen lds
  v_mfma_f32_16x16x32_bf16 v[112:115], a[24:27], v[176:179], v[112:115]
  ds_read_b128 v[160:163], v15 offset:16384
  ds_write_b128 v20, v[232:235] offset:37888
  v_mfma_f32_16x16x32_bf16 v[116:119], a[28:31], v[176:179], v[116:119]
  v_mfma_f32_16x16x32_bf16 v[120:123], a[32:35], v[176:179], v[120:123]
  s_waitcnt lgkmcnt(5)
  v_mfma_f32_16x16x32_bf16 v[124:127], a[24:27], v[180:183], v[124:127]
  ds_read_b128 v[164:167], v15 offset:18432
  v_mfma_f32_16x16x32_bf16 v[128:131], a[28:31], v[180:183], v[128:131]
  v_mfma_f32_16x16x32_bf16 v[132:135], a[32:35], v[180:183], v[132:135]
  s_waitcnt lgkmcnt(5)
  ds_write_b128 v20, v[236:239] offset:38912
  v_mfma_f32_16x16x32_bf16 v[136:139], a[24:27], v[184:187], v[136:139]
  ds_read_b128 v[168:171], v15 offset:20480
  v_mfma_f32_16x16x32_bf16 v[140:143], a[28:31], v[184:187], v[140:143]
  s_add_u32 m0, s31, 67584
  s_cmp_eq_u32 s26, s89
  s_cselect_b32 s25, s90, 162688
  v_mfma_f32_16x16x32_bf16 v[144:147], a[32:35], v[184:187], v[144:147]
  s_sub_u32 s21, s26, 2
  s_waitcnt lgkmcnt(5)
  buffer_load_dwordx4 v12, s[8:11], s30 offen lds
  v_mfma_f32_16x16x32_bf16 v[148:151], a[24:27], v[188:191], v[148:151]
  ds_read_b128 v[172:175], v15 offset:22528
  v_mfma_f32_16x16x32_bf16 v[152:155], a[28:31], v[188:191], v[152:155]
  s_cmp_lt_u32 s21, s91
  s_cbranch_scc1 qs_265
qs_266:
  s_waitcnt lgkmcnt(2)
  v_mfma_f32_16x16x32_bf16 v[156:159], a[32:35], v[188:191], v[156:159]
  s_add_u32 s29, s50, 0
  s_waitcnt lgkmcnt(5)
  buffer_load_dwordx4 v[192:195], v26, s[16:19], s29 offen offset:0 sc1
  v_mfma_f32_16x16x32_bf16 v[64:67], a[36:39], v[160:163], v[64:67]
  ds_read_b128 v[176:179], v15 offset:24576
  v_mfma_f32_16x16x32_bf16 v[68:71], a[40:43], v[160:163], v[68:71]
  v_mfma_f32_16x16x32_bf16 v[72:75], a[44:47], v[160:163], v[72:75]
  s_waitcnt lgkmcnt(4)
  buffer_load_dwordx4 v[196:199], v26, s[16:19], s29 offen offset:1024 sc1
  v_mfma_f32_16x16x32_bf16 v[76:79], a[36:39], v[164:167], v[76:79]
  ds_read_b128 v[180:183], v15 offset:26624
  v_mfma_f32_16x16x32_bf16 v[80:83], a[40:43], v[164:167], v[80:83]
  s_add_u32 m0, s31, 68608
  v_mfma_f32_16x16x32_bf16 v[84:87], a[44:47], v[164:167], v[84:87]
  s_waitcnt lgkmcnt(3)
  buffer_load_dwordx4 v13, s[8:11], s30 offen lds
  v_mfma_f32_16x16x32_bf16 v[88:91], a[36:39], v[168:171], v[88:91]
  s_add_u32 s30, s30, 128
  ds_read_b128 v[184:187], v15 offset:28672
  v_mfma_f32_16x16x32_bf16 v[92:95], a[40:43], v[168:171], v[92:95]
  v_mfma_f32_16x16x32_bf16 v[96:99], a[44:47], v[168:171], v[96:99]
  s_waitcnt lgkmcnt(3)
  buffer_load_dwordx4 v[224:227], v26, s[16:19], s29 offen offset:2048 sc1
  s_add_u32 s29, s50, 16384
  v_mfma_f32_16x16x32_bf16 v[100:103], a[36:39], v[172:175], v[100:103]
  ds_read_b128 v[188:191], v15 offset:30720
  v_mfma_f32_16x16x32_bf16 v[104:107], a[40:43], v[172:175], v[104:107]
  v_mfma_f32_16x16x32_bf16 v[108:111], a[44:47], v[172:175], v[108:111]
  s_waitcnt lgkmcnt(3)
  buffer_load_dwordx4 v[200:203], v26, s[16:19], s29 offen offset:0 sc1
  v_mfma_f32_16x16x32_bf16 v[112:115], a[36:39], v[176:179], v[112:115]
  s_waitcnt vmcnt(21)
  s_barrier
  ds_read_b128 v[160:163], v14 offset:32768
  v_mfma_f32_16x16x32_bf16 v[116:119], a[40:43], v[176:179], v[116:119]
  v_mfma_f32_16x16x32_bf16 v[120:123], a[44:47], v[176:179], v[120:123]
  s_waitcnt lgkmcnt(3)
  buffer_load_dwordx4 v[204:207], v26, s[16:19], s29 offen offset:1024 sc1
  v_mfma_f32_16x16x32_bf16 v[124:127], a[36:39], v[180:183], v[124:127]
  ds_read_b128 v[164:167], v14 offset:34816
  v_mfma_f32_16x16x32_bf16 v[128:131], a[40:43], v[180:183], v[128:131]
  v_mfma_f32_16x16x32_bf16 v[132:135], a[44:47], v[180:183], v[132:135]
  s_waitcnt lgkmcnt(3)
  buffer_load_dwordx4 v[228:231], v26, s[16:19], s29 offen offset:2048 sc1
  s_add_u32 s29, s50, 32768
  v_mfma_f32_16x16x32_bf16 v[136:139], a[36:39], v[184:187], v[136:139]
  ds_read_b128 v[168:171], v14 offset:36864
  v_mfma_f32_16x16x32_bf16 v[140:143], a[40:43], v[184:187], v[140:143]
  v_mfma_f32_16x16x32_bf16 v[144:147], a[44:47], v[184:187], v[144:147]
  s_waitcnt lgkmcnt(3)
  buffer_load_dwordx4 v[208:211], v26, s[16:19], s29 offen offset:0 sc1
  v_mfma_f32_16x16x32_bf16 v[148:151], a[36:39], v[188:191], v[148:151]
  ds_read_b128 v[172:175], v14 offset:38912
  v_mfma_f32_16x16x32_bf16 v[152:155], a[40:43], v[188:191], v[152:155]
  v_mfma_f32_16x16x32_bf16 v[156:159], a[44:47], v[188:191], v[156:159]
  s_waitcnt lgkmcnt(3)
  buffer_load_dwordx4 v[212:215], v26, s[16:19], s29 offen offset:1024 sc1
  v_mfma_f32_16x16x32_bf16 v[64:67], a[48:51], v[160:163], v[64:67]
  ds_read_b128 v[176:179], v14 offset:40960
  v_mfma_f32_16x16x32_bf16 v[68:71], a[52:55], v[160:163], v[68:71]
  s_add_u32 m0, s31, 0
  v_mfma_f32_16x16x32_bf16 v[72:75], a[56:59], v[160:163], v[72:75]
  s_waitcnt lgkmcnt(3)
  buffer_load_dwordx4 v10, s[8:11], s30 offen lds
  v_mfma_f32_16x16x32_bf16 v[76:79], a[48:51], v[164:167], v[76:79]
  ds_read_b128 v[180:183], v14 offset:43008
  v_mfma_f32_16x16x32_bf16 v[80:83], a[52:55], v[164:167], v[80:83]
  v_mfma_f32_16x16x32_bf16 v[84:87], a[56:59], v[164:167], v[84:87]
  s_waitcnt lgkmcnt(3)
  buffer_load_dwordx4 v[232:235], v26, s[16:19], s29 offen offset:2048 sc1
  s_add_u32 s29, s50, 49152
  v_mfma_f32_16x16x32_bf16 v[88:91], a[48:51], v[168:171], v[88:91]
  ds_read_b128 v[184:187], v14 offset:45056
  v_mfma_f32_16x16x32_bf16 v[92:95], a[52:55], v[168:171], v[92:95]
  v_mfma_f32_16x16x32_bf16 v[96:99], a[56:59], v[168:171], v[96:99]
  s_waitcnt lgkmcnt(3)
  buffer_load_dwordx4 v[216:219], v26, s[16:19], s29 offen offset:0 sc1
  v_mfma_f32_16x16x32_bf16 v[100:103], a[48:51], v[172:175], v[100:103]
  ds_read_b128 v[188:191], v14 offset:47104
  v_mfma_f32_16x16x32_bf16 v[104:107], a[52:55], v[172:175], v[104:107]
  s_add_u32 m0, s31, 1024
  v_mfma_f32_16x16x32_bf16 v[108:111], a[56:59], v[172:175], v[108:111]
  s_waitcnt lgkmcnt(3)
  buffer_load_dwordx4 v11, s[8:11], s30 offen lds
  v_mfma_f32_16x16x32_bf16 v[112:115], a[48:51], v[176:179], v[112:115]
  ds_read_b128 v[160:163], v15 offset:32768
  v_mfma_f32_16x16x32_bf16 v[116:119], a[52:55], v[176:179], v[116:119]
  v_mfma_f32_16x16x32_bf16 v[120:123], a[56:59], v[176:179], v[120:123]
  s_waitcnt lgkmcnt(3)
  buffer_load_dwordx4 v[220:223], v26, s[16:19], s29 offen offset:1024 sc1
  v_mfma_f32_16x16x32_bf16 v[124:127], a[48:51], v[180:183], v[124:127]
  ds_read_b128 v[164:167], v15 offset:34816
  v_mfma_f32_16x16x32_bf16 v[128:131], a[52:55], v[180:183], v[128:131]
  v_mfma_f32_16x16x32_bf16 v[132:135], a[56:59], v[180:183], v[132:135]
  s_waitcnt lgkmcnt(3)
  buffer_load_dwordx4 v[236:239], v26, s[16:19], s29 offen offset:2048 sc1
  v_mfma_f32_16x16x32_bf16 v[136:139], a[48:51], v[184:187], v[136:139]
  ds_read_b128 v[168:171], v15 offset:36864
  v_mfma_f32_16x16x32_bf16 v[140:143], a[52:55], v[184:187], v[140:143]
  s_add_u32 m0, s31, 2048
  v_mfma_f32_16x16x32_bf16 v[144:147], a[56:59], v[184:187], v[144:147]
  s_waitcnt lgkmcnt(3)
  buffer_load_dwordx4 v12, s[8:11], s30 offen lds
  v_mfma_f32_16x16x32_bf16 v[148:151], a[48:51], v[188:191], v[148:151]
  ds_read_b128 v[172:175], v15 offset:38912
  v_mfma_f32_16x16x32_bf16 v[152:155], a[52:55], v[188:191], v[152:155]
  v_mfma_f32_16x16x32_bf16 v[156:159], a[56:59], v[188:191], v[156:159]
  s_waitcnt lgkmcnt(3)
  v_mfma_f32_16x16x32_bf16 v[64:67], a[60:63], v[160:163], v[64:67]
  ds_read_b128 v[176:179], v15 offset:40960
  v_mfma_f32_16x16x32_bf16 v[68:71], a[64:67], v[160:163], v[68:71]
  v_mfma_f32_16x16x32_bf16 v[72:75], a[68:71], v[160:163], v[72:75]
  s_waitcnt lgkmcnt(3)
  v_mfma_f32_16x16x32_bf16 v[76:79], a[60:63], v[164:167], v[76:79]
  ds_read_b128 v[180:183], v15 offset:43008
  v_mfma_f32_16x16x32_bf16 v[80:83], a[64:67], v[164:167], v[80:83]
  s_add_u32 m0, s31, 3072
  v_mfma_f32_16x16x32_bf16 v[84:87], a[68:71], v[164:167], v[84:87]
  s_waitcnt lgkmcnt(3)
  buffer_load_dwordx4 v13, s[8:11], s30 offen lds
  v_mfma_f32_16x16x32_bf16 v[88:91], a[60:63], v[168:171], v[88:91]
  s_add_u32 s30, s30, 128
  ds_read_b128 v[184:187], v15 offset:45056
  v_mfma_f32_16x16x32_bf16 v[92:95], a[64:67], v[168:171], v[92:95]
  v_mfma_f32_16x16x32_bf16 v[96:99], a[68:71], v[168:171], v[96:99]
  s_waitcnt lgkmcnt(3)
  v_mfma_f32_16x16x32_bf16 v[100:103], a[60:63], v[172:175], v[100:103]
  ds_read_b128 v[188:191], v15 offset:47104
  v_mfma_f32_16x16x32_bf16 v[104:107], a[64:67], v[172:175], v[104:107]
  v_mfma_f32_16x16x32_bf16 v[108:111], a[68:71], v[172:175], v[108:111]
  s_waitcnt lgkmcnt(3)
  v_mfma_f32_16x16x32_bf16 v[112:115], a[60:63], v[176:179], v[112:115]
  s_waitcnt vmcnt(26)
  s_barrier
  ds_read_b128 v[160:163], v14 offset:49152
  v_mfma_f32_16x16x32_bf16 v[116:119], a[64:67], v[176:179], v[116:119]
  v_mfma_f32_16x16x32_bf16 v[120:123], a[68:71], v[176:179], v[120:123]
  s_waitcnt lgkmcnt(3)
  v_mfma_f32_16x16x32_bf16 v[124:127], a[60:63], v[180:183], v[124:127]
  ds_read_b128 v[164:167], v14 offset:51200
  v_mfma_f32_16x16x32_bf16 v[128:131], a[64:67], v[180:183], v[128:131]
  v_mfma_f32_16x16x32_bf16 v[132:135], a[68:71], v[180:183], v[132:135]
  s_waitcnt lgkmcnt(3)
  v_mfma_f32_16x16x32_bf16 v[136:139], a[60:63], v[184:187], v[136:139]
  ds_read_b128 v[168:171], v14 offset:53248
  v_mfma_f32_16x16x32_bf16 v[140:143], a[64:67], v[184:187], v[140:143]
  v_mfma_f32_16x16x32_bf16 v[144:147], a[68:71], v[184:187], v[144:147]
  s_waitcnt lgkmcnt(3)
  v_mfma_f32_16x16x32_bf16 v[148:151], a[60:63], v[188:191], v[148:151]
  ds_read_b128 v[172:175], v14 offset:55296
  v_mfma_f32_16x16x32_bf16 v[152:155], a[64:67], v[188:191], v[152:155]
  v_mfma_f32_16x16x32_bf16 v[156:159], a[68:71], v[188:191], v[156:159]
  s_waitcnt lgkmcnt(3)
  v_mfma_f32_16x16x32_bf16 v[64:67], a[72:75], v[160:163], v[64:67]
  ds_read_b128 v[176:179], v14 offset:57344
  v_mfma_f32_16x16x32_bf16 v[68:71], a[76:79], v[160:163], v[68:71]
  s_add_u32 m0, s31, 16384
  v_mfma_f32_16x16x32_bf16 v[72:75], a[80:83], v[160:163], v[72:75]
  s_waitcnt lgkmcnt(3)
  buffer_load_dwordx4 v10, s[8:11], s30 offen lds
  v_mfma_f32_16x16x32_bf16 v[76:79], a[72:75], v[164:167], v[76:79]
  ds_read_b128 v[180:183], v14 offset:59392
  v_mfma_f32_16x16x32_bf16 v[80:83], a[76:79], v[164:167], v[80:83]
  v_mfma_f32_16x16x32_bf16 v[84:87], a[80:83], v[164:167], v[84:87]
  s_waitcnt lgkmcnt(3)
  v_mfma_f32_16x16x32_bf16 v[88:91], a[72:75], v[168:171], v[88:91]
  ds_read_b128 v[184:187], v14 offset:61440
  v_mfma_f32_16x16x32_bf16 v[92:95], a[76:79], v[168:171], v[92:95]
  v_mfma_f32_16x16x32_bf16 v[96:99], a[80:83], v[168:171], v[96:99]
  s_waitcnt lgkmcnt(3)
  v_mfma_f32_16x16x32_bf16 v[100:103], a[72:75], v[172:175], v[100:103]
  ds_read_b128 v[188:191], v14 offset:63488
  v_mfma_f32_16x16x32_bf16 v[104:107], a[76:79], v[172:175], v[104:107]
  s_add_u32 m0, s31, 17408
  v_mfma_f32_16x16x32_bf16 v[108:111], a[80:83], v[172:175], v[108:111]
  s_waitcnt lgkmcnt(3)
  buffer_load_dwordx4 v11, s[8:11], s30 offen lds
  v_mfma_f32_16x16x32_bf16 v[112:115], a[72:75], v[176:179], v[112:115]
  ds_read_b128 v[160:163], v15 offset:49152
  v_mfma_f32_16x16x32_bf16 v[116:119], a[76:79], v[176:179], v[116:119]
  v_mfma_f32_16x16x32_bf16 v[120:123], a[80:83], v[176:179], v[120:123]
  s_waitcnt lgkmcnt(3)
  v_mfma_f32_16x16x32_bf16 v[124:127], a[72:75], v[180:183], v[124:127]
  ds_read_b128 v[164:167], v15 offset:51200
  v_mfma_f32_16x16x32_bf16 v[128:131], a[76:79], v[180:183], v[128:131]
  v_mfma_f32_16x16x32_bf16 v[132:135], a[80:83], v[180:183], v[132:135]
  s_waitcnt lgkmcnt(3)
  v_mfma_f32_16x16x32_bf16 v[136:139], a[72:75], v[184:187], v[136:139]
  ds_read_b128 v[168:171], v15 offset:53248
  v_mfma_f32_16x16x32_bf16 v[140:143], a[76:79], v[184:187], v[140:143]
  s_add_u32 m0, s31, 18432
  v_mfma_f32_16x16x32_bf16 v[144:147], a[80:83], v[184:187], v[144:147]
  s_waitcnt lgkmcnt(3)
  buffer_load_dwordx4 v12, s[8:11], s30 offen lds
  v_mfma_f32_16x16x32_bf16 v[148:151], a[72:75], v[188:191], v[148:151]
  ds_read_b128 v[172:175], v15 offset:55296
  v_mfma_f32_16x16x32_bf16 v[152:155], a[76:79], v[188:191], v[152:155]
  v_mfma_f32_16x16x32_bf16 v[156:159], a[80:83], v[188:191], v[156:159]
  s_waitcnt lgkmcnt(3)
  v_mfma_f32_16x16x32_bf16 v[64:67], a[84:87], v[160:163], v[64:67]
  ds_read_b128 v[176:179], v15 offset:57344
  v_mfma_f32_16x16x32_bf16 v[68:71], a[88:91], v[160:163], v[68:71]
  v_mfma_f32_16x16x32_bf16 v[72:75], a[92:95], v[160:163], v[72:75]
  s_waitcnt lgkmcnt(3)
  v_mfma_f32_16x16x32_bf16 v[76:79], a[84:87], v[164:167], v[76:79]
  ds_read_b128 v[180:183], v15 offset:59392
  v_mfma_f32_16x16x32_bf16 v[80:83], a[88:91], v[164:167], v[80:83]
  s_add_u32 m0, s31, 19456
  v_mfma_f32_16x16x32_bf16 v[84:87], a[92:95], v[164:167], v[84:87]
  s_waitcnt lgkmcnt(3)
  buffer_load_dwordx4 v13, s[8:11], s30 offen lds
  v_mfma_f32_16x16x32_bf16 v[88:91], a[84:87], v[168:171], v[88:91]
  s_add_u32 s30, s30, 128
  ds_read_b128 v[184:187], v15 offset:61440
  v_mfma_f32_16x16x32_bf16 v[92:95], a[88:91], v[168:171], v[92:95]
  v_mfma_f32_16x16x32_bf16 v[96:99], a[92:95], v[168:171], v[96:99]
  s_waitcnt lgkmcnt(3)
  v_mfma_f32_16x16x32_bf16 v[100:103], a[84:87], v[172:175], v[100:103]
  ds_read_b128 v[188:191], v15 offset:63488
  v_mfma_f32_16x16x32_bf16 v[104:107], a[88:91], v[172:175], v[104:107]
  v_mfma_f32_16x16x32_bf16 v[108:111], a[92:95], v[172:175], v[108:111]
  s_waitcnt lgkmcnt(3)
  v_mfma_f32_16x16x32_bf16 v[112:115], a[84:87], v[176:179], v[112:115]
  s_waitcnt vmcnt(18)
  s_barrier
  ds_read_b128 v[160:163], v16 offset:0
  v_mfma_f32_16x16x32_bf16 v[116:119], a[88:91], v[176:179], v[116:119]
  v_mfma_f32_16x16x32_bf16 v[120:123], a[92:95], v[176:179], v[120:123]
  s_waitcnt lgkmcnt(3)
  v_mfma_f32_16x16x32_bf16 v[124:127], a[84:87], v[180:183], v[124:127]
  ds_read_b128 v[164:167], v16 offset:2048
  v_mfma_f32_16x16x32_bf16 v[128:131], a[88:91], v[180:183], v[128:131]
  v_mfma_f32_16x16x32_bf16 v[132:135], a[92:95], v[180:183], v[132:135]
  s_waitcnt lgkmcnt(3)
  v_mfma_f32_16x16x32_bf16 v[136:139], a[84:87], v[184:187], v[136:139]
  ds_read_b128 v[168:171], v16 offset:4096
  v_mfma_f32_16x16x32_bf16 v[140:143], a[88:91], v[184:187], v[140:143]
  v_mfma_f32_16x16x32_bf16 v[144:147], a[92:95], v[184:187], v[144:147]
  s_waitcnt lgkmcnt(3)
  v_mfma_f32_16x16x32_bf16 v[148:151], a[84:87], v[188:191], v[148:151]
  ds_read_b128 v[172:175], v16 offset:6144
  v_mfma_f32_16x16x32_bf16 v[152:155], a[88:91], v[188:191], v[152:155]
  v_mfma_f32_16x16x32_bf16 v[156:159], a[92:95], v[188:191], v[156:159]
  s_waitcnt lgkmcnt(3)
  v_mfma_f32_16x16x32_bf16 v[64:67], a[96:99], v[160:163], v[64:67]
  ds_read_b128 v[176:179], v16 offset:8192
  v_mfma_f32_16x16x32_bf16 v[68:71], a[100:103], v[160:163], v[68:71]
  s_add_u32 m0, s31, 32768
  v_mfma_f32_16x16x32_bf16 v[72:75], a[104:107], v[160:163], v[72:75]
  s_waitcnt lgkmcnt(3)
  buffer_load_dwordx4 v10, s[8:11], s30 offen lds
  v_mfma_f32_16x16x32_bf16 v[76:79], a[96:99], v[164:167], v[76:79]
  ds_read_b128 v[180:183], v16 offset:10240
  v_mfma_f32_16x16x32_bf16 v[80:83], a[100:103], v[164:167], v[80:83]
  v_mfma_f32_16x16x32_bf16 v[84:87], a[104:107], v[164:167], v[84:87]
  s_waitcnt lgkmcnt(3)
  v_mfma_f32_16x16x32_bf16 v[88:91], a[96:99], v[168:171], v[88:91]
  ds_read_b128 v[184:187], v16 offset:12288
  v_mfma_f32_16x16x32_bf16 v[92:95], a[100:103], v[168:171], v[92:95]
  v_mfma_f32_16x16x32_bf16 v[96:99], a[104:107], v[168:171], v[96:99]
  s_waitcnt lgkmcnt(3)
  v_mfma_f32_16x16x32_bf16 v[100:103], a[96:99], v[172:175], v[100:103]
  ds_read_b128 v[188:191], v16 offset:14336
  v_mfma_f32_16x16x32_bf16 v[104:107], a[100:103], v[172:175], v[104:107]
  s_add_u32 m0, s31, 33792
  v_mfma_f32_16x16x32_bf16 v[108:111], a[104:107], v[172:175], v[108:111]
  s_waitcnt lgkmcnt(3)
  buffer_load_dwordx4 v11, s[8:11], s30 offen lds
  v_mfma_f32_16x16x32_bf16 v[112:115], a[96:99], v[176:179], v[112:115]
  ds_read_b128 v[160:163], v17 offset:0
  v_mfma_f32_16x16x32_bf16 v[116:119], a[100:103], v[176:179], v[116:119]
  v_mfma_f32_16x16x32_bf16 v[120:123], a[104:107], v[176:179], v[120:123]
  s_waitcnt lgkmcnt(3)
  v_mfma_f32_16x16x32_bf16 v[124:127], a[96:99], v[180:183], v[124:127]
  ds_read_b128 v[164:167], v17 offset:2048
  v_mfma_f32_16x16x32_bf16 v[128:131], a[100:103], v[180:183], v[128:131]
  v_mfma_f32_16x16x32_bf16 v[132:135], a[104:107], v[180:183], v[132:135]
  s_waitcnt lgkmcnt(3)
  v_mfma_f32_16x16x32_bf16 v[136:139], a[96:99], v[184:187], v[136:139]
  ds_read_b128 v[168:171], v17 offset:4096
  v_mfma_f32_16x16x32_bf16 v[140:143], a[100:103], v[184:187], v[140:143]
  s_add_u32 m0, s31, 34816
  v_mfma_f32_16x16x32_bf16 v[144:147], a[104:107], v[184:187], v[144:147]
  s_waitcnt lgkmcnt(3)
  buffer_load_dwordx4 v12, s[8:11], s30 offen lds
  v_mfma_f32_16x16x32_bf16 v[148:151], a[96:99], v[188:191], v[148:151]
  ds_read_b128 v[172:175], v17 offset:6144
  v_mfma_f32_16x16x32_bf16 v[152:155], a[100:103], v[188:191], v[152:155]
  v_mfma_f32_16x16x32_bf16 v[156:159], a[104:107], v[188:191], v[156:159]
  s_waitcnt lgkmcnt(3)
  v_mfma_f32_16x16x32_bf16 v[64:67], a[108:111], v[160:163], v[64:67]
  ds_read_b128 v[176:179], v17 offset:8192
  v_mfma_f32_16x16x32_bf16 v[68:71], a[112:115], v[160:163], v[68:71]
  v_mfma_f32_16x16x32_bf16 v[72:75], a[116:119], v[160:163], v[72:75]
  s_waitcnt lgkmcnt(3)
  v_mfma_f32_16x16x32_bf16 v[76:79], a[108:111], v[164:167], v[76:79]
  ds_read_b128 v[180:183], v17 offset:10240
  v_mfma_f32_16x16x32_bf16 v[80:83], a[112:115], v[164:167], v[80:83]
  s_add_u32 m0, s31, 35840
  v_mfma_f32_16x16x32_bf16 v[84:87], a[116:119], v[164:167], v[84:87]
  s_waitcnt lgkmcnt(3)
  buffer_load_dwordx4 v13, s[8:11], s30 offen lds
  v_mfma_f32_16x16x32_bf16 v[88:91], a[108:111], v[168:171], v[88:91]
  s_add_u32 s30, s30, 128
  ds_read_b128 v[184:187], v17 offset:12288
  v_mfma_f32_16x16x32_bf16 v[92:95], a[112:115], v[168:171], v[92:95]
  v_mfma_f32_16x16x32_bf16 v[96:99], a[116:119], v[168:171], v[96:99]
  s_waitcnt lgkmcnt(3)
  v_mfma_f32_16x16x32_bf16 v[100:103], a[108:111], v[172:175], v[100:103]
  ds_read_b128 v[188:191], v17 offset:14336
  v_mfma_f32_16x16x32_bf16 v[104:107], a[112:115], v[172:175], v[104:107]
  v_mfma_f32_16x16x32_bf16 v[108:111], a[116:119], v[172:175], v[108:111]
  s_waitcnt lgkmcnt(3)
  v_mfma_f32_16x16x32_bf16 v[112:115], a[108:111], v[176:179], v[112:115]
  s_waitcnt vmcnt(8)
  s_barrier
  ds_read_b128 v[160:163], v14 offset:0
  v_mfma_f32_16x16x32_bf16 v[116:119], a[112:115], v[176:179], v[116:119]
  v_mfma_f32_16x16x32_bf16 v[120:123], a[116:119], v[176:179], v[120:123]
  s_waitcnt lgkmcnt(3)
  v_mfma_f32_16x16x32_bf16 v[124:127], a[108:111], v[180:183], v[124:127]
  ds_read_b128 v[164:167], v14 offset:2048
  v_mfma_f32_16x16x32_bf16 v[128:131], a[112:115], v[180:183], v[128:131]
  v_mfma_f32_16x16x32_bf16 v[132:135], a[116:119], v[180:183], v[132:135]
  s_waitcnt lgkmcnt(3)
  v_mfma_f32_16x16x32_bf16 v[136:139], a[108:111], v[184:187], v[136:139]
  ds_read_b128 v[168:171], v14 offset:4096
  v_mfma_f32_16x16x32_bf16 v[140:143], a[112:115], v[184:187], v[140:143]
  v_mfma_f32_16x16x32_bf16 v[144:147], a[116:119], v[184:187], v[144:147]
  s_waitcnt lgkmcnt(3)
  v_mfma_f32_16x16x32_bf16 v[148:151], a[108:111], v[188:191], v[148:151]
  ds_read_b128 v[172:175], v14 offset:6144
  v_mfma_f32_16x16x32_bf16 v[152:155], a[112:115], v[188:191], v[152:155]
  v_mfma_f32_16x16x32_bf16 v[156:159], a[116:119], v[188:191], v[156:159]
  s_waitcnt lgkmcnt(3)
  v_mfma_f32_16x16x32_bf16 v[64:67], a[120:123], v[160:163], v[64:67]
  ds_read_b128 v[176:179], v14 offset:8192
  v_mfma_f32_16x16x32_bf16 v[68:71], a[124:127], v[160:163], v[68:71]
  s_add_u32 m0, s31, 49152
  v_mfma_f32_16x16x32_bf16 v[72:75], a[128:131], v[160:163], v[72:75]
  s_waitcnt lgkmcnt(3)
  buffer_load_dwordx4 v10, s[8:11], s30 offen lds
  v_mfma_f32_16x16x32_bf16 v[76:79], a[120:123], v[164:167], v[76:79]
  ds_read_b128 v[180:183], v14 offset:10240
  s_waitcnt vmcnt(11)
  v_mfma_f32_16x16x32_bf16 v[80:83], a[124:127], v[164:167], v[80:83]
  v_swap_b32 v226, v228
  v_swap_b32 v227, v229
  v_mfma_f32_16x16x32_bf16 v[84:87], a[128:131], v[164:167], v[84:87]
  s_waitcnt lgkmcnt(3)
  v_swap_b32 v234, v236
  v_swap_b32 v235, v237
  v_mfma_f32_16x16x32_bf16 v[88:91], a[120:123], v[168:171], v[88:91]
  ds_read_b128 v[184:187], v14 offset:12288
  v_mfma_f32_16x16x32_bf16 v[92:95], a[124:127], v[168:171], v[92:95]
  ds_read_b128 v[56:59], v21 offset:0
  ds_read_b128 v[60:63], v21 offset:1024
  v_mfma_f32_16x16x32_bf16 v[96:99], a[128:131], v[168:171], v[96:99]
  s_waitcnt lgkmcnt(5)
  v_mfma_f32_16x16x32_bf16 v[100:103], a[120:123], v[172:175], v[100:103]
  ds_read_b128 v[188:191], v14 offset:14336
  v_mfma_f32_16x16x32_bf16 v[104:107], a[124:127], v[172:175], v[104:107]
  s_add_u32 m0, s31, 50176
  v_mfma_f32_16x16x32_bf16 v[108:111], a[128:131], v[172:175], v[108:111]
  s_waitcnt lgkmcnt(5)
  buffer_load_dwordx4 v11, s[8:11], s30 offen lds
  v_mfma_f32_16x16x32_bf16 v[112:115], a[120:123], v[176:179], v[112:115]
  ds_read_b128 v[160:163], v15 offset:0
  v_mfma_f32_16x16x32_bf16 v[116:119], a[124:127], v[176:179], v[116:119]
  ds_read_b128 v[248:251], v21 offset:3072
  ds_read_b128 v[252:255], v21 offset:4096
  v_mfma_f32_16x16x32_bf16 v[120:123], a[128:131], v[176:179], v[120:123]
  s_waitcnt lgkmcnt(4)
  v_mfma_f32_16x16x32_bf16 v[36:39], v[192:195], v[56:59], 0
  v_mfma_f32_16x16x32_bf16 v[44:47], v[192:195], v[60:63], 0
  v_mfma_f32_16x16x32_bf16 v[48:51], v[196:199], v[60:63], 0
  v_mfma_f32_16x16x32_bf16 v[40:43], a[240:243], v[56:59], 0
  v_mfma_f32_16x16x32_bf16 v[52:55], a[240:243], v[60:63], 0
  s_waitcnt lgkmcnt(7)
  ds_read2st64_b64 v[56:59], v22 offset0:0 offset1:6
  ds_read2st64_b64 v[60:63], v23 offset0:0 offset1:6
  v_mfma_f32_16x16x32_bf16 v[124:127], a[120:123], v[180:183], v[124:127]
  ds_read_b128 v[164:167], v15 offset:2048
  v_mfma_f32_16x16x32_bf16 v[128:131], a[124:127], v[180:183], v[128:131]
  v_mfma_f32_16x16x32_bf16 v[132:135], a[128:131], v[180:183], v[132:135]
  s_waitcnt lgkmcnt(9)
  v_mfma_f32_16x16x32_bf16 v[136:139], a[120:123], v[184:187], v[136:139]
  ds_read_b128 v[168:171], v15 offset:4096
  v_mfma_f32_16x16x32_bf16 v[140:143], a[124:127], v[184:187], v[140:143]
  s_add_u32 m0, s31, 51200
  v_mfma_f32_16x16x32_bf16 v[144:147], a[128:131], v[184:187], v[144:147]
  s_waitcnt lgkmcnt(4)
  buffer_load_dwordx4 v12, s[8:11], s30 offen lds
  v_mfma_f32_16x16x32_bf16 v[36:39], v[200:203], v[248:251], v[36:39]
  v_mfma_f32_16x16x32_bf16 v[44:47], v[200:203], v[252:255], v[44:47]
  v_mfma_f32_16x16x32_bf16 v[48:51], v[204:207], v[252:255], v[48:51]
  v_mfma_f32_16x16x32_bf16 v[40:43], a[244:247], v[248:251], v[40:43]
  v_mfma_f32_16x16x32_bf16 v[52:55], a[244:247], v[252:255], v[52:55]
  s_waitcnt lgkmcnt(7)
  ds_read_b128 v[248:251], v21 offset:6144
  ds_read_b128 v[252:255], v21 offset:7168
  v_mfma_f32_16x16x32_bf16 v[148:151], a[120:123], v[188:191], v[148:151]
  ds_read_b128 v[172:175], v15 offset:6144
  v_mfma_f32_16x16x32_bf16 v[152:155], a[124:127], v[188:191], v[152:155]
  v_mfma_f32_16x16x32_bf16 v[156:159], a[128:131], v[188:191], v[156:159]
  s_waitcnt lgkmcnt(9)
  v_mfma_f32_16x16x32_bf16 v[64:67], a[132:135], v[160:163], v[64:67]
  ds_read_b128 v[176:179], v15 offset:8192
  v_mfma_f32_16x16x32_bf16 v[68:71], a[136:139], v[160:163], v[68:71]
  v_mfma_f32_16x16x32_bf16 v[72:75], a[140:143], v[160:163], v[72:75]
  s_waitcnt lgkmcnt(6)
  v_mfma_f32_16x16x32_bf16 v[36:39], v[224:227], v[56:59], v[36:39]
  v_mfma_f32_16x16x32_bf16 v[44:47], v[224:227], v[60:63], v[44:47]
  v_mfma_f32_16x16x32_bf16 v[48:51], v[228:231], v[60:63], v[48:51]
  v_mfma_f32_16x16x32_bf16 v[40:43], v[240:243], v[56:59], v[40:43]
  v_mfma_f32_16x16x32_bf16 v[52:55], v[240:243], v[60:63], v[52:55]
  s_waitcnt lgkmcnt(5)
  ds_read_b128 v[56:59], v21 offset:9216
  ds_read_b128 v[60:63], v21 offset:10240
  v_mfma_f32_16x16x32_bf16 v[76:79], a[132:135], v[164:167], v[76:79]
  ds_read_b128 v[180:183], v15 offset:10240
  v_mfma_f32_16x16x32_bf16 v[80:83], a[136:139], v[164:167], v[80:83]
  s_add_u32 m0, s31, 52224
  v_mfma_f32_16x16x32_bf16 v[84:87], a[140:143], v[164:167], v[84:87]
  s_waitcnt lgkmcnt(7)
  buffer_load_dwordx4 v13, s[8:11], s30 offen lds
  v_mfma_f32_16x16x32_bf16 v[88:91], a[132:135], v[168:171], v[88:91]
  s_add_u32 s30, s30, 128
  ds_read_b128 v[184:187], v15 offset:12288
  v_mfma_f32_16x16x32_bf16 v[92:95], a[136:139], v[168:171], v[92:95]
  v_mfma_f32_16x16x32_bf16 v[96:99], a[140:143], v[168:171], v[96:99]
  s_waitcnt lgkmcnt(6)
  v_mfma_f32_16x16x32_bf16 v[36:39], v[208:211], v[248:251], v[36:39]
  v_mfma_f32_16x16x32_bf16 v[44:47], v[208:211], v[252:255], v[44:47]
  v_mfma_f32_16x16x32_bf16 v[48:51], v[212:215], v[252:255], v[48:51]
  v_mfma_f32_16x16x32_bf16 v[40:43], a[248:251], v[248:251], v[40:43]
  v_mfma_f32_16x16x32_bf16 v[52:55], a[248:251], v[252:255], v[52:55]
  s_waitcnt lgkmcnt(5)
  ds_read2st64_b64 v[248:251], v22 offset0:12 offset1:18
  ds_read2st64_b64 v[252:255], v23 offset0:12 offset1:18
  v_mfma_f32_16x16x32_bf16 v[100:103], a[132:135], v[172:175], v[100:103]
  ds_read_b128 v[188:191], v15 offset:14336
  v_mfma_f32_16x16x32_bf16 v[104:107], a[136:139], v[172:175], v[104:107]
  v_mfma_f32_16x16x32_bf16 v[108:111], a[140:143], v[172:175], v[108:111]
  s_waitcnt lgkmcnt(7)
  v_mfma_f32_16x16x32_bf16 v[112:115], a[132:135], v[176:179], v[112:115]
  s_waitcnt vmcnt(8)
  s_barrier
  ds_read_b128 v[160:163], v14 offset:16384
  v_mfma_f32_16x16x32_bf16 v[116:119], a[136:139], v[176:179], v[116:119]
  v_mfma_f32_16x16x32_bf16 v[120:123], a[140:143], v[176:179], v[120:123]
  s_waitcnt lgkmcnt(6)
  v_mfma_f32_16x16x32_bf16 v[36:39], v[216:219], v[56:59], v[36:39]
  v_mfma_f32_16x16x32_bf16 v[44:47], v[216:219], v[60:63], v[44:47]
  v_mfma_f32_16x16x32_bf16 v[48:51], v[220:223], v[60:63], v[48:51]
  v_mfma_f32_16x16x32_bf16 v[40:43], a[252:255], v[56:59], v[40:43]
  v_mfma_f32_16x16x32_bf16 v[52:55], a[252:255], v[60:63], v[52:55]
  s_waitcnt lgkmcnt(5)
  v_mfma_f32_16x16x32_bf16 v[124:127], a[132:135], v[180:183], v[124:127]
  ds_read_b128 v[164:167], v14 offset:18432
  v_mfma_f32_16x16x32_bf16 v[128:131], a[136:139], v[180:183], v[128:131]
  v_mfma_f32_16x16x32_bf16 v[132:135], a[140:143], v[180:183], v[132:135]
  s_waitcnt lgkmcnt(5)
  v_mfma_f32_16x16x32_bf16 v[136:139], a[132:135], v[184:187], v[136:139]
  ds_read_b128 v[168:171], v14 offset:20480
  v_mfma_f32_16x16x32_bf16 v[140:143], a[136:139], v[184:187], v[140:143]
  v_mfma_f32_16x16x32_bf16 v[144:147], a[140:143], v[184:187], v[144:147]
  s_waitcnt lgkmcnt(4)
  v_mfma_f32_16x16x32_bf16 v[36:39], v[232:235], v[248:251], v[36:39]
  v_mfma_f32_16x16x32_bf16 v[44:47], v[232:235], v[252:255], v[44:47]
  v_mfma_f32_16x16x32_bf16 v[48:51], v[236:239], v[252:255], v[48:51]
  v_mfma_f32_16x16x32_bf16 v[40:43], v[244:247], v[248:251], v[40:43]
  v_mfma_f32_16x16x32_bf16 v[52:55], v[244:247], v[252:255], v[52:55]
  s_waitcnt lgkmcnt(3)
  v_mfma_f32_16x16x32_bf16 v[148:151], a[132:135], v[188:191], v[148:151]
  ds_read_b128 v[172:175], v14 offset:22528
  v_mfma_f32_16x16x32_bf16 v[152:155], a[136:139], v[188:191], v[152:155]
  v_mfma_f32_16x16x32_bf16 v[156:159], a[140:143], v[188:191], v[156:159]
  s_waitcnt lgkmcnt(3)
  v_cndmask_b32 v36, v31, v36, s[64:65]
  v_cndmask_b32 v48, v31, v48, s[64:65]
  v_mfma_f32_16x16x32_bf16 v[64:67], a[144:147], v[160:163], v[64:67]
  ds_read_b128 v[176:179], v14 offset:24576
  v_cndmask_b32 v37, v31, v37, s[66:67]
  v_mfma_f32_16x16x32_bf16 v[68:71], a[148:151], v[160:163], v[68:71]
  s_add_u32 m0, s31, 65536
  v_cndmask_b32 v49, v31, v49, s[66:67]
  v_cndmask_b32 v38, v31, v38, s[68:69]
  v_mfma_f32_16x16x32_bf16 v[72:75], a[152:155], v[160:163], v[72:75]
  s_waitcnt lgkmcnt(3)
  buffer_load_dwordx4 v10, s[8:11], s30 offen lds
  v_cndmask_b32 v50, v31, v50, s[68:69]
  v_mfma_f32_16x16x32_bf16 v[76:79], a[144:147], v[164:167], v[76:79]
  ds_read_b128 v[180:183], v14 offset:26624
  v_cndmask_b32 v39, v31, v39, s[70:71]
  v_mfma_f32_16x16x32_bf16 v[80:83], a[148:151], v[164:167], v[80:83]
  v_cndmask_b32 v51, v31, v51, s[70:71]
  v_max3_f32 v34, v36, v37, v38
  v_mfma_f32_16x16x32_bf16 v[84:87], a[152:155], v[164:167], v[84:87]
  s_waitcnt lgkmcnt(3)
  v_max3_f32 v34, v34, v39, v40
  v_max3_f32 v34, v34, v41, v42
  v_mfma_f32_16x16x32_bf16 v[88:91], a[144:147], v[168:171], v[88:91]
  ds_read_b128 v[184:187], v14 offset:28672
  v_max_f32 v34, v34, v43
  v_mfma_f32_16x16x32_bf16 v[92:95], a[148:151], v[168:171], v[92:95]
  v_mov_b32 v35, v34
  v_mfma_f32_16x16x32_bf16 v[96:99], a[152:155], v[168:171], v[96:99]
  s_waitcnt lgkmcnt(3)
  v_permlane32_swap_b32 v34, v35
  v_max_f32 v34, v34, v35
  v_mfma_f32_16x16x32_bf16 v[100:103], a[144:147], v[172:175], v[100:103]
  ds_read_b128 v[188:191], v14 offset:30720
  v_mov_b32 v35, v34
  v_mfma_f32_16x16x32_bf16 v[104:107], a[148:151], v[172:175], v[104:107]
  s_add_u32 m0, s31, 66560
  v_permlane16_swap_b32 v34, v35
  v_max_f32 v34, v34, v35
  v_mfma_f32_16x16x32_bf16 v[108:111], a[152:155], v[172:175], v[108:111]
  s_waitcnt lgkmcnt(3)
  buffer_load_dwordx4 v11, s[8:11], s30 offen lds
  v_mul_f32 v34, s83, v34
  v_mfma_f32_16x16x32_bf16 v[112:115], a[144:147], v[176:179], v[112:115]
  ds_read_b128 v[160:163], v15 offset:16384
  v_fma_f32 v36, v36, s83, -v34
  v_mfma_f32_16x16x32_bf16 v[116:119], a[148:151], v[176:179], v[116:119]
  v_fma_f32 v37, v37, s83, -v34
  v_fma_f32 v38, v38, s83, -v34
  v_mfma_f32_16x16x32_bf16 v[120:123], a[152:155], v[176:179], v[120:123]
  s_waitcnt lgkmcnt(3)
  v_fma_f32 v39, v39, s83, -v34
  v_fma_f32 v40, v40, s83, -v34
  v_mfma_f32_16x16x32_bf16 v[124:127], a[144:147], v[180:183], v[124:127]
  ds_read_b128 v[164:167], v15 offset:18432
  v_fma_f32 v41, v41, s83, -v34
  v_mfma_f32_16x16x32_bf16 v[128:131], a[148:151], v[180:183], v[128:131]
  v_fma_f32 v42, v42, s83, -v34
  v_fma_f32 v43, v43, s83, -v34
  v_mfma_f32_16x16x32_bf16 v[132:135], a[152:155], v[180:183], v[132:135]
  s_waitcnt lgkmcnt(3)
  v_exp_f32 v36, v36
  v_mfma_f32_16x16x32_bf16 v[136:139], a[144:147], v[184:187], v[136:139]
  ds_read_b128 v[168:171], v15 offset:20480
  v_mfma_f32_16x16x32_bf16 v[140:143], a[148:151], v[184:187], v[140:143]
  s_add_u32 m0, s31, 67584
  v_exp_f32 v37, v37
  v_mfma_f32_16x16x32_bf16 v[144:147], a[152:155], v[184:187], v[144:147]
  s_waitcnt lgkmcnt(3)
  buffer_load_dwordx4 v12, s[8:11], s30 offen lds
  v_mfma_f32_16x16x32_bf16 v[148:151], a[144:147], v[188:191], v[148:151]
  ds_read_b128 v[172:175], v15 offset:22528
  v_mfma_f32_16x16x32_bf16 v[152:155], a[148:151], v[188:191], v[152:155]
  v_exp_f32 v38, v38
  v_mfma_f32_16x16x32_bf16 v[156:159], a[152:155], v[188:191], v[156:159]
  s_waitcnt lgkmcnt(3)
  v_exp_f32 v39, v39
  v_mfma_f32_16x16x32_bf16 v[64:67], a[156:159], v[160:163], v[64:67]
  ds_read_b128 v[176:179], v15 offset:24576
  v_mfma_f32_16x16x32_bf16 v[68:71], a[160:163], v[160:163], v[68:71]
  v_exp_f32 v40, v40
  v_mfma_f32_16x16x32_bf16 v[72:75], a[164:167], v[160:163], v[72:75]
  s_waitcnt lgkmcnt(3)
  v_exp_f32 v41, v41
  v_mfma_f32_16x16x32_bf16 v[76:79], a[156:159], v[164:167], v[76:79]
  ds_read_b128 v[180:183], v15 offset:26624
  v_mfma_f32_16x16x32_bf16 v[80:83], a[160:163], v[164:167], v[80:83]
  s_add_u32 m0, s31, 68608
  v_exp_f32 v42, v42
  v_mfma_f32_16x16x32_bf16 v[84:87], a[164:167], v[164:167], v[84:87]
  s_waitcnt lgkmcnt(3)
  buffer_load_dwordx4 v13, s[8:11], s30 offen lds
  v_mfma_f32_16x16x32_bf16 v[88:91], a[156:159], v[168:171], v[88:91]
  s_add_u32 s30, s30, s25
  ds_read_b128 v[184:187], v15 offset:28672
  v_mfma_f32_16x16x32_bf16 v[92:95], a[160:163], v[168:171], v[92:95]
  v_exp_f32 v43, v43
  v_mfma_f32_16x16x32_bf16 v[96:99], a[164:167], v[168:171], v[96:99]
  s_waitcnt lgkmcnt(3)
  v_add_f32 v34, v40, v41
  v_add_f32 v34, v34, v42
  v_mfma_f32_16x16x32_bf16 v[100:103], a[156:159], v[172:175], v[100:103]
  ds_read_b128 v[188:191], v15 offset:30720
  v_add_f32 v34, v34, v43
  v_mfma_f32_16x16x32_bf16 v[104:107], a[160:163], v[172:175], v[104:107]
  v_cndmask_b32 v34, 0, v34, s[62:63]
  v_add_f32 v34, v34, v36
  v_mfma_f32_16x16x32_bf16 v[108:111], a[164:167], v[172:175], v[108:111]
  s_waitcnt lgkmcnt(3)
  v_add_f32 v34, v34, v37
  v_add_f32 v34, v34, v38
  v_mfma_f32_16x16x32_bf16 v[112:115], a[156:159], v[176:179], v[112:115]
  s_waitcnt vmcnt(8)
  s_barrier
  ds_read_b128 v[160:163], v14 offset:32768
  v_mfma_f32_16x16x32_bf16 v[116:119], a[160:163], v[176:179], v[116:119]
  v_add_f32 v34, v34, v39
  v_mov_b32 v35, v34
  v_mfma_f32_16x16x32_bf16 v[120:123], a[164:167], v[176:179], v[120:123]
  s_waitcnt lgkmcnt(3)
  v_permlane32_swap_b32 v34, v35
  v_add_f32 v34, v34, v35
  v_mfma_f32_16x16x32_bf16 v[124:127], a[156:159], v[180:183], v[124:127]
  ds_read_b128 v[164:167], v14 offset:34816
  v_mov_b32 v35, v34
  v_mfma_f32_16x16x32_bf16 v[128:131], a[160:163], v[180:183], v[128:131]
  v_permlane16_swap_b32 v34, v35
  v_add_f32 v34, v34, v35
  v_mfma_f32_16x16x32_bf16 v[132:135], a[164:167], v[180:183], v[132:135]
  s_waitcnt lgkmcnt(3)
  v_rcp_f32 v34, v34
  v_mfma_f32_16x16x32_bf16 v[136:139], a[156:159], v[184:187], v[136:139]
  ds_read_b128 v[168:171], v14 offset:36864
  v_mul_f32 v36, v36, v34
  v_mfma_f32_16x16x32_bf16 v[140:143], a[160:163], v[184:187], v[140:143]
  v_mul_f32 v37, v37, v34
  v_mul_f32 v38, v38, v34
  v_mfma_f32_16x16x32_bf16 v[144:147], a[164:167], v[184:187], v[144:147]
  s_waitcnt lgkmcnt(3)
  v_mul_f32 v39, v39, v34
  v_mul_f32 v40, v40, v34
  v_mfma_f32_16x16x32_bf16 v[148:151], a[156:159], v[188:191], v[148:151]
  ds_read_b128 v[172:175], v14 offset:38912
  v_mul_f32 v41, v41, v34
  v_mfma_f32_16x16x32_bf16 v[152:155], a[160:163], v[188:191], v[152:155]
  v_mul_f32 v42, v42, v34
  v_mul_f32 v43, v43, v34
  v_mfma_f32_16x16x32_bf16 v[156:159], a[164:167], v[188:191], v[156:159]
  s_waitcnt lgkmcnt(3)
  v_max3_f32 v34, v44, v45, v46
  v_max3_f32 v34, v34, v47, v48
  v_mfma_f32_16x16x32_bf16 v[64:67], a[168:171], v[160:163], v[64:67]
  ds_read_b128 v[176:179], v14 offset:40960
  v_max3_f32 v34, v34, v49, v50
  v_mfma_f32_16x16x32_bf16 v[68:71], a[172:175], v[160:163], v[68:71]
  s_add_u32 m0, s31, 0
  v_max3_f32 v34, v34, v51, v52
  v_max3_f32 v34, v34, v53, v54
  v_mfma_f32_16x16x32_bf16 v[72:75], a[176:179], v[160:163], v[72:75]
  s_waitcnt lgkmcnt(3)
  buffer_load_dwordx4 v10, s[8:11], s30 offen lds
  v_max_f32 v34, v34, v55
  v_mfma_f32_16x16x32_bf16 v[76:79], a[168:171], v[164:167], v[76:79]
  ds_read_b128 v[180:183], v14 offset:43008
  v_mov_b32 v35, v34
  v_mfma_f32_16x16x32_bf16 v[80:83], a[172:175], v[164:167], v[80:83]
  v_permlane32_swap_b32 v34, v35
  v_max_f32 v34, v34, v35
  v_mfma_f32_16x16x32_bf16 v[84:87], a[176:179], v[164:167], v[84:87]
  s_waitcnt lgkmcnt(3)
  v_mov_b32 v35, v34
  v_mfma_f32_16x16x32_bf16 v[88:91], a[168:171], v[168:171], v[88:91]
  ds_read_b128 v[184:187], v14 offset:45056
  v_permlane16_swap_b32 v34, v35
  v_mfma_f32_16x16x32_bf16 v[92:95], a[172:175], v[168:171], v[92:95]
  v_max_f32 v34, v34, v35
  v_mul_f32 v34, s83, v34
  v_mfma_f32_16x16x32_bf16 v[96:99], a[176:179], v[168:171], v[96:99]
  s_waitcnt lgkmcnt(3)
  v_fma_f32 v44, v44, s83, -v34
  v_fma_f32 v45, v45, s83, -v34
  v_mfma_f32_16x16x32_bf16 v[100:103], a[168:171], v[172:175], v[100:103]
  ds_read_b128 v[188:191], v14 offset:47104
  v_fma_f32 v46, v46, s83, -v34
  v_mfma_f32_16x16x32_bf16 v[104:107], a[172:175], v[172:175], v[104:107]
  s_add_u32 m0, s31, 1024
  v_fma_f32 v47, v47, s83, -v34
  v_fma_f32 v48, v48, s83, -v34
  v_mfma_f32_16x16x32_bf16 v[108:111], a[176:179], v[172:175], v[108:111]
  s_waitcnt lgkmcnt(3)
  buffer_load_dwordx4 v11, s[8:11], s30 offen lds
  v_fma_f32 v49, v49, s83, -v34
  v_mfma_f32_16x16x32_bf16 v[112:115], a[168:171], v[176:179], v[112:115]
  ds_read_b128 v[160:163], v15 offset:32768
  v_fma_f32 v50, v50, s83, -v34
  v_mfma_f32_16x16x32_bf16 v[116:119], a[172:175], v[176:179], v[116:119]
  v_fma_f32 v51, v51, s83, -v34
  v_fma_f32 v52, v52, s83, -v34
  v_mfma_f32_16x16x32_bf16 v[120:123], a[176:179], v[176:179], v[120:123]
  s_waitcnt lgkmcnt(3)
  v_fma_f32 v53, v53, s83, -v34
  v_fma_f32 v54, v54, s83, -v34
  v_mfma_f32_16x16x32_bf16 v[124:127], a[168:171], v[180:183], v[124:127]
  ds_read_b128 v[164:167], v15 offset:34816
  v_fma_f32 v55, v55, s83, -v34
  v_mfma_f32_16x16x32_bf16 v[128:131], a[172:175], v[180:183], v[128:131]
  v_exp_f32 v44, v44
  v_mfma_f32_16x16x32_bf16 v[132:135], a[176:179], v[180:183], v[132:135]
  s_waitcnt lgkmcnt(3)
  v_exp_f32 v45, v45
  v_mfma_f32_16x16x32_bf16 v[136:139], a[168:171], v[184:187], v[136:139]
  ds_read_b128 v[168:171], v15 offset:36864
  v_mfma_f32_16x16x32_bf16 v[140:143], a[172:175], v[184:187], v[140:143]
  s_add_u32 m0, s31, 2048
  v_exp_f32 v46, v46
  v_mfma_f32_16x16x32_bf16 v[144:147], a[176:179], v[184:187], v[144:147]
  s_waitcnt lgkmcnt(3)
  buffer_load_dwordx4 v12, s[8:11], s30 offen lds
  v_mfma_f32_16x16x32_bf16 v[148:151], a[168:171], v[188:191], v[148:151]
  ds_read_b128 v[172:175], v15 offset:38912
  v_mfma_f32_16x16x32_bf16 v[152:155], a[172:175], v[188:191], v[152:155]
  v_exp_f32 v47, v47
  v_mfma_f32_16x16x32_bf16 v[156:159], a[176:179], v[188:191], v[156:159]
  s_waitcnt lgkmcnt(3)
  v_exp_f32 v48, v48
  v_mfma_f32_16x16x32_bf16 v[64:67], a[180:183], v[160:163], v[64:67]
  ds_read_b128 v[176:179], v15 offset:40960
  v_mfma_f32_16x16x32_bf16 v[68:71], a[184:187], v[160:163], v[68:71]
  v_exp_f32 v49, v49
  v_mfma_f32_16x16x32_bf16 v[72:75], a[188:191], v[160:163], v[72:75]
  s_waitcnt lgkmcnt(3)
  v_exp_f32 v50, v50
  v_mfma_f32_16x16x32_bf16 v[76:79], a[180:183], v[164:167], v[76:79]
  ds_read_b128 v[180:183], v15 offset:43008
  v_mfma_f32_16x16x32_bf16 v[80:83], a[184:187], v[164:167], v[80:83]
  s_add_u32 m0, s31, 3072
  v_exp_f32 v51, v51
  v_mfma_f32_16x16x32_bf16 v[84:87], a[188:191], v[164:167], v[84:87]
  s_waitcnt lgkmcnt(3)
  buffer_load_dwordx4 v13, s[8:11], s30 offen lds
  v_mfma_f32_16x16x32_bf16 v[88:91], a[180:183], v[168:171], v[88:91]
  s_add_u32 s30, s30, 128
  ds_read_b128 v[184:187], v15 offset:45056
  v_mfma_f32_16x16x32_bf16 v[92:95], a[184:187], v[168:171], v[92:95]
  v_exp_f32 v52, v52
  v_mfma_f32_16x16x32_bf16 v[96:99], a[188:191], v[168:171], v[96:99]
  s_waitcnt lgkmcnt(3)
  v_exp_f32 v53, v53
  v_mfma_f32_16x16x32_bf16 v[100:103], a[180:183], v[172:175], v[100:103]
  ds_read_b128 v[188:191], v15 offset:47104
  v_mfma_f32_16x16x32_bf16 v[104:107], a[184:187], v[172:175], v[104:107]
  v_exp_f32 v54, v54
  v_mfma_f32_16x16x32_bf16 v[108:111], a[188:191], v[172:175], v[108:111]
  s_waitcnt lgkmcnt(3)
  v_exp_f32 v55, v55
  v_mfma_f32_16x16x32_bf16 v[112:115], a[180:183], v[176:179], v[112:115]
  s_waitcnt vmcnt(8)
  s_barrier
  ds_read_b128 v[160:163], v14 offset:49152
  v_mfma_f32_16x16x32_bf16 v[116:119], a[184:187], v[176:179], v[116:119]
  v_add_f32 v34, v52, v53
  v_add_f32 v34, v34, v54
  v_mfma_f32_16x16x32_bf16 v[120:123], a[188:191], v[176:179], v[120:123]
  s_waitcnt lgkmcnt(3)
  v_add_f32 v34, v34, v55
  v_cndmask_b32 v34, 0, v34, s[62:63]
  v_mfma_f32_16x16x32_bf16 v[124:127], a[180:183], v[180:183], v[124:127]
  ds_read_b128 v[164:167], v14 offset:51200
  v_add_f32 v34, v34, v44
  v_mfma_f32_16x16x32_bf16 v[128:131], a[184:187], v[180:183], v[128:131]
  v_add_f32 v34, v34, v45
  v_add_f32 v34, v34, v46
  v_mfma_f32_16x16x32_bf16 v[132:135], a[188:191], v[180:183], v[132:135]
  s_waitcnt lgkmcnt(3)
  v_add_f32 v34, v34, v47
  v_add_f32 v34, v34, v48
  v_mfma_f32_16x16x32_bf16 v[136:139], a[180:183], v[184:187], v[136:139]
  ds_read_b128 v[168:171], v14 offset:53248
  v_add_f32 v34, v34, v49
  v_mfma_f32_16x16x32_bf16 v[140:143], a[184:187], v[184:187], v[140:143]
  v_add_f32 v34, v34, v50
  v_add_f32 v34, v34, v51
  v_mfma_f32_16x16x32_bf16 v[144:147], a[188:191], v[184:187], v[144:147]
  s_waitcnt lgkmcnt(3)
  v_mov_b32 v35, v34
  v_mfma_f32_16x16x32_bf16 v[148:151], a[180:183], v[188:191], v[148:151]
  ds_read_b128 v[172:175], v14 offset:55296
  v_permlane32_swap_b32 v34, v35
  v_mfma_f32_16x16x32_bf16 v[152:155], a[184:187], v[188:191], v[152:155]
  v_add_f32 v34, v34, v35
  v_mov_b32 v35, v34
  v_mfma_f32_16x16x32_bf16 v[156:159], a[188:191], v[188:191], v[156:159]
  s_waitcnt lgkmcnt(3)
  v_permlane16_swap_b32 v34, v35
  v_add_f32 v34, v34, v35
  v_mfma_f32_16x16x32_bf16 v[64:67], a[192:195], v[160:163], v[64:67]
  ds_read_b128 v[176:179], v14 offset:57344
  v_mfma_f32_16x16x32_bf16 v[68:71], a[196:199], v[160:163], v[68:71]
  s_add_u32 m0, s31, 16384
  v_rcp_f32 v34, v34
  v_mfma_f32_16x16x32_bf16 v[72:75], a[200:203], v[160:163], v[72:75]
  s_waitcnt lgkmcnt(3)
  buffer_load_dwordx4 v10, s[8:11], s30 offen lds
  v_mul_f32 v44, v44, v34
  v_mfma_f32_16x16x32_bf16 v[76:79], a[192:195], v[164:167], v[76:79]
  ds_read_b128 v[180:183], v14 offset:59392
  v_mul_f32 v45, v45, v34
  v_mfma_f32_16x16x32_bf16 v[80:83], a[196:199], v[164:167], v[80:83]
  v_mul_f32 v46, v46, v34
  v_mul_f32 v47, v47, v34
  v_mfma_f32_16x16x32_bf16 v[84:87], a[200:203], v[164:167], v[84:87]
  s_waitcnt lgkmcnt(3)
  v_mul_f32 v48, v48, v34
  v_mul_f32 v49, v49, v34
  v_mfma_f32_16x16x32_bf16 v[88:91], a[192:195], v[168:171], v[88:91]
  ds_read_b128 v[184:187], v14 offset:61440
  v_mul_f32 v50, v50, v34
  v_mfma_f32_16x16x32_bf16 v[92:95], a[196:199], v[168:171], v[92:95]
  v_mul_f32 v51, v51, v34
  v_mul_f32 v52, v52, v34
  v_mfma_f32_16x16x32_bf16 v[96:99], a[200:203], v[168:171], v[96:99]
  s_waitcnt lgkmcnt(3)
  v_mul_f32 v53, v53, v34
  v_mul_f32 v54, v54, v34
  v_mfma_f32_16x16x32_bf16 v[100:103], a[192:195], v[172:175], v[100:103]
  ds_read_b128 v[188:191], v14 offset:63488
  v_mul_f32 v55, v55, v34
  v_mfma_f32_16x16x32_bf16 v[104:107], a[196:199], v[172:175], v[104:107]
  s_add_u32 m0, s31, 17408
  v_cvt_pk_bf16_f32 v56, v44, v45
  v_cvt_pk_bf16_f32 v57, v46, v47
  v_mfma_f32_16x16x32_bf16 v[108:111], a[200:203], v[172:175], v[108:111]
  s_waitcnt lgkmcnt(3)
  buffer_load_dwordx4 v11, s[8:11], s30 offen lds
  v_cvt_pk_bf16_f32 v58, v48, v49
  v_mfma_f32_16x16x32_bf16 v[112:115], a[192:195], v[176:179], v[112:115]
  ds_read_b128 v[160:163], v15 offset:49152
  v_cvt_pk_bf16_f32 v59, v50, v51
  v_mfma_f32_16x16x32_bf16 v[116:119], a[196:199], v[176:179], v[116:119]
  v_cvt_pk_bf16_f32 v60, v40, v41
  v_cvt_pk_bf16_f32 v61, v42, v43
  v_mfma_f32_16x16x32_bf16 v[120:123], a[200:203], v[176:179], v[120:123]
  s_waitcnt lgkmcnt(3)
  v_cvt_pk_bf16_f32 v62, v52, v53
  v_cvt_pk_bf16_f32 v63, v54, v55
  v_mfma_f32_16x16x32_bf16 v[124:127], a[192:195], v[180:183], v[124:127]
  ds_read_b128 v[164:167], v15 offset:51200
  v_cvt_pk_bf16_f32 v248, v36, v37
  v_mfma_f32_16x16x32_bf16 v[128:131], a[196:199], v[180:183], v[128:131]
  v_cvt_pk_bf16_f32 v249, v38, v39
  buffer_store_dwordx4 v[56:59], v26, s[16:19], s81 offen sc1
  v_mfma_f32_16x16x32_bf16 v[132:135], a[200:203], v[180:183], v[132:135]
  s_waitcnt lgkmcnt(3)
  v_mfma_f32_16x16x32_bf16 v[136:139], a[192:195], v[184:187], v[136:139]
  ds_read_b128 v[168:171], v15 offset:53248
  v_mfma_f32_16x16x32_bf16 v[140:143], a[196:199], v[184:187], v[140:143]
  s_add_u32 m0, s31, 18432
  v_mfma_f32_16x16x32_bf16 v[144:147], a[200:203], v[184:187], v[144:147]
  s_waitcnt lgkmcnt(3)
  buffer_load_dwordx4 v12, s[8:11], s30 offen lds
  v_mfma_f32_16x16x32_bf16 v[148:151], a[192:195], v[188:191], v[148:151]
  ds_read_b128 v[172:175], v15 offset:55296
  v_mfma_f32_16x16x32_bf16 v[152:155], a[196:199], v[188:191], v[152:155]
  v_mfma_f32_16x16x32_bf16 v[156:159], a[200:203], v[188:191], v[156:159]
  s_waitcnt lgkmcnt(3)
  buffer_store_dwordx4 v[60:63], v26, s[16:19], s81 offen offset:1024 sc1
  v_mfma_f32_16x16x32_bf16 v[64:67], a[204:207], v[160:163], v[64:67]
  ds_read_b128 v[176:179], v15 offset:57344
  v_mfma_f32_16x16x32_bf16 v[68:71], a[208:211], v[160:163], v[68:71]
  v_mfma_f32_16x16x32_bf16 v[72:75], a[212:215], v[160:163], v[72:75]
  s_waitcnt lgkmcnt(3)
  buffer_store_dwordx2 v[248:249], v29, s[16:19], s81 offen offset:2048 sc1
  v_mfma_f32_16x16x32_bf16 v[76:79], a[204:207], v[164:167], v[76:79]
  ds_read_b128 v[180:183], v15 offset:59392
  s_mov_b32 s84, s82
  v_mfma_f32_16x16x32_bf16 v[80:83], a[208:211], v[164:167], v[80:83]
  s_add_u32 m0, s31, 19456
  v_mfma_f32_16x16x32_bf16 v[84:87], a[212:215], v[164:167], v[84:87]
  s_waitcnt lgkmcnt(3)
  buffer_load_dwordx4 v13, s[8:11], s30 offen lds
  v_mfma_f32_16x16x32_bf16 v[88:91], a[204:207], v[168:171], v[88:91]
  s_add_u32 s30, s30, 128
  ds_read_b128 v[184:187], v15 offset:61440
  v_mfma_f32_16x16x32_bf16 v[92:95], a[208:211], v[168:171], v[92:95]
  s_cmp_le_u32 s26, s85
  s_cbranch_scc1 qa2_263
  s_mov_b32 s49, s43
  s_mov_b32 s50, s45
  s_mov_b32 s81, s47
  s_mov_b32 s82, s48
  s_add_u32 s43, s43, 4
  s_add_u32 s45, s45, 8388608
  s_add_u32 s47, s47, 2097152
  s_xor_b32 s47, s47, 8192
  s_add_u32 s48, s48, 512
qa3_264:
  v_mfma_f32_16x16x32_bf16 v[96:99], a[212:215], v[168:171], v[96:99]
  s_waitcnt lgkmcnt(3)
  v_mfma_f32_16x16x32_bf16 v[100:103], a[204:207], v[172:175], v[100:103]
  ds_read_b128 v[188:191], v15 offset:63488
  v_mfma_f32_16x16x32_bf16 v[104:107], a[208:211], v[172:175], v[104:107]
  v_mfma_f32_16x16x32_bf16 v[108:111], a[212:215], v[172:175], v[108:111]
  s_waitcnt lgkmcnt(3)
  v_mfma_f32_16x16x32_bf16 v[112:115], a[204:207], v[176:179], v[112:115]
  s_waitcnt vmcnt(11)
  s_barrier
  ds_read_b128 v[160:163], v16 offset:0
  v_mfma_f32_16x16x32_bf16 v[116:119], a[208:211], v[176:179], v[116:119]
  buffer_load_dword v32, v30, s[72:75], s77 offen sc1
  v_mfma_f32_16x16x32_bf16 v[120:123], a[212:215], v[176:179], v[120:123]
  s_waitcnt lgkmcnt(3)
  v_mfma_f32_16x16x32_bf16 v[124:127], a[204:207], v[180:183], v[124:127]
  ds_read_b128 v[164:167], v16 offset:2048
  v_mfma_f32_16x16x32_bf16 v[128:131], a[208:211], v[180:183], v[128:131]
  v_mfma_f32_16x16x32_bf16 v[132:135], a[212:215], v[180:183], v[132:135]
  s_waitcnt lgkmcnt(3)
  v_mfma_f32_16x16x32_bf16 v[136:139], a[204:207], v[184:187], v[136:139]
  ds_read_b128 v[168:171], v16 offset:4096
  v_mfma_f32_16x16x32_bf16 v[140:143], a[208:211], v[184:187], v[140:143]
  v_mfma_f32_16x16x32_bf16 v[144:147], a[212:215], v[184:187], v[144:147]
  s_waitcnt lgkmcnt(3)
  v_mfma_f32_16x16x32_bf16 v[148:151], a[204:207], v[188:191], v[148:151]
  ds_read_b128 v[172:175], v16 offset:6144
  v_mfma_f32_16x16x32_bf16 v[152:155], a[208:211], v[188:191], v[152:155]
  v_mfma_f32_16x16x32_bf16 v[156:159], a[212:215], v[188:191], v[156:159]
  s_waitcnt lgkmcnt(3)
  v_mfma_f32_16x16x32_bf16 v[64:67], a[216:219], v[160:163], v[64:67]
  ds_read_b128 v[176:179], v16 offset:8192
  v_mfma_f32_16x16x32_bf16 v[68:71], a[220:223], v[160:163], v[68:71]
  s_add_u32 m0, s31, 32768
  v_mfma_f32_16x16x32_bf16 v[72:75], a[224:227], v[160:163], v[72:75]
  s_waitcnt lgkmcnt(3)
  buffer_load_dwordx4 v10, s[8:11], s30 offen lds
  v_mfma_f32_16x16x32_bf16 v[76:79], a[216:219], v[164:167], v[76:79]
  ds_read_b128 v[180:183], v16 offset:10240
  v_mfma_f32_16x16x32_bf16 v[80:83], a[220:223], v[164:167], v[80:83]
  v_mfma_f32_16x16x32_bf16 v[84:87], a[224:227], v[164:167], v[84:87]
  s_waitcnt lgkmcnt(3)
  v_mfma_f32_16x16x32_bf16 v[88:91], a[216:219], v[168:171], v[88:91]
  ds_read_b128 v[184:187], v16 offset:12288
  v_mfma_f32_16x16x32_bf16 v[92:95], a[220:223], v[168:171], v[92:95]
  s_add_u32 m0, s31, 33792
  v_mfma_f32_16x16x32_bf16 v[96:99], a[224:227], v[168:171], v[96:99]
  s_waitcnt lgkmcnt(3)
  buffer_load_dwordx4 v11, s[8:11], s30 offen lds
  v_mfma_f32_16x16x32_bf16 v[100:103], a[216:219], v[172:175], v[100:103]
  ds_read_b128 v[188:191], v16 offset:14336
  v_mfma_f32_16x16x32_bf16 v[104:107], a[220:223], v[172:175], v[104:107]
  v_mfma_f32_16x16x32_bf16 v[108:111], a[224:227], v[172:175], v[108:111]
  s_waitcnt lgkmcnt(3)
  v_mfma_f32_16x16x32_bf16 v[112:115], a[216:219], v[176:179], v[112:115]
  ds_read_b128 v[160:163], v17 offset:0
  v_mfma_f32_16x16x32_bf16 v[116:119], a[220:223], v[176:179], v[116:119]
  s_add_u32 m0, s31, 34816
  v_mfma_f32_16x16x32_bf16 v[120:123], a[224:227], v[176:179], v[120:123]
  s_waitcnt lgkmcnt(3)
  buffer_load_dwordx4 v12, s[8:11], s30 offen lds
  v_mfma_f32_16x16x32_bf16 v[124:127], a[216:219], v[180:183], v[124:127]
  ds_read_b128 v[164:167], v17 offset:2048
  v_mfma_f32_16x16x32_bf16 v[128:131], a[220:223], v[180:183], v[128:131]
  v_mfma_f32_16x16x32_bf16 v[132:135], a[224:227], v[180:183], v[132:135]
  s_waitcnt lgkmcnt(3)
  v_mfma_f32_16x16x32_bf16 v[136:139], a[216:219], v[184:187], v[136:139]
  ds_read_b128 v[168:171], v17 offset:4096
  v_mfma_f32_16x16x32_bf16 v[140:143], a[220:223], v[184:187], v[140:143]
  s_add_u32 m0, s31, 35840
  v_mfma_f32_16x16x32_bf16 v[144:147], a[224:227], v[184:187], v[144:147]
  s_waitcnt lgkmcnt(3)
  buffer_load_dwordx4 v13, s[8:11], s30 offen lds
  v_mfma_f32_16x16x32_bf16 v[148:151], a[216:219], v[188:191], v[148:151]
  s_add_u32 s30, s30, 128
  ds_read_b128 v[172:175], v17 offset:6144
  v_mfma_f32_16x16x32_bf16 v[152:155], a[220:223], v[188:191], v[152:155]
  v_mfma_f32_16x16x32_bf16 v[156:159], a[224:227], v[188:191], v[156:159]
  s_waitcnt lgkmcnt(3)
  v_mfma_f32_16x16x32_bf16 v[64:67], a[228:231], v[160:163], v[64:67]
  ds_read_b128 v[176:179], v17 offset:8192
  v_mfma_f32_16x16x32_bf16 v[68:71], a[232:235], v[160:163], v[68:71]
  v_mfma_f32_16x16x32_bf16 v[72:75], a[236:239], v[160:163], v[72:75]
  s_waitcnt lgkmcnt(3)
  v_mfma_f32_16x16x32_bf16 v[76:79], a[228:231], v[164:167], v[76:79]
  ds_read_b128 v[180:183], v17 offset:10240
  v_cvt_pk_bf16_f32 v192, v64, v65
  v_mfma_f32_16x16x32_bf16 v[80:83], a[232:235], v[164:167], v[80:83]
  v_cvt_pk_bf16_f32 v193, v66, v67
  v_cvt_pk_bf16_f32 v194, v68, v69
  v_mfma_f32_16x16x32_bf16 v[84:87], a[236:239], v[164:167], v[84:87]
  s_waitcnt lgkmcnt(3)
  v_cvt_pk_bf16_f32 v195, v70, v71
  v_cvt_pk_bf16_f32 v200, v72, v73
  v_mfma_f32_16x16x32_bf16 v[88:91], a[228:231], v[168:171], v[88:91]
  ds_read_b128 v[184:187], v17 offset:12288
  v_cvt_pk_bf16_f32 v201, v74, v75
  v_mfma_f32_16x16x32_bf16 v[92:95], a[232:235], v[168:171], v[92:95]
  v_cvt_pk_bf16_f32 v196, v76, v77
  v_cvt_pk_bf16_f32 v197, v78, v79
  v_mfma_f32_16x16x32_bf16 v[96:99], a[236:239], v[168:171], v[96:99]
  s_waitcnt lgkmcnt(3)
  v_cvt_pk_bf16_f32 v198, v80, v81
  v_cvt_pk_bf16_f32 v199, v82, v83
  v_mfma_f32_16x16x32_bf16 v[100:103], a[228:231], v[172:175], v[100:103]
  ds_read_b128 v[188:191], v17 offset:14336
  v_cvt_pk_bf16_f32 v202, v84, v85
  v_mfma_f32_16x16x32_bf16 v[104:107], a[232:235], v[172:175], v[104:107]
  v_cvt_pk_bf16_f32 v203, v86, v87
  v_cvt_pk_bf16_f32 v204, v88, v89
  v_mfma_f32_16x16x32_bf16 v[108:111], a[236:239], v[172:175], v[108:111]
  s_waitcnt lgkmcnt(3)
  v_cvt_pk_bf16_f32 v205, v90, v91
  v_cvt_pk_bf16_f32 v206, v92, v93
  v_mfma_f32_16x16x32_bf16 v[112:115], a[228:231], v[176:179], v[112:115]
  s_waitcnt vmcnt(12)
  s_barrier
  ds_read_b128 v[160:163], v14 offset:0
  v_mfma_f32_16x16x32_bf16 v[116:119], a[232:235], v[176:179], v[116:119]
  v_cvt_pk_bf16_f32 v207, v94, v95
  v_cvt_pk_bf16_f32 v212, v96, v97
  v_mfma_f32_16x16x32_bf16 v[120:123], a[236:239], v[176:179], v[120:123]
  s_waitcnt lgkmcnt(3)
  v_cvt_pk_bf16_f32 v213, v98, v99
  v_cvt_pk_bf16_f32 v208, v100, v101
  v_mfma_f32_16x16x32_bf16 v[124:127], a[228:231], v[180:183], v[124:127]
  ds_read_b128 v[164:167], v14 offset:2048
  v_cvt_pk_bf16_f32 v209, v102, v103
  v_mfma_f32_16x16x32_bf16 v[128:131], a[232:235], v[180:183], v[128:131]
  v_cvt_pk_bf16_f32 v210, v104, v105
  v_cvt_pk_bf16_f32 v211, v106, v107
  v_mfma_f32_16x16x32_bf16 v[132:135], a[236:239], v[180:183], v[132:135]
  s_waitcnt lgkmcnt(3)
  v_cvt_pk_bf16_f32 v214, v108, v109
  v_cvt_pk_bf16_f32 v215, v110, v111
  v_mfma_f32_16x16x32_bf16 v[136:139], a[228:231], v[184:187], v[136:139]
  ds_read_b128 v[168:171], v14 offset:4096
  v_cvt_pk_bf16_f32 v216, v112, v113
  v_mfma_f32_16x16x32_bf16 v[140:143], a[232:235], v[184:187], v[140:143]
  v_cvt_pk_bf16_f32 v217, v114, v115
  v_cvt_pk_bf16_f32 v218, v116, v117
  v_mfma_f32_16x16x32_bf16 v[144:147], a[236:239], v[184:187], v[144:147]
  s_waitcnt lgkmcnt(3)
  v_cvt_pk_bf16_f32 v219, v118, v119
  v_cvt_pk_bf16_f32 v224, v120, v121
  v_mfma_f32_16x16x32_bf16 v[148:151], a[228:231], v[188:191], v[148:151]
  ds_read_b128 v[172:175], v14 offset:6144
  v_cvt_pk_bf16_f32 v225, v122, v123
  v_mfma_f32_16x16x32_bf16 v[152:155], a[232:235], v[188:191], v[152:155]
  s_sub_u32 s26, s26, 1
  s_cmp_gt_u32 s26, 0
  v_cvt_pk_bf16_f32 v220, v124, v125
  v_mfma_f32_16x16x32_bf16 v[156:159], a[236:239], v[188:191], v[156:159]
  s_waitcnt lgkmcnt(3)
  s_cbranch_scc1 qa_267
  s_nop 7
  v_cvt_pk_bf16_f32 v221, v126, v127
  v_cvt_pk_bf16_f32 v222, v128, v129
  v_cvt_pk_bf16_f32 v223, v130, v131
  v_cvt_pk_bf16_f32 v226, v132, v133
  v_cvt_pk_bf16_f32 v227, v134, v135
  v_cvt_pk_bf16_f32 v228, v136, v137
  v_cvt_pk_bf16_f32 v229, v138, v139
  v_cvt_pk_bf16_f32 v230, v140, v141
  v_cvt_pk_bf16_f32 v231, v142, v143
  v_cvt_pk_bf16_f32 v236, v144, v145
  v_cvt_pk_bf16_f32 v237, v146, v147
  v_cvt_pk_bf16_f32 v232, v148, v149
  v_cvt_pk_bf16_f32 v233, v150, v151
  v_cvt_pk_bf16_f32 v234, v152, v153
  v_cvt_pk_bf16_f32 v235, v154, v155
  v_cvt_pk_bf16_f32 v238, v156, v157
  v_cvt_pk_bf16_f32 v239, v158, v159
  s_waitcnt lgkmcnt(0)
  s_mul_i32 s86, s42, 393216
  ds_read_b128 v[64:67], v21 offset:0
  ds_read_b128 v[68:71], v21 offset:1024
  ds_read_b128 v[72:75], v21 offset:3072
  ds_read_b128 v[76:79], v21 offset:4096
  ds_read2st64_b64 v[80:83], v22 offset0:0 offset1:6
  ds_read2st64_b64 v[84:87], v23 offset0:0 offset1:6
  ds_read_b128 v[88:91], v21 offset:6144
  ds_read_b128 v[92:95], v21 offset:7168
  ds_read_b128 v[96:99], v21 offset:9216
  ds_read_b128 v[100:103], v21 offset:10240
  ds_read2st64_b64 v[104:107], v22 offset0:12 offset1:18
  ds_read2st64_b64 v[108:111], v23 offset0:12 offset1:18
  s_waitcnt lgkmcnt(0)
  s_barrier
  ds_write_b128 v20, v[192:195] offset:0
  ds_write_b128 v20, v[196:199] offset:1024
  ds_write_b128 v20, v[200:203] offset:2048
  ds_write_b128 v20, v[204:207] offset:12288
  ds_write_b128 v20, v[208:211] offset:13312
  ds_write_b128 v20, v[212:215] offset:14336
  ds_write_b128 v20, v[216:219] offset:24576
  ds_write_b128 v20, v[220:223] offset:25600
  ds_write_b128 v20, v[224:227] offset:26624
  ds_write_b128 v20, v[228:231] offset:36864
  ds_write_b128 v20, v[232:235] offset:37888
  ds_write_b128 v20, v[236:239] offset:38912
  s_waitcnt lgkmcnt(0)
  s_barrier
  s_cmp_eq_u32 s40, 0
  s_cbranch_scc1 qf_270
  s_mov_b32 s49, s43
  s_mov_b32 s50, s45
  s_mov_b32 s81, s47
  s_mov_b32 s82, s48
  s_add_u32 s43, s43, 4
  s_add_u32 s45, s45, 8388608
  s_add_u32 s47, s47, 2097152
  s_xor_b32 s47, s47, 8192
  s_add_u32 s48, s48, 512
  s_cmp_gt_u32 s49, 60
  s_cselect_b32 s23, 58, s49
  s_mov_b32 s101, 0
wm_273:
  buffer_load_dword v34, v30, s[72:75], s77 offen sc1
  s_add_u32 s101, s101, 1
  s_cmp_gt_u32 s101, 131072
  s_cbranch_scc1 main_end
  s_waitcnt vmcnt(0)
  v_cmp_gt_u32 vcc, s23, v34
  v_readfirstlane_b32 s100, v34
  s_nop 0
  s_cbranch_vccz wm_274
  s_sleep 4
  s_add_u32 s100, s100, 2
  s_cmp_ge_u32 s100, s23
  s_cbranch_scc1 wm_273
  s_sleep 40
  s_branch wm_273
wm_274:
  s_add_u32 s29, s50, 0
  buffer_load_dwordx4 v[112:115], v26, s[16:19], s29 offen offset:0 sc1
  buffer_load_dwordx4 v[116:119], v26, s[16:19], s29 offen offset:1024 sc1
  buffer_load_dwordx4 v[144:147], v26, s[16:19], s29 offen offset:2048 sc1
  s_add_u32 s29, s50, 16384
  buffer_load_dwordx4 v[120:123], v26, s[16:19], s29 offen offset:0 sc1
  buffer_load_dwordx4 v[124:127], v26, s[16:19], s29 offen offset:1024 sc1
  buffer_load_dwordx4 v[148:151], v26, s[16:19], s29 offen offset:2048 sc1
  s_add_u32 s29, s50, 32768
  buffer_load_dwordx4 v[128:131], v26, s[16:19], s29 offen offset:0 sc1
  buffer_load_dwordx4 v[132:135], v26, s[16:19], s29 offen offset:1024 sc1
  buffer_load_dwordx4 v[152:155], v26, s[16:19], s29 offen offset:2048 sc1
  s_add_u32 s29, s50, 49152
  buffer_load_dwordx4 v[136:139], v26, s[16:19], s29 offen offset:0 sc1
  buffer_load_dwordx4 v[140:143], v26, s[16:19], s29 offen offset:1024 sc1
  buffer_load_dwordx4 v[156:159], v26, s[16:19], s29 offen offset:2048 sc1
  s_waitcnt vmcnt(0) lgkmcnt(0)
  v_swap_b32 v146, v148
  v_swap_b32 v147, v149
  v_swap_b32 v154, v156
  v_swap_b32 v155, v157
  s_nop 1
  v_mfma_f32_16x16x32_bf16 v[36:39], v[112:115], v[64:67], 0
  v_mfma_f32_16x16x32_bf16 v[44:47], v[112:115], v[68:71], 0
  v_mfma_f32_16x16x32_bf16 v[48:51], v[116:119], v[68:71], 0
  v_mfma_f32_16x16x32_bf16 v[36:39], v[120:123], v[72:75], v[36:39]
  v_mfma_f32_16x16x32_bf16 v[44:47], v[120:123], v[76:79], v[44:47]
  v_mfma_f32_16x16x32_bf16 v[48:51], v[124:127], v[76:79], v[48:51]
  v_mfma_f32_16x16x32_bf16 v[36:39], v[144:147], v[80:83], v[36:39]
  v_mfma_f32_16x16x32_bf16 v[44:47], v[144:147], v[84:87], v[44:47]
  v_mfma_f32_16x16x32_bf16 v[48:51], v[148:151], v[84:87], v[48:51]
  v_mfma_f32_16x16x32_bf16 v[36:39], v[128:131], v[88:91], v[36:39]
  v_mfma_f32_16x16x32_bf16 v[44:47], v[128:131], v[92:95], v[44:47]
  v_mfma_f32_16x16x32_bf16 v[48:51], v[132:135], v[92:95], v[48:51]
  v_mfma_f32_16x16x32_bf16 v[36:39], v[136:139], v[96:99], v[36:39]
  v_mfma_f32_16x16x32_bf16 v[44:47], v[136:139], v[100:103], v[44:47]
  v_mfma_f32_16x16x32_bf16 v[48:51], v[140:143], v[100:103], v[48:51]
  v_mfma_f32_16x16x32_bf16 v[36:39], v[152:155], v[104:107], v[36:39]
  v_mfma_f32_16x16x32_bf16 v[44:47], v[152:155], v[108:111], v[44:47]
  v_mfma_f32_16x16x32_bf16 v[48:51], v[156:159], v[108:111], v[48:51]
  s_cmp_le_u32 s49, 60
  s_cbranch_scc1 qtp_277
  s_sub_u32 s23, s49, 1
  s_min_u32 s23, s23, 62
  s_mov_b32 s101, 0
wm_278:
  buffer_load_dword v34, v30, s[72:75], s77 offen sc1
  s_add_u32 s101, s101, 1
  s_cmp_gt_u32 s101, 131072
  s_cbranch_scc1 main_end
  s_waitcnt vmcnt(0)
  v_cmp_gt_u32 vcc, s23, v34
  v_readfirstlane_b32 s100, v34
  s_nop 0
  s_cbranch_vccz wm_279
  s_sleep 4
  s_add_u32 s100, s100, 2
  s_cmp_ge_u32 s100, s23
  s_cbranch_scc1 wm_278
  s_sleep 40
  s_branch wm_278
wm_279:
qtp_277:
  s_mov_b32 s101, 0
  s_branch qtp_276
qtp_275:
  s_sleep 2
qtp_276:
  s_add_u32 s29, s50, 4096
  buffer_load_dwordx4 v[160:163], v24, s[16:19], s29 offen offset:2560 sc1
  buffer_load_dwordx2 v[240:241], v25, s[16:19], s29 offen offset:3072 sc1
  s_add_u32 s29, s50, 20480
  buffer_load_dwordx4 v[164:167], v24, s[16:19], s29 offen offset:2560 sc1
  buffer_load_dwordx2 v[242:243], v25, s[16:19], s29 offen offset:3072 sc1
  s_add_u32 s29, s50, 36864
  buffer_load_dwordx4 v[168:171], v24, s[16:19], s29 offen offset:2560 sc1
  buffer_load_dwordx2 v[244:245], v25, s[16:19], s29 offen offset:3072 sc1
  s_add_u32 s29, s50, 53248
  buffer_load_dwordx4 v[172:175], v24, s[16:19], s29 offen offset:2560 sc1
  buffer_load_dwordx2 v[246:247], v25, s[16:19], s29 offen offset:3072 sc1
  s_add_u32 s101, s101, 1
  s_cmp_gt_u32 s101, 131072
  s_cbranch_scc1 main_end
  s_waitcnt vmcnt(0)
  v_max3_u32 v34, v160, v164, v168
  v_max3_u32 v34, v34, v172, v240
  v_max3_u32 v34, v34, v242, v244
  v_max_u32 v34, v34, v246
  v_cmp_eq_u32 vcc, -1, v34
  s_nop 1
  s_cbranch_vccnz qtp_275
  v_mfma_f32_16x16x32_bf16 v[40:43], v[160:163], v[64:67], 0
  v_mfma_f32_16x16x32_bf16 v[52:55], v[160:163], v[68:71], 0
  v_mfma_f32_16x16x32_bf16 v[40:43], v[164:167], v[72:75], v[40:43]
  v_mfma_f32_16x16x32_bf16 v[52:55], v[164:167], v[76:79], v[52:55]
  v_mfma_f32_16x16x32_bf16 v[40:43], v[240:243], v[80:83], v[40:43]
  v_mfma_f32_16x16x32_bf16 v[52:55], v[240:243], v[84:87], v[52:55]
  v_mfma_f32_16x16x32_bf16 v[40:43], v[168:171], v[88:91], v[40:43]
  v_mfma_f32_16x16x32_bf16 v[52:55], v[168:171], v[92:95], v[52:55]
  v_mfma_f32_16x16x32_bf16 v[40:43], v[172:175], v[96:99], v[40:43]
  v_mfma_f32_16x16x32_bf16 v[52:55], v[172:175], v[100:103], v[52:55]
  v_mfma_f32_16x16x32_bf16 v[40:43], v[244:247], v[104:107], v[40:43]
  v_mfma_f32_16x16x32_bf16 v[52:55], v[244:247], v[108:111], v[52:55]
  s_nop 4
  v_cndmask_b32 v36, v31, v36, s[64:65]
  v_cndmask_b32 v48, v31, v48, s[64:65]
  v_cndmask_b32 v37, v31, v37, s[66:67]
  v_cndmask_b32 v49, v31, v49, s[66:67]
  v_cndmask_b32 v38, v31, v38, s[68:69]
  v_cndmask_b32 v50, v31, v50, s[68:69]
  v_cndmask_b32 v39, v31, v39, s[70:71]
  v_cndmask_b32 v51, v31, v51, s[70:71]
  v_max3_f32 v34, v36, v37, v38
  v_max3_f32 v34, v34, v39, v40
  v_max3_f32 v34, v34, v41, v42
  v_max_f32 v34, v34, v43
  v_mov_b32 v35, v34
  s_nop 1
  v_permlane32_swap_b32 v34, v35
  v_max_f32 v34, v34, v35
  v_mov_b32 v35, v34
  s_nop 1
  v_permlane16_swap_b32 v34, v35
  v_max_f32 v34, v34, v35
  v_mul_f32 v34, s83, v34
  v_fma_f32 v36, v36, s83, -v34
  v_fma_f32 v37, v37, s83, -v34
  v_fma_f32 v38, v38, s83, -v34
  v_fma_f32 v39, v39, s83, -v34
  v_fma_f32 v40, v40, s83, -v34
  v_fma_f32 v41, v41, s83, -v34
  v_fma_f32 v42, v42, s83, -v34
  v_fma_f32 v43, v43, s83, -v34
  v_exp_f32 v36, v36
  v_exp_f32 v37, v37
  v_exp_f32 v38, v38
  v_exp_f32 v39, v39
  v_exp_f32 v40, v40
  v_exp_f32 v41, v41
  v_exp_f32 v42, v42
  v_exp_f32 v43, v43
  s_nop 0
  v_add_f32 v34, v40, v41
  v_add_f32 v34, v34, v42
  v_add_f32 v34, v34, v43
  v_cndmask_b32 v34, 0, v34, s[62:63]
  v_add_f32 v34, v34, v36
  v_add_f32 v34, v34, v37
  v_add_f32 v34, v34, v38
  v_add_f32 v34, v34, v39
  v_mov_b32 v35, v34
  s_nop 1
  v_permlane32_swap_b32 v34, v35
  v_add_f32 v34, v34, v35
  v_mov_b32 v35, v34
  s_nop 1
  v_permlane16_swap_b32 v34, v35
  v_add_f32 v34, v34, v35
  v_rcp_f32 v34, v34
  s_nop 0
  v_mul_f32 v36, v36, v34
  v_mul_f32 v37, v37, v34
  v_mul_f32 v38, v38, v34
  v_mul_f32 v39, v39, v34
  v_mul_f32 v40, v40, v34
  v_mul_f32 v41, v41, v34
  v_mul_f32 v42, v42, v34
  v_mul_f32 v43, v43, v34
  v_max3_f32 v34, v44, v45, v46
  v_max3_f32 v34, v34, v47, v48
  v_max3_f32 v34, v34, v49, v50
  v_max3_f32 v34, v34, v51, v52
  v_max3_f32 v34, v34, v53, v54
  v_max_f32 v34, v34, v55
  v_mov_b32 v35, v34
  s_nop 1
  v_permlane32_swap_b32 v34, v35
  v_max_f32 v34, v34, v35
  v_mov_b32 v35, v34
  s_nop 1
  v_permlane16_swap_b32 v34, v35
  v_max_f32 v34, v34, v35
  v_mul_f32 v34, s83, v34
  v_fma_f32 v44, v44, s83, -v34
  v_fma_f32 v45, v45, s83, -v34
  v_fma_f32 v46, v46, s83, -v34
  v_fma_f32 v47, v47, s83, -v34
  v_fma_f32 v48, v48, s83, -v34
  v_fma_f32 v49, v49, s83, -v34
  v_fma_f32 v50, v50, s83, -v34
  v_fma_f32 v51, v51, s83, -v34
  v_fma_f32 v52, v52, s83, -v34
  v_fma_f32 v53, v53, s83, -v34
  v_fma_f32 v54, v54, s83, -v34
  v_fma_f32 v55, v55, s83, -v34
  v_exp_f32 v44, v44
  v_exp_f32 v45, v45
  v_exp_f32 v46, v46
  v_exp_f32 v47, v47
  v_exp_f32 v48, v48
  v_exp_f32 v49, v49
  v_exp_f32 v50, v50
  v_exp_f32 v51, v51
  v_exp_f32 v52, v52
  v_exp_f32 v53, v53
  v_exp_f32 v54, v54
  v_exp_f32 v55, v55
  s_nop 0
  v_add_f32 v34, v52, v53
  v_add_f32 v34, v34, v54
  v_add_f32 v34, v34, v55
  v_cndmask_b32 v34, 0, v34, s[62:63]
  v_add_f32 v34, v34, v44
  v_add_f32 v34, v34, v45
  v_add_f32 v34, v34, v46
  v_add_f32 v34, v34, v47
  v_add_f32 v34, v34, v48
  v_add_f32 v34, v34, v49
  v_add_f32 v34, v34, v50
  v_add_f32 v34, v34, v51
  v_mov_b32 v35, v34
  s_nop 1
  v_permlane32_swap_b32 v34, v35
  v_add_f32 v34, v34, v35
  v_mov_b32 v35, v34
  s_nop 1
  v_permlane16_swap_b32 v34, v35
  v_add_f32 v34, v34, v35
  v_rcp_f32 v34, v34
  s_nop 0
  v_mul_f32 v44, v44, v34
  v_mul_f32 v45, v45, v34
  v_mul_f32 v46, v46, v34
  v_mul_f32 v47, v47, v34
  v_mul_f32 v48, v48, v34
  v_mul_f32 v49, v49, v34
  v_mul_f32 v50, v50, v34
  v_mul_f32 v51, v51, v34
  v_mul_f32 v52, v52, v34
  v_mul_f32 v53, v53, v34
  v_mul_f32 v54, v54, v34
  v_mul_f32 v55, v55, v34
  v_cvt_pk_bf16_f32 v56, v44, v45
  v_cvt_pk_bf16_f32 v57, v46, v47
  v_cvt_pk_bf16_f32 v58, v48, v49
  v_cvt_pk_bf16_f32 v59, v50, v51
  v_cvt_pk_bf16_f32 v60, v40, v41
  v_cvt_pk_bf16_f32 v61, v42, v43
  v_cvt_pk_bf16_f32 v62, v52, v53
  v_cvt_pk_bf16_f32 v63, v54, v55
  v_cvt_pk_bf16_f32 v248, v36, v37
  v_cvt_pk_bf16_f32 v249, v38, v39
  buffer_store_dwordx4 v[56:59], v26, s[16:19], s81 offen sc1
  buffer_store_dwordx4 v[60:63], v26, s[16:19], s81 offen offset:1024 sc1
  buffer_store_dwordx2 v[248:249], v29, s[16:19], s81 offen offset:2048 sc1
  s_mov_b32 s84, s82
qf_270:
  ds_read_b128 v[64:67], v21 offset:0
  ds_read_b128 v[68:71], v21 offset:1024
  ds_read_b128 v[72:75], v21 offset:3072
  ds_read_b128 v[76:79], v21 offset:4096
  ds_read2st64_b64 v[80:83], v22 offset0:0 offset1:6
  ds_read2st64_b64 v[84:87], v23 offset0:0 offset1:6
  ds_read_b128 v[88:91], v21 offset:6144
  ds_read_b128 v[92:95], v21 offset:7168
  ds_read_b128 v[96:99], v21 offset:9216
  ds_read_b128 v[100:103], v21 offset:10240
  ds_read2st64_b64 v[104:107], v22 offset0:12 offset1:18
  ds_read2st64_b64 v[108:111], v23 offset0:12 offset1:18
  s_waitcnt vmcnt(0)
  buffer_atomic_add v28, v33, s[72:75], s84 offen sc1
  s_mov_b32 s49, s43
  s_mov_b32 s50, s45
  s_mov_b32 s81, s47
  s_mov_b32 s82, s48
  s_add_u32 s43, s43, 4
  s_add_u32 s45, s45, 8388608
  s_add_u32 s47, s47, 2097152
  s_xor_b32 s47, s47, 8192
  s_add_u32 s48, s48, 512
  s_cmp_gt_u32 s49, 60
  s_cselect_b32 s23, 58, s49
  s_mov_b32 s101, 0
wm_280:
  buffer_load_dword v34, v30, s[72:75], s77 offen sc1
  s_add_u32 s101, s101, 1
  s_cmp_gt_u32 s101, 131072
  s_cbranch_scc1 main_end
  s_waitcnt vmcnt(0)
  v_cmp_gt_u32 vcc, s23, v34
  v_readfirstlane_b32 s100, v34
  s_nop 0
  s_cbranch_vccz wm_281
  s_sleep 4
  s_add_u32 s100, s100, 2
  s_cmp_ge_u32 s100, s23
  s_cbranch_scc1 wm_280
  s_sleep 40
  s_branch wm_280
wm_281:
  s_add_u32 s29, s50, 0
  buffer_load_dwordx4 v[112:115], v26, s[16:19], s29 offen offset:0 sc1
  buffer_load_dwordx4 v[116:119], v26, s[16:19], s29 offen offset:1024 sc1
  buffer_load_dwordx4 v[144:147], v26, s[16:19], s29 offen offset:2048 sc1
  s_add_u32 s29, s50, 16384
  buffer_load_dwordx4 v[120:123], v26, s[16:19], s29 offen offset:0 sc1
  buffer_load_dwordx4 v[124:127], v26, s[16:19], s29 offen offset:1024 sc1
  buffer_load_dwordx4 v[148:151], v26, s[16:19], s29 offen offset:2048 sc1
  s_add_u32 s29, s50, 32768
  buffer_load_dwordx4 v[128:131], v26, s[16:19], s29 offen offset:0 sc1
  buffer_load_dwordx4 v[132:135], v26, s[16:19], s29 offen offset:1024 sc1
  buffer_load_dwordx4 v[152:155], v26, s[16:19], s29 offen offset:2048 sc1
  s_add_u32 s29, s50, 49152
  buffer_load_dwordx4 v[136:139], v26, s[16:19], s29 offen offset:0 sc1
  buffer_load_dwordx4 v[140:143], v26, s[16:19], s29 offen offset:1024 sc1
  buffer_load_dwordx4 v[156:159], v26, s[16:19], s29 offen offset:2048 sc1
  s_waitcnt vmcnt(0) lgkmcnt(0)
  v_swap_b32 v146, v148
  v_swap_b32 v147, v149
  v_swap_b32 v154, v156
  v_swap_b32 v155, v157
  s_nop 1
  v_mfma_f32_16x16x32_bf16 v[36:39], v[112:115], v[64:67], 0
  v_mfma_f32_16x16x32_bf16 v[44:47], v[112:115], v[68:71], 0
  v_mfma_f32_16x16x32_bf16 v[48:51], v[116:119], v[68:71], 0
  v_mfma_f32_16x16x32_bf16 v[36:39], v[120:123], v[72:75], v[36:39]
  v_mfma_f32_16x16x32_bf16 v[44:47], v[120:123], v[76:79], v[44:47]
  v_mfma_f32_16x16x32_bf16 v[48:51], v[124:127], v[76:79], v[48:51]
  v_mfma_f32_16x16x32_bf16 v[36:39], v[144:147], v[80:83], v[36:39]
  v_mfma_f32_16x16x32_bf16 v[44:47], v[144:147], v[84:87], v[44:47]
  v_mfma_f32_16x16x32_bf16 v[48:51], v[148:151], v[84:87], v[48:51]
  v_mfma_f32_16x16x32_bf16 v[36:39], v[128:131], v[88:91], v[36:39]
  v_mfma_f32_16x16x32_bf16 v[44:47], v[128:131], v[92:95], v[44:47]
  v_mfma_f32_16x16x32_bf16 v[48:51], v[132:135], v[92:95], v[48:51]
  v_mfma_f32_16x16x32_bf16 v[36:39], v[136:139], v[96:99], v[36:39]
  v_mfma_f32_16x16x32_bf16 v[44:47], v[136:139], v[100:103], v[44:47]
  v_mfma_f32_16x16x32_bf16 v[48:51], v[140:143], v[100:103], v[48:51]
  v_mfma_f32_16x16x32_bf16 v[36:39], v[152:155], v[104:107], v[36:39]
  v_mfma_f32_16x16x32_bf16 v[44:47], v[152:155], v[108:111], v[44:47]
  v_mfma_f32_16x16x32_bf16 v[48:51], v[156:159], v[108:111], v[48:51]
  s_cmp_le_u32 s49, 60
  s_cbranch_scc1 qtp_284
  s_sub_u32 s23, s49, 1
  s_min_u32 s23, s23, 62
  s_mov_b32 s101, 0
wm_285:
  buffer_load_dword v34, v30, s[72:75], s77 offen sc1
  s_add_u32 s101, s101, 1
  s_cmp_gt_u32 s101, 131072
  s_cbranch_scc1 main_end
  s_waitcnt vmcnt(0)
  v_cmp_gt_u32 vcc, s23, v34
  v_readfirstlane_b32 s100, v34
  s_nop 0
  s_cbranch_vccz wm_286
  s_sleep 4
  s_add_u32 s100, s100, 2
  s_cmp_ge_u32 s100, s23
  s_cbranch_scc1 wm_285
  s_sleep 40
  s_branch wm_285
wm_286:
qtp_284:
  s_mov_b32 s101, 0
  s_branch qtp_283
qtp_282:
  s_sleep 2
qtp_283:
  s_add_u32 s29, s50, 4096
  buffer_load_dwordx4 v[160:163], v24, s[16:19], s29 offen offset:2560 sc1
  buffer_load_dwordx2 v[240:241], v25, s[16:19], s29 offen offset:3072 sc1
  s_add_u32 s29, s50, 20480
  buffer_load_dwordx4 v[164:167], v24, s[16:19], s29 offen offset:2560 sc1
  buffer_load_dwordx2 v[242:243], v25, s[16:19], s29 offen offset:3072 sc1
  s_add_u32 s29, s50, 36864
  buffer_load_dwordx4 v[168:171], v24, s[16:19], s29 offen offset:2560 sc1
  buffer_load_dwordx2 v[244:245], v25, s[16:19], s29 offen offset:3072 sc1
  s_add_u32 s29, s50, 53248
  buffer_load_dwordx4 v[172:175], v24, s[16:19], s29 offen offset:2560 sc1
  buffer_load_dwordx2 v[246:247], v25, s[16:19], s29 offen offset:3072 sc1
  s_add_u32 s101, s101, 1
  s_cmp_gt_u32 s101, 131072
  s_cbranch_scc1 main_end
  s_waitcnt vmcnt(0)
  v_max3_u32 v34, v160, v164, v168
  v_max3_u32 v34, v34, v172, v240
  v_max3_u32 v34, v34, v242, v244
  v_max_u32 v34, v34, v246
  v_cmp_eq_u32 vcc, -1, v34
  s_nop 1
  s_cbranch_vccnz qtp_282
  v_mfma_f32_16x16x32_bf16 v[40:43], v[160:163], v[64:67], 0
  v_mfma_f32_16x16x32_bf16 v[52:55], v[160:163], v[68:71], 0
  v_mfma_f32_16x16x32_bf16 v[40:43], v[164:167], v[72:75], v[40:43]
  v_mfma_f32_16x16x32_bf16 v[52:55], v[164:167], v[76:79], v[52:55]
  v_mfma_f32_16x16x32_bf16 v[40:43], v[240:243], v[80:83], v[40:43]
  v_mfma_f32_16x16x32_bf16 v[52:55], v[240:243], v[84:87], v[52:55]
  v_mfma_f32_16x16x32_bf16 v[40:43], v[168:171], v[88:91], v[40:43]
  v_mfma_f32_16x16x32_bf16 v[52:55], v[168:171], v[92:95], v[52:55]
  v_mfma_f32_16x16x32_bf16 v[40:43], v[172:175], v[96:99], v[40:43]
  v_mfma_f32_16x16x32_bf16 v[52:55], v[172:175], v[100:103], v[52:55]
  v_mfma_f32_16x16x32_bf16 v[40:43], v[244:247], v[104:107], v[40:43]
  v_mfma_f32_16x16x32_bf16 v[52:55], v[244:247], v[108:111], v[52:55]
  s_nop 4
  v_cndmask_b32 v36, v31, v36, s[64:65]
  v_cndmask_b32 v48, v31, v48, s[64:65]
  v_cndmask_b32 v37, v31, v37, s[66:67]
  v_cndmask_b32 v49, v31, v49, s[66:67]
  v_cndmask_b32 v38, v31, v38, s[68:69]
  v_cndmask_b32 v50, v31, v50, s[68:69]
  v_cndmask_b32 v39, v31, v39, s[70:71]
  v_cndmask_b32 v51, v31, v51, s[70:71]
  v_max3_f32 v34, v36, v37, v38
  v_max3_f32 v34, v34, v39, v40
  v_max3_f32 v34, v34, v41, v42
  v_max_f32 v34, v34, v43
  v_mov_b32 v35, v34
  s_nop 1
  v_permlane32_swap_b32 v34, v35
  v_max_f32 v34, v34, v35
  v_mov_b32 v35, v34
  s_nop 1
  v_permlane16_swap_b32 v34, v35
  v_max_f32 v34, v34, v35
  v_mul_f32 v34, s83, v34
  v_fma_f32 v36, v36, s83, -v34
  v_fma_f32 v37, v37, s83, -v34
  v_fma_f32 v38, v38, s83, -v34
  v_fma_f32 v39, v39, s83, -v34
  v_fma_f32 v40, v40, s83, -v34
  v_fma_f32 v41, v41, s83, -v34
  v_fma_f32 v42, v42, s83, -v34
  v_fma_f32 v43, v43, s83, -v34
  v_exp_f32 v36, v36
  v_exp_f32 v37, v37
  v_exp_f32 v38, v38
  v_exp_f32 v39, v39
  v_exp_f32 v40, v40
  v_exp_f32 v41, v41
  v_exp_f32 v42, v42
  v_exp_f32 v43, v43
  s_nop 0
  v_add_f32 v34, v40, v41
  v_add_f32 v34, v34, v42
  v_add_f32 v34, v34, v43
  v_cndmask_b32 v34, 0, v34, s[62:63]
  v_add_f32 v34, v34, v36
  v_add_f32 v34, v34, v37
  v_add_f32 v34, v34, v38
  v_add_f32 v34, v34, v39
  v_mov_b32 v35, v34
  s_nop 1
  v_permlane32_swap_b32 v34, v35
  v_add_f32 v34, v34, v35
  v_mov_b32 v35, v34
  s_nop 1
  v_permlane16_swap_b32 v34, v35
  v_add_f32 v34, v34, v35
  v_rcp_f32 v34, v34
  s_nop 0
  v_mul_f32 v36, v36, v34
  v_mul_f32 v37, v37, v34
  v_mul_f32 v38, v38, v34
  v_mul_f32 v39, v39, v34
  v_mul_f32 v40, v40, v34
  v_mul_f32 v41, v41, v34
  v_mul_f32 v42, v42, v34
  v_mul_f32 v43, v43, v34
  v_max3_f32 v34, v44, v45, v46
  v_max3_f32 v34, v34, v47, v48
  v_max3_f32 v34, v34, v49, v50
  v_max3_f32 v34, v34, v51, v52
  v_max3_f32 v34, v34, v53, v54
  v_max_f32 v34, v34, v55
  v_mov_b32 v35, v34
  s_nop 1
  v_permlane32_swap_b32 v34, v35
  v_max_f32 v34, v34, v35
  v_mov_b32 v35, v34
  s_nop 1
  v_permlane16_swap_b32 v34, v35
  v_max_f32 v34, v34, v35
  v_mul_f32 v34, s83, v34
  v_fma_f32 v44, v44, s83, -v34
  v_fma_f32 v45, v45, s83, -v34
  v_fma_f32 v46, v46, s83, -v34
  v_fma_f32 v47, v47, s83, -v34
  v_fma_f32 v48, v48, s83, -v34
  v_fma_f32 v49, v49, s83, -v34
  v_fma_f32 v50, v50, s83, -v34
  v_fma_f32 v51, v51, s83, -v34
  v_fma_f32 v52, v52, s83, -v34
  v_fma_f32 v53, v53, s83, -v34
  v_fma_f32 v54, v54, s83, -v34
  v_fma_f32 v55, v55, s83, -v34
  v_exp_f32 v44, v44
  v_exp_f32 v45, v45
  v_exp_f32 v46, v46
  v_exp_f32 v47, v47
  v_exp_f32 v48, v48
  v_exp_f32 v49, v49
  v_exp_f32 v50, v50
  v_exp_f32 v51, v51
  v_exp_f32 v52, v52
  v_exp_f32 v53, v53
  v_exp_f32 v54, v54
  v_exp_f32 v55, v55
  s_nop 0
  v_add_f32 v34, v52, v53
  v_add_f32 v34, v34, v54
  v_add_f32 v34, v34, v55
  v_cndmask_b32 v34, 0, v34, s[62:63]
  v_add_f32 v34, v34, v44
  v_add_f32 v34, v34, v45
  v_add_f32 v34, v34, v46
  v_add_f32 v34, v34, v47
  v_add_f32 v34, v34, v48
  v_add_f32 v34, v34, v49
  v_add_f32 v34, v34, v50
  v_add_f32 v34, v34, v51
  v_mov_b32 v35, v34
  s_nop 1
  v_permlane32_swap_b32 v34, v35
  v_add_f32 v34, v34, v35
  v_mov_b32 v35, v34
  s_nop 1
  v_permlane16_swap_b32 v34, v35
  v_add_f32 v34, v34, v35
  v_rcp_f32 v34, v34
  s_nop 0
  v_mul_f32 v44, v44, v34
  v_mul_f32 v45, v45, v34
  v_mul_f32 v46, v46, v34
  v_mul_f32 v47, v47, v34
  v_mul_f32 v48, v48, v34
  v_mul_f32 v49, v49, v34
  v_mul_f32 v50, v50, v34
  v_mul_f32 v51, v51, v34
  v_mul_f32 v52, v52, v34
  v_mul_f32 v53, v53, v34
  v_mul_f32 v54, v54, v34
  v_mul_f32 v55, v55, v34
  v_cvt_pk_bf16_f32 v56, v44, v45
  v_cvt_pk_bf16_f32 v57, v46, v47
  v_cvt_pk_bf16_f32 v58, v48, v49
  v_cvt_pk_bf16_f32 v59, v50, v51
  v_cvt_pk_bf16_f32 v60, v40, v41
  v_cvt_pk_bf16_f32 v61, v42, v43
  v_cvt_pk_bf16_f32 v62, v52, v53
  v_cvt_pk_bf16_f32 v63, v54, v55
  v_cvt_pk_bf16_f32 v248, v36, v37
  v_cvt_pk_bf16_f32 v249, v38, v39
  buffer_store_dwordx4 v[56:59], v26, s[16:19], s81 offen sc1
  buffer_store_dwordx4 v[60:63], v26, s[16:19], s81 offen offset:1024 sc1
  buffer_store_dwordx2 v[248:249], v29, s[16:19], s81 offen offset:2048 sc1
  s_mov_b32 s84, s82
qf_271:
  s_cmp_eq_u32 s91, 0
  s_cbranch_scc1 qf_272
  s_sub_u32 s91, s91, 1
  s_mul_i32 s21, s20, 12288
  s_add_u32 s21, s21, s86
  s_add_u32 s86, s86, 49152
  buffer_load_dwordx4 v[64:67], v26, s[56:59], s21 offen offset:0 sc1
  buffer_load_dwordx4 v[68:71], v26, s[56:59], s21 offen offset:1024 sc1
  buffer_load_dwordx4 v[96:99], v26, s[56:59], s21 offen offset:2048 sc1
  s_add_u32 s21, s21, 3072
  buffer_load_dwordx4 v[72:75], v26, s[56:59], s21 offen offset:0 sc1
  buffer_load_dwordx4 v[76:79], v26, s[56:59], s21 offen offset:1024 sc1
  buffer_load_dwordx4 v[100:103], v26, s[56:59], s21 offen offset:2048 sc1
  s_add_u32 s21, s21, 3072
  buffer_load_dwordx4 v[80:83], v26, s[56:59], s21 offen offset:0 sc1
  buffer_load_dwordx4 v[84:87], v26, s[56:59], s21 offen offset:1024 sc1
  buffer_load_dwordx4 v[104:107], v26, s[56:59], s21 offen offset:2048 sc1
  s_add_u32 s21, s21, 3072
  buffer_load_dwordx4 v[88:91], v26, s[56:59], s21 offen offset:0 sc1
  buffer_load_dwordx4 v[92:95], v26, s[56:59], s21 offen offset:1024 sc1
  buffer_load_dwordx4 v[108:111], v26, s[56:59], s21 offen offset:2048 sc1
  s_add_u32 s21, s21, 3072
  s_waitcnt vmcnt(0)
  buffer_atomic_add v28, v33, s[72:75], s84 offen sc1
  s_mov_b32 s49, s43
  s_mov_b32 s50, s45
  s_mov_b32 s81, s47
  s_mov_b32 s82, s48
  s_add_u32 s43, s43, 4
  s_add_u32 s45, s45, 8388608
  s_add_u32 s47, s47, 2097152
  s_xor_b32 s47, s47, 8192
  s_add_u32 s48, s48, 512
  s_cmp_gt_u32 s49, 60
  s_cselect_b32 s23, 58, s49
  s_mov_b32 s101, 0
wm_287:
  buffer_load_dword v34, v30, s[72:75], s77 offen sc1
  s_add_u32 s101, s101, 1
  s_cmp_gt_u32 s101, 131072
  s_cbranch_scc1 main_end
  s_waitcnt vmcnt(0)
  v_cmp_gt_u32 vcc, s23, v34
  v_readfirstlane_b32 s100, v34
  s_nop 0
  s_cbranch_vccz wm_288
  s_sleep 4
  s_add_u32 s100, s100, 2
  s_cmp_ge_u32 s100, s23
  s_cbranch_scc1 wm_287
  s_sleep 40
  s_branch wm_287
wm_288:
  s_add_u32 s29, s50, 0
  buffer_load_dwordx4 v[112:115], v26, s[16:19], s29 offen offset:0 sc1
  buffer_load_dwordx4 v[116:119], v26, s[16:19], s29 offen offset:1024 sc1
  buffer_load_dwordx4 v[144:147], v26, s[16:19], s29 offen offset:2048 sc1
  s_add_u32 s29, s50, 16384
  buffer_load_dwordx4 v[120:123], v26, s[16:19], s29 offen offset:0 sc1
  buffer_load_dwordx4 v[124:127], v26, s[16:19], s29 offen offset:1024 sc1
  buffer_load_dwordx4 v[148:151], v26, s[16:19], s29 offen offset:2048 sc1
  s_add_u32 s29, s50, 32768
  buffer_load_dwordx4 v[128:131], v26, s[16:19], s29 offen offset:0 sc1
  buffer_load_dwordx4 v[132:135], v26, s[16:19], s29 offen offset:1024 sc1
  buffer_load_dwordx4 v[152:155], v26, s[16:19], s29 offen offset:2048 sc1
  s_add_u32 s29, s50, 49152
  buffer_load_dwordx4 v[136:139], v26, s[16:19], s29 offen offset:0 sc1
  buffer_load_dwordx4 v[140:143], v26, s[16:19], s29 offen offset:1024 sc1
  buffer_load_dwordx4 v[156:159], v26, s[16:19], s29 offen offset:2048 sc1
  s_waitcnt vmcnt(0) lgkmcnt(0)
  v_swap_b32 v98, v100
  v_swap_b32 v99, v101
  v_swap_b32 v106, v108
  v_swap_b32 v107, v109
  v_swap_b32 v146, v148
  v_swap_b32 v147, v149
  v_swap_b32 v154, v156
  v_swap_b32 v155, v157
  s_nop 1
  v_mfma_f32_16x16x32_bf16 v[36:39], v[112:115], v[64:67], 0
  v_mfma_f32_16x16x32_bf16 v[44:47], v[112:115], v[68:71], 0
  v_mfma_f32_16x16x32_bf16 v[48:51], v[116:119], v[68:71], 0
  v_mfma_f32_16x16x32_bf16 v[36:39], v[120:123], v[72:75], v[36:39]
  v_mfma_f32_16x16x32_bf16 v[44:47], v[120:123], v[76:79], v[44:47]
  v_mfma_f32_16x16x32_bf16 v[48:51], v[124:127], v[76:79], v[48:51]
  v_mfma_f32_16x16x32_bf16 v[36:39], v[144:147], v[96:99], v[36:39]
  v_mfma_f32_16x16x32_bf16 v[44:47], v[144:147], v[100:103], v[44:47]
  v_mfma_f32_16x16x32_bf16 v[48:51], v[148:151], v[100:103], v[48:51]
  v_mfma_f32_16x16x32_bf16 v[36:39], v[128:131], v[80:83], v[36:39]
  v_mfma_f32_16x16x32_bf16 v[44:47], v[128:131], v[84:87], v[44:47]
  v_mfma_f32_16x16x32_bf16 v[48:51], v[132:135], v[84:87], v[48:51]
  v_mfma_f32_16x16x32_bf16 v[36:39], v[136:139], v[88:91], v[36:39]
  v_mfma_f32_16x16x32_bf16 v[44:47], v[136:139], v[92:95], v[44:47]
  v_mfma_f32_16x16x32_bf16 v[48:51], v[140:143], v[92:95], v[48:51]
  v_mfma_f32_16x16x32_bf16 v[36:39], v[152:155], v[104:107], v[36:39]
  v_mfma_f32_16x16x32_bf16 v[44:47], v[152:155], v[108:111], v[44:47]
  v_mfma_f32_16x16x32_bf16 v[48:51], v[156:159], v[108:111], v[48:51]
  s_cmp_le_u32 s49, 60
  s_cbranch_scc1 qtp_291
  s_sub_u32 s23, s49, 1
  s_min_u32 s23, s23, 62
  s_mov_b32 s101, 0
wm_292:
  buffer_load_dword v34, v30, s[72:75], s77 offen sc1
  s_add_u32 s101, s101, 1
  s_cmp_gt_u32 s101, 131072
  s_cbranch_scc1 main_end
  s_waitcnt vmcnt(0)
  v_cmp_gt_u32 vcc, s23, v34
  v_readfirstlane_b32 s100, v34
  s_nop 0
  s_cbranch_vccz wm_293
  s_sleep 4
  s_add_u32 s100, s100, 2
  s_cmp_ge_u32 s100, s23
  s_cbranch_scc1 wm_292
  s_sleep 40
  s_branch wm_292
wm_293:
qtp_291:
  s_mov_b32 s101, 0
  s_branch qtp_290
qtp_289:
  s_sleep 2
qtp_290:
  s_add_u32 s29, s50, 4096
  buffer_load_dwordx4 v[160:163], v24, s[16:19], s29 offen offset:2560 sc1
  buffer_load_dwordx2 v[240:241], v25, s[16:19], s29 offen offset:3072 sc1
  s_add_u32 s29, s50, 20480
  buffer_load_dwordx4 v[164:167], v24, s[16:19], s29 offen offset:2560 sc1
  buffer_load_dwordx2 v[242:243], v25, s[16:19], s29 offen offset:3072 sc1
  s_add_u32 s29, s50, 36864
  buffer_load_dwordx4 v[168:171], v24, s[16:19], s29 offen offset:2560 sc1
  buffer_load_dwordx2 v[244:245], v25, s[16:19], s29 offen offset:3072 sc1
  s_add_u32 s29, s50, 53248
  buffer_load_dwordx4 v[172:175], v24, s[16:19], s29 offen offset:2560 sc1
  buffer_load_dwordx2 v[246:247], v25, s[16:19], s29 offen offset:3072 sc1
  s_add_u32 s101, s101, 1
  s_cmp_gt_u32 s101, 131072
  s_cbranch_scc1 main_end
  s_waitcnt vmcnt(0)
  v_max3_u32 v34, v160, v164, v168
  v_max3_u32 v34, v34, v172, v240
  v_max3_u32 v34, v34, v242, v244
  v_max_u32 v34, v34, v246
  v_cmp_eq_u32 vcc, -1, v34
  s_nop 1
  s_cbranch_vccnz qtp_289
  v_mfma_f32_16x16x32_bf16 v[40:43], v[160:163], v[64:67], 0
  v_mfma_f32_16x16x32_bf16 v[52:55], v[160:163], v[68:71], 0
  v_mfma_f32_16x16x32_bf16 v[40:43], v[164:167], v[72:75], v[40:43]
  v_mfma_f32_16x16x32_bf16 v[52:55], v[164:167], v[76:79], v[52:55]
  v_mfma_f32_16x16x32_bf16 v[40:43], v[240:243], v[96:99], v[40:43]
  v_mfma_f32_16x16x32_bf16 v[52:55], v[240:243], v[100:103], v[52:55]
  v_mfma_f32_16x16x32_bf16 v[40:43], v[168:171], v[80:83], v[40:43]
  v_mfma_f32_16x16x32_bf16 v[52:55], v[168:171], v[84:87], v[52:55]
  v_mfma_f32_16x16x32_bf16 v[40:43], v[172:175], v[88:91], v[40:43]
  v_mfma_f32_16x16x32_bf16 v[52:55], v[172:175], v[92:95], v[52:55]
  v_mfma_f32_16x16x32_bf16 v[40:43], v[244:247], v[104:107], v[40:43]
  v_mfma_f32_16x16x32_bf16 v[52:55], v[244:247], v[108:111], v[52:55]
  s_nop 4
  v_cndmask_b32 v36, v31, v36, s[64:65]
  v_cndmask_b32 v48, v31, v48, s[64:65]
  v_cndmask_b32 v37, v31, v37, s[66:67]
  v_cndmask_b32 v49, v31, v49, s[66:67]
  v_cndmask_b32 v38, v31, v38, s[68:69]
  v_cndmask_b32 v50, v31, v50, s[68:69]
  v_cndmask_b32 v39, v31, v39, s[70:71]
  v_cndmask_b32 v51, v31, v51, s[70:71]
  v_max3_f32 v34, v36, v37, v38
  v_max3_f32 v34, v34, v39, v40
  v_max3_f32 v34, v34, v41, v42
  v_max_f32 v34, v34, v43
  v_mov_b32 v35, v34
  s_nop 1
  v_permlane32_swap_b32 v34, v35
  v_max_f32 v34, v34, v35
  v_mov_b32 v35, v34
  s_nop 1
  v_permlane16_swap_b32 v34, v35
  v_max_f32 v34, v34, v35
  v_mul_f32 v34, s83, v34
  v_fma_f32 v36, v36, s83, -v34
  v_fma_f32 v37, v37, s83, -v34
  v_fma_f32 v38, v38, s83, -v34
  v_fma_f32 v39, v39, s83, -v34
  v_fma_f32 v40, v40, s83, -v34
  v_fma_f32 v41, v41, s83, -v34
  v_fma_f32 v42, v42, s83, -v34
  v_fma_f32 v43, v43, s83, -v34
  v_exp_f32 v36, v36
  v_exp_f32 v37, v37
  v_exp_f32 v38, v38
  v_exp_f32 v39, v39
  v_exp_f32 v40, v40
  v_exp_f32 v41, v41
  v_exp_f32 v42, v42
  v_exp_f32 v43, v43
  s_nop 0
  v_add_f32 v34, v40, v41
  v_add_f32 v34, v34, v42
  v_add_f32 v34, v34, v43
  v_cndmask_b32 v34, 0, v34, s[62:63]
  v_add_f32 v34, v34, v36
  v_add_f32 v34, v34, v37
  v_add_f32 v34, v34, v38
  v_add_f32 v34, v34, v39
  v_mov_b32 v35, v34
  s_nop 1
  v_permlane32_swap_b32 v34, v35
  v_add_f32 v34, v34, v35
  v_mov_b32 v35, v34
  s_nop 1
  v_permlane16_swap_b32 v34, v35
  v_add_f32 v34, v34, v35
  v_rcp_f32 v34, v34
  s_nop 0
  v_mul_f32 v36, v36, v34
  v_mul_f32 v37, v37, v34
  v_mul_f32 v38, v38, v34
  v_mul_f32 v39, v39, v34
  v_mul_f32 v40, v40, v34
  v_mul_f32 v41, v41, v34
  v_mul_f32 v42, v42, v34
  v_mul_f32 v43, v43, v34
  v_max3_f32 v34, v44, v45, v46
  v_max3_f32 v34, v34, v47, v48
  v_max3_f32 v34, v34, v49, v50
  v_max3_f32 v34, v34, v51, v52
  v_max3_f32 v34, v34, v53, v54
  v_max_f32 v34, v34, v55
  v_mov_b32 v35, v34
  s_nop 1
  v_permlane32_swap_b32 v34, v35
  v_max_f32 v34, v34, v35
  v_mov_b32 v35, v34
  s_nop 1
  v_permlane16_swap_b32 v34, v35
  v_max_f32 v34, v34, v35
  v_mul_f32 v34, s83, v34
  v_fma_f32 v44, v44, s83, -v34
  v_fma_f32 v45, v45, s83, -v34
  v_fma_f32 v46, v46, s83, -v34
  v_fma_f32 v47, v47, s83, -v34
  v_fma_f32 v48, v48, s83, -v34
  v_fma_f32 v49, v49, s83, -v34
  v_fma_f32 v50, v50, s83, -v34
  v_fma_f32 v51, v51, s83, -v34
  v_fma_f32 v52, v52, s83, -v34
  v_fma_f32 v53, v53, s83, -v34
  v_fma_f32 v54, v54, s83, -v34
  v_fma_f32 v55, v55, s83, -v34
  v_exp_f32 v44, v44
  v_exp_f32 v45, v45
  v_exp_f32 v46, v46
  v_exp_f32 v47, v47
  v_exp_f32 v48, v48
  v_exp_f32 v49, v49
  v_exp_f32 v50, v50
  v_exp_f32 v51, v51
  v_exp_f32 v52, v52
  v_exp_f32 v53, v53
  v_exp_f32 v54, v54
  v_exp_f32 v55, v55
  s_nop 0
  v_add_f32 v34, v52, v53
  v_add_f32 v34, v34, v54
  v_add_f32 v34, v34, v55
  v_cndmask_b32 v34, 0, v34, s[62:63]
  v_add_f32 v34, v34, v44
  v_add_f32 v34, v34, v45
  v_add_f32 v34, v34, v46
  v_add_f32 v34, v34, v47
  v_add_f32 v34, v34, v48
  v_add_f32 v34, v34, v49
  v_add_f32 v34, v34, v50
  v_add_f32 v34, v34, v51
  v_mov_b32 v35, v34
  s_nop 1
  v_permlane32_swap_b32 v34, v35
  v_add_f32 v34, v34, v35
  v_mov_b32 v35, v34
  s_nop 1
  v_permlane16_swap_b32 v34, v35
  v_add_f32 v34, v34, v35
  v_rcp_f32 v34, v34
  s_nop 0
  v_mul_f32 v44, v44, v34
  v_mul_f32 v45, v45, v34
  v_mul_f32 v46, v46, v34
  v_mul_f32 v47, v47, v34
  v_mul_f32 v48, v48, v34
  v_mul_f32 v49, v49, v34
  v_mul_f32 v50, v50, v34
  v_mul_f32 v51, v51, v34
  v_mul_f32 v52, v52, v34
  v_mul_f32 v53, v53, v34
  v_mul_f32 v54, v54, v34
  v_mul_f32 v55, v55, v34
  v_cvt_pk_bf16_f32 v56, v44, v45
  v_cvt_pk_bf16_f32 v57, v46, v47
  v_cvt_pk_bf16_f32 v58, v48, v49
  v_cvt_pk_bf16_f32 v59, v50, v51
  v_cvt_pk_bf16_f32 v60, v40, v41
  v_cvt_pk_bf16_f32 v61, v42, v43
  v_cvt_pk_bf16_f32 v62, v52, v53
  v_cvt_pk_bf16_f32 v63, v54, v55
  v_cvt_pk_bf16_f32 v248, v36, v37
  v_cvt_pk_bf16_f32 v249, v38, v39
  buffer_store_dwordx4 v[56:59], v26, s[16:19], s81 offen sc1
  buffer_store_dwordx4 v[60:63], v26, s[16:19], s81 offen offset:1024 sc1
  buffer_store_dwordx2 v[248:249], v29, s[16:19], s81 offen offset:2048 sc1
  s_mov_b32 s84, s82
  s_branch qf_271
qf_272:
  s_waitcnt vmcnt(0)
  buffer_atomic_add v28, v33, s[72:75], s82 offen sc1
  s_branch qe_294
qw_268:
  s_mov_b32 s101, 0
wm_295:
  buffer_load_dword v32, v30, s[72:75], s77 offen sc1
  s_add_u32 s101, s101, 1
  s_cmp_gt_u32 s101, 131072
  s_cbranch_scc1 main_end
  s_waitcnt vmcnt(0)
  v_cmp_gt_u32 vcc, s49, v32
  v_readfirstlane_b32 s100, v32
  s_nop 0
  s_cbranch_vccz wm_296
  s_sleep 4
  s_add_u32 s100, s100, 2
  s_cmp_ge_u32 s100, s49
  s_cbranch_scc1 wm_295
  s_sleep 60
  s_branch wm_295
wm_296:
  s_branch qj_269
qa2_263:
  s_mov_b32 s49, 0
  s_mov_b32 s50, 1073741824
  s_mov_b32 s81, 1073741824
  s_mov_b32 s82, 1073741824
  s_branch qa3_264
qs_265:
  s_mul_i32 s21, s20, 3072
  s_add_u32 s21, s21, s86
  buffer_store_dwordx4 v[192:195], v26, s[56:59], s21 offen offset:0 sc1
  buffer_store_dwordx4 v[196:199], v26, s[56:59], s21 offen offset:1024 sc1
  buffer_store_dwordx4 v[200:203], v26, s[56:59], s21 offen offset:2048 sc1
  s_add_u32 s21, s21, 12288
  buffer_store_dwordx4 v[204:207], v26, s[56:59], s21 offen offset:0 sc1
  buffer_store_dwordx4 v[208:211], v26, s[56:59], s21 offen offset:1024 sc1
  buffer_store_dwordx4 v[212:215], v26, s[56:59], s21 offen offset:2048 sc1
  s_add_u32 s21, s21, 12288
  buffer_store_dwordx4 v[216:219], v26, s[56:59], s21 offen offset:0 sc1
  buffer_store_dwordx4 v[220:223], v26, s[56:59], s21 offen offset:1024 sc1
  buffer_store_dwordx4 v[224:227], v26, s[56:59], s21 offen offset:2048 sc1
  s_add_u32 s21, s21, 12288
  buffer_store_dwordx4 v[228:231], v26, s[56:59], s21 offen offset:0 sc1
  buffer_store_dwordx4 v[232:235], v26, s[56:59], s21 offen offset:1024 sc1
  buffer_store_dwordx4 v[236:239], v26, s[56:59], s21 offen offset:2048 sc1
  s_add_u32 s21, s21, 12288
  s_add_u32 s86, s86, 49152
  s_branch qs_266
qe_294:
queue:
  s_mov_b32 s87, 16
  s_mov_b32 s88, 0
queue2:
  s_load_dwordx2 s[4:5], s[0:1], 88
  s_load_dwordx2 s[6:7], s[0:1], 72
  s_load_dwordx2 s[38:39], s[0:1], 104
  s_lshr_b32 s58, s3, 4
  s_bfe_u32 s21, s3, 0x20003
  s_cmp_lt_u32 s3, 64
  s_cselect_b32 s58, s58, s21
  s_cselect_b32 s21, 1, 0
  s_lshr_b32 s41, s3, s21
  s_and_b32 s41, s41, 7
  s_lshl_b32 s59, s58, 3
  s_add_u32 s59, s59, s41
  s_lshl_b32 s59, s59, 7
  s_add_u32 s59, s59, 40960
  s_xor_b32 s59, s59, s80
  s_waitcnt vmcnt(0) lgkmcnt(0)
  s_barrier
  s_mov_b32 s8, s4
  s_mov_b32 s9, s5
  s_mov_b32 s10, 2621440
  s_mov_b32 s11, 0x00020000
  s_mov_b32 s12, s6
  s_mov_b32 s13, s7
  s_mov_b32 s14, 819200
  s_mov_b32 s15, 0x00020000
  s_mov_b32 s16, s38
  s_mov_b32 s17, s39
  s_mov_b32 s18, 218103808
  s_mov_b32 s19, 0x00020000
  s_add_u32 s28, s38, 175112192
  s_addc_u32 s29, s39, 0
  s_mov_b32 s30, 8192
  s_mov_b32 s31, 0x00020000
  s_add_u32 s72, s38, 173080576
  s_addc_u32 s73, s39, 0
  s_mov_b32 s74, 49152
  s_mov_b32 s75, 0x00020000
  v_mov_b32 v30, 102400
  v_mov_b32 v233, 0x40000000
  v_cmp_eq_u32 vcc, 0, v0
  v_and_b32 v7, 7, v1
  v_lshlrev_b32 v7, 7, v7
  v_cndmask_b32 v233, v233, 0, vcc
  v_mov_b32 v29, 1
  buffer_atomic_add v29, v233, s[72:75], s59 offen sc0 sc1
  v_bfe_u32 v31, v1, 3, 2
  v_lshl_add_u32 v31, v31, 2, v7
  s_lshl_b32 s51, s20, 10
  s_add_u32 s51, s51, 4096
  s_xor_b32 s51, s51, s80
  buffer_load_dword v8, v31, s[72:75], s51 offen sc1
  v_and_b32 v25, 3, v1
  v_lshlrev_b32 v25, 7, v25
  s_xor_b32 s56, s80, 29696
  buffer_load_dword v26, v25, s[72:75], s56 offen sc1
  s_mul_i32 s21, s20, 204800
  s_mul_i32 s22, s41, 160
  s_add_u32 s21, s21, s22
  s_mul_i32 s22, s20, 25600
  v_add_u32 v5, 0, v1
  v_mul_u32_u24 v6, 6554, v5
  v_lshrrev_b32 v6, 16, v6
  v_mul_u32_u24 v6, 1120, v6
  v_lshl_add_u32 v144, v5, 4, v6
  v_add_u32 v5, 64, v1
  v_mul_u32_u24 v6, 6554, v5
  v_lshrrev_b32 v6, 16, v6
  v_mul_u32_u24 v6, 1120, v6
  v_lshl_add_u32 v145, v5, 4, v6
  v_add_u32 v5, 128, v1
  v_mul_u32_u24 v6, 6554, v5
  v_lshrrev_b32 v6, 16, v6
  v_mul_u32_u24 v6, 1120, v6
  v_lshl_add_u32 v146, v5, 4, v6
  v_add_u32 v5, 192, v1
  v_mul_u32_u24 v6, 6554, v5
  v_lshrrev_b32 v6, 16, v6
  v_mul_u32_u24 v6, 1120, v6
  v_lshl_add_u32 v147, v5, 4, v6
  v_add_u32 v5, 256, v1
  v_mul_u32_u24 v6, 6554, v5
  v_lshrrev_b32 v6, 16, v6
  v_mul_u32_u24 v6, 1120, v6
  v_lshl_add_u32 v148, v5, 4, v6
  s_add_u32 m0, s22, 0
  s_nop 0
  buffer_load_dwordx4 v144, s[12:15], s21 offen lds
  s_add_u32 m0, s22, 1024
  s_nop 0
  buffer_load_dwordx4 v145, s[12:15], s21 offen lds
  s_add_u32 m0, s22, 2048
  s_nop 0
  buffer_load_dwordx4 v146, s[12:15], s21 offen lds
  s_add_u32 m0, s22, 3072
  s_nop 0
  buffer_load_dwordx4 v147, s[12:15], s21 offen lds
  s_add_u32 m0, s22, 4096
  s_nop 0
  buffer_load_dwordx4 v148, s[12:15], s21 offen lds
  s_add_u32 s21, s21, 40960
  s_add_u32 m0, s22, 5120
  s_nop 0
  buffer_load_dwordx4 v144, s[12:15], s21 offen lds
  s_add_u32 m0, s22, 6144
  s_nop 0
  buffer_load_dwordx4 v145, s[12:15], s21 offen lds
  s_add_u32 m0, s22, 7168
  s_nop 0
  buffer_load_dwordx4 v146, s[12:15], s21 offen lds
  s_add_u32 m0, s22, 8192
  s_nop 0
  buffer_load_dwordx4 v147, s[12:15], s21 offen lds
  s_add_u32 m0, s22, 9216
  s_nop 0
  buffer_load_dwordx4 v148, s[12:15], s21 offen lds
  s_add_u32 s21, s21, 40960
  s_add_u32 m0, s22, 10240
  s_nop 0
  buffer_load_dwordx4 v144, s[12:15], s21 offen lds
  s_add_u32 m0, s22, 11264
  s_nop 0
  buffer_load_dwordx4 v145, s[12:15], s21 offen lds
  s_add_u32 m0, s22, 12288
  s_nop 0
  buffer_load_dwordx4 v146, s[12:15], s21 offen lds
  s_add_u32 m0, s22, 13312
  s_nop 0
  buffer_load_dwordx4 v147, s[12:15], s21 offen lds
  s_add_u32 m0, s22, 14336
  s_nop 0
  buffer_load_dwordx4 v148, s[12:15], s21 offen lds
  s_add_u32 s21, s21, 40960
  s_add_u32 m0, s22, 15360
  s_nop 0
  buffer_load_dwordx4 v144, s[12:15], s21 offen lds
  s_add_u32 m0, s22, 16384
  s_nop 0
  buffer_load_dwordx4 v145, s[12:15], s21 offen lds
  s_add_u32 m0, s22, 17408
  s_nop 0
  buffer_load_dwordx4 v146, s[12:15], s21 offen lds
  s_add_u32 m0, s22, 18432
  s_nop 0
  buffer_load_dwordx4 v147, s[12:15], s21 offen lds
  s_add_u32 m0, s22, 19456
  s_nop 0
  buffer_load_dwordx4 v148, s[12:15], s21 offen lds
  s_add_u32 s21, s21, 40960
  s_add_u32 m0, s22, 20480
  s_nop 0
  buffer_load_dwordx4 v144, s[12:15], s21 offen lds
  s_add_u32 m0, s22, 21504
  s_nop 0
  buffer_load_dwordx4 v145, s[12:15], s21 offen lds
  s_add_u32 m0, s22, 22528
  s_nop 0
  buffer_load_dwordx4 v146, s[12:15], s21 offen lds
  s_add_u32 m0, s22, 23552
  s_nop 0
  buffer_load_dwordx4 v147, s[12:15], s21 offen lds
  s_add_u32 m0, s22, 24576
  s_nop 0
  buffer_load_dwordx4 v148, s[12:15], s21 offen lds
  s_add_u32 s21, s21, 40960
  v_lshrrev_b32 v5, 2, v2
  v_and_b32 v6, 3, v2
  v_lshlrev_b32 v6, 3, v6
  v_lshl_add_u32 v9, v3, 2, v5
  v_mul_u32_u24 v9, 160, v9
  v_add3_u32 v152, v9, v6, s22
  v_add_u32 v153, v152, v6
  v_mul_u32_u24 v9, 20, v3
  v_add_u32 v9, v9, v5
  v_mul_u32_u24 v9, 160, v9
  v_add3_u32 v154, v9, v6, s22
  v_add_u32 v155, v154, v6
  v_lshlrev_b32 v4, 4, v1
  v_lshlrev_b32 v5, 3, v1
  v_lshlrev_b32 v6, 2, v2
  v_mul_u32_u24 v9, 1280, v2
  v_lshl_add_u32 v13, v3, 3, v9
  v_lshl_add_u32 v9, v3, 4, v9
  s_mul_i32 s21, s20, 10240
  v_add_u32 v10, s21, v4
  s_and_b32 s43, s20, 1
  s_lshr_b32 s44, s20, 1
  s_mul_i32 s21, s44, 6
  s_add_u32 s21, s21, s43
  s_lshl_b32 s21, s21, 10
  v_add_u32 v11, s21, v4
  s_add_u32 s21, s43, 4
  s_lshl_b32 s21, s21, 10
  v_add_u32 v12, s21, v4
  v_lshrrev_b32 v20, 5, v1
  v_mul_u32_u24 v21, 2560, v20
  v_add_u32 v21, v21, v4
  v_and_b32 v22, 31, v1
  v_lshlrev_b32 v22, 4, v22
  v_mul_u32_u24 v14, 640, v20
  v_add_u32 v22, v22, v14
  v_add_u32 v28, 16384, v22
  v_and_b32 v15, 1, v3
  v_lshl_add_u32 v14, v15, 6, v14
  v_lshrrev_b32 v16, 3, v2
  v_mul_u32_u24 v16, 16320, v16
  v_lshl_add_u32 v16, v2, 3, v16
  v_add_u32 v14, v14, v16
  v_add_u32 v15, 40960, v11
  v_lshlrev_b32 v17, 2, v7
  v_bfe_u32 v16, v1, 3, 1
  v_lshl_add_u32 v17, v16, 3, v17
  v_add_u32 v16, 40960, v12
  v_cmp_gt_u32 s[66:67], 16, v1
  s_lshr_b32 s52, s41, 1
  s_lshl_b32 s52, s52, 7
  s_and_b32 s21, s41, 1
  s_lshl_b32 s21, s21, 4
  s_add_u32 s52, s52, s21
  s_add_u32 s52, s52, 0
  s_xor_b32 s52, s52, s80
  v_add_u32 v17, s52, v17
  s_lshl_b32 s21, s20, 17
  s_lshl_b32 s22, s41, 10
  s_add_u32 s42, s21, s22
  s_lshl_b32 s53, s20, 19
  s_lshl_b32 s60, s41, 15
  s_add_u32 s60, s60, s53
  s_add_u32 s60, s60, 4096
  s_lshr_b32 s22, s41, 1
  s_lshl_b32 s22, s22, 14
  s_add_u32 s53, s53, s22
  s_and_b32 s22, s41, 1
  s_lshl_b32 s22, s22, 12
  s_add_u32 s53, s53, s22
  v_mov_b32 v70, 0
  v_mov_b32 v71, 0
  v_mov_b32 v78, 0
  v_mov_b32 v79, 0
  v_mov_b32 v86, 0
  v_mov_b32 v87, 0
  v_mov_b32 v94, 0
  v_mov_b32 v95, 0
  v_mov_b32 v102, 0
  v_mov_b32 v103, 0
  v_mov_b32 v110, 0
  v_mov_b32 v111, 0
  v_mov_b32 v118, 0
  v_mov_b32 v119, 0
  v_mov_b32 v126, 0
  v_mov_b32 v127, 0
  s_waitcnt vmcnt(25)
  s_cmp_lg_u32 s20, 0
  s_cbranch_scc1 pvq_298
  s_mov_b64 exec, 1
  ds_write_b32 v30, v29
  s_mov_b64 exec, -1
pvq_298:
  v_readlane_b32 s50, v8, 0
  v_readlane_b32 s21, v8, 1
  s_min_u32 s50, s50, s21
  v_readlane_b32 s21, v8, 2
  s_min_u32 s50, s50, s21
  v_readlane_b32 s21, v8, 3
  s_min_u32 s50, s50, s21
  v_readlane_b32 s21, v8, 4
  s_min_u32 s50, s50, s21
  v_readlane_b32 s21, v8, 5
  s_min_u32 s50, s50, s21
  v_readlane_b32 s21, v8, 6
  s_min_u32 s50, s50, s21
  v_readlane_b32 s21, v8, 7
  s_min_u32 s50, s50, s21
  v_readlane_b32 s21, v8, 8
  s_min_u32 s50, s50, s21
  v_readlane_b32 s21, v8, 9
  s_min_u32 s50, s50, s21
  v_readlane_b32 s21, v8, 10
  s_min_u32 s50, s50, s21
  v_readlane_b32 s21, v8, 11
  s_min_u32 s50, s50, s21
  v_readlane_b32 s21, v8, 12
  s_min_u32 s50, s50, s21
  v_readlane_b32 s21, v8, 13
  s_min_u32 s50, s50, s21
  v_readlane_b32 s21, v8, 14
  s_min_u32 s50, s50, s21
  v_readlane_b32 s21, v8, 15
  s_min_u32 s50, s50, s21
  v_readlane_b32 s21, v8, 16
  s_min_u32 s50, s50, s21
  v_readlane_b32 s21, v8, 17
  s_min_u32 s50, s50, s21
  v_readlane_b32 s21, v8, 18
  s_min_u32 s50, s50, s21
  v_readlane_b32 s21, v8, 19
  s_min_u32 s50, s50, s21
  v_readlane_b32 s21, v8, 20
  s_min_u32 s50, s50, s21
  v_readlane_b32 s21, v8, 21
  s_min_u32 s50, s50, s21
  v_readlane_b32 s21, v8, 22
  s_min_u32 s50, s50, s21
  v_readlane_b32 s21, v8, 23
  s_min_u32 s50, s50, s21
  v_readlane_b32 s21, v8, 24
  s_min_u32 s50, s50, s21
  v_readlane_b32 s21, v8, 25
  s_min_u32 s50, s50, s21
  v_readlane_b32 s21, v8, 26
  s_min_u32 s50, s50, s21
  v_readlane_b32 s21, v8, 27
  s_min_u32 s50, s50, s21
  v_readlane_b32 s21, v8, 28
  s_min_u32 s50, s50, s21
  v_readlane_b32 s21, v8, 29
  s_min_u32 s50, s50, s21
  v_readlane_b32 s21, v8, 30
  s_min_u32 s50, s50, s21
  v_readlane_b32 s21, v8, 31
  s_min_u32 s50, s50, s21
  v_cmp_gt_u32 vcc, 16, v26
  s_waitcnt lgkmcnt(0)
  s_barrier
  ds_read_b32 v23, v30
  s_cbranch_vccz pv_297
  s_mov_b32 s101, 0
wm_299:
  buffer_load_dword v26, v25, s[72:75], s56 offen sc1
  s_add_u32 s101, s101, 1
  s_cmp_gt_u32 s101, 131072
  s_cbranch_scc1 main_end
  s_waitcnt vmcnt(0)
  v_cmp_gt_u32 vcc, 16, v26
  v_readfirstlane_b32 s100, v26
  s_nop 0
  s_cbranch_vccz wm_300
  s_sleep 16
  s_branch wm_299
wm_300:
pv_297:
  s_mov_b32 s71, 0
pv_late:
  s_waitcnt lgkmcnt(0)
  v_readfirstlane_b32 s2, v23
  s_cmp_ge_u32 s2, 16
  s_cbranch_scc1 pv_done
  s_lshl_b32 s40, s2, 2
  s_add_u32 s40, s40, s58
  s_lshl_b32 s21, s40, 7
  s_add_u32 s21, s21, 8192
  s_xor_b32 s21, s21, s80
  v_mov_b32 v18, s21
  v_cndmask_b32 v18, v17, v18, s[66:67]
  s_add_u32 s21, s40, 1
  v_mov_b32 v19, s21
  v_cndmask_b32 v19, v19, 32, s[66:67]
  buffer_load_dword v27, v18, s[72:75], 0 offen sc1
  s_lshl_b32 s55, s40, 19
  s_lshl_b32 s21, s40, 11
  s_and_b32 s21, s21, 8192
  s_xor_b32 s21, s21, s80
  s_add_u32 s55, s55, s21
  s_add_u32 s55, s55, 136314880
  s_lshl_b32 s21, s20, 15
  s_xor_b32 s54, s55, 8192
  s_add_u32 s54, s54, 48234496
  s_add_u32 s54, s54, s21
  s_lshl_b32 s57, s40, 1
  s_add_u32 s57, s57, s43
  s_lshl_b32 s45, s57, 6
  s_add_u32 s69, s54, 262144
  s_cmp_lt_u32 s2, 16
  s_cselect_b32 s69, s69, 0x40000000
  s_cmp_lt_u32 s2, 12
  s_cselect_b32 s65, s87, 0
  s_cmp_gt_u32 s65, 1
  s_cselect_b32 s64, s59, 0x40000000
  s_cselect_b32 s65, 1, 0
  v_mov_b32 v29, 1
  buffer_atomic_add v29, v233, s[72:75], s64 offen sc0 sc1
  buffer_load_dword v232, v6, s[28:31], s45 offen sc1
  buffer_load_dwordx4 v[192:195], v4, s[16:19], s69 offen offset:0 sc1
  buffer_load_dwordx4 v[196:199], v4, s[16:19], s69 offen offset:1024 sc1
  buffer_load_dwordx2 v[208:209], v5, s[16:19], s69 offen offset:2048 sc1
  s_add_u32 s69, s69, 2560
  buffer_load_dwordx4 v[200:203], v4, s[16:19], s69 offen offset:0 sc1
  buffer_load_dwordx4 v[204:207], v4, s[16:19], s69 offen offset:1024 sc1
  buffer_load_dwordx2 v[210:211], v5, s[16:19], s69 offen offset:2048 sc1
  s_add_u32 s69, s69, 13824
  buffer_load_dwordx4 v[212:215], v4, s[16:19], s69 offen offset:0 sc1
  buffer_load_dwordx4 v[216:219], v4, s[16:19], s69 offen offset:1024 sc1
  buffer_load_dwordx2 v[228:229], v5, s[16:19], s69 offen offset:2048 sc1
  s_add_u32 s69, s69, 2560
  buffer_load_dwordx4 v[220:223], v4, s[16:19], s69 offen offset:0 sc1
  buffer_load_dwordx4 v[224:227], v4, s[16:19], s69 offen offset:1024 sc1
  buffer_load_dwordx2 v[230:231], v5, s[16:19], s69 offen offset:2048 sc1
  s_add_u32 s69, s69, 13824
  s_waitcnt vmcnt(14)
  s_add_u32 s23, s40, 1
  s_cmp_ge_u32 s50, s23
  s_cbranch_scc1 pv_301
  s_mov_b32 s101, 0
wm_304:
  buffer_load_dword v8, v31, s[72:75], s51 offen sc1
  s_add_u32 s101, s101, 1
  s_cmp_gt_u32 s101, 131072
  s_cbranch_scc1 main_end
  s_waitcnt vmcnt(0)
  v_cmp_gt_u32 vcc, s23, v8
  v_readfirstlane_b32 s100, v8
  s_nop 0
  s_cbranch_vccz wm_305
  s_sleep 8
  s_add_u32 s100, s100, 2
  s_cmp_ge_u32 s100, s23
  s_cbranch_scc1 wm_304
  s_sleep 60
  s_branch wm_304
wm_305:
  v_readlane_b32 s50, v8, 0
  v_readlane_b32 s21, v8, 1
  s_min_u32 s50, s50, s21
  v_readlane_b32 s21, v8, 2
  s_min_u32 s50, s50, s21
  v_readlane_b32 s21, v8, 3
  s_min_u32 s50, s50, s21
  v_readlane_b32 s21, v8, 4
  s_min_u32 s50, s50, s21
  v_readlane_b32 s21, v8, 5
  s_min_u32 s50, s50, s21
  v_readlane_b32 s21, v8, 6
  s_min_u32 s50, s50, s21
  v_readlane_b32 s21, v8, 7
  s_min_u32 s50, s50, s21
  v_readlane_b32 s21, v8, 8
  s_min_u32 s50, s50, s21
  v_readlane_b32 s21, v8, 9
  s_min_u32 s50, s50, s21
  v_readlane_b32 s21, v8, 10
  s_min_u32 s50, s50, s21
  v_readlane_b32 s21, v8, 11
  s_min_u32 s50, s50, s21
  v_readlane_b32 s21, v8, 12
  s_min_u32 s50, s50, s21
  v_readlane_b32 s21, v8, 13
  s_min_u32 s50, s50, s21
  v_readlane_b32 s21, v8, 14
  s_min_u32 s50, s50, s21
  v_readlane_b32 s21, v8, 15
  s_min_u32 s50, s50, s21
  v_readlane_b32 s21, v8, 16
  s_min_u32 s50, s50, s21
  v_readlane_b32 s21, v8, 17
  s_min_u32 s50, s50, s21
  v_readlane_b32 s21, v8, 18
  s_min_u32 s50, s50, s21
  v_readlane_b32 s21, v8, 19
  s_min_u32 s50, s50, s21
  v_readlane_b32 s21, v8, 20
  s_min_u32 s50, s50, s21
  v_readlane_b32 s21, v8, 21
  s_min_u32 s50, s50, s21
  v_readlane_b32 s21, v8, 22
  s_min_u32 s50, s50, s21
  v_readlane_b32 s21, v8, 23
  s_min_u32 s50, s50, s21
  v_readlane_b32 s21, v8, 24
  s_min_u32 s50, s50, s21
  v_readlane_b32 s21, v8, 25
  s_min_u32 s50, s50, s21
  v_readlane_b32 s21, v8, 26
  s_min_u32 s50, s50, s21
  v_readlane_b32 s21, v8, 27
  s_min_u32 s50, s50, s21
  v_readlane_b32 s21, v8, 28
  s_min_u32 s50, s50, s21
  v_readlane_b32 s21, v8, 29
  s_min_u32 s50, s50, s21
  v_readlane_b32 s21, v8, 30
  s_min_u32 s50, s50, s21
  v_readlane_b32 s21, v8, 31
  s_min_u32 s50, s50, s21
pv_301:
  v_cmp_gt_u32 vcc, v19, v27
  s_lshl_b32 s61, s40, 21
  s_lshl_b32 s21, s40, 13
  s_and_b32 s21, s21, 8192
  s_xor_b32 s21, s21, s80
  s_add_u32 s61, s61, s21
  s_lshl_b32 s21, s20, 15
  s_add_u32 s47, s54, s21
  s_add_u32 s48, s61, s60
  s_xor_b32 s68, s61, 8192
  s_add_u32 s68, s68, s53
  s_add_u32 s70, s55, s42
  s_xor_b32 s70, s70, 0
  s_mov_b32 s62, 0
  s_cbranch_vccnz pv_302
  s_mov_b32 s62, 1
  buffer_load_dwordx4 a[0:3], v4, s[16:19], s68 offen offset:0 sc1
  buffer_load_dwordx4 a[4:7], v4, s[16:19], s68 offen offset:1024 sc1
  buffer_load_dwordx4 v[32:35], v22, s[16:19], s48 offen offset:0 sc1
  buffer_load_dwordx4 a[8:11], v4, s[16:19], s70 offen sc1
  s_add_u32 s70, s70, 16384
  buffer_load_dwordx4 a[12:15], v4, s[16:19], s68 offen offset:2048 sc1
  buffer_load_dwordx4 a[16:19], v4, s[16:19], s68 offen offset:3072 sc1
  s_add_u32 s68, s68, 65536
  buffer_load_dwordx4 v[64:67], v4, s[16:19], s47 offen sc1
  buffer_load_dwordx2 v[68:69], v5, s[16:19], s47 offen offset:2048 sc1
  buffer_load_dwordx4 v[128:131], v21, s[16:19], s47 offen offset:1024 sc1
  s_add_u32 s47, s47, 2560
  buffer_load_dwordx4 a[20:23], v4, s[16:19], s68 offen offset:0 sc1
  buffer_load_dwordx4 a[24:27], v4, s[16:19], s68 offen offset:1024 sc1
  buffer_load_dwordx4 v[40:43], v28, s[16:19], s48 offen offset:0 sc1
  buffer_load_dwordx4 a[28:31], v4, s[16:19], s70 offen sc1
  s_add_u32 s70, s70, 16384
  buffer_load_dwordx4 a[32:35], v4, s[16:19], s68 offen offset:2048 sc1
  buffer_load_dwordx4 a[36:39], v4, s[16:19], s68 offen offset:3072 sc1
  s_add_u32 s68, s68, 65536
  buffer_load_dwordx2 v[184:185], v14, s[16:19], s48 offen offset:512 sc1
  buffer_load_dwordx4 v[72:75], v4, s[16:19], s47 offen sc1
  buffer_load_dwordx2 v[76:77], v5, s[16:19], s47 offen offset:2048 sc1
  s_add_u32 s47, s47, 13824
  buffer_load_dwordx4 a[40:43], v4, s[16:19], s68 offen offset:0 sc1
  buffer_load_dwordx4 a[44:47], v4, s[16:19], s68 offen offset:1024 sc1
  buffer_load_dwordx4 v[36:39], v22, s[16:19], s48 offen offset:1280 sc1
  buffer_load_dwordx4 a[48:51], v4, s[16:19], s70 offen sc1
  s_add_u32 s70, s70, 16384
  buffer_load_dwordx4 a[52:55], v4, s[16:19], s68 offen offset:2048 sc1
  buffer_load_dwordx4 a[56:59], v4, s[16:19], s68 offen offset:3072 sc1
  s_add_u32 s68, s68, 65536
  buffer_load_dwordx4 v[80:83], v4, s[16:19], s47 offen sc1
  buffer_load_dwordx2 v[84:85], v5, s[16:19], s47 offen offset:2048 sc1
  buffer_load_dwordx4 v[132:135], v21, s[16:19], s47 offen offset:1024 sc1
  s_add_u32 s47, s47, 2560
  buffer_load_dwordx4 a[60:63], v4, s[16:19], s68 offen offset:0 sc1
  buffer_load_dwordx4 a[64:67], v4, s[16:19], s68 offen offset:1024 sc1
  buffer_load_dwordx4 v[44:47], v28, s[16:19], s48 offen offset:1280 sc1
  buffer_load_dwordx4 a[68:71], v4, s[16:19], s70 offen sc1
  s_add_u32 s70, s70, 16384
  buffer_load_dwordx4 a[72:75], v4, s[16:19], s68 offen offset:2048 sc1
  buffer_load_dwordx4 a[76:79], v4, s[16:19], s68 offen offset:3072 sc1
  s_add_u32 s68, s68, 65536
  buffer_load_dwordx2 v[186:187], v14, s[16:19], s48 offen offset:1792 sc1
  s_add_u32 s48, s48, 262144
  buffer_load_dwordx4 v[88:91], v4, s[16:19], s47 offen sc1
  buffer_load_dwordx2 v[92:93], v5, s[16:19], s47 offen offset:2048 sc1
  s_add_u32 s47, s47, 13824
  s_branch pv_303
pv_302:
  buffer_load_dwordx4 a[0:3], v4, s[16:19], s68 offen offset:0 sc1
  buffer_load_dwordx4 a[4:7], v4, s[16:19], s68 offen offset:1024 sc1
  buffer_load_dwordx4 a[8:11], v4, s[16:19], s70 offen sc1
  s_add_u32 s70, s70, 16384
  buffer_load_dwordx4 a[12:15], v4, s[16:19], s68 offen offset:2048 sc1
  buffer_load_dwordx4 a[16:19], v4, s[16:19], s68 offen offset:3072 sc1
  s_add_u32 s68, s68, 65536
  buffer_load_dwordx4 a[20:23], v4, s[16:19], s68 offen offset:0 sc1
  buffer_load_dwordx4 a[24:27], v4, s[16:19], s68 offen offset:1024 sc1
  buffer_load_dwordx4 a[28:31], v4, s[16:19], s70 offen sc1
  s_add_u32 s70, s70, 16384
  buffer_load_dwordx4 a[32:35], v4, s[16:19], s68 offen offset:2048 sc1
  buffer_load_dwordx4 a[36:39], v4, s[16:19], s68 offen offset:3072 sc1
  s_add_u32 s68, s68, 65536
  buffer_load_dwordx4 a[40:43], v4, s[16:19], s68 offen offset:0 sc1
  buffer_load_dwordx4 a[44:47], v4, s[16:19], s68 offen offset:1024 sc1
  buffer_load_dwordx4 a[48:51], v4, s[16:19], s70 offen sc1
  s_add_u32 s70, s70, 16384
  buffer_load_dwordx4 a[52:55], v4, s[16:19], s68 offen offset:2048 sc1
  buffer_load_dwordx4 a[56:59], v4, s[16:19], s68 offen offset:3072 sc1
  s_add_u32 s68, s68, 65536
  buffer_load_dwordx4 a[60:63], v4, s[16:19], s68 offen offset:0 sc1
  buffer_load_dwordx4 a[64:67], v4, s[16:19], s68 offen offset:1024 sc1
  buffer_load_dwordx4 a[68:71], v4, s[16:19], s70 offen sc1
  s_add_u32 s70, s70, 16384
  buffer_load_dwordx4 a[72:75], v4, s[16:19], s68 offen offset:2048 sc1
  buffer_load_dwordx4 a[76:79], v4, s[16:19], s68 offen offset:3072 sc1
  s_add_u32 s68, s68, 65536
  buffer_load_dwordx4 a[80:83], v4, s[16:19], s68 offen offset:0 sc1
  buffer_load_dwordx4 a[84:87], v4, s[16:19], s68 offen offset:1024 sc1
  buffer_load_dwordx4 a[88:91], v4, s[16:19], s70 offen sc1
  s_add_u32 s70, s70, 16384
  buffer_load_dwordx4 a[92:95], v4, s[16:19], s68 offen offset:2048 sc1
  buffer_load_dwordx4 a[96:99], v4, s[16:19], s68 offen offset:3072 sc1
  s_add_u32 s68, s68, 65536
  buffer_load_dwordx4 a[100:103], v4, s[16:19], s68 offen offset:0 sc1
  buffer_load_dwordx4 a[104:107], v4, s[16:19], s68 offen offset:1024 sc1
  buffer_load_dwordx4 a[108:111], v4, s[16:19], s70 offen sc1
  s_add_u32 s70, s70, 16384
  buffer_load_dwordx4 a[112:115], v4, s[16:19], s68 offen offset:2048 sc1
  buffer_load_dwordx4 a[116:119], v4, s[16:19], s68 offen offset:3072 sc1
  s_add_u32 s68, s68, 65536
  buffer_load_dwordx4 a[120:123], v4, s[16:19], s68 offen offset:0 sc1
  buffer_load_dwordx4 a[124:127], v4, s[16:19], s68 offen offset:1024 sc1
  buffer_load_dwordx4 a[128:131], v4, s[16:19], s70 offen sc1
  s_add_u32 s70, s70, 16384
  buffer_load_dwordx4 a[132:135], v4, s[16:19], s68 offen offset:2048 sc1
  buffer_load_dwordx4 a[136:139], v4, s[16:19], s68 offen offset:3072 sc1
  s_add_u32 s68, s68, 65536
  buffer_load_dwordx4 a[140:143], v4, s[16:19], s68 offen offset:0 sc1
  buffer_load_dwordx4 a[144:147], v4, s[16:19], s68 offen offset:1024 sc1
  buffer_load_dwordx4 a[148:151], v4, s[16:19], s70 offen sc1
  s_add_u32 s70, s70, 16384
  buffer_load_dwordx4 a[152:155], v4, s[16:19], s68 offen offset:2048 sc1
  buffer_load_dwordx4 a[156:159], v4, s[16:19], s68 offen offset:3072 sc1
  s_add_u32 s68, s68, 65536
pv_303:
  s_cmp_eq_u32 s71, 1
  s_cbranch_scc1 pv_first
  ds_read_b64_tr_b16 a[160:161], v153 offset:0
  ds_read_b64_tr_b16 a[162:163], v153 offset:3200
  ds_read_b64_tr_b16 a[164:165], v153 offset:8
  ds_read_b64_tr_b16 a[166:167], v153 offset:3208
  ds_read_b64_tr_b16 a[168:169], v152 offset:64
  ds_read_b64_tr_b16 a[170:171], v152 offset:3264
  ds_read_b64_tr_b16 a[172:173], v153 offset:96
  ds_read_b64_tr_b16 a[174:175], v153 offset:3296
  ds_read_b64_tr_b16 a[176:177], v153 offset:104
  ds_read_b64_tr_b16 a[178:179], v153 offset:3304
  ds_read_b64_tr_b16 a[180:181], v153 offset:6400
  ds_read_b64_tr_b16 a[182:183], v153 offset:9600
  ds_read_b64_tr_b16 a[184:185], v153 offset:6408
  ds_read_b64_tr_b16 a[186:187], v153 offset:9608
  ds_read_b64_tr_b16 a[188:189], v152 offset:6464
  ds_read_b64_tr_b16 a[190:191], v152 offset:9664
  ds_read_b64_tr_b16 a[192:193], v153 offset:6496
  ds_read_b64_tr_b16 a[194:195], v153 offset:9696
  ds_read_b64_tr_b16 a[196:197], v153 offset:6504
  ds_read_b64_tr_b16 a[198:199], v153 offset:9704
  ds_read_b64_tr_b16 a[200:201], v153 offset:12800
  ds_read_b64_tr_b16 a[202:203], v153 offset:16000
  ds_read_b64_tr_b16 a[204:205], v153 offset:12808
  ds_read_b64_tr_b16 a[206:207], v153 offset:16008
  ds_read_b64_tr_b16 a[208:209], v152 offset:12864
  ds_read_b64_tr_b16 a[210:211], v152 offset:16064
  ds_read_b64_tr_b16 a[212:213], v153 offset:12896
  ds_read_b64_tr_b16 a[214:215], v153 offset:16096
  ds_read_b64_tr_b16 a[216:217], v153 offset:12904
  ds_read_b64_tr_b16 a[218:219], v153 offset:16104
  ds_read_b64_tr_b16 a[220:221], v153 offset:19200
  ds_read_b64_tr_b16 a[222:223], v153 offset:22400
  ds_read_b64_tr_b16 a[224:225], v153 offset:19208
  ds_read_b64_tr_b16 a[226:227], v153 offset:22408
  ds_read_b64_tr_b16 a[228:229], v152 offset:19264
  ds_read_b64_tr_b16 a[230:231], v152 offset:22464
  ds_read_b64_tr_b16 a[232:233], v153 offset:19296
  ds_read_b64_tr_b16 a[234:235], v153 offset:22496
  ds_read_b64_tr_b16 a[236:237], v153 offset:19304
  ds_read_b64_tr_b16 a[238:239], v153 offset:22504
  ds_read_b64_tr_b16 a[240:241], v155 offset:2560
  ds_read_b64_tr_b16 a[242:243], v155 offset:15360
  ds_read_b64_tr_b16 a[244:245], v155 offset:2568
  ds_read_b64_tr_b16 a[246:247], v155 offset:15368
  ds_read_b64_tr_b16 a[248:249], v154 offset:2624
  ds_read_b64_tr_b16 a[250:251], v154 offset:15424
  ds_read_b64_tr_b16 a[252:253], v155 offset:2656
  ds_read_b64_tr_b16 a[254:255], v155 offset:15456
  ds_read_b64_tr_b16 v[252:253], v155 offset:2664
  ds_read_b64_tr_b16 v[254:255], v155 offset:15464
pv_first:
  s_waitcnt lgkmcnt(0)
  s_barrier
pv_loop:
  s_mov_b32 s63, s40
  s_mul_i32 s46, s57, 20480
  s_mul_i32 s22, s41, 160
  s_add_u32 s49, s46, s22
  s_mul_i32 s21, s44, 96
  s_add_u32 s46, s49, s21
  s_sub_u32 s87, s87, 1
  s_waitcnt vmcnt(36)
  v_mov_b32 v24, v232
  s_cmp_lg_u32 s20, 0
  s_cbranch_scc1 pvq_311
  s_mov_b64 exec, 1
  ds_write_b32 v30, v29
  s_mov_b64 exec, -1
pvq_311:
  s_cmp_eq_u32 s62, 0
  s_cbranch_scc1 pvw_306
  v_mfma_f32_16x16x32_bf16 v[144:147], a[160:163], v[192:195], 0
  v_mfma_f32_16x16x32_bf16 v[148:151], a[160:163], v[212:215], 0
  buffer_load_dwordx4 a[80:83], v4, s[16:19], s68 offen offset:0 sc1
  v_mfma_f32_16x16x32_bf16 v[152:155], a[164:167], v[192:195], 0
  v_mfma_f32_16x16x32_bf16 v[156:159], a[164:167], v[212:215], 0
  v_mfma_f32_16x16x32_bf16 v[160:163], a[168:171], v[192:195], 0
  buffer_load_dwordx4 a[84:87], v4, s[16:19], s68 offen offset:1024 sc1
  v_mfma_f32_16x16x32_bf16 v[164:167], a[168:171], v[212:215], 0
  v_mfma_f32_16x16x32_bf16 v[168:171], a[172:175], v[192:195], 0
  v_mfma_f32_16x16x32_bf16 v[172:175], a[172:175], v[212:215], 0
  buffer_load_dwordx4 v[48:51], v22, s[16:19], s48 offen offset:0 sc1
  v_mfma_f32_16x16x32_bf16 v[176:179], a[176:179], v[192:195], 0
  v_mfma_f32_16x16x32_bf16 v[180:183], a[176:179], v[212:215], 0
  buffer_load_dwordx4 a[88:91], v4, s[16:19], s70 offen sc1
  s_add_u32 s70, s70, 16384
  v_mfma_f32_16x16x32_bf16 v[144:147], a[180:183], v[196:199], v[144:147]
  v_mfma_f32_16x16x32_bf16 v[148:151], a[180:183], v[216:219], v[148:151]
  v_mfma_f32_16x16x32_bf16 v[152:155], a[184:187], v[196:199], v[152:155]
  buffer_load_dwordx4 a[92:95], v4, s[16:19], s68 offen offset:2048 sc1
  v_mfma_f32_16x16x32_bf16 v[156:159], a[184:187], v[216:219], v[156:159]
  v_mfma_f32_16x16x32_bf16 v[160:163], a[188:191], v[196:199], v[160:163]
  v_mfma_f32_16x16x32_bf16 v[164:167], a[188:191], v[216:219], v[164:167]
  buffer_load_dwordx4 a[96:99], v4, s[16:19], s68 offen offset:3072 sc1
  s_add_u32 s68, s68, 65536
  v_mfma_f32_16x16x32_bf16 v[168:171], a[192:195], v[196:199], v[168:171]
  v_mfma_f32_16x16x32_bf16 v[172:175], a[192:195], v[216:219], v[172:175]
  v_mfma_f32_16x16x32_bf16 v[176:179], a[196:199], v[196:199], v[176:179]
  buffer_load_dwordx4 v[96:99], v4, s[16:19], s47 offen sc1
  v_mfma_f32_16x16x32_bf16 v[180:183], a[196:199], v[216:219], v[180:183]
  v_mfma_f32_16x16x32_bf16 v[144:147], a[200:203], v[200:203], v[144:147]
  v_mfma_f32_16x16x32_bf16 v[148:151], a[200:203], v[220:223], v[148:151]
  buffer_load_dwordx2 v[100:101], v5, s[16:19], s47 offen offset:2048 sc1
  v_mfma_f32_16x16x32_bf16 v[152:155], a[204:207], v[200:203], v[152:155]
  v_mfma_f32_16x16x32_bf16 v[156:159], a[204:207], v[220:223], v[156:159]
  buffer_load_dwordx4 v[136:139], v21, s[16:19], s47 offen offset:1024 sc1
  s_add_u32 s47, s47, 2560
  v_mfma_f32_16x16x32_bf16 v[160:163], a[208:211], v[200:203], v[160:163]
  v_mfma_f32_16x16x32_bf16 v[164:167], a[208:211], v[220:223], v[164:167]
  v_mfma_f32_16x16x32_bf16 v[168:171], a[212:215], v[200:203], v[168:171]
  buffer_load_dwordx4 a[100:103], v4, s[16:19], s68 offen offset:0 sc1
  v_mfma_f32_16x16x32_bf16 v[172:175], a[212:215], v[220:223], v[172:175]
  v_mfma_f32_16x16x32_bf16 v[176:179], a[216:219], v[200:203], v[176:179]
  v_mfma_f32_16x16x32_bf16 v[180:183], a[216:219], v[220:223], v[180:183]
  buffer_load_dwordx4 a[104:107], v4, s[16:19], s68 offen offset:1024 sc1
  v_mfma_f32_16x16x32_bf16 v[144:147], a[220:223], v[204:207], v[144:147]
  v_mfma_f32_16x16x32_bf16 v[148:151], a[220:223], v[224:227], v[148:151]
  v_mfma_f32_16x16x32_bf16 v[152:155], a[224:227], v[204:207], v[152:155]
  buffer_load_dwordx4 v[56:59], v28, s[16:19], s48 offen offset:0 sc1
  v_mfma_f32_16x16x32_bf16 v[156:159], a[224:227], v[224:227], v[156:159]
  v_mfma_f32_16x16x32_bf16 v[160:163], a[228:231], v[204:207], v[160:163]
  v_mfma_f32_16x16x32_bf16 v[164:167], a[228:231], v[224:227], v[164:167]
  buffer_load_dwordx4 a[108:111], v4, s[16:19], s70 offen sc1
  s_add_u32 s70, s70, 16384
  v_mfma_f32_16x16x32_bf16 v[168:171], a[232:235], v[204:207], v[168:171]
  v_mfma_f32_16x16x32_bf16 v[172:175], a[232:235], v[224:227], v[172:175]
  buffer_load_dwordx4 a[112:115], v4, s[16:19], s68 offen offset:2048 sc1
  v_mfma_f32_16x16x32_bf16 v[176:179], a[236:239], v[204:207], v[176:179]
  v_mfma_f32_16x16x32_bf16 v[180:183], a[236:239], v[224:227], v[180:183]
  v_mfma_f32_16x16x32_bf16 v[144:147], a[240:243], v[208:211], v[144:147]
  buffer_load_dwordx4 a[116:119], v4, s[16:19], s68 offen offset:3072 sc1
  s_add_u32 s68, s68, 65536
  v_mfma_f32_16x16x32_bf16 v[148:151], a[240:243], v[228:231], v[148:151]
  v_mfma_f32_16x16x32_bf16 v[152:155], a[244:247], v[208:211], v[152:155]
  v_mfma_f32_16x16x32_bf16 v[156:159], a[244:247], v[228:231], v[156:159]
  buffer_load_dwordx2 v[188:189], v14, s[16:19], s48 offen offset:512 sc1
  v_mfma_f32_16x16x32_bf16 v[160:163], a[248:251], v[208:211], v[160:163]
  v_mfma_f32_16x16x32_bf16 v[164:167], a[248:251], v[228:231], v[164:167]
  v_mfma_f32_16x16x32_bf16 v[168:171], a[252:255], v[208:211], v[168:171]
  buffer_load_dwordx4 v[104:107], v4, s[16:19], s47 offen sc1
  v_mfma_f32_16x16x32_bf16 v[172:175], a[252:255], v[228:231], v[172:175]
  v_mfma_f32_16x16x32_bf16 v[176:179], v[252:255], v[208:211], v[176:179]
  v_mfma_f32_16x16x32_bf16 v[180:183], v[252:255], v[228:231], v[180:183]
  buffer_load_dwordx2 v[108:109], v5, s[16:19], s47 offen offset:2048 sc1
  s_add_u32 s47, s47, 13824
  ds_write_b128 v10, v[144:147] offset:40960
  buffer_load_dwordx4 a[120:123], v4, s[16:19], s68 offen offset:0 sc1
  ds_write_b128 v10, v[148:151] offset:41984
  buffer_load_dwordx4 a[124:127], v4, s[16:19], s68 offen offset:1024 sc1
  ds_write_b128 v10, v[152:155] offset:43008
  ds_write_b128 v10, v[156:159] offset:44032
  s_waitcnt vmcnt(40)
  buffer_load_dwordx4 v[52:55], v22, s[16:19], s48 offen offset:1280 sc1
  ds_write_b128 v10, v[160:163] offset:45056
  buffer_load_dwordx4 a[128:131], v4, s[16:19], s70 offen sc1
  s_add_u32 s70, s70, 16384
  ds_write_b128 v10, v[164:167] offset:46080
  buffer_load_dwordx4 a[132:135], v4, s[16:19], s68 offen offset:2048 sc1
  ds_write_b128 v10, v[168:171] offset:47104
  buffer_load_dwordx4 a[136:139], v4, s[16:19], s68 offen offset:3072 sc1
  s_add_u32 s68, s68, 65536
  ds_write_b128 v10, v[172:175] offset:48128
  buffer_load_dwordx4 v[112:115], v4, s[16:19], s47 offen sc1
  s_nop 1
  ds_write_b128 v10, v[176:179] offset:49152
  buffer_load_dwordx2 v[116:117], v5, s[16:19], s47 offen offset:2048 sc1
  ds_write_b128 v10, v[180:183] offset:50176
  buffer_load_dwordx4 v[140:143], v21, s[16:19], s47 offen offset:1024 sc1
  s_add_u32 s47, s47, 2560
  s_waitcnt lgkmcnt(0)
  s_barrier
  ds_read_b32 v23, v30
  s_waitcnt lgkmcnt(0)
  v_readfirstlane_b32 s2, v23
  s_min_u32 s2, s2, 16
  s_cmp_eq_u32 s65, 0
  s_cselect_b32 s2, 17, s2
  buffer_load_dwordx4 a[140:143], v4, s[16:19], s68 offen offset:0 sc1
  s_lshl_b32 s40, s2, 2
  s_add_u32 s40, s40, s58
  s_lshl_b32 s21, s40, 7
  s_add_u32 s21, s21, 8192
  s_xor_b32 s21, s21, s80
  v_mov_b32 v18, s21
  v_cndmask_b32 v18, v17, v18, s[66:67]
  s_add_u32 s21, s40, 1
  v_mov_b32 v19, s21
  v_cndmask_b32 v19, v19, 32, s[66:67]
  buffer_load_dword v27, v18, s[72:75], 0 offen sc1
  buffer_load_dwordx4 a[144:147], v4, s[16:19], s68 offen offset:1024 sc1
  v_sub_f32 v25, 1.0, v24
  v_cvt_pk_bf16_f32 v26, v25, v25
  v_lshlrev_b32 v25, 16, v26
  ds_read_b128 v[144:147], v15 offset:0
  ds_read_b128 v[148:151], v15 offset:10240
  ds_read_b128 v[152:155], v15 offset:20480
  ds_read_b128 v[156:159], v15 offset:30720
  ds_read_b128 v[160:163], v15 offset:2048
  ds_read_b128 v[164:167], v15 offset:12288
  ds_read_b128 v[168:171], v15 offset:22528
  ds_read_b128 v[172:175], v15 offset:32768
  s_waitcnt lgkmcnt(4)
  buffer_load_dwordx4 v[60:63], v28, s[16:19], s48 offen offset:1280 sc1
  v_pk_add_f32 v[144:145], v[144:145], v[148:149]
  v_pk_add_f32 v[152:153], v[152:153], v[156:157]
  v_pk_add_f32 v[146:147], v[146:147], v[150:151]
  v_pk_add_f32 v[154:155], v[154:155], v[158:159]
  v_pk_add_f32 v[176:177], v[144:145], v[152:153]
  v_pk_add_f32 v[178:179], v[146:147], v[154:155]
  ds_read_b128 v[144:147], v16 offset:0
  ds_read_b128 v[148:151], v16 offset:10240
  ds_read_b128 v[152:155], v16 offset:20480
  ds_read_b128 v[156:159], v16 offset:30720
  v_cvt_pk_bf16_f32 v26, v176, v177
  buffer_load_dwordx4 a[148:151], v4, s[16:19], s70 offen sc1
  s_add_u32 s70, s70, 16384
  v_lshlrev_b32 v240, 16, v26
  v_and_b32 v241, 0xffff0000, v26
  v_mul_f32 v240, v240, v25
  v_mul_f32 v241, v241, v25
  v_cvt_pk_bf16_f32 v26, v240, v241
  v_lshlrev_b32 v240, 16, v26
  v_and_b32 v241, 0xffff0000, v26
  v_cvt_pk_bf16_f32 v26, v178, v179
  v_lshlrev_b32 v242, 16, v26
  v_and_b32 v243, 0xffff0000, v26
  v_mul_f32 v242, v242, v25
  buffer_load_dwordx4 a[152:155], v4, s[16:19], s68 offen offset:2048 sc1
  v_mul_f32 v243, v243, v25
  v_cvt_pk_bf16_f32 v26, v242, v243
  v_lshlrev_b32 v242, 16, v26
  v_and_b32 v243, 0xffff0000, v26
  s_waitcnt lgkmcnt(4)
  v_pk_add_f32 v[160:161], v[160:161], v[164:165]
  v_pk_add_f32 v[168:169], v[168:169], v[172:173]
  v_pk_add_f32 v[162:163], v[162:163], v[166:167]
  v_pk_add_f32 v[170:171], v[170:171], v[174:175]
  v_pk_add_f32 v[176:177], v[160:161], v[168:169]
  v_pk_add_f32 v[178:179], v[162:163], v[170:171]
  buffer_load_dwordx4 a[156:159], v4, s[16:19], s68 offen offset:3072 sc1
  s_add_u32 s68, s68, 65536
  v_cvt_pk_bf16_f32 v26, v176, v177
  v_lshlrev_b32 v244, 16, v26
  v_and_b32 v245, 0xffff0000, v26
  v_mul_f32 v244, v244, v25
  v_mul_f32 v245, v245, v25
  v_cvt_pk_bf16_f32 v26, v244, v245
  v_lshlrev_b32 v244, 16, v26
  v_and_b32 v245, 0xffff0000, v26
  v_cvt_pk_bf16_f32 v26, v178, v179
  v_lshlrev_b32 v246, 16, v26
  v_and_b32 v247, 0xffff0000, v26
  buffer_load_dwordx2 v[190:191], v14, s[16:19], s48 offen offset:1792 sc1
  s_add_u32 s48, s48, 262144
  v_mul_f32 v246, v246, v25
  v_mul_f32 v247, v247, v25
  v_cvt_pk_bf16_f32 v26, v246, v247
  v_lshlrev_b32 v246, 16, v26
  v_and_b32 v247, 0xffff0000, v26
  s_waitcnt lgkmcnt(0)
  v_pk_add_f32 v[144:145], v[144:145], v[148:149]
  v_pk_add_f32 v[152:153], v[152:153], v[156:157]
  v_pk_add_f32 v[146:147], v[146:147], v[150:151]
  v_pk_add_f32 v[154:155], v[154:155], v[158:159]
  v_pk_add_f32 v[176:177], v[144:145], v[152:153]
  v_pk_add_f32 v[178:179], v[146:147], v[154:155]
  buffer_load_dwordx4 v[120:123], v4, s[16:19], s47 offen sc1
  v_cvt_pk_bf16_f32 v26, v176, v177
  v_lshlrev_b32 v248, 16, v26
  v_and_b32 v249, 0xffff0000, v26
  v_mul_f32 v248, v248, v25
  v_mul_f32 v249, v249, v25
  v_cvt_pk_bf16_f32 v26, v248, v249
  v_lshlrev_b32 v248, 16, v26
  v_and_b32 v249, 0xffff0000, v26
  v_cvt_pk_bf16_f32 v26, v178, v179
  v_lshlrev_b32 v250, 16, v26
  v_and_b32 v251, 0xffff0000, v26
  buffer_load_dwordx2 v[124:125], v5, s[16:19], s47 offen offset:2048 sc1
  s_add_u32 s47, s47, 13824
  v_mul_f32 v250, v250, v25
  v_mul_f32 v251, v251, v25
  v_cvt_pk_bf16_f32 v26, v250, v251
  v_lshlrev_b32 v250, 16, v26
  v_and_b32 v251, 0xffff0000, v26
  s_barrier
  s_lshl_b32 s55, s40, 19
  s_lshl_b32 s21, s40, 11
  s_and_b32 s21, s21, 8192
  s_xor_b32 s21, s21, s80
  s_add_u32 s55, s55, s21
  s_add_u32 s55, s55, 136314880
  s_lshl_b32 s21, s20, 15
  s_xor_b32 s54, s55, 8192
  s_add_u32 s54, s54, 48234496
  s_add_u32 s54, s54, s21
  s_lshl_b32 s57, s40, 1
  s_add_u32 s57, s57, s43
  s_lshl_b32 s45, s57, 6
  s_add_u32 s69, s54, 262144
  s_cmp_lt_u32 s2, 16
  s_cselect_b32 s69, s69, 0x40000000
  s_cmp_lt_u32 s2, 12
  s_cselect_b32 s65, s87, 0
  s_cmp_gt_u32 s65, 1
  s_cselect_b32 s64, s59, 0x40000000
  s_cselect_b32 s65, 1, 0
  s_waitcnt vmcnt(37)
  v_mfma_f32_16x16x32_bf16 v[148:151], a[0:3], v[64:67], 0
  v_mfma_f32_16x16x32_bf16 v[144:147], a[0:3], v[68:71], 0
  v_mov_b32 v29, 1
  buffer_atomic_add v29, v233, s[72:75], s64 offen sc0 sc1
  v_mfma_f32_16x16x32_bf16 v[156:159], a[4:7], v[64:67], 0
  v_mfma_f32_16x16x32_bf16 v[152:155], a[4:7], v[68:71], 0
  v_mfma_f32_16x16x32_bf16 v[164:167], a[8:11], v[64:67], 0
  v_mfma_f32_16x16x32_bf16 v[160:163], a[8:11], v[68:71], 0
  buffer_load_dword v232, v6, s[28:31], s45 offen sc1
  v_mfma_f32_16x16x32_bf16 v[172:175], a[12:15], v[64:67], 0
  v_mfma_f32_16x16x32_bf16 v[168:171], a[12:15], v[68:71], 0
  v_mfma_f32_16x16x32_bf16 v[180:183], a[16:19], v[64:67], 0
  v_mfma_f32_16x16x32_bf16 v[176:179], a[16:19], v[68:71], 0
  buffer_load_dwordx4 v[192:195], v4, s[16:19], s69 offen offset:0 sc1
  v_mfma_f32_16x16x32_bf16 v[148:151], a[20:23], v[72:75], v[148:151]
  v_mfma_f32_16x16x32_bf16 v[144:147], a[20:23], v[76:79], v[144:147]
  v_mfma_f32_16x16x32_bf16 v[156:159], a[24:27], v[72:75], v[156:159]
  v_mfma_f32_16x16x32_bf16 v[152:155], a[24:27], v[76:79], v[152:155]
  buffer_load_dwordx4 v[196:199], v4, s[16:19], s69 offen offset:1024 sc1
  v_mfma_f32_16x16x32_bf16 v[164:167], a[28:31], v[72:75], v[164:167]
  v_mfma_f32_16x16x32_bf16 v[160:163], a[28:31], v[76:79], v[160:163]
  v_mfma_f32_16x16x32_bf16 v[172:175], a[32:35], v[72:75], v[172:175]
  buffer_load_dwordx2 v[208:209], v5, s[16:19], s69 offen offset:2048 sc1
  s_add_u32 s69, s69, 2560
  v_mfma_f32_16x16x32_bf16 v[168:171], a[32:35], v[76:79], v[168:171]
  v_mfma_f32_16x16x32_bf16 v[180:183], a[36:39], v[72:75], v[180:183]
  v_mfma_f32_16x16x32_bf16 v[176:179], a[36:39], v[76:79], v[176:179]
  v_mfma_f32_16x16x32_bf16 v[148:151], a[40:43], v[80:83], v[148:151]
  buffer_load_dwordx4 v[200:203], v4, s[16:19], s69 offen offset:0 sc1
  v_mfma_f32_16x16x32_bf16 v[144:147], a[40:43], v[84:87], v[144:147]
  v_mfma_f32_16x16x32_bf16 v[156:159], a[44:47], v[80:83], v[156:159]
  v_mfma_f32_16x16x32_bf16 v[152:155], a[44:47], v[84:87], v[152:155]
  v_mfma_f32_16x16x32_bf16 v[164:167], a[48:51], v[80:83], v[164:167]
  buffer_load_dwordx4 v[204:207], v4, s[16:19], s69 offen offset:1024 sc1
  v_mfma_f32_16x16x32_bf16 v[160:163], a[48:51], v[84:87], v[160:163]
  v_mfma_f32_16x16x32_bf16 v[172:175], a[52:55], v[80:83], v[172:175]
  v_mfma_f32_16x16x32_bf16 v[168:171], a[52:55], v[84:87], v[168:171]
  buffer_load_dwordx2 v[210:211], v5, s[16:19], s69 offen offset:2048 sc1
  s_add_u32 s69, s69, 13824
  v_mfma_f32_16x16x32_bf16 v[180:183], a[56:59], v[80:83], v[180:183]
  v_mfma_f32_16x16x32_bf16 v[176:179], a[56:59], v[84:87], v[176:179]
  v_mfma_f32_16x16x32_bf16 v[148:151], a[60:63], v[88:91], v[148:151]
  v_mfma_f32_16x16x32_bf16 v[144:147], a[60:63], v[92:95], v[144:147]
  buffer_load_dwordx4 v[212:215], v4, s[16:19], s69 offen offset:0 sc1
  v_mfma_f32_16x16x32_bf16 v[156:159], a[64:67], v[88:91], v[156:159]
  v_mfma_f32_16x16x32_bf16 v[152:155], a[64:67], v[92:95], v[152:155]
  v_mfma_f32_16x16x32_bf16 v[164:167], a[68:71], v[88:91], v[164:167]
  v_mfma_f32_16x16x32_bf16 v[160:163], a[68:71], v[92:95], v[160:163]
  buffer_load_dwordx4 v[216:219], v4, s[16:19], s69 offen offset:1024 sc1
  v_mfma_f32_16x16x32_bf16 v[172:175], a[72:75], v[88:91], v[172:175]
  v_mfma_f32_16x16x32_bf16 v[168:171], a[72:75], v[92:95], v[168:171]
  v_mfma_f32_16x16x32_bf16 v[180:183], a[76:79], v[88:91], v[180:183]
  v_mfma_f32_16x16x32_bf16 v[176:179], a[76:79], v[92:95], v[176:179]
  buffer_load_dwordx2 v[228:229], v5, s[16:19], s69 offen offset:2048 sc1
  s_add_u32 s69, s69, 2560
  v_swap_b32 v130, v132
  v_swap_b32 v131, v133
  v_swap_b32 v34, v36
  v_swap_b32 v35, v37
  v_swap_b32 v42, v44
  v_swap_b32 v43, v45
  s_nop 1
  v_mfma_f32_16x16x32_bf16 v[144:147], v[32:35], v[128:131], v[144:147]
  v_mfma_f32_16x16x32_bf16 v[148:151], v[32:35], v[132:135], v[148:151]
  buffer_load_dwordx4 v[220:223], v4, s[16:19], s69 offen offset:0 sc1
  v_mfma_f32_16x16x32_bf16 v[152:155], v[36:39], v[128:131], v[152:155]
  v_mfma_f32_16x16x32_bf16 v[156:159], v[36:39], v[132:135], v[156:159]
  v_mfma_f32_16x16x32_bf16 v[160:163], v[184:187], v[128:131], v[160:163]
  buffer_load_dwordx4 v[224:227], v4, s[16:19], s69 offen offset:1024 sc1
  v_mfma_f32_16x16x32_bf16 v[164:167], v[184:187], v[132:135], v[164:167]
  v_mfma_f32_16x16x32_bf16 v[168:171], v[40:43], v[128:131], v[168:171]
  v_mfma_f32_16x16x32_bf16 v[172:175], v[40:43], v[132:135], v[172:175]
  v_mfma_f32_16x16x32_bf16 v[176:179], v[44:47], v[128:131], v[176:179]
  buffer_load_dwordx2 v[230:231], v5, s[16:19], s69 offen offset:2048 sc1
  s_add_u32 s69, s69, 13824
  v_mfma_f32_16x16x32_bf16 v[180:183], v[44:47], v[132:135], v[180:183]
  s_waitcnt vmcnt(22)
  v_cmp_gt_u32 vcc, v19, v27
  s_cmp_le_u32 s50, s40
  s_cbranch_scc1 pv_312
  s_cbranch_vccnz pv_312
  s_lshl_b32 s61, s40, 21
  s_lshl_b32 s21, s40, 13
  s_and_b32 s21, s21, 8192
  s_xor_b32 s21, s21, s80
  s_add_u32 s61, s61, s21
  s_lshl_b32 s21, s20, 15
  s_add_u32 s47, s54, s21
  s_add_u32 s48, s61, s60
  s_xor_b32 s68, s61, 8192
  s_add_u32 s68, s68, s53
  s_add_u32 s70, s55, s42
  s_xor_b32 s70, s70, 0
  s_waitcnt vmcnt(42)
  v_mfma_f32_16x16x32_bf16 v[148:151], a[80:83], v[96:99], v[148:151]
  v_mfma_f32_16x16x32_bf16 v[144:147], a[80:83], v[100:103], v[144:147]
  buffer_load_dwordx4 a[0:3], v4, s[16:19], s68 offen offset:0 sc1
  v_mfma_f32_16x16x32_bf16 v[156:159], a[84:87], v[96:99], v[156:159]
  v_mfma_f32_16x16x32_bf16 v[152:155], a[84:87], v[100:103], v[152:155]
  v_mfma_f32_16x16x32_bf16 v[164:167], a[88:91], v[96:99], v[164:167]
  buffer_load_dwordx4 a[4:7], v4, s[16:19], s68 offen offset:1024 sc1
  v_mfma_f32_16x16x32_bf16 v[160:163], a[88:91], v[100:103], v[160:163]
  v_mfma_f32_16x16x32_bf16 v[172:175], a[92:95], v[96:99], v[172:175]
  v_mfma_f32_16x16x32_bf16 v[168:171], a[92:95], v[100:103], v[168:171]
  buffer_load_dwordx4 v[32:35], v22, s[16:19], s48 offen offset:0 sc1
  v_mfma_f32_16x16x32_bf16 v[180:183], a[96:99], v[96:99], v[180:183]
  v_mfma_f32_16x16x32_bf16 v[176:179], a[96:99], v[100:103], v[176:179]
  s_waitcnt vmcnt(36)
  v_mfma_f32_16x16x32_bf16 v[148:151], a[100:103], v[104:107], v[148:151]
  buffer_load_dwordx4 a[8:11], v4, s[16:19], s70 offen sc1
  s_add_u32 s70, s70, 16384
  v_mfma_f32_16x16x32_bf16 v[144:147], a[100:103], v[108:111], v[144:147]
  v_mfma_f32_16x16x32_bf16 v[156:159], a[104:107], v[104:107], v[156:159]
  v_mfma_f32_16x16x32_bf16 v[152:155], a[104:107], v[108:111], v[152:155]
  buffer_load_dwordx4 a[12:15], v4, s[16:19], s68 offen offset:2048 sc1
  v_mfma_f32_16x16x32_bf16 v[164:167], a[108:111], v[104:107], v[164:167]
  v_mfma_f32_16x16x32_bf16 v[160:163], a[108:111], v[108:111], v[160:163]
  buffer_load_dwordx4 a[16:19], v4, s[16:19], s68 offen offset:3072 sc1
  s_add_u32 s68, s68, 65536
  v_mfma_f32_16x16x32_bf16 v[172:175], a[112:115], v[104:107], v[172:175]
  v_mfma_f32_16x16x32_bf16 v[168:171], a[112:115], v[108:111], v[168:171]
  v_mfma_f32_16x16x32_bf16 v[180:183], a[116:119], v[104:107], v[180:183]
  buffer_load_dwordx4 v[64:67], v4, s[16:19], s47 offen sc1
  v_mfma_f32_16x16x32_bf16 v[176:179], a[116:119], v[108:111], v[176:179]
  s_waitcnt vmcnt(31)
  v_mfma_f32_16x16x32_bf16 v[148:151], a[120:123], v[112:115], v[148:151]
  v_mfma_f32_16x16x32_bf16 v[144:147], a[120:123], v[116:119], v[144:147]
  buffer_load_dwordx2 v[68:69], v5, s[16:19], s47 offen offset:2048 sc1
  v_mfma_f32_16x16x32_bf16 v[156:159], a[124:127], v[112:115], v[156:159]
  v_mfma_f32_16x16x32_bf16 v[152:155], a[124:127], v[116:119], v[152:155]
  v_mfma_f32_16x16x32_bf16 v[164:167], a[128:131], v[112:115], v[164:167]
  buffer_load_dwordx4 v[128:131], v21, s[16:19], s47 offen offset:1024 sc1
  s_add_u32 s47, s47, 2560
  v_mfma_f32_16x16x32_bf16 v[160:163], a[128:131], v[116:119], v[160:163]
  v_mfma_f32_16x16x32_bf16 v[172:175], a[132:135], v[112:115], v[172:175]
  v_mfma_f32_16x16x32_bf16 v[168:171], a[132:135], v[116:119], v[168:171]
  buffer_load_dwordx4 a[20:23], v4, s[16:19], s68 offen offset:0 sc1
  v_mfma_f32_16x16x32_bf16 v[180:183], a[136:139], v[112:115], v[180:183]
  v_mfma_f32_16x16x32_bf16 v[176:179], a[136:139], v[116:119], v[176:179]
  s_waitcnt vmcnt(24)
  v_mfma_f32_16x16x32_bf16 v[148:151], a[140:143], v[120:123], v[148:151]
  buffer_load_dwordx4 a[24:27], v4, s[16:19], s68 offen offset:1024 sc1
  v_mfma_f32_16x16x32_bf16 v[144:147], a[140:143], v[124:127], v[144:147]
  v_mfma_f32_16x16x32_bf16 v[156:159], a[144:147], v[120:123], v[156:159]
  v_mfma_f32_16x16x32_bf16 v[152:155], a[144:147], v[124:127], v[152:155]
  buffer_load_dwordx4 v[40:43], v28, s[16:19], s48 offen offset:0 sc1
  v_mfma_f32_16x16x32_bf16 v[164:167], a[148:151], v[120:123], v[164:167]
  v_mfma_f32_16x16x32_bf16 v[160:163], a[148:151], v[124:127], v[160:163]
  v_mfma_f32_16x16x32_bf16 v[172:175], a[152:155], v[120:123], v[172:175]
  buffer_load_dwordx4 a[28:31], v4, s[16:19], s70 offen sc1
  s_add_u32 s70, s70, 16384
  v_mfma_f32_16x16x32_bf16 v[168:171], a[152:155], v[124:127], v[168:171]
  v_mfma_f32_16x16x32_bf16 v[180:183], a[156:159], v[120:123], v[180:183]
  v_mfma_f32_16x16x32_bf16 v[176:179], a[156:159], v[124:127], v[176:179]
  buffer_load_dwordx4 a[32:35], v4, s[16:19], s68 offen offset:2048 sc1
  v_swap_b32 v138, v140
  v_swap_b32 v139, v141
  v_swap_b32 v50, v52
  v_swap_b32 v51, v53
  v_swap_b32 v58, v60
  v_swap_b32 v59, v61
  s_nop 1
  v_mfma_f32_16x16x32_bf16 v[144:147], v[48:51], v[136:139], v[144:147]
  buffer_load_dwordx4 a[36:39], v4, s[16:19], s68 offen offset:3072 sc1
  s_add_u32 s68, s68, 65536
  v_mfma_f32_16x16x32_bf16 v[148:151], v[48:51], v[140:143], v[148:151]
  v_mfma_f32_16x16x32_bf16 v[152:155], v[52:55], v[136:139], v[152:155]
  v_mfma_f32_16x16x32_bf16 v[156:159], v[52:55], v[140:143], v[156:159]
  buffer_load_dwordx2 v[184:185], v14, s[16:19], s48 offen offset:512 sc1
  v_mfma_f32_16x16x32_bf16 v[160:163], v[188:191], v[136:139], v[160:163]
  v_mfma_f32_16x16x32_bf16 v[164:167], v[188:191], v[140:143], v[164:167]
  v_mfma_f32_16x16x32_bf16 v[168:171], v[56:59], v[136:139], v[168:171]
  buffer_load_dwordx4 v[72:75], v4, s[16:19], s47 offen sc1
  v_mfma_f32_16x16x32_bf16 v[172:175], v[56:59], v[140:143], v[172:175]
  v_mfma_f32_16x16x32_bf16 v[176:179], v[60:63], v[136:139], v[176:179]
  v_mfma_f32_16x16x32_bf16 v[180:183], v[60:63], v[140:143], v[180:183]
  buffer_load_dwordx2 v[76:77], v5, s[16:19], s47 offen offset:2048 sc1
  s_add_u32 s47, s47, 13824
  s_nop 0
  ds_write_b128 v10, v[144:147] offset:0
  buffer_load_dwordx4 a[40:43], v4, s[16:19], s68 offen offset:0 sc1
  ds_write_b128 v10, v[148:151] offset:1024
  buffer_load_dwordx4 a[44:47], v4, s[16:19], s68 offen offset:1024 sc1
  ds_write_b128 v10, v[152:155] offset:2048
  ds_write_b128 v10, v[156:159] offset:3072
  buffer_load_dwordx4 v[36:39], v22, s[16:19], s48 offen offset:1280 sc1
  ds_write_b128 v10, v[160:163] offset:4096
  buffer_load_dwordx4 a[48:51], v4, s[16:19], s70 offen sc1
  s_add_u32 s70, s70, 16384
  ds_write_b128 v10, v[164:167] offset:5120
  buffer_load_dwordx4 a[52:55], v4, s[16:19], s68 offen offset:2048 sc1
  ds_write_b128 v10, v[168:171] offset:6144
  buffer_load_dwordx4 a[56:59], v4, s[16:19], s68 offen offset:3072 sc1
  s_add_u32 s68, s68, 65536
  ds_write_b128 v10, v[172:175] offset:7168
  buffer_load_dwordx4 v[80:83], v4, s[16:19], s47 offen sc1
  s_nop 1
  ds_write_b128 v10, v[176:179] offset:8192
  buffer_load_dwordx2 v[84:85], v5, s[16:19], s47 offen offset:2048 sc1
  ds_write_b128 v10, v[180:183] offset:9216
  buffer_load_dwordx4 v[132:135], v21, s[16:19], s47 offen offset:1024 sc1
  s_add_u32 s47, s47, 2560
  s_waitcnt lgkmcnt(0)
  s_barrier
  ds_read_b128 v[144:147], v11 offset:0
  ds_read_b128 v[148:151], v11 offset:10240
  ds_read_b128 v[152:155], v11 offset:20480
  ds_read_b128 v[156:159], v11 offset:30720
  ds_read_b128 v[160:163], v11 offset:2048
  ds_read_b128 v[164:167], v11 offset:12288
  ds_read_b128 v[168:171], v11 offset:22528
  ds_read_b128 v[172:175], v11 offset:32768
  s_waitcnt lgkmcnt(4)
  buffer_load_dwordx4 a[60:63], v4, s[16:19], s68 offen offset:0 sc1
  v_pk_add_f32 v[144:145], v[144:145], v[148:149]
  v_pk_add_f32 v[152:153], v[152:153], v[156:157]
  v_pk_add_f32 v[146:147], v[146:147], v[150:151]
  v_pk_add_f32 v[154:155], v[154:155], v[158:159]
  v_pk_add_f32 v[176:177], v[144:145], v[152:153]
  v_pk_add_f32 v[178:179], v[146:147], v[154:155]
  ds_read_b128 v[144:147], v12 offset:0
  ds_read_b128 v[148:151], v12 offset:10240
  ds_read_b128 v[152:155], v12 offset:20480
  ds_read_b128 v[156:159], v12 offset:30720
  v_cvt_pk_bf16_f32 v26, v176, v177
  buffer_load_dwordx4 a[64:67], v4, s[16:19], s68 offen offset:1024 sc1
  v_lshlrev_b32 v176, 16, v26
  v_and_b32 v177, 0xffff0000, v26
  v_mul_f32 v176, v176, v24
  v_mul_f32 v177, v177, v24
  v_cvt_pk_bf16_f32 v26, v176, v177
  v_lshlrev_b32 v176, 16, v26
  v_and_b32 v177, 0xffff0000, v26
  v_add_f32 v176, v176, v240
  v_add_f32 v177, v177, v241
  v_cvt_pk_bf16_f32 v236, v176, v177
  v_cvt_pk_bf16_f32 v26, v178, v179
  v_lshlrev_b32 v178, 16, v26
  buffer_load_dwordx4 v[44:47], v28, s[16:19], s48 offen offset:1280 sc1
  v_and_b32 v179, 0xffff0000, v26
  v_mul_f32 v178, v178, v24
  v_mul_f32 v179, v179, v24
  v_cvt_pk_bf16_f32 v26, v178, v179
  v_lshlrev_b32 v178, 16, v26
  v_and_b32 v179, 0xffff0000, v26
  v_add_f32 v178, v178, v242
  v_add_f32 v179, v179, v243
  v_cvt_pk_bf16_f32 v237, v178, v179
  s_waitcnt lgkmcnt(4)
  v_pk_add_f32 v[160:161], v[160:161], v[164:165]
  v_pk_add_f32 v[168:169], v[168:169], v[172:173]
  buffer_load_dwordx4 a[68:71], v4, s[16:19], s70 offen sc1
  s_add_u32 s70, s70, 16384
  v_pk_add_f32 v[162:163], v[162:163], v[166:167]
  v_pk_add_f32 v[170:171], v[170:171], v[174:175]
  v_pk_add_f32 v[176:177], v[160:161], v[168:169]
  v_pk_add_f32 v[178:179], v[162:163], v[170:171]
  v_cvt_pk_bf16_f32 v26, v176, v177
  v_lshlrev_b32 v176, 16, v26
  v_and_b32 v177, 0xffff0000, v26
  v_mul_f32 v176, v176, v24
  v_mul_f32 v177, v177, v24
  v_cvt_pk_bf16_f32 v26, v176, v177
  v_lshlrev_b32 v176, 16, v26
  buffer_load_dwordx4 a[72:75], v4, s[16:19], s68 offen offset:2048 sc1
  v_and_b32 v177, 0xffff0000, v26
  v_add_f32 v176, v176, v244
  v_add_f32 v177, v177, v245
  v_cvt_pk_bf16_f32 v238, v176, v177
  v_cvt_pk_bf16_f32 v26, v178, v179
  v_lshlrev_b32 v178, 16, v26
  v_and_b32 v179, 0xffff0000, v26
  v_mul_f32 v178, v178, v24
  v_mul_f32 v179, v179, v24
  v_cvt_pk_bf16_f32 v26, v178, v179
  v_lshlrev_b32 v178, 16, v26
  v_and_b32 v179, 0xffff0000, v26
  buffer_load_dwordx4 a[76:79], v4, s[16:19], s68 offen offset:3072 sc1
  s_add_u32 s68, s68, 65536
  v_add_f32 v178, v178, v246
  v_add_f32 v179, v179, v247
  v_cvt_pk_bf16_f32 v239, v178, v179
  buffer_store_dwordx4 v[236:239], v9, s[8:11], s46 offen
  s_cmp_lt_u32 s20, 2
  s_cselect_b32 s49, s49, 0x40000000
  s_waitcnt lgkmcnt(0)
  v_pk_add_f32 v[144:145], v[144:145], v[148:149]
  v_pk_add_f32 v[152:153], v[152:153], v[156:157]
  v_pk_add_f32 v[146:147], v[146:147], v[150:151]
  v_pk_add_f32 v[154:155], v[154:155], v[158:159]
  buffer_load_dwordx2 v[186:187], v14, s[16:19], s48 offen offset:1792 sc1
  s_add_u32 s48, s48, 262144
  v_pk_add_f32 v[176:177], v[144:145], v[152:153]
  v_pk_add_f32 v[178:179], v[146:147], v[154:155]
  v_cvt_pk_bf16_f32 v26, v176, v177
  v_lshlrev_b32 v176, 16, v26
  v_and_b32 v177, 0xffff0000, v26
  v_mul_f32 v176, v176, v24
  v_mul_f32 v177, v177, v24
  v_cvt_pk_bf16_f32 v26, v176, v177
  v_lshlrev_b32 v176, 16, v26
  v_and_b32 v177, 0xffff0000, v26
  v_add_f32 v176, v176, v248
  v_add_f32 v177, v177, v249
  buffer_load_dwordx4 v[88:91], v4, s[16:19], s47 offen sc1
  v_cvt_pk_bf16_f32 v234, v176, v177
  v_cvt_pk_bf16_f32 v26, v178, v179
  v_lshlrev_b32 v178, 16, v26
  v_and_b32 v179, 0xffff0000, v26
  v_mul_f32 v178, v178, v24
  v_mul_f32 v179, v179, v24
  v_cvt_pk_bf16_f32 v26, v178, v179
  v_lshlrev_b32 v178, 16, v26
  v_and_b32 v179, 0xffff0000, v26
  v_add_f32 v178, v178, v250
  v_add_f32 v179, v179, v251
  v_cvt_pk_bf16_f32 v235, v178, v179
  buffer_load_dwordx2 v[92:93], v5, s[16:19], s47 offen offset:2048 sc1
  s_add_u32 s47, s47, 13824
  buffer_store_dwordx2 v[234:235], v13, s[8:11], s49 offen offset:64
  s_branch pv_loop
pv_312:
  s_waitcnt vmcnt(42)
  v_mfma_f32_16x16x32_bf16 v[148:151], a[80:83], v[96:99], v[148:151]
  v_mfma_f32_16x16x32_bf16 v[144:147], a[80:83], v[100:103], v[144:147]
  v_mfma_f32_16x16x32_bf16 v[156:159], a[84:87], v[96:99], v[156:159]
  v_mfma_f32_16x16x32_bf16 v[152:155], a[84:87], v[100:103], v[152:155]
  v_mfma_f32_16x16x32_bf16 v[164:167], a[88:91], v[96:99], v[164:167]
  v_mfma_f32_16x16x32_bf16 v[160:163], a[88:91], v[100:103], v[160:163]
  v_mfma_f32_16x16x32_bf16 v[172:175], a[92:95], v[96:99], v[172:175]
  v_mfma_f32_16x16x32_bf16 v[168:171], a[92:95], v[100:103], v[168:171]
  v_mfma_f32_16x16x32_bf16 v[180:183], a[96:99], v[96:99], v[180:183]
  v_mfma_f32_16x16x32_bf16 v[176:179], a[96:99], v[100:103], v[176:179]
  s_waitcnt vmcnt(33)
  v_mfma_f32_16x16x32_bf16 v[148:151], a[100:103], v[104:107], v[148:151]
  v_mfma_f32_16x16x32_bf16 v[144:147], a[100:103], v[108:111], v[144:147]
  v_mfma_f32_16x16x32_bf16 v[156:159], a[104:107], v[104:107], v[156:159]
  v_mfma_f32_16x16x32_bf16 v[152:155], a[104:107], v[108:111], v[152:155]
  v_mfma_f32_16x16x32_bf16 v[164:167], a[108:111], v[104:107], v[164:167]
  v_mfma_f32_16x16x32_bf16 v[160:163], a[108:111], v[108:111], v[160:163]
  v_mfma_f32_16x16x32_bf16 v[172:175], a[112:115], v[104:107], v[172:175]
  v_mfma_f32_16x16x32_bf16 v[168:171], a[112:115], v[108:111], v[168:171]
  v_mfma_f32_16x16x32_bf16 v[180:183], a[116:119], v[104:107], v[180:183]
  v_mfma_f32_16x16x32_bf16 v[176:179], a[116:119], v[108:111], v[176:179]
  s_waitcnt vmcnt(24)
  v_mfma_f32_16x16x32_bf16 v[148:151], a[120:123], v[112:115], v[148:151]
  v_mfma_f32_16x16x32_bf16 v[144:147], a[120:123], v[116:119], v[144:147]
  v_mfma_f32_16x16x32_bf16 v[156:159], a[124:127], v[112:115], v[156:159]
  v_mfma_f32_16x16x32_bf16 v[152:155], a[124:127], v[116:119], v[152:155]
  v_mfma_f32_16x16x32_bf16 v[164:167], a[128:131], v[112:115], v[164:167]
  v_mfma_f32_16x16x32_bf16 v[160:163], a[128:131], v[116:119], v[160:163]
  v_mfma_f32_16x16x32_bf16 v[172:175], a[132:135], v[112:115], v[172:175]
  v_mfma_f32_16x16x32_bf16 v[168:171], a[132:135], v[116:119], v[168:171]
  v_mfma_f32_16x16x32_bf16 v[180:183], a[136:139], v[112:115], v[180:183]
  v_mfma_f32_16x16x32_bf16 v[176:179], a[136:139], v[116:119], v[176:179]
  s_waitcnt vmcnt(14)
  v_mfma_f32_16x16x32_bf16 v[148:151], a[140:143], v[120:123], v[148:151]
  v_mfma_f32_16x16x32_bf16 v[144:147], a[140:143], v[124:127], v[144:147]
  v_mfma_f32_16x16x32_bf16 v[156:159], a[144:147], v[120:123], v[156:159]
  v_mfma_f32_16x16x32_bf16 v[152:155], a[144:147], v[124:127], v[152:155]
  v_mfma_f32_16x16x32_bf16 v[164:167], a[148:151], v[120:123], v[164:167]
  v_mfma_f32_16x16x32_bf16 v[160:163], a[148:151], v[124:127], v[160:163]
  v_mfma_f32_16x16x32_bf16 v[172:175], a[152:155], v[120:123], v[172:175]
  v_mfma_f32_16x16x32_bf16 v[168:171], a[152:155], v[124:127], v[168:171]
  v_mfma_f32_16x16x32_bf16 v[180:183], a[156:159], v[120:123], v[180:183]
  v_mfma_f32_16x16x32_bf16 v[176:179], a[156:159], v[124:127], v[176:179]
  v_swap_b32 v138, v140
  v_swap_b32 v139, v141
  v_swap_b32 v50, v52
  v_swap_b32 v51, v53
  v_swap_b32 v58, v60
  v_swap_b32 v59, v61
  s_nop 1
  v_mfma_f32_16x16x32_bf16 v[144:147], v[48:51], v[136:139], v[144:147]
  v_mfma_f32_16x16x32_bf16 v[148:151], v[48:51], v[140:143], v[148:151]
  v_mfma_f32_16x16x32_bf16 v[152:155], v[52:55], v[136:139], v[152:155]
  v_mfma_f32_16x16x32_bf16 v[156:159], v[52:55], v[140:143], v[156:159]
  v_mfma_f32_16x16x32_bf16 v[160:163], v[188:191], v[136:139], v[160:163]
  v_mfma_f32_16x16x32_bf16 v[164:167], v[188:191], v[140:143], v[164:167]
  v_mfma_f32_16x16x32_bf16 v[168:171], v[56:59], v[136:139], v[168:171]
  v_mfma_f32_16x16x32_bf16 v[172:175], v[56:59], v[140:143], v[172:175]
  v_mfma_f32_16x16x32_bf16 v[176:179], v[60:63], v[136:139], v[176:179]
  v_mfma_f32_16x16x32_bf16 v[180:183], v[60:63], v[140:143], v[180:183]
  s_branch pve_307
pvw_306:
  v_mfma_f32_16x16x32_bf16 v[144:147], a[160:163], v[192:195], 0
  v_mfma_f32_16x16x32_bf16 v[148:151], a[160:163], v[212:215], 0
  v_mfma_f32_16x16x32_bf16 v[152:155], a[164:167], v[192:195], 0
  v_mfma_f32_16x16x32_bf16 v[156:159], a[164:167], v[212:215], 0
  v_mfma_f32_16x16x32_bf16 v[160:163], a[168:171], v[192:195], 0
  v_mfma_f32_16x16x32_bf16 v[164:167], a[168:171], v[212:215], 0
  v_mfma_f32_16x16x32_bf16 v[168:171], a[172:175], v[192:195], 0
  v_mfma_f32_16x16x32_bf16 v[172:175], a[172:175], v[212:215], 0
  v_mfma_f32_16x16x32_bf16 v[176:179], a[176:179], v[192:195], 0
  v_mfma_f32_16x16x32_bf16 v[180:183], a[176:179], v[212:215], 0
  v_mfma_f32_16x16x32_bf16 v[144:147], a[180:183], v[196:199], v[144:147]
  v_mfma_f32_16x16x32_bf16 v[148:151], a[180:183], v[216:219], v[148:151]
  v_mfma_f32_16x16x32_bf16 v[152:155], a[184:187], v[196:199], v[152:155]
  v_mfma_f32_16x16x32_bf16 v[156:159], a[184:187], v[216:219], v[156:159]
  v_mfma_f32_16x16x32_bf16 v[160:163], a[188:191], v[196:199], v[160:163]
  v_mfma_f32_16x16x32_bf16 v[164:167], a[188:191], v[216:219], v[164:167]
  v_mfma_f32_16x16x32_bf16 v[168:171], a[192:195], v[196:199], v[168:171]
  v_mfma_f32_16x16x32_bf16 v[172:175], a[192:195], v[216:219], v[172:175]
  v_mfma_f32_16x16x32_bf16 v[176:179], a[196:199], v[196:199], v[176:179]
  v_mfma_f32_16x16x32_bf16 v[180:183], a[196:199], v[216:219], v[180:183]
  v_mfma_f32_16x16x32_bf16 v[144:147], a[200:203], v[200:203], v[144:147]
  v_mfma_f32_16x16x32_bf16 v[148:151], a[200:203], v[220:223], v[148:151]
  v_mfma_f32_16x16x32_bf16 v[152:155], a[204:207], v[200:203], v[152:155]
  v_mfma_f32_16x16x32_bf16 v[156:159], a[204:207], v[220:223], v[156:159]
  v_mfma_f32_16x16x32_bf16 v[160:163], a[208:211], v[200:203], v[160:163]
  v_mfma_f32_16x16x32_bf16 v[164:167], a[208:211], v[220:223], v[164:167]
  v_mfma_f32_16x16x32_bf16 v[168:171], a[212:215], v[200:203], v[168:171]
  v_mfma_f32_16x16x32_bf16 v[172:175], a[212:215], v[220:223], v[172:175]
  v_mfma_f32_16x16x32_bf16 v[176:179], a[216:219], v[200:203], v[176:179]
  v_mfma_f32_16x16x32_bf16 v[180:183], a[216:219], v[220:223], v[180:183]
  v_mfma_f32_16x16x32_bf16 v[144:147], a[220:223], v[204:207], v[144:147]
  v_mfma_f32_16x16x32_bf16 v[148:151], a[220:223], v[224:227], v[148:151]
  v_mfma_f32_16x16x32_bf16 v[152:155], a[224:227], v[204:207], v[152:155]
  v_mfma_f32_16x16x32_bf16 v[156:159], a[224:227], v[224:227], v[156:159]
  v_mfma_f32_16x16x32_bf16 v[160:163], a[228:231], v[204:207], v[160:163]
  v_mfma_f32_16x16x32_bf16 v[164:167], a[228:231], v[224:227], v[164:167]
  v_mfma_f32_16x16x32_bf16 v[168:171], a[232:235], v[204:207], v[168:171]
  v_mfma_f32_16x16x32_bf16 v[172:175], a[232:235], v[224:227], v[172:175]
  v_mfma_f32_16x16x32_bf16 v[176:179], a[236:239], v[204:207], v[176:179]
  v_mfma_f32_16x16x32_bf16 v[180:183], a[236:239], v[224:227], v[180:183]
  v_mfma_f32_16x16x32_bf16 v[144:147], a[240:243], v[208:211], v[144:147]
  v_mfma_f32_16x16x32_bf16 v[148:151], a[240:243], v[228:231], v[148:151]
  v_mfma_f32_16x16x32_bf16 v[152:155], a[244:247], v[208:211], v[152:155]
  v_mfma_f32_16x16x32_bf16 v[156:159], a[244:247], v[228:231], v[156:159]
  v_mfma_f32_16x16x32_bf16 v[160:163], a[248:251], v[208:211], v[160:163]
  v_mfma_f32_16x16x32_bf16 v[164:167], a[248:251], v[228:231], v[164:167]
  v_mfma_f32_16x16x32_bf16 v[168:171], a[252:255], v[208:211], v[168:171]
  v_mfma_f32_16x16x32_bf16 v[172:175], a[252:255], v[228:231], v[172:175]
  v_mfma_f32_16x16x32_bf16 v[176:179], v[252:255], v[208:211], v[176:179]
  v_mfma_f32_16x16x32_bf16 v[180:183], v[252:255], v[228:231], v[180:183]
  ds_write_b128 v10, v[144:147] offset:40960
  ds_write_b128 v10, v[148:151] offset:41984
  ds_write_b128 v10, v[152:155] offset:43008
  ds_write_b128 v10, v[156:159] offset:44032
  ds_write_b128 v10, v[160:163] offset:45056
  ds_write_b128 v10, v[164:167] offset:46080
  ds_write_b128 v10, v[168:171] offset:47104
  ds_write_b128 v10, v[172:175] offset:48128
  s_nop 1
  ds_write_b128 v10, v[176:179] offset:49152
  ds_write_b128 v10, v[180:183] offset:50176
  s_waitcnt lgkmcnt(0)
  s_barrier
  ds_read_b32 v23, v30
  s_waitcnt lgkmcnt(0)
  v_readfirstlane_b32 s2, v23
  s_min_u32 s2, s2, 16
  s_cmp_eq_u32 s65, 0
  s_cselect_b32 s2, 17, s2
  v_sub_f32 v25, 1.0, v24
  v_cvt_pk_bf16_f32 v26, v25, v25
  v_lshlrev_b32 v25, 16, v26
  ds_read_b128 v[144:147], v15 offset:0
  ds_read_b128 v[148:151], v15 offset:10240
  ds_read_b128 v[152:155], v15 offset:20480
  ds_read_b128 v[156:159], v15 offset:30720
  ds_read_b128 v[160:163], v15 offset:2048
  ds_read_b128 v[164:167], v15 offset:12288
  ds_read_b128 v[168:171], v15 offset:22528
  ds_read_b128 v[172:175], v15 offset:32768
  s_waitcnt lgkmcnt(4)
  v_pk_add_f32 v[144:145], v[144:145], v[148:149]
  v_pk_add_f32 v[152:153], v[152:153], v[156:157]
  v_pk_add_f32 v[146:147], v[146:147], v[150:151]
  v_pk_add_f32 v[154:155], v[154:155], v[158:159]
  v_pk_add_f32 v[176:177], v[144:145], v[152:153]
  v_pk_add_f32 v[178:179], v[146:147], v[154:155]
  ds_read_b128 v[144:147], v16 offset:0
  ds_read_b128 v[148:151], v16 offset:10240
  ds_read_b128 v[152:155], v16 offset:20480
  ds_read_b128 v[156:159], v16 offset:30720
  v_cvt_pk_bf16_f32 v26, v176, v177
  v_lshlrev_b32 v240, 16, v26
  v_and_b32 v241, 0xffff0000, v26
  v_mul_f32 v240, v240, v25
  v_mul_f32 v241, v241, v25
  v_cvt_pk_bf16_f32 v26, v240, v241
  v_lshlrev_b32 v240, 16, v26
  v_and_b32 v241, 0xffff0000, v26
  v_cvt_pk_bf16_f32 v26, v178, v179
  v_lshlrev_b32 v242, 16, v26
  v_and_b32 v243, 0xffff0000, v26
  v_mul_f32 v242, v242, v25
  v_mul_f32 v243, v243, v25
  v_cvt_pk_bf16_f32 v26, v242, v243
  v_lshlrev_b32 v242, 16, v26
  v_and_b32 v243, 0xffff0000, v26
  s_waitcnt lgkmcnt(4)
  v_pk_add_f32 v[160:161], v[160:161], v[164:165]
  v_pk_add_f32 v[168:169], v[168:169], v[172:173]
  v_pk_add_f32 v[162:163], v[162:163], v[166:167]
  v_pk_add_f32 v[170:171], v[170:171], v[174:175]
  v_pk_add_f32 v[176:177], v[160:161], v[168:169]
  v_pk_add_f32 v[178:179], v[162:163], v[170:171]
  v_cvt_pk_bf16_f32 v26, v176, v177
  v_lshlrev_b32 v244, 16, v26
  v_and_b32 v245, 0xffff0000, v26
  v_mul_f32 v244, v244, v25
  v_mul_f32 v245, v245, v25
  v_cvt_pk_bf16_f32 v26, v244, v245
  v_lshlrev_b32 v244, 16, v26
  v_and_b32 v245, 0xffff0000, v26
  v_cvt_pk_bf16_f32 v26, v178, v179
  v_lshlrev_b32 v246, 16, v26
  v_and_b32 v247, 0xffff0000, v26
  v_mul_f32 v246, v246, v25
  v_mul_f32 v247, v247, v25
  v_cvt_pk_bf16_f32 v26, v246, v247
  v_lshlrev_b32 v246, 16, v26
  v_and_b32 v247, 0xffff0000, v26
  s_waitcnt lgkmcnt(0)
  v_pk_add_f32 v[144:145], v[144:145], v[148:149]
  v_pk_add_f32 v[152:153], v[152:153], v[156:157]
  v_pk_add_f32 v[146:147], v[146:147], v[150:151]
  v_pk_add_f32 v[154:155], v[154:155], v[158:159]
  v_pk_add_f32 v[176:177], v[144:145], v[152:153]
  v_pk_add_f32 v[178:179], v[146:147], v[154:155]
  v_cvt_pk_bf16_f32 v26, v176, v177
  v_lshlrev_b32 v248, 16, v26
  v_and_b32 v249, 0xffff0000, v26
  v_mul_f32 v248, v248, v25
  v_mul_f32 v249, v249, v25
  v_cvt_pk_bf16_f32 v26, v248, v249
  v_lshlrev_b32 v248, 16, v26
  v_and_b32 v249, 0xffff0000, v26
  v_cvt_pk_bf16_f32 v26, v178, v179
  v_lshlrev_b32 v250, 16, v26
  v_and_b32 v251, 0xffff0000, v26
  v_mul_f32 v250, v250, v25
  v_mul_f32 v251, v251, v25
  v_cvt_pk_bf16_f32 v26, v250, v251
  v_lshlrev_b32 v250, 16, v26
  v_and_b32 v251, 0xffff0000, v26
  s_cmp_ge_u32 s40, 60
  s_cbranch_scc1 pvt_313
  s_cmp_lg_u32 s20, 0
  s_cbranch_scc1 wr_315
  s_mov_b32 s101, 0
wr_314:
  buffer_load_dword v26, v18, s[72:75], 0 offen sc1
  s_add_u32 s101, s101, 1
  s_cmp_gt_u32 s101, 131072
  s_cbranch_scc1 main_end
  s_waitcnt vmcnt(0)
  v_cmp_gt_u32 vcc, v19, v26
  v_readfirstlane_b32 s100, v26
  s_nop 0
  s_cbranch_vccz wr_315
  s_sleep 2
  s_cmp_lg_u32 s100, 0
  s_cbranch_scc1 wr_314
  s_sleep 24
  s_branch wr_314
wr_315:
  s_barrier
  s_waitcnt vmcnt(10)
  buffer_load_dwordx4 v[64:67], v4, s[16:19], s47 offen sc1
  buffer_load_dwordx2 v[68:69], v5, s[16:19], s47 offen offset:2048 sc1
  buffer_load_dwordx4 v[128:131], v21, s[16:19], s47 offen offset:1024 sc1
  s_add_u32 s47, s47, 2560
  buffer_load_dwordx4 v[72:75], v4, s[16:19], s47 offen sc1
  buffer_load_dwordx2 v[76:77], v5, s[16:19], s47 offen offset:2048 sc1
  s_add_u32 s47, s47, 13824
  buffer_load_dwordx4 v[80:83], v4, s[16:19], s47 offen sc1
  buffer_load_dwordx2 v[84:85], v5, s[16:19], s47 offen offset:2048 sc1
  buffer_load_dwordx4 v[132:135], v21, s[16:19], s47 offen offset:1024 sc1
  s_add_u32 s47, s47, 2560
  buffer_load_dwordx4 v[88:91], v4, s[16:19], s47 offen sc1
  buffer_load_dwordx2 v[92:93], v5, s[16:19], s47 offen offset:2048 sc1
  s_add_u32 s47, s47, 13824
  buffer_load_dwordx4 v[32:35], v22, s[16:19], s48 offen offset:0 sc1
  buffer_load_dwordx4 v[40:43], v28, s[16:19], s48 offen offset:0 sc1
  buffer_load_dwordx2 v[184:185], v14, s[16:19], s48 offen offset:512 sc1
  buffer_load_dwordx4 v[36:39], v22, s[16:19], s48 offen offset:1280 sc1
  buffer_load_dwordx4 v[44:47], v28, s[16:19], s48 offen offset:1280 sc1
  buffer_load_dwordx2 v[186:187], v14, s[16:19], s48 offen offset:1792 sc1
  s_add_u32 s48, s48, 262144
  buffer_load_dwordx4 v[96:99], v4, s[16:19], s47 offen sc1
  buffer_load_dwordx2 v[100:101], v5, s[16:19], s47 offen offset:2048 sc1
  buffer_load_dwordx4 v[136:139], v21, s[16:19], s47 offen offset:1024 sc1
  s_add_u32 s47, s47, 2560
  buffer_load_dwordx4 v[104:107], v4, s[16:19], s47 offen sc1
  buffer_load_dwordx2 v[108:109], v5, s[16:19], s47 offen offset:2048 sc1
  s_add_u32 s47, s47, 13824
  buffer_load_dwordx4 v[112:115], v4, s[16:19], s47 offen sc1
  buffer_load_dwordx2 v[116:117], v5, s[16:19], s47 offen offset:2048 sc1
  buffer_load_dwordx4 v[140:143], v21, s[16:19], s47 offen offset:1024 sc1
  s_add_u32 s47, s47, 2560
  buffer_load_dwordx4 v[120:123], v4, s[16:19], s47 offen sc1
  buffer_load_dwordx2 v[124:125], v5, s[16:19], s47 offen offset:2048 sc1
  s_add_u32 s47, s47, 13824
  buffer_load_dwordx4 v[48:51], v22, s[16:19], s48 offen offset:0 sc1
  buffer_load_dwordx4 v[56:59], v28, s[16:19], s48 offen offset:0 sc1
  buffer_load_dwordx2 v[188:189], v14, s[16:19], s48 offen offset:512 sc1
  buffer_load_dwordx4 v[52:55], v22, s[16:19], s48 offen offset:1280 sc1
  buffer_load_dwordx4 v[60:63], v28, s[16:19], s48 offen offset:1280 sc1
  buffer_load_dwordx2 v[190:191], v14, s[16:19], s48 offen offset:1792 sc1
  s_add_u32 s48, s48, 262144
  s_lshl_b32 s40, s2, 2
  s_add_u32 s40, s40, s58
  s_lshl_b32 s21, s40, 7
  s_add_u32 s21, s21, 8192
  s_xor_b32 s21, s21, s80
  v_mov_b32 v18, s21
  v_cndmask_b32 v18, v17, v18, s[66:67]
  s_add_u32 s21, s40, 1
  v_mov_b32 v19, s21
  v_cndmask_b32 v19, v19, 32, s[66:67]
  buffer_load_dword v27, v18, s[72:75], 0 offen sc1
  s_lshl_b32 s55, s40, 19
  s_lshl_b32 s21, s40, 11
  s_and_b32 s21, s21, 8192
  s_xor_b32 s21, s21, s80
  s_add_u32 s55, s55, s21
  s_add_u32 s55, s55, 136314880
  s_lshl_b32 s21, s20, 15
  s_xor_b32 s54, s55, 8192
  s_add_u32 s54, s54, 48234496
  s_add_u32 s54, s54, s21
  s_lshl_b32 s57, s40, 1
  s_add_u32 s57, s57, s43
  s_lshl_b32 s45, s57, 6
  s_add_u32 s69, s54, 262144
  s_cmp_lt_u32 s2, 16
  s_cselect_b32 s69, s69, 0x40000000
  s_cmp_lt_u32 s2, 12
  s_cselect_b32 s65, s87, 0
  s_cmp_gt_u32 s65, 1
  s_cselect_b32 s64, s59, 0x40000000
  s_cselect_b32 s65, 1, 0
  v_mov_b32 v29, 1
  buffer_atomic_add v29, v233, s[72:75], s64 offen sc0 sc1
  buffer_load_dword v232, v6, s[28:31], s45 offen sc1
  buffer_load_dwordx4 v[192:195], v4, s[16:19], s69 offen offset:0 sc1
  buffer_load_dwordx4 v[196:199], v4, s[16:19], s69 offen offset:1024 sc1
  buffer_load_dwordx2 v[208:209], v5, s[16:19], s69 offen offset:2048 sc1
  s_add_u32 s69, s69, 2560
  buffer_load_dwordx4 v[200:203], v4, s[16:19], s69 offen offset:0 sc1
  buffer_load_dwordx4 v[204:207], v4, s[16:19], s69 offen offset:1024 sc1
  buffer_load_dwordx2 v[210:211], v5, s[16:19], s69 offen offset:2048 sc1
  s_add_u32 s69, s69, 13824
  buffer_load_dwordx4 v[212:215], v4, s[16:19], s69 offen offset:0 sc1
  buffer_load_dwordx4 v[216:219], v4, s[16:19], s69 offen offset:1024 sc1
  buffer_load_dwordx2 v[228:229], v5, s[16:19], s69 offen offset:2048 sc1
  s_add_u32 s69, s69, 2560
  buffer_load_dwordx4 v[220:223], v4, s[16:19], s69 offen offset:0 sc1
  buffer_load_dwordx4 v[224:227], v4, s[16:19], s69 offen offset:1024 sc1
  buffer_load_dwordx2 v[230:231], v5, s[16:19], s69 offen offset:2048 sc1
  s_add_u32 s69, s69, 13824
  s_waitcnt vmcnt(45)
  v_mfma_f32_16x16x32_bf16 v[148:151], a[0:3], v[64:67], 0
  v_mfma_f32_16x16x32_bf16 v[144:147], a[0:3], v[68:71], 0
  v_mfma_f32_16x16x32_bf16 v[156:159], a[4:7], v[64:67], 0
  v_mfma_f32_16x16x32_bf16 v[152:155], a[4:7], v[68:71], 0
  v_mfma_f32_16x16x32_bf16 v[164:167], a[8:11], v[64:67], 0
  v_mfma_f32_16x16x32_bf16 v[160:163], a[8:11], v[68:71], 0
  v_mfma_f32_16x16x32_bf16 v[172:175], a[12:15], v[64:67], 0
  v_mfma_f32_16x16x32_bf16 v[168:171], a[12:15], v[68:71], 0
  v_mfma_f32_16x16x32_bf16 v[180:183], a[16:19], v[64:67], 0
  v_mfma_f32_16x16x32_bf16 v[176:179], a[16:19], v[68:71], 0
  s_waitcnt vmcnt(42)
  v_mfma_f32_16x16x32_bf16 v[148:151], a[20:23], v[72:75], v[148:151]
  v_mfma_f32_16x16x32_bf16 v[144:147], a[20:23], v[76:79], v[144:147]
  v_mfma_f32_16x16x32_bf16 v[156:159], a[24:27], v[72:75], v[156:159]
  v_mfma_f32_16x16x32_bf16 v[152:155], a[24:27], v[76:79], v[152:155]
  v_mfma_f32_16x16x32_bf16 v[164:167], a[28:31], v[72:75], v[164:167]
  v_mfma_f32_16x16x32_bf16 v[160:163], a[28:31], v[76:79], v[160:163]
  v_mfma_f32_16x16x32_bf16 v[172:175], a[32:35], v[72:75], v[172:175]
  v_mfma_f32_16x16x32_bf16 v[168:171], a[32:35], v[76:79], v[168:171]
  v_mfma_f32_16x16x32_bf16 v[180:183], a[36:39], v[72:75], v[180:183]
  v_mfma_f32_16x16x32_bf16 v[176:179], a[36:39], v[76:79], v[176:179]
  s_waitcnt vmcnt(40)
  v_mfma_f32_16x16x32_bf16 v[148:151], a[40:43], v[80:83], v[148:151]
  v_mfma_f32_16x16x32_bf16 v[144:147], a[40:43], v[84:87], v[144:147]
  v_mfma_f32_16x16x32_bf16 v[156:159], a[44:47], v[80:83], v[156:159]
  v_mfma_f32_16x16x32_bf16 v[152:155], a[44:47], v[84:87], v[152:155]
  v_mfma_f32_16x16x32_bf16 v[164:167], a[48:51], v[80:83], v[164:167]
  v_mfma_f32_16x16x32_bf16 v[160:163], a[48:51], v[84:87], v[160:163]
  v_mfma_f32_16x16x32_bf16 v[172:175], a[52:55], v[80:83], v[172:175]
  v_mfma_f32_16x16x32_bf16 v[168:171], a[52:55], v[84:87], v[168:171]
  v_mfma_f32_16x16x32_bf16 v[180:183], a[56:59], v[80:83], v[180:183]
  v_mfma_f32_16x16x32_bf16 v[176:179], a[56:59], v[84:87], v[176:179]
  s_waitcnt vmcnt(37)
  v_mfma_f32_16x16x32_bf16 v[148:151], a[60:63], v[88:91], v[148:151]
  v_mfma_f32_16x16x32_bf16 v[144:147], a[60:63], v[92:95], v[144:147]
  v_mfma_f32_16x16x32_bf16 v[156:159], a[64:67], v[88:91], v[156:159]
  v_mfma_f32_16x16x32_bf16 v[152:155], a[64:67], v[92:95], v[152:155]
  v_mfma_f32_16x16x32_bf16 v[164:167], a[68:71], v[88:91], v[164:167]
  v_mfma_f32_16x16x32_bf16 v[160:163], a[68:71], v[92:95], v[160:163]
  v_mfma_f32_16x16x32_bf16 v[172:175], a[72:75], v[88:91], v[172:175]
  v_mfma_f32_16x16x32_bf16 v[168:171], a[72:75], v[92:95], v[168:171]
  v_mfma_f32_16x16x32_bf16 v[180:183], a[76:79], v[88:91], v[180:183]
  v_mfma_f32_16x16x32_bf16 v[176:179], a[76:79], v[92:95], v[176:179]
  s_waitcnt vmcnt(31)
  v_swap_b32 v130, v132
  v_swap_b32 v131, v133
  v_swap_b32 v34, v36
  v_swap_b32 v35, v37
  v_swap_b32 v42, v44
  v_swap_b32 v43, v45
  s_nop 1
  v_mfma_f32_16x16x32_bf16 v[144:147], v[32:35], v[128:131], v[144:147]
  v_mfma_f32_16x16x32_bf16 v[148:151], v[32:35], v[132:135], v[148:151]
  v_mfma_f32_16x16x32_bf16 v[152:155], v[36:39], v[128:131], v[152:155]
  v_mfma_f32_16x16x32_bf16 v[156:159], v[36:39], v[132:135], v[156:159]
  v_mfma_f32_16x16x32_bf16 v[160:163], v[184:187], v[128:131], v[160:163]
  v_mfma_f32_16x16x32_bf16 v[164:167], v[184:187], v[132:135], v[164:167]
  v_mfma_f32_16x16x32_bf16 v[168:171], v[40:43], v[128:131], v[168:171]
  v_mfma_f32_16x16x32_bf16 v[172:175], v[40:43], v[132:135], v[172:175]
  v_mfma_f32_16x16x32_bf16 v[176:179], v[44:47], v[128:131], v[176:179]
  v_mfma_f32_16x16x32_bf16 v[180:183], v[44:47], v[132:135], v[180:183]
  s_waitcnt vmcnt(29)
  v_mfma_f32_16x16x32_bf16 v[148:151], a[80:83], v[96:99], v[148:151]
  v_mfma_f32_16x16x32_bf16 v[144:147], a[80:83], v[100:103], v[144:147]
  v_mfma_f32_16x16x32_bf16 v[156:159], a[84:87], v[96:99], v[156:159]
  v_mfma_f32_16x16x32_bf16 v[152:155], a[84:87], v[100:103], v[152:155]
  v_mfma_f32_16x16x32_bf16 v[164:167], a[88:91], v[96:99], v[164:167]
  v_mfma_f32_16x16x32_bf16 v[160:163], a[88:91], v[100:103], v[160:163]
  v_mfma_f32_16x16x32_bf16 v[172:175], a[92:95], v[96:99], v[172:175]
  v_mfma_f32_16x16x32_bf16 v[168:171], a[92:95], v[100:103], v[168:171]
  v_mfma_f32_16x16x32_bf16 v[180:183], a[96:99], v[96:99], v[180:183]
  v_mfma_f32_16x16x32_bf16 v[176:179], a[96:99], v[100:103], v[176:179]
  s_waitcnt vmcnt(26)
  v_mfma_f32_16x16x32_bf16 v[148:151], a[100:103], v[104:107], v[148:151]
  v_mfma_f32_16x16x32_bf16 v[144:147], a[100:103], v[108:111], v[144:147]
  v_mfma_f32_16x16x32_bf16 v[156:159], a[104:107], v[104:107], v[156:159]
  v_mfma_f32_16x16x32_bf16 v[152:155], a[104:107], v[108:111], v[152:155]
  v_mfma_f32_16x16x32_bf16 v[164:167], a[108:111], v[104:107], v[164:167]
  v_mfma_f32_16x16x32_bf16 v[160:163], a[108:111], v[108:111], v[160:163]
  v_mfma_f32_16x16x32_bf16 v[172:175], a[112:115], v[104:107], v[172:175]
  v_mfma_f32_16x16x32_bf16 v[168:171], a[112:115], v[108:111], v[168:171]
  v_mfma_f32_16x16x32_bf16 v[180:183], a[116:119], v[104:107], v[180:183]
  v_mfma_f32_16x16x32_bf16 v[176:179], a[116:119], v[108:111], v[176:179]
  s_waitcnt vmcnt(24)
  v_mfma_f32_16x16x32_bf16 v[148:151], a[120:123], v[112:115], v[148:151]
  v_mfma_f32_16x16x32_bf16 v[144:147], a[120:123], v[116:119], v[144:147]
  v_mfma_f32_16x16x32_bf16 v[156:159], a[124:127], v[112:115], v[156:159]
  v_mfma_f32_16x16x32_bf16 v[152:155], a[124:127], v[116:119], v[152:155]
  v_mfma_f32_16x16x32_bf16 v[164:167], a[128:131], v[112:115], v[164:167]
  v_mfma_f32_16x16x32_bf16 v[160:163], a[128:131], v[116:119], v[160:163]
  v_mfma_f32_16x16x32_bf16 v[172:175], a[132:135], v[112:115], v[172:175]
  v_mfma_f32_16x16x32_bf16 v[168:171], a[132:135], v[116:119], v[168:171]
  v_mfma_f32_16x16x32_bf16 v[180:183], a[136:139], v[112:115], v[180:183]
  v_mfma_f32_16x16x32_bf16 v[176:179], a[136:139], v[116:119], v[176:179]
  s_waitcnt vmcnt(21)
  v_mfma_f32_16x16x32_bf16 v[148:151], a[140:143], v[120:123], v[148:151]
  v_mfma_f32_16x16x32_bf16 v[144:147], a[140:143], v[124:127], v[144:147]
  v_mfma_f32_16x16x32_bf16 v[156:159], a[144:147], v[120:123], v[156:159]
  v_mfma_f32_16x16x32_bf16 v[152:155], a[144:147], v[124:127], v[152:155]
  v_mfma_f32_16x16x32_bf16 v[164:167], a[148:151], v[120:123], v[164:167]
  v_mfma_f32_16x16x32_bf16 v[160:163], a[148:151], v[124:127], v[160:163]
  v_mfma_f32_16x16x32_bf16 v[172:175], a[152:155], v[120:123], v[172:175]
  v_mfma_f32_16x16x32_bf16 v[168:171], a[152:155], v[124:127], v[168:171]
  v_mfma_f32_16x16x32_bf16 v[180:183], a[156:159], v[120:123], v[180:183]
  v_mfma_f32_16x16x32_bf16 v[176:179], a[156:159], v[124:127], v[176:179]
  s_waitcnt vmcnt(15)
  v_swap_b32 v138, v140
  v_swap_b32 v139, v141
  v_swap_b32 v50, v52
  v_swap_b32 v51, v53
  v_swap_b32 v58, v60
  v_swap_b32 v59, v61
  s_nop 1
  v_mfma_f32_16x16x32_bf16 v[144:147], v[48:51], v[136:139], v[144:147]
  v_mfma_f32_16x16x32_bf16 v[148:151], v[48:51], v[140:143], v[148:151]
  v_mfma_f32_16x16x32_bf16 v[152:155], v[52:55], v[136:139], v[152:155]
  v_mfma_f32_16x16x32_bf16 v[156:159], v[52:55], v[140:143], v[156:159]
  v_mfma_f32_16x16x32_bf16 v[160:163], v[188:191], v[136:139], v[160:163]
  v_mfma_f32_16x16x32_bf16 v[164:167], v[188:191], v[140:143], v[164:167]
  v_mfma_f32_16x16x32_bf16 v[168:171], v[56:59], v[136:139], v[168:171]
  v_mfma_f32_16x16x32_bf16 v[172:175], v[56:59], v[140:143], v[172:175]
  v_mfma_f32_16x16x32_bf16 v[176:179], v[60:63], v[136:139], v[176:179]
  v_mfma_f32_16x16x32_bf16 v[180:183], v[60:63], v[140:143], v[180:183]
  s_branch pve_307
pvt_313:
  s_min_u32 s21, s40, 62
  v_mov_b32 v19, s21
  v_mov_b32 v18, v17
  s_cmp_lg_u32 s20, 0
  s_cbranch_scc1 wr_317
  s_mov_b32 s101, 0
wr_316:
  buffer_load_dword v26, v18, s[72:75], 0 offen sc1
  s_add_u32 s101, s101, 1
  s_cmp_gt_u32 s101, 131072
  s_cbranch_scc1 main_end
  s_waitcnt vmcnt(0)
  v_cmp_gt_u32 vcc, v19, v26
  v_readfirstlane_b32 s100, v26
  s_nop 0
  s_cbranch_vccz wr_317
  s_sleep 6
  s_cmp_lg_u32 s100, 0
  s_cbranch_scc1 wr_316
  s_sleep 0
  s_branch wr_316
wr_317:
  s_barrier
  s_lshl_b32 s40, s2, 2
  s_add_u32 s40, s40, s58
  s_lshl_b32 s21, s40, 7
  s_add_u32 s21, s21, 8192
  s_xor_b32 s21, s21, s80
  v_mov_b32 v18, s21
  v_cndmask_b32 v18, v17, v18, s[66:67]
  s_add_u32 s21, s40, 1
  v_mov_b32 v19, s21
  v_cndmask_b32 v19, v19, 32, s[66:67]
  buffer_load_dword v27, v18, s[72:75], 0 offen sc1
  s_lshl_b32 s55, s40, 19
  s_lshl_b32 s21, s40, 11
  s_and_b32 s21, s21, 8192
  s_xor_b32 s21, s21, s80
  s_add_u32 s55, s55, s21
  s_add_u32 s55, s55, 136314880
  s_lshl_b32 s21, s20, 15
  s_xor_b32 s54, s55, 8192
  s_add_u32 s54, s54, 48234496
  s_add_u32 s54, s54, s21
  s_lshl_b32 s57, s40, 1
  s_add_u32 s57, s57, s43
  s_lshl_b32 s45, s57, 6
  s_add_u32 s69, s54, 262144
  s_cmp_lt_u32 s2, 16
  s_cselect_b32 s69, s69, 0x40000000
  s_cmp_lt_u32 s2, 12
  s_cselect_b32 s65, s87, 0
  s_cmp_gt_u32 s65, 1
  s_cselect_b32 s64, s59, 0x40000000
  s_cselect_b32 s65, 1, 0
  v_mov_b32 v29, 1
  buffer_atomic_add v29, v233, s[72:75], s64 offen sc0 sc1
  buffer_load_dword v232, v6, s[28:31], s45 offen sc1
  buffer_load_dwordx4 v[192:195], v4, s[16:19], s69 offen offset:0 sc1
  buffer_load_dwordx4 v[196:199], v4, s[16:19], s69 offen offset:1024 sc1
  buffer_load_dwordx2 v[208:209], v5, s[16:19], s69 offen offset:2048 sc1
  s_add_u32 s69, s69, 2560
  buffer_load_dwordx4 v[200:203], v4, s[16:19], s69 offen offset:0 sc1
  buffer_load_dwordx4 v[204:207], v4, s[16:19], s69 offen offset:1024 sc1
  buffer_load_dwordx2 v[210:211], v5, s[16:19], s69 offen offset:2048 sc1
  s_add_u32 s69, s69, 13824
  buffer_load_dwordx4 v[212:215], v4, s[16:19], s69 offen offset:0 sc1
  buffer_load_dwordx4 v[216:219], v4, s[16:19], s69 offen offset:1024 sc1
  buffer_load_dwordx2 v[228:229], v5, s[16:19], s69 offen offset:2048 sc1
  s_add_u32 s69, s69, 2560
  buffer_load_dwordx4 v[220:223], v4, s[16:19], s69 offen offset:0 sc1
  buffer_load_dwordx4 v[224:227], v4, s[16:19], s69 offen offset:1024 sc1
  buffer_load_dwordx2 v[230:231], v5, s[16:19], s69 offen offset:2048 sc1
  s_add_u32 s69, s69, 13824
  s_mov_b32 s56, s48
  buffer_load_dwordx4 v[32:35], v22, s[16:19], s56 offen offset:0 sc1
  buffer_load_dwordx4 v[40:43], v28, s[16:19], s56 offen offset:0 sc1
  buffer_load_dwordx2 v[184:185], v14, s[16:19], s56 offen offset:512 sc1
  buffer_load_dwordx4 v[36:39], v22, s[16:19], s56 offen offset:1280 sc1
  buffer_load_dwordx4 v[44:47], v28, s[16:19], s56 offen offset:1280 sc1
  buffer_load_dwordx2 v[186:187], v14, s[16:19], s56 offen offset:1792 sc1
  s_add_u32 s56, s56, 262144
  buffer_load_dwordx4 v[48:51], v22, s[16:19], s56 offen offset:0 sc1
  buffer_load_dwordx4 v[56:59], v28, s[16:19], s56 offen offset:0 sc1
  buffer_load_dwordx2 v[188:189], v14, s[16:19], s56 offen offset:512 sc1
  buffer_load_dwordx4 v[52:55], v22, s[16:19], s56 offen offset:1280 sc1
  buffer_load_dwordx4 v[60:63], v28, s[16:19], s56 offen offset:1280 sc1
  buffer_load_dwordx2 v[190:191], v14, s[16:19], s56 offen offset:1792 sc1
  s_add_u32 s56, s56, 262144
  s_mov_b32 s101, 0
  s_branch pvr_319
pvr_318:
  s_sleep 6
  s_mov_b32 s56, s48
  buffer_load_dwordx4 v[32:35], v22, s[16:19], s56 offen offset:0 sc1
  buffer_load_dwordx4 v[40:43], v28, s[16:19], s56 offen offset:0 sc1
  buffer_load_dwordx2 v[184:185], v14, s[16:19], s56 offen offset:512 sc1
  buffer_load_dwordx4 v[36:39], v22, s[16:19], s56 offen offset:1280 sc1
  buffer_load_dwordx4 v[44:47], v28, s[16:19], s56 offen offset:1280 sc1
  buffer_load_dwordx2 v[186:187], v14, s[16:19], s56 offen offset:1792 sc1
  s_add_u32 s56, s56, 262144
  buffer_load_dwordx4 v[48:51], v22, s[16:19], s56 offen offset:0 sc1
  buffer_load_dwordx4 v[56:59], v28, s[16:19], s56 offen offset:0 sc1
  buffer_load_dwordx2 v[188:189], v14, s[16:19], s56 offen offset:512 sc1
  buffer_load_dwordx4 v[52:55], v22, s[16:19], s56 offen offset:1280 sc1
  buffer_load_dwordx4 v[60:63], v28, s[16:19], s56 offen offset:1280 sc1
  buffer_load_dwordx2 v[190:191], v14, s[16:19], s56 offen offset:1792 sc1
  s_add_u32 s56, s56, 262144
  s_add_u32 s101, s101, 1
  s_cmp_gt_u32 s101, 131072
  s_cbranch_scc1 main_end
pvr_319:
  s_waitcnt vmcnt(0)
  v_max3_u32 v26, v32, v36, v40
  v_max3_u32 v26, v26, v44, v184
  v_max3_u32 v26, v26, v186, v48
  v_max3_u32 v26, v26, v52, v56
  v_max3_u32 v26, v26, v60, v188
  v_max3_u32 v26, v26, v190, v190
  v_cmp_eq_u32 vcc, -1, v26
  s_nop 1
  s_cbranch_vccnz pvr_318
  s_add_u32 s56, s47, 0
  buffer_load_dwordx4 v[64:67], v4, s[16:19], s56 offen sc1
  buffer_load_dwordx2 v[68:69], v5, s[16:19], s56 offen offset:2048 sc1
  buffer_load_dwordx4 v[128:131], v21, s[16:19], s56 offen offset:1024 sc1
  s_add_u32 s56, s56, 2560
  buffer_load_dwordx4 v[72:75], v4, s[16:19], s56 offen sc1
  buffer_load_dwordx2 v[76:77], v5, s[16:19], s56 offen offset:2048 sc1
  s_add_u32 s56, s56, 13824
  buffer_load_dwordx4 v[80:83], v4, s[16:19], s56 offen sc1
  buffer_load_dwordx2 v[84:85], v5, s[16:19], s56 offen offset:2048 sc1
  buffer_load_dwordx4 v[132:135], v21, s[16:19], s56 offen offset:1024 sc1
  s_add_u32 s56, s56, 2560
  buffer_load_dwordx4 v[88:91], v4, s[16:19], s56 offen sc1
  buffer_load_dwordx2 v[92:93], v5, s[16:19], s56 offen offset:2048 sc1
  s_add_u32 s56, s56, 13824
  s_mov_b32 s101, 0
  s_branch pvr_321
pvr_320:
  s_sleep 2
  s_add_u32 s56, s47, 0
  buffer_load_dwordx4 v[64:67], v4, s[16:19], s56 offen sc1
  buffer_load_dwordx2 v[68:69], v5, s[16:19], s56 offen offset:2048 sc1
  buffer_load_dwordx4 v[128:131], v21, s[16:19], s56 offen offset:1024 sc1
  s_add_u32 s56, s56, 2560
  buffer_load_dwordx4 v[72:75], v4, s[16:19], s56 offen sc1
  buffer_load_dwordx2 v[76:77], v5, s[16:19], s56 offen offset:2048 sc1
  s_add_u32 s56, s56, 13824
  buffer_load_dwordx4 v[80:83], v4, s[16:19], s56 offen sc1
  buffer_load_dwordx2 v[84:85], v5, s[16:19], s56 offen offset:2048 sc1
  buffer_load_dwordx4 v[132:135], v21, s[16:19], s56 offen offset:1024 sc1
  s_add_u32 s56, s56, 2560
  buffer_load_dwordx4 v[88:91], v4, s[16:19], s56 offen sc1
  buffer_load_dwordx2 v[92:93], v5, s[16:19], s56 offen offset:2048 sc1
  s_add_u32 s56, s56, 13824
  s_add_u32 s101, s101, 1
  s_cmp_gt_u32 s101, 131072
  s_cbranch_scc1 main_end
pvr_321:
  s_waitcnt vmcnt(0)
  v_max3_u32 v26, v64, v68, v72
  v_max3_u32 v26, v26, v76, v80
  v_max3_u32 v26, v26, v84, v88
  v_max3_u32 v26, v26, v92, v128
  v_max3_u32 v26, v26, v132, v132
  v_cmp_eq_u32 vcc, -1, v26
  s_nop 1
  s_cbranch_vccnz pvr_320
  s_add_u32 s56, s47, 32768
  buffer_load_dwordx4 v[96:99], v4, s[16:19], s56 offen sc1
  buffer_load_dwordx2 v[100:101], v5, s[16:19], s56 offen offset:2048 sc1
  buffer_load_dwordx4 v[136:139], v21, s[16:19], s56 offen offset:1024 sc1
  s_add_u32 s56, s56, 2560
  buffer_load_dwordx4 v[104:107], v4, s[16:19], s56 offen sc1
  buffer_load_dwordx2 v[108:109], v5, s[16:19], s56 offen offset:2048 sc1
  s_add_u32 s56, s56, 13824
  buffer_load_dwordx4 v[112:115], v4, s[16:19], s56 offen sc1
  buffer_load_dwordx2 v[116:117], v5, s[16:19], s56 offen offset:2048 sc1
  buffer_load_dwordx4 v[140:143], v21, s[16:19], s56 offen offset:1024 sc1
  s_add_u32 s56, s56, 2560
  buffer_load_dwordx4 v[120:123], v4, s[16:19], s56 offen sc1
  buffer_load_dwordx2 v[124:125], v5, s[16:19], s56 offen offset:2048 sc1
  s_add_u32 s56, s56, 13824
  v_mfma_f32_16x16x32_bf16 v[148:151], a[0:3], v[64:67], 0
  v_mfma_f32_16x16x32_bf16 v[144:147], a[0:3], v[68:71], 0
  v_mfma_f32_16x16x32_bf16 v[156:159], a[4:7], v[64:67], 0
  v_mfma_f32_16x16x32_bf16 v[152:155], a[4:7], v[68:71], 0
  v_mfma_f32_16x16x32_bf16 v[164:167], a[8:11], v[64:67], 0
  v_mfma_f32_16x16x32_bf16 v[160:163], a[8:11], v[68:71], 0
  v_mfma_f32_16x16x32_bf16 v[172:175], a[12:15], v[64:67], 0
  v_mfma_f32_16x16x32_bf16 v[168:171], a[12:15], v[68:71], 0
  v_mfma_f32_16x16x32_bf16 v[180:183], a[16:19], v[64:67], 0
  v_mfma_f32_16x16x32_bf16 v[176:179], a[16:19], v[68:71], 0
  v_mfma_f32_16x16x32_bf16 v[148:151], a[20:23], v[72:75], v[148:151]
  v_mfma_f32_16x16x32_bf16 v[144:147], a[20:23], v[76:79], v[144:147]
  v_mfma_f32_16x16x32_bf16 v[156:159], a[24:27], v[72:75], v[156:159]
  v_mfma_f32_16x16x32_bf16 v[152:155], a[24:27], v[76:79], v[152:155]
  v_mfma_f32_16x16x32_bf16 v[164:167], a[28:31], v[72:75], v[164:167]
  v_mfma_f32_16x16x32_bf16 v[160:163], a[28:31], v[76:79], v[160:163]
  v_mfma_f32_16x16x32_bf16 v[172:175], a[32:35], v[72:75], v[172:175]
  v_mfma_f32_16x16x32_bf16 v[168:171], a[32:35], v[76:79], v[168:171]
  v_mfma_f32_16x16x32_bf16 v[180:183], a[36:39], v[72:75], v[180:183]
  v_mfma_f32_16x16x32_bf16 v[176:179], a[36:39], v[76:79], v[176:179]
  v_mfma_f32_16x16x32_bf16 v[148:151], a[40:43], v[80:83], v[148:151]
  v_mfma_f32_16x16x32_bf16 v[144:147], a[40:43], v[84:87], v[144:147]
  v_mfma_f32_16x16x32_bf16 v[156:159], a[44:47], v[80:83], v[156:159]
  v_mfma_f32_16x16x32_bf16 v[152:155], a[44:47], v[84:87], v[152:155]
  v_mfma_f32_16x16x32_bf16 v[164:167], a[48:51], v[80:83], v[164:167]
  v_mfma_f32_16x16x32_bf16 v[160:163], a[48:51], v[84:87], v[160:163]
  v_mfma_f32_16x16x32_bf16 v[172:175], a[52:55], v[80:83], v[172:175]
  v_mfma_f32_16x16x32_bf16 v[168:171], a[52:55], v[84:87], v[168:171]
  v_mfma_f32_16x16x32_bf16 v[180:183], a[56:59], v[80:83], v[180:183]
  v_mfma_f32_16x16x32_bf16 v[176:179], a[56:59], v[84:87], v[176:179]
  v_mfma_f32_16x16x32_bf16 v[148:151], a[60:63], v[88:91], v[148:151]
  v_mfma_f32_16x16x32_bf16 v[144:147], a[60:63], v[92:95], v[144:147]
  v_mfma_f32_16x16x32_bf16 v[156:159], a[64:67], v[88:91], v[156:159]
  v_mfma_f32_16x16x32_bf16 v[152:155], a[64:67], v[92:95], v[152:155]
  v_mfma_f32_16x16x32_bf16 v[164:167], a[68:71], v[88:91], v[164:167]
  v_mfma_f32_16x16x32_bf16 v[160:163], a[68:71], v[92:95], v[160:163]
  v_mfma_f32_16x16x32_bf16 v[172:175], a[72:75], v[88:91], v[172:175]
  v_mfma_f32_16x16x32_bf16 v[168:171], a[72:75], v[92:95], v[168:171]
  v_mfma_f32_16x16x32_bf16 v[180:183], a[76:79], v[88:91], v[180:183]
  v_mfma_f32_16x16x32_bf16 v[176:179], a[76:79], v[92:95], v[176:179]
  v_swap_b32 v130, v132
  v_swap_b32 v131, v133
  v_swap_b32 v34, v36
  v_swap_b32 v35, v37
  v_swap_b32 v42, v44
  v_swap_b32 v43, v45
  s_nop 1
  v_mfma_f32_16x16x32_bf16 v[144:147], v[32:35], v[128:131], v[144:147]
  v_mfma_f32_16x16x32_bf16 v[148:151], v[32:35], v[132:135], v[148:151]
  v_mfma_f32_16x16x32_bf16 v[152:155], v[36:39], v[128:131], v[152:155]
  v_mfma_f32_16x16x32_bf16 v[156:159], v[36:39], v[132:135], v[156:159]
  v_mfma_f32_16x16x32_bf16 v[160:163], v[184:187], v[128:131], v[160:163]
  v_mfma_f32_16x16x32_bf16 v[164:167], v[184:187], v[132:135], v[164:167]
  v_mfma_f32_16x16x32_bf16 v[168:171], v[40:43], v[128:131], v[168:171]
  v_mfma_f32_16x16x32_bf16 v[172:175], v[40:43], v[132:135], v[172:175]
  v_mfma_f32_16x16x32_bf16 v[176:179], v[44:47], v[128:131], v[176:179]
  v_mfma_f32_16x16x32_bf16 v[180:183], v[44:47], v[132:135], v[180:183]
  s_mov_b32 s101, 0
  s_branch pvr_323
pvr_322:
  s_sleep 1
  s_add_u32 s56, s47, 32768
  buffer_load_dwordx4 v[96:99], v4, s[16:19], s56 offen sc1
  buffer_load_dwordx2 v[100:101], v5, s[16:19], s56 offen offset:2048 sc1
  buffer_load_dwordx4 v[136:139], v21, s[16:19], s56 offen offset:1024 sc1
  s_add_u32 s56, s56, 2560
  buffer_load_dwordx4 v[104:107], v4, s[16:19], s56 offen sc1
  buffer_load_dwordx2 v[108:109], v5, s[16:19], s56 offen offset:2048 sc1
  s_add_u32 s56, s56, 13824
  buffer_load_dwordx4 v[112:115], v4, s[16:19], s56 offen sc1
  buffer_load_dwordx2 v[116:117], v5, s[16:19], s56 offen offset:2048 sc1
  buffer_load_dwordx4 v[140:143], v21, s[16:19], s56 offen offset:1024 sc1
  s_add_u32 s56, s56, 2560
  buffer_load_dwordx4 v[120:123], v4, s[16:19], s56 offen sc1
  buffer_load_dwordx2 v[124:125], v5, s[16:19], s56 offen offset:2048 sc1
  s_add_u32 s56, s56, 13824
  s_add_u32 s101, s101, 1
  s_cmp_gt_u32 s101, 131072
  s_cbranch_scc1 main_end
pvr_323:
  s_waitcnt vmcnt(0)
  v_max3_u32 v26, v96, v100, v104
  v_max3_u32 v26, v26, v108, v112
  v_max3_u32 v26, v26, v116, v120
  v_max3_u32 v26, v26, v124, v136
  v_max3_u32 v26, v26, v140, v140
  v_cmp_eq_u32 vcc, -1, v26
  s_nop 1
  s_cbranch_vccnz pvr_322
  v_mfma_f32_16x16x32_bf16 v[148:151], a[80:83], v[96:99], v[148:151]
  v_mfma_f32_16x16x32_bf16 v[144:147], a[80:83], v[100:103], v[144:147]
  v_mfma_f32_16x16x32_bf16 v[156:159], a[84:87], v[96:99], v[156:159]
  v_mfma_f32_16x16x32_bf16 v[152:155], a[84:87], v[100:103], v[152:155]
  v_mfma_f32_16x16x32_bf16 v[164:167], a[88:91], v[96:99], v[164:167]
  v_mfma_f32_16x16x32_bf16 v[160:163], a[88:91], v[100:103], v[160:163]
  v_mfma_f32_16x16x32_bf16 v[172:175], a[92:95], v[96:99], v[172:175]
  v_mfma_f32_16x16x32_bf16 v[168:171], a[92:95], v[100:103], v[168:171]
  v_mfma_f32_16x16x32_bf16 v[180:183], a[96:99], v[96:99], v[180:183]
  v_mfma_f32_16x16x32_bf16 v[176:179], a[96:99], v[100:103], v[176:179]
  v_mfma_f32_16x16x32_bf16 v[148:151], a[100:103], v[104:107], v[148:151]
  v_mfma_f32_16x16x32_bf16 v[144:147], a[100:103], v[108:111], v[144:147]
  v_mfma_f32_16x16x32_bf16 v[156:159], a[104:107], v[104:107], v[156:159]
  v_mfma_f32_16x16x32_bf16 v[152:155], a[104:107], v[108:111], v[152:155]
  v_mfma_f32_16x16x32_bf16 v[164:167], a[108:111], v[104:107], v[164:167]
  v_mfma_f32_16x16x32_bf16 v[160:163], a[108:111], v[108:111], v[160:163]
  v_mfma_f32_16x16x32_bf16 v[172:175], a[112:115], v[104:107], v[172:175]
  v_mfma_f32_16x16x32_bf16 v[168:171], a[112:115], v[108:111], v[168:171]
  v_mfma_f32_16x16x32_bf16 v[180:183], a[116:119], v[104:107], v[180:183]
  v_mfma_f32_16x16x32_bf16 v[176:179], a[116:119], v[108:111], v[176:179]
  v_mfma_f32_16x16x32_bf16 v[148:151], a[120:123], v[112:115], v[148:151]
  v_mfma_f32_16x16x32_bf16 v[144:147], a[120:123], v[116:119], v[144:147]
  v_mfma_f32_16x16x32_bf16 v[156:159], a[124:127], v[112:115], v[156:159]
  v_mfma_f32_16x16x32_bf16 v[152:155], a[124:127], v[116:119], v[152:155]
  v_mfma_f32_16x16x32_bf16 v[164:167], a[128:131], v[112:115], v[164:167]
  v_mfma_f32_16x16x32_bf16 v[160:163], a[128:131], v[116:119], v[160:163]
  v_mfma_f32_16x16x32_bf16 v[172:175], a[132:135], v[112:115], v[172:175]
  v_mfma_f32_16x16x32_bf16 v[168:171], a[132:135], v[116:119], v[168:171]
  v_mfma_f32_16x16x32_bf16 v[180:183], a[136:139], v[112:115], v[180:183]
  v_mfma_f32_16x16x32_bf16 v[176:179], a[136:139], v[116:119], v[176:179]
  v_mfma_f32_16x16x32_bf16 v[148:151], a[140:143], v[120:123], v[148:151]
  v_mfma_f32_16x16x32_bf16 v[144:147], a[140:143], v[124:127], v[144:147]
  v_mfma_f32_16x16x32_bf16 v[156:159], a[144:147], v[120:123], v[156:159]
  v_mfma_f32_16x16x32_bf16 v[152:155], a[144:147], v[124:127], v[152:155]
  v_mfma_f32_16x16x32_bf16 v[164:167], a[148:151], v[120:123], v[164:167]
  v_mfma_f32_16x16x32_bf16 v[160:163], a[148:151], v[124:127], v[160:163]
  v_mfma_f32_16x16x32_bf16 v[172:175], a[152:155], v[120:123], v[172:175]
  v_mfma_f32_16x16x32_bf16 v[168:171], a[152:155], v[124:127], v[168:171]
  v_mfma_f32_16x16x32_bf16 v[180:183], a[156:159], v[120:123], v[180:183]
  v_mfma_f32_16x16x32_bf16 v[176:179], a[156:159], v[124:127], v[176:179]
  v_swap_b32 v138, v140
  v_swap_b32 v139, v141
  v_swap_b32 v50, v52
  v_swap_b32 v51, v53
  v_swap_b32 v58, v60
  v_swap_b32 v59, v61
  s_nop 1
  v_mfma_f32_16x16x32_bf16 v[144:147], v[48:51], v[136:139], v[144:147]
  v_mfma_f32_16x16x32_bf16 v[148:151], v[48:51], v[140:143], v[148:151]
  v_mfma_f32_16x16x32_bf16 v[152:155], v[52:55], v[136:139], v[152:155]
  v_mfma_f32_16x16x32_bf16 v[156:159], v[52:55], v[140:143], v[156:159]
  v_mfma_f32_16x16x32_bf16 v[160:163], v[188:191], v[136:139], v[160:163]
  v_mfma_f32_16x16x32_bf16 v[164:167], v[188:191], v[140:143], v[164:167]
  v_mfma_f32_16x16x32_bf16 v[168:171], v[56:59], v[136:139], v[168:171]
  v_mfma_f32_16x16x32_bf16 v[172:175], v[56:59], v[140:143], v[172:175]
  v_mfma_f32_16x16x32_bf16 v[176:179], v[60:63], v[136:139], v[176:179]
  v_mfma_f32_16x16x32_bf16 v[180:183], v[60:63], v[140:143], v[180:183]
pve_307:
  s_nop 0
  ds_write_b128 v10, v[144:147] offset:0
  ds_write_b128 v10, v[148:151] offset:1024
  ds_write_b128 v10, v[152:155] offset:2048
  ds_write_b128 v10, v[156:159] offset:3072
  ds_write_b128 v10, v[160:163] offset:4096
  ds_write_b128 v10, v[164:167] offset:5120
  ds_write_b128 v10, v[168:171] offset:6144
  ds_write_b128 v10, v[172:175] offset:7168
  s_nop 1
  ds_write_b128 v10, v[176:179] offset:8192
  ds_write_b128 v10, v[180:183] offset:9216
  s_cmp_ge_u32 s2, 16
  s_cbranch_scc1 pv_310
  s_waitcnt vmcnt(14)
  s_add_u32 s23, s40, 1
  s_cmp_ge_u32 s50, s23
  s_cbranch_scc1 pv_324
  s_mov_b32 s101, 0
wm_327:
  buffer_load_dword v8, v31, s[72:75], s51 offen sc1
  s_add_u32 s101, s101, 1
  s_cmp_gt_u32 s101, 131072
  s_cbranch_scc1 main_end
  s_waitcnt vmcnt(0)
  v_cmp_gt_u32 vcc, s23, v8
  v_readfirstlane_b32 s100, v8
  s_nop 0
  s_cbranch_vccz wm_328
  s_sleep 8
  s_add_u32 s100, s100, 2
  s_cmp_ge_u32 s100, s23
  s_cbranch_scc1 wm_327
  s_sleep 60
  s_branch wm_327
wm_328:
  v_readlane_b32 s50, v8, 0
  v_readlane_b32 s21, v8, 1
  s_min_u32 s50, s50, s21
  v_readlane_b32 s21, v8, 2
  s_min_u32 s50, s50, s21
  v_readlane_b32 s21, v8, 3
  s_min_u32 s50, s50, s21
  v_readlane_b32 s21, v8, 4
  s_min_u32 s50, s50, s21
  v_readlane_b32 s21, v8, 5
  s_min_u32 s50, s50, s21
  v_readlane_b32 s21, v8, 6
  s_min_u32 s50, s50, s21
  v_readlane_b32 s21, v8, 7
  s_min_u32 s50, s50, s21
  v_readlane_b32 s21, v8, 8
  s_min_u32 s50, s50, s21
  v_readlane_b32 s21, v8, 9
  s_min_u32 s50, s50, s21
  v_readlane_b32 s21, v8, 10
  s_min_u32 s50, s50, s21
  v_readlane_b32 s21, v8, 11
  s_min_u32 s50, s50, s21
  v_readlane_b32 s21, v8, 12
  s_min_u32 s50, s50, s21
  v_readlane_b32 s21, v8, 13
  s_min_u32 s50, s50, s21
  v_readlane_b32 s21, v8, 14
  s_min_u32 s50, s50, s21
  v_readlane_b32 s21, v8, 15
  s_min_u32 s50, s50, s21
  v_readlane_b32 s21, v8, 16
  s_min_u32 s50, s50, s21
  v_readlane_b32 s21, v8, 17
  s_min_u32 s50, s50, s21
  v_readlane_b32 s21, v8, 18
  s_min_u32 s50, s50, s21
  v_readlane_b32 s21, v8, 19
  s_min_u32 s50, s50, s21
  v_readlane_b32 s21, v8, 20
  s_min_u32 s50, s50, s21
  v_readlane_b32 s21, v8, 21
  s_min_u32 s50, s50, s21
  v_readlane_b32 s21, v8, 22
  s_min_u32 s50, s50, s21
  v_readlane_b32 s21, v8, 23
  s_min_u32 s50, s50, s21
  v_readlane_b32 s21, v8, 24
  s_min_u32 s50, s50, s21
  v_readlane_b32 s21, v8, 25
  s_min_u32 s50, s50, s21
  v_readlane_b32 s21, v8, 26
  s_min_u32 s50, s50, s21
  v_readlane_b32 s21, v8, 27
  s_min_u32 s50, s50, s21
  v_readlane_b32 s21, v8, 28
  s_min_u32 s50, s50, s21
  v_readlane_b32 s21, v8, 29
  s_min_u32 s50, s50, s21
  v_readlane_b32 s21, v8, 30
  s_min_u32 s50, s50, s21
  v_readlane_b32 s21, v8, 31
  s_min_u32 s50, s50, s21
pv_324:
  v_cmp_gt_u32 vcc, v19, v27
  s_lshl_b32 s61, s40, 21
  s_lshl_b32 s21, s40, 13
  s_and_b32 s21, s21, 8192
  s_xor_b32 s21, s21, s80
  s_add_u32 s61, s61, s21
  s_lshl_b32 s21, s20, 15
  s_add_u32 s47, s54, s21
  s_add_u32 s48, s61, s60
  s_xor_b32 s68, s61, 8192
  s_add_u32 s68, s68, s53
  s_add_u32 s70, s55, s42
  s_xor_b32 s70, s70, 0
  s_mov_b32 s62, 0
  s_cbranch_vccnz pv_325
  s_mov_b32 s62, 1
  buffer_load_dwordx4 a[0:3], v4, s[16:19], s68 offen offset:0 sc1
  buffer_load_dwordx4 a[4:7], v4, s[16:19], s68 offen offset:1024 sc1
  buffer_load_dwordx4 v[32:35], v22, s[16:19], s48 offen offset:0 sc1
  buffer_load_dwordx4 a[8:11], v4, s[16:19], s70 offen sc1
  s_add_u32 s70, s70, 16384
  buffer_load_dwordx4 a[12:15], v4, s[16:19], s68 offen offset:2048 sc1
  buffer_load_dwordx4 a[16:19], v4, s[16:19], s68 offen offset:3072 sc1
  s_add_u32 s68, s68, 65536
  buffer_load_dwordx4 v[64:67], v4, s[16:19], s47 offen sc1
  buffer_load_dwordx2 v[68:69], v5, s[16:19], s47 offen offset:2048 sc1
  buffer_load_dwordx4 v[128:131], v21, s[16:19], s47 offen offset:1024 sc1
  s_add_u32 s47, s47, 2560
  buffer_load_dwordx4 a[20:23], v4, s[16:19], s68 offen offset:0 sc1
  buffer_load_dwordx4 a[24:27], v4, s[16:19], s68 offen offset:1024 sc1
  buffer_load_dwordx4 v[40:43], v28, s[16:19], s48 offen offset:0 sc1
  buffer_load_dwordx4 a[28:31], v4, s[16:19], s70 offen sc1
  s_add_u32 s70, s70, 16384
  buffer_load_dwordx4 a[32:35], v4, s[16:19], s68 offen offset:2048 sc1
  buffer_load_dwordx4 a[36:39], v4, s[16:19], s68 offen offset:3072 sc1
  s_add_u32 s68, s68, 65536
  buffer_load_dwordx2 v[184:185], v14, s[16:19], s48 offen offset:512 sc1
  buffer_load_dwordx4 v[72:75], v4, s[16:19], s47 offen sc1
  buffer_load_dwordx2 v[76:77], v5, s[16:19], s47 offen offset:2048 sc1
  s_add_u32 s47, s47, 13824
  buffer_load_dwordx4 a[40:43], v4, s[16:19], s68 offen offset:0 sc1
  buffer_load_dwordx4 a[44:47], v4, s[16:19], s68 offen offset:1024 sc1
  buffer_load_dwordx4 v[36:39], v22, s[16:19], s48 offen offset:1280 sc1
  buffer_load_dwordx4 a[48:51], v4, s[16:19], s70 offen sc1
  s_add_u32 s70, s70, 16384
  buffer_load_dwordx4 a[52:55], v4, s[16:19], s68 offen offset:2048 sc1
  buffer_load_dwordx4 a[56:59], v4, s[16:19], s68 offen offset:3072 sc1
  s_add_u32 s68, s68, 65536
  buffer_load_dwordx4 v[80:83], v4, s[16:19], s47 offen sc1
  buffer_load_dwordx2 v[84:85], v5, s[16:19], s47 offen offset:2048 sc1
  buffer_load_dwordx4 v[132:135], v21, s[16:19], s47 offen offset:1024 sc1
  s_add_u32 s47, s47, 2560
  buffer_load_dwordx4 a[60:63], v4, s[16:19], s68 offen offset:0 sc1
  buffer_load_dwordx4 a[64:67], v4, s[16:19], s68 offen offset:1024 sc1
  buffer_load_dwordx4 v[44:47], v28, s[16:19], s48 offen offset:1280 sc1
  buffer_load_dwordx4 a[68:71], v4, s[16:19], s70 offen sc1
  s_add_u32 s70, s70, 16384
  buffer_load_dwordx4 a[72:75], v4, s[16:19], s68 offen offset:2048 sc1
  buffer_load_dwordx4 a[76:79], v4, s[16:19], s68 offen offset:3072 sc1
  s_add_u32 s68, s68, 65536
  buffer_load_dwordx2 v[186:187], v14, s[16:19], s48 offen offset:1792 sc1
  s_add_u32 s48, s48, 262144
  buffer_load_dwordx4 v[88:91], v4, s[16:19], s47 offen sc1
  buffer_load_dwordx2 v[92:93], v5, s[16:19], s47 offen offset:2048 sc1
  s_add_u32 s47, s47, 13824
  s_branch pv_326
pv_325:
  buffer_load_dwordx4 a[0:3], v4, s[16:19], s68 offen offset:0 sc1
  buffer_load_dwordx4 a[4:7], v4, s[16:19], s68 offen offset:1024 sc1
  buffer_load_dwordx4 a[8:11], v4, s[16:19], s70 offen sc1
  s_add_u32 s70, s70, 16384
  buffer_load_dwordx4 a[12:15], v4, s[16:19], s68 offen offset:2048 sc1
  buffer_load_dwordx4 a[16:19], v4, s[16:19], s68 offen offset:3072 sc1
  s_add_u32 s68, s68, 65536
  buffer_load_dwordx4 a[20:23], v4, s[16:19], s68 offen offset:0 sc1
  buffer_load_dwordx4 a[24:27], v4, s[16:19], s68 offen offset:1024 sc1
  buffer_load_dwordx4 a[28:31], v4, s[16:19], s70 offen sc1
  s_add_u32 s70, s70, 16384
  buffer_load_dwordx4 a[32:35], v4, s[16:19], s68 offen offset:2048 sc1
  buffer_load_dwordx4 a[36:39], v4, s[16:19], s68 offen offset:3072 sc1
  s_add_u32 s68, s68, 65536
  buffer_load_dwordx4 a[40:43], v4, s[16:19], s68 offen offset:0 sc1
  buffer_load_dwordx4 a[44:47], v4, s[16:19], s68 offen offset:1024 sc1
  buffer_load_dwordx4 a[48:51], v4, s[16:19], s70 offen sc1
  s_add_u32 s70, s70, 16384
  buffer_load_dwordx4 a[52:55], v4, s[16:19], s68 offen offset:2048 sc1
  buffer_load_dwordx4 a[56:59], v4, s[16:19], s68 offen offset:3072 sc1
  s_add_u32 s68, s68, 65536
  buffer_load_dwordx4 a[60:63], v4, s[16:19], s68 offen offset:0 sc1
  buffer_load_dwordx4 a[64:67], v4, s[16:19], s68 offen offset:1024 sc1
  buffer_load_dwordx4 a[68:71], v4, s[16:19], s70 offen sc1
  s_add_u32 s70, s70, 16384
  buffer_load_dwordx4 a[72:75], v4, s[16:19], s68 offen offset:2048 sc1
  buffer_load_dwordx4 a[76:79], v4, s[16:19], s68 offen offset:3072 sc1
  s_add_u32 s68, s68, 65536
  buffer_load_dwordx4 a[80:83], v4, s[16:19], s68 offen offset:0 sc1
  buffer_load_dwordx4 a[84:87], v4, s[16:19], s68 offen offset:1024 sc1
  buffer_load_dwordx4 a[88:91], v4, s[16:19], s70 offen sc1
  s_add_u32 s70, s70, 16384
  buffer_load_dwordx4 a[92:95], v4, s[16:19], s68 offen offset:2048 sc1
  buffer_load_dwordx4 a[96:99], v4, s[16:19], s68 offen offset:3072 sc1
  s_add_u32 s68, s68, 65536
  buffer_load_dwordx4 a[100:103], v4, s[16:19], s68 offen offset:0 sc1
  buffer_load_dwordx4 a[104:107], v4, s[16:19], s68 offen offset:1024 sc1
  buffer_load_dwordx4 a[108:111], v4, s[16:19], s70 offen sc1
  s_add_u32 s70, s70, 16384
  buffer_load_dwordx4 a[112:115], v4, s[16:19], s68 offen offset:2048 sc1
  buffer_load_dwordx4 a[116:119], v4, s[16:19], s68 offen offset:3072 sc1
  s_add_u32 s68, s68, 65536
  buffer_load_dwordx4 a[120:123], v4, s[16:19], s68 offen offset:0 sc1
  buffer_load_dwordx4 a[124:127], v4, s[16:19], s68 offen offset:1024 sc1
  buffer_load_dwordx4 a[128:131], v4, s[16:19], s70 offen sc1
  s_add_u32 s70, s70, 16384
  buffer_load_dwordx4 a[132:135], v4, s[16:19], s68 offen offset:2048 sc1
  buffer_load_dwordx4 a[136:139], v4, s[16:19], s68 offen offset:3072 sc1
  s_add_u32 s68, s68, 65536
  buffer_load_dwordx4 a[140:143], v4, s[16:19], s68 offen offset:0 sc1
  buffer_load_dwordx4 a[144:147], v4, s[16:19], s68 offen offset:1024 sc1
  buffer_load_dwordx4 a[148:151], v4, s[16:19], s70 offen sc1
  s_add_u32 s70, s70, 16384
  buffer_load_dwordx4 a[152:155], v4, s[16:19], s68 offen offset:2048 sc1
  buffer_load_dwordx4 a[156:159], v4, s[16:19], s68 offen offset:3072 sc1
  s_add_u32 s68, s68, 65536
pv_326:
pv_310:
  s_waitcnt lgkmcnt(0)
  s_barrier
  ds_read_b128 v[144:147], v11 offset:0
  ds_read_b128 v[148:151], v11 offset:10240
  ds_read_b128 v[152:155], v11 offset:20480
  ds_read_b128 v[156:159], v11 offset:30720
  ds_read_b128 v[160:163], v11 offset:2048
  ds_read_b128 v[164:167], v11 offset:12288
  ds_read_b128 v[168:171], v11 offset:22528
  ds_read_b128 v[172:175], v11 offset:32768
  s_waitcnt lgkmcnt(4)
  v_pk_add_f32 v[144:145], v[144:145], v[148:149]
  v_pk_add_f32 v[152:153], v[152:153], v[156:157]
  v_pk_add_f32 v[146:147], v[146:147], v[150:151]
  v_pk_add_f32 v[154:155], v[154:155], v[158:159]
  v_pk_add_f32 v[176:177], v[144:145], v[152:153]
  v_pk_add_f32 v[178:179], v[146:147], v[154:155]
  ds_read_b128 v[144:147], v12 offset:0
  ds_read_b128 v[148:151], v12 offset:10240
  ds_read_b128 v[152:155], v12 offset:20480
  ds_read_b128 v[156:159], v12 offset:30720
  v_cvt_pk_bf16_f32 v26, v176, v177
  v_lshlrev_b32 v176, 16, v26
  v_and_b32 v177, 0xffff0000, v26
  v_mul_f32 v176, v176, v24
  v_mul_f32 v177, v177, v24
  v_cvt_pk_bf16_f32 v26, v176, v177
  v_lshlrev_b32 v176, 16, v26
  v_and_b32 v177, 0xffff0000, v26
  v_add_f32 v176, v176, v240
  v_add_f32 v177, v177, v241
  v_cvt_pk_bf16_f32 v236, v176, v177
  v_cvt_pk_bf16_f32 v26, v178, v179
  v_lshlrev_b32 v178, 16, v26
  v_and_b32 v179, 0xffff0000, v26
  v_mul_f32 v178, v178, v24
  v_mul_f32 v179, v179, v24
  v_cvt_pk_bf16_f32 v26, v178, v179
  v_lshlrev_b32 v178, 16, v26
  v_and_b32 v179, 0xffff0000, v26
  v_add_f32 v178, v178, v242
  v_add_f32 v179, v179, v243
  v_cvt_pk_bf16_f32 v237, v178, v179
  s_waitcnt lgkmcnt(4)
  v_pk_add_f32 v[160:161], v[160:161], v[164:165]
  v_pk_add_f32 v[168:169], v[168:169], v[172:173]
  v_pk_add_f32 v[162:163], v[162:163], v[166:167]
  v_pk_add_f32 v[170:171], v[170:171], v[174:175]
  v_pk_add_f32 v[176:177], v[160:161], v[168:169]
  v_pk_add_f32 v[178:179], v[162:163], v[170:171]
  v_cvt_pk_bf16_f32 v26, v176, v177
  v_lshlrev_b32 v176, 16, v26
  v_and_b32 v177, 0xffff0000, v26
  v_mul_f32 v176, v176, v24
  v_mul_f32 v177, v177, v24
  v_cvt_pk_bf16_f32 v26, v176, v177
  v_lshlrev_b32 v176, 16, v26
  v_and_b32 v177, 0xffff0000, v26
  v_add_f32 v176, v176, v244
  v_add_f32 v177, v177, v245
  v_cvt_pk_bf16_f32 v238, v176, v177
  v_cvt_pk_bf16_f32 v26, v178, v179
  v_lshlrev_b32 v178, 16, v26
  v_and_b32 v179, 0xffff0000, v26
  v_mul_f32 v178, v178, v24
  v_mul_f32 v179, v179, v24
  v_cvt_pk_bf16_f32 v26, v178, v179
  v_lshlrev_b32 v178, 16, v26
  v_and_b32 v179, 0xffff0000, v26
  v_add_f32 v178, v178, v246
  v_add_f32 v179, v179, v247
  v_cvt_pk_bf16_f32 v239, v178, v179
  buffer_store_dwordx4 v[236:239], v9, s[8:11], s46 offen
  s_cmp_lt_u32 s20, 2
  s_cselect_b32 s49, s49, 0x40000000
  s_waitcnt lgkmcnt(0)
  v_pk_add_f32 v[144:145], v[144:145], v[148:149]
  v_pk_add_f32 v[152:153], v[152:153], v[156:157]
  v_pk_add_f32 v[146:147], v[146:147], v[150:151]
  v_pk_add_f32 v[154:155], v[154:155], v[158:159]
  v_pk_add_f32 v[176:177], v[144:145], v[152:153]
  v_pk_add_f32 v[178:179], v[146:147], v[154:155]
  v_cvt_pk_bf16_f32 v26, v176, v177
  v_lshlrev_b32 v176, 16, v26
  v_and_b32 v177, 0xffff0000, v26
  v_mul_f32 v176, v176, v24
  v_mul_f32 v177, v177, v24
  v_cvt_pk_bf16_f32 v26, v176, v177
  v_lshlrev_b32 v176, 16, v26
  v_and_b32 v177, 0xffff0000, v26
  v_add_f32 v176, v176, v248
  v_add_f32 v177, v177, v249
  v_cvt_pk_bf16_f32 v234, v176, v177
  v_cvt_pk_bf16_f32 v26, v178, v179
  v_lshlrev_b32 v178, 16, v26
  v_and_b32 v179, 0xffff0000, v26
  v_mul_f32 v178, v178, v24
  v_mul_f32 v179, v179, v24
  v_cvt_pk_bf16_f32 v26, v178, v179
  v_lshlrev_b32 v178, 16, v26
  v_and_b32 v179, 0xffff0000, v26
  v_add_f32 v178, v178, v250
  v_add_f32 v179, v179, v251
  v_cvt_pk_bf16_f32 v235, v178, v179
  buffer_store_dwordx2 v[234:235], v13, s[8:11], s49 offen offset:64
  s_cmp_lt_u32 s2, 16
  s_cbranch_scc1 pv_loop
  s_cmp_eq_u32 s2, 16
  s_cselect_b32 s87, 0, s87
  s_cmp_eq_u32 s87, 0
  s_cbranch_scc1 pv_done
  s_waitcnt vmcnt(2)
  v_mov_b32 v29, 1
  buffer_atomic_add v29, v233, s[72:75], s59 offen sc0 sc1
  s_waitcnt vmcnt(0)
  s_cmp_lg_u32 s20, 0
  s_cbranch_scc1 pvq_329
  s_mov_b64 exec, 1
  ds_write_b32 v30, v29
  s_mov_b64 exec, -1
pvq_329:
  s_mov_b32 s71, 1
  s_waitcnt lgkmcnt(0)
  s_barrier
  ds_read_b32 v23, v30
  s_branch pv_late
pv_done:
main_fin:
  s_waitcnt vmcnt(0)
main_end:
  s_endpgm
.section .rodata,"a"
.p2align 6
.amdhsa_kernel gated_mix__memory_aug_recurrent_mem_tr__sliding_local_dilated__prompt_kernel
  .amdhsa_next_free_vgpr 512
  .amdhsa_next_free_sgpr 102
  .amdhsa_accum_offset 256
  .amdhsa_group_segment_fixed_size 0
  .amdhsa_kernarg_size 112
  .amdhsa_user_sgpr_count 2
  .amdhsa_user_sgpr_kernarg_segment_ptr 1
  .amdhsa_system_sgpr_workgroup_id_x 1
.end_amdhsa_kernel
.text
```

```asm
; @launch kernel=gated_mix__memory_aug_recurrent_mem_tr__sliding_local_dilated__prompt_kernel grid=(256,1,1) block=(256,1,1) lds=163840
.amdgcn_target "amdgcn-amd-amdhsa--gfx950"
.text
.globl gated_mix__memory_aug_recurrent_mem_tr__sliding_local_dilated__prompt_kernel
.p2align 8
.type gated_mix__memory_aug_recurrent_mem_tr__sliding_local_dilated__prompt_kernel,@function
gated_mix__memory_aug_recurrent_mem_tr__sliding_local_dilated__prompt_kernel:
  s_cmp_ge_u32 s2, 256
  s_cbranch_scc1 end0
  s_load_dwordx2 s[4:5], s[0:1], 96
  s_load_dwordx2 s[38:39], s[0:1], 104
  s_load_dwordx2 s[64:65], s[0:1], 0
  v_lshrrev_b32 v1, 6, v0
  v_and_b32 v2, 15, v0
  v_readfirstlane_b32 s20, v1
  v_and_b32 v1, 63, v0
  v_lshrrev_b32 v3, 4, v1
  s_getreg_b32 s50, hwreg(HW_REG_XCC_ID)
  s_and_b32 s50, s50, 7
  s_waitcnt lgkmcnt(0)
  s_mov_b32 s32, s4
  s_mov_b32 s33, s5
  s_mov_b32 s34, 256
  s_mov_b32 s35, 0x00020000
  v_mov_b32 v21, 0
  s_cmp_lg_u32 s20, 0
  s_cbranch_scc1 rk_1
  s_and_b32 s21, s50, 1
  s_lshl_b32 s21, s21, 7
  s_lshl_b32 s22, s50, 1
  s_and_b32 s22, s22, 12
  s_add_u32 s21, s21, s22
  v_mov_b32 v22, s21
  v_mov_b32 v23, 1
  s_mov_b64 exec, 1
  buffer_atomic_add v23, v22, s[32:35], 0 offen sc0 sc1
  s_waitcnt vmcnt(0)
  v_readfirstlane_b32 s51, v23
  s_lshl_b32 s22, s50, 5
  s_add_u32 s22, s22, s51
  s_cmp_lt_u32 s51, 32
  s_cbranch_scc1 rk_2
  v_mov_b32 v24, 72
  v_mov_b32 v25, 1
  buffer_atomic_add v25, v24, s[32:35], 0 offen sc0 sc1
  s_waitcnt vmcnt(0)
  v_readfirstlane_b32 s23, v25
  s_mov_b32 s101, 0
  s_mov_b64 exec, -1
  v_lshlrev_b32 v24, 2, v1
rk_3:
  s_sleep 8
  buffer_load_dword v25, v24, s[32:35], 0 offen sc1
  s_add_u32 s101, s101, 1
  s_cmp_gt_u32 s101, 131072
  s_cbranch_scc1 end0
  s_waitcnt vmcnt(0)
  v_readlane_b32 s21, v25, 0
  v_readlane_b32 s22, v25, 32
  s_add_u32 s21, s21, s22
  v_readlane_b32 s22, v25, 1
  s_add_u32 s21, s21, s22
  v_readlane_b32 s22, v25, 33
  s_add_u32 s21, s21, s22
  v_readlane_b32 s22, v25, 2
  s_add_u32 s21, s21, s22
  v_readlane_b32 s22, v25, 34
  s_add_u32 s21, s21, s22
  v_readlane_b32 s22, v25, 3
  s_add_u32 s21, s21, s22
  v_readlane_b32 s22, v25, 35
  s_add_u32 s21, s21, s22
  s_cmp_lt_u32 s21, 256
  s_cbranch_scc1 rk_3
  s_mov_b64 exec, 1
  s_mov_b32 s24, 0
rk_5:
  s_and_b32 s21, s24, 1
  s_lshl_b32 s21, s21, 5
  s_lshr_b32 s22, s24, 1
  s_add_u32 s21, s21, s22
  v_readlane_b32 s21, v25, s21
  s_min_u32 s21, s21, 32
  s_sub_u32 s25, 32, s21
  s_cmp_lt_u32 s23, s25
  s_cbranch_scc1 rk_4
  s_sub_u32 s23, s23, s25
  s_add_u32 s24, s24, 1
  s_cmp_lt_u32 s24, 8
  s_cbranch_scc1 rk_5
  s_branch end0
rk_4:
  s_lshl_b32 s22, s24, 5
  s_add_u32 s22, s22, s21
  s_add_u32 s22, s22, s23
  s_or_b32 s22, s22, 0x100
rk_2:
  v_mov_b32 v23, s22
  ds_write_b32 v21, v23
  s_waitcnt lgkmcnt(0)
  s_mov_b64 exec, -1
rk_1:
  s_waitcnt vmcnt(0)
  s_barrier
  ds_read_b32 v23, v21
  s_waitcnt lgkmcnt(0)
  v_readfirstlane_b32 s22, v23
  s_barrier
  s_lshr_b32 s53, s22, 8
  s_and_b32 s22, s22, 255
  s_cmp_ge_u32 s22, 128
  s_cbranch_scc1 gemm_side
  s_lshr_b32 s50, s22, 4
  s_and_b32 s51, s22, 15
  s_load_dwordx2 s[4:5], s[0:1], 8
  s_load_dwordx4 s[40:43], s[0:1], 16
  s_load_dwordx4 s[44:47], s[0:1], 32
  s_load_dwordx2 s[48:49], s[0:1], 104
  s_lshr_b32 s55, s51, 2
  s_and_b32 s56, s51, 3
  s_lshl_b32 s57, s50, 2
  s_add_u32 s58, s57, s55
  s_add_u32 s59, s57, s20
  s_lshr_b32 s60, s51, 1
  s_and_b32 s61, s51, 1
  s_mul_i32 s81, s20, 40960
  v_lshlrev_b32 v4, 4, v1
  s_waitcnt lgkmcnt(0)
  s_mov_b32 s12, s44
  s_mov_b32 s13, s45
  s_mov_b32 s14, 7864320
  s_mov_b32 s15, 0x00020000
  s_mov_b32 s16, s46
  s_mov_b32 s17, s47
  s_mov_b32 s18, 7864320
  s_mov_b32 s19, 0x00020000
  s_mov_b32 s24, s40
  s_mov_b32 s25, s41
  s_mov_b32 s26, 7864320
  s_mov_b32 s27, 0x00020000
  s_mov_b32 s28, s42
  s_mov_b32 s29, s43
  s_mov_b32 s30, 7864320
  s_mov_b32 s31, 0x00020000
  s_mov_b32 s36, s4
  s_mov_b32 s37, s5
  s_mov_b32 s38, 10240
  s_mov_b32 s39, 0x00020000
  s_add_u32 s8, s48, 174063616
  s_addc_u32 s9, s49, 0
  s_mov_b32 s10, 495616
  s_mov_b32 s11, 0x00020000
  s_add_u32 s4, s48, 171966464
  s_addc_u32 s5, s49, 0
  s_mov_b32 s6, 1048576
  s_mov_b32 s7, 0x00020000
  v_add_u32 v66, 0, v1
  v_mul_u32_u24 v67, 2731, v66
  v_lshrrev_b32 v67, 16, v67
  v_mul_u32_u24 v48, 24, v67
  v_sub_u32 v66, v66, v48
  v_mul_u32_u24 v67, 12288, v67
  v_lshl_add_u32 v48, v66, 4, v67
  v_add_u32 v66, 64, v1
  v_mul_u32_u24 v67, 2731, v66
  v_lshrrev_b32 v67, 16, v67
  v_mul_u32_u24 v49, 24, v67
  v_sub_u32 v66, v66, v49
  v_mul_u32_u24 v67, 12288, v67
  v_lshl_add_u32 v49, v66, 4, v67
  v_add_u32 v66, 128, v1
  v_mul_u32_u24 v67, 2731, v66
  v_lshrrev_b32 v67, 16, v67
  v_mul_u32_u24 v50, 24, v67
  v_sub_u32 v66, v66, v50
  v_mul_u32_u24 v67, 12288, v67
  v_lshl_add_u32 v50, v66, 4, v67
  s_mul_i32 s21, s51, 491520
  s_mul_i32 s80, s59, 384
  s_add_u32 s21, s21, s80
  s_mov_b32 s23, s21
  v_add_u32 v66, 0, v1
  v_mul_u32_u24 v67, 10923, v66
  v_lshrrev_b32 v67, 16, v67
  v_mul_u32_u24 v60, 6, v67
  v_sub_u32 v66, v66, v60
  v_mul_u32_u24 v67, 1280, v67
  v_lshl_add_u32 v60, v66, 4, v67
  v_add_u32 v66, 64, v1
  v_mul_u32_u24 v67, 10923, v66
  v_lshrrev_b32 v67, 16, v67
  v_mul_u32_u24 v61, 6, v67
  v_sub_u32 v66, v66, v61
  v_mul_u32_u24 v67, 1280, v67
  v_lshl_add_u32 v61, v66, 4, v67
  v_add_u32 v66, 128, v1
  v_mul_u32_u24 v67, 10923, v66
  v_lshrrev_b32 v67, 16, v67
  v_mul_u32_u24 v62, 6, v67
  v_sub_u32 v66, v66, v62
  v_mul_u32_u24 v67, 1280, v67
  v_lshl_add_u32 v62, v66, 4, v67
  s_mul_i32 s21, s59, 245760
  s_mul_i32 s22, s60, 160
  s_add_u32 s21, s21, s22
  s_lshl_b32 s22, s61, 6
  s_add_u32 s21, s21, s22
  s_add_u32 m0, s81, 0
  s_nop 0
  buffer_load_dwordx4 v60, s[16:19], s21 offen lds
  s_add_u32 m0, s81, 1024
  s_nop 0
  buffer_load_dwordx4 v61, s[16:19], s21 offen lds
  s_add_u32 m0, s81, 2048
  s_nop 0
  buffer_load_dwordx4 v62, s[16:19], s21 offen lds
  s_add_u32 s21, s21, 40960
  s_add_u32 m0, s81, 3072
  s_nop 0
  buffer_load_dwordx4 v60, s[16:19], s21 offen lds
  s_add_u32 m0, s81, 4096
  s_nop 0
  buffer_load_dwordx4 v61, s[16:19], s21 offen lds
  s_add_u32 m0, s81, 5120
  s_nop 0
  buffer_load_dwordx4 v62, s[16:19], s21 offen lds
  s_add_u32 s21, s21, 40960
  s_add_u32 m0, s81, 6144
  s_nop 0
  buffer_load_dwordx4 v60, s[16:19], s21 offen lds
  s_add_u32 m0, s81, 7168
  s_nop 0
  buffer_load_dwordx4 v61, s[16:19], s21 offen lds
  s_add_u32 m0, s81, 8192
  s_nop 0
  buffer_load_dwordx4 v62, s[16:19], s21 offen lds
  s_add_u32 s21, s21, 40960
  s_add_u32 m0, s81, 9216
  s_nop 0
  buffer_load_dwordx4 v60, s[16:19], s21 offen lds
  s_add_u32 m0, s81, 10240
  s_nop 0
  buffer_load_dwordx4 v61, s[16:19], s21 offen lds
  s_add_u32 m0, s81, 11264
  s_nop 0
  buffer_load_dwordx4 v62, s[16:19], s21 offen lds
  s_add_u32 s21, s21, 40960
  s_add_u32 m0, s81, 12288
  s_nop 0
  buffer_load_dwordx4 v60, s[16:19], s21 offen lds
  s_add_u32 m0, s81, 13312
  s_nop 0
  buffer_load_dwordx4 v61, s[16:19], s21 offen lds
  s_add_u32 m0, s81, 14336
  s_nop 0
  buffer_load_dwordx4 v62, s[16:19], s21 offen lds
  s_add_u32 s21, s21, 40960
  s_add_u32 m0, s81, 15360
  s_nop 0
  buffer_load_dwordx4 v60, s[16:19], s21 offen lds
  s_add_u32 m0, s81, 16384
  s_nop 0
  buffer_load_dwordx4 v61, s[16:19], s21 offen lds
  s_add_u32 m0, s81, 17408
  s_nop 0
  buffer_load_dwordx4 v62, s[16:19], s21 offen lds
  s_add_u32 s21, s21, 40960
  v_add_u32 v66, 0, v1
  v_mul_u32_u24 v67, 2731, v66
  v_lshrrev_b32 v67, 16, v67
  v_mul_u32_u24 v48, 24, v67
  v_sub_u32 v66, v66, v48
  v_lshrrev_b32 v48, 2, v67
  v_lshlrev_b32 v48, 1, v48
  v_or_b32 v48, 0, v48
  v_xor_b32 v66, v66, v48
  v_add_u32 v67, 0, v67
  v_mul_u32_u24 v67, 12288, v67
  v_lshl_add_u32 v48, v66, 4, v67
  v_add_u32 v66, 64, v1
  v_mul_u32_u24 v67, 2731, v66
  v_lshrrev_b32 v67, 16, v67
  v_mul_u32_u24 v49, 24, v67
  v_sub_u32 v66, v66, v49
  v_lshrrev_b32 v49, 2, v67
  v_lshlrev_b32 v49, 1, v49
  v_or_b32 v49, 0, v49
  v_xor_b32 v66, v66, v49
  v_add_u32 v67, 0, v67
  v_mul_u32_u24 v67, 12288, v67
  v_lshl_add_u32 v49, v66, 4, v67
  v_add_u32 v66, 128, v1
  v_mul_u32_u24 v67, 2731, v66
  v_lshrrev_b32 v67, 16, v67
  v_mul_u32_u24 v50, 24, v67
  v_sub_u32 v66, v66, v50
  v_lshrrev_b32 v50, 2, v67
  v_lshlrev_b32 v50, 1, v50
  v_or_b32 v50, 0, v50
  v_xor_b32 v66, v66, v50
  v_add_u32 v67, 0, v67
  v_mul_u32_u24 v67, 12288, v67
  v_lshl_add_u32 v50, v66, 4, v67
  v_add_u32 v66, 0, v1
  v_mul_u32_u24 v67, 2731, v66
  v_lshrrev_b32 v67, 16, v67
  v_mul_u32_u24 v51, 24, v67
  v_sub_u32 v66, v66, v51
  v_lshrrev_b32 v51, 2, v67
  v_lshlrev_b32 v51, 1, v51
  v_or_b32 v51, 1, v51
  v_xor_b32 v66, v66, v51
  v_add_u32 v67, 8, v67
  v_mul_u32_u24 v67, 12288, v67
  v_lshl_add_u32 v51, v66, 4, v67
  v_add_u32 v66, 64, v1
  v_mul_u32_u24 v67, 2731, v66
  v_lshrrev_b32 v67, 16, v67
  v_mul_u32_u24 v52, 24, v67
  v_sub_u32 v66, v66, v52
  v_lshrrev_b32 v52, 2, v67
  v_lshlrev_b32 v52, 1, v52
  v_or_b32 v52, 1, v52
  v_xor_b32 v66, v66, v52
  v_add_u32 v67, 8, v67
  v_mul_u32_u24 v67, 12288, v67
  v_lshl_add_u32 v52, v66, 4, v67
  v_add_u32 v66, 128, v1
  v_mul_u32_u24 v67, 2731, v66
  v_lshrrev_b32 v67, 16, v67
  v_mul_u32_u24 v53, 24, v67
  v_sub_u32 v66, v66, v53
  v_lshrrev_b32 v53, 2, v67
  v_lshlrev_b32 v53, 1, v53
  v_or_b32 v53, 1, v53
  v_xor_b32 v66, v66, v53
  v_add_u32 v67, 8, v67
  v_mul_u32_u24 v67, 12288, v67
  v_lshl_add_u32 v53, v66, 4, v67
  v_add_u32 v66, 0, v1
  v_mul_u32_u24 v67, 2731, v66
  v_lshrrev_b32 v67, 16, v67
  v_mul_u32_u24 v54, 24, v67
  v_sub_u32 v66, v66, v54
  v_lshrrev_b32 v54, 2, v67
  v_lshlrev_b32 v54, 1, v54
  v_or_b32 v54, 4, v54
  v_xor_b32 v66, v66, v54
  v_add_u32 v67, 16, v67
  v_mul_u32_u24 v67, 12288, v67
  v_lshl_add_u32 v54, v66, 4, v67
  v_add_u32 v66, 64, v1
  v_mul_u32_u24 v67, 2731, v66
  v_lshrrev_b32 v67, 16, v67
  v_mul_u32_u24 v55, 24, v67
  v_sub_u32 v66, v66, v55
  v_lshrrev_b32 v55, 2, v67
  v_lshlrev_b32 v55, 1, v55
  v_or_b32 v55, 4, v55
  v_xor_b32 v66, v66, v55
  v_add_u32 v67, 16, v67
  v_mul_u32_u24 v67, 12288, v67
  v_lshl_add_u32 v55, v66, 4, v67
  v_add_u32 v66, 128, v1
  v_mul_u32_u24 v67, 2731, v66
  v_lshrrev_b32 v67, 16, v67
  v_mul_u32_u24 v56, 24, v67
  v_sub_u32 v66, v66, v56
  v_lshrrev_b32 v56, 2, v67
  v_lshlrev_b32 v56, 1, v56
  v_or_b32 v56, 4, v56
  v_xor_b32 v66, v66, v56
  v_add_u32 v67, 16, v67
  v_mul_u32_u24 v67, 12288, v67
  v_lshl_add_u32 v56, v66, 4, v67
  v_add_u32 v66, 0, v1
  v_mul_u32_u24 v67, 2731, v66
  v_lshrrev_b32 v67, 16, v67
  v_mul_u32_u24 v57, 24, v67
  v_sub_u32 v66, v66, v57
  v_lshrrev_b32 v57, 2, v67
  v_lshlrev_b32 v57, 1, v57
  v_or_b32 v57, 5, v57
  v_xor_b32 v66, v66, v57
  v_add_u32 v67, 24, v67
  v_mul_u32_u24 v67, 12288, v67
  v_lshl_add_u32 v57, v66, 4, v67
  v_add_u32 v66, 64, v1
  v_mul_u32_u24 v67, 2731, v66
  v_lshrrev_b32 v67, 16, v67
  v_mul_u32_u24 v58, 24, v67
  v_sub_u32 v66, v66, v58
  v_lshrrev_b32 v58, 2, v67
  v_lshlrev_b32 v58, 1, v58
  v_or_b32 v58, 5, v58
  v_xor_b32 v66, v66, v58
  v_add_u32 v67, 24, v67
  v_mul_u32_u24 v67, 12288, v67
  v_lshl_add_u32 v58, v66, 4, v67
  v_add_u32 v66, 128, v1
  v_mul_u32_u24 v67, 2731, v66
  v_lshrrev_b32 v67, 16, v67
  v_mul_u32_u24 v59, 24, v67
  v_sub_u32 v66, v66, v59
  v_lshrrev_b32 v59, 2, v67
  v_lshlrev_b32 v59, 1, v59
  v_or_b32 v59, 5, v59
  v_xor_b32 v66, v66, v59
  v_add_u32 v67, 24, v67
  v_mul_u32_u24 v67, 12288, v67
  v_lshl_add_u32 v59, v66, 4, v67
  s_add_u32 m0, s81, 24576
  s_nop 0
  buffer_load_dwordx4 v48, s[12:15], s80 offen lds
  s_add_u32 m0, s81, 25600
  s_nop 0
  buffer_load_dwordx4 v49, s[12:15], s80 offen lds
  s_add_u32 m0, s81, 26624
  s_nop 0
  buffer_load_dwordx4 v50, s[12:15], s80 offen lds
  s_add_u32 m0, s81, 27648
  s_nop 0
  buffer_load_dwordx4 v51, s[12:15], s80 offen lds
  s_add_u32 m0, s81, 28672
  s_nop 0
  buffer_load_dwordx4 v52, s[12:15], s80 offen lds
  s_add_u32 m0, s81, 29696
  s_nop 0
  buffer_load_dwordx4 v53, s[12:15], s80 offen lds
  s_add_u32 m0, s81, 30720
  s_nop 0
  buffer_load_dwordx4 v54, s[12:15], s80 offen lds
  s_add_u32 m0, s81, 31744
  s_nop 0
  buffer_load_dwordx4 v55, s[12:15], s80 offen lds
  s_add_u32 m0, s81, 32768
  s_nop 0
  buffer_load_dwordx4 v56, s[12:15], s80 offen lds
  s_add_u32 m0, s81, 33792
  s_nop 0
  buffer_load_dwordx4 v57, s[12:15], s80 offen lds
  s_add_u32 m0, s81, 34816
  s_nop 0
  buffer_load_dwordx4 v58, s[12:15], s80 offen lds
  s_add_u32 m0, s81, 35840
  s_nop 0
  buffer_load_dwordx4 v59, s[12:15], s80 offen lds
  s_add_u32 s80, s80, 393216
  v_add_u32 v66, 0, v1
  v_mul_u32_u24 v67, 10923, v66
  v_lshrrev_b32 v67, 16, v67
  v_mul_u32_u24 v63, 6, v67
  v_sub_u32 v66, v66, v63
  v_mul_u32_u24 v67, 12288, v67
  v_lshl_add_u32 v63, v66, 4, v67
  v_add_u32 v66, 64, v1
  v_mul_u32_u24 v67, 10923, v66
  v_lshrrev_b32 v67, 16, v67
  v_mul_u32_u24 v64, 6, v67
  v_sub_u32 v66, v66, v64
  v_mul_u32_u24 v67, 12288, v67
  v_lshl_add_u32 v64, v66, 4, v67
  v_add_u32 v66, 128, v1
  v_mul_u32_u24 v67, 10923, v66
  v_lshrrev_b32 v67, 16, v67
  v_mul_u32_u24 v65, 6, v67
  v_sub_u32 v66, v66, v65
  v_mul_u32_u24 v67, 12288, v67
  v_lshl_add_u32 v65, v66, 4, v67
  s_mul_i32 s79, s58, 384
  s_mul_i32 s22, s56, 96
  s_add_u32 s79, s79, s22
  s_mul_i32 s22, s20, 1966080
  s_add_u32 s79, s79, s22
  v_and_b32 v224, 7, v2
  v_lshrrev_b32 v225, 3, v2
  v_lshlrev_b32 v12, 3, v1
  v_mov_b32 v23, 0
  v_mov_b32 v226, 0x4444
  v_mov_b32 v227, 0xeeee
  v_cmp_eq_u32 vcc, 1, v225
  v_cmp_gt_u32 s[62:63], 8, v2
  v_cmp_le_u32 s[68:69], 8, v2
  v_cndmask_b32 v22, v226, v227, vcc
  v_cmp_gt_u32 vcc, 32, v1
  v_mov_b32 v226, 0x3dd53b95
  v_cmp_gt_u32 s[66:67], 40, v1
  v_cndmask_b32 v24, 1.0, v226, vcc
  v_cndmask_b32 v25, 1.0, v226, vcc
  v_min_u32 v226, 39, v1
  v_and_b32 v227, 31, v1
  v_lshlrev_b32 v227, 2, v227
  v_lshl_add_u32 v5, v226, 7, v227
  v_mul_u32_u24 v226, 192, v3
  v_lshl_add_u32 v226, v2, 3, v226
  s_mul_i32 s21, s20, 768
  s_add_u32 s21, s21, 10240
  v_add_u32 v6, s21, v226
  v_and_b32 v226, 3, v2
  v_mul_u32_u24 v226, 192, v226
  v_lshrrev_b32 v227, 2, v2
  v_lshl_add_u32 v227, v3, 2, v227
  v_lshl_add_u32 v226, v227, 3, v226
  v_add_u32 v7, 10240, v226
  s_mul_i32 s21, s58, 2560
  s_add_u32 s21, s21, 40960
  s_lshr_b32 s22, s56, 1
  s_lshl_b32 s22, s22, 10
  s_and_b32 s23, s56, 1
  s_lshl_b32 s23, s23, 3
  s_add_u32 s22, s22, s23
  s_lshl_b32 s23, s20, 7
  s_add_u32 s22, s22, s23
  s_add_u32 s22, s22, s21
  v_lshlrev_b32 v226, 8, v3
  v_lshl_add_u32 v226, v224, 4, v226
  v_add_u32 v8, s22, v226
  s_lshl_b32 s22, s56, 2
  s_add_u32 s22, s22, s21
  s_add_u32 s22, s22, 2048
  v_and_b32 v226, 0x1ff, v226
  v_add_u32 v226, s22, v226
  s_cmp_eq_u32 s20, 2
  s_cselect_b64 vcc, -1, 0
  v_cmp_le_u32 s[64:65], 32, v1
  v_cndmask_b32 v8, v8, v226, vcc
  s_cselect_b64 s[64:65], s[64:65], -1
  s_and_b64 s[64:65], s[64:65], s[62:63]
  s_mul_i32 s21, s59, 2560
  s_add_u32 s21, s21, 40960
  v_add_u32 v9, s21, v4
  v_and_b32 v226, 0x1ff, v4
  s_add_u32 s21, s21, 2048
  v_add_u32 v10, s21, v226
  v_lshrrev_b32 v226, 2, v2
  v_and_b32 v227, 1, v2
  v_lshl_add_u32 v228, v226, 1, v227
  v_and_b32 v227, 2, v2
  v_cmp_eq_u32 vcc, 0, v227
  s_lshr_b32 s21, s20, 1
  s_lshl_b32 s21, s21, 9
  s_and_b32 s22, s20, 1
  s_lshl_b32 s22, s22, 6
  s_add_u32 s21, s21, s22
  s_add_u32 s21, s21, 12544
  v_lshlrev_b32 v226, 7, v3
  v_lshl_add_u32 v226, v228, 3, v226
  v_add_u32 v226, s21, v226
  v_mov_b32 v227, 13568
  v_cndmask_b32 v11, v227, v226, vcc
  s_lshl_b32 s21, s20, 9
  s_add_u32 s21, s21, 40960
  v_lshlrev_b32 v226, 7, v3
  v_lshl_add_u32 v226, v228, 4, v226
  v_add_u32 v226, s21, v226
  v_mov_b32 v227, 46080
  v_cndmask_b32 v19, v227, v226, vcc
  s_lshl_b32 s21, s20, 11
  s_add_u32 s21, s21, 32768
  v_add_u32 v18, s21, v4
  s_and_b32 s21, s20, 1
  s_lshl_b32 s22, s21, 10
  s_add_u32 s22, s22, 43008
  v_add_u32 v20, s22, v4
  s_lshl_b32 s22, s21, 3
  s_add_u32 s22, s22, 45056
  v_add_u32 v21, s22, v4
  s_mul_i32 s21, s20, 640
  s_add_u32 s22, s21, 13824
  v_lshlrev_b32 v226, 4, v224
  v_lshl_add_u32 v227, v3, 7, v226
  v_add_u32 v13, s22, v227
  v_lshl_add_u32 v227, v3, 2, v226
  s_add_u32 s22, s22, 512
  v_add_u32 v14, s22, v227
  v_lshrrev_b32 v228, 5, v1
  v_add_u32 v26, s21, v4
  v_lshl_add_u32 v228, v228, 1, v225
  v_mul_u32_u24 v228, 640, v228
  v_and_b32 v226, 1, v3
  v_lshl_add_u32 v228, v226, 6, v228
  v_lshl_add_u32 v228, v224, 3, v228
  v_add_u32 v43, 512, v228
  s_and_b32 s21, s50, 1
  s_lshl_b32 s21, s21, 4
  s_add_u32 s21, s21, s51
  s_lshl_b32 s22, s20, 5
  s_add_u32 s21, s21, s22
  s_cmp_lt_u32 s21, 80
  s_cselect_b32 s78, 1, 0
  s_cselect_b32 s21, s21, 0
  s_lshl_b32 s22, s21, 7
  v_add_u32 v17, s22, v227
  s_lshr_b32 s22, s21, 3
  s_lshl_b32 s22, s22, 14
  s_and_b32 s21, s21, 7
  s_lshl_b32 s21, s21, 10
  s_add_u32 s21, s21, s22
  v_add_u32 v16, s21, v4
  s_mul_i32 s21, s60, 10
  s_mul_i32 s22, s61, 6
  s_add_u32 s22, s22, s21
  s_add_u32 s21, s21, s61
  s_add_u32 s21, s21, 4
  v_lshrrev_b32 v226, 3, v1
  v_cmp_gt_u32 vcc, 4, v226
  v_add_u32 v226, s22, v226
  v_mov_b32 v227, s21
  v_cndmask_b32 v226, v227, v226, vcc
  v_lshrrev_b32 v227, 3, v226
  v_lshlrev_b32 v227, 14, v227
  v_and_b32 v226, 7, v226
  v_lshl_add_u32 v226, v226, 10, v227
  v_lshl_add_u32 v226, v224, 4, v226
  s_lshl_b32 s21, s50, 7
  v_add_u32 v15, s21, v226
  v_and_b32 v226, 1, v2
  v_lshlrev_b32 v226, 4, v226
  v_mov_b32 v227, 0x3c00
  v_lshlrev_b32 v226, v226, v227
  v_lshrrev_b32 v227, 1, v2
  v_cmp_eq_u32 vcc, 0, v227
  s_nop 1
  v_cndmask_b32 v44, 0, v226, vcc
  v_cmp_eq_u32 vcc, 2, v227
  s_nop 1
  v_cndmask_b32 v45, 0, v226, vcc
  v_cmp_eq_u32 vcc, 4, v227
  s_nop 1
  v_cndmask_b32 v46, 0, v226, vcc
  v_cmp_eq_u32 vcc, 6, v227
  s_nop 1
  v_cndmask_b32 v47, 0, v226, vcc
  v_lshrrev_b32 v226, 5, v1
  v_lshlrev_b32 v226, 14, v226
  v_bfe_u32 v227, v1, 3, 2
  v_lshl_add_u32 v226, v227, 8, v226
  v_lshl_add_u32 v226, v224, 4, v226
  s_lshl_b32 s21, s61, 7
  v_add_u32 v32, s21, v226
  v_lshlrev_b32 v226, 4, v224
  v_lshl_add_u32 v36, v3, 7, v226
  v_lshrrev_b32 v37, 1, v36
  v_and_b32 v41, 3, v1
  v_lshlrev_b32 v41, 7, v41
  v_mov_b32 v226, 0x40000000
  v_cmp_gt_u32 vcc, 32, v1
  v_cndmask_b32 v36, v226, v36, s[68:69]
  v_cndmask_b32 v37, v226, v37, s[68:69]
  v_cndmask_b32 v26, v226, v26, vcc
  s_lshr_b32 s21, s50, 1
  s_lshl_b32 s21, s21, 8
  s_add_u32 s21, s21, 491520
  v_and_b32 v227, 31, v1
  v_lshl_add_u32 v33, v227, 2, s21
  s_and_b32 s22, s50, 1
  s_lshl_b32 s22, s22, 4
  s_add_u32 s22, s22, s51
  v_cmp_eq_u32 vcc, s22, v1
  s_nop 1
  v_cndmask_b32 v34, v226, v33, vcc
  v_mov_b32 v28, -1
  v_mov_b32 v29, -1
  v_mov_b32 v30, -1
  v_mov_b32 v31, -1
  s_lshr_b32 s21, s50, 1
  s_mul_i32 s77, s21, 10240
  s_cmp_eq_u32 s20, 3
  s_cbranch_scc1 ar_8
  s_mov_b64 exec, s[64:65]
  s_cmp_eq_u32 s20, 2
  s_cbranch_scc1 ar_7
  s_mov_b32 s21, 0
  buffer_store_dwordx2 v[28:29], v8, s[8:11], s21 offen
  s_mov_b32 s21, 122880
  buffer_store_dwordx2 v[28:29], v8, s[8:11], s21 offen
  s_mov_b32 s21, 245760
  buffer_store_dwordx2 v[28:29], v8, s[8:11], s21 offen
  s_mov_b32 s21, 368640
  buffer_store_dwordx2 v[28:29], v8, s[8:11], s21 offen
  s_branch ar_9
ar_7:
  s_mov_b32 s21, 0
  buffer_store_dword v28, v8, s[8:11], s21 offen
  buffer_store_dword v28, v8, s[8:11], s21 offen offset:128
  s_mov_b32 s21, 122880
  buffer_store_dword v28, v8, s[8:11], s21 offen
  buffer_store_dword v28, v8, s[8:11], s21 offen offset:128
  s_mov_b32 s21, 245760
  buffer_store_dword v28, v8, s[8:11], s21 offen
  buffer_store_dword v28, v8, s[8:11], s21 offen offset:128
  s_mov_b32 s21, 368640
  buffer_store_dword v28, v8, s[8:11], s21 offen
  buffer_store_dword v28, v8, s[8:11], s21 offen offset:128
ar_9:
  s_cmp_eq_u32 s78, 0
  s_cbranch_scc1 ar_10
  s_mov_b64 exec, s[62:63]
  s_add_u32 s21, s77, 0
  buffer_store_dword v28, v17, s[8:11], s21 offen
  s_add_u32 s21, s77, 122880
  buffer_store_dword v28, v17, s[8:11], s21 offen
  s_add_u32 s21, s77, 245760
  buffer_store_dword v28, v17, s[8:11], s21 offen
  s_add_u32 s21, s77, 368640
  buffer_store_dword v28, v17, s[8:11], s21 offen
  s_branch ar_10
ar_8:
  buffer_store_dword v28, v34, s[8:11], 0 offen
  s_mov_b64 exec, s[66:67]
  s_mov_b32 s21, 0
  buffer_store_dwordx4 v[28:31], v15, s[4:7], s21 offen sc1
  s_mov_b32 s21, 262144
  buffer_store_dwordx4 v[28:31], v15, s[4:7], s21 offen sc1
  s_mov_b32 s21, 524288
  buffer_store_dwordx4 v[28:31], v15, s[4:7], s21 offen sc1
  s_mov_b32 s21, 786432
  buffer_store_dwordx4 v[28:31], v15, s[4:7], s21 offen sc1
  s_mov_b32 s21, 8192
  buffer_store_dwordx4 v[28:31], v15, s[4:7], s21 offen sc1
  s_mov_b32 s21, 270336
  buffer_store_dwordx4 v[28:31], v15, s[4:7], s21 offen sc1
  s_mov_b32 s21, 532480
  buffer_store_dwordx4 v[28:31], v15, s[4:7], s21 offen sc1
  s_mov_b32 s21, 794624
  buffer_store_dwordx4 v[28:31], v15, s[4:7], s21 offen sc1
ar_10:
  s_mov_b64 exec, -1
  v_lshrrev_b32 v66, 2, v2
  v_lshl_add_u32 v66, v3, 3, v66
  v_mul_u32_u24 v66, 96, v66
  v_add_u32 v66, s81, v66
  v_and_b32 v67, 3, v2
  s_lshl_b32 s21, s61, 5
  v_lshl_add_u32 v68, v67, 4, v66
  v_add_u32 v68, s21, v68
  s_mul_i32 s21, s61, 48
  s_sub_u32 s21, 64, s21
  v_and_b32 v67, 1, v2
  v_lshl_add_u32 v69, v67, 3, v66
  v_add_u32 v69, s21, v69
  v_lshrrev_b32 v226, 3, v2
  v_lshlrev_b32 v226, 4, v226
  v_bfe_u32 v227, v2, 1, 1
  v_lshl_add_u32 v226, v227, 3, v226
  v_and_b32 v227, 5, v2
  v_add_u32 v226, v226, v227
  v_mul_u32_u24 v226, 384, v226
  v_add_u32 v226, s81, v226
  v_lshrrev_b32 v227, 1, v2
  v_xor_b32 v227, v227, v3
  v_lshl_add_u32 v70, v227, 4, v226
  v_xor_b32 v227, 4, v227
  v_lshl_add_u32 v71, v227, 4, v226
  s_waitcnt vmcnt(0)
  ds_read_b64_tr_b16 v[72:73], v68 offset:0
  ds_read_b64_tr_b16 v[74:75], v68 offset:384
  ds_read_b64_tr_b16 v[76:77], v68 offset:8
  ds_read_b64_tr_b16 v[78:79], v68 offset:392
  ds_read_b64_tr_b16 v[80:81], v69 offset:0
  ds_read_b64_tr_b16 v[82:83], v69 offset:384
  ds_read_b64_tr_b16 v[84:85], v68 offset:3072
  ds_read_b64_tr_b16 v[86:87], v68 offset:3456
  ds_read_b64_tr_b16 v[88:89], v68 offset:3080
  ds_read_b64_tr_b16 v[90:91], v68 offset:3464
  ds_read_b64_tr_b16 v[92:93], v69 offset:3072
  ds_read_b64_tr_b16 v[94:95], v69 offset:3456
  ds_read_b64_tr_b16 v[96:97], v68 offset:6144
  ds_read_b64_tr_b16 v[98:99], v68 offset:6528
  ds_read_b64_tr_b16 v[100:101], v68 offset:6152
  ds_read_b64_tr_b16 v[102:103], v68 offset:6536
  ds_read_b64_tr_b16 v[104:105], v69 offset:6144
  ds_read_b64_tr_b16 v[106:107], v69 offset:6528
  ds_read_b64_tr_b16 v[108:109], v68 offset:9216
  ds_read_b64_tr_b16 v[110:111], v68 offset:9600
  ds_read_b64_tr_b16 v[112:113], v68 offset:9224
  ds_read_b64_tr_b16 v[114:115], v68 offset:9608
  ds_read_b64_tr_b16 v[116:117], v69 offset:9216
  ds_read_b64_tr_b16 v[118:119], v69 offset:9600
  ds_read_b64_tr_b16 v[120:121], v68 offset:12288
  ds_read_b64_tr_b16 v[122:123], v68 offset:12672
  ds_read_b64_tr_b16 v[124:125], v68 offset:12296
  ds_read_b64_tr_b16 v[126:127], v68 offset:12680
  ds_read_b64_tr_b16 v[128:129], v69 offset:12288
  ds_read_b64_tr_b16 v[130:131], v69 offset:12672
  ds_read_b64_tr_b16 v[132:133], v68 offset:15360
  ds_read_b64_tr_b16 v[134:135], v68 offset:15744
  ds_read_b64_tr_b16 v[136:137], v68 offset:15368
  ds_read_b64_tr_b16 v[138:139], v68 offset:15752
  ds_read_b64_tr_b16 v[140:141], v69 offset:15360
  ds_read_b64_tr_b16 v[142:143], v69 offset:15744
  s_waitcnt lgkmcnt(0)
  s_barrier
  s_cmp_lg_u32 s20, 0
  s_cbranch_scc1 ic_11
  v_mov_b32 v68, 64
  v_mov_b32 v69, 1
  s_mov_b64 exec, 1
  buffer_atomic_add v69, v68, s[32:35], 0 offen sc1
  s_mov_b64 exec, -1
ic_11:
  s_add_u32 m0, s81, 0
  s_nop 0
  buffer_load_dwordx4 v48, s[12:15], s80 offen lds
  s_add_u32 m0, s81, 1024
  s_nop 0
  buffer_load_dwordx4 v49, s[12:15], s80 offen lds
  s_add_u32 m0, s81, 2048
  s_nop 0
  buffer_load_dwordx4 v50, s[12:15], s80 offen lds
  s_add_u32 m0, s81, 3072
  s_nop 0
  buffer_load_dwordx4 v51, s[12:15], s80 offen lds
  s_add_u32 m0, s81, 4096
  s_nop 0
  buffer_load_dwordx4 v52, s[12:15], s80 offen lds
  s_add_u32 m0, s81, 5120
  s_nop 0
  buffer_load_dwordx4 v53, s[12:15], s80 offen lds
  s_add_u32 m0, s81, 6144
  s_nop 0
  buffer_load_dwordx4 v54, s[12:15], s80 offen lds
  s_add_u32 m0, s81, 7168
  s_nop 0
  buffer_load_dwordx4 v55, s[12:15], s80 offen lds
  s_add_u32 m0, s81, 8192
  s_nop 0
  buffer_load_dwordx4 v56, s[12:15], s80 offen lds
  s_add_u32 m0, s81, 9216
  s_nop 0
  buffer_load_dwordx4 v57, s[12:15], s80 offen lds
  s_add_u32 m0, s81, 10240
  s_nop 0
  buffer_load_dwordx4 v58, s[12:15], s80 offen lds
  s_add_u32 m0, s81, 11264
  s_nop 0
  buffer_load_dwordx4 v59, s[12:15], s80 offen lds
  s_add_u32 s80, s80, 393216
  s_add_u32 s16, s48, 173080576
  s_addc_u32 s17, s49, 0
  s_mov_b32 s18, 49152
  s_mov_b32 s19, 0x00020000
  v_add_u32 v68, s81, v4
  v_and_b32 v69, 7, v2
  v_lshl_add_u32 v69, v3, 3, v69
  v_and_b32 v67, 8, v2
  v_lshl_add_u32 v69, v69, 4, v67
  v_add_u32 v69, s81, v69
  v_lshlrev_b32 v67, 2, v1
  s_lshl_b32 s90, s50, 9
  s_and_b32 s21, s51, 12
  s_add_u32 s90, s90, s21
  s_add_u32 s90, s90, 4096
  ds_read_b128 v[208:211], v70 offset:24576
  ds_read_b128 v[212:215], v71 offset:24576
  ds_read_b128 v[216:219], v70 offset:24704
  s_waitcnt lgkmcnt(2)
  v_mfma_f32_16x16x32_bf16 v[184:187], v[208:211], v[72:75], 0
  ds_read_b128 v[220:223], v71 offset:24704
  v_mfma_f32_16x16x32_bf16 v[188:191], v[208:211], v[76:79], 0
  s_add_u32 m0, s81, 12288
  s_nop 0
  buffer_load_dwordx4 v48, s[12:15], s80 offen lds
  v_mfma_f32_16x16x32_bf16 v[192:195], v[208:211], v[80:83], 0
  s_waitcnt lgkmcnt(2)
  v_mfma_f32_16x16x32_bf16 v[184:187], v[212:215], v[84:87], v[184:187]
  ds_read_b128 v[208:211], v70 offset:24832
  v_mfma_f32_16x16x32_bf16 v[188:191], v[212:215], v[88:91], v[188:191]
  s_add_u32 m0, s81, 13312
  s_nop 0
  buffer_load_dwordx4 v49, s[12:15], s80 offen lds
  v_mfma_f32_16x16x32_bf16 v[192:195], v[212:215], v[92:95], v[192:195]
  s_waitcnt lgkmcnt(2)
  v_mfma_f32_16x16x32_bf16 v[184:187], v[216:219], v[96:99], v[184:187]
  ds_read_b128 v[212:215], v71 offset:24832
  v_mfma_f32_16x16x32_bf16 v[188:191], v[216:219], v[100:103], v[188:191]
  s_add_u32 m0, s81, 14336
  s_nop 0
  buffer_load_dwordx4 v50, s[12:15], s80 offen lds
  v_mfma_f32_16x16x32_bf16 v[192:195], v[216:219], v[104:107], v[192:195]
  s_waitcnt lgkmcnt(2)
  v_mfma_f32_16x16x32_bf16 v[184:187], v[220:223], v[108:111], v[184:187]
  ds_read_b128 v[216:219], v70 offset:25344
  v_mfma_f32_16x16x32_bf16 v[188:191], v[220:223], v[112:115], v[188:191]
  s_add_u32 m0, s81, 15360
  s_nop 0
  buffer_load_dwordx4 v51, s[12:15], s80 offen lds
  v_mfma_f32_16x16x32_bf16 v[192:195], v[220:223], v[116:119], v[192:195]
  s_waitcnt lgkmcnt(2)
  v_mfma_f32_16x16x32_bf16 v[184:187], v[208:211], v[120:123], v[184:187]
  ds_read_b128 v[220:223], v71 offset:25344
  v_mfma_f32_16x16x32_bf16 v[188:191], v[208:211], v[124:127], v[188:191]
  s_add_u32 m0, s81, 16384
  s_nop 0
  buffer_load_dwordx4 v52, s[12:15], s80 offen lds
  v_mfma_f32_16x16x32_bf16 v[192:195], v[208:211], v[128:131], v[192:195]
  s_waitcnt lgkmcnt(2)
  v_mfma_f32_16x16x32_bf16 v[184:187], v[212:215], v[132:135], v[184:187]
  ds_read_b128 v[208:211], v70 offset:25472
  v_mfma_f32_16x16x32_bf16 v[188:191], v[212:215], v[136:139], v[188:191]
  s_add_u32 m0, s81, 17408
  s_nop 0
  buffer_load_dwordx4 v53, s[12:15], s80 offen lds
  v_mfma_f32_16x16x32_bf16 v[192:195], v[212:215], v[140:143], v[192:195]
  s_waitcnt lgkmcnt(2)
  v_mfma_f32_16x16x32_bf16 v[196:199], v[216:219], v[72:75], 0
  ds_read_b128 v[212:215], v71 offset:25472
  v_mfma_f32_16x16x32_bf16 v[200:203], v[216:219], v[76:79], 0
  s_add_u32 m0, s81, 18432
  s_nop 0
  buffer_load_dwordx4 v54, s[12:15], s80 offen lds
  v_mfma_f32_16x16x32_bf16 v[204:207], v[216:219], v[80:83], 0
  s_waitcnt lgkmcnt(2)
  v_mfma_f32_16x16x32_bf16 v[196:199], v[220:223], v[84:87], v[196:199]
  ds_read_b128 v[216:219], v70 offset:25600
  v_cvt_pk_bf16_f32 v248, v184, v185
  v_mfma_f32_16x16x32_bf16 v[200:203], v[220:223], v[88:91], v[200:203]
  s_add_u32 m0, s81, 19456
  s_nop 0
  buffer_load_dwordx4 v55, s[12:15], s80 offen lds
  v_mfma_f32_16x16x32_bf16 v[204:207], v[220:223], v[92:95], v[204:207]
  v_cvt_pk_bf16_f32 v249, v186, v187
  s_waitcnt lgkmcnt(2)
  v_mfma_f32_16x16x32_bf16 v[196:199], v[208:211], v[96:99], v[196:199]
  ds_read_b128 v[220:223], v71 offset:25600
  v_cvt_pk_bf16_f32 v250, v188, v189
  v_mfma_f32_16x16x32_bf16 v[200:203], v[208:211], v[100:103], v[200:203]
  s_add_u32 m0, s81, 20480
  s_nop 0
  buffer_load_dwordx4 v56, s[12:15], s80 offen lds
  v_mfma_f32_16x16x32_bf16 v[204:207], v[208:211], v[104:107], v[204:207]
  v_cvt_pk_bf16_f32 v251, v190, v191
  s_waitcnt lgkmcnt(2)
  v_mfma_f32_16x16x32_bf16 v[196:199], v[212:215], v[108:111], v[196:199]
  v_accvgpr_write_b32 a0, v248
  v_mfma_f32_16x16x32_bf16 v[200:203], v[212:215], v[112:115], v[200:203]
  s_add_u32 m0, s81, 21504
  s_nop 0
  buffer_load_dwordx4 v57, s[12:15], s80 offen lds
  v_mfma_f32_16x16x32_bf16 v[204:207], v[212:215], v[116:119], v[204:207]
  v_accvgpr_write_b32 a1, v249
  s_waitcnt lgkmcnt(1)
  v_mfma_f32_16x16x32_bf16 v[196:199], v[216:219], v[120:123], v[196:199]
  v_accvgpr_write_b32 a80, v250
  v_mfma_f32_16x16x32_bf16 v[200:203], v[216:219], v[124:127], v[200:203]
  s_add_u32 m0, s81, 22528
  s_nop 0
  buffer_load_dwordx4 v58, s[12:15], s80 offen lds
  v_mfma_f32_16x16x32_bf16 v[204:207], v[216:219], v[128:131], v[204:207]
  v_accvgpr_write_b32 a81, v251
  s_waitcnt lgkmcnt(0)
  v_mfma_f32_16x16x32_bf16 v[196:199], v[220:223], v[132:135], v[196:199]
  v_cvt_pk_bf16_f32 v144, v192, v193
  v_cvt_pk_bf16_f32 v145, v194, v195
  v_mfma_f32_16x16x32_bf16 v[200:203], v[220:223], v[136:139], v[200:203]
  s_add_u32 m0, s81, 23552
  s_nop 0
  buffer_load_dwordx4 v59, s[12:15], s80 offen lds
  s_add_u32 s80, s80, 393216
  v_mfma_f32_16x16x32_bf16 v[204:207], v[220:223], v[140:143], v[204:207]
  s_waitcnt vmcnt(12)
  ds_read_b128 v[208:211], v70 offset:0
  ds_read_b128 v[212:215], v71 offset:0
  ds_read_b128 v[216:219], v70 offset:128
  s_waitcnt lgkmcnt(2)
  v_mfma_f32_16x16x32_bf16 v[184:187], v[208:211], v[72:75], 0
  ds_read_b128 v[220:223], v71 offset:128
  v_mfma_f32_16x16x32_bf16 v[188:191], v[208:211], v[76:79], 0
  s_add_u32 m0, s81, 24576
  s_nop 0
  buffer_load_dwordx4 v48, s[12:15], s80 offen lds
  v_mfma_f32_16x16x32_bf16 v[192:195], v[208:211], v[80:83], 0
  s_waitcnt lgkmcnt(2)
  v_mfma_f32_16x16x32_bf16 v[184:187], v[212:215], v[84:87], v[184:187]
  ds_read_b128 v[208:211], v70 offset:256
  v_cvt_pk_bf16_f32 v248, v196, v197
  v_mfma_f32_16x16x32_bf16 v[188:191], v[212:215], v[88:91], v[188:191]
  s_add_u32 m0, s81, 25600
  s_nop 0
  buffer_load_dwordx4 v49, s[12:15], s80 offen lds
  v_mfma_f32_16x16x32_bf16 v[192:195], v[212:215], v[92:95], v[192:195]
  v_cvt_pk_bf16_f32 v249, v198, v199
  s_waitcnt lgkmcnt(2)
  v_mfma_f32_16x16x32_bf16 v[184:187], v[216:219], v[96:99], v[184:187]
  ds_read_b128 v[212:215], v71 offset:256
  v_cvt_pk_bf16_f32 v250, v200, v201
  v_mfma_f32_16x16x32_bf16 v[188:191], v[216:219], v[100:103], v[188:191]
  s_add_u32 m0, s81, 26624
  s_nop 0
  buffer_load_dwordx4 v50, s[12:15], s80 offen lds
  v_mfma_f32_16x16x32_bf16 v[192:195], v[216:219], v[104:107], v[192:195]
  v_cvt_pk_bf16_f32 v251, v202, v203
  s_waitcnt lgkmcnt(2)
  v_mfma_f32_16x16x32_bf16 v[184:187], v[220:223], v[108:111], v[184:187]
  ds_read_b128 v[216:219], v70 offset:768
  v_accvgpr_write_b32 a2, v248
  v_mfma_f32_16x16x32_bf16 v[188:191], v[220:223], v[112:115], v[188:191]
  s_add_u32 m0, s81, 27648
  s_nop 0
  buffer_load_dwordx4 v51, s[12:15], s80 offen lds
  v_mfma_f32_16x16x32_bf16 v[192:195], v[220:223], v[116:119], v[192:195]
  v_accvgpr_write_b32 a3, v249
  s_waitcnt lgkmcnt(2)
  v_mfma_f32_16x16x32_bf16 v[184:187], v[208:211], v[120:123], v[184:187]
  ds_read_b128 v[220:223], v71 offset:768
  v_accvgpr_write_b32 a82, v250
  v_mfma_f32_16x16x32_bf16 v[188:191], v[208:211], v[124:127], v[188:191]
  s_add_u32 m0, s81, 28672
  s_nop 0
  buffer_load_dwordx4 v52, s[12:15], s80 offen lds
  v_mfma_f32_16x16x32_bf16 v[192:195], v[208:211], v[128:131], v[192:195]
  v_accvgpr_write_b32 a83, v251
  s_waitcnt lgkmcnt(2)
  v_mfma_f32_16x16x32_bf16 v[184:187], v[212:215], v[132:135], v[184:187]
  ds_read_b128 v[208:211], v70 offset:896
  s_mov_b64 exec, s[68:69]
  v_cvt_pk_bf16_f32 v144, v204, v205
  v_cvt_pk_bf16_f32 v145, v206, v207
  s_mov_b64 exec, -1
  v_mfma_f32_16x16x32_bf16 v[188:191], v[212:215], v[136:139], v[188:191]
  s_add_u32 m0, s81, 29696
  s_nop 0
  buffer_load_dwordx4 v53, s[12:15], s80 offen lds
  v_mfma_f32_16x16x32_bf16 v[192:195], v[212:215], v[140:143], v[192:195]
  s_waitcnt lgkmcnt(2)
  v_mfma_f32_16x16x32_bf16 v[196:199], v[216:219], v[72:75], 0
  ds_read_b128 v[212:215], v71 offset:896
  v_mfma_f32_16x16x32_bf16 v[200:203], v[216:219], v[76:79], 0
  s_add_u32 m0, s81, 30720
  s_nop 0
  buffer_load_dwordx4 v54, s[12:15], s80 offen lds
  v_mfma_f32_16x16x32_bf16 v[204:207], v[216:219], v[80:83], 0
  s_waitcnt lgkmcnt(2)
  v_mfma_f32_16x16x32_bf16 v[196:199], v[220:223], v[84:87], v[196:199]
  ds_read_b128 v[216:219], v70 offset:1024
  v_cvt_pk_bf16_f32 v248, v184, v185
  v_mfma_f32_16x16x32_bf16 v[200:203], v[220:223], v[88:91], v[200:203]
  s_add_u32 m0, s81, 31744
  s_nop 0
  buffer_load_dwordx4 v55, s[12:15], s80 offen lds
  v_mfma_f32_16x16x32_bf16 v[204:207], v[220:223], v[92:95], v[204:207]
  v_cvt_pk_bf16_f32 v249, v186, v187
  s_waitcnt lgkmcnt(2)
  v_mfma_f32_16x16x32_bf16 v[196:199], v[208:211], v[96:99], v[196:199]
  ds_read_b128 v[220:223], v71 offset:1024
  v_cvt_pk_bf16_f32 v250, v188, v189
  v_mfma_f32_16x16x32_bf16 v[200:203], v[208:211], v[100:103], v[200:203]
  s_add_u32 m0, s81, 32768
  s_nop 0
  buffer_load_dwordx4 v56, s[12:15], s80 offen lds
  v_mfma_f32_16x16x32_bf16 v[204:207], v[208:211], v[104:107], v[204:207]
  v_cvt_pk_bf16_f32 v251, v190, v191
  s_waitcnt lgkmcnt(2)
  v_mfma_f32_16x16x32_bf16 v[196:199], v[212:215], v[108:111], v[196:199]
  v_accvgpr_write_b32 a4, v248
  v_mfma_f32_16x16x32_bf16 v[200:203], v[212:215], v[112:115], v[200:203]
  s_add_u32 m0, s81, 33792
  s_nop 0
  buffer_load_dwordx4 v57, s[12:15], s80 offen lds
  v_mfma_f32_16x16x32_bf16 v[204:207], v[212:215], v[116:119], v[204:207]
  v_accvgpr_write_b32 a5, v249
  s_waitcnt lgkmcnt(1)
  v_mfma_f32_16x16x32_bf16 v[196:199], v[216:219], v[120:123], v[196:199]
  v_accvgpr_write_b32 a84, v250
  v_mfma_f32_16x16x32_bf16 v[200:203], v[216:219], v[124:127], v[200:203]
  s_add_u32 m0, s81, 34816
  s_nop 0
  buffer_load_dwordx4 v58, s[12:15], s80 offen lds
  v_mfma_f32_16x16x32_bf16 v[204:207], v[216:219], v[128:131], v[204:207]
  v_accvgpr_write_b32 a85, v251
  s_waitcnt lgkmcnt(0)
  v_mfma_f32_16x16x32_bf16 v[196:199], v[220:223], v[132:135], v[196:199]
  v_cvt_pk_bf16_f32 v146, v192, v193
  v_cvt_pk_bf16_f32 v147, v194, v195
  v_mfma_f32_16x16x32_bf16 v[200:203], v[220:223], v[136:139], v[200:203]
  s_add_u32 m0, s81, 35840
  s_nop 0
  buffer_load_dwordx4 v59, s[12:15], s80 offen lds
  s_add_u32 s80, s80, 393216
  v_mfma_f32_16x16x32_bf16 v[204:207], v[220:223], v[140:143], v[204:207]
  s_waitcnt vmcnt(12)
  ds_read_b128 v[208:211], v70 offset:12288
  ds_read_b128 v[212:215], v71 offset:12288
  ds_read_b128 v[216:219], v70 offset:12416
  s_waitcnt lgkmcnt(2)
  v_mfma_f32_16x16x32_bf16 v[184:187], v[208:211], v[72:75], 0
  ds_read_b128 v[220:223], v71 offset:12416
  v_mfma_f32_16x16x32_bf16 v[188:191], v[208:211], v[76:79], 0
  s_add_u32 m0, s81, 0
  s_nop 0
  buffer_load_dwordx4 v48, s[12:15], s80 offen lds
  v_mfma_f32_16x16x32_bf16 v[192:195], v[208:211], v[80:83], 0
  s_waitcnt lgkmcnt(2)
  v_mfma_f32_16x16x32_bf16 v[184:187], v[212:215], v[84:87], v[184:187]
  ds_read_b128 v[208:211], v70 offset:12544
  v_cvt_pk_bf16_f32 v248, v196, v197
  v_mfma_f32_16x16x32_bf16 v[188:191], v[212:215], v[88:91], v[188:191]
  s_add_u32 m0, s81, 1024
  s_nop 0
  buffer_load_dwordx4 v49, s[12:15], s80 offen lds
  v_mfma_f32_16x16x32_bf16 v[192:195], v[212:215], v[92:95], v[192:195]
  v_cvt_pk_bf16_f32 v249, v198, v199
  s_waitcnt lgkmcnt(2)
  v_mfma_f32_16x16x32_bf16 v[184:187], v[216:219], v[96:99], v[184:187]
  ds_read_b128 v[212:215], v71 offset:12544
  v_cvt_pk_bf16_f32 v250, v200, v201
  v_mfma_f32_16x16x32_bf16 v[188:191], v[216:219], v[100:103], v[188:191]
  s_add_u32 m0, s81, 2048
  s_nop 0
  buffer_load_dwordx4 v50, s[12:15], s80 offen lds
  v_mfma_f32_16x16x32_bf16 v[192:195], v[216:219], v[104:107], v[192:195]
  v_cvt_pk_bf16_f32 v251, v202, v203
  s_waitcnt lgkmcnt(2)
  v_mfma_f32_16x16x32_bf16 v[184:187], v[220:223], v[108:111], v[184:187]
  ds_read_b128 v[216:219], v70 offset:13056
  v_accvgpr_write_b32 a6, v248
  v_mfma_f32_16x16x32_bf16 v[188:191], v[220:223], v[112:115], v[188:191]
  s_add_u32 m0, s81, 3072
  s_nop 0
  buffer_load_dwordx4 v51, s[12:15], s80 offen lds
  v_mfma_f32_16x16x32_bf16 v[192:195], v[220:223], v[116:119], v[192:195]
  v_accvgpr_write_b32 a7, v249
  s_waitcnt lgkmcnt(2)
  v_mfma_f32_16x16x32_bf16 v[184:187], v[208:211], v[120:123], v[184:187]
  ds_read_b128 v[220:223], v71 offset:13056
  v_accvgpr_write_b32 a86, v250
  v_mfma_f32_16x16x32_bf16 v[188:191], v[208:211], v[124:127], v[188:191]
  s_add_u32 m0, s81, 4096
  s_nop 0
  buffer_load_dwordx4 v52, s[12:15], s80 offen lds
  v_mfma_f32_16x16x32_bf16 v[192:195], v[208:211], v[128:131], v[192:195]
  v_accvgpr_write_b32 a87, v251
  s_waitcnt lgkmcnt(2)
  v_mfma_f32_16x16x32_bf16 v[184:187], v[212:215], v[132:135], v[184:187]
  ds_read_b128 v[208:211], v70 offset:13184
  s_mov_b64 exec, s[68:69]
  v_cvt_pk_bf16_f32 v146, v204, v205
  v_cvt_pk_bf16_f32 v147, v206, v207
  s_mov_b64 exec, -1
  v_mfma_f32_16x16x32_bf16 v[188:191], v[212:215], v[136:139], v[188:191]
  s_add_u32 m0, s81, 5120
  s_nop 0
  buffer_load_dwordx4 v53, s[12:15], s80 offen lds
  v_mfma_f32_16x16x32_bf16 v[192:195], v[212:215], v[140:143], v[192:195]
  s_waitcnt lgkmcnt(2)
  v_mfma_f32_16x16x32_bf16 v[196:199], v[216:219], v[72:75], 0
  ds_read_b128 v[212:215], v71 offset:13184
  v_mfma_f32_16x16x32_bf16 v[200:203], v[216:219], v[76:79], 0
  s_add_u32 m0, s81, 6144
  s_nop 0
  buffer_load_dwordx4 v54, s[12:15], s80 offen lds
  v_mfma_f32_16x16x32_bf16 v[204:207], v[216:219], v[80:83], 0
  s_waitcnt lgkmcnt(2)
  v_mfma_f32_16x16x32_bf16 v[196:199], v[220:223], v[84:87], v[196:199]
  ds_read_b128 v[216:219], v70 offset:13312
  v_cvt_pk_bf16_f32 v248, v184, v185
  v_mfma_f32_16x16x32_bf16 v[200:203], v[220:223], v[88:91], v[200:203]
  s_add_u32 m0, s81, 7168
  s_nop 0
  buffer_load_dwordx4 v55, s[12:15], s80 offen lds
  v_mfma_f32_16x16x32_bf16 v[204:207], v[220:223], v[92:95], v[204:207]
  v_cvt_pk_bf16_f32 v249, v186, v187
  s_waitcnt lgkmcnt(2)
  v_mfma_f32_16x16x32_bf16 v[196:199], v[208:211], v[96:99], v[196:199]
  ds_read_b128 v[220:223], v71 offset:13312
  v_cvt_pk_bf16_f32 v250, v188, v189
  v_mfma_f32_16x16x32_bf16 v[200:203], v[208:211], v[100:103], v[200:203]
  s_add_u32 m0, s81, 8192
  s_nop 0
  buffer_load_dwordx4 v56, s[12:15], s80 offen lds
  v_mfma_f32_16x16x32_bf16 v[204:207], v[208:211], v[104:107], v[204:207]
  v_cvt_pk_bf16_f32 v251, v190, v191
  s_waitcnt lgkmcnt(2)
  v_mfma_f32_16x16x32_bf16 v[196:199], v[212:215], v[108:111], v[196:199]
  v_accvgpr_write_b32 a8, v248
  v_mfma_f32_16x16x32_bf16 v[200:203], v[212:215], v[112:115], v[200:203]
  s_add_u32 m0, s81, 9216
  s_nop 0
  buffer_load_dwordx4 v57, s[12:15], s80 offen lds
  v_mfma_f32_16x16x32_bf16 v[204:207], v[212:215], v[116:119], v[204:207]
  v_accvgpr_write_b32 a9, v249
  s_waitcnt lgkmcnt(1)
  v_mfma_f32_16x16x32_bf16 v[196:199], v[216:219], v[120:123], v[196:199]
  v_accvgpr_write_b32 a88, v250
  v_mfma_f32_16x16x32_bf16 v[200:203], v[216:219], v[124:127], v[200:203]
  s_add_u32 m0, s81, 10240
  s_nop 0
  buffer_load_dwordx4 v58, s[12:15], s80 offen lds
  v_mfma_f32_16x16x32_bf16 v[204:207], v[216:219], v[128:131], v[204:207]
  v_accvgpr_write_b32 a89, v251
  s_waitcnt lgkmcnt(0)
  v_mfma_f32_16x16x32_bf16 v[196:199], v[220:223], v[132:135], v[196:199]
  v_cvt_pk_bf16_f32 v148, v192, v193
  v_cvt_pk_bf16_f32 v149, v194, v195
  v_mfma_f32_16x16x32_bf16 v[200:203], v[220:223], v[136:139], v[200:203]
  s_add_u32 m0, s81, 11264
  s_nop 0
  buffer_load_dwordx4 v59, s[12:15], s80 offen lds
  s_add_u32 s80, s80, 393216
  v_mfma_f32_16x16x32_bf16 v[204:207], v[220:223], v[140:143], v[204:207]
  s_waitcnt vmcnt(12)
  ds_read_b128 v[208:211], v70 offset:24576
  ds_read_b128 v[212:215], v71 offset:24576
  ds_read_b128 v[216:219], v70 offset:24704
  s_waitcnt lgkmcnt(2)
  v_mfma_f32_16x16x32_bf16 v[184:187], v[208:211], v[72:75], 0
  ds_read_b128 v[220:223], v71 offset:24704
  v_mfma_f32_16x16x32_bf16 v[188:191], v[208:211], v[76:79], 0
  s_add_u32 m0, s81, 12288
  s_nop 0
  buffer_load_dwordx4 v48, s[12:15], s80 offen lds
  v_mfma_f32_16x16x32_bf16 v[192:195], v[208:211], v[80:83], 0
  s_waitcnt lgkmcnt(2)
  v_mfma_f32_16x16x32_bf16 v[184:187], v[212:215], v[84:87], v[184:187]
  ds_read_b128 v[208:211], v70 offset:24832
  v_cvt_pk_bf16_f32 v248, v196, v197
  v_mfma_f32_16x16x32_bf16 v[188:191], v[212:215], v[88:91], v[188:191]
  s_add_u32 m0, s81, 13312
  s_nop 0
  buffer_load_dwordx4 v49, s[12:15], s80 offen lds
  v_mfma_f32_16x16x32_bf16 v[192:195], v[212:215], v[92:95], v[192:195]
  v_cvt_pk_bf16_f32 v249, v198, v199
  s_waitcnt lgkmcnt(2)
  v_mfma_f32_16x16x32_bf16 v[184:187], v[216:219], v[96:99], v[184:187]
  ds_read_b128 v[212:215], v71 offset:24832
  v_cvt_pk_bf16_f32 v250, v200, v201
  v_mfma_f32_16x16x32_bf16 v[188:191], v[216:219], v[100:103], v[188:191]
  s_add_u32 m0, s81, 14336
  s_nop 0
  buffer_load_dwordx4 v50, s[12:15], s80 offen lds
  v_mfma_f32_16x16x32_bf16 v[192:195], v[216:219], v[104:107], v[192:195]
  v_cvt_pk_bf16_f32 v251, v202, v203
  s_waitcnt lgkmcnt(2)
  v_mfma_f32_16x16x32_bf16 v[184:187], v[220:223], v[108:111], v[184:187]
  ds_read_b128 v[216:219], v70 offset:25344
  v_accvgpr_write_b32 a10, v248
  v_mfma_f32_16x16x32_bf16 v[188:191], v[220:223], v[112:115], v[188:191]
  s_add_u32 m0, s81, 15360
  s_nop 0
  buffer_load_dwordx4 v51, s[12:15], s80 offen lds
  v_mfma_f32_16x16x32_bf16 v[192:195], v[220:223], v[116:119], v[192:195]
  v_accvgpr_write_b32 a11, v249
  s_waitcnt lgkmcnt(2)
  v_mfma_f32_16x16x32_bf16 v[184:187], v[208:211], v[120:123], v[184:187]
  ds_read_b128 v[220:223], v71 offset:25344
  v_accvgpr_write_b32 a90, v250
  v_mfma_f32_16x16x32_bf16 v[188:191], v[208:211], v[124:127], v[188:191]
  s_add_u32 m0, s81, 16384
  s_nop 0
  buffer_load_dwordx4 v52, s[12:15], s80 offen lds
  v_mfma_f32_16x16x32_bf16 v[192:195], v[208:211], v[128:131], v[192:195]
  v_accvgpr_write_b32 a91, v251
  s_waitcnt lgkmcnt(2)
  v_mfma_f32_16x16x32_bf16 v[184:187], v[212:215], v[132:135], v[184:187]
  ds_read_b128 v[208:211], v70 offset:25472
  s_mov_b64 exec, s[68:69]
  v_cvt_pk_bf16_f32 v148, v204, v205
  v_cvt_pk_bf16_f32 v149, v206, v207
  s_mov_b64 exec, -1
  v_mfma_f32_16x16x32_bf16 v[188:191], v[212:215], v[136:139], v[188:191]
  s_add_u32 m0, s81, 17408
  s_nop 0
  buffer_load_dwordx4 v53, s[12:15], s80 offen lds
  v_mfma_f32_16x16x32_bf16 v[192:195], v[212:215], v[140:143], v[192:195]
  s_waitcnt lgkmcnt(2)
  v_mfma_f32_16x16x32_bf16 v[196:199], v[216:219], v[72:75], 0
  ds_read_b128 v[212:215], v71 offset:25472
  v_mfma_f32_16x16x32_bf16 v[200:203], v[216:219], v[76:79], 0
  s_add_u32 m0, s81, 18432
  s_nop 0
  buffer_load_dwordx4 v54, s[12:15], s80 offen lds
  v_mfma_f32_16x16x32_bf16 v[204:207], v[216:219], v[80:83], 0
  s_waitcnt lgkmcnt(2)
  v_mfma_f32_16x16x32_bf16 v[196:199], v[220:223], v[84:87], v[196:199]
  ds_read_b128 v[216:219], v70 offset:25600
  v_cvt_pk_bf16_f32 v248, v184, v185
  v_mfma_f32_16x16x32_bf16 v[200:203], v[220:223], v[88:91], v[200:203]
  s_add_u32 m0, s81, 19456
  s_nop 0
  buffer_load_dwordx4 v55, s[12:15], s80 offen lds
  v_mfma_f32_16x16x32_bf16 v[204:207], v[220:223], v[92:95], v[204:207]
  v_cvt_pk_bf16_f32 v249, v186, v187
  s_waitcnt lgkmcnt(2)
  v_mfma_f32_16x16x32_bf16 v[196:199], v[208:211], v[96:99], v[196:199]
  ds_read_b128 v[220:223], v71 offset:25600
  v_cvt_pk_bf16_f32 v250, v188, v189
  v_mfma_f32_16x16x32_bf16 v[200:203], v[208:211], v[100:103], v[200:203]
  s_add_u32 m0, s81, 20480
  s_nop 0
  buffer_load_dwordx4 v56, s[12:15], s80 offen lds
  v_mfma_f32_16x16x32_bf16 v[204:207], v[208:211], v[104:107], v[204:207]
  v_cvt_pk_bf16_f32 v251, v190, v191
  s_waitcnt lgkmcnt(2)
  v_mfma_f32_16x16x32_bf16 v[196:199], v[212:215], v[108:111], v[196:199]
  v_accvgpr_write_b32 a12, v248
  v_mfma_f32_16x16x32_bf16 v[200:203], v[212:215], v[112:115], v[200:203]
  s_add_u32 m0, s81, 21504
  s_nop 0
  buffer_load_dwordx4 v57, s[12:15], s80 offen lds
  v_mfma_f32_16x16x32_bf16 v[204:207], v[212:215], v[116:119], v[204:207]
  v_accvgpr_write_b32 a13, v249
  s_waitcnt lgkmcnt(1)
  v_mfma_f32_16x16x32_bf16 v[196:199], v[216:219], v[120:123], v[196:199]
  v_accvgpr_write_b32 a92, v250
  v_mfma_f32_16x16x32_bf16 v[200:203], v[216:219], v[124:127], v[200:203]
  s_add_u32 m0, s81, 22528
  s_nop 0
  buffer_load_dwordx4 v58, s[12:15], s80 offen lds
  v_mfma_f32_16x16x32_bf16 v[204:207], v[216:219], v[128:131], v[204:207]
  v_accvgpr_write_b32 a93, v251
  s_waitcnt lgkmcnt(0)
  v_mfma_f32_16x16x32_bf16 v[196:199], v[220:223], v[132:135], v[196:199]
  v_cvt_pk_bf16_f32 v150, v192, v193
  v_cvt_pk_bf16_f32 v151, v194, v195
  v_mfma_f32_16x16x32_bf16 v[200:203], v[220:223], v[136:139], v[200:203]
  s_add_u32 m0, s81, 23552
  s_nop 0
  buffer_load_dwordx4 v59, s[12:15], s80 offen lds
  s_add_u32 s80, s80, 393216
  v_mfma_f32_16x16x32_bf16 v[204:207], v[220:223], v[140:143], v[204:207]
  s_waitcnt vmcnt(12)
  ds_read_b128 v[208:211], v70 offset:0
  ds_read_b128 v[212:215], v71 offset:0
  ds_read_b128 v[216:219], v70 offset:128
  s_waitcnt lgkmcnt(2)
  v_mfma_f32_16x16x32_bf16 v[184:187], v[208:211], v[72:75], 0
  ds_read_b128 v[220:223], v71 offset:128
  v_mfma_f32_16x16x32_bf16 v[188:191], v[208:211], v[76:79], 0
  s_add_u32 m0, s81, 24576
  s_nop 0
  buffer_load_dwordx4 v48, s[12:15], s80 offen lds
  v_mfma_f32_16x16x32_bf16 v[192:195], v[208:211], v[80:83], 0
  s_waitcnt lgkmcnt(2)
  v_mfma_f32_16x16x32_bf16 v[184:187], v[212:215], v[84:87], v[184:187]
  ds_read_b128 v[208:211], v70 offset:256
  v_cvt_pk_bf16_f32 v248, v196, v197
  v_mfma_f32_16x16x32_bf16 v[188:191], v[212:215], v[88:91], v[188:191]
  s_add_u32 m0, s81, 25600
  s_nop 0
  buffer_load_dwordx4 v49, s[12:15], s80 offen lds
  v_mfma_f32_16x16x32_bf16 v[192:195], v[212:215], v[92:95], v[192:195]
  v_cvt_pk_bf16_f32 v249, v198, v199
  s_waitcnt lgkmcnt(2)
  v_mfma_f32_16x16x32_bf16 v[184:187], v[216:219], v[96:99], v[184:187]
  ds_read_b128 v[212:215], v71 offset:256
  v_cvt_pk_bf16_f32 v250, v200, v201
  v_mfma_f32_16x16x32_bf16 v[188:191], v[216:219], v[100:103], v[188:191]
  s_add_u32 m0, s81, 26624
  s_nop 0
  buffer_load_dwordx4 v50, s[12:15], s80 offen lds
  v_mfma_f32_16x16x32_bf16 v[192:195], v[216:219], v[104:107], v[192:195]
  v_cvt_pk_bf16_f32 v251, v202, v203
  s_waitcnt lgkmcnt(2)
  v_mfma_f32_16x16x32_bf16 v[184:187], v[220:223], v[108:111], v[184:187]
  ds_read_b128 v[216:219], v70 offset:768
  v_accvgpr_write_b32 a14, v248
  v_mfma_f32_16x16x32_bf16 v[188:191], v[220:223], v[112:115], v[188:191]
  s_add_u32 m0, s81, 27648
  s_nop 0
  buffer_load_dwordx4 v51, s[12:15], s80 offen lds
  v_mfma_f32_16x16x32_bf16 v[192:195], v[220:223], v[116:119], v[192:195]
  v_accvgpr_write_b32 a15, v249
  s_waitcnt lgkmcnt(2)
  v_mfma_f32_16x16x32_bf16 v[184:187], v[208:211], v[120:123], v[184:187]
  ds_read_b128 v[220:223], v71 offset:768
  v_accvgpr_write_b32 a94, v250
  v_mfma_f32_16x16x32_bf16 v[188:191], v[208:211], v[124:127], v[188:191]
  s_add_u32 m0, s81, 28672
  s_nop 0
  buffer_load_dwordx4 v52, s[12:15], s80 offen lds
  v_mfma_f32_16x16x32_bf16 v[192:195], v[208:211], v[128:131], v[192:195]
  v_accvgpr_write_b32 a95, v251
  s_waitcnt lgkmcnt(2)
  v_mfma_f32_16x16x32_bf16 v[184:187], v[212:215], v[132:135], v[184:187]
  ds_read_b128 v[208:211], v70 offset:896
  s_mov_b64 exec, s[68:69]
  v_cvt_pk_bf16_f32 v150, v204, v205
  v_cvt_pk_bf16_f32 v151, v206, v207
  s_mov_b64 exec, -1
  v_mfma_f32_16x16x32_bf16 v[188:191], v[212:215], v[136:139], v[188:191]
  s_add_u32 m0, s81, 29696
  s_nop 0
  buffer_load_dwordx4 v53, s[12:15], s80 offen lds
  v_mfma_f32_16x16x32_bf16 v[192:195], v[212:215], v[140:143], v[192:195]
  s_waitcnt lgkmcnt(2)
  v_mfma_f32_16x16x32_bf16 v[196:199], v[216:219], v[72:75], 0
  ds_read_b128 v[212:215], v71 offset:896
  v_mfma_f32_16x16x32_bf16 v[200:203], v[216:219], v[76:79], 0
  s_add_u32 m0, s81, 30720
  s_nop 0
  buffer_load_dwordx4 v54, s[12:15], s80 offen lds
  v_mfma_f32_16x16x32_bf16 v[204:207], v[216:219], v[80:83], 0
  s_waitcnt lgkmcnt(2)
  v_mfma_f32_16x16x32_bf16 v[196:199], v[220:223], v[84:87], v[196:199]
  ds_read_b128 v[216:219], v70 offset:1024
  v_cvt_pk_bf16_f32 v248, v184, v185
  v_mfma_f32_16x16x32_bf16 v[200:203], v[220:223], v[88:91], v[200:203]
  s_add_u32 m0, s81, 31744
  s_nop 0
  buffer_load_dwordx4 v55, s[12:15], s80 offen lds
  v_mfma_f32_16x16x32_bf16 v[204:207], v[220:223], v[92:95], v[204:207]
  v_cvt_pk_bf16_f32 v249, v186, v187
  s_waitcnt lgkmcnt(2)
  v_mfma_f32_16x16x32_bf16 v[196:199], v[208:211], v[96:99], v[196:199]
  ds_read_b128 v[220:223], v71 offset:1024
  v_cvt_pk_bf16_f32 v250, v188, v189
  v_mfma_f32_16x16x32_bf16 v[200:203], v[208:211], v[100:103], v[200:203]
  s_add_u32 m0, s81, 32768
  s_nop 0
  buffer_load_dwordx4 v56, s[12:15], s80 offen lds
  v_mfma_f32_16x16x32_bf16 v[204:207], v[208:211], v[104:107], v[204:207]
  v_cvt_pk_bf16_f32 v251, v190, v191
  s_waitcnt lgkmcnt(2)
  v_mfma_f32_16x16x32_bf16 v[196:199], v[212:215], v[108:111], v[196:199]
  v_accvgpr_write_b32 a16, v248
  v_mfma_f32_16x16x32_bf16 v[200:203], v[212:215], v[112:115], v[200:203]
  s_add_u32 m0, s81, 33792
  s_nop 0
  buffer_load_dwordx4 v57, s[12:15], s80 offen lds
  v_mfma_f32_16x16x32_bf16 v[204:207], v[212:215], v[116:119], v[204:207]
  v_accvgpr_write_b32 a17, v249
  s_waitcnt lgkmcnt(1)
  v_mfma_f32_16x16x32_bf16 v[196:199], v[216:219], v[120:123], v[196:199]
  v_accvgpr_write_b32 a96, v250
  v_mfma_f32_16x16x32_bf16 v[200:203], v[216:219], v[124:127], v[200:203]
  s_add_u32 m0, s81, 34816
  s_nop 0
  buffer_load_dwordx4 v58, s[12:15], s80 offen lds
  v_mfma_f32_16x16x32_bf16 v[204:207], v[216:219], v[128:131], v[204:207]
  v_accvgpr_write_b32 a97, v251
  s_waitcnt lgkmcnt(0)
  v_mfma_f32_16x16x32_bf16 v[196:199], v[220:223], v[132:135], v[196:199]
  v_cvt_pk_bf16_f32 v152, v192, v193
  v_cvt_pk_bf16_f32 v153, v194, v195
  v_mfma_f32_16x16x32_bf16 v[200:203], v[220:223], v[136:139], v[200:203]
  s_add_u32 m0, s81, 35840
  s_nop 0
  buffer_load_dwordx4 v59, s[12:15], s80 offen lds
  s_add_u32 s80, s80, 393216
  v_mfma_f32_16x16x32_bf16 v[204:207], v[220:223], v[140:143], v[204:207]
  s_waitcnt vmcnt(12)
  ds_read_b128 v[208:211], v70 offset:12288
  ds_read_b128 v[212:215], v71 offset:12288
  ds_read_b128 v[216:219], v70 offset:12416
  s_waitcnt lgkmcnt(2)
  v_mfma_f32_16x16x32_bf16 v[184:187], v[208:211], v[72:75], 0
  ds_read_b128 v[220:223], v71 offset:12416
  v_mfma_f32_16x16x32_bf16 v[188:191], v[208:211], v[76:79], 0
  s_add_u32 m0, s81, 0
  s_nop 0
  buffer_load_dwordx4 v48, s[12:15], s80 offen lds
  v_mfma_f32_16x16x32_bf16 v[192:195], v[208:211], v[80:83], 0
  s_waitcnt lgkmcnt(2)
  v_mfma_f32_16x16x32_bf16 v[184:187], v[212:215], v[84:87], v[184:187]
  ds_read_b128 v[208:211], v70 offset:12544
  v_cvt_pk_bf16_f32 v248, v196, v197
  v_mfma_f32_16x16x32_bf16 v[188:191], v[212:215], v[88:91], v[188:191]
  s_add_u32 m0, s81, 1024
  s_nop 0
  buffer_load_dwordx4 v49, s[12:15], s80 offen lds
  v_mfma_f32_16x16x32_bf16 v[192:195], v[212:215], v[92:95], v[192:195]
  v_cvt_pk_bf16_f32 v249, v198, v199
  s_waitcnt lgkmcnt(2)
  v_mfma_f32_16x16x32_bf16 v[184:187], v[216:219], v[96:99], v[184:187]
  ds_read_b128 v[212:215], v71 offset:12544
  v_cvt_pk_bf16_f32 v250, v200, v201
  v_mfma_f32_16x16x32_bf16 v[188:191], v[216:219], v[100:103], v[188:191]
  s_add_u32 m0, s81, 2048
  s_nop 0
  buffer_load_dwordx4 v50, s[12:15], s80 offen lds
  v_mfma_f32_16x16x32_bf16 v[192:195], v[216:219], v[104:107], v[192:195]
  v_cvt_pk_bf16_f32 v251, v202, v203
  s_waitcnt lgkmcnt(2)
  v_mfma_f32_16x16x32_bf16 v[184:187], v[220:223], v[108:111], v[184:187]
  ds_read_b128 v[216:219], v70 offset:13056
  v_accvgpr_write_b32 a18, v248
  v_mfma_f32_16x16x32_bf16 v[188:191], v[220:223], v[112:115], v[188:191]
  s_add_u32 m0, s81, 3072
  s_nop 0
  buffer_load_dwordx4 v51, s[12:15], s80 offen lds
  v_mfma_f32_16x16x32_bf16 v[192:195], v[220:223], v[116:119], v[192:195]
  v_accvgpr_write_b32 a19, v249
  s_waitcnt lgkmcnt(2)
  v_mfma_f32_16x16x32_bf16 v[184:187], v[208:211], v[120:123], v[184:187]
  ds_read_b128 v[220:223], v71 offset:13056
  v_accvgpr_write_b32 a98, v250
  v_mfma_f32_16x16x32_bf16 v[188:191], v[208:211], v[124:127], v[188:191]
  s_add_u32 m0, s81, 4096
  s_nop 0
  buffer_load_dwordx4 v52, s[12:15], s80 offen lds
  v_mfma_f32_16x16x32_bf16 v[192:195], v[208:211], v[128:131], v[192:195]
  v_accvgpr_write_b32 a99, v251
  s_waitcnt lgkmcnt(2)
  v_mfma_f32_16x16x32_bf16 v[184:187], v[212:215], v[132:135], v[184:187]
  ds_read_b128 v[208:211], v70 offset:13184
  s_mov_b64 exec, s[68:69]
  v_cvt_pk_bf16_f32 v152, v204, v205
  v_cvt_pk_bf16_f32 v153, v206, v207
  s_mov_b64 exec, -1
  v_mfma_f32_16x16x32_bf16 v[188:191], v[212:215], v[136:139], v[188:191]
  s_add_u32 m0, s81, 5120
  s_nop 0
  buffer_load_dwordx4 v53, s[12:15], s80 offen lds
  v_mfma_f32_16x16x32_bf16 v[192:195], v[212:215], v[140:143], v[192:195]
  s_waitcnt lgkmcnt(2)
  v_mfma_f32_16x16x32_bf16 v[196:199], v[216:219], v[72:75], 0
  ds_read_b128 v[212:215], v71 offset:13184
  v_mfma_f32_16x16x32_bf16 v[200:203], v[216:219], v[76:79], 0
  s_add_u32 m0, s81, 6144
  s_nop 0
  buffer_load_dwordx4 v54, s[12:15], s80 offen lds
  v_mfma_f32_16x16x32_bf16 v[204:207], v[216:219], v[80:83], 0
  s_waitcnt lgkmcnt(2)
  v_mfma_f32_16x16x32_bf16 v[196:199], v[220:223], v[84:87], v[196:199]
  ds_read_b128 v[216:219], v70 offset:13312
  v_cvt_pk_bf16_f32 v248, v184, v185
  v_mfma_f32_16x16x32_bf16 v[200:203], v[220:223], v[88:91], v[200:203]
  s_add_u32 m0, s81, 7168
  s_nop 0
  buffer_load_dwordx4 v55, s[12:15], s80 offen lds
  v_mfma_f32_16x16x32_bf16 v[204:207], v[220:223], v[92:95], v[204:207]
  v_cvt_pk_bf16_f32 v249, v186, v187
  s_waitcnt lgkmcnt(2)
  v_mfma_f32_16x16x32_bf16 v[196:199], v[208:211], v[96:99], v[196:199]
  ds_read_b128 v[220:223], v71 offset:13312
  v_cvt_pk_bf16_f32 v250, v188, v189
  v_mfma_f32_16x16x32_bf16 v[200:203], v[208:211], v[100:103], v[200:203]
  s_add_u32 m0, s81, 8192
  s_nop 0
  buffer_load_dwordx4 v56, s[12:15], s80 offen lds
  v_mfma_f32_16x16x32_bf16 v[204:207], v[208:211], v[104:107], v[204:207]
  v_cvt_pk_bf16_f32 v251, v190, v191
  s_waitcnt lgkmcnt(2)
  v_mfma_f32_16x16x32_bf16 v[196:199], v[212:215], v[108:111], v[196:199]
  v_accvgpr_write_b32 a20, v248
  v_mfma_f32_16x16x32_bf16 v[200:203], v[212:215], v[112:115], v[200:203]
  s_add_u32 m0, s81, 9216
  s_nop 0
  buffer_load_dwordx4 v57, s[12:15], s80 offen lds
  v_mfma_f32_16x16x32_bf16 v[204:207], v[212:215], v[116:119], v[204:207]
  v_accvgpr_write_b32 a21, v249
  s_waitcnt lgkmcnt(1)
  v_mfma_f32_16x16x32_bf16 v[196:199], v[216:219], v[120:123], v[196:199]
  v_accvgpr_write_b32 a100, v250
  v_mfma_f32_16x16x32_bf16 v[200:203], v[216:219], v[124:127], v[200:203]
  s_add_u32 m0, s81, 10240
  s_nop 0
  buffer_load_dwordx4 v58, s[12:15], s80 offen lds
  v_mfma_f32_16x16x32_bf16 v[204:207], v[216:219], v[128:131], v[204:207]
  v_accvgpr_write_b32 a101, v251
  s_waitcnt lgkmcnt(0)
  v_mfma_f32_16x16x32_bf16 v[196:199], v[220:223], v[132:135], v[196:199]
  v_cvt_pk_bf16_f32 v154, v192, v193
  v_cvt_pk_bf16_f32 v155, v194, v195
  v_mfma_f32_16x16x32_bf16 v[200:203], v[220:223], v[136:139], v[200:203]
  s_add_u32 m0, s81, 11264
  s_nop 0
  buffer_load_dwordx4 v59, s[12:15], s80 offen lds
  s_add_u32 s80, s80, 393216
  v_mfma_f32_16x16x32_bf16 v[204:207], v[220:223], v[140:143], v[204:207]
  s_add_u32 s21, s79, 0
  buffer_load_dwordx4 a[172:175], v63, s[28:31], s21 offen
  s_add_u32 s21, s79, 0
  buffer_load_dwordx4 a[176:179], v64, s[28:31], s21 offen
  s_add_u32 s21, s79, 0
  buffer_load_dwordx4 a[180:183], v65, s[28:31], s21 offen
  s_waitcnt vmcnt(15)
  ds_read_b128 v[208:211], v70 offset:24576
  ds_read_b128 v[212:215], v71 offset:24576
  ds_read_b128 v[216:219], v70 offset:24704
  s_waitcnt lgkmcnt(2)
  v_mfma_f32_16x16x32_bf16 v[184:187], v[208:211], v[72:75], 0
  ds_read_b128 v[220:223], v71 offset:24704
  v_mfma_f32_16x16x32_bf16 v[188:191], v[208:211], v[76:79], 0
  s_add_u32 m0, s81, 12288
  s_nop 0
  buffer_load_dwordx4 v48, s[12:15], s80 offen lds
  v_mfma_f32_16x16x32_bf16 v[192:195], v[208:211], v[80:83], 0
  s_waitcnt lgkmcnt(2)
  v_mfma_f32_16x16x32_bf16 v[184:187], v[212:215], v[84:87], v[184:187]
  ds_read_b128 v[208:211], v70 offset:24832
  v_cvt_pk_bf16_f32 v248, v196, v197
  v_mfma_f32_16x16x32_bf16 v[188:191], v[212:215], v[88:91], v[188:191]
  s_add_u32 m0, s81, 13312
  s_nop 0
  buffer_load_dwordx4 v49, s[12:15], s80 offen lds
  v_mfma_f32_16x16x32_bf16 v[192:195], v[212:215], v[92:95], v[192:195]
  v_cvt_pk_bf16_f32 v249, v198, v199
  s_waitcnt lgkmcnt(2)
  v_mfma_f32_16x16x32_bf16 v[184:187], v[216:219], v[96:99], v[184:187]
  ds_read_b128 v[212:215], v71 offset:24832
  v_cvt_pk_bf16_f32 v250, v200, v201
  v_mfma_f32_16x16x32_bf16 v[188:191], v[216:219], v[100:103], v[188:191]
  s_add_u32 m0, s81, 14336
  s_nop 0
  buffer_load_dwordx4 v50, s[12:15], s80 offen lds
  v_mfma_f32_16x16x32_bf16 v[192:195], v[216:219], v[104:107], v[192:195]
  v_cvt_pk_bf16_f32 v251, v202, v203
  s_waitcnt lgkmcnt(2)
  v_mfma_f32_16x16x32_bf16 v[184:187], v[220:223], v[108:111], v[184:187]
  ds_read_b128 v[216:219], v70 offset:25344
  v_accvgpr_write_b32 a22, v248
  v_mfma_f32_16x16x32_bf16 v[188:191], v[220:223], v[112:115], v[188:191]
  s_add_u32 m0, s81, 15360
  s_nop 0
  buffer_load_dwordx4 v51, s[12:15], s80 offen lds
  v_mfma_f32_16x16x32_bf16 v[192:195], v[220:223], v[116:119], v[192:195]
  v_accvgpr_write_b32 a23, v249
  s_waitcnt lgkmcnt(2)
  v_mfma_f32_16x16x32_bf16 v[184:187], v[208:211], v[120:123], v[184:187]
  ds_read_b128 v[220:223], v71 offset:25344
  v_accvgpr_write_b32 a102, v250
  v_mfma_f32_16x16x32_bf16 v[188:191], v[208:211], v[124:127], v[188:191]
  s_add_u32 m0, s81, 16384
  s_nop 0
  buffer_load_dwordx4 v52, s[12:15], s80 offen lds
  v_mfma_f32_16x16x32_bf16 v[192:195], v[208:211], v[128:131], v[192:195]
  v_accvgpr_write_b32 a103, v251
  s_waitcnt lgkmcnt(2)
  v_mfma_f32_16x16x32_bf16 v[184:187], v[212:215], v[132:135], v[184:187]
  ds_read_b128 v[208:211], v70 offset:25472
  s_mov_b64 exec, s[68:69]
  v_cvt_pk_bf16_f32 v154, v204, v205
  v_cvt_pk_bf16_f32 v155, v206, v207
  s_mov_b64 exec, -1
  v_mfma_f32_16x16x32_bf16 v[188:191], v[212:215], v[136:139], v[188:191]
  s_add_u32 m0, s81, 17408
  s_nop 0
  buffer_load_dwordx4 v53, s[12:15], s80 offen lds
  v_mfma_f32_16x16x32_bf16 v[192:195], v[212:215], v[140:143], v[192:195]
  s_waitcnt lgkmcnt(2)
  v_mfma_f32_16x16x32_bf16 v[196:199], v[216:219], v[72:75], 0
  ds_read_b128 v[212:215], v71 offset:25472
  v_mfma_f32_16x16x32_bf16 v[200:203], v[216:219], v[76:79], 0
  s_add_u32 m0, s81, 18432
  s_nop 0
  buffer_load_dwordx4 v54, s[12:15], s80 offen lds
  v_mfma_f32_16x16x32_bf16 v[204:207], v[216:219], v[80:83], 0
  s_waitcnt lgkmcnt(2)
  v_mfma_f32_16x16x32_bf16 v[196:199], v[220:223], v[84:87], v[196:199]
  ds_read_b128 v[216:219], v70 offset:25600
  v_cvt_pk_bf16_f32 v248, v184, v185
  v_mfma_f32_16x16x32_bf16 v[200:203], v[220:223], v[88:91], v[200:203]
  s_add_u32 m0, s81, 19456
  s_nop 0
  buffer_load_dwordx4 v55, s[12:15], s80 offen lds
  v_mfma_f32_16x16x32_bf16 v[204:207], v[220:223], v[92:95], v[204:207]
  v_cvt_pk_bf16_f32 v249, v186, v187
  s_waitcnt lgkmcnt(2)
  v_mfma_f32_16x16x32_bf16 v[196:199], v[208:211], v[96:99], v[196:199]
  ds_read_b128 v[220:223], v71 offset:25600
  v_cvt_pk_bf16_f32 v250, v188, v189
  v_mfma_f32_16x16x32_bf16 v[200:203], v[208:211], v[100:103], v[200:203]
  s_add_u32 m0, s81, 20480
  s_nop 0
  buffer_load_dwordx4 v56, s[12:15], s80 offen lds
  v_mfma_f32_16x16x32_bf16 v[204:207], v[208:211], v[104:107], v[204:207]
  v_cvt_pk_bf16_f32 v251, v190, v191
  s_waitcnt lgkmcnt(2)
  v_mfma_f32_16x16x32_bf16 v[196:199], v[212:215], v[108:111], v[196:199]
  v_accvgpr_write_b32 a24, v248
  v_mfma_f32_16x16x32_bf16 v[200:203], v[212:215], v[112:115], v[200:203]
  s_add_u32 m0, s81, 21504
  s_nop 0
  buffer_load_dwordx4 v57, s[12:15], s80 offen lds
  v_mfma_f32_16x16x32_bf16 v[204:207], v[212:215], v[116:119], v[204:207]
  v_accvgpr_write_b32 a25, v249
  s_waitcnt lgkmcnt(1)
  v_mfma_f32_16x16x32_bf16 v[196:199], v[216:219], v[120:123], v[196:199]
  v_accvgpr_write_b32 a104, v250
  v_mfma_f32_16x16x32_bf16 v[200:203], v[216:219], v[124:127], v[200:203]
  s_add_u32 m0, s81, 22528
  s_nop 0
  buffer_load_dwordx4 v58, s[12:15], s80 offen lds
  v_mfma_f32_16x16x32_bf16 v[204:207], v[216:219], v[128:131], v[204:207]
  v_accvgpr_write_b32 a105, v251
  s_waitcnt lgkmcnt(0)
  v_mfma_f32_16x16x32_bf16 v[196:199], v[220:223], v[132:135], v[196:199]
  v_cvt_pk_bf16_f32 v156, v192, v193
  v_cvt_pk_bf16_f32 v157, v194, v195
  v_mfma_f32_16x16x32_bf16 v[200:203], v[220:223], v[136:139], v[200:203]
  s_add_u32 m0, s81, 23552
  s_nop 0
  buffer_load_dwordx4 v59, s[12:15], s80 offen lds
  s_add_u32 s80, s80, 393216
  v_mfma_f32_16x16x32_bf16 v[204:207], v[220:223], v[140:143], v[204:207]
  s_add_u32 s21, s79, 393216
  buffer_load_dwordx4 a[196:199], v63, s[28:31], s21 offen
  s_add_u32 s21, s79, 393216
  buffer_load_dwordx4 a[200:203], v64, s[28:31], s21 offen
  s_add_u32 s21, s79, 393216
  buffer_load_dwordx4 a[204:207], v65, s[28:31], s21 offen
  s_waitcnt vmcnt(18)
  ds_read_b128 v[208:211], v70 offset:0
  ds_read_b128 v[212:215], v71 offset:0
  ds_read_b128 v[216:219], v70 offset:128
  s_waitcnt lgkmcnt(2)
  v_mfma_f32_16x16x32_bf16 v[184:187], v[208:211], v[72:75], 0
  ds_read_b128 v[220:223], v71 offset:128
  v_mfma_f32_16x16x32_bf16 v[188:191], v[208:211], v[76:79], 0
  s_add_u32 m0, s81, 24576
  s_nop 0
  buffer_load_dwordx4 v48, s[12:15], s80 offen lds
  v_mfma_f32_16x16x32_bf16 v[192:195], v[208:211], v[80:83], 0
  s_waitcnt lgkmcnt(2)
  v_mfma_f32_16x16x32_bf16 v[184:187], v[212:215], v[84:87], v[184:187]
  ds_read_b128 v[208:211], v70 offset:256
  v_cvt_pk_bf16_f32 v248, v196, v197
  v_mfma_f32_16x16x32_bf16 v[188:191], v[212:215], v[88:91], v[188:191]
  s_add_u32 m0, s81, 25600
  s_nop 0
  buffer_load_dwordx4 v49, s[12:15], s80 offen lds
  v_mfma_f32_16x16x32_bf16 v[192:195], v[212:215], v[92:95], v[192:195]
  v_cvt_pk_bf16_f32 v249, v198, v199
  s_waitcnt lgkmcnt(2)
  v_mfma_f32_16x16x32_bf16 v[184:187], v[216:219], v[96:99], v[184:187]
  ds_read_b128 v[212:215], v71 offset:256
  v_cvt_pk_bf16_f32 v250, v200, v201
  v_mfma_f32_16x16x32_bf16 v[188:191], v[216:219], v[100:103], v[188:191]
  s_add_u32 m0, s81, 26624
  s_nop 0
  buffer_load_dwordx4 v50, s[12:15], s80 offen lds
  v_mfma_f32_16x16x32_bf16 v[192:195], v[216:219], v[104:107], v[192:195]
  v_cvt_pk_bf16_f32 v251, v202, v203
  s_waitcnt lgkmcnt(2)
  v_mfma_f32_16x16x32_bf16 v[184:187], v[220:223], v[108:111], v[184:187]
  ds_read_b128 v[216:219], v70 offset:768
  v_accvgpr_write_b32 a26, v248
  v_mfma_f32_16x16x32_bf16 v[188:191], v[220:223], v[112:115], v[188:191]
  s_add_u32 m0, s81, 27648
  s_nop 0
  buffer_load_dwordx4 v51, s[12:15], s80 offen lds
  v_mfma_f32_16x16x32_bf16 v[192:195], v[220:223], v[116:119], v[192:195]
  v_accvgpr_write_b32 a27, v249
  s_waitcnt lgkmcnt(2)
  v_mfma_f32_16x16x32_bf16 v[184:187], v[208:211], v[120:123], v[184:187]
  ds_read_b128 v[220:223], v71 offset:768
  v_accvgpr_write_b32 a106, v250
  v_mfma_f32_16x16x32_bf16 v[188:191], v[208:211], v[124:127], v[188:191]
  s_add_u32 m0, s81, 28672
  s_nop 0
  buffer_load_dwordx4 v52, s[12:15], s80 offen lds
  v_mfma_f32_16x16x32_bf16 v[192:195], v[208:211], v[128:131], v[192:195]
  v_accvgpr_write_b32 a107, v251
  s_waitcnt lgkmcnt(2)
  v_mfma_f32_16x16x32_bf16 v[184:187], v[212:215], v[132:135], v[184:187]
  ds_read_b128 v[208:211], v70 offset:896
  s_mov_b64 exec, s[68:69]
  v_cvt_pk_bf16_f32 v156, v204, v205
  v_cvt_pk_bf16_f32 v157, v206, v207
  s_mov_b64 exec, -1
  v_mfma_f32_16x16x32_bf16 v[188:191], v[212:215], v[136:139], v[188:191]
  s_add_u32 m0, s81, 29696
  s_nop 0
  buffer_load_dwordx4 v53, s[12:15], s80 offen lds
  v_mfma_f32_16x16x32_bf16 v[192:195], v[212:215], v[140:143], v[192:195]
  s_waitcnt lgkmcnt(2)
  v_mfma_f32_16x16x32_bf16 v[196:199], v[216:219], v[72:75], 0
  ds_read_b128 v[212:215], v71 offset:896
  v_mfma_f32_16x16x32_bf16 v[200:203], v[216:219], v[76:79], 0
  s_add_u32 m0, s81, 30720
  s_nop 0
  buffer_load_dwordx4 v54, s[12:15], s80 offen lds
  v_mfma_f32_16x16x32_bf16 v[204:207], v[216:219], v[80:83], 0
  s_waitcnt lgkmcnt(2)
  v_mfma_f32_16x16x32_bf16 v[196:199], v[220:223], v[84:87], v[196:199]
  ds_read_b128 v[216:219], v70 offset:1024
  v_cvt_pk_bf16_f32 v248, v184, v185
  v_mfma_f32_16x16x32_bf16 v[200:203], v[220:223], v[88:91], v[200:203]
  s_add_u32 m0, s81, 31744
  s_nop 0
  buffer_load_dwordx4 v55, s[12:15], s80 offen lds
  v_mfma_f32_16x16x32_bf16 v[204:207], v[220:223], v[92:95], v[204:207]
  v_cvt_pk_bf16_f32 v249, v186, v187
  s_waitcnt lgkmcnt(2)
  v_mfma_f32_16x16x32_bf16 v[196:199], v[208:211], v[96:99], v[196:199]
  ds_read_b128 v[220:223], v71 offset:1024
  v_cvt_pk_bf16_f32 v250, v188, v189
  v_mfma_f32_16x16x32_bf16 v[200:203], v[208:211], v[100:103], v[200:203]
  s_add_u32 m0, s81, 32768
  s_nop 0
  buffer_load_dwordx4 v56, s[12:15], s80 offen lds
  v_mfma_f32_16x16x32_bf16 v[204:207], v[208:211], v[104:107], v[204:207]
  v_cvt_pk_bf16_f32 v251, v190, v191
  s_waitcnt lgkmcnt(2)
  v_mfma_f32_16x16x32_bf16 v[196:199], v[212:215], v[108:111], v[196:199]
  v_accvgpr_write_b32 a28, v248
  v_mfma_f32_16x16x32_bf16 v[200:203], v[212:215], v[112:115], v[200:203]
  s_add_u32 m0, s81, 33792
  s_nop 0
  buffer_load_dwordx4 v57, s[12:15], s80 offen lds
  v_mfma_f32_16x16x32_bf16 v[204:207], v[212:215], v[116:119], v[204:207]
  v_accvgpr_write_b32 a29, v249
  s_waitcnt lgkmcnt(1)
  v_mfma_f32_16x16x32_bf16 v[196:199], v[216:219], v[120:123], v[196:199]
  v_accvgpr_write_b32 a108, v250
  v_mfma_f32_16x16x32_bf16 v[200:203], v[216:219], v[124:127], v[200:203]
  s_add_u32 m0, s81, 34816
  s_nop 0
  buffer_load_dwordx4 v58, s[12:15], s80 offen lds
  v_mfma_f32_16x16x32_bf16 v[204:207], v[216:219], v[128:131], v[204:207]
  v_accvgpr_write_b32 a109, v251
  s_waitcnt lgkmcnt(0)
  v_mfma_f32_16x16x32_bf16 v[196:199], v[220:223], v[132:135], v[196:199]
  v_cvt_pk_bf16_f32 v158, v192, v193
  v_cvt_pk_bf16_f32 v159, v194, v195
  v_mfma_f32_16x16x32_bf16 v[200:203], v[220:223], v[136:139], v[200:203]
  s_add_u32 m0, s81, 35840
  s_nop 0
  buffer_load_dwordx4 v59, s[12:15], s80 offen lds
  s_add_u32 s80, s80, 393216
  v_mfma_f32_16x16x32_bf16 v[204:207], v[220:223], v[140:143], v[204:207]
  s_add_u32 s21, s79, 786432
  buffer_load_dwordx4 a[220:223], v63, s[28:31], s21 offen
  s_add_u32 s21, s79, 786432
  buffer_load_dwordx4 a[224:227], v64, s[28:31], s21 offen
  s_add_u32 s21, s79, 786432
  buffer_load_dwordx4 a[228:231], v65, s[28:31], s21 offen
  s_waitcnt vmcnt(18)
  ds_read_b128 v[208:211], v70 offset:12288
  ds_read_b128 v[212:215], v71 offset:12288
  ds_read_b128 v[216:219], v70 offset:12416
  s_waitcnt lgkmcnt(2)
  v_mfma_f32_16x16x32_bf16 v[184:187], v[208:211], v[72:75], 0
  ds_read_b128 v[220:223], v71 offset:12416
  v_mfma_f32_16x16x32_bf16 v[188:191], v[208:211], v[76:79], 0
  s_add_u32 m0, s81, 0
  s_nop 0
  buffer_load_dwordx4 v48, s[12:15], s80 offen lds
  v_mfma_f32_16x16x32_bf16 v[192:195], v[208:211], v[80:83], 0
  s_waitcnt lgkmcnt(2)
  v_mfma_f32_16x16x32_bf16 v[184:187], v[212:215], v[84:87], v[184:187]
  ds_read_b128 v[208:211], v70 offset:12544
  v_cvt_pk_bf16_f32 v248, v196, v197
  v_mfma_f32_16x16x32_bf16 v[188:191], v[212:215], v[88:91], v[188:191]
  s_add_u32 m0, s81, 1024
  s_nop 0
  buffer_load_dwordx4 v49, s[12:15], s80 offen lds
  v_mfma_f32_16x16x32_bf16 v[192:195], v[212:215], v[92:95], v[192:195]
  v_cvt_pk_bf16_f32 v249, v198, v199
  s_waitcnt lgkmcnt(2)
  v_mfma_f32_16x16x32_bf16 v[184:187], v[216:219], v[96:99], v[184:187]
  ds_read_b128 v[212:215], v71 offset:12544
  v_cvt_pk_bf16_f32 v250, v200, v201
  v_mfma_f32_16x16x32_bf16 v[188:191], v[216:219], v[100:103], v[188:191]
  s_add_u32 m0, s81, 2048
  s_nop 0
  buffer_load_dwordx4 v50, s[12:15], s80 offen lds
  v_mfma_f32_16x16x32_bf16 v[192:195], v[216:219], v[104:107], v[192:195]
  v_cvt_pk_bf16_f32 v251, v202, v203
  s_waitcnt lgkmcnt(2)
  v_mfma_f32_16x16x32_bf16 v[184:187], v[220:223], v[108:111], v[184:187]
  ds_read_b128 v[216:219], v70 offset:13056
  v_accvgpr_write_b32 a30, v248
  v_mfma_f32_16x16x32_bf16 v[188:191], v[220:223], v[112:115], v[188:191]
  s_add_u32 m0, s81, 3072
  s_nop 0
  buffer_load_dwordx4 v51, s[12:15], s80 offen lds
  v_mfma_f32_16x16x32_bf16 v[192:195], v[220:223], v[116:119], v[192:195]
  v_accvgpr_write_b32 a31, v249
  s_waitcnt lgkmcnt(2)
  v_mfma_f32_16x16x32_bf16 v[184:187], v[208:211], v[120:123], v[184:187]
  ds_read_b128 v[220:223], v71 offset:13056
  v_accvgpr_write_b32 a110, v250
  v_mfma_f32_16x16x32_bf16 v[188:191], v[208:211], v[124:127], v[188:191]
  s_add_u32 m0, s81, 4096
  s_nop 0
  buffer_load_dwordx4 v52, s[12:15], s80 offen lds
  v_mfma_f32_16x16x32_bf16 v[192:195], v[208:211], v[128:131], v[192:195]
  v_accvgpr_write_b32 a111, v251
  s_waitcnt lgkmcnt(2)
  v_mfma_f32_16x16x32_bf16 v[184:187], v[212:215], v[132:135], v[184:187]
  ds_read_b128 v[208:211], v70 offset:13184
  s_mov_b64 exec, s[68:69]
  v_cvt_pk_bf16_f32 v158, v204, v205
  v_cvt_pk_bf16_f32 v159, v206, v207
  s_mov_b64 exec, -1
  v_mfma_f32_16x16x32_bf16 v[188:191], v[212:215], v[136:139], v[188:191]
  s_add_u32 m0, s81, 5120
  s_nop 0
  buffer_load_dwordx4 v53, s[12:15], s80 offen lds
  v_mfma_f32_16x16x32_bf16 v[192:195], v[212:215], v[140:143], v[192:195]
  s_waitcnt lgkmcnt(2)
  v_mfma_f32_16x16x32_bf16 v[196:199], v[216:219], v[72:75], 0
  ds_read_b128 v[212:215], v71 offset:13184
  v_mfma_f32_16x16x32_bf16 v[200:203], v[216:219], v[76:79], 0
  s_add_u32 m0, s81, 6144
  s_nop 0
  buffer_load_dwordx4 v54, s[12:15], s80 offen lds
  v_mfma_f32_16x16x32_bf16 v[204:207], v[216:219], v[80:83], 0
  s_waitcnt lgkmcnt(2)
  v_mfma_f32_16x16x32_bf16 v[196:199], v[220:223], v[84:87], v[196:199]
  ds_read_b128 v[216:219], v70 offset:13312
  v_cvt_pk_bf16_f32 v248, v184, v185
  v_mfma_f32_16x16x32_bf16 v[200:203], v[220:223], v[88:91], v[200:203]
  s_add_u32 m0, s81, 7168
  s_nop 0
  buffer_load_dwordx4 v55, s[12:15], s80 offen lds
  v_mfma_f32_16x16x32_bf16 v[204:207], v[220:223], v[92:95], v[204:207]
  v_cvt_pk_bf16_f32 v249, v186, v187
  s_waitcnt lgkmcnt(2)
  v_mfma_f32_16x16x32_bf16 v[196:199], v[208:211], v[96:99], v[196:199]
  ds_read_b128 v[220:223], v71 offset:13312
  v_cvt_pk_bf16_f32 v250, v188, v189
  v_mfma_f32_16x16x32_bf16 v[200:203], v[208:211], v[100:103], v[200:203]
  s_add_u32 m0, s81, 8192
  s_nop 0
  buffer_load_dwordx4 v56, s[12:15], s80 offen lds
  v_mfma_f32_16x16x32_bf16 v[204:207], v[208:211], v[104:107], v[204:207]
  v_cvt_pk_bf16_f32 v251, v190, v191
  s_waitcnt lgkmcnt(2)
  v_mfma_f32_16x16x32_bf16 v[196:199], v[212:215], v[108:111], v[196:199]
  v_accvgpr_write_b32 a32, v248
  v_mfma_f32_16x16x32_bf16 v[200:203], v[212:215], v[112:115], v[200:203]
  s_add_u32 m0, s81, 9216
  s_nop 0
  buffer_load_dwordx4 v57, s[12:15], s80 offen lds
  v_mfma_f32_16x16x32_bf16 v[204:207], v[212:215], v[116:119], v[204:207]
  v_accvgpr_write_b32 a33, v249
  s_waitcnt lgkmcnt(1)
  v_mfma_f32_16x16x32_bf16 v[196:199], v[216:219], v[120:123], v[196:199]
  v_accvgpr_write_b32 a112, v250
  v_mfma_f32_16x16x32_bf16 v[200:203], v[216:219], v[124:127], v[200:203]
  s_add_u32 m0, s81, 10240
  s_nop 0
  buffer_load_dwordx4 v58, s[12:15], s80 offen lds
  v_mfma_f32_16x16x32_bf16 v[204:207], v[216:219], v[128:131], v[204:207]
  v_accvgpr_write_b32 a113, v251
  s_waitcnt lgkmcnt(0)
  v_mfma_f32_16x16x32_bf16 v[196:199], v[220:223], v[132:135], v[196:199]
  v_cvt_pk_bf16_f32 v160, v192, v193
  v_cvt_pk_bf16_f32 v161, v194, v195
  v_mfma_f32_16x16x32_bf16 v[200:203], v[220:223], v[136:139], v[200:203]
  s_add_u32 m0, s81, 11264
  s_nop 0
  buffer_load_dwordx4 v59, s[12:15], s80 offen lds
  s_add_u32 s80, s80, 393216
  v_mfma_f32_16x16x32_bf16 v[204:207], v[220:223], v[140:143], v[204:207]
  s_add_u32 s21, s79, 1179648
  buffer_load_dwordx4 a[244:247], v63, s[28:31], s21 offen
  s_add_u32 s21, s79, 1179648
  buffer_load_dwordx4 a[248:251], v64, s[28:31], s21 offen
  s_add_u32 s21, s79, 1179648
  buffer_load_dwordx4 a[252:255], v65, s[28:31], s21 offen
  s_waitcnt vmcnt(18)
  ds_read_b128 v[208:211], v70 offset:24576
  ds_read_b128 v[212:215], v71 offset:24576
  ds_read_b128 v[216:219], v70 offset:24704
  s_waitcnt lgkmcnt(2)
  v_mfma_f32_16x16x32_bf16 v[184:187], v[208:211], v[72:75], 0
  ds_read_b128 v[220:223], v71 offset:24704
  v_mfma_f32_16x16x32_bf16 v[188:191], v[208:211], v[76:79], 0
  s_add_u32 m0, s81, 12288
  s_nop 0
  buffer_load_dwordx4 v48, s[12:15], s80 offen lds
  v_mfma_f32_16x16x32_bf16 v[192:195], v[208:211], v[80:83], 0
  s_waitcnt lgkmcnt(2)
  v_mfma_f32_16x16x32_bf16 v[184:187], v[212:215], v[84:87], v[184:187]
  ds_read_b128 v[208:211], v70 offset:24832
  v_cvt_pk_bf16_f32 v248, v196, v197
  v_mfma_f32_16x16x32_bf16 v[188:191], v[212:215], v[88:91], v[188:191]
  s_add_u32 m0, s81, 13312
  s_nop 0
  buffer_load_dwordx4 v49, s[12:15], s80 offen lds
  v_mfma_f32_16x16x32_bf16 v[192:195], v[212:215], v[92:95], v[192:195]
  v_cvt_pk_bf16_f32 v249, v198, v199
  s_waitcnt lgkmcnt(2)
  v_mfma_f32_16x16x32_bf16 v[184:187], v[216:219], v[96:99], v[184:187]
  ds_read_b128 v[212:215], v71 offset:24832
  v_cvt_pk_bf16_f32 v250, v200, v201
  v_mfma_f32_16x16x32_bf16 v[188:191], v[216:219], v[100:103], v[188:191]
  s_add_u32 m0, s81, 14336
  s_nop 0
  buffer_load_dwordx4 v50, s[12:15], s80 offen lds
  v_mfma_f32_16x16x32_bf16 v[192:195], v[216:219], v[104:107], v[192:195]
  v_cvt_pk_bf16_f32 v251, v202, v203
  s_waitcnt lgkmcnt(2)
  v_mfma_f32_16x16x32_bf16 v[184:187], v[220:223], v[108:111], v[184:187]
  ds_read_b128 v[216:219], v70 offset:25344
  v_accvgpr_write_b32 a34, v248
  v_mfma_f32_16x16x32_bf16 v[188:191], v[220:223], v[112:115], v[188:191]
  s_add_u32 m0, s81, 15360
  s_nop 0
  buffer_load_dwordx4 v51, s[12:15], s80 offen lds
  v_mfma_f32_16x16x32_bf16 v[192:195], v[220:223], v[116:119], v[192:195]
  v_accvgpr_write_b32 a35, v249
  s_waitcnt lgkmcnt(2)
  v_mfma_f32_16x16x32_bf16 v[184:187], v[208:211], v[120:123], v[184:187]
  ds_read_b128 v[220:223], v71 offset:25344
  v_accvgpr_write_b32 a114, v250
  v_mfma_f32_16x16x32_bf16 v[188:191], v[208:211], v[124:127], v[188:191]
  s_add_u32 m0, s81, 16384
  s_nop 0
  buffer_load_dwordx4 v52, s[12:15], s80 offen lds
  v_mfma_f32_16x16x32_bf16 v[192:195], v[208:211], v[128:131], v[192:195]
  v_accvgpr_write_b32 a115, v251
  s_waitcnt lgkmcnt(2)
  v_mfma_f32_16x16x32_bf16 v[184:187], v[212:215], v[132:135], v[184:187]
  ds_read_b128 v[208:211], v70 offset:25472
  s_mov_b64 exec, s[68:69]
  v_cvt_pk_bf16_f32 v160, v204, v205
  v_cvt_pk_bf16_f32 v161, v206, v207
  s_mov_b64 exec, -1
  v_mfma_f32_16x16x32_bf16 v[188:191], v[212:215], v[136:139], v[188:191]
  s_add_u32 m0, s81, 17408
  s_nop 0
  buffer_load_dwordx4 v53, s[12:15], s80 offen lds
  v_mfma_f32_16x16x32_bf16 v[192:195], v[212:215], v[140:143], v[192:195]
  s_waitcnt lgkmcnt(2)
  v_mfma_f32_16x16x32_bf16 v[196:199], v[216:219], v[72:75], 0
  ds_read_b128 v[212:215], v71 offset:25472
  v_mfma_f32_16x16x32_bf16 v[200:203], v[216:219], v[76:79], 0
  s_add_u32 m0, s81, 18432
  s_nop 0
  buffer_load_dwordx4 v54, s[12:15], s80 offen lds
  v_mfma_f32_16x16x32_bf16 v[204:207], v[216:219], v[80:83], 0
  s_waitcnt lgkmcnt(2)
  v_mfma_f32_16x16x32_bf16 v[196:199], v[220:223], v[84:87], v[196:199]
  ds_read_b128 v[216:219], v70 offset:25600
  v_cvt_pk_bf16_f32 v248, v184, v185
  v_mfma_f32_16x16x32_bf16 v[200:203], v[220:223], v[88:91], v[200:203]
  s_add_u32 m0, s81, 19456
  s_nop 0
  buffer_load_dwordx4 v55, s[12:15], s80 offen lds
  v_mfma_f32_16x16x32_bf16 v[204:207], v[220:223], v[92:95], v[204:207]
  v_cvt_pk_bf16_f32 v249, v186, v187
  s_waitcnt lgkmcnt(2)
  v_mfma_f32_16x16x32_bf16 v[196:199], v[208:211], v[96:99], v[196:199]
  ds_read_b128 v[220:223], v71 offset:25600
  v_cvt_pk_bf16_f32 v250, v188, v189
  v_mfma_f32_16x16x32_bf16 v[200:203], v[208:211], v[100:103], v[200:203]
  s_add_u32 m0, s81, 20480
  s_nop 0
  buffer_load_dwordx4 v56, s[12:15], s80 offen lds
  v_mfma_f32_16x16x32_bf16 v[204:207], v[208:211], v[104:107], v[204:207]
  v_cvt_pk_bf16_f32 v251, v190, v191
  s_waitcnt lgkmcnt(2)
  v_mfma_f32_16x16x32_bf16 v[196:199], v[212:215], v[108:111], v[196:199]
  v_accvgpr_write_b32 a36, v248
  v_mfma_f32_16x16x32_bf16 v[200:203], v[212:215], v[112:115], v[200:203]
  s_add_u32 m0, s81, 21504
  s_nop 0
  buffer_load_dwordx4 v57, s[12:15], s80 offen lds
  v_mfma_f32_16x16x32_bf16 v[204:207], v[212:215], v[116:119], v[204:207]
  v_accvgpr_write_b32 a37, v249
  s_waitcnt lgkmcnt(1)
  v_mfma_f32_16x16x32_bf16 v[196:199], v[216:219], v[120:123], v[196:199]
  v_accvgpr_write_b32 a116, v250
  v_mfma_f32_16x16x32_bf16 v[200:203], v[216:219], v[124:127], v[200:203]
  s_add_u32 m0, s81, 22528
  s_nop 0
  buffer_load_dwordx4 v58, s[12:15], s80 offen lds
  v_mfma_f32_16x16x32_bf16 v[204:207], v[216:219], v[128:131], v[204:207]
  v_accvgpr_write_b32 a117, v251
  s_waitcnt lgkmcnt(0)
  v_mfma_f32_16x16x32_bf16 v[196:199], v[220:223], v[132:135], v[196:199]
  v_cvt_pk_bf16_f32 v162, v192, v193
  v_cvt_pk_bf16_f32 v163, v194, v195
  v_mfma_f32_16x16x32_bf16 v[200:203], v[220:223], v[136:139], v[200:203]
  s_add_u32 m0, s81, 23552
  s_nop 0
  buffer_load_dwordx4 v59, s[12:15], s80 offen lds
  s_add_u32 s80, s80, 393216
  v_mfma_f32_16x16x32_bf16 v[204:207], v[220:223], v[140:143], v[204:207]
  s_add_u32 s21, s79, 1572864
  buffer_load_dwordx4 v[236:239], v63, s[28:31], s21 offen
  s_add_u32 s21, s79, 1572864
  buffer_load_dwordx4 v[240:243], v64, s[28:31], s21 offen
  s_add_u32 s21, s79, 1572864
  buffer_load_dwordx4 v[244:247], v65, s[28:31], s21 offen
  s_waitcnt vmcnt(18)
  ds_read_b128 v[208:211], v70 offset:0
  ds_read_b128 v[212:215], v71 offset:0
  ds_read_b128 v[216:219], v70 offset:128
  s_waitcnt lgkmcnt(2)
  v_mfma_f32_16x16x32_bf16 v[184:187], v[208:211], v[72:75], 0
  ds_read_b128 v[220:223], v71 offset:128
  v_mfma_f32_16x16x32_bf16 v[188:191], v[208:211], v[76:79], 0
  s_add_u32 m0, s81, 24576
  s_nop 0
  buffer_load_dwordx4 v48, s[12:15], s80 offen lds
  ds_write_b64 v69, v[144:145] offset:36864
  v_mfma_f32_16x16x32_bf16 v[192:195], v[208:211], v[80:83], 0
  s_waitcnt lgkmcnt(3)
  v_mfma_f32_16x16x32_bf16 v[184:187], v[212:215], v[84:87], v[184:187]
  ds_read_b128 v[208:211], v70 offset:256
  v_cvt_pk_bf16_f32 v248, v196, v197
  v_mfma_f32_16x16x32_bf16 v[188:191], v[212:215], v[88:91], v[188:191]
  s_add_u32 m0, s81, 25600
  s_nop 0
  buffer_load_dwordx4 v49, s[12:15], s80 offen lds
  ds_write_b64 v69, v[146:147] offset:37376
  v_mfma_f32_16x16x32_bf16 v[192:195], v[212:215], v[92:95], v[192:195]
  v_cvt_pk_bf16_f32 v249, v198, v199
  s_waitcnt lgkmcnt(4)
  v_mfma_f32_16x16x32_bf16 v[184:187], v[216:219], v[96:99], v[184:187]
  ds_read_b128 v[212:215], v71 offset:256
  v_cvt_pk_bf16_f32 v250, v200, v201
  v_mfma_f32_16x16x32_bf16 v[188:191], v[216:219], v[100:103], v[188:191]
  s_add_u32 m0, s81, 26624
  s_nop 0
  buffer_load_dwordx4 v50, s[12:15], s80 offen lds
  ds_write_b64 v69, v[148:149] offset:37888
  v_mfma_f32_16x16x32_bf16 v[192:195], v[216:219], v[104:107], v[192:195]
  v_cvt_pk_bf16_f32 v251, v202, v203
  s_waitcnt lgkmcnt(5)
  v_mfma_f32_16x16x32_bf16 v[184:187], v[220:223], v[108:111], v[184:187]
  ds_read_b128 v[216:219], v70 offset:768
  v_accvgpr_write_b32 a38, v248
  v_mfma_f32_16x16x32_bf16 v[188:191], v[220:223], v[112:115], v[188:191]
  s_add_u32 m0, s81, 27648
  s_nop 0
  buffer_load_dwordx4 v51, s[12:15], s80 offen lds
  ds_write_b64 v69, v[150:151] offset:38400
  v_mfma_f32_16x16x32_bf16 v[192:195], v[220:223], v[116:119], v[192:195]
  v_accvgpr_write_b32 a39, v249
  s_waitcnt lgkmcnt(5)
  v_mfma_f32_16x16x32_bf16 v[184:187], v[208:211], v[120:123], v[184:187]
  ds_read_b128 v[220:223], v71 offset:768
  v_accvgpr_write_b32 a118, v250
  v_mfma_f32_16x16x32_bf16 v[188:191], v[208:211], v[124:127], v[188:191]
  s_add_u32 m0, s81, 28672
  s_nop 0
  buffer_load_dwordx4 v52, s[12:15], s80 offen lds
  ds_write_b64 v69, v[152:153] offset:38912
  v_mfma_f32_16x16x32_bf16 v[192:195], v[208:211], v[128:131], v[192:195]
  v_accvgpr_write_b32 a119, v251
  s_waitcnt lgkmcnt(5)
  v_mfma_f32_16x16x32_bf16 v[184:187], v[212:215], v[132:135], v[184:187]
  ds_read_b128 v[208:211], v70 offset:896
  s_mov_b64 exec, s[68:69]
  v_cvt_pk_bf16_f32 v162, v204, v205
  v_cvt_pk_bf16_f32 v163, v206, v207
  s_mov_b64 exec, -1
  v_mfma_f32_16x16x32_bf16 v[188:191], v[212:215], v[136:139], v[188:191]
  s_add_u32 m0, s81, 29696
  s_nop 0
  buffer_load_dwordx4 v53, s[12:15], s80 offen lds
  ds_write_b64 v69, v[154:155] offset:39424
  v_mfma_f32_16x16x32_bf16 v[192:195], v[212:215], v[140:143], v[192:195]
  s_waitcnt lgkmcnt(5)
  v_mfma_f32_16x16x32_bf16 v[196:199], v[216:219], v[72:75], 0
  ds_read_b128 v[212:215], v71 offset:896
  v_mfma_f32_16x16x32_bf16 v[200:203], v[216:219], v[76:79], 0
  s_add_u32 m0, s81, 30720
  s_nop 0
  buffer_load_dwordx4 v54, s[12:15], s80 offen lds
  ds_write_b64 v69, v[156:157] offset:39936
  v_mfma_f32_16x16x32_bf16 v[204:207], v[216:219], v[80:83], 0
  s_waitcnt lgkmcnt(5)
  v_mfma_f32_16x16x32_bf16 v[196:199], v[220:223], v[84:87], v[196:199]
  ds_read_b128 v[216:219], v70 offset:1024
  v_cvt_pk_bf16_f32 v248, v184, v185
  v_mfma_f32_16x16x32_bf16 v[200:203], v[220:223], v[88:91], v[200:203]
  s_add_u32 m0, s81, 31744
  s_nop 0
  buffer_load_dwordx4 v55, s[12:15], s80 offen lds
  ds_write_b64 v69, v[158:159] offset:40448
  v_mfma_f32_16x16x32_bf16 v[204:207], v[220:223], v[92:95], v[204:207]
  v_cvt_pk_bf16_f32 v249, v186, v187
  s_waitcnt lgkmcnt(5)
  v_mfma_f32_16x16x32_bf16 v[196:199], v[208:211], v[96:99], v[196:199]
  ds_read_b128 v[220:223], v71 offset:1024
  v_cvt_pk_bf16_f32 v250, v188, v189
  v_mfma_f32_16x16x32_bf16 v[200:203], v[208:211], v[100:103], v[200:203]
  s_add_u32 m0, s81, 32768
  s_nop 0
  buffer_load_dwordx4 v56, s[12:15], s80 offen lds
  v_mfma_f32_16x16x32_bf16 v[204:207], v[208:211], v[104:107], v[204:207]
  v_cvt_pk_bf16_f32 v251, v190, v191
  s_waitcnt lgkmcnt(4)
  v_mfma_f32_16x16x32_bf16 v[196:199], v[212:215], v[108:111], v[196:199]
  v_accvgpr_write_b32 a40, v248
  v_mfma_f32_16x16x32_bf16 v[200:203], v[212:215], v[112:115], v[200:203]
  s_add_u32 m0, s81, 33792
  s_nop 0
  buffer_load_dwordx4 v57, s[12:15], s80 offen lds
  v_mfma_f32_16x16x32_bf16 v[204:207], v[212:215], v[116:119], v[204:207]
  v_accvgpr_write_b32 a41, v249
  s_waitcnt lgkmcnt(2)
  v_mfma_f32_16x16x32_bf16 v[196:199], v[216:219], v[120:123], v[196:199]
  v_accvgpr_write_b32 a120, v250
  v_mfma_f32_16x16x32_bf16 v[200:203], v[216:219], v[124:127], v[200:203]
  s_add_u32 m0, s81, 34816
  s_nop 0
  buffer_load_dwordx4 v58, s[12:15], s80 offen lds
  v_mfma_f32_16x16x32_bf16 v[204:207], v[216:219], v[128:131], v[204:207]
  v_accvgpr_write_b32 a121, v251
  s_waitcnt lgkmcnt(0)
  v_mfma_f32_16x16x32_bf16 v[196:199], v[220:223], v[132:135], v[196:199]
  v_cvt_pk_bf16_f32 v164, v192, v193
  v_cvt_pk_bf16_f32 v165, v194, v195
  v_mfma_f32_16x16x32_bf16 v[200:203], v[220:223], v[136:139], v[200:203]
  s_add_u32 m0, s81, 35840
  s_nop 0
  buffer_load_dwordx4 v59, s[12:15], s80 offen lds
  s_add_u32 s80, s80, 393216
  v_mfma_f32_16x16x32_bf16 v[204:207], v[220:223], v[140:143], v[204:207]
  s_add_u32 s21, s79, 0
  buffer_load_dwordx4 a[160:163], v63, s[24:27], s21 offen
  s_add_u32 s21, s79, 0
  buffer_load_dwordx4 a[164:167], v64, s[24:27], s21 offen
  s_add_u32 s21, s79, 0
  buffer_load_dwordx4 a[168:171], v65, s[24:27], s21 offen
  s_waitcnt vmcnt(18)
  ds_read_b128 v[208:211], v70 offset:12288
  ds_read_b128 v[212:215], v71 offset:12288
  ds_read_b128 v[216:219], v70 offset:12416
  s_waitcnt lgkmcnt(2)
  v_mfma_f32_16x16x32_bf16 v[184:187], v[208:211], v[72:75], 0
  ds_read_b128 v[220:223], v71 offset:12416
  v_mfma_f32_16x16x32_bf16 v[188:191], v[208:211], v[76:79], 0
  s_add_u32 m0, s81, 0
  s_nop 0
  buffer_load_dwordx4 v48, s[12:15], s80 offen lds
  v_mfma_f32_16x16x32_bf16 v[192:195], v[208:211], v[80:83], 0
  s_waitcnt lgkmcnt(2)
  v_mfma_f32_16x16x32_bf16 v[184:187], v[212:215], v[84:87], v[184:187]
  ds_read_b128 v[208:211], v70 offset:12544
  v_cvt_pk_bf16_f32 v248, v196, v197
  v_mfma_f32_16x16x32_bf16 v[188:191], v[212:215], v[88:91], v[188:191]
  s_add_u32 m0, s81, 1024
  s_nop 0
  buffer_load_dwordx4 v49, s[12:15], s80 offen lds
  v_mfma_f32_16x16x32_bf16 v[192:195], v[212:215], v[92:95], v[192:195]
  v_cvt_pk_bf16_f32 v249, v198, v199
  s_waitcnt lgkmcnt(2)
  v_mfma_f32_16x16x32_bf16 v[184:187], v[216:219], v[96:99], v[184:187]
  ds_read_b128 v[212:215], v71 offset:12544
  v_cvt_pk_bf16_f32 v250, v200, v201
  v_mfma_f32_16x16x32_bf16 v[188:191], v[216:219], v[100:103], v[188:191]
  s_add_u32 m0, s81, 2048
  s_nop 0
  buffer_load_dwordx4 v50, s[12:15], s80 offen lds
  v_mfma_f32_16x16x32_bf16 v[192:195], v[216:219], v[104:107], v[192:195]
  v_cvt_pk_bf16_f32 v251, v202, v203
  s_waitcnt lgkmcnt(2)
  v_mfma_f32_16x16x32_bf16 v[184:187], v[220:223], v[108:111], v[184:187]
  ds_read_b128 v[216:219], v70 offset:13056
  v_accvgpr_write_b32 a42, v248
  v_mfma_f32_16x16x32_bf16 v[188:191], v[220:223], v[112:115], v[188:191]
  s_add_u32 m0, s81, 3072
  s_nop 0
  buffer_load_dwordx4 v51, s[12:15], s80 offen lds
  v_mfma_f32_16x16x32_bf16 v[192:195], v[220:223], v[116:119], v[192:195]
  v_accvgpr_write_b32 a43, v249
  s_waitcnt lgkmcnt(2)
  v_mfma_f32_16x16x32_bf16 v[184:187], v[208:211], v[120:123], v[184:187]
  ds_read_b128 v[220:223], v71 offset:13056
  v_accvgpr_write_b32 a122, v250
  v_mfma_f32_16x16x32_bf16 v[188:191], v[208:211], v[124:127], v[188:191]
  s_add_u32 m0, s81, 4096
  s_nop 0
  buffer_load_dwordx4 v52, s[12:15], s80 offen lds
  v_mfma_f32_16x16x32_bf16 v[192:195], v[208:211], v[128:131], v[192:195]
  v_accvgpr_write_b32 a123, v251
  s_waitcnt lgkmcnt(2)
  v_mfma_f32_16x16x32_bf16 v[184:187], v[212:215], v[132:135], v[184:187]
  ds_read_b128 v[208:211], v70 offset:13184
  s_mov_b64 exec, s[68:69]
  v_cvt_pk_bf16_f32 v164, v204, v205
  v_cvt_pk_bf16_f32 v165, v206, v207
  s_mov_b64 exec, -1
  v_mfma_f32_16x16x32_bf16 v[188:191], v[212:215], v[136:139], v[188:191]
  s_add_u32 m0, s81, 5120
  s_nop 0
  buffer_load_dwordx4 v53, s[12:15], s80 offen lds
  v_mfma_f32_16x16x32_bf16 v[192:195], v[212:215], v[140:143], v[192:195]
  s_waitcnt lgkmcnt(2)
  v_mfma_f32_16x16x32_bf16 v[196:199], v[216:219], v[72:75], 0
  ds_read_b128 v[212:215], v71 offset:13184
  v_mfma_f32_16x16x32_bf16 v[200:203], v[216:219], v[76:79], 0
  s_add_u32 m0, s81, 6144
  s_nop 0
  buffer_load_dwordx4 v54, s[12:15], s80 offen lds
  v_mfma_f32_16x16x32_bf16 v[204:207], v[216:219], v[80:83], 0
  s_waitcnt lgkmcnt(2)
  v_mfma_f32_16x16x32_bf16 v[196:199], v[220:223], v[84:87], v[196:199]
  ds_read_b128 v[216:219], v70 offset:13312
  v_cvt_pk_bf16_f32 v248, v184, v185
  v_mfma_f32_16x16x32_bf16 v[200:203], v[220:223], v[88:91], v[200:203]
  s_add_u32 m0, s81, 7168
  s_nop 0
  buffer_load_dwordx4 v55, s[12:15], s80 offen lds
  v_mfma_f32_16x16x32_bf16 v[204:207], v[220:223], v[92:95], v[204:207]
  v_cvt_pk_bf16_f32 v249, v186, v187
  s_waitcnt lgkmcnt(2)
  v_mfma_f32_16x16x32_bf16 v[196:199], v[208:211], v[96:99], v[196:199]
  ds_read_b128 v[220:223], v71 offset:13312
  v_cvt_pk_bf16_f32 v250, v188, v189
  v_mfma_f32_16x16x32_bf16 v[200:203], v[208:211], v[100:103], v[200:203]
  s_add_u32 m0, s81, 8192
  s_nop 0
  buffer_load_dwordx4 v56, s[12:15], s80 offen lds
  v_mfma_f32_16x16x32_bf16 v[204:207], v[208:211], v[104:107], v[204:207]
  v_cvt_pk_bf16_f32 v251, v190, v191
  s_waitcnt lgkmcnt(2)
  v_mfma_f32_16x16x32_bf16 v[196:199], v[212:215], v[108:111], v[196:199]
  v_accvgpr_write_b32 a44, v248
  v_mfma_f32_16x16x32_bf16 v[200:203], v[212:215], v[112:115], v[200:203]
  s_add_u32 m0, s81, 9216
  s_nop 0
  buffer_load_dwordx4 v57, s[12:15], s80 offen lds
  v_mfma_f32_16x16x32_bf16 v[204:207], v[212:215], v[116:119], v[204:207]
  v_accvgpr_write_b32 a45, v249
  s_waitcnt lgkmcnt(1)
  v_mfma_f32_16x16x32_bf16 v[196:199], v[216:219], v[120:123], v[196:199]
  v_accvgpr_write_b32 a124, v250
  v_mfma_f32_16x16x32_bf16 v[200:203], v[216:219], v[124:127], v[200:203]
  s_add_u32 m0, s81, 10240
  s_nop 0
  buffer_load_dwordx4 v58, s[12:15], s80 offen lds
  v_mfma_f32_16x16x32_bf16 v[204:207], v[216:219], v[128:131], v[204:207]
  v_accvgpr_write_b32 a125, v251
  s_waitcnt lgkmcnt(0)
  v_mfma_f32_16x16x32_bf16 v[196:199], v[220:223], v[132:135], v[196:199]
  v_cvt_pk_bf16_f32 v166, v192, v193
  v_cvt_pk_bf16_f32 v167, v194, v195
  v_mfma_f32_16x16x32_bf16 v[200:203], v[220:223], v[136:139], v[200:203]
  s_add_u32 m0, s81, 11264
  s_nop 0
  buffer_load_dwordx4 v59, s[12:15], s80 offen lds
  s_add_u32 s80, s80, 393216
  v_mfma_f32_16x16x32_bf16 v[204:207], v[220:223], v[140:143], v[204:207]
  s_add_u32 s21, s79, 393216
  buffer_load_dwordx4 a[184:187], v63, s[24:27], s21 offen
  s_add_u32 s21, s79, 393216
  buffer_load_dwordx4 a[188:191], v64, s[24:27], s21 offen
  s_add_u32 s21, s79, 393216
  buffer_load_dwordx4 a[192:195], v65, s[24:27], s21 offen
  s_waitcnt vmcnt(18)
  ds_read_b128 v[208:211], v70 offset:24576
  ds_read_b128 v[212:215], v71 offset:24576
  ds_read_b128 v[216:219], v70 offset:24704
  s_waitcnt lgkmcnt(2)
  v_mfma_f32_16x16x32_bf16 v[184:187], v[208:211], v[72:75], 0
  ds_read_b128 v[220:223], v71 offset:24704
  v_mfma_f32_16x16x32_bf16 v[188:191], v[208:211], v[76:79], 0
  s_add_u32 m0, s81, 12288
  s_nop 0
  buffer_load_dwordx4 v48, s[12:15], s80 offen lds
  v_mfma_f32_16x16x32_bf16 v[192:195], v[208:211], v[80:83], 0
  s_waitcnt lgkmcnt(2)
  v_mfma_f32_16x16x32_bf16 v[184:187], v[212:215], v[84:87], v[184:187]
  ds_read_b128 v[208:211], v70 offset:24832
  v_cvt_pk_bf16_f32 v248, v196, v197
  v_mfma_f32_16x16x32_bf16 v[188:191], v[212:215], v[88:91], v[188:191]
  s_add_u32 m0, s81, 13312
  s_nop 0
  buffer_load_dwordx4 v49, s[12:15], s80 offen lds
  v_mfma_f32_16x16x32_bf16 v[192:195], v[212:215], v[92:95], v[192:195]
  v_cvt_pk_bf16_f32 v249, v198, v199
  s_waitcnt lgkmcnt(2)
  v_mfma_f32_16x16x32_bf16 v[184:187], v[216:219], v[96:99], v[184:187]
  ds_read_b128 v[212:215], v71 offset:24832
  v_cvt_pk_bf16_f32 v250, v200, v201
  v_mfma_f32_16x16x32_bf16 v[188:191], v[216:219], v[100:103], v[188:191]
  s_add_u32 m0, s81, 14336
  s_nop 0
  buffer_load_dwordx4 v50, s[12:15], s80 offen lds
  v_mfma_f32_16x16x32_bf16 v[192:195], v[216:219], v[104:107], v[192:195]
  v_cvt_pk_bf16_f32 v251, v202, v203
  s_waitcnt lgkmcnt(2)
  v_mfma_f32_16x16x32_bf16 v[184:187], v[220:223], v[108:111], v[184:187]
  ds_read_b128 v[216:219], v70 offset:25344
  v_accvgpr_write_b32 a46, v248
  v_mfma_f32_16x16x32_bf16 v[188:191], v[220:223], v[112:115], v[188:191]
  s_add_u32 m0, s81, 15360
  s_nop 0
  buffer_load_dwordx4 v51, s[12:15], s80 offen lds
  v_mfma_f32_16x16x32_bf16 v[192:195], v[220:223], v[116:119], v[192:195]
  v_accvgpr_write_b32 a47, v249
  s_waitcnt lgkmcnt(2)
  v_mfma_f32_16x16x32_bf16 v[184:187], v[208:211], v[120:123], v[184:187]
  ds_read_b128 v[220:223], v71 offset:25344
  v_accvgpr_write_b32 a126, v250
  v_mfma_f32_16x16x32_bf16 v[188:191], v[208:211], v[124:127], v[188:191]
  s_add_u32 m0, s81, 16384
  s_nop 0
  buffer_load_dwordx4 v52, s[12:15], s80 offen lds
  v_mfma_f32_16x16x32_bf16 v[192:195], v[208:211], v[128:131], v[192:195]
  v_accvgpr_write_b32 a127, v251
  s_waitcnt lgkmcnt(2)
  v_mfma_f32_16x16x32_bf16 v[184:187], v[212:215], v[132:135], v[184:187]
  ds_read_b128 v[208:211], v70 offset:25472
  s_mov_b64 exec, s[68:69]
  v_cvt_pk_bf16_f32 v166, v204, v205
  v_cvt_pk_bf16_f32 v167, v206, v207
  s_mov_b64 exec, -1
  v_mfma_f32_16x16x32_bf16 v[188:191], v[212:215], v[136:139], v[188:191]
  s_add_u32 m0, s81, 17408
  s_nop 0
  buffer_load_dwordx4 v53, s[12:15], s80 offen lds
  v_mfma_f32_16x16x32_bf16 v[192:195], v[212:215], v[140:143], v[192:195]
  s_waitcnt lgkmcnt(2)
  v_mfma_f32_16x16x32_bf16 v[196:199], v[216:219], v[72:75], 0
  ds_read_b128 v[212:215], v71 offset:25472
  v_mfma_f32_16x16x32_bf16 v[200:203], v[216:219], v[76:79], 0
  s_add_u32 m0, s81, 18432
  s_nop 0
  buffer_load_dwordx4 v54, s[12:15], s80 offen lds
  v_mfma_f32_16x16x32_bf16 v[204:207], v[216:219], v[80:83], 0
  s_waitcnt lgkmcnt(2)
  v_mfma_f32_16x16x32_bf16 v[196:199], v[220:223], v[84:87], v[196:199]
  ds_read_b128 v[216:219], v70 offset:25600
  v_cvt_pk_bf16_f32 v248, v184, v185
  v_mfma_f32_16x16x32_bf16 v[200:203], v[220:223], v[88:91], v[200:203]
  s_add_u32 m0, s81, 19456
  s_nop 0
  buffer_load_dwordx4 v55, s[12:15], s80 offen lds
  v_mfma_f32_16x16x32_bf16 v[204:207], v[220:223], v[92:95], v[204:207]
  v_cvt_pk_bf16_f32 v249, v186, v187
  s_waitcnt lgkmcnt(2)
  v_mfma_f32_16x16x32_bf16 v[196:199], v[208:211], v[96:99], v[196:199]
  ds_read_b128 v[220:223], v71 offset:25600
  v_cvt_pk_bf16_f32 v250, v188, v189
  v_mfma_f32_16x16x32_bf16 v[200:203], v[208:211], v[100:103], v[200:203]
  s_add_u32 m0, s81, 20480
  s_nop 0
  buffer_load_dwordx4 v56, s[12:15], s80 offen lds
  v_mfma_f32_16x16x32_bf16 v[204:207], v[208:211], v[104:107], v[204:207]
  v_cvt_pk_bf16_f32 v251, v190, v191
  s_waitcnt lgkmcnt(2)
  v_mfma_f32_16x16x32_bf16 v[196:199], v[212:215], v[108:111], v[196:199]
  v_accvgpr_write_b32 a48, v248
  v_mfma_f32_16x16x32_bf16 v[200:203], v[212:215], v[112:115], v[200:203]
  s_add_u32 m0, s81, 21504
  s_nop 0
  buffer_load_dwordx4 v57, s[12:15], s80 offen lds
  v_mfma_f32_16x16x32_bf16 v[204:207], v[212:215], v[116:119], v[204:207]
  v_accvgpr_write_b32 a49, v249
  s_waitcnt lgkmcnt(1)
  v_mfma_f32_16x16x32_bf16 v[196:199], v[216:219], v[120:123], v[196:199]
  v_accvgpr_write_b32 a128, v250
  v_mfma_f32_16x16x32_bf16 v[200:203], v[216:219], v[124:127], v[200:203]
  s_add_u32 m0, s81, 22528
  s_nop 0
  buffer_load_dwordx4 v58, s[12:15], s80 offen lds
  v_mfma_f32_16x16x32_bf16 v[204:207], v[216:219], v[128:131], v[204:207]
  v_accvgpr_write_b32 a129, v251
  s_waitcnt lgkmcnt(0)
  v_mfma_f32_16x16x32_bf16 v[196:199], v[220:223], v[132:135], v[196:199]
  v_cvt_pk_bf16_f32 v168, v192, v193
  v_cvt_pk_bf16_f32 v169, v194, v195
  v_mfma_f32_16x16x32_bf16 v[200:203], v[220:223], v[136:139], v[200:203]
  s_add_u32 m0, s81, 23552
  s_nop 0
  buffer_load_dwordx4 v59, s[12:15], s80 offen lds
  s_add_u32 s80, s80, 393216
  v_mfma_f32_16x16x32_bf16 v[204:207], v[220:223], v[140:143], v[204:207]
  s_add_u32 s21, s79, 786432
  buffer_load_dwordx4 a[208:211], v63, s[24:27], s21 offen
  s_add_u32 s21, s79, 786432
  buffer_load_dwordx4 a[212:215], v64, s[24:27], s21 offen
  s_add_u32 s21, s79, 786432
  buffer_load_dwordx4 a[216:219], v65, s[24:27], s21 offen
  s_waitcnt vmcnt(18)
  buffer_load_dword v66, v67, s[32:35], 0 offen sc1
  ds_read_b128 v[208:211], v70 offset:0
  ds_read_b128 v[212:215], v71 offset:0
  ds_read_b128 v[216:219], v70 offset:128
  s_waitcnt lgkmcnt(2)
  v_mfma_f32_16x16x32_bf16 v[184:187], v[208:211], v[72:75], 0
  ds_read_b128 v[220:223], v71 offset:128
  v_mfma_f32_16x16x32_bf16 v[188:191], v[208:211], v[76:79], 0
  s_add_u32 m0, s81, 24576
  s_nop 0
  buffer_load_dwordx4 v48, s[12:15], s80 offen lds
  v_mfma_f32_16x16x32_bf16 v[192:195], v[208:211], v[80:83], 0
  s_waitcnt lgkmcnt(2)
  v_mfma_f32_16x16x32_bf16 v[184:187], v[212:215], v[84:87], v[184:187]
  ds_read_b128 v[208:211], v70 offset:256
  v_cvt_pk_bf16_f32 v248, v196, v197
  v_mfma_f32_16x16x32_bf16 v[188:191], v[212:215], v[88:91], v[188:191]
  s_add_u32 m0, s81, 25600
  s_nop 0
  buffer_load_dwordx4 v49, s[12:15], s80 offen lds
  v_mfma_f32_16x16x32_bf16 v[192:195], v[212:215], v[92:95], v[192:195]
  v_cvt_pk_bf16_f32 v249, v198, v199
  s_waitcnt lgkmcnt(2)
  v_mfma_f32_16x16x32_bf16 v[184:187], v[216:219], v[96:99], v[184:187]
  ds_read_b128 v[212:215], v71 offset:256
  v_cvt_pk_bf16_f32 v250, v200, v201
  v_mfma_f32_16x16x32_bf16 v[188:191], v[216:219], v[100:103], v[188:191]
  s_add_u32 m0, s81, 26624
  s_nop 0
  buffer_load_dwordx4 v50, s[12:15], s80 offen lds
  v_mfma_f32_16x16x32_bf16 v[192:195], v[216:219], v[104:107], v[192:195]
  v_cvt_pk_bf16_f32 v251, v202, v203
  s_waitcnt lgkmcnt(2)
  v_mfma_f32_16x16x32_bf16 v[184:187], v[220:223], v[108:111], v[184:187]
  ds_read_b128 v[216:219], v70 offset:768
  v_accvgpr_write_b32 a50, v248
  v_mfma_f32_16x16x32_bf16 v[188:191], v[220:223], v[112:115], v[188:191]
  s_add_u32 m0, s81, 27648
  s_nop 0
  buffer_load_dwordx4 v51, s[12:15], s80 offen lds
  v_mfma_f32_16x16x32_bf16 v[192:195], v[220:223], v[116:119], v[192:195]
  v_accvgpr_write_b32 a51, v249
  s_waitcnt lgkmcnt(2)
  v_mfma_f32_16x16x32_bf16 v[184:187], v[208:211], v[120:123], v[184:187]
  ds_read_b128 v[220:223], v71 offset:768
  v_accvgpr_write_b32 a130, v250
  v_mfma_f32_16x16x32_bf16 v[188:191], v[208:211], v[124:127], v[188:191]
  s_add_u32 m0, s81, 28672
  s_nop 0
  buffer_load_dwordx4 v52, s[12:15], s80 offen lds
  v_mfma_f32_16x16x32_bf16 v[192:195], v[208:211], v[128:131], v[192:195]
  v_accvgpr_write_b32 a131, v251
  s_waitcnt lgkmcnt(2)
  v_mfma_f32_16x16x32_bf16 v[184:187], v[212:215], v[132:135], v[184:187]
  ds_read_b128 v[208:211], v70 offset:896
  s_mov_b64 exec, s[68:69]
  v_cvt_pk_bf16_f32 v168, v204, v205
  v_cvt_pk_bf16_f32 v169, v206, v207
  s_mov_b64 exec, -1
  v_mfma_f32_16x16x32_bf16 v[188:191], v[212:215], v[136:139], v[188:191]
  s_add_u32 m0, s81, 29696
  s_nop 0
  buffer_load_dwordx4 v53, s[12:15], s80 offen lds
  v_mfma_f32_16x16x32_bf16 v[192:195], v[212:215], v[140:143], v[192:195]
  s_waitcnt lgkmcnt(2)
  v_mfma_f32_16x16x32_bf16 v[196:199], v[216:219], v[72:75], 0
  ds_read_b128 v[212:215], v71 offset:896
  v_mfma_f32_16x16x32_bf16 v[200:203], v[216:219], v[76:79], 0
  s_add_u32 m0, s81, 30720
  s_nop 0
  buffer_load_dwordx4 v54, s[12:15], s80 offen lds
  v_mfma_f32_16x16x32_bf16 v[204:207], v[216:219], v[80:83], 0
  s_waitcnt lgkmcnt(2)
  v_mfma_f32_16x16x32_bf16 v[196:199], v[220:223], v[84:87], v[196:199]
  ds_read_b128 v[216:219], v70 offset:1024
  v_cvt_pk_bf16_f32 v248, v184, v185
  v_mfma_f32_16x16x32_bf16 v[200:203], v[220:223], v[88:91], v[200:203]
  s_add_u32 m0, s81, 31744
  s_nop 0
  buffer_load_dwordx4 v55, s[12:15], s80 offen lds
  v_mfma_f32_16x16x32_bf16 v[204:207], v[220:223], v[92:95], v[204:207]
  v_cvt_pk_bf16_f32 v249, v186, v187
  s_waitcnt lgkmcnt(2)
  v_mfma_f32_16x16x32_bf16 v[196:199], v[208:211], v[96:99], v[196:199]
  ds_read_b128 v[220:223], v71 offset:1024
  v_cvt_pk_bf16_f32 v250, v188, v189
  v_mfma_f32_16x16x32_bf16 v[200:203], v[208:211], v[100:103], v[200:203]
  s_add_u32 m0, s81, 32768
  s_nop 0
  buffer_load_dwordx4 v56, s[12:15], s80 offen lds
  v_mfma_f32_16x16x32_bf16 v[204:207], v[208:211], v[104:107], v[204:207]
  v_cvt_pk_bf16_f32 v251, v190, v191
  s_waitcnt lgkmcnt(2)
  v_mfma_f32_16x16x32_bf16 v[196:199], v[212:215], v[108:111], v[196:199]
  v_accvgpr_write_b32 a52, v248
  v_mfma_f32_16x16x32_bf16 v[200:203], v[212:215], v[112:115], v[200:203]
  s_add_u32 m0, s81, 33792
  s_nop 0
  buffer_load_dwordx4 v57, s[12:15], s80 offen lds
  v_mfma_f32_16x16x32_bf16 v[204:207], v[212:215], v[116:119], v[204:207]
  v_accvgpr_write_b32 a53, v249
  s_waitcnt lgkmcnt(1)
  v_mfma_f32_16x16x32_bf16 v[196:199], v[216:219], v[120:123], v[196:199]
  v_accvgpr_write_b32 a132, v250
  v_mfma_f32_16x16x32_bf16 v[200:203], v[216:219], v[124:127], v[200:203]
  s_add_u32 m0, s81, 34816
  s_nop 0
  buffer_load_dwordx4 v58, s[12:15], s80 offen lds
  v_mfma_f32_16x16x32_bf16 v[204:207], v[216:219], v[128:131], v[204:207]
  v_accvgpr_write_b32 a133, v251
  s_waitcnt lgkmcnt(0)
  v_mfma_f32_16x16x32_bf16 v[196:199], v[220:223], v[132:135], v[196:199]
  v_cvt_pk_bf16_f32 v170, v192, v193
  v_cvt_pk_bf16_f32 v171, v194, v195
  v_mfma_f32_16x16x32_bf16 v[200:203], v[220:223], v[136:139], v[200:203]
  s_add_u32 m0, s81, 35840
  s_nop 0
  buffer_load_dwordx4 v59, s[12:15], s80 offen lds
  s_add_u32 s80, s80, 393216
  v_mfma_f32_16x16x32_bf16 v[204:207], v[220:223], v[140:143], v[204:207]
  s_add_u32 s21, s79, 1179648
  buffer_load_dwordx4 a[232:235], v63, s[24:27], s21 offen
  s_add_u32 s21, s79, 1179648
  buffer_load_dwordx4 a[236:239], v64, s[24:27], s21 offen
  s_add_u32 s21, s79, 1179648
  buffer_load_dwordx4 a[240:243], v65, s[24:27], s21 offen
  s_waitcnt vmcnt(19)
  ds_read_b128 v[208:211], v70 offset:12288
  ds_read_b128 v[212:215], v71 offset:12288
  ds_read_b128 v[216:219], v70 offset:12416
  s_waitcnt lgkmcnt(2)
  v_mfma_f32_16x16x32_bf16 v[184:187], v[208:211], v[72:75], 0
  ds_read_b128 v[220:223], v71 offset:12416
  v_mfma_f32_16x16x32_bf16 v[188:191], v[208:211], v[76:79], 0
  s_add_u32 m0, s81, 0
  s_nop 0
  buffer_load_dwordx4 v48, s[12:15], s80 offen lds
  v_mfma_f32_16x16x32_bf16 v[192:195], v[208:211], v[80:83], 0
  s_waitcnt lgkmcnt(2)
  v_mfma_f32_16x16x32_bf16 v[184:187], v[212:215], v[84:87], v[184:187]
  ds_read_b128 v[208:211], v70 offset:12544
  v_cvt_pk_bf16_f32 v248, v196, v197
  v_mfma_f32_16x16x32_bf16 v[188:191], v[212:215], v[88:91], v[188:191]
  s_add_u32 m0, s81, 1024
  s_nop 0
  buffer_load_dwordx4 v49, s[12:15], s80 offen lds
  v_mfma_f32_16x16x32_bf16 v[192:195], v[212:215], v[92:95], v[192:195]
  v_cvt_pk_bf16_f32 v249, v198, v199
  s_waitcnt lgkmcnt(2)
  v_mfma_f32_16x16x32_bf16 v[184:187], v[216:219], v[96:99], v[184:187]
  ds_read_b128 v[212:215], v71 offset:12544
  v_cvt_pk_bf16_f32 v250, v200, v201
  v_mfma_f32_16x16x32_bf16 v[188:191], v[216:219], v[100:103], v[188:191]
  s_add_u32 m0, s81, 2048
  s_nop 0
  buffer_load_dwordx4 v50, s[12:15], s80 offen lds
  v_mfma_f32_16x16x32_bf16 v[192:195], v[216:219], v[104:107], v[192:195]
  v_cvt_pk_bf16_f32 v251, v202, v203
  s_waitcnt lgkmcnt(2)
  v_mfma_f32_16x16x32_bf16 v[184:187], v[220:223], v[108:111], v[184:187]
  ds_read_b128 v[216:219], v70 offset:13056
  v_accvgpr_write_b32 a54, v248
  v_mfma_f32_16x16x32_bf16 v[188:191], v[220:223], v[112:115], v[188:191]
  s_add_u32 m0, s81, 3072
  s_nop 0
  buffer_load_dwordx4 v51, s[12:15], s80 offen lds
  v_mfma_f32_16x16x32_bf16 v[192:195], v[220:223], v[116:119], v[192:195]
  v_accvgpr_write_b32 a55, v249
  s_waitcnt lgkmcnt(2)
  v_mfma_f32_16x16x32_bf16 v[184:187], v[208:211], v[120:123], v[184:187]
  ds_read_b128 v[220:223], v71 offset:13056
  v_accvgpr_write_b32 a134, v250
  v_mfma_f32_16x16x32_bf16 v[188:191], v[208:211], v[124:127], v[188:191]
  s_add_u32 m0, s81, 4096
  s_nop 0
  buffer_load_dwordx4 v52, s[12:15], s80 offen lds
  v_mfma_f32_16x16x32_bf16 v[192:195], v[208:211], v[128:131], v[192:195]
  v_accvgpr_write_b32 a135, v251
  s_waitcnt lgkmcnt(2)
  v_mfma_f32_16x16x32_bf16 v[184:187], v[212:215], v[132:135], v[184:187]
  ds_read_b128 v[208:211], v70 offset:13184
  s_mov_b64 exec, s[68:69]
  v_cvt_pk_bf16_f32 v170, v204, v205
  v_cvt_pk_bf16_f32 v171, v206, v207
  s_mov_b64 exec, -1
  v_mfma_f32_16x16x32_bf16 v[188:191], v[212:215], v[136:139], v[188:191]
  s_add_u32 m0, s81, 5120
  s_nop 0
  buffer_load_dwordx4 v53, s[12:15], s80 offen lds
  v_mfma_f32_16x16x32_bf16 v[192:195], v[212:215], v[140:143], v[192:195]
  s_waitcnt lgkmcnt(2)
  v_mfma_f32_16x16x32_bf16 v[196:199], v[216:219], v[72:75], 0
  ds_read_b128 v[212:215], v71 offset:13184
  v_mfma_f32_16x16x32_bf16 v[200:203], v[216:219], v[76:79], 0
  s_add_u32 m0, s81, 6144
  s_nop 0
  buffer_load_dwordx4 v54, s[12:15], s80 offen lds
  v_mfma_f32_16x16x32_bf16 v[204:207], v[216:219], v[80:83], 0
  s_waitcnt lgkmcnt(2)
  v_mfma_f32_16x16x32_bf16 v[196:199], v[220:223], v[84:87], v[196:199]
  ds_read_b128 v[216:219], v70 offset:13312
  v_cvt_pk_bf16_f32 v248, v184, v185
  v_mfma_f32_16x16x32_bf16 v[200:203], v[220:223], v[88:91], v[200:203]
  s_add_u32 m0, s81, 7168
  s_nop 0
  buffer_load_dwordx4 v55, s[12:15], s80 offen lds
  v_mfma_f32_16x16x32_bf16 v[204:207], v[220:223], v[92:95], v[204:207]
  v_cvt_pk_bf16_f32 v249, v186, v187
  s_waitcnt lgkmcnt(2)
  v_mfma_f32_16x16x32_bf16 v[196:199], v[208:211], v[96:99], v[196:199]
  ds_read_b128 v[220:223], v71 offset:13312
  v_cvt_pk_bf16_f32 v250, v188, v189
  v_mfma_f32_16x16x32_bf16 v[200:203], v[208:211], v[100:103], v[200:203]
  s_add_u32 m0, s81, 8192
  s_nop 0
  buffer_load_dwordx4 v56, s[12:15], s80 offen lds
  v_mfma_f32_16x16x32_bf16 v[204:207], v[208:211], v[104:107], v[204:207]
  v_cvt_pk_bf16_f32 v251, v190, v191
  s_waitcnt lgkmcnt(2)
  v_mfma_f32_16x16x32_bf16 v[196:199], v[212:215], v[108:111], v[196:199]
  v_accvgpr_write_b32 a56, v248
  v_mfma_f32_16x16x32_bf16 v[200:203], v[212:215], v[112:115], v[200:203]
  s_add_u32 m0, s81, 9216
  s_nop 0
  buffer_load_dwordx4 v57, s[12:15], s80 offen lds
  v_mfma_f32_16x16x32_bf16 v[204:207], v[212:215], v[116:119], v[204:207]
  v_accvgpr_write_b32 a57, v249
  s_waitcnt lgkmcnt(1)
  v_mfma_f32_16x16x32_bf16 v[196:199], v[216:219], v[120:123], v[196:199]
  v_accvgpr_write_b32 a136, v250
  v_mfma_f32_16x16x32_bf16 v[200:203], v[216:219], v[124:127], v[200:203]
  s_add_u32 m0, s81, 10240
  s_nop 0
  buffer_load_dwordx4 v58, s[12:15], s80 offen lds
  v_mfma_f32_16x16x32_bf16 v[204:207], v[216:219], v[128:131], v[204:207]
  v_accvgpr_write_b32 a137, v251
  s_waitcnt lgkmcnt(0)
  v_mfma_f32_16x16x32_bf16 v[196:199], v[220:223], v[132:135], v[196:199]
  v_cvt_pk_bf16_f32 v172, v192, v193
  v_cvt_pk_bf16_f32 v173, v194, v195
  v_mfma_f32_16x16x32_bf16 v[200:203], v[220:223], v[136:139], v[200:203]
  s_add_u32 m0, s81, 11264
  s_nop 0
  buffer_load_dwordx4 v59, s[12:15], s80 offen lds
  s_add_u32 s80, s80, 393216
  v_mfma_f32_16x16x32_bf16 v[204:207], v[220:223], v[140:143], v[204:207]
  s_add_u32 s21, s79, 1572864
  buffer_load_dwordx4 v[224:227], v63, s[24:27], s21 offen
  s_add_u32 s21, s79, 1572864
  buffer_load_dwordx4 v[228:231], v64, s[24:27], s21 offen
  s_add_u32 s21, s79, 1572864
  buffer_load_dwordx4 v[232:235], v65, s[24:27], s21 offen
  s_waitcnt vmcnt(18)
  ds_read_b128 v[208:211], v70 offset:24576
  ds_read_b128 v[212:215], v71 offset:24576
  ds_read_b128 v[216:219], v70 offset:24704
  s_waitcnt lgkmcnt(2)
  v_mfma_f32_16x16x32_bf16 v[184:187], v[208:211], v[72:75], 0
  ds_read_b128 v[220:223], v71 offset:24704
  v_mfma_f32_16x16x32_bf16 v[188:191], v[208:211], v[76:79], 0
  s_add_u32 m0, s81, 12288
  s_nop 0
  buffer_load_dwordx4 v48, s[12:15], s80 offen lds
  v_mfma_f32_16x16x32_bf16 v[192:195], v[208:211], v[80:83], 0
  s_waitcnt lgkmcnt(2)
  v_mfma_f32_16x16x32_bf16 v[184:187], v[212:215], v[84:87], v[184:187]
  ds_read_b128 v[208:211], v70 offset:24832
  v_cvt_pk_bf16_f32 v248, v196, v197
  v_mfma_f32_16x16x32_bf16 v[188:191], v[212:215], v[88:91], v[188:191]
  s_add_u32 m0, s81, 13312
  s_nop 0
  buffer_load_dwordx4 v49, s[12:15], s80 offen lds
  v_mfma_f32_16x16x32_bf16 v[192:195], v[212:215], v[92:95], v[192:195]
  v_cvt_pk_bf16_f32 v249, v198, v199
  s_waitcnt lgkmcnt(2)
  v_mfma_f32_16x16x32_bf16 v[184:187], v[216:219], v[96:99], v[184:187]
  ds_read_b128 v[212:215], v71 offset:24832
  v_cvt_pk_bf16_f32 v250, v200, v201
  v_mfma_f32_16x16x32_bf16 v[188:191], v[216:219], v[100:103], v[188:191]
  s_add_u32 m0, s81, 14336
  s_nop 0
  buffer_load_dwordx4 v50, s[12:15], s80 offen lds
  v_mfma_f32_16x16x32_bf16 v[192:195], v[216:219], v[104:107], v[192:195]
  v_cvt_pk_bf16_f32 v251, v202, v203
  s_waitcnt lgkmcnt(2)
  v_mfma_f32_16x16x32_bf16 v[184:187], v[220:223], v[108:111], v[184:187]
  ds_read_b128 v[216:219], v70 offset:25344
  v_accvgpr_write_b32 a58, v248
  v_mfma_f32_16x16x32_bf16 v[188:191], v[220:223], v[112:115], v[188:191]
  s_add_u32 m0, s81, 15360
  s_nop 0
  buffer_load_dwordx4 v51, s[12:15], s80 offen lds
  v_mfma_f32_16x16x32_bf16 v[192:195], v[220:223], v[116:119], v[192:195]
  v_accvgpr_write_b32 a59, v249
  s_waitcnt lgkmcnt(2)
  v_mfma_f32_16x16x32_bf16 v[184:187], v[208:211], v[120:123], v[184:187]
  ds_read_b128 v[220:223], v71 offset:25344
  v_accvgpr_write_b32 a138, v250
  v_mfma_f32_16x16x32_bf16 v[188:191], v[208:211], v[124:127], v[188:191]
  s_add_u32 m0, s81, 16384
  s_nop 0
  buffer_load_dwordx4 v52, s[12:15], s80 offen lds
  v_mfma_f32_16x16x32_bf16 v[192:195], v[208:211], v[128:131], v[192:195]
  v_accvgpr_write_b32 a139, v251
  s_waitcnt lgkmcnt(2)
  v_mfma_f32_16x16x32_bf16 v[184:187], v[212:215], v[132:135], v[184:187]
  ds_read_b128 v[208:211], v70 offset:25472
  s_mov_b64 exec, s[68:69]
  v_cvt_pk_bf16_f32 v172, v204, v205
  v_cvt_pk_bf16_f32 v173, v206, v207
  s_mov_b64 exec, -1
  v_mfma_f32_16x16x32_bf16 v[188:191], v[212:215], v[136:139], v[188:191]
  s_add_u32 m0, s81, 17408
  s_nop 0
  buffer_load_dwordx4 v53, s[12:15], s80 offen lds
  v_mfma_f32_16x16x32_bf16 v[192:195], v[212:215], v[140:143], v[192:195]
  s_waitcnt lgkmcnt(2)
  v_mfma_f32_16x16x32_bf16 v[196:199], v[216:219], v[72:75], 0
  ds_read_b128 v[212:215], v71 offset:25472
  v_mfma_f32_16x16x32_bf16 v[200:203], v[216:219], v[76:79], 0
  s_add_u32 m0, s81, 18432
  s_nop 0
  buffer_load_dwordx4 v54, s[12:15], s80 offen lds
  v_mfma_f32_16x16x32_bf16 v[204:207], v[216:219], v[80:83], 0
  s_waitcnt lgkmcnt(2)
  v_mfma_f32_16x16x32_bf16 v[196:199], v[220:223], v[84:87], v[196:199]
  ds_read_b128 v[216:219], v70 offset:25600
  v_cvt_pk_bf16_f32 v248, v184, v185
  v_mfma_f32_16x16x32_bf16 v[200:203], v[220:223], v[88:91], v[200:203]
  s_add_u32 m0, s81, 19456
  s_nop 0
  buffer_load_dwordx4 v55, s[12:15], s80 offen lds
  v_mfma_f32_16x16x32_bf16 v[204:207], v[220:223], v[92:95], v[204:207]
  v_cvt_pk_bf16_f32 v249, v186, v187
  s_waitcnt lgkmcnt(2)
  v_mfma_f32_16x16x32_bf16 v[196:199], v[208:211], v[96:99], v[196:199]
  ds_read_b128 v[220:223], v71 offset:25600
  v_cvt_pk_bf16_f32 v250, v188, v189
  v_mfma_f32_16x16x32_bf16 v[200:203], v[208:211], v[100:103], v[200:203]
  s_add_u32 m0, s81, 20480
  s_nop 0
  buffer_load_dwordx4 v56, s[12:15], s80 offen lds
  v_mfma_f32_16x16x32_bf16 v[204:207], v[208:211], v[104:107], v[204:207]
  v_cvt_pk_bf16_f32 v251, v190, v191
  s_waitcnt lgkmcnt(2)
  v_mfma_f32_16x16x32_bf16 v[196:199], v[212:215], v[108:111], v[196:199]
  v_accvgpr_write_b32 a60, v248
  v_mfma_f32_16x16x32_bf16 v[200:203], v[212:215], v[112:115], v[200:203]
  s_add_u32 m0, s81, 21504
  s_nop 0
  buffer_load_dwordx4 v57, s[12:15], s80 offen lds
  v_mfma_f32_16x16x32_bf16 v[204:207], v[212:215], v[116:119], v[204:207]
  v_accvgpr_write_b32 a61, v249
  s_waitcnt lgkmcnt(1)
  v_mfma_f32_16x16x32_bf16 v[196:199], v[216:219], v[120:123], v[196:199]
  v_accvgpr_write_b32 a140, v250
  v_mfma_f32_16x16x32_bf16 v[200:203], v[216:219], v[124:127], v[200:203]
  s_add_u32 m0, s81, 22528
  s_nop 0
  buffer_load_dwordx4 v58, s[12:15], s80 offen lds
  v_mfma_f32_16x16x32_bf16 v[204:207], v[216:219], v[128:131], v[204:207]
  v_accvgpr_write_b32 a141, v251
  s_waitcnt lgkmcnt(0)
  v_mfma_f32_16x16x32_bf16 v[196:199], v[220:223], v[132:135], v[196:199]
  v_cvt_pk_bf16_f32 v174, v192, v193
  v_cvt_pk_bf16_f32 v175, v194, v195
  v_mfma_f32_16x16x32_bf16 v[200:203], v[220:223], v[136:139], v[200:203]
  s_add_u32 m0, s81, 23552
  s_nop 0
  buffer_load_dwordx4 v59, s[12:15], s80 offen lds
  s_add_u32 s80, s80, 393216
  v_mfma_f32_16x16x32_bf16 v[204:207], v[220:223], v[140:143], v[204:207]
  s_waitcnt vmcnt(15)
  s_and_b32 s21, s50, 1
  s_lshl_b32 s21, s21, 4
  s_add_u32 s21, s21, s51
  s_lshl_b32 s22, s21, 10
  s_add_u32 s22, s22, s77
  s_add_u32 s23, s77, 30720
  s_cmp_lt_u32 s21, 10
  s_cselect_b32 s23, 0, s23
  s_add_u32 s22, s22, s23
  s_mul_i32 s23, s20, 122880
  s_add_u32 s22, s22, s23
  buffer_load_dwordx4 v[252:255], v4, s[8:11], s22 offen sc1
  ds_read_b128 v[208:211], v70 offset:0
  ds_read_b128 v[212:215], v71 offset:0
  ds_read_b128 v[216:219], v70 offset:128
  s_waitcnt lgkmcnt(2)
  v_mfma_f32_16x16x32_bf16 v[184:187], v[208:211], v[72:75], 0
  ds_read_b128 v[220:223], v71 offset:128
  v_mfma_f32_16x16x32_bf16 v[188:191], v[208:211], v[76:79], 0
  s_add_u32 m0, s81, 24576
  s_nop 0
  buffer_load_dwordx4 v48, s[12:15], s80 offen lds
  v_mfma_f32_16x16x32_bf16 v[192:195], v[208:211], v[80:83], 0
  s_waitcnt lgkmcnt(2)
  v_mfma_f32_16x16x32_bf16 v[184:187], v[212:215], v[84:87], v[184:187]
  ds_read_b128 v[208:211], v70 offset:256
  v_cvt_pk_bf16_f32 v248, v196, v197
  v_mfma_f32_16x16x32_bf16 v[188:191], v[212:215], v[88:91], v[188:191]
  s_add_u32 m0, s81, 25600
  s_nop 0
  buffer_load_dwordx4 v49, s[12:15], s80 offen lds
  v_mfma_f32_16x16x32_bf16 v[192:195], v[212:215], v[92:95], v[192:195]
  v_cvt_pk_bf16_f32 v249, v198, v199
  s_waitcnt lgkmcnt(2)
  v_mfma_f32_16x16x32_bf16 v[184:187], v[216:219], v[96:99], v[184:187]
  ds_read_b128 v[212:215], v71 offset:256
  v_cvt_pk_bf16_f32 v250, v200, v201
  v_mfma_f32_16x16x32_bf16 v[188:191], v[216:219], v[100:103], v[188:191]
  s_add_u32 m0, s81, 26624
  s_nop 0
  buffer_load_dwordx4 v50, s[12:15], s80 offen lds
  v_mfma_f32_16x16x32_bf16 v[192:195], v[216:219], v[104:107], v[192:195]
  v_cvt_pk_bf16_f32 v251, v202, v203
  s_waitcnt lgkmcnt(2)
  v_mfma_f32_16x16x32_bf16 v[184:187], v[220:223], v[108:111], v[184:187]
  ds_read_b128 v[216:219], v70 offset:768
  v_accvgpr_write_b32 a62, v248
  v_mfma_f32_16x16x32_bf16 v[188:191], v[220:223], v[112:115], v[188:191]
  s_add_u32 m0, s81, 27648
  s_nop 0
  buffer_load_dwordx4 v51, s[12:15], s80 offen lds
  v_mfma_f32_16x16x32_bf16 v[192:195], v[220:223], v[116:119], v[192:195]
  v_accvgpr_write_b32 a63, v249
  s_waitcnt lgkmcnt(2)
  v_mfma_f32_16x16x32_bf16 v[184:187], v[208:211], v[120:123], v[184:187]
  ds_read_b128 v[220:223], v71 offset:768
  v_accvgpr_write_b32 a142, v250
  v_mfma_f32_16x16x32_bf16 v[188:191], v[208:211], v[124:127], v[188:191]
  s_add_u32 m0, s81, 28672
  s_nop 0
  buffer_load_dwordx4 v52, s[12:15], s80 offen lds
  v_mfma_f32_16x16x32_bf16 v[192:195], v[208:211], v[128:131], v[192:195]
  v_accvgpr_write_b32 a143, v251
  s_waitcnt lgkmcnt(2)
  v_mfma_f32_16x16x32_bf16 v[184:187], v[212:215], v[132:135], v[184:187]
  ds_read_b128 v[208:211], v70 offset:896
  s_mov_b64 exec, s[68:69]
  v_cvt_pk_bf16_f32 v174, v204, v205
  v_cvt_pk_bf16_f32 v175, v206, v207
  s_mov_b64 exec, -1
  v_mfma_f32_16x16x32_bf16 v[188:191], v[212:215], v[136:139], v[188:191]
  s_add_u32 m0, s81, 29696
  s_nop 0
  buffer_load_dwordx4 v53, s[12:15], s80 offen lds
  v_mfma_f32_16x16x32_bf16 v[192:195], v[212:215], v[140:143], v[192:195]
  s_waitcnt lgkmcnt(2)
  v_mfma_f32_16x16x32_bf16 v[196:199], v[216:219], v[72:75], 0
  ds_read_b128 v[212:215], v71 offset:896
  v_mfma_f32_16x16x32_bf16 v[200:203], v[216:219], v[76:79], 0
  s_add_u32 m0, s81, 30720
  s_nop 0
  buffer_load_dwordx4 v54, s[12:15], s80 offen lds
  v_mfma_f32_16x16x32_bf16 v[204:207], v[216:219], v[80:83], 0
  s_waitcnt lgkmcnt(2)
  v_mfma_f32_16x16x32_bf16 v[196:199], v[220:223], v[84:87], v[196:199]
  ds_read_b128 v[216:219], v70 offset:1024
  v_cvt_pk_bf16_f32 v248, v184, v185
  v_mfma_f32_16x16x32_bf16 v[200:203], v[220:223], v[88:91], v[200:203]
  s_add_u32 m0, s81, 31744
  s_nop 0
  buffer_load_dwordx4 v55, s[12:15], s80 offen lds
  v_mfma_f32_16x16x32_bf16 v[204:207], v[220:223], v[92:95], v[204:207]
  v_cvt_pk_bf16_f32 v249, v186, v187
  s_waitcnt lgkmcnt(2)
  v_mfma_f32_16x16x32_bf16 v[196:199], v[208:211], v[96:99], v[196:199]
  ds_read_b128 v[220:223], v71 offset:1024
  v_cvt_pk_bf16_f32 v250, v188, v189
  v_mfma_f32_16x16x32_bf16 v[200:203], v[208:211], v[100:103], v[200:203]
  s_add_u32 m0, s81, 32768
  s_nop 0
  buffer_load_dwordx4 v56, s[12:15], s80 offen lds
  v_mfma_f32_16x16x32_bf16 v[204:207], v[208:211], v[104:107], v[204:207]
  v_cvt_pk_bf16_f32 v251, v190, v191
  s_waitcnt lgkmcnt(2)
  v_mfma_f32_16x16x32_bf16 v[196:199], v[212:215], v[108:111], v[196:199]
  v_accvgpr_write_b32 a64, v248
  v_mfma_f32_16x16x32_bf16 v[200:203], v[212:215], v[112:115], v[200:203]
  s_add_u32 m0, s81, 33792
  s_nop 0
  buffer_load_dwordx4 v57, s[12:15], s80 offen lds
  v_mfma_f32_16x16x32_bf16 v[204:207], v[212:215], v[116:119], v[204:207]
  v_accvgpr_write_b32 a65, v249
  s_waitcnt lgkmcnt(1)
  v_mfma_f32_16x16x32_bf16 v[196:199], v[216:219], v[120:123], v[196:199]
  v_accvgpr_write_b32 a144, v250
  v_mfma_f32_16x16x32_bf16 v[200:203], v[216:219], v[124:127], v[200:203]
  s_add_u32 m0, s81, 34816
  s_nop 0
  buffer_load_dwordx4 v58, s[12:15], s80 offen lds
  v_mfma_f32_16x16x32_bf16 v[204:207], v[216:219], v[128:131], v[204:207]
  v_accvgpr_write_b32 a145, v251
  s_waitcnt lgkmcnt(0)
  v_mfma_f32_16x16x32_bf16 v[196:199], v[220:223], v[132:135], v[196:199]
  v_cvt_pk_bf16_f32 v176, v192, v193
  v_cvt_pk_bf16_f32 v177, v194, v195
  v_mfma_f32_16x16x32_bf16 v[200:203], v[220:223], v[136:139], v[200:203]
  s_add_u32 m0, s81, 35840
  s_nop 0
  buffer_load_dwordx4 v59, s[12:15], s80 offen lds
  s_add_u32 s80, s80, 393216
  v_mfma_f32_16x16x32_bf16 v[204:207], v[220:223], v[140:143], v[204:207]
  s_waitcnt vmcnt(13)
  ds_read_b128 v[208:211], v70 offset:12288
  ds_read_b128 v[212:215], v71 offset:12288
  ds_read_b128 v[216:219], v70 offset:12416
  s_waitcnt lgkmcnt(2)
  v_mfma_f32_16x16x32_bf16 v[184:187], v[208:211], v[72:75], 0
  ds_read_b128 v[220:223], v71 offset:12416
  v_mfma_f32_16x16x32_bf16 v[188:191], v[208:211], v[76:79], 0
  s_add_u32 m0, s81, 0
  s_nop 0
  buffer_load_dwordx4 v48, s[12:15], s80 offen lds
  v_mfma_f32_16x16x32_bf16 v[192:195], v[208:211], v[80:83], 0
  s_waitcnt lgkmcnt(2)
  v_mfma_f32_16x16x32_bf16 v[184:187], v[212:215], v[84:87], v[184:187]
  ds_read_b128 v[208:211], v70 offset:12544
  v_cvt_pk_bf16_f32 v248, v196, v197
  v_mfma_f32_16x16x32_bf16 v[188:191], v[212:215], v[88:91], v[188:191]
  s_add_u32 m0, s81, 1024
  s_nop 0
  buffer_load_dwordx4 v49, s[12:15], s80 offen lds
  v_mfma_f32_16x16x32_bf16 v[192:195], v[212:215], v[92:95], v[192:195]
  v_cvt_pk_bf16_f32 v249, v198, v199
  s_waitcnt lgkmcnt(2)
  v_mfma_f32_16x16x32_bf16 v[184:187], v[216:219], v[96:99], v[184:187]
  ds_read_b128 v[212:215], v71 offset:12544
  v_cvt_pk_bf16_f32 v250, v200, v201
  v_mfma_f32_16x16x32_bf16 v[188:191], v[216:219], v[100:103], v[188:191]
  s_add_u32 m0, s81, 2048
  s_nop 0
  buffer_load_dwordx4 v50, s[12:15], s80 offen lds
  v_mfma_f32_16x16x32_bf16 v[192:195], v[216:219], v[104:107], v[192:195]
  v_cvt_pk_bf16_f32 v251, v202, v203
  s_waitcnt lgkmcnt(2)
  v_mfma_f32_16x16x32_bf16 v[184:187], v[220:223], v[108:111], v[184:187]
  ds_read_b128 v[216:219], v70 offset:13056
  v_accvgpr_write_b32 a66, v248
  v_mfma_f32_16x16x32_bf16 v[188:191], v[220:223], v[112:115], v[188:191]
  s_add_u32 m0, s81, 3072
  s_nop 0
  buffer_load_dwordx4 v51, s[12:15], s80 offen lds
  v_mfma_f32_16x16x32_bf16 v[192:195], v[220:223], v[116:119], v[192:195]
  v_accvgpr_write_b32 a67, v249
  s_waitcnt lgkmcnt(2)
  v_mfma_f32_16x16x32_bf16 v[184:187], v[208:211], v[120:123], v[184:187]
  ds_read_b128 v[220:223], v71 offset:13056
  v_accvgpr_write_b32 a146, v250
  v_mfma_f32_16x16x32_bf16 v[188:191], v[208:211], v[124:127], v[188:191]
  s_add_u32 m0, s81, 4096
  s_nop 0
  buffer_load_dwordx4 v52, s[12:15], s80 offen lds
  v_mfma_f32_16x16x32_bf16 v[192:195], v[208:211], v[128:131], v[192:195]
  v_accvgpr_write_b32 a147, v251
  s_waitcnt lgkmcnt(2)
  v_mfma_f32_16x16x32_bf16 v[184:187], v[212:215], v[132:135], v[184:187]
  ds_read_b128 v[208:211], v70 offset:13184
  s_mov_b64 exec, s[68:69]
  v_cvt_pk_bf16_f32 v176, v204, v205
  v_cvt_pk_bf16_f32 v177, v206, v207
  s_mov_b64 exec, -1
  v_mfma_f32_16x16x32_bf16 v[188:191], v[212:215], v[136:139], v[188:191]
  s_add_u32 m0, s81, 5120
  s_nop 0
  buffer_load_dwordx4 v53, s[12:15], s80 offen lds
  v_mfma_f32_16x16x32_bf16 v[192:195], v[212:215], v[140:143], v[192:195]
  s_waitcnt lgkmcnt(2)
  v_mfma_f32_16x16x32_bf16 v[196:199], v[216:219], v[72:75], 0
  ds_read_b128 v[212:215], v71 offset:13184
  v_mfma_f32_16x16x32_bf16 v[200:203], v[216:219], v[76:79], 0
  s_add_u32 m0, s81, 6144
  s_nop 0
  buffer_load_dwordx4 v54, s[12:15], s80 offen lds
  v_mfma_f32_16x16x32_bf16 v[204:207], v[216:219], v[80:83], 0
  s_waitcnt lgkmcnt(2)
  v_mfma_f32_16x16x32_bf16 v[196:199], v[220:223], v[84:87], v[196:199]
  ds_read_b128 v[216:219], v70 offset:13312
  v_cvt_pk_bf16_f32 v248, v184, v185
  v_mfma_f32_16x16x32_bf16 v[200:203], v[220:223], v[88:91], v[200:203]
  s_add_u32 m0, s81, 7168
  s_nop 0
  buffer_load_dwordx4 v55, s[12:15], s80 offen lds
  v_mfma_f32_16x16x32_bf16 v[204:207], v[220:223], v[92:95], v[204:207]
  v_cvt_pk_bf16_f32 v249, v186, v187
  s_waitcnt lgkmcnt(2)
  v_mfma_f32_16x16x32_bf16 v[196:199], v[208:211], v[96:99], v[196:199]
  ds_read_b128 v[220:223], v71 offset:13312
  v_cvt_pk_bf16_f32 v250, v188, v189
  v_mfma_f32_16x16x32_bf16 v[200:203], v[208:211], v[100:103], v[200:203]
  s_add_u32 m0, s81, 8192
  s_nop 0
  buffer_load_dwordx4 v56, s[12:15], s80 offen lds
  v_mfma_f32_16x16x32_bf16 v[204:207], v[208:211], v[104:107], v[204:207]
  v_cvt_pk_bf16_f32 v251, v190, v191
  s_waitcnt lgkmcnt(2)
  v_mfma_f32_16x16x32_bf16 v[196:199], v[212:215], v[108:111], v[196:199]
  v_accvgpr_write_b32 a68, v248
  v_mfma_f32_16x16x32_bf16 v[200:203], v[212:215], v[112:115], v[200:203]
  s_add_u32 m0, s81, 9216
  s_nop 0
  buffer_load_dwordx4 v57, s[12:15], s80 offen lds
  v_mfma_f32_16x16x32_bf16 v[204:207], v[212:215], v[116:119], v[204:207]
  v_accvgpr_write_b32 a69, v249
  s_waitcnt lgkmcnt(1)
  v_mfma_f32_16x16x32_bf16 v[196:199], v[216:219], v[120:123], v[196:199]
  v_accvgpr_write_b32 a148, v250
  v_mfma_f32_16x16x32_bf16 v[200:203], v[216:219], v[124:127], v[200:203]
  s_add_u32 m0, s81, 10240
  s_nop 0
  buffer_load_dwordx4 v58, s[12:15], s80 offen lds
  v_mfma_f32_16x16x32_bf16 v[204:207], v[216:219], v[128:131], v[204:207]
  v_accvgpr_write_b32 a149, v251
  s_waitcnt lgkmcnt(0)
  v_mfma_f32_16x16x32_bf16 v[196:199], v[220:223], v[132:135], v[196:199]
  v_cvt_pk_bf16_f32 v178, v192, v193
  v_cvt_pk_bf16_f32 v179, v194, v195
  v_mfma_f32_16x16x32_bf16 v[200:203], v[220:223], v[136:139], v[200:203]
  s_add_u32 m0, s81, 11264
  s_nop 0
  buffer_load_dwordx4 v59, s[12:15], s80 offen lds
  s_add_u32 s80, s80, 393216
  v_mfma_f32_16x16x32_bf16 v[204:207], v[220:223], v[140:143], v[204:207]
  s_waitcnt vmcnt(12)
  v_readlane_b32 s83, v66, 19
  s_sub_u32 s21, s83, 1
  s_lshl_b32 s21, s21, 13
  s_and_b32 s21, s21, 8192
  s_xor_b32 s76, s90, s21
  buffer_load_dword v66, v67, s[32:35], 0 offen sc1
  buffer_load_dword v42, v41, s[16:19], s76 offen sc1
  ds_read_b128 v[208:211], v70 offset:24576
  ds_read_b128 v[212:215], v71 offset:24576
  ds_read_b128 v[216:219], v70 offset:24704
  s_waitcnt lgkmcnt(2)
  v_mfma_f32_16x16x32_bf16 v[184:187], v[208:211], v[72:75], 0
  ds_read_b128 v[220:223], v71 offset:24704
  v_mfma_f32_16x16x32_bf16 v[188:191], v[208:211], v[76:79], 0
  ds_write_b128 v68, a[160:163] offset:12288
  v_mfma_f32_16x16x32_bf16 v[192:195], v[208:211], v[80:83], 0
  s_waitcnt lgkmcnt(3)
  v_mfma_f32_16x16x32_bf16 v[184:187], v[212:215], v[84:87], v[184:187]
  ds_read_b128 v[208:211], v70 offset:24832
  v_cvt_pk_bf16_f32 v248, v196, v197
  v_mfma_f32_16x16x32_bf16 v[188:191], v[212:215], v[88:91], v[188:191]
  ds_write_b128 v68, a[164:167] offset:13312
  v_mfma_f32_16x16x32_bf16 v[192:195], v[212:215], v[92:95], v[192:195]
  v_cvt_pk_bf16_f32 v249, v198, v199
  s_waitcnt lgkmcnt(4)
  v_mfma_f32_16x16x32_bf16 v[184:187], v[216:219], v[96:99], v[184:187]
  ds_read_b128 v[212:215], v71 offset:24832
  v_cvt_pk_bf16_f32 v250, v200, v201
  v_mfma_f32_16x16x32_bf16 v[188:191], v[216:219], v[100:103], v[188:191]
  ds_write_b128 v68, a[168:171] offset:14336
  v_mfma_f32_16x16x32_bf16 v[192:195], v[216:219], v[104:107], v[192:195]
  v_cvt_pk_bf16_f32 v251, v202, v203
  s_waitcnt lgkmcnt(5)
  v_mfma_f32_16x16x32_bf16 v[184:187], v[220:223], v[108:111], v[184:187]
  ds_read_b128 v[216:219], v70 offset:25344
  v_accvgpr_write_b32 a70, v248
  v_mfma_f32_16x16x32_bf16 v[188:191], v[220:223], v[112:115], v[188:191]
  ds_write_b128 v68, a[172:175] offset:15360
  v_mfma_f32_16x16x32_bf16 v[192:195], v[220:223], v[116:119], v[192:195]
  v_accvgpr_write_b32 a71, v249
  s_waitcnt lgkmcnt(5)
  v_mfma_f32_16x16x32_bf16 v[184:187], v[208:211], v[120:123], v[184:187]
  ds_read_b128 v[220:223], v71 offset:25344
  v_accvgpr_write_b32 a150, v250
  v_mfma_f32_16x16x32_bf16 v[188:191], v[208:211], v[124:127], v[188:191]
  ds_write_b128 v68, a[176:179] offset:16384
  v_mfma_f32_16x16x32_bf16 v[192:195], v[208:211], v[128:131], v[192:195]
  v_accvgpr_write_b32 a151, v251
  s_waitcnt lgkmcnt(5)
  v_mfma_f32_16x16x32_bf16 v[184:187], v[212:215], v[132:135], v[184:187]
  ds_read_b128 v[208:211], v70 offset:25472
  s_mov_b64 exec, s[68:69]
  v_cvt_pk_bf16_f32 v178, v204, v205
  v_cvt_pk_bf16_f32 v179, v206, v207
  s_mov_b64 exec, -1
  v_mfma_f32_16x16x32_bf16 v[188:191], v[212:215], v[136:139], v[188:191]
  ds_write_b128 v68, a[180:183] offset:17408
  v_mfma_f32_16x16x32_bf16 v[192:195], v[212:215], v[140:143], v[192:195]
  s_waitcnt lgkmcnt(5)
  v_mfma_f32_16x16x32_bf16 v[196:199], v[216:219], v[72:75], 0
  ds_read_b128 v[212:215], v71 offset:25472
  v_mfma_f32_16x16x32_bf16 v[200:203], v[216:219], v[76:79], 0
  ds_write_b128 v68, a[184:187] offset:18432
  v_mfma_f32_16x16x32_bf16 v[204:207], v[216:219], v[80:83], 0
  s_waitcnt lgkmcnt(5)
  v_mfma_f32_16x16x32_bf16 v[196:199], v[220:223], v[84:87], v[196:199]
  ds_read_b128 v[216:219], v70 offset:25600
  v_cvt_pk_bf16_f32 v248, v184, v185
  v_mfma_f32_16x16x32_bf16 v[200:203], v[220:223], v[88:91], v[200:203]
  ds_write_b128 v68, a[188:191] offset:19456
  v_mfma_f32_16x16x32_bf16 v[204:207], v[220:223], v[92:95], v[204:207]
  v_cvt_pk_bf16_f32 v249, v186, v187
  s_waitcnt lgkmcnt(5)
  v_mfma_f32_16x16x32_bf16 v[196:199], v[208:211], v[96:99], v[196:199]
  ds_read_b128 v[220:223], v71 offset:25600
  v_cvt_pk_bf16_f32 v250, v188, v189
  v_mfma_f32_16x16x32_bf16 v[200:203], v[208:211], v[100:103], v[200:203]
  ds_write_b128 v68, a[192:195] offset:20480
  v_mfma_f32_16x16x32_bf16 v[204:207], v[208:211], v[104:107], v[204:207]
  v_cvt_pk_bf16_f32 v251, v190, v191
  s_waitcnt lgkmcnt(5)
  v_mfma_f32_16x16x32_bf16 v[196:199], v[212:215], v[108:111], v[196:199]
  v_accvgpr_write_b32 a72, v248
  v_mfma_f32_16x16x32_bf16 v[200:203], v[212:215], v[112:115], v[200:203]
  ds_write_b128 v68, a[196:199] offset:21504
  v_mfma_f32_16x16x32_bf16 v[204:207], v[212:215], v[116:119], v[204:207]
  v_accvgpr_write_b32 a73, v249
  s_waitcnt lgkmcnt(4)
  v_mfma_f32_16x16x32_bf16 v[196:199], v[216:219], v[120:123], v[196:199]
  v_accvgpr_write_b32 a152, v250
  v_mfma_f32_16x16x32_bf16 v[200:203], v[216:219], v[124:127], v[200:203]
  ds_write_b128 v68, a[200:203] offset:22528
  v_mfma_f32_16x16x32_bf16 v[204:207], v[216:219], v[128:131], v[204:207]
  v_accvgpr_write_b32 a153, v251
  s_waitcnt lgkmcnt(3)
  v_mfma_f32_16x16x32_bf16 v[196:199], v[220:223], v[132:135], v[196:199]
  v_cvt_pk_bf16_f32 v180, v192, v193
  v_cvt_pk_bf16_f32 v181, v194, v195
  v_mfma_f32_16x16x32_bf16 v[200:203], v[220:223], v[136:139], v[200:203]
  ds_write_b128 v68, a[204:207] offset:23552
  v_mfma_f32_16x16x32_bf16 v[204:207], v[220:223], v[140:143], v[204:207]
  s_waitcnt vmcnt(2)
  ds_read_b128 v[208:211], v70 offset:0
  ds_read_b128 v[212:215], v71 offset:0
  ds_read_b128 v[216:219], v70 offset:128
  s_waitcnt lgkmcnt(2)
  v_mfma_f32_16x16x32_bf16 v[184:187], v[208:211], v[72:75], 0
  ds_read_b128 v[220:223], v71 offset:128
  v_mfma_f32_16x16x32_bf16 v[188:191], v[208:211], v[76:79], 0
  ds_write_b128 v68, a[208:211] offset:24576
  v_mfma_f32_16x16x32_bf16 v[192:195], v[208:211], v[80:83], 0
  s_waitcnt lgkmcnt(3)
  v_mfma_f32_16x16x32_bf16 v[184:187], v[212:215], v[84:87], v[184:187]
  ds_read_b128 v[208:211], v70 offset:256
  v_cvt_pk_bf16_f32 v248, v196, v197
  v_mfma_f32_16x16x32_bf16 v[188:191], v[212:215], v[88:91], v[188:191]
  ds_write_b128 v68, a[212:215] offset:25600
  v_mfma_f32_16x16x32_bf16 v[192:195], v[212:215], v[92:95], v[192:195]
  v_cvt_pk_bf16_f32 v249, v198, v199
  s_waitcnt lgkmcnt(4)
  v_mfma_f32_16x16x32_bf16 v[184:187], v[216:219], v[96:99], v[184:187]
  ds_read_b128 v[212:215], v71 offset:256
  v_cvt_pk_bf16_f32 v250, v200, v201
  v_mfma_f32_16x16x32_bf16 v[188:191], v[216:219], v[100:103], v[188:191]
  ds_write_b128 v68, a[216:219] offset:26624
  v_mfma_f32_16x16x32_bf16 v[192:195], v[216:219], v[104:107], v[192:195]
  v_cvt_pk_bf16_f32 v251, v202, v203
  s_waitcnt lgkmcnt(5)
  v_mfma_f32_16x16x32_bf16 v[184:187], v[220:223], v[108:111], v[184:187]
  ds_read_b128 v[216:219], v70 offset:768
  v_accvgpr_write_b32 a74, v248
  v_mfma_f32_16x16x32_bf16 v[188:191], v[220:223], v[112:115], v[188:191]
  ds_write_b128 v68, a[220:223] offset:27648
  v_mfma_f32_16x16x32_bf16 v[192:195], v[220:223], v[116:119], v[192:195]
  v_accvgpr_write_b32 a75, v249
  s_waitcnt lgkmcnt(5)
  v_mfma_f32_16x16x32_bf16 v[184:187], v[208:211], v[120:123], v[184:187]
  ds_read_b128 v[220:223], v71 offset:768
  v_accvgpr_write_b32 a154, v250
  v_mfma_f32_16x16x32_bf16 v[188:191], v[208:211], v[124:127], v[188:191]
  ds_write_b128 v68, a[224:227] offset:28672
  v_mfma_f32_16x16x32_bf16 v[192:195], v[208:211], v[128:131], v[192:195]
  v_accvgpr_write_b32 a155, v251
  s_waitcnt lgkmcnt(5)
  v_mfma_f32_16x16x32_bf16 v[184:187], v[212:215], v[132:135], v[184:187]
  ds_read_b128 v[208:211], v70 offset:896
  s_mov_b64 exec, s[68:69]
  v_cvt_pk_bf16_f32 v180, v204, v205
  v_cvt_pk_bf16_f32 v181, v206, v207
  s_mov_b64 exec, -1
  v_mfma_f32_16x16x32_bf16 v[188:191], v[212:215], v[136:139], v[188:191]
  ds_write_b128 v68, a[228:231] offset:29696
  v_mfma_f32_16x16x32_bf16 v[192:195], v[212:215], v[140:143], v[192:195]
  s_waitcnt lgkmcnt(5)
  v_mfma_f32_16x16x32_bf16 v[196:199], v[216:219], v[72:75], 0
  ds_read_b128 v[212:215], v71 offset:896
  v_mfma_f32_16x16x32_bf16 v[200:203], v[216:219], v[76:79], 0
  ds_write_b128 v68, a[232:235] offset:30720
  v_mfma_f32_16x16x32_bf16 v[204:207], v[216:219], v[80:83], 0
  s_waitcnt lgkmcnt(5)
  v_mfma_f32_16x16x32_bf16 v[196:199], v[220:223], v[84:87], v[196:199]
  ds_read_b128 v[216:219], v70 offset:1024
  v_cvt_pk_bf16_f32 v248, v184, v185
  v_mfma_f32_16x16x32_bf16 v[200:203], v[220:223], v[88:91], v[200:203]
  ds_write_b128 v68, a[236:239] offset:31744
  v_mfma_f32_16x16x32_bf16 v[204:207], v[220:223], v[92:95], v[204:207]
  v_cvt_pk_bf16_f32 v249, v186, v187
  s_waitcnt lgkmcnt(5)
  v_mfma_f32_16x16x32_bf16 v[196:199], v[208:211], v[96:99], v[196:199]
  ds_read_b128 v[220:223], v71 offset:1024
  v_cvt_pk_bf16_f32 v250, v188, v189
  v_mfma_f32_16x16x32_bf16 v[200:203], v[208:211], v[100:103], v[200:203]
  ds_write_b128 v68, a[240:243] offset:32768
  v_mfma_f32_16x16x32_bf16 v[204:207], v[208:211], v[104:107], v[204:207]
  v_cvt_pk_bf16_f32 v251, v190, v191
  s_waitcnt lgkmcnt(5)
  v_mfma_f32_16x16x32_bf16 v[196:199], v[212:215], v[108:111], v[196:199]
  v_accvgpr_write_b32 a76, v248
  v_mfma_f32_16x16x32_bf16 v[200:203], v[212:215], v[112:115], v[200:203]
  ds_write_b128 v68, a[244:247] offset:33792
  v_mfma_f32_16x16x32_bf16 v[204:207], v[212:215], v[116:119], v[204:207]
  v_accvgpr_write_b32 a77, v249
  s_waitcnt lgkmcnt(4)
  v_mfma_f32_16x16x32_bf16 v[196:199], v[216:219], v[120:123], v[196:199]
  v_accvgpr_write_b32 a156, v250
  v_mfma_f32_16x16x32_bf16 v[200:203], v[216:219], v[124:127], v[200:203]
  ds_write_b128 v68, a[248:251] offset:34816
  v_mfma_f32_16x16x32_bf16 v[204:207], v[216:219], v[128:131], v[204:207]
  v_accvgpr_write_b32 a157, v251
  s_waitcnt lgkmcnt(3)
  v_mfma_f32_16x16x32_bf16 v[196:199], v[220:223], v[132:135], v[196:199]
  v_cvt_pk_bf16_f32 v182, v192, v193
  v_cvt_pk_bf16_f32 v183, v194, v195
  v_mfma_f32_16x16x32_bf16 v[200:203], v[220:223], v[136:139], v[200:203]
  ds_write_b128 v68, a[252:255] offset:35840
  v_mfma_f32_16x16x32_bf16 v[204:207], v[220:223], v[140:143], v[204:207]
  s_nop 7
  v_cvt_pk_bf16_f32 v248, v196, v197
  v_cvt_pk_bf16_f32 v249, v198, v199
  v_cvt_pk_bf16_f32 v250, v200, v201
  v_cvt_pk_bf16_f32 v251, v202, v203
  v_accvgpr_write_b32 a78, v248
  v_accvgpr_write_b32 a79, v249
  v_accvgpr_write_b32 a158, v250
  v_accvgpr_write_b32 a159, v251
  s_mov_b64 exec, s[68:69]
  v_cvt_pk_bf16_f32 v182, v204, v205
  v_cvt_pk_bf16_f32 v183, v206, v207
  s_mov_b64 exec, -1
  ds_write_b128 v68, v[224:227] offset:0
  ds_write_b128 v68, v[228:231] offset:1024
  ds_write_b128 v68, v[232:235] offset:2048
  ds_write_b128 v68, v[236:239] offset:3072
  ds_write_b128 v68, v[240:243] offset:4096
  ds_write_b128 v68, v[244:247] offset:5120
  ds_write_b64 v69, v[160:161] offset:6144
  ds_write_b64 v69, v[162:163] offset:6656
  ds_write_b64 v69, v[164:165] offset:7168
  ds_write_b64 v69, v[166:167] offset:7680
  ds_write_b64 v69, v[168:169] offset:8192
  ds_write_b64 v69, v[170:171] offset:8704
  ds_write_b64 v69, v[172:173] offset:9216
  ds_write_b64 v69, v[174:175] offset:9728
  ds_write_b64 v69, v[176:177] offset:10240
  ds_write_b64 v69, v[178:179] offset:10752
  ds_write_b64 v69, v[180:181] offset:11264
  ds_write_b64 v69, v[182:183] offset:11776
  v_lshrrev_b32 v100, 1, v3
  v_lshlrev_b32 v100, 4, v100
  v_and_b32 v101, 8, v2
  v_add_u32 v100, v100, v101
  v_and_b32 v101, 1, v3
  v_lshl_add_u32 v100, v101, 2, v100
  v_bfe_u32 v101, v2, 2, 1
  v_add_u32 v100, v100, v101
  v_mul_u32_u24 v100, 96, v100
  v_and_b32 v101, 3, v2
  v_lshl_add_u32 v100, v101, 3, v100
  s_lshl_b32 s21, s20, 5
  v_add_u32 v100, s21, v100
  v_add_u32 v101, 3072, v100
  v_cndmask_b32 v88, v100, v101, s[68:69]
  v_cndmask_b32 v92, v101, v100, s[68:69]
  v_add_u32 v89, 40960, v88
  v_add_u32 v93, 40960, v92
  v_add_u32 v90, 81920, v88
  v_add_u32 v94, 81920, v92
  v_add_u32 v91, 122880, v88
  v_add_u32 v95, 122880, v92
  v_and_b32 v100, 7, v2
  v_lshl_add_u32 v100, v3, 3, v100
  v_lshrrev_b32 v101, 3, v2
  v_mul_u32_u24 v101, 40960, v101
  v_lshl_add_u32 v96, v100, 4, v101
  v_add_u32 v97, 81920, v96
  s_bfe_u32 s82, s50, 0x10001
  s_lshl_b32 s82, s82, 5
  s_lshr_b32 s21, s50, 2
  s_add_u32 s82, s82, s21
  s_mov_b32 s101, 0
  s_branch fm_13
fm_12:
  s_sleep 8
fm_14:
  buffer_load_dword v66, v67, s[32:35], 0 offen sc1
  buffer_load_dword v42, v41, s[16:19], s76 offen sc1
  s_add_u32 s101, s101, 1
  s_cmp_gt_u32 s101, 131072
  s_cbranch_scc1 end0
fm_13:
  s_waitcnt vmcnt(0)
  s_mov_b32 s84, s83
  v_readlane_b32 s83, v66, 19
  s_sub_u32 s21, s83, 1
  s_lshl_b32 s21, s21, 13
  s_and_b32 s21, s21, 8192
  s_xor_b32 s76, s90, s21
  s_cmp_eq_u32 s83, 0
  s_cbranch_scc1 fm_12
  s_cmp_eq_u32 s84, 0
  s_cbranch_scc1 fm_14
  v_readlane_b32 s22, v66, 0
  v_readlane_b32 s23, v66, 32
  s_add_u32 s22, s22, s23
  v_readlane_b32 s23, v66, 1
  s_add_u32 s22, s22, s23
  v_readlane_b32 s23, v66, 33
  s_add_u32 s22, s22, s23
  v_readlane_b32 s23, v66, 2
  s_add_u32 s22, s22, s23
  v_readlane_b32 s23, v66, 34
  s_add_u32 s22, s22, s23
  v_readlane_b32 s23, v66, 3
  s_add_u32 s22, s22, s23
  v_readlane_b32 s23, v66, 35
  s_add_u32 s22, s22, s23
  v_readlane_b32 s21, v66, 16
  v_cmp_gt_u32 vcc, 2, v42
  s_cmp_lt_u32 s22, 256
  s_cbranch_scc1 fm_12
  s_cmp_lt_u32 s21, 128
  s_cbranch_scc1 fm_12
  s_cbranch_vccnz fm_12
  v_readlane_b32 s21, v66, s82
  v_cmp_ne_u32 vcc, 32, v66
  s_cmp_ge_u32 s21, 32
  s_cselect_b32 s84, 1, 0
  s_andn2_b32 s53, s84, s53
  s_and_b32 s21, vcc_lo, 15
  s_and_b32 s22, vcc_hi, 15
  s_or_b32 s85, s21, s22
  s_xor_b32 s83, s76, s90
  s_lshl_b32 s70, s50, 4
  s_add_u32 s79, s70, s55
  s_add_u32 s70, s70, s51
  s_lshl_b32 s70, s70, 14
  s_lshl_b32 s79, s79, 14
  s_lshl_b32 s21, s56, 11
  s_add_u32 s79, s79, s21
  s_lshl_b32 s72, s50, 16
  s_lshl_b32 s21, s60, 10
  s_add_u32 s72, s72, s21
  s_add_u32 s72, s72, 136314880
  s_mov_b32 s74, 32768
  s_add_u32 s73, s70, s83
  s_add_u32 s70, s73, 4096
  s_add_u32 s72, s72, s83
  s_xor_b32 s21, s83, 8192
  s_add_u32 s79, s79, s21
  s_add_u32 s12, s48, 173080576
  s_addc_u32 s13, s49, 0
  s_mov_b32 s14, 49152
  s_mov_b32 s15, 0x00020000
  s_mov_b32 s16, s48
  s_mov_b32 s17, s49
  s_mov_b32 s18, 218103808
  s_mov_b32 s19, 0x00020000
  s_waitcnt lgkmcnt(0)
  s_lshl_b32 s21, s20, 16
  s_add_u32 s21, s21, s79
  buffer_load_dwordx4 v[144:147], v4, s[16:19], s21 offen sc1
  buffer_load_dwordx4 v[148:151], v4, s[16:19], s21 offen offset:1024 sc1
  v_subrev_u32 v100, 43008, v20
  v_subrev_u32 v101, 43008, v21
  buffer_load_dwordx4 v[112:115], v100, s[16:19], s73 offen sc1
  buffer_load_dwordx2 v[116:117], v101, s[16:19], s73 offen sc1
  v_and_b32 v100, 127, v19
  v_lshl_add_u32 v100, v3, 8, v100
  v_and_b32 v101, 2, v2
  v_cmp_eq_u32 vcc, 0, v101
  s_lshl_b32 s21, s20, 14
  s_lshl_b32 s22, s61, 7
  s_add_u32 s21, s21, s22
  s_add_u32 s21, s21, s72
  v_mov_b32 v152, 0x3f803f80
  v_mov_b32 v153, 0x3f803f80
  v_mov_b32 v154, 0x3f803f80
  v_mov_b32 v155, 0x3f803f80
  s_mov_b64 exec, vcc
  buffer_load_dwordx4 v[152:155], v100, s[16:19], s21 offen sc1
  s_mov_b64 exec, -1
  v_and_b32 v100, 7, v1
  v_mul_u32_u24 v100, 1280, v100
  v_lshrrev_b32 v101, 3, v1
  v_lshl_add_u32 v100, v101, 4, v100
  buffer_load_dwordx4 v[48:51], v100, s[36:39], 0 offen offset:0
  buffer_load_dwordx4 v[52:55], v100, s[36:39], 0 offen offset:128
  buffer_load_dwordx4 v[56:59], v100, s[36:39], 0 offen offset:256
  buffer_load_dwordx4 v[60:63], v100, s[36:39], 0 offen offset:384
  buffer_load_dwordx4 v[64:67], v100, s[36:39], 0 offen offset:512
  buffer_load_dwordx4 v[68:71], v100, s[36:39], 0 offen offset:640
  buffer_load_dwordx4 v[72:75], v100, s[36:39], 0 offen offset:768
  buffer_load_dwordx4 v[76:79], v100, s[36:39], 0 offen offset:896
  buffer_load_dwordx4 v[80:83], v100, s[36:39], 0 offen offset:1024
  buffer_load_dwordx4 v[84:87], v100, s[36:39], 0 offen offset:1152
  s_barrier
  s_cmp_eq_u32 s20, 3
  s_cbranch_scc1 w3_16
  ds_read_b64_tr_b16 a[160:161], v88 offset:12288
  ds_read_b64_tr_b16 a[162:163], v88 offset:12480
  ds_read_b64_tr_b16 a[164:165], v88 offset:18432
  ds_read_b64_tr_b16 a[166:167], v88 offset:18624
  ds_read_b64_tr_b16 a[168:169], v88 offset:24576
  ds_read_b64_tr_b16 a[170:171], v88 offset:24768
  ds_read_b64_tr_b16 a[172:173], v88 offset:30720
  ds_read_b64_tr_b16 a[174:175], v88 offset:30912
  ds_read_b64_tr_b16 a[176:177], v88 offset:0
  ds_read_b64_tr_b16 a[178:179], v88 offset:192
  ds_read_b64_tr_b16 a[180:181], v89 offset:12288
  ds_read_b64_tr_b16 a[182:183], v89 offset:12480
  ds_read_b64_tr_b16 a[184:185], v89 offset:18432
  ds_read_b64_tr_b16 a[186:187], v89 offset:18624
  ds_read_b64_tr_b16 a[188:189], v89 offset:24576
  ds_read_b64_tr_b16 a[190:191], v89 offset:24768
  ds_read_b64_tr_b16 a[192:193], v89 offset:30720
  ds_read_b64_tr_b16 a[194:195], v89 offset:30912
  ds_read_b64_tr_b16 a[196:197], v89 offset:0
  ds_read_b64_tr_b16 a[198:199], v89 offset:192
  ds_read_b64_tr_b16 a[200:201], v90 offset:12288
  ds_read_b64_tr_b16 a[202:203], v90 offset:12480
  ds_read_b64_tr_b16 a[204:205], v90 offset:18432
  ds_read_b64_tr_b16 a[206:207], v90 offset:18624
  ds_read_b64_tr_b16 a[208:209], v90 offset:24576
  ds_read_b64_tr_b16 a[210:211], v90 offset:24768
  ds_read_b64_tr_b16 a[212:213], v90 offset:30720
  ds_read_b64_tr_b16 a[214:215], v90 offset:30912
  ds_read_b64_tr_b16 a[216:217], v90 offset:0
  ds_read_b64_tr_b16 a[218:219], v90 offset:192
  ds_read_b64_tr_b16 a[220:221], v91 offset:12288
  ds_read_b64_tr_b16 a[222:223], v91 offset:12480
  ds_read_b64_tr_b16 a[224:225], v91 offset:18432
  ds_read_b64_tr_b16 a[226:227], v91 offset:18624
  ds_read_b64_tr_b16 a[228:229], v91 offset:24576
  ds_read_b64_tr_b16 a[230:231], v91 offset:24768
  ds_read_b64_tr_b16 a[232:233], v91 offset:30720
  ds_read_b64_tr_b16 a[234:235], v91 offset:30912
  ds_read_b64_tr_b16 a[236:237], v91 offset:0
  ds_read_b64_tr_b16 a[238:239], v91 offset:192
  ds_read_b64_tr_b16 a[240:241], v92 offset:12288
  ds_read_b64_tr_b16 a[242:243], v92 offset:12480
  ds_read_b64_tr_b16 a[244:245], v92 offset:18432
  ds_read_b64_tr_b16 a[246:247], v92 offset:18624
  ds_read_b64_tr_b16 a[248:249], v92 offset:24576
  ds_read_b64_tr_b16 a[250:251], v92 offset:24768
  ds_read_b64_tr_b16 a[252:253], v92 offset:30720
  ds_read_b64_tr_b16 a[254:255], v92 offset:30912
  ds_read_b64_tr_b16 v[192:193], v92 offset:0
  ds_read_b64_tr_b16 v[194:195], v92 offset:192
  ds_read_b64_tr_b16 v[196:197], v93 offset:12288
  ds_read_b64_tr_b16 v[198:199], v93 offset:12480
  ds_read_b64_tr_b16 v[200:201], v93 offset:18432
  ds_read_b64_tr_b16 v[202:203], v93 offset:18624
  ds_read_b64_tr_b16 v[204:205], v93 offset:24576
  ds_read_b64_tr_b16 v[206:207], v93 offset:24768
  ds_read_b64_tr_b16 v[208:209], v93 offset:30720
  ds_read_b64_tr_b16 v[210:211], v93 offset:30912
  ds_read_b64_tr_b16 v[212:213], v93 offset:0
  ds_read_b64_tr_b16 v[214:215], v93 offset:192
  ds_read_b64_tr_b16 v[216:217], v94 offset:12288
  ds_read_b64_tr_b16 v[218:219], v94 offset:12480
  ds_read_b64_tr_b16 v[220:221], v94 offset:18432
  ds_read_b64_tr_b16 v[222:223], v94 offset:18624
  ds_read_b64_tr_b16 v[224:225], v94 offset:24576
  ds_read_b64_tr_b16 v[226:227], v94 offset:24768
  ds_read_b64_tr_b16 v[228:229], v94 offset:30720
  ds_read_b64_tr_b16 v[230:231], v94 offset:30912
  ds_read_b64_tr_b16 v[232:233], v94 offset:0
  ds_read_b64_tr_b16 v[234:235], v94 offset:192
  ds_read_b64_tr_b16 v[236:237], v95 offset:12288
  ds_read_b64_tr_b16 v[238:239], v95 offset:12480
  ds_read_b64_tr_b16 v[240:241], v95 offset:18432
  ds_read_b64_tr_b16 v[242:243], v95 offset:18624
  ds_read_b64_tr_b16 v[244:245], v95 offset:24576
  ds_read_b64_tr_b16 v[246:247], v95 offset:24768
  ds_read_b64_tr_b16 v[248:249], v95 offset:30720
  ds_read_b64_tr_b16 v[250:251], v95 offset:30912
  ds_read_b64_tr_b16 v[252:253], v95 offset:0
  ds_read_b64_tr_b16 v[254:255], v95 offset:192
  s_branch w3_17
w3_16:
  ds_read_b128 a[160:163], v96 offset:36864
  ds_read_b128 a[164:167], v96 offset:37376
  ds_read_b128 a[168:171], v96 offset:37888
  ds_read_b128 a[172:175], v96 offset:38400
  ds_read_b128 a[176:179], v96 offset:38912
  ds_read_b128 a[180:183], v96 offset:39424
  ds_read_b128 a[184:187], v96 offset:39936
  ds_read_b128 a[188:191], v96 offset:40448
  ds_read_b128 a[192:195], v96 offset:6144
  ds_read_b128 a[196:199], v96 offset:6656
  ds_read_b128 a[200:203], v96 offset:7168
  ds_read_b128 a[204:207], v96 offset:7680
  ds_read_b128 a[208:211], v96 offset:8192
  ds_read_b128 a[212:215], v96 offset:8704
  ds_read_b128 a[216:219], v96 offset:9216
  ds_read_b128 a[220:223], v96 offset:9728
  ds_read_b128 a[224:227], v96 offset:10240
  ds_read_b128 a[228:231], v96 offset:10752
  ds_read_b128 a[232:235], v96 offset:11264
  ds_read_b128 a[236:239], v96 offset:11776
  ds_read_b128 a[240:243], v97 offset:36864
  ds_read_b128 a[244:247], v97 offset:37376
  ds_read_b128 a[248:251], v97 offset:37888
  ds_read_b128 a[252:255], v97 offset:38400
  ds_read_b128 v[192:195], v97 offset:38912
  ds_read_b128 v[196:199], v97 offset:39424
  ds_read_b128 v[200:203], v97 offset:39936
  ds_read_b128 v[204:207], v97 offset:40448
  ds_read_b128 v[208:211], v97 offset:6144
  ds_read_b128 v[212:215], v97 offset:6656
  ds_read_b128 v[216:219], v97 offset:7168
  ds_read_b128 v[220:223], v97 offset:7680
  ds_read_b128 v[224:227], v97 offset:8192
  ds_read_b128 v[228:231], v97 offset:8704
  ds_read_b128 v[232:235], v97 offset:9216
  ds_read_b128 v[236:239], v97 offset:9728
  ds_read_b128 v[240:243], v97 offset:10240
  ds_read_b128 v[244:247], v97 offset:10752
  ds_read_b128 v[248:251], v97 offset:11264
  ds_read_b128 v[252:255], v97 offset:11776
w3_17:
  s_cmp_eq_u32 s85, 0
  s_cbranch_scc1 fm_15
  s_cmp_eq_u32 s20, 3
  s_cbranch_scc1 ar_19
  s_mov_b64 exec, s[64:65]
  s_cmp_eq_u32 s20, 2
  s_cbranch_scc1 ar_18
  s_mov_b32 s21, 0
  buffer_store_dwordx2 v[28:29], v8, s[8:11], s21 offen sc1
  s_mov_b32 s21, 122880
  buffer_store_dwordx2 v[28:29], v8, s[8:11], s21 offen sc1
  s_mov_b32 s21, 245760
  buffer_store_dwordx2 v[28:29], v8, s[8:11], s21 offen sc1
  s_mov_b32 s21, 368640
  buffer_store_dwordx2 v[28:29], v8, s[8:11], s21 offen sc1
  s_branch ar_20
ar_18:
  s_mov_b32 s21, 0
  buffer_store_dword v28, v8, s[8:11], s21 offen sc1
  buffer_store_dword v28, v8, s[8:11], s21 offen offset:128 sc1
  s_mov_b32 s21, 122880
  buffer_store_dword v28, v8, s[8:11], s21 offen sc1
  buffer_store_dword v28, v8, s[8:11], s21 offen offset:128 sc1
  s_mov_b32 s21, 245760
  buffer_store_dword v28, v8, s[8:11], s21 offen sc1
  buffer_store_dword v28, v8, s[8:11], s21 offen offset:128 sc1
  s_mov_b32 s21, 368640
  buffer_store_dword v28, v8, s[8:11], s21 offen sc1
  buffer_store_dword v28, v8, s[8:11], s21 offen offset:128 sc1
ar_20:
  s_cmp_eq_u32 s78, 0
  s_cbranch_scc1 ar_21
  s_mov_b64 exec, s[62:63]
  s_add_u32 s21, s77, 0
  buffer_store_dword v28, v17, s[8:11], s21 offen sc1
  s_add_u32 s21, s77, 122880
  buffer_store_dword v28, v17, s[8:11], s21 offen sc1
  s_add_u32 s21, s77, 245760
  buffer_store_dword v28, v17, s[8:11], s21 offen sc1
  s_add_u32 s21, s77, 368640
  buffer_store_dword v28, v17, s[8:11], s21 offen sc1
  s_branch ar_21
ar_19:
  buffer_store_dword v28, v34, s[8:11], 0 offen sc1
  s_mov_b64 exec, s[66:67]
  s_mov_b32 s21, 0
  buffer_store_dwordx4 v[28:31], v15, s[4:7], s21 offen sc1
  s_mov_b32 s21, 262144
  buffer_store_dwordx4 v[28:31], v15, s[4:7], s21 offen sc1
  s_mov_b32 s21, 524288
  buffer_store_dwordx4 v[28:31], v15, s[4:7], s21 offen sc1
  s_mov_b32 s21, 786432
  buffer_store_dwordx4 v[28:31], v15, s[4:7], s21 offen sc1
  s_mov_b32 s21, 8192
  buffer_store_dwordx4 v[28:31], v15, s[4:7], s21 offen sc1
  s_mov_b32 s21, 270336
  buffer_store_dwordx4 v[28:31], v15, s[4:7], s21 offen sc1
  s_mov_b32 s21, 532480
  buffer_store_dwordx4 v[28:31], v15, s[4:7], s21 offen sc1
  s_mov_b32 s21, 794624
  buffer_store_dwordx4 v[28:31], v15, s[4:7], s21 offen sc1
ar_21:
  s_mov_b64 exec, -1
  s_waitcnt vmcnt(0)
  s_barrier
  s_mov_b32 s21, 100
  s_cmp_lg_u32 s20, 0
  s_cbranch_scc1 af_22
  v_mov_b32 v166, 0
  v_mov_b32 v167, 1
  s_mov_b64 exec, 1
  buffer_atomic_add v167, v166, s[32:35], s21 offen sc1
  s_mov_b64 exec, -1
  s_nop 1
af_22:
  s_cmp_lg_u32 s20, 0
  s_cbranch_scc1 wf_24
  v_mov_b32 v166, 0
  s_mov_b32 s101, 0
wf_23:
  buffer_load_dword v167, v166, s[32:35], s21 offen sc1
  s_add_u32 s101, s101, 1
  s_cmp_gt_u32 s101, 131072
  s_cbranch_scc1 end0
  s_waitcnt vmcnt(0)
  v_readfirstlane_b32 s100, v167
  s_cmp_ge_u32 s100, 128
  s_cbranch_scc1 wf_24
  s_sleep 8
  s_branch wf_23
wf_24:
  s_barrier
fm_15:
  s_xor_b32 s74, s74, 16384
  s_add_u32 s73, s73, 2097152
  s_xor_b32 s73, s73, 8192
  s_add_u32 s79, s79, 2097152
  s_xor_b32 s79, s79, 8192
  s_add_u32 s21, s72, 524288
  s_xor_b32 s72, s72, s21
  s_lshr_b32 s72, s72, 8
  s_and_b32 s72, s72, 8192
  s_xor_b32 s72, s72, s21
  s_add_u32 s71, s73, 4096
  s_mov_b32 s91, 1024
  s_sub_u32 s21, s73, 0
  s_cmp_lt_u32 s21, 125829120
  s_cselect_b32 s71, s71, s79
  s_cselect_b32 s91, s91, 65536
  v_add_u32 v15, s83, v15
  v_add_u32 v16, s83, v16
  s_mov_b32 s75, s77
  s_lshl_b32 s77, s58, 7
  s_lshl_b32 s21, s56, 3
  s_add_u32 s77, s77, s21
  s_add_u32 s77, s77, 0
  s_xor_b32 s77, s77, s83
  s_mov_b32 s80, 1400897536
  s_mov_b32 s52, 0
  s_mov_b32 s81, 0
  v_xor_b32 v18, 16384, v18
  v_xor_b32 v19, 16384, v19
  v_xor_b32 v20, 16384, v20
  v_xor_b32 v21, 16384, v21
  v_mov_b32 v168, 0x3f803f80
  v_mov_b32 v169, 0x3f803f80
  v_mov_b32 v170, 0x3f803f80
  v_mov_b32 v171, 0x3f803f80
  v_mov_b32 v166, 0x3f003f00
  v_mov_b32 v167, 0x3f003f00
  s_waitcnt lgkmcnt(0)
  s_barrier
  ds_write_b128 v23, v[168:171] offset:46080
  ds_write_b128 v23, v[168:171] offset:62464
  ds_write_b64 v23, v[166:167] offset:13568
  v_mov_b32 v88, 0
  v_mov_b32 v89, 0
  v_mov_b32 v90, 0
  v_mov_b32 v91, 0
  v_mov_b32 v92, 0
  v_mov_b32 v93, 0
  v_mov_b32 v94, 0
  v_mov_b32 v95, 0
  v_mov_b32 v96, 0
  v_mov_b32 v97, 0
  v_mov_b32 v98, 0
  v_mov_b32 v99, 0
  v_mov_b32 v100, 0
  v_mov_b32 v101, 0
  v_mov_b32 v102, 0
  v_mov_b32 v103, 0
  v_mov_b32 v110, 0
  v_mov_b32 v111, 0
  v_mov_b32 v118, 0
  v_mov_b32 v119, 0
  v_mov_b32 v142, 0
  v_mov_b32 v143, 0
  v_mov_b32 v162, 0
  v_mov_b32 v163, 0
  s_and_b32 s21, s52, 3
  s_mul_i32 s56, s21, 122880
  s_add_u32 s21, s52, 1
  s_and_b32 s21, s21, 3
  s_mul_i32 s55, s21, 122880
  s_add_u32 s55, s55, s75
  s_add_u32 s21, s52, 2
  s_and_b32 s21, s21, 3
  s_mul_i32 s57, s21, 122880
  s_add_u32 s21, s52, 3
  s_and_b32 s21, s21, 3
  s_mul_i32 s59, s21, 122880
  s_add_u32 s59, s59, s75
  s_bfe_u32 s61, s52, 0x10002
  s_and_b32 s21, s52, 3
  s_lshl_b32 s60, s21, 18
  s_mov_b32 s58, s55
  s_waitcnt lgkmcnt(0)
  s_lshl_b32 s21, s53, 2
  s_add_u32 s21, s21, s20
  s_cmp_eq_u32 s21, 0
  s_cbranch_scc1 E_25
  s_cmp_eq_u32 s21, 4
  s_cbranch_scc1 E_26
  s_cmp_eq_u32 s21, 1
  s_cbranch_scc1 E_27
  s_cmp_eq_u32 s21, 5
  s_cbranch_scc1 E_28
  s_cmp_eq_u32 s21, 2
  s_cbranch_scc1 E_29
  s_cmp_eq_u32 s21, 6
  s_cbranch_scc1 E_30
  s_cmp_eq_u32 s21, 3
  s_cbranch_scc1 E_31
  s_cmp_eq_u32 s21, 7
  s_cbranch_scc1 E_32
  s_branch end0
E_26:
  v_add_u32 v190, 0, v4
  ds_write_b64 v6, v[28:29]
  ds_write_b32 v13, v28
  ds_write_b32 v14, v28
  s_waitcnt vmcnt(0)
  ds_write_b128 v190, v[48:51] offset:0
  ds_write_b128 v190, v[52:55] offset:1024
  s_waitcnt lgkmcnt(0)
  s_add_u32 m0, s74, 4096
  s_add_u32 s21, s79, 131072
  buffer_load_dwordx4 v4, s[16:19], s21 offen offset:1024 sc1 lds
  s_add_u32 m0, s74, 9216
  s_add_u32 s21, s72, 32768
  buffer_load_dwordx4 v32, s[16:19], s21 offen sc1 lds
  s_xor_b32 s74, s74, 16384
  s_add_u32 s73, s73, 2097152
  s_xor_b32 s73, s73, 8192
  s_add_u32 s79, s79, 2097152
  s_xor_b32 s79, s79, 8192
  s_add_u32 s21, s72, 524288
  s_xor_b32 s72, s72, s21
  s_lshr_b32 s72, s72, 8
  s_and_b32 s72, s72, 8192
  s_xor_b32 s72, s72, s21
  s_add_u32 s71, s73, 4096
  s_mov_b32 s91, 1024
  s_sub_u32 s21, s73, 0
  s_cmp_lt_u32 s21, 125829120
  s_cselect_b32 s71, s71, s79
  s_cselect_b32 s91, s91, 65536
  s_branch mo_38
  .p2align 3
top_33:
  s_waitcnt vmcnt(1)
  ds_write_b128 v190, v[48:51] offset:0
  v_cmp_eq_u32 s[22:23], -1, v48
  s_waitcnt vmcnt(0)
  ds_write_b128 v190, v[52:55] offset:1024
  v_cmp_eq_u32 s[98:99], -1, v52
  s_or_b64 vcc, s[22:23], s[98:99]
  s_cbranch_scc1 mr_34
mo_38:
  s_barrier
  ds_read_b128 v[56:59], v4 offset:2048
  ds_read_b128 v[60:63], v4 offset:3072
  v_smfmac_f32_16x16x64_bf16 v[92:95], v[48:51], a[240:247], v22
  ds_read_b128 v[64:67], v4 offset:4096
  v_smfmac_f32_16x16x64_bf16 v[88:91], v[48:51], a[160:167], v22
  ds_read_b128 v[68:71], v4 offset:5120
  v_smfmac_f32_16x16x64_bf16 v[92:95], v[52:55], a[248:255], v22
  ds_read_b128 v[72:75], v4 offset:6144
  v_smfmac_f32_16x16x64_bf16 v[88:91], v[52:55], a[168:175], v22
  s_waitcnt lgkmcnt(4)
  ds_read_b128 v[76:79], v4 offset:7168
  v_smfmac_f32_16x16x64_bf16 v[92:95], v[56:59], v[192:199], v22
  ds_read_b128 v[80:83], v4 offset:8192
  v_smfmac_f32_16x16x64_bf16 v[88:91], v[56:59], a[176:183], v22
  s_waitcnt lgkmcnt(5)
  ds_read_b128 v[84:87], v4 offset:9216
  v_smfmac_f32_16x16x64_bf16 v[92:95], v[60:63], v[200:207], v22
  v_smfmac_f32_16x16x64_bf16 v[88:91], v[60:63], a[184:191], v22
  s_waitcnt lgkmcnt(5)
  v_smfmac_f32_16x16x64_bf16 v[92:95], v[64:67], v[208:215], v22
  s_waitcnt lgkmcnt(4)
  v_smfmac_f32_16x16x64_bf16 v[92:95], v[68:71], v[216:223], v22
  s_waitcnt lgkmcnt(3)
  v_smfmac_f32_16x16x64_bf16 v[92:95], v[72:75], v[224:231], v22
  s_waitcnt lgkmcnt(2)
  v_smfmac_f32_16x16x64_bf16 v[92:95], v[76:79], v[232:239], v22
  s_waitcnt lgkmcnt(1)
  v_smfmac_f32_16x16x64_bf16 v[92:95], v[80:83], v[240:247], v22
  s_waitcnt lgkmcnt(0)
  v_smfmac_f32_16x16x64_bf16 v[92:95], v[84:87], v[248:255], v22
  v_smfmac_f32_16x16x64_bf16 v[88:91], v[64:67], a[192:199], v22
  v_smfmac_f32_16x16x64_bf16 v[88:91], v[68:71], a[200:207], v22
  v_smfmac_f32_16x16x64_bf16 v[88:91], v[72:75], a[208:215], v22
  v_permlane32_swap_b32 v92, v93
  v_smfmac_f32_16x16x64_bf16 v[88:91], v[76:79], a[216:223], v22
  v_permlane32_swap_b32 v94, v95
  v_smfmac_f32_16x16x64_bf16 v[88:91], v[80:83], a[224:231], v22
  v_permlane32_swap_b32 v93, v92
  v_smfmac_f32_16x16x64_bf16 v[88:91], v[84:87], a[232:239], v22
  v_permlane32_swap_b32 v95, v94
  v_pk_mul_f32 v[120:121], v[92:93], v[24:25] op_sel:[1,0] op_sel_hi:[0,1]
  v_pk_mul_f32 v[122:123], v[94:95], v[24:25] op_sel:[1,0] op_sel_hi:[0,1]
  s_nop 4
  v_pk_fma_f32 v[88:89], v[88:89], v[24:25], v[120:121]
  v_pk_fma_f32 v[90:91], v[90:91], v[24:25], v[122:123]
  v_cvt_pk_bf16_f32 v120, v88, v89
  v_cvt_pk_bf16_f32 v121, v90, v91
  ds_write_b64 v6, v[120:121]
  s_barrier
  ds_read_b64_tr_b16 v[104:105], v7 offset:0
  ds_read_b64_tr_b16 v[106:107], v7 offset:768
  ds_read_b64_tr_b16 v[108:109], v7 offset:1536
  s_waitcnt lgkmcnt(1)
  v_mfma_f32_16x16x32_bf16 v[120:123], v[112:115], v[104:107], 0
  s_waitcnt lgkmcnt(0)
  v_mfma_f32_16x16x32_bf16 v[120:123], v[116:119], v[108:111], v[120:123]
  s_mov_b64 exec, s[64:65]
  s_nop 6
  v_cmpx_o_f32 vcc, v120, v121
  v_cvt_pk_f16_f32 v120, v120, v121
  v_cvt_pk_f16_f32 v121, v122, v123
  buffer_store_dwordx2 v[120:121], v8, s[8:11], s56 offen
  s_xor_b64 s[98:99], exec, s[64:65]
  s_mov_b64 exec, -1
  s_waitcnt lgkmcnt(0)
  s_barrier
  ds_read_b64_tr_b16 v[104:105], v7 offset:0
  ds_read_b64_tr_b16 v[106:107], v7 offset:768
  ds_read_b64_tr_b16 v[108:109], v7 offset:1536
  ds_read_b32 v27, v12 offset:12544
  ds_read_b64 v[140:141], v11
  s_waitcnt lgkmcnt(1)
  v_cmp_u_f32 vcc, v104, v106
  v_cmp_u_f32 s[22:23], v108, v27
  s_nop 1
  s_or_b64 vcc, vcc, s[22:23]
  s_cbranch_vccnz mn_35
mk_36:
  s_cmp_eq_u32 s52, 63
  s_cbranch_scc1 last_37
  s_cmp_lg_u64 s[98:99], 0
  s_cbranch_scc1 sf_39
sf_40:
  s_nop 15
  s_nop 10
  v_smfmac_f32_16x16x64_bf16 v[96:99], v[48:51], a[0:7], v22
  v_smfmac_f32_16x16x64_bf16 v[100:103], v[48:51], a[80:87], v22
  v_smfmac_f32_16x16x64_bf16 v[96:99], v[52:55], a[8:15], v22
  v_smfmac_f32_16x16x64_bf16 v[100:103], v[52:55], a[88:95], v22
  v_smfmac_f32_16x16x64_bf16 v[96:99], v[56:59], a[16:23], v22
  v_smfmac_f32_16x16x64_bf16 v[100:103], v[56:59], a[96:103], v22
  buffer_load_dwordx4 v[132:135], v10, s[8:11], s56 offen sc1
  v_smfmac_f32_16x16x64_bf16 v[96:99], v[60:63], a[24:31], v22
  buffer_load_dwordx4 v[124:127], v9, s[8:11], s56 offen sc1
  v_smfmac_f32_16x16x64_bf16 v[96:99], v[64:67], a[32:39], v22
  buffer_load_dwordx4 v[128:131], v9, s[8:11], s56 offen offset:1024 sc1
  v_smfmac_f32_16x16x64_bf16 v[96:99], v[68:71], a[40:47], v22
  v_smfmac_f32_16x16x64_bf16 v[96:99], v[72:75], a[48:55], v22
  v_smfmac_f32_16x16x64_bf16 v[96:99], v[76:79], a[56:63], v22
  v_smfmac_f32_16x16x64_bf16 v[96:99], v[80:83], a[64:71], v22
  v_smfmac_f32_16x16x64_bf16 v[96:99], v[84:87], a[72:79], v22
  v_smfmac_f32_16x16x64_bf16 v[100:103], v[60:63], a[104:111], v22
  v_smfmac_f32_16x16x64_bf16 v[100:103], v[64:67], a[112:119], v22
  v_smfmac_f32_16x16x64_bf16 v[100:103], v[68:71], a[120:127], v22
  v_smfmac_f32_16x16x64_bf16 v[100:103], v[72:75], a[128:135], v22
  v_cvt_pk_bf16_f32 v136, v96, v97
  v_smfmac_f32_16x16x64_bf16 v[100:103], v[76:79], a[136:143], v22
  v_cvt_pk_bf16_f32 v137, v98, v99
  v_smfmac_f32_16x16x64_bf16 v[100:103], v[80:83], a[144:151], v22
  v_smfmac_f32_16x16x64_bf16 v[100:103], v[84:87], a[152:159], v22
  s_nop 7
  v_cvt_pk_bf16_f32 v138, v100, v101
  v_cvt_pk_bf16_f32 v139, v102, v103
  s_waitcnt vmcnt(2) lgkmcnt(0)
  v_pk_add_f16 v164, v132, v133
  v_pk_add_f16 v165, v134, v135
  v_fma_mix_f32 v170, v164, 1.0, v165 op_sel:[0,0,0] op_sel_hi:[1,0,1]
  v_fma_mix_f32 v171, v164, 1.0, v165 op_sel:[1,0,1] op_sel_hi:[1,0,1]
  v_exp_f32 v176, v170
  v_exp_f32 v177, v171
  s_waitcnt vmcnt(1)
  v_cvt_pk_bf16_f32 v160, v176, v177
  v_pk_add_f16 v120, v124, v126
  v_pk_add_f16 v121, v125, v127
  v_mov_b32_dpp v161, v160 row_ror:8 row_mask:0xf bank_mask:0xf
  s_waitcnt vmcnt(0)
  v_pk_add_f16 v122, v128, v130
  v_mfma_f32_16x16x32_bf16 v[178:181], v[140:143], v[160:163], 0
  v_fma_mix_f32 v166, v120, 1.0, v122 op_sel:[0,0,0] op_sel_hi:[1,0,1]
  v_fma_mix_f32 v167, v120, 1.0, v122 op_sel:[1,0,1] op_sel_hi:[1,0,1]
  v_cmp_u_f32 vcc, v166, v170
  v_pk_add_f16 v123, v129, v131
  v_exp_f32 v172, v166
  v_mfma_f32_16x16x32_bf16 v[182:185], v[136:139], v[160:163], 0
  s_cbranch_vccnz sr_41
  v_exp_f32 v173, v167
  v_fma_mix_f32 v168, v121, 1.0, v123 op_sel:[0,0,0] op_sel_hi:[1,0,1]
  v_fma_mix_f32 v169, v121, 1.0, v123 op_sel:[1,0,1] op_sel_hi:[1,0,1]
  v_cvt_pk_bf16_f32 v156, v172, v173
  v_exp_f32 v174, v168
  v_exp_f32 v175, v169
  v_mov_b32_dpp v158, v156 row_ror:8 row_mask:0xf bank_mask:0xf
  v_cvt_pk_bf16_f32 v157, v174, v175
  v_mfma_f32_16x16x32_bf16 v[186:189], v[138:141], v[160:163], 0
  s_nop 0
  v_mov_b32_dpp v159, v157 row_ror:8 row_mask:0xf bank_mask:0xf
  s_nop 1
pv_42:
  v_mfma_f32_16x16x32_bf16 v[178:181], v[152:155], v[156:159], v[178:181]
  v_mfma_f32_16x16x32_bf16 v[182:185], v[144:147], v[156:159], v[182:185]
  v_mfma_f32_16x16x32_bf16 v[186:189], v[148:151], v[156:159], v[186:189]
  s_mov_b64 exec, s[62:63]
  s_nop 0
  v_rcp_f32 v164, v180
  v_cmp_ngt_f32 s[22:23], s80, v180
  v_cmp_ngt_f32 vcc, s80, v164
  v_pk_mul_f32 v[182:183], v[182:183], v[164:165] op_sel_hi:[1,0]
  v_pk_mul_f32 v[184:185], v[184:185], v[164:165] op_sel_hi:[1,0]
  v_pk_mul_f32 v[178:179], v[178:179], v[164:165] op_sel_hi:[1,0]
  v_pk_mul_f32 v[186:187], v[186:187], v[164:165] op_sel_hi:[1,0]
  v_pk_mul_f32 v[188:189], v[188:189], v[164:165] op_sel_hi:[1,0]
  v_cvt_pk_f16_f32 v64, v178, v179
  s_or_b64 vcc, vcc, s[22:23]
  s_cbranch_scc1 fx_44
fk_45:
  ds_write_b32 v14, v64
  v_cvt_pk_f16_f32 v60, v182, v183
  v_cvt_pk_f16_f32 v61, v184, v185
  v_cvt_pk_f16_f32 v62, v186, v187
  v_cvt_pk_f16_f32 v63, v188, v189
  ds_write_b128 v13, v[60:63]
  s_barrier
  s_mov_b64 exec, -1
  s_add_u32 m0, s74, 4096
  s_add_u32 s21, s79, 131072
  buffer_load_dwordx4 v4, s[16:19], s21 offen offset:1024 sc1 lds
  s_add_u32 m0, s74, 9216
  s_add_u32 s21, s72, 32768
  buffer_load_dwordx4 v32, s[16:19], s21 offen sc1 lds
  s_xor_b32 s74, s74, 16384
  s_add_u32 s73, s73, 2097152
  s_xor_b32 s73, s73, 8192
  s_add_u32 s79, s79, 2097152
  s_xor_b32 s79, s79, 8192
  s_add_u32 s21, s72, 524288
  s_xor_b32 s72, s72, s21
  s_lshr_b32 s72, s72, 8
  s_and_b32 s72, s72, 8192
  s_xor_b32 s72, s72, s21
  s_add_u32 s71, s73, 4096
  s_mov_b32 s91, 1024
  s_sub_u32 s21, s73, 0
  s_cmp_lt_u32 s21, 125829120
  s_cselect_b32 s71, s71, s79
  s_cselect_b32 s91, s91, 65536
  v_permlane32_swap_b32 v96, v100
  v_permlane32_swap_b32 v97, v101
  v_permlane32_swap_b32 v98, v102
  v_permlane32_swap_b32 v99, v103
  v_pk_add_f32 v[96:97], v[96:97], v[100:101]
  v_pk_add_f32 v[98:99], v[98:99], v[102:103]
  v_cvt_pk_bf16_f32 v100, v96, v97
  v_cvt_pk_bf16_f32 v101, v98, v99
  s_nop 0
  v_permlane32_swap_b32 v100, v102
  v_permlane32_swap_b32 v101, v103
  v_min_u32 v100, -2, v100
  s_nop 6
  buffer_store_dwordx4 v[100:103], v26, s[16:19], s70 offen sc1
  v_min_u32 v104, -2, v104
  buffer_store_dwordx4 v[104:107], v36, s[16:19], s70 offen offset:2560 sc1
  s_add_u32 s70, s70, 2097152
  s_xor_b32 s70, s70, 8192
  ds_read_b128 v[144:147], v18
  ds_read_b128 v[148:151], v18 offset:1024
  ds_read_b128 v[152:155], v19
  ds_read_b128 v[112:115], v20
  ds_read_b64 v[116:117], v21
  v_xor_b32 v18, 16384, v18
  v_xor_b32 v19, 16384, v19
  v_xor_b32 v20, 16384, v20
  v_xor_b32 v21, 16384, v21
  v_mov_b32 v88, 0
  v_mov_b32 v89, 0
  v_mov_b32 v90, 0
  v_mov_b32 v91, 0
  v_mov_b32 v92, 0
  v_mov_b32 v93, 0
  v_mov_b32 v94, 0
  v_mov_b32 v95, 0
  v_mov_b32 v96, 0
  v_mov_b32 v97, 0
  v_mov_b32 v98, 0
  v_mov_b32 v99, 0
  v_mov_b32 v100, 0
  v_mov_b32 v101, 0
  v_mov_b32 v102, 0
  v_mov_b32 v103, 0
  s_mov_b32 s81, 0
  s_waitcnt lgkmcnt(0)
  s_barrier
  s_mov_b64 exec, s[64:65]
  buffer_store_dwordx2 v[28:29], v8, s[8:11], s57 offen
  s_mov_b64 exec, -1
  ds_write_b128 v190, v[28:31] offset:0
  ds_write_b128 v190, v[28:31] offset:1024
  ds_write_b64 v6, v[28:29]
  s_mov_b64 exec, s[62:63]
  buffer_store_dword v28, v17, s[8:11], s59 offen
  s_mov_b64 exec, -1
  s_sleep 3
  s_nop 1
  buffer_load_dwordx4 v[68:71], v16, s[4:7], s60 offen sc1
  s_sleep 3
  s_nop 1
  buffer_load_dwordx4 v[72:75], v16, s[4:7], s60 offen sc1
  s_waitcnt vmcnt(1)
  v_mfma_f32_16x16x32_f16 v[120:123], v[44:47], v[68:71], 0
  v_bitop3_b32 v27, v68, s61, 1 bitop3:0x28
  v_cmp_ne_u32 vcc, 0, v27
  s_nop 1
  s_cbranch_vccnz p2_50
  s_nop 2
pg_49:
  v_add_f32_dpp v120, v120, v120 row_ror:8 row_mask:0xf bank_mask:0xf
  v_add_f32_dpp v121, v121, v121 row_ror:8 row_mask:0xf bank_mask:0xf
  s_mov_b64 exec, s[62:63]
  v_cvt_pk_bf16_f32 v120, v120, v121
  v_min_u32 v120, -2, v120
  buffer_store_dword v120, v17, s[8:11], s55 offen
  s_mov_b64 exec, -1
nt_46:
  s_barrier
  s_mov_b32 s58, s55
  s_add_u32 s52, s52, 1
  ds_write_b32 v13, v28
  ds_write_b32 v14, v28
  s_and_b32 s21, s52, 3
  s_mul_i32 s56, s21, 122880
  s_add_u32 s21, s52, 1
  s_and_b32 s21, s21, 3
  s_mul_i32 s55, s21, 122880
  s_add_u32 s55, s55, s75
  s_add_u32 s21, s52, 2
  s_and_b32 s21, s21, 3
  s_mul_i32 s57, s21, 122880
  s_add_u32 s21, s52, 3
  s_and_b32 s21, s21, 3
  s_mul_i32 s59, s21, 122880
  s_add_u32 s59, s59, s75
  s_bfe_u32 s61, s52, 0x10002
  s_and_b32 s21, s52, 3
  s_lshl_b32 s60, s21, 18
  s_mov_b32 s54, 0
  s_sleep 2
  s_nop 10
  s_waitcnt lgkmcnt(0)
  buffer_load_dwordx4 v[48:51], v190, s[8:11], s58 offen offset:0 sc1
  buffer_load_dwordx4 v[52:55], v190, s[8:11], s58 offen offset:1024 sc1
  s_branch top_33
mr_34:
  s_mov_b64 exec, s[22:23]
  s_cbranch_execz ms_51
  buffer_load_dwordx4 v[48:51], v190, s[8:11], s58 offen offset:0 sc1
ms_51:
  s_mov_b64 exec, s[98:99]
  s_cbranch_execz ms_52
  buffer_load_dwordx4 v[52:55], v190, s[8:11], s58 offen offset:1024 sc1
ms_52:
  s_add_u32 s54, s54, 1
  s_cmp_gt_u32 s54, 131072
  s_cbranch_scc1 end0
  s_waitcnt vmcnt(0)
  s_mov_b64 exec, s[22:23]
  ds_write_b128 v190, v[48:51] offset:0
  v_cmp_eq_u32 s[22:23], -1, v48
  s_mov_b64 exec, s[98:99]
  ds_write_b128 v190, v[52:55] offset:1024
  v_cmp_eq_u32 s[98:99], -1, v52
  s_mov_b64 exec, -1
  s_or_b64 vcc, s[22:23], s[98:99]
  s_cbranch_scc1 mr_34
  s_branch mo_38
sf_39:
  s_waitcnt lgkmcnt(1)
  v_mfma_f32_16x16x32_bf16 v[120:123], v[112:115], v[104:107], 0
  s_waitcnt lgkmcnt(0)
  v_mfma_f32_16x16x32_bf16 v[120:123], v[116:119], v[108:111], v[120:123]
  s_mov_b64 exec, s[64:65]
  s_nop 6
  v_cvt_pk_f16_f32 v120, v120, v121
  v_cvt_pk_f16_f32 v121, v122, v123
  buffer_store_dwordx2 v[120:121], v8, s[8:11], s56 offen
  s_mov_b64 exec, -1
  s_branch sf_40
mn_35:
  s_bitcmp1_b32 s81, 1
  s_cbranch_scc1 mk_36
  s_or_b32 s81, s81, 2
  s_nop 7
  v_mov_b32 v88, 0
  v_mov_b32 v89, 0
  v_mov_b32 v90, 0
  v_mov_b32 v91, 0
  v_mov_b32 v92, 0
  v_mov_b32 v93, 0
  v_mov_b32 v94, 0
  v_mov_b32 v95, 0
  v_mov_b32 v96, 0
  v_mov_b32 v97, 0
  v_mov_b32 v98, 0
  v_mov_b32 v99, 0
  v_mov_b32 v100, 0
  v_mov_b32 v101, 0
  v_mov_b32 v102, 0
  v_mov_b32 v103, 0
  s_cmp_eq_u32 s52, 0
  s_cbranch_scc1 mx_54
mx_53:
  buffer_load_dwordx4 v[48:51], v190, s[8:11], s58 offen offset:0 sc1
  buffer_load_dwordx4 v[52:55], v190, s[8:11], s58 offen offset:1024 sc1
  s_add_u32 s54, s54, 1
  s_cmp_gt_u32 s54, 131072
  s_cbranch_scc1 end0
  s_waitcnt vmcnt(0)
  v_max3_u32 v27, v48, v49, v50
  v_max3_u32 v27, v27, v51, v52
  v_max3_u32 v27, v27, v53, v54
  v_max3_u32 v27, v27, v55, v55
  v_cmp_eq_u32 vcc, -1, v27
  s_nop 1
  s_cbranch_vccnz mx_53
  ds_write_b128 v190, v[48:51] offset:0
  ds_write_b128 v190, v[52:55] offset:1024
mx_54:
  s_waitcnt lgkmcnt(0)
  s_branch mo_38
sr_41:
  s_mov_b32 s54, 0
sr_55:
  s_mov_b64 exec, vcc
  buffer_load_dwordx4 v[124:127], v9, s[8:11], s56 offen sc1
  buffer_load_dwordx4 v[128:131], v9, s[8:11], s56 offen offset:1024 sc1
  buffer_load_dwordx4 v[132:135], v10, s[8:11], s56 offen sc1
  s_mov_b64 exec, -1
  s_add_u32 s54, s54, 1
  s_cmp_gt_u32 s54, 131072
  s_cbranch_scc1 end0
  s_waitcnt vmcnt(0)
  v_pk_add_f16 v164, v132, v133
  v_pk_add_f16 v165, v134, v135
  v_pk_add_f16 v120, v124, v126
  v_pk_add_f16 v122, v128, v130
  v_fma_mix_f32 v170, v164, 1.0, v165 op_sel:[0,0,0] op_sel_hi:[1,0,1]
  v_fma_mix_f32 v166, v120, 1.0, v122 op_sel:[0,0,0] op_sel_hi:[1,0,1]
  v_pk_add_f16 v121, v125, v127
  v_cmp_u_f32 vcc, v166, v170
  v_pk_add_f16 v123, v129, v131
  v_fma_mix_f32 v171, v164, 1.0, v165 op_sel:[1,0,1] op_sel_hi:[1,0,1]
  v_fma_mix_f32 v167, v120, 1.0, v122 op_sel:[1,0,1] op_sel_hi:[1,0,1]
  v_fma_mix_f32 v168, v121, 1.0, v123 op_sel:[0,0,0] op_sel_hi:[1,0,1]
  v_fma_mix_f32 v169, v121, 1.0, v123 op_sel:[1,0,1] op_sel_hi:[1,0,1]
  s_cbranch_vccz ex_43
  s_and_b32 s21, s54, 31
  s_cbranch_scc1 sr_55
  v_max3_u32 v27, v124, v126, v128
  v_max3_u32 v27, v27, v130, v132
  v_max3_u32 v27, v27, v133, v134
  v_max3_u32 v27, v27, v135, v135
  v_cmp_eq_u32 vcc, -1, v27
  s_nop 1
  s_cbranch_vccnz sr_55
ex_43:
  v_exp_f32 v176, v170
  v_exp_f32 v177, v171
  v_exp_f32 v172, v166
  v_cvt_pk_bf16_f32 v160, v176, v177
  v_exp_f32 v173, v167
  v_exp_f32 v174, v168
  v_mov_b32_dpp v161, v160 row_ror:8 row_mask:0xf bank_mask:0xf
  v_cvt_pk_bf16_f32 v156, v172, v173
  v_exp_f32 v175, v169
  v_mfma_f32_16x16x32_bf16 v[178:181], v[140:143], v[160:163], 0
  v_mov_b32_dpp v158, v156 row_ror:8 row_mask:0xf bank_mask:0xf
  v_cvt_pk_bf16_f32 v157, v174, v175
  v_mfma_f32_16x16x32_bf16 v[182:185], v[136:139], v[160:163], 0
  s_nop 0
  v_mov_b32_dpp v159, v157 row_ror:8 row_mask:0xf bank_mask:0xf
  v_mfma_f32_16x16x32_bf16 v[186:189], v[138:141], v[160:163], 0
  s_branch pv_42
fx_44:
  s_bitcmp1_b32 s81, 0
  s_cbranch_scc1 fk_45
  s_or_b32 s81, s81, 1
  s_mov_b64 exec, -1
  v_max3_f32 v164, v166, v167, v168
  v_max3_f32 v165, v169, v170, v171
  v_max_f32 v164, v164, v165
  s_nop 1
  v_max_f32_dpp v164, v164, v164 row_ror:8 row_mask:0xf bank_mask:0xf
  v_mov_b32 v165, v164
  s_nop 1
  v_permlane32_swap_b32 v164, v165
  v_max_f32 v164, v164, v165
  v_mov_b32 v165, v164
  s_nop 1
  v_permlane16_swap_b32 v164, v165
  v_max_f32 v164, v164, v165
  v_sub_f32 v166, v166, v164
  v_sub_f32 v167, v167, v164
  v_sub_f32 v168, v168, v164
  v_sub_f32 v169, v169, v164
  v_sub_f32 v170, v170, v164
  v_sub_f32 v171, v171, v164
  s_branch ex_43
p2_50:
  s_mov_b32 s54, 0
  buffer_load_dwordx4 v[68:71], v16, s[4:7], s60 offen sc1
  s_waitcnt vmcnt(1)
  v_mfma_f32_16x16x32_f16 v[120:123], v[44:47], v[72:75], 0
  v_bitop3_b32 v27, v72, s61, 1 bitop3:0x28
  v_cmp_ne_u32 vcc, 0, v27
  s_nop 1
  s_cbranch_vccz pg_49
  buffer_load_dwordx4 v[72:75], v16, s[4:7], s60 offen sc1
pp_48:
  s_waitcnt vmcnt(1)
  v_mfma_f32_16x16x32_f16 v[120:123], v[44:47], v[68:71], 0
  v_bitop3_b32 v27, v68, s61, 1 bitop3:0x28
  v_cmp_ne_u32 vcc, 0, v27
  s_nop 1
  s_cbranch_vccz pg_49
  buffer_load_dwordx4 v[68:71], v16, s[4:7], s60 offen sc1
  s_waitcnt vmcnt(1)
  v_mfma_f32_16x16x32_f16 v[120:123], v[44:47], v[72:75], 0
  v_bitop3_b32 v27, v72, s61, 1 bitop3:0x28
  v_cmp_ne_u32 vcc, 0, v27
  s_nop 1
  s_cbranch_vccz pg_49
  buffer_load_dwordx4 v[72:75], v16, s[4:7], s60 offen sc1
  s_add_u32 s54, s54, 1
  s_cmp_gt_u32 s54, 131072
  s_cbranch_scc1 end0
  s_branch pp_48
last_37:
  v_min_u32 v104, -2, v104
  buffer_store_dwordx4 v[104:107], v36, s[16:19], s70 offen offset:2560 sc1
  v_smfmac_f32_16x16x64_bf16 v[96:99], v[48:51], a[0:7], v22
  v_smfmac_f32_16x16x64_bf16 v[100:103], v[48:51], a[80:87], v22
  v_smfmac_f32_16x16x64_bf16 v[96:99], v[52:55], a[8:15], v22
  v_smfmac_f32_16x16x64_bf16 v[100:103], v[52:55], a[88:95], v22
  v_smfmac_f32_16x16x64_bf16 v[96:99], v[56:59], a[16:23], v22
  v_smfmac_f32_16x16x64_bf16 v[100:103], v[56:59], a[96:103], v22
  v_smfmac_f32_16x16x64_bf16 v[96:99], v[60:63], a[24:31], v22
  v_smfmac_f32_16x16x64_bf16 v[96:99], v[64:67], a[32:39], v22
  v_smfmac_f32_16x16x64_bf16 v[96:99], v[68:71], a[40:47], v22
  v_smfmac_f32_16x16x64_bf16 v[96:99], v[72:75], a[48:55], v22
  v_smfmac_f32_16x16x64_bf16 v[96:99], v[76:79], a[56:63], v22
  v_smfmac_f32_16x16x64_bf16 v[96:99], v[80:83], a[64:71], v22
  v_smfmac_f32_16x16x64_bf16 v[96:99], v[84:87], a[72:79], v22
  v_smfmac_f32_16x16x64_bf16 v[100:103], v[60:63], a[104:111], v22
  v_smfmac_f32_16x16x64_bf16 v[100:103], v[64:67], a[112:119], v22
  v_smfmac_f32_16x16x64_bf16 v[100:103], v[68:71], a[120:127], v22
  v_smfmac_f32_16x16x64_bf16 v[100:103], v[72:75], a[128:135], v22
  v_smfmac_f32_16x16x64_bf16 v[100:103], v[76:79], a[136:143], v22
  v_smfmac_f32_16x16x64_bf16 v[100:103], v[80:83], a[144:151], v22
  v_smfmac_f32_16x16x64_bf16 v[100:103], v[84:87], a[152:159], v22
  s_nop 7
  v_permlane32_swap_b32 v96, v100
  v_permlane32_swap_b32 v97, v101
  v_permlane32_swap_b32 v98, v102
  v_permlane32_swap_b32 v99, v103
  v_pk_add_f32 v[96:97], v[96:97], v[100:101]
  v_pk_add_f32 v[98:99], v[98:99], v[102:103]
  v_cvt_pk_bf16_f32 v100, v96, v97
  v_cvt_pk_bf16_f32 v101, v98, v99
  s_nop 0
  v_permlane32_swap_b32 v100, v102
  v_permlane32_swap_b32 v101, v103
  v_min_u32 v100, -2, v100
  buffer_store_dwordx4 v[100:103], v26, s[16:19], s70 offen sc1
  s_waitcnt vmcnt(0)
  s_barrier
  s_branch chain_done
E_28:
  v_add_u32 v190, 2048, v4
  ds_write_b64 v6, v[28:29]
  ds_write_b32 v13, v28
  ds_write_b32 v14, v28
  s_waitcnt vmcnt(0)
  ds_write_b128 v190, v[56:59] offset:0
  ds_write_b128 v190, v[60:63] offset:1024
  ds_write_b128 v190, v[64:67] offset:2048
  s_waitcnt lgkmcnt(0)
  s_add_u32 m0, s74, 6144
  s_add_u32 s21, s79, 196608
  buffer_load_dwordx4 v4, s[16:19], s21 offen offset:1024 sc1 lds
  s_add_u32 m0, s74, 4096
  s_mul_i32 s21, s91, 2
  s_add_u32 s21, s21, s71
  buffer_load_dwordx4 v4, s[16:19], s21 offen sc1 lds
  s_xor_b32 s74, s74, 16384
  s_add_u32 s73, s73, 2097152
  s_xor_b32 s73, s73, 8192
  s_add_u32 s79, s79, 2097152
  s_xor_b32 s79, s79, 8192
  s_add_u32 s21, s72, 524288
  s_xor_b32 s72, s72, s21
  s_lshr_b32 s72, s72, 8
  s_and_b32 s72, s72, 8192
  s_xor_b32 s72, s72, s21
  s_add_u32 s71, s73, 4096
  s_mov_b32 s91, 1024
  s_sub_u32 s21, s73, 0
  s_cmp_lt_u32 s21, 125829120
  s_cselect_b32 s71, s71, s79
  s_cselect_b32 s91, s91, 65536
  s_branch mo_62
  .p2align 3
top_57:
  s_waitcnt vmcnt(2)
  ds_write_b128 v190, v[56:59] offset:0
  v_cmp_eq_u32 s[22:23], -1, v56
  s_waitcnt vmcnt(1)
  ds_write_b128 v190, v[60:63] offset:1024
  v_cmp_eq_u32 s[98:99], -1, v60
  s_waitcnt vmcnt(0)
  ds_write_b128 v190, v[64:67] offset:2048
  v_cmp_eq_u32 s[100:101], -1, v64
  s_or_b64 vcc, s[22:23], s[98:99]
  s_or_b64 vcc, vcc, s[100:101]
  s_cbranch_scc1 mr_58
mo_62:
  s_barrier
  ds_read_b128 v[48:51], v4 offset:0
  ds_read_b128 v[52:55], v4 offset:1024
  v_smfmac_f32_16x16x64_bf16 v[92:95], v[56:59], v[192:199], v22
  ds_read_b128 v[68:71], v4 offset:5120
  v_smfmac_f32_16x16x64_bf16 v[88:91], v[56:59], a[176:183], v22
  ds_read_b128 v[72:75], v4 offset:6144
  v_smfmac_f32_16x16x64_bf16 v[92:95], v[60:63], v[200:207], v22
  ds_read_b128 v[76:79], v4 offset:7168
  v_smfmac_f32_16x16x64_bf16 v[88:91], v[60:63], a[184:191], v22
  ds_read_b128 v[80:83], v4 offset:8192
  v_smfmac_f32_16x16x64_bf16 v[92:95], v[64:67], v[208:215], v22
  ds_read_b128 v[84:87], v4 offset:9216
  v_smfmac_f32_16x16x64_bf16 v[88:91], v[64:67], a[192:199], v22
  s_waitcnt lgkmcnt(6)
  v_smfmac_f32_16x16x64_bf16 v[92:95], v[48:51], a[240:247], v22
  v_smfmac_f32_16x16x64_bf16 v[88:91], v[48:51], a[160:167], v22
  s_waitcnt lgkmcnt(5)
  v_smfmac_f32_16x16x64_bf16 v[92:95], v[52:55], a[248:255], v22
  s_waitcnt lgkmcnt(4)
  v_smfmac_f32_16x16x64_bf16 v[92:95], v[68:71], v[216:223], v22
  s_waitcnt lgkmcnt(3)
  v_smfmac_f32_16x16x64_bf16 v[92:95], v[72:75], v[224:231], v22
  s_waitcnt lgkmcnt(2)
  v_smfmac_f32_16x16x64_bf16 v[92:95], v[76:79], v[232:239], v22
  s_waitcnt lgkmcnt(1)
  v_smfmac_f32_16x16x64_bf16 v[92:95], v[80:83], v[240:247], v22
  s_waitcnt lgkmcnt(0)
  v_smfmac_f32_16x16x64_bf16 v[92:95], v[84:87], v[248:255], v22
  v_smfmac_f32_16x16x64_bf16 v[88:91], v[52:55], a[168:175], v22
  v_smfmac_f32_16x16x64_bf16 v[88:91], v[68:71], a[200:207], v22
  v_smfmac_f32_16x16x64_bf16 v[88:91], v[72:75], a[208:215], v22
  v_permlane32_swap_b32 v92, v93
  v_smfmac_f32_16x16x64_bf16 v[88:91], v[76:79], a[216:223], v22
  v_permlane32_swap_b32 v94, v95
  v_smfmac_f32_16x16x64_bf16 v[88:91], v[80:83], a[224:231], v22
  v_permlane32_swap_b32 v93, v92
  v_smfmac_f32_16x16x64_bf16 v[88:91], v[84:87], a[232:239], v22
  v_permlane32_swap_b32 v95, v94
  v_pk_mul_f32 v[120:121], v[92:93], v[24:25] op_sel:[1,0] op_sel_hi:[0,1]
  v_pk_mul_f32 v[122:123], v[94:95], v[24:25] op_sel:[1,0] op_sel_hi:[0,1]
  s_nop 4
  v_pk_fma_f32 v[88:89], v[88:89], v[24:25], v[120:121]
  v_pk_fma_f32 v[90:91], v[90:91], v[24:25], v[122:123]
  v_cvt_pk_bf16_f32 v120, v88, v89
  v_cvt_pk_bf16_f32 v121, v90, v91
  ds_write_b64 v6, v[120:121]
  s_barrier
  ds_read_b64_tr_b16 v[104:105], v7 offset:0
  ds_read_b64_tr_b16 v[106:107], v7 offset:768
  ds_read_b64_tr_b16 v[108:109], v7 offset:1536
  s_waitcnt lgkmcnt(1)
  v_mfma_f32_16x16x32_bf16 v[120:123], v[112:115], v[104:107], 0
  s_waitcnt lgkmcnt(0)
  v_mfma_f32_16x16x32_bf16 v[120:123], v[116:119], v[108:111], v[120:123]
  s_mov_b64 exec, s[64:65]
  s_nop 6
  v_cmpx_o_f32 vcc, v120, v121
  v_cvt_pk_f16_f32 v120, v120, v121
  v_cvt_pk_f16_f32 v121, v122, v123
  buffer_store_dwordx2 v[120:121], v8, s[8:11], s56 offen
  s_xor_b64 s[98:99], exec, s[64:65]
  s_mov_b64 exec, -1
  s_waitcnt lgkmcnt(0)
  s_barrier
  ds_read_b64_tr_b16 v[104:105], v7 offset:0
  ds_read_b64_tr_b16 v[106:107], v7 offset:768
  ds_read_b64_tr_b16 v[108:109], v7 offset:1536
  ds_read_b32 v27, v12 offset:12544
  ds_read_b64 v[140:141], v11
  s_waitcnt lgkmcnt(1)
  v_cmp_u_f32 vcc, v104, v106
  v_cmp_u_f32 s[22:23], v108, v27
  s_nop 1
  s_or_b64 vcc, vcc, s[22:23]
  s_cbranch_vccnz mn_59
mk_60:
  s_cmp_eq_u32 s52, 63
  s_cbranch_scc1 last_61
  s_cmp_lg_u64 s[98:99], 0
  s_cbranch_scc1 sf_63
sf_64:
  s_nop 15
  s_nop 10
  v_smfmac_f32_16x16x64_bf16 v[96:99], v[48:51], a[0:7], v22
  v_smfmac_f32_16x16x64_bf16 v[100:103], v[48:51], a[80:87], v22
  v_smfmac_f32_16x16x64_bf16 v[96:99], v[52:55], a[8:15], v22
  v_smfmac_f32_16x16x64_bf16 v[100:103], v[52:55], a[88:95], v22
  v_smfmac_f32_16x16x64_bf16 v[96:99], v[56:59], a[16:23], v22
  v_smfmac_f32_16x16x64_bf16 v[100:103], v[56:59], a[96:103], v22
  buffer_load_dwordx4 v[132:135], v10, s[8:11], s56 offen sc1
  v_smfmac_f32_16x16x64_bf16 v[96:99], v[60:63], a[24:31], v22
  buffer_load_dwordx4 v[124:127], v9, s[8:11], s56 offen sc1
  v_smfmac_f32_16x16x64_bf16 v[96:99], v[64:67], a[32:39], v22
  buffer_load_dwordx4 v[128:131], v9, s[8:11], s56 offen offset:1024 sc1
  v_smfmac_f32_16x16x64_bf16 v[96:99], v[68:71], a[40:47], v22
  v_smfmac_f32_16x16x64_bf16 v[96:99], v[72:75], a[48:55], v22
  v_smfmac_f32_16x16x64_bf16 v[96:99], v[76:79], a[56:63], v22
  v_smfmac_f32_16x16x64_bf16 v[96:99], v[80:83], a[64:71], v22
  v_smfmac_f32_16x16x64_bf16 v[96:99], v[84:87], a[72:79], v22
  v_smfmac_f32_16x16x64_bf16 v[100:103], v[60:63], a[104:111], v22
  v_smfmac_f32_16x16x64_bf16 v[100:103], v[64:67], a[112:119], v22
  v_smfmac_f32_16x16x64_bf16 v[100:103], v[68:71], a[120:127], v22
  v_smfmac_f32_16x16x64_bf16 v[100:103], v[72:75], a[128:135], v22
  v_cvt_pk_bf16_f32 v136, v96, v97
  v_smfmac_f32_16x16x64_bf16 v[100:103], v[76:79], a[136:143], v22
  v_cvt_pk_bf16_f32 v137, v98, v99
  v_smfmac_f32_16x16x64_bf16 v[100:103], v[80:83], a[144:151], v22
  v_smfmac_f32_16x16x64_bf16 v[100:103], v[84:87], a[152:159], v22
  s_nop 7
  v_cvt_pk_bf16_f32 v138, v100, v101
  v_cvt_pk_bf16_f32 v139, v102, v103
  s_waitcnt vmcnt(2) lgkmcnt(0)
  v_pk_add_f16 v164, v132, v133
  v_pk_add_f16 v165, v134, v135
  v_fma_mix_f32 v170, v164, 1.0, v165 op_sel:[0,0,0] op_sel_hi:[1,0,1]
  v_fma_mix_f32 v171, v164, 1.0, v165 op_sel:[1,0,1] op_sel_hi:[1,0,1]
  v_exp_f32 v176, v170
  v_exp_f32 v177, v171
  s_waitcnt vmcnt(1)
  v_cvt_pk_bf16_f32 v160, v176, v177
  v_pk_add_f16 v120, v124, v126
  v_pk_add_f16 v121, v125, v127
  v_mov_b32_dpp v161, v160 row_ror:8 row_mask:0xf bank_mask:0xf
  s_waitcnt vmcnt(0)
  v_pk_add_f16 v122, v128, v130
  v_mfma_f32_16x16x32_bf16 v[178:181], v[140:143], v[160:163], 0
  v_fma_mix_f32 v166, v120, 1.0, v122 op_sel:[0,0,0] op_sel_hi:[1,0,1]
  v_fma_mix_f32 v167, v120, 1.0, v122 op_sel:[1,0,1] op_sel_hi:[1,0,1]
  v_cmp_u_f32 vcc, v166, v170
  v_pk_add_f16 v123, v129, v131
  v_exp_f32 v172, v166
  v_mfma_f32_16x16x32_bf16 v[182:185], v[136:139], v[160:163], 0
  s_cbranch_vccnz sr_65
  v_exp_f32 v173, v167
  v_fma_mix_f32 v168, v121, 1.0, v123 op_sel:[0,0,0] op_sel_hi:[1,0,1]
  v_fma_mix_f32 v169, v121, 1.0, v123 op_sel:[1,0,1] op_sel_hi:[1,0,1]
  v_cvt_pk_bf16_f32 v156, v172, v173
  v_exp_f32 v174, v168
  v_exp_f32 v175, v169
  v_mov_b32_dpp v158, v156 row_ror:8 row_mask:0xf bank_mask:0xf
  v_cvt_pk_bf16_f32 v157, v174, v175
  v_mfma_f32_16x16x32_bf16 v[186:189], v[138:141], v[160:163], 0
  s_nop 0
  v_mov_b32_dpp v159, v157 row_ror:8 row_mask:0xf bank_mask:0xf
  s_nop 1
pv_66:
  v_mfma_f32_16x16x32_bf16 v[178:181], v[152:155], v[156:159], v[178:181]
  v_mfma_f32_16x16x32_bf16 v[182:185], v[144:147], v[156:159], v[182:185]
  v_mfma_f32_16x16x32_bf16 v[186:189], v[148:151], v[156:159], v[186:189]
  s_mov_b64 exec, s[62:63]
  s_nop 0
  v_rcp_f32 v164, v180
  v_cmp_ngt_f32 s[22:23], s80, v180
  v_cmp_ngt_f32 vcc, s80, v164
  v_pk_mul_f32 v[182:183], v[182:183], v[164:165] op_sel_hi:[1,0]
  v_pk_mul_f32 v[184:185], v[184:185], v[164:165] op_sel_hi:[1,0]
  v_pk_mul_f32 v[178:179], v[178:179], v[164:165] op_sel_hi:[1,0]
  v_pk_mul_f32 v[186:187], v[186:187], v[164:165] op_sel_hi:[1,0]
  v_pk_mul_f32 v[188:189], v[188:189], v[164:165] op_sel_hi:[1,0]
  v_cvt_pk_f16_f32 v64, v178, v179
  s_or_b64 vcc, vcc, s[22:23]
  s_cbranch_scc1 fx_68
fk_69:
  ds_write_b32 v14, v64
  v_cvt_pk_f16_f32 v60, v182, v183
  v_cvt_pk_f16_f32 v61, v184, v185
  v_cvt_pk_f16_f32 v62, v186, v187
  v_cvt_pk_f16_f32 v63, v188, v189
  ds_write_b128 v13, v[60:63]
  s_barrier
  s_mov_b64 exec, -1
  s_add_u32 m0, s74, 6144
  s_add_u32 s21, s79, 196608
  buffer_load_dwordx4 v4, s[16:19], s21 offen offset:1024 sc1 lds
  s_add_u32 m0, s74, 4096
  s_mul_i32 s21, s91, 2
  s_add_u32 s21, s21, s71
  buffer_load_dwordx4 v4, s[16:19], s21 offen sc1 lds
  s_xor_b32 s74, s74, 16384
  s_add_u32 s73, s73, 2097152
  s_xor_b32 s73, s73, 8192
  s_add_u32 s79, s79, 2097152
  s_xor_b32 s79, s79, 8192
  s_add_u32 s21, s72, 524288
  s_xor_b32 s72, s72, s21
  s_lshr_b32 s72, s72, 8
  s_and_b32 s72, s72, 8192
  s_xor_b32 s72, s72, s21
  s_add_u32 s71, s73, 4096
  s_mov_b32 s91, 1024
  s_sub_u32 s21, s73, 0
  s_cmp_lt_u32 s21, 125829120
  s_cselect_b32 s71, s71, s79
  s_cselect_b32 s91, s91, 65536
  v_permlane32_swap_b32 v96, v100
  v_permlane32_swap_b32 v97, v101
  v_permlane32_swap_b32 v98, v102
  v_permlane32_swap_b32 v99, v103
  v_pk_add_f32 v[96:97], v[96:97], v[100:101]
  v_pk_add_f32 v[98:99], v[98:99], v[102:103]
  v_cvt_pk_bf16_f32 v100, v96, v97
  v_cvt_pk_bf16_f32 v101, v98, v99
  s_nop 0
  v_permlane32_swap_b32 v100, v102
  v_permlane32_swap_b32 v101, v103
  v_min_u32 v100, -2, v100
  s_nop 6
  buffer_store_dwordx4 v[100:103], v26, s[16:19], s70 offen sc1
  v_min_u32 v108, -2, v108
  buffer_store_dwordx2 v[108:109], v37, s[16:19], s70 offen offset:3072 sc1
  s_add_u32 s70, s70, 2097152
  s_xor_b32 s70, s70, 8192
  ds_read_b128 v[144:147], v18
  ds_read_b128 v[148:151], v18 offset:1024
  ds_read_b128 v[152:155], v19
  ds_read_b128 v[112:115], v20
  ds_read_b64 v[116:117], v21
  v_xor_b32 v18, 16384, v18
  v_xor_b32 v19, 16384, v19
  v_xor_b32 v20, 16384, v20
  v_xor_b32 v21, 16384, v21
  v_mov_b32 v88, 0
  v_mov_b32 v89, 0
  v_mov_b32 v90, 0
  v_mov_b32 v91, 0
  v_mov_b32 v92, 0
  v_mov_b32 v93, 0
  v_mov_b32 v94, 0
  v_mov_b32 v95, 0
  v_mov_b32 v96, 0
  v_mov_b32 v97, 0
  v_mov_b32 v98, 0
  v_mov_b32 v99, 0
  v_mov_b32 v100, 0
  v_mov_b32 v101, 0
  v_mov_b32 v102, 0
  v_mov_b32 v103, 0
  s_mov_b32 s81, 0
  s_waitcnt lgkmcnt(0)
  s_barrier
  s_mov_b64 exec, s[64:65]
  buffer_store_dwordx2 v[28:29], v8, s[8:11], s57 offen
  s_mov_b64 exec, -1
  ds_write_b128 v190, v[28:31] offset:0
  ds_write_b128 v190, v[28:31] offset:1024
  ds_write_b128 v190, v[28:31] offset:2048
  ds_write_b64 v6, v[28:29]
  s_mov_b64 exec, s[62:63]
  buffer_store_dword v28, v17, s[8:11], s59 offen
  s_mov_b64 exec, -1
  s_sleep 3
  s_nop 1
  buffer_load_dwordx4 v[68:71], v16, s[4:7], s60 offen sc1
  s_sleep 3
  s_nop 1
  buffer_load_dwordx4 v[72:75], v16, s[4:7], s60 offen sc1
  s_waitcnt vmcnt(1)
  v_mfma_f32_16x16x32_f16 v[120:123], v[44:47], v[68:71], 0
  v_bitop3_b32 v27, v68, s61, 1 bitop3:0x28
  v_cmp_ne_u32 vcc, 0, v27
  s_nop 1
  s_cbranch_vccnz p2_74
  s_nop 2
pg_73:
  v_add_f32_dpp v120, v120, v120 row_ror:8 row_mask:0xf bank_mask:0xf
  v_add_f32_dpp v121, v121, v121 row_ror:8 row_mask:0xf bank_mask:0xf
  s_mov_b64 exec, s[62:63]
  v_cvt_pk_bf16_f32 v120, v120, v121
  v_min_u32 v120, -2, v120
  buffer_store_dword v120, v17, s[8:11], s55 offen
  s_mov_b64 exec, -1
nt_70:
  s_barrier
  s_mov_b32 s58, s55
  s_add_u32 s52, s52, 1
  ds_write_b32 v13, v28
  ds_write_b32 v14, v28
  s_and_b32 s21, s52, 3
  s_mul_i32 s56, s21, 122880
  s_add_u32 s21, s52, 1
  s_and_b32 s21, s21, 3
  s_mul_i32 s55, s21, 122880
  s_add_u32 s55, s55, s75
  s_add_u32 s21, s52, 2
  s_and_b32 s21, s21, 3
  s_mul_i32 s57, s21, 122880
  s_add_u32 s21, s52, 3
  s_and_b32 s21, s21, 3
  s_mul_i32 s59, s21, 122880
  s_add_u32 s59, s59, s75
  s_bfe_u32 s61, s52, 0x10002
  s_and_b32 s21, s52, 3
  s_lshl_b32 s60, s21, 18
  s_mov_b32 s54, 0
  s_sleep 2
  s_nop 10
  s_waitcnt lgkmcnt(0)
  buffer_load_dwordx4 v[56:59], v190, s[8:11], s58 offen offset:0 sc1
  buffer_load_dwordx4 v[60:63], v190, s[8:11], s58 offen offset:1024 sc1
  buffer_load_dwordx4 v[64:67], v190, s[8:11], s58 offen offset:2048 sc1
  s_branch top_57
mr_58:
  s_mov_b64 exec, s[22:23]
  s_cbranch_execz ms_75
  buffer_load_dwordx4 v[56:59], v190, s[8:11], s58 offen offset:0 sc1
ms_75:
  s_mov_b64 exec, s[98:99]
  s_cbranch_execz ms_76
  buffer_load_dwordx4 v[60:63], v190, s[8:11], s58 offen offset:1024 sc1
ms_76:
  s_mov_b64 exec, s[100:101]
  s_cbranch_execz ms_77
  buffer_load_dwordx4 v[64:67], v190, s[8:11], s58 offen offset:2048 sc1
ms_77:
  s_add_u32 s54, s54, 1
  s_cmp_gt_u32 s54, 131072
  s_cbranch_scc1 end0
  s_waitcnt vmcnt(0)
  s_mov_b64 exec, s[22:23]
  ds_write_b128 v190, v[56:59] offset:0
  v_cmp_eq_u32 s[22:23], -1, v56
  s_mov_b64 exec, s[98:99]
  ds_write_b128 v190, v[60:63] offset:1024
  v_cmp_eq_u32 s[98:99], -1, v60
  s_mov_b64 exec, s[100:101]
  ds_write_b128 v190, v[64:67] offset:2048
  v_cmp_eq_u32 s[100:101], -1, v64
  s_mov_b64 exec, -1
  s_or_b64 vcc, s[22:23], s[98:99]
  s_or_b64 vcc, vcc, s[100:101]
  s_cbranch_scc1 mr_58
  s_branch mo_62
sf_63:
  s_waitcnt lgkmcnt(1)
  v_mfma_f32_16x16x32_bf16 v[120:123], v[112:115], v[104:107], 0
  s_waitcnt lgkmcnt(0)
  v_mfma_f32_16x16x32_bf16 v[120:123], v[116:119], v[108:111], v[120:123]
  s_mov_b64 exec, s[64:65]
  s_nop 6
  v_cvt_pk_f16_f32 v120, v120, v121
  v_cvt_pk_f16_f32 v121, v122, v123
  buffer_store_dwordx2 v[120:121], v8, s[8:11], s56 offen
  s_mov_b64 exec, -1
  s_branch sf_64
mn_59:
  s_bitcmp1_b32 s81, 1
  s_cbranch_scc1 mk_60
  s_or_b32 s81, s81, 2
  s_nop 7
  v_mov_b32 v88, 0
  v_mov_b32 v89, 0
  v_mov_b32 v90, 0
  v_mov_b32 v91, 0
  v_mov_b32 v92, 0
  v_mov_b32 v93, 0
  v_mov_b32 v94, 0
  v_mov_b32 v95, 0
  v_mov_b32 v96, 0
  v_mov_b32 v97, 0
  v_mov_b32 v98, 0
  v_mov_b32 v99, 0
  v_mov_b32 v100, 0
  v_mov_b32 v101, 0
  v_mov_b32 v102, 0
  v_mov_b32 v103, 0
  s_cmp_eq_u32 s52, 0
  s_cbranch_scc1 mx_79
mx_78:
  buffer_load_dwordx4 v[56:59], v190, s[8:11], s58 offen offset:0 sc1
  buffer_load_dwordx4 v[60:63], v190, s[8:11], s58 offen offset:1024 sc1
  buffer_load_dwordx4 v[64:67], v190, s[8:11], s58 offen offset:2048 sc1
  s_add_u32 s54, s54, 1
  s_cmp_gt_u32 s54, 131072
  s_cbranch_scc1 end0
  s_waitcnt vmcnt(0)
  v_max3_u32 v27, v56, v57, v58
  v_max3_u32 v27, v27, v59, v60
  v_max3_u32 v27, v27, v61, v62
  v_max3_u32 v27, v27, v63, v64
  v_max3_u32 v27, v27, v65, v66
  v_max3_u32 v27, v27, v67, v67
  v_cmp_eq_u32 vcc, -1, v27
  s_nop 1
  s_cbranch_vccnz mx_78
  ds_write_b128 v190, v[56:59] offset:0
  ds_write_b128 v190, v[60:63] offset:1024
  ds_write_b128 v190, v[64:67] offset:2048
mx_79:
  s_waitcnt lgkmcnt(0)
  s_branch mo_62
sr_65:
  s_mov_b32 s54, 0
sr_80:
  s_mov_b64 exec, vcc
  buffer_load_dwordx4 v[124:127], v9, s[8:11], s56 offen sc1
  buffer_load_dwordx4 v[128:131], v9, s[8:11], s56 offen offset:1024 sc1
  buffer_load_dwordx4 v[132:135], v10, s[8:11], s56 offen sc1
  s_mov_b64 exec, -1
  s_add_u32 s54, s54, 1
  s_cmp_gt_u32 s54, 131072
  s_cbranch_scc1 end0
  s_waitcnt vmcnt(0)
  v_pk_add_f16 v164, v132, v133
  v_pk_add_f16 v165, v134, v135
  v_pk_add_f16 v120, v124, v126
  v_pk_add_f16 v122, v128, v130
  v_fma_mix_f32 v170, v164, 1.0, v165 op_sel:[0,0,0] op_sel_hi:[1,0,1]
  v_fma_mix_f32 v166, v120, 1.0, v122 op_sel:[0,0,0] op_sel_hi:[1,0,1]
  v_pk_add_f16 v121, v125, v127
  v_cmp_u_f32 vcc, v166, v170
  v_pk_add_f16 v123, v129, v131
  v_fma_mix_f32 v171, v164, 1.0, v165 op_sel:[1,0,1] op_sel_hi:[1,0,1]
  v_fma_mix_f32 v167, v120, 1.0, v122 op_sel:[1,0,1] op_sel_hi:[1,0,1]
  v_fma_mix_f32 v168, v121, 1.0, v123 op_sel:[0,0,0] op_sel_hi:[1,0,1]
  v_fma_mix_f32 v169, v121, 1.0, v123 op_sel:[1,0,1] op_sel_hi:[1,0,1]
  s_cbranch_vccz ex_67
  s_and_b32 s21, s54, 31
  s_cbranch_scc1 sr_80
  v_max3_u32 v27, v124, v126, v128
  v_max3_u32 v27, v27, v130, v132
  v_max3_u32 v27, v27, v133, v134
  v_max3_u32 v27, v27, v135, v135
  v_cmp_eq_u32 vcc, -1, v27
  s_nop 1
  s_cbranch_vccnz sr_80
ex_67:
  v_exp_f32 v176, v170
  v_exp_f32 v177, v171
  v_exp_f32 v172, v166
  v_cvt_pk_bf16_f32 v160, v176, v177
  v_exp_f32 v173, v167
  v_exp_f32 v174, v168
  v_mov_b32_dpp v161, v160 row_ror:8 row_mask:0xf bank_mask:0xf
  v_cvt_pk_bf16_f32 v156, v172, v173
  v_exp_f32 v175, v169
  v_mfma_f32_16x16x32_bf16 v[178:181], v[140:143], v[160:163], 0
  v_mov_b32_dpp v158, v156 row_ror:8 row_mask:0xf bank_mask:0xf
  v_cvt_pk_bf16_f32 v157, v174, v175
  v_mfma_f32_16x16x32_bf16 v[182:185], v[136:139], v[160:163], 0
  s_nop 0
  v_mov_b32_dpp v159, v157 row_ror:8 row_mask:0xf bank_mask:0xf
  v_mfma_f32_16x16x32_bf16 v[186:189], v[138:141], v[160:163], 0
  s_branch pv_66
fx_68:
  s_bitcmp1_b32 s81, 0
  s_cbranch_scc1 fk_69
  s_or_b32 s81, s81, 1
  s_mov_b64 exec, -1
  v_max3_f32 v164, v166, v167, v168
  v_max3_f32 v165, v169, v170, v171
  v_max_f32 v164, v164, v165
  s_nop 1
  v_max_f32_dpp v164, v164, v164 row_ror:8 row_mask:0xf bank_mask:0xf
  v_mov_b32 v165, v164
  s_nop 1
  v_permlane32_swap_b32 v164, v165
  v_max_f32 v164, v164, v165
  v_mov_b32 v165, v164
  s_nop 1
  v_permlane16_swap_b32 v164, v165
  v_max_f32 v164, v164, v165
  v_sub_f32 v166, v166, v164
  v_sub_f32 v167, v167, v164
  v_sub_f32 v168, v168, v164
  v_sub_f32 v169, v169, v164
  v_sub_f32 v170, v170, v164
  v_sub_f32 v171, v171, v164
  s_branch ex_67
p2_74:
  s_mov_b32 s54, 0
  buffer_load_dwordx4 v[68:71], v16, s[4:7], s60 offen sc1
  s_waitcnt vmcnt(1)
  v_mfma_f32_16x16x32_f16 v[120:123], v[44:47], v[72:75], 0
  v_bitop3_b32 v27, v72, s61, 1 bitop3:0x28
  v_cmp_ne_u32 vcc, 0, v27
  s_nop 1
  s_cbranch_vccz pg_73
  buffer_load_dwordx4 v[72:75], v16, s[4:7], s60 offen sc1
pp_72:
  s_waitcnt vmcnt(1)
  v_mfma_f32_16x16x32_f16 v[120:123], v[44:47], v[68:71], 0
  v_bitop3_b32 v27, v68, s61, 1 bitop3:0x28
  v_cmp_ne_u32 vcc, 0, v27
  s_nop 1
  s_cbranch_vccz pg_73
  buffer_load_dwordx4 v[68:71], v16, s[4:7], s60 offen sc1
  s_waitcnt vmcnt(1)
  v_mfma_f32_16x16x32_f16 v[120:123], v[44:47], v[72:75], 0
  v_bitop3_b32 v27, v72, s61, 1 bitop3:0x28
  v_cmp_ne_u32 vcc, 0, v27
  s_nop 1
  s_cbranch_vccz pg_73
  buffer_load_dwordx4 v[72:75], v16, s[4:7], s60 offen sc1
  s_add_u32 s54, s54, 1
  s_cmp_gt_u32 s54, 131072
  s_cbranch_scc1 end0
  s_branch pp_72
last_61:
  v_min_u32 v108, -2, v108
  buffer_store_dwordx2 v[108:109], v37, s[16:19], s70 offen offset:3072 sc1
  v_smfmac_f32_16x16x64_bf16 v[96:99], v[48:51], a[0:7], v22
  v_smfmac_f32_16x16x64_bf16 v[100:103], v[48:51], a[80:87], v22
  v_smfmac_f32_16x16x64_bf16 v[96:99], v[52:55], a[8:15], v22
  v_smfmac_f32_16x16x64_bf16 v[100:103], v[52:55], a[88:95], v22
  v_smfmac_f32_16x16x64_bf16 v[96:99], v[56:59], a[16:23], v22
  v_smfmac_f32_16x16x64_bf16 v[100:103], v[56:59], a[96:103], v22
  v_smfmac_f32_16x16x64_bf16 v[96:99], v[60:63], a[24:31], v22
  v_smfmac_f32_16x16x64_bf16 v[96:99], v[64:67], a[32:39], v22
  v_smfmac_f32_16x16x64_bf16 v[96:99], v[68:71], a[40:47], v22
  v_smfmac_f32_16x16x64_bf16 v[96:99], v[72:75], a[48:55], v22
  v_smfmac_f32_16x16x64_bf16 v[96:99], v[76:79], a[56:63], v22
  v_smfmac_f32_16x16x64_bf16 v[96:99], v[80:83], a[64:71], v22
  v_smfmac_f32_16x16x64_bf16 v[96:99], v[84:87], a[72:79], v22
  v_smfmac_f32_16x16x64_bf16 v[100:103], v[60:63], a[104:111], v22
  v_smfmac_f32_16x16x64_bf16 v[100:103], v[64:67], a[112:119], v22
  v_smfmac_f32_16x16x64_bf16 v[100:103], v[68:71], a[120:127], v22
  v_smfmac_f32_16x16x64_bf16 v[100:103], v[72:75], a[128:135], v22
  v_smfmac_f32_16x16x64_bf16 v[100:103], v[76:79], a[136:143], v22
  v_smfmac_f32_16x16x64_bf16 v[100:103], v[80:83], a[144:151], v22
  v_smfmac_f32_16x16x64_bf16 v[100:103], v[84:87], a[152:159], v22
  s_nop 7
  v_permlane32_swap_b32 v96, v100
  v_permlane32_swap_b32 v97, v101
  v_permlane32_swap_b32 v98, v102
  v_permlane32_swap_b32 v99, v103
  v_pk_add_f32 v[96:97], v[96:97], v[100:101]
  v_pk_add_f32 v[98:99], v[98:99], v[102:103]
  v_cvt_pk_bf16_f32 v100, v96, v97
  v_cvt_pk_bf16_f32 v101, v98, v99
  s_nop 0
  v_permlane32_swap_b32 v100, v102
  v_permlane32_swap_b32 v101, v103
  v_min_u32 v100, -2, v100
  buffer_store_dwordx4 v[100:103], v26, s[16:19], s70 offen sc1
  s_waitcnt vmcnt(0)
  s_barrier
  s_branch chain_done
E_30:
  v_add_u32 v190, 5120, v4
  ds_write_b64 v6, v[28:29]
  ds_write_b32 v13, v28
  ds_write_b32 v14, v28
  s_waitcnt vmcnt(0)
  ds_write_b128 v190, v[68:71] offset:0
  ds_write_b128 v190, v[72:75] offset:1024
  s_waitcnt lgkmcnt(0)
  s_add_u32 m0, s74, 8192
  s_add_u32 s21, s72, 0
  buffer_load_dwordx4 v32, s[16:19], s21 offen sc1 lds
  s_add_u32 m0, s74, 6144
  s_mul_i32 s21, s91, 3
  s_add_u32 s21, s21, s71
  buffer_load_dwordx4 v4, s[16:19], s21 offen sc1 lds
  s_xor_b32 s74, s74, 16384
  s_add_u32 s73, s73, 2097152
  s_xor_b32 s73, s73, 8192
  s_add_u32 s79, s79, 2097152
  s_xor_b32 s79, s79, 8192
  s_add_u32 s21, s72, 524288
  s_xor_b32 s72, s72, s21
  s_lshr_b32 s72, s72, 8
  s_and_b32 s72, s72, 8192
  s_xor_b32 s72, s72, s21
  s_add_u32 s71, s73, 4096
  s_mov_b32 s91, 1024
  s_sub_u32 s21, s73, 0
  s_cmp_lt_u32 s21, 125829120
  s_cselect_b32 s71, s71, s79
  s_cselect_b32 s91, s91, 65536
  s_branch mo_87
  .p2align 3
top_82:
  s_waitcnt vmcnt(1)
  ds_write_b128 v190, v[68:71] offset:0
  v_cmp_eq_u32 s[22:23], -1, v68
  s_waitcnt vmcnt(0)
  ds_write_b128 v190, v[72:75] offset:1024
  v_cmp_eq_u32 s[98:99], -1, v72
  s_or_b64 vcc, s[22:23], s[98:99]
  s_cbranch_scc1 mr_83
mo_87:
  s_barrier
  ds_read_b128 v[48:51], v4 offset:0
  ds_read_b128 v[52:55], v4 offset:1024
  v_smfmac_f32_16x16x64_bf16 v[92:95], v[68:71], v[216:223], v22
  ds_read_b128 v[56:59], v4 offset:2048
  v_smfmac_f32_16x16x64_bf16 v[88:91], v[68:71], a[200:207], v22
  ds_read_b128 v[60:63], v4 offset:3072
  v_smfmac_f32_16x16x64_bf16 v[92:95], v[72:75], v[224:231], v22
  ds_read_b128 v[64:67], v4 offset:4096
  v_smfmac_f32_16x16x64_bf16 v[88:91], v[72:75], a[208:215], v22
  s_waitcnt lgkmcnt(4)
  ds_read_b128 v[76:79], v4 offset:7168
  v_smfmac_f32_16x16x64_bf16 v[92:95], v[48:51], a[240:247], v22
  ds_read_b128 v[80:83], v4 offset:8192
  v_smfmac_f32_16x16x64_bf16 v[88:91], v[48:51], a[160:167], v22
  s_waitcnt lgkmcnt(5)
  ds_read_b128 v[84:87], v4 offset:9216
  v_smfmac_f32_16x16x64_bf16 v[92:95], v[52:55], a[248:255], v22
  v_smfmac_f32_16x16x64_bf16 v[88:91], v[52:55], a[168:175], v22
  s_waitcnt lgkmcnt(5)
  v_smfmac_f32_16x16x64_bf16 v[92:95], v[56:59], v[192:199], v22
  s_waitcnt lgkmcnt(4)
  v_smfmac_f32_16x16x64_bf16 v[92:95], v[60:63], v[200:207], v22
  s_waitcnt lgkmcnt(3)
  v_smfmac_f32_16x16x64_bf16 v[92:95], v[64:67], v[208:215], v22
  s_waitcnt lgkmcnt(2)
  v_smfmac_f32_16x16x64_bf16 v[92:95], v[76:79], v[232:239], v22
  s_waitcnt lgkmcnt(1)
  v_smfmac_f32_16x16x64_bf16 v[92:95], v[80:83], v[240:247], v22
  s_waitcnt lgkmcnt(0)
  v_smfmac_f32_16x16x64_bf16 v[92:95], v[84:87], v[248:255], v22
  v_smfmac_f32_16x16x64_bf16 v[88:91], v[56:59], a[176:183], v22
  v_smfmac_f32_16x16x64_bf16 v[88:91], v[60:63], a[184:191], v22
  v_smfmac_f32_16x16x64_bf16 v[88:91], v[64:67], a[192:199], v22
  v_permlane32_swap_b32 v92, v93
  v_smfmac_f32_16x16x64_bf16 v[88:91], v[76:79], a[216:223], v22
  v_permlane32_swap_b32 v94, v95
  v_smfmac_f32_16x16x64_bf16 v[88:91], v[80:83], a[224:231], v22
  v_permlane32_swap_b32 v93, v92
  v_smfmac_f32_16x16x64_bf16 v[88:91], v[84:87], a[232:239], v22
  v_permlane32_swap_b32 v95, v94
  v_pk_mul_f32 v[120:121], v[92:93], v[24:25] op_sel:[1,0] op_sel_hi:[0,1]
  v_pk_mul_f32 v[122:123], v[94:95], v[24:25] op_sel:[1,0] op_sel_hi:[0,1]
  s_nop 4
  v_pk_fma_f32 v[88:89], v[88:89], v[24:25], v[120:121]
  v_pk_fma_f32 v[90:91], v[90:91], v[24:25], v[122:123]
  v_cvt_pk_bf16_f32 v120, v88, v89
  v_cvt_pk_bf16_f32 v121, v90, v91
  ds_write_b64 v6, v[120:121]
  s_barrier
  ds_read_b64_tr_b16 v[104:105], v7 offset:0
  ds_read_b64_tr_b16 v[106:107], v7 offset:768
  ds_read_b64_tr_b16 v[108:109], v7 offset:1536
  s_waitcnt lgkmcnt(1)
  v_mfma_f32_16x16x32_bf16 v[120:123], v[104:107], v[104:107], 0
  s_waitcnt lgkmcnt(0)
  v_mfma_f32_16x16x32_bf16 v[120:123], v[108:111], v[108:111], v[120:123]
  s_mov_b64 exec, s[64:65]
  s_nop 6
  v_cmpx_o_f32 vcc, v120, v121
  v_cvt_pk_f16_f32 v120, v120, v121
  buffer_store_dword v120, v8, s[8:11], s56 offen
  v_cmpx_o_f32 vcc, v122, v123
  v_cvt_pk_f16_f32 v121, v122, v123
  buffer_store_dword v121, v8, s[8:11], s56 offen offset:128
  s_xor_b64 s[98:99], exec, s[64:65]
  s_mov_b64 exec, -1
  s_waitcnt lgkmcnt(0)
  s_barrier
  ds_read_b64_tr_b16 v[104:105], v7 offset:0
  ds_read_b64_tr_b16 v[106:107], v7 offset:768
  ds_read_b64_tr_b16 v[108:109], v7 offset:1536
  ds_read_b32 v27, v12 offset:12544
  ds_read_b64 v[140:141], v11
  s_waitcnt lgkmcnt(1)
  v_cmp_u_f32 vcc, v104, v106
  v_cmp_u_f32 s[22:23], v108, v27
  s_nop 1
  s_or_b64 vcc, vcc, s[22:23]
  s_cbranch_vccnz mn_84
mk_85:
  s_cmp_eq_u32 s52, 63
  s_cbranch_scc1 last_86
  s_cmp_lg_u64 s[98:99], 0
  s_cbranch_scc1 sf_88
sf_89:
  s_nop 15
  s_nop 10
  v_smfmac_f32_16x16x64_bf16 v[96:99], v[48:51], a[0:7], v22
  v_smfmac_f32_16x16x64_bf16 v[100:103], v[48:51], a[80:87], v22
  v_smfmac_f32_16x16x64_bf16 v[96:99], v[52:55], a[8:15], v22
  v_smfmac_f32_16x16x64_bf16 v[100:103], v[52:55], a[88:95], v22
  v_smfmac_f32_16x16x64_bf16 v[96:99], v[56:59], a[16:23], v22
  v_smfmac_f32_16x16x64_bf16 v[100:103], v[56:59], a[96:103], v22
  buffer_load_dwordx4 v[132:135], v10, s[8:11], s56 offen sc1
  v_smfmac_f32_16x16x64_bf16 v[96:99], v[60:63], a[24:31], v22
  buffer_load_dwordx4 v[124:127], v9, s[8:11], s56 offen sc1
  v_smfmac_f32_16x16x64_bf16 v[96:99], v[64:67], a[32:39], v22
  buffer_load_dwordx4 v[128:131], v9, s[8:11], s56 offen offset:1024 sc1
  v_smfmac_f32_16x16x64_bf16 v[96:99], v[68:71], a[40:47], v22
  v_smfmac_f32_16x16x64_bf16 v[96:99], v[72:75], a[48:55], v22
  v_smfmac_f32_16x16x64_bf16 v[96:99], v[76:79], a[56:63], v22
  v_smfmac_f32_16x16x64_bf16 v[96:99], v[80:83], a[64:71], v22
  v_smfmac_f32_16x16x64_bf16 v[96:99], v[84:87], a[72:79], v22
  v_smfmac_f32_16x16x64_bf16 v[100:103], v[60:63], a[104:111], v22
  v_smfmac_f32_16x16x64_bf16 v[100:103], v[64:67], a[112:119], v22
  v_smfmac_f32_16x16x64_bf16 v[100:103], v[68:71], a[120:127], v22
  v_smfmac_f32_16x16x64_bf16 v[100:103], v[72:75], a[128:135], v22
  v_cvt_pk_bf16_f32 v136, v96, v97
  v_smfmac_f32_16x16x64_bf16 v[100:103], v[76:79], a[136:143], v22
  v_cvt_pk_bf16_f32 v137, v98, v99
  v_smfmac_f32_16x16x64_bf16 v[100:103], v[80:83], a[144:151], v22
  v_smfmac_f32_16x16x64_bf16 v[100:103], v[84:87], a[152:159], v22
  s_nop 7
  v_cvt_pk_bf16_f32 v138, v100, v101
  v_cvt_pk_bf16_f32 v139, v102, v103
  s_waitcnt vmcnt(2) lgkmcnt(0)
  v_pk_add_f16 v164, v132, v133
  v_pk_add_f16 v165, v134, v135
  v_fma_mix_f32 v170, v164, 1.0, v165 op_sel:[0,0,0] op_sel_hi:[1,0,1]
  v_fma_mix_f32 v171, v164, 1.0, v165 op_sel:[1,0,1] op_sel_hi:[1,0,1]
  v_exp_f32 v176, v170
  v_exp_f32 v177, v171
  s_waitcnt vmcnt(1)
  v_cvt_pk_bf16_f32 v160, v176, v177
  v_pk_add_f16 v120, v124, v126
  v_pk_add_f16 v121, v125, v127
  v_mov_b32_dpp v161, v160 row_ror:8 row_mask:0xf bank_mask:0xf
  s_waitcnt vmcnt(0)
  v_pk_add_f16 v122, v128, v130
  v_mfma_f32_16x16x32_bf16 v[178:181], v[140:143], v[160:163], 0
  v_fma_mix_f32 v166, v120, 1.0, v122 op_sel:[0,0,0] op_sel_hi:[1,0,1]
  v_fma_mix_f32 v167, v120, 1.0, v122 op_sel:[1,0,1] op_sel_hi:[1,0,1]
  v_cmp_u_f32 vcc, v166, v170
  v_pk_add_f16 v123, v129, v131
  v_exp_f32 v172, v166
  v_mfma_f32_16x16x32_bf16 v[182:185], v[136:139], v[160:163], 0
  s_cbranch_vccnz sr_90
  v_exp_f32 v173, v167
  v_fma_mix_f32 v168, v121, 1.0, v123 op_sel:[0,0,0] op_sel_hi:[1,0,1]
  v_fma_mix_f32 v169, v121, 1.0, v123 op_sel:[1,0,1] op_sel_hi:[1,0,1]
  v_cvt_pk_bf16_f32 v156, v172, v173
  v_exp_f32 v174, v168
  v_exp_f32 v175, v169
  v_mov_b32_dpp v158, v156 row_ror:8 row_mask:0xf bank_mask:0xf
  v_cvt_pk_bf16_f32 v157, v174, v175
  v_mfma_f32_16x16x32_bf16 v[186:189], v[138:141], v[160:163], 0
  s_nop 0
  v_mov_b32_dpp v159, v157 row_ror:8 row_mask:0xf bank_mask:0xf
  s_nop 1
pv_91:
  v_mfma_f32_16x16x32_bf16 v[178:181], v[152:155], v[156:159], v[178:181]
  v_mfma_f32_16x16x32_bf16 v[182:185], v[144:147], v[156:159], v[182:185]
  v_mfma_f32_16x16x32_bf16 v[186:189], v[148:151], v[156:159], v[186:189]
  s_mov_b64 exec, s[62:63]
  s_nop 0
  v_rcp_f32 v164, v180
  v_cmp_ngt_f32 s[22:23], s80, v180
  v_cmp_ngt_f32 vcc, s80, v164
  v_pk_mul_f32 v[182:183], v[182:183], v[164:165] op_sel_hi:[1,0]
  v_pk_mul_f32 v[184:185], v[184:185], v[164:165] op_sel_hi:[1,0]
  v_pk_mul_f32 v[178:179], v[178:179], v[164:165] op_sel_hi:[1,0]
  v_pk_mul_f32 v[186:187], v[186:187], v[164:165] op_sel_hi:[1,0]
  v_pk_mul_f32 v[188:189], v[188:189], v[164:165] op_sel_hi:[1,0]
  v_cvt_pk_f16_f32 v64, v178, v179
  s_or_b64 vcc, vcc, s[22:23]
  s_cbranch_scc1 fx_93
fk_94:
  ds_write_b32 v14, v64
  v_cvt_pk_f16_f32 v60, v182, v183
  v_cvt_pk_f16_f32 v61, v184, v185
  v_cvt_pk_f16_f32 v62, v186, v187
  v_cvt_pk_f16_f32 v63, v188, v189
  ds_write_b128 v13, v[60:63]
  s_barrier
  s_mov_b64 exec, -1
  s_and_b32 s21, s52, 3
  s_cmp_lt_u32 s52, 58
  s_cselect_b32 s21, s21, 0
  s_cmp_lg_u32 s21, 0
  s_cbranch_scc1 fs_95
  v_mov_b32 v27, s52
  s_mov_b64 exec, 1
  buffer_store_dword v27, v23, s[12:15], s77 offen sc1
  s_mov_b64 exec, -1
fs_95:
  s_add_u32 m0, s74, 8192
  s_add_u32 s21, s72, 0
  buffer_load_dwordx4 v32, s[16:19], s21 offen sc1 lds
  s_add_u32 m0, s74, 6144
  s_mul_i32 s21, s91, 3
  s_add_u32 s21, s21, s71
  buffer_load_dwordx4 v4, s[16:19], s21 offen sc1 lds
  s_xor_b32 s74, s74, 16384
  s_add_u32 s73, s73, 2097152
  s_xor_b32 s73, s73, 8192
  s_add_u32 s79, s79, 2097152
  s_xor_b32 s79, s79, 8192
  s_add_u32 s21, s72, 524288
  s_xor_b32 s72, s72, s21
  s_lshr_b32 s72, s72, 8
  s_and_b32 s72, s72, 8192
  s_xor_b32 s72, s72, s21
  s_add_u32 s71, s73, 4096
  s_mov_b32 s91, 1024
  s_sub_u32 s21, s73, 0
  s_cmp_lt_u32 s21, 125829120
  s_cselect_b32 s71, s71, s79
  s_cselect_b32 s91, s91, 65536
  v_permlane32_swap_b32 v96, v100
  v_permlane32_swap_b32 v97, v101
  v_permlane32_swap_b32 v98, v102
  v_permlane32_swap_b32 v99, v103
  v_pk_add_f32 v[96:97], v[96:97], v[100:101]
  v_pk_add_f32 v[98:99], v[98:99], v[102:103]
  v_cvt_pk_bf16_f32 v100, v96, v97
  v_cvt_pk_bf16_f32 v101, v98, v99
  s_nop 0
  v_permlane32_swap_b32 v100, v102
  v_permlane32_swap_b32 v101, v103
  v_min_u32 v100, -2, v100
  s_nop 6
  buffer_store_dwordx4 v[100:103], v26, s[16:19], s70 offen sc1
  s_add_u32 s70, s70, 2097152
  s_xor_b32 s70, s70, 8192
  ds_read_b128 v[144:147], v18
  ds_read_b128 v[148:151], v18 offset:1024
  ds_read_b128 v[152:155], v19
  v_xor_b32 v18, 16384, v18
  v_xor_b32 v19, 16384, v19
  v_mov_b32 v88, 0
  v_mov_b32 v89, 0
  v_mov_b32 v90, 0
  v_mov_b32 v91, 0
  v_mov_b32 v92, 0
  v_mov_b32 v93, 0
  v_mov_b32 v94, 0
  v_mov_b32 v95, 0
  v_mov_b32 v96, 0
  v_mov_b32 v97, 0
  v_mov_b32 v98, 0
  v_mov_b32 v99, 0
  v_mov_b32 v100, 0
  v_mov_b32 v101, 0
  v_mov_b32 v102, 0
  v_mov_b32 v103, 0
  s_mov_b32 s81, 0
  s_waitcnt lgkmcnt(0)
  s_barrier
  s_mov_b64 exec, s[64:65]
  buffer_store_dword v28, v8, s[8:11], s57 offen
  buffer_store_dword v28, v8, s[8:11], s57 offen offset:128
  s_mov_b64 exec, -1
  ds_write_b128 v190, v[28:31] offset:0
  ds_write_b128 v190, v[28:31] offset:1024
  ds_write_b64 v6, v[28:29]
  s_mov_b64 exec, -1
  s_cmp_eq_u32 s78, 0
  s_cbranch_scc1 nt_97
  s_mov_b64 exec, s[62:63]
  buffer_store_dword v28, v17, s[8:11], s59 offen
  s_mov_b64 exec, -1
  s_sleep 3
  s_nop 1
  buffer_load_dwordx4 v[68:71], v16, s[4:7], s60 offen sc1
  s_sleep 3
  s_nop 1
  buffer_load_dwordx4 v[72:75], v16, s[4:7], s60 offen sc1
  s_waitcnt vmcnt(1)
  v_mfma_f32_16x16x32_f16 v[120:123], v[44:47], v[68:71], 0
  v_bitop3_b32 v27, v68, s61, 1 bitop3:0x28
  v_cmp_ne_u32 vcc, 0, v27
  s_nop 1
  s_cbranch_vccnz p2_100
  s_nop 2
pg_99:
  v_add_f32_dpp v120, v120, v120 row_ror:8 row_mask:0xf bank_mask:0xf
  v_add_f32_dpp v121, v121, v121 row_ror:8 row_mask:0xf bank_mask:0xf
  s_mov_b64 exec, s[62:63]
  v_cvt_pk_bf16_f32 v120, v120, v121
  v_min_u32 v120, -2, v120
  buffer_store_dword v120, v17, s[8:11], s55 offen
  s_mov_b64 exec, -1
nt_96:
  s_barrier
  s_mov_b32 s58, s55
  s_add_u32 s52, s52, 1
  ds_write_b32 v13, v28
  ds_write_b32 v14, v28
  s_and_b32 s21, s52, 3
  s_mul_i32 s56, s21, 122880
  s_add_u32 s21, s52, 1
  s_and_b32 s21, s21, 3
  s_mul_i32 s55, s21, 122880
  s_add_u32 s55, s55, s75
  s_add_u32 s21, s52, 2
  s_and_b32 s21, s21, 3
  s_mul_i32 s57, s21, 122880
  s_add_u32 s21, s52, 3
  s_and_b32 s21, s21, 3
  s_mul_i32 s59, s21, 122880
  s_add_u32 s59, s59, s75
  s_bfe_u32 s61, s52, 0x10002
  s_and_b32 s21, s52, 3
  s_lshl_b32 s60, s21, 18
  s_mov_b32 s54, 0
  s_sleep 2
  s_nop 10
  s_waitcnt lgkmcnt(0)
  buffer_load_dwordx4 v[68:71], v190, s[8:11], s58 offen offset:0 sc1
  buffer_load_dwordx4 v[72:75], v190, s[8:11], s58 offen offset:1024 sc1
  s_branch top_82
mr_83:
  s_mov_b64 exec, s[22:23]
  s_cbranch_execz ms_101
  buffer_load_dwordx4 v[68:71], v190, s[8:11], s58 offen offset:0 sc1
ms_101:
  s_mov_b64 exec, s[98:99]
  s_cbranch_execz ms_102
  buffer_load_dwordx4 v[72:75], v190, s[8:11], s58 offen offset:1024 sc1
ms_102:
  s_add_u32 s54, s54, 1
  s_cmp_gt_u32 s54, 131072
  s_cbranch_scc1 end0
  s_waitcnt vmcnt(0)
  s_mov_b64 exec, s[22:23]
  ds_write_b128 v190, v[68:71] offset:0
  v_cmp_eq_u32 s[22:23], -1, v68
  s_mov_b64 exec, s[98:99]
  ds_write_b128 v190, v[72:75] offset:1024
  v_cmp_eq_u32 s[98:99], -1, v72
  s_mov_b64 exec, -1
  s_or_b64 vcc, s[22:23], s[98:99]
  s_cbranch_scc1 mr_83
  s_branch mo_87
sf_88:
  s_waitcnt lgkmcnt(1)
  v_mfma_f32_16x16x32_bf16 v[120:123], v[104:107], v[104:107], 0
  s_waitcnt lgkmcnt(0)
  v_mfma_f32_16x16x32_bf16 v[120:123], v[108:111], v[108:111], v[120:123]
  s_mov_b64 exec, s[64:65]
  s_nop 6
  v_cvt_pk_f16_f32 v120, v120, v121
  buffer_store_dword v120, v8, s[8:11], s56 offen
  v_cvt_pk_f16_f32 v121, v122, v123
  buffer_store_dword v121, v8, s[8:11], s56 offen offset:128
  s_mov_b64 exec, -1
  s_branch sf_89
mn_84:
  s_bitcmp1_b32 s81, 1
  s_cbranch_scc1 mk_85
  s_or_b32 s81, s81, 2
  s_nop 7
  v_mov_b32 v88, 0
  v_mov_b32 v89, 0
  v_mov_b32 v90, 0
  v_mov_b32 v91, 0
  v_mov_b32 v92, 0
  v_mov_b32 v93, 0
  v_mov_b32 v94, 0
  v_mov_b32 v95, 0
  v_mov_b32 v96, 0
  v_mov_b32 v97, 0
  v_mov_b32 v98, 0
  v_mov_b32 v99, 0
  v_mov_b32 v100, 0
  v_mov_b32 v101, 0
  v_mov_b32 v102, 0
  v_mov_b32 v103, 0
  s_cmp_eq_u32 s52, 0
  s_cbranch_scc1 mx_104
mx_103:
  buffer_load_dwordx4 v[68:71], v190, s[8:11], s58 offen offset:0 sc1
  buffer_load_dwordx4 v[72:75], v190, s[8:11], s58 offen offset:1024 sc1
  s_add_u32 s54, s54, 1
  s_cmp_gt_u32 s54, 131072
  s_cbranch_scc1 end0
  s_waitcnt vmcnt(0)
  v_max3_u32 v27, v68, v69, v70
  v_max3_u32 v27, v27, v71, v72
  v_max3_u32 v27, v27, v73, v74
  v_max3_u32 v27, v27, v75, v75
  v_cmp_eq_u32 vcc, -1, v27
  s_nop 1
  s_cbranch_vccnz mx_103
  ds_write_b128 v190, v[68:71] offset:0
  ds_write_b128 v190, v[72:75] offset:1024
mx_104:
  s_waitcnt lgkmcnt(0)
  s_branch mo_87
sr_90:
  s_mov_b32 s54, 0
sr_105:
  s_mov_b64 exec, vcc
  buffer_load_dwordx4 v[124:127], v9, s[8:11], s56 offen sc1
  buffer_load_dwordx4 v[128:131], v9, s[8:11], s56 offen offset:1024 sc1
  buffer_load_dwordx4 v[132:135], v10, s[8:11], s56 offen sc1
  s_mov_b64 exec, -1
  s_add_u32 s54, s54, 1
  s_cmp_gt_u32 s54, 131072
  s_cbranch_scc1 end0
  s_waitcnt vmcnt(0)
  v_pk_add_f16 v164, v132, v133
  v_pk_add_f16 v165, v134, v135
  v_pk_add_f16 v120, v124, v126
  v_pk_add_f16 v122, v128, v130
  v_fma_mix_f32 v170, v164, 1.0, v165 op_sel:[0,0,0] op_sel_hi:[1,0,1]
  v_fma_mix_f32 v166, v120, 1.0, v122 op_sel:[0,0,0] op_sel_hi:[1,0,1]
  v_pk_add_f16 v121, v125, v127
  v_cmp_u_f32 vcc, v166, v170
  v_pk_add_f16 v123, v129, v131
  v_fma_mix_f32 v171, v164, 1.0, v165 op_sel:[1,0,1] op_sel_hi:[1,0,1]
  v_fma_mix_f32 v167, v120, 1.0, v122 op_sel:[1,0,1] op_sel_hi:[1,0,1]
  v_fma_mix_f32 v168, v121, 1.0, v123 op_sel:[0,0,0] op_sel_hi:[1,0,1]
  v_fma_mix_f32 v169, v121, 1.0, v123 op_sel:[1,0,1] op_sel_hi:[1,0,1]
  s_cbranch_vccz ex_92
  s_and_b32 s21, s54, 31
  s_cbranch_scc1 sr_105
  v_max3_u32 v27, v124, v126, v128
  v_max3_u32 v27, v27, v130, v132
  v_max3_u32 v27, v27, v133, v134
  v_max3_u32 v27, v27, v135, v135
  v_cmp_eq_u32 vcc, -1, v27
  s_nop 1
  s_cbranch_vccnz sr_105
ex_92:
  v_exp_f32 v176, v170
  v_exp_f32 v177, v171
  v_exp_f32 v172, v166
  v_cvt_pk_bf16_f32 v160, v176, v177
  v_exp_f32 v173, v167
  v_exp_f32 v174, v168
  v_mov_b32_dpp v161, v160 row_ror:8 row_mask:0xf bank_mask:0xf
  v_cvt_pk_bf16_f32 v156, v172, v173
  v_exp_f32 v175, v169
  v_mfma_f32_16x16x32_bf16 v[178:181], v[140:143], v[160:163], 0
  v_mov_b32_dpp v158, v156 row_ror:8 row_mask:0xf bank_mask:0xf
  v_cvt_pk_bf16_f32 v157, v174, v175
  v_mfma_f32_16x16x32_bf16 v[182:185], v[136:139], v[160:163], 0
  s_nop 0
  v_mov_b32_dpp v159, v157 row_ror:8 row_mask:0xf bank_mask:0xf
  v_mfma_f32_16x16x32_bf16 v[186:189], v[138:141], v[160:163], 0
  s_branch pv_91
fx_93:
  s_bitcmp1_b32 s81, 0
  s_cbranch_scc1 fk_94
  s_or_b32 s81, s81, 1
  s_mov_b64 exec, -1
  v_max3_f32 v164, v166, v167, v168
  v_max3_f32 v165, v169, v170, v171
  v_max_f32 v164, v164, v165
  s_nop 1
  v_max_f32_dpp v164, v164, v164 row_ror:8 row_mask:0xf bank_mask:0xf
  v_mov_b32 v165, v164
  s_nop 1
  v_permlane32_swap_b32 v164, v165
  v_max_f32 v164, v164, v165
  v_mov_b32 v165, v164
  s_nop 1
  v_permlane16_swap_b32 v164, v165
  v_max_f32 v164, v164, v165
  v_sub_f32 v166, v166, v164
  v_sub_f32 v167, v167, v164
  v_sub_f32 v168, v168, v164
  v_sub_f32 v169, v169, v164
  v_sub_f32 v170, v170, v164
  v_sub_f32 v171, v171, v164
  s_branch ex_92
nt_97:
  s_branch nt_96
p2_100:
  s_mov_b32 s54, 0
  buffer_load_dwordx4 v[68:71], v16, s[4:7], s60 offen sc1
  s_waitcnt vmcnt(1)
  v_mfma_f32_16x16x32_f16 v[120:123], v[44:47], v[72:75], 0
  v_bitop3_b32 v27, v72, s61, 1 bitop3:0x28
  v_cmp_ne_u32 vcc, 0, v27
  s_nop 1
  s_cbranch_vccz pg_99
  buffer_load_dwordx4 v[72:75], v16, s[4:7], s60 offen sc1
pp_98:
  s_waitcnt vmcnt(1)
  v_mfma_f32_16x16x32_f16 v[120:123], v[44:47], v[68:71], 0
  v_bitop3_b32 v27, v68, s61, 1 bitop3:0x28
  v_cmp_ne_u32 vcc, 0, v27
  s_nop 1
  s_cbranch_vccz pg_99
  buffer_load_dwordx4 v[68:71], v16, s[4:7], s60 offen sc1
  s_waitcnt vmcnt(1)
  v_mfma_f32_16x16x32_f16 v[120:123], v[44:47], v[72:75], 0
  v_bitop3_b32 v27, v72, s61, 1 bitop3:0x28
  v_cmp_ne_u32 vcc, 0, v27
  s_nop 1
  s_cbranch_vccz pg_99
  buffer_load_dwordx4 v[72:75], v16, s[4:7], s60 offen sc1
  s_add_u32 s54, s54, 1
  s_cmp_gt_u32 s54, 131072
  s_cbranch_scc1 end0
  s_branch pp_98
last_86:
  v_smfmac_f32_16x16x64_bf16 v[96:99], v[48:51], a[0:7], v22
  v_smfmac_f32_16x16x64_bf16 v[100:103], v[48:51], a[80:87], v22
  v_smfmac_f32_16x16x64_bf16 v[96:99], v[52:55], a[8:15], v22
  v_smfmac_f32_16x16x64_bf16 v[100:103], v[52:55], a[88:95], v22
  v_smfmac_f32_16x16x64_bf16 v[96:99], v[56:59], a[16:23], v22
  v_smfmac_f32_16x16x64_bf16 v[100:103], v[56:59], a[96:103], v22
  v_smfmac_f32_16x16x64_bf16 v[96:99], v[60:63], a[24:31], v22
  v_smfmac_f32_16x16x64_bf16 v[96:99], v[64:67], a[32:39], v22
  v_smfmac_f32_16x16x64_bf16 v[96:99], v[68:71], a[40:47], v22
  v_smfmac_f32_16x16x64_bf16 v[96:99], v[72:75], a[48:55], v22
  v_smfmac_f32_16x16x64_bf16 v[96:99], v[76:79], a[56:63], v22
  v_smfmac_f32_16x16x64_bf16 v[96:99], v[80:83], a[64:71], v22
  v_smfmac_f32_16x16x64_bf16 v[96:99], v[84:87], a[72:79], v22
  v_smfmac_f32_16x16x64_bf16 v[100:103], v[60:63], a[104:111], v22
  v_smfmac_f32_16x16x64_bf16 v[100:103], v[64:67], a[112:119], v22
  v_smfmac_f32_16x16x64_bf16 v[100:103], v[68:71], a[120:127], v22
  v_smfmac_f32_16x16x64_bf16 v[100:103], v[72:75], a[128:135], v22
  v_smfmac_f32_16x16x64_bf16 v[100:103], v[76:79], a[136:143], v22
  v_smfmac_f32_16x16x64_bf16 v[100:103], v[80:83], a[144:151], v22
  v_smfmac_f32_16x16x64_bf16 v[100:103], v[84:87], a[152:159], v22
  s_nop 7
  v_permlane32_swap_b32 v96, v100
  v_permlane32_swap_b32 v97, v101
  v_permlane32_swap_b32 v98, v102
  v_permlane32_swap_b32 v99, v103
  v_pk_add_f32 v[96:97], v[96:97], v[100:101]
  v_pk_add_f32 v[98:99], v[98:99], v[102:103]
  v_cvt_pk_bf16_f32 v100, v96, v97
  v_cvt_pk_bf16_f32 v101, v98, v99
  s_nop 0
  v_permlane32_swap_b32 v100, v102
  v_permlane32_swap_b32 v101, v103
  v_min_u32 v100, -2, v100
  buffer_store_dwordx4 v[100:103], v26, s[16:19], s70 offen sc1
  s_waitcnt vmcnt(0)
  s_barrier
  s_branch chain_done
E_32:
  v_add_u32 v190, 7168, v4
  ds_write_b32 v13, v28
  ds_write_b32 v14, v28
  s_waitcnt vmcnt(0)
  ds_write_b128 v190, v[76:79] offset:0
  ds_write_b128 v190, v[80:83] offset:1024
  ds_write_b128 v190, v[84:87] offset:2048
  s_waitcnt lgkmcnt(0)
  s_branch mo_112
  .p2align 3
top_107:
  s_waitcnt vmcnt(2)
  ds_write_b128 v190, v[76:79] offset:0
  v_cmp_eq_u32 s[22:23], -1, v76
  s_waitcnt vmcnt(1)
  ds_write_b128 v190, v[80:83] offset:1024
  v_cmp_eq_u32 s[98:99], -1, v80
  s_waitcnt vmcnt(0)
  ds_write_b128 v190, v[84:87] offset:2048
  v_cmp_eq_u32 s[100:101], -1, v84
  s_or_b64 vcc, s[22:23], s[98:99]
  s_or_b64 vcc, vcc, s[100:101]
  s_cbranch_scc1 mr_108
mo_112:
  s_barrier
  ds_read_b128 v[48:51], v4 offset:0
  ds_read_b128 v[52:55], v4 offset:1024
  v_smfmac_f32_16x16x64_bf16 v[92:95], v[76:79], v[232:239], v22
  ds_read_b128 v[56:59], v4 offset:2048
  ds_read_b128 v[60:63], v4 offset:3072
  v_smfmac_f32_16x16x64_bf16 v[88:91], v[76:79], a[216:223], v22
  s_add_u32 m0, s74, 0
  s_add_u32 s21, s79, 0
  buffer_load_dwordx4 v4, s[16:19], s21 offen offset:1024 sc1 lds
  v_smfmac_f32_16x16x64_bf16 v[92:95], v[80:83], v[240:247], v22
  ds_read_b128 v[64:67], v4 offset:4096
  ds_read_b128 v[68:71], v4 offset:5120
  s_add_u32 s22, s52, 3
  s_min_u32 s22, s22, 64
  v_smfmac_f32_16x16x64_bf16 v[88:91], v[80:83], a[224:231], v22
  s_add_u32 m0, s74, 2048
  s_add_u32 s21, s79, 65536
  buffer_load_dwordx4 v4, s[16:19], s21 offen offset:1024 sc1 lds
  v_cmp_gt_u32 vcc, s22, v42
  v_smfmac_f32_16x16x64_bf16 v[92:95], v[84:87], v[248:255], v22
  ds_read_b128 v[72:75], v4 offset:6144
  s_cbranch_vccnz kw_113
kv_114:
  v_smfmac_f32_16x16x64_bf16 v[88:91], v[84:87], a[232:239], v22
  s_waitcnt lgkmcnt(6)
  s_add_u32 m0, s74, 10240
  s_nop 0
  buffer_load_dwordx4 v4, s[16:19], s73 offen offset:0 sc1 lds
  v_smfmac_f32_16x16x64_bf16 v[92:95], v[48:51], a[240:247], v22
  v_smfmac_f32_16x16x64_bf16 v[88:91], v[48:51], a[160:167], v22
  s_waitcnt lgkmcnt(5)
  s_add_u32 m0, s74, 10240
  s_nop 0
  buffer_load_dwordx4 v4, s[16:19], s73 offen offset:1024 sc1 lds
  v_smfmac_f32_16x16x64_bf16 v[92:95], v[52:55], a[248:255], v22
  s_waitcnt lgkmcnt(4)
  v_smfmac_f32_16x16x64_bf16 v[92:95], v[56:59], v[192:199], v22
  s_waitcnt lgkmcnt(3)
  s_add_u32 m0, s74, 10240
  s_nop 0
  buffer_load_dwordx4 v4, s[16:19], s73 offen offset:2048 sc1 lds
  v_smfmac_f32_16x16x64_bf16 v[92:95], v[60:63], v[200:207], v22
  s_waitcnt lgkmcnt(2)
  v_smfmac_f32_16x16x64_bf16 v[92:95], v[64:67], v[208:215], v22
  s_waitcnt lgkmcnt(1)
  s_add_u32 m0, s74, 0
  s_mul_i32 s21, s91, 0
  s_add_u32 s21, s21, s71
  buffer_load_dwordx4 v4, s[16:19], s21 offen sc1 lds
  v_smfmac_f32_16x16x64_bf16 v[92:95], v[68:71], v[216:223], v22
  s_waitcnt lgkmcnt(0)
  v_smfmac_f32_16x16x64_bf16 v[92:95], v[72:75], v[224:231], v22
  s_add_u32 m0, s74, 2048
  s_mul_i32 s21, s91, 1
  s_add_u32 s21, s21, s71
  buffer_load_dwordx4 v4, s[16:19], s21 offen sc1 lds
  v_smfmac_f32_16x16x64_bf16 v[88:91], v[52:55], a[168:175], v22
  v_smfmac_f32_16x16x64_bf16 v[88:91], v[56:59], a[176:183], v22
  v_smfmac_f32_16x16x64_bf16 v[88:91], v[60:63], a[184:191], v22
  v_cvt_pk_bf16_f32 v122, v92, v93
  v_smfmac_f32_16x16x64_bf16 v[88:91], v[64:67], a[192:199], v22
  v_cvt_pk_bf16_f32 v123, v94, v95
  s_barrier
  v_smfmac_f32_16x16x64_bf16 v[88:91], v[68:71], a[200:207], v22
  ds_write_b64 v12, v[122:123] offset:13056
  v_smfmac_f32_16x16x64_bf16 v[88:91], v[72:75], a[208:215], v22
  v_smfmac_f32_16x16x64_bf16 v[96:99], v[48:51], a[0:7], v22
  v_smfmac_f32_16x16x64_bf16 v[100:103], v[48:51], a[80:87], v22
  v_smfmac_f32_16x16x64_bf16 v[96:99], v[52:55], a[8:15], v22
  v_cvt_pk_bf16_f32 v120, v88, v89
  v_cvt_pk_bf16_f32 v121, v90, v91
  ds_write_b64 v12, v[120:121] offset:12544
  v_smfmac_f32_16x16x64_bf16 v[100:103], v[52:55], a[88:95], v22
  s_waitcnt lgkmcnt(0)
  s_barrier
  ds_read_b64_tr_b16 v[104:105], v7 offset:0
  ds_read_b64_tr_b16 v[106:107], v7 offset:768
  ds_read_b64_tr_b16 v[108:109], v7 offset:1536
  ds_read_b32 v27, v12 offset:12544
  ds_read_b64 v[140:141], v11
  s_waitcnt lgkmcnt(1)
  v_cmp_u_f32 vcc, v104, v106
  v_cmp_u_f32 s[22:23], v108, v27
  s_nop 1
  s_or_b64 vcc, vcc, s[22:23]
  s_cbranch_vccnz mn_109
mk_110:
  s_cmp_eq_u32 s52, 63
  s_cbranch_scc1 last_111
  v_permlane32_swap_b32 v88, v92
  v_permlane32_swap_b32 v89, v93
  v_permlane32_swap_b32 v90, v94
  v_permlane32_swap_b32 v91, v95
  v_pk_add_f32 v[88:89], v[88:89], v[92:93]
  v_pk_add_f32 v[90:91], v[90:91], v[94:95]
  v_cvt_pk_bf16_f32 v92, v88, v89
  v_cvt_pk_bf16_f32 v93, v90, v91
  v_min_u32 v92, -2, v92
  s_nop 0
  v_smfmac_f32_16x16x64_bf16 v[96:99], v[56:59], a[16:23], v22
  v_smfmac_f32_16x16x64_bf16 v[100:103], v[56:59], a[96:103], v22
  v_smfmac_f32_16x16x64_bf16 v[96:99], v[60:63], a[24:31], v22
  v_smfmac_f32_16x16x64_bf16 v[96:99], v[64:67], a[32:39], v22
  v_smfmac_f32_16x16x64_bf16 v[96:99], v[68:71], a[40:47], v22
  v_smfmac_f32_16x16x64_bf16 v[96:99], v[72:75], a[48:55], v22
  v_smfmac_f32_16x16x64_bf16 v[96:99], v[76:79], a[56:63], v22
  v_smfmac_f32_16x16x64_bf16 v[96:99], v[80:83], a[64:71], v22
  v_smfmac_f32_16x16x64_bf16 v[96:99], v[84:87], a[72:79], v22
  v_smfmac_f32_16x16x64_bf16 v[100:103], v[60:63], a[104:111], v22
  v_smfmac_f32_16x16x64_bf16 v[100:103], v[64:67], a[112:119], v22
  buffer_load_dwordx4 v[132:135], v10, s[8:11], s56 offen sc1
  v_smfmac_f32_16x16x64_bf16 v[100:103], v[68:71], a[120:127], v22
  buffer_load_dwordx4 v[124:127], v9, s[8:11], s56 offen sc1
  v_smfmac_f32_16x16x64_bf16 v[100:103], v[72:75], a[128:135], v22
  buffer_load_dwordx4 v[128:131], v9, s[8:11], s56 offen offset:1024 sc1
  v_cvt_pk_bf16_f32 v136, v96, v97
  v_smfmac_f32_16x16x64_bf16 v[100:103], v[76:79], a[136:143], v22
  v_cvt_pk_bf16_f32 v137, v98, v99
  v_smfmac_f32_16x16x64_bf16 v[100:103], v[80:83], a[144:151], v22
  v_smfmac_f32_16x16x64_bf16 v[100:103], v[84:87], a[152:159], v22
  s_nop 7
  v_cvt_pk_bf16_f32 v138, v100, v101
  v_cvt_pk_bf16_f32 v139, v102, v103
  v_permlane32_swap_b32 v96, v100
  v_permlane32_swap_b32 v97, v101
  v_permlane32_swap_b32 v98, v102
  v_permlane32_swap_b32 v99, v103
  v_pk_add_f32 v[96:97], v[96:97], v[100:101]
  v_pk_add_f32 v[98:99], v[98:99], v[102:103]
  v_cvt_pk_bf16_f32 v100, v96, v97
  v_cvt_pk_bf16_f32 v101, v98, v99
  s_nop 0
  v_permlane32_swap_b32 v100, v102
  v_permlane32_swap_b32 v101, v103
  v_min_u32 v100, -2, v100
  s_waitcnt vmcnt(2) lgkmcnt(0)
  v_pk_add_f16 v164, v132, v133
  v_pk_add_f16 v165, v134, v135
  v_fma_mix_f32 v170, v164, 1.0, v165 op_sel:[0,0,0] op_sel_hi:[1,0,1]
  v_fma_mix_f32 v171, v164, 1.0, v165 op_sel:[1,0,1] op_sel_hi:[1,0,1]
  v_exp_f32 v176, v170
  v_exp_f32 v177, v171
  s_waitcnt vmcnt(1)
  v_cvt_pk_bf16_f32 v160, v176, v177
  v_pk_add_f16 v120, v124, v126
  v_pk_add_f16 v121, v125, v127
  v_mov_b32_dpp v161, v160 row_ror:8 row_mask:0xf bank_mask:0xf
  s_waitcnt vmcnt(0)
  v_pk_add_f16 v122, v128, v130
  v_mfma_f32_16x16x32_bf16 v[178:181], v[140:143], v[160:163], 0
  v_fma_mix_f32 v166, v120, 1.0, v122 op_sel:[0,0,0] op_sel_hi:[1,0,1]
  v_fma_mix_f32 v167, v120, 1.0, v122 op_sel:[1,0,1] op_sel_hi:[1,0,1]
  v_cmp_u_f32 vcc, v166, v170
  v_pk_add_f16 v123, v129, v131
  v_exp_f32 v172, v166
  v_mfma_f32_16x16x32_bf16 v[182:185], v[136:139], v[160:163], 0
  s_cbranch_vccnz sr_117
  v_exp_f32 v173, v167
  v_fma_mix_f32 v168, v121, 1.0, v123 op_sel:[0,0,0] op_sel_hi:[1,0,1]
  v_fma_mix_f32 v169, v121, 1.0, v123 op_sel:[1,0,1] op_sel_hi:[1,0,1]
  v_cvt_pk_bf16_f32 v156, v172, v173
  v_exp_f32 v174, v168
  v_exp_f32 v175, v169
  v_mov_b32_dpp v158, v156 row_ror:8 row_mask:0xf bank_mask:0xf
  v_cvt_pk_bf16_f32 v157, v174, v175
  v_mfma_f32_16x16x32_bf16 v[186:189], v[138:141], v[160:163], 0
  s_nop 0
  v_mov_b32_dpp v159, v157 row_ror:8 row_mask:0xf bank_mask:0xf
  s_nop 1
pv_118:
  v_mfma_f32_16x16x32_bf16 v[178:181], v[152:155], v[156:159], v[178:181]
  v_mfma_f32_16x16x32_bf16 v[182:185], v[144:147], v[156:159], v[182:185]
  v_mfma_f32_16x16x32_bf16 v[186:189], v[148:151], v[156:159], v[186:189]
  s_mov_b64 exec, s[62:63]
  s_nop 0
  v_rcp_f32 v164, v180
  v_cmp_ngt_f32 s[22:23], s80, v180
  v_cmp_ngt_f32 vcc, s80, v164
  v_pk_mul_f32 v[182:183], v[182:183], v[164:165] op_sel_hi:[1,0]
  v_pk_mul_f32 v[184:185], v[184:185], v[164:165] op_sel_hi:[1,0]
  v_pk_mul_f32 v[178:179], v[178:179], v[164:165] op_sel_hi:[1,0]
  v_pk_mul_f32 v[186:187], v[186:187], v[164:165] op_sel_hi:[1,0]
  v_pk_mul_f32 v[188:189], v[188:189], v[164:165] op_sel_hi:[1,0]
  v_cvt_pk_f16_f32 v64, v178, v179
  s_or_b64 vcc, vcc, s[22:23]
  s_cbranch_scc1 fx_120
fk_121:
  ds_write_b32 v14, v64
  v_cvt_pk_f16_f32 v60, v182, v183
  v_cvt_pk_f16_f32 v61, v184, v185
  v_cvt_pk_f16_f32 v62, v186, v187
  v_cvt_pk_f16_f32 v63, v188, v189
  ds_write_b128 v13, v[60:63]
  s_mov_b64 exec, s[66:67]
  s_barrier
  ds_read_b128 v[166:169], v4 offset:13824
  ds_read_b128 v[170:173], v4 offset:14464
  ds_read_b128 v[174:177], v4 offset:15104
  ds_read_b128 v[178:181], v4 offset:15744
  s_waitcnt lgkmcnt(2)
  v_pk_add_f16 v166, v166, v170
  v_pk_add_f16 v167, v167, v171
  v_pk_add_f16 v168, v168, v172
  v_pk_add_f16 v169, v169, v173
  s_waitcnt lgkmcnt(1)
  v_pk_add_f16 v166, v166, v174
  v_pk_add_f16 v167, v167, v175
  v_pk_add_f16 v168, v168, v176
  v_pk_add_f16 v169, v169, v177
  s_waitcnt lgkmcnt(0)
  v_pk_add_f16 v166, v166, v178
  v_cmpx_o_f16 vcc, v166, v166
  v_pk_add_f16 v167, v167, v179
  v_pk_add_f16 v168, v168, v180
  v_pk_add_f16 v169, v169, v181
  v_and_or_b32 v166, v166, -2, s61
  buffer_store_dwordx4 v[166:169], v15, s[4:7], s60 offen sc1
  s_xor_b64 s[98:99], exec, s[66:67]
  s_mov_b64 exec, -1
  buffer_store_dwordx4 v[100:103], v26, s[16:19], s70 offen sc1
  buffer_store_dwordx2 v[92:93], v43, s[16:19], s70 offen sc1
  s_add_u32 s70, s70, 2097152
  s_xor_b32 s70, s70, 8192
  ds_read_b128 v[144:147], v18
  ds_read_b128 v[148:151], v18 offset:1024
  ds_read_b128 v[152:155], v19
  v_xor_b32 v18, 16384, v18
  v_xor_b32 v19, 16384, v19
  v_mov_b32 v88, 0
  v_mov_b32 v89, 0
  v_mov_b32 v90, 0
  v_mov_b32 v91, 0
  v_mov_b32 v92, 0
  v_mov_b32 v93, 0
  v_mov_b32 v94, 0
  v_mov_b32 v95, 0
  v_mov_b32 v96, 0
  v_mov_b32 v97, 0
  v_mov_b32 v98, 0
  v_mov_b32 v99, 0
  v_mov_b32 v100, 0
  v_mov_b32 v101, 0
  v_mov_b32 v102, 0
  v_mov_b32 v103, 0
  s_mov_b32 s81, 0
  s_waitcnt lgkmcnt(0)
  s_barrier
  s_cmp_lg_u64 s[98:99], 0
  s_cbranch_scc1 pf_122
pf_123:
  s_xor_b32 s74, s74, 16384
  s_add_u32 s73, s73, 2097152
  s_xor_b32 s73, s73, 8192
  s_add_u32 s79, s79, 2097152
  s_xor_b32 s79, s79, 8192
  s_add_u32 s21, s72, 524288
  s_xor_b32 s72, s72, s21
  s_lshr_b32 s72, s72, 8
  s_and_b32 s72, s72, 8192
  s_xor_b32 s72, s72, s21
  s_add_u32 s71, s73, 4096
  s_mov_b32 s91, 1024
  s_sub_u32 s21, s73, 0
  s_cmp_lt_u32 s21, 125829120
  s_cselect_b32 s71, s71, s79
  s_cselect_b32 s91, s91, 65536
  v_mov_b32 v166, s52
  s_add_u32 s22, s52, 5
  s_min_u32 s22, s22, 64
  v_cmp_gt_u32 vcc, s22, v42
  s_cbranch_vccz fv_125
  buffer_load_dword v42, v41, s[12:15], s76 offen sc1
fv_125:
  ds_write_b128 v190, v[28:31] offset:0
  ds_write_b128 v190, v[28:31] offset:1024
  ds_write_b128 v190, v[28:31] offset:2048
nt_124:
  s_barrier
  s_mov_b32 s58, s55
  s_add_u32 s52, s52, 1
  ds_write_b32 v13, v28
  ds_write_b32 v14, v28
  s_and_b32 s21, s52, 3
  s_mul_i32 s56, s21, 122880
  s_add_u32 s21, s52, 1
  s_and_b32 s21, s21, 3
  s_mul_i32 s55, s21, 122880
  s_add_u32 s55, s55, s75
  s_add_u32 s21, s52, 2
  s_and_b32 s21, s21, 3
  s_mul_i32 s57, s21, 122880
  s_add_u32 s21, s52, 3
  s_and_b32 s21, s21, 3
  s_mul_i32 s59, s21, 122880
  s_add_u32 s59, s59, s75
  s_bfe_u32 s61, s52, 0x10002
  s_and_b32 s21, s52, 3
  s_lshl_b32 s60, s21, 18
  s_mov_b32 s54, 0
  s_sleep 2
  s_nop 10
  s_waitcnt lgkmcnt(0)
  buffer_load_dwordx4 v[76:79], v190, s[8:11], s58 offen offset:0 sc1
  buffer_load_dwordx4 v[80:83], v190, s[8:11], s58 offen offset:1024 sc1
  buffer_load_dwordx4 v[84:87], v190, s[8:11], s58 offen offset:2048 sc1
  s_branch top_107
mr_108:
  s_mov_b64 exec, s[22:23]
  s_cbranch_execz ms_126
  buffer_load_dwordx4 v[76:79], v190, s[8:11], s58 offen offset:0 sc1
ms_126:
  s_mov_b64 exec, s[98:99]
  s_cbranch_execz ms_127
  buffer_load_dwordx4 v[80:83], v190, s[8:11], s58 offen offset:1024 sc1
ms_127:
  s_mov_b64 exec, s[100:101]
  s_cbranch_execz ms_128
  buffer_load_dwordx4 v[84:87], v190, s[8:11], s58 offen offset:2048 sc1
ms_128:
  s_add_u32 s54, s54, 1
  s_cmp_gt_u32 s54, 131072
  s_cbranch_scc1 end0
  s_waitcnt vmcnt(0)
  s_mov_b64 exec, s[22:23]
  ds_write_b128 v190, v[76:79] offset:0
  v_cmp_eq_u32 s[22:23], -1, v76
  s_mov_b64 exec, s[98:99]
  ds_write_b128 v190, v[80:83] offset:1024
  v_cmp_eq_u32 s[98:99], -1, v80
  s_mov_b64 exec, s[100:101]
  ds_write_b128 v190, v[84:87] offset:2048
  v_cmp_eq_u32 s[100:101], -1, v84
  s_mov_b64 exec, -1
  s_or_b64 vcc, s[22:23], s[98:99]
  s_or_b64 vcc, vcc, s[100:101]
  s_cbranch_scc1 mr_108
  s_branch mo_112
kw_113:
  s_mov_b32 s101, 0
wm_129:
  buffer_load_dword v42, v41, s[12:15], s76 offen sc1
  s_add_u32 s101, s101, 1
  s_cmp_gt_u32 s101, 131072
  s_cbranch_scc1 end0
  s_waitcnt vmcnt(0)
  v_cmp_gt_u32 vcc, s22, v42
  v_readfirstlane_b32 s100, v42
  s_nop 0
  s_cbranch_vccz wm_130
  s_sleep 1
  s_branch wm_129
wm_130:
  s_branch kv_114
mn_109:
  s_bitcmp1_b32 s81, 1
  s_cbranch_scc1 mk_110
  s_or_b32 s81, s81, 2
  s_nop 7
  v_mov_b32 v88, 0
  v_mov_b32 v89, 0
  v_mov_b32 v90, 0
  v_mov_b32 v91, 0
  v_mov_b32 v92, 0
  v_mov_b32 v93, 0
  v_mov_b32 v94, 0
  v_mov_b32 v95, 0
  v_mov_b32 v96, 0
  v_mov_b32 v97, 0
  v_mov_b32 v98, 0
  v_mov_b32 v99, 0
  v_mov_b32 v100, 0
  v_mov_b32 v101, 0
  v_mov_b32 v102, 0
  v_mov_b32 v103, 0
  s_cmp_eq_u32 s52, 0
  s_cbranch_scc1 mx_132
mx_131:
  buffer_load_dwordx4 v[76:79], v190, s[8:11], s58 offen offset:0 sc1
  buffer_load_dwordx4 v[80:83], v190, s[8:11], s58 offen offset:1024 sc1
  buffer_load_dwordx4 v[84:87], v190, s[8:11], s58 offen offset:2048 sc1
  s_add_u32 s54, s54, 1
  s_cmp_gt_u32 s54, 131072
  s_cbranch_scc1 end0
  s_waitcnt vmcnt(0)
  v_max3_u32 v27, v76, v77, v78
  v_max3_u32 v27, v27, v79, v80
  v_max3_u32 v27, v27, v81, v82
  v_max3_u32 v27, v27, v83, v84
  v_max3_u32 v27, v27, v85, v86
  v_max3_u32 v27, v27, v87, v87
  v_cmp_eq_u32 vcc, -1, v27
  s_nop 1
  s_cbranch_vccnz mx_131
  ds_write_b128 v190, v[76:79] offset:0
  ds_write_b128 v190, v[80:83] offset:1024
  ds_write_b128 v190, v[84:87] offset:2048
mx_132:
  s_waitcnt lgkmcnt(0)
  s_branch mo_112
sr_117:
  s_mov_b32 s54, 0
sr_133:
  s_mov_b64 exec, vcc
  buffer_load_dwordx4 v[124:127], v9, s[8:11], s56 offen sc1
  buffer_load_dwordx4 v[128:131], v9, s[8:11], s56 offen offset:1024 sc1
  buffer_load_dwordx4 v[132:135], v10, s[8:11], s56 offen sc1
  s_mov_b64 exec, -1
  s_add_u32 s54, s54, 1
  s_cmp_gt_u32 s54, 131072
  s_cbranch_scc1 end0
  s_waitcnt vmcnt(0)
  v_pk_add_f16 v164, v132, v133
  v_pk_add_f16 v165, v134, v135
  v_pk_add_f16 v120, v124, v126
  v_pk_add_f16 v122, v128, v130
  v_fma_mix_f32 v170, v164, 1.0, v165 op_sel:[0,0,0] op_sel_hi:[1,0,1]
  v_fma_mix_f32 v166, v120, 1.0, v122 op_sel:[0,0,0] op_sel_hi:[1,0,1]
  v_pk_add_f16 v121, v125, v127
  v_cmp_u_f32 vcc, v166, v170
  v_pk_add_f16 v123, v129, v131
  v_fma_mix_f32 v171, v164, 1.0, v165 op_sel:[1,0,1] op_sel_hi:[1,0,1]
  v_fma_mix_f32 v167, v120, 1.0, v122 op_sel:[1,0,1] op_sel_hi:[1,0,1]
  v_fma_mix_f32 v168, v121, 1.0, v123 op_sel:[0,0,0] op_sel_hi:[1,0,1]
  v_fma_mix_f32 v169, v121, 1.0, v123 op_sel:[1,0,1] op_sel_hi:[1,0,1]
  s_cbranch_vccz ex_119
  s_and_b32 s21, s54, 31
  s_cbranch_scc1 sr_133
  v_max3_u32 v27, v124, v126, v128
  v_max3_u32 v27, v27, v130, v132
  v_max3_u32 v27, v27, v133, v134
  v_max3_u32 v27, v27, v135, v135
  v_cmp_eq_u32 vcc, -1, v27
  s_nop 1
  s_cbranch_vccnz sr_133
ex_119:
  v_exp_f32 v176, v170
  v_exp_f32 v177, v171
  v_exp_f32 v172, v166
  v_cvt_pk_bf16_f32 v160, v176, v177
  v_exp_f32 v173, v167
  v_exp_f32 v174, v168
  v_mov_b32_dpp v161, v160 row_ror:8 row_mask:0xf bank_mask:0xf
  v_cvt_pk_bf16_f32 v156, v172, v173
  v_exp_f32 v175, v169
  v_mfma_f32_16x16x32_bf16 v[178:181], v[140:143], v[160:163], 0
  v_mov_b32_dpp v158, v156 row_ror:8 row_mask:0xf bank_mask:0xf
  v_cvt_pk_bf16_f32 v157, v174, v175
  v_mfma_f32_16x16x32_bf16 v[182:185], v[136:139], v[160:163], 0
  s_nop 0
  v_mov_b32_dpp v159, v157 row_ror:8 row_mask:0xf bank_mask:0xf
  v_mfma_f32_16x16x32_bf16 v[186:189], v[138:141], v[160:163], 0
  s_branch pv_118
fx_120:
  s_bitcmp1_b32 s81, 0
  s_cbranch_scc1 fk_121
  s_or_b32 s81, s81, 1
  s_mov_b64 exec, -1
  v_max3_f32 v164, v166, v167, v168
  v_max3_f32 v165, v169, v170, v171
  v_max_f32 v164, v164, v165
  s_nop 1
  v_max_f32_dpp v164, v164, v164 row_ror:8 row_mask:0xf bank_mask:0xf
  v_mov_b32 v165, v164
  s_nop 1
  v_permlane32_swap_b32 v164, v165
  v_max_f32 v164, v164, v165
  v_mov_b32 v165, v164
  s_nop 1
  v_permlane16_swap_b32 v164, v165
  v_max_f32 v164, v164, v165
  v_sub_f32 v166, v166, v164
  v_sub_f32 v167, v167, v164
  v_sub_f32 v168, v168, v164
  v_sub_f32 v169, v169, v164
  v_sub_f32 v170, v170, v164
  v_sub_f32 v171, v171, v164
  s_branch ex_119
pf_122:
  s_mov_b64 exec, s[66:67]
  ds_read_b128 v[166:169], v4 offset:13824
  ds_read_b128 v[170:173], v4 offset:14464
  ds_read_b128 v[174:177], v4 offset:15104
  ds_read_b128 v[178:181], v4 offset:15744
  s_waitcnt lgkmcnt(2)
  v_pk_add_f16 v166, v166, v170
  v_pk_add_f16 v167, v167, v171
  v_pk_add_f16 v168, v168, v172
  v_pk_add_f16 v169, v169, v173
  s_waitcnt lgkmcnt(1)
  v_pk_add_f16 v166, v166, v174
  v_pk_add_f16 v167, v167, v175
  v_pk_add_f16 v168, v168, v176
  v_pk_add_f16 v169, v169, v177
  s_waitcnt lgkmcnt(0)
  v_pk_add_f16 v166, v166, v178
  v_pk_add_f16 v167, v167, v179
  v_pk_add_f16 v168, v168, v180
  v_pk_add_f16 v169, v169, v181
  v_and_or_b32 v166, v166, -2, s61
  buffer_store_dwordx4 v[166:169], v15, s[4:7], s60 offen sc1
  s_mov_b64 exec, -1
  s_nop 1
  s_branch pf_123
last_111:
  v_permlane32_swap_b32 v88, v92
  v_permlane32_swap_b32 v89, v93
  v_permlane32_swap_b32 v90, v94
  v_permlane32_swap_b32 v91, v95
  v_pk_add_f32 v[88:89], v[88:89], v[92:93]
  v_pk_add_f32 v[90:91], v[90:91], v[94:95]
  v_cvt_pk_bf16_f32 v92, v88, v89
  v_cvt_pk_bf16_f32 v93, v90, v91
  v_min_u32 v92, -2, v92
  buffer_store_dwordx2 v[92:93], v43, s[16:19], s70 offen sc1
  v_smfmac_f32_16x16x64_bf16 v[96:99], v[56:59], a[16:23], v22
  v_smfmac_f32_16x16x64_bf16 v[100:103], v[56:59], a[96:103], v22
  v_smfmac_f32_16x16x64_bf16 v[96:99], v[60:63], a[24:31], v22
  v_smfmac_f32_16x16x64_bf16 v[96:99], v[64:67], a[32:39], v22
  v_smfmac_f32_16x16x64_bf16 v[96:99], v[68:71], a[40:47], v22
  v_smfmac_f32_16x16x64_bf16 v[96:99], v[72:75], a[48:55], v22
  v_smfmac_f32_16x16x64_bf16 v[96:99], v[76:79], a[56:63], v22
  v_smfmac_f32_16x16x64_bf16 v[96:99], v[80:83], a[64:71], v22
  v_smfmac_f32_16x16x64_bf16 v[96:99], v[84:87], a[72:79], v22
  v_smfmac_f32_16x16x64_bf16 v[100:103], v[60:63], a[104:111], v22
  v_smfmac_f32_16x16x64_bf16 v[100:103], v[64:67], a[112:119], v22
  v_smfmac_f32_16x16x64_bf16 v[100:103], v[68:71], a[120:127], v22
  v_smfmac_f32_16x16x64_bf16 v[100:103], v[72:75], a[128:135], v22
  v_smfmac_f32_16x16x64_bf16 v[100:103], v[76:79], a[136:143], v22
  v_smfmac_f32_16x16x64_bf16 v[100:103], v[80:83], a[144:151], v22
  v_smfmac_f32_16x16x64_bf16 v[100:103], v[84:87], a[152:159], v22
  s_nop 7
  v_permlane32_swap_b32 v96, v100
  v_permlane32_swap_b32 v97, v101
  v_permlane32_swap_b32 v98, v102
  v_permlane32_swap_b32 v99, v103
  v_pk_add_f32 v[96:97], v[96:97], v[100:101]
  v_pk_add_f32 v[98:99], v[98:99], v[102:103]
  v_cvt_pk_bf16_f32 v100, v96, v97
  v_cvt_pk_bf16_f32 v101, v98, v99
  s_nop 0
  v_permlane32_swap_b32 v100, v102
  v_permlane32_swap_b32 v101, v103
  v_min_u32 v100, -2, v100
  buffer_store_dwordx4 v[100:103], v26, s[16:19], s70 offen sc1
  s_waitcnt vmcnt(0)
  s_barrier
  v_mov_b32 v166, 64
  s_mov_b64 exec, 1
  buffer_store_dword v166, v23, s[12:15], s77 offen sc1
  s_mov_b64 exec, -1
  s_branch chain_done
E_25:
  v_add_u32 v190, 0, v4
  ds_write_b64 v6, v[28:29]
  ds_write_b32 v13, v28
  ds_write_b32 v14, v28
  s_waitcnt vmcnt(0)
  ds_write_b128 v190, v[48:51] offset:0
  ds_write_b128 v190, v[52:55] offset:1024
  s_waitcnt lgkmcnt(0)
  s_add_u32 m0, s74, 4096
  s_add_u32 s21, s79, 131072
  buffer_load_dwordx4 v4, s[16:19], s21 offen offset:1024 sc1 lds
  s_add_u32 m0, s74, 9216
  s_add_u32 s21, s72, 32768
  buffer_load_dwordx4 v32, s[16:19], s21 offen sc1 lds
  s_xor_b32 s74, s74, 16384
  s_add_u32 s73, s73, 2097152
  s_xor_b32 s73, s73, 8192
  s_add_u32 s79, s79, 2097152
  s_xor_b32 s79, s79, 8192
  s_add_u32 s21, s72, 524288
  s_xor_b32 s72, s72, s21
  s_lshr_b32 s72, s72, 8
  s_and_b32 s72, s72, 8192
  s_xor_b32 s72, s72, s21
  s_add_u32 s71, s73, 4096
  s_mov_b32 s91, 1024
  s_sub_u32 s21, s73, 0
  s_cmp_lt_u32 s21, 125829120
  s_cselect_b32 s71, s71, s79
  s_cselect_b32 s91, s91, 65536
  s_branch mo_140
  .p2align 3
top_135:
  s_waitcnt vmcnt(1)
  ds_write_b128 v190, v[48:51] offset:0
  v_cmp_eq_u32 s[22:23], -1, v48
  s_waitcnt vmcnt(0)
  ds_write_b128 v190, v[52:55] offset:1024
  v_cmp_eq_u32 s[98:99], -1, v52
  s_or_b64 vcc, s[22:23], s[98:99]
  s_cbranch_scc1 mr_136
mo_140:
  s_barrier
  ds_read_b128 v[56:59], v4 offset:2048
  ds_read_b128 v[60:63], v4 offset:3072
  v_smfmac_f32_16x16x64_bf16 v[92:95], v[48:51], a[240:247], v22
  ds_read_b128 v[64:67], v4 offset:4096
  v_smfmac_f32_16x16x64_bf16 v[88:91], v[48:51], a[160:167], v22
  ds_read_b128 v[68:71], v4 offset:5120
  v_smfmac_f32_16x16x64_bf16 v[92:95], v[52:55], a[248:255], v22
  ds_read_b128 v[72:75], v4 offset:6144
  v_smfmac_f32_16x16x64_bf16 v[88:91], v[52:55], a[168:175], v22
  s_waitcnt lgkmcnt(4)
  ds_read_b128 v[76:79], v4 offset:7168
  v_smfmac_f32_16x16x64_bf16 v[92:95], v[56:59], v[192:199], v22
  ds_read_b128 v[80:83], v4 offset:8192
  v_smfmac_f32_16x16x64_bf16 v[88:91], v[56:59], a[176:183], v22
  s_waitcnt lgkmcnt(5)
  ds_read_b128 v[84:87], v4 offset:9216
  v_smfmac_f32_16x16x64_bf16 v[92:95], v[60:63], v[200:207], v22
  v_smfmac_f32_16x16x64_bf16 v[88:91], v[60:63], a[184:191], v22
  s_waitcnt lgkmcnt(5)
  v_smfmac_f32_16x16x64_bf16 v[92:95], v[64:67], v[208:215], v22
  s_waitcnt lgkmcnt(4)
  v_smfmac_f32_16x16x64_bf16 v[92:95], v[68:71], v[216:223], v22
  s_waitcnt lgkmcnt(3)
  v_smfmac_f32_16x16x64_bf16 v[92:95], v[72:75], v[224:231], v22
  s_waitcnt lgkmcnt(2)
  v_smfmac_f32_16x16x64_bf16 v[92:95], v[76:79], v[232:239], v22
  s_waitcnt lgkmcnt(1)
  v_smfmac_f32_16x16x64_bf16 v[92:95], v[80:83], v[240:247], v22
  s_waitcnt lgkmcnt(0)
  v_smfmac_f32_16x16x64_bf16 v[92:95], v[84:87], v[248:255], v22
  v_smfmac_f32_16x16x64_bf16 v[88:91], v[64:67], a[192:199], v22
  v_smfmac_f32_16x16x64_bf16 v[88:91], v[68:71], a[200:207], v22
  v_smfmac_f32_16x16x64_bf16 v[88:91], v[72:75], a[208:215], v22
  v_permlane32_swap_b32 v92, v93
  v_smfmac_f32_16x16x64_bf16 v[88:91], v[76:79], a[216:223], v22
  v_permlane32_swap_b32 v94, v95
  v_smfmac_f32_16x16x64_bf16 v[88:91], v[80:83], a[224:231], v22
  v_permlane32_swap_b32 v93, v92
  v_smfmac_f32_16x16x64_bf16 v[88:91], v[84:87], a[232:239], v22
  v_permlane32_swap_b32 v95, v94
  v_pk_mul_f32 v[120:121], v[92:93], v[24:25] op_sel:[1,0] op_sel_hi:[0,1]
  v_pk_mul_f32 v[122:123], v[94:95], v[24:25] op_sel:[1,0] op_sel_hi:[0,1]
  s_nop 4
  v_pk_fma_f32 v[88:89], v[88:89], v[24:25], v[120:121]
  v_pk_fma_f32 v[90:91], v[90:91], v[24:25], v[122:123]
  v_cvt_pk_bf16_f32 v120, v88, v89
  v_cvt_pk_bf16_f32 v121, v90, v91
  ds_write_b64 v6, v[120:121]
  s_barrier
  ds_read_b64_tr_b16 v[104:105], v7 offset:0
  ds_read_b64_tr_b16 v[106:107], v7 offset:768
  ds_read_b64_tr_b16 v[108:109], v7 offset:1536
  s_waitcnt lgkmcnt(1)
  v_mfma_f32_16x16x32_bf16 v[120:123], v[112:115], v[104:107], 0
  s_waitcnt lgkmcnt(0)
  v_mfma_f32_16x16x32_bf16 v[120:123], v[116:119], v[108:111], v[120:123]
  s_mov_b64 exec, s[64:65]
  s_nop 6
  v_cmpx_o_f32 vcc, v120, v121
  v_cvt_pk_f16_f32 v120, v120, v121
  v_cvt_pk_f16_f32 v121, v122, v123
  buffer_store_dwordx2 v[120:121], v8, s[8:11], s56 offen sc1
  s_xor_b64 s[98:99], exec, s[64:65]
  s_mov_b64 exec, -1
  s_waitcnt lgkmcnt(0)
  s_barrier
  ds_read_b64_tr_b16 v[104:105], v7 offset:0
  ds_read_b64_tr_b16 v[106:107], v7 offset:768
  ds_read_b64_tr_b16 v[108:109], v7 offset:1536
  ds_read_b32 v27, v12 offset:12544
  ds_read_b64 v[140:141], v11
  s_waitcnt lgkmcnt(1)
  v_cmp_u_f32 vcc, v104, v106
  v_cmp_u_f32 s[22:23], v108, v27
  s_nop 1
  s_or_b64 vcc, vcc, s[22:23]
  s_cbranch_vccnz mn_137
mk_138:
  s_cmp_eq_u32 s52, 63
  s_cbranch_scc1 last_139
  s_cmp_lg_u64 s[98:99], 0
  s_cbranch_scc1 sf_141
sf_142:
  s_nop 15
  s_nop 10
  v_smfmac_f32_16x16x64_bf16 v[96:99], v[48:51], a[0:7], v22
  v_smfmac_f32_16x16x64_bf16 v[100:103], v[48:51], a[80:87], v22
  v_smfmac_f32_16x16x64_bf16 v[96:99], v[52:55], a[8:15], v22
  v_smfmac_f32_16x16x64_bf16 v[100:103], v[52:55], a[88:95], v22
  v_smfmac_f32_16x16x64_bf16 v[96:99], v[56:59], a[16:23], v22
  v_smfmac_f32_16x16x64_bf16 v[100:103], v[56:59], a[96:103], v22
  buffer_load_dwordx4 v[132:135], v10, s[8:11], s56 offen sc1
  v_smfmac_f32_16x16x64_bf16 v[96:99], v[60:63], a[24:31], v22
  buffer_load_dwordx4 v[124:127], v9, s[8:11], s56 offen sc1
  v_smfmac_f32_16x16x64_bf16 v[96:99], v[64:67], a[32:39], v22
  buffer_load_dwordx4 v[128:131], v9, s[8:11], s56 offen offset:1024 sc1
  v_smfmac_f32_16x16x64_bf16 v[96:99], v[68:71], a[40:47], v22
  v_smfmac_f32_16x16x64_bf16 v[96:99], v[72:75], a[48:55], v22
  v_smfmac_f32_16x16x64_bf16 v[96:99], v[76:79], a[56:63], v22
  v_smfmac_f32_16x16x64_bf16 v[96:99], v[80:83], a[64:71], v22
  v_smfmac_f32_16x16x64_bf16 v[96:99], v[84:87], a[72:79], v22
  v_smfmac_f32_16x16x64_bf16 v[100:103], v[60:63], a[104:111], v22
  v_smfmac_f32_16x16x64_bf16 v[100:103], v[64:67], a[112:119], v22
  v_smfmac_f32_16x16x64_bf16 v[100:103], v[68:71], a[120:127], v22
  v_smfmac_f32_16x16x64_bf16 v[100:103], v[72:75], a[128:135], v22
  v_cvt_pk_bf16_f32 v136, v96, v97
  v_smfmac_f32_16x16x64_bf16 v[100:103], v[76:79], a[136:143], v22
  v_cvt_pk_bf16_f32 v137, v98, v99
  v_smfmac_f32_16x16x64_bf16 v[100:103], v[80:83], a[144:151], v22
  v_smfmac_f32_16x16x64_bf16 v[100:103], v[84:87], a[152:159], v22
  s_nop 7
  v_cvt_pk_bf16_f32 v138, v100, v101
  v_cvt_pk_bf16_f32 v139, v102, v103
  s_waitcnt vmcnt(2) lgkmcnt(0)
  v_pk_add_f16 v164, v132, v133
  v_pk_add_f16 v165, v134, v135
  v_fma_mix_f32 v170, v164, 1.0, v165 op_sel:[0,0,0] op_sel_hi:[1,0,1]
  v_fma_mix_f32 v171, v164, 1.0, v165 op_sel:[1,0,1] op_sel_hi:[1,0,1]
  v_exp_f32 v176, v170
  v_exp_f32 v177, v171
  s_waitcnt vmcnt(1)
  v_cvt_pk_bf16_f32 v160, v176, v177
  v_pk_add_f16 v120, v124, v126
  v_pk_add_f16 v121, v125, v127
  v_mov_b32_dpp v161, v160 row_ror:8 row_mask:0xf bank_mask:0xf
  s_waitcnt vmcnt(0)
  v_pk_add_f16 v122, v128, v130
  v_mfma_f32_16x16x32_bf16 v[178:181], v[140:143], v[160:163], 0
  v_fma_mix_f32 v166, v120, 1.0, v122 op_sel:[0,0,0] op_sel_hi:[1,0,1]
  v_fma_mix_f32 v167, v120, 1.0, v122 op_sel:[1,0,1] op_sel_hi:[1,0,1]
  v_cmp_u_f32 vcc, v166, v170
  v_pk_add_f16 v123, v129, v131
  v_exp_f32 v172, v166
  v_mfma_f32_16x16x32_bf16 v[182:185], v[136:139], v[160:163], 0
  s_cbranch_vccnz sr_143
  v_exp_f32 v173, v167
  v_fma_mix_f32 v168, v121, 1.0, v123 op_sel:[0,0,0] op_sel_hi:[1,0,1]
  v_fma_mix_f32 v169, v121, 1.0, v123 op_sel:[1,0,1] op_sel_hi:[1,0,1]
  v_cvt_pk_bf16_f32 v156, v172, v173
  v_exp_f32 v174, v168
  v_exp_f32 v175, v169
  v_mov_b32_dpp v158, v156 row_ror:8 row_mask:0xf bank_mask:0xf
  v_cvt_pk_bf16_f32 v157, v174, v175
  v_mfma_f32_16x16x32_bf16 v[186:189], v[138:141], v[160:163], 0
  s_nop 0
  v_mov_b32_dpp v159, v157 row_ror:8 row_mask:0xf bank_mask:0xf
  s_nop 1
pv_144:
  v_mfma_f32_16x16x32_bf16 v[178:181], v[152:155], v[156:159], v[178:181]
  v_mfma_f32_16x16x32_bf16 v[182:185], v[144:147], v[156:159], v[182:185]
  v_mfma_f32_16x16x32_bf16 v[186:189], v[148:151], v[156:159], v[186:189]
  s_mov_b64 exec, s[62:63]
  s_nop 0
  v_rcp_f32 v164, v180
  v_cmp_ngt_f32 s[22:23], s80, v180
  v_cmp_ngt_f32 vcc, s80, v164
  v_pk_mul_f32 v[182:183], v[182:183], v[164:165] op_sel_hi:[1,0]
  v_pk_mul_f32 v[184:185], v[184:185], v[164:165] op_sel_hi:[1,0]
  v_pk_mul_f32 v[178:179], v[178:179], v[164:165] op_sel_hi:[1,0]
  v_pk_mul_f32 v[186:187], v[186:187], v[164:165] op_sel_hi:[1,0]
  v_pk_mul_f32 v[188:189], v[188:189], v[164:165] op_sel_hi:[1,0]
  v_cvt_pk_f16_f32 v64, v178, v179
  s_or_b64 vcc, vcc, s[22:23]
  s_cbranch_scc1 fx_146
fk_147:
  ds_write_b32 v14, v64
  v_cvt_pk_f16_f32 v60, v182, v183
  v_cvt_pk_f16_f32 v61, v184, v185
  v_cvt_pk_f16_f32 v62, v186, v187
  v_cvt_pk_f16_f32 v63, v188, v189
  ds_write_b128 v13, v[60:63]
  s_barrier
  s_mov_b64 exec, -1
  s_add_u32 m0, s74, 4096
  s_add_u32 s21, s79, 131072
  buffer_load_dwordx4 v4, s[16:19], s21 offen offset:1024 sc1 lds
  s_add_u32 m0, s74, 9216
  s_add_u32 s21, s72, 32768
  buffer_load_dwordx4 v32, s[16:19], s21 offen sc1 lds
  s_xor_b32 s74, s74, 16384
  s_add_u32 s73, s73, 2097152
  s_xor_b32 s73, s73, 8192
  s_add_u32 s79, s79, 2097152
  s_xor_b32 s79, s79, 8192
  s_add_u32 s21, s72, 524288
  s_xor_b32 s72, s72, s21
  s_lshr_b32 s72, s72, 8
  s_and_b32 s72, s72, 8192
  s_xor_b32 s72, s72, s21
  s_add_u32 s71, s73, 4096
  s_mov_b32 s91, 1024
  s_sub_u32 s21, s73, 0
  s_cmp_lt_u32 s21, 125829120
  s_cselect_b32 s71, s71, s79
  s_cselect_b32 s91, s91, 65536
  v_permlane32_swap_b32 v96, v100
  v_permlane32_swap_b32 v97, v101
  v_permlane32_swap_b32 v98, v102
  v_permlane32_swap_b32 v99, v103
  v_pk_add_f32 v[96:97], v[96:97], v[100:101]
  v_pk_add_f32 v[98:99], v[98:99], v[102:103]
  v_cvt_pk_bf16_f32 v100, v96, v97
  v_cvt_pk_bf16_f32 v101, v98, v99
  s_nop 0
  v_permlane32_swap_b32 v100, v102
  v_permlane32_swap_b32 v101, v103
  v_min_u32 v100, -2, v100
  s_nop 6
  buffer_store_dwordx4 v[100:103], v26, s[16:19], s70 offen sc1
  v_min_u32 v104, -2, v104
  buffer_store_dwordx4 v[104:107], v36, s[16:19], s70 offen offset:2560 sc1
  s_add_u32 s70, s70, 2097152
  s_xor_b32 s70, s70, 8192
  ds_read_b128 v[144:147], v18
  ds_read_b128 v[148:151], v18 offset:1024
  ds_read_b128 v[152:155], v19
  ds_read_b128 v[112:115], v20
  ds_read_b64 v[116:117], v21
  v_xor_b32 v18, 16384, v18
  v_xor_b32 v19, 16384, v19
  v_xor_b32 v20, 16384, v20
  v_xor_b32 v21, 16384, v21
  v_mov_b32 v88, 0
  v_mov_b32 v89, 0
  v_mov_b32 v90, 0
  v_mov_b32 v91, 0
  v_mov_b32 v92, 0
  v_mov_b32 v93, 0
  v_mov_b32 v94, 0
  v_mov_b32 v95, 0
  v_mov_b32 v96, 0
  v_mov_b32 v97, 0
  v_mov_b32 v98, 0
  v_mov_b32 v99, 0
  v_mov_b32 v100, 0
  v_mov_b32 v101, 0
  v_mov_b32 v102, 0
  v_mov_b32 v103, 0
  s_mov_b32 s81, 0
  s_waitcnt lgkmcnt(0)
  s_barrier
  s_mov_b64 exec, s[64:65]
  buffer_store_dwordx2 v[28:29], v8, s[8:11], s57 offen sc1
  s_mov_b64 exec, -1
  ds_write_b128 v190, v[28:31] offset:0
  ds_write_b128 v190, v[28:31] offset:1024
  ds_write_b64 v6, v[28:29]
  s_mov_b64 exec, s[62:63]
  buffer_store_dword v28, v17, s[8:11], s59 offen sc1
  s_mov_b64 exec, -1
  s_sleep 3
  s_nop 1
  buffer_load_dwordx4 v[68:71], v16, s[4:7], s60 offen sc1
  s_sleep 3
  s_nop 1
  buffer_load_dwordx4 v[72:75], v16, s[4:7], s60 offen sc1
  s_waitcnt vmcnt(1)
  v_mfma_f32_16x16x32_f16 v[120:123], v[44:47], v[68:71], 0
  v_bitop3_b32 v27, v68, s61, 1 bitop3:0x28
  v_cmp_ne_u32 vcc, 0, v27
  s_nop 1
  s_cbranch_vccnz p2_152
  s_nop 2
pg_151:
  v_add_f32_dpp v120, v120, v120 row_ror:8 row_mask:0xf bank_mask:0xf
  v_add_f32_dpp v121, v121, v121 row_ror:8 row_mask:0xf bank_mask:0xf
  s_mov_b64 exec, s[62:63]
  v_cvt_pk_bf16_f32 v120, v120, v121
  v_min_u32 v120, -2, v120
  buffer_store_dword v120, v17, s[8:11], s55 offen sc1
  s_mov_b64 exec, -1
nt_148:
  s_barrier
  s_mov_b32 s58, s55
  s_add_u32 s52, s52, 1
  ds_write_b32 v13, v28
  ds_write_b32 v14, v28
  s_and_b32 s21, s52, 3
  s_mul_i32 s56, s21, 122880
  s_add_u32 s21, s52, 1
  s_and_b32 s21, s21, 3
  s_mul_i32 s55, s21, 122880
  s_add_u32 s55, s55, s75
  s_add_u32 s21, s52, 2
  s_and_b32 s21, s21, 3
  s_mul_i32 s57, s21, 122880
  s_add_u32 s21, s52, 3
  s_and_b32 s21, s21, 3
  s_mul_i32 s59, s21, 122880
  s_add_u32 s59, s59, s75
  s_bfe_u32 s61, s52, 0x10002
  s_and_b32 s21, s52, 3
  s_lshl_b32 s60, s21, 18
  s_mov_b32 s54, 0
  s_sleep 2
  s_nop 10
  s_waitcnt lgkmcnt(0)
  buffer_load_dwordx4 v[48:51], v190, s[8:11], s58 offen offset:0 sc1
  buffer_load_dwordx4 v[52:55], v190, s[8:11], s58 offen offset:1024 sc1
  s_branch top_135
mr_136:
  s_mov_b64 exec, s[22:23]
  s_cbranch_execz ms_153
  buffer_load_dwordx4 v[48:51], v190, s[8:11], s58 offen offset:0 sc1
ms_153:
  s_mov_b64 exec, s[98:99]
  s_cbranch_execz ms_154
  buffer_load_dwordx4 v[52:55], v190, s[8:11], s58 offen offset:1024 sc1
ms_154:
  s_add_u32 s54, s54, 1
  s_cmp_gt_u32 s54, 131072
  s_cbranch_scc1 end0
  s_waitcnt vmcnt(0)
  s_mov_b64 exec, s[22:23]
  ds_write_b128 v190, v[48:51] offset:0
  v_cmp_eq_u32 s[22:23], -1, v48
  s_mov_b64 exec, s[98:99]
  ds_write_b128 v190, v[52:55] offset:1024
  v_cmp_eq_u32 s[98:99], -1, v52
  s_mov_b64 exec, -1
  s_or_b64 vcc, s[22:23], s[98:99]
  s_cbranch_scc1 mr_136
  s_branch mo_140
sf_141:
  s_waitcnt lgkmcnt(1)
  v_mfma_f32_16x16x32_bf16 v[120:123], v[112:115], v[104:107], 0
  s_waitcnt lgkmcnt(0)
  v_mfma_f32_16x16x32_bf16 v[120:123], v[116:119], v[108:111], v[120:123]
  s_mov_b64 exec, s[64:65]
  s_nop 6
  v_cvt_pk_f16_f32 v120, v120, v121
  v_cvt_pk_f16_f32 v121, v122, v123
  buffer_store_dwordx2 v[120:121], v8, s[8:11], s56 offen sc1
  s_mov_b64 exec, -1
  s_branch sf_142
mn_137:
  s_bitcmp1_b32 s81, 1
  s_cbranch_scc1 mk_138
  s_or_b32 s81, s81, 2
  s_nop 7
  v_mov_b32 v88, 0
  v_mov_b32 v89, 0
  v_mov_b32 v90, 0
  v_mov_b32 v91, 0
  v_mov_b32 v92, 0
  v_mov_b32 v93, 0
  v_mov_b32 v94, 0
  v_mov_b32 v95, 0
  v_mov_b32 v96, 0
  v_mov_b32 v97, 0
  v_mov_b32 v98, 0
  v_mov_b32 v99, 0
  v_mov_b32 v100, 0
  v_mov_b32 v101, 0
  v_mov_b32 v102, 0
  v_mov_b32 v103, 0
  s_cmp_eq_u32 s52, 0
  s_cbranch_scc1 mx_156
mx_155:
  buffer_load_dwordx4 v[48:51], v190, s[8:11], s58 offen offset:0 sc1
  buffer_load_dwordx4 v[52:55], v190, s[8:11], s58 offen offset:1024 sc1
  s_add_u32 s54, s54, 1
  s_cmp_gt_u32 s54, 131072
  s_cbranch_scc1 end0
  s_waitcnt vmcnt(0)
  v_max3_u32 v27, v48, v49, v50
  v_max3_u32 v27, v27, v51, v52
  v_max3_u32 v27, v27, v53, v54
  v_max3_u32 v27, v27, v55, v55
  v_cmp_eq_u32 vcc, -1, v27
  s_nop 1
  s_cbranch_vccnz mx_155
  ds_write_b128 v190, v[48:51] offset:0
  ds_write_b128 v190, v[52:55] offset:1024
mx_156:
  s_waitcnt lgkmcnt(0)
  s_branch mo_140
sr_143:
  s_mov_b32 s54, 0
sr_157:
  s_mov_b64 exec, vcc
  buffer_load_dwordx4 v[124:127], v9, s[8:11], s56 offen sc1
  buffer_load_dwordx4 v[128:131], v9, s[8:11], s56 offen offset:1024 sc1
  buffer_load_dwordx4 v[132:135], v10, s[8:11], s56 offen sc1
  s_mov_b64 exec, -1
  s_add_u32 s54, s54, 1
  s_cmp_gt_u32 s54, 131072
  s_cbranch_scc1 end0
  s_waitcnt vmcnt(0)
  v_pk_add_f16 v164, v132, v133
  v_pk_add_f16 v165, v134, v135
  v_pk_add_f16 v120, v124, v126
  v_pk_add_f16 v122, v128, v130
  v_fma_mix_f32 v170, v164, 1.0, v165 op_sel:[0,0,0] op_sel_hi:[1,0,1]
  v_fma_mix_f32 v166, v120, 1.0, v122 op_sel:[0,0,0] op_sel_hi:[1,0,1]
  v_pk_add_f16 v121, v125, v127
  v_cmp_u_f32 vcc, v166, v170
  v_pk_add_f16 v123, v129, v131
  v_fma_mix_f32 v171, v164, 1.0, v165 op_sel:[1,0,1] op_sel_hi:[1,0,1]
  v_fma_mix_f32 v167, v120, 1.0, v122 op_sel:[1,0,1] op_sel_hi:[1,0,1]
  v_fma_mix_f32 v168, v121, 1.0, v123 op_sel:[0,0,0] op_sel_hi:[1,0,1]
  v_fma_mix_f32 v169, v121, 1.0, v123 op_sel:[1,0,1] op_sel_hi:[1,0,1]
  s_cbranch_vccz ex_145
  s_and_b32 s21, s54, 31
  s_cbranch_scc1 sr_157
  v_max3_u32 v27, v124, v126, v128
  v_max3_u32 v27, v27, v130, v132
  v_max3_u32 v27, v27, v133, v134
  v_max3_u32 v27, v27, v135, v135
  v_cmp_eq_u32 vcc, -1, v27
  s_nop 1
  s_cbranch_vccnz sr_157
ex_145:
  v_exp_f32 v176, v170
  v_exp_f32 v177, v171
  v_exp_f32 v172, v166
  v_cvt_pk_bf16_f32 v160, v176, v177
  v_exp_f32 v173, v167
  v_exp_f32 v174, v168
  v_mov_b32_dpp v161, v160 row_ror:8 row_mask:0xf bank_mask:0xf
  v_cvt_pk_bf16_f32 v156, v172, v173
  v_exp_f32 v175, v169
  v_mfma_f32_16x16x32_bf16 v[178:181], v[140:143], v[160:163], 0
  v_mov_b32_dpp v158, v156 row_ror:8 row_mask:0xf bank_mask:0xf
  v_cvt_pk_bf16_f32 v157, v174, v175
  v_mfma_f32_16x16x32_bf16 v[182:185], v[136:139], v[160:163], 0
  s_nop 0
  v_mov_b32_dpp v159, v157 row_ror:8 row_mask:0xf bank_mask:0xf
  v_mfma_f32_16x16x32_bf16 v[186:189], v[138:141], v[160:163], 0
  s_branch pv_144
fx_146:
  s_bitcmp1_b32 s81, 0
  s_cbranch_scc1 fk_147
  s_or_b32 s81, s81, 1
  s_mov_b64 exec, -1
  v_max3_f32 v164, v166, v167, v168
  v_max3_f32 v165, v169, v170, v171
  v_max_f32 v164, v164, v165
  s_nop 1
  v_max_f32_dpp v164, v164, v164 row_ror:8 row_mask:0xf bank_mask:0xf
  v_mov_b32 v165, v164
  s_nop 1
  v_permlane32_swap_b32 v164, v165
  v_max_f32 v164, v164, v165
  v_mov_b32 v165, v164
  s_nop 1
  v_permlane16_swap_b32 v164, v165
  v_max_f32 v164, v164, v165
  v_sub_f32 v166, v166, v164
  v_sub_f32 v167, v167, v164
  v_sub_f32 v168, v168, v164
  v_sub_f32 v169, v169, v164
  v_sub_f32 v170, v170, v164
  v_sub_f32 v171, v171, v164
  s_branch ex_145
p2_152:
  s_mov_b32 s54, 0
  buffer_load_dwordx4 v[68:71], v16, s[4:7], s60 offen sc1
  s_waitcnt vmcnt(1)
  v_mfma_f32_16x16x32_f16 v[120:123], v[44:47], v[72:75], 0
  v_bitop3_b32 v27, v72, s61, 1 bitop3:0x28
  v_cmp_ne_u32 vcc, 0, v27
  s_nop 1
  s_cbranch_vccz pg_151
  buffer_load_dwordx4 v[72:75], v16, s[4:7], s60 offen sc1
pp_150:
  s_waitcnt vmcnt(1)
  v_mfma_f32_16x16x32_f16 v[120:123], v[44:47], v[68:71], 0
  v_bitop3_b32 v27, v68, s61, 1 bitop3:0x28
  v_cmp_ne_u32 vcc, 0, v27
  s_nop 1
  s_cbranch_vccz pg_151
  buffer_load_dwordx4 v[68:71], v16, s[4:7], s60 offen sc1
  s_waitcnt vmcnt(1)
  v_mfma_f32_16x16x32_f16 v[120:123], v[44:47], v[72:75], 0
  v_bitop3_b32 v27, v72, s61, 1 bitop3:0x28
  v_cmp_ne_u32 vcc, 0, v27
  s_nop 1
  s_cbranch_vccz pg_151
  buffer_load_dwordx4 v[72:75], v16, s[4:7], s60 offen sc1
  s_add_u32 s54, s54, 1
  s_cmp_gt_u32 s54, 131072
  s_cbranch_scc1 end0
  s_branch pp_150
last_139:
  v_min_u32 v104, -2, v104
  buffer_store_dwordx4 v[104:107], v36, s[16:19], s70 offen offset:2560 sc1
  v_smfmac_f32_16x16x64_bf16 v[96:99], v[48:51], a[0:7], v22
  v_smfmac_f32_16x16x64_bf16 v[100:103], v[48:51], a[80:87], v22
  v_smfmac_f32_16x16x64_bf16 v[96:99], v[52:55], a[8:15], v22
  v_smfmac_f32_16x16x64_bf16 v[100:103], v[52:55], a[88:95], v22
  v_smfmac_f32_16x16x64_bf16 v[96:99], v[56:59], a[16:23], v22
  v_smfmac_f32_16x16x64_bf16 v[100:103], v[56:59], a[96:103], v22
  v_smfmac_f32_16x16x64_bf16 v[96:99], v[60:63], a[24:31], v22
  v_smfmac_f32_16x16x64_bf16 v[96:99], v[64:67], a[32:39], v22
  v_smfmac_f32_16x16x64_bf16 v[96:99], v[68:71], a[40:47], v22
  v_smfmac_f32_16x16x64_bf16 v[96:99], v[72:75], a[48:55], v22
  v_smfmac_f32_16x16x64_bf16 v[96:99], v[76:79], a[56:63], v22
  v_smfmac_f32_16x16x64_bf16 v[96:99], v[80:83], a[64:71], v22
  v_smfmac_f32_16x16x64_bf16 v[96:99], v[84:87], a[72:79], v22
  v_smfmac_f32_16x16x64_bf16 v[100:103], v[60:63], a[104:111], v22
  v_smfmac_f32_16x16x64_bf16 v[100:103], v[64:67], a[112:119], v22
  v_smfmac_f32_16x16x64_bf16 v[100:103], v[68:71], a[120:127], v22
  v_smfmac_f32_16x16x64_bf16 v[100:103], v[72:75], a[128:135], v22
  v_smfmac_f32_16x16x64_bf16 v[100:103], v[76:79], a[136:143], v22
  v_smfmac_f32_16x16x64_bf16 v[100:103], v[80:83], a[144:151], v22
  v_smfmac_f32_16x16x64_bf16 v[100:103], v[84:87], a[152:159], v22
  s_nop 7
  v_permlane32_swap_b32 v96, v100
  v_permlane32_swap_b32 v97, v101
  v_permlane32_swap_b32 v98, v102
  v_permlane32_swap_b32 v99, v103
  v_pk_add_f32 v[96:97], v[96:97], v[100:101]
  v_pk_add_f32 v[98:99], v[98:99], v[102:103]
  v_cvt_pk_bf16_f32 v100, v96, v97
  v_cvt_pk_bf16_f32 v101, v98, v99
  s_nop 0
  v_permlane32_swap_b32 v100, v102
  v_permlane32_swap_b32 v101, v103
  v_min_u32 v100, -2, v100
  buffer_store_dwordx4 v[100:103], v26, s[16:19], s70 offen sc1
  s_waitcnt vmcnt(0)
  s_barrier
  s_branch chain_done
E_27:
  v_add_u32 v190, 2048, v4
  ds_write_b64 v6, v[28:29]
  ds_write_b32 v13, v28
  ds_write_b32 v14, v28
  s_waitcnt vmcnt(0)
  ds_write_b128 v190, v[56:59] offset:0
  ds_write_b128 v190, v[60:63] offset:1024
  ds_write_b128 v190, v[64:67] offset:2048
  s_waitcnt lgkmcnt(0)
  s_add_u32 m0, s74, 6144
  s_add_u32 s21, s79, 196608
  buffer_load_dwordx4 v4, s[16:19], s21 offen offset:1024 sc1 lds
  s_add_u32 m0, s74, 4096
  s_mul_i32 s21, s91, 2
  s_add_u32 s21, s21, s71
  buffer_load_dwordx4 v4, s[16:19], s21 offen sc1 lds
  s_xor_b32 s74, s74, 16384
  s_add_u32 s73, s73, 2097152
  s_xor_b32 s73, s73, 8192
  s_add_u32 s79, s79, 2097152
  s_xor_b32 s79, s79, 8192
  s_add_u32 s21, s72, 524288
  s_xor_b32 s72, s72, s21
  s_lshr_b32 s72, s72, 8
  s_and_b32 s72, s72, 8192
  s_xor_b32 s72, s72, s21
  s_add_u32 s71, s73, 4096
  s_mov_b32 s91, 1024
  s_sub_u32 s21, s73, 0
  s_cmp_lt_u32 s21, 125829120
  s_cselect_b32 s71, s71, s79
  s_cselect_b32 s91, s91, 65536
  s_branch mo_164
  .p2align 3
top_159:
  s_waitcnt vmcnt(2)
  ds_write_b128 v190, v[56:59] offset:0
  v_cmp_eq_u32 s[22:23], -1, v56
  s_waitcnt vmcnt(1)
  ds_write_b128 v190, v[60:63] offset:1024
  v_cmp_eq_u32 s[98:99], -1, v60
  s_waitcnt vmcnt(0)
  ds_write_b128 v190, v[64:67] offset:2048
  v_cmp_eq_u32 s[100:101], -1, v64
  s_or_b64 vcc, s[22:23], s[98:99]
  s_or_b64 vcc, vcc, s[100:101]
  s_cbranch_scc1 mr_160
mo_164:
  s_barrier
  ds_read_b128 v[48:51], v4 offset:0
  ds_read_b128 v[52:55], v4 offset:1024
  v_smfmac_f32_16x16x64_bf16 v[92:95], v[56:59], v[192:199], v22
  ds_read_b128 v[68:71], v4 offset:5120
  v_smfmac_f32_16x16x64_bf16 v[88:91], v[56:59], a[176:183], v22
  ds_read_b128 v[72:75], v4 offset:6144
  v_smfmac_f32_16x16x64_bf16 v[92:95], v[60:63], v[200:207], v22
  ds_read_b128 v[76:79], v4 offset:7168
  v_smfmac_f32_16x16x64_bf16 v[88:91], v[60:63], a[184:191], v22
  ds_read_b128 v[80:83], v4 offset:8192
  v_smfmac_f32_16x16x64_bf16 v[92:95], v[64:67], v[208:215], v22
  ds_read_b128 v[84:87], v4 offset:9216
  v_smfmac_f32_16x16x64_bf16 v[88:91], v[64:67], a[192:199], v22
  s_waitcnt lgkmcnt(6)
  v_smfmac_f32_16x16x64_bf16 v[92:95], v[48:51], a[240:247], v22
  v_smfmac_f32_16x16x64_bf16 v[88:91], v[48:51], a[160:167], v22
  s_waitcnt lgkmcnt(5)
  v_smfmac_f32_16x16x64_bf16 v[92:95], v[52:55], a[248:255], v22
  s_waitcnt lgkmcnt(4)
  v_smfmac_f32_16x16x64_bf16 v[92:95], v[68:71], v[216:223], v22
  s_waitcnt lgkmcnt(3)
  v_smfmac_f32_16x16x64_bf16 v[92:95], v[72:75], v[224:231], v22
  s_waitcnt lgkmcnt(2)
  v_smfmac_f32_16x16x64_bf16 v[92:95], v[76:79], v[232:239], v22
  s_waitcnt lgkmcnt(1)
  v_smfmac_f32_16x16x64_bf16 v[92:95], v[80:83], v[240:247], v22
  s_waitcnt lgkmcnt(0)
  v_smfmac_f32_16x16x64_bf16 v[92:95], v[84:87], v[248:255], v22
  v_smfmac_f32_16x16x64_bf16 v[88:91], v[52:55], a[168:175], v22
  v_smfmac_f32_16x16x64_bf16 v[88:91], v[68:71], a[200:207], v22
  v_smfmac_f32_16x16x64_bf16 v[88:91], v[72:75], a[208:215], v22
  v_permlane32_swap_b32 v92, v93
  v_smfmac_f32_16x16x64_bf16 v[88:91], v[76:79], a[216:223], v22
  v_permlane32_swap_b32 v94, v95
  v_smfmac_f32_16x16x64_bf16 v[88:91], v[80:83], a[224:231], v22
  v_permlane32_swap_b32 v93, v92
  v_smfmac_f32_16x16x64_bf16 v[88:91], v[84:87], a[232:239], v22
  v_permlane32_swap_b32 v95, v94
  v_pk_mul_f32 v[120:121], v[92:93], v[24:25] op_sel:[1,0] op_sel_hi:[0,1]
  v_pk_mul_f32 v[122:123], v[94:95], v[24:25] op_sel:[1,0] op_sel_hi:[0,1]
  s_nop 4
  v_pk_fma_f32 v[88:89], v[88:89], v[24:25], v[120:121]
  v_pk_fma_f32 v[90:91], v[90:91], v[24:25], v[122:123]
  v_cvt_pk_bf16_f32 v120, v88, v89
  v_cvt_pk_bf16_f32 v121, v90, v91
  ds_write_b64 v6, v[120:121]
  s_barrier
  ds_read_b64_tr_b16 v[104:105], v7 offset:0
  ds_read_b64_tr_b16 v[106:107], v7 offset:768
  ds_read_b64_tr_b16 v[108:109], v7 offset:1536
  s_waitcnt lgkmcnt(1)
  v_mfma_f32_16x16x32_bf16 v[120:123], v[112:115], v[104:107], 0
  s_waitcnt lgkmcnt(0)
  v_mfma_f32_16x16x32_bf16 v[120:123], v[116:119], v[108:111], v[120:123]
  s_mov_b64 exec, s[64:65]
  s_nop 6
  v_cmpx_o_f32 vcc, v120, v121
  v_cvt_pk_f16_f32 v120, v120, v121
  v_cvt_pk_f16_f32 v121, v122, v123
  buffer_store_dwordx2 v[120:121], v8, s[8:11], s56 offen sc1
  s_xor_b64 s[98:99], exec, s[64:65]
  s_mov_b64 exec, -1
  s_waitcnt lgkmcnt(0)
  s_barrier
  ds_read_b64_tr_b16 v[104:105], v7 offset:0
  ds_read_b64_tr_b16 v[106:107], v7 offset:768
  ds_read_b64_tr_b16 v[108:109], v7 offset:1536
  ds_read_b32 v27, v12 offset:12544
  ds_read_b64 v[140:141], v11
  s_waitcnt lgkmcnt(1)
  v_cmp_u_f32 vcc, v104, v106
  v_cmp_u_f32 s[22:23], v108, v27
  s_nop 1
  s_or_b64 vcc, vcc, s[22:23]
  s_cbranch_vccnz mn_161
mk_162:
  s_cmp_eq_u32 s52, 63
  s_cbranch_scc1 last_163
  s_cmp_lg_u64 s[98:99], 0
  s_cbranch_scc1 sf_165
sf_166:
  s_nop 15
  s_nop 10
  v_smfmac_f32_16x16x64_bf16 v[96:99], v[48:51], a[0:7], v22
  v_smfmac_f32_16x16x64_bf16 v[100:103], v[48:51], a[80:87], v22
  v_smfmac_f32_16x16x64_bf16 v[96:99], v[52:55], a[8:15], v22
  v_smfmac_f32_16x16x64_bf16 v[100:103], v[52:55], a[88:95], v22
  v_smfmac_f32_16x16x64_bf16 v[96:99], v[56:59], a[16:23], v22
  v_smfmac_f32_16x16x64_bf16 v[100:103], v[56:59], a[96:103], v22
  buffer_load_dwordx4 v[132:135], v10, s[8:11], s56 offen sc1
  v_smfmac_f32_16x16x64_bf16 v[96:99], v[60:63], a[24:31], v22
  buffer_load_dwordx4 v[124:127], v9, s[8:11], s56 offen sc1
  v_smfmac_f32_16x16x64_bf16 v[96:99], v[64:67], a[32:39], v22
  buffer_load_dwordx4 v[128:131], v9, s[8:11], s56 offen offset:1024 sc1
  v_smfmac_f32_16x16x64_bf16 v[96:99], v[68:71], a[40:47], v22
  v_smfmac_f32_16x16x64_bf16 v[96:99], v[72:75], a[48:55], v22
  v_smfmac_f32_16x16x64_bf16 v[96:99], v[76:79], a[56:63], v22
  v_smfmac_f32_16x16x64_bf16 v[96:99], v[80:83], a[64:71], v22
  v_smfmac_f32_16x16x64_bf16 v[96:99], v[84:87], a[72:79], v22
  v_smfmac_f32_16x16x64_bf16 v[100:103], v[60:63], a[104:111], v22
  v_smfmac_f32_16x16x64_bf16 v[100:103], v[64:67], a[112:119], v22
  v_smfmac_f32_16x16x64_bf16 v[100:103], v[68:71], a[120:127], v22
  v_smfmac_f32_16x16x64_bf16 v[100:103], v[72:75], a[128:135], v22
  v_cvt_pk_bf16_f32 v136, v96, v97
  v_smfmac_f32_16x16x64_bf16 v[100:103], v[76:79], a[136:143], v22
  v_cvt_pk_bf16_f32 v137, v98, v99
  v_smfmac_f32_16x16x64_bf16 v[100:103], v[80:83], a[144:151], v22
  v_smfmac_f32_16x16x64_bf16 v[100:103], v[84:87], a[152:159], v22
  s_nop 7
  v_cvt_pk_bf16_f32 v138, v100, v101
  v_cvt_pk_bf16_f32 v139, v102, v103
  s_waitcnt vmcnt(2) lgkmcnt(0)
  v_pk_add_f16 v164, v132, v133
  v_pk_add_f16 v165, v134, v135
  v_fma_mix_f32 v170, v164, 1.0, v165 op_sel:[0,0,0] op_sel_hi:[1,0,1]
  v_fma_mix_f32 v171, v164, 1.0, v165 op_sel:[1,0,1] op_sel_hi:[1,0,1]
  v_exp_f32 v176, v170
  v_exp_f32 v177, v171
  s_waitcnt vmcnt(1)
  v_cvt_pk_bf16_f32 v160, v176, v177
  v_pk_add_f16 v120, v124, v126
  v_pk_add_f16 v121, v125, v127
  v_mov_b32_dpp v161, v160 row_ror:8 row_mask:0xf bank_mask:0xf
  s_waitcnt vmcnt(0)
  v_pk_add_f16 v122, v128, v130
  v_mfma_f32_16x16x32_bf16 v[178:181], v[140:143], v[160:163], 0
  v_fma_mix_f32 v166, v120, 1.0, v122 op_sel:[0,0,0] op_sel_hi:[1,0,1]
  v_fma_mix_f32 v167, v120, 1.0, v122 op_sel:[1,0,1] op_sel_hi:[1,0,1]
  v_cmp_u_f32 vcc, v166, v170
  v_pk_add_f16 v123, v129, v131
  v_exp_f32 v172, v166
  v_mfma_f32_16x16x32_bf16 v[182:185], v[136:139], v[160:163], 0
  s_cbranch_vccnz sr_167
  v_exp_f32 v173, v167
  v_fma_mix_f32 v168, v121, 1.0, v123 op_sel:[0,0,0] op_sel_hi:[1,0,1]
  v_fma_mix_f32 v169, v121, 1.0, v123 op_sel:[1,0,1] op_sel_hi:[1,0,1]
  v_cvt_pk_bf16_f32 v156, v172, v173
  v_exp_f32 v174, v168
  v_exp_f32 v175, v169
  v_mov_b32_dpp v158, v156 row_ror:8 row_mask:0xf bank_mask:0xf
  v_cvt_pk_bf16_f32 v157, v174, v175
  v_mfma_f32_16x16x32_bf16 v[186:189], v[138:141], v[160:163], 0
  s_nop 0
  v_mov_b32_dpp v159, v157 row_ror:8 row_mask:0xf bank_mask:0xf
  s_nop 1
pv_168:
  v_mfma_f32_16x16x32_bf16 v[178:181], v[152:155], v[156:159], v[178:181]
  v_mfma_f32_16x16x32_bf16 v[182:185], v[144:147], v[156:159], v[182:185]
  v_mfma_f32_16x16x32_bf16 v[186:189], v[148:151], v[156:159], v[186:189]
  s_mov_b64 exec, s[62:63]
  s_nop 0
  v_rcp_f32 v164, v180
  v_cmp_ngt_f32 s[22:23], s80, v180
  v_cmp_ngt_f32 vcc, s80, v164
  v_pk_mul_f32 v[182:183], v[182:183], v[164:165] op_sel_hi:[1,0]
  v_pk_mul_f32 v[184:185], v[184:185], v[164:165] op_sel_hi:[1,0]
  v_pk_mul_f32 v[178:179], v[178:179], v[164:165] op_sel_hi:[1,0]
  v_pk_mul_f32 v[186:187], v[186:187], v[164:165] op_sel_hi:[1,0]
  v_pk_mul_f32 v[188:189], v[188:189], v[164:165] op_sel_hi:[1,0]
  v_cvt_pk_f16_f32 v64, v178, v179
  s_or_b64 vcc, vcc, s[22:23]
  s_cbranch_scc1 fx_170
fk_171:
  ds_write_b32 v14, v64
  v_cvt_pk_f16_f32 v60, v182, v183
  v_cvt_pk_f16_f32 v61, v184, v185
  v_cvt_pk_f16_f32 v62, v186, v187
  v_cvt_pk_f16_f32 v63, v188, v189
  ds_write_b128 v13, v[60:63]
  s_barrier
  s_mov_b64 exec, -1
  s_add_u32 m0, s74, 6144
  s_add_u32 s21, s79, 196608
  buffer_load_dwordx4 v4, s[16:19], s21 offen offset:1024 sc1 lds
  s_add_u32 m0, s74, 4096
  s_mul_i32 s21, s91, 2
  s_add_u32 s21, s21, s71
  buffer_load_dwordx4 v4, s[16:19], s21 offen sc1 lds
  s_xor_b32 s74, s74, 16384
  s_add_u32 s73, s73, 2097152
  s_xor_b32 s73, s73, 8192
  s_add_u32 s79, s79, 2097152
  s_xor_b32 s79, s79, 8192
  s_add_u32 s21, s72, 524288
  s_xor_b32 s72, s72, s21
  s_lshr_b32 s72, s72, 8
  s_and_b32 s72, s72, 8192
  s_xor_b32 s72, s72, s21
  s_add_u32 s71, s73, 4096
  s_mov_b32 s91, 1024
  s_sub_u32 s21, s73, 0
  s_cmp_lt_u32 s21, 125829120
  s_cselect_b32 s71, s71, s79
  s_cselect_b32 s91, s91, 65536
  v_permlane32_swap_b32 v96, v100
  v_permlane32_swap_b32 v97, v101
  v_permlane32_swap_b32 v98, v102
  v_permlane32_swap_b32 v99, v103
  v_pk_add_f32 v[96:97], v[96:97], v[100:101]
  v_pk_add_f32 v[98:99], v[98:99], v[102:103]
  v_cvt_pk_bf16_f32 v100, v96, v97
  v_cvt_pk_bf16_f32 v101, v98, v99
  s_nop 0
  v_permlane32_swap_b32 v100, v102
  v_permlane32_swap_b32 v101, v103
  v_min_u32 v100, -2, v100
  s_nop 6
  buffer_store_dwordx4 v[100:103], v26, s[16:19], s70 offen sc1
  v_min_u32 v108, -2, v108
  buffer_store_dwordx2 v[108:109], v37, s[16:19], s70 offen offset:3072 sc1
  s_add_u32 s70, s70, 2097152
  s_xor_b32 s70, s70, 8192
  ds_read_b128 v[144:147], v18
  ds_read_b128 v[148:151], v18 offset:1024
  ds_read_b128 v[152:155], v19
  ds_read_b128 v[112:115], v20
  ds_read_b64 v[116:117], v21
  v_xor_b32 v18, 16384, v18
  v_xor_b32 v19, 16384, v19
  v_xor_b32 v20, 16384, v20
  v_xor_b32 v21, 16384, v21
  v_mov_b32 v88, 0
  v_mov_b32 v89, 0
  v_mov_b32 v90, 0
  v_mov_b32 v91, 0
  v_mov_b32 v92, 0
  v_mov_b32 v93, 0
  v_mov_b32 v94, 0
  v_mov_b32 v95, 0
  v_mov_b32 v96, 0
  v_mov_b32 v97, 0
  v_mov_b32 v98, 0
  v_mov_b32 v99, 0
  v_mov_b32 v100, 0
  v_mov_b32 v101, 0
  v_mov_b32 v102, 0
  v_mov_b32 v103, 0
  s_mov_b32 s81, 0
  s_waitcnt lgkmcnt(0)
  s_barrier
  s_mov_b64 exec, s[64:65]
  buffer_store_dwordx2 v[28:29], v8, s[8:11], s57 offen sc1
  s_mov_b64 exec, -1
  ds_write_b128 v190, v[28:31] offset:0
  ds_write_b128 v190, v[28:31] offset:1024
  ds_write_b128 v190, v[28:31] offset:2048
  ds_write_b64 v6, v[28:29]
  s_mov_b64 exec, s[62:63]
  buffer_store_dword v28, v17, s[8:11], s59 offen sc1
  s_mov_b64 exec, -1
  s_sleep 3
  s_nop 1
  buffer_load_dwordx4 v[68:71], v16, s[4:7], s60 offen sc1
  s_sleep 3
  s_nop 1
  buffer_load_dwordx4 v[72:75], v16, s[4:7], s60 offen sc1
  s_waitcnt vmcnt(1)
  v_mfma_f32_16x16x32_f16 v[120:123], v[44:47], v[68:71], 0
  v_bitop3_b32 v27, v68, s61, 1 bitop3:0x28
  v_cmp_ne_u32 vcc, 0, v27
  s_nop 1
  s_cbranch_vccnz p2_176
  s_nop 2
pg_175:
  v_add_f32_dpp v120, v120, v120 row_ror:8 row_mask:0xf bank_mask:0xf
  v_add_f32_dpp v121, v121, v121 row_ror:8 row_mask:0xf bank_mask:0xf
  s_mov_b64 exec, s[62:63]
  v_cvt_pk_bf16_f32 v120, v120, v121
  v_min_u32 v120, -2, v120
  buffer_store_dword v120, v17, s[8:11], s55 offen sc1
  s_mov_b64 exec, -1
nt_172:
  s_barrier
  s_mov_b32 s58, s55
  s_add_u32 s52, s52, 1
  ds_write_b32 v13, v28
  ds_write_b32 v14, v28
  s_and_b32 s21, s52, 3
  s_mul_i32 s56, s21, 122880
  s_add_u32 s21, s52, 1
  s_and_b32 s21, s21, 3
  s_mul_i32 s55, s21, 122880
  s_add_u32 s55, s55, s75
  s_add_u32 s21, s52, 2
  s_and_b32 s21, s21, 3
  s_mul_i32 s57, s21, 122880
  s_add_u32 s21, s52, 3
  s_and_b32 s21, s21, 3
  s_mul_i32 s59, s21, 122880
  s_add_u32 s59, s59, s75
  s_bfe_u32 s61, s52, 0x10002
  s_and_b32 s21, s52, 3
  s_lshl_b32 s60, s21, 18
  s_mov_b32 s54, 0
  s_sleep 2
  s_nop 10
  s_waitcnt lgkmcnt(0)
  buffer_load_dwordx4 v[56:59], v190, s[8:11], s58 offen offset:0 sc1
  buffer_load_dwordx4 v[60:63], v190, s[8:11], s58 offen offset:1024 sc1
  buffer_load_dwordx4 v[64:67], v190, s[8:11], s58 offen offset:2048 sc1
  s_branch top_159
mr_160:
  s_mov_b64 exec, s[22:23]
  s_cbranch_execz ms_177
  buffer_load_dwordx4 v[56:59], v190, s[8:11], s58 offen offset:0 sc1
ms_177:
  s_mov_b64 exec, s[98:99]
  s_cbranch_execz ms_178
  buffer_load_dwordx4 v[60:63], v190, s[8:11], s58 offen offset:1024 sc1
ms_178:
  s_mov_b64 exec, s[100:101]
  s_cbranch_execz ms_179
  buffer_load_dwordx4 v[64:67], v190, s[8:11], s58 offen offset:2048 sc1
ms_179:
  s_add_u32 s54, s54, 1
  s_cmp_gt_u32 s54, 131072
  s_cbranch_scc1 end0
  s_waitcnt vmcnt(0)
  s_mov_b64 exec, s[22:23]
  ds_write_b128 v190, v[56:59] offset:0
  v_cmp_eq_u32 s[22:23], -1, v56
  s_mov_b64 exec, s[98:99]
  ds_write_b128 v190, v[60:63] offset:1024
  v_cmp_eq_u32 s[98:99], -1, v60
  s_mov_b64 exec, s[100:101]
  ds_write_b128 v190, v[64:67] offset:2048
  v_cmp_eq_u32 s[100:101], -1, v64
  s_mov_b64 exec, -1
  s_or_b64 vcc, s[22:23], s[98:99]
  s_or_b64 vcc, vcc, s[100:101]
  s_cbranch_scc1 mr_160
  s_branch mo_164
sf_165:
  s_waitcnt lgkmcnt(1)
  v_mfma_f32_16x16x32_bf16 v[120:123], v[112:115], v[104:107], 0
  s_waitcnt lgkmcnt(0)
  v_mfma_f32_16x16x32_bf16 v[120:123], v[116:119], v[108:111], v[120:123]
  s_mov_b64 exec, s[64:65]
  s_nop 6
  v_cvt_pk_f16_f32 v120, v120, v121
  v_cvt_pk_f16_f32 v121, v122, v123
  buffer_store_dwordx2 v[120:121], v8, s[8:11], s56 offen sc1
  s_mov_b64 exec, -1
  s_branch sf_166
mn_161:
  s_bitcmp1_b32 s81, 1
  s_cbranch_scc1 mk_162
  s_or_b32 s81, s81, 2
  s_nop 7
  v_mov_b32 v88, 0
  v_mov_b32 v89, 0
  v_mov_b32 v90, 0
  v_mov_b32 v91, 0
  v_mov_b32 v92, 0
  v_mov_b32 v93, 0
  v_mov_b32 v94, 0
  v_mov_b32 v95, 0
  v_mov_b32 v96, 0
  v_mov_b32 v97, 0
  v_mov_b32 v98, 0
  v_mov_b32 v99, 0
  v_mov_b32 v100, 0
  v_mov_b32 v101, 0
  v_mov_b32 v102, 0
  v_mov_b32 v103, 0
  s_cmp_eq_u32 s52, 0
  s_cbranch_scc1 mx_181
mx_180:
  buffer_load_dwordx4 v[56:59], v190, s[8:11], s58 offen offset:0 sc1
  buffer_load_dwordx4 v[60:63], v190, s[8:11], s58 offen offset:1024 sc1
  buffer_load_dwordx4 v[64:67], v190, s[8:11], s58 offen offset:2048 sc1
  s_add_u32 s54, s54, 1
  s_cmp_gt_u32 s54, 131072
  s_cbranch_scc1 end0
  s_waitcnt vmcnt(0)
  v_max3_u32 v27, v56, v57, v58
  v_max3_u32 v27, v27, v59, v60
  v_max3_u32 v27, v27, v61, v62
  v_max3_u32 v27, v27, v63, v64
  v_max3_u32 v27, v27, v65, v66
  v_max3_u32 v27, v27, v67, v67
  v_cmp_eq_u32 vcc, -1, v27
  s_nop 1
  s_cbranch_vccnz mx_180
  ds_write_b128 v190, v[56:59] offset:0
  ds_write_b128 v190, v[60:63] offset:1024
  ds_write_b128 v190, v[64:67] offset:2048
mx_181:
  s_waitcnt lgkmcnt(0)
  s_branch mo_164
sr_167:
  s_mov_b32 s54, 0
sr_182:
  s_mov_b64 exec, vcc
  buffer_load_dwordx4 v[124:127], v9, s[8:11], s56 offen sc1
  buffer_load_dwordx4 v[128:131], v9, s[8:11], s56 offen offset:1024 sc1
  buffer_load_dwordx4 v[132:135], v10, s[8:11], s56 offen sc1
  s_mov_b64 exec, -1
  s_add_u32 s54, s54, 1
  s_cmp_gt_u32 s54, 131072
  s_cbranch_scc1 end0
  s_waitcnt vmcnt(0)
  v_pk_add_f16 v164, v132, v133
  v_pk_add_f16 v165, v134, v135
  v_pk_add_f16 v120, v124, v126
  v_pk_add_f16 v122, v128, v130
  v_fma_mix_f32 v170, v164, 1.0, v165 op_sel:[0,0,0] op_sel_hi:[1,0,1]
  v_fma_mix_f32 v166, v120, 1.0, v122 op_sel:[0,0,0] op_sel_hi:[1,0,1]
  v_pk_add_f16 v121, v125, v127
  v_cmp_u_f32 vcc, v166, v170
  v_pk_add_f16 v123, v129, v131
  v_fma_mix_f32 v171, v164, 1.0, v165 op_sel:[1,0,1] op_sel_hi:[1,0,1]
  v_fma_mix_f32 v167, v120, 1.0, v122 op_sel:[1,0,1] op_sel_hi:[1,0,1]
  v_fma_mix_f32 v168, v121, 1.0, v123 op_sel:[0,0,0] op_sel_hi:[1,0,1]
  v_fma_mix_f32 v169, v121, 1.0, v123 op_sel:[1,0,1] op_sel_hi:[1,0,1]
  s_cbranch_vccz ex_169
  s_and_b32 s21, s54, 31
  s_cbranch_scc1 sr_182
  v_max3_u32 v27, v124, v126, v128
  v_max3_u32 v27, v27, v130, v132
  v_max3_u32 v27, v27, v133, v134
  v_max3_u32 v27, v27, v135, v135
  v_cmp_eq_u32 vcc, -1, v27
  s_nop 1
  s_cbranch_vccnz sr_182
ex_169:
  v_exp_f32 v176, v170
  v_exp_f32 v177, v171
  v_exp_f32 v172, v166
  v_cvt_pk_bf16_f32 v160, v176, v177
  v_exp_f32 v173, v167
  v_exp_f32 v174, v168
  v_mov_b32_dpp v161, v160 row_ror:8 row_mask:0xf bank_mask:0xf
  v_cvt_pk_bf16_f32 v156, v172, v173
  v_exp_f32 v175, v169
  v_mfma_f32_16x16x32_bf16 v[178:181], v[140:143], v[160:163], 0
  v_mov_b32_dpp v158, v156 row_ror:8 row_mask:0xf bank_mask:0xf
  v_cvt_pk_bf16_f32 v157, v174, v175
  v_mfma_f32_16x16x32_bf16 v[182:185], v[136:139], v[160:163], 0
  s_nop 0
  v_mov_b32_dpp v159, v157 row_ror:8 row_mask:0xf bank_mask:0xf
  v_mfma_f32_16x16x32_bf16 v[186:189], v[138:141], v[160:163], 0
  s_branch pv_168
fx_170:
  s_bitcmp1_b32 s81, 0
  s_cbranch_scc1 fk_171
  s_or_b32 s81, s81, 1
  s_mov_b64 exec, -1
  v_max3_f32 v164, v166, v167, v168
  v_max3_f32 v165, v169, v170, v171
  v_max_f32 v164, v164, v165
  s_nop 1
  v_max_f32_dpp v164, v164, v164 row_ror:8 row_mask:0xf bank_mask:0xf
  v_mov_b32 v165, v164
  s_nop 1
  v_permlane32_swap_b32 v164, v165
  v_max_f32 v164, v164, v165
  v_mov_b32 v165, v164
  s_nop 1
  v_permlane16_swap_b32 v164, v165
  v_max_f32 v164, v164, v165
  v_sub_f32 v166, v166, v164
  v_sub_f32 v167, v167, v164
  v_sub_f32 v168, v168, v164
  v_sub_f32 v169, v169, v164
  v_sub_f32 v170, v170, v164
  v_sub_f32 v171, v171, v164
  s_branch ex_169
p2_176:
  s_mov_b32 s54, 0
  buffer_load_dwordx4 v[68:71], v16, s[4:7], s60 offen sc1
  s_waitcnt vmcnt(1)
  v_mfma_f32_16x16x32_f16 v[120:123], v[44:47], v[72:75], 0
  v_bitop3_b32 v27, v72, s61, 1 bitop3:0x28
  v_cmp_ne_u32 vcc, 0, v27
  s_nop 1
  s_cbranch_vccz pg_175
  buffer_load_dwordx4 v[72:75], v16, s[4:7], s60 offen sc1
pp_174:
  s_waitcnt vmcnt(1)
  v_mfma_f32_16x16x32_f16 v[120:123], v[44:47], v[68:71], 0
  v_bitop3_b32 v27, v68, s61, 1 bitop3:0x28
  v_cmp_ne_u32 vcc, 0, v27
  s_nop 1
  s_cbranch_vccz pg_175
  buffer_load_dwordx4 v[68:71], v16, s[4:7], s60 offen sc1
  s_waitcnt vmcnt(1)
  v_mfma_f32_16x16x32_f16 v[120:123], v[44:47], v[72:75], 0
  v_bitop3_b32 v27, v72, s61, 1 bitop3:0x28
  v_cmp_ne_u32 vcc, 0, v27
  s_nop 1
  s_cbranch_vccz pg_175
  buffer_load_dwordx4 v[72:75], v16, s[4:7], s60 offen sc1
  s_add_u32 s54, s54, 1
  s_cmp_gt_u32 s54, 131072
  s_cbranch_scc1 end0
  s_branch pp_174
last_163:
  v_min_u32 v108, -2, v108
  buffer_store_dwordx2 v[108:109], v37, s[16:19], s70 offen offset:3072 sc1
  v_smfmac_f32_16x16x64_bf16 v[96:99], v[48:51], a[0:7], v22
  v_smfmac_f32_16x16x64_bf16 v[100:103], v[48:51], a[80:87], v22
  v_smfmac_f32_16x16x64_bf16 v[96:99], v[52:55], a[8:15], v22
  v_smfmac_f32_16x16x64_bf16 v[100:103], v[52:55], a[88:95], v22
  v_smfmac_f32_16x16x64_bf16 v[96:99], v[56:59], a[16:23], v22
  v_smfmac_f32_16x16x64_bf16 v[100:103], v[56:59], a[96:103], v22
  v_smfmac_f32_16x16x64_bf16 v[96:99], v[60:63], a[24:31], v22
  v_smfmac_f32_16x16x64_bf16 v[96:99], v[64:67], a[32:39], v22
  v_smfmac_f32_16x16x64_bf16 v[96:99], v[68:71], a[40:47], v22
  v_smfmac_f32_16x16x64_bf16 v[96:99], v[72:75], a[48:55], v22
  v_smfmac_f32_16x16x64_bf16 v[96:99], v[76:79], a[56:63], v22
  v_smfmac_f32_16x16x64_bf16 v[96:99], v[80:83], a[64:71], v22
  v_smfmac_f32_16x16x64_bf16 v[96:99], v[84:87], a[72:79], v22
  v_smfmac_f32_16x16x64_bf16 v[100:103], v[60:63], a[104:111], v22
  v_smfmac_f32_16x16x64_bf16 v[100:103], v[64:67], a[112:119], v22
  v_smfmac_f32_16x16x64_bf16 v[100:103], v[68:71], a[120:127], v22
  v_smfmac_f32_16x16x64_bf16 v[100:103], v[72:75], a[128:135], v22
  v_smfmac_f32_16x16x64_bf16 v[100:103], v[76:79], a[136:143], v22
  v_smfmac_f32_16x16x64_bf16 v[100:103], v[80:83], a[144:151], v22
  v_smfmac_f32_16x16x64_bf16 v[100:103], v[84:87], a[152:159], v22
  s_nop 7
  v_permlane32_swap_b32 v96, v100
  v_permlane32_swap_b32 v97, v101
  v_permlane32_swap_b32 v98, v102
  v_permlane32_swap_b32 v99, v103
  v_pk_add_f32 v[96:97], v[96:97], v[100:101]
  v_pk_add_f32 v[98:99], v[98:99], v[102:103]
  v_cvt_pk_bf16_f32 v100, v96, v97
  v_cvt_pk_bf16_f32 v101, v98, v99
  s_nop 0
  v_permlane32_swap_b32 v100, v102
  v_permlane32_swap_b32 v101, v103
  v_min_u32 v100, -2, v100
  buffer_store_dwordx4 v[100:103], v26, s[16:19], s70 offen sc1
  s_waitcnt vmcnt(0)
  s_barrier
  s_branch chain_done
E_29:
  v_add_u32 v190, 5120, v4
  ds_write_b64 v6, v[28:29]
  ds_write_b32 v13, v28
  ds_write_b32 v14, v28
  s_waitcnt vmcnt(0)
  ds_write_b128 v190, v[68:71] offset:0
  ds_write_b128 v190, v[72:75] offset:1024
  s_waitcnt lgkmcnt(0)
  s_add_u32 m0, s74, 8192
  s_add_u32 s21, s72, 0
  buffer_load_dwordx4 v32, s[16:19], s21 offen sc1 lds
  s_add_u32 m0, s74, 6144
  s_mul_i32 s21, s91, 3
  s_add_u32 s21, s21, s71
  buffer_load_dwordx4 v4, s[16:19], s21 offen sc1 lds
  s_xor_b32 s74, s74, 16384
  s_add_u32 s73, s73, 2097152
  s_xor_b32 s73, s73, 8192
  s_add_u32 s79, s79, 2097152
  s_xor_b32 s79, s79, 8192
  s_add_u32 s21, s72, 524288
  s_xor_b32 s72, s72, s21
  s_lshr_b32 s72, s72, 8
  s_and_b32 s72, s72, 8192
  s_xor_b32 s72, s72, s21
  s_add_u32 s71, s73, 4096
  s_mov_b32 s91, 1024
  s_sub_u32 s21, s73, 0
  s_cmp_lt_u32 s21, 125829120
  s_cselect_b32 s71, s71, s79
  s_cselect_b32 s91, s91, 65536
  s_branch mo_189
  .p2align 3
top_184:
  s_waitcnt vmcnt(1)
  ds_write_b128 v190, v[68:71] offset:0
  v_cmp_eq_u32 s[22:23], -1, v68
  s_waitcnt vmcnt(0)
  ds_write_b128 v190, v[72:75] offset:1024
  v_cmp_eq_u32 s[98:99], -1, v72
  s_or_b64 vcc, s[22:23], s[98:99]
  s_cbranch_scc1 mr_185
mo_189:
  s_barrier
  ds_read_b128 v[48:51], v4 offset:0
  ds_read_b128 v[52:55], v4 offset:1024
  v_smfmac_f32_16x16x64_bf16 v[92:95], v[68:71], v[216:223], v22
  ds_read_b128 v[56:59], v4 offset:2048
  v_smfmac_f32_16x16x64_bf16 v[88:91], v[68:71], a[200:207], v22
  ds_read_b128 v[60:63], v4 offset:3072
  v_smfmac_f32_16x16x64_bf16 v[92:95], v[72:75], v[224:231], v22
  ds_read_b128 v[64:67], v4 offset:4096
  v_smfmac_f32_16x16x64_bf16 v[88:91], v[72:75], a[208:215], v22
  s_waitcnt lgkmcnt(4)
  ds_read_b128 v[76:79], v4 offset:7168
  v_smfmac_f32_16x16x64_bf16 v[92:95], v[48:51], a[240:247], v22
  ds_read_b128 v[80:83], v4 offset:8192
  v_smfmac_f32_16x16x64_bf16 v[88:91], v[48:51], a[160:167], v22
  s_waitcnt lgkmcnt(5)
  ds_read_b128 v[84:87], v4 offset:9216
  v_smfmac_f32_16x16x64_bf16 v[92:95], v[52:55], a[248:255], v22
  v_smfmac_f32_16x16x64_bf16 v[88:91], v[52:55], a[168:175], v22
  s_waitcnt lgkmcnt(5)
  v_smfmac_f32_16x16x64_bf16 v[92:95], v[56:59], v[192:199], v22
  s_waitcnt lgkmcnt(4)
  v_smfmac_f32_16x16x64_bf16 v[92:95], v[60:63], v[200:207], v22
  s_waitcnt lgkmcnt(3)
  v_smfmac_f32_16x16x64_bf16 v[92:95], v[64:67], v[208:215], v22
  s_waitcnt lgkmcnt(2)
  v_smfmac_f32_16x16x64_bf16 v[92:95], v[76:79], v[232:239], v22
  s_waitcnt lgkmcnt(1)
  v_smfmac_f32_16x16x64_bf16 v[92:95], v[80:83], v[240:247], v22
  s_waitcnt lgkmcnt(0)
  v_smfmac_f32_16x16x64_bf16 v[92:95], v[84:87], v[248:255], v22
  v_smfmac_f32_16x16x64_bf16 v[88:91], v[56:59], a[176:183], v22
  v_smfmac_f32_16x16x64_bf16 v[88:91], v[60:63], a[184:191], v22
  v_smfmac_f32_16x16x64_bf16 v[88:91], v[64:67], a[192:199], v22
  v_permlane32_swap_b32 v92, v93
  v_smfmac_f32_16x16x64_bf16 v[88:91], v[76:79], a[216:223], v22
  v_permlane32_swap_b32 v94, v95
  v_smfmac_f32_16x16x64_bf16 v[88:91], v[80:83], a[224:231], v22
  v_permlane32_swap_b32 v93, v92
  v_smfmac_f32_16x16x64_bf16 v[88:91], v[84:87], a[232:239], v22
  v_permlane32_swap_b32 v95, v94
  v_pk_mul_f32 v[120:121], v[92:93], v[24:25] op_sel:[1,0] op_sel_hi:[0,1]
  v_pk_mul_f32 v[122:123], v[94:95], v[24:25] op_sel:[1,0] op_sel_hi:[0,1]
  s_nop 4
  v_pk_fma_f32 v[88:89], v[88:89], v[24:25], v[120:121]
  v_pk_fma_f32 v[90:91], v[90:91], v[24:25], v[122:123]
  v_cvt_pk_bf16_f32 v120, v88, v89
  v_cvt_pk_bf16_f32 v121, v90, v91
  ds_write_b64 v6, v[120:121]
  s_barrier
  ds_read_b64_tr_b16 v[104:105], v7 offset:0
  ds_read_b64_tr_b16 v[106:107], v7 offset:768
  ds_read_b64_tr_b16 v[108:109], v7 offset:1536
  s_waitcnt lgkmcnt(1)
  v_mfma_f32_16x16x32_bf16 v[120:123], v[104:107], v[104:107], 0
  s_waitcnt lgkmcnt(0)
  v_mfma_f32_16x16x32_bf16 v[120:123], v[108:111], v[108:111], v[120:123]
  s_mov_b64 exec, s[64:65]
  s_nop 6
  v_cmpx_o_f32 vcc, v120, v121
  v_cvt_pk_f16_f32 v120, v120, v121
  buffer_store_dword v120, v8, s[8:11], s56 offen sc1
  v_cmpx_o_f32 vcc, v122, v123
  v_cvt_pk_f16_f32 v121, v122, v123
  buffer_store_dword v121, v8, s[8:11], s56 offen offset:128 sc1
  s_xor_b64 s[98:99], exec, s[64:65]
  s_mov_b64 exec, -1
  s_waitcnt lgkmcnt(0)
  s_barrier
  ds_read_b64_tr_b16 v[104:105], v7 offset:0
  ds_read_b64_tr_b16 v[106:107], v7 offset:768
  ds_read_b64_tr_b16 v[108:109], v7 offset:1536
  ds_read_b32 v27, v12 offset:12544
  ds_read_b64 v[140:141], v11
  s_waitcnt lgkmcnt(1)
  v_cmp_u_f32 vcc, v104, v106
  v_cmp_u_f32 s[22:23], v108, v27
  s_nop 1
  s_or_b64 vcc, vcc, s[22:23]
  s_cbranch_vccnz mn_186
mk_187:
  s_cmp_eq_u32 s52, 63
  s_cbranch_scc1 last_188
  s_cmp_lg_u64 s[98:99], 0
  s_cbranch_scc1 sf_190
sf_191:
  s_nop 15
  s_nop 10
  v_smfmac_f32_16x16x64_bf16 v[96:99], v[48:51], a[0:7], v22
  v_smfmac_f32_16x16x64_bf16 v[100:103], v[48:51], a[80:87], v22
  v_smfmac_f32_16x16x64_bf16 v[96:99], v[52:55], a[8:15], v22
  v_smfmac_f32_16x16x64_bf16 v[100:103], v[52:55], a[88:95], v22
  v_smfmac_f32_16x16x64_bf16 v[96:99], v[56:59], a[16:23], v22
  v_smfmac_f32_16x16x64_bf16 v[100:103], v[56:59], a[96:103], v22
  buffer_load_dwordx4 v[132:135], v10, s[8:11], s56 offen sc1
  v_smfmac_f32_16x16x64_bf16 v[96:99], v[60:63], a[24:31], v22
  buffer_load_dwordx4 v[124:127], v9, s[8:11], s56 offen sc1
  v_smfmac_f32_16x16x64_bf16 v[96:99], v[64:67], a[32:39], v22
  buffer_load_dwordx4 v[128:131], v9, s[8:11], s56 offen offset:1024 sc1
  v_smfmac_f32_16x16x64_bf16 v[96:99], v[68:71], a[40:47], v22
  v_smfmac_f32_16x16x64_bf16 v[96:99], v[72:75], a[48:55], v22
  v_smfmac_f32_16x16x64_bf16 v[96:99], v[76:79], a[56:63], v22
  v_smfmac_f32_16x16x64_bf16 v[96:99], v[80:83], a[64:71], v22
  v_smfmac_f32_16x16x64_bf16 v[96:99], v[84:87], a[72:79], v22
  v_smfmac_f32_16x16x64_bf16 v[100:103], v[60:63], a[104:111], v22
  v_smfmac_f32_16x16x64_bf16 v[100:103], v[64:67], a[112:119], v22
  v_smfmac_f32_16x16x64_bf16 v[100:103], v[68:71], a[120:127], v22
  v_smfmac_f32_16x16x64_bf16 v[100:103], v[72:75], a[128:135], v22
  v_cvt_pk_bf16_f32 v136, v96, v97
  v_smfmac_f32_16x16x64_bf16 v[100:103], v[76:79], a[136:143], v22
  v_cvt_pk_bf16_f32 v137, v98, v99
  v_smfmac_f32_16x16x64_bf16 v[100:103], v[80:83], a[144:151], v22
  v_smfmac_f32_16x16x64_bf16 v[100:103], v[84:87], a[152:159], v22
  s_nop 7
  v_cvt_pk_bf16_f32 v138, v100, v101
  v_cvt_pk_bf16_f32 v139, v102, v103
  s_waitcnt vmcnt(2) lgkmcnt(0)
  v_pk_add_f16 v164, v132, v133
  v_pk_add_f16 v165, v134, v135
  v_fma_mix_f32 v170, v164, 1.0, v165 op_sel:[0,0,0] op_sel_hi:[1,0,1]
  v_fma_mix_f32 v171, v164, 1.0, v165 op_sel:[1,0,1] op_sel_hi:[1,0,1]
  v_exp_f32 v176, v170
  v_exp_f32 v177, v171
  s_waitcnt vmcnt(1)
  v_cvt_pk_bf16_f32 v160, v176, v177
  v_pk_add_f16 v120, v124, v126
  v_pk_add_f16 v121, v125, v127
  v_mov_b32_dpp v161, v160 row_ror:8 row_mask:0xf bank_mask:0xf
  s_waitcnt vmcnt(0)
  v_pk_add_f16 v122, v128, v130
  v_mfma_f32_16x16x32_bf16 v[178:181], v[140:143], v[160:163], 0
  v_fma_mix_f32 v166, v120, 1.0, v122 op_sel:[0,0,0] op_sel_hi:[1,0,1]
  v_fma_mix_f32 v167, v120, 1.0, v122 op_sel:[1,0,1] op_sel_hi:[1,0,1]
  v_cmp_u_f32 vcc, v166, v170
  v_pk_add_f16 v123, v129, v131
  v_exp_f32 v172, v166
  v_mfma_f32_16x16x32_bf16 v[182:185], v[136:139], v[160:163], 0
  s_cbranch_vccnz sr_192
  v_exp_f32 v173, v167
  v_fma_mix_f32 v168, v121, 1.0, v123 op_sel:[0,0,0] op_sel_hi:[1,0,1]
  v_fma_mix_f32 v169, v121, 1.0, v123 op_sel:[1,0,1] op_sel_hi:[1,0,1]
  v_cvt_pk_bf16_f32 v156, v172, v173
  v_exp_f32 v174, v168
  v_exp_f32 v175, v169
  v_mov_b32_dpp v158, v156 row_ror:8 row_mask:0xf bank_mask:0xf
  v_cvt_pk_bf16_f32 v157, v174, v175
  v_mfma_f32_16x16x32_bf16 v[186:189], v[138:141], v[160:163], 0
  s_nop 0
  v_mov_b32_dpp v159, v157 row_ror:8 row_mask:0xf bank_mask:0xf
  s_nop 1
pv_193:
  v_mfma_f32_16x16x32_bf16 v[178:181], v[152:155], v[156:159], v[178:181]
  v_mfma_f32_16x16x32_bf16 v[182:185], v[144:147], v[156:159], v[182:185]
  v_mfma_f32_16x16x32_bf16 v[186:189], v[148:151], v[156:159], v[186:189]
  s_mov_b64 exec, s[62:63]
  s_nop 0
  v_rcp_f32 v164, v180
  v_cmp_ngt_f32 s[22:23], s80, v180
  v_cmp_ngt_f32 vcc, s80, v164
  v_pk_mul_f32 v[182:183], v[182:183], v[164:165] op_sel_hi:[1,0]
  v_pk_mul_f32 v[184:185], v[184:185], v[164:165] op_sel_hi:[1,0]
  v_pk_mul_f32 v[178:179], v[178:179], v[164:165] op_sel_hi:[1,0]
  v_pk_mul_f32 v[186:187], v[186:187], v[164:165] op_sel_hi:[1,0]
  v_pk_mul_f32 v[188:189], v[188:189], v[164:165] op_sel_hi:[1,0]
  v_cvt_pk_f16_f32 v64, v178, v179
  s_or_b64 vcc, vcc, s[22:23]
  s_cbranch_scc1 fx_195
fk_196:
  ds_write_b32 v14, v64
  v_cvt_pk_f16_f32 v60, v182, v183
  v_cvt_pk_f16_f32 v61, v184, v185
  v_cvt_pk_f16_f32 v62, v186, v187
  v_cvt_pk_f16_f32 v63, v188, v189
  ds_write_b128 v13, v[60:63]
  s_barrier
  s_mov_b64 exec, -1
  s_and_b32 s21, s52, 3
  s_cmp_lt_u32 s52, 58
  s_cselect_b32 s21, s21, 0
  s_cmp_lg_u32 s21, 0
  s_cbranch_scc1 fs_197
  v_mov_b32 v27, s52
  s_mov_b64 exec, 1
  buffer_store_dword v27, v23, s[12:15], s77 offen sc1
  s_mov_b64 exec, -1
fs_197:
  s_add_u32 m0, s74, 8192
  s_add_u32 s21, s72, 0
  buffer_load_dwordx4 v32, s[16:19], s21 offen sc1 lds
  s_add_u32 m0, s74, 6144
  s_mul_i32 s21, s91, 3
  s_add_u32 s21, s21, s71
  buffer_load_dwordx4 v4, s[16:19], s21 offen sc1 lds
  s_xor_b32 s74, s74, 16384
  s_add_u32 s73, s73, 2097152
  s_xor_b32 s73, s73, 8192
  s_add_u32 s79, s79, 2097152
  s_xor_b32 s79, s79, 8192
  s_add_u32 s21, s72, 524288
  s_xor_b32 s72, s72, s21
  s_lshr_b32 s72, s72, 8
  s_and_b32 s72, s72, 8192
  s_xor_b32 s72, s72, s21
  s_add_u32 s71, s73, 4096
  s_mov_b32 s91, 1024
  s_sub_u32 s21, s73, 0
  s_cmp_lt_u32 s21, 125829120
  s_cselect_b32 s71, s71, s79
  s_cselect_b32 s91, s91, 65536
  v_permlane32_swap_b32 v96, v100
  v_permlane32_swap_b32 v97, v101
  v_permlane32_swap_b32 v98, v102
  v_permlane32_swap_b32 v99, v103
  v_pk_add_f32 v[96:97], v[96:97], v[100:101]
  v_pk_add_f32 v[98:99], v[98:99], v[102:103]
  v_cvt_pk_bf16_f32 v100, v96, v97
  v_cvt_pk_bf16_f32 v101, v98, v99
  s_nop 0
  v_permlane32_swap_b32 v100, v102
  v_permlane32_swap_b32 v101, v103
  v_min_u32 v100, -2, v100
  s_nop 6
  buffer_store_dwordx4 v[100:103], v26, s[16:19], s70 offen sc1
  s_add_u32 s70, s70, 2097152
  s_xor_b32 s70, s70, 8192
  ds_read_b128 v[144:147], v18
  ds_read_b128 v[148:151], v18 offset:1024
  ds_read_b128 v[152:155], v19
  v_xor_b32 v18, 16384, v18
  v_xor_b32 v19, 16384, v19
  v_mov_b32 v88, 0
  v_mov_b32 v89, 0
  v_mov_b32 v90, 0
  v_mov_b32 v91, 0
  v_mov_b32 v92, 0
  v_mov_b32 v93, 0
  v_mov_b32 v94, 0
  v_mov_b32 v95, 0
  v_mov_b32 v96, 0
  v_mov_b32 v97, 0
  v_mov_b32 v98, 0
  v_mov_b32 v99, 0
  v_mov_b32 v100, 0
  v_mov_b32 v101, 0
  v_mov_b32 v102, 0
  v_mov_b32 v103, 0
  s_mov_b32 s81, 0
  s_waitcnt lgkmcnt(0)
  s_barrier
  s_mov_b64 exec, s[64:65]
  buffer_store_dword v28, v8, s[8:11], s57 offen sc1
  buffer_store_dword v28, v8, s[8:11], s57 offen offset:128 sc1
  s_mov_b64 exec, -1
  ds_write_b128 v190, v[28:31] offset:0
  ds_write_b128 v190, v[28:31] offset:1024
  ds_write_b64 v6, v[28:29]
  s_mov_b64 exec, -1
  s_cmp_eq_u32 s78, 0
  s_cbranch_scc1 nt_199
  s_mov_b64 exec, s[62:63]
  buffer_store_dword v28, v17, s[8:11], s59 offen sc1
  s_mov_b64 exec, -1
  s_sleep 3
  s_nop 1
  buffer_load_dwordx4 v[68:71], v16, s[4:7], s60 offen sc1
  s_sleep 3
  s_nop 1
  buffer_load_dwordx4 v[72:75], v16, s[4:7], s60 offen sc1
  s_waitcnt vmcnt(1)
  v_mfma_f32_16x16x32_f16 v[120:123], v[44:47], v[68:71], 0
  v_bitop3_b32 v27, v68, s61, 1 bitop3:0x28
  v_cmp_ne_u32 vcc, 0, v27
  s_nop 1
  s_cbranch_vccnz p2_202
  s_nop 2
pg_201:
  v_add_f32_dpp v120, v120, v120 row_ror:8 row_mask:0xf bank_mask:0xf
  v_add_f32_dpp v121, v121, v121 row_ror:8 row_mask:0xf bank_mask:0xf
  s_mov_b64 exec, s[62:63]
  v_cvt_pk_bf16_f32 v120, v120, v121
  v_min_u32 v120, -2, v120
  buffer_store_dword v120, v17, s[8:11], s55 offen sc1
  s_mov_b64 exec, -1
nt_198:
  s_barrier
  s_mov_b32 s58, s55
  s_add_u32 s52, s52, 1
  ds_write_b32 v13, v28
  ds_write_b32 v14, v28
  s_and_b32 s21, s52, 3
  s_mul_i32 s56, s21, 122880
  s_add_u32 s21, s52, 1
  s_and_b32 s21, s21, 3
  s_mul_i32 s55, s21, 122880
  s_add_u32 s55, s55, s75
  s_add_u32 s21, s52, 2
  s_and_b32 s21, s21, 3
  s_mul_i32 s57, s21, 122880
  s_add_u32 s21, s52, 3
  s_and_b32 s21, s21, 3
  s_mul_i32 s59, s21, 122880
  s_add_u32 s59, s59, s75
  s_bfe_u32 s61, s52, 0x10002
  s_and_b32 s21, s52, 3
  s_lshl_b32 s60, s21, 18
  s_mov_b32 s54, 0
  s_sleep 2
  s_nop 10
  s_waitcnt lgkmcnt(0)
  buffer_load_dwordx4 v[68:71], v190, s[8:11], s58 offen offset:0 sc1
  buffer_load_dwordx4 v[72:75], v190, s[8:11], s58 offen offset:1024 sc1
  s_branch top_184
mr_185:
  s_mov_b64 exec, s[22:23]
  s_cbranch_execz ms_203
  buffer_load_dwordx4 v[68:71], v190, s[8:11], s58 offen offset:0 sc1
ms_203:
  s_mov_b64 exec, s[98:99]
  s_cbranch_execz ms_204
  buffer_load_dwordx4 v[72:75], v190, s[8:11], s58 offen offset:1024 sc1
ms_204:
  s_add_u32 s54, s54, 1
  s_cmp_gt_u32 s54, 131072
  s_cbranch_scc1 end0
  s_waitcnt vmcnt(0)
  s_mov_b64 exec, s[22:23]
  ds_write_b128 v190, v[68:71] offset:0
  v_cmp_eq_u32 s[22:23], -1, v68
  s_mov_b64 exec, s[98:99]
  ds_write_b128 v190, v[72:75] offset:1024
  v_cmp_eq_u32 s[98:99], -1, v72
  s_mov_b64 exec, -1
  s_or_b64 vcc, s[22:23], s[98:99]
  s_cbranch_scc1 mr_185
  s_branch mo_189
sf_190:
  s_waitcnt lgkmcnt(1)
  v_mfma_f32_16x16x32_bf16 v[120:123], v[104:107], v[104:107], 0
  s_waitcnt lgkmcnt(0)
  v_mfma_f32_16x16x32_bf16 v[120:123], v[108:111], v[108:111], v[120:123]
  s_mov_b64 exec, s[64:65]
  s_nop 6
  v_cvt_pk_f16_f32 v120, v120, v121
  buffer_store_dword v120, v8, s[8:11], s56 offen sc1
  v_cvt_pk_f16_f32 v121, v122, v123
  buffer_store_dword v121, v8, s[8:11], s56 offen offset:128 sc1
  s_mov_b64 exec, -1
  s_branch sf_191
mn_186:
  s_bitcmp1_b32 s81, 1
  s_cbranch_scc1 mk_187
  s_or_b32 s81, s81, 2
  s_nop 7
  v_mov_b32 v88, 0
  v_mov_b32 v89, 0
  v_mov_b32 v90, 0
  v_mov_b32 v91, 0
  v_mov_b32 v92, 0
  v_mov_b32 v93, 0
  v_mov_b32 v94, 0
  v_mov_b32 v95, 0
  v_mov_b32 v96, 0
  v_mov_b32 v97, 0
  v_mov_b32 v98, 0
  v_mov_b32 v99, 0
  v_mov_b32 v100, 0
  v_mov_b32 v101, 0
  v_mov_b32 v102, 0
  v_mov_b32 v103, 0
  s_cmp_eq_u32 s52, 0
  s_cbranch_scc1 mx_206
mx_205:
  buffer_load_dwordx4 v[68:71], v190, s[8:11], s58 offen offset:0 sc1
  buffer_load_dwordx4 v[72:75], v190, s[8:11], s58 offen offset:1024 sc1
  s_add_u32 s54, s54, 1
  s_cmp_gt_u32 s54, 131072
  s_cbranch_scc1 end0
  s_waitcnt vmcnt(0)
  v_max3_u32 v27, v68, v69, v70
  v_max3_u32 v27, v27, v71, v72
  v_max3_u32 v27, v27, v73, v74
  v_max3_u32 v27, v27, v75, v75
  v_cmp_eq_u32 vcc, -1, v27
  s_nop 1
  s_cbranch_vccnz mx_205
  ds_write_b128 v190, v[68:71] offset:0
  ds_write_b128 v190, v[72:75] offset:1024
mx_206:
  s_waitcnt lgkmcnt(0)
  s_branch mo_189
sr_192:
  s_mov_b32 s54, 0
sr_207:
  s_mov_b64 exec, vcc
  buffer_load_dwordx4 v[124:127], v9, s[8:11], s56 offen sc1
  buffer_load_dwordx4 v[128:131], v9, s[8:11], s56 offen offset:1024 sc1
  buffer_load_dwordx4 v[132:135], v10, s[8:11], s56 offen sc1
  s_mov_b64 exec, -1
  s_add_u32 s54, s54, 1
  s_cmp_gt_u32 s54, 131072
  s_cbranch_scc1 end0
  s_waitcnt vmcnt(0)
  v_pk_add_f16 v164, v132, v133
  v_pk_add_f16 v165, v134, v135
  v_pk_add_f16 v120, v124, v126
  v_pk_add_f16 v122, v128, v130
  v_fma_mix_f32 v170, v164, 1.0, v165 op_sel:[0,0,0] op_sel_hi:[1,0,1]
  v_fma_mix_f32 v166, v120, 1.0, v122 op_sel:[0,0,0] op_sel_hi:[1,0,1]
  v_pk_add_f16 v121, v125, v127
  v_cmp_u_f32 vcc, v166, v170
  v_pk_add_f16 v123, v129, v131
  v_fma_mix_f32 v171, v164, 1.0, v165 op_sel:[1,0,1] op_sel_hi:[1,0,1]
  v_fma_mix_f32 v167, v120, 1.0, v122 op_sel:[1,0,1] op_sel_hi:[1,0,1]
  v_fma_mix_f32 v168, v121, 1.0, v123 op_sel:[0,0,0] op_sel_hi:[1,0,1]
  v_fma_mix_f32 v169, v121, 1.0, v123 op_sel:[1,0,1] op_sel_hi:[1,0,1]
  s_cbranch_vccz ex_194
  s_and_b32 s21, s54, 31
  s_cbranch_scc1 sr_207
  v_max3_u32 v27, v124, v126, v128
  v_max3_u32 v27, v27, v130, v132
  v_max3_u32 v27, v27, v133, v134
  v_max3_u32 v27, v27, v135, v135
  v_cmp_eq_u32 vcc, -1, v27
  s_nop 1
  s_cbranch_vccnz sr_207
ex_194:
  v_exp_f32 v176, v170
  v_exp_f32 v177, v171
  v_exp_f32 v172, v166
  v_cvt_pk_bf16_f32 v160, v176, v177
  v_exp_f32 v173, v167
  v_exp_f32 v174, v168
  v_mov_b32_dpp v161, v160 row_ror:8 row_mask:0xf bank_mask:0xf
  v_cvt_pk_bf16_f32 v156, v172, v173
  v_exp_f32 v175, v169
  v_mfma_f32_16x16x32_bf16 v[178:181], v[140:143], v[160:163], 0
  v_mov_b32_dpp v158, v156 row_ror:8 row_mask:0xf bank_mask:0xf
  v_cvt_pk_bf16_f32 v157, v174, v175
  v_mfma_f32_16x16x32_bf16 v[182:185], v[136:139], v[160:163], 0
  s_nop 0
  v_mov_b32_dpp v159, v157 row_ror:8 row_mask:0xf bank_mask:0xf
  v_mfma_f32_16x16x32_bf16 v[186:189], v[138:141], v[160:163], 0
  s_branch pv_193
fx_195:
  s_bitcmp1_b32 s81, 0
  s_cbranch_scc1 fk_196
  s_or_b32 s81, s81, 1
  s_mov_b64 exec, -1
  v_max3_f32 v164, v166, v167, v168
  v_max3_f32 v165, v169, v170, v171
  v_max_f32 v164, v164, v165
  s_nop 1
  v_max_f32_dpp v164, v164, v164 row_ror:8 row_mask:0xf bank_mask:0xf
  v_mov_b32 v165, v164
  s_nop 1
  v_permlane32_swap_b32 v164, v165
  v_max_f32 v164, v164, v165
  v_mov_b32 v165, v164
  s_nop 1
  v_permlane16_swap_b32 v164, v165
  v_max_f32 v164, v164, v165
  v_sub_f32 v166, v166, v164
  v_sub_f32 v167, v167, v164
  v_sub_f32 v168, v168, v164
  v_sub_f32 v169, v169, v164
  v_sub_f32 v170, v170, v164
  v_sub_f32 v171, v171, v164
  s_branch ex_194
nt_199:
  s_branch nt_198
p2_202:
  s_mov_b32 s54, 0
  buffer_load_dwordx4 v[68:71], v16, s[4:7], s60 offen sc1
  s_waitcnt vmcnt(1)
  v_mfma_f32_16x16x32_f16 v[120:123], v[44:47], v[72:75], 0
  v_bitop3_b32 v27, v72, s61, 1 bitop3:0x28
  v_cmp_ne_u32 vcc, 0, v27
  s_nop 1
  s_cbranch_vccz pg_201
  buffer_load_dwordx4 v[72:75], v16, s[4:7], s60 offen sc1
pp_200:
  s_waitcnt vmcnt(1)
  v_mfma_f32_16x16x32_f16 v[120:123], v[44:47], v[68:71], 0
  v_bitop3_b32 v27, v68, s61, 1 bitop3:0x28
  v_cmp_ne_u32 vcc, 0, v27
  s_nop 1
  s_cbranch_vccz pg_201
  buffer_load_dwordx4 v[68:71], v16, s[4:7], s60 offen sc1
  s_waitcnt vmcnt(1)
  v_mfma_f32_16x16x32_f16 v[120:123], v[44:47], v[72:75], 0
  v_bitop3_b32 v27, v72, s61, 1 bitop3:0x28
  v_cmp_ne_u32 vcc, 0, v27
  s_nop 1
  s_cbranch_vccz pg_201
  buffer_load_dwordx4 v[72:75], v16, s[4:7], s60 offen sc1
  s_add_u32 s54, s54, 1
  s_cmp_gt_u32 s54, 131072
  s_cbranch_scc1 end0
  s_branch pp_200
last_188:
  v_smfmac_f32_16x16x64_bf16 v[96:99], v[48:51], a[0:7], v22
  v_smfmac_f32_16x16x64_bf16 v[100:103], v[48:51], a[80:87], v22
  v_smfmac_f32_16x16x64_bf16 v[96:99], v[52:55], a[8:15], v22
  v_smfmac_f32_16x16x64_bf16 v[100:103], v[52:55], a[88:95], v22
  v_smfmac_f32_16x16x64_bf16 v[96:99], v[56:59], a[16:23], v22
  v_smfmac_f32_16x16x64_bf16 v[100:103], v[56:59], a[96:103], v22
  v_smfmac_f32_16x16x64_bf16 v[96:99], v[60:63], a[24:31], v22
  v_smfmac_f32_16x16x64_bf16 v[96:99], v[64:67], a[32:39], v22
  v_smfmac_f32_16x16x64_bf16 v[96:99], v[68:71], a[40:47], v22
  v_smfmac_f32_16x16x64_bf16 v[96:99], v[72:75], a[48:55], v22
  v_smfmac_f32_16x16x64_bf16 v[96:99], v[76:79], a[56:63], v22
  v_smfmac_f32_16x16x64_bf16 v[96:99], v[80:83], a[64:71], v22
  v_smfmac_f32_16x16x64_bf16 v[96:99], v[84:87], a[72:79], v22
  v_smfmac_f32_16x16x64_bf16 v[100:103], v[60:63], a[104:111], v22
  v_smfmac_f32_16x16x64_bf16 v[100:103], v[64:67], a[112:119], v22
  v_smfmac_f32_16x16x64_bf16 v[100:103], v[68:71], a[120:127], v22
  v_smfmac_f32_16x16x64_bf16 v[100:103], v[72:75], a[128:135], v22
  v_smfmac_f32_16x16x64_bf16 v[100:103], v[76:79], a[136:143], v22
  v_smfmac_f32_16x16x64_bf16 v[100:103], v[80:83], a[144:151], v22
  v_smfmac_f32_16x16x64_bf16 v[100:103], v[84:87], a[152:159], v22
  s_nop 7
  v_permlane32_swap_b32 v96, v100
  v_permlane32_swap_b32 v97, v101
  v_permlane32_swap_b32 v98, v102
  v_permlane32_swap_b32 v99, v103
  v_pk_add_f32 v[96:97], v[96:97], v[100:101]
  v_pk_add_f32 v[98:99], v[98:99], v[102:103]
  v_cvt_pk_bf16_f32 v100, v96, v97
  v_cvt_pk_bf16_f32 v101, v98, v99
  s_nop 0
  v_permlane32_swap_b32 v100, v102
  v_permlane32_swap_b32 v101, v103
  v_min_u32 v100, -2, v100
  buffer_store_dwordx4 v[100:103], v26, s[16:19], s70 offen sc1
  s_waitcnt vmcnt(0)
  s_barrier
  s_branch chain_done
E_31:
  v_add_u32 v190, 7168, v4
  ds_write_b32 v13, v28
  ds_write_b32 v14, v28
  s_waitcnt vmcnt(0)
  ds_write_b128 v190, v[76:79] offset:0
  ds_write_b128 v190, v[80:83] offset:1024
  ds_write_b128 v190, v[84:87] offset:2048
  s_waitcnt lgkmcnt(0)
  s_branch mo_214
  .p2align 3
top_209:
  s_waitcnt vmcnt(2)
  ds_write_b128 v190, v[76:79] offset:0
  v_cmp_eq_u32 s[22:23], -1, v76
  s_waitcnt vmcnt(1)
  ds_write_b128 v190, v[80:83] offset:1024
  v_cmp_eq_u32 s[98:99], -1, v80
  s_waitcnt vmcnt(0)
  ds_write_b128 v190, v[84:87] offset:2048
  v_cmp_eq_u32 s[100:101], -1, v84
  s_or_b64 vcc, s[22:23], s[98:99]
  s_or_b64 vcc, vcc, s[100:101]
  s_cbranch_scc1 mr_210
mo_214:
  s_barrier
  ds_read_b128 v[48:51], v4 offset:0
  ds_read_b128 v[52:55], v4 offset:1024
  v_smfmac_f32_16x16x64_bf16 v[92:95], v[76:79], v[232:239], v22
  ds_read_b128 v[56:59], v4 offset:2048
  ds_read_b128 v[60:63], v4 offset:3072
  v_smfmac_f32_16x16x64_bf16 v[88:91], v[76:79], a[216:223], v22
  s_add_u32 m0, s74, 0
  s_add_u32 s21, s79, 0
  buffer_load_dwordx4 v4, s[16:19], s21 offen offset:1024 sc1 lds
  v_smfmac_f32_16x16x64_bf16 v[92:95], v[80:83], v[240:247], v22
  ds_read_b128 v[64:67], v4 offset:4096
  ds_read_b128 v[68:71], v4 offset:5120
  s_add_u32 s22, s52, 3
  s_min_u32 s22, s22, 64
  v_smfmac_f32_16x16x64_bf16 v[88:91], v[80:83], a[224:231], v22
  s_add_u32 m0, s74, 2048
  s_add_u32 s21, s79, 65536
  buffer_load_dwordx4 v4, s[16:19], s21 offen offset:1024 sc1 lds
  v_cmp_gt_u32 vcc, s22, v42
  v_smfmac_f32_16x16x64_bf16 v[92:95], v[84:87], v[248:255], v22
  ds_read_b128 v[72:75], v4 offset:6144
  s_cbranch_vccnz kw_215
kv_216:
  v_smfmac_f32_16x16x64_bf16 v[88:91], v[84:87], a[232:239], v22
  s_waitcnt lgkmcnt(6)
  s_add_u32 m0, s74, 10240
  s_nop 0
  buffer_load_dwordx4 v4, s[16:19], s73 offen offset:0 sc1 lds
  v_smfmac_f32_16x16x64_bf16 v[92:95], v[48:51], a[240:247], v22
  v_smfmac_f32_16x16x64_bf16 v[88:91], v[48:51], a[160:167], v22
  s_waitcnt lgkmcnt(5)
  s_add_u32 m0, s74, 10240
  s_nop 0
  buffer_load_dwordx4 v4, s[16:19], s73 offen offset:1024 sc1 lds
  v_smfmac_f32_16x16x64_bf16 v[92:95], v[52:55], a[248:255], v22
  s_waitcnt lgkmcnt(4)
  v_smfmac_f32_16x16x64_bf16 v[92:95], v[56:59], v[192:199], v22
  s_waitcnt lgkmcnt(3)
  s_add_u32 m0, s74, 10240
  s_nop 0
  buffer_load_dwordx4 v4, s[16:19], s73 offen offset:2048 sc1 lds
  v_smfmac_f32_16x16x64_bf16 v[92:95], v[60:63], v[200:207], v22
  s_waitcnt lgkmcnt(2)
  v_smfmac_f32_16x16x64_bf16 v[92:95], v[64:67], v[208:215], v22
  s_waitcnt lgkmcnt(1)
  s_add_u32 m0, s74, 0
  s_mul_i32 s21, s91, 0
  s_add_u32 s21, s21, s71
  buffer_load_dwordx4 v4, s[16:19], s21 offen sc1 lds
  v_smfmac_f32_16x16x64_bf16 v[92:95], v[68:71], v[216:223], v22
  s_waitcnt lgkmcnt(0)
  v_smfmac_f32_16x16x64_bf16 v[92:95], v[72:75], v[224:231], v22
  s_add_u32 m0, s74, 2048
  s_mul_i32 s21, s91, 1
  s_add_u32 s21, s21, s71
  buffer_load_dwordx4 v4, s[16:19], s21 offen sc1 lds
  v_smfmac_f32_16x16x64_bf16 v[88:91], v[52:55], a[168:175], v22
  v_smfmac_f32_16x16x64_bf16 v[88:91], v[56:59], a[176:183], v22
  v_smfmac_f32_16x16x64_bf16 v[88:91], v[60:63], a[184:191], v22
  v_cvt_pk_bf16_f32 v122, v92, v93
  v_smfmac_f32_16x16x64_bf16 v[88:91], v[64:67], a[192:199], v22
  v_cvt_pk_bf16_f32 v123, v94, v95
  s_barrier
  v_smfmac_f32_16x16x64_bf16 v[88:91], v[68:71], a[200:207], v22
  ds_write_b64 v12, v[122:123] offset:13056
  v_smfmac_f32_16x16x64_bf16 v[88:91], v[72:75], a[208:215], v22
  v_smfmac_f32_16x16x64_bf16 v[96:99], v[48:51], a[0:7], v22
  v_smfmac_f32_16x16x64_bf16 v[100:103], v[48:51], a[80:87], v22
  v_smfmac_f32_16x16x64_bf16 v[96:99], v[52:55], a[8:15], v22
  v_cvt_pk_bf16_f32 v120, v88, v89
  v_cvt_pk_bf16_f32 v121, v90, v91
  ds_write_b64 v12, v[120:121] offset:12544
  v_smfmac_f32_16x16x64_bf16 v[100:103], v[52:55], a[88:95], v22
  s_waitcnt lgkmcnt(0)
  s_barrier
  ds_read_b64_tr_b16 v[104:105], v7 offset:0
  ds_read_b64_tr_b16 v[106:107], v7 offset:768
  ds_read_b64_tr_b16 v[108:109], v7 offset:1536
  ds_read_b32 v27, v12 offset:12544
  ds_read_b64 v[140:141], v11
  s_waitcnt lgkmcnt(1)
  v_cmp_u_f32 vcc, v104, v106
  v_cmp_u_f32 s[22:23], v108, v27
  s_nop 1
  s_or_b64 vcc, vcc, s[22:23]
  s_cbranch_vccnz mn_211
mk_212:
  s_cmp_eq_u32 s52, 63
  s_cbranch_scc1 last_213
  v_permlane32_swap_b32 v88, v92
  v_permlane32_swap_b32 v89, v93
  v_permlane32_swap_b32 v90, v94
  v_permlane32_swap_b32 v91, v95
  v_pk_add_f32 v[88:89], v[88:89], v[92:93]
  v_pk_add_f32 v[90:91], v[90:91], v[94:95]
  v_cvt_pk_bf16_f32 v92, v88, v89
  v_cvt_pk_bf16_f32 v93, v90, v91
  v_min_u32 v92, -2, v92
  s_nop 0
  v_smfmac_f32_16x16x64_bf16 v[96:99], v[56:59], a[16:23], v22
  v_smfmac_f32_16x16x64_bf16 v[100:103], v[56:59], a[96:103], v22
  v_smfmac_f32_16x16x64_bf16 v[96:99], v[60:63], a[24:31], v22
  v_smfmac_f32_16x16x64_bf16 v[96:99], v[64:67], a[32:39], v22
  v_smfmac_f32_16x16x64_bf16 v[96:99], v[68:71], a[40:47], v22
  v_smfmac_f32_16x16x64_bf16 v[96:99], v[72:75], a[48:55], v22
  v_smfmac_f32_16x16x64_bf16 v[96:99], v[76:79], a[56:63], v22
  v_smfmac_f32_16x16x64_bf16 v[96:99], v[80:83], a[64:71], v22
  v_smfmac_f32_16x16x64_bf16 v[96:99], v[84:87], a[72:79], v22
  v_smfmac_f32_16x16x64_bf16 v[100:103], v[60:63], a[104:111], v22
  v_smfmac_f32_16x16x64_bf16 v[100:103], v[64:67], a[112:119], v22
  buffer_load_dwordx4 v[132:135], v10, s[8:11], s56 offen sc1
  v_smfmac_f32_16x16x64_bf16 v[100:103], v[68:71], a[120:127], v22
  buffer_load_dwordx4 v[124:127], v9, s[8:11], s56 offen sc1
  v_smfmac_f32_16x16x64_bf16 v[100:103], v[72:75], a[128:135], v22
  buffer_load_dwordx4 v[128:131], v9, s[8:11], s56 offen offset:1024 sc1
  v_cvt_pk_bf16_f32 v136, v96, v97
  v_smfmac_f32_16x16x64_bf16 v[100:103], v[76:79], a[136:143], v22
  v_cvt_pk_bf16_f32 v137, v98, v99
  v_smfmac_f32_16x16x64_bf16 v[100:103], v[80:83], a[144:151], v22
  v_smfmac_f32_16x16x64_bf16 v[100:103], v[84:87], a[152:159], v22
  s_nop 7
  v_cvt_pk_bf16_f32 v138, v100, v101
  v_cvt_pk_bf16_f32 v139, v102, v103
  v_permlane32_swap_b32 v96, v100
  v_permlane32_swap_b32 v97, v101
  v_permlane32_swap_b32 v98, v102
  v_permlane32_swap_b32 v99, v103
  v_pk_add_f32 v[96:97], v[96:97], v[100:101]
  v_pk_add_f32 v[98:99], v[98:99], v[102:103]
  v_cvt_pk_bf16_f32 v100, v96, v97
  v_cvt_pk_bf16_f32 v101, v98, v99
  s_nop 0
  v_permlane32_swap_b32 v100, v102
  v_permlane32_swap_b32 v101, v103
  v_min_u32 v100, -2, v100
  s_waitcnt vmcnt(2) lgkmcnt(0)
  v_pk_add_f16 v164, v132, v133
  v_pk_add_f16 v165, v134, v135
  v_fma_mix_f32 v170, v164, 1.0, v165 op_sel:[0,0,0] op_sel_hi:[1,0,1]
  v_fma_mix_f32 v171, v164, 1.0, v165 op_sel:[1,0,1] op_sel_hi:[1,0,1]
  v_exp_f32 v176, v170
  v_exp_f32 v177, v171
  s_waitcnt vmcnt(1)
  v_cvt_pk_bf16_f32 v160, v176, v177
  v_pk_add_f16 v120, v124, v126
  v_pk_add_f16 v121, v125, v127
  v_mov_b32_dpp v161, v160 row_ror:8 row_mask:0xf bank_mask:0xf
  s_waitcnt vmcnt(0)
  v_pk_add_f16 v122, v128, v130
  v_mfma_f32_16x16x32_bf16 v[178:181], v[140:143], v[160:163], 0
  v_fma_mix_f32 v166, v120, 1.0, v122 op_sel:[0,0,0] op_sel_hi:[1,0,1]
  v_fma_mix_f32 v167, v120, 1.0, v122 op_sel:[1,0,1] op_sel_hi:[1,0,1]
  v_cmp_u_f32 vcc, v166, v170
  v_pk_add_f16 v123, v129, v131
  v_exp_f32 v172, v166
  v_mfma_f32_16x16x32_bf16 v[182:185], v[136:139], v[160:163], 0
  s_cbranch_vccnz sr_219
  v_exp_f32 v173, v167
  v_fma_mix_f32 v168, v121, 1.0, v123 op_sel:[0,0,0] op_sel_hi:[1,0,1]
  v_fma_mix_f32 v169, v121, 1.0, v123 op_sel:[1,0,1] op_sel_hi:[1,0,1]
  v_cvt_pk_bf16_f32 v156, v172, v173
  v_exp_f32 v174, v168
  v_exp_f32 v175, v169
  v_mov_b32_dpp v158, v156 row_ror:8 row_mask:0xf bank_mask:0xf
  v_cvt_pk_bf16_f32 v157, v174, v175
  v_mfma_f32_16x16x32_bf16 v[186:189], v[138:141], v[160:163], 0
  s_nop 0
  v_mov_b32_dpp v159, v157 row_ror:8 row_mask:0xf bank_mask:0xf
  s_nop 1
pv_220:
  v_mfma_f32_16x16x32_bf16 v[178:181], v[152:155], v[156:159], v[178:181]
  v_mfma_f32_16x16x32_bf16 v[182:185], v[144:147], v[156:159], v[182:185]
  v_mfma_f32_16x16x32_bf16 v[186:189], v[148:151], v[156:159], v[186:189]
  s_mov_b64 exec, s[62:63]
  s_nop 0
  v_rcp_f32 v164, v180
  v_cmp_ngt_f32 s[22:23], s80, v180
  v_cmp_ngt_f32 vcc, s80, v164
  v_pk_mul_f32 v[182:183], v[182:183], v[164:165] op_sel_hi:[1,0]
  v_pk_mul_f32 v[184:185], v[184:185], v[164:165] op_sel_hi:[1,0]
  v_pk_mul_f32 v[178:179], v[178:179], v[164:165] op_sel_hi:[1,0]
  v_pk_mul_f32 v[186:187], v[186:187], v[164:165] op_sel_hi:[1,0]
  v_pk_mul_f32 v[188:189], v[188:189], v[164:165] op_sel_hi:[1,0]
  v_cvt_pk_f16_f32 v64, v178, v179
  s_or_b64 vcc, vcc, s[22:23]
  s_cbranch_scc1 fx_222
fk_223:
  ds_write_b32 v14, v64
  v_cvt_pk_f16_f32 v60, v182, v183
  v_cvt_pk_f16_f32 v61, v184, v185
  v_cvt_pk_f16_f32 v62, v186, v187
  v_cvt_pk_f16_f32 v63, v188, v189
  ds_write_b128 v13, v[60:63]
  s_mov_b64 exec, s[66:67]
  s_barrier
  ds_read_b128 v[166:169], v4 offset:13824
  ds_read_b128 v[170:173], v4 offset:14464
  ds_read_b128 v[174:177], v4 offset:15104
  ds_read_b128 v[178:181], v4 offset:15744
  s_waitcnt lgkmcnt(2)
  v_pk_add_f16 v166, v166, v170
  v_pk_add_f16 v167, v167, v171
  v_pk_add_f16 v168, v168, v172
  v_pk_add_f16 v169, v169, v173
  s_waitcnt lgkmcnt(1)
  v_pk_add_f16 v166, v166, v174
  v_pk_add_f16 v167, v167, v175
  v_pk_add_f16 v168, v168, v176
  v_pk_add_f16 v169, v169, v177
  s_waitcnt lgkmcnt(0)
  v_pk_add_f16 v166, v166, v178
  v_cmpx_o_f16 vcc, v166, v166
  v_pk_add_f16 v167, v167, v179
  v_pk_add_f16 v168, v168, v180
  v_pk_add_f16 v169, v169, v181
  v_and_or_b32 v166, v166, -2, s61
  buffer_store_dwordx4 v[166:169], v15, s[4:7], s60 offen sc1
  s_xor_b64 s[98:99], exec, s[66:67]
  s_mov_b64 exec, -1
  buffer_store_dwordx4 v[100:103], v26, s[16:19], s70 offen sc1
  buffer_store_dwordx2 v[92:93], v43, s[16:19], s70 offen sc1
  s_add_u32 s70, s70, 2097152
  s_xor_b32 s70, s70, 8192
  ds_read_b128 v[144:147], v18
  ds_read_b128 v[148:151], v18 offset:1024
  ds_read_b128 v[152:155], v19
  v_xor_b32 v18, 16384, v18
  v_xor_b32 v19, 16384, v19
  v_mov_b32 v88, 0
  v_mov_b32 v89, 0
  v_mov_b32 v90, 0
  v_mov_b32 v91, 0
  v_mov_b32 v92, 0
  v_mov_b32 v93, 0
  v_mov_b32 v94, 0
  v_mov_b32 v95, 0
  v_mov_b32 v96, 0
  v_mov_b32 v97, 0
  v_mov_b32 v98, 0
  v_mov_b32 v99, 0
  v_mov_b32 v100, 0
  v_mov_b32 v101, 0
  v_mov_b32 v102, 0
  v_mov_b32 v103, 0
  s_mov_b32 s81, 0
  s_waitcnt lgkmcnt(0)
  s_barrier
  s_cmp_lg_u64 s[98:99], 0
  s_cbranch_scc1 pf_224
pf_225:
  s_xor_b32 s74, s74, 16384
  s_add_u32 s73, s73, 2097152
  s_xor_b32 s73, s73, 8192
  s_add_u32 s79, s79, 2097152
  s_xor_b32 s79, s79, 8192
  s_add_u32 s21, s72, 524288
  s_xor_b32 s72, s72, s21
  s_lshr_b32 s72, s72, 8
  s_and_b32 s72, s72, 8192
  s_xor_b32 s72, s72, s21
  s_add_u32 s71, s73, 4096
  s_mov_b32 s91, 1024
  s_sub_u32 s21, s73, 0
  s_cmp_lt_u32 s21, 125829120
  s_cselect_b32 s71, s71, s79
  s_cselect_b32 s91, s91, 65536
  v_mov_b32 v166, s52
  s_add_u32 s22, s52, 5
  s_min_u32 s22, s22, 64
  v_cmp_gt_u32 vcc, s22, v42
  s_cbranch_vccz fv_227
  buffer_load_dword v42, v41, s[12:15], s76 offen sc1
fv_227:
  ds_write_b128 v190, v[28:31] offset:0
  ds_write_b128 v190, v[28:31] offset:1024
  ds_write_b128 v190, v[28:31] offset:2048
nt_226:
  s_barrier
  s_mov_b32 s58, s55
  s_add_u32 s52, s52, 1
  ds_write_b32 v13, v28
  ds_write_b32 v14, v28
  s_and_b32 s21, s52, 3
  s_mul_i32 s56, s21, 122880
  s_add_u32 s21, s52, 1
  s_and_b32 s21, s21, 3
  s_mul_i32 s55, s21, 122880
  s_add_u32 s55, s55, s75
  s_add_u32 s21, s52, 2
  s_and_b32 s21, s21, 3
  s_mul_i32 s57, s21, 122880
  s_add_u32 s21, s52, 3
  s_and_b32 s21, s21, 3
  s_mul_i32 s59, s21, 122880
  s_add_u32 s59, s59, s75
  s_bfe_u32 s61, s52, 0x10002
  s_and_b32 s21, s52, 3
  s_lshl_b32 s60, s21, 18
  s_mov_b32 s54, 0
  s_sleep 2
  s_nop 10
  s_waitcnt lgkmcnt(0)
  buffer_load_dwordx4 v[76:79], v190, s[8:11], s58 offen offset:0 sc1
  buffer_load_dwordx4 v[80:83], v190, s[8:11], s58 offen offset:1024 sc1
  buffer_load_dwordx4 v[84:87], v190, s[8:11], s58 offen offset:2048 sc1
  s_branch top_209
mr_210:
  s_mov_b64 exec, s[22:23]
  s_cbranch_execz ms_228
  buffer_load_dwordx4 v[76:79], v190, s[8:11], s58 offen offset:0 sc1
ms_228:
  s_mov_b64 exec, s[98:99]
  s_cbranch_execz ms_229
  buffer_load_dwordx4 v[80:83], v190, s[8:11], s58 offen offset:1024 sc1
ms_229:
  s_mov_b64 exec, s[100:101]
  s_cbranch_execz ms_230
  buffer_load_dwordx4 v[84:87], v190, s[8:11], s58 offen offset:2048 sc1
ms_230:
  s_add_u32 s54, s54, 1
  s_cmp_gt_u32 s54, 131072
  s_cbranch_scc1 end0
  s_waitcnt vmcnt(0)
  s_mov_b64 exec, s[22:23]
  ds_write_b128 v190, v[76:79] offset:0
  v_cmp_eq_u32 s[22:23], -1, v76
  s_mov_b64 exec, s[98:99]
  ds_write_b128 v190, v[80:83] offset:1024
  v_cmp_eq_u32 s[98:99], -1, v80
  s_mov_b64 exec, s[100:101]
  ds_write_b128 v190, v[84:87] offset:2048
  v_cmp_eq_u32 s[100:101], -1, v84
  s_mov_b64 exec, -1
  s_or_b64 vcc, s[22:23], s[98:99]
  s_or_b64 vcc, vcc, s[100:101]
  s_cbranch_scc1 mr_210
  s_branch mo_214
kw_215:
  s_mov_b32 s101, 0
wm_231:
  buffer_load_dword v42, v41, s[12:15], s76 offen sc1
  s_add_u32 s101, s101, 1
  s_cmp_gt_u32 s101, 131072
  s_cbranch_scc1 end0
  s_waitcnt vmcnt(0)
  v_cmp_gt_u32 vcc, s22, v42
  v_readfirstlane_b32 s100, v42
  s_nop 0
  s_cbranch_vccz wm_232
  s_sleep 1
  s_branch wm_231
wm_232:
  s_branch kv_216
mn_211:
  s_bitcmp1_b32 s81, 1
  s_cbranch_scc1 mk_212
  s_or_b32 s81, s81, 2
  s_nop 7
  v_mov_b32 v88, 0
  v_mov_b32 v89, 0
  v_mov_b32 v90, 0
  v_mov_b32 v91, 0
  v_mov_b32 v92, 0
  v_mov_b32 v93, 0
  v_mov_b32 v94, 0
  v_mov_b32 v95, 0
  v_mov_b32 v96, 0
  v_mov_b32 v97, 0
  v_mov_b32 v98, 0
  v_mov_b32 v99, 0
  v_mov_b32 v100, 0
  v_mov_b32 v101, 0
  v_mov_b32 v102, 0
  v_mov_b32 v103, 0
  s_cmp_eq_u32 s52, 0
  s_cbranch_scc1 mx_234
mx_233:
  buffer_load_dwordx4 v[76:79], v190, s[8:11], s58 offen offset:0 sc1
  buffer_load_dwordx4 v[80:83], v190, s[8:11], s58 offen offset:1024 sc1
  buffer_load_dwordx4 v[84:87], v190, s[8:11], s58 offen offset:2048 sc1
  s_add_u32 s54, s54, 1
  s_cmp_gt_u32 s54, 131072
  s_cbranch_scc1 end0
  s_waitcnt vmcnt(0)
  v_max3_u32 v27, v76, v77, v78
  v_max3_u32 v27, v27, v79, v80
  v_max3_u32 v27, v27, v81, v82
  v_max3_u32 v27, v27, v83, v84
  v_max3_u32 v27, v27, v85, v86
  v_max3_u32 v27, v27, v87, v87
  v_cmp_eq_u32 vcc, -1, v27
  s_nop 1
  s_cbranch_vccnz mx_233
  ds_write_b128 v190, v[76:79] offset:0
  ds_write_b128 v190, v[80:83] offset:1024
  ds_write_b128 v190, v[84:87] offset:2048
mx_234:
  s_waitcnt lgkmcnt(0)
  s_branch mo_214
sr_219:
  s_mov_b32 s54, 0
sr_235:
  s_mov_b64 exec, vcc
  buffer_load_dwordx4 v[124:127], v9, s[8:11], s56 offen sc1
  buffer_load_dwordx4 v[128:131], v9, s[8:11], s56 offen offset:1024 sc1
  buffer_load_dwordx4 v[132:135], v10, s[8:11], s56 offen sc1
  s_mov_b64 exec, -1
  s_add_u32 s54, s54, 1
  s_cmp_gt_u32 s54, 131072
  s_cbranch_scc1 end0
  s_waitcnt vmcnt(0)
  v_pk_add_f16 v164, v132, v133
  v_pk_add_f16 v165, v134, v135
  v_pk_add_f16 v120, v124, v126
  v_pk_add_f16 v122, v128, v130
  v_fma_mix_f32 v170, v164, 1.0, v165 op_sel:[0,0,0] op_sel_hi:[1,0,1]
  v_fma_mix_f32 v166, v120, 1.0, v122 op_sel:[0,0,0] op_sel_hi:[1,0,1]
  v_pk_add_f16 v121, v125, v127
  v_cmp_u_f32 vcc, v166, v170
  v_pk_add_f16 v123, v129, v131
  v_fma_mix_f32 v171, v164, 1.0, v165 op_sel:[1,0,1] op_sel_hi:[1,0,1]
  v_fma_mix_f32 v167, v120, 1.0, v122 op_sel:[1,0,1] op_sel_hi:[1,0,1]
  v_fma_mix_f32 v168, v121, 1.0, v123 op_sel:[0,0,0] op_sel_hi:[1,0,1]
  v_fma_mix_f32 v169, v121, 1.0, v123 op_sel:[1,0,1] op_sel_hi:[1,0,1]
  s_cbranch_vccz ex_221
  s_and_b32 s21, s54, 31
  s_cbranch_scc1 sr_235
  v_max3_u32 v27, v124, v126, v128
  v_max3_u32 v27, v27, v130, v132
  v_max3_u32 v27, v27, v133, v134
  v_max3_u32 v27, v27, v135, v135
  v_cmp_eq_u32 vcc, -1, v27
  s_nop 1
  s_cbranch_vccnz sr_235
ex_221:
  v_exp_f32 v176, v170
  v_exp_f32 v177, v171
  v_exp_f32 v172, v166
  v_cvt_pk_bf16_f32 v160, v176, v177
  v_exp_f32 v173, v167
  v_exp_f32 v174, v168
  v_mov_b32_dpp v161, v160 row_ror:8 row_mask:0xf bank_mask:0xf
  v_cvt_pk_bf16_f32 v156, v172, v173
  v_exp_f32 v175, v169
  v_mfma_f32_16x16x32_bf16 v[178:181], v[140:143], v[160:163], 0
  v_mov_b32_dpp v158, v156 row_ror:8 row_mask:0xf bank_mask:0xf
  v_cvt_pk_bf16_f32 v157, v174, v175
  v_mfma_f32_16x16x32_bf16 v[182:185], v[136:139], v[160:163], 0
  s_nop 0
  v_mov_b32_dpp v159, v157 row_ror:8 row_mask:0xf bank_mask:0xf
  v_mfma_f32_16x16x32_bf16 v[186:189], v[138:141], v[160:163], 0
  s_branch pv_220
fx_222:
  s_bitcmp1_b32 s81, 0
  s_cbranch_scc1 fk_223
  s_or_b32 s81, s81, 1
  s_mov_b64 exec, -1
  v_max3_f32 v164, v166, v167, v168
  v_max3_f32 v165, v169, v170, v171
  v_max_f32 v164, v164, v165
  s_nop 1
  v_max_f32_dpp v164, v164, v164 row_ror:8 row_mask:0xf bank_mask:0xf
  v_mov_b32 v165, v164
  s_nop 1
  v_permlane32_swap_b32 v164, v165
  v_max_f32 v164, v164, v165
  v_mov_b32 v165, v164
  s_nop 1
  v_permlane16_swap_b32 v164, v165
  v_max_f32 v164, v164, v165
  v_sub_f32 v166, v166, v164
  v_sub_f32 v167, v167, v164
  v_sub_f32 v168, v168, v164
  v_sub_f32 v169, v169, v164
  v_sub_f32 v170, v170, v164
  v_sub_f32 v171, v171, v164
  s_branch ex_221
pf_224:
  s_mov_b64 exec, s[66:67]
  ds_read_b128 v[166:169], v4 offset:13824
  ds_read_b128 v[170:173], v4 offset:14464
  ds_read_b128 v[174:177], v4 offset:15104
  ds_read_b128 v[178:181], v4 offset:15744
  s_waitcnt lgkmcnt(2)
  v_pk_add_f16 v166, v166, v170
  v_pk_add_f16 v167, v167, v171
  v_pk_add_f16 v168, v168, v172
  v_pk_add_f16 v169, v169, v173
  s_waitcnt lgkmcnt(1)
  v_pk_add_f16 v166, v166, v174
  v_pk_add_f16 v167, v167, v175
  v_pk_add_f16 v168, v168, v176
  v_pk_add_f16 v169, v169, v177
  s_waitcnt lgkmcnt(0)
  v_pk_add_f16 v166, v166, v178
  v_pk_add_f16 v167, v167, v179
  v_pk_add_f16 v168, v168, v180
  v_pk_add_f16 v169, v169, v181
  v_and_or_b32 v166, v166, -2, s61
  buffer_store_dwordx4 v[166:169], v15, s[4:7], s60 offen sc1
  s_mov_b64 exec, -1
  s_nop 1
  s_branch pf_225
last_213:
  v_permlane32_swap_b32 v88, v92
  v_permlane32_swap_b32 v89, v93
  v_permlane32_swap_b32 v90, v94
  v_permlane32_swap_b32 v91, v95
  v_pk_add_f32 v[88:89], v[88:89], v[92:93]
  v_pk_add_f32 v[90:91], v[90:91], v[94:95]
  v_cvt_pk_bf16_f32 v92, v88, v89
  v_cvt_pk_bf16_f32 v93, v90, v91
  v_min_u32 v92, -2, v92
  buffer_store_dwordx2 v[92:93], v43, s[16:19], s70 offen sc1
  v_smfmac_f32_16x16x64_bf16 v[96:99], v[56:59], a[16:23], v22
  v_smfmac_f32_16x16x64_bf16 v[100:103], v[56:59], a[96:103], v22
  v_smfmac_f32_16x16x64_bf16 v[96:99], v[60:63], a[24:31], v22
  v_smfmac_f32_16x16x64_bf16 v[96:99], v[64:67], a[32:39], v22
  v_smfmac_f32_16x16x64_bf16 v[96:99], v[68:71], a[40:47], v22
  v_smfmac_f32_16x16x64_bf16 v[96:99], v[72:75], a[48:55], v22
  v_smfmac_f32_16x16x64_bf16 v[96:99], v[76:79], a[56:63], v22
  v_smfmac_f32_16x16x64_bf16 v[96:99], v[80:83], a[64:71], v22
  v_smfmac_f32_16x16x64_bf16 v[96:99], v[84:87], a[72:79], v22
  v_smfmac_f32_16x16x64_bf16 v[100:103], v[60:63], a[104:111], v22
  v_smfmac_f32_16x16x64_bf16 v[100:103], v[64:67], a[112:119], v22
  v_smfmac_f32_16x16x64_bf16 v[100:103], v[68:71], a[120:127], v22
  v_smfmac_f32_16x16x64_bf16 v[100:103], v[72:75], a[128:135], v22
  v_smfmac_f32_16x16x64_bf16 v[100:103], v[76:79], a[136:143], v22
  v_smfmac_f32_16x16x64_bf16 v[100:103], v[80:83], a[144:151], v22
  v_smfmac_f32_16x16x64_bf16 v[100:103], v[84:87], a[152:159], v22
  s_nop 7
  v_permlane32_swap_b32 v96, v100
  v_permlane32_swap_b32 v97, v101
  v_permlane32_swap_b32 v98, v102
  v_permlane32_swap_b32 v99, v103
  v_pk_add_f32 v[96:97], v[96:97], v[100:101]
  v_pk_add_f32 v[98:99], v[98:99], v[102:103]
  v_cvt_pk_bf16_f32 v100, v96, v97
  v_cvt_pk_bf16_f32 v101, v98, v99
  s_nop 0
  v_permlane32_swap_b32 v100, v102
  v_permlane32_swap_b32 v101, v103
  v_min_u32 v100, -2, v100
  buffer_store_dwordx4 v[100:103], v26, s[16:19], s70 offen sc1
  s_waitcnt vmcnt(0)
  s_barrier
  v_mov_b32 v166, 64
  s_mov_b64 exec, 1
  buffer_store_dword v166, v23, s[12:15], s77 offen sc1
  s_mov_b64 exec, -1
  s_branch chain_done
chain_done:
end0:
  s_endpgm
gemm_side:
  s_bfe_u32 s23, s22, 0x20005
  s_add_u32 s22, s22, 31
  s_and_b32 s22, s22, 31
  s_lshl_b32 s21, s23, 3
  s_add_u32 s2, s21, s22
  s_add_u32 s3, s2, 72
  s_add_u32 s24, s2, 48
  s_add_u32 s2, s2, s21
  s_cmp_lt_u32 s22, 24
  s_cselect_b32 s3, s24, s3
  s_cmp_lt_u32 s22, 16
  s_cselect_b32 s3, s2, s3
  s_mov_b32 s2, s3
  s_cmp_ge_u32 s3, 64
  s_cbranch_scc1 not_kv
  s_load_dwordx2 s[4:5], s[0:1], 0
  s_load_dwordx2 s[6:7], s[0:1], 24
  s_load_dwordx2 s[36:37], s[0:1], 32
  s_load_dwordx2 s[38:39], s[0:1], 104
  s_and_b32 s43, s3, 1
  s_bfe_u32 s42, s3, 0x50001
  s_lshr_b32 s40, s42, 2
  s_waitcnt lgkmcnt(0)
  s_cmp_eq_u32 s43, 1
  s_cselect_b32 s6, s36, s6
  s_cselect_b32 s7, s37, s7
  s_mov_b32 s8, s4
  s_mov_b32 s9, s5
  s_mov_b32 s10, 2621440
  s_mov_b32 s11, 0x00020000
  s_mov_b32 s12, s6
  s_mov_b32 s13, s7
  s_mov_b32 s14, 7864320
  s_mov_b32 s15, 0x00020000
  s_mov_b32 s16, s38
  s_mov_b32 s17, s39
  s_mov_b32 s18, 218103808
  s_mov_b32 s19, 0x00020000
  s_add_u32 s72, s38, 173080576
  s_addc_u32 s73, s39, 0
  s_mov_b32 s74, 49152
  s_mov_b32 s75, 0x00020000
  s_mul_i32 s44, s42, 384
  s_mov_b32 s30, 0
  s_mov_b32 s25, 80768
  v_lshrrev_b32 v4, 3, v1
  v_and_b32 v5, 7, v1
  v_xor_b32 v5, v5, v4
  s_mul_i32 s21, s20, 16
  v_add_u32 v4, s21, v4
  v_mul_u32_u24 v4, 1280, v4
  v_lshl_add_u32 v10, v5, 4, v4
  s_mul_i32 s31, s20, 2048
  v_add_u32 v11, 10240, v10
  v_mov_b32 v9, 2731
  v_add_u32 v8, 0, v1
  v_mul_u32_u24 v7, v8, v9
  v_lshrrev_b32 v7, 16, v7
  v_mul_u32_u24 v4, 24, v7
  v_sub_u32 v8, v8, v4
  s_mov_b32 s21, 12288
  v_mul_lo_u32 v7, v7, s21
  v_lshl_add_u32 v4, v8, 4, v7
  v_add_u32 v8, 64, v1
  v_mul_u32_u24 v7, v8, v9
  v_lshrrev_b32 v7, 16, v7
  v_mul_u32_u24 v5, 24, v7
  v_sub_u32 v8, v8, v5
  s_mov_b32 s21, 12288
  v_mul_lo_u32 v7, v7, s21
  v_lshl_add_u32 v5, v8, 4, v7
  v_add_u32 v8, 128, v1
  v_mul_u32_u24 v7, v8, v9
  v_lshrrev_b32 v7, 16, v7
  v_mul_u32_u24 v6, 24, v7
  v_sub_u32 v8, v8, v6
  s_mov_b32 s21, 12288
  v_mul_lo_u32 v7, v7, s21
  v_lshl_add_u32 v6, v8, 4, v7
  v_lshrrev_b32 v7, 2, v2
  v_lshl_add_u32 v7, v3, 3, v7
  v_mul_u32_u24 v7, 384, v7
  v_and_b32 v8, 3, v2
  v_lshlrev_b32 v8, 3, v8
  s_mul_i32 s21, s20, 96
  v_add3_u32 v7, v7, v8, s21
  v_add_u32 v8, 49152, v7
  s_mul_i32 s21, s20, 393216
  s_add_u32 s21, s21, 0
  s_add_u32 s21, s21, s44
  s_mul_i32 s22, s20, 12288
  s_add_u32 s22, s22, 0
  s_add_u32 m0, s22, 0
  s_nop 0
  buffer_load_dwordx4 v4, s[12:15], s21 offen lds
  s_add_u32 m0, s22, 1024
  s_nop 0
  buffer_load_dwordx4 v5, s[12:15], s21 offen lds
  s_add_u32 m0, s22, 2048
  s_nop 0
  buffer_load_dwordx4 v6, s[12:15], s21 offen lds
  s_mul_i32 s21, s20, 393216
  s_add_u32 s21, s21, 98304
  s_add_u32 s21, s21, s44
  s_mul_i32 s22, s20, 12288
  s_add_u32 s22, s22, 3072
  s_add_u32 m0, s22, 0
  s_nop 0
  buffer_load_dwordx4 v4, s[12:15], s21 offen lds
  s_add_u32 m0, s22, 1024
  s_nop 0
  buffer_load_dwordx4 v5, s[12:15], s21 offen lds
  s_add_u32 m0, s22, 2048
  s_nop 0
  buffer_load_dwordx4 v6, s[12:15], s21 offen lds
  s_mul_i32 s21, s20, 393216
  s_add_u32 s21, s21, 196608
  s_add_u32 s21, s21, s44
  s_mul_i32 s22, s20, 12288
  s_add_u32 s22, s22, 6144
  s_add_u32 m0, s22, 0
  s_nop 0
  buffer_load_dwordx4 v4, s[12:15], s21 offen lds
  s_add_u32 m0, s22, 1024
  s_nop 0
  buffer_load_dwordx4 v5, s[12:15], s21 offen lds
  s_add_u32 m0, s22, 2048
  s_nop 0
  buffer_load_dwordx4 v6, s[12:15], s21 offen lds
  s_mul_i32 s21, s20, 393216
  s_add_u32 s21, s21, 294912
  s_add_u32 s21, s21, s44
  s_mul_i32 s22, s20, 12288
  s_add_u32 s22, s22, 9216
  s_add_u32 m0, s22, 0
  s_nop 0
  buffer_load_dwordx4 v4, s[12:15], s21 offen lds
  s_add_u32 m0, s22, 1024
  s_nop 0
  buffer_load_dwordx4 v5, s[12:15], s21 offen lds
  s_add_u32 m0, s22, 2048
  s_nop 0
  buffer_load_dwordx4 v6, s[12:15], s21 offen lds
  s_add_u32 m0, s31, 98304
  s_nop 0
  buffer_load_dwordx4 v10, s[8:11], s30 offen lds
  s_add_u32 m0, s31, 99328
  s_nop 0
  buffer_load_dwordx4 v11, s[8:11], s30 offen lds
  s_add_u32 s30, s30, 128
  s_add_u32 m0, s31, 106496
  s_nop 0
  buffer_load_dwordx4 v10, s[8:11], s30 offen lds
  s_add_u32 m0, s31, 107520
  s_nop 0
  buffer_load_dwordx4 v11, s[8:11], s30 offen lds
  s_add_u32 s30, s30, 128
  s_add_u32 m0, s31, 114688
  s_nop 0
  buffer_load_dwordx4 v10, s[8:11], s30 offen lds
  s_add_u32 m0, s31, 115712
  s_nop 0
  buffer_load_dwordx4 v11, s[8:11], s30 offen lds
  s_add_u32 s30, s30, 128
  s_add_u32 m0, s31, 122880
  s_nop 0
  buffer_load_dwordx4 v10, s[8:11], s30 offen lds
  s_add_u32 m0, s31, 123904
  s_nop 0
  buffer_load_dwordx4 v11, s[8:11], s30 offen lds
  s_add_u32 s30, s30, 128
  s_add_u32 m0, s31, 131072
  s_nop 0
  buffer_load_dwordx4 v10, s[8:11], s30 offen lds
  s_add_u32 m0, s31, 132096
  s_nop 0
  buffer_load_dwordx4 v11, s[8:11], s30 offen lds
  s_add_u32 s30, s30, 128
  s_add_u32 m0, s31, 139264
  s_nop 0
  buffer_load_dwordx4 v10, s[8:11], s30 offen lds
  s_add_u32 m0, s31, 140288
  s_nop 0
  buffer_load_dwordx4 v11, s[8:11], s30 offen lds
  s_add_u32 s30, s30, 128
  s_add_u32 m0, s31, 147456
  s_nop 0
  buffer_load_dwordx4 v10, s[8:11], s30 offen lds
  s_add_u32 m0, s31, 148480
  s_nop 0
  buffer_load_dwordx4 v11, s[8:11], s30 offen lds
  s_add_u32 s30, s30, 128
  s_add_u32 m0, s31, 155648
  s_nop 0
  buffer_load_dwordx4 v10, s[8:11], s30 offen lds
  s_add_u32 m0, s31, 156672
  s_nop 0
  buffer_load_dwordx4 v11, s[8:11], s30 offen lds
  s_add_u32 s30, s30, 128
  s_mul_i32 s21, s20, 393216
  s_add_u32 s21, s21, 1572864
  s_add_u32 s21, s21, s44
  s_mul_i32 s22, s20, 12288
  s_add_u32 s22, s22, 49152
  s_add_u32 m0, s22, 0
  s_nop 0
  buffer_load_dwordx4 v4, s[12:15], s21 offen lds
  s_add_u32 m0, s22, 1024
  s_nop 0
  buffer_load_dwordx4 v5, s[12:15], s21 offen lds
  s_add_u32 m0, s22, 2048
  s_nop 0
  buffer_load_dwordx4 v6, s[12:15], s21 offen lds
  s_mul_i32 s21, s20, 393216
  s_add_u32 s21, s21, 1671168
  s_add_u32 s21, s21, s44
  s_mul_i32 s22, s20, 12288
  s_add_u32 s22, s22, 52224
  s_add_u32 m0, s22, 0
  s_nop 0
  buffer_load_dwordx4 v4, s[12:15], s21 offen lds
  s_add_u32 m0, s22, 1024
  s_nop 0
  buffer_load_dwordx4 v5, s[12:15], s21 offen lds
  s_add_u32 m0, s22, 2048
  s_nop 0
  buffer_load_dwordx4 v6, s[12:15], s21 offen lds
  s_mul_i32 s21, s20, 393216
  s_add_u32 s21, s21, 1769472
  s_add_u32 s21, s21, s44
  s_mul_i32 s22, s20, 12288
  s_add_u32 s22, s22, 55296
  s_add_u32 m0, s22, 0
  s_nop 0
  buffer_load_dwordx4 v4, s[12:15], s21 offen lds
  s_add_u32 m0, s22, 1024
  s_nop 0
  buffer_load_dwordx4 v5, s[12:15], s21 offen lds
  s_add_u32 m0, s22, 2048
  s_nop 0
  buffer_load_dwordx4 v6, s[12:15], s21 offen lds
  s_mul_i32 s21, s20, 393216
  s_add_u32 s21, s21, 1867776
  s_add_u32 s21, s21, s44
  s_mul_i32 s22, s20, 12288
  s_add_u32 s22, s22, 58368
  s_add_u32 m0, s22, 0
  s_nop 0
  buffer_load_dwordx4 v4, s[12:15], s21 offen lds
  s_add_u32 m0, s22, 1024
  s_nop 0
  buffer_load_dwordx4 v5, s[12:15], s21 offen lds
  s_add_u32 m0, s22, 2048
  s_nop 0
  buffer_load_dwordx4 v6, s[12:15], s21 offen lds
  s_waitcnt vmcnt(12)
  s_barrier
  ds_read_b64_tr_b16 a[0:1], v7 offset:0
  ds_read_b64_tr_b16 a[2:3], v7 offset:1536
  ds_read_b64_tr_b16 a[4:5], v7 offset:32
  ds_read_b64_tr_b16 a[6:7], v7 offset:1568
  ds_read_b64_tr_b16 a[8:9], v7 offset:64
  ds_read_b64_tr_b16 a[10:11], v7 offset:1600
  ds_read_b64_tr_b16 a[12:13], v7 offset:12288
  ds_read_b64_tr_b16 a[14:15], v7 offset:13824
  ds_read_b64_tr_b16 a[16:17], v7 offset:12320
  ds_read_b64_tr_b16 a[18:19], v7 offset:13856
  ds_read_b64_tr_b16 a[20:21], v7 offset:12352
  ds_read_b64_tr_b16 a[22:23], v7 offset:13888
  ds_read_b64_tr_b16 a[24:25], v7 offset:24576
  ds_read_b64_tr_b16 a[26:27], v7 offset:26112
  ds_read_b64_tr_b16 a[28:29], v7 offset:24608
  ds_read_b64_tr_b16 a[30:31], v7 offset:26144
  ds_read_b64_tr_b16 a[32:33], v7 offset:24640
  ds_read_b64_tr_b16 a[34:35], v7 offset:26176
  ds_read_b64_tr_b16 a[36:37], v7 offset:36864
  ds_read_b64_tr_b16 a[38:39], v7 offset:38400
  ds_read_b64_tr_b16 a[40:41], v7 offset:36896
  ds_read_b64_tr_b16 a[42:43], v7 offset:38432
  ds_read_b64_tr_b16 a[44:45], v7 offset:36928
  ds_read_b64_tr_b16 a[46:47], v7 offset:38464
  s_waitcnt lgkmcnt(0)
  s_barrier
  s_mul_i32 s21, s20, 393216
  s_add_u32 s21, s21, 3145728
  s_add_u32 s21, s21, s44
  s_mul_i32 s22, s20, 12288
  s_add_u32 s22, s22, 0
  s_add_u32 m0, s22, 0
  s_nop 0
  buffer_load_dwordx4 v4, s[12:15], s21 offen lds
  s_add_u32 m0, s22, 1024
  s_nop 0
  buffer_load_dwordx4 v5, s[12:15], s21 offen lds
  s_add_u32 m0, s22, 2048
  s_nop 0
  buffer_load_dwordx4 v6, s[12:15], s21 offen lds
  s_mul_i32 s21, s20, 393216
  s_add_u32 s21, s21, 3244032
  s_add_u32 s21, s21, s44
  s_mul_i32 s22, s20, 12288
  s_add_u32 s22, s22, 3072
  s_add_u32 m0, s22, 0
  s_nop 0
  buffer_load_dwordx4 v4, s[12:15], s21 offen lds
  s_add_u32 m0, s22, 1024
  s_nop 0
  buffer_load_dwordx4 v5, s[12:15], s21 offen lds
  s_add_u32 m0, s22, 2048
  s_nop 0
  buffer_load_dwordx4 v6, s[12:15], s21 offen lds
  s_mul_i32 s21, s20, 393216
  s_add_u32 s21, s21, 3342336
  s_add_u32 s21, s21, s44
  s_mul_i32 s22, s20, 12288
  s_add_u32 s22, s22, 6144
  s_add_u32 m0, s22, 0
  s_nop 0
  buffer_load_dwordx4 v4, s[12:15], s21 offen lds
  s_add_u32 m0, s22, 1024
  s_nop 0
  buffer_load_dwordx4 v5, s[12:15], s21 offen lds
  s_add_u32 m0, s22, 2048
  s_nop 0
  buffer_load_dwordx4 v6, s[12:15], s21 offen lds
  s_mul_i32 s21, s20, 393216
  s_add_u32 s21, s21, 3440640
  s_add_u32 s21, s21, s44
  s_mul_i32 s22, s20, 12288
  s_add_u32 s22, s22, 9216
  s_add_u32 m0, s22, 0
  s_nop 0
  buffer_load_dwordx4 v4, s[12:15], s21 offen lds
  s_add_u32 m0, s22, 1024
  s_nop 0
  buffer_load_dwordx4 v5, s[12:15], s21 offen lds
  s_add_u32 m0, s22, 2048
  s_nop 0
  buffer_load_dwordx4 v6, s[12:15], s21 offen lds
  s_waitcnt vmcnt(12)
  s_barrier
  ds_read_b64_tr_b16 a[48:49], v8 offset:0
  ds_read_b64_tr_b16 a[50:51], v8 offset:1536
  ds_read_b64_tr_b16 a[52:53], v8 offset:32
  ds_read_b64_tr_b16 a[54:55], v8 offset:1568
  ds_read_b64_tr_b16 a[56:57], v8 offset:64
  ds_read_b64_tr_b16 a[58:59], v8 offset:1600
  ds_read_b64_tr_b16 a[60:61], v8 offset:12288
  ds_read_b64_tr_b16 a[62:63], v8 offset:13824
  ds_read_b64_tr_b16 a[64:65], v8 offset:12320
  ds_read_b64_tr_b16 a[66:67], v8 offset:13856
  ds_read_b64_tr_b16 a[68:69], v8 offset:12352
  ds_read_b64_tr_b16 a[70:71], v8 offset:13888
  ds_read_b64_tr_b16 a[72:73], v8 offset:24576
  ds_read_b64_tr_b16 a[74:75], v8 offset:26112
  ds_read_b64_tr_b16 a[76:77], v8 offset:24608
  ds_read_b64_tr_b16 a[78:79], v8 offset:26144
  ds_read_b64_tr_b16 a[80:81], v8 offset:24640
  ds_read_b64_tr_b16 a[82:83], v8 offset:26176
  ds_read_b64_tr_b16 a[84:85], v8 offset:36864
  ds_read_b64_tr_b16 a[86:87], v8 offset:38400
  ds_read_b64_tr_b16 a[88:89], v8 offset:36896
  ds_read_b64_tr_b16 a[90:91], v8 offset:38432
  ds_read_b64_tr_b16 a[92:93], v8 offset:36928
  ds_read_b64_tr_b16 a[94:95], v8 offset:38464
  s_waitcnt lgkmcnt(0)
  s_barrier
  s_mul_i32 s21, s20, 393216
  s_add_u32 s21, s21, 4718592
  s_add_u32 s21, s21, s44
  s_mul_i32 s22, s20, 12288
  s_add_u32 s22, s22, 49152
  s_add_u32 m0, s22, 0
  s_nop 0
  buffer_load_dwordx4 v4, s[12:15], s21 offen lds
  s_add_u32 m0, s22, 1024
  s_nop 0
  buffer_load_dwordx4 v5, s[12:15], s21 offen lds
  s_add_u32 m0, s22, 2048
  s_nop 0
  buffer_load_dwordx4 v6, s[12:15], s21 offen lds
  s_mul_i32 s21, s20, 393216
  s_add_u32 s21, s21, 4816896
  s_add_u32 s21, s21, s44
  s_mul_i32 s22, s20, 12288
  s_add_u32 s22, s22, 52224
  s_add_u32 m0, s22, 0
  s_nop 0
  buffer_load_dwordx4 v4, s[12:15], s21 offen lds
  s_add_u32 m0, s22, 1024
  s_nop 0
  buffer_load_dwordx4 v5, s[12:15], s21 offen lds
  s_add_u32 m0, s22, 2048
  s_nop 0
  buffer_load_dwordx4 v6, s[12:15], s21 offen lds
  s_mul_i32 s21, s20, 393216
  s_add_u32 s21, s21, 4915200
  s_add_u32 s21, s21, s44
  s_mul_i32 s22, s20, 12288
  s_add_u32 s22, s22, 55296
  s_add_u32 m0, s22, 0
  s_nop 0
  buffer_load_dwordx4 v4, s[12:15], s21 offen lds
  s_add_u32 m0, s22, 1024
  s_nop 0
  buffer_load_dwordx4 v5, s[12:15], s21 offen lds
  s_add_u32 m0, s22, 2048
  s_nop 0
  buffer_load_dwordx4 v6, s[12:15], s21 offen lds
  s_mul_i32 s21, s20, 393216
  s_add_u32 s21, s21, 5013504
  s_add_u32 s21, s21, s44
  s_mul_i32 s22, s20, 12288
  s_add_u32 s22, s22, 58368
  s_add_u32 m0, s22, 0
  s_nop 0
  buffer_load_dwordx4 v4, s[12:15], s21 offen lds
  s_add_u32 m0, s22, 1024
  s_nop 0
  buffer_load_dwordx4 v5, s[12:15], s21 offen lds
  s_add_u32 m0, s22, 2048
  s_nop 0
  buffer_load_dwordx4 v6, s[12:15], s21 offen lds
  v_mov_b32 v29, 76
  buffer_load_dword v29, v29, s[32:35], 0 offen sc1
  v_lshlrev_b32 v28, 4, v1
  s_and_b32 s21, s3, 15
  s_lshl_b32 s21, s21, 2
  s_add_u32 s21, s21, s20
  s_lshl_b32 s21, s21, 10
  s_add_u32 s21, s21, 81920
  buffer_load_dwordx4 v[32:35], v28, s[8:11], s21 offen
  s_add_u32 s21, s21, 65536
  buffer_load_dwordx4 v[32:35], v28, s[8:11], s21 offen
  s_add_u32 s21, s21, 65536
  buffer_load_dwordx4 v[32:35], v28, s[8:11], s21 offen
  s_add_u32 s21, s21, 65536
  buffer_load_dwordx4 v[32:35], v28, s[8:11], s21 offen
  s_add_u32 s21, s21, 65536
  s_waitcnt vmcnt(12)
  s_barrier
  ds_read_b64_tr_b16 a[96:97], v7 offset:0
  ds_read_b64_tr_b16 a[98:99], v7 offset:1536
  ds_read_b64_tr_b16 a[100:101], v7 offset:32
  ds_read_b64_tr_b16 a[102:103], v7 offset:1568
  ds_read_b64_tr_b16 a[104:105], v7 offset:64
  ds_read_b64_tr_b16 a[106:107], v7 offset:1600
  ds_read_b64_tr_b16 a[108:109], v7 offset:12288
  ds_read_b64_tr_b16 a[110:111], v7 offset:13824
  ds_read_b64_tr_b16 a[112:113], v7 offset:12320
  ds_read_b64_tr_b16 a[114:115], v7 offset:13856
  ds_read_b64_tr_b16 a[116:117], v7 offset:12352
  ds_read_b64_tr_b16 a[118:119], v7 offset:13888
  ds_read_b64_tr_b16 a[120:121], v7 offset:24576
  ds_read_b64_tr_b16 a[122:123], v7 offset:26112
  ds_read_b64_tr_b16 a[124:125], v7 offset:24608
  ds_read_b64_tr_b16 a[126:127], v7 offset:26144
  ds_read_b64_tr_b16 a[128:129], v7 offset:24640
  ds_read_b64_tr_b16 a[130:131], v7 offset:26176
  ds_read_b64_tr_b16 a[132:133], v7 offset:36864
  ds_read_b64_tr_b16 a[134:135], v7 offset:38400
  ds_read_b64_tr_b16 a[136:137], v7 offset:36896
  ds_read_b64_tr_b16 a[138:139], v7 offset:38432
  ds_read_b64_tr_b16 a[140:141], v7 offset:36928
  ds_read_b64_tr_b16 a[142:143], v7 offset:38464
  s_waitcnt lgkmcnt(0)
  s_barrier
  s_mul_i32 s21, s20, 393216
  s_add_u32 s21, s21, 6291456
  s_add_u32 s21, s21, s44
  s_mul_i32 s22, s20, 12288
  s_add_u32 s22, s22, 0
  s_add_u32 m0, s22, 0
  s_nop 0
  buffer_load_dwordx4 v4, s[12:15], s21 offen lds
  s_add_u32 m0, s22, 1024
  s_nop 0
  buffer_load_dwordx4 v5, s[12:15], s21 offen lds
  s_add_u32 m0, s22, 2048
  s_nop 0
  buffer_load_dwordx4 v6, s[12:15], s21 offen lds
  s_mul_i32 s21, s20, 393216
  s_add_u32 s21, s21, 6389760
  s_add_u32 s21, s21, s44
  s_mul_i32 s22, s20, 12288
  s_add_u32 s22, s22, 3072
  s_add_u32 m0, s22, 0
  s_nop 0
  buffer_load_dwordx4 v4, s[12:15], s21 offen lds
  s_add_u32 m0, s22, 1024
  s_nop 0
  buffer_load_dwordx4 v5, s[12:15], s21 offen lds
  s_add_u32 m0, s22, 2048
  s_nop 0
  buffer_load_dwordx4 v6, s[12:15], s21 offen lds
  s_mul_i32 s21, s20, 393216
  s_add_u32 s21, s21, 6488064
  s_add_u32 s21, s21, s44
  s_mul_i32 s22, s20, 12288
  s_add_u32 s22, s22, 6144
  s_add_u32 m0, s22, 0
  s_nop 0
  buffer_load_dwordx4 v4, s[12:15], s21 offen lds
  s_add_u32 m0, s22, 1024
  s_nop 0
  buffer_load_dwordx4 v5, s[12:15], s21 offen lds
  s_add_u32 m0, s22, 2048
  s_nop 0
  buffer_load_dwordx4 v6, s[12:15], s21 offen lds
  s_mul_i32 s21, s20, 393216
  s_add_u32 s21, s21, 6586368
  s_add_u32 s21, s21, s44
  s_mul_i32 s22, s20, 12288
  s_add_u32 s22, s22, 9216
  s_add_u32 m0, s22, 0
  s_nop 0
  buffer_load_dwordx4 v4, s[12:15], s21 offen lds
  s_add_u32 m0, s22, 1024
  s_nop 0
  buffer_load_dwordx4 v5, s[12:15], s21 offen lds
  s_add_u32 m0, s22, 2048
  s_nop 0
  buffer_load_dwordx4 v6, s[12:15], s21 offen lds
  s_waitcnt vmcnt(12)
  s_barrier
  ds_read_b64_tr_b16 a[144:145], v8 offset:0
  ds_read_b64_tr_b16 a[146:147], v8 offset:1536
  ds_read_b64_tr_b16 a[148:149], v8 offset:32
  ds_read_b64_tr_b16 a[150:151], v8 offset:1568
  ds_read_b64_tr_b16 a[152:153], v8 offset:64
  ds_read_b64_tr_b16 a[154:155], v8 offset:1600
  ds_read_b64_tr_b16 a[156:157], v8 offset:12288
  ds_read_b64_tr_b16 a[158:159], v8 offset:13824
  ds_read_b64_tr_b16 a[160:161], v8 offset:12320
  ds_read_b64_tr_b16 a[162:163], v8 offset:13856
  ds_read_b64_tr_b16 a[164:165], v8 offset:12352
  ds_read_b64_tr_b16 a[166:167], v8 offset:13888
  ds_read_b64_tr_b16 a[168:169], v8 offset:24576
  ds_read_b64_tr_b16 a[170:171], v8 offset:26112
  ds_read_b64_tr_b16 a[172:173], v8 offset:24608
  ds_read_b64_tr_b16 a[174:175], v8 offset:26144
  ds_read_b64_tr_b16 a[176:177], v8 offset:24640
  ds_read_b64_tr_b16 a[178:179], v8 offset:26176
  ds_read_b64_tr_b16 a[180:181], v8 offset:36864
  ds_read_b64_tr_b16 a[182:183], v8 offset:38400
  ds_read_b64_tr_b16 a[184:185], v8 offset:36896
  ds_read_b64_tr_b16 a[186:187], v8 offset:38432
  ds_read_b64_tr_b16 a[188:189], v8 offset:36928
  ds_read_b64_tr_b16 a[190:191], v8 offset:38464
  s_waitcnt lgkmcnt(0)
  s_barrier
  s_waitcnt vmcnt(0)
  s_barrier
  ds_read_b64_tr_b16 a[192:193], v7 offset:0
  ds_read_b64_tr_b16 a[194:195], v7 offset:1536
  ds_read_b64_tr_b16 a[196:197], v7 offset:32
  ds_read_b64_tr_b16 a[198:199], v7 offset:1568
  ds_read_b64_tr_b16 a[200:201], v7 offset:64
  ds_read_b64_tr_b16 a[202:203], v7 offset:1600
  ds_read_b64_tr_b16 a[204:205], v7 offset:12288
  ds_read_b64_tr_b16 a[206:207], v7 offset:13824
  ds_read_b64_tr_b16 a[208:209], v7 offset:12320
  ds_read_b64_tr_b16 a[210:211], v7 offset:13856
  ds_read_b64_tr_b16 a[212:213], v7 offset:12352
  ds_read_b64_tr_b16 a[214:215], v7 offset:13888
  ds_read_b64_tr_b16 a[216:217], v7 offset:24576
  ds_read_b64_tr_b16 a[218:219], v7 offset:26112
  ds_read_b64_tr_b16 a[220:221], v7 offset:24608
  ds_read_b64_tr_b16 a[222:223], v7 offset:26144
  ds_read_b64_tr_b16 a[224:225], v7 offset:24640
  ds_read_b64_tr_b16 a[226:227], v7 offset:26176
  ds_read_b64_tr_b16 a[228:229], v7 offset:36864
  ds_read_b64_tr_b16 a[230:231], v7 offset:38400
  ds_read_b64_tr_b16 a[232:233], v7 offset:36896
  ds_read_b64_tr_b16 a[234:235], v7 offset:38432
  ds_read_b64_tr_b16 a[236:237], v7 offset:36928
  ds_read_b64_tr_b16 a[238:239], v7 offset:38464
  s_waitcnt lgkmcnt(0)
  s_barrier
  v_and_b32 v6, 7, v2
  v_add_u32 v4, 0, v3
  v_xor_b32 v4, v4, v6
  v_lshlrev_b32 v4, 4, v4
  v_lshl_add_u32 v14, v2, 7, v4
  v_add_u32 v16, 65536, v14
  v_add_u32 v18, 131072, v14
  v_add_u32 v4, 4, v3
  v_xor_b32 v4, v4, v6
  v_lshlrev_b32 v4, 4, v4
  v_lshl_add_u32 v15, v2, 7, v4
  v_add_u32 v17, 65536, v15
  v_add_u32 v19, 131072, v15
  v_lshlrev_b32 v26, 4, v1
  v_mov_b32 v28, 1
  v_mov_b32 v4, 0x40000000
  v_cmp_eq_u32 vcc, 0, v0
  s_nop 1
  v_cndmask_b32 v27, v4, 0, vcc
  s_mov_b32 s26, 6
  s_lshl_b32 s27, s42, 2
  s_add_u32 s27, s27, s20
  s_lshl_b32 s27, s27, 14
  s_lshl_b32 s21, s43, 13
  s_xor_b32 s27, s27, s21
  v_readfirstlane_b32 s100, v29
  s_cmp_lg_u32 s100, 0
  s_cbranch_scc1 kvz_237
  s_mov_b32 s21, 76
  v_mov_b32 v4, 0
  s_mov_b32 s101, 0
wf_238:
  buffer_load_dword v5, v4, s[32:35], s21 offen sc1
  s_add_u32 s101, s101, 1
  s_cmp_gt_u32 s101, 131072
  s_cbranch_scc1 main_end
  s_waitcnt vmcnt(0)
  v_readfirstlane_b32 s100, v5
  s_cmp_ge_u32 s100, 1
  s_cbranch_scc1 wf_239
  s_sleep 8
  s_branch wf_238
wf_239:
kvz_237:
  s_sub_u32 s80, s100, 1
  s_lshl_b32 s80, s80, 13
  s_xor_b32 s27, s27, s80
  s_lshl_b32 s60, s40, 7
  s_add_u32 s60, s60, 28672
  s_xor_b32 s60, s60, s80
  s_mov_b32 s48, 0x40000000
  s_mov_b32 s61, 0x40000000
  s_waitcnt vmcnt(14)
  s_barrier
  ds_read_b128 v[160:163], v16 offset:32768
  ds_read_b128 v[164:167], v16 offset:34816
  ds_read_b128 v[168:171], v16 offset:36864
  ds_read_b128 v[172:175], v16 offset:38912
  s_waitcnt lgkmcnt(3)
  .p2align 3
kvm_240:
  v_mfma_f32_16x16x32_bf16 v[64:67], a[0:3], v[160:163], 0
  s_xor_b32 s29, s48, 0
  ds_read_b128 v[176:179], v17 offset:32768
  v_cvt_pk_bf16_f32 v204, v88, v89
  v_mfma_f32_16x16x32_bf16 v[68:71], a[4:7], v[160:163], 0
  v_cvt_pk_bf16_f32 v205, v90, v91
  v_cvt_pk_bf16_f32 v206, v92, v93
  v_mfma_f32_16x16x32_bf16 v[72:75], a[8:11], v[160:163], 0
  s_waitcnt lgkmcnt(3)
  v_cvt_pk_bf16_f32 v207, v94, v95
  v_cvt_pk_bf16_f32 v212, v96, v97
  v_mfma_f32_16x16x32_bf16 v[76:79], a[0:3], v[164:167], 0
  ds_read_b128 v[180:183], v17 offset:34816
  v_cvt_pk_bf16_f32 v213, v98, v99
  v_mfma_f32_16x16x32_bf16 v[80:83], a[4:7], v[164:167], 0
  v_cvt_pk_bf16_f32 v208, v100, v101
  v_cvt_pk_bf16_f32 v209, v102, v103
  v_mfma_f32_16x16x32_bf16 v[84:87], a[8:11], v[164:167], 0
  s_waitcnt lgkmcnt(3)
  v_cvt_pk_bf16_f32 v210, v104, v105
  v_cvt_pk_bf16_f32 v211, v106, v107
  v_mfma_f32_16x16x32_bf16 v[88:91], a[0:3], v[168:171], 0
  ds_read_b128 v[184:187], v17 offset:36864
  v_cvt_pk_bf16_f32 v214, v108, v109
  v_mfma_f32_16x16x32_bf16 v[92:95], a[4:7], v[168:171], 0
  s_add_u32 m0, s31, 81920
  v_cvt_pk_bf16_f32 v215, v110, v111
  buffer_store_dwordx4 v[192:195], v26, s[16:19], s29 offen offset:0 sc1
  v_mfma_f32_16x16x32_bf16 v[96:99], a[8:11], v[168:171], 0
  s_waitcnt lgkmcnt(3)
  buffer_load_dwordx4 v10, s[8:11], s30 offen lds
  v_mfma_f32_16x16x32_bf16 v[100:103], a[0:3], v[172:175], 0
  ds_read_b128 v[188:191], v17 offset:38912
  v_mfma_f32_16x16x32_bf16 v[104:107], a[4:7], v[172:175], 0
  v_mfma_f32_16x16x32_bf16 v[108:111], a[8:11], v[172:175], 0
  s_waitcnt lgkmcnt(3)
  buffer_store_dwordx4 v[196:199], v26, s[16:19], s29 offen offset:1024 sc1
  v_mfma_f32_16x16x32_bf16 v[64:67], a[12:15], v[176:179], v[64:67]
  s_waitcnt vmcnt(15)
  s_barrier
  ds_read_b128 v[160:163], v16 offset:40960
  v_mfma_f32_16x16x32_bf16 v[68:71], a[16:19], v[176:179], v[68:71]
  s_add_u32 m0, s31, 82944
  v_mfma_f32_16x16x32_bf16 v[72:75], a[20:23], v[176:179], v[72:75]
  s_waitcnt lgkmcnt(3)
  buffer_load_dwordx4 v11, s[8:11], s30 offen lds
  v_mfma_f32_16x16x32_bf16 v[76:79], a[12:15], v[180:183], v[76:79]
  s_add_u32 s30, s30, 128
  ds_read_b128 v[164:167], v16 offset:43008
  buffer_store_dwordx4 v[200:203], v26, s[16:19], s29 offen offset:2048 sc1
  v_mfma_f32_16x16x32_bf16 v[80:83], a[16:19], v[180:183], v[80:83]
  v_mfma_f32_16x16x32_bf16 v[84:87], a[20:23], v[180:183], v[84:87]
  s_waitcnt lgkmcnt(3)
  v_mfma_f32_16x16x32_bf16 v[88:91], a[12:15], v[184:187], v[88:91]
  s_xor_b32 s29, s48, 2105344
  ds_read_b128 v[168:171], v16 offset:45056
  v_mfma_f32_16x16x32_bf16 v[92:95], a[16:19], v[184:187], v[92:95]
  buffer_store_dwordx4 v[204:207], v26, s[16:19], s29 offen offset:0 sc1
  v_mfma_f32_16x16x32_bf16 v[96:99], a[20:23], v[184:187], v[96:99]
  s_waitcnt lgkmcnt(3)
  v_mfma_f32_16x16x32_bf16 v[100:103], a[12:15], v[188:191], v[100:103]
  ds_read_b128 v[172:175], v16 offset:47104
  v_mfma_f32_16x16x32_bf16 v[104:107], a[16:19], v[188:191], v[104:107]
  v_mfma_f32_16x16x32_bf16 v[108:111], a[20:23], v[188:191], v[108:111]
  s_waitcnt lgkmcnt(3)
  buffer_store_dwordx4 v[208:211], v26, s[16:19], s29 offen offset:1024 sc1
  v_mfma_f32_16x16x32_bf16 v[64:67], a[24:27], v[160:163], v[64:67]
  ds_read_b128 v[176:179], v17 offset:40960
  v_mfma_f32_16x16x32_bf16 v[68:71], a[28:31], v[160:163], v[68:71]
  s_add_u32 m0, s31, 90112
  v_mfma_f32_16x16x32_bf16 v[72:75], a[32:35], v[160:163], v[72:75]
  s_waitcnt lgkmcnt(3)
  buffer_load_dwordx4 v10, s[8:11], s30 offen lds
  v_mfma_f32_16x16x32_bf16 v[76:79], a[24:27], v[164:167], v[76:79]
  ds_read_b128 v[180:183], v17 offset:43008
  buffer_store_dwordx4 v[212:215], v26, s[16:19], s29 offen offset:2048 sc1
  v_mfma_f32_16x16x32_bf16 v[80:83], a[28:31], v[164:167], v[80:83]
  v_mfma_f32_16x16x32_bf16 v[84:87], a[32:35], v[164:167], v[84:87]
  s_waitcnt lgkmcnt(3)
  v_mfma_f32_16x16x32_bf16 v[88:91], a[24:27], v[168:171], v[88:91]
  ds_read_b128 v[184:187], v17 offset:45056
  v_mfma_f32_16x16x32_bf16 v[92:95], a[28:31], v[168:171], v[92:95]
  s_add_u32 m0, s31, 91136
  v_mfma_f32_16x16x32_bf16 v[96:99], a[32:35], v[168:171], v[96:99]
  s_waitcnt lgkmcnt(3)
  buffer_load_dwordx4 v11, s[8:11], s30 offen lds
  v_mfma_f32_16x16x32_bf16 v[100:103], a[24:27], v[172:175], v[100:103]
  s_add_u32 s30, s30, s25
  ds_read_b128 v[188:191], v17 offset:47104
  v_mfma_f32_16x16x32_bf16 v[104:107], a[28:31], v[172:175], v[104:107]
  v_mfma_f32_16x16x32_bf16 v[108:111], a[32:35], v[172:175], v[108:111]
  s_waitcnt lgkmcnt(3)
  v_mfma_f32_16x16x32_bf16 v[64:67], a[36:39], v[176:179], v[64:67]
  s_waitcnt vmcnt(20)
  s_barrier
  ds_read_b128 v[160:163], v16 offset:49152
  v_mfma_f32_16x16x32_bf16 v[68:71], a[40:43], v[176:179], v[68:71]
  v_mfma_f32_16x16x32_bf16 v[72:75], a[44:47], v[176:179], v[72:75]
  s_waitcnt lgkmcnt(3)
  v_mfma_f32_16x16x32_bf16 v[76:79], a[36:39], v[180:183], v[76:79]
  ds_read_b128 v[164:167], v16 offset:51200
  v_mfma_f32_16x16x32_bf16 v[80:83], a[40:43], v[180:183], v[80:83]
  v_mfma_f32_16x16x32_bf16 v[84:87], a[44:47], v[180:183], v[84:87]
  s_waitcnt lgkmcnt(3)
  v_mfma_f32_16x16x32_bf16 v[88:91], a[36:39], v[184:187], v[88:91]
  ds_read_b128 v[168:171], v16 offset:53248
  v_mfma_f32_16x16x32_bf16 v[92:95], a[40:43], v[184:187], v[92:95]
  v_mfma_f32_16x16x32_bf16 v[96:99], a[44:47], v[184:187], v[96:99]
  s_waitcnt lgkmcnt(3)
  v_mfma_f32_16x16x32_bf16 v[100:103], a[36:39], v[188:191], v[100:103]
  ds_read_b128 v[172:175], v16 offset:55296
  v_mfma_f32_16x16x32_bf16 v[104:107], a[40:43], v[188:191], v[104:107]
  v_mfma_f32_16x16x32_bf16 v[108:111], a[44:47], v[188:191], v[108:111]
  s_waitcnt lgkmcnt(3)
  v_mfma_f32_16x16x32_bf16 v[64:67], a[48:51], v[160:163], v[64:67]
  ds_read_b128 v[176:179], v17 offset:49152
  v_mfma_f32_16x16x32_bf16 v[68:71], a[52:55], v[160:163], v[68:71]
  s_add_u32 m0, s31, 98304
  v_mfma_f32_16x16x32_bf16 v[72:75], a[56:59], v[160:163], v[72:75]
  s_waitcnt lgkmcnt(3)
  buffer_load_dwordx4 v10, s[8:11], s30 offen lds
  v_mfma_f32_16x16x32_bf16 v[76:79], a[48:51], v[164:167], v[76:79]
  ds_read_b128 v[180:183], v17 offset:51200
  v_mfma_f32_16x16x32_bf16 v[80:83], a[52:55], v[164:167], v[80:83]
  v_mfma_f32_16x16x32_bf16 v[84:87], a[56:59], v[164:167], v[84:87]
  s_waitcnt lgkmcnt(3)
  v_mfma_f32_16x16x32_bf16 v[88:91], a[48:51], v[168:171], v[88:91]
  ds_read_b128 v[184:187], v17 offset:53248
  v_mfma_f32_16x16x32_bf16 v[92:95], a[52:55], v[168:171], v[92:95]
  s_add_u32 m0, s31, 99328
  v_mfma_f32_16x16x32_bf16 v[96:99], a[56:59], v[168:171], v[96:99]
  s_waitcnt lgkmcnt(3)
  buffer_load_dwordx4 v11, s[8:11], s30 offen lds
  v_mfma_f32_16x16x32_bf16 v[100:103], a[48:51], v[172:175], v[100:103]
  s_add_u32 s30, s30, 128
  ds_read_b128 v[188:191], v17 offset:55296
  v_mfma_f32_16x16x32_bf16 v[104:107], a[52:55], v[172:175], v[104:107]
  v_mfma_f32_16x16x32_bf16 v[108:111], a[56:59], v[172:175], v[108:111]
  s_waitcnt lgkmcnt(3)
  v_mfma_f32_16x16x32_bf16 v[64:67], a[60:63], v[176:179], v[64:67]
  s_waitcnt vmcnt(20)
  s_barrier
  ds_read_b128 v[160:163], v16 offset:57344
  v_mfma_f32_16x16x32_bf16 v[68:71], a[64:67], v[176:179], v[68:71]
  v_mfma_f32_16x16x32_bf16 v[72:75], a[68:71], v[176:179], v[72:75]
  s_waitcnt lgkmcnt(3)
  v_mfma_f32_16x16x32_bf16 v[76:79], a[60:63], v[180:183], v[76:79]
  ds_read_b128 v[164:167], v16 offset:59392
  v_mfma_f32_16x16x32_bf16 v[80:83], a[64:67], v[180:183], v[80:83]
  v_mfma_f32_16x16x32_bf16 v[84:87], a[68:71], v[180:183], v[84:87]
  s_waitcnt lgkmcnt(3)
  v_mfma_f32_16x16x32_bf16 v[88:91], a[60:63], v[184:187], v[88:91]
  ds_read_b128 v[168:171], v16 offset:61440
  v_mfma_f32_16x16x32_bf16 v[92:95], a[64:67], v[184:187], v[92:95]
  v_mfma_f32_16x16x32_bf16 v[96:99], a[68:71], v[184:187], v[96:99]
  s_waitcnt lgkmcnt(3)
  v_mfma_f32_16x16x32_bf16 v[100:103], a[60:63], v[188:191], v[100:103]
  ds_read_b128 v[172:175], v16 offset:63488
  v_mfma_f32_16x16x32_bf16 v[104:107], a[64:67], v[188:191], v[104:107]
  v_mfma_f32_16x16x32_bf16 v[108:111], a[68:71], v[188:191], v[108:111]
  s_waitcnt lgkmcnt(3)
  v_mfma_f32_16x16x32_bf16 v[64:67], a[72:75], v[160:163], v[64:67]
  ds_read_b128 v[176:179], v17 offset:57344
  v_mfma_f32_16x16x32_bf16 v[68:71], a[76:79], v[160:163], v[68:71]
  s_add_u32 m0, s31, 106496
  v_mfma_f32_16x16x32_bf16 v[72:75], a[80:83], v[160:163], v[72:75]
  s_waitcnt lgkmcnt(3)
  buffer_load_dwordx4 v10, s[8:11], s30 offen lds
  v_mfma_f32_16x16x32_bf16 v[76:79], a[72:75], v[164:167], v[76:79]
  ds_read_b128 v[180:183], v17 offset:59392
  v_mfma_f32_16x16x32_bf16 v[80:83], a[76:79], v[164:167], v[80:83]
  v_mfma_f32_16x16x32_bf16 v[84:87], a[80:83], v[164:167], v[84:87]
  s_waitcnt lgkmcnt(3)
  v_mfma_f32_16x16x32_bf16 v[88:91], a[72:75], v[168:171], v[88:91]
  ds_read_b128 v[184:187], v17 offset:61440
  v_mfma_f32_16x16x32_bf16 v[92:95], a[76:79], v[168:171], v[92:95]
  s_add_u32 m0, s31, 107520
  v_mfma_f32_16x16x32_bf16 v[96:99], a[80:83], v[168:171], v[96:99]
  s_waitcnt lgkmcnt(3)
  buffer_load_dwordx4 v11, s[8:11], s30 offen lds
  v_mfma_f32_16x16x32_bf16 v[100:103], a[72:75], v[172:175], v[100:103]
  s_add_u32 s30, s30, 128
  ds_read_b128 v[188:191], v17 offset:63488
  v_mfma_f32_16x16x32_bf16 v[104:107], a[76:79], v[172:175], v[104:107]
  v_mfma_f32_16x16x32_bf16 v[108:111], a[80:83], v[172:175], v[108:111]
  s_waitcnt lgkmcnt(3)
  v_mfma_f32_16x16x32_bf16 v[64:67], a[84:87], v[176:179], v[64:67]
  s_waitcnt vmcnt(5)
  s_barrier
  ds_read_b128 v[160:163], v18 offset:0
  v_mfma_f32_16x16x32_bf16 v[68:71], a[88:91], v[176:179], v[68:71]
  buffer_atomic_add v28, v27, s[72:75], s61 offen sc1
  v_mfma_f32_16x16x32_bf16 v[72:75], a[92:95], v[176:179], v[72:75]
  s_waitcnt lgkmcnt(3)
  s_mov_b32 s48, s27
  s_add_u32 s27, s27, 4194304
  v_mfma_f32_16x16x32_bf16 v[76:79], a[84:87], v[180:183], v[76:79]
  s_mov_b32 s61, s60
  ds_read_b128 v[164:167], v18 offset:2048
  s_add_u32 s60, s60, 4
  v_mfma_f32_16x16x32_bf16 v[80:83], a[88:91], v[180:183], v[80:83]
  v_mfma_f32_16x16x32_bf16 v[84:87], a[92:95], v[180:183], v[84:87]
  s_waitcnt lgkmcnt(3)
  v_mfma_f32_16x16x32_bf16 v[88:91], a[84:87], v[184:187], v[88:91]
  ds_read_b128 v[168:171], v18 offset:4096
  v_mfma_f32_16x16x32_bf16 v[92:95], a[88:91], v[184:187], v[92:95]
  v_mfma_f32_16x16x32_bf16 v[96:99], a[92:95], v[184:187], v[96:99]
  s_waitcnt lgkmcnt(3)
  v_mfma_f32_16x16x32_bf16 v[100:103], a[84:87], v[188:191], v[100:103]
  ds_read_b128 v[172:175], v18 offset:6144
  v_mfma_f32_16x16x32_bf16 v[104:107], a[88:91], v[188:191], v[104:107]
  v_mfma_f32_16x16x32_bf16 v[108:111], a[92:95], v[188:191], v[108:111]
  s_waitcnt lgkmcnt(3)
  v_mfma_f32_16x16x32_bf16 v[64:67], a[96:99], v[160:163], v[64:67]
  ds_read_b128 v[176:179], v19 offset:0
  v_mfma_f32_16x16x32_bf16 v[68:71], a[100:103], v[160:163], v[68:71]
  s_add_u32 m0, s31, 114688
  v_mfma_f32_16x16x32_bf16 v[72:75], a[104:107], v[160:163], v[72:75]
  s_waitcnt lgkmcnt(3)
  buffer_load_dwordx4 v10, s[8:11], s30 offen lds
  v_mfma_f32_16x16x32_bf16 v[76:79], a[96:99], v[164:167], v[76:79]
  ds_read_b128 v[180:183], v19 offset:2048
  v_mfma_f32_16x16x32_bf16 v[80:83], a[100:103], v[164:167], v[80:83]
  v_mfma_f32_16x16x32_bf16 v[84:87], a[104:107], v[164:167], v[84:87]
  s_waitcnt lgkmcnt(3)
  v_mfma_f32_16x16x32_bf16 v[88:91], a[96:99], v[168:171], v[88:91]
  ds_read_b128 v[184:187], v19 offset:4096
  v_mfma_f32_16x16x32_bf16 v[92:95], a[100:103], v[168:171], v[92:95]
  s_add_u32 m0, s31, 115712
  v_mfma_f32_16x16x32_bf16 v[96:99], a[104:107], v[168:171], v[96:99]
  s_waitcnt lgkmcnt(3)
  buffer_load_dwordx4 v11, s[8:11], s30 offen lds
  v_mfma_f32_16x16x32_bf16 v[100:103], a[96:99], v[172:175], v[100:103]
  s_add_u32 s30, s30, 128
  ds_read_b128 v[188:191], v19 offset:6144
  v_mfma_f32_16x16x32_bf16 v[104:107], a[100:103], v[172:175], v[104:107]
  v_mfma_f32_16x16x32_bf16 v[108:111], a[104:107], v[172:175], v[108:111]
  s_waitcnt lgkmcnt(3)
  v_mfma_f32_16x16x32_bf16 v[64:67], a[108:111], v[176:179], v[64:67]
  s_waitcnt vmcnt(21)
  s_barrier
  ds_read_b128 v[160:163], v18 offset:8192
  v_mfma_f32_16x16x32_bf16 v[68:71], a[112:115], v[176:179], v[68:71]
  v_mfma_f32_16x16x32_bf16 v[72:75], a[116:119], v[176:179], v[72:75]
  s_waitcnt lgkmcnt(3)
  v_mfma_f32_16x16x32_bf16 v[76:79], a[108:111], v[180:183], v[76:79]
  ds_read_b128 v[164:167], v18 offset:10240
  v_mfma_f32_16x16x32_bf16 v[80:83], a[112:115], v[180:183], v[80:83]
  v_mfma_f32_16x16x32_bf16 v[84:87], a[116:119], v[180:183], v[84:87]
  s_waitcnt lgkmcnt(3)
  v_mfma_f32_16x16x32_bf16 v[88:91], a[108:111], v[184:187], v[88:91]
  ds_read_b128 v[168:171], v18 offset:12288
  v_mfma_f32_16x16x32_bf16 v[92:95], a[112:115], v[184:187], v[92:95]
  v_mfma_f32_16x16x32_bf16 v[96:99], a[116:119], v[184:187], v[96:99]
  s_waitcnt lgkmcnt(3)
  v_mfma_f32_16x16x32_bf16 v[100:103], a[108:111], v[188:191], v[100:103]
  ds_read_b128 v[172:175], v18 offset:14336
  v_mfma_f32_16x16x32_bf16 v[104:107], a[112:115], v[188:191], v[104:107]
  v_mfma_f32_16x16x32_bf16 v[108:111], a[116:119], v[188:191], v[108:111]
  s_waitcnt lgkmcnt(3)
  v_mfma_f32_16x16x32_bf16 v[64:67], a[120:123], v[160:163], v[64:67]
  ds_read_b128 v[176:179], v19 offset:8192
  v_mfma_f32_16x16x32_bf16 v[68:71], a[124:127], v[160:163], v[68:71]
  s_add_u32 m0, s31, 122880
  v_mfma_f32_16x16x32_bf16 v[72:75], a[128:131], v[160:163], v[72:75]
  s_waitcnt lgkmcnt(3)
  buffer_load_dwordx4 v10, s[8:11], s30 offen lds
  v_mfma_f32_16x16x32_bf16 v[76:79], a[120:123], v[164:167], v[76:79]
  ds_read_b128 v[180:183], v19 offset:10240
  v_mfma_f32_16x16x32_bf16 v[80:83], a[124:127], v[164:167], v[80:83]
  v_mfma_f32_16x16x32_bf16 v[84:87], a[128:131], v[164:167], v[84:87]
  s_waitcnt lgkmcnt(3)
  v_mfma_f32_16x16x32_bf16 v[88:91], a[120:123], v[168:171], v[88:91]
  ds_read_b128 v[184:187], v19 offset:12288
  v_mfma_f32_16x16x32_bf16 v[92:95], a[124:127], v[168:171], v[92:95]
  s_add_u32 m0, s31, 123904
  v_mfma_f32_16x16x32_bf16 v[96:99], a[128:131], v[168:171], v[96:99]
  s_waitcnt lgkmcnt(3)
  buffer_load_dwordx4 v11, s[8:11], s30 offen lds
  v_mfma_f32_16x16x32_bf16 v[100:103], a[120:123], v[172:175], v[100:103]
  s_add_u32 s30, s30, 128
  ds_read_b128 v[188:191], v19 offset:14336
  v_mfma_f32_16x16x32_bf16 v[104:107], a[124:127], v[172:175], v[104:107]
  v_mfma_f32_16x16x32_bf16 v[108:111], a[128:131], v[172:175], v[108:111]
  s_waitcnt lgkmcnt(3)
  v_mfma_f32_16x16x32_bf16 v[64:67], a[132:135], v[176:179], v[64:67]
  s_waitcnt vmcnt(21)
  s_barrier
  ds_read_b128 v[160:163], v18 offset:16384
  v_mfma_f32_16x16x32_bf16 v[68:71], a[136:139], v[176:179], v[68:71]
  v_mfma_f32_16x16x32_bf16 v[72:75], a[140:143], v[176:179], v[72:75]
  s_waitcnt lgkmcnt(3)
  v_mfma_f32_16x16x32_bf16 v[76:79], a[132:135], v[180:183], v[76:79]
  ds_read_b128 v[164:167], v18 offset:18432
  v_mfma_f32_16x16x32_bf16 v[80:83], a[136:139], v[180:183], v[80:83]
  v_mfma_f32_16x16x32_bf16 v[84:87], a[140:143], v[180:183], v[84:87]
  s_waitcnt lgkmcnt(3)
  v_mfma_f32_16x16x32_bf16 v[88:91], a[132:135], v[184:187], v[88:91]
  ds_read_b128 v[168:171], v18 offset:20480
  v_mfma_f32_16x16x32_bf16 v[92:95], a[136:139], v[184:187], v[92:95]
  v_mfma_f32_16x16x32_bf16 v[96:99], a[140:143], v[184:187], v[96:99]
  s_waitcnt lgkmcnt(3)
  v_mfma_f32_16x16x32_bf16 v[100:103], a[132:135], v[188:191], v[100:103]
  ds_read_b128 v[172:175], v18 offset:22528
  v_mfma_f32_16x16x32_bf16 v[104:107], a[136:139], v[188:191], v[104:107]
  v_mfma_f32_16x16x32_bf16 v[108:111], a[140:143], v[188:191], v[108:111]
  s_waitcnt lgkmcnt(3)
  v_mfma_f32_16x16x32_bf16 v[64:67], a[144:147], v[160:163], v[64:67]
  ds_read_b128 v[176:179], v19 offset:16384
  v_mfma_f32_16x16x32_bf16 v[68:71], a[148:151], v[160:163], v[68:71]
  s_add_u32 m0, s31, 131072
  v_mfma_f32_16x16x32_bf16 v[72:75], a[152:155], v[160:163], v[72:75]
  s_waitcnt lgkmcnt(3)
  buffer_load_dwordx4 v10, s[8:11], s30 offen lds
  v_mfma_f32_16x16x32_bf16 v[76:79], a[144:147], v[164:167], v[76:79]
  ds_read_b128 v[180:183], v19 offset:18432
  v_mfma_f32_16x16x32_bf16 v[80:83], a[148:151], v[164:167], v[80:83]
  v_mfma_f32_16x16x32_bf16 v[84:87], a[152:155], v[164:167], v[84:87]
  s_waitcnt lgkmcnt(3)
  v_mfma_f32_16x16x32_bf16 v[88:91], a[144:147], v[168:171], v[88:91]
  ds_read_b128 v[184:187], v19 offset:20480
  v_mfma_f32_16x16x32_bf16 v[92:95], a[148:151], v[168:171], v[92:95]
  s_add_u32 m0, s31, 132096
  v_mfma_f32_16x16x32_bf16 v[96:99], a[152:155], v[168:171], v[96:99]
  s_waitcnt lgkmcnt(3)
  buffer_load_dwordx4 v11, s[8:11], s30 offen lds
  v_mfma_f32_16x16x32_bf16 v[100:103], a[144:147], v[172:175], v[100:103]
  s_add_u32 s30, s30, 128
  ds_read_b128 v[188:191], v19 offset:22528
  v_mfma_f32_16x16x32_bf16 v[104:107], a[148:151], v[172:175], v[104:107]
  v_mfma_f32_16x16x32_bf16 v[108:111], a[152:155], v[172:175], v[108:111]
  s_waitcnt lgkmcnt(3)
  v_mfma_f32_16x16x32_bf16 v[64:67], a[156:159], v[176:179], v[64:67]
  s_waitcnt vmcnt(21)
  s_barrier
  ds_read_b128 v[160:163], v18 offset:24576
  v_mfma_f32_16x16x32_bf16 v[68:71], a[160:163], v[176:179], v[68:71]
  v_mfma_f32_16x16x32_bf16 v[72:75], a[164:167], v[176:179], v[72:75]
  s_waitcnt lgkmcnt(3)
  v_mfma_f32_16x16x32_bf16 v[76:79], a[156:159], v[180:183], v[76:79]
  ds_read_b128 v[164:167], v18 offset:26624
  v_mfma_f32_16x16x32_bf16 v[80:83], a[160:163], v[180:183], v[80:83]
  v_mfma_f32_16x16x32_bf16 v[84:87], a[164:167], v[180:183], v[84:87]
  s_waitcnt lgkmcnt(3)
  v_mfma_f32_16x16x32_bf16 v[88:91], a[156:159], v[184:187], v[88:91]
  ds_read_b128 v[168:171], v18 offset:28672
  v_mfma_f32_16x16x32_bf16 v[92:95], a[160:163], v[184:187], v[92:95]
  v_mfma_f32_16x16x32_bf16 v[96:99], a[164:167], v[184:187], v[96:99]
  s_waitcnt lgkmcnt(3)
  v_mfma_f32_16x16x32_bf16 v[100:103], a[156:159], v[188:191], v[100:103]
  ds_read_b128 v[172:175], v18 offset:30720
  v_mfma_f32_16x16x32_bf16 v[104:107], a[160:163], v[188:191], v[104:107]
  v_mfma_f32_16x16x32_bf16 v[108:111], a[164:167], v[188:191], v[108:111]
  s_waitcnt lgkmcnt(3)
  v_mfma_f32_16x16x32_bf16 v[64:67], a[168:171], v[160:163], v[64:67]
  ds_read_b128 v[176:179], v19 offset:24576
  v_mfma_f32_16x16x32_bf16 v[68:71], a[172:175], v[160:163], v[68:71]
  s_add_u32 m0, s31, 139264
  v_mfma_f32_16x16x32_bf16 v[72:75], a[176:179], v[160:163], v[72:75]
  s_waitcnt lgkmcnt(3)
  buffer_load_dwordx4 v10, s[8:11], s30 offen lds
  v_mfma_f32_16x16x32_bf16 v[76:79], a[168:171], v[164:167], v[76:79]
  ds_read_b128 v[180:183], v19 offset:26624
  v_mfma_f32_16x16x32_bf16 v[80:83], a[172:175], v[164:167], v[80:83]
  v_mfma_f32_16x16x32_bf16 v[84:87], a[176:179], v[164:167], v[84:87]
  s_waitcnt lgkmcnt(3)
  v_mfma_f32_16x16x32_bf16 v[88:91], a[168:171], v[168:171], v[88:91]
  ds_read_b128 v[184:187], v19 offset:28672
  v_mfma_f32_16x16x32_bf16 v[92:95], a[172:175], v[168:171], v[92:95]
  s_add_u32 m0, s31, 140288
  v_mfma_f32_16x16x32_bf16 v[96:99], a[176:179], v[168:171], v[96:99]
  s_waitcnt lgkmcnt(3)
  buffer_load_dwordx4 v11, s[8:11], s30 offen lds
  v_mfma_f32_16x16x32_bf16 v[100:103], a[168:171], v[172:175], v[100:103]
  s_add_u32 s30, s30, 128
  ds_read_b128 v[188:191], v19 offset:30720
  v_mfma_f32_16x16x32_bf16 v[104:107], a[172:175], v[172:175], v[104:107]
  v_mfma_f32_16x16x32_bf16 v[108:111], a[176:179], v[172:175], v[108:111]
  s_waitcnt lgkmcnt(3)
  v_mfma_f32_16x16x32_bf16 v[64:67], a[180:183], v[176:179], v[64:67]
  s_waitcnt vmcnt(19)
  s_barrier
  ds_read_b128 v[160:163], v16 offset:16384
  v_mfma_f32_16x16x32_bf16 v[68:71], a[184:187], v[176:179], v[68:71]
  v_mfma_f32_16x16x32_bf16 v[72:75], a[188:191], v[176:179], v[72:75]
  s_waitcnt lgkmcnt(3)
  v_mfma_f32_16x16x32_bf16 v[76:79], a[180:183], v[180:183], v[76:79]
  ds_read_b128 v[164:167], v16 offset:18432
  v_mfma_f32_16x16x32_bf16 v[80:83], a[184:187], v[180:183], v[80:83]
  v_mfma_f32_16x16x32_bf16 v[84:87], a[188:191], v[180:183], v[84:87]
  s_waitcnt lgkmcnt(3)
  v_mfma_f32_16x16x32_bf16 v[88:91], a[180:183], v[184:187], v[88:91]
  ds_read_b128 v[168:171], v16 offset:20480
  v_mfma_f32_16x16x32_bf16 v[92:95], a[184:187], v[184:187], v[92:95]
  v_mfma_f32_16x16x32_bf16 v[96:99], a[188:191], v[184:187], v[96:99]
  s_waitcnt lgkmcnt(3)
  v_mfma_f32_16x16x32_bf16 v[100:103], a[180:183], v[188:191], v[100:103]
  ds_read_b128 v[172:175], v16 offset:22528
  v_mfma_f32_16x16x32_bf16 v[104:107], a[184:187], v[188:191], v[104:107]
  v_mfma_f32_16x16x32_bf16 v[108:111], a[188:191], v[188:191], v[108:111]
  s_waitcnt lgkmcnt(3)
  v_mfma_f32_16x16x32_bf16 v[64:67], a[192:195], v[160:163], v[64:67]
  ds_read_b128 v[176:179], v17 offset:16384
  v_mfma_f32_16x16x32_bf16 v[68:71], a[196:199], v[160:163], v[68:71]
  s_add_u32 m0, s31, 147456
  v_mfma_f32_16x16x32_bf16 v[72:75], a[200:203], v[160:163], v[72:75]
  s_waitcnt lgkmcnt(3)
  buffer_load_dwordx4 v10, s[8:11], s30 offen lds
  v_mfma_f32_16x16x32_bf16 v[76:79], a[192:195], v[164:167], v[76:79]
  ds_read_b128 v[180:183], v17 offset:18432
  v_mfma_f32_16x16x32_bf16 v[80:83], a[196:199], v[164:167], v[80:83]
  v_mfma_f32_16x16x32_bf16 v[84:87], a[200:203], v[164:167], v[84:87]
  s_waitcnt lgkmcnt(3)
  v_mfma_f32_16x16x32_bf16 v[88:91], a[192:195], v[168:171], v[88:91]
  ds_read_b128 v[184:187], v17 offset:20480
  v_mfma_f32_16x16x32_bf16 v[92:95], a[196:199], v[168:171], v[92:95]
  s_add_u32 m0, s31, 148480
  v_mfma_f32_16x16x32_bf16 v[96:99], a[200:203], v[168:171], v[96:99]
  s_waitcnt lgkmcnt(3)
  buffer_load_dwordx4 v11, s[8:11], s30 offen lds
  v_mfma_f32_16x16x32_bf16 v[100:103], a[192:195], v[172:175], v[100:103]
  s_add_u32 s30, s30, 128
  ds_read_b128 v[188:191], v17 offset:22528
  v_mfma_f32_16x16x32_bf16 v[104:107], a[196:199], v[172:175], v[104:107]
  v_mfma_f32_16x16x32_bf16 v[108:111], a[200:203], v[172:175], v[108:111]
  s_waitcnt lgkmcnt(3)
  v_mfma_f32_16x16x32_bf16 v[64:67], a[204:207], v[176:179], v[64:67]
  s_waitcnt vmcnt(15)
  s_barrier
  ds_read_b128 v[160:163], v16 offset:24576
  v_mfma_f32_16x16x32_bf16 v[68:71], a[208:211], v[176:179], v[68:71]
  v_mfma_f32_16x16x32_bf16 v[72:75], a[212:215], v[176:179], v[72:75]
  s_waitcnt lgkmcnt(3)
  v_mfma_f32_16x16x32_bf16 v[76:79], a[204:207], v[180:183], v[76:79]
  ds_read_b128 v[164:167], v16 offset:26624
  v_mfma_f32_16x16x32_bf16 v[80:83], a[208:211], v[180:183], v[80:83]
  v_mfma_f32_16x16x32_bf16 v[84:87], a[212:215], v[180:183], v[84:87]
  s_waitcnt lgkmcnt(3)
  v_mfma_f32_16x16x32_bf16 v[88:91], a[204:207], v[184:187], v[88:91]
  ds_read_b128 v[168:171], v16 offset:28672
  v_mfma_f32_16x16x32_bf16 v[92:95], a[208:211], v[184:187], v[92:95]
  v_mfma_f32_16x16x32_bf16 v[96:99], a[212:215], v[184:187], v[96:99]
  s_waitcnt lgkmcnt(3)
  v_mfma_f32_16x16x32_bf16 v[100:103], a[204:207], v[188:191], v[100:103]
  ds_read_b128 v[172:175], v16 offset:30720
  v_mfma_f32_16x16x32_bf16 v[104:107], a[208:211], v[188:191], v[104:107]
  v_mfma_f32_16x16x32_bf16 v[108:111], a[212:215], v[188:191], v[108:111]
  s_waitcnt lgkmcnt(3)
  v_mfma_f32_16x16x32_bf16 v[64:67], a[216:219], v[160:163], v[64:67]
  ds_read_b128 v[176:179], v17 offset:24576
  v_mfma_f32_16x16x32_bf16 v[68:71], a[220:223], v[160:163], v[68:71]
  s_add_u32 m0, s31, 155648
  v_mfma_f32_16x16x32_bf16 v[72:75], a[224:227], v[160:163], v[72:75]
  s_waitcnt lgkmcnt(3)
  buffer_load_dwordx4 v10, s[8:11], s30 offen lds
  v_mfma_f32_16x16x32_bf16 v[76:79], a[216:219], v[164:167], v[76:79]
  ds_read_b128 v[180:183], v17 offset:26624
  v_mfma_f32_16x16x32_bf16 v[80:83], a[220:223], v[164:167], v[80:83]
  v_mfma_f32_16x16x32_bf16 v[84:87], a[224:227], v[164:167], v[84:87]
  s_waitcnt lgkmcnt(3)
  v_mfma_f32_16x16x32_bf16 v[88:91], a[216:219], v[168:171], v[88:91]
  ds_read_b128 v[184:187], v17 offset:28672
  v_mfma_f32_16x16x32_bf16 v[92:95], a[220:223], v[168:171], v[92:95]
  s_add_u32 m0, s31, 156672
  v_mfma_f32_16x16x32_bf16 v[96:99], a[224:227], v[168:171], v[96:99]
  s_waitcnt lgkmcnt(3)
  buffer_load_dwordx4 v11, s[8:11], s30 offen lds
  v_mfma_f32_16x16x32_bf16 v[100:103], a[216:219], v[172:175], v[100:103]
  s_add_u32 s30, s30, 128
  ds_read_b128 v[188:191], v17 offset:30720
  v_mfma_f32_16x16x32_bf16 v[104:107], a[220:223], v[172:175], v[104:107]
  v_mfma_f32_16x16x32_bf16 v[108:111], a[224:227], v[172:175], v[108:111]
  s_waitcnt lgkmcnt(3)
  v_mfma_f32_16x16x32_bf16 v[64:67], a[228:231], v[176:179], v[64:67]
  s_waitcnt vmcnt(15)
  s_barrier
  ds_read_b128 v[160:163], v16 offset:32768
  v_mfma_f32_16x16x32_bf16 v[68:71], a[232:235], v[176:179], v[68:71]
  v_mfma_f32_16x16x32_bf16 v[72:75], a[236:239], v[176:179], v[72:75]
  s_waitcnt lgkmcnt(3)
  v_mfma_f32_16x16x32_bf16 v[76:79], a[228:231], v[180:183], v[76:79]
  ds_read_b128 v[164:167], v16 offset:34816
  v_cvt_pk_bf16_f32 v192, v64, v65
  v_mfma_f32_16x16x32_bf16 v[80:83], a[232:235], v[180:183], v[80:83]
  v_cvt_pk_bf16_f32 v193, v66, v67
  v_cvt_pk_bf16_f32 v194, v68, v69
  v_mfma_f32_16x16x32_bf16 v[84:87], a[236:239], v[180:183], v[84:87]
  s_waitcnt lgkmcnt(3)
  v_cvt_pk_bf16_f32 v195, v70, v71
  v_cvt_pk_bf16_f32 v200, v72, v73
  v_mfma_f32_16x16x32_bf16 v[88:91], a[228:231], v[184:187], v[88:91]
  ds_read_b128 v[168:171], v16 offset:36864
  v_cvt_pk_bf16_f32 v201, v74, v75
  v_mfma_f32_16x16x32_bf16 v[92:95], a[232:235], v[184:187], v[92:95]
  v_cvt_pk_bf16_f32 v196, v76, v77
  v_cvt_pk_bf16_f32 v197, v78, v79
  v_mfma_f32_16x16x32_bf16 v[96:99], a[236:239], v[184:187], v[96:99]
  s_waitcnt lgkmcnt(3)
  v_cvt_pk_bf16_f32 v198, v80, v81
  v_cvt_pk_bf16_f32 v199, v82, v83
  v_mfma_f32_16x16x32_bf16 v[100:103], a[228:231], v[188:191], v[100:103]
  ds_read_b128 v[172:175], v16 offset:38912
  v_cvt_pk_bf16_f32 v202, v84, v85
  v_mfma_f32_16x16x32_bf16 v[104:107], a[232:235], v[188:191], v[104:107]
  s_sub_u32 s26, s26, 1
  s_cmp_gt_u32 s26, 0
  v_cvt_pk_bf16_f32 v203, v86, v87
  v_mfma_f32_16x16x32_bf16 v[108:111], a[236:239], v[188:191], v[108:111]
  s_waitcnt lgkmcnt(3)
  s_cbranch_scc1 kvm_240
  s_nop 7
  v_cvt_pk_bf16_f32 v204, v88, v89
  v_cvt_pk_bf16_f32 v205, v90, v91
  v_cvt_pk_bf16_f32 v206, v92, v93
  v_cvt_pk_bf16_f32 v207, v94, v95
  v_cvt_pk_bf16_f32 v212, v96, v97
  v_cvt_pk_bf16_f32 v213, v98, v99
  v_cvt_pk_bf16_f32 v208, v100, v101
  v_cvt_pk_bf16_f32 v209, v102, v103
  v_cvt_pk_bf16_f32 v210, v104, v105
  v_cvt_pk_bf16_f32 v211, v106, v107
  v_cvt_pk_bf16_f32 v214, v108, v109
  v_cvt_pk_bf16_f32 v215, v110, v111
  s_xor_b32 s29, s48, 0
  buffer_store_dwordx4 v[192:195], v26, s[16:19], s29 offen offset:0 sc1
  buffer_store_dwordx4 v[196:199], v26, s[16:19], s29 offen offset:1024 sc1
  buffer_store_dwordx4 v[200:203], v26, s[16:19], s29 offen offset:2048 sc1
  s_xor_b32 s29, s48, 2105344
  buffer_store_dwordx4 v[204:207], v26, s[16:19], s29 offen offset:0 sc1
  buffer_store_dwordx4 v[208:211], v26, s[16:19], s29 offen offset:1024 sc1
  buffer_store_dwordx4 v[212:215], v26, s[16:19], s29 offen offset:2048 sc1
  s_mov_b32 s30, 491520
  s_mov_b32 s25, 162688
  v_lshrrev_b32 v4, 3, v1
  v_and_b32 v5, 7, v1
  v_xor_b32 v5, v5, v4
  s_mul_i32 s21, s20, 32
  v_add_u32 v4, s21, v4
  v_mul_u32_u24 v4, 1280, v4
  v_lshl_add_u32 v10, v5, 4, v4
  s_mul_i32 s31, s20, 4096
  v_add_u32 v11, 10240, v10
  v_add_u32 v12, 20480, v10
  v_add_u32 v13, 30720, v10
  s_add_u32 m0, s31, 0
  s_nop 0
  buffer_load_dwordx4 v10, s[8:11], s30 offen lds
  s_add_u32 m0, s31, 1024
  s_nop 0
  buffer_load_dwordx4 v11, s[8:11], s30 offen lds
  s_add_u32 m0, s31, 2048
  s_nop 0
  buffer_load_dwordx4 v12, s[8:11], s30 offen lds
  s_add_u32 m0, s31, 3072
  s_nop 0
  buffer_load_dwordx4 v13, s[8:11], s30 offen lds
  s_add_u32 s30, s30, 128
  s_add_u32 m0, s31, 16384
  s_nop 0
  buffer_load_dwordx4 v10, s[8:11], s30 offen lds
  s_add_u32 m0, s31, 17408
  s_nop 0
  buffer_load_dwordx4 v11, s[8:11], s30 offen lds
  s_add_u32 m0, s31, 18432
  s_nop 0
  buffer_load_dwordx4 v12, s[8:11], s30 offen lds
  s_add_u32 m0, s31, 19456
  s_nop 0
  buffer_load_dwordx4 v13, s[8:11], s30 offen lds
  s_add_u32 s30, s30, 128
  s_add_u32 m0, s31, 32768
  s_nop 0
  buffer_load_dwordx4 v10, s[8:11], s30 offen lds
  s_add_u32 m0, s31, 33792
  s_nop 0
  buffer_load_dwordx4 v11, s[8:11], s30 offen lds
  s_add_u32 m0, s31, 34816
  s_nop 0
  buffer_load_dwordx4 v12, s[8:11], s30 offen lds
  s_add_u32 m0, s31, 35840
  s_nop 0
  buffer_load_dwordx4 v13, s[8:11], s30 offen lds
  s_add_u32 s30, s30, 128
  s_add_u32 m0, s31, 49152
  s_nop 0
  buffer_load_dwordx4 v10, s[8:11], s30 offen lds
  s_add_u32 m0, s31, 50176
  s_nop 0
  buffer_load_dwordx4 v11, s[8:11], s30 offen lds
  s_add_u32 m0, s31, 51200
  s_nop 0
  buffer_load_dwordx4 v12, s[8:11], s30 offen lds
  s_add_u32 m0, s31, 52224
  s_nop 0
  buffer_load_dwordx4 v13, s[8:11], s30 offen lds
  s_add_u32 s30, s30, 128
  s_add_u32 m0, s31, 65536
  s_nop 0
  buffer_load_dwordx4 v10, s[8:11], s30 offen lds
  s_add_u32 m0, s31, 66560
  s_nop 0
  buffer_load_dwordx4 v11, s[8:11], s30 offen lds
  s_add_u32 m0, s31, 67584
  s_nop 0
  buffer_load_dwordx4 v12, s[8:11], s30 offen lds
  s_add_u32 m0, s31, 68608
  s_nop 0
  buffer_load_dwordx4 v13, s[8:11], s30 offen lds
  s_add_u32 s30, s30, 128
  s_waitcnt vmcnt(20) lgkmcnt(0)
  s_barrier
  buffer_atomic_add v28, v27, s[72:75], s61 offen sc1
  s_add_u32 m0, s31, 81920
  s_nop 0
  buffer_load_dwordx4 v10, s[8:11], s30 offen lds
  s_add_u32 m0, s31, 82944
  s_nop 0
  buffer_load_dwordx4 v11, s[8:11], s30 offen lds
  s_add_u32 m0, s31, 83968
  s_nop 0
  buffer_load_dwordx4 v12, s[8:11], s30 offen lds
  s_add_u32 m0, s31, 84992
  s_nop 0
  buffer_load_dwordx4 v13, s[8:11], s30 offen lds
  s_add_u32 s30, s30, 128
  s_mov_b32 s26, 13
  s_mov_b32 s48, 0x40000000
  s_mov_b32 s61, 0x40000000
  s_waitcnt vmcnt(16)
  s_barrier
  ds_read_b128 v[160:163], v14 offset:0
  ds_read_b128 v[164:167], v14 offset:2048
  ds_read_b128 v[168:171], v14 offset:4096
  ds_read_b128 v[172:175], v14 offset:6144
  s_waitcnt lgkmcnt(3)
  .p2align 3
kvs_241:
  v_mfma_f32_16x16x32_bf16 v[64:67], a[0:3], v[160:163], 0
  s_xor_b32 s29, s48, 0
  ds_read_b128 v[176:179], v14 offset:8192
  v_cvt_pk_bf16_f32 v221, v126, v127
  v_mfma_f32_16x16x32_bf16 v[68:71], a[4:7], v[160:163], 0
  v_cvt_pk_bf16_f32 v222, v128, v129
  v_cvt_pk_bf16_f32 v223, v130, v131
  v_mfma_f32_16x16x32_bf16 v[72:75], a[8:11], v[160:163], 0
  s_waitcnt lgkmcnt(3)
  v_cvt_pk_bf16_f32 v226, v132, v133
  v_cvt_pk_bf16_f32 v227, v134, v135
  v_mfma_f32_16x16x32_bf16 v[76:79], a[0:3], v[164:167], 0
  ds_read_b128 v[180:183], v14 offset:10240
  v_cvt_pk_bf16_f32 v228, v136, v137
  v_mfma_f32_16x16x32_bf16 v[80:83], a[4:7], v[164:167], 0
  v_cvt_pk_bf16_f32 v229, v138, v139
  v_cvt_pk_bf16_f32 v230, v140, v141
  v_mfma_f32_16x16x32_bf16 v[84:87], a[8:11], v[164:167], 0
  s_waitcnt lgkmcnt(3)
  v_cvt_pk_bf16_f32 v231, v142, v143
  v_cvt_pk_bf16_f32 v236, v144, v145
  v_mfma_f32_16x16x32_bf16 v[88:91], a[0:3], v[168:171], 0
  ds_read_b128 v[184:187], v14 offset:12288
  v_cvt_pk_bf16_f32 v237, v146, v147
  v_mfma_f32_16x16x32_bf16 v[92:95], a[4:7], v[168:171], 0
  v_cvt_pk_bf16_f32 v232, v148, v149
  v_cvt_pk_bf16_f32 v233, v150, v151
  v_mfma_f32_16x16x32_bf16 v[96:99], a[8:11], v[168:171], 0
  s_waitcnt lgkmcnt(3)
  v_cvt_pk_bf16_f32 v234, v152, v153
  v_cvt_pk_bf16_f32 v235, v154, v155
  v_mfma_f32_16x16x32_bf16 v[100:103], a[0:3], v[172:175], 0
  ds_read_b128 v[188:191], v14 offset:14336
  v_cvt_pk_bf16_f32 v238, v156, v157
  v_mfma_f32_16x16x32_bf16 v[104:107], a[4:7], v[172:175], 0
  v_cvt_pk_bf16_f32 v239, v158, v159
  v_mfma_f32_16x16x32_bf16 v[108:111], a[8:11], v[172:175], 0
  s_waitcnt lgkmcnt(3)
  v_mfma_f32_16x16x32_bf16 v[112:115], a[0:3], v[176:179], 0
  ds_read_b128 v[160:163], v15 offset:0
  v_mfma_f32_16x16x32_bf16 v[116:119], a[4:7], v[176:179], 0
  s_add_u32 m0, s31, 98304
  v_mfma_f32_16x16x32_bf16 v[120:123], a[8:11], v[176:179], 0
  s_waitcnt lgkmcnt(3)
  buffer_load_dwordx4 v10, s[8:11], s30 offen lds
  v_mfma_f32_16x16x32_bf16 v[124:127], a[0:3], v[180:183], 0
  ds_read_b128 v[164:167], v15 offset:2048
  v_mfma_f32_16x16x32_bf16 v[128:131], a[4:7], v[180:183], 0
  v_mfma_f32_16x16x32_bf16 v[132:135], a[8:11], v[180:183], 0
  s_waitcnt lgkmcnt(3)
  v_mfma_f32_16x16x32_bf16 v[136:139], a[0:3], v[184:187], 0
  ds_read_b128 v[168:171], v15 offset:4096
  v_mfma_f32_16x16x32_bf16 v[140:143], a[4:7], v[184:187], 0
  s_add_u32 m0, s31, 99328
  v_mfma_f32_16x16x32_bf16 v[144:147], a[8:11], v[184:187], 0
  s_waitcnt lgkmcnt(3)
  buffer_load_dwordx4 v11, s[8:11], s30 offen lds
  v_mfma_f32_16x16x32_bf16 v[148:151], a[0:3], v[188:191], 0
  ds_read_b128 v[172:175], v15 offset:6144
  v_mfma_f32_16x16x32_bf16 v[152:155], a[4:7], v[188:191], 0
  v_mfma_f32_16x16x32_bf16 v[156:159], a[8:11], v[188:191], 0
  s_waitcnt lgkmcnt(3)
  v_mfma_f32_16x16x32_bf16 v[64:67], a[12:15], v[160:163], v[64:67]
  ds_read_b128 v[176:179], v15 offset:8192
  v_mfma_f32_16x16x32_bf16 v[68:71], a[16:19], v[160:163], v[68:71]
  s_add_u32 m0, s31, 100352
  v_mfma_f32_16x16x32_bf16 v[72:75], a[20:23], v[160:163], v[72:75]
  s_waitcnt lgkmcnt(3)
  buffer_load_dwordx4 v12, s[8:11], s30 offen lds
  v_mfma_f32_16x16x32_bf16 v[76:79], a[12:15], v[164:167], v[76:79]
  ds_read_b128 v[180:183], v15 offset:10240
  v_mfma_f32_16x16x32_bf16 v[80:83], a[16:19], v[164:167], v[80:83]
  v_mfma_f32_16x16x32_bf16 v[84:87], a[20:23], v[164:167], v[84:87]
  s_waitcnt lgkmcnt(3)
  v_mfma_f32_16x16x32_bf16 v[88:91], a[12:15], v[168:171], v[88:91]
  ds_read_b128 v[184:187], v15 offset:12288
  v_mfma_f32_16x16x32_bf16 v[92:95], a[16:19], v[168:171], v[92:95]
  s_add_u32 m0, s31, 101376
  v_mfma_f32_16x16x32_bf16 v[96:99], a[20:23], v[168:171], v[96:99]
  s_waitcnt lgkmcnt(3)
  buffer_load_dwordx4 v13, s[8:11], s30 offen lds
  v_mfma_f32_16x16x32_bf16 v[100:103], a[12:15], v[172:175], v[100:103]
  s_add_u32 s30, s30, 128
  ds_read_b128 v[188:191], v15 offset:14336
  v_mfma_f32_16x16x32_bf16 v[104:107], a[16:19], v[172:175], v[104:107]
  v_mfma_f32_16x16x32_bf16 v[108:111], a[20:23], v[172:175], v[108:111]
  s_waitcnt lgkmcnt(3)
  v_mfma_f32_16x16x32_bf16 v[112:115], a[12:15], v[176:179], v[112:115]
  ds_read_b128 v[160:163], v14 offset:16384
  v_mfma_f32_16x16x32_bf16 v[116:119], a[16:19], v[176:179], v[116:119]
  buffer_store_dwordx4 v[192:195], v26, s[16:19], s29 offen offset:0 sc1
  v_mfma_f32_16x16x32_bf16 v[120:123], a[20:23], v[176:179], v[120:123]
  s_waitcnt lgkmcnt(3)
  v_mfma_f32_16x16x32_bf16 v[124:127], a[12:15], v[180:183], v[124:127]
  ds_read_b128 v[164:167], v14 offset:18432
  v_mfma_f32_16x16x32_bf16 v[128:131], a[16:19], v[180:183], v[128:131]
  v_mfma_f32_16x16x32_bf16 v[132:135], a[20:23], v[180:183], v[132:135]
  s_waitcnt lgkmcnt(3)
  v_mfma_f32_16x16x32_bf16 v[136:139], a[12:15], v[184:187], v[136:139]
  ds_read_b128 v[168:171], v14 offset:20480
  buffer_store_dwordx4 v[196:199], v26, s[16:19], s29 offen offset:1024 sc1
  v_mfma_f32_16x16x32_bf16 v[140:143], a[16:19], v[184:187], v[140:143]
  v_mfma_f32_16x16x32_bf16 v[144:147], a[20:23], v[184:187], v[144:147]
  s_waitcnt lgkmcnt(3)
  v_mfma_f32_16x16x32_bf16 v[148:151], a[12:15], v[188:191], v[148:151]
  ds_read_b128 v[172:175], v14 offset:22528
  v_mfma_f32_16x16x32_bf16 v[152:155], a[16:19], v[188:191], v[152:155]
  v_mfma_f32_16x16x32_bf16 v[156:159], a[20:23], v[188:191], v[156:159]
  s_waitcnt lgkmcnt(3)
  v_mfma_f32_16x16x32_bf16 v[64:67], a[24:27], v[160:163], v[64:67]
  ds_read_b128 v[176:179], v14 offset:24576
  v_mfma_f32_16x16x32_bf16 v[68:71], a[28:31], v[160:163], v[68:71]
  s_add_u32 m0, s31, 114688
  v_mfma_f32_16x16x32_bf16 v[72:75], a[32:35], v[160:163], v[72:75]
  s_waitcnt lgkmcnt(3)
  buffer_load_dwordx4 v10, s[8:11], s30 offen lds
  v_mfma_f32_16x16x32_bf16 v[76:79], a[24:27], v[164:167], v[76:79]
  ds_read_b128 v[180:183], v14 offset:26624
  v_mfma_f32_16x16x32_bf16 v[80:83], a[28:31], v[164:167], v[80:83]
  v_mfma_f32_16x16x32_bf16 v[84:87], a[32:35], v[164:167], v[84:87]
  s_waitcnt lgkmcnt(3)
  v_mfma_f32_16x16x32_bf16 v[88:91], a[24:27], v[168:171], v[88:91]
  ds_read_b128 v[184:187], v14 offset:28672
  v_mfma_f32_16x16x32_bf16 v[92:95], a[28:31], v[168:171], v[92:95]
  buffer_store_dwordx4 v[200:203], v26, s[16:19], s29 offen offset:2048 sc1
  v_mfma_f32_16x16x32_bf16 v[96:99], a[32:35], v[168:171], v[96:99]
  s_waitcnt lgkmcnt(3)
  v_mfma_f32_16x16x32_bf16 v[100:103], a[24:27], v[172:175], v[100:103]
  ds_read_b128 v[188:191], v14 offset:30720
  v_mfma_f32_16x16x32_bf16 v[104:107], a[28:31], v[172:175], v[104:107]
  v_mfma_f32_16x16x32_bf16 v[108:111], a[32:35], v[172:175], v[108:111]
  s_xor_b32 s29, s48, 2105344
  s_waitcnt lgkmcnt(3)
  v_mfma_f32_16x16x32_bf16 v[112:115], a[24:27], v[176:179], v[112:115]
  ds_read_b128 v[160:163], v15 offset:16384
  v_mfma_f32_16x16x32_bf16 v[116:119], a[28:31], v[176:179], v[116:119]
  s_add_u32 m0, s31, 115712
  v_mfma_f32_16x16x32_bf16 v[120:123], a[32:35], v[176:179], v[120:123]
  s_waitcnt lgkmcnt(3)
  buffer_load_dwordx4 v11, s[8:11], s30 offen lds
  v_mfma_f32_16x16x32_bf16 v[124:127], a[24:27], v[180:183], v[124:127]
  ds_read_b128 v[164:167], v15 offset:18432
  v_mfma_f32_16x16x32_bf16 v[128:131], a[28:31], v[180:183], v[128:131]
  v_mfma_f32_16x16x32_bf16 v[132:135], a[32:35], v[180:183], v[132:135]
  s_waitcnt lgkmcnt(3)
  v_mfma_f32_16x16x32_bf16 v[136:139], a[24:27], v[184:187], v[136:139]
  ds_read_b128 v[168:171], v15 offset:20480
  v_mfma_f32_16x16x32_bf16 v[140:143], a[28:31], v[184:187], v[140:143]
  buffer_store_dwordx4 v[204:207], v26, s[16:19], s29 offen offset:0 sc1
  v_mfma_f32_16x16x32_bf16 v[144:147], a[32:35], v[184:187], v[144:147]
  s_waitcnt lgkmcnt(3)
  v_mfma_f32_16x16x32_bf16 v[148:151], a[24:27], v[188:191], v[148:151]
  ds_read_b128 v[172:175], v15 offset:22528
  v_mfma_f32_16x16x32_bf16 v[152:155], a[28:31], v[188:191], v[152:155]
  v_mfma_f32_16x16x32_bf16 v[156:159], a[32:35], v[188:191], v[156:159]
  s_waitcnt lgkmcnt(3)
  v_mfma_f32_16x16x32_bf16 v[64:67], a[36:39], v[160:163], v[64:67]
  ds_read_b128 v[176:179], v15 offset:24576
  v_mfma_f32_16x16x32_bf16 v[68:71], a[40:43], v[160:163], v[68:71]
  s_add_u32 m0, s31, 116736
  v_mfma_f32_16x16x32_bf16 v[72:75], a[44:47], v[160:163], v[72:75]
  s_waitcnt lgkmcnt(3)
  buffer_load_dwordx4 v12, s[8:11], s30 offen lds
  v_mfma_f32_16x16x32_bf16 v[76:79], a[36:39], v[164:167], v[76:79]
  ds_read_b128 v[180:183], v15 offset:26624
  v_mfma_f32_16x16x32_bf16 v[80:83], a[40:43], v[164:167], v[80:83]
  v_mfma_f32_16x16x32_bf16 v[84:87], a[44:47], v[164:167], v[84:87]
  s_waitcnt lgkmcnt(3)
  v_mfma_f32_16x16x32_bf16 v[88:91], a[36:39], v[168:171], v[88:91]
  ds_read_b128 v[184:187], v15 offset:28672
  v_mfma_f32_16x16x32_bf16 v[92:95], a[40:43], v[168:171], v[92:95]
  buffer_store_dwordx4 v[208:211], v26, s[16:19], s29 offen offset:1024 sc1
  v_mfma_f32_16x16x32_bf16 v[96:99], a[44:47], v[168:171], v[96:99]
  s_waitcnt lgkmcnt(3)
  v_mfma_f32_16x16x32_bf16 v[100:103], a[36:39], v[172:175], v[100:103]
  ds_read_b128 v[188:191], v15 offset:30720
  v_mfma_f32_16x16x32_bf16 v[104:107], a[40:43], v[172:175], v[104:107]
  v_mfma_f32_16x16x32_bf16 v[108:111], a[44:47], v[172:175], v[108:111]
  s_waitcnt lgkmcnt(3)
  v_mfma_f32_16x16x32_bf16 v[112:115], a[36:39], v[176:179], v[112:115]
  s_waitcnt vmcnt(20)
  s_barrier
  ds_read_b128 v[160:163], v14 offset:32768
  v_mfma_f32_16x16x32_bf16 v[116:119], a[40:43], v[176:179], v[116:119]
  s_add_u32 m0, s31, 117760
  v_mfma_f32_16x16x32_bf16 v[120:123], a[44:47], v[176:179], v[120:123]
  s_waitcnt lgkmcnt(3)
  buffer_load_dwordx4 v13, s[8:11], s30 offen lds
  v_mfma_f32_16x16x32_bf16 v[124:127], a[36:39], v[180:183], v[124:127]
  s_add_u32 s30, s30, 128
  ds_read_b128 v[164:167], v14 offset:34816
  v_mfma_f32_16x16x32_bf16 v[128:131], a[40:43], v[180:183], v[128:131]
  v_mfma_f32_16x16x32_bf16 v[132:135], a[44:47], v[180:183], v[132:135]
  s_waitcnt lgkmcnt(3)
  v_mfma_f32_16x16x32_bf16 v[136:139], a[36:39], v[184:187], v[136:139]
  ds_read_b128 v[168:171], v14 offset:36864
  v_mfma_f32_16x16x32_bf16 v[140:143], a[40:43], v[184:187], v[140:143]
  buffer_store_dwordx4 v[212:215], v26, s[16:19], s29 offen offset:2048 sc1
  v_mfma_f32_16x16x32_bf16 v[144:147], a[44:47], v[184:187], v[144:147]
  s_waitcnt lgkmcnt(3)
  v_mfma_f32_16x16x32_bf16 v[148:151], a[36:39], v[188:191], v[148:151]
  ds_read_b128 v[172:175], v14 offset:38912
  v_mfma_f32_16x16x32_bf16 v[152:155], a[40:43], v[188:191], v[152:155]
  v_mfma_f32_16x16x32_bf16 v[156:159], a[44:47], v[188:191], v[156:159]
  s_xor_b32 s29, s48, 4194304
  s_waitcnt lgkmcnt(3)
  v_mfma_f32_16x16x32_bf16 v[64:67], a[48:51], v[160:163], v[64:67]
  ds_read_b128 v[176:179], v14 offset:40960
  v_mfma_f32_16x16x32_bf16 v[68:71], a[52:55], v[160:163], v[68:71]
  s_add_u32 m0, s31, 131072
  v_mfma_f32_16x16x32_bf16 v[72:75], a[56:59], v[160:163], v[72:75]
  s_waitcnt lgkmcnt(3)
  buffer_load_dwordx4 v10, s[8:11], s30 offen lds
  v_mfma_f32_16x16x32_bf16 v[76:79], a[48:51], v[164:167], v[76:79]
  ds_read_b128 v[180:183], v14 offset:43008
  v_mfma_f32_16x16x32_bf16 v[80:83], a[52:55], v[164:167], v[80:83]
  v_mfma_f32_16x16x32_bf16 v[84:87], a[56:59], v[164:167], v[84:87]
  s_waitcnt lgkmcnt(3)
  v_mfma_f32_16x16x32_bf16 v[88:91], a[48:51], v[168:171], v[88:91]
  ds_read_b128 v[184:187], v14 offset:45056
  v_mfma_f32_16x16x32_bf16 v[92:95], a[52:55], v[168:171], v[92:95]
  buffer_store_dwordx4 v[216:219], v26, s[16:19], s29 offen offset:0 sc1
  v_mfma_f32_16x16x32_bf16 v[96:99], a[56:59], v[168:171], v[96:99]
  s_waitcnt lgkmcnt(3)
  v_mfma_f32_16x16x32_bf16 v[100:103], a[48:51], v[172:175], v[100:103]
  ds_read_b128 v[188:191], v14 offset:47104
  v_mfma_f32_16x16x32_bf16 v[104:107], a[52:55], v[172:175], v[104:107]
  v_mfma_f32_16x16x32_bf16 v[108:111], a[56:59], v[172:175], v[108:111]
  s_waitcnt lgkmcnt(3)
  v_mfma_f32_16x16x32_bf16 v[112:115], a[48:51], v[176:179], v[112:115]
  ds_read_b128 v[160:163], v15 offset:32768
  v_mfma_f32_16x16x32_bf16 v[116:119], a[52:55], v[176:179], v[116:119]
  s_add_u32 m0, s31, 132096
  v_mfma_f32_16x16x32_bf16 v[120:123], a[56:59], v[176:179], v[120:123]
  s_waitcnt lgkmcnt(3)
  buffer_load_dwordx4 v11, s[8:11], s30 offen lds
  v_mfma_f32_16x16x32_bf16 v[124:127], a[48:51], v[180:183], v[124:127]
  ds_read_b128 v[164:167], v15 offset:34816
  v_mfma_f32_16x16x32_bf16 v[128:131], a[52:55], v[180:183], v[128:131]
  v_mfma_f32_16x16x32_bf16 v[132:135], a[56:59], v[180:183], v[132:135]
  s_waitcnt lgkmcnt(3)
  v_mfma_f32_16x16x32_bf16 v[136:139], a[48:51], v[184:187], v[136:139]
  ds_read_b128 v[168:171], v15 offset:36864
  v_mfma_f32_16x16x32_bf16 v[140:143], a[52:55], v[184:187], v[140:143]
  buffer_store_dwordx4 v[220:223], v26, s[16:19], s29 offen offset:1024 sc1
  v_mfma_f32_16x16x32_bf16 v[144:147], a[56:59], v[184:187], v[144:147]
  s_waitcnt lgkmcnt(3)
  v_mfma_f32_16x16x32_bf16 v[148:151], a[48:51], v[188:191], v[148:151]
  ds_read_b128 v[172:175], v15 offset:38912
  v_mfma_f32_16x16x32_bf16 v[152:155], a[52:55], v[188:191], v[152:155]
  v_mfma_f32_16x16x32_bf16 v[156:159], a[56:59], v[188:191], v[156:159]
  s_waitcnt lgkmcnt(3)
  v_mfma_f32_16x16x32_bf16 v[64:67], a[60:63], v[160:163], v[64:67]
  ds_read_b128 v[176:179], v15 offset:40960
  v_mfma_f32_16x16x32_bf16 v[68:71], a[64:67], v[160:163], v[68:71]
  s_add_u32 m0, s31, 133120
  v_mfma_f32_16x16x32_bf16 v[72:75], a[68:71], v[160:163], v[72:75]
  s_waitcnt lgkmcnt(3)
  buffer_load_dwordx4 v12, s[8:11], s30 offen lds
  v_mfma_f32_16x16x32_bf16 v[76:79], a[60:63], v[164:167], v[76:79]
  ds_read_b128 v[180:183], v15 offset:43008
  v_mfma_f32_16x16x32_bf16 v[80:83], a[64:67], v[164:167], v[80:83]
  v_mfma_f32_16x16x32_bf16 v[84:87], a[68:71], v[164:167], v[84:87]
  s_waitcnt lgkmcnt(3)
  v_mfma_f32_16x16x32_bf16 v[88:91], a[60:63], v[168:171], v[88:91]
  ds_read_b128 v[184:187], v15 offset:45056
  v_mfma_f32_16x16x32_bf16 v[92:95], a[64:67], v[168:171], v[92:95]
  buffer_store_dwordx4 v[224:227], v26, s[16:19], s29 offen offset:2048 sc1
  v_mfma_f32_16x16x32_bf16 v[96:99], a[68:71], v[168:171], v[96:99]
  s_waitcnt lgkmcnt(3)
  v_mfma_f32_16x16x32_bf16 v[100:103], a[60:63], v[172:175], v[100:103]
  ds_read_b128 v[188:191], v15 offset:47104
  v_mfma_f32_16x16x32_bf16 v[104:107], a[64:67], v[172:175], v[104:107]
  v_mfma_f32_16x16x32_bf16 v[108:111], a[68:71], v[172:175], v[108:111]
  s_xor_b32 s29, s48, 6299648
  s_waitcnt lgkmcnt(3)
  v_mfma_f32_16x16x32_bf16 v[112:115], a[60:63], v[176:179], v[112:115]
  ds_read_b128 v[160:163], v14 offset:49152
  v_mfma_f32_16x16x32_bf16 v[116:119], a[64:67], v[176:179], v[116:119]
  s_add_u32 m0, s31, 134144
  v_mfma_f32_16x16x32_bf16 v[120:123], a[68:71], v[176:179], v[120:123]
  s_waitcnt lgkmcnt(3)
  buffer_load_dwordx4 v13, s[8:11], s30 offen lds
  v_mfma_f32_16x16x32_bf16 v[124:127], a[60:63], v[180:183], v[124:127]
  s_add_u32 s30, s30, 128
  ds_read_b128 v[164:167], v14 offset:51200
  v_mfma_f32_16x16x32_bf16 v[128:131], a[64:67], v[180:183], v[128:131]
  v_mfma_f32_16x16x32_bf16 v[132:135], a[68:71], v[180:183], v[132:135]
  s_waitcnt lgkmcnt(3)
  v_mfma_f32_16x16x32_bf16 v[136:139], a[60:63], v[184:187], v[136:139]
  ds_read_b128 v[168:171], v14 offset:53248
  v_mfma_f32_16x16x32_bf16 v[140:143], a[64:67], v[184:187], v[140:143]
  buffer_store_dwordx4 v[228:231], v26, s[16:19], s29 offen offset:0 sc1
  v_mfma_f32_16x16x32_bf16 v[144:147], a[68:71], v[184:187], v[144:147]
  s_waitcnt lgkmcnt(3)
  v_mfma_f32_16x16x32_bf16 v[148:151], a[60:63], v[188:191], v[148:151]
  ds_read_b128 v[172:175], v14 offset:55296
  v_mfma_f32_16x16x32_bf16 v[152:155], a[64:67], v[188:191], v[152:155]
  v_mfma_f32_16x16x32_bf16 v[156:159], a[68:71], v[188:191], v[156:159]
  s_waitcnt lgkmcnt(3)
  v_mfma_f32_16x16x32_bf16 v[64:67], a[72:75], v[160:163], v[64:67]
  ds_read_b128 v[176:179], v14 offset:57344
  v_mfma_f32_16x16x32_bf16 v[68:71], a[76:79], v[160:163], v[68:71]
  s_add_u32 m0, s31, 147456
  v_mfma_f32_16x16x32_bf16 v[72:75], a[80:83], v[160:163], v[72:75]
  s_waitcnt lgkmcnt(3)
  buffer_load_dwordx4 v10, s[8:11], s30 offen lds
  v_mfma_f32_16x16x32_bf16 v[76:79], a[72:75], v[164:167], v[76:79]
  ds_read_b128 v[180:183], v14 offset:59392
  v_mfma_f32_16x16x32_bf16 v[80:83], a[76:79], v[164:167], v[80:83]
  v_mfma_f32_16x16x32_bf16 v[84:87], a[80:83], v[164:167], v[84:87]
  s_waitcnt lgkmcnt(3)
  v_mfma_f32_16x16x32_bf16 v[88:91], a[72:75], v[168:171], v[88:91]
  ds_read_b128 v[184:187], v14 offset:61440
  v_mfma_f32_16x16x32_bf16 v[92:95], a[76:79], v[168:171], v[92:95]
  buffer_store_dwordx4 v[232:235], v26, s[16:19], s29 offen offset:1024 sc1
  v_mfma_f32_16x16x32_bf16 v[96:99], a[80:83], v[168:171], v[96:99]
  s_waitcnt lgkmcnt(3)
  v_mfma_f32_16x16x32_bf16 v[100:103], a[72:75], v[172:175], v[100:103]
  ds_read_b128 v[188:191], v14 offset:63488
  v_mfma_f32_16x16x32_bf16 v[104:107], a[76:79], v[172:175], v[104:107]
  v_mfma_f32_16x16x32_bf16 v[108:111], a[80:83], v[172:175], v[108:111]
  s_waitcnt lgkmcnt(3)
  v_mfma_f32_16x16x32_bf16 v[112:115], a[72:75], v[176:179], v[112:115]
  ds_read_b128 v[160:163], v15 offset:49152
  v_mfma_f32_16x16x32_bf16 v[116:119], a[76:79], v[176:179], v[116:119]
  s_add_u32 m0, s31, 148480
  v_mfma_f32_16x16x32_bf16 v[120:123], a[80:83], v[176:179], v[120:123]
  s_waitcnt lgkmcnt(3)
  buffer_load_dwordx4 v11, s[8:11], s30 offen lds
  v_mfma_f32_16x16x32_bf16 v[124:127], a[72:75], v[180:183], v[124:127]
  ds_read_b128 v[164:167], v15 offset:51200
  v_mfma_f32_16x16x32_bf16 v[128:131], a[76:79], v[180:183], v[128:131]
  v_mfma_f32_16x16x32_bf16 v[132:135], a[80:83], v[180:183], v[132:135]
  s_waitcnt lgkmcnt(3)
  v_mfma_f32_16x16x32_bf16 v[136:139], a[72:75], v[184:187], v[136:139]
  ds_read_b128 v[168:171], v15 offset:53248
  v_mfma_f32_16x16x32_bf16 v[140:143], a[76:79], v[184:187], v[140:143]
  buffer_store_dwordx4 v[236:239], v26, s[16:19], s29 offen offset:2048 sc1
  v_mfma_f32_16x16x32_bf16 v[144:147], a[80:83], v[184:187], v[144:147]
  s_waitcnt lgkmcnt(3)
  v_mfma_f32_16x16x32_bf16 v[148:151], a[72:75], v[188:191], v[148:151]
  ds_read_b128 v[172:175], v15 offset:55296
  v_mfma_f32_16x16x32_bf16 v[152:155], a[76:79], v[188:191], v[152:155]
  v_mfma_f32_16x16x32_bf16 v[156:159], a[80:83], v[188:191], v[156:159]
  s_waitcnt lgkmcnt(3)
  v_mfma_f32_16x16x32_bf16 v[64:67], a[84:87], v[160:163], v[64:67]
  ds_read_b128 v[176:179], v15 offset:57344
  v_mfma_f32_16x16x32_bf16 v[68:71], a[88:91], v[160:163], v[68:71]
  s_add_u32 m0, s31, 149504
  v_mfma_f32_16x16x32_bf16 v[72:75], a[92:95], v[160:163], v[72:75]
  s_waitcnt lgkmcnt(3)
  buffer_load_dwordx4 v12, s[8:11], s30 offen lds
  v_mfma_f32_16x16x32_bf16 v[76:79], a[84:87], v[164:167], v[76:79]
  ds_read_b128 v[180:183], v15 offset:59392
  v_mfma_f32_16x16x32_bf16 v[80:83], a[88:91], v[164:167], v[80:83]
  v_mfma_f32_16x16x32_bf16 v[84:87], a[92:95], v[164:167], v[84:87]
  s_waitcnt lgkmcnt(3)
  v_mfma_f32_16x16x32_bf16 v[88:91], a[84:87], v[168:171], v[88:91]
  ds_read_b128 v[184:187], v15 offset:61440
  v_mfma_f32_16x16x32_bf16 v[92:95], a[88:91], v[168:171], v[92:95]
  v_mfma_f32_16x16x32_bf16 v[96:99], a[92:95], v[168:171], v[96:99]
  s_waitcnt lgkmcnt(3)
  v_mfma_f32_16x16x32_bf16 v[100:103], a[84:87], v[172:175], v[100:103]
  ds_read_b128 v[188:191], v15 offset:63488
  v_mfma_f32_16x16x32_bf16 v[104:107], a[88:91], v[172:175], v[104:107]
  s_cmp_le_u32 s26, 9
  s_cselect_b32 s62, 0x40000000, s61
  s_cselect_b32 s61, s61, 0x40000000
  s_cbranch_scc1 kf_242
  s_waitcnt vmcnt(1)
kf_242:
  v_mfma_f32_16x16x32_bf16 v[108:111], a[92:95], v[172:175], v[108:111]
  s_waitcnt lgkmcnt(3)
  v_mfma_f32_16x16x32_bf16 v[112:115], a[84:87], v[176:179], v[112:115]
  s_waitcnt vmcnt(27)
  s_barrier
  ds_read_b128 v[160:163], v16 offset:0
  v_mfma_f32_16x16x32_bf16 v[116:119], a[88:91], v[176:179], v[116:119]
  s_add_u32 m0, s31, 150528
  v_mfma_f32_16x16x32_bf16 v[120:123], a[92:95], v[176:179], v[120:123]
  s_waitcnt lgkmcnt(3)
  buffer_load_dwordx4 v13, s[8:11], s30 offen lds
  v_mfma_f32_16x16x32_bf16 v[124:127], a[84:87], v[180:183], v[124:127]
  s_add_u32 s30, s30, s25
  ds_read_b128 v[164:167], v16 offset:2048
  v_mfma_f32_16x16x32_bf16 v[128:131], a[88:91], v[180:183], v[128:131]
  v_mfma_f32_16x16x32_bf16 v[132:135], a[92:95], v[180:183], v[132:135]
  s_waitcnt lgkmcnt(3)
  v_mfma_f32_16x16x32_bf16 v[136:139], a[84:87], v[184:187], v[136:139]
  ds_read_b128 v[168:171], v16 offset:4096
  v_mfma_f32_16x16x32_bf16 v[140:143], a[88:91], v[184:187], v[140:143]
  buffer_atomic_add v28, v27, s[72:75], s62 offen sc1
  v_mfma_f32_16x16x32_bf16 v[144:147], a[92:95], v[184:187], v[144:147]
  s_waitcnt lgkmcnt(3)
  v_mfma_f32_16x16x32_bf16 v[148:151], a[84:87], v[188:191], v[148:151]
  ds_read_b128 v[172:175], v16 offset:6144
  v_mfma_f32_16x16x32_bf16 v[152:155], a[88:91], v[188:191], v[152:155]
  v_mfma_f32_16x16x32_bf16 v[156:159], a[92:95], v[188:191], v[156:159]
  s_waitcnt lgkmcnt(3)
  v_mfma_f32_16x16x32_bf16 v[64:67], a[96:99], v[160:163], v[64:67]
  ds_read_b128 v[176:179], v16 offset:8192
  v_mfma_f32_16x16x32_bf16 v[68:71], a[100:103], v[160:163], v[68:71]
  s_add_u32 m0, s31, 0
  v_mfma_f32_16x16x32_bf16 v[72:75], a[104:107], v[160:163], v[72:75]
  s_waitcnt lgkmcnt(3)
  buffer_load_dwordx4 v10, s[8:11], s30 offen lds
  v_mfma_f32_16x16x32_bf16 v[76:79], a[96:99], v[164:167], v[76:79]
  ds_read_b128 v[180:183], v16 offset:10240
  v_mfma_f32_16x16x32_bf16 v[80:83], a[100:103], v[164:167], v[80:83]
  v_mfma_f32_16x16x32_bf16 v[84:87], a[104:107], v[164:167], v[84:87]
  s_waitcnt lgkmcnt(3)
  v_mfma_f32_16x16x32_bf16 v[88:91], a[96:99], v[168:171], v[88:91]
  ds_read_b128 v[184:187], v16 offset:12288
  v_mfma_f32_16x16x32_bf16 v[92:95], a[100:103], v[168:171], v[92:95]
  v_mfma_f32_16x16x32_bf16 v[96:99], a[104:107], v[168:171], v[96:99]
  s_waitcnt lgkmcnt(3)
  v_mfma_f32_16x16x32_bf16 v[100:103], a[96:99], v[172:175], v[100:103]
  ds_read_b128 v[188:191], v16 offset:14336
  v_mfma_f32_16x16x32_bf16 v[104:107], a[100:103], v[172:175], v[104:107]
  v_mfma_f32_16x16x32_bf16 v[108:111], a[104:107], v[172:175], v[108:111]
  s_waitcnt lgkmcnt(3)
  v_mfma_f32_16x16x32_bf16 v[112:115], a[96:99], v[176:179], v[112:115]
  ds_read_b128 v[160:163], v17 offset:0
  v_mfma_f32_16x16x32_bf16 v[116:119], a[100:103], v[176:179], v[116:119]
  s_add_u32 m0, s31, 1024
  v_mfma_f32_16x16x32_bf16 v[120:123], a[104:107], v[176:179], v[120:123]
  s_waitcnt lgkmcnt(3)
  buffer_load_dwordx4 v11, s[8:11], s30 offen lds
  v_mfma_f32_16x16x32_bf16 v[124:127], a[96:99], v[180:183], v[124:127]
  ds_read_b128 v[164:167], v17 offset:2048
  v_mfma_f32_16x16x32_bf16 v[128:131], a[100:103], v[180:183], v[128:131]
  v_mfma_f32_16x16x32_bf16 v[132:135], a[104:107], v[180:183], v[132:135]
  s_waitcnt lgkmcnt(3)
  v_mfma_f32_16x16x32_bf16 v[136:139], a[96:99], v[184:187], v[136:139]
  ds_read_b128 v[168:171], v17 offset:4096
  v_mfma_f32_16x16x32_bf16 v[140:143], a[100:103], v[184:187], v[140:143]
  v_mfma_f32_16x16x32_bf16 v[144:147], a[104:107], v[184:187], v[144:147]
  s_waitcnt lgkmcnt(3)
  v_mfma_f32_16x16x32_bf16 v[148:151], a[96:99], v[188:191], v[148:151]
  ds_read_b128 v[172:175], v17 offset:6144
  v_mfma_f32_16x16x32_bf16 v[152:155], a[100:103], v[188:191], v[152:155]
  v_mfma_f32_16x16x32_bf16 v[156:159], a[104:107], v[188:191], v[156:159]
  s_waitcnt lgkmcnt(3)
  v_mfma_f32_16x16x32_bf16 v[64:67], a[108:111], v[160:163], v[64:67]
  ds_read_b128 v[176:179], v17 offset:8192
  v_mfma_f32_16x16x32_bf16 v[68:71], a[112:115], v[160:163], v[68:71]
  s_add_u32 m0, s31, 2048
  v_mfma_f32_16x16x32_bf16 v[72:75], a[116:119], v[160:163], v[72:75]
  s_waitcnt lgkmcnt(3)
  buffer_load_dwordx4 v12, s[8:11], s30 offen lds
  v_mfma_f32_16x16x32_bf16 v[76:79], a[108:111], v[164:167], v[76:79]
  ds_read_b128 v[180:183], v17 offset:10240
  v_mfma_f32_16x16x32_bf16 v[80:83], a[112:115], v[164:167], v[80:83]
  v_mfma_f32_16x16x32_bf16 v[84:87], a[116:119], v[164:167], v[84:87]
  s_waitcnt lgkmcnt(3)
  v_mfma_f32_16x16x32_bf16 v[88:91], a[108:111], v[168:171], v[88:91]
  ds_read_b128 v[184:187], v17 offset:12288
  v_mfma_f32_16x16x32_bf16 v[92:95], a[112:115], v[168:171], v[92:95]
  v_mfma_f32_16x16x32_bf16 v[96:99], a[116:119], v[168:171], v[96:99]
  s_waitcnt lgkmcnt(3)
  v_mfma_f32_16x16x32_bf16 v[100:103], a[108:111], v[172:175], v[100:103]
  ds_read_b128 v[188:191], v17 offset:14336
  v_mfma_f32_16x16x32_bf16 v[104:107], a[112:115], v[172:175], v[104:107]
  v_mfma_f32_16x16x32_bf16 v[108:111], a[116:119], v[172:175], v[108:111]
  s_waitcnt lgkmcnt(3)
  v_mfma_f32_16x16x32_bf16 v[112:115], a[108:111], v[176:179], v[112:115]
  ds_read_b128 v[160:163], v16 offset:16384
  v_mfma_f32_16x16x32_bf16 v[116:119], a[112:115], v[176:179], v[116:119]
  s_add_u32 m0, s31, 3072
  v_mfma_f32_16x16x32_bf16 v[120:123], a[116:119], v[176:179], v[120:123]
  s_waitcnt lgkmcnt(3)
  buffer_load_dwordx4 v13, s[8:11], s30 offen lds
  v_mfma_f32_16x16x32_bf16 v[124:127], a[108:111], v[180:183], v[124:127]
  s_add_u32 s30, s30, 128
  ds_read_b128 v[164:167], v16 offset:18432
  v_mfma_f32_16x16x32_bf16 v[128:131], a[112:115], v[180:183], v[128:131]
  v_mfma_f32_16x16x32_bf16 v[132:135], a[116:119], v[180:183], v[132:135]
  s_waitcnt lgkmcnt(3)
  v_mfma_f32_16x16x32_bf16 v[136:139], a[108:111], v[184:187], v[136:139]
  ds_read_b128 v[168:171], v16 offset:20480
  v_mfma_f32_16x16x32_bf16 v[140:143], a[112:115], v[184:187], v[140:143]
  v_mfma_f32_16x16x32_bf16 v[144:147], a[116:119], v[184:187], v[144:147]
  s_waitcnt lgkmcnt(3)
  v_mfma_f32_16x16x32_bf16 v[148:151], a[108:111], v[188:191], v[148:151]
  ds_read_b128 v[172:175], v16 offset:22528
  v_mfma_f32_16x16x32_bf16 v[152:155], a[112:115], v[188:191], v[152:155]
  v_mfma_f32_16x16x32_bf16 v[156:159], a[116:119], v[188:191], v[156:159]
  s_waitcnt lgkmcnt(3)
  v_mfma_f32_16x16x32_bf16 v[64:67], a[120:123], v[160:163], v[64:67]
  ds_read_b128 v[176:179], v16 offset:24576
  v_mfma_f32_16x16x32_bf16 v[68:71], a[124:127], v[160:163], v[68:71]
  s_add_u32 m0, s31, 16384
  v_mfma_f32_16x16x32_bf16 v[72:75], a[128:131], v[160:163], v[72:75]
  s_waitcnt lgkmcnt(3)
  buffer_load_dwordx4 v10, s[8:11], s30 offen lds
  v_mfma_f32_16x16x32_bf16 v[76:79], a[120:123], v[164:167], v[76:79]
  ds_read_b128 v[180:183], v16 offset:26624
  v_mfma_f32_16x16x32_bf16 v[80:83], a[124:127], v[164:167], v[80:83]
  v_mfma_f32_16x16x32_bf16 v[84:87], a[128:131], v[164:167], v[84:87]
  s_waitcnt lgkmcnt(3)
  v_mfma_f32_16x16x32_bf16 v[88:91], a[120:123], v[168:171], v[88:91]
  ds_read_b128 v[184:187], v16 offset:28672
  v_mfma_f32_16x16x32_bf16 v[92:95], a[124:127], v[168:171], v[92:95]
  v_mfma_f32_16x16x32_bf16 v[96:99], a[128:131], v[168:171], v[96:99]
  s_waitcnt lgkmcnt(3)
  v_mfma_f32_16x16x32_bf16 v[100:103], a[120:123], v[172:175], v[100:103]
  ds_read_b128 v[188:191], v16 offset:30720
  v_mfma_f32_16x16x32_bf16 v[104:107], a[124:127], v[172:175], v[104:107]
  v_mfma_f32_16x16x32_bf16 v[108:111], a[128:131], v[172:175], v[108:111]
  s_waitcnt lgkmcnt(3)
  v_mfma_f32_16x16x32_bf16 v[112:115], a[120:123], v[176:179], v[112:115]
  ds_read_b128 v[160:163], v17 offset:16384
  v_mfma_f32_16x16x32_bf16 v[116:119], a[124:127], v[176:179], v[116:119]
  s_add_u32 m0, s31, 17408
  v_mfma_f32_16x16x32_bf16 v[120:123], a[128:131], v[176:179], v[120:123]
  s_waitcnt lgkmcnt(3)
  buffer_load_dwordx4 v11, s[8:11], s30 offen lds
  v_mfma_f32_16x16x32_bf16 v[124:127], a[120:123], v[180:183], v[124:127]
  ds_read_b128 v[164:167], v17 offset:18432
  v_mfma_f32_16x16x32_bf16 v[128:131], a[124:127], v[180:183], v[128:131]
  v_mfma_f32_16x16x32_bf16 v[132:135], a[128:131], v[180:183], v[132:135]
  s_waitcnt lgkmcnt(3)
  v_mfma_f32_16x16x32_bf16 v[136:139], a[120:123], v[184:187], v[136:139]
  ds_read_b128 v[168:171], v17 offset:20480
  v_mfma_f32_16x16x32_bf16 v[140:143], a[124:127], v[184:187], v[140:143]
  v_mfma_f32_16x16x32_bf16 v[144:147], a[128:131], v[184:187], v[144:147]
  s_waitcnt lgkmcnt(3)
  v_mfma_f32_16x16x32_bf16 v[148:151], a[120:123], v[188:191], v[148:151]
  ds_read_b128 v[172:175], v17 offset:22528
  v_mfma_f32_16x16x32_bf16 v[152:155], a[124:127], v[188:191], v[152:155]
  v_mfma_f32_16x16x32_bf16 v[156:159], a[128:131], v[188:191], v[156:159]
  s_waitcnt lgkmcnt(3)
  v_mfma_f32_16x16x32_bf16 v[64:67], a[132:135], v[160:163], v[64:67]
  ds_read_b128 v[176:179], v17 offset:24576
  v_mfma_f32_16x16x32_bf16 v[68:71], a[136:139], v[160:163], v[68:71]
  s_add_u32 m0, s31, 18432
  v_mfma_f32_16x16x32_bf16 v[72:75], a[140:143], v[160:163], v[72:75]
  s_waitcnt lgkmcnt(3)
  buffer_load_dwordx4 v12, s[8:11], s30 offen lds
  v_mfma_f32_16x16x32_bf16 v[76:79], a[132:135], v[164:167], v[76:79]
  ds_read_b128 v[180:183], v17 offset:26624
  v_mfma_f32_16x16x32_bf16 v[80:83], a[136:139], v[164:167], v[80:83]
  v_mfma_f32_16x16x32_bf16 v[84:87], a[140:143], v[164:167], v[84:87]
  s_waitcnt lgkmcnt(3)
  v_mfma_f32_16x16x32_bf16 v[88:91], a[132:135], v[168:171], v[88:91]
  ds_read_b128 v[184:187], v17 offset:28672
  v_mfma_f32_16x16x32_bf16 v[92:95], a[136:139], v[168:171], v[92:95]
  v_mfma_f32_16x16x32_bf16 v[96:99], a[140:143], v[168:171], v[96:99]
  s_waitcnt lgkmcnt(3)
  v_mfma_f32_16x16x32_bf16 v[100:103], a[132:135], v[172:175], v[100:103]
  ds_read_b128 v[188:191], v17 offset:30720
  v_mfma_f32_16x16x32_bf16 v[104:107], a[136:139], v[172:175], v[104:107]
  v_mfma_f32_16x16x32_bf16 v[108:111], a[140:143], v[172:175], v[108:111]
  s_waitcnt lgkmcnt(3)
  v_mfma_f32_16x16x32_bf16 v[112:115], a[132:135], v[176:179], v[112:115]
  s_waitcnt vmcnt(23)
  s_barrier
  ds_read_b128 v[160:163], v16 offset:32768
  v_mfma_f32_16x16x32_bf16 v[116:119], a[136:139], v[176:179], v[116:119]
  s_add_u32 m0, s31, 19456
  v_mfma_f32_16x16x32_bf16 v[120:123], a[140:143], v[176:179], v[120:123]
  s_waitcnt lgkmcnt(3)
  buffer_load_dwordx4 v13, s[8:11], s30 offen lds
  v_mfma_f32_16x16x32_bf16 v[124:127], a[132:135], v[180:183], v[124:127]
  s_add_u32 s30, s30, 128
  ds_read_b128 v[164:167], v16 offset:34816
  v_mfma_f32_16x16x32_bf16 v[128:131], a[136:139], v[180:183], v[128:131]
  v_mfma_f32_16x16x32_bf16 v[132:135], a[140:143], v[180:183], v[132:135]
  s_waitcnt lgkmcnt(3)
  v_mfma_f32_16x16x32_bf16 v[136:139], a[132:135], v[184:187], v[136:139]
  ds_read_b128 v[168:171], v16 offset:36864
  v_mfma_f32_16x16x32_bf16 v[140:143], a[136:139], v[184:187], v[140:143]
  v_mfma_f32_16x16x32_bf16 v[144:147], a[140:143], v[184:187], v[144:147]
  s_waitcnt lgkmcnt(3)
  v_mfma_f32_16x16x32_bf16 v[148:151], a[132:135], v[188:191], v[148:151]
  ds_read_b128 v[172:175], v16 offset:38912
  v_mfma_f32_16x16x32_bf16 v[152:155], a[136:139], v[188:191], v[152:155]
  v_mfma_f32_16x16x32_bf16 v[156:159], a[140:143], v[188:191], v[156:159]
  s_waitcnt lgkmcnt(3)
  v_mfma_f32_16x16x32_bf16 v[64:67], a[144:147], v[160:163], v[64:67]
  ds_read_b128 v[176:179], v16 offset:40960
  v_mfma_f32_16x16x32_bf16 v[68:71], a[148:151], v[160:163], v[68:71]
  s_add_u32 m0, s31, 32768
  v_mfma_f32_16x16x32_bf16 v[72:75], a[152:155], v[160:163], v[72:75]
  s_waitcnt lgkmcnt(3)
  buffer_load_dwordx4 v10, s[8:11], s30 offen lds
  v_mfma_f32_16x16x32_bf16 v[76:79], a[144:147], v[164:167], v[76:79]
  ds_read_b128 v[180:183], v16 offset:43008
  v_mfma_f32_16x16x32_bf16 v[80:83], a[148:151], v[164:167], v[80:83]
  v_mfma_f32_16x16x32_bf16 v[84:87], a[152:155], v[164:167], v[84:87]
  s_waitcnt lgkmcnt(3)
  v_mfma_f32_16x16x32_bf16 v[88:91], a[144:147], v[168:171], v[88:91]
  ds_read_b128 v[184:187], v16 offset:45056
  v_mfma_f32_16x16x32_bf16 v[92:95], a[148:151], v[168:171], v[92:95]
  v_mfma_f32_16x16x32_bf16 v[96:99], a[152:155], v[168:171], v[96:99]
  s_waitcnt lgkmcnt(3)
  v_mfma_f32_16x16x32_bf16 v[100:103], a[144:147], v[172:175], v[100:103]
  ds_read_b128 v[188:191], v16 offset:47104
  v_mfma_f32_16x16x32_bf16 v[104:107], a[148:151], v[172:175], v[104:107]
  v_mfma_f32_16x16x32_bf16 v[108:111], a[152:155], v[172:175], v[108:111]
  s_waitcnt lgkmcnt(3)
  v_mfma_f32_16x16x32_bf16 v[112:115], a[144:147], v[176:179], v[112:115]
  ds_read_b128 v[160:163], v17 offset:32768
  v_mfma_f32_16x16x32_bf16 v[116:119], a[148:151], v[176:179], v[116:119]
  s_add_u32 m0, s31, 33792
  v_mfma_f32_16x16x32_bf16 v[120:123], a[152:155], v[176:179], v[120:123]
  s_waitcnt lgkmcnt(3)
  buffer_load_dwordx4 v11, s[8:11], s30 offen lds
  v_mfma_f32_16x16x32_bf16 v[124:127], a[144:147], v[180:183], v[124:127]
  ds_read_b128 v[164:167], v17 offset:34816
  v_mfma_f32_16x16x32_bf16 v[128:131], a[148:151], v[180:183], v[128:131]
  v_mfma_f32_16x16x32_bf16 v[132:135], a[152:155], v[180:183], v[132:135]
  s_waitcnt lgkmcnt(3)
  v_mfma_f32_16x16x32_bf16 v[136:139], a[144:147], v[184:187], v[136:139]
  ds_read_b128 v[168:171], v17 offset:36864
  v_mfma_f32_16x16x32_bf16 v[140:143], a[148:151], v[184:187], v[140:143]
  v_mfma_f32_16x16x32_bf16 v[144:147], a[152:155], v[184:187], v[144:147]
  s_waitcnt lgkmcnt(3)
  v_mfma_f32_16x16x32_bf16 v[148:151], a[144:147], v[188:191], v[148:151]
  ds_read_b128 v[172:175], v17 offset:38912
  v_mfma_f32_16x16x32_bf16 v[152:155], a[148:151], v[188:191], v[152:155]
  v_mfma_f32_16x16x32_bf16 v[156:159], a[152:155], v[188:191], v[156:159]
  s_waitcnt lgkmcnt(3)
  v_mfma_f32_16x16x32_bf16 v[64:67], a[156:159], v[160:163], v[64:67]
  ds_read_b128 v[176:179], v17 offset:40960
  v_mfma_f32_16x16x32_bf16 v[68:71], a[160:163], v[160:163], v[68:71]
  s_add_u32 m0, s31, 34816
  v_mfma_f32_16x16x32_bf16 v[72:75], a[164:167], v[160:163], v[72:75]
  s_waitcnt lgkmcnt(3)
  buffer_load_dwordx4 v12, s[8:11], s30 offen lds
  v_mfma_f32_16x16x32_bf16 v[76:79], a[156:159], v[164:167], v[76:79]
  ds_read_b128 v[180:183], v17 offset:43008
  v_mfma_f32_16x16x32_bf16 v[80:83], a[160:163], v[164:167], v[80:83]
  v_mfma_f32_16x16x32_bf16 v[84:87], a[164:167], v[164:167], v[84:87]
  s_waitcnt lgkmcnt(3)
  v_mfma_f32_16x16x32_bf16 v[88:91], a[156:159], v[168:171], v[88:91]
  ds_read_b128 v[184:187], v17 offset:45056
  v_mfma_f32_16x16x32_bf16 v[92:95], a[160:163], v[168:171], v[92:95]
  v_mfma_f32_16x16x32_bf16 v[96:99], a[164:167], v[168:171], v[96:99]
  s_waitcnt lgkmcnt(3)
  v_mfma_f32_16x16x32_bf16 v[100:103], a[156:159], v[172:175], v[100:103]
  ds_read_b128 v[188:191], v17 offset:47104
  v_mfma_f32_16x16x32_bf16 v[104:107], a[160:163], v[172:175], v[104:107]
  v_mfma_f32_16x16x32_bf16 v[108:111], a[164:167], v[172:175], v[108:111]
  s_waitcnt lgkmcnt(3)
  v_mfma_f32_16x16x32_bf16 v[112:115], a[156:159], v[176:179], v[112:115]
  ds_read_b128 v[160:163], v16 offset:49152
  v_mfma_f32_16x16x32_bf16 v[116:119], a[160:163], v[176:179], v[116:119]
  s_add_u32 m0, s31, 35840
  v_mfma_f32_16x16x32_bf16 v[120:123], a[164:167], v[176:179], v[120:123]
  s_waitcnt lgkmcnt(3)
  buffer_load_dwordx4 v13, s[8:11], s30 offen lds
  v_mfma_f32_16x16x32_bf16 v[124:127], a[156:159], v[180:183], v[124:127]
  s_add_u32 s30, s30, 128
  ds_read_b128 v[164:167], v16 offset:51200
  v_mfma_f32_16x16x32_bf16 v[128:131], a[160:163], v[180:183], v[128:131]
  v_mfma_f32_16x16x32_bf16 v[132:135], a[164:167], v[180:183], v[132:135]
  s_waitcnt lgkmcnt(3)
  v_mfma_f32_16x16x32_bf16 v[136:139], a[156:159], v[184:187], v[136:139]
  ds_read_b128 v[168:171], v16 offset:53248
  v_mfma_f32_16x16x32_bf16 v[140:143], a[160:163], v[184:187], v[140:143]
  v_mfma_f32_16x16x32_bf16 v[144:147], a[164:167], v[184:187], v[144:147]
  s_waitcnt lgkmcnt(3)
  v_mfma_f32_16x16x32_bf16 v[148:151], a[156:159], v[188:191], v[148:151]
  ds_read_b128 v[172:175], v16 offset:55296
  v_mfma_f32_16x16x32_bf16 v[152:155], a[160:163], v[188:191], v[152:155]
  v_mfma_f32_16x16x32_bf16 v[156:159], a[164:167], v[188:191], v[156:159]
  s_waitcnt lgkmcnt(3)
  v_mfma_f32_16x16x32_bf16 v[64:67], a[168:171], v[160:163], v[64:67]
  ds_read_b128 v[176:179], v16 offset:57344
  v_mfma_f32_16x16x32_bf16 v[68:71], a[172:175], v[160:163], v[68:71]
  s_add_u32 m0, s31, 49152
  v_mfma_f32_16x16x32_bf16 v[72:75], a[176:179], v[160:163], v[72:75]
  s_waitcnt lgkmcnt(3)
  buffer_load_dwordx4 v10, s[8:11], s30 offen lds
  v_mfma_f32_16x16x32_bf16 v[76:79], a[168:171], v[164:167], v[76:79]
  ds_read_b128 v[180:183], v16 offset:59392
  v_mfma_f32_16x16x32_bf16 v[80:83], a[172:175], v[164:167], v[80:83]
  v_mfma_f32_16x16x32_bf16 v[84:87], a[176:179], v[164:167], v[84:87]
  s_waitcnt lgkmcnt(3)
  v_mfma_f32_16x16x32_bf16 v[88:91], a[168:171], v[168:171], v[88:91]
  ds_read_b128 v[184:187], v16 offset:61440
  v_mfma_f32_16x16x32_bf16 v[92:95], a[172:175], v[168:171], v[92:95]
  v_mfma_f32_16x16x32_bf16 v[96:99], a[176:179], v[168:171], v[96:99]
  s_waitcnt lgkmcnt(3)
  v_mfma_f32_16x16x32_bf16 v[100:103], a[168:171], v[172:175], v[100:103]
  ds_read_b128 v[188:191], v16 offset:63488
  v_mfma_f32_16x16x32_bf16 v[104:107], a[172:175], v[172:175], v[104:107]
  v_mfma_f32_16x16x32_bf16 v[108:111], a[176:179], v[172:175], v[108:111]
  s_waitcnt lgkmcnt(3)
  v_mfma_f32_16x16x32_bf16 v[112:115], a[168:171], v[176:179], v[112:115]
  ds_read_b128 v[160:163], v17 offset:49152
  v_mfma_f32_16x16x32_bf16 v[116:119], a[172:175], v[176:179], v[116:119]
  s_add_u32 m0, s31, 50176
  v_mfma_f32_16x16x32_bf16 v[120:123], a[176:179], v[176:179], v[120:123]
  s_waitcnt lgkmcnt(3)
  buffer_load_dwordx4 v11, s[8:11], s30 offen lds
  v_mfma_f32_16x16x32_bf16 v[124:127], a[168:171], v[180:183], v[124:127]
  ds_read_b128 v[164:167], v17 offset:51200
  v_mfma_f32_16x16x32_bf16 v[128:131], a[172:175], v[180:183], v[128:131]
  v_mfma_f32_16x16x32_bf16 v[132:135], a[176:179], v[180:183], v[132:135]
  s_waitcnt lgkmcnt(3)
  v_mfma_f32_16x16x32_bf16 v[136:139], a[168:171], v[184:187], v[136:139]
  ds_read_b128 v[168:171], v17 offset:53248
  v_mfma_f32_16x16x32_bf16 v[140:143], a[172:175], v[184:187], v[140:143]
  v_mfma_f32_16x16x32_bf16 v[144:147], a[176:179], v[184:187], v[144:147]
  s_waitcnt lgkmcnt(3)
  v_mfma_f32_16x16x32_bf16 v[148:151], a[168:171], v[188:191], v[148:151]
  ds_read_b128 v[172:175], v17 offset:55296
  v_mfma_f32_16x16x32_bf16 v[152:155], a[172:175], v[188:191], v[152:155]
  v_mfma_f32_16x16x32_bf16 v[156:159], a[176:179], v[188:191], v[156:159]
  s_waitcnt lgkmcnt(3)
  v_mfma_f32_16x16x32_bf16 v[64:67], a[180:183], v[160:163], v[64:67]
  ds_read_b128 v[176:179], v17 offset:57344
  v_mfma_f32_16x16x32_bf16 v[68:71], a[184:187], v[160:163], v[68:71]
  s_add_u32 m0, s31, 51200
  v_mfma_f32_16x16x32_bf16 v[72:75], a[188:191], v[160:163], v[72:75]
  s_waitcnt lgkmcnt(3)
  buffer_load_dwordx4 v12, s[8:11], s30 offen lds
  v_mfma_f32_16x16x32_bf16 v[76:79], a[180:183], v[164:167], v[76:79]
  ds_read_b128 v[180:183], v17 offset:59392
  v_mfma_f32_16x16x32_bf16 v[80:83], a[184:187], v[164:167], v[80:83]
  v_mfma_f32_16x16x32_bf16 v[84:87], a[188:191], v[164:167], v[84:87]
  s_waitcnt lgkmcnt(3)
  v_mfma_f32_16x16x32_bf16 v[88:91], a[180:183], v[168:171], v[88:91]
  ds_read_b128 v[184:187], v17 offset:61440
  v_mfma_f32_16x16x32_bf16 v[92:95], a[184:187], v[168:171], v[92:95]
  v_mfma_f32_16x16x32_bf16 v[96:99], a[188:191], v[168:171], v[96:99]
  s_waitcnt lgkmcnt(3)
  v_mfma_f32_16x16x32_bf16 v[100:103], a[180:183], v[172:175], v[100:103]
  ds_read_b128 v[188:191], v17 offset:63488
  v_mfma_f32_16x16x32_bf16 v[104:107], a[184:187], v[172:175], v[104:107]
  v_mfma_f32_16x16x32_bf16 v[108:111], a[188:191], v[172:175], v[108:111]
  s_waitcnt lgkmcnt(3)
  v_mfma_f32_16x16x32_bf16 v[112:115], a[180:183], v[176:179], v[112:115]
  s_waitcnt vmcnt(16)
  s_barrier
  ds_read_b128 v[160:163], v18 offset:0
  v_mfma_f32_16x16x32_bf16 v[116:119], a[184:187], v[176:179], v[116:119]
  s_add_u32 m0, s31, 52224
  v_mfma_f32_16x16x32_bf16 v[120:123], a[188:191], v[176:179], v[120:123]
  s_waitcnt lgkmcnt(3)
  buffer_load_dwordx4 v13, s[8:11], s30 offen lds
  v_mfma_f32_16x16x32_bf16 v[124:127], a[180:183], v[180:183], v[124:127]
  s_add_u32 s30, s30, 128
  ds_read_b128 v[164:167], v18 offset:2048
  v_mfma_f32_16x16x32_bf16 v[128:131], a[184:187], v[180:183], v[128:131]
  v_mfma_f32_16x16x32_bf16 v[132:135], a[188:191], v[180:183], v[132:135]
  s_waitcnt lgkmcnt(3)
  v_mfma_f32_16x16x32_bf16 v[136:139], a[180:183], v[184:187], v[136:139]
  ds_read_b128 v[168:171], v18 offset:4096
  v_mfma_f32_16x16x32_bf16 v[140:143], a[184:187], v[184:187], v[140:143]
  buffer_atomic_add v28, v27, s[72:75], s61 offen sc1
  v_mfma_f32_16x16x32_bf16 v[144:147], a[188:191], v[184:187], v[144:147]
  s_waitcnt lgkmcnt(3)
  s_mov_b32 s48, s27
  s_add_u32 s27, s27, 8388608
  v_mfma_f32_16x16x32_bf16 v[148:151], a[180:183], v[188:191], v[148:151]
  s_mov_b32 s61, s60
  ds_read_b128 v[172:175], v18 offset:6144
  s_add_u32 s60, s60, 4
  v_mfma_f32_16x16x32_bf16 v[152:155], a[184:187], v[188:191], v[152:155]
  v_mfma_f32_16x16x32_bf16 v[156:159], a[188:191], v[188:191], v[156:159]
  s_waitcnt lgkmcnt(3)
  v_mfma_f32_16x16x32_bf16 v[64:67], a[192:195], v[160:163], v[64:67]
  ds_read_b128 v[176:179], v18 offset:8192
  v_mfma_f32_16x16x32_bf16 v[68:71], a[196:199], v[160:163], v[68:71]
  s_add_u32 m0, s31, 65536
  v_mfma_f32_16x16x32_bf16 v[72:75], a[200:203], v[160:163], v[72:75]
  s_waitcnt lgkmcnt(3)
  buffer_load_dwordx4 v10, s[8:11], s30 offen lds
  v_mfma_f32_16x16x32_bf16 v[76:79], a[192:195], v[164:167], v[76:79]
  ds_read_b128 v[180:183], v18 offset:10240
  v_mfma_f32_16x16x32_bf16 v[80:83], a[196:199], v[164:167], v[80:83]
  v_mfma_f32_16x16x32_bf16 v[84:87], a[200:203], v[164:167], v[84:87]
  s_waitcnt lgkmcnt(3)
  v_mfma_f32_16x16x32_bf16 v[88:91], a[192:195], v[168:171], v[88:91]
  ds_read_b128 v[184:187], v18 offset:12288
  v_mfma_f32_16x16x32_bf16 v[92:95], a[196:199], v[168:171], v[92:95]
  v_mfma_f32_16x16x32_bf16 v[96:99], a[200:203], v[168:171], v[96:99]
  s_waitcnt lgkmcnt(3)
  v_mfma_f32_16x16x32_bf16 v[100:103], a[192:195], v[172:175], v[100:103]
  ds_read_b128 v[188:191], v18 offset:14336
  v_mfma_f32_16x16x32_bf16 v[104:107], a[196:199], v[172:175], v[104:107]
  v_mfma_f32_16x16x32_bf16 v[108:111], a[200:203], v[172:175], v[108:111]
  s_waitcnt lgkmcnt(3)
  v_mfma_f32_16x16x32_bf16 v[112:115], a[192:195], v[176:179], v[112:115]
  ds_read_b128 v[160:163], v19 offset:0
  v_mfma_f32_16x16x32_bf16 v[116:119], a[196:199], v[176:179], v[116:119]
  s_add_u32 m0, s31, 66560
  v_mfma_f32_16x16x32_bf16 v[120:123], a[200:203], v[176:179], v[120:123]
  s_waitcnt lgkmcnt(3)
  buffer_load_dwordx4 v11, s[8:11], s30 offen lds
  v_mfma_f32_16x16x32_bf16 v[124:127], a[192:195], v[180:183], v[124:127]
  ds_read_b128 v[164:167], v19 offset:2048
  v_mfma_f32_16x16x32_bf16 v[128:131], a[196:199], v[180:183], v[128:131]
  v_mfma_f32_16x16x32_bf16 v[132:135], a[200:203], v[180:183], v[132:135]
  s_waitcnt lgkmcnt(3)
  v_mfma_f32_16x16x32_bf16 v[136:139], a[192:195], v[184:187], v[136:139]
  ds_read_b128 v[168:171], v19 offset:4096
  v_mfma_f32_16x16x32_bf16 v[140:143], a[196:199], v[184:187], v[140:143]
  v_mfma_f32_16x16x32_bf16 v[144:147], a[200:203], v[184:187], v[144:147]
  s_waitcnt lgkmcnt(3)
  v_mfma_f32_16x16x32_bf16 v[148:151], a[192:195], v[188:191], v[148:151]
  ds_read_b128 v[172:175], v19 offset:6144
  v_mfma_f32_16x16x32_bf16 v[152:155], a[196:199], v[188:191], v[152:155]
  v_mfma_f32_16x16x32_bf16 v[156:159], a[200:203], v[188:191], v[156:159]
  s_waitcnt lgkmcnt(3)
  v_mfma_f32_16x16x32_bf16 v[64:67], a[204:207], v[160:163], v[64:67]
  ds_read_b128 v[176:179], v19 offset:8192
  v_mfma_f32_16x16x32_bf16 v[68:71], a[208:211], v[160:163], v[68:71]
  s_add_u32 m0, s31, 67584
  v_mfma_f32_16x16x32_bf16 v[72:75], a[212:215], v[160:163], v[72:75]
  s_waitcnt lgkmcnt(3)
  buffer_load_dwordx4 v12, s[8:11], s30 offen lds
  v_mfma_f32_16x16x32_bf16 v[76:79], a[204:207], v[164:167], v[76:79]
  ds_read_b128 v[180:183], v19 offset:10240
  v_mfma_f32_16x16x32_bf16 v[80:83], a[208:211], v[164:167], v[80:83]
  v_mfma_f32_16x16x32_bf16 v[84:87], a[212:215], v[164:167], v[84:87]
  s_waitcnt lgkmcnt(3)
  v_mfma_f32_16x16x32_bf16 v[88:91], a[204:207], v[168:171], v[88:91]
  ds_read_b128 v[184:187], v19 offset:12288
  v_mfma_f32_16x16x32_bf16 v[92:95], a[208:211], v[168:171], v[92:95]
  v_mfma_f32_16x16x32_bf16 v[96:99], a[212:215], v[168:171], v[96:99]
  s_waitcnt lgkmcnt(3)
  v_mfma_f32_16x16x32_bf16 v[100:103], a[204:207], v[172:175], v[100:103]
  ds_read_b128 v[188:191], v19 offset:14336
  v_mfma_f32_16x16x32_bf16 v[104:107], a[208:211], v[172:175], v[104:107]
  v_mfma_f32_16x16x32_bf16 v[108:111], a[212:215], v[172:175], v[108:111]
  s_waitcnt lgkmcnt(3)
  v_mfma_f32_16x16x32_bf16 v[112:115], a[204:207], v[176:179], v[112:115]
  ds_read_b128 v[160:163], v18 offset:16384
  v_mfma_f32_16x16x32_bf16 v[116:119], a[208:211], v[176:179], v[116:119]
  s_add_u32 m0, s31, 68608
  v_mfma_f32_16x16x32_bf16 v[120:123], a[212:215], v[176:179], v[120:123]
  s_waitcnt lgkmcnt(3)
  buffer_load_dwordx4 v13, s[8:11], s30 offen lds
  v_mfma_f32_16x16x32_bf16 v[124:127], a[204:207], v[180:183], v[124:127]
  s_add_u32 s30, s30, 128
  ds_read_b128 v[164:167], v18 offset:18432
  v_mfma_f32_16x16x32_bf16 v[128:131], a[208:211], v[180:183], v[128:131]
  v_mfma_f32_16x16x32_bf16 v[132:135], a[212:215], v[180:183], v[132:135]
  s_waitcnt lgkmcnt(3)
  v_mfma_f32_16x16x32_bf16 v[136:139], a[204:207], v[184:187], v[136:139]
  ds_read_b128 v[168:171], v18 offset:20480
  v_mfma_f32_16x16x32_bf16 v[140:143], a[208:211], v[184:187], v[140:143]
  v_mfma_f32_16x16x32_bf16 v[144:147], a[212:215], v[184:187], v[144:147]
  s_waitcnt lgkmcnt(3)
  v_mfma_f32_16x16x32_bf16 v[148:151], a[204:207], v[188:191], v[148:151]
  ds_read_b128 v[172:175], v18 offset:22528
  v_mfma_f32_16x16x32_bf16 v[152:155], a[208:211], v[188:191], v[152:155]
  v_mfma_f32_16x16x32_bf16 v[156:159], a[212:215], v[188:191], v[156:159]
  s_waitcnt lgkmcnt(3)
  v_mfma_f32_16x16x32_bf16 v[64:67], a[216:219], v[160:163], v[64:67]
  ds_read_b128 v[176:179], v18 offset:24576
  v_mfma_f32_16x16x32_bf16 v[68:71], a[220:223], v[160:163], v[68:71]
  s_add_u32 m0, s31, 81920
  v_mfma_f32_16x16x32_bf16 v[72:75], a[224:227], v[160:163], v[72:75]
  s_waitcnt lgkmcnt(3)
  buffer_load_dwordx4 v10, s[8:11], s30 offen lds
  v_mfma_f32_16x16x32_bf16 v[76:79], a[216:219], v[164:167], v[76:79]
  ds_read_b128 v[180:183], v18 offset:26624
  v_mfma_f32_16x16x32_bf16 v[80:83], a[220:223], v[164:167], v[80:83]
  v_mfma_f32_16x16x32_bf16 v[84:87], a[224:227], v[164:167], v[84:87]
  s_waitcnt lgkmcnt(3)
  v_mfma_f32_16x16x32_bf16 v[88:91], a[216:219], v[168:171], v[88:91]
  ds_read_b128 v[184:187], v18 offset:28672
  v_mfma_f32_16x16x32_bf16 v[92:95], a[220:223], v[168:171], v[92:95]
  s_add_u32 m0, s31, 82944
  v_mfma_f32_16x16x32_bf16 v[96:99], a[224:227], v[168:171], v[96:99]
  s_waitcnt lgkmcnt(3)
  buffer_load_dwordx4 v11, s[8:11], s30 offen lds
  v_mfma_f32_16x16x32_bf16 v[100:103], a[216:219], v[172:175], v[100:103]
  ds_read_b128 v[188:191], v18 offset:30720
  v_mfma_f32_16x16x32_bf16 v[104:107], a[220:223], v[172:175], v[104:107]
  v_mfma_f32_16x16x32_bf16 v[108:111], a[224:227], v[172:175], v[108:111]
  s_waitcnt lgkmcnt(3)
  v_mfma_f32_16x16x32_bf16 v[112:115], a[216:219], v[176:179], v[112:115]
  ds_read_b128 v[160:163], v19 offset:16384
  v_mfma_f32_16x16x32_bf16 v[116:119], a[220:223], v[176:179], v[116:119]
  s_add_u32 m0, s31, 83968
  v_mfma_f32_16x16x32_bf16 v[120:123], a[224:227], v[176:179], v[120:123]
  s_waitcnt lgkmcnt(3)
  buffer_load_dwordx4 v12, s[8:11], s30 offen lds
  v_mfma_f32_16x16x32_bf16 v[124:127], a[216:219], v[180:183], v[124:127]
  ds_read_b128 v[164:167], v19 offset:18432
  v_mfma_f32_16x16x32_bf16 v[128:131], a[220:223], v[180:183], v[128:131]
  v_mfma_f32_16x16x32_bf16 v[132:135], a[224:227], v[180:183], v[132:135]
  s_waitcnt lgkmcnt(3)
  v_mfma_f32_16x16x32_bf16 v[136:139], a[216:219], v[184:187], v[136:139]
  ds_read_b128 v[168:171], v19 offset:20480
  v_mfma_f32_16x16x32_bf16 v[140:143], a[220:223], v[184:187], v[140:143]
  s_add_u32 m0, s31, 84992
  v_mfma_f32_16x16x32_bf16 v[144:147], a[224:227], v[184:187], v[144:147]
  s_waitcnt lgkmcnt(3)
  buffer_load_dwordx4 v13, s[8:11], s30 offen lds
  v_mfma_f32_16x16x32_bf16 v[148:151], a[216:219], v[188:191], v[148:151]
  s_add_u32 s30, s30, 128
  ds_read_b128 v[172:175], v19 offset:22528
  v_mfma_f32_16x16x32_bf16 v[152:155], a[220:223], v[188:191], v[152:155]
  v_mfma_f32_16x16x32_bf16 v[156:159], a[224:227], v[188:191], v[156:159]
  s_waitcnt lgkmcnt(3)
  v_mfma_f32_16x16x32_bf16 v[64:67], a[228:231], v[160:163], v[64:67]
  ds_read_b128 v[176:179], v19 offset:24576
  v_mfma_f32_16x16x32_bf16 v[68:71], a[232:235], v[160:163], v[68:71]
  v_mfma_f32_16x16x32_bf16 v[72:75], a[236:239], v[160:163], v[72:75]
  s_waitcnt lgkmcnt(3)
  v_mfma_f32_16x16x32_bf16 v[76:79], a[228:231], v[164:167], v[76:79]
  ds_read_b128 v[180:183], v19 offset:26624
  v_cvt_pk_bf16_f32 v192, v64, v65
  v_mfma_f32_16x16x32_bf16 v[80:83], a[232:235], v[164:167], v[80:83]
  v_cvt_pk_bf16_f32 v193, v66, v67
  v_cvt_pk_bf16_f32 v194, v68, v69
  v_mfma_f32_16x16x32_bf16 v[84:87], a[236:239], v[164:167], v[84:87]
  s_waitcnt lgkmcnt(3)
  v_cvt_pk_bf16_f32 v195, v70, v71
  v_cvt_pk_bf16_f32 v200, v72, v73
  v_mfma_f32_16x16x32_bf16 v[88:91], a[228:231], v[168:171], v[88:91]
  ds_read_b128 v[184:187], v19 offset:28672
  v_cvt_pk_bf16_f32 v201, v74, v75
  v_mfma_f32_16x16x32_bf16 v[92:95], a[232:235], v[168:171], v[92:95]
  v_cvt_pk_bf16_f32 v196, v76, v77
  v_cvt_pk_bf16_f32 v197, v78, v79
  v_mfma_f32_16x16x32_bf16 v[96:99], a[236:239], v[168:171], v[96:99]
  s_waitcnt lgkmcnt(3)
  v_cvt_pk_bf16_f32 v198, v80, v81
  v_cvt_pk_bf16_f32 v199, v82, v83
  v_mfma_f32_16x16x32_bf16 v[100:103], a[228:231], v[172:175], v[100:103]
  ds_read_b128 v[188:191], v19 offset:30720
  v_cvt_pk_bf16_f32 v202, v84, v85
  v_mfma_f32_16x16x32_bf16 v[104:107], a[232:235], v[172:175], v[104:107]
  v_cvt_pk_bf16_f32 v203, v86, v87
  v_cvt_pk_bf16_f32 v204, v88, v89
  v_mfma_f32_16x16x32_bf16 v[108:111], a[236:239], v[172:175], v[108:111]
  s_waitcnt lgkmcnt(3)
  v_cvt_pk_bf16_f32 v205, v90, v91
  v_cvt_pk_bf16_f32 v206, v92, v93
  v_mfma_f32_16x16x32_bf16 v[112:115], a[228:231], v[176:179], v[112:115]
  s_waitcnt vmcnt(17)
  s_barrier
  ds_read_b128 v[160:163], v14 offset:0
  v_mfma_f32_16x16x32_bf16 v[116:119], a[232:235], v[176:179], v[116:119]
  v_cvt_pk_bf16_f32 v207, v94, v95
  v_cvt_pk_bf16_f32 v212, v96, v97
  v_mfma_f32_16x16x32_bf16 v[120:123], a[236:239], v[176:179], v[120:123]
  s_waitcnt lgkmcnt(3)
  v_cvt_pk_bf16_f32 v213, v98, v99
  v_cvt_pk_bf16_f32 v208, v100, v101
  v_mfma_f32_16x16x32_bf16 v[124:127], a[228:231], v[180:183], v[124:127]
  ds_read_b128 v[164:167], v14 offset:2048
  v_cvt_pk_bf16_f32 v209, v102, v103
  v_mfma_f32_16x16x32_bf16 v[128:131], a[232:235], v[180:183], v[128:131]
  v_cvt_pk_bf16_f32 v210, v104, v105
  v_cvt_pk_bf16_f32 v211, v106, v107
  v_mfma_f32_16x16x32_bf16 v[132:135], a[236:239], v[180:183], v[132:135]
  s_waitcnt lgkmcnt(3)
  v_cvt_pk_bf16_f32 v214, v108, v109
  v_cvt_pk_bf16_f32 v215, v110, v111
  v_mfma_f32_16x16x32_bf16 v[136:139], a[228:231], v[184:187], v[136:139]
  ds_read_b128 v[168:171], v14 offset:4096
  v_cvt_pk_bf16_f32 v216, v112, v113
  v_mfma_f32_16x16x32_bf16 v[140:143], a[232:235], v[184:187], v[140:143]
  v_cvt_pk_bf16_f32 v217, v114, v115
  v_cvt_pk_bf16_f32 v218, v116, v117
  v_mfma_f32_16x16x32_bf16 v[144:147], a[236:239], v[184:187], v[144:147]
  s_waitcnt lgkmcnt(3)
  v_cvt_pk_bf16_f32 v219, v118, v119
  v_cvt_pk_bf16_f32 v224, v120, v121
  v_mfma_f32_16x16x32_bf16 v[148:151], a[228:231], v[188:191], v[148:151]
  ds_read_b128 v[172:175], v14 offset:6144
  v_cvt_pk_bf16_f32 v225, v122, v123
  v_mfma_f32_16x16x32_bf16 v[152:155], a[232:235], v[188:191], v[152:155]
  s_sub_u32 s26, s26, 1
  s_cmp_gt_u32 s26, 0
  v_cvt_pk_bf16_f32 v220, v124, v125
  v_mfma_f32_16x16x32_bf16 v[156:159], a[236:239], v[188:191], v[156:159]
  s_waitcnt lgkmcnt(3)
  s_cbranch_scc1 kvs_241
  s_nop 7
  v_cvt_pk_bf16_f32 v221, v126, v127
  v_cvt_pk_bf16_f32 v222, v128, v129
  v_cvt_pk_bf16_f32 v223, v130, v131
  v_cvt_pk_bf16_f32 v226, v132, v133
  v_cvt_pk_bf16_f32 v227, v134, v135
  v_cvt_pk_bf16_f32 v228, v136, v137
  v_cvt_pk_bf16_f32 v229, v138, v139
  v_cvt_pk_bf16_f32 v230, v140, v141
  v_cvt_pk_bf16_f32 v231, v142, v143
  v_cvt_pk_bf16_f32 v236, v144, v145
  v_cvt_pk_bf16_f32 v237, v146, v147
  v_cvt_pk_bf16_f32 v232, v148, v149
  v_cvt_pk_bf16_f32 v233, v150, v151
  v_cvt_pk_bf16_f32 v234, v152, v153
  v_cvt_pk_bf16_f32 v235, v154, v155
  v_cvt_pk_bf16_f32 v238, v156, v157
  v_cvt_pk_bf16_f32 v239, v158, v159
  s_xor_b32 s29, s48, 0
  buffer_store_dwordx4 v[192:195], v26, s[16:19], s29 offen offset:0 sc1
  buffer_store_dwordx4 v[196:199], v26, s[16:19], s29 offen offset:1024 sc1
  buffer_store_dwordx4 v[200:203], v26, s[16:19], s29 offen offset:2048 sc1
  s_xor_b32 s29, s48, 2105344
  buffer_store_dwordx4 v[204:207], v26, s[16:19], s29 offen offset:0 sc1
  buffer_store_dwordx4 v[208:211], v26, s[16:19], s29 offen offset:1024 sc1
  buffer_store_dwordx4 v[212:215], v26, s[16:19], s29 offen offset:2048 sc1
  s_xor_b32 s29, s48, 4194304
  buffer_store_dwordx4 v[216:219], v26, s[16:19], s29 offen offset:0 sc1
  buffer_store_dwordx4 v[220:223], v26, s[16:19], s29 offen offset:1024 sc1
  buffer_store_dwordx4 v[224:227], v26, s[16:19], s29 offen offset:2048 sc1
  s_xor_b32 s29, s48, 6299648
  buffer_store_dwordx4 v[228:231], v26, s[16:19], s29 offen offset:0 sc1
  buffer_store_dwordx4 v[232:235], v26, s[16:19], s29 offen offset:1024 sc1
  buffer_store_dwordx4 v[236:239], v26, s[16:19], s29 offen offset:2048 sc1
  s_waitcnt vmcnt(0) lgkmcnt(0)
  s_barrier
  buffer_atomic_add v28, v27, s[72:75], s61 offen sc1
  s_bitcmp1_b32 s3, 0
  s_cbranch_scc1 queue
  s_lshr_b32 s2, s3, 1
  s_mov_b32 s40, 12
  s_mov_b32 s41, 4
  s_waitcnt vmcnt(0)
  s_barrier
  s_branch q_entry
  s_branch queue
not_kv:
  s_cmp_ge_u32 s3, 96
  s_cbranch_scc1 not_vw
  s_sub_u32 s2, s3, 64
  s_load_dwordx2 s[6:7], s[0:1], 40
  s_load_dwordx2 s[38:39], s[0:1], 104
  v_lshlrev_b32 v4, 4, v1
  s_waitcnt lgkmcnt(0)
  s_mov_b32 s12, s6
  s_mov_b32 s13, s7
  s_mov_b32 s14, 7864320
  s_mov_b32 s15, 0x00020000
  s_mov_b32 s16, s38
  s_mov_b32 s17, s39
  s_mov_b32 s18, 218103808
  s_mov_b32 s19, 0x00020000
  s_add_u32 s72, s38, 173080576
  s_addc_u32 s73, s39, 0
  s_mov_b32 s74, 49152
  s_mov_b32 s75, 0x00020000
  s_mul_i32 s40, s2, 245760
  s_mul_i32 s22, s20, 30720
  s_add_u32 s40, s40, s22
  s_add_u32 m0, s22, 0
  s_add_u32 s21, s40, 0
  buffer_load_dwordx4 v4, s[12:15], s21 offen offset:0 lds
  buffer_load_dwordx4 v4, s[12:15], s21 offen offset:1024 lds
  buffer_load_dwordx4 v4, s[12:15], s21 offen offset:2048 lds
  buffer_load_dwordx4 v4, s[12:15], s21 offen offset:3072 lds
  s_add_u32 m0, s22, 4096
  s_add_u32 s21, s40, 4096
  buffer_load_dwordx4 v4, s[12:15], s21 offen offset:0 lds
  buffer_load_dwordx4 v4, s[12:15], s21 offen offset:1024 lds
  buffer_load_dwordx4 v4, s[12:15], s21 offen offset:2048 lds
  buffer_load_dwordx4 v4, s[12:15], s21 offen offset:3072 lds
  s_add_u32 m0, s22, 8192
  s_add_u32 s21, s40, 8192
  buffer_load_dwordx4 v4, s[12:15], s21 offen offset:0 lds
  buffer_load_dwordx4 v4, s[12:15], s21 offen offset:1024 lds
  buffer_load_dwordx4 v4, s[12:15], s21 offen offset:2048 lds
  buffer_load_dwordx4 v4, s[12:15], s21 offen offset:3072 lds
  s_add_u32 m0, s22, 12288
  s_add_u32 s21, s40, 12288
  buffer_load_dwordx4 v4, s[12:15], s21 offen offset:0 lds
  buffer_load_dwordx4 v4, s[12:15], s21 offen offset:1024 lds
  buffer_load_dwordx4 v4, s[12:15], s21 offen offset:2048 lds
  buffer_load_dwordx4 v4, s[12:15], s21 offen offset:3072 lds
  s_add_u32 m0, s22, 16384
  s_add_u32 s21, s40, 16384
  buffer_load_dwordx4 v4, s[12:15], s21 offen offset:0 lds
  buffer_load_dwordx4 v4, s[12:15], s21 offen offset:1024 lds
  buffer_load_dwordx4 v4, s[12:15], s21 offen offset:2048 lds
  buffer_load_dwordx4 v4, s[12:15], s21 offen offset:3072 lds
  s_add_u32 m0, s22, 20480
  s_add_u32 s21, s40, 20480
  buffer_load_dwordx4 v4, s[12:15], s21 offen offset:0 lds
  buffer_load_dwordx4 v4, s[12:15], s21 offen offset:1024 lds
  buffer_load_dwordx4 v4, s[12:15], s21 offen offset:2048 lds
  buffer_load_dwordx4 v4, s[12:15], s21 offen offset:3072 lds
  s_add_u32 m0, s22, 24576
  s_add_u32 s21, s40, 24576
  buffer_load_dwordx4 v4, s[12:15], s21 offen offset:0 lds
  buffer_load_dwordx4 v4, s[12:15], s21 offen offset:1024 lds
  buffer_load_dwordx4 v4, s[12:15], s21 offen offset:2048 lds
  buffer_load_dwordx4 v4, s[12:15], s21 offen offset:3072 lds
  s_add_u32 m0, s22, 28672
  s_add_u32 s21, s40, 28672
  buffer_load_dwordx4 v4, s[12:15], s21 offen offset:0 lds
  buffer_load_dwordx4 v4, s[12:15], s21 offen offset:1024 lds
  s_add_u32 s21, s40, 122880
  buffer_load_dwordx4 v[64:67], v4, s[12:15], s21 offen offset:0
  buffer_load_dwordx4 v[68:71], v4, s[12:15], s21 offen offset:1024
  buffer_load_dwordx4 v[72:75], v4, s[12:15], s21 offen offset:2048
  buffer_load_dwordx4 v[76:79], v4, s[12:15], s21 offen offset:3072
  s_add_u32 s21, s40, 126976
  buffer_load_dwordx4 v[80:83], v4, s[12:15], s21 offen offset:0
  buffer_load_dwordx4 v[84:87], v4, s[12:15], s21 offen offset:1024
  buffer_load_dwordx4 v[88:91], v4, s[12:15], s21 offen offset:2048
  buffer_load_dwordx4 v[92:95], v4, s[12:15], s21 offen offset:3072
  s_add_u32 s21, s40, 131072
  buffer_load_dwordx4 v[96:99], v4, s[12:15], s21 offen offset:0
  buffer_load_dwordx4 v[100:103], v4, s[12:15], s21 offen offset:1024
  buffer_load_dwordx4 v[104:107], v4, s[12:15], s21 offen offset:2048
  buffer_load_dwordx4 v[108:111], v4, s[12:15], s21 offen offset:3072
  s_add_u32 s21, s40, 135168
  buffer_load_dwordx4 v[112:115], v4, s[12:15], s21 offen offset:0
  buffer_load_dwordx4 v[116:119], v4, s[12:15], s21 offen offset:1024
  buffer_load_dwordx4 v[120:123], v4, s[12:15], s21 offen offset:2048
  buffer_load_dwordx4 v[124:127], v4, s[12:15], s21 offen offset:3072
  s_add_u32 s21, s40, 139264
  buffer_load_dwordx4 v[128:131], v4, s[12:15], s21 offen offset:0
  buffer_load_dwordx4 v[132:135], v4, s[12:15], s21 offen offset:1024
  buffer_load_dwordx4 v[136:139], v4, s[12:15], s21 offen offset:2048
  buffer_load_dwordx4 v[140:143], v4, s[12:15], s21 offen offset:3072
  s_add_u32 s21, s40, 143360
  buffer_load_dwordx4 v[144:147], v4, s[12:15], s21 offen offset:0
  buffer_load_dwordx4 v[148:151], v4, s[12:15], s21 offen offset:1024
  buffer_load_dwordx4 v[152:155], v4, s[12:15], s21 offen offset:2048
  buffer_load_dwordx4 v[156:159], v4, s[12:15], s21 offen offset:3072
  s_add_u32 s21, s40, 147456
  buffer_load_dwordx4 v[160:163], v4, s[12:15], s21 offen offset:0
  buffer_load_dwordx4 v[164:167], v4, s[12:15], s21 offen offset:1024
  buffer_load_dwordx4 v[168:171], v4, s[12:15], s21 offen offset:2048
  buffer_load_dwordx4 v[172:175], v4, s[12:15], s21 offen offset:3072
  s_add_u32 s21, s40, 151552
  buffer_load_dwordx4 v[176:179], v4, s[12:15], s21 offen offset:0
  buffer_load_dwordx4 v[180:183], v4, s[12:15], s21 offen offset:1024
  v_lshrrev_b32 v6, 2, v2
  v_lshl_add_u32 v6, v3, 2, v6
  v_mul_u32_u24 v6, 1280, v6
  v_and_b32 v7, 3, v2
  v_lshlrev_b32 v7, 3, v7
  s_mul_i32 s21, s20, 320
  v_add3_u32 v6, v6, v7, s21
  v_add_u32 v8, v6, v7
  v_add_u32 v7, 61440, v6
  v_add_u32 v9, 61440, v8
  v_add_u32 v5, s22, v4
  s_waitcnt vmcnt(30)
  s_load_dwordx2 s[36:37], s[0:1], 16
  s_lshl_b32 s23, s2, 2
  s_add_u32 s23, s23, s20
  s_mul_i32 s23, s23, 61440
  s_add_u32 s23, s23, 0
  s_waitcnt lgkmcnt(0)
  s_mov_b32 s24, s36
  s_mov_b32 s25, s37
  s_mov_b32 s26, 7864320
  s_mov_b32 s27, 0x00020000
  buffer_load_dwordx4 v[200:203], v4, s[24:27], s23 offen offset:0
  buffer_load_dwordx4 v[200:203], v4, s[24:27], s23 offen offset:1024
  buffer_load_dwordx4 v[200:203], v4, s[24:27], s23 offen offset:2048
  buffer_load_dwordx4 v[200:203], v4, s[24:27], s23 offen offset:3072
  s_add_u32 s23, s23, 4096
  buffer_load_dwordx4 v[200:203], v4, s[24:27], s23 offen offset:0
  buffer_load_dwordx4 v[200:203], v4, s[24:27], s23 offen offset:1024
  buffer_load_dwordx4 v[200:203], v4, s[24:27], s23 offen offset:2048
  buffer_load_dwordx4 v[200:203], v4, s[24:27], s23 offen offset:3072
  s_add_u32 s23, s23, 4096
  buffer_load_dwordx4 v[200:203], v4, s[24:27], s23 offen offset:0
  buffer_load_dwordx4 v[200:203], v4, s[24:27], s23 offen offset:1024
  buffer_load_dwordx4 v[200:203], v4, s[24:27], s23 offen offset:2048
  buffer_load_dwordx4 v[200:203], v4, s[24:27], s23 offen offset:3072
  s_add_u32 s23, s23, 4096
  buffer_load_dwordx4 v[200:203], v4, s[24:27], s23 offen offset:0
  buffer_load_dwordx4 v[200:203], v4, s[24:27], s23 offen offset:1024
  buffer_load_dwordx4 v[200:203], v4, s[24:27], s23 offen offset:2048
  buffer_load_dwordx4 v[200:203], v4, s[24:27], s23 offen offset:3072
  s_add_u32 s23, s23, 4096
  buffer_load_dwordx4 v[200:203], v4, s[24:27], s23 offen offset:0
  buffer_load_dwordx4 v[200:203], v4, s[24:27], s23 offen offset:1024
  buffer_load_dwordx4 v[200:203], v4, s[24:27], s23 offen offset:2048
  buffer_load_dwordx4 v[200:203], v4, s[24:27], s23 offen offset:3072
  s_add_u32 s23, s23, 4096
  buffer_load_dwordx4 v[200:203], v4, s[24:27], s23 offen offset:0
  buffer_load_dwordx4 v[200:203], v4, s[24:27], s23 offen offset:1024
  buffer_load_dwordx4 v[200:203], v4, s[24:27], s23 offen offset:2048
  buffer_load_dwordx4 v[200:203], v4, s[24:27], s23 offen offset:3072
  s_add_u32 s23, s23, 4096
  buffer_load_dwordx4 v[200:203], v4, s[24:27], s23 offen offset:0
  buffer_load_dwordx4 v[200:203], v4, s[24:27], s23 offen offset:1024
  buffer_load_dwordx4 v[200:203], v4, s[24:27], s23 offen offset:2048
  buffer_load_dwordx4 v[200:203], v4, s[24:27], s23 offen offset:3072
  s_add_u32 s23, s23, 4096
  buffer_load_dwordx4 v[200:203], v4, s[24:27], s23 offen offset:0
  buffer_load_dwordx4 v[200:203], v4, s[24:27], s23 offen offset:1024
  s_barrier
  ds_read_b64_tr_b16 a[0:1], v8 offset:0
  ds_read_b64_tr_b16 a[2:3], v8 offset:20480
  ds_read_b64_tr_b16 a[24:25], v8 offset:8
  ds_read_b64_tr_b16 a[26:27], v8 offset:20488
  ds_read_b64_tr_b16 a[48:49], v6 offset:64
  ds_read_b64_tr_b16 a[50:51], v6 offset:20544
  ds_read_b64_tr_b16 a[72:73], v8 offset:96
  ds_read_b64_tr_b16 a[74:75], v8 offset:20576
  ds_read_b64_tr_b16 a[96:97], v8 offset:104
  ds_read_b64_tr_b16 a[98:99], v8 offset:20584
  ds_read_b64_tr_b16 a[120:121], v8 offset:160
  ds_read_b64_tr_b16 a[122:123], v8 offset:20640
  ds_read_b64_tr_b16 a[144:145], v8 offset:168
  ds_read_b64_tr_b16 a[146:147], v8 offset:20648
  ds_read_b64_tr_b16 a[168:169], v6 offset:224
  ds_read_b64_tr_b16 a[170:171], v6 offset:20704
  ds_read_b64_tr_b16 a[192:193], v8 offset:256
  ds_read_b64_tr_b16 a[194:195], v8 offset:20736
  ds_read_b64_tr_b16 a[216:217], v8 offset:264
  ds_read_b64_tr_b16 a[218:219], v8 offset:20744
  ds_read_b64_tr_b16 a[4:5], v9 offset:0
  ds_read_b64_tr_b16 a[6:7], v9 offset:20480
  ds_read_b64_tr_b16 a[28:29], v9 offset:8
  ds_read_b64_tr_b16 a[30:31], v9 offset:20488
  ds_read_b64_tr_b16 a[52:53], v7 offset:64
  ds_read_b64_tr_b16 a[54:55], v7 offset:20544
  ds_read_b64_tr_b16 a[76:77], v9 offset:96
  ds_read_b64_tr_b16 a[78:79], v9 offset:20576
  ds_read_b64_tr_b16 a[100:101], v9 offset:104
  ds_read_b64_tr_b16 a[102:103], v9 offset:20584
  ds_read_b64_tr_b16 a[124:125], v9 offset:160
  ds_read_b64_tr_b16 a[126:127], v9 offset:20640
  ds_read_b64_tr_b16 a[148:149], v9 offset:168
  ds_read_b64_tr_b16 a[150:151], v9 offset:20648
  ds_read_b64_tr_b16 a[172:173], v7 offset:224
  ds_read_b64_tr_b16 a[174:175], v7 offset:20704
  ds_read_b64_tr_b16 a[196:197], v9 offset:256
  ds_read_b64_tr_b16 a[198:199], v9 offset:20736
  ds_read_b64_tr_b16 a[220:221], v9 offset:264
  ds_read_b64_tr_b16 a[222:223], v9 offset:20744
  ds_read_b64_tr_b16 a[8:9], v8 offset:40960
  ds_read_b64_tr_b16 a[10:11], v9 offset:40960
  ds_read_b64_tr_b16 a[32:33], v8 offset:40968
  ds_read_b64_tr_b16 a[34:35], v9 offset:40968
  ds_read_b64_tr_b16 a[56:57], v6 offset:41024
  ds_read_b64_tr_b16 a[58:59], v7 offset:41024
  ds_read_b64_tr_b16 a[80:81], v8 offset:41056
  ds_read_b64_tr_b16 a[82:83], v9 offset:41056
  ds_read_b64_tr_b16 a[104:105], v8 offset:41064
  ds_read_b64_tr_b16 a[106:107], v9 offset:41064
  ds_read_b64_tr_b16 a[128:129], v8 offset:41120
  ds_read_b64_tr_b16 a[130:131], v9 offset:41120
  ds_read_b64_tr_b16 a[152:153], v8 offset:41128
  ds_read_b64_tr_b16 a[154:155], v9 offset:41128
  ds_read_b64_tr_b16 a[176:177], v6 offset:41184
  ds_read_b64_tr_b16 a[178:179], v7 offset:41184
  ds_read_b64_tr_b16 a[200:201], v8 offset:41216
  ds_read_b64_tr_b16 a[202:203], v9 offset:41216
  ds_read_b64_tr_b16 a[224:225], v8 offset:41224
  ds_read_b64_tr_b16 a[226:227], v9 offset:41224
  s_waitcnt lgkmcnt(0)
  s_barrier
  s_waitcnt vmcnt(30)
  ds_write_b128 v5, v[64:67] offset:0
  ds_write_b128 v5, v[68:71] offset:1024
  ds_write_b128 v5, v[72:75] offset:2048
  ds_write_b128 v5, v[76:79] offset:3072
  ds_write_b128 v5, v[80:83] offset:4096
  ds_write_b128 v5, v[84:87] offset:5120
  ds_write_b128 v5, v[88:91] offset:6144
  ds_write_b128 v5, v[92:95] offset:7168
  ds_write_b128 v5, v[96:99] offset:8192
  ds_write_b128 v5, v[100:103] offset:9216
  ds_write_b128 v5, v[104:107] offset:10240
  ds_write_b128 v5, v[108:111] offset:11264
  ds_write_b128 v5, v[112:115] offset:12288
  ds_write_b128 v5, v[116:119] offset:13312
  ds_write_b128 v5, v[120:123] offset:14336
  ds_write_b128 v5, v[124:127] offset:15360
  ds_write_b128 v5, v[128:131] offset:16384
  ds_write_b128 v5, v[132:135] offset:17408
  ds_write_b128 v5, v[136:139] offset:18432
  ds_write_b128 v5, v[140:143] offset:19456
  ds_write_b128 v5, v[144:147] offset:20480
  ds_write_b128 v5, v[148:151] offset:21504
  ds_write_b128 v5, v[152:155] offset:22528
  ds_write_b128 v5, v[156:159] offset:23552
  ds_write_b128 v5, v[160:163] offset:24576
  ds_write_b128 v5, v[164:167] offset:25600
  ds_write_b128 v5, v[168:171] offset:26624
  ds_write_b128 v5, v[172:175] offset:27648
  ds_write_b128 v5, v[176:179] offset:28672
  ds_write_b128 v5, v[180:183] offset:29696
  s_waitcnt lgkmcnt(0)
  s_barrier
  ds_read_b64_tr_b16 a[12:13], v8 offset:0
  ds_read_b64_tr_b16 a[14:15], v8 offset:20480
  ds_read_b64_tr_b16 a[36:37], v8 offset:8
  ds_read_b64_tr_b16 a[38:39], v8 offset:20488
  ds_read_b64_tr_b16 a[60:61], v6 offset:64
  ds_read_b64_tr_b16 a[62:63], v6 offset:20544
  ds_read_b64_tr_b16 a[84:85], v8 offset:96
  ds_read_b64_tr_b16 a[86:87], v8 offset:20576
  ds_read_b64_tr_b16 a[108:109], v8 offset:104
  ds_read_b64_tr_b16 a[110:111], v8 offset:20584
  ds_read_b64_tr_b16 a[132:133], v8 offset:160
  ds_read_b64_tr_b16 a[134:135], v8 offset:20640
  ds_read_b64_tr_b16 a[156:157], v8 offset:168
  ds_read_b64_tr_b16 a[158:159], v8 offset:20648
  ds_read_b64_tr_b16 a[180:181], v6 offset:224
  ds_read_b64_tr_b16 a[182:183], v6 offset:20704
  ds_read_b64_tr_b16 a[204:205], v8 offset:256
  ds_read_b64_tr_b16 a[206:207], v8 offset:20736
  ds_read_b64_tr_b16 a[228:229], v8 offset:264
  ds_read_b64_tr_b16 a[230:231], v8 offset:20744
  ds_read_b64_tr_b16 a[16:17], v9 offset:0
  ds_read_b64_tr_b16 a[18:19], v9 offset:20480
  ds_read_b64_tr_b16 a[40:41], v9 offset:8
  ds_read_b64_tr_b16 a[42:43], v9 offset:20488
  ds_read_b64_tr_b16 a[64:65], v7 offset:64
  ds_read_b64_tr_b16 a[66:67], v7 offset:20544
  ds_read_b64_tr_b16 a[88:89], v9 offset:96
  ds_read_b64_tr_b16 a[90:91], v9 offset:20576
  ds_read_b64_tr_b16 a[112:113], v9 offset:104
  ds_read_b64_tr_b16 a[114:115], v9 offset:20584
  ds_read_b64_tr_b16 a[136:137], v9 offset:160
  ds_read_b64_tr_b16 a[138:139], v9 offset:20640
  ds_read_b64_tr_b16 a[160:161], v9 offset:168
  ds_read_b64_tr_b16 a[162:163], v9 offset:20648
  ds_read_b64_tr_b16 a[184:185], v7 offset:224
  ds_read_b64_tr_b16 a[186:187], v7 offset:20704
  ds_read_b64_tr_b16 a[208:209], v9 offset:256
  ds_read_b64_tr_b16 a[210:211], v9 offset:20736
  ds_read_b64_tr_b16 a[232:233], v9 offset:264
  ds_read_b64_tr_b16 a[234:235], v9 offset:20744
  ds_read_b64_tr_b16 a[20:21], v8 offset:40960
  ds_read_b64_tr_b16 a[22:23], v9 offset:40960
  ds_read_b64_tr_b16 a[44:45], v8 offset:40968
  ds_read_b64_tr_b16 a[46:47], v9 offset:40968
  ds_read_b64_tr_b16 a[68:69], v6 offset:41024
  ds_read_b64_tr_b16 a[70:71], v7 offset:41024
  ds_read_b64_tr_b16 a[92:93], v8 offset:41056
  ds_read_b64_tr_b16 a[94:95], v9 offset:41056
  ds_read_b64_tr_b16 a[116:117], v8 offset:41064
  ds_read_b64_tr_b16 a[118:119], v9 offset:41064
  ds_read_b64_tr_b16 a[140:141], v8 offset:41120
  ds_read_b64_tr_b16 a[142:143], v9 offset:41120
  ds_read_b64_tr_b16 a[164:165], v8 offset:41128
  ds_read_b64_tr_b16 a[166:167], v9 offset:41128
  ds_read_b64_tr_b16 a[188:189], v6 offset:41184
  ds_read_b64_tr_b16 a[190:191], v7 offset:41184
  ds_read_b64_tr_b16 a[212:213], v8 offset:41216
  ds_read_b64_tr_b16 a[214:215], v9 offset:41216
  ds_read_b64_tr_b16 a[236:237], v8 offset:41224
  ds_read_b64_tr_b16 a[238:239], v9 offset:41224
  s_waitcnt lgkmcnt(0)
  s_barrier
  s_load_dwordx2 s[32:33], s[0:1], 96
  s_waitcnt lgkmcnt(0)
  s_mov_b32 s32, s32
  s_mov_b32 s33, s33
  s_mov_b32 s34, 256
  s_mov_b32 s35, 0x00020000
  s_mov_b32 s21, 76
  v_mov_b32 v4, 0
  s_mov_b32 s101, 0
wf_243:
  buffer_load_dword v5, v4, s[32:35], s21 offen sc1
  s_add_u32 s101, s101, 1
  s_cmp_gt_u32 s101, 131072
  s_cbranch_scc1 main_end
  s_waitcnt vmcnt(0)
  v_readfirstlane_b32 s100, v5
  s_cmp_ge_u32 s100, 1
  s_cbranch_scc1 wf_244
  s_sleep 8
  s_branch wf_243
wf_244:
  s_sub_u32 s80, s100, 1
  s_lshl_b32 s80, s80, 13
  s_lshl_b32 s40, s2, 2
  s_add_u32 s40, s40, s20
  s_lshl_b32 s40, s40, 14
  s_xor_b32 s40, s40, s80
  s_xor_b32 s40, s40, 8192
  s_mul_i32 s47, s20, 3072
  s_lshr_b32 s43, s2, 2
  s_lshl_b32 s43, s43, 7
  s_add_u32 s43, s43, 28672
  s_xor_b32 s43, s43, s80
  s_lshl_b32 s44, s2, 7
  s_lshl_b32 s21, s20, 2
  s_add_u32 s44, s44, s21
  s_add_u32 s44, s44, 4096
  s_xor_b32 s44, s44, s80
  s_lshl_b32 s49, s20, 8
  s_add_u32 s49, s49, 12288
  s_mov_b32 s45, 0
  v_lshlrev_b32 v4, 4, v1
  v_min_u32 v14, 18, v1
  v_lshlrev_b32 v14, 2, v14
  v_mov_b32 v17, 1073741824
  v_cmp_eq_u32 vcc, 0, v1
  s_nop 1
  v_cndmask_b32 v17, v17, 0, vcc
  v_mov_b32 v16, 0
  v_mov_b32 v18, 65536
vwr_245:
  s_cmp_lg_u32 s20, 0
  s_cbranch_scc1 vwr_248
  s_mov_b32 s101, 0
  s_branch vwr_247
vwr_246:
  s_cmp_lg_u32 s101, 1
  s_cbranch_scc1 vwr_249
  buffer_store_dword v16, v17, s[72:75], s44 offen sc1
vwr_249:
  s_sleep 4
vwr_247:
  buffer_load_dword v15, v14, s[72:75], s43 offen sc1
  s_add_u32 s101, s101, 1
  s_cmp_gt_u32 s101, 131072
  s_cbranch_scc1 main_end
  s_waitcnt vmcnt(0)
  v_cmp_le_u32 vcc, 8, v15
  s_nop 1
  s_ff0_i32_b32 s21, vcc_lo
  s_min_u32 s21, s21, 19
  s_lshl_b32 s22, s21, 1
  s_lshl_b32 s21, s21, 2
  s_sub_i32 s21, s21, 12
  s_max_i32 s46, s21, s22
  s_cmp_le_u32 s46, s45
  s_cbranch_scc1 vwr_246
  v_mov_b32 v15, s46
  ds_write_b32 v18, v15
  s_waitcnt lgkmcnt(0)
  s_barrier
  s_branch vwr_250
vwr_248:
  s_waitcnt vmcnt(0)
  buffer_store_dword v16, v17, s[72:75], s44 offen sc1
  s_barrier
  ds_read_b32 v15, v18
  s_waitcnt lgkmcnt(0)
  v_readfirstlane_b32 s46, v15
vwr_250:
  s_and_b32 s50, s45, 2
  s_lshl_b32 s50, s50, 14
  v_add_u32 v10, s50, v4
  v_add_u32 v11, 2048, v10
  v_add_u32 v12, 2056, v10
  v_lshl_add_u32 v13, v1, 2, s50
  s_lshl_b32 s41, s45, 21
  s_add_u32 s41, s41, s40
  s_mov_b32 s48, s45
  s_mov_b32 s56, s41
  s_add_u32 s57, s56, 4096
  s_lshl_b32 s58, s45, 19
  s_lshl_b32 s21, s45, 11
  s_and_b32 s21, s21, 8192
  s_xor_b32 s21, s21, s80
  s_add_u32 s58, s58, s21
  s_add_u32 s58, s58, 136314880
  s_lshl_b32 s21, s2, 14
  s_lshl_b32 s22, s20, 11
  s_add_u32 s21, s21, s22
  s_add_u32 s58, s58, s21
  s_and_b32 s21, s2, 28
  s_add_u32 s21, s21, s20
  s_lshl_b32 s21, s21, 16
  s_and_b32 s22, s2, 3
  s_lshl_b32 s22, s22, 10
  s_add_u32 s21, s21, s22
  s_lshl_b32 s60, s45, 21
  s_add_u32 s60, s60, s21
  s_add_u32 s60, s60, s80
  s_add_u32 s60, s60, -2093056
  s_xor_b32 s60, s60, 8192
  s_mov_b32 s51, 1073741824
  s_mov_b32 s59, 1073741824
  s_mov_b32 s52, s50
  s_cmp_lt_u32 s48, s46
  s_cselect_b32 s53, s41, 1073741824
  s_add_u32 s54, s52, 0
  s_add_u32 m0, s54, s47
  s_nop 0
  buffer_load_dwordx4 v4, s[16:19], s53 offen offset:0 sc1 lds
  buffer_load_dwordx4 v4, s[16:19], s53 offen offset:1024 sc1 lds
  buffer_load_dwordx4 v4, s[16:19], s53 offen offset:2048 sc1 lds
  s_nop 0
  s_add_u32 m0, s54, s49
  s_nop 0
  buffer_load_dword v14, s[72:75], s43 offen sc1 lds
  s_add_u32 s41, s41, 2097152
  s_xor_b32 s41, s41, 8192
  s_add_u32 s48, s48, 1
  s_cmp_lt_u32 s48, s46
  s_cselect_b32 s53, s41, 1073741824
  s_add_u32 s54, s52, 16384
  s_add_u32 m0, s54, s47
  s_nop 0
  buffer_load_dwordx4 v4, s[16:19], s53 offen offset:0 sc1 lds
  buffer_load_dwordx4 v4, s[16:19], s53 offen offset:1024 sc1 lds
  buffer_load_dwordx4 v4, s[16:19], s53 offen offset:2048 sc1 lds
  s_nop 0
  s_add_u32 m0, s54, s49
  s_nop 0
  buffer_load_dword v14, s[72:75], s43 offen sc1 lds
  s_add_u32 s41, s41, 2097152
  s_xor_b32 s41, s41, 8192
  s_add_u32 s48, s48, 1
  s_xor_b32 s52, s52, 32768
  s_waitcnt vmcnt(0)
  s_barrier
  ds_read_b32 v15, v13 offset:28672
  ds_read_b128 v[64:67], v10 offset:0
  ds_read_b128 v[88:91], v10 offset:1024
  ds_read_b128 v[68:71], v10 offset:3072
  ds_read_b128 v[92:95], v10 offset:4096
  ds_read2st64_b64 v[72:75], v11 offset0:0 offset1:6
  ds_read2st64_b64 v[96:99], v12 offset0:0 offset1:6
  ds_read_b128 v[76:79], v10 offset:6144
  ds_read_b128 v[100:103], v10 offset:7168
  ds_read_b128 v[80:83], v10 offset:9216
  ds_read_b128 v[104:107], v10 offset:10240
  ds_read2st64_b64 v[84:87], v11 offset0:12 offset1:18
  ds_read2st64_b64 v[108:111], v12 offset0:12 offset1:18
  s_waitcnt lgkmcnt(12)
  v_cmp_le_u32 vcc, 8, v15
  s_nop 1
  s_ff0_i32_b32 s21, vcc_lo
  s_min_u32 s21, s21, 19
  s_lshl_b32 s22, s21, 1
  s_lshl_b32 s21, s21, 2
  s_sub_i32 s21, s21, 12
  s_max_i32 s21, s21, s22
  s_max_u32 s46, s21, s46
  s_cmp_lt_u32 s48, s46
  s_cselect_b32 s53, s41, 1073741824
  s_add_u32 s54, s52, 0
  s_add_u32 m0, s54, s47
  s_nop 0
  buffer_load_dwordx4 v4, s[16:19], s53 offen offset:0 sc1 lds
  buffer_load_dwordx4 v4, s[16:19], s53 offen offset:1024 sc1 lds
  buffer_load_dwordx4 v4, s[16:19], s53 offen offset:2048 sc1 lds
  s_nop 0
  s_add_u32 m0, s54, s49
  s_nop 0
  buffer_load_dword v14, s[72:75], s43 offen sc1 lds
  s_add_u32 s41, s41, 2097152
  s_xor_b32 s41, s41, 8192
  s_add_u32 s48, s48, 1
  buffer_store_dword v16, v17, s[72:75], s44 offen sc1
  s_waitcnt lgkmcnt(0)
  .p2align 3
vwl_251:
  v_mfma_f32_16x16x32_bf16 v[160:163], v[64:67], a[0:3], 0
  v_mfma_f32_16x16x32_bf16 v[164:167], v[88:91], a[0:3], 0
  v_mfma_f32_16x16x32_bf16 v[160:163], v[68:71], a[4:7], v[160:163]
  s_add_u32 s60, s60, 2097152
  s_xor_b32 s60, s60, 8192
  s_sub_u32 s62, s60, 0
  v_mfma_f32_16x16x32_bf16 v[164:167], v[92:95], a[4:7], v[164:167]
  s_cmp_ge_u32 s62, 125829120
  s_cselect_b32 s62, 1073741824, s60
  v_cvt_pk_bf16_f32 v204, v184, v185
  v_mfma_f32_16x16x32_bf16 v[160:163], v[72:75], a[8:11], v[160:163]
  v_cvt_pk_bf16_f32 v205, v186, v187
  v_cvt_pk_bf16_f32 v206, v188, v189
  v_mfma_f32_16x16x32_bf16 v[164:167], v[96:99], a[8:11], v[164:167]
  v_cvt_pk_bf16_f32 v207, v190, v191
  buffer_store_dwordx4 v[204:207], v4, s[16:19], s51 offen offset:3072 sc1
  v_mfma_f32_16x16x32_bf16 v[160:163], v[76:79], a[12:15], v[160:163]
  v_mfma_f32_16x16x32_bf16 v[164:167], v[100:103], a[12:15], v[164:167]
  s_waitcnt vmcnt(30)
  s_barrier
  ds_read_b32 v15, v13 offset:28672
  v_mfma_f32_16x16x32_bf16 v[160:163], v[80:83], a[16:19], v[160:163]
  ds_read_b128 v[112:115], v10 offset:16384
  v_mfma_f32_16x16x32_bf16 v[164:167], v[104:107], a[16:19], v[164:167]
  v_mfma_f32_16x16x32_bf16 v[160:163], v[84:87], a[20:23], v[160:163]
  ds_read_b128 v[136:139], v10 offset:17408
  v_mfma_f32_16x16x32_bf16 v[164:167], v[108:111], a[20:23], v[164:167]
  v_mfma_f32_16x16x32_bf16 v[168:171], v[64:67], a[24:27], 0
  ds_read_b128 v[116:119], v10 offset:19456
  v_mfma_f32_16x16x32_bf16 v[172:175], v[88:91], a[24:27], 0
  v_mfma_f32_16x16x32_bf16 v[168:171], v[68:71], a[28:31], v[168:171]
  v_cvt_pk_bf16_f32 v192, v160, v161
  v_cvt_pk_bf16_f32 v193, v162, v163
  v_mfma_f32_16x16x32_bf16 v[172:175], v[92:95], a[28:31], v[172:175]
  v_cvt_pk_bf16_f32 v194, v164, v165
  v_cvt_pk_bf16_f32 v195, v166, v167
  v_mfma_f32_16x16x32_bf16 v[168:171], v[72:75], a[32:35], v[168:171]
  buffer_store_dwordx4 v[192:195], v4, s[16:19], s56 offen offset:0 sc1
  ds_read_b128 v[140:143], v10 offset:20480
  v_mfma_f32_16x16x32_bf16 v[172:175], v[96:99], a[32:35], v[172:175]
  v_mfma_f32_16x16x32_bf16 v[168:171], v[76:79], a[36:39], v[168:171]
  ds_read2st64_b64 v[120:123], v11 offset0:32 offset1:38
  v_mfma_f32_16x16x32_bf16 v[172:175], v[100:103], a[36:39], v[172:175]
  v_mfma_f32_16x16x32_bf16 v[168:171], v[80:83], a[40:43], v[168:171]
  s_add_u32 s55, s62, 0
  ds_read2st64_b64 v[144:147], v12 offset0:32 offset1:38
  v_mfma_f32_16x16x32_bf16 v[172:175], v[104:107], a[40:43], v[172:175]
  buffer_store_dwordx4 v[192:195], v4, s[16:19], s55 offen sc1
  v_mfma_f32_16x16x32_bf16 v[168:171], v[84:87], a[44:47], v[168:171]
  ds_read_b128 v[124:127], v10 offset:22528
  v_mfma_f32_16x16x32_bf16 v[172:175], v[108:111], a[44:47], v[172:175]
  v_mfma_f32_16x16x32_bf16 v[176:179], v[64:67], a[48:51], 0
  ds_read_b128 v[148:151], v10 offset:23552
  v_mfma_f32_16x16x32_bf16 v[180:183], v[88:91], a[48:51], 0
  v_mfma_f32_16x16x32_bf16 v[176:179], v[68:71], a[52:55], v[176:179]
  v_cvt_pk_bf16_f32 v196, v168, v169
  v_cvt_pk_bf16_f32 v197, v170, v171
  v_mfma_f32_16x16x32_bf16 v[180:183], v[92:95], a[52:55], v[180:183]
  v_cvt_pk_bf16_f32 v198, v172, v173
  v_cvt_pk_bf16_f32 v199, v174, v175
  v_mfma_f32_16x16x32_bf16 v[176:179], v[72:75], a[56:59], v[176:179]
  buffer_store_dwordx4 v[196:199], v4, s[16:19], s56 offen offset:1024 sc1
  ds_read_b128 v[128:131], v10 offset:25600
  v_mfma_f32_16x16x32_bf16 v[180:183], v[96:99], a[56:59], v[180:183]
  v_mfma_f32_16x16x32_bf16 v[176:179], v[76:79], a[60:63], v[176:179]
  ds_read_b128 v[152:155], v10 offset:26624
  v_mfma_f32_16x16x32_bf16 v[180:183], v[100:103], a[60:63], v[180:183]
  v_mfma_f32_16x16x32_bf16 v[176:179], v[80:83], a[64:67], v[176:179]
  ds_read2st64_b64 v[132:135], v11 offset0:44 offset1:50
  v_mfma_f32_16x16x32_bf16 v[180:183], v[104:107], a[64:67], v[180:183]
  v_mfma_f32_16x16x32_bf16 v[176:179], v[84:87], a[68:71], v[176:179]
  ds_read2st64_b64 v[156:159], v12 offset0:44 offset1:50
  v_mfma_f32_16x16x32_bf16 v[180:183], v[108:111], a[68:71], v[180:183]
  v_mfma_f32_16x16x32_bf16 v[184:187], v[64:67], a[72:75], 0
  v_mfma_f32_16x16x32_bf16 v[188:191], v[88:91], a[72:75], 0
  s_waitcnt lgkmcnt(12)
  v_cmp_le_u32 vcc, 8, v15
  v_mfma_f32_16x16x32_bf16 v[184:187], v[68:71], a[76:79], v[184:187]
  v_cvt_pk_bf16_f32 v200, v176, v177
  v_cvt_pk_bf16_f32 v201, v178, v179
  v_mfma_f32_16x16x32_bf16 v[188:191], v[92:95], a[76:79], v[188:191]
  s_ff0_i32_b32 s21, vcc_lo
  v_cvt_pk_bf16_f32 v202, v180, v181
  v_cvt_pk_bf16_f32 v203, v182, v183
  v_mfma_f32_16x16x32_bf16 v[184:187], v[72:75], a[80:83], v[184:187]
  s_min_u32 s21, s21, 19
  buffer_store_dwordx4 v[200:203], v4, s[16:19], s58 offen offset:0 sc1
  s_lshl_b32 s22, s21, 1
  v_mfma_f32_16x16x32_bf16 v[188:191], v[96:99], a[80:83], v[188:191]
  s_lshl_b32 s21, s21, 2
  s_sub_i32 s21, s21, 12
  s_max_i32 s21, s21, s22
  v_mfma_f32_16x16x32_bf16 v[184:187], v[76:79], a[84:87], v[184:187]
  s_max_u32 s42, s21, s46
  s_cmp_ge_u32 s46, s48
  s_cselect_b32 s46, s42, s46
  v_mfma_f32_16x16x32_bf16 v[188:191], v[100:103], a[84:87], v[188:191]
  s_cmp_lt_u32 s48, s46
  s_cselect_b32 s53, s41, 1073741824
  s_add_u32 s54, s52, 16384
  v_mfma_f32_16x16x32_bf16 v[184:187], v[80:83], a[88:91], v[184:187]
  s_add_u32 m0, s54, s47
  v_mfma_f32_16x16x32_bf16 v[188:191], v[104:107], a[88:91], v[188:191]
  buffer_load_dwordx4 v4, s[16:19], s53 offen offset:0 sc1 lds
  buffer_load_dwordx4 v4, s[16:19], s53 offen offset:1024 sc1 lds
  v_mfma_f32_16x16x32_bf16 v[184:187], v[84:87], a[92:95], v[184:187]
  buffer_load_dwordx4 v4, s[16:19], s53 offen offset:2048 sc1 lds
  v_mfma_f32_16x16x32_bf16 v[188:191], v[108:111], a[92:95], v[188:191]
  s_add_u32 m0, s54, s49
  v_mfma_f32_16x16x32_bf16 v[160:163], v[64:67], a[96:99], 0
  buffer_load_dword v14, s[72:75], s43 offen sc1 lds
  s_add_u32 s41, s41, 2097152
  v_mfma_f32_16x16x32_bf16 v[164:167], v[88:91], a[96:99], 0
  s_xor_b32 s41, s41, 8192
  s_add_u32 s48, s48, 1
  v_mfma_f32_16x16x32_bf16 v[160:163], v[68:71], a[100:103], v[160:163]
  v_cvt_pk_bf16_f32 v204, v184, v185
  v_cvt_pk_bf16_f32 v205, v186, v187
  v_mfma_f32_16x16x32_bf16 v[164:167], v[92:95], a[100:103], v[164:167]
  v_cvt_pk_bf16_f32 v206, v188, v189
  v_cvt_pk_bf16_f32 v207, v190, v191
  v_mfma_f32_16x16x32_bf16 v[160:163], v[72:75], a[104:107], v[160:163]
  buffer_store_dwordx4 v[204:207], v4, s[16:19], s56 offen offset:2048 sc1
  v_mfma_f32_16x16x32_bf16 v[164:167], v[96:99], a[104:107], v[164:167]
  v_mfma_f32_16x16x32_bf16 v[160:163], v[76:79], a[108:111], v[160:163]
  v_mfma_f32_16x16x32_bf16 v[164:167], v[100:103], a[108:111], v[164:167]
  v_mfma_f32_16x16x32_bf16 v[160:163], v[80:83], a[112:115], v[160:163]
  s_add_u32 s55, s62, 16384
  v_mfma_f32_16x16x32_bf16 v[164:167], v[104:107], a[112:115], v[164:167]
  buffer_store_dwordx4 v[204:207], v4, s[16:19], s55 offen sc1
  v_mfma_f32_16x16x32_bf16 v[160:163], v[84:87], a[116:119], v[160:163]
  v_mfma_f32_16x16x32_bf16 v[164:167], v[108:111], a[116:119], v[164:167]
  v_mfma_f32_16x16x32_bf16 v[168:171], v[64:67], a[120:123], 0
  v_mfma_f32_16x16x32_bf16 v[172:175], v[88:91], a[120:123], 0
  v_mfma_f32_16x16x32_bf16 v[168:171], v[68:71], a[124:127], v[168:171]
  v_cvt_pk_bf16_f32 v192, v160, v161
  v_cvt_pk_bf16_f32 v193, v162, v163
  v_mfma_f32_16x16x32_bf16 v[172:175], v[92:95], a[124:127], v[172:175]
  v_cvt_pk_bf16_f32 v194, v164, v165
  v_cvt_pk_bf16_f32 v195, v166, v167
  v_mfma_f32_16x16x32_bf16 v[168:171], v[72:75], a[128:131], v[168:171]
  buffer_store_dwordx4 v[192:195], v4, s[16:19], s56 offen offset:3072 sc1
  v_mfma_f32_16x16x32_bf16 v[172:175], v[96:99], a[128:131], v[172:175]
  v_mfma_f32_16x16x32_bf16 v[168:171], v[76:79], a[132:135], v[168:171]
  v_mfma_f32_16x16x32_bf16 v[172:175], v[100:103], a[132:135], v[172:175]
  v_mfma_f32_16x16x32_bf16 v[168:171], v[80:83], a[136:139], v[168:171]
  v_mfma_f32_16x16x32_bf16 v[172:175], v[104:107], a[136:139], v[172:175]
  v_mfma_f32_16x16x32_bf16 v[168:171], v[84:87], a[140:143], v[168:171]
  v_mfma_f32_16x16x32_bf16 v[172:175], v[108:111], a[140:143], v[172:175]
  v_mfma_f32_16x16x32_bf16 v[176:179], v[64:67], a[144:147], 0
  v_mfma_f32_16x16x32_bf16 v[180:183], v[88:91], a[144:147], 0
  v_mfma_f32_16x16x32_bf16 v[176:179], v[68:71], a[148:151], v[176:179]
  v_cvt_pk_bf16_f32 v196, v168, v169
  v_cvt_pk_bf16_f32 v197, v170, v171
  v_mfma_f32_16x16x32_bf16 v[180:183], v[92:95], a[148:151], v[180:183]
  v_cvt_pk_bf16_f32 v198, v172, v173
  v_cvt_pk_bf16_f32 v199, v174, v175
  v_mfma_f32_16x16x32_bf16 v[176:179], v[72:75], a[152:155], v[176:179]
  buffer_store_dwordx4 v[196:199], v4, s[16:19], s57 offen offset:0 sc1
  v_mfma_f32_16x16x32_bf16 v[180:183], v[96:99], a[152:155], v[180:183]
  v_mfma_f32_16x16x32_bf16 v[176:179], v[76:79], a[156:159], v[176:179]
  v_mfma_f32_16x16x32_bf16 v[180:183], v[100:103], a[156:159], v[180:183]
  v_mfma_f32_16x16x32_bf16 v[176:179], v[80:83], a[160:163], v[176:179]
  s_add_u32 s55, s62, 32768
  v_mfma_f32_16x16x32_bf16 v[180:183], v[104:107], a[160:163], v[180:183]
  buffer_store_dwordx4 v[196:199], v4, s[16:19], s55 offen sc1
  v_mfma_f32_16x16x32_bf16 v[176:179], v[84:87], a[164:167], v[176:179]
  v_mfma_f32_16x16x32_bf16 v[180:183], v[108:111], a[164:167], v[180:183]
  v_mfma_f32_16x16x32_bf16 v[184:187], v[64:67], a[168:171], 0
  v_mfma_f32_16x16x32_bf16 v[188:191], v[88:91], a[168:171], 0
  v_mfma_f32_16x16x32_bf16 v[184:187], v[68:71], a[172:175], v[184:187]
  v_cvt_pk_bf16_f32 v200, v176, v177
  v_cvt_pk_bf16_f32 v201, v178, v179
  v_mfma_f32_16x16x32_bf16 v[188:191], v[92:95], a[172:175], v[188:191]
  v_cvt_pk_bf16_f32 v202, v180, v181
  v_cvt_pk_bf16_f32 v203, v182, v183
  v_mfma_f32_16x16x32_bf16 v[184:187], v[72:75], a[176:179], v[184:187]
  buffer_store_dwordx4 v[200:203], v4, s[16:19], s57 offen offset:1024 sc1
  v_mfma_f32_16x16x32_bf16 v[188:191], v[96:99], a[176:179], v[188:191]
  v_mfma_f32_16x16x32_bf16 v[184:187], v[76:79], a[180:183], v[184:187]
  v_mfma_f32_16x16x32_bf16 v[188:191], v[100:103], a[180:183], v[188:191]
  v_mfma_f32_16x16x32_bf16 v[184:187], v[80:83], a[184:187], v[184:187]
  v_mfma_f32_16x16x32_bf16 v[188:191], v[104:107], a[184:187], v[188:191]
  v_mfma_f32_16x16x32_bf16 v[184:187], v[84:87], a[188:191], v[184:187]
  v_mfma_f32_16x16x32_bf16 v[188:191], v[108:111], a[188:191], v[188:191]
  v_mfma_f32_16x16x32_bf16 v[160:163], v[64:67], a[192:195], 0
  s_min_u32 s21, s45, 56
  v_mov_b32 v16, s21
  s_waitcnt vmcnt(14)
  v_mfma_f32_16x16x32_bf16 v[164:167], v[88:91], a[192:195], 0
  buffer_store_dword v16, v17, s[72:75], s44 offen sc1
  v_mfma_f32_16x16x32_bf16 v[160:163], v[68:71], a[196:199], v[160:163]
  v_cvt_pk_bf16_f32 v204, v184, v185
  v_cvt_pk_bf16_f32 v205, v186, v187
  v_mfma_f32_16x16x32_bf16 v[164:167], v[92:95], a[196:199], v[164:167]
  v_cvt_pk_bf16_f32 v206, v188, v189
  v_cvt_pk_bf16_f32 v207, v190, v191
  v_mfma_f32_16x16x32_bf16 v[160:163], v[72:75], a[200:203], v[160:163]
  buffer_store_dwordx4 v[204:207], v4, s[16:19], s58 offen offset:1024 sc1
  v_mfma_f32_16x16x32_bf16 v[164:167], v[96:99], a[200:203], v[164:167]
  v_mfma_f32_16x16x32_bf16 v[160:163], v[76:79], a[204:207], v[160:163]
  s_add_u32 s56, s56, 2097152
  s_xor_b32 s56, s56, 8192
  s_add_u32 s59, s58, 524288
  v_mfma_f32_16x16x32_bf16 v[164:167], v[100:103], a[204:207], v[164:167]
  s_xor_b32 s58, s58, s59
  s_lshr_b32 s58, s58, 8
  s_and_b32 s58, s58, 8192
  v_mfma_f32_16x16x32_bf16 v[160:163], v[80:83], a[208:211], v[160:163]
  s_xor_b32 s58, s58, s59
  v_mfma_f32_16x16x32_bf16 v[164:167], v[104:107], a[208:211], v[164:167]
  v_mfma_f32_16x16x32_bf16 v[160:163], v[84:87], a[212:215], v[160:163]
  v_mfma_f32_16x16x32_bf16 v[164:167], v[108:111], a[212:215], v[164:167]
  v_mfma_f32_16x16x32_bf16 v[168:171], v[64:67], a[216:219], 0
  v_mfma_f32_16x16x32_bf16 v[172:175], v[88:91], a[216:219], 0
  v_mfma_f32_16x16x32_bf16 v[168:171], v[68:71], a[220:223], v[168:171]
  v_cvt_pk_bf16_f32 v192, v160, v161
  v_cvt_pk_bf16_f32 v193, v162, v163
  v_mfma_f32_16x16x32_bf16 v[172:175], v[92:95], a[220:223], v[172:175]
  v_cvt_pk_bf16_f32 v194, v164, v165
  v_cvt_pk_bf16_f32 v195, v166, v167
  v_mfma_f32_16x16x32_bf16 v[168:171], v[72:75], a[224:227], v[168:171]
  buffer_store_dwordx4 v[192:195], v4, s[16:19], s57 offen offset:2048 sc1
  v_mfma_f32_16x16x32_bf16 v[172:175], v[96:99], a[224:227], v[172:175]
  s_add_u32 s55, s62, 49152
  v_mfma_f32_16x16x32_bf16 v[168:171], v[76:79], a[228:231], v[168:171]
  buffer_store_dwordx4 v[192:195], v4, s[16:19], s55 offen sc1
  s_mov_b32 s51, s57
  v_mfma_f32_16x16x32_bf16 v[172:175], v[100:103], a[228:231], v[172:175]
  s_add_u32 s57, s56, 4096
  s_add_u32 s45, s45, 1
  v_mfma_f32_16x16x32_bf16 v[168:171], v[80:83], a[232:235], v[168:171]
  v_mfma_f32_16x16x32_bf16 v[172:175], v[104:107], a[232:235], v[172:175]
  v_mfma_f32_16x16x32_bf16 v[168:171], v[84:87], a[236:239], v[168:171]
  v_mfma_f32_16x16x32_bf16 v[172:175], v[108:111], a[236:239], v[172:175]
  s_waitcnt lgkmcnt(0)
  v_mfma_f32_16x16x32_bf16 v[176:179], v[112:115], a[0:3], 0
  v_mfma_f32_16x16x32_bf16 v[180:183], v[136:139], a[0:3], 0
  v_mfma_f32_16x16x32_bf16 v[176:179], v[116:119], a[4:7], v[176:179]
  v_cvt_pk_bf16_f32 v196, v168, v169
  v_cvt_pk_bf16_f32 v197, v170, v171
  v_mfma_f32_16x16x32_bf16 v[180:183], v[140:143], a[4:7], v[180:183]
  s_add_u32 s60, s60, 2097152
  v_cvt_pk_bf16_f32 v198, v172, v173
  v_cvt_pk_bf16_f32 v199, v174, v175
  v_mfma_f32_16x16x32_bf16 v[176:179], v[120:123], a[8:11], v[176:179]
  s_xor_b32 s60, s60, 8192
  buffer_store_dwordx4 v[196:199], v4, s[16:19], s51 offen offset:3072 sc1
  s_sub_u32 s62, s60, 0
  v_mfma_f32_16x16x32_bf16 v[180:183], v[144:147], a[8:11], v[180:183]
  s_cmp_ge_u32 s62, 125829120
  s_cselect_b32 s62, 1073741824, s60
  v_mfma_f32_16x16x32_bf16 v[176:179], v[124:127], a[12:15], v[176:179]
  v_mfma_f32_16x16x32_bf16 v[180:183], v[148:151], a[12:15], v[180:183]
  s_waitcnt vmcnt(20)
  s_barrier
  v_xor_b32 v10, 32768, v10
  v_mfma_f32_16x16x32_bf16 v[176:179], v[128:131], a[16:19], v[176:179]
  v_xor_b32 v11, 32768, v11
  v_xor_b32 v12, 32768, v12
  v_mfma_f32_16x16x32_bf16 v[180:183], v[152:155], a[16:19], v[180:183]
  v_xor_b32 v13, 32768, v13
  ds_read_b32 v15, v13 offset:12288
  v_mfma_f32_16x16x32_bf16 v[176:179], v[132:135], a[20:23], v[176:179]
  ds_read_b128 v[64:67], v10 offset:0
  v_mfma_f32_16x16x32_bf16 v[180:183], v[156:159], a[20:23], v[180:183]
  v_mfma_f32_16x16x32_bf16 v[184:187], v[112:115], a[24:27], 0
  ds_read_b128 v[88:91], v10 offset:1024
  v_mfma_f32_16x16x32_bf16 v[188:191], v[136:139], a[24:27], 0
  v_mfma_f32_16x16x32_bf16 v[184:187], v[116:119], a[28:31], v[184:187]
  v_cvt_pk_bf16_f32 v200, v176, v177
  v_cvt_pk_bf16_f32 v201, v178, v179
  v_mfma_f32_16x16x32_bf16 v[188:191], v[140:143], a[28:31], v[188:191]
  v_cvt_pk_bf16_f32 v202, v180, v181
  v_cvt_pk_bf16_f32 v203, v182, v183
  v_mfma_f32_16x16x32_bf16 v[184:187], v[120:123], a[32:35], v[184:187]
  buffer_store_dwordx4 v[200:203], v4, s[16:19], s56 offen offset:0 sc1
  ds_read_b128 v[68:71], v10 offset:3072
  v_mfma_f32_16x16x32_bf16 v[188:191], v[144:147], a[32:35], v[188:191]
  v_mfma_f32_16x16x32_bf16 v[184:187], v[124:127], a[36:39], v[184:187]
  ds_read_b128 v[92:95], v10 offset:4096
  v_mfma_f32_16x16x32_bf16 v[188:191], v[148:151], a[36:39], v[188:191]
  v_mfma_f32_16x16x32_bf16 v[184:187], v[128:131], a[40:43], v[184:187]
  s_add_u32 s55, s62, 0
  ds_read2st64_b64 v[72:75], v11 offset0:0 offset1:6
  v_mfma_f32_16x16x32_bf16 v[188:191], v[152:155], a[40:43], v[188:191]
  buffer_store_dwordx4 v[200:203], v4, s[16:19], s55 offen sc1
  v_mfma_f32_16x16x32_bf16 v[184:187], v[132:135], a[44:47], v[184:187]
  ds_read2st64_b64 v[96:99], v12 offset0:0 offset1:6
  v_mfma_f32_16x16x32_bf16 v[188:191], v[156:159], a[44:47], v[188:191]
  v_mfma_f32_16x16x32_bf16 v[160:163], v[112:115], a[48:51], 0
  ds_read_b128 v[76:79], v10 offset:6144
  v_mfma_f32_16x16x32_bf16 v[164:167], v[136:139], a[48:51], 0
  v_mfma_f32_16x16x32_bf16 v[160:163], v[116:119], a[52:55], v[160:163]
  v_cvt_pk_bf16_f32 v204, v184, v185
  v_cvt_pk_bf16_f32 v205, v186, v187
  v_mfma_f32_16x16x32_bf16 v[164:167], v[140:143], a[52:55], v[164:167]
  v_cvt_pk_bf16_f32 v206, v188, v189
  v_cvt_pk_bf16_f32 v207, v190, v191
  v_mfma_f32_16x16x32_bf16 v[160:163], v[120:123], a[56:59], v[160:163]
  buffer_store_dwordx4 v[204:207], v4, s[16:19], s56 offen offset:1024 sc1
  ds_read_b128 v[100:103], v10 offset:7168
  v_mfma_f32_16x16x32_bf16 v[164:167], v[144:147], a[56:59], v[164:167]
  v_mfma_f32_16x16x32_bf16 v[160:163], v[124:127], a[60:63], v[160:163]
  ds_read_b128 v[80:83], v10 offset:9216
  v_mfma_f32_16x16x32_bf16 v[164:167], v[148:151], a[60:63], v[164:167]
  v_mfma_f32_16x16x32_bf16 v[160:163], v[128:131], a[64:67], v[160:163]
  ds_read_b128 v[104:107], v10 offset:10240
  v_mfma_f32_16x16x32_bf16 v[164:167], v[152:155], a[64:67], v[164:167]
  v_mfma_f32_16x16x32_bf16 v[160:163], v[132:135], a[68:71], v[160:163]
  ds_read2st64_b64 v[84:87], v11 offset0:12 offset1:18
  v_mfma_f32_16x16x32_bf16 v[164:167], v[156:159], a[68:71], v[164:167]
  v_mfma_f32_16x16x32_bf16 v[168:171], v[112:115], a[72:75], 0
  ds_read2st64_b64 v[108:111], v12 offset0:12 offset1:18
  v_mfma_f32_16x16x32_bf16 v[172:175], v[136:139], a[72:75], 0
  v_mfma_f32_16x16x32_bf16 v[168:171], v[116:119], a[76:79], v[168:171]
  v_cvt_pk_bf16_f32 v192, v160, v161
  v_cvt_pk_bf16_f32 v193, v162, v163
  v_mfma_f32_16x16x32_bf16 v[172:175], v[140:143], a[76:79], v[172:175]
  v_cvt_pk_bf16_f32 v194, v164, v165
  v_cvt_pk_bf16_f32 v195, v166, v167
  v_mfma_f32_16x16x32_bf16 v[168:171], v[120:123], a[80:83], v[168:171]
  buffer_store_dwordx4 v[192:195], v4, s[16:19], s58 offen offset:0 sc1
  s_waitcnt lgkmcnt(12)
  v_mfma_f32_16x16x32_bf16 v[172:175], v[144:147], a[80:83], v[172:175]
  v_cmp_le_u32 vcc, 8, v15
  v_mfma_f32_16x16x32_bf16 v[168:171], v[124:127], a[84:87], v[168:171]
  s_ff0_i32_b32 s21, vcc_lo
  s_min_u32 s21, s21, 19
  s_lshl_b32 s22, s21, 1
  v_mfma_f32_16x16x32_bf16 v[172:175], v[148:151], a[84:87], v[172:175]
  s_lshl_b32 s21, s21, 2
  s_sub_i32 s21, s21, 12
  s_max_i32 s21, s21, s22
  v_mfma_f32_16x16x32_bf16 v[168:171], v[128:131], a[88:91], v[168:171]
  s_max_u32 s42, s21, s46
  s_cmp_ge_u32 s46, s48
  s_cselect_b32 s46, s42, s46
  v_mfma_f32_16x16x32_bf16 v[172:175], v[152:155], a[88:91], v[172:175]
  s_xor_b32 s52, s52, 32768
  s_cmp_lt_u32 s48, s46
  s_cselect_b32 s53, s41, 1073741824
  v_mfma_f32_16x16x32_bf16 v[168:171], v[132:135], a[92:95], v[168:171]
  s_add_u32 s54, s52, 0
  s_add_u32 m0, s54, s47
  v_mfma_f32_16x16x32_bf16 v[172:175], v[156:159], a[92:95], v[172:175]
  buffer_load_dwordx4 v4, s[16:19], s53 offen offset:0 sc1 lds
  buffer_load_dwordx4 v4, s[16:19], s53 offen offset:1024 sc1 lds
  v_mfma_f32_16x16x32_bf16 v[176:179], v[112:115], a[96:99], 0
  buffer_load_dwordx4 v4, s[16:19], s53 offen offset:2048 sc1 lds
  v_mfma_f32_16x16x32_bf16 v[180:183], v[136:139], a[96:99], 0
  s_add_u32 m0, s54, s49
  v_mfma_f32_16x16x32_bf16 v[176:179], v[116:119], a[100:103], v[176:179]
  v_cvt_pk_bf16_f32 v196, v168, v169
  v_cvt_pk_bf16_f32 v197, v170, v171
  v_mfma_f32_16x16x32_bf16 v[180:183], v[140:143], a[100:103], v[180:183]
  v_cvt_pk_bf16_f32 v198, v172, v173
  v_cvt_pk_bf16_f32 v199, v174, v175
  v_mfma_f32_16x16x32_bf16 v[176:179], v[120:123], a[104:107], v[176:179]
  buffer_store_dwordx4 v[196:199], v4, s[16:19], s56 offen offset:2048 sc1
  buffer_load_dword v14, s[72:75], s43 offen sc1 lds
  v_mfma_f32_16x16x32_bf16 v[180:183], v[144:147], a[104:107], v[180:183]
  s_add_u32 s41, s41, 2097152
  s_xor_b32 s41, s41, 8192
  s_add_u32 s48, s48, 1
  v_mfma_f32_16x16x32_bf16 v[176:179], v[124:127], a[108:111], v[176:179]
  v_mfma_f32_16x16x32_bf16 v[180:183], v[148:151], a[108:111], v[180:183]
  v_mfma_f32_16x16x32_bf16 v[176:179], v[128:131], a[112:115], v[176:179]
  s_add_u32 s55, s62, 16384
  v_mfma_f32_16x16x32_bf16 v[180:183], v[152:155], a[112:115], v[180:183]
  buffer_store_dwordx4 v[196:199], v4, s[16:19], s55 offen sc1
  v_mfma_f32_16x16x32_bf16 v[176:179], v[132:135], a[116:119], v[176:179]
  v_mfma_f32_16x16x32_bf16 v[180:183], v[156:159], a[116:119], v[180:183]
  v_mfma_f32_16x16x32_bf16 v[184:187], v[112:115], a[120:123], 0
  v_mfma_f32_16x16x32_bf16 v[188:191], v[136:139], a[120:123], 0
  v_mfma_f32_16x16x32_bf16 v[184:187], v[116:119], a[124:127], v[184:187]
  v_cvt_pk_bf16_f32 v200, v176, v177
  v_cvt_pk_bf16_f32 v201, v178, v179
  v_mfma_f32_16x16x32_bf16 v[188:191], v[140:143], a[124:127], v[188:191]
  v_cvt_pk_bf16_f32 v202, v180, v181
  v_cvt_pk_bf16_f32 v203, v182, v183
  v_mfma_f32_16x16x32_bf16 v[184:187], v[120:123], a[128:131], v[184:187]
  buffer_store_dwordx4 v[200:203], v4, s[16:19], s56 offen offset:3072 sc1
  v_mfma_f32_16x16x32_bf16 v[188:191], v[144:147], a[128:131], v[188:191]
  v_mfma_f32_16x16x32_bf16 v[184:187], v[124:127], a[132:135], v[184:187]
  v_mfma_f32_16x16x32_bf16 v[188:191], v[148:151], a[132:135], v[188:191]
  v_mfma_f32_16x16x32_bf16 v[184:187], v[128:131], a[136:139], v[184:187]
  v_mfma_f32_16x16x32_bf16 v[188:191], v[152:155], a[136:139], v[188:191]
  v_mfma_f32_16x16x32_bf16 v[184:187], v[132:135], a[140:143], v[184:187]
  v_mfma_f32_16x16x32_bf16 v[188:191], v[156:159], a[140:143], v[188:191]
  v_mfma_f32_16x16x32_bf16 v[160:163], v[112:115], a[144:147], 0
  v_mfma_f32_16x16x32_bf16 v[164:167], v[136:139], a[144:147], 0
  v_mfma_f32_16x16x32_bf16 v[160:163], v[116:119], a[148:151], v[160:163]
  v_cvt_pk_bf16_f32 v204, v184, v185
  v_cvt_pk_bf16_f32 v205, v186, v187
  v_mfma_f32_16x16x32_bf16 v[164:167], v[140:143], a[148:151], v[164:167]
  v_cvt_pk_bf16_f32 v206, v188, v189
  v_cvt_pk_bf16_f32 v207, v190, v191
  v_mfma_f32_16x16x32_bf16 v[160:163], v[120:123], a[152:155], v[160:163]
  buffer_store_dwordx4 v[204:207], v4, s[16:19], s57 offen offset:0 sc1
  v_mfma_f32_16x16x32_bf16 v[164:167], v[144:147], a[152:155], v[164:167]
  v_mfma_f32_16x16x32_bf16 v[160:163], v[124:127], a[156:159], v[160:163]
  v_mfma_f32_16x16x32_bf16 v[164:167], v[148:151], a[156:159], v[164:167]
  v_mfma_f32_16x16x32_bf16 v[160:163], v[128:131], a[160:163], v[160:163]
  s_add_u32 s55, s62, 32768
  v_mfma_f32_16x16x32_bf16 v[164:167], v[152:155], a[160:163], v[164:167]
  buffer_store_dwordx4 v[204:207], v4, s[16:19], s55 offen sc1
  v_mfma_f32_16x16x32_bf16 v[160:163], v[132:135], a[164:167], v[160:163]
  v_mfma_f32_16x16x32_bf16 v[164:167], v[156:159], a[164:167], v[164:167]
  v_mfma_f32_16x16x32_bf16 v[168:171], v[112:115], a[168:171], 0
  v_mfma_f32_16x16x32_bf16 v[172:175], v[136:139], a[168:171], 0
  v_mfma_f32_16x16x32_bf16 v[168:171], v[116:119], a[172:175], v[168:171]
  v_cvt_pk_bf16_f32 v192, v160, v161
  v_cvt_pk_bf16_f32 v193, v162, v163
  v_mfma_f32_16x16x32_bf16 v[172:175], v[140:143], a[172:175], v[172:175]
  v_cvt_pk_bf16_f32 v194, v164, v165
  v_cvt_pk_bf16_f32 v195, v166, v167
  v_mfma_f32_16x16x32_bf16 v[168:171], v[120:123], a[176:179], v[168:171]
  buffer_store_dwordx4 v[192:195], v4, s[16:19], s57 offen offset:1024 sc1
  v_mfma_f32_16x16x32_bf16 v[172:175], v[144:147], a[176:179], v[172:175]
  v_mfma_f32_16x16x32_bf16 v[168:171], v[124:127], a[180:183], v[168:171]
  v_mfma_f32_16x16x32_bf16 v[172:175], v[148:151], a[180:183], v[172:175]
  v_mfma_f32_16x16x32_bf16 v[168:171], v[128:131], a[184:187], v[168:171]
  v_mfma_f32_16x16x32_bf16 v[172:175], v[152:155], a[184:187], v[172:175]
  v_mfma_f32_16x16x32_bf16 v[168:171], v[132:135], a[188:191], v[168:171]
  v_mfma_f32_16x16x32_bf16 v[172:175], v[156:159], a[188:191], v[172:175]
  v_mfma_f32_16x16x32_bf16 v[176:179], v[112:115], a[192:195], 0
  s_min_u32 s21, s45, 56
  v_mov_b32 v16, s21
  s_waitcnt vmcnt(14)
  v_mfma_f32_16x16x32_bf16 v[180:183], v[136:139], a[192:195], 0
  buffer_store_dword v16, v17, s[72:75], s44 offen sc1
  v_mfma_f32_16x16x32_bf16 v[176:179], v[116:119], a[196:199], v[176:179]
  v_cvt_pk_bf16_f32 v196, v168, v169
  v_cvt_pk_bf16_f32 v197, v170, v171
  v_mfma_f32_16x16x32_bf16 v[180:183], v[140:143], a[196:199], v[180:183]
  v_cvt_pk_bf16_f32 v198, v172, v173
  v_cvt_pk_bf16_f32 v199, v174, v175
  v_mfma_f32_16x16x32_bf16 v[176:179], v[120:123], a[200:203], v[176:179]
  buffer_store_dwordx4 v[196:199], v4, s[16:19], s58 offen offset:1024 sc1
  v_mfma_f32_16x16x32_bf16 v[180:183], v[144:147], a[200:203], v[180:183]
  v_mfma_f32_16x16x32_bf16 v[176:179], v[124:127], a[204:207], v[176:179]
  s_add_u32 s56, s56, 2097152
  s_xor_b32 s56, s56, 8192
  s_add_u32 s59, s58, 524288
  v_mfma_f32_16x16x32_bf16 v[180:183], v[148:151], a[204:207], v[180:183]
  s_xor_b32 s58, s58, s59
  s_lshr_b32 s58, s58, 8
  s_and_b32 s58, s58, 8192
  v_mfma_f32_16x16x32_bf16 v[176:179], v[128:131], a[208:211], v[176:179]
  s_xor_b32 s58, s58, s59
  v_mfma_f32_16x16x32_bf16 v[180:183], v[152:155], a[208:211], v[180:183]
  v_mfma_f32_16x16x32_bf16 v[176:179], v[132:135], a[212:215], v[176:179]
  v_mfma_f32_16x16x32_bf16 v[180:183], v[156:159], a[212:215], v[180:183]
  v_mfma_f32_16x16x32_bf16 v[184:187], v[112:115], a[216:219], 0
  v_mfma_f32_16x16x32_bf16 v[188:191], v[136:139], a[216:219], 0
  v_mfma_f32_16x16x32_bf16 v[184:187], v[116:119], a[220:223], v[184:187]
  v_cvt_pk_bf16_f32 v200, v176, v177
  v_cvt_pk_bf16_f32 v201, v178, v179
  v_mfma_f32_16x16x32_bf16 v[188:191], v[140:143], a[220:223], v[188:191]
  v_cvt_pk_bf16_f32 v202, v180, v181
  v_cvt_pk_bf16_f32 v203, v182, v183
  v_mfma_f32_16x16x32_bf16 v[184:187], v[120:123], a[224:227], v[184:187]
  buffer_store_dwordx4 v[200:203], v4, s[16:19], s57 offen offset:2048 sc1
  v_mfma_f32_16x16x32_bf16 v[188:191], v[144:147], a[224:227], v[188:191]
  s_add_u32 s55, s62, 49152
  v_mfma_f32_16x16x32_bf16 v[184:187], v[124:127], a[228:231], v[184:187]
  buffer_store_dwordx4 v[200:203], v4, s[16:19], s55 offen sc1
  s_mov_b32 s51, s57
  v_mfma_f32_16x16x32_bf16 v[188:191], v[148:151], a[228:231], v[188:191]
  s_add_u32 s57, s56, 4096
  s_add_u32 s45, s45, 1
  v_mfma_f32_16x16x32_bf16 v[184:187], v[128:131], a[232:235], v[184:187]
  v_mfma_f32_16x16x32_bf16 v[188:191], v[152:155], a[232:235], v[188:191]
  v_mfma_f32_16x16x32_bf16 v[184:187], v[132:135], a[236:239], v[184:187]
  s_cmp_lt_u32 s45, s46
  v_mfma_f32_16x16x32_bf16 v[188:191], v[156:159], a[236:239], v[188:191]
  s_waitcnt lgkmcnt(0)
  s_cbranch_scc1 vwl_251
  s_nop 7
  v_cvt_pk_bf16_f32 v204, v184, v185
  v_cvt_pk_bf16_f32 v205, v186, v187
  v_cvt_pk_bf16_f32 v206, v188, v189
  v_cvt_pk_bf16_f32 v207, v190, v191
  buffer_store_dwordx4 v[204:207], v4, s[16:19], s51 offen offset:3072 sc1
  s_min_u32 s21, s45, 56
  v_mov_b32 v16, s21
  s_barrier
  s_mov_b32 s46, s42
  s_cmp_gt_u32 s42, s45
  s_cbranch_scc1 vwr_250
  s_cmp_lt_u32 s45, 64
  s_cbranch_scc1 vwr_245
  v_mov_b32 v244, -1
  v_mov_b32 v245, -1
  v_mov_b32 v246, -1
  v_mov_b32 v247, -1
  v_lshlrev_b32 v21, 3, v1
  s_lshr_b32 s21, s2, 2
  s_lshl_b32 s21, s21, 2
  s_add_u32 s21, s21, s20
  s_lshl_b32 s21, s21, 2
  s_and_b32 s22, s2, 3
  s_add_u32 s21, s21, s22
  s_lshl_b32 s21, s21, 14
  s_xor_b32 s22, s21, s80
  s_xor_b32 s21, s22, 125833216
  buffer_store_dwordx4 v[244:247], v4, s[16:19], s21 offen offset:0 sc1
  buffer_store_dwordx4 v[244:247], v4, s[16:19], s21 offen offset:1024 sc1
  buffer_store_dwordx4 v[244:247], v4, s[16:19], s21 offen offset:2048 sc1
  buffer_store_dwordx4 v[244:247], v4, s[16:19], s21 offen offset:3072 sc1
  s_xor_b32 s21, s22, 127938560
  buffer_store_dwordx4 v[244:247], v4, s[16:19], s21 offen offset:0 sc1
  buffer_store_dwordx4 v[244:247], v4, s[16:19], s21 offen offset:1024 sc1
  buffer_store_dwordx4 v[244:247], v4, s[16:19], s21 offen offset:2048 sc1
  buffer_store_dwordx4 v[244:247], v4, s[16:19], s21 offen offset:3072 sc1
  s_xor_b32 s21, s22, 130027520
  buffer_store_dwordx4 v[244:247], v4, s[16:19], s21 offen offset:0 sc1
  buffer_store_dwordx4 v[244:247], v4, s[16:19], s21 offen offset:1024 sc1
  buffer_store_dwordx4 v[244:247], v4, s[16:19], s21 offen offset:2048 sc1
  buffer_store_dwordx4 v[244:247], v4, s[16:19], s21 offen offset:3072 sc1
  s_xor_b32 s21, s22, 132132864
  buffer_store_dwordx4 v[244:247], v4, s[16:19], s21 offen offset:0 sc1
  buffer_store_dwordx4 v[244:247], v4, s[16:19], s21 offen offset:1024 sc1
  buffer_store_dwordx4 v[244:247], v4, s[16:19], s21 offen offset:2048 sc1
  buffer_store_dwordx4 v[244:247], v4, s[16:19], s21 offen offset:3072 sc1
  s_and_b32 s21, s2, 3
  s_cmp_lg_u32 s21, s20
  s_cbranch_scc1 arm_252
  s_lshr_b32 s21, s2, 1
  s_lshl_b32 s21, s21, 14
  s_and_b32 s22, s2, 1
  s_mul_i32 s22, s22, 2560
  s_add_u32 s21, s21, s22
  s_xor_b32 s22, s21, s80
  s_xor_b32 s21, s22, 216006656
  buffer_store_dwordx4 v[244:247], v4, s[16:19], s21 offen sc1
  buffer_store_dwordx4 v[244:247], v4, s[16:19], s21 offen offset:1024 sc1
  buffer_store_dwordx2 v[244:245], v21, s[16:19], s21 offen offset:2048 sc1
  s_xor_b32 s21, s22, 216530944
  buffer_store_dwordx4 v[244:247], v4, s[16:19], s21 offen sc1
  buffer_store_dwordx4 v[244:247], v4, s[16:19], s21 offen offset:1024 sc1
  buffer_store_dwordx2 v[244:245], v21, s[16:19], s21 offen offset:2048 sc1
  s_xor_b32 s21, s22, 217055232
  buffer_store_dwordx4 v[244:247], v4, s[16:19], s21 offen sc1
  buffer_store_dwordx4 v[244:247], v4, s[16:19], s21 offen offset:1024 sc1
  buffer_store_dwordx2 v[244:245], v21, s[16:19], s21 offen offset:2048 sc1
  s_xor_b32 s21, s22, 217579520
  buffer_store_dwordx4 v[244:247], v4, s[16:19], s21 offen sc1
  buffer_store_dwordx4 v[244:247], v4, s[16:19], s21 offen offset:1024 sc1
  buffer_store_dwordx2 v[244:245], v21, s[16:19], s21 offen offset:2048 sc1
arm_252:
  v_mov_b32 v16, 64
  s_waitcnt vmcnt(0)
  buffer_store_dword v16, v17, s[72:75], s44 offen sc1
  s_branch queue
not_vw:
  s_sub_u32 s2, s3, 96
  s_cmp_lg_u32 s2, 31
  s_cbranch_scc1 not_cal
  s_load_dwordx2 s[72:73], s[0:1], 104
  s_waitcnt lgkmcnt(0)
  s_add_u32 s72, s72, 173080576
  s_addc_u32 s73, s73, 0
  s_mov_b32 s74, 49152
  s_mov_b32 s75, 0x00020000
  v_lshlrev_b32 v8, 4, v0
  v_mov_b32 v4, 0
  v_mov_b32 v5, 0
  v_mov_b32 v6, 0
  v_mov_b32 v7, 0
  s_mov_b32 s21, 0
  buffer_store_dwordx4 v[4:7], v8, s[72:75], s21 offen sc1
  s_mov_b32 s21, 4096
  buffer_store_dwordx4 v[4:7], v8, s[72:75], s21 offen sc1
  s_mov_b32 s21, 8192
  buffer_store_dwordx4 v[4:7], v8, s[72:75], s21 offen sc1
  s_mov_b32 s21, 12288
  buffer_store_dwordx4 v[4:7], v8, s[72:75], s21 offen sc1
  s_mov_b32 s21, 16384
  buffer_store_dwordx4 v[4:7], v8, s[72:75], s21 offen sc1
  s_mov_b32 s21, 20480
  buffer_store_dwordx4 v[4:7], v8, s[72:75], s21 offen sc1
  s_mov_b32 s21, 24576
  buffer_store_dwordx4 v[4:7], v8, s[72:75], s21 offen sc1
  s_mov_b32 s21, 28672
  buffer_store_dwordx4 v[4:7], v8, s[72:75], s21 offen sc1
  s_mov_b32 s21, 32768
  buffer_store_dwordx4 v[4:7], v8, s[72:75], s21 offen sc1
  s_mov_b32 s21, 36864
  buffer_store_dwordx4 v[4:7], v8, s[72:75], s21 offen sc1
  s_mov_b32 s21, 40960
  buffer_store_dwordx4 v[4:7], v8, s[72:75], s21 offen sc1
  s_mov_b32 s21, 45056
  buffer_store_dwordx4 v[4:7], v8, s[72:75], s21 offen sc1
  s_add_u32 s8, s38, 173015040
  s_addc_u32 s9, s39, 0
  s_mov_b32 s10, 131072
  s_mov_b32 s11, 0x00020000
  s_cmp_lg_u32 s20, 0
  s_cbranch_scc1 cal_253
  s_mov_b32 s40, -1
  s_mov_b32 s41, -1
  s_mov_b32 s43, 0
cal_254:
  s_mov_b32 s21, 0
  s_memtime s[98:99]
  s_waitcnt lgkmcnt(0)
  s_buffer_load_dword s22, s[8:11], s21 glc
  s_waitcnt lgkmcnt(0)
  s_memtime s[100:101]
  s_waitcnt lgkmcnt(0)
  s_sub_u32 s21, s100, s98
  s_min_u32 s40, s40, s21
  s_mov_b32 s21, 8192
  s_memtime s[98:99]
  s_waitcnt lgkmcnt(0)
  s_buffer_load_dword s22, s[8:11], s21 glc
  s_waitcnt lgkmcnt(0)
  s_memtime s[100:101]
  s_waitcnt lgkmcnt(0)
  s_sub_u32 s21, s100, s98
  s_min_u32 s41, s41, s21
  s_add_u32 s43, s43, 1
  s_cmp_lt_u32 s43, 6
  s_cbranch_scc1 cal_254
cal_253:
  s_waitcnt vmcnt(0)
  s_barrier
  s_cmp_lg_u32 s20, 0
  s_cbranch_scc1 cal_255
  s_cmp_lt_u32 s41, s40
  s_cselect_b32 s21, 1, 2
  v_mov_b32 v4, s21
  v_mov_b32 v5, s40
  v_mov_b32 v6, s41
  v_mov_b32 v8, 76
  s_mov_b64 exec, 1
  buffer_store_dwordx3 v[4:6], v8, s[32:35], 0 offen sc1
  s_mov_b64 exec, -1
cal_255:
not_cal:
  s_load_dwordx2 s[4:5], s[0:1], 0
  s_load_dwordx2 s[6:7], s[0:1], 64
  s_load_dwordx2 s[38:39], s[0:1], 104
  s_lshr_b32 s41, s2, 3
  s_lshl_b32 s41, s41, 1
  s_and_b32 s21, s2, 1
  s_add_u32 s41, s41, s21
  s_bfe_u32 s42, s2, 0x20001
  s_waitcnt lgkmcnt(0)
  s_mov_b32 s8, s4
  s_mov_b32 s9, s5
  s_mov_b32 s10, 2621440
  s_mov_b32 s11, 0x00020000
  s_mov_b32 s12, s6
  s_mov_b32 s13, s7
  s_mov_b32 s14, 2457600
  s_mov_b32 s15, 0x00020000
  s_mov_b32 s16, s38
  s_mov_b32 s17, s39
  s_mov_b32 s18, 218103808
  s_mov_b32 s19, 0x00020000
  s_add_u32 s72, s38, 173080576
  s_addc_u32 s73, s39, 0
  s_mov_b32 s74, 49152
  s_mov_b32 s75, 0x00020000
  v_lshrrev_b32 v8, 5, v1
  v_or_b32 v9, 0, v8
  v_and_b32 v10, 31, v1
  v_lshlrev_b32 v9, 1, v9
  v_xor_b32 v10, v10, v9
  v_mul_u32_u24 v9, 6554, v10
  v_lshrrev_b32 v9, 16, v9
  v_mul_u32_u24 v11, 1120, v9
  v_lshl_add_u32 v11, v10, 4, v11
  v_mul_u32_u24 v8, 3840, v8
  v_add_u32 v11, v11, v8
  v_mov_b32 v9, 1073741824
  v_cmp_gt_u32 vcc, 30, v10
  s_nop 1
  v_cndmask_b32 v4, v9, v11, vcc
  v_lshrrev_b32 v8, 5, v1
  v_or_b32 v9, 2, v8
  v_and_b32 v10, 31, v1
  v_lshlrev_b32 v9, 1, v9
  v_xor_b32 v10, v10, v9
  v_mul_u32_u24 v9, 6554, v10
  v_lshrrev_b32 v9, 16, v9
  v_mul_u32_u24 v11, 1120, v9
  v_lshl_add_u32 v11, v10, 4, v11
  v_mul_u32_u24 v8, 3840, v8
  v_add_u32 v11, v11, v8
  v_mov_b32 v9, 1073741824
  v_cmp_gt_u32 vcc, 30, v10
  s_nop 1
  v_cndmask_b32 v5, v9, v11, vcc
  v_lshrrev_b32 v8, 5, v1
  v_or_b32 v9, 4, v8
  v_and_b32 v10, 31, v1
  v_lshlrev_b32 v9, 1, v9
  v_xor_b32 v10, v10, v9
  v_mul_u32_u24 v9, 6554, v10
  v_lshrrev_b32 v9, 16, v9
  v_mul_u32_u24 v11, 1120, v9
  v_lshl_add_u32 v11, v10, 4, v11
  v_mul_u32_u24 v8, 3840, v8
  v_add_u32 v11, v11, v8
  v_mov_b32 v9, 1073741824
  v_cmp_gt_u32 vcc, 30, v10
  s_nop 1
  v_cndmask_b32 v6, v9, v11, vcc
  v_lshrrev_b32 v8, 5, v1
  v_or_b32 v9, 6, v8
  v_and_b32 v10, 31, v1
  v_lshlrev_b32 v9, 1, v9
  v_xor_b32 v10, v10, v9
  v_mul_u32_u24 v9, 6554, v10
  v_lshrrev_b32 v9, 16, v9
  v_mul_u32_u24 v11, 1120, v9
  v_lshl_add_u32 v11, v10, 4, v11
  v_mul_u32_u24 v8, 3840, v8
  v_add_u32 v11, v11, v8
  v_mov_b32 v9, 1073741824
  v_cmp_gt_u32 vcc, 30, v10
  s_nop 1
  v_cndmask_b32 v7, v9, v11, vcc
  s_mul_i32 s44, s41, 160
  s_mul_i32 s21, s20, 122880
  s_add_u32 s44, s44, s21
  s_lshl_b32 s45, s20, 14
  s_add_u32 s21, s44, 0
  s_add_u32 m0, s45, 0
  s_nop 0
  buffer_load_dwordx4 v4, s[12:15], s21 offen lds
  s_add_u32 s21, s44, 7680
  s_add_u32 m0, s45, 1024
  s_nop 0
  buffer_load_dwordx4 v5, s[12:15], s21 offen lds
  s_add_u32 s21, s44, 15360
  s_add_u32 m0, s45, 2048
  s_nop 0
  buffer_load_dwordx4 v4, s[12:15], s21 offen lds
  s_add_u32 s21, s44, 23040
  s_add_u32 m0, s45, 3072
  s_nop 0
  buffer_load_dwordx4 v5, s[12:15], s21 offen lds
  s_add_u32 s21, s44, 30720
  s_add_u32 m0, s45, 4096
  s_nop 0
  buffer_load_dwordx4 v6, s[12:15], s21 offen lds
  s_add_u32 s21, s44, 38400
  s_add_u32 m0, s45, 5120
  s_nop 0
  buffer_load_dwordx4 v7, s[12:15], s21 offen lds
  s_add_u32 s21, s44, 46080
  s_add_u32 m0, s45, 6144
  s_nop 0
  buffer_load_dwordx4 v6, s[12:15], s21 offen lds
  s_add_u32 s21, s44, 53760
  s_add_u32 m0, s45, 7168
  s_nop 0
  buffer_load_dwordx4 v7, s[12:15], s21 offen lds
  s_add_u32 s21, s44, 61440
  s_add_u32 m0, s45, 8192
  s_nop 0
  buffer_load_dwordx4 v4, s[12:15], s21 offen lds
  s_add_u32 s21, s44, 69120
  s_add_u32 m0, s45, 9216
  s_nop 0
  buffer_load_dwordx4 v5, s[12:15], s21 offen lds
  s_add_u32 s21, s44, 76800
  s_add_u32 m0, s45, 10240
  s_nop 0
  buffer_load_dwordx4 v4, s[12:15], s21 offen lds
  s_add_u32 s21, s44, 84480
  s_add_u32 m0, s45, 11264
  s_nop 0
  buffer_load_dwordx4 v5, s[12:15], s21 offen lds
  s_add_u32 s21, s44, 92160
  s_add_u32 m0, s45, 12288
  s_nop 0
  buffer_load_dwordx4 v6, s[12:15], s21 offen lds
  s_add_u32 s21, s44, 99840
  s_add_u32 m0, s45, 13312
  s_nop 0
  buffer_load_dwordx4 v7, s[12:15], s21 offen lds
  s_add_u32 s21, s44, 107520
  s_add_u32 m0, s45, 14336
  s_nop 0
  buffer_load_dwordx4 v6, s[12:15], s21 offen lds
  s_add_u32 s21, s44, 115200
  s_add_u32 m0, s45, 15360
  s_nop 0
  buffer_load_dwordx4 v7, s[12:15], s21 offen lds
  s_add_u32 s21, s44, 491520
  s_add_u32 m0, s45, 65536
  s_nop 0
  buffer_load_dwordx4 v4, s[12:15], s21 offen lds
  s_add_u32 s21, s44, 499200
  s_add_u32 m0, s45, 66560
  s_nop 0
  buffer_load_dwordx4 v5, s[12:15], s21 offen lds
  s_add_u32 s21, s44, 506880
  s_add_u32 m0, s45, 67584
  s_nop 0
  buffer_load_dwordx4 v4, s[12:15], s21 offen lds
  s_add_u32 s21, s44, 514560
  s_add_u32 m0, s45, 68608
  s_nop 0
  buffer_load_dwordx4 v5, s[12:15], s21 offen lds
  s_add_u32 s21, s44, 522240
  s_add_u32 m0, s45, 69632
  s_nop 0
  buffer_load_dwordx4 v6, s[12:15], s21 offen lds
  s_add_u32 s21, s44, 529920
  s_add_u32 m0, s45, 70656
  s_nop 0
  buffer_load_dwordx4 v7, s[12:15], s21 offen lds
  s_add_u32 s21, s44, 537600
  s_add_u32 m0, s45, 71680
  s_nop 0
  buffer_load_dwordx4 v6, s[12:15], s21 offen lds
  s_add_u32 s21, s44, 545280
  s_add_u32 m0, s45, 72704
  s_nop 0
  buffer_load_dwordx4 v7, s[12:15], s21 offen lds
  s_add_u32 s21, s44, 552960
  s_add_u32 m0, s45, 73728
  s_nop 0
  buffer_load_dwordx4 v4, s[12:15], s21 offen lds
  s_add_u32 s21, s44, 560640
  s_add_u32 m0, s45, 74752
  s_nop 0
  buffer_load_dwordx4 v5, s[12:15], s21 offen lds
  s_add_u32 s21, s44, 568320
  s_add_u32 m0, s45, 75776
  s_nop 0
  buffer_load_dwordx4 v4, s[12:15], s21 offen lds
  s_add_u32 s21, s44, 576000
  s_add_u32 m0, s45, 76800
  s_nop 0
  buffer_load_dwordx4 v5, s[12:15], s21 offen lds
  s_add_u32 s21, s44, 583680
  s_add_u32 m0, s45, 77824
  s_nop 0
  buffer_load_dwordx4 v6, s[12:15], s21 offen lds
  s_add_u32 s21, s44, 591360
  s_add_u32 m0, s45, 78848
  s_nop 0
  buffer_load_dwordx4 v7, s[12:15], s21 offen lds
  s_add_u32 s21, s44, 599040
  s_add_u32 m0, s45, 79872
  s_nop 0
  buffer_load_dwordx4 v6, s[12:15], s21 offen lds
  s_add_u32 s21, s44, 606720
  s_add_u32 m0, s45, 80896
  s_nop 0
  buffer_load_dwordx4 v7, s[12:15], s21 offen lds
  s_add_u32 s21, s44, 983040
  buffer_load_dwordx4 v[64:67], v4, s[12:15], s21 offen
  s_add_u32 s21, s44, 990720
  buffer_load_dwordx4 v[68:71], v5, s[12:15], s21 offen
  s_add_u32 s21, s44, 998400
  buffer_load_dwordx4 v[72:75], v4, s[12:15], s21 offen
  s_add_u32 s21, s44, 1006080
  buffer_load_dwordx4 v[76:79], v5, s[12:15], s21 offen
  s_add_u32 s21, s44, 1013760
  buffer_load_dwordx4 v[80:83], v6, s[12:15], s21 offen
  s_add_u32 s21, s44, 1021440
  buffer_load_dwordx4 v[84:87], v7, s[12:15], s21 offen
  s_add_u32 s21, s44, 1029120
  buffer_load_dwordx4 v[88:91], v6, s[12:15], s21 offen
  s_add_u32 s21, s44, 1036800
  buffer_load_dwordx4 v[92:95], v7, s[12:15], s21 offen
  s_add_u32 s21, s44, 1044480
  buffer_load_dwordx4 v[96:99], v4, s[12:15], s21 offen
  s_add_u32 s21, s44, 1052160
  buffer_load_dwordx4 v[100:103], v5, s[12:15], s21 offen
  s_add_u32 s21, s44, 1059840
  buffer_load_dwordx4 v[104:107], v4, s[12:15], s21 offen
  s_add_u32 s21, s44, 1067520
  buffer_load_dwordx4 v[108:111], v5, s[12:15], s21 offen
  s_add_u32 s21, s44, 1075200
  buffer_load_dwordx4 v[112:115], v6, s[12:15], s21 offen
  s_add_u32 s21, s44, 1082880
  buffer_load_dwordx4 v[116:119], v7, s[12:15], s21 offen
  s_add_u32 s21, s44, 1090560
  buffer_load_dwordx4 v[120:123], v6, s[12:15], s21 offen
  s_add_u32 s21, s44, 1098240
  buffer_load_dwordx4 v[124:127], v7, s[12:15], s21 offen
  v_lshrrev_b32 v8, 2, v2
  v_and_b32 v9, 1, v3
  v_lshl_add_u32 v9, v9, 2, v8
  v_lshlrev_b32 v9, 5, v9
  v_lshl_add_u32 v8, v3, 3, v8
  v_lshlrev_b32 v8, 9, v8
  v_and_b32 v10, 3, v2
  s_mul_i32 s21, s20, 40
  v_lshl_add_u32 v11, v10, 3, s21
  v_add_u32 v11, 0, v11
  v_xor_b32 v11, v11, v9
  v_add_u32 v12, v11, v8
  v_add_u32 v16, 65536, v12
  v_lshl_add_u32 v11, v10, 3, s21
  v_add_u32 v11, 160, v11
  v_xor_b32 v11, v11, v9
  v_add_u32 v13, v11, v8
  v_add_u32 v17, 65536, v13
  v_mul_u32_u24 v11, 160, v10
  v_add3_u32 v11, v11, 32, s21
  v_min_u32 v11, 480, v11
  v_xor_b32 v11, v11, v9
  v_add_u32 v14, v11, v8
  v_add_u32 v18, 65536, v14
  v_lshl_add_u32 v11, v10, 3, s21
  v_add_u32 v11, 320, v11
  v_xor_b32 v11, v11, v9
  v_add_u32 v15, v11, v8
  v_add_u32 v19, 65536, v15
  v_lshl_add_u32 v23, v1, 4, s45
  v_add_u32 v29, 65536, v23
  s_waitcnt vmcnt(32)
  s_add_u32 s21, s44, 1474560
  buffer_load_dwordx4 v[128:131], v4, s[12:15], s21 offen
  s_add_u32 s21, s44, 1482240
  buffer_load_dwordx4 v[132:135], v5, s[12:15], s21 offen
  s_add_u32 s21, s44, 1489920
  buffer_load_dwordx4 v[136:139], v4, s[12:15], s21 offen
  s_add_u32 s21, s44, 1497600
  buffer_load_dwordx4 v[140:143], v5, s[12:15], s21 offen
  s_add_u32 s21, s44, 1505280
  buffer_load_dwordx4 v[144:147], v6, s[12:15], s21 offen
  s_add_u32 s21, s44, 1512960
  buffer_load_dwordx4 v[148:151], v7, s[12:15], s21 offen
  s_add_u32 s21, s44, 1520640
  buffer_load_dwordx4 v[152:155], v6, s[12:15], s21 offen
  s_add_u32 s21, s44, 1528320
  buffer_load_dwordx4 v[156:159], v7, s[12:15], s21 offen
  s_add_u32 s21, s44, 1536000
  buffer_load_dwordx4 v[160:163], v4, s[12:15], s21 offen
  s_add_u32 s21, s44, 1543680
  buffer_load_dwordx4 v[164:167], v5, s[12:15], s21 offen
  s_add_u32 s21, s44, 1551360
  buffer_load_dwordx4 v[168:171], v4, s[12:15], s21 offen
  s_add_u32 s21, s44, 1559040
  buffer_load_dwordx4 v[172:175], v5, s[12:15], s21 offen
  s_add_u32 s21, s44, 1566720
  buffer_load_dwordx4 v[176:179], v6, s[12:15], s21 offen
  s_add_u32 s21, s44, 1574400
  buffer_load_dwordx4 v[180:183], v7, s[12:15], s21 offen
  s_add_u32 s21, s44, 1582080
  buffer_load_dwordx4 v[184:187], v6, s[12:15], s21 offen
  s_add_u32 s21, s44, 1589760
  buffer_load_dwordx4 v[188:191], v7, s[12:15], s21 offen
  s_barrier
  ds_read_b64_tr_b16 a[0:1], v12 offset:0
  ds_read_b64_tr_b16 a[2:3], v12 offset:2048
  ds_read_b64_tr_b16 a[4:5], v13 offset:0
  ds_read_b64_tr_b16 a[6:7], v13 offset:2048
  ds_read_b64_tr_b16 a[8:9], v14 offset:0
  ds_read_b64_tr_b16 a[10:11], v14 offset:2048
  ds_read_b64_tr_b16 a[12:13], v15 offset:0
  ds_read_b64_tr_b16 a[14:15], v15 offset:2048
  ds_read_b64_tr_b16 a[16:17], v12 offset:16384
  ds_read_b64_tr_b16 a[18:19], v12 offset:18432
  ds_read_b64_tr_b16 a[20:21], v13 offset:16384
  ds_read_b64_tr_b16 a[22:23], v13 offset:18432
  ds_read_b64_tr_b16 a[24:25], v14 offset:16384
  ds_read_b64_tr_b16 a[26:27], v14 offset:18432
  ds_read_b64_tr_b16 a[28:29], v15 offset:16384
  ds_read_b64_tr_b16 a[30:31], v15 offset:18432
  ds_read_b64_tr_b16 a[32:33], v12 offset:32768
  ds_read_b64_tr_b16 a[34:35], v12 offset:34816
  ds_read_b64_tr_b16 a[36:37], v13 offset:32768
  ds_read_b64_tr_b16 a[38:39], v13 offset:34816
  ds_read_b64_tr_b16 a[40:41], v14 offset:32768
  ds_read_b64_tr_b16 a[42:43], v14 offset:34816
  ds_read_b64_tr_b16 a[44:45], v15 offset:32768
  ds_read_b64_tr_b16 a[46:47], v15 offset:34816
  ds_read_b64_tr_b16 a[48:49], v12 offset:49152
  ds_read_b64_tr_b16 a[50:51], v12 offset:51200
  ds_read_b64_tr_b16 a[52:53], v13 offset:49152
  ds_read_b64_tr_b16 a[54:55], v13 offset:51200
  ds_read_b64_tr_b16 a[56:57], v14 offset:49152
  ds_read_b64_tr_b16 a[58:59], v14 offset:51200
  ds_read_b64_tr_b16 a[60:61], v15 offset:49152
  ds_read_b64_tr_b16 a[62:63], v15 offset:51200
  s_waitcnt lgkmcnt(0)
  s_barrier
  s_waitcnt vmcnt(32)
  s_add_u32 s21, s44, 1966080
  buffer_load_dwordx4 v[192:195], v4, s[12:15], s21 offen
  s_add_u32 s21, s44, 1973760
  buffer_load_dwordx4 v[196:199], v5, s[12:15], s21 offen
  s_add_u32 s21, s44, 1981440
  buffer_load_dwordx4 v[200:203], v4, s[12:15], s21 offen
  s_add_u32 s21, s44, 1989120
  buffer_load_dwordx4 v[204:207], v5, s[12:15], s21 offen
  s_add_u32 s21, s44, 1996800
  buffer_load_dwordx4 v[208:211], v6, s[12:15], s21 offen
  s_add_u32 s21, s44, 2004480
  buffer_load_dwordx4 v[212:215], v7, s[12:15], s21 offen
  s_add_u32 s21, s44, 2012160
  buffer_load_dwordx4 v[216:219], v6, s[12:15], s21 offen
  s_add_u32 s21, s44, 2019840
  buffer_load_dwordx4 v[220:223], v7, s[12:15], s21 offen
  s_add_u32 s21, s44, 2027520
  buffer_load_dwordx4 v[224:227], v4, s[12:15], s21 offen
  s_add_u32 s21, s44, 2035200
  buffer_load_dwordx4 v[228:231], v5, s[12:15], s21 offen
  s_add_u32 s21, s44, 2042880
  buffer_load_dwordx4 v[232:235], v4, s[12:15], s21 offen
  s_add_u32 s21, s44, 2050560
  buffer_load_dwordx4 v[236:239], v5, s[12:15], s21 offen
  s_add_u32 s21, s44, 2058240
  buffer_load_dwordx4 v[240:243], v6, s[12:15], s21 offen
  s_add_u32 s21, s44, 2065920
  buffer_load_dwordx4 v[244:247], v7, s[12:15], s21 offen
  s_add_u32 s21, s44, 2073600
  buffer_load_dwordx4 v[248:251], v6, s[12:15], s21 offen
  s_add_u32 s21, s44, 2081280
  buffer_load_dwordx4 v[252:255], v7, s[12:15], s21 offen
  s_barrier
  ds_read_b64_tr_b16 a[64:65], v16 offset:0
  ds_read_b64_tr_b16 a[66:67], v16 offset:2048
  ds_read_b64_tr_b16 a[68:69], v17 offset:0
  ds_read_b64_tr_b16 a[70:71], v17 offset:2048
  ds_read_b64_tr_b16 a[72:73], v18 offset:0
  ds_read_b64_tr_b16 a[74:75], v18 offset:2048
  ds_read_b64_tr_b16 a[76:77], v19 offset:0
  ds_read_b64_tr_b16 a[78:79], v19 offset:2048
  ds_read_b64_tr_b16 a[80:81], v16 offset:16384
  ds_read_b64_tr_b16 a[82:83], v16 offset:18432
  ds_read_b64_tr_b16 a[84:85], v17 offset:16384
  ds_read_b64_tr_b16 a[86:87], v17 offset:18432
  ds_read_b64_tr_b16 a[88:89], v18 offset:16384
  ds_read_b64_tr_b16 a[90:91], v18 offset:18432
  ds_read_b64_tr_b16 a[92:93], v19 offset:16384
  ds_read_b64_tr_b16 a[94:95], v19 offset:18432
  ds_read_b64_tr_b16 a[96:97], v16 offset:32768
  ds_read_b64_tr_b16 a[98:99], v16 offset:34816
  ds_read_b64_tr_b16 a[100:101], v17 offset:32768
  ds_read_b64_tr_b16 a[102:103], v17 offset:34816
  ds_read_b64_tr_b16 a[104:105], v18 offset:32768
  ds_read_b64_tr_b16 a[106:107], v18 offset:34816
  ds_read_b64_tr_b16 a[108:109], v19 offset:32768
  ds_read_b64_tr_b16 a[110:111], v19 offset:34816
  ds_read_b64_tr_b16 a[112:113], v16 offset:49152
  ds_read_b64_tr_b16 a[114:115], v16 offset:51200
  ds_read_b64_tr_b16 a[116:117], v17 offset:49152
  ds_read_b64_tr_b16 a[118:119], v17 offset:51200
  ds_read_b64_tr_b16 a[120:121], v18 offset:49152
  ds_read_b64_tr_b16 a[122:123], v18 offset:51200
  ds_read_b64_tr_b16 a[124:125], v19 offset:49152
  ds_read_b64_tr_b16 a[126:127], v19 offset:51200
  s_waitcnt lgkmcnt(0)
  s_barrier
  s_waitcnt vmcnt(32)
  v_lshlrev_b32 v30, 4, v1
  s_load_dwordx2 s[36:37], s[0:1], 16
  s_lshl_b32 s23, s2, 2
  s_add_u32 s23, s23, s20
  s_mul_i32 s23, s23, 61440
  s_add_u32 s23, s23, 30720
  s_waitcnt lgkmcnt(0)
  s_mov_b32 s24, s36
  s_mov_b32 s25, s37
  s_mov_b32 s26, 7864320
  s_mov_b32 s27, 0x00020000
  buffer_load_dwordx4 v[32:35], v30, s[24:27], s23 offen offset:0
  buffer_load_dwordx4 v[32:35], v30, s[24:27], s23 offen offset:1024
  buffer_load_dwordx4 v[32:35], v30, s[24:27], s23 offen offset:2048
  buffer_load_dwordx4 v[32:35], v30, s[24:27], s23 offen offset:3072
  s_add_u32 s23, s23, 4096
  buffer_load_dwordx4 v[32:35], v30, s[24:27], s23 offen offset:0
  buffer_load_dwordx4 v[32:35], v30, s[24:27], s23 offen offset:1024
  buffer_load_dwordx4 v[32:35], v30, s[24:27], s23 offen offset:2048
  buffer_load_dwordx4 v[32:35], v30, s[24:27], s23 offen offset:3072
  s_add_u32 s23, s23, 4096
  buffer_load_dwordx4 v[32:35], v30, s[24:27], s23 offen offset:0
  buffer_load_dwordx4 v[32:35], v30, s[24:27], s23 offen offset:1024
  buffer_load_dwordx4 v[32:35], v30, s[24:27], s23 offen offset:2048
  buffer_load_dwordx4 v[32:35], v30, s[24:27], s23 offen offset:3072
  s_add_u32 s23, s23, 4096
  buffer_load_dwordx4 v[32:35], v30, s[24:27], s23 offen offset:0
  buffer_load_dwordx4 v[32:35], v30, s[24:27], s23 offen offset:1024
  buffer_load_dwordx4 v[32:35], v30, s[24:27], s23 offen offset:2048
  buffer_load_dwordx4 v[32:35], v30, s[24:27], s23 offen offset:3072
  s_add_u32 s23, s23, 4096
  buffer_load_dwordx4 v[32:35], v30, s[24:27], s23 offen offset:0
  buffer_load_dwordx4 v[32:35], v30, s[24:27], s23 offen offset:1024
  buffer_load_dwordx4 v[32:35], v30, s[24:27], s23 offen offset:2048
  buffer_load_dwordx4 v[32:35], v30, s[24:27], s23 offen offset:3072
  s_add_u32 s23, s23, 4096
  buffer_load_dwordx4 v[32:35], v30, s[24:27], s23 offen offset:0
  buffer_load_dwordx4 v[32:35], v30, s[24:27], s23 offen offset:1024
  buffer_load_dwordx4 v[32:35], v30, s[24:27], s23 offen offset:2048
  buffer_load_dwordx4 v[32:35], v30, s[24:27], s23 offen offset:3072
  s_add_u32 s23, s23, 4096
  buffer_load_dwordx4 v[32:35], v30, s[24:27], s23 offen offset:0
  buffer_load_dwordx4 v[32:35], v30, s[24:27], s23 offen offset:1024
  buffer_load_dwordx4 v[32:35], v30, s[24:27], s23 offen offset:2048
  buffer_load_dwordx4 v[32:35], v30, s[24:27], s23 offen offset:3072
  s_add_u32 s23, s23, 4096
  buffer_load_dwordx4 v[32:35], v30, s[24:27], s23 offen offset:0
  buffer_load_dwordx4 v[32:35], v30, s[24:27], s23 offen offset:1024
  ds_write_b128 v23, v[64:67] offset:0
  ds_write_b128 v23, v[68:71] offset:1024
  ds_write_b128 v23, v[72:75] offset:2048
  ds_write_b128 v23, v[76:79] offset:3072
  ds_write_b128 v23, v[80:83] offset:4096
  ds_write_b128 v23, v[84:87] offset:5120
  ds_write_b128 v23, v[88:91] offset:6144
  ds_write_b128 v23, v[92:95] offset:7168
  ds_write_b128 v23, v[96:99] offset:8192
  ds_write_b128 v23, v[100:103] offset:9216
  ds_write_b128 v23, v[104:107] offset:10240
  ds_write_b128 v23, v[108:111] offset:11264
  ds_write_b128 v23, v[112:115] offset:12288
  ds_write_b128 v23, v[116:119] offset:13312
  ds_write_b128 v23, v[120:123] offset:14336
  ds_write_b128 v23, v[124:127] offset:15360
  s_waitcnt lgkmcnt(0)
  s_barrier
  ds_read_b64_tr_b16 a[128:129], v12 offset:0
  ds_read_b64_tr_b16 a[130:131], v12 offset:2048
  ds_read_b64_tr_b16 a[132:133], v13 offset:0
  ds_read_b64_tr_b16 a[134:135], v13 offset:2048
  ds_read_b64_tr_b16 a[136:137], v14 offset:0
  ds_read_b64_tr_b16 a[138:139], v14 offset:2048
  ds_read_b64_tr_b16 a[140:141], v15 offset:0
  ds_read_b64_tr_b16 a[142:143], v15 offset:2048
  ds_read_b64_tr_b16 a[144:145], v12 offset:16384
  ds_read_b64_tr_b16 a[146:147], v12 offset:18432
  ds_read_b64_tr_b16 a[148:149], v13 offset:16384
  ds_read_b64_tr_b16 a[150:151], v13 offset:18432
  ds_read_b64_tr_b16 a[152:153], v14 offset:16384
  ds_read_b64_tr_b16 a[154:155], v14 offset:18432
  ds_read_b64_tr_b16 a[156:157], v15 offset:16384
  ds_read_b64_tr_b16 a[158:159], v15 offset:18432
  ds_read_b64_tr_b16 a[160:161], v12 offset:32768
  ds_read_b64_tr_b16 a[162:163], v12 offset:34816
  ds_read_b64_tr_b16 a[164:165], v13 offset:32768
  ds_read_b64_tr_b16 a[166:167], v13 offset:34816
  ds_read_b64_tr_b16 a[168:169], v14 offset:32768
  ds_read_b64_tr_b16 a[170:171], v14 offset:34816
  ds_read_b64_tr_b16 a[172:173], v15 offset:32768
  ds_read_b64_tr_b16 a[174:175], v15 offset:34816
  ds_read_b64_tr_b16 a[176:177], v12 offset:49152
  ds_read_b64_tr_b16 a[178:179], v12 offset:51200
  ds_read_b64_tr_b16 a[180:181], v13 offset:49152
  ds_read_b64_tr_b16 a[182:183], v13 offset:51200
  ds_read_b64_tr_b16 a[184:185], v14 offset:49152
  ds_read_b64_tr_b16 a[186:187], v14 offset:51200
  ds_read_b64_tr_b16 a[188:189], v15 offset:49152
  ds_read_b64_tr_b16 a[190:191], v15 offset:51200
  s_waitcnt lgkmcnt(0)
  s_barrier
  s_waitcnt vmcnt(46)
  ds_write_b128 v29, v[128:131] offset:0
  ds_write_b128 v29, v[132:135] offset:1024
  ds_write_b128 v29, v[136:139] offset:2048
  ds_write_b128 v29, v[140:143] offset:3072
  ds_write_b128 v29, v[144:147] offset:4096
  ds_write_b128 v29, v[148:151] offset:5120
  ds_write_b128 v29, v[152:155] offset:6144
  ds_write_b128 v29, v[156:159] offset:7168
  ds_write_b128 v29, v[160:163] offset:8192
  ds_write_b128 v29, v[164:167] offset:9216
  ds_write_b128 v29, v[168:171] offset:10240
  ds_write_b128 v29, v[172:175] offset:11264
  ds_write_b128 v29, v[176:179] offset:12288
  ds_write_b128 v29, v[180:183] offset:13312
  ds_write_b128 v29, v[184:187] offset:14336
  ds_write_b128 v29, v[188:191] offset:15360
  s_waitcnt lgkmcnt(0)
  s_barrier
  ds_read_b64_tr_b16 a[192:193], v16 offset:0
  ds_read_b64_tr_b16 a[194:195], v16 offset:2048
  ds_read_b64_tr_b16 a[196:197], v17 offset:0
  ds_read_b64_tr_b16 a[198:199], v17 offset:2048
  ds_read_b64_tr_b16 a[200:201], v18 offset:0
  ds_read_b64_tr_b16 a[202:203], v18 offset:2048
  ds_read_b64_tr_b16 a[204:205], v19 offset:0
  ds_read_b64_tr_b16 a[206:207], v19 offset:2048
  ds_read_b64_tr_b16 a[208:209], v16 offset:16384
  ds_read_b64_tr_b16 a[210:211], v16 offset:18432
  ds_read_b64_tr_b16 a[212:213], v17 offset:16384
  ds_read_b64_tr_b16 a[214:215], v17 offset:18432
  ds_read_b64_tr_b16 a[216:217], v18 offset:16384
  ds_read_b64_tr_b16 a[218:219], v18 offset:18432
  ds_read_b64_tr_b16 a[220:221], v19 offset:16384
  ds_read_b64_tr_b16 a[222:223], v19 offset:18432
  ds_read_b64_tr_b16 a[224:225], v16 offset:32768
  ds_read_b64_tr_b16 a[226:227], v16 offset:34816
  ds_read_b64_tr_b16 a[228:229], v17 offset:32768
  ds_read_b64_tr_b16 a[230:231], v17 offset:34816
  ds_read_b64_tr_b16 a[232:233], v18 offset:32768
  ds_read_b64_tr_b16 a[234:235], v18 offset:34816
  ds_read_b64_tr_b16 a[236:237], v19 offset:32768
  ds_read_b64_tr_b16 a[238:239], v19 offset:34816
  ds_read_b64_tr_b16 a[240:241], v16 offset:49152
  ds_read_b64_tr_b16 a[242:243], v16 offset:51200
  ds_read_b64_tr_b16 a[244:245], v17 offset:49152
  ds_read_b64_tr_b16 a[246:247], v17 offset:51200
  ds_read_b64_tr_b16 a[248:249], v18 offset:49152
  ds_read_b64_tr_b16 a[250:251], v18 offset:51200
  ds_read_b64_tr_b16 a[252:253], v19 offset:49152
  ds_read_b64_tr_b16 a[254:255], v19 offset:51200
  s_waitcnt lgkmcnt(0)
  s_barrier
  s_waitcnt vmcnt(30)
  ds_write_b128 v23, v[192:195] offset:0
  ds_write_b128 v23, v[196:199] offset:1024
  ds_write_b128 v23, v[200:203] offset:2048
  ds_write_b128 v23, v[204:207] offset:3072
  ds_write_b128 v23, v[208:211] offset:4096
  ds_write_b128 v23, v[212:215] offset:5120
  ds_write_b128 v23, v[216:219] offset:6144
  ds_write_b128 v23, v[220:223] offset:7168
  ds_write_b128 v23, v[224:227] offset:8192
  ds_write_b128 v23, v[228:231] offset:9216
  ds_write_b128 v23, v[232:235] offset:10240
  ds_write_b128 v23, v[236:239] offset:11264
  ds_write_b128 v23, v[240:243] offset:12288
  ds_write_b128 v23, v[244:247] offset:13312
  ds_write_b128 v23, v[248:251] offset:14336
  ds_write_b128 v23, v[252:255] offset:15360
  s_waitcnt lgkmcnt(0)
  s_barrier
  ds_read_b64_tr_b16 v[192:193], v12 offset:0
  ds_read_b64_tr_b16 v[194:195], v12 offset:2048
  ds_read_b64_tr_b16 v[196:197], v13 offset:0
  ds_read_b64_tr_b16 v[198:199], v13 offset:2048
  ds_read_b64_tr_b16 v[200:201], v14 offset:0
  ds_read_b64_tr_b16 v[202:203], v14 offset:2048
  ds_read_b64_tr_b16 v[204:205], v15 offset:0
  ds_read_b64_tr_b16 v[206:207], v15 offset:2048
  ds_read_b64_tr_b16 v[208:209], v12 offset:16384
  ds_read_b64_tr_b16 v[210:211], v12 offset:18432
  ds_read_b64_tr_b16 v[212:213], v13 offset:16384
  ds_read_b64_tr_b16 v[214:215], v13 offset:18432
  ds_read_b64_tr_b16 v[216:217], v14 offset:16384
  ds_read_b64_tr_b16 v[218:219], v14 offset:18432
  ds_read_b64_tr_b16 v[220:221], v15 offset:16384
  ds_read_b64_tr_b16 v[222:223], v15 offset:18432
  ds_read_b64_tr_b16 v[224:225], v12 offset:32768
  ds_read_b64_tr_b16 v[226:227], v12 offset:34816
  ds_read_b64_tr_b16 v[228:229], v13 offset:32768
  ds_read_b64_tr_b16 v[230:231], v13 offset:34816
  ds_read_b64_tr_b16 v[232:233], v14 offset:32768
  ds_read_b64_tr_b16 v[234:235], v14 offset:34816
  ds_read_b64_tr_b16 v[236:237], v15 offset:32768
  ds_read_b64_tr_b16 v[238:239], v15 offset:34816
  ds_read_b64_tr_b16 v[240:241], v12 offset:49152
  ds_read_b64_tr_b16 v[242:243], v12 offset:51200
  ds_read_b64_tr_b16 v[244:245], v13 offset:49152
  ds_read_b64_tr_b16 v[246:247], v13 offset:51200
  ds_read_b64_tr_b16 v[248:249], v14 offset:49152
  ds_read_b64_tr_b16 v[250:251], v14 offset:51200
  ds_read_b64_tr_b16 v[252:253], v15 offset:49152
  ds_read_b64_tr_b16 v[254:255], v15 offset:51200
  s_waitcnt lgkmcnt(0)
  s_barrier
  s_load_dwordx2 s[32:33], s[0:1], 96
  s_waitcnt lgkmcnt(0)
  s_mov_b32 s32, s32
  s_mov_b32 s33, s33
  s_mov_b32 s34, 256
  s_mov_b32 s35, 0x00020000
  s_mov_b32 s21, 76
  v_mov_b32 v4, 0
  s_mov_b32 s101, 0
wf_256:
  buffer_load_dword v5, v4, s[32:35], s21 offen sc1
  s_add_u32 s101, s101, 1
  s_cmp_gt_u32 s101, 131072
  s_cbranch_scc1 main_end
  s_waitcnt vmcnt(0)
  v_readfirstlane_b32 s100, v5
  s_cmp_ge_u32 s100, 1
  s_cbranch_scc1 wf_257
  s_sleep 8
  s_branch wf_256
wf_257:
  s_sub_u32 s80, s100, 1
  s_lshl_b32 s80, s80, 13
  v_lshrrev_b32 v8, 3, v1
  v_and_b32 v9, 7, v1
  v_xor_b32 v9, v9, v8
  s_and_b32 s21, s20, 1
  s_lshl_b32 s21, s21, 4
  s_lshr_b32 s22, s20, 1
  s_add_u32 s21, s21, s22
  v_lshl_add_u32 v8, v8, 1, s21
  v_mul_u32_u24 v8, 1280, v8
  v_lshl_add_u32 v4, v9, 4, v8
  s_lshl_b32 s31, s20, 10
  s_mul_i32 s30, s42, 655360
  s_sub_u32 s46, s30, 40960
  s_cmp_eq_u32 s42, 0
  s_cselect_b32 s46, 1073741824, s46
  s_add_u32 m0, s31, 0
  s_nop 0
  buffer_load_dwordx4 v4, s[8:11], s46 offen offset:0 lds
  s_add_u32 m0, s31, 3968
  s_nop 0
  buffer_load_dwordx4 v4, s[8:11], s46 offen offset:128 lds
  s_add_u32 m0, s31, 7936
  s_nop 0
  buffer_load_dwordx4 v4, s[8:11], s46 offen offset:256 lds
  s_add_u32 m0, s31, 11904
  s_nop 0
  buffer_load_dwordx4 v4, s[8:11], s46 offen offset:384 lds
  s_add_u32 m0, s31, 15872
  s_nop 0
  buffer_load_dwordx4 v4, s[8:11], s46 offen offset:512 lds
  s_add_u32 m0, s31, 19840
  s_nop 0
  buffer_load_dwordx4 v4, s[8:11], s46 offen offset:640 lds
  s_add_u32 m0, s31, 23808
  s_nop 0
  buffer_load_dwordx4 v4, s[8:11], s46 offen offset:768 lds
  s_add_u32 m0, s31, 27776
  s_nop 0
  buffer_load_dwordx4 v4, s[8:11], s46 offen offset:896 lds
  s_add_u32 m0, s31, 31744
  s_nop 0
  buffer_load_dwordx4 v4, s[8:11], s46 offen offset:1024 lds
  s_add_u32 m0, s31, 35712
  s_nop 0
  buffer_load_dwordx4 v4, s[8:11], s46 offen offset:1152 lds
  s_add_u32 s31, s31, 40960
  s_add_u32 m0, s31, 0
  s_nop 0
  buffer_load_dwordx4 v4, s[8:11], s30 offen offset:0 lds
  s_add_u32 m0, s31, 3968
  s_nop 0
  buffer_load_dwordx4 v4, s[8:11], s30 offen offset:128 lds
  s_add_u32 m0, s31, 7936
  s_nop 0
  buffer_load_dwordx4 v4, s[8:11], s30 offen offset:256 lds
  s_add_u32 m0, s31, 11904
  s_nop 0
  buffer_load_dwordx4 v4, s[8:11], s30 offen offset:384 lds
  s_add_u32 m0, s31, 15872
  s_nop 0
  buffer_load_dwordx4 v4, s[8:11], s30 offen offset:512 lds
  s_add_u32 m0, s31, 19840
  s_nop 0
  buffer_load_dwordx4 v4, s[8:11], s30 offen offset:640 lds
  s_add_u32 m0, s31, 23808
  s_nop 0
  buffer_load_dwordx4 v4, s[8:11], s30 offen offset:768 lds
  s_add_u32 m0, s31, 27776
  s_nop 0
  buffer_load_dwordx4 v4, s[8:11], s30 offen offset:896 lds
  s_add_u32 m0, s31, 31744
  s_nop 0
  buffer_load_dwordx4 v4, s[8:11], s30 offen offset:1024 lds
  s_add_u32 m0, s31, 35712
  s_nop 0
  buffer_load_dwordx4 v4, s[8:11], s30 offen offset:1152 lds
  s_add_u32 s31, s31, 40960
  s_add_u32 s30, s30, 40960
  v_and_b32 v10, 7, v2
  v_add_u32 v8, 0, v3
  v_xor_b32 v8, v8, v10
  v_lshlrev_b32 v8, 4, v8
  v_lshl_add_u32 v5, v2, 7, v8
  v_add_u32 v8, 4, v3
  v_xor_b32 v8, v8, v10
  v_lshlrev_b32 v8, 4, v8
  v_lshl_add_u32 v6, v2, 7, v8
  v_mov_b32 v7, v5
  v_mov_b32 v8, v6
  s_mov_b32 s33, 0
  v_lshlrev_b32 v15, 4, v1
  v_mov_b32 v16, 0xf149f2ca
  v_lshrrev_b32 v17, 3, v2
  v_mul_u32_u24 v17, 2560, v17
  v_lshlrev_b32 v18, 1, v10
  s_lshr_b32 s21, s20, 1
  s_lshl_b32 s21, s21, 10
  s_and_b32 s22, s20, 1
  s_lshl_b32 s22, s22, 3
  s_add_u32 s21, s21, s22
  s_add_u32 s21, s21, 131072
  v_lshl_add_u32 v9, v3, 4, v18
  v_lshl_add_u32 v9, v9, 4, v17
  v_add_u32 v9, s21, v9
  s_lshl_b32 s21, s20, 7
  s_add_u32 s21, s21, 133120
  v_lshl_add_u32 v10, v18, 3, v17
  v_add_u32 v10, s21, v10
  v_cmp_eq_u32 vcc, 2, v3
  v_lshlrev_b32 v19, 4, v1
  v_add_u32 v19, 136192, v19
  v_cndmask_b32 v10, v19, v10, vcc
  s_lshr_b32 s21, s20, 1
  s_and_b32 s22, s20, 1
  s_mul_i32 s23, s21, 2560
  s_lshl_b32 s47, s22, 10
  s_add_u32 s47, s47, s23
  s_add_u32 s47, s47, 131072
  v_add_u32 v11, s47, v15
  s_lshl_b32 s47, s22, 8
  s_add_u32 s47, s47, s23
  s_add_u32 s47, s47, 133120
  v_add_u32 v12, s47, v15
  s_mul_i32 s23, s22, 768
  s_sub_u32 s23, 2048, s23
  v_add_u32 v14, s23, v15
  v_mov_b32 v19, 1073741824
  v_cmp_gt_u32 vcc, 16, v1
  s_lshl_b32 s47, s42, 23
  s_lshl_b32 s21, s21, 14
  v_cndmask_b32 v14, v19, v14, vcc
  s_add_u32 s47, s47, s21
  s_lshr_b32 s21, s41, 1
  s_lshl_b32 s21, s21, 15
  s_add_u32 s47, s47, s21
  s_and_b32 s21, s41, 1
  s_mul_i32 s21, s21, 2560
  s_add_u32 s47, s47, s21
  s_xor_b32 s21, s80, 184819712
  s_add_u32 s47, s47, s21
  s_lshl_b32 s22, s22, 10
  s_add_u32 s47, s47, s22
  s_mov_b32 s48, 1073741824
  s_mov_b32 s49, 1073741824
  v_cmp_eq_u32 s[62:63], 0, v3
  v_lshlrev_b32 v17, 2, v3
  v_sub_u32 v17, v17, v2
  s_mov_b32 s82, 0x3e64f92e
  s_mov_b32 s83, 0x3fb8aa3b
  v_mov_b32 v20, 0
  v_mov_b32 v21, 0
  v_mov_b32 v22, 0
  v_mov_b32 v23, 0
  v_add_u32 v18, 7, v17
  v_cmp_gt_u32 s[84:85], 8, v18
  v_cmp_le_i32 s[64:65], 16, v18
  v_mov_b32 v18, 65535
  v_cndmask_b32 v19, 0, v18, s[84:85]
  v_or_b32 v20, v20, v19
  v_cndmask_b32 v19, 0, v18, s[64:65]
  v_or_b32 v22, v22, v19
  s_mov_b64 s[54:55], s[84:85]
  s_or_b64 s[84:85], s[84:85], s[64:65]
  v_add_u32 v18, 8, v17
  v_cmp_gt_u32 s[86:87], 8, v18
  v_cmp_le_i32 s[66:67], 16, v18
  v_mov_b32 v18, 4294901760
  v_cndmask_b32 v19, 0, v18, s[86:87]
  v_or_b32 v20, v20, v19
  v_cndmask_b32 v19, 0, v18, s[66:67]
  v_or_b32 v22, v22, v19
  s_mov_b64 s[56:57], s[86:87]
  s_or_b64 s[86:87], s[86:87], s[66:67]
  v_add_u32 v18, 9, v17
  v_cmp_gt_u32 s[88:89], 8, v18
  v_cmp_le_i32 s[68:69], 16, v18
  v_mov_b32 v18, 65535
  v_cndmask_b32 v19, 0, v18, s[88:89]
  v_or_b32 v21, v21, v19
  v_cndmask_b32 v19, 0, v18, s[68:69]
  v_or_b32 v23, v23, v19
  s_mov_b64 s[58:59], s[88:89]
  s_or_b64 s[88:89], s[88:89], s[68:69]
  v_add_u32 v18, 10, v17
  v_cmp_gt_u32 s[90:91], 8, v18
  v_cmp_le_i32 s[70:71], 16, v18
  v_mov_b32 v18, 4294901760
  v_cndmask_b32 v19, 0, v18, s[90:91]
  v_or_b32 v21, v21, v19
  v_cndmask_b32 v19, 0, v18, s[70:71]
  v_or_b32 v23, v23, v19
  s_mov_b64 s[60:61], s[90:91]
  s_or_b64 s[90:91], s[90:91], s[70:71]
  v_mov_b32 v18, 0x3f80
  v_mov_b32 v19, 0x3f800000
  v_cmp_eq_i32 vcc, 0, v17
  v_cmp_eq_i32 s[22:23], -1, v17
  s_nop 1
  v_cndmask_b32 v24, 0, v18, vcc
  v_cndmask_b32 v24, v24, v19, s[22:23]
  v_cmp_eq_i32 vcc, -2, v17
  v_cmp_eq_i32 s[22:23], -3, v17
  s_nop 1
  v_cndmask_b32 v25, 0, v18, vcc
  v_cndmask_b32 v25, v25, v19, s[22:23]
  v_mov_b32 v26, 0
  v_mov_b32 v27, 0
  v_mov_b32 v60, 0
  v_mov_b32 v61, 0
  v_mov_b32 v62, 0
  v_mov_b32 v63, 0
  v_mov_b32 v64, 0
  v_mov_b32 v65, 0
  v_mov_b32 v66, 0
  v_mov_b32 v67, 0
  v_mov_b32 v68, 0
  v_mov_b32 v69, 0
  v_mov_b32 v70, 0
  v_mov_b32 v71, 0
  v_mov_b32 v72, 0
  v_mov_b32 v73, 0
  v_mov_b32 v74, 0
  v_mov_b32 v75, 0
  v_mov_b32 v76, 0
  v_mov_b32 v77, 0
  v_mov_b32 v78, 0
  v_mov_b32 v79, 0
  v_mov_b32 v80, 0
  v_mov_b32 v81, 0
  v_mov_b32 v82, 0
  v_mov_b32 v83, 0
  v_mov_b32 v84, 0
  v_mov_b32 v85, 0
  v_mov_b32 v86, 0
  v_mov_b32 v87, 0
  v_mov_b32 v88, 0
  v_mov_b32 v89, 0
  v_mov_b32 v90, 0
  v_mov_b32 v91, 0
  v_mov_b32 v92, 0
  v_mov_b32 v93, 0
  v_mov_b32 v94, 0
  v_mov_b32 v95, 0
  v_mov_b32 v96, 0
  v_mov_b32 v97, 0
  v_mov_b32 v98, 0
  v_mov_b32 v99, 0
  v_mov_b32 v100, 0
  v_mov_b32 v101, 0
  v_mov_b32 v102, 0
  v_mov_b32 v103, 0
  v_mov_b32 v104, 0
  v_mov_b32 v105, 0
  v_mov_b32 v106, 0
  v_mov_b32 v107, 0
  v_mov_b32 v108, 0
  v_mov_b32 v109, 0
  v_mov_b32 v110, 0
  v_mov_b32 v111, 0
  v_mov_b32 v112, 0
  v_mov_b32 v113, 0
  v_mov_b32 v114, 0
  v_mov_b32 v115, 0
  v_mov_b32 v116, 0
  v_mov_b32 v117, 0
  v_mov_b32 v118, 0
  v_mov_b32 v119, 0
  v_mov_b32 v120, 0
  v_mov_b32 v121, 0
  v_mov_b32 v122, 0
  v_mov_b32 v123, 0
  v_mov_b32 v124, 0
  v_mov_b32 v125, 0
  v_mov_b32 v126, 0
  v_mov_b32 v127, 0
  v_mov_b32 v128, 0
  v_mov_b32 v129, 0
  v_mov_b32 v130, 0
  v_mov_b32 v131, 0
  s_cmp_eq_u32 s42, 0
  s_cselect_b32 s53, 15, 99
  s_mov_b32 s26, 17
  s_waitcnt vmcnt(10)
  s_barrier
  ds_read_b128 v[28:31], v7 offset:0
  ds_read_b128 v[32:35], v8 offset:0
  ds_read_b128 v[36:39], v7 offset:4096
  ds_read_b128 v[40:43], v8 offset:4096
  s_waitcnt lgkmcnt(3)
  .p2align 3
bfl_258:
  v_mfma_f32_16x16x32_bf16 v[60:63], a[0:3], v[28:31], 0
  ds_read_b128 v[44:47], v7 offset:8192
  v_mfma_f32_16x16x32_bf16 v[64:67], a[4:7], v[28:31], 0
  v_mfma_f32_16x16x32_bf16 v[68:71], a[8:11], v[28:31], 0
  v_cvt_pk_bf16_f32 v128, v84, v85
  v_cvt_pk_bf16_f32 v129, v86, v87
  v_mfma_f32_16x16x32_bf16 v[72:75], v[28:31], a[12:15], 0
  s_waitcnt lgkmcnt(3)
  v_cvt_pk_bf16_f32 v124, v76, v77
  v_cvt_pk_bf16_f32 v125, v78, v79
  v_mfma_f32_16x16x32_bf16 v[60:63], a[16:19], v[32:35], v[60:63]
  ds_read_b128 v[48:51], v8 offset:8192
  v_cvt_pk_bf16_f32 v100, v80, v81
  v_mfma_f32_16x16x32_bf16 v[64:67], a[20:23], v[32:35], v[64:67]
  v_cvt_pk_bf16_f32 v101, v82, v83
  v_cvt_pk_bf16_f32 v116, v88, v89
  v_mfma_f32_16x16x32_bf16 v[68:71], a[24:27], v[32:35], v[68:71]
  s_add_u32 m0, s31, 0
  v_cvt_pk_bf16_f32 v117, v90, v91
  v_cndmask_b32 v126, 0, v128, s[62:63]
  v_mfma_f32_16x16x32_bf16 v[72:75], v[32:35], a[28:31], v[72:75]
  s_waitcnt lgkmcnt(3)
  v_cndmask_b32 v127, 0, v129, s[62:63]
  buffer_load_dwordx4 v4, s[8:11], s30 offen offset:0 lds
  v_mfma_f32_16x16x32_bf16 v[60:63], a[32:35], v[36:39], v[60:63]
  ds_read_b128 v[52:55], v7 offset:12288
  v_mfma_f32_16x16x32_bf16 v[64:67], a[36:39], v[36:39], v[64:67]
  v_mfma_f32_16x16x32_bf16 v[68:71], a[40:43], v[36:39], v[68:71]
  v_mfma_f32_16x16x32_bf16 v[72:75], v[36:39], a[44:47], v[72:75]
  v_mfma_f32_16x16x32_bf16 v[132:135], v[128:131], v[24:27], 0
  s_waitcnt lgkmcnt(3)
  v_permlane16_swap_b32 v128, v102
  v_permlane16_swap_b32 v129, v103
  v_mfma_f32_16x16x32_bf16 v[60:63], a[48:51], v[40:43], v[60:63]
  ds_read_b128 v[56:59], v8 offset:12288
  v_mfma_f32_16x16x32_bf16 v[64:67], a[52:55], v[40:43], v[64:67]
  v_mfma_f32_16x16x32_bf16 v[68:71], a[56:59], v[40:43], v[68:71]
  v_mfma_f32_16x16x32_bf16 v[72:75], v[40:43], a[60:63], v[72:75]
  v_mfma_f32_16x16x32_bf16 v[136:139], v[100:103], v[124:127], 0
  v_mfma_f32_16x16x32_bf16 v[140:143], v[104:107], v[124:127], 0
  s_add_u32 m0, s31, 3968
  s_waitcnt lgkmcnt(3)
  v_mfma_f32_16x16x32_bf16 v[60:63], a[64:67], v[44:47], v[60:63]
  ds_read_b128 v[28:31], v7 offset:16384
  buffer_load_dwordx4 v4, s[8:11], s30 offen offset:128 lds
  v_mfma_f32_16x16x32_bf16 v[64:67], a[68:71], v[44:47], v[64:67]
  v_mfma_f32_16x16x32_bf16 v[68:71], a[72:75], v[44:47], v[68:71]
  v_cvt_pk_bf16_f32 v120, v132, v133
  v_cvt_pk_bf16_f32 v121, v134, v135
  v_mfma_f32_16x16x32_bf16 v[72:75], v[44:47], a[76:79], v[72:75]
  s_waitcnt lgkmcnt(3)
  v_cndmask_b32 v136, v136, v140, s[64:65]
  v_cndmask_b32 v137, v137, v141, s[66:67]
  v_mfma_f32_16x16x32_bf16 v[60:63], a[80:83], v[48:51], v[60:63]
  ds_read_b128 v[32:35], v8 offset:16384
  v_cndmask_b32 v138, v138, v142, s[68:69]
  v_mfma_f32_16x16x32_bf16 v[64:67], a[84:87], v[48:51], v[64:67]
  v_cndmask_b32 v139, v139, v143, s[70:71]
  v_cvt_pk_bf16_f32 v17, v136, v137
  v_mfma_f32_16x16x32_bf16 v[68:71], a[88:91], v[48:51], v[68:71]
  v_lshlrev_b32 v136, 16, v17
  v_and_b32 v137, 0xffff0000, v17
  v_mfma_f32_16x16x32_bf16 v[72:75], v[48:51], a[92:95], v[72:75]
  s_waitcnt lgkmcnt(3)
  v_cvt_pk_bf16_f32 v17, v138, v139
  v_lshlrev_b32 v138, 16, v17
  v_mfma_f32_16x16x32_bf16 v[60:63], a[96:99], v[52:55], v[60:63]
  ds_read_b128 v[36:39], v7 offset:20480
  v_and_b32 v139, 0xffff0000, v17
  v_mfma_f32_16x16x32_bf16 v[64:67], a[100:103], v[52:55], v[64:67]
  v_mul_f32 v136, s82, v136
  v_mul_f32 v137, s82, v137
  v_mfma_f32_16x16x32_bf16 v[68:71], a[104:107], v[52:55], v[68:71]
  v_mul_f32 v138, s82, v138
  v_mul_f32 v139, s82, v139
  v_mfma_f32_16x16x32_bf16 v[72:75], v[52:55], a[108:111], v[72:75]
  s_waitcnt lgkmcnt(3)
  v_cvt_pk_bf16_f32 v17, v136, v137
  v_lshlrev_b32 v136, 16, v17
  v_mfma_f32_16x16x32_bf16 v[60:63], a[112:115], v[56:59], v[60:63]
  s_add_u32 m0, s31, 7936
  ds_read_b128 v[40:43], v8 offset:20480
  v_and_b32 v137, 0xffff0000, v17
  v_mfma_f32_16x16x32_bf16 v[64:67], a[116:119], v[56:59], v[64:67]
  v_cvt_pk_bf16_f32 v17, v138, v139
  v_lshlrev_b32 v138, 16, v17
  v_mfma_f32_16x16x32_bf16 v[68:71], a[120:123], v[56:59], v[68:71]
  v_and_b32 v139, 0xffff0000, v17
  v_cndmask_b32 v136, v16, v136, s[54:55]
  v_mfma_f32_16x16x32_bf16 v[72:75], v[56:59], a[124:127], v[72:75]
  s_waitcnt lgkmcnt(3)
  v_cndmask_b32 v137, v16, v137, s[56:57]
  v_cndmask_b32 v138, v16, v138, s[58:59]
  v_mfma_f32_16x16x32_bf16 v[60:63], a[128:131], v[28:31], v[60:63]
  ds_read_b128 v[44:47], v7 offset:24576
  v_cndmask_b32 v139, v16, v139, s[60:61]
  v_mfma_f32_16x16x32_bf16 v[64:67], a[132:135], v[28:31], v[64:67]
  v_max3_f32 v17, v136, v137, v138
  v_max_f32 v17, v17, v139
  v_mfma_f32_16x16x32_bf16 v[68:71], a[136:139], v[28:31], v[68:71]
  v_mov_b32 v18, v17
  buffer_load_dwordx4 v4, s[8:11], s30 offen offset:256 lds
  v_mfma_f32_16x16x32_bf16 v[72:75], v[28:31], a[140:143], v[72:75]
  s_waitcnt lgkmcnt(3)
  v_permlane32_swap_b32 v17, v18
  v_max_f32 v17, v17, v18
  v_mfma_f32_16x16x32_bf16 v[60:63], a[144:147], v[32:35], v[60:63]
  ds_read_b128 v[48:51], v8 offset:24576
  v_mov_b32 v18, v17
  v_mfma_f32_16x16x32_bf16 v[64:67], a[148:151], v[32:35], v[64:67]
  v_permlane16_swap_b32 v17, v18
  v_max_f32 v17, v17, v18
  v_mfma_f32_16x16x32_bf16 v[68:71], a[152:155], v[32:35], v[68:71]
  v_mul_f32 v17, s83, v17
  v_fma_f32 v136, v136, s83, -v17
  v_mfma_f32_16x16x32_bf16 v[72:75], v[32:35], a[156:159], v[72:75]
  s_waitcnt lgkmcnt(3)
  v_fma_f32 v137, v137, s83, -v17
  v_fma_f32 v138, v138, s83, -v17
  v_mfma_f32_16x16x32_bf16 v[60:63], a[160:163], v[36:39], v[60:63]
  s_add_u32 m0, s31, 11904
  ds_read_b128 v[52:55], v7 offset:28672
  v_fma_f32 v139, v139, s83, -v17
  v_mfma_f32_16x16x32_bf16 v[64:67], a[164:167], v[36:39], v[64:67]
  v_exp_f32 v136, v136
  v_mfma_f32_16x16x32_bf16 v[68:71], a[168:171], v[36:39], v[68:71]
  v_exp_f32 v137, v137
  v_mfma_f32_16x16x32_bf16 v[72:75], v[36:39], a[172:175], v[72:75]
  s_waitcnt lgkmcnt(3)
  v_exp_f32 v138, v138
  v_mfma_f32_16x16x32_bf16 v[60:63], a[176:179], v[40:43], v[60:63]
  ds_read_b128 v[56:59], v8 offset:28672
  buffer_load_dwordx4 v4, s[8:11], s30 offen offset:384 lds
  v_mfma_f32_16x16x32_bf16 v[64:67], a[180:183], v[40:43], v[64:67]
  v_exp_f32 v139, v139
  v_mfma_f32_16x16x32_bf16 v[68:71], a[184:187], v[40:43], v[68:71]
  v_add_f32 v17, v136, v137
  v_add_f32 v18, v138, v139
  v_mfma_f32_16x16x32_bf16 v[72:75], v[40:43], a[188:191], v[72:75]
  s_waitcnt lgkmcnt(3)
  v_add_f32 v17, v17, v18
  v_mov_b32 v18, v17
  v_mfma_f32_16x16x32_bf16 v[60:63], a[192:195], v[44:47], v[60:63]
  ds_read_b128 v[28:31], v7 offset:32768
  v_permlane32_swap_b32 v17, v18
  v_mfma_f32_16x16x32_bf16 v[64:67], a[196:199], v[44:47], v[64:67]
  v_add_f32 v17, v17, v18
  v_mov_b32 v18, v17
  v_mfma_f32_16x16x32_bf16 v[68:71], a[200:203], v[44:47], v[68:71]
  v_permlane16_swap_b32 v17, v18
  v_add_f32 v17, v17, v18
  v_mfma_f32_16x16x32_bf16 v[72:75], v[44:47], a[204:207], v[72:75]
  s_waitcnt lgkmcnt(3)
  v_rcp_f32 v17, v17
  v_mfma_f32_16x16x32_bf16 v[60:63], a[208:211], v[48:51], v[60:63]
  s_add_u32 m0, s31, 15872
  ds_read_b128 v[32:35], v8 offset:32768
  v_mul_f32 v136, v136, v17
  v_mfma_f32_16x16x32_bf16 v[64:67], a[212:215], v[48:51], v[64:67]
  v_mul_f32 v137, v137, v17
  v_mul_f32 v138, v138, v17
  v_mfma_f32_16x16x32_bf16 v[68:71], a[216:219], v[48:51], v[68:71]
  v_mul_f32 v139, v139, v17
  v_cvt_pk_bf16_f32 v144, v136, v137
  v_mfma_f32_16x16x32_bf16 v[72:75], v[48:51], a[220:223], v[72:75]
  s_waitcnt lgkmcnt(3)
  v_cvt_pk_bf16_f32 v145, v138, v139
  v_and_b32 v146, v144, v22
  v_mfma_f32_16x16x32_bf16 v[60:63], a[224:227], v[52:55], v[60:63]
  ds_read_b128 v[36:39], v7 offset:36864
  v_and_b32 v147, v145, v23
  v_mfma_f32_16x16x32_bf16 v[64:67], a[228:231], v[52:55], v[64:67]
  v_and_b32 v144, v144, v20
  v_and_b32 v145, v145, v21
  v_mfma_f32_16x16x32_bf16 v[68:71], a[232:235], v[52:55], v[68:71]
  buffer_load_dwordx4 v4, s[8:11], s30 offen offset:512 lds
  v_mfma_f32_16x16x32_bf16 v[72:75], v[52:55], a[236:239], v[72:75]
  s_waitcnt lgkmcnt(3)
  v_mfma_f32_16x16x32_bf16 v[60:63], a[240:243], v[56:59], v[60:63]
  ds_read_b128 v[40:43], v8 offset:36864
  v_mfma_f32_16x16x32_bf16 v[64:67], a[244:247], v[56:59], v[64:67]
  v_mfma_f32_16x16x32_bf16 v[68:71], a[248:251], v[56:59], v[68:71]
  v_mfma_f32_16x16x32_bf16 v[72:75], v[56:59], a[252:255], v[72:75]
  s_add_u32 m0, s31, 19840
  s_waitcnt lgkmcnt(3)
  v_mfma_f32_16x16x32_bf16 v[60:63], v[192:195], v[28:31], v[60:63]
  ds_read_b128 v[44:47], v7 offset:2048
  buffer_load_dwordx4 v4, s[8:11], s30 offen offset:640 lds
  v_mfma_f32_16x16x32_bf16 v[64:67], v[196:199], v[28:31], v[64:67]
  v_mfma_f32_16x16x32_bf16 v[68:71], v[200:203], v[28:31], v[68:71]
  v_mfma_f32_16x16x32_bf16 v[72:75], v[28:31], v[204:207], v[72:75]
  v_mfma_f32_16x16x32_bf16 v[148:151], v[116:119], v[144:147], 0
  s_cmp_le_u32 s26, s53
  s_cselect_b64 s[54:55], s[84:85], s[54:55]
  v_mfma_f32_16x16x32_bf16 v[152:155], v[120:123], v[144:147], 0
  s_waitcnt lgkmcnt(3)
  v_mov_b32 v104, v100
  v_mov_b32 v105, v101
  v_mfma_f32_16x16x32_bf16 v[60:63], v[208:211], v[32:35], v[60:63]
  ds_read_b128 v[48:51], v8 offset:2048
  v_mov_b32 v106, v102
  v_mfma_f32_16x16x32_bf16 v[64:67], v[212:215], v[32:35], v[64:67]
  v_mov_b32 v107, v103
  v_mov_b32 v118, v116
  v_mfma_f32_16x16x32_bf16 v[68:71], v[216:219], v[32:35], v[68:71]
  v_cvt_pk_bf16_f32 v156, v148, v149
  v_cvt_pk_bf16_f32 v157, v150, v151
  v_mfma_f32_16x16x32_bf16 v[72:75], v[32:35], v[220:223], v[72:75]
  s_waitcnt lgkmcnt(3)
  ds_write_b64 v9, v[156:157] offset:16
  v_cvt_pk_bf16_f32 v158, v152, v153
  v_mfma_f32_16x16x32_bf16 v[60:63], v[224:227], v[36:39], v[60:63]
  ds_read_b128 v[52:55], v7 offset:6144
  v_cvt_pk_bf16_f32 v159, v154, v155
  v_mfma_f32_16x16x32_bf16 v[64:67], v[228:231], v[36:39], v[64:67]
  s_add_u32 m0, s31, 23808
  ds_write_b64 v10, v[158:159] offset:8
  v_mov_b32 v119, v117
  v_mfma_f32_16x16x32_bf16 v[68:71], v[232:235], v[36:39], v[68:71]
  v_mov_b32 v122, v120
  v_mov_b32 v123, v121
  v_mfma_f32_16x16x32_bf16 v[72:75], v[36:39], v[236:239], v[72:75]
  s_waitcnt lgkmcnt(5)
  buffer_load_dwordx4 v4, s[8:11], s30 offen offset:768 lds
  v_mfma_f32_16x16x32_bf16 v[60:63], v[240:243], v[40:43], v[60:63]
  ds_read_b128 v[56:59], v8 offset:6144
  v_mfma_f32_16x16x32_bf16 v[64:67], v[244:247], v[40:43], v[64:67]
  s_cmp_le_u32 s26, s53
  s_cselect_b64 s[56:57], s[86:87], s[56:57]
  v_mfma_f32_16x16x32_bf16 v[68:71], v[248:251], v[40:43], v[68:71]
  s_cmp_le_u32 s26, s53
  s_cselect_b64 s[58:59], s[88:89], s[58:59]
  v_mfma_f32_16x16x32_bf16 v[72:75], v[40:43], v[252:255], v[72:75]
  s_waitcnt lgkmcnt(5)
  s_cmp_le_u32 s26, s53
  s_cselect_b64 s[60:61], s[90:91], s[60:61]
  v_mfma_f32_16x16x32_bf16 v[76:79], a[0:3], v[44:47], 0
  ds_read_b128 v[28:31], v7 offset:10240
  v_mfma_f32_16x16x32_bf16 v[80:83], a[4:7], v[44:47], 0
  s_waitcnt lgkmcnt(2)
  s_barrier
  v_mfma_f32_16x16x32_bf16 v[84:87], a[8:11], v[44:47], 0
  v_cvt_pk_bf16_f32 v128, v68, v69
  v_cvt_pk_bf16_f32 v129, v70, v71
  v_mfma_f32_16x16x32_bf16 v[88:91], v[44:47], a[12:15], 0
  s_waitcnt lgkmcnt(5)
  v_cvt_pk_bf16_f32 v124, v60, v61
  v_cvt_pk_bf16_f32 v125, v62, v63
  v_mfma_f32_16x16x32_bf16 v[76:79], a[16:19], v[48:51], v[76:79]
  ds_read_b128 v[32:35], v8 offset:10240
  v_cvt_pk_bf16_f32 v92, v64, v65
  v_mfma_f32_16x16x32_bf16 v[80:83], a[20:23], v[48:51], v[80:83]
  s_add_u32 m0, s31, 27776
  v_cvt_pk_bf16_f32 v93, v66, v67
  v_cvt_pk_bf16_f32 v108, v72, v73
  v_mfma_f32_16x16x32_bf16 v[84:87], a[24:27], v[48:51], v[84:87]
  v_cvt_pk_bf16_f32 v109, v74, v75
  v_cndmask_b32 v126, 0, v128, s[62:63]
  v_mfma_f32_16x16x32_bf16 v[88:91], v[48:51], a[28:31], v[88:91]
  s_waitcnt lgkmcnt(4)
  v_cndmask_b32 v127, 0, v129, s[62:63]
  v_xor_b32 v9, 8192, v9
  v_mfma_f32_16x16x32_bf16 v[76:79], a[32:35], v[52:55], v[76:79]
  ds_read_b128 v[36:39], v7 offset:14336
  v_xor_b32 v10, 8192, v10
  v_mfma_f32_16x16x32_bf16 v[80:83], a[36:39], v[52:55], v[80:83]
  ds_read_b128 v[160:163], v11
  ds_read_b128 v[164:167], v12
  v_mfma_f32_16x16x32_bf16 v[84:87], a[40:43], v[52:55], v[84:87]
  buffer_load_dwordx4 v4, s[8:11], s30 offen offset:896 lds
  v_mfma_f32_16x16x32_bf16 v[88:91], v[52:55], a[44:47], v[88:91]
  v_mfma_f32_16x16x32_bf16 v[132:135], v[128:131], v[24:27], 0
  s_waitcnt lgkmcnt(5)
  v_permlane16_swap_b32 v128, v94
  v_permlane16_swap_b32 v129, v95
  v_mfma_f32_16x16x32_bf16 v[76:79], a[48:51], v[56:59], v[76:79]
  ds_read_b128 v[40:43], v8 offset:14336
  v_mfma_f32_16x16x32_bf16 v[80:83], a[52:55], v[56:59], v[80:83]
  v_mfma_f32_16x16x32_bf16 v[84:87], a[56:59], v[56:59], v[84:87]
  s_waitcnt lgkmcnt(1)
  buffer_store_dwordx4 v[160:163], v15, s[16:19], s49 offen sc1
  buffer_store_dwordx4 v[164:167], v14, s[16:19], s49 offen sc1
  v_mfma_f32_16x16x32_bf16 v[88:91], v[56:59], a[60:63], v[88:91]
  v_xor_b32 v11, 8192, v11
  v_xor_b32 v12, 8192, v12
  v_mfma_f32_16x16x32_bf16 v[136:139], v[92:95], v[124:127], 0
  s_add_u32 m0, s31, 31744
  s_mov_b32 s49, s48
  s_mov_b32 s48, s47
  v_mfma_f32_16x16x32_bf16 v[140:143], v[96:99], v[124:127], 0
  s_add_u32 s22, s47, 524288
  s_waitcnt lgkmcnt(5)
  buffer_load_dwordx4 v4, s[8:11], s30 offen offset:1024 lds
  v_mfma_f32_16x16x32_bf16 v[76:79], a[64:67], v[28:31], v[76:79]
  s_xor_b32 s47, s47, s22
  ds_read_b128 v[44:47], v7 offset:18432
  s_lshr_b32 s47, s47, 8
  v_mfma_f32_16x16x32_bf16 v[80:83], a[68:71], v[28:31], v[80:83]
  s_and_b32 s47, s47, 8192
  s_xor_b32 s47, s47, s22
  s_sub_u32 s26, s26, 1
  v_mfma_f32_16x16x32_bf16 v[84:87], a[72:75], v[28:31], v[84:87]
  v_cvt_pk_bf16_f32 v112, v132, v133
  v_cvt_pk_bf16_f32 v113, v134, v135
  v_mfma_f32_16x16x32_bf16 v[88:91], v[28:31], a[76:79], v[88:91]
  s_waitcnt lgkmcnt(5)
  v_cndmask_b32 v136, v136, v140, s[64:65]
  v_cndmask_b32 v137, v137, v141, s[66:67]
  v_mfma_f32_16x16x32_bf16 v[76:79], a[80:83], v[32:35], v[76:79]
  ds_read_b128 v[48:51], v8 offset:18432
  v_cndmask_b32 v138, v138, v142, s[68:69]
  v_mfma_f32_16x16x32_bf16 v[80:83], a[84:87], v[32:35], v[80:83]
  v_cndmask_b32 v139, v139, v143, s[70:71]
  v_cvt_pk_bf16_f32 v17, v136, v137
  v_mfma_f32_16x16x32_bf16 v[84:87], a[88:91], v[32:35], v[84:87]
  v_lshlrev_b32 v136, 16, v17
  v_and_b32 v137, 0xffff0000, v17
  v_mfma_f32_16x16x32_bf16 v[88:91], v[32:35], a[92:95], v[88:91]
  s_waitcnt lgkmcnt(5)
  v_cvt_pk_bf16_f32 v17, v138, v139
  v_lshlrev_b32 v138, 16, v17
  v_mfma_f32_16x16x32_bf16 v[76:79], a[96:99], v[36:39], v[76:79]
  ds_read_b128 v[52:55], v7 offset:22528
  v_and_b32 v139, 0xffff0000, v17
  v_mfma_f32_16x16x32_bf16 v[80:83], a[100:103], v[36:39], v[80:83]
  v_mul_f32 v136, s82, v136
  v_mul_f32 v137, s82, v137
  v_mfma_f32_16x16x32_bf16 v[84:87], a[104:107], v[36:39], v[84:87]
  s_add_u32 m0, s31, 35712
  v_mul_f32 v138, s82, v138
  v_mul_f32 v139, s82, v139
  v_mfma_f32_16x16x32_bf16 v[88:91], v[36:39], a[108:111], v[88:91]
  s_waitcnt lgkmcnt(3)
  v_cvt_pk_bf16_f32 v17, v136, v137
  v_lshlrev_b32 v136, 16, v17
  v_mfma_f32_16x16x32_bf16 v[76:79], a[112:115], v[40:43], v[76:79]
  ds_read_b128 v[56:59], v8 offset:22528
  v_and_b32 v137, 0xffff0000, v17
  v_mfma_f32_16x16x32_bf16 v[80:83], a[116:119], v[40:43], v[80:83]
  v_cvt_pk_bf16_f32 v17, v138, v139
  v_lshlrev_b32 v138, 16, v17
  v_mfma_f32_16x16x32_bf16 v[84:87], a[120:123], v[40:43], v[84:87]
  v_and_b32 v139, 0xffff0000, v17
  v_cndmask_b32 v136, v16, v136, s[54:55]
  v_mfma_f32_16x16x32_bf16 v[88:91], v[40:43], a[124:127], v[88:91]
  s_waitcnt lgkmcnt(3)
  v_cndmask_b32 v137, v16, v137, s[56:57]
  v_cndmask_b32 v138, v16, v138, s[58:59]
  v_mfma_f32_16x16x32_bf16 v[76:79], a[128:131], v[44:47], v[76:79]
  ds_read_b128 v[28:31], v7 offset:26624
  v_cndmask_b32 v139, v16, v139, s[60:61]
  v_mfma_f32_16x16x32_bf16 v[80:83], a[132:135], v[44:47], v[80:83]
  v_max3_f32 v17, v136, v137, v138
  v_max_f32 v17, v17, v139
  v_mfma_f32_16x16x32_bf16 v[84:87], a[136:139], v[44:47], v[84:87]
  v_mov_b32 v18, v17
  buffer_load_dwordx4 v4, s[8:11], s30 offen offset:1152 lds
  v_mfma_f32_16x16x32_bf16 v[88:91], v[44:47], a[140:143], v[88:91]
  s_waitcnt lgkmcnt(3)
  v_permlane32_swap_b32 v17, v18
  v_max_f32 v17, v17, v18
  v_mfma_f32_16x16x32_bf16 v[76:79], a[144:147], v[48:51], v[76:79]
  s_add_u32 s30, s30, 40960
  ds_read_b128 v[32:35], v8 offset:26624
  v_mov_b32 v18, v17
  v_mfma_f32_16x16x32_bf16 v[80:83], a[148:151], v[48:51], v[80:83]
  s_add_u32 s31, s31, 40960
  v_permlane16_swap_b32 v17, v18
  v_max_f32 v17, v17, v18
  v_mfma_f32_16x16x32_bf16 v[84:87], a[152:155], v[48:51], v[84:87]
  v_mul_f32 v17, s83, v17
  v_fma_f32 v136, v136, s83, -v17
  v_mfma_f32_16x16x32_bf16 v[88:91], v[48:51], a[156:159], v[88:91]
  s_waitcnt lgkmcnt(3)
  v_fma_f32 v137, v137, s83, -v17
  v_fma_f32 v138, v138, s83, -v17
  v_mfma_f32_16x16x32_bf16 v[76:79], a[160:163], v[52:55], v[76:79]
  ds_read_b128 v[36:39], v7 offset:30720
  v_fma_f32 v139, v139, s83, -v17
  v_mfma_f32_16x16x32_bf16 v[80:83], a[164:167], v[52:55], v[80:83]
  v_exp_f32 v136, v136
  v_mfma_f32_16x16x32_bf16 v[84:87], a[168:171], v[52:55], v[84:87]
  v_exp_f32 v137, v137
  v_mfma_f32_16x16x32_bf16 v[88:91], v[52:55], a[172:175], v[88:91]
  s_waitcnt lgkmcnt(3)
  v_exp_f32 v138, v138
  v_mfma_f32_16x16x32_bf16 v[76:79], a[176:179], v[56:59], v[76:79]
  ds_read_b128 v[40:43], v8 offset:30720
  v_mfma_f32_16x16x32_bf16 v[80:83], a[180:183], v[56:59], v[80:83]
  v_exp_f32 v139, v139
  v_mfma_f32_16x16x32_bf16 v[84:87], a[184:187], v[56:59], v[84:87]
  v_add_f32 v17, v136, v137
  v_add_f32 v18, v138, v139
  v_mfma_f32_16x16x32_bf16 v[88:91], v[56:59], a[188:191], v[88:91]
  s_waitcnt lgkmcnt(3)
  v_add_f32 v17, v17, v18
  v_mov_b32 v18, v17
  v_mfma_f32_16x16x32_bf16 v[76:79], a[192:195], v[28:31], v[76:79]
  ds_read_b128 v[44:47], v7 offset:34816
  v_permlane32_swap_b32 v17, v18
  v_mfma_f32_16x16x32_bf16 v[80:83], a[196:199], v[28:31], v[80:83]
  v_add_f32 v17, v17, v18
  v_mov_b32 v18, v17
  v_mfma_f32_16x16x32_bf16 v[84:87], a[200:203], v[28:31], v[84:87]
  v_permlane16_swap_b32 v17, v18
  v_add_f32 v17, v17, v18
  v_mfma_f32_16x16x32_bf16 v[88:91], v[28:31], a[204:207], v[88:91]
  s_waitcnt lgkmcnt(3)
  v_rcp_f32 v17, v17
  v_mfma_f32_16x16x32_bf16 v[76:79], a[208:211], v[32:35], v[76:79]
  ds_read_b128 v[48:51], v8 offset:34816
  v_mul_f32 v136, v136, v17
  v_mfma_f32_16x16x32_bf16 v[80:83], a[212:215], v[32:35], v[80:83]
  v_mul_f32 v137, v137, v17
  v_mul_f32 v138, v138, v17
  v_mfma_f32_16x16x32_bf16 v[84:87], a[216:219], v[32:35], v[84:87]
  v_mul_f32 v139, v139, v17
  v_cvt_pk_bf16_f32 v144, v136, v137
  v_mfma_f32_16x16x32_bf16 v[88:91], v[32:35], a[220:223], v[88:91]
  s_waitcnt lgkmcnt(3)
  v_cvt_pk_bf16_f32 v145, v138, v139
  v_and_b32 v146, v144, v22
  v_mfma_f32_16x16x32_bf16 v[76:79], a[224:227], v[36:39], v[76:79]
  ds_read_b128 v[52:55], v7 offset:38912
  v_and_b32 v147, v145, v23
  v_mfma_f32_16x16x32_bf16 v[80:83], a[228:231], v[36:39], v[80:83]
  v_and_b32 v144, v144, v20
  v_and_b32 v145, v145, v21
  v_mfma_f32_16x16x32_bf16 v[84:87], a[232:235], v[36:39], v[84:87]
  s_cmp_ge_u32 s31, 122880
  s_cselect_b32 s21, 122880, 0
  s_sub_u32 s31, s31, s21
  v_mfma_f32_16x16x32_bf16 v[88:91], v[36:39], a[236:239], v[88:91]
  s_add_u32 s33, s33, 40960
  s_waitcnt lgkmcnt(3)
  v_mfma_f32_16x16x32_bf16 v[76:79], a[240:243], v[40:43], v[76:79]
  ds_read_b128 v[56:59], v8 offset:38912
  v_mfma_f32_16x16x32_bf16 v[80:83], a[244:247], v[40:43], v[80:83]
  s_cmp_ge_u32 s33, 122880
  s_cselect_b32 s33, 0, s33
  v_mfma_f32_16x16x32_bf16 v[84:87], a[248:251], v[40:43], v[84:87]
  v_add_u32 v7, s33, v5
  v_add_u32 v8, s33, v6
  v_mfma_f32_16x16x32_bf16 v[88:91], v[40:43], a[252:255], v[88:91]
  s_waitcnt lgkmcnt(3)
  v_mfma_f32_16x16x32_bf16 v[76:79], v[192:195], v[44:47], v[76:79]
  s_waitcnt vmcnt(12)
  s_barrier
  ds_read_b128 v[28:31], v7 offset:0
  v_mfma_f32_16x16x32_bf16 v[80:83], v[196:199], v[44:47], v[80:83]
  v_mfma_f32_16x16x32_bf16 v[84:87], v[200:203], v[44:47], v[84:87]
  v_mfma_f32_16x16x32_bf16 v[88:91], v[44:47], v[204:207], v[88:91]
  v_mfma_f32_16x16x32_bf16 v[148:151], v[108:111], v[144:147], 0
  v_mfma_f32_16x16x32_bf16 v[152:155], v[112:115], v[144:147], 0
  s_waitcnt lgkmcnt(3)
  v_mov_b32 v96, v92
  v_mov_b32 v97, v93
  v_mfma_f32_16x16x32_bf16 v[76:79], v[208:211], v[48:51], v[76:79]
  ds_read_b128 v[32:35], v8 offset:0
  v_mov_b32 v98, v94
  v_mfma_f32_16x16x32_bf16 v[80:83], v[212:215], v[48:51], v[80:83]
  v_mov_b32 v99, v95
  v_mov_b32 v110, v108
  v_mfma_f32_16x16x32_bf16 v[84:87], v[216:219], v[48:51], v[84:87]
  v_cvt_pk_bf16_f32 v156, v148, v149
  v_cvt_pk_bf16_f32 v157, v150, v151
  v_mfma_f32_16x16x32_bf16 v[88:91], v[48:51], v[220:223], v[88:91]
  s_waitcnt lgkmcnt(3)
  ds_write_b64 v9, v[156:157] offset:0
  v_cvt_pk_bf16_f32 v158, v152, v153
  v_mfma_f32_16x16x32_bf16 v[76:79], v[224:227], v[52:55], v[76:79]
  ds_read_b128 v[36:39], v7 offset:4096
  v_cvt_pk_bf16_f32 v159, v154, v155
  v_mfma_f32_16x16x32_bf16 v[80:83], v[228:231], v[52:55], v[80:83]
  ds_write_b64 v10, v[158:159] offset:0
  v_mov_b32 v111, v109
  v_mfma_f32_16x16x32_bf16 v[84:87], v[232:235], v[52:55], v[84:87]
  v_mov_b32 v114, v112
  v_mov_b32 v115, v113
  v_mfma_f32_16x16x32_bf16 v[88:91], v[52:55], v[236:239], v[88:91]
  s_waitcnt lgkmcnt(5)
  v_mfma_f32_16x16x32_bf16 v[76:79], v[240:243], v[56:59], v[76:79]
  ds_read_b128 v[40:43], v8 offset:4096
  v_mfma_f32_16x16x32_bf16 v[80:83], v[244:247], v[56:59], v[80:83]
  v_mfma_f32_16x16x32_bf16 v[84:87], v[248:251], v[56:59], v[84:87]
  s_cmp_gt_u32 s26, 0
  v_mfma_f32_16x16x32_bf16 v[88:91], v[56:59], v[252:255], v[88:91]
  s_waitcnt lgkmcnt(5)
  s_cbranch_scc1 bfl_258
  s_nop 7
  v_cvt_pk_bf16_f32 v128, v84, v85
  v_cvt_pk_bf16_f32 v129, v86, v87
  v_cvt_pk_bf16_f32 v124, v76, v77
  v_cvt_pk_bf16_f32 v125, v78, v79
  v_cvt_pk_bf16_f32 v100, v80, v81
  v_cvt_pk_bf16_f32 v101, v82, v83
  v_cvt_pk_bf16_f32 v116, v88, v89
  v_cvt_pk_bf16_f32 v117, v90, v91
  v_cndmask_b32 v126, 0, v128, s[62:63]
  v_cndmask_b32 v127, 0, v129, s[62:63]
  s_nop 1
  v_mfma_f32_16x16x32_bf16 v[132:135], v[128:131], v[24:27], 0
  s_nop 7
  v_permlane16_swap_b32 v128, v102
  v_permlane16_swap_b32 v129, v103
  s_nop 1
  v_mfma_f32_16x16x32_bf16 v[136:139], v[100:103], v[124:127], 0
  v_mfma_f32_16x16x32_bf16 v[140:143], v[104:107], v[124:127], 0
  s_nop 7
  v_cvt_pk_bf16_f32 v120, v132, v133
  v_cvt_pk_bf16_f32 v121, v134, v135
  v_cndmask_b32 v136, v136, v140, s[64:65]
  v_cndmask_b32 v137, v137, v141, s[66:67]
  v_cndmask_b32 v138, v138, v142, s[68:69]
  v_cndmask_b32 v139, v139, v143, s[70:71]
  v_cvt_pk_bf16_f32 v17, v136, v137
  v_lshlrev_b32 v136, 16, v17
  v_and_b32 v137, 0xffff0000, v17
  v_cvt_pk_bf16_f32 v17, v138, v139
  v_lshlrev_b32 v138, 16, v17
  v_and_b32 v139, 0xffff0000, v17
  v_mul_f32 v136, s82, v136
  v_mul_f32 v137, s82, v137
  v_mul_f32 v138, s82, v138
  v_mul_f32 v139, s82, v139
  v_cvt_pk_bf16_f32 v17, v136, v137
  v_lshlrev_b32 v136, 16, v17
  v_and_b32 v137, 0xffff0000, v17
  v_cvt_pk_bf16_f32 v17, v138, v139
  v_lshlrev_b32 v138, 16, v17
  v_and_b32 v139, 0xffff0000, v17
  v_cndmask_b32 v136, v16, v136, s[54:55]
  v_cndmask_b32 v137, v16, v137, s[56:57]
  v_cndmask_b32 v138, v16, v138, s[58:59]
  v_cndmask_b32 v139, v16, v139, s[60:61]
  v_max3_f32 v17, v136, v137, v138
  v_max_f32 v17, v17, v139
  v_mov_b32 v18, v17
  s_nop 1
  v_permlane32_swap_b32 v17, v18
  v_max_f32 v17, v17, v18
  v_mov_b32 v18, v17
  s_nop 1
  v_permlane16_swap_b32 v17, v18
  v_max_f32 v17, v17, v18
  v_mul_f32 v17, s83, v17
  v_fma_f32 v136, v136, s83, -v17
  v_fma_f32 v137, v137, s83, -v17
  v_fma_f32 v138, v138, s83, -v17
  v_fma_f32 v139, v139, s83, -v17
  v_exp_f32 v136, v136
  v_exp_f32 v137, v137
  v_exp_f32 v138, v138
  v_exp_f32 v139, v139
  s_nop 1
  v_add_f32 v17, v136, v137
  v_add_f32 v18, v138, v139
  v_add_f32 v17, v17, v18
  v_mov_b32 v18, v17
  s_nop 1
  v_permlane32_swap_b32 v17, v18
  v_add_f32 v17, v17, v18
  v_mov_b32 v18, v17
  s_nop 1
  v_permlane16_swap_b32 v17, v18
  v_add_f32 v17, v17, v18
  v_rcp_f32 v17, v17
  s_nop 1
  v_mul_f32 v136, v136, v17
  v_mul_f32 v137, v137, v17
  v_mul_f32 v138, v138, v17
  v_mul_f32 v139, v139, v17
  v_cvt_pk_bf16_f32 v144, v136, v137
  v_cvt_pk_bf16_f32 v145, v138, v139
  v_and_b32 v146, v144, v22
  v_and_b32 v147, v145, v23
  v_and_b32 v144, v144, v20
  v_and_b32 v145, v145, v21
  s_nop 1
  v_mfma_f32_16x16x32_bf16 v[148:151], v[116:119], v[144:147], 0
  v_mfma_f32_16x16x32_bf16 v[152:155], v[120:123], v[144:147], 0
  s_nop 7
  v_mov_b32 v104, v100
  v_mov_b32 v105, v101
  v_mov_b32 v106, v102
  v_mov_b32 v107, v103
  v_mov_b32 v118, v116
  v_mov_b32 v119, v117
  v_mov_b32 v122, v120
  v_mov_b32 v123, v121
  v_cvt_pk_bf16_f32 v156, v148, v149
  v_cvt_pk_bf16_f32 v157, v150, v151
  ds_write_b64 v9, v[156:157] offset:16
  v_cvt_pk_bf16_f32 v158, v152, v153
  v_cvt_pk_bf16_f32 v159, v154, v155
  ds_write_b64 v10, v[158:159] offset:8
  s_waitcnt lgkmcnt(0)
  s_barrier
  ds_read_b128 v[160:163], v11
  ds_read_b128 v[164:167], v12
  s_waitcnt lgkmcnt(0)
  buffer_store_dwordx4 v[160:163], v15, s[16:19], s49 offen sc1
  buffer_store_dwordx4 v[164:167], v14, s[16:19], s49 offen sc1
  s_waitcnt vmcnt(0)
  s_barrier
  s_lshl_b32 s21, s42, 7
  s_add_u32 s21, s21, 29696
  s_xor_b32 s21, s21, s80
  s_cmp_lg_u32 s20, 0
  s_cbranch_scc1 af_259
  v_mov_b32 v8, 0
  v_mov_b32 v9, 1
  s_mov_b64 exec, 1
  buffer_atomic_add v9, v8, s[72:75], s21 offen sc1
  s_mov_b64 exec, -1
  s_nop 1
af_259:
  s_barrier
  s_sub_u32 s2, s3, 96
  s_mov_b32 s40, 0
  s_mov_b32 s41, 12
q_entry:
  s_load_dwordx2 s[4:5], s[0:1], 0
  s_load_dwordx2 s[6:7], s[0:1], 16
  s_load_dwordx2 s[38:39], s[0:1], 104
  s_mov_b32 s42, s2
  s_waitcnt lgkmcnt(0)
  s_mov_b32 s8, s4
  s_mov_b32 s9, s5
  s_mov_b32 s10, 2621440
  s_mov_b32 s11, 0x00020000
  s_mov_b32 s12, s6
  s_mov_b32 s13, s7
  s_mov_b32 s14, 7864320
  s_mov_b32 s15, 0x00020000
  s_mov_b32 s16, s38
  s_mov_b32 s17, s39
  s_mov_b32 s18, 218103808
  s_mov_b32 s19, 0x00020000
  s_add_u32 s72, s38, 173080576
  s_addc_u32 s73, s39, 0
  s_mov_b32 s74, 49152
  s_mov_b32 s75, 0x00020000
  s_mul_i32 s44, s42, 384
  s_cmp_lg_u32 s40, 0
  s_cbranch_scc1 qg_260
  s_load_dwordx2 s[36:37], s[0:1], 80
  s_waitcnt lgkmcnt(0)
  s_mov_b32 s24, s36
  s_mov_b32 s25, s37
  s_mov_b32 s26, 1280
  s_mov_b32 s27, 0x00020000
  s_add_u32 s76, s38, 175112192
  s_addc_u32 s77, s39, 0
  s_mov_b32 s78, 8192
  s_mov_b32 s79, 0x00020000
  s_lshl_b32 s59, s2, 2
  s_add_u32 s59, s59, s20
  s_lshl_b32 s59, s59, 4
  v_lshlrev_b32 v10, 2, v1
  v_lshlrev_b32 v11, 4, v1
  s_mul_i32 s22, s59, 1280
  buffer_load_dwordx4 v[12:15], v11, s[24:27], 0 offen
  buffer_load_dword v16, v10, s[24:27], 0 offen offset:1024
  buffer_load_dwordx4 v[192:195], v11, s[8:11], s22 offen
  buffer_load_dword v48, v10, s[8:11], s22 offen offset:1024
  s_add_u32 s22, s22, 1280
  buffer_load_dwordx4 v[196:199], v11, s[8:11], s22 offen
  buffer_load_dword v49, v10, s[8:11], s22 offen offset:1024
  s_add_u32 s22, s22, 1280
  buffer_load_dwordx4 v[200:203], v11, s[8:11], s22 offen
  buffer_load_dword v50, v10, s[8:11], s22 offen offset:1024
  s_add_u32 s22, s22, 1280
  buffer_load_dwordx4 v[204:207], v11, s[8:11], s22 offen
  buffer_load_dword v51, v10, s[8:11], s22 offen offset:1024
  s_add_u32 s22, s22, 1280
  buffer_load_dwordx4 v[208:211], v11, s[8:11], s22 offen
  buffer_load_dword v52, v10, s[8:11], s22 offen offset:1024
  s_add_u32 s22, s22, 1280
  buffer_load_dwordx4 v[212:215], v11, s[8:11], s22 offen
  buffer_load_dword v53, v10, s[8:11], s22 offen offset:1024
  s_add_u32 s22, s22, 1280
  buffer_load_dwordx4 v[216:219], v11, s[8:11], s22 offen
  buffer_load_dword v54, v10, s[8:11], s22 offen offset:1024
  s_add_u32 s22, s22, 1280
  buffer_load_dwordx4 v[220:223], v11, s[8:11], s22 offen
  buffer_load_dword v55, v10, s[8:11], s22 offen offset:1024
  s_add_u32 s22, s22, 1280
  buffer_load_dwordx4 v[224:227], v11, s[8:11], s22 offen
  buffer_load_dword v56, v10, s[8:11], s22 offen offset:1024
  s_add_u32 s22, s22, 1280
  buffer_load_dwordx4 v[228:231], v11, s[8:11], s22 offen
  buffer_load_dword v57, v10, s[8:11], s22 offen offset:1024
  s_add_u32 s22, s22, 1280
  buffer_load_dwordx4 v[232:235], v11, s[8:11], s22 offen
  buffer_load_dword v58, v10, s[8:11], s22 offen offset:1024
  s_add_u32 s22, s22, 1280
  buffer_load_dwordx4 v[236:239], v11, s[8:11], s22 offen
  buffer_load_dword v59, v10, s[8:11], s22 offen offset:1024
  s_add_u32 s22, s22, 1280
  buffer_load_dwordx4 v[240:243], v11, s[8:11], s22 offen
  buffer_load_dword v60, v10, s[8:11], s22 offen offset:1024
  s_add_u32 s22, s22, 1280
  buffer_load_dwordx4 v[244:247], v11, s[8:11], s22 offen
  buffer_load_dword v61, v10, s[8:11], s22 offen offset:1024
  s_add_u32 s22, s22, 1280
  buffer_load_dwordx4 v[248:251], v11, s[8:11], s22 offen
  buffer_load_dword v62, v10, s[8:11], s22 offen offset:1024
  s_add_u32 s22, s22, 1280
  buffer_load_dwordx4 v[252:255], v11, s[8:11], s22 offen
  buffer_load_dword v63, v10, s[8:11], s22 offen offset:1024
  s_add_u32 s22, s22, 1280
  s_load_dwordx2 s[36:37], s[0:1], 72
  s_lshr_b32 s21, s2, 3
  s_mul_i32 s21, s21, 204800
  s_and_b32 s22, s2, 7
  s_mul_i32 s22, s22, 160
  s_add_u32 s21, s21, s22
  s_waitcnt lgkmcnt(0)
  s_mov_b32 s28, s36
  s_mov_b32 s29, s37
  s_mov_b32 s30, 819200
  s_mov_b32 s31, 0x00020000
  s_mul_i32 s22, s20, 51200
  s_add_u32 s21, s21, s22
  s_mul_i32 s22, s20, 6400
  v_add_u32 v22, 0, v1
  v_mul_u32_u24 v23, 6554, v22
  v_lshrrev_b32 v23, 16, v23
  v_mul_u32_u24 v23, 1120, v23
  v_lshl_add_u32 v22, v22, 4, v23
  s_add_u32 m0, s22, 122880
  s_nop 0
  buffer_load_dwordx4 v22, s[28:31], s21 offen lds
  v_add_u32 v22, 64, v1
  v_mul_u32_u24 v23, 6554, v22
  v_lshrrev_b32 v23, 16, v23
  v_mul_u32_u24 v23, 1120, v23
  v_lshl_add_u32 v22, v22, 4, v23
  s_add_u32 m0, s22, 123904
  s_nop 0
  buffer_load_dwordx4 v22, s[28:31], s21 offen lds
  v_add_u32 v22, 128, v1
  v_mul_u32_u24 v23, 6554, v22
  v_lshrrev_b32 v23, 16, v23
  v_mul_u32_u24 v23, 1120, v23
  v_lshl_add_u32 v22, v22, 4, v23
  s_add_u32 m0, s22, 124928
  s_nop 0
  buffer_load_dwordx4 v22, s[28:31], s21 offen lds
  v_add_u32 v22, 192, v1
  v_mul_u32_u24 v23, 6554, v22
  v_lshrrev_b32 v23, 16, v23
  v_mul_u32_u24 v23, 1120, v23
  v_lshl_add_u32 v22, v22, 4, v23
  s_add_u32 m0, s22, 125952
  s_nop 0
  buffer_load_dwordx4 v22, s[28:31], s21 offen lds
  v_add_u32 v22, 256, v1
  v_mul_u32_u24 v23, 6554, v22
  v_lshrrev_b32 v23, 16, v23
  v_mul_u32_u24 v23, 1120, v23
  v_lshl_add_u32 v22, v22, 4, v23
  s_add_u32 m0, s22, 126976
  s_nop 0
  buffer_load_dwordx4 v22, s[28:31], s21 offen lds
  v_add_u32 v22, 320, v1
  v_mul_u32_u24 v23, 6554, v22
  v_lshrrev_b32 v23, 16, v23
  v_mul_u32_u24 v23, 1120, v23
  v_lshl_add_u32 v22, v22, 4, v23
  s_add_u32 m0, s22, 128000
  s_nop 0
  buffer_load_dwordx4 v22, s[28:31], s21 offen lds
  v_add_u32 v22, 384, v1
  v_mul_u32_u24 v23, 6554, v22
  v_lshrrev_b32 v23, 16, v23
  v_mul_u32_u24 v23, 1120, v23
  v_lshl_add_u32 v22, v22, 4, v23
  s_add_u32 m0, s22, 129024
  s_mov_b64 exec, 0xffff
  buffer_load_dwordx4 v22, s[28:31], s21 offen lds
  s_mov_b64 exec, -1
qg_260:
  s_waitcnt vmcnt(30)
  v_mov_b32 v9, 2731
  v_add_u32 v8, 0, v1
  v_mul_u32_u24 v7, v8, v9
  v_lshrrev_b32 v7, 16, v7
  v_mul_u32_u24 v4, 24, v7
  v_sub_u32 v8, v8, v4
  s_mov_b32 s21, 12288
  v_mul_lo_u32 v7, v7, s21
  v_lshl_add_u32 v4, v8, 4, v7
  v_add_u32 v8, 64, v1
  v_mul_u32_u24 v7, v8, v9
  v_lshrrev_b32 v7, 16, v7
  v_mul_u32_u24 v5, 24, v7
  v_sub_u32 v8, v8, v5
  s_mov_b32 s21, 12288
  v_mul_lo_u32 v7, v7, s21
  v_lshl_add_u32 v5, v8, 4, v7
  v_add_u32 v8, 128, v1
  v_mul_u32_u24 v7, v8, v9
  v_lshrrev_b32 v7, 16, v7
  v_mul_u32_u24 v6, 24, v7
  v_sub_u32 v8, v8, v6
  s_mov_b32 s21, 12288
  v_mul_lo_u32 v7, v7, s21
  v_lshl_add_u32 v6, v8, 4, v7
  v_lshrrev_b32 v7, 2, v2
  v_lshl_add_u32 v7, v3, 3, v7
  v_mul_u32_u24 v7, 384, v7
  v_and_b32 v8, 3, v2
  v_lshlrev_b32 v8, 3, v8
  s_mul_i32 s21, s20, 96
  v_add3_u32 v7, v7, v8, s21
  v_add_u32 v8, 61440, v7
  s_mul_i32 s21, s20, 491520
  s_add_u32 s21, s21, 0
  s_add_u32 s21, s21, s44
  s_mul_i32 s22, s20, 15360
  s_add_u32 s22, s22, 0
  s_add_u32 m0, s22, 0
  s_nop 0
  buffer_load_dwordx4 v4, s[12:15], s21 offen lds
  s_add_u32 m0, s22, 1024
  s_nop 0
  buffer_load_dwordx4 v5, s[12:15], s21 offen lds
  s_add_u32 m0, s22, 2048
  s_nop 0
  buffer_load_dwordx4 v6, s[12:15], s21 offen lds
  s_mul_i32 s21, s20, 491520
  s_add_u32 s21, s21, 98304
  s_add_u32 s21, s21, s44
  s_mul_i32 s22, s20, 15360
  s_add_u32 s22, s22, 3072
  s_add_u32 m0, s22, 0
  s_nop 0
  buffer_load_dwordx4 v4, s[12:15], s21 offen lds
  s_add_u32 m0, s22, 1024
  s_nop 0
  buffer_load_dwordx4 v5, s[12:15], s21 offen lds
  s_add_u32 m0, s22, 2048
  s_nop 0
  buffer_load_dwordx4 v6, s[12:15], s21 offen lds
  s_mul_i32 s21, s20, 491520
  s_add_u32 s21, s21, 196608
  s_add_u32 s21, s21, s44
  s_mul_i32 s22, s20, 15360
  s_add_u32 s22, s22, 6144
  s_add_u32 m0, s22, 0
  s_nop 0
  buffer_load_dwordx4 v4, s[12:15], s21 offen lds
  s_add_u32 m0, s22, 1024
  s_nop 0
  buffer_load_dwordx4 v5, s[12:15], s21 offen lds
  s_add_u32 m0, s22, 2048
  s_nop 0
  buffer_load_dwordx4 v6, s[12:15], s21 offen lds
  s_mul_i32 s21, s20, 491520
  s_add_u32 s21, s21, 294912
  s_add_u32 s21, s21, s44
  s_mul_i32 s22, s20, 15360
  s_add_u32 s22, s22, 9216
  s_add_u32 m0, s22, 0
  s_nop 0
  buffer_load_dwordx4 v4, s[12:15], s21 offen lds
  s_add_u32 m0, s22, 1024
  s_nop 0
  buffer_load_dwordx4 v5, s[12:15], s21 offen lds
  s_add_u32 m0, s22, 2048
  s_nop 0
  buffer_load_dwordx4 v6, s[12:15], s21 offen lds
  s_mul_i32 s21, s20, 491520
  s_add_u32 s21, s21, 393216
  s_add_u32 s21, s21, s44
  s_mul_i32 s22, s20, 15360
  s_add_u32 s22, s22, 12288
  s_add_u32 m0, s22, 0
  s_nop 0
  buffer_load_dwordx4 v4, s[12:15], s21 offen lds
  s_add_u32 m0, s22, 1024
  s_nop 0
  buffer_load_dwordx4 v5, s[12:15], s21 offen lds
  s_add_u32 m0, s22, 2048
  s_nop 0
  buffer_load_dwordx4 v6, s[12:15], s21 offen lds
  s_mul_i32 s21, s20, 491520
  s_add_u32 s21, s21, 1966080
  s_add_u32 s21, s21, s44
  s_mul_i32 s22, s20, 15360
  s_add_u32 s22, s22, 61440
  s_add_u32 m0, s22, 0
  s_nop 0
  buffer_load_dwordx4 v4, s[12:15], s21 offen lds
  s_add_u32 m0, s22, 1024
  s_nop 0
  buffer_load_dwordx4 v5, s[12:15], s21 offen lds
  s_add_u32 m0, s22, 2048
  s_nop 0
  buffer_load_dwordx4 v6, s[12:15], s21 offen lds
  s_mul_i32 s21, s20, 491520
  s_add_u32 s21, s21, 2064384
  s_add_u32 s21, s21, s44
  s_mul_i32 s22, s20, 15360
  s_add_u32 s22, s22, 64512
  s_add_u32 m0, s22, 0
  s_nop 0
  buffer_load_dwordx4 v4, s[12:15], s21 offen lds
  s_add_u32 m0, s22, 1024
  s_nop 0
  buffer_load_dwordx4 v5, s[12:15], s21 offen lds
  s_add_u32 m0, s22, 2048
  s_nop 0
  buffer_load_dwordx4 v6, s[12:15], s21 offen lds
  s_mul_i32 s21, s20, 491520
  s_add_u32 s21, s21, 2162688
  s_add_u32 s21, s21, s44
  s_mul_i32 s22, s20, 15360
  s_add_u32 s22, s22, 67584
  s_add_u32 m0, s22, 0
  s_nop 0
  buffer_load_dwordx4 v4, s[12:15], s21 offen lds
  s_add_u32 m0, s22, 1024
  s_nop 0
  buffer_load_dwordx4 v5, s[12:15], s21 offen lds
  s_add_u32 m0, s22, 2048
  s_nop 0
  buffer_load_dwordx4 v6, s[12:15], s21 offen lds
  s_mul_i32 s21, s20, 491520
  s_add_u32 s21, s21, 2260992
  s_add_u32 s21, s21, s44
  s_mul_i32 s22, s20, 15360
  s_add_u32 s22, s22, 70656
  s_add_u32 m0, s22, 0
  s_nop 0
  buffer_load_dwordx4 v4, s[12:15], s21 offen lds
  s_add_u32 m0, s22, 1024
  s_nop 0
  buffer_load_dwordx4 v5, s[12:15], s21 offen lds
  s_add_u32 m0, s22, 2048
  s_nop 0
  buffer_load_dwordx4 v6, s[12:15], s21 offen lds
  s_mul_i32 s21, s20, 491520
  s_add_u32 s21, s21, 2359296
  s_add_u32 s21, s21, s44
  s_mul_i32 s22, s20, 15360
  s_add_u32 s22, s22, 73728
  s_add_u32 m0, s22, 0
  s_nop 0
  buffer_load_dwordx4 v4, s[12:15], s21 offen lds
  s_add_u32 m0, s22, 1024
  s_nop 0
  buffer_load_dwordx4 v5, s[12:15], s21 offen lds
  s_add_u32 m0, s22, 2048
  s_nop 0
  buffer_load_dwordx4 v6, s[12:15], s21 offen lds
  s_waitcnt vmcnt(30)
  s_mul_i32 s21, s20, 491520
  s_add_u32 s21, s21, 3932160
  s_add_u32 s21, s21, s44
  buffer_load_dwordx4 v[64:67], v4, s[12:15], s21 offen
  buffer_load_dwordx4 v[68:71], v5, s[12:15], s21 offen
  buffer_load_dwordx4 v[72:75], v6, s[12:15], s21 offen
  s_mul_i32 s21, s20, 491520
  s_add_u32 s21, s21, 4030464
  s_add_u32 s21, s21, s44
  buffer_load_dwordx4 v[76:79], v4, s[12:15], s21 offen
  buffer_load_dwordx4 v[80:83], v5, s[12:15], s21 offen
  buffer_load_dwordx4 v[84:87], v6, s[12:15], s21 offen
  s_mul_i32 s21, s20, 491520
  s_add_u32 s21, s21, 4128768
  s_add_u32 s21, s21, s44
  buffer_load_dwordx4 v[88:91], v4, s[12:15], s21 offen
  buffer_load_dwordx4 v[92:95], v5, s[12:15], s21 offen
  buffer_load_dwordx4 v[96:99], v6, s[12:15], s21 offen
  s_mul_i32 s21, s20, 491520
  s_add_u32 s21, s21, 4227072
  s_add_u32 s21, s21, s44
  buffer_load_dwordx4 v[100:103], v4, s[12:15], s21 offen
  buffer_load_dwordx4 v[104:107], v5, s[12:15], s21 offen
  buffer_load_dwordx4 v[108:111], v6, s[12:15], s21 offen
  s_mul_i32 s21, s20, 491520
  s_add_u32 s21, s21, 4325376
  s_add_u32 s21, s21, s44
  buffer_load_dwordx4 v[112:115], v4, s[12:15], s21 offen
  buffer_load_dwordx4 v[116:119], v5, s[12:15], s21 offen
  buffer_load_dwordx4 v[120:123], v6, s[12:15], s21 offen
  s_mul_i32 s21, s20, 491520
  s_add_u32 s21, s21, 5898240
  s_add_u32 s21, s21, s44
  buffer_load_dwordx4 v[124:127], v4, s[12:15], s21 offen
  buffer_load_dwordx4 v[128:131], v5, s[12:15], s21 offen
  buffer_load_dwordx4 v[132:135], v6, s[12:15], s21 offen
  s_mul_i32 s21, s20, 491520
  s_add_u32 s21, s21, 5996544
  s_add_u32 s21, s21, s44
  buffer_load_dwordx4 v[136:139], v4, s[12:15], s21 offen
  buffer_load_dwordx4 v[140:143], v5, s[12:15], s21 offen
  buffer_load_dwordx4 v[144:147], v6, s[12:15], s21 offen
  s_mul_i32 s21, s20, 491520
  s_add_u32 s21, s21, 6094848
  s_add_u32 s21, s21, s44
  buffer_load_dwordx4 v[148:151], v4, s[12:15], s21 offen
  buffer_load_dwordx4 v[152:155], v5, s[12:15], s21 offen
  buffer_load_dwordx4 v[156:159], v6, s[12:15], s21 offen
  s_mul_i32 s21, s20, 491520
  s_add_u32 s21, s21, 6193152
  s_add_u32 s21, s21, s44
  buffer_load_dwordx4 v[160:163], v4, s[12:15], s21 offen
  buffer_load_dwordx4 v[164:167], v5, s[12:15], s21 offen
  buffer_load_dwordx4 v[168:171], v6, s[12:15], s21 offen
  s_mul_i32 s21, s20, 491520
  s_add_u32 s21, s21, 6291456
  s_add_u32 s21, s21, s44
  buffer_load_dwordx4 v[172:175], v4, s[12:15], s21 offen
  buffer_load_dwordx4 v[176:179], v5, s[12:15], s21 offen
  buffer_load_dwordx4 v[180:183], v6, s[12:15], s21 offen
  s_mul_i32 s22, s20, 15360
  v_lshl_add_u32 v30, v1, 4, s22
  v_add_u32 v31, 61440, v30
  s_cmp_lg_u32 s40, 0
  s_cbranch_scc1 qg_261
  v_lshlrev_b32 v17, 16, v12
  v_and_b32 v12, 0xffff0000, v12
  v_lshlrev_b32 v18, 16, v13
  v_and_b32 v13, 0xffff0000, v13
  v_lshlrev_b32 v19, 16, v14
  v_and_b32 v14, 0xffff0000, v14
  v_lshlrev_b32 v20, 16, v15
  v_and_b32 v15, 0xffff0000, v15
  v_lshlrev_b32 v21, 16, v16
  v_and_b32 v16, 0xffff0000, v16
  v_mov_b32 v32, 0
  v_lshlrev_b32 v25, 16, v192
  v_and_b32 v26, 0xffff0000, v192
  v_mul_f32 v25, v25, v17
  v_mul_f32 v26, v26, v12
  v_cvt_pk_bf16_f32 v25, v25, v26
  v_lshlrev_b32 v26, 16, v25
  v_and_b32 v25, 0xffff0000, v25
  v_add_f32 v32, v32, v26
  v_add_f32 v32, v32, v25
  v_lshlrev_b32 v25, 16, v193
  v_and_b32 v26, 0xffff0000, v193
  v_mul_f32 v25, v25, v18
  v_mul_f32 v26, v26, v13
  v_cvt_pk_bf16_f32 v25, v25, v26
  v_lshlrev_b32 v26, 16, v25
  v_and_b32 v25, 0xffff0000, v25
  v_add_f32 v32, v32, v26
  v_add_f32 v32, v32, v25
  v_lshlrev_b32 v25, 16, v194
  v_and_b32 v26, 0xffff0000, v194
  v_mul_f32 v25, v25, v19
  v_mul_f32 v26, v26, v14
  v_cvt_pk_bf16_f32 v25, v25, v26
  v_lshlrev_b32 v26, 16, v25
  v_and_b32 v25, 0xffff0000, v25
  v_add_f32 v32, v32, v26
  v_add_f32 v32, v32, v25
  v_lshlrev_b32 v25, 16, v195
  v_and_b32 v26, 0xffff0000, v195
  v_mul_f32 v25, v25, v20
  v_mul_f32 v26, v26, v15
  v_cvt_pk_bf16_f32 v25, v25, v26
  v_lshlrev_b32 v26, 16, v25
  v_and_b32 v25, 0xffff0000, v25
  v_add_f32 v32, v32, v26
  v_add_f32 v32, v32, v25
  v_lshlrev_b32 v25, 16, v48
  v_and_b32 v26, 0xffff0000, v48
  v_mul_f32 v25, v25, v21
  v_mul_f32 v26, v26, v16
  v_cvt_pk_bf16_f32 v25, v25, v26
  v_lshlrev_b32 v26, 16, v25
  v_and_b32 v25, 0xffff0000, v25
  v_add_f32 v32, v32, v26
  v_add_f32 v32, v32, v25
  v_mov_b32 v33, 0
  v_lshlrev_b32 v25, 16, v196
  v_and_b32 v26, 0xffff0000, v196
  v_mul_f32 v25, v25, v17
  v_mul_f32 v26, v26, v12
  v_cvt_pk_bf16_f32 v25, v25, v26
  v_lshlrev_b32 v26, 16, v25
  v_and_b32 v25, 0xffff0000, v25
  v_add_f32 v33, v33, v26
  v_add_f32 v33, v33, v25
  v_lshlrev_b32 v25, 16, v197
  v_and_b32 v26, 0xffff0000, v197
  v_mul_f32 v25, v25, v18
  v_mul_f32 v26, v26, v13
  v_cvt_pk_bf16_f32 v25, v25, v26
  v_lshlrev_b32 v26, 16, v25
  v_and_b32 v25, 0xffff0000, v25
  v_add_f32 v33, v33, v26
  v_add_f32 v33, v33, v25
  v_lshlrev_b32 v25, 16, v198
  v_and_b32 v26, 0xffff0000, v198
  v_mul_f32 v25, v25, v19
  v_mul_f32 v26, v26, v14
  v_cvt_pk_bf16_f32 v25, v25, v26
  v_lshlrev_b32 v26, 16, v25
  v_and_b32 v25, 0xffff0000, v25
  v_add_f32 v33, v33, v26
  v_add_f32 v33, v33, v25
  v_lshlrev_b32 v25, 16, v199
  v_and_b32 v26, 0xffff0000, v199
  v_mul_f32 v25, v25, v20
  v_mul_f32 v26, v26, v15
  v_cvt_pk_bf16_f32 v25, v25, v26
  v_lshlrev_b32 v26, 16, v25
  v_and_b32 v25, 0xffff0000, v25
  v_add_f32 v33, v33, v26
  v_add_f32 v33, v33, v25
  v_lshlrev_b32 v25, 16, v49
  v_and_b32 v26, 0xffff0000, v49
  v_mul_f32 v25, v25, v21
  v_mul_f32 v26, v26, v16
  v_cvt_pk_bf16_f32 v25, v25, v26
  v_lshlrev_b32 v26, 16, v25
  v_and_b32 v25, 0xffff0000, v25
  v_add_f32 v33, v33, v26
  v_add_f32 v33, v33, v25
  v_mov_b32 v34, 0
  v_lshlrev_b32 v25, 16, v200
  v_and_b32 v26, 0xffff0000, v200
  v_mul_f32 v25, v25, v17
  v_mul_f32 v26, v26, v12
  v_cvt_pk_bf16_f32 v25, v25, v26
  v_lshlrev_b32 v26, 16, v25
  v_and_b32 v25, 0xffff0000, v25
  v_add_f32 v34, v34, v26
  v_add_f32 v34, v34, v25
  v_lshlrev_b32 v25, 16, v201
  v_and_b32 v26, 0xffff0000, v201
  v_mul_f32 v25, v25, v18
  v_mul_f32 v26, v26, v13
  v_cvt_pk_bf16_f32 v25, v25, v26
  v_lshlrev_b32 v26, 16, v25
  v_and_b32 v25, 0xffff0000, v25
  v_add_f32 v34, v34, v26
  v_add_f32 v34, v34, v25
  v_lshlrev_b32 v25, 16, v202
  v_and_b32 v26, 0xffff0000, v202
  v_mul_f32 v25, v25, v19
  v_mul_f32 v26, v26, v14
  v_cvt_pk_bf16_f32 v25, v25, v26
  v_lshlrev_b32 v26, 16, v25
  v_and_b32 v25, 0xffff0000, v25
  v_add_f32 v34, v34, v26
  v_add_f32 v34, v34, v25
  v_lshlrev_b32 v25, 16, v203
  v_and_b32 v26, 0xffff0000, v203
  v_mul_f32 v25, v25, v20
  v_mul_f32 v26, v26, v15
  v_cvt_pk_bf16_f32 v25, v25, v26
  v_lshlrev_b32 v26, 16, v25
  v_and_b32 v25, 0xffff0000, v25
  v_add_f32 v34, v34, v26
  v_add_f32 v34, v34, v25
  v_lshlrev_b32 v25, 16, v50
  v_and_b32 v26, 0xffff0000, v50
  v_mul_f32 v25, v25, v21
  v_mul_f32 v26, v26, v16
  v_cvt_pk_bf16_f32 v25, v25, v26
  v_lshlrev_b32 v26, 16, v25
  v_and_b32 v25, 0xffff0000, v25
  v_add_f32 v34, v34, v26
  v_add_f32 v34, v34, v25
  v_mov_b32 v35, 0
  v_lshlrev_b32 v25, 16, v204
  v_and_b32 v26, 0xffff0000, v204
  v_mul_f32 v25, v25, v17
  v_mul_f32 v26, v26, v12
  v_cvt_pk_bf16_f32 v25, v25, v26
  v_lshlrev_b32 v26, 16, v25
  v_and_b32 v25, 0xffff0000, v25
  v_add_f32 v35, v35, v26
  v_add_f32 v35, v35, v25
  v_lshlrev_b32 v25, 16, v205
  v_and_b32 v26, 0xffff0000, v205
  v_mul_f32 v25, v25, v18
  v_mul_f32 v26, v26, v13
  v_cvt_pk_bf16_f32 v25, v25, v26
  v_lshlrev_b32 v26, 16, v25
  v_and_b32 v25, 0xffff0000, v25
  v_add_f32 v35, v35, v26
  v_add_f32 v35, v35, v25
  v_lshlrev_b32 v25, 16, v206
  v_and_b32 v26, 0xffff0000, v206
  v_mul_f32 v25, v25, v19
  v_mul_f32 v26, v26, v14
  v_cvt_pk_bf16_f32 v25, v25, v26
  v_lshlrev_b32 v26, 16, v25
  v_and_b32 v25, 0xffff0000, v25
  v_add_f32 v35, v35, v26
  v_add_f32 v35, v35, v25
  v_lshlrev_b32 v25, 16, v207
  v_and_b32 v26, 0xffff0000, v207
  v_mul_f32 v25, v25, v20
  v_mul_f32 v26, v26, v15
  v_cvt_pk_bf16_f32 v25, v25, v26
  v_lshlrev_b32 v26, 16, v25
  v_and_b32 v25, 0xffff0000, v25
  v_add_f32 v35, v35, v26
  v_add_f32 v35, v35, v25
  v_lshlrev_b32 v25, 16, v51
  v_and_b32 v26, 0xffff0000, v51
  v_mul_f32 v25, v25, v21
  v_mul_f32 v26, v26, v16
  v_cvt_pk_bf16_f32 v25, v25, v26
  v_lshlrev_b32 v26, 16, v25
  v_and_b32 v25, 0xffff0000, v25
  v_add_f32 v35, v35, v26
  v_add_f32 v35, v35, v25
  v_mov_b32 v36, 0
  v_lshlrev_b32 v25, 16, v208
  v_and_b32 v26, 0xffff0000, v208
  v_mul_f32 v25, v25, v17
  v_mul_f32 v26, v26, v12
  v_cvt_pk_bf16_f32 v25, v25, v26
  v_lshlrev_b32 v26, 16, v25
  v_and_b32 v25, 0xffff0000, v25
  v_add_f32 v36, v36, v26
  v_add_f32 v36, v36, v25
  v_lshlrev_b32 v25, 16, v209
  v_and_b32 v26, 0xffff0000, v209
  v_mul_f32 v25, v25, v18
  v_mul_f32 v26, v26, v13
  v_cvt_pk_bf16_f32 v25, v25, v26
  v_lshlrev_b32 v26, 16, v25
  v_and_b32 v25, 0xffff0000, v25
  v_add_f32 v36, v36, v26
  v_add_f32 v36, v36, v25
  v_lshlrev_b32 v25, 16, v210
  v_and_b32 v26, 0xffff0000, v210
  v_mul_f32 v25, v25, v19
  v_mul_f32 v26, v26, v14
  v_cvt_pk_bf16_f32 v25, v25, v26
  v_lshlrev_b32 v26, 16, v25
  v_and_b32 v25, 0xffff0000, v25
  v_add_f32 v36, v36, v26
  v_add_f32 v36, v36, v25
  v_lshlrev_b32 v25, 16, v211
  v_and_b32 v26, 0xffff0000, v211
  v_mul_f32 v25, v25, v20
  v_mul_f32 v26, v26, v15
  v_cvt_pk_bf16_f32 v25, v25, v26
  v_lshlrev_b32 v26, 16, v25
  v_and_b32 v25, 0xffff0000, v25
  v_add_f32 v36, v36, v26
  v_add_f32 v36, v36, v25
  v_lshlrev_b32 v25, 16, v52
  v_and_b32 v26, 0xffff0000, v52
  v_mul_f32 v25, v25, v21
  v_mul_f32 v26, v26, v16
  v_cvt_pk_bf16_f32 v25, v25, v26
  v_lshlrev_b32 v26, 16, v25
  v_and_b32 v25, 0xffff0000, v25
  v_add_f32 v36, v36, v26
  v_add_f32 v36, v36, v25
  v_mov_b32 v37, 0
  v_lshlrev_b32 v25, 16, v212
  v_and_b32 v26, 0xffff0000, v212
  v_mul_f32 v25, v25, v17
  v_mul_f32 v26, v26, v12
  v_cvt_pk_bf16_f32 v25, v25, v26
  v_lshlrev_b32 v26, 16, v25
  v_and_b32 v25, 0xffff0000, v25
  v_add_f32 v37, v37, v26
  v_add_f32 v37, v37, v25
  v_lshlrev_b32 v25, 16, v213
  v_and_b32 v26, 0xffff0000, v213
  v_mul_f32 v25, v25, v18
  v_mul_f32 v26, v26, v13
  v_cvt_pk_bf16_f32 v25, v25, v26
  v_lshlrev_b32 v26, 16, v25
  v_and_b32 v25, 0xffff0000, v25
  v_add_f32 v37, v37, v26
  v_add_f32 v37, v37, v25
  v_lshlrev_b32 v25, 16, v214
  v_and_b32 v26, 0xffff0000, v214
  v_mul_f32 v25, v25, v19
  v_mul_f32 v26, v26, v14
  v_cvt_pk_bf16_f32 v25, v25, v26
  v_lshlrev_b32 v26, 16, v25
  v_and_b32 v25, 0xffff0000, v25
  v_add_f32 v37, v37, v26
  v_add_f32 v37, v37, v25
  v_lshlrev_b32 v25, 16, v215
  v_and_b32 v26, 0xffff0000, v215
  v_mul_f32 v25, v25, v20
  v_mul_f32 v26, v26, v15
  v_cvt_pk_bf16_f32 v25, v25, v26
  v_lshlrev_b32 v26, 16, v25
  v_and_b32 v25, 0xffff0000, v25
  v_add_f32 v37, v37, v26
  v_add_f32 v37, v37, v25
  v_lshlrev_b32 v25, 16, v53
  v_and_b32 v26, 0xffff0000, v53
  v_mul_f32 v25, v25, v21
  v_mul_f32 v26, v26, v16
  v_cvt_pk_bf16_f32 v25, v25, v26
  v_lshlrev_b32 v26, 16, v25
  v_and_b32 v25, 0xffff0000, v25
  v_add_f32 v37, v37, v26
  v_add_f32 v37, v37, v25
  v_mov_b32 v38, 0
  v_lshlrev_b32 v25, 16, v216
  v_and_b32 v26, 0xffff0000, v216
  v_mul_f32 v25, v25, v17
  v_mul_f32 v26, v26, v12
  v_cvt_pk_bf16_f32 v25, v25, v26
  v_lshlrev_b32 v26, 16, v25
  v_and_b32 v25, 0xffff0000, v25
  v_add_f32 v38, v38, v26
  v_add_f32 v38, v38, v25
  v_lshlrev_b32 v25, 16, v217
  v_and_b32 v26, 0xffff0000, v217
  v_mul_f32 v25, v25, v18
  v_mul_f32 v26, v26, v13
  v_cvt_pk_bf16_f32 v25, v25, v26
  v_lshlrev_b32 v26, 16, v25
  v_and_b32 v25, 0xffff0000, v25
  v_add_f32 v38, v38, v26
  v_add_f32 v38, v38, v25
  v_lshlrev_b32 v25, 16, v218
  v_and_b32 v26, 0xffff0000, v218
  v_mul_f32 v25, v25, v19
  v_mul_f32 v26, v26, v14
  v_cvt_pk_bf16_f32 v25, v25, v26
  v_lshlrev_b32 v26, 16, v25
  v_and_b32 v25, 0xffff0000, v25
  v_add_f32 v38, v38, v26
  v_add_f32 v38, v38, v25
  v_lshlrev_b32 v25, 16, v219
  v_and_b32 v26, 0xffff0000, v219
  v_mul_f32 v25, v25, v20
  v_mul_f32 v26, v26, v15
  v_cvt_pk_bf16_f32 v25, v25, v26
  v_lshlrev_b32 v26, 16, v25
  v_and_b32 v25, 0xffff0000, v25
  v_add_f32 v38, v38, v26
  v_add_f32 v38, v38, v25
  v_lshlrev_b32 v25, 16, v54
  v_and_b32 v26, 0xffff0000, v54
  v_mul_f32 v25, v25, v21
  v_mul_f32 v26, v26, v16
  v_cvt_pk_bf16_f32 v25, v25, v26
  v_lshlrev_b32 v26, 16, v25
  v_and_b32 v25, 0xffff0000, v25
  v_add_f32 v38, v38, v26
  v_add_f32 v38, v38, v25
  v_mov_b32 v39, 0
  v_lshlrev_b32 v25, 16, v220
  v_and_b32 v26, 0xffff0000, v220
  v_mul_f32 v25, v25, v17
  v_mul_f32 v26, v26, v12
  v_cvt_pk_bf16_f32 v25, v25, v26
  v_lshlrev_b32 v26, 16, v25
  v_and_b32 v25, 0xffff0000, v25
  v_add_f32 v39, v39, v26
  v_add_f32 v39, v39, v25
  v_lshlrev_b32 v25, 16, v221
  v_and_b32 v26, 0xffff0000, v221
  v_mul_f32 v25, v25, v18
  v_mul_f32 v26, v26, v13
  v_cvt_pk_bf16_f32 v25, v25, v26
  v_lshlrev_b32 v26, 16, v25
  v_and_b32 v25, 0xffff0000, v25
  v_add_f32 v39, v39, v26
  v_add_f32 v39, v39, v25
  v_lshlrev_b32 v25, 16, v222
  v_and_b32 v26, 0xffff0000, v222
  v_mul_f32 v25, v25, v19
  v_mul_f32 v26, v26, v14
  v_cvt_pk_bf16_f32 v25, v25, v26
  v_lshlrev_b32 v26, 16, v25
  v_and_b32 v25, 0xffff0000, v25
  v_add_f32 v39, v39, v26
  v_add_f32 v39, v39, v25
  v_lshlrev_b32 v25, 16, v223
  v_and_b32 v26, 0xffff0000, v223
  v_mul_f32 v25, v25, v20
  v_mul_f32 v26, v26, v15
  v_cvt_pk_bf16_f32 v25, v25, v26
  v_lshlrev_b32 v26, 16, v25
  v_and_b32 v25, 0xffff0000, v25
  v_add_f32 v39, v39, v26
  v_add_f32 v39, v39, v25
  v_lshlrev_b32 v25, 16, v55
  v_and_b32 v26, 0xffff0000, v55
  v_mul_f32 v25, v25, v21
  v_mul_f32 v26, v26, v16
  v_cvt_pk_bf16_f32 v25, v25, v26
  v_lshlrev_b32 v26, 16, v25
  v_and_b32 v25, 0xffff0000, v25
  v_add_f32 v39, v39, v26
  v_add_f32 v39, v39, v25
  v_mov_b32 v40, 0
  v_lshlrev_b32 v25, 16, v224
  v_and_b32 v26, 0xffff0000, v224
  v_mul_f32 v25, v25, v17
  v_mul_f32 v26, v26, v12
  v_cvt_pk_bf16_f32 v25, v25, v26
  v_lshlrev_b32 v26, 16, v25
  v_and_b32 v25, 0xffff0000, v25
  v_add_f32 v40, v40, v26
  v_add_f32 v40, v40, v25
  v_lshlrev_b32 v25, 16, v225
  v_and_b32 v26, 0xffff0000, v225
  v_mul_f32 v25, v25, v18
  v_mul_f32 v26, v26, v13
  v_cvt_pk_bf16_f32 v25, v25, v26
  v_lshlrev_b32 v26, 16, v25
  v_and_b32 v25, 0xffff0000, v25
  v_add_f32 v40, v40, v26
  v_add_f32 v40, v40, v25
  v_lshlrev_b32 v25, 16, v226
  v_and_b32 v26, 0xffff0000, v226
  v_mul_f32 v25, v25, v19
  v_mul_f32 v26, v26, v14
  v_cvt_pk_bf16_f32 v25, v25, v26
  v_lshlrev_b32 v26, 16, v25
  v_and_b32 v25, 0xffff0000, v25
  v_add_f32 v40, v40, v26
  v_add_f32 v40, v40, v25
  v_lshlrev_b32 v25, 16, v227
  v_and_b32 v26, 0xffff0000, v227
  v_mul_f32 v25, v25, v20
  v_mul_f32 v26, v26, v15
  v_cvt_pk_bf16_f32 v25, v25, v26
  v_lshlrev_b32 v26, 16, v25
  v_and_b32 v25, 0xffff0000, v25
  v_add_f32 v40, v40, v26
  v_add_f32 v40, v40, v25
  v_lshlrev_b32 v25, 16, v56
  v_and_b32 v26, 0xffff0000, v56
  v_mul_f32 v25, v25, v21
  v_mul_f32 v26, v26, v16
  v_cvt_pk_bf16_f32 v25, v25, v26
  v_lshlrev_b32 v26, 16, v25
  v_and_b32 v25, 0xffff0000, v25
  v_add_f32 v40, v40, v26
  v_add_f32 v40, v40, v25
  v_mov_b32 v41, 0
  v_lshlrev_b32 v25, 16, v228
  v_and_b32 v26, 0xffff0000, v228
  v_mul_f32 v25, v25, v17
  v_mul_f32 v26, v26, v12
  v_cvt_pk_bf16_f32 v25, v25, v26
  v_lshlrev_b32 v26, 16, v25
  v_and_b32 v25, 0xffff0000, v25
  v_add_f32 v41, v41, v26
  v_add_f32 v41, v41, v25
  v_lshlrev_b32 v25, 16, v229
  v_and_b32 v26, 0xffff0000, v229
  v_mul_f32 v25, v25, v18
  v_mul_f32 v26, v26, v13
  v_cvt_pk_bf16_f32 v25, v25, v26
  v_lshlrev_b32 v26, 16, v25
  v_and_b32 v25, 0xffff0000, v25
  v_add_f32 v41, v41, v26
  v_add_f32 v41, v41, v25
  v_lshlrev_b32 v25, 16, v230
  v_and_b32 v26, 0xffff0000, v230
  v_mul_f32 v25, v25, v19
  v_mul_f32 v26, v26, v14
  v_cvt_pk_bf16_f32 v25, v25, v26
  v_lshlrev_b32 v26, 16, v25
  v_and_b32 v25, 0xffff0000, v25
  v_add_f32 v41, v41, v26
  v_add_f32 v41, v41, v25
  v_lshlrev_b32 v25, 16, v231
  v_and_b32 v26, 0xffff0000, v231
  v_mul_f32 v25, v25, v20
  v_mul_f32 v26, v26, v15
  v_cvt_pk_bf16_f32 v25, v25, v26
  v_lshlrev_b32 v26, 16, v25
  v_and_b32 v25, 0xffff0000, v25
  v_add_f32 v41, v41, v26
  v_add_f32 v41, v41, v25
  v_lshlrev_b32 v25, 16, v57
  v_and_b32 v26, 0xffff0000, v57
  v_mul_f32 v25, v25, v21
  v_mul_f32 v26, v26, v16
  v_cvt_pk_bf16_f32 v25, v25, v26
  v_lshlrev_b32 v26, 16, v25
  v_and_b32 v25, 0xffff0000, v25
  v_add_f32 v41, v41, v26
  v_add_f32 v41, v41, v25
  v_mov_b32 v42, 0
  v_lshlrev_b32 v25, 16, v232
  v_and_b32 v26, 0xffff0000, v232
  v_mul_f32 v25, v25, v17
  v_mul_f32 v26, v26, v12
  v_cvt_pk_bf16_f32 v25, v25, v26
  v_lshlrev_b32 v26, 16, v25
  v_and_b32 v25, 0xffff0000, v25
  v_add_f32 v42, v42, v26
  v_add_f32 v42, v42, v25
  v_lshlrev_b32 v25, 16, v233
  v_and_b32 v26, 0xffff0000, v233
  v_mul_f32 v25, v25, v18
  v_mul_f32 v26, v26, v13
  v_cvt_pk_bf16_f32 v25, v25, v26
  v_lshlrev_b32 v26, 16, v25
  v_and_b32 v25, 0xffff0000, v25
  v_add_f32 v42, v42, v26
  v_add_f32 v42, v42, v25
  v_lshlrev_b32 v25, 16, v234
  v_and_b32 v26, 0xffff0000, v234
  v_mul_f32 v25, v25, v19
  v_mul_f32 v26, v26, v14
  v_cvt_pk_bf16_f32 v25, v25, v26
  v_lshlrev_b32 v26, 16, v25
  v_and_b32 v25, 0xffff0000, v25
  v_add_f32 v42, v42, v26
  v_add_f32 v42, v42, v25
  v_lshlrev_b32 v25, 16, v235
  v_and_b32 v26, 0xffff0000, v235
  v_mul_f32 v25, v25, v20
  v_mul_f32 v26, v26, v15
  v_cvt_pk_bf16_f32 v25, v25, v26
  v_lshlrev_b32 v26, 16, v25
  v_and_b32 v25, 0xffff0000, v25
  v_add_f32 v42, v42, v26
  v_add_f32 v42, v42, v25
  v_lshlrev_b32 v25, 16, v58
  v_and_b32 v26, 0xffff0000, v58
  v_mul_f32 v25, v25, v21
  v_mul_f32 v26, v26, v16
  v_cvt_pk_bf16_f32 v25, v25, v26
  v_lshlrev_b32 v26, 16, v25
  v_and_b32 v25, 0xffff0000, v25
  v_add_f32 v42, v42, v26
  v_add_f32 v42, v42, v25
  v_mov_b32 v43, 0
  v_lshlrev_b32 v25, 16, v236
  v_and_b32 v26, 0xffff0000, v236
  v_mul_f32 v25, v25, v17
  v_mul_f32 v26, v26, v12
  v_cvt_pk_bf16_f32 v25, v25, v26
  v_lshlrev_b32 v26, 16, v25
  v_and_b32 v25, 0xffff0000, v25
  v_add_f32 v43, v43, v26
  v_add_f32 v43, v43, v25
  v_lshlrev_b32 v25, 16, v237
  v_and_b32 v26, 0xffff0000, v237
  v_mul_f32 v25, v25, v18
  v_mul_f32 v26, v26, v13
  v_cvt_pk_bf16_f32 v25, v25, v26
  v_lshlrev_b32 v26, 16, v25
  v_and_b32 v25, 0xffff0000, v25
  v_add_f32 v43, v43, v26
  v_add_f32 v43, v43, v25
  v_lshlrev_b32 v25, 16, v238
  v_and_b32 v26, 0xffff0000, v238
  v_mul_f32 v25, v25, v19
  v_mul_f32 v26, v26, v14
  v_cvt_pk_bf16_f32 v25, v25, v26
  v_lshlrev_b32 v26, 16, v25
  v_and_b32 v25, 0xffff0000, v25
  v_add_f32 v43, v43, v26
  v_add_f32 v43, v43, v25
  v_lshlrev_b32 v25, 16, v239
  v_and_b32 v26, 0xffff0000, v239
  v_mul_f32 v25, v25, v20
  v_mul_f32 v26, v26, v15
  v_cvt_pk_bf16_f32 v25, v25, v26
  v_lshlrev_b32 v26, 16, v25
  v_and_b32 v25, 0xffff0000, v25
  v_add_f32 v43, v43, v26
  v_add_f32 v43, v43, v25
  v_lshlrev_b32 v25, 16, v59
  v_and_b32 v26, 0xffff0000, v59
  v_mul_f32 v25, v25, v21
  v_mul_f32 v26, v26, v16
  v_cvt_pk_bf16_f32 v25, v25, v26
  v_lshlrev_b32 v26, 16, v25
  v_and_b32 v25, 0xffff0000, v25
  v_add_f32 v43, v43, v26
  v_add_f32 v43, v43, v25
  v_mov_b32 v44, 0
  v_lshlrev_b32 v25, 16, v240
  v_and_b32 v26, 0xffff0000, v240
  v_mul_f32 v25, v25, v17
  v_mul_f32 v26, v26, v12
  v_cvt_pk_bf16_f32 v25, v25, v26
  v_lshlrev_b32 v26, 16, v25
  v_and_b32 v25, 0xffff0000, v25
  v_add_f32 v44, v44, v26
  v_add_f32 v44, v44, v25
  v_lshlrev_b32 v25, 16, v241
  v_and_b32 v26, 0xffff0000, v241
  v_mul_f32 v25, v25, v18
  v_mul_f32 v26, v26, v13
  v_cvt_pk_bf16_f32 v25, v25, v26
  v_lshlrev_b32 v26, 16, v25
  v_and_b32 v25, 0xffff0000, v25
  v_add_f32 v44, v44, v26
  v_add_f32 v44, v44, v25
  v_lshlrev_b32 v25, 16, v242
  v_and_b32 v26, 0xffff0000, v242
  v_mul_f32 v25, v25, v19
  v_mul_f32 v26, v26, v14
  v_cvt_pk_bf16_f32 v25, v25, v26
  v_lshlrev_b32 v26, 16, v25
  v_and_b32 v25, 0xffff0000, v25
  v_add_f32 v44, v44, v26
  v_add_f32 v44, v44, v25
  v_lshlrev_b32 v25, 16, v243
  v_and_b32 v26, 0xffff0000, v243
  v_mul_f32 v25, v25, v20
  v_mul_f32 v26, v26, v15
  v_cvt_pk_bf16_f32 v25, v25, v26
  v_lshlrev_b32 v26, 16, v25
  v_and_b32 v25, 0xffff0000, v25
  v_add_f32 v44, v44, v26
  v_add_f32 v44, v44, v25
  v_lshlrev_b32 v25, 16, v60
  v_and_b32 v26, 0xffff0000, v60
  v_mul_f32 v25, v25, v21
  v_mul_f32 v26, v26, v16
  v_cvt_pk_bf16_f32 v25, v25, v26
  v_lshlrev_b32 v26, 16, v25
  v_and_b32 v25, 0xffff0000, v25
  v_add_f32 v44, v44, v26
  v_add_f32 v44, v44, v25
  v_mov_b32 v45, 0
  v_lshlrev_b32 v25, 16, v244
  v_and_b32 v26, 0xffff0000, v244
  v_mul_f32 v25, v25, v17
  v_mul_f32 v26, v26, v12
  v_cvt_pk_bf16_f32 v25, v25, v26
  v_lshlrev_b32 v26, 16, v25
  v_and_b32 v25, 0xffff0000, v25
  v_add_f32 v45, v45, v26
  v_add_f32 v45, v45, v25
  v_lshlrev_b32 v25, 16, v245
  v_and_b32 v26, 0xffff0000, v245
  v_mul_f32 v25, v25, v18
  v_mul_f32 v26, v26, v13
  v_cvt_pk_bf16_f32 v25, v25, v26
  v_lshlrev_b32 v26, 16, v25
  v_and_b32 v25, 0xffff0000, v25
  v_add_f32 v45, v45, v26
  v_add_f32 v45, v45, v25
  v_lshlrev_b32 v25, 16, v246
  v_and_b32 v26, 0xffff0000, v246
  v_mul_f32 v25, v25, v19
  v_mul_f32 v26, v26, v14
  v_cvt_pk_bf16_f32 v25, v25, v26
  v_lshlrev_b32 v26, 16, v25
  v_and_b32 v25, 0xffff0000, v25
  v_add_f32 v45, v45, v26
  v_add_f32 v45, v45, v25
  v_lshlrev_b32 v25, 16, v247
  v_and_b32 v26, 0xffff0000, v247
  v_mul_f32 v25, v25, v20
  v_mul_f32 v26, v26, v15
  v_cvt_pk_bf16_f32 v25, v25, v26
  v_lshlrev_b32 v26, 16, v25
  v_and_b32 v25, 0xffff0000, v25
  v_add_f32 v45, v45, v26
  v_add_f32 v45, v45, v25
  v_lshlrev_b32 v25, 16, v61
  v_and_b32 v26, 0xffff0000, v61
  v_mul_f32 v25, v25, v21
  v_mul_f32 v26, v26, v16
  v_cvt_pk_bf16_f32 v25, v25, v26
  v_lshlrev_b32 v26, 16, v25
  v_and_b32 v25, 0xffff0000, v25
  v_add_f32 v45, v45, v26
  v_add_f32 v45, v45, v25
  v_mov_b32 v46, 0
  v_lshlrev_b32 v25, 16, v248
  v_and_b32 v26, 0xffff0000, v248
  v_mul_f32 v25, v25, v17
  v_mul_f32 v26, v26, v12
  v_cvt_pk_bf16_f32 v25, v25, v26
  v_lshlrev_b32 v26, 16, v25
  v_and_b32 v25, 0xffff0000, v25
  v_add_f32 v46, v46, v26
  v_add_f32 v46, v46, v25
  v_lshlrev_b32 v25, 16, v249
  v_and_b32 v26, 0xffff0000, v249
  v_mul_f32 v25, v25, v18
  v_mul_f32 v26, v26, v13
  v_cvt_pk_bf16_f32 v25, v25, v26
  v_lshlrev_b32 v26, 16, v25
  v_and_b32 v25, 0xffff0000, v25
  v_add_f32 v46, v46, v26
  v_add_f32 v46, v46, v25
  v_lshlrev_b32 v25, 16, v250
  v_and_b32 v26, 0xffff0000, v250
  v_mul_f32 v25, v25, v19
  v_mul_f32 v26, v26, v14
  v_cvt_pk_bf16_f32 v25, v25, v26
  v_lshlrev_b32 v26, 16, v25
  v_and_b32 v25, 0xffff0000, v25
  v_add_f32 v46, v46, v26
  v_add_f32 v46, v46, v25
  v_lshlrev_b32 v25, 16, v251
  v_and_b32 v26, 0xffff0000, v251
  v_mul_f32 v25, v25, v20
  v_mul_f32 v26, v26, v15
  v_cvt_pk_bf16_f32 v25, v25, v26
  v_lshlrev_b32 v26, 16, v25
  v_and_b32 v25, 0xffff0000, v25
  v_add_f32 v46, v46, v26
  v_add_f32 v46, v46, v25
  v_lshlrev_b32 v25, 16, v62
  v_and_b32 v26, 0xffff0000, v62
  v_mul_f32 v25, v25, v21
  v_mul_f32 v26, v26, v16
  v_cvt_pk_bf16_f32 v25, v25, v26
  v_lshlrev_b32 v26, 16, v25
  v_and_b32 v25, 0xffff0000, v25
  v_add_f32 v46, v46, v26
  v_add_f32 v46, v46, v25
  v_mov_b32 v47, 0
  v_lshlrev_b32 v25, 16, v252
  v_and_b32 v26, 0xffff0000, v252
  v_mul_f32 v25, v25, v17
  v_mul_f32 v26, v26, v12
  v_cvt_pk_bf16_f32 v25, v25, v26
  v_lshlrev_b32 v26, 16, v25
  v_and_b32 v25, 0xffff0000, v25
  v_add_f32 v47, v47, v26
  v_add_f32 v47, v47, v25
  v_lshlrev_b32 v25, 16, v253
  v_and_b32 v26, 0xffff0000, v253
  v_mul_f32 v25, v25, v18
  v_mul_f32 v26, v26, v13
  v_cvt_pk_bf16_f32 v25, v25, v26
  v_lshlrev_b32 v26, 16, v25
  v_and_b32 v25, 0xffff0000, v25
  v_add_f32 v47, v47, v26
  v_add_f32 v47, v47, v25
  v_lshlrev_b32 v25, 16, v254
  v_and_b32 v26, 0xffff0000, v254
  v_mul_f32 v25, v25, v19
  v_mul_f32 v26, v26, v14
  v_cvt_pk_bf16_f32 v25, v25, v26
  v_lshlrev_b32 v26, 16, v25
  v_and_b32 v25, 0xffff0000, v25
  v_add_f32 v47, v47, v26
  v_add_f32 v47, v47, v25
  v_lshlrev_b32 v25, 16, v255
  v_and_b32 v26, 0xffff0000, v255
  v_mul_f32 v25, v25, v20
  v_mul_f32 v26, v26, v15
  v_cvt_pk_bf16_f32 v25, v25, v26
  v_lshlrev_b32 v26, 16, v25
  v_and_b32 v25, 0xffff0000, v25
  v_add_f32 v47, v47, v26
  v_add_f32 v47, v47, v25
  v_lshlrev_b32 v25, 16, v63
  v_and_b32 v26, 0xffff0000, v63
  v_mul_f32 v25, v25, v21
  v_mul_f32 v26, v26, v16
  v_cvt_pk_bf16_f32 v25, v25, v26
  v_lshlrev_b32 v26, 16, v25
  v_and_b32 v25, 0xffff0000, v25
  v_add_f32 v47, v47, v26
  v_add_f32 v47, v47, v25
  v_add_f32_dpp v32, v32, v32 row_ror:8 row_mask:0xf bank_mask:0xf
  v_add_f32_dpp v33, v33, v33 row_ror:8 row_mask:0xf bank_mask:0xf
  v_add_f32_dpp v34, v34, v34 row_ror:8 row_mask:0xf bank_mask:0xf
  v_add_f32_dpp v35, v35, v35 row_ror:8 row_mask:0xf bank_mask:0xf
  v_add_f32_dpp v36, v36, v36 row_ror:8 row_mask:0xf bank_mask:0xf
  v_add_f32_dpp v37, v37, v37 row_ror:8 row_mask:0xf bank_mask:0xf
  v_add_f32_dpp v38, v38, v38 row_ror:8 row_mask:0xf bank_mask:0xf
  v_add_f32_dpp v39, v39, v39 row_ror:8 row_mask:0xf bank_mask:0xf
  v_add_f32_dpp v40, v40, v40 row_ror:8 row_mask:0xf bank_mask:0xf
  v_add_f32_dpp v41, v41, v41 row_ror:8 row_mask:0xf bank_mask:0xf
  v_add_f32_dpp v42, v42, v42 row_ror:8 row_mask:0xf bank_mask:0xf
  v_add_f32_dpp v43, v43, v43 row_ror:8 row_mask:0xf bank_mask:0xf
  v_add_f32_dpp v44, v44, v44 row_ror:8 row_mask:0xf bank_mask:0xf
  v_add_f32_dpp v45, v45, v45 row_ror:8 row_mask:0xf bank_mask:0xf
  v_add_f32_dpp v46, v46, v46 row_ror:8 row_mask:0xf bank_mask:0xf
  v_add_f32_dpp v47, v47, v47 row_ror:8 row_mask:0xf bank_mask:0xf
  v_add_f32_dpp v32, v32, v32 row_ror:4 row_mask:0xf bank_mask:0xf
  v_add_f32_dpp v33, v33, v33 row_ror:4 row_mask:0xf bank_mask:0xf
  v_add_f32_dpp v34, v34, v34 row_ror:4 row_mask:0xf bank_mask:0xf
  v_add_f32_dpp v35, v35, v35 row_ror:4 row_mask:0xf bank_mask:0xf
  v_add_f32_dpp v36, v36, v36 row_ror:4 row_mask:0xf bank_mask:0xf
  v_add_f32_dpp v37, v37, v37 row_ror:4 row_mask:0xf bank_mask:0xf
  v_add_f32_dpp v38, v38, v38 row_ror:4 row_mask:0xf bank_mask:0xf
  v_add_f32_dpp v39, v39, v39 row_ror:4 row_mask:0xf bank_mask:0xf
  v_add_f32_dpp v40, v40, v40 row_ror:4 row_mask:0xf bank_mask:0xf
  v_add_f32_dpp v41, v41, v41 row_ror:4 row_mask:0xf bank_mask:0xf
  v_add_f32_dpp v42, v42, v42 row_ror:4 row_mask:0xf bank_mask:0xf
  v_add_f32_dpp v43, v43, v43 row_ror:4 row_mask:0xf bank_mask:0xf
  v_add_f32_dpp v44, v44, v44 row_ror:4 row_mask:0xf bank_mask:0xf
  v_add_f32_dpp v45, v45, v45 row_ror:4 row_mask:0xf bank_mask:0xf
  v_add_f32_dpp v46, v46, v46 row_ror:4 row_mask:0xf bank_mask:0xf
  v_add_f32_dpp v47, v47, v47 row_ror:4 row_mask:0xf bank_mask:0xf
  v_add_f32_dpp v32, v32, v32 row_ror:2 row_mask:0xf bank_mask:0xf
  v_add_f32_dpp v33, v33, v33 row_ror:2 row_mask:0xf bank_mask:0xf
  v_add_f32_dpp v34, v34, v34 row_ror:2 row_mask:0xf bank_mask:0xf
  v_add_f32_dpp v35, v35, v35 row_ror:2 row_mask:0xf bank_mask:0xf
  v_add_f32_dpp v36, v36, v36 row_ror:2 row_mask:0xf bank_mask:0xf
  v_add_f32_dpp v37, v37, v37 row_ror:2 row_mask:0xf bank_mask:0xf
  v_add_f32_dpp v38, v38, v38 row_ror:2 row_mask:0xf bank_mask:0xf
  v_add_f32_dpp v39, v39, v39 row_ror:2 row_mask:0xf bank_mask:0xf
  v_add_f32_dpp v40, v40, v40 row_ror:2 row_mask:0xf bank_mask:0xf
  v_add_f32_dpp v41, v41, v41 row_ror:2 row_mask:0xf bank_mask:0xf
  v_add_f32_dpp v42, v42, v42 row_ror:2 row_mask:0xf bank_mask:0xf
  v_add_f32_dpp v43, v43, v43 row_ror:2 row_mask:0xf bank_mask:0xf
  v_add_f32_dpp v44, v44, v44 row_ror:2 row_mask:0xf bank_mask:0xf
  v_add_f32_dpp v45, v45, v45 row_ror:2 row_mask:0xf bank_mask:0xf
  v_add_f32_dpp v46, v46, v46 row_ror:2 row_mask:0xf bank_mask:0xf
  v_add_f32_dpp v47, v47, v47 row_ror:2 row_mask:0xf bank_mask:0xf
  v_add_f32_dpp v32, v32, v32 row_ror:1 row_mask:0xf bank_mask:0xf
  v_add_f32_dpp v33, v33, v33 row_ror:1 row_mask:0xf bank_mask:0xf
  v_add_f32_dpp v34, v34, v34 row_ror:1 row_mask:0xf bank_mask:0xf
  v_add_f32_dpp v35, v35, v35 row_ror:1 row_mask:0xf bank_mask:0xf
  v_add_f32_dpp v36, v36, v36 row_ror:1 row_mask:0xf bank_mask:0xf
  v_add_f32_dpp v37, v37, v37 row_ror:1 row_mask:0xf bank_mask:0xf
  v_add_f32_dpp v38, v38, v38 row_ror:1 row_mask:0xf bank_mask:0xf
  v_add_f32_dpp v39, v39, v39 row_ror:1 row_mask:0xf bank_mask:0xf
  v_add_f32_dpp v40, v40, v40 row_ror:1 row_mask:0xf bank_mask:0xf
  v_add_f32_dpp v41, v41, v41 row_ror:1 row_mask:0xf bank_mask:0xf
  v_add_f32_dpp v42, v42, v42 row_ror:1 row_mask:0xf bank_mask:0xf
  v_add_f32_dpp v43, v43, v43 row_ror:1 row_mask:0xf bank_mask:0xf
  v_add_f32_dpp v44, v44, v44 row_ror:1 row_mask:0xf bank_mask:0xf
  v_add_f32_dpp v45, v45, v45 row_ror:1 row_mask:0xf bank_mask:0xf
  v_add_f32_dpp v46, v46, v46 row_ror:1 row_mask:0xf bank_mask:0xf
  v_add_f32_dpp v47, v47, v47 row_ror:1 row_mask:0xf bank_mask:0xf
  v_mov_b32 v24, v32
  v_cmp_eq_u32 vcc, 1, v2
  s_nop 1
  v_cndmask_b32 v24, v24, v33, vcc
  v_cmp_eq_u32 vcc, 2, v2
  s_nop 1
  v_cndmask_b32 v24, v24, v34, vcc
  v_cmp_eq_u32 vcc, 3, v2
  s_nop 1
  v_cndmask_b32 v24, v24, v35, vcc
  v_cmp_eq_u32 vcc, 4, v2
  s_nop 1
  v_cndmask_b32 v24, v24, v36, vcc
  v_cmp_eq_u32 vcc, 5, v2
  s_nop 1
  v_cndmask_b32 v24, v24, v37, vcc
  v_cmp_eq_u32 vcc, 6, v2
  s_nop 1
  v_cndmask_b32 v24, v24, v38, vcc
  v_cmp_eq_u32 vcc, 7, v2
  s_nop 1
  v_cndmask_b32 v24, v24, v39, vcc
  v_cmp_eq_u32 vcc, 8, v2
  s_nop 1
  v_cndmask_b32 v24, v24, v40, vcc
  v_cmp_eq_u32 vcc, 9, v2
  s_nop 1
  v_cndmask_b32 v24, v24, v41, vcc
  v_cmp_eq_u32 vcc, 10, v2
  s_nop 1
  v_cndmask_b32 v24, v24, v42, vcc
  v_cmp_eq_u32 vcc, 11, v2
  s_nop 1
  v_cndmask_b32 v24, v24, v43, vcc
  v_cmp_eq_u32 vcc, 12, v2
  s_nop 1
  v_cndmask_b32 v24, v24, v44, vcc
  v_cmp_eq_u32 vcc, 13, v2
  s_nop 1
  v_cndmask_b32 v24, v24, v45, vcc
  v_cmp_eq_u32 vcc, 14, v2
  s_nop 1
  v_cndmask_b32 v24, v24, v46, vcc
  v_cmp_eq_u32 vcc, 15, v2
  s_nop 1
  v_cndmask_b32 v24, v24, v47, vcc
  v_mov_b32 v25, v24
  s_nop 1
  v_permlane32_swap_b32 v24, v25
  v_add_f32 v24, v24, v25
  v_mov_b32 v25, v24
  s_nop 1
  v_permlane16_swap_b32 v24, v25
  v_add_f32 v24, v24, v25
  v_cvt_pk_bf16_f32 v25, v24, v24
  v_lshlrev_b32 v24, 16, v25
  v_mul_f32 v24, 0xbfb8aa3b, v24
  v_exp_f32 v24, v24
  s_nop 0
  v_add_f32 v24, 1.0, v24
  v_rcp_f32 v24, v24
  s_nop 0
  v_cvt_pk_bf16_f32 v25, v24, v24
  v_lshlrev_b32 v24, 16, v25
  s_lshl_b32 s21, s59, 2
  s_mov_b64 exec, 0xffff
  buffer_store_dword v24, v10, s[76:79], s21 offen sc1
  s_mov_b64 exec, -1
qg_261:
  s_waitcnt vmcnt(45)
  s_barrier
  ds_read_b64_tr_b16 a[0:1], v7 offset:0
  ds_read_b64_tr_b16 a[2:3], v7 offset:1536
  ds_read_b64_tr_b16 a[4:5], v7 offset:32
  ds_read_b64_tr_b16 a[6:7], v7 offset:1568
  ds_read_b64_tr_b16 a[8:9], v7 offset:64
  ds_read_b64_tr_b16 a[10:11], v7 offset:1600
  ds_read_b64_tr_b16 a[12:13], v7 offset:12288
  ds_read_b64_tr_b16 a[14:15], v7 offset:13824
  ds_read_b64_tr_b16 a[16:17], v7 offset:12320
  ds_read_b64_tr_b16 a[18:19], v7 offset:13856
  ds_read_b64_tr_b16 a[20:21], v7 offset:12352
  ds_read_b64_tr_b16 a[22:23], v7 offset:13888
  ds_read_b64_tr_b16 a[24:25], v7 offset:24576
  ds_read_b64_tr_b16 a[26:27], v7 offset:26112
  ds_read_b64_tr_b16 a[28:29], v7 offset:24608
  ds_read_b64_tr_b16 a[30:31], v7 offset:26144
  ds_read_b64_tr_b16 a[32:33], v7 offset:24640
  ds_read_b64_tr_b16 a[34:35], v7 offset:26176
  ds_read_b64_tr_b16 a[36:37], v7 offset:36864
  ds_read_b64_tr_b16 a[38:39], v7 offset:38400
  ds_read_b64_tr_b16 a[40:41], v7 offset:36896
  ds_read_b64_tr_b16 a[42:43], v7 offset:38432
  ds_read_b64_tr_b16 a[44:45], v7 offset:36928
  ds_read_b64_tr_b16 a[46:47], v7 offset:38464
  ds_read_b64_tr_b16 a[48:49], v7 offset:49152
  ds_read_b64_tr_b16 a[50:51], v7 offset:50688
  ds_read_b64_tr_b16 a[52:53], v7 offset:49184
  ds_read_b64_tr_b16 a[54:55], v7 offset:50720
  ds_read_b64_tr_b16 a[56:57], v7 offset:49216
  ds_read_b64_tr_b16 a[58:59], v7 offset:50752
  s_waitcnt lgkmcnt(0)
  s_barrier
  s_cmp_lg_u32 s40, 0
  s_cbranch_scc1 qg_262
  s_add_u32 s28, s38, 180355072
  s_addc_u32 s29, s39, 0
  s_mov_b32 s30, 4194304
  s_mov_b32 s31, 0x00020000
  v_lshrrev_b32 v22, 2, v2
  v_and_b32 v23, 3, v2
  v_lshlrev_b32 v23, 3, v23
  v_lshl_add_u32 v24, v3, 2, v22
  v_mul_u32_u24 v24, 160, v24
  s_mul_i32 s21, s20, 6400
  s_add_u32 s21, s21, 122880
  v_add3_u32 v24, v24, v23, s21
  v_add_u32 v25, v24, v23
  v_mul_u32_u24 v26, 20, v3
  v_add_u32 v26, v26, v22
  v_mul_u32_u24 v26, 160, v26
  s_mov_b32 s21, 122880
  v_add3_u32 v26, v26, v23, s21
  v_add_u32 v27, v26, v23
  s_and_b32 s22, s2, 7
  s_lshr_b32 s23, s2, 3
  ds_read_b64_tr_b16 v[192:193], v25 offset:0
  ds_read_b64_tr_b16 v[194:195], v25 offset:3200
  ds_read_b64_tr_b16 v[196:197], v25 offset:8
  ds_read_b64_tr_b16 v[198:199], v25 offset:3208
  ds_read_b64_tr_b16 v[200:201], v24 offset:64
  ds_read_b64_tr_b16 v[202:203], v24 offset:3264
  ds_read_b64_tr_b16 v[204:205], v25 offset:96
  ds_read_b64_tr_b16 v[206:207], v25 offset:3296
  ds_read_b64_tr_b16 v[208:209], v25 offset:104
  ds_read_b64_tr_b16 v[210:211], v25 offset:3304
  ds_read_b64_tr_b16 v[212:213], v27 offset:2560
  ds_read_b64_tr_b16 v[214:215], v27 offset:15360
  ds_read_b64_tr_b16 v[216:217], v27 offset:2568
  ds_read_b64_tr_b16 v[218:219], v27 offset:15368
  ds_read_b64_tr_b16 v[220:221], v26 offset:2624
  ds_read_b64_tr_b16 v[222:223], v26 offset:15424
  ds_read_b64_tr_b16 v[224:225], v27 offset:2656
  ds_read_b64_tr_b16 v[226:227], v27 offset:15456
  ds_read_b64_tr_b16 v[228:229], v27 offset:2664
  ds_read_b64_tr_b16 v[230:231], v27 offset:15464
  s_lshl_b32 s22, s22, 2
  s_add_u32 s22, s22, s23
  s_lshl_b32 s22, s22, 17
  s_lshr_b32 s21, s22, 8
  s_andn2_b32 s21, 8192, s21
  s_xor_b32 s21, s21, s80
  s_add_u32 s22, s22, s21
  s_add_u32 s23, s22, 65536
  s_cmp_eq_u32 s20, 0
  s_cselect_b32 s23, s23, 0x40000000
  s_lshl_b32 s21, s20, 14
  s_add_u32 s22, s22, s21
  v_add_u32 v22, 4096, v11
  s_waitcnt lgkmcnt(0)
  buffer_store_dwordx4 v[192:195], v11, s[28:31], s22 offen offset:0 sc1
  buffer_store_dwordx4 v[196:199], v11, s[28:31], s22 offen offset:1024 sc1
  buffer_store_dwordx4 v[200:203], v11, s[28:31], s22 offen offset:2048 sc1
  buffer_store_dwordx4 v[204:207], v11, s[28:31], s22 offen offset:3072 sc1
  buffer_store_dwordx4 v[208:211], v22, s[28:31], s22 offen offset:0 sc1
  buffer_store_dwordx4 v[212:215], v11, s[28:31], s23 offen offset:0 sc1
  buffer_store_dwordx4 v[216:219], v11, s[28:31], s23 offen offset:1024 sc1
  buffer_store_dwordx4 v[220:223], v11, s[28:31], s23 offen offset:2048 sc1
  buffer_store_dwordx4 v[224:227], v11, s[28:31], s23 offen offset:3072 sc1
  buffer_store_dwordx4 v[228:231], v22, s[28:31], s23 offen offset:0 sc1
qg_262:
  s_waitcnt vmcnt(30)
  s_barrier
  ds_read_b64_tr_b16 a[60:61], v8 offset:0
  ds_read_b64_tr_b16 a[62:63], v8 offset:1536
  ds_read_b64_tr_b16 a[64:65], v8 offset:32
  ds_read_b64_tr_b16 a[66:67], v8 offset:1568
  ds_read_b64_tr_b16 a[68:69], v8 offset:64
  ds_read_b64_tr_b16 a[70:71], v8 offset:1600
  ds_read_b64_tr_b16 a[72:73], v8 offset:12288
  ds_read_b64_tr_b16 a[74:75], v8 offset:13824
  ds_read_b64_tr_b16 a[76:77], v8 offset:12320
  ds_read_b64_tr_b16 a[78:79], v8 offset:13856
  ds_read_b64_tr_b16 a[80:81], v8 offset:12352
  ds_read_b64_tr_b16 a[82:83], v8 offset:13888
  ds_read_b64_tr_b16 a[84:85], v8 offset:24576
  ds_read_b64_tr_b16 a[86:87], v8 offset:26112
  ds_read_b64_tr_b16 a[88:89], v8 offset:24608
  ds_read_b64_tr_b16 a[90:91], v8 offset:26144
  ds_read_b64_tr_b16 a[92:93], v8 offset:24640
  ds_read_b64_tr_b16 a[94:95], v8 offset:26176
  ds_read_b64_tr_b16 a[96:97], v8 offset:36864
  ds_read_b64_tr_b16 a[98:99], v8 offset:38400
  ds_read_b64_tr_b16 a[100:101], v8 offset:36896
  ds_read_b64_tr_b16 a[102:103], v8 offset:38432
  ds_read_b64_tr_b16 a[104:105], v8 offset:36928
  ds_read_b64_tr_b16 a[106:107], v8 offset:38464
  ds_read_b64_tr_b16 a[108:109], v8 offset:49152
  ds_read_b64_tr_b16 a[110:111], v8 offset:50688
  ds_read_b64_tr_b16 a[112:113], v8 offset:49184
  ds_read_b64_tr_b16 a[114:115], v8 offset:50720
  ds_read_b64_tr_b16 a[116:117], v8 offset:49216
  ds_read_b64_tr_b16 a[118:119], v8 offset:50752
  s_waitcnt lgkmcnt(0)
  s_barrier
  s_waitcnt vmcnt(15)
  ds_write_b128 v30, v[64:67] offset:0
  ds_write_b128 v30, v[68:71] offset:1024
  ds_write_b128 v30, v[72:75] offset:2048
  ds_write_b128 v30, v[76:79] offset:3072
  ds_write_b128 v30, v[80:83] offset:4096
  ds_write_b128 v30, v[84:87] offset:5120
  ds_write_b128 v30, v[88:91] offset:6144
  ds_write_b128 v30, v[92:95] offset:7168
  ds_write_b128 v30, v[96:99] offset:8192
  ds_write_b128 v30, v[100:103] offset:9216
  ds_write_b128 v30, v[104:107] offset:10240
  ds_write_b128 v30, v[108:111] offset:11264
  ds_write_b128 v30, v[112:115] offset:12288
  ds_write_b128 v30, v[116:119] offset:13312
  ds_write_b128 v30, v[120:123] offset:14336
  s_waitcnt lgkmcnt(0)
  s_barrier
  ds_read_b64_tr_b16 a[120:121], v7 offset:0
  ds_read_b64_tr_b16 a[122:123], v7 offset:1536
  ds_read_b64_tr_b16 a[124:125], v7 offset:32
  ds_read_b64_tr_b16 a[126:127], v7 offset:1568
  ds_read_b64_tr_b16 a[128:129], v7 offset:64
  ds_read_b64_tr_b16 a[130:131], v7 offset:1600
  ds_read_b64_tr_b16 a[132:133], v7 offset:12288
  ds_read_b64_tr_b16 a[134:135], v7 offset:13824
  ds_read_b64_tr_b16 a[136:137], v7 offset:12320
  ds_read_b64_tr_b16 a[138:139], v7 offset:13856
  ds_read_b64_tr_b16 a[140:141], v7 offset:12352
  ds_read_b64_tr_b16 a[142:143], v7 offset:13888
  ds_read_b64_tr_b16 a[144:145], v7 offset:24576
  ds_read_b64_tr_b16 a[146:147], v7 offset:26112
  ds_read_b64_tr_b16 a[148:149], v7 offset:24608
  ds_read_b64_tr_b16 a[150:151], v7 offset:26144
  ds_read_b64_tr_b16 a[152:153], v7 offset:24640
  ds_read_b64_tr_b16 a[154:155], v7 offset:26176
  ds_read_b64_tr_b16 a[156:157], v7 offset:36864
  ds_read_b64_tr_b16 a[158:159], v7 offset:38400
  ds_read_b64_tr_b16 a[160:161], v7 offset:36896
  ds_read_b64_tr_b16 a[162:163], v7 offset:38432
  ds_read_b64_tr_b16 a[164:165], v7 offset:36928
  ds_read_b64_tr_b16 a[166:167], v7 offset:38464
  ds_read_b64_tr_b16 a[168:169], v7 offset:49152
  ds_read_b64_tr_b16 a[170:171], v7 offset:50688
  ds_read_b64_tr_b16 a[172:173], v7 offset:49184
  ds_read_b64_tr_b16 a[174:175], v7 offset:50720
  ds_read_b64_tr_b16 a[176:177], v7 offset:49216
  ds_read_b64_tr_b16 a[178:179], v7 offset:50752
  s_waitcnt lgkmcnt(0)
  s_barrier
  s_waitcnt vmcnt(0)
  ds_write_b128 v31, v[124:127] offset:0
  ds_write_b128 v31, v[128:131] offset:1024
  ds_write_b128 v31, v[132:135] offset:2048
  ds_write_b128 v31, v[136:139] offset:3072
  ds_write_b128 v31, v[140:143] offset:4096
  ds_write_b128 v31, v[144:147] offset:5120
  ds_write_b128 v31, v[148:151] offset:6144
  ds_write_b128 v31, v[152:155] offset:7168
  ds_write_b128 v31, v[156:159] offset:8192
  ds_write_b128 v31, v[160:163] offset:9216
  ds_write_b128 v31, v[164:167] offset:10240
  ds_write_b128 v31, v[168:171] offset:11264
  ds_write_b128 v31, v[172:175] offset:12288
  ds_write_b128 v31, v[176:179] offset:13312
  ds_write_b128 v31, v[180:183] offset:14336
  s_waitcnt lgkmcnt(0)
  s_barrier
  ds_read_b64_tr_b16 a[180:181], v8 offset:0
  ds_read_b64_tr_b16 a[182:183], v8 offset:1536
  ds_read_b64_tr_b16 a[184:185], v8 offset:32
  ds_read_b64_tr_b16 a[186:187], v8 offset:1568
  ds_read_b64_tr_b16 a[188:189], v8 offset:64
  ds_read_b64_tr_b16 a[190:191], v8 offset:1600
  ds_read_b64_tr_b16 a[192:193], v8 offset:12288
  ds_read_b64_tr_b16 a[194:195], v8 offset:13824
  ds_read_b64_tr_b16 a[196:197], v8 offset:12320
  ds_read_b64_tr_b16 a[198:199], v8 offset:13856
  ds_read_b64_tr_b16 a[200:201], v8 offset:12352
  ds_read_b64_tr_b16 a[202:203], v8 offset:13888
  ds_read_b64_tr_b16 a[204:205], v8 offset:24576
  ds_read_b64_tr_b16 a[206:207], v8 offset:26112
  ds_read_b64_tr_b16 a[208:209], v8 offset:24608
  ds_read_b64_tr_b16 a[210:211], v8 offset:26144
  ds_read_b64_tr_b16 a[212:213], v8 offset:24640
  ds_read_b64_tr_b16 a[214:215], v8 offset:26176
  ds_read_b64_tr_b16 a[216:217], v8 offset:36864
  ds_read_b64_tr_b16 a[218:219], v8 offset:38400
  ds_read_b64_tr_b16 a[220:221], v8 offset:36896
  ds_read_b64_tr_b16 a[222:223], v8 offset:38432
  ds_read_b64_tr_b16 a[224:225], v8 offset:36928
  ds_read_b64_tr_b16 a[226:227], v8 offset:38464
  ds_read_b64_tr_b16 a[228:229], v8 offset:49152
  ds_read_b64_tr_b16 a[230:231], v8 offset:50688
  ds_read_b64_tr_b16 a[232:233], v8 offset:49184
  ds_read_b64_tr_b16 a[234:235], v8 offset:50720
  ds_read_b64_tr_b16 a[236:237], v8 offset:49216
  ds_read_b64_tr_b16 a[238:239], v8 offset:50752
  s_waitcnt lgkmcnt(0)
  s_barrier
  s_and_b32 s21, s2, 3
  s_lshl_b32 s21, s21, 7
  s_add_u32 s21, s21, 29696
  s_xor_b32 s21, s21, s80
  s_cmp_lg_u32 s40, 0
  s_cbranch_scc1 qg_263
  s_cmp_lg_u32 s20, 0
  s_cbranch_scc1 af_264
  v_mov_b32 v8, 0
  v_mov_b32 v9, 1
  s_mov_b64 exec, 1
  buffer_atomic_add v9, v8, s[72:75], s21 offen sc1
  s_mov_b64 exec, -1
  s_nop 1
af_264:
qg_263:
  s_add_u32 s56, s38, 218103808
  s_addc_u32 s57, s39, 0
  s_mov_b32 s58, 12582912
  s_mov_b32 s59, 0x00020000
  s_cmp_eq_u32 s40, 0
  s_cselect_b32 s85, 1, 99
  s_cselect_b32 s89, 99, 3
  s_cselect_b32 s21, 0, 2
  s_add_u32 s21, s21, s40
  s_mul_i32 s30, s21, 163840
  s_mul_i32 s90, s41, 163840
  s_sub_u32 s90, 162688, s90
  s_mov_b32 s26, s41
  s_mul_i32 s86, s42, 393216
  s_sub_u32 s91, s41, 2
  s_cmp_eq_u32 s40, 0
  s_cselect_b32 s91, 0, s91
  s_lshl_b32 s46, s40, 2
  s_add_u32 s46, s46, s20
  v_lshrrev_b32 v4, 3, v1
  v_and_b32 v5, 7, v1
  v_xor_b32 v5, v5, v4
  s_mul_i32 s21, s20, 32
  v_add_u32 v4, s21, v4
  v_mul_u32_u24 v4, 1280, v4
  v_lshl_add_u32 v10, v5, 4, v4
  s_mul_i32 s31, s20, 4096
  v_add_u32 v11, 10240, v10
  v_add_u32 v12, 20480, v10
  v_add_u32 v13, 30720, v10
  s_add_u32 m0, s31, 0
  s_nop 0
  buffer_load_dwordx4 v10, s[8:11], s30 offen lds
  s_add_u32 m0, s31, 1024
  s_nop 0
  buffer_load_dwordx4 v11, s[8:11], s30 offen lds
  s_add_u32 m0, s31, 2048
  s_nop 0
  buffer_load_dwordx4 v12, s[8:11], s30 offen lds
  s_add_u32 m0, s31, 3072
  s_nop 0
  buffer_load_dwordx4 v13, s[8:11], s30 offen lds
  s_add_u32 s30, s30, 128
  s_add_u32 m0, s31, 16384
  s_nop 0
  buffer_load_dwordx4 v10, s[8:11], s30 offen lds
  s_add_u32 m0, s31, 17408
  s_nop 0
  buffer_load_dwordx4 v11, s[8:11], s30 offen lds
  s_add_u32 m0, s31, 18432
  s_nop 0
  buffer_load_dwordx4 v12, s[8:11], s30 offen lds
  s_add_u32 m0, s31, 19456
  s_nop 0
  buffer_load_dwordx4 v13, s[8:11], s30 offen lds
  s_add_u32 s30, s30, 128
  s_add_u32 m0, s31, 32768
  s_nop 0
  buffer_load_dwordx4 v10, s[8:11], s30 offen lds
  s_add_u32 m0, s31, 33792
  s_nop 0
  buffer_load_dwordx4 v11, s[8:11], s30 offen lds
  s_add_u32 m0, s31, 34816
  s_nop 0
  buffer_load_dwordx4 v12, s[8:11], s30 offen lds
  s_add_u32 m0, s31, 35840
  s_nop 0
  buffer_load_dwordx4 v13, s[8:11], s30 offen lds
  s_add_u32 s30, s30, 128
  v_and_b32 v6, 7, v2
  v_add_u32 v4, 0, v3
  v_xor_b32 v4, v4, v6
  v_lshlrev_b32 v4, 4, v4
  v_lshl_add_u32 v14, v2, 7, v4
  v_add_u32 v16, 65536, v14
  v_add_u32 v18, 131072, v14
  v_add_u32 v4, 4, v3
  v_xor_b32 v4, v4, v6
  v_lshlrev_b32 v4, 4, v4
  v_lshl_add_u32 v15, v2, 7, v4
  v_add_u32 v17, 65536, v15
  v_add_u32 v19, 131072, v15
  v_lshlrev_b32 v26, 4, v1
  v_mov_b32 v28, 1
  v_mov_b32 v4, 0x40000000
  v_cmp_eq_u32 vcc, 0, v0
  s_nop 1
  v_cndmask_b32 v27, v4, 0, vcc
  s_mul_i32 s21, s20, 3072
  s_add_u32 s21, s21, 81920
  v_add_u32 v20, s21, v26
  s_mul_i32 s21, s20, 12288
  s_add_u32 s21, s21, 81920
  v_add_u32 v21, s21, v26
  v_add_u32 v22, 2048, v21
  v_add_u32 v23, 2056, v21
  v_and_b32 v4, 7, v2
  v_lshlrev_b32 v4, 4, v4
  v_lshl_add_u32 v24, v3, 7, v4
  v_lshrrev_b32 v25, 1, v24
  v_lshlrev_b32 v29, 3, v1
  v_and_b32 v4, 3, v1
  v_lshlrev_b32 v30, 3, v4
  v_mov_b32 v31, 0xf149f2ca
  v_mov_b32 v32, 0
  v_mov_b32 v4, 1073741824
  v_cmp_eq_u32 vcc, 0, v1
  v_lshlrev_b32 v5, 2, v3
  v_sub_u32 v5, v2, v5
  v_cndmask_b32 v33, v4, 0, vcc
  v_cmp_gt_u32 s[62:63], 2, v3
  s_mov_b32 s83, 0x3dd53b95
  s_lshl_b32 s77, s42, 7
  s_add_u32 s77, s77, 0
  s_xor_b32 s77, s77, s80
  s_lshl_b32 s45, s46, 21
  s_lshl_b32 s21, s46, 13
  s_and_b32 s21, s21, 8192
  s_xor_b32 s21, s21, s80
  s_add_u32 s45, s45, s21
  s_lshl_b32 s21, s42, 16
  s_add_u32 s45, s45, s21
  s_lshr_b32 s47, s42, 1
  s_lshl_b32 s47, s47, 14
  s_and_b32 s22, s42, 1
  s_mul_i32 s22, s22, 2560
  s_add_u32 s47, s47, s22
  s_lshl_b32 s21, s46, 19
  s_lshl_b32 s22, s46, 11
  s_and_b32 s22, s22, 8192
  s_xor_b32 s22, s22, s80
  s_add_u32 s21, s21, s22
  s_add_u32 s21, s21, 136314880
  s_xor_b32 s21, s21, 8192
  s_add_u32 s47, s47, s21
  s_add_u32 s47, s47, 48234496
  s_lshl_b32 s48, s46, 7
  s_add_u32 s48, s48, 8192
  s_xor_b32 s48, s48, s80
  s_add_u32 s43, s46, 1
  s_mov_b32 s49, 0
  s_mov_b32 s50, 1073741824
  s_mov_b32 s81, 1073741824
  s_mov_b32 s82, 1073741824
  s_mov_b32 s84, 1073741824
  v_cmp_le_i32 s[64:65], 0, v5
  v_cmp_le_i32 s[66:67], 1, v5
  v_cmp_le_i32 s[68:69], 2, v5
  v_cmp_le_i32 s[70:71], 3, v5
  s_waitcnt vmcnt(8)
  s_barrier
  ds_read_b128 v[160:163], v14 offset:0
  ds_read_b128 v[164:167], v14 offset:2048
  ds_read_b128 v[168:171], v14 offset:4096
  ds_read_b128 v[172:175], v14 offset:6144
  s_waitcnt lgkmcnt(3)
  .p2align 3
qa_269:
  v_mfma_f32_16x16x32_bf16 v[64:67], a[0:3], v[160:163], 0
  ds_read_b128 v[176:179], v14 offset:8192
  v_cvt_pk_bf16_f32 v221, v126, v127
  v_mfma_f32_16x16x32_bf16 v[68:71], a[4:7], v[160:163], 0
  v_cvt_pk_bf16_f32 v222, v128, v129
  v_cvt_pk_bf16_f32 v223, v130, v131
  v_mfma_f32_16x16x32_bf16 v[72:75], a[8:11], v[160:163], 0
  s_waitcnt lgkmcnt(3)
  v_cvt_pk_bf16_f32 v226, v132, v133
  v_cvt_pk_bf16_f32 v227, v134, v135
  v_mfma_f32_16x16x32_bf16 v[76:79], a[0:3], v[164:167], 0
  ds_read_b128 v[180:183], v14 offset:10240
  v_cvt_pk_bf16_f32 v228, v136, v137
  v_mfma_f32_16x16x32_bf16 v[80:83], a[4:7], v[164:167], 0
  v_cvt_pk_bf16_f32 v229, v138, v139
  v_cvt_pk_bf16_f32 v230, v140, v141
  v_mfma_f32_16x16x32_bf16 v[84:87], a[8:11], v[164:167], 0
  s_waitcnt lgkmcnt(3)
  v_cvt_pk_bf16_f32 v231, v142, v143
  v_cvt_pk_bf16_f32 v236, v144, v145
  v_mfma_f32_16x16x32_bf16 v[88:91], a[0:3], v[168:171], 0
  ds_read_b128 v[184:187], v14 offset:12288
  v_cvt_pk_bf16_f32 v237, v146, v147
  v_mfma_f32_16x16x32_bf16 v[92:95], a[4:7], v[168:171], 0
  v_cvt_pk_bf16_f32 v232, v148, v149
  v_cvt_pk_bf16_f32 v233, v150, v151
  v_mfma_f32_16x16x32_bf16 v[96:99], a[8:11], v[168:171], 0
  s_waitcnt lgkmcnt(3)
  v_cvt_pk_bf16_f32 v234, v152, v153
  v_cvt_pk_bf16_f32 v235, v154, v155
  v_mfma_f32_16x16x32_bf16 v[100:103], a[0:3], v[172:175], 0
  ds_read_b128 v[188:191], v14 offset:14336
  v_cvt_pk_bf16_f32 v238, v156, v157
  v_mfma_f32_16x16x32_bf16 v[104:107], a[4:7], v[172:175], 0
  v_cvt_pk_bf16_f32 v239, v158, v159
  ds_write_b128 v20, v[192:195] offset:0
  v_mfma_f32_16x16x32_bf16 v[108:111], a[8:11], v[172:175], 0
  s_waitcnt lgkmcnt(4)
  v_mfma_f32_16x16x32_bf16 v[112:115], a[0:3], v[176:179], 0
  ds_read_b128 v[160:163], v15 offset:0
  s_waitcnt vmcnt(4)
  v_mfma_f32_16x16x32_bf16 v[116:119], a[4:7], v[176:179], 0
  s_add_u32 m0, s31, 49152
  v_cmp_gt_u32 vcc, s49, v32
  v_mfma_f32_16x16x32_bf16 v[120:123], a[8:11], v[176:179], 0
  s_waitcnt lgkmcnt(4)
  buffer_load_dwordx4 v10, s[8:11], s30 offen lds
  s_cbranch_vccnz qw_270
qj_271:
  v_mfma_f32_16x16x32_bf16 v[124:127], a[0:3], v[180:183], 0
  s_add_u32 s29, s50, 4096
  ds_read_b128 v[164:167], v15 offset:2048
  ds_write_b128 v20, v[196:199] offset:1024
  v_mfma_f32_16x16x32_bf16 v[128:131], a[4:7], v[180:183], 0
  v_mfma_f32_16x16x32_bf16 v[132:135], a[8:11], v[180:183], 0
  s_waitcnt lgkmcnt(5)
  buffer_load_dwordx4 a[240:243], v24, s[16:19], s29 offen offset:2560 sc1
  v_mfma_f32_16x16x32_bf16 v[136:139], a[0:3], v[184:187], 0
  ds_read_b128 v[168:171], v15 offset:4096
  v_mfma_f32_16x16x32_bf16 v[140:143], a[4:7], v[184:187], 0
  s_add_u32 m0, s31, 50176
  v_mfma_f32_16x16x32_bf16 v[144:147], a[8:11], v[184:187], 0
  s_waitcnt lgkmcnt(5)
  buffer_load_dwordx4 v11, s[8:11], s30 offen lds
  ds_write_b128 v20, v[200:203] offset:2048
  v_mfma_f32_16x16x32_bf16 v[148:151], a[0:3], v[188:191], 0
  ds_read_b128 v[172:175], v15 offset:6144
  v_mfma_f32_16x16x32_bf16 v[152:155], a[4:7], v[188:191], 0
  v_mfma_f32_16x16x32_bf16 v[156:159], a[8:11], v[188:191], 0
  s_waitcnt lgkmcnt(5)
  buffer_load_dwordx2 v[240:241], v25, s[16:19], s29 offen offset:3072 sc1
  s_add_u32 s29, s50, 20480
  v_mfma_f32_16x16x32_bf16 v[64:67], a[12:15], v[160:163], v[64:67]
  ds_read_b128 v[176:179], v15 offset:8192
  v_mfma_f32_16x16x32_bf16 v[68:71], a[16:19], v[160:163], v[68:71]
  s_add_u32 m0, s31, 51200
  ds_write_b128 v20, v[204:207] offset:12288
  v_mfma_f32_16x16x32_bf16 v[72:75], a[20:23], v[160:163], v[72:75]
  s_waitcnt lgkmcnt(6)
  buffer_load_dwordx4 v12, s[8:11], s30 offen lds
  v_mfma_f32_16x16x32_bf16 v[76:79], a[12:15], v[164:167], v[76:79]
  ds_read_b128 v[180:183], v15 offset:10240
  v_mfma_f32_16x16x32_bf16 v[80:83], a[16:19], v[164:167], v[80:83]
  v_mfma_f32_16x16x32_bf16 v[84:87], a[20:23], v[164:167], v[84:87]
  s_waitcnt lgkmcnt(5)
  buffer_load_dwordx4 a[244:247], v24, s[16:19], s29 offen offset:2560 sc1
  v_mfma_f32_16x16x32_bf16 v[88:91], a[12:15], v[168:171], v[88:91]
  ds_read_b128 v[184:187], v15 offset:12288
  ds_write_b128 v20, v[208:211] offset:13312
  v_mfma_f32_16x16x32_bf16 v[92:95], a[16:19], v[168:171], v[92:95]
  s_add_u32 m0, s31, 52224
  v_mfma_f32_16x16x32_bf16 v[96:99], a[20:23], v[168:171], v[96:99]
  s_waitcnt lgkmcnt(5)
  buffer_load_dwordx4 v13, s[8:11], s30 offen lds
  v_mfma_f32_16x16x32_bf16 v[100:103], a[12:15], v[172:175], v[100:103]
  s_add_u32 s30, s30, 128
  ds_read_b128 v[188:191], v15 offset:14336
  v_mfma_f32_16x16x32_bf16 v[104:107], a[16:19], v[172:175], v[104:107]
  v_mfma_f32_16x16x32_bf16 v[108:111], a[20:23], v[172:175], v[108:111]
  s_waitcnt lgkmcnt(5)
  ds_write_b128 v20, v[212:215] offset:14336
  v_mfma_f32_16x16x32_bf16 v[112:115], a[12:15], v[176:179], v[112:115]
  s_waitcnt vmcnt(11)
  s_barrier
  ds_read_b128 v[160:163], v14 offset:16384
  v_mfma_f32_16x16x32_bf16 v[116:119], a[16:19], v[176:179], v[116:119]
  s_waitcnt vmcnt(13)
  buffer_atomic_add v28, v33, s[72:75], s84 offen sc1
  v_mfma_f32_16x16x32_bf16 v[120:123], a[20:23], v[176:179], v[120:123]
  s_waitcnt lgkmcnt(5)
  v_mfma_f32_16x16x32_bf16 v[124:127], a[12:15], v[180:183], v[124:127]
  ds_read_b128 v[164:167], v14 offset:18432
  v_mfma_f32_16x16x32_bf16 v[128:131], a[16:19], v[180:183], v[128:131]
  ds_write_b128 v20, v[216:219] offset:24576
  buffer_load_dwordx2 v[242:243], v25, s[16:19], s29 offen offset:3072 sc1
  v_mfma_f32_16x16x32_bf16 v[132:135], a[20:23], v[180:183], v[132:135]
  s_add_u32 s29, s50, 36864
  s_waitcnt lgkmcnt(6)
  v_mfma_f32_16x16x32_bf16 v[136:139], a[12:15], v[184:187], v[136:139]
  ds_read_b128 v[168:171], v14 offset:20480
  v_mfma_f32_16x16x32_bf16 v[140:143], a[16:19], v[184:187], v[140:143]
  buffer_load_dwordx4 a[248:251], v24, s[16:19], s29 offen offset:2560 sc1
  v_mfma_f32_16x16x32_bf16 v[144:147], a[20:23], v[184:187], v[144:147]
  s_waitcnt lgkmcnt(5)
  v_mfma_f32_16x16x32_bf16 v[148:151], a[12:15], v[188:191], v[148:151]
  ds_read_b128 v[172:175], v14 offset:22528
  ds_write_b128 v20, v[220:223] offset:25600
  v_mfma_f32_16x16x32_bf16 v[152:155], a[16:19], v[188:191], v[152:155]
  buffer_load_dwordx2 v[244:245], v25, s[16:19], s29 offen offset:3072 sc1
  s_add_u32 s29, s50, 53248
  v_mfma_f32_16x16x32_bf16 v[156:159], a[20:23], v[188:191], v[156:159]
  s_waitcnt lgkmcnt(5)
  v_mfma_f32_16x16x32_bf16 v[64:67], a[24:27], v[160:163], v[64:67]
  ds_read_b128 v[176:179], v14 offset:24576
  v_mfma_f32_16x16x32_bf16 v[68:71], a[28:31], v[160:163], v[68:71]
  s_add_u32 m0, s31, 65536
  v_mfma_f32_16x16x32_bf16 v[72:75], a[32:35], v[160:163], v[72:75]
  s_waitcnt lgkmcnt(5)
  buffer_load_dwordx4 v10, s[8:11], s30 offen lds
  ds_write_b128 v20, v[224:227] offset:26624
  v_mfma_f32_16x16x32_bf16 v[76:79], a[24:27], v[164:167], v[76:79]
  ds_read_b128 v[180:183], v14 offset:26624
  v_mfma_f32_16x16x32_bf16 v[80:83], a[28:31], v[164:167], v[80:83]
  v_mfma_f32_16x16x32_bf16 v[84:87], a[32:35], v[164:167], v[84:87]
  s_waitcnt lgkmcnt(5)
  buffer_load_dwordx4 a[252:255], v24, s[16:19], s29 offen offset:2560 sc1
  v_mfma_f32_16x16x32_bf16 v[88:91], a[24:27], v[168:171], v[88:91]
  ds_read_b128 v[184:187], v14 offset:28672
  v_mfma_f32_16x16x32_bf16 v[92:95], a[28:31], v[168:171], v[92:95]
  ds_write_b128 v20, v[228:231] offset:36864
  v_mfma_f32_16x16x32_bf16 v[96:99], a[32:35], v[168:171], v[96:99]
  s_waitcnt lgkmcnt(6)
  buffer_load_dwordx2 v[246:247], v25, s[16:19], s29 offen offset:3072 sc1
  v_mfma_f32_16x16x32_bf16 v[100:103], a[24:27], v[172:175], v[100:103]
  ds_read_b128 v[188:191], v14 offset:30720
  v_mfma_f32_16x16x32_bf16 v[104:107], a[28:31], v[172:175], v[104:107]
  s_add_u32 m0, s31, 66560
  v_mfma_f32_16x16x32_bf16 v[108:111], a[32:35], v[172:175], v[108:111]
  s_waitcnt lgkmcnt(5)
  buffer_load_dwordx4 v11, s[8:11], s30 offen lds
  v_mfma_f32_16x16x32_bf16 v[112:115], a[24:27], v[176:179], v[112:115]
  ds_read_b128 v[160:163], v15 offset:16384
  ds_write_b128 v20, v[232:235] offset:37888
  v_mfma_f32_16x16x32_bf16 v[116:119], a[28:31], v[176:179], v[116:119]
  v_mfma_f32_16x16x32_bf16 v[120:123], a[32:35], v[176:179], v[120:123]
  s_waitcnt lgkmcnt(5)
  v_mfma_f32_16x16x32_bf16 v[124:127], a[24:27], v[180:183], v[124:127]
  ds_read_b128 v[164:167], v15 offset:18432
  v_mfma_f32_16x16x32_bf16 v[128:131], a[28:31], v[180:183], v[128:131]
  v_mfma_f32_16x16x32_bf16 v[132:135], a[32:35], v[180:183], v[132:135]
  s_waitcnt lgkmcnt(5)
  ds_write_b128 v20, v[236:239] offset:38912
  v_mfma_f32_16x16x32_bf16 v[136:139], a[24:27], v[184:187], v[136:139]
  ds_read_b128 v[168:171], v15 offset:20480
  v_mfma_f32_16x16x32_bf16 v[140:143], a[28:31], v[184:187], v[140:143]
  s_add_u32 m0, s31, 67584
  s_cmp_eq_u32 s26, s89
  s_cselect_b32 s25, s90, 162688
  v_mfma_f32_16x16x32_bf16 v[144:147], a[32:35], v[184:187], v[144:147]
  s_sub_u32 s21, s26, 2
  s_waitcnt lgkmcnt(5)
  buffer_load_dwordx4 v12, s[8:11], s30 offen lds
  v_mfma_f32_16x16x32_bf16 v[148:151], a[24:27], v[188:191], v[148:151]
  ds_read_b128 v[172:175], v15 offset:22528
  v_mfma_f32_16x16x32_bf16 v[152:155], a[28:31], v[188:191], v[152:155]
  s_cmp_lt_u32 s21, s91
  s_cbranch_scc1 qs_267
qs_268:
  s_waitcnt lgkmcnt(2)
  v_mfma_f32_16x16x32_bf16 v[156:159], a[32:35], v[188:191], v[156:159]
  s_add_u32 s29, s50, 0
  s_waitcnt lgkmcnt(5)
  buffer_load_dwordx4 v[192:195], v26, s[16:19], s29 offen offset:0 sc1
  v_mfma_f32_16x16x32_bf16 v[64:67], a[36:39], v[160:163], v[64:67]
  ds_read_b128 v[176:179], v15 offset:24576
  v_mfma_f32_16x16x32_bf16 v[68:71], a[40:43], v[160:163], v[68:71]
  v_mfma_f32_16x16x32_bf16 v[72:75], a[44:47], v[160:163], v[72:75]
  s_waitcnt lgkmcnt(4)
  buffer_load_dwordx4 v[196:199], v26, s[16:19], s29 offen offset:1024 sc1
  v_mfma_f32_16x16x32_bf16 v[76:79], a[36:39], v[164:167], v[76:79]
  ds_read_b128 v[180:183], v15 offset:26624
  v_mfma_f32_16x16x32_bf16 v[80:83], a[40:43], v[164:167], v[80:83]
  s_add_u32 m0, s31, 68608
  v_mfma_f32_16x16x32_bf16 v[84:87], a[44:47], v[164:167], v[84:87]
  s_waitcnt lgkmcnt(3)
  buffer_load_dwordx4 v13, s[8:11], s30 offen lds
  v_mfma_f32_16x16x32_bf16 v[88:91], a[36:39], v[168:171], v[88:91]
  s_add_u32 s30, s30, 128
  ds_read_b128 v[184:187], v15 offset:28672
  v_mfma_f32_16x16x32_bf16 v[92:95], a[40:43], v[168:171], v[92:95]
  v_mfma_f32_16x16x32_bf16 v[96:99], a[44:47], v[168:171], v[96:99]
  s_waitcnt lgkmcnt(3)
  buffer_load_dwordx4 v[224:227], v26, s[16:19], s29 offen offset:2048 sc1
  s_add_u32 s29, s50, 16384
  v_mfma_f32_16x16x32_bf16 v[100:103], a[36:39], v[172:175], v[100:103]
  ds_read_b128 v[188:191], v15 offset:30720
  v_mfma_f32_16x16x32_bf16 v[104:107], a[40:43], v[172:175], v[104:107]
  v_mfma_f32_16x16x32_bf16 v[108:111], a[44:47], v[172:175], v[108:111]
  s_waitcnt lgkmcnt(3)
  buffer_load_dwordx4 v[200:203], v26, s[16:19], s29 offen offset:0 sc1
  v_mfma_f32_16x16x32_bf16 v[112:115], a[36:39], v[176:179], v[112:115]
  s_waitcnt vmcnt(21)
  s_barrier
  ds_read_b128 v[160:163], v14 offset:32768
  v_mfma_f32_16x16x32_bf16 v[116:119], a[40:43], v[176:179], v[116:119]
  v_mfma_f32_16x16x32_bf16 v[120:123], a[44:47], v[176:179], v[120:123]
  s_waitcnt lgkmcnt(3)
  buffer_load_dwordx4 v[204:207], v26, s[16:19], s29 offen offset:1024 sc1
  v_mfma_f32_16x16x32_bf16 v[124:127], a[36:39], v[180:183], v[124:127]
  ds_read_b128 v[164:167], v14 offset:34816
  v_mfma_f32_16x16x32_bf16 v[128:131], a[40:43], v[180:183], v[128:131]
  v_mfma_f32_16x16x32_bf16 v[132:135], a[44:47], v[180:183], v[132:135]
  s_waitcnt lgkmcnt(3)
  buffer_load_dwordx4 v[228:231], v26, s[16:19], s29 offen offset:2048 sc1
  s_add_u32 s29, s50, 32768
  v_mfma_f32_16x16x32_bf16 v[136:139], a[36:39], v[184:187], v[136:139]
  ds_read_b128 v[168:171], v14 offset:36864
  v_mfma_f32_16x16x32_bf16 v[140:143], a[40:43], v[184:187], v[140:143]
  v_mfma_f32_16x16x32_bf16 v[144:147], a[44:47], v[184:187], v[144:147]
  s_waitcnt lgkmcnt(3)
  buffer_load_dwordx4 v[208:211], v26, s[16:19], s29 offen offset:0 sc1
  v_mfma_f32_16x16x32_bf16 v[148:151], a[36:39], v[188:191], v[148:151]
  ds_read_b128 v[172:175], v14 offset:38912
  v_mfma_f32_16x16x32_bf16 v[152:155], a[40:43], v[188:191], v[152:155]
  v_mfma_f32_16x16x32_bf16 v[156:159], a[44:47], v[188:191], v[156:159]
  s_waitcnt lgkmcnt(3)
  buffer_load_dwordx4 v[212:215], v26, s[16:19], s29 offen offset:1024 sc1
  v_mfma_f32_16x16x32_bf16 v[64:67], a[48:51], v[160:163], v[64:67]
  ds_read_b128 v[176:179], v14 offset:40960
  v_mfma_f32_16x16x32_bf16 v[68:71], a[52:55], v[160:163], v[68:71]
  s_add_u32 m0, s31, 0
  v_mfma_f32_16x16x32_bf16 v[72:75], a[56:59], v[160:163], v[72:75]
  s_waitcnt lgkmcnt(3)
  buffer_load_dwordx4 v10, s[8:11], s30 offen lds
  v_mfma_f32_16x16x32_bf16 v[76:79], a[48:51], v[164:167], v[76:79]
  ds_read_b128 v[180:183], v14 offset:43008
  v_mfma_f32_16x16x32_bf16 v[80:83], a[52:55], v[164:167], v[80:83]
  v_mfma_f32_16x16x32_bf16 v[84:87], a[56:59], v[164:167], v[84:87]
  s_waitcnt lgkmcnt(3)
  buffer_load_dwordx4 v[232:235], v26, s[16:19], s29 offen offset:2048 sc1
  s_add_u32 s29, s50, 49152
  v_mfma_f32_16x16x32_bf16 v[88:91], a[48:51], v[168:171], v[88:91]
  ds_read_b128 v[184:187], v14 offset:45056
  v_mfma_f32_16x16x32_bf16 v[92:95], a[52:55], v[168:171], v[92:95]
  v_mfma_f32_16x16x32_bf16 v[96:99], a[56:59], v[168:171], v[96:99]
  s_waitcnt lgkmcnt(3)
  buffer_load_dwordx4 v[216:219], v26, s[16:19], s29 offen offset:0 sc1
  v_mfma_f32_16x16x32_bf16 v[100:103], a[48:51], v[172:175], v[100:103]
  ds_read_b128 v[188:191], v14 offset:47104
  v_mfma_f32_16x16x32_bf16 v[104:107], a[52:55], v[172:175], v[104:107]
  s_add_u32 m0, s31, 1024
  v_mfma_f32_16x16x32_bf16 v[108:111], a[56:59], v[172:175], v[108:111]
  s_waitcnt lgkmcnt(3)
  buffer_load_dwordx4 v11, s[8:11], s30 offen lds
  v_mfma_f32_16x16x32_bf16 v[112:115], a[48:51], v[176:179], v[112:115]
  ds_read_b128 v[160:163], v15 offset:32768
  v_mfma_f32_16x16x32_bf16 v[116:119], a[52:55], v[176:179], v[116:119]
  v_mfma_f32_16x16x32_bf16 v[120:123], a[56:59], v[176:179], v[120:123]
  s_waitcnt lgkmcnt(3)
  buffer_load_dwordx4 v[220:223], v26, s[16:19], s29 offen offset:1024 sc1
  v_mfma_f32_16x16x32_bf16 v[124:127], a[48:51], v[180:183], v[124:127]
  ds_read_b128 v[164:167], v15 offset:34816
  v_mfma_f32_16x16x32_bf16 v[128:131], a[52:55], v[180:183], v[128:131]
  v_mfma_f32_16x16x32_bf16 v[132:135], a[56:59], v[180:183], v[132:135]
  s_waitcnt lgkmcnt(3)
  buffer_load_dwordx4 v[236:239], v26, s[16:19], s29 offen offset:2048 sc1
  v_mfma_f32_16x16x32_bf16 v[136:139], a[48:51], v[184:187], v[136:139]
  ds_read_b128 v[168:171], v15 offset:36864
  v_mfma_f32_16x16x32_bf16 v[140:143], a[52:55], v[184:187], v[140:143]
  s_add_u32 m0, s31, 2048
  v_mfma_f32_16x16x32_bf16 v[144:147], a[56:59], v[184:187], v[144:147]
  s_waitcnt lgkmcnt(3)
  buffer_load_dwordx4 v12, s[8:11], s30 offen lds
  v_mfma_f32_16x16x32_bf16 v[148:151], a[48:51], v[188:191], v[148:151]
  ds_read_b128 v[172:175], v15 offset:38912
  v_mfma_f32_16x16x32_bf16 v[152:155], a[52:55], v[188:191], v[152:155]
  v_mfma_f32_16x16x32_bf16 v[156:159], a[56:59], v[188:191], v[156:159]
  s_waitcnt lgkmcnt(3)
  v_mfma_f32_16x16x32_bf16 v[64:67], a[60:63], v[160:163], v[64:67]
  ds_read_b128 v[176:179], v15 offset:40960
  v_mfma_f32_16x16x32_bf16 v[68:71], a[64:67], v[160:163], v[68:71]
  v_mfma_f32_16x16x32_bf16 v[72:75], a[68:71], v[160:163], v[72:75]
  s_waitcnt lgkmcnt(3)
  v_mfma_f32_16x16x32_bf16 v[76:79], a[60:63], v[164:167], v[76:79]
  ds_read_b128 v[180:183], v15 offset:43008
  v_mfma_f32_16x16x32_bf16 v[80:83], a[64:67], v[164:167], v[80:83]
  s_add_u32 m0, s31, 3072
  v_mfma_f32_16x16x32_bf16 v[84:87], a[68:71], v[164:167], v[84:87]
  s_waitcnt lgkmcnt(3)
  buffer_load_dwordx4 v13, s[8:11], s30 offen lds
  v_mfma_f32_16x16x32_bf16 v[88:91], a[60:63], v[168:171], v[88:91]
  s_add_u32 s30, s30, 128
  ds_read_b128 v[184:187], v15 offset:45056
  v_mfma_f32_16x16x32_bf16 v[92:95], a[64:67], v[168:171], v[92:95]
  v_mfma_f32_16x16x32_bf16 v[96:99], a[68:71], v[168:171], v[96:99]
  s_waitcnt lgkmcnt(3)
  v_mfma_f32_16x16x32_bf16 v[100:103], a[60:63], v[172:175], v[100:103]
  ds_read_b128 v[188:191], v15 offset:47104
  v_mfma_f32_16x16x32_bf16 v[104:107], a[64:67], v[172:175], v[104:107]
  v_mfma_f32_16x16x32_bf16 v[108:111], a[68:71], v[172:175], v[108:111]
  s_waitcnt lgkmcnt(3)
  v_mfma_f32_16x16x32_bf16 v[112:115], a[60:63], v[176:179], v[112:115]
  s_waitcnt vmcnt(26)
  s_barrier
  ds_read_b128 v[160:163], v14 offset:49152
  v_mfma_f32_16x16x32_bf16 v[116:119], a[64:67], v[176:179], v[116:119]
  v_mfma_f32_16x16x32_bf16 v[120:123], a[68:71], v[176:179], v[120:123]
  s_waitcnt lgkmcnt(3)
  v_mfma_f32_16x16x32_bf16 v[124:127], a[60:63], v[180:183], v[124:127]
  ds_read_b128 v[164:167], v14 offset:51200
  v_mfma_f32_16x16x32_bf16 v[128:131], a[64:67], v[180:183], v[128:131]
  v_mfma_f32_16x16x32_bf16 v[132:135], a[68:71], v[180:183], v[132:135]
  s_waitcnt lgkmcnt(3)
  v_mfma_f32_16x16x32_bf16 v[136:139], a[60:63], v[184:187], v[136:139]
  ds_read_b128 v[168:171], v14 offset:53248
  v_mfma_f32_16x16x32_bf16 v[140:143], a[64:67], v[184:187], v[140:143]
  v_mfma_f32_16x16x32_bf16 v[144:147], a[68:71], v[184:187], v[144:147]
  s_waitcnt lgkmcnt(3)
  v_mfma_f32_16x16x32_bf16 v[148:151], a[60:63], v[188:191], v[148:151]
  ds_read_b128 v[172:175], v14 offset:55296
  v_mfma_f32_16x16x32_bf16 v[152:155], a[64:67], v[188:191], v[152:155]
  v_mfma_f32_16x16x32_bf16 v[156:159], a[68:71], v[188:191], v[156:159]
  s_waitcnt lgkmcnt(3)
  v_mfma_f32_16x16x32_bf16 v[64:67], a[72:75], v[160:163], v[64:67]
  ds_read_b128 v[176:179], v14 offset:57344
  v_mfma_f32_16x16x32_bf16 v[68:71], a[76:79], v[160:163], v[68:71]
  s_add_u32 m0, s31, 16384
  v_mfma_f32_16x16x32_bf16 v[72:75], a[80:83], v[160:163], v[72:75]
  s_waitcnt lgkmcnt(3)
  buffer_load_dwordx4 v10, s[8:11], s30 offen lds
  v_mfma_f32_16x16x32_bf16 v[76:79], a[72:75], v[164:167], v[76:79]
  ds_read_b128 v[180:183], v14 offset:59392
  v_mfma_f32_16x16x32_bf16 v[80:83], a[76:79], v[164:167], v[80:83]
  v_mfma_f32_16x16x32_bf16 v[84:87], a[80:83], v[164:167], v[84:87]
  s_waitcnt lgkmcnt(3)
  v_mfma_f32_16x16x32_bf16 v[88:91], a[72:75], v[168:171], v[88:91]
  ds_read_b128 v[184:187], v14 offset:61440
  v_mfma_f32_16x16x32_bf16 v[92:95], a[76:79], v[168:171], v[92:95]
  v_mfma_f32_16x16x32_bf16 v[96:99], a[80:83], v[168:171], v[96:99]
  s_waitcnt lgkmcnt(3)
  v_mfma_f32_16x16x32_bf16 v[100:103], a[72:75], v[172:175], v[100:103]
  ds_read_b128 v[188:191], v14 offset:63488
  v_mfma_f32_16x16x32_bf16 v[104:107], a[76:79], v[172:175], v[104:107]
  s_add_u32 m0, s31, 17408
  v_mfma_f32_16x16x32_bf16 v[108:111], a[80:83], v[172:175], v[108:111]
  s_waitcnt lgkmcnt(3)
  buffer_load_dwordx4 v11, s[8:11], s30 offen lds
  v_mfma_f32_16x16x32_bf16 v[112:115], a[72:75], v[176:179], v[112:115]
  ds_read_b128 v[160:163], v15 offset:49152
  v_mfma_f32_16x16x32_bf16 v[116:119], a[76:79], v[176:179], v[116:119]
  v_mfma_f32_16x16x32_bf16 v[120:123], a[80:83], v[176:179], v[120:123]
  s_waitcnt lgkmcnt(3)
  v_mfma_f32_16x16x32_bf16 v[124:127], a[72:75], v[180:183], v[124:127]
  ds_read_b128 v[164:167], v15 offset:51200
  v_mfma_f32_16x16x32_bf16 v[128:131], a[76:79], v[180:183], v[128:131]
  v_mfma_f32_16x16x32_bf16 v[132:135], a[80:83], v[180:183], v[132:135]
  s_waitcnt lgkmcnt(3)
  v_mfma_f32_16x16x32_bf16 v[136:139], a[72:75], v[184:187], v[136:139]
  ds_read_b128 v[168:171], v15 offset:53248
  v_mfma_f32_16x16x32_bf16 v[140:143], a[76:79], v[184:187], v[140:143]
  s_add_u32 m0, s31, 18432
  v_mfma_f32_16x16x32_bf16 v[144:147], a[80:83], v[184:187], v[144:147]
  s_waitcnt lgkmcnt(3)
  buffer_load_dwordx4 v12, s[8:11], s30 offen lds
  v_mfma_f32_16x16x32_bf16 v[148:151], a[72:75], v[188:191], v[148:151]
  ds_read_b128 v[172:175], v15 offset:55296
  v_mfma_f32_16x16x32_bf16 v[152:155], a[76:79], v[188:191], v[152:155]
  v_mfma_f32_16x16x32_bf16 v[156:159], a[80:83], v[188:191], v[156:159]
  s_waitcnt lgkmcnt(3)
  v_mfma_f32_16x16x32_bf16 v[64:67], a[84:87], v[160:163], v[64:67]
  ds_read_b128 v[176:179], v15 offset:57344
  v_mfma_f32_16x16x32_bf16 v[68:71], a[88:91], v[160:163], v[68:71]
  v_mfma_f32_16x16x32_bf16 v[72:75], a[92:95], v[160:163], v[72:75]
  s_waitcnt lgkmcnt(3)
  v_mfma_f32_16x16x32_bf16 v[76:79], a[84:87], v[164:167], v[76:79]
  ds_read_b128 v[180:183], v15 offset:59392
  v_mfma_f32_16x16x32_bf16 v[80:83], a[88:91], v[164:167], v[80:83]
  s_add_u32 m0, s31, 19456
  v_mfma_f32_16x16x32_bf16 v[84:87], a[92:95], v[164:167], v[84:87]
  s_waitcnt lgkmcnt(3)
  buffer_load_dwordx4 v13, s[8:11], s30 offen lds
  v_mfma_f32_16x16x32_bf16 v[88:91], a[84:87], v[168:171], v[88:91]
  s_add_u32 s30, s30, 128
  ds_read_b128 v[184:187], v15 offset:61440
  v_mfma_f32_16x16x32_bf16 v[92:95], a[88:91], v[168:171], v[92:95]
  v_mfma_f32_16x16x32_bf16 v[96:99], a[92:95], v[168:171], v[96:99]
  s_waitcnt lgkmcnt(3)
  v_mfma_f32_16x16x32_bf16 v[100:103], a[84:87], v[172:175], v[100:103]
  ds_read_b128 v[188:191], v15 offset:63488
  v_mfma_f32_16x16x32_bf16 v[104:107], a[88:91], v[172:175], v[104:107]
  v_mfma_f32_16x16x32_bf16 v[108:111], a[92:95], v[172:175], v[108:111]
  s_waitcnt lgkmcnt(3)
  v_mfma_f32_16x16x32_bf16 v[112:115], a[84:87], v[176:179], v[112:115]
  s_waitcnt vmcnt(18)
  s_barrier
  ds_read_b128 v[160:163], v16 offset:0
  v_mfma_f32_16x16x32_bf16 v[116:119], a[88:91], v[176:179], v[116:119]
  v_mfma_f32_16x16x32_bf16 v[120:123], a[92:95], v[176:179], v[120:123]
  s_waitcnt lgkmcnt(3)
  v_mfma_f32_16x16x32_bf16 v[124:127], a[84:87], v[180:183], v[124:127]
  ds_read_b128 v[164:167], v16 offset:2048
  v_mfma_f32_16x16x32_bf16 v[128:131], a[88:91], v[180:183], v[128:131]
  v_mfma_f32_16x16x32_bf16 v[132:135], a[92:95], v[180:183], v[132:135]
  s_waitcnt lgkmcnt(3)
  v_mfma_f32_16x16x32_bf16 v[136:139], a[84:87], v[184:187], v[136:139]
  ds_read_b128 v[168:171], v16 offset:4096
  v_mfma_f32_16x16x32_bf16 v[140:143], a[88:91], v[184:187], v[140:143]
  v_mfma_f32_16x16x32_bf16 v[144:147], a[92:95], v[184:187], v[144:147]
  s_waitcnt lgkmcnt(3)
  v_mfma_f32_16x16x32_bf16 v[148:151], a[84:87], v[188:191], v[148:151]
  ds_read_b128 v[172:175], v16 offset:6144
  v_mfma_f32_16x16x32_bf16 v[152:155], a[88:91], v[188:191], v[152:155]
  v_mfma_f32_16x16x32_bf16 v[156:159], a[92:95], v[188:191], v[156:159]
  s_waitcnt lgkmcnt(3)
  v_mfma_f32_16x16x32_bf16 v[64:67], a[96:99], v[160:163], v[64:67]
  ds_read_b128 v[176:179], v16 offset:8192
  v_mfma_f32_16x16x32_bf16 v[68:71], a[100:103], v[160:163], v[68:71]
  s_add_u32 m0, s31, 32768
  v_mfma_f32_16x16x32_bf16 v[72:75], a[104:107], v[160:163], v[72:75]
  s_waitcnt lgkmcnt(3)
  buffer_load_dwordx4 v10, s[8:11], s30 offen lds
  v_mfma_f32_16x16x32_bf16 v[76:79], a[96:99], v[164:167], v[76:79]
  ds_read_b128 v[180:183], v16 offset:10240
  v_mfma_f32_16x16x32_bf16 v[80:83], a[100:103], v[164:167], v[80:83]
  v_mfma_f32_16x16x32_bf16 v[84:87], a[104:107], v[164:167], v[84:87]
  s_waitcnt lgkmcnt(3)
  v_mfma_f32_16x16x32_bf16 v[88:91], a[96:99], v[168:171], v[88:91]
  ds_read_b128 v[184:187], v16 offset:12288
  v_mfma_f32_16x16x32_bf16 v[92:95], a[100:103], v[168:171], v[92:95]
  v_mfma_f32_16x16x32_bf16 v[96:99], a[104:107], v[168:171], v[96:99]
  s_waitcnt lgkmcnt(3)
  v_mfma_f32_16x16x32_bf16 v[100:103], a[96:99], v[172:175], v[100:103]
  ds_read_b128 v[188:191], v16 offset:14336
  v_mfma_f32_16x16x32_bf16 v[104:107], a[100:103], v[172:175], v[104:107]
  s_add_u32 m0, s31, 33792
  v_mfma_f32_16x16x32_bf16 v[108:111], a[104:107], v[172:175], v[108:111]
  s_waitcnt lgkmcnt(3)
  buffer_load_dwordx4 v11, s[8:11], s30 offen lds
  v_mfma_f32_16x16x32_bf16 v[112:115], a[96:99], v[176:179], v[112:115]
  ds_read_b128 v[160:163], v17 offset:0
  v_mfma_f32_16x16x32_bf16 v[116:119], a[100:103], v[176:179], v[116:119]
  v_mfma_f32_16x16x32_bf16 v[120:123], a[104:107], v[176:179], v[120:123]
  s_waitcnt lgkmcnt(3)
  v_mfma_f32_16x16x32_bf16 v[124:127], a[96:99], v[180:183], v[124:127]
  ds_read_b128 v[164:167], v17 offset:2048
  v_mfma_f32_16x16x32_bf16 v[128:131], a[100:103], v[180:183], v[128:131]
  v_mfma_f32_16x16x32_bf16 v[132:135], a[104:107], v[180:183], v[132:135]
  s_waitcnt lgkmcnt(3)
  v_mfma_f32_16x16x32_bf16 v[136:139], a[96:99], v[184:187], v[136:139]
  ds_read_b128 v[168:171], v17 offset:4096
  v_mfma_f32_16x16x32_bf16 v[140:143], a[100:103], v[184:187], v[140:143]
  s_add_u32 m0, s31, 34816
  v_mfma_f32_16x16x32_bf16 v[144:147], a[104:107], v[184:187], v[144:147]
  s_waitcnt lgkmcnt(3)
  buffer_load_dwordx4 v12, s[8:11], s30 offen lds
  v_mfma_f32_16x16x32_bf16 v[148:151], a[96:99], v[188:191], v[148:151]
  ds_read_b128 v[172:175], v17 offset:6144
  v_mfma_f32_16x16x32_bf16 v[152:155], a[100:103], v[188:191], v[152:155]
  v_mfma_f32_16x16x32_bf16 v[156:159], a[104:107], v[188:191], v[156:159]
  s_waitcnt lgkmcnt(3)
  v_mfma_f32_16x16x32_bf16 v[64:67], a[108:111], v[160:163], v[64:67]
  ds_read_b128 v[176:179], v17 offset:8192
  v_mfma_f32_16x16x32_bf16 v[68:71], a[112:115], v[160:163], v[68:71]
  v_mfma_f32_16x16x32_bf16 v[72:75], a[116:119], v[160:163], v[72:75]
  s_waitcnt lgkmcnt(3)
  v_mfma_f32_16x16x32_bf16 v[76:79], a[108:111], v[164:167], v[76:79]
  ds_read_b128 v[180:183], v17 offset:10240
  v_mfma_f32_16x16x32_bf16 v[80:83], a[112:115], v[164:167], v[80:83]
  s_add_u32 m0, s31, 35840
  v_mfma_f32_16x16x32_bf16 v[84:87], a[116:119], v[164:167], v[84:87]
  s_waitcnt lgkmcnt(3)
  buffer_load_dwordx4 v13, s[8:11], s30 offen lds
  v_mfma_f32_16x16x32_bf16 v[88:91], a[108:111], v[168:171], v[88:91]
  s_add_u32 s30, s30, 128
  ds_read_b128 v[184:187], v17 offset:12288
  v_mfma_f32_16x16x32_bf16 v[92:95], a[112:115], v[168:171], v[92:95]
  v_mfma_f32_16x16x32_bf16 v[96:99], a[116:119], v[168:171], v[96:99]
  s_waitcnt lgkmcnt(3)
  v_mfma_f32_16x16x32_bf16 v[100:103], a[108:111], v[172:175], v[100:103]
  ds_read_b128 v[188:191], v17 offset:14336
  v_mfma_f32_16x16x32_bf16 v[104:107], a[112:115], v[172:175], v[104:107]
  v_mfma_f32_16x16x32_bf16 v[108:111], a[116:119], v[172:175], v[108:111]
  s_waitcnt lgkmcnt(3)
  v_mfma_f32_16x16x32_bf16 v[112:115], a[108:111], v[176:179], v[112:115]
  s_waitcnt vmcnt(8)
  s_barrier
  ds_read_b128 v[160:163], v14 offset:0
  v_mfma_f32_16x16x32_bf16 v[116:119], a[112:115], v[176:179], v[116:119]
  v_mfma_f32_16x16x32_bf16 v[120:123], a[116:119], v[176:179], v[120:123]
  s_waitcnt lgkmcnt(3)
  v_mfma_f32_16x16x32_bf16 v[124:127], a[108:111], v[180:183], v[124:127]
  ds_read_b128 v[164:167], v14 offset:2048
  v_mfma_f32_16x16x32_bf16 v[128:131], a[112:115], v[180:183], v[128:131]
  v_mfma_f32_16x16x32_bf16 v[132:135], a[116:119], v[180:183], v[132:135]
  s_waitcnt lgkmcnt(3)
  v_mfma_f32_16x16x32_bf16 v[136:139], a[108:111], v[184:187], v[136:139]
  ds_read_b128 v[168:171], v14 offset:4096
  v_mfma_f32_16x16x32_bf16 v[140:143], a[112:115], v[184:187], v[140:143]
  v_mfma_f32_16x16x32_bf16 v[144:147], a[116:119], v[184:187], v[144:147]
  s_waitcnt lgkmcnt(3)
  v_mfma_f32_16x16x32_bf16 v[148:151], a[108:111], v[188:191], v[148:151]
  ds_read_b128 v[172:175], v14 offset:6144
  v_mfma_f32_16x16x32_bf16 v[152:155], a[112:115], v[188:191], v[152:155]
  v_mfma_f32_16x16x32_bf16 v[156:159], a[116:119], v[188:191], v[156:159]
  s_waitcnt lgkmcnt(3)
  v_mfma_f32_16x16x32_bf16 v[64:67], a[120:123], v[160:163], v[64:67]
  ds_read_b128 v[176:179], v14 offset:8192
  v_mfma_f32_16x16x32_bf16 v[68:71], a[124:127], v[160:163], v[68:71]
  s_add_u32 m0, s31, 49152
  v_mfma_f32_16x16x32_bf16 v[72:75], a[128:131], v[160:163], v[72:75]
  s_waitcnt lgkmcnt(3)
  buffer_load_dwordx4 v10, s[8:11], s30 offen lds
  v_mfma_f32_16x16x32_bf16 v[76:79], a[120:123], v[164:167], v[76:79]
  ds_read_b128 v[180:183], v14 offset:10240
  s_waitcnt vmcnt(11)
  v_mfma_f32_16x16x32_bf16 v[80:83], a[124:127], v[164:167], v[80:83]
  v_swap_b32 v226, v228
  v_swap_b32 v227, v229
  v_mfma_f32_16x16x32_bf16 v[84:87], a[128:131], v[164:167], v[84:87]
  s_waitcnt lgkmcnt(3)
  v_swap_b32 v234, v236
  v_swap_b32 v235, v237
  v_mfma_f32_16x16x32_bf16 v[88:91], a[120:123], v[168:171], v[88:91]
  ds_read_b128 v[184:187], v14 offset:12288
  v_mfma_f32_16x16x32_bf16 v[92:95], a[124:127], v[168:171], v[92:95]
  ds_read_b128 v[56:59], v21 offset:0
  ds_read_b128 v[60:63], v21 offset:1024
  v_mfma_f32_16x16x32_bf16 v[96:99], a[128:131], v[168:171], v[96:99]
  s_waitcnt lgkmcnt(5)
  v_mfma_f32_16x16x32_bf16 v[100:103], a[120:123], v[172:175], v[100:103]
  ds_read_b128 v[188:191], v14 offset:14336
  v_mfma_f32_16x16x32_bf16 v[104:107], a[124:127], v[172:175], v[104:107]
  s_add_u32 m0, s31, 50176
  v_mfma_f32_16x16x32_bf16 v[108:111], a[128:131], v[172:175], v[108:111]
  s_waitcnt lgkmcnt(5)
  buffer_load_dwordx4 v11, s[8:11], s30 offen lds
  v_mfma_f32_16x16x32_bf16 v[112:115], a[120:123], v[176:179], v[112:115]
  ds_read_b128 v[160:163], v15 offset:0
  v_mfma_f32_16x16x32_bf16 v[116:119], a[124:127], v[176:179], v[116:119]
  ds_read_b128 v[248:251], v21 offset:3072
  ds_read_b128 v[252:255], v21 offset:4096
  v_mfma_f32_16x16x32_bf16 v[120:123], a[128:131], v[176:179], v[120:123]
  s_waitcnt lgkmcnt(4)
  v_mfma_f32_16x16x32_bf16 v[36:39], v[192:195], v[56:59], 0
  v_mfma_f32_16x16x32_bf16 v[44:47], v[192:195], v[60:63], 0
  v_mfma_f32_16x16x32_bf16 v[48:51], v[196:199], v[60:63], 0
  v_mfma_f32_16x16x32_bf16 v[40:43], a[240:243], v[56:59], 0
  v_mfma_f32_16x16x32_bf16 v[52:55], a[240:243], v[60:63], 0
  s_waitcnt lgkmcnt(7)
  ds_read2st64_b64 v[56:59], v22 offset0:0 offset1:6
  ds_read2st64_b64 v[60:63], v23 offset0:0 offset1:6
  v_mfma_f32_16x16x32_bf16 v[124:127], a[120:123], v[180:183], v[124:127]
  ds_read_b128 v[164:167], v15 offset:2048
  v_mfma_f32_16x16x32_bf16 v[128:131], a[124:127], v[180:183], v[128:131]
  v_mfma_f32_16x16x32_bf16 v[132:135], a[128:131], v[180:183], v[132:135]
  s_waitcnt lgkmcnt(9)
  v_mfma_f32_16x16x32_bf16 v[136:139], a[120:123], v[184:187], v[136:139]
  ds_read_b128 v[168:171], v15 offset:4096
  v_mfma_f32_16x16x32_bf16 v[140:143], a[124:127], v[184:187], v[140:143]
  s_add_u32 m0, s31, 51200
  v_mfma_f32_16x16x32_bf16 v[144:147], a[128:131], v[184:187], v[144:147]
  s_waitcnt lgkmcnt(4)
  buffer_load_dwordx4 v12, s[8:11], s30 offen lds
  v_mfma_f32_16x16x32_bf16 v[36:39], v[200:203], v[248:251], v[36:39]
  v_mfma_f32_16x16x32_bf16 v[44:47], v[200:203], v[252:255], v[44:47]
  v_mfma_f32_16x16x32_bf16 v[48:51], v[204:207], v[252:255], v[48:51]
  v_mfma_f32_16x16x32_bf16 v[40:43], a[244:247], v[248:251], v[40:43]
  v_mfma_f32_16x16x32_bf16 v[52:55], a[244:247], v[252:255], v[52:55]
  s_waitcnt lgkmcnt(7)
  ds_read_b128 v[248:251], v21 offset:6144
  ds_read_b128 v[252:255], v21 offset:7168
  v_mfma_f32_16x16x32_bf16 v[148:151], a[120:123], v[188:191], v[148:151]
  ds_read_b128 v[172:175], v15 offset:6144
  v_mfma_f32_16x16x32_bf16 v[152:155], a[124:127], v[188:191], v[152:155]
  v_mfma_f32_16x16x32_bf16 v[156:159], a[128:131], v[188:191], v[156:159]
  s_waitcnt lgkmcnt(9)
  v_mfma_f32_16x16x32_bf16 v[64:67], a[132:135], v[160:163], v[64:67]
  ds_read_b128 v[176:179], v15 offset:8192
  v_mfma_f32_16x16x32_bf16 v[68:71], a[136:139], v[160:163], v[68:71]
  v_mfma_f32_16x16x32_bf16 v[72:75], a[140:143], v[160:163], v[72:75]
  s_waitcnt lgkmcnt(6)
  v_mfma_f32_16x16x32_bf16 v[36:39], v[224:227], v[56:59], v[36:39]
  v_mfma_f32_16x16x32_bf16 v[44:47], v[224:227], v[60:63], v[44:47]
  v_mfma_f32_16x16x32_bf16 v[48:51], v[228:231], v[60:63], v[48:51]
  v_mfma_f32_16x16x32_bf16 v[40:43], v[240:243], v[56:59], v[40:43]
  v_mfma_f32_16x16x32_bf16 v[52:55], v[240:243], v[60:63], v[52:55]
  s_waitcnt lgkmcnt(5)
  ds_read_b128 v[56:59], v21 offset:9216
  ds_read_b128 v[60:63], v21 offset:10240
  v_mfma_f32_16x16x32_bf16 v[76:79], a[132:135], v[164:167], v[76:79]
  ds_read_b128 v[180:183], v15 offset:10240
  v_mfma_f32_16x16x32_bf16 v[80:83], a[136:139], v[164:167], v[80:83]
  s_add_u32 m0, s31, 52224
  v_mfma_f32_16x16x32_bf16 v[84:87], a[140:143], v[164:167], v[84:87]
  s_waitcnt lgkmcnt(7)
  buffer_load_dwordx4 v13, s[8:11], s30 offen lds
  v_mfma_f32_16x16x32_bf16 v[88:91], a[132:135], v[168:171], v[88:91]
  s_add_u32 s30, s30, 128
  ds_read_b128 v[184:187], v15 offset:12288
  v_mfma_f32_16x16x32_bf16 v[92:95], a[136:139], v[168:171], v[92:95]
  v_mfma_f32_16x16x32_bf16 v[96:99], a[140:143], v[168:171], v[96:99]
  s_waitcnt lgkmcnt(6)
  v_mfma_f32_16x16x32_bf16 v[36:39], v[208:211], v[248:251], v[36:39]
  v_mfma_f32_16x16x32_bf16 v[44:47], v[208:211], v[252:255], v[44:47]
  v_mfma_f32_16x16x32_bf16 v[48:51], v[212:215], v[252:255], v[48:51]
  v_mfma_f32_16x16x32_bf16 v[40:43], a[248:251], v[248:251], v[40:43]
  v_mfma_f32_16x16x32_bf16 v[52:55], a[248:251], v[252:255], v[52:55]
  s_waitcnt lgkmcnt(5)
  ds_read2st64_b64 v[248:251], v22 offset0:12 offset1:18
  ds_read2st64_b64 v[252:255], v23 offset0:12 offset1:18
  v_mfma_f32_16x16x32_bf16 v[100:103], a[132:135], v[172:175], v[100:103]
  ds_read_b128 v[188:191], v15 offset:14336
  v_mfma_f32_16x16x32_bf16 v[104:107], a[136:139], v[172:175], v[104:107]
  v_mfma_f32_16x16x32_bf16 v[108:111], a[140:143], v[172:175], v[108:111]
  s_waitcnt lgkmcnt(7)
  v_mfma_f32_16x16x32_bf16 v[112:115], a[132:135], v[176:179], v[112:115]
  s_waitcnt vmcnt(8)
  s_barrier
  ds_read_b128 v[160:163], v14 offset:16384
  v_mfma_f32_16x16x32_bf16 v[116:119], a[136:139], v[176:179], v[116:119]
  v_mfma_f32_16x16x32_bf16 v[120:123], a[140:143], v[176:179], v[120:123]
  s_waitcnt lgkmcnt(6)
  v_mfma_f32_16x16x32_bf16 v[36:39], v[216:219], v[56:59], v[36:39]
  v_mfma_f32_16x16x32_bf16 v[44:47], v[216:219], v[60:63], v[44:47]
  v_mfma_f32_16x16x32_bf16 v[48:51], v[220:223], v[60:63], v[48:51]
  v_mfma_f32_16x16x32_bf16 v[40:43], a[252:255], v[56:59], v[40:43]
  v_mfma_f32_16x16x32_bf16 v[52:55], a[252:255], v[60:63], v[52:55]
  s_waitcnt lgkmcnt(5)
  v_mfma_f32_16x16x32_bf16 v[124:127], a[132:135], v[180:183], v[124:127]
  ds_read_b128 v[164:167], v14 offset:18432
  v_mfma_f32_16x16x32_bf16 v[128:131], a[136:139], v[180:183], v[128:131]
  v_mfma_f32_16x16x32_bf16 v[132:135], a[140:143], v[180:183], v[132:135]
  s_waitcnt lgkmcnt(5)
  v_mfma_f32_16x16x32_bf16 v[136:139], a[132:135], v[184:187], v[136:139]
  ds_read_b128 v[168:171], v14 offset:20480
  v_mfma_f32_16x16x32_bf16 v[140:143], a[136:139], v[184:187], v[140:143]
  v_mfma_f32_16x16x32_bf16 v[144:147], a[140:143], v[184:187], v[144:147]
  s_waitcnt lgkmcnt(4)
  v_mfma_f32_16x16x32_bf16 v[36:39], v[232:235], v[248:251], v[36:39]
  v_mfma_f32_16x16x32_bf16 v[44:47], v[232:235], v[252:255], v[44:47]
  v_mfma_f32_16x16x32_bf16 v[48:51], v[236:239], v[252:255], v[48:51]
  v_mfma_f32_16x16x32_bf16 v[40:43], v[244:247], v[248:251], v[40:43]
  v_mfma_f32_16x16x32_bf16 v[52:55], v[244:247], v[252:255], v[52:55]
  s_waitcnt lgkmcnt(3)
  v_mfma_f32_16x16x32_bf16 v[148:151], a[132:135], v[188:191], v[148:151]
  ds_read_b128 v[172:175], v14 offset:22528
  v_mfma_f32_16x16x32_bf16 v[152:155], a[136:139], v[188:191], v[152:155]
  v_mfma_f32_16x16x32_bf16 v[156:159], a[140:143], v[188:191], v[156:159]
  s_waitcnt lgkmcnt(3)
  v_cndmask_b32 v36, v31, v36, s[64:65]
  v_cndmask_b32 v48, v31, v48, s[64:65]
  v_mfma_f32_16x16x32_bf16 v[64:67], a[144:147], v[160:163], v[64:67]
  ds_read_b128 v[176:179], v14 offset:24576
  v_cndmask_b32 v37, v31, v37, s[66:67]
  v_mfma_f32_16x16x32_bf16 v[68:71], a[148:151], v[160:163], v[68:71]
  s_add_u32 m0, s31, 65536
  v_cndmask_b32 v49, v31, v49, s[66:67]
  v_cndmask_b32 v38, v31, v38, s[68:69]
  v_mfma_f32_16x16x32_bf16 v[72:75], a[152:155], v[160:163], v[72:75]
  s_waitcnt lgkmcnt(3)
  buffer_load_dwordx4 v10, s[8:11], s30 offen lds
  v_cndmask_b32 v50, v31, v50, s[68:69]
  v_mfma_f32_16x16x32_bf16 v[76:79], a[144:147], v[164:167], v[76:79]
  ds_read_b128 v[180:183], v14 offset:26624
  v_cndmask_b32 v39, v31, v39, s[70:71]
  v_mfma_f32_16x16x32_bf16 v[80:83], a[148:151], v[164:167], v[80:83]
  v_cndmask_b32 v51, v31, v51, s[70:71]
  v_max3_f32 v34, v36, v37, v38
  v_mfma_f32_16x16x32_bf16 v[84:87], a[152:155], v[164:167], v[84:87]
  s_waitcnt lgkmcnt(3)
  v_max3_f32 v34, v34, v39, v40
  v_max3_f32 v34, v34, v41, v42
  v_mfma_f32_16x16x32_bf16 v[88:91], a[144:147], v[168:171], v[88:91]
  ds_read_b128 v[184:187], v14 offset:28672
  v_max_f32 v34, v34, v43
  v_mfma_f32_16x16x32_bf16 v[92:95], a[148:151], v[168:171], v[92:95]
  v_mov_b32 v35, v34
  v_mfma_f32_16x16x32_bf16 v[96:99], a[152:155], v[168:171], v[96:99]
  s_waitcnt lgkmcnt(3)
  v_permlane32_swap_b32 v34, v35
  v_max_f32 v34, v34, v35
  v_mfma_f32_16x16x32_bf16 v[100:103], a[144:147], v[172:175], v[100:103]
  ds_read_b128 v[188:191], v14 offset:30720
  v_mov_b32 v35, v34
  v_mfma_f32_16x16x32_bf16 v[104:107], a[148:151], v[172:175], v[104:107]
  s_add_u32 m0, s31, 66560
  v_permlane16_swap_b32 v34, v35
  v_max_f32 v34, v34, v35
  v_mfma_f32_16x16x32_bf16 v[108:111], a[152:155], v[172:175], v[108:111]
  s_waitcnt lgkmcnt(3)
  buffer_load_dwordx4 v11, s[8:11], s30 offen lds
  v_mul_f32 v34, s83, v34
  v_mfma_f32_16x16x32_bf16 v[112:115], a[144:147], v[176:179], v[112:115]
  ds_read_b128 v[160:163], v15 offset:16384
  v_fma_f32 v36, v36, s83, -v34
  v_mfma_f32_16x16x32_bf16 v[116:119], a[148:151], v[176:179], v[116:119]
  v_fma_f32 v37, v37, s83, -v34
  v_fma_f32 v38, v38, s83, -v34
  v_mfma_f32_16x16x32_bf16 v[120:123], a[152:155], v[176:179], v[120:123]
  s_waitcnt lgkmcnt(3)
  v_fma_f32 v39, v39, s83, -v34
  v_fma_f32 v40, v40, s83, -v34
  v_mfma_f32_16x16x32_bf16 v[124:127], a[144:147], v[180:183], v[124:127]
  ds_read_b128 v[164:167], v15 offset:18432
  v_fma_f32 v41, v41, s83, -v34
  v_mfma_f32_16x16x32_bf16 v[128:131], a[148:151], v[180:183], v[128:131]
  v_fma_f32 v42, v42, s83, -v34
  v_fma_f32 v43, v43, s83, -v34
  v_mfma_f32_16x16x32_bf16 v[132:135], a[152:155], v[180:183], v[132:135]
  s_waitcnt lgkmcnt(3)
  v_exp_f32 v36, v36
  v_mfma_f32_16x16x32_bf16 v[136:139], a[144:147], v[184:187], v[136:139]
  ds_read_b128 v[168:171], v15 offset:20480
  v_mfma_f32_16x16x32_bf16 v[140:143], a[148:151], v[184:187], v[140:143]
  s_add_u32 m0, s31, 67584
  v_exp_f32 v37, v37
  v_mfma_f32_16x16x32_bf16 v[144:147], a[152:155], v[184:187], v[144:147]
  s_waitcnt lgkmcnt(3)
  buffer_load_dwordx4 v12, s[8:11], s30 offen lds
  v_mfma_f32_16x16x32_bf16 v[148:151], a[144:147], v[188:191], v[148:151]
  ds_read_b128 v[172:175], v15 offset:22528
  v_mfma_f32_16x16x32_bf16 v[152:155], a[148:151], v[188:191], v[152:155]
  v_exp_f32 v38, v38
  v_mfma_f32_16x16x32_bf16 v[156:159], a[152:155], v[188:191], v[156:159]
  s_waitcnt lgkmcnt(3)
  v_exp_f32 v39, v39
  v_mfma_f32_16x16x32_bf16 v[64:67], a[156:159], v[160:163], v[64:67]
  ds_read_b128 v[176:179], v15 offset:24576
  v_mfma_f32_16x16x32_bf16 v[68:71], a[160:163], v[160:163], v[68:71]
  v_exp_f32 v40, v40
  v_mfma_f32_16x16x32_bf16 v[72:75], a[164:167], v[160:163], v[72:75]
  s_waitcnt lgkmcnt(3)
  v_exp_f32 v41, v41
  v_mfma_f32_16x16x32_bf16 v[76:79], a[156:159], v[164:167], v[76:79]
  ds_read_b128 v[180:183], v15 offset:26624
  v_mfma_f32_16x16x32_bf16 v[80:83], a[160:163], v[164:167], v[80:83]
  s_add_u32 m0, s31, 68608
  v_exp_f32 v42, v42
  v_mfma_f32_16x16x32_bf16 v[84:87], a[164:167], v[164:167], v[84:87]
  s_waitcnt lgkmcnt(3)
  buffer_load_dwordx4 v13, s[8:11], s30 offen lds
  v_mfma_f32_16x16x32_bf16 v[88:91], a[156:159], v[168:171], v[88:91]
  s_add_u32 s30, s30, s25
  ds_read_b128 v[184:187], v15 offset:28672
  v_mfma_f32_16x16x32_bf16 v[92:95], a[160:163], v[168:171], v[92:95]
  v_exp_f32 v43, v43
  v_mfma_f32_16x16x32_bf16 v[96:99], a[164:167], v[168:171], v[96:99]
  s_waitcnt lgkmcnt(3)
  v_add_f32 v34, v40, v41
  v_add_f32 v34, v34, v42
  v_mfma_f32_16x16x32_bf16 v[100:103], a[156:159], v[172:175], v[100:103]
  ds_read_b128 v[188:191], v15 offset:30720
  v_add_f32 v34, v34, v43
  v_mfma_f32_16x16x32_bf16 v[104:107], a[160:163], v[172:175], v[104:107]
  v_cndmask_b32 v34, 0, v34, s[62:63]
  v_add_f32 v34, v34, v36
  v_mfma_f32_16x16x32_bf16 v[108:111], a[164:167], v[172:175], v[108:111]
  s_waitcnt lgkmcnt(3)
  v_add_f32 v34, v34, v37
  v_add_f32 v34, v34, v38
  v_mfma_f32_16x16x32_bf16 v[112:115], a[156:159], v[176:179], v[112:115]
  s_waitcnt vmcnt(8)
  s_barrier
  ds_read_b128 v[160:163], v14 offset:32768
  v_mfma_f32_16x16x32_bf16 v[116:119], a[160:163], v[176:179], v[116:119]
  v_add_f32 v34, v34, v39
  v_mov_b32 v35, v34
  v_mfma_f32_16x16x32_bf16 v[120:123], a[164:167], v[176:179], v[120:123]
  s_waitcnt lgkmcnt(3)
  v_permlane32_swap_b32 v34, v35
  v_add_f32 v34, v34, v35
  v_mfma_f32_16x16x32_bf16 v[124:127], a[156:159], v[180:183], v[124:127]
  ds_read_b128 v[164:167], v14 offset:34816
  v_mov_b32 v35, v34
  v_mfma_f32_16x16x32_bf16 v[128:131], a[160:163], v[180:183], v[128:131]
  v_permlane16_swap_b32 v34, v35
  v_add_f32 v34, v34, v35
  v_mfma_f32_16x16x32_bf16 v[132:135], a[164:167], v[180:183], v[132:135]
  s_waitcnt lgkmcnt(3)
  v_rcp_f32 v34, v34
  v_mfma_f32_16x16x32_bf16 v[136:139], a[156:159], v[184:187], v[136:139]
  ds_read_b128 v[168:171], v14 offset:36864
  v_mul_f32 v36, v36, v34
  v_mfma_f32_16x16x32_bf16 v[140:143], a[160:163], v[184:187], v[140:143]
  v_mul_f32 v37, v37, v34
  v_mul_f32 v38, v38, v34
  v_mfma_f32_16x16x32_bf16 v[144:147], a[164:167], v[184:187], v[144:147]
  s_waitcnt lgkmcnt(3)
  v_mul_f32 v39, v39, v34
  v_mul_f32 v40, v40, v34
  v_mfma_f32_16x16x32_bf16 v[148:151], a[156:159], v[188:191], v[148:151]
  ds_read_b128 v[172:175], v14 offset:38912
  v_mul_f32 v41, v41, v34
  v_mfma_f32_16x16x32_bf16 v[152:155], a[160:163], v[188:191], v[152:155]
  v_mul_f32 v42, v42, v34
  v_mul_f32 v43, v43, v34
  v_mfma_f32_16x16x32_bf16 v[156:159], a[164:167], v[188:191], v[156:159]
  s_waitcnt lgkmcnt(3)
  v_max3_f32 v34, v44, v45, v46
  v_max3_f32 v34, v34, v47, v48
  v_mfma_f32_16x16x32_bf16 v[64:67], a[168:171], v[160:163], v[64:67]
  ds_read_b128 v[176:179], v14 offset:40960
  v_max3_f32 v34, v34, v49, v50
  v_mfma_f32_16x16x32_bf16 v[68:71], a[172:175], v[160:163], v[68:71]
  s_add_u32 m0, s31, 0
  v_max3_f32 v34, v34, v51, v52
  v_max3_f32 v34, v34, v53, v54
  v_mfma_f32_16x16x32_bf16 v[72:75], a[176:179], v[160:163], v[72:75]
  s_waitcnt lgkmcnt(3)
  buffer_load_dwordx4 v10, s[8:11], s30 offen lds
  v_max_f32 v34, v34, v55
  v_mfma_f32_16x16x32_bf16 v[76:79], a[168:171], v[164:167], v[76:79]
  ds_read_b128 v[180:183], v14 offset:43008
  v_mov_b32 v35, v34
  v_mfma_f32_16x16x32_bf16 v[80:83], a[172:175], v[164:167], v[80:83]
  v_permlane32_swap_b32 v34, v35
  v_max_f32 v34, v34, v35
  v_mfma_f32_16x16x32_bf16 v[84:87], a[176:179], v[164:167], v[84:87]
  s_waitcnt lgkmcnt(3)
  v_mov_b32 v35, v34
  v_mfma_f32_16x16x32_bf16 v[88:91], a[168:171], v[168:171], v[88:91]
  ds_read_b128 v[184:187], v14 offset:45056
  v_permlane16_swap_b32 v34, v35
  v_mfma_f32_16x16x32_bf16 v[92:95], a[172:175], v[168:171], v[92:95]
  v_max_f32 v34, v34, v35
  v_mul_f32 v34, s83, v34
  v_mfma_f32_16x16x32_bf16 v[96:99], a[176:179], v[168:171], v[96:99]
  s_waitcnt lgkmcnt(3)
  v_fma_f32 v44, v44, s83, -v34
  v_fma_f32 v45, v45, s83, -v34
  v_mfma_f32_16x16x32_bf16 v[100:103], a[168:171], v[172:175], v[100:103]
  ds_read_b128 v[188:191], v14 offset:47104
  v_fma_f32 v46, v46, s83, -v34
  v_mfma_f32_16x16x32_bf16 v[104:107], a[172:175], v[172:175], v[104:107]
  s_add_u32 m0, s31, 1024
  v_fma_f32 v47, v47, s83, -v34
  v_fma_f32 v48, v48, s83, -v34
  v_mfma_f32_16x16x32_bf16 v[108:111], a[176:179], v[172:175], v[108:111]
  s_waitcnt lgkmcnt(3)
  buffer_load_dwordx4 v11, s[8:11], s30 offen lds
  v_fma_f32 v49, v49, s83, -v34
  v_mfma_f32_16x16x32_bf16 v[112:115], a[168:171], v[176:179], v[112:115]
  ds_read_b128 v[160:163], v15 offset:32768
  v_fma_f32 v50, v50, s83, -v34
  v_mfma_f32_16x16x32_bf16 v[116:119], a[172:175], v[176:179], v[116:119]
  v_fma_f32 v51, v51, s83, -v34
  v_fma_f32 v52, v52, s83, -v34
  v_mfma_f32_16x16x32_bf16 v[120:123], a[176:179], v[176:179], v[120:123]
  s_waitcnt lgkmcnt(3)
  v_fma_f32 v53, v53, s83, -v34
  v_fma_f32 v54, v54, s83, -v34
  v_mfma_f32_16x16x32_bf16 v[124:127], a[168:171], v[180:183], v[124:127]
  ds_read_b128 v[164:167], v15 offset:34816
  v_fma_f32 v55, v55, s83, -v34
  v_mfma_f32_16x16x32_bf16 v[128:131], a[172:175], v[180:183], v[128:131]
  v_exp_f32 v44, v44
  v_mfma_f32_16x16x32_bf16 v[132:135], a[176:179], v[180:183], v[132:135]
  s_waitcnt lgkmcnt(3)
  v_exp_f32 v45, v45
  v_mfma_f32_16x16x32_bf16 v[136:139], a[168:171], v[184:187], v[136:139]
  ds_read_b128 v[168:171], v15 offset:36864
  v_mfma_f32_16x16x32_bf16 v[140:143], a[172:175], v[184:187], v[140:143]
  s_add_u32 m0, s31, 2048
  v_exp_f32 v46, v46
  v_mfma_f32_16x16x32_bf16 v[144:147], a[176:179], v[184:187], v[144:147]
  s_waitcnt lgkmcnt(3)
  buffer_load_dwordx4 v12, s[8:11], s30 offen lds
  v_mfma_f32_16x16x32_bf16 v[148:151], a[168:171], v[188:191], v[148:151]
  ds_read_b128 v[172:175], v15 offset:38912
  v_mfma_f32_16x16x32_bf16 v[152:155], a[172:175], v[188:191], v[152:155]
  v_exp_f32 v47, v47
  v_mfma_f32_16x16x32_bf16 v[156:159], a[176:179], v[188:191], v[156:159]
  s_waitcnt lgkmcnt(3)
  v_exp_f32 v48, v48
  v_mfma_f32_16x16x32_bf16 v[64:67], a[180:183], v[160:163], v[64:67]
  ds_read_b128 v[176:179], v15 offset:40960
  v_mfma_f32_16x16x32_bf16 v[68:71], a[184:187], v[160:163], v[68:71]
  v_exp_f32 v49, v49
  v_mfma_f32_16x16x32_bf16 v[72:75], a[188:191], v[160:163], v[72:75]
  s_waitcnt lgkmcnt(3)
  v_exp_f32 v50, v50
  v_mfma_f32_16x16x32_bf16 v[76:79], a[180:183], v[164:167], v[76:79]
  ds_read_b128 v[180:183], v15 offset:43008
  v_mfma_f32_16x16x32_bf16 v[80:83], a[184:187], v[164:167], v[80:83]
  s_add_u32 m0, s31, 3072
  v_exp_f32 v51, v51
  v_mfma_f32_16x16x32_bf16 v[84:87], a[188:191], v[164:167], v[84:87]
  s_waitcnt lgkmcnt(3)
  buffer_load_dwordx4 v13, s[8:11], s30 offen lds
  v_mfma_f32_16x16x32_bf16 v[88:91], a[180:183], v[168:171], v[88:91]
  s_add_u32 s30, s30, 128
  ds_read_b128 v[184:187], v15 offset:45056
  v_mfma_f32_16x16x32_bf16 v[92:95], a[184:187], v[168:171], v[92:95]
  v_exp_f32 v52, v52
  v_mfma_f32_16x16x32_bf16 v[96:99], a[188:191], v[168:171], v[96:99]
  s_waitcnt lgkmcnt(3)
  v_exp_f32 v53, v53
  v_mfma_f32_16x16x32_bf16 v[100:103], a[180:183], v[172:175], v[100:103]
  ds_read_b128 v[188:191], v15 offset:47104
  v_mfma_f32_16x16x32_bf16 v[104:107], a[184:187], v[172:175], v[104:107]
  v_exp_f32 v54, v54
  v_mfma_f32_16x16x32_bf16 v[108:111], a[188:191], v[172:175], v[108:111]
  s_waitcnt lgkmcnt(3)
  v_exp_f32 v55, v55
  v_mfma_f32_16x16x32_bf16 v[112:115], a[180:183], v[176:179], v[112:115]
  s_waitcnt vmcnt(8)
  s_barrier
  ds_read_b128 v[160:163], v14 offset:49152
  v_mfma_f32_16x16x32_bf16 v[116:119], a[184:187], v[176:179], v[116:119]
  v_add_f32 v34, v52, v53
  v_add_f32 v34, v34, v54
  v_mfma_f32_16x16x32_bf16 v[120:123], a[188:191], v[176:179], v[120:123]
  s_waitcnt lgkmcnt(3)
  v_add_f32 v34, v34, v55
  v_cndmask_b32 v34, 0, v34, s[62:63]
  v_mfma_f32_16x16x32_bf16 v[124:127], a[180:183], v[180:183], v[124:127]
  ds_read_b128 v[164:167], v14 offset:51200
  v_add_f32 v34, v34, v44
  v_mfma_f32_16x16x32_bf16 v[128:131], a[184:187], v[180:183], v[128:131]
  v_add_f32 v34, v34, v45
  v_add_f32 v34, v34, v46
  v_mfma_f32_16x16x32_bf16 v[132:135], a[188:191], v[180:183], v[132:135]
  s_waitcnt lgkmcnt(3)
  v_add_f32 v34, v34, v47
  v_add_f32 v34, v34, v48
  v_mfma_f32_16x16x32_bf16 v[136:139], a[180:183], v[184:187], v[136:139]
  ds_read_b128 v[168:171], v14 offset:53248
  v_add_f32 v34, v34, v49
  v_mfma_f32_16x16x32_bf16 v[140:143], a[184:187], v[184:187], v[140:143]
  v_add_f32 v34, v34, v50
  v_add_f32 v34, v34, v51
  v_mfma_f32_16x16x32_bf16 v[144:147], a[188:191], v[184:187], v[144:147]
  s_waitcnt lgkmcnt(3)
  v_mov_b32 v35, v34
  v_mfma_f32_16x16x32_bf16 v[148:151], a[180:183], v[188:191], v[148:151]
  ds_read_b128 v[172:175], v14 offset:55296
  v_permlane32_swap_b32 v34, v35
  v_mfma_f32_16x16x32_bf16 v[152:155], a[184:187], v[188:191], v[152:155]
  v_add_f32 v34, v34, v35
  v_mov_b32 v35, v34
  v_mfma_f32_16x16x32_bf16 v[156:159], a[188:191], v[188:191], v[156:159]
  s_waitcnt lgkmcnt(3)
  v_permlane16_swap_b32 v34, v35
  v_add_f32 v34, v34, v35
  v_mfma_f32_16x16x32_bf16 v[64:67], a[192:195], v[160:163], v[64:67]
  ds_read_b128 v[176:179], v14 offset:57344
  v_mfma_f32_16x16x32_bf16 v[68:71], a[196:199], v[160:163], v[68:71]
  s_add_u32 m0, s31, 16384
  v_rcp_f32 v34, v34
  v_mfma_f32_16x16x32_bf16 v[72:75], a[200:203], v[160:163], v[72:75]
  s_waitcnt lgkmcnt(3)
  buffer_load_dwordx4 v10, s[8:11], s30 offen lds
  v_mul_f32 v44, v44, v34
  v_mfma_f32_16x16x32_bf16 v[76:79], a[192:195], v[164:167], v[76:79]
  ds_read_b128 v[180:183], v14 offset:59392
  v_mul_f32 v45, v45, v34
  v_mfma_f32_16x16x32_bf16 v[80:83], a[196:199], v[164:167], v[80:83]
  v_mul_f32 v46, v46, v34
  v_mul_f32 v47, v47, v34
  v_mfma_f32_16x16x32_bf16 v[84:87], a[200:203], v[164:167], v[84:87]
  s_waitcnt lgkmcnt(3)
  v_mul_f32 v48, v48, v34
  v_mul_f32 v49, v49, v34
  v_mfma_f32_16x16x32_bf16 v[88:91], a[192:195], v[168:171], v[88:91]
  ds_read_b128 v[184:187], v14 offset:61440
  v_mul_f32 v50, v50, v34
  v_mfma_f32_16x16x32_bf16 v[92:95], a[196:199], v[168:171], v[92:95]
  v_mul_f32 v51, v51, v34
  v_mul_f32 v52, v52, v34
  v_mfma_f32_16x16x32_bf16 v[96:99], a[200:203], v[168:171], v[96:99]
  s_waitcnt lgkmcnt(3)
  v_mul_f32 v53, v53, v34
  v_mul_f32 v54, v54, v34
  v_mfma_f32_16x16x32_bf16 v[100:103], a[192:195], v[172:175], v[100:103]
  ds_read_b128 v[188:191], v14 offset:63488
  v_mul_f32 v55, v55, v34
  v_mfma_f32_16x16x32_bf16 v[104:107], a[196:199], v[172:175], v[104:107]
  s_add_u32 m0, s31, 17408
  v_cvt_pk_bf16_f32 v56, v44, v45
  v_cvt_pk_bf16_f32 v57, v46, v47
  v_mfma_f32_16x16x32_bf16 v[108:111], a[200:203], v[172:175], v[108:111]
  s_waitcnt lgkmcnt(3)
  buffer_load_dwordx4 v11, s[8:11], s30 offen lds
  v_cvt_pk_bf16_f32 v58, v48, v49
  v_mfma_f32_16x16x32_bf16 v[112:115], a[192:195], v[176:179], v[112:115]
  ds_read_b128 v[160:163], v15 offset:49152
  v_cvt_pk_bf16_f32 v59, v50, v51
  v_mfma_f32_16x16x32_bf16 v[116:119], a[196:199], v[176:179], v[116:119]
  v_cvt_pk_bf16_f32 v60, v40, v41
  v_cvt_pk_bf16_f32 v61, v42, v43
  v_mfma_f32_16x16x32_bf16 v[120:123], a[200:203], v[176:179], v[120:123]
  s_waitcnt lgkmcnt(3)
  v_cvt_pk_bf16_f32 v62, v52, v53
  v_cvt_pk_bf16_f32 v63, v54, v55
  v_mfma_f32_16x16x32_bf16 v[124:127], a[192:195], v[180:183], v[124:127]
  ds_read_b128 v[164:167], v15 offset:51200
  v_cvt_pk_bf16_f32 v248, v36, v37
  v_mfma_f32_16x16x32_bf16 v[128:131], a[196:199], v[180:183], v[128:131]
  v_cvt_pk_bf16_f32 v249, v38, v39
  buffer_store_dwordx4 v[56:59], v26, s[16:19], s81 offen sc1
  v_mfma_f32_16x16x32_bf16 v[132:135], a[200:203], v[180:183], v[132:135]
  s_waitcnt lgkmcnt(3)
  v_mfma_f32_16x16x32_bf16 v[136:139], a[192:195], v[184:187], v[136:139]
  ds_read_b128 v[168:171], v15 offset:53248
  v_mfma_f32_16x16x32_bf16 v[140:143], a[196:199], v[184:187], v[140:143]
  s_add_u32 m0, s31, 18432
  v_mfma_f32_16x16x32_bf16 v[144:147], a[200:203], v[184:187], v[144:147]
  s_waitcnt lgkmcnt(3)
  buffer_load_dwordx4 v12, s[8:11], s30 offen lds
  v_mfma_f32_16x16x32_bf16 v[148:151], a[192:195], v[188:191], v[148:151]
  ds_read_b128 v[172:175], v15 offset:55296
  v_mfma_f32_16x16x32_bf16 v[152:155], a[196:199], v[188:191], v[152:155]
  v_mfma_f32_16x16x32_bf16 v[156:159], a[200:203], v[188:191], v[156:159]
  s_waitcnt lgkmcnt(3)
  buffer_store_dwordx4 v[60:63], v26, s[16:19], s81 offen offset:1024 sc1
  v_mfma_f32_16x16x32_bf16 v[64:67], a[204:207], v[160:163], v[64:67]
  ds_read_b128 v[176:179], v15 offset:57344
  v_mfma_f32_16x16x32_bf16 v[68:71], a[208:211], v[160:163], v[68:71]
  v_mfma_f32_16x16x32_bf16 v[72:75], a[212:215], v[160:163], v[72:75]
  s_waitcnt lgkmcnt(3)
  buffer_store_dwordx2 v[248:249], v29, s[16:19], s81 offen offset:2048 sc1
  v_mfma_f32_16x16x32_bf16 v[76:79], a[204:207], v[164:167], v[76:79]
  ds_read_b128 v[180:183], v15 offset:59392
  s_mov_b32 s84, s82
  v_mfma_f32_16x16x32_bf16 v[80:83], a[208:211], v[164:167], v[80:83]
  s_add_u32 m0, s31, 19456
  v_mfma_f32_16x16x32_bf16 v[84:87], a[212:215], v[164:167], v[84:87]
  s_waitcnt lgkmcnt(3)
  buffer_load_dwordx4 v13, s[8:11], s30 offen lds
  v_mfma_f32_16x16x32_bf16 v[88:91], a[204:207], v[168:171], v[88:91]
  s_add_u32 s30, s30, 128
  ds_read_b128 v[184:187], v15 offset:61440
  v_mfma_f32_16x16x32_bf16 v[92:95], a[208:211], v[168:171], v[92:95]
  s_cmp_le_u32 s26, s85
  s_cbranch_scc1 qa2_265
  s_mov_b32 s49, s43
  s_mov_b32 s50, s45
  s_mov_b32 s81, s47
  s_mov_b32 s82, s48
  s_add_u32 s43, s43, 4
  s_add_u32 s45, s45, 8388608
  s_add_u32 s47, s47, 2097152
  s_xor_b32 s47, s47, 8192
  s_add_u32 s48, s48, 512
qa3_266:
  v_mfma_f32_16x16x32_bf16 v[96:99], a[212:215], v[168:171], v[96:99]
  s_waitcnt lgkmcnt(3)
  v_mfma_f32_16x16x32_bf16 v[100:103], a[204:207], v[172:175], v[100:103]
  ds_read_b128 v[188:191], v15 offset:63488
  v_mfma_f32_16x16x32_bf16 v[104:107], a[208:211], v[172:175], v[104:107]
  v_mfma_f32_16x16x32_bf16 v[108:111], a[212:215], v[172:175], v[108:111]
  s_waitcnt lgkmcnt(3)
  v_mfma_f32_16x16x32_bf16 v[112:115], a[204:207], v[176:179], v[112:115]
  s_waitcnt vmcnt(11)
  s_barrier
  ds_read_b128 v[160:163], v16 offset:0
  v_mfma_f32_16x16x32_bf16 v[116:119], a[208:211], v[176:179], v[116:119]
  buffer_load_dword v32, v30, s[72:75], s77 offen sc1
  v_mfma_f32_16x16x32_bf16 v[120:123], a[212:215], v[176:179], v[120:123]
  s_waitcnt lgkmcnt(3)
  v_mfma_f32_16x16x32_bf16 v[124:127], a[204:207], v[180:183], v[124:127]
  ds_read_b128 v[164:167], v16 offset:2048
  v_mfma_f32_16x16x32_bf16 v[128:131], a[208:211], v[180:183], v[128:131]
  v_mfma_f32_16x16x32_bf16 v[132:135], a[212:215], v[180:183], v[132:135]
  s_waitcnt lgkmcnt(3)
  v_mfma_f32_16x16x32_bf16 v[136:139], a[204:207], v[184:187], v[136:139]
  ds_read_b128 v[168:171], v16 offset:4096
  v_mfma_f32_16x16x32_bf16 v[140:143], a[208:211], v[184:187], v[140:143]
  v_mfma_f32_16x16x32_bf16 v[144:147], a[212:215], v[184:187], v[144:147]
  s_waitcnt lgkmcnt(3)
  v_mfma_f32_16x16x32_bf16 v[148:151], a[204:207], v[188:191], v[148:151]
  ds_read_b128 v[172:175], v16 offset:6144
  v_mfma_f32_16x16x32_bf16 v[152:155], a[208:211], v[188:191], v[152:155]
  v_mfma_f32_16x16x32_bf16 v[156:159], a[212:215], v[188:191], v[156:159]
  s_waitcnt lgkmcnt(3)
  v_mfma_f32_16x16x32_bf16 v[64:67], a[216:219], v[160:163], v[64:67]
  ds_read_b128 v[176:179], v16 offset:8192
  v_mfma_f32_16x16x32_bf16 v[68:71], a[220:223], v[160:163], v[68:71]
  s_add_u32 m0, s31, 32768
  v_mfma_f32_16x16x32_bf16 v[72:75], a[224:227], v[160:163], v[72:75]
  s_waitcnt lgkmcnt(3)
  buffer_load_dwordx4 v10, s[8:11], s30 offen lds
  v_mfma_f32_16x16x32_bf16 v[76:79], a[216:219], v[164:167], v[76:79]
  ds_read_b128 v[180:183], v16 offset:10240
  v_mfma_f32_16x16x32_bf16 v[80:83], a[220:223], v[164:167], v[80:83]
  v_mfma_f32_16x16x32_bf16 v[84:87], a[224:227], v[164:167], v[84:87]
  s_waitcnt lgkmcnt(3)
  v_mfma_f32_16x16x32_bf16 v[88:91], a[216:219], v[168:171], v[88:91]
  ds_read_b128 v[184:187], v16 offset:12288
  v_mfma_f32_16x16x32_bf16 v[92:95], a[220:223], v[168:171], v[92:95]
  s_add_u32 m0, s31, 33792
  v_mfma_f32_16x16x32_bf16 v[96:99], a[224:227], v[168:171], v[96:99]
  s_waitcnt lgkmcnt(3)
  buffer_load_dwordx4 v11, s[8:11], s30 offen lds
  v_mfma_f32_16x16x32_bf16 v[100:103], a[216:219], v[172:175], v[100:103]
  ds_read_b128 v[188:191], v16 offset:14336
  v_mfma_f32_16x16x32_bf16 v[104:107], a[220:223], v[172:175], v[104:107]
  v_mfma_f32_16x16x32_bf16 v[108:111], a[224:227], v[172:175], v[108:111]
  s_waitcnt lgkmcnt(3)
  v_mfma_f32_16x16x32_bf16 v[112:115], a[216:219], v[176:179], v[112:115]
  ds_read_b128 v[160:163], v17 offset:0
  v_mfma_f32_16x16x32_bf16 v[116:119], a[220:223], v[176:179], v[116:119]
  s_add_u32 m0, s31, 34816
  v_mfma_f32_16x16x32_bf16 v[120:123], a[224:227], v[176:179], v[120:123]
  s_waitcnt lgkmcnt(3)
  buffer_load_dwordx4 v12, s[8:11], s30 offen lds
  v_mfma_f32_16x16x32_bf16 v[124:127], a[216:219], v[180:183], v[124:127]
  ds_read_b128 v[164:167], v17 offset:2048
  v_mfma_f32_16x16x32_bf16 v[128:131], a[220:223], v[180:183], v[128:131]
  v_mfma_f32_16x16x32_bf16 v[132:135], a[224:227], v[180:183], v[132:135]
  s_waitcnt lgkmcnt(3)
  v_mfma_f32_16x16x32_bf16 v[136:139], a[216:219], v[184:187], v[136:139]
  ds_read_b128 v[168:171], v17 offset:4096
  v_mfma_f32_16x16x32_bf16 v[140:143], a[220:223], v[184:187], v[140:143]
  s_add_u32 m0, s31, 35840
  v_mfma_f32_16x16x32_bf16 v[144:147], a[224:227], v[184:187], v[144:147]
  s_waitcnt lgkmcnt(3)
  buffer_load_dwordx4 v13, s[8:11], s30 offen lds
  v_mfma_f32_16x16x32_bf16 v[148:151], a[216:219], v[188:191], v[148:151]
  s_add_u32 s30, s30, 128
  ds_read_b128 v[172:175], v17 offset:6144
  v_mfma_f32_16x16x32_bf16 v[152:155], a[220:223], v[188:191], v[152:155]
  v_mfma_f32_16x16x32_bf16 v[156:159], a[224:227], v[188:191], v[156:159]
  s_waitcnt lgkmcnt(3)
  v_mfma_f32_16x16x32_bf16 v[64:67], a[228:231], v[160:163], v[64:67]
  ds_read_b128 v[176:179], v17 offset:8192
  v_mfma_f32_16x16x32_bf16 v[68:71], a[232:235], v[160:163], v[68:71]
  v_mfma_f32_16x16x32_bf16 v[72:75], a[236:239], v[160:163], v[72:75]
  s_waitcnt lgkmcnt(3)
  v_mfma_f32_16x16x32_bf16 v[76:79], a[228:231], v[164:167], v[76:79]
  ds_read_b128 v[180:183], v17 offset:10240
  v_cvt_pk_bf16_f32 v192, v64, v65
  v_mfma_f32_16x16x32_bf16 v[80:83], a[232:235], v[164:167], v[80:83]
  v_cvt_pk_bf16_f32 v193, v66, v67
  v_cvt_pk_bf16_f32 v194, v68, v69
  v_mfma_f32_16x16x32_bf16 v[84:87], a[236:239], v[164:167], v[84:87]
  s_waitcnt lgkmcnt(3)
  v_cvt_pk_bf16_f32 v195, v70, v71
  v_cvt_pk_bf16_f32 v200, v72, v73
  v_mfma_f32_16x16x32_bf16 v[88:91], a[228:231], v[168:171], v[88:91]
  ds_read_b128 v[184:187], v17 offset:12288
  v_cvt_pk_bf16_f32 v201, v74, v75
  v_mfma_f32_16x16x32_bf16 v[92:95], a[232:235], v[168:171], v[92:95]
  v_cvt_pk_bf16_f32 v196, v76, v77
  v_cvt_pk_bf16_f32 v197, v78, v79
  v_mfma_f32_16x16x32_bf16 v[96:99], a[236:239], v[168:171], v[96:99]
  s_waitcnt lgkmcnt(3)
  v_cvt_pk_bf16_f32 v198, v80, v81
  v_cvt_pk_bf16_f32 v199, v82, v83
  v_mfma_f32_16x16x32_bf16 v[100:103], a[228:231], v[172:175], v[100:103]
  ds_read_b128 v[188:191], v17 offset:14336
  v_cvt_pk_bf16_f32 v202, v84, v85
  v_mfma_f32_16x16x32_bf16 v[104:107], a[232:235], v[172:175], v[104:107]
  v_cvt_pk_bf16_f32 v203, v86, v87
  v_cvt_pk_bf16_f32 v204, v88, v89
  v_mfma_f32_16x16x32_bf16 v[108:111], a[236:239], v[172:175], v[108:111]
  s_waitcnt lgkmcnt(3)
  v_cvt_pk_bf16_f32 v205, v90, v91
  v_cvt_pk_bf16_f32 v206, v92, v93
  v_mfma_f32_16x16x32_bf16 v[112:115], a[228:231], v[176:179], v[112:115]
  s_waitcnt vmcnt(12)
  s_barrier
  ds_read_b128 v[160:163], v14 offset:0
  v_mfma_f32_16x16x32_bf16 v[116:119], a[232:235], v[176:179], v[116:119]
  v_cvt_pk_bf16_f32 v207, v94, v95
  v_cvt_pk_bf16_f32 v212, v96, v97
  v_mfma_f32_16x16x32_bf16 v[120:123], a[236:239], v[176:179], v[120:123]
  s_waitcnt lgkmcnt(3)
  v_cvt_pk_bf16_f32 v213, v98, v99
  v_cvt_pk_bf16_f32 v208, v100, v101
  v_mfma_f32_16x16x32_bf16 v[124:127], a[228:231], v[180:183], v[124:127]
  ds_read_b128 v[164:167], v14 offset:2048
  v_cvt_pk_bf16_f32 v209, v102, v103
  v_mfma_f32_16x16x32_bf16 v[128:131], a[232:235], v[180:183], v[128:131]
  v_cvt_pk_bf16_f32 v210, v104, v105
  v_cvt_pk_bf16_f32 v211, v106, v107
  v_mfma_f32_16x16x32_bf16 v[132:135], a[236:239], v[180:183], v[132:135]
  s_waitcnt lgkmcnt(3)
  v_cvt_pk_bf16_f32 v214, v108, v109
  v_cvt_pk_bf16_f32 v215, v110, v111
  v_mfma_f32_16x16x32_bf16 v[136:139], a[228:231], v[184:187], v[136:139]
  ds_read_b128 v[168:171], v14 offset:4096
  v_cvt_pk_bf16_f32 v216, v112, v113
  v_mfma_f32_16x16x32_bf16 v[140:143], a[232:235], v[184:187], v[140:143]
  v_cvt_pk_bf16_f32 v217, v114, v115
  v_cvt_pk_bf16_f32 v218, v116, v117
  v_mfma_f32_16x16x32_bf16 v[144:147], a[236:239], v[184:187], v[144:147]
  s_waitcnt lgkmcnt(3)
  v_cvt_pk_bf16_f32 v219, v118, v119
  v_cvt_pk_bf16_f32 v224, v120, v121
  v_mfma_f32_16x16x32_bf16 v[148:151], a[228:231], v[188:191], v[148:151]
  ds_read_b128 v[172:175], v14 offset:6144
  v_cvt_pk_bf16_f32 v225, v122, v123
  v_mfma_f32_16x16x32_bf16 v[152:155], a[232:235], v[188:191], v[152:155]
  s_sub_u32 s26, s26, 1
  s_cmp_gt_u32 s26, 0
  v_cvt_pk_bf16_f32 v220, v124, v125
  v_mfma_f32_16x16x32_bf16 v[156:159], a[236:239], v[188:191], v[156:159]
  s_waitcnt lgkmcnt(3)
  s_cbranch_scc1 qa_269
  s_nop 7
  v_cvt_pk_bf16_f32 v221, v126, v127
  v_cvt_pk_bf16_f32 v222, v128, v129
  v_cvt_pk_bf16_f32 v223, v130, v131
  v_cvt_pk_bf16_f32 v226, v132, v133
  v_cvt_pk_bf16_f32 v227, v134, v135
  v_cvt_pk_bf16_f32 v228, v136, v137
  v_cvt_pk_bf16_f32 v229, v138, v139
  v_cvt_pk_bf16_f32 v230, v140, v141
  v_cvt_pk_bf16_f32 v231, v142, v143
  v_cvt_pk_bf16_f32 v236, v144, v145
  v_cvt_pk_bf16_f32 v237, v146, v147
  v_cvt_pk_bf16_f32 v232, v148, v149
  v_cvt_pk_bf16_f32 v233, v150, v151
  v_cvt_pk_bf16_f32 v234, v152, v153
  v_cvt_pk_bf16_f32 v235, v154, v155
  v_cvt_pk_bf16_f32 v238, v156, v157
  v_cvt_pk_bf16_f32 v239, v158, v159
  s_waitcnt lgkmcnt(0)
  s_mul_i32 s86, s42, 393216
  ds_read_b128 v[64:67], v21 offset:0
  ds_read_b128 v[68:71], v21 offset:1024
  ds_read_b128 v[72:75], v21 offset:3072
  ds_read_b128 v[76:79], v21 offset:4096
  ds_read2st64_b64 v[80:83], v22 offset0:0 offset1:6
  ds_read2st64_b64 v[84:87], v23 offset0:0 offset1:6
  ds_read_b128 v[88:91], v21 offset:6144
  ds_read_b128 v[92:95], v21 offset:7168
  ds_read_b128 v[96:99], v21 offset:9216
  ds_read_b128 v[100:103], v21 offset:10240
  ds_read2st64_b64 v[104:107], v22 offset0:12 offset1:18
  ds_read2st64_b64 v[108:111], v23 offset0:12 offset1:18
  s_waitcnt lgkmcnt(0)
  s_barrier
  ds_write_b128 v20, v[192:195] offset:0
  ds_write_b128 v20, v[196:199] offset:1024
  ds_write_b128 v20, v[200:203] offset:2048
  ds_write_b128 v20, v[204:207] offset:12288
  ds_write_b128 v20, v[208:211] offset:13312
  ds_write_b128 v20, v[212:215] offset:14336
  ds_write_b128 v20, v[216:219] offset:24576
  ds_write_b128 v20, v[220:223] offset:25600
  ds_write_b128 v20, v[224:227] offset:26624
  ds_write_b128 v20, v[228:231] offset:36864
  ds_write_b128 v20, v[232:235] offset:37888
  ds_write_b128 v20, v[236:239] offset:38912
  s_waitcnt lgkmcnt(0)
  s_barrier
  s_cmp_eq_u32 s40, 0
  s_cbranch_scc1 qf_272
  s_mov_b32 s49, s43
  s_mov_b32 s50, s45
  s_mov_b32 s81, s47
  s_mov_b32 s82, s48
  s_add_u32 s43, s43, 4
  s_add_u32 s45, s45, 8388608
  s_add_u32 s47, s47, 2097152
  s_xor_b32 s47, s47, 8192
  s_add_u32 s48, s48, 512
  s_cmp_gt_u32 s49, 60
  s_cselect_b32 s23, 58, s49
  s_mov_b32 s101, 0
wm_275:
  buffer_load_dword v34, v30, s[72:75], s77 offen sc1
  s_add_u32 s101, s101, 1
  s_cmp_gt_u32 s101, 131072
  s_cbranch_scc1 main_end
  s_waitcnt vmcnt(0)
  v_cmp_gt_u32 vcc, s23, v34
  v_readfirstlane_b32 s100, v34
  s_nop 0
  s_cbranch_vccz wm_276
  s_sleep 4
  s_add_u32 s100, s100, 2
  s_cmp_ge_u32 s100, s23
  s_cbranch_scc1 wm_275
  s_sleep 40
  s_branch wm_275
wm_276:
  s_add_u32 s29, s50, 0
  buffer_load_dwordx4 v[112:115], v26, s[16:19], s29 offen offset:0 sc1
  buffer_load_dwordx4 v[116:119], v26, s[16:19], s29 offen offset:1024 sc1
  buffer_load_dwordx4 v[144:147], v26, s[16:19], s29 offen offset:2048 sc1
  s_add_u32 s29, s50, 16384
  buffer_load_dwordx4 v[120:123], v26, s[16:19], s29 offen offset:0 sc1
  buffer_load_dwordx4 v[124:127], v26, s[16:19], s29 offen offset:1024 sc1
  buffer_load_dwordx4 v[148:151], v26, s[16:19], s29 offen offset:2048 sc1
  s_add_u32 s29, s50, 32768
  buffer_load_dwordx4 v[128:131], v26, s[16:19], s29 offen offset:0 sc1
  buffer_load_dwordx4 v[132:135], v26, s[16:19], s29 offen offset:1024 sc1
  buffer_load_dwordx4 v[152:155], v26, s[16:19], s29 offen offset:2048 sc1
  s_add_u32 s29, s50, 49152
  buffer_load_dwordx4 v[136:139], v26, s[16:19], s29 offen offset:0 sc1
  buffer_load_dwordx4 v[140:143], v26, s[16:19], s29 offen offset:1024 sc1
  buffer_load_dwordx4 v[156:159], v26, s[16:19], s29 offen offset:2048 sc1
  s_waitcnt vmcnt(0) lgkmcnt(0)
  v_swap_b32 v146, v148
  v_swap_b32 v147, v149
  v_swap_b32 v154, v156
  v_swap_b32 v155, v157
  s_nop 1
  v_mfma_f32_16x16x32_bf16 v[36:39], v[112:115], v[64:67], 0
  v_mfma_f32_16x16x32_bf16 v[44:47], v[112:115], v[68:71], 0
  v_mfma_f32_16x16x32_bf16 v[48:51], v[116:119], v[68:71], 0
  v_mfma_f32_16x16x32_bf16 v[36:39], v[120:123], v[72:75], v[36:39]
  v_mfma_f32_16x16x32_bf16 v[44:47], v[120:123], v[76:79], v[44:47]
  v_mfma_f32_16x16x32_bf16 v[48:51], v[124:127], v[76:79], v[48:51]
  v_mfma_f32_16x16x32_bf16 v[36:39], v[144:147], v[80:83], v[36:39]
  v_mfma_f32_16x16x32_bf16 v[44:47], v[144:147], v[84:87], v[44:47]
  v_mfma_f32_16x16x32_bf16 v[48:51], v[148:151], v[84:87], v[48:51]
  v_mfma_f32_16x16x32_bf16 v[36:39], v[128:131], v[88:91], v[36:39]
  v_mfma_f32_16x16x32_bf16 v[44:47], v[128:131], v[92:95], v[44:47]
  v_mfma_f32_16x16x32_bf16 v[48:51], v[132:135], v[92:95], v[48:51]
  v_mfma_f32_16x16x32_bf16 v[36:39], v[136:139], v[96:99], v[36:39]
  v_mfma_f32_16x16x32_bf16 v[44:47], v[136:139], v[100:103], v[44:47]
  v_mfma_f32_16x16x32_bf16 v[48:51], v[140:143], v[100:103], v[48:51]
  v_mfma_f32_16x16x32_bf16 v[36:39], v[152:155], v[104:107], v[36:39]
  v_mfma_f32_16x16x32_bf16 v[44:47], v[152:155], v[108:111], v[44:47]
  v_mfma_f32_16x16x32_bf16 v[48:51], v[156:159], v[108:111], v[48:51]
  s_cmp_le_u32 s49, 60
  s_cbranch_scc1 qtp_279
  s_sub_u32 s23, s49, 1
  s_min_u32 s23, s23, 62
  s_mov_b32 s101, 0
wm_280:
  buffer_load_dword v34, v30, s[72:75], s77 offen sc1
  s_add_u32 s101, s101, 1
  s_cmp_gt_u32 s101, 131072
  s_cbranch_scc1 main_end
  s_waitcnt vmcnt(0)
  v_cmp_gt_u32 vcc, s23, v34
  v_readfirstlane_b32 s100, v34
  s_nop 0
  s_cbranch_vccz wm_281
  s_sleep 4
  s_add_u32 s100, s100, 2
  s_cmp_ge_u32 s100, s23
  s_cbranch_scc1 wm_280
  s_sleep 40
  s_branch wm_280
wm_281:
qtp_279:
  s_mov_b32 s101, 0
  s_branch qtp_278
qtp_277:
  s_sleep 2
qtp_278:
  s_add_u32 s29, s50, 4096
  buffer_load_dwordx4 v[160:163], v24, s[16:19], s29 offen offset:2560 sc1
  buffer_load_dwordx2 v[240:241], v25, s[16:19], s29 offen offset:3072 sc1
  s_add_u32 s29, s50, 20480
  buffer_load_dwordx4 v[164:167], v24, s[16:19], s29 offen offset:2560 sc1
  buffer_load_dwordx2 v[242:243], v25, s[16:19], s29 offen offset:3072 sc1
  s_add_u32 s29, s50, 36864
  buffer_load_dwordx4 v[168:171], v24, s[16:19], s29 offen offset:2560 sc1
  buffer_load_dwordx2 v[244:245], v25, s[16:19], s29 offen offset:3072 sc1
  s_add_u32 s29, s50, 53248
  buffer_load_dwordx4 v[172:175], v24, s[16:19], s29 offen offset:2560 sc1
  buffer_load_dwordx2 v[246:247], v25, s[16:19], s29 offen offset:3072 sc1
  s_add_u32 s101, s101, 1
  s_cmp_gt_u32 s101, 131072
  s_cbranch_scc1 main_end
  s_waitcnt vmcnt(0)
  v_max3_u32 v34, v160, v164, v168
  v_max3_u32 v34, v34, v172, v240
  v_max3_u32 v34, v34, v242, v244
  v_max_u32 v34, v34, v246
  v_cmp_eq_u32 vcc, -1, v34
  s_nop 1
  s_cbranch_vccnz qtp_277
  v_mfma_f32_16x16x32_bf16 v[40:43], v[160:163], v[64:67], 0
  v_mfma_f32_16x16x32_bf16 v[52:55], v[160:163], v[68:71], 0
  v_mfma_f32_16x16x32_bf16 v[40:43], v[164:167], v[72:75], v[40:43]
  v_mfma_f32_16x16x32_bf16 v[52:55], v[164:167], v[76:79], v[52:55]
  v_mfma_f32_16x16x32_bf16 v[40:43], v[240:243], v[80:83], v[40:43]
  v_mfma_f32_16x16x32_bf16 v[52:55], v[240:243], v[84:87], v[52:55]
  v_mfma_f32_16x16x32_bf16 v[40:43], v[168:171], v[88:91], v[40:43]
  v_mfma_f32_16x16x32_bf16 v[52:55], v[168:171], v[92:95], v[52:55]
  v_mfma_f32_16x16x32_bf16 v[40:43], v[172:175], v[96:99], v[40:43]
  v_mfma_f32_16x16x32_bf16 v[52:55], v[172:175], v[100:103], v[52:55]
  v_mfma_f32_16x16x32_bf16 v[40:43], v[244:247], v[104:107], v[40:43]
  v_mfma_f32_16x16x32_bf16 v[52:55], v[244:247], v[108:111], v[52:55]
  s_nop 4
  v_cndmask_b32 v36, v31, v36, s[64:65]
  v_cndmask_b32 v48, v31, v48, s[64:65]
  v_cndmask_b32 v37, v31, v37, s[66:67]
  v_cndmask_b32 v49, v31, v49, s[66:67]
  v_cndmask_b32 v38, v31, v38, s[68:69]
  v_cndmask_b32 v50, v31, v50, s[68:69]
  v_cndmask_b32 v39, v31, v39, s[70:71]
  v_cndmask_b32 v51, v31, v51, s[70:71]
  v_max3_f32 v34, v36, v37, v38
  v_max3_f32 v34, v34, v39, v40
  v_max3_f32 v34, v34, v41, v42
  v_max_f32 v34, v34, v43
  v_mov_b32 v35, v34
  s_nop 1
  v_permlane32_swap_b32 v34, v35
  v_max_f32 v34, v34, v35
  v_mov_b32 v35, v34
  s_nop 1
  v_permlane16_swap_b32 v34, v35
  v_max_f32 v34, v34, v35
  v_mul_f32 v34, s83, v34
  v_fma_f32 v36, v36, s83, -v34
  v_fma_f32 v37, v37, s83, -v34
  v_fma_f32 v38, v38, s83, -v34
  v_fma_f32 v39, v39, s83, -v34
  v_fma_f32 v40, v40, s83, -v34
  v_fma_f32 v41, v41, s83, -v34
  v_fma_f32 v42, v42, s83, -v34
  v_fma_f32 v43, v43, s83, -v34
  v_exp_f32 v36, v36
  v_exp_f32 v37, v37
  v_exp_f32 v38, v38
  v_exp_f32 v39, v39
  v_exp_f32 v40, v40
  v_exp_f32 v41, v41
  v_exp_f32 v42, v42
  v_exp_f32 v43, v43
  s_nop 0
  v_add_f32 v34, v40, v41
  v_add_f32 v34, v34, v42
  v_add_f32 v34, v34, v43
  v_cndmask_b32 v34, 0, v34, s[62:63]
  v_add_f32 v34, v34, v36
  v_add_f32 v34, v34, v37
  v_add_f32 v34, v34, v38
  v_add_f32 v34, v34, v39
  v_mov_b32 v35, v34
  s_nop 1
  v_permlane32_swap_b32 v34, v35
  v_add_f32 v34, v34, v35
  v_mov_b32 v35, v34
  s_nop 1
  v_permlane16_swap_b32 v34, v35
  v_add_f32 v34, v34, v35
  v_rcp_f32 v34, v34
  s_nop 0
  v_mul_f32 v36, v36, v34
  v_mul_f32 v37, v37, v34
  v_mul_f32 v38, v38, v34
  v_mul_f32 v39, v39, v34
  v_mul_f32 v40, v40, v34
  v_mul_f32 v41, v41, v34
  v_mul_f32 v42, v42, v34
  v_mul_f32 v43, v43, v34
  v_max3_f32 v34, v44, v45, v46
  v_max3_f32 v34, v34, v47, v48
  v_max3_f32 v34, v34, v49, v50
  v_max3_f32 v34, v34, v51, v52
  v_max3_f32 v34, v34, v53, v54
  v_max_f32 v34, v34, v55
  v_mov_b32 v35, v34
  s_nop 1
  v_permlane32_swap_b32 v34, v35
  v_max_f32 v34, v34, v35
  v_mov_b32 v35, v34
  s_nop 1
  v_permlane16_swap_b32 v34, v35
  v_max_f32 v34, v34, v35
  v_mul_f32 v34, s83, v34
  v_fma_f32 v44, v44, s83, -v34
  v_fma_f32 v45, v45, s83, -v34
  v_fma_f32 v46, v46, s83, -v34
  v_fma_f32 v47, v47, s83, -v34
  v_fma_f32 v48, v48, s83, -v34
  v_fma_f32 v49, v49, s83, -v34
  v_fma_f32 v50, v50, s83, -v34
  v_fma_f32 v51, v51, s83, -v34
  v_fma_f32 v52, v52, s83, -v34
  v_fma_f32 v53, v53, s83, -v34
  v_fma_f32 v54, v54, s83, -v34
  v_fma_f32 v55, v55, s83, -v34
  v_exp_f32 v44, v44
  v_exp_f32 v45, v45
  v_exp_f32 v46, v46
  v_exp_f32 v47, v47
  v_exp_f32 v48, v48
  v_exp_f32 v49, v49
  v_exp_f32 v50, v50
  v_exp_f32 v51, v51
  v_exp_f32 v52, v52
  v_exp_f32 v53, v53
  v_exp_f32 v54, v54
  v_exp_f32 v55, v55
  s_nop 0
  v_add_f32 v34, v52, v53
  v_add_f32 v34, v34, v54
  v_add_f32 v34, v34, v55
  v_cndmask_b32 v34, 0, v34, s[62:63]
  v_add_f32 v34, v34, v44
  v_add_f32 v34, v34, v45
  v_add_f32 v34, v34, v46
  v_add_f32 v34, v34, v47
  v_add_f32 v34, v34, v48
  v_add_f32 v34, v34, v49
  v_add_f32 v34, v34, v50
  v_add_f32 v34, v34, v51
  v_mov_b32 v35, v34
  s_nop 1
  v_permlane32_swap_b32 v34, v35
  v_add_f32 v34, v34, v35
  v_mov_b32 v35, v34
  s_nop 1
  v_permlane16_swap_b32 v34, v35
  v_add_f32 v34, v34, v35
  v_rcp_f32 v34, v34
  s_nop 0
  v_mul_f32 v44, v44, v34
  v_mul_f32 v45, v45, v34
  v_mul_f32 v46, v46, v34
  v_mul_f32 v47, v47, v34
  v_mul_f32 v48, v48, v34
  v_mul_f32 v49, v49, v34
  v_mul_f32 v50, v50, v34
  v_mul_f32 v51, v51, v34
  v_mul_f32 v52, v52, v34
  v_mul_f32 v53, v53, v34
  v_mul_f32 v54, v54, v34
  v_mul_f32 v55, v55, v34
  v_cvt_pk_bf16_f32 v56, v44, v45
  v_cvt_pk_bf16_f32 v57, v46, v47
  v_cvt_pk_bf16_f32 v58, v48, v49
  v_cvt_pk_bf16_f32 v59, v50, v51
  v_cvt_pk_bf16_f32 v60, v40, v41
  v_cvt_pk_bf16_f32 v61, v42, v43
  v_cvt_pk_bf16_f32 v62, v52, v53
  v_cvt_pk_bf16_f32 v63, v54, v55
  v_cvt_pk_bf16_f32 v248, v36, v37
  v_cvt_pk_bf16_f32 v249, v38, v39
  buffer_store_dwordx4 v[56:59], v26, s[16:19], s81 offen sc1
  buffer_store_dwordx4 v[60:63], v26, s[16:19], s81 offen offset:1024 sc1
  buffer_store_dwordx2 v[248:249], v29, s[16:19], s81 offen offset:2048 sc1
  s_mov_b32 s84, s82
qf_272:
  ds_read_b128 v[64:67], v21 offset:0
  ds_read_b128 v[68:71], v21 offset:1024
  ds_read_b128 v[72:75], v21 offset:3072
  ds_read_b128 v[76:79], v21 offset:4096
  ds_read2st64_b64 v[80:83], v22 offset0:0 offset1:6
  ds_read2st64_b64 v[84:87], v23 offset0:0 offset1:6
  ds_read_b128 v[88:91], v21 offset:6144
  ds_read_b128 v[92:95], v21 offset:7168
  ds_read_b128 v[96:99], v21 offset:9216
  ds_read_b128 v[100:103], v21 offset:10240
  ds_read2st64_b64 v[104:107], v22 offset0:12 offset1:18
  ds_read2st64_b64 v[108:111], v23 offset0:12 offset1:18
  s_waitcnt vmcnt(0)
  buffer_atomic_add v28, v33, s[72:75], s84 offen sc1
  s_mov_b32 s49, s43
  s_mov_b32 s50, s45
  s_mov_b32 s81, s47
  s_mov_b32 s82, s48
  s_add_u32 s43, s43, 4
  s_add_u32 s45, s45, 8388608
  s_add_u32 s47, s47, 2097152
  s_xor_b32 s47, s47, 8192
  s_add_u32 s48, s48, 512
  s_cmp_gt_u32 s49, 60
  s_cselect_b32 s23, 58, s49
  s_mov_b32 s101, 0
wm_282:
  buffer_load_dword v34, v30, s[72:75], s77 offen sc1
  s_add_u32 s101, s101, 1
  s_cmp_gt_u32 s101, 131072
  s_cbranch_scc1 main_end
  s_waitcnt vmcnt(0)
  v_cmp_gt_u32 vcc, s23, v34
  v_readfirstlane_b32 s100, v34
  s_nop 0
  s_cbranch_vccz wm_283
  s_sleep 4
  s_add_u32 s100, s100, 2
  s_cmp_ge_u32 s100, s23
  s_cbranch_scc1 wm_282
  s_sleep 40
  s_branch wm_282
wm_283:
  s_add_u32 s29, s50, 0
  buffer_load_dwordx4 v[112:115], v26, s[16:19], s29 offen offset:0 sc1
  buffer_load_dwordx4 v[116:119], v26, s[16:19], s29 offen offset:1024 sc1
  buffer_load_dwordx4 v[144:147], v26, s[16:19], s29 offen offset:2048 sc1
  s_add_u32 s29, s50, 16384
  buffer_load_dwordx4 v[120:123], v26, s[16:19], s29 offen offset:0 sc1
  buffer_load_dwordx4 v[124:127], v26, s[16:19], s29 offen offset:1024 sc1
  buffer_load_dwordx4 v[148:151], v26, s[16:19], s29 offen offset:2048 sc1
  s_add_u32 s29, s50, 32768
  buffer_load_dwordx4 v[128:131], v26, s[16:19], s29 offen offset:0 sc1
  buffer_load_dwordx4 v[132:135], v26, s[16:19], s29 offen offset:1024 sc1
  buffer_load_dwordx4 v[152:155], v26, s[16:19], s29 offen offset:2048 sc1
  s_add_u32 s29, s50, 49152
  buffer_load_dwordx4 v[136:139], v26, s[16:19], s29 offen offset:0 sc1
  buffer_load_dwordx4 v[140:143], v26, s[16:19], s29 offen offset:1024 sc1
  buffer_load_dwordx4 v[156:159], v26, s[16:19], s29 offen offset:2048 sc1
  s_waitcnt vmcnt(0) lgkmcnt(0)
  v_swap_b32 v146, v148
  v_swap_b32 v147, v149
  v_swap_b32 v154, v156
  v_swap_b32 v155, v157
  s_nop 1
  v_mfma_f32_16x16x32_bf16 v[36:39], v[112:115], v[64:67], 0
  v_mfma_f32_16x16x32_bf16 v[44:47], v[112:115], v[68:71], 0
  v_mfma_f32_16x16x32_bf16 v[48:51], v[116:119], v[68:71], 0
  v_mfma_f32_16x16x32_bf16 v[36:39], v[120:123], v[72:75], v[36:39]
  v_mfma_f32_16x16x32_bf16 v[44:47], v[120:123], v[76:79], v[44:47]
  v_mfma_f32_16x16x32_bf16 v[48:51], v[124:127], v[76:79], v[48:51]
  v_mfma_f32_16x16x32_bf16 v[36:39], v[144:147], v[80:83], v[36:39]
  v_mfma_f32_16x16x32_bf16 v[44:47], v[144:147], v[84:87], v[44:47]
  v_mfma_f32_16x16x32_bf16 v[48:51], v[148:151], v[84:87], v[48:51]
  v_mfma_f32_16x16x32_bf16 v[36:39], v[128:131], v[88:91], v[36:39]
  v_mfma_f32_16x16x32_bf16 v[44:47], v[128:131], v[92:95], v[44:47]
  v_mfma_f32_16x16x32_bf16 v[48:51], v[132:135], v[92:95], v[48:51]
  v_mfma_f32_16x16x32_bf16 v[36:39], v[136:139], v[96:99], v[36:39]
  v_mfma_f32_16x16x32_bf16 v[44:47], v[136:139], v[100:103], v[44:47]
  v_mfma_f32_16x16x32_bf16 v[48:51], v[140:143], v[100:103], v[48:51]
  v_mfma_f32_16x16x32_bf16 v[36:39], v[152:155], v[104:107], v[36:39]
  v_mfma_f32_16x16x32_bf16 v[44:47], v[152:155], v[108:111], v[44:47]
  v_mfma_f32_16x16x32_bf16 v[48:51], v[156:159], v[108:111], v[48:51]
  s_cmp_le_u32 s49, 60
  s_cbranch_scc1 qtp_286
  s_sub_u32 s23, s49, 1
  s_min_u32 s23, s23, 62
  s_mov_b32 s101, 0
wm_287:
  buffer_load_dword v34, v30, s[72:75], s77 offen sc1
  s_add_u32 s101, s101, 1
  s_cmp_gt_u32 s101, 131072
  s_cbranch_scc1 main_end
  s_waitcnt vmcnt(0)
  v_cmp_gt_u32 vcc, s23, v34
  v_readfirstlane_b32 s100, v34
  s_nop 0
  s_cbranch_vccz wm_288
  s_sleep 4
  s_add_u32 s100, s100, 2
  s_cmp_ge_u32 s100, s23
  s_cbranch_scc1 wm_287
  s_sleep 40
  s_branch wm_287
wm_288:
qtp_286:
  s_mov_b32 s101, 0
  s_branch qtp_285
qtp_284:
  s_sleep 2
qtp_285:
  s_add_u32 s29, s50, 4096
  buffer_load_dwordx4 v[160:163], v24, s[16:19], s29 offen offset:2560 sc1
  buffer_load_dwordx2 v[240:241], v25, s[16:19], s29 offen offset:3072 sc1
  s_add_u32 s29, s50, 20480
  buffer_load_dwordx4 v[164:167], v24, s[16:19], s29 offen offset:2560 sc1
  buffer_load_dwordx2 v[242:243], v25, s[16:19], s29 offen offset:3072 sc1
  s_add_u32 s29, s50, 36864
  buffer_load_dwordx4 v[168:171], v24, s[16:19], s29 offen offset:2560 sc1
  buffer_load_dwordx2 v[244:245], v25, s[16:19], s29 offen offset:3072 sc1
  s_add_u32 s29, s50, 53248
  buffer_load_dwordx4 v[172:175], v24, s[16:19], s29 offen offset:2560 sc1
  buffer_load_dwordx2 v[246:247], v25, s[16:19], s29 offen offset:3072 sc1
  s_add_u32 s101, s101, 1
  s_cmp_gt_u32 s101, 131072
  s_cbranch_scc1 main_end
  s_waitcnt vmcnt(0)
  v_max3_u32 v34, v160, v164, v168
  v_max3_u32 v34, v34, v172, v240
  v_max3_u32 v34, v34, v242, v244
  v_max_u32 v34, v34, v246
  v_cmp_eq_u32 vcc, -1, v34
  s_nop 1
  s_cbranch_vccnz qtp_284
  v_mfma_f32_16x16x32_bf16 v[40:43], v[160:163], v[64:67], 0
  v_mfma_f32_16x16x32_bf16 v[52:55], v[160:163], v[68:71], 0
  v_mfma_f32_16x16x32_bf16 v[40:43], v[164:167], v[72:75], v[40:43]
  v_mfma_f32_16x16x32_bf16 v[52:55], v[164:167], v[76:79], v[52:55]
  v_mfma_f32_16x16x32_bf16 v[40:43], v[240:243], v[80:83], v[40:43]
  v_mfma_f32_16x16x32_bf16 v[52:55], v[240:243], v[84:87], v[52:55]
  v_mfma_f32_16x16x32_bf16 v[40:43], v[168:171], v[88:91], v[40:43]
  v_mfma_f32_16x16x32_bf16 v[52:55], v[168:171], v[92:95], v[52:55]
  v_mfma_f32_16x16x32_bf16 v[40:43], v[172:175], v[96:99], v[40:43]
  v_mfma_f32_16x16x32_bf16 v[52:55], v[172:175], v[100:103], v[52:55]
  v_mfma_f32_16x16x32_bf16 v[40:43], v[244:247], v[104:107], v[40:43]
  v_mfma_f32_16x16x32_bf16 v[52:55], v[244:247], v[108:111], v[52:55]
  s_nop 4
  v_cndmask_b32 v36, v31, v36, s[64:65]
  v_cndmask_b32 v48, v31, v48, s[64:65]
  v_cndmask_b32 v37, v31, v37, s[66:67]
  v_cndmask_b32 v49, v31, v49, s[66:67]
  v_cndmask_b32 v38, v31, v38, s[68:69]
  v_cndmask_b32 v50, v31, v50, s[68:69]
  v_cndmask_b32 v39, v31, v39, s[70:71]
  v_cndmask_b32 v51, v31, v51, s[70:71]
  v_max3_f32 v34, v36, v37, v38
  v_max3_f32 v34, v34, v39, v40
  v_max3_f32 v34, v34, v41, v42
  v_max_f32 v34, v34, v43
  v_mov_b32 v35, v34
  s_nop 1
  v_permlane32_swap_b32 v34, v35
  v_max_f32 v34, v34, v35
  v_mov_b32 v35, v34
  s_nop 1
  v_permlane16_swap_b32 v34, v35
  v_max_f32 v34, v34, v35
  v_mul_f32 v34, s83, v34
  v_fma_f32 v36, v36, s83, -v34
  v_fma_f32 v37, v37, s83, -v34
  v_fma_f32 v38, v38, s83, -v34
  v_fma_f32 v39, v39, s83, -v34
  v_fma_f32 v40, v40, s83, -v34
  v_fma_f32 v41, v41, s83, -v34
  v_fma_f32 v42, v42, s83, -v34
  v_fma_f32 v43, v43, s83, -v34
  v_exp_f32 v36, v36
  v_exp_f32 v37, v37
  v_exp_f32 v38, v38
  v_exp_f32 v39, v39
  v_exp_f32 v40, v40
  v_exp_f32 v41, v41
  v_exp_f32 v42, v42
  v_exp_f32 v43, v43
  s_nop 0
  v_add_f32 v34, v40, v41
  v_add_f32 v34, v34, v42
  v_add_f32 v34, v34, v43
  v_cndmask_b32 v34, 0, v34, s[62:63]
  v_add_f32 v34, v34, v36
  v_add_f32 v34, v34, v37
  v_add_f32 v34, v34, v38
  v_add_f32 v34, v34, v39
  v_mov_b32 v35, v34
  s_nop 1
  v_permlane32_swap_b32 v34, v35
  v_add_f32 v34, v34, v35
  v_mov_b32 v35, v34
  s_nop 1
  v_permlane16_swap_b32 v34, v35
  v_add_f32 v34, v34, v35
  v_rcp_f32 v34, v34
  s_nop 0
  v_mul_f32 v36, v36, v34
  v_mul_f32 v37, v37, v34
  v_mul_f32 v38, v38, v34
  v_mul_f32 v39, v39, v34
  v_mul_f32 v40, v40, v34
  v_mul_f32 v41, v41, v34
  v_mul_f32 v42, v42, v34
  v_mul_f32 v43, v43, v34
  v_max3_f32 v34, v44, v45, v46
  v_max3_f32 v34, v34, v47, v48
  v_max3_f32 v34, v34, v49, v50
  v_max3_f32 v34, v34, v51, v52
  v_max3_f32 v34, v34, v53, v54
  v_max_f32 v34, v34, v55
  v_mov_b32 v35, v34
  s_nop 1
  v_permlane32_swap_b32 v34, v35
  v_max_f32 v34, v34, v35
  v_mov_b32 v35, v34
  s_nop 1
  v_permlane16_swap_b32 v34, v35
  v_max_f32 v34, v34, v35
  v_mul_f32 v34, s83, v34
  v_fma_f32 v44, v44, s83, -v34
  v_fma_f32 v45, v45, s83, -v34
  v_fma_f32 v46, v46, s83, -v34
  v_fma_f32 v47, v47, s83, -v34
  v_fma_f32 v48, v48, s83, -v34
  v_fma_f32 v49, v49, s83, -v34
  v_fma_f32 v50, v50, s83, -v34
  v_fma_f32 v51, v51, s83, -v34
  v_fma_f32 v52, v52, s83, -v34
  v_fma_f32 v53, v53, s83, -v34
  v_fma_f32 v54, v54, s83, -v34
  v_fma_f32 v55, v55, s83, -v34
  v_exp_f32 v44, v44
  v_exp_f32 v45, v45
  v_exp_f32 v46, v46
  v_exp_f32 v47, v47
  v_exp_f32 v48, v48
  v_exp_f32 v49, v49
  v_exp_f32 v50, v50
  v_exp_f32 v51, v51
  v_exp_f32 v52, v52
  v_exp_f32 v53, v53
  v_exp_f32 v54, v54
  v_exp_f32 v55, v55
  s_nop 0
  v_add_f32 v34, v52, v53
  v_add_f32 v34, v34, v54
  v_add_f32 v34, v34, v55
  v_cndmask_b32 v34, 0, v34, s[62:63]
  v_add_f32 v34, v34, v44
  v_add_f32 v34, v34, v45
  v_add_f32 v34, v34, v46
  v_add_f32 v34, v34, v47
  v_add_f32 v34, v34, v48
  v_add_f32 v34, v34, v49
  v_add_f32 v34, v34, v50
  v_add_f32 v34, v34, v51
  v_mov_b32 v35, v34
  s_nop 1
  v_permlane32_swap_b32 v34, v35
  v_add_f32 v34, v34, v35
  v_mov_b32 v35, v34
  s_nop 1
  v_permlane16_swap_b32 v34, v35
  v_add_f32 v34, v34, v35
  v_rcp_f32 v34, v34
  s_nop 0
  v_mul_f32 v44, v44, v34
  v_mul_f32 v45, v45, v34
  v_mul_f32 v46, v46, v34
  v_mul_f32 v47, v47, v34
  v_mul_f32 v48, v48, v34
  v_mul_f32 v49, v49, v34
  v_mul_f32 v50, v50, v34
  v_mul_f32 v51, v51, v34
  v_mul_f32 v52, v52, v34
  v_mul_f32 v53, v53, v34
  v_mul_f32 v54, v54, v34
  v_mul_f32 v55, v55, v34
  v_cvt_pk_bf16_f32 v56, v44, v45
  v_cvt_pk_bf16_f32 v57, v46, v47
  v_cvt_pk_bf16_f32 v58, v48, v49
  v_cvt_pk_bf16_f32 v59, v50, v51
  v_cvt_pk_bf16_f32 v60, v40, v41
  v_cvt_pk_bf16_f32 v61, v42, v43
  v_cvt_pk_bf16_f32 v62, v52, v53
  v_cvt_pk_bf16_f32 v63, v54, v55
  v_cvt_pk_bf16_f32 v248, v36, v37
  v_cvt_pk_bf16_f32 v249, v38, v39
  buffer_store_dwordx4 v[56:59], v26, s[16:19], s81 offen sc1
  buffer_store_dwordx4 v[60:63], v26, s[16:19], s81 offen offset:1024 sc1
  buffer_store_dwordx2 v[248:249], v29, s[16:19], s81 offen offset:2048 sc1
  s_mov_b32 s84, s82
qf_273:
  s_cmp_eq_u32 s91, 0
  s_cbranch_scc1 qf_274
  s_sub_u32 s91, s91, 1
  s_mul_i32 s21, s20, 12288
  s_add_u32 s21, s21, s86
  s_add_u32 s86, s86, 49152
  buffer_load_dwordx4 v[64:67], v26, s[56:59], s21 offen offset:0 sc1
  buffer_load_dwordx4 v[68:71], v26, s[56:59], s21 offen offset:1024 sc1
  buffer_load_dwordx4 v[96:99], v26, s[56:59], s21 offen offset:2048 sc1
  s_add_u32 s21, s21, 3072
  buffer_load_dwordx4 v[72:75], v26, s[56:59], s21 offen offset:0 sc1
  buffer_load_dwordx4 v[76:79], v26, s[56:59], s21 offen offset:1024 sc1
  buffer_load_dwordx4 v[100:103], v26, s[56:59], s21 offen offset:2048 sc1
  s_add_u32 s21, s21, 3072
  buffer_load_dwordx4 v[80:83], v26, s[56:59], s21 offen offset:0 sc1
  buffer_load_dwordx4 v[84:87], v26, s[56:59], s21 offen offset:1024 sc1
  buffer_load_dwordx4 v[104:107], v26, s[56:59], s21 offen offset:2048 sc1
  s_add_u32 s21, s21, 3072
  buffer_load_dwordx4 v[88:91], v26, s[56:59], s21 offen offset:0 sc1
  buffer_load_dwordx4 v[92:95], v26, s[56:59], s21 offen offset:1024 sc1
  buffer_load_dwordx4 v[108:111], v26, s[56:59], s21 offen offset:2048 sc1
  s_add_u32 s21, s21, 3072
  s_waitcnt vmcnt(0)
  buffer_atomic_add v28, v33, s[72:75], s84 offen sc1
  s_mov_b32 s49, s43
  s_mov_b32 s50, s45
  s_mov_b32 s81, s47
  s_mov_b32 s82, s48
  s_add_u32 s43, s43, 4
  s_add_u32 s45, s45, 8388608
  s_add_u32 s47, s47, 2097152
  s_xor_b32 s47, s47, 8192
  s_add_u32 s48, s48, 512
  s_cmp_gt_u32 s49, 60
  s_cselect_b32 s23, 58, s49
  s_mov_b32 s101, 0
wm_289:
  buffer_load_dword v34, v30, s[72:75], s77 offen sc1
  s_add_u32 s101, s101, 1
  s_cmp_gt_u32 s101, 131072
  s_cbranch_scc1 main_end
  s_waitcnt vmcnt(0)
  v_cmp_gt_u32 vcc, s23, v34
  v_readfirstlane_b32 s100, v34
  s_nop 0
  s_cbranch_vccz wm_290
  s_sleep 4
  s_add_u32 s100, s100, 2
  s_cmp_ge_u32 s100, s23
  s_cbranch_scc1 wm_289
  s_sleep 40
  s_branch wm_289
wm_290:
  s_add_u32 s29, s50, 0
  buffer_load_dwordx4 v[112:115], v26, s[16:19], s29 offen offset:0 sc1
  buffer_load_dwordx4 v[116:119], v26, s[16:19], s29 offen offset:1024 sc1
  buffer_load_dwordx4 v[144:147], v26, s[16:19], s29 offen offset:2048 sc1
  s_add_u32 s29, s50, 16384
  buffer_load_dwordx4 v[120:123], v26, s[16:19], s29 offen offset:0 sc1
  buffer_load_dwordx4 v[124:127], v26, s[16:19], s29 offen offset:1024 sc1
  buffer_load_dwordx4 v[148:151], v26, s[16:19], s29 offen offset:2048 sc1
  s_add_u32 s29, s50, 32768
  buffer_load_dwordx4 v[128:131], v26, s[16:19], s29 offen offset:0 sc1
  buffer_load_dwordx4 v[132:135], v26, s[16:19], s29 offen offset:1024 sc1
  buffer_load_dwordx4 v[152:155], v26, s[16:19], s29 offen offset:2048 sc1
  s_add_u32 s29, s50, 49152
  buffer_load_dwordx4 v[136:139], v26, s[16:19], s29 offen offset:0 sc1
  buffer_load_dwordx4 v[140:143], v26, s[16:19], s29 offen offset:1024 sc1
  buffer_load_dwordx4 v[156:159], v26, s[16:19], s29 offen offset:2048 sc1
  s_waitcnt vmcnt(0) lgkmcnt(0)
  v_swap_b32 v98, v100
  v_swap_b32 v99, v101
  v_swap_b32 v106, v108
  v_swap_b32 v107, v109
  v_swap_b32 v146, v148
  v_swap_b32 v147, v149
  v_swap_b32 v154, v156
  v_swap_b32 v155, v157
  s_nop 1
  v_mfma_f32_16x16x32_bf16 v[36:39], v[112:115], v[64:67], 0
  v_mfma_f32_16x16x32_bf16 v[44:47], v[112:115], v[68:71], 0
  v_mfma_f32_16x16x32_bf16 v[48:51], v[116:119], v[68:71], 0
  v_mfma_f32_16x16x32_bf16 v[36:39], v[120:123], v[72:75], v[36:39]
  v_mfma_f32_16x16x32_bf16 v[44:47], v[120:123], v[76:79], v[44:47]
  v_mfma_f32_16x16x32_bf16 v[48:51], v[124:127], v[76:79], v[48:51]
  v_mfma_f32_16x16x32_bf16 v[36:39], v[144:147], v[96:99], v[36:39]
  v_mfma_f32_16x16x32_bf16 v[44:47], v[144:147], v[100:103], v[44:47]
  v_mfma_f32_16x16x32_bf16 v[48:51], v[148:151], v[100:103], v[48:51]
  v_mfma_f32_16x16x32_bf16 v[36:39], v[128:131], v[80:83], v[36:39]
  v_mfma_f32_16x16x32_bf16 v[44:47], v[128:131], v[84:87], v[44:47]
  v_mfma_f32_16x16x32_bf16 v[48:51], v[132:135], v[84:87], v[48:51]
  v_mfma_f32_16x16x32_bf16 v[36:39], v[136:139], v[88:91], v[36:39]
  v_mfma_f32_16x16x32_bf16 v[44:47], v[136:139], v[92:95], v[44:47]
  v_mfma_f32_16x16x32_bf16 v[48:51], v[140:143], v[92:95], v[48:51]
  v_mfma_f32_16x16x32_bf16 v[36:39], v[152:155], v[104:107], v[36:39]
  v_mfma_f32_16x16x32_bf16 v[44:47], v[152:155], v[108:111], v[44:47]
  v_mfma_f32_16x16x32_bf16 v[48:51], v[156:159], v[108:111], v[48:51]
  s_cmp_le_u32 s49, 60
  s_cbranch_scc1 qtp_293
  s_sub_u32 s23, s49, 1
  s_min_u32 s23, s23, 62
  s_mov_b32 s101, 0
wm_294:
  buffer_load_dword v34, v30, s[72:75], s77 offen sc1
  s_add_u32 s101, s101, 1
  s_cmp_gt_u32 s101, 131072
  s_cbranch_scc1 main_end
  s_waitcnt vmcnt(0)
  v_cmp_gt_u32 vcc, s23, v34
  v_readfirstlane_b32 s100, v34
  s_nop 0
  s_cbranch_vccz wm_295
  s_sleep 4
  s_add_u32 s100, s100, 2
  s_cmp_ge_u32 s100, s23
  s_cbranch_scc1 wm_294
  s_sleep 40
  s_branch wm_294
wm_295:
qtp_293:
  s_mov_b32 s101, 0
  s_branch qtp_292
qtp_291:
  s_sleep 2
qtp_292:
  s_add_u32 s29, s50, 4096
  buffer_load_dwordx4 v[160:163], v24, s[16:19], s29 offen offset:2560 sc1
  buffer_load_dwordx2 v[240:241], v25, s[16:19], s29 offen offset:3072 sc1
  s_add_u32 s29, s50, 20480
  buffer_load_dwordx4 v[164:167], v24, s[16:19], s29 offen offset:2560 sc1
  buffer_load_dwordx2 v[242:243], v25, s[16:19], s29 offen offset:3072 sc1
  s_add_u32 s29, s50, 36864
  buffer_load_dwordx4 v[168:171], v24, s[16:19], s29 offen offset:2560 sc1
  buffer_load_dwordx2 v[244:245], v25, s[16:19], s29 offen offset:3072 sc1
  s_add_u32 s29, s50, 53248
  buffer_load_dwordx4 v[172:175], v24, s[16:19], s29 offen offset:2560 sc1
  buffer_load_dwordx2 v[246:247], v25, s[16:19], s29 offen offset:3072 sc1
  s_add_u32 s101, s101, 1
  s_cmp_gt_u32 s101, 131072
  s_cbranch_scc1 main_end
  s_waitcnt vmcnt(0)
  v_max3_u32 v34, v160, v164, v168
  v_max3_u32 v34, v34, v172, v240
  v_max3_u32 v34, v34, v242, v244
  v_max_u32 v34, v34, v246
  v_cmp_eq_u32 vcc, -1, v34
  s_nop 1
  s_cbranch_vccnz qtp_291
  v_mfma_f32_16x16x32_bf16 v[40:43], v[160:163], v[64:67], 0
  v_mfma_f32_16x16x32_bf16 v[52:55], v[160:163], v[68:71], 0
  v_mfma_f32_16x16x32_bf16 v[40:43], v[164:167], v[72:75], v[40:43]
  v_mfma_f32_16x16x32_bf16 v[52:55], v[164:167], v[76:79], v[52:55]
  v_mfma_f32_16x16x32_bf16 v[40:43], v[240:243], v[96:99], v[40:43]
  v_mfma_f32_16x16x32_bf16 v[52:55], v[240:243], v[100:103], v[52:55]
  v_mfma_f32_16x16x32_bf16 v[40:43], v[168:171], v[80:83], v[40:43]
  v_mfma_f32_16x16x32_bf16 v[52:55], v[168:171], v[84:87], v[52:55]
  v_mfma_f32_16x16x32_bf16 v[40:43], v[172:175], v[88:91], v[40:43]
  v_mfma_f32_16x16x32_bf16 v[52:55], v[172:175], v[92:95], v[52:55]
  v_mfma_f32_16x16x32_bf16 v[40:43], v[244:247], v[104:107], v[40:43]
  v_mfma_f32_16x16x32_bf16 v[52:55], v[244:247], v[108:111], v[52:55]
  s_nop 4
  v_cndmask_b32 v36, v31, v36, s[64:65]
  v_cndmask_b32 v48, v31, v48, s[64:65]
  v_cndmask_b32 v37, v31, v37, s[66:67]
  v_cndmask_b32 v49, v31, v49, s[66:67]
  v_cndmask_b32 v38, v31, v38, s[68:69]
  v_cndmask_b32 v50, v31, v50, s[68:69]
  v_cndmask_b32 v39, v31, v39, s[70:71]
  v_cndmask_b32 v51, v31, v51, s[70:71]
  v_max3_f32 v34, v36, v37, v38
  v_max3_f32 v34, v34, v39, v40
  v_max3_f32 v34, v34, v41, v42
  v_max_f32 v34, v34, v43
  v_mov_b32 v35, v34
  s_nop 1
  v_permlane32_swap_b32 v34, v35
  v_max_f32 v34, v34, v35
  v_mov_b32 v35, v34
  s_nop 1
  v_permlane16_swap_b32 v34, v35
  v_max_f32 v34, v34, v35
  v_mul_f32 v34, s83, v34
  v_fma_f32 v36, v36, s83, -v34
  v_fma_f32 v37, v37, s83, -v34
  v_fma_f32 v38, v38, s83, -v34
  v_fma_f32 v39, v39, s83, -v34
  v_fma_f32 v40, v40, s83, -v34
  v_fma_f32 v41, v41, s83, -v34
  v_fma_f32 v42, v42, s83, -v34
  v_fma_f32 v43, v43, s83, -v34
  v_exp_f32 v36, v36
  v_exp_f32 v37, v37
  v_exp_f32 v38, v38
  v_exp_f32 v39, v39
  v_exp_f32 v40, v40
  v_exp_f32 v41, v41
  v_exp_f32 v42, v42
  v_exp_f32 v43, v43
  s_nop 0
  v_add_f32 v34, v40, v41
  v_add_f32 v34, v34, v42
  v_add_f32 v34, v34, v43
  v_cndmask_b32 v34, 0, v34, s[62:63]
  v_add_f32 v34, v34, v36
  v_add_f32 v34, v34, v37
  v_add_f32 v34, v34, v38
  v_add_f32 v34, v34, v39
  v_mov_b32 v35, v34
  s_nop 1
  v_permlane32_swap_b32 v34, v35
  v_add_f32 v34, v34, v35
  v_mov_b32 v35, v34
  s_nop 1
  v_permlane16_swap_b32 v34, v35
  v_add_f32 v34, v34, v35
  v_rcp_f32 v34, v34
  s_nop 0
  v_mul_f32 v36, v36, v34
  v_mul_f32 v37, v37, v34
  v_mul_f32 v38, v38, v34
  v_mul_f32 v39, v39, v34
  v_mul_f32 v40, v40, v34
  v_mul_f32 v41, v41, v34
  v_mul_f32 v42, v42, v34
  v_mul_f32 v43, v43, v34
  v_max3_f32 v34, v44, v45, v46
  v_max3_f32 v34, v34, v47, v48
  v_max3_f32 v34, v34, v49, v50
  v_max3_f32 v34, v34, v51, v52
  v_max3_f32 v34, v34, v53, v54
  v_max_f32 v34, v34, v55
  v_mov_b32 v35, v34
  s_nop 1
  v_permlane32_swap_b32 v34, v35
  v_max_f32 v34, v34, v35
  v_mov_b32 v35, v34
  s_nop 1
  v_permlane16_swap_b32 v34, v35
  v_max_f32 v34, v34, v35
  v_mul_f32 v34, s83, v34
  v_fma_f32 v44, v44, s83, -v34
  v_fma_f32 v45, v45, s83, -v34
  v_fma_f32 v46, v46, s83, -v34
  v_fma_f32 v47, v47, s83, -v34
  v_fma_f32 v48, v48, s83, -v34
  v_fma_f32 v49, v49, s83, -v34
  v_fma_f32 v50, v50, s83, -v34
  v_fma_f32 v51, v51, s83, -v34
  v_fma_f32 v52, v52, s83, -v34
  v_fma_f32 v53, v53, s83, -v34
  v_fma_f32 v54, v54, s83, -v34
  v_fma_f32 v55, v55, s83, -v34
  v_exp_f32 v44, v44
  v_exp_f32 v45, v45
  v_exp_f32 v46, v46
  v_exp_f32 v47, v47
  v_exp_f32 v48, v48
  v_exp_f32 v49, v49
  v_exp_f32 v50, v50
  v_exp_f32 v51, v51
  v_exp_f32 v52, v52
  v_exp_f32 v53, v53
  v_exp_f32 v54, v54
  v_exp_f32 v55, v55
  s_nop 0
  v_add_f32 v34, v52, v53
  v_add_f32 v34, v34, v54
  v_add_f32 v34, v34, v55
  v_cndmask_b32 v34, 0, v34, s[62:63]
  v_add_f32 v34, v34, v44
  v_add_f32 v34, v34, v45
  v_add_f32 v34, v34, v46
  v_add_f32 v34, v34, v47
  v_add_f32 v34, v34, v48
  v_add_f32 v34, v34, v49
  v_add_f32 v34, v34, v50
  v_add_f32 v34, v34, v51
  v_mov_b32 v35, v34
  s_nop 1
  v_permlane32_swap_b32 v34, v35
  v_add_f32 v34, v34, v35
  v_mov_b32 v35, v34
  s_nop 1
  v_permlane16_swap_b32 v34, v35
  v_add_f32 v34, v34, v35
  v_rcp_f32 v34, v34
  s_nop 0
  v_mul_f32 v44, v44, v34
  v_mul_f32 v45, v45, v34
  v_mul_f32 v46, v46, v34
  v_mul_f32 v47, v47, v34
  v_mul_f32 v48, v48, v34
  v_mul_f32 v49, v49, v34
  v_mul_f32 v50, v50, v34
  v_mul_f32 v51, v51, v34
  v_mul_f32 v52, v52, v34
  v_mul_f32 v53, v53, v34
  v_mul_f32 v54, v54, v34
  v_mul_f32 v55, v55, v34
  v_cvt_pk_bf16_f32 v56, v44, v45
  v_cvt_pk_bf16_f32 v57, v46, v47
  v_cvt_pk_bf16_f32 v58, v48, v49
  v_cvt_pk_bf16_f32 v59, v50, v51
  v_cvt_pk_bf16_f32 v60, v40, v41
  v_cvt_pk_bf16_f32 v61, v42, v43
  v_cvt_pk_bf16_f32 v62, v52, v53
  v_cvt_pk_bf16_f32 v63, v54, v55
  v_cvt_pk_bf16_f32 v248, v36, v37
  v_cvt_pk_bf16_f32 v249, v38, v39
  buffer_store_dwordx4 v[56:59], v26, s[16:19], s81 offen sc1
  buffer_store_dwordx4 v[60:63], v26, s[16:19], s81 offen offset:1024 sc1
  buffer_store_dwordx2 v[248:249], v29, s[16:19], s81 offen offset:2048 sc1
  s_mov_b32 s84, s82
  s_branch qf_273
qf_274:
  s_waitcnt vmcnt(0)
  buffer_atomic_add v28, v33, s[72:75], s82 offen sc1
  s_branch qe_296
qw_270:
  s_mov_b32 s101, 0
wm_297:
  buffer_load_dword v32, v30, s[72:75], s77 offen sc1
  s_add_u32 s101, s101, 1
  s_cmp_gt_u32 s101, 131072
  s_cbranch_scc1 main_end
  s_waitcnt vmcnt(0)
  v_cmp_gt_u32 vcc, s49, v32
  v_readfirstlane_b32 s100, v32
  s_nop 0
  s_cbranch_vccz wm_298
  s_sleep 4
  s_add_u32 s100, s100, 2
  s_cmp_ge_u32 s100, s49
  s_cbranch_scc1 wm_297
  s_sleep 60
  s_branch wm_297
wm_298:
  s_branch qj_271
qa2_265:
  s_mov_b32 s49, 0
  s_mov_b32 s50, 1073741824
  s_mov_b32 s81, 1073741824
  s_mov_b32 s82, 1073741824
  s_branch qa3_266
qs_267:
  s_mul_i32 s21, s20, 3072
  s_add_u32 s21, s21, s86
  buffer_store_dwordx4 v[192:195], v26, s[56:59], s21 offen offset:0 sc1
  buffer_store_dwordx4 v[196:199], v26, s[56:59], s21 offen offset:1024 sc1
  buffer_store_dwordx4 v[200:203], v26, s[56:59], s21 offen offset:2048 sc1
  s_add_u32 s21, s21, 12288
  buffer_store_dwordx4 v[204:207], v26, s[56:59], s21 offen offset:0 sc1
  buffer_store_dwordx4 v[208:211], v26, s[56:59], s21 offen offset:1024 sc1
  buffer_store_dwordx4 v[212:215], v26, s[56:59], s21 offen offset:2048 sc1
  s_add_u32 s21, s21, 12288
  buffer_store_dwordx4 v[216:219], v26, s[56:59], s21 offen offset:0 sc1
  buffer_store_dwordx4 v[220:223], v26, s[56:59], s21 offen offset:1024 sc1
  buffer_store_dwordx4 v[224:227], v26, s[56:59], s21 offen offset:2048 sc1
  s_add_u32 s21, s21, 12288
  buffer_store_dwordx4 v[228:231], v26, s[56:59], s21 offen offset:0 sc1
  buffer_store_dwordx4 v[232:235], v26, s[56:59], s21 offen offset:1024 sc1
  buffer_store_dwordx4 v[236:239], v26, s[56:59], s21 offen offset:2048 sc1
  s_add_u32 s21, s21, 12288
  s_add_u32 s86, s86, 49152
  s_branch qs_268
qe_296:
queue:
  s_mov_b32 s87, 16
  s_mov_b32 s88, 0
queue2:
  s_load_dwordx2 s[4:5], s[0:1], 88
  s_load_dwordx2 s[38:39], s[0:1], 104
  s_lshr_b32 s58, s3, 4
  s_bfe_u32 s21, s3, 0x20003
  s_cmp_lt_u32 s3, 64
  s_cselect_b32 s58, s58, s21
  s_cselect_b32 s21, 1, 0
  s_lshr_b32 s41, s3, s21
  s_and_b32 s41, s41, 7
  s_lshl_b32 s59, s58, 3
  s_add_u32 s59, s59, s41
  s_lshl_b32 s59, s59, 7
  s_add_u32 s59, s59, 40960
  s_xor_b32 s59, s59, s80
  s_waitcnt vmcnt(0) lgkmcnt(0)
  s_barrier
  s_mov_b32 s8, s4
  s_mov_b32 s9, s5
  s_mov_b32 s10, 2621440
  s_mov_b32 s11, 0x00020000
  s_add_u32 s12, s38, 180355072
  s_addc_u32 s13, s39, 0
  s_mov_b32 s14, 4194304
  s_mov_b32 s15, 0x00020000
  s_mov_b32 s16, s38
  s_mov_b32 s17, s39
  s_mov_b32 s18, 218103808
  s_mov_b32 s19, 0x00020000
  s_add_u32 s28, s38, 175112192
  s_addc_u32 s29, s39, 0
  s_mov_b32 s30, 8192
  s_mov_b32 s31, 0x00020000
  s_add_u32 s72, s38, 173080576
  s_addc_u32 s73, s39, 0
  s_mov_b32 s74, 49152
  s_mov_b32 s75, 0x00020000
  v_mov_b32 v30, 102400
  v_mov_b32 v233, 0x40000000
  v_cmp_eq_u32 vcc, 0, v0
  v_and_b32 v7, 7, v1
  v_lshlrev_b32 v7, 7, v7
  v_cndmask_b32 v233, v233, 0, vcc
  v_mov_b32 v29, 1
  buffer_atomic_add v29, v233, s[72:75], s59 offen sc0 sc1
  v_bfe_u32 v31, v1, 3, 2
  v_lshl_add_u32 v31, v31, 2, v7
  s_lshl_b32 s51, s20, 10
  s_add_u32 s51, s51, 4096
  s_xor_b32 s51, s51, s80
  buffer_load_dword v8, v31, s[72:75], s51 offen sc1
  v_and_b32 v25, 3, v1
  v_lshlrev_b32 v25, 7, v25
  s_xor_b32 s56, s80, 29696
  buffer_load_dword v26, v25, s[72:75], s56 offen sc1
  v_lshlrev_b32 v4, 4, v1
  v_lshlrev_b32 v5, 3, v1
  v_lshlrev_b32 v6, 2, v2
  v_mul_u32_u24 v9, 1280, v2
  v_lshl_add_u32 v13, v3, 3, v9
  v_lshl_add_u32 v9, v3, 4, v9
  s_mul_i32 s21, s20, 10240
  v_add_u32 v10, s21, v4
  s_and_b32 s43, s20, 1
  s_lshr_b32 s44, s20, 1
  s_mul_i32 s21, s44, 6
  s_add_u32 s21, s21, s43
  s_lshl_b32 s21, s21, 10
  v_add_u32 v11, s21, v4
  s_add_u32 s21, s43, 4
  s_lshl_b32 s21, s21, 10
  v_add_u32 v12, s21, v4
  v_lshrrev_b32 v20, 5, v1
  v_mul_u32_u24 v21, 2560, v20
  v_add_u32 v21, v21, v4
  v_and_b32 v22, 31, v1
  v_lshlrev_b32 v22, 4, v22
  v_mul_u32_u24 v14, 640, v20
  v_add_u32 v22, v22, v14
  v_add_u32 v28, 16384, v22
  v_and_b32 v15, 1, v3
  v_lshl_add_u32 v14, v15, 6, v14
  v_lshrrev_b32 v16, 3, v2
  v_mul_u32_u24 v16, 16320, v16
  v_lshl_add_u32 v16, v2, 3, v16
  v_add_u32 v14, v14, v16
  v_add_u32 v15, 40960, v11
  v_lshlrev_b32 v17, 2, v7
  v_bfe_u32 v16, v1, 3, 1
  v_lshl_add_u32 v17, v16, 3, v17
  v_add_u32 v16, 40960, v12
  v_cmp_gt_u32 s[66:67], 16, v1
  s_lshr_b32 s52, s41, 1
  s_lshl_b32 s52, s52, 7
  s_and_b32 s21, s41, 1
  s_lshl_b32 s21, s21, 4
  s_add_u32 s52, s52, s21
  s_add_u32 s52, s52, 0
  s_xor_b32 s52, s52, s80
  v_add_u32 v17, s52, v17
  s_lshl_b32 s21, s20, 17
  s_lshl_b32 s22, s41, 10
  s_add_u32 s42, s21, s22
  s_lshl_b32 s53, s20, 19
  s_lshl_b32 s60, s41, 15
  s_add_u32 s60, s60, s53
  s_add_u32 s60, s60, 4096
  s_lshr_b32 s22, s41, 1
  s_lshl_b32 s22, s22, 14
  s_add_u32 s53, s53, s22
  s_and_b32 s22, s41, 1
  s_lshl_b32 s22, s22, 12
  s_add_u32 s53, s53, s22
  v_mov_b32 v70, 0
  v_mov_b32 v71, 0
  v_mov_b32 v78, 0
  v_mov_b32 v79, 0
  v_mov_b32 v86, 0
  v_mov_b32 v87, 0
  v_mov_b32 v94, 0
  v_mov_b32 v95, 0
  v_mov_b32 v102, 0
  v_mov_b32 v103, 0
  v_mov_b32 v110, 0
  v_mov_b32 v111, 0
  v_mov_b32 v118, 0
  v_mov_b32 v119, 0
  v_mov_b32 v126, 0
  v_mov_b32 v127, 0
  s_waitcnt vmcnt(0)
  s_cmp_lg_u32 s20, 0
  s_cbranch_scc1 pvq_300
  s_mov_b64 exec, 1
  ds_write_b32 v30, v29
  s_mov_b64 exec, -1
pvq_300:
  v_readlane_b32 s50, v8, 0
  v_readlane_b32 s21, v8, 1
  s_min_u32 s50, s50, s21
  v_readlane_b32 s21, v8, 2
  s_min_u32 s50, s50, s21
  v_readlane_b32 s21, v8, 3
  s_min_u32 s50, s50, s21
  v_readlane_b32 s21, v8, 4
  s_min_u32 s50, s50, s21
  v_readlane_b32 s21, v8, 5
  s_min_u32 s50, s50, s21
  v_readlane_b32 s21, v8, 6
  s_min_u32 s50, s50, s21
  v_readlane_b32 s21, v8, 7
  s_min_u32 s50, s50, s21
  v_readlane_b32 s21, v8, 8
  s_min_u32 s50, s50, s21
  v_readlane_b32 s21, v8, 9
  s_min_u32 s50, s50, s21
  v_readlane_b32 s21, v8, 10
  s_min_u32 s50, s50, s21
  v_readlane_b32 s21, v8, 11
  s_min_u32 s50, s50, s21
  v_readlane_b32 s21, v8, 12
  s_min_u32 s50, s50, s21
  v_readlane_b32 s21, v8, 13
  s_min_u32 s50, s50, s21
  v_readlane_b32 s21, v8, 14
  s_min_u32 s50, s50, s21
  v_readlane_b32 s21, v8, 15
  s_min_u32 s50, s50, s21
  v_readlane_b32 s21, v8, 16
  s_min_u32 s50, s50, s21
  v_readlane_b32 s21, v8, 17
  s_min_u32 s50, s50, s21
  v_readlane_b32 s21, v8, 18
  s_min_u32 s50, s50, s21
  v_readlane_b32 s21, v8, 19
  s_min_u32 s50, s50, s21
  v_readlane_b32 s21, v8, 20
  s_min_u32 s50, s50, s21
  v_readlane_b32 s21, v8, 21
  s_min_u32 s50, s50, s21
  v_readlane_b32 s21, v8, 22
  s_min_u32 s50, s50, s21
  v_readlane_b32 s21, v8, 23
  s_min_u32 s50, s50, s21
  v_readlane_b32 s21, v8, 24
  s_min_u32 s50, s50, s21
  v_readlane_b32 s21, v8, 25
  s_min_u32 s50, s50, s21
  v_readlane_b32 s21, v8, 26
  s_min_u32 s50, s50, s21
  v_readlane_b32 s21, v8, 27
  s_min_u32 s50, s50, s21
  v_readlane_b32 s21, v8, 28
  s_min_u32 s50, s50, s21
  v_readlane_b32 s21, v8, 29
  s_min_u32 s50, s50, s21
  v_readlane_b32 s21, v8, 30
  s_min_u32 s50, s50, s21
  v_readlane_b32 s21, v8, 31
  s_min_u32 s50, s50, s21
  v_cmp_gt_u32 vcc, 16, v26
  s_waitcnt lgkmcnt(0)
  s_barrier
  ds_read_b32 v23, v30
  s_cbranch_vccz pv_299
  s_mov_b32 s101, 0
wm_301:
  buffer_load_dword v26, v25, s[72:75], s56 offen sc1
  s_add_u32 s101, s101, 1
  s_cmp_gt_u32 s101, 131072
  s_cbranch_scc1 main_end
  s_waitcnt vmcnt(0)
  v_cmp_gt_u32 vcc, 16, v26
  v_readfirstlane_b32 s100, v26
  s_nop 0
  s_cbranch_vccz wm_302
  s_sleep 16
  s_branch wm_301
wm_302:
pv_299:
  s_mov_b32 s71, 0
pv_late:
  s_waitcnt lgkmcnt(0)
  v_readfirstlane_b32 s2, v23
  s_cmp_ge_u32 s2, 16
  s_cbranch_scc1 pv_done
  s_lshl_b32 s40, s2, 2
  s_add_u32 s40, s40, s58
  s_lshl_b32 s21, s40, 7
  s_add_u32 s21, s21, 8192
  s_xor_b32 s21, s21, s80
  v_mov_b32 v18, s21
  v_cndmask_b32 v18, v17, v18, s[66:67]
  s_add_u32 s21, s40, 1
  v_mov_b32 v19, s21
  v_cndmask_b32 v19, v19, 32, s[66:67]
  buffer_load_dword v27, v18, s[72:75], 0 offen sc1
  s_cmp_eq_u32 s71, 1
  s_cbranch_scc1 pv_303
  v_add_u32 v25, 4096, v4
  s_lshl_b32 s22, s41, 2
  s_add_u32 s22, s22, s20
  s_lshl_b32 s22, s22, 17
  s_lshr_b32 s21, s22, 8
  s_andn2_b32 s21, 8192, s21
  s_xor_b32 s21, s21, s80
  s_add_u32 s22, s22, s21
  buffer_load_dwordx4 a[160:163], v4, s[12:15], s22 offen offset:0 sc1
  buffer_load_dwordx4 a[164:167], v4, s[12:15], s22 offen offset:1024 sc1
  buffer_load_dwordx4 a[168:171], v4, s[12:15], s22 offen offset:2048 sc1
  buffer_load_dwordx4 a[172:175], v4, s[12:15], s22 offen offset:3072 sc1
  buffer_load_dwordx4 a[176:179], v25, s[12:15], s22 offen offset:0 sc1
  s_add_u32 s22, s22, 16384
  buffer_load_dwordx4 a[180:183], v4, s[12:15], s22 offen offset:0 sc1
  buffer_load_dwordx4 a[184:187], v4, s[12:15], s22 offen offset:1024 sc1
  buffer_load_dwordx4 a[188:191], v4, s[12:15], s22 offen offset:2048 sc1
  buffer_load_dwordx4 a[192:195], v4, s[12:15], s22 offen offset:3072 sc1
  buffer_load_dwordx4 a[196:199], v25, s[12:15], s22 offen offset:0 sc1
  s_add_u32 s22, s22, 16384
  buffer_load_dwordx4 a[200:203], v4, s[12:15], s22 offen offset:0 sc1
  buffer_load_dwordx4 a[204:207], v4, s[12:15], s22 offen offset:1024 sc1
  buffer_load_dwordx4 a[208:211], v4, s[12:15], s22 offen offset:2048 sc1
  buffer_load_dwordx4 a[212:215], v4, s[12:15], s22 offen offset:3072 sc1
  buffer_load_dwordx4 a[216:219], v25, s[12:15], s22 offen offset:0 sc1
  s_add_u32 s22, s22, 16384
  buffer_load_dwordx4 a[220:223], v4, s[12:15], s22 offen offset:0 sc1
  buffer_load_dwordx4 a[224:227], v4, s[12:15], s22 offen offset:1024 sc1
  buffer_load_dwordx4 a[228:231], v4, s[12:15], s22 offen offset:2048 sc1
  buffer_load_dwordx4 a[232:235], v4, s[12:15], s22 offen offset:3072 sc1
  buffer_load_dwordx4 a[236:239], v25, s[12:15], s22 offen offset:0 sc1
  s_add_u32 s22, s22, 16384
  buffer_load_dwordx4 a[240:243], v4, s[12:15], s22 offen offset:0 sc1
  buffer_load_dwordx4 a[244:247], v4, s[12:15], s22 offen offset:1024 sc1
  buffer_load_dwordx4 a[248:251], v4, s[12:15], s22 offen offset:2048 sc1
  buffer_load_dwordx4 a[252:255], v4, s[12:15], s22 offen offset:3072 sc1
  buffer_load_dwordx4 v[252:255], v25, s[12:15], s22 offen offset:0 sc1
  s_add_u32 s22, s22, 16384
pv_303:
  s_lshl_b32 s55, s40, 19
  s_lshl_b32 s21, s40, 11
  s_and_b32 s21, s21, 8192
  s_xor_b32 s21, s21, s80
  s_add_u32 s55, s55, s21
  s_add_u32 s55, s55, 136314880
  s_lshl_b32 s21, s20, 15
  s_xor_b32 s54, s55, 8192
  s_add_u32 s54, s54, 48234496
  s_add_u32 s54, s54, s21
  s_lshl_b32 s57, s40, 1
  s_add_u32 s57, s57, s43
  s_lshl_b32 s45, s57, 6
  s_add_u32 s69, s54, 262144
  s_cmp_lt_u32 s2, 16
  s_cselect_b32 s69, s69, 0x40000000
  s_cmp_lt_u32 s2, 12
  s_cselect_b32 s65, s87, 0
  s_cmp_gt_u32 s65, 1
  s_cselect_b32 s64, s59, 0x40000000
  s_cselect_b32 s65, 1, 0
  v_mov_b32 v29, 1
  buffer_atomic_add v29, v233, s[72:75], s64 offen sc0 sc1
  buffer_load_dword v232, v6, s[28:31], s45 offen sc1
  buffer_load_dwordx4 v[192:195], v4, s[16:19], s69 offen offset:0 sc1
  buffer_load_dwordx4 v[196:199], v4, s[16:19], s69 offen offset:1024 sc1
  buffer_load_dwordx2 v[208:209], v5, s[16:19], s69 offen offset:2048 sc1
  s_add_u32 s69, s69, 2560
  buffer_load_dwordx4 v[200:203], v4, s[16:19], s69 offen offset:0 sc1
  buffer_load_dwordx4 v[204:207], v4, s[16:19], s69 offen offset:1024 sc1
  buffer_load_dwordx2 v[210:211], v5, s[16:19], s69 offen offset:2048 sc1
  s_add_u32 s69, s69, 13824
  buffer_load_dwordx4 v[212:215], v4, s[16:19], s69 offen offset:0 sc1
  buffer_load_dwordx4 v[216:219], v4, s[16:19], s69 offen offset:1024 sc1
  buffer_load_dwordx2 v[228:229], v5, s[16:19], s69 offen offset:2048 sc1
  s_add_u32 s69, s69, 2560
  buffer_load_dwordx4 v[220:223], v4, s[16:19], s69 offen offset:0 sc1
  buffer_load_dwordx4 v[224:227], v4, s[16:19], s69 offen offset:1024 sc1
  buffer_load_dwordx2 v[230:231], v5, s[16:19], s69 offen offset:2048 sc1
  s_add_u32 s69, s69, 13824
  s_waitcnt vmcnt(14)
  s_add_u32 s23, s40, 1
  s_cmp_ge_u32 s50, s23
  s_cbranch_scc1 pv_304
  s_mov_b32 s101, 0
wm_307:
  buffer_load_dword v8, v31, s[72:75], s51 offen sc1
  s_add_u32 s101, s101, 1
  s_cmp_gt_u32 s101, 131072
  s_cbranch_scc1 main_end
  s_waitcnt vmcnt(0)
  v_cmp_gt_u32 vcc, s23, v8
  v_readfirstlane_b32 s100, v8
  s_nop 0
  s_cbranch_vccz wm_308
  s_sleep 8
  s_add_u32 s100, s100, 2
  s_cmp_ge_u32 s100, s23
  s_cbranch_scc1 wm_307
  s_sleep 60
  s_branch wm_307
wm_308:
  v_readlane_b32 s50, v8, 0
  v_readlane_b32 s21, v8, 1
  s_min_u32 s50, s50, s21
  v_readlane_b32 s21, v8, 2
  s_min_u32 s50, s50, s21
  v_readlane_b32 s21, v8, 3
  s_min_u32 s50, s50, s21
  v_readlane_b32 s21, v8, 4
  s_min_u32 s50, s50, s21
  v_readlane_b32 s21, v8, 5
  s_min_u32 s50, s50, s21
  v_readlane_b32 s21, v8, 6
  s_min_u32 s50, s50, s21
  v_readlane_b32 s21, v8, 7
  s_min_u32 s50, s50, s21
  v_readlane_b32 s21, v8, 8
  s_min_u32 s50, s50, s21
  v_readlane_b32 s21, v8, 9
  s_min_u32 s50, s50, s21
  v_readlane_b32 s21, v8, 10
  s_min_u32 s50, s50, s21
  v_readlane_b32 s21, v8, 11
  s_min_u32 s50, s50, s21
  v_readlane_b32 s21, v8, 12
  s_min_u32 s50, s50, s21
  v_readlane_b32 s21, v8, 13
  s_min_u32 s50, s50, s21
  v_readlane_b32 s21, v8, 14
  s_min_u32 s50, s50, s21
  v_readlane_b32 s21, v8, 15
  s_min_u32 s50, s50, s21
  v_readlane_b32 s21, v8, 16
  s_min_u32 s50, s50, s21
  v_readlane_b32 s21, v8, 17
  s_min_u32 s50, s50, s21
  v_readlane_b32 s21, v8, 18
  s_min_u32 s50, s50, s21
  v_readlane_b32 s21, v8, 19
  s_min_u32 s50, s50, s21
  v_readlane_b32 s21, v8, 20
  s_min_u32 s50, s50, s21
  v_readlane_b32 s21, v8, 21
  s_min_u32 s50, s50, s21
  v_readlane_b32 s21, v8, 22
  s_min_u32 s50, s50, s21
  v_readlane_b32 s21, v8, 23
  s_min_u32 s50, s50, s21
  v_readlane_b32 s21, v8, 24
  s_min_u32 s50, s50, s21
  v_readlane_b32 s21, v8, 25
  s_min_u32 s50, s50, s21
  v_readlane_b32 s21, v8, 26
  s_min_u32 s50, s50, s21
  v_readlane_b32 s21, v8, 27
  s_min_u32 s50, s50, s21
  v_readlane_b32 s21, v8, 28
  s_min_u32 s50, s50, s21
  v_readlane_b32 s21, v8, 29
  s_min_u32 s50, s50, s21
  v_readlane_b32 s21, v8, 30
  s_min_u32 s50, s50, s21
  v_readlane_b32 s21, v8, 31
  s_min_u32 s50, s50, s21
pv_304:
  v_cmp_gt_u32 vcc, v19, v27
  s_lshl_b32 s61, s40, 21
  s_lshl_b32 s21, s40, 13
  s_and_b32 s21, s21, 8192
  s_xor_b32 s21, s21, s80
  s_add_u32 s61, s61, s21
  s_lshl_b32 s21, s20, 15
  s_add_u32 s47, s54, s21
  s_add_u32 s48, s61, s60
  s_xor_b32 s68, s61, 8192
  s_add_u32 s68, s68, s53
  s_add_u32 s70, s55, s42
  s_xor_b32 s70, s70, 0
  s_mov_b32 s62, 0
  s_cbranch_vccnz pv_305
  s_mov_b32 s62, 1
  buffer_load_dwordx4 a[0:3], v4, s[16:19], s68 offen offset:0 sc1
  buffer_load_dwordx4 a[4:7], v4, s[16:19], s68 offen offset:1024 sc1
  buffer_load_dwordx4 v[32:35], v22, s[16:19], s48 offen offset:0 sc1
  buffer_load_dwordx4 a[8:11], v4, s[16:19], s70 offen sc1
  s_add_u32 s70, s70, 16384
  buffer_load_dwordx4 a[12:15], v4, s[16:19], s68 offen offset:2048 sc1
  buffer_load_dwordx4 a[16:19], v4, s[16:19], s68 offen offset:3072 sc1
  s_add_u32 s68, s68, 65536
  buffer_load_dwordx4 v[64:67], v4, s[16:19], s47 offen sc1
  buffer_load_dwordx2 v[68:69], v5, s[16:19], s47 offen offset:2048 sc1
  buffer_load_dwordx4 v[128:131], v21, s[16:19], s47 offen offset:1024 sc1
  s_add_u32 s47, s47, 2560
  buffer_load_dwordx4 a[20:23], v4, s[16:19], s68 offen offset:0 sc1
  buffer_load_dwordx4 a[24:27], v4, s[16:19], s68 offen offset:1024 sc1
  buffer_load_dwordx4 v[40:43], v28, s[16:19], s48 offen offset:0 sc1
  buffer_load_dwordx4 a[28:31], v4, s[16:19], s70 offen sc1
  s_add_u32 s70, s70, 16384
  buffer_load_dwordx4 a[32:35], v4, s[16:19], s68 offen offset:2048 sc1
  buffer_load_dwordx4 a[36:39], v4, s[16:19], s68 offen offset:3072 sc1
  s_add_u32 s68, s68, 65536
  buffer_load_dwordx2 v[184:185], v14, s[16:19], s48 offen offset:512 sc1
  buffer_load_dwordx4 v[72:75], v4, s[16:19], s47 offen sc1
  buffer_load_dwordx2 v[76:77], v5, s[16:19], s47 offen offset:2048 sc1
  s_add_u32 s47, s47, 13824
  buffer_load_dwordx4 a[40:43], v4, s[16:19], s68 offen offset:0 sc1
  buffer_load_dwordx4 a[44:47], v4, s[16:19], s68 offen offset:1024 sc1
  buffer_load_dwordx4 v[36:39], v22, s[16:19], s48 offen offset:1280 sc1
  buffer_load_dwordx4 a[48:51], v4, s[16:19], s70 offen sc1
  s_add_u32 s70, s70, 16384
  buffer_load_dwordx4 a[52:55], v4, s[16:19], s68 offen offset:2048 sc1
  buffer_load_dwordx4 a[56:59], v4, s[16:19], s68 offen offset:3072 sc1
  s_add_u32 s68, s68, 65536
  buffer_load_dwordx4 v[80:83], v4, s[16:19], s47 offen sc1
  buffer_load_dwordx2 v[84:85], v5, s[16:19], s47 offen offset:2048 sc1
  buffer_load_dwordx4 v[132:135], v21, s[16:19], s47 offen offset:1024 sc1
  s_add_u32 s47, s47, 2560
  buffer_load_dwordx4 a[60:63], v4, s[16:19], s68 offen offset:0 sc1
  buffer_load_dwordx4 a[64:67], v4, s[16:19], s68 offen offset:1024 sc1
  buffer_load_dwordx4 v[44:47], v28, s[16:19], s48 offen offset:1280 sc1
  buffer_load_dwordx4 a[68:71], v4, s[16:19], s70 offen sc1
  s_add_u32 s70, s70, 16384
  buffer_load_dwordx4 a[72:75], v4, s[16:19], s68 offen offset:2048 sc1
  buffer_load_dwordx4 a[76:79], v4, s[16:19], s68 offen offset:3072 sc1
  s_add_u32 s68, s68, 65536
  buffer_load_dwordx2 v[186:187], v14, s[16:19], s48 offen offset:1792 sc1
  s_add_u32 s48, s48, 262144
  buffer_load_dwordx4 v[88:91], v4, s[16:19], s47 offen sc1
  buffer_load_dwordx2 v[92:93], v5, s[16:19], s47 offen offset:2048 sc1
  s_add_u32 s47, s47, 13824
  s_branch pv_306
pv_305:
  buffer_load_dwordx4 a[0:3], v4, s[16:19], s68 offen offset:0 sc1
  buffer_load_dwordx4 a[4:7], v4, s[16:19], s68 offen offset:1024 sc1
  buffer_load_dwordx4 a[8:11], v4, s[16:19], s70 offen sc1
  s_add_u32 s70, s70, 16384
  buffer_load_dwordx4 a[12:15], v4, s[16:19], s68 offen offset:2048 sc1
  buffer_load_dwordx4 a[16:19], v4, s[16:19], s68 offen offset:3072 sc1
  s_add_u32 s68, s68, 65536
  buffer_load_dwordx4 a[20:23], v4, s[16:19], s68 offen offset:0 sc1
  buffer_load_dwordx4 a[24:27], v4, s[16:19], s68 offen offset:1024 sc1
  buffer_load_dwordx4 a[28:31], v4, s[16:19], s70 offen sc1
  s_add_u32 s70, s70, 16384
  buffer_load_dwordx4 a[32:35], v4, s[16:19], s68 offen offset:2048 sc1
  buffer_load_dwordx4 a[36:39], v4, s[16:19], s68 offen offset:3072 sc1
  s_add_u32 s68, s68, 65536
  buffer_load_dwordx4 a[40:43], v4, s[16:19], s68 offen offset:0 sc1
  buffer_load_dwordx4 a[44:47], v4, s[16:19], s68 offen offset:1024 sc1
  buffer_load_dwordx4 a[48:51], v4, s[16:19], s70 offen sc1
  s_add_u32 s70, s70, 16384
  buffer_load_dwordx4 a[52:55], v4, s[16:19], s68 offen offset:2048 sc1
  buffer_load_dwordx4 a[56:59], v4, s[16:19], s68 offen offset:3072 sc1
  s_add_u32 s68, s68, 65536
  buffer_load_dwordx4 a[60:63], v4, s[16:19], s68 offen offset:0 sc1
  buffer_load_dwordx4 a[64:67], v4, s[16:19], s68 offen offset:1024 sc1
  buffer_load_dwordx4 a[68:71], v4, s[16:19], s70 offen sc1
  s_add_u32 s70, s70, 16384
  buffer_load_dwordx4 a[72:75], v4, s[16:19], s68 offen offset:2048 sc1
  buffer_load_dwordx4 a[76:79], v4, s[16:19], s68 offen offset:3072 sc1
  s_add_u32 s68, s68, 65536
  buffer_load_dwordx4 a[80:83], v4, s[16:19], s68 offen offset:0 sc1
  buffer_load_dwordx4 a[84:87], v4, s[16:19], s68 offen offset:1024 sc1
  buffer_load_dwordx4 a[88:91], v4, s[16:19], s70 offen sc1
  s_add_u32 s70, s70, 16384
  buffer_load_dwordx4 a[92:95], v4, s[16:19], s68 offen offset:2048 sc1
  buffer_load_dwordx4 a[96:99], v4, s[16:19], s68 offen offset:3072 sc1
  s_add_u32 s68, s68, 65536
  buffer_load_dwordx4 a[100:103], v4, s[16:19], s68 offen offset:0 sc1
  buffer_load_dwordx4 a[104:107], v4, s[16:19], s68 offen offset:1024 sc1
  buffer_load_dwordx4 a[108:111], v4, s[16:19], s70 offen sc1
  s_add_u32 s70, s70, 16384
  buffer_load_dwordx4 a[112:115], v4, s[16:19], s68 offen offset:2048 sc1
  buffer_load_dwordx4 a[116:119], v4, s[16:19], s68 offen offset:3072 sc1
  s_add_u32 s68, s68, 65536
  buffer_load_dwordx4 a[120:123], v4, s[16:19], s68 offen offset:0 sc1
  buffer_load_dwordx4 a[124:127], v4, s[16:19], s68 offen offset:1024 sc1
  buffer_load_dwordx4 a[128:131], v4, s[16:19], s70 offen sc1
  s_add_u32 s70, s70, 16384
  buffer_load_dwordx4 a[132:135], v4, s[16:19], s68 offen offset:2048 sc1
  buffer_load_dwordx4 a[136:139], v4, s[16:19], s68 offen offset:3072 sc1
  s_add_u32 s68, s68, 65536
  buffer_load_dwordx4 a[140:143], v4, s[16:19], s68 offen offset:0 sc1
  buffer_load_dwordx4 a[144:147], v4, s[16:19], s68 offen offset:1024 sc1
  buffer_load_dwordx4 a[148:151], v4, s[16:19], s70 offen sc1
  s_add_u32 s70, s70, 16384
  buffer_load_dwordx4 a[152:155], v4, s[16:19], s68 offen offset:2048 sc1
  buffer_load_dwordx4 a[156:159], v4, s[16:19], s68 offen offset:3072 sc1
  s_add_u32 s68, s68, 65536
pv_306:
pv_first:
  s_waitcnt lgkmcnt(0)
  s_barrier
pv_loop:
  s_mov_b32 s63, s40
  s_mul_i32 s46, s57, 20480
  s_mul_i32 s22, s41, 160
  s_add_u32 s49, s46, s22
  s_mul_i32 s21, s44, 96
  s_add_u32 s46, s49, s21
  s_sub_u32 s87, s87, 1
  s_waitcnt vmcnt(36)
  v_mov_b32 v24, v232
  s_cmp_lg_u32 s20, 0
  s_cbranch_scc1 pvq_314
  s_mov_b64 exec, 1
  ds_write_b32 v30, v29
  s_mov_b64 exec, -1
pvq_314:
  s_cmp_eq_u32 s62, 0
  s_cbranch_scc1 pvw_309
  v_mfma_f32_16x16x32_bf16 v[144:147], a[160:163], v[192:195], 0
  v_mfma_f32_16x16x32_bf16 v[148:151], a[160:163], v[212:215], 0
  buffer_load_dwordx4 a[80:83], v4, s[16:19], s68 offen offset:0 sc1
  v_mfma_f32_16x16x32_bf16 v[152:155], a[164:167], v[192:195], 0
  v_mfma_f32_16x16x32_bf16 v[156:159], a[164:167], v[212:215], 0
  v_mfma_f32_16x16x32_bf16 v[160:163], a[168:171], v[192:195], 0
  buffer_load_dwordx4 a[84:87], v4, s[16:19], s68 offen offset:1024 sc1
  v_mfma_f32_16x16x32_bf16 v[164:167], a[168:171], v[212:215], 0
  v_mfma_f32_16x16x32_bf16 v[168:171], a[172:175], v[192:195], 0
  v_mfma_f32_16x16x32_bf16 v[172:175], a[172:175], v[212:215], 0
  buffer_load_dwordx4 v[48:51], v22, s[16:19], s48 offen offset:0 sc1
  v_mfma_f32_16x16x32_bf16 v[176:179], a[176:179], v[192:195], 0
  v_mfma_f32_16x16x32_bf16 v[180:183], a[176:179], v[212:215], 0
  buffer_load_dwordx4 a[88:91], v4, s[16:19], s70 offen sc1
  s_add_u32 s70, s70, 16384
  v_mfma_f32_16x16x32_bf16 v[144:147], a[180:183], v[196:199], v[144:147]
  v_mfma_f32_16x16x32_bf16 v[148:151], a[180:183], v[216:219], v[148:151]
  v_mfma_f32_16x16x32_bf16 v[152:155], a[184:187], v[196:199], v[152:155]
  buffer_load_dwordx4 a[92:95], v4, s[16:19], s68 offen offset:2048 sc1
  v_mfma_f32_16x16x32_bf16 v[156:159], a[184:187], v[216:219], v[156:159]
  v_mfma_f32_16x16x32_bf16 v[160:163], a[188:191], v[196:199], v[160:163]
  v_mfma_f32_16x16x32_bf16 v[164:167], a[188:191], v[216:219], v[164:167]
  buffer_load_dwordx4 a[96:99], v4, s[16:19], s68 offen offset:3072 sc1
  s_add_u32 s68, s68, 65536
  v_mfma_f32_16x16x32_bf16 v[168:171], a[192:195], v[196:199], v[168:171]
  v_mfma_f32_16x16x32_bf16 v[172:175], a[192:195], v[216:219], v[172:175]
  v_mfma_f32_16x16x32_bf16 v[176:179], a[196:199], v[196:199], v[176:179]
  buffer_load_dwordx4 v[96:99], v4, s[16:19], s47 offen sc1
  v_mfma_f32_16x16x32_bf16 v[180:183], a[196:199], v[216:219], v[180:183]
  v_mfma_f32_16x16x32_bf16 v[144:147], a[200:203], v[200:203], v[144:147]
  v_mfma_f32_16x16x32_bf16 v[148:151], a[200:203], v[220:223], v[148:151]
  buffer_load_dwordx2 v[100:101], v5, s[16:19], s47 offen offset:2048 sc1
  v_mfma_f32_16x16x32_bf16 v[152:155], a[204:207], v[200:203], v[152:155]
  v_mfma_f32_16x16x32_bf16 v[156:159], a[204:207], v[220:223], v[156:159]
  buffer_load_dwordx4 v[136:139], v21, s[16:19], s47 offen offset:1024 sc1
  s_add_u32 s47, s47, 2560
  v_mfma_f32_16x16x32_bf16 v[160:163], a[208:211], v[200:203], v[160:163]
  v_mfma_f32_16x16x32_bf16 v[164:167], a[208:211], v[220:223], v[164:167]
  v_mfma_f32_16x16x32_bf16 v[168:171], a[212:215], v[200:203], v[168:171]
  buffer_load_dwordx4 a[100:103], v4, s[16:19], s68 offen offset:0 sc1
  v_mfma_f32_16x16x32_bf16 v[172:175], a[212:215], v[220:223], v[172:175]
  v_mfma_f32_16x16x32_bf16 v[176:179], a[216:219], v[200:203], v[176:179]
  v_mfma_f32_16x16x32_bf16 v[180:183], a[216:219], v[220:223], v[180:183]
  buffer_load_dwordx4 a[104:107], v4, s[16:19], s68 offen offset:1024 sc1
  v_mfma_f32_16x16x32_bf16 v[144:147], a[220:223], v[204:207], v[144:147]
  v_mfma_f32_16x16x32_bf16 v[148:151], a[220:223], v[224:227], v[148:151]
  v_mfma_f32_16x16x32_bf16 v[152:155], a[224:227], v[204:207], v[152:155]
  buffer_load_dwordx4 v[56:59], v28, s[16:19], s48 offen offset:0 sc1
  v_mfma_f32_16x16x32_bf16 v[156:159], a[224:227], v[224:227], v[156:159]
  v_mfma_f32_16x16x32_bf16 v[160:163], a[228:231], v[204:207], v[160:163]
  v_mfma_f32_16x16x32_bf16 v[164:167], a[228:231], v[224:227], v[164:167]
  buffer_load_dwordx4 a[108:111], v4, s[16:19], s70 offen sc1
  s_add_u32 s70, s70, 16384
  v_mfma_f32_16x16x32_bf16 v[168:171], a[232:235], v[204:207], v[168:171]
  v_mfma_f32_16x16x32_bf16 v[172:175], a[232:235], v[224:227], v[172:175]
  buffer_load_dwordx4 a[112:115], v4, s[16:19], s68 offen offset:2048 sc1
  v_mfma_f32_16x16x32_bf16 v[176:179], a[236:239], v[204:207], v[176:179]
  v_mfma_f32_16x16x32_bf16 v[180:183], a[236:239], v[224:227], v[180:183]
  v_mfma_f32_16x16x32_bf16 v[144:147], a[240:243], v[208:211], v[144:147]
  buffer_load_dwordx4 a[116:119], v4, s[16:19], s68 offen offset:3072 sc1
  s_add_u32 s68, s68, 65536
  v_mfma_f32_16x16x32_bf16 v[148:151], a[240:243], v[228:231], v[148:151]
  v_mfma_f32_16x16x32_bf16 v[152:155], a[244:247], v[208:211], v[152:155]
  v_mfma_f32_16x16x32_bf16 v[156:159], a[244:247], v[228:231], v[156:159]
  buffer_load_dwordx2 v[188:189], v14, s[16:19], s48 offen offset:512 sc1
  v_mfma_f32_16x16x32_bf16 v[160:163], a[248:251], v[208:211], v[160:163]
  v_mfma_f32_16x16x32_bf16 v[164:167], a[248:251], v[228:231], v[164:167]
  v_mfma_f32_16x16x32_bf16 v[168:171], a[252:255], v[208:211], v[168:171]
  buffer_load_dwordx4 v[104:107], v4, s[16:19], s47 offen sc1
  v_mfma_f32_16x16x32_bf16 v[172:175], a[252:255], v[228:231], v[172:175]
  v_mfma_f32_16x16x32_bf16 v[176:179], v[252:255], v[208:211], v[176:179]
  v_mfma_f32_16x16x32_bf16 v[180:183], v[252:255], v[228:231], v[180:183]
  buffer_load_dwordx2 v[108:109], v5, s[16:19], s47 offen offset:2048 sc1
  s_add_u32 s47, s47, 13824
  ds_write_b128 v10, v[144:147] offset:40960
  buffer_load_dwordx4 a[120:123], v4, s[16:19], s68 offen offset:0 sc1
  ds_write_b128 v10, v[148:151] offset:41984
  buffer_load_dwordx4 a[124:127], v4, s[16:19], s68 offen offset:1024 sc1
  ds_write_b128 v10, v[152:155] offset:43008
  ds_write_b128 v10, v[156:159] offset:44032
  s_waitcnt vmcnt(40)
  buffer_load_dwordx4 v[52:55], v22, s[16:19], s48 offen offset:1280 sc1
  ds_write_b128 v10, v[160:163] offset:45056
  buffer_load_dwordx4 a[128:131], v4, s[16:19], s70 offen sc1
  s_add_u32 s70, s70, 16384
  ds_write_b128 v10, v[164:167] offset:46080
  buffer_load_dwordx4 a[132:135], v4, s[16:19], s68 offen offset:2048 sc1
  ds_write_b128 v10, v[168:171] offset:47104
  buffer_load_dwordx4 a[136:139], v4, s[16:19], s68 offen offset:3072 sc1
  s_add_u32 s68, s68, 65536
  ds_write_b128 v10, v[172:175] offset:48128
  buffer_load_dwordx4 v[112:115], v4, s[16:19], s47 offen sc1
  s_nop 1
  ds_write_b128 v10, v[176:179] offset:49152
  buffer_load_dwordx2 v[116:117], v5, s[16:19], s47 offen offset:2048 sc1
  ds_write_b128 v10, v[180:183] offset:50176
  buffer_load_dwordx4 v[140:143], v21, s[16:19], s47 offen offset:1024 sc1
  s_add_u32 s47, s47, 2560
  s_waitcnt lgkmcnt(0)
  s_barrier
  ds_read_b32 v23, v30
  s_waitcnt lgkmcnt(0)
  v_readfirstlane_b32 s2, v23
  s_min_u32 s2, s2, 16
  s_cmp_eq_u32 s65, 0
  s_cselect_b32 s2, 17, s2
  buffer_load_dwordx4 a[140:143], v4, s[16:19], s68 offen offset:0 sc1
  s_lshl_b32 s40, s2, 2
  s_add_u32 s40, s40, s58
  s_lshl_b32 s21, s40, 7
  s_add_u32 s21, s21, 8192
  s_xor_b32 s21, s21, s80
  v_mov_b32 v18, s21
  v_cndmask_b32 v18, v17, v18, s[66:67]
  s_add_u32 s21, s40, 1
  v_mov_b32 v19, s21
  v_cndmask_b32 v19, v19, 32, s[66:67]
  buffer_load_dword v27, v18, s[72:75], 0 offen sc1
  buffer_load_dwordx4 a[144:147], v4, s[16:19], s68 offen offset:1024 sc1
  v_sub_f32 v25, 1.0, v24
  v_cvt_pk_bf16_f32 v26, v25, v25
  v_lshlrev_b32 v25, 16, v26
  ds_read_b128 v[144:147], v15 offset:0
  ds_read_b128 v[148:151], v15 offset:10240
  ds_read_b128 v[152:155], v15 offset:20480
  ds_read_b128 v[156:159], v15 offset:30720
  ds_read_b128 v[160:163], v15 offset:2048
  ds_read_b128 v[164:167], v15 offset:12288
  ds_read_b128 v[168:171], v15 offset:22528
  ds_read_b128 v[172:175], v15 offset:32768
  s_waitcnt lgkmcnt(4)
  buffer_load_dwordx4 v[60:63], v28, s[16:19], s48 offen offset:1280 sc1
  v_pk_add_f32 v[144:145], v[144:145], v[148:149]
  v_pk_add_f32 v[152:153], v[152:153], v[156:157]
  v_pk_add_f32 v[146:147], v[146:147], v[150:151]
  v_pk_add_f32 v[154:155], v[154:155], v[158:159]
  v_pk_add_f32 v[176:177], v[144:145], v[152:153]
  v_pk_add_f32 v[178:179], v[146:147], v[154:155]
  ds_read_b128 v[144:147], v16 offset:0
  ds_read_b128 v[148:151], v16 offset:10240
  ds_read_b128 v[152:155], v16 offset:20480
  ds_read_b128 v[156:159], v16 offset:30720
  v_cvt_pk_bf16_f32 v26, v176, v177
  buffer_load_dwordx4 a[148:151], v4, s[16:19], s70 offen sc1
  s_add_u32 s70, s70, 16384
  v_lshlrev_b32 v240, 16, v26
  v_and_b32 v241, 0xffff0000, v26
  v_mul_f32 v240, v240, v25
  v_mul_f32 v241, v241, v25
  v_cvt_pk_bf16_f32 v26, v240, v241
  v_lshlrev_b32 v240, 16, v26
  v_and_b32 v241, 0xffff0000, v26
  v_cvt_pk_bf16_f32 v26, v178, v179
  v_lshlrev_b32 v242, 16, v26
  v_and_b32 v243, 0xffff0000, v26
  v_mul_f32 v242, v242, v25
  buffer_load_dwordx4 a[152:155], v4, s[16:19], s68 offen offset:2048 sc1
  v_mul_f32 v243, v243, v25
  v_cvt_pk_bf16_f32 v26, v242, v243
  v_lshlrev_b32 v242, 16, v26
  v_and_b32 v243, 0xffff0000, v26
  s_waitcnt lgkmcnt(4)
  v_pk_add_f32 v[160:161], v[160:161], v[164:165]
  v_pk_add_f32 v[168:169], v[168:169], v[172:173]
  v_pk_add_f32 v[162:163], v[162:163], v[166:167]
  v_pk_add_f32 v[170:171], v[170:171], v[174:175]
  v_pk_add_f32 v[176:177], v[160:161], v[168:169]
  v_pk_add_f32 v[178:179], v[162:163], v[170:171]
  buffer_load_dwordx4 a[156:159], v4, s[16:19], s68 offen offset:3072 sc1
  s_add_u32 s68, s68, 65536
  v_cvt_pk_bf16_f32 v26, v176, v177
  v_lshlrev_b32 v244, 16, v26
  v_and_b32 v245, 0xffff0000, v26
  v_mul_f32 v244, v244, v25
  v_mul_f32 v245, v245, v25
  v_cvt_pk_bf16_f32 v26, v244, v245
  v_lshlrev_b32 v244, 16, v26
  v_and_b32 v245, 0xffff0000, v26
  v_cvt_pk_bf16_f32 v26, v178, v179
  v_lshlrev_b32 v246, 16, v26
  v_and_b32 v247, 0xffff0000, v26
  buffer_load_dwordx2 v[190:191], v14, s[16:19], s48 offen offset:1792 sc1
  s_add_u32 s48, s48, 262144
  v_mul_f32 v246, v246, v25
  v_mul_f32 v247, v247, v25
  v_cvt_pk_bf16_f32 v26, v246, v247
  v_lshlrev_b32 v246, 16, v26
  v_and_b32 v247, 0xffff0000, v26
  s_waitcnt lgkmcnt(0)
  v_pk_add_f32 v[144:145], v[144:145], v[148:149]
  v_pk_add_f32 v[152:153], v[152:153], v[156:157]
  v_pk_add_f32 v[146:147], v[146:147], v[150:151]
  v_pk_add_f32 v[154:155], v[154:155], v[158:159]
  v_pk_add_f32 v[176:177], v[144:145], v[152:153]
  v_pk_add_f32 v[178:179], v[146:147], v[154:155]
  buffer_load_dwordx4 v[120:123], v4, s[16:19], s47 offen sc1
  v_cvt_pk_bf16_f32 v26, v176, v177
  v_lshlrev_b32 v248, 16, v26
  v_and_b32 v249, 0xffff0000, v26
  v_mul_f32 v248, v248, v25
  v_mul_f32 v249, v249, v25
  v_cvt_pk_bf16_f32 v26, v248, v249
  v_lshlrev_b32 v248, 16, v26
  v_and_b32 v249, 0xffff0000, v26
  v_cvt_pk_bf16_f32 v26, v178, v179
  v_lshlrev_b32 v250, 16, v26
  v_and_b32 v251, 0xffff0000, v26
  buffer_load_dwordx2 v[124:125], v5, s[16:19], s47 offen offset:2048 sc1
  s_add_u32 s47, s47, 13824
  v_mul_f32 v250, v250, v25
  v_mul_f32 v251, v251, v25
  v_cvt_pk_bf16_f32 v26, v250, v251
  v_lshlrev_b32 v250, 16, v26
  v_and_b32 v251, 0xffff0000, v26
  s_barrier
  s_lshl_b32 s55, s40, 19
  s_lshl_b32 s21, s40, 11
  s_and_b32 s21, s21, 8192
  s_xor_b32 s21, s21, s80
  s_add_u32 s55, s55, s21
  s_add_u32 s55, s55, 136314880
  s_lshl_b32 s21, s20, 15
  s_xor_b32 s54, s55, 8192
  s_add_u32 s54, s54, 48234496
  s_add_u32 s54, s54, s21
  s_lshl_b32 s57, s40, 1
  s_add_u32 s57, s57, s43
  s_lshl_b32 s45, s57, 6
  s_add_u32 s69, s54, 262144
  s_cmp_lt_u32 s2, 16
  s_cselect_b32 s69, s69, 0x40000000
  s_cmp_lt_u32 s2, 12
  s_cselect_b32 s65, s87, 0
  s_cmp_gt_u32 s65, 1
  s_cselect_b32 s64, s59, 0x40000000
  s_cselect_b32 s65, 1, 0
  s_waitcnt vmcnt(37)
  v_mfma_f32_16x16x32_bf16 v[148:151], a[0:3], v[64:67], 0
  v_mfma_f32_16x16x32_bf16 v[144:147], a[0:3], v[68:71], 0
  v_mov_b32 v29, 1
  buffer_atomic_add v29, v233, s[72:75], s64 offen sc0 sc1
  v_mfma_f32_16x16x32_bf16 v[156:159], a[4:7], v[64:67], 0
  v_mfma_f32_16x16x32_bf16 v[152:155], a[4:7], v[68:71], 0
  v_mfma_f32_16x16x32_bf16 v[164:167], a[8:11], v[64:67], 0
  v_mfma_f32_16x16x32_bf16 v[160:163], a[8:11], v[68:71], 0
  buffer_load_dword v232, v6, s[28:31], s45 offen sc1
  v_mfma_f32_16x16x32_bf16 v[172:175], a[12:15], v[64:67], 0
  v_mfma_f32_16x16x32_bf16 v[168:171], a[12:15], v[68:71], 0
  v_mfma_f32_16x16x32_bf16 v[180:183], a[16:19], v[64:67], 0
  v_mfma_f32_16x16x32_bf16 v[176:179], a[16:19], v[68:71], 0
  buffer_load_dwordx4 v[192:195], v4, s[16:19], s69 offen offset:0 sc1
  v_mfma_f32_16x16x32_bf16 v[148:151], a[20:23], v[72:75], v[148:151]
  v_mfma_f32_16x16x32_bf16 v[144:147], a[20:23], v[76:79], v[144:147]
  v_mfma_f32_16x16x32_bf16 v[156:159], a[24:27], v[72:75], v[156:159]
  v_mfma_f32_16x16x32_bf16 v[152:155], a[24:27], v[76:79], v[152:155]
  buffer_load_dwordx4 v[196:199], v4, s[16:19], s69 offen offset:1024 sc1
  v_mfma_f32_16x16x32_bf16 v[164:167], a[28:31], v[72:75], v[164:167]
  v_mfma_f32_16x16x32_bf16 v[160:163], a[28:31], v[76:79], v[160:163]
  v_mfma_f32_16x16x32_bf16 v[172:175], a[32:35], v[72:75], v[172:175]
  buffer_load_dwordx2 v[208:209], v5, s[16:19], s69 offen offset:2048 sc1
  s_add_u32 s69, s69, 2560
  v_mfma_f32_16x16x32_bf16 v[168:171], a[32:35], v[76:79], v[168:171]
  v_mfma_f32_16x16x32_bf16 v[180:183], a[36:39], v[72:75], v[180:183]
  v_mfma_f32_16x16x32_bf16 v[176:179], a[36:39], v[76:79], v[176:179]
  v_mfma_f32_16x16x32_bf16 v[148:151], a[40:43], v[80:83], v[148:151]
  buffer_load_dwordx4 v[200:203], v4, s[16:19], s69 offen offset:0 sc1
  v_mfma_f32_16x16x32_bf16 v[144:147], a[40:43], v[84:87], v[144:147]
  v_mfma_f32_16x16x32_bf16 v[156:159], a[44:47], v[80:83], v[156:159]
  v_mfma_f32_16x16x32_bf16 v[152:155], a[44:47], v[84:87], v[152:155]
  v_mfma_f32_16x16x32_bf16 v[164:167], a[48:51], v[80:83], v[164:167]
  buffer_load_dwordx4 v[204:207], v4, s[16:19], s69 offen offset:1024 sc1
  v_mfma_f32_16x16x32_bf16 v[160:163], a[48:51], v[84:87], v[160:163]
  v_mfma_f32_16x16x32_bf16 v[172:175], a[52:55], v[80:83], v[172:175]
  v_mfma_f32_16x16x32_bf16 v[168:171], a[52:55], v[84:87], v[168:171]
  buffer_load_dwordx2 v[210:211], v5, s[16:19], s69 offen offset:2048 sc1
  s_add_u32 s69, s69, 13824
  v_mfma_f32_16x16x32_bf16 v[180:183], a[56:59], v[80:83], v[180:183]
  v_mfma_f32_16x16x32_bf16 v[176:179], a[56:59], v[84:87], v[176:179]
  v_mfma_f32_16x16x32_bf16 v[148:151], a[60:63], v[88:91], v[148:151]
  v_mfma_f32_16x16x32_bf16 v[144:147], a[60:63], v[92:95], v[144:147]
  buffer_load_dwordx4 v[212:215], v4, s[16:19], s69 offen offset:0 sc1
  v_mfma_f32_16x16x32_bf16 v[156:159], a[64:67], v[88:91], v[156:159]
  v_mfma_f32_16x16x32_bf16 v[152:155], a[64:67], v[92:95], v[152:155]
  v_mfma_f32_16x16x32_bf16 v[164:167], a[68:71], v[88:91], v[164:167]
  v_mfma_f32_16x16x32_bf16 v[160:163], a[68:71], v[92:95], v[160:163]
  buffer_load_dwordx4 v[216:219], v4, s[16:19], s69 offen offset:1024 sc1
  v_mfma_f32_16x16x32_bf16 v[172:175], a[72:75], v[88:91], v[172:175]
  v_mfma_f32_16x16x32_bf16 v[168:171], a[72:75], v[92:95], v[168:171]
  v_mfma_f32_16x16x32_bf16 v[180:183], a[76:79], v[88:91], v[180:183]
  v_mfma_f32_16x16x32_bf16 v[176:179], a[76:79], v[92:95], v[176:179]
  buffer_load_dwordx2 v[228:229], v5, s[16:19], s69 offen offset:2048 sc1
  s_add_u32 s69, s69, 2560
  v_swap_b32 v130, v132
  v_swap_b32 v131, v133
  v_swap_b32 v34, v36
  v_swap_b32 v35, v37
  v_swap_b32 v42, v44
  v_swap_b32 v43, v45
  s_nop 1
  v_mfma_f32_16x16x32_bf16 v[144:147], v[32:35], v[128:131], v[144:147]
  v_mfma_f32_16x16x32_bf16 v[148:151], v[32:35], v[132:135], v[148:151]
  buffer_load_dwordx4 v[220:223], v4, s[16:19], s69 offen offset:0 sc1
  v_mfma_f32_16x16x32_bf16 v[152:155], v[36:39], v[128:131], v[152:155]
  v_mfma_f32_16x16x32_bf16 v[156:159], v[36:39], v[132:135], v[156:159]
  v_mfma_f32_16x16x32_bf16 v[160:163], v[184:187], v[128:131], v[160:163]
  buffer_load_dwordx4 v[224:227], v4, s[16:19], s69 offen offset:1024 sc1
  v_mfma_f32_16x16x32_bf16 v[164:167], v[184:187], v[132:135], v[164:167]
  v_mfma_f32_16x16x32_bf16 v[168:171], v[40:43], v[128:131], v[168:171]
  v_mfma_f32_16x16x32_bf16 v[172:175], v[40:43], v[132:135], v[172:175]
  v_mfma_f32_16x16x32_bf16 v[176:179], v[44:47], v[128:131], v[176:179]
  buffer_load_dwordx2 v[230:231], v5, s[16:19], s69 offen offset:2048 sc1
  s_add_u32 s69, s69, 13824
  v_mfma_f32_16x16x32_bf16 v[180:183], v[44:47], v[132:135], v[180:183]
  s_waitcnt vmcnt(22)
  v_cmp_gt_u32 vcc, v19, v27
  s_cmp_le_u32 s50, s40
  s_cbranch_scc1 pv_315
  s_cbranch_vccnz pv_315
  s_lshl_b32 s61, s40, 21
  s_lshl_b32 s21, s40, 13
  s_and_b32 s21, s21, 8192
  s_xor_b32 s21, s21, s80
  s_add_u32 s61, s61, s21
  s_lshl_b32 s21, s20, 15
  s_add_u32 s47, s54, s21
  s_add_u32 s48, s61, s60
  s_xor_b32 s68, s61, 8192
  s_add_u32 s68, s68, s53
  s_add_u32 s70, s55, s42
  s_xor_b32 s70, s70, 0
  s_waitcnt vmcnt(42)
  v_mfma_f32_16x16x32_bf16 v[148:151], a[80:83], v[96:99], v[148:151]
  v_mfma_f32_16x16x32_bf16 v[144:147], a[80:83], v[100:103], v[144:147]
  buffer_load_dwordx4 a[0:3], v4, s[16:19], s68 offen offset:0 sc1
  v_mfma_f32_16x16x32_bf16 v[156:159], a[84:87], v[96:99], v[156:159]
  v_mfma_f32_16x16x32_bf16 v[152:155], a[84:87], v[100:103], v[152:155]
  v_mfma_f32_16x16x32_bf16 v[164:167], a[88:91], v[96:99], v[164:167]
  buffer_load_dwordx4 a[4:7], v4, s[16:19], s68 offen offset:1024 sc1
  v_mfma_f32_16x16x32_bf16 v[160:163], a[88:91], v[100:103], v[160:163]
  v_mfma_f32_16x16x32_bf16 v[172:175], a[92:95], v[96:99], v[172:175]
  v_mfma_f32_16x16x32_bf16 v[168:171], a[92:95], v[100:103], v[168:171]
  buffer_load_dwordx4 v[32:35], v22, s[16:19], s48 offen offset:0 sc1
  v_mfma_f32_16x16x32_bf16 v[180:183], a[96:99], v[96:99], v[180:183]
  v_mfma_f32_16x16x32_bf16 v[176:179], a[96:99], v[100:103], v[176:179]
  s_waitcnt vmcnt(36)
  v_mfma_f32_16x16x32_bf16 v[148:151], a[100:103], v[104:107], v[148:151]
  buffer_load_dwordx4 a[8:11], v4, s[16:19], s70 offen sc1
  s_add_u32 s70, s70, 16384
  v_mfma_f32_16x16x32_bf16 v[144:147], a[100:103], v[108:111], v[144:147]
  v_mfma_f32_16x16x32_bf16 v[156:159], a[104:107], v[104:107], v[156:159]
  v_mfma_f32_16x16x32_bf16 v[152:155], a[104:107], v[108:111], v[152:155]
  buffer_load_dwordx4 a[12:15], v4, s[16:19], s68 offen offset:2048 sc1
  v_mfma_f32_16x16x32_bf16 v[164:167], a[108:111], v[104:107], v[164:167]
  v_mfma_f32_16x16x32_bf16 v[160:163], a[108:111], v[108:111], v[160:163]
  buffer_load_dwordx4 a[16:19], v4, s[16:19], s68 offen offset:3072 sc1
  s_add_u32 s68, s68, 65536
  v_mfma_f32_16x16x32_bf16 v[172:175], a[112:115], v[104:107], v[172:175]
  v_mfma_f32_16x16x32_bf16 v[168:171], a[112:115], v[108:111], v[168:171]
  v_mfma_f32_16x16x32_bf16 v[180:183], a[116:119], v[104:107], v[180:183]
  buffer_load_dwordx4 v[64:67], v4, s[16:19], s47 offen sc1
  v_mfma_f32_16x16x32_bf16 v[176:179], a[116:119], v[108:111], v[176:179]
  s_waitcnt vmcnt(31)
  v_mfma_f32_16x16x32_bf16 v[148:151], a[120:123], v[112:115], v[148:151]
  v_mfma_f32_16x16x32_bf16 v[144:147], a[120:123], v[116:119], v[144:147]
  buffer_load_dwordx2 v[68:69], v5, s[16:19], s47 offen offset:2048 sc1
  v_mfma_f32_16x16x32_bf16 v[156:159], a[124:127], v[112:115], v[156:159]
  v_mfma_f32_16x16x32_bf16 v[152:155], a[124:127], v[116:119], v[152:155]
  v_mfma_f32_16x16x32_bf16 v[164:167], a[128:131], v[112:115], v[164:167]
  buffer_load_dwordx4 v[128:131], v21, s[16:19], s47 offen offset:1024 sc1
  s_add_u32 s47, s47, 2560
  v_mfma_f32_16x16x32_bf16 v[160:163], a[128:131], v[116:119], v[160:163]
  v_mfma_f32_16x16x32_bf16 v[172:175], a[132:135], v[112:115], v[172:175]
  v_mfma_f32_16x16x32_bf16 v[168:171], a[132:135], v[116:119], v[168:171]
  buffer_load_dwordx4 a[20:23], v4, s[16:19], s68 offen offset:0 sc1
  v_mfma_f32_16x16x32_bf16 v[180:183], a[136:139], v[112:115], v[180:183]
  v_mfma_f32_16x16x32_bf16 v[176:179], a[136:139], v[116:119], v[176:179]
  s_waitcnt vmcnt(24)
  v_mfma_f32_16x16x32_bf16 v[148:151], a[140:143], v[120:123], v[148:151]
  buffer_load_dwordx4 a[24:27], v4, s[16:19], s68 offen offset:1024 sc1
  v_mfma_f32_16x16x32_bf16 v[144:147], a[140:143], v[124:127], v[144:147]
  v_mfma_f32_16x16x32_bf16 v[156:159], a[144:147], v[120:123], v[156:159]
  v_mfma_f32_16x16x32_bf16 v[152:155], a[144:147], v[124:127], v[152:155]
  buffer_load_dwordx4 v[40:43], v28, s[16:19], s48 offen offset:0 sc1
  v_mfma_f32_16x16x32_bf16 v[164:167], a[148:151], v[120:123], v[164:167]
  v_mfma_f32_16x16x32_bf16 v[160:163], a[148:151], v[124:127], v[160:163]
  v_mfma_f32_16x16x32_bf16 v[172:175], a[152:155], v[120:123], v[172:175]
  buffer_load_dwordx4 a[28:31], v4, s[16:19], s70 offen sc1
  s_add_u32 s70, s70, 16384
  v_mfma_f32_16x16x32_bf16 v[168:171], a[152:155], v[124:127], v[168:171]
  v_mfma_f32_16x16x32_bf16 v[180:183], a[156:159], v[120:123], v[180:183]
  v_mfma_f32_16x16x32_bf16 v[176:179], a[156:159], v[124:127], v[176:179]
  buffer_load_dwordx4 a[32:35], v4, s[16:19], s68 offen offset:2048 sc1
  v_swap_b32 v138, v140
  v_swap_b32 v139, v141
  v_swap_b32 v50, v52
  v_swap_b32 v51, v53
  v_swap_b32 v58, v60
  v_swap_b32 v59, v61
  s_nop 1
  v_mfma_f32_16x16x32_bf16 v[144:147], v[48:51], v[136:139], v[144:147]
  buffer_load_dwordx4 a[36:39], v4, s[16:19], s68 offen offset:3072 sc1
  s_add_u32 s68, s68, 65536
  v_mfma_f32_16x16x32_bf16 v[148:151], v[48:51], v[140:143], v[148:151]
  v_mfma_f32_16x16x32_bf16 v[152:155], v[52:55], v[136:139], v[152:155]
  v_mfma_f32_16x16x32_bf16 v[156:159], v[52:55], v[140:143], v[156:159]
  buffer_load_dwordx2 v[184:185], v14, s[16:19], s48 offen offset:512 sc1
  v_mfma_f32_16x16x32_bf16 v[160:163], v[188:191], v[136:139], v[160:163]
  v_mfma_f32_16x16x32_bf16 v[164:167], v[188:191], v[140:143], v[164:167]
  v_mfma_f32_16x16x32_bf16 v[168:171], v[56:59], v[136:139], v[168:171]
  buffer_load_dwordx4 v[72:75], v4, s[16:19], s47 offen sc1
  v_mfma_f32_16x16x32_bf16 v[172:175], v[56:59], v[140:143], v[172:175]
  v_mfma_f32_16x16x32_bf16 v[176:179], v[60:63], v[136:139], v[176:179]
  v_mfma_f32_16x16x32_bf16 v[180:183], v[60:63], v[140:143], v[180:183]
  buffer_load_dwordx2 v[76:77], v5, s[16:19], s47 offen offset:2048 sc1
  s_add_u32 s47, s47, 13824
  s_nop 0
  ds_write_b128 v10, v[144:147] offset:0
  buffer_load_dwordx4 a[40:43], v4, s[16:19], s68 offen offset:0 sc1
  ds_write_b128 v10, v[148:151] offset:1024
  buffer_load_dwordx4 a[44:47], v4, s[16:19], s68 offen offset:1024 sc1
  ds_write_b128 v10, v[152:155] offset:2048
  ds_write_b128 v10, v[156:159] offset:3072
  buffer_load_dwordx4 v[36:39], v22, s[16:19], s48 offen offset:1280 sc1
  ds_write_b128 v10, v[160:163] offset:4096
  buffer_load_dwordx4 a[48:51], v4, s[16:19], s70 offen sc1
  s_add_u32 s70, s70, 16384
  ds_write_b128 v10, v[164:167] offset:5120
  buffer_load_dwordx4 a[52:55], v4, s[16:19], s68 offen offset:2048 sc1
  ds_write_b128 v10, v[168:171] offset:6144
  buffer_load_dwordx4 a[56:59], v4, s[16:19], s68 offen offset:3072 sc1
  s_add_u32 s68, s68, 65536
  ds_write_b128 v10, v[172:175] offset:7168
  buffer_load_dwordx4 v[80:83], v4, s[16:19], s47 offen sc1
  s_nop 1
  ds_write_b128 v10, v[176:179] offset:8192
  buffer_load_dwordx2 v[84:85], v5, s[16:19], s47 offen offset:2048 sc1
  ds_write_b128 v10, v[180:183] offset:9216
  buffer_load_dwordx4 v[132:135], v21, s[16:19], s47 offen offset:1024 sc1
  s_add_u32 s47, s47, 2560
  s_waitcnt lgkmcnt(0)
  s_barrier
  ds_read_b128 v[144:147], v11 offset:0
  ds_read_b128 v[148:151], v11 offset:10240
  ds_read_b128 v[152:155], v11 offset:20480
  ds_read_b128 v[156:159], v11 offset:30720
  ds_read_b128 v[160:163], v11 offset:2048
  ds_read_b128 v[164:167], v11 offset:12288
  ds_read_b128 v[168:171], v11 offset:22528
  ds_read_b128 v[172:175], v11 offset:32768
  s_waitcnt lgkmcnt(4)
  buffer_load_dwordx4 a[60:63], v4, s[16:19], s68 offen offset:0 sc1
  v_pk_add_f32 v[144:145], v[144:145], v[148:149]
  v_pk_add_f32 v[152:153], v[152:153], v[156:157]
  v_pk_add_f32 v[146:147], v[146:147], v[150:151]
  v_pk_add_f32 v[154:155], v[154:155], v[158:159]
  v_pk_add_f32 v[176:177], v[144:145], v[152:153]
  v_pk_add_f32 v[178:179], v[146:147], v[154:155]
  ds_read_b128 v[144:147], v12 offset:0
  ds_read_b128 v[148:151], v12 offset:10240
  ds_read_b128 v[152:155], v12 offset:20480
  ds_read_b128 v[156:159], v12 offset:30720
  v_cvt_pk_bf16_f32 v26, v176, v177
  buffer_load_dwordx4 a[64:67], v4, s[16:19], s68 offen offset:1024 sc1
  v_lshlrev_b32 v176, 16, v26
  v_and_b32 v177, 0xffff0000, v26
  v_mul_f32 v176, v176, v24
  v_mul_f32 v177, v177, v24
  v_cvt_pk_bf16_f32 v26, v176, v177
  v_lshlrev_b32 v176, 16, v26
  v_and_b32 v177, 0xffff0000, v26
  v_add_f32 v176, v176, v240
  v_add_f32 v177, v177, v241
  v_cvt_pk_bf16_f32 v236, v176, v177
  v_cvt_pk_bf16_f32 v26, v178, v179
  v_lshlrev_b32 v178, 16, v26
  buffer_load_dwordx4 v[44:47], v28, s[16:19], s48 offen offset:1280 sc1
  v_and_b32 v179, 0xffff0000, v26
  v_mul_f32 v178, v178, v24
  v_mul_f32 v179, v179, v24
  v_cvt_pk_bf16_f32 v26, v178, v179
  v_lshlrev_b32 v178, 16, v26
  v_and_b32 v179, 0xffff0000, v26
  v_add_f32 v178, v178, v242
  v_add_f32 v179, v179, v243
  v_cvt_pk_bf16_f32 v237, v178, v179
  s_waitcnt lgkmcnt(4)
  v_pk_add_f32 v[160:161], v[160:161], v[164:165]
  v_pk_add_f32 v[168:169], v[168:169], v[172:173]
  buffer_load_dwordx4 a[68:71], v4, s[16:19], s70 offen sc1
  s_add_u32 s70, s70, 16384
  v_pk_add_f32 v[162:163], v[162:163], v[166:167]
  v_pk_add_f32 v[170:171], v[170:171], v[174:175]
  v_pk_add_f32 v[176:177], v[160:161], v[168:169]
  v_pk_add_f32 v[178:179], v[162:163], v[170:171]
  v_cvt_pk_bf16_f32 v26, v176, v177
  v_lshlrev_b32 v176, 16, v26
  v_and_b32 v177, 0xffff0000, v26
  v_mul_f32 v176, v176, v24
  v_mul_f32 v177, v177, v24
  v_cvt_pk_bf16_f32 v26, v176, v177
  v_lshlrev_b32 v176, 16, v26
  buffer_load_dwordx4 a[72:75], v4, s[16:19], s68 offen offset:2048 sc1
  v_and_b32 v177, 0xffff0000, v26
  v_add_f32 v176, v176, v244
  v_add_f32 v177, v177, v245
  v_cvt_pk_bf16_f32 v238, v176, v177
  v_cvt_pk_bf16_f32 v26, v178, v179
  v_lshlrev_b32 v178, 16, v26
  v_and_b32 v179, 0xffff0000, v26
  v_mul_f32 v178, v178, v24
  v_mul_f32 v179, v179, v24
  v_cvt_pk_bf16_f32 v26, v178, v179
  v_lshlrev_b32 v178, 16, v26
  v_and_b32 v179, 0xffff0000, v26
  buffer_load_dwordx4 a[76:79], v4, s[16:19], s68 offen offset:3072 sc1
  s_add_u32 s68, s68, 65536
  v_add_f32 v178, v178, v246
  v_add_f32 v179, v179, v247
  v_cvt_pk_bf16_f32 v239, v178, v179
  buffer_store_dwordx4 v[236:239], v9, s[8:11], s46 offen
  s_cmp_lt_u32 s20, 2
  s_cselect_b32 s49, s49, 0x40000000
  s_waitcnt lgkmcnt(0)
  v_pk_add_f32 v[144:145], v[144:145], v[148:149]
  v_pk_add_f32 v[152:153], v[152:153], v[156:157]
  v_pk_add_f32 v[146:147], v[146:147], v[150:151]
  v_pk_add_f32 v[154:155], v[154:155], v[158:159]
  buffer_load_dwordx2 v[186:187], v14, s[16:19], s48 offen offset:1792 sc1
  s_add_u32 s48, s48, 262144
  v_pk_add_f32 v[176:177], v[144:145], v[152:153]
  v_pk_add_f32 v[178:179], v[146:147], v[154:155]
  v_cvt_pk_bf16_f32 v26, v176, v177
  v_lshlrev_b32 v176, 16, v26
  v_and_b32 v177, 0xffff0000, v26
  v_mul_f32 v176, v176, v24
  v_mul_f32 v177, v177, v24
  v_cvt_pk_bf16_f32 v26, v176, v177
  v_lshlrev_b32 v176, 16, v26
  v_and_b32 v177, 0xffff0000, v26
  v_add_f32 v176, v176, v248
  v_add_f32 v177, v177, v249
  buffer_load_dwordx4 v[88:91], v4, s[16:19], s47 offen sc1
  v_cvt_pk_bf16_f32 v234, v176, v177
  v_cvt_pk_bf16_f32 v26, v178, v179
  v_lshlrev_b32 v178, 16, v26
  v_and_b32 v179, 0xffff0000, v26
  v_mul_f32 v178, v178, v24
  v_mul_f32 v179, v179, v24
  v_cvt_pk_bf16_f32 v26, v178, v179
  v_lshlrev_b32 v178, 16, v26
  v_and_b32 v179, 0xffff0000, v26
  v_add_f32 v178, v178, v250
  v_add_f32 v179, v179, v251
  v_cvt_pk_bf16_f32 v235, v178, v179
  buffer_load_dwordx2 v[92:93], v5, s[16:19], s47 offen offset:2048 sc1
  s_add_u32 s47, s47, 13824
  buffer_store_dwordx2 v[234:235], v13, s[8:11], s49 offen offset:64
  s_branch pv_loop
pv_315:
  s_waitcnt vmcnt(42)
  v_mfma_f32_16x16x32_bf16 v[148:151], a[80:83], v[96:99], v[148:151]
  v_mfma_f32_16x16x32_bf16 v[144:147], a[80:83], v[100:103], v[144:147]
  v_mfma_f32_16x16x32_bf16 v[156:159], a[84:87], v[96:99], v[156:159]
  v_mfma_f32_16x16x32_bf16 v[152:155], a[84:87], v[100:103], v[152:155]
  v_mfma_f32_16x16x32_bf16 v[164:167], a[88:91], v[96:99], v[164:167]
  v_mfma_f32_16x16x32_bf16 v[160:163], a[88:91], v[100:103], v[160:163]
  v_mfma_f32_16x16x32_bf16 v[172:175], a[92:95], v[96:99], v[172:175]
  v_mfma_f32_16x16x32_bf16 v[168:171], a[92:95], v[100:103], v[168:171]
  v_mfma_f32_16x16x32_bf16 v[180:183], a[96:99], v[96:99], v[180:183]
  v_mfma_f32_16x16x32_bf16 v[176:179], a[96:99], v[100:103], v[176:179]
  s_waitcnt vmcnt(33)
  v_mfma_f32_16x16x32_bf16 v[148:151], a[100:103], v[104:107], v[148:151]
  v_mfma_f32_16x16x32_bf16 v[144:147], a[100:103], v[108:111], v[144:147]
  v_mfma_f32_16x16x32_bf16 v[156:159], a[104:107], v[104:107], v[156:159]
  v_mfma_f32_16x16x32_bf16 v[152:155], a[104:107], v[108:111], v[152:155]
  v_mfma_f32_16x16x32_bf16 v[164:167], a[108:111], v[104:107], v[164:167]
  v_mfma_f32_16x16x32_bf16 v[160:163], a[108:111], v[108:111], v[160:163]
  v_mfma_f32_16x16x32_bf16 v[172:175], a[112:115], v[104:107], v[172:175]
  v_mfma_f32_16x16x32_bf16 v[168:171], a[112:115], v[108:111], v[168:171]
  v_mfma_f32_16x16x32_bf16 v[180:183], a[116:119], v[104:107], v[180:183]
  v_mfma_f32_16x16x32_bf16 v[176:179], a[116:119], v[108:111], v[176:179]
  s_waitcnt vmcnt(24)
  v_mfma_f32_16x16x32_bf16 v[148:151], a[120:123], v[112:115], v[148:151]
  v_mfma_f32_16x16x32_bf16 v[144:147], a[120:123], v[116:119], v[144:147]
  v_mfma_f32_16x16x32_bf16 v[156:159], a[124:127], v[112:115], v[156:159]
  v_mfma_f32_16x16x32_bf16 v[152:155], a[124:127], v[116:119], v[152:155]
  v_mfma_f32_16x16x32_bf16 v[164:167], a[128:131], v[112:115], v[164:167]
  v_mfma_f32_16x16x32_bf16 v[160:163], a[128:131], v[116:119], v[160:163]
  v_mfma_f32_16x16x32_bf16 v[172:175], a[132:135], v[112:115], v[172:175]
  v_mfma_f32_16x16x32_bf16 v[168:171], a[132:135], v[116:119], v[168:171]
  v_mfma_f32_16x16x32_bf16 v[180:183], a[136:139], v[112:115], v[180:183]
  v_mfma_f32_16x16x32_bf16 v[176:179], a[136:139], v[116:119], v[176:179]
  s_waitcnt vmcnt(14)
  v_mfma_f32_16x16x32_bf16 v[148:151], a[140:143], v[120:123], v[148:151]
  v_mfma_f32_16x16x32_bf16 v[144:147], a[140:143], v[124:127], v[144:147]
  v_mfma_f32_16x16x32_bf16 v[156:159], a[144:147], v[120:123], v[156:159]
  v_mfma_f32_16x16x32_bf16 v[152:155], a[144:147], v[124:127], v[152:155]
  v_mfma_f32_16x16x32_bf16 v[164:167], a[148:151], v[120:123], v[164:167]
  v_mfma_f32_16x16x32_bf16 v[160:163], a[148:151], v[124:127], v[160:163]
  v_mfma_f32_16x16x32_bf16 v[172:175], a[152:155], v[120:123], v[172:175]
  v_mfma_f32_16x16x32_bf16 v[168:171], a[152:155], v[124:127], v[168:171]
  v_mfma_f32_16x16x32_bf16 v[180:183], a[156:159], v[120:123], v[180:183]
  v_mfma_f32_16x16x32_bf16 v[176:179], a[156:159], v[124:127], v[176:179]
  v_swap_b32 v138, v140
  v_swap_b32 v139, v141
  v_swap_b32 v50, v52
  v_swap_b32 v51, v53
  v_swap_b32 v58, v60
  v_swap_b32 v59, v61
  s_nop 1
  v_mfma_f32_16x16x32_bf16 v[144:147], v[48:51], v[136:139], v[144:147]
  v_mfma_f32_16x16x32_bf16 v[148:151], v[48:51], v[140:143], v[148:151]
  v_mfma_f32_16x16x32_bf16 v[152:155], v[52:55], v[136:139], v[152:155]
  v_mfma_f32_16x16x32_bf16 v[156:159], v[52:55], v[140:143], v[156:159]
  v_mfma_f32_16x16x32_bf16 v[160:163], v[188:191], v[136:139], v[160:163]
  v_mfma_f32_16x16x32_bf16 v[164:167], v[188:191], v[140:143], v[164:167]
  v_mfma_f32_16x16x32_bf16 v[168:171], v[56:59], v[136:139], v[168:171]
  v_mfma_f32_16x16x32_bf16 v[172:175], v[56:59], v[140:143], v[172:175]
  v_mfma_f32_16x16x32_bf16 v[176:179], v[60:63], v[136:139], v[176:179]
  v_mfma_f32_16x16x32_bf16 v[180:183], v[60:63], v[140:143], v[180:183]
  s_branch pve_310
pvw_309:
  v_mfma_f32_16x16x32_bf16 v[144:147], a[160:163], v[192:195], 0
  v_mfma_f32_16x16x32_bf16 v[148:151], a[160:163], v[212:215], 0
  v_mfma_f32_16x16x32_bf16 v[152:155], a[164:167], v[192:195], 0
  v_mfma_f32_16x16x32_bf16 v[156:159], a[164:167], v[212:215], 0
  v_mfma_f32_16x16x32_bf16 v[160:163], a[168:171], v[192:195], 0
  v_mfma_f32_16x16x32_bf16 v[164:167], a[168:171], v[212:215], 0
  v_mfma_f32_16x16x32_bf16 v[168:171], a[172:175], v[192:195], 0
  v_mfma_f32_16x16x32_bf16 v[172:175], a[172:175], v[212:215], 0
  v_mfma_f32_16x16x32_bf16 v[176:179], a[176:179], v[192:195], 0
  v_mfma_f32_16x16x32_bf16 v[180:183], a[176:179], v[212:215], 0
  v_mfma_f32_16x16x32_bf16 v[144:147], a[180:183], v[196:199], v[144:147]
  v_mfma_f32_16x16x32_bf16 v[148:151], a[180:183], v[216:219], v[148:151]
  v_mfma_f32_16x16x32_bf16 v[152:155], a[184:187], v[196:199], v[152:155]
  v_mfma_f32_16x16x32_bf16 v[156:159], a[184:187], v[216:219], v[156:159]
  v_mfma_f32_16x16x32_bf16 v[160:163], a[188:191], v[196:199], v[160:163]
  v_mfma_f32_16x16x32_bf16 v[164:167], a[188:191], v[216:219], v[164:167]
  v_mfma_f32_16x16x32_bf16 v[168:171], a[192:195], v[196:199], v[168:171]
  v_mfma_f32_16x16x32_bf16 v[172:175], a[192:195], v[216:219], v[172:175]
  v_mfma_f32_16x16x32_bf16 v[176:179], a[196:199], v[196:199], v[176:179]
  v_mfma_f32_16x16x32_bf16 v[180:183], a[196:199], v[216:219], v[180:183]
  v_mfma_f32_16x16x32_bf16 v[144:147], a[200:203], v[200:203], v[144:147]
  v_mfma_f32_16x16x32_bf16 v[148:151], a[200:203], v[220:223], v[148:151]
  v_mfma_f32_16x16x32_bf16 v[152:155], a[204:207], v[200:203], v[152:155]
  v_mfma_f32_16x16x32_bf16 v[156:159], a[204:207], v[220:223], v[156:159]
  v_mfma_f32_16x16x32_bf16 v[160:163], a[208:211], v[200:203], v[160:163]
  v_mfma_f32_16x16x32_bf16 v[164:167], a[208:211], v[220:223], v[164:167]
  v_mfma_f32_16x16x32_bf16 v[168:171], a[212:215], v[200:203], v[168:171]
  v_mfma_f32_16x16x32_bf16 v[172:175], a[212:215], v[220:223], v[172:175]
  v_mfma_f32_16x16x32_bf16 v[176:179], a[216:219], v[200:203], v[176:179]
  v_mfma_f32_16x16x32_bf16 v[180:183], a[216:219], v[220:223], v[180:183]
  v_mfma_f32_16x16x32_bf16 v[144:147], a[220:223], v[204:207], v[144:147]
  v_mfma_f32_16x16x32_bf16 v[148:151], a[220:223], v[224:227], v[148:151]
  v_mfma_f32_16x16x32_bf16 v[152:155], a[224:227], v[204:207], v[152:155]
  v_mfma_f32_16x16x32_bf16 v[156:159], a[224:227], v[224:227], v[156:159]
  v_mfma_f32_16x16x32_bf16 v[160:163], a[228:231], v[204:207], v[160:163]
  v_mfma_f32_16x16x32_bf16 v[164:167], a[228:231], v[224:227], v[164:167]
  v_mfma_f32_16x16x32_bf16 v[168:171], a[232:235], v[204:207], v[168:171]
  v_mfma_f32_16x16x32_bf16 v[172:175], a[232:235], v[224:227], v[172:175]
  v_mfma_f32_16x16x32_bf16 v[176:179], a[236:239], v[204:207], v[176:179]
  v_mfma_f32_16x16x32_bf16 v[180:183], a[236:239], v[224:227], v[180:183]
  v_mfma_f32_16x16x32_bf16 v[144:147], a[240:243], v[208:211], v[144:147]
  v_mfma_f32_16x16x32_bf16 v[148:151], a[240:243], v[228:231], v[148:151]
  v_mfma_f32_16x16x32_bf16 v[152:155], a[244:247], v[208:211], v[152:155]
  v_mfma_f32_16x16x32_bf16 v[156:159], a[244:247], v[228:231], v[156:159]
  v_mfma_f32_16x16x32_bf16 v[160:163], a[248:251], v[208:211], v[160:163]
  v_mfma_f32_16x16x32_bf16 v[164:167], a[248:251], v[228:231], v[164:167]
  v_mfma_f32_16x16x32_bf16 v[168:171], a[252:255], v[208:211], v[168:171]
  v_mfma_f32_16x16x32_bf16 v[172:175], a[252:255], v[228:231], v[172:175]
  v_mfma_f32_16x16x32_bf16 v[176:179], v[252:255], v[208:211], v[176:179]
  v_mfma_f32_16x16x32_bf16 v[180:183], v[252:255], v[228:231], v[180:183]
  ds_write_b128 v10, v[144:147] offset:40960
  ds_write_b128 v10, v[148:151] offset:41984
  ds_write_b128 v10, v[152:155] offset:43008
  ds_write_b128 v10, v[156:159] offset:44032
  ds_write_b128 v10, v[160:163] offset:45056
  ds_write_b128 v10, v[164:167] offset:46080
  ds_write_b128 v10, v[168:171] offset:47104
  ds_write_b128 v10, v[172:175] offset:48128
  s_nop 1
  ds_write_b128 v10, v[176:179] offset:49152
  ds_write_b128 v10, v[180:183] offset:50176
  s_waitcnt lgkmcnt(0)
  s_barrier
  ds_read_b32 v23, v30
  s_waitcnt lgkmcnt(0)
  v_readfirstlane_b32 s2, v23
  s_min_u32 s2, s2, 16
  s_cmp_eq_u32 s65, 0
  s_cselect_b32 s2, 17, s2
  v_sub_f32 v25, 1.0, v24
  v_cvt_pk_bf16_f32 v26, v25, v25
  v_lshlrev_b32 v25, 16, v26
  ds_read_b128 v[144:147], v15 offset:0
  ds_read_b128 v[148:151], v15 offset:10240
  ds_read_b128 v[152:155], v15 offset:20480
  ds_read_b128 v[156:159], v15 offset:30720
  ds_read_b128 v[160:163], v15 offset:2048
  ds_read_b128 v[164:167], v15 offset:12288
  ds_read_b128 v[168:171], v15 offset:22528
  ds_read_b128 v[172:175], v15 offset:32768
  s_waitcnt lgkmcnt(4)
  v_pk_add_f32 v[144:145], v[144:145], v[148:149]
  v_pk_add_f32 v[152:153], v[152:153], v[156:157]
  v_pk_add_f32 v[146:147], v[146:147], v[150:151]
  v_pk_add_f32 v[154:155], v[154:155], v[158:159]
  v_pk_add_f32 v[176:177], v[144:145], v[152:153]
  v_pk_add_f32 v[178:179], v[146:147], v[154:155]
  ds_read_b128 v[144:147], v16 offset:0
  ds_read_b128 v[148:151], v16 offset:10240
  ds_read_b128 v[152:155], v16 offset:20480
  ds_read_b128 v[156:159], v16 offset:30720
  v_cvt_pk_bf16_f32 v26, v176, v177
  v_lshlrev_b32 v240, 16, v26
  v_and_b32 v241, 0xffff0000, v26
  v_mul_f32 v240, v240, v25
  v_mul_f32 v241, v241, v25
  v_cvt_pk_bf16_f32 v26, v240, v241
  v_lshlrev_b32 v240, 16, v26
  v_and_b32 v241, 0xffff0000, v26
  v_cvt_pk_bf16_f32 v26, v178, v179
  v_lshlrev_b32 v242, 16, v26
  v_and_b32 v243, 0xffff0000, v26
  v_mul_f32 v242, v242, v25
  v_mul_f32 v243, v243, v25
  v_cvt_pk_bf16_f32 v26, v242, v243
  v_lshlrev_b32 v242, 16, v26
  v_and_b32 v243, 0xffff0000, v26
  s_waitcnt lgkmcnt(4)
  v_pk_add_f32 v[160:161], v[160:161], v[164:165]
  v_pk_add_f32 v[168:169], v[168:169], v[172:173]
  v_pk_add_f32 v[162:163], v[162:163], v[166:167]
  v_pk_add_f32 v[170:171], v[170:171], v[174:175]
  v_pk_add_f32 v[176:177], v[160:161], v[168:169]
  v_pk_add_f32 v[178:179], v[162:163], v[170:171]
  v_cvt_pk_bf16_f32 v26, v176, v177
  v_lshlrev_b32 v244, 16, v26
  v_and_b32 v245, 0xffff0000, v26
  v_mul_f32 v244, v244, v25
  v_mul_f32 v245, v245, v25
  v_cvt_pk_bf16_f32 v26, v244, v245
  v_lshlrev_b32 v244, 16, v26
  v_and_b32 v245, 0xffff0000, v26
  v_cvt_pk_bf16_f32 v26, v178, v179
  v_lshlrev_b32 v246, 16, v26
  v_and_b32 v247, 0xffff0000, v26
  v_mul_f32 v246, v246, v25
  v_mul_f32 v247, v247, v25
  v_cvt_pk_bf16_f32 v26, v246, v247
  v_lshlrev_b32 v246, 16, v26
  v_and_b32 v247, 0xffff0000, v26
  s_waitcnt lgkmcnt(0)
  v_pk_add_f32 v[144:145], v[144:145], v[148:149]
  v_pk_add_f32 v[152:153], v[152:153], v[156:157]
  v_pk_add_f32 v[146:147], v[146:147], v[150:151]
  v_pk_add_f32 v[154:155], v[154:155], v[158:159]
  v_pk_add_f32 v[176:177], v[144:145], v[152:153]
  v_pk_add_f32 v[178:179], v[146:147], v[154:155]
  v_cvt_pk_bf16_f32 v26, v176, v177
  v_lshlrev_b32 v248, 16, v26
  v_and_b32 v249, 0xffff0000, v26
  v_mul_f32 v248, v248, v25
  v_mul_f32 v249, v249, v25
  v_cvt_pk_bf16_f32 v26, v248, v249
  v_lshlrev_b32 v248, 16, v26
  v_and_b32 v249, 0xffff0000, v26
  v_cvt_pk_bf16_f32 v26, v178, v179
  v_lshlrev_b32 v250, 16, v26
  v_and_b32 v251, 0xffff0000, v26
  v_mul_f32 v250, v250, v25
  v_mul_f32 v251, v251, v25
  v_cvt_pk_bf16_f32 v26, v250, v251
  v_lshlrev_b32 v250, 16, v26
  v_and_b32 v251, 0xffff0000, v26
  s_cmp_ge_u32 s40, 60
  s_cbranch_scc1 pvt_316
  s_cmp_lg_u32 s20, 0
  s_cbranch_scc1 wr_318
  s_mov_b32 s101, 0
wr_317:
  buffer_load_dword v26, v18, s[72:75], 0 offen sc1
  s_add_u32 s101, s101, 1
  s_cmp_gt_u32 s101, 131072
  s_cbranch_scc1 main_end
  s_waitcnt vmcnt(0)
  v_cmp_gt_u32 vcc, v19, v26
  v_readfirstlane_b32 s100, v26
  s_nop 0
  s_cbranch_vccz wr_318
  s_sleep 2
  s_cmp_lg_u32 s100, 0
  s_cbranch_scc1 wr_317
  s_sleep 24
  s_branch wr_317
wr_318:
  s_barrier
  s_waitcnt vmcnt(10)
  buffer_load_dwordx4 v[64:67], v4, s[16:19], s47 offen sc1
  buffer_load_dwordx2 v[68:69], v5, s[16:19], s47 offen offset:2048 sc1
  buffer_load_dwordx4 v[128:131], v21, s[16:19], s47 offen offset:1024 sc1
  s_add_u32 s47, s47, 2560
  buffer_load_dwordx4 v[72:75], v4, s[16:19], s47 offen sc1
  buffer_load_dwordx2 v[76:77], v5, s[16:19], s47 offen offset:2048 sc1
  s_add_u32 s47, s47, 13824
  buffer_load_dwordx4 v[80:83], v4, s[16:19], s47 offen sc1
  buffer_load_dwordx2 v[84:85], v5, s[16:19], s47 offen offset:2048 sc1
  buffer_load_dwordx4 v[132:135], v21, s[16:19], s47 offen offset:1024 sc1
  s_add_u32 s47, s47, 2560
  buffer_load_dwordx4 v[88:91], v4, s[16:19], s47 offen sc1
  buffer_load_dwordx2 v[92:93], v5, s[16:19], s47 offen offset:2048 sc1
  s_add_u32 s47, s47, 13824
  buffer_load_dwordx4 v[32:35], v22, s[16:19], s48 offen offset:0 sc1
  buffer_load_dwordx4 v[40:43], v28, s[16:19], s48 offen offset:0 sc1
  buffer_load_dwordx2 v[184:185], v14, s[16:19], s48 offen offset:512 sc1
  buffer_load_dwordx4 v[36:39], v22, s[16:19], s48 offen offset:1280 sc1
  buffer_load_dwordx4 v[44:47], v28, s[16:19], s48 offen offset:1280 sc1
  buffer_load_dwordx2 v[186:187], v14, s[16:19], s48 offen offset:1792 sc1
  s_add_u32 s48, s48, 262144
  buffer_load_dwordx4 v[96:99], v4, s[16:19], s47 offen sc1
  buffer_load_dwordx2 v[100:101], v5, s[16:19], s47 offen offset:2048 sc1
  buffer_load_dwordx4 v[136:139], v21, s[16:19], s47 offen offset:1024 sc1
  s_add_u32 s47, s47, 2560
  buffer_load_dwordx4 v[104:107], v4, s[16:19], s47 offen sc1
  buffer_load_dwordx2 v[108:109], v5, s[16:19], s47 offen offset:2048 sc1
  s_add_u32 s47, s47, 13824
  buffer_load_dwordx4 v[112:115], v4, s[16:19], s47 offen sc1
  buffer_load_dwordx2 v[116:117], v5, s[16:19], s47 offen offset:2048 sc1
  buffer_load_dwordx4 v[140:143], v21, s[16:19], s47 offen offset:1024 sc1
  s_add_u32 s47, s47, 2560
  buffer_load_dwordx4 v[120:123], v4, s[16:19], s47 offen sc1
  buffer_load_dwordx2 v[124:125], v5, s[16:19], s47 offen offset:2048 sc1
  s_add_u32 s47, s47, 13824
  buffer_load_dwordx4 v[48:51], v22, s[16:19], s48 offen offset:0 sc1
  buffer_load_dwordx4 v[56:59], v28, s[16:19], s48 offen offset:0 sc1
  buffer_load_dwordx2 v[188:189], v14, s[16:19], s48 offen offset:512 sc1
  buffer_load_dwordx4 v[52:55], v22, s[16:19], s48 offen offset:1280 sc1
  buffer_load_dwordx4 v[60:63], v28, s[16:19], s48 offen offset:1280 sc1
  buffer_load_dwordx2 v[190:191], v14, s[16:19], s48 offen offset:1792 sc1
  s_add_u32 s48, s48, 262144
  s_lshl_b32 s40, s2, 2
  s_add_u32 s40, s40, s58
  s_lshl_b32 s21, s40, 7
  s_add_u32 s21, s21, 8192
  s_xor_b32 s21, s21, s80
  v_mov_b32 v18, s21
  v_cndmask_b32 v18, v17, v18, s[66:67]
  s_add_u32 s21, s40, 1
  v_mov_b32 v19, s21
  v_cndmask_b32 v19, v19, 32, s[66:67]
  buffer_load_dword v27, v18, s[72:75], 0 offen sc1
  s_lshl_b32 s55, s40, 19
  s_lshl_b32 s21, s40, 11
  s_and_b32 s21, s21, 8192
  s_xor_b32 s21, s21, s80
  s_add_u32 s55, s55, s21
  s_add_u32 s55, s55, 136314880
  s_lshl_b32 s21, s20, 15
  s_xor_b32 s54, s55, 8192
  s_add_u32 s54, s54, 48234496
  s_add_u32 s54, s54, s21
  s_lshl_b32 s57, s40, 1
  s_add_u32 s57, s57, s43
  s_lshl_b32 s45, s57, 6
  s_add_u32 s69, s54, 262144
  s_cmp_lt_u32 s2, 16
  s_cselect_b32 s69, s69, 0x40000000
  s_cmp_lt_u32 s2, 12
  s_cselect_b32 s65, s87, 0
  s_cmp_gt_u32 s65, 1
  s_cselect_b32 s64, s59, 0x40000000
  s_cselect_b32 s65, 1, 0
  v_mov_b32 v29, 1
  buffer_atomic_add v29, v233, s[72:75], s64 offen sc0 sc1
  buffer_load_dword v232, v6, s[28:31], s45 offen sc1
  buffer_load_dwordx4 v[192:195], v4, s[16:19], s69 offen offset:0 sc1
  buffer_load_dwordx4 v[196:199], v4, s[16:19], s69 offen offset:1024 sc1
  buffer_load_dwordx2 v[208:209], v5, s[16:19], s69 offen offset:2048 sc1
  s_add_u32 s69, s69, 2560
  buffer_load_dwordx4 v[200:203], v4, s[16:19], s69 offen offset:0 sc1
  buffer_load_dwordx4 v[204:207], v4, s[16:19], s69 offen offset:1024 sc1
  buffer_load_dwordx2 v[210:211], v5, s[16:19], s69 offen offset:2048 sc1
  s_add_u32 s69, s69, 13824
  buffer_load_dwordx4 v[212:215], v4, s[16:19], s69 offen offset:0 sc1
  buffer_load_dwordx4 v[216:219], v4, s[16:19], s69 offen offset:1024 sc1
  buffer_load_dwordx2 v[228:229], v5, s[16:19], s69 offen offset:2048 sc1
  s_add_u32 s69, s69, 2560
  buffer_load_dwordx4 v[220:223], v4, s[16:19], s69 offen offset:0 sc1
  buffer_load_dwordx4 v[224:227], v4, s[16:19], s69 offen offset:1024 sc1
  buffer_load_dwordx2 v[230:231], v5, s[16:19], s69 offen offset:2048 sc1
  s_add_u32 s69, s69, 13824
  s_waitcnt vmcnt(45)
  v_mfma_f32_16x16x32_bf16 v[148:151], a[0:3], v[64:67], 0
  v_mfma_f32_16x16x32_bf16 v[144:147], a[0:3], v[68:71], 0
  v_mfma_f32_16x16x32_bf16 v[156:159], a[4:7], v[64:67], 0
  v_mfma_f32_16x16x32_bf16 v[152:155], a[4:7], v[68:71], 0
  v_mfma_f32_16x16x32_bf16 v[164:167], a[8:11], v[64:67], 0
  v_mfma_f32_16x16x32_bf16 v[160:163], a[8:11], v[68:71], 0
  v_mfma_f32_16x16x32_bf16 v[172:175], a[12:15], v[64:67], 0
  v_mfma_f32_16x16x32_bf16 v[168:171], a[12:15], v[68:71], 0
  v_mfma_f32_16x16x32_bf16 v[180:183], a[16:19], v[64:67], 0
  v_mfma_f32_16x16x32_bf16 v[176:179], a[16:19], v[68:71], 0
  s_waitcnt vmcnt(42)
  v_mfma_f32_16x16x32_bf16 v[148:151], a[20:23], v[72:75], v[148:151]
  v_mfma_f32_16x16x32_bf16 v[144:147], a[20:23], v[76:79], v[144:147]
  v_mfma_f32_16x16x32_bf16 v[156:159], a[24:27], v[72:75], v[156:159]
  v_mfma_f32_16x16x32_bf16 v[152:155], a[24:27], v[76:79], v[152:155]
  v_mfma_f32_16x16x32_bf16 v[164:167], a[28:31], v[72:75], v[164:167]
  v_mfma_f32_16x16x32_bf16 v[160:163], a[28:31], v[76:79], v[160:163]
  v_mfma_f32_16x16x32_bf16 v[172:175], a[32:35], v[72:75], v[172:175]
  v_mfma_f32_16x16x32_bf16 v[168:171], a[32:35], v[76:79], v[168:171]
  v_mfma_f32_16x16x32_bf16 v[180:183], a[36:39], v[72:75], v[180:183]
  v_mfma_f32_16x16x32_bf16 v[176:179], a[36:39], v[76:79], v[176:179]
  s_waitcnt vmcnt(40)
  v_mfma_f32_16x16x32_bf16 v[148:151], a[40:43], v[80:83], v[148:151]
  v_mfma_f32_16x16x32_bf16 v[144:147], a[40:43], v[84:87], v[144:147]
  v_mfma_f32_16x16x32_bf16 v[156:159], a[44:47], v[80:83], v[156:159]
  v_mfma_f32_16x16x32_bf16 v[152:155], a[44:47], v[84:87], v[152:155]
  v_mfma_f32_16x16x32_bf16 v[164:167], a[48:51], v[80:83], v[164:167]
  v_mfma_f32_16x16x32_bf16 v[160:163], a[48:51], v[84:87], v[160:163]
  v_mfma_f32_16x16x32_bf16 v[172:175], a[52:55], v[80:83], v[172:175]
  v_mfma_f32_16x16x32_bf16 v[168:171], a[52:55], v[84:87], v[168:171]
  v_mfma_f32_16x16x32_bf16 v[180:183], a[56:59], v[80:83], v[180:183]
  v_mfma_f32_16x16x32_bf16 v[176:179], a[56:59], v[84:87], v[176:179]
  s_waitcnt vmcnt(37)
  v_mfma_f32_16x16x32_bf16 v[148:151], a[60:63], v[88:91], v[148:151]
  v_mfma_f32_16x16x32_bf16 v[144:147], a[60:63], v[92:95], v[144:147]
  v_mfma_f32_16x16x32_bf16 v[156:159], a[64:67], v[88:91], v[156:159]
  v_mfma_f32_16x16x32_bf16 v[152:155], a[64:67], v[92:95], v[152:155]
  v_mfma_f32_16x16x32_bf16 v[164:167], a[68:71], v[88:91], v[164:167]
  v_mfma_f32_16x16x32_bf16 v[160:163], a[68:71], v[92:95], v[160:163]
  v_mfma_f32_16x16x32_bf16 v[172:175], a[72:75], v[88:91], v[172:175]
  v_mfma_f32_16x16x32_bf16 v[168:171], a[72:75], v[92:95], v[168:171]
  v_mfma_f32_16x16x32_bf16 v[180:183], a[76:79], v[88:91], v[180:183]
  v_mfma_f32_16x16x32_bf16 v[176:179], a[76:79], v[92:95], v[176:179]
  s_waitcnt vmcnt(31)
  v_swap_b32 v130, v132
  v_swap_b32 v131, v133
  v_swap_b32 v34, v36
  v_swap_b32 v35, v37
  v_swap_b32 v42, v44
  v_swap_b32 v43, v45
  s_nop 1
  v_mfma_f32_16x16x32_bf16 v[144:147], v[32:35], v[128:131], v[144:147]
  v_mfma_f32_16x16x32_bf16 v[148:151], v[32:35], v[132:135], v[148:151]
  v_mfma_f32_16x16x32_bf16 v[152:155], v[36:39], v[128:131], v[152:155]
  v_mfma_f32_16x16x32_bf16 v[156:159], v[36:39], v[132:135], v[156:159]
  v_mfma_f32_16x16x32_bf16 v[160:163], v[184:187], v[128:131], v[160:163]
  v_mfma_f32_16x16x32_bf16 v[164:167], v[184:187], v[132:135], v[164:167]
  v_mfma_f32_16x16x32_bf16 v[168:171], v[40:43], v[128:131], v[168:171]
  v_mfma_f32_16x16x32_bf16 v[172:175], v[40:43], v[132:135], v[172:175]
  v_mfma_f32_16x16x32_bf16 v[176:179], v[44:47], v[128:131], v[176:179]
  v_mfma_f32_16x16x32_bf16 v[180:183], v[44:47], v[132:135], v[180:183]
  s_waitcnt vmcnt(29)
  v_mfma_f32_16x16x32_bf16 v[148:151], a[80:83], v[96:99], v[148:151]
  v_mfma_f32_16x16x32_bf16 v[144:147], a[80:83], v[100:103], v[144:147]
  v_mfma_f32_16x16x32_bf16 v[156:159], a[84:87], v[96:99], v[156:159]
  v_mfma_f32_16x16x32_bf16 v[152:155], a[84:87], v[100:103], v[152:155]
  v_mfma_f32_16x16x32_bf16 v[164:167], a[88:91], v[96:99], v[164:167]
  v_mfma_f32_16x16x32_bf16 v[160:163], a[88:91], v[100:103], v[160:163]
  v_mfma_f32_16x16x32_bf16 v[172:175], a[92:95], v[96:99], v[172:175]
  v_mfma_f32_16x16x32_bf16 v[168:171], a[92:95], v[100:103], v[168:171]
  v_mfma_f32_16x16x32_bf16 v[180:183], a[96:99], v[96:99], v[180:183]
  v_mfma_f32_16x16x32_bf16 v[176:179], a[96:99], v[100:103], v[176:179]
  s_waitcnt vmcnt(26)
  v_mfma_f32_16x16x32_bf16 v[148:151], a[100:103], v[104:107], v[148:151]
  v_mfma_f32_16x16x32_bf16 v[144:147], a[100:103], v[108:111], v[144:147]
  v_mfma_f32_16x16x32_bf16 v[156:159], a[104:107], v[104:107], v[156:159]
  v_mfma_f32_16x16x32_bf16 v[152:155], a[104:107], v[108:111], v[152:155]
  v_mfma_f32_16x16x32_bf16 v[164:167], a[108:111], v[104:107], v[164:167]
  v_mfma_f32_16x16x32_bf16 v[160:163], a[108:111], v[108:111], v[160:163]
  v_mfma_f32_16x16x32_bf16 v[172:175], a[112:115], v[104:107], v[172:175]
  v_mfma_f32_16x16x32_bf16 v[168:171], a[112:115], v[108:111], v[168:171]
  v_mfma_f32_16x16x32_bf16 v[180:183], a[116:119], v[104:107], v[180:183]
  v_mfma_f32_16x16x32_bf16 v[176:179], a[116:119], v[108:111], v[176:179]
  s_waitcnt vmcnt(24)
  v_mfma_f32_16x16x32_bf16 v[148:151], a[120:123], v[112:115], v[148:151]
  v_mfma_f32_16x16x32_bf16 v[144:147], a[120:123], v[116:119], v[144:147]
  v_mfma_f32_16x16x32_bf16 v[156:159], a[124:127], v[112:115], v[156:159]
  v_mfma_f32_16x16x32_bf16 v[152:155], a[124:127], v[116:119], v[152:155]
  v_mfma_f32_16x16x32_bf16 v[164:167], a[128:131], v[112:115], v[164:167]
  v_mfma_f32_16x16x32_bf16 v[160:163], a[128:131], v[116:119], v[160:163]
  v_mfma_f32_16x16x32_bf16 v[172:175], a[132:135], v[112:115], v[172:175]
  v_mfma_f32_16x16x32_bf16 v[168:171], a[132:135], v[116:119], v[168:171]
  v_mfma_f32_16x16x32_bf16 v[180:183], a[136:139], v[112:115], v[180:183]
  v_mfma_f32_16x16x32_bf16 v[176:179], a[136:139], v[116:119], v[176:179]
  s_waitcnt vmcnt(21)
  v_mfma_f32_16x16x32_bf16 v[148:151], a[140:143], v[120:123], v[148:151]
  v_mfma_f32_16x16x32_bf16 v[144:147], a[140:143], v[124:127], v[144:147]
  v_mfma_f32_16x16x32_bf16 v[156:159], a[144:147], v[120:123], v[156:159]
  v_mfma_f32_16x16x32_bf16 v[152:155], a[144:147], v[124:127], v[152:155]
  v_mfma_f32_16x16x32_bf16 v[164:167], a[148:151], v[120:123], v[164:167]
  v_mfma_f32_16x16x32_bf16 v[160:163], a[148:151], v[124:127], v[160:163]
  v_mfma_f32_16x16x32_bf16 v[172:175], a[152:155], v[120:123], v[172:175]
  v_mfma_f32_16x16x32_bf16 v[168:171], a[152:155], v[124:127], v[168:171]
  v_mfma_f32_16x16x32_bf16 v[180:183], a[156:159], v[120:123], v[180:183]
  v_mfma_f32_16x16x32_bf16 v[176:179], a[156:159], v[124:127], v[176:179]
  s_waitcnt vmcnt(15)
  v_swap_b32 v138, v140
  v_swap_b32 v139, v141
  v_swap_b32 v50, v52
  v_swap_b32 v51, v53
  v_swap_b32 v58, v60
  v_swap_b32 v59, v61
  s_nop 1
  v_mfma_f32_16x16x32_bf16 v[144:147], v[48:51], v[136:139], v[144:147]
  v_mfma_f32_16x16x32_bf16 v[148:151], v[48:51], v[140:143], v[148:151]
  v_mfma_f32_16x16x32_bf16 v[152:155], v[52:55], v[136:139], v[152:155]
  v_mfma_f32_16x16x32_bf16 v[156:159], v[52:55], v[140:143], v[156:159]
  v_mfma_f32_16x16x32_bf16 v[160:163], v[188:191], v[136:139], v[160:163]
  v_mfma_f32_16x16x32_bf16 v[164:167], v[188:191], v[140:143], v[164:167]
  v_mfma_f32_16x16x32_bf16 v[168:171], v[56:59], v[136:139], v[168:171]
  v_mfma_f32_16x16x32_bf16 v[172:175], v[56:59], v[140:143], v[172:175]
  v_mfma_f32_16x16x32_bf16 v[176:179], v[60:63], v[136:139], v[176:179]
  v_mfma_f32_16x16x32_bf16 v[180:183], v[60:63], v[140:143], v[180:183]
  s_branch pve_310
pvt_316:
  s_min_u32 s21, s40, 62
  v_mov_b32 v19, s21
  v_mov_b32 v18, v17
  s_cmp_lg_u32 s20, 0
  s_cbranch_scc1 wr_320
  s_mov_b32 s101, 0
wr_319:
  buffer_load_dword v26, v18, s[72:75], 0 offen sc1
  s_add_u32 s101, s101, 1
  s_cmp_gt_u32 s101, 131072
  s_cbranch_scc1 main_end
  s_waitcnt vmcnt(0)
  v_cmp_gt_u32 vcc, v19, v26
  v_readfirstlane_b32 s100, v26
  s_nop 0
  s_cbranch_vccz wr_320
  s_sleep 6
  s_cmp_lg_u32 s100, 0
  s_cbranch_scc1 wr_319
  s_sleep 0
  s_branch wr_319
wr_320:
  s_barrier
  s_lshl_b32 s40, s2, 2
  s_add_u32 s40, s40, s58
  s_lshl_b32 s21, s40, 7
  s_add_u32 s21, s21, 8192
  s_xor_b32 s21, s21, s80
  v_mov_b32 v18, s21
  v_cndmask_b32 v18, v17, v18, s[66:67]
  s_add_u32 s21, s40, 1
  v_mov_b32 v19, s21
  v_cndmask_b32 v19, v19, 32, s[66:67]
  buffer_load_dword v27, v18, s[72:75], 0 offen sc1
  s_lshl_b32 s55, s40, 19
  s_lshl_b32 s21, s40, 11
  s_and_b32 s21, s21, 8192
  s_xor_b32 s21, s21, s80
  s_add_u32 s55, s55, s21
  s_add_u32 s55, s55, 136314880
  s_lshl_b32 s21, s20, 15
  s_xor_b32 s54, s55, 8192
  s_add_u32 s54, s54, 48234496
  s_add_u32 s54, s54, s21
  s_lshl_b32 s57, s40, 1
  s_add_u32 s57, s57, s43
  s_lshl_b32 s45, s57, 6
  s_add_u32 s69, s54, 262144
  s_cmp_lt_u32 s2, 16
  s_cselect_b32 s69, s69, 0x40000000
  s_cmp_lt_u32 s2, 12
  s_cselect_b32 s65, s87, 0
  s_cmp_gt_u32 s65, 1
  s_cselect_b32 s64, s59, 0x40000000
  s_cselect_b32 s65, 1, 0
  v_mov_b32 v29, 1
  buffer_atomic_add v29, v233, s[72:75], s64 offen sc0 sc1
  buffer_load_dword v232, v6, s[28:31], s45 offen sc1
  buffer_load_dwordx4 v[192:195], v4, s[16:19], s69 offen offset:0 sc1
  buffer_load_dwordx4 v[196:199], v4, s[16:19], s69 offen offset:1024 sc1
  buffer_load_dwordx2 v[208:209], v5, s[16:19], s69 offen offset:2048 sc1
  s_add_u32 s69, s69, 2560
  buffer_load_dwordx4 v[200:203], v4, s[16:19], s69 offen offset:0 sc1
  buffer_load_dwordx4 v[204:207], v4, s[16:19], s69 offen offset:1024 sc1
  buffer_load_dwordx2 v[210:211], v5, s[16:19], s69 offen offset:2048 sc1
  s_add_u32 s69, s69, 13824
  buffer_load_dwordx4 v[212:215], v4, s[16:19], s69 offen offset:0 sc1
  buffer_load_dwordx4 v[216:219], v4, s[16:19], s69 offen offset:1024 sc1
  buffer_load_dwordx2 v[228:229], v5, s[16:19], s69 offen offset:2048 sc1
  s_add_u32 s69, s69, 2560
  buffer_load_dwordx4 v[220:223], v4, s[16:19], s69 offen offset:0 sc1
  buffer_load_dwordx4 v[224:227], v4, s[16:19], s69 offen offset:1024 sc1
  buffer_load_dwordx2 v[230:231], v5, s[16:19], s69 offen offset:2048 sc1
  s_add_u32 s69, s69, 13824
  s_mov_b32 s56, s48
  buffer_load_dwordx4 v[32:35], v22, s[16:19], s56 offen offset:0 sc1
  buffer_load_dwordx4 v[40:43], v28, s[16:19], s56 offen offset:0 sc1
  buffer_load_dwordx2 v[184:185], v14, s[16:19], s56 offen offset:512 sc1
  buffer_load_dwordx4 v[36:39], v22, s[16:19], s56 offen offset:1280 sc1
  buffer_load_dwordx4 v[44:47], v28, s[16:19], s56 offen offset:1280 sc1
  buffer_load_dwordx2 v[186:187], v14, s[16:19], s56 offen offset:1792 sc1
  s_add_u32 s56, s56, 262144
  buffer_load_dwordx4 v[48:51], v22, s[16:19], s56 offen offset:0 sc1
  buffer_load_dwordx4 v[56:59], v28, s[16:19], s56 offen offset:0 sc1
  buffer_load_dwordx2 v[188:189], v14, s[16:19], s56 offen offset:512 sc1
  buffer_load_dwordx4 v[52:55], v22, s[16:19], s56 offen offset:1280 sc1
  buffer_load_dwordx4 v[60:63], v28, s[16:19], s56 offen offset:1280 sc1
  buffer_load_dwordx2 v[190:191], v14, s[16:19], s56 offen offset:1792 sc1
  s_add_u32 s56, s56, 262144
  s_mov_b32 s101, 0
  s_branch pvr_322
pvr_321:
  s_sleep 6
  s_mov_b32 s56, s48
  buffer_load_dwordx4 v[32:35], v22, s[16:19], s56 offen offset:0 sc1
  buffer_load_dwordx4 v[40:43], v28, s[16:19], s56 offen offset:0 sc1
  buffer_load_dwordx2 v[184:185], v14, s[16:19], s56 offen offset:512 sc1
  buffer_load_dwordx4 v[36:39], v22, s[16:19], s56 offen offset:1280 sc1
  buffer_load_dwordx4 v[44:47], v28, s[16:19], s56 offen offset:1280 sc1
  buffer_load_dwordx2 v[186:187], v14, s[16:19], s56 offen offset:1792 sc1
  s_add_u32 s56, s56, 262144
  buffer_load_dwordx4 v[48:51], v22, s[16:19], s56 offen offset:0 sc1
  buffer_load_dwordx4 v[56:59], v28, s[16:19], s56 offen offset:0 sc1
  buffer_load_dwordx2 v[188:189], v14, s[16:19], s56 offen offset:512 sc1
  buffer_load_dwordx4 v[52:55], v22, s[16:19], s56 offen offset:1280 sc1
  buffer_load_dwordx4 v[60:63], v28, s[16:19], s56 offen offset:1280 sc1
  buffer_load_dwordx2 v[190:191], v14, s[16:19], s56 offen offset:1792 sc1
  s_add_u32 s56, s56, 262144
  s_add_u32 s101, s101, 1
  s_cmp_gt_u32 s101, 131072
  s_cbranch_scc1 main_end
pvr_322:
  s_waitcnt vmcnt(0)
  v_max3_u32 v26, v32, v36, v40
  v_max3_u32 v26, v26, v44, v184
  v_max3_u32 v26, v26, v186, v48
  v_max3_u32 v26, v26, v52, v56
  v_max3_u32 v26, v26, v60, v188
  v_max3_u32 v26, v26, v190, v190
  v_cmp_eq_u32 vcc, -1, v26
  s_nop 1
  s_cbranch_vccnz pvr_321
  s_add_u32 s56, s47, 0
  buffer_load_dwordx4 v[64:67], v4, s[16:19], s56 offen sc1
  buffer_load_dwordx2 v[68:69], v5, s[16:19], s56 offen offset:2048 sc1
  buffer_load_dwordx4 v[128:131], v21, s[16:19], s56 offen offset:1024 sc1
  s_add_u32 s56, s56, 2560
  buffer_load_dwordx4 v[72:75], v4, s[16:19], s56 offen sc1
  buffer_load_dwordx2 v[76:77], v5, s[16:19], s56 offen offset:2048 sc1
  s_add_u32 s56, s56, 13824
  buffer_load_dwordx4 v[80:83], v4, s[16:19], s56 offen sc1
  buffer_load_dwordx2 v[84:85], v5, s[16:19], s56 offen offset:2048 sc1
  buffer_load_dwordx4 v[132:135], v21, s[16:19], s56 offen offset:1024 sc1
  s_add_u32 s56, s56, 2560
  buffer_load_dwordx4 v[88:91], v4, s[16:19], s56 offen sc1
  buffer_load_dwordx2 v[92:93], v5, s[16:19], s56 offen offset:2048 sc1
  s_add_u32 s56, s56, 13824
  s_mov_b32 s101, 0
  s_branch pvr_324
pvr_323:
  s_sleep 2
  s_add_u32 s56, s47, 0
  buffer_load_dwordx4 v[64:67], v4, s[16:19], s56 offen sc1
  buffer_load_dwordx2 v[68:69], v5, s[16:19], s56 offen offset:2048 sc1
  buffer_load_dwordx4 v[128:131], v21, s[16:19], s56 offen offset:1024 sc1
  s_add_u32 s56, s56, 2560
  buffer_load_dwordx4 v[72:75], v4, s[16:19], s56 offen sc1
  buffer_load_dwordx2 v[76:77], v5, s[16:19], s56 offen offset:2048 sc1
  s_add_u32 s56, s56, 13824
  buffer_load_dwordx4 v[80:83], v4, s[16:19], s56 offen sc1
  buffer_load_dwordx2 v[84:85], v5, s[16:19], s56 offen offset:2048 sc1
  buffer_load_dwordx4 v[132:135], v21, s[16:19], s56 offen offset:1024 sc1
  s_add_u32 s56, s56, 2560
  buffer_load_dwordx4 v[88:91], v4, s[16:19], s56 offen sc1
  buffer_load_dwordx2 v[92:93], v5, s[16:19], s56 offen offset:2048 sc1
  s_add_u32 s56, s56, 13824
  s_add_u32 s101, s101, 1
  s_cmp_gt_u32 s101, 131072
  s_cbranch_scc1 main_end
pvr_324:
  s_waitcnt vmcnt(0)
  v_max3_u32 v26, v64, v68, v72
  v_max3_u32 v26, v26, v76, v80
  v_max3_u32 v26, v26, v84, v88
  v_max3_u32 v26, v26, v92, v128
  v_max3_u32 v26, v26, v132, v132
  v_cmp_eq_u32 vcc, -1, v26
  s_nop 1
  s_cbranch_vccnz pvr_323
  s_add_u32 s56, s47, 32768
  buffer_load_dwordx4 v[96:99], v4, s[16:19], s56 offen sc1
  buffer_load_dwordx2 v[100:101], v5, s[16:19], s56 offen offset:2048 sc1
  buffer_load_dwordx4 v[136:139], v21, s[16:19], s56 offen offset:1024 sc1
  s_add_u32 s56, s56, 2560
  buffer_load_dwordx4 v[104:107], v4, s[16:19], s56 offen sc1
  buffer_load_dwordx2 v[108:109], v5, s[16:19], s56 offen offset:2048 sc1
  s_add_u32 s56, s56, 13824
  buffer_load_dwordx4 v[112:115], v4, s[16:19], s56 offen sc1
  buffer_load_dwordx2 v[116:117], v5, s[16:19], s56 offen offset:2048 sc1
  buffer_load_dwordx4 v[140:143], v21, s[16:19], s56 offen offset:1024 sc1
  s_add_u32 s56, s56, 2560
  buffer_load_dwordx4 v[120:123], v4, s[16:19], s56 offen sc1
  buffer_load_dwordx2 v[124:125], v5, s[16:19], s56 offen offset:2048 sc1
  s_add_u32 s56, s56, 13824
  v_mfma_f32_16x16x32_bf16 v[148:151], a[0:3], v[64:67], 0
  v_mfma_f32_16x16x32_bf16 v[144:147], a[0:3], v[68:71], 0
  v_mfma_f32_16x16x32_bf16 v[156:159], a[4:7], v[64:67], 0
  v_mfma_f32_16x16x32_bf16 v[152:155], a[4:7], v[68:71], 0
  v_mfma_f32_16x16x32_bf16 v[164:167], a[8:11], v[64:67], 0
  v_mfma_f32_16x16x32_bf16 v[160:163], a[8:11], v[68:71], 0
  v_mfma_f32_16x16x32_bf16 v[172:175], a[12:15], v[64:67], 0
  v_mfma_f32_16x16x32_bf16 v[168:171], a[12:15], v[68:71], 0
  v_mfma_f32_16x16x32_bf16 v[180:183], a[16:19], v[64:67], 0
  v_mfma_f32_16x16x32_bf16 v[176:179], a[16:19], v[68:71], 0
  v_mfma_f32_16x16x32_bf16 v[148:151], a[20:23], v[72:75], v[148:151]
  v_mfma_f32_16x16x32_bf16 v[144:147], a[20:23], v[76:79], v[144:147]
  v_mfma_f32_16x16x32_bf16 v[156:159], a[24:27], v[72:75], v[156:159]
  v_mfma_f32_16x16x32_bf16 v[152:155], a[24:27], v[76:79], v[152:155]
  v_mfma_f32_16x16x32_bf16 v[164:167], a[28:31], v[72:75], v[164:167]
  v_mfma_f32_16x16x32_bf16 v[160:163], a[28:31], v[76:79], v[160:163]
  v_mfma_f32_16x16x32_bf16 v[172:175], a[32:35], v[72:75], v[172:175]
  v_mfma_f32_16x16x32_bf16 v[168:171], a[32:35], v[76:79], v[168:171]
  v_mfma_f32_16x16x32_bf16 v[180:183], a[36:39], v[72:75], v[180:183]
  v_mfma_f32_16x16x32_bf16 v[176:179], a[36:39], v[76:79], v[176:179]
  v_mfma_f32_16x16x32_bf16 v[148:151], a[40:43], v[80:83], v[148:151]
  v_mfma_f32_16x16x32_bf16 v[144:147], a[40:43], v[84:87], v[144:147]
  v_mfma_f32_16x16x32_bf16 v[156:159], a[44:47], v[80:83], v[156:159]
  v_mfma_f32_16x16x32_bf16 v[152:155], a[44:47], v[84:87], v[152:155]
  v_mfma_f32_16x16x32_bf16 v[164:167], a[48:51], v[80:83], v[164:167]
  v_mfma_f32_16x16x32_bf16 v[160:163], a[48:51], v[84:87], v[160:163]
  v_mfma_f32_16x16x32_bf16 v[172:175], a[52:55], v[80:83], v[172:175]
  v_mfma_f32_16x16x32_bf16 v[168:171], a[52:55], v[84:87], v[168:171]
  v_mfma_f32_16x16x32_bf16 v[180:183], a[56:59], v[80:83], v[180:183]
  v_mfma_f32_16x16x32_bf16 v[176:179], a[56:59], v[84:87], v[176:179]
  v_mfma_f32_16x16x32_bf16 v[148:151], a[60:63], v[88:91], v[148:151]
  v_mfma_f32_16x16x32_bf16 v[144:147], a[60:63], v[92:95], v[144:147]
  v_mfma_f32_16x16x32_bf16 v[156:159], a[64:67], v[88:91], v[156:159]
  v_mfma_f32_16x16x32_bf16 v[152:155], a[64:67], v[92:95], v[152:155]
  v_mfma_f32_16x16x32_bf16 v[164:167], a[68:71], v[88:91], v[164:167]
  v_mfma_f32_16x16x32_bf16 v[160:163], a[68:71], v[92:95], v[160:163]
  v_mfma_f32_16x16x32_bf16 v[172:175], a[72:75], v[88:91], v[172:175]
  v_mfma_f32_16x16x32_bf16 v[168:171], a[72:75], v[92:95], v[168:171]
  v_mfma_f32_16x16x32_bf16 v[180:183], a[76:79], v[88:91], v[180:183]
  v_mfma_f32_16x16x32_bf16 v[176:179], a[76:79], v[92:95], v[176:179]
  v_swap_b32 v130, v132
  v_swap_b32 v131, v133
  v_swap_b32 v34, v36
  v_swap_b32 v35, v37
  v_swap_b32 v42, v44
  v_swap_b32 v43, v45
  s_nop 1
  v_mfma_f32_16x16x32_bf16 v[144:147], v[32:35], v[128:131], v[144:147]
  v_mfma_f32_16x16x32_bf16 v[148:151], v[32:35], v[132:135], v[148:151]
  v_mfma_f32_16x16x32_bf16 v[152:155], v[36:39], v[128:131], v[152:155]
  v_mfma_f32_16x16x32_bf16 v[156:159], v[36:39], v[132:135], v[156:159]
  v_mfma_f32_16x16x32_bf16 v[160:163], v[184:187], v[128:131], v[160:163]
  v_mfma_f32_16x16x32_bf16 v[164:167], v[184:187], v[132:135], v[164:167]
  v_mfma_f32_16x16x32_bf16 v[168:171], v[40:43], v[128:131], v[168:171]
  v_mfma_f32_16x16x32_bf16 v[172:175], v[40:43], v[132:135], v[172:175]
  v_mfma_f32_16x16x32_bf16 v[176:179], v[44:47], v[128:131], v[176:179]
  v_mfma_f32_16x16x32_bf16 v[180:183], v[44:47], v[132:135], v[180:183]
  s_mov_b32 s101, 0
  s_branch pvr_326
pvr_325:
  s_sleep 1
  s_add_u32 s56, s47, 32768
  buffer_load_dwordx4 v[96:99], v4, s[16:19], s56 offen sc1
  buffer_load_dwordx2 v[100:101], v5, s[16:19], s56 offen offset:2048 sc1
  buffer_load_dwordx4 v[136:139], v21, s[16:19], s56 offen offset:1024 sc1
  s_add_u32 s56, s56, 2560
  buffer_load_dwordx4 v[104:107], v4, s[16:19], s56 offen sc1
  buffer_load_dwordx2 v[108:109], v5, s[16:19], s56 offen offset:2048 sc1
  s_add_u32 s56, s56, 13824
  buffer_load_dwordx4 v[112:115], v4, s[16:19], s56 offen sc1
  buffer_load_dwordx2 v[116:117], v5, s[16:19], s56 offen offset:2048 sc1
  buffer_load_dwordx4 v[140:143], v21, s[16:19], s56 offen offset:1024 sc1
  s_add_u32 s56, s56, 2560
  buffer_load_dwordx4 v[120:123], v4, s[16:19], s56 offen sc1
  buffer_load_dwordx2 v[124:125], v5, s[16:19], s56 offen offset:2048 sc1
  s_add_u32 s56, s56, 13824
  s_add_u32 s101, s101, 1
  s_cmp_gt_u32 s101, 131072
  s_cbranch_scc1 main_end
pvr_326:
  s_waitcnt vmcnt(0)
  v_max3_u32 v26, v96, v100, v104
  v_max3_u32 v26, v26, v108, v112
  v_max3_u32 v26, v26, v116, v120
  v_max3_u32 v26, v26, v124, v136
  v_max3_u32 v26, v26, v140, v140
  v_cmp_eq_u32 vcc, -1, v26
  s_nop 1
  s_cbranch_vccnz pvr_325
  v_mfma_f32_16x16x32_bf16 v[148:151], a[80:83], v[96:99], v[148:151]
  v_mfma_f32_16x16x32_bf16 v[144:147], a[80:83], v[100:103], v[144:147]
  v_mfma_f32_16x16x32_bf16 v[156:159], a[84:87], v[96:99], v[156:159]
  v_mfma_f32_16x16x32_bf16 v[152:155], a[84:87], v[100:103], v[152:155]
  v_mfma_f32_16x16x32_bf16 v[164:167], a[88:91], v[96:99], v[164:167]
  v_mfma_f32_16x16x32_bf16 v[160:163], a[88:91], v[100:103], v[160:163]
  v_mfma_f32_16x16x32_bf16 v[172:175], a[92:95], v[96:99], v[172:175]
  v_mfma_f32_16x16x32_bf16 v[168:171], a[92:95], v[100:103], v[168:171]
  v_mfma_f32_16x16x32_bf16 v[180:183], a[96:99], v[96:99], v[180:183]
  v_mfma_f32_16x16x32_bf16 v[176:179], a[96:99], v[100:103], v[176:179]
  v_mfma_f32_16x16x32_bf16 v[148:151], a[100:103], v[104:107], v[148:151]
  v_mfma_f32_16x16x32_bf16 v[144:147], a[100:103], v[108:111], v[144:147]
  v_mfma_f32_16x16x32_bf16 v[156:159], a[104:107], v[104:107], v[156:159]
  v_mfma_f32_16x16x32_bf16 v[152:155], a[104:107], v[108:111], v[152:155]
  v_mfma_f32_16x16x32_bf16 v[164:167], a[108:111], v[104:107], v[164:167]
  v_mfma_f32_16x16x32_bf16 v[160:163], a[108:111], v[108:111], v[160:163]
  v_mfma_f32_16x16x32_bf16 v[172:175], a[112:115], v[104:107], v[172:175]
  v_mfma_f32_16x16x32_bf16 v[168:171], a[112:115], v[108:111], v[168:171]
  v_mfma_f32_16x16x32_bf16 v[180:183], a[116:119], v[104:107], v[180:183]
  v_mfma_f32_16x16x32_bf16 v[176:179], a[116:119], v[108:111], v[176:179]
  v_mfma_f32_16x16x32_bf16 v[148:151], a[120:123], v[112:115], v[148:151]
  v_mfma_f32_16x16x32_bf16 v[144:147], a[120:123], v[116:119], v[144:147]
  v_mfma_f32_16x16x32_bf16 v[156:159], a[124:127], v[112:115], v[156:159]
  v_mfma_f32_16x16x32_bf16 v[152:155], a[124:127], v[116:119], v[152:155]
  v_mfma_f32_16x16x32_bf16 v[164:167], a[128:131], v[112:115], v[164:167]
  v_mfma_f32_16x16x32_bf16 v[160:163], a[128:131], v[116:119], v[160:163]
  v_mfma_f32_16x16x32_bf16 v[172:175], a[132:135], v[112:115], v[172:175]
  v_mfma_f32_16x16x32_bf16 v[168:171], a[132:135], v[116:119], v[168:171]
  v_mfma_f32_16x16x32_bf16 v[180:183], a[136:139], v[112:115], v[180:183]
  v_mfma_f32_16x16x32_bf16 v[176:179], a[136:139], v[116:119], v[176:179]
  v_mfma_f32_16x16x32_bf16 v[148:151], a[140:143], v[120:123], v[148:151]
  v_mfma_f32_16x16x32_bf16 v[144:147], a[140:143], v[124:127], v[144:147]
  v_mfma_f32_16x16x32_bf16 v[156:159], a[144:147], v[120:123], v[156:159]
  v_mfma_f32_16x16x32_bf16 v[152:155], a[144:147], v[124:127], v[152:155]
  v_mfma_f32_16x16x32_bf16 v[164:167], a[148:151], v[120:123], v[164:167]
  v_mfma_f32_16x16x32_bf16 v[160:163], a[148:151], v[124:127], v[160:163]
  v_mfma_f32_16x16x32_bf16 v[172:175], a[152:155], v[120:123], v[172:175]
  v_mfma_f32_16x16x32_bf16 v[168:171], a[152:155], v[124:127], v[168:171]
  v_mfma_f32_16x16x32_bf16 v[180:183], a[156:159], v[120:123], v[180:183]
  v_mfma_f32_16x16x32_bf16 v[176:179], a[156:159], v[124:127], v[176:179]
  v_swap_b32 v138, v140
  v_swap_b32 v139, v141
  v_swap_b32 v50, v52
  v_swap_b32 v51, v53
  v_swap_b32 v58, v60
  v_swap_b32 v59, v61
  s_nop 1
  v_mfma_f32_16x16x32_bf16 v[144:147], v[48:51], v[136:139], v[144:147]
  v_mfma_f32_16x16x32_bf16 v[148:151], v[48:51], v[140:143], v[148:151]
  v_mfma_f32_16x16x32_bf16 v[152:155], v[52:55], v[136:139], v[152:155]
  v_mfma_f32_16x16x32_bf16 v[156:159], v[52:55], v[140:143], v[156:159]
  v_mfma_f32_16x16x32_bf16 v[160:163], v[188:191], v[136:139], v[160:163]
  v_mfma_f32_16x16x32_bf16 v[164:167], v[188:191], v[140:143], v[164:167]
  v_mfma_f32_16x16x32_bf16 v[168:171], v[56:59], v[136:139], v[168:171]
  v_mfma_f32_16x16x32_bf16 v[172:175], v[56:59], v[140:143], v[172:175]
  v_mfma_f32_16x16x32_bf16 v[176:179], v[60:63], v[136:139], v[176:179]
  v_mfma_f32_16x16x32_bf16 v[180:183], v[60:63], v[140:143], v[180:183]
pve_310:
  s_nop 0
  ds_write_b128 v10, v[144:147] offset:0
  ds_write_b128 v10, v[148:151] offset:1024
  ds_write_b128 v10, v[152:155] offset:2048
  ds_write_b128 v10, v[156:159] offset:3072
  ds_write_b128 v10, v[160:163] offset:4096
  ds_write_b128 v10, v[164:167] offset:5120
  ds_write_b128 v10, v[168:171] offset:6144
  ds_write_b128 v10, v[172:175] offset:7168
  s_nop 1
  ds_write_b128 v10, v[176:179] offset:8192
  ds_write_b128 v10, v[180:183] offset:9216
  s_cmp_ge_u32 s2, 16
  s_cbranch_scc1 pv_313
  s_waitcnt vmcnt(14)
  s_add_u32 s23, s40, 1
  s_cmp_ge_u32 s50, s23
  s_cbranch_scc1 pv_327
  s_mov_b32 s101, 0
wm_330:
  buffer_load_dword v8, v31, s[72:75], s51 offen sc1
  s_add_u32 s101, s101, 1
  s_cmp_gt_u32 s101, 131072
  s_cbranch_scc1 main_end
  s_waitcnt vmcnt(0)
  v_cmp_gt_u32 vcc, s23, v8
  v_readfirstlane_b32 s100, v8
  s_nop 0
  s_cbranch_vccz wm_331
  s_sleep 8
  s_add_u32 s100, s100, 2
  s_cmp_ge_u32 s100, s23
  s_cbranch_scc1 wm_330
  s_sleep 60
  s_branch wm_330
wm_331:
  v_readlane_b32 s50, v8, 0
  v_readlane_b32 s21, v8, 1
  s_min_u32 s50, s50, s21
  v_readlane_b32 s21, v8, 2
  s_min_u32 s50, s50, s21
  v_readlane_b32 s21, v8, 3
  s_min_u32 s50, s50, s21
  v_readlane_b32 s21, v8, 4
  s_min_u32 s50, s50, s21
  v_readlane_b32 s21, v8, 5
  s_min_u32 s50, s50, s21
  v_readlane_b32 s21, v8, 6
  s_min_u32 s50, s50, s21
  v_readlane_b32 s21, v8, 7
  s_min_u32 s50, s50, s21
  v_readlane_b32 s21, v8, 8
  s_min_u32 s50, s50, s21
  v_readlane_b32 s21, v8, 9
  s_min_u32 s50, s50, s21
  v_readlane_b32 s21, v8, 10
  s_min_u32 s50, s50, s21
  v_readlane_b32 s21, v8, 11
  s_min_u32 s50, s50, s21
  v_readlane_b32 s21, v8, 12
  s_min_u32 s50, s50, s21
  v_readlane_b32 s21, v8, 13
  s_min_u32 s50, s50, s21
  v_readlane_b32 s21, v8, 14
  s_min_u32 s50, s50, s21
  v_readlane_b32 s21, v8, 15
  s_min_u32 s50, s50, s21
  v_readlane_b32 s21, v8, 16
  s_min_u32 s50, s50, s21
  v_readlane_b32 s21, v8, 17
  s_min_u32 s50, s50, s21
  v_readlane_b32 s21, v8, 18
  s_min_u32 s50, s50, s21
  v_readlane_b32 s21, v8, 19
  s_min_u32 s50, s50, s21
  v_readlane_b32 s21, v8, 20
  s_min_u32 s50, s50, s21
  v_readlane_b32 s21, v8, 21
  s_min_u32 s50, s50, s21
  v_readlane_b32 s21, v8, 22
  s_min_u32 s50, s50, s21
  v_readlane_b32 s21, v8, 23
  s_min_u32 s50, s50, s21
  v_readlane_b32 s21, v8, 24
  s_min_u32 s50, s50, s21
  v_readlane_b32 s21, v8, 25
  s_min_u32 s50, s50, s21
  v_readlane_b32 s21, v8, 26
  s_min_u32 s50, s50, s21
  v_readlane_b32 s21, v8, 27
  s_min_u32 s50, s50, s21
  v_readlane_b32 s21, v8, 28
  s_min_u32 s50, s50, s21
  v_readlane_b32 s21, v8, 29
  s_min_u32 s50, s50, s21
  v_readlane_b32 s21, v8, 30
  s_min_u32 s50, s50, s21
  v_readlane_b32 s21, v8, 31
  s_min_u32 s50, s50, s21
pv_327:
  v_cmp_gt_u32 vcc, v19, v27
  s_lshl_b32 s61, s40, 21
  s_lshl_b32 s21, s40, 13
  s_and_b32 s21, s21, 8192
  s_xor_b32 s21, s21, s80
  s_add_u32 s61, s61, s21
  s_lshl_b32 s21, s20, 15
  s_add_u32 s47, s54, s21
  s_add_u32 s48, s61, s60
  s_xor_b32 s68, s61, 8192
  s_add_u32 s68, s68, s53
  s_add_u32 s70, s55, s42
  s_xor_b32 s70, s70, 0
  s_mov_b32 s62, 0
  s_cbranch_vccnz pv_328
  s_mov_b32 s62, 1
  buffer_load_dwordx4 a[0:3], v4, s[16:19], s68 offen offset:0 sc1
  buffer_load_dwordx4 a[4:7], v4, s[16:19], s68 offen offset:1024 sc1
  buffer_load_dwordx4 v[32:35], v22, s[16:19], s48 offen offset:0 sc1
  buffer_load_dwordx4 a[8:11], v4, s[16:19], s70 offen sc1
  s_add_u32 s70, s70, 16384
  buffer_load_dwordx4 a[12:15], v4, s[16:19], s68 offen offset:2048 sc1
  buffer_load_dwordx4 a[16:19], v4, s[16:19], s68 offen offset:3072 sc1
  s_add_u32 s68, s68, 65536
  buffer_load_dwordx4 v[64:67], v4, s[16:19], s47 offen sc1
  buffer_load_dwordx2 v[68:69], v5, s[16:19], s47 offen offset:2048 sc1
  buffer_load_dwordx4 v[128:131], v21, s[16:19], s47 offen offset:1024 sc1
  s_add_u32 s47, s47, 2560
  buffer_load_dwordx4 a[20:23], v4, s[16:19], s68 offen offset:0 sc1
  buffer_load_dwordx4 a[24:27], v4, s[16:19], s68 offen offset:1024 sc1
  buffer_load_dwordx4 v[40:43], v28, s[16:19], s48 offen offset:0 sc1
  buffer_load_dwordx4 a[28:31], v4, s[16:19], s70 offen sc1
  s_add_u32 s70, s70, 16384
  buffer_load_dwordx4 a[32:35], v4, s[16:19], s68 offen offset:2048 sc1
  buffer_load_dwordx4 a[36:39], v4, s[16:19], s68 offen offset:3072 sc1
  s_add_u32 s68, s68, 65536
  buffer_load_dwordx2 v[184:185], v14, s[16:19], s48 offen offset:512 sc1
  buffer_load_dwordx4 v[72:75], v4, s[16:19], s47 offen sc1
  buffer_load_dwordx2 v[76:77], v5, s[16:19], s47 offen offset:2048 sc1
  s_add_u32 s47, s47, 13824
  buffer_load_dwordx4 a[40:43], v4, s[16:19], s68 offen offset:0 sc1
  buffer_load_dwordx4 a[44:47], v4, s[16:19], s68 offen offset:1024 sc1
  buffer_load_dwordx4 v[36:39], v22, s[16:19], s48 offen offset:1280 sc1
  buffer_load_dwordx4 a[48:51], v4, s[16:19], s70 offen sc1
  s_add_u32 s70, s70, 16384
  buffer_load_dwordx4 a[52:55], v4, s[16:19], s68 offen offset:2048 sc1
  buffer_load_dwordx4 a[56:59], v4, s[16:19], s68 offen offset:3072 sc1
  s_add_u32 s68, s68, 65536
  buffer_load_dwordx4 v[80:83], v4, s[16:19], s47 offen sc1
  buffer_load_dwordx2 v[84:85], v5, s[16:19], s47 offen offset:2048 sc1
  buffer_load_dwordx4 v[132:135], v21, s[16:19], s47 offen offset:1024 sc1
  s_add_u32 s47, s47, 2560
  buffer_load_dwordx4 a[60:63], v4, s[16:19], s68 offen offset:0 sc1
  buffer_load_dwordx4 a[64:67], v4, s[16:19], s68 offen offset:1024 sc1
  buffer_load_dwordx4 v[44:47], v28, s[16:19], s48 offen offset:1280 sc1
  buffer_load_dwordx4 a[68:71], v4, s[16:19], s70 offen sc1
  s_add_u32 s70, s70, 16384
  buffer_load_dwordx4 a[72:75], v4, s[16:19], s68 offen offset:2048 sc1
  buffer_load_dwordx4 a[76:79], v4, s[16:19], s68 offen offset:3072 sc1
  s_add_u32 s68, s68, 65536
  buffer_load_dwordx2 v[186:187], v14, s[16:19], s48 offen offset:1792 sc1
  s_add_u32 s48, s48, 262144
  buffer_load_dwordx4 v[88:91], v4, s[16:19], s47 offen sc1
  buffer_load_dwordx2 v[92:93], v5, s[16:19], s47 offen offset:2048 sc1
  s_add_u32 s47, s47, 13824
  s_branch pv_329
pv_328:
  buffer_load_dwordx4 a[0:3], v4, s[16:19], s68 offen offset:0 sc1
  buffer_load_dwordx4 a[4:7], v4, s[16:19], s68 offen offset:1024 sc1
  buffer_load_dwordx4 a[8:11], v4, s[16:19], s70 offen sc1
  s_add_u32 s70, s70, 16384
  buffer_load_dwordx4 a[12:15], v4, s[16:19], s68 offen offset:2048 sc1
  buffer_load_dwordx4 a[16:19], v4, s[16:19], s68 offen offset:3072 sc1
  s_add_u32 s68, s68, 65536
  buffer_load_dwordx4 a[20:23], v4, s[16:19], s68 offen offset:0 sc1
  buffer_load_dwordx4 a[24:27], v4, s[16:19], s68 offen offset:1024 sc1
  buffer_load_dwordx4 a[28:31], v4, s[16:19], s70 offen sc1
  s_add_u32 s70, s70, 16384
  buffer_load_dwordx4 a[32:35], v4, s[16:19], s68 offen offset:2048 sc1
  buffer_load_dwordx4 a[36:39], v4, s[16:19], s68 offen offset:3072 sc1
  s_add_u32 s68, s68, 65536
  buffer_load_dwordx4 a[40:43], v4, s[16:19], s68 offen offset:0 sc1
  buffer_load_dwordx4 a[44:47], v4, s[16:19], s68 offen offset:1024 sc1
  buffer_load_dwordx4 a[48:51], v4, s[16:19], s70 offen sc1
  s_add_u32 s70, s70, 16384
  buffer_load_dwordx4 a[52:55], v4, s[16:19], s68 offen offset:2048 sc1
  buffer_load_dwordx4 a[56:59], v4, s[16:19], s68 offen offset:3072 sc1
  s_add_u32 s68, s68, 65536
  buffer_load_dwordx4 a[60:63], v4, s[16:19], s68 offen offset:0 sc1
  buffer_load_dwordx4 a[64:67], v4, s[16:19], s68 offen offset:1024 sc1
  buffer_load_dwordx4 a[68:71], v4, s[16:19], s70 offen sc1
  s_add_u32 s70, s70, 16384
  buffer_load_dwordx4 a[72:75], v4, s[16:19], s68 offen offset:2048 sc1
  buffer_load_dwordx4 a[76:79], v4, s[16:19], s68 offen offset:3072 sc1
  s_add_u32 s68, s68, 65536
  buffer_load_dwordx4 a[80:83], v4, s[16:19], s68 offen offset:0 sc1
  buffer_load_dwordx4 a[84:87], v4, s[16:19], s68 offen offset:1024 sc1
  buffer_load_dwordx4 a[88:91], v4, s[16:19], s70 offen sc1
  s_add_u32 s70, s70, 16384
  buffer_load_dwordx4 a[92:95], v4, s[16:19], s68 offen offset:2048 sc1
  buffer_load_dwordx4 a[96:99], v4, s[16:19], s68 offen offset:3072 sc1
  s_add_u32 s68, s68, 65536
  buffer_load_dwordx4 a[100:103], v4, s[16:19], s68 offen offset:0 sc1
  buffer_load_dwordx4 a[104:107], v4, s[16:19], s68 offen offset:1024 sc1
  buffer_load_dwordx4 a[108:111], v4, s[16:19], s70 offen sc1
  s_add_u32 s70, s70, 16384
  buffer_load_dwordx4 a[112:115], v4, s[16:19], s68 offen offset:2048 sc1
  buffer_load_dwordx4 a[116:119], v4, s[16:19], s68 offen offset:3072 sc1
  s_add_u32 s68, s68, 65536
  buffer_load_dwordx4 a[120:123], v4, s[16:19], s68 offen offset:0 sc1
  buffer_load_dwordx4 a[124:127], v4, s[16:19], s68 offen offset:1024 sc1
  buffer_load_dwordx4 a[128:131], v4, s[16:19], s70 offen sc1
  s_add_u32 s70, s70, 16384
  buffer_load_dwordx4 a[132:135], v4, s[16:19], s68 offen offset:2048 sc1
  buffer_load_dwordx4 a[136:139], v4, s[16:19], s68 offen offset:3072 sc1
  s_add_u32 s68, s68, 65536
  buffer_load_dwordx4 a[140:143], v4, s[16:19], s68 offen offset:0 sc1
  buffer_load_dwordx4 a[144:147], v4, s[16:19], s68 offen offset:1024 sc1
  buffer_load_dwordx4 a[148:151], v4, s[16:19], s70 offen sc1
  s_add_u32 s70, s70, 16384
  buffer_load_dwordx4 a[152:155], v4, s[16:19], s68 offen offset:2048 sc1
  buffer_load_dwordx4 a[156:159], v4, s[16:19], s68 offen offset:3072 sc1
  s_add_u32 s68, s68, 65536
pv_329:
pv_313:
  s_waitcnt lgkmcnt(0)
  s_barrier
  ds_read_b128 v[144:147], v11 offset:0
  ds_read_b128 v[148:151], v11 offset:10240
  ds_read_b128 v[152:155], v11 offset:20480
  ds_read_b128 v[156:159], v11 offset:30720
  ds_read_b128 v[160:163], v11 offset:2048
  ds_read_b128 v[164:167], v11 offset:12288
  ds_read_b128 v[168:171], v11 offset:22528
  ds_read_b128 v[172:175], v11 offset:32768
  s_waitcnt lgkmcnt(4)
  v_pk_add_f32 v[144:145], v[144:145], v[148:149]
  v_pk_add_f32 v[152:153], v[152:153], v[156:157]
  v_pk_add_f32 v[146:147], v[146:147], v[150:151]
  v_pk_add_f32 v[154:155], v[154:155], v[158:159]
  v_pk_add_f32 v[176:177], v[144:145], v[152:153]
  v_pk_add_f32 v[178:179], v[146:147], v[154:155]
  ds_read_b128 v[144:147], v12 offset:0
  ds_read_b128 v[148:151], v12 offset:10240
  ds_read_b128 v[152:155], v12 offset:20480
  ds_read_b128 v[156:159], v12 offset:30720
  v_cvt_pk_bf16_f32 v26, v176, v177
  v_lshlrev_b32 v176, 16, v26
  v_and_b32 v177, 0xffff0000, v26
  v_mul_f32 v176, v176, v24
  v_mul_f32 v177, v177, v24
  v_cvt_pk_bf16_f32 v26, v176, v177
  v_lshlrev_b32 v176, 16, v26
  v_and_b32 v177, 0xffff0000, v26
  v_add_f32 v176, v176, v240
  v_add_f32 v177, v177, v241
  v_cvt_pk_bf16_f32 v236, v176, v177
  v_cvt_pk_bf16_f32 v26, v178, v179
  v_lshlrev_b32 v178, 16, v26
  v_and_b32 v179, 0xffff0000, v26
  v_mul_f32 v178, v178, v24
  v_mul_f32 v179, v179, v24
  v_cvt_pk_bf16_f32 v26, v178, v179
  v_lshlrev_b32 v178, 16, v26
  v_and_b32 v179, 0xffff0000, v26
  v_add_f32 v178, v178, v242
  v_add_f32 v179, v179, v243
  v_cvt_pk_bf16_f32 v237, v178, v179
  s_waitcnt lgkmcnt(4)
  v_pk_add_f32 v[160:161], v[160:161], v[164:165]
  v_pk_add_f32 v[168:169], v[168:169], v[172:173]
  v_pk_add_f32 v[162:163], v[162:163], v[166:167]
  v_pk_add_f32 v[170:171], v[170:171], v[174:175]
  v_pk_add_f32 v[176:177], v[160:161], v[168:169]
  v_pk_add_f32 v[178:179], v[162:163], v[170:171]
  v_cvt_pk_bf16_f32 v26, v176, v177
  v_lshlrev_b32 v176, 16, v26
  v_and_b32 v177, 0xffff0000, v26
  v_mul_f32 v176, v176, v24
  v_mul_f32 v177, v177, v24
  v_cvt_pk_bf16_f32 v26, v176, v177
  v_lshlrev_b32 v176, 16, v26
  v_and_b32 v177, 0xffff0000, v26
  v_add_f32 v176, v176, v244
  v_add_f32 v177, v177, v245
  v_cvt_pk_bf16_f32 v238, v176, v177
  v_cvt_pk_bf16_f32 v26, v178, v179
  v_lshlrev_b32 v178, 16, v26
  v_and_b32 v179, 0xffff0000, v26
  v_mul_f32 v178, v178, v24
  v_mul_f32 v179, v179, v24
  v_cvt_pk_bf16_f32 v26, v178, v179
  v_lshlrev_b32 v178, 16, v26
  v_and_b32 v179, 0xffff0000, v26
  v_add_f32 v178, v178, v246
  v_add_f32 v179, v179, v247
  v_cvt_pk_bf16_f32 v239, v178, v179
  buffer_store_dwordx4 v[236:239], v9, s[8:11], s46 offen
  s_cmp_lt_u32 s20, 2
  s_cselect_b32 s49, s49, 0x40000000
  s_waitcnt lgkmcnt(0)
  v_pk_add_f32 v[144:145], v[144:145], v[148:149]
  v_pk_add_f32 v[152:153], v[152:153], v[156:157]
  v_pk_add_f32 v[146:147], v[146:147], v[150:151]
  v_pk_add_f32 v[154:155], v[154:155], v[158:159]
  v_pk_add_f32 v[176:177], v[144:145], v[152:153]
  v_pk_add_f32 v[178:179], v[146:147], v[154:155]
  v_cvt_pk_bf16_f32 v26, v176, v177
  v_lshlrev_b32 v176, 16, v26
  v_and_b32 v177, 0xffff0000, v26
  v_mul_f32 v176, v176, v24
  v_mul_f32 v177, v177, v24
  v_cvt_pk_bf16_f32 v26, v176, v177
  v_lshlrev_b32 v176, 16, v26
  v_and_b32 v177, 0xffff0000, v26
  v_add_f32 v176, v176, v248
  v_add_f32 v177, v177, v249
  v_cvt_pk_bf16_f32 v234, v176, v177
  v_cvt_pk_bf16_f32 v26, v178, v179
  v_lshlrev_b32 v178, 16, v26
  v_and_b32 v179, 0xffff0000, v26
  v_mul_f32 v178, v178, v24
  v_mul_f32 v179, v179, v24
  v_cvt_pk_bf16_f32 v26, v178, v179
  v_lshlrev_b32 v178, 16, v26
  v_and_b32 v179, 0xffff0000, v26
  v_add_f32 v178, v178, v250
  v_add_f32 v179, v179, v251
  v_cvt_pk_bf16_f32 v235, v178, v179
  buffer_store_dwordx2 v[234:235], v13, s[8:11], s49 offen offset:64
  s_cmp_lt_u32 s2, 16
  s_cbranch_scc1 pv_loop
  s_cmp_eq_u32 s2, 16
  s_cselect_b32 s87, 0, s87
  s_cmp_eq_u32 s87, 0
  s_cbranch_scc1 pv_done
  s_waitcnt vmcnt(2)
  v_mov_b32 v29, 1
  buffer_atomic_add v29, v233, s[72:75], s59 offen sc0 sc1
  s_waitcnt vmcnt(0)
  s_cmp_lg_u32 s20, 0
  s_cbranch_scc1 pvq_332
  s_mov_b64 exec, 1
  ds_write_b32 v30, v29
  s_mov_b64 exec, -1
pvq_332:
  s_mov_b32 s71, 1
  s_waitcnt lgkmcnt(0)
  s_barrier
  ds_read_b32 v23, v30
  s_branch pv_late
pv_done:
main_fin:
  s_waitcnt vmcnt(0)
main_end:
  s_endpgm
.section .rodata,"a"
.p2align 6
.amdhsa_kernel gated_mix__memory_aug_recurrent_mem_tr__sliding_local_dilated__prompt_kernel
  .amdhsa_next_free_vgpr 512
  .amdhsa_next_free_sgpr 102
  .amdhsa_accum_offset 256
  .amdhsa_group_segment_fixed_size 0
  .amdhsa_kernarg_size 112
  .amdhsa_user_sgpr_count 2
  .amdhsa_user_sgpr_kernarg_segment_ptr 1
  .amdhsa_system_sgpr_workgroup_id_x 1
.end_amdhsa_kernel
.text
```

```asm
; @launch kernel=gated_mix__memory_aug_recurrent_mem_tr__sliding_local_dilated__prompt_kernel grid=(256,1,1) block=(256,1,1) lds=163840
.amdgcn_target "amdgcn-amd-amdhsa--gfx950"
.text
.globl gated_mix__memory_aug_recurrent_mem_tr__sliding_local_dilated__prompt_kernel
.p2align 8
.type gated_mix__memory_aug_recurrent_mem_tr__sliding_local_dilated__prompt_kernel,@function
gated_mix__memory_aug_recurrent_mem_tr__sliding_local_dilated__prompt_kernel:
  s_cmp_ge_u32 s2, 256
  s_cbranch_scc1 end0
  s_load_dwordx2 s[4:5], s[0:1], 96
  s_load_dwordx2 s[38:39], s[0:1], 104
  s_load_dwordx2 s[64:65], s[0:1], 0
  v_lshrrev_b32 v1, 6, v0
  v_and_b32 v2, 15, v0
  v_readfirstlane_b32 s20, v1
  v_and_b32 v1, 63, v0
  v_lshrrev_b32 v3, 4, v1
  s_getreg_b32 s50, hwreg(HW_REG_XCC_ID)
  s_and_b32 s50, s50, 7
  s_waitcnt lgkmcnt(0)
  s_mov_b32 s32, s4
  s_mov_b32 s33, s5
  s_mov_b32 s34, 256
  s_mov_b32 s35, 0x00020000
  v_mov_b32 v21, 0
  s_cmp_lg_u32 s20, 0
  s_cbranch_scc1 rk_1
  s_and_b32 s21, s50, 1
  s_lshl_b32 s21, s21, 7
  s_lshl_b32 s22, s50, 1
  s_and_b32 s22, s22, 12
  s_add_u32 s21, s21, s22
  v_mov_b32 v22, s21
  v_mov_b32 v23, 1
  s_mov_b64 exec, 1
  buffer_atomic_add v23, v22, s[32:35], 0 offen sc0 sc1
  s_waitcnt vmcnt(0)
  v_readfirstlane_b32 s51, v23
  s_lshl_b32 s22, s50, 5
  s_add_u32 s22, s22, s51
  s_cmp_lt_u32 s51, 32
  s_cbranch_scc1 rk_2
  v_mov_b32 v24, 72
  v_mov_b32 v25, 1
  buffer_atomic_add v25, v24, s[32:35], 0 offen sc0 sc1
  s_waitcnt vmcnt(0)
  v_readfirstlane_b32 s23, v25
  s_mov_b32 s101, 0
  s_mov_b64 exec, -1
  v_lshlrev_b32 v24, 2, v1
rk_3:
  s_sleep 8
  buffer_load_dword v25, v24, s[32:35], 0 offen sc1
  s_add_u32 s101, s101, 1
  s_cmp_gt_u32 s101, 131072
  s_cbranch_scc1 end0
  s_waitcnt vmcnt(0)
  v_readlane_b32 s21, v25, 0
  v_readlane_b32 s22, v25, 32
  s_add_u32 s21, s21, s22
  v_readlane_b32 s22, v25, 1
  s_add_u32 s21, s21, s22
  v_readlane_b32 s22, v25, 33
  s_add_u32 s21, s21, s22
  v_readlane_b32 s22, v25, 2
  s_add_u32 s21, s21, s22
  v_readlane_b32 s22, v25, 34
  s_add_u32 s21, s21, s22
  v_readlane_b32 s22, v25, 3
  s_add_u32 s21, s21, s22
  v_readlane_b32 s22, v25, 35
  s_add_u32 s21, s21, s22
  s_cmp_lt_u32 s21, 256
  s_cbranch_scc1 rk_3
  s_mov_b64 exec, 1
  s_mov_b32 s24, 0
rk_5:
  s_and_b32 s21, s24, 1
  s_lshl_b32 s21, s21, 5
  s_lshr_b32 s22, s24, 1
  s_add_u32 s21, s21, s22
  v_readlane_b32 s21, v25, s21
  s_min_u32 s21, s21, 32
  s_sub_u32 s25, 32, s21
  s_cmp_lt_u32 s23, s25
  s_cbranch_scc1 rk_4
  s_sub_u32 s23, s23, s25
  s_add_u32 s24, s24, 1
  s_cmp_lt_u32 s24, 8
  s_cbranch_scc1 rk_5
  s_branch end0
rk_4:
  s_lshl_b32 s22, s24, 5
  s_add_u32 s22, s22, s21
  s_add_u32 s22, s22, s23
  s_or_b32 s22, s22, 0x100
rk_2:
  v_mov_b32 v23, s22
  ds_write_b32 v21, v23
  s_waitcnt lgkmcnt(0)
  s_mov_b64 exec, -1
rk_1:
  s_waitcnt vmcnt(0)
  s_barrier
  ds_read_b32 v23, v21
  s_waitcnt lgkmcnt(0)
  v_readfirstlane_b32 s22, v23
  s_barrier
  s_lshr_b32 s53, s22, 8
  s_and_b32 s22, s22, 255
  s_cmp_ge_u32 s22, 128
  s_cbranch_scc1 gemm_side
  s_lshr_b32 s50, s22, 4
  s_and_b32 s51, s22, 15
  s_load_dwordx2 s[4:5], s[0:1], 8
  s_load_dwordx4 s[40:43], s[0:1], 16
  s_load_dwordx4 s[44:47], s[0:1], 32
  s_load_dwordx2 s[48:49], s[0:1], 104
  s_lshr_b32 s55, s51, 2
  s_and_b32 s56, s51, 3
  s_lshl_b32 s57, s50, 2
  s_add_u32 s58, s57, s55
  s_add_u32 s59, s57, s20
  s_lshr_b32 s60, s51, 1
  s_and_b32 s61, s51, 1
  s_mul_i32 s81, s20, 40960
  v_lshlrev_b32 v4, 4, v1
  s_waitcnt lgkmcnt(0)
  s_mov_b32 s12, s44
  s_mov_b32 s13, s45
  s_mov_b32 s14, 7864320
  s_mov_b32 s15, 0x00020000
  s_mov_b32 s16, s46
  s_mov_b32 s17, s47
  s_mov_b32 s18, 7864320
  s_mov_b32 s19, 0x00020000
  s_mov_b32 s24, s40
  s_mov_b32 s25, s41
  s_mov_b32 s26, 7864320
  s_mov_b32 s27, 0x00020000
  s_mov_b32 s28, s42
  s_mov_b32 s29, s43
  s_mov_b32 s30, 7864320
  s_mov_b32 s31, 0x00020000
  s_mov_b32 s36, s4
  s_mov_b32 s37, s5
  s_mov_b32 s38, 10240
  s_mov_b32 s39, 0x00020000
  s_add_u32 s8, s48, 174063616
  s_addc_u32 s9, s49, 0
  s_mov_b32 s10, 495616
  s_mov_b32 s11, 0x00020000
  s_add_u32 s4, s48, 171966464
  s_addc_u32 s5, s49, 0
  s_mov_b32 s6, 1048576
  s_mov_b32 s7, 0x00020000
  v_add_u32 v66, 0, v1
  v_mul_u32_u24 v67, 2731, v66
  v_lshrrev_b32 v67, 16, v67
  v_mul_u32_u24 v48, 24, v67
  v_sub_u32 v66, v66, v48
  v_mul_u32_u24 v67, 12288, v67
  v_lshl_add_u32 v48, v66, 4, v67
  v_add_u32 v66, 64, v1
  v_mul_u32_u24 v67, 2731, v66
  v_lshrrev_b32 v67, 16, v67
  v_mul_u32_u24 v49, 24, v67
  v_sub_u32 v66, v66, v49
  v_mul_u32_u24 v67, 12288, v67
  v_lshl_add_u32 v49, v66, 4, v67
  v_add_u32 v66, 128, v1
  v_mul_u32_u24 v67, 2731, v66
  v_lshrrev_b32 v67, 16, v67
  v_mul_u32_u24 v50, 24, v67
  v_sub_u32 v66, v66, v50
  v_mul_u32_u24 v67, 12288, v67
  v_lshl_add_u32 v50, v66, 4, v67
  s_mul_i32 s21, s51, 491520
  s_mul_i32 s80, s59, 384
  s_add_u32 s21, s21, s80
  s_mov_b32 s23, s21
  v_add_u32 v66, 0, v1
  v_mul_u32_u24 v67, 10923, v66
  v_lshrrev_b32 v67, 16, v67
  v_mul_u32_u24 v60, 6, v67
  v_sub_u32 v66, v66, v60
  v_mul_u32_u24 v67, 1280, v67
  v_lshl_add_u32 v60, v66, 4, v67
  v_add_u32 v66, 64, v1
  v_mul_u32_u24 v67, 10923, v66
  v_lshrrev_b32 v67, 16, v67
  v_mul_u32_u24 v61, 6, v67
  v_sub_u32 v66, v66, v61
  v_mul_u32_u24 v67, 1280, v67
  v_lshl_add_u32 v61, v66, 4, v67
  v_add_u32 v66, 128, v1
  v_mul_u32_u24 v67, 10923, v66
  v_lshrrev_b32 v67, 16, v67
  v_mul_u32_u24 v62, 6, v67
  v_sub_u32 v66, v66, v62
  v_mul_u32_u24 v67, 1280, v67
  v_lshl_add_u32 v62, v66, 4, v67
  s_mul_i32 s21, s59, 245760
  s_mul_i32 s22, s60, 160
  s_add_u32 s21, s21, s22
  s_lshl_b32 s22, s61, 6
  s_add_u32 s21, s21, s22
  s_add_u32 m0, s81, 0
  s_nop 0
  buffer_load_dwordx4 v60, s[16:19], s21 offen lds
  s_add_u32 m0, s81, 1024
  s_nop 0
  buffer_load_dwordx4 v61, s[16:19], s21 offen lds
  s_add_u32 m0, s81, 2048
  s_nop 0
  buffer_load_dwordx4 v62, s[16:19], s21 offen lds
  s_add_u32 s21, s21, 40960
  s_add_u32 m0, s81, 3072
  s_nop 0
  buffer_load_dwordx4 v60, s[16:19], s21 offen lds
  s_add_u32 m0, s81, 4096
  s_nop 0
  buffer_load_dwordx4 v61, s[16:19], s21 offen lds
  s_add_u32 m0, s81, 5120
  s_nop 0
  buffer_load_dwordx4 v62, s[16:19], s21 offen lds
  s_add_u32 s21, s21, 40960
  s_add_u32 m0, s81, 6144
  s_nop 0
  buffer_load_dwordx4 v60, s[16:19], s21 offen lds
  s_add_u32 m0, s81, 7168
  s_nop 0
  buffer_load_dwordx4 v61, s[16:19], s21 offen lds
  s_add_u32 m0, s81, 8192
  s_nop 0
  buffer_load_dwordx4 v62, s[16:19], s21 offen lds
  s_add_u32 s21, s21, 40960
  s_add_u32 m0, s81, 9216
  s_nop 0
  buffer_load_dwordx4 v60, s[16:19], s21 offen lds
  s_add_u32 m0, s81, 10240
  s_nop 0
  buffer_load_dwordx4 v61, s[16:19], s21 offen lds
  s_add_u32 m0, s81, 11264
  s_nop 0
  buffer_load_dwordx4 v62, s[16:19], s21 offen lds
  s_add_u32 s21, s21, 40960
  s_add_u32 m0, s81, 12288
  s_nop 0
  buffer_load_dwordx4 v60, s[16:19], s21 offen lds
  s_add_u32 m0, s81, 13312
  s_nop 0
  buffer_load_dwordx4 v61, s[16:19], s21 offen lds
  s_add_u32 m0, s81, 14336
  s_nop 0
  buffer_load_dwordx4 v62, s[16:19], s21 offen lds
  s_add_u32 s21, s21, 40960
  s_add_u32 m0, s81, 15360
  s_nop 0
  buffer_load_dwordx4 v60, s[16:19], s21 offen lds
  s_add_u32 m0, s81, 16384
  s_nop 0
  buffer_load_dwordx4 v61, s[16:19], s21 offen lds
  s_add_u32 m0, s81, 17408
  s_nop 0
  buffer_load_dwordx4 v62, s[16:19], s21 offen lds
  s_add_u32 s21, s21, 40960
  v_add_u32 v66, 0, v1
  v_mul_u32_u24 v67, 2731, v66
  v_lshrrev_b32 v67, 16, v67
  v_mul_u32_u24 v48, 24, v67
  v_sub_u32 v66, v66, v48
  v_lshrrev_b32 v48, 2, v67
  v_lshlrev_b32 v48, 1, v48
  v_or_b32 v48, 0, v48
  v_xor_b32 v66, v66, v48
  v_add_u32 v67, 0, v67
  v_mul_u32_u24 v67, 12288, v67
  v_lshl_add_u32 v48, v66, 4, v67
  v_add_u32 v66, 64, v1
  v_mul_u32_u24 v67, 2731, v66
  v_lshrrev_b32 v67, 16, v67
  v_mul_u32_u24 v49, 24, v67
  v_sub_u32 v66, v66, v49
  v_lshrrev_b32 v49, 2, v67
  v_lshlrev_b32 v49, 1, v49
  v_or_b32 v49, 0, v49
  v_xor_b32 v66, v66, v49
  v_add_u32 v67, 0, v67
  v_mul_u32_u24 v67, 12288, v67
  v_lshl_add_u32 v49, v66, 4, v67
  v_add_u32 v66, 128, v1
  v_mul_u32_u24 v67, 2731, v66
  v_lshrrev_b32 v67, 16, v67
  v_mul_u32_u24 v50, 24, v67
  v_sub_u32 v66, v66, v50
  v_lshrrev_b32 v50, 2, v67
  v_lshlrev_b32 v50, 1, v50
  v_or_b32 v50, 0, v50
  v_xor_b32 v66, v66, v50
  v_add_u32 v67, 0, v67
  v_mul_u32_u24 v67, 12288, v67
  v_lshl_add_u32 v50, v66, 4, v67
  v_add_u32 v66, 0, v1
  v_mul_u32_u24 v67, 2731, v66
  v_lshrrev_b32 v67, 16, v67
  v_mul_u32_u24 v51, 24, v67
  v_sub_u32 v66, v66, v51
  v_lshrrev_b32 v51, 2, v67
  v_lshlrev_b32 v51, 1, v51
  v_or_b32 v51, 1, v51
  v_xor_b32 v66, v66, v51
  v_add_u32 v67, 8, v67
  v_mul_u32_u24 v67, 12288, v67
  v_lshl_add_u32 v51, v66, 4, v67
  v_add_u32 v66, 64, v1
  v_mul_u32_u24 v67, 2731, v66
  v_lshrrev_b32 v67, 16, v67
  v_mul_u32_u24 v52, 24, v67
  v_sub_u32 v66, v66, v52
  v_lshrrev_b32 v52, 2, v67
  v_lshlrev_b32 v52, 1, v52
  v_or_b32 v52, 1, v52
  v_xor_b32 v66, v66, v52
  v_add_u32 v67, 8, v67
  v_mul_u32_u24 v67, 12288, v67
  v_lshl_add_u32 v52, v66, 4, v67
  v_add_u32 v66, 128, v1
  v_mul_u32_u24 v67, 2731, v66
  v_lshrrev_b32 v67, 16, v67
  v_mul_u32_u24 v53, 24, v67
  v_sub_u32 v66, v66, v53
  v_lshrrev_b32 v53, 2, v67
  v_lshlrev_b32 v53, 1, v53
  v_or_b32 v53, 1, v53
  v_xor_b32 v66, v66, v53
  v_add_u32 v67, 8, v67
  v_mul_u32_u24 v67, 12288, v67
  v_lshl_add_u32 v53, v66, 4, v67
  v_add_u32 v66, 0, v1
  v_mul_u32_u24 v67, 2731, v66
  v_lshrrev_b32 v67, 16, v67
  v_mul_u32_u24 v54, 24, v67
  v_sub_u32 v66, v66, v54
  v_lshrrev_b32 v54, 2, v67
  v_lshlrev_b32 v54, 1, v54
  v_or_b32 v54, 4, v54
  v_xor_b32 v66, v66, v54
  v_add_u32 v67, 16, v67
  v_mul_u32_u24 v67, 12288, v67
  v_lshl_add_u32 v54, v66, 4, v67
  v_add_u32 v66, 64, v1
  v_mul_u32_u24 v67, 2731, v66
  v_lshrrev_b32 v67, 16, v67
  v_mul_u32_u24 v55, 24, v67
  v_sub_u32 v66, v66, v55
  v_lshrrev_b32 v55, 2, v67
  v_lshlrev_b32 v55, 1, v55
  v_or_b32 v55, 4, v55
  v_xor_b32 v66, v66, v55
  v_add_u32 v67, 16, v67
  v_mul_u32_u24 v67, 12288, v67
  v_lshl_add_u32 v55, v66, 4, v67
  v_add_u32 v66, 128, v1
  v_mul_u32_u24 v67, 2731, v66
  v_lshrrev_b32 v67, 16, v67
  v_mul_u32_u24 v56, 24, v67
  v_sub_u32 v66, v66, v56
  v_lshrrev_b32 v56, 2, v67
  v_lshlrev_b32 v56, 1, v56
  v_or_b32 v56, 4, v56
  v_xor_b32 v66, v66, v56
  v_add_u32 v67, 16, v67
  v_mul_u32_u24 v67, 12288, v67
  v_lshl_add_u32 v56, v66, 4, v67
  v_add_u32 v66, 0, v1
  v_mul_u32_u24 v67, 2731, v66
  v_lshrrev_b32 v67, 16, v67
  v_mul_u32_u24 v57, 24, v67
  v_sub_u32 v66, v66, v57
  v_lshrrev_b32 v57, 2, v67
  v_lshlrev_b32 v57, 1, v57
  v_or_b32 v57, 5, v57
  v_xor_b32 v66, v66, v57
  v_add_u32 v67, 24, v67
  v_mul_u32_u24 v67, 12288, v67
  v_lshl_add_u32 v57, v66, 4, v67
  v_add_u32 v66, 64, v1
  v_mul_u32_u24 v67, 2731, v66
  v_lshrrev_b32 v67, 16, v67
  v_mul_u32_u24 v58, 24, v67
  v_sub_u32 v66, v66, v58
  v_lshrrev_b32 v58, 2, v67
  v_lshlrev_b32 v58, 1, v58
  v_or_b32 v58, 5, v58
  v_xor_b32 v66, v66, v58
  v_add_u32 v67, 24, v67
  v_mul_u32_u24 v67, 12288, v67
  v_lshl_add_u32 v58, v66, 4, v67
  v_add_u32 v66, 128, v1
  v_mul_u32_u24 v67, 2731, v66
  v_lshrrev_b32 v67, 16, v67
  v_mul_u32_u24 v59, 24, v67
  v_sub_u32 v66, v66, v59
  v_lshrrev_b32 v59, 2, v67
  v_lshlrev_b32 v59, 1, v59
  v_or_b32 v59, 5, v59
  v_xor_b32 v66, v66, v59
  v_add_u32 v67, 24, v67
  v_mul_u32_u24 v67, 12288, v67
  v_lshl_add_u32 v59, v66, 4, v67
  s_add_u32 m0, s81, 24576
  s_nop 0
  buffer_load_dwordx4 v48, s[12:15], s80 offen lds
  s_add_u32 m0, s81, 25600
  s_nop 0
  buffer_load_dwordx4 v49, s[12:15], s80 offen lds
  s_add_u32 m0, s81, 26624
  s_nop 0
  buffer_load_dwordx4 v50, s[12:15], s80 offen lds
  s_add_u32 m0, s81, 27648
  s_nop 0
  buffer_load_dwordx4 v51, s[12:15], s80 offen lds
  s_add_u32 m0, s81, 28672
  s_nop 0
  buffer_load_dwordx4 v52, s[12:15], s80 offen lds
  s_add_u32 m0, s81, 29696
  s_nop 0
  buffer_load_dwordx4 v53, s[12:15], s80 offen lds
  s_add_u32 m0, s81, 30720
  s_nop 0
  buffer_load_dwordx4 v54, s[12:15], s80 offen lds
  s_add_u32 m0, s81, 31744
  s_nop 0
  buffer_load_dwordx4 v55, s[12:15], s80 offen lds
  s_add_u32 m0, s81, 32768
  s_nop 0
  buffer_load_dwordx4 v56, s[12:15], s80 offen lds
  s_add_u32 m0, s81, 33792
  s_nop 0
  buffer_load_dwordx4 v57, s[12:15], s80 offen lds
  s_add_u32 m0, s81, 34816
  s_nop 0
  buffer_load_dwordx4 v58, s[12:15], s80 offen lds
  s_add_u32 m0, s81, 35840
  s_nop 0
  buffer_load_dwordx4 v59, s[12:15], s80 offen lds
  s_add_u32 s80, s80, 393216
  v_add_u32 v66, 0, v1
  v_mul_u32_u24 v67, 10923, v66
  v_lshrrev_b32 v67, 16, v67
  v_mul_u32_u24 v63, 6, v67
  v_sub_u32 v66, v66, v63
  v_mul_u32_u24 v67, 12288, v67
  v_lshl_add_u32 v63, v66, 4, v67
  v_add_u32 v66, 64, v1
  v_mul_u32_u24 v67, 10923, v66
  v_lshrrev_b32 v67, 16, v67
  v_mul_u32_u24 v64, 6, v67
  v_sub_u32 v66, v66, v64
  v_mul_u32_u24 v67, 12288, v67
  v_lshl_add_u32 v64, v66, 4, v67
  v_add_u32 v66, 128, v1
  v_mul_u32_u24 v67, 10923, v66
  v_lshrrev_b32 v67, 16, v67
  v_mul_u32_u24 v65, 6, v67
  v_sub_u32 v66, v66, v65
  v_mul_u32_u24 v67, 12288, v67
  v_lshl_add_u32 v65, v66, 4, v67
  s_mul_i32 s79, s58, 384
  s_mul_i32 s22, s56, 96
  s_add_u32 s79, s79, s22
  s_mul_i32 s22, s20, 1966080
  s_add_u32 s79, s79, s22
  v_and_b32 v224, 7, v2
  v_lshrrev_b32 v225, 3, v2
  v_lshlrev_b32 v12, 3, v1
  v_mov_b32 v23, 0
  v_mov_b32 v226, 0x4444
  v_mov_b32 v227, 0xeeee
  v_cmp_eq_u32 vcc, 1, v225
  v_cmp_gt_u32 s[62:63], 8, v2
  v_cmp_le_u32 s[68:69], 8, v2
  v_cndmask_b32 v22, v226, v227, vcc
  v_cmp_gt_u32 vcc, 32, v1
  v_mov_b32 v226, 0x3dd53b95
  v_cmp_gt_u32 s[66:67], 40, v1
  v_cndmask_b32 v24, 1.0, v226, vcc
  v_cndmask_b32 v25, 1.0, v226, vcc
  v_min_u32 v226, 39, v1
  v_and_b32 v227, 31, v1
  v_lshlrev_b32 v227, 2, v227
  v_lshl_add_u32 v5, v226, 7, v227
  v_mul_u32_u24 v226, 192, v3
  v_lshl_add_u32 v226, v2, 3, v226
  s_mul_i32 s21, s20, 768
  s_add_u32 s21, s21, 10240
  v_add_u32 v6, s21, v226
  v_and_b32 v226, 3, v2
  v_mul_u32_u24 v226, 192, v226
  v_lshrrev_b32 v227, 2, v2
  v_lshl_add_u32 v227, v3, 2, v227
  v_lshl_add_u32 v226, v227, 3, v226
  v_add_u32 v7, 10240, v226
  s_mul_i32 s21, s58, 2560
  s_add_u32 s21, s21, 40960
  s_lshr_b32 s22, s56, 1
  s_lshl_b32 s22, s22, 10
  s_and_b32 s23, s56, 1
  s_lshl_b32 s23, s23, 3
  s_add_u32 s22, s22, s23
  s_lshl_b32 s23, s20, 7
  s_add_u32 s22, s22, s23
  s_add_u32 s22, s22, s21
  v_lshlrev_b32 v226, 8, v3
  v_lshl_add_u32 v226, v224, 4, v226
  v_add_u32 v8, s22, v226
  s_lshl_b32 s22, s56, 2
  s_add_u32 s22, s22, s21
  s_add_u32 s22, s22, 2048
  v_and_b32 v226, 0x1ff, v226
  v_add_u32 v226, s22, v226
  s_cmp_eq_u32 s20, 2
  s_cselect_b64 vcc, -1, 0
  v_cmp_le_u32 s[64:65], 32, v1
  v_cndmask_b32 v8, v8, v226, vcc
  s_cselect_b64 s[64:65], s[64:65], -1
  s_and_b64 s[64:65], s[64:65], s[62:63]
  s_mul_i32 s21, s59, 2560
  s_add_u32 s21, s21, 40960
  v_add_u32 v9, s21, v4
  v_and_b32 v226, 0x1ff, v4
  s_add_u32 s21, s21, 2048
  v_add_u32 v10, s21, v226
  v_lshrrev_b32 v226, 2, v2
  v_and_b32 v227, 1, v2
  v_lshl_add_u32 v228, v226, 1, v227
  v_and_b32 v227, 2, v2
  v_cmp_eq_u32 vcc, 0, v227
  s_lshr_b32 s21, s20, 1
  s_lshl_b32 s21, s21, 9
  s_and_b32 s22, s20, 1
  s_lshl_b32 s22, s22, 6
  s_add_u32 s21, s21, s22
  s_add_u32 s21, s21, 12544
  v_lshlrev_b32 v226, 7, v3
  v_lshl_add_u32 v226, v228, 3, v226
  v_add_u32 v226, s21, v226
  v_mov_b32 v227, 13568
  v_cndmask_b32 v11, v227, v226, vcc
  s_lshl_b32 s21, s20, 9
  s_add_u32 s21, s21, 40960
  v_lshlrev_b32 v226, 7, v3
  v_lshl_add_u32 v226, v228, 4, v226
  v_add_u32 v226, s21, v226
  v_mov_b32 v227, 46080
  v_cndmask_b32 v19, v227, v226, vcc
  s_lshl_b32 s21, s20, 11
  s_add_u32 s21, s21, 32768
  v_add_u32 v18, s21, v4
  s_and_b32 s21, s20, 1
  s_lshl_b32 s22, s21, 10
  s_add_u32 s22, s22, 43008
  v_add_u32 v20, s22, v4
  s_lshl_b32 s22, s21, 3
  s_add_u32 s22, s22, 45056
  v_add_u32 v21, s22, v4
  s_mul_i32 s21, s20, 640
  s_add_u32 s22, s21, 13824
  v_lshlrev_b32 v226, 4, v224
  v_lshl_add_u32 v227, v3, 7, v226
  v_add_u32 v13, s22, v227
  v_lshl_add_u32 v227, v3, 2, v226
  s_add_u32 s22, s22, 512
  v_add_u32 v14, s22, v227
  v_lshrrev_b32 v228, 5, v1
  v_add_u32 v26, s21, v4
  v_lshl_add_u32 v228, v228, 1, v225
  v_mul_u32_u24 v228, 640, v228
  v_and_b32 v226, 1, v3
  v_lshl_add_u32 v228, v226, 6, v228
  v_lshl_add_u32 v228, v224, 3, v228
  v_add_u32 v43, 512, v228
  s_and_b32 s21, s50, 1
  s_lshl_b32 s21, s21, 4
  s_add_u32 s21, s21, s51
  s_lshl_b32 s22, s20, 5
  s_add_u32 s21, s21, s22
  s_cmp_lt_u32 s21, 80
  s_cselect_b32 s78, 1, 0
  s_cselect_b32 s21, s21, 0
  s_lshl_b32 s22, s21, 7
  v_add_u32 v17, s22, v227
  s_lshr_b32 s22, s21, 3
  s_lshl_b32 s22, s22, 14
  s_and_b32 s21, s21, 7
  s_lshl_b32 s21, s21, 10
  s_add_u32 s21, s21, s22
  v_add_u32 v16, s21, v4
  s_mul_i32 s21, s60, 10
  s_mul_i32 s22, s61, 6
  s_add_u32 s22, s22, s21
  s_add_u32 s21, s21, s61
  s_add_u32 s21, s21, 4
  v_lshrrev_b32 v226, 3, v1
  v_cmp_gt_u32 vcc, 4, v226
  v_add_u32 v226, s22, v226
  v_mov_b32 v227, s21
  v_cndmask_b32 v226, v227, v226, vcc
  v_lshrrev_b32 v227, 3, v226
  v_lshlrev_b32 v227, 14, v227
  v_and_b32 v226, 7, v226
  v_lshl_add_u32 v226, v226, 10, v227
  v_lshl_add_u32 v226, v224, 4, v226
  s_lshl_b32 s21, s50, 7
  v_add_u32 v15, s21, v226
  v_and_b32 v226, 1, v2
  v_lshlrev_b32 v226, 4, v226
  v_mov_b32 v227, 0x3c00
  v_lshlrev_b32 v226, v226, v227
  v_lshrrev_b32 v227, 1, v2
  v_cmp_eq_u32 vcc, 0, v227
  s_nop 1
  v_cndmask_b32 v44, 0, v226, vcc
  v_cmp_eq_u32 vcc, 2, v227
  s_nop 1
  v_cndmask_b32 v45, 0, v226, vcc
  v_cmp_eq_u32 vcc, 4, v227
  s_nop 1
  v_cndmask_b32 v46, 0, v226, vcc
  v_cmp_eq_u32 vcc, 6, v227
  s_nop 1
  v_cndmask_b32 v47, 0, v226, vcc
  v_lshrrev_b32 v226, 5, v1
  v_lshlrev_b32 v226, 14, v226
  v_bfe_u32 v227, v1, 3, 2
  v_lshl_add_u32 v226, v227, 8, v226
  v_lshl_add_u32 v226, v224, 4, v226
  s_lshl_b32 s21, s61, 7
  v_add_u32 v32, s21, v226
  v_lshlrev_b32 v226, 4, v224
  v_lshl_add_u32 v36, v3, 7, v226
  v_lshrrev_b32 v37, 1, v36
  v_and_b32 v41, 3, v1
  v_lshlrev_b32 v41, 7, v41
  v_mov_b32 v226, 0x40000000
  v_cmp_gt_u32 vcc, 32, v1
  v_cndmask_b32 v36, v226, v36, s[68:69]
  v_cndmask_b32 v37, v226, v37, s[68:69]
  v_cndmask_b32 v26, v226, v26, vcc
  s_lshr_b32 s21, s50, 1
  s_lshl_b32 s21, s21, 8
  s_add_u32 s21, s21, 491520
  v_and_b32 v227, 31, v1
  v_lshl_add_u32 v33, v227, 2, s21
  s_and_b32 s22, s50, 1
  s_lshl_b32 s22, s22, 4
  s_add_u32 s22, s22, s51
  v_cmp_eq_u32 vcc, s22, v1
  s_nop 1
  v_cndmask_b32 v34, v226, v33, vcc
  v_mov_b32 v28, -1
  v_mov_b32 v29, -1
  v_mov_b32 v30, -1
  v_mov_b32 v31, -1
  s_lshr_b32 s21, s50, 1
  s_mul_i32 s77, s21, 10240
  s_cmp_eq_u32 s20, 3
  s_cbranch_scc1 ar_8
  s_mov_b64 exec, s[64:65]
  s_cmp_eq_u32 s20, 2
  s_cbranch_scc1 ar_7
  s_mov_b32 s21, 0
  buffer_store_dwordx2 v[28:29], v8, s[8:11], s21 offen
  s_mov_b32 s21, 122880
  buffer_store_dwordx2 v[28:29], v8, s[8:11], s21 offen
  s_mov_b32 s21, 245760
  buffer_store_dwordx2 v[28:29], v8, s[8:11], s21 offen
  s_mov_b32 s21, 368640
  buffer_store_dwordx2 v[28:29], v8, s[8:11], s21 offen
  s_branch ar_9
ar_7:
  s_mov_b32 s21, 0
  buffer_store_dword v28, v8, s[8:11], s21 offen
  buffer_store_dword v28, v8, s[8:11], s21 offen offset:128
  s_mov_b32 s21, 122880
  buffer_store_dword v28, v8, s[8:11], s21 offen
  buffer_store_dword v28, v8, s[8:11], s21 offen offset:128
  s_mov_b32 s21, 245760
  buffer_store_dword v28, v8, s[8:11], s21 offen
  buffer_store_dword v28, v8, s[8:11], s21 offen offset:128
  s_mov_b32 s21, 368640
  buffer_store_dword v28, v8, s[8:11], s21 offen
  buffer_store_dword v28, v8, s[8:11], s21 offen offset:128
ar_9:
  s_cmp_eq_u32 s78, 0
  s_cbranch_scc1 ar_10
  s_mov_b64 exec, s[62:63]
  s_add_u32 s21, s77, 0
  buffer_store_dword v28, v17, s[8:11], s21 offen
  s_add_u32 s21, s77, 122880
  buffer_store_dword v28, v17, s[8:11], s21 offen
  s_add_u32 s21, s77, 245760
  buffer_store_dword v28, v17, s[8:11], s21 offen
  s_add_u32 s21, s77, 368640
  buffer_store_dword v28, v17, s[8:11], s21 offen
  s_branch ar_10
ar_8:
  buffer_store_dword v28, v34, s[8:11], 0 offen
  s_mov_b64 exec, s[66:67]
  s_mov_b32 s21, 0
  buffer_store_dwordx4 v[28:31], v15, s[4:7], s21 offen sc1
  s_mov_b32 s21, 262144
  buffer_store_dwordx4 v[28:31], v15, s[4:7], s21 offen sc1
  s_mov_b32 s21, 524288
  buffer_store_dwordx4 v[28:31], v15, s[4:7], s21 offen sc1
  s_mov_b32 s21, 786432
  buffer_store_dwordx4 v[28:31], v15, s[4:7], s21 offen sc1
  s_mov_b32 s21, 8192
  buffer_store_dwordx4 v[28:31], v15, s[4:7], s21 offen sc1
  s_mov_b32 s21, 270336
  buffer_store_dwordx4 v[28:31], v15, s[4:7], s21 offen sc1
  s_mov_b32 s21, 532480
  buffer_store_dwordx4 v[28:31], v15, s[4:7], s21 offen sc1
  s_mov_b32 s21, 794624
  buffer_store_dwordx4 v[28:31], v15, s[4:7], s21 offen sc1
ar_10:
  s_mov_b64 exec, -1
  v_lshrrev_b32 v66, 2, v2
  v_lshl_add_u32 v66, v3, 3, v66
  v_mul_u32_u24 v66, 96, v66
  v_add_u32 v66, s81, v66
  v_and_b32 v67, 3, v2
  s_lshl_b32 s21, s61, 5
  v_lshl_add_u32 v68, v67, 4, v66
  v_add_u32 v68, s21, v68
  s_mul_i32 s21, s61, 48
  s_sub_u32 s21, 64, s21
  v_and_b32 v67, 1, v2
  v_lshl_add_u32 v69, v67, 3, v66
  v_add_u32 v69, s21, v69
  v_lshrrev_b32 v226, 3, v2
  v_lshlrev_b32 v226, 4, v226
  v_bfe_u32 v227, v2, 1, 1
  v_lshl_add_u32 v226, v227, 3, v226
  v_and_b32 v227, 5, v2
  v_add_u32 v226, v226, v227
  v_mul_u32_u24 v226, 384, v226
  v_add_u32 v226, s81, v226
  v_lshrrev_b32 v227, 1, v2
  v_xor_b32 v227, v227, v3
  v_lshl_add_u32 v70, v227, 4, v226
  v_xor_b32 v227, 4, v227
  v_lshl_add_u32 v71, v227, 4, v226
  s_waitcnt vmcnt(0)
  ds_read_b64_tr_b16 v[72:73], v68 offset:0
  ds_read_b64_tr_b16 v[74:75], v68 offset:384
  ds_read_b64_tr_b16 v[76:77], v68 offset:8
  ds_read_b64_tr_b16 v[78:79], v68 offset:392
  ds_read_b64_tr_b16 v[80:81], v69 offset:0
  ds_read_b64_tr_b16 v[82:83], v69 offset:384
  ds_read_b64_tr_b16 v[84:85], v68 offset:3072
  ds_read_b64_tr_b16 v[86:87], v68 offset:3456
  ds_read_b64_tr_b16 v[88:89], v68 offset:3080
  ds_read_b64_tr_b16 v[90:91], v68 offset:3464
  ds_read_b64_tr_b16 v[92:93], v69 offset:3072
  ds_read_b64_tr_b16 v[94:95], v69 offset:3456
  ds_read_b64_tr_b16 v[96:97], v68 offset:6144
  ds_read_b64_tr_b16 v[98:99], v68 offset:6528
  ds_read_b64_tr_b16 v[100:101], v68 offset:6152
  ds_read_b64_tr_b16 v[102:103], v68 offset:6536
  ds_read_b64_tr_b16 v[104:105], v69 offset:6144
  ds_read_b64_tr_b16 v[106:107], v69 offset:6528
  ds_read_b64_tr_b16 v[108:109], v68 offset:9216
  ds_read_b64_tr_b16 v[110:111], v68 offset:9600
  ds_read_b64_tr_b16 v[112:113], v68 offset:9224
  ds_read_b64_tr_b16 v[114:115], v68 offset:9608
  ds_read_b64_tr_b16 v[116:117], v69 offset:9216
  ds_read_b64_tr_b16 v[118:119], v69 offset:9600
  ds_read_b64_tr_b16 v[120:121], v68 offset:12288
  ds_read_b64_tr_b16 v[122:123], v68 offset:12672
  ds_read_b64_tr_b16 v[124:125], v68 offset:12296
  ds_read_b64_tr_b16 v[126:127], v68 offset:12680
  ds_read_b64_tr_b16 v[128:129], v69 offset:12288
  ds_read_b64_tr_b16 v[130:131], v69 offset:12672
  ds_read_b64_tr_b16 v[132:133], v68 offset:15360
  ds_read_b64_tr_b16 v[134:135], v68 offset:15744
  ds_read_b64_tr_b16 v[136:137], v68 offset:15368
  ds_read_b64_tr_b16 v[138:139], v68 offset:15752
  ds_read_b64_tr_b16 v[140:141], v69 offset:15360
  ds_read_b64_tr_b16 v[142:143], v69 offset:15744
  s_waitcnt lgkmcnt(0)
  s_barrier
  s_cmp_lg_u32 s20, 0
  s_cbranch_scc1 ic_11
  v_mov_b32 v68, 64
  v_mov_b32 v69, 1
  s_mov_b64 exec, 1
  buffer_atomic_add v69, v68, s[32:35], 0 offen sc1
  s_mov_b64 exec, -1
ic_11:
  s_add_u32 m0, s81, 0
  s_nop 0
  buffer_load_dwordx4 v48, s[12:15], s80 offen lds
  s_add_u32 m0, s81, 1024
  s_nop 0
  buffer_load_dwordx4 v49, s[12:15], s80 offen lds
  s_add_u32 m0, s81, 2048
  s_nop 0
  buffer_load_dwordx4 v50, s[12:15], s80 offen lds
  s_add_u32 m0, s81, 3072
  s_nop 0
  buffer_load_dwordx4 v51, s[12:15], s80 offen lds
  s_add_u32 m0, s81, 4096
  s_nop 0
  buffer_load_dwordx4 v52, s[12:15], s80 offen lds
  s_add_u32 m0, s81, 5120
  s_nop 0
  buffer_load_dwordx4 v53, s[12:15], s80 offen lds
  s_add_u32 m0, s81, 6144
  s_nop 0
  buffer_load_dwordx4 v54, s[12:15], s80 offen lds
  s_add_u32 m0, s81, 7168
  s_nop 0
  buffer_load_dwordx4 v55, s[12:15], s80 offen lds
  s_add_u32 m0, s81, 8192
  s_nop 0
  buffer_load_dwordx4 v56, s[12:15], s80 offen lds
  s_add_u32 m0, s81, 9216
  s_nop 0
  buffer_load_dwordx4 v57, s[12:15], s80 offen lds
  s_add_u32 m0, s81, 10240
  s_nop 0
  buffer_load_dwordx4 v58, s[12:15], s80 offen lds
  s_add_u32 m0, s81, 11264
  s_nop 0
  buffer_load_dwordx4 v59, s[12:15], s80 offen lds
  s_add_u32 s80, s80, 393216
  s_add_u32 s16, s48, 173080576
  s_addc_u32 s17, s49, 0
  s_mov_b32 s18, 49152
  s_mov_b32 s19, 0x00020000
  v_add_u32 v68, s81, v4
  v_and_b32 v69, 7, v2
  v_lshl_add_u32 v69, v3, 3, v69
  v_and_b32 v67, 8, v2
  v_lshl_add_u32 v69, v69, 4, v67
  v_add_u32 v69, s81, v69
  v_lshlrev_b32 v67, 2, v1
  s_lshl_b32 s90, s50, 9
  s_and_b32 s21, s51, 12
  s_add_u32 s90, s90, s21
  s_add_u32 s90, s90, 4096
  ds_read_b128 v[208:211], v70 offset:24576
  ds_read_b128 v[212:215], v71 offset:24576
  ds_read_b128 v[216:219], v70 offset:24704
  s_waitcnt lgkmcnt(2)
  v_mfma_f32_16x16x32_bf16 v[184:187], v[208:211], v[72:75], 0
  ds_read_b128 v[220:223], v71 offset:24704
  v_mfma_f32_16x16x32_bf16 v[188:191], v[208:211], v[76:79], 0
  s_add_u32 m0, s81, 12288
  s_nop 0
  buffer_load_dwordx4 v48, s[12:15], s80 offen lds
  v_mfma_f32_16x16x32_bf16 v[192:195], v[208:211], v[80:83], 0
  s_waitcnt lgkmcnt(2)
  v_mfma_f32_16x16x32_bf16 v[184:187], v[212:215], v[84:87], v[184:187]
  ds_read_b128 v[208:211], v70 offset:24832
  v_mfma_f32_16x16x32_bf16 v[188:191], v[212:215], v[88:91], v[188:191]
  s_add_u32 m0, s81, 13312
  s_nop 0
  buffer_load_dwordx4 v49, s[12:15], s80 offen lds
  v_mfma_f32_16x16x32_bf16 v[192:195], v[212:215], v[92:95], v[192:195]
  s_waitcnt lgkmcnt(2)
  v_mfma_f32_16x16x32_bf16 v[184:187], v[216:219], v[96:99], v[184:187]
  ds_read_b128 v[212:215], v71 offset:24832
  v_mfma_f32_16x16x32_bf16 v[188:191], v[216:219], v[100:103], v[188:191]
  s_add_u32 m0, s81, 14336
  s_nop 0
  buffer_load_dwordx4 v50, s[12:15], s80 offen lds
  v_mfma_f32_16x16x32_bf16 v[192:195], v[216:219], v[104:107], v[192:195]
  s_waitcnt lgkmcnt(2)
  v_mfma_f32_16x16x32_bf16 v[184:187], v[220:223], v[108:111], v[184:187]
  ds_read_b128 v[216:219], v70 offset:25344
  v_mfma_f32_16x16x32_bf16 v[188:191], v[220:223], v[112:115], v[188:191]
  s_add_u32 m0, s81, 15360
  s_nop 0
  buffer_load_dwordx4 v51, s[12:15], s80 offen lds
  v_mfma_f32_16x16x32_bf16 v[192:195], v[220:223], v[116:119], v[192:195]
  s_waitcnt lgkmcnt(2)
  v_mfma_f32_16x16x32_bf16 v[184:187], v[208:211], v[120:123], v[184:187]
  ds_read_b128 v[220:223], v71 offset:25344
  v_mfma_f32_16x16x32_bf16 v[188:191], v[208:211], v[124:127], v[188:191]
  s_add_u32 m0, s81, 16384
  s_nop 0
  buffer_load_dwordx4 v52, s[12:15], s80 offen lds
  v_mfma_f32_16x16x32_bf16 v[192:195], v[208:211], v[128:131], v[192:195]
  s_waitcnt lgkmcnt(2)
  v_mfma_f32_16x16x32_bf16 v[184:187], v[212:215], v[132:135], v[184:187]
  ds_read_b128 v[208:211], v70 offset:25472
  v_mfma_f32_16x16x32_bf16 v[188:191], v[212:215], v[136:139], v[188:191]
  s_add_u32 m0, s81, 17408
  s_nop 0
  buffer_load_dwordx4 v53, s[12:15], s80 offen lds
  v_mfma_f32_16x16x32_bf16 v[192:195], v[212:215], v[140:143], v[192:195]
  s_waitcnt lgkmcnt(2)
  v_mfma_f32_16x16x32_bf16 v[196:199], v[216:219], v[72:75], 0
  ds_read_b128 v[212:215], v71 offset:25472
  v_mfma_f32_16x16x32_bf16 v[200:203], v[216:219], v[76:79], 0
  s_add_u32 m0, s81, 18432
  s_nop 0
  buffer_load_dwordx4 v54, s[12:15], s80 offen lds
  v_mfma_f32_16x16x32_bf16 v[204:207], v[216:219], v[80:83], 0
  s_waitcnt lgkmcnt(2)
  v_mfma_f32_16x16x32_bf16 v[196:199], v[220:223], v[84:87], v[196:199]
  ds_read_b128 v[216:219], v70 offset:25600
  v_cvt_pk_bf16_f32 v248, v184, v185
  v_mfma_f32_16x16x32_bf16 v[200:203], v[220:223], v[88:91], v[200:203]
  s_add_u32 m0, s81, 19456
  s_nop 0
  buffer_load_dwordx4 v55, s[12:15], s80 offen lds
  v_mfma_f32_16x16x32_bf16 v[204:207], v[220:223], v[92:95], v[204:207]
  v_cvt_pk_bf16_f32 v249, v186, v187
  s_waitcnt lgkmcnt(2)
  v_mfma_f32_16x16x32_bf16 v[196:199], v[208:211], v[96:99], v[196:199]
  ds_read_b128 v[220:223], v71 offset:25600
  v_cvt_pk_bf16_f32 v250, v188, v189
  v_mfma_f32_16x16x32_bf16 v[200:203], v[208:211], v[100:103], v[200:203]
  s_add_u32 m0, s81, 20480
  s_nop 0
  buffer_load_dwordx4 v56, s[12:15], s80 offen lds
  v_mfma_f32_16x16x32_bf16 v[204:207], v[208:211], v[104:107], v[204:207]
  v_cvt_pk_bf16_f32 v251, v190, v191
  s_waitcnt lgkmcnt(2)
  v_mfma_f32_16x16x32_bf16 v[196:199], v[212:215], v[108:111], v[196:199]
  v_accvgpr_write_b32 a0, v248
  v_mfma_f32_16x16x32_bf16 v[200:203], v[212:215], v[112:115], v[200:203]
  s_add_u32 m0, s81, 21504
  s_nop 0
  buffer_load_dwordx4 v57, s[12:15], s80 offen lds
  v_mfma_f32_16x16x32_bf16 v[204:207], v[212:215], v[116:119], v[204:207]
  v_accvgpr_write_b32 a1, v249
  s_waitcnt lgkmcnt(1)
  v_mfma_f32_16x16x32_bf16 v[196:199], v[216:219], v[120:123], v[196:199]
  v_accvgpr_write_b32 a80, v250
  v_mfma_f32_16x16x32_bf16 v[200:203], v[216:219], v[124:127], v[200:203]
  s_add_u32 m0, s81, 22528
  s_nop 0
  buffer_load_dwordx4 v58, s[12:15], s80 offen lds
  v_mfma_f32_16x16x32_bf16 v[204:207], v[216:219], v[128:131], v[204:207]
  v_accvgpr_write_b32 a81, v251
  s_waitcnt lgkmcnt(0)
  v_mfma_f32_16x16x32_bf16 v[196:199], v[220:223], v[132:135], v[196:199]
  v_cvt_pk_bf16_f32 v144, v192, v193
  v_cvt_pk_bf16_f32 v145, v194, v195
  v_mfma_f32_16x16x32_bf16 v[200:203], v[220:223], v[136:139], v[200:203]
  s_add_u32 m0, s81, 23552
  s_nop 0
  buffer_load_dwordx4 v59, s[12:15], s80 offen lds
  s_add_u32 s80, s80, 393216
  v_mfma_f32_16x16x32_bf16 v[204:207], v[220:223], v[140:143], v[204:207]
  s_waitcnt vmcnt(12)
  ds_read_b128 v[208:211], v70 offset:0
  ds_read_b128 v[212:215], v71 offset:0
  ds_read_b128 v[216:219], v70 offset:128
  s_waitcnt lgkmcnt(2)
  v_mfma_f32_16x16x32_bf16 v[184:187], v[208:211], v[72:75], 0
  ds_read_b128 v[220:223], v71 offset:128
  v_mfma_f32_16x16x32_bf16 v[188:191], v[208:211], v[76:79], 0
  s_add_u32 m0, s81, 24576
  s_nop 0
  buffer_load_dwordx4 v48, s[12:15], s80 offen lds
  v_mfma_f32_16x16x32_bf16 v[192:195], v[208:211], v[80:83], 0
  s_waitcnt lgkmcnt(2)
  v_mfma_f32_16x16x32_bf16 v[184:187], v[212:215], v[84:87], v[184:187]
  ds_read_b128 v[208:211], v70 offset:256
  v_cvt_pk_bf16_f32 v248, v196, v197
  v_mfma_f32_16x16x32_bf16 v[188:191], v[212:215], v[88:91], v[188:191]
  s_add_u32 m0, s81, 25600
  s_nop 0
  buffer_load_dwordx4 v49, s[12:15], s80 offen lds
  v_mfma_f32_16x16x32_bf16 v[192:195], v[212:215], v[92:95], v[192:195]
  v_cvt_pk_bf16_f32 v249, v198, v199
  s_waitcnt lgkmcnt(2)
  v_mfma_f32_16x16x32_bf16 v[184:187], v[216:219], v[96:99], v[184:187]
  ds_read_b128 v[212:215], v71 offset:256
  v_cvt_pk_bf16_f32 v250, v200, v201
  v_mfma_f32_16x16x32_bf16 v[188:191], v[216:219], v[100:103], v[188:191]
  s_add_u32 m0, s81, 26624
  s_nop 0
  buffer_load_dwordx4 v50, s[12:15], s80 offen lds
  v_mfma_f32_16x16x32_bf16 v[192:195], v[216:219], v[104:107], v[192:195]
  v_cvt_pk_bf16_f32 v251, v202, v203
  s_waitcnt lgkmcnt(2)
  v_mfma_f32_16x16x32_bf16 v[184:187], v[220:223], v[108:111], v[184:187]
  ds_read_b128 v[216:219], v70 offset:768
  v_accvgpr_write_b32 a2, v248
  v_mfma_f32_16x16x32_bf16 v[188:191], v[220:223], v[112:115], v[188:191]
  s_add_u32 m0, s81, 27648
  s_nop 0
  buffer_load_dwordx4 v51, s[12:15], s80 offen lds
  v_mfma_f32_16x16x32_bf16 v[192:195], v[220:223], v[116:119], v[192:195]
  v_accvgpr_write_b32 a3, v249
  s_waitcnt lgkmcnt(2)
  v_mfma_f32_16x16x32_bf16 v[184:187], v[208:211], v[120:123], v[184:187]
  ds_read_b128 v[220:223], v71 offset:768
  v_accvgpr_write_b32 a82, v250
  v_mfma_f32_16x16x32_bf16 v[188:191], v[208:211], v[124:127], v[188:191]
  s_add_u32 m0, s81, 28672
  s_nop 0
  buffer_load_dwordx4 v52, s[12:15], s80 offen lds
  v_mfma_f32_16x16x32_bf16 v[192:195], v[208:211], v[128:131], v[192:195]
  v_accvgpr_write_b32 a83, v251
  s_waitcnt lgkmcnt(2)
  v_mfma_f32_16x16x32_bf16 v[184:187], v[212:215], v[132:135], v[184:187]
  ds_read_b128 v[208:211], v70 offset:896
  s_mov_b64 exec, s[68:69]
  v_cvt_pk_bf16_f32 v144, v204, v205
  v_cvt_pk_bf16_f32 v145, v206, v207
  s_mov_b64 exec, -1
  v_mfma_f32_16x16x32_bf16 v[188:191], v[212:215], v[136:139], v[188:191]
  s_add_u32 m0, s81, 29696
  s_nop 0
  buffer_load_dwordx4 v53, s[12:15], s80 offen lds
  v_mfma_f32_16x16x32_bf16 v[192:195], v[212:215], v[140:143], v[192:195]
  s_waitcnt lgkmcnt(2)
  v_mfma_f32_16x16x32_bf16 v[196:199], v[216:219], v[72:75], 0
  ds_read_b128 v[212:215], v71 offset:896
  v_mfma_f32_16x16x32_bf16 v[200:203], v[216:219], v[76:79], 0
  s_add_u32 m0, s81, 30720
  s_nop 0
  buffer_load_dwordx4 v54, s[12:15], s80 offen lds
  v_mfma_f32_16x16x32_bf16 v[204:207], v[216:219], v[80:83], 0
  s_waitcnt lgkmcnt(2)
  v_mfma_f32_16x16x32_bf16 v[196:199], v[220:223], v[84:87], v[196:199]
  ds_read_b128 v[216:219], v70 offset:1024
  v_cvt_pk_bf16_f32 v248, v184, v185
  v_mfma_f32_16x16x32_bf16 v[200:203], v[220:223], v[88:91], v[200:203]
  s_add_u32 m0, s81, 31744
  s_nop 0
  buffer_load_dwordx4 v55, s[12:15], s80 offen lds
  v_mfma_f32_16x16x32_bf16 v[204:207], v[220:223], v[92:95], v[204:207]
  v_cvt_pk_bf16_f32 v249, v186, v187
  s_waitcnt lgkmcnt(2)
  v_mfma_f32_16x16x32_bf16 v[196:199], v[208:211], v[96:99], v[196:199]
  ds_read_b128 v[220:223], v71 offset:1024
  v_cvt_pk_bf16_f32 v250, v188, v189
  v_mfma_f32_16x16x32_bf16 v[200:203], v[208:211], v[100:103], v[200:203]
  s_add_u32 m0, s81, 32768
  s_nop 0
  buffer_load_dwordx4 v56, s[12:15], s80 offen lds
  v_mfma_f32_16x16x32_bf16 v[204:207], v[208:211], v[104:107], v[204:207]
  v_cvt_pk_bf16_f32 v251, v190, v191
  s_waitcnt lgkmcnt(2)
  v_mfma_f32_16x16x32_bf16 v[196:199], v[212:215], v[108:111], v[196:199]
  v_accvgpr_write_b32 a4, v248
  v_mfma_f32_16x16x32_bf16 v[200:203], v[212:215], v[112:115], v[200:203]
  s_add_u32 m0, s81, 33792
  s_nop 0
  buffer_load_dwordx4 v57, s[12:15], s80 offen lds
  v_mfma_f32_16x16x32_bf16 v[204:207], v[212:215], v[116:119], v[204:207]
  v_accvgpr_write_b32 a5, v249
  s_waitcnt lgkmcnt(1)
  v_mfma_f32_16x16x32_bf16 v[196:199], v[216:219], v[120:123], v[196:199]
  v_accvgpr_write_b32 a84, v250
  v_mfma_f32_16x16x32_bf16 v[200:203], v[216:219], v[124:127], v[200:203]
  s_add_u32 m0, s81, 34816
  s_nop 0
  buffer_load_dwordx4 v58, s[12:15], s80 offen lds
  v_mfma_f32_16x16x32_bf16 v[204:207], v[216:219], v[128:131], v[204:207]
  v_accvgpr_write_b32 a85, v251
  s_waitcnt lgkmcnt(0)
  v_mfma_f32_16x16x32_bf16 v[196:199], v[220:223], v[132:135], v[196:199]
  v_cvt_pk_bf16_f32 v146, v192, v193
  v_cvt_pk_bf16_f32 v147, v194, v195
  v_mfma_f32_16x16x32_bf16 v[200:203], v[220:223], v[136:139], v[200:203]
  s_add_u32 m0, s81, 35840
  s_nop 0
  buffer_load_dwordx4 v59, s[12:15], s80 offen lds
  s_add_u32 s80, s80, 393216
  v_mfma_f32_16x16x32_bf16 v[204:207], v[220:223], v[140:143], v[204:207]
  s_waitcnt vmcnt(12)
  ds_read_b128 v[208:211], v70 offset:12288
  ds_read_b128 v[212:215], v71 offset:12288
  ds_read_b128 v[216:219], v70 offset:12416
  s_waitcnt lgkmcnt(2)
  v_mfma_f32_16x16x32_bf16 v[184:187], v[208:211], v[72:75], 0
  ds_read_b128 v[220:223], v71 offset:12416
  v_mfma_f32_16x16x32_bf16 v[188:191], v[208:211], v[76:79], 0
  s_add_u32 m0, s81, 0
  s_nop 0
  buffer_load_dwordx4 v48, s[12:15], s80 offen lds
  v_mfma_f32_16x16x32_bf16 v[192:195], v[208:211], v[80:83], 0
  s_waitcnt lgkmcnt(2)
  v_mfma_f32_16x16x32_bf16 v[184:187], v[212:215], v[84:87], v[184:187]
  ds_read_b128 v[208:211], v70 offset:12544
  v_cvt_pk_bf16_f32 v248, v196, v197
  v_mfma_f32_16x16x32_bf16 v[188:191], v[212:215], v[88:91], v[188:191]
  s_add_u32 m0, s81, 1024
  s_nop 0
  buffer_load_dwordx4 v49, s[12:15], s80 offen lds
  v_mfma_f32_16x16x32_bf16 v[192:195], v[212:215], v[92:95], v[192:195]
  v_cvt_pk_bf16_f32 v249, v198, v199
  s_waitcnt lgkmcnt(2)
  v_mfma_f32_16x16x32_bf16 v[184:187], v[216:219], v[96:99], v[184:187]
  ds_read_b128 v[212:215], v71 offset:12544
  v_cvt_pk_bf16_f32 v250, v200, v201
  v_mfma_f32_16x16x32_bf16 v[188:191], v[216:219], v[100:103], v[188:191]
  s_add_u32 m0, s81, 2048
  s_nop 0
  buffer_load_dwordx4 v50, s[12:15], s80 offen lds
  v_mfma_f32_16x16x32_bf16 v[192:195], v[216:219], v[104:107], v[192:195]
  v_cvt_pk_bf16_f32 v251, v202, v203
  s_waitcnt lgkmcnt(2)
  v_mfma_f32_16x16x32_bf16 v[184:187], v[220:223], v[108:111], v[184:187]
  ds_read_b128 v[216:219], v70 offset:13056
  v_accvgpr_write_b32 a6, v248
  v_mfma_f32_16x16x32_bf16 v[188:191], v[220:223], v[112:115], v[188:191]
  s_add_u32 m0, s81, 3072
  s_nop 0
  buffer_load_dwordx4 v51, s[12:15], s80 offen lds
  v_mfma_f32_16x16x32_bf16 v[192:195], v[220:223], v[116:119], v[192:195]
  v_accvgpr_write_b32 a7, v249
  s_waitcnt lgkmcnt(2)
  v_mfma_f32_16x16x32_bf16 v[184:187], v[208:211], v[120:123], v[184:187]
  ds_read_b128 v[220:223], v71 offset:13056
  v_accvgpr_write_b32 a86, v250
  v_mfma_f32_16x16x32_bf16 v[188:191], v[208:211], v[124:127], v[188:191]
  s_add_u32 m0, s81, 4096
  s_nop 0
  buffer_load_dwordx4 v52, s[12:15], s80 offen lds
  v_mfma_f32_16x16x32_bf16 v[192:195], v[208:211], v[128:131], v[192:195]
  v_accvgpr_write_b32 a87, v251
  s_waitcnt lgkmcnt(2)
  v_mfma_f32_16x16x32_bf16 v[184:187], v[212:215], v[132:135], v[184:187]
  ds_read_b128 v[208:211], v70 offset:13184
  s_mov_b64 exec, s[68:69]
  v_cvt_pk_bf16_f32 v146, v204, v205
  v_cvt_pk_bf16_f32 v147, v206, v207
  s_mov_b64 exec, -1
  v_mfma_f32_16x16x32_bf16 v[188:191], v[212:215], v[136:139], v[188:191]
  s_add_u32 m0, s81, 5120
  s_nop 0
  buffer_load_dwordx4 v53, s[12:15], s80 offen lds
  v_mfma_f32_16x16x32_bf16 v[192:195], v[212:215], v[140:143], v[192:195]
  s_waitcnt lgkmcnt(2)
  v_mfma_f32_16x16x32_bf16 v[196:199], v[216:219], v[72:75], 0
  ds_read_b128 v[212:215], v71 offset:13184
  v_mfma_f32_16x16x32_bf16 v[200:203], v[216:219], v[76:79], 0
  s_add_u32 m0, s81, 6144
  s_nop 0
  buffer_load_dwordx4 v54, s[12:15], s80 offen lds
  v_mfma_f32_16x16x32_bf16 v[204:207], v[216:219], v[80:83], 0
  s_waitcnt lgkmcnt(2)
  v_mfma_f32_16x16x32_bf16 v[196:199], v[220:223], v[84:87], v[196:199]
  ds_read_b128 v[216:219], v70 offset:13312
  v_cvt_pk_bf16_f32 v248, v184, v185
  v_mfma_f32_16x16x32_bf16 v[200:203], v[220:223], v[88:91], v[200:203]
  s_add_u32 m0, s81, 7168
  s_nop 0
  buffer_load_dwordx4 v55, s[12:15], s80 offen lds
  v_mfma_f32_16x16x32_bf16 v[204:207], v[220:223], v[92:95], v[204:207]
  v_cvt_pk_bf16_f32 v249, v186, v187
  s_waitcnt lgkmcnt(2)
  v_mfma_f32_16x16x32_bf16 v[196:199], v[208:211], v[96:99], v[196:199]
  ds_read_b128 v[220:223], v71 offset:13312
  v_cvt_pk_bf16_f32 v250, v188, v189
  v_mfma_f32_16x16x32_bf16 v[200:203], v[208:211], v[100:103], v[200:203]
  s_add_u32 m0, s81, 8192
  s_nop 0
  buffer_load_dwordx4 v56, s[12:15], s80 offen lds
  v_mfma_f32_16x16x32_bf16 v[204:207], v[208:211], v[104:107], v[204:207]
  v_cvt_pk_bf16_f32 v251, v190, v191
  s_waitcnt lgkmcnt(2)
  v_mfma_f32_16x16x32_bf16 v[196:199], v[212:215], v[108:111], v[196:199]
  v_accvgpr_write_b32 a8, v248
  v_mfma_f32_16x16x32_bf16 v[200:203], v[212:215], v[112:115], v[200:203]
  s_add_u32 m0, s81, 9216
  s_nop 0
  buffer_load_dwordx4 v57, s[12:15], s80 offen lds
  v_mfma_f32_16x16x32_bf16 v[204:207], v[212:215], v[116:119], v[204:207]
  v_accvgpr_write_b32 a9, v249
  s_waitcnt lgkmcnt(1)
  v_mfma_f32_16x16x32_bf16 v[196:199], v[216:219], v[120:123], v[196:199]
  v_accvgpr_write_b32 a88, v250
  v_mfma_f32_16x16x32_bf16 v[200:203], v[216:219], v[124:127], v[200:203]
  s_add_u32 m0, s81, 10240
  s_nop 0
  buffer_load_dwordx4 v58, s[12:15], s80 offen lds
  v_mfma_f32_16x16x32_bf16 v[204:207], v[216:219], v[128:131], v[204:207]
  v_accvgpr_write_b32 a89, v251
  s_waitcnt lgkmcnt(0)
  v_mfma_f32_16x16x32_bf16 v[196:199], v[220:223], v[132:135], v[196:199]
  v_cvt_pk_bf16_f32 v148, v192, v193
  v_cvt_pk_bf16_f32 v149, v194, v195
  v_mfma_f32_16x16x32_bf16 v[200:203], v[220:223], v[136:139], v[200:203]
  s_add_u32 m0, s81, 11264
  s_nop 0
  buffer_load_dwordx4 v59, s[12:15], s80 offen lds
  s_add_u32 s80, s80, 393216
  v_mfma_f32_16x16x32_bf16 v[204:207], v[220:223], v[140:143], v[204:207]
  s_waitcnt vmcnt(12)
  ds_read_b128 v[208:211], v70 offset:24576
  ds_read_b128 v[212:215], v71 offset:24576
  ds_read_b128 v[216:219], v70 offset:24704
  s_waitcnt lgkmcnt(2)
  v_mfma_f32_16x16x32_bf16 v[184:187], v[208:211], v[72:75], 0
  ds_read_b128 v[220:223], v71 offset:24704
  v_mfma_f32_16x16x32_bf16 v[188:191], v[208:211], v[76:79], 0
  s_add_u32 m0, s81, 12288
  s_nop 0
  buffer_load_dwordx4 v48, s[12:15], s80 offen lds
  v_mfma_f32_16x16x32_bf16 v[192:195], v[208:211], v[80:83], 0
  s_waitcnt lgkmcnt(2)
  v_mfma_f32_16x16x32_bf16 v[184:187], v[212:215], v[84:87], v[184:187]
  ds_read_b128 v[208:211], v70 offset:24832
  v_cvt_pk_bf16_f32 v248, v196, v197
  v_mfma_f32_16x16x32_bf16 v[188:191], v[212:215], v[88:91], v[188:191]
  s_add_u32 m0, s81, 13312
  s_nop 0
  buffer_load_dwordx4 v49, s[12:15], s80 offen lds
  v_mfma_f32_16x16x32_bf16 v[192:195], v[212:215], v[92:95], v[192:195]
  v_cvt_pk_bf16_f32 v249, v198, v199
  s_waitcnt lgkmcnt(2)
  v_mfma_f32_16x16x32_bf16 v[184:187], v[216:219], v[96:99], v[184:187]
  ds_read_b128 v[212:215], v71 offset:24832
  v_cvt_pk_bf16_f32 v250, v200, v201
  v_mfma_f32_16x16x32_bf16 v[188:191], v[216:219], v[100:103], v[188:191]
  s_add_u32 m0, s81, 14336
  s_nop 0
  buffer_load_dwordx4 v50, s[12:15], s80 offen lds
  v_mfma_f32_16x16x32_bf16 v[192:195], v[216:219], v[104:107], v[192:195]
  v_cvt_pk_bf16_f32 v251, v202, v203
  s_waitcnt lgkmcnt(2)
  v_mfma_f32_16x16x32_bf16 v[184:187], v[220:223], v[108:111], v[184:187]
  ds_read_b128 v[216:219], v70 offset:25344
  v_accvgpr_write_b32 a10, v248
  v_mfma_f32_16x16x32_bf16 v[188:191], v[220:223], v[112:115], v[188:191]
  s_add_u32 m0, s81, 15360
  s_nop 0
  buffer_load_dwordx4 v51, s[12:15], s80 offen lds
  v_mfma_f32_16x16x32_bf16 v[192:195], v[220:223], v[116:119], v[192:195]
  v_accvgpr_write_b32 a11, v249
  s_waitcnt lgkmcnt(2)
  v_mfma_f32_16x16x32_bf16 v[184:187], v[208:211], v[120:123], v[184:187]
  ds_read_b128 v[220:223], v71 offset:25344
  v_accvgpr_write_b32 a90, v250
  v_mfma_f32_16x16x32_bf16 v[188:191], v[208:211], v[124:127], v[188:191]
  s_add_u32 m0, s81, 16384
  s_nop 0
  buffer_load_dwordx4 v52, s[12:15], s80 offen lds
  v_mfma_f32_16x16x32_bf16 v[192:195], v[208:211], v[128:131], v[192:195]
  v_accvgpr_write_b32 a91, v251
  s_waitcnt lgkmcnt(2)
  v_mfma_f32_16x16x32_bf16 v[184:187], v[212:215], v[132:135], v[184:187]
  ds_read_b128 v[208:211], v70 offset:25472
  s_mov_b64 exec, s[68:69]
  v_cvt_pk_bf16_f32 v148, v204, v205
  v_cvt_pk_bf16_f32 v149, v206, v207
  s_mov_b64 exec, -1
  v_mfma_f32_16x16x32_bf16 v[188:191], v[212:215], v[136:139], v[188:191]
  s_add_u32 m0, s81, 17408
  s_nop 0
  buffer_load_dwordx4 v53, s[12:15], s80 offen lds
  v_mfma_f32_16x16x32_bf16 v[192:195], v[212:215], v[140:143], v[192:195]
  s_waitcnt lgkmcnt(2)
  v_mfma_f32_16x16x32_bf16 v[196:199], v[216:219], v[72:75], 0
  ds_read_b128 v[212:215], v71 offset:25472
  v_mfma_f32_16x16x32_bf16 v[200:203], v[216:219], v[76:79], 0
  s_add_u32 m0, s81, 18432
  s_nop 0
  buffer_load_dwordx4 v54, s[12:15], s80 offen lds
  v_mfma_f32_16x16x32_bf16 v[204:207], v[216:219], v[80:83], 0
  s_waitcnt lgkmcnt(2)
  v_mfma_f32_16x16x32_bf16 v[196:199], v[220:223], v[84:87], v[196:199]
  ds_read_b128 v[216:219], v70 offset:25600
  v_cvt_pk_bf16_f32 v248, v184, v185
  v_mfma_f32_16x16x32_bf16 v[200:203], v[220:223], v[88:91], v[200:203]
  s_add_u32 m0, s81, 19456
  s_nop 0
  buffer_load_dwordx4 v55, s[12:15], s80 offen lds
  v_mfma_f32_16x16x32_bf16 v[204:207], v[220:223], v[92:95], v[204:207]
  v_cvt_pk_bf16_f32 v249, v186, v187
  s_waitcnt lgkmcnt(2)
  v_mfma_f32_16x16x32_bf16 v[196:199], v[208:211], v[96:99], v[196:199]
  ds_read_b128 v[220:223], v71 offset:25600
  v_cvt_pk_bf16_f32 v250, v188, v189
  v_mfma_f32_16x16x32_bf16 v[200:203], v[208:211], v[100:103], v[200:203]
  s_add_u32 m0, s81, 20480
  s_nop 0
  buffer_load_dwordx4 v56, s[12:15], s80 offen lds
  v_mfma_f32_16x16x32_bf16 v[204:207], v[208:211], v[104:107], v[204:207]
  v_cvt_pk_bf16_f32 v251, v190, v191
  s_waitcnt lgkmcnt(2)
  v_mfma_f32_16x16x32_bf16 v[196:199], v[212:215], v[108:111], v[196:199]
  v_accvgpr_write_b32 a12, v248
  v_mfma_f32_16x16x32_bf16 v[200:203], v[212:215], v[112:115], v[200:203]
  s_add_u32 m0, s81, 21504
  s_nop 0
  buffer_load_dwordx4 v57, s[12:15], s80 offen lds
  v_mfma_f32_16x16x32_bf16 v[204:207], v[212:215], v[116:119], v[204:207]
  v_accvgpr_write_b32 a13, v249
  s_waitcnt lgkmcnt(1)
  v_mfma_f32_16x16x32_bf16 v[196:199], v[216:219], v[120:123], v[196:199]
  v_accvgpr_write_b32 a92, v250
  v_mfma_f32_16x16x32_bf16 v[200:203], v[216:219], v[124:127], v[200:203]
  s_add_u32 m0, s81, 22528
  s_nop 0
  buffer_load_dwordx4 v58, s[12:15], s80 offen lds
  v_mfma_f32_16x16x32_bf16 v[204:207], v[216:219], v[128:131], v[204:207]
  v_accvgpr_write_b32 a93, v251
  s_waitcnt lgkmcnt(0)
  v_mfma_f32_16x16x32_bf16 v[196:199], v[220:223], v[132:135], v[196:199]
  v_cvt_pk_bf16_f32 v150, v192, v193
  v_cvt_pk_bf16_f32 v151, v194, v195
  v_mfma_f32_16x16x32_bf16 v[200:203], v[220:223], v[136:139], v[200:203]
  s_add_u32 m0, s81, 23552
  s_nop 0
  buffer_load_dwordx4 v59, s[12:15], s80 offen lds
  s_add_u32 s80, s80, 393216
  v_mfma_f32_16x16x32_bf16 v[204:207], v[220:223], v[140:143], v[204:207]
  s_waitcnt vmcnt(12)
  ds_read_b128 v[208:211], v70 offset:0
  ds_read_b128 v[212:215], v71 offset:0
  ds_read_b128 v[216:219], v70 offset:128
  s_waitcnt lgkmcnt(2)
  v_mfma_f32_16x16x32_bf16 v[184:187], v[208:211], v[72:75], 0
  ds_read_b128 v[220:223], v71 offset:128
  v_mfma_f32_16x16x32_bf16 v[188:191], v[208:211], v[76:79], 0
  s_add_u32 m0, s81, 24576
  s_nop 0
  buffer_load_dwordx4 v48, s[12:15], s80 offen lds
  v_mfma_f32_16x16x32_bf16 v[192:195], v[208:211], v[80:83], 0
  s_waitcnt lgkmcnt(2)
  v_mfma_f32_16x16x32_bf16 v[184:187], v[212:215], v[84:87], v[184:187]
  ds_read_b128 v[208:211], v70 offset:256
  v_cvt_pk_bf16_f32 v248, v196, v197
  v_mfma_f32_16x16x32_bf16 v[188:191], v[212:215], v[88:91], v[188:191]
  s_add_u32 m0, s81, 25600
  s_nop 0
  buffer_load_dwordx4 v49, s[12:15], s80 offen lds
  v_mfma_f32_16x16x32_bf16 v[192:195], v[212:215], v[92:95], v[192:195]
  v_cvt_pk_bf16_f32 v249, v198, v199
  s_waitcnt lgkmcnt(2)
  v_mfma_f32_16x16x32_bf16 v[184:187], v[216:219], v[96:99], v[184:187]
  ds_read_b128 v[212:215], v71 offset:256
  v_cvt_pk_bf16_f32 v250, v200, v201
  v_mfma_f32_16x16x32_bf16 v[188:191], v[216:219], v[100:103], v[188:191]
  s_add_u32 m0, s81, 26624
  s_nop 0
  buffer_load_dwordx4 v50, s[12:15], s80 offen lds
  v_mfma_f32_16x16x32_bf16 v[192:195], v[216:219], v[104:107], v[192:195]
  v_cvt_pk_bf16_f32 v251, v202, v203
  s_waitcnt lgkmcnt(2)
  v_mfma_f32_16x16x32_bf16 v[184:187], v[220:223], v[108:111], v[184:187]
  ds_read_b128 v[216:219], v70 offset:768
  v_accvgpr_write_b32 a14, v248
  v_mfma_f32_16x16x32_bf16 v[188:191], v[220:223], v[112:115], v[188:191]
  s_add_u32 m0, s81, 27648
  s_nop 0
  buffer_load_dwordx4 v51, s[12:15], s80 offen lds
  v_mfma_f32_16x16x32_bf16 v[192:195], v[220:223], v[116:119], v[192:195]
  v_accvgpr_write_b32 a15, v249
  s_waitcnt lgkmcnt(2)
  v_mfma_f32_16x16x32_bf16 v[184:187], v[208:211], v[120:123], v[184:187]
  ds_read_b128 v[220:223], v71 offset:768
  v_accvgpr_write_b32 a94, v250
  v_mfma_f32_16x16x32_bf16 v[188:191], v[208:211], v[124:127], v[188:191]
  s_add_u32 m0, s81, 28672
  s_nop 0
  buffer_load_dwordx4 v52, s[12:15], s80 offen lds
  v_mfma_f32_16x16x32_bf16 v[192:195], v[208:211], v[128:131], v[192:195]
  v_accvgpr_write_b32 a95, v251
  s_waitcnt lgkmcnt(2)
  v_mfma_f32_16x16x32_bf16 v[184:187], v[212:215], v[132:135], v[184:187]
  ds_read_b128 v[208:211], v70 offset:896
  s_mov_b64 exec, s[68:69]
  v_cvt_pk_bf16_f32 v150, v204, v205
  v_cvt_pk_bf16_f32 v151, v206, v207
  s_mov_b64 exec, -1
  v_mfma_f32_16x16x32_bf16 v[188:191], v[212:215], v[136:139], v[188:191]
  s_add_u32 m0, s81, 29696
  s_nop 0
  buffer_load_dwordx4 v53, s[12:15], s80 offen lds
  v_mfma_f32_16x16x32_bf16 v[192:195], v[212:215], v[140:143], v[192:195]
  s_waitcnt lgkmcnt(2)
  v_mfma_f32_16x16x32_bf16 v[196:199], v[216:219], v[72:75], 0
  ds_read_b128 v[212:215], v71 offset:896
  v_mfma_f32_16x16x32_bf16 v[200:203], v[216:219], v[76:79], 0
  s_add_u32 m0, s81, 30720
  s_nop 0
  buffer_load_dwordx4 v54, s[12:15], s80 offen lds
  v_mfma_f32_16x16x32_bf16 v[204:207], v[216:219], v[80:83], 0
  s_waitcnt lgkmcnt(2)
  v_mfma_f32_16x16x32_bf16 v[196:199], v[220:223], v[84:87], v[196:199]
  ds_read_b128 v[216:219], v70 offset:1024
  v_cvt_pk_bf16_f32 v248, v184, v185
  v_mfma_f32_16x16x32_bf16 v[200:203], v[220:223], v[88:91], v[200:203]
  s_add_u32 m0, s81, 31744
  s_nop 0
  buffer_load_dwordx4 v55, s[12:15], s80 offen lds
  v_mfma_f32_16x16x32_bf16 v[204:207], v[220:223], v[92:95], v[204:207]
  v_cvt_pk_bf16_f32 v249, v186, v187
  s_waitcnt lgkmcnt(2)
  v_mfma_f32_16x16x32_bf16 v[196:199], v[208:211], v[96:99], v[196:199]
  ds_read_b128 v[220:223], v71 offset:1024
  v_cvt_pk_bf16_f32 v250, v188, v189
  v_mfma_f32_16x16x32_bf16 v[200:203], v[208:211], v[100:103], v[200:203]
  s_add_u32 m0, s81, 32768
  s_nop 0
  buffer_load_dwordx4 v56, s[12:15], s80 offen lds
  v_mfma_f32_16x16x32_bf16 v[204:207], v[208:211], v[104:107], v[204:207]
  v_cvt_pk_bf16_f32 v251, v190, v191
  s_waitcnt lgkmcnt(2)
  v_mfma_f32_16x16x32_bf16 v[196:199], v[212:215], v[108:111], v[196:199]
  v_accvgpr_write_b32 a16, v248
  v_mfma_f32_16x16x32_bf16 v[200:203], v[212:215], v[112:115], v[200:203]
  s_add_u32 m0, s81, 33792
  s_nop 0
  buffer_load_dwordx4 v57, s[12:15], s80 offen lds
  v_mfma_f32_16x16x32_bf16 v[204:207], v[212:215], v[116:119], v[204:207]
  v_accvgpr_write_b32 a17, v249
  s_waitcnt lgkmcnt(1)
  v_mfma_f32_16x16x32_bf16 v[196:199], v[216:219], v[120:123], v[196:199]
  v_accvgpr_write_b32 a96, v250
  v_mfma_f32_16x16x32_bf16 v[200:203], v[216:219], v[124:127], v[200:203]
  s_add_u32 m0, s81, 34816
  s_nop 0
  buffer_load_dwordx4 v58, s[12:15], s80 offen lds
  v_mfma_f32_16x16x32_bf16 v[204:207], v[216:219], v[128:131], v[204:207]
  v_accvgpr_write_b32 a97, v251
  s_waitcnt lgkmcnt(0)
  v_mfma_f32_16x16x32_bf16 v[196:199], v[220:223], v[132:135], v[196:199]
  v_cvt_pk_bf16_f32 v152, v192, v193
  v_cvt_pk_bf16_f32 v153, v194, v195
  v_mfma_f32_16x16x32_bf16 v[200:203], v[220:223], v[136:139], v[200:203]
  s_add_u32 m0, s81, 35840
  s_nop 0
  buffer_load_dwordx4 v59, s[12:15], s80 offen lds
  s_add_u32 s80, s80, 393216
  v_mfma_f32_16x16x32_bf16 v[204:207], v[220:223], v[140:143], v[204:207]
  s_waitcnt vmcnt(12)
  ds_read_b128 v[208:211], v70 offset:12288
  ds_read_b128 v[212:215], v71 offset:12288
  ds_read_b128 v[216:219], v70 offset:12416
  s_waitcnt lgkmcnt(2)
  v_mfma_f32_16x16x32_bf16 v[184:187], v[208:211], v[72:75], 0
  ds_read_b128 v[220:223], v71 offset:12416
  v_mfma_f32_16x16x32_bf16 v[188:191], v[208:211], v[76:79], 0
  s_add_u32 m0, s81, 0
  s_nop 0
  buffer_load_dwordx4 v48, s[12:15], s80 offen lds
  v_mfma_f32_16x16x32_bf16 v[192:195], v[208:211], v[80:83], 0
  s_waitcnt lgkmcnt(2)
  v_mfma_f32_16x16x32_bf16 v[184:187], v[212:215], v[84:87], v[184:187]
  ds_read_b128 v[208:211], v70 offset:12544
  v_cvt_pk_bf16_f32 v248, v196, v197
  v_mfma_f32_16x16x32_bf16 v[188:191], v[212:215], v[88:91], v[188:191]
  s_add_u32 m0, s81, 1024
  s_nop 0
  buffer_load_dwordx4 v49, s[12:15], s80 offen lds
  v_mfma_f32_16x16x32_bf16 v[192:195], v[212:215], v[92:95], v[192:195]
  v_cvt_pk_bf16_f32 v249, v198, v199
  s_waitcnt lgkmcnt(2)
  v_mfma_f32_16x16x32_bf16 v[184:187], v[216:219], v[96:99], v[184:187]
  ds_read_b128 v[212:215], v71 offset:12544
  v_cvt_pk_bf16_f32 v250, v200, v201
  v_mfma_f32_16x16x32_bf16 v[188:191], v[216:219], v[100:103], v[188:191]
  s_add_u32 m0, s81, 2048
  s_nop 0
  buffer_load_dwordx4 v50, s[12:15], s80 offen lds
  v_mfma_f32_16x16x32_bf16 v[192:195], v[216:219], v[104:107], v[192:195]
  v_cvt_pk_bf16_f32 v251, v202, v203
  s_waitcnt lgkmcnt(2)
  v_mfma_f32_16x16x32_bf16 v[184:187], v[220:223], v[108:111], v[184:187]
  ds_read_b128 v[216:219], v70 offset:13056
  v_accvgpr_write_b32 a18, v248
  v_mfma_f32_16x16x32_bf16 v[188:191], v[220:223], v[112:115], v[188:191]
  s_add_u32 m0, s81, 3072
  s_nop 0
  buffer_load_dwordx4 v51, s[12:15], s80 offen lds
  v_mfma_f32_16x16x32_bf16 v[192:195], v[220:223], v[116:119], v[192:195]
  v_accvgpr_write_b32 a19, v249
  s_waitcnt lgkmcnt(2)
  v_mfma_f32_16x16x32_bf16 v[184:187], v[208:211], v[120:123], v[184:187]
  ds_read_b128 v[220:223], v71 offset:13056
  v_accvgpr_write_b32 a98, v250
  v_mfma_f32_16x16x32_bf16 v[188:191], v[208:211], v[124:127], v[188:191]
  s_add_u32 m0, s81, 4096
  s_nop 0
  buffer_load_dwordx4 v52, s[12:15], s80 offen lds
  v_mfma_f32_16x16x32_bf16 v[192:195], v[208:211], v[128:131], v[192:195]
  v_accvgpr_write_b32 a99, v251
  s_waitcnt lgkmcnt(2)
  v_mfma_f32_16x16x32_bf16 v[184:187], v[212:215], v[132:135], v[184:187]
  ds_read_b128 v[208:211], v70 offset:13184
  s_mov_b64 exec, s[68:69]
  v_cvt_pk_bf16_f32 v152, v204, v205
  v_cvt_pk_bf16_f32 v153, v206, v207
  s_mov_b64 exec, -1
  v_mfma_f32_16x16x32_bf16 v[188:191], v[212:215], v[136:139], v[188:191]
  s_add_u32 m0, s81, 5120
  s_nop 0
  buffer_load_dwordx4 v53, s[12:15], s80 offen lds
  v_mfma_f32_16x16x32_bf16 v[192:195], v[212:215], v[140:143], v[192:195]
  s_waitcnt lgkmcnt(2)
  v_mfma_f32_16x16x32_bf16 v[196:199], v[216:219], v[72:75], 0
  ds_read_b128 v[212:215], v71 offset:13184
  v_mfma_f32_16x16x32_bf16 v[200:203], v[216:219], v[76:79], 0
  s_add_u32 m0, s81, 6144
  s_nop 0
  buffer_load_dwordx4 v54, s[12:15], s80 offen lds
  v_mfma_f32_16x16x32_bf16 v[204:207], v[216:219], v[80:83], 0
  s_waitcnt lgkmcnt(2)
  v_mfma_f32_16x16x32_bf16 v[196:199], v[220:223], v[84:87], v[196:199]
  ds_read_b128 v[216:219], v70 offset:13312
  v_cvt_pk_bf16_f32 v248, v184, v185
  v_mfma_f32_16x16x32_bf16 v[200:203], v[220:223], v[88:91], v[200:203]
  s_add_u32 m0, s81, 7168
  s_nop 0
  buffer_load_dwordx4 v55, s[12:15], s80 offen lds
  v_mfma_f32_16x16x32_bf16 v[204:207], v[220:223], v[92:95], v[204:207]
  v_cvt_pk_bf16_f32 v249, v186, v187
  s_waitcnt lgkmcnt(2)
  v_mfma_f32_16x16x32_bf16 v[196:199], v[208:211], v[96:99], v[196:199]
  ds_read_b128 v[220:223], v71 offset:13312
  v_cvt_pk_bf16_f32 v250, v188, v189
  v_mfma_f32_16x16x32_bf16 v[200:203], v[208:211], v[100:103], v[200:203]
  s_add_u32 m0, s81, 8192
  s_nop 0
  buffer_load_dwordx4 v56, s[12:15], s80 offen lds
  v_mfma_f32_16x16x32_bf16 v[204:207], v[208:211], v[104:107], v[204:207]
  v_cvt_pk_bf16_f32 v251, v190, v191
  s_waitcnt lgkmcnt(2)
  v_mfma_f32_16x16x32_bf16 v[196:199], v[212:215], v[108:111], v[196:199]
  v_accvgpr_write_b32 a20, v248
  v_mfma_f32_16x16x32_bf16 v[200:203], v[212:215], v[112:115], v[200:203]
  s_add_u32 m0, s81, 9216
  s_nop 0
  buffer_load_dwordx4 v57, s[12:15], s80 offen lds
  v_mfma_f32_16x16x32_bf16 v[204:207], v[212:215], v[116:119], v[204:207]
  v_accvgpr_write_b32 a21, v249
  s_waitcnt lgkmcnt(1)
  v_mfma_f32_16x16x32_bf16 v[196:199], v[216:219], v[120:123], v[196:199]
  v_accvgpr_write_b32 a100, v250
  v_mfma_f32_16x16x32_bf16 v[200:203], v[216:219], v[124:127], v[200:203]
  s_add_u32 m0, s81, 10240
  s_nop 0
  buffer_load_dwordx4 v58, s[12:15], s80 offen lds
  v_mfma_f32_16x16x32_bf16 v[204:207], v[216:219], v[128:131], v[204:207]
  v_accvgpr_write_b32 a101, v251
  s_waitcnt lgkmcnt(0)
  v_mfma_f32_16x16x32_bf16 v[196:199], v[220:223], v[132:135], v[196:199]
  v_cvt_pk_bf16_f32 v154, v192, v193
  v_cvt_pk_bf16_f32 v155, v194, v195
  v_mfma_f32_16x16x32_bf16 v[200:203], v[220:223], v[136:139], v[200:203]
  s_add_u32 m0, s81, 11264
  s_nop 0
  buffer_load_dwordx4 v59, s[12:15], s80 offen lds
  s_add_u32 s80, s80, 393216
  v_mfma_f32_16x16x32_bf16 v[204:207], v[220:223], v[140:143], v[204:207]
  s_add_u32 s21, s79, 0
  buffer_load_dwordx4 a[172:175], v63, s[28:31], s21 offen
  s_add_u32 s21, s79, 0
  buffer_load_dwordx4 a[176:179], v64, s[28:31], s21 offen
  s_add_u32 s21, s79, 0
  buffer_load_dwordx4 a[180:183], v65, s[28:31], s21 offen
  s_waitcnt vmcnt(15)
  ds_read_b128 v[208:211], v70 offset:24576
  ds_read_b128 v[212:215], v71 offset:24576
  ds_read_b128 v[216:219], v70 offset:24704
  s_waitcnt lgkmcnt(2)
  v_mfma_f32_16x16x32_bf16 v[184:187], v[208:211], v[72:75], 0
  ds_read_b128 v[220:223], v71 offset:24704
  v_mfma_f32_16x16x32_bf16 v[188:191], v[208:211], v[76:79], 0
  s_add_u32 m0, s81, 12288
  s_nop 0
  buffer_load_dwordx4 v48, s[12:15], s80 offen lds
  v_mfma_f32_16x16x32_bf16 v[192:195], v[208:211], v[80:83], 0
  s_waitcnt lgkmcnt(2)
  v_mfma_f32_16x16x32_bf16 v[184:187], v[212:215], v[84:87], v[184:187]
  ds_read_b128 v[208:211], v70 offset:24832
  v_cvt_pk_bf16_f32 v248, v196, v197
  v_mfma_f32_16x16x32_bf16 v[188:191], v[212:215], v[88:91], v[188:191]
  s_add_u32 m0, s81, 13312
  s_nop 0
  buffer_load_dwordx4 v49, s[12:15], s80 offen lds
  v_mfma_f32_16x16x32_bf16 v[192:195], v[212:215], v[92:95], v[192:195]
  v_cvt_pk_bf16_f32 v249, v198, v199
  s_waitcnt lgkmcnt(2)
  v_mfma_f32_16x16x32_bf16 v[184:187], v[216:219], v[96:99], v[184:187]
  ds_read_b128 v[212:215], v71 offset:24832
  v_cvt_pk_bf16_f32 v250, v200, v201
  v_mfma_f32_16x16x32_bf16 v[188:191], v[216:219], v[100:103], v[188:191]
  s_add_u32 m0, s81, 14336
  s_nop 0
  buffer_load_dwordx4 v50, s[12:15], s80 offen lds
  v_mfma_f32_16x16x32_bf16 v[192:195], v[216:219], v[104:107], v[192:195]
  v_cvt_pk_bf16_f32 v251, v202, v203
  s_waitcnt lgkmcnt(2)
  v_mfma_f32_16x16x32_bf16 v[184:187], v[220:223], v[108:111], v[184:187]
  ds_read_b128 v[216:219], v70 offset:25344
  v_accvgpr_write_b32 a22, v248
  v_mfma_f32_16x16x32_bf16 v[188:191], v[220:223], v[112:115], v[188:191]
  s_add_u32 m0, s81, 15360
  s_nop 0
  buffer_load_dwordx4 v51, s[12:15], s80 offen lds
  v_mfma_f32_16x16x32_bf16 v[192:195], v[220:223], v[116:119], v[192:195]
  v_accvgpr_write_b32 a23, v249
  s_waitcnt lgkmcnt(2)
  v_mfma_f32_16x16x32_bf16 v[184:187], v[208:211], v[120:123], v[184:187]
  ds_read_b128 v[220:223], v71 offset:25344
  v_accvgpr_write_b32 a102, v250
  v_mfma_f32_16x16x32_bf16 v[188:191], v[208:211], v[124:127], v[188:191]
  s_add_u32 m0, s81, 16384
  s_nop 0
  buffer_load_dwordx4 v52, s[12:15], s80 offen lds
  v_mfma_f32_16x16x32_bf16 v[192:195], v[208:211], v[128:131], v[192:195]
  v_accvgpr_write_b32 a103, v251
  s_waitcnt lgkmcnt(2)
  v_mfma_f32_16x16x32_bf16 v[184:187], v[212:215], v[132:135], v[184:187]
  ds_read_b128 v[208:211], v70 offset:25472
  s_mov_b64 exec, s[68:69]
  v_cvt_pk_bf16_f32 v154, v204, v205
  v_cvt_pk_bf16_f32 v155, v206, v207
  s_mov_b64 exec, -1
  v_mfma_f32_16x16x32_bf16 v[188:191], v[212:215], v[136:139], v[188:191]
  s_add_u32 m0, s81, 17408
  s_nop 0
  buffer_load_dwordx4 v53, s[12:15], s80 offen lds
  v_mfma_f32_16x16x32_bf16 v[192:195], v[212:215], v[140:143], v[192:195]
  s_waitcnt lgkmcnt(2)
  v_mfma_f32_16x16x32_bf16 v[196:199], v[216:219], v[72:75], 0
  ds_read_b128 v[212:215], v71 offset:25472
  v_mfma_f32_16x16x32_bf16 v[200:203], v[216:219], v[76:79], 0
  s_add_u32 m0, s81, 18432
  s_nop 0
  buffer_load_dwordx4 v54, s[12:15], s80 offen lds
  v_mfma_f32_16x16x32_bf16 v[204:207], v[216:219], v[80:83], 0
  s_waitcnt lgkmcnt(2)
  v_mfma_f32_16x16x32_bf16 v[196:199], v[220:223], v[84:87], v[196:199]
  ds_read_b128 v[216:219], v70 offset:25600
  v_cvt_pk_bf16_f32 v248, v184, v185
  v_mfma_f32_16x16x32_bf16 v[200:203], v[220:223], v[88:91], v[200:203]
  s_add_u32 m0, s81, 19456
  s_nop 0
  buffer_load_dwordx4 v55, s[12:15], s80 offen lds
  v_mfma_f32_16x16x32_bf16 v[204:207], v[220:223], v[92:95], v[204:207]
  v_cvt_pk_bf16_f32 v249, v186, v187
  s_waitcnt lgkmcnt(2)
  v_mfma_f32_16x16x32_bf16 v[196:199], v[208:211], v[96:99], v[196:199]
  ds_read_b128 v[220:223], v71 offset:25600
  v_cvt_pk_bf16_f32 v250, v188, v189
  v_mfma_f32_16x16x32_bf16 v[200:203], v[208:211], v[100:103], v[200:203]
  s_add_u32 m0, s81, 20480
  s_nop 0
  buffer_load_dwordx4 v56, s[12:15], s80 offen lds
  v_mfma_f32_16x16x32_bf16 v[204:207], v[208:211], v[104:107], v[204:207]
  v_cvt_pk_bf16_f32 v251, v190, v191
  s_waitcnt lgkmcnt(2)
  v_mfma_f32_16x16x32_bf16 v[196:199], v[212:215], v[108:111], v[196:199]
  v_accvgpr_write_b32 a24, v248
  v_mfma_f32_16x16x32_bf16 v[200:203], v[212:215], v[112:115], v[200:203]
  s_add_u32 m0, s81, 21504
  s_nop 0
  buffer_load_dwordx4 v57, s[12:15], s80 offen lds
  v_mfma_f32_16x16x32_bf16 v[204:207], v[212:215], v[116:119], v[204:207]
  v_accvgpr_write_b32 a25, v249
  s_waitcnt lgkmcnt(1)
  v_mfma_f32_16x16x32_bf16 v[196:199], v[216:219], v[120:123], v[196:199]
  v_accvgpr_write_b32 a104, v250
  v_mfma_f32_16x16x32_bf16 v[200:203], v[216:219], v[124:127], v[200:203]
  s_add_u32 m0, s81, 22528
  s_nop 0
  buffer_load_dwordx4 v58, s[12:15], s80 offen lds
  v_mfma_f32_16x16x32_bf16 v[204:207], v[216:219], v[128:131], v[204:207]
  v_accvgpr_write_b32 a105, v251
  s_waitcnt lgkmcnt(0)
  v_mfma_f32_16x16x32_bf16 v[196:199], v[220:223], v[132:135], v[196:199]
  v_cvt_pk_bf16_f32 v156, v192, v193
  v_cvt_pk_bf16_f32 v157, v194, v195
  v_mfma_f32_16x16x32_bf16 v[200:203], v[220:223], v[136:139], v[200:203]
  s_add_u32 m0, s81, 23552
  s_nop 0
  buffer_load_dwordx4 v59, s[12:15], s80 offen lds
  s_add_u32 s80, s80, 393216
  v_mfma_f32_16x16x32_bf16 v[204:207], v[220:223], v[140:143], v[204:207]
  s_add_u32 s21, s79, 393216
  buffer_load_dwordx4 a[196:199], v63, s[28:31], s21 offen
  s_add_u32 s21, s79, 393216
  buffer_load_dwordx4 a[200:203], v64, s[28:31], s21 offen
  s_add_u32 s21, s79, 393216
  buffer_load_dwordx4 a[204:207], v65, s[28:31], s21 offen
  s_waitcnt vmcnt(18)
  ds_read_b128 v[208:211], v70 offset:0
  ds_read_b128 v[212:215], v71 offset:0
  ds_read_b128 v[216:219], v70 offset:128
  s_waitcnt lgkmcnt(2)
  v_mfma_f32_16x16x32_bf16 v[184:187], v[208:211], v[72:75], 0
  ds_read_b128 v[220:223], v71 offset:128
  v_mfma_f32_16x16x32_bf16 v[188:191], v[208:211], v[76:79], 0
  s_add_u32 m0, s81, 24576
  s_nop 0
  buffer_load_dwordx4 v48, s[12:15], s80 offen lds
  v_mfma_f32_16x16x32_bf16 v[192:195], v[208:211], v[80:83], 0
  s_waitcnt lgkmcnt(2)
  v_mfma_f32_16x16x32_bf16 v[184:187], v[212:215], v[84:87], v[184:187]
  ds_read_b128 v[208:211], v70 offset:256
  v_cvt_pk_bf16_f32 v248, v196, v197
  v_mfma_f32_16x16x32_bf16 v[188:191], v[212:215], v[88:91], v[188:191]
  s_add_u32 m0, s81, 25600
  s_nop 0
  buffer_load_dwordx4 v49, s[12:15], s80 offen lds
  v_mfma_f32_16x16x32_bf16 v[192:195], v[212:215], v[92:95], v[192:195]
  v_cvt_pk_bf16_f32 v249, v198, v199
  s_waitcnt lgkmcnt(2)
  v_mfma_f32_16x16x32_bf16 v[184:187], v[216:219], v[96:99], v[184:187]
  ds_read_b128 v[212:215], v71 offset:256
  v_cvt_pk_bf16_f32 v250, v200, v201
  v_mfma_f32_16x16x32_bf16 v[188:191], v[216:219], v[100:103], v[188:191]
  s_add_u32 m0, s81, 26624
  s_nop 0
  buffer_load_dwordx4 v50, s[12:15], s80 offen lds
  v_mfma_f32_16x16x32_bf16 v[192:195], v[216:219], v[104:107], v[192:195]
  v_cvt_pk_bf16_f32 v251, v202, v203
  s_waitcnt lgkmcnt(2)
  v_mfma_f32_16x16x32_bf16 v[184:187], v[220:223], v[108:111], v[184:187]
  ds_read_b128 v[216:219], v70 offset:768
  v_accvgpr_write_b32 a26, v248
  v_mfma_f32_16x16x32_bf16 v[188:191], v[220:223], v[112:115], v[188:191]
  s_add_u32 m0, s81, 27648
  s_nop 0
  buffer_load_dwordx4 v51, s[12:15], s80 offen lds
  v_mfma_f32_16x16x32_bf16 v[192:195], v[220:223], v[116:119], v[192:195]
  v_accvgpr_write_b32 a27, v249
  s_waitcnt lgkmcnt(2)
  v_mfma_f32_16x16x32_bf16 v[184:187], v[208:211], v[120:123], v[184:187]
  ds_read_b128 v[220:223], v71 offset:768
  v_accvgpr_write_b32 a106, v250
  v_mfma_f32_16x16x32_bf16 v[188:191], v[208:211], v[124:127], v[188:191]
  s_add_u32 m0, s81, 28672
  s_nop 0
  buffer_load_dwordx4 v52, s[12:15], s80 offen lds
  v_mfma_f32_16x16x32_bf16 v[192:195], v[208:211], v[128:131], v[192:195]
  v_accvgpr_write_b32 a107, v251
  s_waitcnt lgkmcnt(2)
  v_mfma_f32_16x16x32_bf16 v[184:187], v[212:215], v[132:135], v[184:187]
  ds_read_b128 v[208:211], v70 offset:896
  s_mov_b64 exec, s[68:69]
  v_cvt_pk_bf16_f32 v156, v204, v205
  v_cvt_pk_bf16_f32 v157, v206, v207
  s_mov_b64 exec, -1
  v_mfma_f32_16x16x32_bf16 v[188:191], v[212:215], v[136:139], v[188:191]
  s_add_u32 m0, s81, 29696
  s_nop 0
  buffer_load_dwordx4 v53, s[12:15], s80 offen lds
  v_mfma_f32_16x16x32_bf16 v[192:195], v[212:215], v[140:143], v[192:195]
  s_waitcnt lgkmcnt(2)
  v_mfma_f32_16x16x32_bf16 v[196:199], v[216:219], v[72:75], 0
  ds_read_b128 v[212:215], v71 offset:896
  v_mfma_f32_16x16x32_bf16 v[200:203], v[216:219], v[76:79], 0
  s_add_u32 m0, s81, 30720
  s_nop 0
  buffer_load_dwordx4 v54, s[12:15], s80 offen lds
  v_mfma_f32_16x16x32_bf16 v[204:207], v[216:219], v[80:83], 0
  s_waitcnt lgkmcnt(2)
  v_mfma_f32_16x16x32_bf16 v[196:199], v[220:223], v[84:87], v[196:199]
  ds_read_b128 v[216:219], v70 offset:1024
  v_cvt_pk_bf16_f32 v248, v184, v185
  v_mfma_f32_16x16x32_bf16 v[200:203], v[220:223], v[88:91], v[200:203]
  s_add_u32 m0, s81, 31744
  s_nop 0
  buffer_load_dwordx4 v55, s[12:15], s80 offen lds
  v_mfma_f32_16x16x32_bf16 v[204:207], v[220:223], v[92:95], v[204:207]
  v_cvt_pk_bf16_f32 v249, v186, v187
  s_waitcnt lgkmcnt(2)
  v_mfma_f32_16x16x32_bf16 v[196:199], v[208:211], v[96:99], v[196:199]
  ds_read_b128 v[220:223], v71 offset:1024
  v_cvt_pk_bf16_f32 v250, v188, v189
  v_mfma_f32_16x16x32_bf16 v[200:203], v[208:211], v[100:103], v[200:203]
  s_add_u32 m0, s81, 32768
  s_nop 0
  buffer_load_dwordx4 v56, s[12:15], s80 offen lds
  v_mfma_f32_16x16x32_bf16 v[204:207], v[208:211], v[104:107], v[204:207]
  v_cvt_pk_bf16_f32 v251, v190, v191
  s_waitcnt lgkmcnt(2)
  v_mfma_f32_16x16x32_bf16 v[196:199], v[212:215], v[108:111], v[196:199]
  v_accvgpr_write_b32 a28, v248
  v_mfma_f32_16x16x32_bf16 v[200:203], v[212:215], v[112:115], v[200:203]
  s_add_u32 m0, s81, 33792
  s_nop 0
  buffer_load_dwordx4 v57, s[12:15], s80 offen lds
  v_mfma_f32_16x16x32_bf16 v[204:207], v[212:215], v[116:119], v[204:207]
  v_accvgpr_write_b32 a29, v249
  s_waitcnt lgkmcnt(1)
  v_mfma_f32_16x16x32_bf16 v[196:199], v[216:219], v[120:123], v[196:199]
  v_accvgpr_write_b32 a108, v250
  v_mfma_f32_16x16x32_bf16 v[200:203], v[216:219], v[124:127], v[200:203]
  s_add_u32 m0, s81, 34816
  s_nop 0
  buffer_load_dwordx4 v58, s[12:15], s80 offen lds
  v_mfma_f32_16x16x32_bf16 v[204:207], v[216:219], v[128:131], v[204:207]
  v_accvgpr_write_b32 a109, v251
  s_waitcnt lgkmcnt(0)
  v_mfma_f32_16x16x32_bf16 v[196:199], v[220:223], v[132:135], v[196:199]
  v_cvt_pk_bf16_f32 v158, v192, v193
  v_cvt_pk_bf16_f32 v159, v194, v195
  v_mfma_f32_16x16x32_bf16 v[200:203], v[220:223], v[136:139], v[200:203]
  s_add_u32 m0, s81, 35840
  s_nop 0
  buffer_load_dwordx4 v59, s[12:15], s80 offen lds
  s_add_u32 s80, s80, 393216
  v_mfma_f32_16x16x32_bf16 v[204:207], v[220:223], v[140:143], v[204:207]
  s_add_u32 s21, s79, 786432
  buffer_load_dwordx4 a[220:223], v63, s[28:31], s21 offen
  s_add_u32 s21, s79, 786432
  buffer_load_dwordx4 a[224:227], v64, s[28:31], s21 offen
  s_add_u32 s21, s79, 786432
  buffer_load_dwordx4 a[228:231], v65, s[28:31], s21 offen
  s_waitcnt vmcnt(18)
  ds_read_b128 v[208:211], v70 offset:12288
  ds_read_b128 v[212:215], v71 offset:12288
  ds_read_b128 v[216:219], v70 offset:12416
  s_waitcnt lgkmcnt(2)
  v_mfma_f32_16x16x32_bf16 v[184:187], v[208:211], v[72:75], 0
  ds_read_b128 v[220:223], v71 offset:12416
  v_mfma_f32_16x16x32_bf16 v[188:191], v[208:211], v[76:79], 0
  s_add_u32 m0, s81, 0
  s_nop 0
  buffer_load_dwordx4 v48, s[12:15], s80 offen lds
  v_mfma_f32_16x16x32_bf16 v[192:195], v[208:211], v[80:83], 0
  s_waitcnt lgkmcnt(2)
  v_mfma_f32_16x16x32_bf16 v[184:187], v[212:215], v[84:87], v[184:187]
  ds_read_b128 v[208:211], v70 offset:12544
  v_cvt_pk_bf16_f32 v248, v196, v197
  v_mfma_f32_16x16x32_bf16 v[188:191], v[212:215], v[88:91], v[188:191]
  s_add_u32 m0, s81, 1024
  s_nop 0
  buffer_load_dwordx4 v49, s[12:15], s80 offen lds
  v_mfma_f32_16x16x32_bf16 v[192:195], v[212:215], v[92:95], v[192:195]
  v_cvt_pk_bf16_f32 v249, v198, v199
  s_waitcnt lgkmcnt(2)
  v_mfma_f32_16x16x32_bf16 v[184:187], v[216:219], v[96:99], v[184:187]
  ds_read_b128 v[212:215], v71 offset:12544
  v_cvt_pk_bf16_f32 v250, v200, v201
  v_mfma_f32_16x16x32_bf16 v[188:191], v[216:219], v[100:103], v[188:191]
  s_add_u32 m0, s81, 2048
  s_nop 0
  buffer_load_dwordx4 v50, s[12:15], s80 offen lds
  v_mfma_f32_16x16x32_bf16 v[192:195], v[216:219], v[104:107], v[192:195]
  v_cvt_pk_bf16_f32 v251, v202, v203
  s_waitcnt lgkmcnt(2)
  v_mfma_f32_16x16x32_bf16 v[184:187], v[220:223], v[108:111], v[184:187]
  ds_read_b128 v[216:219], v70 offset:13056
  v_accvgpr_write_b32 a30, v248
  v_mfma_f32_16x16x32_bf16 v[188:191], v[220:223], v[112:115], v[188:191]
  s_add_u32 m0, s81, 3072
  s_nop 0
  buffer_load_dwordx4 v51, s[12:15], s80 offen lds
  v_mfma_f32_16x16x32_bf16 v[192:195], v[220:223], v[116:119], v[192:195]
  v_accvgpr_write_b32 a31, v249
  s_waitcnt lgkmcnt(2)
  v_mfma_f32_16x16x32_bf16 v[184:187], v[208:211], v[120:123], v[184:187]
  ds_read_b128 v[220:223], v71 offset:13056
  v_accvgpr_write_b32 a110, v250
  v_mfma_f32_16x16x32_bf16 v[188:191], v[208:211], v[124:127], v[188:191]
  s_add_u32 m0, s81, 4096
  s_nop 0
  buffer_load_dwordx4 v52, s[12:15], s80 offen lds
  v_mfma_f32_16x16x32_bf16 v[192:195], v[208:211], v[128:131], v[192:195]
  v_accvgpr_write_b32 a111, v251
  s_waitcnt lgkmcnt(2)
  v_mfma_f32_16x16x32_bf16 v[184:187], v[212:215], v[132:135], v[184:187]
  ds_read_b128 v[208:211], v70 offset:13184
  s_mov_b64 exec, s[68:69]
  v_cvt_pk_bf16_f32 v158, v204, v205
  v_cvt_pk_bf16_f32 v159, v206, v207
  s_mov_b64 exec, -1
  v_mfma_f32_16x16x32_bf16 v[188:191], v[212:215], v[136:139], v[188:191]
  s_add_u32 m0, s81, 5120
  s_nop 0
  buffer_load_dwordx4 v53, s[12:15], s80 offen lds
  v_mfma_f32_16x16x32_bf16 v[192:195], v[212:215], v[140:143], v[192:195]
  s_waitcnt lgkmcnt(2)
  v_mfma_f32_16x16x32_bf16 v[196:199], v[216:219], v[72:75], 0
  ds_read_b128 v[212:215], v71 offset:13184
  v_mfma_f32_16x16x32_bf16 v[200:203], v[216:219], v[76:79], 0
  s_add_u32 m0, s81, 6144
  s_nop 0
  buffer_load_dwordx4 v54, s[12:15], s80 offen lds
  v_mfma_f32_16x16x32_bf16 v[204:207], v[216:219], v[80:83], 0
  s_waitcnt lgkmcnt(2)
  v_mfma_f32_16x16x32_bf16 v[196:199], v[220:223], v[84:87], v[196:199]
  ds_read_b128 v[216:219], v70 offset:13312
  v_cvt_pk_bf16_f32 v248, v184, v185
  v_mfma_f32_16x16x32_bf16 v[200:203], v[220:223], v[88:91], v[200:203]
  s_add_u32 m0, s81, 7168
  s_nop 0
  buffer_load_dwordx4 v55, s[12:15], s80 offen lds
  v_mfma_f32_16x16x32_bf16 v[204:207], v[220:223], v[92:95], v[204:207]
  v_cvt_pk_bf16_f32 v249, v186, v187
  s_waitcnt lgkmcnt(2)
  v_mfma_f32_16x16x32_bf16 v[196:199], v[208:211], v[96:99], v[196:199]
  ds_read_b128 v[220:223], v71 offset:13312
  v_cvt_pk_bf16_f32 v250, v188, v189
  v_mfma_f32_16x16x32_bf16 v[200:203], v[208:211], v[100:103], v[200:203]
  s_add_u32 m0, s81, 8192
  s_nop 0
  buffer_load_dwordx4 v56, s[12:15], s80 offen lds
  v_mfma_f32_16x16x32_bf16 v[204:207], v[208:211], v[104:107], v[204:207]
  v_cvt_pk_bf16_f32 v251, v190, v191
  s_waitcnt lgkmcnt(2)
  v_mfma_f32_16x16x32_bf16 v[196:199], v[212:215], v[108:111], v[196:199]
  v_accvgpr_write_b32 a32, v248
  v_mfma_f32_16x16x32_bf16 v[200:203], v[212:215], v[112:115], v[200:203]
  s_add_u32 m0, s81, 9216
  s_nop 0
  buffer_load_dwordx4 v57, s[12:15], s80 offen lds
  v_mfma_f32_16x16x32_bf16 v[204:207], v[212:215], v[116:119], v[204:207]
  v_accvgpr_write_b32 a33, v249
  s_waitcnt lgkmcnt(1)
  v_mfma_f32_16x16x32_bf16 v[196:199], v[216:219], v[120:123], v[196:199]
  v_accvgpr_write_b32 a112, v250
  v_mfma_f32_16x16x32_bf16 v[200:203], v[216:219], v[124:127], v[200:203]
  s_add_u32 m0, s81, 10240
  s_nop 0
  buffer_load_dwordx4 v58, s[12:15], s80 offen lds
  v_mfma_f32_16x16x32_bf16 v[204:207], v[216:219], v[128:131], v[204:207]
  v_accvgpr_write_b32 a113, v251
  s_waitcnt lgkmcnt(0)
  v_mfma_f32_16x16x32_bf16 v[196:199], v[220:223], v[132:135], v[196:199]
  v_cvt_pk_bf16_f32 v160, v192, v193
  v_cvt_pk_bf16_f32 v161, v194, v195
  v_mfma_f32_16x16x32_bf16 v[200:203], v[220:223], v[136:139], v[200:203]
  s_add_u32 m0, s81, 11264
  s_nop 0
  buffer_load_dwordx4 v59, s[12:15], s80 offen lds
  s_add_u32 s80, s80, 393216
  v_mfma_f32_16x16x32_bf16 v[204:207], v[220:223], v[140:143], v[204:207]
  s_add_u32 s21, s79, 1179648
  buffer_load_dwordx4 a[244:247], v63, s[28:31], s21 offen
  s_add_u32 s21, s79, 1179648
  buffer_load_dwordx4 a[248:251], v64, s[28:31], s21 offen
  s_add_u32 s21, s79, 1179648
  buffer_load_dwordx4 a[252:255], v65, s[28:31], s21 offen
  s_waitcnt vmcnt(18)
  ds_read_b128 v[208:211], v70 offset:24576
  ds_read_b128 v[212:215], v71 offset:24576
  ds_read_b128 v[216:219], v70 offset:24704
  s_waitcnt lgkmcnt(2)
  v_mfma_f32_16x16x32_bf16 v[184:187], v[208:211], v[72:75], 0
  ds_read_b128 v[220:223], v71 offset:24704
  v_mfma_f32_16x16x32_bf16 v[188:191], v[208:211], v[76:79], 0
  s_add_u32 m0, s81, 12288
  s_nop 0
  buffer_load_dwordx4 v48, s[12:15], s80 offen lds
  v_mfma_f32_16x16x32_bf16 v[192:195], v[208:211], v[80:83], 0
  s_waitcnt lgkmcnt(2)
  v_mfma_f32_16x16x32_bf16 v[184:187], v[212:215], v[84:87], v[184:187]
  ds_read_b128 v[208:211], v70 offset:24832
  v_cvt_pk_bf16_f32 v248, v196, v197
  v_mfma_f32_16x16x32_bf16 v[188:191], v[212:215], v[88:91], v[188:191]
  s_add_u32 m0, s81, 13312
  s_nop 0
  buffer_load_dwordx4 v49, s[12:15], s80 offen lds
  v_mfma_f32_16x16x32_bf16 v[192:195], v[212:215], v[92:95], v[192:195]
  v_cvt_pk_bf16_f32 v249, v198, v199
  s_waitcnt lgkmcnt(2)
  v_mfma_f32_16x16x32_bf16 v[184:187], v[216:219], v[96:99], v[184:187]
  ds_read_b128 v[212:215], v71 offset:24832
  v_cvt_pk_bf16_f32 v250, v200, v201
  v_mfma_f32_16x16x32_bf16 v[188:191], v[216:219], v[100:103], v[188:191]
  s_add_u32 m0, s81, 14336
  s_nop 0
  buffer_load_dwordx4 v50, s[12:15], s80 offen lds
  v_mfma_f32_16x16x32_bf16 v[192:195], v[216:219], v[104:107], v[192:195]
  v_cvt_pk_bf16_f32 v251, v202, v203
  s_waitcnt lgkmcnt(2)
  v_mfma_f32_16x16x32_bf16 v[184:187], v[220:223], v[108:111], v[184:187]
  ds_read_b128 v[216:219], v70 offset:25344
  v_accvgpr_write_b32 a34, v248
  v_mfma_f32_16x16x32_bf16 v[188:191], v[220:223], v[112:115], v[188:191]
  s_add_u32 m0, s81, 15360
  s_nop 0
  buffer_load_dwordx4 v51, s[12:15], s80 offen lds
  v_mfma_f32_16x16x32_bf16 v[192:195], v[220:223], v[116:119], v[192:195]
  v_accvgpr_write_b32 a35, v249
  s_waitcnt lgkmcnt(2)
  v_mfma_f32_16x16x32_bf16 v[184:187], v[208:211], v[120:123], v[184:187]
  ds_read_b128 v[220:223], v71 offset:25344
  v_accvgpr_write_b32 a114, v250
  v_mfma_f32_16x16x32_bf16 v[188:191], v[208:211], v[124:127], v[188:191]
  s_add_u32 m0, s81, 16384
  s_nop 0
  buffer_load_dwordx4 v52, s[12:15], s80 offen lds
  v_mfma_f32_16x16x32_bf16 v[192:195], v[208:211], v[128:131], v[192:195]
  v_accvgpr_write_b32 a115, v251
  s_waitcnt lgkmcnt(2)
  v_mfma_f32_16x16x32_bf16 v[184:187], v[212:215], v[132:135], v[184:187]
  ds_read_b128 v[208:211], v70 offset:25472
  s_mov_b64 exec, s[68:69]
  v_cvt_pk_bf16_f32 v160, v204, v205
  v_cvt_pk_bf16_f32 v161, v206, v207
  s_mov_b64 exec, -1
  v_mfma_f32_16x16x32_bf16 v[188:191], v[212:215], v[136:139], v[188:191]
  s_add_u32 m0, s81, 17408
  s_nop 0
  buffer_load_dwordx4 v53, s[12:15], s80 offen lds
  v_mfma_f32_16x16x32_bf16 v[192:195], v[212:215], v[140:143], v[192:195]
  s_waitcnt lgkmcnt(2)
  v_mfma_f32_16x16x32_bf16 v[196:199], v[216:219], v[72:75], 0
  ds_read_b128 v[212:215], v71 offset:25472
  v_mfma_f32_16x16x32_bf16 v[200:203], v[216:219], v[76:79], 0
  s_add_u32 m0, s81, 18432
  s_nop 0
  buffer_load_dwordx4 v54, s[12:15], s80 offen lds
  v_mfma_f32_16x16x32_bf16 v[204:207], v[216:219], v[80:83], 0
  s_waitcnt lgkmcnt(2)
  v_mfma_f32_16x16x32_bf16 v[196:199], v[220:223], v[84:87], v[196:199]
  ds_read_b128 v[216:219], v70 offset:25600
  v_cvt_pk_bf16_f32 v248, v184, v185
  v_mfma_f32_16x16x32_bf16 v[200:203], v[220:223], v[88:91], v[200:203]
  s_add_u32 m0, s81, 19456
  s_nop 0
  buffer_load_dwordx4 v55, s[12:15], s80 offen lds
  v_mfma_f32_16x16x32_bf16 v[204:207], v[220:223], v[92:95], v[204:207]
  v_cvt_pk_bf16_f32 v249, v186, v187
  s_waitcnt lgkmcnt(2)
  v_mfma_f32_16x16x32_bf16 v[196:199], v[208:211], v[96:99], v[196:199]
  ds_read_b128 v[220:223], v71 offset:25600
  v_cvt_pk_bf16_f32 v250, v188, v189
  v_mfma_f32_16x16x32_bf16 v[200:203], v[208:211], v[100:103], v[200:203]
  s_add_u32 m0, s81, 20480
  s_nop 0
  buffer_load_dwordx4 v56, s[12:15], s80 offen lds
  v_mfma_f32_16x16x32_bf16 v[204:207], v[208:211], v[104:107], v[204:207]
  v_cvt_pk_bf16_f32 v251, v190, v191
  s_waitcnt lgkmcnt(2)
  v_mfma_f32_16x16x32_bf16 v[196:199], v[212:215], v[108:111], v[196:199]
  v_accvgpr_write_b32 a36, v248
  v_mfma_f32_16x16x32_bf16 v[200:203], v[212:215], v[112:115], v[200:203]
  s_add_u32 m0, s81, 21504
  s_nop 0
  buffer_load_dwordx4 v57, s[12:15], s80 offen lds
  v_mfma_f32_16x16x32_bf16 v[204:207], v[212:215], v[116:119], v[204:207]
  v_accvgpr_write_b32 a37, v249
  s_waitcnt lgkmcnt(1)
  v_mfma_f32_16x16x32_bf16 v[196:199], v[216:219], v[120:123], v[196:199]
  v_accvgpr_write_b32 a116, v250
  v_mfma_f32_16x16x32_bf16 v[200:203], v[216:219], v[124:127], v[200:203]
  s_add_u32 m0, s81, 22528
  s_nop 0
  buffer_load_dwordx4 v58, s[12:15], s80 offen lds
  v_mfma_f32_16x16x32_bf16 v[204:207], v[216:219], v[128:131], v[204:207]
  v_accvgpr_write_b32 a117, v251
  s_waitcnt lgkmcnt(0)
  v_mfma_f32_16x16x32_bf16 v[196:199], v[220:223], v[132:135], v[196:199]
  v_cvt_pk_bf16_f32 v162, v192, v193
  v_cvt_pk_bf16_f32 v163, v194, v195
  v_mfma_f32_16x16x32_bf16 v[200:203], v[220:223], v[136:139], v[200:203]
  s_add_u32 m0, s81, 23552
  s_nop 0
  buffer_load_dwordx4 v59, s[12:15], s80 offen lds
  s_add_u32 s80, s80, 393216
  v_mfma_f32_16x16x32_bf16 v[204:207], v[220:223], v[140:143], v[204:207]
  s_add_u32 s21, s79, 1572864
  buffer_load_dwordx4 v[236:239], v63, s[28:31], s21 offen
  s_add_u32 s21, s79, 1572864
  buffer_load_dwordx4 v[240:243], v64, s[28:31], s21 offen
  s_add_u32 s21, s79, 1572864
  buffer_load_dwordx4 v[244:247], v65, s[28:31], s21 offen
  s_waitcnt vmcnt(18)
  ds_read_b128 v[208:211], v70 offset:0
  ds_read_b128 v[212:215], v71 offset:0
  ds_read_b128 v[216:219], v70 offset:128
  s_waitcnt lgkmcnt(2)
  v_mfma_f32_16x16x32_bf16 v[184:187], v[208:211], v[72:75], 0
  ds_read_b128 v[220:223], v71 offset:128
  v_mfma_f32_16x16x32_bf16 v[188:191], v[208:211], v[76:79], 0
  s_add_u32 m0, s81, 24576
  s_nop 0
  buffer_load_dwordx4 v48, s[12:15], s80 offen lds
  ds_write_b64 v69, v[144:145] offset:36864
  v_mfma_f32_16x16x32_bf16 v[192:195], v[208:211], v[80:83], 0
  s_waitcnt lgkmcnt(3)
  v_mfma_f32_16x16x32_bf16 v[184:187], v[212:215], v[84:87], v[184:187]
  ds_read_b128 v[208:211], v70 offset:256
  v_cvt_pk_bf16_f32 v248, v196, v197
  v_mfma_f32_16x16x32_bf16 v[188:191], v[212:215], v[88:91], v[188:191]
  s_add_u32 m0, s81, 25600
  s_nop 0
  buffer_load_dwordx4 v49, s[12:15], s80 offen lds
  ds_write_b64 v69, v[146:147] offset:37376
  v_mfma_f32_16x16x32_bf16 v[192:195], v[212:215], v[92:95], v[192:195]
  v_cvt_pk_bf16_f32 v249, v198, v199
  s_waitcnt lgkmcnt(4)
  v_mfma_f32_16x16x32_bf16 v[184:187], v[216:219], v[96:99], v[184:187]
  ds_read_b128 v[212:215], v71 offset:256
  v_cvt_pk_bf16_f32 v250, v200, v201
  v_mfma_f32_16x16x32_bf16 v[188:191], v[216:219], v[100:103], v[188:191]
  s_add_u32 m0, s81, 26624
  s_nop 0
  buffer_load_dwordx4 v50, s[12:15], s80 offen lds
  ds_write_b64 v69, v[148:149] offset:37888
  v_mfma_f32_16x16x32_bf16 v[192:195], v[216:219], v[104:107], v[192:195]
  v_cvt_pk_bf16_f32 v251, v202, v203
  s_waitcnt lgkmcnt(5)
  v_mfma_f32_16x16x32_bf16 v[184:187], v[220:223], v[108:111], v[184:187]
  ds_read_b128 v[216:219], v70 offset:768
  v_accvgpr_write_b32 a38, v248
  v_mfma_f32_16x16x32_bf16 v[188:191], v[220:223], v[112:115], v[188:191]
  s_add_u32 m0, s81, 27648
  s_nop 0
  buffer_load_dwordx4 v51, s[12:15], s80 offen lds
  ds_write_b64 v69, v[150:151] offset:38400
  v_mfma_f32_16x16x32_bf16 v[192:195], v[220:223], v[116:119], v[192:195]
  v_accvgpr_write_b32 a39, v249
  s_waitcnt lgkmcnt(5)
  v_mfma_f32_16x16x32_bf16 v[184:187], v[208:211], v[120:123], v[184:187]
  ds_read_b128 v[220:223], v71 offset:768
  v_accvgpr_write_b32 a118, v250
  v_mfma_f32_16x16x32_bf16 v[188:191], v[208:211], v[124:127], v[188:191]
  s_add_u32 m0, s81, 28672
  s_nop 0
  buffer_load_dwordx4 v52, s[12:15], s80 offen lds
  ds_write_b64 v69, v[152:153] offset:38912
  v_mfma_f32_16x16x32_bf16 v[192:195], v[208:211], v[128:131], v[192:195]
  v_accvgpr_write_b32 a119, v251
  s_waitcnt lgkmcnt(5)
  v_mfma_f32_16x16x32_bf16 v[184:187], v[212:215], v[132:135], v[184:187]
  ds_read_b128 v[208:211], v70 offset:896
  s_mov_b64 exec, s[68:69]
  v_cvt_pk_bf16_f32 v162, v204, v205
  v_cvt_pk_bf16_f32 v163, v206, v207
  s_mov_b64 exec, -1
  v_mfma_f32_16x16x32_bf16 v[188:191], v[212:215], v[136:139], v[188:191]
  s_add_u32 m0, s81, 29696
  s_nop 0
  buffer_load_dwordx4 v53, s[12:15], s80 offen lds
  ds_write_b64 v69, v[154:155] offset:39424
  v_mfma_f32_16x16x32_bf16 v[192:195], v[212:215], v[140:143], v[192:195]
  s_waitcnt lgkmcnt(5)
  v_mfma_f32_16x16x32_bf16 v[196:199], v[216:219], v[72:75], 0
  ds_read_b128 v[212:215], v71 offset:896
  v_mfma_f32_16x16x32_bf16 v[200:203], v[216:219], v[76:79], 0
  s_add_u32 m0, s81, 30720
  s_nop 0
  buffer_load_dwordx4 v54, s[12:15], s80 offen lds
  ds_write_b64 v69, v[156:157] offset:39936
  v_mfma_f32_16x16x32_bf16 v[204:207], v[216:219], v[80:83], 0
  s_waitcnt lgkmcnt(5)
  v_mfma_f32_16x16x32_bf16 v[196:199], v[220:223], v[84:87], v[196:199]
  ds_read_b128 v[216:219], v70 offset:1024
  v_cvt_pk_bf16_f32 v248, v184, v185
  v_mfma_f32_16x16x32_bf16 v[200:203], v[220:223], v[88:91], v[200:203]
  s_add_u32 m0, s81, 31744
  s_nop 0
  buffer_load_dwordx4 v55, s[12:15], s80 offen lds
  ds_write_b64 v69, v[158:159] offset:40448
  v_mfma_f32_16x16x32_bf16 v[204:207], v[220:223], v[92:95], v[204:207]
  v_cvt_pk_bf16_f32 v249, v186, v187
  s_waitcnt lgkmcnt(5)
  v_mfma_f32_16x16x32_bf16 v[196:199], v[208:211], v[96:99], v[196:199]
  ds_read_b128 v[220:223], v71 offset:1024
  v_cvt_pk_bf16_f32 v250, v188, v189
  v_mfma_f32_16x16x32_bf16 v[200:203], v[208:211], v[100:103], v[200:203]
  s_add_u32 m0, s81, 32768
  s_nop 0
  buffer_load_dwordx4 v56, s[12:15], s80 offen lds
  v_mfma_f32_16x16x32_bf16 v[204:207], v[208:211], v[104:107], v[204:207]
  v_cvt_pk_bf16_f32 v251, v190, v191
  s_waitcnt lgkmcnt(4)
  v_mfma_f32_16x16x32_bf16 v[196:199], v[212:215], v[108:111], v[196:199]
  v_accvgpr_write_b32 a40, v248
  v_mfma_f32_16x16x32_bf16 v[200:203], v[212:215], v[112:115], v[200:203]
  s_add_u32 m0, s81, 33792
  s_nop 0
  buffer_load_dwordx4 v57, s[12:15], s80 offen lds
  v_mfma_f32_16x16x32_bf16 v[204:207], v[212:215], v[116:119], v[204:207]
  v_accvgpr_write_b32 a41, v249
  s_waitcnt lgkmcnt(2)
  v_mfma_f32_16x16x32_bf16 v[196:199], v[216:219], v[120:123], v[196:199]
  v_accvgpr_write_b32 a120, v250
  v_mfma_f32_16x16x32_bf16 v[200:203], v[216:219], v[124:127], v[200:203]
  s_add_u32 m0, s81, 34816
  s_nop 0
  buffer_load_dwordx4 v58, s[12:15], s80 offen lds
  v_mfma_f32_16x16x32_bf16 v[204:207], v[216:219], v[128:131], v[204:207]
  v_accvgpr_write_b32 a121, v251
  s_waitcnt lgkmcnt(0)
  v_mfma_f32_16x16x32_bf16 v[196:199], v[220:223], v[132:135], v[196:199]
  v_cvt_pk_bf16_f32 v164, v192, v193
  v_cvt_pk_bf16_f32 v165, v194, v195
  v_mfma_f32_16x16x32_bf16 v[200:203], v[220:223], v[136:139], v[200:203]
  s_add_u32 m0, s81, 35840
  s_nop 0
  buffer_load_dwordx4 v59, s[12:15], s80 offen lds
  s_add_u32 s80, s80, 393216
  v_mfma_f32_16x16x32_bf16 v[204:207], v[220:223], v[140:143], v[204:207]
  s_add_u32 s21, s79, 0
  buffer_load_dwordx4 a[160:163], v63, s[24:27], s21 offen
  s_add_u32 s21, s79, 0
  buffer_load_dwordx4 a[164:167], v64, s[24:27], s21 offen
  s_add_u32 s21, s79, 0
  buffer_load_dwordx4 a[168:171], v65, s[24:27], s21 offen
  s_waitcnt vmcnt(18)
  ds_read_b128 v[208:211], v70 offset:12288
  ds_read_b128 v[212:215], v71 offset:12288
  ds_read_b128 v[216:219], v70 offset:12416
  s_waitcnt lgkmcnt(2)
  v_mfma_f32_16x16x32_bf16 v[184:187], v[208:211], v[72:75], 0
  ds_read_b128 v[220:223], v71 offset:12416
  v_mfma_f32_16x16x32_bf16 v[188:191], v[208:211], v[76:79], 0
  s_add_u32 m0, s81, 0
  s_nop 0
  buffer_load_dwordx4 v48, s[12:15], s80 offen lds
  v_mfma_f32_16x16x32_bf16 v[192:195], v[208:211], v[80:83], 0
  s_waitcnt lgkmcnt(2)
  v_mfma_f32_16x16x32_bf16 v[184:187], v[212:215], v[84:87], v[184:187]
  ds_read_b128 v[208:211], v70 offset:12544
  v_cvt_pk_bf16_f32 v248, v196, v197
  v_mfma_f32_16x16x32_bf16 v[188:191], v[212:215], v[88:91], v[188:191]
  s_add_u32 m0, s81, 1024
  s_nop 0
  buffer_load_dwordx4 v49, s[12:15], s80 offen lds
  v_mfma_f32_16x16x32_bf16 v[192:195], v[212:215], v[92:95], v[192:195]
  v_cvt_pk_bf16_f32 v249, v198, v199
  s_waitcnt lgkmcnt(2)
  v_mfma_f32_16x16x32_bf16 v[184:187], v[216:219], v[96:99], v[184:187]
  ds_read_b128 v[212:215], v71 offset:12544
  v_cvt_pk_bf16_f32 v250, v200, v201
  v_mfma_f32_16x16x32_bf16 v[188:191], v[216:219], v[100:103], v[188:191]
  s_add_u32 m0, s81, 2048
  s_nop 0
  buffer_load_dwordx4 v50, s[12:15], s80 offen lds
  v_mfma_f32_16x16x32_bf16 v[192:195], v[216:219], v[104:107], v[192:195]
  v_cvt_pk_bf16_f32 v251, v202, v203
  s_waitcnt lgkmcnt(2)
  v_mfma_f32_16x16x32_bf16 v[184:187], v[220:223], v[108:111], v[184:187]
  ds_read_b128 v[216:219], v70 offset:13056
  v_accvgpr_write_b32 a42, v248
  v_mfma_f32_16x16x32_bf16 v[188:191], v[220:223], v[112:115], v[188:191]
  s_add_u32 m0, s81, 3072
  s_nop 0
  buffer_load_dwordx4 v51, s[12:15], s80 offen lds
  v_mfma_f32_16x16x32_bf16 v[192:195], v[220:223], v[116:119], v[192:195]
  v_accvgpr_write_b32 a43, v249
  s_waitcnt lgkmcnt(2)
  v_mfma_f32_16x16x32_bf16 v[184:187], v[208:211], v[120:123], v[184:187]
  ds_read_b128 v[220:223], v71 offset:13056
  v_accvgpr_write_b32 a122, v250
  v_mfma_f32_16x16x32_bf16 v[188:191], v[208:211], v[124:127], v[188:191]
  s_add_u32 m0, s81, 4096
  s_nop 0
  buffer_load_dwordx4 v52, s[12:15], s80 offen lds
  v_mfma_f32_16x16x32_bf16 v[192:195], v[208:211], v[128:131], v[192:195]
  v_accvgpr_write_b32 a123, v251
  s_waitcnt lgkmcnt(2)
  v_mfma_f32_16x16x32_bf16 v[184:187], v[212:215], v[132:135], v[184:187]
  ds_read_b128 v[208:211], v70 offset:13184
  s_mov_b64 exec, s[68:69]
  v_cvt_pk_bf16_f32 v164, v204, v205
  v_cvt_pk_bf16_f32 v165, v206, v207
  s_mov_b64 exec, -1
  v_mfma_f32_16x16x32_bf16 v[188:191], v[212:215], v[136:139], v[188:191]
  s_add_u32 m0, s81, 5120
  s_nop 0
  buffer_load_dwordx4 v53, s[12:15], s80 offen lds
  v_mfma_f32_16x16x32_bf16 v[192:195], v[212:215], v[140:143], v[192:195]
  s_waitcnt lgkmcnt(2)
  v_mfma_f32_16x16x32_bf16 v[196:199], v[216:219], v[72:75], 0
  ds_read_b128 v[212:215], v71 offset:13184
  v_mfma_f32_16x16x32_bf16 v[200:203], v[216:219], v[76:79], 0
  s_add_u32 m0, s81, 6144
  s_nop 0
  buffer_load_dwordx4 v54, s[12:15], s80 offen lds
  v_mfma_f32_16x16x32_bf16 v[204:207], v[216:219], v[80:83], 0
  s_waitcnt lgkmcnt(2)
  v_mfma_f32_16x16x32_bf16 v[196:199], v[220:223], v[84:87], v[196:199]
  ds_read_b128 v[216:219], v70 offset:13312
  v_cvt_pk_bf16_f32 v248, v184, v185
  v_mfma_f32_16x16x32_bf16 v[200:203], v[220:223], v[88:91], v[200:203]
  s_add_u32 m0, s81, 7168
  s_nop 0
  buffer_load_dwordx4 v55, s[12:15], s80 offen lds
  v_mfma_f32_16x16x32_bf16 v[204:207], v[220:223], v[92:95], v[204:207]
  v_cvt_pk_bf16_f32 v249, v186, v187
  s_waitcnt lgkmcnt(2)
  v_mfma_f32_16x16x32_bf16 v[196:199], v[208:211], v[96:99], v[196:199]
  ds_read_b128 v[220:223], v71 offset:13312
  v_cvt_pk_bf16_f32 v250, v188, v189
  v_mfma_f32_16x16x32_bf16 v[200:203], v[208:211], v[100:103], v[200:203]
  s_add_u32 m0, s81, 8192
  s_nop 0
  buffer_load_dwordx4 v56, s[12:15], s80 offen lds
  v_mfma_f32_16x16x32_bf16 v[204:207], v[208:211], v[104:107], v[204:207]
  v_cvt_pk_bf16_f32 v251, v190, v191
  s_waitcnt lgkmcnt(2)
  v_mfma_f32_16x16x32_bf16 v[196:199], v[212:215], v[108:111], v[196:199]
  v_accvgpr_write_b32 a44, v248
  v_mfma_f32_16x16x32_bf16 v[200:203], v[212:215], v[112:115], v[200:203]
  s_add_u32 m0, s81, 9216
  s_nop 0
  buffer_load_dwordx4 v57, s[12:15], s80 offen lds
  v_mfma_f32_16x16x32_bf16 v[204:207], v[212:215], v[116:119], v[204:207]
  v_accvgpr_write_b32 a45, v249
  s_waitcnt lgkmcnt(1)
  v_mfma_f32_16x16x32_bf16 v[196:199], v[216:219], v[120:123], v[196:199]
  v_accvgpr_write_b32 a124, v250
  v_mfma_f32_16x16x32_bf16 v[200:203], v[216:219], v[124:127], v[200:203]
  s_add_u32 m0, s81, 10240
  s_nop 0
  buffer_load_dwordx4 v58, s[12:15], s80 offen lds
  v_mfma_f32_16x16x32_bf16 v[204:207], v[216:219], v[128:131], v[204:207]
  v_accvgpr_write_b32 a125, v251
  s_waitcnt lgkmcnt(0)
  v_mfma_f32_16x16x32_bf16 v[196:199], v[220:223], v[132:135], v[196:199]
  v_cvt_pk_bf16_f32 v166, v192, v193
  v_cvt_pk_bf16_f32 v167, v194, v195
  v_mfma_f32_16x16x32_bf16 v[200:203], v[220:223], v[136:139], v[200:203]
  s_add_u32 m0, s81, 11264
  s_nop 0
  buffer_load_dwordx4 v59, s[12:15], s80 offen lds
  s_add_u32 s80, s80, 393216
  v_mfma_f32_16x16x32_bf16 v[204:207], v[220:223], v[140:143], v[204:207]
  s_add_u32 s21, s79, 393216
  buffer_load_dwordx4 a[184:187], v63, s[24:27], s21 offen
  s_add_u32 s21, s79, 393216
  buffer_load_dwordx4 a[188:191], v64, s[24:27], s21 offen
  s_add_u32 s21, s79, 393216
  buffer_load_dwordx4 a[192:195], v65, s[24:27], s21 offen
  s_waitcnt vmcnt(18)
  ds_read_b128 v[208:211], v70 offset:24576
  ds_read_b128 v[212:215], v71 offset:24576
  ds_read_b128 v[216:219], v70 offset:24704
  s_waitcnt lgkmcnt(2)
  v_mfma_f32_16x16x32_bf16 v[184:187], v[208:211], v[72:75], 0
  ds_read_b128 v[220:223], v71 offset:24704
  v_mfma_f32_16x16x32_bf16 v[188:191], v[208:211], v[76:79], 0
  s_add_u32 m0, s81, 12288
  s_nop 0
  buffer_load_dwordx4 v48, s[12:15], s80 offen lds
  v_mfma_f32_16x16x32_bf16 v[192:195], v[208:211], v[80:83], 0
  s_waitcnt lgkmcnt(2)
  v_mfma_f32_16x16x32_bf16 v[184:187], v[212:215], v[84:87], v[184:187]
  ds_read_b128 v[208:211], v70 offset:24832
  v_cvt_pk_bf16_f32 v248, v196, v197
  v_mfma_f32_16x16x32_bf16 v[188:191], v[212:215], v[88:91], v[188:191]
  s_add_u32 m0, s81, 13312
  s_nop 0
  buffer_load_dwordx4 v49, s[12:15], s80 offen lds
  v_mfma_f32_16x16x32_bf16 v[192:195], v[212:215], v[92:95], v[192:195]
  v_cvt_pk_bf16_f32 v249, v198, v199
  s_waitcnt lgkmcnt(2)
  v_mfma_f32_16x16x32_bf16 v[184:187], v[216:219], v[96:99], v[184:187]
  ds_read_b128 v[212:215], v71 offset:24832
  v_cvt_pk_bf16_f32 v250, v200, v201
  v_mfma_f32_16x16x32_bf16 v[188:191], v[216:219], v[100:103], v[188:191]
  s_add_u32 m0, s81, 14336
  s_nop 0
  buffer_load_dwordx4 v50, s[12:15], s80 offen lds
  v_mfma_f32_16x16x32_bf16 v[192:195], v[216:219], v[104:107], v[192:195]
  v_cvt_pk_bf16_f32 v251, v202, v203
  s_waitcnt lgkmcnt(2)
  v_mfma_f32_16x16x32_bf16 v[184:187], v[220:223], v[108:111], v[184:187]
  ds_read_b128 v[216:219], v70 offset:25344
  v_accvgpr_write_b32 a46, v248
  v_mfma_f32_16x16x32_bf16 v[188:191], v[220:223], v[112:115], v[188:191]
  s_add_u32 m0, s81, 15360
  s_nop 0
  buffer_load_dwordx4 v51, s[12:15], s80 offen lds
  v_mfma_f32_16x16x32_bf16 v[192:195], v[220:223], v[116:119], v[192:195]
  v_accvgpr_write_b32 a47, v249
  s_waitcnt lgkmcnt(2)
  v_mfma_f32_16x16x32_bf16 v[184:187], v[208:211], v[120:123], v[184:187]
  ds_read_b128 v[220:223], v71 offset:25344
  v_accvgpr_write_b32 a126, v250
  v_mfma_f32_16x16x32_bf16 v[188:191], v[208:211], v[124:127], v[188:191]
  s_add_u32 m0, s81, 16384
  s_nop 0
  buffer_load_dwordx4 v52, s[12:15], s80 offen lds
  v_mfma_f32_16x16x32_bf16 v[192:195], v[208:211], v[128:131], v[192:195]
  v_accvgpr_write_b32 a127, v251
  s_waitcnt lgkmcnt(2)
  v_mfma_f32_16x16x32_bf16 v[184:187], v[212:215], v[132:135], v[184:187]
  ds_read_b128 v[208:211], v70 offset:25472
  s_mov_b64 exec, s[68:69]
  v_cvt_pk_bf16_f32 v166, v204, v205
  v_cvt_pk_bf16_f32 v167, v206, v207
  s_mov_b64 exec, -1
  v_mfma_f32_16x16x32_bf16 v[188:191], v[212:215], v[136:139], v[188:191]
  s_add_u32 m0, s81, 17408
  s_nop 0
  buffer_load_dwordx4 v53, s[12:15], s80 offen lds
  v_mfma_f32_16x16x32_bf16 v[192:195], v[212:215], v[140:143], v[192:195]
  s_waitcnt lgkmcnt(2)
  v_mfma_f32_16x16x32_bf16 v[196:199], v[216:219], v[72:75], 0
  ds_read_b128 v[212:215], v71 offset:25472
  v_mfma_f32_16x16x32_bf16 v[200:203], v[216:219], v[76:79], 0
  s_add_u32 m0, s81, 18432
  s_nop 0
  buffer_load_dwordx4 v54, s[12:15], s80 offen lds
  v_mfma_f32_16x16x32_bf16 v[204:207], v[216:219], v[80:83], 0
  s_waitcnt lgkmcnt(2)
  v_mfma_f32_16x16x32_bf16 v[196:199], v[220:223], v[84:87], v[196:199]
  ds_read_b128 v[216:219], v70 offset:25600
  v_cvt_pk_bf16_f32 v248, v184, v185
  v_mfma_f32_16x16x32_bf16 v[200:203], v[220:223], v[88:91], v[200:203]
  s_add_u32 m0, s81, 19456
  s_nop 0
  buffer_load_dwordx4 v55, s[12:15], s80 offen lds
  v_mfma_f32_16x16x32_bf16 v[204:207], v[220:223], v[92:95], v[204:207]
  v_cvt_pk_bf16_f32 v249, v186, v187
  s_waitcnt lgkmcnt(2)
  v_mfma_f32_16x16x32_bf16 v[196:199], v[208:211], v[96:99], v[196:199]
  ds_read_b128 v[220:223], v71 offset:25600
  v_cvt_pk_bf16_f32 v250, v188, v189
  v_mfma_f32_16x16x32_bf16 v[200:203], v[208:211], v[100:103], v[200:203]
  s_add_u32 m0, s81, 20480
  s_nop 0
  buffer_load_dwordx4 v56, s[12:15], s80 offen lds
  v_mfma_f32_16x16x32_bf16 v[204:207], v[208:211], v[104:107], v[204:207]
  v_cvt_pk_bf16_f32 v251, v190, v191
  s_waitcnt lgkmcnt(2)
  v_mfma_f32_16x16x32_bf16 v[196:199], v[212:215], v[108:111], v[196:199]
  v_accvgpr_write_b32 a48, v248
  v_mfma_f32_16x16x32_bf16 v[200:203], v[212:215], v[112:115], v[200:203]
  s_add_u32 m0, s81, 21504
  s_nop 0
  buffer_load_dwordx4 v57, s[12:15], s80 offen lds
  v_mfma_f32_16x16x32_bf16 v[204:207], v[212:215], v[116:119], v[204:207]
  v_accvgpr_write_b32 a49, v249
  s_waitcnt lgkmcnt(1)
  v_mfma_f32_16x16x32_bf16 v[196:199], v[216:219], v[120:123], v[196:199]
  v_accvgpr_write_b32 a128, v250
  v_mfma_f32_16x16x32_bf16 v[200:203], v[216:219], v[124:127], v[200:203]
  s_add_u32 m0, s81, 22528
  s_nop 0
  buffer_load_dwordx4 v58, s[12:15], s80 offen lds
  v_mfma_f32_16x16x32_bf16 v[204:207], v[216:219], v[128:131], v[204:207]
  v_accvgpr_write_b32 a129, v251
  s_waitcnt lgkmcnt(0)
  v_mfma_f32_16x16x32_bf16 v[196:199], v[220:223], v[132:135], v[196:199]
  v_cvt_pk_bf16_f32 v168, v192, v193
  v_cvt_pk_bf16_f32 v169, v194, v195
  v_mfma_f32_16x16x32_bf16 v[200:203], v[220:223], v[136:139], v[200:203]
  s_add_u32 m0, s81, 23552
  s_nop 0
  buffer_load_dwordx4 v59, s[12:15], s80 offen lds
  s_add_u32 s80, s80, 393216
  v_mfma_f32_16x16x32_bf16 v[204:207], v[220:223], v[140:143], v[204:207]
  s_add_u32 s21, s79, 786432
  buffer_load_dwordx4 a[208:211], v63, s[24:27], s21 offen
  s_add_u32 s21, s79, 786432
  buffer_load_dwordx4 a[212:215], v64, s[24:27], s21 offen
  s_add_u32 s21, s79, 786432
  buffer_load_dwordx4 a[216:219], v65, s[24:27], s21 offen
  s_waitcnt vmcnt(18)
  buffer_load_dword v66, v67, s[32:35], 0 offen sc1
  ds_read_b128 v[208:211], v70 offset:0
  ds_read_b128 v[212:215], v71 offset:0
  ds_read_b128 v[216:219], v70 offset:128
  s_waitcnt lgkmcnt(2)
  v_mfma_f32_16x16x32_bf16 v[184:187], v[208:211], v[72:75], 0
  ds_read_b128 v[220:223], v71 offset:128
  v_mfma_f32_16x16x32_bf16 v[188:191], v[208:211], v[76:79], 0
  s_add_u32 m0, s81, 24576
  s_nop 0
  buffer_load_dwordx4 v48, s[12:15], s80 offen lds
  v_mfma_f32_16x16x32_bf16 v[192:195], v[208:211], v[80:83], 0
  s_waitcnt lgkmcnt(2)
  v_mfma_f32_16x16x32_bf16 v[184:187], v[212:215], v[84:87], v[184:187]
  ds_read_b128 v[208:211], v70 offset:256
  v_cvt_pk_bf16_f32 v248, v196, v197
  v_mfma_f32_16x16x32_bf16 v[188:191], v[212:215], v[88:91], v[188:191]
  s_add_u32 m0, s81, 25600
  s_nop 0
  buffer_load_dwordx4 v49, s[12:15], s80 offen lds
  v_mfma_f32_16x16x32_bf16 v[192:195], v[212:215], v[92:95], v[192:195]
  v_cvt_pk_bf16_f32 v249, v198, v199
  s_waitcnt lgkmcnt(2)
  v_mfma_f32_16x16x32_bf16 v[184:187], v[216:219], v[96:99], v[184:187]
  ds_read_b128 v[212:215], v71 offset:256
  v_cvt_pk_bf16_f32 v250, v200, v201
  v_mfma_f32_16x16x32_bf16 v[188:191], v[216:219], v[100:103], v[188:191]
  s_add_u32 m0, s81, 26624
  s_nop 0
  buffer_load_dwordx4 v50, s[12:15], s80 offen lds
  v_mfma_f32_16x16x32_bf16 v[192:195], v[216:219], v[104:107], v[192:195]
  v_cvt_pk_bf16_f32 v251, v202, v203
  s_waitcnt lgkmcnt(2)
  v_mfma_f32_16x16x32_bf16 v[184:187], v[220:223], v[108:111], v[184:187]
  ds_read_b128 v[216:219], v70 offset:768
  v_accvgpr_write_b32 a50, v248
  v_mfma_f32_16x16x32_bf16 v[188:191], v[220:223], v[112:115], v[188:191]
  s_add_u32 m0, s81, 27648
  s_nop 0
  buffer_load_dwordx4 v51, s[12:15], s80 offen lds
  v_mfma_f32_16x16x32_bf16 v[192:195], v[220:223], v[116:119], v[192:195]
  v_accvgpr_write_b32 a51, v249
  s_waitcnt lgkmcnt(2)
  v_mfma_f32_16x16x32_bf16 v[184:187], v[208:211], v[120:123], v[184:187]
  ds_read_b128 v[220:223], v71 offset:768
  v_accvgpr_write_b32 a130, v250
  v_mfma_f32_16x16x32_bf16 v[188:191], v[208:211], v[124:127], v[188:191]
  s_add_u32 m0, s81, 28672
  s_nop 0
  buffer_load_dwordx4 v52, s[12:15], s80 offen lds
  v_mfma_f32_16x16x32_bf16 v[192:195], v[208:211], v[128:131], v[192:195]
  v_accvgpr_write_b32 a131, v251
  s_waitcnt lgkmcnt(2)
  v_mfma_f32_16x16x32_bf16 v[184:187], v[212:215], v[132:135], v[184:187]
  ds_read_b128 v[208:211], v70 offset:896
  s_mov_b64 exec, s[68:69]
  v_cvt_pk_bf16_f32 v168, v204, v205
  v_cvt_pk_bf16_f32 v169, v206, v207
  s_mov_b64 exec, -1
  v_mfma_f32_16x16x32_bf16 v[188:191], v[212:215], v[136:139], v[188:191]
  s_add_u32 m0, s81, 29696
  s_nop 0
  buffer_load_dwordx4 v53, s[12:15], s80 offen lds
  v_mfma_f32_16x16x32_bf16 v[192:195], v[212:215], v[140:143], v[192:195]
  s_waitcnt lgkmcnt(2)
  v_mfma_f32_16x16x32_bf16 v[196:199], v[216:219], v[72:75], 0
  ds_read_b128 v[212:215], v71 offset:896
  v_mfma_f32_16x16x32_bf16 v[200:203], v[216:219], v[76:79], 0
  s_add_u32 m0, s81, 30720
  s_nop 0
  buffer_load_dwordx4 v54, s[12:15], s80 offen lds
  v_mfma_f32_16x16x32_bf16 v[204:207], v[216:219], v[80:83], 0
  s_waitcnt lgkmcnt(2)
  v_mfma_f32_16x16x32_bf16 v[196:199], v[220:223], v[84:87], v[196:199]
  ds_read_b128 v[216:219], v70 offset:1024
  v_cvt_pk_bf16_f32 v248, v184, v185
  v_mfma_f32_16x16x32_bf16 v[200:203], v[220:223], v[88:91], v[200:203]
  s_add_u32 m0, s81, 31744
  s_nop 0
  buffer_load_dwordx4 v55, s[12:15], s80 offen lds
  v_mfma_f32_16x16x32_bf16 v[204:207], v[220:223], v[92:95], v[204:207]
  v_cvt_pk_bf16_f32 v249, v186, v187
  s_waitcnt lgkmcnt(2)
  v_mfma_f32_16x16x32_bf16 v[196:199], v[208:211], v[96:99], v[196:199]
  ds_read_b128 v[220:223], v71 offset:1024
  v_cvt_pk_bf16_f32 v250, v188, v189
  v_mfma_f32_16x16x32_bf16 v[200:203], v[208:211], v[100:103], v[200:203]
  s_add_u32 m0, s81, 32768
  s_nop 0
  buffer_load_dwordx4 v56, s[12:15], s80 offen lds
  v_mfma_f32_16x16x32_bf16 v[204:207], v[208:211], v[104:107], v[204:207]
  v_cvt_pk_bf16_f32 v251, v190, v191
  s_waitcnt lgkmcnt(2)
  v_mfma_f32_16x16x32_bf16 v[196:199], v[212:215], v[108:111], v[196:199]
  v_accvgpr_write_b32 a52, v248
  v_mfma_f32_16x16x32_bf16 v[200:203], v[212:215], v[112:115], v[200:203]
  s_add_u32 m0, s81, 33792
  s_nop 0
  buffer_load_dwordx4 v57, s[12:15], s80 offen lds
  v_mfma_f32_16x16x32_bf16 v[204:207], v[212:215], v[116:119], v[204:207]
  v_accvgpr_write_b32 a53, v249
  s_waitcnt lgkmcnt(1)
  v_mfma_f32_16x16x32_bf16 v[196:199], v[216:219], v[120:123], v[196:199]
  v_accvgpr_write_b32 a132, v250
  v_mfma_f32_16x16x32_bf16 v[200:203], v[216:219], v[124:127], v[200:203]
  s_add_u32 m0, s81, 34816
  s_nop 0
  buffer_load_dwordx4 v58, s[12:15], s80 offen lds
  v_mfma_f32_16x16x32_bf16 v[204:207], v[216:219], v[128:131], v[204:207]
  v_accvgpr_write_b32 a133, v251
  s_waitcnt lgkmcnt(0)
  v_mfma_f32_16x16x32_bf16 v[196:199], v[220:223], v[132:135], v[196:199]
  v_cvt_pk_bf16_f32 v170, v192, v193
  v_cvt_pk_bf16_f32 v171, v194, v195
  v_mfma_f32_16x16x32_bf16 v[200:203], v[220:223], v[136:139], v[200:203]
  s_add_u32 m0, s81, 35840
  s_nop 0
  buffer_load_dwordx4 v59, s[12:15], s80 offen lds
  s_add_u32 s80, s80, 393216
  v_mfma_f32_16x16x32_bf16 v[204:207], v[220:223], v[140:143], v[204:207]
  s_add_u32 s21, s79, 1179648
  buffer_load_dwordx4 a[232:235], v63, s[24:27], s21 offen
  s_add_u32 s21, s79, 1179648
  buffer_load_dwordx4 a[236:239], v64, s[24:27], s21 offen
  s_add_u32 s21, s79, 1179648
  buffer_load_dwordx4 a[240:243], v65, s[24:27], s21 offen
  s_waitcnt vmcnt(19)
  ds_read_b128 v[208:211], v70 offset:12288
  ds_read_b128 v[212:215], v71 offset:12288
  ds_read_b128 v[216:219], v70 offset:12416
  s_waitcnt lgkmcnt(2)
  v_mfma_f32_16x16x32_bf16 v[184:187], v[208:211], v[72:75], 0
  ds_read_b128 v[220:223], v71 offset:12416
  v_mfma_f32_16x16x32_bf16 v[188:191], v[208:211], v[76:79], 0
  s_add_u32 m0, s81, 0
  s_nop 0
  buffer_load_dwordx4 v48, s[12:15], s80 offen lds
  v_mfma_f32_16x16x32_bf16 v[192:195], v[208:211], v[80:83], 0
  s_waitcnt lgkmcnt(2)
  v_mfma_f32_16x16x32_bf16 v[184:187], v[212:215], v[84:87], v[184:187]
  ds_read_b128 v[208:211], v70 offset:12544
  v_cvt_pk_bf16_f32 v248, v196, v197
  v_mfma_f32_16x16x32_bf16 v[188:191], v[212:215], v[88:91], v[188:191]
  s_add_u32 m0, s81, 1024
  s_nop 0
  buffer_load_dwordx4 v49, s[12:15], s80 offen lds
  v_mfma_f32_16x16x32_bf16 v[192:195], v[212:215], v[92:95], v[192:195]
  v_cvt_pk_bf16_f32 v249, v198, v199
  s_waitcnt lgkmcnt(2)
  v_mfma_f32_16x16x32_bf16 v[184:187], v[216:219], v[96:99], v[184:187]
  ds_read_b128 v[212:215], v71 offset:12544
  v_cvt_pk_bf16_f32 v250, v200, v201
  v_mfma_f32_16x16x32_bf16 v[188:191], v[216:219], v[100:103], v[188:191]
  s_add_u32 m0, s81, 2048
  s_nop 0
  buffer_load_dwordx4 v50, s[12:15], s80 offen lds
  v_mfma_f32_16x16x32_bf16 v[192:195], v[216:219], v[104:107], v[192:195]
  v_cvt_pk_bf16_f32 v251, v202, v203
  s_waitcnt lgkmcnt(2)
  v_mfma_f32_16x16x32_bf16 v[184:187], v[220:223], v[108:111], v[184:187]
  ds_read_b128 v[216:219], v70 offset:13056
  v_accvgpr_write_b32 a54, v248
  v_mfma_f32_16x16x32_bf16 v[188:191], v[220:223], v[112:115], v[188:191]
  s_add_u32 m0, s81, 3072
  s_nop 0
  buffer_load_dwordx4 v51, s[12:15], s80 offen lds
  v_mfma_f32_16x16x32_bf16 v[192:195], v[220:223], v[116:119], v[192:195]
  v_accvgpr_write_b32 a55, v249
  s_waitcnt lgkmcnt(2)
  v_mfma_f32_16x16x32_bf16 v[184:187], v[208:211], v[120:123], v[184:187]
  ds_read_b128 v[220:223], v71 offset:13056
  v_accvgpr_write_b32 a134, v250
  v_mfma_f32_16x16x32_bf16 v[188:191], v[208:211], v[124:127], v[188:191]
  s_add_u32 m0, s81, 4096
  s_nop 0
  buffer_load_dwordx4 v52, s[12:15], s80 offen lds
  v_mfma_f32_16x16x32_bf16 v[192:195], v[208:211], v[128:131], v[192:195]
  v_accvgpr_write_b32 a135, v251
  s_waitcnt lgkmcnt(2)
  v_mfma_f32_16x16x32_bf16 v[184:187], v[212:215], v[132:135], v[184:187]
  ds_read_b128 v[208:211], v70 offset:13184
  s_mov_b64 exec, s[68:69]
  v_cvt_pk_bf16_f32 v170, v204, v205
  v_cvt_pk_bf16_f32 v171, v206, v207
  s_mov_b64 exec, -1
  v_mfma_f32_16x16x32_bf16 v[188:191], v[212:215], v[136:139], v[188:191]
  s_add_u32 m0, s81, 5120
  s_nop 0
  buffer_load_dwordx4 v53, s[12:15], s80 offen lds
  v_mfma_f32_16x16x32_bf16 v[192:195], v[212:215], v[140:143], v[192:195]
  s_waitcnt lgkmcnt(2)
  v_mfma_f32_16x16x32_bf16 v[196:199], v[216:219], v[72:75], 0
  ds_read_b128 v[212:215], v71 offset:13184
  v_mfma_f32_16x16x32_bf16 v[200:203], v[216:219], v[76:79], 0
  s_add_u32 m0, s81, 6144
  s_nop 0
  buffer_load_dwordx4 v54, s[12:15], s80 offen lds
  v_mfma_f32_16x16x32_bf16 v[204:207], v[216:219], v[80:83], 0
  s_waitcnt lgkmcnt(2)
  v_mfma_f32_16x16x32_bf16 v[196:199], v[220:223], v[84:87], v[196:199]
  ds_read_b128 v[216:219], v70 offset:13312
  v_cvt_pk_bf16_f32 v248, v184, v185
  v_mfma_f32_16x16x32_bf16 v[200:203], v[220:223], v[88:91], v[200:203]
  s_add_u32 m0, s81, 7168
  s_nop 0
  buffer_load_dwordx4 v55, s[12:15], s80 offen lds
  v_mfma_f32_16x16x32_bf16 v[204:207], v[220:223], v[92:95], v[204:207]
  v_cvt_pk_bf16_f32 v249, v186, v187
  s_waitcnt lgkmcnt(2)
  v_mfma_f32_16x16x32_bf16 v[196:199], v[208:211], v[96:99], v[196:199]
  ds_read_b128 v[220:223], v71 offset:13312
  v_cvt_pk_bf16_f32 v250, v188, v189
  v_mfma_f32_16x16x32_bf16 v[200:203], v[208:211], v[100:103], v[200:203]
  s_add_u32 m0, s81, 8192
  s_nop 0
  buffer_load_dwordx4 v56, s[12:15], s80 offen lds
  v_mfma_f32_16x16x32_bf16 v[204:207], v[208:211], v[104:107], v[204:207]
  v_cvt_pk_bf16_f32 v251, v190, v191
  s_waitcnt lgkmcnt(2)
  v_mfma_f32_16x16x32_bf16 v[196:199], v[212:215], v[108:111], v[196:199]
  v_accvgpr_write_b32 a56, v248
  v_mfma_f32_16x16x32_bf16 v[200:203], v[212:215], v[112:115], v[200:203]
  s_add_u32 m0, s81, 9216
  s_nop 0
  buffer_load_dwordx4 v57, s[12:15], s80 offen lds
  v_mfma_f32_16x16x32_bf16 v[204:207], v[212:215], v[116:119], v[204:207]
  v_accvgpr_write_b32 a57, v249
  s_waitcnt lgkmcnt(1)
  v_mfma_f32_16x16x32_bf16 v[196:199], v[216:219], v[120:123], v[196:199]
  v_accvgpr_write_b32 a136, v250
  v_mfma_f32_16x16x32_bf16 v[200:203], v[216:219], v[124:127], v[200:203]
  s_add_u32 m0, s81, 10240
  s_nop 0
  buffer_load_dwordx4 v58, s[12:15], s80 offen lds
  v_mfma_f32_16x16x32_bf16 v[204:207], v[216:219], v[128:131], v[204:207]
  v_accvgpr_write_b32 a137, v251
  s_waitcnt lgkmcnt(0)
  v_mfma_f32_16x16x32_bf16 v[196:199], v[220:223], v[132:135], v[196:199]
  v_cvt_pk_bf16_f32 v172, v192, v193
  v_cvt_pk_bf16_f32 v173, v194, v195
  v_mfma_f32_16x16x32_bf16 v[200:203], v[220:223], v[136:139], v[200:203]
  s_add_u32 m0, s81, 11264
  s_nop 0
  buffer_load_dwordx4 v59, s[12:15], s80 offen lds
  s_add_u32 s80, s80, 393216
  v_mfma_f32_16x16x32_bf16 v[204:207], v[220:223], v[140:143], v[204:207]
  s_add_u32 s21, s79, 1572864
  buffer_load_dwordx4 v[224:227], v63, s[24:27], s21 offen
  s_add_u32 s21, s79, 1572864
  buffer_load_dwordx4 v[228:231], v64, s[24:27], s21 offen
  s_add_u32 s21, s79, 1572864
  buffer_load_dwordx4 v[232:235], v65, s[24:27], s21 offen
  s_waitcnt vmcnt(18)
  ds_read_b128 v[208:211], v70 offset:24576
  ds_read_b128 v[212:215], v71 offset:24576
  ds_read_b128 v[216:219], v70 offset:24704
  s_waitcnt lgkmcnt(2)
  v_mfma_f32_16x16x32_bf16 v[184:187], v[208:211], v[72:75], 0
  ds_read_b128 v[220:223], v71 offset:24704
  v_mfma_f32_16x16x32_bf16 v[188:191], v[208:211], v[76:79], 0
  s_add_u32 m0, s81, 12288
  s_nop 0
  buffer_load_dwordx4 v48, s[12:15], s80 offen lds
  v_mfma_f32_16x16x32_bf16 v[192:195], v[208:211], v[80:83], 0
  s_waitcnt lgkmcnt(2)
  v_mfma_f32_16x16x32_bf16 v[184:187], v[212:215], v[84:87], v[184:187]
  ds_read_b128 v[208:211], v70 offset:24832
  v_cvt_pk_bf16_f32 v248, v196, v197
  v_mfma_f32_16x16x32_bf16 v[188:191], v[212:215], v[88:91], v[188:191]
  s_add_u32 m0, s81, 13312
  s_nop 0
  buffer_load_dwordx4 v49, s[12:15], s80 offen lds
  v_mfma_f32_16x16x32_bf16 v[192:195], v[212:215], v[92:95], v[192:195]
  v_cvt_pk_bf16_f32 v249, v198, v199
  s_waitcnt lgkmcnt(2)
  v_mfma_f32_16x16x32_bf16 v[184:187], v[216:219], v[96:99], v[184:187]
  ds_read_b128 v[212:215], v71 offset:24832
  v_cvt_pk_bf16_f32 v250, v200, v201
  v_mfma_f32_16x16x32_bf16 v[188:191], v[216:219], v[100:103], v[188:191]
  s_add_u32 m0, s81, 14336
  s_nop 0
  buffer_load_dwordx4 v50, s[12:15], s80 offen lds
  v_mfma_f32_16x16x32_bf16 v[192:195], v[216:219], v[104:107], v[192:195]
  v_cvt_pk_bf16_f32 v251, v202, v203
  s_waitcnt lgkmcnt(2)
  v_mfma_f32_16x16x32_bf16 v[184:187], v[220:223], v[108:111], v[184:187]
  ds_read_b128 v[216:219], v70 offset:25344
  v_accvgpr_write_b32 a58, v248
  v_mfma_f32_16x16x32_bf16 v[188:191], v[220:223], v[112:115], v[188:191]
  s_add_u32 m0, s81, 15360
  s_nop 0
  buffer_load_dwordx4 v51, s[12:15], s80 offen lds
  v_mfma_f32_16x16x32_bf16 v[192:195], v[220:223], v[116:119], v[192:195]
  v_accvgpr_write_b32 a59, v249
  s_waitcnt lgkmcnt(2)
  v_mfma_f32_16x16x32_bf16 v[184:187], v[208:211], v[120:123], v[184:187]
  ds_read_b128 v[220:223], v71 offset:25344
  v_accvgpr_write_b32 a138, v250
  v_mfma_f32_16x16x32_bf16 v[188:191], v[208:211], v[124:127], v[188:191]
  s_add_u32 m0, s81, 16384
  s_nop 0
  buffer_load_dwordx4 v52, s[12:15], s80 offen lds
  v_mfma_f32_16x16x32_bf16 v[192:195], v[208:211], v[128:131], v[192:195]
  v_accvgpr_write_b32 a139, v251
  s_waitcnt lgkmcnt(2)
  v_mfma_f32_16x16x32_bf16 v[184:187], v[212:215], v[132:135], v[184:187]
  ds_read_b128 v[208:211], v70 offset:25472
  s_mov_b64 exec, s[68:69]
  v_cvt_pk_bf16_f32 v172, v204, v205
  v_cvt_pk_bf16_f32 v173, v206, v207
  s_mov_b64 exec, -1
  v_mfma_f32_16x16x32_bf16 v[188:191], v[212:215], v[136:139], v[188:191]
  s_add_u32 m0, s81, 17408
  s_nop 0
  buffer_load_dwordx4 v53, s[12:15], s80 offen lds
  v_mfma_f32_16x16x32_bf16 v[192:195], v[212:215], v[140:143], v[192:195]
  s_waitcnt lgkmcnt(2)
  v_mfma_f32_16x16x32_bf16 v[196:199], v[216:219], v[72:75], 0
  ds_read_b128 v[212:215], v71 offset:25472
  v_mfma_f32_16x16x32_bf16 v[200:203], v[216:219], v[76:79], 0
  s_add_u32 m0, s81, 18432
  s_nop 0
  buffer_load_dwordx4 v54, s[12:15], s80 offen lds
  v_mfma_f32_16x16x32_bf16 v[204:207], v[216:219], v[80:83], 0
  s_waitcnt lgkmcnt(2)
  v_mfma_f32_16x16x32_bf16 v[196:199], v[220:223], v[84:87], v[196:199]
  ds_read_b128 v[216:219], v70 offset:25600
  v_cvt_pk_bf16_f32 v248, v184, v185
  v_mfma_f32_16x16x32_bf16 v[200:203], v[220:223], v[88:91], v[200:203]
  s_add_u32 m0, s81, 19456
  s_nop 0
  buffer_load_dwordx4 v55, s[12:15], s80 offen lds
  v_mfma_f32_16x16x32_bf16 v[204:207], v[220:223], v[92:95], v[204:207]
  v_cvt_pk_bf16_f32 v249, v186, v187
  s_waitcnt lgkmcnt(2)
  v_mfma_f32_16x16x32_bf16 v[196:199], v[208:211], v[96:99], v[196:199]
  ds_read_b128 v[220:223], v71 offset:25600
  v_cvt_pk_bf16_f32 v250, v188, v189
  v_mfma_f32_16x16x32_bf16 v[200:203], v[208:211], v[100:103], v[200:203]
  s_add_u32 m0, s81, 20480
  s_nop 0
  buffer_load_dwordx4 v56, s[12:15], s80 offen lds
  v_mfma_f32_16x16x32_bf16 v[204:207], v[208:211], v[104:107], v[204:207]
  v_cvt_pk_bf16_f32 v251, v190, v191
  s_waitcnt lgkmcnt(2)
  v_mfma_f32_16x16x32_bf16 v[196:199], v[212:215], v[108:111], v[196:199]
  v_accvgpr_write_b32 a60, v248
  v_mfma_f32_16x16x32_bf16 v[200:203], v[212:215], v[112:115], v[200:203]
  s_add_u32 m0, s81, 21504
  s_nop 0
  buffer_load_dwordx4 v57, s[12:15], s80 offen lds
  v_mfma_f32_16x16x32_bf16 v[204:207], v[212:215], v[116:119], v[204:207]
  v_accvgpr_write_b32 a61, v249
  s_waitcnt lgkmcnt(1)
  v_mfma_f32_16x16x32_bf16 v[196:199], v[216:219], v[120:123], v[196:199]
  v_accvgpr_write_b32 a140, v250
  v_mfma_f32_16x16x32_bf16 v[200:203], v[216:219], v[124:127], v[200:203]
  s_add_u32 m0, s81, 22528
  s_nop 0
  buffer_load_dwordx4 v58, s[12:15], s80 offen lds
  v_mfma_f32_16x16x32_bf16 v[204:207], v[216:219], v[128:131], v[204:207]
  v_accvgpr_write_b32 a141, v251
  s_waitcnt lgkmcnt(0)
  v_mfma_f32_16x16x32_bf16 v[196:199], v[220:223], v[132:135], v[196:199]
  v_cvt_pk_bf16_f32 v174, v192, v193
  v_cvt_pk_bf16_f32 v175, v194, v195
  v_mfma_f32_16x16x32_bf16 v[200:203], v[220:223], v[136:139], v[200:203]
  s_add_u32 m0, s81, 23552
  s_nop 0
  buffer_load_dwordx4 v59, s[12:15], s80 offen lds
  s_add_u32 s80, s80, 393216
  v_mfma_f32_16x16x32_bf16 v[204:207], v[220:223], v[140:143], v[204:207]
  s_waitcnt vmcnt(15)
  s_and_b32 s21, s50, 1
  s_lshl_b32 s21, s21, 4
  s_add_u32 s21, s21, s51
  s_lshl_b32 s22, s21, 10
  s_add_u32 s22, s22, s77
  s_add_u32 s23, s77, 30720
  s_cmp_lt_u32 s21, 10
  s_cselect_b32 s23, 0, s23
  s_add_u32 s22, s22, s23
  s_mul_i32 s23, s20, 122880
  s_add_u32 s22, s22, s23
  buffer_load_dwordx4 v[252:255], v4, s[8:11], s22 offen sc1
  ds_read_b128 v[208:211], v70 offset:0
  ds_read_b128 v[212:215], v71 offset:0
  ds_read_b128 v[216:219], v70 offset:128
  s_waitcnt lgkmcnt(2)
  v_mfma_f32_16x16x32_bf16 v[184:187], v[208:211], v[72:75], 0
  ds_read_b128 v[220:223], v71 offset:128
  v_mfma_f32_16x16x32_bf16 v[188:191], v[208:211], v[76:79], 0
  s_add_u32 m0, s81, 24576
  s_nop 0
  buffer_load_dwordx4 v48, s[12:15], s80 offen lds
  v_mfma_f32_16x16x32_bf16 v[192:195], v[208:211], v[80:83], 0
  s_waitcnt lgkmcnt(2)
  v_mfma_f32_16x16x32_bf16 v[184:187], v[212:215], v[84:87], v[184:187]
  ds_read_b128 v[208:211], v70 offset:256
  v_cvt_pk_bf16_f32 v248, v196, v197
  v_mfma_f32_16x16x32_bf16 v[188:191], v[212:215], v[88:91], v[188:191]
  s_add_u32 m0, s81, 25600
  s_nop 0
  buffer_load_dwordx4 v49, s[12:15], s80 offen lds
  v_mfma_f32_16x16x32_bf16 v[192:195], v[212:215], v[92:95], v[192:195]
  v_cvt_pk_bf16_f32 v249, v198, v199
  s_waitcnt lgkmcnt(2)
  v_mfma_f32_16x16x32_bf16 v[184:187], v[216:219], v[96:99], v[184:187]
  ds_read_b128 v[212:215], v71 offset:256
  v_cvt_pk_bf16_f32 v250, v200, v201
  v_mfma_f32_16x16x32_bf16 v[188:191], v[216:219], v[100:103], v[188:191]
  s_add_u32 m0, s81, 26624
  s_nop 0
  buffer_load_dwordx4 v50, s[12:15], s80 offen lds
  v_mfma_f32_16x16x32_bf16 v[192:195], v[216:219], v[104:107], v[192:195]
  v_cvt_pk_bf16_f32 v251, v202, v203
  s_waitcnt lgkmcnt(2)
  v_mfma_f32_16x16x32_bf16 v[184:187], v[220:223], v[108:111], v[184:187]
  ds_read_b128 v[216:219], v70 offset:768
  v_accvgpr_write_b32 a62, v248
  v_mfma_f32_16x16x32_bf16 v[188:191], v[220:223], v[112:115], v[188:191]
  s_add_u32 m0, s81, 27648
  s_nop 0
  buffer_load_dwordx4 v51, s[12:15], s80 offen lds
  v_mfma_f32_16x16x32_bf16 v[192:195], v[220:223], v[116:119], v[192:195]
  v_accvgpr_write_b32 a63, v249
  s_waitcnt lgkmcnt(2)
  v_mfma_f32_16x16x32_bf16 v[184:187], v[208:211], v[120:123], v[184:187]
  ds_read_b128 v[220:223], v71 offset:768
  v_accvgpr_write_b32 a142, v250
  v_mfma_f32_16x16x32_bf16 v[188:191], v[208:211], v[124:127], v[188:191]
  s_add_u32 m0, s81, 28672
  s_nop 0
  buffer_load_dwordx4 v52, s[12:15], s80 offen lds
  v_mfma_f32_16x16x32_bf16 v[192:195], v[208:211], v[128:131], v[192:195]
  v_accvgpr_write_b32 a143, v251
  s_waitcnt lgkmcnt(2)
  v_mfma_f32_16x16x32_bf16 v[184:187], v[212:215], v[132:135], v[184:187]
  ds_read_b128 v[208:211], v70 offset:896
  s_mov_b64 exec, s[68:69]
  v_cvt_pk_bf16_f32 v174, v204, v205
  v_cvt_pk_bf16_f32 v175, v206, v207
  s_mov_b64 exec, -1
  v_mfma_f32_16x16x32_bf16 v[188:191], v[212:215], v[136:139], v[188:191]
  s_add_u32 m0, s81, 29696
  s_nop 0
  buffer_load_dwordx4 v53, s[12:15], s80 offen lds
  v_mfma_f32_16x16x32_bf16 v[192:195], v[212:215], v[140:143], v[192:195]
  s_waitcnt lgkmcnt(2)
  v_mfma_f32_16x16x32_bf16 v[196:199], v[216:219], v[72:75], 0
  ds_read_b128 v[212:215], v71 offset:896
  v_mfma_f32_16x16x32_bf16 v[200:203], v[216:219], v[76:79], 0
  s_add_u32 m0, s81, 30720
  s_nop 0
  buffer_load_dwordx4 v54, s[12:15], s80 offen lds
  v_mfma_f32_16x16x32_bf16 v[204:207], v[216:219], v[80:83], 0
  s_waitcnt lgkmcnt(2)
  v_mfma_f32_16x16x32_bf16 v[196:199], v[220:223], v[84:87], v[196:199]
  ds_read_b128 v[216:219], v70 offset:1024
  v_cvt_pk_bf16_f32 v248, v184, v185
  v_mfma_f32_16x16x32_bf16 v[200:203], v[220:223], v[88:91], v[200:203]
  s_add_u32 m0, s81, 31744
  s_nop 0
  buffer_load_dwordx4 v55, s[12:15], s80 offen lds
  v_mfma_f32_16x16x32_bf16 v[204:207], v[220:223], v[92:95], v[204:207]
  v_cvt_pk_bf16_f32 v249, v186, v187
  s_waitcnt lgkmcnt(2)
  v_mfma_f32_16x16x32_bf16 v[196:199], v[208:211], v[96:99], v[196:199]
  ds_read_b128 v[220:223], v71 offset:1024
  v_cvt_pk_bf16_f32 v250, v188, v189
  v_mfma_f32_16x16x32_bf16 v[200:203], v[208:211], v[100:103], v[200:203]
  s_add_u32 m0, s81, 32768
  s_nop 0
  buffer_load_dwordx4 v56, s[12:15], s80 offen lds
  v_mfma_f32_16x16x32_bf16 v[204:207], v[208:211], v[104:107], v[204:207]
  v_cvt_pk_bf16_f32 v251, v190, v191
  s_waitcnt lgkmcnt(2)
  v_mfma_f32_16x16x32_bf16 v[196:199], v[212:215], v[108:111], v[196:199]
  v_accvgpr_write_b32 a64, v248
  v_mfma_f32_16x16x32_bf16 v[200:203], v[212:215], v[112:115], v[200:203]
  s_add_u32 m0, s81, 33792
  s_nop 0
  buffer_load_dwordx4 v57, s[12:15], s80 offen lds
  v_mfma_f32_16x16x32_bf16 v[204:207], v[212:215], v[116:119], v[204:207]
  v_accvgpr_write_b32 a65, v249
  s_waitcnt lgkmcnt(1)
  v_mfma_f32_16x16x32_bf16 v[196:199], v[216:219], v[120:123], v[196:199]
  v_accvgpr_write_b32 a144, v250
  v_mfma_f32_16x16x32_bf16 v[200:203], v[216:219], v[124:127], v[200:203]
  s_add_u32 m0, s81, 34816
  s_nop 0
  buffer_load_dwordx4 v58, s[12:15], s80 offen lds
  v_mfma_f32_16x16x32_bf16 v[204:207], v[216:219], v[128:131], v[204:207]
  v_accvgpr_write_b32 a145, v251
  s_waitcnt lgkmcnt(0)
  v_mfma_f32_16x16x32_bf16 v[196:199], v[220:223], v[132:135], v[196:199]
  v_cvt_pk_bf16_f32 v176, v192, v193
  v_cvt_pk_bf16_f32 v177, v194, v195
  v_mfma_f32_16x16x32_bf16 v[200:203], v[220:223], v[136:139], v[200:203]
  s_add_u32 m0, s81, 35840
  s_nop 0
  buffer_load_dwordx4 v59, s[12:15], s80 offen lds
  s_add_u32 s80, s80, 393216
  v_mfma_f32_16x16x32_bf16 v[204:207], v[220:223], v[140:143], v[204:207]
  s_waitcnt vmcnt(13)
  ds_read_b128 v[208:211], v70 offset:12288
  ds_read_b128 v[212:215], v71 offset:12288
  ds_read_b128 v[216:219], v70 offset:12416
  s_waitcnt lgkmcnt(2)
  v_mfma_f32_16x16x32_bf16 v[184:187], v[208:211], v[72:75], 0
  ds_read_b128 v[220:223], v71 offset:12416
  v_mfma_f32_16x16x32_bf16 v[188:191], v[208:211], v[76:79], 0
  s_add_u32 m0, s81, 0
  s_nop 0
  buffer_load_dwordx4 v48, s[12:15], s80 offen lds
  v_mfma_f32_16x16x32_bf16 v[192:195], v[208:211], v[80:83], 0
  s_waitcnt lgkmcnt(2)
  v_mfma_f32_16x16x32_bf16 v[184:187], v[212:215], v[84:87], v[184:187]
  ds_read_b128 v[208:211], v70 offset:12544
  v_cvt_pk_bf16_f32 v248, v196, v197
  v_mfma_f32_16x16x32_bf16 v[188:191], v[212:215], v[88:91], v[188:191]
  s_add_u32 m0, s81, 1024
  s_nop 0
  buffer_load_dwordx4 v49, s[12:15], s80 offen lds
  v_mfma_f32_16x16x32_bf16 v[192:195], v[212:215], v[92:95], v[192:195]
  v_cvt_pk_bf16_f32 v249, v198, v199
  s_waitcnt lgkmcnt(2)
  v_mfma_f32_16x16x32_bf16 v[184:187], v[216:219], v[96:99], v[184:187]
  ds_read_b128 v[212:215], v71 offset:12544
  v_cvt_pk_bf16_f32 v250, v200, v201
  v_mfma_f32_16x16x32_bf16 v[188:191], v[216:219], v[100:103], v[188:191]
  s_add_u32 m0, s81, 2048
  s_nop 0
  buffer_load_dwordx4 v50, s[12:15], s80 offen lds
  v_mfma_f32_16x16x32_bf16 v[192:195], v[216:219], v[104:107], v[192:195]
  v_cvt_pk_bf16_f32 v251, v202, v203
  s_waitcnt lgkmcnt(2)
  v_mfma_f32_16x16x32_bf16 v[184:187], v[220:223], v[108:111], v[184:187]
  ds_read_b128 v[216:219], v70 offset:13056
  v_accvgpr_write_b32 a66, v248
  v_mfma_f32_16x16x32_bf16 v[188:191], v[220:223], v[112:115], v[188:191]
  s_add_u32 m0, s81, 3072
  s_nop 0
  buffer_load_dwordx4 v51, s[12:15], s80 offen lds
  v_mfma_f32_16x16x32_bf16 v[192:195], v[220:223], v[116:119], v[192:195]
  v_accvgpr_write_b32 a67, v249
  s_waitcnt lgkmcnt(2)
  v_mfma_f32_16x16x32_bf16 v[184:187], v[208:211], v[120:123], v[184:187]
  ds_read_b128 v[220:223], v71 offset:13056
  v_accvgpr_write_b32 a146, v250
  v_mfma_f32_16x16x32_bf16 v[188:191], v[208:211], v[124:127], v[188:191]
  s_add_u32 m0, s81, 4096
  s_nop 0
  buffer_load_dwordx4 v52, s[12:15], s80 offen lds
  v_mfma_f32_16x16x32_bf16 v[192:195], v[208:211], v[128:131], v[192:195]
  v_accvgpr_write_b32 a147, v251
  s_waitcnt lgkmcnt(2)
  v_mfma_f32_16x16x32_bf16 v[184:187], v[212:215], v[132:135], v[184:187]
  ds_read_b128 v[208:211], v70 offset:13184
  s_mov_b64 exec, s[68:69]
  v_cvt_pk_bf16_f32 v176, v204, v205
  v_cvt_pk_bf16_f32 v177, v206, v207
  s_mov_b64 exec, -1
  v_mfma_f32_16x16x32_bf16 v[188:191], v[212:215], v[136:139], v[188:191]
  s_add_u32 m0, s81, 5120
  s_nop 0
  buffer_load_dwordx4 v53, s[12:15], s80 offen lds
  v_mfma_f32_16x16x32_bf16 v[192:195], v[212:215], v[140:143], v[192:195]
  s_waitcnt lgkmcnt(2)
  v_mfma_f32_16x16x32_bf16 v[196:199], v[216:219], v[72:75], 0
  ds_read_b128 v[212:215], v71 offset:13184
  v_mfma_f32_16x16x32_bf16 v[200:203], v[216:219], v[76:79], 0
  s_add_u32 m0, s81, 6144
  s_nop 0
  buffer_load_dwordx4 v54, s[12:15], s80 offen lds
  v_mfma_f32_16x16x32_bf16 v[204:207], v[216:219], v[80:83], 0
  s_waitcnt lgkmcnt(2)
  v_mfma_f32_16x16x32_bf16 v[196:199], v[220:223], v[84:87], v[196:199]
  ds_read_b128 v[216:219], v70 offset:13312
  v_cvt_pk_bf16_f32 v248, v184, v185
  v_mfma_f32_16x16x32_bf16 v[200:203], v[220:223], v[88:91], v[200:203]
  s_add_u32 m0, s81, 7168
  s_nop 0
  buffer_load_dwordx4 v55, s[12:15], s80 offen lds
  v_mfma_f32_16x16x32_bf16 v[204:207], v[220:223], v[92:95], v[204:207]
  v_cvt_pk_bf16_f32 v249, v186, v187
  s_waitcnt lgkmcnt(2)
  v_mfma_f32_16x16x32_bf16 v[196:199], v[208:211], v[96:99], v[196:199]
  ds_read_b128 v[220:223], v71 offset:13312
  v_cvt_pk_bf16_f32 v250, v188, v189
  v_mfma_f32_16x16x32_bf16 v[200:203], v[208:211], v[100:103], v[200:203]
  s_add_u32 m0, s81, 8192
  s_nop 0
  buffer_load_dwordx4 v56, s[12:15], s80 offen lds
  v_mfma_f32_16x16x32_bf16 v[204:207], v[208:211], v[104:107], v[204:207]
  v_cvt_pk_bf16_f32 v251, v190, v191
  s_waitcnt lgkmcnt(2)
  v_mfma_f32_16x16x32_bf16 v[196:199], v[212:215], v[108:111], v[196:199]
  v_accvgpr_write_b32 a68, v248
  v_mfma_f32_16x16x32_bf16 v[200:203], v[212:215], v[112:115], v[200:203]
  s_add_u32 m0, s81, 9216
  s_nop 0
  buffer_load_dwordx4 v57, s[12:15], s80 offen lds
  v_mfma_f32_16x16x32_bf16 v[204:207], v[212:215], v[116:119], v[204:207]
  v_accvgpr_write_b32 a69, v249
  s_waitcnt lgkmcnt(1)
  v_mfma_f32_16x16x32_bf16 v[196:199], v[216:219], v[120:123], v[196:199]
  v_accvgpr_write_b32 a148, v250
  v_mfma_f32_16x16x32_bf16 v[200:203], v[216:219], v[124:127], v[200:203]
  s_add_u32 m0, s81, 10240
  s_nop 0
  buffer_load_dwordx4 v58, s[12:15], s80 offen lds
  v_mfma_f32_16x16x32_bf16 v[204:207], v[216:219], v[128:131], v[204:207]
  v_accvgpr_write_b32 a149, v251
  s_waitcnt lgkmcnt(0)
  v_mfma_f32_16x16x32_bf16 v[196:199], v[220:223], v[132:135], v[196:199]
  v_cvt_pk_bf16_f32 v178, v192, v193
  v_cvt_pk_bf16_f32 v179, v194, v195
  v_mfma_f32_16x16x32_bf16 v[200:203], v[220:223], v[136:139], v[200:203]
  s_add_u32 m0, s81, 11264
  s_nop 0
  buffer_load_dwordx4 v59, s[12:15], s80 offen lds
  s_add_u32 s80, s80, 393216
  v_mfma_f32_16x16x32_bf16 v[204:207], v[220:223], v[140:143], v[204:207]
  s_waitcnt vmcnt(12)
  v_readlane_b32 s83, v66, 19
  s_sub_u32 s21, s83, 1
  s_lshl_b32 s21, s21, 13
  s_and_b32 s21, s21, 8192
  s_xor_b32 s76, s90, s21
  buffer_load_dword v66, v67, s[32:35], 0 offen sc1
  buffer_load_dword v42, v41, s[16:19], s76 offen sc1
  ds_read_b128 v[208:211], v70 offset:24576
  ds_read_b128 v[212:215], v71 offset:24576
  ds_read_b128 v[216:219], v70 offset:24704
  s_waitcnt lgkmcnt(2)
  v_mfma_f32_16x16x32_bf16 v[184:187], v[208:211], v[72:75], 0
  ds_read_b128 v[220:223], v71 offset:24704
  v_mfma_f32_16x16x32_bf16 v[188:191], v[208:211], v[76:79], 0
  ds_write_b128 v68, a[160:163] offset:12288
  v_mfma_f32_16x16x32_bf16 v[192:195], v[208:211], v[80:83], 0
  s_waitcnt lgkmcnt(3)
  v_mfma_f32_16x16x32_bf16 v[184:187], v[212:215], v[84:87], v[184:187]
  ds_read_b128 v[208:211], v70 offset:24832
  v_cvt_pk_bf16_f32 v248, v196, v197
  v_mfma_f32_16x16x32_bf16 v[188:191], v[212:215], v[88:91], v[188:191]
  ds_write_b128 v68, a[164:167] offset:13312
  v_mfma_f32_16x16x32_bf16 v[192:195], v[212:215], v[92:95], v[192:195]
  v_cvt_pk_bf16_f32 v249, v198, v199
  s_waitcnt lgkmcnt(4)
  v_mfma_f32_16x16x32_bf16 v[184:187], v[216:219], v[96:99], v[184:187]
  ds_read_b128 v[212:215], v71 offset:24832
  v_cvt_pk_bf16_f32 v250, v200, v201
  v_mfma_f32_16x16x32_bf16 v[188:191], v[216:219], v[100:103], v[188:191]
  ds_write_b128 v68, a[168:171] offset:14336
  v_mfma_f32_16x16x32_bf16 v[192:195], v[216:219], v[104:107], v[192:195]
  v_cvt_pk_bf16_f32 v251, v202, v203
  s_waitcnt lgkmcnt(5)
  v_mfma_f32_16x16x32_bf16 v[184:187], v[220:223], v[108:111], v[184:187]
  ds_read_b128 v[216:219], v70 offset:25344
  v_accvgpr_write_b32 a70, v248
  v_mfma_f32_16x16x32_bf16 v[188:191], v[220:223], v[112:115], v[188:191]
  ds_write_b128 v68, a[172:175] offset:15360
  v_mfma_f32_16x16x32_bf16 v[192:195], v[220:223], v[116:119], v[192:195]
  v_accvgpr_write_b32 a71, v249
  s_waitcnt lgkmcnt(5)
  v_mfma_f32_16x16x32_bf16 v[184:187], v[208:211], v[120:123], v[184:187]
  ds_read_b128 v[220:223], v71 offset:25344
  v_accvgpr_write_b32 a150, v250
  v_mfma_f32_16x16x32_bf16 v[188:191], v[208:211], v[124:127], v[188:191]
  ds_write_b128 v68, a[176:179] offset:16384
  v_mfma_f32_16x16x32_bf16 v[192:195], v[208:211], v[128:131], v[192:195]
  v_accvgpr_write_b32 a151, v251
  s_waitcnt lgkmcnt(5)
  v_mfma_f32_16x16x32_bf16 v[184:187], v[212:215], v[132:135], v[184:187]
  ds_read_b128 v[208:211], v70 offset:25472
  s_mov_b64 exec, s[68:69]
  v_cvt_pk_bf16_f32 v178, v204, v205
  v_cvt_pk_bf16_f32 v179, v206, v207
  s_mov_b64 exec, -1
  v_mfma_f32_16x16x32_bf16 v[188:191], v[212:215], v[136:139], v[188:191]
  ds_write_b128 v68, a[180:183] offset:17408
  v_mfma_f32_16x16x32_bf16 v[192:195], v[212:215], v[140:143], v[192:195]
  s_waitcnt lgkmcnt(5)
  v_mfma_f32_16x16x32_bf16 v[196:199], v[216:219], v[72:75], 0
  ds_read_b128 v[212:215], v71 offset:25472
  v_mfma_f32_16x16x32_bf16 v[200:203], v[216:219], v[76:79], 0
  ds_write_b128 v68, a[184:187] offset:18432
  v_mfma_f32_16x16x32_bf16 v[204:207], v[216:219], v[80:83], 0
  s_waitcnt lgkmcnt(5)
  v_mfma_f32_16x16x32_bf16 v[196:199], v[220:223], v[84:87], v[196:199]
  ds_read_b128 v[216:219], v70 offset:25600
  v_cvt_pk_bf16_f32 v248, v184, v185
  v_mfma_f32_16x16x32_bf16 v[200:203], v[220:223], v[88:91], v[200:203]
  ds_write_b128 v68, a[188:191] offset:19456
  v_mfma_f32_16x16x32_bf16 v[204:207], v[220:223], v[92:95], v[204:207]
  v_cvt_pk_bf16_f32 v249, v186, v187
  s_waitcnt lgkmcnt(5)
  v_mfma_f32_16x16x32_bf16 v[196:199], v[208:211], v[96:99], v[196:199]
  ds_read_b128 v[220:223], v71 offset:25600
  v_cvt_pk_bf16_f32 v250, v188, v189
  v_mfma_f32_16x16x32_bf16 v[200:203], v[208:211], v[100:103], v[200:203]
  ds_write_b128 v68, a[192:195] offset:20480
  v_mfma_f32_16x16x32_bf16 v[204:207], v[208:211], v[104:107], v[204:207]
  v_cvt_pk_bf16_f32 v251, v190, v191
  s_waitcnt lgkmcnt(5)
  v_mfma_f32_16x16x32_bf16 v[196:199], v[212:215], v[108:111], v[196:199]
  v_accvgpr_write_b32 a72, v248
  v_mfma_f32_16x16x32_bf16 v[200:203], v[212:215], v[112:115], v[200:203]
  ds_write_b128 v68, a[196:199] offset:21504
  v_mfma_f32_16x16x32_bf16 v[204:207], v[212:215], v[116:119], v[204:207]
  v_accvgpr_write_b32 a73, v249
  s_waitcnt lgkmcnt(4)
  v_mfma_f32_16x16x32_bf16 v[196:199], v[216:219], v[120:123], v[196:199]
  v_accvgpr_write_b32 a152, v250
  v_mfma_f32_16x16x32_bf16 v[200:203], v[216:219], v[124:127], v[200:203]
  ds_write_b128 v68, a[200:203] offset:22528
  v_mfma_f32_16x16x32_bf16 v[204:207], v[216:219], v[128:131], v[204:207]
  v_accvgpr_write_b32 a153, v251
  s_waitcnt lgkmcnt(3)
  v_mfma_f32_16x16x32_bf16 v[196:199], v[220:223], v[132:135], v[196:199]
  v_cvt_pk_bf16_f32 v180, v192, v193
  v_cvt_pk_bf16_f32 v181, v194, v195
  v_mfma_f32_16x16x32_bf16 v[200:203], v[220:223], v[136:139], v[200:203]
  ds_write_b128 v68, a[204:207] offset:23552
  v_mfma_f32_16x16x32_bf16 v[204:207], v[220:223], v[140:143], v[204:207]
  s_waitcnt vmcnt(2)
  ds_read_b128 v[208:211], v70 offset:0
  ds_read_b128 v[212:215], v71 offset:0
  ds_read_b128 v[216:219], v70 offset:128
  s_waitcnt lgkmcnt(2)
  v_mfma_f32_16x16x32_bf16 v[184:187], v[208:211], v[72:75], 0
  ds_read_b128 v[220:223], v71 offset:128
  v_mfma_f32_16x16x32_bf16 v[188:191], v[208:211], v[76:79], 0
  ds_write_b128 v68, a[208:211] offset:24576
  v_mfma_f32_16x16x32_bf16 v[192:195], v[208:211], v[80:83], 0
  s_waitcnt lgkmcnt(3)
  v_mfma_f32_16x16x32_bf16 v[184:187], v[212:215], v[84:87], v[184:187]
  ds_read_b128 v[208:211], v70 offset:256
  v_cvt_pk_bf16_f32 v248, v196, v197
  v_mfma_f32_16x16x32_bf16 v[188:191], v[212:215], v[88:91], v[188:191]
  ds_write_b128 v68, a[212:215] offset:25600
  v_mfma_f32_16x16x32_bf16 v[192:195], v[212:215], v[92:95], v[192:195]
  v_cvt_pk_bf16_f32 v249, v198, v199
  s_waitcnt lgkmcnt(4)
  v_mfma_f32_16x16x32_bf16 v[184:187], v[216:219], v[96:99], v[184:187]
  ds_read_b128 v[212:215], v71 offset:256
  v_cvt_pk_bf16_f32 v250, v200, v201
  v_mfma_f32_16x16x32_bf16 v[188:191], v[216:219], v[100:103], v[188:191]
  ds_write_b128 v68, a[216:219] offset:26624
  v_mfma_f32_16x16x32_bf16 v[192:195], v[216:219], v[104:107], v[192:195]
  v_cvt_pk_bf16_f32 v251, v202, v203
  s_waitcnt lgkmcnt(5)
  v_mfma_f32_16x16x32_bf16 v[184:187], v[220:223], v[108:111], v[184:187]
  ds_read_b128 v[216:219], v70 offset:768
  v_accvgpr_write_b32 a74, v248
  v_mfma_f32_16x16x32_bf16 v[188:191], v[220:223], v[112:115], v[188:191]
  ds_write_b128 v68, a[220:223] offset:27648
  v_mfma_f32_16x16x32_bf16 v[192:195], v[220:223], v[116:119], v[192:195]
  v_accvgpr_write_b32 a75, v249
  s_waitcnt lgkmcnt(5)
  v_mfma_f32_16x16x32_bf16 v[184:187], v[208:211], v[120:123], v[184:187]
  ds_read_b128 v[220:223], v71 offset:768
  v_accvgpr_write_b32 a154, v250
  v_mfma_f32_16x16x32_bf16 v[188:191], v[208:211], v[124:127], v[188:191]
  ds_write_b128 v68, a[224:227] offset:28672
  v_mfma_f32_16x16x32_bf16 v[192:195], v[208:211], v[128:131], v[192:195]
  v_accvgpr_write_b32 a155, v251
  s_waitcnt lgkmcnt(5)
  v_mfma_f32_16x16x32_bf16 v[184:187], v[212:215], v[132:135], v[184:187]
  ds_read_b128 v[208:211], v70 offset:896
  s_mov_b64 exec, s[68:69]
  v_cvt_pk_bf16_f32 v180, v204, v205
  v_cvt_pk_bf16_f32 v181, v206, v207
  s_mov_b64 exec, -1
  v_mfma_f32_16x16x32_bf16 v[188:191], v[212:215], v[136:139], v[188:191]
  ds_write_b128 v68, a[228:231] offset:29696
  v_mfma_f32_16x16x32_bf16 v[192:195], v[212:215], v[140:143], v[192:195]
  s_waitcnt lgkmcnt(5)
  v_mfma_f32_16x16x32_bf16 v[196:199], v[216:219], v[72:75], 0
  ds_read_b128 v[212:215], v71 offset:896
  v_mfma_f32_16x16x32_bf16 v[200:203], v[216:219], v[76:79], 0
  ds_write_b128 v68, a[232:235] offset:30720
  v_mfma_f32_16x16x32_bf16 v[204:207], v[216:219], v[80:83], 0
  s_waitcnt lgkmcnt(5)
  v_mfma_f32_16x16x32_bf16 v[196:199], v[220:223], v[84:87], v[196:199]
  ds_read_b128 v[216:219], v70 offset:1024
  v_cvt_pk_bf16_f32 v248, v184, v185
  v_mfma_f32_16x16x32_bf16 v[200:203], v[220:223], v[88:91], v[200:203]
  ds_write_b128 v68, a[236:239] offset:31744
  v_mfma_f32_16x16x32_bf16 v[204:207], v[220:223], v[92:95], v[204:207]
  v_cvt_pk_bf16_f32 v249, v186, v187
  s_waitcnt lgkmcnt(5)
  v_mfma_f32_16x16x32_bf16 v[196:199], v[208:211], v[96:99], v[196:199]
  ds_read_b128 v[220:223], v71 offset:1024
  v_cvt_pk_bf16_f32 v250, v188, v189
  v_mfma_f32_16x16x32_bf16 v[200:203], v[208:211], v[100:103], v[200:203]
  ds_write_b128 v68, a[240:243] offset:32768
  v_mfma_f32_16x16x32_bf16 v[204:207], v[208:211], v[104:107], v[204:207]
  v_cvt_pk_bf16_f32 v251, v190, v191
  s_waitcnt lgkmcnt(5)
  v_mfma_f32_16x16x32_bf16 v[196:199], v[212:215], v[108:111], v[196:199]
  v_accvgpr_write_b32 a76, v248
  v_mfma_f32_16x16x32_bf16 v[200:203], v[212:215], v[112:115], v[200:203]
  ds_write_b128 v68, a[244:247] offset:33792
  v_mfma_f32_16x16x32_bf16 v[204:207], v[212:215], v[116:119], v[204:207]
  v_accvgpr_write_b32 a77, v249
  s_waitcnt lgkmcnt(4)
  v_mfma_f32_16x16x32_bf16 v[196:199], v[216:219], v[120:123], v[196:199]
  v_accvgpr_write_b32 a156, v250
  v_mfma_f32_16x16x32_bf16 v[200:203], v[216:219], v[124:127], v[200:203]
  ds_write_b128 v68, a[248:251] offset:34816
  v_mfma_f32_16x16x32_bf16 v[204:207], v[216:219], v[128:131], v[204:207]
  v_accvgpr_write_b32 a157, v251
  s_waitcnt lgkmcnt(3)
  v_mfma_f32_16x16x32_bf16 v[196:199], v[220:223], v[132:135], v[196:199]
  v_cvt_pk_bf16_f32 v182, v192, v193
  v_cvt_pk_bf16_f32 v183, v194, v195
  v_mfma_f32_16x16x32_bf16 v[200:203], v[220:223], v[136:139], v[200:203]
  ds_write_b128 v68, a[252:255] offset:35840
  v_mfma_f32_16x16x32_bf16 v[204:207], v[220:223], v[140:143], v[204:207]
  s_nop 7
  v_cvt_pk_bf16_f32 v248, v196, v197
  v_cvt_pk_bf16_f32 v249, v198, v199
  v_cvt_pk_bf16_f32 v250, v200, v201
  v_cvt_pk_bf16_f32 v251, v202, v203
  v_accvgpr_write_b32 a78, v248
  v_accvgpr_write_b32 a79, v249
  v_accvgpr_write_b32 a158, v250
  v_accvgpr_write_b32 a159, v251
  s_mov_b64 exec, s[68:69]
  v_cvt_pk_bf16_f32 v182, v204, v205
  v_cvt_pk_bf16_f32 v183, v206, v207
  s_mov_b64 exec, -1
  ds_write_b128 v68, v[224:227] offset:0
  ds_write_b128 v68, v[228:231] offset:1024
  ds_write_b128 v68, v[232:235] offset:2048
  ds_write_b128 v68, v[236:239] offset:3072
  ds_write_b128 v68, v[240:243] offset:4096
  ds_write_b128 v68, v[244:247] offset:5120
  ds_write_b64 v69, v[160:161] offset:6144
  ds_write_b64 v69, v[162:163] offset:6656
  ds_write_b64 v69, v[164:165] offset:7168
  ds_write_b64 v69, v[166:167] offset:7680
  ds_write_b64 v69, v[168:169] offset:8192
  ds_write_b64 v69, v[170:171] offset:8704
  ds_write_b64 v69, v[172:173] offset:9216
  ds_write_b64 v69, v[174:175] offset:9728
  ds_write_b64 v69, v[176:177] offset:10240
  ds_write_b64 v69, v[178:179] offset:10752
  ds_write_b64 v69, v[180:181] offset:11264
  ds_write_b64 v69, v[182:183] offset:11776
  v_lshrrev_b32 v100, 1, v3
  v_lshlrev_b32 v100, 4, v100
  v_and_b32 v101, 8, v2
  v_add_u32 v100, v100, v101
  v_and_b32 v101, 1, v3
  v_lshl_add_u32 v100, v101, 2, v100
  v_bfe_u32 v101, v2, 2, 1
  v_add_u32 v100, v100, v101
  v_mul_u32_u24 v100, 96, v100
  v_and_b32 v101, 3, v2
  v_lshl_add_u32 v100, v101, 3, v100
  s_lshl_b32 s21, s20, 5
  v_add_u32 v100, s21, v100
  v_add_u32 v101, 3072, v100
  v_cndmask_b32 v88, v100, v101, s[68:69]
  v_cndmask_b32 v92, v101, v100, s[68:69]
  v_add_u32 v89, 40960, v88
  v_add_u32 v93, 40960, v92
  v_add_u32 v90, 81920, v88
  v_add_u32 v94, 81920, v92
  v_add_u32 v91, 122880, v88
  v_add_u32 v95, 122880, v92
  v_and_b32 v100, 7, v2
  v_lshl_add_u32 v100, v3, 3, v100
  v_lshrrev_b32 v101, 3, v2
  v_mul_u32_u24 v101, 40960, v101
  v_lshl_add_u32 v96, v100, 4, v101
  v_add_u32 v97, 81920, v96
  s_bfe_u32 s82, s50, 0x10001
  s_lshl_b32 s82, s82, 5
  s_lshr_b32 s21, s50, 2
  s_add_u32 s82, s82, s21
  s_mov_b32 s101, 0
  s_branch fm_13
fm_12:
  s_sleep 8
fm_14:
  buffer_load_dword v66, v67, s[32:35], 0 offen sc1
  buffer_load_dword v42, v41, s[16:19], s76 offen sc1
  s_add_u32 s101, s101, 1
  s_cmp_gt_u32 s101, 131072
  s_cbranch_scc1 end0
fm_13:
  s_waitcnt vmcnt(0)
  s_mov_b32 s84, s83
  v_readlane_b32 s83, v66, 19
  s_sub_u32 s21, s83, 1
  s_lshl_b32 s21, s21, 13
  s_and_b32 s21, s21, 8192
  s_xor_b32 s76, s90, s21
  s_cmp_eq_u32 s83, 0
  s_cbranch_scc1 fm_12
  s_cmp_eq_u32 s84, 0
  s_cbranch_scc1 fm_14
  v_readlane_b32 s22, v66, 0
  v_readlane_b32 s23, v66, 32
  s_add_u32 s22, s22, s23
  v_readlane_b32 s23, v66, 1
  s_add_u32 s22, s22, s23
  v_readlane_b32 s23, v66, 33
  s_add_u32 s22, s22, s23
  v_readlane_b32 s23, v66, 2
  s_add_u32 s22, s22, s23
  v_readlane_b32 s23, v66, 34
  s_add_u32 s22, s22, s23
  v_readlane_b32 s23, v66, 3
  s_add_u32 s22, s22, s23
  v_readlane_b32 s23, v66, 35
  s_add_u32 s22, s22, s23
  v_readlane_b32 s21, v66, 16
  v_cmp_gt_u32 vcc, 2, v42
  s_cmp_lt_u32 s22, 256
  s_cbranch_scc1 fm_12
  s_cmp_lt_u32 s21, 128
  s_cbranch_scc1 fm_12
  s_cbranch_vccnz fm_12
  v_readlane_b32 s21, v66, s82
  v_cmp_ne_u32 vcc, 32, v66
  s_cmp_ge_u32 s21, 32
  s_cselect_b32 s84, 1, 0
  s_andn2_b32 s53, s84, s53
  s_and_b32 s21, vcc_lo, 15
  s_and_b32 s22, vcc_hi, 15
  s_or_b32 s85, s21, s22
  s_xor_b32 s83, s76, s90
  s_lshl_b32 s70, s50, 4
  s_add_u32 s79, s70, s55
  s_add_u32 s70, s70, s51
  s_lshl_b32 s70, s70, 14
  s_lshl_b32 s79, s79, 14
  s_lshl_b32 s21, s56, 11
  s_add_u32 s79, s79, s21
  s_lshl_b32 s72, s50, 16
  s_lshl_b32 s21, s60, 10
  s_add_u32 s72, s72, s21
  s_add_u32 s72, s72, 136314880
  s_mov_b32 s74, 32768
  s_add_u32 s73, s70, s83
  s_add_u32 s70, s73, 4096
  s_add_u32 s72, s72, s83
  s_xor_b32 s21, s83, 8192
  s_add_u32 s79, s79, s21
  s_add_u32 s12, s48, 173080576
  s_addc_u32 s13, s49, 0
  s_mov_b32 s14, 49152
  s_mov_b32 s15, 0x00020000
  s_mov_b32 s16, s48
  s_mov_b32 s17, s49
  s_mov_b32 s18, 218103808
  s_mov_b32 s19, 0x00020000
  s_waitcnt lgkmcnt(0)
  s_lshl_b32 s21, s20, 16
  s_add_u32 s21, s21, s79
  buffer_load_dwordx4 v[144:147], v4, s[16:19], s21 offen sc1
  buffer_load_dwordx4 v[148:151], v4, s[16:19], s21 offen offset:1024 sc1
  v_subrev_u32 v100, 43008, v20
  v_subrev_u32 v101, 43008, v21
  buffer_load_dwordx4 v[112:115], v100, s[16:19], s73 offen sc1
  buffer_load_dwordx2 v[116:117], v101, s[16:19], s73 offen sc1
  v_and_b32 v100, 127, v19
  v_lshl_add_u32 v100, v3, 8, v100
  v_and_b32 v101, 2, v2
  v_cmp_eq_u32 vcc, 0, v101
  s_lshl_b32 s21, s20, 14
  s_lshl_b32 s22, s61, 7
  s_add_u32 s21, s21, s22
  s_add_u32 s21, s21, s72
  v_mov_b32 v152, 0x3f803f80
  v_mov_b32 v153, 0x3f803f80
  v_mov_b32 v154, 0x3f803f80
  v_mov_b32 v155, 0x3f803f80
  s_mov_b64 exec, vcc
  buffer_load_dwordx4 v[152:155], v100, s[16:19], s21 offen sc1
  s_mov_b64 exec, -1
  v_and_b32 v100, 7, v1
  v_mul_u32_u24 v100, 1280, v100
  v_lshrrev_b32 v101, 3, v1
  v_lshl_add_u32 v100, v101, 4, v100
  buffer_load_dwordx4 v[48:51], v100, s[36:39], 0 offen offset:0
  buffer_load_dwordx4 v[52:55], v100, s[36:39], 0 offen offset:128
  buffer_load_dwordx4 v[56:59], v100, s[36:39], 0 offen offset:256
  buffer_load_dwordx4 v[60:63], v100, s[36:39], 0 offen offset:384
  buffer_load_dwordx4 v[64:67], v100, s[36:39], 0 offen offset:512
  buffer_load_dwordx4 v[68:71], v100, s[36:39], 0 offen offset:640
  buffer_load_dwordx4 v[72:75], v100, s[36:39], 0 offen offset:768
  buffer_load_dwordx4 v[76:79], v100, s[36:39], 0 offen offset:896
  buffer_load_dwordx4 v[80:83], v100, s[36:39], 0 offen offset:1024
  buffer_load_dwordx4 v[84:87], v100, s[36:39], 0 offen offset:1152
  s_barrier
  s_cmp_eq_u32 s20, 3
  s_cbranch_scc1 w3_16
  ds_read_b64_tr_b16 a[160:161], v88 offset:12288
  ds_read_b64_tr_b16 a[162:163], v88 offset:12480
  ds_read_b64_tr_b16 a[164:165], v88 offset:18432
  ds_read_b64_tr_b16 a[166:167], v88 offset:18624
  ds_read_b64_tr_b16 a[168:169], v88 offset:24576
  ds_read_b64_tr_b16 a[170:171], v88 offset:24768
  ds_read_b64_tr_b16 a[172:173], v88 offset:30720
  ds_read_b64_tr_b16 a[174:175], v88 offset:30912
  ds_read_b64_tr_b16 a[176:177], v88 offset:0
  ds_read_b64_tr_b16 a[178:179], v88 offset:192
  ds_read_b64_tr_b16 a[180:181], v89 offset:12288
  ds_read_b64_tr_b16 a[182:183], v89 offset:12480
  ds_read_b64_tr_b16 a[184:185], v89 offset:18432
  ds_read_b64_tr_b16 a[186:187], v89 offset:18624
  ds_read_b64_tr_b16 a[188:189], v89 offset:24576
  ds_read_b64_tr_b16 a[190:191], v89 offset:24768
  ds_read_b64_tr_b16 a[192:193], v89 offset:30720
  ds_read_b64_tr_b16 a[194:195], v89 offset:30912
  ds_read_b64_tr_b16 a[196:197], v89 offset:0
  ds_read_b64_tr_b16 a[198:199], v89 offset:192
  ds_read_b64_tr_b16 a[200:201], v90 offset:12288
  ds_read_b64_tr_b16 a[202:203], v90 offset:12480
  ds_read_b64_tr_b16 a[204:205], v90 offset:18432
  ds_read_b64_tr_b16 a[206:207], v90 offset:18624
  ds_read_b64_tr_b16 a[208:209], v90 offset:24576
  ds_read_b64_tr_b16 a[210:211], v90 offset:24768
  ds_read_b64_tr_b16 a[212:213], v90 offset:30720
  ds_read_b64_tr_b16 a[214:215], v90 offset:30912
  ds_read_b64_tr_b16 a[216:217], v90 offset:0
  ds_read_b64_tr_b16 a[218:219], v90 offset:192
  ds_read_b64_tr_b16 a[220:221], v91 offset:12288
  ds_read_b64_tr_b16 a[222:223], v91 offset:12480
  ds_read_b64_tr_b16 a[224:225], v91 offset:18432
  ds_read_b64_tr_b16 a[226:227], v91 offset:18624
  ds_read_b64_tr_b16 a[228:229], v91 offset:24576
  ds_read_b64_tr_b16 a[230:231], v91 offset:24768
  ds_read_b64_tr_b16 a[232:233], v91 offset:30720
  ds_read_b64_tr_b16 a[234:235], v91 offset:30912
  ds_read_b64_tr_b16 a[236:237], v91 offset:0
  ds_read_b64_tr_b16 a[238:239], v91 offset:192
  ds_read_b64_tr_b16 a[240:241], v92 offset:12288
  ds_read_b64_tr_b16 a[242:243], v92 offset:12480
  ds_read_b64_tr_b16 a[244:245], v92 offset:18432
  ds_read_b64_tr_b16 a[246:247], v92 offset:18624
  ds_read_b64_tr_b16 a[248:249], v92 offset:24576
  ds_read_b64_tr_b16 a[250:251], v92 offset:24768
  ds_read_b64_tr_b16 a[252:253], v92 offset:30720
  ds_read_b64_tr_b16 a[254:255], v92 offset:30912
  ds_read_b64_tr_b16 v[192:193], v92 offset:0
  ds_read_b64_tr_b16 v[194:195], v92 offset:192
  ds_read_b64_tr_b16 v[196:197], v93 offset:12288
  ds_read_b64_tr_b16 v[198:199], v93 offset:12480
  ds_read_b64_tr_b16 v[200:201], v93 offset:18432
  ds_read_b64_tr_b16 v[202:203], v93 offset:18624
  ds_read_b64_tr_b16 v[204:205], v93 offset:24576
  ds_read_b64_tr_b16 v[206:207], v93 offset:24768
  ds_read_b64_tr_b16 v[208:209], v93 offset:30720
  ds_read_b64_tr_b16 v[210:211], v93 offset:30912
  ds_read_b64_tr_b16 v[212:213], v93 offset:0
  ds_read_b64_tr_b16 v[214:215], v93 offset:192
  ds_read_b64_tr_b16 v[216:217], v94 offset:12288
  ds_read_b64_tr_b16 v[218:219], v94 offset:12480
  ds_read_b64_tr_b16 v[220:221], v94 offset:18432
  ds_read_b64_tr_b16 v[222:223], v94 offset:18624
  ds_read_b64_tr_b16 v[224:225], v94 offset:24576
  ds_read_b64_tr_b16 v[226:227], v94 offset:24768
  ds_read_b64_tr_b16 v[228:229], v94 offset:30720
  ds_read_b64_tr_b16 v[230:231], v94 offset:30912
  ds_read_b64_tr_b16 v[232:233], v94 offset:0
  ds_read_b64_tr_b16 v[234:235], v94 offset:192
  ds_read_b64_tr_b16 v[236:237], v95 offset:12288
  ds_read_b64_tr_b16 v[238:239], v95 offset:12480
  ds_read_b64_tr_b16 v[240:241], v95 offset:18432
  ds_read_b64_tr_b16 v[242:243], v95 offset:18624
  ds_read_b64_tr_b16 v[244:245], v95 offset:24576
  ds_read_b64_tr_b16 v[246:247], v95 offset:24768
  ds_read_b64_tr_b16 v[248:249], v95 offset:30720
  ds_read_b64_tr_b16 v[250:251], v95 offset:30912
  ds_read_b64_tr_b16 v[252:253], v95 offset:0
  ds_read_b64_tr_b16 v[254:255], v95 offset:192
  s_branch w3_17
w3_16:
  ds_read_b128 a[160:163], v96 offset:36864
  ds_read_b128 a[164:167], v96 offset:37376
  ds_read_b128 a[168:171], v96 offset:37888
  ds_read_b128 a[172:175], v96 offset:38400
  ds_read_b128 a[176:179], v96 offset:38912
  ds_read_b128 a[180:183], v96 offset:39424
  ds_read_b128 a[184:187], v96 offset:39936
  ds_read_b128 a[188:191], v96 offset:40448
  ds_read_b128 a[192:195], v96 offset:6144
  ds_read_b128 a[196:199], v96 offset:6656
  ds_read_b128 a[200:203], v96 offset:7168
  ds_read_b128 a[204:207], v96 offset:7680
  ds_read_b128 a[208:211], v96 offset:8192
  ds_read_b128 a[212:215], v96 offset:8704
  ds_read_b128 a[216:219], v96 offset:9216
  ds_read_b128 a[220:223], v96 offset:9728
  ds_read_b128 a[224:227], v96 offset:10240
  ds_read_b128 a[228:231], v96 offset:10752
  ds_read_b128 a[232:235], v96 offset:11264
  ds_read_b128 a[236:239], v96 offset:11776
  ds_read_b128 a[240:243], v97 offset:36864
  ds_read_b128 a[244:247], v97 offset:37376
  ds_read_b128 a[248:251], v97 offset:37888
  ds_read_b128 a[252:255], v97 offset:38400
  ds_read_b128 v[192:195], v97 offset:38912
  ds_read_b128 v[196:199], v97 offset:39424
  ds_read_b128 v[200:203], v97 offset:39936
  ds_read_b128 v[204:207], v97 offset:40448
  ds_read_b128 v[208:211], v97 offset:6144
  ds_read_b128 v[212:215], v97 offset:6656
  ds_read_b128 v[216:219], v97 offset:7168
  ds_read_b128 v[220:223], v97 offset:7680
  ds_read_b128 v[224:227], v97 offset:8192
  ds_read_b128 v[228:231], v97 offset:8704
  ds_read_b128 v[232:235], v97 offset:9216
  ds_read_b128 v[236:239], v97 offset:9728
  ds_read_b128 v[240:243], v97 offset:10240
  ds_read_b128 v[244:247], v97 offset:10752
  ds_read_b128 v[248:251], v97 offset:11264
  ds_read_b128 v[252:255], v97 offset:11776
w3_17:
  s_cmp_eq_u32 s85, 0
  s_cbranch_scc1 fm_15
  s_cmp_eq_u32 s20, 3
  s_cbranch_scc1 ar_19
  s_mov_b64 exec, s[64:65]
  s_cmp_eq_u32 s20, 2
  s_cbranch_scc1 ar_18
  s_mov_b32 s21, 0
  buffer_store_dwordx2 v[28:29], v8, s[8:11], s21 offen sc1
  s_mov_b32 s21, 122880
  buffer_store_dwordx2 v[28:29], v8, s[8:11], s21 offen sc1
  s_mov_b32 s21, 245760
  buffer_store_dwordx2 v[28:29], v8, s[8:11], s21 offen sc1
  s_mov_b32 s21, 368640
  buffer_store_dwordx2 v[28:29], v8, s[8:11], s21 offen sc1
  s_branch ar_20
ar_18:
  s_mov_b32 s21, 0
  buffer_store_dword v28, v8, s[8:11], s21 offen sc1
  buffer_store_dword v28, v8, s[8:11], s21 offen offset:128 sc1
  s_mov_b32 s21, 122880
  buffer_store_dword v28, v8, s[8:11], s21 offen sc1
  buffer_store_dword v28, v8, s[8:11], s21 offen offset:128 sc1
  s_mov_b32 s21, 245760
  buffer_store_dword v28, v8, s[8:11], s21 offen sc1
  buffer_store_dword v28, v8, s[8:11], s21 offen offset:128 sc1
  s_mov_b32 s21, 368640
  buffer_store_dword v28, v8, s[8:11], s21 offen sc1
  buffer_store_dword v28, v8, s[8:11], s21 offen offset:128 sc1
ar_20:
  s_cmp_eq_u32 s78, 0
  s_cbranch_scc1 ar_21
  s_mov_b64 exec, s[62:63]
  s_add_u32 s21, s77, 0
  buffer_store_dword v28, v17, s[8:11], s21 offen sc1
  s_add_u32 s21, s77, 122880
  buffer_store_dword v28, v17, s[8:11], s21 offen sc1
  s_add_u32 s21, s77, 245760
  buffer_store_dword v28, v17, s[8:11], s21 offen sc1
  s_add_u32 s21, s77, 368640
  buffer_store_dword v28, v17, s[8:11], s21 offen sc1
  s_branch ar_21
ar_19:
  buffer_store_dword v28, v34, s[8:11], 0 offen sc1
  s_mov_b64 exec, s[66:67]
  s_mov_b32 s21, 0
  buffer_store_dwordx4 v[28:31], v15, s[4:7], s21 offen sc1
  s_mov_b32 s21, 262144
  buffer_store_dwordx4 v[28:31], v15, s[4:7], s21 offen sc1
  s_mov_b32 s21, 524288
  buffer_store_dwordx4 v[28:31], v15, s[4:7], s21 offen sc1
  s_mov_b32 s21, 786432
  buffer_store_dwordx4 v[28:31], v15, s[4:7], s21 offen sc1
  s_mov_b32 s21, 8192
  buffer_store_dwordx4 v[28:31], v15, s[4:7], s21 offen sc1
  s_mov_b32 s21, 270336
  buffer_store_dwordx4 v[28:31], v15, s[4:7], s21 offen sc1
  s_mov_b32 s21, 532480
  buffer_store_dwordx4 v[28:31], v15, s[4:7], s21 offen sc1
  s_mov_b32 s21, 794624
  buffer_store_dwordx4 v[28:31], v15, s[4:7], s21 offen sc1
ar_21:
  s_mov_b64 exec, -1
  s_waitcnt vmcnt(0)
  s_barrier
  s_mov_b32 s21, 100
  s_cmp_lg_u32 s20, 0
  s_cbranch_scc1 af_22
  v_mov_b32 v166, 0
  v_mov_b32 v167, 1
  s_mov_b64 exec, 1
  buffer_atomic_add v167, v166, s[32:35], s21 offen sc1
  s_mov_b64 exec, -1
  s_nop 1
af_22:
  s_cmp_lg_u32 s20, 0
  s_cbranch_scc1 wf_24
  v_mov_b32 v166, 0
  s_mov_b32 s101, 0
wf_23:
  buffer_load_dword v167, v166, s[32:35], s21 offen sc1
  s_add_u32 s101, s101, 1
  s_cmp_gt_u32 s101, 131072
  s_cbranch_scc1 end0
  s_waitcnt vmcnt(0)
  v_readfirstlane_b32 s100, v167
  s_cmp_ge_u32 s100, 128
  s_cbranch_scc1 wf_24
  s_sleep 8
  s_branch wf_23
wf_24:
  s_barrier
fm_15:
  s_xor_b32 s74, s74, 16384
  s_add_u32 s73, s73, 2097152
  s_xor_b32 s73, s73, 8192
  s_add_u32 s79, s79, 2097152
  s_xor_b32 s79, s79, 8192
  s_add_u32 s21, s72, 524288
  s_xor_b32 s72, s72, s21
  s_lshr_b32 s72, s72, 8
  s_and_b32 s72, s72, 8192
  s_xor_b32 s72, s72, s21
  s_add_u32 s71, s73, 4096
  s_mov_b32 s91, 1024
  s_sub_u32 s21, s73, 0
  s_cmp_lt_u32 s21, 125829120
  s_cselect_b32 s71, s71, s79
  s_cselect_b32 s91, s91, 65536
  v_add_u32 v15, s83, v15
  v_add_u32 v16, s83, v16
  s_mov_b32 s75, s77
  s_lshl_b32 s77, s58, 7
  s_lshl_b32 s21, s56, 3
  s_add_u32 s77, s77, s21
  s_add_u32 s77, s77, 0
  s_xor_b32 s77, s77, s83
  s_mov_b32 s80, 1400897536
  s_mov_b32 s52, 0
  s_mov_b32 s81, 0
  v_xor_b32 v18, 16384, v18
  v_xor_b32 v19, 16384, v19
  v_xor_b32 v20, 16384, v20
  v_xor_b32 v21, 16384, v21
  v_mov_b32 v168, 0x3f803f80
  v_mov_b32 v169, 0x3f803f80
  v_mov_b32 v170, 0x3f803f80
  v_mov_b32 v171, 0x3f803f80
  v_mov_b32 v166, 0x3f003f00
  v_mov_b32 v167, 0x3f003f00
  s_waitcnt lgkmcnt(0)
  s_barrier
  ds_write_b128 v23, v[168:171] offset:46080
  ds_write_b128 v23, v[168:171] offset:62464
  ds_write_b64 v23, v[166:167] offset:13568
  v_mov_b32 v88, 0
  v_mov_b32 v89, 0
  v_mov_b32 v90, 0
  v_mov_b32 v91, 0
  v_mov_b32 v92, 0
  v_mov_b32 v93, 0
  v_mov_b32 v94, 0
  v_mov_b32 v95, 0
  v_mov_b32 v96, 0
  v_mov_b32 v97, 0
  v_mov_b32 v98, 0
  v_mov_b32 v99, 0
  v_mov_b32 v100, 0
  v_mov_b32 v101, 0
  v_mov_b32 v102, 0
  v_mov_b32 v103, 0
  v_mov_b32 v110, 0
  v_mov_b32 v111, 0
  v_mov_b32 v118, 0
  v_mov_b32 v119, 0
  v_mov_b32 v142, 0
  v_mov_b32 v143, 0
  v_mov_b32 v162, 0
  v_mov_b32 v163, 0
  s_and_b32 s21, s52, 3
  s_mul_i32 s56, s21, 122880
  s_add_u32 s21, s52, 1
  s_and_b32 s21, s21, 3
  s_mul_i32 s55, s21, 122880
  s_add_u32 s55, s55, s75
  s_add_u32 s21, s52, 2
  s_and_b32 s21, s21, 3
  s_mul_i32 s57, s21, 122880
  s_add_u32 s21, s52, 3
  s_and_b32 s21, s21, 3
  s_mul_i32 s59, s21, 122880
  s_add_u32 s59, s59, s75
  s_bfe_u32 s61, s52, 0x10002
  s_and_b32 s21, s52, 3
  s_lshl_b32 s60, s21, 18
  s_mov_b32 s58, s55
  s_waitcnt lgkmcnt(0)
  s_lshl_b32 s21, s53, 2
  s_add_u32 s21, s21, s20
  s_cmp_eq_u32 s21, 0
  s_cbranch_scc1 E_25
  s_cmp_eq_u32 s21, 4
  s_cbranch_scc1 E_26
  s_cmp_eq_u32 s21, 1
  s_cbranch_scc1 E_27
  s_cmp_eq_u32 s21, 5
  s_cbranch_scc1 E_28
  s_cmp_eq_u32 s21, 2
  s_cbranch_scc1 E_29
  s_cmp_eq_u32 s21, 6
  s_cbranch_scc1 E_30
  s_cmp_eq_u32 s21, 3
  s_cbranch_scc1 E_31
  s_cmp_eq_u32 s21, 7
  s_cbranch_scc1 E_32
  s_branch end0
E_26:
  v_add_u32 v190, 0, v4
  ds_write_b64 v6, v[28:29]
  ds_write_b32 v13, v28
  ds_write_b32 v14, v28
  s_waitcnt vmcnt(0)
  ds_write_b128 v190, v[48:51] offset:0
  ds_write_b128 v190, v[52:55] offset:1024
  s_waitcnt lgkmcnt(0)
  s_add_u32 m0, s74, 4096
  s_add_u32 s21, s79, 131072
  buffer_load_dwordx4 v4, s[16:19], s21 offen offset:1024 sc1 lds
  s_add_u32 m0, s74, 9216
  s_add_u32 s21, s72, 32768
  buffer_load_dwordx4 v32, s[16:19], s21 offen sc1 lds
  s_xor_b32 s74, s74, 16384
  s_add_u32 s73, s73, 2097152
  s_xor_b32 s73, s73, 8192
  s_add_u32 s79, s79, 2097152
  s_xor_b32 s79, s79, 8192
  s_add_u32 s21, s72, 524288
  s_xor_b32 s72, s72, s21
  s_lshr_b32 s72, s72, 8
  s_and_b32 s72, s72, 8192
  s_xor_b32 s72, s72, s21
  s_add_u32 s71, s73, 4096
  s_mov_b32 s91, 1024
  s_sub_u32 s21, s73, 0
  s_cmp_lt_u32 s21, 125829120
  s_cselect_b32 s71, s71, s79
  s_cselect_b32 s91, s91, 65536
  s_branch mo_38
  .p2align 3
top_33:
  s_waitcnt vmcnt(1)
  ds_write_b128 v190, v[48:51] offset:0
  v_cmp_eq_u32 s[22:23], -1, v48
  s_waitcnt vmcnt(0)
  ds_write_b128 v190, v[52:55] offset:1024
  v_cmp_eq_u32 s[98:99], -1, v52
  s_or_b64 vcc, s[22:23], s[98:99]
  s_cbranch_scc1 mr_34
mo_38:
  s_barrier
  ds_read_b128 v[56:59], v4 offset:2048
  ds_read_b128 v[60:63], v4 offset:3072
  v_smfmac_f32_16x16x64_bf16 v[92:95], v[48:51], a[240:247], v22
  ds_read_b128 v[64:67], v4 offset:4096
  v_smfmac_f32_16x16x64_bf16 v[88:91], v[48:51], a[160:167], v22
  ds_read_b128 v[68:71], v4 offset:5120
  v_smfmac_f32_16x16x64_bf16 v[92:95], v[52:55], a[248:255], v22
  ds_read_b128 v[72:75], v4 offset:6144
  v_smfmac_f32_16x16x64_bf16 v[88:91], v[52:55], a[168:175], v22
  s_waitcnt lgkmcnt(4)
  ds_read_b128 v[76:79], v4 offset:7168
  v_smfmac_f32_16x16x64_bf16 v[92:95], v[56:59], v[192:199], v22
  ds_read_b128 v[80:83], v4 offset:8192
  v_smfmac_f32_16x16x64_bf16 v[88:91], v[56:59], a[176:183], v22
  s_waitcnt lgkmcnt(5)
  ds_read_b128 v[84:87], v4 offset:9216
  v_smfmac_f32_16x16x64_bf16 v[92:95], v[60:63], v[200:207], v22
  v_smfmac_f32_16x16x64_bf16 v[88:91], v[60:63], a[184:191], v22
  s_waitcnt lgkmcnt(5)
  v_smfmac_f32_16x16x64_bf16 v[92:95], v[64:67], v[208:215], v22
  s_waitcnt lgkmcnt(4)
  v_smfmac_f32_16x16x64_bf16 v[92:95], v[68:71], v[216:223], v22
  s_waitcnt lgkmcnt(3)
  v_smfmac_f32_16x16x64_bf16 v[92:95], v[72:75], v[224:231], v22
  s_waitcnt lgkmcnt(2)
  v_smfmac_f32_16x16x64_bf16 v[92:95], v[76:79], v[232:239], v22
  s_waitcnt lgkmcnt(1)
  v_smfmac_f32_16x16x64_bf16 v[92:95], v[80:83], v[240:247], v22
  s_waitcnt lgkmcnt(0)
  v_smfmac_f32_16x16x64_bf16 v[92:95], v[84:87], v[248:255], v22
  v_smfmac_f32_16x16x64_bf16 v[88:91], v[64:67], a[192:199], v22
  v_smfmac_f32_16x16x64_bf16 v[88:91], v[68:71], a[200:207], v22
  v_smfmac_f32_16x16x64_bf16 v[88:91], v[72:75], a[208:215], v22
  v_permlane32_swap_b32 v92, v93
  v_smfmac_f32_16x16x64_bf16 v[88:91], v[76:79], a[216:223], v22
  v_permlane32_swap_b32 v94, v95
  v_smfmac_f32_16x16x64_bf16 v[88:91], v[80:83], a[224:231], v22
  v_permlane32_swap_b32 v93, v92
  v_smfmac_f32_16x16x64_bf16 v[88:91], v[84:87], a[232:239], v22
  v_permlane32_swap_b32 v95, v94
  v_pk_mul_f32 v[120:121], v[92:93], v[24:25] op_sel:[1,0] op_sel_hi:[0,1]
  v_pk_mul_f32 v[122:123], v[94:95], v[24:25] op_sel:[1,0] op_sel_hi:[0,1]
  s_nop 4
  v_pk_fma_f32 v[88:89], v[88:89], v[24:25], v[120:121]
  v_pk_fma_f32 v[90:91], v[90:91], v[24:25], v[122:123]
  v_cvt_pk_bf16_f32 v120, v88, v89
  v_cvt_pk_bf16_f32 v121, v90, v91
  ds_write_b64 v6, v[120:121]
  s_barrier
  ds_read_b64_tr_b16 v[104:105], v7 offset:0
  ds_read_b64_tr_b16 v[106:107], v7 offset:768
  ds_read_b64_tr_b16 v[108:109], v7 offset:1536
  s_waitcnt lgkmcnt(1)
  v_mfma_f32_16x16x32_bf16 v[120:123], v[112:115], v[104:107], 0
  s_waitcnt lgkmcnt(0)
  v_mfma_f32_16x16x32_bf16 v[120:123], v[116:119], v[108:111], v[120:123]
  s_mov_b64 exec, s[64:65]
  s_nop 6
  v_cmpx_o_f32 vcc, v120, v121
  v_cvt_pk_f16_f32 v120, v120, v121
  v_cvt_pk_f16_f32 v121, v122, v123
  buffer_store_dwordx2 v[120:121], v8, s[8:11], s56 offen
  s_xor_b64 s[98:99], exec, s[64:65]
  s_mov_b64 exec, -1
  s_waitcnt lgkmcnt(0)
  s_barrier
  ds_read_b64_tr_b16 v[104:105], v7 offset:0
  ds_read_b64_tr_b16 v[106:107], v7 offset:768
  ds_read_b64_tr_b16 v[108:109], v7 offset:1536
  ds_read_b32 v27, v12 offset:12544
  ds_read_b64 v[140:141], v11
  s_waitcnt lgkmcnt(1)
  v_cmp_u_f32 vcc, v104, v106
  v_cmp_u_f32 s[22:23], v108, v27
  s_nop 1
  s_or_b64 vcc, vcc, s[22:23]
  s_cbranch_vccnz mn_35
mk_36:
  s_cmp_eq_u32 s52, 63
  s_cbranch_scc1 last_37
  s_cmp_lg_u64 s[98:99], 0
  s_cbranch_scc1 sf_39
sf_40:
  s_nop 15
  s_nop 10
  v_smfmac_f32_16x16x64_bf16 v[96:99], v[48:51], a[0:7], v22
  v_smfmac_f32_16x16x64_bf16 v[100:103], v[48:51], a[80:87], v22
  v_smfmac_f32_16x16x64_bf16 v[96:99], v[52:55], a[8:15], v22
  v_smfmac_f32_16x16x64_bf16 v[100:103], v[52:55], a[88:95], v22
  v_smfmac_f32_16x16x64_bf16 v[96:99], v[56:59], a[16:23], v22
  v_smfmac_f32_16x16x64_bf16 v[100:103], v[56:59], a[96:103], v22
  buffer_load_dwordx4 v[132:135], v10, s[8:11], s56 offen sc1
  v_smfmac_f32_16x16x64_bf16 v[96:99], v[60:63], a[24:31], v22
  buffer_load_dwordx4 v[124:127], v9, s[8:11], s56 offen sc1
  v_smfmac_f32_16x16x64_bf16 v[96:99], v[64:67], a[32:39], v22
  buffer_load_dwordx4 v[128:131], v9, s[8:11], s56 offen offset:1024 sc1
  v_smfmac_f32_16x16x64_bf16 v[96:99], v[68:71], a[40:47], v22
  v_smfmac_f32_16x16x64_bf16 v[96:99], v[72:75], a[48:55], v22
  v_smfmac_f32_16x16x64_bf16 v[96:99], v[76:79], a[56:63], v22
  v_smfmac_f32_16x16x64_bf16 v[96:99], v[80:83], a[64:71], v22
  v_smfmac_f32_16x16x64_bf16 v[96:99], v[84:87], a[72:79], v22
  v_smfmac_f32_16x16x64_bf16 v[100:103], v[60:63], a[104:111], v22
  v_smfmac_f32_16x16x64_bf16 v[100:103], v[64:67], a[112:119], v22
  v_smfmac_f32_16x16x64_bf16 v[100:103], v[68:71], a[120:127], v22
  v_smfmac_f32_16x16x64_bf16 v[100:103], v[72:75], a[128:135], v22
  v_cvt_pk_bf16_f32 v136, v96, v97
  v_smfmac_f32_16x16x64_bf16 v[100:103], v[76:79], a[136:143], v22
  v_cvt_pk_bf16_f32 v137, v98, v99
  v_smfmac_f32_16x16x64_bf16 v[100:103], v[80:83], a[144:151], v22
  v_smfmac_f32_16x16x64_bf16 v[100:103], v[84:87], a[152:159], v22
  s_nop 7
  v_cvt_pk_bf16_f32 v138, v100, v101
  v_cvt_pk_bf16_f32 v139, v102, v103
  s_waitcnt vmcnt(2) lgkmcnt(0)
  v_pk_add_f16 v164, v132, v133
  v_pk_add_f16 v165, v134, v135
  v_fma_mix_f32 v170, v164, 1.0, v165 op_sel:[0,0,0] op_sel_hi:[1,0,1]
  v_fma_mix_f32 v171, v164, 1.0, v165 op_sel:[1,0,1] op_sel_hi:[1,0,1]
  v_exp_f32 v176, v170
  v_exp_f32 v177, v171
  s_waitcnt vmcnt(1)
  v_cvt_pk_bf16_f32 v160, v176, v177
  v_pk_add_f16 v120, v124, v126
  v_pk_add_f16 v121, v125, v127
  v_mov_b32_dpp v161, v160 row_ror:8 row_mask:0xf bank_mask:0xf
  s_waitcnt vmcnt(0)
  v_pk_add_f16 v122, v128, v130
  v_mfma_f32_16x16x32_bf16 v[178:181], v[140:143], v[160:163], 0
  v_fma_mix_f32 v166, v120, 1.0, v122 op_sel:[0,0,0] op_sel_hi:[1,0,1]
  v_fma_mix_f32 v167, v120, 1.0, v122 op_sel:[1,0,1] op_sel_hi:[1,0,1]
  v_cmp_u_f32 vcc, v166, v170
  v_pk_add_f16 v123, v129, v131
  v_exp_f32 v172, v166
  v_mfma_f32_16x16x32_bf16 v[182:185], v[136:139], v[160:163], 0
  s_cbranch_vccnz sr_41
  v_exp_f32 v173, v167
  v_fma_mix_f32 v168, v121, 1.0, v123 op_sel:[0,0,0] op_sel_hi:[1,0,1]
  v_fma_mix_f32 v169, v121, 1.0, v123 op_sel:[1,0,1] op_sel_hi:[1,0,1]
  v_cvt_pk_bf16_f32 v156, v172, v173
  v_exp_f32 v174, v168
  v_exp_f32 v175, v169
  v_mov_b32_dpp v158, v156 row_ror:8 row_mask:0xf bank_mask:0xf
  v_cvt_pk_bf16_f32 v157, v174, v175
  v_mfma_f32_16x16x32_bf16 v[186:189], v[138:141], v[160:163], 0
  s_nop 0
  v_mov_b32_dpp v159, v157 row_ror:8 row_mask:0xf bank_mask:0xf
  s_nop 1
pv_42:
  v_mfma_f32_16x16x32_bf16 v[178:181], v[152:155], v[156:159], v[178:181]
  v_mfma_f32_16x16x32_bf16 v[182:185], v[144:147], v[156:159], v[182:185]
  v_mfma_f32_16x16x32_bf16 v[186:189], v[148:151], v[156:159], v[186:189]
  s_mov_b64 exec, s[62:63]
  s_nop 0
  v_rcp_f32 v164, v180
  v_cmp_ngt_f32 s[22:23], s80, v180
  v_cmp_ngt_f32 vcc, s80, v164
  v_pk_mul_f32 v[182:183], v[182:183], v[164:165] op_sel_hi:[1,0]
  v_pk_mul_f32 v[184:185], v[184:185], v[164:165] op_sel_hi:[1,0]
  v_pk_mul_f32 v[178:179], v[178:179], v[164:165] op_sel_hi:[1,0]
  v_pk_mul_f32 v[186:187], v[186:187], v[164:165] op_sel_hi:[1,0]
  v_pk_mul_f32 v[188:189], v[188:189], v[164:165] op_sel_hi:[1,0]
  v_cvt_pk_f16_f32 v64, v178, v179
  s_or_b64 vcc, vcc, s[22:23]
  s_cbranch_scc1 fx_44
fk_45:
  ds_write_b32 v14, v64
  v_cvt_pk_f16_f32 v60, v182, v183
  v_cvt_pk_f16_f32 v61, v184, v185
  v_cvt_pk_f16_f32 v62, v186, v187
  v_cvt_pk_f16_f32 v63, v188, v189
  ds_write_b128 v13, v[60:63]
  s_barrier
  s_mov_b64 exec, -1
  s_add_u32 m0, s74, 4096
  s_add_u32 s21, s79, 131072
  buffer_load_dwordx4 v4, s[16:19], s21 offen offset:1024 sc1 lds
  s_add_u32 m0, s74, 9216
  s_add_u32 s21, s72, 32768
  buffer_load_dwordx4 v32, s[16:19], s21 offen sc1 lds
  s_xor_b32 s74, s74, 16384
  s_add_u32 s73, s73, 2097152
  s_xor_b32 s73, s73, 8192
  s_add_u32 s79, s79, 2097152
  s_xor_b32 s79, s79, 8192
  s_add_u32 s21, s72, 524288
  s_xor_b32 s72, s72, s21
  s_lshr_b32 s72, s72, 8
  s_and_b32 s72, s72, 8192
  s_xor_b32 s72, s72, s21
  s_add_u32 s71, s73, 4096
  s_mov_b32 s91, 1024
  s_sub_u32 s21, s73, 0
  s_cmp_lt_u32 s21, 125829120
  s_cselect_b32 s71, s71, s79
  s_cselect_b32 s91, s91, 65536
  v_permlane32_swap_b32 v96, v100
  v_permlane32_swap_b32 v97, v101
  v_permlane32_swap_b32 v98, v102
  v_permlane32_swap_b32 v99, v103
  v_pk_add_f32 v[96:97], v[96:97], v[100:101]
  v_pk_add_f32 v[98:99], v[98:99], v[102:103]
  v_cvt_pk_bf16_f32 v100, v96, v97
  v_cvt_pk_bf16_f32 v101, v98, v99
  s_nop 0
  v_permlane32_swap_b32 v100, v102
  v_permlane32_swap_b32 v101, v103
  v_min_u32 v100, -2, v100
  s_nop 6
  buffer_store_dwordx4 v[100:103], v26, s[16:19], s70 offen sc1
  v_min_u32 v104, -2, v104
  buffer_store_dwordx4 v[104:107], v36, s[16:19], s70 offen offset:2560 sc1
  s_add_u32 s70, s70, 2097152
  s_xor_b32 s70, s70, 8192
  ds_read_b128 v[144:147], v18
  ds_read_b128 v[148:151], v18 offset:1024
  ds_read_b128 v[152:155], v19
  ds_read_b128 v[112:115], v20
  ds_read_b64 v[116:117], v21
  v_xor_b32 v18, 16384, v18
  v_xor_b32 v19, 16384, v19
  v_xor_b32 v20, 16384, v20
  v_xor_b32 v21, 16384, v21
  v_mov_b32 v88, 0
  v_mov_b32 v89, 0
  v_mov_b32 v90, 0
  v_mov_b32 v91, 0
  v_mov_b32 v92, 0
  v_mov_b32 v93, 0
  v_mov_b32 v94, 0
  v_mov_b32 v95, 0
  v_mov_b32 v96, 0
  v_mov_b32 v97, 0
  v_mov_b32 v98, 0
  v_mov_b32 v99, 0
  v_mov_b32 v100, 0
  v_mov_b32 v101, 0
  v_mov_b32 v102, 0
  v_mov_b32 v103, 0
  s_mov_b32 s81, 0
  s_waitcnt lgkmcnt(0)
  s_barrier
  s_mov_b64 exec, s[64:65]
  buffer_store_dwordx2 v[28:29], v8, s[8:11], s57 offen
  s_mov_b64 exec, -1
  ds_write_b128 v190, v[28:31] offset:0
  ds_write_b128 v190, v[28:31] offset:1024
  ds_write_b64 v6, v[28:29]
  s_mov_b64 exec, s[62:63]
  buffer_store_dword v28, v17, s[8:11], s59 offen
  s_mov_b64 exec, -1
  s_sleep 3
  s_nop 1
  buffer_load_dwordx4 v[68:71], v16, s[4:7], s60 offen sc1
  s_sleep 3
  s_nop 1
  buffer_load_dwordx4 v[72:75], v16, s[4:7], s60 offen sc1
  s_waitcnt vmcnt(1)
  v_mfma_f32_16x16x32_f16 v[120:123], v[44:47], v[68:71], 0
  v_bitop3_b32 v27, v68, s61, 1 bitop3:0x28
  v_cmp_ne_u32 vcc, 0, v27
  s_nop 1
  s_cbranch_vccnz p2_50
  s_nop 2
pg_49:
  v_add_f32_dpp v120, v120, v120 row_ror:8 row_mask:0xf bank_mask:0xf
  v_add_f32_dpp v121, v121, v121 row_ror:8 row_mask:0xf bank_mask:0xf
  s_mov_b64 exec, s[62:63]
  v_cvt_pk_bf16_f32 v120, v120, v121
  v_min_u32 v120, -2, v120
  buffer_store_dword v120, v17, s[8:11], s55 offen
  s_mov_b64 exec, -1
nt_46:
  s_barrier
  s_mov_b32 s58, s55
  s_add_u32 s52, s52, 1
  ds_write_b32 v13, v28
  ds_write_b32 v14, v28
  s_and_b32 s21, s52, 3
  s_mul_i32 s56, s21, 122880
  s_add_u32 s21, s52, 1
  s_and_b32 s21, s21, 3
  s_mul_i32 s55, s21, 122880
  s_add_u32 s55, s55, s75
  s_add_u32 s21, s52, 2
  s_and_b32 s21, s21, 3
  s_mul_i32 s57, s21, 122880
  s_add_u32 s21, s52, 3
  s_and_b32 s21, s21, 3
  s_mul_i32 s59, s21, 122880
  s_add_u32 s59, s59, s75
  s_bfe_u32 s61, s52, 0x10002
  s_and_b32 s21, s52, 3
  s_lshl_b32 s60, s21, 18
  s_mov_b32 s54, 0
  s_sleep 2
  s_nop 10
  s_waitcnt lgkmcnt(0)
  buffer_load_dwordx4 v[48:51], v190, s[8:11], s58 offen offset:0 sc1
  buffer_load_dwordx4 v[52:55], v190, s[8:11], s58 offen offset:1024 sc1
  s_branch top_33
mr_34:
  s_mov_b64 exec, s[22:23]
  s_cbranch_execz ms_51
  buffer_load_dwordx4 v[48:51], v190, s[8:11], s58 offen offset:0 sc1
ms_51:
  s_mov_b64 exec, s[98:99]
  s_cbranch_execz ms_52
  buffer_load_dwordx4 v[52:55], v190, s[8:11], s58 offen offset:1024 sc1
ms_52:
  s_add_u32 s54, s54, 1
  s_cmp_gt_u32 s54, 131072
  s_cbranch_scc1 end0
  s_waitcnt vmcnt(0)
  s_mov_b64 exec, s[22:23]
  ds_write_b128 v190, v[48:51] offset:0
  v_cmp_eq_u32 s[22:23], -1, v48
  s_mov_b64 exec, s[98:99]
  ds_write_b128 v190, v[52:55] offset:1024
  v_cmp_eq_u32 s[98:99], -1, v52
  s_mov_b64 exec, -1
  s_or_b64 vcc, s[22:23], s[98:99]
  s_cbranch_scc1 mr_34
  s_branch mo_38
sf_39:
  s_waitcnt lgkmcnt(1)
  v_mfma_f32_16x16x32_bf16 v[120:123], v[112:115], v[104:107], 0
  s_waitcnt lgkmcnt(0)
  v_mfma_f32_16x16x32_bf16 v[120:123], v[116:119], v[108:111], v[120:123]
  s_mov_b64 exec, s[64:65]
  s_nop 6
  v_cvt_pk_f16_f32 v120, v120, v121
  v_cvt_pk_f16_f32 v121, v122, v123
  buffer_store_dwordx2 v[120:121], v8, s[8:11], s56 offen
  s_mov_b64 exec, -1
  s_branch sf_40
mn_35:
  s_bitcmp1_b32 s81, 1
  s_cbranch_scc1 mk_36
  s_or_b32 s81, s81, 2
  s_nop 7
  v_mov_b32 v88, 0
  v_mov_b32 v89, 0
  v_mov_b32 v90, 0
  v_mov_b32 v91, 0
  v_mov_b32 v92, 0
  v_mov_b32 v93, 0
  v_mov_b32 v94, 0
  v_mov_b32 v95, 0
  v_mov_b32 v96, 0
  v_mov_b32 v97, 0
  v_mov_b32 v98, 0
  v_mov_b32 v99, 0
  v_mov_b32 v100, 0
  v_mov_b32 v101, 0
  v_mov_b32 v102, 0
  v_mov_b32 v103, 0
  s_cmp_eq_u32 s52, 0
  s_cbranch_scc1 mx_54
mx_53:
  buffer_load_dwordx4 v[48:51], v190, s[8:11], s58 offen offset:0 sc1
  buffer_load_dwordx4 v[52:55], v190, s[8:11], s58 offen offset:1024 sc1
  s_add_u32 s54, s54, 1
  s_cmp_gt_u32 s54, 131072
  s_cbranch_scc1 end0
  s_waitcnt vmcnt(0)
  v_max3_u32 v27, v48, v49, v50
  v_max3_u32 v27, v27, v51, v52
  v_max3_u32 v27, v27, v53, v54
  v_max3_u32 v27, v27, v55, v55
  v_cmp_eq_u32 vcc, -1, v27
  s_nop 1
  s_cbranch_vccnz mx_53
  ds_write_b128 v190, v[48:51] offset:0
  ds_write_b128 v190, v[52:55] offset:1024
mx_54:
  s_waitcnt lgkmcnt(0)
  s_branch mo_38
sr_41:
  s_mov_b32 s54, 0
sr_55:
  s_mov_b64 exec, vcc
  buffer_load_dwordx4 v[124:127], v9, s[8:11], s56 offen sc1
  buffer_load_dwordx4 v[128:131], v9, s[8:11], s56 offen offset:1024 sc1
  buffer_load_dwordx4 v[132:135], v10, s[8:11], s56 offen sc1
  s_mov_b64 exec, -1
  s_add_u32 s54, s54, 1
  s_cmp_gt_u32 s54, 131072
  s_cbranch_scc1 end0
  s_waitcnt vmcnt(0)
  v_pk_add_f16 v164, v132, v133
  v_pk_add_f16 v165, v134, v135
  v_pk_add_f16 v120, v124, v126
  v_pk_add_f16 v122, v128, v130
  v_fma_mix_f32 v170, v164, 1.0, v165 op_sel:[0,0,0] op_sel_hi:[1,0,1]
  v_fma_mix_f32 v166, v120, 1.0, v122 op_sel:[0,0,0] op_sel_hi:[1,0,1]
  v_pk_add_f16 v121, v125, v127
  v_cmp_u_f32 vcc, v166, v170
  v_pk_add_f16 v123, v129, v131
  v_fma_mix_f32 v171, v164, 1.0, v165 op_sel:[1,0,1] op_sel_hi:[1,0,1]
  v_fma_mix_f32 v167, v120, 1.0, v122 op_sel:[1,0,1] op_sel_hi:[1,0,1]
  v_fma_mix_f32 v168, v121, 1.0, v123 op_sel:[0,0,0] op_sel_hi:[1,0,1]
  v_fma_mix_f32 v169, v121, 1.0, v123 op_sel:[1,0,1] op_sel_hi:[1,0,1]
  s_cbranch_vccz ex_43
  s_and_b32 s21, s54, 31
  s_cbranch_scc1 sr_55
  v_max3_u32 v27, v124, v126, v128
  v_max3_u32 v27, v27, v130, v132
  v_max3_u32 v27, v27, v133, v134
  v_max3_u32 v27, v27, v135, v135
  v_cmp_eq_u32 vcc, -1, v27
  s_nop 1
  s_cbranch_vccnz sr_55
ex_43:
  v_exp_f32 v176, v170
  v_exp_f32 v177, v171
  v_exp_f32 v172, v166
  v_cvt_pk_bf16_f32 v160, v176, v177
  v_exp_f32 v173, v167
  v_exp_f32 v174, v168
  v_mov_b32_dpp v161, v160 row_ror:8 row_mask:0xf bank_mask:0xf
  v_cvt_pk_bf16_f32 v156, v172, v173
  v_exp_f32 v175, v169
  v_mfma_f32_16x16x32_bf16 v[178:181], v[140:143], v[160:163], 0
  v_mov_b32_dpp v158, v156 row_ror:8 row_mask:0xf bank_mask:0xf
  v_cvt_pk_bf16_f32 v157, v174, v175
  v_mfma_f32_16x16x32_bf16 v[182:185], v[136:139], v[160:163], 0
  s_nop 0
  v_mov_b32_dpp v159, v157 row_ror:8 row_mask:0xf bank_mask:0xf
  v_mfma_f32_16x16x32_bf16 v[186:189], v[138:141], v[160:163], 0
  s_branch pv_42
fx_44:
  s_bitcmp1_b32 s81, 0
  s_cbranch_scc1 fk_45
  s_or_b32 s81, s81, 1
  s_mov_b64 exec, -1
  v_max3_f32 v164, v166, v167, v168
  v_max3_f32 v165, v169, v170, v171
  v_max_f32 v164, v164, v165
  s_nop 1
  v_max_f32_dpp v164, v164, v164 row_ror:8 row_mask:0xf bank_mask:0xf
  v_mov_b32 v165, v164
  s_nop 1
  v_permlane32_swap_b32 v164, v165
  v_max_f32 v164, v164, v165
  v_mov_b32 v165, v164
  s_nop 1
  v_permlane16_swap_b32 v164, v165
  v_max_f32 v164, v164, v165
  v_sub_f32 v166, v166, v164
  v_sub_f32 v167, v167, v164
  v_sub_f32 v168, v168, v164
  v_sub_f32 v169, v169, v164
  v_sub_f32 v170, v170, v164
  v_sub_f32 v171, v171, v164
  s_branch ex_43
p2_50:
  s_mov_b32 s54, 0
  buffer_load_dwordx4 v[68:71], v16, s[4:7], s60 offen sc1
  s_waitcnt vmcnt(1)
  v_mfma_f32_16x16x32_f16 v[120:123], v[44:47], v[72:75], 0
  v_bitop3_b32 v27, v72, s61, 1 bitop3:0x28
  v_cmp_ne_u32 vcc, 0, v27
  s_nop 1
  s_cbranch_vccz pg_49
  buffer_load_dwordx4 v[72:75], v16, s[4:7], s60 offen sc1
pp_48:
  s_waitcnt vmcnt(1)
  v_mfma_f32_16x16x32_f16 v[120:123], v[44:47], v[68:71], 0
  v_bitop3_b32 v27, v68, s61, 1 bitop3:0x28
  v_cmp_ne_u32 vcc, 0, v27
  s_nop 1
  s_cbranch_vccz pg_49
  buffer_load_dwordx4 v[68:71], v16, s[4:7], s60 offen sc1
  s_waitcnt vmcnt(1)
  v_mfma_f32_16x16x32_f16 v[120:123], v[44:47], v[72:75], 0
  v_bitop3_b32 v27, v72, s61, 1 bitop3:0x28
  v_cmp_ne_u32 vcc, 0, v27
  s_nop 1
  s_cbranch_vccz pg_49
  buffer_load_dwordx4 v[72:75], v16, s[4:7], s60 offen sc1
  s_add_u32 s54, s54, 1
  s_cmp_gt_u32 s54, 131072
  s_cbranch_scc1 end0
  s_branch pp_48
last_37:
  v_min_u32 v104, -2, v104
  buffer_store_dwordx4 v[104:107], v36, s[16:19], s70 offen offset:2560 sc1
  v_smfmac_f32_16x16x64_bf16 v[96:99], v[48:51], a[0:7], v22
  v_smfmac_f32_16x16x64_bf16 v[100:103], v[48:51], a[80:87], v22
  v_smfmac_f32_16x16x64_bf16 v[96:99], v[52:55], a[8:15], v22
  v_smfmac_f32_16x16x64_bf16 v[100:103], v[52:55], a[88:95], v22
  v_smfmac_f32_16x16x64_bf16 v[96:99], v[56:59], a[16:23], v22
  v_smfmac_f32_16x16x64_bf16 v[100:103], v[56:59], a[96:103], v22
  v_smfmac_f32_16x16x64_bf16 v[96:99], v[60:63], a[24:31], v22
  v_smfmac_f32_16x16x64_bf16 v[96:99], v[64:67], a[32:39], v22
  v_smfmac_f32_16x16x64_bf16 v[96:99], v[68:71], a[40:47], v22
  v_smfmac_f32_16x16x64_bf16 v[96:99], v[72:75], a[48:55], v22
  v_smfmac_f32_16x16x64_bf16 v[96:99], v[76:79], a[56:63], v22
  v_smfmac_f32_16x16x64_bf16 v[96:99], v[80:83], a[64:71], v22
  v_smfmac_f32_16x16x64_bf16 v[96:99], v[84:87], a[72:79], v22
  v_smfmac_f32_16x16x64_bf16 v[100:103], v[60:63], a[104:111], v22
  v_smfmac_f32_16x16x64_bf16 v[100:103], v[64:67], a[112:119], v22
  v_smfmac_f32_16x16x64_bf16 v[100:103], v[68:71], a[120:127], v22
  v_smfmac_f32_16x16x64_bf16 v[100:103], v[72:75], a[128:135], v22
  v_smfmac_f32_16x16x64_bf16 v[100:103], v[76:79], a[136:143], v22
  v_smfmac_f32_16x16x64_bf16 v[100:103], v[80:83], a[144:151], v22
  v_smfmac_f32_16x16x64_bf16 v[100:103], v[84:87], a[152:159], v22
  s_nop 7
  v_permlane32_swap_b32 v96, v100
  v_permlane32_swap_b32 v97, v101
  v_permlane32_swap_b32 v98, v102
  v_permlane32_swap_b32 v99, v103
  v_pk_add_f32 v[96:97], v[96:97], v[100:101]
  v_pk_add_f32 v[98:99], v[98:99], v[102:103]
  v_cvt_pk_bf16_f32 v100, v96, v97
  v_cvt_pk_bf16_f32 v101, v98, v99
  s_nop 0
  v_permlane32_swap_b32 v100, v102
  v_permlane32_swap_b32 v101, v103
  v_min_u32 v100, -2, v100
  buffer_store_dwordx4 v[100:103], v26, s[16:19], s70 offen sc1
  s_waitcnt vmcnt(0)
  s_barrier
  s_branch chain_done
E_28:
  v_add_u32 v190, 2048, v4
  ds_write_b64 v6, v[28:29]
  ds_write_b32 v13, v28
  ds_write_b32 v14, v28
  s_waitcnt vmcnt(0)
  ds_write_b128 v190, v[56:59] offset:0
  ds_write_b128 v190, v[60:63] offset:1024
  ds_write_b128 v190, v[64:67] offset:2048
  s_waitcnt lgkmcnt(0)
  s_add_u32 m0, s74, 6144
  s_add_u32 s21, s79, 196608
  buffer_load_dwordx4 v4, s[16:19], s21 offen offset:1024 sc1 lds
  s_add_u32 m0, s74, 4096
  s_mul_i32 s21, s91, 2
  s_add_u32 s21, s21, s71
  buffer_load_dwordx4 v4, s[16:19], s21 offen sc1 lds
  s_xor_b32 s74, s74, 16384
  s_add_u32 s73, s73, 2097152
  s_xor_b32 s73, s73, 8192
  s_add_u32 s79, s79, 2097152
  s_xor_b32 s79, s79, 8192
  s_add_u32 s21, s72, 524288
  s_xor_b32 s72, s72, s21
  s_lshr_b32 s72, s72, 8
  s_and_b32 s72, s72, 8192
  s_xor_b32 s72, s72, s21
  s_add_u32 s71, s73, 4096
  s_mov_b32 s91, 1024
  s_sub_u32 s21, s73, 0
  s_cmp_lt_u32 s21, 125829120
  s_cselect_b32 s71, s71, s79
  s_cselect_b32 s91, s91, 65536
  s_branch mo_62
  .p2align 3
top_57:
  s_waitcnt vmcnt(2)
  ds_write_b128 v190, v[56:59] offset:0
  v_cmp_eq_u32 s[22:23], -1, v56
  s_waitcnt vmcnt(1)
  ds_write_b128 v190, v[60:63] offset:1024
  v_cmp_eq_u32 s[98:99], -1, v60
  s_waitcnt vmcnt(0)
  ds_write_b128 v190, v[64:67] offset:2048
  v_cmp_eq_u32 s[100:101], -1, v64
  s_or_b64 vcc, s[22:23], s[98:99]
  s_or_b64 vcc, vcc, s[100:101]
  s_cbranch_scc1 mr_58
mo_62:
  s_barrier
  ds_read_b128 v[48:51], v4 offset:0
  ds_read_b128 v[52:55], v4 offset:1024
  v_smfmac_f32_16x16x64_bf16 v[92:95], v[56:59], v[192:199], v22
  ds_read_b128 v[68:71], v4 offset:5120
  v_smfmac_f32_16x16x64_bf16 v[88:91], v[56:59], a[176:183], v22
  ds_read_b128 v[72:75], v4 offset:6144
  v_smfmac_f32_16x16x64_bf16 v[92:95], v[60:63], v[200:207], v22
  ds_read_b128 v[76:79], v4 offset:7168
  v_smfmac_f32_16x16x64_bf16 v[88:91], v[60:63], a[184:191], v22
  ds_read_b128 v[80:83], v4 offset:8192
  v_smfmac_f32_16x16x64_bf16 v[92:95], v[64:67], v[208:215], v22
  ds_read_b128 v[84:87], v4 offset:9216
  v_smfmac_f32_16x16x64_bf16 v[88:91], v[64:67], a[192:199], v22
  s_waitcnt lgkmcnt(6)
  v_smfmac_f32_16x16x64_bf16 v[92:95], v[48:51], a[240:247], v22
  v_smfmac_f32_16x16x64_bf16 v[88:91], v[48:51], a[160:167], v22
  s_waitcnt lgkmcnt(5)
  v_smfmac_f32_16x16x64_bf16 v[92:95], v[52:55], a[248:255], v22
  s_waitcnt lgkmcnt(4)
  v_smfmac_f32_16x16x64_bf16 v[92:95], v[68:71], v[216:223], v22
  s_waitcnt lgkmcnt(3)
  v_smfmac_f32_16x16x64_bf16 v[92:95], v[72:75], v[224:231], v22
  s_waitcnt lgkmcnt(2)
  v_smfmac_f32_16x16x64_bf16 v[92:95], v[76:79], v[232:239], v22
  s_waitcnt lgkmcnt(1)
  v_smfmac_f32_16x16x64_bf16 v[92:95], v[80:83], v[240:247], v22
  s_waitcnt lgkmcnt(0)
  v_smfmac_f32_16x16x64_bf16 v[92:95], v[84:87], v[248:255], v22
  v_smfmac_f32_16x16x64_bf16 v[88:91], v[52:55], a[168:175], v22
  v_smfmac_f32_16x16x64_bf16 v[88:91], v[68:71], a[200:207], v22
  v_smfmac_f32_16x16x64_bf16 v[88:91], v[72:75], a[208:215], v22
  v_permlane32_swap_b32 v92, v93
  v_smfmac_f32_16x16x64_bf16 v[88:91], v[76:79], a[216:223], v22
  v_permlane32_swap_b32 v94, v95
  v_smfmac_f32_16x16x64_bf16 v[88:91], v[80:83], a[224:231], v22
  v_permlane32_swap_b32 v93, v92
  v_smfmac_f32_16x16x64_bf16 v[88:91], v[84:87], a[232:239], v22
  v_permlane32_swap_b32 v95, v94
  v_pk_mul_f32 v[120:121], v[92:93], v[24:25] op_sel:[1,0] op_sel_hi:[0,1]
  v_pk_mul_f32 v[122:123], v[94:95], v[24:25] op_sel:[1,0] op_sel_hi:[0,1]
  s_nop 4
  v_pk_fma_f32 v[88:89], v[88:89], v[24:25], v[120:121]
  v_pk_fma_f32 v[90:91], v[90:91], v[24:25], v[122:123]
  v_cvt_pk_bf16_f32 v120, v88, v89
  v_cvt_pk_bf16_f32 v121, v90, v91
  ds_write_b64 v6, v[120:121]
  s_barrier
  ds_read_b64_tr_b16 v[104:105], v7 offset:0
  ds_read_b64_tr_b16 v[106:107], v7 offset:768
  ds_read_b64_tr_b16 v[108:109], v7 offset:1536
  s_waitcnt lgkmcnt(1)
  v_mfma_f32_16x16x32_bf16 v[120:123], v[112:115], v[104:107], 0
  s_waitcnt lgkmcnt(0)
  v_mfma_f32_16x16x32_bf16 v[120:123], v[116:119], v[108:111], v[120:123]
  s_mov_b64 exec, s[64:65]
  s_nop 6
  v_cmpx_o_f32 vcc, v120, v121
  v_cvt_pk_f16_f32 v120, v120, v121
  v_cvt_pk_f16_f32 v121, v122, v123
  buffer_store_dwordx2 v[120:121], v8, s[8:11], s56 offen
  s_xor_b64 s[98:99], exec, s[64:65]
  s_mov_b64 exec, -1
  s_waitcnt lgkmcnt(0)
  s_barrier
  ds_read_b64_tr_b16 v[104:105], v7 offset:0
  ds_read_b64_tr_b16 v[106:107], v7 offset:768
  ds_read_b64_tr_b16 v[108:109], v7 offset:1536
  ds_read_b32 v27, v12 offset:12544
  ds_read_b64 v[140:141], v11
  s_waitcnt lgkmcnt(1)
  v_cmp_u_f32 vcc, v104, v106
  v_cmp_u_f32 s[22:23], v108, v27
  s_nop 1
  s_or_b64 vcc, vcc, s[22:23]
  s_cbranch_vccnz mn_59
mk_60:
  s_cmp_eq_u32 s52, 63
  s_cbranch_scc1 last_61
  s_cmp_lg_u64 s[98:99], 0
  s_cbranch_scc1 sf_63
sf_64:
  s_nop 15
  s_nop 10
  v_smfmac_f32_16x16x64_bf16 v[96:99], v[48:51], a[0:7], v22
  v_smfmac_f32_16x16x64_bf16 v[100:103], v[48:51], a[80:87], v22
  v_smfmac_f32_16x16x64_bf16 v[96:99], v[52:55], a[8:15], v22
  v_smfmac_f32_16x16x64_bf16 v[100:103], v[52:55], a[88:95], v22
  v_smfmac_f32_16x16x64_bf16 v[96:99], v[56:59], a[16:23], v22
  v_smfmac_f32_16x16x64_bf16 v[100:103], v[56:59], a[96:103], v22
  buffer_load_dwordx4 v[132:135], v10, s[8:11], s56 offen sc1
  v_smfmac_f32_16x16x64_bf16 v[96:99], v[60:63], a[24:31], v22
  buffer_load_dwordx4 v[124:127], v9, s[8:11], s56 offen sc1
  v_smfmac_f32_16x16x64_bf16 v[96:99], v[64:67], a[32:39], v22
  buffer_load_dwordx4 v[128:131], v9, s[8:11], s56 offen offset:1024 sc1
  v_smfmac_f32_16x16x64_bf16 v[96:99], v[68:71], a[40:47], v22
  v_smfmac_f32_16x16x64_bf16 v[96:99], v[72:75], a[48:55], v22
  v_smfmac_f32_16x16x64_bf16 v[96:99], v[76:79], a[56:63], v22
  v_smfmac_f32_16x16x64_bf16 v[96:99], v[80:83], a[64:71], v22
  v_smfmac_f32_16x16x64_bf16 v[96:99], v[84:87], a[72:79], v22
  v_smfmac_f32_16x16x64_bf16 v[100:103], v[60:63], a[104:111], v22
  v_smfmac_f32_16x16x64_bf16 v[100:103], v[64:67], a[112:119], v22
  v_smfmac_f32_16x16x64_bf16 v[100:103], v[68:71], a[120:127], v22
  v_smfmac_f32_16x16x64_bf16 v[100:103], v[72:75], a[128:135], v22
  v_cvt_pk_bf16_f32 v136, v96, v97
  v_smfmac_f32_16x16x64_bf16 v[100:103], v[76:79], a[136:143], v22
  v_cvt_pk_bf16_f32 v137, v98, v99
  v_smfmac_f32_16x16x64_bf16 v[100:103], v[80:83], a[144:151], v22
  v_smfmac_f32_16x16x64_bf16 v[100:103], v[84:87], a[152:159], v22
  s_nop 7
  v_cvt_pk_bf16_f32 v138, v100, v101
  v_cvt_pk_bf16_f32 v139, v102, v103
  s_waitcnt vmcnt(2) lgkmcnt(0)
  v_pk_add_f16 v164, v132, v133
  v_pk_add_f16 v165, v134, v135
  v_fma_mix_f32 v170, v164, 1.0, v165 op_sel:[0,0,0] op_sel_hi:[1,0,1]
  v_fma_mix_f32 v171, v164, 1.0, v165 op_sel:[1,0,1] op_sel_hi:[1,0,1]
  v_exp_f32 v176, v170
  v_exp_f32 v177, v171
  s_waitcnt vmcnt(1)
  v_cvt_pk_bf16_f32 v160, v176, v177
  v_pk_add_f16 v120, v124, v126
  v_pk_add_f16 v121, v125, v127
  v_mov_b32_dpp v161, v160 row_ror:8 row_mask:0xf bank_mask:0xf
  s_waitcnt vmcnt(0)
  v_pk_add_f16 v122, v128, v130
  v_mfma_f32_16x16x32_bf16 v[178:181], v[140:143], v[160:163], 0
  v_fma_mix_f32 v166, v120, 1.0, v122 op_sel:[0,0,0] op_sel_hi:[1,0,1]
  v_fma_mix_f32 v167, v120, 1.0, v122 op_sel:[1,0,1] op_sel_hi:[1,0,1]
  v_cmp_u_f32 vcc, v166, v170
  v_pk_add_f16 v123, v129, v131
  v_exp_f32 v172, v166
  v_mfma_f32_16x16x32_bf16 v[182:185], v[136:139], v[160:163], 0
  s_cbranch_vccnz sr_65
  v_exp_f32 v173, v167
  v_fma_mix_f32 v168, v121, 1.0, v123 op_sel:[0,0,0] op_sel_hi:[1,0,1]
  v_fma_mix_f32 v169, v121, 1.0, v123 op_sel:[1,0,1] op_sel_hi:[1,0,1]
  v_cvt_pk_bf16_f32 v156, v172, v173
  v_exp_f32 v174, v168
  v_exp_f32 v175, v169
  v_mov_b32_dpp v158, v156 row_ror:8 row_mask:0xf bank_mask:0xf
  v_cvt_pk_bf16_f32 v157, v174, v175
  v_mfma_f32_16x16x32_bf16 v[186:189], v[138:141], v[160:163], 0
  s_nop 0
  v_mov_b32_dpp v159, v157 row_ror:8 row_mask:0xf bank_mask:0xf
  s_nop 1
pv_66:
  v_mfma_f32_16x16x32_bf16 v[178:181], v[152:155], v[156:159], v[178:181]
  v_mfma_f32_16x16x32_bf16 v[182:185], v[144:147], v[156:159], v[182:185]
  v_mfma_f32_16x16x32_bf16 v[186:189], v[148:151], v[156:159], v[186:189]
  s_mov_b64 exec, s[62:63]
  s_nop 0
  v_rcp_f32 v164, v180
  v_cmp_ngt_f32 s[22:23], s80, v180
  v_cmp_ngt_f32 vcc, s80, v164
  v_pk_mul_f32 v[182:183], v[182:183], v[164:165] op_sel_hi:[1,0]
  v_pk_mul_f32 v[184:185], v[184:185], v[164:165] op_sel_hi:[1,0]
  v_pk_mul_f32 v[178:179], v[178:179], v[164:165] op_sel_hi:[1,0]
  v_pk_mul_f32 v[186:187], v[186:187], v[164:165] op_sel_hi:[1,0]
  v_pk_mul_f32 v[188:189], v[188:189], v[164:165] op_sel_hi:[1,0]
  v_cvt_pk_f16_f32 v64, v178, v179
  s_or_b64 vcc, vcc, s[22:23]
  s_cbranch_scc1 fx_68
fk_69:
  ds_write_b32 v14, v64
  v_cvt_pk_f16_f32 v60, v182, v183
  v_cvt_pk_f16_f32 v61, v184, v185
  v_cvt_pk_f16_f32 v62, v186, v187
  v_cvt_pk_f16_f32 v63, v188, v189
  ds_write_b128 v13, v[60:63]
  s_barrier
  s_mov_b64 exec, -1
  s_add_u32 m0, s74, 6144
  s_add_u32 s21, s79, 196608
  buffer_load_dwordx4 v4, s[16:19], s21 offen offset:1024 sc1 lds
  s_add_u32 m0, s74, 4096
  s_mul_i32 s21, s91, 2
  s_add_u32 s21, s21, s71
  buffer_load_dwordx4 v4, s[16:19], s21 offen sc1 lds
  s_xor_b32 s74, s74, 16384
  s_add_u32 s73, s73, 2097152
  s_xor_b32 s73, s73, 8192
  s_add_u32 s79, s79, 2097152
  s_xor_b32 s79, s79, 8192
  s_add_u32 s21, s72, 524288
  s_xor_b32 s72, s72, s21
  s_lshr_b32 s72, s72, 8
  s_and_b32 s72, s72, 8192
  s_xor_b32 s72, s72, s21
  s_add_u32 s71, s73, 4096
  s_mov_b32 s91, 1024
  s_sub_u32 s21, s73, 0
  s_cmp_lt_u32 s21, 125829120
  s_cselect_b32 s71, s71, s79
  s_cselect_b32 s91, s91, 65536
  v_permlane32_swap_b32 v96, v100
  v_permlane32_swap_b32 v97, v101
  v_permlane32_swap_b32 v98, v102
  v_permlane32_swap_b32 v99, v103
  v_pk_add_f32 v[96:97], v[96:97], v[100:101]
  v_pk_add_f32 v[98:99], v[98:99], v[102:103]
  v_cvt_pk_bf16_f32 v100, v96, v97
  v_cvt_pk_bf16_f32 v101, v98, v99
  s_nop 0
  v_permlane32_swap_b32 v100, v102
  v_permlane32_swap_b32 v101, v103
  v_min_u32 v100, -2, v100
  s_nop 6
  buffer_store_dwordx4 v[100:103], v26, s[16:19], s70 offen sc1
  v_min_u32 v108, -2, v108
  buffer_store_dwordx2 v[108:109], v37, s[16:19], s70 offen offset:3072 sc1
  s_add_u32 s70, s70, 2097152
  s_xor_b32 s70, s70, 8192
  ds_read_b128 v[144:147], v18
  ds_read_b128 v[148:151], v18 offset:1024
  ds_read_b128 v[152:155], v19
  ds_read_b128 v[112:115], v20
  ds_read_b64 v[116:117], v21
  v_xor_b32 v18, 16384, v18
  v_xor_b32 v19, 16384, v19
  v_xor_b32 v20, 16384, v20
  v_xor_b32 v21, 16384, v21
  v_mov_b32 v88, 0
  v_mov_b32 v89, 0
  v_mov_b32 v90, 0
  v_mov_b32 v91, 0
  v_mov_b32 v92, 0
  v_mov_b32 v93, 0
  v_mov_b32 v94, 0
  v_mov_b32 v95, 0
  v_mov_b32 v96, 0
  v_mov_b32 v97, 0
  v_mov_b32 v98, 0
  v_mov_b32 v99, 0
  v_mov_b32 v100, 0
  v_mov_b32 v101, 0
  v_mov_b32 v102, 0
  v_mov_b32 v103, 0
  s_mov_b32 s81, 0
  s_waitcnt lgkmcnt(0)
  s_barrier
  s_mov_b64 exec, s[64:65]
  buffer_store_dwordx2 v[28:29], v8, s[8:11], s57 offen
  s_mov_b64 exec, -1
  ds_write_b128 v190, v[28:31] offset:0
  ds_write_b128 v190, v[28:31] offset:1024
  ds_write_b128 v190, v[28:31] offset:2048
  ds_write_b64 v6, v[28:29]
  s_mov_b64 exec, s[62:63]
  buffer_store_dword v28, v17, s[8:11], s59 offen
  s_mov_b64 exec, -1
  s_sleep 3
  s_nop 1
  buffer_load_dwordx4 v[68:71], v16, s[4:7], s60 offen sc1
  s_sleep 3
  s_nop 1
  buffer_load_dwordx4 v[72:75], v16, s[4:7], s60 offen sc1
  s_waitcnt vmcnt(1)
  v_mfma_f32_16x16x32_f16 v[120:123], v[44:47], v[68:71], 0
  v_bitop3_b32 v27, v68, s61, 1 bitop3:0x28
  v_cmp_ne_u32 vcc, 0, v27
  s_nop 1
  s_cbranch_vccnz p2_74
  s_nop 2
pg_73:
  v_add_f32_dpp v120, v120, v120 row_ror:8 row_mask:0xf bank_mask:0xf
  v_add_f32_dpp v121, v121, v121 row_ror:8 row_mask:0xf bank_mask:0xf
  s_mov_b64 exec, s[62:63]
  v_cvt_pk_bf16_f32 v120, v120, v121
  v_min_u32 v120, -2, v120
  buffer_store_dword v120, v17, s[8:11], s55 offen
  s_mov_b64 exec, -1
nt_70:
  s_barrier
  s_mov_b32 s58, s55
  s_add_u32 s52, s52, 1
  ds_write_b32 v13, v28
  ds_write_b32 v14, v28
  s_and_b32 s21, s52, 3
  s_mul_i32 s56, s21, 122880
  s_add_u32 s21, s52, 1
  s_and_b32 s21, s21, 3
  s_mul_i32 s55, s21, 122880
  s_add_u32 s55, s55, s75
  s_add_u32 s21, s52, 2
  s_and_b32 s21, s21, 3
  s_mul_i32 s57, s21, 122880
  s_add_u32 s21, s52, 3
  s_and_b32 s21, s21, 3
  s_mul_i32 s59, s21, 122880
  s_add_u32 s59, s59, s75
  s_bfe_u32 s61, s52, 0x10002
  s_and_b32 s21, s52, 3
  s_lshl_b32 s60, s21, 18
  s_mov_b32 s54, 0
  s_sleep 2
  s_nop 10
  s_waitcnt lgkmcnt(0)
  buffer_load_dwordx4 v[56:59], v190, s[8:11], s58 offen offset:0 sc1
  buffer_load_dwordx4 v[60:63], v190, s[8:11], s58 offen offset:1024 sc1
  buffer_load_dwordx4 v[64:67], v190, s[8:11], s58 offen offset:2048 sc1
  s_branch top_57
mr_58:
  s_mov_b64 exec, s[22:23]
  s_cbranch_execz ms_75
  buffer_load_dwordx4 v[56:59], v190, s[8:11], s58 offen offset:0 sc1
ms_75:
  s_mov_b64 exec, s[98:99]
  s_cbranch_execz ms_76
  buffer_load_dwordx4 v[60:63], v190, s[8:11], s58 offen offset:1024 sc1
ms_76:
  s_mov_b64 exec, s[100:101]
  s_cbranch_execz ms_77
  buffer_load_dwordx4 v[64:67], v190, s[8:11], s58 offen offset:2048 sc1
ms_77:
  s_add_u32 s54, s54, 1
  s_cmp_gt_u32 s54, 131072
  s_cbranch_scc1 end0
  s_waitcnt vmcnt(0)
  s_mov_b64 exec, s[22:23]
  ds_write_b128 v190, v[56:59] offset:0
  v_cmp_eq_u32 s[22:23], -1, v56
  s_mov_b64 exec, s[98:99]
  ds_write_b128 v190, v[60:63] offset:1024
  v_cmp_eq_u32 s[98:99], -1, v60
  s_mov_b64 exec, s[100:101]
  ds_write_b128 v190, v[64:67] offset:2048
  v_cmp_eq_u32 s[100:101], -1, v64
  s_mov_b64 exec, -1
  s_or_b64 vcc, s[22:23], s[98:99]
  s_or_b64 vcc, vcc, s[100:101]
  s_cbranch_scc1 mr_58
  s_branch mo_62
sf_63:
  s_waitcnt lgkmcnt(1)
  v_mfma_f32_16x16x32_bf16 v[120:123], v[112:115], v[104:107], 0
  s_waitcnt lgkmcnt(0)
  v_mfma_f32_16x16x32_bf16 v[120:123], v[116:119], v[108:111], v[120:123]
  s_mov_b64 exec, s[64:65]
  s_nop 6
  v_cvt_pk_f16_f32 v120, v120, v121
  v_cvt_pk_f16_f32 v121, v122, v123
  buffer_store_dwordx2 v[120:121], v8, s[8:11], s56 offen
  s_mov_b64 exec, -1
  s_branch sf_64
mn_59:
  s_bitcmp1_b32 s81, 1
  s_cbranch_scc1 mk_60
  s_or_b32 s81, s81, 2
  s_nop 7
  v_mov_b32 v88, 0
  v_mov_b32 v89, 0
  v_mov_b32 v90, 0
  v_mov_b32 v91, 0
  v_mov_b32 v92, 0
  v_mov_b32 v93, 0
  v_mov_b32 v94, 0
  v_mov_b32 v95, 0
  v_mov_b32 v96, 0
  v_mov_b32 v97, 0
  v_mov_b32 v98, 0
  v_mov_b32 v99, 0
  v_mov_b32 v100, 0
  v_mov_b32 v101, 0
  v_mov_b32 v102, 0
  v_mov_b32 v103, 0
  s_cmp_eq_u32 s52, 0
  s_cbranch_scc1 mx_79
mx_78:
  buffer_load_dwordx4 v[56:59], v190, s[8:11], s58 offen offset:0 sc1
  buffer_load_dwordx4 v[60:63], v190, s[8:11], s58 offen offset:1024 sc1
  buffer_load_dwordx4 v[64:67], v190, s[8:11], s58 offen offset:2048 sc1
  s_add_u32 s54, s54, 1
  s_cmp_gt_u32 s54, 131072
  s_cbranch_scc1 end0
  s_waitcnt vmcnt(0)
  v_max3_u32 v27, v56, v57, v58
  v_max3_u32 v27, v27, v59, v60
  v_max3_u32 v27, v27, v61, v62
  v_max3_u32 v27, v27, v63, v64
  v_max3_u32 v27, v27, v65, v66
  v_max3_u32 v27, v27, v67, v67
  v_cmp_eq_u32 vcc, -1, v27
  s_nop 1
  s_cbranch_vccnz mx_78
  ds_write_b128 v190, v[56:59] offset:0
  ds_write_b128 v190, v[60:63] offset:1024
  ds_write_b128 v190, v[64:67] offset:2048
mx_79:
  s_waitcnt lgkmcnt(0)
  s_branch mo_62
sr_65:
  s_mov_b32 s54, 0
sr_80:
  s_mov_b64 exec, vcc
  buffer_load_dwordx4 v[124:127], v9, s[8:11], s56 offen sc1
  buffer_load_dwordx4 v[128:131], v9, s[8:11], s56 offen offset:1024 sc1
  buffer_load_dwordx4 v[132:135], v10, s[8:11], s56 offen sc1
  s_mov_b64 exec, -1
  s_add_u32 s54, s54, 1
  s_cmp_gt_u32 s54, 131072
  s_cbranch_scc1 end0
  s_waitcnt vmcnt(0)
  v_pk_add_f16 v164, v132, v133
  v_pk_add_f16 v165, v134, v135
  v_pk_add_f16 v120, v124, v126
  v_pk_add_f16 v122, v128, v130
  v_fma_mix_f32 v170, v164, 1.0, v165 op_sel:[0,0,0] op_sel_hi:[1,0,1]
  v_fma_mix_f32 v166, v120, 1.0, v122 op_sel:[0,0,0] op_sel_hi:[1,0,1]
  v_pk_add_f16 v121, v125, v127
  v_cmp_u_f32 vcc, v166, v170
  v_pk_add_f16 v123, v129, v131
  v_fma_mix_f32 v171, v164, 1.0, v165 op_sel:[1,0,1] op_sel_hi:[1,0,1]
  v_fma_mix_f32 v167, v120, 1.0, v122 op_sel:[1,0,1] op_sel_hi:[1,0,1]
  v_fma_mix_f32 v168, v121, 1.0, v123 op_sel:[0,0,0] op_sel_hi:[1,0,1]
  v_fma_mix_f32 v169, v121, 1.0, v123 op_sel:[1,0,1] op_sel_hi:[1,0,1]
  s_cbranch_vccz ex_67
  s_and_b32 s21, s54, 31
  s_cbranch_scc1 sr_80
  v_max3_u32 v27, v124, v126, v128
  v_max3_u32 v27, v27, v130, v132
  v_max3_u32 v27, v27, v133, v134
  v_max3_u32 v27, v27, v135, v135
  v_cmp_eq_u32 vcc, -1, v27
  s_nop 1
  s_cbranch_vccnz sr_80
ex_67:
  v_exp_f32 v176, v170
  v_exp_f32 v177, v171
  v_exp_f32 v172, v166
  v_cvt_pk_bf16_f32 v160, v176, v177
  v_exp_f32 v173, v167
  v_exp_f32 v174, v168
  v_mov_b32_dpp v161, v160 row_ror:8 row_mask:0xf bank_mask:0xf
  v_cvt_pk_bf16_f32 v156, v172, v173
  v_exp_f32 v175, v169
  v_mfma_f32_16x16x32_bf16 v[178:181], v[140:143], v[160:163], 0
  v_mov_b32_dpp v158, v156 row_ror:8 row_mask:0xf bank_mask:0xf
  v_cvt_pk_bf16_f32 v157, v174, v175
  v_mfma_f32_16x16x32_bf16 v[182:185], v[136:139], v[160:163], 0
  s_nop 0
  v_mov_b32_dpp v159, v157 row_ror:8 row_mask:0xf bank_mask:0xf
  v_mfma_f32_16x16x32_bf16 v[186:189], v[138:141], v[160:163], 0
  s_branch pv_66
fx_68:
  s_bitcmp1_b32 s81, 0
  s_cbranch_scc1 fk_69
  s_or_b32 s81, s81, 1
  s_mov_b64 exec, -1
  v_max3_f32 v164, v166, v167, v168
  v_max3_f32 v165, v169, v170, v171
  v_max_f32 v164, v164, v165
  s_nop 1
  v_max_f32_dpp v164, v164, v164 row_ror:8 row_mask:0xf bank_mask:0xf
  v_mov_b32 v165, v164
  s_nop 1
  v_permlane32_swap_b32 v164, v165
  v_max_f32 v164, v164, v165
  v_mov_b32 v165, v164
  s_nop 1
  v_permlane16_swap_b32 v164, v165
  v_max_f32 v164, v164, v165
  v_sub_f32 v166, v166, v164
  v_sub_f32 v167, v167, v164
  v_sub_f32 v168, v168, v164
  v_sub_f32 v169, v169, v164
  v_sub_f32 v170, v170, v164
  v_sub_f32 v171, v171, v164
  s_branch ex_67
p2_74:
  s_mov_b32 s54, 0
  buffer_load_dwordx4 v[68:71], v16, s[4:7], s60 offen sc1
  s_waitcnt vmcnt(1)
  v_mfma_f32_16x16x32_f16 v[120:123], v[44:47], v[72:75], 0
  v_bitop3_b32 v27, v72, s61, 1 bitop3:0x28
  v_cmp_ne_u32 vcc, 0, v27
  s_nop 1
  s_cbranch_vccz pg_73
  buffer_load_dwordx4 v[72:75], v16, s[4:7], s60 offen sc1
pp_72:
  s_waitcnt vmcnt(1)
  v_mfma_f32_16x16x32_f16 v[120:123], v[44:47], v[68:71], 0
  v_bitop3_b32 v27, v68, s61, 1 bitop3:0x28
  v_cmp_ne_u32 vcc, 0, v27
  s_nop 1
  s_cbranch_vccz pg_73
  buffer_load_dwordx4 v[68:71], v16, s[4:7], s60 offen sc1
  s_waitcnt vmcnt(1)
  v_mfma_f32_16x16x32_f16 v[120:123], v[44:47], v[72:75], 0
  v_bitop3_b32 v27, v72, s61, 1 bitop3:0x28
  v_cmp_ne_u32 vcc, 0, v27
  s_nop 1
  s_cbranch_vccz pg_73
  buffer_load_dwordx4 v[72:75], v16, s[4:7], s60 offen sc1
  s_add_u32 s54, s54, 1
  s_cmp_gt_u32 s54, 131072
  s_cbranch_scc1 end0
  s_branch pp_72
last_61:
  v_min_u32 v108, -2, v108
  buffer_store_dwordx2 v[108:109], v37, s[16:19], s70 offen offset:3072 sc1
  v_smfmac_f32_16x16x64_bf16 v[96:99], v[48:51], a[0:7], v22
  v_smfmac_f32_16x16x64_bf16 v[100:103], v[48:51], a[80:87], v22
  v_smfmac_f32_16x16x64_bf16 v[96:99], v[52:55], a[8:15], v22
  v_smfmac_f32_16x16x64_bf16 v[100:103], v[52:55], a[88:95], v22
  v_smfmac_f32_16x16x64_bf16 v[96:99], v[56:59], a[16:23], v22
  v_smfmac_f32_16x16x64_bf16 v[100:103], v[56:59], a[96:103], v22
  v_smfmac_f32_16x16x64_bf16 v[96:99], v[60:63], a[24:31], v22
  v_smfmac_f32_16x16x64_bf16 v[96:99], v[64:67], a[32:39], v22
  v_smfmac_f32_16x16x64_bf16 v[96:99], v[68:71], a[40:47], v22
  v_smfmac_f32_16x16x64_bf16 v[96:99], v[72:75], a[48:55], v22
  v_smfmac_f32_16x16x64_bf16 v[96:99], v[76:79], a[56:63], v22
  v_smfmac_f32_16x16x64_bf16 v[96:99], v[80:83], a[64:71], v22
  v_smfmac_f32_16x16x64_bf16 v[96:99], v[84:87], a[72:79], v22
  v_smfmac_f32_16x16x64_bf16 v[100:103], v[60:63], a[104:111], v22
  v_smfmac_f32_16x16x64_bf16 v[100:103], v[64:67], a[112:119], v22
  v_smfmac_f32_16x16x64_bf16 v[100:103], v[68:71], a[120:127], v22
  v_smfmac_f32_16x16x64_bf16 v[100:103], v[72:75], a[128:135], v22
  v_smfmac_f32_16x16x64_bf16 v[100:103], v[76:79], a[136:143], v22
  v_smfmac_f32_16x16x64_bf16 v[100:103], v[80:83], a[144:151], v22
  v_smfmac_f32_16x16x64_bf16 v[100:103], v[84:87], a[152:159], v22
  s_nop 7
  v_permlane32_swap_b32 v96, v100
  v_permlane32_swap_b32 v97, v101
  v_permlane32_swap_b32 v98, v102
  v_permlane32_swap_b32 v99, v103
  v_pk_add_f32 v[96:97], v[96:97], v[100:101]
  v_pk_add_f32 v[98:99], v[98:99], v[102:103]
  v_cvt_pk_bf16_f32 v100, v96, v97
  v_cvt_pk_bf16_f32 v101, v98, v99
  s_nop 0
  v_permlane32_swap_b32 v100, v102
  v_permlane32_swap_b32 v101, v103
  v_min_u32 v100, -2, v100
  buffer_store_dwordx4 v[100:103], v26, s[16:19], s70 offen sc1
  s_waitcnt vmcnt(0)
  s_barrier
  s_branch chain_done
E_30:
  v_add_u32 v190, 5120, v4
  ds_write_b64 v6, v[28:29]
  ds_write_b32 v13, v28
  ds_write_b32 v14, v28
  s_waitcnt vmcnt(0)
  ds_write_b128 v190, v[68:71] offset:0
  ds_write_b128 v190, v[72:75] offset:1024
  s_waitcnt lgkmcnt(0)
  s_add_u32 m0, s74, 8192
  s_add_u32 s21, s72, 0
  buffer_load_dwordx4 v32, s[16:19], s21 offen sc1 lds
  s_add_u32 m0, s74, 6144
  s_mul_i32 s21, s91, 3
  s_add_u32 s21, s21, s71
  buffer_load_dwordx4 v4, s[16:19], s21 offen sc1 lds
  s_xor_b32 s74, s74, 16384
  s_add_u32 s73, s73, 2097152
  s_xor_b32 s73, s73, 8192
  s_add_u32 s79, s79, 2097152
  s_xor_b32 s79, s79, 8192
  s_add_u32 s21, s72, 524288
  s_xor_b32 s72, s72, s21
  s_lshr_b32 s72, s72, 8
  s_and_b32 s72, s72, 8192
  s_xor_b32 s72, s72, s21
  s_add_u32 s71, s73, 4096
  s_mov_b32 s91, 1024
  s_sub_u32 s21, s73, 0
  s_cmp_lt_u32 s21, 125829120
  s_cselect_b32 s71, s71, s79
  s_cselect_b32 s91, s91, 65536
  s_branch mo_87
  .p2align 3
top_82:
  s_waitcnt vmcnt(1)
  ds_write_b128 v190, v[68:71] offset:0
  v_cmp_eq_u32 s[22:23], -1, v68
  s_waitcnt vmcnt(0)
  ds_write_b128 v190, v[72:75] offset:1024
  v_cmp_eq_u32 s[98:99], -1, v72
  s_or_b64 vcc, s[22:23], s[98:99]
  s_cbranch_scc1 mr_83
mo_87:
  s_barrier
  ds_read_b128 v[48:51], v4 offset:0
  ds_read_b128 v[52:55], v4 offset:1024
  v_smfmac_f32_16x16x64_bf16 v[92:95], v[68:71], v[216:223], v22
  ds_read_b128 v[56:59], v4 offset:2048
  v_smfmac_f32_16x16x64_bf16 v[88:91], v[68:71], a[200:207], v22
  ds_read_b128 v[60:63], v4 offset:3072
  v_smfmac_f32_16x16x64_bf16 v[92:95], v[72:75], v[224:231], v22
  ds_read_b128 v[64:67], v4 offset:4096
  v_smfmac_f32_16x16x64_bf16 v[88:91], v[72:75], a[208:215], v22
  s_waitcnt lgkmcnt(4)
  ds_read_b128 v[76:79], v4 offset:7168
  v_smfmac_f32_16x16x64_bf16 v[92:95], v[48:51], a[240:247], v22
  ds_read_b128 v[80:83], v4 offset:8192
  v_smfmac_f32_16x16x64_bf16 v[88:91], v[48:51], a[160:167], v22
  s_waitcnt lgkmcnt(5)
  ds_read_b128 v[84:87], v4 offset:9216
  v_smfmac_f32_16x16x64_bf16 v[92:95], v[52:55], a[248:255], v22
  v_smfmac_f32_16x16x64_bf16 v[88:91], v[52:55], a[168:175], v22
  s_waitcnt lgkmcnt(5)
  v_smfmac_f32_16x16x64_bf16 v[92:95], v[56:59], v[192:199], v22
  s_waitcnt lgkmcnt(4)
  v_smfmac_f32_16x16x64_bf16 v[92:95], v[60:63], v[200:207], v22
  s_waitcnt lgkmcnt(3)
  v_smfmac_f32_16x16x64_bf16 v[92:95], v[64:67], v[208:215], v22
  s_waitcnt lgkmcnt(2)
  v_smfmac_f32_16x16x64_bf16 v[92:95], v[76:79], v[232:239], v22
  s_waitcnt lgkmcnt(1)
  v_smfmac_f32_16x16x64_bf16 v[92:95], v[80:83], v[240:247], v22
  s_waitcnt lgkmcnt(0)
  v_smfmac_f32_16x16x64_bf16 v[92:95], v[84:87], v[248:255], v22
  v_smfmac_f32_16x16x64_bf16 v[88:91], v[56:59], a[176:183], v22
  v_smfmac_f32_16x16x64_bf16 v[88:91], v[60:63], a[184:191], v22
  v_smfmac_f32_16x16x64_bf16 v[88:91], v[64:67], a[192:199], v22
  v_permlane32_swap_b32 v92, v93
  v_smfmac_f32_16x16x64_bf16 v[88:91], v[76:79], a[216:223], v22
  v_permlane32_swap_b32 v94, v95
  v_smfmac_f32_16x16x64_bf16 v[88:91], v[80:83], a[224:231], v22
  v_permlane32_swap_b32 v93, v92
  v_smfmac_f32_16x16x64_bf16 v[88:91], v[84:87], a[232:239], v22
  v_permlane32_swap_b32 v95, v94
  v_pk_mul_f32 v[120:121], v[92:93], v[24:25] op_sel:[1,0] op_sel_hi:[0,1]
  v_pk_mul_f32 v[122:123], v[94:95], v[24:25] op_sel:[1,0] op_sel_hi:[0,1]
  s_nop 4
  v_pk_fma_f32 v[88:89], v[88:89], v[24:25], v[120:121]
  v_pk_fma_f32 v[90:91], v[90:91], v[24:25], v[122:123]
  v_cvt_pk_bf16_f32 v120, v88, v89
  v_cvt_pk_bf16_f32 v121, v90, v91
  ds_write_b64 v6, v[120:121]
  s_barrier
  ds_read_b64_tr_b16 v[104:105], v7 offset:0
  ds_read_b64_tr_b16 v[106:107], v7 offset:768
  ds_read_b64_tr_b16 v[108:109], v7 offset:1536
  s_waitcnt lgkmcnt(1)
  v_mfma_f32_16x16x32_bf16 v[120:123], v[104:107], v[104:107], 0
  s_waitcnt lgkmcnt(0)
  v_mfma_f32_16x16x32_bf16 v[120:123], v[108:111], v[108:111], v[120:123]
  s_mov_b64 exec, s[64:65]
  s_nop 6
  v_cmpx_o_f32 vcc, v120, v121
  v_cvt_pk_f16_f32 v120, v120, v121
  buffer_store_dword v120, v8, s[8:11], s56 offen
  v_cmpx_o_f32 vcc, v122, v123
  v_cvt_pk_f16_f32 v121, v122, v123
  buffer_store_dword v121, v8, s[8:11], s56 offen offset:128
  s_xor_b64 s[98:99], exec, s[64:65]
  s_mov_b64 exec, -1
  s_waitcnt lgkmcnt(0)
  s_barrier
  ds_read_b64_tr_b16 v[104:105], v7 offset:0
  ds_read_b64_tr_b16 v[106:107], v7 offset:768
  ds_read_b64_tr_b16 v[108:109], v7 offset:1536
  ds_read_b32 v27, v12 offset:12544
  ds_read_b64 v[140:141], v11
  s_waitcnt lgkmcnt(1)
  v_cmp_u_f32 vcc, v104, v106
  v_cmp_u_f32 s[22:23], v108, v27
  s_nop 1
  s_or_b64 vcc, vcc, s[22:23]
  s_cbranch_vccnz mn_84
mk_85:
  s_cmp_eq_u32 s52, 63
  s_cbranch_scc1 last_86
  s_cmp_lg_u64 s[98:99], 0
  s_cbranch_scc1 sf_88
sf_89:
  s_nop 15
  s_nop 10
  v_smfmac_f32_16x16x64_bf16 v[96:99], v[48:51], a[0:7], v22
  v_smfmac_f32_16x16x64_bf16 v[100:103], v[48:51], a[80:87], v22
  v_smfmac_f32_16x16x64_bf16 v[96:99], v[52:55], a[8:15], v22
  v_smfmac_f32_16x16x64_bf16 v[100:103], v[52:55], a[88:95], v22
  v_smfmac_f32_16x16x64_bf16 v[96:99], v[56:59], a[16:23], v22
  v_smfmac_f32_16x16x64_bf16 v[100:103], v[56:59], a[96:103], v22
  buffer_load_dwordx4 v[132:135], v10, s[8:11], s56 offen sc1
  v_smfmac_f32_16x16x64_bf16 v[96:99], v[60:63], a[24:31], v22
  buffer_load_dwordx4 v[124:127], v9, s[8:11], s56 offen sc1
  v_smfmac_f32_16x16x64_bf16 v[96:99], v[64:67], a[32:39], v22
  buffer_load_dwordx4 v[128:131], v9, s[8:11], s56 offen offset:1024 sc1
  v_smfmac_f32_16x16x64_bf16 v[96:99], v[68:71], a[40:47], v22
  v_smfmac_f32_16x16x64_bf16 v[96:99], v[72:75], a[48:55], v22
  v_smfmac_f32_16x16x64_bf16 v[96:99], v[76:79], a[56:63], v22
  v_smfmac_f32_16x16x64_bf16 v[96:99], v[80:83], a[64:71], v22
  v_smfmac_f32_16x16x64_bf16 v[96:99], v[84:87], a[72:79], v22
  v_smfmac_f32_16x16x64_bf16 v[100:103], v[60:63], a[104:111], v22
  v_smfmac_f32_16x16x64_bf16 v[100:103], v[64:67], a[112:119], v22
  v_smfmac_f32_16x16x64_bf16 v[100:103], v[68:71], a[120:127], v22
  v_smfmac_f32_16x16x64_bf16 v[100:103], v[72:75], a[128:135], v22
  v_cvt_pk_bf16_f32 v136, v96, v97
  v_smfmac_f32_16x16x64_bf16 v[100:103], v[76:79], a[136:143], v22
  v_cvt_pk_bf16_f32 v137, v98, v99
  v_smfmac_f32_16x16x64_bf16 v[100:103], v[80:83], a[144:151], v22
  v_smfmac_f32_16x16x64_bf16 v[100:103], v[84:87], a[152:159], v22
  s_nop 7
  v_cvt_pk_bf16_f32 v138, v100, v101
  v_cvt_pk_bf16_f32 v139, v102, v103
  s_waitcnt vmcnt(2) lgkmcnt(0)
  v_pk_add_f16 v164, v132, v133
  v_pk_add_f16 v165, v134, v135
  v_fma_mix_f32 v170, v164, 1.0, v165 op_sel:[0,0,0] op_sel_hi:[1,0,1]
  v_fma_mix_f32 v171, v164, 1.0, v165 op_sel:[1,0,1] op_sel_hi:[1,0,1]
  v_exp_f32 v176, v170
  v_exp_f32 v177, v171
  s_waitcnt vmcnt(1)
  v_cvt_pk_bf16_f32 v160, v176, v177
  v_pk_add_f16 v120, v124, v126
  v_pk_add_f16 v121, v125, v127
  v_mov_b32_dpp v161, v160 row_ror:8 row_mask:0xf bank_mask:0xf
  s_waitcnt vmcnt(0)
  v_pk_add_f16 v122, v128, v130
  v_mfma_f32_16x16x32_bf16 v[178:181], v[140:143], v[160:163], 0
  v_fma_mix_f32 v166, v120, 1.0, v122 op_sel:[0,0,0] op_sel_hi:[1,0,1]
  v_fma_mix_f32 v167, v120, 1.0, v122 op_sel:[1,0,1] op_sel_hi:[1,0,1]
  v_cmp_u_f32 vcc, v166, v170
  v_pk_add_f16 v123, v129, v131
  v_exp_f32 v172, v166
  v_mfma_f32_16x16x32_bf16 v[182:185], v[136:139], v[160:163], 0
  s_cbranch_vccnz sr_90
  v_exp_f32 v173, v167
  v_fma_mix_f32 v168, v121, 1.0, v123 op_sel:[0,0,0] op_sel_hi:[1,0,1]
  v_fma_mix_f32 v169, v121, 1.0, v123 op_sel:[1,0,1] op_sel_hi:[1,0,1]
  v_cvt_pk_bf16_f32 v156, v172, v173
  v_exp_f32 v174, v168
  v_exp_f32 v175, v169
  v_mov_b32_dpp v158, v156 row_ror:8 row_mask:0xf bank_mask:0xf
  v_cvt_pk_bf16_f32 v157, v174, v175
  v_mfma_f32_16x16x32_bf16 v[186:189], v[138:141], v[160:163], 0
  s_nop 0
  v_mov_b32_dpp v159, v157 row_ror:8 row_mask:0xf bank_mask:0xf
  s_nop 1
pv_91:
  v_mfma_f32_16x16x32_bf16 v[178:181], v[152:155], v[156:159], v[178:181]
  v_mfma_f32_16x16x32_bf16 v[182:185], v[144:147], v[156:159], v[182:185]
  v_mfma_f32_16x16x32_bf16 v[186:189], v[148:151], v[156:159], v[186:189]
  s_mov_b64 exec, s[62:63]
  s_nop 0
  v_rcp_f32 v164, v180
  v_cmp_ngt_f32 s[22:23], s80, v180
  v_cmp_ngt_f32 vcc, s80, v164
  v_pk_mul_f32 v[182:183], v[182:183], v[164:165] op_sel_hi:[1,0]
  v_pk_mul_f32 v[184:185], v[184:185], v[164:165] op_sel_hi:[1,0]
  v_pk_mul_f32 v[178:179], v[178:179], v[164:165] op_sel_hi:[1,0]
  v_pk_mul_f32 v[186:187], v[186:187], v[164:165] op_sel_hi:[1,0]
  v_pk_mul_f32 v[188:189], v[188:189], v[164:165] op_sel_hi:[1,0]
  v_cvt_pk_f16_f32 v64, v178, v179
  s_or_b64 vcc, vcc, s[22:23]
  s_cbranch_scc1 fx_93
fk_94:
  ds_write_b32 v14, v64
  v_cvt_pk_f16_f32 v60, v182, v183
  v_cvt_pk_f16_f32 v61, v184, v185
  v_cvt_pk_f16_f32 v62, v186, v187
  v_cvt_pk_f16_f32 v63, v188, v189
  ds_write_b128 v13, v[60:63]
  s_barrier
  s_mov_b64 exec, -1
  s_and_b32 s21, s52, 3
  s_cmp_lt_u32 s52, 58
  s_cselect_b32 s21, s21, 0
  s_cmp_lg_u32 s21, 0
  s_cbranch_scc1 fs_95
  v_mov_b32 v27, s52
  s_mov_b64 exec, 1
  buffer_store_dword v27, v23, s[12:15], s77 offen sc1
  s_mov_b64 exec, -1
fs_95:
  s_add_u32 m0, s74, 8192
  s_add_u32 s21, s72, 0
  buffer_load_dwordx4 v32, s[16:19], s21 offen sc1 lds
  s_add_u32 m0, s74, 6144
  s_mul_i32 s21, s91, 3
  s_add_u32 s21, s21, s71
  buffer_load_dwordx4 v4, s[16:19], s21 offen sc1 lds
  s_xor_b32 s74, s74, 16384
  s_add_u32 s73, s73, 2097152
  s_xor_b32 s73, s73, 8192
  s_add_u32 s79, s79, 2097152
  s_xor_b32 s79, s79, 8192
  s_add_u32 s21, s72, 524288
  s_xor_b32 s72, s72, s21
  s_lshr_b32 s72, s72, 8
  s_and_b32 s72, s72, 8192
  s_xor_b32 s72, s72, s21
  s_add_u32 s71, s73, 4096
  s_mov_b32 s91, 1024
  s_sub_u32 s21, s73, 0
  s_cmp_lt_u32 s21, 125829120
  s_cselect_b32 s71, s71, s79
  s_cselect_b32 s91, s91, 65536
  v_permlane32_swap_b32 v96, v100
  v_permlane32_swap_b32 v97, v101
  v_permlane32_swap_b32 v98, v102
  v_permlane32_swap_b32 v99, v103
  v_pk_add_f32 v[96:97], v[96:97], v[100:101]
  v_pk_add_f32 v[98:99], v[98:99], v[102:103]
  v_cvt_pk_bf16_f32 v100, v96, v97
  v_cvt_pk_bf16_f32 v101, v98, v99
  s_nop 0
  v_permlane32_swap_b32 v100, v102
  v_permlane32_swap_b32 v101, v103
  v_min_u32 v100, -2, v100
  s_nop 6
  buffer_store_dwordx4 v[100:103], v26, s[16:19], s70 offen sc1
  s_add_u32 s70, s70, 2097152
  s_xor_b32 s70, s70, 8192
  ds_read_b128 v[144:147], v18
  ds_read_b128 v[148:151], v18 offset:1024
  ds_read_b128 v[152:155], v19
  v_xor_b32 v18, 16384, v18
  v_xor_b32 v19, 16384, v19
  v_mov_b32 v88, 0
  v_mov_b32 v89, 0
  v_mov_b32 v90, 0
  v_mov_b32 v91, 0
  v_mov_b32 v92, 0
  v_mov_b32 v93, 0
  v_mov_b32 v94, 0
  v_mov_b32 v95, 0
  v_mov_b32 v96, 0
  v_mov_b32 v97, 0
  v_mov_b32 v98, 0
  v_mov_b32 v99, 0
  v_mov_b32 v100, 0
  v_mov_b32 v101, 0
  v_mov_b32 v102, 0
  v_mov_b32 v103, 0
  s_mov_b32 s81, 0
  s_waitcnt lgkmcnt(0)
  s_barrier
  s_mov_b64 exec, s[64:65]
  buffer_store_dword v28, v8, s[8:11], s57 offen
  buffer_store_dword v28, v8, s[8:11], s57 offen offset:128
  s_mov_b64 exec, -1
  ds_write_b128 v190, v[28:31] offset:0
  ds_write_b128 v190, v[28:31] offset:1024
  ds_write_b64 v6, v[28:29]
  s_mov_b64 exec, -1
  s_cmp_eq_u32 s78, 0
  s_cbranch_scc1 nt_97
  s_mov_b64 exec, s[62:63]
  buffer_store_dword v28, v17, s[8:11], s59 offen
  s_mov_b64 exec, -1
  s_sleep 3
  s_nop 1
  buffer_load_dwordx4 v[68:71], v16, s[4:7], s60 offen sc1
  s_sleep 3
  s_nop 1
  buffer_load_dwordx4 v[72:75], v16, s[4:7], s60 offen sc1
  s_waitcnt vmcnt(1)
  v_mfma_f32_16x16x32_f16 v[120:123], v[44:47], v[68:71], 0
  v_bitop3_b32 v27, v68, s61, 1 bitop3:0x28
  v_cmp_ne_u32 vcc, 0, v27
  s_nop 1
  s_cbranch_vccnz p2_100
  s_nop 2
pg_99:
  v_add_f32_dpp v120, v120, v120 row_ror:8 row_mask:0xf bank_mask:0xf
  v_add_f32_dpp v121, v121, v121 row_ror:8 row_mask:0xf bank_mask:0xf
  s_mov_b64 exec, s[62:63]
  v_cvt_pk_bf16_f32 v120, v120, v121
  v_min_u32 v120, -2, v120
  buffer_store_dword v120, v17, s[8:11], s55 offen
  s_mov_b64 exec, -1
nt_96:
  s_barrier
  s_mov_b32 s58, s55
  s_add_u32 s52, s52, 1
  ds_write_b32 v13, v28
  ds_write_b32 v14, v28
  s_and_b32 s21, s52, 3
  s_mul_i32 s56, s21, 122880
  s_add_u32 s21, s52, 1
  s_and_b32 s21, s21, 3
  s_mul_i32 s55, s21, 122880
  s_add_u32 s55, s55, s75
  s_add_u32 s21, s52, 2
  s_and_b32 s21, s21, 3
  s_mul_i32 s57, s21, 122880
  s_add_u32 s21, s52, 3
  s_and_b32 s21, s21, 3
  s_mul_i32 s59, s21, 122880
  s_add_u32 s59, s59, s75
  s_bfe_u32 s61, s52, 0x10002
  s_and_b32 s21, s52, 3
  s_lshl_b32 s60, s21, 18
  s_mov_b32 s54, 0
  s_sleep 2
  s_nop 10
  s_waitcnt lgkmcnt(0)
  buffer_load_dwordx4 v[68:71], v190, s[8:11], s58 offen offset:0 sc1
  buffer_load_dwordx4 v[72:75], v190, s[8:11], s58 offen offset:1024 sc1
  s_branch top_82
mr_83:
  s_mov_b64 exec, s[22:23]
  s_cbranch_execz ms_101
  buffer_load_dwordx4 v[68:71], v190, s[8:11], s58 offen offset:0 sc1
ms_101:
  s_mov_b64 exec, s[98:99]
  s_cbranch_execz ms_102
  buffer_load_dwordx4 v[72:75], v190, s[8:11], s58 offen offset:1024 sc1
ms_102:
  s_add_u32 s54, s54, 1
  s_cmp_gt_u32 s54, 131072
  s_cbranch_scc1 end0
  s_waitcnt vmcnt(0)
  s_mov_b64 exec, s[22:23]
  ds_write_b128 v190, v[68:71] offset:0
  v_cmp_eq_u32 s[22:23], -1, v68
  s_mov_b64 exec, s[98:99]
  ds_write_b128 v190, v[72:75] offset:1024
  v_cmp_eq_u32 s[98:99], -1, v72
  s_mov_b64 exec, -1
  s_or_b64 vcc, s[22:23], s[98:99]
  s_cbranch_scc1 mr_83
  s_branch mo_87
sf_88:
  s_waitcnt lgkmcnt(1)
  v_mfma_f32_16x16x32_bf16 v[120:123], v[104:107], v[104:107], 0
  s_waitcnt lgkmcnt(0)
  v_mfma_f32_16x16x32_bf16 v[120:123], v[108:111], v[108:111], v[120:123]
  s_mov_b64 exec, s[64:65]
  s_nop 6
  v_cvt_pk_f16_f32 v120, v120, v121
  buffer_store_dword v120, v8, s[8:11], s56 offen
  v_cvt_pk_f16_f32 v121, v122, v123
  buffer_store_dword v121, v8, s[8:11], s56 offen offset:128
  s_mov_b64 exec, -1
  s_branch sf_89
mn_84:
  s_bitcmp1_b32 s81, 1
  s_cbranch_scc1 mk_85
  s_or_b32 s81, s81, 2
  s_nop 7
  v_mov_b32 v88, 0
  v_mov_b32 v89, 0
  v_mov_b32 v90, 0
  v_mov_b32 v91, 0
  v_mov_b32 v92, 0
  v_mov_b32 v93, 0
  v_mov_b32 v94, 0
  v_mov_b32 v95, 0
  v_mov_b32 v96, 0
  v_mov_b32 v97, 0
  v_mov_b32 v98, 0
  v_mov_b32 v99, 0
  v_mov_b32 v100, 0
  v_mov_b32 v101, 0
  v_mov_b32 v102, 0
  v_mov_b32 v103, 0
  s_cmp_eq_u32 s52, 0
  s_cbranch_scc1 mx_104
mx_103:
  buffer_load_dwordx4 v[68:71], v190, s[8:11], s58 offen offset:0 sc1
  buffer_load_dwordx4 v[72:75], v190, s[8:11], s58 offen offset:1024 sc1
  s_add_u32 s54, s54, 1
  s_cmp_gt_u32 s54, 131072
  s_cbranch_scc1 end0
  s_waitcnt vmcnt(0)
  v_max3_u32 v27, v68, v69, v70
  v_max3_u32 v27, v27, v71, v72
  v_max3_u32 v27, v27, v73, v74
  v_max3_u32 v27, v27, v75, v75
  v_cmp_eq_u32 vcc, -1, v27
  s_nop 1
  s_cbranch_vccnz mx_103
  ds_write_b128 v190, v[68:71] offset:0
  ds_write_b128 v190, v[72:75] offset:1024
mx_104:
  s_waitcnt lgkmcnt(0)
  s_branch mo_87
sr_90:
  s_mov_b32 s54, 0
sr_105:
  s_mov_b64 exec, vcc
  buffer_load_dwordx4 v[124:127], v9, s[8:11], s56 offen sc1
  buffer_load_dwordx4 v[128:131], v9, s[8:11], s56 offen offset:1024 sc1
  buffer_load_dwordx4 v[132:135], v10, s[8:11], s56 offen sc1
  s_mov_b64 exec, -1
  s_add_u32 s54, s54, 1
  s_cmp_gt_u32 s54, 131072
  s_cbranch_scc1 end0
  s_waitcnt vmcnt(0)
  v_pk_add_f16 v164, v132, v133
  v_pk_add_f16 v165, v134, v135
  v_pk_add_f16 v120, v124, v126
  v_pk_add_f16 v122, v128, v130
  v_fma_mix_f32 v170, v164, 1.0, v165 op_sel:[0,0,0] op_sel_hi:[1,0,1]
  v_fma_mix_f32 v166, v120, 1.0, v122 op_sel:[0,0,0] op_sel_hi:[1,0,1]
  v_pk_add_f16 v121, v125, v127
  v_cmp_u_f32 vcc, v166, v170
  v_pk_add_f16 v123, v129, v131
  v_fma_mix_f32 v171, v164, 1.0, v165 op_sel:[1,0,1] op_sel_hi:[1,0,1]
  v_fma_mix_f32 v167, v120, 1.0, v122 op_sel:[1,0,1] op_sel_hi:[1,0,1]
  v_fma_mix_f32 v168, v121, 1.0, v123 op_sel:[0,0,0] op_sel_hi:[1,0,1]
  v_fma_mix_f32 v169, v121, 1.0, v123 op_sel:[1,0,1] op_sel_hi:[1,0,1]
  s_cbranch_vccz ex_92
  s_and_b32 s21, s54, 31
  s_cbranch_scc1 sr_105
  v_max3_u32 v27, v124, v126, v128
  v_max3_u32 v27, v27, v130, v132
  v_max3_u32 v27, v27, v133, v134
  v_max3_u32 v27, v27, v135, v135
  v_cmp_eq_u32 vcc, -1, v27
  s_nop 1
  s_cbranch_vccnz sr_105
ex_92:
  v_exp_f32 v176, v170
  v_exp_f32 v177, v171
  v_exp_f32 v172, v166
  v_cvt_pk_bf16_f32 v160, v176, v177
  v_exp_f32 v173, v167
  v_exp_f32 v174, v168
  v_mov_b32_dpp v161, v160 row_ror:8 row_mask:0xf bank_mask:0xf
  v_cvt_pk_bf16_f32 v156, v172, v173
  v_exp_f32 v175, v169
  v_mfma_f32_16x16x32_bf16 v[178:181], v[140:143], v[160:163], 0
  v_mov_b32_dpp v158, v156 row_ror:8 row_mask:0xf bank_mask:0xf
  v_cvt_pk_bf16_f32 v157, v174, v175
  v_mfma_f32_16x16x32_bf16 v[182:185], v[136:139], v[160:163], 0
  s_nop 0
  v_mov_b32_dpp v159, v157 row_ror:8 row_mask:0xf bank_mask:0xf
  v_mfma_f32_16x16x32_bf16 v[186:189], v[138:141], v[160:163], 0
  s_branch pv_91
fx_93:
  s_bitcmp1_b32 s81, 0
  s_cbranch_scc1 fk_94
  s_or_b32 s81, s81, 1
  s_mov_b64 exec, -1
  v_max3_f32 v164, v166, v167, v168
  v_max3_f32 v165, v169, v170, v171
  v_max_f32 v164, v164, v165
  s_nop 1
  v_max_f32_dpp v164, v164, v164 row_ror:8 row_mask:0xf bank_mask:0xf
  v_mov_b32 v165, v164
  s_nop 1
  v_permlane32_swap_b32 v164, v165
  v_max_f32 v164, v164, v165
  v_mov_b32 v165, v164
  s_nop 1
  v_permlane16_swap_b32 v164, v165
  v_max_f32 v164, v164, v165
  v_sub_f32 v166, v166, v164
  v_sub_f32 v167, v167, v164
  v_sub_f32 v168, v168, v164
  v_sub_f32 v169, v169, v164
  v_sub_f32 v170, v170, v164
  v_sub_f32 v171, v171, v164
  s_branch ex_92
nt_97:
  s_branch nt_96
p2_100:
  s_mov_b32 s54, 0
  buffer_load_dwordx4 v[68:71], v16, s[4:7], s60 offen sc1
  s_waitcnt vmcnt(1)
  v_mfma_f32_16x16x32_f16 v[120:123], v[44:47], v[72:75], 0
  v_bitop3_b32 v27, v72, s61, 1 bitop3:0x28
  v_cmp_ne_u32 vcc, 0, v27
  s_nop 1
  s_cbranch_vccz pg_99
  buffer_load_dwordx4 v[72:75], v16, s[4:7], s60 offen sc1
pp_98:
  s_waitcnt vmcnt(1)
  v_mfma_f32_16x16x32_f16 v[120:123], v[44:47], v[68:71], 0
  v_bitop3_b32 v27, v68, s61, 1 bitop3:0x28
  v_cmp_ne_u32 vcc, 0, v27
  s_nop 1
  s_cbranch_vccz pg_99
  buffer_load_dwordx4 v[68:71], v16, s[4:7], s60 offen sc1
  s_waitcnt vmcnt(1)
  v_mfma_f32_16x16x32_f16 v[120:123], v[44:47], v[72:75], 0
  v_bitop3_b32 v27, v72, s61, 1 bitop3:0x28
  v_cmp_ne_u32 vcc, 0, v27
  s_nop 1
  s_cbranch_vccz pg_99
  buffer_load_dwordx4 v[72:75], v16, s[4:7], s60 offen sc1
  s_add_u32 s54, s54, 1
  s_cmp_gt_u32 s54, 131072
  s_cbranch_scc1 end0
  s_branch pp_98
last_86:
  v_smfmac_f32_16x16x64_bf16 v[96:99], v[48:51], a[0:7], v22
  v_smfmac_f32_16x16x64_bf16 v[100:103], v[48:51], a[80:87], v22
  v_smfmac_f32_16x16x64_bf16 v[96:99], v[52:55], a[8:15], v22
  v_smfmac_f32_16x16x64_bf16 v[100:103], v[52:55], a[88:95], v22
  v_smfmac_f32_16x16x64_bf16 v[96:99], v[56:59], a[16:23], v22
  v_smfmac_f32_16x16x64_bf16 v[100:103], v[56:59], a[96:103], v22
  v_smfmac_f32_16x16x64_bf16 v[96:99], v[60:63], a[24:31], v22
  v_smfmac_f32_16x16x64_bf16 v[96:99], v[64:67], a[32:39], v22
  v_smfmac_f32_16x16x64_bf16 v[96:99], v[68:71], a[40:47], v22
  v_smfmac_f32_16x16x64_bf16 v[96:99], v[72:75], a[48:55], v22
  v_smfmac_f32_16x16x64_bf16 v[96:99], v[76:79], a[56:63], v22
  v_smfmac_f32_16x16x64_bf16 v[96:99], v[80:83], a[64:71], v22
  v_smfmac_f32_16x16x64_bf16 v[96:99], v[84:87], a[72:79], v22
  v_smfmac_f32_16x16x64_bf16 v[100:103], v[60:63], a[104:111], v22
  v_smfmac_f32_16x16x64_bf16 v[100:103], v[64:67], a[112:119], v22
  v_smfmac_f32_16x16x64_bf16 v[100:103], v[68:71], a[120:127], v22
  v_smfmac_f32_16x16x64_bf16 v[100:103], v[72:75], a[128:135], v22
  v_smfmac_f32_16x16x64_bf16 v[100:103], v[76:79], a[136:143], v22
  v_smfmac_f32_16x16x64_bf16 v[100:103], v[80:83], a[144:151], v22
  v_smfmac_f32_16x16x64_bf16 v[100:103], v[84:87], a[152:159], v22
  s_nop 7
  v_permlane32_swap_b32 v96, v100
  v_permlane32_swap_b32 v97, v101
  v_permlane32_swap_b32 v98, v102
  v_permlane32_swap_b32 v99, v103
  v_pk_add_f32 v[96:97], v[96:97], v[100:101]
  v_pk_add_f32 v[98:99], v[98:99], v[102:103]
  v_cvt_pk_bf16_f32 v100, v96, v97
  v_cvt_pk_bf16_f32 v101, v98, v99
  s_nop 0
  v_permlane32_swap_b32 v100, v102
  v_permlane32_swap_b32 v101, v103
  v_min_u32 v100, -2, v100
  buffer_store_dwordx4 v[100:103], v26, s[16:19], s70 offen sc1
  s_waitcnt vmcnt(0)
  s_barrier
  s_branch chain_done
E_32:
  v_add_u32 v190, 7168, v4
  ds_write_b32 v13, v28
  ds_write_b32 v14, v28
  s_waitcnt vmcnt(0)
  ds_write_b128 v190, v[76:79] offset:0
  ds_write_b128 v190, v[80:83] offset:1024
  ds_write_b128 v190, v[84:87] offset:2048
  s_waitcnt lgkmcnt(0)
  s_branch mo_112
  .p2align 3
top_107:
  s_waitcnt vmcnt(2)
  ds_write_b128 v190, v[76:79] offset:0
  v_cmp_eq_u32 s[22:23], -1, v76
  s_waitcnt vmcnt(1)
  ds_write_b128 v190, v[80:83] offset:1024
  v_cmp_eq_u32 s[98:99], -1, v80
  s_waitcnt vmcnt(0)
  ds_write_b128 v190, v[84:87] offset:2048
  v_cmp_eq_u32 s[100:101], -1, v84
  s_or_b64 vcc, s[22:23], s[98:99]
  s_or_b64 vcc, vcc, s[100:101]
  s_cbranch_scc1 mr_108
mo_112:
  s_barrier
  ds_read_b128 v[48:51], v4 offset:0
  ds_read_b128 v[52:55], v4 offset:1024
  v_smfmac_f32_16x16x64_bf16 v[92:95], v[76:79], v[232:239], v22
  ds_read_b128 v[56:59], v4 offset:2048
  ds_read_b128 v[60:63], v4 offset:3072
  v_smfmac_f32_16x16x64_bf16 v[88:91], v[76:79], a[216:223], v22
  s_add_u32 m0, s74, 0
  s_add_u32 s21, s79, 0
  buffer_load_dwordx4 v4, s[16:19], s21 offen offset:1024 sc1 lds
  v_smfmac_f32_16x16x64_bf16 v[92:95], v[80:83], v[240:247], v22
  ds_read_b128 v[64:67], v4 offset:4096
  ds_read_b128 v[68:71], v4 offset:5120
  s_add_u32 s22, s52, 3
  s_min_u32 s22, s22, 64
  v_smfmac_f32_16x16x64_bf16 v[88:91], v[80:83], a[224:231], v22
  s_add_u32 m0, s74, 2048
  s_add_u32 s21, s79, 65536
  buffer_load_dwordx4 v4, s[16:19], s21 offen offset:1024 sc1 lds
  v_cmp_gt_u32 vcc, s22, v42
  v_smfmac_f32_16x16x64_bf16 v[92:95], v[84:87], v[248:255], v22
  ds_read_b128 v[72:75], v4 offset:6144
  s_cbranch_vccnz kw_113
kv_114:
  v_smfmac_f32_16x16x64_bf16 v[88:91], v[84:87], a[232:239], v22
  s_waitcnt lgkmcnt(6)
  s_add_u32 m0, s74, 10240
  s_nop 0
  buffer_load_dwordx4 v4, s[16:19], s73 offen offset:0 sc1 lds
  v_smfmac_f32_16x16x64_bf16 v[92:95], v[48:51], a[240:247], v22
  v_smfmac_f32_16x16x64_bf16 v[88:91], v[48:51], a[160:167], v22
  s_waitcnt lgkmcnt(5)
  s_add_u32 m0, s74, 10240
  s_nop 0
  buffer_load_dwordx4 v4, s[16:19], s73 offen offset:1024 sc1 lds
  v_smfmac_f32_16x16x64_bf16 v[92:95], v[52:55], a[248:255], v22
  s_waitcnt lgkmcnt(4)
  v_smfmac_f32_16x16x64_bf16 v[92:95], v[56:59], v[192:199], v22
  s_waitcnt lgkmcnt(3)
  s_add_u32 m0, s74, 10240
  s_nop 0
  buffer_load_dwordx4 v4, s[16:19], s73 offen offset:2048 sc1 lds
  v_smfmac_f32_16x16x64_bf16 v[92:95], v[60:63], v[200:207], v22
  s_waitcnt lgkmcnt(2)
  v_smfmac_f32_16x16x64_bf16 v[92:95], v[64:67], v[208:215], v22
  s_waitcnt lgkmcnt(1)
  s_add_u32 m0, s74, 0
  s_mul_i32 s21, s91, 0
  s_add_u32 s21, s21, s71
  buffer_load_dwordx4 v4, s[16:19], s21 offen sc1 lds
  v_smfmac_f32_16x16x64_bf16 v[92:95], v[68:71], v[216:223], v22
  s_waitcnt lgkmcnt(0)
  v_smfmac_f32_16x16x64_bf16 v[92:95], v[72:75], v[224:231], v22
  s_add_u32 m0, s74, 2048
  s_mul_i32 s21, s91, 1
  s_add_u32 s21, s21, s71
  buffer_load_dwordx4 v4, s[16:19], s21 offen sc1 lds
  v_smfmac_f32_16x16x64_bf16 v[88:91], v[52:55], a[168:175], v22
  v_smfmac_f32_16x16x64_bf16 v[88:91], v[56:59], a[176:183], v22
  v_smfmac_f32_16x16x64_bf16 v[88:91], v[60:63], a[184:191], v22
  v_cvt_pk_bf16_f32 v122, v92, v93
  v_smfmac_f32_16x16x64_bf16 v[88:91], v[64:67], a[192:199], v22
  v_cvt_pk_bf16_f32 v123, v94, v95
  s_barrier
  v_smfmac_f32_16x16x64_bf16 v[88:91], v[68:71], a[200:207], v22
  ds_write_b64 v12, v[122:123] offset:13056
  v_smfmac_f32_16x16x64_bf16 v[88:91], v[72:75], a[208:215], v22
  v_smfmac_f32_16x16x64_bf16 v[96:99], v[48:51], a[0:7], v22
  v_smfmac_f32_16x16x64_bf16 v[100:103], v[48:51], a[80:87], v22
  v_smfmac_f32_16x16x64_bf16 v[96:99], v[52:55], a[8:15], v22
  v_cvt_pk_bf16_f32 v120, v88, v89
  v_cvt_pk_bf16_f32 v121, v90, v91
  ds_write_b64 v12, v[120:121] offset:12544
  v_smfmac_f32_16x16x64_bf16 v[100:103], v[52:55], a[88:95], v22
  s_waitcnt lgkmcnt(0)
  s_barrier
  ds_read_b64_tr_b16 v[104:105], v7 offset:0
  ds_read_b64_tr_b16 v[106:107], v7 offset:768
  ds_read_b64_tr_b16 v[108:109], v7 offset:1536
  ds_read_b32 v27, v12 offset:12544
  ds_read_b64 v[140:141], v11
  s_waitcnt lgkmcnt(1)
  v_cmp_u_f32 vcc, v104, v106
  v_cmp_u_f32 s[22:23], v108, v27
  s_nop 1
  s_or_b64 vcc, vcc, s[22:23]
  s_cbranch_vccnz mn_109
mk_110:
  s_cmp_eq_u32 s52, 63
  s_cbranch_scc1 last_111
  v_permlane32_swap_b32 v88, v92
  v_permlane32_swap_b32 v89, v93
  v_permlane32_swap_b32 v90, v94
  v_permlane32_swap_b32 v91, v95
  v_pk_add_f32 v[88:89], v[88:89], v[92:93]
  v_pk_add_f32 v[90:91], v[90:91], v[94:95]
  v_cvt_pk_bf16_f32 v92, v88, v89
  v_cvt_pk_bf16_f32 v93, v90, v91
  v_min_u32 v92, -2, v92
  s_nop 0
  v_smfmac_f32_16x16x64_bf16 v[96:99], v[56:59], a[16:23], v22
  v_smfmac_f32_16x16x64_bf16 v[100:103], v[56:59], a[96:103], v22
  v_smfmac_f32_16x16x64_bf16 v[96:99], v[60:63], a[24:31], v22
  v_smfmac_f32_16x16x64_bf16 v[96:99], v[64:67], a[32:39], v22
  v_smfmac_f32_16x16x64_bf16 v[96:99], v[68:71], a[40:47], v22
  v_smfmac_f32_16x16x64_bf16 v[96:99], v[72:75], a[48:55], v22
  v_smfmac_f32_16x16x64_bf16 v[96:99], v[76:79], a[56:63], v22
  v_smfmac_f32_16x16x64_bf16 v[96:99], v[80:83], a[64:71], v22
  v_smfmac_f32_16x16x64_bf16 v[96:99], v[84:87], a[72:79], v22
  v_smfmac_f32_16x16x64_bf16 v[100:103], v[60:63], a[104:111], v22
  v_smfmac_f32_16x16x64_bf16 v[100:103], v[64:67], a[112:119], v22
  buffer_load_dwordx4 v[132:135], v10, s[8:11], s56 offen sc1
  v_smfmac_f32_16x16x64_bf16 v[100:103], v[68:71], a[120:127], v22
  buffer_load_dwordx4 v[124:127], v9, s[8:11], s56 offen sc1
  v_smfmac_f32_16x16x64_bf16 v[100:103], v[72:75], a[128:135], v22
  buffer_load_dwordx4 v[128:131], v9, s[8:11], s56 offen offset:1024 sc1
  v_cvt_pk_bf16_f32 v136, v96, v97
  v_smfmac_f32_16x16x64_bf16 v[100:103], v[76:79], a[136:143], v22
  v_cvt_pk_bf16_f32 v137, v98, v99
  v_smfmac_f32_16x16x64_bf16 v[100:103], v[80:83], a[144:151], v22
  v_smfmac_f32_16x16x64_bf16 v[100:103], v[84:87], a[152:159], v22
  s_nop 7
  v_cvt_pk_bf16_f32 v138, v100, v101
  v_cvt_pk_bf16_f32 v139, v102, v103
  v_permlane32_swap_b32 v96, v100
  v_permlane32_swap_b32 v97, v101
  v_permlane32_swap_b32 v98, v102
  v_permlane32_swap_b32 v99, v103
  v_pk_add_f32 v[96:97], v[96:97], v[100:101]
  v_pk_add_f32 v[98:99], v[98:99], v[102:103]
  v_cvt_pk_bf16_f32 v100, v96, v97
  v_cvt_pk_bf16_f32 v101, v98, v99
  s_nop 0
  v_permlane32_swap_b32 v100, v102
  v_permlane32_swap_b32 v101, v103
  v_min_u32 v100, -2, v100
  s_waitcnt vmcnt(2) lgkmcnt(0)
  v_pk_add_f16 v164, v132, v133
  v_pk_add_f16 v165, v134, v135
  v_fma_mix_f32 v170, v164, 1.0, v165 op_sel:[0,0,0] op_sel_hi:[1,0,1]
  v_fma_mix_f32 v171, v164, 1.0, v165 op_sel:[1,0,1] op_sel_hi:[1,0,1]
  v_exp_f32 v176, v170
  v_exp_f32 v177, v171
  s_waitcnt vmcnt(1)
  v_cvt_pk_bf16_f32 v160, v176, v177
  v_pk_add_f16 v120, v124, v126
  v_pk_add_f16 v121, v125, v127
  v_mov_b32_dpp v161, v160 row_ror:8 row_mask:0xf bank_mask:0xf
  s_waitcnt vmcnt(0)
  v_pk_add_f16 v122, v128, v130
  v_mfma_f32_16x16x32_bf16 v[178:181], v[140:143], v[160:163], 0
  v_fma_mix_f32 v166, v120, 1.0, v122 op_sel:[0,0,0] op_sel_hi:[1,0,1]
  v_fma_mix_f32 v167, v120, 1.0, v122 op_sel:[1,0,1] op_sel_hi:[1,0,1]
  v_cmp_u_f32 vcc, v166, v170
  v_pk_add_f16 v123, v129, v131
  v_exp_f32 v172, v166
  v_mfma_f32_16x16x32_bf16 v[182:185], v[136:139], v[160:163], 0
  s_cbranch_vccnz sr_117
  v_exp_f32 v173, v167
  v_fma_mix_f32 v168, v121, 1.0, v123 op_sel:[0,0,0] op_sel_hi:[1,0,1]
  v_fma_mix_f32 v169, v121, 1.0, v123 op_sel:[1,0,1] op_sel_hi:[1,0,1]
  v_cvt_pk_bf16_f32 v156, v172, v173
  v_exp_f32 v174, v168
  v_exp_f32 v175, v169
  v_mov_b32_dpp v158, v156 row_ror:8 row_mask:0xf bank_mask:0xf
  v_cvt_pk_bf16_f32 v157, v174, v175
  v_mfma_f32_16x16x32_bf16 v[186:189], v[138:141], v[160:163], 0
  s_nop 0
  v_mov_b32_dpp v159, v157 row_ror:8 row_mask:0xf bank_mask:0xf
  s_nop 1
pv_118:
  v_mfma_f32_16x16x32_bf16 v[178:181], v[152:155], v[156:159], v[178:181]
  v_mfma_f32_16x16x32_bf16 v[182:185], v[144:147], v[156:159], v[182:185]
  v_mfma_f32_16x16x32_bf16 v[186:189], v[148:151], v[156:159], v[186:189]
  s_mov_b64 exec, s[62:63]
  s_nop 0
  v_rcp_f32 v164, v180
  v_cmp_ngt_f32 s[22:23], s80, v180
  v_cmp_ngt_f32 vcc, s80, v164
  v_pk_mul_f32 v[182:183], v[182:183], v[164:165] op_sel_hi:[1,0]
  v_pk_mul_f32 v[184:185], v[184:185], v[164:165] op_sel_hi:[1,0]
  v_pk_mul_f32 v[178:179], v[178:179], v[164:165] op_sel_hi:[1,0]
  v_pk_mul_f32 v[186:187], v[186:187], v[164:165] op_sel_hi:[1,0]
  v_pk_mul_f32 v[188:189], v[188:189], v[164:165] op_sel_hi:[1,0]
  v_cvt_pk_f16_f32 v64, v178, v179
  s_or_b64 vcc, vcc, s[22:23]
  s_cbranch_scc1 fx_120
fk_121:
  ds_write_b32 v14, v64
  v_cvt_pk_f16_f32 v60, v182, v183
  v_cvt_pk_f16_f32 v61, v184, v185
  v_cvt_pk_f16_f32 v62, v186, v187
  v_cvt_pk_f16_f32 v63, v188, v189
  ds_write_b128 v13, v[60:63]
  s_mov_b64 exec, s[66:67]
  s_barrier
  ds_read_b128 v[166:169], v4 offset:13824
  ds_read_b128 v[170:173], v4 offset:14464
  ds_read_b128 v[174:177], v4 offset:15104
  ds_read_b128 v[178:181], v4 offset:15744
  s_waitcnt lgkmcnt(2)
  v_pk_add_f16 v166, v166, v170
  v_pk_add_f16 v167, v167, v171
  v_pk_add_f16 v168, v168, v172
  v_pk_add_f16 v169, v169, v173
  s_waitcnt lgkmcnt(1)
  v_pk_add_f16 v166, v166, v174
  v_pk_add_f16 v167, v167, v175
  v_pk_add_f16 v168, v168, v176
  v_pk_add_f16 v169, v169, v177
  s_waitcnt lgkmcnt(0)
  v_pk_add_f16 v166, v166, v178
  v_cmpx_o_f16 vcc, v166, v166
  v_pk_add_f16 v167, v167, v179
  v_pk_add_f16 v168, v168, v180
  v_pk_add_f16 v169, v169, v181
  v_and_or_b32 v166, v166, -2, s61
  buffer_store_dwordx4 v[166:169], v15, s[4:7], s60 offen sc1
  s_xor_b64 s[98:99], exec, s[66:67]
  s_mov_b64 exec, -1
  buffer_store_dwordx4 v[100:103], v26, s[16:19], s70 offen sc1
  buffer_store_dwordx2 v[92:93], v43, s[16:19], s70 offen sc1
  s_add_u32 s70, s70, 2097152
  s_xor_b32 s70, s70, 8192
  ds_read_b128 v[144:147], v18
  ds_read_b128 v[148:151], v18 offset:1024
  ds_read_b128 v[152:155], v19
  v_xor_b32 v18, 16384, v18
  v_xor_b32 v19, 16384, v19
  v_mov_b32 v88, 0
  v_mov_b32 v89, 0
  v_mov_b32 v90, 0
  v_mov_b32 v91, 0
  v_mov_b32 v92, 0
  v_mov_b32 v93, 0
  v_mov_b32 v94, 0
  v_mov_b32 v95, 0
  v_mov_b32 v96, 0
  v_mov_b32 v97, 0
  v_mov_b32 v98, 0
  v_mov_b32 v99, 0
  v_mov_b32 v100, 0
  v_mov_b32 v101, 0
  v_mov_b32 v102, 0
  v_mov_b32 v103, 0
  s_mov_b32 s81, 0
  s_waitcnt lgkmcnt(0)
  s_barrier
  s_cmp_lg_u64 s[98:99], 0
  s_cbranch_scc1 pf_122
pf_123:
  s_xor_b32 s74, s74, 16384
  s_add_u32 s73, s73, 2097152
  s_xor_b32 s73, s73, 8192
  s_add_u32 s79, s79, 2097152
  s_xor_b32 s79, s79, 8192
  s_add_u32 s21, s72, 524288
  s_xor_b32 s72, s72, s21
  s_lshr_b32 s72, s72, 8
  s_and_b32 s72, s72, 8192
  s_xor_b32 s72, s72, s21
  s_add_u32 s71, s73, 4096
  s_mov_b32 s91, 1024
  s_sub_u32 s21, s73, 0
  s_cmp_lt_u32 s21, 125829120
  s_cselect_b32 s71, s71, s79
  s_cselect_b32 s91, s91, 65536
  v_mov_b32 v166, s52
  s_add_u32 s22, s52, 5
  s_min_u32 s22, s22, 64
  v_cmp_gt_u32 vcc, s22, v42
  s_cbranch_vccz fv_125
  buffer_load_dword v42, v41, s[12:15], s76 offen sc1
fv_125:
  ds_write_b128 v190, v[28:31] offset:0
  ds_write_b128 v190, v[28:31] offset:1024
  ds_write_b128 v190, v[28:31] offset:2048
nt_124:
  s_barrier
  s_mov_b32 s58, s55
  s_add_u32 s52, s52, 1
  ds_write_b32 v13, v28
  ds_write_b32 v14, v28
  s_and_b32 s21, s52, 3
  s_mul_i32 s56, s21, 122880
  s_add_u32 s21, s52, 1
  s_and_b32 s21, s21, 3
  s_mul_i32 s55, s21, 122880
  s_add_u32 s55, s55, s75
  s_add_u32 s21, s52, 2
  s_and_b32 s21, s21, 3
  s_mul_i32 s57, s21, 122880
  s_add_u32 s21, s52, 3
  s_and_b32 s21, s21, 3
  s_mul_i32 s59, s21, 122880
  s_add_u32 s59, s59, s75
  s_bfe_u32 s61, s52, 0x10002
  s_and_b32 s21, s52, 3
  s_lshl_b32 s60, s21, 18
  s_mov_b32 s54, 0
  s_sleep 2
  s_nop 10
  s_waitcnt lgkmcnt(0)
  buffer_load_dwordx4 v[76:79], v190, s[8:11], s58 offen offset:0 sc1
  buffer_load_dwordx4 v[80:83], v190, s[8:11], s58 offen offset:1024 sc1
  buffer_load_dwordx4 v[84:87], v190, s[8:11], s58 offen offset:2048 sc1
  s_branch top_107
mr_108:
  s_mov_b64 exec, s[22:23]
  s_cbranch_execz ms_126
  buffer_load_dwordx4 v[76:79], v190, s[8:11], s58 offen offset:0 sc1
ms_126:
  s_mov_b64 exec, s[98:99]
  s_cbranch_execz ms_127
  buffer_load_dwordx4 v[80:83], v190, s[8:11], s58 offen offset:1024 sc1
ms_127:
  s_mov_b64 exec, s[100:101]
  s_cbranch_execz ms_128
  buffer_load_dwordx4 v[84:87], v190, s[8:11], s58 offen offset:2048 sc1
ms_128:
  s_add_u32 s54, s54, 1
  s_cmp_gt_u32 s54, 131072
  s_cbranch_scc1 end0
  s_waitcnt vmcnt(0)
  s_mov_b64 exec, s[22:23]
  ds_write_b128 v190, v[76:79] offset:0
  v_cmp_eq_u32 s[22:23], -1, v76
  s_mov_b64 exec, s[98:99]
  ds_write_b128 v190, v[80:83] offset:1024
  v_cmp_eq_u32 s[98:99], -1, v80
  s_mov_b64 exec, s[100:101]
  ds_write_b128 v190, v[84:87] offset:2048
  v_cmp_eq_u32 s[100:101], -1, v84
  s_mov_b64 exec, -1
  s_or_b64 vcc, s[22:23], s[98:99]
  s_or_b64 vcc, vcc, s[100:101]
  s_cbranch_scc1 mr_108
  s_branch mo_112
kw_113:
  s_mov_b32 s101, 0
wm_129:
  buffer_load_dword v42, v41, s[12:15], s76 offen sc1
  s_add_u32 s101, s101, 1
  s_cmp_gt_u32 s101, 131072
  s_cbranch_scc1 end0
  s_waitcnt vmcnt(0)
  v_cmp_gt_u32 vcc, s22, v42
  v_readfirstlane_b32 s100, v42
  s_nop 0
  s_cbranch_vccz wm_130
  s_sleep 1
  s_branch wm_129
wm_130:
  s_branch kv_114
mn_109:
  s_bitcmp1_b32 s81, 1
  s_cbranch_scc1 mk_110
  s_or_b32 s81, s81, 2
  s_nop 7
  v_mov_b32 v88, 0
  v_mov_b32 v89, 0
  v_mov_b32 v90, 0
  v_mov_b32 v91, 0
  v_mov_b32 v92, 0
  v_mov_b32 v93, 0
  v_mov_b32 v94, 0
  v_mov_b32 v95, 0
  v_mov_b32 v96, 0
  v_mov_b32 v97, 0
  v_mov_b32 v98, 0
  v_mov_b32 v99, 0
  v_mov_b32 v100, 0
  v_mov_b32 v101, 0
  v_mov_b32 v102, 0
  v_mov_b32 v103, 0
  s_cmp_eq_u32 s52, 0
  s_cbranch_scc1 mx_132
mx_131:
  buffer_load_dwordx4 v[76:79], v190, s[8:11], s58 offen offset:0 sc1
  buffer_load_dwordx4 v[80:83], v190, s[8:11], s58 offen offset:1024 sc1
  buffer_load_dwordx4 v[84:87], v190, s[8:11], s58 offen offset:2048 sc1
  s_add_u32 s54, s54, 1
  s_cmp_gt_u32 s54, 131072
  s_cbranch_scc1 end0
  s_waitcnt vmcnt(0)
  v_max3_u32 v27, v76, v77, v78
  v_max3_u32 v27, v27, v79, v80
  v_max3_u32 v27, v27, v81, v82
  v_max3_u32 v27, v27, v83, v84
  v_max3_u32 v27, v27, v85, v86
  v_max3_u32 v27, v27, v87, v87
  v_cmp_eq_u32 vcc, -1, v27
  s_nop 1
  s_cbranch_vccnz mx_131
  ds_write_b128 v190, v[76:79] offset:0
  ds_write_b128 v190, v[80:83] offset:1024
  ds_write_b128 v190, v[84:87] offset:2048
mx_132:
  s_waitcnt lgkmcnt(0)
  s_branch mo_112
sr_117:
  s_mov_b32 s54, 0
sr_133:
  s_mov_b64 exec, vcc
  buffer_load_dwordx4 v[124:127], v9, s[8:11], s56 offen sc1
  buffer_load_dwordx4 v[128:131], v9, s[8:11], s56 offen offset:1024 sc1
  buffer_load_dwordx4 v[132:135], v10, s[8:11], s56 offen sc1
  s_mov_b64 exec, -1
  s_add_u32 s54, s54, 1
  s_cmp_gt_u32 s54, 131072
  s_cbranch_scc1 end0
  s_waitcnt vmcnt(0)
  v_pk_add_f16 v164, v132, v133
  v_pk_add_f16 v165, v134, v135
  v_pk_add_f16 v120, v124, v126
  v_pk_add_f16 v122, v128, v130
  v_fma_mix_f32 v170, v164, 1.0, v165 op_sel:[0,0,0] op_sel_hi:[1,0,1]
  v_fma_mix_f32 v166, v120, 1.0, v122 op_sel:[0,0,0] op_sel_hi:[1,0,1]
  v_pk_add_f16 v121, v125, v127
  v_cmp_u_f32 vcc, v166, v170
  v_pk_add_f16 v123, v129, v131
  v_fma_mix_f32 v171, v164, 1.0, v165 op_sel:[1,0,1] op_sel_hi:[1,0,1]
  v_fma_mix_f32 v167, v120, 1.0, v122 op_sel:[1,0,1] op_sel_hi:[1,0,1]
  v_fma_mix_f32 v168, v121, 1.0, v123 op_sel:[0,0,0] op_sel_hi:[1,0,1]
  v_fma_mix_f32 v169, v121, 1.0, v123 op_sel:[1,0,1] op_sel_hi:[1,0,1]
  s_cbranch_vccz ex_119
  s_and_b32 s21, s54, 31
  s_cbranch_scc1 sr_133
  v_max3_u32 v27, v124, v126, v128
  v_max3_u32 v27, v27, v130, v132
  v_max3_u32 v27, v27, v133, v134
  v_max3_u32 v27, v27, v135, v135
  v_cmp_eq_u32 vcc, -1, v27
  s_nop 1
  s_cbranch_vccnz sr_133
ex_119:
  v_exp_f32 v176, v170
  v_exp_f32 v177, v171
  v_exp_f32 v172, v166
  v_cvt_pk_bf16_f32 v160, v176, v177
  v_exp_f32 v173, v167
  v_exp_f32 v174, v168
  v_mov_b32_dpp v161, v160 row_ror:8 row_mask:0xf bank_mask:0xf
  v_cvt_pk_bf16_f32 v156, v172, v173
  v_exp_f32 v175, v169
  v_mfma_f32_16x16x32_bf16 v[178:181], v[140:143], v[160:163], 0
  v_mov_b32_dpp v158, v156 row_ror:8 row_mask:0xf bank_mask:0xf
  v_cvt_pk_bf16_f32 v157, v174, v175
  v_mfma_f32_16x16x32_bf16 v[182:185], v[136:139], v[160:163], 0
  s_nop 0
  v_mov_b32_dpp v159, v157 row_ror:8 row_mask:0xf bank_mask:0xf
  v_mfma_f32_16x16x32_bf16 v[186:189], v[138:141], v[160:163], 0
  s_branch pv_118
fx_120:
  s_bitcmp1_b32 s81, 0
  s_cbranch_scc1 fk_121
  s_or_b32 s81, s81, 1
  s_mov_b64 exec, -1
  v_max3_f32 v164, v166, v167, v168
  v_max3_f32 v165, v169, v170, v171
  v_max_f32 v164, v164, v165
  s_nop 1
  v_max_f32_dpp v164, v164, v164 row_ror:8 row_mask:0xf bank_mask:0xf
  v_mov_b32 v165, v164
  s_nop 1
  v_permlane32_swap_b32 v164, v165
  v_max_f32 v164, v164, v165
  v_mov_b32 v165, v164
  s_nop 1
  v_permlane16_swap_b32 v164, v165
  v_max_f32 v164, v164, v165
  v_sub_f32 v166, v166, v164
  v_sub_f32 v167, v167, v164
  v_sub_f32 v168, v168, v164
  v_sub_f32 v169, v169, v164
  v_sub_f32 v170, v170, v164
  v_sub_f32 v171, v171, v164
  s_branch ex_119
pf_122:
  s_mov_b64 exec, s[66:67]
  ds_read_b128 v[166:169], v4 offset:13824
  ds_read_b128 v[170:173], v4 offset:14464
  ds_read_b128 v[174:177], v4 offset:15104
  ds_read_b128 v[178:181], v4 offset:15744
  s_waitcnt lgkmcnt(2)
  v_pk_add_f16 v166, v166, v170
  v_pk_add_f16 v167, v167, v171
  v_pk_add_f16 v168, v168, v172
  v_pk_add_f16 v169, v169, v173
  s_waitcnt lgkmcnt(1)
  v_pk_add_f16 v166, v166, v174
  v_pk_add_f16 v167, v167, v175
  v_pk_add_f16 v168, v168, v176
  v_pk_add_f16 v169, v169, v177
  s_waitcnt lgkmcnt(0)
  v_pk_add_f16 v166, v166, v178
  v_pk_add_f16 v167, v167, v179
  v_pk_add_f16 v168, v168, v180
  v_pk_add_f16 v169, v169, v181
  v_and_or_b32 v166, v166, -2, s61
  buffer_store_dwordx4 v[166:169], v15, s[4:7], s60 offen sc1
  s_mov_b64 exec, -1
  s_nop 1
  s_branch pf_123
last_111:
  v_permlane32_swap_b32 v88, v92
  v_permlane32_swap_b32 v89, v93
  v_permlane32_swap_b32 v90, v94
  v_permlane32_swap_b32 v91, v95
  v_pk_add_f32 v[88:89], v[88:89], v[92:93]
  v_pk_add_f32 v[90:91], v[90:91], v[94:95]
  v_cvt_pk_bf16_f32 v92, v88, v89
  v_cvt_pk_bf16_f32 v93, v90, v91
  v_min_u32 v92, -2, v92
  buffer_store_dwordx2 v[92:93], v43, s[16:19], s70 offen sc1
  v_smfmac_f32_16x16x64_bf16 v[96:99], v[56:59], a[16:23], v22
  v_smfmac_f32_16x16x64_bf16 v[100:103], v[56:59], a[96:103], v22
  v_smfmac_f32_16x16x64_bf16 v[96:99], v[60:63], a[24:31], v22
  v_smfmac_f32_16x16x64_bf16 v[96:99], v[64:67], a[32:39], v22
  v_smfmac_f32_16x16x64_bf16 v[96:99], v[68:71], a[40:47], v22
  v_smfmac_f32_16x16x64_bf16 v[96:99], v[72:75], a[48:55], v22
  v_smfmac_f32_16x16x64_bf16 v[96:99], v[76:79], a[56:63], v22
  v_smfmac_f32_16x16x64_bf16 v[96:99], v[80:83], a[64:71], v22
  v_smfmac_f32_16x16x64_bf16 v[96:99], v[84:87], a[72:79], v22
  v_smfmac_f32_16x16x64_bf16 v[100:103], v[60:63], a[104:111], v22
  v_smfmac_f32_16x16x64_bf16 v[100:103], v[64:67], a[112:119], v22
  v_smfmac_f32_16x16x64_bf16 v[100:103], v[68:71], a[120:127], v22
  v_smfmac_f32_16x16x64_bf16 v[100:103], v[72:75], a[128:135], v22
  v_smfmac_f32_16x16x64_bf16 v[100:103], v[76:79], a[136:143], v22
  v_smfmac_f32_16x16x64_bf16 v[100:103], v[80:83], a[144:151], v22
  v_smfmac_f32_16x16x64_bf16 v[100:103], v[84:87], a[152:159], v22
  s_nop 7
  v_permlane32_swap_b32 v96, v100
  v_permlane32_swap_b32 v97, v101
  v_permlane32_swap_b32 v98, v102
  v_permlane32_swap_b32 v99, v103
  v_pk_add_f32 v[96:97], v[96:97], v[100:101]
  v_pk_add_f32 v[98:99], v[98:99], v[102:103]
  v_cvt_pk_bf16_f32 v100, v96, v97
  v_cvt_pk_bf16_f32 v101, v98, v99
  s_nop 0
  v_permlane32_swap_b32 v100, v102
  v_permlane32_swap_b32 v101, v103
  v_min_u32 v100, -2, v100
  buffer_store_dwordx4 v[100:103], v26, s[16:19], s70 offen sc1
  s_waitcnt vmcnt(0)
  s_barrier
  v_mov_b32 v166, 64
  s_mov_b64 exec, 1
  buffer_store_dword v166, v23, s[12:15], s77 offen sc1
  s_mov_b64 exec, -1
  s_branch chain_done
E_25:
  v_add_u32 v190, 0, v4
  ds_write_b64 v6, v[28:29]
  ds_write_b32 v13, v28
  ds_write_b32 v14, v28
  s_waitcnt vmcnt(0)
  ds_write_b128 v190, v[48:51] offset:0
  ds_write_b128 v190, v[52:55] offset:1024
  s_waitcnt lgkmcnt(0)
  s_add_u32 m0, s74, 4096
  s_add_u32 s21, s79, 131072
  buffer_load_dwordx4 v4, s[16:19], s21 offen offset:1024 sc1 lds
  s_add_u32 m0, s74, 9216
  s_add_u32 s21, s72, 32768
  buffer_load_dwordx4 v32, s[16:19], s21 offen sc1 lds
  s_xor_b32 s74, s74, 16384
  s_add_u32 s73, s73, 2097152
  s_xor_b32 s73, s73, 8192
  s_add_u32 s79, s79, 2097152
  s_xor_b32 s79, s79, 8192
  s_add_u32 s21, s72, 524288
  s_xor_b32 s72, s72, s21
  s_lshr_b32 s72, s72, 8
  s_and_b32 s72, s72, 8192
  s_xor_b32 s72, s72, s21
  s_add_u32 s71, s73, 4096
  s_mov_b32 s91, 1024
  s_sub_u32 s21, s73, 0
  s_cmp_lt_u32 s21, 125829120
  s_cselect_b32 s71, s71, s79
  s_cselect_b32 s91, s91, 65536
  s_branch mo_140
  .p2align 3
top_135:
  s_waitcnt vmcnt(1)
  ds_write_b128 v190, v[48:51] offset:0
  v_cmp_eq_u32 s[22:23], -1, v48
  s_waitcnt vmcnt(0)
  ds_write_b128 v190, v[52:55] offset:1024
  v_cmp_eq_u32 s[98:99], -1, v52
  s_or_b64 vcc, s[22:23], s[98:99]
  s_cbranch_scc1 mr_136
mo_140:
  s_barrier
  ds_read_b128 v[56:59], v4 offset:2048
  ds_read_b128 v[60:63], v4 offset:3072
  v_smfmac_f32_16x16x64_bf16 v[92:95], v[48:51], a[240:247], v22
  ds_read_b128 v[64:67], v4 offset:4096
  v_smfmac_f32_16x16x64_bf16 v[88:91], v[48:51], a[160:167], v22
  ds_read_b128 v[68:71], v4 offset:5120
  v_smfmac_f32_16x16x64_bf16 v[92:95], v[52:55], a[248:255], v22
  ds_read_b128 v[72:75], v4 offset:6144
  v_smfmac_f32_16x16x64_bf16 v[88:91], v[52:55], a[168:175], v22
  s_waitcnt lgkmcnt(4)
  ds_read_b128 v[76:79], v4 offset:7168
  v_smfmac_f32_16x16x64_bf16 v[92:95], v[56:59], v[192:199], v22
  ds_read_b128 v[80:83], v4 offset:8192
  v_smfmac_f32_16x16x64_bf16 v[88:91], v[56:59], a[176:183], v22
  s_waitcnt lgkmcnt(5)
  ds_read_b128 v[84:87], v4 offset:9216
  v_smfmac_f32_16x16x64_bf16 v[92:95], v[60:63], v[200:207], v22
  v_smfmac_f32_16x16x64_bf16 v[88:91], v[60:63], a[184:191], v22
  s_waitcnt lgkmcnt(5)
  v_smfmac_f32_16x16x64_bf16 v[92:95], v[64:67], v[208:215], v22
  s_waitcnt lgkmcnt(4)
  v_smfmac_f32_16x16x64_bf16 v[92:95], v[68:71], v[216:223], v22
  s_waitcnt lgkmcnt(3)
  v_smfmac_f32_16x16x64_bf16 v[92:95], v[72:75], v[224:231], v22
  s_waitcnt lgkmcnt(2)
  v_smfmac_f32_16x16x64_bf16 v[92:95], v[76:79], v[232:239], v22
  s_waitcnt lgkmcnt(1)
  v_smfmac_f32_16x16x64_bf16 v[92:95], v[80:83], v[240:247], v22
  s_waitcnt lgkmcnt(0)
  v_smfmac_f32_16x16x64_bf16 v[92:95], v[84:87], v[248:255], v22
  v_smfmac_f32_16x16x64_bf16 v[88:91], v[64:67], a[192:199], v22
  v_smfmac_f32_16x16x64_bf16 v[88:91], v[68:71], a[200:207], v22
  v_smfmac_f32_16x16x64_bf16 v[88:91], v[72:75], a[208:215], v22
  v_permlane32_swap_b32 v92, v93
  v_smfmac_f32_16x16x64_bf16 v[88:91], v[76:79], a[216:223], v22
  v_permlane32_swap_b32 v94, v95
  v_smfmac_f32_16x16x64_bf16 v[88:91], v[80:83], a[224:231], v22
  v_permlane32_swap_b32 v93, v92
  v_smfmac_f32_16x16x64_bf16 v[88:91], v[84:87], a[232:239], v22
  v_permlane32_swap_b32 v95, v94
  v_pk_mul_f32 v[120:121], v[92:93], v[24:25] op_sel:[1,0] op_sel_hi:[0,1]
  v_pk_mul_f32 v[122:123], v[94:95], v[24:25] op_sel:[1,0] op_sel_hi:[0,1]
  s_nop 4
  v_pk_fma_f32 v[88:89], v[88:89], v[24:25], v[120:121]
  v_pk_fma_f32 v[90:91], v[90:91], v[24:25], v[122:123]
  v_cvt_pk_bf16_f32 v120, v88, v89
  v_cvt_pk_bf16_f32 v121, v90, v91
  ds_write_b64 v6, v[120:121]
  s_barrier
  ds_read_b64_tr_b16 v[104:105], v7 offset:0
  ds_read_b64_tr_b16 v[106:107], v7 offset:768
  ds_read_b64_tr_b16 v[108:109], v7 offset:1536
  s_waitcnt lgkmcnt(1)
  v_mfma_f32_16x16x32_bf16 v[120:123], v[112:115], v[104:107], 0
  s_waitcnt lgkmcnt(0)
  v_mfma_f32_16x16x32_bf16 v[120:123], v[116:119], v[108:111], v[120:123]
  s_mov_b64 exec, s[64:65]
  s_nop 6
  v_cmpx_o_f32 vcc, v120, v121
  v_cvt_pk_f16_f32 v120, v120, v121
  v_cvt_pk_f16_f32 v121, v122, v123
  buffer_store_dwordx2 v[120:121], v8, s[8:11], s56 offen sc1
  s_xor_b64 s[98:99], exec, s[64:65]
  s_mov_b64 exec, -1
  s_waitcnt lgkmcnt(0)
  s_barrier
  ds_read_b64_tr_b16 v[104:105], v7 offset:0
  ds_read_b64_tr_b16 v[106:107], v7 offset:768
  ds_read_b64_tr_b16 v[108:109], v7 offset:1536
  ds_read_b32 v27, v12 offset:12544
  ds_read_b64 v[140:141], v11
  s_waitcnt lgkmcnt(1)
  v_cmp_u_f32 vcc, v104, v106
  v_cmp_u_f32 s[22:23], v108, v27
  s_nop 1
  s_or_b64 vcc, vcc, s[22:23]
  s_cbranch_vccnz mn_137
mk_138:
  s_cmp_eq_u32 s52, 63
  s_cbranch_scc1 last_139
  s_cmp_lg_u64 s[98:99], 0
  s_cbranch_scc1 sf_141
sf_142:
  s_nop 15
  s_nop 10
  v_smfmac_f32_16x16x64_bf16 v[96:99], v[48:51], a[0:7], v22
  v_smfmac_f32_16x16x64_bf16 v[100:103], v[48:51], a[80:87], v22
  v_smfmac_f32_16x16x64_bf16 v[96:99], v[52:55], a[8:15], v22
  v_smfmac_f32_16x16x64_bf16 v[100:103], v[52:55], a[88:95], v22
  v_smfmac_f32_16x16x64_bf16 v[96:99], v[56:59], a[16:23], v22
  v_smfmac_f32_16x16x64_bf16 v[100:103], v[56:59], a[96:103], v22
  buffer_load_dwordx4 v[132:135], v10, s[8:11], s56 offen sc1
  v_smfmac_f32_16x16x64_bf16 v[96:99], v[60:63], a[24:31], v22
  buffer_load_dwordx4 v[124:127], v9, s[8:11], s56 offen sc1
  v_smfmac_f32_16x16x64_bf16 v[96:99], v[64:67], a[32:39], v22
  buffer_load_dwordx4 v[128:131], v9, s[8:11], s56 offen offset:1024 sc1
  v_smfmac_f32_16x16x64_bf16 v[96:99], v[68:71], a[40:47], v22
  v_smfmac_f32_16x16x64_bf16 v[96:99], v[72:75], a[48:55], v22
  v_smfmac_f32_16x16x64_bf16 v[96:99], v[76:79], a[56:63], v22
  v_smfmac_f32_16x16x64_bf16 v[96:99], v[80:83], a[64:71], v22
  v_smfmac_f32_16x16x64_bf16 v[96:99], v[84:87], a[72:79], v22
  v_smfmac_f32_16x16x64_bf16 v[100:103], v[60:63], a[104:111], v22
  v_smfmac_f32_16x16x64_bf16 v[100:103], v[64:67], a[112:119], v22
  v_smfmac_f32_16x16x64_bf16 v[100:103], v[68:71], a[120:127], v22
  v_smfmac_f32_16x16x64_bf16 v[100:103], v[72:75], a[128:135], v22
  v_cvt_pk_bf16_f32 v136, v96, v97
  v_smfmac_f32_16x16x64_bf16 v[100:103], v[76:79], a[136:143], v22
  v_cvt_pk_bf16_f32 v137, v98, v99
  v_smfmac_f32_16x16x64_bf16 v[100:103], v[80:83], a[144:151], v22
  v_smfmac_f32_16x16x64_bf16 v[100:103], v[84:87], a[152:159], v22
  s_nop 7
  v_cvt_pk_bf16_f32 v138, v100, v101
  v_cvt_pk_bf16_f32 v139, v102, v103
  s_waitcnt vmcnt(2) lgkmcnt(0)
  v_pk_add_f16 v164, v132, v133
  v_pk_add_f16 v165, v134, v135
  v_fma_mix_f32 v170, v164, 1.0, v165 op_sel:[0,0,0] op_sel_hi:[1,0,1]
  v_fma_mix_f32 v171, v164, 1.0, v165 op_sel:[1,0,1] op_sel_hi:[1,0,1]
  v_exp_f32 v176, v170
  v_exp_f32 v177, v171
  s_waitcnt vmcnt(1)
  v_cvt_pk_bf16_f32 v160, v176, v177
  v_pk_add_f16 v120, v124, v126
  v_pk_add_f16 v121, v125, v127
  v_mov_b32_dpp v161, v160 row_ror:8 row_mask:0xf bank_mask:0xf
  s_waitcnt vmcnt(0)
  v_pk_add_f16 v122, v128, v130
  v_mfma_f32_16x16x32_bf16 v[178:181], v[140:143], v[160:163], 0
  v_fma_mix_f32 v166, v120, 1.0, v122 op_sel:[0,0,0] op_sel_hi:[1,0,1]
  v_fma_mix_f32 v167, v120, 1.0, v122 op_sel:[1,0,1] op_sel_hi:[1,0,1]
  v_cmp_u_f32 vcc, v166, v170
  v_pk_add_f16 v123, v129, v131
  v_exp_f32 v172, v166
  v_mfma_f32_16x16x32_bf16 v[182:185], v[136:139], v[160:163], 0
  s_cbranch_vccnz sr_143
  v_exp_f32 v173, v167
  v_fma_mix_f32 v168, v121, 1.0, v123 op_sel:[0,0,0] op_sel_hi:[1,0,1]
  v_fma_mix_f32 v169, v121, 1.0, v123 op_sel:[1,0,1] op_sel_hi:[1,0,1]
  v_cvt_pk_bf16_f32 v156, v172, v173
  v_exp_f32 v174, v168
  v_exp_f32 v175, v169
  v_mov_b32_dpp v158, v156 row_ror:8 row_mask:0xf bank_mask:0xf
  v_cvt_pk_bf16_f32 v157, v174, v175
  v_mfma_f32_16x16x32_bf16 v[186:189], v[138:141], v[160:163], 0
  s_nop 0
  v_mov_b32_dpp v159, v157 row_ror:8 row_mask:0xf bank_mask:0xf
  s_nop 1
pv_144:
  v_mfma_f32_16x16x32_bf16 v[178:181], v[152:155], v[156:159], v[178:181]
  v_mfma_f32_16x16x32_bf16 v[182:185], v[144:147], v[156:159], v[182:185]
  v_mfma_f32_16x16x32_bf16 v[186:189], v[148:151], v[156:159], v[186:189]
  s_mov_b64 exec, s[62:63]
  s_nop 0
  v_rcp_f32 v164, v180
  v_cmp_ngt_f32 s[22:23], s80, v180
  v_cmp_ngt_f32 vcc, s80, v164
  v_pk_mul_f32 v[182:183], v[182:183], v[164:165] op_sel_hi:[1,0]
  v_pk_mul_f32 v[184:185], v[184:185], v[164:165] op_sel_hi:[1,0]
  v_pk_mul_f32 v[178:179], v[178:179], v[164:165] op_sel_hi:[1,0]
  v_pk_mul_f32 v[186:187], v[186:187], v[164:165] op_sel_hi:[1,0]
  v_pk_mul_f32 v[188:189], v[188:189], v[164:165] op_sel_hi:[1,0]
  v_cvt_pk_f16_f32 v64, v178, v179
  s_or_b64 vcc, vcc, s[22:23]
  s_cbranch_scc1 fx_146
fk_147:
  ds_write_b32 v14, v64
  v_cvt_pk_f16_f32 v60, v182, v183
  v_cvt_pk_f16_f32 v61, v184, v185
  v_cvt_pk_f16_f32 v62, v186, v187
  v_cvt_pk_f16_f32 v63, v188, v189
  ds_write_b128 v13, v[60:63]
  s_barrier
  s_mov_b64 exec, -1
  s_add_u32 m0, s74, 4096
  s_add_u32 s21, s79, 131072
  buffer_load_dwordx4 v4, s[16:19], s21 offen offset:1024 sc1 lds
  s_add_u32 m0, s74, 9216
  s_add_u32 s21, s72, 32768
  buffer_load_dwordx4 v32, s[16:19], s21 offen sc1 lds
  s_xor_b32 s74, s74, 16384
  s_add_u32 s73, s73, 2097152
  s_xor_b32 s73, s73, 8192
  s_add_u32 s79, s79, 2097152
  s_xor_b32 s79, s79, 8192
  s_add_u32 s21, s72, 524288
  s_xor_b32 s72, s72, s21
  s_lshr_b32 s72, s72, 8
  s_and_b32 s72, s72, 8192
  s_xor_b32 s72, s72, s21
  s_add_u32 s71, s73, 4096
  s_mov_b32 s91, 1024
  s_sub_u32 s21, s73, 0
  s_cmp_lt_u32 s21, 125829120
  s_cselect_b32 s71, s71, s79
  s_cselect_b32 s91, s91, 65536
  v_permlane32_swap_b32 v96, v100
  v_permlane32_swap_b32 v97, v101
  v_permlane32_swap_b32 v98, v102
  v_permlane32_swap_b32 v99, v103
  v_pk_add_f32 v[96:97], v[96:97], v[100:101]
  v_pk_add_f32 v[98:99], v[98:99], v[102:103]
  v_cvt_pk_bf16_f32 v100, v96, v97
  v_cvt_pk_bf16_f32 v101, v98, v99
  s_nop 0
  v_permlane32_swap_b32 v100, v102
  v_permlane32_swap_b32 v101, v103
  v_min_u32 v100, -2, v100
  s_nop 6
  buffer_store_dwordx4 v[100:103], v26, s[16:19], s70 offen sc1
  v_min_u32 v104, -2, v104
  buffer_store_dwordx4 v[104:107], v36, s[16:19], s70 offen offset:2560 sc1
  s_add_u32 s70, s70, 2097152
  s_xor_b32 s70, s70, 8192
  ds_read_b128 v[144:147], v18
  ds_read_b128 v[148:151], v18 offset:1024
  ds_read_b128 v[152:155], v19
  ds_read_b128 v[112:115], v20
  ds_read_b64 v[116:117], v21
  v_xor_b32 v18, 16384, v18
  v_xor_b32 v19, 16384, v19
  v_xor_b32 v20, 16384, v20
  v_xor_b32 v21, 16384, v21
  v_mov_b32 v88, 0
  v_mov_b32 v89, 0
  v_mov_b32 v90, 0
  v_mov_b32 v91, 0
  v_mov_b32 v92, 0
  v_mov_b32 v93, 0
  v_mov_b32 v94, 0
  v_mov_b32 v95, 0
  v_mov_b32 v96, 0
  v_mov_b32 v97, 0
  v_mov_b32 v98, 0
  v_mov_b32 v99, 0
  v_mov_b32 v100, 0
  v_mov_b32 v101, 0
  v_mov_b32 v102, 0
  v_mov_b32 v103, 0
  s_mov_b32 s81, 0
  s_waitcnt lgkmcnt(0)
  s_barrier
  s_mov_b64 exec, s[64:65]
  buffer_store_dwordx2 v[28:29], v8, s[8:11], s57 offen sc1
  s_mov_b64 exec, -1
  ds_write_b128 v190, v[28:31] offset:0
  ds_write_b128 v190, v[28:31] offset:1024
  ds_write_b64 v6, v[28:29]
  s_mov_b64 exec, s[62:63]
  buffer_store_dword v28, v17, s[8:11], s59 offen sc1
  s_mov_b64 exec, -1
  s_sleep 3
  s_nop 1
  buffer_load_dwordx4 v[68:71], v16, s[4:7], s60 offen sc1
  s_sleep 3
  s_nop 1
  buffer_load_dwordx4 v[72:75], v16, s[4:7], s60 offen sc1
  s_waitcnt vmcnt(1)
  v_mfma_f32_16x16x32_f16 v[120:123], v[44:47], v[68:71], 0
  v_bitop3_b32 v27, v68, s61, 1 bitop3:0x28
  v_cmp_ne_u32 vcc, 0, v27
  s_nop 1
  s_cbranch_vccnz p2_152
  s_nop 2
pg_151:
  v_add_f32_dpp v120, v120, v120 row_ror:8 row_mask:0xf bank_mask:0xf
  v_add_f32_dpp v121, v121, v121 row_ror:8 row_mask:0xf bank_mask:0xf
  s_mov_b64 exec, s[62:63]
  v_cvt_pk_bf16_f32 v120, v120, v121
  v_min_u32 v120, -2, v120
  buffer_store_dword v120, v17, s[8:11], s55 offen sc1
  s_mov_b64 exec, -1
nt_148:
  s_barrier
  s_mov_b32 s58, s55
  s_add_u32 s52, s52, 1
  ds_write_b32 v13, v28
  ds_write_b32 v14, v28
  s_and_b32 s21, s52, 3
  s_mul_i32 s56, s21, 122880
  s_add_u32 s21, s52, 1
  s_and_b32 s21, s21, 3
  s_mul_i32 s55, s21, 122880
  s_add_u32 s55, s55, s75
  s_add_u32 s21, s52, 2
  s_and_b32 s21, s21, 3
  s_mul_i32 s57, s21, 122880
  s_add_u32 s21, s52, 3
  s_and_b32 s21, s21, 3
  s_mul_i32 s59, s21, 122880
  s_add_u32 s59, s59, s75
  s_bfe_u32 s61, s52, 0x10002
  s_and_b32 s21, s52, 3
  s_lshl_b32 s60, s21, 18
  s_mov_b32 s54, 0
  s_sleep 2
  s_nop 10
  s_waitcnt lgkmcnt(0)
  buffer_load_dwordx4 v[48:51], v190, s[8:11], s58 offen offset:0 sc1
  buffer_load_dwordx4 v[52:55], v190, s[8:11], s58 offen offset:1024 sc1
  s_branch top_135
mr_136:
  s_mov_b64 exec, s[22:23]
  s_cbranch_execz ms_153
  buffer_load_dwordx4 v[48:51], v190, s[8:11], s58 offen offset:0 sc1
ms_153:
  s_mov_b64 exec, s[98:99]
  s_cbranch_execz ms_154
  buffer_load_dwordx4 v[52:55], v190, s[8:11], s58 offen offset:1024 sc1
ms_154:
  s_add_u32 s54, s54, 1
  s_cmp_gt_u32 s54, 131072
  s_cbranch_scc1 end0
  s_waitcnt vmcnt(0)
  s_mov_b64 exec, s[22:23]
  ds_write_b128 v190, v[48:51] offset:0
  v_cmp_eq_u32 s[22:23], -1, v48
  s_mov_b64 exec, s[98:99]
  ds_write_b128 v190, v[52:55] offset:1024
  v_cmp_eq_u32 s[98:99], -1, v52
  s_mov_b64 exec, -1
  s_or_b64 vcc, s[22:23], s[98:99]
  s_cbranch_scc1 mr_136
  s_branch mo_140
sf_141:
  s_waitcnt lgkmcnt(1)
  v_mfma_f32_16x16x32_bf16 v[120:123], v[112:115], v[104:107], 0
  s_waitcnt lgkmcnt(0)
  v_mfma_f32_16x16x32_bf16 v[120:123], v[116:119], v[108:111], v[120:123]
  s_mov_b64 exec, s[64:65]
  s_nop 6
  v_cvt_pk_f16_f32 v120, v120, v121
  v_cvt_pk_f16_f32 v121, v122, v123
  buffer_store_dwordx2 v[120:121], v8, s[8:11], s56 offen sc1
  s_mov_b64 exec, -1
  s_branch sf_142
mn_137:
  s_bitcmp1_b32 s81, 1
  s_cbranch_scc1 mk_138
  s_or_b32 s81, s81, 2
  s_nop 7
  v_mov_b32 v88, 0
  v_mov_b32 v89, 0
  v_mov_b32 v90, 0
  v_mov_b32 v91, 0
  v_mov_b32 v92, 0
  v_mov_b32 v93, 0
  v_mov_b32 v94, 0
  v_mov_b32 v95, 0
  v_mov_b32 v96, 0
  v_mov_b32 v97, 0
  v_mov_b32 v98, 0
  v_mov_b32 v99, 0
  v_mov_b32 v100, 0
  v_mov_b32 v101, 0
  v_mov_b32 v102, 0
  v_mov_b32 v103, 0
  s_cmp_eq_u32 s52, 0
  s_cbranch_scc1 mx_156
mx_155:
  buffer_load_dwordx4 v[48:51], v190, s[8:11], s58 offen offset:0 sc1
  buffer_load_dwordx4 v[52:55], v190, s[8:11], s58 offen offset:1024 sc1
  s_add_u32 s54, s54, 1
  s_cmp_gt_u32 s54, 131072
  s_cbranch_scc1 end0
  s_waitcnt vmcnt(0)
  v_max3_u32 v27, v48, v49, v50
  v_max3_u32 v27, v27, v51, v52
  v_max3_u32 v27, v27, v53, v54
  v_max3_u32 v27, v27, v55, v55
  v_cmp_eq_u32 vcc, -1, v27
  s_nop 1
  s_cbranch_vccnz mx_155
  ds_write_b128 v190, v[48:51] offset:0
  ds_write_b128 v190, v[52:55] offset:1024
mx_156:
  s_waitcnt lgkmcnt(0)
  s_branch mo_140
sr_143:
  s_mov_b32 s54, 0
sr_157:
  s_mov_b64 exec, vcc
  buffer_load_dwordx4 v[124:127], v9, s[8:11], s56 offen sc1
  buffer_load_dwordx4 v[128:131], v9, s[8:11], s56 offen offset:1024 sc1
  buffer_load_dwordx4 v[132:135], v10, s[8:11], s56 offen sc1
  s_mov_b64 exec, -1
  s_add_u32 s54, s54, 1
  s_cmp_gt_u32 s54, 131072
  s_cbranch_scc1 end0
  s_waitcnt vmcnt(0)
  v_pk_add_f16 v164, v132, v133
  v_pk_add_f16 v165, v134, v135
  v_pk_add_f16 v120, v124, v126
  v_pk_add_f16 v122, v128, v130
  v_fma_mix_f32 v170, v164, 1.0, v165 op_sel:[0,0,0] op_sel_hi:[1,0,1]
  v_fma_mix_f32 v166, v120, 1.0, v122 op_sel:[0,0,0] op_sel_hi:[1,0,1]
  v_pk_add_f16 v121, v125, v127
  v_cmp_u_f32 vcc, v166, v170
  v_pk_add_f16 v123, v129, v131
  v_fma_mix_f32 v171, v164, 1.0, v165 op_sel:[1,0,1] op_sel_hi:[1,0,1]
  v_fma_mix_f32 v167, v120, 1.0, v122 op_sel:[1,0,1] op_sel_hi:[1,0,1]
  v_fma_mix_f32 v168, v121, 1.0, v123 op_sel:[0,0,0] op_sel_hi:[1,0,1]
  v_fma_mix_f32 v169, v121, 1.0, v123 op_sel:[1,0,1] op_sel_hi:[1,0,1]
  s_cbranch_vccz ex_145
  s_and_b32 s21, s54, 31
  s_cbranch_scc1 sr_157
  v_max3_u32 v27, v124, v126, v128
  v_max3_u32 v27, v27, v130, v132
  v_max3_u32 v27, v27, v133, v134
  v_max3_u32 v27, v27, v135, v135
  v_cmp_eq_u32 vcc, -1, v27
  s_nop 1
  s_cbranch_vccnz sr_157
ex_145:
  v_exp_f32 v176, v170
  v_exp_f32 v177, v171
  v_exp_f32 v172, v166
  v_cvt_pk_bf16_f32 v160, v176, v177
  v_exp_f32 v173, v167
  v_exp_f32 v174, v168
  v_mov_b32_dpp v161, v160 row_ror:8 row_mask:0xf bank_mask:0xf
  v_cvt_pk_bf16_f32 v156, v172, v173
  v_exp_f32 v175, v169
  v_mfma_f32_16x16x32_bf16 v[178:181], v[140:143], v[160:163], 0
  v_mov_b32_dpp v158, v156 row_ror:8 row_mask:0xf bank_mask:0xf
  v_cvt_pk_bf16_f32 v157, v174, v175
  v_mfma_f32_16x16x32_bf16 v[182:185], v[136:139], v[160:163], 0
  s_nop 0
  v_mov_b32_dpp v159, v157 row_ror:8 row_mask:0xf bank_mask:0xf
  v_mfma_f32_16x16x32_bf16 v[186:189], v[138:141], v[160:163], 0
  s_branch pv_144
fx_146:
  s_bitcmp1_b32 s81, 0
  s_cbranch_scc1 fk_147
  s_or_b32 s81, s81, 1
  s_mov_b64 exec, -1
  v_max3_f32 v164, v166, v167, v168
  v_max3_f32 v165, v169, v170, v171
  v_max_f32 v164, v164, v165
  s_nop 1
  v_max_f32_dpp v164, v164, v164 row_ror:8 row_mask:0xf bank_mask:0xf
  v_mov_b32 v165, v164
  s_nop 1
  v_permlane32_swap_b32 v164, v165
  v_max_f32 v164, v164, v165
  v_mov_b32 v165, v164
  s_nop 1
  v_permlane16_swap_b32 v164, v165
  v_max_f32 v164, v164, v165
  v_sub_f32 v166, v166, v164
  v_sub_f32 v167, v167, v164
  v_sub_f32 v168, v168, v164
  v_sub_f32 v169, v169, v164
  v_sub_f32 v170, v170, v164
  v_sub_f32 v171, v171, v164
  s_branch ex_145
p2_152:
  s_mov_b32 s54, 0
  buffer_load_dwordx4 v[68:71], v16, s[4:7], s60 offen sc1
  s_waitcnt vmcnt(1)
  v_mfma_f32_16x16x32_f16 v[120:123], v[44:47], v[72:75], 0
  v_bitop3_b32 v27, v72, s61, 1 bitop3:0x28
  v_cmp_ne_u32 vcc, 0, v27
  s_nop 1
  s_cbranch_vccz pg_151
  buffer_load_dwordx4 v[72:75], v16, s[4:7], s60 offen sc1
pp_150:
  s_waitcnt vmcnt(1)
  v_mfma_f32_16x16x32_f16 v[120:123], v[44:47], v[68:71], 0
  v_bitop3_b32 v27, v68, s61, 1 bitop3:0x28
  v_cmp_ne_u32 vcc, 0, v27
  s_nop 1
  s_cbranch_vccz pg_151
  buffer_load_dwordx4 v[68:71], v16, s[4:7], s60 offen sc1
  s_waitcnt vmcnt(1)
  v_mfma_f32_16x16x32_f16 v[120:123], v[44:47], v[72:75], 0
  v_bitop3_b32 v27, v72, s61, 1 bitop3:0x28
  v_cmp_ne_u32 vcc, 0, v27
  s_nop 1
  s_cbranch_vccz pg_151
  buffer_load_dwordx4 v[72:75], v16, s[4:7], s60 offen sc1
  s_add_u32 s54, s54, 1
  s_cmp_gt_u32 s54, 131072
  s_cbranch_scc1 end0
  s_branch pp_150
last_139:
  v_min_u32 v104, -2, v104
  buffer_store_dwordx4 v[104:107], v36, s[16:19], s70 offen offset:2560 sc1
  v_smfmac_f32_16x16x64_bf16 v[96:99], v[48:51], a[0:7], v22
  v_smfmac_f32_16x16x64_bf16 v[100:103], v[48:51], a[80:87], v22
  v_smfmac_f32_16x16x64_bf16 v[96:99], v[52:55], a[8:15], v22
  v_smfmac_f32_16x16x64_bf16 v[100:103], v[52:55], a[88:95], v22
  v_smfmac_f32_16x16x64_bf16 v[96:99], v[56:59], a[16:23], v22
  v_smfmac_f32_16x16x64_bf16 v[100:103], v[56:59], a[96:103], v22
  v_smfmac_f32_16x16x64_bf16 v[96:99], v[60:63], a[24:31], v22
  v_smfmac_f32_16x16x64_bf16 v[96:99], v[64:67], a[32:39], v22
  v_smfmac_f32_16x16x64_bf16 v[96:99], v[68:71], a[40:47], v22
  v_smfmac_f32_16x16x64_bf16 v[96:99], v[72:75], a[48:55], v22
  v_smfmac_f32_16x16x64_bf16 v[96:99], v[76:79], a[56:63], v22
  v_smfmac_f32_16x16x64_bf16 v[96:99], v[80:83], a[64:71], v22
  v_smfmac_f32_16x16x64_bf16 v[96:99], v[84:87], a[72:79], v22
  v_smfmac_f32_16x16x64_bf16 v[100:103], v[60:63], a[104:111], v22
  v_smfmac_f32_16x16x64_bf16 v[100:103], v[64:67], a[112:119], v22
  v_smfmac_f32_16x16x64_bf16 v[100:103], v[68:71], a[120:127], v22
  v_smfmac_f32_16x16x64_bf16 v[100:103], v[72:75], a[128:135], v22
  v_smfmac_f32_16x16x64_bf16 v[100:103], v[76:79], a[136:143], v22
  v_smfmac_f32_16x16x64_bf16 v[100:103], v[80:83], a[144:151], v22
  v_smfmac_f32_16x16x64_bf16 v[100:103], v[84:87], a[152:159], v22
  s_nop 7
  v_permlane32_swap_b32 v96, v100
  v_permlane32_swap_b32 v97, v101
  v_permlane32_swap_b32 v98, v102
  v_permlane32_swap_b32 v99, v103
  v_pk_add_f32 v[96:97], v[96:97], v[100:101]
  v_pk_add_f32 v[98:99], v[98:99], v[102:103]
  v_cvt_pk_bf16_f32 v100, v96, v97
  v_cvt_pk_bf16_f32 v101, v98, v99
  s_nop 0
  v_permlane32_swap_b32 v100, v102
  v_permlane32_swap_b32 v101, v103
  v_min_u32 v100, -2, v100
  buffer_store_dwordx4 v[100:103], v26, s[16:19], s70 offen sc1
  s_waitcnt vmcnt(0)
  s_barrier
  s_branch chain_done
E_27:
  v_add_u32 v190, 2048, v4
  ds_write_b64 v6, v[28:29]
  ds_write_b32 v13, v28
  ds_write_b32 v14, v28
  s_waitcnt vmcnt(0)
  ds_write_b128 v190, v[56:59] offset:0
  ds_write_b128 v190, v[60:63] offset:1024
  ds_write_b128 v190, v[64:67] offset:2048
  s_waitcnt lgkmcnt(0)
  s_add_u32 m0, s74, 6144
  s_add_u32 s21, s79, 196608
  buffer_load_dwordx4 v4, s[16:19], s21 offen offset:1024 sc1 lds
  s_add_u32 m0, s74, 4096
  s_mul_i32 s21, s91, 2
  s_add_u32 s21, s21, s71
  buffer_load_dwordx4 v4, s[16:19], s21 offen sc1 lds
  s_xor_b32 s74, s74, 16384
  s_add_u32 s73, s73, 2097152
  s_xor_b32 s73, s73, 8192
  s_add_u32 s79, s79, 2097152
  s_xor_b32 s79, s79, 8192
  s_add_u32 s21, s72, 524288
  s_xor_b32 s72, s72, s21
  s_lshr_b32 s72, s72, 8
  s_and_b32 s72, s72, 8192
  s_xor_b32 s72, s72, s21
  s_add_u32 s71, s73, 4096
  s_mov_b32 s91, 1024
  s_sub_u32 s21, s73, 0
  s_cmp_lt_u32 s21, 125829120
  s_cselect_b32 s71, s71, s79
  s_cselect_b32 s91, s91, 65536
  s_branch mo_164
  .p2align 3
top_159:
  s_waitcnt vmcnt(2)
  ds_write_b128 v190, v[56:59] offset:0
  v_cmp_eq_u32 s[22:23], -1, v56
  s_waitcnt vmcnt(1)
  ds_write_b128 v190, v[60:63] offset:1024
  v_cmp_eq_u32 s[98:99], -1, v60
  s_waitcnt vmcnt(0)
  ds_write_b128 v190, v[64:67] offset:2048
  v_cmp_eq_u32 s[100:101], -1, v64
  s_or_b64 vcc, s[22:23], s[98:99]
  s_or_b64 vcc, vcc, s[100:101]
  s_cbranch_scc1 mr_160
mo_164:
  s_barrier
  ds_read_b128 v[48:51], v4 offset:0
  ds_read_b128 v[52:55], v4 offset:1024
  v_smfmac_f32_16x16x64_bf16 v[92:95], v[56:59], v[192:199], v22
  ds_read_b128 v[68:71], v4 offset:5120
  v_smfmac_f32_16x16x64_bf16 v[88:91], v[56:59], a[176:183], v22
  ds_read_b128 v[72:75], v4 offset:6144
  v_smfmac_f32_16x16x64_bf16 v[92:95], v[60:63], v[200:207], v22
  ds_read_b128 v[76:79], v4 offset:7168
  v_smfmac_f32_16x16x64_bf16 v[88:91], v[60:63], a[184:191], v22
  ds_read_b128 v[80:83], v4 offset:8192
  v_smfmac_f32_16x16x64_bf16 v[92:95], v[64:67], v[208:215], v22
  ds_read_b128 v[84:87], v4 offset:9216
  v_smfmac_f32_16x16x64_bf16 v[88:91], v[64:67], a[192:199], v22
  s_waitcnt lgkmcnt(6)
  v_smfmac_f32_16x16x64_bf16 v[92:95], v[48:51], a[240:247], v22
  v_smfmac_f32_16x16x64_bf16 v[88:91], v[48:51], a[160:167], v22
  s_waitcnt lgkmcnt(5)
  v_smfmac_f32_16x16x64_bf16 v[92:95], v[52:55], a[248:255], v22
  s_waitcnt lgkmcnt(4)
  v_smfmac_f32_16x16x64_bf16 v[92:95], v[68:71], v[216:223], v22
  s_waitcnt lgkmcnt(3)
  v_smfmac_f32_16x16x64_bf16 v[92:95], v[72:75], v[224:231], v22
  s_waitcnt lgkmcnt(2)
  v_smfmac_f32_16x16x64_bf16 v[92:95], v[76:79], v[232:239], v22
  s_waitcnt lgkmcnt(1)
  v_smfmac_f32_16x16x64_bf16 v[92:95], v[80:83], v[240:247], v22
  s_waitcnt lgkmcnt(0)
  v_smfmac_f32_16x16x64_bf16 v[92:95], v[84:87], v[248:255], v22
  v_smfmac_f32_16x16x64_bf16 v[88:91], v[52:55], a[168:175], v22
  v_smfmac_f32_16x16x64_bf16 v[88:91], v[68:71], a[200:207], v22
  v_smfmac_f32_16x16x64_bf16 v[88:91], v[72:75], a[208:215], v22
  v_permlane32_swap_b32 v92, v93
  v_smfmac_f32_16x16x64_bf16 v[88:91], v[76:79], a[216:223], v22
  v_permlane32_swap_b32 v94, v95
  v_smfmac_f32_16x16x64_bf16 v[88:91], v[80:83], a[224:231], v22
  v_permlane32_swap_b32 v93, v92
  v_smfmac_f32_16x16x64_bf16 v[88:91], v[84:87], a[232:239], v22
  v_permlane32_swap_b32 v95, v94
  v_pk_mul_f32 v[120:121], v[92:93], v[24:25] op_sel:[1,0] op_sel_hi:[0,1]
  v_pk_mul_f32 v[122:123], v[94:95], v[24:25] op_sel:[1,0] op_sel_hi:[0,1]
  s_nop 4
  v_pk_fma_f32 v[88:89], v[88:89], v[24:25], v[120:121]
  v_pk_fma_f32 v[90:91], v[90:91], v[24:25], v[122:123]
  v_cvt_pk_bf16_f32 v120, v88, v89
  v_cvt_pk_bf16_f32 v121, v90, v91
  ds_write_b64 v6, v[120:121]
  s_barrier
  ds_read_b64_tr_b16 v[104:105], v7 offset:0
  ds_read_b64_tr_b16 v[106:107], v7 offset:768
  ds_read_b64_tr_b16 v[108:109], v7 offset:1536
  s_waitcnt lgkmcnt(1)
  v_mfma_f32_16x16x32_bf16 v[120:123], v[112:115], v[104:107], 0
  s_waitcnt lgkmcnt(0)
  v_mfma_f32_16x16x32_bf16 v[120:123], v[116:119], v[108:111], v[120:123]
  s_mov_b64 exec, s[64:65]
  s_nop 6
  v_cmpx_o_f32 vcc, v120, v121
  v_cvt_pk_f16_f32 v120, v120, v121
  v_cvt_pk_f16_f32 v121, v122, v123
  buffer_store_dwordx2 v[120:121], v8, s[8:11], s56 offen sc1
  s_xor_b64 s[98:99], exec, s[64:65]
  s_mov_b64 exec, -1
  s_waitcnt lgkmcnt(0)
  s_barrier
  ds_read_b64_tr_b16 v[104:105], v7 offset:0
  ds_read_b64_tr_b16 v[106:107], v7 offset:768
  ds_read_b64_tr_b16 v[108:109], v7 offset:1536
  ds_read_b32 v27, v12 offset:12544
  ds_read_b64 v[140:141], v11
  s_waitcnt lgkmcnt(1)
  v_cmp_u_f32 vcc, v104, v106
  v_cmp_u_f32 s[22:23], v108, v27
  s_nop 1
  s_or_b64 vcc, vcc, s[22:23]
  s_cbranch_vccnz mn_161
mk_162:
  s_cmp_eq_u32 s52, 63
  s_cbranch_scc1 last_163
  s_cmp_lg_u64 s[98:99], 0
  s_cbranch_scc1 sf_165
sf_166:
  s_nop 15
  s_nop 10
  v_smfmac_f32_16x16x64_bf16 v[96:99], v[48:51], a[0:7], v22
  v_smfmac_f32_16x16x64_bf16 v[100:103], v[48:51], a[80:87], v22
  v_smfmac_f32_16x16x64_bf16 v[96:99], v[52:55], a[8:15], v22
  v_smfmac_f32_16x16x64_bf16 v[100:103], v[52:55], a[88:95], v22
  v_smfmac_f32_16x16x64_bf16 v[96:99], v[56:59], a[16:23], v22
  v_smfmac_f32_16x16x64_bf16 v[100:103], v[56:59], a[96:103], v22
  buffer_load_dwordx4 v[132:135], v10, s[8:11], s56 offen sc1
  v_smfmac_f32_16x16x64_bf16 v[96:99], v[60:63], a[24:31], v22
  buffer_load_dwordx4 v[124:127], v9, s[8:11], s56 offen sc1
  v_smfmac_f32_16x16x64_bf16 v[96:99], v[64:67], a[32:39], v22
  buffer_load_dwordx4 v[128:131], v9, s[8:11], s56 offen offset:1024 sc1
  v_smfmac_f32_16x16x64_bf16 v[96:99], v[68:71], a[40:47], v22
  v_smfmac_f32_16x16x64_bf16 v[96:99], v[72:75], a[48:55], v22
  v_smfmac_f32_16x16x64_bf16 v[96:99], v[76:79], a[56:63], v22
  v_smfmac_f32_16x16x64_bf16 v[96:99], v[80:83], a[64:71], v22
  v_smfmac_f32_16x16x64_bf16 v[96:99], v[84:87], a[72:79], v22
  v_smfmac_f32_16x16x64_bf16 v[100:103], v[60:63], a[104:111], v22
  v_smfmac_f32_16x16x64_bf16 v[100:103], v[64:67], a[112:119], v22
  v_smfmac_f32_16x16x64_bf16 v[100:103], v[68:71], a[120:127], v22
  v_smfmac_f32_16x16x64_bf16 v[100:103], v[72:75], a[128:135], v22
  v_cvt_pk_bf16_f32 v136, v96, v97
  v_smfmac_f32_16x16x64_bf16 v[100:103], v[76:79], a[136:143], v22
  v_cvt_pk_bf16_f32 v137, v98, v99
  v_smfmac_f32_16x16x64_bf16 v[100:103], v[80:83], a[144:151], v22
  v_smfmac_f32_16x16x64_bf16 v[100:103], v[84:87], a[152:159], v22
  s_nop 7
  v_cvt_pk_bf16_f32 v138, v100, v101
  v_cvt_pk_bf16_f32 v139, v102, v103
  s_waitcnt vmcnt(2) lgkmcnt(0)
  v_pk_add_f16 v164, v132, v133
  v_pk_add_f16 v165, v134, v135
  v_fma_mix_f32 v170, v164, 1.0, v165 op_sel:[0,0,0] op_sel_hi:[1,0,1]
  v_fma_mix_f32 v171, v164, 1.0, v165 op_sel:[1,0,1] op_sel_hi:[1,0,1]
  v_exp_f32 v176, v170
  v_exp_f32 v177, v171
  s_waitcnt vmcnt(1)
  v_cvt_pk_bf16_f32 v160, v176, v177
  v_pk_add_f16 v120, v124, v126
  v_pk_add_f16 v121, v125, v127
  v_mov_b32_dpp v161, v160 row_ror:8 row_mask:0xf bank_mask:0xf
  s_waitcnt vmcnt(0)
  v_pk_add_f16 v122, v128, v130
  v_mfma_f32_16x16x32_bf16 v[178:181], v[140:143], v[160:163], 0
  v_fma_mix_f32 v166, v120, 1.0, v122 op_sel:[0,0,0] op_sel_hi:[1,0,1]
  v_fma_mix_f32 v167, v120, 1.0, v122 op_sel:[1,0,1] op_sel_hi:[1,0,1]
  v_cmp_u_f32 vcc, v166, v170
  v_pk_add_f16 v123, v129, v131
  v_exp_f32 v172, v166
  v_mfma_f32_16x16x32_bf16 v[182:185], v[136:139], v[160:163], 0
  s_cbranch_vccnz sr_167
  v_exp_f32 v173, v167
  v_fma_mix_f32 v168, v121, 1.0, v123 op_sel:[0,0,0] op_sel_hi:[1,0,1]
  v_fma_mix_f32 v169, v121, 1.0, v123 op_sel:[1,0,1] op_sel_hi:[1,0,1]
  v_cvt_pk_bf16_f32 v156, v172, v173
  v_exp_f32 v174, v168
  v_exp_f32 v175, v169
  v_mov_b32_dpp v158, v156 row_ror:8 row_mask:0xf bank_mask:0xf
  v_cvt_pk_bf16_f32 v157, v174, v175
  v_mfma_f32_16x16x32_bf16 v[186:189], v[138:141], v[160:163], 0
  s_nop 0
  v_mov_b32_dpp v159, v157 row_ror:8 row_mask:0xf bank_mask:0xf
  s_nop 1
pv_168:
  v_mfma_f32_16x16x32_bf16 v[178:181], v[152:155], v[156:159], v[178:181]
  v_mfma_f32_16x16x32_bf16 v[182:185], v[144:147], v[156:159], v[182:185]
  v_mfma_f32_16x16x32_bf16 v[186:189], v[148:151], v[156:159], v[186:189]
  s_mov_b64 exec, s[62:63]
  s_nop 0
  v_rcp_f32 v164, v180
  v_cmp_ngt_f32 s[22:23], s80, v180
  v_cmp_ngt_f32 vcc, s80, v164
  v_pk_mul_f32 v[182:183], v[182:183], v[164:165] op_sel_hi:[1,0]
  v_pk_mul_f32 v[184:185], v[184:185], v[164:165] op_sel_hi:[1,0]
  v_pk_mul_f32 v[178:179], v[178:179], v[164:165] op_sel_hi:[1,0]
  v_pk_mul_f32 v[186:187], v[186:187], v[164:165] op_sel_hi:[1,0]
  v_pk_mul_f32 v[188:189], v[188:189], v[164:165] op_sel_hi:[1,0]
  v_cvt_pk_f16_f32 v64, v178, v179
  s_or_b64 vcc, vcc, s[22:23]
  s_cbranch_scc1 fx_170
fk_171:
  ds_write_b32 v14, v64
  v_cvt_pk_f16_f32 v60, v182, v183
  v_cvt_pk_f16_f32 v61, v184, v185
  v_cvt_pk_f16_f32 v62, v186, v187
  v_cvt_pk_f16_f32 v63, v188, v189
  ds_write_b128 v13, v[60:63]
  s_barrier
  s_mov_b64 exec, -1
  s_add_u32 m0, s74, 6144
  s_add_u32 s21, s79, 196608
  buffer_load_dwordx4 v4, s[16:19], s21 offen offset:1024 sc1 lds
  s_add_u32 m0, s74, 4096
  s_mul_i32 s21, s91, 2
  s_add_u32 s21, s21, s71
  buffer_load_dwordx4 v4, s[16:19], s21 offen sc1 lds
  s_xor_b32 s74, s74, 16384
  s_add_u32 s73, s73, 2097152
  s_xor_b32 s73, s73, 8192
  s_add_u32 s79, s79, 2097152
  s_xor_b32 s79, s79, 8192
  s_add_u32 s21, s72, 524288
  s_xor_b32 s72, s72, s21
  s_lshr_b32 s72, s72, 8
  s_and_b32 s72, s72, 8192
  s_xor_b32 s72, s72, s21
  s_add_u32 s71, s73, 4096
  s_mov_b32 s91, 1024
  s_sub_u32 s21, s73, 0
  s_cmp_lt_u32 s21, 125829120
  s_cselect_b32 s71, s71, s79
  s_cselect_b32 s91, s91, 65536
  v_permlane32_swap_b32 v96, v100
  v_permlane32_swap_b32 v97, v101
  v_permlane32_swap_b32 v98, v102
  v_permlane32_swap_b32 v99, v103
  v_pk_add_f32 v[96:97], v[96:97], v[100:101]
  v_pk_add_f32 v[98:99], v[98:99], v[102:103]
  v_cvt_pk_bf16_f32 v100, v96, v97
  v_cvt_pk_bf16_f32 v101, v98, v99
  s_nop 0
  v_permlane32_swap_b32 v100, v102
  v_permlane32_swap_b32 v101, v103
  v_min_u32 v100, -2, v100
  s_nop 6
  buffer_store_dwordx4 v[100:103], v26, s[16:19], s70 offen sc1
  v_min_u32 v108, -2, v108
  buffer_store_dwordx2 v[108:109], v37, s[16:19], s70 offen offset:3072 sc1
  s_add_u32 s70, s70, 2097152
  s_xor_b32 s70, s70, 8192
  ds_read_b128 v[144:147], v18
  ds_read_b128 v[148:151], v18 offset:1024
  ds_read_b128 v[152:155], v19
  ds_read_b128 v[112:115], v20
  ds_read_b64 v[116:117], v21
  v_xor_b32 v18, 16384, v18
  v_xor_b32 v19, 16384, v19
  v_xor_b32 v20, 16384, v20
  v_xor_b32 v21, 16384, v21
  v_mov_b32 v88, 0
  v_mov_b32 v89, 0
  v_mov_b32 v90, 0
  v_mov_b32 v91, 0
  v_mov_b32 v92, 0
  v_mov_b32 v93, 0
  v_mov_b32 v94, 0
  v_mov_b32 v95, 0
  v_mov_b32 v96, 0
  v_mov_b32 v97, 0
  v_mov_b32 v98, 0
  v_mov_b32 v99, 0
  v_mov_b32 v100, 0
  v_mov_b32 v101, 0
  v_mov_b32 v102, 0
  v_mov_b32 v103, 0
  s_mov_b32 s81, 0
  s_waitcnt lgkmcnt(0)
  s_barrier
  s_mov_b64 exec, s[64:65]
  buffer_store_dwordx2 v[28:29], v8, s[8:11], s57 offen sc1
  s_mov_b64 exec, -1
  ds_write_b128 v190, v[28:31] offset:0
  ds_write_b128 v190, v[28:31] offset:1024
  ds_write_b128 v190, v[28:31] offset:2048
  ds_write_b64 v6, v[28:29]
  s_mov_b64 exec, s[62:63]
  buffer_store_dword v28, v17, s[8:11], s59 offen sc1
  s_mov_b64 exec, -1
  s_sleep 3
  s_nop 1
  buffer_load_dwordx4 v[68:71], v16, s[4:7], s60 offen sc1
  s_sleep 3
  s_nop 1
  buffer_load_dwordx4 v[72:75], v16, s[4:7], s60 offen sc1
  s_waitcnt vmcnt(1)
  v_mfma_f32_16x16x32_f16 v[120:123], v[44:47], v[68:71], 0
  v_bitop3_b32 v27, v68, s61, 1 bitop3:0x28
  v_cmp_ne_u32 vcc, 0, v27
  s_nop 1
  s_cbranch_vccnz p2_176
  s_nop 2
pg_175:
  v_add_f32_dpp v120, v120, v120 row_ror:8 row_mask:0xf bank_mask:0xf
  v_add_f32_dpp v121, v121, v121 row_ror:8 row_mask:0xf bank_mask:0xf
  s_mov_b64 exec, s[62:63]
  v_cvt_pk_bf16_f32 v120, v120, v121
  v_min_u32 v120, -2, v120
  buffer_store_dword v120, v17, s[8:11], s55 offen sc1
  s_mov_b64 exec, -1
nt_172:
  s_barrier
  s_mov_b32 s58, s55
  s_add_u32 s52, s52, 1
  ds_write_b32 v13, v28
  ds_write_b32 v14, v28
  s_and_b32 s21, s52, 3
  s_mul_i32 s56, s21, 122880
  s_add_u32 s21, s52, 1
  s_and_b32 s21, s21, 3
  s_mul_i32 s55, s21, 122880
  s_add_u32 s55, s55, s75
  s_add_u32 s21, s52, 2
  s_and_b32 s21, s21, 3
  s_mul_i32 s57, s21, 122880
  s_add_u32 s21, s52, 3
  s_and_b32 s21, s21, 3
  s_mul_i32 s59, s21, 122880
  s_add_u32 s59, s59, s75
  s_bfe_u32 s61, s52, 0x10002
  s_and_b32 s21, s52, 3
  s_lshl_b32 s60, s21, 18
  s_mov_b32 s54, 0
  s_sleep 2
  s_nop 10
  s_waitcnt lgkmcnt(0)
  buffer_load_dwordx4 v[56:59], v190, s[8:11], s58 offen offset:0 sc1
  buffer_load_dwordx4 v[60:63], v190, s[8:11], s58 offen offset:1024 sc1
  buffer_load_dwordx4 v[64:67], v190, s[8:11], s58 offen offset:2048 sc1
  s_branch top_159
mr_160:
  s_mov_b64 exec, s[22:23]
  s_cbranch_execz ms_177
  buffer_load_dwordx4 v[56:59], v190, s[8:11], s58 offen offset:0 sc1
ms_177:
  s_mov_b64 exec, s[98:99]
  s_cbranch_execz ms_178
  buffer_load_dwordx4 v[60:63], v190, s[8:11], s58 offen offset:1024 sc1
ms_178:
  s_mov_b64 exec, s[100:101]
  s_cbranch_execz ms_179
  buffer_load_dwordx4 v[64:67], v190, s[8:11], s58 offen offset:2048 sc1
ms_179:
  s_add_u32 s54, s54, 1
  s_cmp_gt_u32 s54, 131072
  s_cbranch_scc1 end0
  s_waitcnt vmcnt(0)
  s_mov_b64 exec, s[22:23]
  ds_write_b128 v190, v[56:59] offset:0
  v_cmp_eq_u32 s[22:23], -1, v56
  s_mov_b64 exec, s[98:99]
  ds_write_b128 v190, v[60:63] offset:1024
  v_cmp_eq_u32 s[98:99], -1, v60
  s_mov_b64 exec, s[100:101]
  ds_write_b128 v190, v[64:67] offset:2048
  v_cmp_eq_u32 s[100:101], -1, v64
  s_mov_b64 exec, -1
  s_or_b64 vcc, s[22:23], s[98:99]
  s_or_b64 vcc, vcc, s[100:101]
  s_cbranch_scc1 mr_160
  s_branch mo_164
sf_165:
  s_waitcnt lgkmcnt(1)
  v_mfma_f32_16x16x32_bf16 v[120:123], v[112:115], v[104:107], 0
  s_waitcnt lgkmcnt(0)
  v_mfma_f32_16x16x32_bf16 v[120:123], v[116:119], v[108:111], v[120:123]
  s_mov_b64 exec, s[64:65]
  s_nop 6
  v_cvt_pk_f16_f32 v120, v120, v121
  v_cvt_pk_f16_f32 v121, v122, v123
  buffer_store_dwordx2 v[120:121], v8, s[8:11], s56 offen sc1
  s_mov_b64 exec, -1
  s_branch sf_166
mn_161:
  s_bitcmp1_b32 s81, 1
  s_cbranch_scc1 mk_162
  s_or_b32 s81, s81, 2
  s_nop 7
  v_mov_b32 v88, 0
  v_mov_b32 v89, 0
  v_mov_b32 v90, 0
  v_mov_b32 v91, 0
  v_mov_b32 v92, 0
  v_mov_b32 v93, 0
  v_mov_b32 v94, 0
  v_mov_b32 v95, 0
  v_mov_b32 v96, 0
  v_mov_b32 v97, 0
  v_mov_b32 v98, 0
  v_mov_b32 v99, 0
  v_mov_b32 v100, 0
  v_mov_b32 v101, 0
  v_mov_b32 v102, 0
  v_mov_b32 v103, 0
  s_cmp_eq_u32 s52, 0
  s_cbranch_scc1 mx_181
mx_180:
  buffer_load_dwordx4 v[56:59], v190, s[8:11], s58 offen offset:0 sc1
  buffer_load_dwordx4 v[60:63], v190, s[8:11], s58 offen offset:1024 sc1
  buffer_load_dwordx4 v[64:67], v190, s[8:11], s58 offen offset:2048 sc1
  s_add_u32 s54, s54, 1
  s_cmp_gt_u32 s54, 131072
  s_cbranch_scc1 end0
  s_waitcnt vmcnt(0)
  v_max3_u32 v27, v56, v57, v58
  v_max3_u32 v27, v27, v59, v60
  v_max3_u32 v27, v27, v61, v62
  v_max3_u32 v27, v27, v63, v64
  v_max3_u32 v27, v27, v65, v66
  v_max3_u32 v27, v27, v67, v67
  v_cmp_eq_u32 vcc, -1, v27
  s_nop 1
  s_cbranch_vccnz mx_180
  ds_write_b128 v190, v[56:59] offset:0
  ds_write_b128 v190, v[60:63] offset:1024
  ds_write_b128 v190, v[64:67] offset:2048
mx_181:
  s_waitcnt lgkmcnt(0)
  s_branch mo_164
sr_167:
  s_mov_b32 s54, 0
sr_182:
  s_mov_b64 exec, vcc
  buffer_load_dwordx4 v[124:127], v9, s[8:11], s56 offen sc1
  buffer_load_dwordx4 v[128:131], v9, s[8:11], s56 offen offset:1024 sc1
  buffer_load_dwordx4 v[132:135], v10, s[8:11], s56 offen sc1
  s_mov_b64 exec, -1
  s_add_u32 s54, s54, 1
  s_cmp_gt_u32 s54, 131072
  s_cbranch_scc1 end0
  s_waitcnt vmcnt(0)
  v_pk_add_f16 v164, v132, v133
  v_pk_add_f16 v165, v134, v135
  v_pk_add_f16 v120, v124, v126
  v_pk_add_f16 v122, v128, v130
  v_fma_mix_f32 v170, v164, 1.0, v165 op_sel:[0,0,0] op_sel_hi:[1,0,1]
  v_fma_mix_f32 v166, v120, 1.0, v122 op_sel:[0,0,0] op_sel_hi:[1,0,1]
  v_pk_add_f16 v121, v125, v127
  v_cmp_u_f32 vcc, v166, v170
  v_pk_add_f16 v123, v129, v131
  v_fma_mix_f32 v171, v164, 1.0, v165 op_sel:[1,0,1] op_sel_hi:[1,0,1]
  v_fma_mix_f32 v167, v120, 1.0, v122 op_sel:[1,0,1] op_sel_hi:[1,0,1]
  v_fma_mix_f32 v168, v121, 1.0, v123 op_sel:[0,0,0] op_sel_hi:[1,0,1]
  v_fma_mix_f32 v169, v121, 1.0, v123 op_sel:[1,0,1] op_sel_hi:[1,0,1]
  s_cbranch_vccz ex_169
  s_and_b32 s21, s54, 31
  s_cbranch_scc1 sr_182
  v_max3_u32 v27, v124, v126, v128
  v_max3_u32 v27, v27, v130, v132
  v_max3_u32 v27, v27, v133, v134
  v_max3_u32 v27, v27, v135, v135
  v_cmp_eq_u32 vcc, -1, v27
  s_nop 1
  s_cbranch_vccnz sr_182
ex_169:
  v_exp_f32 v176, v170
  v_exp_f32 v177, v171
  v_exp_f32 v172, v166
  v_cvt_pk_bf16_f32 v160, v176, v177
  v_exp_f32 v173, v167
  v_exp_f32 v174, v168
  v_mov_b32_dpp v161, v160 row_ror:8 row_mask:0xf bank_mask:0xf
  v_cvt_pk_bf16_f32 v156, v172, v173
  v_exp_f32 v175, v169
  v_mfma_f32_16x16x32_bf16 v[178:181], v[140:143], v[160:163], 0
  v_mov_b32_dpp v158, v156 row_ror:8 row_mask:0xf bank_mask:0xf
  v_cvt_pk_bf16_f32 v157, v174, v175
  v_mfma_f32_16x16x32_bf16 v[182:185], v[136:139], v[160:163], 0
  s_nop 0
  v_mov_b32_dpp v159, v157 row_ror:8 row_mask:0xf bank_mask:0xf
  v_mfma_f32_16x16x32_bf16 v[186:189], v[138:141], v[160:163], 0
  s_branch pv_168
fx_170:
  s_bitcmp1_b32 s81, 0
  s_cbranch_scc1 fk_171
  s_or_b32 s81, s81, 1
  s_mov_b64 exec, -1
  v_max3_f32 v164, v166, v167, v168
  v_max3_f32 v165, v169, v170, v171
  v_max_f32 v164, v164, v165
  s_nop 1
  v_max_f32_dpp v164, v164, v164 row_ror:8 row_mask:0xf bank_mask:0xf
  v_mov_b32 v165, v164
  s_nop 1
  v_permlane32_swap_b32 v164, v165
  v_max_f32 v164, v164, v165
  v_mov_b32 v165, v164
  s_nop 1
  v_permlane16_swap_b32 v164, v165
  v_max_f32 v164, v164, v165
  v_sub_f32 v166, v166, v164
  v_sub_f32 v167, v167, v164
  v_sub_f32 v168, v168, v164
  v_sub_f32 v169, v169, v164
  v_sub_f32 v170, v170, v164
  v_sub_f32 v171, v171, v164
  s_branch ex_169
p2_176:
  s_mov_b32 s54, 0
  buffer_load_dwordx4 v[68:71], v16, s[4:7], s60 offen sc1
  s_waitcnt vmcnt(1)
  v_mfma_f32_16x16x32_f16 v[120:123], v[44:47], v[72:75], 0
  v_bitop3_b32 v27, v72, s61, 1 bitop3:0x28
  v_cmp_ne_u32 vcc, 0, v27
  s_nop 1
  s_cbranch_vccz pg_175
  buffer_load_dwordx4 v[72:75], v16, s[4:7], s60 offen sc1
pp_174:
  s_waitcnt vmcnt(1)
  v_mfma_f32_16x16x32_f16 v[120:123], v[44:47], v[68:71], 0
  v_bitop3_b32 v27, v68, s61, 1 bitop3:0x28
  v_cmp_ne_u32 vcc, 0, v27
  s_nop 1
  s_cbranch_vccz pg_175
  buffer_load_dwordx4 v[68:71], v16, s[4:7], s60 offen sc1
  s_waitcnt vmcnt(1)
  v_mfma_f32_16x16x32_f16 v[120:123], v[44:47], v[72:75], 0
  v_bitop3_b32 v27, v72, s61, 1 bitop3:0x28
  v_cmp_ne_u32 vcc, 0, v27
  s_nop 1
  s_cbranch_vccz pg_175
  buffer_load_dwordx4 v[72:75], v16, s[4:7], s60 offen sc1
  s_add_u32 s54, s54, 1
  s_cmp_gt_u32 s54, 131072
  s_cbranch_scc1 end0
  s_branch pp_174
last_163:
  v_min_u32 v108, -2, v108
  buffer_store_dwordx2 v[108:109], v37, s[16:19], s70 offen offset:3072 sc1
  v_smfmac_f32_16x16x64_bf16 v[96:99], v[48:51], a[0:7], v22
  v_smfmac_f32_16x16x64_bf16 v[100:103], v[48:51], a[80:87], v22
  v_smfmac_f32_16x16x64_bf16 v[96:99], v[52:55], a[8:15], v22
  v_smfmac_f32_16x16x64_bf16 v[100:103], v[52:55], a[88:95], v22
  v_smfmac_f32_16x16x64_bf16 v[96:99], v[56:59], a[16:23], v22
  v_smfmac_f32_16x16x64_bf16 v[100:103], v[56:59], a[96:103], v22
  v_smfmac_f32_16x16x64_bf16 v[96:99], v[60:63], a[24:31], v22
  v_smfmac_f32_16x16x64_bf16 v[96:99], v[64:67], a[32:39], v22
  v_smfmac_f32_16x16x64_bf16 v[96:99], v[68:71], a[40:47], v22
  v_smfmac_f32_16x16x64_bf16 v[96:99], v[72:75], a[48:55], v22
  v_smfmac_f32_16x16x64_bf16 v[96:99], v[76:79], a[56:63], v22
  v_smfmac_f32_16x16x64_bf16 v[96:99], v[80:83], a[64:71], v22
  v_smfmac_f32_16x16x64_bf16 v[96:99], v[84:87], a[72:79], v22
  v_smfmac_f32_16x16x64_bf16 v[100:103], v[60:63], a[104:111], v22
  v_smfmac_f32_16x16x64_bf16 v[100:103], v[64:67], a[112:119], v22
  v_smfmac_f32_16x16x64_bf16 v[100:103], v[68:71], a[120:127], v22
  v_smfmac_f32_16x16x64_bf16 v[100:103], v[72:75], a[128:135], v22
  v_smfmac_f32_16x16x64_bf16 v[100:103], v[76:79], a[136:143], v22
  v_smfmac_f32_16x16x64_bf16 v[100:103], v[80:83], a[144:151], v22
  v_smfmac_f32_16x16x64_bf16 v[100:103], v[84:87], a[152:159], v22
  s_nop 7
  v_permlane32_swap_b32 v96, v100
  v_permlane32_swap_b32 v97, v101
  v_permlane32_swap_b32 v98, v102
  v_permlane32_swap_b32 v99, v103
  v_pk_add_f32 v[96:97], v[96:97], v[100:101]
  v_pk_add_f32 v[98:99], v[98:99], v[102:103]
  v_cvt_pk_bf16_f32 v100, v96, v97
  v_cvt_pk_bf16_f32 v101, v98, v99
  s_nop 0
  v_permlane32_swap_b32 v100, v102
  v_permlane32_swap_b32 v101, v103
  v_min_u32 v100, -2, v100
  buffer_store_dwordx4 v[100:103], v26, s[16:19], s70 offen sc1
  s_waitcnt vmcnt(0)
  s_barrier
  s_branch chain_done
E_29:
  v_add_u32 v190, 5120, v4
  ds_write_b64 v6, v[28:29]
  ds_write_b32 v13, v28
  ds_write_b32 v14, v28
  s_waitcnt vmcnt(0)
  ds_write_b128 v190, v[68:71] offset:0
  ds_write_b128 v190, v[72:75] offset:1024
  s_waitcnt lgkmcnt(0)
  s_add_u32 m0, s74, 8192
  s_add_u32 s21, s72, 0
  buffer_load_dwordx4 v32, s[16:19], s21 offen sc1 lds
  s_add_u32 m0, s74, 6144
  s_mul_i32 s21, s91, 3
  s_add_u32 s21, s21, s71
  buffer_load_dwordx4 v4, s[16:19], s21 offen sc1 lds
  s_xor_b32 s74, s74, 16384
  s_add_u32 s73, s73, 2097152
  s_xor_b32 s73, s73, 8192
  s_add_u32 s79, s79, 2097152
  s_xor_b32 s79, s79, 8192
  s_add_u32 s21, s72, 524288
  s_xor_b32 s72, s72, s21
  s_lshr_b32 s72, s72, 8
  s_and_b32 s72, s72, 8192
  s_xor_b32 s72, s72, s21
  s_add_u32 s71, s73, 4096
  s_mov_b32 s91, 1024
  s_sub_u32 s21, s73, 0
  s_cmp_lt_u32 s21, 125829120
  s_cselect_b32 s71, s71, s79
  s_cselect_b32 s91, s91, 65536
  s_branch mo_189
  .p2align 3
top_184:
  s_waitcnt vmcnt(1)
  ds_write_b128 v190, v[68:71] offset:0
  v_cmp_eq_u32 s[22:23], -1, v68
  s_waitcnt vmcnt(0)
  ds_write_b128 v190, v[72:75] offset:1024
  v_cmp_eq_u32 s[98:99], -1, v72
  s_or_b64 vcc, s[22:23], s[98:99]
  s_cbranch_scc1 mr_185
mo_189:
  s_barrier
  ds_read_b128 v[48:51], v4 offset:0
  ds_read_b128 v[52:55], v4 offset:1024
  v_smfmac_f32_16x16x64_bf16 v[92:95], v[68:71], v[216:223], v22
  ds_read_b128 v[56:59], v4 offset:2048
  v_smfmac_f32_16x16x64_bf16 v[88:91], v[68:71], a[200:207], v22
  ds_read_b128 v[60:63], v4 offset:3072
  v_smfmac_f32_16x16x64_bf16 v[92:95], v[72:75], v[224:231], v22
  ds_read_b128 v[64:67], v4 offset:4096
  v_smfmac_f32_16x16x64_bf16 v[88:91], v[72:75], a[208:215], v22
  s_waitcnt lgkmcnt(4)
  ds_read_b128 v[76:79], v4 offset:7168
  v_smfmac_f32_16x16x64_bf16 v[92:95], v[48:51], a[240:247], v22
  ds_read_b128 v[80:83], v4 offset:8192
  v_smfmac_f32_16x16x64_bf16 v[88:91], v[48:51], a[160:167], v22
  s_waitcnt lgkmcnt(5)
  ds_read_b128 v[84:87], v4 offset:9216
  v_smfmac_f32_16x16x64_bf16 v[92:95], v[52:55], a[248:255], v22
  v_smfmac_f32_16x16x64_bf16 v[88:91], v[52:55], a[168:175], v22
  s_waitcnt lgkmcnt(5)
  v_smfmac_f32_16x16x64_bf16 v[92:95], v[56:59], v[192:199], v22
  s_waitcnt lgkmcnt(4)
  v_smfmac_f32_16x16x64_bf16 v[92:95], v[60:63], v[200:207], v22
  s_waitcnt lgkmcnt(3)
  v_smfmac_f32_16x16x64_bf16 v[92:95], v[64:67], v[208:215], v22
  s_waitcnt lgkmcnt(2)
  v_smfmac_f32_16x16x64_bf16 v[92:95], v[76:79], v[232:239], v22
  s_waitcnt lgkmcnt(1)
  v_smfmac_f32_16x16x64_bf16 v[92:95], v[80:83], v[240:247], v22
  s_waitcnt lgkmcnt(0)
  v_smfmac_f32_16x16x64_bf16 v[92:95], v[84:87], v[248:255], v22
  v_smfmac_f32_16x16x64_bf16 v[88:91], v[56:59], a[176:183], v22
  v_smfmac_f32_16x16x64_bf16 v[88:91], v[60:63], a[184:191], v22
  v_smfmac_f32_16x16x64_bf16 v[88:91], v[64:67], a[192:199], v22
  v_permlane32_swap_b32 v92, v93
  v_smfmac_f32_16x16x64_bf16 v[88:91], v[76:79], a[216:223], v22
  v_permlane32_swap_b32 v94, v95
  v_smfmac_f32_16x16x64_bf16 v[88:91], v[80:83], a[224:231], v22
  v_permlane32_swap_b32 v93, v92
  v_smfmac_f32_16x16x64_bf16 v[88:91], v[84:87], a[232:239], v22
  v_permlane32_swap_b32 v95, v94
  v_pk_mul_f32 v[120:121], v[92:93], v[24:25] op_sel:[1,0] op_sel_hi:[0,1]
  v_pk_mul_f32 v[122:123], v[94:95], v[24:25] op_sel:[1,0] op_sel_hi:[0,1]
  s_nop 4
  v_pk_fma_f32 v[88:89], v[88:89], v[24:25], v[120:121]
  v_pk_fma_f32 v[90:91], v[90:91], v[24:25], v[122:123]
  v_cvt_pk_bf16_f32 v120, v88, v89
  v_cvt_pk_bf16_f32 v121, v90, v91
  ds_write_b64 v6, v[120:121]
  s_barrier
  ds_read_b64_tr_b16 v[104:105], v7 offset:0
  ds_read_b64_tr_b16 v[106:107], v7 offset:768
  ds_read_b64_tr_b16 v[108:109], v7 offset:1536
  s_waitcnt lgkmcnt(1)
  v_mfma_f32_16x16x32_bf16 v[120:123], v[104:107], v[104:107], 0
  s_waitcnt lgkmcnt(0)
  v_mfma_f32_16x16x32_bf16 v[120:123], v[108:111], v[108:111], v[120:123]
  s_mov_b64 exec, s[64:65]
  s_nop 6
  v_cmpx_o_f32 vcc, v120, v121
  v_cvt_pk_f16_f32 v120, v120, v121
  buffer_store_dword v120, v8, s[8:11], s56 offen sc1
  v_cmpx_o_f32 vcc, v122, v123
  v_cvt_pk_f16_f32 v121, v122, v123
  buffer_store_dword v121, v8, s[8:11], s56 offen offset:128 sc1
  s_xor_b64 s[98:99], exec, s[64:65]
  s_mov_b64 exec, -1
  s_waitcnt lgkmcnt(0)
  s_barrier
  ds_read_b64_tr_b16 v[104:105], v7 offset:0
  ds_read_b64_tr_b16 v[106:107], v7 offset:768
  ds_read_b64_tr_b16 v[108:109], v7 offset:1536
  ds_read_b32 v27, v12 offset:12544
  ds_read_b64 v[140:141], v11
  s_waitcnt lgkmcnt(1)
  v_cmp_u_f32 vcc, v104, v106
  v_cmp_u_f32 s[22:23], v108, v27
  s_nop 1
  s_or_b64 vcc, vcc, s[22:23]
  s_cbranch_vccnz mn_186
mk_187:
  s_cmp_eq_u32 s52, 63
  s_cbranch_scc1 last_188
  s_cmp_lg_u64 s[98:99], 0
  s_cbranch_scc1 sf_190
sf_191:
  s_nop 15
  s_nop 10
  v_smfmac_f32_16x16x64_bf16 v[96:99], v[48:51], a[0:7], v22
  v_smfmac_f32_16x16x64_bf16 v[100:103], v[48:51], a[80:87], v22
  v_smfmac_f32_16x16x64_bf16 v[96:99], v[52:55], a[8:15], v22
  v_smfmac_f32_16x16x64_bf16 v[100:103], v[52:55], a[88:95], v22
  v_smfmac_f32_16x16x64_bf16 v[96:99], v[56:59], a[16:23], v22
  v_smfmac_f32_16x16x64_bf16 v[100:103], v[56:59], a[96:103], v22
  buffer_load_dwordx4 v[132:135], v10, s[8:11], s56 offen sc1
  v_smfmac_f32_16x16x64_bf16 v[96:99], v[60:63], a[24:31], v22
  buffer_load_dwordx4 v[124:127], v9, s[8:11], s56 offen sc1
  v_smfmac_f32_16x16x64_bf16 v[96:99], v[64:67], a[32:39], v22
  buffer_load_dwordx4 v[128:131], v9, s[8:11], s56 offen offset:1024 sc1
  v_smfmac_f32_16x16x64_bf16 v[96:99], v[68:71], a[40:47], v22
  v_smfmac_f32_16x16x64_bf16 v[96:99], v[72:75], a[48:55], v22
  v_smfmac_f32_16x16x64_bf16 v[96:99], v[76:79], a[56:63], v22
  v_smfmac_f32_16x16x64_bf16 v[96:99], v[80:83], a[64:71], v22
  v_smfmac_f32_16x16x64_bf16 v[96:99], v[84:87], a[72:79], v22
  v_smfmac_f32_16x16x64_bf16 v[100:103], v[60:63], a[104:111], v22
  v_smfmac_f32_16x16x64_bf16 v[100:103], v[64:67], a[112:119], v22
  v_smfmac_f32_16x16x64_bf16 v[100:103], v[68:71], a[120:127], v22
  v_smfmac_f32_16x16x64_bf16 v[100:103], v[72:75], a[128:135], v22
  v_cvt_pk_bf16_f32 v136, v96, v97
  v_smfmac_f32_16x16x64_bf16 v[100:103], v[76:79], a[136:143], v22
  v_cvt_pk_bf16_f32 v137, v98, v99
  v_smfmac_f32_16x16x64_bf16 v[100:103], v[80:83], a[144:151], v22
  v_smfmac_f32_16x16x64_bf16 v[100:103], v[84:87], a[152:159], v22
  s_nop 7
  v_cvt_pk_bf16_f32 v138, v100, v101
  v_cvt_pk_bf16_f32 v139, v102, v103
  s_waitcnt vmcnt(2) lgkmcnt(0)
  v_pk_add_f16 v164, v132, v133
  v_pk_add_f16 v165, v134, v135
  v_fma_mix_f32 v170, v164, 1.0, v165 op_sel:[0,0,0] op_sel_hi:[1,0,1]
  v_fma_mix_f32 v171, v164, 1.0, v165 op_sel:[1,0,1] op_sel_hi:[1,0,1]
  v_exp_f32 v176, v170
  v_exp_f32 v177, v171
  s_waitcnt vmcnt(1)
  v_cvt_pk_bf16_f32 v160, v176, v177
  v_pk_add_f16 v120, v124, v126
  v_pk_add_f16 v121, v125, v127
  v_mov_b32_dpp v161, v160 row_ror:8 row_mask:0xf bank_mask:0xf
  s_waitcnt vmcnt(0)
  v_pk_add_f16 v122, v128, v130
  v_mfma_f32_16x16x32_bf16 v[178:181], v[140:143], v[160:163], 0
  v_fma_mix_f32 v166, v120, 1.0, v122 op_sel:[0,0,0] op_sel_hi:[1,0,1]
  v_fma_mix_f32 v167, v120, 1.0, v122 op_sel:[1,0,1] op_sel_hi:[1,0,1]
  v_cmp_u_f32 vcc, v166, v170
  v_pk_add_f16 v123, v129, v131
  v_exp_f32 v172, v166
  v_mfma_f32_16x16x32_bf16 v[182:185], v[136:139], v[160:163], 0
  s_cbranch_vccnz sr_192
  v_exp_f32 v173, v167
  v_fma_mix_f32 v168, v121, 1.0, v123 op_sel:[0,0,0] op_sel_hi:[1,0,1]
  v_fma_mix_f32 v169, v121, 1.0, v123 op_sel:[1,0,1] op_sel_hi:[1,0,1]
  v_cvt_pk_bf16_f32 v156, v172, v173
  v_exp_f32 v174, v168
  v_exp_f32 v175, v169
  v_mov_b32_dpp v158, v156 row_ror:8 row_mask:0xf bank_mask:0xf
  v_cvt_pk_bf16_f32 v157, v174, v175
  v_mfma_f32_16x16x32_bf16 v[186:189], v[138:141], v[160:163], 0
  s_nop 0
  v_mov_b32_dpp v159, v157 row_ror:8 row_mask:0xf bank_mask:0xf
  s_nop 1
pv_193:
  v_mfma_f32_16x16x32_bf16 v[178:181], v[152:155], v[156:159], v[178:181]
  v_mfma_f32_16x16x32_bf16 v[182:185], v[144:147], v[156:159], v[182:185]
  v_mfma_f32_16x16x32_bf16 v[186:189], v[148:151], v[156:159], v[186:189]
  s_mov_b64 exec, s[62:63]
  s_nop 0
  v_rcp_f32 v164, v180
  v_cmp_ngt_f32 s[22:23], s80, v180
  v_cmp_ngt_f32 vcc, s80, v164
  v_pk_mul_f32 v[182:183], v[182:183], v[164:165] op_sel_hi:[1,0]
  v_pk_mul_f32 v[184:185], v[184:185], v[164:165] op_sel_hi:[1,0]
  v_pk_mul_f32 v[178:179], v[178:179], v[164:165] op_sel_hi:[1,0]
  v_pk_mul_f32 v[186:187], v[186:187], v[164:165] op_sel_hi:[1,0]
  v_pk_mul_f32 v[188:189], v[188:189], v[164:165] op_sel_hi:[1,0]
  v_cvt_pk_f16_f32 v64, v178, v179
  s_or_b64 vcc, vcc, s[22:23]
  s_cbranch_scc1 fx_195
fk_196:
  ds_write_b32 v14, v64
  v_cvt_pk_f16_f32 v60, v182, v183
  v_cvt_pk_f16_f32 v61, v184, v185
  v_cvt_pk_f16_f32 v62, v186, v187
  v_cvt_pk_f16_f32 v63, v188, v189
  ds_write_b128 v13, v[60:63]
  s_barrier
  s_mov_b64 exec, -1
  s_and_b32 s21, s52, 3
  s_cmp_lt_u32 s52, 58
  s_cselect_b32 s21, s21, 0
  s_cmp_lg_u32 s21, 0
  s_cbranch_scc1 fs_197
  v_mov_b32 v27, s52
  s_mov_b64 exec, 1
  buffer_store_dword v27, v23, s[12:15], s77 offen sc1
  s_mov_b64 exec, -1
fs_197:
  s_add_u32 m0, s74, 8192
  s_add_u32 s21, s72, 0
  buffer_load_dwordx4 v32, s[16:19], s21 offen sc1 lds
  s_add_u32 m0, s74, 6144
  s_mul_i32 s21, s91, 3
  s_add_u32 s21, s21, s71
  buffer_load_dwordx4 v4, s[16:19], s21 offen sc1 lds
  s_xor_b32 s74, s74, 16384
  s_add_u32 s73, s73, 2097152
  s_xor_b32 s73, s73, 8192
  s_add_u32 s79, s79, 2097152
  s_xor_b32 s79, s79, 8192
  s_add_u32 s21, s72, 524288
  s_xor_b32 s72, s72, s21
  s_lshr_b32 s72, s72, 8
  s_and_b32 s72, s72, 8192
  s_xor_b32 s72, s72, s21
  s_add_u32 s71, s73, 4096
  s_mov_b32 s91, 1024
  s_sub_u32 s21, s73, 0
  s_cmp_lt_u32 s21, 125829120
  s_cselect_b32 s71, s71, s79
  s_cselect_b32 s91, s91, 65536
  v_permlane32_swap_b32 v96, v100
  v_permlane32_swap_b32 v97, v101
  v_permlane32_swap_b32 v98, v102
  v_permlane32_swap_b32 v99, v103
  v_pk_add_f32 v[96:97], v[96:97], v[100:101]
  v_pk_add_f32 v[98:99], v[98:99], v[102:103]
  v_cvt_pk_bf16_f32 v100, v96, v97
  v_cvt_pk_bf16_f32 v101, v98, v99
  s_nop 0
  v_permlane32_swap_b32 v100, v102
  v_permlane32_swap_b32 v101, v103
  v_min_u32 v100, -2, v100
  s_nop 6
  buffer_store_dwordx4 v[100:103], v26, s[16:19], s70 offen sc1
  s_add_u32 s70, s70, 2097152
  s_xor_b32 s70, s70, 8192
  ds_read_b128 v[144:147], v18
  ds_read_b128 v[148:151], v18 offset:1024
  ds_read_b128 v[152:155], v19
  v_xor_b32 v18, 16384, v18
  v_xor_b32 v19, 16384, v19
  v_mov_b32 v88, 0
  v_mov_b32 v89, 0
  v_mov_b32 v90, 0
  v_mov_b32 v91, 0
  v_mov_b32 v92, 0
  v_mov_b32 v93, 0
  v_mov_b32 v94, 0
  v_mov_b32 v95, 0
  v_mov_b32 v96, 0
  v_mov_b32 v97, 0
  v_mov_b32 v98, 0
  v_mov_b32 v99, 0
  v_mov_b32 v100, 0
  v_mov_b32 v101, 0
  v_mov_b32 v102, 0
  v_mov_b32 v103, 0
  s_mov_b32 s81, 0
  s_waitcnt lgkmcnt(0)
  s_barrier
  s_mov_b64 exec, s[64:65]
  buffer_store_dword v28, v8, s[8:11], s57 offen sc1
  buffer_store_dword v28, v8, s[8:11], s57 offen offset:128 sc1
  s_mov_b64 exec, -1
  ds_write_b128 v190, v[28:31] offset:0
  ds_write_b128 v190, v[28:31] offset:1024
  ds_write_b64 v6, v[28:29]
  s_mov_b64 exec, -1
  s_cmp_eq_u32 s78, 0
  s_cbranch_scc1 nt_199
  s_mov_b64 exec, s[62:63]
  buffer_store_dword v28, v17, s[8:11], s59 offen sc1
  s_mov_b64 exec, -1
  s_sleep 3
  s_nop 1
  buffer_load_dwordx4 v[68:71], v16, s[4:7], s60 offen sc1
  s_sleep 3
  s_nop 1
  buffer_load_dwordx4 v[72:75], v16, s[4:7], s60 offen sc1
  s_waitcnt vmcnt(1)
  v_mfma_f32_16x16x32_f16 v[120:123], v[44:47], v[68:71], 0
  v_bitop3_b32 v27, v68, s61, 1 bitop3:0x28
  v_cmp_ne_u32 vcc, 0, v27
  s_nop 1
  s_cbranch_vccnz p2_202
  s_nop 2
pg_201:
  v_add_f32_dpp v120, v120, v120 row_ror:8 row_mask:0xf bank_mask:0xf
  v_add_f32_dpp v121, v121, v121 row_ror:8 row_mask:0xf bank_mask:0xf
  s_mov_b64 exec, s[62:63]
  v_cvt_pk_bf16_f32 v120, v120, v121
  v_min_u32 v120, -2, v120
  buffer_store_dword v120, v17, s[8:11], s55 offen sc1
  s_mov_b64 exec, -1
nt_198:
  s_barrier
  s_mov_b32 s58, s55
  s_add_u32 s52, s52, 1
  ds_write_b32 v13, v28
  ds_write_b32 v14, v28
  s_and_b32 s21, s52, 3
  s_mul_i32 s56, s21, 122880
  s_add_u32 s21, s52, 1
  s_and_b32 s21, s21, 3
  s_mul_i32 s55, s21, 122880
  s_add_u32 s55, s55, s75
  s_add_u32 s21, s52, 2
  s_and_b32 s21, s21, 3
  s_mul_i32 s57, s21, 122880
  s_add_u32 s21, s52, 3
  s_and_b32 s21, s21, 3
  s_mul_i32 s59, s21, 122880
  s_add_u32 s59, s59, s75
  s_bfe_u32 s61, s52, 0x10002
  s_and_b32 s21, s52, 3
  s_lshl_b32 s60, s21, 18
  s_mov_b32 s54, 0
  s_sleep 2
  s_nop 10
  s_waitcnt lgkmcnt(0)
  buffer_load_dwordx4 v[68:71], v190, s[8:11], s58 offen offset:0 sc1
  buffer_load_dwordx4 v[72:75], v190, s[8:11], s58 offen offset:1024 sc1
  s_branch top_184
mr_185:
  s_mov_b64 exec, s[22:23]
  s_cbranch_execz ms_203
  buffer_load_dwordx4 v[68:71], v190, s[8:11], s58 offen offset:0 sc1
ms_203:
  s_mov_b64 exec, s[98:99]
  s_cbranch_execz ms_204
  buffer_load_dwordx4 v[72:75], v190, s[8:11], s58 offen offset:1024 sc1
ms_204:
  s_add_u32 s54, s54, 1
  s_cmp_gt_u32 s54, 131072
  s_cbranch_scc1 end0
  s_waitcnt vmcnt(0)
  s_mov_b64 exec, s[22:23]
  ds_write_b128 v190, v[68:71] offset:0
  v_cmp_eq_u32 s[22:23], -1, v68
  s_mov_b64 exec, s[98:99]
  ds_write_b128 v190, v[72:75] offset:1024
  v_cmp_eq_u32 s[98:99], -1, v72
  s_mov_b64 exec, -1
  s_or_b64 vcc, s[22:23], s[98:99]
  s_cbranch_scc1 mr_185
  s_branch mo_189
sf_190:
  s_waitcnt lgkmcnt(1)
  v_mfma_f32_16x16x32_bf16 v[120:123], v[104:107], v[104:107], 0
  s_waitcnt lgkmcnt(0)
  v_mfma_f32_16x16x32_bf16 v[120:123], v[108:111], v[108:111], v[120:123]
  s_mov_b64 exec, s[64:65]
  s_nop 6
  v_cvt_pk_f16_f32 v120, v120, v121
  buffer_store_dword v120, v8, s[8:11], s56 offen sc1
  v_cvt_pk_f16_f32 v121, v122, v123
  buffer_store_dword v121, v8, s[8:11], s56 offen offset:128 sc1
  s_mov_b64 exec, -1
  s_branch sf_191
mn_186:
  s_bitcmp1_b32 s81, 1
  s_cbranch_scc1 mk_187
  s_or_b32 s81, s81, 2
  s_nop 7
  v_mov_b32 v88, 0
  v_mov_b32 v89, 0
  v_mov_b32 v90, 0
  v_mov_b32 v91, 0
  v_mov_b32 v92, 0
  v_mov_b32 v93, 0
  v_mov_b32 v94, 0
  v_mov_b32 v95, 0
  v_mov_b32 v96, 0
  v_mov_b32 v97, 0
  v_mov_b32 v98, 0
  v_mov_b32 v99, 0
  v_mov_b32 v100, 0
  v_mov_b32 v101, 0
  v_mov_b32 v102, 0
  v_mov_b32 v103, 0
  s_cmp_eq_u32 s52, 0
  s_cbranch_scc1 mx_206
mx_205:
  buffer_load_dwordx4 v[68:71], v190, s[8:11], s58 offen offset:0 sc1
  buffer_load_dwordx4 v[72:75], v190, s[8:11], s58 offen offset:1024 sc1
  s_add_u32 s54, s54, 1
  s_cmp_gt_u32 s54, 131072
  s_cbranch_scc1 end0
  s_waitcnt vmcnt(0)
  v_max3_u32 v27, v68, v69, v70
  v_max3_u32 v27, v27, v71, v72
  v_max3_u32 v27, v27, v73, v74
  v_max3_u32 v27, v27, v75, v75
  v_cmp_eq_u32 vcc, -1, v27
  s_nop 1
  s_cbranch_vccnz mx_205
  ds_write_b128 v190, v[68:71] offset:0
  ds_write_b128 v190, v[72:75] offset:1024
mx_206:
  s_waitcnt lgkmcnt(0)
  s_branch mo_189
sr_192:
  s_mov_b32 s54, 0
sr_207:
  s_mov_b64 exec, vcc
  buffer_load_dwordx4 v[124:127], v9, s[8:11], s56 offen sc1
  buffer_load_dwordx4 v[128:131], v9, s[8:11], s56 offen offset:1024 sc1
  buffer_load_dwordx4 v[132:135], v10, s[8:11], s56 offen sc1
  s_mov_b64 exec, -1
  s_add_u32 s54, s54, 1
  s_cmp_gt_u32 s54, 131072
  s_cbranch_scc1 end0
  s_waitcnt vmcnt(0)
  v_pk_add_f16 v164, v132, v133
  v_pk_add_f16 v165, v134, v135
  v_pk_add_f16 v120, v124, v126
  v_pk_add_f16 v122, v128, v130
  v_fma_mix_f32 v170, v164, 1.0, v165 op_sel:[0,0,0] op_sel_hi:[1,0,1]
  v_fma_mix_f32 v166, v120, 1.0, v122 op_sel:[0,0,0] op_sel_hi:[1,0,1]
  v_pk_add_f16 v121, v125, v127
  v_cmp_u_f32 vcc, v166, v170
  v_pk_add_f16 v123, v129, v131
  v_fma_mix_f32 v171, v164, 1.0, v165 op_sel:[1,0,1] op_sel_hi:[1,0,1]
  v_fma_mix_f32 v167, v120, 1.0, v122 op_sel:[1,0,1] op_sel_hi:[1,0,1]
  v_fma_mix_f32 v168, v121, 1.0, v123 op_sel:[0,0,0] op_sel_hi:[1,0,1]
  v_fma_mix_f32 v169, v121, 1.0, v123 op_sel:[1,0,1] op_sel_hi:[1,0,1]
  s_cbranch_vccz ex_194
  s_and_b32 s21, s54, 31
  s_cbranch_scc1 sr_207
  v_max3_u32 v27, v124, v126, v128
  v_max3_u32 v27, v27, v130, v132
  v_max3_u32 v27, v27, v133, v134
  v_max3_u32 v27, v27, v135, v135
  v_cmp_eq_u32 vcc, -1, v27
  s_nop 1
  s_cbranch_vccnz sr_207
ex_194:
  v_exp_f32 v176, v170
  v_exp_f32 v177, v171
  v_exp_f32 v172, v166
  v_cvt_pk_bf16_f32 v160, v176, v177
  v_exp_f32 v173, v167
  v_exp_f32 v174, v168
  v_mov_b32_dpp v161, v160 row_ror:8 row_mask:0xf bank_mask:0xf
  v_cvt_pk_bf16_f32 v156, v172, v173
  v_exp_f32 v175, v169
  v_mfma_f32_16x16x32_bf16 v[178:181], v[140:143], v[160:163], 0
  v_mov_b32_dpp v158, v156 row_ror:8 row_mask:0xf bank_mask:0xf
  v_cvt_pk_bf16_f32 v157, v174, v175
  v_mfma_f32_16x16x32_bf16 v[182:185], v[136:139], v[160:163], 0
  s_nop 0
  v_mov_b32_dpp v159, v157 row_ror:8 row_mask:0xf bank_mask:0xf
  v_mfma_f32_16x16x32_bf16 v[186:189], v[138:141], v[160:163], 0
  s_branch pv_193
fx_195:
  s_bitcmp1_b32 s81, 0
  s_cbranch_scc1 fk_196
  s_or_b32 s81, s81, 1
  s_mov_b64 exec, -1
  v_max3_f32 v164, v166, v167, v168
  v_max3_f32 v165, v169, v170, v171
  v_max_f32 v164, v164, v165
  s_nop 1
  v_max_f32_dpp v164, v164, v164 row_ror:8 row_mask:0xf bank_mask:0xf
  v_mov_b32 v165, v164
  s_nop 1
  v_permlane32_swap_b32 v164, v165
  v_max_f32 v164, v164, v165
  v_mov_b32 v165, v164
  s_nop 1
  v_permlane16_swap_b32 v164, v165
  v_max_f32 v164, v164, v165
  v_sub_f32 v166, v166, v164
  v_sub_f32 v167, v167, v164
  v_sub_f32 v168, v168, v164
  v_sub_f32 v169, v169, v164
  v_sub_f32 v170, v170, v164
  v_sub_f32 v171, v171, v164
  s_branch ex_194
nt_199:
  s_branch nt_198
p2_202:
  s_mov_b32 s54, 0
  buffer_load_dwordx4 v[68:71], v16, s[4:7], s60 offen sc1
  s_waitcnt vmcnt(1)
  v_mfma_f32_16x16x32_f16 v[120:123], v[44:47], v[72:75], 0
  v_bitop3_b32 v27, v72, s61, 1 bitop3:0x28
  v_cmp_ne_u32 vcc, 0, v27
  s_nop 1
  s_cbranch_vccz pg_201
  buffer_load_dwordx4 v[72:75], v16, s[4:7], s60 offen sc1
pp_200:
  s_waitcnt vmcnt(1)
  v_mfma_f32_16x16x32_f16 v[120:123], v[44:47], v[68:71], 0
  v_bitop3_b32 v27, v68, s61, 1 bitop3:0x28
  v_cmp_ne_u32 vcc, 0, v27
  s_nop 1
  s_cbranch_vccz pg_201
  buffer_load_dwordx4 v[68:71], v16, s[4:7], s60 offen sc1
  s_waitcnt vmcnt(1)
  v_mfma_f32_16x16x32_f16 v[120:123], v[44:47], v[72:75], 0
  v_bitop3_b32 v27, v72, s61, 1 bitop3:0x28
  v_cmp_ne_u32 vcc, 0, v27
  s_nop 1
  s_cbranch_vccz pg_201
  buffer_load_dwordx4 v[72:75], v16, s[4:7], s60 offen sc1
  s_add_u32 s54, s54, 1
  s_cmp_gt_u32 s54, 131072
  s_cbranch_scc1 end0
  s_branch pp_200
last_188:
  v_smfmac_f32_16x16x64_bf16 v[96:99], v[48:51], a[0:7], v22
  v_smfmac_f32_16x16x64_bf16 v[100:103], v[48:51], a[80:87], v22
  v_smfmac_f32_16x16x64_bf16 v[96:99], v[52:55], a[8:15], v22
  v_smfmac_f32_16x16x64_bf16 v[100:103], v[52:55], a[88:95], v22
  v_smfmac_f32_16x16x64_bf16 v[96:99], v[56:59], a[16:23], v22
  v_smfmac_f32_16x16x64_bf16 v[100:103], v[56:59], a[96:103], v22
  v_smfmac_f32_16x16x64_bf16 v[96:99], v[60:63], a[24:31], v22
  v_smfmac_f32_16x16x64_bf16 v[96:99], v[64:67], a[32:39], v22
  v_smfmac_f32_16x16x64_bf16 v[96:99], v[68:71], a[40:47], v22
  v_smfmac_f32_16x16x64_bf16 v[96:99], v[72:75], a[48:55], v22
  v_smfmac_f32_16x16x64_bf16 v[96:99], v[76:79], a[56:63], v22
  v_smfmac_f32_16x16x64_bf16 v[96:99], v[80:83], a[64:71], v22
  v_smfmac_f32_16x16x64_bf16 v[96:99], v[84:87], a[72:79], v22
  v_smfmac_f32_16x16x64_bf16 v[100:103], v[60:63], a[104:111], v22
  v_smfmac_f32_16x16x64_bf16 v[100:103], v[64:67], a[112:119], v22
  v_smfmac_f32_16x16x64_bf16 v[100:103], v[68:71], a[120:127], v22
  v_smfmac_f32_16x16x64_bf16 v[100:103], v[72:75], a[128:135], v22
  v_smfmac_f32_16x16x64_bf16 v[100:103], v[76:79], a[136:143], v22
  v_smfmac_f32_16x16x64_bf16 v[100:103], v[80:83], a[144:151], v22
  v_smfmac_f32_16x16x64_bf16 v[100:103], v[84:87], a[152:159], v22
  s_nop 7
  v_permlane32_swap_b32 v96, v100
  v_permlane32_swap_b32 v97, v101
  v_permlane32_swap_b32 v98, v102
  v_permlane32_swap_b32 v99, v103
  v_pk_add_f32 v[96:97], v[96:97], v[100:101]
  v_pk_add_f32 v[98:99], v[98:99], v[102:103]
  v_cvt_pk_bf16_f32 v100, v96, v97
  v_cvt_pk_bf16_f32 v101, v98, v99
  s_nop 0
  v_permlane32_swap_b32 v100, v102
  v_permlane32_swap_b32 v101, v103
  v_min_u32 v100, -2, v100
  buffer_store_dwordx4 v[100:103], v26, s[16:19], s70 offen sc1
  s_waitcnt vmcnt(0)
  s_barrier
  s_branch chain_done
E_31:
  v_add_u32 v190, 7168, v4
  ds_write_b32 v13, v28
  ds_write_b32 v14, v28
  s_waitcnt vmcnt(0)
  ds_write_b128 v190, v[76:79] offset:0
  ds_write_b128 v190, v[80:83] offset:1024
  ds_write_b128 v190, v[84:87] offset:2048
  s_waitcnt lgkmcnt(0)
  s_branch mo_214
  .p2align 3
top_209:
  s_waitcnt vmcnt(2)
  ds_write_b128 v190, v[76:79] offset:0
  v_cmp_eq_u32 s[22:23], -1, v76
  s_waitcnt vmcnt(1)
  ds_write_b128 v190, v[80:83] offset:1024
  v_cmp_eq_u32 s[98:99], -1, v80
  s_waitcnt vmcnt(0)
  ds_write_b128 v190, v[84:87] offset:2048
  v_cmp_eq_u32 s[100:101], -1, v84
  s_or_b64 vcc, s[22:23], s[98:99]
  s_or_b64 vcc, vcc, s[100:101]
  s_cbranch_scc1 mr_210
mo_214:
  s_barrier
  ds_read_b128 v[48:51], v4 offset:0
  ds_read_b128 v[52:55], v4 offset:1024
  v_smfmac_f32_16x16x64_bf16 v[92:95], v[76:79], v[232:239], v22
  ds_read_b128 v[56:59], v4 offset:2048
  ds_read_b128 v[60:63], v4 offset:3072
  v_smfmac_f32_16x16x64_bf16 v[88:91], v[76:79], a[216:223], v22
  s_add_u32 m0, s74, 0
  s_add_u32 s21, s79, 0
  buffer_load_dwordx4 v4, s[16:19], s21 offen offset:1024 sc1 lds
  v_smfmac_f32_16x16x64_bf16 v[92:95], v[80:83], v[240:247], v22
  ds_read_b128 v[64:67], v4 offset:4096
  ds_read_b128 v[68:71], v4 offset:5120
  s_add_u32 s22, s52, 3
  s_min_u32 s22, s22, 64
  v_smfmac_f32_16x16x64_bf16 v[88:91], v[80:83], a[224:231], v22
  s_add_u32 m0, s74, 2048
  s_add_u32 s21, s79, 65536
  buffer_load_dwordx4 v4, s[16:19], s21 offen offset:1024 sc1 lds
  v_cmp_gt_u32 vcc, s22, v42
  v_smfmac_f32_16x16x64_bf16 v[92:95], v[84:87], v[248:255], v22
  ds_read_b128 v[72:75], v4 offset:6144
  s_cbranch_vccnz kw_215
kv_216:
  v_smfmac_f32_16x16x64_bf16 v[88:91], v[84:87], a[232:239], v22
  s_waitcnt lgkmcnt(6)
  s_add_u32 m0, s74, 10240
  s_nop 0
  buffer_load_dwordx4 v4, s[16:19], s73 offen offset:0 sc1 lds
  v_smfmac_f32_16x16x64_bf16 v[92:95], v[48:51], a[240:247], v22
  v_smfmac_f32_16x16x64_bf16 v[88:91], v[48:51], a[160:167], v22
  s_waitcnt lgkmcnt(5)
  s_add_u32 m0, s74, 10240
  s_nop 0
  buffer_load_dwordx4 v4, s[16:19], s73 offen offset:1024 sc1 lds
  v_smfmac_f32_16x16x64_bf16 v[92:95], v[52:55], a[248:255], v22
  s_waitcnt lgkmcnt(4)
  v_smfmac_f32_16x16x64_bf16 v[92:95], v[56:59], v[192:199], v22
  s_waitcnt lgkmcnt(3)
  s_add_u32 m0, s74, 10240
  s_nop 0
  buffer_load_dwordx4 v4, s[16:19], s73 offen offset:2048 sc1 lds
  v_smfmac_f32_16x16x64_bf16 v[92:95], v[60:63], v[200:207], v22
  s_waitcnt lgkmcnt(2)
  v_smfmac_f32_16x16x64_bf16 v[92:95], v[64:67], v[208:215], v22
  s_waitcnt lgkmcnt(1)
  s_add_u32 m0, s74, 0
  s_mul_i32 s21, s91, 0
  s_add_u32 s21, s21, s71
  buffer_load_dwordx4 v4, s[16:19], s21 offen sc1 lds
  v_smfmac_f32_16x16x64_bf16 v[92:95], v[68:71], v[216:223], v22
  s_waitcnt lgkmcnt(0)
  v_smfmac_f32_16x16x64_bf16 v[92:95], v[72:75], v[224:231], v22
  s_add_u32 m0, s74, 2048
  s_mul_i32 s21, s91, 1
  s_add_u32 s21, s21, s71
  buffer_load_dwordx4 v4, s[16:19], s21 offen sc1 lds
  v_smfmac_f32_16x16x64_bf16 v[88:91], v[52:55], a[168:175], v22
  v_smfmac_f32_16x16x64_bf16 v[88:91], v[56:59], a[176:183], v22
  v_smfmac_f32_16x16x64_bf16 v[88:91], v[60:63], a[184:191], v22
  v_cvt_pk_bf16_f32 v122, v92, v93
  v_smfmac_f32_16x16x64_bf16 v[88:91], v[64:67], a[192:199], v22
  v_cvt_pk_bf16_f32 v123, v94, v95
  s_barrier
  v_smfmac_f32_16x16x64_bf16 v[88:91], v[68:71], a[200:207], v22
  ds_write_b64 v12, v[122:123] offset:13056
  v_smfmac_f32_16x16x64_bf16 v[88:91], v[72:75], a[208:215], v22
  v_smfmac_f32_16x16x64_bf16 v[96:99], v[48:51], a[0:7], v22
  v_smfmac_f32_16x16x64_bf16 v[100:103], v[48:51], a[80:87], v22
  v_smfmac_f32_16x16x64_bf16 v[96:99], v[52:55], a[8:15], v22
  v_cvt_pk_bf16_f32 v120, v88, v89
  v_cvt_pk_bf16_f32 v121, v90, v91
  ds_write_b64 v12, v[120:121] offset:12544
  v_smfmac_f32_16x16x64_bf16 v[100:103], v[52:55], a[88:95], v22
  s_waitcnt lgkmcnt(0)
  s_barrier
  ds_read_b64_tr_b16 v[104:105], v7 offset:0
  ds_read_b64_tr_b16 v[106:107], v7 offset:768
  ds_read_b64_tr_b16 v[108:109], v7 offset:1536
  ds_read_b32 v27, v12 offset:12544
  ds_read_b64 v[140:141], v11
  s_waitcnt lgkmcnt(1)
  v_cmp_u_f32 vcc, v104, v106
  v_cmp_u_f32 s[22:23], v108, v27
  s_nop 1
  s_or_b64 vcc, vcc, s[22:23]
  s_cbranch_vccnz mn_211
mk_212:
  s_cmp_eq_u32 s52, 63
  s_cbranch_scc1 last_213
  v_permlane32_swap_b32 v88, v92
  v_permlane32_swap_b32 v89, v93
  v_permlane32_swap_b32 v90, v94
  v_permlane32_swap_b32 v91, v95
  v_pk_add_f32 v[88:89], v[88:89], v[92:93]
  v_pk_add_f32 v[90:91], v[90:91], v[94:95]
  v_cvt_pk_bf16_f32 v92, v88, v89
  v_cvt_pk_bf16_f32 v93, v90, v91
  v_min_u32 v92, -2, v92
  s_nop 0
  v_smfmac_f32_16x16x64_bf16 v[96:99], v[56:59], a[16:23], v22
  v_smfmac_f32_16x16x64_bf16 v[100:103], v[56:59], a[96:103], v22
  v_smfmac_f32_16x16x64_bf16 v[96:99], v[60:63], a[24:31], v22
  v_smfmac_f32_16x16x64_bf16 v[96:99], v[64:67], a[32:39], v22
  v_smfmac_f32_16x16x64_bf16 v[96:99], v[68:71], a[40:47], v22
  v_smfmac_f32_16x16x64_bf16 v[96:99], v[72:75], a[48:55], v22
  v_smfmac_f32_16x16x64_bf16 v[96:99], v[76:79], a[56:63], v22
  v_smfmac_f32_16x16x64_bf16 v[96:99], v[80:83], a[64:71], v22
  v_smfmac_f32_16x16x64_bf16 v[96:99], v[84:87], a[72:79], v22
  v_smfmac_f32_16x16x64_bf16 v[100:103], v[60:63], a[104:111], v22
  v_smfmac_f32_16x16x64_bf16 v[100:103], v[64:67], a[112:119], v22
  buffer_load_dwordx4 v[132:135], v10, s[8:11], s56 offen sc1
  v_smfmac_f32_16x16x64_bf16 v[100:103], v[68:71], a[120:127], v22
  buffer_load_dwordx4 v[124:127], v9, s[8:11], s56 offen sc1
  v_smfmac_f32_16x16x64_bf16 v[100:103], v[72:75], a[128:135], v22
  buffer_load_dwordx4 v[128:131], v9, s[8:11], s56 offen offset:1024 sc1
  v_cvt_pk_bf16_f32 v136, v96, v97
  v_smfmac_f32_16x16x64_bf16 v[100:103], v[76:79], a[136:143], v22
  v_cvt_pk_bf16_f32 v137, v98, v99
  v_smfmac_f32_16x16x64_bf16 v[100:103], v[80:83], a[144:151], v22
  v_smfmac_f32_16x16x64_bf16 v[100:103], v[84:87], a[152:159], v22
  s_nop 7
  v_cvt_pk_bf16_f32 v138, v100, v101
  v_cvt_pk_bf16_f32 v139, v102, v103
  v_permlane32_swap_b32 v96, v100
  v_permlane32_swap_b32 v97, v101
  v_permlane32_swap_b32 v98, v102
  v_permlane32_swap_b32 v99, v103
  v_pk_add_f32 v[96:97], v[96:97], v[100:101]
  v_pk_add_f32 v[98:99], v[98:99], v[102:103]
  v_cvt_pk_bf16_f32 v100, v96, v97
  v_cvt_pk_bf16_f32 v101, v98, v99
  s_nop 0
  v_permlane32_swap_b32 v100, v102
  v_permlane32_swap_b32 v101, v103
  v_min_u32 v100, -2, v100
  s_waitcnt vmcnt(2) lgkmcnt(0)
  v_pk_add_f16 v164, v132, v133
  v_pk_add_f16 v165, v134, v135
  v_fma_mix_f32 v170, v164, 1.0, v165 op_sel:[0,0,0] op_sel_hi:[1,0,1]
  v_fma_mix_f32 v171, v164, 1.0, v165 op_sel:[1,0,1] op_sel_hi:[1,0,1]
  v_exp_f32 v176, v170
  v_exp_f32 v177, v171
  s_waitcnt vmcnt(1)
  v_cvt_pk_bf16_f32 v160, v176, v177
  v_pk_add_f16 v120, v124, v126
  v_pk_add_f16 v121, v125, v127
  v_mov_b32_dpp v161, v160 row_ror:8 row_mask:0xf bank_mask:0xf
  s_waitcnt vmcnt(0)
  v_pk_add_f16 v122, v128, v130
  v_mfma_f32_16x16x32_bf16 v[178:181], v[140:143], v[160:163], 0
  v_fma_mix_f32 v166, v120, 1.0, v122 op_sel:[0,0,0] op_sel_hi:[1,0,1]
  v_fma_mix_f32 v167, v120, 1.0, v122 op_sel:[1,0,1] op_sel_hi:[1,0,1]
  v_cmp_u_f32 vcc, v166, v170
  v_pk_add_f16 v123, v129, v131
  v_exp_f32 v172, v166
  v_mfma_f32_16x16x32_bf16 v[182:185], v[136:139], v[160:163], 0
  s_cbranch_vccnz sr_219
  v_exp_f32 v173, v167
  v_fma_mix_f32 v168, v121, 1.0, v123 op_sel:[0,0,0] op_sel_hi:[1,0,1]
  v_fma_mix_f32 v169, v121, 1.0, v123 op_sel:[1,0,1] op_sel_hi:[1,0,1]
  v_cvt_pk_bf16_f32 v156, v172, v173
  v_exp_f32 v174, v168
  v_exp_f32 v175, v169
  v_mov_b32_dpp v158, v156 row_ror:8 row_mask:0xf bank_mask:0xf
  v_cvt_pk_bf16_f32 v157, v174, v175
  v_mfma_f32_16x16x32_bf16 v[186:189], v[138:141], v[160:163], 0
  s_nop 0
  v_mov_b32_dpp v159, v157 row_ror:8 row_mask:0xf bank_mask:0xf
  s_nop 1
pv_220:
  v_mfma_f32_16x16x32_bf16 v[178:181], v[152:155], v[156:159], v[178:181]
  v_mfma_f32_16x16x32_bf16 v[182:185], v[144:147], v[156:159], v[182:185]
  v_mfma_f32_16x16x32_bf16 v[186:189], v[148:151], v[156:159], v[186:189]
  s_mov_b64 exec, s[62:63]
  s_nop 0
  v_rcp_f32 v164, v180
  v_cmp_ngt_f32 s[22:23], s80, v180
  v_cmp_ngt_f32 vcc, s80, v164
  v_pk_mul_f32 v[182:183], v[182:183], v[164:165] op_sel_hi:[1,0]
  v_pk_mul_f32 v[184:185], v[184:185], v[164:165] op_sel_hi:[1,0]
  v_pk_mul_f32 v[178:179], v[178:179], v[164:165] op_sel_hi:[1,0]
  v_pk_mul_f32 v[186:187], v[186:187], v[164:165] op_sel_hi:[1,0]
  v_pk_mul_f32 v[188:189], v[188:189], v[164:165] op_sel_hi:[1,0]
  v_cvt_pk_f16_f32 v64, v178, v179
  s_or_b64 vcc, vcc, s[22:23]
  s_cbranch_scc1 fx_222
fk_223:
  ds_write_b32 v14, v64
  v_cvt_pk_f16_f32 v60, v182, v183
  v_cvt_pk_f16_f32 v61, v184, v185
  v_cvt_pk_f16_f32 v62, v186, v187
  v_cvt_pk_f16_f32 v63, v188, v189
  ds_write_b128 v13, v[60:63]
  s_mov_b64 exec, s[66:67]
  s_barrier
  ds_read_b128 v[166:169], v4 offset:13824
  ds_read_b128 v[170:173], v4 offset:14464
  ds_read_b128 v[174:177], v4 offset:15104
  ds_read_b128 v[178:181], v4 offset:15744
  s_waitcnt lgkmcnt(2)
  v_pk_add_f16 v166, v166, v170
  v_pk_add_f16 v167, v167, v171
  v_pk_add_f16 v168, v168, v172
  v_pk_add_f16 v169, v169, v173
  s_waitcnt lgkmcnt(1)
  v_pk_add_f16 v166, v166, v174
  v_pk_add_f16 v167, v167, v175
  v_pk_add_f16 v168, v168, v176
  v_pk_add_f16 v169, v169, v177
  s_waitcnt lgkmcnt(0)
  v_pk_add_f16 v166, v166, v178
  v_cmpx_o_f16 vcc, v166, v166
  v_pk_add_f16 v167, v167, v179
  v_pk_add_f16 v168, v168, v180
  v_pk_add_f16 v169, v169, v181
  v_and_or_b32 v166, v166, -2, s61
  buffer_store_dwordx4 v[166:169], v15, s[4:7], s60 offen sc1
  s_xor_b64 s[98:99], exec, s[66:67]
  s_mov_b64 exec, -1
  buffer_store_dwordx4 v[100:103], v26, s[16:19], s70 offen sc1
  buffer_store_dwordx2 v[92:93], v43, s[16:19], s70 offen sc1
  s_add_u32 s70, s70, 2097152
  s_xor_b32 s70, s70, 8192
  ds_read_b128 v[144:147], v18
  ds_read_b128 v[148:151], v18 offset:1024
  ds_read_b128 v[152:155], v19
  v_xor_b32 v18, 16384, v18
  v_xor_b32 v19, 16384, v19
  v_mov_b32 v88, 0
  v_mov_b32 v89, 0
  v_mov_b32 v90, 0
  v_mov_b32 v91, 0
  v_mov_b32 v92, 0
  v_mov_b32 v93, 0
  v_mov_b32 v94, 0
  v_mov_b32 v95, 0
  v_mov_b32 v96, 0
  v_mov_b32 v97, 0
  v_mov_b32 v98, 0
  v_mov_b32 v99, 0
  v_mov_b32 v100, 0
  v_mov_b32 v101, 0
  v_mov_b32 v102, 0
  v_mov_b32 v103, 0
  s_mov_b32 s81, 0
  s_waitcnt lgkmcnt(0)
  s_barrier
  s_cmp_lg_u64 s[98:99], 0
  s_cbranch_scc1 pf_224
pf_225:
  s_xor_b32 s74, s74, 16384
  s_add_u32 s73, s73, 2097152
  s_xor_b32 s73, s73, 8192
  s_add_u32 s79, s79, 2097152
  s_xor_b32 s79, s79, 8192
  s_add_u32 s21, s72, 524288
  s_xor_b32 s72, s72, s21
  s_lshr_b32 s72, s72, 8
  s_and_b32 s72, s72, 8192
  s_xor_b32 s72, s72, s21
  s_add_u32 s71, s73, 4096
  s_mov_b32 s91, 1024
  s_sub_u32 s21, s73, 0
  s_cmp_lt_u32 s21, 125829120
  s_cselect_b32 s71, s71, s79
  s_cselect_b32 s91, s91, 65536
  v_mov_b32 v166, s52
  s_add_u32 s22, s52, 5
  s_min_u32 s22, s22, 64
  v_cmp_gt_u32 vcc, s22, v42
  s_cbranch_vccz fv_227
  buffer_load_dword v42, v41, s[12:15], s76 offen sc1
fv_227:
  ds_write_b128 v190, v[28:31] offset:0
  ds_write_b128 v190, v[28:31] offset:1024
  ds_write_b128 v190, v[28:31] offset:2048
nt_226:
  s_barrier
  s_mov_b32 s58, s55
  s_add_u32 s52, s52, 1
  ds_write_b32 v13, v28
  ds_write_b32 v14, v28
  s_and_b32 s21, s52, 3
  s_mul_i32 s56, s21, 122880
  s_add_u32 s21, s52, 1
  s_and_b32 s21, s21, 3
  s_mul_i32 s55, s21, 122880
  s_add_u32 s55, s55, s75
  s_add_u32 s21, s52, 2
  s_and_b32 s21, s21, 3
  s_mul_i32 s57, s21, 122880
  s_add_u32 s21, s52, 3
  s_and_b32 s21, s21, 3
  s_mul_i32 s59, s21, 122880
  s_add_u32 s59, s59, s75
  s_bfe_u32 s61, s52, 0x10002
  s_and_b32 s21, s52, 3
  s_lshl_b32 s60, s21, 18
  s_mov_b32 s54, 0
  s_sleep 2
  s_nop 10
  s_waitcnt lgkmcnt(0)
  buffer_load_dwordx4 v[76:79], v190, s[8:11], s58 offen offset:0 sc1
  buffer_load_dwordx4 v[80:83], v190, s[8:11], s58 offen offset:1024 sc1
  buffer_load_dwordx4 v[84:87], v190, s[8:11], s58 offen offset:2048 sc1
  s_branch top_209
mr_210:
  s_mov_b64 exec, s[22:23]
  s_cbranch_execz ms_228
  buffer_load_dwordx4 v[76:79], v190, s[8:11], s58 offen offset:0 sc1
ms_228:
  s_mov_b64 exec, s[98:99]
  s_cbranch_execz ms_229
  buffer_load_dwordx4 v[80:83], v190, s[8:11], s58 offen offset:1024 sc1
ms_229:
  s_mov_b64 exec, s[100:101]
  s_cbranch_execz ms_230
  buffer_load_dwordx4 v[84:87], v190, s[8:11], s58 offen offset:2048 sc1
ms_230:
  s_add_u32 s54, s54, 1
  s_cmp_gt_u32 s54, 131072
  s_cbranch_scc1 end0
  s_waitcnt vmcnt(0)
  s_mov_b64 exec, s[22:23]
  ds_write_b128 v190, v[76:79] offset:0
  v_cmp_eq_u32 s[22:23], -1, v76
  s_mov_b64 exec, s[98:99]
  ds_write_b128 v190, v[80:83] offset:1024
  v_cmp_eq_u32 s[98:99], -1, v80
  s_mov_b64 exec, s[100:101]
  ds_write_b128 v190, v[84:87] offset:2048
  v_cmp_eq_u32 s[100:101], -1, v84
  s_mov_b64 exec, -1
  s_or_b64 vcc, s[22:23], s[98:99]
  s_or_b64 vcc, vcc, s[100:101]
  s_cbranch_scc1 mr_210
  s_branch mo_214
kw_215:
  s_mov_b32 s101, 0
wm_231:
  buffer_load_dword v42, v41, s[12:15], s76 offen sc1
  s_add_u32 s101, s101, 1
  s_cmp_gt_u32 s101, 131072
  s_cbranch_scc1 end0
  s_waitcnt vmcnt(0)
  v_cmp_gt_u32 vcc, s22, v42
  v_readfirstlane_b32 s100, v42
  s_nop 0
  s_cbranch_vccz wm_232
  s_sleep 1
  s_branch wm_231
wm_232:
  s_branch kv_216
mn_211:
  s_bitcmp1_b32 s81, 1
  s_cbranch_scc1 mk_212
  s_or_b32 s81, s81, 2
  s_nop 7
  v_mov_b32 v88, 0
  v_mov_b32 v89, 0
  v_mov_b32 v90, 0
  v_mov_b32 v91, 0
  v_mov_b32 v92, 0
  v_mov_b32 v93, 0
  v_mov_b32 v94, 0
  v_mov_b32 v95, 0
  v_mov_b32 v96, 0
  v_mov_b32 v97, 0
  v_mov_b32 v98, 0
  v_mov_b32 v99, 0
  v_mov_b32 v100, 0
  v_mov_b32 v101, 0
  v_mov_b32 v102, 0
  v_mov_b32 v103, 0
  s_cmp_eq_u32 s52, 0
  s_cbranch_scc1 mx_234
mx_233:
  buffer_load_dwordx4 v[76:79], v190, s[8:11], s58 offen offset:0 sc1
  buffer_load_dwordx4 v[80:83], v190, s[8:11], s58 offen offset:1024 sc1
  buffer_load_dwordx4 v[84:87], v190, s[8:11], s58 offen offset:2048 sc1
  s_add_u32 s54, s54, 1
  s_cmp_gt_u32 s54, 131072
  s_cbranch_scc1 end0
  s_waitcnt vmcnt(0)
  v_max3_u32 v27, v76, v77, v78
  v_max3_u32 v27, v27, v79, v80
  v_max3_u32 v27, v27, v81, v82
  v_max3_u32 v27, v27, v83, v84
  v_max3_u32 v27, v27, v85, v86
  v_max3_u32 v27, v27, v87, v87
  v_cmp_eq_u32 vcc, -1, v27
  s_nop 1
  s_cbranch_vccnz mx_233
  ds_write_b128 v190, v[76:79] offset:0
  ds_write_b128 v190, v[80:83] offset:1024
  ds_write_b128 v190, v[84:87] offset:2048
mx_234:
  s_waitcnt lgkmcnt(0)
  s_branch mo_214
sr_219:
  s_mov_b32 s54, 0
sr_235:
  s_mov_b64 exec, vcc
  buffer_load_dwordx4 v[124:127], v9, s[8:11], s56 offen sc1
  buffer_load_dwordx4 v[128:131], v9, s[8:11], s56 offen offset:1024 sc1
  buffer_load_dwordx4 v[132:135], v10, s[8:11], s56 offen sc1
  s_mov_b64 exec, -1
  s_add_u32 s54, s54, 1
  s_cmp_gt_u32 s54, 131072
  s_cbranch_scc1 end0
  s_waitcnt vmcnt(0)
  v_pk_add_f16 v164, v132, v133
  v_pk_add_f16 v165, v134, v135
  v_pk_add_f16 v120, v124, v126
  v_pk_add_f16 v122, v128, v130
  v_fma_mix_f32 v170, v164, 1.0, v165 op_sel:[0,0,0] op_sel_hi:[1,0,1]
  v_fma_mix_f32 v166, v120, 1.0, v122 op_sel:[0,0,0] op_sel_hi:[1,0,1]
  v_pk_add_f16 v121, v125, v127
  v_cmp_u_f32 vcc, v166, v170
  v_pk_add_f16 v123, v129, v131
  v_fma_mix_f32 v171, v164, 1.0, v165 op_sel:[1,0,1] op_sel_hi:[1,0,1]
  v_fma_mix_f32 v167, v120, 1.0, v122 op_sel:[1,0,1] op_sel_hi:[1,0,1]
  v_fma_mix_f32 v168, v121, 1.0, v123 op_sel:[0,0,0] op_sel_hi:[1,0,1]
  v_fma_mix_f32 v169, v121, 1.0, v123 op_sel:[1,0,1] op_sel_hi:[1,0,1]
  s_cbranch_vccz ex_221
  s_and_b32 s21, s54, 31
  s_cbranch_scc1 sr_235
  v_max3_u32 v27, v124, v126, v128
  v_max3_u32 v27, v27, v130, v132
  v_max3_u32 v27, v27, v133, v134
  v_max3_u32 v27, v27, v135, v135
  v_cmp_eq_u32 vcc, -1, v27
  s_nop 1
  s_cbranch_vccnz sr_235
ex_221:
  v_exp_f32 v176, v170
  v_exp_f32 v177, v171
  v_exp_f32 v172, v166
  v_cvt_pk_bf16_f32 v160, v176, v177
  v_exp_f32 v173, v167
  v_exp_f32 v174, v168
  v_mov_b32_dpp v161, v160 row_ror:8 row_mask:0xf bank_mask:0xf
  v_cvt_pk_bf16_f32 v156, v172, v173
  v_exp_f32 v175, v169
  v_mfma_f32_16x16x32_bf16 v[178:181], v[140:143], v[160:163], 0
  v_mov_b32_dpp v158, v156 row_ror:8 row_mask:0xf bank_mask:0xf
  v_cvt_pk_bf16_f32 v157, v174, v175
  v_mfma_f32_16x16x32_bf16 v[182:185], v[136:139], v[160:163], 0
  s_nop 0
  v_mov_b32_dpp v159, v157 row_ror:8 row_mask:0xf bank_mask:0xf
  v_mfma_f32_16x16x32_bf16 v[186:189], v[138:141], v[160:163], 0
  s_branch pv_220
fx_222:
  s_bitcmp1_b32 s81, 0
  s_cbranch_scc1 fk_223
  s_or_b32 s81, s81, 1
  s_mov_b64 exec, -1
  v_max3_f32 v164, v166, v167, v168
  v_max3_f32 v165, v169, v170, v171
  v_max_f32 v164, v164, v165
  s_nop 1
  v_max_f32_dpp v164, v164, v164 row_ror:8 row_mask:0xf bank_mask:0xf
  v_mov_b32 v165, v164
  s_nop 1
  v_permlane32_swap_b32 v164, v165
  v_max_f32 v164, v164, v165
  v_mov_b32 v165, v164
  s_nop 1
  v_permlane16_swap_b32 v164, v165
  v_max_f32 v164, v164, v165
  v_sub_f32 v166, v166, v164
  v_sub_f32 v167, v167, v164
  v_sub_f32 v168, v168, v164
  v_sub_f32 v169, v169, v164
  v_sub_f32 v170, v170, v164
  v_sub_f32 v171, v171, v164
  s_branch ex_221
pf_224:
  s_mov_b64 exec, s[66:67]
  ds_read_b128 v[166:169], v4 offset:13824
  ds_read_b128 v[170:173], v4 offset:14464
  ds_read_b128 v[174:177], v4 offset:15104
  ds_read_b128 v[178:181], v4 offset:15744
  s_waitcnt lgkmcnt(2)
  v_pk_add_f16 v166, v166, v170
  v_pk_add_f16 v167, v167, v171
  v_pk_add_f16 v168, v168, v172
  v_pk_add_f16 v169, v169, v173
  s_waitcnt lgkmcnt(1)
  v_pk_add_f16 v166, v166, v174
  v_pk_add_f16 v167, v167, v175
  v_pk_add_f16 v168, v168, v176
  v_pk_add_f16 v169, v169, v177
  s_waitcnt lgkmcnt(0)
  v_pk_add_f16 v166, v166, v178
  v_pk_add_f16 v167, v167, v179
  v_pk_add_f16 v168, v168, v180
  v_pk_add_f16 v169, v169, v181
  v_and_or_b32 v166, v166, -2, s61
  buffer_store_dwordx4 v[166:169], v15, s[4:7], s60 offen sc1
  s_mov_b64 exec, -1
  s_nop 1
  s_branch pf_225
last_213:
  v_permlane32_swap_b32 v88, v92
  v_permlane32_swap_b32 v89, v93
  v_permlane32_swap_b32 v90, v94
  v_permlane32_swap_b32 v91, v95
  v_pk_add_f32 v[88:89], v[88:89], v[92:93]
  v_pk_add_f32 v[90:91], v[90:91], v[94:95]
  v_cvt_pk_bf16_f32 v92, v88, v89
  v_cvt_pk_bf16_f32 v93, v90, v91
  v_min_u32 v92, -2, v92
  buffer_store_dwordx2 v[92:93], v43, s[16:19], s70 offen sc1
  v_smfmac_f32_16x16x64_bf16 v[96:99], v[56:59], a[16:23], v22
  v_smfmac_f32_16x16x64_bf16 v[100:103], v[56:59], a[96:103], v22
  v_smfmac_f32_16x16x64_bf16 v[96:99], v[60:63], a[24:31], v22
  v_smfmac_f32_16x16x64_bf16 v[96:99], v[64:67], a[32:39], v22
  v_smfmac_f32_16x16x64_bf16 v[96:99], v[68:71], a[40:47], v22
  v_smfmac_f32_16x16x64_bf16 v[96:99], v[72:75], a[48:55], v22
  v_smfmac_f32_16x16x64_bf16 v[96:99], v[76:79], a[56:63], v22
  v_smfmac_f32_16x16x64_bf16 v[96:99], v[80:83], a[64:71], v22
  v_smfmac_f32_16x16x64_bf16 v[96:99], v[84:87], a[72:79], v22
  v_smfmac_f32_16x16x64_bf16 v[100:103], v[60:63], a[104:111], v22
  v_smfmac_f32_16x16x64_bf16 v[100:103], v[64:67], a[112:119], v22
  v_smfmac_f32_16x16x64_bf16 v[100:103], v[68:71], a[120:127], v22
  v_smfmac_f32_16x16x64_bf16 v[100:103], v[72:75], a[128:135], v22
  v_smfmac_f32_16x16x64_bf16 v[100:103], v[76:79], a[136:143], v22
  v_smfmac_f32_16x16x64_bf16 v[100:103], v[80:83], a[144:151], v22
  v_smfmac_f32_16x16x64_bf16 v[100:103], v[84:87], a[152:159], v22
  s_nop 7
  v_permlane32_swap_b32 v96, v100
  v_permlane32_swap_b32 v97, v101
  v_permlane32_swap_b32 v98, v102
  v_permlane32_swap_b32 v99, v103
  v_pk_add_f32 v[96:97], v[96:97], v[100:101]
  v_pk_add_f32 v[98:99], v[98:99], v[102:103]
  v_cvt_pk_bf16_f32 v100, v96, v97
  v_cvt_pk_bf16_f32 v101, v98, v99
  s_nop 0
  v_permlane32_swap_b32 v100, v102
  v_permlane32_swap_b32 v101, v103
  v_min_u32 v100, -2, v100
  buffer_store_dwordx4 v[100:103], v26, s[16:19], s70 offen sc1
  s_waitcnt vmcnt(0)
  s_barrier
  v_mov_b32 v166, 64
  s_mov_b64 exec, 1
  buffer_store_dword v166, v23, s[12:15], s77 offen sc1
  s_mov_b64 exec, -1
  s_branch chain_done
chain_done:
end0:
  s_endpgm
gemm_side:
  s_bfe_u32 s23, s22, 0x20005
  s_add_u32 s22, s22, 31
  s_and_b32 s22, s22, 31
  s_lshl_b32 s21, s23, 3
  s_add_u32 s2, s21, s22
  s_add_u32 s3, s2, 72
  s_add_u32 s24, s2, 48
  s_add_u32 s2, s2, s21
  s_cmp_lt_u32 s22, 24
  s_cselect_b32 s3, s24, s3
  s_cmp_lt_u32 s22, 16
  s_cselect_b32 s3, s2, s3
  s_mov_b32 s2, s3
  s_cmp_ge_u32 s3, 64
  s_cbranch_scc1 not_kv
  s_load_dwordx2 s[4:5], s[0:1], 0
  s_load_dwordx2 s[6:7], s[0:1], 24
  s_load_dwordx2 s[36:37], s[0:1], 32
  s_load_dwordx2 s[38:39], s[0:1], 104
  s_and_b32 s43, s3, 1
  s_bfe_u32 s42, s3, 0x50001
  s_lshr_b32 s40, s42, 2
  s_waitcnt lgkmcnt(0)
  s_cmp_eq_u32 s43, 1
  s_cselect_b32 s6, s36, s6
  s_cselect_b32 s7, s37, s7
  s_mov_b32 s8, s4
  s_mov_b32 s9, s5
  s_mov_b32 s10, 2621440
  s_mov_b32 s11, 0x00020000
  s_mov_b32 s12, s6
  s_mov_b32 s13, s7
  s_mov_b32 s14, 7864320
  s_mov_b32 s15, 0x00020000
  s_mov_b32 s16, s38
  s_mov_b32 s17, s39
  s_mov_b32 s18, 218103808
  s_mov_b32 s19, 0x00020000
  s_add_u32 s72, s38, 173080576
  s_addc_u32 s73, s39, 0
  s_mov_b32 s74, 49152
  s_mov_b32 s75, 0x00020000
  s_mul_i32 s44, s42, 384
  s_mov_b32 s30, 0
  s_mov_b32 s25, 80768
  v_lshrrev_b32 v4, 3, v1
  v_and_b32 v5, 7, v1
  v_xor_b32 v5, v5, v4
  s_mul_i32 s21, s20, 16
  v_add_u32 v4, s21, v4
  v_mul_u32_u24 v4, 1280, v4
  v_lshl_add_u32 v10, v5, 4, v4
  s_mul_i32 s31, s20, 2048
  v_add_u32 v11, 10240, v10
  s_mul_i32 s22, s20, 4
  s_and_b32 s22, s22, 1
  s_lshl_b32 s22, s22, 2
  s_mov_b32 s21, 12288
  v_add_u32 v30, 0, v1
  v_mul_u32_u24 v31, 2731, v30
  v_lshrrev_b32 v31, 16, v31
  v_mul_u32_u24 v4, 24, v31
  v_sub_u32 v30, v30, v4
  v_and_b32 v4, 2, v31
  v_xor_b32 v30, v30, v4
  v_xor_b32 v30, s22, v30
  v_mul_lo_u32 v31, v31, s21
  v_lshl_add_u32 v4, v30, 4, v31
  v_xor_b32 v7, 64, v4
  v_add_u32 v30, 64, v1
  v_mul_u32_u24 v31, 2731, v30
  v_lshrrev_b32 v31, 16, v31
  v_mul_u32_u24 v5, 24, v31
  v_sub_u32 v30, v30, v5
  v_and_b32 v5, 2, v31
  v_xor_b32 v30, v30, v5
  v_xor_b32 v30, s22, v30
  v_mul_lo_u32 v31, v31, s21
  v_lshl_add_u32 v5, v30, 4, v31
  v_xor_b32 v8, 64, v5
  v_add_u32 v30, 128, v1
  v_mul_u32_u24 v31, 2731, v30
  v_lshrrev_b32 v31, 16, v31
  v_mul_u32_u24 v6, 24, v31
  v_sub_u32 v30, v30, v6
  v_and_b32 v6, 2, v31
  v_xor_b32 v30, v30, v6
  v_xor_b32 v30, s22, v30
  v_mul_lo_u32 v31, v31, s21
  v_lshl_add_u32 v6, v30, 4, v31
  v_xor_b32 v9, 64, v6
  s_mul_i32 s21, s20, 393216
  s_add_u32 s21, s21, 0
  s_add_u32 s21, s21, s44
  s_mul_i32 s22, s20, 12288
  s_add_u32 s22, s22, 0
  s_add_u32 m0, s22, 0
  s_nop 0
  buffer_load_dwordx4 v4, s[12:15], s21 offen lds
  s_add_u32 m0, s22, 1024
  s_nop 0
  buffer_load_dwordx4 v5, s[12:15], s21 offen lds
  s_add_u32 m0, s22, 2048
  s_nop 0
  buffer_load_dwordx4 v6, s[12:15], s21 offen lds
  s_mul_i32 s21, s20, 393216
  s_add_u32 s21, s21, 98304
  s_add_u32 s21, s21, s44
  s_mul_i32 s22, s20, 12288
  s_add_u32 s22, s22, 3072
  s_add_u32 m0, s22, 0
  s_nop 0
  buffer_load_dwordx4 v7, s[12:15], s21 offen lds
  s_add_u32 m0, s22, 1024
  s_nop 0
  buffer_load_dwordx4 v8, s[12:15], s21 offen lds
  s_add_u32 m0, s22, 2048
  s_nop 0
  buffer_load_dwordx4 v9, s[12:15], s21 offen lds
  s_mul_i32 s21, s20, 393216
  s_add_u32 s21, s21, 196608
  s_add_u32 s21, s21, s44
  s_mul_i32 s22, s20, 12288
  s_add_u32 s22, s22, 6144
  s_add_u32 m0, s22, 0
  s_nop 0
  buffer_load_dwordx4 v4, s[12:15], s21 offen lds
  s_add_u32 m0, s22, 1024
  s_nop 0
  buffer_load_dwordx4 v5, s[12:15], s21 offen lds
  s_add_u32 m0, s22, 2048
  s_nop 0
  buffer_load_dwordx4 v6, s[12:15], s21 offen lds
  s_mul_i32 s21, s20, 393216
  s_add_u32 s21, s21, 294912
  s_add_u32 s21, s21, s44
  s_mul_i32 s22, s20, 12288
  s_add_u32 s22, s22, 9216
  s_add_u32 m0, s22, 0
  s_nop 0
  buffer_load_dwordx4 v7, s[12:15], s21 offen lds
  s_add_u32 m0, s22, 1024
  s_nop 0
  buffer_load_dwordx4 v8, s[12:15], s21 offen lds
  s_add_u32 m0, s22, 2048
  s_nop 0
  buffer_load_dwordx4 v9, s[12:15], s21 offen lds
  s_add_u32 m0, s31, 98304
  s_nop 0
  buffer_load_dwordx4 v10, s[8:11], s30 offen lds
  s_add_u32 m0, s31, 99328
  s_nop 0
  buffer_load_dwordx4 v11, s[8:11], s30 offen lds
  s_add_u32 s30, s30, 128
  s_add_u32 m0, s31, 106496
  s_nop 0
  buffer_load_dwordx4 v10, s[8:11], s30 offen lds
  s_add_u32 m0, s31, 107520
  s_nop 0
  buffer_load_dwordx4 v11, s[8:11], s30 offen lds
  s_add_u32 s30, s30, 128
  s_add_u32 m0, s31, 114688
  s_nop 0
  buffer_load_dwordx4 v10, s[8:11], s30 offen lds
  s_add_u32 m0, s31, 115712
  s_nop 0
  buffer_load_dwordx4 v11, s[8:11], s30 offen lds
  s_add_u32 s30, s30, 128
  s_add_u32 m0, s31, 122880
  s_nop 0
  buffer_load_dwordx4 v10, s[8:11], s30 offen lds
  s_add_u32 m0, s31, 123904
  s_nop 0
  buffer_load_dwordx4 v11, s[8:11], s30 offen lds
  s_add_u32 s30, s30, 128
  s_add_u32 m0, s31, 131072
  s_nop 0
  buffer_load_dwordx4 v10, s[8:11], s30 offen lds
  s_add_u32 m0, s31, 132096
  s_nop 0
  buffer_load_dwordx4 v11, s[8:11], s30 offen lds
  s_add_u32 s30, s30, 128
  s_add_u32 m0, s31, 139264
  s_nop 0
  buffer_load_dwordx4 v10, s[8:11], s30 offen lds
  s_add_u32 m0, s31, 140288
  s_nop 0
  buffer_load_dwordx4 v11, s[8:11], s30 offen lds
  s_add_u32 s30, s30, 128
  s_add_u32 m0, s31, 147456
  s_nop 0
  buffer_load_dwordx4 v10, s[8:11], s30 offen lds
  s_add_u32 m0, s31, 148480
  s_nop 0
  buffer_load_dwordx4 v11, s[8:11], s30 offen lds
  s_add_u32 s30, s30, 128
  s_add_u32 m0, s31, 155648
  s_nop 0
  buffer_load_dwordx4 v10, s[8:11], s30 offen lds
  s_add_u32 m0, s31, 156672
  s_nop 0
  buffer_load_dwordx4 v11, s[8:11], s30 offen lds
  s_add_u32 s30, s30, 128
  s_mul_i32 s21, s20, 393216
  s_add_u32 s21, s21, 1572864
  s_add_u32 s21, s21, s44
  s_mul_i32 s22, s20, 12288
  s_add_u32 s22, s22, 49152
  s_add_u32 m0, s22, 0
  s_nop 0
  buffer_load_dwordx4 v4, s[12:15], s21 offen lds
  s_add_u32 m0, s22, 1024
  s_nop 0
  buffer_load_dwordx4 v5, s[12:15], s21 offen lds
  s_add_u32 m0, s22, 2048
  s_nop 0
  buffer_load_dwordx4 v6, s[12:15], s21 offen lds
  s_mul_i32 s21, s20, 393216
  s_add_u32 s21, s21, 1671168
  s_add_u32 s21, s21, s44
  s_mul_i32 s22, s20, 12288
  s_add_u32 s22, s22, 52224
  s_add_u32 m0, s22, 0
  s_nop 0
  buffer_load_dwordx4 v7, s[12:15], s21 offen lds
  s_add_u32 m0, s22, 1024
  s_nop 0
  buffer_load_dwordx4 v8, s[12:15], s21 offen lds
  s_add_u32 m0, s22, 2048
  s_nop 0
  buffer_load_dwordx4 v9, s[12:15], s21 offen lds
  s_mul_i32 s21, s20, 393216
  s_add_u32 s21, s21, 1769472
  s_add_u32 s21, s21, s44
  s_mul_i32 s22, s20, 12288
  s_add_u32 s22, s22, 55296
  s_add_u32 m0, s22, 0
  s_nop 0
  buffer_load_dwordx4 v4, s[12:15], s21 offen lds
  s_add_u32 m0, s22, 1024
  s_nop 0
  buffer_load_dwordx4 v5, s[12:15], s21 offen lds
  s_add_u32 m0, s22, 2048
  s_nop 0
  buffer_load_dwordx4 v6, s[12:15], s21 offen lds
  s_mul_i32 s21, s20, 393216
  s_add_u32 s21, s21, 1867776
  s_add_u32 s21, s21, s44
  s_mul_i32 s22, s20, 12288
  s_add_u32 s22, s22, 58368
  s_add_u32 m0, s22, 0
  s_nop 0
  buffer_load_dwordx4 v7, s[12:15], s21 offen lds
  s_add_u32 m0, s22, 1024
  s_nop 0
  buffer_load_dwordx4 v8, s[12:15], s21 offen lds
  s_add_u32 m0, s22, 2048
  s_nop 0
  buffer_load_dwordx4 v9, s[12:15], s21 offen lds
  v_lshrrev_b32 v30, 2, v2
  v_lshl_add_u32 v30, v3, 3, v30
  v_mul_u32_u24 v30, 384, v30
  v_and_b32 v31, 3, v2
  v_lshl_add_u32 v30, v31, 3, v30
  v_lshrrev_b32 v31, 3, v1
  v_and_b32 v31, 3, v31
  v_lshlrev_b32 v31, 5, v31
  s_mul_i32 s21, s20, 96
  s_add_u32 s21, s21, 0
  v_xor_b32 v184, s21, v31
  v_add_u32 v184, v184, v30
  v_add_u32 v187, 49152, v184
  s_mul_i32 s21, s20, 96
  s_add_u32 s21, s21, 32
  v_xor_b32 v185, s21, v31
  v_add_u32 v185, v185, v30
  v_add_u32 v188, 49152, v185
  s_mul_i32 s21, s20, 96
  s_add_u32 s21, s21, 64
  v_xor_b32 v186, s21, v31
  v_add_u32 v186, v186, v30
  v_add_u32 v189, 49152, v186
  s_waitcnt vmcnt(12)
  s_barrier
  ds_read_b64_tr_b16 a[0:1], v184 offset:0
  ds_read_b64_tr_b16 a[2:3], v184 offset:1536
  ds_read_b64_tr_b16 a[4:5], v185 offset:0
  ds_read_b64_tr_b16 a[6:7], v185 offset:1536
  ds_read_b64_tr_b16 a[8:9], v186 offset:0
  ds_read_b64_tr_b16 a[10:11], v186 offset:1536
  ds_read_b64_tr_b16 a[12:13], v184 offset:12288
  ds_read_b64_tr_b16 a[14:15], v184 offset:13824
  ds_read_b64_tr_b16 a[16:17], v185 offset:12288
  ds_read_b64_tr_b16 a[18:19], v185 offset:13824
  ds_read_b64_tr_b16 a[20:21], v186 offset:12288
  ds_read_b64_tr_b16 a[22:23], v186 offset:13824
  ds_read_b64_tr_b16 a[24:25], v184 offset:24576
  ds_read_b64_tr_b16 a[26:27], v184 offset:26112
  ds_read_b64_tr_b16 a[28:29], v185 offset:24576
  ds_read_b64_tr_b16 a[30:31], v185 offset:26112
  ds_read_b64_tr_b16 a[32:33], v186 offset:24576
  ds_read_b64_tr_b16 a[34:35], v186 offset:26112
  ds_read_b64_tr_b16 a[36:37], v184 offset:36864
  ds_read_b64_tr_b16 a[38:39], v184 offset:38400
  ds_read_b64_tr_b16 a[40:41], v185 offset:36864
  ds_read_b64_tr_b16 a[42:43], v185 offset:38400
  ds_read_b64_tr_b16 a[44:45], v186 offset:36864
  ds_read_b64_tr_b16 a[46:47], v186 offset:38400
  s_waitcnt lgkmcnt(0)
  s_barrier
  s_mul_i32 s21, s20, 393216
  s_add_u32 s21, s21, 3145728
  s_add_u32 s21, s21, s44
  s_mul_i32 s22, s20, 12288
  s_add_u32 s22, s22, 0
  s_add_u32 m0, s22, 0
  s_nop 0
  buffer_load_dwordx4 v4, s[12:15], s21 offen lds
  s_add_u32 m0, s22, 1024
  s_nop 0
  buffer_load_dwordx4 v5, s[12:15], s21 offen lds
  s_add_u32 m0, s22, 2048
  s_nop 0
  buffer_load_dwordx4 v6, s[12:15], s21 offen lds
  s_mul_i32 s21, s20, 393216
  s_add_u32 s21, s21, 3244032
  s_add_u32 s21, s21, s44
  s_mul_i32 s22, s20, 12288
  s_add_u32 s22, s22, 3072
  s_add_u32 m0, s22, 0
  s_nop 0
  buffer_load_dwordx4 v7, s[12:15], s21 offen lds
  s_add_u32 m0, s22, 1024
  s_nop 0
  buffer_load_dwordx4 v8, s[12:15], s21 offen lds
  s_add_u32 m0, s22, 2048
  s_nop 0
  buffer_load_dwordx4 v9, s[12:15], s21 offen lds
  s_mul_i32 s21, s20, 393216
  s_add_u32 s21, s21, 3342336
  s_add_u32 s21, s21, s44
  s_mul_i32 s22, s20, 12288
  s_add_u32 s22, s22, 6144
  s_add_u32 m0, s22, 0
  s_nop 0
  buffer_load_dwordx4 v4, s[12:15], s21 offen lds
  s_add_u32 m0, s22, 1024
  s_nop 0
  buffer_load_dwordx4 v5, s[12:15], s21 offen lds
  s_add_u32 m0, s22, 2048
  s_nop 0
  buffer_load_dwordx4 v6, s[12:15], s21 offen lds
  s_mul_i32 s21, s20, 393216
  s_add_u32 s21, s21, 3440640
  s_add_u32 s21, s21, s44
  s_mul_i32 s22, s20, 12288
  s_add_u32 s22, s22, 9216
  s_add_u32 m0, s22, 0
  s_nop 0
  buffer_load_dwordx4 v7, s[12:15], s21 offen lds
  s_add_u32 m0, s22, 1024
  s_nop 0
  buffer_load_dwordx4 v8, s[12:15], s21 offen lds
  s_add_u32 m0, s22, 2048
  s_nop 0
  buffer_load_dwordx4 v9, s[12:15], s21 offen lds
  s_waitcnt vmcnt(12)
  s_barrier
  ds_read_b64_tr_b16 a[48:49], v187 offset:0
  ds_read_b64_tr_b16 a[50:51], v187 offset:1536
  ds_read_b64_tr_b16 a[52:53], v188 offset:0
  ds_read_b64_tr_b16 a[54:55], v188 offset:1536
  ds_read_b64_tr_b16 a[56:57], v189 offset:0
  ds_read_b64_tr_b16 a[58:59], v189 offset:1536
  ds_read_b64_tr_b16 a[60:61], v187 offset:12288
  ds_read_b64_tr_b16 a[62:63], v187 offset:13824
  ds_read_b64_tr_b16 a[64:65], v188 offset:12288
  ds_read_b64_tr_b16 a[66:67], v188 offset:13824
  ds_read_b64_tr_b16 a[68:69], v189 offset:12288
  ds_read_b64_tr_b16 a[70:71], v189 offset:13824
  ds_read_b64_tr_b16 a[72:73], v187 offset:24576
  ds_read_b64_tr_b16 a[74:75], v187 offset:26112
  ds_read_b64_tr_b16 a[76:77], v188 offset:24576
  ds_read_b64_tr_b16 a[78:79], v188 offset:26112
  ds_read_b64_tr_b16 a[80:81], v189 offset:24576
  ds_read_b64_tr_b16 a[82:83], v189 offset:26112
  ds_read_b64_tr_b16 a[84:85], v187 offset:36864
  ds_read_b64_tr_b16 a[86:87], v187 offset:38400
  ds_read_b64_tr_b16 a[88:89], v188 offset:36864
  ds_read_b64_tr_b16 a[90:91], v188 offset:38400
  ds_read_b64_tr_b16 a[92:93], v189 offset:36864
  ds_read_b64_tr_b16 a[94:95], v189 offset:38400
  s_waitcnt lgkmcnt(0)
  s_barrier
  s_mul_i32 s21, s20, 393216
  s_add_u32 s21, s21, 4718592
  s_add_u32 s21, s21, s44
  s_mul_i32 s22, s20, 12288
  s_add_u32 s22, s22, 49152
  s_add_u32 m0, s22, 0
  s_nop 0
  buffer_load_dwordx4 v4, s[12:15], s21 offen lds
  s_add_u32 m0, s22, 1024
  s_nop 0
  buffer_load_dwordx4 v5, s[12:15], s21 offen lds
  s_add_u32 m0, s22, 2048
  s_nop 0
  buffer_load_dwordx4 v6, s[12:15], s21 offen lds
  s_mul_i32 s21, s20, 393216
  s_add_u32 s21, s21, 4816896
  s_add_u32 s21, s21, s44
  s_mul_i32 s22, s20, 12288
  s_add_u32 s22, s22, 52224
  s_add_u32 m0, s22, 0
  s_nop 0
  buffer_load_dwordx4 v7, s[12:15], s21 offen lds
  s_add_u32 m0, s22, 1024
  s_nop 0
  buffer_load_dwordx4 v8, s[12:15], s21 offen lds
  s_add_u32 m0, s22, 2048
  s_nop 0
  buffer_load_dwordx4 v9, s[12:15], s21 offen lds
  s_mul_i32 s21, s20, 393216
  s_add_u32 s21, s21, 4915200
  s_add_u32 s21, s21, s44
  s_mul_i32 s22, s20, 12288
  s_add_u32 s22, s22, 55296
  s_add_u32 m0, s22, 0
  s_nop 0
  buffer_load_dwordx4 v4, s[12:15], s21 offen lds
  s_add_u32 m0, s22, 1024
  s_nop 0
  buffer_load_dwordx4 v5, s[12:15], s21 offen lds
  s_add_u32 m0, s22, 2048
  s_nop 0
  buffer_load_dwordx4 v6, s[12:15], s21 offen lds
  s_mul_i32 s21, s20, 393216
  s_add_u32 s21, s21, 5013504
  s_add_u32 s21, s21, s44
  s_mul_i32 s22, s20, 12288
  s_add_u32 s22, s22, 58368
  s_add_u32 m0, s22, 0
  s_nop 0
  buffer_load_dwordx4 v7, s[12:15], s21 offen lds
  s_add_u32 m0, s22, 1024
  s_nop 0
  buffer_load_dwordx4 v8, s[12:15], s21 offen lds
  s_add_u32 m0, s22, 2048
  s_nop 0
  buffer_load_dwordx4 v9, s[12:15], s21 offen lds
  v_mov_b32 v29, 76
  buffer_load_dword v29, v29, s[32:35], 0 offen sc1
  s_waitcnt vmcnt(12)
  s_barrier
  ds_read_b64_tr_b16 a[96:97], v184 offset:0
  ds_read_b64_tr_b16 a[98:99], v184 offset:1536
  ds_read_b64_tr_b16 a[100:101], v185 offset:0
  ds_read_b64_tr_b16 a[102:103], v185 offset:1536
  ds_read_b64_tr_b16 a[104:105], v186 offset:0
  ds_read_b64_tr_b16 a[106:107], v186 offset:1536
  ds_read_b64_tr_b16 a[108:109], v184 offset:12288
  ds_read_b64_tr_b16 a[110:111], v184 offset:13824
  ds_read_b64_tr_b16 a[112:113], v185 offset:12288
  ds_read_b64_tr_b16 a[114:115], v185 offset:13824
  ds_read_b64_tr_b16 a[116:117], v186 offset:12288
  ds_read_b64_tr_b16 a[118:119], v186 offset:13824
  ds_read_b64_tr_b16 a[120:121], v184 offset:24576
  ds_read_b64_tr_b16 a[122:123], v184 offset:26112
  ds_read_b64_tr_b16 a[124:125], v185 offset:24576
  ds_read_b64_tr_b16 a[126:127], v185 offset:26112
  ds_read_b64_tr_b16 a[128:129], v186 offset:24576
  ds_read_b64_tr_b16 a[130:131], v186 offset:26112
  ds_read_b64_tr_b16 a[132:133], v184 offset:36864
  ds_read_b64_tr_b16 a[134:135], v184 offset:38400
  ds_read_b64_tr_b16 a[136:137], v185 offset:36864
  ds_read_b64_tr_b16 a[138:139], v185 offset:38400
  ds_read_b64_tr_b16 a[140:141], v186 offset:36864
  ds_read_b64_tr_b16 a[142:143], v186 offset:38400
  s_waitcnt lgkmcnt(0)
  s_barrier
  s_mul_i32 s21, s20, 393216
  s_add_u32 s21, s21, 6291456
  s_add_u32 s21, s21, s44
  s_mul_i32 s22, s20, 12288
  s_add_u32 s22, s22, 0
  s_add_u32 m0, s22, 0
  s_nop 0
  buffer_load_dwordx4 v4, s[12:15], s21 offen lds
  s_add_u32 m0, s22, 1024
  s_nop 0
  buffer_load_dwordx4 v5, s[12:15], s21 offen lds
  s_add_u32 m0, s22, 2048
  s_nop 0
  buffer_load_dwordx4 v6, s[12:15], s21 offen lds
  s_mul_i32 s21, s20, 393216
  s_add_u32 s21, s21, 6389760
  s_add_u32 s21, s21, s44
  s_mul_i32 s22, s20, 12288
  s_add_u32 s22, s22, 3072
  s_add_u32 m0, s22, 0
  s_nop 0
  buffer_load_dwordx4 v7, s[12:15], s21 offen lds
  s_add_u32 m0, s22, 1024
  s_nop 0
  buffer_load_dwordx4 v8, s[12:15], s21 offen lds
  s_add_u32 m0, s22, 2048
  s_nop 0
  buffer_load_dwordx4 v9, s[12:15], s21 offen lds
  s_mul_i32 s21, s20, 393216
  s_add_u32 s21, s21, 6488064
  s_add_u32 s21, s21, s44
  s_mul_i32 s22, s20, 12288
  s_add_u32 s22, s22, 6144
  s_add_u32 m0, s22, 0
  s_nop 0
  buffer_load_dwordx4 v4, s[12:15], s21 offen lds
  s_add_u32 m0, s22, 1024
  s_nop 0
  buffer_load_dwordx4 v5, s[12:15], s21 offen lds
  s_add_u32 m0, s22, 2048
  s_nop 0
  buffer_load_dwordx4 v6, s[12:15], s21 offen lds
  s_mul_i32 s21, s20, 393216
  s_add_u32 s21, s21, 6586368
  s_add_u32 s21, s21, s44
  s_mul_i32 s22, s20, 12288
  s_add_u32 s22, s22, 9216
  s_add_u32 m0, s22, 0
  s_nop 0
  buffer_load_dwordx4 v7, s[12:15], s21 offen lds
  s_add_u32 m0, s22, 1024
  s_nop 0
  buffer_load_dwordx4 v8, s[12:15], s21 offen lds
  s_add_u32 m0, s22, 2048
  s_nop 0
  buffer_load_dwordx4 v9, s[12:15], s21 offen lds
  s_waitcnt vmcnt(12)
  s_barrier
  ds_read_b64_tr_b16 a[144:145], v187 offset:0
  ds_read_b64_tr_b16 a[146:147], v187 offset:1536
  ds_read_b64_tr_b16 a[148:149], v188 offset:0
  ds_read_b64_tr_b16 a[150:151], v188 offset:1536
  ds_read_b64_tr_b16 a[152:153], v189 offset:0
  ds_read_b64_tr_b16 a[154:155], v189 offset:1536
  ds_read_b64_tr_b16 a[156:157], v187 offset:12288
  ds_read_b64_tr_b16 a[158:159], v187 offset:13824
  ds_read_b64_tr_b16 a[160:161], v188 offset:12288
  ds_read_b64_tr_b16 a[162:163], v188 offset:13824
  ds_read_b64_tr_b16 a[164:165], v189 offset:12288
  ds_read_b64_tr_b16 a[166:167], v189 offset:13824
  ds_read_b64_tr_b16 a[168:169], v187 offset:24576
  ds_read_b64_tr_b16 a[170:171], v187 offset:26112
  ds_read_b64_tr_b16 a[172:173], v188 offset:24576
  ds_read_b64_tr_b16 a[174:175], v188 offset:26112
  ds_read_b64_tr_b16 a[176:177], v189 offset:24576
  ds_read_b64_tr_b16 a[178:179], v189 offset:26112
  ds_read_b64_tr_b16 a[180:181], v187 offset:36864
  ds_read_b64_tr_b16 a[182:183], v187 offset:38400
  ds_read_b64_tr_b16 a[184:185], v188 offset:36864
  ds_read_b64_tr_b16 a[186:187], v188 offset:38400
  ds_read_b64_tr_b16 a[188:189], v189 offset:36864
  ds_read_b64_tr_b16 a[190:191], v189 offset:38400
  s_waitcnt lgkmcnt(0)
  s_barrier
  s_waitcnt vmcnt(0)
  s_barrier
  ds_read_b64_tr_b16 a[192:193], v184 offset:0
  ds_read_b64_tr_b16 a[194:195], v184 offset:1536
  ds_read_b64_tr_b16 a[196:197], v185 offset:0
  ds_read_b64_tr_b16 a[198:199], v185 offset:1536
  ds_read_b64_tr_b16 a[200:201], v186 offset:0
  ds_read_b64_tr_b16 a[202:203], v186 offset:1536
  ds_read_b64_tr_b16 a[204:205], v184 offset:12288
  ds_read_b64_tr_b16 a[206:207], v184 offset:13824
  ds_read_b64_tr_b16 a[208:209], v185 offset:12288
  ds_read_b64_tr_b16 a[210:211], v185 offset:13824
  ds_read_b64_tr_b16 a[212:213], v186 offset:12288
  ds_read_b64_tr_b16 a[214:215], v186 offset:13824
  ds_read_b64_tr_b16 a[216:217], v184 offset:24576
  ds_read_b64_tr_b16 a[218:219], v184 offset:26112
  ds_read_b64_tr_b16 a[220:221], v185 offset:24576
  ds_read_b64_tr_b16 a[222:223], v185 offset:26112
  ds_read_b64_tr_b16 a[224:225], v186 offset:24576
  ds_read_b64_tr_b16 a[226:227], v186 offset:26112
  ds_read_b64_tr_b16 a[228:229], v184 offset:36864
  ds_read_b64_tr_b16 a[230:231], v184 offset:38400
  ds_read_b64_tr_b16 a[232:233], v185 offset:36864
  ds_read_b64_tr_b16 a[234:235], v185 offset:38400
  ds_read_b64_tr_b16 a[236:237], v186 offset:36864
  ds_read_b64_tr_b16 a[238:239], v186 offset:38400
  s_waitcnt lgkmcnt(0)
  s_barrier
  v_and_b32 v6, 7, v2
  v_add_u32 v4, 0, v3
  v_xor_b32 v4, v4, v6
  v_lshlrev_b32 v4, 4, v4
  v_lshl_add_u32 v14, v2, 7, v4
  v_add_u32 v16, 65536, v14
  v_add_u32 v18, 131072, v14
  v_add_u32 v4, 4, v3
  v_xor_b32 v4, v4, v6
  v_lshlrev_b32 v4, 4, v4
  v_lshl_add_u32 v15, v2, 7, v4
  v_add_u32 v17, 65536, v15
  v_add_u32 v19, 131072, v15
  v_lshlrev_b32 v26, 4, v1
  v_mov_b32 v28, 1
  v_mov_b32 v4, 0x40000000
  v_cmp_eq_u32 vcc, 0, v0
  s_nop 1
  v_cndmask_b32 v27, v4, 0, vcc
  s_mov_b32 s26, 6
  s_lshl_b32 s27, s42, 2
  s_add_u32 s27, s27, s20
  s_lshl_b32 s27, s27, 14
  s_lshl_b32 s21, s43, 13
  s_xor_b32 s27, s27, s21
  v_readfirstlane_b32 s100, v29
  s_cmp_lg_u32 s100, 0
  s_cbranch_scc1 kvz_237
  s_mov_b32 s21, 76
  v_mov_b32 v4, 0
  s_mov_b32 s101, 0
wf_238:
  buffer_load_dword v5, v4, s[32:35], s21 offen sc1
  s_add_u32 s101, s101, 1
  s_cmp_gt_u32 s101, 131072
  s_cbranch_scc1 main_end
  s_waitcnt vmcnt(0)
  v_readfirstlane_b32 s100, v5
  s_cmp_ge_u32 s100, 1
  s_cbranch_scc1 wf_239
  s_sleep 8
  s_branch wf_238
wf_239:
kvz_237:
  s_sub_u32 s80, s100, 1
  s_lshl_b32 s80, s80, 13
  s_xor_b32 s27, s27, s80
  s_lshl_b32 s60, s40, 7
  s_add_u32 s60, s60, 28672
  s_xor_b32 s60, s60, s80
  s_mov_b32 s48, 0x40000000
  s_mov_b32 s61, 0x40000000
  s_waitcnt vmcnt(14)
  s_barrier
  ds_read_b128 v[160:163], v16 offset:32768
  ds_read_b128 v[164:167], v16 offset:34816
  ds_read_b128 v[168:171], v16 offset:36864
  ds_read_b128 v[172:175], v16 offset:38912
  s_waitcnt lgkmcnt(3)
  .p2align 3
kvm_240:
  v_mfma_f32_16x16x32_bf16 v[64:67], a[0:3], v[160:163], 0
  s_xor_b32 s29, s48, 0
  ds_read_b128 v[176:179], v17 offset:32768
  v_cvt_pk_bf16_f32 v204, v88, v89
  v_mfma_f32_16x16x32_bf16 v[68:71], a[4:7], v[160:163], 0
  v_cvt_pk_bf16_f32 v205, v90, v91
  v_cvt_pk_bf16_f32 v206, v92, v93
  v_mfma_f32_16x16x32_bf16 v[72:75], a[8:11], v[160:163], 0
  s_waitcnt lgkmcnt(3)
  v_cvt_pk_bf16_f32 v207, v94, v95
  v_cvt_pk_bf16_f32 v212, v96, v97
  v_mfma_f32_16x16x32_bf16 v[76:79], a[0:3], v[164:167], 0
  ds_read_b128 v[180:183], v17 offset:34816
  v_cvt_pk_bf16_f32 v213, v98, v99
  v_mfma_f32_16x16x32_bf16 v[80:83], a[4:7], v[164:167], 0
  v_cvt_pk_bf16_f32 v208, v100, v101
  v_cvt_pk_bf16_f32 v209, v102, v103
  v_mfma_f32_16x16x32_bf16 v[84:87], a[8:11], v[164:167], 0
  s_waitcnt lgkmcnt(3)
  v_cvt_pk_bf16_f32 v210, v104, v105
  v_cvt_pk_bf16_f32 v211, v106, v107
  v_mfma_f32_16x16x32_bf16 v[88:91], a[0:3], v[168:171], 0
  ds_read_b128 v[184:187], v17 offset:36864
  v_cvt_pk_bf16_f32 v214, v108, v109
  v_mfma_f32_16x16x32_bf16 v[92:95], a[4:7], v[168:171], 0
  s_add_u32 m0, s31, 81920
  v_cvt_pk_bf16_f32 v215, v110, v111
  buffer_store_dwordx4 v[192:195], v26, s[16:19], s29 offen offset:0 sc1
  v_mfma_f32_16x16x32_bf16 v[96:99], a[8:11], v[168:171], 0
  s_waitcnt lgkmcnt(3)
  buffer_load_dwordx4 v10, s[8:11], s30 offen lds
  v_mfma_f32_16x16x32_bf16 v[100:103], a[0:3], v[172:175], 0
  ds_read_b128 v[188:191], v17 offset:38912
  v_mfma_f32_16x16x32_bf16 v[104:107], a[4:7], v[172:175], 0
  v_mfma_f32_16x16x32_bf16 v[108:111], a[8:11], v[172:175], 0
  s_waitcnt lgkmcnt(3)
  buffer_store_dwordx4 v[196:199], v26, s[16:19], s29 offen offset:1024 sc1
  v_mfma_f32_16x16x32_bf16 v[64:67], a[12:15], v[176:179], v[64:67]
  s_waitcnt vmcnt(15)
  s_barrier
  ds_read_b128 v[160:163], v16 offset:40960
  v_mfma_f32_16x16x32_bf16 v[68:71], a[16:19], v[176:179], v[68:71]
  s_add_u32 m0, s31, 82944
  v_mfma_f32_16x16x32_bf16 v[72:75], a[20:23], v[176:179], v[72:75]
  s_waitcnt lgkmcnt(3)
  buffer_load_dwordx4 v11, s[8:11], s30 offen lds
  v_mfma_f32_16x16x32_bf16 v[76:79], a[12:15], v[180:183], v[76:79]
  s_add_u32 s30, s30, 128
  ds_read_b128 v[164:167], v16 offset:43008
  buffer_store_dwordx4 v[200:203], v26, s[16:19], s29 offen offset:2048 sc1
  v_mfma_f32_16x16x32_bf16 v[80:83], a[16:19], v[180:183], v[80:83]
  v_mfma_f32_16x16x32_bf16 v[84:87], a[20:23], v[180:183], v[84:87]
  s_waitcnt lgkmcnt(3)
  v_mfma_f32_16x16x32_bf16 v[88:91], a[12:15], v[184:187], v[88:91]
  s_xor_b32 s29, s48, 2105344
  ds_read_b128 v[168:171], v16 offset:45056
  v_mfma_f32_16x16x32_bf16 v[92:95], a[16:19], v[184:187], v[92:95]
  buffer_store_dwordx4 v[204:207], v26, s[16:19], s29 offen offset:0 sc1
  v_mfma_f32_16x16x32_bf16 v[96:99], a[20:23], v[184:187], v[96:99]
  s_waitcnt lgkmcnt(3)
  v_mfma_f32_16x16x32_bf16 v[100:103], a[12:15], v[188:191], v[100:103]
  ds_read_b128 v[172:175], v16 offset:47104
  v_mfma_f32_16x16x32_bf16 v[104:107], a[16:19], v[188:191], v[104:107]
  v_mfma_f32_16x16x32_bf16 v[108:111], a[20:23], v[188:191], v[108:111]
  s_waitcnt lgkmcnt(3)
  buffer_store_dwordx4 v[208:211], v26, s[16:19], s29 offen offset:1024 sc1
  v_mfma_f32_16x16x32_bf16 v[64:67], a[24:27], v[160:163], v[64:67]
  ds_read_b128 v[176:179], v17 offset:40960
  v_mfma_f32_16x16x32_bf16 v[68:71], a[28:31], v[160:163], v[68:71]
  s_add_u32 m0, s31, 90112
  v_mfma_f32_16x16x32_bf16 v[72:75], a[32:35], v[160:163], v[72:75]
  s_waitcnt lgkmcnt(3)
  buffer_load_dwordx4 v10, s[8:11], s30 offen lds
  v_mfma_f32_16x16x32_bf16 v[76:79], a[24:27], v[164:167], v[76:79]
  ds_read_b128 v[180:183], v17 offset:43008
  buffer_store_dwordx4 v[212:215], v26, s[16:19], s29 offen offset:2048 sc1
  v_mfma_f32_16x16x32_bf16 v[80:83], a[28:31], v[164:167], v[80:83]
  v_mfma_f32_16x16x32_bf16 v[84:87], a[32:35], v[164:167], v[84:87]
  s_waitcnt lgkmcnt(3)
  v_mfma_f32_16x16x32_bf16 v[88:91], a[24:27], v[168:171], v[88:91]
  ds_read_b128 v[184:187], v17 offset:45056
  v_mfma_f32_16x16x32_bf16 v[92:95], a[28:31], v[168:171], v[92:95]
  s_add_u32 m0, s31, 91136
  v_mfma_f32_16x16x32_bf16 v[96:99], a[32:35], v[168:171], v[96:99]
  s_waitcnt lgkmcnt(3)
  buffer_load_dwordx4 v11, s[8:11], s30 offen lds
  v_mfma_f32_16x16x32_bf16 v[100:103], a[24:27], v[172:175], v[100:103]
  s_add_u32 s30, s30, s25
  ds_read_b128 v[188:191], v17 offset:47104
  v_mfma_f32_16x16x32_bf16 v[104:107], a[28:31], v[172:175], v[104:107]
  v_mfma_f32_16x16x32_bf16 v[108:111], a[32:35], v[172:175], v[108:111]
  s_waitcnt lgkmcnt(3)
  v_mfma_f32_16x16x32_bf16 v[64:67], a[36:39], v[176:179], v[64:67]
  s_waitcnt vmcnt(20)
  s_barrier
  ds_read_b128 v[160:163], v16 offset:49152
  v_mfma_f32_16x16x32_bf16 v[68:71], a[40:43], v[176:179], v[68:71]
  v_mfma_f32_16x16x32_bf16 v[72:75], a[44:47], v[176:179], v[72:75]
  s_waitcnt lgkmcnt(3)
  v_mfma_f32_16x16x32_bf16 v[76:79], a[36:39], v[180:183], v[76:79]
  ds_read_b128 v[164:167], v16 offset:51200
  v_mfma_f32_16x16x32_bf16 v[80:83], a[40:43], v[180:183], v[80:83]
  v_mfma_f32_16x16x32_bf16 v[84:87], a[44:47], v[180:183], v[84:87]
  s_waitcnt lgkmcnt(3)
  v_mfma_f32_16x16x32_bf16 v[88:91], a[36:39], v[184:187], v[88:91]
  ds_read_b128 v[168:171], v16 offset:53248
  v_mfma_f32_16x16x32_bf16 v[92:95], a[40:43], v[184:187], v[92:95]
  v_mfma_f32_16x16x32_bf16 v[96:99], a[44:47], v[184:187], v[96:99]
  s_waitcnt lgkmcnt(3)
  v_mfma_f32_16x16x32_bf16 v[100:103], a[36:39], v[188:191], v[100:103]
  ds_read_b128 v[172:175], v16 offset:55296
  v_mfma_f32_16x16x32_bf16 v[104:107], a[40:43], v[188:191], v[104:107]
  v_mfma_f32_16x16x32_bf16 v[108:111], a[44:47], v[188:191], v[108:111]
  s_waitcnt lgkmcnt(3)
  v_mfma_f32_16x16x32_bf16 v[64:67], a[48:51], v[160:163], v[64:67]
  ds_read_b128 v[176:179], v17 offset:49152
  v_mfma_f32_16x16x32_bf16 v[68:71], a[52:55], v[160:163], v[68:71]
  s_add_u32 m0, s31, 98304
  v_mfma_f32_16x16x32_bf16 v[72:75], a[56:59], v[160:163], v[72:75]
  s_waitcnt lgkmcnt(3)
  buffer_load_dwordx4 v10, s[8:11], s30 offen lds
  v_mfma_f32_16x16x32_bf16 v[76:79], a[48:51], v[164:167], v[76:79]
  ds_read_b128 v[180:183], v17 offset:51200
  v_mfma_f32_16x16x32_bf16 v[80:83], a[52:55], v[164:167], v[80:83]
  v_mfma_f32_16x16x32_bf16 v[84:87], a[56:59], v[164:167], v[84:87]
  s_waitcnt lgkmcnt(3)
  v_mfma_f32_16x16x32_bf16 v[88:91], a[48:51], v[168:171], v[88:91]
  ds_read_b128 v[184:187], v17 offset:53248
  v_mfma_f32_16x16x32_bf16 v[92:95], a[52:55], v[168:171], v[92:95]
  s_add_u32 m0, s31, 99328
  v_mfma_f32_16x16x32_bf16 v[96:99], a[56:59], v[168:171], v[96:99]
  s_waitcnt lgkmcnt(3)
  buffer_load_dwordx4 v11, s[8:11], s30 offen lds
  v_mfma_f32_16x16x32_bf16 v[100:103], a[48:51], v[172:175], v[100:103]
  s_add_u32 s30, s30, 128
  ds_read_b128 v[188:191], v17 offset:55296
  v_mfma_f32_16x16x32_bf16 v[104:107], a[52:55], v[172:175], v[104:107]
  v_mfma_f32_16x16x32_bf16 v[108:111], a[56:59], v[172:175], v[108:111]
  s_waitcnt lgkmcnt(3)
  v_mfma_f32_16x16x32_bf16 v[64:67], a[60:63], v[176:179], v[64:67]
  s_waitcnt vmcnt(20)
  s_barrier
  ds_read_b128 v[160:163], v16 offset:57344
  v_mfma_f32_16x16x32_bf16 v[68:71], a[64:67], v[176:179], v[68:71]
  v_mfma_f32_16x16x32_bf16 v[72:75], a[68:71], v[176:179], v[72:75]
  s_waitcnt lgkmcnt(3)
  v_mfma_f32_16x16x32_bf16 v[76:79], a[60:63], v[180:183], v[76:79]
  ds_read_b128 v[164:167], v16 offset:59392
  v_mfma_f32_16x16x32_bf16 v[80:83], a[64:67], v[180:183], v[80:83]
  v_mfma_f32_16x16x32_bf16 v[84:87], a[68:71], v[180:183], v[84:87]
  s_waitcnt lgkmcnt(3)
  v_mfma_f32_16x16x32_bf16 v[88:91], a[60:63], v[184:187], v[88:91]
  ds_read_b128 v[168:171], v16 offset:61440
  v_mfma_f32_16x16x32_bf16 v[92:95], a[64:67], v[184:187], v[92:95]
  v_mfma_f32_16x16x32_bf16 v[96:99], a[68:71], v[184:187], v[96:99]
  s_waitcnt lgkmcnt(3)
  v_mfma_f32_16x16x32_bf16 v[100:103], a[60:63], v[188:191], v[100:103]
  ds_read_b128 v[172:175], v16 offset:63488
  v_mfma_f32_16x16x32_bf16 v[104:107], a[64:67], v[188:191], v[104:107]
  v_mfma_f32_16x16x32_bf16 v[108:111], a[68:71], v[188:191], v[108:111]
  s_waitcnt lgkmcnt(3)
  v_mfma_f32_16x16x32_bf16 v[64:67], a[72:75], v[160:163], v[64:67]
  ds_read_b128 v[176:179], v17 offset:57344
  v_mfma_f32_16x16x32_bf16 v[68:71], a[76:79], v[160:163], v[68:71]
  s_add_u32 m0, s31, 106496
  v_mfma_f32_16x16x32_bf16 v[72:75], a[80:83], v[160:163], v[72:75]
  s_waitcnt lgkmcnt(3)
  buffer_load_dwordx4 v10, s[8:11], s30 offen lds
  v_mfma_f32_16x16x32_bf16 v[76:79], a[72:75], v[164:167], v[76:79]
  ds_read_b128 v[180:183], v17 offset:59392
  v_mfma_f32_16x16x32_bf16 v[80:83], a[76:79], v[164:167], v[80:83]
  v_mfma_f32_16x16x32_bf16 v[84:87], a[80:83], v[164:167], v[84:87]
  s_waitcnt lgkmcnt(3)
  v_mfma_f32_16x16x32_bf16 v[88:91], a[72:75], v[168:171], v[88:91]
  ds_read_b128 v[184:187], v17 offset:61440
  v_mfma_f32_16x16x32_bf16 v[92:95], a[76:79], v[168:171], v[92:95]
  s_add_u32 m0, s31, 107520
  v_mfma_f32_16x16x32_bf16 v[96:99], a[80:83], v[168:171], v[96:99]
  s_waitcnt lgkmcnt(3)
  buffer_load_dwordx4 v11, s[8:11], s30 offen lds
  v_mfma_f32_16x16x32_bf16 v[100:103], a[72:75], v[172:175], v[100:103]
  s_add_u32 s30, s30, 128
  ds_read_b128 v[188:191], v17 offset:63488
  v_mfma_f32_16x16x32_bf16 v[104:107], a[76:79], v[172:175], v[104:107]
  v_mfma_f32_16x16x32_bf16 v[108:111], a[80:83], v[172:175], v[108:111]
  s_waitcnt lgkmcnt(3)
  v_mfma_f32_16x16x32_bf16 v[64:67], a[84:87], v[176:179], v[64:67]
  s_waitcnt vmcnt(5)
  s_barrier
  ds_read_b128 v[160:163], v18 offset:0
  v_mfma_f32_16x16x32_bf16 v[68:71], a[88:91], v[176:179], v[68:71]
  buffer_atomic_add v28, v27, s[72:75], s61 offen sc1
  v_mfma_f32_16x16x32_bf16 v[72:75], a[92:95], v[176:179], v[72:75]
  s_waitcnt lgkmcnt(3)
  s_mov_b32 s48, s27
  s_add_u32 s27, s27, 4194304
  v_mfma_f32_16x16x32_bf16 v[76:79], a[84:87], v[180:183], v[76:79]
  s_mov_b32 s61, s60
  ds_read_b128 v[164:167], v18 offset:2048
  s_add_u32 s60, s60, 4
  v_mfma_f32_16x16x32_bf16 v[80:83], a[88:91], v[180:183], v[80:83]
  v_mfma_f32_16x16x32_bf16 v[84:87], a[92:95], v[180:183], v[84:87]
  s_waitcnt lgkmcnt(3)
  v_mfma_f32_16x16x32_bf16 v[88:91], a[84:87], v[184:187], v[88:91]
  ds_read_b128 v[168:171], v18 offset:4096
  v_mfma_f32_16x16x32_bf16 v[92:95], a[88:91], v[184:187], v[92:95]
  v_mfma_f32_16x16x32_bf16 v[96:99], a[92:95], v[184:187], v[96:99]
  s_waitcnt lgkmcnt(3)
  v_mfma_f32_16x16x32_bf16 v[100:103], a[84:87], v[188:191], v[100:103]
  ds_read_b128 v[172:175], v18 offset:6144
  v_mfma_f32_16x16x32_bf16 v[104:107], a[88:91], v[188:191], v[104:107]
  v_mfma_f32_16x16x32_bf16 v[108:111], a[92:95], v[188:191], v[108:111]
  s_waitcnt lgkmcnt(3)
  v_mfma_f32_16x16x32_bf16 v[64:67], a[96:99], v[160:163], v[64:67]
  ds_read_b128 v[176:179], v19 offset:0
  v_mfma_f32_16x16x32_bf16 v[68:71], a[100:103], v[160:163], v[68:71]
  s_add_u32 m0, s31, 114688
  v_mfma_f32_16x16x32_bf16 v[72:75], a[104:107], v[160:163], v[72:75]
  s_waitcnt lgkmcnt(3)
  buffer_load_dwordx4 v10, s[8:11], s30 offen lds
  v_mfma_f32_16x16x32_bf16 v[76:79], a[96:99], v[164:167], v[76:79]
  ds_read_b128 v[180:183], v19 offset:2048
  v_mfma_f32_16x16x32_bf16 v[80:83], a[100:103], v[164:167], v[80:83]
  v_mfma_f32_16x16x32_bf16 v[84:87], a[104:107], v[164:167], v[84:87]
  s_waitcnt lgkmcnt(3)
  v_mfma_f32_16x16x32_bf16 v[88:91], a[96:99], v[168:171], v[88:91]
  ds_read_b128 v[184:187], v19 offset:4096
  v_mfma_f32_16x16x32_bf16 v[92:95], a[100:103], v[168:171], v[92:95]
  s_add_u32 m0, s31, 115712
  v_mfma_f32_16x16x32_bf16 v[96:99], a[104:107], v[168:171], v[96:99]
  s_waitcnt lgkmcnt(3)
  buffer_load_dwordx4 v11, s[8:11], s30 offen lds
  v_mfma_f32_16x16x32_bf16 v[100:103], a[96:99], v[172:175], v[100:103]
  s_add_u32 s30, s30, 128
  ds_read_b128 v[188:191], v19 offset:6144
  v_mfma_f32_16x16x32_bf16 v[104:107], a[100:103], v[172:175], v[104:107]
  v_mfma_f32_16x16x32_bf16 v[108:111], a[104:107], v[172:175], v[108:111]
  s_waitcnt lgkmcnt(3)
  v_mfma_f32_16x16x32_bf16 v[64:67], a[108:111], v[176:179], v[64:67]
  s_waitcnt vmcnt(21)
  s_barrier
  ds_read_b128 v[160:163], v18 offset:8192
  v_mfma_f32_16x16x32_bf16 v[68:71], a[112:115], v[176:179], v[68:71]
  v_mfma_f32_16x16x32_bf16 v[72:75], a[116:119], v[176:179], v[72:75]
  s_waitcnt lgkmcnt(3)
  v_mfma_f32_16x16x32_bf16 v[76:79], a[108:111], v[180:183], v[76:79]
  ds_read_b128 v[164:167], v18 offset:10240
  v_mfma_f32_16x16x32_bf16 v[80:83], a[112:115], v[180:183], v[80:83]
  v_mfma_f32_16x16x32_bf16 v[84:87], a[116:119], v[180:183], v[84:87]
  s_waitcnt lgkmcnt(3)
  v_mfma_f32_16x16x32_bf16 v[88:91], a[108:111], v[184:187], v[88:91]
  ds_read_b128 v[168:171], v18 offset:12288
  v_mfma_f32_16x16x32_bf16 v[92:95], a[112:115], v[184:187], v[92:95]
  v_mfma_f32_16x16x32_bf16 v[96:99], a[116:119], v[184:187], v[96:99]
  s_waitcnt lgkmcnt(3)
  v_mfma_f32_16x16x32_bf16 v[100:103], a[108:111], v[188:191], v[100:103]
  ds_read_b128 v[172:175], v18 offset:14336
  v_mfma_f32_16x16x32_bf16 v[104:107], a[112:115], v[188:191], v[104:107]
  v_mfma_f32_16x16x32_bf16 v[108:111], a[116:119], v[188:191], v[108:111]
  s_waitcnt lgkmcnt(3)
  v_mfma_f32_16x16x32_bf16 v[64:67], a[120:123], v[160:163], v[64:67]
  ds_read_b128 v[176:179], v19 offset:8192
  v_mfma_f32_16x16x32_bf16 v[68:71], a[124:127], v[160:163], v[68:71]
  s_add_u32 m0, s31, 122880
  v_mfma_f32_16x16x32_bf16 v[72:75], a[128:131], v[160:163], v[72:75]
  s_waitcnt lgkmcnt(3)
  buffer_load_dwordx4 v10, s[8:11], s30 offen lds
  v_mfma_f32_16x16x32_bf16 v[76:79], a[120:123], v[164:167], v[76:79]
  ds_read_b128 v[180:183], v19 offset:10240
  v_mfma_f32_16x16x32_bf16 v[80:83], a[124:127], v[164:167], v[80:83]
  v_mfma_f32_16x16x32_bf16 v[84:87], a[128:131], v[164:167], v[84:87]
  s_waitcnt lgkmcnt(3)
  v_mfma_f32_16x16x32_bf16 v[88:91], a[120:123], v[168:171], v[88:91]
  ds_read_b128 v[184:187], v19 offset:12288
  v_mfma_f32_16x16x32_bf16 v[92:95], a[124:127], v[168:171], v[92:95]
  s_add_u32 m0, s31, 123904
  v_mfma_f32_16x16x32_bf16 v[96:99], a[128:131], v[168:171], v[96:99]
  s_waitcnt lgkmcnt(3)
  buffer_load_dwordx4 v11, s[8:11], s30 offen lds
  v_mfma_f32_16x16x32_bf16 v[100:103], a[120:123], v[172:175], v[100:103]
  s_add_u32 s30, s30, 128
  ds_read_b128 v[188:191], v19 offset:14336
  v_mfma_f32_16x16x32_bf16 v[104:107], a[124:127], v[172:175], v[104:107]
  v_mfma_f32_16x16x32_bf16 v[108:111], a[128:131], v[172:175], v[108:111]
  s_waitcnt lgkmcnt(3)
  v_mfma_f32_16x16x32_bf16 v[64:67], a[132:135], v[176:179], v[64:67]
  s_waitcnt vmcnt(21)
  s_barrier
  ds_read_b128 v[160:163], v18 offset:16384
  v_mfma_f32_16x16x32_bf16 v[68:71], a[136:139], v[176:179], v[68:71]
  v_mfma_f32_16x16x32_bf16 v[72:75], a[140:143], v[176:179], v[72:75]
  s_waitcnt lgkmcnt(3)
  v_mfma_f32_16x16x32_bf16 v[76:79], a[132:135], v[180:183], v[76:79]
  ds_read_b128 v[164:167], v18 offset:18432
  v_mfma_f32_16x16x32_bf16 v[80:83], a[136:139], v[180:183], v[80:83]
  v_mfma_f32_16x16x32_bf16 v[84:87], a[140:143], v[180:183], v[84:87]
  s_waitcnt lgkmcnt(3)
  v_mfma_f32_16x16x32_bf16 v[88:91], a[132:135], v[184:187], v[88:91]
  ds_read_b128 v[168:171], v18 offset:20480
  v_mfma_f32_16x16x32_bf16 v[92:95], a[136:139], v[184:187], v[92:95]
  v_mfma_f32_16x16x32_bf16 v[96:99], a[140:143], v[184:187], v[96:99]
  s_waitcnt lgkmcnt(3)
  v_mfma_f32_16x16x32_bf16 v[100:103], a[132:135], v[188:191], v[100:103]
  ds_read_b128 v[172:175], v18 offset:22528
  v_mfma_f32_16x16x32_bf16 v[104:107], a[136:139], v[188:191], v[104:107]
  v_mfma_f32_16x16x32_bf16 v[108:111], a[140:143], v[188:191], v[108:111]
  s_waitcnt lgkmcnt(3)
  v_mfma_f32_16x16x32_bf16 v[64:67], a[144:147], v[160:163], v[64:67]
  ds_read_b128 v[176:179], v19 offset:16384
  v_mfma_f32_16x16x32_bf16 v[68:71], a[148:151], v[160:163], v[68:71]
  s_add_u32 m0, s31, 131072
  v_mfma_f32_16x16x32_bf16 v[72:75], a[152:155], v[160:163], v[72:75]
  s_waitcnt lgkmcnt(3)
  buffer_load_dwordx4 v10, s[8:11], s30 offen lds
  v_mfma_f32_16x16x32_bf16 v[76:79], a[144:147], v[164:167], v[76:79]
  ds_read_b128 v[180:183], v19 offset:18432
  v_mfma_f32_16x16x32_bf16 v[80:83], a[148:151], v[164:167], v[80:83]
  v_mfma_f32_16x16x32_bf16 v[84:87], a[152:155], v[164:167], v[84:87]
  s_waitcnt lgkmcnt(3)
  v_mfma_f32_16x16x32_bf16 v[88:91], a[144:147], v[168:171], v[88:91]
  ds_read_b128 v[184:187], v19 offset:20480
  v_mfma_f32_16x16x32_bf16 v[92:95], a[148:151], v[168:171], v[92:95]
  s_add_u32 m0, s31, 132096
  v_mfma_f32_16x16x32_bf16 v[96:99], a[152:155], v[168:171], v[96:99]
  s_waitcnt lgkmcnt(3)
  buffer_load_dwordx4 v11, s[8:11], s30 offen lds
  v_mfma_f32_16x16x32_bf16 v[100:103], a[144:147], v[172:175], v[100:103]
  s_add_u32 s30, s30, 128
  ds_read_b128 v[188:191], v19 offset:22528
  v_mfma_f32_16x16x32_bf16 v[104:107], a[148:151], v[172:175], v[104:107]
  v_mfma_f32_16x16x32_bf16 v[108:111], a[152:155], v[172:175], v[108:111]
  s_waitcnt lgkmcnt(3)
  v_mfma_f32_16x16x32_bf16 v[64:67], a[156:159], v[176:179], v[64:67]
  s_waitcnt vmcnt(21)
  s_barrier
  ds_read_b128 v[160:163], v18 offset:24576
  v_mfma_f32_16x16x32_bf16 v[68:71], a[160:163], v[176:179], v[68:71]
  v_mfma_f32_16x16x32_bf16 v[72:75], a[164:167], v[176:179], v[72:75]
  s_waitcnt lgkmcnt(3)
  v_mfma_f32_16x16x32_bf16 v[76:79], a[156:159], v[180:183], v[76:79]
  ds_read_b128 v[164:167], v18 offset:26624
  v_mfma_f32_16x16x32_bf16 v[80:83], a[160:163], v[180:183], v[80:83]
  v_mfma_f32_16x16x32_bf16 v[84:87], a[164:167], v[180:183], v[84:87]
  s_waitcnt lgkmcnt(3)
  v_mfma_f32_16x16x32_bf16 v[88:91], a[156:159], v[184:187], v[88:91]
  ds_read_b128 v[168:171], v18 offset:28672
  v_mfma_f32_16x16x32_bf16 v[92:95], a[160:163], v[184:187], v[92:95]
  v_mfma_f32_16x16x32_bf16 v[96:99], a[164:167], v[184:187], v[96:99]
  s_waitcnt lgkmcnt(3)
  v_mfma_f32_16x16x32_bf16 v[100:103], a[156:159], v[188:191], v[100:103]
  ds_read_b128 v[172:175], v18 offset:30720
  v_mfma_f32_16x16x32_bf16 v[104:107], a[160:163], v[188:191], v[104:107]
  v_mfma_f32_16x16x32_bf16 v[108:111], a[164:167], v[188:191], v[108:111]
  s_waitcnt lgkmcnt(3)
  v_mfma_f32_16x16x32_bf16 v[64:67], a[168:171], v[160:163], v[64:67]
  ds_read_b128 v[176:179], v19 offset:24576
  v_mfma_f32_16x16x32_bf16 v[68:71], a[172:175], v[160:163], v[68:71]
  s_add_u32 m0, s31, 139264
  v_mfma_f32_16x16x32_bf16 v[72:75], a[176:179], v[160:163], v[72:75]
  s_waitcnt lgkmcnt(3)
  buffer_load_dwordx4 v10, s[8:11], s30 offen lds
  v_mfma_f32_16x16x32_bf16 v[76:79], a[168:171], v[164:167], v[76:79]
  ds_read_b128 v[180:183], v19 offset:26624
  v_mfma_f32_16x16x32_bf16 v[80:83], a[172:175], v[164:167], v[80:83]
  v_mfma_f32_16x16x32_bf16 v[84:87], a[176:179], v[164:167], v[84:87]
  s_waitcnt lgkmcnt(3)
  v_mfma_f32_16x16x32_bf16 v[88:91], a[168:171], v[168:171], v[88:91]
  ds_read_b128 v[184:187], v19 offset:28672
  v_mfma_f32_16x16x32_bf16 v[92:95], a[172:175], v[168:171], v[92:95]
  s_add_u32 m0, s31, 140288
  v_mfma_f32_16x16x32_bf16 v[96:99], a[176:179], v[168:171], v[96:99]
  s_waitcnt lgkmcnt(3)
  buffer_load_dwordx4 v11, s[8:11], s30 offen lds
  v_mfma_f32_16x16x32_bf16 v[100:103], a[168:171], v[172:175], v[100:103]
  s_add_u32 s30, s30, 128
  ds_read_b128 v[188:191], v19 offset:30720
  v_mfma_f32_16x16x32_bf16 v[104:107], a[172:175], v[172:175], v[104:107]
  v_mfma_f32_16x16x32_bf16 v[108:111], a[176:179], v[172:175], v[108:111]
  s_waitcnt lgkmcnt(3)
  v_mfma_f32_16x16x32_bf16 v[64:67], a[180:183], v[176:179], v[64:67]
  s_waitcnt vmcnt(19)
  s_barrier
  ds_read_b128 v[160:163], v16 offset:16384
  v_mfma_f32_16x16x32_bf16 v[68:71], a[184:187], v[176:179], v[68:71]
  v_mfma_f32_16x16x32_bf16 v[72:75], a[188:191], v[176:179], v[72:75]
  s_waitcnt lgkmcnt(3)
  v_mfma_f32_16x16x32_bf16 v[76:79], a[180:183], v[180:183], v[76:79]
  ds_read_b128 v[164:167], v16 offset:18432
  v_mfma_f32_16x16x32_bf16 v[80:83], a[184:187], v[180:183], v[80:83]
  v_mfma_f32_16x16x32_bf16 v[84:87], a[188:191], v[180:183], v[84:87]
  s_waitcnt lgkmcnt(3)
  v_mfma_f32_16x16x32_bf16 v[88:91], a[180:183], v[184:187], v[88:91]
  ds_read_b128 v[168:171], v16 offset:20480
  v_mfma_f32_16x16x32_bf16 v[92:95], a[184:187], v[184:187], v[92:95]
  v_mfma_f32_16x16x32_bf16 v[96:99], a[188:191], v[184:187], v[96:99]
  s_waitcnt lgkmcnt(3)
  v_mfma_f32_16x16x32_bf16 v[100:103], a[180:183], v[188:191], v[100:103]
  ds_read_b128 v[172:175], v16 offset:22528
  v_mfma_f32_16x16x32_bf16 v[104:107], a[184:187], v[188:191], v[104:107]
  v_mfma_f32_16x16x32_bf16 v[108:111], a[188:191], v[188:191], v[108:111]
  s_waitcnt lgkmcnt(3)
  v_mfma_f32_16x16x32_bf16 v[64:67], a[192:195], v[160:163], v[64:67]
  ds_read_b128 v[176:179], v17 offset:16384
  v_mfma_f32_16x16x32_bf16 v[68:71], a[196:199], v[160:163], v[68:71]
  s_add_u32 m0, s31, 147456
  v_mfma_f32_16x16x32_bf16 v[72:75], a[200:203], v[160:163], v[72:75]
  s_waitcnt lgkmcnt(3)
  buffer_load_dwordx4 v10, s[8:11], s30 offen lds
  v_mfma_f32_16x16x32_bf16 v[76:79], a[192:195], v[164:167], v[76:79]
  ds_read_b128 v[180:183], v17 offset:18432
  v_mfma_f32_16x16x32_bf16 v[80:83], a[196:199], v[164:167], v[80:83]
  v_mfma_f32_16x16x32_bf16 v[84:87], a[200:203], v[164:167], v[84:87]
  s_waitcnt lgkmcnt(3)
  v_mfma_f32_16x16x32_bf16 v[88:91], a[192:195], v[168:171], v[88:91]
  ds_read_b128 v[184:187], v17 offset:20480
  v_mfma_f32_16x16x32_bf16 v[92:95], a[196:199], v[168:171], v[92:95]
  s_add_u32 m0, s31, 148480
  v_mfma_f32_16x16x32_bf16 v[96:99], a[200:203], v[168:171], v[96:99]
  s_waitcnt lgkmcnt(3)
  buffer_load_dwordx4 v11, s[8:11], s30 offen lds
  v_mfma_f32_16x16x32_bf16 v[100:103], a[192:195], v[172:175], v[100:103]
  s_add_u32 s30, s30, 128
  ds_read_b128 v[188:191], v17 offset:22528
  v_mfma_f32_16x16x32_bf16 v[104:107], a[196:199], v[172:175], v[104:107]
  v_mfma_f32_16x16x32_bf16 v[108:111], a[200:203], v[172:175], v[108:111]
  s_waitcnt lgkmcnt(3)
  v_mfma_f32_16x16x32_bf16 v[64:67], a[204:207], v[176:179], v[64:67]
  s_waitcnt vmcnt(15)
  s_barrier
  ds_read_b128 v[160:163], v16 offset:24576
  v_mfma_f32_16x16x32_bf16 v[68:71], a[208:211], v[176:179], v[68:71]
  v_mfma_f32_16x16x32_bf16 v[72:75], a[212:215], v[176:179], v[72:75]
  s_waitcnt lgkmcnt(3)
  v_mfma_f32_16x16x32_bf16 v[76:79], a[204:207], v[180:183], v[76:79]
  ds_read_b128 v[164:167], v16 offset:26624
  v_mfma_f32_16x16x32_bf16 v[80:83], a[208:211], v[180:183], v[80:83]
  v_mfma_f32_16x16x32_bf16 v[84:87], a[212:215], v[180:183], v[84:87]
  s_waitcnt lgkmcnt(3)
  v_mfma_f32_16x16x32_bf16 v[88:91], a[204:207], v[184:187], v[88:91]
  ds_read_b128 v[168:171], v16 offset:28672
  v_mfma_f32_16x16x32_bf16 v[92:95], a[208:211], v[184:187], v[92:95]
  v_mfma_f32_16x16x32_bf16 v[96:99], a[212:215], v[184:187], v[96:99]
  s_waitcnt lgkmcnt(3)
  v_mfma_f32_16x16x32_bf16 v[100:103], a[204:207], v[188:191], v[100:103]
  ds_read_b128 v[172:175], v16 offset:30720
  v_mfma_f32_16x16x32_bf16 v[104:107], a[208:211], v[188:191], v[104:107]
  v_mfma_f32_16x16x32_bf16 v[108:111], a[212:215], v[188:191], v[108:111]
  s_waitcnt lgkmcnt(3)
  v_mfma_f32_16x16x32_bf16 v[64:67], a[216:219], v[160:163], v[64:67]
  ds_read_b128 v[176:179], v17 offset:24576
  v_mfma_f32_16x16x32_bf16 v[68:71], a[220:223], v[160:163], v[68:71]
  s_add_u32 m0, s31, 155648
  v_mfma_f32_16x16x32_bf16 v[72:75], a[224:227], v[160:163], v[72:75]
  s_waitcnt lgkmcnt(3)
  buffer_load_dwordx4 v10, s[8:11], s30 offen lds
  v_mfma_f32_16x16x32_bf16 v[76:79], a[216:219], v[164:167], v[76:79]
  ds_read_b128 v[180:183], v17 offset:26624
  v_mfma_f32_16x16x32_bf16 v[80:83], a[220:223], v[164:167], v[80:83]
  v_mfma_f32_16x16x32_bf16 v[84:87], a[224:227], v[164:167], v[84:87]
  s_waitcnt lgkmcnt(3)
  v_mfma_f32_16x16x32_bf16 v[88:91], a[216:219], v[168:171], v[88:91]
  ds_read_b128 v[184:187], v17 offset:28672
  v_mfma_f32_16x16x32_bf16 v[92:95], a[220:223], v[168:171], v[92:95]
  s_add_u32 m0, s31, 156672
  v_mfma_f32_16x16x32_bf16 v[96:99], a[224:227], v[168:171], v[96:99]
  s_waitcnt lgkmcnt(3)
  buffer_load_dwordx4 v11, s[8:11], s30 offen lds
  v_mfma_f32_16x16x32_bf16 v[100:103], a[216:219], v[172:175], v[100:103]
  s_add_u32 s30, s30, 128
  ds_read_b128 v[188:191], v17 offset:30720
  v_mfma_f32_16x16x32_bf16 v[104:107], a[220:223], v[172:175], v[104:107]
  v_mfma_f32_16x16x32_bf16 v[108:111], a[224:227], v[172:175], v[108:111]
  s_waitcnt lgkmcnt(3)
  v_mfma_f32_16x16x32_bf16 v[64:67], a[228:231], v[176:179], v[64:67]
  s_waitcnt vmcnt(15)
  s_barrier
  ds_read_b128 v[160:163], v16 offset:32768
  v_mfma_f32_16x16x32_bf16 v[68:71], a[232:235], v[176:179], v[68:71]
  v_mfma_f32_16x16x32_bf16 v[72:75], a[236:239], v[176:179], v[72:75]
  s_waitcnt lgkmcnt(3)
  v_mfma_f32_16x16x32_bf16 v[76:79], a[228:231], v[180:183], v[76:79]
  ds_read_b128 v[164:167], v16 offset:34816
  v_cvt_pk_bf16_f32 v192, v64, v65
  v_mfma_f32_16x16x32_bf16 v[80:83], a[232:235], v[180:183], v[80:83]
  v_cvt_pk_bf16_f32 v193, v66, v67
  v_cvt_pk_bf16_f32 v194, v68, v69
  v_mfma_f32_16x16x32_bf16 v[84:87], a[236:239], v[180:183], v[84:87]
  s_waitcnt lgkmcnt(3)
  v_cvt_pk_bf16_f32 v195, v70, v71
  v_cvt_pk_bf16_f32 v200, v72, v73
  v_mfma_f32_16x16x32_bf16 v[88:91], a[228:231], v[184:187], v[88:91]
  ds_read_b128 v[168:171], v16 offset:36864
  v_cvt_pk_bf16_f32 v201, v74, v75
  v_mfma_f32_16x16x32_bf16 v[92:95], a[232:235], v[184:187], v[92:95]
  v_cvt_pk_bf16_f32 v196, v76, v77
  v_cvt_pk_bf16_f32 v197, v78, v79
  v_mfma_f32_16x16x32_bf16 v[96:99], a[236:239], v[184:187], v[96:99]
  s_waitcnt lgkmcnt(3)
  v_cvt_pk_bf16_f32 v198, v80, v81
  v_cvt_pk_bf16_f32 v199, v82, v83
  v_mfma_f32_16x16x32_bf16 v[100:103], a[228:231], v[188:191], v[100:103]
  ds_read_b128 v[172:175], v16 offset:38912
  v_cvt_pk_bf16_f32 v202, v84, v85
  v_mfma_f32_16x16x32_bf16 v[104:107], a[232:235], v[188:191], v[104:107]
  s_sub_u32 s26, s26, 1
  s_cmp_gt_u32 s26, 0
  v_cvt_pk_bf16_f32 v203, v86, v87
  v_mfma_f32_16x16x32_bf16 v[108:111], a[236:239], v[188:191], v[108:111]
  s_waitcnt lgkmcnt(3)
  s_cbranch_scc1 kvm_240
  s_nop 7
  v_cvt_pk_bf16_f32 v204, v88, v89
  v_cvt_pk_bf16_f32 v205, v90, v91
  v_cvt_pk_bf16_f32 v206, v92, v93
  v_cvt_pk_bf16_f32 v207, v94, v95
  v_cvt_pk_bf16_f32 v212, v96, v97
  v_cvt_pk_bf16_f32 v213, v98, v99
  v_cvt_pk_bf16_f32 v208, v100, v101
  v_cvt_pk_bf16_f32 v209, v102, v103
  v_cvt_pk_bf16_f32 v210, v104, v105
  v_cvt_pk_bf16_f32 v211, v106, v107
  v_cvt_pk_bf16_f32 v214, v108, v109
  v_cvt_pk_bf16_f32 v215, v110, v111
  s_xor_b32 s29, s48, 0
  buffer_store_dwordx4 v[192:195], v26, s[16:19], s29 offen offset:0 sc1
  buffer_store_dwordx4 v[196:199], v26, s[16:19], s29 offen offset:1024 sc1
  buffer_store_dwordx4 v[200:203], v26, s[16:19], s29 offen offset:2048 sc1
  s_xor_b32 s29, s48, 2105344
  buffer_store_dwordx4 v[204:207], v26, s[16:19], s29 offen offset:0 sc1
  buffer_store_dwordx4 v[208:211], v26, s[16:19], s29 offen offset:1024 sc1
  buffer_store_dwordx4 v[212:215], v26, s[16:19], s29 offen offset:2048 sc1
  s_mov_b32 s30, 491520
  s_mov_b32 s25, 162688
  v_lshrrev_b32 v4, 3, v1
  v_and_b32 v5, 7, v1
  v_xor_b32 v5, v5, v4
  s_mul_i32 s21, s20, 32
  v_add_u32 v4, s21, v4
  v_mul_u32_u24 v4, 1280, v4
  v_lshl_add_u32 v10, v5, 4, v4
  s_mul_i32 s31, s20, 4096
  v_add_u32 v11, 10240, v10
  v_add_u32 v12, 20480, v10
  v_add_u32 v13, 30720, v10
  s_add_u32 m0, s31, 0
  s_nop 0
  buffer_load_dwordx4 v10, s[8:11], s30 offen lds
  s_add_u32 m0, s31, 1024
  s_nop 0
  buffer_load_dwordx4 v11, s[8:11], s30 offen lds
  s_add_u32 m0, s31, 2048
  s_nop 0
  buffer_load_dwordx4 v12, s[8:11], s30 offen lds
  s_add_u32 m0, s31, 3072
  s_nop 0
  buffer_load_dwordx4 v13, s[8:11], s30 offen lds
  s_add_u32 s30, s30, 128
  s_add_u32 m0, s31, 16384
  s_nop 0
  buffer_load_dwordx4 v10, s[8:11], s30 offen lds
  s_add_u32 m0, s31, 17408
  s_nop 0
  buffer_load_dwordx4 v11, s[8:11], s30 offen lds
  s_add_u32 m0, s31, 18432
  s_nop 0
  buffer_load_dwordx4 v12, s[8:11], s30 offen lds
  s_add_u32 m0, s31, 19456
  s_nop 0
  buffer_load_dwordx4 v13, s[8:11], s30 offen lds
  s_add_u32 s30, s30, 128
  s_add_u32 m0, s31, 32768
  s_nop 0
  buffer_load_dwordx4 v10, s[8:11], s30 offen lds
  s_add_u32 m0, s31, 33792
  s_nop 0
  buffer_load_dwordx4 v11, s[8:11], s30 offen lds
  s_add_u32 m0, s31, 34816
  s_nop 0
  buffer_load_dwordx4 v12, s[8:11], s30 offen lds
  s_add_u32 m0, s31, 35840
  s_nop 0
  buffer_load_dwordx4 v13, s[8:11], s30 offen lds
  s_add_u32 s30, s30, 128
  s_add_u32 m0, s31, 49152
  s_nop 0
  buffer_load_dwordx4 v10, s[8:11], s30 offen lds
  s_add_u32 m0, s31, 50176
  s_nop 0
  buffer_load_dwordx4 v11, s[8:11], s30 offen lds
  s_add_u32 m0, s31, 51200
  s_nop 0
  buffer_load_dwordx4 v12, s[8:11], s30 offen lds
  s_add_u32 m0, s31, 52224
  s_nop 0
  buffer_load_dwordx4 v13, s[8:11], s30 offen lds
  s_add_u32 s30, s30, 128
  s_add_u32 m0, s31, 65536
  s_nop 0
  buffer_load_dwordx4 v10, s[8:11], s30 offen lds
  s_add_u32 m0, s31, 66560
  s_nop 0
  buffer_load_dwordx4 v11, s[8:11], s30 offen lds
  s_add_u32 m0, s31, 67584
  s_nop 0
  buffer_load_dwordx4 v12, s[8:11], s30 offen lds
  s_add_u32 m0, s31, 68608
  s_nop 0
  buffer_load_dwordx4 v13, s[8:11], s30 offen lds
  s_add_u32 s30, s30, 128
  s_waitcnt vmcnt(20) lgkmcnt(0)
  s_barrier
  buffer_atomic_add v28, v27, s[72:75], s61 offen sc1
  s_add_u32 m0, s31, 81920
  s_nop 0
  buffer_load_dwordx4 v10, s[8:11], s30 offen lds
  s_add_u32 m0, s31, 82944
  s_nop 0
  buffer_load_dwordx4 v11, s[8:11], s30 offen lds
  s_add_u32 m0, s31, 83968
  s_nop 0
  buffer_load_dwordx4 v12, s[8:11], s30 offen lds
  s_add_u32 m0, s31, 84992
  s_nop 0
  buffer_load_dwordx4 v13, s[8:11], s30 offen lds
  s_add_u32 s30, s30, 128
  s_mov_b32 s26, 13
  s_load_dwordx2 s[64:65], s[0:1], 16
  s_mul_i32 s68, s42, 384
  s_mul_i32 s21, s20, 1966080
  s_add_u32 s68, s68, s21
  v_mul_u32_u24 v5, 21846, v1
  v_lshrrev_b32 v5, 16, v5
  v_mul_u32_u24 v5, 11904, v5
  v_lshl_add_u32 v20, v1, 7, v5
  s_waitcnt lgkmcnt(0)
  s_mov_b32 s64, s64
  s_mov_b32 s65, s65
  s_mov_b32 s66, 7864320
  s_mov_b32 s67, 0x00020000
  s_cmp_eq_u32 s43, 0
  s_cselect_b32 s63, 2, 0
  s_mov_b32 s48, 0x40000000
  s_mov_b32 s61, 0x40000000
  s_waitcnt vmcnt(16)
  s_barrier
  ds_read_b128 v[160:163], v14 offset:0
  ds_read_b128 v[164:167], v14 offset:2048
  ds_read_b128 v[168:171], v14 offset:4096
  ds_read_b128 v[172:175], v14 offset:6144
  s_waitcnt lgkmcnt(3)
  .p2align 3
kvs_241:
  v_mfma_f32_16x16x32_bf16 v[64:67], a[0:3], v[160:163], 0
  s_xor_b32 s29, s48, 0
  ds_read_b128 v[176:179], v14 offset:8192
  v_cvt_pk_bf16_f32 v221, v126, v127
  v_mfma_f32_16x16x32_bf16 v[68:71], a[4:7], v[160:163], 0
  v_cvt_pk_bf16_f32 v222, v128, v129
  v_cvt_pk_bf16_f32 v223, v130, v131
  v_mfma_f32_16x16x32_bf16 v[72:75], a[8:11], v[160:163], 0
  s_waitcnt lgkmcnt(3)
  v_cvt_pk_bf16_f32 v226, v132, v133
  v_cvt_pk_bf16_f32 v227, v134, v135
  v_mfma_f32_16x16x32_bf16 v[76:79], a[0:3], v[164:167], 0
  ds_read_b128 v[180:183], v14 offset:10240
  v_cvt_pk_bf16_f32 v228, v136, v137
  v_mfma_f32_16x16x32_bf16 v[80:83], a[4:7], v[164:167], 0
  v_cvt_pk_bf16_f32 v229, v138, v139
  v_cvt_pk_bf16_f32 v230, v140, v141
  v_mfma_f32_16x16x32_bf16 v[84:87], a[8:11], v[164:167], 0
  s_waitcnt lgkmcnt(3)
  v_cvt_pk_bf16_f32 v231, v142, v143
  v_cvt_pk_bf16_f32 v236, v144, v145
  v_mfma_f32_16x16x32_bf16 v[88:91], a[0:3], v[168:171], 0
  ds_read_b128 v[184:187], v14 offset:12288
  v_cvt_pk_bf16_f32 v237, v146, v147
  v_mfma_f32_16x16x32_bf16 v[92:95], a[4:7], v[168:171], 0
  v_cvt_pk_bf16_f32 v232, v148, v149
  v_cvt_pk_bf16_f32 v233, v150, v151
  v_mfma_f32_16x16x32_bf16 v[96:99], a[8:11], v[168:171], 0
  s_waitcnt lgkmcnt(3)
  v_cvt_pk_bf16_f32 v234, v152, v153
  v_cvt_pk_bf16_f32 v235, v154, v155
  v_mfma_f32_16x16x32_bf16 v[100:103], a[0:3], v[172:175], 0
  ds_read_b128 v[188:191], v14 offset:14336
  v_cvt_pk_bf16_f32 v238, v156, v157
  v_mfma_f32_16x16x32_bf16 v[104:107], a[4:7], v[172:175], 0
  v_cvt_pk_bf16_f32 v239, v158, v159
  v_mfma_f32_16x16x32_bf16 v[108:111], a[8:11], v[172:175], 0
  s_waitcnt lgkmcnt(3)
  v_mfma_f32_16x16x32_bf16 v[112:115], a[0:3], v[176:179], 0
  ds_read_b128 v[160:163], v15 offset:0
  v_mfma_f32_16x16x32_bf16 v[116:119], a[4:7], v[176:179], 0
  s_add_u32 m0, s31, 98304
  v_mfma_f32_16x16x32_bf16 v[120:123], a[8:11], v[176:179], 0
  s_waitcnt lgkmcnt(3)
  buffer_load_dwordx4 v10, s[8:11], s30 offen lds
  v_mfma_f32_16x16x32_bf16 v[124:127], a[0:3], v[180:183], 0
  ds_read_b128 v[164:167], v15 offset:2048
  v_mfma_f32_16x16x32_bf16 v[128:131], a[4:7], v[180:183], 0
  v_mfma_f32_16x16x32_bf16 v[132:135], a[8:11], v[180:183], 0
  s_waitcnt lgkmcnt(3)
  v_mfma_f32_16x16x32_bf16 v[136:139], a[0:3], v[184:187], 0
  ds_read_b128 v[168:171], v15 offset:4096
  v_mfma_f32_16x16x32_bf16 v[140:143], a[4:7], v[184:187], 0
  s_add_u32 m0, s31, 99328
  v_mfma_f32_16x16x32_bf16 v[144:147], a[8:11], v[184:187], 0
  s_waitcnt lgkmcnt(3)
  buffer_load_dwordx4 v11, s[8:11], s30 offen lds
  v_mfma_f32_16x16x32_bf16 v[148:151], a[0:3], v[188:191], 0
  ds_read_b128 v[172:175], v15 offset:6144
  v_mfma_f32_16x16x32_bf16 v[152:155], a[4:7], v[188:191], 0
  v_mfma_f32_16x16x32_bf16 v[156:159], a[8:11], v[188:191], 0
  s_waitcnt lgkmcnt(3)
  v_mfma_f32_16x16x32_bf16 v[64:67], a[12:15], v[160:163], v[64:67]
  ds_read_b128 v[176:179], v15 offset:8192
  v_mfma_f32_16x16x32_bf16 v[68:71], a[16:19], v[160:163], v[68:71]
  s_add_u32 m0, s31, 100352
  v_mfma_f32_16x16x32_bf16 v[72:75], a[20:23], v[160:163], v[72:75]
  s_waitcnt lgkmcnt(3)
  buffer_load_dwordx4 v12, s[8:11], s30 offen lds
  v_mfma_f32_16x16x32_bf16 v[76:79], a[12:15], v[164:167], v[76:79]
  ds_read_b128 v[180:183], v15 offset:10240
  v_mfma_f32_16x16x32_bf16 v[80:83], a[16:19], v[164:167], v[80:83]
  v_mfma_f32_16x16x32_bf16 v[84:87], a[20:23], v[164:167], v[84:87]
  s_waitcnt lgkmcnt(3)
  v_mfma_f32_16x16x32_bf16 v[88:91], a[12:15], v[168:171], v[88:91]
  ds_read_b128 v[184:187], v15 offset:12288
  v_mfma_f32_16x16x32_bf16 v[92:95], a[16:19], v[168:171], v[92:95]
  s_add_u32 m0, s31, 101376
  v_mfma_f32_16x16x32_bf16 v[96:99], a[20:23], v[168:171], v[96:99]
  s_waitcnt lgkmcnt(3)
  buffer_load_dwordx4 v13, s[8:11], s30 offen lds
  v_mfma_f32_16x16x32_bf16 v[100:103], a[12:15], v[172:175], v[100:103]
  s_add_u32 s30, s30, 128
  ds_read_b128 v[188:191], v15 offset:14336
  v_mfma_f32_16x16x32_bf16 v[104:107], a[16:19], v[172:175], v[104:107]
  v_mfma_f32_16x16x32_bf16 v[108:111], a[20:23], v[172:175], v[108:111]
  s_waitcnt lgkmcnt(3)
  v_mfma_f32_16x16x32_bf16 v[112:115], a[12:15], v[176:179], v[112:115]
  ds_read_b128 v[160:163], v14 offset:16384
  v_mfma_f32_16x16x32_bf16 v[116:119], a[16:19], v[176:179], v[116:119]
  buffer_store_dwordx4 v[192:195], v26, s[16:19], s29 offen offset:0 sc1
  v_mfma_f32_16x16x32_bf16 v[120:123], a[20:23], v[176:179], v[120:123]
  s_waitcnt lgkmcnt(3)
  v_mfma_f32_16x16x32_bf16 v[124:127], a[12:15], v[180:183], v[124:127]
  ds_read_b128 v[164:167], v14 offset:18432
  v_mfma_f32_16x16x32_bf16 v[128:131], a[16:19], v[180:183], v[128:131]
  v_mfma_f32_16x16x32_bf16 v[132:135], a[20:23], v[180:183], v[132:135]
  s_waitcnt lgkmcnt(3)
  v_mfma_f32_16x16x32_bf16 v[136:139], a[12:15], v[184:187], v[136:139]
  ds_read_b128 v[168:171], v14 offset:20480
  buffer_store_dwordx4 v[196:199], v26, s[16:19], s29 offen offset:1024 sc1
  v_mfma_f32_16x16x32_bf16 v[140:143], a[16:19], v[184:187], v[140:143]
  v_mfma_f32_16x16x32_bf16 v[144:147], a[20:23], v[184:187], v[144:147]
  s_waitcnt lgkmcnt(3)
  v_mfma_f32_16x16x32_bf16 v[148:151], a[12:15], v[188:191], v[148:151]
  ds_read_b128 v[172:175], v14 offset:22528
  v_mfma_f32_16x16x32_bf16 v[152:155], a[16:19], v[188:191], v[152:155]
  v_mfma_f32_16x16x32_bf16 v[156:159], a[20:23], v[188:191], v[156:159]
  s_waitcnt lgkmcnt(3)
  v_mfma_f32_16x16x32_bf16 v[64:67], a[24:27], v[160:163], v[64:67]
  ds_read_b128 v[176:179], v14 offset:24576
  v_mfma_f32_16x16x32_bf16 v[68:71], a[28:31], v[160:163], v[68:71]
  s_add_u32 m0, s31, 114688
  v_mfma_f32_16x16x32_bf16 v[72:75], a[32:35], v[160:163], v[72:75]
  s_waitcnt lgkmcnt(3)
  buffer_load_dwordx4 v10, s[8:11], s30 offen lds
  v_mfma_f32_16x16x32_bf16 v[76:79], a[24:27], v[164:167], v[76:79]
  ds_read_b128 v[180:183], v14 offset:26624
  v_mfma_f32_16x16x32_bf16 v[80:83], a[28:31], v[164:167], v[80:83]
  v_mfma_f32_16x16x32_bf16 v[84:87], a[32:35], v[164:167], v[84:87]
  s_waitcnt lgkmcnt(3)
  v_mfma_f32_16x16x32_bf16 v[88:91], a[24:27], v[168:171], v[88:91]
  ds_read_b128 v[184:187], v14 offset:28672
  v_mfma_f32_16x16x32_bf16 v[92:95], a[28:31], v[168:171], v[92:95]
  buffer_store_dwordx4 v[200:203], v26, s[16:19], s29 offen offset:2048 sc1
  v_mfma_f32_16x16x32_bf16 v[96:99], a[32:35], v[168:171], v[96:99]
  s_waitcnt lgkmcnt(3)
  v_mfma_f32_16x16x32_bf16 v[100:103], a[24:27], v[172:175], v[100:103]
  ds_read_b128 v[188:191], v14 offset:30720
  v_mfma_f32_16x16x32_bf16 v[104:107], a[28:31], v[172:175], v[104:107]
  s_cmp_le_u32 s26, s63
  s_cbranch_scc1 wp_243
wp_243r:
  v_mfma_f32_16x16x32_bf16 v[108:111], a[32:35], v[172:175], v[108:111]
  s_xor_b32 s29, s48, 2105344
  s_waitcnt lgkmcnt(3)
  v_mfma_f32_16x16x32_bf16 v[112:115], a[24:27], v[176:179], v[112:115]
  ds_read_b128 v[160:163], v15 offset:16384
  v_mfma_f32_16x16x32_bf16 v[116:119], a[28:31], v[176:179], v[116:119]
  s_add_u32 m0, s31, 115712
  v_mfma_f32_16x16x32_bf16 v[120:123], a[32:35], v[176:179], v[120:123]
  s_waitcnt lgkmcnt(3)
  buffer_load_dwordx4 v11, s[8:11], s30 offen lds
  v_mfma_f32_16x16x32_bf16 v[124:127], a[24:27], v[180:183], v[124:127]
  ds_read_b128 v[164:167], v15 offset:18432
  v_mfma_f32_16x16x32_bf16 v[128:131], a[28:31], v[180:183], v[128:131]
  v_mfma_f32_16x16x32_bf16 v[132:135], a[32:35], v[180:183], v[132:135]
  s_waitcnt lgkmcnt(3)
  v_mfma_f32_16x16x32_bf16 v[136:139], a[24:27], v[184:187], v[136:139]
  ds_read_b128 v[168:171], v15 offset:20480
  v_mfma_f32_16x16x32_bf16 v[140:143], a[28:31], v[184:187], v[140:143]
  buffer_store_dwordx4 v[204:207], v26, s[16:19], s29 offen offset:0 sc1
  v_mfma_f32_16x16x32_bf16 v[144:147], a[32:35], v[184:187], v[144:147]
  s_waitcnt lgkmcnt(3)
  v_mfma_f32_16x16x32_bf16 v[148:151], a[24:27], v[188:191], v[148:151]
  ds_read_b128 v[172:175], v15 offset:22528
  v_mfma_f32_16x16x32_bf16 v[152:155], a[28:31], v[188:191], v[152:155]
  v_mfma_f32_16x16x32_bf16 v[156:159], a[32:35], v[188:191], v[156:159]
  s_waitcnt lgkmcnt(3)
  v_mfma_f32_16x16x32_bf16 v[64:67], a[36:39], v[160:163], v[64:67]
  ds_read_b128 v[176:179], v15 offset:24576
  v_mfma_f32_16x16x32_bf16 v[68:71], a[40:43], v[160:163], v[68:71]
  s_add_u32 m0, s31, 116736
  v_mfma_f32_16x16x32_bf16 v[72:75], a[44:47], v[160:163], v[72:75]
  s_waitcnt lgkmcnt(3)
  buffer_load_dwordx4 v12, s[8:11], s30 offen lds
  v_mfma_f32_16x16x32_bf16 v[76:79], a[36:39], v[164:167], v[76:79]
  ds_read_b128 v[180:183], v15 offset:26624
  v_mfma_f32_16x16x32_bf16 v[80:83], a[40:43], v[164:167], v[80:83]
  v_mfma_f32_16x16x32_bf16 v[84:87], a[44:47], v[164:167], v[84:87]
  s_waitcnt lgkmcnt(3)
  v_mfma_f32_16x16x32_bf16 v[88:91], a[36:39], v[168:171], v[88:91]
  ds_read_b128 v[184:187], v15 offset:28672
  v_mfma_f32_16x16x32_bf16 v[92:95], a[40:43], v[168:171], v[92:95]
  buffer_store_dwordx4 v[208:211], v26, s[16:19], s29 offen offset:1024 sc1
  v_mfma_f32_16x16x32_bf16 v[96:99], a[44:47], v[168:171], v[96:99]
  s_waitcnt lgkmcnt(3)
  v_mfma_f32_16x16x32_bf16 v[100:103], a[36:39], v[172:175], v[100:103]
  ds_read_b128 v[188:191], v15 offset:30720
  v_mfma_f32_16x16x32_bf16 v[104:107], a[40:43], v[172:175], v[104:107]
  v_mfma_f32_16x16x32_bf16 v[108:111], a[44:47], v[172:175], v[108:111]
  s_waitcnt lgkmcnt(3)
  v_mfma_f32_16x16x32_bf16 v[112:115], a[36:39], v[176:179], v[112:115]
  s_waitcnt vmcnt(20)
  s_barrier
  ds_read_b128 v[160:163], v14 offset:32768
  v_mfma_f32_16x16x32_bf16 v[116:119], a[40:43], v[176:179], v[116:119]
  s_add_u32 m0, s31, 117760
  v_mfma_f32_16x16x32_bf16 v[120:123], a[44:47], v[176:179], v[120:123]
  s_waitcnt lgkmcnt(3)
  buffer_load_dwordx4 v13, s[8:11], s30 offen lds
  v_mfma_f32_16x16x32_bf16 v[124:127], a[36:39], v[180:183], v[124:127]
  s_add_u32 s30, s30, 128
  ds_read_b128 v[164:167], v14 offset:34816
  v_mfma_f32_16x16x32_bf16 v[128:131], a[40:43], v[180:183], v[128:131]
  v_mfma_f32_16x16x32_bf16 v[132:135], a[44:47], v[180:183], v[132:135]
  s_waitcnt lgkmcnt(3)
  v_mfma_f32_16x16x32_bf16 v[136:139], a[36:39], v[184:187], v[136:139]
  ds_read_b128 v[168:171], v14 offset:36864
  v_mfma_f32_16x16x32_bf16 v[140:143], a[40:43], v[184:187], v[140:143]
  buffer_store_dwordx4 v[212:215], v26, s[16:19], s29 offen offset:2048 sc1
  v_mfma_f32_16x16x32_bf16 v[144:147], a[44:47], v[184:187], v[144:147]
  s_waitcnt lgkmcnt(3)
  v_mfma_f32_16x16x32_bf16 v[148:151], a[36:39], v[188:191], v[148:151]
  ds_read_b128 v[172:175], v14 offset:38912
  v_mfma_f32_16x16x32_bf16 v[152:155], a[40:43], v[188:191], v[152:155]
  v_mfma_f32_16x16x32_bf16 v[156:159], a[44:47], v[188:191], v[156:159]
  s_xor_b32 s29, s48, 4194304
  s_waitcnt lgkmcnt(3)
  v_mfma_f32_16x16x32_bf16 v[64:67], a[48:51], v[160:163], v[64:67]
  ds_read_b128 v[176:179], v14 offset:40960
  v_mfma_f32_16x16x32_bf16 v[68:71], a[52:55], v[160:163], v[68:71]
  s_add_u32 m0, s31, 131072
  v_mfma_f32_16x16x32_bf16 v[72:75], a[56:59], v[160:163], v[72:75]
  s_waitcnt lgkmcnt(3)
  buffer_load_dwordx4 v10, s[8:11], s30 offen lds
  v_mfma_f32_16x16x32_bf16 v[76:79], a[48:51], v[164:167], v[76:79]
  ds_read_b128 v[180:183], v14 offset:43008
  v_mfma_f32_16x16x32_bf16 v[80:83], a[52:55], v[164:167], v[80:83]
  v_mfma_f32_16x16x32_bf16 v[84:87], a[56:59], v[164:167], v[84:87]
  s_waitcnt lgkmcnt(3)
  v_mfma_f32_16x16x32_bf16 v[88:91], a[48:51], v[168:171], v[88:91]
  ds_read_b128 v[184:187], v14 offset:45056
  v_mfma_f32_16x16x32_bf16 v[92:95], a[52:55], v[168:171], v[92:95]
  buffer_store_dwordx4 v[216:219], v26, s[16:19], s29 offen offset:0 sc1
  v_mfma_f32_16x16x32_bf16 v[96:99], a[56:59], v[168:171], v[96:99]
  s_waitcnt lgkmcnt(3)
  v_mfma_f32_16x16x32_bf16 v[100:103], a[48:51], v[172:175], v[100:103]
  ds_read_b128 v[188:191], v14 offset:47104
  v_mfma_f32_16x16x32_bf16 v[104:107], a[52:55], v[172:175], v[104:107]
  v_mfma_f32_16x16x32_bf16 v[108:111], a[56:59], v[172:175], v[108:111]
  s_waitcnt lgkmcnt(3)
  v_mfma_f32_16x16x32_bf16 v[112:115], a[48:51], v[176:179], v[112:115]
  ds_read_b128 v[160:163], v15 offset:32768
  v_mfma_f32_16x16x32_bf16 v[116:119], a[52:55], v[176:179], v[116:119]
  s_add_u32 m0, s31, 132096
  v_mfma_f32_16x16x32_bf16 v[120:123], a[56:59], v[176:179], v[120:123]
  s_waitcnt lgkmcnt(3)
  buffer_load_dwordx4 v11, s[8:11], s30 offen lds
  v_mfma_f32_16x16x32_bf16 v[124:127], a[48:51], v[180:183], v[124:127]
  ds_read_b128 v[164:167], v15 offset:34816
  v_mfma_f32_16x16x32_bf16 v[128:131], a[52:55], v[180:183], v[128:131]
  v_mfma_f32_16x16x32_bf16 v[132:135], a[56:59], v[180:183], v[132:135]
  s_waitcnt lgkmcnt(3)
  v_mfma_f32_16x16x32_bf16 v[136:139], a[48:51], v[184:187], v[136:139]
  ds_read_b128 v[168:171], v15 offset:36864
  v_mfma_f32_16x16x32_bf16 v[140:143], a[52:55], v[184:187], v[140:143]
  buffer_store_dwordx4 v[220:223], v26, s[16:19], s29 offen offset:1024 sc1
  v_mfma_f32_16x16x32_bf16 v[144:147], a[56:59], v[184:187], v[144:147]
  s_waitcnt lgkmcnt(3)
  v_mfma_f32_16x16x32_bf16 v[148:151], a[48:51], v[188:191], v[148:151]
  ds_read_b128 v[172:175], v15 offset:38912
  v_mfma_f32_16x16x32_bf16 v[152:155], a[52:55], v[188:191], v[152:155]
  v_mfma_f32_16x16x32_bf16 v[156:159], a[56:59], v[188:191], v[156:159]
  s_waitcnt lgkmcnt(3)
  v_mfma_f32_16x16x32_bf16 v[64:67], a[60:63], v[160:163], v[64:67]
  ds_read_b128 v[176:179], v15 offset:40960
  v_mfma_f32_16x16x32_bf16 v[68:71], a[64:67], v[160:163], v[68:71]
  s_add_u32 m0, s31, 133120
  v_mfma_f32_16x16x32_bf16 v[72:75], a[68:71], v[160:163], v[72:75]
  s_waitcnt lgkmcnt(3)
  buffer_load_dwordx4 v12, s[8:11], s30 offen lds
  v_mfma_f32_16x16x32_bf16 v[76:79], a[60:63], v[164:167], v[76:79]
  ds_read_b128 v[180:183], v15 offset:43008
  v_mfma_f32_16x16x32_bf16 v[80:83], a[64:67], v[164:167], v[80:83]
  v_mfma_f32_16x16x32_bf16 v[84:87], a[68:71], v[164:167], v[84:87]
  s_waitcnt lgkmcnt(3)
  v_mfma_f32_16x16x32_bf16 v[88:91], a[60:63], v[168:171], v[88:91]
  ds_read_b128 v[184:187], v15 offset:45056
  v_mfma_f32_16x16x32_bf16 v[92:95], a[64:67], v[168:171], v[92:95]
  buffer_store_dwordx4 v[224:227], v26, s[16:19], s29 offen offset:2048 sc1
  v_mfma_f32_16x16x32_bf16 v[96:99], a[68:71], v[168:171], v[96:99]
  s_waitcnt lgkmcnt(3)
  v_mfma_f32_16x16x32_bf16 v[100:103], a[60:63], v[172:175], v[100:103]
  ds_read_b128 v[188:191], v15 offset:47104
  v_mfma_f32_16x16x32_bf16 v[104:107], a[64:67], v[172:175], v[104:107]
  v_mfma_f32_16x16x32_bf16 v[108:111], a[68:71], v[172:175], v[108:111]
  s_xor_b32 s29, s48, 6299648
  s_waitcnt lgkmcnt(3)
  v_mfma_f32_16x16x32_bf16 v[112:115], a[60:63], v[176:179], v[112:115]
  ds_read_b128 v[160:163], v14 offset:49152
  v_mfma_f32_16x16x32_bf16 v[116:119], a[64:67], v[176:179], v[116:119]
  s_add_u32 m0, s31, 134144
  v_mfma_f32_16x16x32_bf16 v[120:123], a[68:71], v[176:179], v[120:123]
  s_waitcnt lgkmcnt(3)
  buffer_load_dwordx4 v13, s[8:11], s30 offen lds
  v_mfma_f32_16x16x32_bf16 v[124:127], a[60:63], v[180:183], v[124:127]
  s_add_u32 s30, s30, 128
  ds_read_b128 v[164:167], v14 offset:51200
  v_mfma_f32_16x16x32_bf16 v[128:131], a[64:67], v[180:183], v[128:131]
  v_mfma_f32_16x16x32_bf16 v[132:135], a[68:71], v[180:183], v[132:135]
  s_waitcnt lgkmcnt(3)
  v_mfma_f32_16x16x32_bf16 v[136:139], a[60:63], v[184:187], v[136:139]
  ds_read_b128 v[168:171], v14 offset:53248
  v_mfma_f32_16x16x32_bf16 v[140:143], a[64:67], v[184:187], v[140:143]
  buffer_store_dwordx4 v[228:231], v26, s[16:19], s29 offen offset:0 sc1
  v_mfma_f32_16x16x32_bf16 v[144:147], a[68:71], v[184:187], v[144:147]
  s_waitcnt lgkmcnt(3)
  v_mfma_f32_16x16x32_bf16 v[148:151], a[60:63], v[188:191], v[148:151]
  ds_read_b128 v[172:175], v14 offset:55296
  v_mfma_f32_16x16x32_bf16 v[152:155], a[64:67], v[188:191], v[152:155]
  v_mfma_f32_16x16x32_bf16 v[156:159], a[68:71], v[188:191], v[156:159]
  s_waitcnt lgkmcnt(3)
  v_mfma_f32_16x16x32_bf16 v[64:67], a[72:75], v[160:163], v[64:67]
  ds_read_b128 v[176:179], v14 offset:57344
  v_mfma_f32_16x16x32_bf16 v[68:71], a[76:79], v[160:163], v[68:71]
  s_add_u32 m0, s31, 147456
  v_mfma_f32_16x16x32_bf16 v[72:75], a[80:83], v[160:163], v[72:75]
  s_waitcnt lgkmcnt(3)
  buffer_load_dwordx4 v10, s[8:11], s30 offen lds
  v_mfma_f32_16x16x32_bf16 v[76:79], a[72:75], v[164:167], v[76:79]
  ds_read_b128 v[180:183], v14 offset:59392
  v_mfma_f32_16x16x32_bf16 v[80:83], a[76:79], v[164:167], v[80:83]
  v_mfma_f32_16x16x32_bf16 v[84:87], a[80:83], v[164:167], v[84:87]
  s_waitcnt lgkmcnt(3)
  v_mfma_f32_16x16x32_bf16 v[88:91], a[72:75], v[168:171], v[88:91]
  ds_read_b128 v[184:187], v14 offset:61440
  v_mfma_f32_16x16x32_bf16 v[92:95], a[76:79], v[168:171], v[92:95]
  buffer_store_dwordx4 v[232:235], v26, s[16:19], s29 offen offset:1024 sc1
  v_mfma_f32_16x16x32_bf16 v[96:99], a[80:83], v[168:171], v[96:99]
  s_waitcnt lgkmcnt(3)
  v_mfma_f32_16x16x32_bf16 v[100:103], a[72:75], v[172:175], v[100:103]
  ds_read_b128 v[188:191], v14 offset:63488
  v_mfma_f32_16x16x32_bf16 v[104:107], a[76:79], v[172:175], v[104:107]
  s_cmp_le_u32 s26, s63
  s_cbranch_scc1 wp_244
wp_244r:
  v_mfma_f32_16x16x32_bf16 v[108:111], a[80:83], v[172:175], v[108:111]
  s_waitcnt lgkmcnt(3)
  v_mfma_f32_16x16x32_bf16 v[112:115], a[72:75], v[176:179], v[112:115]
  ds_read_b128 v[160:163], v15 offset:49152
  v_mfma_f32_16x16x32_bf16 v[116:119], a[76:79], v[176:179], v[116:119]
  s_add_u32 m0, s31, 148480
  v_mfma_f32_16x16x32_bf16 v[120:123], a[80:83], v[176:179], v[120:123]
  s_waitcnt lgkmcnt(3)
  buffer_load_dwordx4 v11, s[8:11], s30 offen lds
  v_mfma_f32_16x16x32_bf16 v[124:127], a[72:75], v[180:183], v[124:127]
  ds_read_b128 v[164:167], v15 offset:51200
  v_mfma_f32_16x16x32_bf16 v[128:131], a[76:79], v[180:183], v[128:131]
  v_mfma_f32_16x16x32_bf16 v[132:135], a[80:83], v[180:183], v[132:135]
  s_waitcnt lgkmcnt(3)
  v_mfma_f32_16x16x32_bf16 v[136:139], a[72:75], v[184:187], v[136:139]
  ds_read_b128 v[168:171], v15 offset:53248
  v_mfma_f32_16x16x32_bf16 v[140:143], a[76:79], v[184:187], v[140:143]
  buffer_store_dwordx4 v[236:239], v26, s[16:19], s29 offen offset:2048 sc1
  v_mfma_f32_16x16x32_bf16 v[144:147], a[80:83], v[184:187], v[144:147]
  s_waitcnt lgkmcnt(3)
  v_mfma_f32_16x16x32_bf16 v[148:151], a[72:75], v[188:191], v[148:151]
  ds_read_b128 v[172:175], v15 offset:55296
  v_mfma_f32_16x16x32_bf16 v[152:155], a[76:79], v[188:191], v[152:155]
  v_mfma_f32_16x16x32_bf16 v[156:159], a[80:83], v[188:191], v[156:159]
  s_waitcnt lgkmcnt(3)
  v_mfma_f32_16x16x32_bf16 v[64:67], a[84:87], v[160:163], v[64:67]
  ds_read_b128 v[176:179], v15 offset:57344
  v_mfma_f32_16x16x32_bf16 v[68:71], a[88:91], v[160:163], v[68:71]
  s_add_u32 m0, s31, 149504
  v_mfma_f32_16x16x32_bf16 v[72:75], a[92:95], v[160:163], v[72:75]
  s_waitcnt lgkmcnt(3)
  buffer_load_dwordx4 v12, s[8:11], s30 offen lds
  v_mfma_f32_16x16x32_bf16 v[76:79], a[84:87], v[164:167], v[76:79]
  ds_read_b128 v[180:183], v15 offset:59392
  v_mfma_f32_16x16x32_bf16 v[80:83], a[88:91], v[164:167], v[80:83]
  v_mfma_f32_16x16x32_bf16 v[84:87], a[92:95], v[164:167], v[84:87]
  s_waitcnt lgkmcnt(3)
  v_mfma_f32_16x16x32_bf16 v[88:91], a[84:87], v[168:171], v[88:91]
  ds_read_b128 v[184:187], v15 offset:61440
  v_mfma_f32_16x16x32_bf16 v[92:95], a[88:91], v[168:171], v[92:95]
  v_mfma_f32_16x16x32_bf16 v[96:99], a[92:95], v[168:171], v[96:99]
  s_waitcnt lgkmcnt(3)
  v_mfma_f32_16x16x32_bf16 v[100:103], a[84:87], v[172:175], v[100:103]
  ds_read_b128 v[188:191], v15 offset:63488
  v_mfma_f32_16x16x32_bf16 v[104:107], a[88:91], v[172:175], v[104:107]
  s_cmp_le_u32 s26, 9
  s_cselect_b32 s62, 0x40000000, s61
  s_cselect_b32 s61, s61, 0x40000000
  s_cbranch_scc1 kf_242
  s_waitcnt vmcnt(1)
kf_242:
  v_mfma_f32_16x16x32_bf16 v[108:111], a[92:95], v[172:175], v[108:111]
  s_waitcnt lgkmcnt(3)
  v_mfma_f32_16x16x32_bf16 v[112:115], a[84:87], v[176:179], v[112:115]
  s_waitcnt vmcnt(27)
  s_barrier
  ds_read_b128 v[160:163], v16 offset:0
  v_mfma_f32_16x16x32_bf16 v[116:119], a[88:91], v[176:179], v[116:119]
  s_add_u32 m0, s31, 150528
  v_mfma_f32_16x16x32_bf16 v[120:123], a[92:95], v[176:179], v[120:123]
  s_waitcnt lgkmcnt(3)
  buffer_load_dwordx4 v13, s[8:11], s30 offen lds
  v_mfma_f32_16x16x32_bf16 v[124:127], a[84:87], v[180:183], v[124:127]
  s_add_u32 s30, s30, s25
  ds_read_b128 v[164:167], v16 offset:2048
  v_mfma_f32_16x16x32_bf16 v[128:131], a[88:91], v[180:183], v[128:131]
  v_mfma_f32_16x16x32_bf16 v[132:135], a[92:95], v[180:183], v[132:135]
  s_waitcnt lgkmcnt(3)
  v_mfma_f32_16x16x32_bf16 v[136:139], a[84:87], v[184:187], v[136:139]
  ds_read_b128 v[168:171], v16 offset:4096
  v_mfma_f32_16x16x32_bf16 v[140:143], a[88:91], v[184:187], v[140:143]
  buffer_atomic_add v28, v27, s[72:75], s62 offen sc1
  v_mfma_f32_16x16x32_bf16 v[144:147], a[92:95], v[184:187], v[144:147]
  s_waitcnt lgkmcnt(3)
  v_mfma_f32_16x16x32_bf16 v[148:151], a[84:87], v[188:191], v[148:151]
  ds_read_b128 v[172:175], v16 offset:6144
  v_mfma_f32_16x16x32_bf16 v[152:155], a[88:91], v[188:191], v[152:155]
  v_mfma_f32_16x16x32_bf16 v[156:159], a[92:95], v[188:191], v[156:159]
  s_waitcnt lgkmcnt(3)
  v_mfma_f32_16x16x32_bf16 v[64:67], a[96:99], v[160:163], v[64:67]
  ds_read_b128 v[176:179], v16 offset:8192
  v_mfma_f32_16x16x32_bf16 v[68:71], a[100:103], v[160:163], v[68:71]
  s_add_u32 m0, s31, 0
  v_mfma_f32_16x16x32_bf16 v[72:75], a[104:107], v[160:163], v[72:75]
  s_waitcnt lgkmcnt(3)
  buffer_load_dwordx4 v10, s[8:11], s30 offen lds
  v_mfma_f32_16x16x32_bf16 v[76:79], a[96:99], v[164:167], v[76:79]
  ds_read_b128 v[180:183], v16 offset:10240
  v_mfma_f32_16x16x32_bf16 v[80:83], a[100:103], v[164:167], v[80:83]
  v_mfma_f32_16x16x32_bf16 v[84:87], a[104:107], v[164:167], v[84:87]
  s_waitcnt lgkmcnt(3)
  v_mfma_f32_16x16x32_bf16 v[88:91], a[96:99], v[168:171], v[88:91]
  ds_read_b128 v[184:187], v16 offset:12288
  v_mfma_f32_16x16x32_bf16 v[92:95], a[100:103], v[168:171], v[92:95]
  v_mfma_f32_16x16x32_bf16 v[96:99], a[104:107], v[168:171], v[96:99]
  s_waitcnt lgkmcnt(3)
  v_mfma_f32_16x16x32_bf16 v[100:103], a[96:99], v[172:175], v[100:103]
  ds_read_b128 v[188:191], v16 offset:14336
  v_mfma_f32_16x16x32_bf16 v[104:107], a[100:103], v[172:175], v[104:107]
  v_mfma_f32_16x16x32_bf16 v[108:111], a[104:107], v[172:175], v[108:111]
  s_waitcnt lgkmcnt(3)
  v_mfma_f32_16x16x32_bf16 v[112:115], a[96:99], v[176:179], v[112:115]
  ds_read_b128 v[160:163], v17 offset:0
  v_mfma_f32_16x16x32_bf16 v[116:119], a[100:103], v[176:179], v[116:119]
  s_add_u32 m0, s31, 1024
  v_mfma_f32_16x16x32_bf16 v[120:123], a[104:107], v[176:179], v[120:123]
  s_waitcnt lgkmcnt(3)
  buffer_load_dwordx4 v11, s[8:11], s30 offen lds
  v_mfma_f32_16x16x32_bf16 v[124:127], a[96:99], v[180:183], v[124:127]
  ds_read_b128 v[164:167], v17 offset:2048
  v_mfma_f32_16x16x32_bf16 v[128:131], a[100:103], v[180:183], v[128:131]
  v_mfma_f32_16x16x32_bf16 v[132:135], a[104:107], v[180:183], v[132:135]
  s_waitcnt lgkmcnt(3)
  v_mfma_f32_16x16x32_bf16 v[136:139], a[96:99], v[184:187], v[136:139]
  ds_read_b128 v[168:171], v17 offset:4096
  v_mfma_f32_16x16x32_bf16 v[140:143], a[100:103], v[184:187], v[140:143]
  v_mfma_f32_16x16x32_bf16 v[144:147], a[104:107], v[184:187], v[144:147]
  s_waitcnt lgkmcnt(3)
  v_mfma_f32_16x16x32_bf16 v[148:151], a[96:99], v[188:191], v[148:151]
  ds_read_b128 v[172:175], v17 offset:6144
  v_mfma_f32_16x16x32_bf16 v[152:155], a[100:103], v[188:191], v[152:155]
  v_mfma_f32_16x16x32_bf16 v[156:159], a[104:107], v[188:191], v[156:159]
  s_waitcnt lgkmcnt(3)
  v_mfma_f32_16x16x32_bf16 v[64:67], a[108:111], v[160:163], v[64:67]
  ds_read_b128 v[176:179], v17 offset:8192
  v_mfma_f32_16x16x32_bf16 v[68:71], a[112:115], v[160:163], v[68:71]
  s_add_u32 m0, s31, 2048
  v_mfma_f32_16x16x32_bf16 v[72:75], a[116:119], v[160:163], v[72:75]
  s_waitcnt lgkmcnt(3)
  buffer_load_dwordx4 v12, s[8:11], s30 offen lds
  v_mfma_f32_16x16x32_bf16 v[76:79], a[108:111], v[164:167], v[76:79]
  ds_read_b128 v[180:183], v17 offset:10240
  v_mfma_f32_16x16x32_bf16 v[80:83], a[112:115], v[164:167], v[80:83]
  v_mfma_f32_16x16x32_bf16 v[84:87], a[116:119], v[164:167], v[84:87]
  s_waitcnt lgkmcnt(3)
  v_mfma_f32_16x16x32_bf16 v[88:91], a[108:111], v[168:171], v[88:91]
  ds_read_b128 v[184:187], v17 offset:12288
  v_mfma_f32_16x16x32_bf16 v[92:95], a[112:115], v[168:171], v[92:95]
  v_mfma_f32_16x16x32_bf16 v[96:99], a[116:119], v[168:171], v[96:99]
  s_waitcnt lgkmcnt(3)
  v_mfma_f32_16x16x32_bf16 v[100:103], a[108:111], v[172:175], v[100:103]
  ds_read_b128 v[188:191], v17 offset:14336
  v_mfma_f32_16x16x32_bf16 v[104:107], a[112:115], v[172:175], v[104:107]
  v_mfma_f32_16x16x32_bf16 v[108:111], a[116:119], v[172:175], v[108:111]
  s_waitcnt lgkmcnt(3)
  v_mfma_f32_16x16x32_bf16 v[112:115], a[108:111], v[176:179], v[112:115]
  ds_read_b128 v[160:163], v16 offset:16384
  v_mfma_f32_16x16x32_bf16 v[116:119], a[112:115], v[176:179], v[116:119]
  s_add_u32 m0, s31, 3072
  v_mfma_f32_16x16x32_bf16 v[120:123], a[116:119], v[176:179], v[120:123]
  s_waitcnt lgkmcnt(3)
  buffer_load_dwordx4 v13, s[8:11], s30 offen lds
  v_mfma_f32_16x16x32_bf16 v[124:127], a[108:111], v[180:183], v[124:127]
  s_add_u32 s30, s30, 128
  ds_read_b128 v[164:167], v16 offset:18432
  v_mfma_f32_16x16x32_bf16 v[128:131], a[112:115], v[180:183], v[128:131]
  v_mfma_f32_16x16x32_bf16 v[132:135], a[116:119], v[180:183], v[132:135]
  s_waitcnt lgkmcnt(3)
  v_mfma_f32_16x16x32_bf16 v[136:139], a[108:111], v[184:187], v[136:139]
  ds_read_b128 v[168:171], v16 offset:20480
  v_mfma_f32_16x16x32_bf16 v[140:143], a[112:115], v[184:187], v[140:143]
  v_mfma_f32_16x16x32_bf16 v[144:147], a[116:119], v[184:187], v[144:147]
  s_waitcnt lgkmcnt(3)
  v_mfma_f32_16x16x32_bf16 v[148:151], a[108:111], v[188:191], v[148:151]
  ds_read_b128 v[172:175], v16 offset:22528
  v_mfma_f32_16x16x32_bf16 v[152:155], a[112:115], v[188:191], v[152:155]
  v_mfma_f32_16x16x32_bf16 v[156:159], a[116:119], v[188:191], v[156:159]
  s_waitcnt lgkmcnt(3)
  v_mfma_f32_16x16x32_bf16 v[64:67], a[120:123], v[160:163], v[64:67]
  ds_read_b128 v[176:179], v16 offset:24576
  v_mfma_f32_16x16x32_bf16 v[68:71], a[124:127], v[160:163], v[68:71]
  s_add_u32 m0, s31, 16384
  v_mfma_f32_16x16x32_bf16 v[72:75], a[128:131], v[160:163], v[72:75]
  s_waitcnt lgkmcnt(3)
  buffer_load_dwordx4 v10, s[8:11], s30 offen lds
  v_mfma_f32_16x16x32_bf16 v[76:79], a[120:123], v[164:167], v[76:79]
  ds_read_b128 v[180:183], v16 offset:26624
  v_mfma_f32_16x16x32_bf16 v[80:83], a[124:127], v[164:167], v[80:83]
  v_mfma_f32_16x16x32_bf16 v[84:87], a[128:131], v[164:167], v[84:87]
  s_waitcnt lgkmcnt(3)
  v_mfma_f32_16x16x32_bf16 v[88:91], a[120:123], v[168:171], v[88:91]
  ds_read_b128 v[184:187], v16 offset:28672
  v_mfma_f32_16x16x32_bf16 v[92:95], a[124:127], v[168:171], v[92:95]
  v_mfma_f32_16x16x32_bf16 v[96:99], a[128:131], v[168:171], v[96:99]
  s_waitcnt lgkmcnt(3)
  v_mfma_f32_16x16x32_bf16 v[100:103], a[120:123], v[172:175], v[100:103]
  ds_read_b128 v[188:191], v16 offset:30720
  v_mfma_f32_16x16x32_bf16 v[104:107], a[124:127], v[172:175], v[104:107]
  s_cmp_le_u32 s26, s63
  s_cbranch_scc1 wp_245
wp_245r:
  v_mfma_f32_16x16x32_bf16 v[108:111], a[128:131], v[172:175], v[108:111]
  s_waitcnt lgkmcnt(3)
  v_mfma_f32_16x16x32_bf16 v[112:115], a[120:123], v[176:179], v[112:115]
  ds_read_b128 v[160:163], v17 offset:16384
  v_mfma_f32_16x16x32_bf16 v[116:119], a[124:127], v[176:179], v[116:119]
  s_add_u32 m0, s31, 17408
  v_mfma_f32_16x16x32_bf16 v[120:123], a[128:131], v[176:179], v[120:123]
  s_waitcnt lgkmcnt(3)
  buffer_load_dwordx4 v11, s[8:11], s30 offen lds
  v_mfma_f32_16x16x32_bf16 v[124:127], a[120:123], v[180:183], v[124:127]
  ds_read_b128 v[164:167], v17 offset:18432
  v_mfma_f32_16x16x32_bf16 v[128:131], a[124:127], v[180:183], v[128:131]
  v_mfma_f32_16x16x32_bf16 v[132:135], a[128:131], v[180:183], v[132:135]
  s_waitcnt lgkmcnt(3)
  v_mfma_f32_16x16x32_bf16 v[136:139], a[120:123], v[184:187], v[136:139]
  ds_read_b128 v[168:171], v17 offset:20480
  v_mfma_f32_16x16x32_bf16 v[140:143], a[124:127], v[184:187], v[140:143]
  v_mfma_f32_16x16x32_bf16 v[144:147], a[128:131], v[184:187], v[144:147]
  s_waitcnt lgkmcnt(3)
  v_mfma_f32_16x16x32_bf16 v[148:151], a[120:123], v[188:191], v[148:151]
  ds_read_b128 v[172:175], v17 offset:22528
  v_mfma_f32_16x16x32_bf16 v[152:155], a[124:127], v[188:191], v[152:155]
  v_mfma_f32_16x16x32_bf16 v[156:159], a[128:131], v[188:191], v[156:159]
  s_waitcnt lgkmcnt(3)
  v_mfma_f32_16x16x32_bf16 v[64:67], a[132:135], v[160:163], v[64:67]
  ds_read_b128 v[176:179], v17 offset:24576
  v_mfma_f32_16x16x32_bf16 v[68:71], a[136:139], v[160:163], v[68:71]
  s_add_u32 m0, s31, 18432
  v_mfma_f32_16x16x32_bf16 v[72:75], a[140:143], v[160:163], v[72:75]
  s_waitcnt lgkmcnt(3)
  buffer_load_dwordx4 v12, s[8:11], s30 offen lds
  v_mfma_f32_16x16x32_bf16 v[76:79], a[132:135], v[164:167], v[76:79]
  ds_read_b128 v[180:183], v17 offset:26624
  v_mfma_f32_16x16x32_bf16 v[80:83], a[136:139], v[164:167], v[80:83]
  v_mfma_f32_16x16x32_bf16 v[84:87], a[140:143], v[164:167], v[84:87]
  s_waitcnt lgkmcnt(3)
  v_mfma_f32_16x16x32_bf16 v[88:91], a[132:135], v[168:171], v[88:91]
  ds_read_b128 v[184:187], v17 offset:28672
  v_mfma_f32_16x16x32_bf16 v[92:95], a[136:139], v[168:171], v[92:95]
  v_mfma_f32_16x16x32_bf16 v[96:99], a[140:143], v[168:171], v[96:99]
  s_waitcnt lgkmcnt(3)
  v_mfma_f32_16x16x32_bf16 v[100:103], a[132:135], v[172:175], v[100:103]
  ds_read_b128 v[188:191], v17 offset:30720
  v_mfma_f32_16x16x32_bf16 v[104:107], a[136:139], v[172:175], v[104:107]
  v_mfma_f32_16x16x32_bf16 v[108:111], a[140:143], v[172:175], v[108:111]
  s_waitcnt lgkmcnt(3)
  v_mfma_f32_16x16x32_bf16 v[112:115], a[132:135], v[176:179], v[112:115]
  s_waitcnt vmcnt(23)
  s_barrier
  ds_read_b128 v[160:163], v16 offset:32768
  v_mfma_f32_16x16x32_bf16 v[116:119], a[136:139], v[176:179], v[116:119]
  s_add_u32 m0, s31, 19456
  v_mfma_f32_16x16x32_bf16 v[120:123], a[140:143], v[176:179], v[120:123]
  s_waitcnt lgkmcnt(3)
  buffer_load_dwordx4 v13, s[8:11], s30 offen lds
  v_mfma_f32_16x16x32_bf16 v[124:127], a[132:135], v[180:183], v[124:127]
  s_add_u32 s30, s30, 128
  ds_read_b128 v[164:167], v16 offset:34816
  v_mfma_f32_16x16x32_bf16 v[128:131], a[136:139], v[180:183], v[128:131]
  v_mfma_f32_16x16x32_bf16 v[132:135], a[140:143], v[180:183], v[132:135]
  s_waitcnt lgkmcnt(3)
  v_mfma_f32_16x16x32_bf16 v[136:139], a[132:135], v[184:187], v[136:139]
  ds_read_b128 v[168:171], v16 offset:36864
  v_mfma_f32_16x16x32_bf16 v[140:143], a[136:139], v[184:187], v[140:143]
  v_mfma_f32_16x16x32_bf16 v[144:147], a[140:143], v[184:187], v[144:147]
  s_waitcnt lgkmcnt(3)
  v_mfma_f32_16x16x32_bf16 v[148:151], a[132:135], v[188:191], v[148:151]
  ds_read_b128 v[172:175], v16 offset:38912
  v_mfma_f32_16x16x32_bf16 v[152:155], a[136:139], v[188:191], v[152:155]
  v_mfma_f32_16x16x32_bf16 v[156:159], a[140:143], v[188:191], v[156:159]
  s_waitcnt lgkmcnt(3)
  v_mfma_f32_16x16x32_bf16 v[64:67], a[144:147], v[160:163], v[64:67]
  ds_read_b128 v[176:179], v16 offset:40960
  v_mfma_f32_16x16x32_bf16 v[68:71], a[148:151], v[160:163], v[68:71]
  s_add_u32 m0, s31, 32768
  v_mfma_f32_16x16x32_bf16 v[72:75], a[152:155], v[160:163], v[72:75]
  s_waitcnt lgkmcnt(3)
  buffer_load_dwordx4 v10, s[8:11], s30 offen lds
  v_mfma_f32_16x16x32_bf16 v[76:79], a[144:147], v[164:167], v[76:79]
  ds_read_b128 v[180:183], v16 offset:43008
  v_mfma_f32_16x16x32_bf16 v[80:83], a[148:151], v[164:167], v[80:83]
  v_mfma_f32_16x16x32_bf16 v[84:87], a[152:155], v[164:167], v[84:87]
  s_waitcnt lgkmcnt(3)
  v_mfma_f32_16x16x32_bf16 v[88:91], a[144:147], v[168:171], v[88:91]
  ds_read_b128 v[184:187], v16 offset:45056
  v_mfma_f32_16x16x32_bf16 v[92:95], a[148:151], v[168:171], v[92:95]
  v_mfma_f32_16x16x32_bf16 v[96:99], a[152:155], v[168:171], v[96:99]
  s_waitcnt lgkmcnt(3)
  v_mfma_f32_16x16x32_bf16 v[100:103], a[144:147], v[172:175], v[100:103]
  ds_read_b128 v[188:191], v16 offset:47104
  v_mfma_f32_16x16x32_bf16 v[104:107], a[148:151], v[172:175], v[104:107]
  v_mfma_f32_16x16x32_bf16 v[108:111], a[152:155], v[172:175], v[108:111]
  s_waitcnt lgkmcnt(3)
  v_mfma_f32_16x16x32_bf16 v[112:115], a[144:147], v[176:179], v[112:115]
  ds_read_b128 v[160:163], v17 offset:32768
  v_mfma_f32_16x16x32_bf16 v[116:119], a[148:151], v[176:179], v[116:119]
  s_add_u32 m0, s31, 33792
  v_mfma_f32_16x16x32_bf16 v[120:123], a[152:155], v[176:179], v[120:123]
  s_waitcnt lgkmcnt(3)
  buffer_load_dwordx4 v11, s[8:11], s30 offen lds
  v_mfma_f32_16x16x32_bf16 v[124:127], a[144:147], v[180:183], v[124:127]
  ds_read_b128 v[164:167], v17 offset:34816
  v_mfma_f32_16x16x32_bf16 v[128:131], a[148:151], v[180:183], v[128:131]
  v_mfma_f32_16x16x32_bf16 v[132:135], a[152:155], v[180:183], v[132:135]
  s_waitcnt lgkmcnt(3)
  v_mfma_f32_16x16x32_bf16 v[136:139], a[144:147], v[184:187], v[136:139]
  ds_read_b128 v[168:171], v17 offset:36864
  v_mfma_f32_16x16x32_bf16 v[140:143], a[148:151], v[184:187], v[140:143]
  v_mfma_f32_16x16x32_bf16 v[144:147], a[152:155], v[184:187], v[144:147]
  s_waitcnt lgkmcnt(3)
  v_mfma_f32_16x16x32_bf16 v[148:151], a[144:147], v[188:191], v[148:151]
  ds_read_b128 v[172:175], v17 offset:38912
  v_mfma_f32_16x16x32_bf16 v[152:155], a[148:151], v[188:191], v[152:155]
  v_mfma_f32_16x16x32_bf16 v[156:159], a[152:155], v[188:191], v[156:159]
  s_waitcnt lgkmcnt(3)
  v_mfma_f32_16x16x32_bf16 v[64:67], a[156:159], v[160:163], v[64:67]
  ds_read_b128 v[176:179], v17 offset:40960
  v_mfma_f32_16x16x32_bf16 v[68:71], a[160:163], v[160:163], v[68:71]
  s_add_u32 m0, s31, 34816
  v_mfma_f32_16x16x32_bf16 v[72:75], a[164:167], v[160:163], v[72:75]
  s_waitcnt lgkmcnt(3)
  buffer_load_dwordx4 v12, s[8:11], s30 offen lds
  v_mfma_f32_16x16x32_bf16 v[76:79], a[156:159], v[164:167], v[76:79]
  ds_read_b128 v[180:183], v17 offset:43008
  v_mfma_f32_16x16x32_bf16 v[80:83], a[160:163], v[164:167], v[80:83]
  v_mfma_f32_16x16x32_bf16 v[84:87], a[164:167], v[164:167], v[84:87]
  s_waitcnt lgkmcnt(3)
  v_mfma_f32_16x16x32_bf16 v[88:91], a[156:159], v[168:171], v[88:91]
  ds_read_b128 v[184:187], v17 offset:45056
  v_mfma_f32_16x16x32_bf16 v[92:95], a[160:163], v[168:171], v[92:95]
  v_mfma_f32_16x16x32_bf16 v[96:99], a[164:167], v[168:171], v[96:99]
  s_waitcnt lgkmcnt(3)
  v_mfma_f32_16x16x32_bf16 v[100:103], a[156:159], v[172:175], v[100:103]
  ds_read_b128 v[188:191], v17 offset:47104
  v_mfma_f32_16x16x32_bf16 v[104:107], a[160:163], v[172:175], v[104:107]
  v_mfma_f32_16x16x32_bf16 v[108:111], a[164:167], v[172:175], v[108:111]
  s_waitcnt lgkmcnt(3)
  v_mfma_f32_16x16x32_bf16 v[112:115], a[156:159], v[176:179], v[112:115]
  ds_read_b128 v[160:163], v16 offset:49152
  v_mfma_f32_16x16x32_bf16 v[116:119], a[160:163], v[176:179], v[116:119]
  s_add_u32 m0, s31, 35840
  v_mfma_f32_16x16x32_bf16 v[120:123], a[164:167], v[176:179], v[120:123]
  s_waitcnt lgkmcnt(3)
  buffer_load_dwordx4 v13, s[8:11], s30 offen lds
  v_mfma_f32_16x16x32_bf16 v[124:127], a[156:159], v[180:183], v[124:127]
  s_add_u32 s30, s30, 128
  ds_read_b128 v[164:167], v16 offset:51200
  v_mfma_f32_16x16x32_bf16 v[128:131], a[160:163], v[180:183], v[128:131]
  v_mfma_f32_16x16x32_bf16 v[132:135], a[164:167], v[180:183], v[132:135]
  s_waitcnt lgkmcnt(3)
  v_mfma_f32_16x16x32_bf16 v[136:139], a[156:159], v[184:187], v[136:139]
  ds_read_b128 v[168:171], v16 offset:53248
  v_mfma_f32_16x16x32_bf16 v[140:143], a[160:163], v[184:187], v[140:143]
  v_mfma_f32_16x16x32_bf16 v[144:147], a[164:167], v[184:187], v[144:147]
  s_waitcnt lgkmcnt(3)
  v_mfma_f32_16x16x32_bf16 v[148:151], a[156:159], v[188:191], v[148:151]
  ds_read_b128 v[172:175], v16 offset:55296
  v_mfma_f32_16x16x32_bf16 v[152:155], a[160:163], v[188:191], v[152:155]
  v_mfma_f32_16x16x32_bf16 v[156:159], a[164:167], v[188:191], v[156:159]
  s_waitcnt lgkmcnt(3)
  v_mfma_f32_16x16x32_bf16 v[64:67], a[168:171], v[160:163], v[64:67]
  ds_read_b128 v[176:179], v16 offset:57344
  v_mfma_f32_16x16x32_bf16 v[68:71], a[172:175], v[160:163], v[68:71]
  s_add_u32 m0, s31, 49152
  v_mfma_f32_16x16x32_bf16 v[72:75], a[176:179], v[160:163], v[72:75]
  s_waitcnt lgkmcnt(3)
  buffer_load_dwordx4 v10, s[8:11], s30 offen lds
  v_mfma_f32_16x16x32_bf16 v[76:79], a[168:171], v[164:167], v[76:79]
  ds_read_b128 v[180:183], v16 offset:59392
  v_mfma_f32_16x16x32_bf16 v[80:83], a[172:175], v[164:167], v[80:83]
  v_mfma_f32_16x16x32_bf16 v[84:87], a[176:179], v[164:167], v[84:87]
  s_waitcnt lgkmcnt(3)
  v_mfma_f32_16x16x32_bf16 v[88:91], a[168:171], v[168:171], v[88:91]
  ds_read_b128 v[184:187], v16 offset:61440
  v_mfma_f32_16x16x32_bf16 v[92:95], a[172:175], v[168:171], v[92:95]
  v_mfma_f32_16x16x32_bf16 v[96:99], a[176:179], v[168:171], v[96:99]
  s_waitcnt lgkmcnt(3)
  v_mfma_f32_16x16x32_bf16 v[100:103], a[168:171], v[172:175], v[100:103]
  ds_read_b128 v[188:191], v16 offset:63488
  v_mfma_f32_16x16x32_bf16 v[104:107], a[172:175], v[172:175], v[104:107]
  s_cmp_le_u32 s26, s63
  s_cbranch_scc1 wp_246
wp_246r:
  v_mfma_f32_16x16x32_bf16 v[108:111], a[176:179], v[172:175], v[108:111]
  s_waitcnt lgkmcnt(3)
  v_mfma_f32_16x16x32_bf16 v[112:115], a[168:171], v[176:179], v[112:115]
  ds_read_b128 v[160:163], v17 offset:49152
  v_mfma_f32_16x16x32_bf16 v[116:119], a[172:175], v[176:179], v[116:119]
  s_add_u32 m0, s31, 50176
  v_mfma_f32_16x16x32_bf16 v[120:123], a[176:179], v[176:179], v[120:123]
  s_waitcnt lgkmcnt(3)
  buffer_load_dwordx4 v11, s[8:11], s30 offen lds
  v_mfma_f32_16x16x32_bf16 v[124:127], a[168:171], v[180:183], v[124:127]
  ds_read_b128 v[164:167], v17 offset:51200
  v_mfma_f32_16x16x32_bf16 v[128:131], a[172:175], v[180:183], v[128:131]
  v_mfma_f32_16x16x32_bf16 v[132:135], a[176:179], v[180:183], v[132:135]
  s_waitcnt lgkmcnt(3)
  v_mfma_f32_16x16x32_bf16 v[136:139], a[168:171], v[184:187], v[136:139]
  ds_read_b128 v[168:171], v17 offset:53248
  v_mfma_f32_16x16x32_bf16 v[140:143], a[172:175], v[184:187], v[140:143]
  v_mfma_f32_16x16x32_bf16 v[144:147], a[176:179], v[184:187], v[144:147]
  s_waitcnt lgkmcnt(3)
  v_mfma_f32_16x16x32_bf16 v[148:151], a[168:171], v[188:191], v[148:151]
  ds_read_b128 v[172:175], v17 offset:55296
  v_mfma_f32_16x16x32_bf16 v[152:155], a[172:175], v[188:191], v[152:155]
  v_mfma_f32_16x16x32_bf16 v[156:159], a[176:179], v[188:191], v[156:159]
  s_waitcnt lgkmcnt(3)
  v_mfma_f32_16x16x32_bf16 v[64:67], a[180:183], v[160:163], v[64:67]
  ds_read_b128 v[176:179], v17 offset:57344
  v_mfma_f32_16x16x32_bf16 v[68:71], a[184:187], v[160:163], v[68:71]
  s_add_u32 m0, s31, 51200
  v_mfma_f32_16x16x32_bf16 v[72:75], a[188:191], v[160:163], v[72:75]
  s_waitcnt lgkmcnt(3)
  buffer_load_dwordx4 v12, s[8:11], s30 offen lds
  v_mfma_f32_16x16x32_bf16 v[76:79], a[180:183], v[164:167], v[76:79]
  ds_read_b128 v[180:183], v17 offset:59392
  v_mfma_f32_16x16x32_bf16 v[80:83], a[184:187], v[164:167], v[80:83]
  v_mfma_f32_16x16x32_bf16 v[84:87], a[188:191], v[164:167], v[84:87]
  s_waitcnt lgkmcnt(3)
  v_mfma_f32_16x16x32_bf16 v[88:91], a[180:183], v[168:171], v[88:91]
  ds_read_b128 v[184:187], v17 offset:61440
  v_mfma_f32_16x16x32_bf16 v[92:95], a[184:187], v[168:171], v[92:95]
  v_mfma_f32_16x16x32_bf16 v[96:99], a[188:191], v[168:171], v[96:99]
  s_waitcnt lgkmcnt(3)
  v_mfma_f32_16x16x32_bf16 v[100:103], a[180:183], v[172:175], v[100:103]
  ds_read_b128 v[188:191], v17 offset:63488
  v_mfma_f32_16x16x32_bf16 v[104:107], a[184:187], v[172:175], v[104:107]
  v_mfma_f32_16x16x32_bf16 v[108:111], a[188:191], v[172:175], v[108:111]
  s_waitcnt lgkmcnt(3)
  v_mfma_f32_16x16x32_bf16 v[112:115], a[180:183], v[176:179], v[112:115]
  s_waitcnt vmcnt(16)
  s_barrier
  ds_read_b128 v[160:163], v18 offset:0
  v_mfma_f32_16x16x32_bf16 v[116:119], a[184:187], v[176:179], v[116:119]
  s_add_u32 m0, s31, 52224
  v_mfma_f32_16x16x32_bf16 v[120:123], a[188:191], v[176:179], v[120:123]
  s_waitcnt lgkmcnt(3)
  buffer_load_dwordx4 v13, s[8:11], s30 offen lds
  v_mfma_f32_16x16x32_bf16 v[124:127], a[180:183], v[180:183], v[124:127]
  s_add_u32 s30, s30, 128
  ds_read_b128 v[164:167], v18 offset:2048
  v_mfma_f32_16x16x32_bf16 v[128:131], a[184:187], v[180:183], v[128:131]
  v_mfma_f32_16x16x32_bf16 v[132:135], a[188:191], v[180:183], v[132:135]
  s_waitcnt lgkmcnt(3)
  v_mfma_f32_16x16x32_bf16 v[136:139], a[180:183], v[184:187], v[136:139]
  ds_read_b128 v[168:171], v18 offset:4096
  v_mfma_f32_16x16x32_bf16 v[140:143], a[184:187], v[184:187], v[140:143]
  buffer_atomic_add v28, v27, s[72:75], s61 offen sc1
  v_mfma_f32_16x16x32_bf16 v[144:147], a[188:191], v[184:187], v[144:147]
  s_waitcnt lgkmcnt(3)
  s_mov_b32 s48, s27
  s_add_u32 s27, s27, 8388608
  v_mfma_f32_16x16x32_bf16 v[148:151], a[180:183], v[188:191], v[148:151]
  s_mov_b32 s61, s60
  ds_read_b128 v[172:175], v18 offset:6144
  s_add_u32 s60, s60, 4
  v_mfma_f32_16x16x32_bf16 v[152:155], a[184:187], v[188:191], v[152:155]
  v_mfma_f32_16x16x32_bf16 v[156:159], a[188:191], v[188:191], v[156:159]
  s_waitcnt lgkmcnt(3)
  v_mfma_f32_16x16x32_bf16 v[64:67], a[192:195], v[160:163], v[64:67]
  ds_read_b128 v[176:179], v18 offset:8192
  v_mfma_f32_16x16x32_bf16 v[68:71], a[196:199], v[160:163], v[68:71]
  s_add_u32 m0, s31, 65536
  v_mfma_f32_16x16x32_bf16 v[72:75], a[200:203], v[160:163], v[72:75]
  s_waitcnt lgkmcnt(3)
  buffer_load_dwordx4 v10, s[8:11], s30 offen lds
  v_mfma_f32_16x16x32_bf16 v[76:79], a[192:195], v[164:167], v[76:79]
  ds_read_b128 v[180:183], v18 offset:10240
  v_mfma_f32_16x16x32_bf16 v[80:83], a[196:199], v[164:167], v[80:83]
  v_mfma_f32_16x16x32_bf16 v[84:87], a[200:203], v[164:167], v[84:87]
  s_waitcnt lgkmcnt(3)
  v_mfma_f32_16x16x32_bf16 v[88:91], a[192:195], v[168:171], v[88:91]
  ds_read_b128 v[184:187], v18 offset:12288
  v_mfma_f32_16x16x32_bf16 v[92:95], a[196:199], v[168:171], v[92:95]
  v_mfma_f32_16x16x32_bf16 v[96:99], a[200:203], v[168:171], v[96:99]
  s_waitcnt lgkmcnt(3)
  v_mfma_f32_16x16x32_bf16 v[100:103], a[192:195], v[172:175], v[100:103]
  ds_read_b128 v[188:191], v18 offset:14336
  v_mfma_f32_16x16x32_bf16 v[104:107], a[196:199], v[172:175], v[104:107]
  v_mfma_f32_16x16x32_bf16 v[108:111], a[200:203], v[172:175], v[108:111]
  s_waitcnt lgkmcnt(3)
  v_mfma_f32_16x16x32_bf16 v[112:115], a[192:195], v[176:179], v[112:115]
  ds_read_b128 v[160:163], v19 offset:0
  v_mfma_f32_16x16x32_bf16 v[116:119], a[196:199], v[176:179], v[116:119]
  s_add_u32 m0, s31, 66560
  v_mfma_f32_16x16x32_bf16 v[120:123], a[200:203], v[176:179], v[120:123]
  s_waitcnt lgkmcnt(3)
  buffer_load_dwordx4 v11, s[8:11], s30 offen lds
  v_mfma_f32_16x16x32_bf16 v[124:127], a[192:195], v[180:183], v[124:127]
  ds_read_b128 v[164:167], v19 offset:2048
  v_mfma_f32_16x16x32_bf16 v[128:131], a[196:199], v[180:183], v[128:131]
  v_mfma_f32_16x16x32_bf16 v[132:135], a[200:203], v[180:183], v[132:135]
  s_waitcnt lgkmcnt(3)
  v_mfma_f32_16x16x32_bf16 v[136:139], a[192:195], v[184:187], v[136:139]
  ds_read_b128 v[168:171], v19 offset:4096
  v_mfma_f32_16x16x32_bf16 v[140:143], a[196:199], v[184:187], v[140:143]
  v_mfma_f32_16x16x32_bf16 v[144:147], a[200:203], v[184:187], v[144:147]
  s_waitcnt lgkmcnt(3)
  v_mfma_f32_16x16x32_bf16 v[148:151], a[192:195], v[188:191], v[148:151]
  ds_read_b128 v[172:175], v19 offset:6144
  v_mfma_f32_16x16x32_bf16 v[152:155], a[196:199], v[188:191], v[152:155]
  v_mfma_f32_16x16x32_bf16 v[156:159], a[200:203], v[188:191], v[156:159]
  s_waitcnt lgkmcnt(3)
  v_mfma_f32_16x16x32_bf16 v[64:67], a[204:207], v[160:163], v[64:67]
  ds_read_b128 v[176:179], v19 offset:8192
  v_mfma_f32_16x16x32_bf16 v[68:71], a[208:211], v[160:163], v[68:71]
  s_add_u32 m0, s31, 67584
  v_mfma_f32_16x16x32_bf16 v[72:75], a[212:215], v[160:163], v[72:75]
  s_waitcnt lgkmcnt(3)
  buffer_load_dwordx4 v12, s[8:11], s30 offen lds
  v_mfma_f32_16x16x32_bf16 v[76:79], a[204:207], v[164:167], v[76:79]
  ds_read_b128 v[180:183], v19 offset:10240
  v_mfma_f32_16x16x32_bf16 v[80:83], a[208:211], v[164:167], v[80:83]
  v_mfma_f32_16x16x32_bf16 v[84:87], a[212:215], v[164:167], v[84:87]
  s_waitcnt lgkmcnt(3)
  v_mfma_f32_16x16x32_bf16 v[88:91], a[204:207], v[168:171], v[88:91]
  ds_read_b128 v[184:187], v19 offset:12288
  v_mfma_f32_16x16x32_bf16 v[92:95], a[208:211], v[168:171], v[92:95]
  v_mfma_f32_16x16x32_bf16 v[96:99], a[212:215], v[168:171], v[96:99]
  s_waitcnt lgkmcnt(3)
  v_mfma_f32_16x16x32_bf16 v[100:103], a[204:207], v[172:175], v[100:103]
  ds_read_b128 v[188:191], v19 offset:14336
  v_mfma_f32_16x16x32_bf16 v[104:107], a[208:211], v[172:175], v[104:107]
  v_mfma_f32_16x16x32_bf16 v[108:111], a[212:215], v[172:175], v[108:111]
  s_waitcnt lgkmcnt(3)
  v_mfma_f32_16x16x32_bf16 v[112:115], a[204:207], v[176:179], v[112:115]
  ds_read_b128 v[160:163], v18 offset:16384
  v_mfma_f32_16x16x32_bf16 v[116:119], a[208:211], v[176:179], v[116:119]
  s_add_u32 m0, s31, 68608
  v_mfma_f32_16x16x32_bf16 v[120:123], a[212:215], v[176:179], v[120:123]
  s_waitcnt lgkmcnt(3)
  buffer_load_dwordx4 v13, s[8:11], s30 offen lds
  v_mfma_f32_16x16x32_bf16 v[124:127], a[204:207], v[180:183], v[124:127]
  s_add_u32 s30, s30, 128
  ds_read_b128 v[164:167], v18 offset:18432
  v_mfma_f32_16x16x32_bf16 v[128:131], a[208:211], v[180:183], v[128:131]
  v_mfma_f32_16x16x32_bf16 v[132:135], a[212:215], v[180:183], v[132:135]
  s_waitcnt lgkmcnt(3)
  v_mfma_f32_16x16x32_bf16 v[136:139], a[204:207], v[184:187], v[136:139]
  ds_read_b128 v[168:171], v18 offset:20480
  v_mfma_f32_16x16x32_bf16 v[140:143], a[208:211], v[184:187], v[140:143]
  v_mfma_f32_16x16x32_bf16 v[144:147], a[212:215], v[184:187], v[144:147]
  s_waitcnt lgkmcnt(3)
  v_mfma_f32_16x16x32_bf16 v[148:151], a[204:207], v[188:191], v[148:151]
  ds_read_b128 v[172:175], v18 offset:22528
  v_mfma_f32_16x16x32_bf16 v[152:155], a[208:211], v[188:191], v[152:155]
  v_mfma_f32_16x16x32_bf16 v[156:159], a[212:215], v[188:191], v[156:159]
  s_waitcnt lgkmcnt(3)
  v_mfma_f32_16x16x32_bf16 v[64:67], a[216:219], v[160:163], v[64:67]
  ds_read_b128 v[176:179], v18 offset:24576
  v_mfma_f32_16x16x32_bf16 v[68:71], a[220:223], v[160:163], v[68:71]
  s_add_u32 m0, s31, 81920
  v_mfma_f32_16x16x32_bf16 v[72:75], a[224:227], v[160:163], v[72:75]
  s_waitcnt lgkmcnt(3)
  buffer_load_dwordx4 v10, s[8:11], s30 offen lds
  v_mfma_f32_16x16x32_bf16 v[76:79], a[216:219], v[164:167], v[76:79]
  ds_read_b128 v[180:183], v18 offset:26624
  v_mfma_f32_16x16x32_bf16 v[80:83], a[220:223], v[164:167], v[80:83]
  v_mfma_f32_16x16x32_bf16 v[84:87], a[224:227], v[164:167], v[84:87]
  s_waitcnt lgkmcnt(3)
  v_mfma_f32_16x16x32_bf16 v[88:91], a[216:219], v[168:171], v[88:91]
  ds_read_b128 v[184:187], v18 offset:28672
  v_mfma_f32_16x16x32_bf16 v[92:95], a[220:223], v[168:171], v[92:95]
  s_add_u32 m0, s31, 82944
  v_mfma_f32_16x16x32_bf16 v[96:99], a[224:227], v[168:171], v[96:99]
  s_waitcnt lgkmcnt(3)
  buffer_load_dwordx4 v11, s[8:11], s30 offen lds
  v_mfma_f32_16x16x32_bf16 v[100:103], a[216:219], v[172:175], v[100:103]
  ds_read_b128 v[188:191], v18 offset:30720
  v_mfma_f32_16x16x32_bf16 v[104:107], a[220:223], v[172:175], v[104:107]
  v_mfma_f32_16x16x32_bf16 v[108:111], a[224:227], v[172:175], v[108:111]
  s_waitcnt lgkmcnt(3)
  v_mfma_f32_16x16x32_bf16 v[112:115], a[216:219], v[176:179], v[112:115]
  ds_read_b128 v[160:163], v19 offset:16384
  v_mfma_f32_16x16x32_bf16 v[116:119], a[220:223], v[176:179], v[116:119]
  s_add_u32 m0, s31, 83968
  v_mfma_f32_16x16x32_bf16 v[120:123], a[224:227], v[176:179], v[120:123]
  s_waitcnt lgkmcnt(3)
  buffer_load_dwordx4 v12, s[8:11], s30 offen lds
  v_mfma_f32_16x16x32_bf16 v[124:127], a[216:219], v[180:183], v[124:127]
  ds_read_b128 v[164:167], v19 offset:18432
  v_mfma_f32_16x16x32_bf16 v[128:131], a[220:223], v[180:183], v[128:131]
  v_mfma_f32_16x16x32_bf16 v[132:135], a[224:227], v[180:183], v[132:135]
  s_waitcnt lgkmcnt(3)
  v_mfma_f32_16x16x32_bf16 v[136:139], a[216:219], v[184:187], v[136:139]
  ds_read_b128 v[168:171], v19 offset:20480
  v_mfma_f32_16x16x32_bf16 v[140:143], a[220:223], v[184:187], v[140:143]
  s_add_u32 m0, s31, 84992
  v_mfma_f32_16x16x32_bf16 v[144:147], a[224:227], v[184:187], v[144:147]
  s_waitcnt lgkmcnt(3)
  buffer_load_dwordx4 v13, s[8:11], s30 offen lds
  v_mfma_f32_16x16x32_bf16 v[148:151], a[216:219], v[188:191], v[148:151]
  s_add_u32 s30, s30, 128
  ds_read_b128 v[172:175], v19 offset:22528
  v_mfma_f32_16x16x32_bf16 v[152:155], a[220:223], v[188:191], v[152:155]
  v_mfma_f32_16x16x32_bf16 v[156:159], a[224:227], v[188:191], v[156:159]
  s_waitcnt lgkmcnt(3)
  v_mfma_f32_16x16x32_bf16 v[64:67], a[228:231], v[160:163], v[64:67]
  ds_read_b128 v[176:179], v19 offset:24576
  v_mfma_f32_16x16x32_bf16 v[68:71], a[232:235], v[160:163], v[68:71]
  v_mfma_f32_16x16x32_bf16 v[72:75], a[236:239], v[160:163], v[72:75]
  s_waitcnt lgkmcnt(3)
  v_mfma_f32_16x16x32_bf16 v[76:79], a[228:231], v[164:167], v[76:79]
  ds_read_b128 v[180:183], v19 offset:26624
  v_cvt_pk_bf16_f32 v192, v64, v65
  v_mfma_f32_16x16x32_bf16 v[80:83], a[232:235], v[164:167], v[80:83]
  v_cvt_pk_bf16_f32 v193, v66, v67
  v_cvt_pk_bf16_f32 v194, v68, v69
  v_mfma_f32_16x16x32_bf16 v[84:87], a[236:239], v[164:167], v[84:87]
  s_waitcnt lgkmcnt(3)
  v_cvt_pk_bf16_f32 v195, v70, v71
  v_cvt_pk_bf16_f32 v200, v72, v73
  v_mfma_f32_16x16x32_bf16 v[88:91], a[228:231], v[168:171], v[88:91]
  ds_read_b128 v[184:187], v19 offset:28672
  v_cvt_pk_bf16_f32 v201, v74, v75
  v_mfma_f32_16x16x32_bf16 v[92:95], a[232:235], v[168:171], v[92:95]
  v_cvt_pk_bf16_f32 v196, v76, v77
  v_cvt_pk_bf16_f32 v197, v78, v79
  v_mfma_f32_16x16x32_bf16 v[96:99], a[236:239], v[168:171], v[96:99]
  s_waitcnt lgkmcnt(3)
  v_cvt_pk_bf16_f32 v198, v80, v81
  v_cvt_pk_bf16_f32 v199, v82, v83
  v_mfma_f32_16x16x32_bf16 v[100:103], a[228:231], v[172:175], v[100:103]
  ds_read_b128 v[188:191], v19 offset:30720
  v_cvt_pk_bf16_f32 v202, v84, v85
  v_mfma_f32_16x16x32_bf16 v[104:107], a[232:235], v[172:175], v[104:107]
  v_cvt_pk_bf16_f32 v203, v86, v87
  v_cvt_pk_bf16_f32 v204, v88, v89
  v_mfma_f32_16x16x32_bf16 v[108:111], a[236:239], v[172:175], v[108:111]
  s_waitcnt lgkmcnt(3)
  v_cvt_pk_bf16_f32 v205, v90, v91
  v_cvt_pk_bf16_f32 v206, v92, v93
  v_mfma_f32_16x16x32_bf16 v[112:115], a[228:231], v[176:179], v[112:115]
  s_waitcnt vmcnt(17)
  s_barrier
  ds_read_b128 v[160:163], v14 offset:0
  v_mfma_f32_16x16x32_bf16 v[116:119], a[232:235], v[176:179], v[116:119]
  v_cvt_pk_bf16_f32 v207, v94, v95
  v_cvt_pk_bf16_f32 v212, v96, v97
  v_mfma_f32_16x16x32_bf16 v[120:123], a[236:239], v[176:179], v[120:123]
  s_waitcnt lgkmcnt(3)
  v_cvt_pk_bf16_f32 v213, v98, v99
  v_cvt_pk_bf16_f32 v208, v100, v101
  v_mfma_f32_16x16x32_bf16 v[124:127], a[228:231], v[180:183], v[124:127]
  ds_read_b128 v[164:167], v14 offset:2048
  v_cvt_pk_bf16_f32 v209, v102, v103
  v_mfma_f32_16x16x32_bf16 v[128:131], a[232:235], v[180:183], v[128:131]
  v_cvt_pk_bf16_f32 v210, v104, v105
  v_cvt_pk_bf16_f32 v211, v106, v107
  v_mfma_f32_16x16x32_bf16 v[132:135], a[236:239], v[180:183], v[132:135]
  s_waitcnt lgkmcnt(3)
  v_cvt_pk_bf16_f32 v214, v108, v109
  v_cvt_pk_bf16_f32 v215, v110, v111
  v_mfma_f32_16x16x32_bf16 v[136:139], a[228:231], v[184:187], v[136:139]
  ds_read_b128 v[168:171], v14 offset:4096
  v_cvt_pk_bf16_f32 v216, v112, v113
  v_mfma_f32_16x16x32_bf16 v[140:143], a[232:235], v[184:187], v[140:143]
  v_cvt_pk_bf16_f32 v217, v114, v115
  v_cvt_pk_bf16_f32 v218, v116, v117
  v_mfma_f32_16x16x32_bf16 v[144:147], a[236:239], v[184:187], v[144:147]
  s_waitcnt lgkmcnt(3)
  v_cvt_pk_bf16_f32 v219, v118, v119
  v_cvt_pk_bf16_f32 v224, v120, v121
  v_mfma_f32_16x16x32_bf16 v[148:151], a[228:231], v[188:191], v[148:151]
  ds_read_b128 v[172:175], v14 offset:6144
  v_cvt_pk_bf16_f32 v225, v122, v123
  v_mfma_f32_16x16x32_bf16 v[152:155], a[232:235], v[188:191], v[152:155]
  s_sub_u32 s26, s26, 1
  s_cmp_gt_u32 s26, 0
  v_cvt_pk_bf16_f32 v220, v124, v125
  v_mfma_f32_16x16x32_bf16 v[156:159], a[236:239], v[188:191], v[156:159]
  s_waitcnt lgkmcnt(3)
  s_cbranch_scc1 kvs_241
  s_nop 7
  v_cvt_pk_bf16_f32 v221, v126, v127
  v_cvt_pk_bf16_f32 v222, v128, v129
  v_cvt_pk_bf16_f32 v223, v130, v131
  v_cvt_pk_bf16_f32 v226, v132, v133
  v_cvt_pk_bf16_f32 v227, v134, v135
  v_cvt_pk_bf16_f32 v228, v136, v137
  v_cvt_pk_bf16_f32 v229, v138, v139
  v_cvt_pk_bf16_f32 v230, v140, v141
  v_cvt_pk_bf16_f32 v231, v142, v143
  v_cvt_pk_bf16_f32 v236, v144, v145
  v_cvt_pk_bf16_f32 v237, v146, v147
  v_cvt_pk_bf16_f32 v232, v148, v149
  v_cvt_pk_bf16_f32 v233, v150, v151
  v_cvt_pk_bf16_f32 v234, v152, v153
  v_cvt_pk_bf16_f32 v235, v154, v155
  v_cvt_pk_bf16_f32 v238, v156, v157
  v_cvt_pk_bf16_f32 v239, v158, v159
  s_xor_b32 s29, s48, 0
  buffer_store_dwordx4 v[192:195], v26, s[16:19], s29 offen offset:0 sc1
  buffer_store_dwordx4 v[196:199], v26, s[16:19], s29 offen offset:1024 sc1
  buffer_store_dwordx4 v[200:203], v26, s[16:19], s29 offen offset:2048 sc1
  s_xor_b32 s29, s48, 2105344
  buffer_store_dwordx4 v[204:207], v26, s[16:19], s29 offen offset:0 sc1
  buffer_store_dwordx4 v[208:211], v26, s[16:19], s29 offen offset:1024 sc1
  buffer_store_dwordx4 v[212:215], v26, s[16:19], s29 offen offset:2048 sc1
  s_xor_b32 s29, s48, 4194304
  buffer_store_dwordx4 v[216:219], v26, s[16:19], s29 offen offset:0 sc1
  buffer_store_dwordx4 v[220:223], v26, s[16:19], s29 offen offset:1024 sc1
  buffer_store_dwordx4 v[224:227], v26, s[16:19], s29 offen offset:2048 sc1
  s_xor_b32 s29, s48, 6299648
  buffer_store_dwordx4 v[228:231], v26, s[16:19], s29 offen offset:0 sc1
  buffer_store_dwordx4 v[232:235], v26, s[16:19], s29 offen offset:1024 sc1
  buffer_store_dwordx4 v[236:239], v26, s[16:19], s29 offen offset:2048 sc1
  s_waitcnt vmcnt(0) lgkmcnt(0)
  s_barrier
  buffer_atomic_add v28, v27, s[72:75], s61 offen sc1
  s_branch wp_247
wp_243:
  buffer_load_dword v32, v20, s[64:67], s68 offen
  s_add_u32 s68, s68, 258048
  s_branch wp_243r
wp_244:
  buffer_load_dword v32, v20, s[64:67], s68 offen
  s_add_u32 s68, s68, 258048
  s_branch wp_244r
wp_245:
  buffer_load_dword v32, v20, s[64:67], s68 offen
  s_add_u32 s68, s68, 258048
  s_branch wp_245r
wp_246:
  buffer_load_dword v32, v20, s[64:67], s68 offen
  s_add_u32 s68, s68, 258048
  s_branch wp_246r
wp_247:
  s_bitcmp1_b32 s3, 0
  s_cbranch_scc1 queue
  s_lshr_b32 s2, s3, 1
  s_mov_b32 s40, 10
  s_mov_b32 s41, 6
  s_waitcnt vmcnt(0)
  s_barrier
  s_branch q_entry
  s_branch queue
not_kv:
  s_cmp_ge_u32 s3, 96
  s_cbranch_scc1 not_vw
  s_sub_u32 s2, s3, 64
  s_load_dwordx2 s[6:7], s[0:1], 40
  s_load_dwordx2 s[38:39], s[0:1], 104
  v_lshlrev_b32 v4, 4, v1
  s_waitcnt lgkmcnt(0)
  s_mov_b32 s12, s6
  s_mov_b32 s13, s7
  s_mov_b32 s14, 7864320
  s_mov_b32 s15, 0x00020000
  s_mov_b32 s16, s38
  s_mov_b32 s17, s39
  s_mov_b32 s18, 218103808
  s_mov_b32 s19, 0x00020000
  s_add_u32 s72, s38, 173080576
  s_addc_u32 s73, s39, 0
  s_mov_b32 s74, 49152
  s_mov_b32 s75, 0x00020000
  s_mul_i32 s40, s2, 245760
  s_mul_i32 s22, s20, 30720
  s_add_u32 s40, s40, s22
  s_add_u32 m0, s22, 0
  s_add_u32 s21, s40, 0
  buffer_load_dwordx4 v4, s[12:15], s21 offen offset:0 lds
  buffer_load_dwordx4 v4, s[12:15], s21 offen offset:1024 lds
  buffer_load_dwordx4 v4, s[12:15], s21 offen offset:2048 lds
  buffer_load_dwordx4 v4, s[12:15], s21 offen offset:3072 lds
  s_add_u32 m0, s22, 4096
  s_add_u32 s21, s40, 4096
  buffer_load_dwordx4 v4, s[12:15], s21 offen offset:0 lds
  buffer_load_dwordx4 v4, s[12:15], s21 offen offset:1024 lds
  buffer_load_dwordx4 v4, s[12:15], s21 offen offset:2048 lds
  buffer_load_dwordx4 v4, s[12:15], s21 offen offset:3072 lds
  s_add_u32 m0, s22, 8192
  s_add_u32 s21, s40, 8192
  buffer_load_dwordx4 v4, s[12:15], s21 offen offset:0 lds
  buffer_load_dwordx4 v4, s[12:15], s21 offen offset:1024 lds
  buffer_load_dwordx4 v4, s[12:15], s21 offen offset:2048 lds
  buffer_load_dwordx4 v4, s[12:15], s21 offen offset:3072 lds
  s_add_u32 m0, s22, 12288
  s_add_u32 s21, s40, 12288
  buffer_load_dwordx4 v4, s[12:15], s21 offen offset:0 lds
  buffer_load_dwordx4 v4, s[12:15], s21 offen offset:1024 lds
  buffer_load_dwordx4 v4, s[12:15], s21 offen offset:2048 lds
  buffer_load_dwordx4 v4, s[12:15], s21 offen offset:3072 lds
  s_add_u32 m0, s22, 16384
  s_add_u32 s21, s40, 16384
  buffer_load_dwordx4 v4, s[12:15], s21 offen offset:0 lds
  buffer_load_dwordx4 v4, s[12:15], s21 offen offset:1024 lds
  buffer_load_dwordx4 v4, s[12:15], s21 offen offset:2048 lds
  buffer_load_dwordx4 v4, s[12:15], s21 offen offset:3072 lds
  s_add_u32 m0, s22, 20480
  s_add_u32 s21, s40, 20480
  buffer_load_dwordx4 v4, s[12:15], s21 offen offset:0 lds
  buffer_load_dwordx4 v4, s[12:15], s21 offen offset:1024 lds
  buffer_load_dwordx4 v4, s[12:15], s21 offen offset:2048 lds
  buffer_load_dwordx4 v4, s[12:15], s21 offen offset:3072 lds
  s_add_u32 m0, s22, 24576
  s_add_u32 s21, s40, 24576
  buffer_load_dwordx4 v4, s[12:15], s21 offen offset:0 lds
  buffer_load_dwordx4 v4, s[12:15], s21 offen offset:1024 lds
  buffer_load_dwordx4 v4, s[12:15], s21 offen offset:2048 lds
  buffer_load_dwordx4 v4, s[12:15], s21 offen offset:3072 lds
  s_add_u32 m0, s22, 28672
  s_add_u32 s21, s40, 28672
  buffer_load_dwordx4 v4, s[12:15], s21 offen offset:0 lds
  buffer_load_dwordx4 v4, s[12:15], s21 offen offset:1024 lds
  s_add_u32 s21, s40, 122880
  buffer_load_dwordx4 v[64:67], v4, s[12:15], s21 offen offset:0
  buffer_load_dwordx4 v[68:71], v4, s[12:15], s21 offen offset:1024
  buffer_load_dwordx4 v[72:75], v4, s[12:15], s21 offen offset:2048
  buffer_load_dwordx4 v[76:79], v4, s[12:15], s21 offen offset:3072
  s_add_u32 s21, s40, 126976
  buffer_load_dwordx4 v[80:83], v4, s[12:15], s21 offen offset:0
  buffer_load_dwordx4 v[84:87], v4, s[12:15], s21 offen offset:1024
  buffer_load_dwordx4 v[88:91], v4, s[12:15], s21 offen offset:2048
  buffer_load_dwordx4 v[92:95], v4, s[12:15], s21 offen offset:3072
  s_add_u32 s21, s40, 131072
  buffer_load_dwordx4 v[96:99], v4, s[12:15], s21 offen offset:0
  buffer_load_dwordx4 v[100:103], v4, s[12:15], s21 offen offset:1024
  buffer_load_dwordx4 v[104:107], v4, s[12:15], s21 offen offset:2048
  buffer_load_dwordx4 v[108:111], v4, s[12:15], s21 offen offset:3072
  s_add_u32 s21, s40, 135168
  buffer_load_dwordx4 v[112:115], v4, s[12:15], s21 offen offset:0
  buffer_load_dwordx4 v[116:119], v4, s[12:15], s21 offen offset:1024
  buffer_load_dwordx4 v[120:123], v4, s[12:15], s21 offen offset:2048
  buffer_load_dwordx4 v[124:127], v4, s[12:15], s21 offen offset:3072
  s_add_u32 s21, s40, 139264
  buffer_load_dwordx4 v[128:131], v4, s[12:15], s21 offen offset:0
  buffer_load_dwordx4 v[132:135], v4, s[12:15], s21 offen offset:1024
  buffer_load_dwordx4 v[136:139], v4, s[12:15], s21 offen offset:2048
  buffer_load_dwordx4 v[140:143], v4, s[12:15], s21 offen offset:3072
  s_add_u32 s21, s40, 143360
  buffer_load_dwordx4 v[144:147], v4, s[12:15], s21 offen offset:0
  buffer_load_dwordx4 v[148:151], v4, s[12:15], s21 offen offset:1024
  buffer_load_dwordx4 v[152:155], v4, s[12:15], s21 offen offset:2048
  buffer_load_dwordx4 v[156:159], v4, s[12:15], s21 offen offset:3072
  s_add_u32 s21, s40, 147456
  buffer_load_dwordx4 v[160:163], v4, s[12:15], s21 offen offset:0
  buffer_load_dwordx4 v[164:167], v4, s[12:15], s21 offen offset:1024
  buffer_load_dwordx4 v[168:171], v4, s[12:15], s21 offen offset:2048
  buffer_load_dwordx4 v[172:175], v4, s[12:15], s21 offen offset:3072
  s_add_u32 s21, s40, 151552
  buffer_load_dwordx4 v[176:179], v4, s[12:15], s21 offen offset:0
  buffer_load_dwordx4 v[180:183], v4, s[12:15], s21 offen offset:1024
  v_lshrrev_b32 v6, 2, v2
  v_lshl_add_u32 v6, v3, 2, v6
  v_mul_u32_u24 v6, 1280, v6
  v_and_b32 v7, 3, v2
  v_lshlrev_b32 v7, 3, v7
  s_mul_i32 s21, s20, 320
  v_add3_u32 v6, v6, v7, s21
  v_add_u32 v8, v6, v7
  v_add_u32 v7, 61440, v6
  v_add_u32 v9, 61440, v8
  v_add_u32 v5, s22, v4
  s_waitcnt vmcnt(30)
  s_load_dwordx2 s[24:25], s[0:1], 16
  v_lshlrev_b32 v200, 7, v1
  s_lshl_b32 s23, s2, 2
  s_add_u32 s23, s23, s20
  s_mul_i32 s23, s23, 61440
  s_add_u32 s23, s23, 0
  s_waitcnt lgkmcnt(0)
  s_mov_b32 s24, s24
  s_mov_b32 s25, s25
  s_mov_b32 s26, 7864320
  s_mov_b32 s27, 0x00020000
  buffer_load_dword v201, v200, s[24:27], s23 offen
  s_add_u32 s23, s23, 8192
  buffer_load_dword v201, v200, s[24:27], s23 offen
  s_add_u32 s23, s23, 8192
  buffer_load_dword v201, v200, s[24:27], s23 offen
  s_add_u32 s23, s23, 8192
  buffer_load_dword v201, v200, s[24:27], s23 offen
  s_add_u32 s23, s23, 8192
  buffer_load_dword v201, v200, s[24:27], s23 offen
  s_add_u32 s23, s23, 8192
  buffer_load_dword v201, v200, s[24:27], s23 offen
  s_add_u32 s23, s23, 8192
  buffer_load_dword v201, v200, s[24:27], s23 offen
  s_add_u32 s23, s23, 8192
  buffer_load_dword v201, v200, s[24:27], s23 offen
  s_add_u32 s23, s23, 8192
  s_barrier
  ds_read_b64_tr_b16 a[0:1], v8 offset:0
  ds_read_b64_tr_b16 a[2:3], v8 offset:20480
  ds_read_b64_tr_b16 a[24:25], v8 offset:8
  ds_read_b64_tr_b16 a[26:27], v8 offset:20488
  ds_read_b64_tr_b16 a[48:49], v6 offset:64
  ds_read_b64_tr_b16 a[50:51], v6 offset:20544
  ds_read_b64_tr_b16 a[72:73], v8 offset:96
  ds_read_b64_tr_b16 a[74:75], v8 offset:20576
  ds_read_b64_tr_b16 a[96:97], v8 offset:104
  ds_read_b64_tr_b16 a[98:99], v8 offset:20584
  ds_read_b64_tr_b16 a[120:121], v8 offset:160
  ds_read_b64_tr_b16 a[122:123], v8 offset:20640
  ds_read_b64_tr_b16 a[144:145], v8 offset:168
  ds_read_b64_tr_b16 a[146:147], v8 offset:20648
  ds_read_b64_tr_b16 a[168:169], v6 offset:224
  ds_read_b64_tr_b16 a[170:171], v6 offset:20704
  ds_read_b64_tr_b16 a[192:193], v8 offset:256
  ds_read_b64_tr_b16 a[194:195], v8 offset:20736
  ds_read_b64_tr_b16 a[216:217], v8 offset:264
  ds_read_b64_tr_b16 a[218:219], v8 offset:20744
  ds_read_b64_tr_b16 a[4:5], v9 offset:0
  ds_read_b64_tr_b16 a[6:7], v9 offset:20480
  ds_read_b64_tr_b16 a[28:29], v9 offset:8
  ds_read_b64_tr_b16 a[30:31], v9 offset:20488
  ds_read_b64_tr_b16 a[52:53], v7 offset:64
  ds_read_b64_tr_b16 a[54:55], v7 offset:20544
  ds_read_b64_tr_b16 a[76:77], v9 offset:96
  ds_read_b64_tr_b16 a[78:79], v9 offset:20576
  ds_read_b64_tr_b16 a[100:101], v9 offset:104
  ds_read_b64_tr_b16 a[102:103], v9 offset:20584
  ds_read_b64_tr_b16 a[124:125], v9 offset:160
  ds_read_b64_tr_b16 a[126:127], v9 offset:20640
  ds_read_b64_tr_b16 a[148:149], v9 offset:168
  ds_read_b64_tr_b16 a[150:151], v9 offset:20648
  ds_read_b64_tr_b16 a[172:173], v7 offset:224
  ds_read_b64_tr_b16 a[174:175], v7 offset:20704
  ds_read_b64_tr_b16 a[196:197], v9 offset:256
  ds_read_b64_tr_b16 a[198:199], v9 offset:20736
  ds_read_b64_tr_b16 a[220:221], v9 offset:264
  ds_read_b64_tr_b16 a[222:223], v9 offset:20744
  ds_read_b64_tr_b16 a[8:9], v8 offset:40960
  ds_read_b64_tr_b16 a[10:11], v9 offset:40960
  ds_read_b64_tr_b16 a[32:33], v8 offset:40968
  ds_read_b64_tr_b16 a[34:35], v9 offset:40968
  ds_read_b64_tr_b16 a[56:57], v6 offset:41024
  ds_read_b64_tr_b16 a[58:59], v7 offset:41024
  ds_read_b64_tr_b16 a[80:81], v8 offset:41056
  ds_read_b64_tr_b16 a[82:83], v9 offset:41056
  ds_read_b64_tr_b16 a[104:105], v8 offset:41064
  ds_read_b64_tr_b16 a[106:107], v9 offset:41064
  ds_read_b64_tr_b16 a[128:129], v8 offset:41120
  ds_read_b64_tr_b16 a[130:131], v9 offset:41120
  ds_read_b64_tr_b16 a[152:153], v8 offset:41128
  ds_read_b64_tr_b16 a[154:155], v9 offset:41128
  ds_read_b64_tr_b16 a[176:177], v6 offset:41184
  ds_read_b64_tr_b16 a[178:179], v7 offset:41184
  ds_read_b64_tr_b16 a[200:201], v8 offset:41216
  ds_read_b64_tr_b16 a[202:203], v9 offset:41216
  ds_read_b64_tr_b16 a[224:225], v8 offset:41224
  ds_read_b64_tr_b16 a[226:227], v9 offset:41224
  s_waitcnt lgkmcnt(0)
  s_barrier
  s_waitcnt vmcnt(8)
  ds_write_b128 v5, v[64:67] offset:0
  ds_write_b128 v5, v[68:71] offset:1024
  ds_write_b128 v5, v[72:75] offset:2048
  ds_write_b128 v5, v[76:79] offset:3072
  ds_write_b128 v5, v[80:83] offset:4096
  ds_write_b128 v5, v[84:87] offset:5120
  ds_write_b128 v5, v[88:91] offset:6144
  ds_write_b128 v5, v[92:95] offset:7168
  ds_write_b128 v5, v[96:99] offset:8192
  ds_write_b128 v5, v[100:103] offset:9216
  ds_write_b128 v5, v[104:107] offset:10240
  ds_write_b128 v5, v[108:111] offset:11264
  ds_write_b128 v5, v[112:115] offset:12288
  ds_write_b128 v5, v[116:119] offset:13312
  ds_write_b128 v5, v[120:123] offset:14336
  ds_write_b128 v5, v[124:127] offset:15360
  ds_write_b128 v5, v[128:131] offset:16384
  ds_write_b128 v5, v[132:135] offset:17408
  ds_write_b128 v5, v[136:139] offset:18432
  ds_write_b128 v5, v[140:143] offset:19456
  ds_write_b128 v5, v[144:147] offset:20480
  ds_write_b128 v5, v[148:151] offset:21504
  ds_write_b128 v5, v[152:155] offset:22528
  ds_write_b128 v5, v[156:159] offset:23552
  ds_write_b128 v5, v[160:163] offset:24576
  ds_write_b128 v5, v[164:167] offset:25600
  ds_write_b128 v5, v[168:171] offset:26624
  ds_write_b128 v5, v[172:175] offset:27648
  ds_write_b128 v5, v[176:179] offset:28672
  ds_write_b128 v5, v[180:183] offset:29696
  s_waitcnt lgkmcnt(0)
  s_barrier
  ds_read_b64_tr_b16 a[12:13], v8 offset:0
  ds_read_b64_tr_b16 a[14:15], v8 offset:20480
  ds_read_b64_tr_b16 a[36:37], v8 offset:8
  ds_read_b64_tr_b16 a[38:39], v8 offset:20488
  ds_read_b64_tr_b16 a[60:61], v6 offset:64
  ds_read_b64_tr_b16 a[62:63], v6 offset:20544
  ds_read_b64_tr_b16 a[84:85], v8 offset:96
  ds_read_b64_tr_b16 a[86:87], v8 offset:20576
  ds_read_b64_tr_b16 a[108:109], v8 offset:104
  ds_read_b64_tr_b16 a[110:111], v8 offset:20584
  ds_read_b64_tr_b16 a[132:133], v8 offset:160
  ds_read_b64_tr_b16 a[134:135], v8 offset:20640
  ds_read_b64_tr_b16 a[156:157], v8 offset:168
  ds_read_b64_tr_b16 a[158:159], v8 offset:20648
  ds_read_b64_tr_b16 a[180:181], v6 offset:224
  ds_read_b64_tr_b16 a[182:183], v6 offset:20704
  ds_read_b64_tr_b16 a[204:205], v8 offset:256
  ds_read_b64_tr_b16 a[206:207], v8 offset:20736
  ds_read_b64_tr_b16 a[228:229], v8 offset:264
  ds_read_b64_tr_b16 a[230:231], v8 offset:20744
  ds_read_b64_tr_b16 a[16:17], v9 offset:0
  ds_read_b64_tr_b16 a[18:19], v9 offset:20480
  ds_read_b64_tr_b16 a[40:41], v9 offset:8
  ds_read_b64_tr_b16 a[42:43], v9 offset:20488
  ds_read_b64_tr_b16 a[64:65], v7 offset:64
  ds_read_b64_tr_b16 a[66:67], v7 offset:20544
  ds_read_b64_tr_b16 a[88:89], v9 offset:96
  ds_read_b64_tr_b16 a[90:91], v9 offset:20576
  ds_read_b64_tr_b16 a[112:113], v9 offset:104
  ds_read_b64_tr_b16 a[114:115], v9 offset:20584
  ds_read_b64_tr_b16 a[136:137], v9 offset:160
  ds_read_b64_tr_b16 a[138:139], v9 offset:20640
  ds_read_b64_tr_b16 a[160:161], v9 offset:168
  ds_read_b64_tr_b16 a[162:163], v9 offset:20648
  ds_read_b64_tr_b16 a[184:185], v7 offset:224
  ds_read_b64_tr_b16 a[186:187], v7 offset:20704
  ds_read_b64_tr_b16 a[208:209], v9 offset:256
  ds_read_b64_tr_b16 a[210:211], v9 offset:20736
  ds_read_b64_tr_b16 a[232:233], v9 offset:264
  ds_read_b64_tr_b16 a[234:235], v9 offset:20744
  ds_read_b64_tr_b16 a[20:21], v8 offset:40960
  ds_read_b64_tr_b16 a[22:23], v9 offset:40960
  ds_read_b64_tr_b16 a[44:45], v8 offset:40968
  ds_read_b64_tr_b16 a[46:47], v9 offset:40968
  ds_read_b64_tr_b16 a[68:69], v6 offset:41024
  ds_read_b64_tr_b16 a[70:71], v7 offset:41024
  ds_read_b64_tr_b16 a[92:93], v8 offset:41056
  ds_read_b64_tr_b16 a[94:95], v9 offset:41056
  ds_read_b64_tr_b16 a[116:117], v8 offset:41064
  ds_read_b64_tr_b16 a[118:119], v9 offset:41064
  ds_read_b64_tr_b16 a[140:141], v8 offset:41120
  ds_read_b64_tr_b16 a[142:143], v9 offset:41120
  ds_read_b64_tr_b16 a[164:165], v8 offset:41128
  ds_read_b64_tr_b16 a[166:167], v9 offset:41128
  ds_read_b64_tr_b16 a[188:189], v6 offset:41184
  ds_read_b64_tr_b16 a[190:191], v7 offset:41184
  ds_read_b64_tr_b16 a[212:213], v8 offset:41216
  ds_read_b64_tr_b16 a[214:215], v9 offset:41216
  ds_read_b64_tr_b16 a[236:237], v8 offset:41224
  ds_read_b64_tr_b16 a[238:239], v9 offset:41224
  s_waitcnt lgkmcnt(0)
  s_barrier
  s_load_dwordx2 s[32:33], s[0:1], 96
  s_waitcnt lgkmcnt(0)
  s_mov_b32 s32, s32
  s_mov_b32 s33, s33
  s_mov_b32 s34, 256
  s_mov_b32 s35, 0x00020000
  s_mov_b32 s21, 76
  v_mov_b32 v4, 0
  s_mov_b32 s101, 0
wf_248:
  buffer_load_dword v5, v4, s[32:35], s21 offen sc1
  s_add_u32 s101, s101, 1
  s_cmp_gt_u32 s101, 131072
  s_cbranch_scc1 main_end
  s_waitcnt vmcnt(0)
  v_readfirstlane_b32 s100, v5
  s_cmp_ge_u32 s100, 1
  s_cbranch_scc1 wf_249
  s_sleep 8
  s_branch wf_248
wf_249:
  s_sub_u32 s80, s100, 1
  s_lshl_b32 s80, s80, 13
  s_lshl_b32 s40, s2, 2
  s_add_u32 s40, s40, s20
  s_lshl_b32 s40, s40, 14
  s_xor_b32 s40, s40, s80
  s_xor_b32 s40, s40, 8192
  s_mul_i32 s47, s20, 3072
  s_lshr_b32 s43, s2, 2
  s_lshl_b32 s43, s43, 7
  s_add_u32 s43, s43, 28672
  s_xor_b32 s43, s43, s80
  s_lshl_b32 s44, s2, 7
  s_lshl_b32 s21, s20, 2
  s_add_u32 s44, s44, s21
  s_add_u32 s44, s44, 4096
  s_xor_b32 s44, s44, s80
  s_lshl_b32 s49, s20, 8
  s_add_u32 s49, s49, 12288
  s_mov_b32 s45, 0
  v_lshlrev_b32 v4, 4, v1
  v_min_u32 v14, 18, v1
  v_lshlrev_b32 v14, 2, v14
  v_mov_b32 v17, 1073741824
  v_cmp_eq_u32 vcc, 0, v1
  s_nop 1
  v_cndmask_b32 v17, v17, 0, vcc
  v_mov_b32 v16, 0
  v_mov_b32 v18, 65536
vwr_250:
  s_cmp_lg_u32 s20, 0
  s_cbranch_scc1 vwr_253
  s_mov_b32 s101, 0
  s_branch vwr_252
vwr_251:
  s_cmp_lg_u32 s101, 1
  s_cbranch_scc1 vwr_254
  buffer_store_dword v16, v17, s[72:75], s44 offen sc1
vwr_254:
  s_sleep 4
vwr_252:
  buffer_load_dword v15, v14, s[72:75], s43 offen sc1
  s_add_u32 s101, s101, 1
  s_cmp_gt_u32 s101, 131072
  s_cbranch_scc1 main_end
  s_waitcnt vmcnt(0)
  v_cmp_le_u32 vcc, 8, v15
  s_nop 1
  s_ff0_i32_b32 s21, vcc_lo
  s_min_u32 s21, s21, 19
  s_lshl_b32 s22, s21, 1
  s_lshl_b32 s21, s21, 2
  s_sub_i32 s21, s21, 12
  s_max_i32 s46, s21, s22
  s_cmp_le_u32 s46, s45
  s_cbranch_scc1 vwr_251
  v_mov_b32 v15, s46
  ds_write_b32 v18, v15
  s_waitcnt lgkmcnt(0)
  s_barrier
  s_branch vwr_255
vwr_253:
  s_waitcnt vmcnt(0)
  buffer_store_dword v16, v17, s[72:75], s44 offen sc1
  s_barrier
  ds_read_b32 v15, v18
  s_waitcnt lgkmcnt(0)
  v_readfirstlane_b32 s46, v15
vwr_255:
  s_and_b32 s50, s45, 2
  s_lshl_b32 s50, s50, 14
  v_add_u32 v10, s50, v4
  v_add_u32 v11, 2048, v10
  v_add_u32 v12, 2056, v10
  v_lshlrev_b32 v13, 2, v1
  s_lshl_b32 s41, s45, 21
  s_add_u32 s41, s41, s40
  s_mov_b32 s48, s45
  s_mov_b32 s56, s41
  s_add_u32 s57, s56, 4096
  s_lshl_b32 s58, s45, 19
  s_lshl_b32 s21, s45, 11
  s_and_b32 s21, s21, 8192
  s_xor_b32 s21, s21, s80
  s_add_u32 s58, s58, s21
  s_add_u32 s58, s58, 136314880
  s_lshl_b32 s21, s2, 14
  s_lshl_b32 s22, s20, 11
  s_add_u32 s21, s21, s22
  s_add_u32 s58, s58, s21
  s_and_b32 s21, s2, 28
  s_add_u32 s21, s21, s20
  s_lshl_b32 s21, s21, 16
  s_and_b32 s22, s2, 3
  s_lshl_b32 s22, s22, 10
  s_add_u32 s21, s21, s22
  s_lshl_b32 s60, s45, 21
  s_add_u32 s60, s60, s21
  s_add_u32 s60, s60, s80
  s_add_u32 s60, s60, -2093056
  s_xor_b32 s60, s60, 8192
  s_mov_b32 s51, 1073741824
  s_mov_b32 s59, 1073741824
  s_mov_b32 s52, s50
  s_cmp_lt_u32 s48, s46
  s_cselect_b32 s53, s41, 1073741824
  s_add_u32 s54, s52, 0
  s_add_u32 m0, s54, s47
  s_nop 0
  buffer_load_dwordx4 v4, s[16:19], s53 offen offset:0 sc1 lds
  buffer_load_dwordx4 v4, s[16:19], s53 offen offset:1024 sc1 lds
  buffer_load_dwordx4 v4, s[16:19], s53 offen offset:2048 sc1 lds
  s_add_u32 s41, s41, 2097152
  s_xor_b32 s41, s41, 8192
  s_add_u32 s48, s48, 1
  s_cmp_lt_u32 s48, s46
  s_cselect_b32 s53, s41, 1073741824
  s_add_u32 s54, s52, 16384
  s_add_u32 m0, s54, s47
  s_nop 0
  buffer_load_dwordx4 v4, s[16:19], s53 offen offset:0 sc1 lds
  buffer_load_dwordx4 v4, s[16:19], s53 offen offset:1024 sc1 lds
  buffer_load_dwordx4 v4, s[16:19], s53 offen offset:2048 sc1 lds
  s_add_u32 s41, s41, 2097152
  s_xor_b32 s41, s41, 8192
  s_add_u32 s48, s48, 1
  s_xor_b32 s52, s52, 32768
  s_waitcnt vmcnt(3)
  s_barrier
  ds_read_b128 v[64:67], v10 offset:0
  ds_read_b128 v[88:91], v10 offset:1024
  ds_read_b128 v[68:71], v10 offset:3072
  ds_read_b128 v[92:95], v10 offset:4096
  ds_read2st64_b64 v[72:75], v11 offset0:0 offset1:6
  ds_read2st64_b64 v[96:99], v12 offset0:0 offset1:6
  ds_read_b128 v[76:79], v10 offset:6144
  ds_read_b128 v[100:103], v10 offset:7168
  ds_read_b128 v[80:83], v10 offset:9216
  ds_read_b128 v[104:107], v10 offset:10240
  ds_read2st64_b64 v[84:87], v11 offset0:12 offset1:18
  ds_read2st64_b64 v[108:111], v12 offset0:12 offset1:18
  buffer_store_dword v16, v17, s[72:75], s44 offen sc1
  s_waitcnt lgkmcnt(0)
  .p2align 3
vwl_256:
  v_mfma_f32_16x16x32_bf16 v[160:163], v[64:67], a[0:3], 0
  v_mfma_f32_16x16x32_bf16 v[164:167], v[88:91], a[0:3], 0
  v_mfma_f32_16x16x32_bf16 v[160:163], v[68:71], a[4:7], v[160:163]
  v_cvt_pk_bf16_f32 v204, v184, v185
  v_cvt_pk_bf16_f32 v205, v186, v187
  v_mfma_f32_16x16x32_bf16 v[164:167], v[92:95], a[4:7], v[164:167]
  s_add_u32 s60, s60, 2097152
  v_cvt_pk_bf16_f32 v206, v188, v189
  v_cvt_pk_bf16_f32 v207, v190, v191
  v_mfma_f32_16x16x32_bf16 v[160:163], v[72:75], a[8:11], v[160:163]
  s_xor_b32 s60, s60, 8192
  buffer_store_dwordx4 v[204:207], v4, s[16:19], s51 offen offset:3072 sc1
  s_sub_u32 s62, s60, 0
  v_mfma_f32_16x16x32_bf16 v[164:167], v[96:99], a[8:11], v[164:167]
  s_cmp_ge_u32 s62, 125829120
  s_cselect_b32 s62, 1073741824, s60
  v_mfma_f32_16x16x32_bf16 v[160:163], v[76:79], a[12:15], v[160:163]
  v_mfma_f32_16x16x32_bf16 v[164:167], v[100:103], a[12:15], v[164:167]
  v_mfma_f32_16x16x32_bf16 v[160:163], v[80:83], a[16:19], v[160:163]
  s_add_u32 m0, s49, 0
  v_mfma_f32_16x16x32_bf16 v[164:167], v[104:107], a[16:19], v[164:167]
  buffer_load_dword v14, s[72:75], s43 offen sc1 lds
  v_mfma_f32_16x16x32_bf16 v[160:163], v[84:87], a[20:23], v[160:163]
  v_mfma_f32_16x16x32_bf16 v[164:167], v[108:111], a[20:23], v[164:167]
  v_mfma_f32_16x16x32_bf16 v[168:171], v[64:67], a[24:27], 0
  v_mfma_f32_16x16x32_bf16 v[172:175], v[88:91], a[24:27], 0
  v_mfma_f32_16x16x32_bf16 v[168:171], v[68:71], a[28:31], v[168:171]
  v_cvt_pk_bf16_f32 v192, v160, v161
  v_cvt_pk_bf16_f32 v193, v162, v163
  v_mfma_f32_16x16x32_bf16 v[172:175], v[92:95], a[28:31], v[172:175]
  v_cvt_pk_bf16_f32 v194, v164, v165
  v_cvt_pk_bf16_f32 v195, v166, v167
  v_mfma_f32_16x16x32_bf16 v[168:171], v[72:75], a[32:35], v[168:171]
  buffer_store_dwordx4 v[192:195], v4, s[16:19], s56 offen offset:0 sc1
  v_mfma_f32_16x16x32_bf16 v[172:175], v[96:99], a[32:35], v[172:175]
  v_mfma_f32_16x16x32_bf16 v[168:171], v[76:79], a[36:39], v[168:171]
  v_mfma_f32_16x16x32_bf16 v[172:175], v[100:103], a[36:39], v[172:175]
  v_mfma_f32_16x16x32_bf16 v[168:171], v[80:83], a[40:43], v[168:171]
  v_mfma_f32_16x16x32_bf16 v[172:175], v[104:107], a[40:43], v[172:175]
  s_add_u32 s55, s62, 0
  v_mfma_f32_16x16x32_bf16 v[168:171], v[84:87], a[44:47], v[168:171]
  buffer_store_dwordx4 v[192:195], v4, s[16:19], s55 offen sc1
  v_mfma_f32_16x16x32_bf16 v[172:175], v[108:111], a[44:47], v[172:175]
  v_mfma_f32_16x16x32_bf16 v[176:179], v[64:67], a[48:51], 0
  v_mfma_f32_16x16x32_bf16 v[180:183], v[88:91], a[48:51], 0
  v_mfma_f32_16x16x32_bf16 v[176:179], v[68:71], a[52:55], v[176:179]
  v_cvt_pk_bf16_f32 v196, v168, v169
  v_cvt_pk_bf16_f32 v197, v170, v171
  v_mfma_f32_16x16x32_bf16 v[180:183], v[92:95], a[52:55], v[180:183]
  v_cvt_pk_bf16_f32 v198, v172, v173
  v_cvt_pk_bf16_f32 v199, v174, v175
  v_mfma_f32_16x16x32_bf16 v[176:179], v[72:75], a[56:59], v[176:179]
  buffer_store_dwordx4 v[196:199], v4, s[16:19], s56 offen offset:1024 sc1
  v_mfma_f32_16x16x32_bf16 v[180:183], v[96:99], a[56:59], v[180:183]
  v_mfma_f32_16x16x32_bf16 v[176:179], v[76:79], a[60:63], v[176:179]
  v_mfma_f32_16x16x32_bf16 v[180:183], v[100:103], a[60:63], v[180:183]
  v_mfma_f32_16x16x32_bf16 v[176:179], v[80:83], a[64:67], v[176:179]
  v_mfma_f32_16x16x32_bf16 v[180:183], v[104:107], a[64:67], v[180:183]
  v_mfma_f32_16x16x32_bf16 v[176:179], v[84:87], a[68:71], v[176:179]
  v_mfma_f32_16x16x32_bf16 v[180:183], v[108:111], a[68:71], v[180:183]
  v_mfma_f32_16x16x32_bf16 v[184:187], v[64:67], a[72:75], 0
  v_mfma_f32_16x16x32_bf16 v[188:191], v[88:91], a[72:75], 0
  v_mfma_f32_16x16x32_bf16 v[184:187], v[68:71], a[76:79], v[184:187]
  v_cvt_pk_bf16_f32 v200, v176, v177
  v_cvt_pk_bf16_f32 v201, v178, v179
  v_mfma_f32_16x16x32_bf16 v[188:191], v[92:95], a[76:79], v[188:191]
  v_cvt_pk_bf16_f32 v202, v180, v181
  v_cvt_pk_bf16_f32 v203, v182, v183
  v_mfma_f32_16x16x32_bf16 v[184:187], v[72:75], a[80:83], v[184:187]
  buffer_store_dwordx4 v[200:203], v4, s[16:19], s58 offen offset:0 sc1
  v_mfma_f32_16x16x32_bf16 v[188:191], v[96:99], a[80:83], v[188:191]
  v_mfma_f32_16x16x32_bf16 v[184:187], v[76:79], a[84:87], v[184:187]
  v_mfma_f32_16x16x32_bf16 v[188:191], v[100:103], a[84:87], v[188:191]
  v_mfma_f32_16x16x32_bf16 v[184:187], v[80:83], a[88:91], v[184:187]
  v_mfma_f32_16x16x32_bf16 v[188:191], v[104:107], a[88:91], v[188:191]
  v_mfma_f32_16x16x32_bf16 v[184:187], v[84:87], a[92:95], v[184:187]
  v_mfma_f32_16x16x32_bf16 v[188:191], v[108:111], a[92:95], v[188:191]
  v_mfma_f32_16x16x32_bf16 v[160:163], v[64:67], a[96:99], 0
  v_mfma_f32_16x16x32_bf16 v[164:167], v[88:91], a[96:99], 0
  v_mfma_f32_16x16x32_bf16 v[160:163], v[68:71], a[100:103], v[160:163]
  v_cvt_pk_bf16_f32 v204, v184, v185
  v_cvt_pk_bf16_f32 v205, v186, v187
  v_mfma_f32_16x16x32_bf16 v[164:167], v[92:95], a[100:103], v[164:167]
  v_cvt_pk_bf16_f32 v206, v188, v189
  v_cvt_pk_bf16_f32 v207, v190, v191
  v_mfma_f32_16x16x32_bf16 v[160:163], v[72:75], a[104:107], v[160:163]
  buffer_store_dwordx4 v[204:207], v4, s[16:19], s56 offen offset:2048 sc1
  v_mfma_f32_16x16x32_bf16 v[164:167], v[96:99], a[104:107], v[164:167]
  v_mfma_f32_16x16x32_bf16 v[160:163], v[76:79], a[108:111], v[160:163]
  s_waitcnt vmcnt(5)
  s_barrier
  ds_read_b32 v15, v13 offset:12288
  v_mfma_f32_16x16x32_bf16 v[164:167], v[100:103], a[108:111], v[164:167]
  ds_read_b128 v[112:115], v10 offset:16384
  s_min_u32 s23, s45, 56
  v_mfma_f32_16x16x32_bf16 v[160:163], v[80:83], a[112:115], v[160:163]
  v_mov_b32 v16, s23
  s_waitcnt vmcnt(6)
  v_mfma_f32_16x16x32_bf16 v[164:167], v[104:107], a[112:115], v[164:167]
  s_add_u32 s55, s62, 16384
  ds_read_b128 v[136:139], v10 offset:17408
  v_mfma_f32_16x16x32_bf16 v[160:163], v[84:87], a[116:119], v[160:163]
  buffer_store_dwordx4 v[204:207], v4, s[16:19], s55 offen sc1
  s_waitcnt lgkmcnt(2)
  v_mfma_f32_16x16x32_bf16 v[164:167], v[108:111], a[116:119], v[164:167]
  ds_read_b128 v[116:119], v10 offset:19456
  v_cmp_le_u32 vcc, 8, v15
  v_mfma_f32_16x16x32_bf16 v[168:171], v[64:67], a[120:123], 0
  s_ff0_i32_b32 s21, vcc_lo
  s_min_u32 s21, s21, 19
  s_lshl_b32 s22, s21, 1
  v_mfma_f32_16x16x32_bf16 v[172:175], v[88:91], a[120:123], 0
  s_lshl_b32 s21, s21, 2
  ds_read_b128 v[140:143], v10 offset:20480
  s_sub_i32 s21, s21, 12
  v_mfma_f32_16x16x32_bf16 v[168:171], v[68:71], a[124:127], v[168:171]
  s_max_i32 s21, s21, s22
  v_cvt_pk_bf16_f32 v192, v160, v161
  v_cvt_pk_bf16_f32 v193, v162, v163
  v_mfma_f32_16x16x32_bf16 v[172:175], v[92:95], a[124:127], v[172:175]
  s_max_u32 s42, s21, s46
  v_cvt_pk_bf16_f32 v194, v164, v165
  v_cvt_pk_bf16_f32 v195, v166, v167
  v_mfma_f32_16x16x32_bf16 v[168:171], v[72:75], a[128:131], v[168:171]
  buffer_store_dwordx4 v[192:195], v4, s[16:19], s56 offen offset:3072 sc1
  ds_read2st64_b64 v[120:123], v11 offset0:32 offset1:38
  v_mfma_f32_16x16x32_bf16 v[172:175], v[96:99], a[128:131], v[172:175]
  s_cmp_ge_u32 s46, s48
  s_cselect_b32 s46, s42, s46
  v_mfma_f32_16x16x32_bf16 v[168:171], v[76:79], a[132:135], v[168:171]
  ds_read2st64_b64 v[144:147], v12 offset0:32 offset1:38
  v_mfma_f32_16x16x32_bf16 v[172:175], v[100:103], a[132:135], v[172:175]
  s_cmp_lt_u32 s48, s46
  s_cselect_b32 s53, s41, 1073741824
  s_add_u32 s54, s52, 0
  v_mfma_f32_16x16x32_bf16 v[168:171], v[80:83], a[136:139], v[168:171]
  s_add_u32 m0, s54, s47
  ds_read_b128 v[124:127], v10 offset:22528
  v_mfma_f32_16x16x32_bf16 v[172:175], v[104:107], a[136:139], v[172:175]
  buffer_load_dwordx4 v4, s[16:19], s53 offen offset:0 sc1 lds
  v_mfma_f32_16x16x32_bf16 v[168:171], v[84:87], a[140:143], v[168:171]
  ds_read_b128 v[148:151], v10 offset:23552
  v_mfma_f32_16x16x32_bf16 v[172:175], v[108:111], a[140:143], v[172:175]
  v_mfma_f32_16x16x32_bf16 v[176:179], v[64:67], a[144:147], 0
  ds_read_b128 v[128:131], v10 offset:25600
  buffer_store_dword v16, v17, s[72:75], s44 offen sc1
  v_mfma_f32_16x16x32_bf16 v[180:183], v[88:91], a[144:147], 0
  v_mfma_f32_16x16x32_bf16 v[176:179], v[68:71], a[148:151], v[176:179]
  v_cvt_pk_bf16_f32 v196, v168, v169
  v_cvt_pk_bf16_f32 v197, v170, v171
  v_mfma_f32_16x16x32_bf16 v[180:183], v[92:95], a[148:151], v[180:183]
  v_cvt_pk_bf16_f32 v198, v172, v173
  v_cvt_pk_bf16_f32 v199, v174, v175
  v_mfma_f32_16x16x32_bf16 v[176:179], v[72:75], a[152:155], v[176:179]
  buffer_store_dwordx4 v[196:199], v4, s[16:19], s57 offen offset:0 sc1
  ds_read_b128 v[152:155], v10 offset:26624
  v_mfma_f32_16x16x32_bf16 v[180:183], v[96:99], a[152:155], v[180:183]
  v_mfma_f32_16x16x32_bf16 v[176:179], v[76:79], a[156:159], v[176:179]
  ds_read2st64_b64 v[132:135], v11 offset0:44 offset1:50
  v_mfma_f32_16x16x32_bf16 v[180:183], v[100:103], a[156:159], v[180:183]
  v_mfma_f32_16x16x32_bf16 v[176:179], v[80:83], a[160:163], v[176:179]
  ds_read2st64_b64 v[156:159], v12 offset0:44 offset1:50
  v_mfma_f32_16x16x32_bf16 v[180:183], v[104:107], a[160:163], v[180:183]
  s_add_u32 s55, s62, 32768
  v_mfma_f32_16x16x32_bf16 v[176:179], v[84:87], a[164:167], v[176:179]
  buffer_store_dwordx4 v[196:199], v4, s[16:19], s55 offen sc1
  v_mfma_f32_16x16x32_bf16 v[180:183], v[108:111], a[164:167], v[180:183]
  v_mfma_f32_16x16x32_bf16 v[184:187], v[64:67], a[168:171], 0
  v_mfma_f32_16x16x32_bf16 v[188:191], v[88:91], a[168:171], 0
  v_mfma_f32_16x16x32_bf16 v[184:187], v[68:71], a[172:175], v[184:187]
  v_cvt_pk_bf16_f32 v200, v176, v177
  v_cvt_pk_bf16_f32 v201, v178, v179
  v_mfma_f32_16x16x32_bf16 v[188:191], v[92:95], a[172:175], v[188:191]
  v_cvt_pk_bf16_f32 v202, v180, v181
  v_cvt_pk_bf16_f32 v203, v182, v183
  v_mfma_f32_16x16x32_bf16 v[184:187], v[72:75], a[176:179], v[184:187]
  buffer_store_dwordx4 v[200:203], v4, s[16:19], s57 offen offset:1024 sc1
  v_mfma_f32_16x16x32_bf16 v[188:191], v[96:99], a[176:179], v[188:191]
  v_mfma_f32_16x16x32_bf16 v[184:187], v[76:79], a[180:183], v[184:187]
  v_mfma_f32_16x16x32_bf16 v[188:191], v[100:103], a[180:183], v[188:191]
  v_mfma_f32_16x16x32_bf16 v[184:187], v[80:83], a[184:187], v[184:187]
  v_mfma_f32_16x16x32_bf16 v[188:191], v[104:107], a[184:187], v[188:191]
  buffer_load_dwordx4 v4, s[16:19], s53 offen offset:1024 sc1 lds
  v_mfma_f32_16x16x32_bf16 v[184:187], v[84:87], a[188:191], v[184:187]
  v_mfma_f32_16x16x32_bf16 v[188:191], v[108:111], a[188:191], v[188:191]
  v_mfma_f32_16x16x32_bf16 v[160:163], v[64:67], a[192:195], 0
  v_mfma_f32_16x16x32_bf16 v[164:167], v[88:91], a[192:195], 0
  v_mfma_f32_16x16x32_bf16 v[160:163], v[68:71], a[196:199], v[160:163]
  v_cvt_pk_bf16_f32 v204, v184, v185
  v_cvt_pk_bf16_f32 v205, v186, v187
  v_mfma_f32_16x16x32_bf16 v[164:167], v[92:95], a[196:199], v[164:167]
  v_cvt_pk_bf16_f32 v206, v188, v189
  v_cvt_pk_bf16_f32 v207, v190, v191
  v_mfma_f32_16x16x32_bf16 v[160:163], v[72:75], a[200:203], v[160:163]
  buffer_store_dwordx4 v[204:207], v4, s[16:19], s58 offen offset:1024 sc1
  v_mfma_f32_16x16x32_bf16 v[164:167], v[96:99], a[200:203], v[164:167]
  v_mfma_f32_16x16x32_bf16 v[160:163], v[76:79], a[204:207], v[160:163]
  s_add_u32 s56, s56, 2097152
  s_xor_b32 s56, s56, 8192
  s_add_u32 s59, s58, 524288
  v_mfma_f32_16x16x32_bf16 v[164:167], v[100:103], a[204:207], v[164:167]
  s_xor_b32 s58, s58, s59
  s_lshr_b32 s58, s58, 8
  s_and_b32 s58, s58, 8192
  v_mfma_f32_16x16x32_bf16 v[160:163], v[80:83], a[208:211], v[160:163]
  s_xor_b32 s58, s58, s59
  v_mfma_f32_16x16x32_bf16 v[164:167], v[104:107], a[208:211], v[164:167]
  buffer_load_dwordx4 v4, s[16:19], s53 offen offset:2048 sc1 lds
  s_add_u32 s41, s41, 2097152
  v_mfma_f32_16x16x32_bf16 v[160:163], v[84:87], a[212:215], v[160:163]
  s_xor_b32 s41, s41, 8192
  s_add_u32 s48, s48, 1
  v_mfma_f32_16x16x32_bf16 v[164:167], v[108:111], a[212:215], v[164:167]
  v_mfma_f32_16x16x32_bf16 v[168:171], v[64:67], a[216:219], 0
  v_mfma_f32_16x16x32_bf16 v[172:175], v[88:91], a[216:219], 0
  v_mfma_f32_16x16x32_bf16 v[168:171], v[68:71], a[220:223], v[168:171]
  v_cvt_pk_bf16_f32 v192, v160, v161
  v_cvt_pk_bf16_f32 v193, v162, v163
  v_mfma_f32_16x16x32_bf16 v[172:175], v[92:95], a[220:223], v[172:175]
  v_cvt_pk_bf16_f32 v194, v164, v165
  v_cvt_pk_bf16_f32 v195, v166, v167
  v_mfma_f32_16x16x32_bf16 v[168:171], v[72:75], a[224:227], v[168:171]
  buffer_store_dwordx4 v[192:195], v4, s[16:19], s57 offen offset:2048 sc1
  v_mfma_f32_16x16x32_bf16 v[172:175], v[96:99], a[224:227], v[172:175]
  v_mfma_f32_16x16x32_bf16 v[168:171], v[76:79], a[228:231], v[168:171]
  s_mov_b32 s51, s57
  s_add_u32 s57, s56, 4096
  s_add_u32 s45, s45, 1
  v_mfma_f32_16x16x32_bf16 v[172:175], v[100:103], a[228:231], v[172:175]
  s_add_u32 s55, s62, 49152
  v_mfma_f32_16x16x32_bf16 v[168:171], v[80:83], a[232:235], v[168:171]
  buffer_store_dwordx4 v[192:195], v4, s[16:19], s55 offen sc1
  v_mfma_f32_16x16x32_bf16 v[172:175], v[104:107], a[232:235], v[172:175]
  v_mfma_f32_16x16x32_bf16 v[168:171], v[84:87], a[236:239], v[168:171]
  v_mfma_f32_16x16x32_bf16 v[172:175], v[108:111], a[236:239], v[172:175]
  s_waitcnt lgkmcnt(0)
  v_mfma_f32_16x16x32_bf16 v[176:179], v[112:115], a[0:3], 0
  v_mfma_f32_16x16x32_bf16 v[180:183], v[136:139], a[0:3], 0
  v_mfma_f32_16x16x32_bf16 v[176:179], v[116:119], a[4:7], v[176:179]
  v_cvt_pk_bf16_f32 v196, v168, v169
  v_cvt_pk_bf16_f32 v197, v170, v171
  v_mfma_f32_16x16x32_bf16 v[180:183], v[140:143], a[4:7], v[180:183]
  s_add_u32 s60, s60, 2097152
  v_cvt_pk_bf16_f32 v198, v172, v173
  v_cvt_pk_bf16_f32 v199, v174, v175
  v_mfma_f32_16x16x32_bf16 v[176:179], v[120:123], a[8:11], v[176:179]
  s_xor_b32 s60, s60, 8192
  buffer_store_dwordx4 v[196:199], v4, s[16:19], s51 offen offset:3072 sc1
  s_sub_u32 s62, s60, 0
  v_mfma_f32_16x16x32_bf16 v[180:183], v[144:147], a[8:11], v[180:183]
  s_cmp_ge_u32 s62, 125829120
  s_cselect_b32 s62, 1073741824, s60
  v_mfma_f32_16x16x32_bf16 v[176:179], v[124:127], a[12:15], v[176:179]
  v_mfma_f32_16x16x32_bf16 v[180:183], v[148:151], a[12:15], v[180:183]
  v_mfma_f32_16x16x32_bf16 v[176:179], v[128:131], a[16:19], v[176:179]
  s_add_u32 m0, s49, 16384
  v_mfma_f32_16x16x32_bf16 v[180:183], v[152:155], a[16:19], v[180:183]
  buffer_load_dword v14, s[72:75], s43 offen sc1 lds
  v_mfma_f32_16x16x32_bf16 v[176:179], v[132:135], a[20:23], v[176:179]
  v_mfma_f32_16x16x32_bf16 v[180:183], v[156:159], a[20:23], v[180:183]
  v_mfma_f32_16x16x32_bf16 v[184:187], v[112:115], a[24:27], 0
  v_mfma_f32_16x16x32_bf16 v[188:191], v[136:139], a[24:27], 0
  v_mfma_f32_16x16x32_bf16 v[184:187], v[116:119], a[28:31], v[184:187]
  v_cvt_pk_bf16_f32 v200, v176, v177
  v_cvt_pk_bf16_f32 v201, v178, v179
  v_mfma_f32_16x16x32_bf16 v[188:191], v[140:143], a[28:31], v[188:191]
  v_cvt_pk_bf16_f32 v202, v180, v181
  v_cvt_pk_bf16_f32 v203, v182, v183
  v_mfma_f32_16x16x32_bf16 v[184:187], v[120:123], a[32:35], v[184:187]
  buffer_store_dwordx4 v[200:203], v4, s[16:19], s56 offen offset:0 sc1
  v_mfma_f32_16x16x32_bf16 v[188:191], v[144:147], a[32:35], v[188:191]
  v_mfma_f32_16x16x32_bf16 v[184:187], v[124:127], a[36:39], v[184:187]
  v_mfma_f32_16x16x32_bf16 v[188:191], v[148:151], a[36:39], v[188:191]
  v_mfma_f32_16x16x32_bf16 v[184:187], v[128:131], a[40:43], v[184:187]
  v_mfma_f32_16x16x32_bf16 v[188:191], v[152:155], a[40:43], v[188:191]
  s_add_u32 s55, s62, 0
  v_mfma_f32_16x16x32_bf16 v[184:187], v[132:135], a[44:47], v[184:187]
  buffer_store_dwordx4 v[200:203], v4, s[16:19], s55 offen sc1
  v_mfma_f32_16x16x32_bf16 v[188:191], v[156:159], a[44:47], v[188:191]
  v_mfma_f32_16x16x32_bf16 v[160:163], v[112:115], a[48:51], 0
  v_mfma_f32_16x16x32_bf16 v[164:167], v[136:139], a[48:51], 0
  v_mfma_f32_16x16x32_bf16 v[160:163], v[116:119], a[52:55], v[160:163]
  v_cvt_pk_bf16_f32 v204, v184, v185
  v_cvt_pk_bf16_f32 v205, v186, v187
  v_mfma_f32_16x16x32_bf16 v[164:167], v[140:143], a[52:55], v[164:167]
  v_cvt_pk_bf16_f32 v206, v188, v189
  v_cvt_pk_bf16_f32 v207, v190, v191
  v_mfma_f32_16x16x32_bf16 v[160:163], v[120:123], a[56:59], v[160:163]
  buffer_store_dwordx4 v[204:207], v4, s[16:19], s56 offen offset:1024 sc1
  v_mfma_f32_16x16x32_bf16 v[164:167], v[144:147], a[56:59], v[164:167]
  v_mfma_f32_16x16x32_bf16 v[160:163], v[124:127], a[60:63], v[160:163]
  v_mfma_f32_16x16x32_bf16 v[164:167], v[148:151], a[60:63], v[164:167]
  v_mfma_f32_16x16x32_bf16 v[160:163], v[128:131], a[64:67], v[160:163]
  v_mfma_f32_16x16x32_bf16 v[164:167], v[152:155], a[64:67], v[164:167]
  v_mfma_f32_16x16x32_bf16 v[160:163], v[132:135], a[68:71], v[160:163]
  v_mfma_f32_16x16x32_bf16 v[164:167], v[156:159], a[68:71], v[164:167]
  v_mfma_f32_16x16x32_bf16 v[168:171], v[112:115], a[72:75], 0
  v_mfma_f32_16x16x32_bf16 v[172:175], v[136:139], a[72:75], 0
  v_mfma_f32_16x16x32_bf16 v[168:171], v[116:119], a[76:79], v[168:171]
  v_cvt_pk_bf16_f32 v192, v160, v161
  v_cvt_pk_bf16_f32 v193, v162, v163
  v_mfma_f32_16x16x32_bf16 v[172:175], v[140:143], a[76:79], v[172:175]
  v_cvt_pk_bf16_f32 v194, v164, v165
  v_cvt_pk_bf16_f32 v195, v166, v167
  v_mfma_f32_16x16x32_bf16 v[168:171], v[120:123], a[80:83], v[168:171]
  buffer_store_dwordx4 v[192:195], v4, s[16:19], s58 offen offset:0 sc1
  v_mfma_f32_16x16x32_bf16 v[172:175], v[144:147], a[80:83], v[172:175]
  v_mfma_f32_16x16x32_bf16 v[168:171], v[124:127], a[84:87], v[168:171]
  v_mfma_f32_16x16x32_bf16 v[172:175], v[148:151], a[84:87], v[172:175]
  v_mfma_f32_16x16x32_bf16 v[168:171], v[128:131], a[88:91], v[168:171]
  v_mfma_f32_16x16x32_bf16 v[172:175], v[152:155], a[88:91], v[172:175]
  v_mfma_f32_16x16x32_bf16 v[168:171], v[132:135], a[92:95], v[168:171]
  v_mfma_f32_16x16x32_bf16 v[172:175], v[156:159], a[92:95], v[172:175]
  v_mfma_f32_16x16x32_bf16 v[176:179], v[112:115], a[96:99], 0
  v_mfma_f32_16x16x32_bf16 v[180:183], v[136:139], a[96:99], 0
  v_mfma_f32_16x16x32_bf16 v[176:179], v[116:119], a[100:103], v[176:179]
  v_cvt_pk_bf16_f32 v196, v168, v169
  v_cvt_pk_bf16_f32 v197, v170, v171
  v_mfma_f32_16x16x32_bf16 v[180:183], v[140:143], a[100:103], v[180:183]
  v_cvt_pk_bf16_f32 v198, v172, v173
  v_cvt_pk_bf16_f32 v199, v174, v175
  v_mfma_f32_16x16x32_bf16 v[176:179], v[120:123], a[104:107], v[176:179]
  buffer_store_dwordx4 v[196:199], v4, s[16:19], s56 offen offset:2048 sc1
  v_mfma_f32_16x16x32_bf16 v[180:183], v[144:147], a[104:107], v[180:183]
  v_mfma_f32_16x16x32_bf16 v[176:179], v[124:127], a[108:111], v[176:179]
  s_waitcnt vmcnt(5)
  s_barrier
  ds_read_b32 v15, v13 offset:28672
  v_mfma_f32_16x16x32_bf16 v[180:183], v[148:151], a[108:111], v[180:183]
  v_xor_b32 v10, 32768, v10
  v_xor_b32 v11, 32768, v11
  v_mfma_f32_16x16x32_bf16 v[176:179], v[128:131], a[112:115], v[176:179]
  v_xor_b32 v12, 32768, v12
  ds_read_b128 v[64:67], v10 offset:0
  v_mfma_f32_16x16x32_bf16 v[180:183], v[152:155], a[112:115], v[180:183]
  s_add_u32 s55, s62, 16384
  s_min_u32 s23, s45, 56
  v_mov_b32 v16, s23
  v_mfma_f32_16x16x32_bf16 v[176:179], v[132:135], a[116:119], v[176:179]
  buffer_store_dwordx4 v[196:199], v4, s[16:19], s55 offen sc1
  ds_read_b128 v[88:91], v10 offset:1024
  v_mfma_f32_16x16x32_bf16 v[180:183], v[156:159], a[116:119], v[180:183]
  s_waitcnt vmcnt(7)
  v_mfma_f32_16x16x32_bf16 v[184:187], v[112:115], a[120:123], 0
  ds_read_b128 v[68:71], v10 offset:3072
  s_waitcnt lgkmcnt(3)
  v_mfma_f32_16x16x32_bf16 v[188:191], v[136:139], a[120:123], 0
  v_cmp_le_u32 vcc, 8, v15
  buffer_store_dword v16, v17, s[72:75], s44 offen sc1
  v_mfma_f32_16x16x32_bf16 v[184:187], v[116:119], a[124:127], v[184:187]
  v_cvt_pk_bf16_f32 v200, v176, v177
  v_cvt_pk_bf16_f32 v201, v178, v179
  v_mfma_f32_16x16x32_bf16 v[188:191], v[140:143], a[124:127], v[188:191]
  s_ff0_i32_b32 s21, vcc_lo
  v_cvt_pk_bf16_f32 v202, v180, v181
  v_cvt_pk_bf16_f32 v203, v182, v183
  v_mfma_f32_16x16x32_bf16 v[184:187], v[120:123], a[128:131], v[184:187]
  s_min_u32 s21, s21, 19
  buffer_store_dwordx4 v[200:203], v4, s[16:19], s56 offen offset:3072 sc1
  ds_read_b128 v[92:95], v10 offset:4096
  v_mfma_f32_16x16x32_bf16 v[188:191], v[144:147], a[128:131], v[188:191]
  s_lshl_b32 s22, s21, 1
  s_lshl_b32 s21, s21, 2
  s_sub_i32 s21, s21, 12
  v_mfma_f32_16x16x32_bf16 v[184:187], v[124:127], a[132:135], v[184:187]
  s_max_i32 s21, s21, s22
  ds_read2st64_b64 v[72:75], v11 offset0:0 offset1:6
  s_max_u32 s42, s21, s46
  v_mfma_f32_16x16x32_bf16 v[188:191], v[148:151], a[132:135], v[188:191]
  s_cmp_ge_u32 s46, s48
  s_cselect_b32 s46, s42, s46
  v_mfma_f32_16x16x32_bf16 v[184:187], v[128:131], a[136:139], v[184:187]
  ds_read2st64_b64 v[96:99], v12 offset0:0 offset1:6
  v_mfma_f32_16x16x32_bf16 v[188:191], v[152:155], a[136:139], v[188:191]
  s_cmp_lt_u32 s48, s46
  s_cselect_b32 s53, s41, 1073741824
  s_add_u32 s54, s52, 16384
  v_mfma_f32_16x16x32_bf16 v[184:187], v[132:135], a[140:143], v[184:187]
  s_add_u32 m0, s54, s47
  ds_read_b128 v[76:79], v10 offset:6144
  v_mfma_f32_16x16x32_bf16 v[188:191], v[156:159], a[140:143], v[188:191]
  buffer_load_dwordx4 v4, s[16:19], s53 offen offset:0 sc1 lds
  v_mfma_f32_16x16x32_bf16 v[160:163], v[112:115], a[144:147], 0
  ds_read_b128 v[100:103], v10 offset:7168
  v_mfma_f32_16x16x32_bf16 v[164:167], v[136:139], a[144:147], 0
  v_mfma_f32_16x16x32_bf16 v[160:163], v[116:119], a[148:151], v[160:163]
  v_cvt_pk_bf16_f32 v204, v184, v185
  v_cvt_pk_bf16_f32 v205, v186, v187
  v_mfma_f32_16x16x32_bf16 v[164:167], v[140:143], a[148:151], v[164:167]
  v_cvt_pk_bf16_f32 v206, v188, v189
  v_cvt_pk_bf16_f32 v207, v190, v191
  v_mfma_f32_16x16x32_bf16 v[160:163], v[120:123], a[152:155], v[160:163]
  buffer_store_dwordx4 v[204:207], v4, s[16:19], s57 offen offset:0 sc1
  ds_read_b128 v[80:83], v10 offset:9216
  v_mfma_f32_16x16x32_bf16 v[164:167], v[144:147], a[152:155], v[164:167]
  v_mfma_f32_16x16x32_bf16 v[160:163], v[124:127], a[156:159], v[160:163]
  ds_read_b128 v[104:107], v10 offset:10240
  v_mfma_f32_16x16x32_bf16 v[164:167], v[148:151], a[156:159], v[164:167]
  v_mfma_f32_16x16x32_bf16 v[160:163], v[128:131], a[160:163], v[160:163]
  ds_read2st64_b64 v[84:87], v11 offset0:12 offset1:18
  v_mfma_f32_16x16x32_bf16 v[164:167], v[152:155], a[160:163], v[164:167]
  s_add_u32 s55, s62, 32768
  v_mfma_f32_16x16x32_bf16 v[160:163], v[132:135], a[164:167], v[160:163]
  buffer_store_dwordx4 v[204:207], v4, s[16:19], s55 offen sc1
  ds_read2st64_b64 v[108:111], v12 offset0:12 offset1:18
  v_mfma_f32_16x16x32_bf16 v[164:167], v[156:159], a[164:167], v[164:167]
  v_mfma_f32_16x16x32_bf16 v[168:171], v[112:115], a[168:171], 0
  v_mfma_f32_16x16x32_bf16 v[172:175], v[136:139], a[168:171], 0
  v_mfma_f32_16x16x32_bf16 v[168:171], v[116:119], a[172:175], v[168:171]
  v_cvt_pk_bf16_f32 v192, v160, v161
  v_cvt_pk_bf16_f32 v193, v162, v163
  v_mfma_f32_16x16x32_bf16 v[172:175], v[140:143], a[172:175], v[172:175]
  v_cvt_pk_bf16_f32 v194, v164, v165
  v_cvt_pk_bf16_f32 v195, v166, v167
  v_mfma_f32_16x16x32_bf16 v[168:171], v[120:123], a[176:179], v[168:171]
  buffer_store_dwordx4 v[192:195], v4, s[16:19], s57 offen offset:1024 sc1
  v_mfma_f32_16x16x32_bf16 v[172:175], v[144:147], a[176:179], v[172:175]
  v_mfma_f32_16x16x32_bf16 v[168:171], v[124:127], a[180:183], v[168:171]
  v_mfma_f32_16x16x32_bf16 v[172:175], v[148:151], a[180:183], v[172:175]
  v_mfma_f32_16x16x32_bf16 v[168:171], v[128:131], a[184:187], v[168:171]
  v_mfma_f32_16x16x32_bf16 v[172:175], v[152:155], a[184:187], v[172:175]
  buffer_load_dwordx4 v4, s[16:19], s53 offen offset:1024 sc1 lds
  v_mfma_f32_16x16x32_bf16 v[168:171], v[132:135], a[188:191], v[168:171]
  v_mfma_f32_16x16x32_bf16 v[172:175], v[156:159], a[188:191], v[172:175]
  v_mfma_f32_16x16x32_bf16 v[176:179], v[112:115], a[192:195], 0
  v_mfma_f32_16x16x32_bf16 v[180:183], v[136:139], a[192:195], 0
  v_mfma_f32_16x16x32_bf16 v[176:179], v[116:119], a[196:199], v[176:179]
  v_cvt_pk_bf16_f32 v196, v168, v169
  v_cvt_pk_bf16_f32 v197, v170, v171
  v_mfma_f32_16x16x32_bf16 v[180:183], v[140:143], a[196:199], v[180:183]
  v_cvt_pk_bf16_f32 v198, v172, v173
  v_cvt_pk_bf16_f32 v199, v174, v175
  v_mfma_f32_16x16x32_bf16 v[176:179], v[120:123], a[200:203], v[176:179]
  buffer_store_dwordx4 v[196:199], v4, s[16:19], s58 offen offset:1024 sc1
  v_mfma_f32_16x16x32_bf16 v[180:183], v[144:147], a[200:203], v[180:183]
  v_mfma_f32_16x16x32_bf16 v[176:179], v[124:127], a[204:207], v[176:179]
  s_add_u32 s56, s56, 2097152
  s_xor_b32 s56, s56, 8192
  s_add_u32 s59, s58, 524288
  v_mfma_f32_16x16x32_bf16 v[180:183], v[148:151], a[204:207], v[180:183]
  s_xor_b32 s58, s58, s59
  s_lshr_b32 s58, s58, 8
  s_and_b32 s58, s58, 8192
  v_mfma_f32_16x16x32_bf16 v[176:179], v[128:131], a[208:211], v[176:179]
  s_xor_b32 s58, s58, s59
  v_mfma_f32_16x16x32_bf16 v[180:183], v[152:155], a[208:211], v[180:183]
  buffer_load_dwordx4 v4, s[16:19], s53 offen offset:2048 sc1 lds
  s_add_u32 s41, s41, 2097152
  v_mfma_f32_16x16x32_bf16 v[176:179], v[132:135], a[212:215], v[176:179]
  s_xor_b32 s41, s41, 8192
  s_add_u32 s48, s48, 1
  s_xor_b32 s52, s52, 32768
  v_mfma_f32_16x16x32_bf16 v[180:183], v[156:159], a[212:215], v[180:183]
  v_mfma_f32_16x16x32_bf16 v[184:187], v[112:115], a[216:219], 0
  v_mfma_f32_16x16x32_bf16 v[188:191], v[136:139], a[216:219], 0
  v_mfma_f32_16x16x32_bf16 v[184:187], v[116:119], a[220:223], v[184:187]
  v_cvt_pk_bf16_f32 v200, v176, v177
  v_cvt_pk_bf16_f32 v201, v178, v179
  v_mfma_f32_16x16x32_bf16 v[188:191], v[140:143], a[220:223], v[188:191]
  v_cvt_pk_bf16_f32 v202, v180, v181
  v_cvt_pk_bf16_f32 v203, v182, v183
  v_mfma_f32_16x16x32_bf16 v[184:187], v[120:123], a[224:227], v[184:187]
  buffer_store_dwordx4 v[200:203], v4, s[16:19], s57 offen offset:2048 sc1
  v_mfma_f32_16x16x32_bf16 v[188:191], v[144:147], a[224:227], v[188:191]
  v_mfma_f32_16x16x32_bf16 v[184:187], v[124:127], a[228:231], v[184:187]
  s_mov_b32 s51, s57
  s_add_u32 s57, s56, 4096
  s_add_u32 s45, s45, 1
  v_mfma_f32_16x16x32_bf16 v[188:191], v[148:151], a[228:231], v[188:191]
  s_add_u32 s55, s62, 49152
  v_mfma_f32_16x16x32_bf16 v[184:187], v[128:131], a[232:235], v[184:187]
  buffer_store_dwordx4 v[200:203], v4, s[16:19], s55 offen sc1
  v_mfma_f32_16x16x32_bf16 v[188:191], v[152:155], a[232:235], v[188:191]
  v_mfma_f32_16x16x32_bf16 v[184:187], v[132:135], a[236:239], v[184:187]
  s_cmp_lt_u32 s45, s46
  v_mfma_f32_16x16x32_bf16 v[188:191], v[156:159], a[236:239], v[188:191]
  s_waitcnt lgkmcnt(0)
  s_cbranch_scc1 vwl_256
  s_nop 7
  v_cvt_pk_bf16_f32 v204, v184, v185
  v_cvt_pk_bf16_f32 v205, v186, v187
  v_cvt_pk_bf16_f32 v206, v188, v189
  v_cvt_pk_bf16_f32 v207, v190, v191
  buffer_store_dwordx4 v[204:207], v4, s[16:19], s51 offen offset:3072 sc1
  s_min_u32 s21, s45, 56
  v_mov_b32 v16, s21
  s_barrier
  s_mov_b32 s46, s42
  s_cmp_gt_u32 s42, s45
  s_cbranch_scc1 vwr_255
  s_cmp_lt_u32 s45, 64
  s_cbranch_scc1 vwr_250
  v_mov_b32 v244, -1
  v_mov_b32 v245, -1
  v_mov_b32 v246, -1
  v_mov_b32 v247, -1
  v_lshlrev_b32 v21, 3, v1
  s_lshr_b32 s21, s2, 2
  s_lshl_b32 s21, s21, 2
  s_add_u32 s21, s21, s20
  s_lshl_b32 s21, s21, 2
  s_and_b32 s22, s2, 3
  s_add_u32 s21, s21, s22
  s_lshl_b32 s21, s21, 14
  s_xor_b32 s22, s21, s80
  s_xor_b32 s21, s22, 125833216
  buffer_store_dwordx4 v[244:247], v4, s[16:19], s21 offen offset:0 sc1
  buffer_store_dwordx4 v[244:247], v4, s[16:19], s21 offen offset:1024 sc1
  buffer_store_dwordx4 v[244:247], v4, s[16:19], s21 offen offset:2048 sc1
  buffer_store_dwordx4 v[244:247], v4, s[16:19], s21 offen offset:3072 sc1
  s_xor_b32 s21, s22, 127938560
  buffer_store_dwordx4 v[244:247], v4, s[16:19], s21 offen offset:0 sc1
  buffer_store_dwordx4 v[244:247], v4, s[16:19], s21 offen offset:1024 sc1
  buffer_store_dwordx4 v[244:247], v4, s[16:19], s21 offen offset:2048 sc1
  buffer_store_dwordx4 v[244:247], v4, s[16:19], s21 offen offset:3072 sc1
  s_xor_b32 s21, s22, 130027520
  buffer_store_dwordx4 v[244:247], v4, s[16:19], s21 offen offset:0 sc1
  buffer_store_dwordx4 v[244:247], v4, s[16:19], s21 offen offset:1024 sc1
  buffer_store_dwordx4 v[244:247], v4, s[16:19], s21 offen offset:2048 sc1
  buffer_store_dwordx4 v[244:247], v4, s[16:19], s21 offen offset:3072 sc1
  s_xor_b32 s21, s22, 132132864
  buffer_store_dwordx4 v[244:247], v4, s[16:19], s21 offen offset:0 sc1
  buffer_store_dwordx4 v[244:247], v4, s[16:19], s21 offen offset:1024 sc1
  buffer_store_dwordx4 v[244:247], v4, s[16:19], s21 offen offset:2048 sc1
  buffer_store_dwordx4 v[244:247], v4, s[16:19], s21 offen offset:3072 sc1
  s_and_b32 s21, s2, 3
  s_cmp_lg_u32 s21, s20
  s_cbranch_scc1 arm_257
  s_lshr_b32 s21, s2, 1
  s_lshl_b32 s21, s21, 14
  s_and_b32 s22, s2, 1
  s_mul_i32 s22, s22, 2560
  s_add_u32 s21, s21, s22
  s_xor_b32 s22, s21, s80
  s_xor_b32 s21, s22, 216006656
  buffer_store_dwordx4 v[244:247], v4, s[16:19], s21 offen sc1
  buffer_store_dwordx4 v[244:247], v4, s[16:19], s21 offen offset:1024 sc1
  buffer_store_dwordx2 v[244:245], v21, s[16:19], s21 offen offset:2048 sc1
  s_xor_b32 s21, s22, 216530944
  buffer_store_dwordx4 v[244:247], v4, s[16:19], s21 offen sc1
  buffer_store_dwordx4 v[244:247], v4, s[16:19], s21 offen offset:1024 sc1
  buffer_store_dwordx2 v[244:245], v21, s[16:19], s21 offen offset:2048 sc1
  s_xor_b32 s21, s22, 217055232
  buffer_store_dwordx4 v[244:247], v4, s[16:19], s21 offen sc1
  buffer_store_dwordx4 v[244:247], v4, s[16:19], s21 offen offset:1024 sc1
  buffer_store_dwordx2 v[244:245], v21, s[16:19], s21 offen offset:2048 sc1
  s_xor_b32 s21, s22, 217579520
  buffer_store_dwordx4 v[244:247], v4, s[16:19], s21 offen sc1
  buffer_store_dwordx4 v[244:247], v4, s[16:19], s21 offen offset:1024 sc1
  buffer_store_dwordx2 v[244:245], v21, s[16:19], s21 offen offset:2048 sc1
arm_257:
  v_mov_b32 v16, 64
  s_waitcnt vmcnt(0)
  buffer_store_dword v16, v17, s[72:75], s44 offen sc1
  s_branch queue
not_vw:
  s_sub_u32 s2, s3, 96
  s_cmp_lg_u32 s2, 31
  s_cbranch_scc1 not_cal
  s_load_dwordx2 s[72:73], s[0:1], 104
  s_waitcnt lgkmcnt(0)
  s_add_u32 s72, s72, 173080576
  s_addc_u32 s73, s73, 0
  s_mov_b32 s74, 49152
  s_mov_b32 s75, 0x00020000
  v_lshlrev_b32 v8, 4, v0
  v_mov_b32 v4, 0
  v_mov_b32 v5, 0
  v_mov_b32 v6, 0
  v_mov_b32 v7, 0
  s_mov_b32 s21, 0
  buffer_store_dwordx4 v[4:7], v8, s[72:75], s21 offen sc1
  s_mov_b32 s21, 4096
  buffer_store_dwordx4 v[4:7], v8, s[72:75], s21 offen sc1
  s_mov_b32 s21, 8192
  buffer_store_dwordx4 v[4:7], v8, s[72:75], s21 offen sc1
  s_mov_b32 s21, 12288
  buffer_store_dwordx4 v[4:7], v8, s[72:75], s21 offen sc1
  s_mov_b32 s21, 16384
  buffer_store_dwordx4 v[4:7], v8, s[72:75], s21 offen sc1
  s_mov_b32 s21, 20480
  buffer_store_dwordx4 v[4:7], v8, s[72:75], s21 offen sc1
  s_mov_b32 s21, 24576
  buffer_store_dwordx4 v[4:7], v8, s[72:75], s21 offen sc1
  s_mov_b32 s21, 28672
  buffer_store_dwordx4 v[4:7], v8, s[72:75], s21 offen sc1
  s_mov_b32 s21, 32768
  buffer_store_dwordx4 v[4:7], v8, s[72:75], s21 offen sc1
  s_mov_b32 s21, 36864
  buffer_store_dwordx4 v[4:7], v8, s[72:75], s21 offen sc1
  s_mov_b32 s21, 40960
  buffer_store_dwordx4 v[4:7], v8, s[72:75], s21 offen sc1
  s_mov_b32 s21, 45056
  buffer_store_dwordx4 v[4:7], v8, s[72:75], s21 offen sc1
  s_add_u32 s8, s38, 173015040
  s_addc_u32 s9, s39, 0
  s_mov_b32 s10, 131072
  s_mov_b32 s11, 0x00020000
  s_cmp_lg_u32 s20, 0
  s_cbranch_scc1 cal_258
  s_mov_b32 s40, -1
  s_mov_b32 s41, -1
  s_mov_b32 s43, 0
cal_259:
  s_mov_b32 s21, 0
  s_memtime s[98:99]
  s_waitcnt lgkmcnt(0)
  s_buffer_load_dword s22, s[8:11], s21 glc
  s_waitcnt lgkmcnt(0)
  s_memtime s[100:101]
  s_waitcnt lgkmcnt(0)
  s_sub_u32 s21, s100, s98
  s_min_u32 s40, s40, s21
  s_mov_b32 s21, 8192
  s_memtime s[98:99]
  s_waitcnt lgkmcnt(0)
  s_buffer_load_dword s22, s[8:11], s21 glc
  s_waitcnt lgkmcnt(0)
  s_memtime s[100:101]
  s_waitcnt lgkmcnt(0)
  s_sub_u32 s21, s100, s98
  s_min_u32 s41, s41, s21
  s_add_u32 s43, s43, 1
  s_cmp_lt_u32 s43, 6
  s_cbranch_scc1 cal_259
cal_258:
  s_waitcnt vmcnt(0)
  s_barrier
  s_cmp_lg_u32 s20, 0
  s_cbranch_scc1 cal_260
  s_cmp_lt_u32 s41, s40
  s_cselect_b32 s21, 1, 2
  v_mov_b32 v4, s21
  v_mov_b32 v5, s40
  v_mov_b32 v6, s41
  v_mov_b32 v8, 76
  s_mov_b64 exec, 1
  buffer_store_dwordx3 v[4:6], v8, s[32:35], 0 offen sc1
  s_mov_b64 exec, -1
cal_260:
not_cal:
  s_load_dwordx2 s[4:5], s[0:1], 0
  s_load_dwordx2 s[6:7], s[0:1], 64
  s_load_dwordx2 s[38:39], s[0:1], 104
  s_lshr_b32 s41, s2, 3
  s_lshl_b32 s41, s41, 1
  s_and_b32 s21, s2, 1
  s_add_u32 s41, s41, s21
  s_bfe_u32 s42, s2, 0x20001
  s_waitcnt lgkmcnt(0)
  s_mov_b32 s8, s4
  s_mov_b32 s9, s5
  s_mov_b32 s10, 2621440
  s_mov_b32 s11, 0x00020000
  s_mov_b32 s12, s6
  s_mov_b32 s13, s7
  s_mov_b32 s14, 2457600
  s_mov_b32 s15, 0x00020000
  s_mov_b32 s16, s38
  s_mov_b32 s17, s39
  s_mov_b32 s18, 218103808
  s_mov_b32 s19, 0x00020000
  s_add_u32 s72, s38, 173080576
  s_addc_u32 s73, s39, 0
  s_mov_b32 s74, 49152
  s_mov_b32 s75, 0x00020000
  v_lshrrev_b32 v8, 5, v1
  v_or_b32 v9, 0, v8
  v_and_b32 v10, 31, v1
  v_lshlrev_b32 v9, 1, v9
  v_xor_b32 v10, v10, v9
  v_mul_u32_u24 v9, 6554, v10
  v_lshrrev_b32 v9, 16, v9
  v_mul_u32_u24 v11, 1120, v9
  v_lshl_add_u32 v11, v10, 4, v11
  v_mul_u32_u24 v8, 3840, v8
  v_add_u32 v11, v11, v8
  v_mov_b32 v9, 1073741824
  v_cmp_gt_u32 vcc, 30, v10
  s_nop 1
  v_cndmask_b32 v4, v9, v11, vcc
  v_lshrrev_b32 v8, 5, v1
  v_or_b32 v9, 2, v8
  v_and_b32 v10, 31, v1
  v_lshlrev_b32 v9, 1, v9
  v_xor_b32 v10, v10, v9
  v_mul_u32_u24 v9, 6554, v10
  v_lshrrev_b32 v9, 16, v9
  v_mul_u32_u24 v11, 1120, v9
  v_lshl_add_u32 v11, v10, 4, v11
  v_mul_u32_u24 v8, 3840, v8
  v_add_u32 v11, v11, v8
  v_mov_b32 v9, 1073741824
  v_cmp_gt_u32 vcc, 30, v10
  s_nop 1
  v_cndmask_b32 v5, v9, v11, vcc
  v_lshrrev_b32 v8, 5, v1
  v_or_b32 v9, 4, v8
  v_and_b32 v10, 31, v1
  v_lshlrev_b32 v9, 1, v9
  v_xor_b32 v10, v10, v9
  v_mul_u32_u24 v9, 6554, v10
  v_lshrrev_b32 v9, 16, v9
  v_mul_u32_u24 v11, 1120, v9
  v_lshl_add_u32 v11, v10, 4, v11
  v_mul_u32_u24 v8, 3840, v8
  v_add_u32 v11, v11, v8
  v_mov_b32 v9, 1073741824
  v_cmp_gt_u32 vcc, 30, v10
  s_nop 1
  v_cndmask_b32 v6, v9, v11, vcc
  v_lshrrev_b32 v8, 5, v1
  v_or_b32 v9, 6, v8
  v_and_b32 v10, 31, v1
  v_lshlrev_b32 v9, 1, v9
  v_xor_b32 v10, v10, v9
  v_mul_u32_u24 v9, 6554, v10
  v_lshrrev_b32 v9, 16, v9
  v_mul_u32_u24 v11, 1120, v9
  v_lshl_add_u32 v11, v10, 4, v11
  v_mul_u32_u24 v8, 3840, v8
  v_add_u32 v11, v11, v8
  v_mov_b32 v9, 1073741824
  v_cmp_gt_u32 vcc, 30, v10
  s_nop 1
  v_cndmask_b32 v7, v9, v11, vcc
  s_mul_i32 s44, s41, 160
  s_mul_i32 s21, s20, 122880
  s_add_u32 s44, s44, s21
  s_lshl_b32 s45, s20, 14
  s_add_u32 s21, s44, 0
  s_add_u32 m0, s45, 0
  s_nop 0
  buffer_load_dwordx4 v4, s[12:15], s21 offen lds
  s_add_u32 s21, s44, 7680
  s_add_u32 m0, s45, 1024
  s_nop 0
  buffer_load_dwordx4 v5, s[12:15], s21 offen lds
  s_add_u32 s21, s44, 15360
  s_add_u32 m0, s45, 2048
  s_nop 0
  buffer_load_dwordx4 v4, s[12:15], s21 offen lds
  s_add_u32 s21, s44, 23040
  s_add_u32 m0, s45, 3072
  s_nop 0
  buffer_load_dwordx4 v5, s[12:15], s21 offen lds
  s_add_u32 s21, s44, 30720
  s_add_u32 m0, s45, 4096
  s_nop 0
  buffer_load_dwordx4 v6, s[12:15], s21 offen lds
  s_add_u32 s21, s44, 38400
  s_add_u32 m0, s45, 5120
  s_nop 0
  buffer_load_dwordx4 v7, s[12:15], s21 offen lds
  s_add_u32 s21, s44, 46080
  s_add_u32 m0, s45, 6144
  s_nop 0
  buffer_load_dwordx4 v6, s[12:15], s21 offen lds
  s_add_u32 s21, s44, 53760
  s_add_u32 m0, s45, 7168
  s_nop 0
  buffer_load_dwordx4 v7, s[12:15], s21 offen lds
  s_add_u32 s21, s44, 61440
  s_add_u32 m0, s45, 8192
  s_nop 0
  buffer_load_dwordx4 v4, s[12:15], s21 offen lds
  s_add_u32 s21, s44, 69120
  s_add_u32 m0, s45, 9216
  s_nop 0
  buffer_load_dwordx4 v5, s[12:15], s21 offen lds
  s_add_u32 s21, s44, 76800
  s_add_u32 m0, s45, 10240
  s_nop 0
  buffer_load_dwordx4 v4, s[12:15], s21 offen lds
  s_add_u32 s21, s44, 84480
  s_add_u32 m0, s45, 11264
  s_nop 0
  buffer_load_dwordx4 v5, s[12:15], s21 offen lds
  s_add_u32 s21, s44, 92160
  s_add_u32 m0, s45, 12288
  s_nop 0
  buffer_load_dwordx4 v6, s[12:15], s21 offen lds
  s_add_u32 s21, s44, 99840
  s_add_u32 m0, s45, 13312
  s_nop 0
  buffer_load_dwordx4 v7, s[12:15], s21 offen lds
  s_add_u32 s21, s44, 107520
  s_add_u32 m0, s45, 14336
  s_nop 0
  buffer_load_dwordx4 v6, s[12:15], s21 offen lds
  s_add_u32 s21, s44, 115200
  s_add_u32 m0, s45, 15360
  s_nop 0
  buffer_load_dwordx4 v7, s[12:15], s21 offen lds
  s_add_u32 s21, s44, 491520
  s_add_u32 m0, s45, 65536
  s_nop 0
  buffer_load_dwordx4 v4, s[12:15], s21 offen lds
  s_add_u32 s21, s44, 499200
  s_add_u32 m0, s45, 66560
  s_nop 0
  buffer_load_dwordx4 v5, s[12:15], s21 offen lds
  s_add_u32 s21, s44, 506880
  s_add_u32 m0, s45, 67584
  s_nop 0
  buffer_load_dwordx4 v4, s[12:15], s21 offen lds
  s_add_u32 s21, s44, 514560
  s_add_u32 m0, s45, 68608
  s_nop 0
  buffer_load_dwordx4 v5, s[12:15], s21 offen lds
  s_add_u32 s21, s44, 522240
  s_add_u32 m0, s45, 69632
  s_nop 0
  buffer_load_dwordx4 v6, s[12:15], s21 offen lds
  s_add_u32 s21, s44, 529920
  s_add_u32 m0, s45, 70656
  s_nop 0
  buffer_load_dwordx4 v7, s[12:15], s21 offen lds
  s_add_u32 s21, s44, 537600
  s_add_u32 m0, s45, 71680
  s_nop 0
  buffer_load_dwordx4 v6, s[12:15], s21 offen lds
  s_add_u32 s21, s44, 545280
  s_add_u32 m0, s45, 72704
  s_nop 0
  buffer_load_dwordx4 v7, s[12:15], s21 offen lds
  s_add_u32 s21, s44, 552960
  s_add_u32 m0, s45, 73728
  s_nop 0
  buffer_load_dwordx4 v4, s[12:15], s21 offen lds
  s_add_u32 s21, s44, 560640
  s_add_u32 m0, s45, 74752
  s_nop 0
  buffer_load_dwordx4 v5, s[12:15], s21 offen lds
  s_add_u32 s21, s44, 568320
  s_add_u32 m0, s45, 75776
  s_nop 0
  buffer_load_dwordx4 v4, s[12:15], s21 offen lds
  s_add_u32 s21, s44, 576000
  s_add_u32 m0, s45, 76800
  s_nop 0
  buffer_load_dwordx4 v5, s[12:15], s21 offen lds
  s_add_u32 s21, s44, 583680
  s_add_u32 m0, s45, 77824
  s_nop 0
  buffer_load_dwordx4 v6, s[12:15], s21 offen lds
  s_add_u32 s21, s44, 591360
  s_add_u32 m0, s45, 78848
  s_nop 0
  buffer_load_dwordx4 v7, s[12:15], s21 offen lds
  s_add_u32 s21, s44, 599040
  s_add_u32 m0, s45, 79872
  s_nop 0
  buffer_load_dwordx4 v6, s[12:15], s21 offen lds
  s_add_u32 s21, s44, 606720
  s_add_u32 m0, s45, 80896
  s_nop 0
  buffer_load_dwordx4 v7, s[12:15], s21 offen lds
  s_add_u32 s21, s44, 983040
  buffer_load_dwordx4 v[64:67], v4, s[12:15], s21 offen
  s_add_u32 s21, s44, 990720
  buffer_load_dwordx4 v[68:71], v5, s[12:15], s21 offen
  s_add_u32 s21, s44, 998400
  buffer_load_dwordx4 v[72:75], v4, s[12:15], s21 offen
  s_add_u32 s21, s44, 1006080
  buffer_load_dwordx4 v[76:79], v5, s[12:15], s21 offen
  s_add_u32 s21, s44, 1013760
  buffer_load_dwordx4 v[80:83], v6, s[12:15], s21 offen
  s_add_u32 s21, s44, 1021440
  buffer_load_dwordx4 v[84:87], v7, s[12:15], s21 offen
  s_add_u32 s21, s44, 1029120
  buffer_load_dwordx4 v[88:91], v6, s[12:15], s21 offen
  s_add_u32 s21, s44, 1036800
  buffer_load_dwordx4 v[92:95], v7, s[12:15], s21 offen
  s_add_u32 s21, s44, 1044480
  buffer_load_dwordx4 v[96:99], v4, s[12:15], s21 offen
  s_add_u32 s21, s44, 1052160
  buffer_load_dwordx4 v[100:103], v5, s[12:15], s21 offen
  s_add_u32 s21, s44, 1059840
  buffer_load_dwordx4 v[104:107], v4, s[12:15], s21 offen
  s_add_u32 s21, s44, 1067520
  buffer_load_dwordx4 v[108:111], v5, s[12:15], s21 offen
  s_add_u32 s21, s44, 1075200
  buffer_load_dwordx4 v[112:115], v6, s[12:15], s21 offen
  s_add_u32 s21, s44, 1082880
  buffer_load_dwordx4 v[116:119], v7, s[12:15], s21 offen
  s_add_u32 s21, s44, 1090560
  buffer_load_dwordx4 v[120:123], v6, s[12:15], s21 offen
  s_add_u32 s21, s44, 1098240
  buffer_load_dwordx4 v[124:127], v7, s[12:15], s21 offen
  v_lshrrev_b32 v8, 2, v2
  v_and_b32 v9, 1, v3
  v_lshl_add_u32 v9, v9, 2, v8
  v_lshlrev_b32 v9, 5, v9
  v_lshl_add_u32 v8, v3, 3, v8
  v_lshlrev_b32 v8, 9, v8
  v_and_b32 v10, 3, v2
  s_mul_i32 s21, s20, 40
  v_lshl_add_u32 v11, v10, 3, s21
  v_add_u32 v11, 0, v11
  v_xor_b32 v11, v11, v9
  v_add_u32 v12, v11, v8
  v_add_u32 v16, 65536, v12
  v_lshl_add_u32 v11, v10, 3, s21
  v_add_u32 v11, 160, v11
  v_xor_b32 v11, v11, v9
  v_add_u32 v13, v11, v8
  v_add_u32 v17, 65536, v13
  v_mul_u32_u24 v11, 160, v10
  v_add3_u32 v11, v11, 32, s21
  v_min_u32 v11, 480, v11
  v_xor_b32 v11, v11, v9
  v_add_u32 v14, v11, v8
  v_add_u32 v18, 65536, v14
  v_lshl_add_u32 v11, v10, 3, s21
  v_add_u32 v11, 320, v11
  v_xor_b32 v11, v11, v9
  v_add_u32 v15, v11, v8
  v_add_u32 v19, 65536, v15
  v_lshl_add_u32 v23, v1, 4, s45
  v_add_u32 v29, 65536, v23
  s_waitcnt vmcnt(32)
  s_add_u32 s21, s44, 1474560
  buffer_load_dwordx4 v[128:131], v4, s[12:15], s21 offen
  s_add_u32 s21, s44, 1482240
  buffer_load_dwordx4 v[132:135], v5, s[12:15], s21 offen
  s_add_u32 s21, s44, 1489920
  buffer_load_dwordx4 v[136:139], v4, s[12:15], s21 offen
  s_add_u32 s21, s44, 1497600
  buffer_load_dwordx4 v[140:143], v5, s[12:15], s21 offen
  s_add_u32 s21, s44, 1505280
  buffer_load_dwordx4 v[144:147], v6, s[12:15], s21 offen
  s_add_u32 s21, s44, 1512960
  buffer_load_dwordx4 v[148:151], v7, s[12:15], s21 offen
  s_add_u32 s21, s44, 1520640
  buffer_load_dwordx4 v[152:155], v6, s[12:15], s21 offen
  s_add_u32 s21, s44, 1528320
  buffer_load_dwordx4 v[156:159], v7, s[12:15], s21 offen
  s_add_u32 s21, s44, 1536000
  buffer_load_dwordx4 v[160:163], v4, s[12:15], s21 offen
  s_add_u32 s21, s44, 1543680
  buffer_load_dwordx4 v[164:167], v5, s[12:15], s21 offen
  s_add_u32 s21, s44, 1551360
  buffer_load_dwordx4 v[168:171], v4, s[12:15], s21 offen
  s_add_u32 s21, s44, 1559040
  buffer_load_dwordx4 v[172:175], v5, s[12:15], s21 offen
  s_add_u32 s21, s44, 1566720
  buffer_load_dwordx4 v[176:179], v6, s[12:15], s21 offen
  s_add_u32 s21, s44, 1574400
  buffer_load_dwordx4 v[180:183], v7, s[12:15], s21 offen
  s_add_u32 s21, s44, 1582080
  buffer_load_dwordx4 v[184:187], v6, s[12:15], s21 offen
  s_add_u32 s21, s44, 1589760
  buffer_load_dwordx4 v[188:191], v7, s[12:15], s21 offen
  s_barrier
  ds_read_b64_tr_b16 a[0:1], v12 offset:0
  ds_read_b64_tr_b16 a[2:3], v12 offset:2048
  ds_read_b64_tr_b16 a[4:5], v13 offset:0
  ds_read_b64_tr_b16 a[6:7], v13 offset:2048
  ds_read_b64_tr_b16 a[8:9], v14 offset:0
  ds_read_b64_tr_b16 a[10:11], v14 offset:2048
  ds_read_b64_tr_b16 a[12:13], v15 offset:0
  ds_read_b64_tr_b16 a[14:15], v15 offset:2048
  ds_read_b64_tr_b16 a[16:17], v12 offset:16384
  ds_read_b64_tr_b16 a[18:19], v12 offset:18432
  ds_read_b64_tr_b16 a[20:21], v13 offset:16384
  ds_read_b64_tr_b16 a[22:23], v13 offset:18432
  ds_read_b64_tr_b16 a[24:25], v14 offset:16384
  ds_read_b64_tr_b16 a[26:27], v14 offset:18432
  ds_read_b64_tr_b16 a[28:29], v15 offset:16384
  ds_read_b64_tr_b16 a[30:31], v15 offset:18432
  ds_read_b64_tr_b16 a[32:33], v12 offset:32768
  ds_read_b64_tr_b16 a[34:35], v12 offset:34816
  ds_read_b64_tr_b16 a[36:37], v13 offset:32768
  ds_read_b64_tr_b16 a[38:39], v13 offset:34816
  ds_read_b64_tr_b16 a[40:41], v14 offset:32768
  ds_read_b64_tr_b16 a[42:43], v14 offset:34816
  ds_read_b64_tr_b16 a[44:45], v15 offset:32768
  ds_read_b64_tr_b16 a[46:47], v15 offset:34816
  ds_read_b64_tr_b16 a[48:49], v12 offset:49152
  ds_read_b64_tr_b16 a[50:51], v12 offset:51200
  ds_read_b64_tr_b16 a[52:53], v13 offset:49152
  ds_read_b64_tr_b16 a[54:55], v13 offset:51200
  ds_read_b64_tr_b16 a[56:57], v14 offset:49152
  ds_read_b64_tr_b16 a[58:59], v14 offset:51200
  ds_read_b64_tr_b16 a[60:61], v15 offset:49152
  ds_read_b64_tr_b16 a[62:63], v15 offset:51200
  s_waitcnt lgkmcnt(0)
  s_barrier
  s_waitcnt vmcnt(32)
  s_add_u32 s21, s44, 1966080
  buffer_load_dwordx4 v[192:195], v4, s[12:15], s21 offen
  s_add_u32 s21, s44, 1973760
  buffer_load_dwordx4 v[196:199], v5, s[12:15], s21 offen
  s_add_u32 s21, s44, 1981440
  buffer_load_dwordx4 v[200:203], v4, s[12:15], s21 offen
  s_add_u32 s21, s44, 1989120
  buffer_load_dwordx4 v[204:207], v5, s[12:15], s21 offen
  s_add_u32 s21, s44, 1996800
  buffer_load_dwordx4 v[208:211], v6, s[12:15], s21 offen
  s_add_u32 s21, s44, 2004480
  buffer_load_dwordx4 v[212:215], v7, s[12:15], s21 offen
  s_add_u32 s21, s44, 2012160
  buffer_load_dwordx4 v[216:219], v6, s[12:15], s21 offen
  s_add_u32 s21, s44, 2019840
  buffer_load_dwordx4 v[220:223], v7, s[12:15], s21 offen
  s_add_u32 s21, s44, 2027520
  buffer_load_dwordx4 v[224:227], v4, s[12:15], s21 offen
  s_add_u32 s21, s44, 2035200
  buffer_load_dwordx4 v[228:231], v5, s[12:15], s21 offen
  s_add_u32 s21, s44, 2042880
  buffer_load_dwordx4 v[232:235], v4, s[12:15], s21 offen
  s_add_u32 s21, s44, 2050560
  buffer_load_dwordx4 v[236:239], v5, s[12:15], s21 offen
  s_add_u32 s21, s44, 2058240
  buffer_load_dwordx4 v[240:243], v6, s[12:15], s21 offen
  s_add_u32 s21, s44, 2065920
  buffer_load_dwordx4 v[244:247], v7, s[12:15], s21 offen
  s_add_u32 s21, s44, 2073600
  buffer_load_dwordx4 v[248:251], v6, s[12:15], s21 offen
  s_add_u32 s21, s44, 2081280
  buffer_load_dwordx4 v[252:255], v7, s[12:15], s21 offen
  s_barrier
  ds_read_b64_tr_b16 a[64:65], v16 offset:0
  ds_read_b64_tr_b16 a[66:67], v16 offset:2048
  ds_read_b64_tr_b16 a[68:69], v17 offset:0
  ds_read_b64_tr_b16 a[70:71], v17 offset:2048
  ds_read_b64_tr_b16 a[72:73], v18 offset:0
  ds_read_b64_tr_b16 a[74:75], v18 offset:2048
  ds_read_b64_tr_b16 a[76:77], v19 offset:0
  ds_read_b64_tr_b16 a[78:79], v19 offset:2048
  ds_read_b64_tr_b16 a[80:81], v16 offset:16384
  ds_read_b64_tr_b16 a[82:83], v16 offset:18432
  ds_read_b64_tr_b16 a[84:85], v17 offset:16384
  ds_read_b64_tr_b16 a[86:87], v17 offset:18432
  ds_read_b64_tr_b16 a[88:89], v18 offset:16384
  ds_read_b64_tr_b16 a[90:91], v18 offset:18432
  ds_read_b64_tr_b16 a[92:93], v19 offset:16384
  ds_read_b64_tr_b16 a[94:95], v19 offset:18432
  ds_read_b64_tr_b16 a[96:97], v16 offset:32768
  ds_read_b64_tr_b16 a[98:99], v16 offset:34816
  ds_read_b64_tr_b16 a[100:101], v17 offset:32768
  ds_read_b64_tr_b16 a[102:103], v17 offset:34816
  ds_read_b64_tr_b16 a[104:105], v18 offset:32768
  ds_read_b64_tr_b16 a[106:107], v18 offset:34816
  ds_read_b64_tr_b16 a[108:109], v19 offset:32768
  ds_read_b64_tr_b16 a[110:111], v19 offset:34816
  ds_read_b64_tr_b16 a[112:113], v16 offset:49152
  ds_read_b64_tr_b16 a[114:115], v16 offset:51200
  ds_read_b64_tr_b16 a[116:117], v17 offset:49152
  ds_read_b64_tr_b16 a[118:119], v17 offset:51200
  ds_read_b64_tr_b16 a[120:121], v18 offset:49152
  ds_read_b64_tr_b16 a[122:123], v18 offset:51200
  ds_read_b64_tr_b16 a[124:125], v19 offset:49152
  ds_read_b64_tr_b16 a[126:127], v19 offset:51200
  s_waitcnt lgkmcnt(0)
  s_barrier
  s_waitcnt vmcnt(32)
  ds_write_b128 v23, v[64:67] offset:0
  ds_write_b128 v23, v[68:71] offset:1024
  ds_write_b128 v23, v[72:75] offset:2048
  ds_write_b128 v23, v[76:79] offset:3072
  ds_write_b128 v23, v[80:83] offset:4096
  ds_write_b128 v23, v[84:87] offset:5120
  ds_write_b128 v23, v[88:91] offset:6144
  ds_write_b128 v23, v[92:95] offset:7168
  ds_write_b128 v23, v[96:99] offset:8192
  ds_write_b128 v23, v[100:103] offset:9216
  ds_write_b128 v23, v[104:107] offset:10240
  ds_write_b128 v23, v[108:111] offset:11264
  ds_write_b128 v23, v[112:115] offset:12288
  ds_write_b128 v23, v[116:119] offset:13312
  ds_write_b128 v23, v[120:123] offset:14336
  ds_write_b128 v23, v[124:127] offset:15360
  s_waitcnt lgkmcnt(0)
  s_barrier
  ds_read_b64_tr_b16 a[128:129], v12 offset:0
  ds_read_b64_tr_b16 a[130:131], v12 offset:2048
  ds_read_b64_tr_b16 a[132:133], v13 offset:0
  ds_read_b64_tr_b16 a[134:135], v13 offset:2048
  ds_read_b64_tr_b16 a[136:137], v14 offset:0
  ds_read_b64_tr_b16 a[138:139], v14 offset:2048
  ds_read_b64_tr_b16 a[140:141], v15 offset:0
  ds_read_b64_tr_b16 a[142:143], v15 offset:2048
  ds_read_b64_tr_b16 a[144:145], v12 offset:16384
  ds_read_b64_tr_b16 a[146:147], v12 offset:18432
  ds_read_b64_tr_b16 a[148:149], v13 offset:16384
  ds_read_b64_tr_b16 a[150:151], v13 offset:18432
  ds_read_b64_tr_b16 a[152:153], v14 offset:16384
  ds_read_b64_tr_b16 a[154:155], v14 offset:18432
  ds_read_b64_tr_b16 a[156:157], v15 offset:16384
  ds_read_b64_tr_b16 a[158:159], v15 offset:18432
  ds_read_b64_tr_b16 a[160:161], v12 offset:32768
  ds_read_b64_tr_b16 a[162:163], v12 offset:34816
  ds_read_b64_tr_b16 a[164:165], v13 offset:32768
  ds_read_b64_tr_b16 a[166:167], v13 offset:34816
  ds_read_b64_tr_b16 a[168:169], v14 offset:32768
  ds_read_b64_tr_b16 a[170:171], v14 offset:34816
  ds_read_b64_tr_b16 a[172:173], v15 offset:32768
  ds_read_b64_tr_b16 a[174:175], v15 offset:34816
  ds_read_b64_tr_b16 a[176:177], v12 offset:49152
  ds_read_b64_tr_b16 a[178:179], v12 offset:51200
  ds_read_b64_tr_b16 a[180:181], v13 offset:49152
  ds_read_b64_tr_b16 a[182:183], v13 offset:51200
  ds_read_b64_tr_b16 a[184:185], v14 offset:49152
  ds_read_b64_tr_b16 a[186:187], v14 offset:51200
  ds_read_b64_tr_b16 a[188:189], v15 offset:49152
  ds_read_b64_tr_b16 a[190:191], v15 offset:51200
  s_waitcnt lgkmcnt(0)
  s_barrier
  s_waitcnt vmcnt(16)
  s_load_dwordx2 s[24:25], s[0:1], 0
  v_lshlrev_b32 v32, 7, v1
  s_lshl_b32 s23, s2, 2
  s_add_u32 s23, s23, s20
  s_mul_i32 s23, s23, 20480
  s_add_u32 s23, s23, 0
  s_waitcnt lgkmcnt(0)
  s_mov_b32 s24, s24
  s_mov_b32 s25, s25
  s_mov_b32 s26, 2621440
  s_mov_b32 s27, 0x00020000
  buffer_load_dword v33, v32, s[24:27], s23 offen
  s_add_u32 s23, s23, 8192
  buffer_load_dword v33, v32, s[24:27], s23 offen
  s_add_u32 s23, s23, 8192
  buffer_load_dword v33, v32, s[24:27], s23 offen
  s_add_u32 s23, s23, 8192
  s_load_dwordx2 s[24:25], s[0:1], 72
  v_lshlrev_b32 v32, 7, v1
  s_lshl_b32 s23, s2, 2
  s_add_u32 s23, s23, s20
  s_mul_i32 s23, s23, 6400
  s_add_u32 s23, s23, 0
  s_waitcnt lgkmcnt(0)
  s_mov_b32 s24, s24
  s_mov_b32 s25, s25
  s_mov_b32 s26, 819200
  s_mov_b32 s27, 0x00020000
  buffer_load_dword v33, v32, s[24:27], s23 offen
  s_add_u32 s23, s23, 8192
  ds_write_b128 v29, v[128:131] offset:0
  ds_write_b128 v29, v[132:135] offset:1024
  ds_write_b128 v29, v[136:139] offset:2048
  ds_write_b128 v29, v[140:143] offset:3072
  ds_write_b128 v29, v[144:147] offset:4096
  ds_write_b128 v29, v[148:151] offset:5120
  ds_write_b128 v29, v[152:155] offset:6144
  ds_write_b128 v29, v[156:159] offset:7168
  ds_write_b128 v29, v[160:163] offset:8192
  ds_write_b128 v29, v[164:167] offset:9216
  ds_write_b128 v29, v[168:171] offset:10240
  ds_write_b128 v29, v[172:175] offset:11264
  ds_write_b128 v29, v[176:179] offset:12288
  ds_write_b128 v29, v[180:183] offset:13312
  ds_write_b128 v29, v[184:187] offset:14336
  ds_write_b128 v29, v[188:191] offset:15360
  s_waitcnt lgkmcnt(0)
  s_barrier
  ds_read_b64_tr_b16 a[192:193], v16 offset:0
  ds_read_b64_tr_b16 a[194:195], v16 offset:2048
  ds_read_b64_tr_b16 a[196:197], v17 offset:0
  ds_read_b64_tr_b16 a[198:199], v17 offset:2048
  ds_read_b64_tr_b16 a[200:201], v18 offset:0
  ds_read_b64_tr_b16 a[202:203], v18 offset:2048
  ds_read_b64_tr_b16 a[204:205], v19 offset:0
  ds_read_b64_tr_b16 a[206:207], v19 offset:2048
  ds_read_b64_tr_b16 a[208:209], v16 offset:16384
  ds_read_b64_tr_b16 a[210:211], v16 offset:18432
  ds_read_b64_tr_b16 a[212:213], v17 offset:16384
  ds_read_b64_tr_b16 a[214:215], v17 offset:18432
  ds_read_b64_tr_b16 a[216:217], v18 offset:16384
  ds_read_b64_tr_b16 a[218:219], v18 offset:18432
  ds_read_b64_tr_b16 a[220:221], v19 offset:16384
  ds_read_b64_tr_b16 a[222:223], v19 offset:18432
  ds_read_b64_tr_b16 a[224:225], v16 offset:32768
  ds_read_b64_tr_b16 a[226:227], v16 offset:34816
  ds_read_b64_tr_b16 a[228:229], v17 offset:32768
  ds_read_b64_tr_b16 a[230:231], v17 offset:34816
  ds_read_b64_tr_b16 a[232:233], v18 offset:32768
  ds_read_b64_tr_b16 a[234:235], v18 offset:34816
  ds_read_b64_tr_b16 a[236:237], v19 offset:32768
  ds_read_b64_tr_b16 a[238:239], v19 offset:34816
  ds_read_b64_tr_b16 a[240:241], v16 offset:49152
  ds_read_b64_tr_b16 a[242:243], v16 offset:51200
  ds_read_b64_tr_b16 a[244:245], v17 offset:49152
  ds_read_b64_tr_b16 a[246:247], v17 offset:51200
  ds_read_b64_tr_b16 a[248:249], v18 offset:49152
  ds_read_b64_tr_b16 a[250:251], v18 offset:51200
  ds_read_b64_tr_b16 a[252:253], v19 offset:49152
  ds_read_b64_tr_b16 a[254:255], v19 offset:51200
  s_waitcnt lgkmcnt(0)
  s_barrier
  s_waitcnt vmcnt(4)
  ds_write_b128 v23, v[192:195] offset:0
  ds_write_b128 v23, v[196:199] offset:1024
  ds_write_b128 v23, v[200:203] offset:2048
  ds_write_b128 v23, v[204:207] offset:3072
  ds_write_b128 v23, v[208:211] offset:4096
  ds_write_b128 v23, v[212:215] offset:5120
  ds_write_b128 v23, v[216:219] offset:6144
  ds_write_b128 v23, v[220:223] offset:7168
  ds_write_b128 v23, v[224:227] offset:8192
  ds_write_b128 v23, v[228:231] offset:9216
  ds_write_b128 v23, v[232:235] offset:10240
  ds_write_b128 v23, v[236:239] offset:11264
  ds_write_b128 v23, v[240:243] offset:12288
  ds_write_b128 v23, v[244:247] offset:13312
  ds_write_b128 v23, v[248:251] offset:14336
  ds_write_b128 v23, v[252:255] offset:15360
  s_waitcnt lgkmcnt(0)
  s_barrier
  ds_read_b64_tr_b16 v[192:193], v12 offset:0
  ds_read_b64_tr_b16 v[194:195], v12 offset:2048
  ds_read_b64_tr_b16 v[196:197], v13 offset:0
  ds_read_b64_tr_b16 v[198:199], v13 offset:2048
  ds_read_b64_tr_b16 v[200:201], v14 offset:0
  ds_read_b64_tr_b16 v[202:203], v14 offset:2048
  ds_read_b64_tr_b16 v[204:205], v15 offset:0
  ds_read_b64_tr_b16 v[206:207], v15 offset:2048
  ds_read_b64_tr_b16 v[208:209], v12 offset:16384
  ds_read_b64_tr_b16 v[210:211], v12 offset:18432
  ds_read_b64_tr_b16 v[212:213], v13 offset:16384
  ds_read_b64_tr_b16 v[214:215], v13 offset:18432
  ds_read_b64_tr_b16 v[216:217], v14 offset:16384
  ds_read_b64_tr_b16 v[218:219], v14 offset:18432
  ds_read_b64_tr_b16 v[220:221], v15 offset:16384
  ds_read_b64_tr_b16 v[222:223], v15 offset:18432
  ds_read_b64_tr_b16 v[224:225], v12 offset:32768
  ds_read_b64_tr_b16 v[226:227], v12 offset:34816
  ds_read_b64_tr_b16 v[228:229], v13 offset:32768
  ds_read_b64_tr_b16 v[230:231], v13 offset:34816
  ds_read_b64_tr_b16 v[232:233], v14 offset:32768
  ds_read_b64_tr_b16 v[234:235], v14 offset:34816
  ds_read_b64_tr_b16 v[236:237], v15 offset:32768
  ds_read_b64_tr_b16 v[238:239], v15 offset:34816
  ds_read_b64_tr_b16 v[240:241], v12 offset:49152
  ds_read_b64_tr_b16 v[242:243], v12 offset:51200
  ds_read_b64_tr_b16 v[244:245], v13 offset:49152
  ds_read_b64_tr_b16 v[246:247], v13 offset:51200
  ds_read_b64_tr_b16 v[248:249], v14 offset:49152
  ds_read_b64_tr_b16 v[250:251], v14 offset:51200
  ds_read_b64_tr_b16 v[252:253], v15 offset:49152
  ds_read_b64_tr_b16 v[254:255], v15 offset:51200
  s_waitcnt lgkmcnt(0)
  s_barrier
  s_load_dwordx2 s[32:33], s[0:1], 96
  s_waitcnt lgkmcnt(0)
  s_mov_b32 s32, s32
  s_mov_b32 s33, s33
  s_mov_b32 s34, 256
  s_mov_b32 s35, 0x00020000
  s_mov_b32 s21, 76
  v_mov_b32 v4, 0
  s_mov_b32 s101, 0
wf_261:
  buffer_load_dword v5, v4, s[32:35], s21 offen sc1
  s_add_u32 s101, s101, 1
  s_cmp_gt_u32 s101, 131072
  s_cbranch_scc1 main_end
  s_waitcnt vmcnt(0)
  v_readfirstlane_b32 s100, v5
  s_cmp_ge_u32 s100, 1
  s_cbranch_scc1 wf_262
  s_sleep 8
  s_branch wf_261
wf_262:
  s_sub_u32 s80, s100, 1
  s_lshl_b32 s80, s80, 13
  v_lshrrev_b32 v8, 3, v1
  v_and_b32 v9, 7, v1
  v_xor_b32 v9, v9, v8
  s_and_b32 s21, s20, 1
  s_lshl_b32 s21, s21, 4
  s_lshr_b32 s22, s20, 1
  s_add_u32 s21, s21, s22
  v_lshl_add_u32 v8, v8, 1, s21
  v_mul_u32_u24 v8, 1280, v8
  v_lshl_add_u32 v4, v9, 4, v8
  s_lshl_b32 s31, s20, 10
  s_mul_i32 s30, s42, 655360
  s_sub_u32 s46, s30, 40960
  s_cmp_eq_u32 s42, 0
  s_cselect_b32 s46, 1073741824, s46
  s_add_u32 m0, s31, 0
  s_nop 0
  buffer_load_dwordx4 v4, s[8:11], s46 offen offset:0 lds
  s_add_u32 m0, s31, 3968
  s_nop 0
  buffer_load_dwordx4 v4, s[8:11], s46 offen offset:128 lds
  s_add_u32 m0, s31, 7936
  s_nop 0
  buffer_load_dwordx4 v4, s[8:11], s46 offen offset:256 lds
  s_add_u32 m0, s31, 11904
  s_nop 0
  buffer_load_dwordx4 v4, s[8:11], s46 offen offset:384 lds
  s_add_u32 m0, s31, 15872
  s_nop 0
  buffer_load_dwordx4 v4, s[8:11], s46 offen offset:512 lds
  s_add_u32 m0, s31, 19840
  s_nop 0
  buffer_load_dwordx4 v4, s[8:11], s46 offen offset:640 lds
  s_add_u32 m0, s31, 23808
  s_nop 0
  buffer_load_dwordx4 v4, s[8:11], s46 offen offset:768 lds
  s_add_u32 m0, s31, 27776
  s_nop 0
  buffer_load_dwordx4 v4, s[8:11], s46 offen offset:896 lds
  s_add_u32 m0, s31, 31744
  s_nop 0
  buffer_load_dwordx4 v4, s[8:11], s46 offen offset:1024 lds
  s_add_u32 m0, s31, 35712
  s_nop 0
  buffer_load_dwordx4 v4, s[8:11], s46 offen offset:1152 lds
  s_add_u32 s31, s31, 40960
  s_add_u32 m0, s31, 0
  s_nop 0
  buffer_load_dwordx4 v4, s[8:11], s30 offen offset:0 lds
  s_add_u32 m0, s31, 3968
  s_nop 0
  buffer_load_dwordx4 v4, s[8:11], s30 offen offset:128 lds
  s_add_u32 m0, s31, 7936
  s_nop 0
  buffer_load_dwordx4 v4, s[8:11], s30 offen offset:256 lds
  s_add_u32 m0, s31, 11904
  s_nop 0
  buffer_load_dwordx4 v4, s[8:11], s30 offen offset:384 lds
  s_add_u32 m0, s31, 15872
  s_nop 0
  buffer_load_dwordx4 v4, s[8:11], s30 offen offset:512 lds
  s_add_u32 m0, s31, 19840
  s_nop 0
  buffer_load_dwordx4 v4, s[8:11], s30 offen offset:640 lds
  s_add_u32 m0, s31, 23808
  s_nop 0
  buffer_load_dwordx4 v4, s[8:11], s30 offen offset:768 lds
  s_add_u32 m0, s31, 27776
  s_nop 0
  buffer_load_dwordx4 v4, s[8:11], s30 offen offset:896 lds
  s_add_u32 m0, s31, 31744
  s_nop 0
  buffer_load_dwordx4 v4, s[8:11], s30 offen offset:1024 lds
  s_add_u32 m0, s31, 35712
  s_nop 0
  buffer_load_dwordx4 v4, s[8:11], s30 offen offset:1152 lds
  s_add_u32 s31, s31, 40960
  s_add_u32 s30, s30, 40960
  v_and_b32 v10, 7, v2
  v_add_u32 v8, 0, v3
  v_xor_b32 v8, v8, v10
  v_lshlrev_b32 v8, 4, v8
  v_lshl_add_u32 v5, v2, 7, v8
  v_add_u32 v8, 4, v3
  v_xor_b32 v8, v8, v10
  v_lshlrev_b32 v8, 4, v8
  v_lshl_add_u32 v6, v2, 7, v8
  v_mov_b32 v7, v5
  v_mov_b32 v8, v6
  s_mov_b32 s33, 0
  v_lshlrev_b32 v15, 4, v1
  v_mov_b32 v16, 0xf149f2ca
  v_lshrrev_b32 v17, 3, v2
  v_mul_u32_u24 v17, 2560, v17
  v_lshlrev_b32 v18, 1, v10
  s_lshr_b32 s21, s20, 1
  s_lshl_b32 s21, s21, 10
  s_and_b32 s22, s20, 1
  s_lshl_b32 s22, s22, 3
  s_add_u32 s21, s21, s22
  s_add_u32 s21, s21, 131072
  v_lshl_add_u32 v9, v3, 4, v18
  v_lshl_add_u32 v9, v9, 4, v17
  v_add_u32 v9, s21, v9
  s_lshl_b32 s21, s20, 7
  s_add_u32 s21, s21, 133120
  v_lshl_add_u32 v10, v18, 3, v17
  v_add_u32 v10, s21, v10
  v_cmp_eq_u32 vcc, 2, v3
  v_lshlrev_b32 v19, 4, v1
  v_add_u32 v19, 136192, v19
  v_cndmask_b32 v10, v19, v10, vcc
  s_lshr_b32 s21, s20, 1
  s_and_b32 s22, s20, 1
  s_mul_i32 s23, s21, 2560
  s_lshl_b32 s47, s22, 10
  s_add_u32 s47, s47, s23
  s_add_u32 s47, s47, 131072
  v_add_u32 v11, s47, v15
  s_lshl_b32 s47, s22, 8
  s_add_u32 s47, s47, s23
  s_add_u32 s47, s47, 133120
  v_add_u32 v12, s47, v15
  s_mul_i32 s23, s22, 768
  s_sub_u32 s23, 2048, s23
  v_add_u32 v14, s23, v15
  v_mov_b32 v19, 1073741824
  v_cmp_gt_u32 vcc, 16, v1
  s_lshl_b32 s47, s42, 23
  s_lshl_b32 s21, s21, 14
  v_cndmask_b32 v14, v19, v14, vcc
  s_add_u32 s47, s47, s21
  s_lshr_b32 s21, s41, 1
  s_lshl_b32 s21, s21, 15
  s_add_u32 s47, s47, s21
  s_and_b32 s21, s41, 1
  s_mul_i32 s21, s21, 2560
  s_add_u32 s47, s47, s21
  s_xor_b32 s21, s80, 184819712
  s_add_u32 s47, s47, s21
  s_lshl_b32 s22, s22, 10
  s_add_u32 s47, s47, s22
  s_mov_b32 s48, 1073741824
  s_mov_b32 s49, 1073741824
  v_cmp_eq_u32 s[62:63], 0, v3
  v_lshlrev_b32 v17, 2, v3
  v_sub_u32 v17, v17, v2
  s_mov_b32 s82, 0x3e64f92e
  s_mov_b32 s83, 0x3fb8aa3b
  v_mov_b32 v20, 0
  v_mov_b32 v21, 0
  v_mov_b32 v22, 0
  v_mov_b32 v23, 0
  v_add_u32 v18, 7, v17
  v_cmp_gt_u32 s[84:85], 8, v18
  v_cmp_le_i32 s[64:65], 16, v18
  v_mov_b32 v18, 65535
  v_cndmask_b32 v19, 0, v18, s[84:85]
  v_or_b32 v20, v20, v19
  v_cndmask_b32 v19, 0, v18, s[64:65]
  v_or_b32 v22, v22, v19
  s_mov_b64 s[54:55], s[84:85]
  s_or_b64 s[84:85], s[84:85], s[64:65]
  v_add_u32 v18, 8, v17
  v_cmp_gt_u32 s[86:87], 8, v18
  v_cmp_le_i32 s[66:67], 16, v18
  v_mov_b32 v18, 4294901760
  v_cndmask_b32 v19, 0, v18, s[86:87]
  v_or_b32 v20, v20, v19
  v_cndmask_b32 v19, 0, v18, s[66:67]
  v_or_b32 v22, v22, v19
  s_mov_b64 s[56:57], s[86:87]
  s_or_b64 s[86:87], s[86:87], s[66:67]
  v_add_u32 v18, 9, v17
  v_cmp_gt_u32 s[88:89], 8, v18
  v_cmp_le_i32 s[68:69], 16, v18
  v_mov_b32 v18, 65535
  v_cndmask_b32 v19, 0, v18, s[88:89]
  v_or_b32 v21, v21, v19
  v_cndmask_b32 v19, 0, v18, s[68:69]
  v_or_b32 v23, v23, v19
  s_mov_b64 s[58:59], s[88:89]
  s_or_b64 s[88:89], s[88:89], s[68:69]
  v_add_u32 v18, 10, v17
  v_cmp_gt_u32 s[90:91], 8, v18
  v_cmp_le_i32 s[70:71], 16, v18
  v_mov_b32 v18, 4294901760
  v_cndmask_b32 v19, 0, v18, s[90:91]
  v_or_b32 v21, v21, v19
  v_cndmask_b32 v19, 0, v18, s[70:71]
  v_or_b32 v23, v23, v19
  s_mov_b64 s[60:61], s[90:91]
  s_or_b64 s[90:91], s[90:91], s[70:71]
  v_mov_b32 v18, 0x3f80
  v_mov_b32 v19, 0x3f800000
  v_cmp_eq_i32 vcc, 0, v17
  v_cmp_eq_i32 s[22:23], -1, v17
  s_nop 1
  v_cndmask_b32 v24, 0, v18, vcc
  v_cndmask_b32 v24, v24, v19, s[22:23]
  v_cmp_eq_i32 vcc, -2, v17
  v_cmp_eq_i32 s[22:23], -3, v17
  s_nop 1
  v_cndmask_b32 v25, 0, v18, vcc
  v_cndmask_b32 v25, v25, v19, s[22:23]
  v_mov_b32 v26, 0
  v_mov_b32 v27, 0
  v_mov_b32 v60, 0
  v_mov_b32 v61, 0
  v_mov_b32 v62, 0
  v_mov_b32 v63, 0
  v_mov_b32 v64, 0
  v_mov_b32 v65, 0
  v_mov_b32 v66, 0
  v_mov_b32 v67, 0
  v_mov_b32 v68, 0
  v_mov_b32 v69, 0
  v_mov_b32 v70, 0
  v_mov_b32 v71, 0
  v_mov_b32 v72, 0
  v_mov_b32 v73, 0
  v_mov_b32 v74, 0
  v_mov_b32 v75, 0
  v_mov_b32 v76, 0
  v_mov_b32 v77, 0
  v_mov_b32 v78, 0
  v_mov_b32 v79, 0
  v_mov_b32 v80, 0
  v_mov_b32 v81, 0
  v_mov_b32 v82, 0
  v_mov_b32 v83, 0
  v_mov_b32 v84, 0
  v_mov_b32 v85, 0
  v_mov_b32 v86, 0
  v_mov_b32 v87, 0
  v_mov_b32 v88, 0
  v_mov_b32 v89, 0
  v_mov_b32 v90, 0
  v_mov_b32 v91, 0
  v_mov_b32 v92, 0
  v_mov_b32 v93, 0
  v_mov_b32 v94, 0
  v_mov_b32 v95, 0
  v_mov_b32 v96, 0
  v_mov_b32 v97, 0
  v_mov_b32 v98, 0
  v_mov_b32 v99, 0
  v_mov_b32 v100, 0
  v_mov_b32 v101, 0
  v_mov_b32 v102, 0
  v_mov_b32 v103, 0
  v_mov_b32 v104, 0
  v_mov_b32 v105, 0
  v_mov_b32 v106, 0
  v_mov_b32 v107, 0
  v_mov_b32 v108, 0
  v_mov_b32 v109, 0
  v_mov_b32 v110, 0
  v_mov_b32 v111, 0
  v_mov_b32 v112, 0
  v_mov_b32 v113, 0
  v_mov_b32 v114, 0
  v_mov_b32 v115, 0
  v_mov_b32 v116, 0
  v_mov_b32 v117, 0
  v_mov_b32 v118, 0
  v_mov_b32 v119, 0
  v_mov_b32 v120, 0
  v_mov_b32 v121, 0
  v_mov_b32 v122, 0
  v_mov_b32 v123, 0
  v_mov_b32 v124, 0
  v_mov_b32 v125, 0
  v_mov_b32 v126, 0
  v_mov_b32 v127, 0
  v_mov_b32 v128, 0
  v_mov_b32 v129, 0
  v_mov_b32 v130, 0
  v_mov_b32 v131, 0
  s_load_dwordx2 s[36:37], s[0:1], 80
  s_lshl_b32 s50, s41, 2
  s_add_u32 s50, s50, s20
  s_and_b32 s21, s50, 7
  s_waitcnt lgkmcnt(0)
  s_mov_b32 s24, s36
  s_mov_b32 s25, s37
  s_mov_b32 s26, 1280
  s_mov_b32 s27, 0x00020000
  s_add_u32 s76, s38, 175112192
  s_addc_u32 s77, s39, 0
  s_mov_b32 s78, 8192
  s_mov_b32 s79, 0x00020000
  s_lshl_b32 s21, s21, 4
  v_lshlrev_b32 v186, 2, v1
  v_xor_b32 v186, s21, v186
  v_and_b32 v187, 31, v1
  v_lshrrev_b32 v189, 5, v1
  v_lshlrev_b32 v189, 12, v189
  v_lshl_add_u32 v189, v187, 2, v189
  s_lshl_b32 s21, s50, 7
  v_add_u32 v189, s21, v189
  v_mov_b32 v188, v189
  buffer_load_dword v174, v186, s[24:27], 0 offen offset:0
  buffer_load_dword v175, v186, s[24:27], 0 offen offset:256
  buffer_load_dword v176, v186, s[24:27], 0 offen offset:512
  buffer_load_dword v177, v186, s[24:27], 0 offen offset:768
  buffer_load_dword v178, v186, s[24:27], 0 offen offset:1024
  s_load_dwordx2 s[12:13], s[0:1], 16
  s_mul_i32 s51, s2, 384
  s_mul_i32 s21, s20, 1966080
  s_add_u32 s51, s51, s21
  v_mul_u32_u24 v187, 21846, v1
  v_lshrrev_b32 v187, 16, v187
  v_mul_u32_u24 v187, 11904, v187
  v_lshl_add_u32 v190, v1, 7, v187
  s_waitcnt lgkmcnt(0)
  s_mov_b32 s12, s12
  s_mov_b32 s13, s13
  s_mov_b32 s14, 7864320
  s_mov_b32 s15, 0x00020000
  s_waitcnt vmcnt(0)
  v_lshlrev_b32 v169, 16, v174
  v_and_b32 v174, 0xffff0000, v174
  v_lshlrev_b32 v170, 16, v175
  v_and_b32 v175, 0xffff0000, v175
  v_lshlrev_b32 v171, 16, v176
  v_and_b32 v176, 0xffff0000, v176
  v_lshlrev_b32 v172, 16, v177
  v_and_b32 v177, 0xffff0000, v177
  v_lshlrev_b32 v173, 16, v178
  v_and_b32 v178, 0xffff0000, v178
  s_cmp_eq_u32 s42, 0
  s_cselect_b32 s53, 15, 99
  s_mov_b32 s26, 17
  s_mov_b32 s52, -1
  s_waitcnt vmcnt(10)
  s_barrier
  ds_read_b128 v[28:31], v7 offset:0
  ds_read_b128 v[32:35], v8 offset:0
  ds_read_b128 v[36:39], v7 offset:4096
  ds_read_b128 v[40:43], v8 offset:4096
  s_waitcnt lgkmcnt(3)
  .p2align 3
bfl_263:
  v_mfma_f32_16x16x32_bf16 v[60:63], a[0:3], v[28:31], 0
  ds_read_b128 v[44:47], v7 offset:8192
  v_mfma_f32_16x16x32_bf16 v[64:67], a[4:7], v[28:31], 0
  ds_read_b32 v179, v188 offset:0
  ds_read_b32 v180, v188 offset:8192
  v_mfma_f32_16x16x32_bf16 v[68:71], a[8:11], v[28:31], 0
  v_cvt_pk_bf16_f32 v128, v84, v85
  v_cvt_pk_bf16_f32 v129, v86, v87
  v_mfma_f32_16x16x32_bf16 v[72:75], v[28:31], a[12:15], 0
  s_waitcnt lgkmcnt(5)
  v_cvt_pk_bf16_f32 v124, v76, v77
  v_cvt_pk_bf16_f32 v125, v78, v79
  v_mfma_f32_16x16x32_bf16 v[60:63], a[16:19], v[32:35], v[60:63]
  ds_read_b128 v[48:51], v8 offset:8192
  v_cvt_pk_bf16_f32 v100, v80, v81
  v_mfma_f32_16x16x32_bf16 v[64:67], a[20:23], v[32:35], v[64:67]
  v_cvt_pk_bf16_f32 v101, v82, v83
  v_cvt_pk_bf16_f32 v116, v88, v89
  v_mfma_f32_16x16x32_bf16 v[68:71], a[24:27], v[32:35], v[68:71]
  s_add_u32 m0, s31, 0
  v_cvt_pk_bf16_f32 v117, v90, v91
  v_cndmask_b32 v126, 0, v128, s[62:63]
  v_mfma_f32_16x16x32_bf16 v[72:75], v[32:35], a[28:31], v[72:75]
  s_waitcnt lgkmcnt(5)
  v_cndmask_b32 v127, 0, v129, s[62:63]
  buffer_load_dwordx4 v4, s[8:11], s30 offen offset:0 lds
  v_mfma_f32_16x16x32_bf16 v[60:63], a[32:35], v[36:39], v[60:63]
  ds_read_b128 v[52:55], v7 offset:12288
  ds_read_b32 v181, v188 offset:16384
  v_mfma_f32_16x16x32_bf16 v[64:67], a[36:39], v[36:39], v[64:67]
  ds_read_b32 v182, v188 offset:24576
  ds_read_b32 v183, v188 offset:32768
  v_mfma_f32_16x16x32_bf16 v[68:71], a[40:43], v[36:39], v[68:71]
  v_mfma_f32_16x16x32_bf16 v[72:75], v[36:39], a[44:47], v[72:75]
  v_mfma_f32_16x16x32_bf16 v[132:135], v[128:131], v[24:27], 0
  s_waitcnt lgkmcnt(8)
  v_permlane16_swap_b32 v128, v102
  v_permlane16_swap_b32 v129, v103
  v_mfma_f32_16x16x32_bf16 v[60:63], a[48:51], v[40:43], v[60:63]
  ds_read_b128 v[56:59], v8 offset:12288
  s_waitcnt lgkmcnt(1)
  v_mfma_f32_16x16x32_bf16 v[64:67], a[52:55], v[40:43], v[64:67]
  s_cmp_le_u32 s26, 4
  s_cbranch_scc1 wp_264
wp_264r:
  v_lshlrev_b32 v186, 16, v179
  v_mfma_f32_16x16x32_bf16 v[68:71], a[56:59], v[40:43], v[68:71]
  v_and_b32 v187, 0xffff0000, v179
  v_mul_f32 v186, v186, v169
  v_mfma_f32_16x16x32_bf16 v[72:75], v[40:43], a[60:63], v[72:75]
  v_mul_f32 v187, v187, v174
  v_cvt_pk_bf16_f32 v186, v186, v187
  v_mfma_f32_16x16x32_bf16 v[136:139], v[100:103], v[124:127], 0
  v_lshlrev_b32 v187, 16, v186
  v_and_b32 v186, 0xffff0000, v186
  v_mfma_f32_16x16x32_bf16 v[140:143], v[104:107], v[124:127], 0
  s_add_u32 m0, s31, 3968
  s_waitcnt lgkmcnt(8)
  v_add_f32 v184, v186, v187
  v_mfma_f32_16x16x32_bf16 v[60:63], a[64:67], v[44:47], v[60:63]
  ds_read_b128 v[28:31], v7 offset:16384
  buffer_load_dwordx4 v4, s[8:11], s30 offen offset:128 lds
  v_mfma_f32_16x16x32_bf16 v[64:67], a[68:71], v[44:47], v[64:67]
  v_lshlrev_b32 v186, 16, v180
  v_and_b32 v187, 0xffff0000, v180
  v_mfma_f32_16x16x32_bf16 v[68:71], a[72:75], v[44:47], v[68:71]
  v_cvt_pk_bf16_f32 v120, v132, v133
  v_cvt_pk_bf16_f32 v121, v134, v135
  v_mfma_f32_16x16x32_bf16 v[72:75], v[44:47], a[76:79], v[72:75]
  s_waitcnt lgkmcnt(6)
  v_cndmask_b32 v136, v136, v140, s[64:65]
  v_cndmask_b32 v137, v137, v141, s[66:67]
  v_mfma_f32_16x16x32_bf16 v[60:63], a[80:83], v[48:51], v[60:63]
  ds_read_b128 v[32:35], v8 offset:16384
  v_cndmask_b32 v138, v138, v142, s[68:69]
  v_mfma_f32_16x16x32_bf16 v[64:67], a[84:87], v[48:51], v[64:67]
  v_cndmask_b32 v139, v139, v143, s[70:71]
  v_cvt_pk_bf16_f32 v17, v136, v137
  v_mfma_f32_16x16x32_bf16 v[68:71], a[88:91], v[48:51], v[68:71]
  v_lshlrev_b32 v136, 16, v17
  v_and_b32 v137, 0xffff0000, v17
  v_mfma_f32_16x16x32_bf16 v[72:75], v[48:51], a[92:95], v[72:75]
  s_waitcnt lgkmcnt(6)
  v_cvt_pk_bf16_f32 v17, v138, v139
  v_lshlrev_b32 v138, 16, v17
  v_mfma_f32_16x16x32_bf16 v[60:63], a[96:99], v[52:55], v[60:63]
  ds_read_b128 v[36:39], v7 offset:20480
  v_and_b32 v139, 0xffff0000, v17
  v_mfma_f32_16x16x32_bf16 v[64:67], a[100:103], v[52:55], v[64:67]
  v_mul_f32 v136, s82, v136
  v_mul_f32 v137, s82, v137
  v_mfma_f32_16x16x32_bf16 v[68:71], a[104:107], v[52:55], v[68:71]
  v_mul_f32 v138, s82, v138
  v_mul_f32 v139, s82, v139
  v_mfma_f32_16x16x32_bf16 v[72:75], v[52:55], a[108:111], v[72:75]
  s_waitcnt lgkmcnt(3)
  v_cvt_pk_bf16_f32 v17, v136, v137
  v_lshlrev_b32 v136, 16, v17
  v_mfma_f32_16x16x32_bf16 v[60:63], a[112:115], v[56:59], v[60:63]
  s_add_u32 m0, s31, 7936
  ds_read_b128 v[40:43], v8 offset:20480
  v_and_b32 v137, 0xffff0000, v17
  v_mfma_f32_16x16x32_bf16 v[64:67], a[116:119], v[56:59], v[64:67]
  v_cvt_pk_bf16_f32 v17, v138, v139
  v_lshlrev_b32 v138, 16, v17
  v_mfma_f32_16x16x32_bf16 v[68:71], a[120:123], v[56:59], v[68:71]
  v_and_b32 v139, 0xffff0000, v17
  v_cndmask_b32 v136, v16, v136, s[54:55]
  v_mfma_f32_16x16x32_bf16 v[72:75], v[56:59], a[124:127], v[72:75]
  s_waitcnt lgkmcnt(3)
  v_cndmask_b32 v137, v16, v137, s[56:57]
  v_cndmask_b32 v138, v16, v138, s[58:59]
  v_mfma_f32_16x16x32_bf16 v[60:63], a[128:131], v[28:31], v[60:63]
  ds_read_b128 v[44:47], v7 offset:24576
  v_cndmask_b32 v139, v16, v139, s[60:61]
  v_mfma_f32_16x16x32_bf16 v[64:67], a[132:135], v[28:31], v[64:67]
  v_max3_f32 v17, v136, v137, v138
  v_max_f32 v17, v17, v139
  v_mfma_f32_16x16x32_bf16 v[68:71], a[136:139], v[28:31], v[68:71]
  v_mov_b32 v18, v17
  buffer_load_dwordx4 v4, s[8:11], s30 offen offset:256 lds
  v_mfma_f32_16x16x32_bf16 v[72:75], v[28:31], a[140:143], v[72:75]
  s_waitcnt lgkmcnt(3)
  v_permlane32_swap_b32 v17, v18
  v_max_f32 v17, v17, v18
  v_mfma_f32_16x16x32_bf16 v[60:63], a[144:147], v[32:35], v[60:63]
  ds_read_b128 v[48:51], v8 offset:24576
  v_mov_b32 v18, v17
  v_mfma_f32_16x16x32_bf16 v[64:67], a[148:151], v[32:35], v[64:67]
  v_permlane16_swap_b32 v17, v18
  v_max_f32 v17, v17, v18
  v_mfma_f32_16x16x32_bf16 v[68:71], a[152:155], v[32:35], v[68:71]
  v_mul_f32 v17, s83, v17
  v_fma_f32 v136, v136, s83, -v17
  v_mfma_f32_16x16x32_bf16 v[72:75], v[32:35], a[156:159], v[72:75]
  s_waitcnt lgkmcnt(3)
  v_fma_f32 v137, v137, s83, -v17
  v_fma_f32 v138, v138, s83, -v17
  v_mfma_f32_16x16x32_bf16 v[60:63], a[160:163], v[36:39], v[60:63]
  s_add_u32 m0, s31, 11904
  ds_read_b128 v[52:55], v7 offset:28672
  v_fma_f32 v139, v139, s83, -v17
  v_mfma_f32_16x16x32_bf16 v[64:67], a[164:167], v[36:39], v[64:67]
  v_exp_f32 v136, v136
  v_mfma_f32_16x16x32_bf16 v[68:71], a[168:171], v[36:39], v[68:71]
  v_exp_f32 v137, v137
  v_mfma_f32_16x16x32_bf16 v[72:75], v[36:39], a[172:175], v[72:75]
  s_waitcnt lgkmcnt(3)
  v_exp_f32 v138, v138
  v_mfma_f32_16x16x32_bf16 v[60:63], a[176:179], v[40:43], v[60:63]
  ds_read_b128 v[56:59], v8 offset:28672
  buffer_load_dwordx4 v4, s[8:11], s30 offen offset:384 lds
  v_mfma_f32_16x16x32_bf16 v[64:67], a[180:183], v[40:43], v[64:67]
  v_exp_f32 v139, v139
  v_mfma_f32_16x16x32_bf16 v[68:71], a[184:187], v[40:43], v[68:71]
  v_add_f32 v17, v136, v137
  v_add_f32 v18, v138, v139
  v_mfma_f32_16x16x32_bf16 v[72:75], v[40:43], a[188:191], v[72:75]
  s_waitcnt lgkmcnt(3)
  v_add_f32 v17, v17, v18
  v_mov_b32 v18, v17
  v_mfma_f32_16x16x32_bf16 v[60:63], a[192:195], v[44:47], v[60:63]
  ds_read_b128 v[28:31], v7 offset:32768
  v_permlane32_swap_b32 v17, v18
  v_mfma_f32_16x16x32_bf16 v[64:67], a[196:199], v[44:47], v[64:67]
  v_add_f32 v17, v17, v18
  v_mov_b32 v18, v17
  v_mfma_f32_16x16x32_bf16 v[68:71], a[200:203], v[44:47], v[68:71]
  v_permlane16_swap_b32 v17, v18
  v_add_f32 v17, v17, v18
  v_mfma_f32_16x16x32_bf16 v[72:75], v[44:47], a[204:207], v[72:75]
  s_waitcnt lgkmcnt(3)
  v_rcp_f32 v17, v17
  v_mfma_f32_16x16x32_bf16 v[60:63], a[208:211], v[48:51], v[60:63]
  s_add_u32 m0, s31, 15872
  ds_read_b128 v[32:35], v8 offset:32768
  v_mul_f32 v136, v136, v17
  v_mfma_f32_16x16x32_bf16 v[64:67], a[212:215], v[48:51], v[64:67]
  v_mul_f32 v137, v137, v17
  v_mul_f32 v138, v138, v17
  v_mfma_f32_16x16x32_bf16 v[68:71], a[216:219], v[48:51], v[68:71]
  v_mul_f32 v139, v139, v17
  v_cvt_pk_bf16_f32 v144, v136, v137
  v_mfma_f32_16x16x32_bf16 v[72:75], v[48:51], a[220:223], v[72:75]
  s_waitcnt lgkmcnt(3)
  v_cvt_pk_bf16_f32 v145, v138, v139
  v_and_b32 v146, v144, v22
  v_mfma_f32_16x16x32_bf16 v[60:63], a[224:227], v[52:55], v[60:63]
  ds_read_b128 v[36:39], v7 offset:36864
  v_and_b32 v147, v145, v23
  v_mfma_f32_16x16x32_bf16 v[64:67], a[228:231], v[52:55], v[64:67]
  v_and_b32 v144, v144, v20
  v_and_b32 v145, v145, v21
  v_mfma_f32_16x16x32_bf16 v[68:71], a[232:235], v[52:55], v[68:71]
  buffer_load_dwordx4 v4, s[8:11], s30 offen offset:512 lds
  v_mul_f32 v186, v186, v170
  v_mfma_f32_16x16x32_bf16 v[72:75], v[52:55], a[236:239], v[72:75]
  s_waitcnt lgkmcnt(3)
  v_mul_f32 v187, v187, v175
  v_cvt_pk_bf16_f32 v186, v186, v187
  v_mfma_f32_16x16x32_bf16 v[60:63], a[240:243], v[56:59], v[60:63]
  ds_read_b128 v[40:43], v8 offset:36864
  v_lshlrev_b32 v187, 16, v186
  v_mfma_f32_16x16x32_bf16 v[64:67], a[244:247], v[56:59], v[64:67]
  v_and_b32 v186, 0xffff0000, v186
  v_add_f32 v184, v184, v187
  v_mfma_f32_16x16x32_bf16 v[68:71], a[248:251], v[56:59], v[68:71]
  v_add_f32 v184, v184, v186
  v_lshlrev_b32 v186, 16, v181
  v_mfma_f32_16x16x32_bf16 v[72:75], v[56:59], a[252:255], v[72:75]
  s_add_u32 m0, s31, 19840
  s_waitcnt lgkmcnt(3)
  v_and_b32 v187, 0xffff0000, v181
  v_mfma_f32_16x16x32_bf16 v[60:63], v[192:195], v[28:31], v[60:63]
  ds_read_b128 v[44:47], v7 offset:2048
  buffer_load_dwordx4 v4, s[8:11], s30 offen offset:640 lds
  v_mfma_f32_16x16x32_bf16 v[64:67], v[196:199], v[28:31], v[64:67]
  v_mul_f32 v186, v186, v171
  v_mul_f32 v187, v187, v176
  v_mfma_f32_16x16x32_bf16 v[68:71], v[200:203], v[28:31], v[68:71]
  v_cvt_pk_bf16_f32 v186, v186, v187
  v_lshlrev_b32 v187, 16, v186
  v_mfma_f32_16x16x32_bf16 v[72:75], v[28:31], v[204:207], v[72:75]
  s_cmp_le_u32 s26, 4
  s_cbranch_scc1 wp_265
wp_265r:
  v_and_b32 v186, 0xffff0000, v186
  v_mfma_f32_16x16x32_bf16 v[148:151], v[116:119], v[144:147], 0
  s_cmp_le_u32 s26, s53
  s_cselect_b64 s[54:55], s[84:85], s[54:55]
  v_add_f32 v184, v184, v187
  v_mfma_f32_16x16x32_bf16 v[152:155], v[120:123], v[144:147], 0
  s_waitcnt lgkmcnt(3)
  v_mov_b32 v104, v100
  v_mov_b32 v105, v101
  v_mfma_f32_16x16x32_bf16 v[60:63], v[208:211], v[32:35], v[60:63]
  ds_read_b128 v[48:51], v8 offset:2048
  v_mov_b32 v106, v102
  v_mfma_f32_16x16x32_bf16 v[64:67], v[212:215], v[32:35], v[64:67]
  v_mov_b32 v107, v103
  v_mov_b32 v118, v116
  v_mfma_f32_16x16x32_bf16 v[68:71], v[216:219], v[32:35], v[68:71]
  v_cvt_pk_bf16_f32 v156, v148, v149
  v_cvt_pk_bf16_f32 v157, v150, v151
  v_mfma_f32_16x16x32_bf16 v[72:75], v[32:35], v[220:223], v[72:75]
  s_waitcnt lgkmcnt(3)
  ds_write_b64 v9, v[156:157] offset:16
  v_cvt_pk_bf16_f32 v158, v152, v153
  v_mfma_f32_16x16x32_bf16 v[60:63], v[224:227], v[36:39], v[60:63]
  ds_read_b128 v[52:55], v7 offset:6144
  v_cvt_pk_bf16_f32 v159, v154, v155
  v_mfma_f32_16x16x32_bf16 v[64:67], v[228:231], v[36:39], v[64:67]
  s_add_u32 m0, s31, 23808
  ds_write_b64 v10, v[158:159] offset:8
  v_mov_b32 v119, v117
  v_mfma_f32_16x16x32_bf16 v[68:71], v[232:235], v[36:39], v[68:71]
  v_mov_b32 v122, v120
  v_mov_b32 v123, v121
  v_mfma_f32_16x16x32_bf16 v[72:75], v[36:39], v[236:239], v[72:75]
  s_waitcnt lgkmcnt(5)
  buffer_load_dwordx4 v4, s[8:11], s30 offen offset:768 lds
  v_add_f32 v184, v184, v186
  v_mfma_f32_16x16x32_bf16 v[60:63], v[240:243], v[40:43], v[60:63]
  ds_read_b128 v[56:59], v8 offset:6144
  v_lshlrev_b32 v186, 16, v182
  v_mfma_f32_16x16x32_bf16 v[64:67], v[244:247], v[40:43], v[64:67]
  s_cmp_le_u32 s26, s53
  s_cselect_b64 s[56:57], s[86:87], s[56:57]
  v_and_b32 v187, 0xffff0000, v182
  v_mfma_f32_16x16x32_bf16 v[68:71], v[248:251], v[40:43], v[68:71]
  s_cmp_le_u32 s26, s53
  s_cselect_b64 s[58:59], s[88:89], s[58:59]
  v_mul_f32 v186, v186, v172
  v_mfma_f32_16x16x32_bf16 v[72:75], v[40:43], v[252:255], v[72:75]
  s_waitcnt lgkmcnt(5)
  s_cmp_le_u32 s26, s53
  s_cselect_b64 s[60:61], s[90:91], s[60:61]
  v_mfma_f32_16x16x32_bf16 v[76:79], a[0:3], v[44:47], 0
  ds_read_b128 v[28:31], v7 offset:10240
  v_mul_f32 v187, v187, v177
  v_mfma_f32_16x16x32_bf16 v[80:83], a[4:7], v[44:47], 0
  s_waitcnt lgkmcnt(2)
  s_barrier
  v_cvt_pk_bf16_f32 v186, v186, v187
  v_mfma_f32_16x16x32_bf16 v[84:87], a[8:11], v[44:47], 0
  v_cvt_pk_bf16_f32 v128, v68, v69
  v_cvt_pk_bf16_f32 v129, v70, v71
  v_mfma_f32_16x16x32_bf16 v[88:91], v[44:47], a[12:15], 0
  s_waitcnt lgkmcnt(5)
  v_cvt_pk_bf16_f32 v124, v60, v61
  v_cvt_pk_bf16_f32 v125, v62, v63
  v_mfma_f32_16x16x32_bf16 v[76:79], a[16:19], v[48:51], v[76:79]
  ds_read_b128 v[32:35], v8 offset:10240
  v_cvt_pk_bf16_f32 v92, v64, v65
  v_mfma_f32_16x16x32_bf16 v[80:83], a[20:23], v[48:51], v[80:83]
  s_add_u32 m0, s31, 27776
  v_cvt_pk_bf16_f32 v93, v66, v67
  v_cvt_pk_bf16_f32 v108, v72, v73
  v_mfma_f32_16x16x32_bf16 v[84:87], a[24:27], v[48:51], v[84:87]
  v_cvt_pk_bf16_f32 v109, v74, v75
  v_cndmask_b32 v126, 0, v128, s[62:63]
  v_mfma_f32_16x16x32_bf16 v[88:91], v[48:51], a[28:31], v[88:91]
  s_waitcnt lgkmcnt(4)
  v_cndmask_b32 v127, 0, v129, s[62:63]
  v_xor_b32 v9, 8192, v9
  v_mfma_f32_16x16x32_bf16 v[76:79], a[32:35], v[52:55], v[76:79]
  ds_read_b128 v[36:39], v7 offset:14336
  v_xor_b32 v10, 8192, v10
  v_mfma_f32_16x16x32_bf16 v[80:83], a[36:39], v[52:55], v[80:83]
  ds_read_b128 v[160:163], v11
  ds_read_b128 v[164:167], v12
  v_mfma_f32_16x16x32_bf16 v[84:87], a[40:43], v[52:55], v[84:87]
  buffer_load_dwordx4 v4, s[8:11], s30 offen offset:896 lds
  v_lshlrev_b32 v187, 16, v186
  v_mfma_f32_16x16x32_bf16 v[88:91], v[52:55], a[44:47], v[88:91]
  v_and_b32 v186, 0xffff0000, v186
  v_add_f32 v184, v184, v187
  v_mfma_f32_16x16x32_bf16 v[132:135], v[128:131], v[24:27], 0
  s_waitcnt lgkmcnt(5)
  v_permlane16_swap_b32 v128, v94
  v_permlane16_swap_b32 v129, v95
  v_mfma_f32_16x16x32_bf16 v[76:79], a[48:51], v[56:59], v[76:79]
  ds_read_b128 v[40:43], v8 offset:14336
  v_add_f32 v184, v184, v186
  v_mfma_f32_16x16x32_bf16 v[80:83], a[52:55], v[56:59], v[80:83]
  v_lshlrev_b32 v186, 16, v183
  v_and_b32 v187, 0xffff0000, v183
  v_mfma_f32_16x16x32_bf16 v[84:87], a[56:59], v[56:59], v[84:87]
  s_waitcnt lgkmcnt(1)
  buffer_store_dwordx4 v[160:163], v15, s[16:19], s49 offen sc1
  buffer_store_dwordx4 v[164:167], v14, s[16:19], s49 offen sc1
  v_mfma_f32_16x16x32_bf16 v[88:91], v[56:59], a[60:63], v[88:91]
  v_xor_b32 v11, 8192, v11
  v_xor_b32 v12, 8192, v12
  v_mfma_f32_16x16x32_bf16 v[136:139], v[92:95], v[124:127], 0
  s_add_u32 m0, s31, 31744
  s_mov_b32 s49, s48
  s_mov_b32 s48, s47
  v_mfma_f32_16x16x32_bf16 v[140:143], v[96:99], v[124:127], 0
  s_add_u32 s22, s47, 524288
  s_waitcnt lgkmcnt(5)
  buffer_load_dwordx4 v4, s[8:11], s30 offen offset:1024 lds
  v_mfma_f32_16x16x32_bf16 v[76:79], a[64:67], v[28:31], v[76:79]
  s_xor_b32 s47, s47, s22
  ds_read_b128 v[44:47], v7 offset:18432
  s_lshr_b32 s47, s47, 8
  v_mfma_f32_16x16x32_bf16 v[80:83], a[68:71], v[28:31], v[80:83]
  s_and_b32 s47, s47, 8192
  s_xor_b32 s47, s47, s22
  s_sub_u32 s26, s26, 1
  v_mfma_f32_16x16x32_bf16 v[84:87], a[72:75], v[28:31], v[84:87]
  v_cvt_pk_bf16_f32 v112, v132, v133
  v_cvt_pk_bf16_f32 v113, v134, v135
  v_mfma_f32_16x16x32_bf16 v[88:91], v[28:31], a[76:79], v[88:91]
  s_waitcnt lgkmcnt(5)
  v_cndmask_b32 v136, v136, v140, s[64:65]
  v_cndmask_b32 v137, v137, v141, s[66:67]
  v_mfma_f32_16x16x32_bf16 v[76:79], a[80:83], v[32:35], v[76:79]
  ds_read_b128 v[48:51], v8 offset:18432
  v_cndmask_b32 v138, v138, v142, s[68:69]
  v_mfma_f32_16x16x32_bf16 v[80:83], a[84:87], v[32:35], v[80:83]
  v_cndmask_b32 v139, v139, v143, s[70:71]
  v_cvt_pk_bf16_f32 v17, v136, v137
  v_mfma_f32_16x16x32_bf16 v[84:87], a[88:91], v[32:35], v[84:87]
  v_lshlrev_b32 v136, 16, v17
  v_and_b32 v137, 0xffff0000, v17
  v_mfma_f32_16x16x32_bf16 v[88:91], v[32:35], a[92:95], v[88:91]
  s_waitcnt lgkmcnt(5)
  v_cvt_pk_bf16_f32 v17, v138, v139
  v_lshlrev_b32 v138, 16, v17
  v_mfma_f32_16x16x32_bf16 v[76:79], a[96:99], v[36:39], v[76:79]
  ds_read_b128 v[52:55], v7 offset:22528
  v_and_b32 v139, 0xffff0000, v17
  v_mfma_f32_16x16x32_bf16 v[80:83], a[100:103], v[36:39], v[80:83]
  v_mul_f32 v136, s82, v136
  v_mul_f32 v137, s82, v137
  v_mfma_f32_16x16x32_bf16 v[84:87], a[104:107], v[36:39], v[84:87]
  s_add_u32 m0, s31, 35712
  v_mul_f32 v138, s82, v138
  v_mul_f32 v139, s82, v139
  v_mfma_f32_16x16x32_bf16 v[88:91], v[36:39], a[108:111], v[88:91]
  s_waitcnt lgkmcnt(3)
  v_cvt_pk_bf16_f32 v17, v136, v137
  v_lshlrev_b32 v136, 16, v17
  v_mfma_f32_16x16x32_bf16 v[76:79], a[112:115], v[40:43], v[76:79]
  ds_read_b128 v[56:59], v8 offset:22528
  v_and_b32 v137, 0xffff0000, v17
  v_mfma_f32_16x16x32_bf16 v[80:83], a[116:119], v[40:43], v[80:83]
  v_cvt_pk_bf16_f32 v17, v138, v139
  v_lshlrev_b32 v138, 16, v17
  v_mfma_f32_16x16x32_bf16 v[84:87], a[120:123], v[40:43], v[84:87]
  v_and_b32 v139, 0xffff0000, v17
  v_cndmask_b32 v136, v16, v136, s[54:55]
  v_mfma_f32_16x16x32_bf16 v[88:91], v[40:43], a[124:127], v[88:91]
  s_waitcnt lgkmcnt(3)
  v_cndmask_b32 v137, v16, v137, s[56:57]
  v_cndmask_b32 v138, v16, v138, s[58:59]
  v_mfma_f32_16x16x32_bf16 v[76:79], a[128:131], v[44:47], v[76:79]
  ds_read_b128 v[28:31], v7 offset:26624
  v_cndmask_b32 v139, v16, v139, s[60:61]
  v_mfma_f32_16x16x32_bf16 v[80:83], a[132:135], v[44:47], v[80:83]
  v_max3_f32 v17, v136, v137, v138
  v_max_f32 v17, v17, v139
  v_mfma_f32_16x16x32_bf16 v[84:87], a[136:139], v[44:47], v[84:87]
  v_mov_b32 v18, v17
  buffer_load_dwordx4 v4, s[8:11], s30 offen offset:1152 lds
  v_mfma_f32_16x16x32_bf16 v[88:91], v[44:47], a[140:143], v[88:91]
  s_waitcnt lgkmcnt(3)
  v_permlane32_swap_b32 v17, v18
  v_max_f32 v17, v17, v18
  v_mfma_f32_16x16x32_bf16 v[76:79], a[144:147], v[48:51], v[76:79]
  s_add_u32 s30, s30, 40960
  ds_read_b128 v[32:35], v8 offset:26624
  v_mov_b32 v18, v17
  v_mfma_f32_16x16x32_bf16 v[80:83], a[148:151], v[48:51], v[80:83]
  s_add_u32 s31, s31, 40960
  v_permlane16_swap_b32 v17, v18
  v_max_f32 v17, v17, v18
  v_mfma_f32_16x16x32_bf16 v[84:87], a[152:155], v[48:51], v[84:87]
  v_mul_f32 v17, s83, v17
  v_fma_f32 v136, v136, s83, -v17
  v_mfma_f32_16x16x32_bf16 v[88:91], v[48:51], a[156:159], v[88:91]
  s_waitcnt lgkmcnt(3)
  v_fma_f32 v137, v137, s83, -v17
  v_fma_f32 v138, v138, s83, -v17
  v_mfma_f32_16x16x32_bf16 v[76:79], a[160:163], v[52:55], v[76:79]
  ds_read_b128 v[36:39], v7 offset:30720
  v_fma_f32 v139, v139, s83, -v17
  v_mfma_f32_16x16x32_bf16 v[80:83], a[164:167], v[52:55], v[80:83]
  v_exp_f32 v136, v136
  v_mfma_f32_16x16x32_bf16 v[84:87], a[168:171], v[52:55], v[84:87]
  v_exp_f32 v137, v137
  v_mfma_f32_16x16x32_bf16 v[88:91], v[52:55], a[172:175], v[88:91]
  s_waitcnt lgkmcnt(3)
  v_exp_f32 v138, v138
  v_mfma_f32_16x16x32_bf16 v[76:79], a[176:179], v[56:59], v[76:79]
  ds_read_b128 v[40:43], v8 offset:30720
  v_mul_f32 v186, v186, v173
  v_mfma_f32_16x16x32_bf16 v[80:83], a[180:183], v[56:59], v[80:83]
  v_exp_f32 v139, v139
  v_mfma_f32_16x16x32_bf16 v[84:87], a[184:187], v[56:59], v[84:87]
  v_add_f32 v17, v136, v137
  v_add_f32 v18, v138, v139
  v_mfma_f32_16x16x32_bf16 v[88:91], v[56:59], a[188:191], v[88:91]
  s_waitcnt lgkmcnt(3)
  v_add_f32 v17, v17, v18
  v_mov_b32 v18, v17
  v_mfma_f32_16x16x32_bf16 v[76:79], a[192:195], v[28:31], v[76:79]
  ds_read_b128 v[44:47], v7 offset:34816
  v_permlane32_swap_b32 v17, v18
  v_mfma_f32_16x16x32_bf16 v[80:83], a[196:199], v[28:31], v[80:83]
  v_add_f32 v17, v17, v18
  v_mov_b32 v18, v17
  v_mfma_f32_16x16x32_bf16 v[84:87], a[200:203], v[28:31], v[84:87]
  v_permlane16_swap_b32 v17, v18
  v_add_f32 v17, v17, v18
  v_mfma_f32_16x16x32_bf16 v[88:91], v[28:31], a[204:207], v[88:91]
  s_waitcnt lgkmcnt(3)
  v_rcp_f32 v17, v17
  v_mfma_f32_16x16x32_bf16 v[76:79], a[208:211], v[32:35], v[76:79]
  ds_read_b128 v[48:51], v8 offset:34816
  v_mul_f32 v136, v136, v17
  v_mfma_f32_16x16x32_bf16 v[80:83], a[212:215], v[32:35], v[80:83]
  v_mul_f32 v137, v137, v17
  v_mul_f32 v138, v138, v17
  v_mfma_f32_16x16x32_bf16 v[84:87], a[216:219], v[32:35], v[84:87]
  v_mul_f32 v139, v139, v17
  v_cvt_pk_bf16_f32 v144, v136, v137
  v_mfma_f32_16x16x32_bf16 v[88:91], v[32:35], a[220:223], v[88:91]
  s_waitcnt lgkmcnt(3)
  v_cvt_pk_bf16_f32 v145, v138, v139
  v_and_b32 v146, v144, v22
  v_mfma_f32_16x16x32_bf16 v[76:79], a[224:227], v[36:39], v[76:79]
  ds_read_b128 v[52:55], v7 offset:38912
  v_and_b32 v147, v145, v23
  v_mfma_f32_16x16x32_bf16 v[80:83], a[228:231], v[36:39], v[80:83]
  v_and_b32 v144, v144, v20
  v_and_b32 v145, v145, v21
  v_mfma_f32_16x16x32_bf16 v[84:87], a[232:235], v[36:39], v[84:87]
  s_cmp_ge_u32 s31, 122880
  s_cselect_b32 s21, 122880, 0
  s_sub_u32 s31, s31, s21
  v_mfma_f32_16x16x32_bf16 v[88:91], v[36:39], a[236:239], v[88:91]
  s_add_u32 s33, s33, 40960
  s_waitcnt lgkmcnt(3)
  v_mul_f32 v187, v187, v178
  v_mfma_f32_16x16x32_bf16 v[76:79], a[240:243], v[40:43], v[76:79]
  ds_read_b128 v[56:59], v8 offset:38912
  v_cvt_pk_bf16_f32 v186, v186, v187
  v_mfma_f32_16x16x32_bf16 v[80:83], a[244:247], v[40:43], v[80:83]
  s_cmp_ge_u32 s33, 122880
  s_cselect_b32 s33, 0, s33
  v_lshlrev_b32 v187, 16, v186
  v_mfma_f32_16x16x32_bf16 v[84:87], a[248:251], v[40:43], v[84:87]
  v_add_u32 v7, s33, v5
  v_add_u32 v8, s33, v6
  v_mfma_f32_16x16x32_bf16 v[88:91], v[40:43], a[252:255], v[88:91]
  s_waitcnt lgkmcnt(3)
  v_and_b32 v186, 0xffff0000, v186
  v_add_f32 v184, v184, v187
  v_mfma_f32_16x16x32_bf16 v[76:79], v[192:195], v[44:47], v[76:79]
  s_waitcnt vmcnt(12)
  s_barrier
  ds_read_b128 v[28:31], v7 offset:0
  v_mfma_f32_16x16x32_bf16 v[80:83], v[196:199], v[44:47], v[80:83]
  v_add_u32 v188, s33, v189
  v_add_f32 v184, v184, v186
  v_mfma_f32_16x16x32_bf16 v[84:87], v[200:203], v[44:47], v[84:87]
  v_add_f32_dpp v184, v184, v184 row_ror:8 row_mask:0xf bank_mask:0xf
  v_mfma_f32_16x16x32_bf16 v[88:91], v[44:47], v[204:207], v[88:91]
  v_add_f32_dpp v184, v184, v184 row_ror:4 row_mask:0xf bank_mask:0xf
  v_mfma_f32_16x16x32_bf16 v[148:151], v[108:111], v[144:147], 0
  v_add_f32_dpp v184, v184, v184 row_ror:2 row_mask:0xf bank_mask:0xf
  v_mfma_f32_16x16x32_bf16 v[152:155], v[112:115], v[144:147], 0
  s_waitcnt lgkmcnt(3)
  v_mov_b32 v96, v92
  v_mov_b32 v97, v93
  v_mfma_f32_16x16x32_bf16 v[76:79], v[208:211], v[48:51], v[76:79]
  ds_read_b128 v[32:35], v8 offset:0
  v_mov_b32 v98, v94
  v_mfma_f32_16x16x32_bf16 v[80:83], v[212:215], v[48:51], v[80:83]
  v_mov_b32 v99, v95
  v_mov_b32 v110, v108
  v_mfma_f32_16x16x32_bf16 v[84:87], v[216:219], v[48:51], v[84:87]
  v_cvt_pk_bf16_f32 v156, v148, v149
  v_cvt_pk_bf16_f32 v157, v150, v151
  v_mfma_f32_16x16x32_bf16 v[88:91], v[48:51], v[220:223], v[88:91]
  s_waitcnt lgkmcnt(3)
  ds_write_b64 v9, v[156:157] offset:0
  v_cvt_pk_bf16_f32 v158, v152, v153
  v_mfma_f32_16x16x32_bf16 v[76:79], v[224:227], v[52:55], v[76:79]
  ds_read_b128 v[36:39], v7 offset:4096
  v_cvt_pk_bf16_f32 v159, v154, v155
  v_mfma_f32_16x16x32_bf16 v[80:83], v[228:231], v[52:55], v[80:83]
  ds_write_b64 v10, v[158:159] offset:0
  v_mov_b32 v111, v109
  v_mfma_f32_16x16x32_bf16 v[84:87], v[232:235], v[52:55], v[84:87]
  v_mov_b32 v114, v112
  v_mov_b32 v115, v113
  v_mfma_f32_16x16x32_bf16 v[88:91], v[52:55], v[236:239], v[88:91]
  s_waitcnt lgkmcnt(5)
  v_add_f32_dpp v184, v184, v184 row_ror:1 row_mask:0xf bank_mask:0xf
  v_cmp_eq_u32 vcc, s52, v2
  v_mfma_f32_16x16x32_bf16 v[76:79], v[240:243], v[56:59], v[76:79]
  ds_read_b128 v[40:43], v8 offset:4096
  v_cndmask_b32 v185, v185, v184, vcc
  v_mfma_f32_16x16x32_bf16 v[80:83], v[244:247], v[56:59], v[80:83]
  s_add_u32 s52, s52, 1
  v_mfma_f32_16x16x32_bf16 v[84:87], v[248:251], v[56:59], v[84:87]
  s_cmp_gt_u32 s26, 0
  v_mfma_f32_16x16x32_bf16 v[88:91], v[56:59], v[252:255], v[88:91]
  s_waitcnt lgkmcnt(5)
  s_cbranch_scc1 bfl_263
  s_branch wp_266
wp_264:
  buffer_load_dword v191, v190, s[12:15], s51 offen
  s_add_u32 s51, s51, 258048
  s_branch wp_264r
wp_265:
  buffer_load_dword v191, v190, s[12:15], s51 offen
  s_add_u32 s51, s51, 258048
  s_branch wp_265r
wp_266:
  v_mov_b32 v186, v185
  s_nop 1
  v_permlane32_swap_b32 v185, v186
  v_add_f32 v185, v185, v186
  v_mov_b32 v186, v185
  s_nop 1
  v_permlane16_swap_b32 v185, v186
  v_add_f32 v185, v185, v186
  v_cvt_pk_bf16_f32 v186, v185, v185
  v_lshlrev_b32 v185, 16, v186
  v_mul_f32 v185, 0xbfb8aa3b, v185
  v_exp_f32 v185, v185
  s_nop 0
  v_add_f32 v185, 1.0, v185
  v_rcp_f32 v185, v185
  s_nop 0
  v_cvt_pk_bf16_f32 v186, v185, v185
  v_lshlrev_b32 v185, 16, v186
  s_and_b32 s21, s50, 15
  s_lshl_b32 s21, s21, 1
  s_lshr_b32 s22, s50, 4
  s_add_u32 s21, s21, s22
  s_lshl_b32 s22, s42, 9
  s_add_u32 s21, s21, s22
  s_lshl_b32 s21, s21, 2
  v_lshlrev_b32 v187, 7, v2
  buffer_store_dword v185, v187, s[76:79], s21 offen sc1
  s_nop 7
  v_cvt_pk_bf16_f32 v128, v84, v85
  v_cvt_pk_bf16_f32 v129, v86, v87
  v_cvt_pk_bf16_f32 v124, v76, v77
  v_cvt_pk_bf16_f32 v125, v78, v79
  v_cvt_pk_bf16_f32 v100, v80, v81
  v_cvt_pk_bf16_f32 v101, v82, v83
  v_cvt_pk_bf16_f32 v116, v88, v89
  v_cvt_pk_bf16_f32 v117, v90, v91
  v_cndmask_b32 v126, 0, v128, s[62:63]
  v_cndmask_b32 v127, 0, v129, s[62:63]
  s_nop 1
  v_mfma_f32_16x16x32_bf16 v[132:135], v[128:131], v[24:27], 0
  s_nop 7
  v_permlane16_swap_b32 v128, v102
  v_permlane16_swap_b32 v129, v103
  s_nop 1
  v_mfma_f32_16x16x32_bf16 v[136:139], v[100:103], v[124:127], 0
  v_mfma_f32_16x16x32_bf16 v[140:143], v[104:107], v[124:127], 0
  s_nop 7
  v_cvt_pk_bf16_f32 v120, v132, v133
  v_cvt_pk_bf16_f32 v121, v134, v135
  v_cndmask_b32 v136, v136, v140, s[64:65]
  v_cndmask_b32 v137, v137, v141, s[66:67]
  v_cndmask_b32 v138, v138, v142, s[68:69]
  v_cndmask_b32 v139, v139, v143, s[70:71]
  v_cvt_pk_bf16_f32 v17, v136, v137
  v_lshlrev_b32 v136, 16, v17
  v_and_b32 v137, 0xffff0000, v17
  v_cvt_pk_bf16_f32 v17, v138, v139
  v_lshlrev_b32 v138, 16, v17
  v_and_b32 v139, 0xffff0000, v17
  v_mul_f32 v136, s82, v136
  v_mul_f32 v137, s82, v137
  v_mul_f32 v138, s82, v138
  v_mul_f32 v139, s82, v139
  v_cvt_pk_bf16_f32 v17, v136, v137
  v_lshlrev_b32 v136, 16, v17
  v_and_b32 v137, 0xffff0000, v17
  v_cvt_pk_bf16_f32 v17, v138, v139
  v_lshlrev_b32 v138, 16, v17
  v_and_b32 v139, 0xffff0000, v17
  v_cndmask_b32 v136, v16, v136, s[54:55]
  v_cndmask_b32 v137, v16, v137, s[56:57]
  v_cndmask_b32 v138, v16, v138, s[58:59]
  v_cndmask_b32 v139, v16, v139, s[60:61]
  v_max3_f32 v17, v136, v137, v138
  v_max_f32 v17, v17, v139
  v_mov_b32 v18, v17
  s_nop 1
  v_permlane32_swap_b32 v17, v18
  v_max_f32 v17, v17, v18
  v_mov_b32 v18, v17
  s_nop 1
  v_permlane16_swap_b32 v17, v18
  v_max_f32 v17, v17, v18
  v_mul_f32 v17, s83, v17
  v_fma_f32 v136, v136, s83, -v17
  v_fma_f32 v137, v137, s83, -v17
  v_fma_f32 v138, v138, s83, -v17
  v_fma_f32 v139, v139, s83, -v17
  v_exp_f32 v136, v136
  v_exp_f32 v137, v137
  v_exp_f32 v138, v138
  v_exp_f32 v139, v139
  s_nop 1
  v_add_f32 v17, v136, v137
  v_add_f32 v18, v138, v139
  v_add_f32 v17, v17, v18
  v_mov_b32 v18, v17
  s_nop 1
  v_permlane32_swap_b32 v17, v18
  v_add_f32 v17, v17, v18
  v_mov_b32 v18, v17
  s_nop 1
  v_permlane16_swap_b32 v17, v18
  v_add_f32 v17, v17, v18
  v_rcp_f32 v17, v17
  s_nop 1
  v_mul_f32 v136, v136, v17
  v_mul_f32 v137, v137, v17
  v_mul_f32 v138, v138, v17
  v_mul_f32 v139, v139, v17
  v_cvt_pk_bf16_f32 v144, v136, v137
  v_cvt_pk_bf16_f32 v145, v138, v139
  v_and_b32 v146, v144, v22
  v_and_b32 v147, v145, v23
  v_and_b32 v144, v144, v20
  v_and_b32 v145, v145, v21
  s_nop 1
  v_mfma_f32_16x16x32_bf16 v[148:151], v[116:119], v[144:147], 0
  v_mfma_f32_16x16x32_bf16 v[152:155], v[120:123], v[144:147], 0
  s_nop 7
  v_mov_b32 v104, v100
  v_mov_b32 v105, v101
  v_mov_b32 v106, v102
  v_mov_b32 v107, v103
  v_mov_b32 v118, v116
  v_mov_b32 v119, v117
  v_mov_b32 v122, v120
  v_mov_b32 v123, v121
  v_cvt_pk_bf16_f32 v156, v148, v149
  v_cvt_pk_bf16_f32 v157, v150, v151
  ds_write_b64 v9, v[156:157] offset:16
  v_cvt_pk_bf16_f32 v158, v152, v153
  v_cvt_pk_bf16_f32 v159, v154, v155
  ds_write_b64 v10, v[158:159] offset:8
  s_waitcnt lgkmcnt(0)
  s_barrier
  ds_read_b128 v[160:163], v11
  ds_read_b128 v[164:167], v12
  s_waitcnt lgkmcnt(0)
  buffer_store_dwordx4 v[160:163], v15, s[16:19], s49 offen sc1
  buffer_store_dwordx4 v[164:167], v14, s[16:19], s49 offen sc1
  s_waitcnt vmcnt(0)
  s_barrier
  s_lshl_b32 s21, s42, 7
  s_add_u32 s21, s21, 29696
  s_xor_b32 s21, s21, s80
  s_cmp_lg_u32 s20, 0
  s_cbranch_scc1 af_267
  v_mov_b32 v8, 0
  v_mov_b32 v9, 1
  s_mov_b64 exec, 1
  buffer_atomic_add v9, v8, s[72:75], s21 offen sc1
  s_mov_b64 exec, -1
  s_nop 1
af_267:
  s_barrier
  s_sub_u32 s2, s3, 96
  s_mov_b32 s40, 0
  s_mov_b32 s41, 10
q_entry:
  s_load_dwordx2 s[4:5], s[0:1], 0
  s_load_dwordx2 s[6:7], s[0:1], 16
  s_load_dwordx2 s[38:39], s[0:1], 104
  s_mov_b32 s42, s2
  s_waitcnt lgkmcnt(0)
  s_mov_b32 s8, s4
  s_mov_b32 s9, s5
  s_mov_b32 s10, 2621440
  s_mov_b32 s11, 0x00020000
  s_mov_b32 s12, s6
  s_mov_b32 s13, s7
  s_mov_b32 s14, 7864320
  s_mov_b32 s15, 0x00020000
  s_mov_b32 s16, s38
  s_mov_b32 s17, s39
  s_mov_b32 s18, 218103808
  s_mov_b32 s19, 0x00020000
  s_add_u32 s72, s38, 173080576
  s_addc_u32 s73, s39, 0
  s_mov_b32 s74, 49152
  s_mov_b32 s75, 0x00020000
  s_mul_i32 s44, s42, 384
  s_cmp_lg_u32 s40, 0
  s_cbranch_scc1 qg_268
  v_lshlrev_b32 v11, 4, v1
  s_load_dwordx2 s[36:37], s[0:1], 72
  s_lshr_b32 s21, s2, 3
  s_mul_i32 s21, s21, 204800
  s_and_b32 s22, s2, 7
  s_mul_i32 s22, s22, 160
  s_add_u32 s21, s21, s22
  s_waitcnt lgkmcnt(0)
  s_mov_b32 s28, s36
  s_mov_b32 s29, s37
  s_mov_b32 s30, 819200
  s_mov_b32 s31, 0x00020000
  s_mul_i32 s22, s20, 51200
  s_add_u32 s21, s21, s22
  s_mul_i32 s22, s20, 6400
  v_add_u32 v22, 0, v1
  v_mul_u32_u24 v23, 6554, v22
  v_lshrrev_b32 v23, 16, v23
  v_mul_u32_u24 v23, 1120, v23
  v_lshl_add_u32 v22, v22, 4, v23
  s_add_u32 m0, s22, 122880
  s_nop 0
  buffer_load_dwordx4 v22, s[28:31], s21 offen lds
  v_add_u32 v22, 64, v1
  v_mul_u32_u24 v23, 6554, v22
  v_lshrrev_b32 v23, 16, v23
  v_mul_u32_u24 v23, 1120, v23
  v_lshl_add_u32 v22, v22, 4, v23
  s_add_u32 m0, s22, 123904
  s_nop 0
  buffer_load_dwordx4 v22, s[28:31], s21 offen lds
  v_add_u32 v22, 128, v1
  v_mul_u32_u24 v23, 6554, v22
  v_lshrrev_b32 v23, 16, v23
  v_mul_u32_u24 v23, 1120, v23
  v_lshl_add_u32 v22, v22, 4, v23
  s_add_u32 m0, s22, 124928
  s_nop 0
  buffer_load_dwordx4 v22, s[28:31], s21 offen lds
  v_add_u32 v22, 192, v1
  v_mul_u32_u24 v23, 6554, v22
  v_lshrrev_b32 v23, 16, v23
  v_mul_u32_u24 v23, 1120, v23
  v_lshl_add_u32 v22, v22, 4, v23
  s_add_u32 m0, s22, 125952
  s_nop 0
  buffer_load_dwordx4 v22, s[28:31], s21 offen lds
  v_add_u32 v22, 256, v1
  v_mul_u32_u24 v23, 6554, v22
  v_lshrrev_b32 v23, 16, v23
  v_mul_u32_u24 v23, 1120, v23
  v_lshl_add_u32 v22, v22, 4, v23
  s_add_u32 m0, s22, 126976
  s_nop 0
  buffer_load_dwordx4 v22, s[28:31], s21 offen lds
  v_add_u32 v22, 320, v1
  v_mul_u32_u24 v23, 6554, v22
  v_lshrrev_b32 v23, 16, v23
  v_mul_u32_u24 v23, 1120, v23
  v_lshl_add_u32 v22, v22, 4, v23
  s_add_u32 m0, s22, 128000
  s_nop 0
  buffer_load_dwordx4 v22, s[28:31], s21 offen lds
  v_add_u32 v22, 384, v1
  v_mul_u32_u24 v23, 6554, v22
  v_lshrrev_b32 v23, 16, v23
  v_mul_u32_u24 v23, 1120, v23
  v_lshl_add_u32 v22, v22, 4, v23
  s_add_u32 m0, s22, 129024
  s_mov_b64 exec, 0xffff
  buffer_load_dwordx4 v22, s[28:31], s21 offen lds
  s_mov_b64 exec, -1
qg_268:
  s_mul_i32 s22, s20, 5
  s_and_b32 s22, s22, 1
  s_lshl_b32 s22, s22, 2
  s_mov_b32 s21, 12288
  v_add_u32 v30, 0, v1
  v_mul_u32_u24 v31, 2731, v30
  v_lshrrev_b32 v31, 16, v31
  v_mul_u32_u24 v4, 24, v31
  v_sub_u32 v30, v30, v4
  v_and_b32 v4, 2, v31
  v_xor_b32 v30, v30, v4
  v_xor_b32 v30, s22, v30
  v_mul_lo_u32 v31, v31, s21
  v_lshl_add_u32 v4, v30, 4, v31
  v_xor_b32 v7, 64, v4
  v_add_u32 v30, 64, v1
  v_mul_u32_u24 v31, 2731, v30
  v_lshrrev_b32 v31, 16, v31
  v_mul_u32_u24 v5, 24, v31
  v_sub_u32 v30, v30, v5
  v_and_b32 v5, 2, v31
  v_xor_b32 v30, v30, v5
  v_xor_b32 v30, s22, v30
  v_mul_lo_u32 v31, v31, s21
  v_lshl_add_u32 v5, v30, 4, v31
  v_xor_b32 v8, 64, v5
  v_add_u32 v30, 128, v1
  v_mul_u32_u24 v31, 2731, v30
  v_lshrrev_b32 v31, 16, v31
  v_mul_u32_u24 v6, 24, v31
  v_sub_u32 v30, v30, v6
  v_and_b32 v6, 2, v31
  v_xor_b32 v30, v30, v6
  v_xor_b32 v30, s22, v30
  v_mul_lo_u32 v31, v31, s21
  v_lshl_add_u32 v6, v30, 4, v31
  v_xor_b32 v9, 64, v6
  s_mul_i32 s21, s20, 491520
  s_add_u32 s21, s21, 0
  s_add_u32 s21, s21, s44
  s_mul_i32 s22, s20, 15360
  s_add_u32 s22, s22, 0
  s_add_u32 m0, s22, 0
  s_nop 0
  buffer_load_dwordx4 v4, s[12:15], s21 offen lds
  s_add_u32 m0, s22, 1024
  s_nop 0
  buffer_load_dwordx4 v5, s[12:15], s21 offen lds
  s_add_u32 m0, s22, 2048
  s_nop 0
  buffer_load_dwordx4 v6, s[12:15], s21 offen lds
  s_mul_i32 s21, s20, 491520
  s_add_u32 s21, s21, 98304
  s_add_u32 s21, s21, s44
  s_mul_i32 s22, s20, 15360
  s_add_u32 s22, s22, 3072
  s_add_u32 m0, s22, 0
  s_nop 0
  buffer_load_dwordx4 v7, s[12:15], s21 offen lds
  s_add_u32 m0, s22, 1024
  s_nop 0
  buffer_load_dwordx4 v8, s[12:15], s21 offen lds
  s_add_u32 m0, s22, 2048
  s_nop 0
  buffer_load_dwordx4 v9, s[12:15], s21 offen lds
  s_mul_i32 s21, s20, 491520
  s_add_u32 s21, s21, 196608
  s_add_u32 s21, s21, s44
  s_mul_i32 s22, s20, 15360
  s_add_u32 s22, s22, 6144
  s_add_u32 m0, s22, 0
  s_nop 0
  buffer_load_dwordx4 v4, s[12:15], s21 offen lds
  s_add_u32 m0, s22, 1024
  s_nop 0
  buffer_load_dwordx4 v5, s[12:15], s21 offen lds
  s_add_u32 m0, s22, 2048
  s_nop 0
  buffer_load_dwordx4 v6, s[12:15], s21 offen lds
  s_mul_i32 s21, s20, 491520
  s_add_u32 s21, s21, 294912
  s_add_u32 s21, s21, s44
  s_mul_i32 s22, s20, 15360
  s_add_u32 s22, s22, 9216
  s_add_u32 m0, s22, 0
  s_nop 0
  buffer_load_dwordx4 v7, s[12:15], s21 offen lds
  s_add_u32 m0, s22, 1024
  s_nop 0
  buffer_load_dwordx4 v8, s[12:15], s21 offen lds
  s_add_u32 m0, s22, 2048
  s_nop 0
  buffer_load_dwordx4 v9, s[12:15], s21 offen lds
  s_mul_i32 s21, s20, 491520
  s_add_u32 s21, s21, 393216
  s_add_u32 s21, s21, s44
  s_mul_i32 s22, s20, 15360
  s_add_u32 s22, s22, 12288
  s_add_u32 m0, s22, 0
  s_nop 0
  buffer_load_dwordx4 v4, s[12:15], s21 offen lds
  s_add_u32 m0, s22, 1024
  s_nop 0
  buffer_load_dwordx4 v5, s[12:15], s21 offen lds
  s_add_u32 m0, s22, 2048
  s_nop 0
  buffer_load_dwordx4 v6, s[12:15], s21 offen lds
  s_mul_i32 s21, s20, 491520
  s_add_u32 s21, s21, 1966080
  s_add_u32 s21, s21, s44
  s_mul_i32 s22, s20, 15360
  s_add_u32 s22, s22, 61440
  s_add_u32 m0, s22, 0
  s_nop 0
  buffer_load_dwordx4 v4, s[12:15], s21 offen lds
  s_add_u32 m0, s22, 1024
  s_nop 0
  buffer_load_dwordx4 v5, s[12:15], s21 offen lds
  s_add_u32 m0, s22, 2048
  s_nop 0
  buffer_load_dwordx4 v6, s[12:15], s21 offen lds
  s_mul_i32 s21, s20, 491520
  s_add_u32 s21, s21, 2064384
  s_add_u32 s21, s21, s44
  s_mul_i32 s22, s20, 15360
  s_add_u32 s22, s22, 64512
  s_add_u32 m0, s22, 0
  s_nop 0
  buffer_load_dwordx4 v7, s[12:15], s21 offen lds
  s_add_u32 m0, s22, 1024
  s_nop 0
  buffer_load_dwordx4 v8, s[12:15], s21 offen lds
  s_add_u32 m0, s22, 2048
  s_nop 0
  buffer_load_dwordx4 v9, s[12:15], s21 offen lds
  s_mul_i32 s21, s20, 491520
  s_add_u32 s21, s21, 2162688
  s_add_u32 s21, s21, s44
  s_mul_i32 s22, s20, 15360
  s_add_u32 s22, s22, 67584
  s_add_u32 m0, s22, 0
  s_nop 0
  buffer_load_dwordx4 v4, s[12:15], s21 offen lds
  s_add_u32 m0, s22, 1024
  s_nop 0
  buffer_load_dwordx4 v5, s[12:15], s21 offen lds
  s_add_u32 m0, s22, 2048
  s_nop 0
  buffer_load_dwordx4 v6, s[12:15], s21 offen lds
  s_mul_i32 s21, s20, 491520
  s_add_u32 s21, s21, 2260992
  s_add_u32 s21, s21, s44
  s_mul_i32 s22, s20, 15360
  s_add_u32 s22, s22, 70656
  s_add_u32 m0, s22, 0
  s_nop 0
  buffer_load_dwordx4 v7, s[12:15], s21 offen lds
  s_add_u32 m0, s22, 1024
  s_nop 0
  buffer_load_dwordx4 v8, s[12:15], s21 offen lds
  s_add_u32 m0, s22, 2048
  s_nop 0
  buffer_load_dwordx4 v9, s[12:15], s21 offen lds
  s_mul_i32 s21, s20, 491520
  s_add_u32 s21, s21, 2359296
  s_add_u32 s21, s21, s44
  s_mul_i32 s22, s20, 15360
  s_add_u32 s22, s22, 73728
  s_add_u32 m0, s22, 0
  s_nop 0
  buffer_load_dwordx4 v4, s[12:15], s21 offen lds
  s_add_u32 m0, s22, 1024
  s_nop 0
  buffer_load_dwordx4 v5, s[12:15], s21 offen lds
  s_add_u32 m0, s22, 2048
  s_nop 0
  buffer_load_dwordx4 v6, s[12:15], s21 offen lds
  s_waitcnt vmcnt(33)
  s_mul_i32 s21, s20, 491520
  s_add_u32 s21, s21, 3932160
  s_add_u32 s21, s21, s44
  buffer_load_dwordx4 v[64:67], v4, s[12:15], s21 offen
  buffer_load_dwordx4 v[68:71], v5, s[12:15], s21 offen
  buffer_load_dwordx4 v[72:75], v6, s[12:15], s21 offen
  s_mul_i32 s21, s20, 491520
  s_add_u32 s21, s21, 4030464
  s_add_u32 s21, s21, s44
  buffer_load_dwordx4 v[76:79], v7, s[12:15], s21 offen
  buffer_load_dwordx4 v[80:83], v8, s[12:15], s21 offen
  buffer_load_dwordx4 v[84:87], v9, s[12:15], s21 offen
  s_mul_i32 s21, s20, 491520
  s_add_u32 s21, s21, 4128768
  s_add_u32 s21, s21, s44
  buffer_load_dwordx4 v[88:91], v4, s[12:15], s21 offen
  buffer_load_dwordx4 v[92:95], v5, s[12:15], s21 offen
  buffer_load_dwordx4 v[96:99], v6, s[12:15], s21 offen
  s_mul_i32 s21, s20, 491520
  s_add_u32 s21, s21, 4227072
  s_add_u32 s21, s21, s44
  buffer_load_dwordx4 v[100:103], v7, s[12:15], s21 offen
  buffer_load_dwordx4 v[104:107], v8, s[12:15], s21 offen
  buffer_load_dwordx4 v[108:111], v9, s[12:15], s21 offen
  s_mul_i32 s21, s20, 491520
  s_add_u32 s21, s21, 4325376
  s_add_u32 s21, s21, s44
  buffer_load_dwordx4 v[112:115], v4, s[12:15], s21 offen
  buffer_load_dwordx4 v[116:119], v5, s[12:15], s21 offen
  buffer_load_dwordx4 v[120:123], v6, s[12:15], s21 offen
  s_mul_i32 s21, s20, 491520
  s_add_u32 s21, s21, 5898240
  s_add_u32 s21, s21, s44
  buffer_load_dwordx4 v[124:127], v4, s[12:15], s21 offen
  buffer_load_dwordx4 v[128:131], v5, s[12:15], s21 offen
  buffer_load_dwordx4 v[132:135], v6, s[12:15], s21 offen
  s_mul_i32 s21, s20, 491520
  s_add_u32 s21, s21, 5996544
  s_add_u32 s21, s21, s44
  buffer_load_dwordx4 v[136:139], v7, s[12:15], s21 offen
  buffer_load_dwordx4 v[140:143], v8, s[12:15], s21 offen
  buffer_load_dwordx4 v[144:147], v9, s[12:15], s21 offen
  s_mul_i32 s21, s20, 491520
  s_add_u32 s21, s21, 6094848
  s_add_u32 s21, s21, s44
  buffer_load_dwordx4 v[148:151], v4, s[12:15], s21 offen
  buffer_load_dwordx4 v[152:155], v5, s[12:15], s21 offen
  buffer_load_dwordx4 v[156:159], v6, s[12:15], s21 offen
  s_mul_i32 s21, s20, 491520
  s_add_u32 s21, s21, 6193152
  s_add_u32 s21, s21, s44
  buffer_load_dwordx4 v[160:163], v7, s[12:15], s21 offen
  buffer_load_dwordx4 v[164:167], v8, s[12:15], s21 offen
  buffer_load_dwordx4 v[168:171], v9, s[12:15], s21 offen
  s_mul_i32 s21, s20, 491520
  s_add_u32 s21, s21, 6291456
  s_add_u32 s21, s21, s44
  buffer_load_dwordx4 v[172:175], v4, s[12:15], s21 offen
  buffer_load_dwordx4 v[176:179], v5, s[12:15], s21 offen
  buffer_load_dwordx4 v[180:183], v6, s[12:15], s21 offen
  v_lshrrev_b32 v30, 2, v2
  v_lshl_add_u32 v30, v3, 3, v30
  v_mul_u32_u24 v30, 384, v30
  v_and_b32 v31, 3, v2
  v_lshl_add_u32 v30, v31, 3, v30
  v_lshrrev_b32 v31, 3, v1
  v_and_b32 v31, 3, v31
  v_lshlrev_b32 v31, 5, v31
  s_mul_i32 s21, s20, 96
  s_add_u32 s21, s21, 0
  v_xor_b32 v184, s21, v31
  v_add_u32 v184, v184, v30
  v_add_u32 v187, 61440, v184
  s_mul_i32 s21, s20, 96
  s_add_u32 s21, s21, 32
  v_xor_b32 v185, s21, v31
  v_add_u32 v185, v185, v30
  v_add_u32 v188, 61440, v185
  s_mul_i32 s21, s20, 96
  s_add_u32 s21, s21, 64
  v_xor_b32 v186, s21, v31
  v_add_u32 v186, v186, v30
  v_add_u32 v189, 61440, v186
  s_mul_i32 s22, s20, 15360
  v_lshl_add_u32 v30, v1, 4, s22
  v_add_u32 v31, 61440, v30
  s_waitcnt vmcnt(45)
  s_barrier
  ds_read_b64_tr_b16 a[0:1], v184 offset:0
  ds_read_b64_tr_b16 a[2:3], v184 offset:1536
  ds_read_b64_tr_b16 a[4:5], v185 offset:0
  ds_read_b64_tr_b16 a[6:7], v185 offset:1536
  ds_read_b64_tr_b16 a[8:9], v186 offset:0
  ds_read_b64_tr_b16 a[10:11], v186 offset:1536
  ds_read_b64_tr_b16 a[12:13], v184 offset:12288
  ds_read_b64_tr_b16 a[14:15], v184 offset:13824
  ds_read_b64_tr_b16 a[16:17], v185 offset:12288
  ds_read_b64_tr_b16 a[18:19], v185 offset:13824
  ds_read_b64_tr_b16 a[20:21], v186 offset:12288
  ds_read_b64_tr_b16 a[22:23], v186 offset:13824
  ds_read_b64_tr_b16 a[24:25], v184 offset:24576
  ds_read_b64_tr_b16 a[26:27], v184 offset:26112
  ds_read_b64_tr_b16 a[28:29], v185 offset:24576
  ds_read_b64_tr_b16 a[30:31], v185 offset:26112
  ds_read_b64_tr_b16 a[32:33], v186 offset:24576
  ds_read_b64_tr_b16 a[34:35], v186 offset:26112
  ds_read_b64_tr_b16 a[36:37], v184 offset:36864
  ds_read_b64_tr_b16 a[38:39], v184 offset:38400
  ds_read_b64_tr_b16 a[40:41], v185 offset:36864
  ds_read_b64_tr_b16 a[42:43], v185 offset:38400
  ds_read_b64_tr_b16 a[44:45], v186 offset:36864
  ds_read_b64_tr_b16 a[46:47], v186 offset:38400
  ds_read_b64_tr_b16 a[48:49], v184 offset:49152
  ds_read_b64_tr_b16 a[50:51], v184 offset:50688
  ds_read_b64_tr_b16 a[52:53], v185 offset:49152
  ds_read_b64_tr_b16 a[54:55], v185 offset:50688
  ds_read_b64_tr_b16 a[56:57], v186 offset:49152
  ds_read_b64_tr_b16 a[58:59], v186 offset:50688
  s_waitcnt lgkmcnt(0)
  s_barrier
  s_cmp_lg_u32 s40, 0
  s_cbranch_scc1 qg_269
  s_add_u32 s28, s38, 180355072
  s_addc_u32 s29, s39, 0
  s_mov_b32 s30, 4194304
  s_mov_b32 s31, 0x00020000
  v_lshrrev_b32 v22, 2, v2
  v_and_b32 v23, 3, v2
  v_lshlrev_b32 v23, 3, v23
  v_lshl_add_u32 v24, v3, 2, v22
  v_mul_u32_u24 v24, 160, v24
  s_mul_i32 s21, s20, 6400
  s_add_u32 s21, s21, 122880
  v_add3_u32 v24, v24, v23, s21
  v_add_u32 v25, v24, v23
  v_mul_u32_u24 v26, 20, v3
  v_add_u32 v26, v26, v22
  v_mul_u32_u24 v26, 160, v26
  s_mov_b32 s21, 122880
  v_add3_u32 v26, v26, v23, s21
  v_add_u32 v27, v26, v23
  s_and_b32 s22, s2, 7
  s_lshr_b32 s23, s2, 3
  ds_read_b64_tr_b16 v[192:193], v25 offset:0
  ds_read_b64_tr_b16 v[194:195], v25 offset:3200
  ds_read_b64_tr_b16 v[196:197], v25 offset:8
  ds_read_b64_tr_b16 v[198:199], v25 offset:3208
  ds_read_b64_tr_b16 v[200:201], v24 offset:64
  ds_read_b64_tr_b16 v[202:203], v24 offset:3264
  ds_read_b64_tr_b16 v[204:205], v25 offset:96
  ds_read_b64_tr_b16 v[206:207], v25 offset:3296
  ds_read_b64_tr_b16 v[208:209], v25 offset:104
  ds_read_b64_tr_b16 v[210:211], v25 offset:3304
  ds_read_b64_tr_b16 v[212:213], v27 offset:2560
  ds_read_b64_tr_b16 v[214:215], v27 offset:15360
  ds_read_b64_tr_b16 v[216:217], v27 offset:2568
  ds_read_b64_tr_b16 v[218:219], v27 offset:15368
  ds_read_b64_tr_b16 v[220:221], v26 offset:2624
  ds_read_b64_tr_b16 v[222:223], v26 offset:15424
  ds_read_b64_tr_b16 v[224:225], v27 offset:2656
  ds_read_b64_tr_b16 v[226:227], v27 offset:15456
  ds_read_b64_tr_b16 v[228:229], v27 offset:2664
  ds_read_b64_tr_b16 v[230:231], v27 offset:15464
  s_lshl_b32 s22, s22, 2
  s_add_u32 s22, s22, s23
  s_lshl_b32 s22, s22, 17
  s_lshr_b32 s21, s22, 8
  s_andn2_b32 s21, 8192, s21
  s_xor_b32 s21, s21, s80
  s_add_u32 s22, s22, s21
  s_add_u32 s23, s22, 65536
  s_cmp_eq_u32 s20, 0
  s_cselect_b32 s23, s23, 0x40000000
  s_lshl_b32 s21, s20, 14
  s_add_u32 s22, s22, s21
  v_add_u32 v22, 4096, v11
  s_waitcnt lgkmcnt(0)
  buffer_store_dwordx4 v[192:195], v11, s[28:31], s22 offen offset:0 sc1
  buffer_store_dwordx4 v[196:199], v11, s[28:31], s22 offen offset:1024 sc1
  buffer_store_dwordx4 v[200:203], v11, s[28:31], s22 offen offset:2048 sc1
  buffer_store_dwordx4 v[204:207], v11, s[28:31], s22 offen offset:3072 sc1
  buffer_store_dwordx4 v[208:211], v22, s[28:31], s22 offen offset:0 sc1
  buffer_store_dwordx4 v[212:215], v11, s[28:31], s23 offen offset:0 sc1
  buffer_store_dwordx4 v[216:219], v11, s[28:31], s23 offen offset:1024 sc1
  buffer_store_dwordx4 v[220:223], v11, s[28:31], s23 offen offset:2048 sc1
  buffer_store_dwordx4 v[224:227], v11, s[28:31], s23 offen offset:3072 sc1
  buffer_store_dwordx4 v[228:231], v22, s[28:31], s23 offen offset:0 sc1
qg_269:
  s_waitcnt vmcnt(30)
  s_barrier
  ds_read_b64_tr_b16 a[60:61], v187 offset:0
  ds_read_b64_tr_b16 a[62:63], v187 offset:1536
  ds_read_b64_tr_b16 a[64:65], v188 offset:0
  ds_read_b64_tr_b16 a[66:67], v188 offset:1536
  ds_read_b64_tr_b16 a[68:69], v189 offset:0
  ds_read_b64_tr_b16 a[70:71], v189 offset:1536
  ds_read_b64_tr_b16 a[72:73], v187 offset:12288
  ds_read_b64_tr_b16 a[74:75], v187 offset:13824
  ds_read_b64_tr_b16 a[76:77], v188 offset:12288
  ds_read_b64_tr_b16 a[78:79], v188 offset:13824
  ds_read_b64_tr_b16 a[80:81], v189 offset:12288
  ds_read_b64_tr_b16 a[82:83], v189 offset:13824
  ds_read_b64_tr_b16 a[84:85], v187 offset:24576
  ds_read_b64_tr_b16 a[86:87], v187 offset:26112
  ds_read_b64_tr_b16 a[88:89], v188 offset:24576
  ds_read_b64_tr_b16 a[90:91], v188 offset:26112
  ds_read_b64_tr_b16 a[92:93], v189 offset:24576
  ds_read_b64_tr_b16 a[94:95], v189 offset:26112
  ds_read_b64_tr_b16 a[96:97], v187 offset:36864
  ds_read_b64_tr_b16 a[98:99], v187 offset:38400
  ds_read_b64_tr_b16 a[100:101], v188 offset:36864
  ds_read_b64_tr_b16 a[102:103], v188 offset:38400
  ds_read_b64_tr_b16 a[104:105], v189 offset:36864
  ds_read_b64_tr_b16 a[106:107], v189 offset:38400
  ds_read_b64_tr_b16 a[108:109], v187 offset:49152
  ds_read_b64_tr_b16 a[110:111], v187 offset:50688
  ds_read_b64_tr_b16 a[112:113], v188 offset:49152
  ds_read_b64_tr_b16 a[114:115], v188 offset:50688
  ds_read_b64_tr_b16 a[116:117], v189 offset:49152
  ds_read_b64_tr_b16 a[118:119], v189 offset:50688
  s_waitcnt lgkmcnt(0)
  s_barrier
  s_waitcnt vmcnt(15)
  ds_write_b128 v30, v[64:67] offset:0
  ds_write_b128 v30, v[68:71] offset:1024
  ds_write_b128 v30, v[72:75] offset:2048
  ds_write_b128 v30, v[76:79] offset:3072
  ds_write_b128 v30, v[80:83] offset:4096
  ds_write_b128 v30, v[84:87] offset:5120
  ds_write_b128 v30, v[88:91] offset:6144
  ds_write_b128 v30, v[92:95] offset:7168
  ds_write_b128 v30, v[96:99] offset:8192
  ds_write_b128 v30, v[100:103] offset:9216
  ds_write_b128 v30, v[104:107] offset:10240
  ds_write_b128 v30, v[108:111] offset:11264
  ds_write_b128 v30, v[112:115] offset:12288
  ds_write_b128 v30, v[116:119] offset:13312
  ds_write_b128 v30, v[120:123] offset:14336
  s_waitcnt lgkmcnt(0)
  s_barrier
  ds_read_b64_tr_b16 a[120:121], v184 offset:0
  ds_read_b64_tr_b16 a[122:123], v184 offset:1536
  ds_read_b64_tr_b16 a[124:125], v185 offset:0
  ds_read_b64_tr_b16 a[126:127], v185 offset:1536
  ds_read_b64_tr_b16 a[128:129], v186 offset:0
  ds_read_b64_tr_b16 a[130:131], v186 offset:1536
  ds_read_b64_tr_b16 a[132:133], v184 offset:12288
  ds_read_b64_tr_b16 a[134:135], v184 offset:13824
  ds_read_b64_tr_b16 a[136:137], v185 offset:12288
  ds_read_b64_tr_b16 a[138:139], v185 offset:13824
  ds_read_b64_tr_b16 a[140:141], v186 offset:12288
  ds_read_b64_tr_b16 a[142:143], v186 offset:13824
  ds_read_b64_tr_b16 a[144:145], v184 offset:24576
  ds_read_b64_tr_b16 a[146:147], v184 offset:26112
  ds_read_b64_tr_b16 a[148:149], v185 offset:24576
  ds_read_b64_tr_b16 a[150:151], v185 offset:26112
  ds_read_b64_tr_b16 a[152:153], v186 offset:24576
  ds_read_b64_tr_b16 a[154:155], v186 offset:26112
  ds_read_b64_tr_b16 a[156:157], v184 offset:36864
  ds_read_b64_tr_b16 a[158:159], v184 offset:38400
  ds_read_b64_tr_b16 a[160:161], v185 offset:36864
  ds_read_b64_tr_b16 a[162:163], v185 offset:38400
  ds_read_b64_tr_b16 a[164:165], v186 offset:36864
  ds_read_b64_tr_b16 a[166:167], v186 offset:38400
  ds_read_b64_tr_b16 a[168:169], v184 offset:49152
  ds_read_b64_tr_b16 a[170:171], v184 offset:50688
  ds_read_b64_tr_b16 a[172:173], v185 offset:49152
  ds_read_b64_tr_b16 a[174:175], v185 offset:50688
  ds_read_b64_tr_b16 a[176:177], v186 offset:49152
  ds_read_b64_tr_b16 a[178:179], v186 offset:50688
  s_waitcnt lgkmcnt(0)
  s_barrier
  s_waitcnt vmcnt(0)
  s_cmp_eq_u32 s40, 0
  s_cselect_b32 s30, 0, 2457600
  v_lshrrev_b32 v4, 3, v1
  v_and_b32 v5, 7, v1
  v_xor_b32 v5, v5, v4
  s_mul_i32 s21, s20, 32
  v_add_u32 v4, s21, v4
  v_mul_u32_u24 v4, 1280, v4
  v_lshl_add_u32 v10, v5, 4, v4
  s_mul_i32 s31, s20, 4096
  v_add_u32 v11, 10240, v10
  v_add_u32 v12, 20480, v10
  v_add_u32 v13, 30720, v10
  s_add_u32 m0, s31, 0
  s_nop 0
  buffer_load_dwordx4 v10, s[8:11], s30 offen lds
  s_add_u32 m0, s31, 1024
  s_nop 0
  buffer_load_dwordx4 v11, s[8:11], s30 offen lds
  s_add_u32 m0, s31, 2048
  s_nop 0
  buffer_load_dwordx4 v12, s[8:11], s30 offen lds
  s_add_u32 m0, s31, 3072
  s_nop 0
  buffer_load_dwordx4 v13, s[8:11], s30 offen lds
  s_add_u32 s30, s30, 128
  s_add_u32 m0, s31, 16384
  s_nop 0
  buffer_load_dwordx4 v10, s[8:11], s30 offen lds
  s_add_u32 m0, s31, 17408
  s_nop 0
  buffer_load_dwordx4 v11, s[8:11], s30 offen lds
  s_add_u32 m0, s31, 18432
  s_nop 0
  buffer_load_dwordx4 v12, s[8:11], s30 offen lds
  s_add_u32 m0, s31, 19456
  s_nop 0
  buffer_load_dwordx4 v13, s[8:11], s30 offen lds
  s_add_u32 s30, s30, 128
  s_add_u32 m0, s31, 32768
  s_nop 0
  buffer_load_dwordx4 v10, s[8:11], s30 offen lds
  s_add_u32 m0, s31, 33792
  s_nop 0
  buffer_load_dwordx4 v11, s[8:11], s30 offen lds
  s_add_u32 m0, s31, 34816
  s_nop 0
  buffer_load_dwordx4 v12, s[8:11], s30 offen lds
  s_add_u32 m0, s31, 35840
  s_nop 0
  buffer_load_dwordx4 v13, s[8:11], s30 offen lds
  s_add_u32 s30, s30, 128
  ds_write_b128 v31, v[124:127] offset:0
  ds_write_b128 v31, v[128:131] offset:1024
  ds_write_b128 v31, v[132:135] offset:2048
  ds_write_b128 v31, v[136:139] offset:3072
  ds_write_b128 v31, v[140:143] offset:4096
  ds_write_b128 v31, v[144:147] offset:5120
  ds_write_b128 v31, v[148:151] offset:6144
  ds_write_b128 v31, v[152:155] offset:7168
  ds_write_b128 v31, v[156:159] offset:8192
  ds_write_b128 v31, v[160:163] offset:9216
  ds_write_b128 v31, v[164:167] offset:10240
  ds_write_b128 v31, v[168:171] offset:11264
  ds_write_b128 v31, v[172:175] offset:12288
  ds_write_b128 v31, v[176:179] offset:13312
  ds_write_b128 v31, v[180:183] offset:14336
  s_waitcnt lgkmcnt(0)
  s_barrier
  ds_read_b64_tr_b16 a[180:181], v187 offset:0
  ds_read_b64_tr_b16 a[182:183], v187 offset:1536
  ds_read_b64_tr_b16 a[184:185], v188 offset:0
  ds_read_b64_tr_b16 a[186:187], v188 offset:1536
  ds_read_b64_tr_b16 a[188:189], v189 offset:0
  ds_read_b64_tr_b16 a[190:191], v189 offset:1536
  ds_read_b64_tr_b16 a[192:193], v187 offset:12288
  ds_read_b64_tr_b16 a[194:195], v187 offset:13824
  ds_read_b64_tr_b16 a[196:197], v188 offset:12288
  ds_read_b64_tr_b16 a[198:199], v188 offset:13824
  ds_read_b64_tr_b16 a[200:201], v189 offset:12288
  ds_read_b64_tr_b16 a[202:203], v189 offset:13824
  ds_read_b64_tr_b16 a[204:205], v187 offset:24576
  ds_read_b64_tr_b16 a[206:207], v187 offset:26112
  ds_read_b64_tr_b16 a[208:209], v188 offset:24576
  ds_read_b64_tr_b16 a[210:211], v188 offset:26112
  ds_read_b64_tr_b16 a[212:213], v189 offset:24576
  ds_read_b64_tr_b16 a[214:215], v189 offset:26112
  ds_read_b64_tr_b16 a[216:217], v187 offset:36864
  ds_read_b64_tr_b16 a[218:219], v187 offset:38400
  ds_read_b64_tr_b16 a[220:221], v188 offset:36864
  ds_read_b64_tr_b16 a[222:223], v188 offset:38400
  ds_read_b64_tr_b16 a[224:225], v189 offset:36864
  ds_read_b64_tr_b16 a[226:227], v189 offset:38400
  ds_read_b64_tr_b16 a[228:229], v187 offset:49152
  ds_read_b64_tr_b16 a[230:231], v187 offset:50688
  ds_read_b64_tr_b16 a[232:233], v188 offset:49152
  ds_read_b64_tr_b16 a[234:235], v188 offset:50688
  ds_read_b64_tr_b16 a[236:237], v189 offset:49152
  ds_read_b64_tr_b16 a[238:239], v189 offset:50688
  s_waitcnt lgkmcnt(0)
  s_barrier
  s_and_b32 s21, s2, 3
  s_lshl_b32 s21, s21, 7
  s_add_u32 s21, s21, 29696
  s_xor_b32 s21, s21, s80
  s_cmp_lg_u32 s40, 0
  s_cbranch_scc1 qg_270
  s_cmp_lg_u32 s20, 0
  s_cbranch_scc1 af_271
  v_mov_b32 v8, 0
  v_mov_b32 v9, 1
  s_mov_b64 exec, 1
  buffer_atomic_add v9, v8, s[72:75], s21 offen sc1
  s_mov_b64 exec, -1
  s_nop 1
af_271:
qg_270:
  s_add_u32 s56, s38, 218103808
  s_addc_u32 s57, s39, 0
  s_mov_b32 s58, 12582912
  s_mov_b32 s59, 0x00020000
  s_cmp_eq_u32 s40, 0
  s_cselect_b32 s85, 1, 2
  s_cselect_b32 s91, 0, 1
  s_sub_u32 s87, s41, s91
  s_add_u32 s89, s87, 1
  s_mul_i32 s90, s41, 163840
  s_sub_u32 s90, 162688, s90
  s_mov_b32 s26, s41
  s_mul_i32 s86, s42, 393216
  s_lshl_b32 s46, s40, 2
  s_add_u32 s46, s46, s20
  v_and_b32 v6, 7, v2
  v_add_u32 v4, 0, v3
  v_xor_b32 v4, v4, v6
  v_lshlrev_b32 v4, 4, v4
  v_lshl_add_u32 v14, v2, 7, v4
  v_add_u32 v16, 65536, v14
  v_add_u32 v18, 131072, v14
  v_add_u32 v4, 4, v3
  v_xor_b32 v4, v4, v6
  v_lshlrev_b32 v4, 4, v4
  v_lshl_add_u32 v15, v2, 7, v4
  v_add_u32 v17, 65536, v15
  v_add_u32 v19, 131072, v15
  v_lshlrev_b32 v26, 4, v1
  v_mov_b32 v28, 1
  v_mov_b32 v4, 0x40000000
  v_cmp_eq_u32 vcc, 0, v0
  s_nop 1
  v_cndmask_b32 v27, v4, 0, vcc
  s_mul_i32 s21, s20, 3072
  s_add_u32 s21, s21, 81920
  v_add_u32 v20, s21, v26
  s_mul_i32 s21, s20, 12288
  s_add_u32 s21, s21, 81920
  v_add_u32 v21, s21, v26
  v_add_u32 v22, 2048, v21
  v_add_u32 v23, 2056, v21
  v_and_b32 v4, 7, v2
  v_lshlrev_b32 v4, 4, v4
  v_lshl_add_u32 v24, v3, 7, v4
  v_lshrrev_b32 v25, 1, v24
  v_lshlrev_b32 v29, 3, v1
  v_and_b32 v4, 3, v1
  v_lshlrev_b32 v30, 3, v4
  v_mov_b32 v31, 0xf149f2ca
  v_mov_b32 v32, 0
  v_mov_b32 v4, 1073741824
  v_cmp_eq_u32 vcc, 0, v1
  v_lshlrev_b32 v5, 2, v3
  v_sub_u32 v5, v2, v5
  v_cndmask_b32 v33, v4, 0, vcc
  v_cmp_gt_u32 s[62:63], 2, v3
  s_mov_b32 s83, 0x3dd53b95
  s_lshl_b32 s77, s42, 7
  s_add_u32 s77, s77, 0
  s_xor_b32 s77, s77, s80
  s_lshl_b32 s45, s46, 21
  s_lshl_b32 s21, s46, 13
  s_and_b32 s21, s21, 8192
  s_xor_b32 s21, s21, s80
  s_add_u32 s45, s45, s21
  s_lshl_b32 s21, s42, 16
  s_add_u32 s45, s45, s21
  s_lshr_b32 s47, s42, 1
  s_lshl_b32 s47, s47, 14
  s_and_b32 s22, s42, 1
  s_mul_i32 s22, s22, 2560
  s_add_u32 s47, s47, s22
  s_lshl_b32 s21, s46, 19
  s_lshl_b32 s22, s46, 11
  s_and_b32 s22, s22, 8192
  s_xor_b32 s22, s22, s80
  s_add_u32 s21, s21, s22
  s_add_u32 s21, s21, 136314880
  s_xor_b32 s21, s21, 8192
  s_add_u32 s47, s47, s21
  s_add_u32 s47, s47, 48234496
  s_lshl_b32 s48, s46, 7
  s_add_u32 s48, s48, 8192
  s_xor_b32 s48, s48, s80
  s_add_u32 s43, s46, 1
  s_mov_b32 s49, 0
  s_mov_b32 s50, 1073741824
  s_mov_b32 s81, 1073741824
  s_mov_b32 s82, 1073741824
  s_mov_b32 s84, 1073741824
  v_cmp_le_i32 s[64:65], 0, v5
  v_cmp_le_i32 s[66:67], 1, v5
  v_cmp_le_i32 s[68:69], 2, v5
  v_cmp_le_i32 s[70:71], 3, v5
  s_waitcnt vmcnt(8)
  s_barrier
  ds_read_b128 v[160:163], v14 offset:0
  ds_read_b128 v[164:167], v14 offset:2048
  ds_read_b128 v[168:171], v14 offset:4096
  ds_read_b128 v[172:175], v14 offset:6144
  s_waitcnt lgkmcnt(3)
  .p2align 3
qa_276:
  v_mfma_f32_16x16x32_bf16 v[64:67], a[0:3], v[160:163], 0
  ds_read_b128 v[176:179], v14 offset:8192
  v_cvt_pk_bf16_f32 v221, v126, v127
  v_mfma_f32_16x16x32_bf16 v[68:71], a[4:7], v[160:163], 0
  v_cvt_pk_bf16_f32 v222, v128, v129
  v_cvt_pk_bf16_f32 v223, v130, v131
  v_mfma_f32_16x16x32_bf16 v[72:75], a[8:11], v[160:163], 0
  s_waitcnt lgkmcnt(3)
  v_cvt_pk_bf16_f32 v226, v132, v133
  v_cvt_pk_bf16_f32 v227, v134, v135
  v_mfma_f32_16x16x32_bf16 v[76:79], a[0:3], v[164:167], 0
  ds_read_b128 v[180:183], v14 offset:10240
  v_cvt_pk_bf16_f32 v228, v136, v137
  v_mfma_f32_16x16x32_bf16 v[80:83], a[4:7], v[164:167], 0
  v_cvt_pk_bf16_f32 v229, v138, v139
  v_cvt_pk_bf16_f32 v230, v140, v141
  v_mfma_f32_16x16x32_bf16 v[84:87], a[8:11], v[164:167], 0
  s_waitcnt lgkmcnt(3)
  v_cvt_pk_bf16_f32 v231, v142, v143
  v_cvt_pk_bf16_f32 v236, v144, v145
  v_mfma_f32_16x16x32_bf16 v[88:91], a[0:3], v[168:171], 0
  ds_read_b128 v[184:187], v14 offset:12288
  v_cvt_pk_bf16_f32 v237, v146, v147
  v_mfma_f32_16x16x32_bf16 v[92:95], a[4:7], v[168:171], 0
  v_cvt_pk_bf16_f32 v232, v148, v149
  v_cvt_pk_bf16_f32 v233, v150, v151
  v_mfma_f32_16x16x32_bf16 v[96:99], a[8:11], v[168:171], 0
  s_waitcnt lgkmcnt(3)
  v_cvt_pk_bf16_f32 v234, v152, v153
  v_cvt_pk_bf16_f32 v235, v154, v155
  v_mfma_f32_16x16x32_bf16 v[100:103], a[0:3], v[172:175], 0
  ds_read_b128 v[188:191], v14 offset:14336
  v_cvt_pk_bf16_f32 v238, v156, v157
  v_mfma_f32_16x16x32_bf16 v[104:107], a[4:7], v[172:175], 0
  v_cvt_pk_bf16_f32 v239, v158, v159
  ds_write_b128 v20, v[192:195] offset:0
  v_mfma_f32_16x16x32_bf16 v[108:111], a[8:11], v[172:175], 0
  s_waitcnt lgkmcnt(4)
  v_mfma_f32_16x16x32_bf16 v[112:115], a[0:3], v[176:179], 0
  ds_read_b128 v[160:163], v15 offset:0
  s_waitcnt vmcnt(4)
  v_mfma_f32_16x16x32_bf16 v[116:119], a[4:7], v[176:179], 0
  s_add_u32 m0, s31, 49152
  v_cmp_gt_u32 vcc, s49, v32
  v_mfma_f32_16x16x32_bf16 v[120:123], a[8:11], v[176:179], 0
  s_waitcnt lgkmcnt(4)
  buffer_load_dwordx4 v10, s[8:11], s30 offen lds
  s_cbranch_vccnz qw_277
qj_278:
  v_mfma_f32_16x16x32_bf16 v[124:127], a[0:3], v[180:183], 0
  s_add_u32 s29, s50, 4096
  ds_read_b128 v[164:167], v15 offset:2048
  ds_write_b128 v20, v[196:199] offset:1024
  v_mfma_f32_16x16x32_bf16 v[128:131], a[4:7], v[180:183], 0
  v_mfma_f32_16x16x32_bf16 v[132:135], a[8:11], v[180:183], 0
  s_waitcnt lgkmcnt(5)
  buffer_load_dwordx4 a[240:243], v24, s[16:19], s29 offen offset:2560 sc1
  v_mfma_f32_16x16x32_bf16 v[136:139], a[0:3], v[184:187], 0
  ds_read_b128 v[168:171], v15 offset:4096
  v_mfma_f32_16x16x32_bf16 v[140:143], a[4:7], v[184:187], 0
  s_add_u32 m0, s31, 50176
  v_mfma_f32_16x16x32_bf16 v[144:147], a[8:11], v[184:187], 0
  s_waitcnt lgkmcnt(5)
  buffer_load_dwordx4 v11, s[8:11], s30 offen lds
  ds_write_b128 v20, v[200:203] offset:2048
  v_mfma_f32_16x16x32_bf16 v[148:151], a[0:3], v[188:191], 0
  ds_read_b128 v[172:175], v15 offset:6144
  v_mfma_f32_16x16x32_bf16 v[152:155], a[4:7], v[188:191], 0
  v_mfma_f32_16x16x32_bf16 v[156:159], a[8:11], v[188:191], 0
  s_waitcnt lgkmcnt(5)
  buffer_load_dwordx2 v[240:241], v25, s[16:19], s29 offen offset:3072 sc1
  s_add_u32 s29, s50, 20480
  v_mfma_f32_16x16x32_bf16 v[64:67], a[12:15], v[160:163], v[64:67]
  ds_read_b128 v[176:179], v15 offset:8192
  v_mfma_f32_16x16x32_bf16 v[68:71], a[16:19], v[160:163], v[68:71]
  s_add_u32 m0, s31, 51200
  ds_write_b128 v20, v[204:207] offset:12288
  v_mfma_f32_16x16x32_bf16 v[72:75], a[20:23], v[160:163], v[72:75]
  s_waitcnt lgkmcnt(6)
  buffer_load_dwordx4 v12, s[8:11], s30 offen lds
  v_mfma_f32_16x16x32_bf16 v[76:79], a[12:15], v[164:167], v[76:79]
  ds_read_b128 v[180:183], v15 offset:10240
  v_mfma_f32_16x16x32_bf16 v[80:83], a[16:19], v[164:167], v[80:83]
  v_mfma_f32_16x16x32_bf16 v[84:87], a[20:23], v[164:167], v[84:87]
  s_waitcnt lgkmcnt(5)
  buffer_load_dwordx4 a[244:247], v24, s[16:19], s29 offen offset:2560 sc1
  v_mfma_f32_16x16x32_bf16 v[88:91], a[12:15], v[168:171], v[88:91]
  ds_read_b128 v[184:187], v15 offset:12288
  ds_write_b128 v20, v[208:211] offset:13312
  v_mfma_f32_16x16x32_bf16 v[92:95], a[16:19], v[168:171], v[92:95]
  s_add_u32 m0, s31, 52224
  v_mfma_f32_16x16x32_bf16 v[96:99], a[20:23], v[168:171], v[96:99]
  s_waitcnt lgkmcnt(5)
  buffer_load_dwordx4 v13, s[8:11], s30 offen lds
  v_mfma_f32_16x16x32_bf16 v[100:103], a[12:15], v[172:175], v[100:103]
  s_add_u32 s30, s30, 128
  ds_read_b128 v[188:191], v15 offset:14336
  v_mfma_f32_16x16x32_bf16 v[104:107], a[16:19], v[172:175], v[104:107]
  v_mfma_f32_16x16x32_bf16 v[108:111], a[20:23], v[172:175], v[108:111]
  s_waitcnt lgkmcnt(5)
  ds_write_b128 v20, v[212:215] offset:14336
  v_mfma_f32_16x16x32_bf16 v[112:115], a[12:15], v[176:179], v[112:115]
  s_waitcnt vmcnt(11)
  s_barrier
  ds_read_b128 v[160:163], v14 offset:16384
  v_mfma_f32_16x16x32_bf16 v[116:119], a[16:19], v[176:179], v[116:119]
  s_waitcnt vmcnt(13)
  buffer_atomic_add v28, v33, s[72:75], s84 offen sc1
  v_mfma_f32_16x16x32_bf16 v[120:123], a[20:23], v[176:179], v[120:123]
  s_waitcnt lgkmcnt(5)
  v_mfma_f32_16x16x32_bf16 v[124:127], a[12:15], v[180:183], v[124:127]
  ds_read_b128 v[164:167], v14 offset:18432
  v_mfma_f32_16x16x32_bf16 v[128:131], a[16:19], v[180:183], v[128:131]
  ds_write_b128 v20, v[216:219] offset:24576
  buffer_load_dwordx2 v[242:243], v25, s[16:19], s29 offen offset:3072 sc1
  v_mfma_f32_16x16x32_bf16 v[132:135], a[20:23], v[180:183], v[132:135]
  s_add_u32 s29, s50, 36864
  s_waitcnt lgkmcnt(6)
  v_mfma_f32_16x16x32_bf16 v[136:139], a[12:15], v[184:187], v[136:139]
  ds_read_b128 v[168:171], v14 offset:20480
  v_mfma_f32_16x16x32_bf16 v[140:143], a[16:19], v[184:187], v[140:143]
  buffer_load_dwordx4 a[248:251], v24, s[16:19], s29 offen offset:2560 sc1
  v_mfma_f32_16x16x32_bf16 v[144:147], a[20:23], v[184:187], v[144:147]
  s_waitcnt lgkmcnt(5)
  v_mfma_f32_16x16x32_bf16 v[148:151], a[12:15], v[188:191], v[148:151]
  ds_read_b128 v[172:175], v14 offset:22528
  ds_write_b128 v20, v[220:223] offset:25600
  v_mfma_f32_16x16x32_bf16 v[152:155], a[16:19], v[188:191], v[152:155]
  buffer_load_dwordx2 v[244:245], v25, s[16:19], s29 offen offset:3072 sc1
  s_add_u32 s29, s50, 53248
  v_mfma_f32_16x16x32_bf16 v[156:159], a[20:23], v[188:191], v[156:159]
  s_waitcnt lgkmcnt(5)
  v_mfma_f32_16x16x32_bf16 v[64:67], a[24:27], v[160:163], v[64:67]
  ds_read_b128 v[176:179], v14 offset:24576
  v_mfma_f32_16x16x32_bf16 v[68:71], a[28:31], v[160:163], v[68:71]
  s_add_u32 m0, s31, 65536
  v_mfma_f32_16x16x32_bf16 v[72:75], a[32:35], v[160:163], v[72:75]
  s_waitcnt lgkmcnt(5)
  buffer_load_dwordx4 v10, s[8:11], s30 offen lds
  ds_write_b128 v20, v[224:227] offset:26624
  v_mfma_f32_16x16x32_bf16 v[76:79], a[24:27], v[164:167], v[76:79]
  ds_read_b128 v[180:183], v14 offset:26624
  v_mfma_f32_16x16x32_bf16 v[80:83], a[28:31], v[164:167], v[80:83]
  v_mfma_f32_16x16x32_bf16 v[84:87], a[32:35], v[164:167], v[84:87]
  s_waitcnt lgkmcnt(5)
  buffer_load_dwordx4 a[252:255], v24, s[16:19], s29 offen offset:2560 sc1
  v_mfma_f32_16x16x32_bf16 v[88:91], a[24:27], v[168:171], v[88:91]
  ds_read_b128 v[184:187], v14 offset:28672
  v_mfma_f32_16x16x32_bf16 v[92:95], a[28:31], v[168:171], v[92:95]
  ds_write_b128 v20, v[228:231] offset:36864
  v_mfma_f32_16x16x32_bf16 v[96:99], a[32:35], v[168:171], v[96:99]
  s_waitcnt lgkmcnt(6)
  buffer_load_dwordx2 v[246:247], v25, s[16:19], s29 offen offset:3072 sc1
  v_mfma_f32_16x16x32_bf16 v[100:103], a[24:27], v[172:175], v[100:103]
  ds_read_b128 v[188:191], v14 offset:30720
  v_mfma_f32_16x16x32_bf16 v[104:107], a[28:31], v[172:175], v[104:107]
  s_add_u32 m0, s31, 66560
  v_mfma_f32_16x16x32_bf16 v[108:111], a[32:35], v[172:175], v[108:111]
  s_waitcnt lgkmcnt(5)
  buffer_load_dwordx4 v11, s[8:11], s30 offen lds
  v_mfma_f32_16x16x32_bf16 v[112:115], a[24:27], v[176:179], v[112:115]
  ds_read_b128 v[160:163], v15 offset:16384
  ds_write_b128 v20, v[232:235] offset:37888
  v_mfma_f32_16x16x32_bf16 v[116:119], a[28:31], v[176:179], v[116:119]
  v_mfma_f32_16x16x32_bf16 v[120:123], a[32:35], v[176:179], v[120:123]
  s_waitcnt lgkmcnt(5)
  v_mfma_f32_16x16x32_bf16 v[124:127], a[24:27], v[180:183], v[124:127]
  ds_read_b128 v[164:167], v15 offset:18432
  v_mfma_f32_16x16x32_bf16 v[128:131], a[28:31], v[180:183], v[128:131]
  v_mfma_f32_16x16x32_bf16 v[132:135], a[32:35], v[180:183], v[132:135]
  s_waitcnt lgkmcnt(5)
  ds_write_b128 v20, v[236:239] offset:38912
  v_mfma_f32_16x16x32_bf16 v[136:139], a[24:27], v[184:187], v[136:139]
  ds_read_b128 v[168:171], v15 offset:20480
  v_mfma_f32_16x16x32_bf16 v[140:143], a[28:31], v[184:187], v[140:143]
  s_add_u32 m0, s31, 67584
  s_cmp_eq_u32 s26, s89
  s_cselect_b32 s25, s90, 162688
  v_mfma_f32_16x16x32_bf16 v[144:147], a[32:35], v[184:187], v[144:147]
  s_sub_u32 s21, s26, s87
  s_waitcnt lgkmcnt(5)
  buffer_load_dwordx4 v12, s[8:11], s30 offen lds
  v_mfma_f32_16x16x32_bf16 v[148:151], a[24:27], v[188:191], v[148:151]
  ds_read_b128 v[172:175], v15 offset:22528
  v_mfma_f32_16x16x32_bf16 v[152:155], a[28:31], v[188:191], v[152:155]
  s_cmp_lt_u32 s21, s91
  s_cbranch_scc1 qs_274
qs_275:
  s_waitcnt lgkmcnt(2)
  v_mfma_f32_16x16x32_bf16 v[156:159], a[32:35], v[188:191], v[156:159]
  s_add_u32 s29, s50, 0
  s_waitcnt lgkmcnt(5)
  buffer_load_dwordx4 v[192:195], v26, s[16:19], s29 offen offset:0 sc1
  v_mfma_f32_16x16x32_bf16 v[64:67], a[36:39], v[160:163], v[64:67]
  ds_read_b128 v[176:179], v15 offset:24576
  v_mfma_f32_16x16x32_bf16 v[68:71], a[40:43], v[160:163], v[68:71]
  v_mfma_f32_16x16x32_bf16 v[72:75], a[44:47], v[160:163], v[72:75]
  s_waitcnt lgkmcnt(4)
  buffer_load_dwordx4 v[196:199], v26, s[16:19], s29 offen offset:1024 sc1
  v_mfma_f32_16x16x32_bf16 v[76:79], a[36:39], v[164:167], v[76:79]
  ds_read_b128 v[180:183], v15 offset:26624
  v_mfma_f32_16x16x32_bf16 v[80:83], a[40:43], v[164:167], v[80:83]
  s_add_u32 m0, s31, 68608
  v_mfma_f32_16x16x32_bf16 v[84:87], a[44:47], v[164:167], v[84:87]
  s_waitcnt lgkmcnt(3)
  buffer_load_dwordx4 v13, s[8:11], s30 offen lds
  v_mfma_f32_16x16x32_bf16 v[88:91], a[36:39], v[168:171], v[88:91]
  s_add_u32 s30, s30, 128
  ds_read_b128 v[184:187], v15 offset:28672
  v_mfma_f32_16x16x32_bf16 v[92:95], a[40:43], v[168:171], v[92:95]
  v_mfma_f32_16x16x32_bf16 v[96:99], a[44:47], v[168:171], v[96:99]
  s_waitcnt lgkmcnt(3)
  buffer_load_dwordx4 v[224:227], v26, s[16:19], s29 offen offset:2048 sc1
  s_add_u32 s29, s50, 16384
  v_mfma_f32_16x16x32_bf16 v[100:103], a[36:39], v[172:175], v[100:103]
  ds_read_b128 v[188:191], v15 offset:30720
  v_mfma_f32_16x16x32_bf16 v[104:107], a[40:43], v[172:175], v[104:107]
  v_mfma_f32_16x16x32_bf16 v[108:111], a[44:47], v[172:175], v[108:111]
  s_waitcnt lgkmcnt(3)
  buffer_load_dwordx4 v[200:203], v26, s[16:19], s29 offen offset:0 sc1
  v_mfma_f32_16x16x32_bf16 v[112:115], a[36:39], v[176:179], v[112:115]
  s_waitcnt vmcnt(21)
  s_barrier
  ds_read_b128 v[160:163], v14 offset:32768
  v_mfma_f32_16x16x32_bf16 v[116:119], a[40:43], v[176:179], v[116:119]
  v_mfma_f32_16x16x32_bf16 v[120:123], a[44:47], v[176:179], v[120:123]
  s_waitcnt lgkmcnt(3)
  buffer_load_dwordx4 v[204:207], v26, s[16:19], s29 offen offset:1024 sc1
  v_mfma_f32_16x16x32_bf16 v[124:127], a[36:39], v[180:183], v[124:127]
  ds_read_b128 v[164:167], v14 offset:34816
  v_mfma_f32_16x16x32_bf16 v[128:131], a[40:43], v[180:183], v[128:131]
  v_mfma_f32_16x16x32_bf16 v[132:135], a[44:47], v[180:183], v[132:135]
  s_waitcnt lgkmcnt(3)
  buffer_load_dwordx4 v[228:231], v26, s[16:19], s29 offen offset:2048 sc1
  s_add_u32 s29, s50, 32768
  v_mfma_f32_16x16x32_bf16 v[136:139], a[36:39], v[184:187], v[136:139]
  ds_read_b128 v[168:171], v14 offset:36864
  v_mfma_f32_16x16x32_bf16 v[140:143], a[40:43], v[184:187], v[140:143]
  v_mfma_f32_16x16x32_bf16 v[144:147], a[44:47], v[184:187], v[144:147]
  s_waitcnt lgkmcnt(3)
  buffer_load_dwordx4 v[208:211], v26, s[16:19], s29 offen offset:0 sc1
  v_mfma_f32_16x16x32_bf16 v[148:151], a[36:39], v[188:191], v[148:151]
  ds_read_b128 v[172:175], v14 offset:38912
  v_mfma_f32_16x16x32_bf16 v[152:155], a[40:43], v[188:191], v[152:155]
  v_mfma_f32_16x16x32_bf16 v[156:159], a[44:47], v[188:191], v[156:159]
  s_waitcnt lgkmcnt(3)
  buffer_load_dwordx4 v[212:215], v26, s[16:19], s29 offen offset:1024 sc1
  v_mfma_f32_16x16x32_bf16 v[64:67], a[48:51], v[160:163], v[64:67]
  ds_read_b128 v[176:179], v14 offset:40960
  v_mfma_f32_16x16x32_bf16 v[68:71], a[52:55], v[160:163], v[68:71]
  s_add_u32 m0, s31, 0
  v_mfma_f32_16x16x32_bf16 v[72:75], a[56:59], v[160:163], v[72:75]
  s_waitcnt lgkmcnt(3)
  buffer_load_dwordx4 v10, s[8:11], s30 offen lds
  v_mfma_f32_16x16x32_bf16 v[76:79], a[48:51], v[164:167], v[76:79]
  ds_read_b128 v[180:183], v14 offset:43008
  v_mfma_f32_16x16x32_bf16 v[80:83], a[52:55], v[164:167], v[80:83]
  v_mfma_f32_16x16x32_bf16 v[84:87], a[56:59], v[164:167], v[84:87]
  s_waitcnt lgkmcnt(3)
  buffer_load_dwordx4 v[232:235], v26, s[16:19], s29 offen offset:2048 sc1
  s_add_u32 s29, s50, 49152
  v_mfma_f32_16x16x32_bf16 v[88:91], a[48:51], v[168:171], v[88:91]
  ds_read_b128 v[184:187], v14 offset:45056
  v_mfma_f32_16x16x32_bf16 v[92:95], a[52:55], v[168:171], v[92:95]
  v_mfma_f32_16x16x32_bf16 v[96:99], a[56:59], v[168:171], v[96:99]
  s_waitcnt lgkmcnt(3)
  buffer_load_dwordx4 v[216:219], v26, s[16:19], s29 offen offset:0 sc1
  v_mfma_f32_16x16x32_bf16 v[100:103], a[48:51], v[172:175], v[100:103]
  ds_read_b128 v[188:191], v14 offset:47104
  v_mfma_f32_16x16x32_bf16 v[104:107], a[52:55], v[172:175], v[104:107]
  s_add_u32 m0, s31, 1024
  v_mfma_f32_16x16x32_bf16 v[108:111], a[56:59], v[172:175], v[108:111]
  s_waitcnt lgkmcnt(3)
  buffer_load_dwordx4 v11, s[8:11], s30 offen lds
  v_mfma_f32_16x16x32_bf16 v[112:115], a[48:51], v[176:179], v[112:115]
  ds_read_b128 v[160:163], v15 offset:32768
  v_mfma_f32_16x16x32_bf16 v[116:119], a[52:55], v[176:179], v[116:119]
  v_mfma_f32_16x16x32_bf16 v[120:123], a[56:59], v[176:179], v[120:123]
  s_waitcnt lgkmcnt(3)
  buffer_load_dwordx4 v[220:223], v26, s[16:19], s29 offen offset:1024 sc1
  v_mfma_f32_16x16x32_bf16 v[124:127], a[48:51], v[180:183], v[124:127]
  ds_read_b128 v[164:167], v15 offset:34816
  v_mfma_f32_16x16x32_bf16 v[128:131], a[52:55], v[180:183], v[128:131]
  v_mfma_f32_16x16x32_bf16 v[132:135], a[56:59], v[180:183], v[132:135]
  s_waitcnt lgkmcnt(3)
  buffer_load_dwordx4 v[236:239], v26, s[16:19], s29 offen offset:2048 sc1
  v_mfma_f32_16x16x32_bf16 v[136:139], a[48:51], v[184:187], v[136:139]
  ds_read_b128 v[168:171], v15 offset:36864
  v_mfma_f32_16x16x32_bf16 v[140:143], a[52:55], v[184:187], v[140:143]
  s_add_u32 m0, s31, 2048
  v_mfma_f32_16x16x32_bf16 v[144:147], a[56:59], v[184:187], v[144:147]
  s_waitcnt lgkmcnt(3)
  buffer_load_dwordx4 v12, s[8:11], s30 offen lds
  v_mfma_f32_16x16x32_bf16 v[148:151], a[48:51], v[188:191], v[148:151]
  ds_read_b128 v[172:175], v15 offset:38912
  v_mfma_f32_16x16x32_bf16 v[152:155], a[52:55], v[188:191], v[152:155]
  v_mfma_f32_16x16x32_bf16 v[156:159], a[56:59], v[188:191], v[156:159]
  s_waitcnt lgkmcnt(3)
  v_mfma_f32_16x16x32_bf16 v[64:67], a[60:63], v[160:163], v[64:67]
  ds_read_b128 v[176:179], v15 offset:40960
  v_mfma_f32_16x16x32_bf16 v[68:71], a[64:67], v[160:163], v[68:71]
  v_mfma_f32_16x16x32_bf16 v[72:75], a[68:71], v[160:163], v[72:75]
  s_waitcnt lgkmcnt(3)
  v_mfma_f32_16x16x32_bf16 v[76:79], a[60:63], v[164:167], v[76:79]
  ds_read_b128 v[180:183], v15 offset:43008
  v_mfma_f32_16x16x32_bf16 v[80:83], a[64:67], v[164:167], v[80:83]
  s_add_u32 m0, s31, 3072
  v_mfma_f32_16x16x32_bf16 v[84:87], a[68:71], v[164:167], v[84:87]
  s_waitcnt lgkmcnt(3)
  buffer_load_dwordx4 v13, s[8:11], s30 offen lds
  v_mfma_f32_16x16x32_bf16 v[88:91], a[60:63], v[168:171], v[88:91]
  s_add_u32 s30, s30, 128
  ds_read_b128 v[184:187], v15 offset:45056
  v_mfma_f32_16x16x32_bf16 v[92:95], a[64:67], v[168:171], v[92:95]
  v_mfma_f32_16x16x32_bf16 v[96:99], a[68:71], v[168:171], v[96:99]
  s_waitcnt lgkmcnt(3)
  v_mfma_f32_16x16x32_bf16 v[100:103], a[60:63], v[172:175], v[100:103]
  ds_read_b128 v[188:191], v15 offset:47104
  v_mfma_f32_16x16x32_bf16 v[104:107], a[64:67], v[172:175], v[104:107]
  v_mfma_f32_16x16x32_bf16 v[108:111], a[68:71], v[172:175], v[108:111]
  s_waitcnt lgkmcnt(3)
  v_mfma_f32_16x16x32_bf16 v[112:115], a[60:63], v[176:179], v[112:115]
  s_waitcnt vmcnt(26)
  s_barrier
  ds_read_b128 v[160:163], v14 offset:49152
  v_mfma_f32_16x16x32_bf16 v[116:119], a[64:67], v[176:179], v[116:119]
  v_mfma_f32_16x16x32_bf16 v[120:123], a[68:71], v[176:179], v[120:123]
  s_waitcnt lgkmcnt(3)
  v_mfma_f32_16x16x32_bf16 v[124:127], a[60:63], v[180:183], v[124:127]
  ds_read_b128 v[164:167], v14 offset:51200
  v_mfma_f32_16x16x32_bf16 v[128:131], a[64:67], v[180:183], v[128:131]
  v_mfma_f32_16x16x32_bf16 v[132:135], a[68:71], v[180:183], v[132:135]
  s_waitcnt lgkmcnt(3)
  v_mfma_f32_16x16x32_bf16 v[136:139], a[60:63], v[184:187], v[136:139]
  ds_read_b128 v[168:171], v14 offset:53248
  v_mfma_f32_16x16x32_bf16 v[140:143], a[64:67], v[184:187], v[140:143]
  v_mfma_f32_16x16x32_bf16 v[144:147], a[68:71], v[184:187], v[144:147]
  s_waitcnt lgkmcnt(3)
  v_mfma_f32_16x16x32_bf16 v[148:151], a[60:63], v[188:191], v[148:151]
  ds_read_b128 v[172:175], v14 offset:55296
  v_mfma_f32_16x16x32_bf16 v[152:155], a[64:67], v[188:191], v[152:155]
  v_mfma_f32_16x16x32_bf16 v[156:159], a[68:71], v[188:191], v[156:159]
  s_waitcnt lgkmcnt(3)
  v_mfma_f32_16x16x32_bf16 v[64:67], a[72:75], v[160:163], v[64:67]
  ds_read_b128 v[176:179], v14 offset:57344
  v_mfma_f32_16x16x32_bf16 v[68:71], a[76:79], v[160:163], v[68:71]
  s_add_u32 m0, s31, 16384
  v_mfma_f32_16x16x32_bf16 v[72:75], a[80:83], v[160:163], v[72:75]
  s_waitcnt lgkmcnt(3)
  buffer_load_dwordx4 v10, s[8:11], s30 offen lds
  v_mfma_f32_16x16x32_bf16 v[76:79], a[72:75], v[164:167], v[76:79]
  ds_read_b128 v[180:183], v14 offset:59392
  v_mfma_f32_16x16x32_bf16 v[80:83], a[76:79], v[164:167], v[80:83]
  v_mfma_f32_16x16x32_bf16 v[84:87], a[80:83], v[164:167], v[84:87]
  s_waitcnt lgkmcnt(3)
  v_mfma_f32_16x16x32_bf16 v[88:91], a[72:75], v[168:171], v[88:91]
  ds_read_b128 v[184:187], v14 offset:61440
  v_mfma_f32_16x16x32_bf16 v[92:95], a[76:79], v[168:171], v[92:95]
  v_mfma_f32_16x16x32_bf16 v[96:99], a[80:83], v[168:171], v[96:99]
  s_waitcnt lgkmcnt(3)
  v_mfma_f32_16x16x32_bf16 v[100:103], a[72:75], v[172:175], v[100:103]
  ds_read_b128 v[188:191], v14 offset:63488
  v_mfma_f32_16x16x32_bf16 v[104:107], a[76:79], v[172:175], v[104:107]
  s_add_u32 m0, s31, 17408
  v_mfma_f32_16x16x32_bf16 v[108:111], a[80:83], v[172:175], v[108:111]
  s_waitcnt lgkmcnt(3)
  buffer_load_dwordx4 v11, s[8:11], s30 offen lds
  v_mfma_f32_16x16x32_bf16 v[112:115], a[72:75], v[176:179], v[112:115]
  ds_read_b128 v[160:163], v15 offset:49152
  v_mfma_f32_16x16x32_bf16 v[116:119], a[76:79], v[176:179], v[116:119]
  v_mfma_f32_16x16x32_bf16 v[120:123], a[80:83], v[176:179], v[120:123]
  s_waitcnt lgkmcnt(3)
  v_mfma_f32_16x16x32_bf16 v[124:127], a[72:75], v[180:183], v[124:127]
  ds_read_b128 v[164:167], v15 offset:51200
  v_mfma_f32_16x16x32_bf16 v[128:131], a[76:79], v[180:183], v[128:131]
  v_mfma_f32_16x16x32_bf16 v[132:135], a[80:83], v[180:183], v[132:135]
  s_waitcnt lgkmcnt(3)
  v_mfma_f32_16x16x32_bf16 v[136:139], a[72:75], v[184:187], v[136:139]
  ds_read_b128 v[168:171], v15 offset:53248
  v_mfma_f32_16x16x32_bf16 v[140:143], a[76:79], v[184:187], v[140:143]
  s_add_u32 m0, s31, 18432
  v_mfma_f32_16x16x32_bf16 v[144:147], a[80:83], v[184:187], v[144:147]
  s_waitcnt lgkmcnt(3)
  buffer_load_dwordx4 v12, s[8:11], s30 offen lds
  v_mfma_f32_16x16x32_bf16 v[148:151], a[72:75], v[188:191], v[148:151]
  ds_read_b128 v[172:175], v15 offset:55296
  v_mfma_f32_16x16x32_bf16 v[152:155], a[76:79], v[188:191], v[152:155]
  v_mfma_f32_16x16x32_bf16 v[156:159], a[80:83], v[188:191], v[156:159]
  s_waitcnt lgkmcnt(3)
  v_mfma_f32_16x16x32_bf16 v[64:67], a[84:87], v[160:163], v[64:67]
  ds_read_b128 v[176:179], v15 offset:57344
  v_mfma_f32_16x16x32_bf16 v[68:71], a[88:91], v[160:163], v[68:71]
  v_mfma_f32_16x16x32_bf16 v[72:75], a[92:95], v[160:163], v[72:75]
  s_waitcnt lgkmcnt(3)
  v_mfma_f32_16x16x32_bf16 v[76:79], a[84:87], v[164:167], v[76:79]
  ds_read_b128 v[180:183], v15 offset:59392
  v_mfma_f32_16x16x32_bf16 v[80:83], a[88:91], v[164:167], v[80:83]
  s_add_u32 m0, s31, 19456
  v_mfma_f32_16x16x32_bf16 v[84:87], a[92:95], v[164:167], v[84:87]
  s_waitcnt lgkmcnt(3)
  buffer_load_dwordx4 v13, s[8:11], s30 offen lds
  v_mfma_f32_16x16x32_bf16 v[88:91], a[84:87], v[168:171], v[88:91]
  s_add_u32 s30, s30, 128
  ds_read_b128 v[184:187], v15 offset:61440
  v_mfma_f32_16x16x32_bf16 v[92:95], a[88:91], v[168:171], v[92:95]
  v_mfma_f32_16x16x32_bf16 v[96:99], a[92:95], v[168:171], v[96:99]
  s_waitcnt lgkmcnt(3)
  v_mfma_f32_16x16x32_bf16 v[100:103], a[84:87], v[172:175], v[100:103]
  ds_read_b128 v[188:191], v15 offset:63488
  v_mfma_f32_16x16x32_bf16 v[104:107], a[88:91], v[172:175], v[104:107]
  v_mfma_f32_16x16x32_bf16 v[108:111], a[92:95], v[172:175], v[108:111]
  s_waitcnt lgkmcnt(3)
  v_mfma_f32_16x16x32_bf16 v[112:115], a[84:87], v[176:179], v[112:115]
  s_waitcnt vmcnt(18)
  s_barrier
  ds_read_b128 v[160:163], v16 offset:0
  v_mfma_f32_16x16x32_bf16 v[116:119], a[88:91], v[176:179], v[116:119]
  v_mfma_f32_16x16x32_bf16 v[120:123], a[92:95], v[176:179], v[120:123]
  s_waitcnt lgkmcnt(3)
  v_mfma_f32_16x16x32_bf16 v[124:127], a[84:87], v[180:183], v[124:127]
  ds_read_b128 v[164:167], v16 offset:2048
  v_mfma_f32_16x16x32_bf16 v[128:131], a[88:91], v[180:183], v[128:131]
  v_mfma_f32_16x16x32_bf16 v[132:135], a[92:95], v[180:183], v[132:135]
  s_waitcnt lgkmcnt(3)
  v_mfma_f32_16x16x32_bf16 v[136:139], a[84:87], v[184:187], v[136:139]
  ds_read_b128 v[168:171], v16 offset:4096
  v_mfma_f32_16x16x32_bf16 v[140:143], a[88:91], v[184:187], v[140:143]
  v_mfma_f32_16x16x32_bf16 v[144:147], a[92:95], v[184:187], v[144:147]
  s_waitcnt lgkmcnt(3)
  v_mfma_f32_16x16x32_bf16 v[148:151], a[84:87], v[188:191], v[148:151]
  ds_read_b128 v[172:175], v16 offset:6144
  v_mfma_f32_16x16x32_bf16 v[152:155], a[88:91], v[188:191], v[152:155]
  v_mfma_f32_16x16x32_bf16 v[156:159], a[92:95], v[188:191], v[156:159]
  s_waitcnt lgkmcnt(3)
  v_mfma_f32_16x16x32_bf16 v[64:67], a[96:99], v[160:163], v[64:67]
  ds_read_b128 v[176:179], v16 offset:8192
  v_mfma_f32_16x16x32_bf16 v[68:71], a[100:103], v[160:163], v[68:71]
  s_add_u32 m0, s31, 32768
  v_mfma_f32_16x16x32_bf16 v[72:75], a[104:107], v[160:163], v[72:75]
  s_waitcnt lgkmcnt(3)
  buffer_load_dwordx4 v10, s[8:11], s30 offen lds
  v_mfma_f32_16x16x32_bf16 v[76:79], a[96:99], v[164:167], v[76:79]
  ds_read_b128 v[180:183], v16 offset:10240
  v_mfma_f32_16x16x32_bf16 v[80:83], a[100:103], v[164:167], v[80:83]
  v_mfma_f32_16x16x32_bf16 v[84:87], a[104:107], v[164:167], v[84:87]
  s_waitcnt lgkmcnt(3)
  v_mfma_f32_16x16x32_bf16 v[88:91], a[96:99], v[168:171], v[88:91]
  ds_read_b128 v[184:187], v16 offset:12288
  v_mfma_f32_16x16x32_bf16 v[92:95], a[100:103], v[168:171], v[92:95]
  v_mfma_f32_16x16x32_bf16 v[96:99], a[104:107], v[168:171], v[96:99]
  s_waitcnt lgkmcnt(3)
  v_mfma_f32_16x16x32_bf16 v[100:103], a[96:99], v[172:175], v[100:103]
  ds_read_b128 v[188:191], v16 offset:14336
  v_mfma_f32_16x16x32_bf16 v[104:107], a[100:103], v[172:175], v[104:107]
  s_add_u32 m0, s31, 33792
  v_mfma_f32_16x16x32_bf16 v[108:111], a[104:107], v[172:175], v[108:111]
  s_waitcnt lgkmcnt(3)
  buffer_load_dwordx4 v11, s[8:11], s30 offen lds
  v_mfma_f32_16x16x32_bf16 v[112:115], a[96:99], v[176:179], v[112:115]
  ds_read_b128 v[160:163], v17 offset:0
  v_mfma_f32_16x16x32_bf16 v[116:119], a[100:103], v[176:179], v[116:119]
  v_mfma_f32_16x16x32_bf16 v[120:123], a[104:107], v[176:179], v[120:123]
  s_waitcnt lgkmcnt(3)
  v_mfma_f32_16x16x32_bf16 v[124:127], a[96:99], v[180:183], v[124:127]
  ds_read_b128 v[164:167], v17 offset:2048
  v_mfma_f32_16x16x32_bf16 v[128:131], a[100:103], v[180:183], v[128:131]
  v_mfma_f32_16x16x32_bf16 v[132:135], a[104:107], v[180:183], v[132:135]
  s_waitcnt lgkmcnt(3)
  v_mfma_f32_16x16x32_bf16 v[136:139], a[96:99], v[184:187], v[136:139]
  ds_read_b128 v[168:171], v17 offset:4096
  v_mfma_f32_16x16x32_bf16 v[140:143], a[100:103], v[184:187], v[140:143]
  s_add_u32 m0, s31, 34816
  v_mfma_f32_16x16x32_bf16 v[144:147], a[104:107], v[184:187], v[144:147]
  s_waitcnt lgkmcnt(3)
  buffer_load_dwordx4 v12, s[8:11], s30 offen lds
  v_mfma_f32_16x16x32_bf16 v[148:151], a[96:99], v[188:191], v[148:151]
  ds_read_b128 v[172:175], v17 offset:6144
  v_mfma_f32_16x16x32_bf16 v[152:155], a[100:103], v[188:191], v[152:155]
  v_mfma_f32_16x16x32_bf16 v[156:159], a[104:107], v[188:191], v[156:159]
  s_waitcnt lgkmcnt(3)
  v_mfma_f32_16x16x32_bf16 v[64:67], a[108:111], v[160:163], v[64:67]
  ds_read_b128 v[176:179], v17 offset:8192
  v_mfma_f32_16x16x32_bf16 v[68:71], a[112:115], v[160:163], v[68:71]
  v_mfma_f32_16x16x32_bf16 v[72:75], a[116:119], v[160:163], v[72:75]
  s_waitcnt lgkmcnt(3)
  v_mfma_f32_16x16x32_bf16 v[76:79], a[108:111], v[164:167], v[76:79]
  ds_read_b128 v[180:183], v17 offset:10240
  v_mfma_f32_16x16x32_bf16 v[80:83], a[112:115], v[164:167], v[80:83]
  s_add_u32 m0, s31, 35840
  v_mfma_f32_16x16x32_bf16 v[84:87], a[116:119], v[164:167], v[84:87]
  s_waitcnt lgkmcnt(3)
  buffer_load_dwordx4 v13, s[8:11], s30 offen lds
  v_mfma_f32_16x16x32_bf16 v[88:91], a[108:111], v[168:171], v[88:91]
  s_add_u32 s30, s30, 128
  ds_read_b128 v[184:187], v17 offset:12288
  v_mfma_f32_16x16x32_bf16 v[92:95], a[112:115], v[168:171], v[92:95]
  v_mfma_f32_16x16x32_bf16 v[96:99], a[116:119], v[168:171], v[96:99]
  s_waitcnt lgkmcnt(3)
  v_mfma_f32_16x16x32_bf16 v[100:103], a[108:111], v[172:175], v[100:103]
  ds_read_b128 v[188:191], v17 offset:14336
  v_mfma_f32_16x16x32_bf16 v[104:107], a[112:115], v[172:175], v[104:107]
  v_mfma_f32_16x16x32_bf16 v[108:111], a[116:119], v[172:175], v[108:111]
  s_waitcnt lgkmcnt(3)
  v_mfma_f32_16x16x32_bf16 v[112:115], a[108:111], v[176:179], v[112:115]
  s_waitcnt vmcnt(8)
  s_barrier
  ds_read_b128 v[160:163], v14 offset:0
  v_mfma_f32_16x16x32_bf16 v[116:119], a[112:115], v[176:179], v[116:119]
  v_mfma_f32_16x16x32_bf16 v[120:123], a[116:119], v[176:179], v[120:123]
  s_waitcnt lgkmcnt(3)
  v_mfma_f32_16x16x32_bf16 v[124:127], a[108:111], v[180:183], v[124:127]
  ds_read_b128 v[164:167], v14 offset:2048
  v_mfma_f32_16x16x32_bf16 v[128:131], a[112:115], v[180:183], v[128:131]
  v_mfma_f32_16x16x32_bf16 v[132:135], a[116:119], v[180:183], v[132:135]
  s_waitcnt lgkmcnt(3)
  v_mfma_f32_16x16x32_bf16 v[136:139], a[108:111], v[184:187], v[136:139]
  ds_read_b128 v[168:171], v14 offset:4096
  v_mfma_f32_16x16x32_bf16 v[140:143], a[112:115], v[184:187], v[140:143]
  v_mfma_f32_16x16x32_bf16 v[144:147], a[116:119], v[184:187], v[144:147]
  s_waitcnt lgkmcnt(3)
  v_mfma_f32_16x16x32_bf16 v[148:151], a[108:111], v[188:191], v[148:151]
  ds_read_b128 v[172:175], v14 offset:6144
  v_mfma_f32_16x16x32_bf16 v[152:155], a[112:115], v[188:191], v[152:155]
  v_mfma_f32_16x16x32_bf16 v[156:159], a[116:119], v[188:191], v[156:159]
  s_waitcnt lgkmcnt(3)
  v_mfma_f32_16x16x32_bf16 v[64:67], a[120:123], v[160:163], v[64:67]
  ds_read_b128 v[176:179], v14 offset:8192
  v_mfma_f32_16x16x32_bf16 v[68:71], a[124:127], v[160:163], v[68:71]
  s_add_u32 m0, s31, 49152
  v_mfma_f32_16x16x32_bf16 v[72:75], a[128:131], v[160:163], v[72:75]
  s_waitcnt lgkmcnt(3)
  buffer_load_dwordx4 v10, s[8:11], s30 offen lds
  v_mfma_f32_16x16x32_bf16 v[76:79], a[120:123], v[164:167], v[76:79]
  ds_read_b128 v[180:183], v14 offset:10240
  s_waitcnt vmcnt(11)
  v_mfma_f32_16x16x32_bf16 v[80:83], a[124:127], v[164:167], v[80:83]
  v_swap_b32 v226, v228
  v_swap_b32 v227, v229
  v_mfma_f32_16x16x32_bf16 v[84:87], a[128:131], v[164:167], v[84:87]
  s_waitcnt lgkmcnt(3)
  v_swap_b32 v234, v236
  v_swap_b32 v235, v237
  v_mfma_f32_16x16x32_bf16 v[88:91], a[120:123], v[168:171], v[88:91]
  ds_read_b128 v[184:187], v14 offset:12288
  v_mfma_f32_16x16x32_bf16 v[92:95], a[124:127], v[168:171], v[92:95]
  ds_read_b128 v[56:59], v21 offset:0
  ds_read_b128 v[60:63], v21 offset:1024
  v_mfma_f32_16x16x32_bf16 v[96:99], a[128:131], v[168:171], v[96:99]
  s_waitcnt lgkmcnt(5)
  v_mfma_f32_16x16x32_bf16 v[100:103], a[120:123], v[172:175], v[100:103]
  ds_read_b128 v[188:191], v14 offset:14336
  v_mfma_f32_16x16x32_bf16 v[104:107], a[124:127], v[172:175], v[104:107]
  s_add_u32 m0, s31, 50176
  v_mfma_f32_16x16x32_bf16 v[108:111], a[128:131], v[172:175], v[108:111]
  s_waitcnt lgkmcnt(5)
  buffer_load_dwordx4 v11, s[8:11], s30 offen lds
  v_mfma_f32_16x16x32_bf16 v[112:115], a[120:123], v[176:179], v[112:115]
  ds_read_b128 v[160:163], v15 offset:0
  v_mfma_f32_16x16x32_bf16 v[116:119], a[124:127], v[176:179], v[116:119]
  ds_read_b128 v[248:251], v21 offset:3072
  ds_read_b128 v[252:255], v21 offset:4096
  v_mfma_f32_16x16x32_bf16 v[120:123], a[128:131], v[176:179], v[120:123]
  s_waitcnt lgkmcnt(4)
  v_mfma_f32_16x16x32_bf16 v[36:39], v[192:195], v[56:59], 0
  v_mfma_f32_16x16x32_bf16 v[44:47], v[192:195], v[60:63], 0
  v_mfma_f32_16x16x32_bf16 v[48:51], v[196:199], v[60:63], 0
  v_mfma_f32_16x16x32_bf16 v[40:43], a[240:243], v[56:59], 0
  v_mfma_f32_16x16x32_bf16 v[52:55], a[240:243], v[60:63], 0
  s_waitcnt lgkmcnt(7)
  ds_read2st64_b64 v[56:59], v22 offset0:0 offset1:6
  ds_read2st64_b64 v[60:63], v23 offset0:0 offset1:6
  v_mfma_f32_16x16x32_bf16 v[124:127], a[120:123], v[180:183], v[124:127]
  ds_read_b128 v[164:167], v15 offset:2048
  v_mfma_f32_16x16x32_bf16 v[128:131], a[124:127], v[180:183], v[128:131]
  v_mfma_f32_16x16x32_bf16 v[132:135], a[128:131], v[180:183], v[132:135]
  s_waitcnt lgkmcnt(9)
  v_mfma_f32_16x16x32_bf16 v[136:139], a[120:123], v[184:187], v[136:139]
  ds_read_b128 v[168:171], v15 offset:4096
  v_mfma_f32_16x16x32_bf16 v[140:143], a[124:127], v[184:187], v[140:143]
  s_add_u32 m0, s31, 51200
  v_mfma_f32_16x16x32_bf16 v[144:147], a[128:131], v[184:187], v[144:147]
  s_waitcnt lgkmcnt(4)
  buffer_load_dwordx4 v12, s[8:11], s30 offen lds
  v_mfma_f32_16x16x32_bf16 v[36:39], v[200:203], v[248:251], v[36:39]
  v_mfma_f32_16x16x32_bf16 v[44:47], v[200:203], v[252:255], v[44:47]
  v_mfma_f32_16x16x32_bf16 v[48:51], v[204:207], v[252:255], v[48:51]
  v_mfma_f32_16x16x32_bf16 v[40:43], a[244:247], v[248:251], v[40:43]
  v_mfma_f32_16x16x32_bf16 v[52:55], a[244:247], v[252:255], v[52:55]
  s_waitcnt lgkmcnt(7)
  ds_read_b128 v[248:251], v21 offset:6144
  ds_read_b128 v[252:255], v21 offset:7168
  v_mfma_f32_16x16x32_bf16 v[148:151], a[120:123], v[188:191], v[148:151]
  ds_read_b128 v[172:175], v15 offset:6144
  v_mfma_f32_16x16x32_bf16 v[152:155], a[124:127], v[188:191], v[152:155]
  v_mfma_f32_16x16x32_bf16 v[156:159], a[128:131], v[188:191], v[156:159]
  s_waitcnt lgkmcnt(9)
  v_mfma_f32_16x16x32_bf16 v[64:67], a[132:135], v[160:163], v[64:67]
  ds_read_b128 v[176:179], v15 offset:8192
  v_mfma_f32_16x16x32_bf16 v[68:71], a[136:139], v[160:163], v[68:71]
  v_mfma_f32_16x16x32_bf16 v[72:75], a[140:143], v[160:163], v[72:75]
  s_waitcnt lgkmcnt(6)
  v_mfma_f32_16x16x32_bf16 v[36:39], v[224:227], v[56:59], v[36:39]
  v_mfma_f32_16x16x32_bf16 v[44:47], v[224:227], v[60:63], v[44:47]
  v_mfma_f32_16x16x32_bf16 v[48:51], v[228:231], v[60:63], v[48:51]
  v_mfma_f32_16x16x32_bf16 v[40:43], v[240:243], v[56:59], v[40:43]
  v_mfma_f32_16x16x32_bf16 v[52:55], v[240:243], v[60:63], v[52:55]
  s_waitcnt lgkmcnt(5)
  ds_read_b128 v[56:59], v21 offset:9216
  ds_read_b128 v[60:63], v21 offset:10240
  v_mfma_f32_16x16x32_bf16 v[76:79], a[132:135], v[164:167], v[76:79]
  ds_read_b128 v[180:183], v15 offset:10240
  v_mfma_f32_16x16x32_bf16 v[80:83], a[136:139], v[164:167], v[80:83]
  s_add_u32 m0, s31, 52224
  v_mfma_f32_16x16x32_bf16 v[84:87], a[140:143], v[164:167], v[84:87]
  s_waitcnt lgkmcnt(7)
  buffer_load_dwordx4 v13, s[8:11], s30 offen lds
  v_mfma_f32_16x16x32_bf16 v[88:91], a[132:135], v[168:171], v[88:91]
  s_add_u32 s30, s30, 128
  ds_read_b128 v[184:187], v15 offset:12288
  v_mfma_f32_16x16x32_bf16 v[92:95], a[136:139], v[168:171], v[92:95]
  v_mfma_f32_16x16x32_bf16 v[96:99], a[140:143], v[168:171], v[96:99]
  s_waitcnt lgkmcnt(6)
  v_mfma_f32_16x16x32_bf16 v[36:39], v[208:211], v[248:251], v[36:39]
  v_mfma_f32_16x16x32_bf16 v[44:47], v[208:211], v[252:255], v[44:47]
  v_mfma_f32_16x16x32_bf16 v[48:51], v[212:215], v[252:255], v[48:51]
  v_mfma_f32_16x16x32_bf16 v[40:43], a[248:251], v[248:251], v[40:43]
  v_mfma_f32_16x16x32_bf16 v[52:55], a[248:251], v[252:255], v[52:55]
  s_waitcnt lgkmcnt(5)
  ds_read2st64_b64 v[248:251], v22 offset0:12 offset1:18
  ds_read2st64_b64 v[252:255], v23 offset0:12 offset1:18
  v_mfma_f32_16x16x32_bf16 v[100:103], a[132:135], v[172:175], v[100:103]
  ds_read_b128 v[188:191], v15 offset:14336
  v_mfma_f32_16x16x32_bf16 v[104:107], a[136:139], v[172:175], v[104:107]
  v_mfma_f32_16x16x32_bf16 v[108:111], a[140:143], v[172:175], v[108:111]
  s_waitcnt lgkmcnt(7)
  v_mfma_f32_16x16x32_bf16 v[112:115], a[132:135], v[176:179], v[112:115]
  s_waitcnt vmcnt(8)
  s_barrier
  ds_read_b128 v[160:163], v14 offset:16384
  v_mfma_f32_16x16x32_bf16 v[116:119], a[136:139], v[176:179], v[116:119]
  v_mfma_f32_16x16x32_bf16 v[120:123], a[140:143], v[176:179], v[120:123]
  s_waitcnt lgkmcnt(6)
  v_mfma_f32_16x16x32_bf16 v[36:39], v[216:219], v[56:59], v[36:39]
  v_mfma_f32_16x16x32_bf16 v[44:47], v[216:219], v[60:63], v[44:47]
  v_mfma_f32_16x16x32_bf16 v[48:51], v[220:223], v[60:63], v[48:51]
  v_mfma_f32_16x16x32_bf16 v[40:43], a[252:255], v[56:59], v[40:43]
  v_mfma_f32_16x16x32_bf16 v[52:55], a[252:255], v[60:63], v[52:55]
  s_waitcnt lgkmcnt(5)
  v_mfma_f32_16x16x32_bf16 v[124:127], a[132:135], v[180:183], v[124:127]
  ds_read_b128 v[164:167], v14 offset:18432
  v_mfma_f32_16x16x32_bf16 v[128:131], a[136:139], v[180:183], v[128:131]
  v_mfma_f32_16x16x32_bf16 v[132:135], a[140:143], v[180:183], v[132:135]
  s_waitcnt lgkmcnt(5)
  v_mfma_f32_16x16x32_bf16 v[136:139], a[132:135], v[184:187], v[136:139]
  ds_read_b128 v[168:171], v14 offset:20480
  v_mfma_f32_16x16x32_bf16 v[140:143], a[136:139], v[184:187], v[140:143]
  v_mfma_f32_16x16x32_bf16 v[144:147], a[140:143], v[184:187], v[144:147]
  s_waitcnt lgkmcnt(4)
  v_mfma_f32_16x16x32_bf16 v[36:39], v[232:235], v[248:251], v[36:39]
  v_mfma_f32_16x16x32_bf16 v[44:47], v[232:235], v[252:255], v[44:47]
  v_mfma_f32_16x16x32_bf16 v[48:51], v[236:239], v[252:255], v[48:51]
  v_mfma_f32_16x16x32_bf16 v[40:43], v[244:247], v[248:251], v[40:43]
  v_mfma_f32_16x16x32_bf16 v[52:55], v[244:247], v[252:255], v[52:55]
  s_waitcnt lgkmcnt(3)
  v_mfma_f32_16x16x32_bf16 v[148:151], a[132:135], v[188:191], v[148:151]
  ds_read_b128 v[172:175], v14 offset:22528
  v_mfma_f32_16x16x32_bf16 v[152:155], a[136:139], v[188:191], v[152:155]
  v_mfma_f32_16x16x32_bf16 v[156:159], a[140:143], v[188:191], v[156:159]
  s_waitcnt lgkmcnt(3)
  v_cndmask_b32 v36, v31, v36, s[64:65]
  v_cndmask_b32 v48, v31, v48, s[64:65]
  v_mfma_f32_16x16x32_bf16 v[64:67], a[144:147], v[160:163], v[64:67]
  ds_read_b128 v[176:179], v14 offset:24576
  v_cndmask_b32 v37, v31, v37, s[66:67]
  v_mfma_f32_16x16x32_bf16 v[68:71], a[148:151], v[160:163], v[68:71]
  s_add_u32 m0, s31, 65536
  v_cndmask_b32 v49, v31, v49, s[66:67]
  v_cndmask_b32 v38, v31, v38, s[68:69]
  v_mfma_f32_16x16x32_bf16 v[72:75], a[152:155], v[160:163], v[72:75]
  s_waitcnt lgkmcnt(3)
  buffer_load_dwordx4 v10, s[8:11], s30 offen lds
  v_cndmask_b32 v50, v31, v50, s[68:69]
  v_mfma_f32_16x16x32_bf16 v[76:79], a[144:147], v[164:167], v[76:79]
  ds_read_b128 v[180:183], v14 offset:26624
  v_cndmask_b32 v39, v31, v39, s[70:71]
  v_mfma_f32_16x16x32_bf16 v[80:83], a[148:151], v[164:167], v[80:83]
  v_cndmask_b32 v51, v31, v51, s[70:71]
  v_max3_f32 v34, v36, v37, v38
  v_mfma_f32_16x16x32_bf16 v[84:87], a[152:155], v[164:167], v[84:87]
  s_waitcnt lgkmcnt(3)
  v_max3_f32 v34, v34, v39, v40
  v_max3_f32 v34, v34, v41, v42
  v_mfma_f32_16x16x32_bf16 v[88:91], a[144:147], v[168:171], v[88:91]
  ds_read_b128 v[184:187], v14 offset:28672
  v_max_f32 v34, v34, v43
  v_mfma_f32_16x16x32_bf16 v[92:95], a[148:151], v[168:171], v[92:95]
  v_mov_b32 v35, v34
  v_mfma_f32_16x16x32_bf16 v[96:99], a[152:155], v[168:171], v[96:99]
  s_waitcnt lgkmcnt(3)
  v_permlane32_swap_b32 v34, v35
  v_max_f32 v34, v34, v35
  v_mfma_f32_16x16x32_bf16 v[100:103], a[144:147], v[172:175], v[100:103]
  ds_read_b128 v[188:191], v14 offset:30720
  v_mov_b32 v35, v34
  v_mfma_f32_16x16x32_bf16 v[104:107], a[148:151], v[172:175], v[104:107]
  s_add_u32 m0, s31, 66560
  v_permlane16_swap_b32 v34, v35
  v_max_f32 v34, v34, v35
  v_mfma_f32_16x16x32_bf16 v[108:111], a[152:155], v[172:175], v[108:111]
  s_waitcnt lgkmcnt(3)
  buffer_load_dwordx4 v11, s[8:11], s30 offen lds
  v_mul_f32 v34, s83, v34
  v_mfma_f32_16x16x32_bf16 v[112:115], a[144:147], v[176:179], v[112:115]
  ds_read_b128 v[160:163], v15 offset:16384
  v_fma_f32 v36, v36, s83, -v34
  v_mfma_f32_16x16x32_bf16 v[116:119], a[148:151], v[176:179], v[116:119]
  v_fma_f32 v37, v37, s83, -v34
  v_fma_f32 v38, v38, s83, -v34
  v_mfma_f32_16x16x32_bf16 v[120:123], a[152:155], v[176:179], v[120:123]
  s_waitcnt lgkmcnt(3)
  v_fma_f32 v39, v39, s83, -v34
  v_fma_f32 v40, v40, s83, -v34
  v_mfma_f32_16x16x32_bf16 v[124:127], a[144:147], v[180:183], v[124:127]
  ds_read_b128 v[164:167], v15 offset:18432
  v_fma_f32 v41, v41, s83, -v34
  v_mfma_f32_16x16x32_bf16 v[128:131], a[148:151], v[180:183], v[128:131]
  v_fma_f32 v42, v42, s83, -v34
  v_fma_f32 v43, v43, s83, -v34
  v_mfma_f32_16x16x32_bf16 v[132:135], a[152:155], v[180:183], v[132:135]
  s_waitcnt lgkmcnt(3)
  v_exp_f32 v36, v36
  v_mfma_f32_16x16x32_bf16 v[136:139], a[144:147], v[184:187], v[136:139]
  ds_read_b128 v[168:171], v15 offset:20480
  v_mfma_f32_16x16x32_bf16 v[140:143], a[148:151], v[184:187], v[140:143]
  s_add_u32 m0, s31, 67584
  v_exp_f32 v37, v37
  v_mfma_f32_16x16x32_bf16 v[144:147], a[152:155], v[184:187], v[144:147]
  s_waitcnt lgkmcnt(3)
  buffer_load_dwordx4 v12, s[8:11], s30 offen lds
  v_mfma_f32_16x16x32_bf16 v[148:151], a[144:147], v[188:191], v[148:151]
  ds_read_b128 v[172:175], v15 offset:22528
  v_mfma_f32_16x16x32_bf16 v[152:155], a[148:151], v[188:191], v[152:155]
  v_exp_f32 v38, v38
  v_mfma_f32_16x16x32_bf16 v[156:159], a[152:155], v[188:191], v[156:159]
  s_waitcnt lgkmcnt(3)
  v_exp_f32 v39, v39
  v_mfma_f32_16x16x32_bf16 v[64:67], a[156:159], v[160:163], v[64:67]
  ds_read_b128 v[176:179], v15 offset:24576
  v_mfma_f32_16x16x32_bf16 v[68:71], a[160:163], v[160:163], v[68:71]
  v_exp_f32 v40, v40
  v_mfma_f32_16x16x32_bf16 v[72:75], a[164:167], v[160:163], v[72:75]
  s_waitcnt lgkmcnt(3)
  v_exp_f32 v41, v41
  v_mfma_f32_16x16x32_bf16 v[76:79], a[156:159], v[164:167], v[76:79]
  ds_read_b128 v[180:183], v15 offset:26624
  v_mfma_f32_16x16x32_bf16 v[80:83], a[160:163], v[164:167], v[80:83]
  s_add_u32 m0, s31, 68608
  v_exp_f32 v42, v42
  v_mfma_f32_16x16x32_bf16 v[84:87], a[164:167], v[164:167], v[84:87]
  s_waitcnt lgkmcnt(3)
  buffer_load_dwordx4 v13, s[8:11], s30 offen lds
  v_mfma_f32_16x16x32_bf16 v[88:91], a[156:159], v[168:171], v[88:91]
  s_add_u32 s30, s30, s25
  ds_read_b128 v[184:187], v15 offset:28672
  v_mfma_f32_16x16x32_bf16 v[92:95], a[160:163], v[168:171], v[92:95]
  v_exp_f32 v43, v43
  v_mfma_f32_16x16x32_bf16 v[96:99], a[164:167], v[168:171], v[96:99]
  s_waitcnt lgkmcnt(3)
  v_add_f32 v34, v40, v41
  v_add_f32 v34, v34, v42
  v_mfma_f32_16x16x32_bf16 v[100:103], a[156:159], v[172:175], v[100:103]
  ds_read_b128 v[188:191], v15 offset:30720
  v_add_f32 v34, v34, v43
  v_mfma_f32_16x16x32_bf16 v[104:107], a[160:163], v[172:175], v[104:107]
  v_cndmask_b32 v34, 0, v34, s[62:63]
  v_add_f32 v34, v34, v36
  v_mfma_f32_16x16x32_bf16 v[108:111], a[164:167], v[172:175], v[108:111]
  s_waitcnt lgkmcnt(3)
  v_add_f32 v34, v34, v37
  v_add_f32 v34, v34, v38
  v_mfma_f32_16x16x32_bf16 v[112:115], a[156:159], v[176:179], v[112:115]
  s_waitcnt vmcnt(8)
  s_barrier
  ds_read_b128 v[160:163], v14 offset:32768
  v_mfma_f32_16x16x32_bf16 v[116:119], a[160:163], v[176:179], v[116:119]
  v_add_f32 v34, v34, v39
  v_mov_b32 v35, v34
  v_mfma_f32_16x16x32_bf16 v[120:123], a[164:167], v[176:179], v[120:123]
  s_waitcnt lgkmcnt(3)
  v_permlane32_swap_b32 v34, v35
  v_add_f32 v34, v34, v35
  v_mfma_f32_16x16x32_bf16 v[124:127], a[156:159], v[180:183], v[124:127]
  ds_read_b128 v[164:167], v14 offset:34816
  v_mov_b32 v35, v34
  v_mfma_f32_16x16x32_bf16 v[128:131], a[160:163], v[180:183], v[128:131]
  v_permlane16_swap_b32 v34, v35
  v_add_f32 v34, v34, v35
  v_mfma_f32_16x16x32_bf16 v[132:135], a[164:167], v[180:183], v[132:135]
  s_waitcnt lgkmcnt(3)
  v_rcp_f32 v34, v34
  v_mfma_f32_16x16x32_bf16 v[136:139], a[156:159], v[184:187], v[136:139]
  ds_read_b128 v[168:171], v14 offset:36864
  v_mul_f32 v36, v36, v34
  v_mfma_f32_16x16x32_bf16 v[140:143], a[160:163], v[184:187], v[140:143]
  v_mul_f32 v37, v37, v34
  v_mul_f32 v38, v38, v34
  v_mfma_f32_16x16x32_bf16 v[144:147], a[164:167], v[184:187], v[144:147]
  s_waitcnt lgkmcnt(3)
  v_mul_f32 v39, v39, v34
  v_mul_f32 v40, v40, v34
  v_mfma_f32_16x16x32_bf16 v[148:151], a[156:159], v[188:191], v[148:151]
  ds_read_b128 v[172:175], v14 offset:38912
  v_mul_f32 v41, v41, v34
  v_mfma_f32_16x16x32_bf16 v[152:155], a[160:163], v[188:191], v[152:155]
  v_mul_f32 v42, v42, v34
  v_mul_f32 v43, v43, v34
  v_mfma_f32_16x16x32_bf16 v[156:159], a[164:167], v[188:191], v[156:159]
  s_waitcnt lgkmcnt(3)
  v_max3_f32 v34, v44, v45, v46
  v_max3_f32 v34, v34, v47, v48
  v_mfma_f32_16x16x32_bf16 v[64:67], a[168:171], v[160:163], v[64:67]
  ds_read_b128 v[176:179], v14 offset:40960
  v_max3_f32 v34, v34, v49, v50
  v_mfma_f32_16x16x32_bf16 v[68:71], a[172:175], v[160:163], v[68:71]
  s_add_u32 m0, s31, 0
  v_max3_f32 v34, v34, v51, v52
  v_max3_f32 v34, v34, v53, v54
  v_mfma_f32_16x16x32_bf16 v[72:75], a[176:179], v[160:163], v[72:75]
  s_waitcnt lgkmcnt(3)
  buffer_load_dwordx4 v10, s[8:11], s30 offen lds
  v_max_f32 v34, v34, v55
  v_mfma_f32_16x16x32_bf16 v[76:79], a[168:171], v[164:167], v[76:79]
  ds_read_b128 v[180:183], v14 offset:43008
  v_mov_b32 v35, v34
  v_mfma_f32_16x16x32_bf16 v[80:83], a[172:175], v[164:167], v[80:83]
  v_permlane32_swap_b32 v34, v35
  v_max_f32 v34, v34, v35
  v_mfma_f32_16x16x32_bf16 v[84:87], a[176:179], v[164:167], v[84:87]
  s_waitcnt lgkmcnt(3)
  v_mov_b32 v35, v34
  v_mfma_f32_16x16x32_bf16 v[88:91], a[168:171], v[168:171], v[88:91]
  ds_read_b128 v[184:187], v14 offset:45056
  v_permlane16_swap_b32 v34, v35
  v_mfma_f32_16x16x32_bf16 v[92:95], a[172:175], v[168:171], v[92:95]
  v_max_f32 v34, v34, v35
  v_mul_f32 v34, s83, v34
  v_mfma_f32_16x16x32_bf16 v[96:99], a[176:179], v[168:171], v[96:99]
  s_waitcnt lgkmcnt(3)
  v_fma_f32 v44, v44, s83, -v34
  v_fma_f32 v45, v45, s83, -v34
  v_mfma_f32_16x16x32_bf16 v[100:103], a[168:171], v[172:175], v[100:103]
  ds_read_b128 v[188:191], v14 offset:47104
  v_fma_f32 v46, v46, s83, -v34
  v_mfma_f32_16x16x32_bf16 v[104:107], a[172:175], v[172:175], v[104:107]
  s_add_u32 m0, s31, 1024
  v_fma_f32 v47, v47, s83, -v34
  v_fma_f32 v48, v48, s83, -v34
  v_mfma_f32_16x16x32_bf16 v[108:111], a[176:179], v[172:175], v[108:111]
  s_waitcnt lgkmcnt(3)
  buffer_load_dwordx4 v11, s[8:11], s30 offen lds
  v_fma_f32 v49, v49, s83, -v34
  v_mfma_f32_16x16x32_bf16 v[112:115], a[168:171], v[176:179], v[112:115]
  ds_read_b128 v[160:163], v15 offset:32768
  v_fma_f32 v50, v50, s83, -v34
  v_mfma_f32_16x16x32_bf16 v[116:119], a[172:175], v[176:179], v[116:119]
  v_fma_f32 v51, v51, s83, -v34
  v_fma_f32 v52, v52, s83, -v34
  v_mfma_f32_16x16x32_bf16 v[120:123], a[176:179], v[176:179], v[120:123]
  s_waitcnt lgkmcnt(3)
  v_fma_f32 v53, v53, s83, -v34
  v_fma_f32 v54, v54, s83, -v34
  v_mfma_f32_16x16x32_bf16 v[124:127], a[168:171], v[180:183], v[124:127]
  ds_read_b128 v[164:167], v15 offset:34816
  v_fma_f32 v55, v55, s83, -v34
  v_mfma_f32_16x16x32_bf16 v[128:131], a[172:175], v[180:183], v[128:131]
  v_exp_f32 v44, v44
  v_mfma_f32_16x16x32_bf16 v[132:135], a[176:179], v[180:183], v[132:135]
  s_waitcnt lgkmcnt(3)
  v_exp_f32 v45, v45
  v_mfma_f32_16x16x32_bf16 v[136:139], a[168:171], v[184:187], v[136:139]
  ds_read_b128 v[168:171], v15 offset:36864
  v_mfma_f32_16x16x32_bf16 v[140:143], a[172:175], v[184:187], v[140:143]
  s_add_u32 m0, s31, 2048
  v_exp_f32 v46, v46
  v_mfma_f32_16x16x32_bf16 v[144:147], a[176:179], v[184:187], v[144:147]
  s_waitcnt lgkmcnt(3)
  buffer_load_dwordx4 v12, s[8:11], s30 offen lds
  v_mfma_f32_16x16x32_bf16 v[148:151], a[168:171], v[188:191], v[148:151]
  ds_read_b128 v[172:175], v15 offset:38912
  v_mfma_f32_16x16x32_bf16 v[152:155], a[172:175], v[188:191], v[152:155]
  v_exp_f32 v47, v47
  v_mfma_f32_16x16x32_bf16 v[156:159], a[176:179], v[188:191], v[156:159]
  s_waitcnt lgkmcnt(3)
  v_exp_f32 v48, v48
  v_mfma_f32_16x16x32_bf16 v[64:67], a[180:183], v[160:163], v[64:67]
  ds_read_b128 v[176:179], v15 offset:40960
  v_mfma_f32_16x16x32_bf16 v[68:71], a[184:187], v[160:163], v[68:71]
  v_exp_f32 v49, v49
  v_mfma_f32_16x16x32_bf16 v[72:75], a[188:191], v[160:163], v[72:75]
  s_waitcnt lgkmcnt(3)
  v_exp_f32 v50, v50
  v_mfma_f32_16x16x32_bf16 v[76:79], a[180:183], v[164:167], v[76:79]
  ds_read_b128 v[180:183], v15 offset:43008
  v_mfma_f32_16x16x32_bf16 v[80:83], a[184:187], v[164:167], v[80:83]
  s_add_u32 m0, s31, 3072
  v_exp_f32 v51, v51
  v_mfma_f32_16x16x32_bf16 v[84:87], a[188:191], v[164:167], v[84:87]
  s_waitcnt lgkmcnt(3)
  buffer_load_dwordx4 v13, s[8:11], s30 offen lds
  v_mfma_f32_16x16x32_bf16 v[88:91], a[180:183], v[168:171], v[88:91]
  s_add_u32 s30, s30, 128
  ds_read_b128 v[184:187], v15 offset:45056
  v_mfma_f32_16x16x32_bf16 v[92:95], a[184:187], v[168:171], v[92:95]
  v_exp_f32 v52, v52
  v_mfma_f32_16x16x32_bf16 v[96:99], a[188:191], v[168:171], v[96:99]
  s_waitcnt lgkmcnt(3)
  v_exp_f32 v53, v53
  v_mfma_f32_16x16x32_bf16 v[100:103], a[180:183], v[172:175], v[100:103]
  ds_read_b128 v[188:191], v15 offset:47104
  v_mfma_f32_16x16x32_bf16 v[104:107], a[184:187], v[172:175], v[104:107]
  v_exp_f32 v54, v54
  v_mfma_f32_16x16x32_bf16 v[108:111], a[188:191], v[172:175], v[108:111]
  s_waitcnt lgkmcnt(3)
  v_exp_f32 v55, v55
  v_mfma_f32_16x16x32_bf16 v[112:115], a[180:183], v[176:179], v[112:115]
  s_waitcnt vmcnt(8)
  s_barrier
  ds_read_b128 v[160:163], v14 offset:49152
  v_mfma_f32_16x16x32_bf16 v[116:119], a[184:187], v[176:179], v[116:119]
  v_add_f32 v34, v52, v53
  v_add_f32 v34, v34, v54
  v_mfma_f32_16x16x32_bf16 v[120:123], a[188:191], v[176:179], v[120:123]
  s_waitcnt lgkmcnt(3)
  v_add_f32 v34, v34, v55
  v_cndmask_b32 v34, 0, v34, s[62:63]
  v_mfma_f32_16x16x32_bf16 v[124:127], a[180:183], v[180:183], v[124:127]
  ds_read_b128 v[164:167], v14 offset:51200
  v_add_f32 v34, v34, v44
  v_mfma_f32_16x16x32_bf16 v[128:131], a[184:187], v[180:183], v[128:131]
  v_add_f32 v34, v34, v45
  v_add_f32 v34, v34, v46
  v_mfma_f32_16x16x32_bf16 v[132:135], a[188:191], v[180:183], v[132:135]
  s_waitcnt lgkmcnt(3)
  v_add_f32 v34, v34, v47
  v_add_f32 v34, v34, v48
  v_mfma_f32_16x16x32_bf16 v[136:139], a[180:183], v[184:187], v[136:139]
  ds_read_b128 v[168:171], v14 offset:53248
  v_add_f32 v34, v34, v49
  v_mfma_f32_16x16x32_bf16 v[140:143], a[184:187], v[184:187], v[140:143]
  v_add_f32 v34, v34, v50
  v_add_f32 v34, v34, v51
  v_mfma_f32_16x16x32_bf16 v[144:147], a[188:191], v[184:187], v[144:147]
  s_waitcnt lgkmcnt(3)
  v_mov_b32 v35, v34
  v_mfma_f32_16x16x32_bf16 v[148:151], a[180:183], v[188:191], v[148:151]
  ds_read_b128 v[172:175], v14 offset:55296
  v_permlane32_swap_b32 v34, v35
  v_mfma_f32_16x16x32_bf16 v[152:155], a[184:187], v[188:191], v[152:155]
  v_add_f32 v34, v34, v35
  v_mov_b32 v35, v34
  v_mfma_f32_16x16x32_bf16 v[156:159], a[188:191], v[188:191], v[156:159]
  s_waitcnt lgkmcnt(3)
  v_permlane16_swap_b32 v34, v35
  v_add_f32 v34, v34, v35
  v_mfma_f32_16x16x32_bf16 v[64:67], a[192:195], v[160:163], v[64:67]
  ds_read_b128 v[176:179], v14 offset:57344
  v_mfma_f32_16x16x32_bf16 v[68:71], a[196:199], v[160:163], v[68:71]
  s_add_u32 m0, s31, 16384
  v_rcp_f32 v34, v34
  v_mfma_f32_16x16x32_bf16 v[72:75], a[200:203], v[160:163], v[72:75]
  s_waitcnt lgkmcnt(3)
  buffer_load_dwordx4 v10, s[8:11], s30 offen lds
  v_mul_f32 v44, v44, v34
  v_mfma_f32_16x16x32_bf16 v[76:79], a[192:195], v[164:167], v[76:79]
  ds_read_b128 v[180:183], v14 offset:59392
  v_mul_f32 v45, v45, v34
  v_mfma_f32_16x16x32_bf16 v[80:83], a[196:199], v[164:167], v[80:83]
  v_mul_f32 v46, v46, v34
  v_mul_f32 v47, v47, v34
  v_mfma_f32_16x16x32_bf16 v[84:87], a[200:203], v[164:167], v[84:87]
  s_waitcnt lgkmcnt(3)
  v_mul_f32 v48, v48, v34
  v_mul_f32 v49, v49, v34
  v_mfma_f32_16x16x32_bf16 v[88:91], a[192:195], v[168:171], v[88:91]
  ds_read_b128 v[184:187], v14 offset:61440
  v_mul_f32 v50, v50, v34
  v_mfma_f32_16x16x32_bf16 v[92:95], a[196:199], v[168:171], v[92:95]
  v_mul_f32 v51, v51, v34
  v_mul_f32 v52, v52, v34
  v_mfma_f32_16x16x32_bf16 v[96:99], a[200:203], v[168:171], v[96:99]
  s_waitcnt lgkmcnt(3)
  v_mul_f32 v53, v53, v34
  v_mul_f32 v54, v54, v34
  v_mfma_f32_16x16x32_bf16 v[100:103], a[192:195], v[172:175], v[100:103]
  ds_read_b128 v[188:191], v14 offset:63488
  v_mul_f32 v55, v55, v34
  v_mfma_f32_16x16x32_bf16 v[104:107], a[196:199], v[172:175], v[104:107]
  s_add_u32 m0, s31, 17408
  v_cvt_pk_bf16_f32 v56, v44, v45
  v_cvt_pk_bf16_f32 v57, v46, v47
  v_mfma_f32_16x16x32_bf16 v[108:111], a[200:203], v[172:175], v[108:111]
  s_waitcnt lgkmcnt(3)
  buffer_load_dwordx4 v11, s[8:11], s30 offen lds
  v_cvt_pk_bf16_f32 v58, v48, v49
  v_mfma_f32_16x16x32_bf16 v[112:115], a[192:195], v[176:179], v[112:115]
  ds_read_b128 v[160:163], v15 offset:49152
  v_cvt_pk_bf16_f32 v59, v50, v51
  v_mfma_f32_16x16x32_bf16 v[116:119], a[196:199], v[176:179], v[116:119]
  v_cvt_pk_bf16_f32 v60, v40, v41
  v_cvt_pk_bf16_f32 v61, v42, v43
  v_mfma_f32_16x16x32_bf16 v[120:123], a[200:203], v[176:179], v[120:123]
  s_waitcnt lgkmcnt(3)
  v_cvt_pk_bf16_f32 v62, v52, v53
  v_cvt_pk_bf16_f32 v63, v54, v55
  v_mfma_f32_16x16x32_bf16 v[124:127], a[192:195], v[180:183], v[124:127]
  ds_read_b128 v[164:167], v15 offset:51200
  v_cvt_pk_bf16_f32 v248, v36, v37
  v_mfma_f32_16x16x32_bf16 v[128:131], a[196:199], v[180:183], v[128:131]
  v_cvt_pk_bf16_f32 v249, v38, v39
  buffer_store_dwordx4 v[56:59], v26, s[16:19], s81 offen sc1
  v_mfma_f32_16x16x32_bf16 v[132:135], a[200:203], v[180:183], v[132:135]
  s_waitcnt lgkmcnt(3)
  v_mfma_f32_16x16x32_bf16 v[136:139], a[192:195], v[184:187], v[136:139]
  ds_read_b128 v[168:171], v15 offset:53248
  v_mfma_f32_16x16x32_bf16 v[140:143], a[196:199], v[184:187], v[140:143]
  s_add_u32 m0, s31, 18432
  v_mfma_f32_16x16x32_bf16 v[144:147], a[200:203], v[184:187], v[144:147]
  s_waitcnt lgkmcnt(3)
  buffer_load_dwordx4 v12, s[8:11], s30 offen lds
  v_mfma_f32_16x16x32_bf16 v[148:151], a[192:195], v[188:191], v[148:151]
  ds_read_b128 v[172:175], v15 offset:55296
  v_mfma_f32_16x16x32_bf16 v[152:155], a[196:199], v[188:191], v[152:155]
  v_mfma_f32_16x16x32_bf16 v[156:159], a[200:203], v[188:191], v[156:159]
  s_waitcnt lgkmcnt(3)
  buffer_store_dwordx4 v[60:63], v26, s[16:19], s81 offen offset:1024 sc1
  v_mfma_f32_16x16x32_bf16 v[64:67], a[204:207], v[160:163], v[64:67]
  ds_read_b128 v[176:179], v15 offset:57344
  v_mfma_f32_16x16x32_bf16 v[68:71], a[208:211], v[160:163], v[68:71]
  v_mfma_f32_16x16x32_bf16 v[72:75], a[212:215], v[160:163], v[72:75]
  s_waitcnt lgkmcnt(3)
  buffer_store_dwordx2 v[248:249], v29, s[16:19], s81 offen offset:2048 sc1
  v_mfma_f32_16x16x32_bf16 v[76:79], a[204:207], v[164:167], v[76:79]
  ds_read_b128 v[180:183], v15 offset:59392
  s_mov_b32 s84, s82
  v_mfma_f32_16x16x32_bf16 v[80:83], a[208:211], v[164:167], v[80:83]
  s_add_u32 m0, s31, 19456
  s_cmp_gt_u32 s26, s87
  s_cselect_b32 s21, 0, s26
  v_mfma_f32_16x16x32_bf16 v[84:87], a[212:215], v[164:167], v[84:87]
  s_waitcnt lgkmcnt(3)
  buffer_load_dwordx4 v13, s[8:11], s30 offen lds
  v_mfma_f32_16x16x32_bf16 v[88:91], a[204:207], v[168:171], v[88:91]
  s_add_u32 s30, s30, 128
  ds_read_b128 v[184:187], v15 offset:61440
  v_mfma_f32_16x16x32_bf16 v[92:95], a[208:211], v[168:171], v[92:95]
  s_cmp_le_u32 s21, s85
  s_cbranch_scc1 qa2_272
  s_mov_b32 s49, s43
  s_mov_b32 s50, s45
  s_mov_b32 s81, s47
  s_mov_b32 s82, s48
  s_add_u32 s43, s43, 4
  s_add_u32 s45, s45, 8388608
  s_add_u32 s47, s47, 2097152
  s_xor_b32 s47, s47, 8192
  s_add_u32 s48, s48, 512
qa3_273:
  v_mfma_f32_16x16x32_bf16 v[96:99], a[212:215], v[168:171], v[96:99]
  s_waitcnt lgkmcnt(3)
  v_mfma_f32_16x16x32_bf16 v[100:103], a[204:207], v[172:175], v[100:103]
  ds_read_b128 v[188:191], v15 offset:63488
  v_mfma_f32_16x16x32_bf16 v[104:107], a[208:211], v[172:175], v[104:107]
  v_mfma_f32_16x16x32_bf16 v[108:111], a[212:215], v[172:175], v[108:111]
  s_waitcnt lgkmcnt(3)
  v_mfma_f32_16x16x32_bf16 v[112:115], a[204:207], v[176:179], v[112:115]
  s_waitcnt vmcnt(11)
  s_barrier
  ds_read_b128 v[160:163], v16 offset:0
  v_mfma_f32_16x16x32_bf16 v[116:119], a[208:211], v[176:179], v[116:119]
  buffer_load_dword v32, v30, s[72:75], s77 offen sc1
  v_mfma_f32_16x16x32_bf16 v[120:123], a[212:215], v[176:179], v[120:123]
  s_waitcnt lgkmcnt(3)
  v_mfma_f32_16x16x32_bf16 v[124:127], a[204:207], v[180:183], v[124:127]
  ds_read_b128 v[164:167], v16 offset:2048
  v_mfma_f32_16x16x32_bf16 v[128:131], a[208:211], v[180:183], v[128:131]
  v_mfma_f32_16x16x32_bf16 v[132:135], a[212:215], v[180:183], v[132:135]
  s_waitcnt lgkmcnt(3)
  v_mfma_f32_16x16x32_bf16 v[136:139], a[204:207], v[184:187], v[136:139]
  ds_read_b128 v[168:171], v16 offset:4096
  v_mfma_f32_16x16x32_bf16 v[140:143], a[208:211], v[184:187], v[140:143]
  v_mfma_f32_16x16x32_bf16 v[144:147], a[212:215], v[184:187], v[144:147]
  s_waitcnt lgkmcnt(3)
  v_mfma_f32_16x16x32_bf16 v[148:151], a[204:207], v[188:191], v[148:151]
  ds_read_b128 v[172:175], v16 offset:6144
  v_mfma_f32_16x16x32_bf16 v[152:155], a[208:211], v[188:191], v[152:155]
  v_mfma_f32_16x16x32_bf16 v[156:159], a[212:215], v[188:191], v[156:159]
  s_waitcnt lgkmcnt(3)
  v_mfma_f32_16x16x32_bf16 v[64:67], a[216:219], v[160:163], v[64:67]
  ds_read_b128 v[176:179], v16 offset:8192
  v_mfma_f32_16x16x32_bf16 v[68:71], a[220:223], v[160:163], v[68:71]
  s_add_u32 m0, s31, 32768
  v_mfma_f32_16x16x32_bf16 v[72:75], a[224:227], v[160:163], v[72:75]
  s_waitcnt lgkmcnt(3)
  buffer_load_dwordx4 v10, s[8:11], s30 offen lds
  v_mfma_f32_16x16x32_bf16 v[76:79], a[216:219], v[164:167], v[76:79]
  ds_read_b128 v[180:183], v16 offset:10240
  v_mfma_f32_16x16x32_bf16 v[80:83], a[220:223], v[164:167], v[80:83]
  v_mfma_f32_16x16x32_bf16 v[84:87], a[224:227], v[164:167], v[84:87]
  s_waitcnt lgkmcnt(3)
  v_mfma_f32_16x16x32_bf16 v[88:91], a[216:219], v[168:171], v[88:91]
  ds_read_b128 v[184:187], v16 offset:12288
  v_mfma_f32_16x16x32_bf16 v[92:95], a[220:223], v[168:171], v[92:95]
  s_add_u32 m0, s31, 33792
  v_mfma_f32_16x16x32_bf16 v[96:99], a[224:227], v[168:171], v[96:99]
  s_waitcnt lgkmcnt(3)
  buffer_load_dwordx4 v11, s[8:11], s30 offen lds
  v_mfma_f32_16x16x32_bf16 v[100:103], a[216:219], v[172:175], v[100:103]
  ds_read_b128 v[188:191], v16 offset:14336
  v_mfma_f32_16x16x32_bf16 v[104:107], a[220:223], v[172:175], v[104:107]
  v_mfma_f32_16x16x32_bf16 v[108:111], a[224:227], v[172:175], v[108:111]
  s_waitcnt lgkmcnt(3)
  v_mfma_f32_16x16x32_bf16 v[112:115], a[216:219], v[176:179], v[112:115]
  ds_read_b128 v[160:163], v17 offset:0
  v_mfma_f32_16x16x32_bf16 v[116:119], a[220:223], v[176:179], v[116:119]
  s_add_u32 m0, s31, 34816
  v_mfma_f32_16x16x32_bf16 v[120:123], a[224:227], v[176:179], v[120:123]
  s_waitcnt lgkmcnt(3)
  buffer_load_dwordx4 v12, s[8:11], s30 offen lds
  v_mfma_f32_16x16x32_bf16 v[124:127], a[216:219], v[180:183], v[124:127]
  ds_read_b128 v[164:167], v17 offset:2048
  v_mfma_f32_16x16x32_bf16 v[128:131], a[220:223], v[180:183], v[128:131]
  v_mfma_f32_16x16x32_bf16 v[132:135], a[224:227], v[180:183], v[132:135]
  s_waitcnt lgkmcnt(3)
  v_mfma_f32_16x16x32_bf16 v[136:139], a[216:219], v[184:187], v[136:139]
  ds_read_b128 v[168:171], v17 offset:4096
  v_mfma_f32_16x16x32_bf16 v[140:143], a[220:223], v[184:187], v[140:143]
  s_add_u32 m0, s31, 35840
  v_mfma_f32_16x16x32_bf16 v[144:147], a[224:227], v[184:187], v[144:147]
  s_waitcnt lgkmcnt(3)
  buffer_load_dwordx4 v13, s[8:11], s30 offen lds
  v_mfma_f32_16x16x32_bf16 v[148:151], a[216:219], v[188:191], v[148:151]
  s_add_u32 s30, s30, 128
  ds_read_b128 v[172:175], v17 offset:6144
  v_mfma_f32_16x16x32_bf16 v[152:155], a[220:223], v[188:191], v[152:155]
  v_mfma_f32_16x16x32_bf16 v[156:159], a[224:227], v[188:191], v[156:159]
  s_waitcnt lgkmcnt(3)
  v_mfma_f32_16x16x32_bf16 v[64:67], a[228:231], v[160:163], v[64:67]
  ds_read_b128 v[176:179], v17 offset:8192
  v_mfma_f32_16x16x32_bf16 v[68:71], a[232:235], v[160:163], v[68:71]
  v_mfma_f32_16x16x32_bf16 v[72:75], a[236:239], v[160:163], v[72:75]
  s_waitcnt lgkmcnt(3)
  v_mfma_f32_16x16x32_bf16 v[76:79], a[228:231], v[164:167], v[76:79]
  ds_read_b128 v[180:183], v17 offset:10240
  v_cvt_pk_bf16_f32 v192, v64, v65
  v_mfma_f32_16x16x32_bf16 v[80:83], a[232:235], v[164:167], v[80:83]
  v_cvt_pk_bf16_f32 v193, v66, v67
  v_cvt_pk_bf16_f32 v194, v68, v69
  v_mfma_f32_16x16x32_bf16 v[84:87], a[236:239], v[164:167], v[84:87]
  s_waitcnt lgkmcnt(3)
  v_cvt_pk_bf16_f32 v195, v70, v71
  v_cvt_pk_bf16_f32 v200, v72, v73
  v_mfma_f32_16x16x32_bf16 v[88:91], a[228:231], v[168:171], v[88:91]
  ds_read_b128 v[184:187], v17 offset:12288
  v_cvt_pk_bf16_f32 v201, v74, v75
  v_mfma_f32_16x16x32_bf16 v[92:95], a[232:235], v[168:171], v[92:95]
  v_cvt_pk_bf16_f32 v196, v76, v77
  v_cvt_pk_bf16_f32 v197, v78, v79
  v_mfma_f32_16x16x32_bf16 v[96:99], a[236:239], v[168:171], v[96:99]
  s_waitcnt lgkmcnt(3)
  v_cvt_pk_bf16_f32 v198, v80, v81
  v_cvt_pk_bf16_f32 v199, v82, v83
  v_mfma_f32_16x16x32_bf16 v[100:103], a[228:231], v[172:175], v[100:103]
  ds_read_b128 v[188:191], v17 offset:14336
  v_cvt_pk_bf16_f32 v202, v84, v85
  v_mfma_f32_16x16x32_bf16 v[104:107], a[232:235], v[172:175], v[104:107]
  v_cvt_pk_bf16_f32 v203, v86, v87
  v_cvt_pk_bf16_f32 v204, v88, v89
  v_mfma_f32_16x16x32_bf16 v[108:111], a[236:239], v[172:175], v[108:111]
  s_waitcnt lgkmcnt(3)
  v_cvt_pk_bf16_f32 v205, v90, v91
  v_cvt_pk_bf16_f32 v206, v92, v93
  v_mfma_f32_16x16x32_bf16 v[112:115], a[228:231], v[176:179], v[112:115]
  s_waitcnt vmcnt(12)
  s_barrier
  ds_read_b128 v[160:163], v14 offset:0
  v_mfma_f32_16x16x32_bf16 v[116:119], a[232:235], v[176:179], v[116:119]
  v_cvt_pk_bf16_f32 v207, v94, v95
  v_cvt_pk_bf16_f32 v212, v96, v97
  v_mfma_f32_16x16x32_bf16 v[120:123], a[236:239], v[176:179], v[120:123]
  s_waitcnt lgkmcnt(3)
  v_cvt_pk_bf16_f32 v213, v98, v99
  v_cvt_pk_bf16_f32 v208, v100, v101
  v_mfma_f32_16x16x32_bf16 v[124:127], a[228:231], v[180:183], v[124:127]
  ds_read_b128 v[164:167], v14 offset:2048
  v_cvt_pk_bf16_f32 v209, v102, v103
  v_mfma_f32_16x16x32_bf16 v[128:131], a[232:235], v[180:183], v[128:131]
  v_cvt_pk_bf16_f32 v210, v104, v105
  v_cvt_pk_bf16_f32 v211, v106, v107
  v_mfma_f32_16x16x32_bf16 v[132:135], a[236:239], v[180:183], v[132:135]
  s_waitcnt lgkmcnt(3)
  v_cvt_pk_bf16_f32 v214, v108, v109
  v_cvt_pk_bf16_f32 v215, v110, v111
  v_mfma_f32_16x16x32_bf16 v[136:139], a[228:231], v[184:187], v[136:139]
  ds_read_b128 v[168:171], v14 offset:4096
  v_cvt_pk_bf16_f32 v216, v112, v113
  v_mfma_f32_16x16x32_bf16 v[140:143], a[232:235], v[184:187], v[140:143]
  v_cvt_pk_bf16_f32 v217, v114, v115
  v_cvt_pk_bf16_f32 v218, v116, v117
  v_mfma_f32_16x16x32_bf16 v[144:147], a[236:239], v[184:187], v[144:147]
  s_waitcnt lgkmcnt(3)
  v_cvt_pk_bf16_f32 v219, v118, v119
  v_cvt_pk_bf16_f32 v224, v120, v121
  v_mfma_f32_16x16x32_bf16 v[148:151], a[228:231], v[188:191], v[148:151]
  ds_read_b128 v[172:175], v14 offset:6144
  v_cvt_pk_bf16_f32 v225, v122, v123
  v_mfma_f32_16x16x32_bf16 v[152:155], a[232:235], v[188:191], v[152:155]
  s_sub_u32 s26, s26, 1
  s_cmp_gt_u32 s26, 0
  v_cvt_pk_bf16_f32 v220, v124, v125
  v_mfma_f32_16x16x32_bf16 v[156:159], a[236:239], v[188:191], v[156:159]
  s_waitcnt lgkmcnt(3)
  s_cbranch_scc1 qa_276
  s_nop 7
  v_cvt_pk_bf16_f32 v221, v126, v127
  v_cvt_pk_bf16_f32 v222, v128, v129
  v_cvt_pk_bf16_f32 v223, v130, v131
  v_cvt_pk_bf16_f32 v226, v132, v133
  v_cvt_pk_bf16_f32 v227, v134, v135
  v_cvt_pk_bf16_f32 v228, v136, v137
  v_cvt_pk_bf16_f32 v229, v138, v139
  v_cvt_pk_bf16_f32 v230, v140, v141
  v_cvt_pk_bf16_f32 v231, v142, v143
  v_cvt_pk_bf16_f32 v236, v144, v145
  v_cvt_pk_bf16_f32 v237, v146, v147
  v_cvt_pk_bf16_f32 v232, v148, v149
  v_cvt_pk_bf16_f32 v233, v150, v151
  v_cvt_pk_bf16_f32 v234, v152, v153
  v_cvt_pk_bf16_f32 v235, v154, v155
  v_cvt_pk_bf16_f32 v238, v156, v157
  v_cvt_pk_bf16_f32 v239, v158, v159
  s_waitcnt lgkmcnt(0)
  s_mul_i32 s86, s42, 393216
  ds_read_b128 v[64:67], v21 offset:0
  ds_read_b128 v[68:71], v21 offset:1024
  ds_read_b128 v[72:75], v21 offset:3072
  ds_read_b128 v[76:79], v21 offset:4096
  ds_read2st64_b64 v[80:83], v22 offset0:0 offset1:6
  ds_read2st64_b64 v[84:87], v23 offset0:0 offset1:6
  ds_read_b128 v[88:91], v21 offset:6144
  ds_read_b128 v[92:95], v21 offset:7168
  ds_read_b128 v[96:99], v21 offset:9216
  ds_read_b128 v[100:103], v21 offset:10240
  ds_read2st64_b64 v[104:107], v22 offset0:12 offset1:18
  ds_read2st64_b64 v[108:111], v23 offset0:12 offset1:18
  s_waitcnt lgkmcnt(0)
  s_barrier
  ds_write_b128 v20, v[192:195] offset:0
  ds_write_b128 v20, v[196:199] offset:1024
  ds_write_b128 v20, v[200:203] offset:2048
  ds_write_b128 v20, v[204:207] offset:12288
  ds_write_b128 v20, v[208:211] offset:13312
  ds_write_b128 v20, v[212:215] offset:14336
  ds_write_b128 v20, v[216:219] offset:24576
  ds_write_b128 v20, v[220:223] offset:25600
  ds_write_b128 v20, v[224:227] offset:26624
  ds_write_b128 v20, v[228:231] offset:36864
  ds_write_b128 v20, v[232:235] offset:37888
  ds_write_b128 v20, v[236:239] offset:38912
  s_waitcnt lgkmcnt(0)
  s_barrier
  s_cmp_eq_u32 s40, 0
  s_cbranch_scc1 qf_279
  s_mov_b32 s49, s43
  s_mov_b32 s50, s45
  s_mov_b32 s81, s47
  s_mov_b32 s82, s48
  s_add_u32 s43, s43, 4
  s_add_u32 s45, s45, 8388608
  s_add_u32 s47, s47, 2097152
  s_xor_b32 s47, s47, 8192
  s_add_u32 s48, s48, 512
  s_cmp_gt_u32 s49, 60
  s_cselect_b32 s23, 58, s49
  s_mov_b32 s101, 0
wm_282:
  buffer_load_dword v34, v30, s[72:75], s77 offen sc1
  s_add_u32 s101, s101, 1
  s_cmp_gt_u32 s101, 131072
  s_cbranch_scc1 main_end
  s_waitcnt vmcnt(0)
  v_cmp_gt_u32 vcc, s23, v34
  v_readfirstlane_b32 s100, v34
  s_nop 0
  s_cbranch_vccz wm_283
  s_sleep 4
  s_add_u32 s100, s100, 2
  s_cmp_ge_u32 s100, s23
  s_cbranch_scc1 wm_282
  s_sleep 40
  s_branch wm_282
wm_283:
  s_add_u32 s29, s50, 0
  buffer_load_dwordx4 v[112:115], v26, s[16:19], s29 offen offset:0 sc1
  buffer_load_dwordx4 v[116:119], v26, s[16:19], s29 offen offset:1024 sc1
  buffer_load_dwordx4 v[144:147], v26, s[16:19], s29 offen offset:2048 sc1
  s_add_u32 s29, s50, 16384
  buffer_load_dwordx4 v[120:123], v26, s[16:19], s29 offen offset:0 sc1
  buffer_load_dwordx4 v[124:127], v26, s[16:19], s29 offen offset:1024 sc1
  buffer_load_dwordx4 v[148:151], v26, s[16:19], s29 offen offset:2048 sc1
  s_add_u32 s29, s50, 32768
  buffer_load_dwordx4 v[128:131], v26, s[16:19], s29 offen offset:0 sc1
  buffer_load_dwordx4 v[132:135], v26, s[16:19], s29 offen offset:1024 sc1
  buffer_load_dwordx4 v[152:155], v26, s[16:19], s29 offen offset:2048 sc1
  s_add_u32 s29, s50, 49152
  buffer_load_dwordx4 v[136:139], v26, s[16:19], s29 offen offset:0 sc1
  buffer_load_dwordx4 v[140:143], v26, s[16:19], s29 offen offset:1024 sc1
  buffer_load_dwordx4 v[156:159], v26, s[16:19], s29 offen offset:2048 sc1
  s_waitcnt vmcnt(0) lgkmcnt(0)
  v_swap_b32 v146, v148
  v_swap_b32 v147, v149
  v_swap_b32 v154, v156
  v_swap_b32 v155, v157
  s_nop 1
  v_mfma_f32_16x16x32_bf16 v[36:39], v[112:115], v[64:67], 0
  v_mfma_f32_16x16x32_bf16 v[44:47], v[112:115], v[68:71], 0
  v_mfma_f32_16x16x32_bf16 v[48:51], v[116:119], v[68:71], 0
  v_mfma_f32_16x16x32_bf16 v[36:39], v[120:123], v[72:75], v[36:39]
  v_mfma_f32_16x16x32_bf16 v[44:47], v[120:123], v[76:79], v[44:47]
  v_mfma_f32_16x16x32_bf16 v[48:51], v[124:127], v[76:79], v[48:51]
  v_mfma_f32_16x16x32_bf16 v[36:39], v[144:147], v[80:83], v[36:39]
  v_mfma_f32_16x16x32_bf16 v[44:47], v[144:147], v[84:87], v[44:47]
  v_mfma_f32_16x16x32_bf16 v[48:51], v[148:151], v[84:87], v[48:51]
  v_mfma_f32_16x16x32_bf16 v[36:39], v[128:131], v[88:91], v[36:39]
  v_mfma_f32_16x16x32_bf16 v[44:47], v[128:131], v[92:95], v[44:47]
  v_mfma_f32_16x16x32_bf16 v[48:51], v[132:135], v[92:95], v[48:51]
  v_mfma_f32_16x16x32_bf16 v[36:39], v[136:139], v[96:99], v[36:39]
  v_mfma_f32_16x16x32_bf16 v[44:47], v[136:139], v[100:103], v[44:47]
  v_mfma_f32_16x16x32_bf16 v[48:51], v[140:143], v[100:103], v[48:51]
  v_mfma_f32_16x16x32_bf16 v[36:39], v[152:155], v[104:107], v[36:39]
  v_mfma_f32_16x16x32_bf16 v[44:47], v[152:155], v[108:111], v[44:47]
  v_mfma_f32_16x16x32_bf16 v[48:51], v[156:159], v[108:111], v[48:51]
  s_cmp_le_u32 s49, 60
  s_cbranch_scc1 qtp_286
  s_sub_u32 s23, s49, 1
  s_min_u32 s23, s23, 62
  s_mov_b32 s101, 0
wm_287:
  buffer_load_dword v34, v30, s[72:75], s77 offen sc1
  s_add_u32 s101, s101, 1
  s_cmp_gt_u32 s101, 131072
  s_cbranch_scc1 main_end
  s_waitcnt vmcnt(0)
  v_cmp_gt_u32 vcc, s23, v34
  v_readfirstlane_b32 s100, v34
  s_nop 0
  s_cbranch_vccz wm_288
  s_sleep 4
  s_add_u32 s100, s100, 2
  s_cmp_ge_u32 s100, s23
  s_cbranch_scc1 wm_287
  s_sleep 40
  s_branch wm_287
wm_288:
qtp_286:
  s_mov_b32 s101, 0
  s_branch qtp_285
qtp_284:
  s_sleep 2
qtp_285:
  s_add_u32 s29, s50, 4096
  buffer_load_dwordx4 v[160:163], v24, s[16:19], s29 offen offset:2560 sc1
  buffer_load_dwordx2 v[240:241], v25, s[16:19], s29 offen offset:3072 sc1
  s_add_u32 s29, s50, 20480
  buffer_load_dwordx4 v[164:167], v24, s[16:19], s29 offen offset:2560 sc1
  buffer_load_dwordx2 v[242:243], v25, s[16:19], s29 offen offset:3072 sc1
  s_add_u32 s29, s50, 36864
  buffer_load_dwordx4 v[168:171], v24, s[16:19], s29 offen offset:2560 sc1
  buffer_load_dwordx2 v[244:245], v25, s[16:19], s29 offen offset:3072 sc1
  s_add_u32 s29, s50, 53248
  buffer_load_dwordx4 v[172:175], v24, s[16:19], s29 offen offset:2560 sc1
  buffer_load_dwordx2 v[246:247], v25, s[16:19], s29 offen offset:3072 sc1
  s_add_u32 s101, s101, 1
  s_cmp_gt_u32 s101, 131072
  s_cbranch_scc1 main_end
  s_waitcnt vmcnt(0)
  v_max3_u32 v34, v160, v164, v168
  v_max3_u32 v34, v34, v172, v240
  v_max3_u32 v34, v34, v242, v244
  v_max_u32 v34, v34, v246
  v_cmp_eq_u32 vcc, -1, v34
  s_nop 1
  s_cbranch_vccnz qtp_284
  v_mfma_f32_16x16x32_bf16 v[40:43], v[160:163], v[64:67], 0
  v_mfma_f32_16x16x32_bf16 v[52:55], v[160:163], v[68:71], 0
  v_mfma_f32_16x16x32_bf16 v[40:43], v[164:167], v[72:75], v[40:43]
  v_mfma_f32_16x16x32_bf16 v[52:55], v[164:167], v[76:79], v[52:55]
  v_mfma_f32_16x16x32_bf16 v[40:43], v[240:243], v[80:83], v[40:43]
  v_mfma_f32_16x16x32_bf16 v[52:55], v[240:243], v[84:87], v[52:55]
  v_mfma_f32_16x16x32_bf16 v[40:43], v[168:171], v[88:91], v[40:43]
  v_mfma_f32_16x16x32_bf16 v[52:55], v[168:171], v[92:95], v[52:55]
  v_mfma_f32_16x16x32_bf16 v[40:43], v[172:175], v[96:99], v[40:43]
  v_mfma_f32_16x16x32_bf16 v[52:55], v[172:175], v[100:103], v[52:55]
  v_mfma_f32_16x16x32_bf16 v[40:43], v[244:247], v[104:107], v[40:43]
  v_mfma_f32_16x16x32_bf16 v[52:55], v[244:247], v[108:111], v[52:55]
  s_nop 4
  v_cndmask_b32 v36, v31, v36, s[64:65]
  v_cndmask_b32 v48, v31, v48, s[64:65]
  v_cndmask_b32 v37, v31, v37, s[66:67]
  v_cndmask_b32 v49, v31, v49, s[66:67]
  v_cndmask_b32 v38, v31, v38, s[68:69]
  v_cndmask_b32 v50, v31, v50, s[68:69]
  v_cndmask_b32 v39, v31, v39, s[70:71]
  v_cndmask_b32 v51, v31, v51, s[70:71]
  v_max3_f32 v34, v36, v37, v38
  v_max3_f32 v34, v34, v39, v40
  v_max3_f32 v34, v34, v41, v42
  v_max_f32 v34, v34, v43
  v_mov_b32 v35, v34
  s_nop 1
  v_permlane32_swap_b32 v34, v35
  v_max_f32 v34, v34, v35
  v_mov_b32 v35, v34
  s_nop 1
  v_permlane16_swap_b32 v34, v35
  v_max_f32 v34, v34, v35
  v_mul_f32 v34, s83, v34
  v_fma_f32 v36, v36, s83, -v34
  v_fma_f32 v37, v37, s83, -v34
  v_fma_f32 v38, v38, s83, -v34
  v_fma_f32 v39, v39, s83, -v34
  v_fma_f32 v40, v40, s83, -v34
  v_fma_f32 v41, v41, s83, -v34
  v_fma_f32 v42, v42, s83, -v34
  v_fma_f32 v43, v43, s83, -v34
  v_exp_f32 v36, v36
  v_exp_f32 v37, v37
  v_exp_f32 v38, v38
  v_exp_f32 v39, v39
  v_exp_f32 v40, v40
  v_exp_f32 v41, v41
  v_exp_f32 v42, v42
  v_exp_f32 v43, v43
  s_nop 0
  v_add_f32 v34, v40, v41
  v_add_f32 v34, v34, v42
  v_add_f32 v34, v34, v43
  v_cndmask_b32 v34, 0, v34, s[62:63]
  v_add_f32 v34, v34, v36
  v_add_f32 v34, v34, v37
  v_add_f32 v34, v34, v38
  v_add_f32 v34, v34, v39
  v_mov_b32 v35, v34
  s_nop 1
  v_permlane32_swap_b32 v34, v35
  v_add_f32 v34, v34, v35
  v_mov_b32 v35, v34
  s_nop 1
  v_permlane16_swap_b32 v34, v35
  v_add_f32 v34, v34, v35
  v_rcp_f32 v34, v34
  s_nop 0
  v_mul_f32 v36, v36, v34
  v_mul_f32 v37, v37, v34
  v_mul_f32 v38, v38, v34
  v_mul_f32 v39, v39, v34
  v_mul_f32 v40, v40, v34
  v_mul_f32 v41, v41, v34
  v_mul_f32 v42, v42, v34
  v_mul_f32 v43, v43, v34
  v_max3_f32 v34, v44, v45, v46
  v_max3_f32 v34, v34, v47, v48
  v_max3_f32 v34, v34, v49, v50
  v_max3_f32 v34, v34, v51, v52
  v_max3_f32 v34, v34, v53, v54
  v_max_f32 v34, v34, v55
  v_mov_b32 v35, v34
  s_nop 1
  v_permlane32_swap_b32 v34, v35
  v_max_f32 v34, v34, v35
  v_mov_b32 v35, v34
  s_nop 1
  v_permlane16_swap_b32 v34, v35
  v_max_f32 v34, v34, v35
  v_mul_f32 v34, s83, v34
  v_fma_f32 v44, v44, s83, -v34
  v_fma_f32 v45, v45, s83, -v34
  v_fma_f32 v46, v46, s83, -v34
  v_fma_f32 v47, v47, s83, -v34
  v_fma_f32 v48, v48, s83, -v34
  v_fma_f32 v49, v49, s83, -v34
  v_fma_f32 v50, v50, s83, -v34
  v_fma_f32 v51, v51, s83, -v34
  v_fma_f32 v52, v52, s83, -v34
  v_fma_f32 v53, v53, s83, -v34
  v_fma_f32 v54, v54, s83, -v34
  v_fma_f32 v55, v55, s83, -v34
  v_exp_f32 v44, v44
  v_exp_f32 v45, v45
  v_exp_f32 v46, v46
  v_exp_f32 v47, v47
  v_exp_f32 v48, v48
  v_exp_f32 v49, v49
  v_exp_f32 v50, v50
  v_exp_f32 v51, v51
  v_exp_f32 v52, v52
  v_exp_f32 v53, v53
  v_exp_f32 v54, v54
  v_exp_f32 v55, v55
  s_nop 0
  v_add_f32 v34, v52, v53
  v_add_f32 v34, v34, v54
  v_add_f32 v34, v34, v55
  v_cndmask_b32 v34, 0, v34, s[62:63]
  v_add_f32 v34, v34, v44
  v_add_f32 v34, v34, v45
  v_add_f32 v34, v34, v46
  v_add_f32 v34, v34, v47
  v_add_f32 v34, v34, v48
  v_add_f32 v34, v34, v49
  v_add_f32 v34, v34, v50
  v_add_f32 v34, v34, v51
  v_mov_b32 v35, v34
  s_nop 1
  v_permlane32_swap_b32 v34, v35
  v_add_f32 v34, v34, v35
  v_mov_b32 v35, v34
  s_nop 1
  v_permlane16_swap_b32 v34, v35
  v_add_f32 v34, v34, v35
  v_rcp_f32 v34, v34
  s_nop 0
  v_mul_f32 v44, v44, v34
  v_mul_f32 v45, v45, v34
  v_mul_f32 v46, v46, v34
  v_mul_f32 v47, v47, v34
  v_mul_f32 v48, v48, v34
  v_mul_f32 v49, v49, v34
  v_mul_f32 v50, v50, v34
  v_mul_f32 v51, v51, v34
  v_mul_f32 v52, v52, v34
  v_mul_f32 v53, v53, v34
  v_mul_f32 v54, v54, v34
  v_mul_f32 v55, v55, v34
  v_cvt_pk_bf16_f32 v56, v44, v45
  v_cvt_pk_bf16_f32 v57, v46, v47
  v_cvt_pk_bf16_f32 v58, v48, v49
  v_cvt_pk_bf16_f32 v59, v50, v51
  v_cvt_pk_bf16_f32 v60, v40, v41
  v_cvt_pk_bf16_f32 v61, v42, v43
  v_cvt_pk_bf16_f32 v62, v52, v53
  v_cvt_pk_bf16_f32 v63, v54, v55
  v_cvt_pk_bf16_f32 v248, v36, v37
  v_cvt_pk_bf16_f32 v249, v38, v39
  buffer_store_dwordx4 v[56:59], v26, s[16:19], s81 offen sc1
  buffer_store_dwordx4 v[60:63], v26, s[16:19], s81 offen offset:1024 sc1
  buffer_store_dwordx2 v[248:249], v29, s[16:19], s81 offen offset:2048 sc1
  s_mov_b32 s84, s82
qf_279:
  ds_read_b128 v[64:67], v21 offset:0
  ds_read_b128 v[68:71], v21 offset:1024
  ds_read_b128 v[72:75], v21 offset:3072
  ds_read_b128 v[76:79], v21 offset:4096
  ds_read2st64_b64 v[80:83], v22 offset0:0 offset1:6
  ds_read2st64_b64 v[84:87], v23 offset0:0 offset1:6
  ds_read_b128 v[88:91], v21 offset:6144
  ds_read_b128 v[92:95], v21 offset:7168
  ds_read_b128 v[96:99], v21 offset:9216
  ds_read_b128 v[100:103], v21 offset:10240
  ds_read2st64_b64 v[104:107], v22 offset0:12 offset1:18
  ds_read2st64_b64 v[108:111], v23 offset0:12 offset1:18
  s_waitcnt vmcnt(0)
  buffer_atomic_add v28, v33, s[72:75], s84 offen sc1
  s_mov_b32 s49, s43
  s_mov_b32 s50, s45
  s_mov_b32 s81, s47
  s_mov_b32 s82, s48
  s_add_u32 s43, s43, 4
  s_add_u32 s45, s45, 8388608
  s_add_u32 s47, s47, 2097152
  s_xor_b32 s47, s47, 8192
  s_add_u32 s48, s48, 512
  s_cmp_gt_u32 s49, 60
  s_cselect_b32 s23, 58, s49
  s_mov_b32 s101, 0
wm_289:
  buffer_load_dword v34, v30, s[72:75], s77 offen sc1
  s_add_u32 s101, s101, 1
  s_cmp_gt_u32 s101, 131072
  s_cbranch_scc1 main_end
  s_waitcnt vmcnt(0)
  v_cmp_gt_u32 vcc, s23, v34
  v_readfirstlane_b32 s100, v34
  s_nop 0
  s_cbranch_vccz wm_290
  s_sleep 4
  s_add_u32 s100, s100, 2
  s_cmp_ge_u32 s100, s23
  s_cbranch_scc1 wm_289
  s_sleep 40
  s_branch wm_289
wm_290:
  s_add_u32 s29, s50, 0
  buffer_load_dwordx4 v[112:115], v26, s[16:19], s29 offen offset:0 sc1
  buffer_load_dwordx4 v[116:119], v26, s[16:19], s29 offen offset:1024 sc1
  buffer_load_dwordx4 v[144:147], v26, s[16:19], s29 offen offset:2048 sc1
  s_add_u32 s29, s50, 16384
  buffer_load_dwordx4 v[120:123], v26, s[16:19], s29 offen offset:0 sc1
  buffer_load_dwordx4 v[124:127], v26, s[16:19], s29 offen offset:1024 sc1
  buffer_load_dwordx4 v[148:151], v26, s[16:19], s29 offen offset:2048 sc1
  s_add_u32 s29, s50, 32768
  buffer_load_dwordx4 v[128:131], v26, s[16:19], s29 offen offset:0 sc1
  buffer_load_dwordx4 v[132:135], v26, s[16:19], s29 offen offset:1024 sc1
  buffer_load_dwordx4 v[152:155], v26, s[16:19], s29 offen offset:2048 sc1
  s_add_u32 s29, s50, 49152
  buffer_load_dwordx4 v[136:139], v26, s[16:19], s29 offen offset:0 sc1
  buffer_load_dwordx4 v[140:143], v26, s[16:19], s29 offen offset:1024 sc1
  buffer_load_dwordx4 v[156:159], v26, s[16:19], s29 offen offset:2048 sc1
  s_waitcnt vmcnt(0) lgkmcnt(0)
  v_swap_b32 v146, v148
  v_swap_b32 v147, v149
  v_swap_b32 v154, v156
  v_swap_b32 v155, v157
  s_nop 1
  v_mfma_f32_16x16x32_bf16 v[36:39], v[112:115], v[64:67], 0
  v_mfma_f32_16x16x32_bf16 v[44:47], v[112:115], v[68:71], 0
  v_mfma_f32_16x16x32_bf16 v[48:51], v[116:119], v[68:71], 0
  v_mfma_f32_16x16x32_bf16 v[36:39], v[120:123], v[72:75], v[36:39]
  v_mfma_f32_16x16x32_bf16 v[44:47], v[120:123], v[76:79], v[44:47]
  v_mfma_f32_16x16x32_bf16 v[48:51], v[124:127], v[76:79], v[48:51]
  v_mfma_f32_16x16x32_bf16 v[36:39], v[144:147], v[80:83], v[36:39]
  v_mfma_f32_16x16x32_bf16 v[44:47], v[144:147], v[84:87], v[44:47]
  v_mfma_f32_16x16x32_bf16 v[48:51], v[148:151], v[84:87], v[48:51]
  v_mfma_f32_16x16x32_bf16 v[36:39], v[128:131], v[88:91], v[36:39]
  v_mfma_f32_16x16x32_bf16 v[44:47], v[128:131], v[92:95], v[44:47]
  v_mfma_f32_16x16x32_bf16 v[48:51], v[132:135], v[92:95], v[48:51]
  v_mfma_f32_16x16x32_bf16 v[36:39], v[136:139], v[96:99], v[36:39]
  v_mfma_f32_16x16x32_bf16 v[44:47], v[136:139], v[100:103], v[44:47]
  v_mfma_f32_16x16x32_bf16 v[48:51], v[140:143], v[100:103], v[48:51]
  v_mfma_f32_16x16x32_bf16 v[36:39], v[152:155], v[104:107], v[36:39]
  v_mfma_f32_16x16x32_bf16 v[44:47], v[152:155], v[108:111], v[44:47]
  v_mfma_f32_16x16x32_bf16 v[48:51], v[156:159], v[108:111], v[48:51]
  s_cmp_le_u32 s49, 60
  s_cbranch_scc1 qtp_293
  s_sub_u32 s23, s49, 1
  s_min_u32 s23, s23, 62
  s_mov_b32 s101, 0
wm_294:
  buffer_load_dword v34, v30, s[72:75], s77 offen sc1
  s_add_u32 s101, s101, 1
  s_cmp_gt_u32 s101, 131072
  s_cbranch_scc1 main_end
  s_waitcnt vmcnt(0)
  v_cmp_gt_u32 vcc, s23, v34
  v_readfirstlane_b32 s100, v34
  s_nop 0
  s_cbranch_vccz wm_295
  s_sleep 4
  s_add_u32 s100, s100, 2
  s_cmp_ge_u32 s100, s23
  s_cbranch_scc1 wm_294
  s_sleep 40
  s_branch wm_294
wm_295:
qtp_293:
  s_mov_b32 s101, 0
  s_branch qtp_292
qtp_291:
  s_sleep 2
qtp_292:
  s_add_u32 s29, s50, 4096
  buffer_load_dwordx4 v[160:163], v24, s[16:19], s29 offen offset:2560 sc1
  buffer_load_dwordx2 v[240:241], v25, s[16:19], s29 offen offset:3072 sc1
  s_add_u32 s29, s50, 20480
  buffer_load_dwordx4 v[164:167], v24, s[16:19], s29 offen offset:2560 sc1
  buffer_load_dwordx2 v[242:243], v25, s[16:19], s29 offen offset:3072 sc1
  s_add_u32 s29, s50, 36864
  buffer_load_dwordx4 v[168:171], v24, s[16:19], s29 offen offset:2560 sc1
  buffer_load_dwordx2 v[244:245], v25, s[16:19], s29 offen offset:3072 sc1
  s_add_u32 s29, s50, 53248
  buffer_load_dwordx4 v[172:175], v24, s[16:19], s29 offen offset:2560 sc1
  buffer_load_dwordx2 v[246:247], v25, s[16:19], s29 offen offset:3072 sc1
  s_add_u32 s101, s101, 1
  s_cmp_gt_u32 s101, 131072
  s_cbranch_scc1 main_end
  s_waitcnt vmcnt(0)
  v_max3_u32 v34, v160, v164, v168
  v_max3_u32 v34, v34, v172, v240
  v_max3_u32 v34, v34, v242, v244
  v_max_u32 v34, v34, v246
  v_cmp_eq_u32 vcc, -1, v34
  s_nop 1
  s_cbranch_vccnz qtp_291
  v_mfma_f32_16x16x32_bf16 v[40:43], v[160:163], v[64:67], 0
  v_mfma_f32_16x16x32_bf16 v[52:55], v[160:163], v[68:71], 0
  v_mfma_f32_16x16x32_bf16 v[40:43], v[164:167], v[72:75], v[40:43]
  v_mfma_f32_16x16x32_bf16 v[52:55], v[164:167], v[76:79], v[52:55]
  v_mfma_f32_16x16x32_bf16 v[40:43], v[240:243], v[80:83], v[40:43]
  v_mfma_f32_16x16x32_bf16 v[52:55], v[240:243], v[84:87], v[52:55]
  v_mfma_f32_16x16x32_bf16 v[40:43], v[168:171], v[88:91], v[40:43]
  v_mfma_f32_16x16x32_bf16 v[52:55], v[168:171], v[92:95], v[52:55]
  v_mfma_f32_16x16x32_bf16 v[40:43], v[172:175], v[96:99], v[40:43]
  v_mfma_f32_16x16x32_bf16 v[52:55], v[172:175], v[100:103], v[52:55]
  v_mfma_f32_16x16x32_bf16 v[40:43], v[244:247], v[104:107], v[40:43]
  v_mfma_f32_16x16x32_bf16 v[52:55], v[244:247], v[108:111], v[52:55]
  s_nop 4
  v_cndmask_b32 v36, v31, v36, s[64:65]
  v_cndmask_b32 v48, v31, v48, s[64:65]
  v_cndmask_b32 v37, v31, v37, s[66:67]
  v_cndmask_b32 v49, v31, v49, s[66:67]
  v_cndmask_b32 v38, v31, v38, s[68:69]
  v_cndmask_b32 v50, v31, v50, s[68:69]
  v_cndmask_b32 v39, v31, v39, s[70:71]
  v_cndmask_b32 v51, v31, v51, s[70:71]
  v_max3_f32 v34, v36, v37, v38
  v_max3_f32 v34, v34, v39, v40
  v_max3_f32 v34, v34, v41, v42
  v_max_f32 v34, v34, v43
  v_mov_b32 v35, v34
  s_nop 1
  v_permlane32_swap_b32 v34, v35
  v_max_f32 v34, v34, v35
  v_mov_b32 v35, v34
  s_nop 1
  v_permlane16_swap_b32 v34, v35
  v_max_f32 v34, v34, v35
  v_mul_f32 v34, s83, v34
  v_fma_f32 v36, v36, s83, -v34
  v_fma_f32 v37, v37, s83, -v34
  v_fma_f32 v38, v38, s83, -v34
  v_fma_f32 v39, v39, s83, -v34
  v_fma_f32 v40, v40, s83, -v34
  v_fma_f32 v41, v41, s83, -v34
  v_fma_f32 v42, v42, s83, -v34
  v_fma_f32 v43, v43, s83, -v34
  v_exp_f32 v36, v36
  v_exp_f32 v37, v37
  v_exp_f32 v38, v38
  v_exp_f32 v39, v39
  v_exp_f32 v40, v40
  v_exp_f32 v41, v41
  v_exp_f32 v42, v42
  v_exp_f32 v43, v43
  s_nop 0
  v_add_f32 v34, v40, v41
  v_add_f32 v34, v34, v42
  v_add_f32 v34, v34, v43
  v_cndmask_b32 v34, 0, v34, s[62:63]
  v_add_f32 v34, v34, v36
  v_add_f32 v34, v34, v37
  v_add_f32 v34, v34, v38
  v_add_f32 v34, v34, v39
  v_mov_b32 v35, v34
  s_nop 1
  v_permlane32_swap_b32 v34, v35
  v_add_f32 v34, v34, v35
  v_mov_b32 v35, v34
  s_nop 1
  v_permlane16_swap_b32 v34, v35
  v_add_f32 v34, v34, v35
  v_rcp_f32 v34, v34
  s_nop 0
  v_mul_f32 v36, v36, v34
  v_mul_f32 v37, v37, v34
  v_mul_f32 v38, v38, v34
  v_mul_f32 v39, v39, v34
  v_mul_f32 v40, v40, v34
  v_mul_f32 v41, v41, v34
  v_mul_f32 v42, v42, v34
  v_mul_f32 v43, v43, v34
  v_max3_f32 v34, v44, v45, v46
  v_max3_f32 v34, v34, v47, v48
  v_max3_f32 v34, v34, v49, v50
  v_max3_f32 v34, v34, v51, v52
  v_max3_f32 v34, v34, v53, v54
  v_max_f32 v34, v34, v55
  v_mov_b32 v35, v34
  s_nop 1
  v_permlane32_swap_b32 v34, v35
  v_max_f32 v34, v34, v35
  v_mov_b32 v35, v34
  s_nop 1
  v_permlane16_swap_b32 v34, v35
  v_max_f32 v34, v34, v35
  v_mul_f32 v34, s83, v34
  v_fma_f32 v44, v44, s83, -v34
  v_fma_f32 v45, v45, s83, -v34
  v_fma_f32 v46, v46, s83, -v34
  v_fma_f32 v47, v47, s83, -v34
  v_fma_f32 v48, v48, s83, -v34
  v_fma_f32 v49, v49, s83, -v34
  v_fma_f32 v50, v50, s83, -v34
  v_fma_f32 v51, v51, s83, -v34
  v_fma_f32 v52, v52, s83, -v34
  v_fma_f32 v53, v53, s83, -v34
  v_fma_f32 v54, v54, s83, -v34
  v_fma_f32 v55, v55, s83, -v34
  v_exp_f32 v44, v44
  v_exp_f32 v45, v45
  v_exp_f32 v46, v46
  v_exp_f32 v47, v47
  v_exp_f32 v48, v48
  v_exp_f32 v49, v49
  v_exp_f32 v50, v50
  v_exp_f32 v51, v51
  v_exp_f32 v52, v52
  v_exp_f32 v53, v53
  v_exp_f32 v54, v54
  v_exp_f32 v55, v55
  s_nop 0
  v_add_f32 v34, v52, v53
  v_add_f32 v34, v34, v54
  v_add_f32 v34, v34, v55
  v_cndmask_b32 v34, 0, v34, s[62:63]
  v_add_f32 v34, v34, v44
  v_add_f32 v34, v34, v45
  v_add_f32 v34, v34, v46
  v_add_f32 v34, v34, v47
  v_add_f32 v34, v34, v48
  v_add_f32 v34, v34, v49
  v_add_f32 v34, v34, v50
  v_add_f32 v34, v34, v51
  v_mov_b32 v35, v34
  s_nop 1
  v_permlane32_swap_b32 v34, v35
  v_add_f32 v34, v34, v35
  v_mov_b32 v35, v34
  s_nop 1
  v_permlane16_swap_b32 v34, v35
  v_add_f32 v34, v34, v35
  v_rcp_f32 v34, v34
  s_nop 0
  v_mul_f32 v44, v44, v34
  v_mul_f32 v45, v45, v34
  v_mul_f32 v46, v46, v34
  v_mul_f32 v47, v47, v34
  v_mul_f32 v48, v48, v34
  v_mul_f32 v49, v49, v34
  v_mul_f32 v50, v50, v34
  v_mul_f32 v51, v51, v34
  v_mul_f32 v52, v52, v34
  v_mul_f32 v53, v53, v34
  v_mul_f32 v54, v54, v34
  v_mul_f32 v55, v55, v34
  v_cvt_pk_bf16_f32 v56, v44, v45
  v_cvt_pk_bf16_f32 v57, v46, v47
  v_cvt_pk_bf16_f32 v58, v48, v49
  v_cvt_pk_bf16_f32 v59, v50, v51
  v_cvt_pk_bf16_f32 v60, v40, v41
  v_cvt_pk_bf16_f32 v61, v42, v43
  v_cvt_pk_bf16_f32 v62, v52, v53
  v_cvt_pk_bf16_f32 v63, v54, v55
  v_cvt_pk_bf16_f32 v248, v36, v37
  v_cvt_pk_bf16_f32 v249, v38, v39
  buffer_store_dwordx4 v[56:59], v26, s[16:19], s81 offen sc1
  buffer_store_dwordx4 v[60:63], v26, s[16:19], s81 offen offset:1024 sc1
  buffer_store_dwordx2 v[248:249], v29, s[16:19], s81 offen offset:2048 sc1
  s_mov_b32 s84, s82
qf_280:
  s_cmp_eq_u32 s91, 0
  s_cbranch_scc1 qf_281
  s_sub_u32 s91, s91, 1
  s_mul_i32 s21, s20, 12288
  s_add_u32 s21, s21, s86
  s_add_u32 s86, s86, 49152
  buffer_load_dwordx4 v[64:67], v26, s[56:59], s21 offen offset:0 sc1
  buffer_load_dwordx4 v[68:71], v26, s[56:59], s21 offen offset:1024 sc1
  buffer_load_dwordx4 v[96:99], v26, s[56:59], s21 offen offset:2048 sc1
  s_add_u32 s21, s21, 3072
  buffer_load_dwordx4 v[72:75], v26, s[56:59], s21 offen offset:0 sc1
  buffer_load_dwordx4 v[76:79], v26, s[56:59], s21 offen offset:1024 sc1
  buffer_load_dwordx4 v[100:103], v26, s[56:59], s21 offen offset:2048 sc1
  s_add_u32 s21, s21, 3072
  buffer_load_dwordx4 v[80:83], v26, s[56:59], s21 offen offset:0 sc1
  buffer_load_dwordx4 v[84:87], v26, s[56:59], s21 offen offset:1024 sc1
  buffer_load_dwordx4 v[104:107], v26, s[56:59], s21 offen offset:2048 sc1
  s_add_u32 s21, s21, 3072
  buffer_load_dwordx4 v[88:91], v26, s[56:59], s21 offen offset:0 sc1
  buffer_load_dwordx4 v[92:95], v26, s[56:59], s21 offen offset:1024 sc1
  buffer_load_dwordx4 v[108:111], v26, s[56:59], s21 offen offset:2048 sc1
  s_add_u32 s21, s21, 3072
  s_waitcnt vmcnt(0)
  buffer_atomic_add v28, v33, s[72:75], s84 offen sc1
  s_mov_b32 s49, s43
  s_mov_b32 s50, s45
  s_mov_b32 s81, s47
  s_mov_b32 s82, s48
  s_add_u32 s43, s43, 4
  s_add_u32 s45, s45, 8388608
  s_add_u32 s47, s47, 2097152
  s_xor_b32 s47, s47, 8192
  s_add_u32 s48, s48, 512
  s_cmp_gt_u32 s49, 60
  s_cselect_b32 s23, 58, s49
  s_mov_b32 s101, 0
wm_296:
  buffer_load_dword v34, v30, s[72:75], s77 offen sc1
  s_add_u32 s101, s101, 1
  s_cmp_gt_u32 s101, 131072
  s_cbranch_scc1 main_end
  s_waitcnt vmcnt(0)
  v_cmp_gt_u32 vcc, s23, v34
  v_readfirstlane_b32 s100, v34
  s_nop 0
  s_cbranch_vccz wm_297
  s_sleep 4
  s_add_u32 s100, s100, 2
  s_cmp_ge_u32 s100, s23
  s_cbranch_scc1 wm_296
  s_sleep 40
  s_branch wm_296
wm_297:
  s_add_u32 s29, s50, 0
  buffer_load_dwordx4 v[112:115], v26, s[16:19], s29 offen offset:0 sc1
  buffer_load_dwordx4 v[116:119], v26, s[16:19], s29 offen offset:1024 sc1
  buffer_load_dwordx4 v[144:147], v26, s[16:19], s29 offen offset:2048 sc1
  s_add_u32 s29, s50, 16384
  buffer_load_dwordx4 v[120:123], v26, s[16:19], s29 offen offset:0 sc1
  buffer_load_dwordx4 v[124:127], v26, s[16:19], s29 offen offset:1024 sc1
  buffer_load_dwordx4 v[148:151], v26, s[16:19], s29 offen offset:2048 sc1
  s_add_u32 s29, s50, 32768
  buffer_load_dwordx4 v[128:131], v26, s[16:19], s29 offen offset:0 sc1
  buffer_load_dwordx4 v[132:135], v26, s[16:19], s29 offen offset:1024 sc1
  buffer_load_dwordx4 v[152:155], v26, s[16:19], s29 offen offset:2048 sc1
  s_add_u32 s29, s50, 49152
  buffer_load_dwordx4 v[136:139], v26, s[16:19], s29 offen offset:0 sc1
  buffer_load_dwordx4 v[140:143], v26, s[16:19], s29 offen offset:1024 sc1
  buffer_load_dwordx4 v[156:159], v26, s[16:19], s29 offen offset:2048 sc1
  s_waitcnt vmcnt(0) lgkmcnt(0)
  v_swap_b32 v98, v100
  v_swap_b32 v99, v101
  v_swap_b32 v106, v108
  v_swap_b32 v107, v109
  v_swap_b32 v146, v148
  v_swap_b32 v147, v149
  v_swap_b32 v154, v156
  v_swap_b32 v155, v157
  s_nop 1
  v_mfma_f32_16x16x32_bf16 v[36:39], v[112:115], v[64:67], 0
  v_mfma_f32_16x16x32_bf16 v[44:47], v[112:115], v[68:71], 0
  v_mfma_f32_16x16x32_bf16 v[48:51], v[116:119], v[68:71], 0
  v_mfma_f32_16x16x32_bf16 v[36:39], v[120:123], v[72:75], v[36:39]
  v_mfma_f32_16x16x32_bf16 v[44:47], v[120:123], v[76:79], v[44:47]
  v_mfma_f32_16x16x32_bf16 v[48:51], v[124:127], v[76:79], v[48:51]
  v_mfma_f32_16x16x32_bf16 v[36:39], v[144:147], v[96:99], v[36:39]
  v_mfma_f32_16x16x32_bf16 v[44:47], v[144:147], v[100:103], v[44:47]
  v_mfma_f32_16x16x32_bf16 v[48:51], v[148:151], v[100:103], v[48:51]
  v_mfma_f32_16x16x32_bf16 v[36:39], v[128:131], v[80:83], v[36:39]
  v_mfma_f32_16x16x32_bf16 v[44:47], v[128:131], v[84:87], v[44:47]
  v_mfma_f32_16x16x32_bf16 v[48:51], v[132:135], v[84:87], v[48:51]
  v_mfma_f32_16x16x32_bf16 v[36:39], v[136:139], v[88:91], v[36:39]
  v_mfma_f32_16x16x32_bf16 v[44:47], v[136:139], v[92:95], v[44:47]
  v_mfma_f32_16x16x32_bf16 v[48:51], v[140:143], v[92:95], v[48:51]
  v_mfma_f32_16x16x32_bf16 v[36:39], v[152:155], v[104:107], v[36:39]
  v_mfma_f32_16x16x32_bf16 v[44:47], v[152:155], v[108:111], v[44:47]
  v_mfma_f32_16x16x32_bf16 v[48:51], v[156:159], v[108:111], v[48:51]
  s_cmp_le_u32 s49, 60
  s_cbranch_scc1 qtp_300
  s_sub_u32 s23, s49, 1
  s_min_u32 s23, s23, 62
  s_mov_b32 s101, 0
wm_301:
  buffer_load_dword v34, v30, s[72:75], s77 offen sc1
  s_add_u32 s101, s101, 1
  s_cmp_gt_u32 s101, 131072
  s_cbranch_scc1 main_end
  s_waitcnt vmcnt(0)
  v_cmp_gt_u32 vcc, s23, v34
  v_readfirstlane_b32 s100, v34
  s_nop 0
  s_cbranch_vccz wm_302
  s_sleep 4
  s_add_u32 s100, s100, 2
  s_cmp_ge_u32 s100, s23
  s_cbranch_scc1 wm_301
  s_sleep 40
  s_branch wm_301
wm_302:
qtp_300:
  s_mov_b32 s101, 0
  s_branch qtp_299
qtp_298:
  s_sleep 2
qtp_299:
  s_add_u32 s29, s50, 4096
  buffer_load_dwordx4 v[160:163], v24, s[16:19], s29 offen offset:2560 sc1
  buffer_load_dwordx2 v[240:241], v25, s[16:19], s29 offen offset:3072 sc1
  s_add_u32 s29, s50, 20480
  buffer_load_dwordx4 v[164:167], v24, s[16:19], s29 offen offset:2560 sc1
  buffer_load_dwordx2 v[242:243], v25, s[16:19], s29 offen offset:3072 sc1
  s_add_u32 s29, s50, 36864
  buffer_load_dwordx4 v[168:171], v24, s[16:19], s29 offen offset:2560 sc1
  buffer_load_dwordx2 v[244:245], v25, s[16:19], s29 offen offset:3072 sc1
  s_add_u32 s29, s50, 53248
  buffer_load_dwordx4 v[172:175], v24, s[16:19], s29 offen offset:2560 sc1
  buffer_load_dwordx2 v[246:247], v25, s[16:19], s29 offen offset:3072 sc1
  s_add_u32 s101, s101, 1
  s_cmp_gt_u32 s101, 131072
  s_cbranch_scc1 main_end
  s_waitcnt vmcnt(0)
  v_max3_u32 v34, v160, v164, v168
  v_max3_u32 v34, v34, v172, v240
  v_max3_u32 v34, v34, v242, v244
  v_max_u32 v34, v34, v246
  v_cmp_eq_u32 vcc, -1, v34
  s_nop 1
  s_cbranch_vccnz qtp_298
  v_mfma_f32_16x16x32_bf16 v[40:43], v[160:163], v[64:67], 0
  v_mfma_f32_16x16x32_bf16 v[52:55], v[160:163], v[68:71], 0
  v_mfma_f32_16x16x32_bf16 v[40:43], v[164:167], v[72:75], v[40:43]
  v_mfma_f32_16x16x32_bf16 v[52:55], v[164:167], v[76:79], v[52:55]
  v_mfma_f32_16x16x32_bf16 v[40:43], v[240:243], v[96:99], v[40:43]
  v_mfma_f32_16x16x32_bf16 v[52:55], v[240:243], v[100:103], v[52:55]
  v_mfma_f32_16x16x32_bf16 v[40:43], v[168:171], v[80:83], v[40:43]
  v_mfma_f32_16x16x32_bf16 v[52:55], v[168:171], v[84:87], v[52:55]
  v_mfma_f32_16x16x32_bf16 v[40:43], v[172:175], v[88:91], v[40:43]
  v_mfma_f32_16x16x32_bf16 v[52:55], v[172:175], v[92:95], v[52:55]
  v_mfma_f32_16x16x32_bf16 v[40:43], v[244:247], v[104:107], v[40:43]
  v_mfma_f32_16x16x32_bf16 v[52:55], v[244:247], v[108:111], v[52:55]
  s_nop 4
  v_cndmask_b32 v36, v31, v36, s[64:65]
  v_cndmask_b32 v48, v31, v48, s[64:65]
  v_cndmask_b32 v37, v31, v37, s[66:67]
  v_cndmask_b32 v49, v31, v49, s[66:67]
  v_cndmask_b32 v38, v31, v38, s[68:69]
  v_cndmask_b32 v50, v31, v50, s[68:69]
  v_cndmask_b32 v39, v31, v39, s[70:71]
  v_cndmask_b32 v51, v31, v51, s[70:71]
  v_max3_f32 v34, v36, v37, v38
  v_max3_f32 v34, v34, v39, v40
  v_max3_f32 v34, v34, v41, v42
  v_max_f32 v34, v34, v43
  v_mov_b32 v35, v34
  s_nop 1
  v_permlane32_swap_b32 v34, v35
  v_max_f32 v34, v34, v35
  v_mov_b32 v35, v34
  s_nop 1
  v_permlane16_swap_b32 v34, v35
  v_max_f32 v34, v34, v35
  v_mul_f32 v34, s83, v34
  v_fma_f32 v36, v36, s83, -v34
  v_fma_f32 v37, v37, s83, -v34
  v_fma_f32 v38, v38, s83, -v34
  v_fma_f32 v39, v39, s83, -v34
  v_fma_f32 v40, v40, s83, -v34
  v_fma_f32 v41, v41, s83, -v34
  v_fma_f32 v42, v42, s83, -v34
  v_fma_f32 v43, v43, s83, -v34
  v_exp_f32 v36, v36
  v_exp_f32 v37, v37
  v_exp_f32 v38, v38
  v_exp_f32 v39, v39
  v_exp_f32 v40, v40
  v_exp_f32 v41, v41
  v_exp_f32 v42, v42
  v_exp_f32 v43, v43
  s_nop 0
  v_add_f32 v34, v40, v41
  v_add_f32 v34, v34, v42
  v_add_f32 v34, v34, v43
  v_cndmask_b32 v34, 0, v34, s[62:63]
  v_add_f32 v34, v34, v36
  v_add_f32 v34, v34, v37
  v_add_f32 v34, v34, v38
  v_add_f32 v34, v34, v39
  v_mov_b32 v35, v34
  s_nop 1
  v_permlane32_swap_b32 v34, v35
  v_add_f32 v34, v34, v35
  v_mov_b32 v35, v34
  s_nop 1
  v_permlane16_swap_b32 v34, v35
  v_add_f32 v34, v34, v35
  v_rcp_f32 v34, v34
  s_nop 0
  v_mul_f32 v36, v36, v34
  v_mul_f32 v37, v37, v34
  v_mul_f32 v38, v38, v34
  v_mul_f32 v39, v39, v34
  v_mul_f32 v40, v40, v34
  v_mul_f32 v41, v41, v34
  v_mul_f32 v42, v42, v34
  v_mul_f32 v43, v43, v34
  v_max3_f32 v34, v44, v45, v46
  v_max3_f32 v34, v34, v47, v48
  v_max3_f32 v34, v34, v49, v50
  v_max3_f32 v34, v34, v51, v52
  v_max3_f32 v34, v34, v53, v54
  v_max_f32 v34, v34, v55
  v_mov_b32 v35, v34
  s_nop 1
  v_permlane32_swap_b32 v34, v35
  v_max_f32 v34, v34, v35
  v_mov_b32 v35, v34
  s_nop 1
  v_permlane16_swap_b32 v34, v35
  v_max_f32 v34, v34, v35
  v_mul_f32 v34, s83, v34
  v_fma_f32 v44, v44, s83, -v34
  v_fma_f32 v45, v45, s83, -v34
  v_fma_f32 v46, v46, s83, -v34
  v_fma_f32 v47, v47, s83, -v34
  v_fma_f32 v48, v48, s83, -v34
  v_fma_f32 v49, v49, s83, -v34
  v_fma_f32 v50, v50, s83, -v34
  v_fma_f32 v51, v51, s83, -v34
  v_fma_f32 v52, v52, s83, -v34
  v_fma_f32 v53, v53, s83, -v34
  v_fma_f32 v54, v54, s83, -v34
  v_fma_f32 v55, v55, s83, -v34
  v_exp_f32 v44, v44
  v_exp_f32 v45, v45
  v_exp_f32 v46, v46
  v_exp_f32 v47, v47
  v_exp_f32 v48, v48
  v_exp_f32 v49, v49
  v_exp_f32 v50, v50
  v_exp_f32 v51, v51
  v_exp_f32 v52, v52
  v_exp_f32 v53, v53
  v_exp_f32 v54, v54
  v_exp_f32 v55, v55
  s_nop 0
  v_add_f32 v34, v52, v53
  v_add_f32 v34, v34, v54
  v_add_f32 v34, v34, v55
  v_cndmask_b32 v34, 0, v34, s[62:63]
  v_add_f32 v34, v34, v44
  v_add_f32 v34, v34, v45
  v_add_f32 v34, v34, v46
  v_add_f32 v34, v34, v47
  v_add_f32 v34, v34, v48
  v_add_f32 v34, v34, v49
  v_add_f32 v34, v34, v50
  v_add_f32 v34, v34, v51
  v_mov_b32 v35, v34
  s_nop 1
  v_permlane32_swap_b32 v34, v35
  v_add_f32 v34, v34, v35
  v_mov_b32 v35, v34
  s_nop 1
  v_permlane16_swap_b32 v34, v35
  v_add_f32 v34, v34, v35
  v_rcp_f32 v34, v34
  s_nop 0
  v_mul_f32 v44, v44, v34
  v_mul_f32 v45, v45, v34
  v_mul_f32 v46, v46, v34
  v_mul_f32 v47, v47, v34
  v_mul_f32 v48, v48, v34
  v_mul_f32 v49, v49, v34
  v_mul_f32 v50, v50, v34
  v_mul_f32 v51, v51, v34
  v_mul_f32 v52, v52, v34
  v_mul_f32 v53, v53, v34
  v_mul_f32 v54, v54, v34
  v_mul_f32 v55, v55, v34
  v_cvt_pk_bf16_f32 v56, v44, v45
  v_cvt_pk_bf16_f32 v57, v46, v47
  v_cvt_pk_bf16_f32 v58, v48, v49
  v_cvt_pk_bf16_f32 v59, v50, v51
  v_cvt_pk_bf16_f32 v60, v40, v41
  v_cvt_pk_bf16_f32 v61, v42, v43
  v_cvt_pk_bf16_f32 v62, v52, v53
  v_cvt_pk_bf16_f32 v63, v54, v55
  v_cvt_pk_bf16_f32 v248, v36, v37
  v_cvt_pk_bf16_f32 v249, v38, v39
  buffer_store_dwordx4 v[56:59], v26, s[16:19], s81 offen sc1
  buffer_store_dwordx4 v[60:63], v26, s[16:19], s81 offen offset:1024 sc1
  buffer_store_dwordx2 v[248:249], v29, s[16:19], s81 offen offset:2048 sc1
  s_mov_b32 s84, s82
  s_branch qf_280
qf_281:
  s_waitcnt vmcnt(0)
  buffer_atomic_add v28, v33, s[72:75], s82 offen sc1
  s_branch qe_303
qw_277:
  s_mov_b32 s101, 0
wm_304:
  buffer_load_dword v32, v30, s[72:75], s77 offen sc1
  s_add_u32 s101, s101, 1
  s_cmp_gt_u32 s101, 131072
  s_cbranch_scc1 main_end
  s_waitcnt vmcnt(0)
  v_cmp_gt_u32 vcc, s49, v32
  v_readfirstlane_b32 s100, v32
  s_nop 0
  s_cbranch_vccz wm_305
  s_sleep 4
  s_add_u32 s100, s100, 2
  s_cmp_ge_u32 s100, s49
  s_cbranch_scc1 wm_304
  s_sleep 60
  s_branch wm_304
wm_305:
  s_branch qj_278
qa2_272:
  s_mov_b32 s49, 0
  s_mov_b32 s50, 1073741824
  s_mov_b32 s81, 1073741824
  s_mov_b32 s82, 1073741824
  s_branch qa3_273
qs_274:
  s_mul_i32 s21, s20, 3072
  s_add_u32 s21, s21, s86
  buffer_store_dwordx4 v[192:195], v26, s[56:59], s21 offen offset:0 sc1
  buffer_store_dwordx4 v[196:199], v26, s[56:59], s21 offen offset:1024 sc1
  buffer_store_dwordx4 v[200:203], v26, s[56:59], s21 offen offset:2048 sc1
  s_add_u32 s21, s21, 12288
  buffer_store_dwordx4 v[204:207], v26, s[56:59], s21 offen offset:0 sc1
  buffer_store_dwordx4 v[208:211], v26, s[56:59], s21 offen offset:1024 sc1
  buffer_store_dwordx4 v[212:215], v26, s[56:59], s21 offen offset:2048 sc1
  s_add_u32 s21, s21, 12288
  buffer_store_dwordx4 v[216:219], v26, s[56:59], s21 offen offset:0 sc1
  buffer_store_dwordx4 v[220:223], v26, s[56:59], s21 offen offset:1024 sc1
  buffer_store_dwordx4 v[224:227], v26, s[56:59], s21 offen offset:2048 sc1
  s_add_u32 s21, s21, 12288
  buffer_store_dwordx4 v[228:231], v26, s[56:59], s21 offen offset:0 sc1
  buffer_store_dwordx4 v[232:235], v26, s[56:59], s21 offen offset:1024 sc1
  buffer_store_dwordx4 v[236:239], v26, s[56:59], s21 offen offset:2048 sc1
  s_add_u32 s21, s21, 12288
  s_add_u32 s86, s86, 49152
  s_branch qs_275
qe_303:
queue:
  s_mov_b32 s87, 16
  s_mov_b32 s88, 0
queue2:
  s_load_dwordx2 s[4:5], s[0:1], 88
  s_load_dwordx2 s[38:39], s[0:1], 104
  s_lshr_b32 s58, s3, 4
  s_bfe_u32 s21, s3, 0x20003
  s_cmp_lt_u32 s3, 64
  s_cselect_b32 s58, s58, s21
  s_cselect_b32 s21, 1, 0
  s_lshr_b32 s41, s3, s21
  s_and_b32 s41, s41, 7
  s_lshl_b32 s59, s58, 3
  s_add_u32 s59, s59, s41
  s_lshl_b32 s59, s59, 7
  s_add_u32 s59, s59, 40960
  s_xor_b32 s59, s59, s80
  s_waitcnt vmcnt(0) lgkmcnt(0)
  s_barrier
  s_mov_b32 s8, s4
  s_mov_b32 s9, s5
  s_mov_b32 s10, 2621440
  s_mov_b32 s11, 0x00020000
  s_add_u32 s12, s38, 180355072
  s_addc_u32 s13, s39, 0
  s_mov_b32 s14, 4194304
  s_mov_b32 s15, 0x00020000
  s_mov_b32 s16, s38
  s_mov_b32 s17, s39
  s_mov_b32 s18, 218103808
  s_mov_b32 s19, 0x00020000
  s_add_u32 s28, s38, 175112192
  s_addc_u32 s29, s39, 0
  s_mov_b32 s30, 8192
  s_mov_b32 s31, 0x00020000
  s_add_u32 s72, s38, 173080576
  s_addc_u32 s73, s39, 0
  s_mov_b32 s74, 49152
  s_mov_b32 s75, 0x00020000
  v_mov_b32 v30, 102400
  v_mov_b32 v233, 0x40000000
  v_cmp_eq_u32 vcc, 0, v0
  v_and_b32 v7, 7, v1
  v_lshlrev_b32 v7, 7, v7
  v_cndmask_b32 v233, v233, 0, vcc
  v_mov_b32 v29, 1
  buffer_atomic_add v29, v233, s[72:75], s59 offen sc0 sc1
  v_bfe_u32 v31, v1, 3, 2
  v_lshl_add_u32 v31, v31, 2, v7
  s_lshl_b32 s51, s20, 10
  s_add_u32 s51, s51, 4096
  s_xor_b32 s51, s51, s80
  buffer_load_dword v8, v31, s[72:75], s51 offen sc1
  v_and_b32 v25, 3, v1
  v_lshlrev_b32 v25, 7, v25
  s_xor_b32 s56, s80, 29696
  buffer_load_dword v26, v25, s[72:75], s56 offen sc1
  v_lshlrev_b32 v4, 4, v1
  v_lshlrev_b32 v5, 3, v1
  v_lshlrev_b32 v6, 2, v2
  v_mul_u32_u24 v9, 1280, v2
  v_lshl_add_u32 v13, v3, 3, v9
  v_lshl_add_u32 v9, v3, 4, v9
  s_mul_i32 s21, s20, 10240
  v_add_u32 v10, s21, v4
  s_and_b32 s43, s20, 1
  s_lshr_b32 s44, s20, 1
  s_mul_i32 s21, s44, 6
  s_add_u32 s21, s21, s43
  s_lshl_b32 s21, s21, 10
  v_add_u32 v11, s21, v4
  s_add_u32 s21, s43, 4
  s_lshl_b32 s21, s21, 10
  v_add_u32 v12, s21, v4
  v_lshrrev_b32 v20, 5, v1
  v_mul_u32_u24 v21, 2560, v20
  v_add_u32 v21, v21, v4
  v_and_b32 v22, 31, v1
  v_lshlrev_b32 v22, 4, v22
  v_mul_u32_u24 v14, 640, v20
  v_add_u32 v22, v22, v14
  v_add_u32 v28, 16384, v22
  v_and_b32 v15, 1, v3
  v_lshl_add_u32 v14, v15, 6, v14
  v_lshrrev_b32 v16, 3, v2
  v_mul_u32_u24 v16, 16320, v16
  v_lshl_add_u32 v16, v2, 3, v16
  v_add_u32 v14, v14, v16
  v_add_u32 v15, 40960, v11
  v_lshlrev_b32 v17, 2, v7
  v_bfe_u32 v16, v1, 3, 1
  v_lshl_add_u32 v17, v16, 3, v17
  v_add_u32 v16, 40960, v12
  v_cmp_gt_u32 s[66:67], 16, v1
  s_lshr_b32 s52, s41, 1
  s_lshl_b32 s52, s52, 7
  s_and_b32 s21, s41, 1
  s_lshl_b32 s21, s21, 4
  s_add_u32 s52, s52, s21
  s_add_u32 s52, s52, 0
  s_xor_b32 s52, s52, s80
  v_add_u32 v17, s52, v17
  s_lshl_b32 s21, s20, 17
  s_lshl_b32 s22, s41, 10
  s_add_u32 s42, s21, s22
  s_lshl_b32 s53, s20, 19
  s_lshl_b32 s60, s41, 15
  s_add_u32 s60, s60, s53
  s_add_u32 s60, s60, 4096
  s_lshr_b32 s22, s41, 1
  s_lshl_b32 s22, s22, 14
  s_add_u32 s53, s53, s22
  s_and_b32 s22, s41, 1
  s_lshl_b32 s22, s22, 12
  s_add_u32 s53, s53, s22
  v_mov_b32 v70, 0
  v_mov_b32 v71, 0
  v_mov_b32 v78, 0
  v_mov_b32 v79, 0
  v_mov_b32 v86, 0
  v_mov_b32 v87, 0
  v_mov_b32 v94, 0
  v_mov_b32 v95, 0
  v_mov_b32 v102, 0
  v_mov_b32 v103, 0
  v_mov_b32 v110, 0
  v_mov_b32 v111, 0
  v_mov_b32 v118, 0
  v_mov_b32 v119, 0
  v_mov_b32 v126, 0
  v_mov_b32 v127, 0
  s_waitcnt vmcnt(0)
  s_cmp_lg_u32 s20, 0
  s_cbranch_scc1 pvq_307
  s_mov_b64 exec, 1
  ds_write_b32 v30, v29
  s_mov_b64 exec, -1
pvq_307:
  v_readlane_b32 s50, v8, 0
  v_readlane_b32 s21, v8, 1
  s_min_u32 s50, s50, s21
  v_readlane_b32 s21, v8, 2
  s_min_u32 s50, s50, s21
  v_readlane_b32 s21, v8, 3
  s_min_u32 s50, s50, s21
  v_readlane_b32 s21, v8, 4
  s_min_u32 s50, s50, s21
  v_readlane_b32 s21, v8, 5
  s_min_u32 s50, s50, s21
  v_readlane_b32 s21, v8, 6
  s_min_u32 s50, s50, s21
  v_readlane_b32 s21, v8, 7
  s_min_u32 s50, s50, s21
  v_readlane_b32 s21, v8, 8
  s_min_u32 s50, s50, s21
  v_readlane_b32 s21, v8, 9
  s_min_u32 s50, s50, s21
  v_readlane_b32 s21, v8, 10
  s_min_u32 s50, s50, s21
  v_readlane_b32 s21, v8, 11
  s_min_u32 s50, s50, s21
  v_readlane_b32 s21, v8, 12
  s_min_u32 s50, s50, s21
  v_readlane_b32 s21, v8, 13
  s_min_u32 s50, s50, s21
  v_readlane_b32 s21, v8, 14
  s_min_u32 s50, s50, s21
  v_readlane_b32 s21, v8, 15
  s_min_u32 s50, s50, s21
  v_readlane_b32 s21, v8, 16
  s_min_u32 s50, s50, s21
  v_readlane_b32 s21, v8, 17
  s_min_u32 s50, s50, s21
  v_readlane_b32 s21, v8, 18
  s_min_u32 s50, s50, s21
  v_readlane_b32 s21, v8, 19
  s_min_u32 s50, s50, s21
  v_readlane_b32 s21, v8, 20
  s_min_u32 s50, s50, s21
  v_readlane_b32 s21, v8, 21
  s_min_u32 s50, s50, s21
  v_readlane_b32 s21, v8, 22
  s_min_u32 s50, s50, s21
  v_readlane_b32 s21, v8, 23
  s_min_u32 s50, s50, s21
  v_readlane_b32 s21, v8, 24
  s_min_u32 s50, s50, s21
  v_readlane_b32 s21, v8, 25
  s_min_u32 s50, s50, s21
  v_readlane_b32 s21, v8, 26
  s_min_u32 s50, s50, s21
  v_readlane_b32 s21, v8, 27
  s_min_u32 s50, s50, s21
  v_readlane_b32 s21, v8, 28
  s_min_u32 s50, s50, s21
  v_readlane_b32 s21, v8, 29
  s_min_u32 s50, s50, s21
  v_readlane_b32 s21, v8, 30
  s_min_u32 s50, s50, s21
  v_readlane_b32 s21, v8, 31
  s_min_u32 s50, s50, s21
  v_cmp_gt_u32 vcc, 16, v26
  s_waitcnt lgkmcnt(0)
  s_barrier
  ds_read_b32 v23, v30
  s_cbranch_vccz pv_306
  s_mov_b32 s101, 0
wm_308:
  buffer_load_dword v26, v25, s[72:75], s56 offen sc1
  s_add_u32 s101, s101, 1
  s_cmp_gt_u32 s101, 131072
  s_cbranch_scc1 main_end
  s_waitcnt vmcnt(0)
  v_cmp_gt_u32 vcc, 16, v26
  v_readfirstlane_b32 s100, v26
  s_nop 0
  s_cbranch_vccz wm_309
  s_sleep 16
  s_branch wm_308
wm_309:
pv_306:
  s_mov_b32 s71, 0
pv_late:
  s_waitcnt lgkmcnt(0)
  v_readfirstlane_b32 s2, v23
  s_cmp_ge_u32 s2, 16
  s_cbranch_scc1 pv_done
  s_lshl_b32 s40, s2, 2
  s_add_u32 s40, s40, s58
  s_lshl_b32 s21, s40, 7
  s_add_u32 s21, s21, 8192
  s_xor_b32 s21, s21, s80
  v_mov_b32 v18, s21
  v_cndmask_b32 v18, v17, v18, s[66:67]
  s_add_u32 s21, s40, 1
  v_mov_b32 v19, s21
  v_cndmask_b32 v19, v19, 32, s[66:67]
  buffer_load_dword v27, v18, s[72:75], 0 offen sc1
  s_cmp_eq_u32 s71, 1
  s_cbranch_scc1 pv_310
  v_add_u32 v25, 4096, v4
  s_lshl_b32 s22, s41, 2
  s_add_u32 s22, s22, s20
  s_lshl_b32 s22, s22, 17
  s_lshr_b32 s21, s22, 8
  s_andn2_b32 s21, 8192, s21
  s_xor_b32 s21, s21, s80
  s_add_u32 s22, s22, s21
  buffer_load_dwordx4 a[160:163], v4, s[12:15], s22 offen offset:0 sc1
  buffer_load_dwordx4 a[164:167], v4, s[12:15], s22 offen offset:1024 sc1
  buffer_load_dwordx4 a[168:171], v4, s[12:15], s22 offen offset:2048 sc1
  buffer_load_dwordx4 a[172:175], v4, s[12:15], s22 offen offset:3072 sc1
  buffer_load_dwordx4 a[176:179], v25, s[12:15], s22 offen offset:0 sc1
  s_add_u32 s22, s22, 16384
  buffer_load_dwordx4 a[180:183], v4, s[12:15], s22 offen offset:0 sc1
  buffer_load_dwordx4 a[184:187], v4, s[12:15], s22 offen offset:1024 sc1
  buffer_load_dwordx4 a[188:191], v4, s[12:15], s22 offen offset:2048 sc1
  buffer_load_dwordx4 a[192:195], v4, s[12:15], s22 offen offset:3072 sc1
  buffer_load_dwordx4 a[196:199], v25, s[12:15], s22 offen offset:0 sc1
  s_add_u32 s22, s22, 16384
  buffer_load_dwordx4 a[200:203], v4, s[12:15], s22 offen offset:0 sc1
  buffer_load_dwordx4 a[204:207], v4, s[12:15], s22 offen offset:1024 sc1
  buffer_load_dwordx4 a[208:211], v4, s[12:15], s22 offen offset:2048 sc1
  buffer_load_dwordx4 a[212:215], v4, s[12:15], s22 offen offset:3072 sc1
  buffer_load_dwordx4 a[216:219], v25, s[12:15], s22 offen offset:0 sc1
  s_add_u32 s22, s22, 16384
  buffer_load_dwordx4 a[220:223], v4, s[12:15], s22 offen offset:0 sc1
  buffer_load_dwordx4 a[224:227], v4, s[12:15], s22 offen offset:1024 sc1
  buffer_load_dwordx4 a[228:231], v4, s[12:15], s22 offen offset:2048 sc1
  buffer_load_dwordx4 a[232:235], v4, s[12:15], s22 offen offset:3072 sc1
  buffer_load_dwordx4 a[236:239], v25, s[12:15], s22 offen offset:0 sc1
  s_add_u32 s22, s22, 16384
  buffer_load_dwordx4 a[240:243], v4, s[12:15], s22 offen offset:0 sc1
  buffer_load_dwordx4 a[244:247], v4, s[12:15], s22 offen offset:1024 sc1
  buffer_load_dwordx4 a[248:251], v4, s[12:15], s22 offen offset:2048 sc1
  buffer_load_dwordx4 a[252:255], v4, s[12:15], s22 offen offset:3072 sc1
  buffer_load_dwordx4 v[252:255], v25, s[12:15], s22 offen offset:0 sc1
  s_add_u32 s22, s22, 16384
pv_310:
  s_lshl_b32 s55, s40, 19
  s_lshl_b32 s21, s40, 11
  s_and_b32 s21, s21, 8192
  s_xor_b32 s21, s21, s80
  s_add_u32 s55, s55, s21
  s_add_u32 s55, s55, 136314880
  s_lshl_b32 s21, s20, 15
  s_xor_b32 s54, s55, 8192
  s_add_u32 s54, s54, 48234496
  s_add_u32 s54, s54, s21
  s_lshl_b32 s57, s40, 1
  s_add_u32 s57, s57, s43
  s_lshl_b32 s45, s57, 6
  s_add_u32 s69, s54, 262144
  s_cmp_lt_u32 s2, 16
  s_cselect_b32 s69, s69, 0x40000000
  s_cmp_lt_u32 s2, 12
  s_cselect_b32 s65, s87, 0
  s_cmp_gt_u32 s65, 1
  s_cselect_b32 s64, s59, 0x40000000
  s_cselect_b32 s65, 1, 0
  v_mov_b32 v29, 1
  buffer_atomic_add v29, v233, s[72:75], s64 offen sc0 sc1
  buffer_load_dword v232, v6, s[28:31], s45 offen sc1
  buffer_load_dwordx4 v[192:195], v4, s[16:19], s69 offen offset:0 sc1
  buffer_load_dwordx4 v[196:199], v4, s[16:19], s69 offen offset:1024 sc1
  buffer_load_dwordx2 v[208:209], v5, s[16:19], s69 offen offset:2048 sc1
  s_add_u32 s69, s69, 2560
  buffer_load_dwordx4 v[200:203], v4, s[16:19], s69 offen offset:0 sc1
  buffer_load_dwordx4 v[204:207], v4, s[16:19], s69 offen offset:1024 sc1
  buffer_load_dwordx2 v[210:211], v5, s[16:19], s69 offen offset:2048 sc1
  s_add_u32 s69, s69, 13824
  buffer_load_dwordx4 v[212:215], v4, s[16:19], s69 offen offset:0 sc1
  buffer_load_dwordx4 v[216:219], v4, s[16:19], s69 offen offset:1024 sc1
  buffer_load_dwordx2 v[228:229], v5, s[16:19], s69 offen offset:2048 sc1
  s_add_u32 s69, s69, 2560
  buffer_load_dwordx4 v[220:223], v4, s[16:19], s69 offen offset:0 sc1
  buffer_load_dwordx4 v[224:227], v4, s[16:19], s69 offen offset:1024 sc1
  buffer_load_dwordx2 v[230:231], v5, s[16:19], s69 offen offset:2048 sc1
  s_add_u32 s69, s69, 13824
  s_waitcnt vmcnt(14)
  s_add_u32 s23, s40, 1
  s_cmp_ge_u32 s50, s23
  s_cbranch_scc1 pv_311
  s_mov_b32 s101, 0
wm_314:
  buffer_load_dword v8, v31, s[72:75], s51 offen sc1
  s_add_u32 s101, s101, 1
  s_cmp_gt_u32 s101, 131072
  s_cbranch_scc1 main_end
  s_waitcnt vmcnt(0)
  v_cmp_gt_u32 vcc, s23, v8
  v_readfirstlane_b32 s100, v8
  s_nop 0
  s_cbranch_vccz wm_315
  s_sleep 8
  s_add_u32 s100, s100, 2
  s_cmp_ge_u32 s100, s23
  s_cbranch_scc1 wm_314
  s_sleep 60
  s_branch wm_314
wm_315:
  v_readlane_b32 s50, v8, 0
  v_readlane_b32 s21, v8, 1
  s_min_u32 s50, s50, s21
  v_readlane_b32 s21, v8, 2
  s_min_u32 s50, s50, s21
  v_readlane_b32 s21, v8, 3
  s_min_u32 s50, s50, s21
  v_readlane_b32 s21, v8, 4
  s_min_u32 s50, s50, s21
  v_readlane_b32 s21, v8, 5
  s_min_u32 s50, s50, s21
  v_readlane_b32 s21, v8, 6
  s_min_u32 s50, s50, s21
  v_readlane_b32 s21, v8, 7
  s_min_u32 s50, s50, s21
  v_readlane_b32 s21, v8, 8
  s_min_u32 s50, s50, s21
  v_readlane_b32 s21, v8, 9
  s_min_u32 s50, s50, s21
  v_readlane_b32 s21, v8, 10
  s_min_u32 s50, s50, s21
  v_readlane_b32 s21, v8, 11
  s_min_u32 s50, s50, s21
  v_readlane_b32 s21, v8, 12
  s_min_u32 s50, s50, s21
  v_readlane_b32 s21, v8, 13
  s_min_u32 s50, s50, s21
  v_readlane_b32 s21, v8, 14
  s_min_u32 s50, s50, s21
  v_readlane_b32 s21, v8, 15
  s_min_u32 s50, s50, s21
  v_readlane_b32 s21, v8, 16
  s_min_u32 s50, s50, s21
  v_readlane_b32 s21, v8, 17
  s_min_u32 s50, s50, s21
  v_readlane_b32 s21, v8, 18
  s_min_u32 s50, s50, s21
  v_readlane_b32 s21, v8, 19
  s_min_u32 s50, s50, s21
  v_readlane_b32 s21, v8, 20
  s_min_u32 s50, s50, s21
  v_readlane_b32 s21, v8, 21
  s_min_u32 s50, s50, s21
  v_readlane_b32 s21, v8, 22
  s_min_u32 s50, s50, s21
  v_readlane_b32 s21, v8, 23
  s_min_u32 s50, s50, s21
  v_readlane_b32 s21, v8, 24
  s_min_u32 s50, s50, s21
  v_readlane_b32 s21, v8, 25
  s_min_u32 s50, s50, s21
  v_readlane_b32 s21, v8, 26
  s_min_u32 s50, s50, s21
  v_readlane_b32 s21, v8, 27
  s_min_u32 s50, s50, s21
  v_readlane_b32 s21, v8, 28
  s_min_u32 s50, s50, s21
  v_readlane_b32 s21, v8, 29
  s_min_u32 s50, s50, s21
  v_readlane_b32 s21, v8, 30
  s_min_u32 s50, s50, s21
  v_readlane_b32 s21, v8, 31
  s_min_u32 s50, s50, s21
pv_311:
  v_cmp_gt_u32 vcc, v19, v27
  s_lshl_b32 s61, s40, 21
  s_lshl_b32 s21, s40, 13
  s_and_b32 s21, s21, 8192
  s_xor_b32 s21, s21, s80
  s_add_u32 s61, s61, s21
  s_lshl_b32 s21, s20, 15
  s_add_u32 s47, s54, s21
  s_add_u32 s48, s61, s60
  s_xor_b32 s68, s61, 8192
  s_add_u32 s68, s68, s53
  s_add_u32 s70, s55, s42
  s_xor_b32 s70, s70, 0
  s_mov_b32 s62, 0
  s_cbranch_vccnz pv_312
  s_mov_b32 s62, 1
  buffer_load_dwordx4 a[0:3], v4, s[16:19], s68 offen offset:0 sc1
  buffer_load_dwordx4 a[4:7], v4, s[16:19], s68 offen offset:1024 sc1
  buffer_load_dwordx4 v[32:35], v22, s[16:19], s48 offen offset:0 sc1
  buffer_load_dwordx4 a[8:11], v4, s[16:19], s70 offen sc1
  s_add_u32 s70, s70, 16384
  buffer_load_dwordx4 a[12:15], v4, s[16:19], s68 offen offset:2048 sc1
  buffer_load_dwordx4 a[16:19], v4, s[16:19], s68 offen offset:3072 sc1
  s_add_u32 s68, s68, 65536
  buffer_load_dwordx4 v[64:67], v4, s[16:19], s47 offen sc1
  buffer_load_dwordx2 v[68:69], v5, s[16:19], s47 offen offset:2048 sc1
  buffer_load_dwordx4 v[128:131], v21, s[16:19], s47 offen offset:1024 sc1
  s_add_u32 s47, s47, 2560
  buffer_load_dwordx4 a[20:23], v4, s[16:19], s68 offen offset:0 sc1
  buffer_load_dwordx4 a[24:27], v4, s[16:19], s68 offen offset:1024 sc1
  buffer_load_dwordx4 v[40:43], v28, s[16:19], s48 offen offset:0 sc1
  buffer_load_dwordx4 a[28:31], v4, s[16:19], s70 offen sc1
  s_add_u32 s70, s70, 16384
  buffer_load_dwordx4 a[32:35], v4, s[16:19], s68 offen offset:2048 sc1
  buffer_load_dwordx4 a[36:39], v4, s[16:19], s68 offen offset:3072 sc1
  s_add_u32 s68, s68, 65536
  buffer_load_dwordx2 v[184:185], v14, s[16:19], s48 offen offset:512 sc1
  buffer_load_dwordx4 v[72:75], v4, s[16:19], s47 offen sc1
  buffer_load_dwordx2 v[76:77], v5, s[16:19], s47 offen offset:2048 sc1
  s_add_u32 s47, s47, 13824
  buffer_load_dwordx4 a[40:43], v4, s[16:19], s68 offen offset:0 sc1
  buffer_load_dwordx4 a[44:47], v4, s[16:19], s68 offen offset:1024 sc1
  buffer_load_dwordx4 v[36:39], v22, s[16:19], s48 offen offset:1280 sc1
  buffer_load_dwordx4 a[48:51], v4, s[16:19], s70 offen sc1
  s_add_u32 s70, s70, 16384
  buffer_load_dwordx4 a[52:55], v4, s[16:19], s68 offen offset:2048 sc1
  buffer_load_dwordx4 a[56:59], v4, s[16:19], s68 offen offset:3072 sc1
  s_add_u32 s68, s68, 65536
  buffer_load_dwordx4 v[80:83], v4, s[16:19], s47 offen sc1
  buffer_load_dwordx2 v[84:85], v5, s[16:19], s47 offen offset:2048 sc1
  buffer_load_dwordx4 v[132:135], v21, s[16:19], s47 offen offset:1024 sc1
  s_add_u32 s47, s47, 2560
  buffer_load_dwordx4 a[60:63], v4, s[16:19], s68 offen offset:0 sc1
  buffer_load_dwordx4 a[64:67], v4, s[16:19], s68 offen offset:1024 sc1
  buffer_load_dwordx4 v[44:47], v28, s[16:19], s48 offen offset:1280 sc1
  buffer_load_dwordx4 a[68:71], v4, s[16:19], s70 offen sc1
  s_add_u32 s70, s70, 16384
  buffer_load_dwordx4 a[72:75], v4, s[16:19], s68 offen offset:2048 sc1
  buffer_load_dwordx4 a[76:79], v4, s[16:19], s68 offen offset:3072 sc1
  s_add_u32 s68, s68, 65536
  buffer_load_dwordx2 v[186:187], v14, s[16:19], s48 offen offset:1792 sc1
  s_add_u32 s48, s48, 262144
  buffer_load_dwordx4 v[88:91], v4, s[16:19], s47 offen sc1
  buffer_load_dwordx2 v[92:93], v5, s[16:19], s47 offen offset:2048 sc1
  s_add_u32 s47, s47, 13824
  s_branch pv_313
pv_312:
  buffer_load_dwordx4 a[0:3], v4, s[16:19], s68 offen offset:0 sc1
  buffer_load_dwordx4 a[4:7], v4, s[16:19], s68 offen offset:1024 sc1
  buffer_load_dwordx4 a[8:11], v4, s[16:19], s70 offen sc1
  s_add_u32 s70, s70, 16384
  buffer_load_dwordx4 a[12:15], v4, s[16:19], s68 offen offset:2048 sc1
  buffer_load_dwordx4 a[16:19], v4, s[16:19], s68 offen offset:3072 sc1
  s_add_u32 s68, s68, 65536
  buffer_load_dwordx4 a[20:23], v4, s[16:19], s68 offen offset:0 sc1
  buffer_load_dwordx4 a[24:27], v4, s[16:19], s68 offen offset:1024 sc1
  buffer_load_dwordx4 a[28:31], v4, s[16:19], s70 offen sc1
  s_add_u32 s70, s70, 16384
  buffer_load_dwordx4 a[32:35], v4, s[16:19], s68 offen offset:2048 sc1
  buffer_load_dwordx4 a[36:39], v4, s[16:19], s68 offen offset:3072 sc1
  s_add_u32 s68, s68, 65536
  buffer_load_dwordx4 a[40:43], v4, s[16:19], s68 offen offset:0 sc1
  buffer_load_dwordx4 a[44:47], v4, s[16:19], s68 offen offset:1024 sc1
  buffer_load_dwordx4 a[48:51], v4, s[16:19], s70 offen sc1
  s_add_u32 s70, s70, 16384
  buffer_load_dwordx4 a[52:55], v4, s[16:19], s68 offen offset:2048 sc1
  buffer_load_dwordx4 a[56:59], v4, s[16:19], s68 offen offset:3072 sc1
  s_add_u32 s68, s68, 65536
  buffer_load_dwordx4 a[60:63], v4, s[16:19], s68 offen offset:0 sc1
  buffer_load_dwordx4 a[64:67], v4, s[16:19], s68 offen offset:1024 sc1
  buffer_load_dwordx4 a[68:71], v4, s[16:19], s70 offen sc1
  s_add_u32 s70, s70, 16384
  buffer_load_dwordx4 a[72:75], v4, s[16:19], s68 offen offset:2048 sc1
  buffer_load_dwordx4 a[76:79], v4, s[16:19], s68 offen offset:3072 sc1
  s_add_u32 s68, s68, 65536
  buffer_load_dwordx4 a[80:83], v4, s[16:19], s68 offen offset:0 sc1
  buffer_load_dwordx4 a[84:87], v4, s[16:19], s68 offen offset:1024 sc1
  buffer_load_dwordx4 a[88:91], v4, s[16:19], s70 offen sc1
  s_add_u32 s70, s70, 16384
  buffer_load_dwordx4 a[92:95], v4, s[16:19], s68 offen offset:2048 sc1
  buffer_load_dwordx4 a[96:99], v4, s[16:19], s68 offen offset:3072 sc1
  s_add_u32 s68, s68, 65536
  buffer_load_dwordx4 a[100:103], v4, s[16:19], s68 offen offset:0 sc1
  buffer_load_dwordx4 a[104:107], v4, s[16:19], s68 offen offset:1024 sc1
  buffer_load_dwordx4 a[108:111], v4, s[16:19], s70 offen sc1
  s_add_u32 s70, s70, 16384
  buffer_load_dwordx4 a[112:115], v4, s[16:19], s68 offen offset:2048 sc1
  buffer_load_dwordx4 a[116:119], v4, s[16:19], s68 offen offset:3072 sc1
  s_add_u32 s68, s68, 65536
  buffer_load_dwordx4 a[120:123], v4, s[16:19], s68 offen offset:0 sc1
  buffer_load_dwordx4 a[124:127], v4, s[16:19], s68 offen offset:1024 sc1
  buffer_load_dwordx4 a[128:131], v4, s[16:19], s70 offen sc1
  s_add_u32 s70, s70, 16384
  buffer_load_dwordx4 a[132:135], v4, s[16:19], s68 offen offset:2048 sc1
  buffer_load_dwordx4 a[136:139], v4, s[16:19], s68 offen offset:3072 sc1
  s_add_u32 s68, s68, 65536
  buffer_load_dwordx4 a[140:143], v4, s[16:19], s68 offen offset:0 sc1
  buffer_load_dwordx4 a[144:147], v4, s[16:19], s68 offen offset:1024 sc1
  buffer_load_dwordx4 a[148:151], v4, s[16:19], s70 offen sc1
  s_add_u32 s70, s70, 16384
  buffer_load_dwordx4 a[152:155], v4, s[16:19], s68 offen offset:2048 sc1
  buffer_load_dwordx4 a[156:159], v4, s[16:19], s68 offen offset:3072 sc1
  s_add_u32 s68, s68, 65536
pv_313:
pv_first:
  s_waitcnt lgkmcnt(0)
  s_barrier
pv_loop:
  s_mov_b32 s63, s40
  s_mul_i32 s46, s57, 20480
  s_mul_i32 s22, s41, 160
  s_add_u32 s49, s46, s22
  s_mul_i32 s21, s44, 96
  s_add_u32 s46, s49, s21
  s_sub_u32 s87, s87, 1
  s_waitcnt vmcnt(36)
  v_mov_b32 v24, v232
  s_cmp_lg_u32 s20, 0
  s_cbranch_scc1 pvq_321
  s_mov_b64 exec, 1
  ds_write_b32 v30, v29
  s_mov_b64 exec, -1
pvq_321:
  s_cmp_eq_u32 s62, 0
  s_cbranch_scc1 pvw_316
  v_mfma_f32_16x16x32_bf16 v[144:147], a[160:163], v[192:195], 0
  v_mfma_f32_16x16x32_bf16 v[148:151], a[160:163], v[212:215], 0
  buffer_load_dwordx4 a[80:83], v4, s[16:19], s68 offen offset:0 sc1
  v_mfma_f32_16x16x32_bf16 v[152:155], a[164:167], v[192:195], 0
  v_mfma_f32_16x16x32_bf16 v[156:159], a[164:167], v[212:215], 0
  v_mfma_f32_16x16x32_bf16 v[160:163], a[168:171], v[192:195], 0
  buffer_load_dwordx4 a[84:87], v4, s[16:19], s68 offen offset:1024 sc1
  v_mfma_f32_16x16x32_bf16 v[164:167], a[168:171], v[212:215], 0
  v_mfma_f32_16x16x32_bf16 v[168:171], a[172:175], v[192:195], 0
  v_mfma_f32_16x16x32_bf16 v[172:175], a[172:175], v[212:215], 0
  buffer_load_dwordx4 v[48:51], v22, s[16:19], s48 offen offset:0 sc1
  v_mfma_f32_16x16x32_bf16 v[176:179], a[176:179], v[192:195], 0
  v_mfma_f32_16x16x32_bf16 v[180:183], a[176:179], v[212:215], 0
  buffer_load_dwordx4 a[88:91], v4, s[16:19], s70 offen sc1
  s_add_u32 s70, s70, 16384
  v_mfma_f32_16x16x32_bf16 v[144:147], a[180:183], v[196:199], v[144:147]
  v_mfma_f32_16x16x32_bf16 v[148:151], a[180:183], v[216:219], v[148:151]
  v_mfma_f32_16x16x32_bf16 v[152:155], a[184:187], v[196:199], v[152:155]
  buffer_load_dwordx4 a[92:95], v4, s[16:19], s68 offen offset:2048 sc1
  v_mfma_f32_16x16x32_bf16 v[156:159], a[184:187], v[216:219], v[156:159]
  v_mfma_f32_16x16x32_bf16 v[160:163], a[188:191], v[196:199], v[160:163]
  v_mfma_f32_16x16x32_bf16 v[164:167], a[188:191], v[216:219], v[164:167]
  buffer_load_dwordx4 a[96:99], v4, s[16:19], s68 offen offset:3072 sc1
  s_add_u32 s68, s68, 65536
  v_mfma_f32_16x16x32_bf16 v[168:171], a[192:195], v[196:199], v[168:171]
  v_mfma_f32_16x16x32_bf16 v[172:175], a[192:195], v[216:219], v[172:175]
  v_mfma_f32_16x16x32_bf16 v[176:179], a[196:199], v[196:199], v[176:179]
  buffer_load_dwordx4 v[96:99], v4, s[16:19], s47 offen sc1
  v_mfma_f32_16x16x32_bf16 v[180:183], a[196:199], v[216:219], v[180:183]
  v_mfma_f32_16x16x32_bf16 v[144:147], a[200:203], v[200:203], v[144:147]
  v_mfma_f32_16x16x32_bf16 v[148:151], a[200:203], v[220:223], v[148:151]
  buffer_load_dwordx2 v[100:101], v5, s[16:19], s47 offen offset:2048 sc1
  v_mfma_f32_16x16x32_bf16 v[152:155], a[204:207], v[200:203], v[152:155]
  v_mfma_f32_16x16x32_bf16 v[156:159], a[204:207], v[220:223], v[156:159]
  buffer_load_dwordx4 v[136:139], v21, s[16:19], s47 offen offset:1024 sc1
  s_add_u32 s47, s47, 2560
  v_mfma_f32_16x16x32_bf16 v[160:163], a[208:211], v[200:203], v[160:163]
  v_mfma_f32_16x16x32_bf16 v[164:167], a[208:211], v[220:223], v[164:167]
  v_mfma_f32_16x16x32_bf16 v[168:171], a[212:215], v[200:203], v[168:171]
  buffer_load_dwordx4 a[100:103], v4, s[16:19], s68 offen offset:0 sc1
  v_mfma_f32_16x16x32_bf16 v[172:175], a[212:215], v[220:223], v[172:175]
  v_mfma_f32_16x16x32_bf16 v[176:179], a[216:219], v[200:203], v[176:179]
  v_mfma_f32_16x16x32_bf16 v[180:183], a[216:219], v[220:223], v[180:183]
  buffer_load_dwordx4 a[104:107], v4, s[16:19], s68 offen offset:1024 sc1
  v_mfma_f32_16x16x32_bf16 v[144:147], a[220:223], v[204:207], v[144:147]
  v_mfma_f32_16x16x32_bf16 v[148:151], a[220:223], v[224:227], v[148:151]
  v_mfma_f32_16x16x32_bf16 v[152:155], a[224:227], v[204:207], v[152:155]
  buffer_load_dwordx4 v[56:59], v28, s[16:19], s48 offen offset:0 sc1
  v_mfma_f32_16x16x32_bf16 v[156:159], a[224:227], v[224:227], v[156:159]
  v_mfma_f32_16x16x32_bf16 v[160:163], a[228:231], v[204:207], v[160:163]
  v_mfma_f32_16x16x32_bf16 v[164:167], a[228:231], v[224:227], v[164:167]
  buffer_load_dwordx4 a[108:111], v4, s[16:19], s70 offen sc1
  s_add_u32 s70, s70, 16384
  v_mfma_f32_16x16x32_bf16 v[168:171], a[232:235], v[204:207], v[168:171]
  v_mfma_f32_16x16x32_bf16 v[172:175], a[232:235], v[224:227], v[172:175]
  buffer_load_dwordx4 a[112:115], v4, s[16:19], s68 offen offset:2048 sc1
  v_mfma_f32_16x16x32_bf16 v[176:179], a[236:239], v[204:207], v[176:179]
  v_mfma_f32_16x16x32_bf16 v[180:183], a[236:239], v[224:227], v[180:183]
  v_mfma_f32_16x16x32_bf16 v[144:147], a[240:243], v[208:211], v[144:147]
  buffer_load_dwordx4 a[116:119], v4, s[16:19], s68 offen offset:3072 sc1
  s_add_u32 s68, s68, 65536
  v_mfma_f32_16x16x32_bf16 v[148:151], a[240:243], v[228:231], v[148:151]
  v_mfma_f32_16x16x32_bf16 v[152:155], a[244:247], v[208:211], v[152:155]
  v_mfma_f32_16x16x32_bf16 v[156:159], a[244:247], v[228:231], v[156:159]
  buffer_load_dwordx2 v[188:189], v14, s[16:19], s48 offen offset:512 sc1
  v_mfma_f32_16x16x32_bf16 v[160:163], a[248:251], v[208:211], v[160:163]
  v_mfma_f32_16x16x32_bf16 v[164:167], a[248:251], v[228:231], v[164:167]
  v_mfma_f32_16x16x32_bf16 v[168:171], a[252:255], v[208:211], v[168:171]
  buffer_load_dwordx4 v[104:107], v4, s[16:19], s47 offen sc1
  v_mfma_f32_16x16x32_bf16 v[172:175], a[252:255], v[228:231], v[172:175]
  v_mfma_f32_16x16x32_bf16 v[176:179], v[252:255], v[208:211], v[176:179]
  v_mfma_f32_16x16x32_bf16 v[180:183], v[252:255], v[228:231], v[180:183]
  buffer_load_dwordx2 v[108:109], v5, s[16:19], s47 offen offset:2048 sc1
  s_add_u32 s47, s47, 13824
  ds_write_b128 v10, v[144:147] offset:40960
  buffer_load_dwordx4 a[120:123], v4, s[16:19], s68 offen offset:0 sc1
  ds_write_b128 v10, v[148:151] offset:41984
  buffer_load_dwordx4 a[124:127], v4, s[16:19], s68 offen offset:1024 sc1
  ds_write_b128 v10, v[152:155] offset:43008
  ds_write_b128 v10, v[156:159] offset:44032
  s_waitcnt vmcnt(40)
  buffer_load_dwordx4 v[52:55], v22, s[16:19], s48 offen offset:1280 sc1
  ds_write_b128 v10, v[160:163] offset:45056
  buffer_load_dwordx4 a[128:131], v4, s[16:19], s70 offen sc1
  s_add_u32 s70, s70, 16384
  ds_write_b128 v10, v[164:167] offset:46080
  buffer_load_dwordx4 a[132:135], v4, s[16:19], s68 offen offset:2048 sc1
  ds_write_b128 v10, v[168:171] offset:47104
  buffer_load_dwordx4 a[136:139], v4, s[16:19], s68 offen offset:3072 sc1
  s_add_u32 s68, s68, 65536
  ds_write_b128 v10, v[172:175] offset:48128
  buffer_load_dwordx4 v[112:115], v4, s[16:19], s47 offen sc1
  s_nop 1
  ds_write_b128 v10, v[176:179] offset:49152
  buffer_load_dwordx2 v[116:117], v5, s[16:19], s47 offen offset:2048 sc1
  ds_write_b128 v10, v[180:183] offset:50176
  buffer_load_dwordx4 v[140:143], v21, s[16:19], s47 offen offset:1024 sc1
  s_add_u32 s47, s47, 2560
  s_waitcnt lgkmcnt(0)
  s_barrier
  ds_read_b32 v23, v30
  s_waitcnt lgkmcnt(0)
  v_readfirstlane_b32 s2, v23
  s_min_u32 s2, s2, 16
  s_cmp_eq_u32 s65, 0
  s_cselect_b32 s2, 17, s2
  buffer_load_dwordx4 a[140:143], v4, s[16:19], s68 offen offset:0 sc1
  s_lshl_b32 s40, s2, 2
  s_add_u32 s40, s40, s58
  s_lshl_b32 s21, s40, 7
  s_add_u32 s21, s21, 8192
  s_xor_b32 s21, s21, s80
  v_mov_b32 v18, s21
  v_cndmask_b32 v18, v17, v18, s[66:67]
  s_add_u32 s21, s40, 1
  v_mov_b32 v19, s21
  v_cndmask_b32 v19, v19, 32, s[66:67]
  buffer_load_dword v27, v18, s[72:75], 0 offen sc1
  buffer_load_dwordx4 a[144:147], v4, s[16:19], s68 offen offset:1024 sc1
  v_sub_f32 v25, 1.0, v24
  v_cvt_pk_bf16_f32 v26, v25, v25
  v_lshlrev_b32 v25, 16, v26
  ds_read_b128 v[144:147], v15 offset:0
  ds_read_b128 v[148:151], v15 offset:10240
  ds_read_b128 v[152:155], v15 offset:20480
  ds_read_b128 v[156:159], v15 offset:30720
  ds_read_b128 v[160:163], v15 offset:2048
  ds_read_b128 v[164:167], v15 offset:12288
  ds_read_b128 v[168:171], v15 offset:22528
  ds_read_b128 v[172:175], v15 offset:32768
  s_waitcnt lgkmcnt(4)
  buffer_load_dwordx4 v[60:63], v28, s[16:19], s48 offen offset:1280 sc1
  v_pk_add_f32 v[144:145], v[144:145], v[148:149]
  v_pk_add_f32 v[152:153], v[152:153], v[156:157]
  v_pk_add_f32 v[146:147], v[146:147], v[150:151]
  v_pk_add_f32 v[154:155], v[154:155], v[158:159]
  v_pk_add_f32 v[176:177], v[144:145], v[152:153]
  v_pk_add_f32 v[178:179], v[146:147], v[154:155]
  ds_read_b128 v[144:147], v16 offset:0
  ds_read_b128 v[148:151], v16 offset:10240
  ds_read_b128 v[152:155], v16 offset:20480
  ds_read_b128 v[156:159], v16 offset:30720
  v_cvt_pk_bf16_f32 v26, v176, v177
  buffer_load_dwordx4 a[148:151], v4, s[16:19], s70 offen sc1
  s_add_u32 s70, s70, 16384
  v_lshlrev_b32 v240, 16, v26
  v_and_b32 v241, 0xffff0000, v26
  v_mul_f32 v240, v240, v25
  v_mul_f32 v241, v241, v25
  v_cvt_pk_bf16_f32 v26, v240, v241
  v_lshlrev_b32 v240, 16, v26
  v_and_b32 v241, 0xffff0000, v26
  v_cvt_pk_bf16_f32 v26, v178, v179
  v_lshlrev_b32 v242, 16, v26
  v_and_b32 v243, 0xffff0000, v26
  v_mul_f32 v242, v242, v25
  buffer_load_dwordx4 a[152:155], v4, s[16:19], s68 offen offset:2048 sc1
  v_mul_f32 v243, v243, v25
  v_cvt_pk_bf16_f32 v26, v242, v243
  v_lshlrev_b32 v242, 16, v26
  v_and_b32 v243, 0xffff0000, v26
  s_waitcnt lgkmcnt(4)
  v_pk_add_f32 v[160:161], v[160:161], v[164:165]
  v_pk_add_f32 v[168:169], v[168:169], v[172:173]
  v_pk_add_f32 v[162:163], v[162:163], v[166:167]
  v_pk_add_f32 v[170:171], v[170:171], v[174:175]
  v_pk_add_f32 v[176:177], v[160:161], v[168:169]
  v_pk_add_f32 v[178:179], v[162:163], v[170:171]
  buffer_load_dwordx4 a[156:159], v4, s[16:19], s68 offen offset:3072 sc1
  s_add_u32 s68, s68, 65536
  v_cvt_pk_bf16_f32 v26, v176, v177
  v_lshlrev_b32 v244, 16, v26
  v_and_b32 v245, 0xffff0000, v26
  v_mul_f32 v244, v244, v25
  v_mul_f32 v245, v245, v25
  v_cvt_pk_bf16_f32 v26, v244, v245
  v_lshlrev_b32 v244, 16, v26
  v_and_b32 v245, 0xffff0000, v26
  v_cvt_pk_bf16_f32 v26, v178, v179
  v_lshlrev_b32 v246, 16, v26
  v_and_b32 v247, 0xffff0000, v26
  buffer_load_dwordx2 v[190:191], v14, s[16:19], s48 offen offset:1792 sc1
  s_add_u32 s48, s48, 262144
  v_mul_f32 v246, v246, v25
  v_mul_f32 v247, v247, v25
  v_cvt_pk_bf16_f32 v26, v246, v247
  v_lshlrev_b32 v246, 16, v26
  v_and_b32 v247, 0xffff0000, v26
  s_waitcnt lgkmcnt(0)
  v_pk_add_f32 v[144:145], v[144:145], v[148:149]
  v_pk_add_f32 v[152:153], v[152:153], v[156:157]
  v_pk_add_f32 v[146:147], v[146:147], v[150:151]
  v_pk_add_f32 v[154:155], v[154:155], v[158:159]
  v_pk_add_f32 v[176:177], v[144:145], v[152:153]
  v_pk_add_f32 v[178:179], v[146:147], v[154:155]
  buffer_load_dwordx4 v[120:123], v4, s[16:19], s47 offen sc1
  v_cvt_pk_bf16_f32 v26, v176, v177
  v_lshlrev_b32 v248, 16, v26
  v_and_b32 v249, 0xffff0000, v26
  v_mul_f32 v248, v248, v25
  v_mul_f32 v249, v249, v25
  v_cvt_pk_bf16_f32 v26, v248, v249
  v_lshlrev_b32 v248, 16, v26
  v_and_b32 v249, 0xffff0000, v26
  v_cvt_pk_bf16_f32 v26, v178, v179
  v_lshlrev_b32 v250, 16, v26
  v_and_b32 v251, 0xffff0000, v26
  buffer_load_dwordx2 v[124:125], v5, s[16:19], s47 offen offset:2048 sc1
  s_add_u32 s47, s47, 13824
  v_mul_f32 v250, v250, v25
  v_mul_f32 v251, v251, v25
  v_cvt_pk_bf16_f32 v26, v250, v251
  v_lshlrev_b32 v250, 16, v26
  v_and_b32 v251, 0xffff0000, v26
  s_barrier
  s_lshl_b32 s55, s40, 19
  s_lshl_b32 s21, s40, 11
  s_and_b32 s21, s21, 8192
  s_xor_b32 s21, s21, s80
  s_add_u32 s55, s55, s21
  s_add_u32 s55, s55, 136314880
  s_lshl_b32 s21, s20, 15
  s_xor_b32 s54, s55, 8192
  s_add_u32 s54, s54, 48234496
  s_add_u32 s54, s54, s21
  s_lshl_b32 s57, s40, 1
  s_add_u32 s57, s57, s43
  s_lshl_b32 s45, s57, 6
  s_add_u32 s69, s54, 262144
  s_cmp_lt_u32 s2, 16
  s_cselect_b32 s69, s69, 0x40000000
  s_cmp_lt_u32 s2, 12
  s_cselect_b32 s65, s87, 0
  s_cmp_gt_u32 s65, 1
  s_cselect_b32 s64, s59, 0x40000000
  s_cselect_b32 s65, 1, 0
  s_waitcnt vmcnt(37)
  v_mfma_f32_16x16x32_bf16 v[148:151], a[0:3], v[64:67], 0
  v_mfma_f32_16x16x32_bf16 v[144:147], a[0:3], v[68:71], 0
  v_mov_b32 v29, 1
  buffer_atomic_add v29, v233, s[72:75], s64 offen sc0 sc1
  v_mfma_f32_16x16x32_bf16 v[156:159], a[4:7], v[64:67], 0
  v_mfma_f32_16x16x32_bf16 v[152:155], a[4:7], v[68:71], 0
  v_mfma_f32_16x16x32_bf16 v[164:167], a[8:11], v[64:67], 0
  v_mfma_f32_16x16x32_bf16 v[160:163], a[8:11], v[68:71], 0
  buffer_load_dword v232, v6, s[28:31], s45 offen sc1
  v_mfma_f32_16x16x32_bf16 v[172:175], a[12:15], v[64:67], 0
  v_mfma_f32_16x16x32_bf16 v[168:171], a[12:15], v[68:71], 0
  v_mfma_f32_16x16x32_bf16 v[180:183], a[16:19], v[64:67], 0
  v_mfma_f32_16x16x32_bf16 v[176:179], a[16:19], v[68:71], 0
  buffer_load_dwordx4 v[192:195], v4, s[16:19], s69 offen offset:0 sc1
  v_mfma_f32_16x16x32_bf16 v[148:151], a[20:23], v[72:75], v[148:151]
  v_mfma_f32_16x16x32_bf16 v[144:147], a[20:23], v[76:79], v[144:147]
  v_mfma_f32_16x16x32_bf16 v[156:159], a[24:27], v[72:75], v[156:159]
  v_mfma_f32_16x16x32_bf16 v[152:155], a[24:27], v[76:79], v[152:155]
  buffer_load_dwordx4 v[196:199], v4, s[16:19], s69 offen offset:1024 sc1
  v_mfma_f32_16x16x32_bf16 v[164:167], a[28:31], v[72:75], v[164:167]
  v_mfma_f32_16x16x32_bf16 v[160:163], a[28:31], v[76:79], v[160:163]
  v_mfma_f32_16x16x32_bf16 v[172:175], a[32:35], v[72:75], v[172:175]
  buffer_load_dwordx2 v[208:209], v5, s[16:19], s69 offen offset:2048 sc1
  s_add_u32 s69, s69, 2560
  v_mfma_f32_16x16x32_bf16 v[168:171], a[32:35], v[76:79], v[168:171]
  v_mfma_f32_16x16x32_bf16 v[180:183], a[36:39], v[72:75], v[180:183]
  v_mfma_f32_16x16x32_bf16 v[176:179], a[36:39], v[76:79], v[176:179]
  v_mfma_f32_16x16x32_bf16 v[148:151], a[40:43], v[80:83], v[148:151]
  buffer_load_dwordx4 v[200:203], v4, s[16:19], s69 offen offset:0 sc1
  v_mfma_f32_16x16x32_bf16 v[144:147], a[40:43], v[84:87], v[144:147]
  v_mfma_f32_16x16x32_bf16 v[156:159], a[44:47], v[80:83], v[156:159]
  v_mfma_f32_16x16x32_bf16 v[152:155], a[44:47], v[84:87], v[152:155]
  v_mfma_f32_16x16x32_bf16 v[164:167], a[48:51], v[80:83], v[164:167]
  buffer_load_dwordx4 v[204:207], v4, s[16:19], s69 offen offset:1024 sc1
  v_mfma_f32_16x16x32_bf16 v[160:163], a[48:51], v[84:87], v[160:163]
  v_mfma_f32_16x16x32_bf16 v[172:175], a[52:55], v[80:83], v[172:175]
  v_mfma_f32_16x16x32_bf16 v[168:171], a[52:55], v[84:87], v[168:171]
  buffer_load_dwordx2 v[210:211], v5, s[16:19], s69 offen offset:2048 sc1
  s_add_u32 s69, s69, 13824
  v_mfma_f32_16x16x32_bf16 v[180:183], a[56:59], v[80:83], v[180:183]
  v_mfma_f32_16x16x32_bf16 v[176:179], a[56:59], v[84:87], v[176:179]
  v_mfma_f32_16x16x32_bf16 v[148:151], a[60:63], v[88:91], v[148:151]
  v_mfma_f32_16x16x32_bf16 v[144:147], a[60:63], v[92:95], v[144:147]
  buffer_load_dwordx4 v[212:215], v4, s[16:19], s69 offen offset:0 sc1
  v_mfma_f32_16x16x32_bf16 v[156:159], a[64:67], v[88:91], v[156:159]
  v_mfma_f32_16x16x32_bf16 v[152:155], a[64:67], v[92:95], v[152:155]
  v_mfma_f32_16x16x32_bf16 v[164:167], a[68:71], v[88:91], v[164:167]
  v_mfma_f32_16x16x32_bf16 v[160:163], a[68:71], v[92:95], v[160:163]
  buffer_load_dwordx4 v[216:219], v4, s[16:19], s69 offen offset:1024 sc1
  v_mfma_f32_16x16x32_bf16 v[172:175], a[72:75], v[88:91], v[172:175]
  v_mfma_f32_16x16x32_bf16 v[168:171], a[72:75], v[92:95], v[168:171]
  v_mfma_f32_16x16x32_bf16 v[180:183], a[76:79], v[88:91], v[180:183]
  v_mfma_f32_16x16x32_bf16 v[176:179], a[76:79], v[92:95], v[176:179]
  buffer_load_dwordx2 v[228:229], v5, s[16:19], s69 offen offset:2048 sc1
  s_add_u32 s69, s69, 2560
  v_swap_b32 v130, v132
  v_swap_b32 v131, v133
  v_swap_b32 v34, v36
  v_swap_b32 v35, v37
  v_swap_b32 v42, v44
  v_swap_b32 v43, v45
  s_nop 1
  v_mfma_f32_16x16x32_bf16 v[144:147], v[32:35], v[128:131], v[144:147]
  v_mfma_f32_16x16x32_bf16 v[148:151], v[32:35], v[132:135], v[148:151]
  buffer_load_dwordx4 v[220:223], v4, s[16:19], s69 offen offset:0 sc1
  v_mfma_f32_16x16x32_bf16 v[152:155], v[36:39], v[128:131], v[152:155]
  v_mfma_f32_16x16x32_bf16 v[156:159], v[36:39], v[132:135], v[156:159]
  v_mfma_f32_16x16x32_bf16 v[160:163], v[184:187], v[128:131], v[160:163]
  buffer_load_dwordx4 v[224:227], v4, s[16:19], s69 offen offset:1024 sc1
  v_mfma_f32_16x16x32_bf16 v[164:167], v[184:187], v[132:135], v[164:167]
  v_mfma_f32_16x16x32_bf16 v[168:171], v[40:43], v[128:131], v[168:171]
  v_mfma_f32_16x16x32_bf16 v[172:175], v[40:43], v[132:135], v[172:175]
  v_mfma_f32_16x16x32_bf16 v[176:179], v[44:47], v[128:131], v[176:179]
  buffer_load_dwordx2 v[230:231], v5, s[16:19], s69 offen offset:2048 sc1
  s_add_u32 s69, s69, 13824
  v_mfma_f32_16x16x32_bf16 v[180:183], v[44:47], v[132:135], v[180:183]
  s_waitcnt vmcnt(22)
  v_cmp_gt_u32 vcc, v19, v27
  s_cmp_le_u32 s50, s40
  s_cbranch_scc1 pv_322
  s_cbranch_vccnz pv_322
  s_lshl_b32 s61, s40, 21
  s_lshl_b32 s21, s40, 13
  s_and_b32 s21, s21, 8192
  s_xor_b32 s21, s21, s80
  s_add_u32 s61, s61, s21
  s_lshl_b32 s21, s20, 15
  s_add_u32 s47, s54, s21
  s_add_u32 s48, s61, s60
  s_xor_b32 s68, s61, 8192
  s_add_u32 s68, s68, s53
  s_add_u32 s70, s55, s42
  s_xor_b32 s70, s70, 0
  s_waitcnt vmcnt(42)
  v_mfma_f32_16x16x32_bf16 v[148:151], a[80:83], v[96:99], v[148:151]
  v_mfma_f32_16x16x32_bf16 v[144:147], a[80:83], v[100:103], v[144:147]
  buffer_load_dwordx4 a[0:3], v4, s[16:19], s68 offen offset:0 sc1
  v_mfma_f32_16x16x32_bf16 v[156:159], a[84:87], v[96:99], v[156:159]
  v_mfma_f32_16x16x32_bf16 v[152:155], a[84:87], v[100:103], v[152:155]
  v_mfma_f32_16x16x32_bf16 v[164:167], a[88:91], v[96:99], v[164:167]
  buffer_load_dwordx4 a[4:7], v4, s[16:19], s68 offen offset:1024 sc1
  v_mfma_f32_16x16x32_bf16 v[160:163], a[88:91], v[100:103], v[160:163]
  v_mfma_f32_16x16x32_bf16 v[172:175], a[92:95], v[96:99], v[172:175]
  v_mfma_f32_16x16x32_bf16 v[168:171], a[92:95], v[100:103], v[168:171]
  buffer_load_dwordx4 v[32:35], v22, s[16:19], s48 offen offset:0 sc1
  v_mfma_f32_16x16x32_bf16 v[180:183], a[96:99], v[96:99], v[180:183]
  v_mfma_f32_16x16x32_bf16 v[176:179], a[96:99], v[100:103], v[176:179]
  s_waitcnt vmcnt(36)
  v_mfma_f32_16x16x32_bf16 v[148:151], a[100:103], v[104:107], v[148:151]
  buffer_load_dwordx4 a[8:11], v4, s[16:19], s70 offen sc1
  s_add_u32 s70, s70, 16384
  v_mfma_f32_16x16x32_bf16 v[144:147], a[100:103], v[108:111], v[144:147]
  v_mfma_f32_16x16x32_bf16 v[156:159], a[104:107], v[104:107], v[156:159]
  v_mfma_f32_16x16x32_bf16 v[152:155], a[104:107], v[108:111], v[152:155]
  buffer_load_dwordx4 a[12:15], v4, s[16:19], s68 offen offset:2048 sc1
  v_mfma_f32_16x16x32_bf16 v[164:167], a[108:111], v[104:107], v[164:167]
  v_mfma_f32_16x16x32_bf16 v[160:163], a[108:111], v[108:111], v[160:163]
  buffer_load_dwordx4 a[16:19], v4, s[16:19], s68 offen offset:3072 sc1
  s_add_u32 s68, s68, 65536
  v_mfma_f32_16x16x32_bf16 v[172:175], a[112:115], v[104:107], v[172:175]
  v_mfma_f32_16x16x32_bf16 v[168:171], a[112:115], v[108:111], v[168:171]
  v_mfma_f32_16x16x32_bf16 v[180:183], a[116:119], v[104:107], v[180:183]
  buffer_load_dwordx4 v[64:67], v4, s[16:19], s47 offen sc1
  v_mfma_f32_16x16x32_bf16 v[176:179], a[116:119], v[108:111], v[176:179]
  s_waitcnt vmcnt(31)
  v_mfma_f32_16x16x32_bf16 v[148:151], a[120:123], v[112:115], v[148:151]
  v_mfma_f32_16x16x32_bf16 v[144:147], a[120:123], v[116:119], v[144:147]
  buffer_load_dwordx2 v[68:69], v5, s[16:19], s47 offen offset:2048 sc1
  v_mfma_f32_16x16x32_bf16 v[156:159], a[124:127], v[112:115], v[156:159]
  v_mfma_f32_16x16x32_bf16 v[152:155], a[124:127], v[116:119], v[152:155]
  v_mfma_f32_16x16x32_bf16 v[164:167], a[128:131], v[112:115], v[164:167]
  buffer_load_dwordx4 v[128:131], v21, s[16:19], s47 offen offset:1024 sc1
  s_add_u32 s47, s47, 2560
  v_mfma_f32_16x16x32_bf16 v[160:163], a[128:131], v[116:119], v[160:163]
  v_mfma_f32_16x16x32_bf16 v[172:175], a[132:135], v[112:115], v[172:175]
  v_mfma_f32_16x16x32_bf16 v[168:171], a[132:135], v[116:119], v[168:171]
  buffer_load_dwordx4 a[20:23], v4, s[16:19], s68 offen offset:0 sc1
  v_mfma_f32_16x16x32_bf16 v[180:183], a[136:139], v[112:115], v[180:183]
  v_mfma_f32_16x16x32_bf16 v[176:179], a[136:139], v[116:119], v[176:179]
  s_waitcnt vmcnt(24)
  v_mfma_f32_16x16x32_bf16 v[148:151], a[140:143], v[120:123], v[148:151]
  buffer_load_dwordx4 a[24:27], v4, s[16:19], s68 offen offset:1024 sc1
  v_mfma_f32_16x16x32_bf16 v[144:147], a[140:143], v[124:127], v[144:147]
  v_mfma_f32_16x16x32_bf16 v[156:159], a[144:147], v[120:123], v[156:159]
  v_mfma_f32_16x16x32_bf16 v[152:155], a[144:147], v[124:127], v[152:155]
  buffer_load_dwordx4 v[40:43], v28, s[16:19], s48 offen offset:0 sc1
  v_mfma_f32_16x16x32_bf16 v[164:167], a[148:151], v[120:123], v[164:167]
  v_mfma_f32_16x16x32_bf16 v[160:163], a[148:151], v[124:127], v[160:163]
  v_mfma_f32_16x16x32_bf16 v[172:175], a[152:155], v[120:123], v[172:175]
  buffer_load_dwordx4 a[28:31], v4, s[16:19], s70 offen sc1
  s_add_u32 s70, s70, 16384
  v_mfma_f32_16x16x32_bf16 v[168:171], a[152:155], v[124:127], v[168:171]
  v_mfma_f32_16x16x32_bf16 v[180:183], a[156:159], v[120:123], v[180:183]
  v_mfma_f32_16x16x32_bf16 v[176:179], a[156:159], v[124:127], v[176:179]
  buffer_load_dwordx4 a[32:35], v4, s[16:19], s68 offen offset:2048 sc1
  v_swap_b32 v138, v140
  v_swap_b32 v139, v141
  v_swap_b32 v50, v52
  v_swap_b32 v51, v53
  v_swap_b32 v58, v60
  v_swap_b32 v59, v61
  s_nop 1
  v_mfma_f32_16x16x32_bf16 v[144:147], v[48:51], v[136:139], v[144:147]
  buffer_load_dwordx4 a[36:39], v4, s[16:19], s68 offen offset:3072 sc1
  s_add_u32 s68, s68, 65536
  v_mfma_f32_16x16x32_bf16 v[148:151], v[48:51], v[140:143], v[148:151]
  v_mfma_f32_16x16x32_bf16 v[152:155], v[52:55], v[136:139], v[152:155]
  v_mfma_f32_16x16x32_bf16 v[156:159], v[52:55], v[140:143], v[156:159]
  buffer_load_dwordx2 v[184:185], v14, s[16:19], s48 offen offset:512 sc1
  v_mfma_f32_16x16x32_bf16 v[160:163], v[188:191], v[136:139], v[160:163]
  v_mfma_f32_16x16x32_bf16 v[164:167], v[188:191], v[140:143], v[164:167]
  v_mfma_f32_16x16x32_bf16 v[168:171], v[56:59], v[136:139], v[168:171]
  buffer_load_dwordx4 v[72:75], v4, s[16:19], s47 offen sc1
  v_mfma_f32_16x16x32_bf16 v[172:175], v[56:59], v[140:143], v[172:175]
  v_mfma_f32_16x16x32_bf16 v[176:179], v[60:63], v[136:139], v[176:179]
  v_mfma_f32_16x16x32_bf16 v[180:183], v[60:63], v[140:143], v[180:183]
  buffer_load_dwordx2 v[76:77], v5, s[16:19], s47 offen offset:2048 sc1
  s_add_u32 s47, s47, 13824
  s_nop 0
  ds_write_b128 v10, v[144:147] offset:0
  buffer_load_dwordx4 a[40:43], v4, s[16:19], s68 offen offset:0 sc1
  ds_write_b128 v10, v[148:151] offset:1024
  buffer_load_dwordx4 a[44:47], v4, s[16:19], s68 offen offset:1024 sc1
  ds_write_b128 v10, v[152:155] offset:2048
  ds_write_b128 v10, v[156:159] offset:3072
  buffer_load_dwordx4 v[36:39], v22, s[16:19], s48 offen offset:1280 sc1
  ds_write_b128 v10, v[160:163] offset:4096
  buffer_load_dwordx4 a[48:51], v4, s[16:19], s70 offen sc1
  s_add_u32 s70, s70, 16384
  ds_write_b128 v10, v[164:167] offset:5120
  buffer_load_dwordx4 a[52:55], v4, s[16:19], s68 offen offset:2048 sc1
  ds_write_b128 v10, v[168:171] offset:6144
  buffer_load_dwordx4 a[56:59], v4, s[16:19], s68 offen offset:3072 sc1
  s_add_u32 s68, s68, 65536
  ds_write_b128 v10, v[172:175] offset:7168
  buffer_load_dwordx4 v[80:83], v4, s[16:19], s47 offen sc1
  s_nop 1
  ds_write_b128 v10, v[176:179] offset:8192
  buffer_load_dwordx2 v[84:85], v5, s[16:19], s47 offen offset:2048 sc1
  ds_write_b128 v10, v[180:183] offset:9216
  buffer_load_dwordx4 v[132:135], v21, s[16:19], s47 offen offset:1024 sc1
  s_add_u32 s47, s47, 2560
  s_waitcnt lgkmcnt(0)
  s_barrier
  ds_read_b128 v[144:147], v11 offset:0
  ds_read_b128 v[148:151], v11 offset:10240
  ds_read_b128 v[152:155], v11 offset:20480
  ds_read_b128 v[156:159], v11 offset:30720
  ds_read_b128 v[160:163], v11 offset:2048
  ds_read_b128 v[164:167], v11 offset:12288
  ds_read_b128 v[168:171], v11 offset:22528
  ds_read_b128 v[172:175], v11 offset:32768
  s_waitcnt lgkmcnt(4)
  buffer_load_dwordx4 a[60:63], v4, s[16:19], s68 offen offset:0 sc1
  v_pk_add_f32 v[144:145], v[144:145], v[148:149]
  v_pk_add_f32 v[152:153], v[152:153], v[156:157]
  v_pk_add_f32 v[146:147], v[146:147], v[150:151]
  v_pk_add_f32 v[154:155], v[154:155], v[158:159]
  v_pk_add_f32 v[176:177], v[144:145], v[152:153]
  v_pk_add_f32 v[178:179], v[146:147], v[154:155]
  ds_read_b128 v[144:147], v12 offset:0
  ds_read_b128 v[148:151], v12 offset:10240
  ds_read_b128 v[152:155], v12 offset:20480
  ds_read_b128 v[156:159], v12 offset:30720
  v_cvt_pk_bf16_f32 v26, v176, v177
  buffer_load_dwordx4 a[64:67], v4, s[16:19], s68 offen offset:1024 sc1
  v_lshlrev_b32 v176, 16, v26
  v_and_b32 v177, 0xffff0000, v26
  v_mul_f32 v176, v176, v24
  v_mul_f32 v177, v177, v24
  v_cvt_pk_bf16_f32 v26, v176, v177
  v_lshlrev_b32 v176, 16, v26
  v_and_b32 v177, 0xffff0000, v26
  v_add_f32 v176, v176, v240
  v_add_f32 v177, v177, v241
  v_cvt_pk_bf16_f32 v236, v176, v177
  v_cvt_pk_bf16_f32 v26, v178, v179
  v_lshlrev_b32 v178, 16, v26
  buffer_load_dwordx4 v[44:47], v28, s[16:19], s48 offen offset:1280 sc1
  v_and_b32 v179, 0xffff0000, v26
  v_mul_f32 v178, v178, v24
  v_mul_f32 v179, v179, v24
  v_cvt_pk_bf16_f32 v26, v178, v179
  v_lshlrev_b32 v178, 16, v26
  v_and_b32 v179, 0xffff0000, v26
  v_add_f32 v178, v178, v242
  v_add_f32 v179, v179, v243
  v_cvt_pk_bf16_f32 v237, v178, v179
  s_waitcnt lgkmcnt(4)
  v_pk_add_f32 v[160:161], v[160:161], v[164:165]
  v_pk_add_f32 v[168:169], v[168:169], v[172:173]
  buffer_load_dwordx4 a[68:71], v4, s[16:19], s70 offen sc1
  s_add_u32 s70, s70, 16384
  v_pk_add_f32 v[162:163], v[162:163], v[166:167]
  v_pk_add_f32 v[170:171], v[170:171], v[174:175]
  v_pk_add_f32 v[176:177], v[160:161], v[168:169]
  v_pk_add_f32 v[178:179], v[162:163], v[170:171]
  v_cvt_pk_bf16_f32 v26, v176, v177
  v_lshlrev_b32 v176, 16, v26
  v_and_b32 v177, 0xffff0000, v26
  v_mul_f32 v176, v176, v24
  v_mul_f32 v177, v177, v24
  v_cvt_pk_bf16_f32 v26, v176, v177
  v_lshlrev_b32 v176, 16, v26
  buffer_load_dwordx4 a[72:75], v4, s[16:19], s68 offen offset:2048 sc1
  v_and_b32 v177, 0xffff0000, v26
  v_add_f32 v176, v176, v244
  v_add_f32 v177, v177, v245
  v_cvt_pk_bf16_f32 v238, v176, v177
  v_cvt_pk_bf16_f32 v26, v178, v179
  v_lshlrev_b32 v178, 16, v26
  v_and_b32 v179, 0xffff0000, v26
  v_mul_f32 v178, v178, v24
  v_mul_f32 v179, v179, v24
  v_cvt_pk_bf16_f32 v26, v178, v179
  v_lshlrev_b32 v178, 16, v26
  v_and_b32 v179, 0xffff0000, v26
  buffer_load_dwordx4 a[76:79], v4, s[16:19], s68 offen offset:3072 sc1
  s_add_u32 s68, s68, 65536
  v_add_f32 v178, v178, v246
  v_add_f32 v179, v179, v247
  v_cvt_pk_bf16_f32 v239, v178, v179
  buffer_store_dwordx4 v[236:239], v9, s[8:11], s46 offen
  s_cmp_lt_u32 s20, 2
  s_cselect_b32 s49, s49, 0x40000000
  s_waitcnt lgkmcnt(0)
  v_pk_add_f32 v[144:145], v[144:145], v[148:149]
  v_pk_add_f32 v[152:153], v[152:153], v[156:157]
  v_pk_add_f32 v[146:147], v[146:147], v[150:151]
  v_pk_add_f32 v[154:155], v[154:155], v[158:159]
  buffer_load_dwordx2 v[186:187], v14, s[16:19], s48 offen offset:1792 sc1
  s_add_u32 s48, s48, 262144
  v_pk_add_f32 v[176:177], v[144:145], v[152:153]
  v_pk_add_f32 v[178:179], v[146:147], v[154:155]
  v_cvt_pk_bf16_f32 v26, v176, v177
  v_lshlrev_b32 v176, 16, v26
  v_and_b32 v177, 0xffff0000, v26
  v_mul_f32 v176, v176, v24
  v_mul_f32 v177, v177, v24
  v_cvt_pk_bf16_f32 v26, v176, v177
  v_lshlrev_b32 v176, 16, v26
  v_and_b32 v177, 0xffff0000, v26
  v_add_f32 v176, v176, v248
  v_add_f32 v177, v177, v249
  buffer_load_dwordx4 v[88:91], v4, s[16:19], s47 offen sc1
  v_cvt_pk_bf16_f32 v234, v176, v177
  v_cvt_pk_bf16_f32 v26, v178, v179
  v_lshlrev_b32 v178, 16, v26
  v_and_b32 v179, 0xffff0000, v26
  v_mul_f32 v178, v178, v24
  v_mul_f32 v179, v179, v24
  v_cvt_pk_bf16_f32 v26, v178, v179
  v_lshlrev_b32 v178, 16, v26
  v_and_b32 v179, 0xffff0000, v26
  v_add_f32 v178, v178, v250
  v_add_f32 v179, v179, v251
  v_cvt_pk_bf16_f32 v235, v178, v179
  buffer_load_dwordx2 v[92:93], v5, s[16:19], s47 offen offset:2048 sc1
  s_add_u32 s47, s47, 13824
  buffer_store_dwordx2 v[234:235], v13, s[8:11], s49 offen offset:64
  s_branch pv_loop
pv_322:
  s_waitcnt vmcnt(42)
  v_mfma_f32_16x16x32_bf16 v[148:151], a[80:83], v[96:99], v[148:151]
  v_mfma_f32_16x16x32_bf16 v[144:147], a[80:83], v[100:103], v[144:147]
  v_mfma_f32_16x16x32_bf16 v[156:159], a[84:87], v[96:99], v[156:159]
  v_mfma_f32_16x16x32_bf16 v[152:155], a[84:87], v[100:103], v[152:155]
  v_mfma_f32_16x16x32_bf16 v[164:167], a[88:91], v[96:99], v[164:167]
  v_mfma_f32_16x16x32_bf16 v[160:163], a[88:91], v[100:103], v[160:163]
  v_mfma_f32_16x16x32_bf16 v[172:175], a[92:95], v[96:99], v[172:175]
  v_mfma_f32_16x16x32_bf16 v[168:171], a[92:95], v[100:103], v[168:171]
  v_mfma_f32_16x16x32_bf16 v[180:183], a[96:99], v[96:99], v[180:183]
  v_mfma_f32_16x16x32_bf16 v[176:179], a[96:99], v[100:103], v[176:179]
  s_waitcnt vmcnt(33)
  v_mfma_f32_16x16x32_bf16 v[148:151], a[100:103], v[104:107], v[148:151]
  v_mfma_f32_16x16x32_bf16 v[144:147], a[100:103], v[108:111], v[144:147]
  v_mfma_f32_16x16x32_bf16 v[156:159], a[104:107], v[104:107], v[156:159]
  v_mfma_f32_16x16x32_bf16 v[152:155], a[104:107], v[108:111], v[152:155]
  v_mfma_f32_16x16x32_bf16 v[164:167], a[108:111], v[104:107], v[164:167]
  v_mfma_f32_16x16x32_bf16 v[160:163], a[108:111], v[108:111], v[160:163]
  v_mfma_f32_16x16x32_bf16 v[172:175], a[112:115], v[104:107], v[172:175]
  v_mfma_f32_16x16x32_bf16 v[168:171], a[112:115], v[108:111], v[168:171]
  v_mfma_f32_16x16x32_bf16 v[180:183], a[116:119], v[104:107], v[180:183]
  v_mfma_f32_16x16x32_bf16 v[176:179], a[116:119], v[108:111], v[176:179]
  s_waitcnt vmcnt(24)
  v_mfma_f32_16x16x32_bf16 v[148:151], a[120:123], v[112:115], v[148:151]
  v_mfma_f32_16x16x32_bf16 v[144:147], a[120:123], v[116:119], v[144:147]
  v_mfma_f32_16x16x32_bf16 v[156:159], a[124:127], v[112:115], v[156:159]
  v_mfma_f32_16x16x32_bf16 v[152:155], a[124:127], v[116:119], v[152:155]
  v_mfma_f32_16x16x32_bf16 v[164:167], a[128:131], v[112:115], v[164:167]
  v_mfma_f32_16x16x32_bf16 v[160:163], a[128:131], v[116:119], v[160:163]
  v_mfma_f32_16x16x32_bf16 v[172:175], a[132:135], v[112:115], v[172:175]
  v_mfma_f32_16x16x32_bf16 v[168:171], a[132:135], v[116:119], v[168:171]
  v_mfma_f32_16x16x32_bf16 v[180:183], a[136:139], v[112:115], v[180:183]
  v_mfma_f32_16x16x32_bf16 v[176:179], a[136:139], v[116:119], v[176:179]
  s_waitcnt vmcnt(14)
  v_mfma_f32_16x16x32_bf16 v[148:151], a[140:143], v[120:123], v[148:151]
  v_mfma_f32_16x16x32_bf16 v[144:147], a[140:143], v[124:127], v[144:147]
  v_mfma_f32_16x16x32_bf16 v[156:159], a[144:147], v[120:123], v[156:159]
  v_mfma_f32_16x16x32_bf16 v[152:155], a[144:147], v[124:127], v[152:155]
  v_mfma_f32_16x16x32_bf16 v[164:167], a[148:151], v[120:123], v[164:167]
  v_mfma_f32_16x16x32_bf16 v[160:163], a[148:151], v[124:127], v[160:163]
  v_mfma_f32_16x16x32_bf16 v[172:175], a[152:155], v[120:123], v[172:175]
  v_mfma_f32_16x16x32_bf16 v[168:171], a[152:155], v[124:127], v[168:171]
  v_mfma_f32_16x16x32_bf16 v[180:183], a[156:159], v[120:123], v[180:183]
  v_mfma_f32_16x16x32_bf16 v[176:179], a[156:159], v[124:127], v[176:179]
  v_swap_b32 v138, v140
  v_swap_b32 v139, v141
  v_swap_b32 v50, v52
  v_swap_b32 v51, v53
  v_swap_b32 v58, v60
  v_swap_b32 v59, v61
  s_nop 1
  v_mfma_f32_16x16x32_bf16 v[144:147], v[48:51], v[136:139], v[144:147]
  v_mfma_f32_16x16x32_bf16 v[148:151], v[48:51], v[140:143], v[148:151]
  v_mfma_f32_16x16x32_bf16 v[152:155], v[52:55], v[136:139], v[152:155]
  v_mfma_f32_16x16x32_bf16 v[156:159], v[52:55], v[140:143], v[156:159]
  v_mfma_f32_16x16x32_bf16 v[160:163], v[188:191], v[136:139], v[160:163]
  v_mfma_f32_16x16x32_bf16 v[164:167], v[188:191], v[140:143], v[164:167]
  v_mfma_f32_16x16x32_bf16 v[168:171], v[56:59], v[136:139], v[168:171]
  v_mfma_f32_16x16x32_bf16 v[172:175], v[56:59], v[140:143], v[172:175]
  v_mfma_f32_16x16x32_bf16 v[176:179], v[60:63], v[136:139], v[176:179]
  v_mfma_f32_16x16x32_bf16 v[180:183], v[60:63], v[140:143], v[180:183]
  s_branch pve_317
pvw_316:
  v_mfma_f32_16x16x32_bf16 v[144:147], a[160:163], v[192:195], 0
  v_mfma_f32_16x16x32_bf16 v[148:151], a[160:163], v[212:215], 0
  v_mfma_f32_16x16x32_bf16 v[152:155], a[164:167], v[192:195], 0
  v_mfma_f32_16x16x32_bf16 v[156:159], a[164:167], v[212:215], 0
  v_mfma_f32_16x16x32_bf16 v[160:163], a[168:171], v[192:195], 0
  v_mfma_f32_16x16x32_bf16 v[164:167], a[168:171], v[212:215], 0
  v_mfma_f32_16x16x32_bf16 v[168:171], a[172:175], v[192:195], 0
  v_mfma_f32_16x16x32_bf16 v[172:175], a[172:175], v[212:215], 0
  v_mfma_f32_16x16x32_bf16 v[176:179], a[176:179], v[192:195], 0
  v_mfma_f32_16x16x32_bf16 v[180:183], a[176:179], v[212:215], 0
  v_mfma_f32_16x16x32_bf16 v[144:147], a[180:183], v[196:199], v[144:147]
  v_mfma_f32_16x16x32_bf16 v[148:151], a[180:183], v[216:219], v[148:151]
  v_mfma_f32_16x16x32_bf16 v[152:155], a[184:187], v[196:199], v[152:155]
  v_mfma_f32_16x16x32_bf16 v[156:159], a[184:187], v[216:219], v[156:159]
  v_mfma_f32_16x16x32_bf16 v[160:163], a[188:191], v[196:199], v[160:163]
  v_mfma_f32_16x16x32_bf16 v[164:167], a[188:191], v[216:219], v[164:167]
  v_mfma_f32_16x16x32_bf16 v[168:171], a[192:195], v[196:199], v[168:171]
  v_mfma_f32_16x16x32_bf16 v[172:175], a[192:195], v[216:219], v[172:175]
  v_mfma_f32_16x16x32_bf16 v[176:179], a[196:199], v[196:199], v[176:179]
  v_mfma_f32_16x16x32_bf16 v[180:183], a[196:199], v[216:219], v[180:183]
  v_mfma_f32_16x16x32_bf16 v[144:147], a[200:203], v[200:203], v[144:147]
  v_mfma_f32_16x16x32_bf16 v[148:151], a[200:203], v[220:223], v[148:151]
  v_mfma_f32_16x16x32_bf16 v[152:155], a[204:207], v[200:203], v[152:155]
  v_mfma_f32_16x16x32_bf16 v[156:159], a[204:207], v[220:223], v[156:159]
  v_mfma_f32_16x16x32_bf16 v[160:163], a[208:211], v[200:203], v[160:163]
  v_mfma_f32_16x16x32_bf16 v[164:167], a[208:211], v[220:223], v[164:167]
  v_mfma_f32_16x16x32_bf16 v[168:171], a[212:215], v[200:203], v[168:171]
  v_mfma_f32_16x16x32_bf16 v[172:175], a[212:215], v[220:223], v[172:175]
  v_mfma_f32_16x16x32_bf16 v[176:179], a[216:219], v[200:203], v[176:179]
  v_mfma_f32_16x16x32_bf16 v[180:183], a[216:219], v[220:223], v[180:183]
  v_mfma_f32_16x16x32_bf16 v[144:147], a[220:223], v[204:207], v[144:147]
  v_mfma_f32_16x16x32_bf16 v[148:151], a[220:223], v[224:227], v[148:151]
  v_mfma_f32_16x16x32_bf16 v[152:155], a[224:227], v[204:207], v[152:155]
  v_mfma_f32_16x16x32_bf16 v[156:159], a[224:227], v[224:227], v[156:159]
  v_mfma_f32_16x16x32_bf16 v[160:163], a[228:231], v[204:207], v[160:163]
  v_mfma_f32_16x16x32_bf16 v[164:167], a[228:231], v[224:227], v[164:167]
  v_mfma_f32_16x16x32_bf16 v[168:171], a[232:235], v[204:207], v[168:171]
  v_mfma_f32_16x16x32_bf16 v[172:175], a[232:235], v[224:227], v[172:175]
  v_mfma_f32_16x16x32_bf16 v[176:179], a[236:239], v[204:207], v[176:179]
  v_mfma_f32_16x16x32_bf16 v[180:183], a[236:239], v[224:227], v[180:183]
  v_mfma_f32_16x16x32_bf16 v[144:147], a[240:243], v[208:211], v[144:147]
  v_mfma_f32_16x16x32_bf16 v[148:151], a[240:243], v[228:231], v[148:151]
  v_mfma_f32_16x16x32_bf16 v[152:155], a[244:247], v[208:211], v[152:155]
  v_mfma_f32_16x16x32_bf16 v[156:159], a[244:247], v[228:231], v[156:159]
  v_mfma_f32_16x16x32_bf16 v[160:163], a[248:251], v[208:211], v[160:163]
  v_mfma_f32_16x16x32_bf16 v[164:167], a[248:251], v[228:231], v[164:167]
  v_mfma_f32_16x16x32_bf16 v[168:171], a[252:255], v[208:211], v[168:171]
  v_mfma_f32_16x16x32_bf16 v[172:175], a[252:255], v[228:231], v[172:175]
  v_mfma_f32_16x16x32_bf16 v[176:179], v[252:255], v[208:211], v[176:179]
  v_mfma_f32_16x16x32_bf16 v[180:183], v[252:255], v[228:231], v[180:183]
  ds_write_b128 v10, v[144:147] offset:40960
  ds_write_b128 v10, v[148:151] offset:41984
  ds_write_b128 v10, v[152:155] offset:43008
  ds_write_b128 v10, v[156:159] offset:44032
  ds_write_b128 v10, v[160:163] offset:45056
  ds_write_b128 v10, v[164:167] offset:46080
  ds_write_b128 v10, v[168:171] offset:47104
  ds_write_b128 v10, v[172:175] offset:48128
  s_nop 1
  ds_write_b128 v10, v[176:179] offset:49152
  ds_write_b128 v10, v[180:183] offset:50176
  s_waitcnt lgkmcnt(0)
  s_barrier
  ds_read_b32 v23, v30
  s_waitcnt lgkmcnt(0)
  v_readfirstlane_b32 s2, v23
  s_min_u32 s2, s2, 16
  s_cmp_eq_u32 s65, 0
  s_cselect_b32 s2, 17, s2
  v_sub_f32 v25, 1.0, v24
  v_cvt_pk_bf16_f32 v26, v25, v25
  v_lshlrev_b32 v25, 16, v26
  ds_read_b128 v[144:147], v15 offset:0
  ds_read_b128 v[148:151], v15 offset:10240
  ds_read_b128 v[152:155], v15 offset:20480
  ds_read_b128 v[156:159], v15 offset:30720
  ds_read_b128 v[160:163], v15 offset:2048
  ds_read_b128 v[164:167], v15 offset:12288
  ds_read_b128 v[168:171], v15 offset:22528
  ds_read_b128 v[172:175], v15 offset:32768
  s_waitcnt lgkmcnt(4)
  v_pk_add_f32 v[144:145], v[144:145], v[148:149]
  v_pk_add_f32 v[152:153], v[152:153], v[156:157]
  v_pk_add_f32 v[146:147], v[146:147], v[150:151]
  v_pk_add_f32 v[154:155], v[154:155], v[158:159]
  v_pk_add_f32 v[176:177], v[144:145], v[152:153]
  v_pk_add_f32 v[178:179], v[146:147], v[154:155]
  ds_read_b128 v[144:147], v16 offset:0
  ds_read_b128 v[148:151], v16 offset:10240
  ds_read_b128 v[152:155], v16 offset:20480
  ds_read_b128 v[156:159], v16 offset:30720
  v_cvt_pk_bf16_f32 v26, v176, v177
  v_lshlrev_b32 v240, 16, v26
  v_and_b32 v241, 0xffff0000, v26
  v_mul_f32 v240, v240, v25
  v_mul_f32 v241, v241, v25
  v_cvt_pk_bf16_f32 v26, v240, v241
  v_lshlrev_b32 v240, 16, v26
  v_and_b32 v241, 0xffff0000, v26
  v_cvt_pk_bf16_f32 v26, v178, v179
  v_lshlrev_b32 v242, 16, v26
  v_and_b32 v243, 0xffff0000, v26
  v_mul_f32 v242, v242, v25
  v_mul_f32 v243, v243, v25
  v_cvt_pk_bf16_f32 v26, v242, v243
  v_lshlrev_b32 v242, 16, v26
  v_and_b32 v243, 0xffff0000, v26
  s_waitcnt lgkmcnt(4)
  v_pk_add_f32 v[160:161], v[160:161], v[164:165]
  v_pk_add_f32 v[168:169], v[168:169], v[172:173]
  v_pk_add_f32 v[162:163], v[162:163], v[166:167]
  v_pk_add_f32 v[170:171], v[170:171], v[174:175]
  v_pk_add_f32 v[176:177], v[160:161], v[168:169]
  v_pk_add_f32 v[178:179], v[162:163], v[170:171]
  v_cvt_pk_bf16_f32 v26, v176, v177
  v_lshlrev_b32 v244, 16, v26
  v_and_b32 v245, 0xffff0000, v26
  v_mul_f32 v244, v244, v25
  v_mul_f32 v245, v245, v25
  v_cvt_pk_bf16_f32 v26, v244, v245
  v_lshlrev_b32 v244, 16, v26
  v_and_b32 v245, 0xffff0000, v26
  v_cvt_pk_bf16_f32 v26, v178, v179
  v_lshlrev_b32 v246, 16, v26
  v_and_b32 v247, 0xffff0000, v26
  v_mul_f32 v246, v246, v25
  v_mul_f32 v247, v247, v25
  v_cvt_pk_bf16_f32 v26, v246, v247
  v_lshlrev_b32 v246, 16, v26
  v_and_b32 v247, 0xffff0000, v26
  s_waitcnt lgkmcnt(0)
  v_pk_add_f32 v[144:145], v[144:145], v[148:149]
  v_pk_add_f32 v[152:153], v[152:153], v[156:157]
  v_pk_add_f32 v[146:147], v[146:147], v[150:151]
  v_pk_add_f32 v[154:155], v[154:155], v[158:159]
  v_pk_add_f32 v[176:177], v[144:145], v[152:153]
  v_pk_add_f32 v[178:179], v[146:147], v[154:155]
  v_cvt_pk_bf16_f32 v26, v176, v177
  v_lshlrev_b32 v248, 16, v26
  v_and_b32 v249, 0xffff0000, v26
  v_mul_f32 v248, v248, v25
  v_mul_f32 v249, v249, v25
  v_cvt_pk_bf16_f32 v26, v248, v249
  v_lshlrev_b32 v248, 16, v26
  v_and_b32 v249, 0xffff0000, v26
  v_cvt_pk_bf16_f32 v26, v178, v179
  v_lshlrev_b32 v250, 16, v26
  v_and_b32 v251, 0xffff0000, v26
  v_mul_f32 v250, v250, v25
  v_mul_f32 v251, v251, v25
  v_cvt_pk_bf16_f32 v26, v250, v251
  v_lshlrev_b32 v250, 16, v26
  v_and_b32 v251, 0xffff0000, v26
  s_cmp_ge_u32 s40, 60
  s_cbranch_scc1 pvt_323
  s_cmp_lg_u32 s20, 0
  s_cbranch_scc1 wr_325
  s_mov_b32 s101, 0
wr_324:
  buffer_load_dword v26, v18, s[72:75], 0 offen sc1
  s_add_u32 s101, s101, 1
  s_cmp_gt_u32 s101, 131072
  s_cbranch_scc1 main_end
  s_waitcnt vmcnt(0)
  v_cmp_gt_u32 vcc, v19, v26
  v_readfirstlane_b32 s100, v26
  s_nop 0
  s_cbranch_vccz wr_325
  s_sleep 2
  s_cmp_lg_u32 s100, 0
  s_cbranch_scc1 wr_324
  s_sleep 24
  s_branch wr_324
wr_325:
  s_barrier
  s_waitcnt vmcnt(10)
  buffer_load_dwordx4 v[64:67], v4, s[16:19], s47 offen sc1
  buffer_load_dwordx2 v[68:69], v5, s[16:19], s47 offen offset:2048 sc1
  buffer_load_dwordx4 v[128:131], v21, s[16:19], s47 offen offset:1024 sc1
  s_add_u32 s47, s47, 2560
  buffer_load_dwordx4 v[72:75], v4, s[16:19], s47 offen sc1
  buffer_load_dwordx2 v[76:77], v5, s[16:19], s47 offen offset:2048 sc1
  s_add_u32 s47, s47, 13824
  buffer_load_dwordx4 v[80:83], v4, s[16:19], s47 offen sc1
  buffer_load_dwordx2 v[84:85], v5, s[16:19], s47 offen offset:2048 sc1
  buffer_load_dwordx4 v[132:135], v21, s[16:19], s47 offen offset:1024 sc1
  s_add_u32 s47, s47, 2560
  buffer_load_dwordx4 v[88:91], v4, s[16:19], s47 offen sc1
  buffer_load_dwordx2 v[92:93], v5, s[16:19], s47 offen offset:2048 sc1
  s_add_u32 s47, s47, 13824
  buffer_load_dwordx4 v[32:35], v22, s[16:19], s48 offen offset:0 sc1
  buffer_load_dwordx4 v[40:43], v28, s[16:19], s48 offen offset:0 sc1
  buffer_load_dwordx2 v[184:185], v14, s[16:19], s48 offen offset:512 sc1
  buffer_load_dwordx4 v[36:39], v22, s[16:19], s48 offen offset:1280 sc1
  buffer_load_dwordx4 v[44:47], v28, s[16:19], s48 offen offset:1280 sc1
  buffer_load_dwordx2 v[186:187], v14, s[16:19], s48 offen offset:1792 sc1
  s_add_u32 s48, s48, 262144
  buffer_load_dwordx4 v[96:99], v4, s[16:19], s47 offen sc1
  buffer_load_dwordx2 v[100:101], v5, s[16:19], s47 offen offset:2048 sc1
  buffer_load_dwordx4 v[136:139], v21, s[16:19], s47 offen offset:1024 sc1
  s_add_u32 s47, s47, 2560
  buffer_load_dwordx4 v[104:107], v4, s[16:19], s47 offen sc1
  buffer_load_dwordx2 v[108:109], v5, s[16:19], s47 offen offset:2048 sc1
  s_add_u32 s47, s47, 13824
  buffer_load_dwordx4 v[112:115], v4, s[16:19], s47 offen sc1
  buffer_load_dwordx2 v[116:117], v5, s[16:19], s47 offen offset:2048 sc1
  buffer_load_dwordx4 v[140:143], v21, s[16:19], s47 offen offset:1024 sc1
  s_add_u32 s47, s47, 2560
  buffer_load_dwordx4 v[120:123], v4, s[16:19], s47 offen sc1
  buffer_load_dwordx2 v[124:125], v5, s[16:19], s47 offen offset:2048 sc1
  s_add_u32 s47, s47, 13824
  buffer_load_dwordx4 v[48:51], v22, s[16:19], s48 offen offset:0 sc1
  buffer_load_dwordx4 v[56:59], v28, s[16:19], s48 offen offset:0 sc1
  buffer_load_dwordx2 v[188:189], v14, s[16:19], s48 offen offset:512 sc1
  buffer_load_dwordx4 v[52:55], v22, s[16:19], s48 offen offset:1280 sc1
  buffer_load_dwordx4 v[60:63], v28, s[16:19], s48 offen offset:1280 sc1
  buffer_load_dwordx2 v[190:191], v14, s[16:19], s48 offen offset:1792 sc1
  s_add_u32 s48, s48, 262144
  s_lshl_b32 s40, s2, 2
  s_add_u32 s40, s40, s58
  s_lshl_b32 s21, s40, 7
  s_add_u32 s21, s21, 8192
  s_xor_b32 s21, s21, s80
  v_mov_b32 v18, s21
  v_cndmask_b32 v18, v17, v18, s[66:67]
  s_add_u32 s21, s40, 1
  v_mov_b32 v19, s21
  v_cndmask_b32 v19, v19, 32, s[66:67]
  buffer_load_dword v27, v18, s[72:75], 0 offen sc1
  s_lshl_b32 s55, s40, 19
  s_lshl_b32 s21, s40, 11
  s_and_b32 s21, s21, 8192
  s_xor_b32 s21, s21, s80
  s_add_u32 s55, s55, s21
  s_add_u32 s55, s55, 136314880
  s_lshl_b32 s21, s20, 15
  s_xor_b32 s54, s55, 8192
  s_add_u32 s54, s54, 48234496
  s_add_u32 s54, s54, s21
  s_lshl_b32 s57, s40, 1
  s_add_u32 s57, s57, s43
  s_lshl_b32 s45, s57, 6
  s_add_u32 s69, s54, 262144
  s_cmp_lt_u32 s2, 16
  s_cselect_b32 s69, s69, 0x40000000
  s_cmp_lt_u32 s2, 12
  s_cselect_b32 s65, s87, 0
  s_cmp_gt_u32 s65, 1
  s_cselect_b32 s64, s59, 0x40000000
  s_cselect_b32 s65, 1, 0
  v_mov_b32 v29, 1
  buffer_atomic_add v29, v233, s[72:75], s64 offen sc0 sc1
  buffer_load_dword v232, v6, s[28:31], s45 offen sc1
  buffer_load_dwordx4 v[192:195], v4, s[16:19], s69 offen offset:0 sc1
  buffer_load_dwordx4 v[196:199], v4, s[16:19], s69 offen offset:1024 sc1
  buffer_load_dwordx2 v[208:209], v5, s[16:19], s69 offen offset:2048 sc1
  s_add_u32 s69, s69, 2560
  buffer_load_dwordx4 v[200:203], v4, s[16:19], s69 offen offset:0 sc1
  buffer_load_dwordx4 v[204:207], v4, s[16:19], s69 offen offset:1024 sc1
  buffer_load_dwordx2 v[210:211], v5, s[16:19], s69 offen offset:2048 sc1
  s_add_u32 s69, s69, 13824
  buffer_load_dwordx4 v[212:215], v4, s[16:19], s69 offen offset:0 sc1
  buffer_load_dwordx4 v[216:219], v4, s[16:19], s69 offen offset:1024 sc1
  buffer_load_dwordx2 v[228:229], v5, s[16:19], s69 offen offset:2048 sc1
  s_add_u32 s69, s69, 2560
  buffer_load_dwordx4 v[220:223], v4, s[16:19], s69 offen offset:0 sc1
  buffer_load_dwordx4 v[224:227], v4, s[16:19], s69 offen offset:1024 sc1
  buffer_load_dwordx2 v[230:231], v5, s[16:19], s69 offen offset:2048 sc1
  s_add_u32 s69, s69, 13824
  s_waitcnt vmcnt(45)
  v_mfma_f32_16x16x32_bf16 v[148:151], a[0:3], v[64:67], 0
  v_mfma_f32_16x16x32_bf16 v[144:147], a[0:3], v[68:71], 0
  v_mfma_f32_16x16x32_bf16 v[156:159], a[4:7], v[64:67], 0
  v_mfma_f32_16x16x32_bf16 v[152:155], a[4:7], v[68:71], 0
  v_mfma_f32_16x16x32_bf16 v[164:167], a[8:11], v[64:67], 0
  v_mfma_f32_16x16x32_bf16 v[160:163], a[8:11], v[68:71], 0
  v_mfma_f32_16x16x32_bf16 v[172:175], a[12:15], v[64:67], 0
  v_mfma_f32_16x16x32_bf16 v[168:171], a[12:15], v[68:71], 0
  v_mfma_f32_16x16x32_bf16 v[180:183], a[16:19], v[64:67], 0
  v_mfma_f32_16x16x32_bf16 v[176:179], a[16:19], v[68:71], 0
  s_waitcnt vmcnt(42)
  v_mfma_f32_16x16x32_bf16 v[148:151], a[20:23], v[72:75], v[148:151]
  v_mfma_f32_16x16x32_bf16 v[144:147], a[20:23], v[76:79], v[144:147]
  v_mfma_f32_16x16x32_bf16 v[156:159], a[24:27], v[72:75], v[156:159]
  v_mfma_f32_16x16x32_bf16 v[152:155], a[24:27], v[76:79], v[152:155]
  v_mfma_f32_16x16x32_bf16 v[164:167], a[28:31], v[72:75], v[164:167]
  v_mfma_f32_16x16x32_bf16 v[160:163], a[28:31], v[76:79], v[160:163]
  v_mfma_f32_16x16x32_bf16 v[172:175], a[32:35], v[72:75], v[172:175]
  v_mfma_f32_16x16x32_bf16 v[168:171], a[32:35], v[76:79], v[168:171]
  v_mfma_f32_16x16x32_bf16 v[180:183], a[36:39], v[72:75], v[180:183]
  v_mfma_f32_16x16x32_bf16 v[176:179], a[36:39], v[76:79], v[176:179]
  s_waitcnt vmcnt(40)
  v_mfma_f32_16x16x32_bf16 v[148:151], a[40:43], v[80:83], v[148:151]
  v_mfma_f32_16x16x32_bf16 v[144:147], a[40:43], v[84:87], v[144:147]
  v_mfma_f32_16x16x32_bf16 v[156:159], a[44:47], v[80:83], v[156:159]
  v_mfma_f32_16x16x32_bf16 v[152:155], a[44:47], v[84:87], v[152:155]
  v_mfma_f32_16x16x32_bf16 v[164:167], a[48:51], v[80:83], v[164:167]
  v_mfma_f32_16x16x32_bf16 v[160:163], a[48:51], v[84:87], v[160:163]
  v_mfma_f32_16x16x32_bf16 v[172:175], a[52:55], v[80:83], v[172:175]
  v_mfma_f32_16x16x32_bf16 v[168:171], a[52:55], v[84:87], v[168:171]
  v_mfma_f32_16x16x32_bf16 v[180:183], a[56:59], v[80:83], v[180:183]
  v_mfma_f32_16x16x32_bf16 v[176:179], a[56:59], v[84:87], v[176:179]
  s_waitcnt vmcnt(37)
  v_mfma_f32_16x16x32_bf16 v[148:151], a[60:63], v[88:91], v[148:151]
  v_mfma_f32_16x16x32_bf16 v[144:147], a[60:63], v[92:95], v[144:147]
  v_mfma_f32_16x16x32_bf16 v[156:159], a[64:67], v[88:91], v[156:159]
  v_mfma_f32_16x16x32_bf16 v[152:155], a[64:67], v[92:95], v[152:155]
  v_mfma_f32_16x16x32_bf16 v[164:167], a[68:71], v[88:91], v[164:167]
  v_mfma_f32_16x16x32_bf16 v[160:163], a[68:71], v[92:95], v[160:163]
  v_mfma_f32_16x16x32_bf16 v[172:175], a[72:75], v[88:91], v[172:175]
  v_mfma_f32_16x16x32_bf16 v[168:171], a[72:75], v[92:95], v[168:171]
  v_mfma_f32_16x16x32_bf16 v[180:183], a[76:79], v[88:91], v[180:183]
  v_mfma_f32_16x16x32_bf16 v[176:179], a[76:79], v[92:95], v[176:179]
  s_waitcnt vmcnt(31)
  v_swap_b32 v130, v132
  v_swap_b32 v131, v133
  v_swap_b32 v34, v36
  v_swap_b32 v35, v37
  v_swap_b32 v42, v44
  v_swap_b32 v43, v45
  s_nop 1
  v_mfma_f32_16x16x32_bf16 v[144:147], v[32:35], v[128:131], v[144:147]
  v_mfma_f32_16x16x32_bf16 v[148:151], v[32:35], v[132:135], v[148:151]
  v_mfma_f32_16x16x32_bf16 v[152:155], v[36:39], v[128:131], v[152:155]
  v_mfma_f32_16x16x32_bf16 v[156:159], v[36:39], v[132:135], v[156:159]
  v_mfma_f32_16x16x32_bf16 v[160:163], v[184:187], v[128:131], v[160:163]
  v_mfma_f32_16x16x32_bf16 v[164:167], v[184:187], v[132:135], v[164:167]
  v_mfma_f32_16x16x32_bf16 v[168:171], v[40:43], v[128:131], v[168:171]
  v_mfma_f32_16x16x32_bf16 v[172:175], v[40:43], v[132:135], v[172:175]
  v_mfma_f32_16x16x32_bf16 v[176:179], v[44:47], v[128:131], v[176:179]
  v_mfma_f32_16x16x32_bf16 v[180:183], v[44:47], v[132:135], v[180:183]
  s_waitcnt vmcnt(29)
  v_mfma_f32_16x16x32_bf16 v[148:151], a[80:83], v[96:99], v[148:151]
  v_mfma_f32_16x16x32_bf16 v[144:147], a[80:83], v[100:103], v[144:147]
  v_mfma_f32_16x16x32_bf16 v[156:159], a[84:87], v[96:99], v[156:159]
  v_mfma_f32_16x16x32_bf16 v[152:155], a[84:87], v[100:103], v[152:155]
  v_mfma_f32_16x16x32_bf16 v[164:167], a[88:91], v[96:99], v[164:167]
  v_mfma_f32_16x16x32_bf16 v[160:163], a[88:91], v[100:103], v[160:163]
  v_mfma_f32_16x16x32_bf16 v[172:175], a[92:95], v[96:99], v[172:175]
  v_mfma_f32_16x16x32_bf16 v[168:171], a[92:95], v[100:103], v[168:171]
  v_mfma_f32_16x16x32_bf16 v[180:183], a[96:99], v[96:99], v[180:183]
  v_mfma_f32_16x16x32_bf16 v[176:179], a[96:99], v[100:103], v[176:179]
  s_waitcnt vmcnt(26)
  v_mfma_f32_16x16x32_bf16 v[148:151], a[100:103], v[104:107], v[148:151]
  v_mfma_f32_16x16x32_bf16 v[144:147], a[100:103], v[108:111], v[144:147]
  v_mfma_f32_16x16x32_bf16 v[156:159], a[104:107], v[104:107], v[156:159]
  v_mfma_f32_16x16x32_bf16 v[152:155], a[104:107], v[108:111], v[152:155]
  v_mfma_f32_16x16x32_bf16 v[164:167], a[108:111], v[104:107], v[164:167]
  v_mfma_f32_16x16x32_bf16 v[160:163], a[108:111], v[108:111], v[160:163]
  v_mfma_f32_16x16x32_bf16 v[172:175], a[112:115], v[104:107], v[172:175]
  v_mfma_f32_16x16x32_bf16 v[168:171], a[112:115], v[108:111], v[168:171]
  v_mfma_f32_16x16x32_bf16 v[180:183], a[116:119], v[104:107], v[180:183]
  v_mfma_f32_16x16x32_bf16 v[176:179], a[116:119], v[108:111], v[176:179]
  s_waitcnt vmcnt(24)
  v_mfma_f32_16x16x32_bf16 v[148:151], a[120:123], v[112:115], v[148:151]
  v_mfma_f32_16x16x32_bf16 v[144:147], a[120:123], v[116:119], v[144:147]
  v_mfma_f32_16x16x32_bf16 v[156:159], a[124:127], v[112:115], v[156:159]
  v_mfma_f32_16x16x32_bf16 v[152:155], a[124:127], v[116:119], v[152:155]
  v_mfma_f32_16x16x32_bf16 v[164:167], a[128:131], v[112:115], v[164:167]
  v_mfma_f32_16x16x32_bf16 v[160:163], a[128:131], v[116:119], v[160:163]
  v_mfma_f32_16x16x32_bf16 v[172:175], a[132:135], v[112:115], v[172:175]
  v_mfma_f32_16x16x32_bf16 v[168:171], a[132:135], v[116:119], v[168:171]
  v_mfma_f32_16x16x32_bf16 v[180:183], a[136:139], v[112:115], v[180:183]
  v_mfma_f32_16x16x32_bf16 v[176:179], a[136:139], v[116:119], v[176:179]
  s_waitcnt vmcnt(21)
  v_mfma_f32_16x16x32_bf16 v[148:151], a[140:143], v[120:123], v[148:151]
  v_mfma_f32_16x16x32_bf16 v[144:147], a[140:143], v[124:127], v[144:147]
  v_mfma_f32_16x16x32_bf16 v[156:159], a[144:147], v[120:123], v[156:159]
  v_mfma_f32_16x16x32_bf16 v[152:155], a[144:147], v[124:127], v[152:155]
  v_mfma_f32_16x16x32_bf16 v[164:167], a[148:151], v[120:123], v[164:167]
  v_mfma_f32_16x16x32_bf16 v[160:163], a[148:151], v[124:127], v[160:163]
  v_mfma_f32_16x16x32_bf16 v[172:175], a[152:155], v[120:123], v[172:175]
  v_mfma_f32_16x16x32_bf16 v[168:171], a[152:155], v[124:127], v[168:171]
  v_mfma_f32_16x16x32_bf16 v[180:183], a[156:159], v[120:123], v[180:183]
  v_mfma_f32_16x16x32_bf16 v[176:179], a[156:159], v[124:127], v[176:179]
  s_waitcnt vmcnt(15)
  v_swap_b32 v138, v140
  v_swap_b32 v139, v141
  v_swap_b32 v50, v52
  v_swap_b32 v51, v53
  v_swap_b32 v58, v60
  v_swap_b32 v59, v61
  s_nop 1
  v_mfma_f32_16x16x32_bf16 v[144:147], v[48:51], v[136:139], v[144:147]
  v_mfma_f32_16x16x32_bf16 v[148:151], v[48:51], v[140:143], v[148:151]
  v_mfma_f32_16x16x32_bf16 v[152:155], v[52:55], v[136:139], v[152:155]
  v_mfma_f32_16x16x32_bf16 v[156:159], v[52:55], v[140:143], v[156:159]
  v_mfma_f32_16x16x32_bf16 v[160:163], v[188:191], v[136:139], v[160:163]
  v_mfma_f32_16x16x32_bf16 v[164:167], v[188:191], v[140:143], v[164:167]
  v_mfma_f32_16x16x32_bf16 v[168:171], v[56:59], v[136:139], v[168:171]
  v_mfma_f32_16x16x32_bf16 v[172:175], v[56:59], v[140:143], v[172:175]
  v_mfma_f32_16x16x32_bf16 v[176:179], v[60:63], v[136:139], v[176:179]
  v_mfma_f32_16x16x32_bf16 v[180:183], v[60:63], v[140:143], v[180:183]
  s_branch pve_317
pvt_323:
  s_min_u32 s21, s40, 62
  v_mov_b32 v19, s21
  v_mov_b32 v18, v17
  s_cmp_lg_u32 s20, 0
  s_cbranch_scc1 wr_327
  s_mov_b32 s101, 0
wr_326:
  buffer_load_dword v26, v18, s[72:75], 0 offen sc1
  s_add_u32 s101, s101, 1
  s_cmp_gt_u32 s101, 131072
  s_cbranch_scc1 main_end
  s_waitcnt vmcnt(0)
  v_cmp_gt_u32 vcc, v19, v26
  v_readfirstlane_b32 s100, v26
  s_nop 0
  s_cbranch_vccz wr_327
  s_sleep 6
  s_cmp_lg_u32 s100, 0
  s_cbranch_scc1 wr_326
  s_sleep 0
  s_branch wr_326
wr_327:
  s_barrier
  s_lshl_b32 s40, s2, 2
  s_add_u32 s40, s40, s58
  s_lshl_b32 s21, s40, 7
  s_add_u32 s21, s21, 8192
  s_xor_b32 s21, s21, s80
  v_mov_b32 v18, s21
  v_cndmask_b32 v18, v17, v18, s[66:67]
  s_add_u32 s21, s40, 1
  v_mov_b32 v19, s21
  v_cndmask_b32 v19, v19, 32, s[66:67]
  buffer_load_dword v27, v18, s[72:75], 0 offen sc1
  s_lshl_b32 s55, s40, 19
  s_lshl_b32 s21, s40, 11
  s_and_b32 s21, s21, 8192
  s_xor_b32 s21, s21, s80
  s_add_u32 s55, s55, s21
  s_add_u32 s55, s55, 136314880
  s_lshl_b32 s21, s20, 15
  s_xor_b32 s54, s55, 8192
  s_add_u32 s54, s54, 48234496
  s_add_u32 s54, s54, s21
  s_lshl_b32 s57, s40, 1
  s_add_u32 s57, s57, s43
  s_lshl_b32 s45, s57, 6
  s_add_u32 s69, s54, 262144
  s_cmp_lt_u32 s2, 16
  s_cselect_b32 s69, s69, 0x40000000
  s_cmp_lt_u32 s2, 12
  s_cselect_b32 s65, s87, 0
  s_cmp_gt_u32 s65, 1
  s_cselect_b32 s64, s59, 0x40000000
  s_cselect_b32 s65, 1, 0
  v_mov_b32 v29, 1
  buffer_atomic_add v29, v233, s[72:75], s64 offen sc0 sc1
  buffer_load_dword v232, v6, s[28:31], s45 offen sc1
  buffer_load_dwordx4 v[192:195], v4, s[16:19], s69 offen offset:0 sc1
  buffer_load_dwordx4 v[196:199], v4, s[16:19], s69 offen offset:1024 sc1
  buffer_load_dwordx2 v[208:209], v5, s[16:19], s69 offen offset:2048 sc1
  s_add_u32 s69, s69, 2560
  buffer_load_dwordx4 v[200:203], v4, s[16:19], s69 offen offset:0 sc1
  buffer_load_dwordx4 v[204:207], v4, s[16:19], s69 offen offset:1024 sc1
  buffer_load_dwordx2 v[210:211], v5, s[16:19], s69 offen offset:2048 sc1
  s_add_u32 s69, s69, 13824
  buffer_load_dwordx4 v[212:215], v4, s[16:19], s69 offen offset:0 sc1
  buffer_load_dwordx4 v[216:219], v4, s[16:19], s69 offen offset:1024 sc1
  buffer_load_dwordx2 v[228:229], v5, s[16:19], s69 offen offset:2048 sc1
  s_add_u32 s69, s69, 2560
  buffer_load_dwordx4 v[220:223], v4, s[16:19], s69 offen offset:0 sc1
  buffer_load_dwordx4 v[224:227], v4, s[16:19], s69 offen offset:1024 sc1
  buffer_load_dwordx2 v[230:231], v5, s[16:19], s69 offen offset:2048 sc1
  s_add_u32 s69, s69, 13824
  s_mov_b32 s56, s48
  buffer_load_dwordx4 v[32:35], v22, s[16:19], s56 offen offset:0 sc1
  buffer_load_dwordx4 v[40:43], v28, s[16:19], s56 offen offset:0 sc1
  buffer_load_dwordx2 v[184:185], v14, s[16:19], s56 offen offset:512 sc1
  buffer_load_dwordx4 v[36:39], v22, s[16:19], s56 offen offset:1280 sc1
  buffer_load_dwordx4 v[44:47], v28, s[16:19], s56 offen offset:1280 sc1
  buffer_load_dwordx2 v[186:187], v14, s[16:19], s56 offen offset:1792 sc1
  s_add_u32 s56, s56, 262144
  buffer_load_dwordx4 v[48:51], v22, s[16:19], s56 offen offset:0 sc1
  buffer_load_dwordx4 v[56:59], v28, s[16:19], s56 offen offset:0 sc1
  buffer_load_dwordx2 v[188:189], v14, s[16:19], s56 offen offset:512 sc1
  buffer_load_dwordx4 v[52:55], v22, s[16:19], s56 offen offset:1280 sc1
  buffer_load_dwordx4 v[60:63], v28, s[16:19], s56 offen offset:1280 sc1
  buffer_load_dwordx2 v[190:191], v14, s[16:19], s56 offen offset:1792 sc1
  s_add_u32 s56, s56, 262144
  s_mov_b32 s101, 0
  s_branch pvr_329
pvr_328:
  s_sleep 6
  s_mov_b32 s56, s48
  buffer_load_dwordx4 v[32:35], v22, s[16:19], s56 offen offset:0 sc1
  buffer_load_dwordx4 v[40:43], v28, s[16:19], s56 offen offset:0 sc1
  buffer_load_dwordx2 v[184:185], v14, s[16:19], s56 offen offset:512 sc1
  buffer_load_dwordx4 v[36:39], v22, s[16:19], s56 offen offset:1280 sc1
  buffer_load_dwordx4 v[44:47], v28, s[16:19], s56 offen offset:1280 sc1
  buffer_load_dwordx2 v[186:187], v14, s[16:19], s56 offen offset:1792 sc1
  s_add_u32 s56, s56, 262144
  buffer_load_dwordx4 v[48:51], v22, s[16:19], s56 offen offset:0 sc1
  buffer_load_dwordx4 v[56:59], v28, s[16:19], s56 offen offset:0 sc1
  buffer_load_dwordx2 v[188:189], v14, s[16:19], s56 offen offset:512 sc1
  buffer_load_dwordx4 v[52:55], v22, s[16:19], s56 offen offset:1280 sc1
  buffer_load_dwordx4 v[60:63], v28, s[16:19], s56 offen offset:1280 sc1
  buffer_load_dwordx2 v[190:191], v14, s[16:19], s56 offen offset:1792 sc1
  s_add_u32 s56, s56, 262144
  s_add_u32 s101, s101, 1
  s_cmp_gt_u32 s101, 131072
  s_cbranch_scc1 main_end
pvr_329:
  s_waitcnt vmcnt(0)
  v_max3_u32 v26, v32, v36, v40
  v_max3_u32 v26, v26, v44, v184
  v_max3_u32 v26, v26, v186, v48
  v_max3_u32 v26, v26, v52, v56
  v_max3_u32 v26, v26, v60, v188
  v_max3_u32 v26, v26, v190, v190
  v_cmp_eq_u32 vcc, -1, v26
  s_nop 1
  s_cbranch_vccnz pvr_328
  s_add_u32 s56, s47, 0
  buffer_load_dwordx4 v[64:67], v4, s[16:19], s56 offen sc1
  buffer_load_dwordx2 v[68:69], v5, s[16:19], s56 offen offset:2048 sc1
  buffer_load_dwordx4 v[128:131], v21, s[16:19], s56 offen offset:1024 sc1
  s_add_u32 s56, s56, 2560
  buffer_load_dwordx4 v[72:75], v4, s[16:19], s56 offen sc1
  buffer_load_dwordx2 v[76:77], v5, s[16:19], s56 offen offset:2048 sc1
  s_add_u32 s56, s56, 13824
  buffer_load_dwordx4 v[80:83], v4, s[16:19], s56 offen sc1
  buffer_load_dwordx2 v[84:85], v5, s[16:19], s56 offen offset:2048 sc1
  buffer_load_dwordx4 v[132:135], v21, s[16:19], s56 offen offset:1024 sc1
  s_add_u32 s56, s56, 2560
  buffer_load_dwordx4 v[88:91], v4, s[16:19], s56 offen sc1
  buffer_load_dwordx2 v[92:93], v5, s[16:19], s56 offen offset:2048 sc1
  s_add_u32 s56, s56, 13824
  s_mov_b32 s101, 0
  s_branch pvr_331
pvr_330:
  s_sleep 2
  s_add_u32 s56, s47, 0
  buffer_load_dwordx4 v[64:67], v4, s[16:19], s56 offen sc1
  buffer_load_dwordx2 v[68:69], v5, s[16:19], s56 offen offset:2048 sc1
  buffer_load_dwordx4 v[128:131], v21, s[16:19], s56 offen offset:1024 sc1
  s_add_u32 s56, s56, 2560
  buffer_load_dwordx4 v[72:75], v4, s[16:19], s56 offen sc1
  buffer_load_dwordx2 v[76:77], v5, s[16:19], s56 offen offset:2048 sc1
  s_add_u32 s56, s56, 13824
  buffer_load_dwordx4 v[80:83], v4, s[16:19], s56 offen sc1
  buffer_load_dwordx2 v[84:85], v5, s[16:19], s56 offen offset:2048 sc1
  buffer_load_dwordx4 v[132:135], v21, s[16:19], s56 offen offset:1024 sc1
  s_add_u32 s56, s56, 2560
  buffer_load_dwordx4 v[88:91], v4, s[16:19], s56 offen sc1
  buffer_load_dwordx2 v[92:93], v5, s[16:19], s56 offen offset:2048 sc1
  s_add_u32 s56, s56, 13824
  s_add_u32 s101, s101, 1
  s_cmp_gt_u32 s101, 131072
  s_cbranch_scc1 main_end
pvr_331:
  s_waitcnt vmcnt(0)
  v_max3_u32 v26, v64, v68, v72
  v_max3_u32 v26, v26, v76, v80
  v_max3_u32 v26, v26, v84, v88
  v_max3_u32 v26, v26, v92, v128
  v_max3_u32 v26, v26, v132, v132
  v_cmp_eq_u32 vcc, -1, v26
  s_nop 1
  s_cbranch_vccnz pvr_330
  s_add_u32 s56, s47, 32768
  buffer_load_dwordx4 v[96:99], v4, s[16:19], s56 offen sc1
  buffer_load_dwordx2 v[100:101], v5, s[16:19], s56 offen offset:2048 sc1
  buffer_load_dwordx4 v[136:139], v21, s[16:19], s56 offen offset:1024 sc1
  s_add_u32 s56, s56, 2560
  buffer_load_dwordx4 v[104:107], v4, s[16:19], s56 offen sc1
  buffer_load_dwordx2 v[108:109], v5, s[16:19], s56 offen offset:2048 sc1
  s_add_u32 s56, s56, 13824
  buffer_load_dwordx4 v[112:115], v4, s[16:19], s56 offen sc1
  buffer_load_dwordx2 v[116:117], v5, s[16:19], s56 offen offset:2048 sc1
  buffer_load_dwordx4 v[140:143], v21, s[16:19], s56 offen offset:1024 sc1
  s_add_u32 s56, s56, 2560
  buffer_load_dwordx4 v[120:123], v4, s[16:19], s56 offen sc1
  buffer_load_dwordx2 v[124:125], v5, s[16:19], s56 offen offset:2048 sc1
  s_add_u32 s56, s56, 13824
  v_mfma_f32_16x16x32_bf16 v[148:151], a[0:3], v[64:67], 0
  v_mfma_f32_16x16x32_bf16 v[144:147], a[0:3], v[68:71], 0
  v_mfma_f32_16x16x32_bf16 v[156:159], a[4:7], v[64:67], 0
  v_mfma_f32_16x16x32_bf16 v[152:155], a[4:7], v[68:71], 0
  v_mfma_f32_16x16x32_bf16 v[164:167], a[8:11], v[64:67], 0
  v_mfma_f32_16x16x32_bf16 v[160:163], a[8:11], v[68:71], 0
  v_mfma_f32_16x16x32_bf16 v[172:175], a[12:15], v[64:67], 0
  v_mfma_f32_16x16x32_bf16 v[168:171], a[12:15], v[68:71], 0
  v_mfma_f32_16x16x32_bf16 v[180:183], a[16:19], v[64:67], 0
  v_mfma_f32_16x16x32_bf16 v[176:179], a[16:19], v[68:71], 0
  v_mfma_f32_16x16x32_bf16 v[148:151], a[20:23], v[72:75], v[148:151]
  v_mfma_f32_16x16x32_bf16 v[144:147], a[20:23], v[76:79], v[144:147]
  v_mfma_f32_16x16x32_bf16 v[156:159], a[24:27], v[72:75], v[156:159]
  v_mfma_f32_16x16x32_bf16 v[152:155], a[24:27], v[76:79], v[152:155]
  v_mfma_f32_16x16x32_bf16 v[164:167], a[28:31], v[72:75], v[164:167]
  v_mfma_f32_16x16x32_bf16 v[160:163], a[28:31], v[76:79], v[160:163]
  v_mfma_f32_16x16x32_bf16 v[172:175], a[32:35], v[72:75], v[172:175]
  v_mfma_f32_16x16x32_bf16 v[168:171], a[32:35], v[76:79], v[168:171]
  v_mfma_f32_16x16x32_bf16 v[180:183], a[36:39], v[72:75], v[180:183]
  v_mfma_f32_16x16x32_bf16 v[176:179], a[36:39], v[76:79], v[176:179]
  v_mfma_f32_16x16x32_bf16 v[148:151], a[40:43], v[80:83], v[148:151]
  v_mfma_f32_16x16x32_bf16 v[144:147], a[40:43], v[84:87], v[144:147]
  v_mfma_f32_16x16x32_bf16 v[156:159], a[44:47], v[80:83], v[156:159]
  v_mfma_f32_16x16x32_bf16 v[152:155], a[44:47], v[84:87], v[152:155]
  v_mfma_f32_16x16x32_bf16 v[164:167], a[48:51], v[80:83], v[164:167]
  v_mfma_f32_16x16x32_bf16 v[160:163], a[48:51], v[84:87], v[160:163]
  v_mfma_f32_16x16x32_bf16 v[172:175], a[52:55], v[80:83], v[172:175]
  v_mfma_f32_16x16x32_bf16 v[168:171], a[52:55], v[84:87], v[168:171]
  v_mfma_f32_16x16x32_bf16 v[180:183], a[56:59], v[80:83], v[180:183]
  v_mfma_f32_16x16x32_bf16 v[176:179], a[56:59], v[84:87], v[176:179]
  v_mfma_f32_16x16x32_bf16 v[148:151], a[60:63], v[88:91], v[148:151]
  v_mfma_f32_16x16x32_bf16 v[144:147], a[60:63], v[92:95], v[144:147]
  v_mfma_f32_16x16x32_bf16 v[156:159], a[64:67], v[88:91], v[156:159]
  v_mfma_f32_16x16x32_bf16 v[152:155], a[64:67], v[92:95], v[152:155]
  v_mfma_f32_16x16x32_bf16 v[164:167], a[68:71], v[88:91], v[164:167]
  v_mfma_f32_16x16x32_bf16 v[160:163], a[68:71], v[92:95], v[160:163]
  v_mfma_f32_16x16x32_bf16 v[172:175], a[72:75], v[88:91], v[172:175]
  v_mfma_f32_16x16x32_bf16 v[168:171], a[72:75], v[92:95], v[168:171]
  v_mfma_f32_16x16x32_bf16 v[180:183], a[76:79], v[88:91], v[180:183]
  v_mfma_f32_16x16x32_bf16 v[176:179], a[76:79], v[92:95], v[176:179]
  v_swap_b32 v130, v132
  v_swap_b32 v131, v133
  v_swap_b32 v34, v36
  v_swap_b32 v35, v37
  v_swap_b32 v42, v44
  v_swap_b32 v43, v45
  s_nop 1
  v_mfma_f32_16x16x32_bf16 v[144:147], v[32:35], v[128:131], v[144:147]
  v_mfma_f32_16x16x32_bf16 v[148:151], v[32:35], v[132:135], v[148:151]
  v_mfma_f32_16x16x32_bf16 v[152:155], v[36:39], v[128:131], v[152:155]
  v_mfma_f32_16x16x32_bf16 v[156:159], v[36:39], v[132:135], v[156:159]
  v_mfma_f32_16x16x32_bf16 v[160:163], v[184:187], v[128:131], v[160:163]
  v_mfma_f32_16x16x32_bf16 v[164:167], v[184:187], v[132:135], v[164:167]
  v_mfma_f32_16x16x32_bf16 v[168:171], v[40:43], v[128:131], v[168:171]
  v_mfma_f32_16x16x32_bf16 v[172:175], v[40:43], v[132:135], v[172:175]
  v_mfma_f32_16x16x32_bf16 v[176:179], v[44:47], v[128:131], v[176:179]
  v_mfma_f32_16x16x32_bf16 v[180:183], v[44:47], v[132:135], v[180:183]
  s_mov_b32 s101, 0
  s_branch pvr_333
pvr_332:
  s_sleep 1
  s_add_u32 s56, s47, 32768
  buffer_load_dwordx4 v[96:99], v4, s[16:19], s56 offen sc1
  buffer_load_dwordx2 v[100:101], v5, s[16:19], s56 offen offset:2048 sc1
  buffer_load_dwordx4 v[136:139], v21, s[16:19], s56 offen offset:1024 sc1
  s_add_u32 s56, s56, 2560
  buffer_load_dwordx4 v[104:107], v4, s[16:19], s56 offen sc1
  buffer_load_dwordx2 v[108:109], v5, s[16:19], s56 offen offset:2048 sc1
  s_add_u32 s56, s56, 13824
  buffer_load_dwordx4 v[112:115], v4, s[16:19], s56 offen sc1
  buffer_load_dwordx2 v[116:117], v5, s[16:19], s56 offen offset:2048 sc1
  buffer_load_dwordx4 v[140:143], v21, s[16:19], s56 offen offset:1024 sc1
  s_add_u32 s56, s56, 2560
  buffer_load_dwordx4 v[120:123], v4, s[16:19], s56 offen sc1
  buffer_load_dwordx2 v[124:125], v5, s[16:19], s56 offen offset:2048 sc1
  s_add_u32 s56, s56, 13824
  s_add_u32 s101, s101, 1
  s_cmp_gt_u32 s101, 131072
  s_cbranch_scc1 main_end
pvr_333:
  s_waitcnt vmcnt(0)
  v_max3_u32 v26, v96, v100, v104
  v_max3_u32 v26, v26, v108, v112
  v_max3_u32 v26, v26, v116, v120
  v_max3_u32 v26, v26, v124, v136
  v_max3_u32 v26, v26, v140, v140
  v_cmp_eq_u32 vcc, -1, v26
  s_nop 1
  s_cbranch_vccnz pvr_332
  v_mfma_f32_16x16x32_bf16 v[148:151], a[80:83], v[96:99], v[148:151]
  v_mfma_f32_16x16x32_bf16 v[144:147], a[80:83], v[100:103], v[144:147]
  v_mfma_f32_16x16x32_bf16 v[156:159], a[84:87], v[96:99], v[156:159]
  v_mfma_f32_16x16x32_bf16 v[152:155], a[84:87], v[100:103], v[152:155]
  v_mfma_f32_16x16x32_bf16 v[164:167], a[88:91], v[96:99], v[164:167]
  v_mfma_f32_16x16x32_bf16 v[160:163], a[88:91], v[100:103], v[160:163]
  v_mfma_f32_16x16x32_bf16 v[172:175], a[92:95], v[96:99], v[172:175]
  v_mfma_f32_16x16x32_bf16 v[168:171], a[92:95], v[100:103], v[168:171]
  v_mfma_f32_16x16x32_bf16 v[180:183], a[96:99], v[96:99], v[180:183]
  v_mfma_f32_16x16x32_bf16 v[176:179], a[96:99], v[100:103], v[176:179]
  v_mfma_f32_16x16x32_bf16 v[148:151], a[100:103], v[104:107], v[148:151]
  v_mfma_f32_16x16x32_bf16 v[144:147], a[100:103], v[108:111], v[144:147]
  v_mfma_f32_16x16x32_bf16 v[156:159], a[104:107], v[104:107], v[156:159]
  v_mfma_f32_16x16x32_bf16 v[152:155], a[104:107], v[108:111], v[152:155]
  v_mfma_f32_16x16x32_bf16 v[164:167], a[108:111], v[104:107], v[164:167]
  v_mfma_f32_16x16x32_bf16 v[160:163], a[108:111], v[108:111], v[160:163]
  v_mfma_f32_16x16x32_bf16 v[172:175], a[112:115], v[104:107], v[172:175]
  v_mfma_f32_16x16x32_bf16 v[168:171], a[112:115], v[108:111], v[168:171]
  v_mfma_f32_16x16x32_bf16 v[180:183], a[116:119], v[104:107], v[180:183]
  v_mfma_f32_16x16x32_bf16 v[176:179], a[116:119], v[108:111], v[176:179]
  v_mfma_f32_16x16x32_bf16 v[148:151], a[120:123], v[112:115], v[148:151]
  v_mfma_f32_16x16x32_bf16 v[144:147], a[120:123], v[116:119], v[144:147]
  v_mfma_f32_16x16x32_bf16 v[156:159], a[124:127], v[112:115], v[156:159]
  v_mfma_f32_16x16x32_bf16 v[152:155], a[124:127], v[116:119], v[152:155]
  v_mfma_f32_16x16x32_bf16 v[164:167], a[128:131], v[112:115], v[164:167]
  v_mfma_f32_16x16x32_bf16 v[160:163], a[128:131], v[116:119], v[160:163]
  v_mfma_f32_16x16x32_bf16 v[172:175], a[132:135], v[112:115], v[172:175]
  v_mfma_f32_16x16x32_bf16 v[168:171], a[132:135], v[116:119], v[168:171]
  v_mfma_f32_16x16x32_bf16 v[180:183], a[136:139], v[112:115], v[180:183]
  v_mfma_f32_16x16x32_bf16 v[176:179], a[136:139], v[116:119], v[176:179]
  v_mfma_f32_16x16x32_bf16 v[148:151], a[140:143], v[120:123], v[148:151]
  v_mfma_f32_16x16x32_bf16 v[144:147], a[140:143], v[124:127], v[144:147]
  v_mfma_f32_16x16x32_bf16 v[156:159], a[144:147], v[120:123], v[156:159]
  v_mfma_f32_16x16x32_bf16 v[152:155], a[144:147], v[124:127], v[152:155]
  v_mfma_f32_16x16x32_bf16 v[164:167], a[148:151], v[120:123], v[164:167]
  v_mfma_f32_16x16x32_bf16 v[160:163], a[148:151], v[124:127], v[160:163]
  v_mfma_f32_16x16x32_bf16 v[172:175], a[152:155], v[120:123], v[172:175]
  v_mfma_f32_16x16x32_bf16 v[168:171], a[152:155], v[124:127], v[168:171]
  v_mfma_f32_16x16x32_bf16 v[180:183], a[156:159], v[120:123], v[180:183]
  v_mfma_f32_16x16x32_bf16 v[176:179], a[156:159], v[124:127], v[176:179]
  v_swap_b32 v138, v140
  v_swap_b32 v139, v141
  v_swap_b32 v50, v52
  v_swap_b32 v51, v53
  v_swap_b32 v58, v60
  v_swap_b32 v59, v61
  s_nop 1
  v_mfma_f32_16x16x32_bf16 v[144:147], v[48:51], v[136:139], v[144:147]
  v_mfma_f32_16x16x32_bf16 v[148:151], v[48:51], v[140:143], v[148:151]
  v_mfma_f32_16x16x32_bf16 v[152:155], v[52:55], v[136:139], v[152:155]
  v_mfma_f32_16x16x32_bf16 v[156:159], v[52:55], v[140:143], v[156:159]
  v_mfma_f32_16x16x32_bf16 v[160:163], v[188:191], v[136:139], v[160:163]
  v_mfma_f32_16x16x32_bf16 v[164:167], v[188:191], v[140:143], v[164:167]
  v_mfma_f32_16x16x32_bf16 v[168:171], v[56:59], v[136:139], v[168:171]
  v_mfma_f32_16x16x32_bf16 v[172:175], v[56:59], v[140:143], v[172:175]
  v_mfma_f32_16x16x32_bf16 v[176:179], v[60:63], v[136:139], v[176:179]
  v_mfma_f32_16x16x32_bf16 v[180:183], v[60:63], v[140:143], v[180:183]
pve_317:
  s_nop 0
  ds_write_b128 v10, v[144:147] offset:0
  ds_write_b128 v10, v[148:151] offset:1024
  ds_write_b128 v10, v[152:155] offset:2048
  ds_write_b128 v10, v[156:159] offset:3072
  ds_write_b128 v10, v[160:163] offset:4096
  ds_write_b128 v10, v[164:167] offset:5120
  ds_write_b128 v10, v[168:171] offset:6144
  ds_write_b128 v10, v[172:175] offset:7168
  s_nop 1
  ds_write_b128 v10, v[176:179] offset:8192
  ds_write_b128 v10, v[180:183] offset:9216
  s_cmp_ge_u32 s2, 16
  s_cbranch_scc1 pv_320
  s_waitcnt vmcnt(14)
  s_add_u32 s23, s40, 1
  s_cmp_ge_u32 s50, s23
  s_cbranch_scc1 pv_334
  s_mov_b32 s101, 0
wm_337:
  buffer_load_dword v8, v31, s[72:75], s51 offen sc1
  s_add_u32 s101, s101, 1
  s_cmp_gt_u32 s101, 131072
  s_cbranch_scc1 main_end
  s_waitcnt vmcnt(0)
  v_cmp_gt_u32 vcc, s23, v8
  v_readfirstlane_b32 s100, v8
  s_nop 0
  s_cbranch_vccz wm_338
  s_sleep 8
  s_add_u32 s100, s100, 2
  s_cmp_ge_u32 s100, s23
  s_cbranch_scc1 wm_337
  s_sleep 60
  s_branch wm_337
wm_338:
  v_readlane_b32 s50, v8, 0
  v_readlane_b32 s21, v8, 1
  s_min_u32 s50, s50, s21
  v_readlane_b32 s21, v8, 2
  s_min_u32 s50, s50, s21
  v_readlane_b32 s21, v8, 3
  s_min_u32 s50, s50, s21
  v_readlane_b32 s21, v8, 4
  s_min_u32 s50, s50, s21
  v_readlane_b32 s21, v8, 5
  s_min_u32 s50, s50, s21
  v_readlane_b32 s21, v8, 6
  s_min_u32 s50, s50, s21
  v_readlane_b32 s21, v8, 7
  s_min_u32 s50, s50, s21
  v_readlane_b32 s21, v8, 8
  s_min_u32 s50, s50, s21
  v_readlane_b32 s21, v8, 9
  s_min_u32 s50, s50, s21
  v_readlane_b32 s21, v8, 10
  s_min_u32 s50, s50, s21
  v_readlane_b32 s21, v8, 11
  s_min_u32 s50, s50, s21
  v_readlane_b32 s21, v8, 12
  s_min_u32 s50, s50, s21
  v_readlane_b32 s21, v8, 13
  s_min_u32 s50, s50, s21
  v_readlane_b32 s21, v8, 14
  s_min_u32 s50, s50, s21
  v_readlane_b32 s21, v8, 15
  s_min_u32 s50, s50, s21
  v_readlane_b32 s21, v8, 16
  s_min_u32 s50, s50, s21
  v_readlane_b32 s21, v8, 17
  s_min_u32 s50, s50, s21
  v_readlane_b32 s21, v8, 18
  s_min_u32 s50, s50, s21
  v_readlane_b32 s21, v8, 19
  s_min_u32 s50, s50, s21
  v_readlane_b32 s21, v8, 20
  s_min_u32 s50, s50, s21
  v_readlane_b32 s21, v8, 21
  s_min_u32 s50, s50, s21
  v_readlane_b32 s21, v8, 22
  s_min_u32 s50, s50, s21
  v_readlane_b32 s21, v8, 23
  s_min_u32 s50, s50, s21
  v_readlane_b32 s21, v8, 24
  s_min_u32 s50, s50, s21
  v_readlane_b32 s21, v8, 25
  s_min_u32 s50, s50, s21
  v_readlane_b32 s21, v8, 26
  s_min_u32 s50, s50, s21
  v_readlane_b32 s21, v8, 27
  s_min_u32 s50, s50, s21
  v_readlane_b32 s21, v8, 28
  s_min_u32 s50, s50, s21
  v_readlane_b32 s21, v8, 29
  s_min_u32 s50, s50, s21
  v_readlane_b32 s21, v8, 30
  s_min_u32 s50, s50, s21
  v_readlane_b32 s21, v8, 31
  s_min_u32 s50, s50, s21
pv_334:
  v_cmp_gt_u32 vcc, v19, v27
  s_lshl_b32 s61, s40, 21
  s_lshl_b32 s21, s40, 13
  s_and_b32 s21, s21, 8192
  s_xor_b32 s21, s21, s80
  s_add_u32 s61, s61, s21
  s_lshl_b32 s21, s20, 15
  s_add_u32 s47, s54, s21
  s_add_u32 s48, s61, s60
  s_xor_b32 s68, s61, 8192
  s_add_u32 s68, s68, s53
  s_add_u32 s70, s55, s42
  s_xor_b32 s70, s70, 0
  s_mov_b32 s62, 0
  s_cbranch_vccnz pv_335
  s_mov_b32 s62, 1
  buffer_load_dwordx4 a[0:3], v4, s[16:19], s68 offen offset:0 sc1
  buffer_load_dwordx4 a[4:7], v4, s[16:19], s68 offen offset:1024 sc1
  buffer_load_dwordx4 v[32:35], v22, s[16:19], s48 offen offset:0 sc1
  buffer_load_dwordx4 a[8:11], v4, s[16:19], s70 offen sc1
  s_add_u32 s70, s70, 16384
  buffer_load_dwordx4 a[12:15], v4, s[16:19], s68 offen offset:2048 sc1
  buffer_load_dwordx4 a[16:19], v4, s[16:19], s68 offen offset:3072 sc1
  s_add_u32 s68, s68, 65536
  buffer_load_dwordx4 v[64:67], v4, s[16:19], s47 offen sc1
  buffer_load_dwordx2 v[68:69], v5, s[16:19], s47 offen offset:2048 sc1
  buffer_load_dwordx4 v[128:131], v21, s[16:19], s47 offen offset:1024 sc1
  s_add_u32 s47, s47, 2560
  buffer_load_dwordx4 a[20:23], v4, s[16:19], s68 offen offset:0 sc1
  buffer_load_dwordx4 a[24:27], v4, s[16:19], s68 offen offset:1024 sc1
  buffer_load_dwordx4 v[40:43], v28, s[16:19], s48 offen offset:0 sc1
  buffer_load_dwordx4 a[28:31], v4, s[16:19], s70 offen sc1
  s_add_u32 s70, s70, 16384
  buffer_load_dwordx4 a[32:35], v4, s[16:19], s68 offen offset:2048 sc1
  buffer_load_dwordx4 a[36:39], v4, s[16:19], s68 offen offset:3072 sc1
  s_add_u32 s68, s68, 65536
  buffer_load_dwordx2 v[184:185], v14, s[16:19], s48 offen offset:512 sc1
  buffer_load_dwordx4 v[72:75], v4, s[16:19], s47 offen sc1
  buffer_load_dwordx2 v[76:77], v5, s[16:19], s47 offen offset:2048 sc1
  s_add_u32 s47, s47, 13824
  buffer_load_dwordx4 a[40:43], v4, s[16:19], s68 offen offset:0 sc1
  buffer_load_dwordx4 a[44:47], v4, s[16:19], s68 offen offset:1024 sc1
  buffer_load_dwordx4 v[36:39], v22, s[16:19], s48 offen offset:1280 sc1
  buffer_load_dwordx4 a[48:51], v4, s[16:19], s70 offen sc1
  s_add_u32 s70, s70, 16384
  buffer_load_dwordx4 a[52:55], v4, s[16:19], s68 offen offset:2048 sc1
  buffer_load_dwordx4 a[56:59], v4, s[16:19], s68 offen offset:3072 sc1
  s_add_u32 s68, s68, 65536
  buffer_load_dwordx4 v[80:83], v4, s[16:19], s47 offen sc1
  buffer_load_dwordx2 v[84:85], v5, s[16:19], s47 offen offset:2048 sc1
  buffer_load_dwordx4 v[132:135], v21, s[16:19], s47 offen offset:1024 sc1
  s_add_u32 s47, s47, 2560
  buffer_load_dwordx4 a[60:63], v4, s[16:19], s68 offen offset:0 sc1
  buffer_load_dwordx4 a[64:67], v4, s[16:19], s68 offen offset:1024 sc1
  buffer_load_dwordx4 v[44:47], v28, s[16:19], s48 offen offset:1280 sc1
  buffer_load_dwordx4 a[68:71], v4, s[16:19], s70 offen sc1
  s_add_u32 s70, s70, 16384
  buffer_load_dwordx4 a[72:75], v4, s[16:19], s68 offen offset:2048 sc1
  buffer_load_dwordx4 a[76:79], v4, s[16:19], s68 offen offset:3072 sc1
  s_add_u32 s68, s68, 65536
  buffer_load_dwordx2 v[186:187], v14, s[16:19], s48 offen offset:1792 sc1
  s_add_u32 s48, s48, 262144
  buffer_load_dwordx4 v[88:91], v4, s[16:19], s47 offen sc1
  buffer_load_dwordx2 v[92:93], v5, s[16:19], s47 offen offset:2048 sc1
  s_add_u32 s47, s47, 13824
  s_branch pv_336
pv_335:
  buffer_load_dwordx4 a[0:3], v4, s[16:19], s68 offen offset:0 sc1
  buffer_load_dwordx4 a[4:7], v4, s[16:19], s68 offen offset:1024 sc1
  buffer_load_dwordx4 a[8:11], v4, s[16:19], s70 offen sc1
  s_add_u32 s70, s70, 16384
  buffer_load_dwordx4 a[12:15], v4, s[16:19], s68 offen offset:2048 sc1
  buffer_load_dwordx4 a[16:19], v4, s[16:19], s68 offen offset:3072 sc1
  s_add_u32 s68, s68, 65536
  buffer_load_dwordx4 a[20:23], v4, s[16:19], s68 offen offset:0 sc1
  buffer_load_dwordx4 a[24:27], v4, s[16:19], s68 offen offset:1024 sc1
  buffer_load_dwordx4 a[28:31], v4, s[16:19], s70 offen sc1
  s_add_u32 s70, s70, 16384
  buffer_load_dwordx4 a[32:35], v4, s[16:19], s68 offen offset:2048 sc1
  buffer_load_dwordx4 a[36:39], v4, s[16:19], s68 offen offset:3072 sc1
  s_add_u32 s68, s68, 65536
  buffer_load_dwordx4 a[40:43], v4, s[16:19], s68 offen offset:0 sc1
  buffer_load_dwordx4 a[44:47], v4, s[16:19], s68 offen offset:1024 sc1
  buffer_load_dwordx4 a[48:51], v4, s[16:19], s70 offen sc1
  s_add_u32 s70, s70, 16384
  buffer_load_dwordx4 a[52:55], v4, s[16:19], s68 offen offset:2048 sc1
  buffer_load_dwordx4 a[56:59], v4, s[16:19], s68 offen offset:3072 sc1
  s_add_u32 s68, s68, 65536
  buffer_load_dwordx4 a[60:63], v4, s[16:19], s68 offen offset:0 sc1
  buffer_load_dwordx4 a[64:67], v4, s[16:19], s68 offen offset:1024 sc1
  buffer_load_dwordx4 a[68:71], v4, s[16:19], s70 offen sc1
  s_add_u32 s70, s70, 16384
  buffer_load_dwordx4 a[72:75], v4, s[16:19], s68 offen offset:2048 sc1
  buffer_load_dwordx4 a[76:79], v4, s[16:19], s68 offen offset:3072 sc1
  s_add_u32 s68, s68, 65536
  buffer_load_dwordx4 a[80:83], v4, s[16:19], s68 offen offset:0 sc1
  buffer_load_dwordx4 a[84:87], v4, s[16:19], s68 offen offset:1024 sc1
  buffer_load_dwordx4 a[88:91], v4, s[16:19], s70 offen sc1
  s_add_u32 s70, s70, 16384
  buffer_load_dwordx4 a[92:95], v4, s[16:19], s68 offen offset:2048 sc1
  buffer_load_dwordx4 a[96:99], v4, s[16:19], s68 offen offset:3072 sc1
  s_add_u32 s68, s68, 65536
  buffer_load_dwordx4 a[100:103], v4, s[16:19], s68 offen offset:0 sc1
  buffer_load_dwordx4 a[104:107], v4, s[16:19], s68 offen offset:1024 sc1
  buffer_load_dwordx4 a[108:111], v4, s[16:19], s70 offen sc1
  s_add_u32 s70, s70, 16384
  buffer_load_dwordx4 a[112:115], v4, s[16:19], s68 offen offset:2048 sc1
  buffer_load_dwordx4 a[116:119], v4, s[16:19], s68 offen offset:3072 sc1
  s_add_u32 s68, s68, 65536
  buffer_load_dwordx4 a[120:123], v4, s[16:19], s68 offen offset:0 sc1
  buffer_load_dwordx4 a[124:127], v4, s[16:19], s68 offen offset:1024 sc1
  buffer_load_dwordx4 a[128:131], v4, s[16:19], s70 offen sc1
  s_add_u32 s70, s70, 16384
  buffer_load_dwordx4 a[132:135], v4, s[16:19], s68 offen offset:2048 sc1
  buffer_load_dwordx4 a[136:139], v4, s[16:19], s68 offen offset:3072 sc1
  s_add_u32 s68, s68, 65536
  buffer_load_dwordx4 a[140:143], v4, s[16:19], s68 offen offset:0 sc1
  buffer_load_dwordx4 a[144:147], v4, s[16:19], s68 offen offset:1024 sc1
  buffer_load_dwordx4 a[148:151], v4, s[16:19], s70 offen sc1
  s_add_u32 s70, s70, 16384
  buffer_load_dwordx4 a[152:155], v4, s[16:19], s68 offen offset:2048 sc1
  buffer_load_dwordx4 a[156:159], v4, s[16:19], s68 offen offset:3072 sc1
  s_add_u32 s68, s68, 65536
pv_336:
pv_320:
  s_waitcnt lgkmcnt(0)
  s_barrier
  ds_read_b128 v[144:147], v11 offset:0
  ds_read_b128 v[148:151], v11 offset:10240
  ds_read_b128 v[152:155], v11 offset:20480
  ds_read_b128 v[156:159], v11 offset:30720
  ds_read_b128 v[160:163], v11 offset:2048
  ds_read_b128 v[164:167], v11 offset:12288
  ds_read_b128 v[168:171], v11 offset:22528
  ds_read_b128 v[172:175], v11 offset:32768
  s_waitcnt lgkmcnt(4)
  v_pk_add_f32 v[144:145], v[144:145], v[148:149]
  v_pk_add_f32 v[152:153], v[152:153], v[156:157]
  v_pk_add_f32 v[146:147], v[146:147], v[150:151]
  v_pk_add_f32 v[154:155], v[154:155], v[158:159]
  v_pk_add_f32 v[176:177], v[144:145], v[152:153]
  v_pk_add_f32 v[178:179], v[146:147], v[154:155]
  ds_read_b128 v[144:147], v12 offset:0
  ds_read_b128 v[148:151], v12 offset:10240
  ds_read_b128 v[152:155], v12 offset:20480
  ds_read_b128 v[156:159], v12 offset:30720
  v_cvt_pk_bf16_f32 v26, v176, v177
  v_lshlrev_b32 v176, 16, v26
  v_and_b32 v177, 0xffff0000, v26
  v_mul_f32 v176, v176, v24
  v_mul_f32 v177, v177, v24
  v_cvt_pk_bf16_f32 v26, v176, v177
  v_lshlrev_b32 v176, 16, v26
  v_and_b32 v177, 0xffff0000, v26
  v_add_f32 v176, v176, v240
  v_add_f32 v177, v177, v241
  v_cvt_pk_bf16_f32 v236, v176, v177
  v_cvt_pk_bf16_f32 v26, v178, v179
  v_lshlrev_b32 v178, 16, v26
  v_and_b32 v179, 0xffff0000, v26
  v_mul_f32 v178, v178, v24
  v_mul_f32 v179, v179, v24
  v_cvt_pk_bf16_f32 v26, v178, v179
  v_lshlrev_b32 v178, 16, v26
  v_and_b32 v179, 0xffff0000, v26
  v_add_f32 v178, v178, v242
  v_add_f32 v179, v179, v243
  v_cvt_pk_bf16_f32 v237, v178, v179
  s_waitcnt lgkmcnt(4)
  v_pk_add_f32 v[160:161], v[160:161], v[164:165]
  v_pk_add_f32 v[168:169], v[168:169], v[172:173]
  v_pk_add_f32 v[162:163], v[162:163], v[166:167]
  v_pk_add_f32 v[170:171], v[170:171], v[174:175]
  v_pk_add_f32 v[176:177], v[160:161], v[168:169]
  v_pk_add_f32 v[178:179], v[162:163], v[170:171]
  v_cvt_pk_bf16_f32 v26, v176, v177
  v_lshlrev_b32 v176, 16, v26
  v_and_b32 v177, 0xffff0000, v26
  v_mul_f32 v176, v176, v24
  v_mul_f32 v177, v177, v24
  v_cvt_pk_bf16_f32 v26, v176, v177
  v_lshlrev_b32 v176, 16, v26
  v_and_b32 v177, 0xffff0000, v26
  v_add_f32 v176, v176, v244
  v_add_f32 v177, v177, v245
  v_cvt_pk_bf16_f32 v238, v176, v177
  v_cvt_pk_bf16_f32 v26, v178, v179
  v_lshlrev_b32 v178, 16, v26
  v_and_b32 v179, 0xffff0000, v26
  v_mul_f32 v178, v178, v24
  v_mul_f32 v179, v179, v24
  v_cvt_pk_bf16_f32 v26, v178, v179
  v_lshlrev_b32 v178, 16, v26
  v_and_b32 v179, 0xffff0000, v26
  v_add_f32 v178, v178, v246
  v_add_f32 v179, v179, v247
  v_cvt_pk_bf16_f32 v239, v178, v179
  buffer_store_dwordx4 v[236:239], v9, s[8:11], s46 offen
  s_cmp_lt_u32 s20, 2
  s_cselect_b32 s49, s49, 0x40000000
  s_waitcnt lgkmcnt(0)
  v_pk_add_f32 v[144:145], v[144:145], v[148:149]
  v_pk_add_f32 v[152:153], v[152:153], v[156:157]
  v_pk_add_f32 v[146:147], v[146:147], v[150:151]
  v_pk_add_f32 v[154:155], v[154:155], v[158:159]
  v_pk_add_f32 v[176:177], v[144:145], v[152:153]
  v_pk_add_f32 v[178:179], v[146:147], v[154:155]
  v_cvt_pk_bf16_f32 v26, v176, v177
  v_lshlrev_b32 v176, 16, v26
  v_and_b32 v177, 0xffff0000, v26
  v_mul_f32 v176, v176, v24
  v_mul_f32 v177, v177, v24
  v_cvt_pk_bf16_f32 v26, v176, v177
  v_lshlrev_b32 v176, 16, v26
  v_and_b32 v177, 0xffff0000, v26
  v_add_f32 v176, v176, v248
  v_add_f32 v177, v177, v249
  v_cvt_pk_bf16_f32 v234, v176, v177
  v_cvt_pk_bf16_f32 v26, v178, v179
  v_lshlrev_b32 v178, 16, v26
  v_and_b32 v179, 0xffff0000, v26
  v_mul_f32 v178, v178, v24
  v_mul_f32 v179, v179, v24
  v_cvt_pk_bf16_f32 v26, v178, v179
  v_lshlrev_b32 v178, 16, v26
  v_and_b32 v179, 0xffff0000, v26
  v_add_f32 v178, v178, v250
  v_add_f32 v179, v179, v251
  v_cvt_pk_bf16_f32 v235, v178, v179
  buffer_store_dwordx2 v[234:235], v13, s[8:11], s49 offen offset:64
  s_cmp_lt_u32 s2, 16
  s_cbranch_scc1 pv_loop
  s_cmp_eq_u32 s2, 16
  s_cselect_b32 s87, 0, s87
  s_cmp_eq_u32 s87, 0
  s_cbranch_scc1 pv_done
  s_waitcnt vmcnt(2)
  v_mov_b32 v29, 1
  buffer_atomic_add v29, v233, s[72:75], s59 offen sc0 sc1
  s_waitcnt vmcnt(0)
  s_cmp_lg_u32 s20, 0
  s_cbranch_scc1 pvq_339
  s_mov_b64 exec, 1
  ds_write_b32 v30, v29
  s_mov_b64 exec, -1
pvq_339:
  s_mov_b32 s71, 1
  s_waitcnt lgkmcnt(0)
  s_barrier
  ds_read_b32 v23, v30
  s_branch pv_late
pv_done:
main_fin:
  s_waitcnt vmcnt(0)
main_end:
  s_endpgm
.section .rodata,"a"
.p2align 6
.amdhsa_kernel gated_mix__memory_aug_recurrent_mem_tr__sliding_local_dilated__prompt_kernel
  .amdhsa_next_free_vgpr 512
  .amdhsa_next_free_sgpr 102
  .amdhsa_accum_offset 256
  .amdhsa_group_segment_fixed_size 0
  .amdhsa_kernarg_size 112
  .amdhsa_user_sgpr_count 2
  .amdhsa_user_sgpr_kernarg_segment_ptr 1
  .amdhsa_system_sgpr_workgroup_id_x 1
.end_amdhsa_kernel
.text
```

```asm
; @launch kernel=gated_mix__memory_aug_recurrent_mem_tr__sliding_local_dilated__prompt_kernel grid=(256,1,1) block=(256,1,1) lds=163840
.amdgcn_target "amdgcn-amd-amdhsa--gfx950"
.text
.globl gated_mix__memory_aug_recurrent_mem_tr__sliding_local_dilated__prompt_kernel
.p2align 8
.type gated_mix__memory_aug_recurrent_mem_tr__sliding_local_dilated__prompt_kernel,@function
gated_mix__memory_aug_recurrent_mem_tr__sliding_local_dilated__prompt_kernel:
  s_cmp_ge_u32 s2, 256
  s_cbranch_scc1 end0
  s_load_dwordx2 s[4:5], s[0:1], 96
  s_load_dwordx2 s[38:39], s[0:1], 104
  s_load_dwordx2 s[64:65], s[0:1], 0
  v_lshrrev_b32 v1, 6, v0
  v_and_b32 v2, 15, v0
  v_readfirstlane_b32 s20, v1
  v_and_b32 v1, 63, v0
  v_lshrrev_b32 v3, 4, v1
  s_getreg_b32 s50, hwreg(HW_REG_XCC_ID)
  s_and_b32 s50, s50, 7
  s_waitcnt lgkmcnt(0)
  s_mov_b32 s32, s4
  s_mov_b32 s33, s5
  s_mov_b32 s34, 256
  s_mov_b32 s35, 0x00020000
  v_mov_b32 v21, 0
  s_cmp_lg_u32 s20, 0
  s_cbranch_scc1 rk_1
  s_and_b32 s21, s50, 1
  s_lshl_b32 s21, s21, 7
  s_lshl_b32 s22, s50, 1
  s_and_b32 s22, s22, 12
  s_add_u32 s21, s21, s22
  v_mov_b32 v22, s21
  v_mov_b32 v23, 1
  s_mov_b64 exec, 1
  buffer_atomic_add v23, v22, s[32:35], 0 offen sc0 sc1
  s_waitcnt vmcnt(0)
  v_readfirstlane_b32 s51, v23
  s_lshl_b32 s22, s50, 5
  s_add_u32 s22, s22, s51
  s_cmp_lt_u32 s51, 32
  s_cbranch_scc1 rk_2
  v_mov_b32 v24, 72
  v_mov_b32 v25, 1
  buffer_atomic_add v25, v24, s[32:35], 0 offen sc0 sc1
  s_waitcnt vmcnt(0)
  v_readfirstlane_b32 s23, v25
  s_mov_b32 s101, 0
  s_mov_b64 exec, -1
  v_lshlrev_b32 v24, 2, v1
rk_3:
  s_sleep 8
  buffer_load_dword v25, v24, s[32:35], 0 offen sc1
  s_add_u32 s101, s101, 1
  s_cmp_gt_u32 s101, 131072
  s_cbranch_scc1 end0
  s_waitcnt vmcnt(0)
  v_readlane_b32 s21, v25, 0
  v_readlane_b32 s22, v25, 32
  s_add_u32 s21, s21, s22
  v_readlane_b32 s22, v25, 1
  s_add_u32 s21, s21, s22
  v_readlane_b32 s22, v25, 33
  s_add_u32 s21, s21, s22
  v_readlane_b32 s22, v25, 2
  s_add_u32 s21, s21, s22
  v_readlane_b32 s22, v25, 34
  s_add_u32 s21, s21, s22
  v_readlane_b32 s22, v25, 3
  s_add_u32 s21, s21, s22
  v_readlane_b32 s22, v25, 35
  s_add_u32 s21, s21, s22
  s_cmp_lt_u32 s21, 256
  s_cbranch_scc1 rk_3
  s_mov_b64 exec, 1
  s_mov_b32 s24, 0
rk_5:
  s_and_b32 s21, s24, 1
  s_lshl_b32 s21, s21, 5
  s_lshr_b32 s22, s24, 1
  s_add_u32 s21, s21, s22
  v_readlane_b32 s21, v25, s21
  s_min_u32 s21, s21, 32
  s_sub_u32 s25, 32, s21
  s_cmp_lt_u32 s23, s25
  s_cbranch_scc1 rk_4
  s_sub_u32 s23, s23, s25
  s_add_u32 s24, s24, 1
  s_cmp_lt_u32 s24, 8
  s_cbranch_scc1 rk_5
  s_branch end0
rk_4:
  s_lshl_b32 s22, s24, 5
  s_add_u32 s22, s22, s21
  s_add_u32 s22, s22, s23
  s_or_b32 s22, s22, 0x100
rk_2:
  v_mov_b32 v23, s22
  ds_write_b32 v21, v23
  s_waitcnt lgkmcnt(0)
  s_mov_b64 exec, -1
rk_1:
  s_waitcnt vmcnt(0)
  s_barrier
  ds_read_b32 v23, v21
  s_waitcnt lgkmcnt(0)
  v_readfirstlane_b32 s22, v23
  s_barrier
  s_lshr_b32 s53, s22, 8
  s_and_b32 s22, s22, 255
  s_cmp_ge_u32 s22, 128
  s_cbranch_scc1 gemm_side
  s_lshr_b32 s50, s22, 4
  s_and_b32 s51, s22, 15
  s_load_dwordx2 s[4:5], s[0:1], 8
  s_load_dwordx4 s[40:43], s[0:1], 16
  s_load_dwordx4 s[44:47], s[0:1], 32
  s_load_dwordx2 s[48:49], s[0:1], 104
  s_lshr_b32 s55, s51, 2
  s_and_b32 s56, s51, 3
  s_lshl_b32 s57, s50, 2
  s_add_u32 s58, s57, s55
  s_add_u32 s59, s57, s20
  s_lshr_b32 s60, s51, 1
  s_and_b32 s61, s51, 1
  s_mul_i32 s81, s20, 40960
  v_lshlrev_b32 v4, 4, v1
  s_waitcnt lgkmcnt(0)
  s_mov_b32 s12, s44
  s_mov_b32 s13, s45
  s_mov_b32 s14, 7864320
  s_mov_b32 s15, 0x00020000
  s_mov_b32 s16, s46
  s_mov_b32 s17, s47
  s_mov_b32 s18, 7864320
  s_mov_b32 s19, 0x00020000
  s_mov_b32 s24, s40
  s_mov_b32 s25, s41
  s_mov_b32 s26, 7864320
  s_mov_b32 s27, 0x00020000
  s_mov_b32 s28, s42
  s_mov_b32 s29, s43
  s_mov_b32 s30, 7864320
  s_mov_b32 s31, 0x00020000
  s_mov_b32 s36, s4
  s_mov_b32 s37, s5
  s_mov_b32 s38, 10240
  s_mov_b32 s39, 0x00020000
  s_add_u32 s8, s48, 174063616
  s_addc_u32 s9, s49, 0
  s_mov_b32 s10, 495616
  s_mov_b32 s11, 0x00020000
  s_add_u32 s4, s48, 171966464
  s_addc_u32 s5, s49, 0
  s_mov_b32 s6, 1048576
  s_mov_b32 s7, 0x00020000
  v_add_u32 v66, 0, v1
  v_mul_u32_u24 v67, 2731, v66
  v_lshrrev_b32 v67, 16, v67
  v_mul_u32_u24 v48, 24, v67
  v_sub_u32 v66, v66, v48
  v_mul_u32_u24 v67, 12288, v67
  v_lshl_add_u32 v48, v66, 4, v67
  v_add_u32 v66, 64, v1
  v_mul_u32_u24 v67, 2731, v66
  v_lshrrev_b32 v67, 16, v67
  v_mul_u32_u24 v49, 24, v67
  v_sub_u32 v66, v66, v49
  v_mul_u32_u24 v67, 12288, v67
  v_lshl_add_u32 v49, v66, 4, v67
  v_add_u32 v66, 128, v1
  v_mul_u32_u24 v67, 2731, v66
  v_lshrrev_b32 v67, 16, v67
  v_mul_u32_u24 v50, 24, v67
  v_sub_u32 v66, v66, v50
  v_mul_u32_u24 v67, 12288, v67
  v_lshl_add_u32 v50, v66, 4, v67
  s_mul_i32 s21, s51, 491520
  s_mul_i32 s80, s59, 384
  s_add_u32 s21, s21, s80
  s_mov_b32 s23, s21
  v_add_u32 v66, 0, v1
  v_mul_u32_u24 v67, 10923, v66
  v_lshrrev_b32 v67, 16, v67
  v_mul_u32_u24 v60, 6, v67
  v_sub_u32 v66, v66, v60
  v_mul_u32_u24 v67, 1280, v67
  v_lshl_add_u32 v60, v66, 4, v67
  v_add_u32 v66, 64, v1
  v_mul_u32_u24 v67, 10923, v66
  v_lshrrev_b32 v67, 16, v67
  v_mul_u32_u24 v61, 6, v67
  v_sub_u32 v66, v66, v61
  v_mul_u32_u24 v67, 1280, v67
  v_lshl_add_u32 v61, v66, 4, v67
  v_add_u32 v66, 128, v1
  v_mul_u32_u24 v67, 10923, v66
  v_lshrrev_b32 v67, 16, v67
  v_mul_u32_u24 v62, 6, v67
  v_sub_u32 v66, v66, v62
  v_mul_u32_u24 v67, 1280, v67
  v_lshl_add_u32 v62, v66, 4, v67
  s_mul_i32 s21, s59, 245760
  s_mul_i32 s22, s60, 160
  s_add_u32 s21, s21, s22
  s_lshl_b32 s22, s61, 6
  s_add_u32 s21, s21, s22
  s_add_u32 m0, s81, 0
  s_nop 0
  buffer_load_dwordx4 v60, s[16:19], s21 offen lds
  s_add_u32 m0, s81, 1024
  s_nop 0
  buffer_load_dwordx4 v61, s[16:19], s21 offen lds
  s_add_u32 m0, s81, 2048
  s_nop 0
  buffer_load_dwordx4 v62, s[16:19], s21 offen lds
  s_add_u32 s21, s21, 40960
  s_add_u32 m0, s81, 3072
  s_nop 0
  buffer_load_dwordx4 v60, s[16:19], s21 offen lds
  s_add_u32 m0, s81, 4096
  s_nop 0
  buffer_load_dwordx4 v61, s[16:19], s21 offen lds
  s_add_u32 m0, s81, 5120
  s_nop 0
  buffer_load_dwordx4 v62, s[16:19], s21 offen lds
  s_add_u32 s21, s21, 40960
  s_add_u32 m0, s81, 6144
  s_nop 0
  buffer_load_dwordx4 v60, s[16:19], s21 offen lds
  s_add_u32 m0, s81, 7168
  s_nop 0
  buffer_load_dwordx4 v61, s[16:19], s21 offen lds
  s_add_u32 m0, s81, 8192
  s_nop 0
  buffer_load_dwordx4 v62, s[16:19], s21 offen lds
  s_add_u32 s21, s21, 40960
  s_add_u32 m0, s81, 9216
  s_nop 0
  buffer_load_dwordx4 v60, s[16:19], s21 offen lds
  s_add_u32 m0, s81, 10240
  s_nop 0
  buffer_load_dwordx4 v61, s[16:19], s21 offen lds
  s_add_u32 m0, s81, 11264
  s_nop 0
  buffer_load_dwordx4 v62, s[16:19], s21 offen lds
  s_add_u32 s21, s21, 40960
  s_add_u32 m0, s81, 12288
  s_nop 0
  buffer_load_dwordx4 v60, s[16:19], s21 offen lds
  s_add_u32 m0, s81, 13312
  s_nop 0
  buffer_load_dwordx4 v61, s[16:19], s21 offen lds
  s_add_u32 m0, s81, 14336
  s_nop 0
  buffer_load_dwordx4 v62, s[16:19], s21 offen lds
  s_add_u32 s21, s21, 40960
  s_add_u32 m0, s81, 15360
  s_nop 0
  buffer_load_dwordx4 v60, s[16:19], s21 offen lds
  s_add_u32 m0, s81, 16384
  s_nop 0
  buffer_load_dwordx4 v61, s[16:19], s21 offen lds
  s_add_u32 m0, s81, 17408
  s_nop 0
  buffer_load_dwordx4 v62, s[16:19], s21 offen lds
  s_add_u32 s21, s21, 40960
  v_add_u32 v66, 0, v1
  v_mul_u32_u24 v67, 2731, v66
  v_lshrrev_b32 v67, 16, v67
  v_mul_u32_u24 v48, 24, v67
  v_sub_u32 v66, v66, v48
  v_lshrrev_b32 v48, 2, v67
  v_lshlrev_b32 v48, 1, v48
  v_or_b32 v48, 0, v48
  v_xor_b32 v66, v66, v48
  v_add_u32 v67, 0, v67
  v_mul_u32_u24 v67, 12288, v67
  v_lshl_add_u32 v48, v66, 4, v67
  v_add_u32 v66, 64, v1
  v_mul_u32_u24 v67, 2731, v66
  v_lshrrev_b32 v67, 16, v67
  v_mul_u32_u24 v49, 24, v67
  v_sub_u32 v66, v66, v49
  v_lshrrev_b32 v49, 2, v67
  v_lshlrev_b32 v49, 1, v49
  v_or_b32 v49, 0, v49
  v_xor_b32 v66, v66, v49
  v_add_u32 v67, 0, v67
  v_mul_u32_u24 v67, 12288, v67
  v_lshl_add_u32 v49, v66, 4, v67
  v_add_u32 v66, 128, v1
  v_mul_u32_u24 v67, 2731, v66
  v_lshrrev_b32 v67, 16, v67
  v_mul_u32_u24 v50, 24, v67
  v_sub_u32 v66, v66, v50
  v_lshrrev_b32 v50, 2, v67
  v_lshlrev_b32 v50, 1, v50
  v_or_b32 v50, 0, v50
  v_xor_b32 v66, v66, v50
  v_add_u32 v67, 0, v67
  v_mul_u32_u24 v67, 12288, v67
  v_lshl_add_u32 v50, v66, 4, v67
  v_add_u32 v66, 0, v1
  v_mul_u32_u24 v67, 2731, v66
  v_lshrrev_b32 v67, 16, v67
  v_mul_u32_u24 v51, 24, v67
  v_sub_u32 v66, v66, v51
  v_lshrrev_b32 v51, 2, v67
  v_lshlrev_b32 v51, 1, v51
  v_or_b32 v51, 1, v51
  v_xor_b32 v66, v66, v51
  v_add_u32 v67, 8, v67
  v_mul_u32_u24 v67, 12288, v67
  v_lshl_add_u32 v51, v66, 4, v67
  v_add_u32 v66, 64, v1
  v_mul_u32_u24 v67, 2731, v66
  v_lshrrev_b32 v67, 16, v67
  v_mul_u32_u24 v52, 24, v67
  v_sub_u32 v66, v66, v52
  v_lshrrev_b32 v52, 2, v67
  v_lshlrev_b32 v52, 1, v52
  v_or_b32 v52, 1, v52
  v_xor_b32 v66, v66, v52
  v_add_u32 v67, 8, v67
  v_mul_u32_u24 v67, 12288, v67
  v_lshl_add_u32 v52, v66, 4, v67
  v_add_u32 v66, 128, v1
  v_mul_u32_u24 v67, 2731, v66
  v_lshrrev_b32 v67, 16, v67
  v_mul_u32_u24 v53, 24, v67
  v_sub_u32 v66, v66, v53
  v_lshrrev_b32 v53, 2, v67
  v_lshlrev_b32 v53, 1, v53
  v_or_b32 v53, 1, v53
  v_xor_b32 v66, v66, v53
  v_add_u32 v67, 8, v67
  v_mul_u32_u24 v67, 12288, v67
  v_lshl_add_u32 v53, v66, 4, v67
  v_add_u32 v66, 0, v1
  v_mul_u32_u24 v67, 2731, v66
  v_lshrrev_b32 v67, 16, v67
  v_mul_u32_u24 v54, 24, v67
  v_sub_u32 v66, v66, v54
  v_lshrrev_b32 v54, 2, v67
  v_lshlrev_b32 v54, 1, v54
  v_or_b32 v54, 4, v54
  v_xor_b32 v66, v66, v54
  v_add_u32 v67, 16, v67
  v_mul_u32_u24 v67, 12288, v67
  v_lshl_add_u32 v54, v66, 4, v67
  v_add_u32 v66, 64, v1
  v_mul_u32_u24 v67, 2731, v66
  v_lshrrev_b32 v67, 16, v67
  v_mul_u32_u24 v55, 24, v67
  v_sub_u32 v66, v66, v55
  v_lshrrev_b32 v55, 2, v67
  v_lshlrev_b32 v55, 1, v55
  v_or_b32 v55, 4, v55
  v_xor_b32 v66, v66, v55
  v_add_u32 v67, 16, v67
  v_mul_u32_u24 v67, 12288, v67
  v_lshl_add_u32 v55, v66, 4, v67
  v_add_u32 v66, 128, v1
  v_mul_u32_u24 v67, 2731, v66
  v_lshrrev_b32 v67, 16, v67
  v_mul_u32_u24 v56, 24, v67
  v_sub_u32 v66, v66, v56
  v_lshrrev_b32 v56, 2, v67
  v_lshlrev_b32 v56, 1, v56
  v_or_b32 v56, 4, v56
  v_xor_b32 v66, v66, v56
  v_add_u32 v67, 16, v67
  v_mul_u32_u24 v67, 12288, v67
  v_lshl_add_u32 v56, v66, 4, v67
  v_add_u32 v66, 0, v1
  v_mul_u32_u24 v67, 2731, v66
  v_lshrrev_b32 v67, 16, v67
  v_mul_u32_u24 v57, 24, v67
  v_sub_u32 v66, v66, v57
  v_lshrrev_b32 v57, 2, v67
  v_lshlrev_b32 v57, 1, v57
  v_or_b32 v57, 5, v57
  v_xor_b32 v66, v66, v57
  v_add_u32 v67, 24, v67
  v_mul_u32_u24 v67, 12288, v67
  v_lshl_add_u32 v57, v66, 4, v67
  v_add_u32 v66, 64, v1
  v_mul_u32_u24 v67, 2731, v66
  v_lshrrev_b32 v67, 16, v67
  v_mul_u32_u24 v58, 24, v67
  v_sub_u32 v66, v66, v58
  v_lshrrev_b32 v58, 2, v67
  v_lshlrev_b32 v58, 1, v58
  v_or_b32 v58, 5, v58
  v_xor_b32 v66, v66, v58
  v_add_u32 v67, 24, v67
  v_mul_u32_u24 v67, 12288, v67
  v_lshl_add_u32 v58, v66, 4, v67
  v_add_u32 v66, 128, v1
  v_mul_u32_u24 v67, 2731, v66
  v_lshrrev_b32 v67, 16, v67
  v_mul_u32_u24 v59, 24, v67
  v_sub_u32 v66, v66, v59
  v_lshrrev_b32 v59, 2, v67
  v_lshlrev_b32 v59, 1, v59
  v_or_b32 v59, 5, v59
  v_xor_b32 v66, v66, v59
  v_add_u32 v67, 24, v67
  v_mul_u32_u24 v67, 12288, v67
  v_lshl_add_u32 v59, v66, 4, v67
  s_add_u32 m0, s81, 24576
  s_nop 0
  buffer_load_dwordx4 v48, s[12:15], s80 offen lds
  s_add_u32 m0, s81, 25600
  s_nop 0
  buffer_load_dwordx4 v49, s[12:15], s80 offen lds
  s_add_u32 m0, s81, 26624
  s_nop 0
  buffer_load_dwordx4 v50, s[12:15], s80 offen lds
  s_add_u32 m0, s81, 27648
  s_nop 0
  buffer_load_dwordx4 v51, s[12:15], s80 offen lds
  s_add_u32 m0, s81, 28672
  s_nop 0
  buffer_load_dwordx4 v52, s[12:15], s80 offen lds
  s_add_u32 m0, s81, 29696
  s_nop 0
  buffer_load_dwordx4 v53, s[12:15], s80 offen lds
  s_add_u32 m0, s81, 30720
  s_nop 0
  buffer_load_dwordx4 v54, s[12:15], s80 offen lds
  s_add_u32 m0, s81, 31744
  s_nop 0
  buffer_load_dwordx4 v55, s[12:15], s80 offen lds
  s_add_u32 m0, s81, 32768
  s_nop 0
  buffer_load_dwordx4 v56, s[12:15], s80 offen lds
  s_add_u32 m0, s81, 33792
  s_nop 0
  buffer_load_dwordx4 v57, s[12:15], s80 offen lds
  s_add_u32 m0, s81, 34816
  s_nop 0
  buffer_load_dwordx4 v58, s[12:15], s80 offen lds
  s_add_u32 m0, s81, 35840
  s_nop 0
  buffer_load_dwordx4 v59, s[12:15], s80 offen lds
  s_add_u32 s80, s80, 393216
  v_add_u32 v66, 0, v1
  v_mul_u32_u24 v67, 10923, v66
  v_lshrrev_b32 v67, 16, v67
  v_mul_u32_u24 v63, 6, v67
  v_sub_u32 v66, v66, v63
  v_mul_u32_u24 v67, 12288, v67
  v_lshl_add_u32 v63, v66, 4, v67
  v_add_u32 v66, 64, v1
  v_mul_u32_u24 v67, 10923, v66
  v_lshrrev_b32 v67, 16, v67
  v_mul_u32_u24 v64, 6, v67
  v_sub_u32 v66, v66, v64
  v_mul_u32_u24 v67, 12288, v67
  v_lshl_add_u32 v64, v66, 4, v67
  v_add_u32 v66, 128, v1
  v_mul_u32_u24 v67, 10923, v66
  v_lshrrev_b32 v67, 16, v67
  v_mul_u32_u24 v65, 6, v67
  v_sub_u32 v66, v66, v65
  v_mul_u32_u24 v67, 12288, v67
  v_lshl_add_u32 v65, v66, 4, v67
  s_mul_i32 s79, s58, 384
  s_mul_i32 s22, s56, 96
  s_add_u32 s79, s79, s22
  s_mul_i32 s22, s20, 1966080
  s_add_u32 s79, s79, s22
  v_and_b32 v224, 7, v2
  v_lshrrev_b32 v225, 3, v2
  v_lshlrev_b32 v12, 3, v1
  v_mov_b32 v23, 0
  v_mov_b32 v226, 0x4444
  v_mov_b32 v227, 0xeeee
  v_cmp_eq_u32 vcc, 1, v225
  v_cmp_gt_u32 s[62:63], 8, v2
  v_cmp_le_u32 s[68:69], 8, v2
  v_cndmask_b32 v22, v226, v227, vcc
  v_cmp_gt_u32 vcc, 32, v1
  v_mov_b32 v226, 0x3dd53b95
  v_cmp_gt_u32 s[66:67], 40, v1
  v_cndmask_b32 v24, 1.0, v226, vcc
  v_cndmask_b32 v25, 1.0, v226, vcc
  v_min_u32 v226, 39, v1
  v_and_b32 v227, 31, v1
  v_lshlrev_b32 v227, 2, v227
  v_lshl_add_u32 v5, v226, 7, v227
  v_mul_u32_u24 v226, 192, v3
  v_lshl_add_u32 v226, v2, 3, v226
  s_mul_i32 s21, s20, 768
  s_add_u32 s21, s21, 10240
  v_add_u32 v6, s21, v226
  v_and_b32 v226, 3, v2
  v_mul_u32_u24 v226, 192, v226
  v_lshrrev_b32 v227, 2, v2
  v_lshl_add_u32 v227, v3, 2, v227
  v_lshl_add_u32 v226, v227, 3, v226
  v_add_u32 v7, 10240, v226
  s_mul_i32 s21, s58, 2560
  s_add_u32 s21, s21, 40960
  s_lshr_b32 s22, s56, 1
  s_lshl_b32 s22, s22, 10
  s_and_b32 s23, s56, 1
  s_lshl_b32 s23, s23, 3
  s_add_u32 s22, s22, s23
  s_lshl_b32 s23, s20, 7
  s_add_u32 s22, s22, s23
  s_add_u32 s22, s22, s21
  v_lshlrev_b32 v226, 8, v3
  v_lshl_add_u32 v226, v224, 4, v226
  v_add_u32 v8, s22, v226
  s_lshl_b32 s22, s56, 2
  s_add_u32 s22, s22, s21
  s_add_u32 s22, s22, 2048
  v_and_b32 v226, 0x1ff, v226
  v_add_u32 v226, s22, v226
  s_cmp_eq_u32 s20, 2
  s_cselect_b64 vcc, -1, 0
  v_cmp_le_u32 s[64:65], 32, v1
  v_cndmask_b32 v8, v8, v226, vcc
  s_cselect_b64 s[64:65], s[64:65], -1
  s_and_b64 s[64:65], s[64:65], s[62:63]
  s_mul_i32 s21, s59, 2560
  s_add_u32 s21, s21, 40960
  v_add_u32 v9, s21, v4
  v_and_b32 v226, 0x1ff, v4
  s_add_u32 s21, s21, 2048
  v_add_u32 v10, s21, v226
  v_lshrrev_b32 v226, 2, v2
  v_and_b32 v227, 1, v2
  v_lshl_add_u32 v228, v226, 1, v227
  v_and_b32 v227, 2, v2
  v_cmp_eq_u32 vcc, 0, v227
  s_lshr_b32 s21, s20, 1
  s_lshl_b32 s21, s21, 9
  s_and_b32 s22, s20, 1
  s_lshl_b32 s22, s22, 6
  s_add_u32 s21, s21, s22
  s_add_u32 s21, s21, 12544
  v_lshlrev_b32 v226, 7, v3
  v_lshl_add_u32 v226, v228, 3, v226
  v_add_u32 v226, s21, v226
  v_mov_b32 v227, 13568
  v_cndmask_b32 v11, v227, v226, vcc
  s_lshl_b32 s21, s20, 9
  s_add_u32 s21, s21, 40960
  v_lshlrev_b32 v226, 7, v3
  v_lshl_add_u32 v226, v228, 4, v226
  v_add_u32 v226, s21, v226
  v_mov_b32 v227, 46080
  v_cndmask_b32 v19, v227, v226, vcc
  s_lshl_b32 s21, s20, 11
  s_add_u32 s21, s21, 32768
  v_add_u32 v18, s21, v4
  s_and_b32 s21, s20, 1
  s_lshl_b32 s22, s21, 10
  s_add_u32 s22, s22, 43008
  v_add_u32 v20, s22, v4
  s_lshl_b32 s22, s21, 3
  s_add_u32 s22, s22, 45056
  v_add_u32 v21, s22, v4
  s_mul_i32 s21, s20, 640
  s_add_u32 s22, s21, 13824
  v_lshlrev_b32 v226, 4, v224
  v_lshl_add_u32 v227, v3, 7, v226
  v_add_u32 v13, s22, v227
  v_lshl_add_u32 v227, v3, 2, v226
  s_add_u32 s22, s22, 512
  v_add_u32 v14, s22, v227
  v_lshrrev_b32 v228, 5, v1
  v_add_u32 v26, s21, v4
  v_lshl_add_u32 v228, v228, 1, v225
  v_mul_u32_u24 v228, 640, v228
  v_and_b32 v226, 1, v3
  v_lshl_add_u32 v228, v226, 6, v228
  v_lshl_add_u32 v228, v224, 3, v228
  v_add_u32 v43, 512, v228
  s_and_b32 s21, s50, 1
  s_lshl_b32 s21, s21, 4
  s_add_u32 s21, s21, s51
  s_lshl_b32 s22, s20, 5
  s_add_u32 s21, s21, s22
  s_cmp_lt_u32 s21, 80
  s_cselect_b32 s78, 1, 0
  s_cselect_b32 s21, s21, 0
  s_lshl_b32 s22, s21, 7
  v_add_u32 v17, s22, v227
  s_lshr_b32 s22, s21, 3
  s_lshl_b32 s22, s22, 14
  s_and_b32 s21, s21, 7
  s_lshl_b32 s21, s21, 10
  s_add_u32 s21, s21, s22
  v_add_u32 v16, s21, v4
  s_mul_i32 s21, s60, 10
  s_mul_i32 s22, s61, 6
  s_add_u32 s22, s22, s21
  s_add_u32 s21, s21, s61
  s_add_u32 s21, s21, 4
  v_lshrrev_b32 v226, 3, v1
  v_cmp_gt_u32 vcc, 4, v226
  v_add_u32 v226, s22, v226
  v_mov_b32 v227, s21
  v_cndmask_b32 v226, v227, v226, vcc
  v_lshrrev_b32 v227, 3, v226
  v_lshlrev_b32 v227, 14, v227
  v_and_b32 v226, 7, v226
  v_lshl_add_u32 v226, v226, 10, v227
  v_lshl_add_u32 v226, v224, 4, v226
  s_lshl_b32 s21, s50, 7
  v_add_u32 v15, s21, v226
  v_and_b32 v226, 1, v2
  v_lshlrev_b32 v226, 4, v226
  v_mov_b32 v227, 0x3c00
  v_lshlrev_b32 v226, v226, v227
  v_lshrrev_b32 v227, 1, v2
  v_cmp_eq_u32 vcc, 0, v227
  s_nop 1
  v_cndmask_b32 v44, 0, v226, vcc
  v_cmp_eq_u32 vcc, 2, v227
  s_nop 1
  v_cndmask_b32 v45, 0, v226, vcc
  v_cmp_eq_u32 vcc, 4, v227
  s_nop 1
  v_cndmask_b32 v46, 0, v226, vcc
  v_cmp_eq_u32 vcc, 6, v227
  s_nop 1
  v_cndmask_b32 v47, 0, v226, vcc
  v_lshrrev_b32 v226, 5, v1
  v_lshlrev_b32 v226, 14, v226
  v_bfe_u32 v227, v1, 3, 2
  v_lshl_add_u32 v226, v227, 8, v226
  v_lshl_add_u32 v226, v224, 4, v226
  s_lshl_b32 s21, s61, 7
  v_add_u32 v32, s21, v226
  v_lshlrev_b32 v226, 4, v224
  v_lshl_add_u32 v36, v3, 7, v226
  v_lshrrev_b32 v37, 1, v36
  v_and_b32 v41, 3, v1
  v_lshlrev_b32 v41, 7, v41
  v_mov_b32 v226, 0x40000000
  v_cmp_gt_u32 vcc, 32, v1
  v_cndmask_b32 v36, v226, v36, s[68:69]
  v_cndmask_b32 v37, v226, v37, s[68:69]
  v_cndmask_b32 v26, v226, v26, vcc
  s_lshr_b32 s21, s50, 1
  s_lshl_b32 s21, s21, 8
  s_add_u32 s21, s21, 491520
  v_and_b32 v227, 31, v1
  v_lshl_add_u32 v33, v227, 2, s21
  s_and_b32 s22, s50, 1
  s_lshl_b32 s22, s22, 4
  s_add_u32 s22, s22, s51
  v_cmp_eq_u32 vcc, s22, v1
  s_nop 1
  v_cndmask_b32 v34, v226, v33, vcc
  v_mov_b32 v28, -1
  v_mov_b32 v29, -1
  v_mov_b32 v30, -1
  v_mov_b32 v31, -1
  s_lshr_b32 s21, s50, 1
  s_mul_i32 s77, s21, 10240
  s_cmp_eq_u32 s20, 3
  s_cbranch_scc1 ar_8
  s_mov_b64 exec, s[64:65]
  s_cmp_eq_u32 s20, 2
  s_cbranch_scc1 ar_7
  s_mov_b32 s21, 0
  buffer_store_dwordx2 v[28:29], v8, s[8:11], s21 offen
  s_mov_b32 s21, 122880
  buffer_store_dwordx2 v[28:29], v8, s[8:11], s21 offen
  s_mov_b32 s21, 245760
  buffer_store_dwordx2 v[28:29], v8, s[8:11], s21 offen
  s_mov_b32 s21, 368640
  buffer_store_dwordx2 v[28:29], v8, s[8:11], s21 offen
  s_branch ar_9
ar_7:
  s_mov_b32 s21, 0
  buffer_store_dword v28, v8, s[8:11], s21 offen
  buffer_store_dword v28, v8, s[8:11], s21 offen offset:128
  s_mov_b32 s21, 122880
  buffer_store_dword v28, v8, s[8:11], s21 offen
  buffer_store_dword v28, v8, s[8:11], s21 offen offset:128
  s_mov_b32 s21, 245760
  buffer_store_dword v28, v8, s[8:11], s21 offen
  buffer_store_dword v28, v8, s[8:11], s21 offen offset:128
  s_mov_b32 s21, 368640
  buffer_store_dword v28, v8, s[8:11], s21 offen
  buffer_store_dword v28, v8, s[8:11], s21 offen offset:128
ar_9:
  s_cmp_eq_u32 s78, 0
  s_cbranch_scc1 ar_10
  s_mov_b64 exec, s[62:63]
  s_add_u32 s21, s77, 0
  buffer_store_dword v28, v17, s[8:11], s21 offen
  s_add_u32 s21, s77, 122880
  buffer_store_dword v28, v17, s[8:11], s21 offen
  s_add_u32 s21, s77, 245760
  buffer_store_dword v28, v17, s[8:11], s21 offen
  s_add_u32 s21, s77, 368640
  buffer_store_dword v28, v17, s[8:11], s21 offen
  s_branch ar_10
ar_8:
  buffer_store_dword v28, v34, s[8:11], 0 offen
  s_mov_b64 exec, s[66:67]
  s_mov_b32 s21, 0
  buffer_store_dwordx4 v[28:31], v15, s[4:7], s21 offen sc1
  s_mov_b32 s21, 262144
  buffer_store_dwordx4 v[28:31], v15, s[4:7], s21 offen sc1
  s_mov_b32 s21, 524288
  buffer_store_dwordx4 v[28:31], v15, s[4:7], s21 offen sc1
  s_mov_b32 s21, 786432
  buffer_store_dwordx4 v[28:31], v15, s[4:7], s21 offen sc1
  s_mov_b32 s21, 8192
  buffer_store_dwordx4 v[28:31], v15, s[4:7], s21 offen sc1
  s_mov_b32 s21, 270336
  buffer_store_dwordx4 v[28:31], v15, s[4:7], s21 offen sc1
  s_mov_b32 s21, 532480
  buffer_store_dwordx4 v[28:31], v15, s[4:7], s21 offen sc1
  s_mov_b32 s21, 794624
  buffer_store_dwordx4 v[28:31], v15, s[4:7], s21 offen sc1
ar_10:
  s_mov_b64 exec, -1
  v_lshrrev_b32 v66, 2, v2
  v_lshl_add_u32 v66, v3, 3, v66
  v_mul_u32_u24 v66, 96, v66
  v_add_u32 v66, s81, v66
  v_and_b32 v67, 3, v2
  s_lshl_b32 s21, s61, 5
  v_lshl_add_u32 v68, v67, 4, v66
  v_add_u32 v68, s21, v68
  s_mul_i32 s21, s61, 48
  s_sub_u32 s21, 64, s21
  v_and_b32 v67, 1, v2
  v_lshl_add_u32 v69, v67, 3, v66
  v_add_u32 v69, s21, v69
  v_lshrrev_b32 v226, 3, v2
  v_lshlrev_b32 v226, 4, v226
  v_bfe_u32 v227, v2, 1, 1
  v_lshl_add_u32 v226, v227, 3, v226
  v_and_b32 v227, 5, v2
  v_add_u32 v226, v226, v227
  v_mul_u32_u24 v226, 384, v226
  v_add_u32 v226, s81, v226
  v_lshrrev_b32 v227, 1, v2
  v_xor_b32 v227, v227, v3
  v_lshl_add_u32 v70, v227, 4, v226
  v_xor_b32 v227, 4, v227
  v_lshl_add_u32 v71, v227, 4, v226
  s_waitcnt vmcnt(0)
  ds_read_b64_tr_b16 v[72:73], v68 offset:0
  ds_read_b64_tr_b16 v[74:75], v68 offset:384
  ds_read_b64_tr_b16 v[76:77], v68 offset:8
  ds_read_b64_tr_b16 v[78:79], v68 offset:392
  ds_read_b64_tr_b16 v[80:81], v69 offset:0
  ds_read_b64_tr_b16 v[82:83], v69 offset:384
  ds_read_b64_tr_b16 v[84:85], v68 offset:3072
  ds_read_b64_tr_b16 v[86:87], v68 offset:3456
  ds_read_b64_tr_b16 v[88:89], v68 offset:3080
  ds_read_b64_tr_b16 v[90:91], v68 offset:3464
  ds_read_b64_tr_b16 v[92:93], v69 offset:3072
  ds_read_b64_tr_b16 v[94:95], v69 offset:3456
  ds_read_b64_tr_b16 v[96:97], v68 offset:6144
  ds_read_b64_tr_b16 v[98:99], v68 offset:6528
  ds_read_b64_tr_b16 v[100:101], v68 offset:6152
  ds_read_b64_tr_b16 v[102:103], v68 offset:6536
  ds_read_b64_tr_b16 v[104:105], v69 offset:6144
  ds_read_b64_tr_b16 v[106:107], v69 offset:6528
  ds_read_b64_tr_b16 v[108:109], v68 offset:9216
  ds_read_b64_tr_b16 v[110:111], v68 offset:9600
  ds_read_b64_tr_b16 v[112:113], v68 offset:9224
  ds_read_b64_tr_b16 v[114:115], v68 offset:9608
  ds_read_b64_tr_b16 v[116:117], v69 offset:9216
  ds_read_b64_tr_b16 v[118:119], v69 offset:9600
  ds_read_b64_tr_b16 v[120:121], v68 offset:12288
  ds_read_b64_tr_b16 v[122:123], v68 offset:12672
  ds_read_b64_tr_b16 v[124:125], v68 offset:12296
  ds_read_b64_tr_b16 v[126:127], v68 offset:12680
  ds_read_b64_tr_b16 v[128:129], v69 offset:12288
  ds_read_b64_tr_b16 v[130:131], v69 offset:12672
  ds_read_b64_tr_b16 v[132:133], v68 offset:15360
  ds_read_b64_tr_b16 v[134:135], v68 offset:15744
  ds_read_b64_tr_b16 v[136:137], v68 offset:15368
  ds_read_b64_tr_b16 v[138:139], v68 offset:15752
  ds_read_b64_tr_b16 v[140:141], v69 offset:15360
  ds_read_b64_tr_b16 v[142:143], v69 offset:15744
  s_waitcnt lgkmcnt(0)
  s_barrier
  s_cmp_lg_u32 s20, 0
  s_cbranch_scc1 ic_11
  v_mov_b32 v68, 64
  v_mov_b32 v69, 1
  s_mov_b64 exec, 1
  buffer_atomic_add v69, v68, s[32:35], 0 offen sc1
  s_mov_b64 exec, -1
ic_11:
  s_add_u32 m0, s81, 0
  s_nop 0
  buffer_load_dwordx4 v48, s[12:15], s80 offen lds
  s_add_u32 m0, s81, 1024
  s_nop 0
  buffer_load_dwordx4 v49, s[12:15], s80 offen lds
  s_add_u32 m0, s81, 2048
  s_nop 0
  buffer_load_dwordx4 v50, s[12:15], s80 offen lds
  s_add_u32 m0, s81, 3072
  s_nop 0
  buffer_load_dwordx4 v51, s[12:15], s80 offen lds
  s_add_u32 m0, s81, 4096
  s_nop 0
  buffer_load_dwordx4 v52, s[12:15], s80 offen lds
  s_add_u32 m0, s81, 5120
  s_nop 0
  buffer_load_dwordx4 v53, s[12:15], s80 offen lds
  s_add_u32 m0, s81, 6144
  s_nop 0
  buffer_load_dwordx4 v54, s[12:15], s80 offen lds
  s_add_u32 m0, s81, 7168
  s_nop 0
  buffer_load_dwordx4 v55, s[12:15], s80 offen lds
  s_add_u32 m0, s81, 8192
  s_nop 0
  buffer_load_dwordx4 v56, s[12:15], s80 offen lds
  s_add_u32 m0, s81, 9216
  s_nop 0
  buffer_load_dwordx4 v57, s[12:15], s80 offen lds
  s_add_u32 m0, s81, 10240
  s_nop 0
  buffer_load_dwordx4 v58, s[12:15], s80 offen lds
  s_add_u32 m0, s81, 11264
  s_nop 0
  buffer_load_dwordx4 v59, s[12:15], s80 offen lds
  s_add_u32 s80, s80, 393216
  s_add_u32 s16, s48, 173080576
  s_addc_u32 s17, s49, 0
  s_mov_b32 s18, 49152
  s_mov_b32 s19, 0x00020000
  v_add_u32 v68, s81, v4
  v_and_b32 v69, 7, v2
  v_lshl_add_u32 v69, v3, 3, v69
  v_and_b32 v67, 8, v2
  v_lshl_add_u32 v69, v69, 4, v67
  v_add_u32 v69, s81, v69
  v_lshlrev_b32 v67, 2, v1
  s_lshl_b32 s90, s50, 9
  s_and_b32 s21, s51, 12
  s_add_u32 s90, s90, s21
  s_add_u32 s90, s90, 4096
  ds_read_b128 v[208:211], v70 offset:24576
  ds_read_b128 v[212:215], v71 offset:24576
  ds_read_b128 v[216:219], v70 offset:24704
  s_waitcnt lgkmcnt(2)
  v_mfma_f32_16x16x32_bf16 v[184:187], v[208:211], v[72:75], 0
  ds_read_b128 v[220:223], v71 offset:24704
  v_mfma_f32_16x16x32_bf16 v[188:191], v[208:211], v[76:79], 0
  s_add_u32 m0, s81, 12288
  s_nop 0
  buffer_load_dwordx4 v48, s[12:15], s80 offen lds
  v_mfma_f32_16x16x32_bf16 v[192:195], v[208:211], v[80:83], 0
  s_waitcnt lgkmcnt(2)
  v_mfma_f32_16x16x32_bf16 v[184:187], v[212:215], v[84:87], v[184:187]
  ds_read_b128 v[208:211], v70 offset:24832
  v_mfma_f32_16x16x32_bf16 v[188:191], v[212:215], v[88:91], v[188:191]
  s_add_u32 m0, s81, 13312
  s_nop 0
  buffer_load_dwordx4 v49, s[12:15], s80 offen lds
  v_mfma_f32_16x16x32_bf16 v[192:195], v[212:215], v[92:95], v[192:195]
  s_waitcnt lgkmcnt(2)
  v_mfma_f32_16x16x32_bf16 v[184:187], v[216:219], v[96:99], v[184:187]
  ds_read_b128 v[212:215], v71 offset:24832
  v_mfma_f32_16x16x32_bf16 v[188:191], v[216:219], v[100:103], v[188:191]
  s_add_u32 m0, s81, 14336
  s_nop 0
  buffer_load_dwordx4 v50, s[12:15], s80 offen lds
  v_mfma_f32_16x16x32_bf16 v[192:195], v[216:219], v[104:107], v[192:195]
  s_waitcnt lgkmcnt(2)
  v_mfma_f32_16x16x32_bf16 v[184:187], v[220:223], v[108:111], v[184:187]
  ds_read_b128 v[216:219], v70 offset:25344
  v_mfma_f32_16x16x32_bf16 v[188:191], v[220:223], v[112:115], v[188:191]
  s_add_u32 m0, s81, 15360
  s_nop 0
  buffer_load_dwordx4 v51, s[12:15], s80 offen lds
  v_mfma_f32_16x16x32_bf16 v[192:195], v[220:223], v[116:119], v[192:195]
  s_waitcnt lgkmcnt(2)
  v_mfma_f32_16x16x32_bf16 v[184:187], v[208:211], v[120:123], v[184:187]
  ds_read_b128 v[220:223], v71 offset:25344
  v_mfma_f32_16x16x32_bf16 v[188:191], v[208:211], v[124:127], v[188:191]
  s_add_u32 m0, s81, 16384
  s_nop 0
  buffer_load_dwordx4 v52, s[12:15], s80 offen lds
  v_mfma_f32_16x16x32_bf16 v[192:195], v[208:211], v[128:131], v[192:195]
  s_waitcnt lgkmcnt(2)
  v_mfma_f32_16x16x32_bf16 v[184:187], v[212:215], v[132:135], v[184:187]
  ds_read_b128 v[208:211], v70 offset:25472
  v_mfma_f32_16x16x32_bf16 v[188:191], v[212:215], v[136:139], v[188:191]
  s_add_u32 m0, s81, 17408
  s_nop 0
  buffer_load_dwordx4 v53, s[12:15], s80 offen lds
  v_mfma_f32_16x16x32_bf16 v[192:195], v[212:215], v[140:143], v[192:195]
  s_waitcnt lgkmcnt(2)
  v_mfma_f32_16x16x32_bf16 v[196:199], v[216:219], v[72:75], 0
  ds_read_b128 v[212:215], v71 offset:25472
  v_mfma_f32_16x16x32_bf16 v[200:203], v[216:219], v[76:79], 0
  s_add_u32 m0, s81, 18432
  s_nop 0
  buffer_load_dwordx4 v54, s[12:15], s80 offen lds
  v_mfma_f32_16x16x32_bf16 v[204:207], v[216:219], v[80:83], 0
  s_waitcnt lgkmcnt(2)
  v_mfma_f32_16x16x32_bf16 v[196:199], v[220:223], v[84:87], v[196:199]
  ds_read_b128 v[216:219], v70 offset:25600
  v_cvt_pk_bf16_f32 v248, v184, v185
  v_mfma_f32_16x16x32_bf16 v[200:203], v[220:223], v[88:91], v[200:203]
  s_add_u32 m0, s81, 19456
  s_nop 0
  buffer_load_dwordx4 v55, s[12:15], s80 offen lds
  v_mfma_f32_16x16x32_bf16 v[204:207], v[220:223], v[92:95], v[204:207]
  v_cvt_pk_bf16_f32 v249, v186, v187
  s_waitcnt lgkmcnt(2)
  v_mfma_f32_16x16x32_bf16 v[196:199], v[208:211], v[96:99], v[196:199]
  ds_read_b128 v[220:223], v71 offset:25600
  v_cvt_pk_bf16_f32 v250, v188, v189
  v_mfma_f32_16x16x32_bf16 v[200:203], v[208:211], v[100:103], v[200:203]
  s_add_u32 m0, s81, 20480
  s_nop 0
  buffer_load_dwordx4 v56, s[12:15], s80 offen lds
  v_mfma_f32_16x16x32_bf16 v[204:207], v[208:211], v[104:107], v[204:207]
  v_cvt_pk_bf16_f32 v251, v190, v191
  s_waitcnt lgkmcnt(2)
  v_mfma_f32_16x16x32_bf16 v[196:199], v[212:215], v[108:111], v[196:199]
  v_accvgpr_write_b32 a0, v248
  v_mfma_f32_16x16x32_bf16 v[200:203], v[212:215], v[112:115], v[200:203]
  s_add_u32 m0, s81, 21504
  s_nop 0
  buffer_load_dwordx4 v57, s[12:15], s80 offen lds
  v_mfma_f32_16x16x32_bf16 v[204:207], v[212:215], v[116:119], v[204:207]
  v_accvgpr_write_b32 a1, v249
  s_waitcnt lgkmcnt(1)
  v_mfma_f32_16x16x32_bf16 v[196:199], v[216:219], v[120:123], v[196:199]
  v_accvgpr_write_b32 a80, v250
  v_mfma_f32_16x16x32_bf16 v[200:203], v[216:219], v[124:127], v[200:203]
  s_add_u32 m0, s81, 22528
  s_nop 0
  buffer_load_dwordx4 v58, s[12:15], s80 offen lds
  v_mfma_f32_16x16x32_bf16 v[204:207], v[216:219], v[128:131], v[204:207]
  v_accvgpr_write_b32 a81, v251
  s_waitcnt lgkmcnt(0)
  v_mfma_f32_16x16x32_bf16 v[196:199], v[220:223], v[132:135], v[196:199]
  v_cvt_pk_bf16_f32 v144, v192, v193
  v_cvt_pk_bf16_f32 v145, v194, v195
  v_mfma_f32_16x16x32_bf16 v[200:203], v[220:223], v[136:139], v[200:203]
  s_add_u32 m0, s81, 23552
  s_nop 0
  buffer_load_dwordx4 v59, s[12:15], s80 offen lds
  s_add_u32 s80, s80, 393216
  v_mfma_f32_16x16x32_bf16 v[204:207], v[220:223], v[140:143], v[204:207]
  s_waitcnt vmcnt(12)
  ds_read_b128 v[208:211], v70 offset:0
  ds_read_b128 v[212:215], v71 offset:0
  ds_read_b128 v[216:219], v70 offset:128
  s_waitcnt lgkmcnt(2)
  v_mfma_f32_16x16x32_bf16 v[184:187], v[208:211], v[72:75], 0
  ds_read_b128 v[220:223], v71 offset:128
  v_mfma_f32_16x16x32_bf16 v[188:191], v[208:211], v[76:79], 0
  s_add_u32 m0, s81, 24576
  s_nop 0
  buffer_load_dwordx4 v48, s[12:15], s80 offen lds
  v_mfma_f32_16x16x32_bf16 v[192:195], v[208:211], v[80:83], 0
  s_waitcnt lgkmcnt(2)
  v_mfma_f32_16x16x32_bf16 v[184:187], v[212:215], v[84:87], v[184:187]
  ds_read_b128 v[208:211], v70 offset:256
  v_cvt_pk_bf16_f32 v248, v196, v197
  v_mfma_f32_16x16x32_bf16 v[188:191], v[212:215], v[88:91], v[188:191]
  s_add_u32 m0, s81, 25600
  s_nop 0
  buffer_load_dwordx4 v49, s[12:15], s80 offen lds
  v_mfma_f32_16x16x32_bf16 v[192:195], v[212:215], v[92:95], v[192:195]
  v_cvt_pk_bf16_f32 v249, v198, v199
  s_waitcnt lgkmcnt(2)
  v_mfma_f32_16x16x32_bf16 v[184:187], v[216:219], v[96:99], v[184:187]
  ds_read_b128 v[212:215], v71 offset:256
  v_cvt_pk_bf16_f32 v250, v200, v201
  v_mfma_f32_16x16x32_bf16 v[188:191], v[216:219], v[100:103], v[188:191]
  s_add_u32 m0, s81, 26624
  s_nop 0
  buffer_load_dwordx4 v50, s[12:15], s80 offen lds
  v_mfma_f32_16x16x32_bf16 v[192:195], v[216:219], v[104:107], v[192:195]
  v_cvt_pk_bf16_f32 v251, v202, v203
  s_waitcnt lgkmcnt(2)
  v_mfma_f32_16x16x32_bf16 v[184:187], v[220:223], v[108:111], v[184:187]
  ds_read_b128 v[216:219], v70 offset:768
  v_accvgpr_write_b32 a2, v248
  v_mfma_f32_16x16x32_bf16 v[188:191], v[220:223], v[112:115], v[188:191]
  s_add_u32 m0, s81, 27648
  s_nop 0
  buffer_load_dwordx4 v51, s[12:15], s80 offen lds
  v_mfma_f32_16x16x32_bf16 v[192:195], v[220:223], v[116:119], v[192:195]
  v_accvgpr_write_b32 a3, v249
  s_waitcnt lgkmcnt(2)
  v_mfma_f32_16x16x32_bf16 v[184:187], v[208:211], v[120:123], v[184:187]
  ds_read_b128 v[220:223], v71 offset:768
  v_accvgpr_write_b32 a82, v250
  v_mfma_f32_16x16x32_bf16 v[188:191], v[208:211], v[124:127], v[188:191]
  s_add_u32 m0, s81, 28672
  s_nop 0
  buffer_load_dwordx4 v52, s[12:15], s80 offen lds
  v_mfma_f32_16x16x32_bf16 v[192:195], v[208:211], v[128:131], v[192:195]
  v_accvgpr_write_b32 a83, v251
  s_waitcnt lgkmcnt(2)
  v_mfma_f32_16x16x32_bf16 v[184:187], v[212:215], v[132:135], v[184:187]
  ds_read_b128 v[208:211], v70 offset:896
  s_mov_b64 exec, s[68:69]
  v_cvt_pk_bf16_f32 v144, v204, v205
  v_cvt_pk_bf16_f32 v145, v206, v207
  s_mov_b64 exec, -1
  v_mfma_f32_16x16x32_bf16 v[188:191], v[212:215], v[136:139], v[188:191]
  s_add_u32 m0, s81, 29696
  s_nop 0
  buffer_load_dwordx4 v53, s[12:15], s80 offen lds
  v_mfma_f32_16x16x32_bf16 v[192:195], v[212:215], v[140:143], v[192:195]
  s_waitcnt lgkmcnt(2)
  v_mfma_f32_16x16x32_bf16 v[196:199], v[216:219], v[72:75], 0
  ds_read_b128 v[212:215], v71 offset:896
  v_mfma_f32_16x16x32_bf16 v[200:203], v[216:219], v[76:79], 0
  s_add_u32 m0, s81, 30720
  s_nop 0
  buffer_load_dwordx4 v54, s[12:15], s80 offen lds
  v_mfma_f32_16x16x32_bf16 v[204:207], v[216:219], v[80:83], 0
  s_waitcnt lgkmcnt(2)
  v_mfma_f32_16x16x32_bf16 v[196:199], v[220:223], v[84:87], v[196:199]
  ds_read_b128 v[216:219], v70 offset:1024
  v_cvt_pk_bf16_f32 v248, v184, v185
  v_mfma_f32_16x16x32_bf16 v[200:203], v[220:223], v[88:91], v[200:203]
  s_add_u32 m0, s81, 31744
  s_nop 0
  buffer_load_dwordx4 v55, s[12:15], s80 offen lds
  v_mfma_f32_16x16x32_bf16 v[204:207], v[220:223], v[92:95], v[204:207]
  v_cvt_pk_bf16_f32 v249, v186, v187
  s_waitcnt lgkmcnt(2)
  v_mfma_f32_16x16x32_bf16 v[196:199], v[208:211], v[96:99], v[196:199]
  ds_read_b128 v[220:223], v71 offset:1024
  v_cvt_pk_bf16_f32 v250, v188, v189
  v_mfma_f32_16x16x32_bf16 v[200:203], v[208:211], v[100:103], v[200:203]
  s_add_u32 m0, s81, 32768
  s_nop 0
  buffer_load_dwordx4 v56, s[12:15], s80 offen lds
  v_mfma_f32_16x16x32_bf16 v[204:207], v[208:211], v[104:107], v[204:207]
  v_cvt_pk_bf16_f32 v251, v190, v191
  s_waitcnt lgkmcnt(2)
  v_mfma_f32_16x16x32_bf16 v[196:199], v[212:215], v[108:111], v[196:199]
  v_accvgpr_write_b32 a4, v248
  v_mfma_f32_16x16x32_bf16 v[200:203], v[212:215], v[112:115], v[200:203]
  s_add_u32 m0, s81, 33792
  s_nop 0
  buffer_load_dwordx4 v57, s[12:15], s80 offen lds
  v_mfma_f32_16x16x32_bf16 v[204:207], v[212:215], v[116:119], v[204:207]
  v_accvgpr_write_b32 a5, v249
  s_waitcnt lgkmcnt(1)
  v_mfma_f32_16x16x32_bf16 v[196:199], v[216:219], v[120:123], v[196:199]
  v_accvgpr_write_b32 a84, v250
  v_mfma_f32_16x16x32_bf16 v[200:203], v[216:219], v[124:127], v[200:203]
  s_add_u32 m0, s81, 34816
  s_nop 0
  buffer_load_dwordx4 v58, s[12:15], s80 offen lds
  v_mfma_f32_16x16x32_bf16 v[204:207], v[216:219], v[128:131], v[204:207]
  v_accvgpr_write_b32 a85, v251
  s_waitcnt lgkmcnt(0)
  v_mfma_f32_16x16x32_bf16 v[196:199], v[220:223], v[132:135], v[196:199]
  v_cvt_pk_bf16_f32 v146, v192, v193
  v_cvt_pk_bf16_f32 v147, v194, v195
  v_mfma_f32_16x16x32_bf16 v[200:203], v[220:223], v[136:139], v[200:203]
  s_add_u32 m0, s81, 35840
  s_nop 0
  buffer_load_dwordx4 v59, s[12:15], s80 offen lds
  s_add_u32 s80, s80, 393216
  v_mfma_f32_16x16x32_bf16 v[204:207], v[220:223], v[140:143], v[204:207]
  s_waitcnt vmcnt(12)
  ds_read_b128 v[208:211], v70 offset:12288
  ds_read_b128 v[212:215], v71 offset:12288
  ds_read_b128 v[216:219], v70 offset:12416
  s_waitcnt lgkmcnt(2)
  v_mfma_f32_16x16x32_bf16 v[184:187], v[208:211], v[72:75], 0
  ds_read_b128 v[220:223], v71 offset:12416
  v_mfma_f32_16x16x32_bf16 v[188:191], v[208:211], v[76:79], 0
  s_add_u32 m0, s81, 0
  s_nop 0
  buffer_load_dwordx4 v48, s[12:15], s80 offen lds
  v_mfma_f32_16x16x32_bf16 v[192:195], v[208:211], v[80:83], 0
  s_waitcnt lgkmcnt(2)
  v_mfma_f32_16x16x32_bf16 v[184:187], v[212:215], v[84:87], v[184:187]
  ds_read_b128 v[208:211], v70 offset:12544
  v_cvt_pk_bf16_f32 v248, v196, v197
  v_mfma_f32_16x16x32_bf16 v[188:191], v[212:215], v[88:91], v[188:191]
  s_add_u32 m0, s81, 1024
  s_nop 0
  buffer_load_dwordx4 v49, s[12:15], s80 offen lds
  v_mfma_f32_16x16x32_bf16 v[192:195], v[212:215], v[92:95], v[192:195]
  v_cvt_pk_bf16_f32 v249, v198, v199
  s_waitcnt lgkmcnt(2)
  v_mfma_f32_16x16x32_bf16 v[184:187], v[216:219], v[96:99], v[184:187]
  ds_read_b128 v[212:215], v71 offset:12544
  v_cvt_pk_bf16_f32 v250, v200, v201
  v_mfma_f32_16x16x32_bf16 v[188:191], v[216:219], v[100:103], v[188:191]
  s_add_u32 m0, s81, 2048
  s_nop 0
  buffer_load_dwordx4 v50, s[12:15], s80 offen lds
  v_mfma_f32_16x16x32_bf16 v[192:195], v[216:219], v[104:107], v[192:195]
  v_cvt_pk_bf16_f32 v251, v202, v203
  s_waitcnt lgkmcnt(2)
  v_mfma_f32_16x16x32_bf16 v[184:187], v[220:223], v[108:111], v[184:187]
  ds_read_b128 v[216:219], v70 offset:13056
  v_accvgpr_write_b32 a6, v248
  v_mfma_f32_16x16x32_bf16 v[188:191], v[220:223], v[112:115], v[188:191]
  s_add_u32 m0, s81, 3072
  s_nop 0
  buffer_load_dwordx4 v51, s[12:15], s80 offen lds
  v_mfma_f32_16x16x32_bf16 v[192:195], v[220:223], v[116:119], v[192:195]
  v_accvgpr_write_b32 a7, v249
  s_waitcnt lgkmcnt(2)
  v_mfma_f32_16x16x32_bf16 v[184:187], v[208:211], v[120:123], v[184:187]
  ds_read_b128 v[220:223], v71 offset:13056
  v_accvgpr_write_b32 a86, v250
  v_mfma_f32_16x16x32_bf16 v[188:191], v[208:211], v[124:127], v[188:191]
  s_add_u32 m0, s81, 4096
  s_nop 0
  buffer_load_dwordx4 v52, s[12:15], s80 offen lds
  v_mfma_f32_16x16x32_bf16 v[192:195], v[208:211], v[128:131], v[192:195]
  v_accvgpr_write_b32 a87, v251
  s_waitcnt lgkmcnt(2)
  v_mfma_f32_16x16x32_bf16 v[184:187], v[212:215], v[132:135], v[184:187]
  ds_read_b128 v[208:211], v70 offset:13184
  s_mov_b64 exec, s[68:69]
  v_cvt_pk_bf16_f32 v146, v204, v205
  v_cvt_pk_bf16_f32 v147, v206, v207
  s_mov_b64 exec, -1
  v_mfma_f32_16x16x32_bf16 v[188:191], v[212:215], v[136:139], v[188:191]
  s_add_u32 m0, s81, 5120
  s_nop 0
  buffer_load_dwordx4 v53, s[12:15], s80 offen lds
  v_mfma_f32_16x16x32_bf16 v[192:195], v[212:215], v[140:143], v[192:195]
  s_waitcnt lgkmcnt(2)
  v_mfma_f32_16x16x32_bf16 v[196:199], v[216:219], v[72:75], 0
  ds_read_b128 v[212:215], v71 offset:13184
  v_mfma_f32_16x16x32_bf16 v[200:203], v[216:219], v[76:79], 0
  s_add_u32 m0, s81, 6144
  s_nop 0
  buffer_load_dwordx4 v54, s[12:15], s80 offen lds
  v_mfma_f32_16x16x32_bf16 v[204:207], v[216:219], v[80:83], 0
  s_waitcnt lgkmcnt(2)
  v_mfma_f32_16x16x32_bf16 v[196:199], v[220:223], v[84:87], v[196:199]
  ds_read_b128 v[216:219], v70 offset:13312
  v_cvt_pk_bf16_f32 v248, v184, v185
  v_mfma_f32_16x16x32_bf16 v[200:203], v[220:223], v[88:91], v[200:203]
  s_add_u32 m0, s81, 7168
  s_nop 0
  buffer_load_dwordx4 v55, s[12:15], s80 offen lds
  v_mfma_f32_16x16x32_bf16 v[204:207], v[220:223], v[92:95], v[204:207]
  v_cvt_pk_bf16_f32 v249, v186, v187
  s_waitcnt lgkmcnt(2)
  v_mfma_f32_16x16x32_bf16 v[196:199], v[208:211], v[96:99], v[196:199]
  ds_read_b128 v[220:223], v71 offset:13312
  v_cvt_pk_bf16_f32 v250, v188, v189
  v_mfma_f32_16x16x32_bf16 v[200:203], v[208:211], v[100:103], v[200:203]
  s_add_u32 m0, s81, 8192
  s_nop 0
  buffer_load_dwordx4 v56, s[12:15], s80 offen lds
  v_mfma_f32_16x16x32_bf16 v[204:207], v[208:211], v[104:107], v[204:207]
  v_cvt_pk_bf16_f32 v251, v190, v191
  s_waitcnt lgkmcnt(2)
  v_mfma_f32_16x16x32_bf16 v[196:199], v[212:215], v[108:111], v[196:199]
  v_accvgpr_write_b32 a8, v248
  v_mfma_f32_16x16x32_bf16 v[200:203], v[212:215], v[112:115], v[200:203]
  s_add_u32 m0, s81, 9216
  s_nop 0
  buffer_load_dwordx4 v57, s[12:15], s80 offen lds
  v_mfma_f32_16x16x32_bf16 v[204:207], v[212:215], v[116:119], v[204:207]
  v_accvgpr_write_b32 a9, v249
  s_waitcnt lgkmcnt(1)
  v_mfma_f32_16x16x32_bf16 v[196:199], v[216:219], v[120:123], v[196:199]
  v_accvgpr_write_b32 a88, v250
  v_mfma_f32_16x16x32_bf16 v[200:203], v[216:219], v[124:127], v[200:203]
  s_add_u32 m0, s81, 10240
  s_nop 0
  buffer_load_dwordx4 v58, s[12:15], s80 offen lds
  v_mfma_f32_16x16x32_bf16 v[204:207], v[216:219], v[128:131], v[204:207]
  v_accvgpr_write_b32 a89, v251
  s_waitcnt lgkmcnt(0)
  v_mfma_f32_16x16x32_bf16 v[196:199], v[220:223], v[132:135], v[196:199]
  v_cvt_pk_bf16_f32 v148, v192, v193
  v_cvt_pk_bf16_f32 v149, v194, v195
  v_mfma_f32_16x16x32_bf16 v[200:203], v[220:223], v[136:139], v[200:203]
  s_add_u32 m0, s81, 11264
  s_nop 0
  buffer_load_dwordx4 v59, s[12:15], s80 offen lds
  s_add_u32 s80, s80, 393216
  v_mfma_f32_16x16x32_bf16 v[204:207], v[220:223], v[140:143], v[204:207]
  s_waitcnt vmcnt(12)
  ds_read_b128 v[208:211], v70 offset:24576
  ds_read_b128 v[212:215], v71 offset:24576
  ds_read_b128 v[216:219], v70 offset:24704
  s_waitcnt lgkmcnt(2)
  v_mfma_f32_16x16x32_bf16 v[184:187], v[208:211], v[72:75], 0
  ds_read_b128 v[220:223], v71 offset:24704
  v_mfma_f32_16x16x32_bf16 v[188:191], v[208:211], v[76:79], 0
  s_add_u32 m0, s81, 12288
  s_nop 0
  buffer_load_dwordx4 v48, s[12:15], s80 offen lds
  v_mfma_f32_16x16x32_bf16 v[192:195], v[208:211], v[80:83], 0
  s_waitcnt lgkmcnt(2)
  v_mfma_f32_16x16x32_bf16 v[184:187], v[212:215], v[84:87], v[184:187]
  ds_read_b128 v[208:211], v70 offset:24832
  v_cvt_pk_bf16_f32 v248, v196, v197
  v_mfma_f32_16x16x32_bf16 v[188:191], v[212:215], v[88:91], v[188:191]
  s_add_u32 m0, s81, 13312
  s_nop 0
  buffer_load_dwordx4 v49, s[12:15], s80 offen lds
  v_mfma_f32_16x16x32_bf16 v[192:195], v[212:215], v[92:95], v[192:195]
  v_cvt_pk_bf16_f32 v249, v198, v199
  s_waitcnt lgkmcnt(2)
  v_mfma_f32_16x16x32_bf16 v[184:187], v[216:219], v[96:99], v[184:187]
  ds_read_b128 v[212:215], v71 offset:24832
  v_cvt_pk_bf16_f32 v250, v200, v201
  v_mfma_f32_16x16x32_bf16 v[188:191], v[216:219], v[100:103], v[188:191]
  s_add_u32 m0, s81, 14336
  s_nop 0
  buffer_load_dwordx4 v50, s[12:15], s80 offen lds
  v_mfma_f32_16x16x32_bf16 v[192:195], v[216:219], v[104:107], v[192:195]
  v_cvt_pk_bf16_f32 v251, v202, v203
  s_waitcnt lgkmcnt(2)
  v_mfma_f32_16x16x32_bf16 v[184:187], v[220:223], v[108:111], v[184:187]
  ds_read_b128 v[216:219], v70 offset:25344
  v_accvgpr_write_b32 a10, v248
  v_mfma_f32_16x16x32_bf16 v[188:191], v[220:223], v[112:115], v[188:191]
  s_add_u32 m0, s81, 15360
  s_nop 0
  buffer_load_dwordx4 v51, s[12:15], s80 offen lds
  v_mfma_f32_16x16x32_bf16 v[192:195], v[220:223], v[116:119], v[192:195]
  v_accvgpr_write_b32 a11, v249
  s_waitcnt lgkmcnt(2)
  v_mfma_f32_16x16x32_bf16 v[184:187], v[208:211], v[120:123], v[184:187]
  ds_read_b128 v[220:223], v71 offset:25344
  v_accvgpr_write_b32 a90, v250
  v_mfma_f32_16x16x32_bf16 v[188:191], v[208:211], v[124:127], v[188:191]
  s_add_u32 m0, s81, 16384
  s_nop 0
  buffer_load_dwordx4 v52, s[12:15], s80 offen lds
  v_mfma_f32_16x16x32_bf16 v[192:195], v[208:211], v[128:131], v[192:195]
  v_accvgpr_write_b32 a91, v251
  s_waitcnt lgkmcnt(2)
  v_mfma_f32_16x16x32_bf16 v[184:187], v[212:215], v[132:135], v[184:187]
  ds_read_b128 v[208:211], v70 offset:25472
  s_mov_b64 exec, s[68:69]
  v_cvt_pk_bf16_f32 v148, v204, v205
  v_cvt_pk_bf16_f32 v149, v206, v207
  s_mov_b64 exec, -1
  v_mfma_f32_16x16x32_bf16 v[188:191], v[212:215], v[136:139], v[188:191]
  s_add_u32 m0, s81, 17408
  s_nop 0
  buffer_load_dwordx4 v53, s[12:15], s80 offen lds
  v_mfma_f32_16x16x32_bf16 v[192:195], v[212:215], v[140:143], v[192:195]
  s_waitcnt lgkmcnt(2)
  v_mfma_f32_16x16x32_bf16 v[196:199], v[216:219], v[72:75], 0
  ds_read_b128 v[212:215], v71 offset:25472
  v_mfma_f32_16x16x32_bf16 v[200:203], v[216:219], v[76:79], 0
  s_add_u32 m0, s81, 18432
  s_nop 0
  buffer_load_dwordx4 v54, s[12:15], s80 offen lds
  v_mfma_f32_16x16x32_bf16 v[204:207], v[216:219], v[80:83], 0
  s_waitcnt lgkmcnt(2)
  v_mfma_f32_16x16x32_bf16 v[196:199], v[220:223], v[84:87], v[196:199]
  ds_read_b128 v[216:219], v70 offset:25600
  v_cvt_pk_bf16_f32 v248, v184, v185
  v_mfma_f32_16x16x32_bf16 v[200:203], v[220:223], v[88:91], v[200:203]
  s_add_u32 m0, s81, 19456
  s_nop 0
  buffer_load_dwordx4 v55, s[12:15], s80 offen lds
  v_mfma_f32_16x16x32_bf16 v[204:207], v[220:223], v[92:95], v[204:207]
  v_cvt_pk_bf16_f32 v249, v186, v187
  s_waitcnt lgkmcnt(2)
  v_mfma_f32_16x16x32_bf16 v[196:199], v[208:211], v[96:99], v[196:199]
  ds_read_b128 v[220:223], v71 offset:25600
  v_cvt_pk_bf16_f32 v250, v188, v189
  v_mfma_f32_16x16x32_bf16 v[200:203], v[208:211], v[100:103], v[200:203]
  s_add_u32 m0, s81, 20480
  s_nop 0
  buffer_load_dwordx4 v56, s[12:15], s80 offen lds
  v_mfma_f32_16x16x32_bf16 v[204:207], v[208:211], v[104:107], v[204:207]
  v_cvt_pk_bf16_f32 v251, v190, v191
  s_waitcnt lgkmcnt(2)
  v_mfma_f32_16x16x32_bf16 v[196:199], v[212:215], v[108:111], v[196:199]
  v_accvgpr_write_b32 a12, v248
  v_mfma_f32_16x16x32_bf16 v[200:203], v[212:215], v[112:115], v[200:203]
  s_add_u32 m0, s81, 21504
  s_nop 0
  buffer_load_dwordx4 v57, s[12:15], s80 offen lds
  v_mfma_f32_16x16x32_bf16 v[204:207], v[212:215], v[116:119], v[204:207]
  v_accvgpr_write_b32 a13, v249
  s_waitcnt lgkmcnt(1)
  v_mfma_f32_16x16x32_bf16 v[196:199], v[216:219], v[120:123], v[196:199]
  v_accvgpr_write_b32 a92, v250
  v_mfma_f32_16x16x32_bf16 v[200:203], v[216:219], v[124:127], v[200:203]
  s_add_u32 m0, s81, 22528
  s_nop 0
  buffer_load_dwordx4 v58, s[12:15], s80 offen lds
  v_mfma_f32_16x16x32_bf16 v[204:207], v[216:219], v[128:131], v[204:207]
  v_accvgpr_write_b32 a93, v251
  s_waitcnt lgkmcnt(0)
  v_mfma_f32_16x16x32_bf16 v[196:199], v[220:223], v[132:135], v[196:199]
  v_cvt_pk_bf16_f32 v150, v192, v193
  v_cvt_pk_bf16_f32 v151, v194, v195
  v_mfma_f32_16x16x32_bf16 v[200:203], v[220:223], v[136:139], v[200:203]
  s_add_u32 m0, s81, 23552
  s_nop 0
  buffer_load_dwordx4 v59, s[12:15], s80 offen lds
  s_add_u32 s80, s80, 393216
  v_mfma_f32_16x16x32_bf16 v[204:207], v[220:223], v[140:143], v[204:207]
  s_waitcnt vmcnt(12)
  ds_read_b128 v[208:211], v70 offset:0
  ds_read_b128 v[212:215], v71 offset:0
  ds_read_b128 v[216:219], v70 offset:128
  s_waitcnt lgkmcnt(2)
  v_mfma_f32_16x16x32_bf16 v[184:187], v[208:211], v[72:75], 0
  ds_read_b128 v[220:223], v71 offset:128
  v_mfma_f32_16x16x32_bf16 v[188:191], v[208:211], v[76:79], 0
  s_add_u32 m0, s81, 24576
  s_nop 0
  buffer_load_dwordx4 v48, s[12:15], s80 offen lds
  v_mfma_f32_16x16x32_bf16 v[192:195], v[208:211], v[80:83], 0
  s_waitcnt lgkmcnt(2)
  v_mfma_f32_16x16x32_bf16 v[184:187], v[212:215], v[84:87], v[184:187]
  ds_read_b128 v[208:211], v70 offset:256
  v_cvt_pk_bf16_f32 v248, v196, v197
  v_mfma_f32_16x16x32_bf16 v[188:191], v[212:215], v[88:91], v[188:191]
  s_add_u32 m0, s81, 25600
  s_nop 0
  buffer_load_dwordx4 v49, s[12:15], s80 offen lds
  v_mfma_f32_16x16x32_bf16 v[192:195], v[212:215], v[92:95], v[192:195]
  v_cvt_pk_bf16_f32 v249, v198, v199
  s_waitcnt lgkmcnt(2)
  v_mfma_f32_16x16x32_bf16 v[184:187], v[216:219], v[96:99], v[184:187]
  ds_read_b128 v[212:215], v71 offset:256
  v_cvt_pk_bf16_f32 v250, v200, v201
  v_mfma_f32_16x16x32_bf16 v[188:191], v[216:219], v[100:103], v[188:191]
  s_add_u32 m0, s81, 26624
  s_nop 0
  buffer_load_dwordx4 v50, s[12:15], s80 offen lds
  v_mfma_f32_16x16x32_bf16 v[192:195], v[216:219], v[104:107], v[192:195]
  v_cvt_pk_bf16_f32 v251, v202, v203
  s_waitcnt lgkmcnt(2)
  v_mfma_f32_16x16x32_bf16 v[184:187], v[220:223], v[108:111], v[184:187]
  ds_read_b128 v[216:219], v70 offset:768
  v_accvgpr_write_b32 a14, v248
  v_mfma_f32_16x16x32_bf16 v[188:191], v[220:223], v[112:115], v[188:191]
  s_add_u32 m0, s81, 27648
  s_nop 0
  buffer_load_dwordx4 v51, s[12:15], s80 offen lds
  v_mfma_f32_16x16x32_bf16 v[192:195], v[220:223], v[116:119], v[192:195]
  v_accvgpr_write_b32 a15, v249
  s_waitcnt lgkmcnt(2)
  v_mfma_f32_16x16x32_bf16 v[184:187], v[208:211], v[120:123], v[184:187]
  ds_read_b128 v[220:223], v71 offset:768
  v_accvgpr_write_b32 a94, v250
  v_mfma_f32_16x16x32_bf16 v[188:191], v[208:211], v[124:127], v[188:191]
  s_add_u32 m0, s81, 28672
  s_nop 0
  buffer_load_dwordx4 v52, s[12:15], s80 offen lds
  v_mfma_f32_16x16x32_bf16 v[192:195], v[208:211], v[128:131], v[192:195]
  v_accvgpr_write_b32 a95, v251
  s_waitcnt lgkmcnt(2)
  v_mfma_f32_16x16x32_bf16 v[184:187], v[212:215], v[132:135], v[184:187]
  ds_read_b128 v[208:211], v70 offset:896
  s_mov_b64 exec, s[68:69]
  v_cvt_pk_bf16_f32 v150, v204, v205
  v_cvt_pk_bf16_f32 v151, v206, v207
  s_mov_b64 exec, -1
  v_mfma_f32_16x16x32_bf16 v[188:191], v[212:215], v[136:139], v[188:191]
  s_add_u32 m0, s81, 29696
  s_nop 0
  buffer_load_dwordx4 v53, s[12:15], s80 offen lds
  v_mfma_f32_16x16x32_bf16 v[192:195], v[212:215], v[140:143], v[192:195]
  s_waitcnt lgkmcnt(2)
  v_mfma_f32_16x16x32_bf16 v[196:199], v[216:219], v[72:75], 0
  ds_read_b128 v[212:215], v71 offset:896
  v_mfma_f32_16x16x32_bf16 v[200:203], v[216:219], v[76:79], 0
  s_add_u32 m0, s81, 30720
  s_nop 0
  buffer_load_dwordx4 v54, s[12:15], s80 offen lds
  v_mfma_f32_16x16x32_bf16 v[204:207], v[216:219], v[80:83], 0
  s_waitcnt lgkmcnt(2)
  v_mfma_f32_16x16x32_bf16 v[196:199], v[220:223], v[84:87], v[196:199]
  ds_read_b128 v[216:219], v70 offset:1024
  v_cvt_pk_bf16_f32 v248, v184, v185
  v_mfma_f32_16x16x32_bf16 v[200:203], v[220:223], v[88:91], v[200:203]
  s_add_u32 m0, s81, 31744
  s_nop 0
  buffer_load_dwordx4 v55, s[12:15], s80 offen lds
  v_mfma_f32_16x16x32_bf16 v[204:207], v[220:223], v[92:95], v[204:207]
  v_cvt_pk_bf16_f32 v249, v186, v187
  s_waitcnt lgkmcnt(2)
  v_mfma_f32_16x16x32_bf16 v[196:199], v[208:211], v[96:99], v[196:199]
  ds_read_b128 v[220:223], v71 offset:1024
  v_cvt_pk_bf16_f32 v250, v188, v189
  v_mfma_f32_16x16x32_bf16 v[200:203], v[208:211], v[100:103], v[200:203]
  s_add_u32 m0, s81, 32768
  s_nop 0
  buffer_load_dwordx4 v56, s[12:15], s80 offen lds
  v_mfma_f32_16x16x32_bf16 v[204:207], v[208:211], v[104:107], v[204:207]
  v_cvt_pk_bf16_f32 v251, v190, v191
  s_waitcnt lgkmcnt(2)
  v_mfma_f32_16x16x32_bf16 v[196:199], v[212:215], v[108:111], v[196:199]
  v_accvgpr_write_b32 a16, v248
  v_mfma_f32_16x16x32_bf16 v[200:203], v[212:215], v[112:115], v[200:203]
  s_add_u32 m0, s81, 33792
  s_nop 0
  buffer_load_dwordx4 v57, s[12:15], s80 offen lds
  v_mfma_f32_16x16x32_bf16 v[204:207], v[212:215], v[116:119], v[204:207]
  v_accvgpr_write_b32 a17, v249
  s_waitcnt lgkmcnt(1)
  v_mfma_f32_16x16x32_bf16 v[196:199], v[216:219], v[120:123], v[196:199]
  v_accvgpr_write_b32 a96, v250
  v_mfma_f32_16x16x32_bf16 v[200:203], v[216:219], v[124:127], v[200:203]
  s_add_u32 m0, s81, 34816
  s_nop 0
  buffer_load_dwordx4 v58, s[12:15], s80 offen lds
  v_mfma_f32_16x16x32_bf16 v[204:207], v[216:219], v[128:131], v[204:207]
  v_accvgpr_write_b32 a97, v251
  s_waitcnt lgkmcnt(0)
  v_mfma_f32_16x16x32_bf16 v[196:199], v[220:223], v[132:135], v[196:199]
  v_cvt_pk_bf16_f32 v152, v192, v193
  v_cvt_pk_bf16_f32 v153, v194, v195
  v_mfma_f32_16x16x32_bf16 v[200:203], v[220:223], v[136:139], v[200:203]
  s_add_u32 m0, s81, 35840
  s_nop 0
  buffer_load_dwordx4 v59, s[12:15], s80 offen lds
  s_add_u32 s80, s80, 393216
  v_mfma_f32_16x16x32_bf16 v[204:207], v[220:223], v[140:143], v[204:207]
  s_waitcnt vmcnt(12)
  ds_read_b128 v[208:211], v70 offset:12288
  ds_read_b128 v[212:215], v71 offset:12288
  ds_read_b128 v[216:219], v70 offset:12416
  s_waitcnt lgkmcnt(2)
  v_mfma_f32_16x16x32_bf16 v[184:187], v[208:211], v[72:75], 0
  ds_read_b128 v[220:223], v71 offset:12416
  v_mfma_f32_16x16x32_bf16 v[188:191], v[208:211], v[76:79], 0
  s_add_u32 m0, s81, 0
  s_nop 0
  buffer_load_dwordx4 v48, s[12:15], s80 offen lds
  v_mfma_f32_16x16x32_bf16 v[192:195], v[208:211], v[80:83], 0
  s_waitcnt lgkmcnt(2)
  v_mfma_f32_16x16x32_bf16 v[184:187], v[212:215], v[84:87], v[184:187]
  ds_read_b128 v[208:211], v70 offset:12544
  v_cvt_pk_bf16_f32 v248, v196, v197
  v_mfma_f32_16x16x32_bf16 v[188:191], v[212:215], v[88:91], v[188:191]
  s_add_u32 m0, s81, 1024
  s_nop 0
  buffer_load_dwordx4 v49, s[12:15], s80 offen lds
  v_mfma_f32_16x16x32_bf16 v[192:195], v[212:215], v[92:95], v[192:195]
  v_cvt_pk_bf16_f32 v249, v198, v199
  s_waitcnt lgkmcnt(2)
  v_mfma_f32_16x16x32_bf16 v[184:187], v[216:219], v[96:99], v[184:187]
  ds_read_b128 v[212:215], v71 offset:12544
  v_cvt_pk_bf16_f32 v250, v200, v201
  v_mfma_f32_16x16x32_bf16 v[188:191], v[216:219], v[100:103], v[188:191]
  s_add_u32 m0, s81, 2048
  s_nop 0
  buffer_load_dwordx4 v50, s[12:15], s80 offen lds
  v_mfma_f32_16x16x32_bf16 v[192:195], v[216:219], v[104:107], v[192:195]
  v_cvt_pk_bf16_f32 v251, v202, v203
  s_waitcnt lgkmcnt(2)
  v_mfma_f32_16x16x32_bf16 v[184:187], v[220:223], v[108:111], v[184:187]
  ds_read_b128 v[216:219], v70 offset:13056
  v_accvgpr_write_b32 a18, v248
  v_mfma_f32_16x16x32_bf16 v[188:191], v[220:223], v[112:115], v[188:191]
  s_add_u32 m0, s81, 3072
  s_nop 0
  buffer_load_dwordx4 v51, s[12:15], s80 offen lds
  v_mfma_f32_16x16x32_bf16 v[192:195], v[220:223], v[116:119], v[192:195]
  v_accvgpr_write_b32 a19, v249
  s_waitcnt lgkmcnt(2)
  v_mfma_f32_16x16x32_bf16 v[184:187], v[208:211], v[120:123], v[184:187]
  ds_read_b128 v[220:223], v71 offset:13056
  v_accvgpr_write_b32 a98, v250
  v_mfma_f32_16x16x32_bf16 v[188:191], v[208:211], v[124:127], v[188:191]
  s_add_u32 m0, s81, 4096
  s_nop 0
  buffer_load_dwordx4 v52, s[12:15], s80 offen lds
  v_mfma_f32_16x16x32_bf16 v[192:195], v[208:211], v[128:131], v[192:195]
  v_accvgpr_write_b32 a99, v251
  s_waitcnt lgkmcnt(2)
  v_mfma_f32_16x16x32_bf16 v[184:187], v[212:215], v[132:135], v[184:187]
  ds_read_b128 v[208:211], v70 offset:13184
  s_mov_b64 exec, s[68:69]
  v_cvt_pk_bf16_f32 v152, v204, v205
  v_cvt_pk_bf16_f32 v153, v206, v207
  s_mov_b64 exec, -1
  v_mfma_f32_16x16x32_bf16 v[188:191], v[212:215], v[136:139], v[188:191]
  s_add_u32 m0, s81, 5120
  s_nop 0
  buffer_load_dwordx4 v53, s[12:15], s80 offen lds
  v_mfma_f32_16x16x32_bf16 v[192:195], v[212:215], v[140:143], v[192:195]
  s_waitcnt lgkmcnt(2)
  v_mfma_f32_16x16x32_bf16 v[196:199], v[216:219], v[72:75], 0
  ds_read_b128 v[212:215], v71 offset:13184
  v_mfma_f32_16x16x32_bf16 v[200:203], v[216:219], v[76:79], 0
  s_add_u32 m0, s81, 6144
  s_nop 0
  buffer_load_dwordx4 v54, s[12:15], s80 offen lds
  v_mfma_f32_16x16x32_bf16 v[204:207], v[216:219], v[80:83], 0
  s_waitcnt lgkmcnt(2)
  v_mfma_f32_16x16x32_bf16 v[196:199], v[220:223], v[84:87], v[196:199]
  ds_read_b128 v[216:219], v70 offset:13312
  v_cvt_pk_bf16_f32 v248, v184, v185
  v_mfma_f32_16x16x32_bf16 v[200:203], v[220:223], v[88:91], v[200:203]
  s_add_u32 m0, s81, 7168
  s_nop 0
  buffer_load_dwordx4 v55, s[12:15], s80 offen lds
  v_mfma_f32_16x16x32_bf16 v[204:207], v[220:223], v[92:95], v[204:207]
  v_cvt_pk_bf16_f32 v249, v186, v187
  s_waitcnt lgkmcnt(2)
  v_mfma_f32_16x16x32_bf16 v[196:199], v[208:211], v[96:99], v[196:199]
  ds_read_b128 v[220:223], v71 offset:13312
  v_cvt_pk_bf16_f32 v250, v188, v189
  v_mfma_f32_16x16x32_bf16 v[200:203], v[208:211], v[100:103], v[200:203]
  s_add_u32 m0, s81, 8192
  s_nop 0
  buffer_load_dwordx4 v56, s[12:15], s80 offen lds
  v_mfma_f32_16x16x32_bf16 v[204:207], v[208:211], v[104:107], v[204:207]
  v_cvt_pk_bf16_f32 v251, v190, v191
  s_waitcnt lgkmcnt(2)
  v_mfma_f32_16x16x32_bf16 v[196:199], v[212:215], v[108:111], v[196:199]
  v_accvgpr_write_b32 a20, v248
  v_mfma_f32_16x16x32_bf16 v[200:203], v[212:215], v[112:115], v[200:203]
  s_add_u32 m0, s81, 9216
  s_nop 0
  buffer_load_dwordx4 v57, s[12:15], s80 offen lds
  v_mfma_f32_16x16x32_bf16 v[204:207], v[212:215], v[116:119], v[204:207]
  v_accvgpr_write_b32 a21, v249
  s_waitcnt lgkmcnt(1)
  v_mfma_f32_16x16x32_bf16 v[196:199], v[216:219], v[120:123], v[196:199]
  v_accvgpr_write_b32 a100, v250
  v_mfma_f32_16x16x32_bf16 v[200:203], v[216:219], v[124:127], v[200:203]
  s_add_u32 m0, s81, 10240
  s_nop 0
  buffer_load_dwordx4 v58, s[12:15], s80 offen lds
  v_mfma_f32_16x16x32_bf16 v[204:207], v[216:219], v[128:131], v[204:207]
  v_accvgpr_write_b32 a101, v251
  s_waitcnt lgkmcnt(0)
  v_mfma_f32_16x16x32_bf16 v[196:199], v[220:223], v[132:135], v[196:199]
  v_cvt_pk_bf16_f32 v154, v192, v193
  v_cvt_pk_bf16_f32 v155, v194, v195
  v_mfma_f32_16x16x32_bf16 v[200:203], v[220:223], v[136:139], v[200:203]
  s_add_u32 m0, s81, 11264
  s_nop 0
  buffer_load_dwordx4 v59, s[12:15], s80 offen lds
  s_add_u32 s80, s80, 393216
  v_mfma_f32_16x16x32_bf16 v[204:207], v[220:223], v[140:143], v[204:207]
  s_add_u32 s21, s79, 0
  buffer_load_dwordx4 a[172:175], v63, s[28:31], s21 offen
  s_add_u32 s21, s79, 0
  buffer_load_dwordx4 a[176:179], v64, s[28:31], s21 offen
  s_add_u32 s21, s79, 0
  buffer_load_dwordx4 a[180:183], v65, s[28:31], s21 offen
  s_waitcnt vmcnt(15)
  ds_read_b128 v[208:211], v70 offset:24576
  ds_read_b128 v[212:215], v71 offset:24576
  ds_read_b128 v[216:219], v70 offset:24704
  s_waitcnt lgkmcnt(2)
  v_mfma_f32_16x16x32_bf16 v[184:187], v[208:211], v[72:75], 0
  ds_read_b128 v[220:223], v71 offset:24704
  v_mfma_f32_16x16x32_bf16 v[188:191], v[208:211], v[76:79], 0
  s_add_u32 m0, s81, 12288
  s_nop 0
  buffer_load_dwordx4 v48, s[12:15], s80 offen lds
  v_mfma_f32_16x16x32_bf16 v[192:195], v[208:211], v[80:83], 0
  s_waitcnt lgkmcnt(2)
  v_mfma_f32_16x16x32_bf16 v[184:187], v[212:215], v[84:87], v[184:187]
  ds_read_b128 v[208:211], v70 offset:24832
  v_cvt_pk_bf16_f32 v248, v196, v197
  v_mfma_f32_16x16x32_bf16 v[188:191], v[212:215], v[88:91], v[188:191]
  s_add_u32 m0, s81, 13312
  s_nop 0
  buffer_load_dwordx4 v49, s[12:15], s80 offen lds
  v_mfma_f32_16x16x32_bf16 v[192:195], v[212:215], v[92:95], v[192:195]
  v_cvt_pk_bf16_f32 v249, v198, v199
  s_waitcnt lgkmcnt(2)
  v_mfma_f32_16x16x32_bf16 v[184:187], v[216:219], v[96:99], v[184:187]
  ds_read_b128 v[212:215], v71 offset:24832
  v_cvt_pk_bf16_f32 v250, v200, v201
  v_mfma_f32_16x16x32_bf16 v[188:191], v[216:219], v[100:103], v[188:191]
  s_add_u32 m0, s81, 14336
  s_nop 0
  buffer_load_dwordx4 v50, s[12:15], s80 offen lds
  v_mfma_f32_16x16x32_bf16 v[192:195], v[216:219], v[104:107], v[192:195]
  v_cvt_pk_bf16_f32 v251, v202, v203
  s_waitcnt lgkmcnt(2)
  v_mfma_f32_16x16x32_bf16 v[184:187], v[220:223], v[108:111], v[184:187]
  ds_read_b128 v[216:219], v70 offset:25344
  v_accvgpr_write_b32 a22, v248
  v_mfma_f32_16x16x32_bf16 v[188:191], v[220:223], v[112:115], v[188:191]
  s_add_u32 m0, s81, 15360
  s_nop 0
  buffer_load_dwordx4 v51, s[12:15], s80 offen lds
  v_mfma_f32_16x16x32_bf16 v[192:195], v[220:223], v[116:119], v[192:195]
  v_accvgpr_write_b32 a23, v249
  s_waitcnt lgkmcnt(2)
  v_mfma_f32_16x16x32_bf16 v[184:187], v[208:211], v[120:123], v[184:187]
  ds_read_b128 v[220:223], v71 offset:25344
  v_accvgpr_write_b32 a102, v250
  v_mfma_f32_16x16x32_bf16 v[188:191], v[208:211], v[124:127], v[188:191]
  s_add_u32 m0, s81, 16384
  s_nop 0
  buffer_load_dwordx4 v52, s[12:15], s80 offen lds
  v_mfma_f32_16x16x32_bf16 v[192:195], v[208:211], v[128:131], v[192:195]
  v_accvgpr_write_b32 a103, v251
  s_waitcnt lgkmcnt(2)
  v_mfma_f32_16x16x32_bf16 v[184:187], v[212:215], v[132:135], v[184:187]
  ds_read_b128 v[208:211], v70 offset:25472
  s_mov_b64 exec, s[68:69]
  v_cvt_pk_bf16_f32 v154, v204, v205
  v_cvt_pk_bf16_f32 v155, v206, v207
  s_mov_b64 exec, -1
  v_mfma_f32_16x16x32_bf16 v[188:191], v[212:215], v[136:139], v[188:191]
  s_add_u32 m0, s81, 17408
  s_nop 0
  buffer_load_dwordx4 v53, s[12:15], s80 offen lds
  v_mfma_f32_16x16x32_bf16 v[192:195], v[212:215], v[140:143], v[192:195]
  s_waitcnt lgkmcnt(2)
  v_mfma_f32_16x16x32_bf16 v[196:199], v[216:219], v[72:75], 0
  ds_read_b128 v[212:215], v71 offset:25472
  v_mfma_f32_16x16x32_bf16 v[200:203], v[216:219], v[76:79], 0
  s_add_u32 m0, s81, 18432
  s_nop 0
  buffer_load_dwordx4 v54, s[12:15], s80 offen lds
  v_mfma_f32_16x16x32_bf16 v[204:207], v[216:219], v[80:83], 0
  s_waitcnt lgkmcnt(2)
  v_mfma_f32_16x16x32_bf16 v[196:199], v[220:223], v[84:87], v[196:199]
  ds_read_b128 v[216:219], v70 offset:25600
  v_cvt_pk_bf16_f32 v248, v184, v185
  v_mfma_f32_16x16x32_bf16 v[200:203], v[220:223], v[88:91], v[200:203]
  s_add_u32 m0, s81, 19456
  s_nop 0
  buffer_load_dwordx4 v55, s[12:15], s80 offen lds
  v_mfma_f32_16x16x32_bf16 v[204:207], v[220:223], v[92:95], v[204:207]
  v_cvt_pk_bf16_f32 v249, v186, v187
  s_waitcnt lgkmcnt(2)
  v_mfma_f32_16x16x32_bf16 v[196:199], v[208:211], v[96:99], v[196:199]
  ds_read_b128 v[220:223], v71 offset:25600
  v_cvt_pk_bf16_f32 v250, v188, v189
  v_mfma_f32_16x16x32_bf16 v[200:203], v[208:211], v[100:103], v[200:203]
  s_add_u32 m0, s81, 20480
  s_nop 0
  buffer_load_dwordx4 v56, s[12:15], s80 offen lds
  v_mfma_f32_16x16x32_bf16 v[204:207], v[208:211], v[104:107], v[204:207]
  v_cvt_pk_bf16_f32 v251, v190, v191
  s_waitcnt lgkmcnt(2)
  v_mfma_f32_16x16x32_bf16 v[196:199], v[212:215], v[108:111], v[196:199]
  v_accvgpr_write_b32 a24, v248
  v_mfma_f32_16x16x32_bf16 v[200:203], v[212:215], v[112:115], v[200:203]
  s_add_u32 m0, s81, 21504
  s_nop 0
  buffer_load_dwordx4 v57, s[12:15], s80 offen lds
  v_mfma_f32_16x16x32_bf16 v[204:207], v[212:215], v[116:119], v[204:207]
  v_accvgpr_write_b32 a25, v249
  s_waitcnt lgkmcnt(1)
  v_mfma_f32_16x16x32_bf16 v[196:199], v[216:219], v[120:123], v[196:199]
  v_accvgpr_write_b32 a104, v250
  v_mfma_f32_16x16x32_bf16 v[200:203], v[216:219], v[124:127], v[200:203]
  s_add_u32 m0, s81, 22528
  s_nop 0
  buffer_load_dwordx4 v58, s[12:15], s80 offen lds
  v_mfma_f32_16x16x32_bf16 v[204:207], v[216:219], v[128:131], v[204:207]
  v_accvgpr_write_b32 a105, v251
  s_waitcnt lgkmcnt(0)
  v_mfma_f32_16x16x32_bf16 v[196:199], v[220:223], v[132:135], v[196:199]
  v_cvt_pk_bf16_f32 v156, v192, v193
  v_cvt_pk_bf16_f32 v157, v194, v195
  v_mfma_f32_16x16x32_bf16 v[200:203], v[220:223], v[136:139], v[200:203]
  s_add_u32 m0, s81, 23552
  s_nop 0
  buffer_load_dwordx4 v59, s[12:15], s80 offen lds
  s_add_u32 s80, s80, 393216
  v_mfma_f32_16x16x32_bf16 v[204:207], v[220:223], v[140:143], v[204:207]
  s_add_u32 s21, s79, 393216
  buffer_load_dwordx4 a[196:199], v63, s[28:31], s21 offen
  s_add_u32 s21, s79, 393216
  buffer_load_dwordx4 a[200:203], v64, s[28:31], s21 offen
  s_add_u32 s21, s79, 393216
  buffer_load_dwordx4 a[204:207], v65, s[28:31], s21 offen
  s_waitcnt vmcnt(18)
  ds_read_b128 v[208:211], v70 offset:0
  ds_read_b128 v[212:215], v71 offset:0
  ds_read_b128 v[216:219], v70 offset:128
  s_waitcnt lgkmcnt(2)
  v_mfma_f32_16x16x32_bf16 v[184:187], v[208:211], v[72:75], 0
  ds_read_b128 v[220:223], v71 offset:128
  v_mfma_f32_16x16x32_bf16 v[188:191], v[208:211], v[76:79], 0
  s_add_u32 m0, s81, 24576
  s_nop 0
  buffer_load_dwordx4 v48, s[12:15], s80 offen lds
  v_mfma_f32_16x16x32_bf16 v[192:195], v[208:211], v[80:83], 0
  s_waitcnt lgkmcnt(2)
  v_mfma_f32_16x16x32_bf16 v[184:187], v[212:215], v[84:87], v[184:187]
  ds_read_b128 v[208:211], v70 offset:256
  v_cvt_pk_bf16_f32 v248, v196, v197
  v_mfma_f32_16x16x32_bf16 v[188:191], v[212:215], v[88:91], v[188:191]
  s_add_u32 m0, s81, 25600
  s_nop 0
  buffer_load_dwordx4 v49, s[12:15], s80 offen lds
  v_mfma_f32_16x16x32_bf16 v[192:195], v[212:215], v[92:95], v[192:195]
  v_cvt_pk_bf16_f32 v249, v198, v199
  s_waitcnt lgkmcnt(2)
  v_mfma_f32_16x16x32_bf16 v[184:187], v[216:219], v[96:99], v[184:187]
  ds_read_b128 v[212:215], v71 offset:256
  v_cvt_pk_bf16_f32 v250, v200, v201
  v_mfma_f32_16x16x32_bf16 v[188:191], v[216:219], v[100:103], v[188:191]
  s_add_u32 m0, s81, 26624
  s_nop 0
  buffer_load_dwordx4 v50, s[12:15], s80 offen lds
  v_mfma_f32_16x16x32_bf16 v[192:195], v[216:219], v[104:107], v[192:195]
  v_cvt_pk_bf16_f32 v251, v202, v203
  s_waitcnt lgkmcnt(2)
  v_mfma_f32_16x16x32_bf16 v[184:187], v[220:223], v[108:111], v[184:187]
  ds_read_b128 v[216:219], v70 offset:768
  v_accvgpr_write_b32 a26, v248
  v_mfma_f32_16x16x32_bf16 v[188:191], v[220:223], v[112:115], v[188:191]
  s_add_u32 m0, s81, 27648
  s_nop 0
  buffer_load_dwordx4 v51, s[12:15], s80 offen lds
  v_mfma_f32_16x16x32_bf16 v[192:195], v[220:223], v[116:119], v[192:195]
  v_accvgpr_write_b32 a27, v249
  s_waitcnt lgkmcnt(2)
  v_mfma_f32_16x16x32_bf16 v[184:187], v[208:211], v[120:123], v[184:187]
  ds_read_b128 v[220:223], v71 offset:768
  v_accvgpr_write_b32 a106, v250
  v_mfma_f32_16x16x32_bf16 v[188:191], v[208:211], v[124:127], v[188:191]
  s_add_u32 m0, s81, 28672
  s_nop 0
  buffer_load_dwordx4 v52, s[12:15], s80 offen lds
  v_mfma_f32_16x16x32_bf16 v[192:195], v[208:211], v[128:131], v[192:195]
  v_accvgpr_write_b32 a107, v251
  s_waitcnt lgkmcnt(2)
  v_mfma_f32_16x16x32_bf16 v[184:187], v[212:215], v[132:135], v[184:187]
  ds_read_b128 v[208:211], v70 offset:896
  s_mov_b64 exec, s[68:69]
  v_cvt_pk_bf16_f32 v156, v204, v205
  v_cvt_pk_bf16_f32 v157, v206, v207
  s_mov_b64 exec, -1
  v_mfma_f32_16x16x32_bf16 v[188:191], v[212:215], v[136:139], v[188:191]
  s_add_u32 m0, s81, 29696
  s_nop 0
  buffer_load_dwordx4 v53, s[12:15], s80 offen lds
  v_mfma_f32_16x16x32_bf16 v[192:195], v[212:215], v[140:143], v[192:195]
  s_waitcnt lgkmcnt(2)
  v_mfma_f32_16x16x32_bf16 v[196:199], v[216:219], v[72:75], 0
  ds_read_b128 v[212:215], v71 offset:896
  v_mfma_f32_16x16x32_bf16 v[200:203], v[216:219], v[76:79], 0
  s_add_u32 m0, s81, 30720
  s_nop 0
  buffer_load_dwordx4 v54, s[12:15], s80 offen lds
  v_mfma_f32_16x16x32_bf16 v[204:207], v[216:219], v[80:83], 0
  s_waitcnt lgkmcnt(2)
  v_mfma_f32_16x16x32_bf16 v[196:199], v[220:223], v[84:87], v[196:199]
  ds_read_b128 v[216:219], v70 offset:1024
  v_cvt_pk_bf16_f32 v248, v184, v185
  v_mfma_f32_16x16x32_bf16 v[200:203], v[220:223], v[88:91], v[200:203]
  s_add_u32 m0, s81, 31744
  s_nop 0
  buffer_load_dwordx4 v55, s[12:15], s80 offen lds
  v_mfma_f32_16x16x32_bf16 v[204:207], v[220:223], v[92:95], v[204:207]
  v_cvt_pk_bf16_f32 v249, v186, v187
  s_waitcnt lgkmcnt(2)
  v_mfma_f32_16x16x32_bf16 v[196:199], v[208:211], v[96:99], v[196:199]
  ds_read_b128 v[220:223], v71 offset:1024
  v_cvt_pk_bf16_f32 v250, v188, v189
  v_mfma_f32_16x16x32_bf16 v[200:203], v[208:211], v[100:103], v[200:203]
  s_add_u32 m0, s81, 32768
  s_nop 0
  buffer_load_dwordx4 v56, s[12:15], s80 offen lds
  v_mfma_f32_16x16x32_bf16 v[204:207], v[208:211], v[104:107], v[204:207]
  v_cvt_pk_bf16_f32 v251, v190, v191
  s_waitcnt lgkmcnt(2)
  v_mfma_f32_16x16x32_bf16 v[196:199], v[212:215], v[108:111], v[196:199]
  v_accvgpr_write_b32 a28, v248
  v_mfma_f32_16x16x32_bf16 v[200:203], v[212:215], v[112:115], v[200:203]
  s_add_u32 m0, s81, 33792
  s_nop 0
  buffer_load_dwordx4 v57, s[12:15], s80 offen lds
  v_mfma_f32_16x16x32_bf16 v[204:207], v[212:215], v[116:119], v[204:207]
  v_accvgpr_write_b32 a29, v249
  s_waitcnt lgkmcnt(1)
  v_mfma_f32_16x16x32_bf16 v[196:199], v[216:219], v[120:123], v[196:199]
  v_accvgpr_write_b32 a108, v250
  v_mfma_f32_16x16x32_bf16 v[200:203], v[216:219], v[124:127], v[200:203]
  s_add_u32 m0, s81, 34816
  s_nop 0
  buffer_load_dwordx4 v58, s[12:15], s80 offen lds
  v_mfma_f32_16x16x32_bf16 v[204:207], v[216:219], v[128:131], v[204:207]
  v_accvgpr_write_b32 a109, v251
  s_waitcnt lgkmcnt(0)
  v_mfma_f32_16x16x32_bf16 v[196:199], v[220:223], v[132:135], v[196:199]
  v_cvt_pk_bf16_f32 v158, v192, v193
  v_cvt_pk_bf16_f32 v159, v194, v195
  v_mfma_f32_16x16x32_bf16 v[200:203], v[220:223], v[136:139], v[200:203]
  s_add_u32 m0, s81, 35840
  s_nop 0
  buffer_load_dwordx4 v59, s[12:15], s80 offen lds
  s_add_u32 s80, s80, 393216
  v_mfma_f32_16x16x32_bf16 v[204:207], v[220:223], v[140:143], v[204:207]
  s_add_u32 s21, s79, 786432
  buffer_load_dwordx4 a[220:223], v63, s[28:31], s21 offen
  s_add_u32 s21, s79, 786432
  buffer_load_dwordx4 a[224:227], v64, s[28:31], s21 offen
  s_add_u32 s21, s79, 786432
  buffer_load_dwordx4 a[228:231], v65, s[28:31], s21 offen
  s_waitcnt vmcnt(18)
  ds_read_b128 v[208:211], v70 offset:12288
  ds_read_b128 v[212:215], v71 offset:12288
  ds_read_b128 v[216:219], v70 offset:12416
  s_waitcnt lgkmcnt(2)
  v_mfma_f32_16x16x32_bf16 v[184:187], v[208:211], v[72:75], 0
  ds_read_b128 v[220:223], v71 offset:12416
  v_mfma_f32_16x16x32_bf16 v[188:191], v[208:211], v[76:79], 0
  s_add_u32 m0, s81, 0
  s_nop 0
  buffer_load_dwordx4 v48, s[12:15], s80 offen lds
  v_mfma_f32_16x16x32_bf16 v[192:195], v[208:211], v[80:83], 0
  s_waitcnt lgkmcnt(2)
  v_mfma_f32_16x16x32_bf16 v[184:187], v[212:215], v[84:87], v[184:187]
  ds_read_b128 v[208:211], v70 offset:12544
  v_cvt_pk_bf16_f32 v248, v196, v197
  v_mfma_f32_16x16x32_bf16 v[188:191], v[212:215], v[88:91], v[188:191]
  s_add_u32 m0, s81, 1024
  s_nop 0
  buffer_load_dwordx4 v49, s[12:15], s80 offen lds
  v_mfma_f32_16x16x32_bf16 v[192:195], v[212:215], v[92:95], v[192:195]
  v_cvt_pk_bf16_f32 v249, v198, v199
  s_waitcnt lgkmcnt(2)
  v_mfma_f32_16x16x32_bf16 v[184:187], v[216:219], v[96:99], v[184:187]
  ds_read_b128 v[212:215], v71 offset:12544
  v_cvt_pk_bf16_f32 v250, v200, v201
  v_mfma_f32_16x16x32_bf16 v[188:191], v[216:219], v[100:103], v[188:191]
  s_add_u32 m0, s81, 2048
  s_nop 0
  buffer_load_dwordx4 v50, s[12:15], s80 offen lds
  v_mfma_f32_16x16x32_bf16 v[192:195], v[216:219], v[104:107], v[192:195]
  v_cvt_pk_bf16_f32 v251, v202, v203
  s_waitcnt lgkmcnt(2)
  v_mfma_f32_16x16x32_bf16 v[184:187], v[220:223], v[108:111], v[184:187]
  ds_read_b128 v[216:219], v70 offset:13056
  v_accvgpr_write_b32 a30, v248
  v_mfma_f32_16x16x32_bf16 v[188:191], v[220:223], v[112:115], v[188:191]
  s_add_u32 m0, s81, 3072
  s_nop 0
  buffer_load_dwordx4 v51, s[12:15], s80 offen lds
  v_mfma_f32_16x16x32_bf16 v[192:195], v[220:223], v[116:119], v[192:195]
  v_accvgpr_write_b32 a31, v249
  s_waitcnt lgkmcnt(2)
  v_mfma_f32_16x16x32_bf16 v[184:187], v[208:211], v[120:123], v[184:187]
  ds_read_b128 v[220:223], v71 offset:13056
  v_accvgpr_write_b32 a110, v250
  v_mfma_f32_16x16x32_bf16 v[188:191], v[208:211], v[124:127], v[188:191]
  s_add_u32 m0, s81, 4096
  s_nop 0
  buffer_load_dwordx4 v52, s[12:15], s80 offen lds
  v_mfma_f32_16x16x32_bf16 v[192:195], v[208:211], v[128:131], v[192:195]
  v_accvgpr_write_b32 a111, v251
  s_waitcnt lgkmcnt(2)
  v_mfma_f32_16x16x32_bf16 v[184:187], v[212:215], v[132:135], v[184:187]
  ds_read_b128 v[208:211], v70 offset:13184
  s_mov_b64 exec, s[68:69]
  v_cvt_pk_bf16_f32 v158, v204, v205
  v_cvt_pk_bf16_f32 v159, v206, v207
  s_mov_b64 exec, -1
  v_mfma_f32_16x16x32_bf16 v[188:191], v[212:215], v[136:139], v[188:191]
  s_add_u32 m0, s81, 5120
  s_nop 0
  buffer_load_dwordx4 v53, s[12:15], s80 offen lds
  v_mfma_f32_16x16x32_bf16 v[192:195], v[212:215], v[140:143], v[192:195]
  s_waitcnt lgkmcnt(2)
  v_mfma_f32_16x16x32_bf16 v[196:199], v[216:219], v[72:75], 0
  ds_read_b128 v[212:215], v71 offset:13184
  v_mfma_f32_16x16x32_bf16 v[200:203], v[216:219], v[76:79], 0
  s_add_u32 m0, s81, 6144
  s_nop 0
  buffer_load_dwordx4 v54, s[12:15], s80 offen lds
  v_mfma_f32_16x16x32_bf16 v[204:207], v[216:219], v[80:83], 0
  s_waitcnt lgkmcnt(2)
  v_mfma_f32_16x16x32_bf16 v[196:199], v[220:223], v[84:87], v[196:199]
  ds_read_b128 v[216:219], v70 offset:13312
  v_cvt_pk_bf16_f32 v248, v184, v185
  v_mfma_f32_16x16x32_bf16 v[200:203], v[220:223], v[88:91], v[200:203]
  s_add_u32 m0, s81, 7168
  s_nop 0
  buffer_load_dwordx4 v55, s[12:15], s80 offen lds
  v_mfma_f32_16x16x32_bf16 v[204:207], v[220:223], v[92:95], v[204:207]
  v_cvt_pk_bf16_f32 v249, v186, v187
  s_waitcnt lgkmcnt(2)
  v_mfma_f32_16x16x32_bf16 v[196:199], v[208:211], v[96:99], v[196:199]
  ds_read_b128 v[220:223], v71 offset:13312
  v_cvt_pk_bf16_f32 v250, v188, v189
  v_mfma_f32_16x16x32_bf16 v[200:203], v[208:211], v[100:103], v[200:203]
  s_add_u32 m0, s81, 8192
  s_nop 0
  buffer_load_dwordx4 v56, s[12:15], s80 offen lds
  v_mfma_f32_16x16x32_bf16 v[204:207], v[208:211], v[104:107], v[204:207]
  v_cvt_pk_bf16_f32 v251, v190, v191
  s_waitcnt lgkmcnt(2)
  v_mfma_f32_16x16x32_bf16 v[196:199], v[212:215], v[108:111], v[196:199]
  v_accvgpr_write_b32 a32, v248
  v_mfma_f32_16x16x32_bf16 v[200:203], v[212:215], v[112:115], v[200:203]
  s_add_u32 m0, s81, 9216
  s_nop 0
  buffer_load_dwordx4 v57, s[12:15], s80 offen lds
  v_mfma_f32_16x16x32_bf16 v[204:207], v[212:215], v[116:119], v[204:207]
  v_accvgpr_write_b32 a33, v249
  s_waitcnt lgkmcnt(1)
  v_mfma_f32_16x16x32_bf16 v[196:199], v[216:219], v[120:123], v[196:199]
  v_accvgpr_write_b32 a112, v250
  v_mfma_f32_16x16x32_bf16 v[200:203], v[216:219], v[124:127], v[200:203]
  s_add_u32 m0, s81, 10240
  s_nop 0
  buffer_load_dwordx4 v58, s[12:15], s80 offen lds
  v_mfma_f32_16x16x32_bf16 v[204:207], v[216:219], v[128:131], v[204:207]
  v_accvgpr_write_b32 a113, v251
  s_waitcnt lgkmcnt(0)
  v_mfma_f32_16x16x32_bf16 v[196:199], v[220:223], v[132:135], v[196:199]
  v_cvt_pk_bf16_f32 v160, v192, v193
  v_cvt_pk_bf16_f32 v161, v194, v195
  v_mfma_f32_16x16x32_bf16 v[200:203], v[220:223], v[136:139], v[200:203]
  s_add_u32 m0, s81, 11264
  s_nop 0
  buffer_load_dwordx4 v59, s[12:15], s80 offen lds
  s_add_u32 s80, s80, 393216
  v_mfma_f32_16x16x32_bf16 v[204:207], v[220:223], v[140:143], v[204:207]
  s_add_u32 s21, s79, 1179648
  buffer_load_dwordx4 a[244:247], v63, s[28:31], s21 offen
  s_add_u32 s21, s79, 1179648
  buffer_load_dwordx4 a[248:251], v64, s[28:31], s21 offen
  s_add_u32 s21, s79, 1179648
  buffer_load_dwordx4 a[252:255], v65, s[28:31], s21 offen
  s_waitcnt vmcnt(18)
  ds_read_b128 v[208:211], v70 offset:24576
  ds_read_b128 v[212:215], v71 offset:24576
  ds_read_b128 v[216:219], v70 offset:24704
  s_waitcnt lgkmcnt(2)
  v_mfma_f32_16x16x32_bf16 v[184:187], v[208:211], v[72:75], 0
  ds_read_b128 v[220:223], v71 offset:24704
  v_mfma_f32_16x16x32_bf16 v[188:191], v[208:211], v[76:79], 0
  s_add_u32 m0, s81, 12288
  s_nop 0
  buffer_load_dwordx4 v48, s[12:15], s80 offen lds
  v_mfma_f32_16x16x32_bf16 v[192:195], v[208:211], v[80:83], 0
  s_waitcnt lgkmcnt(2)
  v_mfma_f32_16x16x32_bf16 v[184:187], v[212:215], v[84:87], v[184:187]
  ds_read_b128 v[208:211], v70 offset:24832
  v_cvt_pk_bf16_f32 v248, v196, v197
  v_mfma_f32_16x16x32_bf16 v[188:191], v[212:215], v[88:91], v[188:191]
  s_add_u32 m0, s81, 13312
  s_nop 0
  buffer_load_dwordx4 v49, s[12:15], s80 offen lds
  v_mfma_f32_16x16x32_bf16 v[192:195], v[212:215], v[92:95], v[192:195]
  v_cvt_pk_bf16_f32 v249, v198, v199
  s_waitcnt lgkmcnt(2)
  v_mfma_f32_16x16x32_bf16 v[184:187], v[216:219], v[96:99], v[184:187]
  ds_read_b128 v[212:215], v71 offset:24832
  v_cvt_pk_bf16_f32 v250, v200, v201
  v_mfma_f32_16x16x32_bf16 v[188:191], v[216:219], v[100:103], v[188:191]
  s_add_u32 m0, s81, 14336
  s_nop 0
  buffer_load_dwordx4 v50, s[12:15], s80 offen lds
  v_mfma_f32_16x16x32_bf16 v[192:195], v[216:219], v[104:107], v[192:195]
  v_cvt_pk_bf16_f32 v251, v202, v203
  s_waitcnt lgkmcnt(2)
  v_mfma_f32_16x16x32_bf16 v[184:187], v[220:223], v[108:111], v[184:187]
  ds_read_b128 v[216:219], v70 offset:25344
  v_accvgpr_write_b32 a34, v248
  v_mfma_f32_16x16x32_bf16 v[188:191], v[220:223], v[112:115], v[188:191]
  s_add_u32 m0, s81, 15360
  s_nop 0
  buffer_load_dwordx4 v51, s[12:15], s80 offen lds
  v_mfma_f32_16x16x32_bf16 v[192:195], v[220:223], v[116:119], v[192:195]
  v_accvgpr_write_b32 a35, v249
  s_waitcnt lgkmcnt(2)
  v_mfma_f32_16x16x32_bf16 v[184:187], v[208:211], v[120:123], v[184:187]
  ds_read_b128 v[220:223], v71 offset:25344
  v_accvgpr_write_b32 a114, v250
  v_mfma_f32_16x16x32_bf16 v[188:191], v[208:211], v[124:127], v[188:191]
  s_add_u32 m0, s81, 16384
  s_nop 0
  buffer_load_dwordx4 v52, s[12:15], s80 offen lds
  v_mfma_f32_16x16x32_bf16 v[192:195], v[208:211], v[128:131], v[192:195]
  v_accvgpr_write_b32 a115, v251
  s_waitcnt lgkmcnt(2)
  v_mfma_f32_16x16x32_bf16 v[184:187], v[212:215], v[132:135], v[184:187]
  ds_read_b128 v[208:211], v70 offset:25472
  s_mov_b64 exec, s[68:69]
  v_cvt_pk_bf16_f32 v160, v204, v205
  v_cvt_pk_bf16_f32 v161, v206, v207
  s_mov_b64 exec, -1
  v_mfma_f32_16x16x32_bf16 v[188:191], v[212:215], v[136:139], v[188:191]
  s_add_u32 m0, s81, 17408
  s_nop 0
  buffer_load_dwordx4 v53, s[12:15], s80 offen lds
  v_mfma_f32_16x16x32_bf16 v[192:195], v[212:215], v[140:143], v[192:195]
  s_waitcnt lgkmcnt(2)
  v_mfma_f32_16x16x32_bf16 v[196:199], v[216:219], v[72:75], 0
  ds_read_b128 v[212:215], v71 offset:25472
  v_mfma_f32_16x16x32_bf16 v[200:203], v[216:219], v[76:79], 0
  s_add_u32 m0, s81, 18432
  s_nop 0
  buffer_load_dwordx4 v54, s[12:15], s80 offen lds
  v_mfma_f32_16x16x32_bf16 v[204:207], v[216:219], v[80:83], 0
  s_waitcnt lgkmcnt(2)
  v_mfma_f32_16x16x32_bf16 v[196:199], v[220:223], v[84:87], v[196:199]
  ds_read_b128 v[216:219], v70 offset:25600
  v_cvt_pk_bf16_f32 v248, v184, v185
  v_mfma_f32_16x16x32_bf16 v[200:203], v[220:223], v[88:91], v[200:203]
  s_add_u32 m0, s81, 19456
  s_nop 0
  buffer_load_dwordx4 v55, s[12:15], s80 offen lds
  v_mfma_f32_16x16x32_bf16 v[204:207], v[220:223], v[92:95], v[204:207]
  v_cvt_pk_bf16_f32 v249, v186, v187
  s_waitcnt lgkmcnt(2)
  v_mfma_f32_16x16x32_bf16 v[196:199], v[208:211], v[96:99], v[196:199]
  ds_read_b128 v[220:223], v71 offset:25600
  v_cvt_pk_bf16_f32 v250, v188, v189
  v_mfma_f32_16x16x32_bf16 v[200:203], v[208:211], v[100:103], v[200:203]
  s_add_u32 m0, s81, 20480
  s_nop 0
  buffer_load_dwordx4 v56, s[12:15], s80 offen lds
  v_mfma_f32_16x16x32_bf16 v[204:207], v[208:211], v[104:107], v[204:207]
  v_cvt_pk_bf16_f32 v251, v190, v191
  s_waitcnt lgkmcnt(2)
  v_mfma_f32_16x16x32_bf16 v[196:199], v[212:215], v[108:111], v[196:199]
  v_accvgpr_write_b32 a36, v248
  v_mfma_f32_16x16x32_bf16 v[200:203], v[212:215], v[112:115], v[200:203]
  s_add_u32 m0, s81, 21504
  s_nop 0
  buffer_load_dwordx4 v57, s[12:15], s80 offen lds
  v_mfma_f32_16x16x32_bf16 v[204:207], v[212:215], v[116:119], v[204:207]
  v_accvgpr_write_b32 a37, v249
  s_waitcnt lgkmcnt(1)
  v_mfma_f32_16x16x32_bf16 v[196:199], v[216:219], v[120:123], v[196:199]
  v_accvgpr_write_b32 a116, v250
  v_mfma_f32_16x16x32_bf16 v[200:203], v[216:219], v[124:127], v[200:203]
  s_add_u32 m0, s81, 22528
  s_nop 0
  buffer_load_dwordx4 v58, s[12:15], s80 offen lds
  v_mfma_f32_16x16x32_bf16 v[204:207], v[216:219], v[128:131], v[204:207]
  v_accvgpr_write_b32 a117, v251
  s_waitcnt lgkmcnt(0)
  v_mfma_f32_16x16x32_bf16 v[196:199], v[220:223], v[132:135], v[196:199]
  v_cvt_pk_bf16_f32 v162, v192, v193
  v_cvt_pk_bf16_f32 v163, v194, v195
  v_mfma_f32_16x16x32_bf16 v[200:203], v[220:223], v[136:139], v[200:203]
  s_add_u32 m0, s81, 23552
  s_nop 0
  buffer_load_dwordx4 v59, s[12:15], s80 offen lds
  s_add_u32 s80, s80, 393216
  v_mfma_f32_16x16x32_bf16 v[204:207], v[220:223], v[140:143], v[204:207]
  s_add_u32 s21, s79, 1572864
  buffer_load_dwordx4 v[236:239], v63, s[28:31], s21 offen
  s_add_u32 s21, s79, 1572864
  buffer_load_dwordx4 v[240:243], v64, s[28:31], s21 offen
  s_add_u32 s21, s79, 1572864
  buffer_load_dwordx4 v[244:247], v65, s[28:31], s21 offen
  s_waitcnt vmcnt(18)
  ds_read_b128 v[208:211], v70 offset:0
  ds_read_b128 v[212:215], v71 offset:0
  ds_read_b128 v[216:219], v70 offset:128
  s_waitcnt lgkmcnt(2)
  v_mfma_f32_16x16x32_bf16 v[184:187], v[208:211], v[72:75], 0
  ds_read_b128 v[220:223], v71 offset:128
  v_mfma_f32_16x16x32_bf16 v[188:191], v[208:211], v[76:79], 0
  s_add_u32 m0, s81, 24576
  s_nop 0
  buffer_load_dwordx4 v48, s[12:15], s80 offen lds
  ds_write_b64 v69, v[144:145] offset:36864
  v_mfma_f32_16x16x32_bf16 v[192:195], v[208:211], v[80:83], 0
  s_waitcnt lgkmcnt(3)
  v_mfma_f32_16x16x32_bf16 v[184:187], v[212:215], v[84:87], v[184:187]
  ds_read_b128 v[208:211], v70 offset:256
  v_cvt_pk_bf16_f32 v248, v196, v197
  v_mfma_f32_16x16x32_bf16 v[188:191], v[212:215], v[88:91], v[188:191]
  s_add_u32 m0, s81, 25600
  s_nop 0
  buffer_load_dwordx4 v49, s[12:15], s80 offen lds
  ds_write_b64 v69, v[146:147] offset:37376
  v_mfma_f32_16x16x32_bf16 v[192:195], v[212:215], v[92:95], v[192:195]
  v_cvt_pk_bf16_f32 v249, v198, v199
  s_waitcnt lgkmcnt(4)
  v_mfma_f32_16x16x32_bf16 v[184:187], v[216:219], v[96:99], v[184:187]
  ds_read_b128 v[212:215], v71 offset:256
  v_cvt_pk_bf16_f32 v250, v200, v201
  v_mfma_f32_16x16x32_bf16 v[188:191], v[216:219], v[100:103], v[188:191]
  s_add_u32 m0, s81, 26624
  s_nop 0
  buffer_load_dwordx4 v50, s[12:15], s80 offen lds
  ds_write_b64 v69, v[148:149] offset:37888
  v_mfma_f32_16x16x32_bf16 v[192:195], v[216:219], v[104:107], v[192:195]
  v_cvt_pk_bf16_f32 v251, v202, v203
  s_waitcnt lgkmcnt(5)
  v_mfma_f32_16x16x32_bf16 v[184:187], v[220:223], v[108:111], v[184:187]
  ds_read_b128 v[216:219], v70 offset:768
  v_accvgpr_write_b32 a38, v248
  v_mfma_f32_16x16x32_bf16 v[188:191], v[220:223], v[112:115], v[188:191]
  s_add_u32 m0, s81, 27648
  s_nop 0
  buffer_load_dwordx4 v51, s[12:15], s80 offen lds
  ds_write_b64 v69, v[150:151] offset:38400
  v_mfma_f32_16x16x32_bf16 v[192:195], v[220:223], v[116:119], v[192:195]
  v_accvgpr_write_b32 a39, v249
  s_waitcnt lgkmcnt(5)
  v_mfma_f32_16x16x32_bf16 v[184:187], v[208:211], v[120:123], v[184:187]
  ds_read_b128 v[220:223], v71 offset:768
  v_accvgpr_write_b32 a118, v250
  v_mfma_f32_16x16x32_bf16 v[188:191], v[208:211], v[124:127], v[188:191]
  s_add_u32 m0, s81, 28672
  s_nop 0
  buffer_load_dwordx4 v52, s[12:15], s80 offen lds
  ds_write_b64 v69, v[152:153] offset:38912
  v_mfma_f32_16x16x32_bf16 v[192:195], v[208:211], v[128:131], v[192:195]
  v_accvgpr_write_b32 a119, v251
  s_waitcnt lgkmcnt(5)
  v_mfma_f32_16x16x32_bf16 v[184:187], v[212:215], v[132:135], v[184:187]
  ds_read_b128 v[208:211], v70 offset:896
  s_mov_b64 exec, s[68:69]
  v_cvt_pk_bf16_f32 v162, v204, v205
  v_cvt_pk_bf16_f32 v163, v206, v207
  s_mov_b64 exec, -1
  v_mfma_f32_16x16x32_bf16 v[188:191], v[212:215], v[136:139], v[188:191]
  s_add_u32 m0, s81, 29696
  s_nop 0
  buffer_load_dwordx4 v53, s[12:15], s80 offen lds
  ds_write_b64 v69, v[154:155] offset:39424
  v_mfma_f32_16x16x32_bf16 v[192:195], v[212:215], v[140:143], v[192:195]
  s_waitcnt lgkmcnt(5)
  v_mfma_f32_16x16x32_bf16 v[196:199], v[216:219], v[72:75], 0
  ds_read_b128 v[212:215], v71 offset:896
  v_mfma_f32_16x16x32_bf16 v[200:203], v[216:219], v[76:79], 0
  s_add_u32 m0, s81, 30720
  s_nop 0
  buffer_load_dwordx4 v54, s[12:15], s80 offen lds
  ds_write_b64 v69, v[156:157] offset:39936
  v_mfma_f32_16x16x32_bf16 v[204:207], v[216:219], v[80:83], 0
  s_waitcnt lgkmcnt(5)
  v_mfma_f32_16x16x32_bf16 v[196:199], v[220:223], v[84:87], v[196:199]
  ds_read_b128 v[216:219], v70 offset:1024
  v_cvt_pk_bf16_f32 v248, v184, v185
  v_mfma_f32_16x16x32_bf16 v[200:203], v[220:223], v[88:91], v[200:203]
  s_add_u32 m0, s81, 31744
  s_nop 0
  buffer_load_dwordx4 v55, s[12:15], s80 offen lds
  ds_write_b64 v69, v[158:159] offset:40448
  v_mfma_f32_16x16x32_bf16 v[204:207], v[220:223], v[92:95], v[204:207]
  v_cvt_pk_bf16_f32 v249, v186, v187
  s_waitcnt lgkmcnt(5)
  v_mfma_f32_16x16x32_bf16 v[196:199], v[208:211], v[96:99], v[196:199]
  ds_read_b128 v[220:223], v71 offset:1024
  v_cvt_pk_bf16_f32 v250, v188, v189
  v_mfma_f32_16x16x32_bf16 v[200:203], v[208:211], v[100:103], v[200:203]
  s_add_u32 m0, s81, 32768
  s_nop 0
  buffer_load_dwordx4 v56, s[12:15], s80 offen lds
  v_mfma_f32_16x16x32_bf16 v[204:207], v[208:211], v[104:107], v[204:207]
  v_cvt_pk_bf16_f32 v251, v190, v191
  s_waitcnt lgkmcnt(4)
  v_mfma_f32_16x16x32_bf16 v[196:199], v[212:215], v[108:111], v[196:199]
  v_accvgpr_write_b32 a40, v248
  v_mfma_f32_16x16x32_bf16 v[200:203], v[212:215], v[112:115], v[200:203]
  s_add_u32 m0, s81, 33792
  s_nop 0
  buffer_load_dwordx4 v57, s[12:15], s80 offen lds
  v_mfma_f32_16x16x32_bf16 v[204:207], v[212:215], v[116:119], v[204:207]
  v_accvgpr_write_b32 a41, v249
  s_waitcnt lgkmcnt(2)
  v_mfma_f32_16x16x32_bf16 v[196:199], v[216:219], v[120:123], v[196:199]
  v_accvgpr_write_b32 a120, v250
  v_mfma_f32_16x16x32_bf16 v[200:203], v[216:219], v[124:127], v[200:203]
  s_add_u32 m0, s81, 34816
  s_nop 0
  buffer_load_dwordx4 v58, s[12:15], s80 offen lds
  v_mfma_f32_16x16x32_bf16 v[204:207], v[216:219], v[128:131], v[204:207]
  v_accvgpr_write_b32 a121, v251
  s_waitcnt lgkmcnt(0)
  v_mfma_f32_16x16x32_bf16 v[196:199], v[220:223], v[132:135], v[196:199]
  v_cvt_pk_bf16_f32 v164, v192, v193
  v_cvt_pk_bf16_f32 v165, v194, v195
  v_mfma_f32_16x16x32_bf16 v[200:203], v[220:223], v[136:139], v[200:203]
  s_add_u32 m0, s81, 35840
  s_nop 0
  buffer_load_dwordx4 v59, s[12:15], s80 offen lds
  s_add_u32 s80, s80, 393216
  v_mfma_f32_16x16x32_bf16 v[204:207], v[220:223], v[140:143], v[204:207]
  s_add_u32 s21, s79, 0
  buffer_load_dwordx4 a[160:163], v63, s[24:27], s21 offen
  s_add_u32 s21, s79, 0
  buffer_load_dwordx4 a[164:167], v64, s[24:27], s21 offen
  s_add_u32 s21, s79, 0
  buffer_load_dwordx4 a[168:171], v65, s[24:27], s21 offen
  s_waitcnt vmcnt(18)
  s_getpc_b64 s[22:23]
cpf_base:
  s_add_u32 s22, s22, post_wvo-cpf_base
  s_addc_u32 s23, s23, 0
  v_lshlrev_b32 v252, 7, v0
  v_mov_b32 v253, s23
  v_add_co_u32 v252, vcc, s22, v252
  s_nop 1
  v_addc_co_u32 v253, vcc, 0, v253, vcc
  global_load_dword v254, v[252:253], off
  ds_read_b128 v[208:211], v70 offset:12288
  ds_read_b128 v[212:215], v71 offset:12288
  ds_read_b128 v[216:219], v70 offset:12416
  s_waitcnt lgkmcnt(2)
  v_mfma_f32_16x16x32_bf16 v[184:187], v[208:211], v[72:75], 0
  ds_read_b128 v[220:223], v71 offset:12416
  v_mfma_f32_16x16x32_bf16 v[188:191], v[208:211], v[76:79], 0
  s_add_u32 m0, s81, 0
  s_nop 0
  buffer_load_dwordx4 v48, s[12:15], s80 offen lds
  v_mfma_f32_16x16x32_bf16 v[192:195], v[208:211], v[80:83], 0
  s_waitcnt lgkmcnt(2)
  v_mfma_f32_16x16x32_bf16 v[184:187], v[212:215], v[84:87], v[184:187]
  ds_read_b128 v[208:211], v70 offset:12544
  v_cvt_pk_bf16_f32 v248, v196, v197
  v_mfma_f32_16x16x32_bf16 v[188:191], v[212:215], v[88:91], v[188:191]
  s_add_u32 m0, s81, 1024
  s_nop 0
  buffer_load_dwordx4 v49, s[12:15], s80 offen lds
  v_mfma_f32_16x16x32_bf16 v[192:195], v[212:215], v[92:95], v[192:195]
  v_cvt_pk_bf16_f32 v249, v198, v199
  s_waitcnt lgkmcnt(2)
  v_mfma_f32_16x16x32_bf16 v[184:187], v[216:219], v[96:99], v[184:187]
  ds_read_b128 v[212:215], v71 offset:12544
  v_cvt_pk_bf16_f32 v250, v200, v201
  v_mfma_f32_16x16x32_bf16 v[188:191], v[216:219], v[100:103], v[188:191]
  s_add_u32 m0, s81, 2048
  s_nop 0
  buffer_load_dwordx4 v50, s[12:15], s80 offen lds
  v_mfma_f32_16x16x32_bf16 v[192:195], v[216:219], v[104:107], v[192:195]
  v_cvt_pk_bf16_f32 v251, v202, v203
  s_waitcnt lgkmcnt(2)
  v_mfma_f32_16x16x32_bf16 v[184:187], v[220:223], v[108:111], v[184:187]
  ds_read_b128 v[216:219], v70 offset:13056
  v_accvgpr_write_b32 a42, v248
  v_mfma_f32_16x16x32_bf16 v[188:191], v[220:223], v[112:115], v[188:191]
  s_add_u32 m0, s81, 3072
  s_nop 0
  buffer_load_dwordx4 v51, s[12:15], s80 offen lds
  v_mfma_f32_16x16x32_bf16 v[192:195], v[220:223], v[116:119], v[192:195]
  v_accvgpr_write_b32 a43, v249
  s_waitcnt lgkmcnt(2)
  v_mfma_f32_16x16x32_bf16 v[184:187], v[208:211], v[120:123], v[184:187]
  ds_read_b128 v[220:223], v71 offset:13056
  v_accvgpr_write_b32 a122, v250
  v_mfma_f32_16x16x32_bf16 v[188:191], v[208:211], v[124:127], v[188:191]
  s_add_u32 m0, s81, 4096
  s_nop 0
  buffer_load_dwordx4 v52, s[12:15], s80 offen lds
  v_mfma_f32_16x16x32_bf16 v[192:195], v[208:211], v[128:131], v[192:195]
  v_accvgpr_write_b32 a123, v251
  s_waitcnt lgkmcnt(2)
  v_mfma_f32_16x16x32_bf16 v[184:187], v[212:215], v[132:135], v[184:187]
  ds_read_b128 v[208:211], v70 offset:13184
  s_mov_b64 exec, s[68:69]
  v_cvt_pk_bf16_f32 v164, v204, v205
  v_cvt_pk_bf16_f32 v165, v206, v207
  s_mov_b64 exec, -1
  v_mfma_f32_16x16x32_bf16 v[188:191], v[212:215], v[136:139], v[188:191]
  s_add_u32 m0, s81, 5120
  s_nop 0
  buffer_load_dwordx4 v53, s[12:15], s80 offen lds
  v_mfma_f32_16x16x32_bf16 v[192:195], v[212:215], v[140:143], v[192:195]
  s_waitcnt lgkmcnt(2)
  v_mfma_f32_16x16x32_bf16 v[196:199], v[216:219], v[72:75], 0
  ds_read_b128 v[212:215], v71 offset:13184
  v_mfma_f32_16x16x32_bf16 v[200:203], v[216:219], v[76:79], 0
  s_add_u32 m0, s81, 6144
  s_nop 0
  buffer_load_dwordx4 v54, s[12:15], s80 offen lds
  v_mfma_f32_16x16x32_bf16 v[204:207], v[216:219], v[80:83], 0
  s_waitcnt lgkmcnt(2)
  v_mfma_f32_16x16x32_bf16 v[196:199], v[220:223], v[84:87], v[196:199]
  ds_read_b128 v[216:219], v70 offset:13312
  v_cvt_pk_bf16_f32 v248, v184, v185
  v_mfma_f32_16x16x32_bf16 v[200:203], v[220:223], v[88:91], v[200:203]
  s_add_u32 m0, s81, 7168
  s_nop 0
  buffer_load_dwordx4 v55, s[12:15], s80 offen lds
  v_mfma_f32_16x16x32_bf16 v[204:207], v[220:223], v[92:95], v[204:207]
  v_cvt_pk_bf16_f32 v249, v186, v187
  s_waitcnt lgkmcnt(2)
  v_mfma_f32_16x16x32_bf16 v[196:199], v[208:211], v[96:99], v[196:199]
  ds_read_b128 v[220:223], v71 offset:13312
  v_cvt_pk_bf16_f32 v250, v188, v189
  v_mfma_f32_16x16x32_bf16 v[200:203], v[208:211], v[100:103], v[200:203]
  s_add_u32 m0, s81, 8192
  s_nop 0
  buffer_load_dwordx4 v56, s[12:15], s80 offen lds
  v_mfma_f32_16x16x32_bf16 v[204:207], v[208:211], v[104:107], v[204:207]
  v_cvt_pk_bf16_f32 v251, v190, v191
  s_waitcnt lgkmcnt(2)
  v_mfma_f32_16x16x32_bf16 v[196:199], v[212:215], v[108:111], v[196:199]
  v_accvgpr_write_b32 a44, v248
  v_mfma_f32_16x16x32_bf16 v[200:203], v[212:215], v[112:115], v[200:203]
  s_add_u32 m0, s81, 9216
  s_nop 0
  buffer_load_dwordx4 v57, s[12:15], s80 offen lds
  v_mfma_f32_16x16x32_bf16 v[204:207], v[212:215], v[116:119], v[204:207]
  v_accvgpr_write_b32 a45, v249
  s_waitcnt lgkmcnt(1)
  v_mfma_f32_16x16x32_bf16 v[196:199], v[216:219], v[120:123], v[196:199]
  v_accvgpr_write_b32 a124, v250
  v_mfma_f32_16x16x32_bf16 v[200:203], v[216:219], v[124:127], v[200:203]
  s_add_u32 m0, s81, 10240
  s_nop 0
  buffer_load_dwordx4 v58, s[12:15], s80 offen lds
  v_mfma_f32_16x16x32_bf16 v[204:207], v[216:219], v[128:131], v[204:207]
  v_accvgpr_write_b32 a125, v251
  s_waitcnt lgkmcnt(0)
  v_mfma_f32_16x16x32_bf16 v[196:199], v[220:223], v[132:135], v[196:199]
  v_cvt_pk_bf16_f32 v166, v192, v193
  v_cvt_pk_bf16_f32 v167, v194, v195
  v_mfma_f32_16x16x32_bf16 v[200:203], v[220:223], v[136:139], v[200:203]
  s_add_u32 m0, s81, 11264
  s_nop 0
  buffer_load_dwordx4 v59, s[12:15], s80 offen lds
  s_add_u32 s80, s80, 393216
  v_mfma_f32_16x16x32_bf16 v[204:207], v[220:223], v[140:143], v[204:207]
  s_add_u32 s21, s79, 393216
  buffer_load_dwordx4 a[184:187], v63, s[24:27], s21 offen
  s_add_u32 s21, s79, 393216
  buffer_load_dwordx4 a[188:191], v64, s[24:27], s21 offen
  s_add_u32 s21, s79, 393216
  buffer_load_dwordx4 a[192:195], v65, s[24:27], s21 offen
  s_waitcnt vmcnt(19)
  ds_read_b128 v[208:211], v70 offset:24576
  ds_read_b128 v[212:215], v71 offset:24576
  ds_read_b128 v[216:219], v70 offset:24704
  s_waitcnt lgkmcnt(2)
  v_mfma_f32_16x16x32_bf16 v[184:187], v[208:211], v[72:75], 0
  ds_read_b128 v[220:223], v71 offset:24704
  v_mfma_f32_16x16x32_bf16 v[188:191], v[208:211], v[76:79], 0
  s_add_u32 m0, s81, 12288
  s_nop 0
  buffer_load_dwordx4 v48, s[12:15], s80 offen lds
  v_mfma_f32_16x16x32_bf16 v[192:195], v[208:211], v[80:83], 0
  s_waitcnt lgkmcnt(2)
  v_mfma_f32_16x16x32_bf16 v[184:187], v[212:215], v[84:87], v[184:187]
  ds_read_b128 v[208:211], v70 offset:24832
  v_cvt_pk_bf16_f32 v248, v196, v197
  v_mfma_f32_16x16x32_bf16 v[188:191], v[212:215], v[88:91], v[188:191]
  s_add_u32 m0, s81, 13312
  s_nop 0
  buffer_load_dwordx4 v49, s[12:15], s80 offen lds
  v_mfma_f32_16x16x32_bf16 v[192:195], v[212:215], v[92:95], v[192:195]
  v_cvt_pk_bf16_f32 v249, v198, v199
  s_waitcnt lgkmcnt(2)
  v_mfma_f32_16x16x32_bf16 v[184:187], v[216:219], v[96:99], v[184:187]
  ds_read_b128 v[212:215], v71 offset:24832
  v_cvt_pk_bf16_f32 v250, v200, v201
  v_mfma_f32_16x16x32_bf16 v[188:191], v[216:219], v[100:103], v[188:191]
  s_add_u32 m0, s81, 14336
  s_nop 0
  buffer_load_dwordx4 v50, s[12:15], s80 offen lds
  v_mfma_f32_16x16x32_bf16 v[192:195], v[216:219], v[104:107], v[192:195]
  v_cvt_pk_bf16_f32 v251, v202, v203
  s_waitcnt lgkmcnt(2)
  v_mfma_f32_16x16x32_bf16 v[184:187], v[220:223], v[108:111], v[184:187]
  ds_read_b128 v[216:219], v70 offset:25344
  v_accvgpr_write_b32 a46, v248
  v_mfma_f32_16x16x32_bf16 v[188:191], v[220:223], v[112:115], v[188:191]
  s_add_u32 m0, s81, 15360
  s_nop 0
  buffer_load_dwordx4 v51, s[12:15], s80 offen lds
  v_mfma_f32_16x16x32_bf16 v[192:195], v[220:223], v[116:119], v[192:195]
  v_accvgpr_write_b32 a47, v249
  s_waitcnt lgkmcnt(2)
  v_mfma_f32_16x16x32_bf16 v[184:187], v[208:211], v[120:123], v[184:187]
  ds_read_b128 v[220:223], v71 offset:25344
  v_accvgpr_write_b32 a126, v250
  v_mfma_f32_16x16x32_bf16 v[188:191], v[208:211], v[124:127], v[188:191]
  s_add_u32 m0, s81, 16384
  s_nop 0
  buffer_load_dwordx4 v52, s[12:15], s80 offen lds
  v_mfma_f32_16x16x32_bf16 v[192:195], v[208:211], v[128:131], v[192:195]
  v_accvgpr_write_b32 a127, v251
  s_waitcnt lgkmcnt(2)
  v_mfma_f32_16x16x32_bf16 v[184:187], v[212:215], v[132:135], v[184:187]
  ds_read_b128 v[208:211], v70 offset:25472
  s_mov_b64 exec, s[68:69]
  v_cvt_pk_bf16_f32 v166, v204, v205
  v_cvt_pk_bf16_f32 v167, v206, v207
  s_mov_b64 exec, -1
  v_mfma_f32_16x16x32_bf16 v[188:191], v[212:215], v[136:139], v[188:191]
  s_add_u32 m0, s81, 17408
  s_nop 0
  buffer_load_dwordx4 v53, s[12:15], s80 offen lds
  v_mfma_f32_16x16x32_bf16 v[192:195], v[212:215], v[140:143], v[192:195]
  s_waitcnt lgkmcnt(2)
  v_mfma_f32_16x16x32_bf16 v[196:199], v[216:219], v[72:75], 0
  ds_read_b128 v[212:215], v71 offset:25472
  v_mfma_f32_16x16x32_bf16 v[200:203], v[216:219], v[76:79], 0
  s_add_u32 m0, s81, 18432
  s_nop 0
  buffer_load_dwordx4 v54, s[12:15], s80 offen lds
  v_mfma_f32_16x16x32_bf16 v[204:207], v[216:219], v[80:83], 0
  s_waitcnt lgkmcnt(2)
  v_mfma_f32_16x16x32_bf16 v[196:199], v[220:223], v[84:87], v[196:199]
  ds_read_b128 v[216:219], v70 offset:25600
  v_cvt_pk_bf16_f32 v248, v184, v185
  v_mfma_f32_16x16x32_bf16 v[200:203], v[220:223], v[88:91], v[200:203]
  s_add_u32 m0, s81, 19456
  s_nop 0
  buffer_load_dwordx4 v55, s[12:15], s80 offen lds
  v_mfma_f32_16x16x32_bf16 v[204:207], v[220:223], v[92:95], v[204:207]
  v_cvt_pk_bf16_f32 v249, v186, v187
  s_waitcnt lgkmcnt(2)
  v_mfma_f32_16x16x32_bf16 v[196:199], v[208:211], v[96:99], v[196:199]
  ds_read_b128 v[220:223], v71 offset:25600
  v_cvt_pk_bf16_f32 v250, v188, v189
  v_mfma_f32_16x16x32_bf16 v[200:203], v[208:211], v[100:103], v[200:203]
  s_add_u32 m0, s81, 20480
  s_nop 0
  buffer_load_dwordx4 v56, s[12:15], s80 offen lds
  v_mfma_f32_16x16x32_bf16 v[204:207], v[208:211], v[104:107], v[204:207]
  v_cvt_pk_bf16_f32 v251, v190, v191
  s_waitcnt lgkmcnt(2)
  v_mfma_f32_16x16x32_bf16 v[196:199], v[212:215], v[108:111], v[196:199]
  v_accvgpr_write_b32 a48, v248
  v_mfma_f32_16x16x32_bf16 v[200:203], v[212:215], v[112:115], v[200:203]
  s_add_u32 m0, s81, 21504
  s_nop 0
  buffer_load_dwordx4 v57, s[12:15], s80 offen lds
  v_mfma_f32_16x16x32_bf16 v[204:207], v[212:215], v[116:119], v[204:207]
  v_accvgpr_write_b32 a49, v249
  s_waitcnt lgkmcnt(1)
  v_mfma_f32_16x16x32_bf16 v[196:199], v[216:219], v[120:123], v[196:199]
  v_accvgpr_write_b32 a128, v250
  v_mfma_f32_16x16x32_bf16 v[200:203], v[216:219], v[124:127], v[200:203]
  s_add_u32 m0, s81, 22528
  s_nop 0
  buffer_load_dwordx4 v58, s[12:15], s80 offen lds
  v_mfma_f32_16x16x32_bf16 v[204:207], v[216:219], v[128:131], v[204:207]
  v_accvgpr_write_b32 a129, v251
  s_waitcnt lgkmcnt(0)
  v_mfma_f32_16x16x32_bf16 v[196:199], v[220:223], v[132:135], v[196:199]
  v_cvt_pk_bf16_f32 v168, v192, v193
  v_cvt_pk_bf16_f32 v169, v194, v195
  v_mfma_f32_16x16x32_bf16 v[200:203], v[220:223], v[136:139], v[200:203]
  s_add_u32 m0, s81, 23552
  s_nop 0
  buffer_load_dwordx4 v59, s[12:15], s80 offen lds
  s_add_u32 s80, s80, 393216
  v_mfma_f32_16x16x32_bf16 v[204:207], v[220:223], v[140:143], v[204:207]
  s_add_u32 s21, s79, 786432
  buffer_load_dwordx4 a[208:211], v63, s[24:27], s21 offen
  s_add_u32 s21, s79, 786432
  buffer_load_dwordx4 a[212:215], v64, s[24:27], s21 offen
  s_add_u32 s21, s79, 786432
  buffer_load_dwordx4 a[216:219], v65, s[24:27], s21 offen
  s_waitcnt vmcnt(18)
  buffer_load_dword v66, v67, s[32:35], 0 offen sc1
  ds_read_b128 v[208:211], v70 offset:0
  ds_read_b128 v[212:215], v71 offset:0
  ds_read_b128 v[216:219], v70 offset:128
  s_waitcnt lgkmcnt(2)
  v_mfma_f32_16x16x32_bf16 v[184:187], v[208:211], v[72:75], 0
  ds_read_b128 v[220:223], v71 offset:128
  v_mfma_f32_16x16x32_bf16 v[188:191], v[208:211], v[76:79], 0
  s_add_u32 m0, s81, 24576
  s_nop 0
  buffer_load_dwordx4 v48, s[12:15], s80 offen lds
  v_mfma_f32_16x16x32_bf16 v[192:195], v[208:211], v[80:83], 0
  s_waitcnt lgkmcnt(2)
  v_mfma_f32_16x16x32_bf16 v[184:187], v[212:215], v[84:87], v[184:187]
  ds_read_b128 v[208:211], v70 offset:256
  v_cvt_pk_bf16_f32 v248, v196, v197
  v_mfma_f32_16x16x32_bf16 v[188:191], v[212:215], v[88:91], v[188:191]
  s_add_u32 m0, s81, 25600
  s_nop 0
  buffer_load_dwordx4 v49, s[12:15], s80 offen lds
  v_mfma_f32_16x16x32_bf16 v[192:195], v[212:215], v[92:95], v[192:195]
  v_cvt_pk_bf16_f32 v249, v198, v199
  s_waitcnt lgkmcnt(2)
  v_mfma_f32_16x16x32_bf16 v[184:187], v[216:219], v[96:99], v[184:187]
  ds_read_b128 v[212:215], v71 offset:256
  v_cvt_pk_bf16_f32 v250, v200, v201
  v_mfma_f32_16x16x32_bf16 v[188:191], v[216:219], v[100:103], v[188:191]
  s_add_u32 m0, s81, 26624
  s_nop 0
  buffer_load_dwordx4 v50, s[12:15], s80 offen lds
  v_mfma_f32_16x16x32_bf16 v[192:195], v[216:219], v[104:107], v[192:195]
  v_cvt_pk_bf16_f32 v251, v202, v203
  s_waitcnt lgkmcnt(2)
  v_mfma_f32_16x16x32_bf16 v[184:187], v[220:223], v[108:111], v[184:187]
  ds_read_b128 v[216:219], v70 offset:768
  v_accvgpr_write_b32 a50, v248
  v_mfma_f32_16x16x32_bf16 v[188:191], v[220:223], v[112:115], v[188:191]
  s_add_u32 m0, s81, 27648
  s_nop 0
  buffer_load_dwordx4 v51, s[12:15], s80 offen lds
  v_mfma_f32_16x16x32_bf16 v[192:195], v[220:223], v[116:119], v[192:195]
  v_accvgpr_write_b32 a51, v249
  s_waitcnt lgkmcnt(2)
  v_mfma_f32_16x16x32_bf16 v[184:187], v[208:211], v[120:123], v[184:187]
  ds_read_b128 v[220:223], v71 offset:768
  v_accvgpr_write_b32 a130, v250
  v_mfma_f32_16x16x32_bf16 v[188:191], v[208:211], v[124:127], v[188:191]
  s_add_u32 m0, s81, 28672
  s_nop 0
  buffer_load_dwordx4 v52, s[12:15], s80 offen lds
  v_mfma_f32_16x16x32_bf16 v[192:195], v[208:211], v[128:131], v[192:195]
  v_accvgpr_write_b32 a131, v251
  s_waitcnt lgkmcnt(2)
  v_mfma_f32_16x16x32_bf16 v[184:187], v[212:215], v[132:135], v[184:187]
  ds_read_b128 v[208:211], v70 offset:896
  s_mov_b64 exec, s[68:69]
  v_cvt_pk_bf16_f32 v168, v204, v205
  v_cvt_pk_bf16_f32 v169, v206, v207
  s_mov_b64 exec, -1
  v_mfma_f32_16x16x32_bf16 v[188:191], v[212:215], v[136:139], v[188:191]
  s_add_u32 m0, s81, 29696
  s_nop 0
  buffer_load_dwordx4 v53, s[12:15], s80 offen lds
  v_mfma_f32_16x16x32_bf16 v[192:195], v[212:215], v[140:143], v[192:195]
  s_waitcnt lgkmcnt(2)
  v_mfma_f32_16x16x32_bf16 v[196:199], v[216:219], v[72:75], 0
  ds_read_b128 v[212:215], v71 offset:896
  v_mfma_f32_16x16x32_bf16 v[200:203], v[216:219], v[76:79], 0
  s_add_u32 m0, s81, 30720
  s_nop 0
  buffer_load_dwordx4 v54, s[12:15], s80 offen lds
  v_mfma_f32_16x16x32_bf16 v[204:207], v[216:219], v[80:83], 0
  s_waitcnt lgkmcnt(2)
  v_mfma_f32_16x16x32_bf16 v[196:199], v[220:223], v[84:87], v[196:199]
  ds_read_b128 v[216:219], v70 offset:1024
  v_cvt_pk_bf16_f32 v248, v184, v185
  v_mfma_f32_16x16x32_bf16 v[200:203], v[220:223], v[88:91], v[200:203]
  s_add_u32 m0, s81, 31744
  s_nop 0
  buffer_load_dwordx4 v55, s[12:15], s80 offen lds
  v_mfma_f32_16x16x32_bf16 v[204:207], v[220:223], v[92:95], v[204:207]
  v_cvt_pk_bf16_f32 v249, v186, v187
  s_waitcnt lgkmcnt(2)
  v_mfma_f32_16x16x32_bf16 v[196:199], v[208:211], v[96:99], v[196:199]
  ds_read_b128 v[220:223], v71 offset:1024
  v_cvt_pk_bf16_f32 v250, v188, v189
  v_mfma_f32_16x16x32_bf16 v[200:203], v[208:211], v[100:103], v[200:203]
  s_add_u32 m0, s81, 32768
  s_nop 0
  buffer_load_dwordx4 v56, s[12:15], s80 offen lds
  v_mfma_f32_16x16x32_bf16 v[204:207], v[208:211], v[104:107], v[204:207]
  v_cvt_pk_bf16_f32 v251, v190, v191
  s_waitcnt lgkmcnt(2)
  v_mfma_f32_16x16x32_bf16 v[196:199], v[212:215], v[108:111], v[196:199]
  v_accvgpr_write_b32 a52, v248
  v_mfma_f32_16x16x32_bf16 v[200:203], v[212:215], v[112:115], v[200:203]
  s_add_u32 m0, s81, 33792
  s_nop 0
  buffer_load_dwordx4 v57, s[12:15], s80 offen lds
  v_mfma_f32_16x16x32_bf16 v[204:207], v[212:215], v[116:119], v[204:207]
  v_accvgpr_write_b32 a53, v249
  s_waitcnt lgkmcnt(1)
  v_mfma_f32_16x16x32_bf16 v[196:199], v[216:219], v[120:123], v[196:199]
  v_accvgpr_write_b32 a132, v250
  v_mfma_f32_16x16x32_bf16 v[200:203], v[216:219], v[124:127], v[200:203]
  s_add_u32 m0, s81, 34816
  s_nop 0
  buffer_load_dwordx4 v58, s[12:15], s80 offen lds
  v_mfma_f32_16x16x32_bf16 v[204:207], v[216:219], v[128:131], v[204:207]
  v_accvgpr_write_b32 a133, v251
  s_waitcnt lgkmcnt(0)
  v_mfma_f32_16x16x32_bf16 v[196:199], v[220:223], v[132:135], v[196:199]
  v_cvt_pk_bf16_f32 v170, v192, v193
  v_cvt_pk_bf16_f32 v171, v194, v195
  v_mfma_f32_16x16x32_bf16 v[200:203], v[220:223], v[136:139], v[200:203]
  s_add_u32 m0, s81, 35840
  s_nop 0
  buffer_load_dwordx4 v59, s[12:15], s80 offen lds
  s_add_u32 s80, s80, 393216
  v_mfma_f32_16x16x32_bf16 v[204:207], v[220:223], v[140:143], v[204:207]
  s_add_u32 s21, s79, 1179648
  buffer_load_dwordx4 a[232:235], v63, s[24:27], s21 offen
  s_add_u32 s21, s79, 1179648
  buffer_load_dwordx4 a[236:239], v64, s[24:27], s21 offen
  s_add_u32 s21, s79, 1179648
  buffer_load_dwordx4 a[240:243], v65, s[24:27], s21 offen
  s_waitcnt vmcnt(19)
  ds_read_b128 v[208:211], v70 offset:12288
  ds_read_b128 v[212:215], v71 offset:12288
  ds_read_b128 v[216:219], v70 offset:12416
  s_waitcnt lgkmcnt(2)
  v_mfma_f32_16x16x32_bf16 v[184:187], v[208:211], v[72:75], 0
  ds_read_b128 v[220:223], v71 offset:12416
  v_mfma_f32_16x16x32_bf16 v[188:191], v[208:211], v[76:79], 0
  s_add_u32 m0, s81, 0
  s_nop 0
  buffer_load_dwordx4 v48, s[12:15], s80 offen lds
  v_mfma_f32_16x16x32_bf16 v[192:195], v[208:211], v[80:83], 0
  s_waitcnt lgkmcnt(2)
  v_mfma_f32_16x16x32_bf16 v[184:187], v[212:215], v[84:87], v[184:187]
  ds_read_b128 v[208:211], v70 offset:12544
  v_cvt_pk_bf16_f32 v248, v196, v197
  v_mfma_f32_16x16x32_bf16 v[188:191], v[212:215], v[88:91], v[188:191]
  s_add_u32 m0, s81, 1024
  s_nop 0
  buffer_load_dwordx4 v49, s[12:15], s80 offen lds
  v_mfma_f32_16x16x32_bf16 v[192:195], v[212:215], v[92:95], v[192:195]
  v_cvt_pk_bf16_f32 v249, v198, v199
  s_waitcnt lgkmcnt(2)
  v_mfma_f32_16x16x32_bf16 v[184:187], v[216:219], v[96:99], v[184:187]
  ds_read_b128 v[212:215], v71 offset:12544
  v_cvt_pk_bf16_f32 v250, v200, v201
  v_mfma_f32_16x16x32_bf16 v[188:191], v[216:219], v[100:103], v[188:191]
  s_add_u32 m0, s81, 2048
  s_nop 0
  buffer_load_dwordx4 v50, s[12:15], s80 offen lds
  v_mfma_f32_16x16x32_bf16 v[192:195], v[216:219], v[104:107], v[192:195]
  v_cvt_pk_bf16_f32 v251, v202, v203
  s_waitcnt lgkmcnt(2)
  v_mfma_f32_16x16x32_bf16 v[184:187], v[220:223], v[108:111], v[184:187]
  ds_read_b128 v[216:219], v70 offset:13056
  v_accvgpr_write_b32 a54, v248
  v_mfma_f32_16x16x32_bf16 v[188:191], v[220:223], v[112:115], v[188:191]
  s_add_u32 m0, s81, 3072
  s_nop 0
  buffer_load_dwordx4 v51, s[12:15], s80 offen lds
  v_mfma_f32_16x16x32_bf16 v[192:195], v[220:223], v[116:119], v[192:195]
  v_accvgpr_write_b32 a55, v249
  s_waitcnt lgkmcnt(2)
  v_mfma_f32_16x16x32_bf16 v[184:187], v[208:211], v[120:123], v[184:187]
  ds_read_b128 v[220:223], v71 offset:13056
  v_accvgpr_write_b32 a134, v250
  v_mfma_f32_16x16x32_bf16 v[188:191], v[208:211], v[124:127], v[188:191]
  s_add_u32 m0, s81, 4096
  s_nop 0
  buffer_load_dwordx4 v52, s[12:15], s80 offen lds
  v_mfma_f32_16x16x32_bf16 v[192:195], v[208:211], v[128:131], v[192:195]
  v_accvgpr_write_b32 a135, v251
  s_waitcnt lgkmcnt(2)
  v_mfma_f32_16x16x32_bf16 v[184:187], v[212:215], v[132:135], v[184:187]
  ds_read_b128 v[208:211], v70 offset:13184
  s_mov_b64 exec, s[68:69]
  v_cvt_pk_bf16_f32 v170, v204, v205
  v_cvt_pk_bf16_f32 v171, v206, v207
  s_mov_b64 exec, -1
  v_mfma_f32_16x16x32_bf16 v[188:191], v[212:215], v[136:139], v[188:191]
  s_add_u32 m0, s81, 5120
  s_nop 0
  buffer_load_dwordx4 v53, s[12:15], s80 offen lds
  v_mfma_f32_16x16x32_bf16 v[192:195], v[212:215], v[140:143], v[192:195]
  s_waitcnt lgkmcnt(2)
  v_mfma_f32_16x16x32_bf16 v[196:199], v[216:219], v[72:75], 0
  ds_read_b128 v[212:215], v71 offset:13184
  v_mfma_f32_16x16x32_bf16 v[200:203], v[216:219], v[76:79], 0
  s_add_u32 m0, s81, 6144
  s_nop 0
  buffer_load_dwordx4 v54, s[12:15], s80 offen lds
  v_mfma_f32_16x16x32_bf16 v[204:207], v[216:219], v[80:83], 0
  s_waitcnt lgkmcnt(2)
  v_mfma_f32_16x16x32_bf16 v[196:199], v[220:223], v[84:87], v[196:199]
  ds_read_b128 v[216:219], v70 offset:13312
  v_cvt_pk_bf16_f32 v248, v184, v185
  v_mfma_f32_16x16x32_bf16 v[200:203], v[220:223], v[88:91], v[200:203]
  s_add_u32 m0, s81, 7168
  s_nop 0
  buffer_load_dwordx4 v55, s[12:15], s80 offen lds
  v_mfma_f32_16x16x32_bf16 v[204:207], v[220:223], v[92:95], v[204:207]
  v_cvt_pk_bf16_f32 v249, v186, v187
  s_waitcnt lgkmcnt(2)
  v_mfma_f32_16x16x32_bf16 v[196:199], v[208:211], v[96:99], v[196:199]
  ds_read_b128 v[220:223], v71 offset:13312
  v_cvt_pk_bf16_f32 v250, v188, v189
  v_mfma_f32_16x16x32_bf16 v[200:203], v[208:211], v[100:103], v[200:203]
  s_add_u32 m0, s81, 8192
  s_nop 0
  buffer_load_dwordx4 v56, s[12:15], s80 offen lds
  v_mfma_f32_16x16x32_bf16 v[204:207], v[208:211], v[104:107], v[204:207]
  v_cvt_pk_bf16_f32 v251, v190, v191
  s_waitcnt lgkmcnt(2)
  v_mfma_f32_16x16x32_bf16 v[196:199], v[212:215], v[108:111], v[196:199]
  v_accvgpr_write_b32 a56, v248
  v_mfma_f32_16x16x32_bf16 v[200:203], v[212:215], v[112:115], v[200:203]
  s_add_u32 m0, s81, 9216
  s_nop 0
  buffer_load_dwordx4 v57, s[12:15], s80 offen lds
  v_mfma_f32_16x16x32_bf16 v[204:207], v[212:215], v[116:119], v[204:207]
  v_accvgpr_write_b32 a57, v249
  s_waitcnt lgkmcnt(1)
  v_mfma_f32_16x16x32_bf16 v[196:199], v[216:219], v[120:123], v[196:199]
  v_accvgpr_write_b32 a136, v250
  v_mfma_f32_16x16x32_bf16 v[200:203], v[216:219], v[124:127], v[200:203]
  s_add_u32 m0, s81, 10240
  s_nop 0
  buffer_load_dwordx4 v58, s[12:15], s80 offen lds
  v_mfma_f32_16x16x32_bf16 v[204:207], v[216:219], v[128:131], v[204:207]
  v_accvgpr_write_b32 a137, v251
  s_waitcnt lgkmcnt(0)
  v_mfma_f32_16x16x32_bf16 v[196:199], v[220:223], v[132:135], v[196:199]
  v_cvt_pk_bf16_f32 v172, v192, v193
  v_cvt_pk_bf16_f32 v173, v194, v195
  v_mfma_f32_16x16x32_bf16 v[200:203], v[220:223], v[136:139], v[200:203]
  s_add_u32 m0, s81, 11264
  s_nop 0
  buffer_load_dwordx4 v59, s[12:15], s80 offen lds
  s_add_u32 s80, s80, 393216
  v_mfma_f32_16x16x32_bf16 v[204:207], v[220:223], v[140:143], v[204:207]
  s_add_u32 s21, s79, 1572864
  buffer_load_dwordx4 v[224:227], v63, s[24:27], s21 offen
  s_add_u32 s21, s79, 1572864
  buffer_load_dwordx4 v[228:231], v64, s[24:27], s21 offen
  s_add_u32 s21, s79, 1572864
  buffer_load_dwordx4 v[232:235], v65, s[24:27], s21 offen
  s_waitcnt vmcnt(18)
  ds_read_b128 v[208:211], v70 offset:24576
  ds_read_b128 v[212:215], v71 offset:24576
  ds_read_b128 v[216:219], v70 offset:24704
  s_waitcnt lgkmcnt(2)
  v_mfma_f32_16x16x32_bf16 v[184:187], v[208:211], v[72:75], 0
  ds_read_b128 v[220:223], v71 offset:24704
  v_mfma_f32_16x16x32_bf16 v[188:191], v[208:211], v[76:79], 0
  s_add_u32 m0, s81, 12288
  s_nop 0
  buffer_load_dwordx4 v48, s[12:15], s80 offen lds
  v_mfma_f32_16x16x32_bf16 v[192:195], v[208:211], v[80:83], 0
  s_waitcnt lgkmcnt(2)
  v_mfma_f32_16x16x32_bf16 v[184:187], v[212:215], v[84:87], v[184:187]
  ds_read_b128 v[208:211], v70 offset:24832
  v_cvt_pk_bf16_f32 v248, v196, v197
  v_mfma_f32_16x16x32_bf16 v[188:191], v[212:215], v[88:91], v[188:191]
  s_add_u32 m0, s81, 13312
  s_nop 0
  buffer_load_dwordx4 v49, s[12:15], s80 offen lds
  v_mfma_f32_16x16x32_bf16 v[192:195], v[212:215], v[92:95], v[192:195]
  v_cvt_pk_bf16_f32 v249, v198, v199
  s_waitcnt lgkmcnt(2)
  v_mfma_f32_16x16x32_bf16 v[184:187], v[216:219], v[96:99], v[184:187]
  ds_read_b128 v[212:215], v71 offset:24832
  v_cvt_pk_bf16_f32 v250, v200, v201
  v_mfma_f32_16x16x32_bf16 v[188:191], v[216:219], v[100:103], v[188:191]
  s_add_u32 m0, s81, 14336
  s_nop 0
  buffer_load_dwordx4 v50, s[12:15], s80 offen lds
  v_mfma_f32_16x16x32_bf16 v[192:195], v[216:219], v[104:107], v[192:195]
  v_cvt_pk_bf16_f32 v251, v202, v203
  s_waitcnt lgkmcnt(2)
  v_mfma_f32_16x16x32_bf16 v[184:187], v[220:223], v[108:111], v[184:187]
  ds_read_b128 v[216:219], v70 offset:25344
  v_accvgpr_write_b32 a58, v248
  v_mfma_f32_16x16x32_bf16 v[188:191], v[220:223], v[112:115], v[188:191]
  s_add_u32 m0, s81, 15360
  s_nop 0
  buffer_load_dwordx4 v51, s[12:15], s80 offen lds
  v_mfma_f32_16x16x32_bf16 v[192:195], v[220:223], v[116:119], v[192:195]
  v_accvgpr_write_b32 a59, v249
  s_waitcnt lgkmcnt(2)
  v_mfma_f32_16x16x32_bf16 v[184:187], v[208:211], v[120:123], v[184:187]
  ds_read_b128 v[220:223], v71 offset:25344
  v_accvgpr_write_b32 a138, v250
  v_mfma_f32_16x16x32_bf16 v[188:191], v[208:211], v[124:127], v[188:191]
  s_add_u32 m0, s81, 16384
  s_nop 0
  buffer_load_dwordx4 v52, s[12:15], s80 offen lds
  v_mfma_f32_16x16x32_bf16 v[192:195], v[208:211], v[128:131], v[192:195]
  v_accvgpr_write_b32 a139, v251
  s_waitcnt lgkmcnt(2)
  v_mfma_f32_16x16x32_bf16 v[184:187], v[212:215], v[132:135], v[184:187]
  ds_read_b128 v[208:211], v70 offset:25472
  s_mov_b64 exec, s[68:69]
  v_cvt_pk_bf16_f32 v172, v204, v205
  v_cvt_pk_bf16_f32 v173, v206, v207
  s_mov_b64 exec, -1
  v_mfma_f32_16x16x32_bf16 v[188:191], v[212:215], v[136:139], v[188:191]
  s_add_u32 m0, s81, 17408
  s_nop 0
  buffer_load_dwordx4 v53, s[12:15], s80 offen lds
  v_mfma_f32_16x16x32_bf16 v[192:195], v[212:215], v[140:143], v[192:195]
  s_waitcnt lgkmcnt(2)
  v_mfma_f32_16x16x32_bf16 v[196:199], v[216:219], v[72:75], 0
  ds_read_b128 v[212:215], v71 offset:25472
  v_mfma_f32_16x16x32_bf16 v[200:203], v[216:219], v[76:79], 0
  s_add_u32 m0, s81, 18432
  s_nop 0
  buffer_load_dwordx4 v54, s[12:15], s80 offen lds
  v_mfma_f32_16x16x32_bf16 v[204:207], v[216:219], v[80:83], 0
  s_waitcnt lgkmcnt(2)
  v_mfma_f32_16x16x32_bf16 v[196:199], v[220:223], v[84:87], v[196:199]
  ds_read_b128 v[216:219], v70 offset:25600
  v_cvt_pk_bf16_f32 v248, v184, v185
  v_mfma_f32_16x16x32_bf16 v[200:203], v[220:223], v[88:91], v[200:203]
  s_add_u32 m0, s81, 19456
  s_nop 0
  buffer_load_dwordx4 v55, s[12:15], s80 offen lds
  v_mfma_f32_16x16x32_bf16 v[204:207], v[220:223], v[92:95], v[204:207]
  v_cvt_pk_bf16_f32 v249, v186, v187
  s_waitcnt lgkmcnt(2)
  v_mfma_f32_16x16x32_bf16 v[196:199], v[208:211], v[96:99], v[196:199]
  ds_read_b128 v[220:223], v71 offset:25600
  v_cvt_pk_bf16_f32 v250, v188, v189
  v_mfma_f32_16x16x32_bf16 v[200:203], v[208:211], v[100:103], v[200:203]
  s_add_u32 m0, s81, 20480
  s_nop 0
  buffer_load_dwordx4 v56, s[12:15], s80 offen lds
  v_mfma_f32_16x16x32_bf16 v[204:207], v[208:211], v[104:107], v[204:207]
  v_cvt_pk_bf16_f32 v251, v190, v191
  s_waitcnt lgkmcnt(2)
  v_mfma_f32_16x16x32_bf16 v[196:199], v[212:215], v[108:111], v[196:199]
  v_accvgpr_write_b32 a60, v248
  v_mfma_f32_16x16x32_bf16 v[200:203], v[212:215], v[112:115], v[200:203]
  s_add_u32 m0, s81, 21504
  s_nop 0
  buffer_load_dwordx4 v57, s[12:15], s80 offen lds
  v_mfma_f32_16x16x32_bf16 v[204:207], v[212:215], v[116:119], v[204:207]
  v_accvgpr_write_b32 a61, v249
  s_waitcnt lgkmcnt(1)
  v_mfma_f32_16x16x32_bf16 v[196:199], v[216:219], v[120:123], v[196:199]
  v_accvgpr_write_b32 a140, v250
  v_mfma_f32_16x16x32_bf16 v[200:203], v[216:219], v[124:127], v[200:203]
  s_add_u32 m0, s81, 22528
  s_nop 0
  buffer_load_dwordx4 v58, s[12:15], s80 offen lds
  v_mfma_f32_16x16x32_bf16 v[204:207], v[216:219], v[128:131], v[204:207]
  v_accvgpr_write_b32 a141, v251
  s_waitcnt lgkmcnt(0)
  v_mfma_f32_16x16x32_bf16 v[196:199], v[220:223], v[132:135], v[196:199]
  v_cvt_pk_bf16_f32 v174, v192, v193
  v_cvt_pk_bf16_f32 v175, v194, v195
  v_mfma_f32_16x16x32_bf16 v[200:203], v[220:223], v[136:139], v[200:203]
  s_add_u32 m0, s81, 23552
  s_nop 0
  buffer_load_dwordx4 v59, s[12:15], s80 offen lds
  s_add_u32 s80, s80, 393216
  v_mfma_f32_16x16x32_bf16 v[204:207], v[220:223], v[140:143], v[204:207]
  s_waitcnt vmcnt(15)
  s_and_b32 s21, s50, 1
  s_lshl_b32 s21, s21, 4
  s_add_u32 s21, s21, s51
  s_lshl_b32 s22, s21, 10
  s_add_u32 s22, s22, s77
  s_add_u32 s23, s77, 30720
  s_cmp_lt_u32 s21, 10
  s_cselect_b32 s23, 0, s23
  s_add_u32 s22, s22, s23
  s_mul_i32 s23, s20, 122880
  s_add_u32 s22, s22, s23
  buffer_load_dwordx4 v[252:255], v4, s[8:11], s22 offen sc1
  ds_read_b128 v[208:211], v70 offset:0
  ds_read_b128 v[212:215], v71 offset:0
  ds_read_b128 v[216:219], v70 offset:128
  s_waitcnt lgkmcnt(2)
  v_mfma_f32_16x16x32_bf16 v[184:187], v[208:211], v[72:75], 0
  ds_read_b128 v[220:223], v71 offset:128
  v_mfma_f32_16x16x32_bf16 v[188:191], v[208:211], v[76:79], 0
  s_add_u32 m0, s81, 24576
  s_nop 0
  buffer_load_dwordx4 v48, s[12:15], s80 offen lds
  v_mfma_f32_16x16x32_bf16 v[192:195], v[208:211], v[80:83], 0
  s_waitcnt lgkmcnt(2)
  v_mfma_f32_16x16x32_bf16 v[184:187], v[212:215], v[84:87], v[184:187]
  ds_read_b128 v[208:211], v70 offset:256
  v_cvt_pk_bf16_f32 v248, v196, v197
  v_mfma_f32_16x16x32_bf16 v[188:191], v[212:215], v[88:91], v[188:191]
  s_add_u32 m0, s81, 25600
  s_nop 0
  buffer_load_dwordx4 v49, s[12:15], s80 offen lds
  v_mfma_f32_16x16x32_bf16 v[192:195], v[212:215], v[92:95], v[192:195]
  v_cvt_pk_bf16_f32 v249, v198, v199
  s_waitcnt lgkmcnt(2)
  v_mfma_f32_16x16x32_bf16 v[184:187], v[216:219], v[96:99], v[184:187]
  ds_read_b128 v[212:215], v71 offset:256
  v_cvt_pk_bf16_f32 v250, v200, v201
  v_mfma_f32_16x16x32_bf16 v[188:191], v[216:219], v[100:103], v[188:191]
  s_add_u32 m0, s81, 26624
  s_nop 0
  buffer_load_dwordx4 v50, s[12:15], s80 offen lds
  v_mfma_f32_16x16x32_bf16 v[192:195], v[216:219], v[104:107], v[192:195]
  v_cvt_pk_bf16_f32 v251, v202, v203
  s_waitcnt lgkmcnt(2)
  v_mfma_f32_16x16x32_bf16 v[184:187], v[220:223], v[108:111], v[184:187]
  ds_read_b128 v[216:219], v70 offset:768
  v_accvgpr_write_b32 a62, v248
  v_mfma_f32_16x16x32_bf16 v[188:191], v[220:223], v[112:115], v[188:191]
  s_add_u32 m0, s81, 27648
  s_nop 0
  buffer_load_dwordx4 v51, s[12:15], s80 offen lds
  v_mfma_f32_16x16x32_bf16 v[192:195], v[220:223], v[116:119], v[192:195]
  v_accvgpr_write_b32 a63, v249
  s_waitcnt lgkmcnt(2)
  v_mfma_f32_16x16x32_bf16 v[184:187], v[208:211], v[120:123], v[184:187]
  ds_read_b128 v[220:223], v71 offset:768
  v_accvgpr_write_b32 a142, v250
  v_mfma_f32_16x16x32_bf16 v[188:191], v[208:211], v[124:127], v[188:191]
  s_add_u32 m0, s81, 28672
  s_nop 0
  buffer_load_dwordx4 v52, s[12:15], s80 offen lds
  v_mfma_f32_16x16x32_bf16 v[192:195], v[208:211], v[128:131], v[192:195]
  v_accvgpr_write_b32 a143, v251
  s_waitcnt lgkmcnt(2)
  v_mfma_f32_16x16x32_bf16 v[184:187], v[212:215], v[132:135], v[184:187]
  ds_read_b128 v[208:211], v70 offset:896
  s_mov_b64 exec, s[68:69]
  v_cvt_pk_bf16_f32 v174, v204, v205
  v_cvt_pk_bf16_f32 v175, v206, v207
  s_mov_b64 exec, -1
  v_mfma_f32_16x16x32_bf16 v[188:191], v[212:215], v[136:139], v[188:191]
  s_add_u32 m0, s81, 29696
  s_nop 0
  buffer_load_dwordx4 v53, s[12:15], s80 offen lds
  v_mfma_f32_16x16x32_bf16 v[192:195], v[212:215], v[140:143], v[192:195]
  s_waitcnt lgkmcnt(2)
  v_mfma_f32_16x16x32_bf16 v[196:199], v[216:219], v[72:75], 0
  ds_read_b128 v[212:215], v71 offset:896
  v_mfma_f32_16x16x32_bf16 v[200:203], v[216:219], v[76:79], 0
  s_add_u32 m0, s81, 30720
  s_nop 0
  buffer_load_dwordx4 v54, s[12:15], s80 offen lds
  v_mfma_f32_16x16x32_bf16 v[204:207], v[216:219], v[80:83], 0
  s_waitcnt lgkmcnt(2)
  v_mfma_f32_16x16x32_bf16 v[196:199], v[220:223], v[84:87], v[196:199]
  ds_read_b128 v[216:219], v70 offset:1024
  v_cvt_pk_bf16_f32 v248, v184, v185
  v_mfma_f32_16x16x32_bf16 v[200:203], v[220:223], v[88:91], v[200:203]
  s_add_u32 m0, s81, 31744
  s_nop 0
  buffer_load_dwordx4 v55, s[12:15], s80 offen lds
  v_mfma_f32_16x16x32_bf16 v[204:207], v[220:223], v[92:95], v[204:207]
  v_cvt_pk_bf16_f32 v249, v186, v187
  s_waitcnt lgkmcnt(2)
  v_mfma_f32_16x16x32_bf16 v[196:199], v[208:211], v[96:99], v[196:199]
  ds_read_b128 v[220:223], v71 offset:1024
  v_cvt_pk_bf16_f32 v250, v188, v189
  v_mfma_f32_16x16x32_bf16 v[200:203], v[208:211], v[100:103], v[200:203]
  s_add_u32 m0, s81, 32768
  s_nop 0
  buffer_load_dwordx4 v56, s[12:15], s80 offen lds
  v_mfma_f32_16x16x32_bf16 v[204:207], v[208:211], v[104:107], v[204:207]
  v_cvt_pk_bf16_f32 v251, v190, v191
  s_waitcnt lgkmcnt(2)
  v_mfma_f32_16x16x32_bf16 v[196:199], v[212:215], v[108:111], v[196:199]
  v_accvgpr_write_b32 a64, v248
  v_mfma_f32_16x16x32_bf16 v[200:203], v[212:215], v[112:115], v[200:203]
  s_add_u32 m0, s81, 33792
  s_nop 0
  buffer_load_dwordx4 v57, s[12:15], s80 offen lds
  v_mfma_f32_16x16x32_bf16 v[204:207], v[212:215], v[116:119], v[204:207]
  v_accvgpr_write_b32 a65, v249
  s_waitcnt lgkmcnt(1)
  v_mfma_f32_16x16x32_bf16 v[196:199], v[216:219], v[120:123], v[196:199]
  v_accvgpr_write_b32 a144, v250
  v_mfma_f32_16x16x32_bf16 v[200:203], v[216:219], v[124:127], v[200:203]
  s_add_u32 m0, s81, 34816
  s_nop 0
  buffer_load_dwordx4 v58, s[12:15], s80 offen lds
  v_mfma_f32_16x16x32_bf16 v[204:207], v[216:219], v[128:131], v[204:207]
  v_accvgpr_write_b32 a145, v251
  s_waitcnt lgkmcnt(0)
  v_mfma_f32_16x16x32_bf16 v[196:199], v[220:223], v[132:135], v[196:199]
  v_cvt_pk_bf16_f32 v176, v192, v193
  v_cvt_pk_bf16_f32 v177, v194, v195
  v_mfma_f32_16x16x32_bf16 v[200:203], v[220:223], v[136:139], v[200:203]
  s_add_u32 m0, s81, 35840
  s_nop 0
  buffer_load_dwordx4 v59, s[12:15], s80 offen lds
  s_add_u32 s80, s80, 393216
  v_mfma_f32_16x16x32_bf16 v[204:207], v[220:223], v[140:143], v[204:207]
  s_waitcnt vmcnt(13)
  ds_read_b128 v[208:211], v70 offset:12288
  ds_read_b128 v[212:215], v71 offset:12288
  ds_read_b128 v[216:219], v70 offset:12416
  s_waitcnt lgkmcnt(2)
  v_mfma_f32_16x16x32_bf16 v[184:187], v[208:211], v[72:75], 0
  ds_read_b128 v[220:223], v71 offset:12416
  v_mfma_f32_16x16x32_bf16 v[188:191], v[208:211], v[76:79], 0
  s_add_u32 m0, s81, 0
  s_nop 0
  buffer_load_dwordx4 v48, s[12:15], s80 offen lds
  v_mfma_f32_16x16x32_bf16 v[192:195], v[208:211], v[80:83], 0
  s_waitcnt lgkmcnt(2)
  v_mfma_f32_16x16x32_bf16 v[184:187], v[212:215], v[84:87], v[184:187]
  ds_read_b128 v[208:211], v70 offset:12544
  v_cvt_pk_bf16_f32 v248, v196, v197
  v_mfma_f32_16x16x32_bf16 v[188:191], v[212:215], v[88:91], v[188:191]
  s_add_u32 m0, s81, 1024
  s_nop 0
  buffer_load_dwordx4 v49, s[12:15], s80 offen lds
  v_mfma_f32_16x16x32_bf16 v[192:195], v[212:215], v[92:95], v[192:195]
  v_cvt_pk_bf16_f32 v249, v198, v199
  s_waitcnt lgkmcnt(2)
  v_mfma_f32_16x16x32_bf16 v[184:187], v[216:219], v[96:99], v[184:187]
  ds_read_b128 v[212:215], v71 offset:12544
  v_cvt_pk_bf16_f32 v250, v200, v201
  v_mfma_f32_16x16x32_bf16 v[188:191], v[216:219], v[100:103], v[188:191]
  s_add_u32 m0, s81, 2048
  s_nop 0
  buffer_load_dwordx4 v50, s[12:15], s80 offen lds
  v_mfma_f32_16x16x32_bf16 v[192:195], v[216:219], v[104:107], v[192:195]
  v_cvt_pk_bf16_f32 v251, v202, v203
  s_waitcnt lgkmcnt(2)
  v_mfma_f32_16x16x32_bf16 v[184:187], v[220:223], v[108:111], v[184:187]
  ds_read_b128 v[216:219], v70 offset:13056
  v_accvgpr_write_b32 a66, v248
  v_mfma_f32_16x16x32_bf16 v[188:191], v[220:223], v[112:115], v[188:191]
  s_add_u32 m0, s81, 3072
  s_nop 0
  buffer_load_dwordx4 v51, s[12:15], s80 offen lds
  v_mfma_f32_16x16x32_bf16 v[192:195], v[220:223], v[116:119], v[192:195]
  v_accvgpr_write_b32 a67, v249
  s_waitcnt lgkmcnt(2)
  v_mfma_f32_16x16x32_bf16 v[184:187], v[208:211], v[120:123], v[184:187]
  ds_read_b128 v[220:223], v71 offset:13056
  v_accvgpr_write_b32 a146, v250
  v_mfma_f32_16x16x32_bf16 v[188:191], v[208:211], v[124:127], v[188:191]
  s_add_u32 m0, s81, 4096
  s_nop 0
  buffer_load_dwordx4 v52, s[12:15], s80 offen lds
  v_mfma_f32_16x16x32_bf16 v[192:195], v[208:211], v[128:131], v[192:195]
  v_accvgpr_write_b32 a147, v251
  s_waitcnt lgkmcnt(2)
  v_mfma_f32_16x16x32_bf16 v[184:187], v[212:215], v[132:135], v[184:187]
  ds_read_b128 v[208:211], v70 offset:13184
  s_mov_b64 exec, s[68:69]
  v_cvt_pk_bf16_f32 v176, v204, v205
  v_cvt_pk_bf16_f32 v177, v206, v207
  s_mov_b64 exec, -1
  v_mfma_f32_16x16x32_bf16 v[188:191], v[212:215], v[136:139], v[188:191]
  s_add_u32 m0, s81, 5120
  s_nop 0
  buffer_load_dwordx4 v53, s[12:15], s80 offen lds
  v_mfma_f32_16x16x32_bf16 v[192:195], v[212:215], v[140:143], v[192:195]
  s_waitcnt lgkmcnt(2)
  v_mfma_f32_16x16x32_bf16 v[196:199], v[216:219], v[72:75], 0
  ds_read_b128 v[212:215], v71 offset:13184
  v_mfma_f32_16x16x32_bf16 v[200:203], v[216:219], v[76:79], 0
  s_add_u32 m0, s81, 6144
  s_nop 0
  buffer_load_dwordx4 v54, s[12:15], s80 offen lds
  v_mfma_f32_16x16x32_bf16 v[204:207], v[216:219], v[80:83], 0
  s_waitcnt lgkmcnt(2)
  v_mfma_f32_16x16x32_bf16 v[196:199], v[220:223], v[84:87], v[196:199]
  ds_read_b128 v[216:219], v70 offset:13312
  v_cvt_pk_bf16_f32 v248, v184, v185
  v_mfma_f32_16x16x32_bf16 v[200:203], v[220:223], v[88:91], v[200:203]
  s_add_u32 m0, s81, 7168
  s_nop 0
  buffer_load_dwordx4 v55, s[12:15], s80 offen lds
  v_mfma_f32_16x16x32_bf16 v[204:207], v[220:223], v[92:95], v[204:207]
  v_cvt_pk_bf16_f32 v249, v186, v187
  s_waitcnt lgkmcnt(2)
  v_mfma_f32_16x16x32_bf16 v[196:199], v[208:211], v[96:99], v[196:199]
  ds_read_b128 v[220:223], v71 offset:13312
  v_cvt_pk_bf16_f32 v250, v188, v189
  v_mfma_f32_16x16x32_bf16 v[200:203], v[208:211], v[100:103], v[200:203]
  s_add_u32 m0, s81, 8192
  s_nop 0
  buffer_load_dwordx4 v56, s[12:15], s80 offen lds
  v_mfma_f32_16x16x32_bf16 v[204:207], v[208:211], v[104:107], v[204:207]
  v_cvt_pk_bf16_f32 v251, v190, v191
  s_waitcnt lgkmcnt(2)
  v_mfma_f32_16x16x32_bf16 v[196:199], v[212:215], v[108:111], v[196:199]
  v_accvgpr_write_b32 a68, v248
  v_mfma_f32_16x16x32_bf16 v[200:203], v[212:215], v[112:115], v[200:203]
  s_add_u32 m0, s81, 9216
  s_nop 0
  buffer_load_dwordx4 v57, s[12:15], s80 offen lds
  v_mfma_f32_16x16x32_bf16 v[204:207], v[212:215], v[116:119], v[204:207]
  v_accvgpr_write_b32 a69, v249
  s_waitcnt lgkmcnt(1)
  v_mfma_f32_16x16x32_bf16 v[196:199], v[216:219], v[120:123], v[196:199]
  v_accvgpr_write_b32 a148, v250
  v_mfma_f32_16x16x32_bf16 v[200:203], v[216:219], v[124:127], v[200:203]
  s_add_u32 m0, s81, 10240
  s_nop 0
  buffer_load_dwordx4 v58, s[12:15], s80 offen lds
  v_mfma_f32_16x16x32_bf16 v[204:207], v[216:219], v[128:131], v[204:207]
  v_accvgpr_write_b32 a149, v251
  s_waitcnt lgkmcnt(0)
  v_mfma_f32_16x16x32_bf16 v[196:199], v[220:223], v[132:135], v[196:199]
  v_cvt_pk_bf16_f32 v178, v192, v193
  v_cvt_pk_bf16_f32 v179, v194, v195
  v_mfma_f32_16x16x32_bf16 v[200:203], v[220:223], v[136:139], v[200:203]
  s_add_u32 m0, s81, 11264
  s_nop 0
  buffer_load_dwordx4 v59, s[12:15], s80 offen lds
  s_add_u32 s80, s80, 393216
  v_mfma_f32_16x16x32_bf16 v[204:207], v[220:223], v[140:143], v[204:207]
  s_waitcnt vmcnt(12)
  v_readlane_b32 s83, v66, 19
  s_sub_u32 s21, s83, 1
  s_lshl_b32 s21, s21, 13
  s_and_b32 s21, s21, 8192
  s_xor_b32 s76, s90, s21
  buffer_load_dword v66, v67, s[32:35], 0 offen sc1
  buffer_load_dword v42, v41, s[16:19], s76 offen sc1
  ds_read_b128 v[208:211], v70 offset:24576
  ds_read_b128 v[212:215], v71 offset:24576
  ds_read_b128 v[216:219], v70 offset:24704
  s_waitcnt lgkmcnt(2)
  v_mfma_f32_16x16x32_bf16 v[184:187], v[208:211], v[72:75], 0
  ds_read_b128 v[220:223], v71 offset:24704
  v_mfma_f32_16x16x32_bf16 v[188:191], v[208:211], v[76:79], 0
  ds_write_b128 v68, a[160:163] offset:12288
  v_mfma_f32_16x16x32_bf16 v[192:195], v[208:211], v[80:83], 0
  s_waitcnt lgkmcnt(3)
  v_mfma_f32_16x16x32_bf16 v[184:187], v[212:215], v[84:87], v[184:187]
  ds_read_b128 v[208:211], v70 offset:24832
  v_cvt_pk_bf16_f32 v248, v196, v197
  v_mfma_f32_16x16x32_bf16 v[188:191], v[212:215], v[88:91], v[188:191]
  ds_write_b128 v68, a[164:167] offset:13312
  v_mfma_f32_16x16x32_bf16 v[192:195], v[212:215], v[92:95], v[192:195]
  v_cvt_pk_bf16_f32 v249, v198, v199
  s_waitcnt lgkmcnt(4)
  v_mfma_f32_16x16x32_bf16 v[184:187], v[216:219], v[96:99], v[184:187]
  ds_read_b128 v[212:215], v71 offset:24832
  v_cvt_pk_bf16_f32 v250, v200, v201
  v_mfma_f32_16x16x32_bf16 v[188:191], v[216:219], v[100:103], v[188:191]
  ds_write_b128 v68, a[168:171] offset:14336
  v_mfma_f32_16x16x32_bf16 v[192:195], v[216:219], v[104:107], v[192:195]
  v_cvt_pk_bf16_f32 v251, v202, v203
  s_waitcnt lgkmcnt(5)
  v_mfma_f32_16x16x32_bf16 v[184:187], v[220:223], v[108:111], v[184:187]
  ds_read_b128 v[216:219], v70 offset:25344
  v_accvgpr_write_b32 a70, v248
  v_mfma_f32_16x16x32_bf16 v[188:191], v[220:223], v[112:115], v[188:191]
  ds_write_b128 v68, a[172:175] offset:15360
  v_mfma_f32_16x16x32_bf16 v[192:195], v[220:223], v[116:119], v[192:195]
  v_accvgpr_write_b32 a71, v249
  s_waitcnt lgkmcnt(5)
  v_mfma_f32_16x16x32_bf16 v[184:187], v[208:211], v[120:123], v[184:187]
  ds_read_b128 v[220:223], v71 offset:25344
  v_accvgpr_write_b32 a150, v250
  v_mfma_f32_16x16x32_bf16 v[188:191], v[208:211], v[124:127], v[188:191]
  ds_write_b128 v68, a[176:179] offset:16384
  v_mfma_f32_16x16x32_bf16 v[192:195], v[208:211], v[128:131], v[192:195]
  v_accvgpr_write_b32 a151, v251
  s_waitcnt lgkmcnt(5)
  v_mfma_f32_16x16x32_bf16 v[184:187], v[212:215], v[132:135], v[184:187]
  ds_read_b128 v[208:211], v70 offset:25472
  s_mov_b64 exec, s[68:69]
  v_cvt_pk_bf16_f32 v178, v204, v205
  v_cvt_pk_bf16_f32 v179, v206, v207
  s_mov_b64 exec, -1
  v_mfma_f32_16x16x32_bf16 v[188:191], v[212:215], v[136:139], v[188:191]
  ds_write_b128 v68, a[180:183] offset:17408
  v_mfma_f32_16x16x32_bf16 v[192:195], v[212:215], v[140:143], v[192:195]
  s_waitcnt lgkmcnt(5)
  v_mfma_f32_16x16x32_bf16 v[196:199], v[216:219], v[72:75], 0
  ds_read_b128 v[212:215], v71 offset:25472
  v_mfma_f32_16x16x32_bf16 v[200:203], v[216:219], v[76:79], 0
  ds_write_b128 v68, a[184:187] offset:18432
  v_mfma_f32_16x16x32_bf16 v[204:207], v[216:219], v[80:83], 0
  s_waitcnt lgkmcnt(5)
  v_mfma_f32_16x16x32_bf16 v[196:199], v[220:223], v[84:87], v[196:199]
  ds_read_b128 v[216:219], v70 offset:25600
  v_cvt_pk_bf16_f32 v248, v184, v185
  v_mfma_f32_16x16x32_bf16 v[200:203], v[220:223], v[88:91], v[200:203]
  ds_write_b128 v68, a[188:191] offset:19456
  v_mfma_f32_16x16x32_bf16 v[204:207], v[220:223], v[92:95], v[204:207]
  v_cvt_pk_bf16_f32 v249, v186, v187
  s_waitcnt lgkmcnt(5)
  v_mfma_f32_16x16x32_bf16 v[196:199], v[208:211], v[96:99], v[196:199]
  ds_read_b128 v[220:223], v71 offset:25600
  v_cvt_pk_bf16_f32 v250, v188, v189
  v_mfma_f32_16x16x32_bf16 v[200:203], v[208:211], v[100:103], v[200:203]
  ds_write_b128 v68, a[192:195] offset:20480
  v_mfma_f32_16x16x32_bf16 v[204:207], v[208:211], v[104:107], v[204:207]
  v_cvt_pk_bf16_f32 v251, v190, v191
  s_waitcnt lgkmcnt(5)
  v_mfma_f32_16x16x32_bf16 v[196:199], v[212:215], v[108:111], v[196:199]
  v_accvgpr_write_b32 a72, v248
  v_mfma_f32_16x16x32_bf16 v[200:203], v[212:215], v[112:115], v[200:203]
  ds_write_b128 v68, a[196:199] offset:21504
  v_mfma_f32_16x16x32_bf16 v[204:207], v[212:215], v[116:119], v[204:207]
  v_accvgpr_write_b32 a73, v249
  s_waitcnt lgkmcnt(4)
  v_mfma_f32_16x16x32_bf16 v[196:199], v[216:219], v[120:123], v[196:199]
  v_accvgpr_write_b32 a152, v250
  v_mfma_f32_16x16x32_bf16 v[200:203], v[216:219], v[124:127], v[200:203]
  ds_write_b128 v68, a[200:203] offset:22528
  v_mfma_f32_16x16x32_bf16 v[204:207], v[216:219], v[128:131], v[204:207]
  v_accvgpr_write_b32 a153, v251
  s_waitcnt lgkmcnt(3)
  v_mfma_f32_16x16x32_bf16 v[196:199], v[220:223], v[132:135], v[196:199]
  v_cvt_pk_bf16_f32 v180, v192, v193
  v_cvt_pk_bf16_f32 v181, v194, v195
  v_mfma_f32_16x16x32_bf16 v[200:203], v[220:223], v[136:139], v[200:203]
  ds_write_b128 v68, a[204:207] offset:23552
  v_mfma_f32_16x16x32_bf16 v[204:207], v[220:223], v[140:143], v[204:207]
  s_waitcnt vmcnt(2)
  ds_read_b128 v[208:211], v70 offset:0
  ds_read_b128 v[212:215], v71 offset:0
  ds_read_b128 v[216:219], v70 offset:128
  s_waitcnt lgkmcnt(2)
  v_mfma_f32_16x16x32_bf16 v[184:187], v[208:211], v[72:75], 0
  ds_read_b128 v[220:223], v71 offset:128
  v_mfma_f32_16x16x32_bf16 v[188:191], v[208:211], v[76:79], 0
  ds_write_b128 v68, a[208:211] offset:24576
  v_mfma_f32_16x16x32_bf16 v[192:195], v[208:211], v[80:83], 0
  s_waitcnt lgkmcnt(3)
  v_mfma_f32_16x16x32_bf16 v[184:187], v[212:215], v[84:87], v[184:187]
  ds_read_b128 v[208:211], v70 offset:256
  v_cvt_pk_bf16_f32 v248, v196, v197
  v_mfma_f32_16x16x32_bf16 v[188:191], v[212:215], v[88:91], v[188:191]
  ds_write_b128 v68, a[212:215] offset:25600
  v_mfma_f32_16x16x32_bf16 v[192:195], v[212:215], v[92:95], v[192:195]
  v_cvt_pk_bf16_f32 v249, v198, v199
  s_waitcnt lgkmcnt(4)
  v_mfma_f32_16x16x32_bf16 v[184:187], v[216:219], v[96:99], v[184:187]
  ds_read_b128 v[212:215], v71 offset:256
  v_cvt_pk_bf16_f32 v250, v200, v201
  v_mfma_f32_16x16x32_bf16 v[188:191], v[216:219], v[100:103], v[188:191]
  ds_write_b128 v68, a[216:219] offset:26624
  v_mfma_f32_16x16x32_bf16 v[192:195], v[216:219], v[104:107], v[192:195]
  v_cvt_pk_bf16_f32 v251, v202, v203
  s_waitcnt lgkmcnt(5)
  v_mfma_f32_16x16x32_bf16 v[184:187], v[220:223], v[108:111], v[184:187]
  ds_read_b128 v[216:219], v70 offset:768
  v_accvgpr_write_b32 a74, v248
  v_mfma_f32_16x16x32_bf16 v[188:191], v[220:223], v[112:115], v[188:191]
  ds_write_b128 v68, a[220:223] offset:27648
  v_mfma_f32_16x16x32_bf16 v[192:195], v[220:223], v[116:119], v[192:195]
  v_accvgpr_write_b32 a75, v249
  s_waitcnt lgkmcnt(5)
  v_mfma_f32_16x16x32_bf16 v[184:187], v[208:211], v[120:123], v[184:187]
  ds_read_b128 v[220:223], v71 offset:768
  v_accvgpr_write_b32 a154, v250
  v_mfma_f32_16x16x32_bf16 v[188:191], v[208:211], v[124:127], v[188:191]
  ds_write_b128 v68, a[224:227] offset:28672
  v_mfma_f32_16x16x32_bf16 v[192:195], v[208:211], v[128:131], v[192:195]
  v_accvgpr_write_b32 a155, v251
  s_waitcnt lgkmcnt(5)
  v_mfma_f32_16x16x32_bf16 v[184:187], v[212:215], v[132:135], v[184:187]
  ds_read_b128 v[208:211], v70 offset:896
  s_mov_b64 exec, s[68:69]
  v_cvt_pk_bf16_f32 v180, v204, v205
  v_cvt_pk_bf16_f32 v181, v206, v207
  s_mov_b64 exec, -1
  v_mfma_f32_16x16x32_bf16 v[188:191], v[212:215], v[136:139], v[188:191]
  ds_write_b128 v68, a[228:231] offset:29696
  v_mfma_f32_16x16x32_bf16 v[192:195], v[212:215], v[140:143], v[192:195]
  s_waitcnt lgkmcnt(5)
  v_mfma_f32_16x16x32_bf16 v[196:199], v[216:219], v[72:75], 0
  ds_read_b128 v[212:215], v71 offset:896
  v_mfma_f32_16x16x32_bf16 v[200:203], v[216:219], v[76:79], 0
  ds_write_b128 v68, a[232:235] offset:30720
  v_mfma_f32_16x16x32_bf16 v[204:207], v[216:219], v[80:83], 0
  s_waitcnt lgkmcnt(5)
  v_mfma_f32_16x16x32_bf16 v[196:199], v[220:223], v[84:87], v[196:199]
  ds_read_b128 v[216:219], v70 offset:1024
  v_cvt_pk_bf16_f32 v248, v184, v185
  v_mfma_f32_16x16x32_bf16 v[200:203], v[220:223], v[88:91], v[200:203]
  ds_write_b128 v68, a[236:239] offset:31744
  v_mfma_f32_16x16x32_bf16 v[204:207], v[220:223], v[92:95], v[204:207]
  v_cvt_pk_bf16_f32 v249, v186, v187
  s_waitcnt lgkmcnt(5)
  v_mfma_f32_16x16x32_bf16 v[196:199], v[208:211], v[96:99], v[196:199]
  ds_read_b128 v[220:223], v71 offset:1024
  v_cvt_pk_bf16_f32 v250, v188, v189
  v_mfma_f32_16x16x32_bf16 v[200:203], v[208:211], v[100:103], v[200:203]
  ds_write_b128 v68, a[240:243] offset:32768
  v_mfma_f32_16x16x32_bf16 v[204:207], v[208:211], v[104:107], v[204:207]
  v_cvt_pk_bf16_f32 v251, v190, v191
  s_waitcnt lgkmcnt(5)
  v_mfma_f32_16x16x32_bf16 v[196:199], v[212:215], v[108:111], v[196:199]
  v_accvgpr_write_b32 a76, v248
  v_mfma_f32_16x16x32_bf16 v[200:203], v[212:215], v[112:115], v[200:203]
  ds_write_b128 v68, a[244:247] offset:33792
  v_mfma_f32_16x16x32_bf16 v[204:207], v[212:215], v[116:119], v[204:207]
  v_accvgpr_write_b32 a77, v249
  s_waitcnt lgkmcnt(4)
  v_mfma_f32_16x16x32_bf16 v[196:199], v[216:219], v[120:123], v[196:199]
  v_accvgpr_write_b32 a156, v250
  v_mfma_f32_16x16x32_bf16 v[200:203], v[216:219], v[124:127], v[200:203]
  ds_write_b128 v68, a[248:251] offset:34816
  v_mfma_f32_16x16x32_bf16 v[204:207], v[216:219], v[128:131], v[204:207]
  v_accvgpr_write_b32 a157, v251
  s_waitcnt lgkmcnt(3)
  v_mfma_f32_16x16x32_bf16 v[196:199], v[220:223], v[132:135], v[196:199]
  v_cvt_pk_bf16_f32 v182, v192, v193
  v_cvt_pk_bf16_f32 v183, v194, v195
  v_mfma_f32_16x16x32_bf16 v[200:203], v[220:223], v[136:139], v[200:203]
  ds_write_b128 v68, a[252:255] offset:35840
  v_mfma_f32_16x16x32_bf16 v[204:207], v[220:223], v[140:143], v[204:207]
  s_nop 7
  v_cvt_pk_bf16_f32 v248, v196, v197
  v_cvt_pk_bf16_f32 v249, v198, v199
  v_cvt_pk_bf16_f32 v250, v200, v201
  v_cvt_pk_bf16_f32 v251, v202, v203
  v_accvgpr_write_b32 a78, v248
  v_accvgpr_write_b32 a79, v249
  v_accvgpr_write_b32 a158, v250
  v_accvgpr_write_b32 a159, v251
  s_mov_b64 exec, s[68:69]
  v_cvt_pk_bf16_f32 v182, v204, v205
  v_cvt_pk_bf16_f32 v183, v206, v207
  s_mov_b64 exec, -1
post_wvo:
  ds_write_b128 v68, v[224:227] offset:0
  ds_write_b128 v68, v[228:231] offset:1024
  ds_write_b128 v68, v[232:235] offset:2048
  ds_write_b128 v68, v[236:239] offset:3072
  ds_write_b128 v68, v[240:243] offset:4096
  ds_write_b128 v68, v[244:247] offset:5120
  ds_write_b64 v69, v[160:161] offset:6144
  ds_write_b64 v69, v[162:163] offset:6656
  ds_write_b64 v69, v[164:165] offset:7168
  ds_write_b64 v69, v[166:167] offset:7680
  ds_write_b64 v69, v[168:169] offset:8192
  ds_write_b64 v69, v[170:171] offset:8704
  ds_write_b64 v69, v[172:173] offset:9216
  ds_write_b64 v69, v[174:175] offset:9728
  ds_write_b64 v69, v[176:177] offset:10240
  ds_write_b64 v69, v[178:179] offset:10752
  ds_write_b64 v69, v[180:181] offset:11264
  ds_write_b64 v69, v[182:183] offset:11776
  v_lshrrev_b32 v100, 1, v3
  v_lshlrev_b32 v100, 4, v100
  v_and_b32 v101, 8, v2
  v_add_u32 v100, v100, v101
  v_and_b32 v101, 1, v3
  v_lshl_add_u32 v100, v101, 2, v100
  v_bfe_u32 v101, v2, 2, 1
  v_add_u32 v100, v100, v101
  v_mul_u32_u24 v100, 96, v100
  v_and_b32 v101, 3, v2
  v_lshl_add_u32 v100, v101, 3, v100
  s_lshl_b32 s21, s20, 5
  v_add_u32 v100, s21, v100
  v_add_u32 v101, 3072, v100
  v_cndmask_b32 v88, v100, v101, s[68:69]
  v_cndmask_b32 v92, v101, v100, s[68:69]
  v_add_u32 v89, 40960, v88
  v_add_u32 v93, 40960, v92
  v_add_u32 v90, 81920, v88
  v_add_u32 v94, 81920, v92
  v_add_u32 v91, 122880, v88
  v_add_u32 v95, 122880, v92
  v_and_b32 v100, 7, v2
  v_lshl_add_u32 v100, v3, 3, v100
  v_lshrrev_b32 v101, 3, v2
  v_mul_u32_u24 v101, 40960, v101
  v_lshl_add_u32 v96, v100, 4, v101
  v_add_u32 v97, 81920, v96
  s_bfe_u32 s82, s50, 0x10001
  s_lshl_b32 s82, s82, 5
  s_lshr_b32 s21, s50, 2
  s_add_u32 s82, s82, s21
  s_mov_b32 s101, 0
  s_branch fm_13
fm_12:
  s_sleep 8
fm_14:
  buffer_load_dword v66, v67, s[32:35], 0 offen sc1
  buffer_load_dword v42, v41, s[16:19], s76 offen sc1
  s_add_u32 s101, s101, 1
  s_cmp_gt_u32 s101, 131072
  s_cbranch_scc1 end0
fm_13:
  s_waitcnt vmcnt(0)
  s_mov_b32 s84, s83
  v_readlane_b32 s83, v66, 19
  s_sub_u32 s21, s83, 1
  s_lshl_b32 s21, s21, 13
  s_and_b32 s21, s21, 8192
  s_xor_b32 s76, s90, s21
  s_cmp_eq_u32 s83, 0
  s_cbranch_scc1 fm_12
  s_cmp_eq_u32 s84, 0
  s_cbranch_scc1 fm_14
  v_readlane_b32 s22, v66, 0
  v_readlane_b32 s23, v66, 32
  s_add_u32 s22, s22, s23
  v_readlane_b32 s23, v66, 1
  s_add_u32 s22, s22, s23
  v_readlane_b32 s23, v66, 33
  s_add_u32 s22, s22, s23
  v_readlane_b32 s23, v66, 2
  s_add_u32 s22, s22, s23
  v_readlane_b32 s23, v66, 34
  s_add_u32 s22, s22, s23
  v_readlane_b32 s23, v66, 3
  s_add_u32 s22, s22, s23
  v_readlane_b32 s23, v66, 35
  s_add_u32 s22, s22, s23
  v_readlane_b32 s21, v66, 16
  v_cmp_gt_u32 vcc, 2, v42
  s_cmp_lt_u32 s22, 256
  s_cbranch_scc1 fm_12
  s_cmp_lt_u32 s21, 128
  s_cbranch_scc1 fm_12
  s_cbranch_vccnz fm_12
  v_readlane_b32 s21, v66, s82
  v_cmp_ne_u32 vcc, 32, v66
  s_cmp_ge_u32 s21, 32
  s_cselect_b32 s84, 1, 0
  s_andn2_b32 s53, s84, s53
  s_and_b32 s21, vcc_lo, 15
  s_and_b32 s22, vcc_hi, 15
  s_or_b32 s85, s21, s22
  s_xor_b32 s83, s76, s90
  s_lshl_b32 s70, s50, 4
  s_add_u32 s79, s70, s55
  s_add_u32 s70, s70, s51
  s_lshl_b32 s70, s70, 14
  s_lshl_b32 s79, s79, 14
  s_lshl_b32 s21, s56, 11
  s_add_u32 s79, s79, s21
  s_lshl_b32 s72, s50, 16
  s_lshl_b32 s21, s60, 10
  s_add_u32 s72, s72, s21
  s_add_u32 s72, s72, 136314880
  s_mov_b32 s74, 32768
  s_add_u32 s73, s70, s83
  s_add_u32 s70, s73, 4096
  s_add_u32 s72, s72, s83
  s_xor_b32 s21, s83, 8192
  s_add_u32 s79, s79, s21
  s_add_u32 s12, s48, 173080576
  s_addc_u32 s13, s49, 0
  s_mov_b32 s14, 49152
  s_mov_b32 s15, 0x00020000
  s_mov_b32 s16, s48
  s_mov_b32 s17, s49
  s_mov_b32 s18, 218103808
  s_mov_b32 s19, 0x00020000
  s_waitcnt lgkmcnt(0)
  s_lshl_b32 s21, s20, 16
  s_add_u32 s21, s21, s79
  buffer_load_dwordx4 v[144:147], v4, s[16:19], s21 offen sc1
  buffer_load_dwordx4 v[148:151], v4, s[16:19], s21 offen offset:1024 sc1
  v_subrev_u32 v100, 43008, v20
  v_subrev_u32 v101, 43008, v21
  buffer_load_dwordx4 v[112:115], v100, s[16:19], s73 offen sc1
  buffer_load_dwordx2 v[116:117], v101, s[16:19], s73 offen sc1
  v_and_b32 v100, 127, v19
  v_lshl_add_u32 v100, v3, 8, v100
  v_and_b32 v101, 2, v2
  v_cmp_eq_u32 vcc, 0, v101
  s_lshl_b32 s21, s20, 14
  s_lshl_b32 s22, s61, 7
  s_add_u32 s21, s21, s22
  s_add_u32 s21, s21, s72
  v_mov_b32 v152, 0x3f803f80
  v_mov_b32 v153, 0x3f803f80
  v_mov_b32 v154, 0x3f803f80
  v_mov_b32 v155, 0x3f803f80
  s_mov_b64 exec, vcc
  buffer_load_dwordx4 v[152:155], v100, s[16:19], s21 offen sc1
  s_mov_b64 exec, -1
  v_and_b32 v100, 7, v1
  v_mul_u32_u24 v100, 1280, v100
  v_lshrrev_b32 v101, 3, v1
  v_lshl_add_u32 v100, v101, 4, v100
  buffer_load_dwordx4 v[48:51], v100, s[36:39], 0 offen offset:0
  buffer_load_dwordx4 v[52:55], v100, s[36:39], 0 offen offset:128
  buffer_load_dwordx4 v[56:59], v100, s[36:39], 0 offen offset:256
  buffer_load_dwordx4 v[60:63], v100, s[36:39], 0 offen offset:384
  buffer_load_dwordx4 v[64:67], v100, s[36:39], 0 offen offset:512
  buffer_load_dwordx4 v[68:71], v100, s[36:39], 0 offen offset:640
  buffer_load_dwordx4 v[72:75], v100, s[36:39], 0 offen offset:768
  buffer_load_dwordx4 v[76:79], v100, s[36:39], 0 offen offset:896
  buffer_load_dwordx4 v[80:83], v100, s[36:39], 0 offen offset:1024
  buffer_load_dwordx4 v[84:87], v100, s[36:39], 0 offen offset:1152
  s_barrier
  s_cmp_eq_u32 s20, 3
  s_cbranch_scc1 w3_16
  ds_read_b64_tr_b16 a[160:161], v88 offset:12288
  ds_read_b64_tr_b16 a[162:163], v88 offset:12480
  ds_read_b64_tr_b16 a[164:165], v88 offset:18432
  ds_read_b64_tr_b16 a[166:167], v88 offset:18624
  ds_read_b64_tr_b16 a[168:169], v88 offset:24576
  ds_read_b64_tr_b16 a[170:171], v88 offset:24768
  ds_read_b64_tr_b16 a[172:173], v88 offset:30720
  ds_read_b64_tr_b16 a[174:175], v88 offset:30912
  ds_read_b64_tr_b16 a[176:177], v88 offset:0
  ds_read_b64_tr_b16 a[178:179], v88 offset:192
  ds_read_b64_tr_b16 a[180:181], v89 offset:12288
  ds_read_b64_tr_b16 a[182:183], v89 offset:12480
  ds_read_b64_tr_b16 a[184:185], v89 offset:18432
  ds_read_b64_tr_b16 a[186:187], v89 offset:18624
  ds_read_b64_tr_b16 a[188:189], v89 offset:24576
  ds_read_b64_tr_b16 a[190:191], v89 offset:24768
  ds_read_b64_tr_b16 a[192:193], v89 offset:30720
  ds_read_b64_tr_b16 a[194:195], v89 offset:30912
  ds_read_b64_tr_b16 a[196:197], v89 offset:0
  ds_read_b64_tr_b16 a[198:199], v89 offset:192
  ds_read_b64_tr_b16 a[200:201], v90 offset:12288
  ds_read_b64_tr_b16 a[202:203], v90 offset:12480
  ds_read_b64_tr_b16 a[204:205], v90 offset:18432
  ds_read_b64_tr_b16 a[206:207], v90 offset:18624
  ds_read_b64_tr_b16 a[208:209], v90 offset:24576
  ds_read_b64_tr_b16 a[210:211], v90 offset:24768
  ds_read_b64_tr_b16 a[212:213], v90 offset:30720
  ds_read_b64_tr_b16 a[214:215], v90 offset:30912
  ds_read_b64_tr_b16 a[216:217], v90 offset:0
  ds_read_b64_tr_b16 a[218:219], v90 offset:192
  ds_read_b64_tr_b16 a[220:221], v91 offset:12288
  ds_read_b64_tr_b16 a[222:223], v91 offset:12480
  ds_read_b64_tr_b16 a[224:225], v91 offset:18432
  ds_read_b64_tr_b16 a[226:227], v91 offset:18624
  ds_read_b64_tr_b16 a[228:229], v91 offset:24576
  ds_read_b64_tr_b16 a[230:231], v91 offset:24768
  ds_read_b64_tr_b16 a[232:233], v91 offset:30720
  ds_read_b64_tr_b16 a[234:235], v91 offset:30912
  ds_read_b64_tr_b16 a[236:237], v91 offset:0
  ds_read_b64_tr_b16 a[238:239], v91 offset:192
  ds_read_b64_tr_b16 a[240:241], v92 offset:12288
  ds_read_b64_tr_b16 a[242:243], v92 offset:12480
  ds_read_b64_tr_b16 a[244:245], v92 offset:18432
  ds_read_b64_tr_b16 a[246:247], v92 offset:18624
  ds_read_b64_tr_b16 a[248:249], v92 offset:24576
  ds_read_b64_tr_b16 a[250:251], v92 offset:24768
  ds_read_b64_tr_b16 a[252:253], v92 offset:30720
  ds_read_b64_tr_b16 a[254:255], v92 offset:30912
  ds_read_b64_tr_b16 v[192:193], v92 offset:0
  ds_read_b64_tr_b16 v[194:195], v92 offset:192
  ds_read_b64_tr_b16 v[196:197], v93 offset:12288
  ds_read_b64_tr_b16 v[198:199], v93 offset:12480
  ds_read_b64_tr_b16 v[200:201], v93 offset:18432
  ds_read_b64_tr_b16 v[202:203], v93 offset:18624
  ds_read_b64_tr_b16 v[204:205], v93 offset:24576
  ds_read_b64_tr_b16 v[206:207], v93 offset:24768
  ds_read_b64_tr_b16 v[208:209], v93 offset:30720
  ds_read_b64_tr_b16 v[210:211], v93 offset:30912
  ds_read_b64_tr_b16 v[212:213], v93 offset:0
  ds_read_b64_tr_b16 v[214:215], v93 offset:192
  ds_read_b64_tr_b16 v[216:217], v94 offset:12288
  ds_read_b64_tr_b16 v[218:219], v94 offset:12480
  ds_read_b64_tr_b16 v[220:221], v94 offset:18432
  ds_read_b64_tr_b16 v[222:223], v94 offset:18624
  ds_read_b64_tr_b16 v[224:225], v94 offset:24576
  ds_read_b64_tr_b16 v[226:227], v94 offset:24768
  ds_read_b64_tr_b16 v[228:229], v94 offset:30720
  ds_read_b64_tr_b16 v[230:231], v94 offset:30912
  ds_read_b64_tr_b16 v[232:233], v94 offset:0
  ds_read_b64_tr_b16 v[234:235], v94 offset:192
  ds_read_b64_tr_b16 v[236:237], v95 offset:12288
  ds_read_b64_tr_b16 v[238:239], v95 offset:12480
  ds_read_b64_tr_b16 v[240:241], v95 offset:18432
  ds_read_b64_tr_b16 v[242:243], v95 offset:18624
  ds_read_b64_tr_b16 v[244:245], v95 offset:24576
  ds_read_b64_tr_b16 v[246:247], v95 offset:24768
  ds_read_b64_tr_b16 v[248:249], v95 offset:30720
  ds_read_b64_tr_b16 v[250:251], v95 offset:30912
  ds_read_b64_tr_b16 v[252:253], v95 offset:0
  ds_read_b64_tr_b16 v[254:255], v95 offset:192
  s_branch w3_17
w3_16:
  ds_read_b128 a[160:163], v96 offset:36864
  ds_read_b128 a[164:167], v96 offset:37376
  ds_read_b128 a[168:171], v96 offset:37888
  ds_read_b128 a[172:175], v96 offset:38400
  ds_read_b128 a[176:179], v96 offset:38912
  ds_read_b128 a[180:183], v96 offset:39424
  ds_read_b128 a[184:187], v96 offset:39936
  ds_read_b128 a[188:191], v96 offset:40448
  ds_read_b128 a[192:195], v96 offset:6144
  ds_read_b128 a[196:199], v96 offset:6656
  ds_read_b128 a[200:203], v96 offset:7168
  ds_read_b128 a[204:207], v96 offset:7680
  ds_read_b128 a[208:211], v96 offset:8192
  ds_read_b128 a[212:215], v96 offset:8704
  ds_read_b128 a[216:219], v96 offset:9216
  ds_read_b128 a[220:223], v96 offset:9728
  ds_read_b128 a[224:227], v96 offset:10240
  ds_read_b128 a[228:231], v96 offset:10752
  ds_read_b128 a[232:235], v96 offset:11264
  ds_read_b128 a[236:239], v96 offset:11776
  ds_read_b128 a[240:243], v97 offset:36864
  ds_read_b128 a[244:247], v97 offset:37376
  ds_read_b128 a[248:251], v97 offset:37888
  ds_read_b128 a[252:255], v97 offset:38400
  ds_read_b128 v[192:195], v97 offset:38912
  ds_read_b128 v[196:199], v97 offset:39424
  ds_read_b128 v[200:203], v97 offset:39936
  ds_read_b128 v[204:207], v97 offset:40448
  ds_read_b128 v[208:211], v97 offset:6144
  ds_read_b128 v[212:215], v97 offset:6656
  ds_read_b128 v[216:219], v97 offset:7168
  ds_read_b128 v[220:223], v97 offset:7680
  ds_read_b128 v[224:227], v97 offset:8192
  ds_read_b128 v[228:231], v97 offset:8704
  ds_read_b128 v[232:235], v97 offset:9216
  ds_read_b128 v[236:239], v97 offset:9728
  ds_read_b128 v[240:243], v97 offset:10240
  ds_read_b128 v[244:247], v97 offset:10752
  ds_read_b128 v[248:251], v97 offset:11264
  ds_read_b128 v[252:255], v97 offset:11776
w3_17:
  s_cmp_eq_u32 s85, 0
  s_cbranch_scc1 fm_15
  s_cmp_eq_u32 s20, 3
  s_cbranch_scc1 ar_19
  s_mov_b64 exec, s[64:65]
  s_cmp_eq_u32 s20, 2
  s_cbranch_scc1 ar_18
  s_mov_b32 s21, 0
  buffer_store_dwordx2 v[28:29], v8, s[8:11], s21 offen sc1
  s_mov_b32 s21, 122880
  buffer_store_dwordx2 v[28:29], v8, s[8:11], s21 offen sc1
  s_mov_b32 s21, 245760
  buffer_store_dwordx2 v[28:29], v8, s[8:11], s21 offen sc1
  s_mov_b32 s21, 368640
  buffer_store_dwordx2 v[28:29], v8, s[8:11], s21 offen sc1
  s_branch ar_20
ar_18:
  s_mov_b32 s21, 0
  buffer_store_dword v28, v8, s[8:11], s21 offen sc1
  buffer_store_dword v28, v8, s[8:11], s21 offen offset:128 sc1
  s_mov_b32 s21, 122880
  buffer_store_dword v28, v8, s[8:11], s21 offen sc1
  buffer_store_dword v28, v8, s[8:11], s21 offen offset:128 sc1
  s_mov_b32 s21, 245760
  buffer_store_dword v28, v8, s[8:11], s21 offen sc1
  buffer_store_dword v28, v8, s[8:11], s21 offen offset:128 sc1
  s_mov_b32 s21, 368640
  buffer_store_dword v28, v8, s[8:11], s21 offen sc1
  buffer_store_dword v28, v8, s[8:11], s21 offen offset:128 sc1
ar_20:
  s_cmp_eq_u32 s78, 0
  s_cbranch_scc1 ar_21
  s_mov_b64 exec, s[62:63]
  s_add_u32 s21, s77, 0
  buffer_store_dword v28, v17, s[8:11], s21 offen sc1
  s_add_u32 s21, s77, 122880
  buffer_store_dword v28, v17, s[8:11], s21 offen sc1
  s_add_u32 s21, s77, 245760
  buffer_store_dword v28, v17, s[8:11], s21 offen sc1
  s_add_u32 s21, s77, 368640
  buffer_store_dword v28, v17, s[8:11], s21 offen sc1
  s_branch ar_21
ar_19:
  buffer_store_dword v28, v34, s[8:11], 0 offen sc1
  s_mov_b64 exec, s[66:67]
  s_mov_b32 s21, 0
  buffer_store_dwordx4 v[28:31], v15, s[4:7], s21 offen sc1
  s_mov_b32 s21, 262144
  buffer_store_dwordx4 v[28:31], v15, s[4:7], s21 offen sc1
  s_mov_b32 s21, 524288
  buffer_store_dwordx4 v[28:31], v15, s[4:7], s21 offen sc1
  s_mov_b32 s21, 786432
  buffer_store_dwordx4 v[28:31], v15, s[4:7], s21 offen sc1
  s_mov_b32 s21, 8192
  buffer_store_dwordx4 v[28:31], v15, s[4:7], s21 offen sc1
  s_mov_b32 s21, 270336
  buffer_store_dwordx4 v[28:31], v15, s[4:7], s21 offen sc1
  s_mov_b32 s21, 532480
  buffer_store_dwordx4 v[28:31], v15, s[4:7], s21 offen sc1
  s_mov_b32 s21, 794624
  buffer_store_dwordx4 v[28:31], v15, s[4:7], s21 offen sc1
ar_21:
  s_mov_b64 exec, -1
  s_waitcnt vmcnt(0)
  s_barrier
  s_mov_b32 s21, 100
  s_cmp_lg_u32 s20, 0
  s_cbranch_scc1 af_22
  v_mov_b32 v166, 0
  v_mov_b32 v167, 1
  s_mov_b64 exec, 1
  buffer_atomic_add v167, v166, s[32:35], s21 offen sc1
  s_mov_b64 exec, -1
  s_nop 1
af_22:
  s_cmp_lg_u32 s20, 0
  s_cbranch_scc1 wf_24
  v_mov_b32 v166, 0
  s_mov_b32 s101, 0
wf_23:
  buffer_load_dword v167, v166, s[32:35], s21 offen sc1
  s_add_u32 s101, s101, 1
  s_cmp_gt_u32 s101, 131072
  s_cbranch_scc1 end0
  s_waitcnt vmcnt(0)
  v_readfirstlane_b32 s100, v167
  s_cmp_ge_u32 s100, 128
  s_cbranch_scc1 wf_24
  s_sleep 8
  s_branch wf_23
wf_24:
  s_barrier
fm_15:
  s_xor_b32 s74, s74, 16384
  s_add_u32 s73, s73, 2097152
  s_xor_b32 s73, s73, 8192
  s_add_u32 s79, s79, 2097152
  s_xor_b32 s79, s79, 8192
  s_add_u32 s21, s72, 524288
  s_xor_b32 s72, s72, s21
  s_lshr_b32 s72, s72, 8
  s_and_b32 s72, s72, 8192
  s_xor_b32 s72, s72, s21
  s_add_u32 s71, s73, 4096
  s_mov_b32 s91, 1024
  s_sub_u32 s21, s73, 0
  s_cmp_lt_u32 s21, 125829120
  s_cselect_b32 s71, s71, s79
  s_cselect_b32 s91, s91, 65536
  v_add_u32 v15, s83, v15
  v_add_u32 v16, s83, v16
  s_mov_b32 s75, s77
  s_lshl_b32 s77, s58, 7
  s_lshl_b32 s21, s56, 3
  s_add_u32 s77, s77, s21
  s_add_u32 s77, s77, 0
  s_xor_b32 s77, s77, s83
  s_mov_b32 s80, 1400897536
  s_mov_b32 s52, 0
  s_mov_b32 s81, 0
  v_xor_b32 v18, 16384, v18
  v_xor_b32 v19, 16384, v19
  v_xor_b32 v20, 16384, v20
  v_xor_b32 v21, 16384, v21
  v_mov_b32 v168, 0x3f803f80
  v_mov_b32 v169, 0x3f803f80
  v_mov_b32 v170, 0x3f803f80
  v_mov_b32 v171, 0x3f803f80
  v_mov_b32 v166, 0x3f003f00
  v_mov_b32 v167, 0x3f003f00
  s_waitcnt lgkmcnt(0)
  s_barrier
  ds_write_b128 v23, v[168:171] offset:46080
  ds_write_b128 v23, v[168:171] offset:62464
  ds_write_b64 v23, v[166:167] offset:13568
  v_mov_b32 v88, 0
  v_mov_b32 v89, 0
  v_mov_b32 v90, 0
  v_mov_b32 v91, 0
  v_mov_b32 v92, 0
  v_mov_b32 v93, 0
  v_mov_b32 v94, 0
  v_mov_b32 v95, 0
  v_mov_b32 v96, 0
  v_mov_b32 v97, 0
  v_mov_b32 v98, 0
  v_mov_b32 v99, 0
  v_mov_b32 v100, 0
  v_mov_b32 v101, 0
  v_mov_b32 v102, 0
  v_mov_b32 v103, 0
  v_mov_b32 v110, 0
  v_mov_b32 v111, 0
  v_mov_b32 v118, 0
  v_mov_b32 v119, 0
  v_mov_b32 v142, 0
  v_mov_b32 v143, 0
  v_mov_b32 v162, 0
  v_mov_b32 v163, 0
  s_and_b32 s21, s52, 3
  s_mul_i32 s56, s21, 122880
  s_add_u32 s21, s52, 1
  s_and_b32 s21, s21, 3
  s_mul_i32 s55, s21, 122880
  s_add_u32 s55, s55, s75
  s_add_u32 s21, s52, 2
  s_and_b32 s21, s21, 3
  s_mul_i32 s57, s21, 122880
  s_add_u32 s21, s52, 3
  s_and_b32 s21, s21, 3
  s_mul_i32 s59, s21, 122880
  s_add_u32 s59, s59, s75
  s_bfe_u32 s61, s52, 0x10002
  s_and_b32 s21, s52, 3
  s_lshl_b32 s60, s21, 18
  s_mov_b32 s58, s55
  s_waitcnt lgkmcnt(0)
  s_lshl_b32 s21, s53, 2
  s_add_u32 s21, s21, s20
  s_cmp_eq_u32 s21, 0
  s_cbranch_scc1 E_25
  s_cmp_eq_u32 s21, 4
  s_cbranch_scc1 E_26
  s_cmp_eq_u32 s21, 1
  s_cbranch_scc1 E_27
  s_cmp_eq_u32 s21, 5
  s_cbranch_scc1 E_28
  s_cmp_eq_u32 s21, 2
  s_cbranch_scc1 E_29
  s_cmp_eq_u32 s21, 6
  s_cbranch_scc1 E_30
  s_cmp_eq_u32 s21, 3
  s_cbranch_scc1 E_31
  s_cmp_eq_u32 s21, 7
  s_cbranch_scc1 E_32
  s_branch end0
E_26:
  v_add_u32 v190, 0, v4
  ds_write_b64 v6, v[28:29]
  ds_write_b32 v13, v28
  ds_write_b32 v14, v28
  s_waitcnt vmcnt(0)
  ds_write_b128 v190, v[48:51] offset:0
  ds_write_b128 v190, v[52:55] offset:1024
  s_waitcnt lgkmcnt(0)
  s_add_u32 m0, s74, 4096
  s_add_u32 s21, s79, 131072
  buffer_load_dwordx4 v4, s[16:19], s21 offen offset:1024 sc1 lds
  s_add_u32 m0, s74, 9216
  s_add_u32 s21, s72, 32768
  buffer_load_dwordx4 v32, s[16:19], s21 offen sc1 lds
  s_xor_b32 s74, s74, 16384
  s_add_u32 s73, s73, 2097152
  s_xor_b32 s73, s73, 8192
  s_add_u32 s79, s79, 2097152
  s_xor_b32 s79, s79, 8192
  s_add_u32 s21, s72, 524288
  s_xor_b32 s72, s72, s21
  s_lshr_b32 s72, s72, 8
  s_and_b32 s72, s72, 8192
  s_xor_b32 s72, s72, s21
  s_add_u32 s71, s73, 4096
  s_mov_b32 s91, 1024
  s_sub_u32 s21, s73, 0
  s_cmp_lt_u32 s21, 125829120
  s_cselect_b32 s71, s71, s79
  s_cselect_b32 s91, s91, 65536
  s_branch mo_38
  .p2align 3
top_33:
  s_waitcnt vmcnt(1)
  ds_write_b128 v190, v[48:51] offset:0
  v_cmp_eq_u32 s[22:23], -1, v48
  s_waitcnt vmcnt(0)
  ds_write_b128 v190, v[52:55] offset:1024
  v_cmp_eq_u32 s[98:99], -1, v52
  s_or_b64 vcc, s[22:23], s[98:99]
  s_cbranch_scc1 mr_34
mo_38:
  s_barrier
  ds_read_b128 v[56:59], v4 offset:2048
  ds_read_b128 v[60:63], v4 offset:3072
  v_smfmac_f32_16x16x64_bf16 v[92:95], v[48:51], a[240:247], v22
  ds_read_b128 v[64:67], v4 offset:4096
  v_smfmac_f32_16x16x64_bf16 v[88:91], v[48:51], a[160:167], v22
  ds_read_b128 v[68:71], v4 offset:5120
  v_smfmac_f32_16x16x64_bf16 v[92:95], v[52:55], a[248:255], v22
  ds_read_b128 v[72:75], v4 offset:6144
  v_smfmac_f32_16x16x64_bf16 v[88:91], v[52:55], a[168:175], v22
  s_waitcnt lgkmcnt(4)
  ds_read_b128 v[76:79], v4 offset:7168
  v_smfmac_f32_16x16x64_bf16 v[92:95], v[56:59], v[192:199], v22
  ds_read_b128 v[80:83], v4 offset:8192
  v_smfmac_f32_16x16x64_bf16 v[88:91], v[56:59], a[176:183], v22
  s_waitcnt lgkmcnt(5)
  ds_read_b128 v[84:87], v4 offset:9216
  v_smfmac_f32_16x16x64_bf16 v[92:95], v[60:63], v[200:207], v22
  v_smfmac_f32_16x16x64_bf16 v[88:91], v[60:63], a[184:191], v22
  s_waitcnt lgkmcnt(5)
  v_smfmac_f32_16x16x64_bf16 v[92:95], v[64:67], v[208:215], v22
  s_waitcnt lgkmcnt(4)
  v_smfmac_f32_16x16x64_bf16 v[92:95], v[68:71], v[216:223], v22
  s_waitcnt lgkmcnt(3)
  v_smfmac_f32_16x16x64_bf16 v[92:95], v[72:75], v[224:231], v22
  s_waitcnt lgkmcnt(2)
  v_smfmac_f32_16x16x64_bf16 v[92:95], v[76:79], v[232:239], v22
  s_waitcnt lgkmcnt(1)
  v_smfmac_f32_16x16x64_bf16 v[92:95], v[80:83], v[240:247], v22
  s_waitcnt lgkmcnt(0)
  v_smfmac_f32_16x16x64_bf16 v[92:95], v[84:87], v[248:255], v22
  v_smfmac_f32_16x16x64_bf16 v[88:91], v[64:67], a[192:199], v22
  v_smfmac_f32_16x16x64_bf16 v[88:91], v[68:71], a[200:207], v22
  v_smfmac_f32_16x16x64_bf16 v[88:91], v[72:75], a[208:215], v22
  v_permlane32_swap_b32 v92, v93
  v_smfmac_f32_16x16x64_bf16 v[88:91], v[76:79], a[216:223], v22
  v_permlane32_swap_b32 v94, v95
  v_smfmac_f32_16x16x64_bf16 v[88:91], v[80:83], a[224:231], v22
  v_permlane32_swap_b32 v93, v92
  v_smfmac_f32_16x16x64_bf16 v[88:91], v[84:87], a[232:239], v22
  v_permlane32_swap_b32 v95, v94
  v_pk_mul_f32 v[120:121], v[92:93], v[24:25] op_sel:[1,0] op_sel_hi:[0,1]
  v_pk_mul_f32 v[122:123], v[94:95], v[24:25] op_sel:[1,0] op_sel_hi:[0,1]
  s_nop 4
  v_pk_fma_f32 v[88:89], v[88:89], v[24:25], v[120:121]
  v_pk_fma_f32 v[90:91], v[90:91], v[24:25], v[122:123]
  v_cvt_pk_bf16_f32 v120, v88, v89
  v_cvt_pk_bf16_f32 v121, v90, v91
  ds_write_b64 v6, v[120:121]
  s_barrier
  ds_read_b64_tr_b16 v[104:105], v7 offset:0
  ds_read_b64_tr_b16 v[106:107], v7 offset:768
  ds_read_b64_tr_b16 v[108:109], v7 offset:1536
  s_waitcnt lgkmcnt(1)
  v_mfma_f32_16x16x32_bf16 v[120:123], v[112:115], v[104:107], 0
  s_waitcnt lgkmcnt(0)
  v_mfma_f32_16x16x32_bf16 v[120:123], v[116:119], v[108:111], v[120:123]
  s_mov_b64 exec, s[64:65]
  s_nop 6
  v_cmpx_o_f32 vcc, v120, v121
  v_cvt_pk_f16_f32 v120, v120, v121
  v_cvt_pk_f16_f32 v121, v122, v123
  buffer_store_dwordx2 v[120:121], v8, s[8:11], s56 offen
  s_xor_b64 s[98:99], exec, s[64:65]
  s_mov_b64 exec, -1
  s_waitcnt lgkmcnt(0)
  s_barrier
  ds_read_b64_tr_b16 v[104:105], v7 offset:0
  ds_read_b64_tr_b16 v[106:107], v7 offset:768
  ds_read_b64_tr_b16 v[108:109], v7 offset:1536
  ds_read_b32 v27, v12 offset:12544
  ds_read_b64 v[140:141], v11
  s_waitcnt lgkmcnt(1)
  v_cmp_u_f32 vcc, v104, v106
  v_cmp_u_f32 s[22:23], v108, v27
  s_nop 1
  s_or_b64 vcc, vcc, s[22:23]
  s_cbranch_vccnz mn_35
mk_36:
  s_cmp_eq_u32 s52, 63
  s_cbranch_scc1 last_37
  s_cmp_lg_u64 s[98:99], 0
  s_cbranch_scc1 sf_39
sf_40:
  s_nop 15
  s_nop 10
  v_smfmac_f32_16x16x64_bf16 v[96:99], v[48:51], a[0:7], v22
  v_smfmac_f32_16x16x64_bf16 v[100:103], v[48:51], a[80:87], v22
  v_smfmac_f32_16x16x64_bf16 v[96:99], v[52:55], a[8:15], v22
  v_smfmac_f32_16x16x64_bf16 v[100:103], v[52:55], a[88:95], v22
  v_smfmac_f32_16x16x64_bf16 v[96:99], v[56:59], a[16:23], v22
  v_smfmac_f32_16x16x64_bf16 v[100:103], v[56:59], a[96:103], v22
  buffer_load_dwordx4 v[132:135], v10, s[8:11], s56 offen sc1
  v_smfmac_f32_16x16x64_bf16 v[96:99], v[60:63], a[24:31], v22
  buffer_load_dwordx4 v[124:127], v9, s[8:11], s56 offen sc1
  v_smfmac_f32_16x16x64_bf16 v[96:99], v[64:67], a[32:39], v22
  buffer_load_dwordx4 v[128:131], v9, s[8:11], s56 offen offset:1024 sc1
  v_smfmac_f32_16x16x64_bf16 v[96:99], v[68:71], a[40:47], v22
  v_smfmac_f32_16x16x64_bf16 v[96:99], v[72:75], a[48:55], v22
  v_smfmac_f32_16x16x64_bf16 v[96:99], v[76:79], a[56:63], v22
  v_smfmac_f32_16x16x64_bf16 v[96:99], v[80:83], a[64:71], v22
  v_smfmac_f32_16x16x64_bf16 v[96:99], v[84:87], a[72:79], v22
  v_smfmac_f32_16x16x64_bf16 v[100:103], v[60:63], a[104:111], v22
  v_smfmac_f32_16x16x64_bf16 v[100:103], v[64:67], a[112:119], v22
  v_smfmac_f32_16x16x64_bf16 v[100:103], v[68:71], a[120:127], v22
  v_smfmac_f32_16x16x64_bf16 v[100:103], v[72:75], a[128:135], v22
  v_cvt_pk_bf16_f32 v136, v96, v97
  v_smfmac_f32_16x16x64_bf16 v[100:103], v[76:79], a[136:143], v22
  v_cvt_pk_bf16_f32 v137, v98, v99
  v_smfmac_f32_16x16x64_bf16 v[100:103], v[80:83], a[144:151], v22
  v_smfmac_f32_16x16x64_bf16 v[100:103], v[84:87], a[152:159], v22
  s_nop 7
  v_cvt_pk_bf16_f32 v138, v100, v101
  v_cvt_pk_bf16_f32 v139, v102, v103
  s_waitcnt vmcnt(2) lgkmcnt(0)
  v_pk_add_f16 v164, v132, v133
  v_pk_add_f16 v165, v134, v135
  v_fma_mix_f32 v170, v164, 1.0, v165 op_sel:[0,0,0] op_sel_hi:[1,0,1]
  v_fma_mix_f32 v171, v164, 1.0, v165 op_sel:[1,0,1] op_sel_hi:[1,0,1]
  v_exp_f32 v176, v170
  v_exp_f32 v177, v171
  s_waitcnt vmcnt(1)
  v_cvt_pk_bf16_f32 v160, v176, v177
  v_pk_add_f16 v120, v124, v126
  v_pk_add_f16 v121, v125, v127
  v_mov_b32_dpp v161, v160 row_ror:8 row_mask:0xf bank_mask:0xf
  s_waitcnt vmcnt(0)
  v_pk_add_f16 v122, v128, v130
  v_mfma_f32_16x16x32_bf16 v[178:181], v[140:143], v[160:163], 0
  v_fma_mix_f32 v166, v120, 1.0, v122 op_sel:[0,0,0] op_sel_hi:[1,0,1]
  v_fma_mix_f32 v167, v120, 1.0, v122 op_sel:[1,0,1] op_sel_hi:[1,0,1]
  v_cmp_u_f32 vcc, v166, v170
  v_pk_add_f16 v123, v129, v131
  v_exp_f32 v172, v166
  v_mfma_f32_16x16x32_bf16 v[182:185], v[136:139], v[160:163], 0
  s_cbranch_vccnz sr_41
  v_exp_f32 v173, v167
  v_fma_mix_f32 v168, v121, 1.0, v123 op_sel:[0,0,0] op_sel_hi:[1,0,1]
  v_fma_mix_f32 v169, v121, 1.0, v123 op_sel:[1,0,1] op_sel_hi:[1,0,1]
  v_cvt_pk_bf16_f32 v156, v172, v173
  v_exp_f32 v174, v168
  v_exp_f32 v175, v169
  v_mov_b32_dpp v158, v156 row_ror:8 row_mask:0xf bank_mask:0xf
  v_cvt_pk_bf16_f32 v157, v174, v175
  v_mfma_f32_16x16x32_bf16 v[186:189], v[138:141], v[160:163], 0
  s_nop 0
  v_mov_b32_dpp v159, v157 row_ror:8 row_mask:0xf bank_mask:0xf
  s_nop 1
pv_42:
  v_mfma_f32_16x16x32_bf16 v[178:181], v[152:155], v[156:159], v[178:181]
  v_mfma_f32_16x16x32_bf16 v[182:185], v[144:147], v[156:159], v[182:185]
  v_mfma_f32_16x16x32_bf16 v[186:189], v[148:151], v[156:159], v[186:189]
  s_mov_b64 exec, s[62:63]
  s_nop 0
  v_rcp_f32 v164, v180
  v_cmp_ngt_f32 s[22:23], s80, v180
  v_cmp_ngt_f32 vcc, s80, v164
  v_pk_mul_f32 v[182:183], v[182:183], v[164:165] op_sel_hi:[1,0]
  v_pk_mul_f32 v[184:185], v[184:185], v[164:165] op_sel_hi:[1,0]
  v_pk_mul_f32 v[178:179], v[178:179], v[164:165] op_sel_hi:[1,0]
  v_pk_mul_f32 v[186:187], v[186:187], v[164:165] op_sel_hi:[1,0]
  v_pk_mul_f32 v[188:189], v[188:189], v[164:165] op_sel_hi:[1,0]
  v_cvt_pk_f16_f32 v64, v178, v179
  s_or_b64 vcc, vcc, s[22:23]
  s_cbranch_scc1 fx_44
fk_45:
  ds_write_b32 v14, v64
  v_cvt_pk_f16_f32 v60, v182, v183
  v_cvt_pk_f16_f32 v61, v184, v185
  v_cvt_pk_f16_f32 v62, v186, v187
  v_cvt_pk_f16_f32 v63, v188, v189
  ds_write_b128 v13, v[60:63]
  s_barrier
  s_mov_b64 exec, -1
  s_add_u32 m0, s74, 4096
  s_add_u32 s21, s79, 131072
  buffer_load_dwordx4 v4, s[16:19], s21 offen offset:1024 sc1 lds
  s_add_u32 m0, s74, 9216
  s_add_u32 s21, s72, 32768
  buffer_load_dwordx4 v32, s[16:19], s21 offen sc1 lds
  s_xor_b32 s74, s74, 16384
  s_add_u32 s73, s73, 2097152
  s_xor_b32 s73, s73, 8192
  s_add_u32 s79, s79, 2097152
  s_xor_b32 s79, s79, 8192
  s_add_u32 s21, s72, 524288
  s_xor_b32 s72, s72, s21
  s_lshr_b32 s72, s72, 8
  s_and_b32 s72, s72, 8192
  s_xor_b32 s72, s72, s21
  s_add_u32 s71, s73, 4096
  s_mov_b32 s91, 1024
  s_sub_u32 s21, s73, 0
  s_cmp_lt_u32 s21, 125829120
  s_cselect_b32 s71, s71, s79
  s_cselect_b32 s91, s91, 65536
  v_permlane32_swap_b32 v96, v100
  v_permlane32_swap_b32 v97, v101
  v_permlane32_swap_b32 v98, v102
  v_permlane32_swap_b32 v99, v103
  v_pk_add_f32 v[96:97], v[96:97], v[100:101]
  v_pk_add_f32 v[98:99], v[98:99], v[102:103]
  v_cvt_pk_bf16_f32 v100, v96, v97
  v_cvt_pk_bf16_f32 v101, v98, v99
  s_nop 0
  v_permlane32_swap_b32 v100, v102
  v_permlane32_swap_b32 v101, v103
  v_min_u32 v100, -2, v100
  s_nop 6
  buffer_store_dwordx4 v[100:103], v26, s[16:19], s70 offen sc1
  v_min_u32 v104, -2, v104
  buffer_store_dwordx4 v[104:107], v36, s[16:19], s70 offen offset:2560 sc1
  s_add_u32 s70, s70, 2097152
  s_xor_b32 s70, s70, 8192
  ds_read_b128 v[144:147], v18
  ds_read_b128 v[148:151], v18 offset:1024
  ds_read_b128 v[152:155], v19
  ds_read_b128 v[112:115], v20
  ds_read_b64 v[116:117], v21
  v_xor_b32 v18, 16384, v18
  v_xor_b32 v19, 16384, v19
  v_xor_b32 v20, 16384, v20
  v_xor_b32 v21, 16384, v21
  v_mov_b32 v88, 0
  v_mov_b32 v89, 0
  v_mov_b32 v90, 0
  v_mov_b32 v91, 0
  v_mov_b32 v92, 0
  v_mov_b32 v93, 0
  v_mov_b32 v94, 0
  v_mov_b32 v95, 0
  v_mov_b32 v96, 0
  v_mov_b32 v97, 0
  v_mov_b32 v98, 0
  v_mov_b32 v99, 0
  v_mov_b32 v100, 0
  v_mov_b32 v101, 0
  v_mov_b32 v102, 0
  v_mov_b32 v103, 0
  s_mov_b32 s81, 0
  s_waitcnt lgkmcnt(0)
  s_barrier
  s_mov_b64 exec, s[64:65]
  buffer_store_dwordx2 v[28:29], v8, s[8:11], s57 offen
  s_mov_b64 exec, -1
  ds_write_b128 v190, v[28:31] offset:0
  ds_write_b128 v190, v[28:31] offset:1024
  ds_write_b64 v6, v[28:29]
  s_mov_b64 exec, s[62:63]
  buffer_store_dword v28, v17, s[8:11], s59 offen
  s_mov_b64 exec, -1
  s_sleep 3
  s_nop 1
  buffer_load_dwordx4 v[68:71], v16, s[4:7], s60 offen sc1
  s_sleep 3
  s_nop 1
  buffer_load_dwordx4 v[72:75], v16, s[4:7], s60 offen sc1
  s_waitcnt vmcnt(1)
  v_mfma_f32_16x16x32_f16 v[120:123], v[44:47], v[68:71], 0
  v_bitop3_b32 v27, v68, s61, 1 bitop3:0x28
  v_cmp_ne_u32 vcc, 0, v27
  s_nop 1
  s_cbranch_vccnz p2_50
  s_nop 2
pg_49:
  v_add_f32_dpp v120, v120, v120 row_ror:8 row_mask:0xf bank_mask:0xf
  v_add_f32_dpp v121, v121, v121 row_ror:8 row_mask:0xf bank_mask:0xf
  s_mov_b64 exec, s[62:63]
  v_cvt_pk_bf16_f32 v120, v120, v121
  v_min_u32 v120, -2, v120
  buffer_store_dword v120, v17, s[8:11], s55 offen
  s_mov_b64 exec, -1
nt_46:
  s_barrier
  s_mov_b32 s58, s55
  s_add_u32 s52, s52, 1
  ds_write_b32 v13, v28
  ds_write_b32 v14, v28
  s_and_b32 s21, s52, 3
  s_mul_i32 s56, s21, 122880
  s_add_u32 s21, s52, 1
  s_and_b32 s21, s21, 3
  s_mul_i32 s55, s21, 122880
  s_add_u32 s55, s55, s75
  s_add_u32 s21, s52, 2
  s_and_b32 s21, s21, 3
  s_mul_i32 s57, s21, 122880
  s_add_u32 s21, s52, 3
  s_and_b32 s21, s21, 3
  s_mul_i32 s59, s21, 122880
  s_add_u32 s59, s59, s75
  s_bfe_u32 s61, s52, 0x10002
  s_and_b32 s21, s52, 3
  s_lshl_b32 s60, s21, 18
  s_mov_b32 s54, 0
  s_sleep 2
  s_nop 10
  s_waitcnt lgkmcnt(0)
  buffer_load_dwordx4 v[48:51], v190, s[8:11], s58 offen offset:0 sc1
  buffer_load_dwordx4 v[52:55], v190, s[8:11], s58 offen offset:1024 sc1
  s_branch top_33
mr_34:
  s_mov_b64 exec, s[22:23]
  s_cbranch_execz ms_51
  buffer_load_dwordx4 v[48:51], v190, s[8:11], s58 offen offset:0 sc1
ms_51:
  s_mov_b64 exec, s[98:99]
  s_cbranch_execz ms_52
  buffer_load_dwordx4 v[52:55], v190, s[8:11], s58 offen offset:1024 sc1
ms_52:
  s_add_u32 s54, s54, 1
  s_cmp_gt_u32 s54, 131072
  s_cbranch_scc1 end0
  s_waitcnt vmcnt(0)
  s_mov_b64 exec, s[22:23]
  ds_write_b128 v190, v[48:51] offset:0
  v_cmp_eq_u32 s[22:23], -1, v48
  s_mov_b64 exec, s[98:99]
  ds_write_b128 v190, v[52:55] offset:1024
  v_cmp_eq_u32 s[98:99], -1, v52
  s_mov_b64 exec, -1
  s_or_b64 vcc, s[22:23], s[98:99]
  s_cbranch_scc1 mr_34
  s_branch mo_38
sf_39:
  s_waitcnt lgkmcnt(1)
  v_mfma_f32_16x16x32_bf16 v[120:123], v[112:115], v[104:107], 0
  s_waitcnt lgkmcnt(0)
  v_mfma_f32_16x16x32_bf16 v[120:123], v[116:119], v[108:111], v[120:123]
  s_mov_b64 exec, s[64:65]
  s_nop 6
  v_cvt_pk_f16_f32 v120, v120, v121
  v_cvt_pk_f16_f32 v121, v122, v123
  buffer_store_dwordx2 v[120:121], v8, s[8:11], s56 offen
  s_mov_b64 exec, -1
  s_branch sf_40
mn_35:
  s_bitcmp1_b32 s81, 1
  s_cbranch_scc1 mk_36
  s_or_b32 s81, s81, 2
  s_nop 7
  v_mov_b32 v88, 0
  v_mov_b32 v89, 0
  v_mov_b32 v90, 0
  v_mov_b32 v91, 0
  v_mov_b32 v92, 0
  v_mov_b32 v93, 0
  v_mov_b32 v94, 0
  v_mov_b32 v95, 0
  v_mov_b32 v96, 0
  v_mov_b32 v97, 0
  v_mov_b32 v98, 0
  v_mov_b32 v99, 0
  v_mov_b32 v100, 0
  v_mov_b32 v101, 0
  v_mov_b32 v102, 0
  v_mov_b32 v103, 0
  s_cmp_eq_u32 s52, 0
  s_cbranch_scc1 mx_54
mx_53:
  buffer_load_dwordx4 v[48:51], v190, s[8:11], s58 offen offset:0 sc1
  buffer_load_dwordx4 v[52:55], v190, s[8:11], s58 offen offset:1024 sc1
  s_add_u32 s54, s54, 1
  s_cmp_gt_u32 s54, 131072
  s_cbranch_scc1 end0
  s_waitcnt vmcnt(0)
  v_max3_u32 v27, v48, v49, v50
  v_max3_u32 v27, v27, v51, v52
  v_max3_u32 v27, v27, v53, v54
  v_max3_u32 v27, v27, v55, v55
  v_cmp_eq_u32 vcc, -1, v27
  s_nop 1
  s_cbranch_vccnz mx_53
  ds_write_b128 v190, v[48:51] offset:0
  ds_write_b128 v190, v[52:55] offset:1024
mx_54:
  s_waitcnt lgkmcnt(0)
  s_branch mo_38
sr_41:
  s_mov_b32 s54, 0
sr_55:
  s_mov_b64 exec, vcc
  buffer_load_dwordx4 v[124:127], v9, s[8:11], s56 offen sc1
  buffer_load_dwordx4 v[128:131], v9, s[8:11], s56 offen offset:1024 sc1
  buffer_load_dwordx4 v[132:135], v10, s[8:11], s56 offen sc1
  s_mov_b64 exec, -1
  s_add_u32 s54, s54, 1
  s_cmp_gt_u32 s54, 131072
  s_cbranch_scc1 end0
  s_waitcnt vmcnt(0)
  v_pk_add_f16 v164, v132, v133
  v_pk_add_f16 v165, v134, v135
  v_pk_add_f16 v120, v124, v126
  v_pk_add_f16 v122, v128, v130
  v_fma_mix_f32 v170, v164, 1.0, v165 op_sel:[0,0,0] op_sel_hi:[1,0,1]
  v_fma_mix_f32 v166, v120, 1.0, v122 op_sel:[0,0,0] op_sel_hi:[1,0,1]
  v_pk_add_f16 v121, v125, v127
  v_cmp_u_f32 vcc, v166, v170
  v_pk_add_f16 v123, v129, v131
  v_fma_mix_f32 v171, v164, 1.0, v165 op_sel:[1,0,1] op_sel_hi:[1,0,1]
  v_fma_mix_f32 v167, v120, 1.0, v122 op_sel:[1,0,1] op_sel_hi:[1,0,1]
  v_fma_mix_f32 v168, v121, 1.0, v123 op_sel:[0,0,0] op_sel_hi:[1,0,1]
  v_fma_mix_f32 v169, v121, 1.0, v123 op_sel:[1,0,1] op_sel_hi:[1,0,1]
  s_cbranch_vccz ex_43
  s_and_b32 s21, s54, 31
  s_cbranch_scc1 sr_55
  v_max3_u32 v27, v124, v126, v128
  v_max3_u32 v27, v27, v130, v132
  v_max3_u32 v27, v27, v133, v134
  v_max3_u32 v27, v27, v135, v135
  v_cmp_eq_u32 vcc, -1, v27
  s_nop 1
  s_cbranch_vccnz sr_55
ex_43:
  v_exp_f32 v176, v170
  v_exp_f32 v177, v171
  v_exp_f32 v172, v166
  v_cvt_pk_bf16_f32 v160, v176, v177
  v_exp_f32 v173, v167
  v_exp_f32 v174, v168
  v_mov_b32_dpp v161, v160 row_ror:8 row_mask:0xf bank_mask:0xf
  v_cvt_pk_bf16_f32 v156, v172, v173
  v_exp_f32 v175, v169
  v_mfma_f32_16x16x32_bf16 v[178:181], v[140:143], v[160:163], 0
  v_mov_b32_dpp v158, v156 row_ror:8 row_mask:0xf bank_mask:0xf
  v_cvt_pk_bf16_f32 v157, v174, v175
  v_mfma_f32_16x16x32_bf16 v[182:185], v[136:139], v[160:163], 0
  s_nop 0
  v_mov_b32_dpp v159, v157 row_ror:8 row_mask:0xf bank_mask:0xf
  v_mfma_f32_16x16x32_bf16 v[186:189], v[138:141], v[160:163], 0
  s_branch pv_42
fx_44:
  s_bitcmp1_b32 s81, 0
  s_cbranch_scc1 fk_45
  s_or_b32 s81, s81, 1
  s_mov_b64 exec, -1
  v_max3_f32 v164, v166, v167, v168
  v_max3_f32 v165, v169, v170, v171
  v_max_f32 v164, v164, v165
  s_nop 1
  v_max_f32_dpp v164, v164, v164 row_ror:8 row_mask:0xf bank_mask:0xf
  v_mov_b32 v165, v164
  s_nop 1
  v_permlane32_swap_b32 v164, v165
  v_max_f32 v164, v164, v165
  v_mov_b32 v165, v164
  s_nop 1
  v_permlane16_swap_b32 v164, v165
  v_max_f32 v164, v164, v165
  v_sub_f32 v166, v166, v164
  v_sub_f32 v167, v167, v164
  v_sub_f32 v168, v168, v164
  v_sub_f32 v169, v169, v164
  v_sub_f32 v170, v170, v164
  v_sub_f32 v171, v171, v164
  s_branch ex_43
p2_50:
  s_mov_b32 s54, 0
  buffer_load_dwordx4 v[68:71], v16, s[4:7], s60 offen sc1
  s_waitcnt vmcnt(1)
  v_mfma_f32_16x16x32_f16 v[120:123], v[44:47], v[72:75], 0
  v_bitop3_b32 v27, v72, s61, 1 bitop3:0x28
  v_cmp_ne_u32 vcc, 0, v27
  s_nop 1
  s_cbranch_vccz pg_49
  buffer_load_dwordx4 v[72:75], v16, s[4:7], s60 offen sc1
pp_48:
  s_waitcnt vmcnt(1)
  v_mfma_f32_16x16x32_f16 v[120:123], v[44:47], v[68:71], 0
  v_bitop3_b32 v27, v68, s61, 1 bitop3:0x28
  v_cmp_ne_u32 vcc, 0, v27
  s_nop 1
  s_cbranch_vccz pg_49
  buffer_load_dwordx4 v[68:71], v16, s[4:7], s60 offen sc1
  s_waitcnt vmcnt(1)
  v_mfma_f32_16x16x32_f16 v[120:123], v[44:47], v[72:75], 0
  v_bitop3_b32 v27, v72, s61, 1 bitop3:0x28
  v_cmp_ne_u32 vcc, 0, v27
  s_nop 1
  s_cbranch_vccz pg_49
  buffer_load_dwordx4 v[72:75], v16, s[4:7], s60 offen sc1
  s_add_u32 s54, s54, 1
  s_cmp_gt_u32 s54, 131072
  s_cbranch_scc1 end0
  s_branch pp_48
last_37:
  v_min_u32 v104, -2, v104
  buffer_store_dwordx4 v[104:107], v36, s[16:19], s70 offen offset:2560 sc1
  v_smfmac_f32_16x16x64_bf16 v[96:99], v[48:51], a[0:7], v22
  v_smfmac_f32_16x16x64_bf16 v[100:103], v[48:51], a[80:87], v22
  v_smfmac_f32_16x16x64_bf16 v[96:99], v[52:55], a[8:15], v22
  v_smfmac_f32_16x16x64_bf16 v[100:103], v[52:55], a[88:95], v22
  v_smfmac_f32_16x16x64_bf16 v[96:99], v[56:59], a[16:23], v22
  v_smfmac_f32_16x16x64_bf16 v[100:103], v[56:59], a[96:103], v22
  v_smfmac_f32_16x16x64_bf16 v[96:99], v[60:63], a[24:31], v22
  v_smfmac_f32_16x16x64_bf16 v[96:99], v[64:67], a[32:39], v22
  v_smfmac_f32_16x16x64_bf16 v[96:99], v[68:71], a[40:47], v22
  v_smfmac_f32_16x16x64_bf16 v[96:99], v[72:75], a[48:55], v22
  v_smfmac_f32_16x16x64_bf16 v[96:99], v[76:79], a[56:63], v22
  v_smfmac_f32_16x16x64_bf16 v[96:99], v[80:83], a[64:71], v22
  v_smfmac_f32_16x16x64_bf16 v[96:99], v[84:87], a[72:79], v22
  v_smfmac_f32_16x16x64_bf16 v[100:103], v[60:63], a[104:111], v22
  v_smfmac_f32_16x16x64_bf16 v[100:103], v[64:67], a[112:119], v22
  v_smfmac_f32_16x16x64_bf16 v[100:103], v[68:71], a[120:127], v22
  v_smfmac_f32_16x16x64_bf16 v[100:103], v[72:75], a[128:135], v22
  v_smfmac_f32_16x16x64_bf16 v[100:103], v[76:79], a[136:143], v22
  v_smfmac_f32_16x16x64_bf16 v[100:103], v[80:83], a[144:151], v22
  v_smfmac_f32_16x16x64_bf16 v[100:103], v[84:87], a[152:159], v22
  s_nop 7
  v_permlane32_swap_b32 v96, v100
  v_permlane32_swap_b32 v97, v101
  v_permlane32_swap_b32 v98, v102
  v_permlane32_swap_b32 v99, v103
  v_pk_add_f32 v[96:97], v[96:97], v[100:101]
  v_pk_add_f32 v[98:99], v[98:99], v[102:103]
  v_cvt_pk_bf16_f32 v100, v96, v97
  v_cvt_pk_bf16_f32 v101, v98, v99
  s_nop 0
  v_permlane32_swap_b32 v100, v102
  v_permlane32_swap_b32 v101, v103
  v_min_u32 v100, -2, v100
  buffer_store_dwordx4 v[100:103], v26, s[16:19], s70 offen sc1
  s_waitcnt vmcnt(0)
  s_barrier
  s_branch chain_done
E_28:
  v_add_u32 v190, 2048, v4
  ds_write_b64 v6, v[28:29]
  ds_write_b32 v13, v28
  ds_write_b32 v14, v28
  s_waitcnt vmcnt(0)
  ds_write_b128 v190, v[56:59] offset:0
  ds_write_b128 v190, v[60:63] offset:1024
  ds_write_b128 v190, v[64:67] offset:2048
  s_waitcnt lgkmcnt(0)
  s_add_u32 m0, s74, 6144
  s_add_u32 s21, s79, 196608
  buffer_load_dwordx4 v4, s[16:19], s21 offen offset:1024 sc1 lds
  s_add_u32 m0, s74, 4096
  s_mul_i32 s21, s91, 2
  s_add_u32 s21, s21, s71
  buffer_load_dwordx4 v4, s[16:19], s21 offen sc1 lds
  s_xor_b32 s74, s74, 16384
  s_add_u32 s73, s73, 2097152
  s_xor_b32 s73, s73, 8192
  s_add_u32 s79, s79, 2097152
  s_xor_b32 s79, s79, 8192
  s_add_u32 s21, s72, 524288
  s_xor_b32 s72, s72, s21
  s_lshr_b32 s72, s72, 8
  s_and_b32 s72, s72, 8192
  s_xor_b32 s72, s72, s21
  s_add_u32 s71, s73, 4096
  s_mov_b32 s91, 1024
  s_sub_u32 s21, s73, 0
  s_cmp_lt_u32 s21, 125829120
  s_cselect_b32 s71, s71, s79
  s_cselect_b32 s91, s91, 65536
  s_branch mo_62
  .p2align 3
top_57:
  s_waitcnt vmcnt(2)
  ds_write_b128 v190, v[56:59] offset:0
  v_cmp_eq_u32 s[22:23], -1, v56
  s_waitcnt vmcnt(1)
  ds_write_b128 v190, v[60:63] offset:1024
  v_cmp_eq_u32 s[98:99], -1, v60
  s_waitcnt vmcnt(0)
  ds_write_b128 v190, v[64:67] offset:2048
  v_cmp_eq_u32 s[100:101], -1, v64
  s_or_b64 vcc, s[22:23], s[98:99]
  s_or_b64 vcc, vcc, s[100:101]
  s_cbranch_scc1 mr_58
mo_62:
  s_barrier
  ds_read_b128 v[48:51], v4 offset:0
  ds_read_b128 v[52:55], v4 offset:1024
  v_smfmac_f32_16x16x64_bf16 v[92:95], v[56:59], v[192:199], v22
  ds_read_b128 v[68:71], v4 offset:5120
  v_smfmac_f32_16x16x64_bf16 v[88:91], v[56:59], a[176:183], v22
  ds_read_b128 v[72:75], v4 offset:6144
  v_smfmac_f32_16x16x64_bf16 v[92:95], v[60:63], v[200:207], v22
  ds_read_b128 v[76:79], v4 offset:7168
  v_smfmac_f32_16x16x64_bf16 v[88:91], v[60:63], a[184:191], v22
  ds_read_b128 v[80:83], v4 offset:8192
  v_smfmac_f32_16x16x64_bf16 v[92:95], v[64:67], v[208:215], v22
  ds_read_b128 v[84:87], v4 offset:9216
  v_smfmac_f32_16x16x64_bf16 v[88:91], v[64:67], a[192:199], v22
  s_waitcnt lgkmcnt(6)
  v_smfmac_f32_16x16x64_bf16 v[92:95], v[48:51], a[240:247], v22
  v_smfmac_f32_16x16x64_bf16 v[88:91], v[48:51], a[160:167], v22
  s_waitcnt lgkmcnt(5)
  v_smfmac_f32_16x16x64_bf16 v[92:95], v[52:55], a[248:255], v22
  s_waitcnt lgkmcnt(4)
  v_smfmac_f32_16x16x64_bf16 v[92:95], v[68:71], v[216:223], v22
  s_waitcnt lgkmcnt(3)
  v_smfmac_f32_16x16x64_bf16 v[92:95], v[72:75], v[224:231], v22
  s_waitcnt lgkmcnt(2)
  v_smfmac_f32_16x16x64_bf16 v[92:95], v[76:79], v[232:239], v22
  s_waitcnt lgkmcnt(1)
  v_smfmac_f32_16x16x64_bf16 v[92:95], v[80:83], v[240:247], v22
  s_waitcnt lgkmcnt(0)
  v_smfmac_f32_16x16x64_bf16 v[92:95], v[84:87], v[248:255], v22
  v_smfmac_f32_16x16x64_bf16 v[88:91], v[52:55], a[168:175], v22
  v_smfmac_f32_16x16x64_bf16 v[88:91], v[68:71], a[200:207], v22
  v_smfmac_f32_16x16x64_bf16 v[88:91], v[72:75], a[208:215], v22
  v_permlane32_swap_b32 v92, v93
  v_smfmac_f32_16x16x64_bf16 v[88:91], v[76:79], a[216:223], v22
  v_permlane32_swap_b32 v94, v95
  v_smfmac_f32_16x16x64_bf16 v[88:91], v[80:83], a[224:231], v22
  v_permlane32_swap_b32 v93, v92
  v_smfmac_f32_16x16x64_bf16 v[88:91], v[84:87], a[232:239], v22
  v_permlane32_swap_b32 v95, v94
  v_pk_mul_f32 v[120:121], v[92:93], v[24:25] op_sel:[1,0] op_sel_hi:[0,1]
  v_pk_mul_f32 v[122:123], v[94:95], v[24:25] op_sel:[1,0] op_sel_hi:[0,1]
  s_nop 4
  v_pk_fma_f32 v[88:89], v[88:89], v[24:25], v[120:121]
  v_pk_fma_f32 v[90:91], v[90:91], v[24:25], v[122:123]
  v_cvt_pk_bf16_f32 v120, v88, v89
  v_cvt_pk_bf16_f32 v121, v90, v91
  ds_write_b64 v6, v[120:121]
  s_barrier
  ds_read_b64_tr_b16 v[104:105], v7 offset:0
  ds_read_b64_tr_b16 v[106:107], v7 offset:768
  ds_read_b64_tr_b16 v[108:109], v7 offset:1536
  s_waitcnt lgkmcnt(1)
  v_mfma_f32_16x16x32_bf16 v[120:123], v[112:115], v[104:107], 0
  s_waitcnt lgkmcnt(0)
  v_mfma_f32_16x16x32_bf16 v[120:123], v[116:119], v[108:111], v[120:123]
  s_mov_b64 exec, s[64:65]
  s_nop 6
  v_cmpx_o_f32 vcc, v120, v121
  v_cvt_pk_f16_f32 v120, v120, v121
  v_cvt_pk_f16_f32 v121, v122, v123
  buffer_store_dwordx2 v[120:121], v8, s[8:11], s56 offen
  s_xor_b64 s[98:99], exec, s[64:65]
  s_mov_b64 exec, -1
  s_waitcnt lgkmcnt(0)
  s_barrier
  ds_read_b64_tr_b16 v[104:105], v7 offset:0
  ds_read_b64_tr_b16 v[106:107], v7 offset:768
  ds_read_b64_tr_b16 v[108:109], v7 offset:1536
  ds_read_b32 v27, v12 offset:12544
  ds_read_b64 v[140:141], v11
  s_waitcnt lgkmcnt(1)
  v_cmp_u_f32 vcc, v104, v106
  v_cmp_u_f32 s[22:23], v108, v27
  s_nop 1
  s_or_b64 vcc, vcc, s[22:23]
  s_cbranch_vccnz mn_59
mk_60:
  s_cmp_eq_u32 s52, 63
  s_cbranch_scc1 last_61
  s_cmp_lg_u64 s[98:99], 0
  s_cbranch_scc1 sf_63
sf_64:
  s_nop 15
  s_nop 10
  v_smfmac_f32_16x16x64_bf16 v[96:99], v[48:51], a[0:7], v22
  v_smfmac_f32_16x16x64_bf16 v[100:103], v[48:51], a[80:87], v22
  v_smfmac_f32_16x16x64_bf16 v[96:99], v[52:55], a[8:15], v22
  v_smfmac_f32_16x16x64_bf16 v[100:103], v[52:55], a[88:95], v22
  v_smfmac_f32_16x16x64_bf16 v[96:99], v[56:59], a[16:23], v22
  v_smfmac_f32_16x16x64_bf16 v[100:103], v[56:59], a[96:103], v22
  buffer_load_dwordx4 v[132:135], v10, s[8:11], s56 offen sc1
  v_smfmac_f32_16x16x64_bf16 v[96:99], v[60:63], a[24:31], v22
  buffer_load_dwordx4 v[124:127], v9, s[8:11], s56 offen sc1
  v_smfmac_f32_16x16x64_bf16 v[96:99], v[64:67], a[32:39], v22
  buffer_load_dwordx4 v[128:131], v9, s[8:11], s56 offen offset:1024 sc1
  v_smfmac_f32_16x16x64_bf16 v[96:99], v[68:71], a[40:47], v22
  v_smfmac_f32_16x16x64_bf16 v[96:99], v[72:75], a[48:55], v22
  v_smfmac_f32_16x16x64_bf16 v[96:99], v[76:79], a[56:63], v22
  v_smfmac_f32_16x16x64_bf16 v[96:99], v[80:83], a[64:71], v22
  v_smfmac_f32_16x16x64_bf16 v[96:99], v[84:87], a[72:79], v22
  v_smfmac_f32_16x16x64_bf16 v[100:103], v[60:63], a[104:111], v22
  v_smfmac_f32_16x16x64_bf16 v[100:103], v[64:67], a[112:119], v22
  v_smfmac_f32_16x16x64_bf16 v[100:103], v[68:71], a[120:127], v22
  v_smfmac_f32_16x16x64_bf16 v[100:103], v[72:75], a[128:135], v22
  v_cvt_pk_bf16_f32 v136, v96, v97
  v_smfmac_f32_16x16x64_bf16 v[100:103], v[76:79], a[136:143], v22
  v_cvt_pk_bf16_f32 v137, v98, v99
  v_smfmac_f32_16x16x64_bf16 v[100:103], v[80:83], a[144:151], v22
  v_smfmac_f32_16x16x64_bf16 v[100:103], v[84:87], a[152:159], v22
  s_nop 7
  v_cvt_pk_bf16_f32 v138, v100, v101
  v_cvt_pk_bf16_f32 v139, v102, v103
  s_waitcnt vmcnt(2) lgkmcnt(0)
  v_pk_add_f16 v164, v132, v133
  v_pk_add_f16 v165, v134, v135
  v_fma_mix_f32 v170, v164, 1.0, v165 op_sel:[0,0,0] op_sel_hi:[1,0,1]
  v_fma_mix_f32 v171, v164, 1.0, v165 op_sel:[1,0,1] op_sel_hi:[1,0,1]
  v_exp_f32 v176, v170
  v_exp_f32 v177, v171
  s_waitcnt vmcnt(1)
  v_cvt_pk_bf16_f32 v160, v176, v177
  v_pk_add_f16 v120, v124, v126
  v_pk_add_f16 v121, v125, v127
  v_mov_b32_dpp v161, v160 row_ror:8 row_mask:0xf bank_mask:0xf
  s_waitcnt vmcnt(0)
  v_pk_add_f16 v122, v128, v130
  v_mfma_f32_16x16x32_bf16 v[178:181], v[140:143], v[160:163], 0
  v_fma_mix_f32 v166, v120, 1.0, v122 op_sel:[0,0,0] op_sel_hi:[1,0,1]
  v_fma_mix_f32 v167, v120, 1.0, v122 op_sel:[1,0,1] op_sel_hi:[1,0,1]
  v_cmp_u_f32 vcc, v166, v170
  v_pk_add_f16 v123, v129, v131
  v_exp_f32 v172, v166
  v_mfma_f32_16x16x32_bf16 v[182:185], v[136:139], v[160:163], 0
  s_cbranch_vccnz sr_65
  v_exp_f32 v173, v167
  v_fma_mix_f32 v168, v121, 1.0, v123 op_sel:[0,0,0] op_sel_hi:[1,0,1]
  v_fma_mix_f32 v169, v121, 1.0, v123 op_sel:[1,0,1] op_sel_hi:[1,0,1]
  v_cvt_pk_bf16_f32 v156, v172, v173
  v_exp_f32 v174, v168
  v_exp_f32 v175, v169
  v_mov_b32_dpp v158, v156 row_ror:8 row_mask:0xf bank_mask:0xf
  v_cvt_pk_bf16_f32 v157, v174, v175
  v_mfma_f32_16x16x32_bf16 v[186:189], v[138:141], v[160:163], 0
  s_nop 0
  v_mov_b32_dpp v159, v157 row_ror:8 row_mask:0xf bank_mask:0xf
  s_nop 1
pv_66:
  v_mfma_f32_16x16x32_bf16 v[178:181], v[152:155], v[156:159], v[178:181]
  v_mfma_f32_16x16x32_bf16 v[182:185], v[144:147], v[156:159], v[182:185]
  v_mfma_f32_16x16x32_bf16 v[186:189], v[148:151], v[156:159], v[186:189]
  s_mov_b64 exec, s[62:63]
  s_nop 0
  v_rcp_f32 v164, v180
  v_cmp_ngt_f32 s[22:23], s80, v180
  v_cmp_ngt_f32 vcc, s80, v164
  v_pk_mul_f32 v[182:183], v[182:183], v[164:165] op_sel_hi:[1,0]
  v_pk_mul_f32 v[184:185], v[184:185], v[164:165] op_sel_hi:[1,0]
  v_pk_mul_f32 v[178:179], v[178:179], v[164:165] op_sel_hi:[1,0]
  v_pk_mul_f32 v[186:187], v[186:187], v[164:165] op_sel_hi:[1,0]
  v_pk_mul_f32 v[188:189], v[188:189], v[164:165] op_sel_hi:[1,0]
  v_cvt_pk_f16_f32 v64, v178, v179
  s_or_b64 vcc, vcc, s[22:23]
  s_cbranch_scc1 fx_68
fk_69:
  ds_write_b32 v14, v64
  v_cvt_pk_f16_f32 v60, v182, v183
  v_cvt_pk_f16_f32 v61, v184, v185
  v_cvt_pk_f16_f32 v62, v186, v187
  v_cvt_pk_f16_f32 v63, v188, v189
  ds_write_b128 v13, v[60:63]
  s_barrier
  s_mov_b64 exec, -1
  s_add_u32 m0, s74, 6144
  s_add_u32 s21, s79, 196608
  buffer_load_dwordx4 v4, s[16:19], s21 offen offset:1024 sc1 lds
  s_add_u32 m0, s74, 4096
  s_mul_i32 s21, s91, 2
  s_add_u32 s21, s21, s71
  buffer_load_dwordx4 v4, s[16:19], s21 offen sc1 lds
  s_xor_b32 s74, s74, 16384
  s_add_u32 s73, s73, 2097152
  s_xor_b32 s73, s73, 8192
  s_add_u32 s79, s79, 2097152
  s_xor_b32 s79, s79, 8192
  s_add_u32 s21, s72, 524288
  s_xor_b32 s72, s72, s21
  s_lshr_b32 s72, s72, 8
  s_and_b32 s72, s72, 8192
  s_xor_b32 s72, s72, s21
  s_add_u32 s71, s73, 4096
  s_mov_b32 s91, 1024
  s_sub_u32 s21, s73, 0
  s_cmp_lt_u32 s21, 125829120
  s_cselect_b32 s71, s71, s79
  s_cselect_b32 s91, s91, 65536
  v_permlane32_swap_b32 v96, v100
  v_permlane32_swap_b32 v97, v101
  v_permlane32_swap_b32 v98, v102
  v_permlane32_swap_b32 v99, v103
  v_pk_add_f32 v[96:97], v[96:97], v[100:101]
  v_pk_add_f32 v[98:99], v[98:99], v[102:103]
  v_cvt_pk_bf16_f32 v100, v96, v97
  v_cvt_pk_bf16_f32 v101, v98, v99
  s_nop 0
  v_permlane32_swap_b32 v100, v102
  v_permlane32_swap_b32 v101, v103
  v_min_u32 v100, -2, v100
  s_nop 6
  buffer_store_dwordx4 v[100:103], v26, s[16:19], s70 offen sc1
  v_min_u32 v108, -2, v108
  buffer_store_dwordx2 v[108:109], v37, s[16:19], s70 offen offset:3072 sc1
  s_add_u32 s70, s70, 2097152
  s_xor_b32 s70, s70, 8192
  ds_read_b128 v[144:147], v18
  ds_read_b128 v[148:151], v18 offset:1024
  ds_read_b128 v[152:155], v19
  ds_read_b128 v[112:115], v20
  ds_read_b64 v[116:117], v21
  v_xor_b32 v18, 16384, v18
  v_xor_b32 v19, 16384, v19
  v_xor_b32 v20, 16384, v20
  v_xor_b32 v21, 16384, v21
  v_mov_b32 v88, 0
  v_mov_b32 v89, 0
  v_mov_b32 v90, 0
  v_mov_b32 v91, 0
  v_mov_b32 v92, 0
  v_mov_b32 v93, 0
  v_mov_b32 v94, 0
  v_mov_b32 v95, 0
  v_mov_b32 v96, 0
  v_mov_b32 v97, 0
  v_mov_b32 v98, 0
  v_mov_b32 v99, 0
  v_mov_b32 v100, 0
  v_mov_b32 v101, 0
  v_mov_b32 v102, 0
  v_mov_b32 v103, 0
  s_mov_b32 s81, 0
  s_waitcnt lgkmcnt(0)
  s_barrier
  s_mov_b64 exec, s[64:65]
  buffer_store_dwordx2 v[28:29], v8, s[8:11], s57 offen
  s_mov_b64 exec, -1
  ds_write_b128 v190, v[28:31] offset:0
  ds_write_b128 v190, v[28:31] offset:1024
  ds_write_b128 v190, v[28:31] offset:2048
  ds_write_b64 v6, v[28:29]
  s_mov_b64 exec, s[62:63]
  buffer_store_dword v28, v17, s[8:11], s59 offen
  s_mov_b64 exec, -1
  s_sleep 3
  s_nop 1
  buffer_load_dwordx4 v[68:71], v16, s[4:7], s60 offen sc1
  s_sleep 3
  s_nop 1
  buffer_load_dwordx4 v[72:75], v16, s[4:7], s60 offen sc1
  s_waitcnt vmcnt(1)
  v_mfma_f32_16x16x32_f16 v[120:123], v[44:47], v[68:71], 0
  v_bitop3_b32 v27, v68, s61, 1 bitop3:0x28
  v_cmp_ne_u32 vcc, 0, v27
  s_nop 1
  s_cbranch_vccnz p2_74
  s_nop 2
pg_73:
  v_add_f32_dpp v120, v120, v120 row_ror:8 row_mask:0xf bank_mask:0xf
  v_add_f32_dpp v121, v121, v121 row_ror:8 row_mask:0xf bank_mask:0xf
  s_mov_b64 exec, s[62:63]
  v_cvt_pk_bf16_f32 v120, v120, v121
  v_min_u32 v120, -2, v120
  buffer_store_dword v120, v17, s[8:11], s55 offen
  s_mov_b64 exec, -1
nt_70:
  s_barrier
  s_mov_b32 s58, s55
  s_add_u32 s52, s52, 1
  ds_write_b32 v13, v28
  ds_write_b32 v14, v28
  s_and_b32 s21, s52, 3
  s_mul_i32 s56, s21, 122880
  s_add_u32 s21, s52, 1
  s_and_b32 s21, s21, 3
  s_mul_i32 s55, s21, 122880
  s_add_u32 s55, s55, s75
  s_add_u32 s21, s52, 2
  s_and_b32 s21, s21, 3
  s_mul_i32 s57, s21, 122880
  s_add_u32 s21, s52, 3
  s_and_b32 s21, s21, 3
  s_mul_i32 s59, s21, 122880
  s_add_u32 s59, s59, s75
  s_bfe_u32 s61, s52, 0x10002
  s_and_b32 s21, s52, 3
  s_lshl_b32 s60, s21, 18
  s_mov_b32 s54, 0
  s_sleep 2
  s_nop 10
  s_waitcnt lgkmcnt(0)
  buffer_load_dwordx4 v[56:59], v190, s[8:11], s58 offen offset:0 sc1
  buffer_load_dwordx4 v[60:63], v190, s[8:11], s58 offen offset:1024 sc1
  buffer_load_dwordx4 v[64:67], v190, s[8:11], s58 offen offset:2048 sc1
  s_branch top_57
mr_58:
  s_mov_b64 exec, s[22:23]
  s_cbranch_execz ms_75
  buffer_load_dwordx4 v[56:59], v190, s[8:11], s58 offen offset:0 sc1
ms_75:
  s_mov_b64 exec, s[98:99]
  s_cbranch_execz ms_76
  buffer_load_dwordx4 v[60:63], v190, s[8:11], s58 offen offset:1024 sc1
ms_76:
  s_mov_b64 exec, s[100:101]
  s_cbranch_execz ms_77
  buffer_load_dwordx4 v[64:67], v190, s[8:11], s58 offen offset:2048 sc1
ms_77:
  s_add_u32 s54, s54, 1
  s_cmp_gt_u32 s54, 131072
  s_cbranch_scc1 end0
  s_waitcnt vmcnt(0)
  s_mov_b64 exec, s[22:23]
  ds_write_b128 v190, v[56:59] offset:0
  v_cmp_eq_u32 s[22:23], -1, v56
  s_mov_b64 exec, s[98:99]
  ds_write_b128 v190, v[60:63] offset:1024
  v_cmp_eq_u32 s[98:99], -1, v60
  s_mov_b64 exec, s[100:101]
  ds_write_b128 v190, v[64:67] offset:2048
  v_cmp_eq_u32 s[100:101], -1, v64
  s_mov_b64 exec, -1
  s_or_b64 vcc, s[22:23], s[98:99]
  s_or_b64 vcc, vcc, s[100:101]
  s_cbranch_scc1 mr_58
  s_branch mo_62
sf_63:
  s_waitcnt lgkmcnt(1)
  v_mfma_f32_16x16x32_bf16 v[120:123], v[112:115], v[104:107], 0
  s_waitcnt lgkmcnt(0)
  v_mfma_f32_16x16x32_bf16 v[120:123], v[116:119], v[108:111], v[120:123]
  s_mov_b64 exec, s[64:65]
  s_nop 6
  v_cvt_pk_f16_f32 v120, v120, v121
  v_cvt_pk_f16_f32 v121, v122, v123
  buffer_store_dwordx2 v[120:121], v8, s[8:11], s56 offen
  s_mov_b64 exec, -1
  s_branch sf_64
mn_59:
  s_bitcmp1_b32 s81, 1
  s_cbranch_scc1 mk_60
  s_or_b32 s81, s81, 2
  s_nop 7
  v_mov_b32 v88, 0
  v_mov_b32 v89, 0
  v_mov_b32 v90, 0
  v_mov_b32 v91, 0
  v_mov_b32 v92, 0
  v_mov_b32 v93, 0
  v_mov_b32 v94, 0
  v_mov_b32 v95, 0
  v_mov_b32 v96, 0
  v_mov_b32 v97, 0
  v_mov_b32 v98, 0
  v_mov_b32 v99, 0
  v_mov_b32 v100, 0
  v_mov_b32 v101, 0
  v_mov_b32 v102, 0
  v_mov_b32 v103, 0
  s_cmp_eq_u32 s52, 0
  s_cbranch_scc1 mx_79
mx_78:
  buffer_load_dwordx4 v[56:59], v190, s[8:11], s58 offen offset:0 sc1
  buffer_load_dwordx4 v[60:63], v190, s[8:11], s58 offen offset:1024 sc1
  buffer_load_dwordx4 v[64:67], v190, s[8:11], s58 offen offset:2048 sc1
  s_add_u32 s54, s54, 1
  s_cmp_gt_u32 s54, 131072
  s_cbranch_scc1 end0
  s_waitcnt vmcnt(0)
  v_max3_u32 v27, v56, v57, v58
  v_max3_u32 v27, v27, v59, v60
  v_max3_u32 v27, v27, v61, v62
  v_max3_u32 v27, v27, v63, v64
  v_max3_u32 v27, v27, v65, v66
  v_max3_u32 v27, v27, v67, v67
  v_cmp_eq_u32 vcc, -1, v27
  s_nop 1
  s_cbranch_vccnz mx_78
  ds_write_b128 v190, v[56:59] offset:0
  ds_write_b128 v190, v[60:63] offset:1024
  ds_write_b128 v190, v[64:67] offset:2048
mx_79:
  s_waitcnt lgkmcnt(0)
  s_branch mo_62
sr_65:
  s_mov_b32 s54, 0
sr_80:
  s_mov_b64 exec, vcc
  buffer_load_dwordx4 v[124:127], v9, s[8:11], s56 offen sc1
  buffer_load_dwordx4 v[128:131], v9, s[8:11], s56 offen offset:1024 sc1
  buffer_load_dwordx4 v[132:135], v10, s[8:11], s56 offen sc1
  s_mov_b64 exec, -1
  s_add_u32 s54, s54, 1
  s_cmp_gt_u32 s54, 131072
  s_cbranch_scc1 end0
  s_waitcnt vmcnt(0)
  v_pk_add_f16 v164, v132, v133
  v_pk_add_f16 v165, v134, v135
  v_pk_add_f16 v120, v124, v126
  v_pk_add_f16 v122, v128, v130
  v_fma_mix_f32 v170, v164, 1.0, v165 op_sel:[0,0,0] op_sel_hi:[1,0,1]
  v_fma_mix_f32 v166, v120, 1.0, v122 op_sel:[0,0,0] op_sel_hi:[1,0,1]
  v_pk_add_f16 v121, v125, v127
  v_cmp_u_f32 vcc, v166, v170
  v_pk_add_f16 v123, v129, v131
  v_fma_mix_f32 v171, v164, 1.0, v165 op_sel:[1,0,1] op_sel_hi:[1,0,1]
  v_fma_mix_f32 v167, v120, 1.0, v122 op_sel:[1,0,1] op_sel_hi:[1,0,1]
  v_fma_mix_f32 v168, v121, 1.0, v123 op_sel:[0,0,0] op_sel_hi:[1,0,1]
  v_fma_mix_f32 v169, v121, 1.0, v123 op_sel:[1,0,1] op_sel_hi:[1,0,1]
  s_cbranch_vccz ex_67
  s_and_b32 s21, s54, 31
  s_cbranch_scc1 sr_80
  v_max3_u32 v27, v124, v126, v128
  v_max3_u32 v27, v27, v130, v132
  v_max3_u32 v27, v27, v133, v134
  v_max3_u32 v27, v27, v135, v135
  v_cmp_eq_u32 vcc, -1, v27
  s_nop 1
  s_cbranch_vccnz sr_80
ex_67:
  v_exp_f32 v176, v170
  v_exp_f32 v177, v171
  v_exp_f32 v172, v166
  v_cvt_pk_bf16_f32 v160, v176, v177
  v_exp_f32 v173, v167
  v_exp_f32 v174, v168
  v_mov_b32_dpp v161, v160 row_ror:8 row_mask:0xf bank_mask:0xf
  v_cvt_pk_bf16_f32 v156, v172, v173
  v_exp_f32 v175, v169
  v_mfma_f32_16x16x32_bf16 v[178:181], v[140:143], v[160:163], 0
  v_mov_b32_dpp v158, v156 row_ror:8 row_mask:0xf bank_mask:0xf
  v_cvt_pk_bf16_f32 v157, v174, v175
  v_mfma_f32_16x16x32_bf16 v[182:185], v[136:139], v[160:163], 0
  s_nop 0
  v_mov_b32_dpp v159, v157 row_ror:8 row_mask:0xf bank_mask:0xf
  v_mfma_f32_16x16x32_bf16 v[186:189], v[138:141], v[160:163], 0
  s_branch pv_66
fx_68:
  s_bitcmp1_b32 s81, 0
  s_cbranch_scc1 fk_69
  s_or_b32 s81, s81, 1
  s_mov_b64 exec, -1
  v_max3_f32 v164, v166, v167, v168
  v_max3_f32 v165, v169, v170, v171
  v_max_f32 v164, v164, v165
  s_nop 1
  v_max_f32_dpp v164, v164, v164 row_ror:8 row_mask:0xf bank_mask:0xf
  v_mov_b32 v165, v164
  s_nop 1
  v_permlane32_swap_b32 v164, v165
  v_max_f32 v164, v164, v165
  v_mov_b32 v165, v164
  s_nop 1
  v_permlane16_swap_b32 v164, v165
  v_max_f32 v164, v164, v165
  v_sub_f32 v166, v166, v164
  v_sub_f32 v167, v167, v164
  v_sub_f32 v168, v168, v164
  v_sub_f32 v169, v169, v164
  v_sub_f32 v170, v170, v164
  v_sub_f32 v171, v171, v164
  s_branch ex_67
p2_74:
  s_mov_b32 s54, 0
  buffer_load_dwordx4 v[68:71], v16, s[4:7], s60 offen sc1
  s_waitcnt vmcnt(1)
  v_mfma_f32_16x16x32_f16 v[120:123], v[44:47], v[72:75], 0
  v_bitop3_b32 v27, v72, s61, 1 bitop3:0x28
  v_cmp_ne_u32 vcc, 0, v27
  s_nop 1
  s_cbranch_vccz pg_73
  buffer_load_dwordx4 v[72:75], v16, s[4:7], s60 offen sc1
pp_72:
  s_waitcnt vmcnt(1)
  v_mfma_f32_16x16x32_f16 v[120:123], v[44:47], v[68:71], 0
  v_bitop3_b32 v27, v68, s61, 1 bitop3:0x28
  v_cmp_ne_u32 vcc, 0, v27
  s_nop 1
  s_cbranch_vccz pg_73
  buffer_load_dwordx4 v[68:71], v16, s[4:7], s60 offen sc1
  s_waitcnt vmcnt(1)
  v_mfma_f32_16x16x32_f16 v[120:123], v[44:47], v[72:75], 0
  v_bitop3_b32 v27, v72, s61, 1 bitop3:0x28
  v_cmp_ne_u32 vcc, 0, v27
  s_nop 1
  s_cbranch_vccz pg_73
  buffer_load_dwordx4 v[72:75], v16, s[4:7], s60 offen sc1
  s_add_u32 s54, s54, 1
  s_cmp_gt_u32 s54, 131072
  s_cbranch_scc1 end0
  s_branch pp_72
last_61:
  v_min_u32 v108, -2, v108
  buffer_store_dwordx2 v[108:109], v37, s[16:19], s70 offen offset:3072 sc1
  v_smfmac_f32_16x16x64_bf16 v[96:99], v[48:51], a[0:7], v22
  v_smfmac_f32_16x16x64_bf16 v[100:103], v[48:51], a[80:87], v22
  v_smfmac_f32_16x16x64_bf16 v[96:99], v[52:55], a[8:15], v22
  v_smfmac_f32_16x16x64_bf16 v[100:103], v[52:55], a[88:95], v22
  v_smfmac_f32_16x16x64_bf16 v[96:99], v[56:59], a[16:23], v22
  v_smfmac_f32_16x16x64_bf16 v[100:103], v[56:59], a[96:103], v22
  v_smfmac_f32_16x16x64_bf16 v[96:99], v[60:63], a[24:31], v22
  v_smfmac_f32_16x16x64_bf16 v[96:99], v[64:67], a[32:39], v22
  v_smfmac_f32_16x16x64_bf16 v[96:99], v[68:71], a[40:47], v22
  v_smfmac_f32_16x16x64_bf16 v[96:99], v[72:75], a[48:55], v22
  v_smfmac_f32_16x16x64_bf16 v[96:99], v[76:79], a[56:63], v22
  v_smfmac_f32_16x16x64_bf16 v[96:99], v[80:83], a[64:71], v22
  v_smfmac_f32_16x16x64_bf16 v[96:99], v[84:87], a[72:79], v22
  v_smfmac_f32_16x16x64_bf16 v[100:103], v[60:63], a[104:111], v22
  v_smfmac_f32_16x16x64_bf16 v[100:103], v[64:67], a[112:119], v22
  v_smfmac_f32_16x16x64_bf16 v[100:103], v[68:71], a[120:127], v22
  v_smfmac_f32_16x16x64_bf16 v[100:103], v[72:75], a[128:135], v22
  v_smfmac_f32_16x16x64_bf16 v[100:103], v[76:79], a[136:143], v22
  v_smfmac_f32_16x16x64_bf16 v[100:103], v[80:83], a[144:151], v22
  v_smfmac_f32_16x16x64_bf16 v[100:103], v[84:87], a[152:159], v22
  s_nop 7
  v_permlane32_swap_b32 v96, v100
  v_permlane32_swap_b32 v97, v101
  v_permlane32_swap_b32 v98, v102
  v_permlane32_swap_b32 v99, v103
  v_pk_add_f32 v[96:97], v[96:97], v[100:101]
  v_pk_add_f32 v[98:99], v[98:99], v[102:103]
  v_cvt_pk_bf16_f32 v100, v96, v97
  v_cvt_pk_bf16_f32 v101, v98, v99
  s_nop 0
  v_permlane32_swap_b32 v100, v102
  v_permlane32_swap_b32 v101, v103
  v_min_u32 v100, -2, v100
  buffer_store_dwordx4 v[100:103], v26, s[16:19], s70 offen sc1
  s_waitcnt vmcnt(0)
  s_barrier
  s_branch chain_done
E_30:
  v_add_u32 v190, 5120, v4
  ds_write_b64 v6, v[28:29]
  ds_write_b32 v13, v28
  ds_write_b32 v14, v28
  s_waitcnt vmcnt(0)
  ds_write_b128 v190, v[68:71] offset:0
  ds_write_b128 v190, v[72:75] offset:1024
  s_waitcnt lgkmcnt(0)
  s_add_u32 m0, s74, 8192
  s_add_u32 s21, s72, 0
  buffer_load_dwordx4 v32, s[16:19], s21 offen sc1 lds
  s_add_u32 m0, s74, 6144
  s_mul_i32 s21, s91, 3
  s_add_u32 s21, s21, s71
  buffer_load_dwordx4 v4, s[16:19], s21 offen sc1 lds
  s_xor_b32 s74, s74, 16384
  s_add_u32 s73, s73, 2097152
  s_xor_b32 s73, s73, 8192
  s_add_u32 s79, s79, 2097152
  s_xor_b32 s79, s79, 8192
  s_add_u32 s21, s72, 524288
  s_xor_b32 s72, s72, s21
  s_lshr_b32 s72, s72, 8
  s_and_b32 s72, s72, 8192
  s_xor_b32 s72, s72, s21
  s_add_u32 s71, s73, 4096
  s_mov_b32 s91, 1024
  s_sub_u32 s21, s73, 0
  s_cmp_lt_u32 s21, 125829120
  s_cselect_b32 s71, s71, s79
  s_cselect_b32 s91, s91, 65536
  s_branch mo_87
  .p2align 3
top_82:
  s_waitcnt vmcnt(1)
  ds_write_b128 v190, v[68:71] offset:0
  v_cmp_eq_u32 s[22:23], -1, v68
  s_waitcnt vmcnt(0)
  ds_write_b128 v190, v[72:75] offset:1024
  v_cmp_eq_u32 s[98:99], -1, v72
  s_or_b64 vcc, s[22:23], s[98:99]
  s_cbranch_scc1 mr_83
mo_87:
  s_barrier
  ds_read_b128 v[48:51], v4 offset:0
  ds_read_b128 v[52:55], v4 offset:1024
  v_smfmac_f32_16x16x64_bf16 v[92:95], v[68:71], v[216:223], v22
  ds_read_b128 v[56:59], v4 offset:2048
  v_smfmac_f32_16x16x64_bf16 v[88:91], v[68:71], a[200:207], v22
  ds_read_b128 v[60:63], v4 offset:3072
  v_smfmac_f32_16x16x64_bf16 v[92:95], v[72:75], v[224:231], v22
  ds_read_b128 v[64:67], v4 offset:4096
  v_smfmac_f32_16x16x64_bf16 v[88:91], v[72:75], a[208:215], v22
  s_waitcnt lgkmcnt(4)
  ds_read_b128 v[76:79], v4 offset:7168
  v_smfmac_f32_16x16x64_bf16 v[92:95], v[48:51], a[240:247], v22
  ds_read_b128 v[80:83], v4 offset:8192
  v_smfmac_f32_16x16x64_bf16 v[88:91], v[48:51], a[160:167], v22
  s_waitcnt lgkmcnt(5)
  ds_read_b128 v[84:87], v4 offset:9216
  v_smfmac_f32_16x16x64_bf16 v[92:95], v[52:55], a[248:255], v22
  v_smfmac_f32_16x16x64_bf16 v[88:91], v[52:55], a[168:175], v22
  s_waitcnt lgkmcnt(5)
  v_smfmac_f32_16x16x64_bf16 v[92:95], v[56:59], v[192:199], v22
  s_waitcnt lgkmcnt(4)
  v_smfmac_f32_16x16x64_bf16 v[92:95], v[60:63], v[200:207], v22
  s_waitcnt lgkmcnt(3)
  v_smfmac_f32_16x16x64_bf16 v[92:95], v[64:67], v[208:215], v22
  s_waitcnt lgkmcnt(2)
  v_smfmac_f32_16x16x64_bf16 v[92:95], v[76:79], v[232:239], v22
  s_waitcnt lgkmcnt(1)
  v_smfmac_f32_16x16x64_bf16 v[92:95], v[80:83], v[240:247], v22
  s_waitcnt lgkmcnt(0)
  v_smfmac_f32_16x16x64_bf16 v[92:95], v[84:87], v[248:255], v22
  v_smfmac_f32_16x16x64_bf16 v[88:91], v[56:59], a[176:183], v22
  v_smfmac_f32_16x16x64_bf16 v[88:91], v[60:63], a[184:191], v22
  v_smfmac_f32_16x16x64_bf16 v[88:91], v[64:67], a[192:199], v22
  v_permlane32_swap_b32 v92, v93
  v_smfmac_f32_16x16x64_bf16 v[88:91], v[76:79], a[216:223], v22
  v_permlane32_swap_b32 v94, v95
  v_smfmac_f32_16x16x64_bf16 v[88:91], v[80:83], a[224:231], v22
  v_permlane32_swap_b32 v93, v92
  v_smfmac_f32_16x16x64_bf16 v[88:91], v[84:87], a[232:239], v22
  v_permlane32_swap_b32 v95, v94
  v_pk_mul_f32 v[120:121], v[92:93], v[24:25] op_sel:[1,0] op_sel_hi:[0,1]
  v_pk_mul_f32 v[122:123], v[94:95], v[24:25] op_sel:[1,0] op_sel_hi:[0,1]
  s_nop 4
  v_pk_fma_f32 v[88:89], v[88:89], v[24:25], v[120:121]
  v_pk_fma_f32 v[90:91], v[90:91], v[24:25], v[122:123]
  v_cvt_pk_bf16_f32 v120, v88, v89
  v_cvt_pk_bf16_f32 v121, v90, v91
  ds_write_b64 v6, v[120:121]
  s_barrier
  ds_read_b64_tr_b16 v[104:105], v7 offset:0
  ds_read_b64_tr_b16 v[106:107], v7 offset:768
  ds_read_b64_tr_b16 v[108:109], v7 offset:1536
  s_waitcnt lgkmcnt(1)
  v_mfma_f32_16x16x32_bf16 v[120:123], v[104:107], v[104:107], 0
  s_waitcnt lgkmcnt(0)
  v_mfma_f32_16x16x32_bf16 v[120:123], v[108:111], v[108:111], v[120:123]
  s_mov_b64 exec, s[64:65]
  s_nop 6
  v_cmpx_o_f32 vcc, v120, v121
  v_cvt_pk_f16_f32 v120, v120, v121
  buffer_store_dword v120, v8, s[8:11], s56 offen
  v_cmpx_o_f32 vcc, v122, v123
  v_cvt_pk_f16_f32 v121, v122, v123
  buffer_store_dword v121, v8, s[8:11], s56 offen offset:128
  s_xor_b64 s[98:99], exec, s[64:65]
  s_mov_b64 exec, -1
  s_waitcnt lgkmcnt(0)
  s_barrier
  ds_read_b64_tr_b16 v[104:105], v7 offset:0
  ds_read_b64_tr_b16 v[106:107], v7 offset:768
  ds_read_b64_tr_b16 v[108:109], v7 offset:1536
  ds_read_b32 v27, v12 offset:12544
  ds_read_b64 v[140:141], v11
  s_waitcnt lgkmcnt(1)
  v_cmp_u_f32 vcc, v104, v106
  v_cmp_u_f32 s[22:23], v108, v27
  s_nop 1
  s_or_b64 vcc, vcc, s[22:23]
  s_cbranch_vccnz mn_84
mk_85:
  s_cmp_eq_u32 s52, 63
  s_cbranch_scc1 last_86
  s_cmp_lg_u64 s[98:99], 0
  s_cbranch_scc1 sf_88
sf_89:
  s_nop 15
  s_nop 10
  v_smfmac_f32_16x16x64_bf16 v[96:99], v[48:51], a[0:7], v22
  v_smfmac_f32_16x16x64_bf16 v[100:103], v[48:51], a[80:87], v22
  v_smfmac_f32_16x16x64_bf16 v[96:99], v[52:55], a[8:15], v22
  v_smfmac_f32_16x16x64_bf16 v[100:103], v[52:55], a[88:95], v22
  v_smfmac_f32_16x16x64_bf16 v[96:99], v[56:59], a[16:23], v22
  v_smfmac_f32_16x16x64_bf16 v[100:103], v[56:59], a[96:103], v22
  buffer_load_dwordx4 v[132:135], v10, s[8:11], s56 offen sc1
  v_smfmac_f32_16x16x64_bf16 v[96:99], v[60:63], a[24:31], v22
  buffer_load_dwordx4 v[124:127], v9, s[8:11], s56 offen sc1
  v_smfmac_f32_16x16x64_bf16 v[96:99], v[64:67], a[32:39], v22
  buffer_load_dwordx4 v[128:131], v9, s[8:11], s56 offen offset:1024 sc1
  v_smfmac_f32_16x16x64_bf16 v[96:99], v[68:71], a[40:47], v22
  v_smfmac_f32_16x16x64_bf16 v[96:99], v[72:75], a[48:55], v22
  v_smfmac_f32_16x16x64_bf16 v[96:99], v[76:79], a[56:63], v22
  v_smfmac_f32_16x16x64_bf16 v[96:99], v[80:83], a[64:71], v22
  v_smfmac_f32_16x16x64_bf16 v[96:99], v[84:87], a[72:79], v22
  v_smfmac_f32_16x16x64_bf16 v[100:103], v[60:63], a[104:111], v22
  v_smfmac_f32_16x16x64_bf16 v[100:103], v[64:67], a[112:119], v22
  v_smfmac_f32_16x16x64_bf16 v[100:103], v[68:71], a[120:127], v22
  v_smfmac_f32_16x16x64_bf16 v[100:103], v[72:75], a[128:135], v22
  v_cvt_pk_bf16_f32 v136, v96, v97
  v_smfmac_f32_16x16x64_bf16 v[100:103], v[76:79], a[136:143], v22
  v_cvt_pk_bf16_f32 v137, v98, v99
  v_smfmac_f32_16x16x64_bf16 v[100:103], v[80:83], a[144:151], v22
  v_smfmac_f32_16x16x64_bf16 v[100:103], v[84:87], a[152:159], v22
  s_nop 7
  v_cvt_pk_bf16_f32 v138, v100, v101
  v_cvt_pk_bf16_f32 v139, v102, v103
  s_waitcnt vmcnt(2) lgkmcnt(0)
  v_pk_add_f16 v164, v132, v133
  v_pk_add_f16 v165, v134, v135
  v_fma_mix_f32 v170, v164, 1.0, v165 op_sel:[0,0,0] op_sel_hi:[1,0,1]
  v_fma_mix_f32 v171, v164, 1.0, v165 op_sel:[1,0,1] op_sel_hi:[1,0,1]
  v_exp_f32 v176, v170
  v_exp_f32 v177, v171
  s_waitcnt vmcnt(1)
  v_cvt_pk_bf16_f32 v160, v176, v177
  v_pk_add_f16 v120, v124, v126
  v_pk_add_f16 v121, v125, v127
  v_mov_b32_dpp v161, v160 row_ror:8 row_mask:0xf bank_mask:0xf
  s_waitcnt vmcnt(0)
  v_pk_add_f16 v122, v128, v130
  v_mfma_f32_16x16x32_bf16 v[178:181], v[140:143], v[160:163], 0
  v_fma_mix_f32 v166, v120, 1.0, v122 op_sel:[0,0,0] op_sel_hi:[1,0,1]
  v_fma_mix_f32 v167, v120, 1.0, v122 op_sel:[1,0,1] op_sel_hi:[1,0,1]
  v_cmp_u_f32 vcc, v166, v170
  v_pk_add_f16 v123, v129, v131
  v_exp_f32 v172, v166
  v_mfma_f32_16x16x32_bf16 v[182:185], v[136:139], v[160:163], 0
  s_cbranch_vccnz sr_90
  v_exp_f32 v173, v167
  v_fma_mix_f32 v168, v121, 1.0, v123 op_sel:[0,0,0] op_sel_hi:[1,0,1]
  v_fma_mix_f32 v169, v121, 1.0, v123 op_sel:[1,0,1] op_sel_hi:[1,0,1]
  v_cvt_pk_bf16_f32 v156, v172, v173
  v_exp_f32 v174, v168
  v_exp_f32 v175, v169
  v_mov_b32_dpp v158, v156 row_ror:8 row_mask:0xf bank_mask:0xf
  v_cvt_pk_bf16_f32 v157, v174, v175
  v_mfma_f32_16x16x32_bf16 v[186:189], v[138:141], v[160:163], 0
  s_nop 0
  v_mov_b32_dpp v159, v157 row_ror:8 row_mask:0xf bank_mask:0xf
  s_nop 1
pv_91:
  v_mfma_f32_16x16x32_bf16 v[178:181], v[152:155], v[156:159], v[178:181]
  v_mfma_f32_16x16x32_bf16 v[182:185], v[144:147], v[156:159], v[182:185]
  v_mfma_f32_16x16x32_bf16 v[186:189], v[148:151], v[156:159], v[186:189]
  s_mov_b64 exec, s[62:63]
  s_nop 0
  v_rcp_f32 v164, v180
  v_cmp_ngt_f32 s[22:23], s80, v180
  v_cmp_ngt_f32 vcc, s80, v164
  v_pk_mul_f32 v[182:183], v[182:183], v[164:165] op_sel_hi:[1,0]
  v_pk_mul_f32 v[184:185], v[184:185], v[164:165] op_sel_hi:[1,0]
  v_pk_mul_f32 v[178:179], v[178:179], v[164:165] op_sel_hi:[1,0]
  v_pk_mul_f32 v[186:187], v[186:187], v[164:165] op_sel_hi:[1,0]
  v_pk_mul_f32 v[188:189], v[188:189], v[164:165] op_sel_hi:[1,0]
  v_cvt_pk_f16_f32 v64, v178, v179
  s_or_b64 vcc, vcc, s[22:23]
  s_cbranch_scc1 fx_93
fk_94:
  ds_write_b32 v14, v64
  v_cvt_pk_f16_f32 v60, v182, v183
  v_cvt_pk_f16_f32 v61, v184, v185
  v_cvt_pk_f16_f32 v62, v186, v187
  v_cvt_pk_f16_f32 v63, v188, v189
  ds_write_b128 v13, v[60:63]
  s_barrier
  s_mov_b64 exec, -1
  s_and_b32 s21, s52, 3
  s_cmp_lt_u32 s52, 58
  s_cselect_b32 s21, s21, 0
  s_cmp_lg_u32 s21, 0
  s_cbranch_scc1 fs_95
  v_mov_b32 v27, s52
  s_mov_b64 exec, 1
  buffer_store_dword v27, v23, s[12:15], s77 offen sc1
  s_mov_b64 exec, -1
fs_95:
  s_add_u32 m0, s74, 8192
  s_add_u32 s21, s72, 0
  buffer_load_dwordx4 v32, s[16:19], s21 offen sc1 lds
  s_add_u32 m0, s74, 6144
  s_mul_i32 s21, s91, 3
  s_add_u32 s21, s21, s71
  buffer_load_dwordx4 v4, s[16:19], s21 offen sc1 lds
  s_xor_b32 s74, s74, 16384
  s_add_u32 s73, s73, 2097152
  s_xor_b32 s73, s73, 8192
  s_add_u32 s79, s79, 2097152
  s_xor_b32 s79, s79, 8192
  s_add_u32 s21, s72, 524288
  s_xor_b32 s72, s72, s21
  s_lshr_b32 s72, s72, 8
  s_and_b32 s72, s72, 8192
  s_xor_b32 s72, s72, s21
  s_add_u32 s71, s73, 4096
  s_mov_b32 s91, 1024
  s_sub_u32 s21, s73, 0
  s_cmp_lt_u32 s21, 125829120
  s_cselect_b32 s71, s71, s79
  s_cselect_b32 s91, s91, 65536
  v_permlane32_swap_b32 v96, v100
  v_permlane32_swap_b32 v97, v101
  v_permlane32_swap_b32 v98, v102
  v_permlane32_swap_b32 v99, v103
  v_pk_add_f32 v[96:97], v[96:97], v[100:101]
  v_pk_add_f32 v[98:99], v[98:99], v[102:103]
  v_cvt_pk_bf16_f32 v100, v96, v97
  v_cvt_pk_bf16_f32 v101, v98, v99
  s_nop 0
  v_permlane32_swap_b32 v100, v102
  v_permlane32_swap_b32 v101, v103
  v_min_u32 v100, -2, v100
  s_nop 6
  buffer_store_dwordx4 v[100:103], v26, s[16:19], s70 offen sc1
  s_add_u32 s70, s70, 2097152
  s_xor_b32 s70, s70, 8192
  ds_read_b128 v[144:147], v18
  ds_read_b128 v[148:151], v18 offset:1024
  ds_read_b128 v[152:155], v19
  v_xor_b32 v18, 16384, v18
  v_xor_b32 v19, 16384, v19
  v_mov_b32 v88, 0
  v_mov_b32 v89, 0
  v_mov_b32 v90, 0
  v_mov_b32 v91, 0
  v_mov_b32 v92, 0
  v_mov_b32 v93, 0
  v_mov_b32 v94, 0
  v_mov_b32 v95, 0
  v_mov_b32 v96, 0
  v_mov_b32 v97, 0
  v_mov_b32 v98, 0
  v_mov_b32 v99, 0
  v_mov_b32 v100, 0
  v_mov_b32 v101, 0
  v_mov_b32 v102, 0
  v_mov_b32 v103, 0
  s_mov_b32 s81, 0
  s_waitcnt lgkmcnt(0)
  s_barrier
  s_mov_b64 exec, s[64:65]
  buffer_store_dword v28, v8, s[8:11], s57 offen
  buffer_store_dword v28, v8, s[8:11], s57 offen offset:128
  s_mov_b64 exec, -1
  ds_write_b128 v190, v[28:31] offset:0
  ds_write_b128 v190, v[28:31] offset:1024
  ds_write_b64 v6, v[28:29]
  s_mov_b64 exec, -1
  s_cmp_eq_u32 s78, 0
  s_cbranch_scc1 nt_97
  s_mov_b64 exec, s[62:63]
  buffer_store_dword v28, v17, s[8:11], s59 offen
  s_mov_b64 exec, -1
  s_sleep 3
  s_nop 1
  buffer_load_dwordx4 v[68:71], v16, s[4:7], s60 offen sc1
  s_sleep 3
  s_nop 1
  buffer_load_dwordx4 v[72:75], v16, s[4:7], s60 offen sc1
  s_waitcnt vmcnt(1)
  v_mfma_f32_16x16x32_f16 v[120:123], v[44:47], v[68:71], 0
  v_bitop3_b32 v27, v68, s61, 1 bitop3:0x28
  v_cmp_ne_u32 vcc, 0, v27
  s_nop 1
  s_cbranch_vccnz p2_100
  s_nop 2
pg_99:
  v_add_f32_dpp v120, v120, v120 row_ror:8 row_mask:0xf bank_mask:0xf
  v_add_f32_dpp v121, v121, v121 row_ror:8 row_mask:0xf bank_mask:0xf
  s_mov_b64 exec, s[62:63]
  v_cvt_pk_bf16_f32 v120, v120, v121
  v_min_u32 v120, -2, v120
  buffer_store_dword v120, v17, s[8:11], s55 offen
  s_mov_b64 exec, -1
nt_96:
  s_barrier
  s_mov_b32 s58, s55
  s_add_u32 s52, s52, 1
  ds_write_b32 v13, v28
  ds_write_b32 v14, v28
  s_and_b32 s21, s52, 3
  s_mul_i32 s56, s21, 122880
  s_add_u32 s21, s52, 1
  s_and_b32 s21, s21, 3
  s_mul_i32 s55, s21, 122880
  s_add_u32 s55, s55, s75
  s_add_u32 s21, s52, 2
  s_and_b32 s21, s21, 3
  s_mul_i32 s57, s21, 122880
  s_add_u32 s21, s52, 3
  s_and_b32 s21, s21, 3
  s_mul_i32 s59, s21, 122880
  s_add_u32 s59, s59, s75
  s_bfe_u32 s61, s52, 0x10002
  s_and_b32 s21, s52, 3
  s_lshl_b32 s60, s21, 18
  s_mov_b32 s54, 0
  s_sleep 2
  s_nop 10
  s_waitcnt lgkmcnt(0)
  buffer_load_dwordx4 v[68:71], v190, s[8:11], s58 offen offset:0 sc1
  buffer_load_dwordx4 v[72:75], v190, s[8:11], s58 offen offset:1024 sc1
  s_branch top_82
mr_83:
  s_mov_b64 exec, s[22:23]
  s_cbranch_execz ms_101
  buffer_load_dwordx4 v[68:71], v190, s[8:11], s58 offen offset:0 sc1
ms_101:
  s_mov_b64 exec, s[98:99]
  s_cbranch_execz ms_102
  buffer_load_dwordx4 v[72:75], v190, s[8:11], s58 offen offset:1024 sc1
ms_102:
  s_add_u32 s54, s54, 1
  s_cmp_gt_u32 s54, 131072
  s_cbranch_scc1 end0
  s_waitcnt vmcnt(0)
  s_mov_b64 exec, s[22:23]
  ds_write_b128 v190, v[68:71] offset:0
  v_cmp_eq_u32 s[22:23], -1, v68
  s_mov_b64 exec, s[98:99]
  ds_write_b128 v190, v[72:75] offset:1024
  v_cmp_eq_u32 s[98:99], -1, v72
  s_mov_b64 exec, -1
  s_or_b64 vcc, s[22:23], s[98:99]
  s_cbranch_scc1 mr_83
  s_branch mo_87
sf_88:
  s_waitcnt lgkmcnt(1)
  v_mfma_f32_16x16x32_bf16 v[120:123], v[104:107], v[104:107], 0
  s_waitcnt lgkmcnt(0)
  v_mfma_f32_16x16x32_bf16 v[120:123], v[108:111], v[108:111], v[120:123]
  s_mov_b64 exec, s[64:65]
  s_nop 6
  v_cvt_pk_f16_f32 v120, v120, v121
  buffer_store_dword v120, v8, s[8:11], s56 offen
  v_cvt_pk_f16_f32 v121, v122, v123
  buffer_store_dword v121, v8, s[8:11], s56 offen offset:128
  s_mov_b64 exec, -1
  s_branch sf_89
mn_84:
  s_bitcmp1_b32 s81, 1
  s_cbranch_scc1 mk_85
  s_or_b32 s81, s81, 2
  s_nop 7
  v_mov_b32 v88, 0
  v_mov_b32 v89, 0
  v_mov_b32 v90, 0
  v_mov_b32 v91, 0
  v_mov_b32 v92, 0
  v_mov_b32 v93, 0
  v_mov_b32 v94, 0
  v_mov_b32 v95, 0
  v_mov_b32 v96, 0
  v_mov_b32 v97, 0
  v_mov_b32 v98, 0
  v_mov_b32 v99, 0
  v_mov_b32 v100, 0
  v_mov_b32 v101, 0
  v_mov_b32 v102, 0
  v_mov_b32 v103, 0
  s_cmp_eq_u32 s52, 0
  s_cbranch_scc1 mx_104
mx_103:
  buffer_load_dwordx4 v[68:71], v190, s[8:11], s58 offen offset:0 sc1
  buffer_load_dwordx4 v[72:75], v190, s[8:11], s58 offen offset:1024 sc1
  s_add_u32 s54, s54, 1
  s_cmp_gt_u32 s54, 131072
  s_cbranch_scc1 end0
  s_waitcnt vmcnt(0)
  v_max3_u32 v27, v68, v69, v70
  v_max3_u32 v27, v27, v71, v72
  v_max3_u32 v27, v27, v73, v74
  v_max3_u32 v27, v27, v75, v75
  v_cmp_eq_u32 vcc, -1, v27
  s_nop 1
  s_cbranch_vccnz mx_103
  ds_write_b128 v190, v[68:71] offset:0
  ds_write_b128 v190, v[72:75] offset:1024
mx_104:
  s_waitcnt lgkmcnt(0)
  s_branch mo_87
sr_90:
  s_mov_b32 s54, 0
sr_105:
  s_mov_b64 exec, vcc
  buffer_load_dwordx4 v[124:127], v9, s[8:11], s56 offen sc1
  buffer_load_dwordx4 v[128:131], v9, s[8:11], s56 offen offset:1024 sc1
  buffer_load_dwordx4 v[132:135], v10, s[8:11], s56 offen sc1
  s_mov_b64 exec, -1
  s_add_u32 s54, s54, 1
  s_cmp_gt_u32 s54, 131072
  s_cbranch_scc1 end0
  s_waitcnt vmcnt(0)
  v_pk_add_f16 v164, v132, v133
  v_pk_add_f16 v165, v134, v135
  v_pk_add_f16 v120, v124, v126
  v_pk_add_f16 v122, v128, v130
  v_fma_mix_f32 v170, v164, 1.0, v165 op_sel:[0,0,0] op_sel_hi:[1,0,1]
  v_fma_mix_f32 v166, v120, 1.0, v122 op_sel:[0,0,0] op_sel_hi:[1,0,1]
  v_pk_add_f16 v121, v125, v127
  v_cmp_u_f32 vcc, v166, v170
  v_pk_add_f16 v123, v129, v131
  v_fma_mix_f32 v171, v164, 1.0, v165 op_sel:[1,0,1] op_sel_hi:[1,0,1]
  v_fma_mix_f32 v167, v120, 1.0, v122 op_sel:[1,0,1] op_sel_hi:[1,0,1]
  v_fma_mix_f32 v168, v121, 1.0, v123 op_sel:[0,0,0] op_sel_hi:[1,0,1]
  v_fma_mix_f32 v169, v121, 1.0, v123 op_sel:[1,0,1] op_sel_hi:[1,0,1]
  s_cbranch_vccz ex_92
  s_and_b32 s21, s54, 31
  s_cbranch_scc1 sr_105
  v_max3_u32 v27, v124, v126, v128
  v_max3_u32 v27, v27, v130, v132
  v_max3_u32 v27, v27, v133, v134
  v_max3_u32 v27, v27, v135, v135
  v_cmp_eq_u32 vcc, -1, v27
  s_nop 1
  s_cbranch_vccnz sr_105
ex_92:
  v_exp_f32 v176, v170
  v_exp_f32 v177, v171
  v_exp_f32 v172, v166
  v_cvt_pk_bf16_f32 v160, v176, v177
  v_exp_f32 v173, v167
  v_exp_f32 v174, v168
  v_mov_b32_dpp v161, v160 row_ror:8 row_mask:0xf bank_mask:0xf
  v_cvt_pk_bf16_f32 v156, v172, v173
  v_exp_f32 v175, v169
  v_mfma_f32_16x16x32_bf16 v[178:181], v[140:143], v[160:163], 0
  v_mov_b32_dpp v158, v156 row_ror:8 row_mask:0xf bank_mask:0xf
  v_cvt_pk_bf16_f32 v157, v174, v175
  v_mfma_f32_16x16x32_bf16 v[182:185], v[136:139], v[160:163], 0
  s_nop 0
  v_mov_b32_dpp v159, v157 row_ror:8 row_mask:0xf bank_mask:0xf
  v_mfma_f32_16x16x32_bf16 v[186:189], v[138:141], v[160:163], 0
  s_branch pv_91
fx_93:
  s_bitcmp1_b32 s81, 0
  s_cbranch_scc1 fk_94
  s_or_b32 s81, s81, 1
  s_mov_b64 exec, -1
  v_max3_f32 v164, v166, v167, v168
  v_max3_f32 v165, v169, v170, v171
  v_max_f32 v164, v164, v165
  s_nop 1
  v_max_f32_dpp v164, v164, v164 row_ror:8 row_mask:0xf bank_mask:0xf
  v_mov_b32 v165, v164
  s_nop 1
  v_permlane32_swap_b32 v164, v165
  v_max_f32 v164, v164, v165
  v_mov_b32 v165, v164
  s_nop 1
  v_permlane16_swap_b32 v164, v165
  v_max_f32 v164, v164, v165
  v_sub_f32 v166, v166, v164
  v_sub_f32 v167, v167, v164
  v_sub_f32 v168, v168, v164
  v_sub_f32 v169, v169, v164
  v_sub_f32 v170, v170, v164
  v_sub_f32 v171, v171, v164
  s_branch ex_92
nt_97:
  s_branch nt_96
p2_100:
  s_mov_b32 s54, 0
  buffer_load_dwordx4 v[68:71], v16, s[4:7], s60 offen sc1
  s_waitcnt vmcnt(1)
  v_mfma_f32_16x16x32_f16 v[120:123], v[44:47], v[72:75], 0
  v_bitop3_b32 v27, v72, s61, 1 bitop3:0x28
  v_cmp_ne_u32 vcc, 0, v27
  s_nop 1
  s_cbranch_vccz pg_99
  buffer_load_dwordx4 v[72:75], v16, s[4:7], s60 offen sc1
pp_98:
  s_waitcnt vmcnt(1)
  v_mfma_f32_16x16x32_f16 v[120:123], v[44:47], v[68:71], 0
  v_bitop3_b32 v27, v68, s61, 1 bitop3:0x28
  v_cmp_ne_u32 vcc, 0, v27
  s_nop 1
  s_cbranch_vccz pg_99
  buffer_load_dwordx4 v[68:71], v16, s[4:7], s60 offen sc1
  s_waitcnt vmcnt(1)
  v_mfma_f32_16x16x32_f16 v[120:123], v[44:47], v[72:75], 0
  v_bitop3_b32 v27, v72, s61, 1 bitop3:0x28
  v_cmp_ne_u32 vcc, 0, v27
  s_nop 1
  s_cbranch_vccz pg_99
  buffer_load_dwordx4 v[72:75], v16, s[4:7], s60 offen sc1
  s_add_u32 s54, s54, 1
  s_cmp_gt_u32 s54, 131072
  s_cbranch_scc1 end0
  s_branch pp_98
last_86:
  v_smfmac_f32_16x16x64_bf16 v[96:99], v[48:51], a[0:7], v22
  v_smfmac_f32_16x16x64_bf16 v[100:103], v[48:51], a[80:87], v22
  v_smfmac_f32_16x16x64_bf16 v[96:99], v[52:55], a[8:15], v22
  v_smfmac_f32_16x16x64_bf16 v[100:103], v[52:55], a[88:95], v22
  v_smfmac_f32_16x16x64_bf16 v[96:99], v[56:59], a[16:23], v22
  v_smfmac_f32_16x16x64_bf16 v[100:103], v[56:59], a[96:103], v22
  v_smfmac_f32_16x16x64_bf16 v[96:99], v[60:63], a[24:31], v22
  v_smfmac_f32_16x16x64_bf16 v[96:99], v[64:67], a[32:39], v22
  v_smfmac_f32_16x16x64_bf16 v[96:99], v[68:71], a[40:47], v22
  v_smfmac_f32_16x16x64_bf16 v[96:99], v[72:75], a[48:55], v22
  v_smfmac_f32_16x16x64_bf16 v[96:99], v[76:79], a[56:63], v22
  v_smfmac_f32_16x16x64_bf16 v[96:99], v[80:83], a[64:71], v22
  v_smfmac_f32_16x16x64_bf16 v[96:99], v[84:87], a[72:79], v22
  v_smfmac_f32_16x16x64_bf16 v[100:103], v[60:63], a[104:111], v22
  v_smfmac_f32_16x16x64_bf16 v[100:103], v[64:67], a[112:119], v22
  v_smfmac_f32_16x16x64_bf16 v[100:103], v[68:71], a[120:127], v22
  v_smfmac_f32_16x16x64_bf16 v[100:103], v[72:75], a[128:135], v22
  v_smfmac_f32_16x16x64_bf16 v[100:103], v[76:79], a[136:143], v22
  v_smfmac_f32_16x16x64_bf16 v[100:103], v[80:83], a[144:151], v22
  v_smfmac_f32_16x16x64_bf16 v[100:103], v[84:87], a[152:159], v22
  s_nop 7
  v_permlane32_swap_b32 v96, v100
  v_permlane32_swap_b32 v97, v101
  v_permlane32_swap_b32 v98, v102
  v_permlane32_swap_b32 v99, v103
  v_pk_add_f32 v[96:97], v[96:97], v[100:101]
  v_pk_add_f32 v[98:99], v[98:99], v[102:103]
  v_cvt_pk_bf16_f32 v100, v96, v97
  v_cvt_pk_bf16_f32 v101, v98, v99
  s_nop 0
  v_permlane32_swap_b32 v100, v102
  v_permlane32_swap_b32 v101, v103
  v_min_u32 v100, -2, v100
  buffer_store_dwordx4 v[100:103], v26, s[16:19], s70 offen sc1
  s_waitcnt vmcnt(0)
  s_barrier
  s_branch chain_done
E_32:
  v_add_u32 v190, 7168, v4
  ds_write_b32 v13, v28
  ds_write_b32 v14, v28
  s_waitcnt vmcnt(0)
  ds_write_b128 v190, v[76:79] offset:0
  ds_write_b128 v190, v[80:83] offset:1024
  ds_write_b128 v190, v[84:87] offset:2048
  s_waitcnt lgkmcnt(0)
  s_branch mo_112
  .p2align 3
top_107:
  s_waitcnt vmcnt(2)
  ds_write_b128 v190, v[76:79] offset:0
  v_cmp_eq_u32 s[22:23], -1, v76
  s_waitcnt vmcnt(1)
  ds_write_b128 v190, v[80:83] offset:1024
  v_cmp_eq_u32 s[98:99], -1, v80
  s_waitcnt vmcnt(0)
  ds_write_b128 v190, v[84:87] offset:2048
  v_cmp_eq_u32 s[100:101], -1, v84
  s_or_b64 vcc, s[22:23], s[98:99]
  s_or_b64 vcc, vcc, s[100:101]
  s_cbranch_scc1 mr_108
mo_112:
  s_barrier
  ds_read_b128 v[48:51], v4 offset:0
  ds_read_b128 v[52:55], v4 offset:1024
  v_smfmac_f32_16x16x64_bf16 v[92:95], v[76:79], v[232:239], v22
  ds_read_b128 v[56:59], v4 offset:2048
  ds_read_b128 v[60:63], v4 offset:3072
  v_smfmac_f32_16x16x64_bf16 v[88:91], v[76:79], a[216:223], v22
  s_add_u32 m0, s74, 0
  s_add_u32 s21, s79, 0
  buffer_load_dwordx4 v4, s[16:19], s21 offen offset:1024 sc1 lds
  v_smfmac_f32_16x16x64_bf16 v[92:95], v[80:83], v[240:247], v22
  ds_read_b128 v[64:67], v4 offset:4096
  ds_read_b128 v[68:71], v4 offset:5120
  s_add_u32 s22, s52, 3
  s_min_u32 s22, s22, 64
  v_smfmac_f32_16x16x64_bf16 v[88:91], v[80:83], a[224:231], v22
  s_add_u32 m0, s74, 2048
  s_add_u32 s21, s79, 65536
  buffer_load_dwordx4 v4, s[16:19], s21 offen offset:1024 sc1 lds
  v_cmp_gt_u32 vcc, s22, v42
  v_smfmac_f32_16x16x64_bf16 v[92:95], v[84:87], v[248:255], v22
  ds_read_b128 v[72:75], v4 offset:6144
  s_cbranch_vccnz kw_113
kv_114:
  v_smfmac_f32_16x16x64_bf16 v[88:91], v[84:87], a[232:239], v22
  s_waitcnt lgkmcnt(6)
  s_add_u32 m0, s74, 10240
  s_nop 0
  buffer_load_dwordx4 v4, s[16:19], s73 offen offset:0 sc1 lds
  v_smfmac_f32_16x16x64_bf16 v[92:95], v[48:51], a[240:247], v22
  v_smfmac_f32_16x16x64_bf16 v[88:91], v[48:51], a[160:167], v22
  s_waitcnt lgkmcnt(5)
  s_add_u32 m0, s74, 10240
  s_nop 0
  buffer_load_dwordx4 v4, s[16:19], s73 offen offset:1024 sc1 lds
  v_smfmac_f32_16x16x64_bf16 v[92:95], v[52:55], a[248:255], v22
  s_waitcnt lgkmcnt(4)
  v_smfmac_f32_16x16x64_bf16 v[92:95], v[56:59], v[192:199], v22
  s_waitcnt lgkmcnt(3)
  s_add_u32 m0, s74, 10240
  s_nop 0
  buffer_load_dwordx4 v4, s[16:19], s73 offen offset:2048 sc1 lds
  v_smfmac_f32_16x16x64_bf16 v[92:95], v[60:63], v[200:207], v22
  s_waitcnt lgkmcnt(2)
  v_smfmac_f32_16x16x64_bf16 v[92:95], v[64:67], v[208:215], v22
  s_waitcnt lgkmcnt(1)
  s_add_u32 m0, s74, 0
  s_mul_i32 s21, s91, 0
  s_add_u32 s21, s21, s71
  buffer_load_dwordx4 v4, s[16:19], s21 offen sc1 lds
  v_smfmac_f32_16x16x64_bf16 v[92:95], v[68:71], v[216:223], v22
  s_waitcnt lgkmcnt(0)
  v_smfmac_f32_16x16x64_bf16 v[92:95], v[72:75], v[224:231], v22
  s_add_u32 m0, s74, 2048
  s_mul_i32 s21, s91, 1
  s_add_u32 s21, s21, s71
  buffer_load_dwordx4 v4, s[16:19], s21 offen sc1 lds
  v_smfmac_f32_16x16x64_bf16 v[88:91], v[52:55], a[168:175], v22
  v_smfmac_f32_16x16x64_bf16 v[88:91], v[56:59], a[176:183], v22
  v_smfmac_f32_16x16x64_bf16 v[88:91], v[60:63], a[184:191], v22
  v_cvt_pk_bf16_f32 v122, v92, v93
  v_smfmac_f32_16x16x64_bf16 v[88:91], v[64:67], a[192:199], v22
  v_cvt_pk_bf16_f32 v123, v94, v95
  s_barrier
  v_smfmac_f32_16x16x64_bf16 v[88:91], v[68:71], a[200:207], v22
  ds_write_b64 v12, v[122:123] offset:13056
  v_smfmac_f32_16x16x64_bf16 v[88:91], v[72:75], a[208:215], v22
  v_smfmac_f32_16x16x64_bf16 v[96:99], v[48:51], a[0:7], v22
  v_smfmac_f32_16x16x64_bf16 v[100:103], v[48:51], a[80:87], v22
  v_smfmac_f32_16x16x64_bf16 v[96:99], v[52:55], a[8:15], v22
  v_cvt_pk_bf16_f32 v120, v88, v89
  v_cvt_pk_bf16_f32 v121, v90, v91
  ds_write_b64 v12, v[120:121] offset:12544
  v_smfmac_f32_16x16x64_bf16 v[100:103], v[52:55], a[88:95], v22
  s_waitcnt lgkmcnt(0)
  s_barrier
  ds_read_b64_tr_b16 v[104:105], v7 offset:0
  ds_read_b64_tr_b16 v[106:107], v7 offset:768
  ds_read_b64_tr_b16 v[108:109], v7 offset:1536
  ds_read_b32 v27, v12 offset:12544
  ds_read_b64 v[140:141], v11
  s_waitcnt lgkmcnt(1)
  v_cmp_u_f32 vcc, v104, v106
  v_cmp_u_f32 s[22:23], v108, v27
  s_nop 1
  s_or_b64 vcc, vcc, s[22:23]
  s_cbranch_vccnz mn_109
mk_110:
  s_cmp_eq_u32 s52, 63
  s_cbranch_scc1 last_111
  v_permlane32_swap_b32 v88, v92
  v_permlane32_swap_b32 v89, v93
  v_permlane32_swap_b32 v90, v94
  v_permlane32_swap_b32 v91, v95
  v_pk_add_f32 v[88:89], v[88:89], v[92:93]
  v_pk_add_f32 v[90:91], v[90:91], v[94:95]
  v_cvt_pk_bf16_f32 v92, v88, v89
  v_cvt_pk_bf16_f32 v93, v90, v91
  v_min_u32 v92, -2, v92
  s_nop 0
  v_smfmac_f32_16x16x64_bf16 v[96:99], v[56:59], a[16:23], v22
  v_smfmac_f32_16x16x64_bf16 v[100:103], v[56:59], a[96:103], v22
  v_smfmac_f32_16x16x64_bf16 v[96:99], v[60:63], a[24:31], v22
  v_smfmac_f32_16x16x64_bf16 v[96:99], v[64:67], a[32:39], v22
  v_smfmac_f32_16x16x64_bf16 v[96:99], v[68:71], a[40:47], v22
  v_smfmac_f32_16x16x64_bf16 v[96:99], v[72:75], a[48:55], v22
  v_smfmac_f32_16x16x64_bf16 v[96:99], v[76:79], a[56:63], v22
  v_smfmac_f32_16x16x64_bf16 v[96:99], v[80:83], a[64:71], v22
  v_smfmac_f32_16x16x64_bf16 v[96:99], v[84:87], a[72:79], v22
  v_smfmac_f32_16x16x64_bf16 v[100:103], v[60:63], a[104:111], v22
  v_smfmac_f32_16x16x64_bf16 v[100:103], v[64:67], a[112:119], v22
  buffer_load_dwordx4 v[132:135], v10, s[8:11], s56 offen sc1
  v_smfmac_f32_16x16x64_bf16 v[100:103], v[68:71], a[120:127], v22
  buffer_load_dwordx4 v[124:127], v9, s[8:11], s56 offen sc1
  v_smfmac_f32_16x16x64_bf16 v[100:103], v[72:75], a[128:135], v22
  buffer_load_dwordx4 v[128:131], v9, s[8:11], s56 offen offset:1024 sc1
  v_cvt_pk_bf16_f32 v136, v96, v97
  v_smfmac_f32_16x16x64_bf16 v[100:103], v[76:79], a[136:143], v22
  v_cvt_pk_bf16_f32 v137, v98, v99
  v_smfmac_f32_16x16x64_bf16 v[100:103], v[80:83], a[144:151], v22
  v_smfmac_f32_16x16x64_bf16 v[100:103], v[84:87], a[152:159], v22
  s_nop 7
  v_cvt_pk_bf16_f32 v138, v100, v101
  v_cvt_pk_bf16_f32 v139, v102, v103
  v_permlane32_swap_b32 v96, v100
  v_permlane32_swap_b32 v97, v101
  v_permlane32_swap_b32 v98, v102
  v_permlane32_swap_b32 v99, v103
  v_pk_add_f32 v[96:97], v[96:97], v[100:101]
  v_pk_add_f32 v[98:99], v[98:99], v[102:103]
  v_cvt_pk_bf16_f32 v100, v96, v97
  v_cvt_pk_bf16_f32 v101, v98, v99
  s_nop 0
  v_permlane32_swap_b32 v100, v102
  v_permlane32_swap_b32 v101, v103
  v_min_u32 v100, -2, v100
  s_waitcnt vmcnt(2) lgkmcnt(0)
  v_pk_add_f16 v164, v132, v133
  v_pk_add_f16 v165, v134, v135
  v_fma_mix_f32 v170, v164, 1.0, v165 op_sel:[0,0,0] op_sel_hi:[1,0,1]
  v_fma_mix_f32 v171, v164, 1.0, v165 op_sel:[1,0,1] op_sel_hi:[1,0,1]
  v_exp_f32 v176, v170
  v_exp_f32 v177, v171
  s_waitcnt vmcnt(1)
  v_cvt_pk_bf16_f32 v160, v176, v177
  v_pk_add_f16 v120, v124, v126
  v_pk_add_f16 v121, v125, v127
  v_mov_b32_dpp v161, v160 row_ror:8 row_mask:0xf bank_mask:0xf
  s_waitcnt vmcnt(0)
  v_pk_add_f16 v122, v128, v130
  v_mfma_f32_16x16x32_bf16 v[178:181], v[140:143], v[160:163], 0
  v_fma_mix_f32 v166, v120, 1.0, v122 op_sel:[0,0,0] op_sel_hi:[1,0,1]
  v_fma_mix_f32 v167, v120, 1.0, v122 op_sel:[1,0,1] op_sel_hi:[1,0,1]
  v_cmp_u_f32 vcc, v166, v170
  v_pk_add_f16 v123, v129, v131
  v_exp_f32 v172, v166
  v_mfma_f32_16x16x32_bf16 v[182:185], v[136:139], v[160:163], 0
  s_cbranch_vccnz sr_117
  v_exp_f32 v173, v167
  v_fma_mix_f32 v168, v121, 1.0, v123 op_sel:[0,0,0] op_sel_hi:[1,0,1]
  v_fma_mix_f32 v169, v121, 1.0, v123 op_sel:[1,0,1] op_sel_hi:[1,0,1]
  v_cvt_pk_bf16_f32 v156, v172, v173
  v_exp_f32 v174, v168
  v_exp_f32 v175, v169
  v_mov_b32_dpp v158, v156 row_ror:8 row_mask:0xf bank_mask:0xf
  v_cvt_pk_bf16_f32 v157, v174, v175
  v_mfma_f32_16x16x32_bf16 v[186:189], v[138:141], v[160:163], 0
  s_nop 0
  v_mov_b32_dpp v159, v157 row_ror:8 row_mask:0xf bank_mask:0xf
  s_nop 1
pv_118:
  v_mfma_f32_16x16x32_bf16 v[178:181], v[152:155], v[156:159], v[178:181]
  v_mfma_f32_16x16x32_bf16 v[182:185], v[144:147], v[156:159], v[182:185]
  v_mfma_f32_16x16x32_bf16 v[186:189], v[148:151], v[156:159], v[186:189]
  s_mov_b64 exec, s[62:63]
  s_nop 0
  v_rcp_f32 v164, v180
  v_cmp_ngt_f32 s[22:23], s80, v180
  v_cmp_ngt_f32 vcc, s80, v164
  v_pk_mul_f32 v[182:183], v[182:183], v[164:165] op_sel_hi:[1,0]
  v_pk_mul_f32 v[184:185], v[184:185], v[164:165] op_sel_hi:[1,0]
  v_pk_mul_f32 v[178:179], v[178:179], v[164:165] op_sel_hi:[1,0]
  v_pk_mul_f32 v[186:187], v[186:187], v[164:165] op_sel_hi:[1,0]
  v_pk_mul_f32 v[188:189], v[188:189], v[164:165] op_sel_hi:[1,0]
  v_cvt_pk_f16_f32 v64, v178, v179
  s_or_b64 vcc, vcc, s[22:23]
  s_cbranch_scc1 fx_120
fk_121:
  ds_write_b32 v14, v64
  v_cvt_pk_f16_f32 v60, v182, v183
  v_cvt_pk_f16_f32 v61, v184, v185
  v_cvt_pk_f16_f32 v62, v186, v187
  v_cvt_pk_f16_f32 v63, v188, v189
  ds_write_b128 v13, v[60:63]
  s_mov_b64 exec, s[66:67]
  s_barrier
  ds_read_b128 v[166:169], v4 offset:13824
  ds_read_b128 v[170:173], v4 offset:14464
  ds_read_b128 v[174:177], v4 offset:15104
  ds_read_b128 v[178:181], v4 offset:15744
  s_waitcnt lgkmcnt(2)
  v_pk_add_f16 v166, v166, v170
  v_pk_add_f16 v167, v167, v171
  v_pk_add_f16 v168, v168, v172
  v_pk_add_f16 v169, v169, v173
  s_waitcnt lgkmcnt(1)
  v_pk_add_f16 v166, v166, v174
  v_pk_add_f16 v167, v167, v175
  v_pk_add_f16 v168, v168, v176
  v_pk_add_f16 v169, v169, v177
  s_waitcnt lgkmcnt(0)
  v_pk_add_f16 v166, v166, v178
  v_cmpx_o_f16 vcc, v166, v166
  v_pk_add_f16 v167, v167, v179
  v_pk_add_f16 v168, v168, v180
  v_pk_add_f16 v169, v169, v181
  v_and_or_b32 v166, v166, -2, s61
  buffer_store_dwordx4 v[166:169], v15, s[4:7], s60 offen sc1
  s_xor_b64 s[98:99], exec, s[66:67]
  s_mov_b64 exec, -1
  buffer_store_dwordx4 v[100:103], v26, s[16:19], s70 offen sc1
  buffer_store_dwordx2 v[92:93], v43, s[16:19], s70 offen sc1
  s_add_u32 s70, s70, 2097152
  s_xor_b32 s70, s70, 8192
  ds_read_b128 v[144:147], v18
  ds_read_b128 v[148:151], v18 offset:1024
  ds_read_b128 v[152:155], v19
  v_xor_b32 v18, 16384, v18
  v_xor_b32 v19, 16384, v19
  v_mov_b32 v88, 0
  v_mov_b32 v89, 0
  v_mov_b32 v90, 0
  v_mov_b32 v91, 0
  v_mov_b32 v92, 0
  v_mov_b32 v93, 0
  v_mov_b32 v94, 0
  v_mov_b32 v95, 0
  v_mov_b32 v96, 0
  v_mov_b32 v97, 0
  v_mov_b32 v98, 0
  v_mov_b32 v99, 0
  v_mov_b32 v100, 0
  v_mov_b32 v101, 0
  v_mov_b32 v102, 0
  v_mov_b32 v103, 0
  s_mov_b32 s81, 0
  s_waitcnt lgkmcnt(0)
  s_barrier
  s_cmp_lg_u64 s[98:99], 0
  s_cbranch_scc1 pf_122
pf_123:
  s_xor_b32 s74, s74, 16384
  s_add_u32 s73, s73, 2097152
  s_xor_b32 s73, s73, 8192
  s_add_u32 s79, s79, 2097152
  s_xor_b32 s79, s79, 8192
  s_add_u32 s21, s72, 524288
  s_xor_b32 s72, s72, s21
  s_lshr_b32 s72, s72, 8
  s_and_b32 s72, s72, 8192
  s_xor_b32 s72, s72, s21
  s_add_u32 s71, s73, 4096
  s_mov_b32 s91, 1024
  s_sub_u32 s21, s73, 0
  s_cmp_lt_u32 s21, 125829120
  s_cselect_b32 s71, s71, s79
  s_cselect_b32 s91, s91, 65536
  v_mov_b32 v166, s52
  s_add_u32 s22, s52, 5
  s_min_u32 s22, s22, 64
  v_cmp_gt_u32 vcc, s22, v42
  s_cbranch_vccz fv_125
  buffer_load_dword v42, v41, s[12:15], s76 offen sc1
fv_125:
  ds_write_b128 v190, v[28:31] offset:0
  ds_write_b128 v190, v[28:31] offset:1024
  ds_write_b128 v190, v[28:31] offset:2048
nt_124:
  s_barrier
  s_mov_b32 s58, s55
  s_add_u32 s52, s52, 1
  ds_write_b32 v13, v28
  ds_write_b32 v14, v28
  s_and_b32 s21, s52, 3
  s_mul_i32 s56, s21, 122880
  s_add_u32 s21, s52, 1
  s_and_b32 s21, s21, 3
  s_mul_i32 s55, s21, 122880
  s_add_u32 s55, s55, s75
  s_add_u32 s21, s52, 2
  s_and_b32 s21, s21, 3
  s_mul_i32 s57, s21, 122880
  s_add_u32 s21, s52, 3
  s_and_b32 s21, s21, 3
  s_mul_i32 s59, s21, 122880
  s_add_u32 s59, s59, s75
  s_bfe_u32 s61, s52, 0x10002
  s_and_b32 s21, s52, 3
  s_lshl_b32 s60, s21, 18
  s_mov_b32 s54, 0
  s_sleep 2
  s_nop 10
  s_waitcnt lgkmcnt(0)
  buffer_load_dwordx4 v[76:79], v190, s[8:11], s58 offen offset:0 sc1
  buffer_load_dwordx4 v[80:83], v190, s[8:11], s58 offen offset:1024 sc1
  buffer_load_dwordx4 v[84:87], v190, s[8:11], s58 offen offset:2048 sc1
  s_branch top_107
mr_108:
  s_mov_b64 exec, s[22:23]
  s_cbranch_execz ms_126
  buffer_load_dwordx4 v[76:79], v190, s[8:11], s58 offen offset:0 sc1
ms_126:
  s_mov_b64 exec, s[98:99]
  s_cbranch_execz ms_127
  buffer_load_dwordx4 v[80:83], v190, s[8:11], s58 offen offset:1024 sc1
ms_127:
  s_mov_b64 exec, s[100:101]
  s_cbranch_execz ms_128
  buffer_load_dwordx4 v[84:87], v190, s[8:11], s58 offen offset:2048 sc1
ms_128:
  s_add_u32 s54, s54, 1
  s_cmp_gt_u32 s54, 131072
  s_cbranch_scc1 end0
  s_waitcnt vmcnt(0)
  s_mov_b64 exec, s[22:23]
  ds_write_b128 v190, v[76:79] offset:0
  v_cmp_eq_u32 s[22:23], -1, v76
  s_mov_b64 exec, s[98:99]
  ds_write_b128 v190, v[80:83] offset:1024
  v_cmp_eq_u32 s[98:99], -1, v80
  s_mov_b64 exec, s[100:101]
  ds_write_b128 v190, v[84:87] offset:2048
  v_cmp_eq_u32 s[100:101], -1, v84
  s_mov_b64 exec, -1
  s_or_b64 vcc, s[22:23], s[98:99]
  s_or_b64 vcc, vcc, s[100:101]
  s_cbranch_scc1 mr_108
  s_branch mo_112
kw_113:
  s_mov_b32 s101, 0
wm_129:
  buffer_load_dword v42, v41, s[12:15], s76 offen sc1
  s_add_u32 s101, s101, 1
  s_cmp_gt_u32 s101, 131072
  s_cbranch_scc1 end0
  s_waitcnt vmcnt(0)
  v_cmp_gt_u32 vcc, s22, v42
  v_readfirstlane_b32 s100, v42
  s_nop 0
  s_cbranch_vccz wm_130
  s_sleep 1
  s_branch wm_129
wm_130:
  s_branch kv_114
mn_109:
  s_bitcmp1_b32 s81, 1
  s_cbranch_scc1 mk_110
  s_or_b32 s81, s81, 2
  s_nop 7
  v_mov_b32 v88, 0
  v_mov_b32 v89, 0
  v_mov_b32 v90, 0
  v_mov_b32 v91, 0
  v_mov_b32 v92, 0
  v_mov_b32 v93, 0
  v_mov_b32 v94, 0
  v_mov_b32 v95, 0
  v_mov_b32 v96, 0
  v_mov_b32 v97, 0
  v_mov_b32 v98, 0
  v_mov_b32 v99, 0
  v_mov_b32 v100, 0
  v_mov_b32 v101, 0
  v_mov_b32 v102, 0
  v_mov_b32 v103, 0
  s_cmp_eq_u32 s52, 0
  s_cbranch_scc1 mx_132
mx_131:
  buffer_load_dwordx4 v[76:79], v190, s[8:11], s58 offen offset:0 sc1
  buffer_load_dwordx4 v[80:83], v190, s[8:11], s58 offen offset:1024 sc1
  buffer_load_dwordx4 v[84:87], v190, s[8:11], s58 offen offset:2048 sc1
  s_add_u32 s54, s54, 1
  s_cmp_gt_u32 s54, 131072
  s_cbranch_scc1 end0
  s_waitcnt vmcnt(0)
  v_max3_u32 v27, v76, v77, v78
  v_max3_u32 v27, v27, v79, v80
  v_max3_u32 v27, v27, v81, v82
  v_max3_u32 v27, v27, v83, v84
  v_max3_u32 v27, v27, v85, v86
  v_max3_u32 v27, v27, v87, v87
  v_cmp_eq_u32 vcc, -1, v27
  s_nop 1
  s_cbranch_vccnz mx_131
  ds_write_b128 v190, v[76:79] offset:0
  ds_write_b128 v190, v[80:83] offset:1024
  ds_write_b128 v190, v[84:87] offset:2048
mx_132:
  s_waitcnt lgkmcnt(0)
  s_branch mo_112
sr_117:
  s_mov_b32 s54, 0
sr_133:
  s_mov_b64 exec, vcc
  buffer_load_dwordx4 v[124:127], v9, s[8:11], s56 offen sc1
  buffer_load_dwordx4 v[128:131], v9, s[8:11], s56 offen offset:1024 sc1
  buffer_load_dwordx4 v[132:135], v10, s[8:11], s56 offen sc1
  s_mov_b64 exec, -1
  s_add_u32 s54, s54, 1
  s_cmp_gt_u32 s54, 131072
  s_cbranch_scc1 end0
  s_waitcnt vmcnt(0)
  v_pk_add_f16 v164, v132, v133
  v_pk_add_f16 v165, v134, v135
  v_pk_add_f16 v120, v124, v126
  v_pk_add_f16 v122, v128, v130
  v_fma_mix_f32 v170, v164, 1.0, v165 op_sel:[0,0,0] op_sel_hi:[1,0,1]
  v_fma_mix_f32 v166, v120, 1.0, v122 op_sel:[0,0,0] op_sel_hi:[1,0,1]
  v_pk_add_f16 v121, v125, v127
  v_cmp_u_f32 vcc, v166, v170
  v_pk_add_f16 v123, v129, v131
  v_fma_mix_f32 v171, v164, 1.0, v165 op_sel:[1,0,1] op_sel_hi:[1,0,1]
  v_fma_mix_f32 v167, v120, 1.0, v122 op_sel:[1,0,1] op_sel_hi:[1,0,1]
  v_fma_mix_f32 v168, v121, 1.0, v123 op_sel:[0,0,0] op_sel_hi:[1,0,1]
  v_fma_mix_f32 v169, v121, 1.0, v123 op_sel:[1,0,1] op_sel_hi:[1,0,1]
  s_cbranch_vccz ex_119
  s_and_b32 s21, s54, 31
  s_cbranch_scc1 sr_133
  v_max3_u32 v27, v124, v126, v128
  v_max3_u32 v27, v27, v130, v132
  v_max3_u32 v27, v27, v133, v134
  v_max3_u32 v27, v27, v135, v135
  v_cmp_eq_u32 vcc, -1, v27
  s_nop 1
  s_cbranch_vccnz sr_133
ex_119:
  v_exp_f32 v176, v170
  v_exp_f32 v177, v171
  v_exp_f32 v172, v166
  v_cvt_pk_bf16_f32 v160, v176, v177
  v_exp_f32 v173, v167
  v_exp_f32 v174, v168
  v_mov_b32_dpp v161, v160 row_ror:8 row_mask:0xf bank_mask:0xf
  v_cvt_pk_bf16_f32 v156, v172, v173
  v_exp_f32 v175, v169
  v_mfma_f32_16x16x32_bf16 v[178:181], v[140:143], v[160:163], 0
  v_mov_b32_dpp v158, v156 row_ror:8 row_mask:0xf bank_mask:0xf
  v_cvt_pk_bf16_f32 v157, v174, v175
  v_mfma_f32_16x16x32_bf16 v[182:185], v[136:139], v[160:163], 0
  s_nop 0
  v_mov_b32_dpp v159, v157 row_ror:8 row_mask:0xf bank_mask:0xf
  v_mfma_f32_16x16x32_bf16 v[186:189], v[138:141], v[160:163], 0
  s_branch pv_118
fx_120:
  s_bitcmp1_b32 s81, 0
  s_cbranch_scc1 fk_121
  s_or_b32 s81, s81, 1
  s_mov_b64 exec, -1
  v_max3_f32 v164, v166, v167, v168
  v_max3_f32 v165, v169, v170, v171
  v_max_f32 v164, v164, v165
  s_nop 1
  v_max_f32_dpp v164, v164, v164 row_ror:8 row_mask:0xf bank_mask:0xf
  v_mov_b32 v165, v164
  s_nop 1
  v_permlane32_swap_b32 v164, v165
  v_max_f32 v164, v164, v165
  v_mov_b32 v165, v164
  s_nop 1
  v_permlane16_swap_b32 v164, v165
  v_max_f32 v164, v164, v165
  v_sub_f32 v166, v166, v164
  v_sub_f32 v167, v167, v164
  v_sub_f32 v168, v168, v164
  v_sub_f32 v169, v169, v164
  v_sub_f32 v170, v170, v164
  v_sub_f32 v171, v171, v164
  s_branch ex_119
pf_122:
  s_mov_b64 exec, s[66:67]
  ds_read_b128 v[166:169], v4 offset:13824
  ds_read_b128 v[170:173], v4 offset:14464
  ds_read_b128 v[174:177], v4 offset:15104
  ds_read_b128 v[178:181], v4 offset:15744
  s_waitcnt lgkmcnt(2)
  v_pk_add_f16 v166, v166, v170
  v_pk_add_f16 v167, v167, v171
  v_pk_add_f16 v168, v168, v172
  v_pk_add_f16 v169, v169, v173
  s_waitcnt lgkmcnt(1)
  v_pk_add_f16 v166, v166, v174
  v_pk_add_f16 v167, v167, v175
  v_pk_add_f16 v168, v168, v176
  v_pk_add_f16 v169, v169, v177
  s_waitcnt lgkmcnt(0)
  v_pk_add_f16 v166, v166, v178
  v_pk_add_f16 v167, v167, v179
  v_pk_add_f16 v168, v168, v180
  v_pk_add_f16 v169, v169, v181
  v_and_or_b32 v166, v166, -2, s61
  buffer_store_dwordx4 v[166:169], v15, s[4:7], s60 offen sc1
  s_mov_b64 exec, -1
  s_nop 1
  s_branch pf_123
last_111:
  v_permlane32_swap_b32 v88, v92
  v_permlane32_swap_b32 v89, v93
  v_permlane32_swap_b32 v90, v94
  v_permlane32_swap_b32 v91, v95
  v_pk_add_f32 v[88:89], v[88:89], v[92:93]
  v_pk_add_f32 v[90:91], v[90:91], v[94:95]
  v_cvt_pk_bf16_f32 v92, v88, v89
  v_cvt_pk_bf16_f32 v93, v90, v91
  v_min_u32 v92, -2, v92
  buffer_store_dwordx2 v[92:93], v43, s[16:19], s70 offen sc1
  v_smfmac_f32_16x16x64_bf16 v[96:99], v[56:59], a[16:23], v22
  v_smfmac_f32_16x16x64_bf16 v[100:103], v[56:59], a[96:103], v22
  v_smfmac_f32_16x16x64_bf16 v[96:99], v[60:63], a[24:31], v22
  v_smfmac_f32_16x16x64_bf16 v[96:99], v[64:67], a[32:39], v22
  v_smfmac_f32_16x16x64_bf16 v[96:99], v[68:71], a[40:47], v22
  v_smfmac_f32_16x16x64_bf16 v[96:99], v[72:75], a[48:55], v22
  v_smfmac_f32_16x16x64_bf16 v[96:99], v[76:79], a[56:63], v22
  v_smfmac_f32_16x16x64_bf16 v[96:99], v[80:83], a[64:71], v22
  v_smfmac_f32_16x16x64_bf16 v[96:99], v[84:87], a[72:79], v22
  v_smfmac_f32_16x16x64_bf16 v[100:103], v[60:63], a[104:111], v22
  v_smfmac_f32_16x16x64_bf16 v[100:103], v[64:67], a[112:119], v22
  v_smfmac_f32_16x16x64_bf16 v[100:103], v[68:71], a[120:127], v22
  v_smfmac_f32_16x16x64_bf16 v[100:103], v[72:75], a[128:135], v22
  v_smfmac_f32_16x16x64_bf16 v[100:103], v[76:79], a[136:143], v22
  v_smfmac_f32_16x16x64_bf16 v[100:103], v[80:83], a[144:151], v22
  v_smfmac_f32_16x16x64_bf16 v[100:103], v[84:87], a[152:159], v22
  s_nop 7
  v_permlane32_swap_b32 v96, v100
  v_permlane32_swap_b32 v97, v101
  v_permlane32_swap_b32 v98, v102
  v_permlane32_swap_b32 v99, v103
  v_pk_add_f32 v[96:97], v[96:97], v[100:101]
  v_pk_add_f32 v[98:99], v[98:99], v[102:103]
  v_cvt_pk_bf16_f32 v100, v96, v97
  v_cvt_pk_bf16_f32 v101, v98, v99
  s_nop 0
  v_permlane32_swap_b32 v100, v102
  v_permlane32_swap_b32 v101, v103
  v_min_u32 v100, -2, v100
  buffer_store_dwordx4 v[100:103], v26, s[16:19], s70 offen sc1
  s_waitcnt vmcnt(0)
  s_barrier
  v_mov_b32 v166, 64
  s_mov_b64 exec, 1
  buffer_store_dword v166, v23, s[12:15], s77 offen sc1
  s_mov_b64 exec, -1
  s_branch chain_done
E_25:
  v_add_u32 v190, 0, v4
  ds_write_b64 v6, v[28:29]
  ds_write_b32 v13, v28
  ds_write_b32 v14, v28
  s_waitcnt vmcnt(0)
  ds_write_b128 v190, v[48:51] offset:0
  ds_write_b128 v190, v[52:55] offset:1024
  s_waitcnt lgkmcnt(0)
  s_add_u32 m0, s74, 4096
  s_add_u32 s21, s79, 131072
  buffer_load_dwordx4 v4, s[16:19], s21 offen offset:1024 sc1 lds
  s_add_u32 m0, s74, 9216
  s_add_u32 s21, s72, 32768
  buffer_load_dwordx4 v32, s[16:19], s21 offen sc1 lds
  s_xor_b32 s74, s74, 16384
  s_add_u32 s73, s73, 2097152
  s_xor_b32 s73, s73, 8192
  s_add_u32 s79, s79, 2097152
  s_xor_b32 s79, s79, 8192
  s_add_u32 s21, s72, 524288
  s_xor_b32 s72, s72, s21
  s_lshr_b32 s72, s72, 8
  s_and_b32 s72, s72, 8192
  s_xor_b32 s72, s72, s21
  s_add_u32 s71, s73, 4096
  s_mov_b32 s91, 1024
  s_sub_u32 s21, s73, 0
  s_cmp_lt_u32 s21, 125829120
  s_cselect_b32 s71, s71, s79
  s_cselect_b32 s91, s91, 65536
  s_branch mo_140
  .p2align 3
top_135:
  s_waitcnt vmcnt(1)
  ds_write_b128 v190, v[48:51] offset:0
  v_cmp_eq_u32 s[22:23], -1, v48
  s_waitcnt vmcnt(0)
  ds_write_b128 v190, v[52:55] offset:1024
  v_cmp_eq_u32 s[98:99], -1, v52
  s_or_b64 vcc, s[22:23], s[98:99]
  s_cbranch_scc1 mr_136
mo_140:
  s_barrier
  ds_read_b128 v[56:59], v4 offset:2048
  ds_read_b128 v[60:63], v4 offset:3072
  v_smfmac_f32_16x16x64_bf16 v[92:95], v[48:51], a[240:247], v22
  ds_read_b128 v[64:67], v4 offset:4096
  v_smfmac_f32_16x16x64_bf16 v[88:91], v[48:51], a[160:167], v22
  ds_read_b128 v[68:71], v4 offset:5120
  v_smfmac_f32_16x16x64_bf16 v[92:95], v[52:55], a[248:255], v22
  ds_read_b128 v[72:75], v4 offset:6144
  v_smfmac_f32_16x16x64_bf16 v[88:91], v[52:55], a[168:175], v22
  s_waitcnt lgkmcnt(4)
  ds_read_b128 v[76:79], v4 offset:7168
  v_smfmac_f32_16x16x64_bf16 v[92:95], v[56:59], v[192:199], v22
  ds_read_b128 v[80:83], v4 offset:8192
  v_smfmac_f32_16x16x64_bf16 v[88:91], v[56:59], a[176:183], v22
  s_waitcnt lgkmcnt(5)
  ds_read_b128 v[84:87], v4 offset:9216
  v_smfmac_f32_16x16x64_bf16 v[92:95], v[60:63], v[200:207], v22
  v_smfmac_f32_16x16x64_bf16 v[88:91], v[60:63], a[184:191], v22
  s_waitcnt lgkmcnt(5)
  v_smfmac_f32_16x16x64_bf16 v[92:95], v[64:67], v[208:215], v22
  s_waitcnt lgkmcnt(4)
  v_smfmac_f32_16x16x64_bf16 v[92:95], v[68:71], v[216:223], v22
  s_waitcnt lgkmcnt(3)
  v_smfmac_f32_16x16x64_bf16 v[92:95], v[72:75], v[224:231], v22
  s_waitcnt lgkmcnt(2)
  v_smfmac_f32_16x16x64_bf16 v[92:95], v[76:79], v[232:239], v22
  s_waitcnt lgkmcnt(1)
  v_smfmac_f32_16x16x64_bf16 v[92:95], v[80:83], v[240:247], v22
  s_waitcnt lgkmcnt(0)
  v_smfmac_f32_16x16x64_bf16 v[92:95], v[84:87], v[248:255], v22
  v_smfmac_f32_16x16x64_bf16 v[88:91], v[64:67], a[192:199], v22
  v_smfmac_f32_16x16x64_bf16 v[88:91], v[68:71], a[200:207], v22
  v_smfmac_f32_16x16x64_bf16 v[88:91], v[72:75], a[208:215], v22
  v_permlane32_swap_b32 v92, v93
  v_smfmac_f32_16x16x64_bf16 v[88:91], v[76:79], a[216:223], v22
  v_permlane32_swap_b32 v94, v95
  v_smfmac_f32_16x16x64_bf16 v[88:91], v[80:83], a[224:231], v22
  v_permlane32_swap_b32 v93, v92
  v_smfmac_f32_16x16x64_bf16 v[88:91], v[84:87], a[232:239], v22
  v_permlane32_swap_b32 v95, v94
  v_pk_mul_f32 v[120:121], v[92:93], v[24:25] op_sel:[1,0] op_sel_hi:[0,1]
  v_pk_mul_f32 v[122:123], v[94:95], v[24:25] op_sel:[1,0] op_sel_hi:[0,1]
  s_nop 4
  v_pk_fma_f32 v[88:89], v[88:89], v[24:25], v[120:121]
  v_pk_fma_f32 v[90:91], v[90:91], v[24:25], v[122:123]
  v_cvt_pk_bf16_f32 v120, v88, v89
  v_cvt_pk_bf16_f32 v121, v90, v91
  ds_write_b64 v6, v[120:121]
  s_barrier
  ds_read_b64_tr_b16 v[104:105], v7 offset:0
  ds_read_b64_tr_b16 v[106:107], v7 offset:768
  ds_read_b64_tr_b16 v[108:109], v7 offset:1536
  s_waitcnt lgkmcnt(1)
  v_mfma_f32_16x16x32_bf16 v[120:123], v[112:115], v[104:107], 0
  s_waitcnt lgkmcnt(0)
  v_mfma_f32_16x16x32_bf16 v[120:123], v[116:119], v[108:111], v[120:123]
  s_mov_b64 exec, s[64:65]
  s_nop 6
  v_cmpx_o_f32 vcc, v120, v121
  v_cvt_pk_f16_f32 v120, v120, v121
  v_cvt_pk_f16_f32 v121, v122, v123
  buffer_store_dwordx2 v[120:121], v8, s[8:11], s56 offen sc1
  s_xor_b64 s[98:99], exec, s[64:65]
  s_mov_b64 exec, -1
  s_waitcnt lgkmcnt(0)
  s_barrier
  ds_read_b64_tr_b16 v[104:105], v7 offset:0
  ds_read_b64_tr_b16 v[106:107], v7 offset:768
  ds_read_b64_tr_b16 v[108:109], v7 offset:1536
  ds_read_b32 v27, v12 offset:12544
  ds_read_b64 v[140:141], v11
  s_waitcnt lgkmcnt(1)
  v_cmp_u_f32 vcc, v104, v106
  v_cmp_u_f32 s[22:23], v108, v27
  s_nop 1
  s_or_b64 vcc, vcc, s[22:23]
  s_cbranch_vccnz mn_137
mk_138:
  s_cmp_eq_u32 s52, 63
  s_cbranch_scc1 last_139
  s_cmp_lg_u64 s[98:99], 0
  s_cbranch_scc1 sf_141
sf_142:
  s_nop 15
  s_nop 10
  v_smfmac_f32_16x16x64_bf16 v[96:99], v[48:51], a[0:7], v22
  v_smfmac_f32_16x16x64_bf16 v[100:103], v[48:51], a[80:87], v22
  v_smfmac_f32_16x16x64_bf16 v[96:99], v[52:55], a[8:15], v22
  v_smfmac_f32_16x16x64_bf16 v[100:103], v[52:55], a[88:95], v22
  v_smfmac_f32_16x16x64_bf16 v[96:99], v[56:59], a[16:23], v22
  v_smfmac_f32_16x16x64_bf16 v[100:103], v[56:59], a[96:103], v22
  buffer_load_dwordx4 v[132:135], v10, s[8:11], s56 offen sc1
  v_smfmac_f32_16x16x64_bf16 v[96:99], v[60:63], a[24:31], v22
  buffer_load_dwordx4 v[124:127], v9, s[8:11], s56 offen sc1
  v_smfmac_f32_16x16x64_bf16 v[96:99], v[64:67], a[32:39], v22
  buffer_load_dwordx4 v[128:131], v9, s[8:11], s56 offen offset:1024 sc1
  v_smfmac_f32_16x16x64_bf16 v[96:99], v[68:71], a[40:47], v22
  v_smfmac_f32_16x16x64_bf16 v[96:99], v[72:75], a[48:55], v22
  v_smfmac_f32_16x16x64_bf16 v[96:99], v[76:79], a[56:63], v22
  v_smfmac_f32_16x16x64_bf16 v[96:99], v[80:83], a[64:71], v22
  v_smfmac_f32_16x16x64_bf16 v[96:99], v[84:87], a[72:79], v22
  v_smfmac_f32_16x16x64_bf16 v[100:103], v[60:63], a[104:111], v22
  v_smfmac_f32_16x16x64_bf16 v[100:103], v[64:67], a[112:119], v22
  v_smfmac_f32_16x16x64_bf16 v[100:103], v[68:71], a[120:127], v22
  v_smfmac_f32_16x16x64_bf16 v[100:103], v[72:75], a[128:135], v22
  v_cvt_pk_bf16_f32 v136, v96, v97
  v_smfmac_f32_16x16x64_bf16 v[100:103], v[76:79], a[136:143], v22
  v_cvt_pk_bf16_f32 v137, v98, v99
  v_smfmac_f32_16x16x64_bf16 v[100:103], v[80:83], a[144:151], v22
  v_smfmac_f32_16x16x64_bf16 v[100:103], v[84:87], a[152:159], v22
  s_nop 7
  v_cvt_pk_bf16_f32 v138, v100, v101
  v_cvt_pk_bf16_f32 v139, v102, v103
  s_waitcnt vmcnt(2) lgkmcnt(0)
  v_pk_add_f16 v164, v132, v133
  v_pk_add_f16 v165, v134, v135
  v_fma_mix_f32 v170, v164, 1.0, v165 op_sel:[0,0,0] op_sel_hi:[1,0,1]
  v_fma_mix_f32 v171, v164, 1.0, v165 op_sel:[1,0,1] op_sel_hi:[1,0,1]
  v_exp_f32 v176, v170
  v_exp_f32 v177, v171
  s_waitcnt vmcnt(1)
  v_cvt_pk_bf16_f32 v160, v176, v177
  v_pk_add_f16 v120, v124, v126
  v_pk_add_f16 v121, v125, v127
  v_mov_b32_dpp v161, v160 row_ror:8 row_mask:0xf bank_mask:0xf
  s_waitcnt vmcnt(0)
  v_pk_add_f16 v122, v128, v130
  v_mfma_f32_16x16x32_bf16 v[178:181], v[140:143], v[160:163], 0
  v_fma_mix_f32 v166, v120, 1.0, v122 op_sel:[0,0,0] op_sel_hi:[1,0,1]
  v_fma_mix_f32 v167, v120, 1.0, v122 op_sel:[1,0,1] op_sel_hi:[1,0,1]
  v_cmp_u_f32 vcc, v166, v170
  v_pk_add_f16 v123, v129, v131
  v_exp_f32 v172, v166
  v_mfma_f32_16x16x32_bf16 v[182:185], v[136:139], v[160:163], 0
  s_cbranch_vccnz sr_143
  v_exp_f32 v173, v167
  v_fma_mix_f32 v168, v121, 1.0, v123 op_sel:[0,0,0] op_sel_hi:[1,0,1]
  v_fma_mix_f32 v169, v121, 1.0, v123 op_sel:[1,0,1] op_sel_hi:[1,0,1]
  v_cvt_pk_bf16_f32 v156, v172, v173
  v_exp_f32 v174, v168
  v_exp_f32 v175, v169
  v_mov_b32_dpp v158, v156 row_ror:8 row_mask:0xf bank_mask:0xf
  v_cvt_pk_bf16_f32 v157, v174, v175
  v_mfma_f32_16x16x32_bf16 v[186:189], v[138:141], v[160:163], 0
  s_nop 0
  v_mov_b32_dpp v159, v157 row_ror:8 row_mask:0xf bank_mask:0xf
  s_nop 1
pv_144:
  v_mfma_f32_16x16x32_bf16 v[178:181], v[152:155], v[156:159], v[178:181]
  v_mfma_f32_16x16x32_bf16 v[182:185], v[144:147], v[156:159], v[182:185]
  v_mfma_f32_16x16x32_bf16 v[186:189], v[148:151], v[156:159], v[186:189]
  s_mov_b64 exec, s[62:63]
  s_nop 0
  v_rcp_f32 v164, v180
  v_cmp_ngt_f32 s[22:23], s80, v180
  v_cmp_ngt_f32 vcc, s80, v164
  v_pk_mul_f32 v[182:183], v[182:183], v[164:165] op_sel_hi:[1,0]
  v_pk_mul_f32 v[184:185], v[184:185], v[164:165] op_sel_hi:[1,0]
  v_pk_mul_f32 v[178:179], v[178:179], v[164:165] op_sel_hi:[1,0]
  v_pk_mul_f32 v[186:187], v[186:187], v[164:165] op_sel_hi:[1,0]
  v_pk_mul_f32 v[188:189], v[188:189], v[164:165] op_sel_hi:[1,0]
  v_cvt_pk_f16_f32 v64, v178, v179
  s_or_b64 vcc, vcc, s[22:23]
  s_cbranch_scc1 fx_146
fk_147:
  ds_write_b32 v14, v64
  v_cvt_pk_f16_f32 v60, v182, v183
  v_cvt_pk_f16_f32 v61, v184, v185
  v_cvt_pk_f16_f32 v62, v186, v187
  v_cvt_pk_f16_f32 v63, v188, v189
  ds_write_b128 v13, v[60:63]
  s_barrier
  s_mov_b64 exec, -1
  s_add_u32 m0, s74, 4096
  s_add_u32 s21, s79, 131072
  buffer_load_dwordx4 v4, s[16:19], s21 offen offset:1024 sc1 lds
  s_add_u32 m0, s74, 9216
  s_add_u32 s21, s72, 32768
  buffer_load_dwordx4 v32, s[16:19], s21 offen sc1 lds
  s_xor_b32 s74, s74, 16384
  s_add_u32 s73, s73, 2097152
  s_xor_b32 s73, s73, 8192
  s_add_u32 s79, s79, 2097152
  s_xor_b32 s79, s79, 8192
  s_add_u32 s21, s72, 524288
  s_xor_b32 s72, s72, s21
  s_lshr_b32 s72, s72, 8
  s_and_b32 s72, s72, 8192
  s_xor_b32 s72, s72, s21
  s_add_u32 s71, s73, 4096
  s_mov_b32 s91, 1024
  s_sub_u32 s21, s73, 0
  s_cmp_lt_u32 s21, 125829120
  s_cselect_b32 s71, s71, s79
  s_cselect_b32 s91, s91, 65536
  v_permlane32_swap_b32 v96, v100
  v_permlane32_swap_b32 v97, v101
  v_permlane32_swap_b32 v98, v102
  v_permlane32_swap_b32 v99, v103
  v_pk_add_f32 v[96:97], v[96:97], v[100:101]
  v_pk_add_f32 v[98:99], v[98:99], v[102:103]
  v_cvt_pk_bf16_f32 v100, v96, v97
  v_cvt_pk_bf16_f32 v101, v98, v99
  s_nop 0
  v_permlane32_swap_b32 v100, v102
  v_permlane32_swap_b32 v101, v103
  v_min_u32 v100, -2, v100
  s_nop 6
  buffer_store_dwordx4 v[100:103], v26, s[16:19], s70 offen sc1
  v_min_u32 v104, -2, v104
  buffer_store_dwordx4 v[104:107], v36, s[16:19], s70 offen offset:2560 sc1
  s_add_u32 s70, s70, 2097152
  s_xor_b32 s70, s70, 8192
  ds_read_b128 v[144:147], v18
  ds_read_b128 v[148:151], v18 offset:1024
  ds_read_b128 v[152:155], v19
  ds_read_b128 v[112:115], v20
  ds_read_b64 v[116:117], v21
  v_xor_b32 v18, 16384, v18
  v_xor_b32 v19, 16384, v19
  v_xor_b32 v20, 16384, v20
  v_xor_b32 v21, 16384, v21
  v_mov_b32 v88, 0
  v_mov_b32 v89, 0
  v_mov_b32 v90, 0
  v_mov_b32 v91, 0
  v_mov_b32 v92, 0
  v_mov_b32 v93, 0
  v_mov_b32 v94, 0
  v_mov_b32 v95, 0
  v_mov_b32 v96, 0
  v_mov_b32 v97, 0
  v_mov_b32 v98, 0
  v_mov_b32 v99, 0
  v_mov_b32 v100, 0
  v_mov_b32 v101, 0
  v_mov_b32 v102, 0
  v_mov_b32 v103, 0
  s_mov_b32 s81, 0
  s_waitcnt lgkmcnt(0)
  s_barrier
  s_mov_b64 exec, s[64:65]
  buffer_store_dwordx2 v[28:29], v8, s[8:11], s57 offen sc1
  s_mov_b64 exec, -1
  ds_write_b128 v190, v[28:31] offset:0
  ds_write_b128 v190, v[28:31] offset:1024
  ds_write_b64 v6, v[28:29]
  s_mov_b64 exec, s[62:63]
  buffer_store_dword v28, v17, s[8:11], s59 offen sc1
  s_mov_b64 exec, -1
  s_sleep 3
  s_nop 1
  buffer_load_dwordx4 v[68:71], v16, s[4:7], s60 offen sc1
  s_sleep 3
  s_nop 1
  buffer_load_dwordx4 v[72:75], v16, s[4:7], s60 offen sc1
  s_waitcnt vmcnt(1)
  v_mfma_f32_16x16x32_f16 v[120:123], v[44:47], v[68:71], 0
  v_bitop3_b32 v27, v68, s61, 1 bitop3:0x28
  v_cmp_ne_u32 vcc, 0, v27
  s_nop 1
  s_cbranch_vccnz p2_152
  s_nop 2
pg_151:
  v_add_f32_dpp v120, v120, v120 row_ror:8 row_mask:0xf bank_mask:0xf
  v_add_f32_dpp v121, v121, v121 row_ror:8 row_mask:0xf bank_mask:0xf
  s_mov_b64 exec, s[62:63]
  v_cvt_pk_bf16_f32 v120, v120, v121
  v_min_u32 v120, -2, v120
  buffer_store_dword v120, v17, s[8:11], s55 offen sc1
  s_mov_b64 exec, -1
nt_148:
  s_barrier
  s_mov_b32 s58, s55
  s_add_u32 s52, s52, 1
  ds_write_b32 v13, v28
  ds_write_b32 v14, v28
  s_and_b32 s21, s52, 3
  s_mul_i32 s56, s21, 122880
  s_add_u32 s21, s52, 1
  s_and_b32 s21, s21, 3
  s_mul_i32 s55, s21, 122880
  s_add_u32 s55, s55, s75
  s_add_u32 s21, s52, 2
  s_and_b32 s21, s21, 3
  s_mul_i32 s57, s21, 122880
  s_add_u32 s21, s52, 3
  s_and_b32 s21, s21, 3
  s_mul_i32 s59, s21, 122880
  s_add_u32 s59, s59, s75
  s_bfe_u32 s61, s52, 0x10002
  s_and_b32 s21, s52, 3
  s_lshl_b32 s60, s21, 18
  s_mov_b32 s54, 0
  s_sleep 2
  s_nop 10
  s_waitcnt lgkmcnt(0)
  buffer_load_dwordx4 v[48:51], v190, s[8:11], s58 offen offset:0 sc1
  buffer_load_dwordx4 v[52:55], v190, s[8:11], s58 offen offset:1024 sc1
  s_branch top_135
mr_136:
  s_mov_b64 exec, s[22:23]
  s_cbranch_execz ms_153
  buffer_load_dwordx4 v[48:51], v190, s[8:11], s58 offen offset:0 sc1
ms_153:
  s_mov_b64 exec, s[98:99]
  s_cbranch_execz ms_154
  buffer_load_dwordx4 v[52:55], v190, s[8:11], s58 offen offset:1024 sc1
ms_154:
  s_add_u32 s54, s54, 1
  s_cmp_gt_u32 s54, 131072
  s_cbranch_scc1 end0
  s_waitcnt vmcnt(0)
  s_mov_b64 exec, s[22:23]
  ds_write_b128 v190, v[48:51] offset:0
  v_cmp_eq_u32 s[22:23], -1, v48
  s_mov_b64 exec, s[98:99]
  ds_write_b128 v190, v[52:55] offset:1024
  v_cmp_eq_u32 s[98:99], -1, v52
  s_mov_b64 exec, -1
  s_or_b64 vcc, s[22:23], s[98:99]
  s_cbranch_scc1 mr_136
  s_branch mo_140
sf_141:
  s_waitcnt lgkmcnt(1)
  v_mfma_f32_16x16x32_bf16 v[120:123], v[112:115], v[104:107], 0
  s_waitcnt lgkmcnt(0)
  v_mfma_f32_16x16x32_bf16 v[120:123], v[116:119], v[108:111], v[120:123]
  s_mov_b64 exec, s[64:65]
  s_nop 6
  v_cvt_pk_f16_f32 v120, v120, v121
  v_cvt_pk_f16_f32 v121, v122, v123
  buffer_store_dwordx2 v[120:121], v8, s[8:11], s56 offen sc1
  s_mov_b64 exec, -1
  s_branch sf_142
mn_137:
  s_bitcmp1_b32 s81, 1
  s_cbranch_scc1 mk_138
  s_or_b32 s81, s81, 2
  s_nop 7
  v_mov_b32 v88, 0
  v_mov_b32 v89, 0
  v_mov_b32 v90, 0
  v_mov_b32 v91, 0
  v_mov_b32 v92, 0
  v_mov_b32 v93, 0
  v_mov_b32 v94, 0
  v_mov_b32 v95, 0
  v_mov_b32 v96, 0
  v_mov_b32 v97, 0
  v_mov_b32 v98, 0
  v_mov_b32 v99, 0
  v_mov_b32 v100, 0
  v_mov_b32 v101, 0
  v_mov_b32 v102, 0
  v_mov_b32 v103, 0
  s_cmp_eq_u32 s52, 0
  s_cbranch_scc1 mx_156
mx_155:
  buffer_load_dwordx4 v[48:51], v190, s[8:11], s58 offen offset:0 sc1
  buffer_load_dwordx4 v[52:55], v190, s[8:11], s58 offen offset:1024 sc1
  s_add_u32 s54, s54, 1
  s_cmp_gt_u32 s54, 131072
  s_cbranch_scc1 end0
  s_waitcnt vmcnt(0)
  v_max3_u32 v27, v48, v49, v50
  v_max3_u32 v27, v27, v51, v52
  v_max3_u32 v27, v27, v53, v54
  v_max3_u32 v27, v27, v55, v55
  v_cmp_eq_u32 vcc, -1, v27
  s_nop 1
  s_cbranch_vccnz mx_155
  ds_write_b128 v190, v[48:51] offset:0
  ds_write_b128 v190, v[52:55] offset:1024
mx_156:
  s_waitcnt lgkmcnt(0)
  s_branch mo_140
sr_143:
  s_mov_b32 s54, 0
sr_157:
  s_mov_b64 exec, vcc
  buffer_load_dwordx4 v[124:127], v9, s[8:11], s56 offen sc1
  buffer_load_dwordx4 v[128:131], v9, s[8:11], s56 offen offset:1024 sc1
  buffer_load_dwordx4 v[132:135], v10, s[8:11], s56 offen sc1
  s_mov_b64 exec, -1
  s_add_u32 s54, s54, 1
  s_cmp_gt_u32 s54, 131072
  s_cbranch_scc1 end0
  s_waitcnt vmcnt(0)
  v_pk_add_f16 v164, v132, v133
  v_pk_add_f16 v165, v134, v135
  v_pk_add_f16 v120, v124, v126
  v_pk_add_f16 v122, v128, v130
  v_fma_mix_f32 v170, v164, 1.0, v165 op_sel:[0,0,0] op_sel_hi:[1,0,1]
  v_fma_mix_f32 v166, v120, 1.0, v122 op_sel:[0,0,0] op_sel_hi:[1,0,1]
  v_pk_add_f16 v121, v125, v127
  v_cmp_u_f32 vcc, v166, v170
  v_pk_add_f16 v123, v129, v131
  v_fma_mix_f32 v171, v164, 1.0, v165 op_sel:[1,0,1] op_sel_hi:[1,0,1]
  v_fma_mix_f32 v167, v120, 1.0, v122 op_sel:[1,0,1] op_sel_hi:[1,0,1]
  v_fma_mix_f32 v168, v121, 1.0, v123 op_sel:[0,0,0] op_sel_hi:[1,0,1]
  v_fma_mix_f32 v169, v121, 1.0, v123 op_sel:[1,0,1] op_sel_hi:[1,0,1]
  s_cbranch_vccz ex_145
  s_and_b32 s21, s54, 31
  s_cbranch_scc1 sr_157
  v_max3_u32 v27, v124, v126, v128
  v_max3_u32 v27, v27, v130, v132
  v_max3_u32 v27, v27, v133, v134
  v_max3_u32 v27, v27, v135, v135
  v_cmp_eq_u32 vcc, -1, v27
  s_nop 1
  s_cbranch_vccnz sr_157
ex_145:
  v_exp_f32 v176, v170
  v_exp_f32 v177, v171
  v_exp_f32 v172, v166
  v_cvt_pk_bf16_f32 v160, v176, v177
  v_exp_f32 v173, v167
  v_exp_f32 v174, v168
  v_mov_b32_dpp v161, v160 row_ror:8 row_mask:0xf bank_mask:0xf
  v_cvt_pk_bf16_f32 v156, v172, v173
  v_exp_f32 v175, v169
  v_mfma_f32_16x16x32_bf16 v[178:181], v[140:143], v[160:163], 0
  v_mov_b32_dpp v158, v156 row_ror:8 row_mask:0xf bank_mask:0xf
  v_cvt_pk_bf16_f32 v157, v174, v175
  v_mfma_f32_16x16x32_bf16 v[182:185], v[136:139], v[160:163], 0
  s_nop 0
  v_mov_b32_dpp v159, v157 row_ror:8 row_mask:0xf bank_mask:0xf
  v_mfma_f32_16x16x32_bf16 v[186:189], v[138:141], v[160:163], 0
  s_branch pv_144
fx_146:
  s_bitcmp1_b32 s81, 0
  s_cbranch_scc1 fk_147
  s_or_b32 s81, s81, 1
  s_mov_b64 exec, -1
  v_max3_f32 v164, v166, v167, v168
  v_max3_f32 v165, v169, v170, v171
  v_max_f32 v164, v164, v165
  s_nop 1
  v_max_f32_dpp v164, v164, v164 row_ror:8 row_mask:0xf bank_mask:0xf
  v_mov_b32 v165, v164
  s_nop 1
  v_permlane32_swap_b32 v164, v165
  v_max_f32 v164, v164, v165
  v_mov_b32 v165, v164
  s_nop 1
  v_permlane16_swap_b32 v164, v165
  v_max_f32 v164, v164, v165
  v_sub_f32 v166, v166, v164
  v_sub_f32 v167, v167, v164
  v_sub_f32 v168, v168, v164
  v_sub_f32 v169, v169, v164
  v_sub_f32 v170, v170, v164
  v_sub_f32 v171, v171, v164
  s_branch ex_145
p2_152:
  s_mov_b32 s54, 0
  buffer_load_dwordx4 v[68:71], v16, s[4:7], s60 offen sc1
  s_waitcnt vmcnt(1)
  v_mfma_f32_16x16x32_f16 v[120:123], v[44:47], v[72:75], 0
  v_bitop3_b32 v27, v72, s61, 1 bitop3:0x28
  v_cmp_ne_u32 vcc, 0, v27
  s_nop 1
  s_cbranch_vccz pg_151
  buffer_load_dwordx4 v[72:75], v16, s[4:7], s60 offen sc1
pp_150:
  s_waitcnt vmcnt(1)
  v_mfma_f32_16x16x32_f16 v[120:123], v[44:47], v[68:71], 0
  v_bitop3_b32 v27, v68, s61, 1 bitop3:0x28
  v_cmp_ne_u32 vcc, 0, v27
  s_nop 1
  s_cbranch_vccz pg_151
  buffer_load_dwordx4 v[68:71], v16, s[4:7], s60 offen sc1
  s_waitcnt vmcnt(1)
  v_mfma_f32_16x16x32_f16 v[120:123], v[44:47], v[72:75], 0
  v_bitop3_b32 v27, v72, s61, 1 bitop3:0x28
  v_cmp_ne_u32 vcc, 0, v27
  s_nop 1
  s_cbranch_vccz pg_151
  buffer_load_dwordx4 v[72:75], v16, s[4:7], s60 offen sc1
  s_add_u32 s54, s54, 1
  s_cmp_gt_u32 s54, 131072
  s_cbranch_scc1 end0
  s_branch pp_150
last_139:
  v_min_u32 v104, -2, v104
  buffer_store_dwordx4 v[104:107], v36, s[16:19], s70 offen offset:2560 sc1
  v_smfmac_f32_16x16x64_bf16 v[96:99], v[48:51], a[0:7], v22
  v_smfmac_f32_16x16x64_bf16 v[100:103], v[48:51], a[80:87], v22
  v_smfmac_f32_16x16x64_bf16 v[96:99], v[52:55], a[8:15], v22
  v_smfmac_f32_16x16x64_bf16 v[100:103], v[52:55], a[88:95], v22
  v_smfmac_f32_16x16x64_bf16 v[96:99], v[56:59], a[16:23], v22
  v_smfmac_f32_16x16x64_bf16 v[100:103], v[56:59], a[96:103], v22
  v_smfmac_f32_16x16x64_bf16 v[96:99], v[60:63], a[24:31], v22
  v_smfmac_f32_16x16x64_bf16 v[96:99], v[64:67], a[32:39], v22
  v_smfmac_f32_16x16x64_bf16 v[96:99], v[68:71], a[40:47], v22
  v_smfmac_f32_16x16x64_bf16 v[96:99], v[72:75], a[48:55], v22
  v_smfmac_f32_16x16x64_bf16 v[96:99], v[76:79], a[56:63], v22
  v_smfmac_f32_16x16x64_bf16 v[96:99], v[80:83], a[64:71], v22
  v_smfmac_f32_16x16x64_bf16 v[96:99], v[84:87], a[72:79], v22
  v_smfmac_f32_16x16x64_bf16 v[100:103], v[60:63], a[104:111], v22
  v_smfmac_f32_16x16x64_bf16 v[100:103], v[64:67], a[112:119], v22
  v_smfmac_f32_16x16x64_bf16 v[100:103], v[68:71], a[120:127], v22
  v_smfmac_f32_16x16x64_bf16 v[100:103], v[72:75], a[128:135], v22
  v_smfmac_f32_16x16x64_bf16 v[100:103], v[76:79], a[136:143], v22
  v_smfmac_f32_16x16x64_bf16 v[100:103], v[80:83], a[144:151], v22
  v_smfmac_f32_16x16x64_bf16 v[100:103], v[84:87], a[152:159], v22
  s_nop 7
  v_permlane32_swap_b32 v96, v100
  v_permlane32_swap_b32 v97, v101
  v_permlane32_swap_b32 v98, v102
  v_permlane32_swap_b32 v99, v103
  v_pk_add_f32 v[96:97], v[96:97], v[100:101]
  v_pk_add_f32 v[98:99], v[98:99], v[102:103]
  v_cvt_pk_bf16_f32 v100, v96, v97
  v_cvt_pk_bf16_f32 v101, v98, v99
  s_nop 0
  v_permlane32_swap_b32 v100, v102
  v_permlane32_swap_b32 v101, v103
  v_min_u32 v100, -2, v100
  buffer_store_dwordx4 v[100:103], v26, s[16:19], s70 offen sc1
  s_waitcnt vmcnt(0)
  s_barrier
  s_branch chain_done
E_27:
  v_add_u32 v190, 2048, v4
  ds_write_b64 v6, v[28:29]
  ds_write_b32 v13, v28
  ds_write_b32 v14, v28
  s_waitcnt vmcnt(0)
  ds_write_b128 v190, v[56:59] offset:0
  ds_write_b128 v190, v[60:63] offset:1024
  ds_write_b128 v190, v[64:67] offset:2048
  s_waitcnt lgkmcnt(0)
  s_add_u32 m0, s74, 6144
  s_add_u32 s21, s79, 196608
  buffer_load_dwordx4 v4, s[16:19], s21 offen offset:1024 sc1 lds
  s_add_u32 m0, s74, 4096
  s_mul_i32 s21, s91, 2
  s_add_u32 s21, s21, s71
  buffer_load_dwordx4 v4, s[16:19], s21 offen sc1 lds
  s_xor_b32 s74, s74, 16384
  s_add_u32 s73, s73, 2097152
  s_xor_b32 s73, s73, 8192
  s_add_u32 s79, s79, 2097152
  s_xor_b32 s79, s79, 8192
  s_add_u32 s21, s72, 524288
  s_xor_b32 s72, s72, s21
  s_lshr_b32 s72, s72, 8
  s_and_b32 s72, s72, 8192
  s_xor_b32 s72, s72, s21
  s_add_u32 s71, s73, 4096
  s_mov_b32 s91, 1024
  s_sub_u32 s21, s73, 0
  s_cmp_lt_u32 s21, 125829120
  s_cselect_b32 s71, s71, s79
  s_cselect_b32 s91, s91, 65536
  s_branch mo_164
  .p2align 3
top_159:
  s_waitcnt vmcnt(2)
  ds_write_b128 v190, v[56:59] offset:0
  v_cmp_eq_u32 s[22:23], -1, v56
  s_waitcnt vmcnt(1)
  ds_write_b128 v190, v[60:63] offset:1024
  v_cmp_eq_u32 s[98:99], -1, v60
  s_waitcnt vmcnt(0)
  ds_write_b128 v190, v[64:67] offset:2048
  v_cmp_eq_u32 s[100:101], -1, v64
  s_or_b64 vcc, s[22:23], s[98:99]
  s_or_b64 vcc, vcc, s[100:101]
  s_cbranch_scc1 mr_160
mo_164:
  s_barrier
  ds_read_b128 v[48:51], v4 offset:0
  ds_read_b128 v[52:55], v4 offset:1024
  v_smfmac_f32_16x16x64_bf16 v[92:95], v[56:59], v[192:199], v22
  ds_read_b128 v[68:71], v4 offset:5120
  v_smfmac_f32_16x16x64_bf16 v[88:91], v[56:59], a[176:183], v22
  ds_read_b128 v[72:75], v4 offset:6144
  v_smfmac_f32_16x16x64_bf16 v[92:95], v[60:63], v[200:207], v22
  ds_read_b128 v[76:79], v4 offset:7168
  v_smfmac_f32_16x16x64_bf16 v[88:91], v[60:63], a[184:191], v22
  ds_read_b128 v[80:83], v4 offset:8192
  v_smfmac_f32_16x16x64_bf16 v[92:95], v[64:67], v[208:215], v22
  ds_read_b128 v[84:87], v4 offset:9216
  v_smfmac_f32_16x16x64_bf16 v[88:91], v[64:67], a[192:199], v22
  s_waitcnt lgkmcnt(6)
  v_smfmac_f32_16x16x64_bf16 v[92:95], v[48:51], a[240:247], v22
  v_smfmac_f32_16x16x64_bf16 v[88:91], v[48:51], a[160:167], v22
  s_waitcnt lgkmcnt(5)
  v_smfmac_f32_16x16x64_bf16 v[92:95], v[52:55], a[248:255], v22
  s_waitcnt lgkmcnt(4)
  v_smfmac_f32_16x16x64_bf16 v[92:95], v[68:71], v[216:223], v22
  s_waitcnt lgkmcnt(3)
  v_smfmac_f32_16x16x64_bf16 v[92:95], v[72:75], v[224:231], v22
  s_waitcnt lgkmcnt(2)
  v_smfmac_f32_16x16x64_bf16 v[92:95], v[76:79], v[232:239], v22
  s_waitcnt lgkmcnt(1)
  v_smfmac_f32_16x16x64_bf16 v[92:95], v[80:83], v[240:247], v22
  s_waitcnt lgkmcnt(0)
  v_smfmac_f32_16x16x64_bf16 v[92:95], v[84:87], v[248:255], v22
  v_smfmac_f32_16x16x64_bf16 v[88:91], v[52:55], a[168:175], v22
  v_smfmac_f32_16x16x64_bf16 v[88:91], v[68:71], a[200:207], v22
  v_smfmac_f32_16x16x64_bf16 v[88:91], v[72:75], a[208:215], v22
  v_permlane32_swap_b32 v92, v93
  v_smfmac_f32_16x16x64_bf16 v[88:91], v[76:79], a[216:223], v22
  v_permlane32_swap_b32 v94, v95
  v_smfmac_f32_16x16x64_bf16 v[88:91], v[80:83], a[224:231], v22
  v_permlane32_swap_b32 v93, v92
  v_smfmac_f32_16x16x64_bf16 v[88:91], v[84:87], a[232:239], v22
  v_permlane32_swap_b32 v95, v94
  v_pk_mul_f32 v[120:121], v[92:93], v[24:25] op_sel:[1,0] op_sel_hi:[0,1]
  v_pk_mul_f32 v[122:123], v[94:95], v[24:25] op_sel:[1,0] op_sel_hi:[0,1]
  s_nop 4
  v_pk_fma_f32 v[88:89], v[88:89], v[24:25], v[120:121]
  v_pk_fma_f32 v[90:91], v[90:91], v[24:25], v[122:123]
  v_cvt_pk_bf16_f32 v120, v88, v89
  v_cvt_pk_bf16_f32 v121, v90, v91
  ds_write_b64 v6, v[120:121]
  s_barrier
  ds_read_b64_tr_b16 v[104:105], v7 offset:0
  ds_read_b64_tr_b16 v[106:107], v7 offset:768
  ds_read_b64_tr_b16 v[108:109], v7 offset:1536
  s_waitcnt lgkmcnt(1)
  v_mfma_f32_16x16x32_bf16 v[120:123], v[112:115], v[104:107], 0
  s_waitcnt lgkmcnt(0)
  v_mfma_f32_16x16x32_bf16 v[120:123], v[116:119], v[108:111], v[120:123]
  s_mov_b64 exec, s[64:65]
  s_nop 6
  v_cmpx_o_f32 vcc, v120, v121
  v_cvt_pk_f16_f32 v120, v120, v121
  v_cvt_pk_f16_f32 v121, v122, v123
  buffer_store_dwordx2 v[120:121], v8, s[8:11], s56 offen sc1
  s_xor_b64 s[98:99], exec, s[64:65]
  s_mov_b64 exec, -1
  s_waitcnt lgkmcnt(0)
  s_barrier
  ds_read_b64_tr_b16 v[104:105], v7 offset:0
  ds_read_b64_tr_b16 v[106:107], v7 offset:768
  ds_read_b64_tr_b16 v[108:109], v7 offset:1536
  ds_read_b32 v27, v12 offset:12544
  ds_read_b64 v[140:141], v11
  s_waitcnt lgkmcnt(1)
  v_cmp_u_f32 vcc, v104, v106
  v_cmp_u_f32 s[22:23], v108, v27
  s_nop 1
  s_or_b64 vcc, vcc, s[22:23]
  s_cbranch_vccnz mn_161
mk_162:
  s_cmp_eq_u32 s52, 63
  s_cbranch_scc1 last_163
  s_cmp_lg_u64 s[98:99], 0
  s_cbranch_scc1 sf_165
sf_166:
  s_nop 15
  s_nop 10
  v_smfmac_f32_16x16x64_bf16 v[96:99], v[48:51], a[0:7], v22
  v_smfmac_f32_16x16x64_bf16 v[100:103], v[48:51], a[80:87], v22
  v_smfmac_f32_16x16x64_bf16 v[96:99], v[52:55], a[8:15], v22
  v_smfmac_f32_16x16x64_bf16 v[100:103], v[52:55], a[88:95], v22
  v_smfmac_f32_16x16x64_bf16 v[96:99], v[56:59], a[16:23], v22
  v_smfmac_f32_16x16x64_bf16 v[100:103], v[56:59], a[96:103], v22
  buffer_load_dwordx4 v[132:135], v10, s[8:11], s56 offen sc1
  v_smfmac_f32_16x16x64_bf16 v[96:99], v[60:63], a[24:31], v22
  buffer_load_dwordx4 v[124:127], v9, s[8:11], s56 offen sc1
  v_smfmac_f32_16x16x64_bf16 v[96:99], v[64:67], a[32:39], v22
  buffer_load_dwordx4 v[128:131], v9, s[8:11], s56 offen offset:1024 sc1
  v_smfmac_f32_16x16x64_bf16 v[96:99], v[68:71], a[40:47], v22
  v_smfmac_f32_16x16x64_bf16 v[96:99], v[72:75], a[48:55], v22
  v_smfmac_f32_16x16x64_bf16 v[96:99], v[76:79], a[56:63], v22
  v_smfmac_f32_16x16x64_bf16 v[96:99], v[80:83], a[64:71], v22
  v_smfmac_f32_16x16x64_bf16 v[96:99], v[84:87], a[72:79], v22
  v_smfmac_f32_16x16x64_bf16 v[100:103], v[60:63], a[104:111], v22
  v_smfmac_f32_16x16x64_bf16 v[100:103], v[64:67], a[112:119], v22
  v_smfmac_f32_16x16x64_bf16 v[100:103], v[68:71], a[120:127], v22
  v_smfmac_f32_16x16x64_bf16 v[100:103], v[72:75], a[128:135], v22
  v_cvt_pk_bf16_f32 v136, v96, v97
  v_smfmac_f32_16x16x64_bf16 v[100:103], v[76:79], a[136:143], v22
  v_cvt_pk_bf16_f32 v137, v98, v99
  v_smfmac_f32_16x16x64_bf16 v[100:103], v[80:83], a[144:151], v22
  v_smfmac_f32_16x16x64_bf16 v[100:103], v[84:87], a[152:159], v22
  s_nop 7
  v_cvt_pk_bf16_f32 v138, v100, v101
  v_cvt_pk_bf16_f32 v139, v102, v103
  s_waitcnt vmcnt(2) lgkmcnt(0)
  v_pk_add_f16 v164, v132, v133
  v_pk_add_f16 v165, v134, v135
  v_fma_mix_f32 v170, v164, 1.0, v165 op_sel:[0,0,0] op_sel_hi:[1,0,1]
  v_fma_mix_f32 v171, v164, 1.0, v165 op_sel:[1,0,1] op_sel_hi:[1,0,1]
  v_exp_f32 v176, v170
  v_exp_f32 v177, v171
  s_waitcnt vmcnt(1)
  v_cvt_pk_bf16_f32 v160, v176, v177
  v_pk_add_f16 v120, v124, v126
  v_pk_add_f16 v121, v125, v127
  v_mov_b32_dpp v161, v160 row_ror:8 row_mask:0xf bank_mask:0xf
  s_waitcnt vmcnt(0)
  v_pk_add_f16 v122, v128, v130
  v_mfma_f32_16x16x32_bf16 v[178:181], v[140:143], v[160:163], 0
  v_fma_mix_f32 v166, v120, 1.0, v122 op_sel:[0,0,0] op_sel_hi:[1,0,1]
  v_fma_mix_f32 v167, v120, 1.0, v122 op_sel:[1,0,1] op_sel_hi:[1,0,1]
  v_cmp_u_f32 vcc, v166, v170
  v_pk_add_f16 v123, v129, v131
  v_exp_f32 v172, v166
  v_mfma_f32_16x16x32_bf16 v[182:185], v[136:139], v[160:163], 0
  s_cbranch_vccnz sr_167
  v_exp_f32 v173, v167
  v_fma_mix_f32 v168, v121, 1.0, v123 op_sel:[0,0,0] op_sel_hi:[1,0,1]
  v_fma_mix_f32 v169, v121, 1.0, v123 op_sel:[1,0,1] op_sel_hi:[1,0,1]
  v_cvt_pk_bf16_f32 v156, v172, v173
  v_exp_f32 v174, v168
  v_exp_f32 v175, v169
  v_mov_b32_dpp v158, v156 row_ror:8 row_mask:0xf bank_mask:0xf
  v_cvt_pk_bf16_f32 v157, v174, v175
  v_mfma_f32_16x16x32_bf16 v[186:189], v[138:141], v[160:163], 0
  s_nop 0
  v_mov_b32_dpp v159, v157 row_ror:8 row_mask:0xf bank_mask:0xf
  s_nop 1
pv_168:
  v_mfma_f32_16x16x32_bf16 v[178:181], v[152:155], v[156:159], v[178:181]
  v_mfma_f32_16x16x32_bf16 v[182:185], v[144:147], v[156:159], v[182:185]
  v_mfma_f32_16x16x32_bf16 v[186:189], v[148:151], v[156:159], v[186:189]
  s_mov_b64 exec, s[62:63]
  s_nop 0
  v_rcp_f32 v164, v180
  v_cmp_ngt_f32 s[22:23], s80, v180
  v_cmp_ngt_f32 vcc, s80, v164
  v_pk_mul_f32 v[182:183], v[182:183], v[164:165] op_sel_hi:[1,0]
  v_pk_mul_f32 v[184:185], v[184:185], v[164:165] op_sel_hi:[1,0]
  v_pk_mul_f32 v[178:179], v[178:179], v[164:165] op_sel_hi:[1,0]
  v_pk_mul_f32 v[186:187], v[186:187], v[164:165] op_sel_hi:[1,0]
  v_pk_mul_f32 v[188:189], v[188:189], v[164:165] op_sel_hi:[1,0]
  v_cvt_pk_f16_f32 v64, v178, v179
  s_or_b64 vcc, vcc, s[22:23]
  s_cbranch_scc1 fx_170
fk_171:
  ds_write_b32 v14, v64
  v_cvt_pk_f16_f32 v60, v182, v183
  v_cvt_pk_f16_f32 v61, v184, v185
  v_cvt_pk_f16_f32 v62, v186, v187
  v_cvt_pk_f16_f32 v63, v188, v189
  ds_write_b128 v13, v[60:63]
  s_barrier
  s_mov_b64 exec, -1
  s_add_u32 m0, s74, 6144
  s_add_u32 s21, s79, 196608
  buffer_load_dwordx4 v4, s[16:19], s21 offen offset:1024 sc1 lds
  s_add_u32 m0, s74, 4096
  s_mul_i32 s21, s91, 2
  s_add_u32 s21, s21, s71
  buffer_load_dwordx4 v4, s[16:19], s21 offen sc1 lds
  s_xor_b32 s74, s74, 16384
  s_add_u32 s73, s73, 2097152
  s_xor_b32 s73, s73, 8192
  s_add_u32 s79, s79, 2097152
  s_xor_b32 s79, s79, 8192
  s_add_u32 s21, s72, 524288
  s_xor_b32 s72, s72, s21
  s_lshr_b32 s72, s72, 8
  s_and_b32 s72, s72, 8192
  s_xor_b32 s72, s72, s21
  s_add_u32 s71, s73, 4096
  s_mov_b32 s91, 1024
  s_sub_u32 s21, s73, 0
  s_cmp_lt_u32 s21, 125829120
  s_cselect_b32 s71, s71, s79
  s_cselect_b32 s91, s91, 65536
  v_permlane32_swap_b32 v96, v100
  v_permlane32_swap_b32 v97, v101
  v_permlane32_swap_b32 v98, v102
  v_permlane32_swap_b32 v99, v103
  v_pk_add_f32 v[96:97], v[96:97], v[100:101]
  v_pk_add_f32 v[98:99], v[98:99], v[102:103]
  v_cvt_pk_bf16_f32 v100, v96, v97
  v_cvt_pk_bf16_f32 v101, v98, v99
  s_nop 0
  v_permlane32_swap_b32 v100, v102
  v_permlane32_swap_b32 v101, v103
  v_min_u32 v100, -2, v100
  s_nop 6
  buffer_store_dwordx4 v[100:103], v26, s[16:19], s70 offen sc1
  v_min_u32 v108, -2, v108
  buffer_store_dwordx2 v[108:109], v37, s[16:19], s70 offen offset:3072 sc1
  s_add_u32 s70, s70, 2097152
  s_xor_b32 s70, s70, 8192
  ds_read_b128 v[144:147], v18
  ds_read_b128 v[148:151], v18 offset:1024
  ds_read_b128 v[152:155], v19
  ds_read_b128 v[112:115], v20
  ds_read_b64 v[116:117], v21
  v_xor_b32 v18, 16384, v18
  v_xor_b32 v19, 16384, v19
  v_xor_b32 v20, 16384, v20
  v_xor_b32 v21, 16384, v21
  v_mov_b32 v88, 0
  v_mov_b32 v89, 0
  v_mov_b32 v90, 0
  v_mov_b32 v91, 0
  v_mov_b32 v92, 0
  v_mov_b32 v93, 0
  v_mov_b32 v94, 0
  v_mov_b32 v95, 0
  v_mov_b32 v96, 0
  v_mov_b32 v97, 0
  v_mov_b32 v98, 0
  v_mov_b32 v99, 0
  v_mov_b32 v100, 0
  v_mov_b32 v101, 0
  v_mov_b32 v102, 0
  v_mov_b32 v103, 0
  s_mov_b32 s81, 0
  s_waitcnt lgkmcnt(0)
  s_barrier
  s_mov_b64 exec, s[64:65]
  buffer_store_dwordx2 v[28:29], v8, s[8:11], s57 offen sc1
  s_mov_b64 exec, -1
  ds_write_b128 v190, v[28:31] offset:0
  ds_write_b128 v190, v[28:31] offset:1024
  ds_write_b128 v190, v[28:31] offset:2048
  ds_write_b64 v6, v[28:29]
  s_mov_b64 exec, s[62:63]
  buffer_store_dword v28, v17, s[8:11], s59 offen sc1
  s_mov_b64 exec, -1
  s_sleep 3
  s_nop 1
  buffer_load_dwordx4 v[68:71], v16, s[4:7], s60 offen sc1
  s_sleep 3
  s_nop 1
  buffer_load_dwordx4 v[72:75], v16, s[4:7], s60 offen sc1
  s_waitcnt vmcnt(1)
  v_mfma_f32_16x16x32_f16 v[120:123], v[44:47], v[68:71], 0
  v_bitop3_b32 v27, v68, s61, 1 bitop3:0x28
  v_cmp_ne_u32 vcc, 0, v27
  s_nop 1
  s_cbranch_vccnz p2_176
  s_nop 2
pg_175:
  v_add_f32_dpp v120, v120, v120 row_ror:8 row_mask:0xf bank_mask:0xf
  v_add_f32_dpp v121, v121, v121 row_ror:8 row_mask:0xf bank_mask:0xf
  s_mov_b64 exec, s[62:63]
  v_cvt_pk_bf16_f32 v120, v120, v121
  v_min_u32 v120, -2, v120
  buffer_store_dword v120, v17, s[8:11], s55 offen sc1
  s_mov_b64 exec, -1
nt_172:
  s_barrier
  s_mov_b32 s58, s55
  s_add_u32 s52, s52, 1
  ds_write_b32 v13, v28
  ds_write_b32 v14, v28
  s_and_b32 s21, s52, 3
  s_mul_i32 s56, s21, 122880
  s_add_u32 s21, s52, 1
  s_and_b32 s21, s21, 3
  s_mul_i32 s55, s21, 122880
  s_add_u32 s55, s55, s75
  s_add_u32 s21, s52, 2
  s_and_b32 s21, s21, 3
  s_mul_i32 s57, s21, 122880
  s_add_u32 s21, s52, 3
  s_and_b32 s21, s21, 3
  s_mul_i32 s59, s21, 122880
  s_add_u32 s59, s59, s75
  s_bfe_u32 s61, s52, 0x10002
  s_and_b32 s21, s52, 3
  s_lshl_b32 s60, s21, 18
  s_mov_b32 s54, 0
  s_sleep 2
  s_nop 10
  s_waitcnt lgkmcnt(0)
  buffer_load_dwordx4 v[56:59], v190, s[8:11], s58 offen offset:0 sc1
  buffer_load_dwordx4 v[60:63], v190, s[8:11], s58 offen offset:1024 sc1
  buffer_load_dwordx4 v[64:67], v190, s[8:11], s58 offen offset:2048 sc1
  s_branch top_159
mr_160:
  s_mov_b64 exec, s[22:23]
  s_cbranch_execz ms_177
  buffer_load_dwordx4 v[56:59], v190, s[8:11], s58 offen offset:0 sc1
ms_177:
  s_mov_b64 exec, s[98:99]
  s_cbranch_execz ms_178
  buffer_load_dwordx4 v[60:63], v190, s[8:11], s58 offen offset:1024 sc1
ms_178:
  s_mov_b64 exec, s[100:101]
  s_cbranch_execz ms_179
  buffer_load_dwordx4 v[64:67], v190, s[8:11], s58 offen offset:2048 sc1
ms_179:
  s_add_u32 s54, s54, 1
  s_cmp_gt_u32 s54, 131072
  s_cbranch_scc1 end0
  s_waitcnt vmcnt(0)
  s_mov_b64 exec, s[22:23]
  ds_write_b128 v190, v[56:59] offset:0
  v_cmp_eq_u32 s[22:23], -1, v56
  s_mov_b64 exec, s[98:99]
  ds_write_b128 v190, v[60:63] offset:1024
  v_cmp_eq_u32 s[98:99], -1, v60
  s_mov_b64 exec, s[100:101]
  ds_write_b128 v190, v[64:67] offset:2048
  v_cmp_eq_u32 s[100:101], -1, v64
  s_mov_b64 exec, -1
  s_or_b64 vcc, s[22:23], s[98:99]
  s_or_b64 vcc, vcc, s[100:101]
  s_cbranch_scc1 mr_160
  s_branch mo_164
sf_165:
  s_waitcnt lgkmcnt(1)
  v_mfma_f32_16x16x32_bf16 v[120:123], v[112:115], v[104:107], 0
  s_waitcnt lgkmcnt(0)
  v_mfma_f32_16x16x32_bf16 v[120:123], v[116:119], v[108:111], v[120:123]
  s_mov_b64 exec, s[64:65]
  s_nop 6
  v_cvt_pk_f16_f32 v120, v120, v121
  v_cvt_pk_f16_f32 v121, v122, v123
  buffer_store_dwordx2 v[120:121], v8, s[8:11], s56 offen sc1
  s_mov_b64 exec, -1
  s_branch sf_166
mn_161:
  s_bitcmp1_b32 s81, 1
  s_cbranch_scc1 mk_162
  s_or_b32 s81, s81, 2
  s_nop 7
  v_mov_b32 v88, 0
  v_mov_b32 v89, 0
  v_mov_b32 v90, 0
  v_mov_b32 v91, 0
  v_mov_b32 v92, 0
  v_mov_b32 v93, 0
  v_mov_b32 v94, 0
  v_mov_b32 v95, 0
  v_mov_b32 v96, 0
  v_mov_b32 v97, 0
  v_mov_b32 v98, 0
  v_mov_b32 v99, 0
  v_mov_b32 v100, 0
  v_mov_b32 v101, 0
  v_mov_b32 v102, 0
  v_mov_b32 v103, 0
  s_cmp_eq_u32 s52, 0
  s_cbranch_scc1 mx_181
mx_180:
  buffer_load_dwordx4 v[56:59], v190, s[8:11], s58 offen offset:0 sc1
  buffer_load_dwordx4 v[60:63], v190, s[8:11], s58 offen offset:1024 sc1
  buffer_load_dwordx4 v[64:67], v190, s[8:11], s58 offen offset:2048 sc1
  s_add_u32 s54, s54, 1
  s_cmp_gt_u32 s54, 131072
  s_cbranch_scc1 end0
  s_waitcnt vmcnt(0)
  v_max3_u32 v27, v56, v57, v58
  v_max3_u32 v27, v27, v59, v60
  v_max3_u32 v27, v27, v61, v62
  v_max3_u32 v27, v27, v63, v64
  v_max3_u32 v27, v27, v65, v66
  v_max3_u32 v27, v27, v67, v67
  v_cmp_eq_u32 vcc, -1, v27
  s_nop 1
  s_cbranch_vccnz mx_180
  ds_write_b128 v190, v[56:59] offset:0
  ds_write_b128 v190, v[60:63] offset:1024
  ds_write_b128 v190, v[64:67] offset:2048
mx_181:
  s_waitcnt lgkmcnt(0)
  s_branch mo_164
sr_167:
  s_mov_b32 s54, 0
sr_182:
  s_mov_b64 exec, vcc
  buffer_load_dwordx4 v[124:127], v9, s[8:11], s56 offen sc1
  buffer_load_dwordx4 v[128:131], v9, s[8:11], s56 offen offset:1024 sc1
  buffer_load_dwordx4 v[132:135], v10, s[8:11], s56 offen sc1
  s_mov_b64 exec, -1
  s_add_u32 s54, s54, 1
  s_cmp_gt_u32 s54, 131072
  s_cbranch_scc1 end0
  s_waitcnt vmcnt(0)
  v_pk_add_f16 v164, v132, v133
  v_pk_add_f16 v165, v134, v135
  v_pk_add_f16 v120, v124, v126
  v_pk_add_f16 v122, v128, v130
  v_fma_mix_f32 v170, v164, 1.0, v165 op_sel:[0,0,0] op_sel_hi:[1,0,1]
  v_fma_mix_f32 v166, v120, 1.0, v122 op_sel:[0,0,0] op_sel_hi:[1,0,1]
  v_pk_add_f16 v121, v125, v127
  v_cmp_u_f32 vcc, v166, v170
  v_pk_add_f16 v123, v129, v131
  v_fma_mix_f32 v171, v164, 1.0, v165 op_sel:[1,0,1] op_sel_hi:[1,0,1]
  v_fma_mix_f32 v167, v120, 1.0, v122 op_sel:[1,0,1] op_sel_hi:[1,0,1]
  v_fma_mix_f32 v168, v121, 1.0, v123 op_sel:[0,0,0] op_sel_hi:[1,0,1]
  v_fma_mix_f32 v169, v121, 1.0, v123 op_sel:[1,0,1] op_sel_hi:[1,0,1]
  s_cbranch_vccz ex_169
  s_and_b32 s21, s54, 31
  s_cbranch_scc1 sr_182
  v_max3_u32 v27, v124, v126, v128
  v_max3_u32 v27, v27, v130, v132
  v_max3_u32 v27, v27, v133, v134
  v_max3_u32 v27, v27, v135, v135
  v_cmp_eq_u32 vcc, -1, v27
  s_nop 1
  s_cbranch_vccnz sr_182
ex_169:
  v_exp_f32 v176, v170
  v_exp_f32 v177, v171
  v_exp_f32 v172, v166
  v_cvt_pk_bf16_f32 v160, v176, v177
  v_exp_f32 v173, v167
  v_exp_f32 v174, v168
  v_mov_b32_dpp v161, v160 row_ror:8 row_mask:0xf bank_mask:0xf
  v_cvt_pk_bf16_f32 v156, v172, v173
  v_exp_f32 v175, v169
  v_mfma_f32_16x16x32_bf16 v[178:181], v[140:143], v[160:163], 0
  v_mov_b32_dpp v158, v156 row_ror:8 row_mask:0xf bank_mask:0xf
  v_cvt_pk_bf16_f32 v157, v174, v175
  v_mfma_f32_16x16x32_bf16 v[182:185], v[136:139], v[160:163], 0
  s_nop 0
  v_mov_b32_dpp v159, v157 row_ror:8 row_mask:0xf bank_mask:0xf
  v_mfma_f32_16x16x32_bf16 v[186:189], v[138:141], v[160:163], 0
  s_branch pv_168
fx_170:
  s_bitcmp1_b32 s81, 0
  s_cbranch_scc1 fk_171
  s_or_b32 s81, s81, 1
  s_mov_b64 exec, -1
  v_max3_f32 v164, v166, v167, v168
  v_max3_f32 v165, v169, v170, v171
  v_max_f32 v164, v164, v165
  s_nop 1
  v_max_f32_dpp v164, v164, v164 row_ror:8 row_mask:0xf bank_mask:0xf
  v_mov_b32 v165, v164
  s_nop 1
  v_permlane32_swap_b32 v164, v165
  v_max_f32 v164, v164, v165
  v_mov_b32 v165, v164
  s_nop 1
  v_permlane16_swap_b32 v164, v165
  v_max_f32 v164, v164, v165
  v_sub_f32 v166, v166, v164
  v_sub_f32 v167, v167, v164
  v_sub_f32 v168, v168, v164
  v_sub_f32 v169, v169, v164
  v_sub_f32 v170, v170, v164
  v_sub_f32 v171, v171, v164
  s_branch ex_169
p2_176:
  s_mov_b32 s54, 0
  buffer_load_dwordx4 v[68:71], v16, s[4:7], s60 offen sc1
  s_waitcnt vmcnt(1)
  v_mfma_f32_16x16x32_f16 v[120:123], v[44:47], v[72:75], 0
  v_bitop3_b32 v27, v72, s61, 1 bitop3:0x28
  v_cmp_ne_u32 vcc, 0, v27
  s_nop 1
  s_cbranch_vccz pg_175
  buffer_load_dwordx4 v[72:75], v16, s[4:7], s60 offen sc1
pp_174:
  s_waitcnt vmcnt(1)
  v_mfma_f32_16x16x32_f16 v[120:123], v[44:47], v[68:71], 0
  v_bitop3_b32 v27, v68, s61, 1 bitop3:0x28
  v_cmp_ne_u32 vcc, 0, v27
  s_nop 1
  s_cbranch_vccz pg_175
  buffer_load_dwordx4 v[68:71], v16, s[4:7], s60 offen sc1
  s_waitcnt vmcnt(1)
  v_mfma_f32_16x16x32_f16 v[120:123], v[44:47], v[72:75], 0
  v_bitop3_b32 v27, v72, s61, 1 bitop3:0x28
  v_cmp_ne_u32 vcc, 0, v27
  s_nop 1
  s_cbranch_vccz pg_175
  buffer_load_dwordx4 v[72:75], v16, s[4:7], s60 offen sc1
  s_add_u32 s54, s54, 1
  s_cmp_gt_u32 s54, 131072
  s_cbranch_scc1 end0
  s_branch pp_174
last_163:
  v_min_u32 v108, -2, v108
  buffer_store_dwordx2 v[108:109], v37, s[16:19], s70 offen offset:3072 sc1
  v_smfmac_f32_16x16x64_bf16 v[96:99], v[48:51], a[0:7], v22
  v_smfmac_f32_16x16x64_bf16 v[100:103], v[48:51], a[80:87], v22
  v_smfmac_f32_16x16x64_bf16 v[96:99], v[52:55], a[8:15], v22
  v_smfmac_f32_16x16x64_bf16 v[100:103], v[52:55], a[88:95], v22
  v_smfmac_f32_16x16x64_bf16 v[96:99], v[56:59], a[16:23], v22
  v_smfmac_f32_16x16x64_bf16 v[100:103], v[56:59], a[96:103], v22
  v_smfmac_f32_16x16x64_bf16 v[96:99], v[60:63], a[24:31], v22
  v_smfmac_f32_16x16x64_bf16 v[96:99], v[64:67], a[32:39], v22
  v_smfmac_f32_16x16x64_bf16 v[96:99], v[68:71], a[40:47], v22
  v_smfmac_f32_16x16x64_bf16 v[96:99], v[72:75], a[48:55], v22
  v_smfmac_f32_16x16x64_bf16 v[96:99], v[76:79], a[56:63], v22
  v_smfmac_f32_16x16x64_bf16 v[96:99], v[80:83], a[64:71], v22
  v_smfmac_f32_16x16x64_bf16 v[96:99], v[84:87], a[72:79], v22
  v_smfmac_f32_16x16x64_bf16 v[100:103], v[60:63], a[104:111], v22
  v_smfmac_f32_16x16x64_bf16 v[100:103], v[64:67], a[112:119], v22
  v_smfmac_f32_16x16x64_bf16 v[100:103], v[68:71], a[120:127], v22
  v_smfmac_f32_16x16x64_bf16 v[100:103], v[72:75], a[128:135], v22
  v_smfmac_f32_16x16x64_bf16 v[100:103], v[76:79], a[136:143], v22
  v_smfmac_f32_16x16x64_bf16 v[100:103], v[80:83], a[144:151], v22
  v_smfmac_f32_16x16x64_bf16 v[100:103], v[84:87], a[152:159], v22
  s_nop 7
  v_permlane32_swap_b32 v96, v100
  v_permlane32_swap_b32 v97, v101
  v_permlane32_swap_b32 v98, v102
  v_permlane32_swap_b32 v99, v103
  v_pk_add_f32 v[96:97], v[96:97], v[100:101]
  v_pk_add_f32 v[98:99], v[98:99], v[102:103]
  v_cvt_pk_bf16_f32 v100, v96, v97
  v_cvt_pk_bf16_f32 v101, v98, v99
  s_nop 0
  v_permlane32_swap_b32 v100, v102
  v_permlane32_swap_b32 v101, v103
  v_min_u32 v100, -2, v100
  buffer_store_dwordx4 v[100:103], v26, s[16:19], s70 offen sc1
  s_waitcnt vmcnt(0)
  s_barrier
  s_branch chain_done
E_29:
  v_add_u32 v190, 5120, v4
  ds_write_b64 v6, v[28:29]
  ds_write_b32 v13, v28
  ds_write_b32 v14, v28
  s_waitcnt vmcnt(0)
  ds_write_b128 v190, v[68:71] offset:0
  ds_write_b128 v190, v[72:75] offset:1024
  s_waitcnt lgkmcnt(0)
  s_add_u32 m0, s74, 8192
  s_add_u32 s21, s72, 0
  buffer_load_dwordx4 v32, s[16:19], s21 offen sc1 lds
  s_add_u32 m0, s74, 6144
  s_mul_i32 s21, s91, 3
  s_add_u32 s21, s21, s71
  buffer_load_dwordx4 v4, s[16:19], s21 offen sc1 lds
  s_xor_b32 s74, s74, 16384
  s_add_u32 s73, s73, 2097152
  s_xor_b32 s73, s73, 8192
  s_add_u32 s79, s79, 2097152
  s_xor_b32 s79, s79, 8192
  s_add_u32 s21, s72, 524288
  s_xor_b32 s72, s72, s21
  s_lshr_b32 s72, s72, 8
  s_and_b32 s72, s72, 8192
  s_xor_b32 s72, s72, s21
  s_add_u32 s71, s73, 4096
  s_mov_b32 s91, 1024
  s_sub_u32 s21, s73, 0
  s_cmp_lt_u32 s21, 125829120
  s_cselect_b32 s71, s71, s79
  s_cselect_b32 s91, s91, 65536
  s_branch mo_189
  .p2align 3
top_184:
  s_waitcnt vmcnt(1)
  ds_write_b128 v190, v[68:71] offset:0
  v_cmp_eq_u32 s[22:23], -1, v68
  s_waitcnt vmcnt(0)
  ds_write_b128 v190, v[72:75] offset:1024
  v_cmp_eq_u32 s[98:99], -1, v72
  s_or_b64 vcc, s[22:23], s[98:99]
  s_cbranch_scc1 mr_185
mo_189:
  s_barrier
  ds_read_b128 v[48:51], v4 offset:0
  ds_read_b128 v[52:55], v4 offset:1024
  v_smfmac_f32_16x16x64_bf16 v[92:95], v[68:71], v[216:223], v22
  ds_read_b128 v[56:59], v4 offset:2048
  v_smfmac_f32_16x16x64_bf16 v[88:91], v[68:71], a[200:207], v22
  ds_read_b128 v[60:63], v4 offset:3072
  v_smfmac_f32_16x16x64_bf16 v[92:95], v[72:75], v[224:231], v22
  ds_read_b128 v[64:67], v4 offset:4096
  v_smfmac_f32_16x16x64_bf16 v[88:91], v[72:75], a[208:215], v22
  s_waitcnt lgkmcnt(4)
  ds_read_b128 v[76:79], v4 offset:7168
  v_smfmac_f32_16x16x64_bf16 v[92:95], v[48:51], a[240:247], v22
  ds_read_b128 v[80:83], v4 offset:8192
  v_smfmac_f32_16x16x64_bf16 v[88:91], v[48:51], a[160:167], v22
  s_waitcnt lgkmcnt(5)
  ds_read_b128 v[84:87], v4 offset:9216
  v_smfmac_f32_16x16x64_bf16 v[92:95], v[52:55], a[248:255], v22
  v_smfmac_f32_16x16x64_bf16 v[88:91], v[52:55], a[168:175], v22
  s_waitcnt lgkmcnt(5)
  v_smfmac_f32_16x16x64_bf16 v[92:95], v[56:59], v[192:199], v22
  s_waitcnt lgkmcnt(4)
  v_smfmac_f32_16x16x64_bf16 v[92:95], v[60:63], v[200:207], v22
  s_waitcnt lgkmcnt(3)
  v_smfmac_f32_16x16x64_bf16 v[92:95], v[64:67], v[208:215], v22
  s_waitcnt lgkmcnt(2)
  v_smfmac_f32_16x16x64_bf16 v[92:95], v[76:79], v[232:239], v22
  s_waitcnt lgkmcnt(1)
  v_smfmac_f32_16x16x64_bf16 v[92:95], v[80:83], v[240:247], v22
  s_waitcnt lgkmcnt(0)
  v_smfmac_f32_16x16x64_bf16 v[92:95], v[84:87], v[248:255], v22
  v_smfmac_f32_16x16x64_bf16 v[88:91], v[56:59], a[176:183], v22
  v_smfmac_f32_16x16x64_bf16 v[88:91], v[60:63], a[184:191], v22
  v_smfmac_f32_16x16x64_bf16 v[88:91], v[64:67], a[192:199], v22
  v_permlane32_swap_b32 v92, v93
  v_smfmac_f32_16x16x64_bf16 v[88:91], v[76:79], a[216:223], v22
  v_permlane32_swap_b32 v94, v95
  v_smfmac_f32_16x16x64_bf16 v[88:91], v[80:83], a[224:231], v22
  v_permlane32_swap_b32 v93, v92
  v_smfmac_f32_16x16x64_bf16 v[88:91], v[84:87], a[232:239], v22
  v_permlane32_swap_b32 v95, v94
  v_pk_mul_f32 v[120:121], v[92:93], v[24:25] op_sel:[1,0] op_sel_hi:[0,1]
  v_pk_mul_f32 v[122:123], v[94:95], v[24:25] op_sel:[1,0] op_sel_hi:[0,1]
  s_nop 4
  v_pk_fma_f32 v[88:89], v[88:89], v[24:25], v[120:121]
  v_pk_fma_f32 v[90:91], v[90:91], v[24:25], v[122:123]
  v_cvt_pk_bf16_f32 v120, v88, v89
  v_cvt_pk_bf16_f32 v121, v90, v91
  ds_write_b64 v6, v[120:121]
  s_barrier
  ds_read_b64_tr_b16 v[104:105], v7 offset:0
  ds_read_b64_tr_b16 v[106:107], v7 offset:768
  ds_read_b64_tr_b16 v[108:109], v7 offset:1536
  s_waitcnt lgkmcnt(1)
  v_mfma_f32_16x16x32_bf16 v[120:123], v[104:107], v[104:107], 0
  s_waitcnt lgkmcnt(0)
  v_mfma_f32_16x16x32_bf16 v[120:123], v[108:111], v[108:111], v[120:123]
  s_mov_b64 exec, s[64:65]
  s_nop 6
  v_cmpx_o_f32 vcc, v120, v121
  v_cvt_pk_f16_f32 v120, v120, v121
  buffer_store_dword v120, v8, s[8:11], s56 offen sc1
  v_cmpx_o_f32 vcc, v122, v123
  v_cvt_pk_f16_f32 v121, v122, v123
  buffer_store_dword v121, v8, s[8:11], s56 offen offset:128 sc1
  s_xor_b64 s[98:99], exec, s[64:65]
  s_mov_b64 exec, -1
  s_waitcnt lgkmcnt(0)
  s_barrier
  ds_read_b64_tr_b16 v[104:105], v7 offset:0
  ds_read_b64_tr_b16 v[106:107], v7 offset:768
  ds_read_b64_tr_b16 v[108:109], v7 offset:1536
  ds_read_b32 v27, v12 offset:12544
  ds_read_b64 v[140:141], v11
  s_waitcnt lgkmcnt(1)
  v_cmp_u_f32 vcc, v104, v106
  v_cmp_u_f32 s[22:23], v108, v27
  s_nop 1
  s_or_b64 vcc, vcc, s[22:23]
  s_cbranch_vccnz mn_186
mk_187:
  s_cmp_eq_u32 s52, 63
  s_cbranch_scc1 last_188
  s_cmp_lg_u64 s[98:99], 0
  s_cbranch_scc1 sf_190
sf_191:
  s_nop 15
  s_nop 10
  v_smfmac_f32_16x16x64_bf16 v[96:99], v[48:51], a[0:7], v22
  v_smfmac_f32_16x16x64_bf16 v[100:103], v[48:51], a[80:87], v22
  v_smfmac_f32_16x16x64_bf16 v[96:99], v[52:55], a[8:15], v22
  v_smfmac_f32_16x16x64_bf16 v[100:103], v[52:55], a[88:95], v22
  v_smfmac_f32_16x16x64_bf16 v[96:99], v[56:59], a[16:23], v22
  v_smfmac_f32_16x16x64_bf16 v[100:103], v[56:59], a[96:103], v22
  buffer_load_dwordx4 v[132:135], v10, s[8:11], s56 offen sc1
  v_smfmac_f32_16x16x64_bf16 v[96:99], v[60:63], a[24:31], v22
  buffer_load_dwordx4 v[124:127], v9, s[8:11], s56 offen sc1
  v_smfmac_f32_16x16x64_bf16 v[96:99], v[64:67], a[32:39], v22
  buffer_load_dwordx4 v[128:131], v9, s[8:11], s56 offen offset:1024 sc1
  v_smfmac_f32_16x16x64_bf16 v[96:99], v[68:71], a[40:47], v22
  v_smfmac_f32_16x16x64_bf16 v[96:99], v[72:75], a[48:55], v22
  v_smfmac_f32_16x16x64_bf16 v[96:99], v[76:79], a[56:63], v22
  v_smfmac_f32_16x16x64_bf16 v[96:99], v[80:83], a[64:71], v22
  v_smfmac_f32_16x16x64_bf16 v[96:99], v[84:87], a[72:79], v22
  v_smfmac_f32_16x16x64_bf16 v[100:103], v[60:63], a[104:111], v22
  v_smfmac_f32_16x16x64_bf16 v[100:103], v[64:67], a[112:119], v22
  v_smfmac_f32_16x16x64_bf16 v[100:103], v[68:71], a[120:127], v22
  v_smfmac_f32_16x16x64_bf16 v[100:103], v[72:75], a[128:135], v22
  v_cvt_pk_bf16_f32 v136, v96, v97
  v_smfmac_f32_16x16x64_bf16 v[100:103], v[76:79], a[136:143], v22
  v_cvt_pk_bf16_f32 v137, v98, v99
  v_smfmac_f32_16x16x64_bf16 v[100:103], v[80:83], a[144:151], v22
  v_smfmac_f32_16x16x64_bf16 v[100:103], v[84:87], a[152:159], v22
  s_nop 7
  v_cvt_pk_bf16_f32 v138, v100, v101
  v_cvt_pk_bf16_f32 v139, v102, v103
  s_waitcnt vmcnt(2) lgkmcnt(0)
  v_pk_add_f16 v164, v132, v133
  v_pk_add_f16 v165, v134, v135
  v_fma_mix_f32 v170, v164, 1.0, v165 op_sel:[0,0,0] op_sel_hi:[1,0,1]
  v_fma_mix_f32 v171, v164, 1.0, v165 op_sel:[1,0,1] op_sel_hi:[1,0,1]
  v_exp_f32 v176, v170
  v_exp_f32 v177, v171
  s_waitcnt vmcnt(1)
  v_cvt_pk_bf16_f32 v160, v176, v177
  v_pk_add_f16 v120, v124, v126
  v_pk_add_f16 v121, v125, v127
  v_mov_b32_dpp v161, v160 row_ror:8 row_mask:0xf bank_mask:0xf
  s_waitcnt vmcnt(0)
  v_pk_add_f16 v122, v128, v130
  v_mfma_f32_16x16x32_bf16 v[178:181], v[140:143], v[160:163], 0
  v_fma_mix_f32 v166, v120, 1.0, v122 op_sel:[0,0,0] op_sel_hi:[1,0,1]
  v_fma_mix_f32 v167, v120, 1.0, v122 op_sel:[1,0,1] op_sel_hi:[1,0,1]
  v_cmp_u_f32 vcc, v166, v170
  v_pk_add_f16 v123, v129, v131
  v_exp_f32 v172, v166
  v_mfma_f32_16x16x32_bf16 v[182:185], v[136:139], v[160:163], 0
  s_cbranch_vccnz sr_192
  v_exp_f32 v173, v167
  v_fma_mix_f32 v168, v121, 1.0, v123 op_sel:[0,0,0] op_sel_hi:[1,0,1]
  v_fma_mix_f32 v169, v121, 1.0, v123 op_sel:[1,0,1] op_sel_hi:[1,0,1]
  v_cvt_pk_bf16_f32 v156, v172, v173
  v_exp_f32 v174, v168
  v_exp_f32 v175, v169
  v_mov_b32_dpp v158, v156 row_ror:8 row_mask:0xf bank_mask:0xf
  v_cvt_pk_bf16_f32 v157, v174, v175
  v_mfma_f32_16x16x32_bf16 v[186:189], v[138:141], v[160:163], 0
  s_nop 0
  v_mov_b32_dpp v159, v157 row_ror:8 row_mask:0xf bank_mask:0xf
  s_nop 1
pv_193:
  v_mfma_f32_16x16x32_bf16 v[178:181], v[152:155], v[156:159], v[178:181]
  v_mfma_f32_16x16x32_bf16 v[182:185], v[144:147], v[156:159], v[182:185]
  v_mfma_f32_16x16x32_bf16 v[186:189], v[148:151], v[156:159], v[186:189]
  s_mov_b64 exec, s[62:63]
  s_nop 0
  v_rcp_f32 v164, v180
  v_cmp_ngt_f32 s[22:23], s80, v180
  v_cmp_ngt_f32 vcc, s80, v164
  v_pk_mul_f32 v[182:183], v[182:183], v[164:165] op_sel_hi:[1,0]
  v_pk_mul_f32 v[184:185], v[184:185], v[164:165] op_sel_hi:[1,0]
  v_pk_mul_f32 v[178:179], v[178:179], v[164:165] op_sel_hi:[1,0]
  v_pk_mul_f32 v[186:187], v[186:187], v[164:165] op_sel_hi:[1,0]
  v_pk_mul_f32 v[188:189], v[188:189], v[164:165] op_sel_hi:[1,0]
  v_cvt_pk_f16_f32 v64, v178, v179
  s_or_b64 vcc, vcc, s[22:23]
  s_cbranch_scc1 fx_195
fk_196:
  ds_write_b32 v14, v64
  v_cvt_pk_f16_f32 v60, v182, v183
  v_cvt_pk_f16_f32 v61, v184, v185
  v_cvt_pk_f16_f32 v62, v186, v187
  v_cvt_pk_f16_f32 v63, v188, v189
  ds_write_b128 v13, v[60:63]
  s_barrier
  s_mov_b64 exec, -1
  s_and_b32 s21, s52, 3
  s_cmp_lt_u32 s52, 58
  s_cselect_b32 s21, s21, 0
  s_cmp_lg_u32 s21, 0
  s_cbranch_scc1 fs_197
  v_mov_b32 v27, s52
  s_mov_b64 exec, 1
  buffer_store_dword v27, v23, s[12:15], s77 offen sc1
  s_mov_b64 exec, -1
fs_197:
  s_add_u32 m0, s74, 8192
  s_add_u32 s21, s72, 0
  buffer_load_dwordx4 v32, s[16:19], s21 offen sc1 lds
  s_add_u32 m0, s74, 6144
  s_mul_i32 s21, s91, 3
  s_add_u32 s21, s21, s71
  buffer_load_dwordx4 v4, s[16:19], s21 offen sc1 lds
  s_xor_b32 s74, s74, 16384
  s_add_u32 s73, s73, 2097152
  s_xor_b32 s73, s73, 8192
  s_add_u32 s79, s79, 2097152
  s_xor_b32 s79, s79, 8192
  s_add_u32 s21, s72, 524288
  s_xor_b32 s72, s72, s21
  s_lshr_b32 s72, s72, 8
  s_and_b32 s72, s72, 8192
  s_xor_b32 s72, s72, s21
  s_add_u32 s71, s73, 4096
  s_mov_b32 s91, 1024
  s_sub_u32 s21, s73, 0
  s_cmp_lt_u32 s21, 125829120
  s_cselect_b32 s71, s71, s79
  s_cselect_b32 s91, s91, 65536
  v_permlane32_swap_b32 v96, v100
  v_permlane32_swap_b32 v97, v101
  v_permlane32_swap_b32 v98, v102
  v_permlane32_swap_b32 v99, v103
  v_pk_add_f32 v[96:97], v[96:97], v[100:101]
  v_pk_add_f32 v[98:99], v[98:99], v[102:103]
  v_cvt_pk_bf16_f32 v100, v96, v97
  v_cvt_pk_bf16_f32 v101, v98, v99
  s_nop 0
  v_permlane32_swap_b32 v100, v102
  v_permlane32_swap_b32 v101, v103
  v_min_u32 v100, -2, v100
  s_nop 6
  buffer_store_dwordx4 v[100:103], v26, s[16:19], s70 offen sc1
  s_add_u32 s70, s70, 2097152
  s_xor_b32 s70, s70, 8192
  ds_read_b128 v[144:147], v18
  ds_read_b128 v[148:151], v18 offset:1024
  ds_read_b128 v[152:155], v19
  v_xor_b32 v18, 16384, v18
  v_xor_b32 v19, 16384, v19
  v_mov_b32 v88, 0
  v_mov_b32 v89, 0
  v_mov_b32 v90, 0
  v_mov_b32 v91, 0
  v_mov_b32 v92, 0
  v_mov_b32 v93, 0
  v_mov_b32 v94, 0
  v_mov_b32 v95, 0
  v_mov_b32 v96, 0
  v_mov_b32 v97, 0
  v_mov_b32 v98, 0
  v_mov_b32 v99, 0
  v_mov_b32 v100, 0
  v_mov_b32 v101, 0
  v_mov_b32 v102, 0
  v_mov_b32 v103, 0
  s_mov_b32 s81, 0
  s_waitcnt lgkmcnt(0)
  s_barrier
  s_mov_b64 exec, s[64:65]
  buffer_store_dword v28, v8, s[8:11], s57 offen sc1
  buffer_store_dword v28, v8, s[8:11], s57 offen offset:128 sc1
  s_mov_b64 exec, -1
  ds_write_b128 v190, v[28:31] offset:0
  ds_write_b128 v190, v[28:31] offset:1024
  ds_write_b64 v6, v[28:29]
  s_mov_b64 exec, -1
  s_cmp_eq_u32 s78, 0
  s_cbranch_scc1 nt_199
  s_mov_b64 exec, s[62:63]
  buffer_store_dword v28, v17, s[8:11], s59 offen sc1
  s_mov_b64 exec, -1
  s_sleep 3
  s_nop 1
  buffer_load_dwordx4 v[68:71], v16, s[4:7], s60 offen sc1
  s_sleep 3
  s_nop 1
  buffer_load_dwordx4 v[72:75], v16, s[4:7], s60 offen sc1
  s_waitcnt vmcnt(1)
  v_mfma_f32_16x16x32_f16 v[120:123], v[44:47], v[68:71], 0
  v_bitop3_b32 v27, v68, s61, 1 bitop3:0x28
  v_cmp_ne_u32 vcc, 0, v27
  s_nop 1
  s_cbranch_vccnz p2_202
  s_nop 2
pg_201:
  v_add_f32_dpp v120, v120, v120 row_ror:8 row_mask:0xf bank_mask:0xf
  v_add_f32_dpp v121, v121, v121 row_ror:8 row_mask:0xf bank_mask:0xf
  s_mov_b64 exec, s[62:63]
  v_cvt_pk_bf16_f32 v120, v120, v121
  v_min_u32 v120, -2, v120
  buffer_store_dword v120, v17, s[8:11], s55 offen sc1
  s_mov_b64 exec, -1
nt_198:
  s_barrier
  s_mov_b32 s58, s55
  s_add_u32 s52, s52, 1
  ds_write_b32 v13, v28
  ds_write_b32 v14, v28
  s_and_b32 s21, s52, 3
  s_mul_i32 s56, s21, 122880
  s_add_u32 s21, s52, 1
  s_and_b32 s21, s21, 3
  s_mul_i32 s55, s21, 122880
  s_add_u32 s55, s55, s75
  s_add_u32 s21, s52, 2
  s_and_b32 s21, s21, 3
  s_mul_i32 s57, s21, 122880
  s_add_u32 s21, s52, 3
  s_and_b32 s21, s21, 3
  s_mul_i32 s59, s21, 122880
  s_add_u32 s59, s59, s75
  s_bfe_u32 s61, s52, 0x10002
  s_and_b32 s21, s52, 3
  s_lshl_b32 s60, s21, 18
  s_mov_b32 s54, 0
  s_sleep 2
  s_nop 10
  s_waitcnt lgkmcnt(0)
  buffer_load_dwordx4 v[68:71], v190, s[8:11], s58 offen offset:0 sc1
  buffer_load_dwordx4 v[72:75], v190, s[8:11], s58 offen offset:1024 sc1
  s_branch top_184
mr_185:
  s_mov_b64 exec, s[22:23]
  s_cbranch_execz ms_203
  buffer_load_dwordx4 v[68:71], v190, s[8:11], s58 offen offset:0 sc1
ms_203:
  s_mov_b64 exec, s[98:99]
  s_cbranch_execz ms_204
  buffer_load_dwordx4 v[72:75], v190, s[8:11], s58 offen offset:1024 sc1
ms_204:
  s_add_u32 s54, s54, 1
  s_cmp_gt_u32 s54, 131072
  s_cbranch_scc1 end0
  s_waitcnt vmcnt(0)
  s_mov_b64 exec, s[22:23]
  ds_write_b128 v190, v[68:71] offset:0
  v_cmp_eq_u32 s[22:23], -1, v68
  s_mov_b64 exec, s[98:99]
  ds_write_b128 v190, v[72:75] offset:1024
  v_cmp_eq_u32 s[98:99], -1, v72
  s_mov_b64 exec, -1
  s_or_b64 vcc, s[22:23], s[98:99]
  s_cbranch_scc1 mr_185
  s_branch mo_189
sf_190:
  s_waitcnt lgkmcnt(1)
  v_mfma_f32_16x16x32_bf16 v[120:123], v[104:107], v[104:107], 0
  s_waitcnt lgkmcnt(0)
  v_mfma_f32_16x16x32_bf16 v[120:123], v[108:111], v[108:111], v[120:123]
  s_mov_b64 exec, s[64:65]
  s_nop 6
  v_cvt_pk_f16_f32 v120, v120, v121
  buffer_store_dword v120, v8, s[8:11], s56 offen sc1
  v_cvt_pk_f16_f32 v121, v122, v123
  buffer_store_dword v121, v8, s[8:11], s56 offen offset:128 sc1
  s_mov_b64 exec, -1
  s_branch sf_191
mn_186:
  s_bitcmp1_b32 s81, 1
  s_cbranch_scc1 mk_187
  s_or_b32 s81, s81, 2
  s_nop 7
  v_mov_b32 v88, 0
  v_mov_b32 v89, 0
  v_mov_b32 v90, 0
  v_mov_b32 v91, 0
  v_mov_b32 v92, 0
  v_mov_b32 v93, 0
  v_mov_b32 v94, 0
  v_mov_b32 v95, 0
  v_mov_b32 v96, 0
  v_mov_b32 v97, 0
  v_mov_b32 v98, 0
  v_mov_b32 v99, 0
  v_mov_b32 v100, 0
  v_mov_b32 v101, 0
  v_mov_b32 v102, 0
  v_mov_b32 v103, 0
  s_cmp_eq_u32 s52, 0
  s_cbranch_scc1 mx_206
mx_205:
  buffer_load_dwordx4 v[68:71], v190, s[8:11], s58 offen offset:0 sc1
  buffer_load_dwordx4 v[72:75], v190, s[8:11], s58 offen offset:1024 sc1
  s_add_u32 s54, s54, 1
  s_cmp_gt_u32 s54, 131072
  s_cbranch_scc1 end0
  s_waitcnt vmcnt(0)
  v_max3_u32 v27, v68, v69, v70
  v_max3_u32 v27, v27, v71, v72
  v_max3_u32 v27, v27, v73, v74
  v_max3_u32 v27, v27, v75, v75
  v_cmp_eq_u32 vcc, -1, v27
  s_nop 1
  s_cbranch_vccnz mx_205
  ds_write_b128 v190, v[68:71] offset:0
  ds_write_b128 v190, v[72:75] offset:1024
mx_206:
  s_waitcnt lgkmcnt(0)
  s_branch mo_189
sr_192:
  s_mov_b32 s54, 0
sr_207:
  s_mov_b64 exec, vcc
  buffer_load_dwordx4 v[124:127], v9, s[8:11], s56 offen sc1
  buffer_load_dwordx4 v[128:131], v9, s[8:11], s56 offen offset:1024 sc1
  buffer_load_dwordx4 v[132:135], v10, s[8:11], s56 offen sc1
  s_mov_b64 exec, -1
  s_add_u32 s54, s54, 1
  s_cmp_gt_u32 s54, 131072
  s_cbranch_scc1 end0
  s_waitcnt vmcnt(0)
  v_pk_add_f16 v164, v132, v133
  v_pk_add_f16 v165, v134, v135
  v_pk_add_f16 v120, v124, v126
  v_pk_add_f16 v122, v128, v130
  v_fma_mix_f32 v170, v164, 1.0, v165 op_sel:[0,0,0] op_sel_hi:[1,0,1]
  v_fma_mix_f32 v166, v120, 1.0, v122 op_sel:[0,0,0] op_sel_hi:[1,0,1]
  v_pk_add_f16 v121, v125, v127
  v_cmp_u_f32 vcc, v166, v170
  v_pk_add_f16 v123, v129, v131
  v_fma_mix_f32 v171, v164, 1.0, v165 op_sel:[1,0,1] op_sel_hi:[1,0,1]
  v_fma_mix_f32 v167, v120, 1.0, v122 op_sel:[1,0,1] op_sel_hi:[1,0,1]
  v_fma_mix_f32 v168, v121, 1.0, v123 op_sel:[0,0,0] op_sel_hi:[1,0,1]
  v_fma_mix_f32 v169, v121, 1.0, v123 op_sel:[1,0,1] op_sel_hi:[1,0,1]
  s_cbranch_vccz ex_194
  s_and_b32 s21, s54, 31
  s_cbranch_scc1 sr_207
  v_max3_u32 v27, v124, v126, v128
  v_max3_u32 v27, v27, v130, v132
  v_max3_u32 v27, v27, v133, v134
  v_max3_u32 v27, v27, v135, v135
  v_cmp_eq_u32 vcc, -1, v27
  s_nop 1
  s_cbranch_vccnz sr_207
ex_194:
  v_exp_f32 v176, v170
  v_exp_f32 v177, v171
  v_exp_f32 v172, v166
  v_cvt_pk_bf16_f32 v160, v176, v177
  v_exp_f32 v173, v167
  v_exp_f32 v174, v168
  v_mov_b32_dpp v161, v160 row_ror:8 row_mask:0xf bank_mask:0xf
  v_cvt_pk_bf16_f32 v156, v172, v173
  v_exp_f32 v175, v169
  v_mfma_f32_16x16x32_bf16 v[178:181], v[140:143], v[160:163], 0
  v_mov_b32_dpp v158, v156 row_ror:8 row_mask:0xf bank_mask:0xf
  v_cvt_pk_bf16_f32 v157, v174, v175
  v_mfma_f32_16x16x32_bf16 v[182:185], v[136:139], v[160:163], 0
  s_nop 0
  v_mov_b32_dpp v159, v157 row_ror:8 row_mask:0xf bank_mask:0xf
  v_mfma_f32_16x16x32_bf16 v[186:189], v[138:141], v[160:163], 0
  s_branch pv_193
fx_195:
  s_bitcmp1_b32 s81, 0
  s_cbranch_scc1 fk_196
  s_or_b32 s81, s81, 1
  s_mov_b64 exec, -1
  v_max3_f32 v164, v166, v167, v168
  v_max3_f32 v165, v169, v170, v171
  v_max_f32 v164, v164, v165
  s_nop 1
  v_max_f32_dpp v164, v164, v164 row_ror:8 row_mask:0xf bank_mask:0xf
  v_mov_b32 v165, v164
  s_nop 1
  v_permlane32_swap_b32 v164, v165
  v_max_f32 v164, v164, v165
  v_mov_b32 v165, v164
  s_nop 1
  v_permlane16_swap_b32 v164, v165
  v_max_f32 v164, v164, v165
  v_sub_f32 v166, v166, v164
  v_sub_f32 v167, v167, v164
  v_sub_f32 v168, v168, v164
  v_sub_f32 v169, v169, v164
  v_sub_f32 v170, v170, v164
  v_sub_f32 v171, v171, v164
  s_branch ex_194
nt_199:
  s_branch nt_198
p2_202:
  s_mov_b32 s54, 0
  buffer_load_dwordx4 v[68:71], v16, s[4:7], s60 offen sc1
  s_waitcnt vmcnt(1)
  v_mfma_f32_16x16x32_f16 v[120:123], v[44:47], v[72:75], 0
  v_bitop3_b32 v27, v72, s61, 1 bitop3:0x28
  v_cmp_ne_u32 vcc, 0, v27
  s_nop 1
  s_cbranch_vccz pg_201
  buffer_load_dwordx4 v[72:75], v16, s[4:7], s60 offen sc1
pp_200:
  s_waitcnt vmcnt(1)
  v_mfma_f32_16x16x32_f16 v[120:123], v[44:47], v[68:71], 0
  v_bitop3_b32 v27, v68, s61, 1 bitop3:0x28
  v_cmp_ne_u32 vcc, 0, v27
  s_nop 1
  s_cbranch_vccz pg_201
  buffer_load_dwordx4 v[68:71], v16, s[4:7], s60 offen sc1
  s_waitcnt vmcnt(1)
  v_mfma_f32_16x16x32_f16 v[120:123], v[44:47], v[72:75], 0
  v_bitop3_b32 v27, v72, s61, 1 bitop3:0x28
  v_cmp_ne_u32 vcc, 0, v27
  s_nop 1
  s_cbranch_vccz pg_201
  buffer_load_dwordx4 v[72:75], v16, s[4:7], s60 offen sc1
  s_add_u32 s54, s54, 1
  s_cmp_gt_u32 s54, 131072
  s_cbranch_scc1 end0
  s_branch pp_200
last_188:
  v_smfmac_f32_16x16x64_bf16 v[96:99], v[48:51], a[0:7], v22
  v_smfmac_f32_16x16x64_bf16 v[100:103], v[48:51], a[80:87], v22
  v_smfmac_f32_16x16x64_bf16 v[96:99], v[52:55], a[8:15], v22
  v_smfmac_f32_16x16x64_bf16 v[100:103], v[52:55], a[88:95], v22
  v_smfmac_f32_16x16x64_bf16 v[96:99], v[56:59], a[16:23], v22
  v_smfmac_f32_16x16x64_bf16 v[100:103], v[56:59], a[96:103], v22
  v_smfmac_f32_16x16x64_bf16 v[96:99], v[60:63], a[24:31], v22
  v_smfmac_f32_16x16x64_bf16 v[96:99], v[64:67], a[32:39], v22
  v_smfmac_f32_16x16x64_bf16 v[96:99], v[68:71], a[40:47], v22
  v_smfmac_f32_16x16x64_bf16 v[96:99], v[72:75], a[48:55], v22
  v_smfmac_f32_16x16x64_bf16 v[96:99], v[76:79], a[56:63], v22
  v_smfmac_f32_16x16x64_bf16 v[96:99], v[80:83], a[64:71], v22
  v_smfmac_f32_16x16x64_bf16 v[96:99], v[84:87], a[72:79], v22
  v_smfmac_f32_16x16x64_bf16 v[100:103], v[60:63], a[104:111], v22
  v_smfmac_f32_16x16x64_bf16 v[100:103], v[64:67], a[112:119], v22
  v_smfmac_f32_16x16x64_bf16 v[100:103], v[68:71], a[120:127], v22
  v_smfmac_f32_16x16x64_bf16 v[100:103], v[72:75], a[128:135], v22
  v_smfmac_f32_16x16x64_bf16 v[100:103], v[76:79], a[136:143], v22
  v_smfmac_f32_16x16x64_bf16 v[100:103], v[80:83], a[144:151], v22
  v_smfmac_f32_16x16x64_bf16 v[100:103], v[84:87], a[152:159], v22
  s_nop 7
  v_permlane32_swap_b32 v96, v100
  v_permlane32_swap_b32 v97, v101
  v_permlane32_swap_b32 v98, v102
  v_permlane32_swap_b32 v99, v103
  v_pk_add_f32 v[96:97], v[96:97], v[100:101]
  v_pk_add_f32 v[98:99], v[98:99], v[102:103]
  v_cvt_pk_bf16_f32 v100, v96, v97
  v_cvt_pk_bf16_f32 v101, v98, v99
  s_nop 0
  v_permlane32_swap_b32 v100, v102
  v_permlane32_swap_b32 v101, v103
  v_min_u32 v100, -2, v100
  buffer_store_dwordx4 v[100:103], v26, s[16:19], s70 offen sc1
  s_waitcnt vmcnt(0)
  s_barrier
  s_branch chain_done
E_31:
  v_add_u32 v190, 7168, v4
  ds_write_b32 v13, v28
  ds_write_b32 v14, v28
  s_waitcnt vmcnt(0)
  ds_write_b128 v190, v[76:79] offset:0
  ds_write_b128 v190, v[80:83] offset:1024
  ds_write_b128 v190, v[84:87] offset:2048
  s_waitcnt lgkmcnt(0)
  s_branch mo_214
  .p2align 3
top_209:
  s_waitcnt vmcnt(2)
  ds_write_b128 v190, v[76:79] offset:0
  v_cmp_eq_u32 s[22:23], -1, v76
  s_waitcnt vmcnt(1)
  ds_write_b128 v190, v[80:83] offset:1024
  v_cmp_eq_u32 s[98:99], -1, v80
  s_waitcnt vmcnt(0)
  ds_write_b128 v190, v[84:87] offset:2048
  v_cmp_eq_u32 s[100:101], -1, v84
  s_or_b64 vcc, s[22:23], s[98:99]
  s_or_b64 vcc, vcc, s[100:101]
  s_cbranch_scc1 mr_210
mo_214:
  s_barrier
  ds_read_b128 v[48:51], v4 offset:0
  ds_read_b128 v[52:55], v4 offset:1024
  v_smfmac_f32_16x16x64_bf16 v[92:95], v[76:79], v[232:239], v22
  ds_read_b128 v[56:59], v4 offset:2048
  ds_read_b128 v[60:63], v4 offset:3072
  v_smfmac_f32_16x16x64_bf16 v[88:91], v[76:79], a[216:223], v22
  s_add_u32 m0, s74, 0
  s_add_u32 s21, s79, 0
  buffer_load_dwordx4 v4, s[16:19], s21 offen offset:1024 sc1 lds
  v_smfmac_f32_16x16x64_bf16 v[92:95], v[80:83], v[240:247], v22
  ds_read_b128 v[64:67], v4 offset:4096
  ds_read_b128 v[68:71], v4 offset:5120
  s_add_u32 s22, s52, 3
  s_min_u32 s22, s22, 64
  v_smfmac_f32_16x16x64_bf16 v[88:91], v[80:83], a[224:231], v22
  s_add_u32 m0, s74, 2048
  s_add_u32 s21, s79, 65536
  buffer_load_dwordx4 v4, s[16:19], s21 offen offset:1024 sc1 lds
  v_cmp_gt_u32 vcc, s22, v42
  v_smfmac_f32_16x16x64_bf16 v[92:95], v[84:87], v[248:255], v22
  ds_read_b128 v[72:75], v4 offset:6144
  s_cbranch_vccnz kw_215
kv_216:
  v_smfmac_f32_16x16x64_bf16 v[88:91], v[84:87], a[232:239], v22
  s_waitcnt lgkmcnt(6)
  s_add_u32 m0, s74, 10240
  s_nop 0
  buffer_load_dwordx4 v4, s[16:19], s73 offen offset:0 sc1 lds
  v_smfmac_f32_16x16x64_bf16 v[92:95], v[48:51], a[240:247], v22
  v_smfmac_f32_16x16x64_bf16 v[88:91], v[48:51], a[160:167], v22
  s_waitcnt lgkmcnt(5)
  s_add_u32 m0, s74, 10240
  s_nop 0
  buffer_load_dwordx4 v4, s[16:19], s73 offen offset:1024 sc1 lds
  v_smfmac_f32_16x16x64_bf16 v[92:95], v[52:55], a[248:255], v22
  s_waitcnt lgkmcnt(4)
  v_smfmac_f32_16x16x64_bf16 v[92:95], v[56:59], v[192:199], v22
  s_waitcnt lgkmcnt(3)
  s_add_u32 m0, s74, 10240
  s_nop 0
  buffer_load_dwordx4 v4, s[16:19], s73 offen offset:2048 sc1 lds
  v_smfmac_f32_16x16x64_bf16 v[92:95], v[60:63], v[200:207], v22
  s_waitcnt lgkmcnt(2)
  v_smfmac_f32_16x16x64_bf16 v[92:95], v[64:67], v[208:215], v22
  s_waitcnt lgkmcnt(1)
  s_add_u32 m0, s74, 0
  s_mul_i32 s21, s91, 0
  s_add_u32 s21, s21, s71
  buffer_load_dwordx4 v4, s[16:19], s21 offen sc1 lds
  v_smfmac_f32_16x16x64_bf16 v[92:95], v[68:71], v[216:223], v22
  s_waitcnt lgkmcnt(0)
  v_smfmac_f32_16x16x64_bf16 v[92:95], v[72:75], v[224:231], v22
  s_add_u32 m0, s74, 2048
  s_mul_i32 s21, s91, 1
  s_add_u32 s21, s21, s71
  buffer_load_dwordx4 v4, s[16:19], s21 offen sc1 lds
  v_smfmac_f32_16x16x64_bf16 v[88:91], v[52:55], a[168:175], v22
  v_smfmac_f32_16x16x64_bf16 v[88:91], v[56:59], a[176:183], v22
  v_smfmac_f32_16x16x64_bf16 v[88:91], v[60:63], a[184:191], v22
  v_cvt_pk_bf16_f32 v122, v92, v93
  v_smfmac_f32_16x16x64_bf16 v[88:91], v[64:67], a[192:199], v22
  v_cvt_pk_bf16_f32 v123, v94, v95
  s_barrier
  v_smfmac_f32_16x16x64_bf16 v[88:91], v[68:71], a[200:207], v22
  ds_write_b64 v12, v[122:123] offset:13056
  v_smfmac_f32_16x16x64_bf16 v[88:91], v[72:75], a[208:215], v22
  v_smfmac_f32_16x16x64_bf16 v[96:99], v[48:51], a[0:7], v22
  v_smfmac_f32_16x16x64_bf16 v[100:103], v[48:51], a[80:87], v22
  v_smfmac_f32_16x16x64_bf16 v[96:99], v[52:55], a[8:15], v22
  v_cvt_pk_bf16_f32 v120, v88, v89
  v_cvt_pk_bf16_f32 v121, v90, v91
  ds_write_b64 v12, v[120:121] offset:12544
  v_smfmac_f32_16x16x64_bf16 v[100:103], v[52:55], a[88:95], v22
  s_waitcnt lgkmcnt(0)
  s_barrier
  ds_read_b64_tr_b16 v[104:105], v7 offset:0
  ds_read_b64_tr_b16 v[106:107], v7 offset:768
  ds_read_b64_tr_b16 v[108:109], v7 offset:1536
  ds_read_b32 v27, v12 offset:12544
  ds_read_b64 v[140:141], v11
  s_waitcnt lgkmcnt(1)
  v_cmp_u_f32 vcc, v104, v106
  v_cmp_u_f32 s[22:23], v108, v27
  s_nop 1
  s_or_b64 vcc, vcc, s[22:23]
  s_cbranch_vccnz mn_211
mk_212:
  s_cmp_eq_u32 s52, 63
  s_cbranch_scc1 last_213
  v_permlane32_swap_b32 v88, v92
  v_permlane32_swap_b32 v89, v93
  v_permlane32_swap_b32 v90, v94
  v_permlane32_swap_b32 v91, v95
  v_pk_add_f32 v[88:89], v[88:89], v[92:93]
  v_pk_add_f32 v[90:91], v[90:91], v[94:95]
  v_cvt_pk_bf16_f32 v92, v88, v89
  v_cvt_pk_bf16_f32 v93, v90, v91
  v_min_u32 v92, -2, v92
  s_nop 0
  v_smfmac_f32_16x16x64_bf16 v[96:99], v[56:59], a[16:23], v22
  v_smfmac_f32_16x16x64_bf16 v[100:103], v[56:59], a[96:103], v22
  v_smfmac_f32_16x16x64_bf16 v[96:99], v[60:63], a[24:31], v22
  v_smfmac_f32_16x16x64_bf16 v[96:99], v[64:67], a[32:39], v22
  v_smfmac_f32_16x16x64_bf16 v[96:99], v[68:71], a[40:47], v22
  v_smfmac_f32_16x16x64_bf16 v[96:99], v[72:75], a[48:55], v22
  v_smfmac_f32_16x16x64_bf16 v[96:99], v[76:79], a[56:63], v22
  v_smfmac_f32_16x16x64_bf16 v[96:99], v[80:83], a[64:71], v22
  v_smfmac_f32_16x16x64_bf16 v[96:99], v[84:87], a[72:79], v22
  v_smfmac_f32_16x16x64_bf16 v[100:103], v[60:63], a[104:111], v22
  v_smfmac_f32_16x16x64_bf16 v[100:103], v[64:67], a[112:119], v22
  buffer_load_dwordx4 v[132:135], v10, s[8:11], s56 offen sc1
  v_smfmac_f32_16x16x64_bf16 v[100:103], v[68:71], a[120:127], v22
  buffer_load_dwordx4 v[124:127], v9, s[8:11], s56 offen sc1
  v_smfmac_f32_16x16x64_bf16 v[100:103], v[72:75], a[128:135], v22
  buffer_load_dwordx4 v[128:131], v9, s[8:11], s56 offen offset:1024 sc1
  v_cvt_pk_bf16_f32 v136, v96, v97
  v_smfmac_f32_16x16x64_bf16 v[100:103], v[76:79], a[136:143], v22
  v_cvt_pk_bf16_f32 v137, v98, v99
  v_smfmac_f32_16x16x64_bf16 v[100:103], v[80:83], a[144:151], v22
  v_smfmac_f32_16x16x64_bf16 v[100:103], v[84:87], a[152:159], v22
  s_nop 7
  v_cvt_pk_bf16_f32 v138, v100, v101
  v_cvt_pk_bf16_f32 v139, v102, v103
  v_permlane32_swap_b32 v96, v100
  v_permlane32_swap_b32 v97, v101
  v_permlane32_swap_b32 v98, v102
  v_permlane32_swap_b32 v99, v103
  v_pk_add_f32 v[96:97], v[96:97], v[100:101]
  v_pk_add_f32 v[98:99], v[98:99], v[102:103]
  v_cvt_pk_bf16_f32 v100, v96, v97
  v_cvt_pk_bf16_f32 v101, v98, v99
  s_nop 0
  v_permlane32_swap_b32 v100, v102
  v_permlane32_swap_b32 v101, v103
  v_min_u32 v100, -2, v100
  s_waitcnt vmcnt(2) lgkmcnt(0)
  v_pk_add_f16 v164, v132, v133
  v_pk_add_f16 v165, v134, v135
  v_fma_mix_f32 v170, v164, 1.0, v165 op_sel:[0,0,0] op_sel_hi:[1,0,1]
  v_fma_mix_f32 v171, v164, 1.0, v165 op_sel:[1,0,1] op_sel_hi:[1,0,1]
  v_exp_f32 v176, v170
  v_exp_f32 v177, v171
  s_waitcnt vmcnt(1)
  v_cvt_pk_bf16_f32 v160, v176, v177
  v_pk_add_f16 v120, v124, v126
  v_pk_add_f16 v121, v125, v127
  v_mov_b32_dpp v161, v160 row_ror:8 row_mask:0xf bank_mask:0xf
  s_waitcnt vmcnt(0)
  v_pk_add_f16 v122, v128, v130
  v_mfma_f32_16x16x32_bf16 v[178:181], v[140:143], v[160:163], 0
  v_fma_mix_f32 v166, v120, 1.0, v122 op_sel:[0,0,0] op_sel_hi:[1,0,1]
  v_fma_mix_f32 v167, v120, 1.0, v122 op_sel:[1,0,1] op_sel_hi:[1,0,1]
  v_cmp_u_f32 vcc, v166, v170
  v_pk_add_f16 v123, v129, v131
  v_exp_f32 v172, v166
  v_mfma_f32_16x16x32_bf16 v[182:185], v[136:139], v[160:163], 0
  s_cbranch_vccnz sr_219
  v_exp_f32 v173, v167
  v_fma_mix_f32 v168, v121, 1.0, v123 op_sel:[0,0,0] op_sel_hi:[1,0,1]
  v_fma_mix_f32 v169, v121, 1.0, v123 op_sel:[1,0,1] op_sel_hi:[1,0,1]
  v_cvt_pk_bf16_f32 v156, v172, v173
  v_exp_f32 v174, v168
  v_exp_f32 v175, v169
  v_mov_b32_dpp v158, v156 row_ror:8 row_mask:0xf bank_mask:0xf
  v_cvt_pk_bf16_f32 v157, v174, v175
  v_mfma_f32_16x16x32_bf16 v[186:189], v[138:141], v[160:163], 0
  s_nop 0
  v_mov_b32_dpp v159, v157 row_ror:8 row_mask:0xf bank_mask:0xf
  s_nop 1
pv_220:
  v_mfma_f32_16x16x32_bf16 v[178:181], v[152:155], v[156:159], v[178:181]
  v_mfma_f32_16x16x32_bf16 v[182:185], v[144:147], v[156:159], v[182:185]
  v_mfma_f32_16x16x32_bf16 v[186:189], v[148:151], v[156:159], v[186:189]
  s_mov_b64 exec, s[62:63]
  s_nop 0
  v_rcp_f32 v164, v180
  v_cmp_ngt_f32 s[22:23], s80, v180
  v_cmp_ngt_f32 vcc, s80, v164
  v_pk_mul_f32 v[182:183], v[182:183], v[164:165] op_sel_hi:[1,0]
  v_pk_mul_f32 v[184:185], v[184:185], v[164:165] op_sel_hi:[1,0]
  v_pk_mul_f32 v[178:179], v[178:179], v[164:165] op_sel_hi:[1,0]
  v_pk_mul_f32 v[186:187], v[186:187], v[164:165] op_sel_hi:[1,0]
  v_pk_mul_f32 v[188:189], v[188:189], v[164:165] op_sel_hi:[1,0]
  v_cvt_pk_f16_f32 v64, v178, v179
  s_or_b64 vcc, vcc, s[22:23]
  s_cbranch_scc1 fx_222
fk_223:
  ds_write_b32 v14, v64
  v_cvt_pk_f16_f32 v60, v182, v183
  v_cvt_pk_f16_f32 v61, v184, v185
  v_cvt_pk_f16_f32 v62, v186, v187
  v_cvt_pk_f16_f32 v63, v188, v189
  ds_write_b128 v13, v[60:63]
  s_mov_b64 exec, s[66:67]
  s_barrier
  ds_read_b128 v[166:169], v4 offset:13824
  ds_read_b128 v[170:173], v4 offset:14464
  ds_read_b128 v[174:177], v4 offset:15104
  ds_read_b128 v[178:181], v4 offset:15744
  s_waitcnt lgkmcnt(2)
  v_pk_add_f16 v166, v166, v170
  v_pk_add_f16 v167, v167, v171
  v_pk_add_f16 v168, v168, v172
  v_pk_add_f16 v169, v169, v173
  s_waitcnt lgkmcnt(1)
  v_pk_add_f16 v166, v166, v174
  v_pk_add_f16 v167, v167, v175
  v_pk_add_f16 v168, v168, v176
  v_pk_add_f16 v169, v169, v177
  s_waitcnt lgkmcnt(0)
  v_pk_add_f16 v166, v166, v178
  v_cmpx_o_f16 vcc, v166, v166
  v_pk_add_f16 v167, v167, v179
  v_pk_add_f16 v168, v168, v180
  v_pk_add_f16 v169, v169, v181
  v_and_or_b32 v166, v166, -2, s61
  buffer_store_dwordx4 v[166:169], v15, s[4:7], s60 offen sc1
  s_xor_b64 s[98:99], exec, s[66:67]
  s_mov_b64 exec, -1
  buffer_store_dwordx4 v[100:103], v26, s[16:19], s70 offen sc1
  buffer_store_dwordx2 v[92:93], v43, s[16:19], s70 offen sc1
  s_add_u32 s70, s70, 2097152
  s_xor_b32 s70, s70, 8192
  ds_read_b128 v[144:147], v18
  ds_read_b128 v[148:151], v18 offset:1024
  ds_read_b128 v[152:155], v19
  v_xor_b32 v18, 16384, v18
  v_xor_b32 v19, 16384, v19
  v_mov_b32 v88, 0
  v_mov_b32 v89, 0
  v_mov_b32 v90, 0
  v_mov_b32 v91, 0
  v_mov_b32 v92, 0
  v_mov_b32 v93, 0
  v_mov_b32 v94, 0
  v_mov_b32 v95, 0
  v_mov_b32 v96, 0
  v_mov_b32 v97, 0
  v_mov_b32 v98, 0
  v_mov_b32 v99, 0
  v_mov_b32 v100, 0
  v_mov_b32 v101, 0
  v_mov_b32 v102, 0
  v_mov_b32 v103, 0
  s_mov_b32 s81, 0
  s_waitcnt lgkmcnt(0)
  s_barrier
  s_cmp_lg_u64 s[98:99], 0
  s_cbranch_scc1 pf_224
pf_225:
  s_xor_b32 s74, s74, 16384
  s_add_u32 s73, s73, 2097152
  s_xor_b32 s73, s73, 8192
  s_add_u32 s79, s79, 2097152
  s_xor_b32 s79, s79, 8192
  s_add_u32 s21, s72, 524288
  s_xor_b32 s72, s72, s21
  s_lshr_b32 s72, s72, 8
  s_and_b32 s72, s72, 8192
  s_xor_b32 s72, s72, s21
  s_add_u32 s71, s73, 4096
  s_mov_b32 s91, 1024
  s_sub_u32 s21, s73, 0
  s_cmp_lt_u32 s21, 125829120
  s_cselect_b32 s71, s71, s79
  s_cselect_b32 s91, s91, 65536
  v_mov_b32 v166, s52
  s_add_u32 s22, s52, 5
  s_min_u32 s22, s22, 64
  v_cmp_gt_u32 vcc, s22, v42
  s_cbranch_vccz fv_227
  buffer_load_dword v42, v41, s[12:15], s76 offen sc1
fv_227:
  ds_write_b128 v190, v[28:31] offset:0
  ds_write_b128 v190, v[28:31] offset:1024
  ds_write_b128 v190, v[28:31] offset:2048
nt_226:
  s_barrier
  s_mov_b32 s58, s55
  s_add_u32 s52, s52, 1
  ds_write_b32 v13, v28
  ds_write_b32 v14, v28
  s_and_b32 s21, s52, 3
  s_mul_i32 s56, s21, 122880
  s_add_u32 s21, s52, 1
  s_and_b32 s21, s21, 3
  s_mul_i32 s55, s21, 122880
  s_add_u32 s55, s55, s75
  s_add_u32 s21, s52, 2
  s_and_b32 s21, s21, 3
  s_mul_i32 s57, s21, 122880
  s_add_u32 s21, s52, 3
  s_and_b32 s21, s21, 3
  s_mul_i32 s59, s21, 122880
  s_add_u32 s59, s59, s75
  s_bfe_u32 s61, s52, 0x10002
  s_and_b32 s21, s52, 3
  s_lshl_b32 s60, s21, 18
  s_mov_b32 s54, 0
  s_sleep 2
  s_nop 10
  s_waitcnt lgkmcnt(0)
  buffer_load_dwordx4 v[76:79], v190, s[8:11], s58 offen offset:0 sc1
  buffer_load_dwordx4 v[80:83], v190, s[8:11], s58 offen offset:1024 sc1
  buffer_load_dwordx4 v[84:87], v190, s[8:11], s58 offen offset:2048 sc1
  s_branch top_209
mr_210:
  s_mov_b64 exec, s[22:23]
  s_cbranch_execz ms_228
  buffer_load_dwordx4 v[76:79], v190, s[8:11], s58 offen offset:0 sc1
ms_228:
  s_mov_b64 exec, s[98:99]
  s_cbranch_execz ms_229
  buffer_load_dwordx4 v[80:83], v190, s[8:11], s58 offen offset:1024 sc1
ms_229:
  s_mov_b64 exec, s[100:101]
  s_cbranch_execz ms_230
  buffer_load_dwordx4 v[84:87], v190, s[8:11], s58 offen offset:2048 sc1
ms_230:
  s_add_u32 s54, s54, 1
  s_cmp_gt_u32 s54, 131072
  s_cbranch_scc1 end0
  s_waitcnt vmcnt(0)
  s_mov_b64 exec, s[22:23]
  ds_write_b128 v190, v[76:79] offset:0
  v_cmp_eq_u32 s[22:23], -1, v76
  s_mov_b64 exec, s[98:99]
  ds_write_b128 v190, v[80:83] offset:1024
  v_cmp_eq_u32 s[98:99], -1, v80
  s_mov_b64 exec, s[100:101]
  ds_write_b128 v190, v[84:87] offset:2048
  v_cmp_eq_u32 s[100:101], -1, v84
  s_mov_b64 exec, -1
  s_or_b64 vcc, s[22:23], s[98:99]
  s_or_b64 vcc, vcc, s[100:101]
  s_cbranch_scc1 mr_210
  s_branch mo_214
kw_215:
  s_mov_b32 s101, 0
wm_231:
  buffer_load_dword v42, v41, s[12:15], s76 offen sc1
  s_add_u32 s101, s101, 1
  s_cmp_gt_u32 s101, 131072
  s_cbranch_scc1 end0
  s_waitcnt vmcnt(0)
  v_cmp_gt_u32 vcc, s22, v42
  v_readfirstlane_b32 s100, v42
  s_nop 0
  s_cbranch_vccz wm_232
  s_sleep 1
  s_branch wm_231
wm_232:
  s_branch kv_216
mn_211:
  s_bitcmp1_b32 s81, 1
  s_cbranch_scc1 mk_212
  s_or_b32 s81, s81, 2
  s_nop 7
  v_mov_b32 v88, 0
  v_mov_b32 v89, 0
  v_mov_b32 v90, 0
  v_mov_b32 v91, 0
  v_mov_b32 v92, 0
  v_mov_b32 v93, 0
  v_mov_b32 v94, 0
  v_mov_b32 v95, 0
  v_mov_b32 v96, 0
  v_mov_b32 v97, 0
  v_mov_b32 v98, 0
  v_mov_b32 v99, 0
  v_mov_b32 v100, 0
  v_mov_b32 v101, 0
  v_mov_b32 v102, 0
  v_mov_b32 v103, 0
  s_cmp_eq_u32 s52, 0
  s_cbranch_scc1 mx_234
mx_233:
  buffer_load_dwordx4 v[76:79], v190, s[8:11], s58 offen offset:0 sc1
  buffer_load_dwordx4 v[80:83], v190, s[8:11], s58 offen offset:1024 sc1
  buffer_load_dwordx4 v[84:87], v190, s[8:11], s58 offen offset:2048 sc1
  s_add_u32 s54, s54, 1
  s_cmp_gt_u32 s54, 131072
  s_cbranch_scc1 end0
  s_waitcnt vmcnt(0)
  v_max3_u32 v27, v76, v77, v78
  v_max3_u32 v27, v27, v79, v80
  v_max3_u32 v27, v27, v81, v82
  v_max3_u32 v27, v27, v83, v84
  v_max3_u32 v27, v27, v85, v86
  v_max3_u32 v27, v27, v87, v87
  v_cmp_eq_u32 vcc, -1, v27
  s_nop 1
  s_cbranch_vccnz mx_233
  ds_write_b128 v190, v[76:79] offset:0
  ds_write_b128 v190, v[80:83] offset:1024
  ds_write_b128 v190, v[84:87] offset:2048
mx_234:
  s_waitcnt lgkmcnt(0)
  s_branch mo_214
sr_219:
  s_mov_b32 s54, 0
sr_235:
  s_mov_b64 exec, vcc
  buffer_load_dwordx4 v[124:127], v9, s[8:11], s56 offen sc1
  buffer_load_dwordx4 v[128:131], v9, s[8:11], s56 offen offset:1024 sc1
  buffer_load_dwordx4 v[132:135], v10, s[8:11], s56 offen sc1
  s_mov_b64 exec, -1
  s_add_u32 s54, s54, 1
  s_cmp_gt_u32 s54, 131072
  s_cbranch_scc1 end0
  s_waitcnt vmcnt(0)
  v_pk_add_f16 v164, v132, v133
  v_pk_add_f16 v165, v134, v135
  v_pk_add_f16 v120, v124, v126
  v_pk_add_f16 v122, v128, v130
  v_fma_mix_f32 v170, v164, 1.0, v165 op_sel:[0,0,0] op_sel_hi:[1,0,1]
  v_fma_mix_f32 v166, v120, 1.0, v122 op_sel:[0,0,0] op_sel_hi:[1,0,1]
  v_pk_add_f16 v121, v125, v127
  v_cmp_u_f32 vcc, v166, v170
  v_pk_add_f16 v123, v129, v131
  v_fma_mix_f32 v171, v164, 1.0, v165 op_sel:[1,0,1] op_sel_hi:[1,0,1]
  v_fma_mix_f32 v167, v120, 1.0, v122 op_sel:[1,0,1] op_sel_hi:[1,0,1]
  v_fma_mix_f32 v168, v121, 1.0, v123 op_sel:[0,0,0] op_sel_hi:[1,0,1]
  v_fma_mix_f32 v169, v121, 1.0, v123 op_sel:[1,0,1] op_sel_hi:[1,0,1]
  s_cbranch_vccz ex_221
  s_and_b32 s21, s54, 31
  s_cbranch_scc1 sr_235
  v_max3_u32 v27, v124, v126, v128
  v_max3_u32 v27, v27, v130, v132
  v_max3_u32 v27, v27, v133, v134
  v_max3_u32 v27, v27, v135, v135
  v_cmp_eq_u32 vcc, -1, v27
  s_nop 1
  s_cbranch_vccnz sr_235
ex_221:
  v_exp_f32 v176, v170
  v_exp_f32 v177, v171
  v_exp_f32 v172, v166
  v_cvt_pk_bf16_f32 v160, v176, v177
  v_exp_f32 v173, v167
  v_exp_f32 v174, v168
  v_mov_b32_dpp v161, v160 row_ror:8 row_mask:0xf bank_mask:0xf
  v_cvt_pk_bf16_f32 v156, v172, v173
  v_exp_f32 v175, v169
  v_mfma_f32_16x16x32_bf16 v[178:181], v[140:143], v[160:163], 0
  v_mov_b32_dpp v158, v156 row_ror:8 row_mask:0xf bank_mask:0xf
  v_cvt_pk_bf16_f32 v157, v174, v175
  v_mfma_f32_16x16x32_bf16 v[182:185], v[136:139], v[160:163], 0
  s_nop 0
  v_mov_b32_dpp v159, v157 row_ror:8 row_mask:0xf bank_mask:0xf
  v_mfma_f32_16x16x32_bf16 v[186:189], v[138:141], v[160:163], 0
  s_branch pv_220
fx_222:
  s_bitcmp1_b32 s81, 0
  s_cbranch_scc1 fk_223
  s_or_b32 s81, s81, 1
  s_mov_b64 exec, -1
  v_max3_f32 v164, v166, v167, v168
  v_max3_f32 v165, v169, v170, v171
  v_max_f32 v164, v164, v165
  s_nop 1
  v_max_f32_dpp v164, v164, v164 row_ror:8 row_mask:0xf bank_mask:0xf
  v_mov_b32 v165, v164
  s_nop 1
  v_permlane32_swap_b32 v164, v165
  v_max_f32 v164, v164, v165
  v_mov_b32 v165, v164
  s_nop 1
  v_permlane16_swap_b32 v164, v165
  v_max_f32 v164, v164, v165
  v_sub_f32 v166, v166, v164
  v_sub_f32 v167, v167, v164
  v_sub_f32 v168, v168, v164
  v_sub_f32 v169, v169, v164
  v_sub_f32 v170, v170, v164
  v_sub_f32 v171, v171, v164
  s_branch ex_221
pf_224:
  s_mov_b64 exec, s[66:67]
  ds_read_b128 v[166:169], v4 offset:13824
  ds_read_b128 v[170:173], v4 offset:14464
  ds_read_b128 v[174:177], v4 offset:15104
  ds_read_b128 v[178:181], v4 offset:15744
  s_waitcnt lgkmcnt(2)
  v_pk_add_f16 v166, v166, v170
  v_pk_add_f16 v167, v167, v171
  v_pk_add_f16 v168, v168, v172
  v_pk_add_f16 v169, v169, v173
  s_waitcnt lgkmcnt(1)
  v_pk_add_f16 v166, v166, v174
  v_pk_add_f16 v167, v167, v175
  v_pk_add_f16 v168, v168, v176
  v_pk_add_f16 v169, v169, v177
  s_waitcnt lgkmcnt(0)
  v_pk_add_f16 v166, v166, v178
  v_pk_add_f16 v167, v167, v179
  v_pk_add_f16 v168, v168, v180
  v_pk_add_f16 v169, v169, v181
  v_and_or_b32 v166, v166, -2, s61
  buffer_store_dwordx4 v[166:169], v15, s[4:7], s60 offen sc1
  s_mov_b64 exec, -1
  s_nop 1
  s_branch pf_225
last_213:
  v_permlane32_swap_b32 v88, v92
  v_permlane32_swap_b32 v89, v93
  v_permlane32_swap_b32 v90, v94
  v_permlane32_swap_b32 v91, v95
  v_pk_add_f32 v[88:89], v[88:89], v[92:93]
  v_pk_add_f32 v[90:91], v[90:91], v[94:95]
  v_cvt_pk_bf16_f32 v92, v88, v89
  v_cvt_pk_bf16_f32 v93, v90, v91
  v_min_u32 v92, -2, v92
  buffer_store_dwordx2 v[92:93], v43, s[16:19], s70 offen sc1
  v_smfmac_f32_16x16x64_bf16 v[96:99], v[56:59], a[16:23], v22
  v_smfmac_f32_16x16x64_bf16 v[100:103], v[56:59], a[96:103], v22
  v_smfmac_f32_16x16x64_bf16 v[96:99], v[60:63], a[24:31], v22
  v_smfmac_f32_16x16x64_bf16 v[96:99], v[64:67], a[32:39], v22
  v_smfmac_f32_16x16x64_bf16 v[96:99], v[68:71], a[40:47], v22
  v_smfmac_f32_16x16x64_bf16 v[96:99], v[72:75], a[48:55], v22
  v_smfmac_f32_16x16x64_bf16 v[96:99], v[76:79], a[56:63], v22
  v_smfmac_f32_16x16x64_bf16 v[96:99], v[80:83], a[64:71], v22
  v_smfmac_f32_16x16x64_bf16 v[96:99], v[84:87], a[72:79], v22
  v_smfmac_f32_16x16x64_bf16 v[100:103], v[60:63], a[104:111], v22
  v_smfmac_f32_16x16x64_bf16 v[100:103], v[64:67], a[112:119], v22
  v_smfmac_f32_16x16x64_bf16 v[100:103], v[68:71], a[120:127], v22
  v_smfmac_f32_16x16x64_bf16 v[100:103], v[72:75], a[128:135], v22
  v_smfmac_f32_16x16x64_bf16 v[100:103], v[76:79], a[136:143], v22
  v_smfmac_f32_16x16x64_bf16 v[100:103], v[80:83], a[144:151], v22
  v_smfmac_f32_16x16x64_bf16 v[100:103], v[84:87], a[152:159], v22
  s_nop 7
  v_permlane32_swap_b32 v96, v100
  v_permlane32_swap_b32 v97, v101
  v_permlane32_swap_b32 v98, v102
  v_permlane32_swap_b32 v99, v103
  v_pk_add_f32 v[96:97], v[96:97], v[100:101]
  v_pk_add_f32 v[98:99], v[98:99], v[102:103]
  v_cvt_pk_bf16_f32 v100, v96, v97
  v_cvt_pk_bf16_f32 v101, v98, v99
  s_nop 0
  v_permlane32_swap_b32 v100, v102
  v_permlane32_swap_b32 v101, v103
  v_min_u32 v100, -2, v100
  buffer_store_dwordx4 v[100:103], v26, s[16:19], s70 offen sc1
  s_waitcnt vmcnt(0)
  s_barrier
  v_mov_b32 v166, 64
  s_mov_b64 exec, 1
  buffer_store_dword v166, v23, s[12:15], s77 offen sc1
  s_mov_b64 exec, -1
  s_branch chain_done
chain_done:
end0:
  s_endpgm
gemm_side:
  s_bfe_u32 s23, s22, 0x20005
  s_add_u32 s22, s22, 31
  s_and_b32 s22, s22, 31
  s_lshl_b32 s21, s23, 3
  s_add_u32 s2, s21, s22
  s_add_u32 s3, s2, 72
  s_add_u32 s24, s2, 48
  s_add_u32 s2, s2, s21
  s_cmp_lt_u32 s22, 24
  s_cselect_b32 s3, s24, s3
  s_cmp_lt_u32 s22, 16
  s_cselect_b32 s3, s2, s3
  s_mov_b32 s2, s3
  s_cmp_ge_u32 s3, 64
  s_cbranch_scc1 not_kv
  s_load_dwordx2 s[4:5], s[0:1], 0
  s_load_dwordx2 s[6:7], s[0:1], 24
  s_load_dwordx2 s[36:37], s[0:1], 32
  s_load_dwordx2 s[38:39], s[0:1], 104
  s_and_b32 s43, s3, 1
  s_bfe_u32 s42, s3, 0x50001
  s_lshr_b32 s40, s42, 2
  s_waitcnt lgkmcnt(0)
  s_cmp_eq_u32 s43, 1
  s_cselect_b32 s6, s36, s6
  s_cselect_b32 s7, s37, s7
  s_mov_b32 s8, s4
  s_mov_b32 s9, s5
  s_mov_b32 s10, 2621440
  s_mov_b32 s11, 0x00020000
  s_mov_b32 s12, s6
  s_mov_b32 s13, s7
  s_mov_b32 s14, 7864320
  s_mov_b32 s15, 0x00020000
  s_mov_b32 s16, s38
  s_mov_b32 s17, s39
  s_mov_b32 s18, 218103808
  s_mov_b32 s19, 0x00020000
  s_add_u32 s72, s38, 173080576
  s_addc_u32 s73, s39, 0
  s_mov_b32 s74, 49152
  s_mov_b32 s75, 0x00020000
  s_mul_i32 s44, s42, 384
  s_mov_b32 s30, 0
  s_mov_b32 s25, 80768
  v_lshrrev_b32 v4, 3, v1
  v_and_b32 v5, 7, v1
  v_xor_b32 v5, v5, v4
  s_mul_i32 s21, s20, 16
  v_add_u32 v4, s21, v4
  v_mul_u32_u24 v4, 1280, v4
  v_lshl_add_u32 v10, v5, 4, v4
  s_mul_i32 s31, s20, 2048
  v_add_u32 v11, 10240, v10
  s_mul_i32 s22, s20, 4
  s_and_b32 s22, s22, 1
  s_lshl_b32 s22, s22, 2
  s_mov_b32 s21, 12288
  v_add_u32 v30, 0, v1
  v_mul_u32_u24 v31, 2731, v30
  v_lshrrev_b32 v31, 16, v31
  v_mul_u32_u24 v4, 24, v31
  v_sub_u32 v30, v30, v4
  v_and_b32 v4, 2, v31
  v_xor_b32 v30, v30, v4
  v_xor_b32 v30, s22, v30
  v_mul_lo_u32 v31, v31, s21
  v_lshl_add_u32 v4, v30, 4, v31
  v_xor_b32 v7, 64, v4
  v_add_u32 v30, 64, v1
  v_mul_u32_u24 v31, 2731, v30
  v_lshrrev_b32 v31, 16, v31
  v_mul_u32_u24 v5, 24, v31
  v_sub_u32 v30, v30, v5
  v_and_b32 v5, 2, v31
  v_xor_b32 v30, v30, v5
  v_xor_b32 v30, s22, v30
  v_mul_lo_u32 v31, v31, s21
  v_lshl_add_u32 v5, v30, 4, v31
  v_xor_b32 v8, 64, v5
  v_add_u32 v30, 128, v1
  v_mul_u32_u24 v31, 2731, v30
  v_lshrrev_b32 v31, 16, v31
  v_mul_u32_u24 v6, 24, v31
  v_sub_u32 v30, v30, v6
  v_and_b32 v6, 2, v31
  v_xor_b32 v30, v30, v6
  v_xor_b32 v30, s22, v30
  v_mul_lo_u32 v31, v31, s21
  v_lshl_add_u32 v6, v30, 4, v31
  v_xor_b32 v9, 64, v6
  s_mul_i32 s21, s20, 393216
  s_add_u32 s21, s21, 0
  s_add_u32 s21, s21, s44
  s_mul_i32 s22, s20, 12288
  s_add_u32 s22, s22, 0
  s_add_u32 m0, s22, 0
  s_nop 0
  buffer_load_dwordx4 v4, s[12:15], s21 offen lds
  s_add_u32 m0, s22, 1024
  s_nop 0
  buffer_load_dwordx4 v5, s[12:15], s21 offen lds
  s_add_u32 m0, s22, 2048
  s_nop 0
  buffer_load_dwordx4 v6, s[12:15], s21 offen lds
  s_mul_i32 s21, s20, 393216
  s_add_u32 s21, s21, 98304
  s_add_u32 s21, s21, s44
  s_mul_i32 s22, s20, 12288
  s_add_u32 s22, s22, 3072
  s_add_u32 m0, s22, 0
  s_nop 0
  buffer_load_dwordx4 v7, s[12:15], s21 offen lds
  s_add_u32 m0, s22, 1024
  s_nop 0
  buffer_load_dwordx4 v8, s[12:15], s21 offen lds
  s_add_u32 m0, s22, 2048
  s_nop 0
  buffer_load_dwordx4 v9, s[12:15], s21 offen lds
  s_mul_i32 s21, s20, 393216
  s_add_u32 s21, s21, 196608
  s_add_u32 s21, s21, s44
  s_mul_i32 s22, s20, 12288
  s_add_u32 s22, s22, 6144
  s_add_u32 m0, s22, 0
  s_nop 0
  buffer_load_dwordx4 v4, s[12:15], s21 offen lds
  s_add_u32 m0, s22, 1024
  s_nop 0
  buffer_load_dwordx4 v5, s[12:15], s21 offen lds
  s_add_u32 m0, s22, 2048
  s_nop 0
  buffer_load_dwordx4 v6, s[12:15], s21 offen lds
  s_mul_i32 s21, s20, 393216
  s_add_u32 s21, s21, 294912
  s_add_u32 s21, s21, s44
  s_mul_i32 s22, s20, 12288
  s_add_u32 s22, s22, 9216
  s_add_u32 m0, s22, 0
  s_nop 0
  buffer_load_dwordx4 v7, s[12:15], s21 offen lds
  s_add_u32 m0, s22, 1024
  s_nop 0
  buffer_load_dwordx4 v8, s[12:15], s21 offen lds
  s_add_u32 m0, s22, 2048
  s_nop 0
  buffer_load_dwordx4 v9, s[12:15], s21 offen lds
  s_add_u32 m0, s31, 98304
  s_nop 0
  buffer_load_dwordx4 v10, s[8:11], s30 offen lds
  s_add_u32 m0, s31, 99328
  s_nop 0
  buffer_load_dwordx4 v11, s[8:11], s30 offen lds
  s_add_u32 s30, s30, 128
  s_add_u32 m0, s31, 106496
  s_nop 0
  buffer_load_dwordx4 v10, s[8:11], s30 offen lds
  s_add_u32 m0, s31, 107520
  s_nop 0
  buffer_load_dwordx4 v11, s[8:11], s30 offen lds
  s_add_u32 s30, s30, 128
  s_add_u32 m0, s31, 114688
  s_nop 0
  buffer_load_dwordx4 v10, s[8:11], s30 offen lds
  s_add_u32 m0, s31, 115712
  s_nop 0
  buffer_load_dwordx4 v11, s[8:11], s30 offen lds
  s_add_u32 s30, s30, 128
  s_add_u32 m0, s31, 122880
  s_nop 0
  buffer_load_dwordx4 v10, s[8:11], s30 offen lds
  s_add_u32 m0, s31, 123904
  s_nop 0
  buffer_load_dwordx4 v11, s[8:11], s30 offen lds
  s_add_u32 s30, s30, 128
  s_add_u32 m0, s31, 131072
  s_nop 0
  buffer_load_dwordx4 v10, s[8:11], s30 offen lds
  s_add_u32 m0, s31, 132096
  s_nop 0
  buffer_load_dwordx4 v11, s[8:11], s30 offen lds
  s_add_u32 s30, s30, 128
  s_add_u32 m0, s31, 139264
  s_nop 0
  buffer_load_dwordx4 v10, s[8:11], s30 offen lds
  s_add_u32 m0, s31, 140288
  s_nop 0
  buffer_load_dwordx4 v11, s[8:11], s30 offen lds
  s_add_u32 s30, s30, 128
  s_add_u32 m0, s31, 147456
  s_nop 0
  buffer_load_dwordx4 v10, s[8:11], s30 offen lds
  s_add_u32 m0, s31, 148480
  s_nop 0
  buffer_load_dwordx4 v11, s[8:11], s30 offen lds
  s_add_u32 s30, s30, 128
  s_add_u32 m0, s31, 155648
  s_nop 0
  buffer_load_dwordx4 v10, s[8:11], s30 offen lds
  s_add_u32 m0, s31, 156672
  s_nop 0
  buffer_load_dwordx4 v11, s[8:11], s30 offen lds
  s_add_u32 s30, s30, 128
  s_mul_i32 s21, s20, 393216
  s_add_u32 s21, s21, 1572864
  s_add_u32 s21, s21, s44
  s_mul_i32 s22, s20, 12288
  s_add_u32 s22, s22, 49152
  s_add_u32 m0, s22, 0
  s_nop 0
  buffer_load_dwordx4 v4, s[12:15], s21 offen lds
  s_add_u32 m0, s22, 1024
  s_nop 0
  buffer_load_dwordx4 v5, s[12:15], s21 offen lds
  s_add_u32 m0, s22, 2048
  s_nop 0
  buffer_load_dwordx4 v6, s[12:15], s21 offen lds
  s_mul_i32 s21, s20, 393216
  s_add_u32 s21, s21, 1671168
  s_add_u32 s21, s21, s44
  s_mul_i32 s22, s20, 12288
  s_add_u32 s22, s22, 52224
  s_add_u32 m0, s22, 0
  s_nop 0
  buffer_load_dwordx4 v7, s[12:15], s21 offen lds
  s_add_u32 m0, s22, 1024
  s_nop 0
  buffer_load_dwordx4 v8, s[12:15], s21 offen lds
  s_add_u32 m0, s22, 2048
  s_nop 0
  buffer_load_dwordx4 v9, s[12:15], s21 offen lds
  s_mul_i32 s21, s20, 393216
  s_add_u32 s21, s21, 1769472
  s_add_u32 s21, s21, s44
  s_mul_i32 s22, s20, 12288
  s_add_u32 s22, s22, 55296
  s_add_u32 m0, s22, 0
  s_nop 0
  buffer_load_dwordx4 v4, s[12:15], s21 offen lds
  s_add_u32 m0, s22, 1024
  s_nop 0
  buffer_load_dwordx4 v5, s[12:15], s21 offen lds
  s_add_u32 m0, s22, 2048
  s_nop 0
  buffer_load_dwordx4 v6, s[12:15], s21 offen lds
  s_mul_i32 s21, s20, 393216
  s_add_u32 s21, s21, 1867776
  s_add_u32 s21, s21, s44
  s_mul_i32 s22, s20, 12288
  s_add_u32 s22, s22, 58368
  s_add_u32 m0, s22, 0
  s_nop 0
  buffer_load_dwordx4 v7, s[12:15], s21 offen lds
  s_add_u32 m0, s22, 1024
  s_nop 0
  buffer_load_dwordx4 v8, s[12:15], s21 offen lds
  s_add_u32 m0, s22, 2048
  s_nop 0
  buffer_load_dwordx4 v9, s[12:15], s21 offen lds
  v_lshrrev_b32 v30, 2, v2
  v_lshl_add_u32 v30, v3, 3, v30
  v_mul_u32_u24 v30, 384, v30
  v_and_b32 v31, 3, v2
  v_lshl_add_u32 v30, v31, 3, v30
  v_lshrrev_b32 v31, 3, v1
  v_and_b32 v31, 3, v31
  v_lshlrev_b32 v31, 5, v31
  s_mul_i32 s21, s20, 96
  s_add_u32 s21, s21, 0
  v_xor_b32 v184, s21, v31
  v_add_u32 v184, v184, v30
  v_add_u32 v187, 49152, v184
  s_mul_i32 s21, s20, 96
  s_add_u32 s21, s21, 32
  v_xor_b32 v185, s21, v31
  v_add_u32 v185, v185, v30
  v_add_u32 v188, 49152, v185
  s_mul_i32 s21, s20, 96
  s_add_u32 s21, s21, 64
  v_xor_b32 v186, s21, v31
  v_add_u32 v186, v186, v30
  v_add_u32 v189, 49152, v186
  s_waitcnt vmcnt(12)
  s_barrier
  ds_read_b64_tr_b16 a[0:1], v184 offset:0
  ds_read_b64_tr_b16 a[2:3], v184 offset:1536
  ds_read_b64_tr_b16 a[4:5], v185 offset:0
  ds_read_b64_tr_b16 a[6:7], v185 offset:1536
  ds_read_b64_tr_b16 a[8:9], v186 offset:0
  ds_read_b64_tr_b16 a[10:11], v186 offset:1536
  ds_read_b64_tr_b16 a[12:13], v184 offset:12288
  ds_read_b64_tr_b16 a[14:15], v184 offset:13824
  ds_read_b64_tr_b16 a[16:17], v185 offset:12288
  ds_read_b64_tr_b16 a[18:19], v185 offset:13824
  ds_read_b64_tr_b16 a[20:21], v186 offset:12288
  ds_read_b64_tr_b16 a[22:23], v186 offset:13824
  ds_read_b64_tr_b16 a[24:25], v184 offset:24576
  ds_read_b64_tr_b16 a[26:27], v184 offset:26112
  ds_read_b64_tr_b16 a[28:29], v185 offset:24576
  ds_read_b64_tr_b16 a[30:31], v185 offset:26112
  ds_read_b64_tr_b16 a[32:33], v186 offset:24576
  ds_read_b64_tr_b16 a[34:35], v186 offset:26112
  ds_read_b64_tr_b16 a[36:37], v184 offset:36864
  ds_read_b64_tr_b16 a[38:39], v184 offset:38400
  ds_read_b64_tr_b16 a[40:41], v185 offset:36864
  ds_read_b64_tr_b16 a[42:43], v185 offset:38400
  ds_read_b64_tr_b16 a[44:45], v186 offset:36864
  ds_read_b64_tr_b16 a[46:47], v186 offset:38400
  s_waitcnt lgkmcnt(0)
  s_barrier
  s_mul_i32 s21, s20, 393216
  s_add_u32 s21, s21, 3145728
  s_add_u32 s21, s21, s44
  s_mul_i32 s22, s20, 12288
  s_add_u32 s22, s22, 0
  s_add_u32 m0, s22, 0
  s_nop 0
  buffer_load_dwordx4 v4, s[12:15], s21 offen lds
  s_add_u32 m0, s22, 1024
  s_nop 0
  buffer_load_dwordx4 v5, s[12:15], s21 offen lds
  s_add_u32 m0, s22, 2048
  s_nop 0
  buffer_load_dwordx4 v6, s[12:15], s21 offen lds
  s_mul_i32 s21, s20, 393216
  s_add_u32 s21, s21, 3244032
  s_add_u32 s21, s21, s44
  s_mul_i32 s22, s20, 12288
  s_add_u32 s22, s22, 3072
  s_add_u32 m0, s22, 0
  s_nop 0
  buffer_load_dwordx4 v7, s[12:15], s21 offen lds
  s_add_u32 m0, s22, 1024
  s_nop 0
  buffer_load_dwordx4 v8, s[12:15], s21 offen lds
  s_add_u32 m0, s22, 2048
  s_nop 0
  buffer_load_dwordx4 v9, s[12:15], s21 offen lds
  s_mul_i32 s21, s20, 393216
  s_add_u32 s21, s21, 3342336
  s_add_u32 s21, s21, s44
  s_mul_i32 s22, s20, 12288
  s_add_u32 s22, s22, 6144
  s_add_u32 m0, s22, 0
  s_nop 0
  buffer_load_dwordx4 v4, s[12:15], s21 offen lds
  s_add_u32 m0, s22, 1024
  s_nop 0
  buffer_load_dwordx4 v5, s[12:15], s21 offen lds
  s_add_u32 m0, s22, 2048
  s_nop 0
  buffer_load_dwordx4 v6, s[12:15], s21 offen lds
  s_mul_i32 s21, s20, 393216
  s_add_u32 s21, s21, 3440640
  s_add_u32 s21, s21, s44
  s_mul_i32 s22, s20, 12288
  s_add_u32 s22, s22, 9216
  s_add_u32 m0, s22, 0
  s_nop 0
  buffer_load_dwordx4 v7, s[12:15], s21 offen lds
  s_add_u32 m0, s22, 1024
  s_nop 0
  buffer_load_dwordx4 v8, s[12:15], s21 offen lds
  s_add_u32 m0, s22, 2048
  s_nop 0
  buffer_load_dwordx4 v9, s[12:15], s21 offen lds
  s_waitcnt vmcnt(12)
  s_barrier
  ds_read_b64_tr_b16 a[48:49], v187 offset:0
  ds_read_b64_tr_b16 a[50:51], v187 offset:1536
  ds_read_b64_tr_b16 a[52:53], v188 offset:0
  ds_read_b64_tr_b16 a[54:55], v188 offset:1536
  ds_read_b64_tr_b16 a[56:57], v189 offset:0
  ds_read_b64_tr_b16 a[58:59], v189 offset:1536
  ds_read_b64_tr_b16 a[60:61], v187 offset:12288
  ds_read_b64_tr_b16 a[62:63], v187 offset:13824
  ds_read_b64_tr_b16 a[64:65], v188 offset:12288
  ds_read_b64_tr_b16 a[66:67], v188 offset:13824
  ds_read_b64_tr_b16 a[68:69], v189 offset:12288
  ds_read_b64_tr_b16 a[70:71], v189 offset:13824
  ds_read_b64_tr_b16 a[72:73], v187 offset:24576
  ds_read_b64_tr_b16 a[74:75], v187 offset:26112
  ds_read_b64_tr_b16 a[76:77], v188 offset:24576
  ds_read_b64_tr_b16 a[78:79], v188 offset:26112
  ds_read_b64_tr_b16 a[80:81], v189 offset:24576
  ds_read_b64_tr_b16 a[82:83], v189 offset:26112
  ds_read_b64_tr_b16 a[84:85], v187 offset:36864
  ds_read_b64_tr_b16 a[86:87], v187 offset:38400
  ds_read_b64_tr_b16 a[88:89], v188 offset:36864
  ds_read_b64_tr_b16 a[90:91], v188 offset:38400
  ds_read_b64_tr_b16 a[92:93], v189 offset:36864
  ds_read_b64_tr_b16 a[94:95], v189 offset:38400
  s_waitcnt lgkmcnt(0)
  s_barrier
  s_mul_i32 s21, s20, 393216
  s_add_u32 s21, s21, 4718592
  s_add_u32 s21, s21, s44
  s_mul_i32 s22, s20, 12288
  s_add_u32 s22, s22, 49152
  s_add_u32 m0, s22, 0
  s_nop 0
  buffer_load_dwordx4 v4, s[12:15], s21 offen lds
  s_add_u32 m0, s22, 1024
  s_nop 0
  buffer_load_dwordx4 v5, s[12:15], s21 offen lds
  s_add_u32 m0, s22, 2048
  s_nop 0
  buffer_load_dwordx4 v6, s[12:15], s21 offen lds
  s_mul_i32 s21, s20, 393216
  s_add_u32 s21, s21, 4816896
  s_add_u32 s21, s21, s44
  s_mul_i32 s22, s20, 12288
  s_add_u32 s22, s22, 52224
  s_add_u32 m0, s22, 0
  s_nop 0
  buffer_load_dwordx4 v7, s[12:15], s21 offen lds
  s_add_u32 m0, s22, 1024
  s_nop 0
  buffer_load_dwordx4 v8, s[12:15], s21 offen lds
  s_add_u32 m0, s22, 2048
  s_nop 0
  buffer_load_dwordx4 v9, s[12:15], s21 offen lds
  s_mul_i32 s21, s20, 393216
  s_add_u32 s21, s21, 4915200
  s_add_u32 s21, s21, s44
  s_mul_i32 s22, s20, 12288
  s_add_u32 s22, s22, 55296
  s_add_u32 m0, s22, 0
  s_nop 0
  buffer_load_dwordx4 v4, s[12:15], s21 offen lds
  s_add_u32 m0, s22, 1024
  s_nop 0
  buffer_load_dwordx4 v5, s[12:15], s21 offen lds
  s_add_u32 m0, s22, 2048
  s_nop 0
  buffer_load_dwordx4 v6, s[12:15], s21 offen lds
  s_mul_i32 s21, s20, 393216
  s_add_u32 s21, s21, 5013504
  s_add_u32 s21, s21, s44
  s_mul_i32 s22, s20, 12288
  s_add_u32 s22, s22, 58368
  s_add_u32 m0, s22, 0
  s_nop 0
  buffer_load_dwordx4 v7, s[12:15], s21 offen lds
  s_add_u32 m0, s22, 1024
  s_nop 0
  buffer_load_dwordx4 v8, s[12:15], s21 offen lds
  s_add_u32 m0, s22, 2048
  s_nop 0
  buffer_load_dwordx4 v9, s[12:15], s21 offen lds
  v_mov_b32 v29, 76
  buffer_load_dword v29, v29, s[32:35], 0 offen sc1
  s_waitcnt vmcnt(12)
  s_barrier
  ds_read_b64_tr_b16 a[96:97], v184 offset:0
  ds_read_b64_tr_b16 a[98:99], v184 offset:1536
  ds_read_b64_tr_b16 a[100:101], v185 offset:0
  ds_read_b64_tr_b16 a[102:103], v185 offset:1536
  ds_read_b64_tr_b16 a[104:105], v186 offset:0
  ds_read_b64_tr_b16 a[106:107], v186 offset:1536
  ds_read_b64_tr_b16 a[108:109], v184 offset:12288
  ds_read_b64_tr_b16 a[110:111], v184 offset:13824
  ds_read_b64_tr_b16 a[112:113], v185 offset:12288
  ds_read_b64_tr_b16 a[114:115], v185 offset:13824
  ds_read_b64_tr_b16 a[116:117], v186 offset:12288
  ds_read_b64_tr_b16 a[118:119], v186 offset:13824
  ds_read_b64_tr_b16 a[120:121], v184 offset:24576
  ds_read_b64_tr_b16 a[122:123], v184 offset:26112
  ds_read_b64_tr_b16 a[124:125], v185 offset:24576
  ds_read_b64_tr_b16 a[126:127], v185 offset:26112
  ds_read_b64_tr_b16 a[128:129], v186 offset:24576
  ds_read_b64_tr_b16 a[130:131], v186 offset:26112
  ds_read_b64_tr_b16 a[132:133], v184 offset:36864
  ds_read_b64_tr_b16 a[134:135], v184 offset:38400
  ds_read_b64_tr_b16 a[136:137], v185 offset:36864
  ds_read_b64_tr_b16 a[138:139], v185 offset:38400
  ds_read_b64_tr_b16 a[140:141], v186 offset:36864
  ds_read_b64_tr_b16 a[142:143], v186 offset:38400
  s_waitcnt lgkmcnt(0)
  s_barrier
  s_mul_i32 s21, s20, 393216
  s_add_u32 s21, s21, 6291456
  s_add_u32 s21, s21, s44
  s_mul_i32 s22, s20, 12288
  s_add_u32 s22, s22, 0
  s_add_u32 m0, s22, 0
  s_nop 0
  buffer_load_dwordx4 v4, s[12:15], s21 offen lds
  s_add_u32 m0, s22, 1024
  s_nop 0
  buffer_load_dwordx4 v5, s[12:15], s21 offen lds
  s_add_u32 m0, s22, 2048
  s_nop 0
  buffer_load_dwordx4 v6, s[12:15], s21 offen lds
  s_mul_i32 s21, s20, 393216
  s_add_u32 s21, s21, 6389760
  s_add_u32 s21, s21, s44
  s_mul_i32 s22, s20, 12288
  s_add_u32 s22, s22, 3072
  s_add_u32 m0, s22, 0
  s_nop 0
  buffer_load_dwordx4 v7, s[12:15], s21 offen lds
  s_add_u32 m0, s22, 1024
  s_nop 0
  buffer_load_dwordx4 v8, s[12:15], s21 offen lds
  s_add_u32 m0, s22, 2048
  s_nop 0
  buffer_load_dwordx4 v9, s[12:15], s21 offen lds
  s_mul_i32 s21, s20, 393216
  s_add_u32 s21, s21, 6488064
  s_add_u32 s21, s21, s44
  s_mul_i32 s22, s20, 12288
  s_add_u32 s22, s22, 6144
  s_add_u32 m0, s22, 0
  s_nop 0
  buffer_load_dwordx4 v4, s[12:15], s21 offen lds
  s_add_u32 m0, s22, 1024
  s_nop 0
  buffer_load_dwordx4 v5, s[12:15], s21 offen lds
  s_add_u32 m0, s22, 2048
  s_nop 0
  buffer_load_dwordx4 v6, s[12:15], s21 offen lds
  s_mul_i32 s21, s20, 393216
  s_add_u32 s21, s21, 6586368
  s_add_u32 s21, s21, s44
  s_mul_i32 s22, s20, 12288
  s_add_u32 s22, s22, 9216
  s_add_u32 m0, s22, 0
  s_nop 0
  buffer_load_dwordx4 v7, s[12:15], s21 offen lds
  s_add_u32 m0, s22, 1024
  s_nop 0
  buffer_load_dwordx4 v8, s[12:15], s21 offen lds
  s_add_u32 m0, s22, 2048
  s_nop 0
  buffer_load_dwordx4 v9, s[12:15], s21 offen lds
  s_waitcnt vmcnt(12)
  s_barrier
  ds_read_b64_tr_b16 a[144:145], v187 offset:0
  ds_read_b64_tr_b16 a[146:147], v187 offset:1536
  ds_read_b64_tr_b16 a[148:149], v188 offset:0
  ds_read_b64_tr_b16 a[150:151], v188 offset:1536
  ds_read_b64_tr_b16 a[152:153], v189 offset:0
  ds_read_b64_tr_b16 a[154:155], v189 offset:1536
  ds_read_b64_tr_b16 a[156:157], v187 offset:12288
  ds_read_b64_tr_b16 a[158:159], v187 offset:13824
  ds_read_b64_tr_b16 a[160:161], v188 offset:12288
  ds_read_b64_tr_b16 a[162:163], v188 offset:13824
  ds_read_b64_tr_b16 a[164:165], v189 offset:12288
  ds_read_b64_tr_b16 a[166:167], v189 offset:13824
  ds_read_b64_tr_b16 a[168:169], v187 offset:24576
  ds_read_b64_tr_b16 a[170:171], v187 offset:26112
  ds_read_b64_tr_b16 a[172:173], v188 offset:24576
  ds_read_b64_tr_b16 a[174:175], v188 offset:26112
  ds_read_b64_tr_b16 a[176:177], v189 offset:24576
  ds_read_b64_tr_b16 a[178:179], v189 offset:26112
  ds_read_b64_tr_b16 a[180:181], v187 offset:36864
  ds_read_b64_tr_b16 a[182:183], v187 offset:38400
  ds_read_b64_tr_b16 a[184:185], v188 offset:36864
  ds_read_b64_tr_b16 a[186:187], v188 offset:38400
  ds_read_b64_tr_b16 a[188:189], v189 offset:36864
  ds_read_b64_tr_b16 a[190:191], v189 offset:38400
  s_waitcnt lgkmcnt(0)
  s_barrier
  s_waitcnt vmcnt(0)
  s_barrier
  ds_read_b64_tr_b16 a[192:193], v184 offset:0
  ds_read_b64_tr_b16 a[194:195], v184 offset:1536
  ds_read_b64_tr_b16 a[196:197], v185 offset:0
  ds_read_b64_tr_b16 a[198:199], v185 offset:1536
  ds_read_b64_tr_b16 a[200:201], v186 offset:0
  ds_read_b64_tr_b16 a[202:203], v186 offset:1536
  ds_read_b64_tr_b16 a[204:205], v184 offset:12288
  ds_read_b64_tr_b16 a[206:207], v184 offset:13824
  ds_read_b64_tr_b16 a[208:209], v185 offset:12288
  ds_read_b64_tr_b16 a[210:211], v185 offset:13824
  ds_read_b64_tr_b16 a[212:213], v186 offset:12288
  ds_read_b64_tr_b16 a[214:215], v186 offset:13824
  ds_read_b64_tr_b16 a[216:217], v184 offset:24576
  ds_read_b64_tr_b16 a[218:219], v184 offset:26112
  ds_read_b64_tr_b16 a[220:221], v185 offset:24576
  ds_read_b64_tr_b16 a[222:223], v185 offset:26112
  ds_read_b64_tr_b16 a[224:225], v186 offset:24576
  ds_read_b64_tr_b16 a[226:227], v186 offset:26112
  ds_read_b64_tr_b16 a[228:229], v184 offset:36864
  ds_read_b64_tr_b16 a[230:231], v184 offset:38400
  ds_read_b64_tr_b16 a[232:233], v185 offset:36864
  ds_read_b64_tr_b16 a[234:235], v185 offset:38400
  ds_read_b64_tr_b16 a[236:237], v186 offset:36864
  ds_read_b64_tr_b16 a[238:239], v186 offset:38400
  s_waitcnt lgkmcnt(0)
  s_barrier
  v_and_b32 v6, 7, v2
  v_add_u32 v4, 0, v3
  v_xor_b32 v4, v4, v6
  v_lshlrev_b32 v4, 4, v4
  v_lshl_add_u32 v14, v2, 7, v4
  v_add_u32 v16, 65536, v14
  v_add_u32 v18, 131072, v14
  v_add_u32 v4, 4, v3
  v_xor_b32 v4, v4, v6
  v_lshlrev_b32 v4, 4, v4
  v_lshl_add_u32 v15, v2, 7, v4
  v_add_u32 v17, 65536, v15
  v_add_u32 v19, 131072, v15
  v_lshlrev_b32 v26, 4, v1
  v_mov_b32 v28, 1
  v_mov_b32 v4, 0x40000000
  v_cmp_eq_u32 vcc, 0, v0
  s_nop 1
  v_cndmask_b32 v27, v4, 0, vcc
  s_mov_b32 s26, 6
  s_lshl_b32 s27, s42, 2
  s_add_u32 s27, s27, s20
  s_lshl_b32 s27, s27, 14
  s_lshl_b32 s21, s43, 13
  s_xor_b32 s27, s27, s21
  v_readfirstlane_b32 s100, v29
  s_cmp_lg_u32 s100, 0
  s_cbranch_scc1 kvz_237
  s_mov_b32 s21, 76
  v_mov_b32 v4, 0
  s_mov_b32 s101, 0
wf_238:
  buffer_load_dword v5, v4, s[32:35], s21 offen sc1
  s_add_u32 s101, s101, 1
  s_cmp_gt_u32 s101, 131072
  s_cbranch_scc1 main_end
  s_waitcnt vmcnt(0)
  v_readfirstlane_b32 s100, v5
  s_cmp_ge_u32 s100, 1
  s_cbranch_scc1 wf_239
  s_sleep 8
  s_branch wf_238
wf_239:
kvz_237:
  s_sub_u32 s80, s100, 1
  s_lshl_b32 s80, s80, 13
  s_xor_b32 s27, s27, s80
  s_lshl_b32 s60, s40, 7
  s_add_u32 s60, s60, 28672
  s_xor_b32 s60, s60, s80
  s_mov_b32 s48, 0x40000000
  s_mov_b32 s61, 0x40000000
  s_waitcnt vmcnt(14)
  s_barrier
  ds_read_b128 v[160:163], v16 offset:32768
  ds_read_b128 v[164:167], v16 offset:34816
  ds_read_b128 v[168:171], v16 offset:36864
  ds_read_b128 v[172:175], v16 offset:38912
  s_waitcnt lgkmcnt(3)
  .p2align 3
kvm_240:
  v_mfma_f32_16x16x32_bf16 v[64:67], a[0:3], v[160:163], 0
  s_xor_b32 s29, s48, 0
  ds_read_b128 v[176:179], v17 offset:32768
  v_cvt_pk_bf16_f32 v204, v88, v89
  v_mfma_f32_16x16x32_bf16 v[68:71], a[4:7], v[160:163], 0
  v_cvt_pk_bf16_f32 v205, v90, v91
  v_cvt_pk_bf16_f32 v206, v92, v93
  v_mfma_f32_16x16x32_bf16 v[72:75], a[8:11], v[160:163], 0
  s_waitcnt lgkmcnt(3)
  v_cvt_pk_bf16_f32 v207, v94, v95
  v_cvt_pk_bf16_f32 v212, v96, v97
  v_mfma_f32_16x16x32_bf16 v[76:79], a[0:3], v[164:167], 0
  ds_read_b128 v[180:183], v17 offset:34816
  v_cvt_pk_bf16_f32 v213, v98, v99
  v_mfma_f32_16x16x32_bf16 v[80:83], a[4:7], v[164:167], 0
  v_cvt_pk_bf16_f32 v208, v100, v101
  v_cvt_pk_bf16_f32 v209, v102, v103
  v_mfma_f32_16x16x32_bf16 v[84:87], a[8:11], v[164:167], 0
  s_waitcnt lgkmcnt(3)
  v_cvt_pk_bf16_f32 v210, v104, v105
  v_cvt_pk_bf16_f32 v211, v106, v107
  v_mfma_f32_16x16x32_bf16 v[88:91], a[0:3], v[168:171], 0
  ds_read_b128 v[184:187], v17 offset:36864
  v_cvt_pk_bf16_f32 v214, v108, v109
  v_mfma_f32_16x16x32_bf16 v[92:95], a[4:7], v[168:171], 0
  s_add_u32 m0, s31, 81920
  v_cvt_pk_bf16_f32 v215, v110, v111
  buffer_store_dwordx4 v[192:195], v26, s[16:19], s29 offen offset:0 sc1
  v_mfma_f32_16x16x32_bf16 v[96:99], a[8:11], v[168:171], 0
  s_waitcnt lgkmcnt(3)
  buffer_load_dwordx4 v10, s[8:11], s30 offen lds
  v_mfma_f32_16x16x32_bf16 v[100:103], a[0:3], v[172:175], 0
  ds_read_b128 v[188:191], v17 offset:38912
  v_mfma_f32_16x16x32_bf16 v[104:107], a[4:7], v[172:175], 0
  v_mfma_f32_16x16x32_bf16 v[108:111], a[8:11], v[172:175], 0
  s_waitcnt lgkmcnt(3)
  buffer_store_dwordx4 v[196:199], v26, s[16:19], s29 offen offset:1024 sc1
  v_mfma_f32_16x16x32_bf16 v[64:67], a[12:15], v[176:179], v[64:67]
  s_waitcnt vmcnt(15)
  s_barrier
  ds_read_b128 v[160:163], v16 offset:40960
  v_mfma_f32_16x16x32_bf16 v[68:71], a[16:19], v[176:179], v[68:71]
  s_add_u32 m0, s31, 82944
  v_mfma_f32_16x16x32_bf16 v[72:75], a[20:23], v[176:179], v[72:75]
  s_waitcnt lgkmcnt(3)
  buffer_load_dwordx4 v11, s[8:11], s30 offen lds
  v_mfma_f32_16x16x32_bf16 v[76:79], a[12:15], v[180:183], v[76:79]
  s_add_u32 s30, s30, 128
  ds_read_b128 v[164:167], v16 offset:43008
  buffer_store_dwordx4 v[200:203], v26, s[16:19], s29 offen offset:2048 sc1
  v_mfma_f32_16x16x32_bf16 v[80:83], a[16:19], v[180:183], v[80:83]
  v_mfma_f32_16x16x32_bf16 v[84:87], a[20:23], v[180:183], v[84:87]
  s_waitcnt lgkmcnt(3)
  v_mfma_f32_16x16x32_bf16 v[88:91], a[12:15], v[184:187], v[88:91]
  s_xor_b32 s29, s48, 2105344
  ds_read_b128 v[168:171], v16 offset:45056
  v_mfma_f32_16x16x32_bf16 v[92:95], a[16:19], v[184:187], v[92:95]
  buffer_store_dwordx4 v[204:207], v26, s[16:19], s29 offen offset:0 sc1
  v_mfma_f32_16x16x32_bf16 v[96:99], a[20:23], v[184:187], v[96:99]
  s_waitcnt lgkmcnt(3)
  v_mfma_f32_16x16x32_bf16 v[100:103], a[12:15], v[188:191], v[100:103]
  ds_read_b128 v[172:175], v16 offset:47104
  v_mfma_f32_16x16x32_bf16 v[104:107], a[16:19], v[188:191], v[104:107]
  v_mfma_f32_16x16x32_bf16 v[108:111], a[20:23], v[188:191], v[108:111]
  s_waitcnt lgkmcnt(3)
  buffer_store_dwordx4 v[208:211], v26, s[16:19], s29 offen offset:1024 sc1
  v_mfma_f32_16x16x32_bf16 v[64:67], a[24:27], v[160:163], v[64:67]
  ds_read_b128 v[176:179], v17 offset:40960
  v_mfma_f32_16x16x32_bf16 v[68:71], a[28:31], v[160:163], v[68:71]
  s_add_u32 m0, s31, 90112
  v_mfma_f32_16x16x32_bf16 v[72:75], a[32:35], v[160:163], v[72:75]
  s_waitcnt lgkmcnt(3)
  buffer_load_dwordx4 v10, s[8:11], s30 offen lds
  v_mfma_f32_16x16x32_bf16 v[76:79], a[24:27], v[164:167], v[76:79]
  ds_read_b128 v[180:183], v17 offset:43008
  buffer_store_dwordx4 v[212:215], v26, s[16:19], s29 offen offset:2048 sc1
  v_mfma_f32_16x16x32_bf16 v[80:83], a[28:31], v[164:167], v[80:83]
  v_mfma_f32_16x16x32_bf16 v[84:87], a[32:35], v[164:167], v[84:87]
  s_waitcnt lgkmcnt(3)
  v_mfma_f32_16x16x32_bf16 v[88:91], a[24:27], v[168:171], v[88:91]
  ds_read_b128 v[184:187], v17 offset:45056
  v_mfma_f32_16x16x32_bf16 v[92:95], a[28:31], v[168:171], v[92:95]
  s_add_u32 m0, s31, 91136
  v_mfma_f32_16x16x32_bf16 v[96:99], a[32:35], v[168:171], v[96:99]
  s_waitcnt lgkmcnt(3)
  buffer_load_dwordx4 v11, s[8:11], s30 offen lds
  v_mfma_f32_16x16x32_bf16 v[100:103], a[24:27], v[172:175], v[100:103]
  s_add_u32 s30, s30, s25
  ds_read_b128 v[188:191], v17 offset:47104
  v_mfma_f32_16x16x32_bf16 v[104:107], a[28:31], v[172:175], v[104:107]
  v_mfma_f32_16x16x32_bf16 v[108:111], a[32:35], v[172:175], v[108:111]
  s_waitcnt lgkmcnt(3)
  v_mfma_f32_16x16x32_bf16 v[64:67], a[36:39], v[176:179], v[64:67]
  s_waitcnt vmcnt(20)
  s_barrier
  ds_read_b128 v[160:163], v16 offset:49152
  v_mfma_f32_16x16x32_bf16 v[68:71], a[40:43], v[176:179], v[68:71]
  v_mfma_f32_16x16x32_bf16 v[72:75], a[44:47], v[176:179], v[72:75]
  s_waitcnt lgkmcnt(3)
  v_mfma_f32_16x16x32_bf16 v[76:79], a[36:39], v[180:183], v[76:79]
  ds_read_b128 v[164:167], v16 offset:51200
  v_mfma_f32_16x16x32_bf16 v[80:83], a[40:43], v[180:183], v[80:83]
  v_mfma_f32_16x16x32_bf16 v[84:87], a[44:47], v[180:183], v[84:87]
  s_waitcnt lgkmcnt(3)
  v_mfma_f32_16x16x32_bf16 v[88:91], a[36:39], v[184:187], v[88:91]
  ds_read_b128 v[168:171], v16 offset:53248
  v_mfma_f32_16x16x32_bf16 v[92:95], a[40:43], v[184:187], v[92:95]
  v_mfma_f32_16x16x32_bf16 v[96:99], a[44:47], v[184:187], v[96:99]
  s_waitcnt lgkmcnt(3)
  v_mfma_f32_16x16x32_bf16 v[100:103], a[36:39], v[188:191], v[100:103]
  ds_read_b128 v[172:175], v16 offset:55296
  v_mfma_f32_16x16x32_bf16 v[104:107], a[40:43], v[188:191], v[104:107]
  v_mfma_f32_16x16x32_bf16 v[108:111], a[44:47], v[188:191], v[108:111]
  s_waitcnt lgkmcnt(3)
  v_mfma_f32_16x16x32_bf16 v[64:67], a[48:51], v[160:163], v[64:67]
  ds_read_b128 v[176:179], v17 offset:49152
  v_mfma_f32_16x16x32_bf16 v[68:71], a[52:55], v[160:163], v[68:71]
  s_add_u32 m0, s31, 98304
  v_mfma_f32_16x16x32_bf16 v[72:75], a[56:59], v[160:163], v[72:75]
  s_waitcnt lgkmcnt(3)
  buffer_load_dwordx4 v10, s[8:11], s30 offen lds
  v_mfma_f32_16x16x32_bf16 v[76:79], a[48:51], v[164:167], v[76:79]
  ds_read_b128 v[180:183], v17 offset:51200
  v_mfma_f32_16x16x32_bf16 v[80:83], a[52:55], v[164:167], v[80:83]
  v_mfma_f32_16x16x32_bf16 v[84:87], a[56:59], v[164:167], v[84:87]
  s_waitcnt lgkmcnt(3)
  v_mfma_f32_16x16x32_bf16 v[88:91], a[48:51], v[168:171], v[88:91]
  ds_read_b128 v[184:187], v17 offset:53248
  v_mfma_f32_16x16x32_bf16 v[92:95], a[52:55], v[168:171], v[92:95]
  s_add_u32 m0, s31, 99328
  v_mfma_f32_16x16x32_bf16 v[96:99], a[56:59], v[168:171], v[96:99]
  s_waitcnt lgkmcnt(3)
  buffer_load_dwordx4 v11, s[8:11], s30 offen lds
  v_mfma_f32_16x16x32_bf16 v[100:103], a[48:51], v[172:175], v[100:103]
  s_add_u32 s30, s30, 128
  ds_read_b128 v[188:191], v17 offset:55296
  v_mfma_f32_16x16x32_bf16 v[104:107], a[52:55], v[172:175], v[104:107]
  v_mfma_f32_16x16x32_bf16 v[108:111], a[56:59], v[172:175], v[108:111]
  s_waitcnt lgkmcnt(3)
  v_mfma_f32_16x16x32_bf16 v[64:67], a[60:63], v[176:179], v[64:67]
  s_waitcnt vmcnt(20)
  s_barrier
  ds_read_b128 v[160:163], v16 offset:57344
  v_mfma_f32_16x16x32_bf16 v[68:71], a[64:67], v[176:179], v[68:71]
  v_mfma_f32_16x16x32_bf16 v[72:75], a[68:71], v[176:179], v[72:75]
  s_waitcnt lgkmcnt(3)
  v_mfma_f32_16x16x32_bf16 v[76:79], a[60:63], v[180:183], v[76:79]
  ds_read_b128 v[164:167], v16 offset:59392
  v_mfma_f32_16x16x32_bf16 v[80:83], a[64:67], v[180:183], v[80:83]
  v_mfma_f32_16x16x32_bf16 v[84:87], a[68:71], v[180:183], v[84:87]
  s_waitcnt lgkmcnt(3)
  v_mfma_f32_16x16x32_bf16 v[88:91], a[60:63], v[184:187], v[88:91]
  ds_read_b128 v[168:171], v16 offset:61440
  v_mfma_f32_16x16x32_bf16 v[92:95], a[64:67], v[184:187], v[92:95]
  v_mfma_f32_16x16x32_bf16 v[96:99], a[68:71], v[184:187], v[96:99]
  s_waitcnt lgkmcnt(3)
  v_mfma_f32_16x16x32_bf16 v[100:103], a[60:63], v[188:191], v[100:103]
  ds_read_b128 v[172:175], v16 offset:63488
  v_mfma_f32_16x16x32_bf16 v[104:107], a[64:67], v[188:191], v[104:107]
  v_mfma_f32_16x16x32_bf16 v[108:111], a[68:71], v[188:191], v[108:111]
  s_waitcnt lgkmcnt(3)
  v_mfma_f32_16x16x32_bf16 v[64:67], a[72:75], v[160:163], v[64:67]
  ds_read_b128 v[176:179], v17 offset:57344
  v_mfma_f32_16x16x32_bf16 v[68:71], a[76:79], v[160:163], v[68:71]
  s_add_u32 m0, s31, 106496
  v_mfma_f32_16x16x32_bf16 v[72:75], a[80:83], v[160:163], v[72:75]
  s_waitcnt lgkmcnt(3)
  buffer_load_dwordx4 v10, s[8:11], s30 offen lds
  v_mfma_f32_16x16x32_bf16 v[76:79], a[72:75], v[164:167], v[76:79]
  ds_read_b128 v[180:183], v17 offset:59392
  v_mfma_f32_16x16x32_bf16 v[80:83], a[76:79], v[164:167], v[80:83]
  v_mfma_f32_16x16x32_bf16 v[84:87], a[80:83], v[164:167], v[84:87]
  s_waitcnt lgkmcnt(3)
  v_mfma_f32_16x16x32_bf16 v[88:91], a[72:75], v[168:171], v[88:91]
  ds_read_b128 v[184:187], v17 offset:61440
  v_mfma_f32_16x16x32_bf16 v[92:95], a[76:79], v[168:171], v[92:95]
  s_add_u32 m0, s31, 107520
  v_mfma_f32_16x16x32_bf16 v[96:99], a[80:83], v[168:171], v[96:99]
  s_waitcnt lgkmcnt(3)
  buffer_load_dwordx4 v11, s[8:11], s30 offen lds
  v_mfma_f32_16x16x32_bf16 v[100:103], a[72:75], v[172:175], v[100:103]
  s_add_u32 s30, s30, 128
  ds_read_b128 v[188:191], v17 offset:63488
  v_mfma_f32_16x16x32_bf16 v[104:107], a[76:79], v[172:175], v[104:107]
  v_mfma_f32_16x16x32_bf16 v[108:111], a[80:83], v[172:175], v[108:111]
  s_waitcnt lgkmcnt(3)
  v_mfma_f32_16x16x32_bf16 v[64:67], a[84:87], v[176:179], v[64:67]
  s_waitcnt vmcnt(5)
  s_barrier
  ds_read_b128 v[160:163], v18 offset:0
  v_mfma_f32_16x16x32_bf16 v[68:71], a[88:91], v[176:179], v[68:71]
  buffer_atomic_add v28, v27, s[72:75], s61 offen sc1
  v_mfma_f32_16x16x32_bf16 v[72:75], a[92:95], v[176:179], v[72:75]
  s_waitcnt lgkmcnt(3)
  s_mov_b32 s48, s27
  s_add_u32 s27, s27, 4194304
  v_mfma_f32_16x16x32_bf16 v[76:79], a[84:87], v[180:183], v[76:79]
  s_mov_b32 s61, s60
  ds_read_b128 v[164:167], v18 offset:2048
  s_add_u32 s60, s60, 4
  v_mfma_f32_16x16x32_bf16 v[80:83], a[88:91], v[180:183], v[80:83]
  v_mfma_f32_16x16x32_bf16 v[84:87], a[92:95], v[180:183], v[84:87]
  s_waitcnt lgkmcnt(3)
  v_mfma_f32_16x16x32_bf16 v[88:91], a[84:87], v[184:187], v[88:91]
  ds_read_b128 v[168:171], v18 offset:4096
  v_mfma_f32_16x16x32_bf16 v[92:95], a[88:91], v[184:187], v[92:95]
  v_mfma_f32_16x16x32_bf16 v[96:99], a[92:95], v[184:187], v[96:99]
  s_waitcnt lgkmcnt(3)
  v_mfma_f32_16x16x32_bf16 v[100:103], a[84:87], v[188:191], v[100:103]
  ds_read_b128 v[172:175], v18 offset:6144
  v_mfma_f32_16x16x32_bf16 v[104:107], a[88:91], v[188:191], v[104:107]
  v_mfma_f32_16x16x32_bf16 v[108:111], a[92:95], v[188:191], v[108:111]
  s_waitcnt lgkmcnt(3)
  v_mfma_f32_16x16x32_bf16 v[64:67], a[96:99], v[160:163], v[64:67]
  ds_read_b128 v[176:179], v19 offset:0
  v_mfma_f32_16x16x32_bf16 v[68:71], a[100:103], v[160:163], v[68:71]
  s_add_u32 m0, s31, 114688
  v_mfma_f32_16x16x32_bf16 v[72:75], a[104:107], v[160:163], v[72:75]
  s_waitcnt lgkmcnt(3)
  buffer_load_dwordx4 v10, s[8:11], s30 offen lds
  v_mfma_f32_16x16x32_bf16 v[76:79], a[96:99], v[164:167], v[76:79]
  ds_read_b128 v[180:183], v19 offset:2048
  v_mfma_f32_16x16x32_bf16 v[80:83], a[100:103], v[164:167], v[80:83]
  v_mfma_f32_16x16x32_bf16 v[84:87], a[104:107], v[164:167], v[84:87]
  s_waitcnt lgkmcnt(3)
  v_mfma_f32_16x16x32_bf16 v[88:91], a[96:99], v[168:171], v[88:91]
  ds_read_b128 v[184:187], v19 offset:4096
  v_mfma_f32_16x16x32_bf16 v[92:95], a[100:103], v[168:171], v[92:95]
  s_add_u32 m0, s31, 115712
  v_mfma_f32_16x16x32_bf16 v[96:99], a[104:107], v[168:171], v[96:99]
  s_waitcnt lgkmcnt(3)
  buffer_load_dwordx4 v11, s[8:11], s30 offen lds
  v_mfma_f32_16x16x32_bf16 v[100:103], a[96:99], v[172:175], v[100:103]
  s_add_u32 s30, s30, 128
  ds_read_b128 v[188:191], v19 offset:6144
  v_mfma_f32_16x16x32_bf16 v[104:107], a[100:103], v[172:175], v[104:107]
  v_mfma_f32_16x16x32_bf16 v[108:111], a[104:107], v[172:175], v[108:111]
  s_waitcnt lgkmcnt(3)
  v_mfma_f32_16x16x32_bf16 v[64:67], a[108:111], v[176:179], v[64:67]
  s_waitcnt vmcnt(21)
  s_barrier
  ds_read_b128 v[160:163], v18 offset:8192
  v_mfma_f32_16x16x32_bf16 v[68:71], a[112:115], v[176:179], v[68:71]
  v_mfma_f32_16x16x32_bf16 v[72:75], a[116:119], v[176:179], v[72:75]
  s_waitcnt lgkmcnt(3)
  v_mfma_f32_16x16x32_bf16 v[76:79], a[108:111], v[180:183], v[76:79]
  ds_read_b128 v[164:167], v18 offset:10240
  v_mfma_f32_16x16x32_bf16 v[80:83], a[112:115], v[180:183], v[80:83]
  v_mfma_f32_16x16x32_bf16 v[84:87], a[116:119], v[180:183], v[84:87]
  s_waitcnt lgkmcnt(3)
  v_mfma_f32_16x16x32_bf16 v[88:91], a[108:111], v[184:187], v[88:91]
  ds_read_b128 v[168:171], v18 offset:12288
  v_mfma_f32_16x16x32_bf16 v[92:95], a[112:115], v[184:187], v[92:95]
  v_mfma_f32_16x16x32_bf16 v[96:99], a[116:119], v[184:187], v[96:99]
  s_waitcnt lgkmcnt(3)
  v_mfma_f32_16x16x32_bf16 v[100:103], a[108:111], v[188:191], v[100:103]
  ds_read_b128 v[172:175], v18 offset:14336
  v_mfma_f32_16x16x32_bf16 v[104:107], a[112:115], v[188:191], v[104:107]
  v_mfma_f32_16x16x32_bf16 v[108:111], a[116:119], v[188:191], v[108:111]
  s_waitcnt lgkmcnt(3)
  v_mfma_f32_16x16x32_bf16 v[64:67], a[120:123], v[160:163], v[64:67]
  ds_read_b128 v[176:179], v19 offset:8192
  v_mfma_f32_16x16x32_bf16 v[68:71], a[124:127], v[160:163], v[68:71]
  s_add_u32 m0, s31, 122880
  v_mfma_f32_16x16x32_bf16 v[72:75], a[128:131], v[160:163], v[72:75]
  s_waitcnt lgkmcnt(3)
  buffer_load_dwordx4 v10, s[8:11], s30 offen lds
  v_mfma_f32_16x16x32_bf16 v[76:79], a[120:123], v[164:167], v[76:79]
  ds_read_b128 v[180:183], v19 offset:10240
  v_mfma_f32_16x16x32_bf16 v[80:83], a[124:127], v[164:167], v[80:83]
  v_mfma_f32_16x16x32_bf16 v[84:87], a[128:131], v[164:167], v[84:87]
  s_waitcnt lgkmcnt(3)
  v_mfma_f32_16x16x32_bf16 v[88:91], a[120:123], v[168:171], v[88:91]
  ds_read_b128 v[184:187], v19 offset:12288
  v_mfma_f32_16x16x32_bf16 v[92:95], a[124:127], v[168:171], v[92:95]
  s_add_u32 m0, s31, 123904
  v_mfma_f32_16x16x32_bf16 v[96:99], a[128:131], v[168:171], v[96:99]
  s_waitcnt lgkmcnt(3)
  buffer_load_dwordx4 v11, s[8:11], s30 offen lds
  v_mfma_f32_16x16x32_bf16 v[100:103], a[120:123], v[172:175], v[100:103]
  s_add_u32 s30, s30, 128
  ds_read_b128 v[188:191], v19 offset:14336
  v_mfma_f32_16x16x32_bf16 v[104:107], a[124:127], v[172:175], v[104:107]
  v_mfma_f32_16x16x32_bf16 v[108:111], a[128:131], v[172:175], v[108:111]
  s_waitcnt lgkmcnt(3)
  v_mfma_f32_16x16x32_bf16 v[64:67], a[132:135], v[176:179], v[64:67]
  s_waitcnt vmcnt(21)
  s_barrier
  ds_read_b128 v[160:163], v18 offset:16384
  v_mfma_f32_16x16x32_bf16 v[68:71], a[136:139], v[176:179], v[68:71]
  v_mfma_f32_16x16x32_bf16 v[72:75], a[140:143], v[176:179], v[72:75]
  s_waitcnt lgkmcnt(3)
  v_mfma_f32_16x16x32_bf16 v[76:79], a[132:135], v[180:183], v[76:79]
  ds_read_b128 v[164:167], v18 offset:18432
  v_mfma_f32_16x16x32_bf16 v[80:83], a[136:139], v[180:183], v[80:83]
  v_mfma_f32_16x16x32_bf16 v[84:87], a[140:143], v[180:183], v[84:87]
  s_waitcnt lgkmcnt(3)
  v_mfma_f32_16x16x32_bf16 v[88:91], a[132:135], v[184:187], v[88:91]
  ds_read_b128 v[168:171], v18 offset:20480
  v_mfma_f32_16x16x32_bf16 v[92:95], a[136:139], v[184:187], v[92:95]
  v_mfma_f32_16x16x32_bf16 v[96:99], a[140:143], v[184:187], v[96:99]
  s_waitcnt lgkmcnt(3)
  v_mfma_f32_16x16x32_bf16 v[100:103], a[132:135], v[188:191], v[100:103]
  ds_read_b128 v[172:175], v18 offset:22528
  v_mfma_f32_16x16x32_bf16 v[104:107], a[136:139], v[188:191], v[104:107]
  v_mfma_f32_16x16x32_bf16 v[108:111], a[140:143], v[188:191], v[108:111]
  s_waitcnt lgkmcnt(3)
  v_mfma_f32_16x16x32_bf16 v[64:67], a[144:147], v[160:163], v[64:67]
  ds_read_b128 v[176:179], v19 offset:16384
  v_mfma_f32_16x16x32_bf16 v[68:71], a[148:151], v[160:163], v[68:71]
  s_add_u32 m0, s31, 131072
  v_mfma_f32_16x16x32_bf16 v[72:75], a[152:155], v[160:163], v[72:75]
  s_waitcnt lgkmcnt(3)
  buffer_load_dwordx4 v10, s[8:11], s30 offen lds
  v_mfma_f32_16x16x32_bf16 v[76:79], a[144:147], v[164:167], v[76:79]
  ds_read_b128 v[180:183], v19 offset:18432
  v_mfma_f32_16x16x32_bf16 v[80:83], a[148:151], v[164:167], v[80:83]
  v_mfma_f32_16x16x32_bf16 v[84:87], a[152:155], v[164:167], v[84:87]
  s_waitcnt lgkmcnt(3)
  v_mfma_f32_16x16x32_bf16 v[88:91], a[144:147], v[168:171], v[88:91]
  ds_read_b128 v[184:187], v19 offset:20480
  v_mfma_f32_16x16x32_bf16 v[92:95], a[148:151], v[168:171], v[92:95]
  s_add_u32 m0, s31, 132096
  v_mfma_f32_16x16x32_bf16 v[96:99], a[152:155], v[168:171], v[96:99]
  s_waitcnt lgkmcnt(3)
  buffer_load_dwordx4 v11, s[8:11], s30 offen lds
  v_mfma_f32_16x16x32_bf16 v[100:103], a[144:147], v[172:175], v[100:103]
  s_add_u32 s30, s30, 128
  ds_read_b128 v[188:191], v19 offset:22528
  v_mfma_f32_16x16x32_bf16 v[104:107], a[148:151], v[172:175], v[104:107]
  v_mfma_f32_16x16x32_bf16 v[108:111], a[152:155], v[172:175], v[108:111]
  s_waitcnt lgkmcnt(3)
  v_mfma_f32_16x16x32_bf16 v[64:67], a[156:159], v[176:179], v[64:67]
  s_waitcnt vmcnt(21)
  s_barrier
  ds_read_b128 v[160:163], v18 offset:24576
  v_mfma_f32_16x16x32_bf16 v[68:71], a[160:163], v[176:179], v[68:71]
  v_mfma_f32_16x16x32_bf16 v[72:75], a[164:167], v[176:179], v[72:75]
  s_waitcnt lgkmcnt(3)
  v_mfma_f32_16x16x32_bf16 v[76:79], a[156:159], v[180:183], v[76:79]
  ds_read_b128 v[164:167], v18 offset:26624
  v_mfma_f32_16x16x32_bf16 v[80:83], a[160:163], v[180:183], v[80:83]
  v_mfma_f32_16x16x32_bf16 v[84:87], a[164:167], v[180:183], v[84:87]
  s_waitcnt lgkmcnt(3)
  v_mfma_f32_16x16x32_bf16 v[88:91], a[156:159], v[184:187], v[88:91]
  ds_read_b128 v[168:171], v18 offset:28672
  v_mfma_f32_16x16x32_bf16 v[92:95], a[160:163], v[184:187], v[92:95]
  v_mfma_f32_16x16x32_bf16 v[96:99], a[164:167], v[184:187], v[96:99]
  s_waitcnt lgkmcnt(3)
  v_mfma_f32_16x16x32_bf16 v[100:103], a[156:159], v[188:191], v[100:103]
  ds_read_b128 v[172:175], v18 offset:30720
  v_mfma_f32_16x16x32_bf16 v[104:107], a[160:163], v[188:191], v[104:107]
  v_mfma_f32_16x16x32_bf16 v[108:111], a[164:167], v[188:191], v[108:111]
  s_waitcnt lgkmcnt(3)
  v_mfma_f32_16x16x32_bf16 v[64:67], a[168:171], v[160:163], v[64:67]
  ds_read_b128 v[176:179], v19 offset:24576
  v_mfma_f32_16x16x32_bf16 v[68:71], a[172:175], v[160:163], v[68:71]
  s_add_u32 m0, s31, 139264
  v_mfma_f32_16x16x32_bf16 v[72:75], a[176:179], v[160:163], v[72:75]
  s_waitcnt lgkmcnt(3)
  buffer_load_dwordx4 v10, s[8:11], s30 offen lds
  v_mfma_f32_16x16x32_bf16 v[76:79], a[168:171], v[164:167], v[76:79]
  ds_read_b128 v[180:183], v19 offset:26624
  v_mfma_f32_16x16x32_bf16 v[80:83], a[172:175], v[164:167], v[80:83]
  v_mfma_f32_16x16x32_bf16 v[84:87], a[176:179], v[164:167], v[84:87]
  s_waitcnt lgkmcnt(3)
  v_mfma_f32_16x16x32_bf16 v[88:91], a[168:171], v[168:171], v[88:91]
  ds_read_b128 v[184:187], v19 offset:28672
  v_mfma_f32_16x16x32_bf16 v[92:95], a[172:175], v[168:171], v[92:95]
  s_add_u32 m0, s31, 140288
  v_mfma_f32_16x16x32_bf16 v[96:99], a[176:179], v[168:171], v[96:99]
  s_waitcnt lgkmcnt(3)
  buffer_load_dwordx4 v11, s[8:11], s30 offen lds
  v_mfma_f32_16x16x32_bf16 v[100:103], a[168:171], v[172:175], v[100:103]
  s_add_u32 s30, s30, 128
  ds_read_b128 v[188:191], v19 offset:30720
  v_mfma_f32_16x16x32_bf16 v[104:107], a[172:175], v[172:175], v[104:107]
  v_mfma_f32_16x16x32_bf16 v[108:111], a[176:179], v[172:175], v[108:111]
  s_waitcnt lgkmcnt(3)
  v_mfma_f32_16x16x32_bf16 v[64:67], a[180:183], v[176:179], v[64:67]
  s_waitcnt vmcnt(19)
  s_barrier
  ds_read_b128 v[160:163], v16 offset:16384
  v_mfma_f32_16x16x32_bf16 v[68:71], a[184:187], v[176:179], v[68:71]
  v_mfma_f32_16x16x32_bf16 v[72:75], a[188:191], v[176:179], v[72:75]
  s_waitcnt lgkmcnt(3)
  v_mfma_f32_16x16x32_bf16 v[76:79], a[180:183], v[180:183], v[76:79]
  ds_read_b128 v[164:167], v16 offset:18432
  v_mfma_f32_16x16x32_bf16 v[80:83], a[184:187], v[180:183], v[80:83]
  v_mfma_f32_16x16x32_bf16 v[84:87], a[188:191], v[180:183], v[84:87]
  s_waitcnt lgkmcnt(3)
  v_mfma_f32_16x16x32_bf16 v[88:91], a[180:183], v[184:187], v[88:91]
  ds_read_b128 v[168:171], v16 offset:20480
  v_mfma_f32_16x16x32_bf16 v[92:95], a[184:187], v[184:187], v[92:95]
  v_mfma_f32_16x16x32_bf16 v[96:99], a[188:191], v[184:187], v[96:99]
  s_waitcnt lgkmcnt(3)
  v_mfma_f32_16x16x32_bf16 v[100:103], a[180:183], v[188:191], v[100:103]
  ds_read_b128 v[172:175], v16 offset:22528
  v_mfma_f32_16x16x32_bf16 v[104:107], a[184:187], v[188:191], v[104:107]
  v_mfma_f32_16x16x32_bf16 v[108:111], a[188:191], v[188:191], v[108:111]
  s_waitcnt lgkmcnt(3)
  v_mfma_f32_16x16x32_bf16 v[64:67], a[192:195], v[160:163], v[64:67]
  ds_read_b128 v[176:179], v17 offset:16384
  v_mfma_f32_16x16x32_bf16 v[68:71], a[196:199], v[160:163], v[68:71]
  s_add_u32 m0, s31, 147456
  v_mfma_f32_16x16x32_bf16 v[72:75], a[200:203], v[160:163], v[72:75]
  s_waitcnt lgkmcnt(3)
  buffer_load_dwordx4 v10, s[8:11], s30 offen lds
  v_mfma_f32_16x16x32_bf16 v[76:79], a[192:195], v[164:167], v[76:79]
  ds_read_b128 v[180:183], v17 offset:18432
  v_mfma_f32_16x16x32_bf16 v[80:83], a[196:199], v[164:167], v[80:83]
  v_mfma_f32_16x16x32_bf16 v[84:87], a[200:203], v[164:167], v[84:87]
  s_waitcnt lgkmcnt(3)
  v_mfma_f32_16x16x32_bf16 v[88:91], a[192:195], v[168:171], v[88:91]
  ds_read_b128 v[184:187], v17 offset:20480
  v_mfma_f32_16x16x32_bf16 v[92:95], a[196:199], v[168:171], v[92:95]
  s_add_u32 m0, s31, 148480
  v_mfma_f32_16x16x32_bf16 v[96:99], a[200:203], v[168:171], v[96:99]
  s_waitcnt lgkmcnt(3)
  buffer_load_dwordx4 v11, s[8:11], s30 offen lds
  v_mfma_f32_16x16x32_bf16 v[100:103], a[192:195], v[172:175], v[100:103]
  s_add_u32 s30, s30, 128
  ds_read_b128 v[188:191], v17 offset:22528
  v_mfma_f32_16x16x32_bf16 v[104:107], a[196:199], v[172:175], v[104:107]
  v_mfma_f32_16x16x32_bf16 v[108:111], a[200:203], v[172:175], v[108:111]
  s_waitcnt lgkmcnt(3)
  v_mfma_f32_16x16x32_bf16 v[64:67], a[204:207], v[176:179], v[64:67]
  s_waitcnt vmcnt(15)
  s_barrier
  ds_read_b128 v[160:163], v16 offset:24576
  v_mfma_f32_16x16x32_bf16 v[68:71], a[208:211], v[176:179], v[68:71]
  v_mfma_f32_16x16x32_bf16 v[72:75], a[212:215], v[176:179], v[72:75]
  s_waitcnt lgkmcnt(3)
  v_mfma_f32_16x16x32_bf16 v[76:79], a[204:207], v[180:183], v[76:79]
  ds_read_b128 v[164:167], v16 offset:26624
  v_mfma_f32_16x16x32_bf16 v[80:83], a[208:211], v[180:183], v[80:83]
  v_mfma_f32_16x16x32_bf16 v[84:87], a[212:215], v[180:183], v[84:87]
  s_waitcnt lgkmcnt(3)
  v_mfma_f32_16x16x32_bf16 v[88:91], a[204:207], v[184:187], v[88:91]
  ds_read_b128 v[168:171], v16 offset:28672
  v_mfma_f32_16x16x32_bf16 v[92:95], a[208:211], v[184:187], v[92:95]
  v_mfma_f32_16x16x32_bf16 v[96:99], a[212:215], v[184:187], v[96:99]
  s_waitcnt lgkmcnt(3)
  v_mfma_f32_16x16x32_bf16 v[100:103], a[204:207], v[188:191], v[100:103]
  ds_read_b128 v[172:175], v16 offset:30720
  v_mfma_f32_16x16x32_bf16 v[104:107], a[208:211], v[188:191], v[104:107]
  v_mfma_f32_16x16x32_bf16 v[108:111], a[212:215], v[188:191], v[108:111]
  s_waitcnt lgkmcnt(3)
  v_mfma_f32_16x16x32_bf16 v[64:67], a[216:219], v[160:163], v[64:67]
  ds_read_b128 v[176:179], v17 offset:24576
  v_mfma_f32_16x16x32_bf16 v[68:71], a[220:223], v[160:163], v[68:71]
  s_add_u32 m0, s31, 155648
  v_mfma_f32_16x16x32_bf16 v[72:75], a[224:227], v[160:163], v[72:75]
  s_waitcnt lgkmcnt(3)
  buffer_load_dwordx4 v10, s[8:11], s30 offen lds
  v_mfma_f32_16x16x32_bf16 v[76:79], a[216:219], v[164:167], v[76:79]
  ds_read_b128 v[180:183], v17 offset:26624
  v_mfma_f32_16x16x32_bf16 v[80:83], a[220:223], v[164:167], v[80:83]
  v_mfma_f32_16x16x32_bf16 v[84:87], a[224:227], v[164:167], v[84:87]
  s_waitcnt lgkmcnt(3)
  v_mfma_f32_16x16x32_bf16 v[88:91], a[216:219], v[168:171], v[88:91]
  ds_read_b128 v[184:187], v17 offset:28672
  v_mfma_f32_16x16x32_bf16 v[92:95], a[220:223], v[168:171], v[92:95]
  s_add_u32 m0, s31, 156672
  v_mfma_f32_16x16x32_bf16 v[96:99], a[224:227], v[168:171], v[96:99]
  s_waitcnt lgkmcnt(3)
  buffer_load_dwordx4 v11, s[8:11], s30 offen lds
  v_mfma_f32_16x16x32_bf16 v[100:103], a[216:219], v[172:175], v[100:103]
  s_add_u32 s30, s30, 128
  ds_read_b128 v[188:191], v17 offset:30720
  v_mfma_f32_16x16x32_bf16 v[104:107], a[220:223], v[172:175], v[104:107]
  v_mfma_f32_16x16x32_bf16 v[108:111], a[224:227], v[172:175], v[108:111]
  s_waitcnt lgkmcnt(3)
  v_mfma_f32_16x16x32_bf16 v[64:67], a[228:231], v[176:179], v[64:67]
  s_waitcnt vmcnt(15)
  s_barrier
  ds_read_b128 v[160:163], v16 offset:32768
  v_mfma_f32_16x16x32_bf16 v[68:71], a[232:235], v[176:179], v[68:71]
  v_mfma_f32_16x16x32_bf16 v[72:75], a[236:239], v[176:179], v[72:75]
  s_waitcnt lgkmcnt(3)
  v_mfma_f32_16x16x32_bf16 v[76:79], a[228:231], v[180:183], v[76:79]
  ds_read_b128 v[164:167], v16 offset:34816
  v_cvt_pk_bf16_f32 v192, v64, v65
  v_mfma_f32_16x16x32_bf16 v[80:83], a[232:235], v[180:183], v[80:83]
  v_cvt_pk_bf16_f32 v193, v66, v67
  v_cvt_pk_bf16_f32 v194, v68, v69
  v_mfma_f32_16x16x32_bf16 v[84:87], a[236:239], v[180:183], v[84:87]
  s_waitcnt lgkmcnt(3)
  v_cvt_pk_bf16_f32 v195, v70, v71
  v_cvt_pk_bf16_f32 v200, v72, v73
  v_mfma_f32_16x16x32_bf16 v[88:91], a[228:231], v[184:187], v[88:91]
  ds_read_b128 v[168:171], v16 offset:36864
  v_cvt_pk_bf16_f32 v201, v74, v75
  v_mfma_f32_16x16x32_bf16 v[92:95], a[232:235], v[184:187], v[92:95]
  v_cvt_pk_bf16_f32 v196, v76, v77
  v_cvt_pk_bf16_f32 v197, v78, v79
  v_mfma_f32_16x16x32_bf16 v[96:99], a[236:239], v[184:187], v[96:99]
  s_waitcnt lgkmcnt(3)
  v_cvt_pk_bf16_f32 v198, v80, v81
  v_cvt_pk_bf16_f32 v199, v82, v83
  v_mfma_f32_16x16x32_bf16 v[100:103], a[228:231], v[188:191], v[100:103]
  ds_read_b128 v[172:175], v16 offset:38912
  v_cvt_pk_bf16_f32 v202, v84, v85
  v_mfma_f32_16x16x32_bf16 v[104:107], a[232:235], v[188:191], v[104:107]
  s_sub_u32 s26, s26, 1
  s_cmp_gt_u32 s26, 0
  v_cvt_pk_bf16_f32 v203, v86, v87
  v_mfma_f32_16x16x32_bf16 v[108:111], a[236:239], v[188:191], v[108:111]
  s_waitcnt lgkmcnt(3)
  s_cbranch_scc1 kvm_240
  s_nop 7
  v_cvt_pk_bf16_f32 v204, v88, v89
  v_cvt_pk_bf16_f32 v205, v90, v91
  v_cvt_pk_bf16_f32 v206, v92, v93
  v_cvt_pk_bf16_f32 v207, v94, v95
  v_cvt_pk_bf16_f32 v212, v96, v97
  v_cvt_pk_bf16_f32 v213, v98, v99
  v_cvt_pk_bf16_f32 v208, v100, v101
  v_cvt_pk_bf16_f32 v209, v102, v103
  v_cvt_pk_bf16_f32 v210, v104, v105
  v_cvt_pk_bf16_f32 v211, v106, v107
  v_cvt_pk_bf16_f32 v214, v108, v109
  v_cvt_pk_bf16_f32 v215, v110, v111
  s_xor_b32 s29, s48, 0
  buffer_store_dwordx4 v[192:195], v26, s[16:19], s29 offen offset:0 sc1
  buffer_store_dwordx4 v[196:199], v26, s[16:19], s29 offen offset:1024 sc1
  buffer_store_dwordx4 v[200:203], v26, s[16:19], s29 offen offset:2048 sc1
  s_xor_b32 s29, s48, 2105344
  buffer_store_dwordx4 v[204:207], v26, s[16:19], s29 offen offset:0 sc1
  buffer_store_dwordx4 v[208:211], v26, s[16:19], s29 offen offset:1024 sc1
  buffer_store_dwordx4 v[212:215], v26, s[16:19], s29 offen offset:2048 sc1
  s_mov_b32 s30, 491520
  s_mov_b32 s25, 162688
  v_lshrrev_b32 v4, 3, v1
  v_and_b32 v5, 7, v1
  v_xor_b32 v5, v5, v4
  s_mul_i32 s21, s20, 32
  v_add_u32 v4, s21, v4
  v_mul_u32_u24 v4, 1280, v4
  v_lshl_add_u32 v10, v5, 4, v4
  s_mul_i32 s31, s20, 4096
  v_add_u32 v11, 10240, v10
  v_add_u32 v12, 20480, v10
  v_add_u32 v13, 30720, v10
  s_add_u32 m0, s31, 0
  s_nop 0
  buffer_load_dwordx4 v10, s[8:11], s30 offen lds
  s_add_u32 m0, s31, 1024
  s_nop 0
  buffer_load_dwordx4 v11, s[8:11], s30 offen lds
  s_add_u32 m0, s31, 2048
  s_nop 0
  buffer_load_dwordx4 v12, s[8:11], s30 offen lds
  s_add_u32 m0, s31, 3072
  s_nop 0
  buffer_load_dwordx4 v13, s[8:11], s30 offen lds
  s_add_u32 s30, s30, 128
  s_add_u32 m0, s31, 16384
  s_nop 0
  buffer_load_dwordx4 v10, s[8:11], s30 offen lds
  s_add_u32 m0, s31, 17408
  s_nop 0
  buffer_load_dwordx4 v11, s[8:11], s30 offen lds
  s_add_u32 m0, s31, 18432
  s_nop 0
  buffer_load_dwordx4 v12, s[8:11], s30 offen lds
  s_add_u32 m0, s31, 19456
  s_nop 0
  buffer_load_dwordx4 v13, s[8:11], s30 offen lds
  s_add_u32 s30, s30, 128
  s_add_u32 m0, s31, 32768
  s_nop 0
  buffer_load_dwordx4 v10, s[8:11], s30 offen lds
  s_add_u32 m0, s31, 33792
  s_nop 0
  buffer_load_dwordx4 v11, s[8:11], s30 offen lds
  s_add_u32 m0, s31, 34816
  s_nop 0
  buffer_load_dwordx4 v12, s[8:11], s30 offen lds
  s_add_u32 m0, s31, 35840
  s_nop 0
  buffer_load_dwordx4 v13, s[8:11], s30 offen lds
  s_add_u32 s30, s30, 128
  s_add_u32 m0, s31, 49152
  s_nop 0
  buffer_load_dwordx4 v10, s[8:11], s30 offen lds
  s_add_u32 m0, s31, 50176
  s_nop 0
  buffer_load_dwordx4 v11, s[8:11], s30 offen lds
  s_add_u32 m0, s31, 51200
  s_nop 0
  buffer_load_dwordx4 v12, s[8:11], s30 offen lds
  s_add_u32 m0, s31, 52224
  s_nop 0
  buffer_load_dwordx4 v13, s[8:11], s30 offen lds
  s_add_u32 s30, s30, 128
  s_add_u32 m0, s31, 65536
  s_nop 0
  buffer_load_dwordx4 v10, s[8:11], s30 offen lds
  s_add_u32 m0, s31, 66560
  s_nop 0
  buffer_load_dwordx4 v11, s[8:11], s30 offen lds
  s_add_u32 m0, s31, 67584
  s_nop 0
  buffer_load_dwordx4 v12, s[8:11], s30 offen lds
  s_add_u32 m0, s31, 68608
  s_nop 0
  buffer_load_dwordx4 v13, s[8:11], s30 offen lds
  s_add_u32 s30, s30, 128
  s_waitcnt vmcnt(20) lgkmcnt(0)
  s_barrier
  buffer_atomic_add v28, v27, s[72:75], s61 offen sc1
  s_add_u32 m0, s31, 81920
  s_nop 0
  buffer_load_dwordx4 v10, s[8:11], s30 offen lds
  s_add_u32 m0, s31, 82944
  s_nop 0
  buffer_load_dwordx4 v11, s[8:11], s30 offen lds
  s_add_u32 m0, s31, 83968
  s_nop 0
  buffer_load_dwordx4 v12, s[8:11], s30 offen lds
  s_add_u32 m0, s31, 84992
  s_nop 0
  buffer_load_dwordx4 v13, s[8:11], s30 offen lds
  s_add_u32 s30, s30, 128
  s_mov_b32 s26, 13
  s_mov_b32 s48, 0x40000000
  s_mov_b32 s61, 0x40000000
  s_waitcnt vmcnt(16)
  s_barrier
  ds_read_b128 v[160:163], v14 offset:0
  ds_read_b128 v[164:167], v14 offset:2048
  ds_read_b128 v[168:171], v14 offset:4096
  ds_read_b128 v[172:175], v14 offset:6144
  s_waitcnt lgkmcnt(3)
  .p2align 3
kvs_241:
  v_mfma_f32_16x16x32_bf16 v[64:67], a[0:3], v[160:163], 0
  s_xor_b32 s29, s48, 0
  ds_read_b128 v[176:179], v14 offset:8192
  v_cvt_pk_bf16_f32 v221, v126, v127
  v_mfma_f32_16x16x32_bf16 v[68:71], a[4:7], v[160:163], 0
  v_cvt_pk_bf16_f32 v222, v128, v129
  v_cvt_pk_bf16_f32 v223, v130, v131
  v_mfma_f32_16x16x32_bf16 v[72:75], a[8:11], v[160:163], 0
  s_waitcnt lgkmcnt(3)
  v_cvt_pk_bf16_f32 v226, v132, v133
  v_cvt_pk_bf16_f32 v227, v134, v135
  v_mfma_f32_16x16x32_bf16 v[76:79], a[0:3], v[164:167], 0
  ds_read_b128 v[180:183], v14 offset:10240
  v_cvt_pk_bf16_f32 v228, v136, v137
  v_mfma_f32_16x16x32_bf16 v[80:83], a[4:7], v[164:167], 0
  v_cvt_pk_bf16_f32 v229, v138, v139
  v_cvt_pk_bf16_f32 v230, v140, v141
  v_mfma_f32_16x16x32_bf16 v[84:87], a[8:11], v[164:167], 0
  s_waitcnt lgkmcnt(3)
  v_cvt_pk_bf16_f32 v231, v142, v143
  v_cvt_pk_bf16_f32 v236, v144, v145
  v_mfma_f32_16x16x32_bf16 v[88:91], a[0:3], v[168:171], 0
  ds_read_b128 v[184:187], v14 offset:12288
  v_cvt_pk_bf16_f32 v237, v146, v147
  v_mfma_f32_16x16x32_bf16 v[92:95], a[4:7], v[168:171], 0
  v_cvt_pk_bf16_f32 v232, v148, v149
  v_cvt_pk_bf16_f32 v233, v150, v151
  v_mfma_f32_16x16x32_bf16 v[96:99], a[8:11], v[168:171], 0
  s_waitcnt lgkmcnt(3)
  v_cvt_pk_bf16_f32 v234, v152, v153
  v_cvt_pk_bf16_f32 v235, v154, v155
  v_mfma_f32_16x16x32_bf16 v[100:103], a[0:3], v[172:175], 0
  ds_read_b128 v[188:191], v14 offset:14336
  v_cvt_pk_bf16_f32 v238, v156, v157
  v_mfma_f32_16x16x32_bf16 v[104:107], a[4:7], v[172:175], 0
  v_cvt_pk_bf16_f32 v239, v158, v159
  v_mfma_f32_16x16x32_bf16 v[108:111], a[8:11], v[172:175], 0
  s_waitcnt lgkmcnt(3)
  v_mfma_f32_16x16x32_bf16 v[112:115], a[0:3], v[176:179], 0
  ds_read_b128 v[160:163], v15 offset:0
  v_mfma_f32_16x16x32_bf16 v[116:119], a[4:7], v[176:179], 0
  s_add_u32 m0, s31, 98304
  v_mfma_f32_16x16x32_bf16 v[120:123], a[8:11], v[176:179], 0
  s_waitcnt lgkmcnt(3)
  buffer_load_dwordx4 v10, s[8:11], s30 offen lds
  v_mfma_f32_16x16x32_bf16 v[124:127], a[0:3], v[180:183], 0
  ds_read_b128 v[164:167], v15 offset:2048
  v_mfma_f32_16x16x32_bf16 v[128:131], a[4:7], v[180:183], 0
  v_mfma_f32_16x16x32_bf16 v[132:135], a[8:11], v[180:183], 0
  s_waitcnt lgkmcnt(3)
  v_mfma_f32_16x16x32_bf16 v[136:139], a[0:3], v[184:187], 0
  ds_read_b128 v[168:171], v15 offset:4096
  v_mfma_f32_16x16x32_bf16 v[140:143], a[4:7], v[184:187], 0
  s_add_u32 m0, s31, 99328
  v_mfma_f32_16x16x32_bf16 v[144:147], a[8:11], v[184:187], 0
  s_waitcnt lgkmcnt(3)
  buffer_load_dwordx4 v11, s[8:11], s30 offen lds
  v_mfma_f32_16x16x32_bf16 v[148:151], a[0:3], v[188:191], 0
  ds_read_b128 v[172:175], v15 offset:6144
  v_mfma_f32_16x16x32_bf16 v[152:155], a[4:7], v[188:191], 0
  v_mfma_f32_16x16x32_bf16 v[156:159], a[8:11], v[188:191], 0
  s_waitcnt lgkmcnt(3)
  v_mfma_f32_16x16x32_bf16 v[64:67], a[12:15], v[160:163], v[64:67]
  ds_read_b128 v[176:179], v15 offset:8192
  v_mfma_f32_16x16x32_bf16 v[68:71], a[16:19], v[160:163], v[68:71]
  s_add_u32 m0, s31, 100352
  v_mfma_f32_16x16x32_bf16 v[72:75], a[20:23], v[160:163], v[72:75]
  s_waitcnt lgkmcnt(3)
  buffer_load_dwordx4 v12, s[8:11], s30 offen lds
  v_mfma_f32_16x16x32_bf16 v[76:79], a[12:15], v[164:167], v[76:79]
  ds_read_b128 v[180:183], v15 offset:10240
  v_mfma_f32_16x16x32_bf16 v[80:83], a[16:19], v[164:167], v[80:83]
  v_mfma_f32_16x16x32_bf16 v[84:87], a[20:23], v[164:167], v[84:87]
  s_waitcnt lgkmcnt(3)
  v_mfma_f32_16x16x32_bf16 v[88:91], a[12:15], v[168:171], v[88:91]
  ds_read_b128 v[184:187], v15 offset:12288
  v_mfma_f32_16x16x32_bf16 v[92:95], a[16:19], v[168:171], v[92:95]
  s_add_u32 m0, s31, 101376
  v_mfma_f32_16x16x32_bf16 v[96:99], a[20:23], v[168:171], v[96:99]
  s_waitcnt lgkmcnt(3)
  buffer_load_dwordx4 v13, s[8:11], s30 offen lds
  v_mfma_f32_16x16x32_bf16 v[100:103], a[12:15], v[172:175], v[100:103]
  s_add_u32 s30, s30, 128
  ds_read_b128 v[188:191], v15 offset:14336
  v_mfma_f32_16x16x32_bf16 v[104:107], a[16:19], v[172:175], v[104:107]
  v_mfma_f32_16x16x32_bf16 v[108:111], a[20:23], v[172:175], v[108:111]
  s_waitcnt lgkmcnt(3)
  v_mfma_f32_16x16x32_bf16 v[112:115], a[12:15], v[176:179], v[112:115]
  ds_read_b128 v[160:163], v14 offset:16384
  v_mfma_f32_16x16x32_bf16 v[116:119], a[16:19], v[176:179], v[116:119]
  buffer_store_dwordx4 v[192:195], v26, s[16:19], s29 offen offset:0 sc1
  v_mfma_f32_16x16x32_bf16 v[120:123], a[20:23], v[176:179], v[120:123]
  s_waitcnt lgkmcnt(3)
  v_mfma_f32_16x16x32_bf16 v[124:127], a[12:15], v[180:183], v[124:127]
  ds_read_b128 v[164:167], v14 offset:18432
  v_mfma_f32_16x16x32_bf16 v[128:131], a[16:19], v[180:183], v[128:131]
  v_mfma_f32_16x16x32_bf16 v[132:135], a[20:23], v[180:183], v[132:135]
  s_waitcnt lgkmcnt(3)
  v_mfma_f32_16x16x32_bf16 v[136:139], a[12:15], v[184:187], v[136:139]
  ds_read_b128 v[168:171], v14 offset:20480
  buffer_store_dwordx4 v[196:199], v26, s[16:19], s29 offen offset:1024 sc1
  v_mfma_f32_16x16x32_bf16 v[140:143], a[16:19], v[184:187], v[140:143]
  v_mfma_f32_16x16x32_bf16 v[144:147], a[20:23], v[184:187], v[144:147]
  s_waitcnt lgkmcnt(3)
  v_mfma_f32_16x16x32_bf16 v[148:151], a[12:15], v[188:191], v[148:151]
  ds_read_b128 v[172:175], v14 offset:22528
  v_mfma_f32_16x16x32_bf16 v[152:155], a[16:19], v[188:191], v[152:155]
  v_mfma_f32_16x16x32_bf16 v[156:159], a[20:23], v[188:191], v[156:159]
  s_waitcnt lgkmcnt(3)
  v_mfma_f32_16x16x32_bf16 v[64:67], a[24:27], v[160:163], v[64:67]
  ds_read_b128 v[176:179], v14 offset:24576
  v_mfma_f32_16x16x32_bf16 v[68:71], a[28:31], v[160:163], v[68:71]
  s_add_u32 m0, s31, 114688
  v_mfma_f32_16x16x32_bf16 v[72:75], a[32:35], v[160:163], v[72:75]
  s_waitcnt lgkmcnt(3)
  buffer_load_dwordx4 v10, s[8:11], s30 offen lds
  v_mfma_f32_16x16x32_bf16 v[76:79], a[24:27], v[164:167], v[76:79]
  ds_read_b128 v[180:183], v14 offset:26624
  v_mfma_f32_16x16x32_bf16 v[80:83], a[28:31], v[164:167], v[80:83]
  v_mfma_f32_16x16x32_bf16 v[84:87], a[32:35], v[164:167], v[84:87]
  s_waitcnt lgkmcnt(3)
  v_mfma_f32_16x16x32_bf16 v[88:91], a[24:27], v[168:171], v[88:91]
  ds_read_b128 v[184:187], v14 offset:28672
  v_mfma_f32_16x16x32_bf16 v[92:95], a[28:31], v[168:171], v[92:95]
  buffer_store_dwordx4 v[200:203], v26, s[16:19], s29 offen offset:2048 sc1
  v_mfma_f32_16x16x32_bf16 v[96:99], a[32:35], v[168:171], v[96:99]
  s_waitcnt lgkmcnt(3)
  v_mfma_f32_16x16x32_bf16 v[100:103], a[24:27], v[172:175], v[100:103]
  ds_read_b128 v[188:191], v14 offset:30720
  v_mfma_f32_16x16x32_bf16 v[104:107], a[28:31], v[172:175], v[104:107]
  v_mfma_f32_16x16x32_bf16 v[108:111], a[32:35], v[172:175], v[108:111]
  s_xor_b32 s29, s48, 2105344
  s_waitcnt lgkmcnt(3)
  v_mfma_f32_16x16x32_bf16 v[112:115], a[24:27], v[176:179], v[112:115]
  ds_read_b128 v[160:163], v15 offset:16384
  v_mfma_f32_16x16x32_bf16 v[116:119], a[28:31], v[176:179], v[116:119]
  s_add_u32 m0, s31, 115712
  v_mfma_f32_16x16x32_bf16 v[120:123], a[32:35], v[176:179], v[120:123]
  s_waitcnt lgkmcnt(3)
  buffer_load_dwordx4 v11, s[8:11], s30 offen lds
  v_mfma_f32_16x16x32_bf16 v[124:127], a[24:27], v[180:183], v[124:127]
  ds_read_b128 v[164:167], v15 offset:18432
  v_mfma_f32_16x16x32_bf16 v[128:131], a[28:31], v[180:183], v[128:131]
  v_mfma_f32_16x16x32_bf16 v[132:135], a[32:35], v[180:183], v[132:135]
  s_waitcnt lgkmcnt(3)
  v_mfma_f32_16x16x32_bf16 v[136:139], a[24:27], v[184:187], v[136:139]
  ds_read_b128 v[168:171], v15 offset:20480
  v_mfma_f32_16x16x32_bf16 v[140:143], a[28:31], v[184:187], v[140:143]
  buffer_store_dwordx4 v[204:207], v26, s[16:19], s29 offen offset:0 sc1
  v_mfma_f32_16x16x32_bf16 v[144:147], a[32:35], v[184:187], v[144:147]
  s_waitcnt lgkmcnt(3)
  v_mfma_f32_16x16x32_bf16 v[148:151], a[24:27], v[188:191], v[148:151]
  ds_read_b128 v[172:175], v15 offset:22528
  v_mfma_f32_16x16x32_bf16 v[152:155], a[28:31], v[188:191], v[152:155]
  v_mfma_f32_16x16x32_bf16 v[156:159], a[32:35], v[188:191], v[156:159]
  s_waitcnt lgkmcnt(3)
  v_mfma_f32_16x16x32_bf16 v[64:67], a[36:39], v[160:163], v[64:67]
  ds_read_b128 v[176:179], v15 offset:24576
  v_mfma_f32_16x16x32_bf16 v[68:71], a[40:43], v[160:163], v[68:71]
  s_add_u32 m0, s31, 116736
  v_mfma_f32_16x16x32_bf16 v[72:75], a[44:47], v[160:163], v[72:75]
  s_waitcnt lgkmcnt(3)
  buffer_load_dwordx4 v12, s[8:11], s30 offen lds
  v_mfma_f32_16x16x32_bf16 v[76:79], a[36:39], v[164:167], v[76:79]
  ds_read_b128 v[180:183], v15 offset:26624
  v_mfma_f32_16x16x32_bf16 v[80:83], a[40:43], v[164:167], v[80:83]
  v_mfma_f32_16x16x32_bf16 v[84:87], a[44:47], v[164:167], v[84:87]
  s_waitcnt lgkmcnt(3)
  v_mfma_f32_16x16x32_bf16 v[88:91], a[36:39], v[168:171], v[88:91]
  ds_read_b128 v[184:187], v15 offset:28672
  v_mfma_f32_16x16x32_bf16 v[92:95], a[40:43], v[168:171], v[92:95]
  buffer_store_dwordx4 v[208:211], v26, s[16:19], s29 offen offset:1024 sc1
  v_mfma_f32_16x16x32_bf16 v[96:99], a[44:47], v[168:171], v[96:99]
  s_waitcnt lgkmcnt(3)
  v_mfma_f32_16x16x32_bf16 v[100:103], a[36:39], v[172:175], v[100:103]
  ds_read_b128 v[188:191], v15 offset:30720
  v_mfma_f32_16x16x32_bf16 v[104:107], a[40:43], v[172:175], v[104:107]
  v_mfma_f32_16x16x32_bf16 v[108:111], a[44:47], v[172:175], v[108:111]
  s_waitcnt lgkmcnt(3)
  v_mfma_f32_16x16x32_bf16 v[112:115], a[36:39], v[176:179], v[112:115]
  s_waitcnt vmcnt(20)
  s_barrier
  ds_read_b128 v[160:163], v14 offset:32768
  v_mfma_f32_16x16x32_bf16 v[116:119], a[40:43], v[176:179], v[116:119]
  s_add_u32 m0, s31, 117760
  v_mfma_f32_16x16x32_bf16 v[120:123], a[44:47], v[176:179], v[120:123]
  s_waitcnt lgkmcnt(3)
  buffer_load_dwordx4 v13, s[8:11], s30 offen lds
  v_mfma_f32_16x16x32_bf16 v[124:127], a[36:39], v[180:183], v[124:127]
  s_add_u32 s30, s30, 128
  ds_read_b128 v[164:167], v14 offset:34816
  v_mfma_f32_16x16x32_bf16 v[128:131], a[40:43], v[180:183], v[128:131]
  v_mfma_f32_16x16x32_bf16 v[132:135], a[44:47], v[180:183], v[132:135]
  s_waitcnt lgkmcnt(3)
  v_mfma_f32_16x16x32_bf16 v[136:139], a[36:39], v[184:187], v[136:139]
  ds_read_b128 v[168:171], v14 offset:36864
  v_mfma_f32_16x16x32_bf16 v[140:143], a[40:43], v[184:187], v[140:143]
  buffer_store_dwordx4 v[212:215], v26, s[16:19], s29 offen offset:2048 sc1
  v_mfma_f32_16x16x32_bf16 v[144:147], a[44:47], v[184:187], v[144:147]
  s_waitcnt lgkmcnt(3)
  v_mfma_f32_16x16x32_bf16 v[148:151], a[36:39], v[188:191], v[148:151]
  ds_read_b128 v[172:175], v14 offset:38912
  v_mfma_f32_16x16x32_bf16 v[152:155], a[40:43], v[188:191], v[152:155]
  v_mfma_f32_16x16x32_bf16 v[156:159], a[44:47], v[188:191], v[156:159]
  s_xor_b32 s29, s48, 4194304
  s_waitcnt lgkmcnt(3)
  v_mfma_f32_16x16x32_bf16 v[64:67], a[48:51], v[160:163], v[64:67]
  ds_read_b128 v[176:179], v14 offset:40960
  v_mfma_f32_16x16x32_bf16 v[68:71], a[52:55], v[160:163], v[68:71]
  s_add_u32 m0, s31, 131072
  v_mfma_f32_16x16x32_bf16 v[72:75], a[56:59], v[160:163], v[72:75]
  s_waitcnt lgkmcnt(3)
  buffer_load_dwordx4 v10, s[8:11], s30 offen lds
  v_mfma_f32_16x16x32_bf16 v[76:79], a[48:51], v[164:167], v[76:79]
  ds_read_b128 v[180:183], v14 offset:43008
  v_mfma_f32_16x16x32_bf16 v[80:83], a[52:55], v[164:167], v[80:83]
  v_mfma_f32_16x16x32_bf16 v[84:87], a[56:59], v[164:167], v[84:87]
  s_waitcnt lgkmcnt(3)
  v_mfma_f32_16x16x32_bf16 v[88:91], a[48:51], v[168:171], v[88:91]
  ds_read_b128 v[184:187], v14 offset:45056
  v_mfma_f32_16x16x32_bf16 v[92:95], a[52:55], v[168:171], v[92:95]
  buffer_store_dwordx4 v[216:219], v26, s[16:19], s29 offen offset:0 sc1
  v_mfma_f32_16x16x32_bf16 v[96:99], a[56:59], v[168:171], v[96:99]
  s_waitcnt lgkmcnt(3)
  v_mfma_f32_16x16x32_bf16 v[100:103], a[48:51], v[172:175], v[100:103]
  ds_read_b128 v[188:191], v14 offset:47104
  v_mfma_f32_16x16x32_bf16 v[104:107], a[52:55], v[172:175], v[104:107]
  v_mfma_f32_16x16x32_bf16 v[108:111], a[56:59], v[172:175], v[108:111]
  s_waitcnt lgkmcnt(3)
  v_mfma_f32_16x16x32_bf16 v[112:115], a[48:51], v[176:179], v[112:115]
  ds_read_b128 v[160:163], v15 offset:32768
  v_mfma_f32_16x16x32_bf16 v[116:119], a[52:55], v[176:179], v[116:119]
  s_add_u32 m0, s31, 132096
  v_mfma_f32_16x16x32_bf16 v[120:123], a[56:59], v[176:179], v[120:123]
  s_waitcnt lgkmcnt(3)
  buffer_load_dwordx4 v11, s[8:11], s30 offen lds
  v_mfma_f32_16x16x32_bf16 v[124:127], a[48:51], v[180:183], v[124:127]
  ds_read_b128 v[164:167], v15 offset:34816
  v_mfma_f32_16x16x32_bf16 v[128:131], a[52:55], v[180:183], v[128:131]
  v_mfma_f32_16x16x32_bf16 v[132:135], a[56:59], v[180:183], v[132:135]
  s_waitcnt lgkmcnt(3)
  v_mfma_f32_16x16x32_bf16 v[136:139], a[48:51], v[184:187], v[136:139]
  ds_read_b128 v[168:171], v15 offset:36864
  v_mfma_f32_16x16x32_bf16 v[140:143], a[52:55], v[184:187], v[140:143]
  buffer_store_dwordx4 v[220:223], v26, s[16:19], s29 offen offset:1024 sc1
  v_mfma_f32_16x16x32_bf16 v[144:147], a[56:59], v[184:187], v[144:147]
  s_waitcnt lgkmcnt(3)
  v_mfma_f32_16x16x32_bf16 v[148:151], a[48:51], v[188:191], v[148:151]
  ds_read_b128 v[172:175], v15 offset:38912
  v_mfma_f32_16x16x32_bf16 v[152:155], a[52:55], v[188:191], v[152:155]
  v_mfma_f32_16x16x32_bf16 v[156:159], a[56:59], v[188:191], v[156:159]
  s_waitcnt lgkmcnt(3)
  v_mfma_f32_16x16x32_bf16 v[64:67], a[60:63], v[160:163], v[64:67]
  ds_read_b128 v[176:179], v15 offset:40960
  v_mfma_f32_16x16x32_bf16 v[68:71], a[64:67], v[160:163], v[68:71]
  s_add_u32 m0, s31, 133120
  v_mfma_f32_16x16x32_bf16 v[72:75], a[68:71], v[160:163], v[72:75]
  s_waitcnt lgkmcnt(3)
  buffer_load_dwordx4 v12, s[8:11], s30 offen lds
  v_mfma_f32_16x16x32_bf16 v[76:79], a[60:63], v[164:167], v[76:79]
  ds_read_b128 v[180:183], v15 offset:43008
  v_mfma_f32_16x16x32_bf16 v[80:83], a[64:67], v[164:167], v[80:83]
  v_mfma_f32_16x16x32_bf16 v[84:87], a[68:71], v[164:167], v[84:87]
  s_waitcnt lgkmcnt(3)
  v_mfma_f32_16x16x32_bf16 v[88:91], a[60:63], v[168:171], v[88:91]
  ds_read_b128 v[184:187], v15 offset:45056
  v_mfma_f32_16x16x32_bf16 v[92:95], a[64:67], v[168:171], v[92:95]
  buffer_store_dwordx4 v[224:227], v26, s[16:19], s29 offen offset:2048 sc1
  v_mfma_f32_16x16x32_bf16 v[96:99], a[68:71], v[168:171], v[96:99]
  s_waitcnt lgkmcnt(3)
  v_mfma_f32_16x16x32_bf16 v[100:103], a[60:63], v[172:175], v[100:103]
  ds_read_b128 v[188:191], v15 offset:47104
  v_mfma_f32_16x16x32_bf16 v[104:107], a[64:67], v[172:175], v[104:107]
  v_mfma_f32_16x16x32_bf16 v[108:111], a[68:71], v[172:175], v[108:111]
  s_xor_b32 s29, s48, 6299648
  s_waitcnt lgkmcnt(3)
  v_mfma_f32_16x16x32_bf16 v[112:115], a[60:63], v[176:179], v[112:115]
  ds_read_b128 v[160:163], v14 offset:49152
  v_mfma_f32_16x16x32_bf16 v[116:119], a[64:67], v[176:179], v[116:119]
  s_add_u32 m0, s31, 134144
  v_mfma_f32_16x16x32_bf16 v[120:123], a[68:71], v[176:179], v[120:123]
  s_waitcnt lgkmcnt(3)
  buffer_load_dwordx4 v13, s[8:11], s30 offen lds
  v_mfma_f32_16x16x32_bf16 v[124:127], a[60:63], v[180:183], v[124:127]
  s_add_u32 s30, s30, 128
  ds_read_b128 v[164:167], v14 offset:51200
  v_mfma_f32_16x16x32_bf16 v[128:131], a[64:67], v[180:183], v[128:131]
  v_mfma_f32_16x16x32_bf16 v[132:135], a[68:71], v[180:183], v[132:135]
  s_waitcnt lgkmcnt(3)
  v_mfma_f32_16x16x32_bf16 v[136:139], a[60:63], v[184:187], v[136:139]
  ds_read_b128 v[168:171], v14 offset:53248
  v_mfma_f32_16x16x32_bf16 v[140:143], a[64:67], v[184:187], v[140:143]
  buffer_store_dwordx4 v[228:231], v26, s[16:19], s29 offen offset:0 sc1
  v_mfma_f32_16x16x32_bf16 v[144:147], a[68:71], v[184:187], v[144:147]
  s_waitcnt lgkmcnt(3)
  v_mfma_f32_16x16x32_bf16 v[148:151], a[60:63], v[188:191], v[148:151]
  ds_read_b128 v[172:175], v14 offset:55296
  v_mfma_f32_16x16x32_bf16 v[152:155], a[64:67], v[188:191], v[152:155]
  v_mfma_f32_16x16x32_bf16 v[156:159], a[68:71], v[188:191], v[156:159]
  s_waitcnt lgkmcnt(3)
  v_mfma_f32_16x16x32_bf16 v[64:67], a[72:75], v[160:163], v[64:67]
  ds_read_b128 v[176:179], v14 offset:57344
  v_mfma_f32_16x16x32_bf16 v[68:71], a[76:79], v[160:163], v[68:71]
  s_add_u32 m0, s31, 147456
  v_mfma_f32_16x16x32_bf16 v[72:75], a[80:83], v[160:163], v[72:75]
  s_waitcnt lgkmcnt(3)
  buffer_load_dwordx4 v10, s[8:11], s30 offen lds
  v_mfma_f32_16x16x32_bf16 v[76:79], a[72:75], v[164:167], v[76:79]
  ds_read_b128 v[180:183], v14 offset:59392
  v_mfma_f32_16x16x32_bf16 v[80:83], a[76:79], v[164:167], v[80:83]
  v_mfma_f32_16x16x32_bf16 v[84:87], a[80:83], v[164:167], v[84:87]
  s_waitcnt lgkmcnt(3)
  v_mfma_f32_16x16x32_bf16 v[88:91], a[72:75], v[168:171], v[88:91]
  ds_read_b128 v[184:187], v14 offset:61440
  v_mfma_f32_16x16x32_bf16 v[92:95], a[76:79], v[168:171], v[92:95]
  buffer_store_dwordx4 v[232:235], v26, s[16:19], s29 offen offset:1024 sc1
  v_mfma_f32_16x16x32_bf16 v[96:99], a[80:83], v[168:171], v[96:99]
  s_waitcnt lgkmcnt(3)
  v_mfma_f32_16x16x32_bf16 v[100:103], a[72:75], v[172:175], v[100:103]
  ds_read_b128 v[188:191], v14 offset:63488
  v_mfma_f32_16x16x32_bf16 v[104:107], a[76:79], v[172:175], v[104:107]
  v_mfma_f32_16x16x32_bf16 v[108:111], a[80:83], v[172:175], v[108:111]
  s_waitcnt lgkmcnt(3)
  v_mfma_f32_16x16x32_bf16 v[112:115], a[72:75], v[176:179], v[112:115]
  ds_read_b128 v[160:163], v15 offset:49152
  v_mfma_f32_16x16x32_bf16 v[116:119], a[76:79], v[176:179], v[116:119]
  s_add_u32 m0, s31, 148480
  v_mfma_f32_16x16x32_bf16 v[120:123], a[80:83], v[176:179], v[120:123]
  s_waitcnt lgkmcnt(3)
  buffer_load_dwordx4 v11, s[8:11], s30 offen lds
  v_mfma_f32_16x16x32_bf16 v[124:127], a[72:75], v[180:183], v[124:127]
  ds_read_b128 v[164:167], v15 offset:51200
  v_mfma_f32_16x16x32_bf16 v[128:131], a[76:79], v[180:183], v[128:131]
  v_mfma_f32_16x16x32_bf16 v[132:135], a[80:83], v[180:183], v[132:135]
  s_waitcnt lgkmcnt(3)
  v_mfma_f32_16x16x32_bf16 v[136:139], a[72:75], v[184:187], v[136:139]
  ds_read_b128 v[168:171], v15 offset:53248
  v_mfma_f32_16x16x32_bf16 v[140:143], a[76:79], v[184:187], v[140:143]
  buffer_store_dwordx4 v[236:239], v26, s[16:19], s29 offen offset:2048 sc1
  v_mfma_f32_16x16x32_bf16 v[144:147], a[80:83], v[184:187], v[144:147]
  s_waitcnt lgkmcnt(3)
  v_mfma_f32_16x16x32_bf16 v[148:151], a[72:75], v[188:191], v[148:151]
  ds_read_b128 v[172:175], v15 offset:55296
  v_mfma_f32_16x16x32_bf16 v[152:155], a[76:79], v[188:191], v[152:155]
  v_mfma_f32_16x16x32_bf16 v[156:159], a[80:83], v[188:191], v[156:159]
  s_waitcnt lgkmcnt(3)
  v_mfma_f32_16x16x32_bf16 v[64:67], a[84:87], v[160:163], v[64:67]
  ds_read_b128 v[176:179], v15 offset:57344
  v_mfma_f32_16x16x32_bf16 v[68:71], a[88:91], v[160:163], v[68:71]
  s_add_u32 m0, s31, 149504
  v_mfma_f32_16x16x32_bf16 v[72:75], a[92:95], v[160:163], v[72:75]
  s_waitcnt lgkmcnt(3)
  buffer_load_dwordx4 v12, s[8:11], s30 offen lds
  v_mfma_f32_16x16x32_bf16 v[76:79], a[84:87], v[164:167], v[76:79]
  ds_read_b128 v[180:183], v15 offset:59392
  v_mfma_f32_16x16x32_bf16 v[80:83], a[88:91], v[164:167], v[80:83]
  v_mfma_f32_16x16x32_bf16 v[84:87], a[92:95], v[164:167], v[84:87]
  s_waitcnt lgkmcnt(3)
  v_mfma_f32_16x16x32_bf16 v[88:91], a[84:87], v[168:171], v[88:91]
  ds_read_b128 v[184:187], v15 offset:61440
  v_mfma_f32_16x16x32_bf16 v[92:95], a[88:91], v[168:171], v[92:95]
  v_mfma_f32_16x16x32_bf16 v[96:99], a[92:95], v[168:171], v[96:99]
  s_waitcnt lgkmcnt(3)
  v_mfma_f32_16x16x32_bf16 v[100:103], a[84:87], v[172:175], v[100:103]
  ds_read_b128 v[188:191], v15 offset:63488
  v_mfma_f32_16x16x32_bf16 v[104:107], a[88:91], v[172:175], v[104:107]
  s_cmp_le_u32 s26, 9
  s_cselect_b32 s62, 0x40000000, s61
  s_cselect_b32 s61, s61, 0x40000000
  s_cbranch_scc1 kf_242
  s_waitcnt vmcnt(1)
kf_242:
  v_mfma_f32_16x16x32_bf16 v[108:111], a[92:95], v[172:175], v[108:111]
  s_waitcnt lgkmcnt(3)
  v_mfma_f32_16x16x32_bf16 v[112:115], a[84:87], v[176:179], v[112:115]
  s_waitcnt vmcnt(27)
  s_barrier
  ds_read_b128 v[160:163], v16 offset:0
  v_mfma_f32_16x16x32_bf16 v[116:119], a[88:91], v[176:179], v[116:119]
  s_add_u32 m0, s31, 150528
  v_mfma_f32_16x16x32_bf16 v[120:123], a[92:95], v[176:179], v[120:123]
  s_waitcnt lgkmcnt(3)
  buffer_load_dwordx4 v13, s[8:11], s30 offen lds
  v_mfma_f32_16x16x32_bf16 v[124:127], a[84:87], v[180:183], v[124:127]
  s_add_u32 s30, s30, s25
  ds_read_b128 v[164:167], v16 offset:2048
  v_mfma_f32_16x16x32_bf16 v[128:131], a[88:91], v[180:183], v[128:131]
  v_mfma_f32_16x16x32_bf16 v[132:135], a[92:95], v[180:183], v[132:135]
  s_waitcnt lgkmcnt(3)
  v_mfma_f32_16x16x32_bf16 v[136:139], a[84:87], v[184:187], v[136:139]
  ds_read_b128 v[168:171], v16 offset:4096
  v_mfma_f32_16x16x32_bf16 v[140:143], a[88:91], v[184:187], v[140:143]
  buffer_atomic_add v28, v27, s[72:75], s62 offen sc1
  v_mfma_f32_16x16x32_bf16 v[144:147], a[92:95], v[184:187], v[144:147]
  s_waitcnt lgkmcnt(3)
  v_mfma_f32_16x16x32_bf16 v[148:151], a[84:87], v[188:191], v[148:151]
  ds_read_b128 v[172:175], v16 offset:6144
  v_mfma_f32_16x16x32_bf16 v[152:155], a[88:91], v[188:191], v[152:155]
  v_mfma_f32_16x16x32_bf16 v[156:159], a[92:95], v[188:191], v[156:159]
  s_waitcnt lgkmcnt(3)
  v_mfma_f32_16x16x32_bf16 v[64:67], a[96:99], v[160:163], v[64:67]
  ds_read_b128 v[176:179], v16 offset:8192
  v_mfma_f32_16x16x32_bf16 v[68:71], a[100:103], v[160:163], v[68:71]
  s_add_u32 m0, s31, 0
  v_mfma_f32_16x16x32_bf16 v[72:75], a[104:107], v[160:163], v[72:75]
  s_waitcnt lgkmcnt(3)
  buffer_load_dwordx4 v10, s[8:11], s30 offen lds
  v_mfma_f32_16x16x32_bf16 v[76:79], a[96:99], v[164:167], v[76:79]
  ds_read_b128 v[180:183], v16 offset:10240
  v_mfma_f32_16x16x32_bf16 v[80:83], a[100:103], v[164:167], v[80:83]
  v_mfma_f32_16x16x32_bf16 v[84:87], a[104:107], v[164:167], v[84:87]
  s_waitcnt lgkmcnt(3)
  v_mfma_f32_16x16x32_bf16 v[88:91], a[96:99], v[168:171], v[88:91]
  ds_read_b128 v[184:187], v16 offset:12288
  v_mfma_f32_16x16x32_bf16 v[92:95], a[100:103], v[168:171], v[92:95]
  v_mfma_f32_16x16x32_bf16 v[96:99], a[104:107], v[168:171], v[96:99]
  s_waitcnt lgkmcnt(3)
  v_mfma_f32_16x16x32_bf16 v[100:103], a[96:99], v[172:175], v[100:103]
  ds_read_b128 v[188:191], v16 offset:14336
  v_mfma_f32_16x16x32_bf16 v[104:107], a[100:103], v[172:175], v[104:107]
  v_mfma_f32_16x16x32_bf16 v[108:111], a[104:107], v[172:175], v[108:111]
  s_waitcnt lgkmcnt(3)
  v_mfma_f32_16x16x32_bf16 v[112:115], a[96:99], v[176:179], v[112:115]
  ds_read_b128 v[160:163], v17 offset:0
  v_mfma_f32_16x16x32_bf16 v[116:119], a[100:103], v[176:179], v[116:119]
  s_add_u32 m0, s31, 1024
  v_mfma_f32_16x16x32_bf16 v[120:123], a[104:107], v[176:179], v[120:123]
  s_waitcnt lgkmcnt(3)
  buffer_load_dwordx4 v11, s[8:11], s30 offen lds
  v_mfma_f32_16x16x32_bf16 v[124:127], a[96:99], v[180:183], v[124:127]
  ds_read_b128 v[164:167], v17 offset:2048
  v_mfma_f32_16x16x32_bf16 v[128:131], a[100:103], v[180:183], v[128:131]
  v_mfma_f32_16x16x32_bf16 v[132:135], a[104:107], v[180:183], v[132:135]
  s_waitcnt lgkmcnt(3)
  v_mfma_f32_16x16x32_bf16 v[136:139], a[96:99], v[184:187], v[136:139]
  ds_read_b128 v[168:171], v17 offset:4096
  v_mfma_f32_16x16x32_bf16 v[140:143], a[100:103], v[184:187], v[140:143]
  v_mfma_f32_16x16x32_bf16 v[144:147], a[104:107], v[184:187], v[144:147]
  s_waitcnt lgkmcnt(3)
  v_mfma_f32_16x16x32_bf16 v[148:151], a[96:99], v[188:191], v[148:151]
  ds_read_b128 v[172:175], v17 offset:6144
  v_mfma_f32_16x16x32_bf16 v[152:155], a[100:103], v[188:191], v[152:155]
  v_mfma_f32_16x16x32_bf16 v[156:159], a[104:107], v[188:191], v[156:159]
  s_waitcnt lgkmcnt(3)
  v_mfma_f32_16x16x32_bf16 v[64:67], a[108:111], v[160:163], v[64:67]
  ds_read_b128 v[176:179], v17 offset:8192
  v_mfma_f32_16x16x32_bf16 v[68:71], a[112:115], v[160:163], v[68:71]
  s_add_u32 m0, s31, 2048
  v_mfma_f32_16x16x32_bf16 v[72:75], a[116:119], v[160:163], v[72:75]
  s_waitcnt lgkmcnt(3)
  buffer_load_dwordx4 v12, s[8:11], s30 offen lds
  v_mfma_f32_16x16x32_bf16 v[76:79], a[108:111], v[164:167], v[76:79]
  ds_read_b128 v[180:183], v17 offset:10240
  v_mfma_f32_16x16x32_bf16 v[80:83], a[112:115], v[164:167], v[80:83]
  v_mfma_f32_16x16x32_bf16 v[84:87], a[116:119], v[164:167], v[84:87]
  s_waitcnt lgkmcnt(3)
  v_mfma_f32_16x16x32_bf16 v[88:91], a[108:111], v[168:171], v[88:91]
  ds_read_b128 v[184:187], v17 offset:12288
  v_mfma_f32_16x16x32_bf16 v[92:95], a[112:115], v[168:171], v[92:95]
  v_mfma_f32_16x16x32_bf16 v[96:99], a[116:119], v[168:171], v[96:99]
  s_waitcnt lgkmcnt(3)
  v_mfma_f32_16x16x32_bf16 v[100:103], a[108:111], v[172:175], v[100:103]
  ds_read_b128 v[188:191], v17 offset:14336
  v_mfma_f32_16x16x32_bf16 v[104:107], a[112:115], v[172:175], v[104:107]
  v_mfma_f32_16x16x32_bf16 v[108:111], a[116:119], v[172:175], v[108:111]
  s_waitcnt lgkmcnt(3)
  v_mfma_f32_16x16x32_bf16 v[112:115], a[108:111], v[176:179], v[112:115]
  ds_read_b128 v[160:163], v16 offset:16384
  v_mfma_f32_16x16x32_bf16 v[116:119], a[112:115], v[176:179], v[116:119]
  s_add_u32 m0, s31, 3072
  v_mfma_f32_16x16x32_bf16 v[120:123], a[116:119], v[176:179], v[120:123]
  s_waitcnt lgkmcnt(3)
  buffer_load_dwordx4 v13, s[8:11], s30 offen lds
  v_mfma_f32_16x16x32_bf16 v[124:127], a[108:111], v[180:183], v[124:127]
  s_add_u32 s30, s30, 128
  ds_read_b128 v[164:167], v16 offset:18432
  v_mfma_f32_16x16x32_bf16 v[128:131], a[112:115], v[180:183], v[128:131]
  v_mfma_f32_16x16x32_bf16 v[132:135], a[116:119], v[180:183], v[132:135]
  s_waitcnt lgkmcnt(3)
  v_mfma_f32_16x16x32_bf16 v[136:139], a[108:111], v[184:187], v[136:139]
  ds_read_b128 v[168:171], v16 offset:20480
  v_mfma_f32_16x16x32_bf16 v[140:143], a[112:115], v[184:187], v[140:143]
  v_mfma_f32_16x16x32_bf16 v[144:147], a[116:119], v[184:187], v[144:147]
  s_waitcnt lgkmcnt(3)
  v_mfma_f32_16x16x32_bf16 v[148:151], a[108:111], v[188:191], v[148:151]
  ds_read_b128 v[172:175], v16 offset:22528
  v_mfma_f32_16x16x32_bf16 v[152:155], a[112:115], v[188:191], v[152:155]
  v_mfma_f32_16x16x32_bf16 v[156:159], a[116:119], v[188:191], v[156:159]
  s_waitcnt lgkmcnt(3)
  v_mfma_f32_16x16x32_bf16 v[64:67], a[120:123], v[160:163], v[64:67]
  ds_read_b128 v[176:179], v16 offset:24576
  v_mfma_f32_16x16x32_bf16 v[68:71], a[124:127], v[160:163], v[68:71]
  s_add_u32 m0, s31, 16384
  v_mfma_f32_16x16x32_bf16 v[72:75], a[128:131], v[160:163], v[72:75]
  s_waitcnt lgkmcnt(3)
  buffer_load_dwordx4 v10, s[8:11], s30 offen lds
  v_mfma_f32_16x16x32_bf16 v[76:79], a[120:123], v[164:167], v[76:79]
  ds_read_b128 v[180:183], v16 offset:26624
  v_mfma_f32_16x16x32_bf16 v[80:83], a[124:127], v[164:167], v[80:83]
  v_mfma_f32_16x16x32_bf16 v[84:87], a[128:131], v[164:167], v[84:87]
  s_waitcnt lgkmcnt(3)
  v_mfma_f32_16x16x32_bf16 v[88:91], a[120:123], v[168:171], v[88:91]
  ds_read_b128 v[184:187], v16 offset:28672
  v_mfma_f32_16x16x32_bf16 v[92:95], a[124:127], v[168:171], v[92:95]
  v_mfma_f32_16x16x32_bf16 v[96:99], a[128:131], v[168:171], v[96:99]
  s_waitcnt lgkmcnt(3)
  v_mfma_f32_16x16x32_bf16 v[100:103], a[120:123], v[172:175], v[100:103]
  ds_read_b128 v[188:191], v16 offset:30720
  v_mfma_f32_16x16x32_bf16 v[104:107], a[124:127], v[172:175], v[104:107]
  v_mfma_f32_16x16x32_bf16 v[108:111], a[128:131], v[172:175], v[108:111]
  s_waitcnt lgkmcnt(3)
  v_mfma_f32_16x16x32_bf16 v[112:115], a[120:123], v[176:179], v[112:115]
  ds_read_b128 v[160:163], v17 offset:16384
  v_mfma_f32_16x16x32_bf16 v[116:119], a[124:127], v[176:179], v[116:119]
  s_add_u32 m0, s31, 17408
  v_mfma_f32_16x16x32_bf16 v[120:123], a[128:131], v[176:179], v[120:123]
  s_waitcnt lgkmcnt(3)
  buffer_load_dwordx4 v11, s[8:11], s30 offen lds
  v_mfma_f32_16x16x32_bf16 v[124:127], a[120:123], v[180:183], v[124:127]
  ds_read_b128 v[164:167], v17 offset:18432
  v_mfma_f32_16x16x32_bf16 v[128:131], a[124:127], v[180:183], v[128:131]
  v_mfma_f32_16x16x32_bf16 v[132:135], a[128:131], v[180:183], v[132:135]
  s_waitcnt lgkmcnt(3)
  v_mfma_f32_16x16x32_bf16 v[136:139], a[120:123], v[184:187], v[136:139]
  ds_read_b128 v[168:171], v17 offset:20480
  v_mfma_f32_16x16x32_bf16 v[140:143], a[124:127], v[184:187], v[140:143]
  v_mfma_f32_16x16x32_bf16 v[144:147], a[128:131], v[184:187], v[144:147]
  s_waitcnt lgkmcnt(3)
  v_mfma_f32_16x16x32_bf16 v[148:151], a[120:123], v[188:191], v[148:151]
  ds_read_b128 v[172:175], v17 offset:22528
  v_mfma_f32_16x16x32_bf16 v[152:155], a[124:127], v[188:191], v[152:155]
  v_mfma_f32_16x16x32_bf16 v[156:159], a[128:131], v[188:191], v[156:159]
  s_waitcnt lgkmcnt(3)
  v_mfma_f32_16x16x32_bf16 v[64:67], a[132:135], v[160:163], v[64:67]
  ds_read_b128 v[176:179], v17 offset:24576
  v_mfma_f32_16x16x32_bf16 v[68:71], a[136:139], v[160:163], v[68:71]
  s_add_u32 m0, s31, 18432
  v_mfma_f32_16x16x32_bf16 v[72:75], a[140:143], v[160:163], v[72:75]
  s_waitcnt lgkmcnt(3)
  buffer_load_dwordx4 v12, s[8:11], s30 offen lds
  v_mfma_f32_16x16x32_bf16 v[76:79], a[132:135], v[164:167], v[76:79]
  ds_read_b128 v[180:183], v17 offset:26624
  v_mfma_f32_16x16x32_bf16 v[80:83], a[136:139], v[164:167], v[80:83]
  v_mfma_f32_16x16x32_bf16 v[84:87], a[140:143], v[164:167], v[84:87]
  s_waitcnt lgkmcnt(3)
  v_mfma_f32_16x16x32_bf16 v[88:91], a[132:135], v[168:171], v[88:91]
  ds_read_b128 v[184:187], v17 offset:28672
  v_mfma_f32_16x16x32_bf16 v[92:95], a[136:139], v[168:171], v[92:95]
  v_mfma_f32_16x16x32_bf16 v[96:99], a[140:143], v[168:171], v[96:99]
  s_waitcnt lgkmcnt(3)
  v_mfma_f32_16x16x32_bf16 v[100:103], a[132:135], v[172:175], v[100:103]
  ds_read_b128 v[188:191], v17 offset:30720
  v_mfma_f32_16x16x32_bf16 v[104:107], a[136:139], v[172:175], v[104:107]
  v_mfma_f32_16x16x32_bf16 v[108:111], a[140:143], v[172:175], v[108:111]
  s_waitcnt lgkmcnt(3)
  v_mfma_f32_16x16x32_bf16 v[112:115], a[132:135], v[176:179], v[112:115]
  s_waitcnt vmcnt(23)
  s_barrier
  ds_read_b128 v[160:163], v16 offset:32768
  v_mfma_f32_16x16x32_bf16 v[116:119], a[136:139], v[176:179], v[116:119]
  s_add_u32 m0, s31, 19456
  v_mfma_f32_16x16x32_bf16 v[120:123], a[140:143], v[176:179], v[120:123]
  s_waitcnt lgkmcnt(3)
  buffer_load_dwordx4 v13, s[8:11], s30 offen lds
  v_mfma_f32_16x16x32_bf16 v[124:127], a[132:135], v[180:183], v[124:127]
  s_add_u32 s30, s30, 128
  ds_read_b128 v[164:167], v16 offset:34816
  v_mfma_f32_16x16x32_bf16 v[128:131], a[136:139], v[180:183], v[128:131]
  v_mfma_f32_16x16x32_bf16 v[132:135], a[140:143], v[180:183], v[132:135]
  s_waitcnt lgkmcnt(3)
  v_mfma_f32_16x16x32_bf16 v[136:139], a[132:135], v[184:187], v[136:139]
  ds_read_b128 v[168:171], v16 offset:36864
  v_mfma_f32_16x16x32_bf16 v[140:143], a[136:139], v[184:187], v[140:143]
  v_mfma_f32_16x16x32_bf16 v[144:147], a[140:143], v[184:187], v[144:147]
  s_waitcnt lgkmcnt(3)
  v_mfma_f32_16x16x32_bf16 v[148:151], a[132:135], v[188:191], v[148:151]
  ds_read_b128 v[172:175], v16 offset:38912
  v_mfma_f32_16x16x32_bf16 v[152:155], a[136:139], v[188:191], v[152:155]
  v_mfma_f32_16x16x32_bf16 v[156:159], a[140:143], v[188:191], v[156:159]
  s_waitcnt lgkmcnt(3)
  v_mfma_f32_16x16x32_bf16 v[64:67], a[144:147], v[160:163], v[64:67]
  ds_read_b128 v[176:179], v16 offset:40960
  v_mfma_f32_16x16x32_bf16 v[68:71], a[148:151], v[160:163], v[68:71]
  s_add_u32 m0, s31, 32768
  v_mfma_f32_16x16x32_bf16 v[72:75], a[152:155], v[160:163], v[72:75]
  s_waitcnt lgkmcnt(3)
  buffer_load_dwordx4 v10, s[8:11], s30 offen lds
  v_mfma_f32_16x16x32_bf16 v[76:79], a[144:147], v[164:167], v[76:79]
  ds_read_b128 v[180:183], v16 offset:43008
  v_mfma_f32_16x16x32_bf16 v[80:83], a[148:151], v[164:167], v[80:83]
  v_mfma_f32_16x16x32_bf16 v[84:87], a[152:155], v[164:167], v[84:87]
  s_waitcnt lgkmcnt(3)
  v_mfma_f32_16x16x32_bf16 v[88:91], a[144:147], v[168:171], v[88:91]
  ds_read_b128 v[184:187], v16 offset:45056
  v_mfma_f32_16x16x32_bf16 v[92:95], a[148:151], v[168:171], v[92:95]
  v_mfma_f32_16x16x32_bf16 v[96:99], a[152:155], v[168:171], v[96:99]
  s_waitcnt lgkmcnt(3)
  v_mfma_f32_16x16x32_bf16 v[100:103], a[144:147], v[172:175], v[100:103]
  ds_read_b128 v[188:191], v16 offset:47104
  v_mfma_f32_16x16x32_bf16 v[104:107], a[148:151], v[172:175], v[104:107]
  v_mfma_f32_16x16x32_bf16 v[108:111], a[152:155], v[172:175], v[108:111]
  s_waitcnt lgkmcnt(3)
  v_mfma_f32_16x16x32_bf16 v[112:115], a[144:147], v[176:179], v[112:115]
  ds_read_b128 v[160:163], v17 offset:32768
  v_mfma_f32_16x16x32_bf16 v[116:119], a[148:151], v[176:179], v[116:119]
  s_add_u32 m0, s31, 33792
  v_mfma_f32_16x16x32_bf16 v[120:123], a[152:155], v[176:179], v[120:123]
  s_waitcnt lgkmcnt(3)
  buffer_load_dwordx4 v11, s[8:11], s30 offen lds
  v_mfma_f32_16x16x32_bf16 v[124:127], a[144:147], v[180:183], v[124:127]
  ds_read_b128 v[164:167], v17 offset:34816
  v_mfma_f32_16x16x32_bf16 v[128:131], a[148:151], v[180:183], v[128:131]
  v_mfma_f32_16x16x32_bf16 v[132:135], a[152:155], v[180:183], v[132:135]
  s_waitcnt lgkmcnt(3)
  v_mfma_f32_16x16x32_bf16 v[136:139], a[144:147], v[184:187], v[136:139]
  ds_read_b128 v[168:171], v17 offset:36864
  v_mfma_f32_16x16x32_bf16 v[140:143], a[148:151], v[184:187], v[140:143]
  v_mfma_f32_16x16x32_bf16 v[144:147], a[152:155], v[184:187], v[144:147]
  s_waitcnt lgkmcnt(3)
  v_mfma_f32_16x16x32_bf16 v[148:151], a[144:147], v[188:191], v[148:151]
  ds_read_b128 v[172:175], v17 offset:38912
  v_mfma_f32_16x16x32_bf16 v[152:155], a[148:151], v[188:191], v[152:155]
  v_mfma_f32_16x16x32_bf16 v[156:159], a[152:155], v[188:191], v[156:159]
  s_waitcnt lgkmcnt(3)
  v_mfma_f32_16x16x32_bf16 v[64:67], a[156:159], v[160:163], v[64:67]
  ds_read_b128 v[176:179], v17 offset:40960
  v_mfma_f32_16x16x32_bf16 v[68:71], a[160:163], v[160:163], v[68:71]
  s_add_u32 m0, s31, 34816
  v_mfma_f32_16x16x32_bf16 v[72:75], a[164:167], v[160:163], v[72:75]
  s_waitcnt lgkmcnt(3)
  buffer_load_dwordx4 v12, s[8:11], s30 offen lds
  v_mfma_f32_16x16x32_bf16 v[76:79], a[156:159], v[164:167], v[76:79]
  ds_read_b128 v[180:183], v17 offset:43008
  v_mfma_f32_16x16x32_bf16 v[80:83], a[160:163], v[164:167], v[80:83]
  v_mfma_f32_16x16x32_bf16 v[84:87], a[164:167], v[164:167], v[84:87]
  s_waitcnt lgkmcnt(3)
  v_mfma_f32_16x16x32_bf16 v[88:91], a[156:159], v[168:171], v[88:91]
  ds_read_b128 v[184:187], v17 offset:45056
  v_mfma_f32_16x16x32_bf16 v[92:95], a[160:163], v[168:171], v[92:95]
  v_mfma_f32_16x16x32_bf16 v[96:99], a[164:167], v[168:171], v[96:99]
  s_waitcnt lgkmcnt(3)
  v_mfma_f32_16x16x32_bf16 v[100:103], a[156:159], v[172:175], v[100:103]
  ds_read_b128 v[188:191], v17 offset:47104
  v_mfma_f32_16x16x32_bf16 v[104:107], a[160:163], v[172:175], v[104:107]
  v_mfma_f32_16x16x32_bf16 v[108:111], a[164:167], v[172:175], v[108:111]
  s_waitcnt lgkmcnt(3)
  v_mfma_f32_16x16x32_bf16 v[112:115], a[156:159], v[176:179], v[112:115]
  ds_read_b128 v[160:163], v16 offset:49152
  v_mfma_f32_16x16x32_bf16 v[116:119], a[160:163], v[176:179], v[116:119]
  s_add_u32 m0, s31, 35840
  v_mfma_f32_16x16x32_bf16 v[120:123], a[164:167], v[176:179], v[120:123]
  s_waitcnt lgkmcnt(3)
  buffer_load_dwordx4 v13, s[8:11], s30 offen lds
  v_mfma_f32_16x16x32_bf16 v[124:127], a[156:159], v[180:183], v[124:127]
  s_add_u32 s30, s30, 128
  ds_read_b128 v[164:167], v16 offset:51200
  v_mfma_f32_16x16x32_bf16 v[128:131], a[160:163], v[180:183], v[128:131]
  v_mfma_f32_16x16x32_bf16 v[132:135], a[164:167], v[180:183], v[132:135]
  s_waitcnt lgkmcnt(3)
  v_mfma_f32_16x16x32_bf16 v[136:139], a[156:159], v[184:187], v[136:139]
  ds_read_b128 v[168:171], v16 offset:53248
  v_mfma_f32_16x16x32_bf16 v[140:143], a[160:163], v[184:187], v[140:143]
  v_mfma_f32_16x16x32_bf16 v[144:147], a[164:167], v[184:187], v[144:147]
  s_waitcnt lgkmcnt(3)
  v_mfma_f32_16x16x32_bf16 v[148:151], a[156:159], v[188:191], v[148:151]
  ds_read_b128 v[172:175], v16 offset:55296
  v_mfma_f32_16x16x32_bf16 v[152:155], a[160:163], v[188:191], v[152:155]
  v_mfma_f32_16x16x32_bf16 v[156:159], a[164:167], v[188:191], v[156:159]
  s_waitcnt lgkmcnt(3)
  v_mfma_f32_16x16x32_bf16 v[64:67], a[168:171], v[160:163], v[64:67]
  ds_read_b128 v[176:179], v16 offset:57344
  v_mfma_f32_16x16x32_bf16 v[68:71], a[172:175], v[160:163], v[68:71]
  s_add_u32 m0, s31, 49152
  v_mfma_f32_16x16x32_bf16 v[72:75], a[176:179], v[160:163], v[72:75]
  s_waitcnt lgkmcnt(3)
  buffer_load_dwordx4 v10, s[8:11], s30 offen lds
  v_mfma_f32_16x16x32_bf16 v[76:79], a[168:171], v[164:167], v[76:79]
  ds_read_b128 v[180:183], v16 offset:59392
  v_mfma_f32_16x16x32_bf16 v[80:83], a[172:175], v[164:167], v[80:83]
  v_mfma_f32_16x16x32_bf16 v[84:87], a[176:179], v[164:167], v[84:87]
  s_waitcnt lgkmcnt(3)
  v_mfma_f32_16x16x32_bf16 v[88:91], a[168:171], v[168:171], v[88:91]
  ds_read_b128 v[184:187], v16 offset:61440
  v_mfma_f32_16x16x32_bf16 v[92:95], a[172:175], v[168:171], v[92:95]
  v_mfma_f32_16x16x32_bf16 v[96:99], a[176:179], v[168:171], v[96:99]
  s_waitcnt lgkmcnt(3)
  v_mfma_f32_16x16x32_bf16 v[100:103], a[168:171], v[172:175], v[100:103]
  ds_read_b128 v[188:191], v16 offset:63488
  v_mfma_f32_16x16x32_bf16 v[104:107], a[172:175], v[172:175], v[104:107]
  v_mfma_f32_16x16x32_bf16 v[108:111], a[176:179], v[172:175], v[108:111]
  s_waitcnt lgkmcnt(3)
  v_mfma_f32_16x16x32_bf16 v[112:115], a[168:171], v[176:179], v[112:115]
  ds_read_b128 v[160:163], v17 offset:49152
  v_mfma_f32_16x16x32_bf16 v[116:119], a[172:175], v[176:179], v[116:119]
  s_add_u32 m0, s31, 50176
  v_mfma_f32_16x16x32_bf16 v[120:123], a[176:179], v[176:179], v[120:123]
  s_waitcnt lgkmcnt(3)
  buffer_load_dwordx4 v11, s[8:11], s30 offen lds
  v_mfma_f32_16x16x32_bf16 v[124:127], a[168:171], v[180:183], v[124:127]
  ds_read_b128 v[164:167], v17 offset:51200
  v_mfma_f32_16x16x32_bf16 v[128:131], a[172:175], v[180:183], v[128:131]
  v_mfma_f32_16x16x32_bf16 v[132:135], a[176:179], v[180:183], v[132:135]
  s_waitcnt lgkmcnt(3)
  v_mfma_f32_16x16x32_bf16 v[136:139], a[168:171], v[184:187], v[136:139]
  ds_read_b128 v[168:171], v17 offset:53248
  v_mfma_f32_16x16x32_bf16 v[140:143], a[172:175], v[184:187], v[140:143]
  v_mfma_f32_16x16x32_bf16 v[144:147], a[176:179], v[184:187], v[144:147]
  s_waitcnt lgkmcnt(3)
  v_mfma_f32_16x16x32_bf16 v[148:151], a[168:171], v[188:191], v[148:151]
  ds_read_b128 v[172:175], v17 offset:55296
  v_mfma_f32_16x16x32_bf16 v[152:155], a[172:175], v[188:191], v[152:155]
  v_mfma_f32_16x16x32_bf16 v[156:159], a[176:179], v[188:191], v[156:159]
  s_waitcnt lgkmcnt(3)
  v_mfma_f32_16x16x32_bf16 v[64:67], a[180:183], v[160:163], v[64:67]
  ds_read_b128 v[176:179], v17 offset:57344
  v_mfma_f32_16x16x32_bf16 v[68:71], a[184:187], v[160:163], v[68:71]
  s_add_u32 m0, s31, 51200
  v_mfma_f32_16x16x32_bf16 v[72:75], a[188:191], v[160:163], v[72:75]
  s_waitcnt lgkmcnt(3)
  buffer_load_dwordx4 v12, s[8:11], s30 offen lds
  v_mfma_f32_16x16x32_bf16 v[76:79], a[180:183], v[164:167], v[76:79]
  ds_read_b128 v[180:183], v17 offset:59392
  v_mfma_f32_16x16x32_bf16 v[80:83], a[184:187], v[164:167], v[80:83]
  v_mfma_f32_16x16x32_bf16 v[84:87], a[188:191], v[164:167], v[84:87]
  s_waitcnt lgkmcnt(3)
  v_mfma_f32_16x16x32_bf16 v[88:91], a[180:183], v[168:171], v[88:91]
  ds_read_b128 v[184:187], v17 offset:61440
  v_mfma_f32_16x16x32_bf16 v[92:95], a[184:187], v[168:171], v[92:95]
  v_mfma_f32_16x16x32_bf16 v[96:99], a[188:191], v[168:171], v[96:99]
  s_waitcnt lgkmcnt(3)
  v_mfma_f32_16x16x32_bf16 v[100:103], a[180:183], v[172:175], v[100:103]
  ds_read_b128 v[188:191], v17 offset:63488
  v_mfma_f32_16x16x32_bf16 v[104:107], a[184:187], v[172:175], v[104:107]
  v_mfma_f32_16x16x32_bf16 v[108:111], a[188:191], v[172:175], v[108:111]
  s_waitcnt lgkmcnt(3)
  v_mfma_f32_16x16x32_bf16 v[112:115], a[180:183], v[176:179], v[112:115]
  s_waitcnt vmcnt(16)
  s_barrier
  ds_read_b128 v[160:163], v18 offset:0
  v_mfma_f32_16x16x32_bf16 v[116:119], a[184:187], v[176:179], v[116:119]
  s_add_u32 m0, s31, 52224
  v_mfma_f32_16x16x32_bf16 v[120:123], a[188:191], v[176:179], v[120:123]
  s_waitcnt lgkmcnt(3)
  buffer_load_dwordx4 v13, s[8:11], s30 offen lds
  v_mfma_f32_16x16x32_bf16 v[124:127], a[180:183], v[180:183], v[124:127]
  s_add_u32 s30, s30, 128
  ds_read_b128 v[164:167], v18 offset:2048
  v_mfma_f32_16x16x32_bf16 v[128:131], a[184:187], v[180:183], v[128:131]
  v_mfma_f32_16x16x32_bf16 v[132:135], a[188:191], v[180:183], v[132:135]
  s_waitcnt lgkmcnt(3)
  v_mfma_f32_16x16x32_bf16 v[136:139], a[180:183], v[184:187], v[136:139]
  ds_read_b128 v[168:171], v18 offset:4096
  v_mfma_f32_16x16x32_bf16 v[140:143], a[184:187], v[184:187], v[140:143]
  buffer_atomic_add v28, v27, s[72:75], s61 offen sc1
  v_mfma_f32_16x16x32_bf16 v[144:147], a[188:191], v[184:187], v[144:147]
  s_waitcnt lgkmcnt(3)
  s_mov_b32 s48, s27
  s_add_u32 s27, s27, 8388608
  v_mfma_f32_16x16x32_bf16 v[148:151], a[180:183], v[188:191], v[148:151]
  s_mov_b32 s61, s60
  ds_read_b128 v[172:175], v18 offset:6144
  s_add_u32 s60, s60, 4
  v_mfma_f32_16x16x32_bf16 v[152:155], a[184:187], v[188:191], v[152:155]
  v_mfma_f32_16x16x32_bf16 v[156:159], a[188:191], v[188:191], v[156:159]
  s_waitcnt lgkmcnt(3)
  v_mfma_f32_16x16x32_bf16 v[64:67], a[192:195], v[160:163], v[64:67]
  ds_read_b128 v[176:179], v18 offset:8192
  v_mfma_f32_16x16x32_bf16 v[68:71], a[196:199], v[160:163], v[68:71]
  s_add_u32 m0, s31, 65536
  v_mfma_f32_16x16x32_bf16 v[72:75], a[200:203], v[160:163], v[72:75]
  s_waitcnt lgkmcnt(3)
  buffer_load_dwordx4 v10, s[8:11], s30 offen lds
  v_mfma_f32_16x16x32_bf16 v[76:79], a[192:195], v[164:167], v[76:79]
  ds_read_b128 v[180:183], v18 offset:10240
  v_mfma_f32_16x16x32_bf16 v[80:83], a[196:199], v[164:167], v[80:83]
  v_mfma_f32_16x16x32_bf16 v[84:87], a[200:203], v[164:167], v[84:87]
  s_waitcnt lgkmcnt(3)
  v_mfma_f32_16x16x32_bf16 v[88:91], a[192:195], v[168:171], v[88:91]
  ds_read_b128 v[184:187], v18 offset:12288
  v_mfma_f32_16x16x32_bf16 v[92:95], a[196:199], v[168:171], v[92:95]
  v_mfma_f32_16x16x32_bf16 v[96:99], a[200:203], v[168:171], v[96:99]
  s_waitcnt lgkmcnt(3)
  v_mfma_f32_16x16x32_bf16 v[100:103], a[192:195], v[172:175], v[100:103]
  ds_read_b128 v[188:191], v18 offset:14336
  v_mfma_f32_16x16x32_bf16 v[104:107], a[196:199], v[172:175], v[104:107]
  v_mfma_f32_16x16x32_bf16 v[108:111], a[200:203], v[172:175], v[108:111]
  s_waitcnt lgkmcnt(3)
  v_mfma_f32_16x16x32_bf16 v[112:115], a[192:195], v[176:179], v[112:115]
  ds_read_b128 v[160:163], v19 offset:0
  v_mfma_f32_16x16x32_bf16 v[116:119], a[196:199], v[176:179], v[116:119]
  s_add_u32 m0, s31, 66560
  v_mfma_f32_16x16x32_bf16 v[120:123], a[200:203], v[176:179], v[120:123]
  s_waitcnt lgkmcnt(3)
  buffer_load_dwordx4 v11, s[8:11], s30 offen lds
  v_mfma_f32_16x16x32_bf16 v[124:127], a[192:195], v[180:183], v[124:127]
  ds_read_b128 v[164:167], v19 offset:2048
  v_mfma_f32_16x16x32_bf16 v[128:131], a[196:199], v[180:183], v[128:131]
  v_mfma_f32_16x16x32_bf16 v[132:135], a[200:203], v[180:183], v[132:135]
  s_waitcnt lgkmcnt(3)
  v_mfma_f32_16x16x32_bf16 v[136:139], a[192:195], v[184:187], v[136:139]
  ds_read_b128 v[168:171], v19 offset:4096
  v_mfma_f32_16x16x32_bf16 v[140:143], a[196:199], v[184:187], v[140:143]
  v_mfma_f32_16x16x32_bf16 v[144:147], a[200:203], v[184:187], v[144:147]
  s_waitcnt lgkmcnt(3)
  v_mfma_f32_16x16x32_bf16 v[148:151], a[192:195], v[188:191], v[148:151]
  ds_read_b128 v[172:175], v19 offset:6144
  v_mfma_f32_16x16x32_bf16 v[152:155], a[196:199], v[188:191], v[152:155]
  v_mfma_f32_16x16x32_bf16 v[156:159], a[200:203], v[188:191], v[156:159]
  s_waitcnt lgkmcnt(3)
  v_mfma_f32_16x16x32_bf16 v[64:67], a[204:207], v[160:163], v[64:67]
  ds_read_b128 v[176:179], v19 offset:8192
  v_mfma_f32_16x16x32_bf16 v[68:71], a[208:211], v[160:163], v[68:71]
  s_add_u32 m0, s31, 67584
  v_mfma_f32_16x16x32_bf16 v[72:75], a[212:215], v[160:163], v[72:75]
  s_waitcnt lgkmcnt(3)
  buffer_load_dwordx4 v12, s[8:11], s30 offen lds
  v_mfma_f32_16x16x32_bf16 v[76:79], a[204:207], v[164:167], v[76:79]
  ds_read_b128 v[180:183], v19 offset:10240
  v_mfma_f32_16x16x32_bf16 v[80:83], a[208:211], v[164:167], v[80:83]
  v_mfma_f32_16x16x32_bf16 v[84:87], a[212:215], v[164:167], v[84:87]
  s_waitcnt lgkmcnt(3)
  v_mfma_f32_16x16x32_bf16 v[88:91], a[204:207], v[168:171], v[88:91]
  ds_read_b128 v[184:187], v19 offset:12288
  v_mfma_f32_16x16x32_bf16 v[92:95], a[208:211], v[168:171], v[92:95]
  v_mfma_f32_16x16x32_bf16 v[96:99], a[212:215], v[168:171], v[96:99]
  s_waitcnt lgkmcnt(3)
  v_mfma_f32_16x16x32_bf16 v[100:103], a[204:207], v[172:175], v[100:103]
  ds_read_b128 v[188:191], v19 offset:14336
  v_mfma_f32_16x16x32_bf16 v[104:107], a[208:211], v[172:175], v[104:107]
  v_mfma_f32_16x16x32_bf16 v[108:111], a[212:215], v[172:175], v[108:111]
  s_waitcnt lgkmcnt(3)
  v_mfma_f32_16x16x32_bf16 v[112:115], a[204:207], v[176:179], v[112:115]
  ds_read_b128 v[160:163], v18 offset:16384
  v_mfma_f32_16x16x32_bf16 v[116:119], a[208:211], v[176:179], v[116:119]
  s_add_u32 m0, s31, 68608
  v_mfma_f32_16x16x32_bf16 v[120:123], a[212:215], v[176:179], v[120:123]
  s_waitcnt lgkmcnt(3)
  buffer_load_dwordx4 v13, s[8:11], s30 offen lds
  v_mfma_f32_16x16x32_bf16 v[124:127], a[204:207], v[180:183], v[124:127]
  s_add_u32 s30, s30, 128
  ds_read_b128 v[164:167], v18 offset:18432
  v_mfma_f32_16x16x32_bf16 v[128:131], a[208:211], v[180:183], v[128:131]
  v_mfma_f32_16x16x32_bf16 v[132:135], a[212:215], v[180:183], v[132:135]
  s_waitcnt lgkmcnt(3)
  v_mfma_f32_16x16x32_bf16 v[136:139], a[204:207], v[184:187], v[136:139]
  ds_read_b128 v[168:171], v18 offset:20480
  v_mfma_f32_16x16x32_bf16 v[140:143], a[208:211], v[184:187], v[140:143]
  v_mfma_f32_16x16x32_bf16 v[144:147], a[212:215], v[184:187], v[144:147]
  s_waitcnt lgkmcnt(3)
  v_mfma_f32_16x16x32_bf16 v[148:151], a[204:207], v[188:191], v[148:151]
  ds_read_b128 v[172:175], v18 offset:22528
  v_mfma_f32_16x16x32_bf16 v[152:155], a[208:211], v[188:191], v[152:155]
  v_mfma_f32_16x16x32_bf16 v[156:159], a[212:215], v[188:191], v[156:159]
  s_waitcnt lgkmcnt(3)
  v_mfma_f32_16x16x32_bf16 v[64:67], a[216:219], v[160:163], v[64:67]
  ds_read_b128 v[176:179], v18 offset:24576
  v_mfma_f32_16x16x32_bf16 v[68:71], a[220:223], v[160:163], v[68:71]
  s_add_u32 m0, s31, 81920
  v_mfma_f32_16x16x32_bf16 v[72:75], a[224:227], v[160:163], v[72:75]
  s_waitcnt lgkmcnt(3)
  buffer_load_dwordx4 v10, s[8:11], s30 offen lds
  v_mfma_f32_16x16x32_bf16 v[76:79], a[216:219], v[164:167], v[76:79]
  ds_read_b128 v[180:183], v18 offset:26624
  v_mfma_f32_16x16x32_bf16 v[80:83], a[220:223], v[164:167], v[80:83]
  v_mfma_f32_16x16x32_bf16 v[84:87], a[224:227], v[164:167], v[84:87]
  s_waitcnt lgkmcnt(3)
  v_mfma_f32_16x16x32_bf16 v[88:91], a[216:219], v[168:171], v[88:91]
  ds_read_b128 v[184:187], v18 offset:28672
  v_mfma_f32_16x16x32_bf16 v[92:95], a[220:223], v[168:171], v[92:95]
  s_add_u32 m0, s31, 82944
  v_mfma_f32_16x16x32_bf16 v[96:99], a[224:227], v[168:171], v[96:99]
  s_waitcnt lgkmcnt(3)
  buffer_load_dwordx4 v11, s[8:11], s30 offen lds
  v_mfma_f32_16x16x32_bf16 v[100:103], a[216:219], v[172:175], v[100:103]
  ds_read_b128 v[188:191], v18 offset:30720
  v_mfma_f32_16x16x32_bf16 v[104:107], a[220:223], v[172:175], v[104:107]
  v_mfma_f32_16x16x32_bf16 v[108:111], a[224:227], v[172:175], v[108:111]
  s_waitcnt lgkmcnt(3)
  v_mfma_f32_16x16x32_bf16 v[112:115], a[216:219], v[176:179], v[112:115]
  ds_read_b128 v[160:163], v19 offset:16384
  v_mfma_f32_16x16x32_bf16 v[116:119], a[220:223], v[176:179], v[116:119]
  s_add_u32 m0, s31, 83968
  v_mfma_f32_16x16x32_bf16 v[120:123], a[224:227], v[176:179], v[120:123]
  s_waitcnt lgkmcnt(3)
  buffer_load_dwordx4 v12, s[8:11], s30 offen lds
  v_mfma_f32_16x16x32_bf16 v[124:127], a[216:219], v[180:183], v[124:127]
  ds_read_b128 v[164:167], v19 offset:18432
  v_mfma_f32_16x16x32_bf16 v[128:131], a[220:223], v[180:183], v[128:131]
  v_mfma_f32_16x16x32_bf16 v[132:135], a[224:227], v[180:183], v[132:135]
  s_waitcnt lgkmcnt(3)
  v_mfma_f32_16x16x32_bf16 v[136:139], a[216:219], v[184:187], v[136:139]
  ds_read_b128 v[168:171], v19 offset:20480
  v_mfma_f32_16x16x32_bf16 v[140:143], a[220:223], v[184:187], v[140:143]
  s_add_u32 m0, s31, 84992
  v_mfma_f32_16x16x32_bf16 v[144:147], a[224:227], v[184:187], v[144:147]
  s_waitcnt lgkmcnt(3)
  buffer_load_dwordx4 v13, s[8:11], s30 offen lds
  v_mfma_f32_16x16x32_bf16 v[148:151], a[216:219], v[188:191], v[148:151]
  s_add_u32 s30, s30, 128
  ds_read_b128 v[172:175], v19 offset:22528
  v_mfma_f32_16x16x32_bf16 v[152:155], a[220:223], v[188:191], v[152:155]
  v_mfma_f32_16x16x32_bf16 v[156:159], a[224:227], v[188:191], v[156:159]
  s_waitcnt lgkmcnt(3)
  v_mfma_f32_16x16x32_bf16 v[64:67], a[228:231], v[160:163], v[64:67]
  ds_read_b128 v[176:179], v19 offset:24576
  v_mfma_f32_16x16x32_bf16 v[68:71], a[232:235], v[160:163], v[68:71]
  v_mfma_f32_16x16x32_bf16 v[72:75], a[236:239], v[160:163], v[72:75]
  s_waitcnt lgkmcnt(3)
  v_mfma_f32_16x16x32_bf16 v[76:79], a[228:231], v[164:167], v[76:79]
  ds_read_b128 v[180:183], v19 offset:26624
  v_cvt_pk_bf16_f32 v192, v64, v65
  v_mfma_f32_16x16x32_bf16 v[80:83], a[232:235], v[164:167], v[80:83]
  v_cvt_pk_bf16_f32 v193, v66, v67
  v_cvt_pk_bf16_f32 v194, v68, v69
  v_mfma_f32_16x16x32_bf16 v[84:87], a[236:239], v[164:167], v[84:87]
  s_waitcnt lgkmcnt(3)
  v_cvt_pk_bf16_f32 v195, v70, v71
  v_cvt_pk_bf16_f32 v200, v72, v73
  v_mfma_f32_16x16x32_bf16 v[88:91], a[228:231], v[168:171], v[88:91]
  ds_read_b128 v[184:187], v19 offset:28672
  v_cvt_pk_bf16_f32 v201, v74, v75
  v_mfma_f32_16x16x32_bf16 v[92:95], a[232:235], v[168:171], v[92:95]
  v_cvt_pk_bf16_f32 v196, v76, v77
  v_cvt_pk_bf16_f32 v197, v78, v79
  v_mfma_f32_16x16x32_bf16 v[96:99], a[236:239], v[168:171], v[96:99]
  s_waitcnt lgkmcnt(3)
  v_cvt_pk_bf16_f32 v198, v80, v81
  v_cvt_pk_bf16_f32 v199, v82, v83
  v_mfma_f32_16x16x32_bf16 v[100:103], a[228:231], v[172:175], v[100:103]
  ds_read_b128 v[188:191], v19 offset:30720
  v_cvt_pk_bf16_f32 v202, v84, v85
  v_mfma_f32_16x16x32_bf16 v[104:107], a[232:235], v[172:175], v[104:107]
  v_cvt_pk_bf16_f32 v203, v86, v87
  v_cvt_pk_bf16_f32 v204, v88, v89
  v_mfma_f32_16x16x32_bf16 v[108:111], a[236:239], v[172:175], v[108:111]
  s_waitcnt lgkmcnt(3)
  v_cvt_pk_bf16_f32 v205, v90, v91
  v_cvt_pk_bf16_f32 v206, v92, v93
  v_mfma_f32_16x16x32_bf16 v[112:115], a[228:231], v[176:179], v[112:115]
  s_waitcnt vmcnt(17)
  s_barrier
  ds_read_b128 v[160:163], v14 offset:0
  v_mfma_f32_16x16x32_bf16 v[116:119], a[232:235], v[176:179], v[116:119]
  v_cvt_pk_bf16_f32 v207, v94, v95
  v_cvt_pk_bf16_f32 v212, v96, v97
  v_mfma_f32_16x16x32_bf16 v[120:123], a[236:239], v[176:179], v[120:123]
  s_waitcnt lgkmcnt(3)
  v_cvt_pk_bf16_f32 v213, v98, v99
  v_cvt_pk_bf16_f32 v208, v100, v101
  v_mfma_f32_16x16x32_bf16 v[124:127], a[228:231], v[180:183], v[124:127]
  ds_read_b128 v[164:167], v14 offset:2048
  v_cvt_pk_bf16_f32 v209, v102, v103
  v_mfma_f32_16x16x32_bf16 v[128:131], a[232:235], v[180:183], v[128:131]
  v_cvt_pk_bf16_f32 v210, v104, v105
  v_cvt_pk_bf16_f32 v211, v106, v107
  v_mfma_f32_16x16x32_bf16 v[132:135], a[236:239], v[180:183], v[132:135]
  s_waitcnt lgkmcnt(3)
  v_cvt_pk_bf16_f32 v214, v108, v109
  v_cvt_pk_bf16_f32 v215, v110, v111
  v_mfma_f32_16x16x32_bf16 v[136:139], a[228:231], v[184:187], v[136:139]
  ds_read_b128 v[168:171], v14 offset:4096
  v_cvt_pk_bf16_f32 v216, v112, v113
  v_mfma_f32_16x16x32_bf16 v[140:143], a[232:235], v[184:187], v[140:143]
  v_cvt_pk_bf16_f32 v217, v114, v115
  v_cvt_pk_bf16_f32 v218, v116, v117
  v_mfma_f32_16x16x32_bf16 v[144:147], a[236:239], v[184:187], v[144:147]
  s_waitcnt lgkmcnt(3)
  v_cvt_pk_bf16_f32 v219, v118, v119
  v_cvt_pk_bf16_f32 v224, v120, v121
  v_mfma_f32_16x16x32_bf16 v[148:151], a[228:231], v[188:191], v[148:151]
  ds_read_b128 v[172:175], v14 offset:6144
  v_cvt_pk_bf16_f32 v225, v122, v123
  v_mfma_f32_16x16x32_bf16 v[152:155], a[232:235], v[188:191], v[152:155]
  s_sub_u32 s26, s26, 1
  s_cmp_gt_u32 s26, 0
  v_cvt_pk_bf16_f32 v220, v124, v125
  v_mfma_f32_16x16x32_bf16 v[156:159], a[236:239], v[188:191], v[156:159]
  s_waitcnt lgkmcnt(3)
  s_cbranch_scc1 kvs_241
  s_nop 7
  v_cvt_pk_bf16_f32 v221, v126, v127
  v_cvt_pk_bf16_f32 v222, v128, v129
  v_cvt_pk_bf16_f32 v223, v130, v131
  v_cvt_pk_bf16_f32 v226, v132, v133
  v_cvt_pk_bf16_f32 v227, v134, v135
  v_cvt_pk_bf16_f32 v228, v136, v137
  v_cvt_pk_bf16_f32 v229, v138, v139
  v_cvt_pk_bf16_f32 v230, v140, v141
  v_cvt_pk_bf16_f32 v231, v142, v143
  v_cvt_pk_bf16_f32 v236, v144, v145
  v_cvt_pk_bf16_f32 v237, v146, v147
  v_cvt_pk_bf16_f32 v232, v148, v149
  v_cvt_pk_bf16_f32 v233, v150, v151
  v_cvt_pk_bf16_f32 v234, v152, v153
  v_cvt_pk_bf16_f32 v235, v154, v155
  v_cvt_pk_bf16_f32 v238, v156, v157
  v_cvt_pk_bf16_f32 v239, v158, v159
  s_xor_b32 s29, s48, 0
  buffer_store_dwordx4 v[192:195], v26, s[16:19], s29 offen offset:0 sc1
  buffer_store_dwordx4 v[196:199], v26, s[16:19], s29 offen offset:1024 sc1
  buffer_store_dwordx4 v[200:203], v26, s[16:19], s29 offen offset:2048 sc1
  s_xor_b32 s29, s48, 2105344
  buffer_store_dwordx4 v[204:207], v26, s[16:19], s29 offen offset:0 sc1
  buffer_store_dwordx4 v[208:211], v26, s[16:19], s29 offen offset:1024 sc1
  buffer_store_dwordx4 v[212:215], v26, s[16:19], s29 offen offset:2048 sc1
  s_xor_b32 s29, s48, 4194304
  buffer_store_dwordx4 v[216:219], v26, s[16:19], s29 offen offset:0 sc1
  buffer_store_dwordx4 v[220:223], v26, s[16:19], s29 offen offset:1024 sc1
  buffer_store_dwordx4 v[224:227], v26, s[16:19], s29 offen offset:2048 sc1
  s_xor_b32 s29, s48, 6299648
  buffer_store_dwordx4 v[228:231], v26, s[16:19], s29 offen offset:0 sc1
  buffer_store_dwordx4 v[232:235], v26, s[16:19], s29 offen offset:1024 sc1
  buffer_store_dwordx4 v[236:239], v26, s[16:19], s29 offen offset:2048 sc1
  s_waitcnt vmcnt(0) lgkmcnt(0)
  s_barrier
  buffer_atomic_add v28, v27, s[72:75], s61 offen sc1
  s_bitcmp1_b32 s3, 0
  s_cbranch_scc1 queue
  s_lshr_b32 s2, s3, 1
  s_mov_b32 s40, 10
  s_mov_b32 s41, 6
  s_waitcnt vmcnt(0)
  s_barrier
  s_branch q_entry
  s_branch queue
not_kv:
  s_cmp_ge_u32 s3, 96
  s_cbranch_scc1 not_vw
  s_sub_u32 s2, s3, 64
  s_load_dwordx2 s[6:7], s[0:1], 40
  s_load_dwordx2 s[38:39], s[0:1], 104
  v_lshlrev_b32 v4, 4, v1
  s_waitcnt lgkmcnt(0)
  s_mov_b32 s12, s6
  s_mov_b32 s13, s7
  s_mov_b32 s14, 7864320
  s_mov_b32 s15, 0x00020000
  s_mov_b32 s16, s38
  s_mov_b32 s17, s39
  s_mov_b32 s18, 218103808
  s_mov_b32 s19, 0x00020000
  s_add_u32 s72, s38, 173080576
  s_addc_u32 s73, s39, 0
  s_mov_b32 s74, 49152
  s_mov_b32 s75, 0x00020000
  s_mul_i32 s40, s2, 245760
  s_mul_i32 s22, s20, 30720
  s_add_u32 s40, s40, s22
  s_add_u32 m0, s22, 0
  s_add_u32 s21, s40, 0
  buffer_load_dwordx4 v4, s[12:15], s21 offen offset:0 lds
  buffer_load_dwordx4 v4, s[12:15], s21 offen offset:1024 lds
  buffer_load_dwordx4 v4, s[12:15], s21 offen offset:2048 lds
  buffer_load_dwordx4 v4, s[12:15], s21 offen offset:3072 lds
  s_add_u32 m0, s22, 4096
  s_add_u32 s21, s40, 4096
  buffer_load_dwordx4 v4, s[12:15], s21 offen offset:0 lds
  buffer_load_dwordx4 v4, s[12:15], s21 offen offset:1024 lds
  buffer_load_dwordx4 v4, s[12:15], s21 offen offset:2048 lds
  buffer_load_dwordx4 v4, s[12:15], s21 offen offset:3072 lds
  s_add_u32 m0, s22, 8192
  s_add_u32 s21, s40, 8192
  buffer_load_dwordx4 v4, s[12:15], s21 offen offset:0 lds
  buffer_load_dwordx4 v4, s[12:15], s21 offen offset:1024 lds
  buffer_load_dwordx4 v4, s[12:15], s21 offen offset:2048 lds
  buffer_load_dwordx4 v4, s[12:15], s21 offen offset:3072 lds
  s_add_u32 m0, s22, 12288
  s_add_u32 s21, s40, 12288
  buffer_load_dwordx4 v4, s[12:15], s21 offen offset:0 lds
  buffer_load_dwordx4 v4, s[12:15], s21 offen offset:1024 lds
  buffer_load_dwordx4 v4, s[12:15], s21 offen offset:2048 lds
  buffer_load_dwordx4 v4, s[12:15], s21 offen offset:3072 lds
  s_add_u32 m0, s22, 16384
  s_add_u32 s21, s40, 16384
  buffer_load_dwordx4 v4, s[12:15], s21 offen offset:0 lds
  buffer_load_dwordx4 v4, s[12:15], s21 offen offset:1024 lds
  buffer_load_dwordx4 v4, s[12:15], s21 offen offset:2048 lds
  buffer_load_dwordx4 v4, s[12:15], s21 offen offset:3072 lds
  s_add_u32 m0, s22, 20480
  s_add_u32 s21, s40, 20480
  buffer_load_dwordx4 v4, s[12:15], s21 offen offset:0 lds
  buffer_load_dwordx4 v4, s[12:15], s21 offen offset:1024 lds
  buffer_load_dwordx4 v4, s[12:15], s21 offen offset:2048 lds
  buffer_load_dwordx4 v4, s[12:15], s21 offen offset:3072 lds
  s_add_u32 m0, s22, 24576
  s_add_u32 s21, s40, 24576
  buffer_load_dwordx4 v4, s[12:15], s21 offen offset:0 lds
  buffer_load_dwordx4 v4, s[12:15], s21 offen offset:1024 lds
  buffer_load_dwordx4 v4, s[12:15], s21 offen offset:2048 lds
  buffer_load_dwordx4 v4, s[12:15], s21 offen offset:3072 lds
  s_add_u32 m0, s22, 28672
  s_add_u32 s21, s40, 28672
  buffer_load_dwordx4 v4, s[12:15], s21 offen offset:0 lds
  buffer_load_dwordx4 v4, s[12:15], s21 offen offset:1024 lds
  s_add_u32 s21, s40, 122880
  buffer_load_dwordx4 v[64:67], v4, s[12:15], s21 offen offset:0
  buffer_load_dwordx4 v[68:71], v4, s[12:15], s21 offen offset:1024
  buffer_load_dwordx4 v[72:75], v4, s[12:15], s21 offen offset:2048
  buffer_load_dwordx4 v[76:79], v4, s[12:15], s21 offen offset:3072
  s_add_u32 s21, s40, 126976
  buffer_load_dwordx4 v[80:83], v4, s[12:15], s21 offen offset:0
  buffer_load_dwordx4 v[84:87], v4, s[12:15], s21 offen offset:1024
  buffer_load_dwordx4 v[88:91], v4, s[12:15], s21 offen offset:2048
  buffer_load_dwordx4 v[92:95], v4, s[12:15], s21 offen offset:3072
  s_add_u32 s21, s40, 131072
  buffer_load_dwordx4 v[96:99], v4, s[12:15], s21 offen offset:0
  buffer_load_dwordx4 v[100:103], v4, s[12:15], s21 offen offset:1024
  buffer_load_dwordx4 v[104:107], v4, s[12:15], s21 offen offset:2048
  buffer_load_dwordx4 v[108:111], v4, s[12:15], s21 offen offset:3072
  s_add_u32 s21, s40, 135168
  buffer_load_dwordx4 v[112:115], v4, s[12:15], s21 offen offset:0
  buffer_load_dwordx4 v[116:119], v4, s[12:15], s21 offen offset:1024
  buffer_load_dwordx4 v[120:123], v4, s[12:15], s21 offen offset:2048
  buffer_load_dwordx4 v[124:127], v4, s[12:15], s21 offen offset:3072
  s_add_u32 s21, s40, 139264
  buffer_load_dwordx4 v[128:131], v4, s[12:15], s21 offen offset:0
  buffer_load_dwordx4 v[132:135], v4, s[12:15], s21 offen offset:1024
  buffer_load_dwordx4 v[136:139], v4, s[12:15], s21 offen offset:2048
  buffer_load_dwordx4 v[140:143], v4, s[12:15], s21 offen offset:3072
  s_add_u32 s21, s40, 143360
  buffer_load_dwordx4 v[144:147], v4, s[12:15], s21 offen offset:0
  buffer_load_dwordx4 v[148:151], v4, s[12:15], s21 offen offset:1024
  buffer_load_dwordx4 v[152:155], v4, s[12:15], s21 offen offset:2048
  buffer_load_dwordx4 v[156:159], v4, s[12:15], s21 offen offset:3072
  s_add_u32 s21, s40, 147456
  buffer_load_dwordx4 v[160:163], v4, s[12:15], s21 offen offset:0
  buffer_load_dwordx4 v[164:167], v4, s[12:15], s21 offen offset:1024
  buffer_load_dwordx4 v[168:171], v4, s[12:15], s21 offen offset:2048
  buffer_load_dwordx4 v[172:175], v4, s[12:15], s21 offen offset:3072
  s_add_u32 s21, s40, 151552
  buffer_load_dwordx4 v[176:179], v4, s[12:15], s21 offen offset:0
  buffer_load_dwordx4 v[180:183], v4, s[12:15], s21 offen offset:1024
  v_lshrrev_b32 v6, 2, v2
  v_lshl_add_u32 v6, v3, 2, v6
  v_mul_u32_u24 v6, 1280, v6
  v_and_b32 v7, 3, v2
  v_lshlrev_b32 v7, 3, v7
  s_mul_i32 s21, s20, 320
  v_add3_u32 v6, v6, v7, s21
  v_add_u32 v8, v6, v7
  v_add_u32 v7, 61440, v6
  v_add_u32 v9, 61440, v8
  v_add_u32 v5, s22, v4
  s_waitcnt vmcnt(30)
  s_load_dwordx2 s[24:25], s[0:1], 16
  v_lshlrev_b32 v200, 7, v1
  s_lshl_b32 s23, s2, 2
  s_add_u32 s23, s23, s20
  s_mul_i32 s23, s23, 61440
  s_add_u32 s23, s23, 0
  s_waitcnt lgkmcnt(0)
  s_mov_b32 s24, s24
  s_mov_b32 s25, s25
  s_mov_b32 s26, 7864320
  s_mov_b32 s27, 0x00020000
  buffer_load_dword v201, v200, s[24:27], s23 offen
  s_add_u32 s23, s23, 8192
  buffer_load_dword v201, v200, s[24:27], s23 offen
  s_add_u32 s23, s23, 8192
  buffer_load_dword v201, v200, s[24:27], s23 offen
  s_add_u32 s23, s23, 8192
  buffer_load_dword v201, v200, s[24:27], s23 offen
  s_add_u32 s23, s23, 8192
  buffer_load_dword v201, v200, s[24:27], s23 offen
  s_add_u32 s23, s23, 8192
  buffer_load_dword v201, v200, s[24:27], s23 offen
  s_add_u32 s23, s23, 8192
  buffer_load_dword v201, v200, s[24:27], s23 offen
  s_add_u32 s23, s23, 8192
  buffer_load_dword v201, v200, s[24:27], s23 offen
  s_add_u32 s23, s23, 8192
  s_barrier
  ds_read_b64_tr_b16 a[0:1], v8 offset:0
  ds_read_b64_tr_b16 a[2:3], v8 offset:20480
  ds_read_b64_tr_b16 a[24:25], v8 offset:8
  ds_read_b64_tr_b16 a[26:27], v8 offset:20488
  ds_read_b64_tr_b16 a[48:49], v6 offset:64
  ds_read_b64_tr_b16 a[50:51], v6 offset:20544
  ds_read_b64_tr_b16 a[72:73], v8 offset:96
  ds_read_b64_tr_b16 a[74:75], v8 offset:20576
  ds_read_b64_tr_b16 a[96:97], v8 offset:104
  ds_read_b64_tr_b16 a[98:99], v8 offset:20584
  ds_read_b64_tr_b16 a[120:121], v8 offset:160
  ds_read_b64_tr_b16 a[122:123], v8 offset:20640
  ds_read_b64_tr_b16 a[144:145], v8 offset:168
  ds_read_b64_tr_b16 a[146:147], v8 offset:20648
  ds_read_b64_tr_b16 a[168:169], v6 offset:224
  ds_read_b64_tr_b16 a[170:171], v6 offset:20704
  ds_read_b64_tr_b16 a[192:193], v8 offset:256
  ds_read_b64_tr_b16 a[194:195], v8 offset:20736
  ds_read_b64_tr_b16 a[216:217], v8 offset:264
  ds_read_b64_tr_b16 a[218:219], v8 offset:20744
  ds_read_b64_tr_b16 a[4:5], v9 offset:0
  ds_read_b64_tr_b16 a[6:7], v9 offset:20480
  ds_read_b64_tr_b16 a[28:29], v9 offset:8
  ds_read_b64_tr_b16 a[30:31], v9 offset:20488
  ds_read_b64_tr_b16 a[52:53], v7 offset:64
  ds_read_b64_tr_b16 a[54:55], v7 offset:20544
  ds_read_b64_tr_b16 a[76:77], v9 offset:96
  ds_read_b64_tr_b16 a[78:79], v9 offset:20576
  ds_read_b64_tr_b16 a[100:101], v9 offset:104
  ds_read_b64_tr_b16 a[102:103], v9 offset:20584
  ds_read_b64_tr_b16 a[124:125], v9 offset:160
  ds_read_b64_tr_b16 a[126:127], v9 offset:20640
  ds_read_b64_tr_b16 a[148:149], v9 offset:168
  ds_read_b64_tr_b16 a[150:151], v9 offset:20648
  ds_read_b64_tr_b16 a[172:173], v7 offset:224
  ds_read_b64_tr_b16 a[174:175], v7 offset:20704
  ds_read_b64_tr_b16 a[196:197], v9 offset:256
  ds_read_b64_tr_b16 a[198:199], v9 offset:20736
  ds_read_b64_tr_b16 a[220:221], v9 offset:264
  ds_read_b64_tr_b16 a[222:223], v9 offset:20744
  ds_read_b64_tr_b16 a[8:9], v8 offset:40960
  ds_read_b64_tr_b16 a[10:11], v9 offset:40960
  ds_read_b64_tr_b16 a[32:33], v8 offset:40968
  ds_read_b64_tr_b16 a[34:35], v9 offset:40968
  ds_read_b64_tr_b16 a[56:57], v6 offset:41024
  ds_read_b64_tr_b16 a[58:59], v7 offset:41024
  ds_read_b64_tr_b16 a[80:81], v8 offset:41056
  ds_read_b64_tr_b16 a[82:83], v9 offset:41056
  ds_read_b64_tr_b16 a[104:105], v8 offset:41064
  ds_read_b64_tr_b16 a[106:107], v9 offset:41064
  ds_read_b64_tr_b16 a[128:129], v8 offset:41120
  ds_read_b64_tr_b16 a[130:131], v9 offset:41120
  ds_read_b64_tr_b16 a[152:153], v8 offset:41128
  ds_read_b64_tr_b16 a[154:155], v9 offset:41128
  ds_read_b64_tr_b16 a[176:177], v6 offset:41184
  ds_read_b64_tr_b16 a[178:179], v7 offset:41184
  ds_read_b64_tr_b16 a[200:201], v8 offset:41216
  ds_read_b64_tr_b16 a[202:203], v9 offset:41216
  ds_read_b64_tr_b16 a[224:225], v8 offset:41224
  ds_read_b64_tr_b16 a[226:227], v9 offset:41224
  s_waitcnt lgkmcnt(0)
  s_barrier
  s_waitcnt vmcnt(8)
  ds_write_b128 v5, v[64:67] offset:0
  ds_write_b128 v5, v[68:71] offset:1024
  ds_write_b128 v5, v[72:75] offset:2048
  ds_write_b128 v5, v[76:79] offset:3072
  ds_write_b128 v5, v[80:83] offset:4096
  ds_write_b128 v5, v[84:87] offset:5120
  ds_write_b128 v5, v[88:91] offset:6144
  ds_write_b128 v5, v[92:95] offset:7168
  ds_write_b128 v5, v[96:99] offset:8192
  ds_write_b128 v5, v[100:103] offset:9216
  ds_write_b128 v5, v[104:107] offset:10240
  ds_write_b128 v5, v[108:111] offset:11264
  ds_write_b128 v5, v[112:115] offset:12288
  ds_write_b128 v5, v[116:119] offset:13312
  ds_write_b128 v5, v[120:123] offset:14336
  ds_write_b128 v5, v[124:127] offset:15360
  ds_write_b128 v5, v[128:131] offset:16384
  ds_write_b128 v5, v[132:135] offset:17408
  ds_write_b128 v5, v[136:139] offset:18432
  ds_write_b128 v5, v[140:143] offset:19456
  ds_write_b128 v5, v[144:147] offset:20480
  ds_write_b128 v5, v[148:151] offset:21504
  ds_write_b128 v5, v[152:155] offset:22528
  ds_write_b128 v5, v[156:159] offset:23552
  ds_write_b128 v5, v[160:163] offset:24576
  ds_write_b128 v5, v[164:167] offset:25600
  ds_write_b128 v5, v[168:171] offset:26624
  ds_write_b128 v5, v[172:175] offset:27648
  ds_write_b128 v5, v[176:179] offset:28672
  ds_write_b128 v5, v[180:183] offset:29696
  s_waitcnt lgkmcnt(0)
  s_barrier
  ds_read_b64_tr_b16 a[12:13], v8 offset:0
  ds_read_b64_tr_b16 a[14:15], v8 offset:20480
  ds_read_b64_tr_b16 a[36:37], v8 offset:8
  ds_read_b64_tr_b16 a[38:39], v8 offset:20488
  ds_read_b64_tr_b16 a[60:61], v6 offset:64
  ds_read_b64_tr_b16 a[62:63], v6 offset:20544
  ds_read_b64_tr_b16 a[84:85], v8 offset:96
  ds_read_b64_tr_b16 a[86:87], v8 offset:20576
  ds_read_b64_tr_b16 a[108:109], v8 offset:104
  ds_read_b64_tr_b16 a[110:111], v8 offset:20584
  ds_read_b64_tr_b16 a[132:133], v8 offset:160
  ds_read_b64_tr_b16 a[134:135], v8 offset:20640
  ds_read_b64_tr_b16 a[156:157], v8 offset:168
  ds_read_b64_tr_b16 a[158:159], v8 offset:20648
  ds_read_b64_tr_b16 a[180:181], v6 offset:224
  ds_read_b64_tr_b16 a[182:183], v6 offset:20704
  ds_read_b64_tr_b16 a[204:205], v8 offset:256
  ds_read_b64_tr_b16 a[206:207], v8 offset:20736
  ds_read_b64_tr_b16 a[228:229], v8 offset:264
  ds_read_b64_tr_b16 a[230:231], v8 offset:20744
  ds_read_b64_tr_b16 a[16:17], v9 offset:0
  ds_read_b64_tr_b16 a[18:19], v9 offset:20480
  ds_read_b64_tr_b16 a[40:41], v9 offset:8
  ds_read_b64_tr_b16 a[42:43], v9 offset:20488
  ds_read_b64_tr_b16 a[64:65], v7 offset:64
  ds_read_b64_tr_b16 a[66:67], v7 offset:20544
  ds_read_b64_tr_b16 a[88:89], v9 offset:96
  ds_read_b64_tr_b16 a[90:91], v9 offset:20576
  ds_read_b64_tr_b16 a[112:113], v9 offset:104
  ds_read_b64_tr_b16 a[114:115], v9 offset:20584
  ds_read_b64_tr_b16 a[136:137], v9 offset:160
  ds_read_b64_tr_b16 a[138:139], v9 offset:20640
  ds_read_b64_tr_b16 a[160:161], v9 offset:168
  ds_read_b64_tr_b16 a[162:163], v9 offset:20648
  ds_read_b64_tr_b16 a[184:185], v7 offset:224
  ds_read_b64_tr_b16 a[186:187], v7 offset:20704
  ds_read_b64_tr_b16 a[208:209], v9 offset:256
  ds_read_b64_tr_b16 a[210:211], v9 offset:20736
  ds_read_b64_tr_b16 a[232:233], v9 offset:264
  ds_read_b64_tr_b16 a[234:235], v9 offset:20744
  ds_read_b64_tr_b16 a[20:21], v8 offset:40960
  ds_read_b64_tr_b16 a[22:23], v9 offset:40960
  ds_read_b64_tr_b16 a[44:45], v8 offset:40968
  ds_read_b64_tr_b16 a[46:47], v9 offset:40968
  ds_read_b64_tr_b16 a[68:69], v6 offset:41024
  ds_read_b64_tr_b16 a[70:71], v7 offset:41024
  ds_read_b64_tr_b16 a[92:93], v8 offset:41056
  ds_read_b64_tr_b16 a[94:95], v9 offset:41056
  ds_read_b64_tr_b16 a[116:117], v8 offset:41064
  ds_read_b64_tr_b16 a[118:119], v9 offset:41064
  ds_read_b64_tr_b16 a[140:141], v8 offset:41120
  ds_read_b64_tr_b16 a[142:143], v9 offset:41120
  ds_read_b64_tr_b16 a[164:165], v8 offset:41128
  ds_read_b64_tr_b16 a[166:167], v9 offset:41128
  ds_read_b64_tr_b16 a[188:189], v6 offset:41184
  ds_read_b64_tr_b16 a[190:191], v7 offset:41184
  ds_read_b64_tr_b16 a[212:213], v8 offset:41216
  ds_read_b64_tr_b16 a[214:215], v9 offset:41216
  ds_read_b64_tr_b16 a[236:237], v8 offset:41224
  ds_read_b64_tr_b16 a[238:239], v9 offset:41224
  s_waitcnt lgkmcnt(0)
  s_barrier
  s_load_dwordx2 s[32:33], s[0:1], 96
  s_waitcnt lgkmcnt(0)
  s_mov_b32 s32, s32
  s_mov_b32 s33, s33
  s_mov_b32 s34, 256
  s_mov_b32 s35, 0x00020000
  s_mov_b32 s21, 76
  v_mov_b32 v4, 0
  s_mov_b32 s101, 0
wf_243:
  buffer_load_dword v5, v4, s[32:35], s21 offen sc1
  s_add_u32 s101, s101, 1
  s_cmp_gt_u32 s101, 131072
  s_cbranch_scc1 main_end
  s_waitcnt vmcnt(0)
  v_readfirstlane_b32 s100, v5
  s_cmp_ge_u32 s100, 1
  s_cbranch_scc1 wf_244
  s_sleep 8
  s_branch wf_243
wf_244:
  s_sub_u32 s80, s100, 1
  s_lshl_b32 s80, s80, 13
  s_lshl_b32 s40, s2, 2
  s_add_u32 s40, s40, s20
  s_lshl_b32 s40, s40, 14
  s_xor_b32 s40, s40, s80
  s_xor_b32 s40, s40, 8192
  s_mul_i32 s47, s20, 3072
  s_lshr_b32 s43, s2, 2
  s_lshl_b32 s43, s43, 7
  s_add_u32 s43, s43, 28672
  s_xor_b32 s43, s43, s80
  s_lshl_b32 s44, s2, 7
  s_lshl_b32 s21, s20, 2
  s_add_u32 s44, s44, s21
  s_add_u32 s44, s44, 4096
  s_xor_b32 s44, s44, s80
  s_lshl_b32 s49, s20, 8
  s_add_u32 s49, s49, 12288
  s_mov_b32 s45, 0
  v_lshlrev_b32 v4, 4, v1
  v_min_u32 v14, 18, v1
  v_lshlrev_b32 v14, 2, v14
  v_mov_b32 v17, 1073741824
  v_cmp_eq_u32 vcc, 0, v1
  s_nop 1
  v_cndmask_b32 v17, v17, 0, vcc
  v_mov_b32 v16, 0
  v_mov_b32 v18, 65536
vwr_245:
  s_cmp_lg_u32 s20, 0
  s_cbranch_scc1 vwr_248
  s_mov_b32 s101, 0
  s_branch vwr_247
vwr_246:
  s_cmp_lg_u32 s101, 1
  s_cbranch_scc1 vwr_249
  buffer_store_dword v16, v17, s[72:75], s44 offen sc1
vwr_249:
  s_sleep 4
vwr_247:
  buffer_load_dword v15, v14, s[72:75], s43 offen sc1
  s_add_u32 s101, s101, 1
  s_cmp_gt_u32 s101, 131072
  s_cbranch_scc1 main_end
  s_waitcnt vmcnt(0)
  v_cmp_le_u32 vcc, 8, v15
  s_nop 1
  s_ff0_i32_b32 s21, vcc_lo
  s_min_u32 s21, s21, 19
  s_lshl_b32 s22, s21, 1
  s_lshl_b32 s21, s21, 2
  s_sub_i32 s21, s21, 12
  s_max_i32 s46, s21, s22
  s_cmp_le_u32 s46, s45
  s_cbranch_scc1 vwr_246
  v_mov_b32 v15, s46
  ds_write_b32 v18, v15
  s_waitcnt lgkmcnt(0)
  s_barrier
  s_branch vwr_250
vwr_248:
  s_waitcnt vmcnt(0)
  buffer_store_dword v16, v17, s[72:75], s44 offen sc1
  s_barrier
  ds_read_b32 v15, v18
  s_waitcnt lgkmcnt(0)
  v_readfirstlane_b32 s46, v15
vwr_250:
  s_and_b32 s50, s45, 2
  s_lshl_b32 s50, s50, 14
  v_add_u32 v10, s50, v4
  v_add_u32 v11, 2048, v10
  v_add_u32 v12, 2056, v10
  v_lshlrev_b32 v13, 2, v1
  s_lshl_b32 s41, s45, 21
  s_add_u32 s41, s41, s40
  s_mov_b32 s48, s45
  s_mov_b32 s56, s41
  s_add_u32 s57, s56, 4096
  s_lshl_b32 s58, s45, 19
  s_lshl_b32 s21, s45, 11
  s_and_b32 s21, s21, 8192
  s_xor_b32 s21, s21, s80
  s_add_u32 s58, s58, s21
  s_add_u32 s58, s58, 136314880
  s_lshl_b32 s21, s2, 14
  s_lshl_b32 s22, s20, 11
  s_add_u32 s21, s21, s22
  s_add_u32 s58, s58, s21
  s_and_b32 s21, s2, 28
  s_add_u32 s21, s21, s20
  s_lshl_b32 s21, s21, 16
  s_and_b32 s22, s2, 3
  s_lshl_b32 s22, s22, 10
  s_add_u32 s21, s21, s22
  s_lshl_b32 s60, s45, 21
  s_add_u32 s60, s60, s21
  s_add_u32 s60, s60, s80
  s_add_u32 s60, s60, -2093056
  s_xor_b32 s60, s60, 8192
  s_mov_b32 s51, 1073741824
  s_mov_b32 s59, 1073741824
  s_mov_b32 s52, s50
  s_cmp_lt_u32 s48, s46
  s_cselect_b32 s53, s41, 1073741824
  s_add_u32 s54, s52, 0
  s_add_u32 m0, s54, s47
  s_nop 0
  buffer_load_dwordx4 v4, s[16:19], s53 offen offset:0 sc1 lds
  buffer_load_dwordx4 v4, s[16:19], s53 offen offset:1024 sc1 lds
  buffer_load_dwordx4 v4, s[16:19], s53 offen offset:2048 sc1 lds
  s_add_u32 s41, s41, 2097152
  s_xor_b32 s41, s41, 8192
  s_add_u32 s48, s48, 1
  s_cmp_lt_u32 s48, s46
  s_cselect_b32 s53, s41, 1073741824
  s_add_u32 s54, s52, 16384
  s_add_u32 m0, s54, s47
  s_nop 0
  buffer_load_dwordx4 v4, s[16:19], s53 offen offset:0 sc1 lds
  buffer_load_dwordx4 v4, s[16:19], s53 offen offset:1024 sc1 lds
  buffer_load_dwordx4 v4, s[16:19], s53 offen offset:2048 sc1 lds
  s_add_u32 s41, s41, 2097152
  s_xor_b32 s41, s41, 8192
  s_add_u32 s48, s48, 1
  s_xor_b32 s52, s52, 32768
  s_waitcnt vmcnt(3)
  s_barrier
  ds_read_b128 v[64:67], v10 offset:0
  ds_read_b128 v[88:91], v10 offset:1024
  ds_read_b128 v[68:71], v10 offset:3072
  ds_read_b128 v[92:95], v10 offset:4096
  ds_read2st64_b64 v[72:75], v11 offset0:0 offset1:6
  ds_read2st64_b64 v[96:99], v12 offset0:0 offset1:6
  ds_read_b128 v[76:79], v10 offset:6144
  ds_read_b128 v[100:103], v10 offset:7168
  ds_read_b128 v[80:83], v10 offset:9216
  ds_read_b128 v[104:107], v10 offset:10240
  ds_read2st64_b64 v[84:87], v11 offset0:12 offset1:18
  ds_read2st64_b64 v[108:111], v12 offset0:12 offset1:18
  buffer_store_dword v16, v17, s[72:75], s44 offen sc1
  s_waitcnt lgkmcnt(0)
  .p2align 3
vwl_251:
  v_mfma_f32_16x16x32_bf16 v[160:163], v[64:67], a[0:3], 0
  v_mfma_f32_16x16x32_bf16 v[164:167], v[88:91], a[0:3], 0
  v_mfma_f32_16x16x32_bf16 v[160:163], v[68:71], a[4:7], v[160:163]
  v_cvt_pk_bf16_f32 v204, v184, v185
  v_cvt_pk_bf16_f32 v205, v186, v187
  v_mfma_f32_16x16x32_bf16 v[164:167], v[92:95], a[4:7], v[164:167]
  s_add_u32 s60, s60, 2097152
  v_cvt_pk_bf16_f32 v206, v188, v189
  v_cvt_pk_bf16_f32 v207, v190, v191
  v_mfma_f32_16x16x32_bf16 v[160:163], v[72:75], a[8:11], v[160:163]
  s_xor_b32 s60, s60, 8192
  buffer_store_dwordx4 v[204:207], v4, s[16:19], s51 offen offset:3072 sc1
  s_sub_u32 s62, s60, 0
  v_mfma_f32_16x16x32_bf16 v[164:167], v[96:99], a[8:11], v[164:167]
  s_cmp_ge_u32 s62, 125829120
  s_cselect_b32 s62, 1073741824, s60
  v_mfma_f32_16x16x32_bf16 v[160:163], v[76:79], a[12:15], v[160:163]
  v_mfma_f32_16x16x32_bf16 v[164:167], v[100:103], a[12:15], v[164:167]
  v_mfma_f32_16x16x32_bf16 v[160:163], v[80:83], a[16:19], v[160:163]
  s_add_u32 m0, s49, 0
  v_mfma_f32_16x16x32_bf16 v[164:167], v[104:107], a[16:19], v[164:167]
  buffer_load_dword v14, s[72:75], s43 offen sc1 lds
  v_mfma_f32_16x16x32_bf16 v[160:163], v[84:87], a[20:23], v[160:163]
  v_mfma_f32_16x16x32_bf16 v[164:167], v[108:111], a[20:23], v[164:167]
  v_mfma_f32_16x16x32_bf16 v[168:171], v[64:67], a[24:27], 0
  v_mfma_f32_16x16x32_bf16 v[172:175], v[88:91], a[24:27], 0
  v_mfma_f32_16x16x32_bf16 v[168:171], v[68:71], a[28:31], v[168:171]
  v_cvt_pk_bf16_f32 v192, v160, v161
  v_cvt_pk_bf16_f32 v193, v162, v163
  v_mfma_f32_16x16x32_bf16 v[172:175], v[92:95], a[28:31], v[172:175]
  v_cvt_pk_bf16_f32 v194, v164, v165
  v_cvt_pk_bf16_f32 v195, v166, v167
  v_mfma_f32_16x16x32_bf16 v[168:171], v[72:75], a[32:35], v[168:171]
  buffer_store_dwordx4 v[192:195], v4, s[16:19], s56 offen offset:0 sc1
  v_mfma_f32_16x16x32_bf16 v[172:175], v[96:99], a[32:35], v[172:175]
  v_mfma_f32_16x16x32_bf16 v[168:171], v[76:79], a[36:39], v[168:171]
  v_mfma_f32_16x16x32_bf16 v[172:175], v[100:103], a[36:39], v[172:175]
  v_mfma_f32_16x16x32_bf16 v[168:171], v[80:83], a[40:43], v[168:171]
  v_mfma_f32_16x16x32_bf16 v[172:175], v[104:107], a[40:43], v[172:175]
  s_add_u32 s55, s62, 0
  v_mfma_f32_16x16x32_bf16 v[168:171], v[84:87], a[44:47], v[168:171]
  buffer_store_dwordx4 v[192:195], v4, s[16:19], s55 offen sc1
  v_mfma_f32_16x16x32_bf16 v[172:175], v[108:111], a[44:47], v[172:175]
  v_mfma_f32_16x16x32_bf16 v[176:179], v[64:67], a[48:51], 0
  v_mfma_f32_16x16x32_bf16 v[180:183], v[88:91], a[48:51], 0
  v_mfma_f32_16x16x32_bf16 v[176:179], v[68:71], a[52:55], v[176:179]
  v_cvt_pk_bf16_f32 v196, v168, v169
  v_cvt_pk_bf16_f32 v197, v170, v171
  v_mfma_f32_16x16x32_bf16 v[180:183], v[92:95], a[52:55], v[180:183]
  v_cvt_pk_bf16_f32 v198, v172, v173
  v_cvt_pk_bf16_f32 v199, v174, v175
  v_mfma_f32_16x16x32_bf16 v[176:179], v[72:75], a[56:59], v[176:179]
  buffer_store_dwordx4 v[196:199], v4, s[16:19], s56 offen offset:1024 sc1
  v_mfma_f32_16x16x32_bf16 v[180:183], v[96:99], a[56:59], v[180:183]
  v_mfma_f32_16x16x32_bf16 v[176:179], v[76:79], a[60:63], v[176:179]
  v_mfma_f32_16x16x32_bf16 v[180:183], v[100:103], a[60:63], v[180:183]
  v_mfma_f32_16x16x32_bf16 v[176:179], v[80:83], a[64:67], v[176:179]
  v_mfma_f32_16x16x32_bf16 v[180:183], v[104:107], a[64:67], v[180:183]
  v_mfma_f32_16x16x32_bf16 v[176:179], v[84:87], a[68:71], v[176:179]
  v_mfma_f32_16x16x32_bf16 v[180:183], v[108:111], a[68:71], v[180:183]
  v_mfma_f32_16x16x32_bf16 v[184:187], v[64:67], a[72:75], 0
  v_mfma_f32_16x16x32_bf16 v[188:191], v[88:91], a[72:75], 0
  v_mfma_f32_16x16x32_bf16 v[184:187], v[68:71], a[76:79], v[184:187]
  v_cvt_pk_bf16_f32 v200, v176, v177
  v_cvt_pk_bf16_f32 v201, v178, v179
  v_mfma_f32_16x16x32_bf16 v[188:191], v[92:95], a[76:79], v[188:191]
  v_cvt_pk_bf16_f32 v202, v180, v181
  v_cvt_pk_bf16_f32 v203, v182, v183
  v_mfma_f32_16x16x32_bf16 v[184:187], v[72:75], a[80:83], v[184:187]
  buffer_store_dwordx4 v[200:203], v4, s[16:19], s58 offen offset:0 sc1
  v_mfma_f32_16x16x32_bf16 v[188:191], v[96:99], a[80:83], v[188:191]
  v_mfma_f32_16x16x32_bf16 v[184:187], v[76:79], a[84:87], v[184:187]
  v_mfma_f32_16x16x32_bf16 v[188:191], v[100:103], a[84:87], v[188:191]
  v_mfma_f32_16x16x32_bf16 v[184:187], v[80:83], a[88:91], v[184:187]
  v_mfma_f32_16x16x32_bf16 v[188:191], v[104:107], a[88:91], v[188:191]
  v_mfma_f32_16x16x32_bf16 v[184:187], v[84:87], a[92:95], v[184:187]
  v_mfma_f32_16x16x32_bf16 v[188:191], v[108:111], a[92:95], v[188:191]
  v_mfma_f32_16x16x32_bf16 v[160:163], v[64:67], a[96:99], 0
  v_mfma_f32_16x16x32_bf16 v[164:167], v[88:91], a[96:99], 0
  v_mfma_f32_16x16x32_bf16 v[160:163], v[68:71], a[100:103], v[160:163]
  v_cvt_pk_bf16_f32 v204, v184, v185
  v_cvt_pk_bf16_f32 v205, v186, v187
  v_mfma_f32_16x16x32_bf16 v[164:167], v[92:95], a[100:103], v[164:167]
  v_cvt_pk_bf16_f32 v206, v188, v189
  v_cvt_pk_bf16_f32 v207, v190, v191
  v_mfma_f32_16x16x32_bf16 v[160:163], v[72:75], a[104:107], v[160:163]
  buffer_store_dwordx4 v[204:207], v4, s[16:19], s56 offen offset:2048 sc1
  v_mfma_f32_16x16x32_bf16 v[164:167], v[96:99], a[104:107], v[164:167]
  v_mfma_f32_16x16x32_bf16 v[160:163], v[76:79], a[108:111], v[160:163]
  s_waitcnt vmcnt(5)
  s_barrier
  ds_read_b32 v15, v13 offset:12288
  v_mfma_f32_16x16x32_bf16 v[164:167], v[100:103], a[108:111], v[164:167]
  ds_read_b128 v[112:115], v10 offset:16384
  s_min_u32 s23, s45, 56
  v_mfma_f32_16x16x32_bf16 v[160:163], v[80:83], a[112:115], v[160:163]
  v_mov_b32 v16, s23
  s_waitcnt vmcnt(6)
  v_mfma_f32_16x16x32_bf16 v[164:167], v[104:107], a[112:115], v[164:167]
  s_add_u32 s55, s62, 16384
  ds_read_b128 v[136:139], v10 offset:17408
  v_mfma_f32_16x16x32_bf16 v[160:163], v[84:87], a[116:119], v[160:163]
  buffer_store_dwordx4 v[204:207], v4, s[16:19], s55 offen sc1
  s_waitcnt lgkmcnt(2)
  v_mfma_f32_16x16x32_bf16 v[164:167], v[108:111], a[116:119], v[164:167]
  ds_read_b128 v[116:119], v10 offset:19456
  v_cmp_le_u32 vcc, 8, v15
  v_mfma_f32_16x16x32_bf16 v[168:171], v[64:67], a[120:123], 0
  s_ff0_i32_b32 s21, vcc_lo
  s_min_u32 s21, s21, 19
  s_lshl_b32 s22, s21, 1
  v_mfma_f32_16x16x32_bf16 v[172:175], v[88:91], a[120:123], 0
  s_lshl_b32 s21, s21, 2
  ds_read_b128 v[140:143], v10 offset:20480
  s_sub_i32 s21, s21, 12
  v_mfma_f32_16x16x32_bf16 v[168:171], v[68:71], a[124:127], v[168:171]
  s_max_i32 s21, s21, s22
  v_cvt_pk_bf16_f32 v192, v160, v161
  v_cvt_pk_bf16_f32 v193, v162, v163
  v_mfma_f32_16x16x32_bf16 v[172:175], v[92:95], a[124:127], v[172:175]
  s_max_u32 s42, s21, s46
  v_cvt_pk_bf16_f32 v194, v164, v165
  v_cvt_pk_bf16_f32 v195, v166, v167
  v_mfma_f32_16x16x32_bf16 v[168:171], v[72:75], a[128:131], v[168:171]
  buffer_store_dwordx4 v[192:195], v4, s[16:19], s56 offen offset:3072 sc1
  ds_read2st64_b64 v[120:123], v11 offset0:32 offset1:38
  v_mfma_f32_16x16x32_bf16 v[172:175], v[96:99], a[128:131], v[172:175]
  s_cmp_ge_u32 s46, s48
  s_cselect_b32 s46, s42, s46
  v_mfma_f32_16x16x32_bf16 v[168:171], v[76:79], a[132:135], v[168:171]
  ds_read2st64_b64 v[144:147], v12 offset0:32 offset1:38
  v_mfma_f32_16x16x32_bf16 v[172:175], v[100:103], a[132:135], v[172:175]
  s_cmp_lt_u32 s48, s46
  s_cselect_b32 s53, s41, 1073741824
  s_add_u32 s54, s52, 0
  v_mfma_f32_16x16x32_bf16 v[168:171], v[80:83], a[136:139], v[168:171]
  s_add_u32 m0, s54, s47
  ds_read_b128 v[124:127], v10 offset:22528
  v_mfma_f32_16x16x32_bf16 v[172:175], v[104:107], a[136:139], v[172:175]
  buffer_load_dwordx4 v4, s[16:19], s53 offen offset:0 sc1 lds
  v_mfma_f32_16x16x32_bf16 v[168:171], v[84:87], a[140:143], v[168:171]
  ds_read_b128 v[148:151], v10 offset:23552
  v_mfma_f32_16x16x32_bf16 v[172:175], v[108:111], a[140:143], v[172:175]
  v_mfma_f32_16x16x32_bf16 v[176:179], v[64:67], a[144:147], 0
  ds_read_b128 v[128:131], v10 offset:25600
  buffer_store_dword v16, v17, s[72:75], s44 offen sc1
  v_mfma_f32_16x16x32_bf16 v[180:183], v[88:91], a[144:147], 0
  v_mfma_f32_16x16x32_bf16 v[176:179], v[68:71], a[148:151], v[176:179]
  v_cvt_pk_bf16_f32 v196, v168, v169
  v_cvt_pk_bf16_f32 v197, v170, v171
  v_mfma_f32_16x16x32_bf16 v[180:183], v[92:95], a[148:151], v[180:183]
  v_cvt_pk_bf16_f32 v198, v172, v173
  v_cvt_pk_bf16_f32 v199, v174, v175
  v_mfma_f32_16x16x32_bf16 v[176:179], v[72:75], a[152:155], v[176:179]
  buffer_store_dwordx4 v[196:199], v4, s[16:19], s57 offen offset:0 sc1
  ds_read_b128 v[152:155], v10 offset:26624
  v_mfma_f32_16x16x32_bf16 v[180:183], v[96:99], a[152:155], v[180:183]
  v_mfma_f32_16x16x32_bf16 v[176:179], v[76:79], a[156:159], v[176:179]
  ds_read2st64_b64 v[132:135], v11 offset0:44 offset1:50
  v_mfma_f32_16x16x32_bf16 v[180:183], v[100:103], a[156:159], v[180:183]
  v_mfma_f32_16x16x32_bf16 v[176:179], v[80:83], a[160:163], v[176:179]
  ds_read2st64_b64 v[156:159], v12 offset0:44 offset1:50
  v_mfma_f32_16x16x32_bf16 v[180:183], v[104:107], a[160:163], v[180:183]
  s_add_u32 s55, s62, 32768
  v_mfma_f32_16x16x32_bf16 v[176:179], v[84:87], a[164:167], v[176:179]
  buffer_store_dwordx4 v[196:199], v4, s[16:19], s55 offen sc1
  v_mfma_f32_16x16x32_bf16 v[180:183], v[108:111], a[164:167], v[180:183]
  v_mfma_f32_16x16x32_bf16 v[184:187], v[64:67], a[168:171], 0
  v_mfma_f32_16x16x32_bf16 v[188:191], v[88:91], a[168:171], 0
  v_mfma_f32_16x16x32_bf16 v[184:187], v[68:71], a[172:175], v[184:187]
  v_cvt_pk_bf16_f32 v200, v176, v177
  v_cvt_pk_bf16_f32 v201, v178, v179
  v_mfma_f32_16x16x32_bf16 v[188:191], v[92:95], a[172:175], v[188:191]
  v_cvt_pk_bf16_f32 v202, v180, v181
  v_cvt_pk_bf16_f32 v203, v182, v183
  v_mfma_f32_16x16x32_bf16 v[184:187], v[72:75], a[176:179], v[184:187]
  buffer_store_dwordx4 v[200:203], v4, s[16:19], s57 offen offset:1024 sc1
  v_mfma_f32_16x16x32_bf16 v[188:191], v[96:99], a[176:179], v[188:191]
  v_mfma_f32_16x16x32_bf16 v[184:187], v[76:79], a[180:183], v[184:187]
  v_mfma_f32_16x16x32_bf16 v[188:191], v[100:103], a[180:183], v[188:191]
  v_mfma_f32_16x16x32_bf16 v[184:187], v[80:83], a[184:187], v[184:187]
  v_mfma_f32_16x16x32_bf16 v[188:191], v[104:107], a[184:187], v[188:191]
  buffer_load_dwordx4 v4, s[16:19], s53 offen offset:1024 sc1 lds
  v_mfma_f32_16x16x32_bf16 v[184:187], v[84:87], a[188:191], v[184:187]
  v_mfma_f32_16x16x32_bf16 v[188:191], v[108:111], a[188:191], v[188:191]
  v_mfma_f32_16x16x32_bf16 v[160:163], v[64:67], a[192:195], 0
  v_mfma_f32_16x16x32_bf16 v[164:167], v[88:91], a[192:195], 0
  v_mfma_f32_16x16x32_bf16 v[160:163], v[68:71], a[196:199], v[160:163]
  v_cvt_pk_bf16_f32 v204, v184, v185
  v_cvt_pk_bf16_f32 v205, v186, v187
  v_mfma_f32_16x16x32_bf16 v[164:167], v[92:95], a[196:199], v[164:167]
  v_cvt_pk_bf16_f32 v206, v188, v189
  v_cvt_pk_bf16_f32 v207, v190, v191
  v_mfma_f32_16x16x32_bf16 v[160:163], v[72:75], a[200:203], v[160:163]
  buffer_store_dwordx4 v[204:207], v4, s[16:19], s58 offen offset:1024 sc1
  v_mfma_f32_16x16x32_bf16 v[164:167], v[96:99], a[200:203], v[164:167]
  v_mfma_f32_16x16x32_bf16 v[160:163], v[76:79], a[204:207], v[160:163]
  s_add_u32 s56, s56, 2097152
  s_xor_b32 s56, s56, 8192
  s_add_u32 s59, s58, 524288
  v_mfma_f32_16x16x32_bf16 v[164:167], v[100:103], a[204:207], v[164:167]
  s_xor_b32 s58, s58, s59
  s_lshr_b32 s58, s58, 8
  s_and_b32 s58, s58, 8192
  v_mfma_f32_16x16x32_bf16 v[160:163], v[80:83], a[208:211], v[160:163]
  s_xor_b32 s58, s58, s59
  v_mfma_f32_16x16x32_bf16 v[164:167], v[104:107], a[208:211], v[164:167]
  buffer_load_dwordx4 v4, s[16:19], s53 offen offset:2048 sc1 lds
  s_add_u32 s41, s41, 2097152
  v_mfma_f32_16x16x32_bf16 v[160:163], v[84:87], a[212:215], v[160:163]
  s_xor_b32 s41, s41, 8192
  s_add_u32 s48, s48, 1
  v_mfma_f32_16x16x32_bf16 v[164:167], v[108:111], a[212:215], v[164:167]
  v_mfma_f32_16x16x32_bf16 v[168:171], v[64:67], a[216:219], 0
  v_mfma_f32_16x16x32_bf16 v[172:175], v[88:91], a[216:219], 0
  v_mfma_f32_16x16x32_bf16 v[168:171], v[68:71], a[220:223], v[168:171]
  v_cvt_pk_bf16_f32 v192, v160, v161
  v_cvt_pk_bf16_f32 v193, v162, v163
  v_mfma_f32_16x16x32_bf16 v[172:175], v[92:95], a[220:223], v[172:175]
  v_cvt_pk_bf16_f32 v194, v164, v165
  v_cvt_pk_bf16_f32 v195, v166, v167
  v_mfma_f32_16x16x32_bf16 v[168:171], v[72:75], a[224:227], v[168:171]
  buffer_store_dwordx4 v[192:195], v4, s[16:19], s57 offen offset:2048 sc1
  v_mfma_f32_16x16x32_bf16 v[172:175], v[96:99], a[224:227], v[172:175]
  v_mfma_f32_16x16x32_bf16 v[168:171], v[76:79], a[228:231], v[168:171]
  s_mov_b32 s51, s57
  s_add_u32 s57, s56, 4096
  s_add_u32 s45, s45, 1
  v_mfma_f32_16x16x32_bf16 v[172:175], v[100:103], a[228:231], v[172:175]
  s_add_u32 s55, s62, 49152
  v_mfma_f32_16x16x32_bf16 v[168:171], v[80:83], a[232:235], v[168:171]
  buffer_store_dwordx4 v[192:195], v4, s[16:19], s55 offen sc1
  v_mfma_f32_16x16x32_bf16 v[172:175], v[104:107], a[232:235], v[172:175]
  v_mfma_f32_16x16x32_bf16 v[168:171], v[84:87], a[236:239], v[168:171]
  v_mfma_f32_16x16x32_bf16 v[172:175], v[108:111], a[236:239], v[172:175]
  s_waitcnt lgkmcnt(0)
  v_mfma_f32_16x16x32_bf16 v[176:179], v[112:115], a[0:3], 0
  v_mfma_f32_16x16x32_bf16 v[180:183], v[136:139], a[0:3], 0
  v_mfma_f32_16x16x32_bf16 v[176:179], v[116:119], a[4:7], v[176:179]
  v_cvt_pk_bf16_f32 v196, v168, v169
  v_cvt_pk_bf16_f32 v197, v170, v171
  v_mfma_f32_16x16x32_bf16 v[180:183], v[140:143], a[4:7], v[180:183]
  s_add_u32 s60, s60, 2097152
  v_cvt_pk_bf16_f32 v198, v172, v173
  v_cvt_pk_bf16_f32 v199, v174, v175
  v_mfma_f32_16x16x32_bf16 v[176:179], v[120:123], a[8:11], v[176:179]
  s_xor_b32 s60, s60, 8192
  buffer_store_dwordx4 v[196:199], v4, s[16:19], s51 offen offset:3072 sc1
  s_sub_u32 s62, s60, 0
  v_mfma_f32_16x16x32_bf16 v[180:183], v[144:147], a[8:11], v[180:183]
  s_cmp_ge_u32 s62, 125829120
  s_cselect_b32 s62, 1073741824, s60
  v_mfma_f32_16x16x32_bf16 v[176:179], v[124:127], a[12:15], v[176:179]
  v_mfma_f32_16x16x32_bf16 v[180:183], v[148:151], a[12:15], v[180:183]
  v_mfma_f32_16x16x32_bf16 v[176:179], v[128:131], a[16:19], v[176:179]
  s_add_u32 m0, s49, 16384
  v_mfma_f32_16x16x32_bf16 v[180:183], v[152:155], a[16:19], v[180:183]
  buffer_load_dword v14, s[72:75], s43 offen sc1 lds
  v_mfma_f32_16x16x32_bf16 v[176:179], v[132:135], a[20:23], v[176:179]
  v_mfma_f32_16x16x32_bf16 v[180:183], v[156:159], a[20:23], v[180:183]
  v_mfma_f32_16x16x32_bf16 v[184:187], v[112:115], a[24:27], 0
  v_mfma_f32_16x16x32_bf16 v[188:191], v[136:139], a[24:27], 0
  v_mfma_f32_16x16x32_bf16 v[184:187], v[116:119], a[28:31], v[184:187]
  v_cvt_pk_bf16_f32 v200, v176, v177
  v_cvt_pk_bf16_f32 v201, v178, v179
  v_mfma_f32_16x16x32_bf16 v[188:191], v[140:143], a[28:31], v[188:191]
  v_cvt_pk_bf16_f32 v202, v180, v181
  v_cvt_pk_bf16_f32 v203, v182, v183
  v_mfma_f32_16x16x32_bf16 v[184:187], v[120:123], a[32:35], v[184:187]
  buffer_store_dwordx4 v[200:203], v4, s[16:19], s56 offen offset:0 sc1
  v_mfma_f32_16x16x32_bf16 v[188:191], v[144:147], a[32:35], v[188:191]
  v_mfma_f32_16x16x32_bf16 v[184:187], v[124:127], a[36:39], v[184:187]
  v_mfma_f32_16x16x32_bf16 v[188:191], v[148:151], a[36:39], v[188:191]
  v_mfma_f32_16x16x32_bf16 v[184:187], v[128:131], a[40:43], v[184:187]
  v_mfma_f32_16x16x32_bf16 v[188:191], v[152:155], a[40:43], v[188:191]
  s_add_u32 s55, s62, 0
  v_mfma_f32_16x16x32_bf16 v[184:187], v[132:135], a[44:47], v[184:187]
  buffer_store_dwordx4 v[200:203], v4, s[16:19], s55 offen sc1
  v_mfma_f32_16x16x32_bf16 v[188:191], v[156:159], a[44:47], v[188:191]
  v_mfma_f32_16x16x32_bf16 v[160:163], v[112:115], a[48:51], 0
  v_mfma_f32_16x16x32_bf16 v[164:167], v[136:139], a[48:51], 0
  v_mfma_f32_16x16x32_bf16 v[160:163], v[116:119], a[52:55], v[160:163]
  v_cvt_pk_bf16_f32 v204, v184, v185
  v_cvt_pk_bf16_f32 v205, v186, v187
  v_mfma_f32_16x16x32_bf16 v[164:167], v[140:143], a[52:55], v[164:167]
  v_cvt_pk_bf16_f32 v206, v188, v189
  v_cvt_pk_bf16_f32 v207, v190, v191
  v_mfma_f32_16x16x32_bf16 v[160:163], v[120:123], a[56:59], v[160:163]
  buffer_store_dwordx4 v[204:207], v4, s[16:19], s56 offen offset:1024 sc1
  v_mfma_f32_16x16x32_bf16 v[164:167], v[144:147], a[56:59], v[164:167]
  v_mfma_f32_16x16x32_bf16 v[160:163], v[124:127], a[60:63], v[160:163]
  v_mfma_f32_16x16x32_bf16 v[164:167], v[148:151], a[60:63], v[164:167]
  v_mfma_f32_16x16x32_bf16 v[160:163], v[128:131], a[64:67], v[160:163]
  v_mfma_f32_16x16x32_bf16 v[164:167], v[152:155], a[64:67], v[164:167]
  v_mfma_f32_16x16x32_bf16 v[160:163], v[132:135], a[68:71], v[160:163]
  v_mfma_f32_16x16x32_bf16 v[164:167], v[156:159], a[68:71], v[164:167]
  v_mfma_f32_16x16x32_bf16 v[168:171], v[112:115], a[72:75], 0
  v_mfma_f32_16x16x32_bf16 v[172:175], v[136:139], a[72:75], 0
  v_mfma_f32_16x16x32_bf16 v[168:171], v[116:119], a[76:79], v[168:171]
  v_cvt_pk_bf16_f32 v192, v160, v161
  v_cvt_pk_bf16_f32 v193, v162, v163
  v_mfma_f32_16x16x32_bf16 v[172:175], v[140:143], a[76:79], v[172:175]
  v_cvt_pk_bf16_f32 v194, v164, v165
  v_cvt_pk_bf16_f32 v195, v166, v167
  v_mfma_f32_16x16x32_bf16 v[168:171], v[120:123], a[80:83], v[168:171]
  buffer_store_dwordx4 v[192:195], v4, s[16:19], s58 offen offset:0 sc1
  v_mfma_f32_16x16x32_bf16 v[172:175], v[144:147], a[80:83], v[172:175]
  v_mfma_f32_16x16x32_bf16 v[168:171], v[124:127], a[84:87], v[168:171]
  v_mfma_f32_16x16x32_bf16 v[172:175], v[148:151], a[84:87], v[172:175]
  v_mfma_f32_16x16x32_bf16 v[168:171], v[128:131], a[88:91], v[168:171]
  v_mfma_f32_16x16x32_bf16 v[172:175], v[152:155], a[88:91], v[172:175]
  v_mfma_f32_16x16x32_bf16 v[168:171], v[132:135], a[92:95], v[168:171]
  v_mfma_f32_16x16x32_bf16 v[172:175], v[156:159], a[92:95], v[172:175]
  v_mfma_f32_16x16x32_bf16 v[176:179], v[112:115], a[96:99], 0
  v_mfma_f32_16x16x32_bf16 v[180:183], v[136:139], a[96:99], 0
  v_mfma_f32_16x16x32_bf16 v[176:179], v[116:119], a[100:103], v[176:179]
  v_cvt_pk_bf16_f32 v196, v168, v169
  v_cvt_pk_bf16_f32 v197, v170, v171
  v_mfma_f32_16x16x32_bf16 v[180:183], v[140:143], a[100:103], v[180:183]
  v_cvt_pk_bf16_f32 v198, v172, v173
  v_cvt_pk_bf16_f32 v199, v174, v175
  v_mfma_f32_16x16x32_bf16 v[176:179], v[120:123], a[104:107], v[176:179]
  buffer_store_dwordx4 v[196:199], v4, s[16:19], s56 offen offset:2048 sc1
  v_mfma_f32_16x16x32_bf16 v[180:183], v[144:147], a[104:107], v[180:183]
  v_mfma_f32_16x16x32_bf16 v[176:179], v[124:127], a[108:111], v[176:179]
  s_waitcnt vmcnt(5)
  s_barrier
  ds_read_b32 v15, v13 offset:28672
  v_mfma_f32_16x16x32_bf16 v[180:183], v[148:151], a[108:111], v[180:183]
  v_xor_b32 v10, 32768, v10
  v_xor_b32 v11, 32768, v11
  v_mfma_f32_16x16x32_bf16 v[176:179], v[128:131], a[112:115], v[176:179]
  v_xor_b32 v12, 32768, v12
  ds_read_b128 v[64:67], v10 offset:0
  v_mfma_f32_16x16x32_bf16 v[180:183], v[152:155], a[112:115], v[180:183]
  s_add_u32 s55, s62, 16384
  s_min_u32 s23, s45, 56
  v_mov_b32 v16, s23
  v_mfma_f32_16x16x32_bf16 v[176:179], v[132:135], a[116:119], v[176:179]
  buffer_store_dwordx4 v[196:199], v4, s[16:19], s55 offen sc1
  ds_read_b128 v[88:91], v10 offset:1024
  v_mfma_f32_16x16x32_bf16 v[180:183], v[156:159], a[116:119], v[180:183]
  s_waitcnt vmcnt(7)
  v_mfma_f32_16x16x32_bf16 v[184:187], v[112:115], a[120:123], 0
  ds_read_b128 v[68:71], v10 offset:3072
  s_waitcnt lgkmcnt(3)
  v_mfma_f32_16x16x32_bf16 v[188:191], v[136:139], a[120:123], 0
  v_cmp_le_u32 vcc, 8, v15
  buffer_store_dword v16, v17, s[72:75], s44 offen sc1
  v_mfma_f32_16x16x32_bf16 v[184:187], v[116:119], a[124:127], v[184:187]
  v_cvt_pk_bf16_f32 v200, v176, v177
  v_cvt_pk_bf16_f32 v201, v178, v179
  v_mfma_f32_16x16x32_bf16 v[188:191], v[140:143], a[124:127], v[188:191]
  s_ff0_i32_b32 s21, vcc_lo
  v_cvt_pk_bf16_f32 v202, v180, v181
  v_cvt_pk_bf16_f32 v203, v182, v183
  v_mfma_f32_16x16x32_bf16 v[184:187], v[120:123], a[128:131], v[184:187]
  s_min_u32 s21, s21, 19
  buffer_store_dwordx4 v[200:203], v4, s[16:19], s56 offen offset:3072 sc1
  ds_read_b128 v[92:95], v10 offset:4096
  v_mfma_f32_16x16x32_bf16 v[188:191], v[144:147], a[128:131], v[188:191]
  s_lshl_b32 s22, s21, 1
  s_lshl_b32 s21, s21, 2
  s_sub_i32 s21, s21, 12
  v_mfma_f32_16x16x32_bf16 v[184:187], v[124:127], a[132:135], v[184:187]
  s_max_i32 s21, s21, s22
  ds_read2st64_b64 v[72:75], v11 offset0:0 offset1:6
  s_max_u32 s42, s21, s46
  v_mfma_f32_16x16x32_bf16 v[188:191], v[148:151], a[132:135], v[188:191]
  s_cmp_ge_u32 s46, s48
  s_cselect_b32 s46, s42, s46
  v_mfma_f32_16x16x32_bf16 v[184:187], v[128:131], a[136:139], v[184:187]
  ds_read2st64_b64 v[96:99], v12 offset0:0 offset1:6
  v_mfma_f32_16x16x32_bf16 v[188:191], v[152:155], a[136:139], v[188:191]
  s_cmp_lt_u32 s48, s46
  s_cselect_b32 s53, s41, 1073741824
  s_add_u32 s54, s52, 16384
  v_mfma_f32_16x16x32_bf16 v[184:187], v[132:135], a[140:143], v[184:187]
  s_add_u32 m0, s54, s47
  ds_read_b128 v[76:79], v10 offset:6144
  v_mfma_f32_16x16x32_bf16 v[188:191], v[156:159], a[140:143], v[188:191]
  buffer_load_dwordx4 v4, s[16:19], s53 offen offset:0 sc1 lds
  v_mfma_f32_16x16x32_bf16 v[160:163], v[112:115], a[144:147], 0
  ds_read_b128 v[100:103], v10 offset:7168
  v_mfma_f32_16x16x32_bf16 v[164:167], v[136:139], a[144:147], 0
  v_mfma_f32_16x16x32_bf16 v[160:163], v[116:119], a[148:151], v[160:163]
  v_cvt_pk_bf16_f32 v204, v184, v185
  v_cvt_pk_bf16_f32 v205, v186, v187
  v_mfma_f32_16x16x32_bf16 v[164:167], v[140:143], a[148:151], v[164:167]
  v_cvt_pk_bf16_f32 v206, v188, v189
  v_cvt_pk_bf16_f32 v207, v190, v191
  v_mfma_f32_16x16x32_bf16 v[160:163], v[120:123], a[152:155], v[160:163]
  buffer_store_dwordx4 v[204:207], v4, s[16:19], s57 offen offset:0 sc1
  ds_read_b128 v[80:83], v10 offset:9216
  v_mfma_f32_16x16x32_bf16 v[164:167], v[144:147], a[152:155], v[164:167]
  v_mfma_f32_16x16x32_bf16 v[160:163], v[124:127], a[156:159], v[160:163]
  ds_read_b128 v[104:107], v10 offset:10240
  v_mfma_f32_16x16x32_bf16 v[164:167], v[148:151], a[156:159], v[164:167]
  v_mfma_f32_16x16x32_bf16 v[160:163], v[128:131], a[160:163], v[160:163]
  ds_read2st64_b64 v[84:87], v11 offset0:12 offset1:18
  v_mfma_f32_16x16x32_bf16 v[164:167], v[152:155], a[160:163], v[164:167]
  s_add_u32 s55, s62, 32768
  v_mfma_f32_16x16x32_bf16 v[160:163], v[132:135], a[164:167], v[160:163]
  buffer_store_dwordx4 v[204:207], v4, s[16:19], s55 offen sc1
  ds_read2st64_b64 v[108:111], v12 offset0:12 offset1:18
  v_mfma_f32_16x16x32_bf16 v[164:167], v[156:159], a[164:167], v[164:167]
  v_mfma_f32_16x16x32_bf16 v[168:171], v[112:115], a[168:171], 0
  v_mfma_f32_16x16x32_bf16 v[172:175], v[136:139], a[168:171], 0
  v_mfma_f32_16x16x32_bf16 v[168:171], v[116:119], a[172:175], v[168:171]
  v_cvt_pk_bf16_f32 v192, v160, v161
  v_cvt_pk_bf16_f32 v193, v162, v163
  v_mfma_f32_16x16x32_bf16 v[172:175], v[140:143], a[172:175], v[172:175]
  v_cvt_pk_bf16_f32 v194, v164, v165
  v_cvt_pk_bf16_f32 v195, v166, v167
  v_mfma_f32_16x16x32_bf16 v[168:171], v[120:123], a[176:179], v[168:171]
  buffer_store_dwordx4 v[192:195], v4, s[16:19], s57 offen offset:1024 sc1
  v_mfma_f32_16x16x32_bf16 v[172:175], v[144:147], a[176:179], v[172:175]
  v_mfma_f32_16x16x32_bf16 v[168:171], v[124:127], a[180:183], v[168:171]
  v_mfma_f32_16x16x32_bf16 v[172:175], v[148:151], a[180:183], v[172:175]
  v_mfma_f32_16x16x32_bf16 v[168:171], v[128:131], a[184:187], v[168:171]
  v_mfma_f32_16x16x32_bf16 v[172:175], v[152:155], a[184:187], v[172:175]
  buffer_load_dwordx4 v4, s[16:19], s53 offen offset:1024 sc1 lds
  v_mfma_f32_16x16x32_bf16 v[168:171], v[132:135], a[188:191], v[168:171]
  v_mfma_f32_16x16x32_bf16 v[172:175], v[156:159], a[188:191], v[172:175]
  v_mfma_f32_16x16x32_bf16 v[176:179], v[112:115], a[192:195], 0
  v_mfma_f32_16x16x32_bf16 v[180:183], v[136:139], a[192:195], 0
  v_mfma_f32_16x16x32_bf16 v[176:179], v[116:119], a[196:199], v[176:179]
  v_cvt_pk_bf16_f32 v196, v168, v169
  v_cvt_pk_bf16_f32 v197, v170, v171
  v_mfma_f32_16x16x32_bf16 v[180:183], v[140:143], a[196:199], v[180:183]
  v_cvt_pk_bf16_f32 v198, v172, v173
  v_cvt_pk_bf16_f32 v199, v174, v175
  v_mfma_f32_16x16x32_bf16 v[176:179], v[120:123], a[200:203], v[176:179]
  buffer_store_dwordx4 v[196:199], v4, s[16:19], s58 offen offset:1024 sc1
  v_mfma_f32_16x16x32_bf16 v[180:183], v[144:147], a[200:203], v[180:183]
  v_mfma_f32_16x16x32_bf16 v[176:179], v[124:127], a[204:207], v[176:179]
  s_add_u32 s56, s56, 2097152
  s_xor_b32 s56, s56, 8192
  s_add_u32 s59, s58, 524288
  v_mfma_f32_16x16x32_bf16 v[180:183], v[148:151], a[204:207], v[180:183]
  s_xor_b32 s58, s58, s59
  s_lshr_b32 s58, s58, 8
  s_and_b32 s58, s58, 8192
  v_mfma_f32_16x16x32_bf16 v[176:179], v[128:131], a[208:211], v[176:179]
  s_xor_b32 s58, s58, s59
  v_mfma_f32_16x16x32_bf16 v[180:183], v[152:155], a[208:211], v[180:183]
  buffer_load_dwordx4 v4, s[16:19], s53 offen offset:2048 sc1 lds
  s_add_u32 s41, s41, 2097152
  v_mfma_f32_16x16x32_bf16 v[176:179], v[132:135], a[212:215], v[176:179]
  s_xor_b32 s41, s41, 8192
  s_add_u32 s48, s48, 1
  s_xor_b32 s52, s52, 32768
  v_mfma_f32_16x16x32_bf16 v[180:183], v[156:159], a[212:215], v[180:183]
  v_mfma_f32_16x16x32_bf16 v[184:187], v[112:115], a[216:219], 0
  v_mfma_f32_16x16x32_bf16 v[188:191], v[136:139], a[216:219], 0
  v_mfma_f32_16x16x32_bf16 v[184:187], v[116:119], a[220:223], v[184:187]
  v_cvt_pk_bf16_f32 v200, v176, v177
  v_cvt_pk_bf16_f32 v201, v178, v179
  v_mfma_f32_16x16x32_bf16 v[188:191], v[140:143], a[220:223], v[188:191]
  v_cvt_pk_bf16_f32 v202, v180, v181
  v_cvt_pk_bf16_f32 v203, v182, v183
  v_mfma_f32_16x16x32_bf16 v[184:187], v[120:123], a[224:227], v[184:187]
  buffer_store_dwordx4 v[200:203], v4, s[16:19], s57 offen offset:2048 sc1
  v_mfma_f32_16x16x32_bf16 v[188:191], v[144:147], a[224:227], v[188:191]
  v_mfma_f32_16x16x32_bf16 v[184:187], v[124:127], a[228:231], v[184:187]
  s_mov_b32 s51, s57
  s_add_u32 s57, s56, 4096
  s_add_u32 s45, s45, 1
  v_mfma_f32_16x16x32_bf16 v[188:191], v[148:151], a[228:231], v[188:191]
  s_add_u32 s55, s62, 49152
  v_mfma_f32_16x16x32_bf16 v[184:187], v[128:131], a[232:235], v[184:187]
  buffer_store_dwordx4 v[200:203], v4, s[16:19], s55 offen sc1
  v_mfma_f32_16x16x32_bf16 v[188:191], v[152:155], a[232:235], v[188:191]
  v_mfma_f32_16x16x32_bf16 v[184:187], v[132:135], a[236:239], v[184:187]
  s_cmp_lt_u32 s45, s46
  v_mfma_f32_16x16x32_bf16 v[188:191], v[156:159], a[236:239], v[188:191]
  s_waitcnt lgkmcnt(0)
  s_cbranch_scc1 vwl_251
  s_nop 7
  v_cvt_pk_bf16_f32 v204, v184, v185
  v_cvt_pk_bf16_f32 v205, v186, v187
  v_cvt_pk_bf16_f32 v206, v188, v189
  v_cvt_pk_bf16_f32 v207, v190, v191
  buffer_store_dwordx4 v[204:207], v4, s[16:19], s51 offen offset:3072 sc1
  s_min_u32 s21, s45, 56
  v_mov_b32 v16, s21
  s_barrier
  s_mov_b32 s46, s42
  s_cmp_gt_u32 s42, s45
  s_cbranch_scc1 vwr_250
  s_cmp_lt_u32 s45, 64
  s_cbranch_scc1 vwr_245
  v_mov_b32 v244, -1
  v_mov_b32 v245, -1
  v_mov_b32 v246, -1
  v_mov_b32 v247, -1
  v_lshlrev_b32 v21, 3, v1
  s_lshr_b32 s21, s2, 2
  s_lshl_b32 s21, s21, 2
  s_add_u32 s21, s21, s20
  s_lshl_b32 s21, s21, 2
  s_and_b32 s22, s2, 3
  s_add_u32 s21, s21, s22
  s_lshl_b32 s21, s21, 14
  s_xor_b32 s22, s21, s80
  s_xor_b32 s21, s22, 125833216
  buffer_store_dwordx4 v[244:247], v4, s[16:19], s21 offen offset:0 sc1
  buffer_store_dwordx4 v[244:247], v4, s[16:19], s21 offen offset:1024 sc1
  buffer_store_dwordx4 v[244:247], v4, s[16:19], s21 offen offset:2048 sc1
  buffer_store_dwordx4 v[244:247], v4, s[16:19], s21 offen offset:3072 sc1
  s_xor_b32 s21, s22, 127938560
  buffer_store_dwordx4 v[244:247], v4, s[16:19], s21 offen offset:0 sc1
  buffer_store_dwordx4 v[244:247], v4, s[16:19], s21 offen offset:1024 sc1
  buffer_store_dwordx4 v[244:247], v4, s[16:19], s21 offen offset:2048 sc1
  buffer_store_dwordx4 v[244:247], v4, s[16:19], s21 offen offset:3072 sc1
  s_xor_b32 s21, s22, 130027520
  buffer_store_dwordx4 v[244:247], v4, s[16:19], s21 offen offset:0 sc1
  buffer_store_dwordx4 v[244:247], v4, s[16:19], s21 offen offset:1024 sc1
  buffer_store_dwordx4 v[244:247], v4, s[16:19], s21 offen offset:2048 sc1
  buffer_store_dwordx4 v[244:247], v4, s[16:19], s21 offen offset:3072 sc1
  s_xor_b32 s21, s22, 132132864
  buffer_store_dwordx4 v[244:247], v4, s[16:19], s21 offen offset:0 sc1
  buffer_store_dwordx4 v[244:247], v4, s[16:19], s21 offen offset:1024 sc1
  buffer_store_dwordx4 v[244:247], v4, s[16:19], s21 offen offset:2048 sc1
  buffer_store_dwordx4 v[244:247], v4, s[16:19], s21 offen offset:3072 sc1
  s_and_b32 s21, s2, 3
  s_cmp_lg_u32 s21, s20
  s_cbranch_scc1 arm_252
  s_lshr_b32 s21, s2, 1
  s_lshl_b32 s21, s21, 14
  s_and_b32 s22, s2, 1
  s_mul_i32 s22, s22, 2560
  s_add_u32 s21, s21, s22
  s_xor_b32 s22, s21, s80
  s_xor_b32 s21, s22, 216006656
  buffer_store_dwordx4 v[244:247], v4, s[16:19], s21 offen sc1
  buffer_store_dwordx4 v[244:247], v4, s[16:19], s21 offen offset:1024 sc1
  buffer_store_dwordx2 v[244:245], v21, s[16:19], s21 offen offset:2048 sc1
  s_xor_b32 s21, s22, 216530944
  buffer_store_dwordx4 v[244:247], v4, s[16:19], s21 offen sc1
  buffer_store_dwordx4 v[244:247], v4, s[16:19], s21 offen offset:1024 sc1
  buffer_store_dwordx2 v[244:245], v21, s[16:19], s21 offen offset:2048 sc1
  s_xor_b32 s21, s22, 217055232
  buffer_store_dwordx4 v[244:247], v4, s[16:19], s21 offen sc1
  buffer_store_dwordx4 v[244:247], v4, s[16:19], s21 offen offset:1024 sc1
  buffer_store_dwordx2 v[244:245], v21, s[16:19], s21 offen offset:2048 sc1
  s_xor_b32 s21, s22, 217579520
  buffer_store_dwordx4 v[244:247], v4, s[16:19], s21 offen sc1
  buffer_store_dwordx4 v[244:247], v4, s[16:19], s21 offen offset:1024 sc1
  buffer_store_dwordx2 v[244:245], v21, s[16:19], s21 offen offset:2048 sc1
arm_252:
  v_mov_b32 v16, 64
  s_waitcnt vmcnt(0)
  buffer_store_dword v16, v17, s[72:75], s44 offen sc1
  s_branch queue
not_vw:
  s_sub_u32 s2, s3, 96
  s_cmp_lg_u32 s2, 31
  s_cbranch_scc1 not_cal
  s_load_dwordx2 s[72:73], s[0:1], 104
  s_waitcnt lgkmcnt(0)
  s_add_u32 s72, s72, 173080576
  s_addc_u32 s73, s73, 0
  s_mov_b32 s74, 49152
  s_mov_b32 s75, 0x00020000
  v_lshlrev_b32 v8, 4, v0
  v_mov_b32 v4, 0
  v_mov_b32 v5, 0
  v_mov_b32 v6, 0
  v_mov_b32 v7, 0
  s_mov_b32 s21, 0
  buffer_store_dwordx4 v[4:7], v8, s[72:75], s21 offen sc1
  s_mov_b32 s21, 4096
  buffer_store_dwordx4 v[4:7], v8, s[72:75], s21 offen sc1
  s_mov_b32 s21, 8192
  buffer_store_dwordx4 v[4:7], v8, s[72:75], s21 offen sc1
  s_mov_b32 s21, 12288
  buffer_store_dwordx4 v[4:7], v8, s[72:75], s21 offen sc1
  s_mov_b32 s21, 16384
  buffer_store_dwordx4 v[4:7], v8, s[72:75], s21 offen sc1
  s_mov_b32 s21, 20480
  buffer_store_dwordx4 v[4:7], v8, s[72:75], s21 offen sc1
  s_mov_b32 s21, 24576
  buffer_store_dwordx4 v[4:7], v8, s[72:75], s21 offen sc1
  s_mov_b32 s21, 28672
  buffer_store_dwordx4 v[4:7], v8, s[72:75], s21 offen sc1
  s_mov_b32 s21, 32768
  buffer_store_dwordx4 v[4:7], v8, s[72:75], s21 offen sc1
  s_mov_b32 s21, 36864
  buffer_store_dwordx4 v[4:7], v8, s[72:75], s21 offen sc1
  s_mov_b32 s21, 40960
  buffer_store_dwordx4 v[4:7], v8, s[72:75], s21 offen sc1
  s_mov_b32 s21, 45056
  buffer_store_dwordx4 v[4:7], v8, s[72:75], s21 offen sc1
  s_add_u32 s8, s38, 173015040
  s_addc_u32 s9, s39, 0
  s_mov_b32 s10, 131072
  s_mov_b32 s11, 0x00020000
  s_cmp_lg_u32 s20, 0
  s_cbranch_scc1 cal_253
  s_mov_b32 s40, -1
  s_mov_b32 s41, -1
  s_mov_b32 s43, 0
cal_254:
  s_mov_b32 s21, 0
  s_memtime s[98:99]
  s_waitcnt lgkmcnt(0)
  s_buffer_load_dword s22, s[8:11], s21 glc
  s_waitcnt lgkmcnt(0)
  s_memtime s[100:101]
  s_waitcnt lgkmcnt(0)
  s_sub_u32 s21, s100, s98
  s_min_u32 s40, s40, s21
  s_mov_b32 s21, 8192
  s_memtime s[98:99]
  s_waitcnt lgkmcnt(0)
  s_buffer_load_dword s22, s[8:11], s21 glc
  s_waitcnt lgkmcnt(0)
  s_memtime s[100:101]
  s_waitcnt lgkmcnt(0)
  s_sub_u32 s21, s100, s98
  s_min_u32 s41, s41, s21
  s_add_u32 s43, s43, 1
  s_cmp_lt_u32 s43, 6
  s_cbranch_scc1 cal_254
cal_253:
  s_waitcnt vmcnt(0)
  s_barrier
  s_cmp_lg_u32 s20, 0
  s_cbranch_scc1 cal_255
  s_cmp_lt_u32 s41, s40
  s_cselect_b32 s21, 1, 2
  v_mov_b32 v4, s21
  v_mov_b32 v5, s40
  v_mov_b32 v6, s41
  v_mov_b32 v8, 76
  s_mov_b64 exec, 1
  buffer_store_dwordx3 v[4:6], v8, s[32:35], 0 offen sc1
  s_mov_b64 exec, -1
cal_255:
not_cal:
  s_load_dwordx2 s[4:5], s[0:1], 0
  s_load_dwordx2 s[6:7], s[0:1], 64
  s_load_dwordx2 s[38:39], s[0:1], 104
  s_lshr_b32 s41, s2, 3
  s_lshl_b32 s41, s41, 1
  s_and_b32 s21, s2, 1
  s_add_u32 s41, s41, s21
  s_bfe_u32 s42, s2, 0x20001
  s_waitcnt lgkmcnt(0)
  s_mov_b32 s8, s4
  s_mov_b32 s9, s5
  s_mov_b32 s10, 2621440
  s_mov_b32 s11, 0x00020000
  s_mov_b32 s12, s6
  s_mov_b32 s13, s7
  s_mov_b32 s14, 2457600
  s_mov_b32 s15, 0x00020000
  s_mov_b32 s16, s38
  s_mov_b32 s17, s39
  s_mov_b32 s18, 218103808
  s_mov_b32 s19, 0x00020000
  s_add_u32 s72, s38, 173080576
  s_addc_u32 s73, s39, 0
  s_mov_b32 s74, 49152
  s_mov_b32 s75, 0x00020000
  s_getpc_b64 s[22:23]
gpf_base:
  s_sub_u32 s22, s22, gpf_base-gemm_side
  s_subb_u32 s23, s23, 0
  s_and_b32 s21, s2, 7
  s_lshl_b32 s21, s21, 15
  v_lshl_add_u32 v32, v0, 7, s21
  v_mov_b32 v33, main_end-gemm_side
  v_min_u32 v32, v32, v33
  v_mov_b32 v33, s23
  v_add_co_u32 v32, vcc, s22, v32
  s_nop 1
  v_addc_co_u32 v33, vcc, 0, v33, vcc
  global_load_dword v34, v[32:33], off
  v_lshrrev_b32 v8, 5, v1
  v_or_b32 v9, 0, v8
  v_and_b32 v10, 31, v1
  v_lshlrev_b32 v9, 1, v9
  v_xor_b32 v10, v10, v9
  v_mul_u32_u24 v9, 6554, v10
  v_lshrrev_b32 v9, 16, v9
  v_mul_u32_u24 v11, 1120, v9
  v_lshl_add_u32 v11, v10, 4, v11
  v_mul_u32_u24 v8, 3840, v8
  v_add_u32 v11, v11, v8
  v_mov_b32 v9, 1073741824
  v_cmp_gt_u32 vcc, 30, v10
  s_nop 1
  v_cndmask_b32 v4, v9, v11, vcc
  v_lshrrev_b32 v8, 5, v1
  v_or_b32 v9, 2, v8
  v_and_b32 v10, 31, v1
  v_lshlrev_b32 v9, 1, v9
  v_xor_b32 v10, v10, v9
  v_mul_u32_u24 v9, 6554, v10
  v_lshrrev_b32 v9, 16, v9
  v_mul_u32_u24 v11, 1120, v9
  v_lshl_add_u32 v11, v10, 4, v11
  v_mul_u32_u24 v8, 3840, v8
  v_add_u32 v11, v11, v8
  v_mov_b32 v9, 1073741824
  v_cmp_gt_u32 vcc, 30, v10
  s_nop 1
  v_cndmask_b32 v5, v9, v11, vcc
  v_lshrrev_b32 v8, 5, v1
  v_or_b32 v9, 4, v8
  v_and_b32 v10, 31, v1
  v_lshlrev_b32 v9, 1, v9
  v_xor_b32 v10, v10, v9
  v_mul_u32_u24 v9, 6554, v10
  v_lshrrev_b32 v9, 16, v9
  v_mul_u32_u24 v11, 1120, v9
  v_lshl_add_u32 v11, v10, 4, v11
  v_mul_u32_u24 v8, 3840, v8
  v_add_u32 v11, v11, v8
  v_mov_b32 v9, 1073741824
  v_cmp_gt_u32 vcc, 30, v10
  s_nop 1
  v_cndmask_b32 v6, v9, v11, vcc
  v_lshrrev_b32 v8, 5, v1
  v_or_b32 v9, 6, v8
  v_and_b32 v10, 31, v1
  v_lshlrev_b32 v9, 1, v9
  v_xor_b32 v10, v10, v9
  v_mul_u32_u24 v9, 6554, v10
  v_lshrrev_b32 v9, 16, v9
  v_mul_u32_u24 v11, 1120, v9
  v_lshl_add_u32 v11, v10, 4, v11
  v_mul_u32_u24 v8, 3840, v8
  v_add_u32 v11, v11, v8
  v_mov_b32 v9, 1073741824
  v_cmp_gt_u32 vcc, 30, v10
  s_nop 1
  v_cndmask_b32 v7, v9, v11, vcc
  s_mul_i32 s44, s41, 160
  s_mul_i32 s21, s20, 122880
  s_add_u32 s44, s44, s21
  s_lshl_b32 s45, s20, 14
  s_add_u32 s21, s44, 0
  s_add_u32 m0, s45, 0
  s_nop 0
  buffer_load_dwordx4 v4, s[12:15], s21 offen lds
  s_add_u32 s21, s44, 7680
  s_add_u32 m0, s45, 1024
  s_nop 0
  buffer_load_dwordx4 v5, s[12:15], s21 offen lds
  s_add_u32 s21, s44, 15360
  s_add_u32 m0, s45, 2048
  s_nop 0
  buffer_load_dwordx4 v4, s[12:15], s21 offen lds
  s_add_u32 s21, s44, 23040
  s_add_u32 m0, s45, 3072
  s_nop 0
  buffer_load_dwordx4 v5, s[12:15], s21 offen lds
  s_add_u32 s21, s44, 30720
  s_add_u32 m0, s45, 4096
  s_nop 0
  buffer_load_dwordx4 v6, s[12:15], s21 offen lds
  s_add_u32 s21, s44, 38400
  s_add_u32 m0, s45, 5120
  s_nop 0
  buffer_load_dwordx4 v7, s[12:15], s21 offen lds
  s_add_u32 s21, s44, 46080
  s_add_u32 m0, s45, 6144
  s_nop 0
  buffer_load_dwordx4 v6, s[12:15], s21 offen lds
  s_add_u32 s21, s44, 53760
  s_add_u32 m0, s45, 7168
  s_nop 0
  buffer_load_dwordx4 v7, s[12:15], s21 offen lds
  s_add_u32 s21, s44, 61440
  s_add_u32 m0, s45, 8192
  s_nop 0
  buffer_load_dwordx4 v4, s[12:15], s21 offen lds
  s_add_u32 s21, s44, 69120
  s_add_u32 m0, s45, 9216
  s_nop 0
  buffer_load_dwordx4 v5, s[12:15], s21 offen lds
  s_add_u32 s21, s44, 76800
  s_add_u32 m0, s45, 10240
  s_nop 0
  buffer_load_dwordx4 v4, s[12:15], s21 offen lds
  s_add_u32 s21, s44, 84480
  s_add_u32 m0, s45, 11264
  s_nop 0
  buffer_load_dwordx4 v5, s[12:15], s21 offen lds
  s_add_u32 s21, s44, 92160
  s_add_u32 m0, s45, 12288
  s_nop 0
  buffer_load_dwordx4 v6, s[12:15], s21 offen lds
  s_add_u32 s21, s44, 99840
  s_add_u32 m0, s45, 13312
  s_nop 0
  buffer_load_dwordx4 v7, s[12:15], s21 offen lds
  s_add_u32 s21, s44, 107520
  s_add_u32 m0, s45, 14336
  s_nop 0
  buffer_load_dwordx4 v6, s[12:15], s21 offen lds
  s_add_u32 s21, s44, 115200
  s_add_u32 m0, s45, 15360
  s_nop 0
  buffer_load_dwordx4 v7, s[12:15], s21 offen lds
  s_add_u32 s21, s44, 491520
  s_add_u32 m0, s45, 65536
  s_nop 0
  buffer_load_dwordx4 v4, s[12:15], s21 offen lds
  s_add_u32 s21, s44, 499200
  s_add_u32 m0, s45, 66560
  s_nop 0
  buffer_load_dwordx4 v5, s[12:15], s21 offen lds
  s_add_u32 s21, s44, 506880
  s_add_u32 m0, s45, 67584
  s_nop 0
  buffer_load_dwordx4 v4, s[12:15], s21 offen lds
  s_add_u32 s21, s44, 514560
  s_add_u32 m0, s45, 68608
  s_nop 0
  buffer_load_dwordx4 v5, s[12:15], s21 offen lds
  s_add_u32 s21, s44, 522240
  s_add_u32 m0, s45, 69632
  s_nop 0
  buffer_load_dwordx4 v6, s[12:15], s21 offen lds
  s_add_u32 s21, s44, 529920
  s_add_u32 m0, s45, 70656
  s_nop 0
  buffer_load_dwordx4 v7, s[12:15], s21 offen lds
  s_add_u32 s21, s44, 537600
  s_add_u32 m0, s45, 71680
  s_nop 0
  buffer_load_dwordx4 v6, s[12:15], s21 offen lds
  s_add_u32 s21, s44, 545280
  s_add_u32 m0, s45, 72704
  s_nop 0
  buffer_load_dwordx4 v7, s[12:15], s21 offen lds
  s_add_u32 s21, s44, 552960
  s_add_u32 m0, s45, 73728
  s_nop 0
  buffer_load_dwordx4 v4, s[12:15], s21 offen lds
  s_add_u32 s21, s44, 560640
  s_add_u32 m0, s45, 74752
  s_nop 0
  buffer_load_dwordx4 v5, s[12:15], s21 offen lds
  s_add_u32 s21, s44, 568320
  s_add_u32 m0, s45, 75776
  s_nop 0
  buffer_load_dwordx4 v4, s[12:15], s21 offen lds
  s_add_u32 s21, s44, 576000
  s_add_u32 m0, s45, 76800
  s_nop 0
  buffer_load_dwordx4 v5, s[12:15], s21 offen lds
  s_add_u32 s21, s44, 583680
  s_add_u32 m0, s45, 77824
  s_nop 0
  buffer_load_dwordx4 v6, s[12:15], s21 offen lds
  s_add_u32 s21, s44, 591360
  s_add_u32 m0, s45, 78848
  s_nop 0
  buffer_load_dwordx4 v7, s[12:15], s21 offen lds
  s_add_u32 s21, s44, 599040
  s_add_u32 m0, s45, 79872
  s_nop 0
  buffer_load_dwordx4 v6, s[12:15], s21 offen lds
  s_add_u32 s21, s44, 606720
  s_add_u32 m0, s45, 80896
  s_nop 0
  buffer_load_dwordx4 v7, s[12:15], s21 offen lds
  s_add_u32 s21, s44, 983040
  buffer_load_dwordx4 v[64:67], v4, s[12:15], s21 offen
  s_add_u32 s21, s44, 990720
  buffer_load_dwordx4 v[68:71], v5, s[12:15], s21 offen
  s_add_u32 s21, s44, 998400
  buffer_load_dwordx4 v[72:75], v4, s[12:15], s21 offen
  s_add_u32 s21, s44, 1006080
  buffer_load_dwordx4 v[76:79], v5, s[12:15], s21 offen
  s_add_u32 s21, s44, 1013760
  buffer_load_dwordx4 v[80:83], v6, s[12:15], s21 offen
  s_add_u32 s21, s44, 1021440
  buffer_load_dwordx4 v[84:87], v7, s[12:15], s21 offen
  s_add_u32 s21, s44, 1029120
  buffer_load_dwordx4 v[88:91], v6, s[12:15], s21 offen
  s_add_u32 s21, s44, 1036800
  buffer_load_dwordx4 v[92:95], v7, s[12:15], s21 offen
  s_add_u32 s21, s44, 1044480
  buffer_load_dwordx4 v[96:99], v4, s[12:15], s21 offen
  s_add_u32 s21, s44, 1052160
  buffer_load_dwordx4 v[100:103], v5, s[12:15], s21 offen
  s_add_u32 s21, s44, 1059840
  buffer_load_dwordx4 v[104:107], v4, s[12:15], s21 offen
  s_add_u32 s21, s44, 1067520
  buffer_load_dwordx4 v[108:111], v5, s[12:15], s21 offen
  s_add_u32 s21, s44, 1075200
  buffer_load_dwordx4 v[112:115], v6, s[12:15], s21 offen
  s_add_u32 s21, s44, 1082880
  buffer_load_dwordx4 v[116:119], v7, s[12:15], s21 offen
  s_add_u32 s21, s44, 1090560
  buffer_load_dwordx4 v[120:123], v6, s[12:15], s21 offen
  s_add_u32 s21, s44, 1098240
  buffer_load_dwordx4 v[124:127], v7, s[12:15], s21 offen
  v_lshrrev_b32 v8, 2, v2
  v_and_b32 v9, 1, v3
  v_lshl_add_u32 v9, v9, 2, v8
  v_lshlrev_b32 v9, 5, v9
  v_lshl_add_u32 v8, v3, 3, v8
  v_lshlrev_b32 v8, 9, v8
  v_and_b32 v10, 3, v2
  s_mul_i32 s21, s20, 40
  v_lshl_add_u32 v11, v10, 3, s21
  v_add_u32 v11, 0, v11
  v_xor_b32 v11, v11, v9
  v_add_u32 v12, v11, v8
  v_add_u32 v16, 65536, v12
  v_lshl_add_u32 v11, v10, 3, s21
  v_add_u32 v11, 160, v11
  v_xor_b32 v11, v11, v9
  v_add_u32 v13, v11, v8
  v_add_u32 v17, 65536, v13
  v_mul_u32_u24 v11, 160, v10
  v_add3_u32 v11, v11, 32, s21
  v_min_u32 v11, 480, v11
  v_xor_b32 v11, v11, v9
  v_add_u32 v14, v11, v8
  v_add_u32 v18, 65536, v14
  v_lshl_add_u32 v11, v10, 3, s21
  v_add_u32 v11, 320, v11
  v_xor_b32 v11, v11, v9
  v_add_u32 v15, v11, v8
  v_add_u32 v19, 65536, v15
  v_lshl_add_u32 v23, v1, 4, s45
  v_add_u32 v29, 65536, v23
  s_waitcnt vmcnt(32)
  s_add_u32 s21, s44, 1474560
  buffer_load_dwordx4 v[128:131], v4, s[12:15], s21 offen
  s_add_u32 s21, s44, 1482240
  buffer_load_dwordx4 v[132:135], v5, s[12:15], s21 offen
  s_add_u32 s21, s44, 1489920
  buffer_load_dwordx4 v[136:139], v4, s[12:15], s21 offen
  s_add_u32 s21, s44, 1497600
  buffer_load_dwordx4 v[140:143], v5, s[12:15], s21 offen
  s_add_u32 s21, s44, 1505280
  buffer_load_dwordx4 v[144:147], v6, s[12:15], s21 offen
  s_add_u32 s21, s44, 1512960
  buffer_load_dwordx4 v[148:151], v7, s[12:15], s21 offen
  s_add_u32 s21, s44, 1520640
  buffer_load_dwordx4 v[152:155], v6, s[12:15], s21 offen
  s_add_u32 s21, s44, 1528320
  buffer_load_dwordx4 v[156:159], v7, s[12:15], s21 offen
  s_add_u32 s21, s44, 1536000
  buffer_load_dwordx4 v[160:163], v4, s[12:15], s21 offen
  s_add_u32 s21, s44, 1543680
  buffer_load_dwordx4 v[164:167], v5, s[12:15], s21 offen
  s_add_u32 s21, s44, 1551360
  buffer_load_dwordx4 v[168:171], v4, s[12:15], s21 offen
  s_add_u32 s21, s44, 1559040
  buffer_load_dwordx4 v[172:175], v5, s[12:15], s21 offen
  s_add_u32 s21, s44, 1566720
  buffer_load_dwordx4 v[176:179], v6, s[12:15], s21 offen
  s_add_u32 s21, s44, 1574400
  buffer_load_dwordx4 v[180:183], v7, s[12:15], s21 offen
  s_add_u32 s21, s44, 1582080
  buffer_load_dwordx4 v[184:187], v6, s[12:15], s21 offen
  s_add_u32 s21, s44, 1589760
  buffer_load_dwordx4 v[188:191], v7, s[12:15], s21 offen
  s_barrier
  ds_read_b64_tr_b16 a[0:1], v12 offset:0
  ds_read_b64_tr_b16 a[2:3], v12 offset:2048
  ds_read_b64_tr_b16 a[4:5], v13 offset:0
  ds_read_b64_tr_b16 a[6:7], v13 offset:2048
  ds_read_b64_tr_b16 a[8:9], v14 offset:0
  ds_read_b64_tr_b16 a[10:11], v14 offset:2048
  ds_read_b64_tr_b16 a[12:13], v15 offset:0
  ds_read_b64_tr_b16 a[14:15], v15 offset:2048
  ds_read_b64_tr_b16 a[16:17], v12 offset:16384
  ds_read_b64_tr_b16 a[18:19], v12 offset:18432
  ds_read_b64_tr_b16 a[20:21], v13 offset:16384
  ds_read_b64_tr_b16 a[22:23], v13 offset:18432
  ds_read_b64_tr_b16 a[24:25], v14 offset:16384
  ds_read_b64_tr_b16 a[26:27], v14 offset:18432
  ds_read_b64_tr_b16 a[28:29], v15 offset:16384
  ds_read_b64_tr_b16 a[30:31], v15 offset:18432
  ds_read_b64_tr_b16 a[32:33], v12 offset:32768
  ds_read_b64_tr_b16 a[34:35], v12 offset:34816
  ds_read_b64_tr_b16 a[36:37], v13 offset:32768
  ds_read_b64_tr_b16 a[38:39], v13 offset:34816
  ds_read_b64_tr_b16 a[40:41], v14 offset:32768
  ds_read_b64_tr_b16 a[42:43], v14 offset:34816
  ds_read_b64_tr_b16 a[44:45], v15 offset:32768
  ds_read_b64_tr_b16 a[46:47], v15 offset:34816
  ds_read_b64_tr_b16 a[48:49], v12 offset:49152
  ds_read_b64_tr_b16 a[50:51], v12 offset:51200
  ds_read_b64_tr_b16 a[52:53], v13 offset:49152
  ds_read_b64_tr_b16 a[54:55], v13 offset:51200
  ds_read_b64_tr_b16 a[56:57], v14 offset:49152
  ds_read_b64_tr_b16 a[58:59], v14 offset:51200
  ds_read_b64_tr_b16 a[60:61], v15 offset:49152
  ds_read_b64_tr_b16 a[62:63], v15 offset:51200
  s_waitcnt lgkmcnt(0)
  s_barrier
  s_waitcnt vmcnt(32)
  s_add_u32 s21, s44, 1966080
  buffer_load_dwordx4 v[192:195], v4, s[12:15], s21 offen
  s_add_u32 s21, s44, 1973760
  buffer_load_dwordx4 v[196:199], v5, s[12:15], s21 offen
  s_add_u32 s21, s44, 1981440
  buffer_load_dwordx4 v[200:203], v4, s[12:15], s21 offen
  s_add_u32 s21, s44, 1989120
  buffer_load_dwordx4 v[204:207], v5, s[12:15], s21 offen
  s_add_u32 s21, s44, 1996800
  buffer_load_dwordx4 v[208:211], v6, s[12:15], s21 offen
  s_add_u32 s21, s44, 2004480
  buffer_load_dwordx4 v[212:215], v7, s[12:15], s21 offen
  s_add_u32 s21, s44, 2012160
  buffer_load_dwordx4 v[216:219], v6, s[12:15], s21 offen
  s_add_u32 s21, s44, 2019840
  buffer_load_dwordx4 v[220:223], v7, s[12:15], s21 offen
  s_add_u32 s21, s44, 2027520
  buffer_load_dwordx4 v[224:227], v4, s[12:15], s21 offen
  s_add_u32 s21, s44, 2035200
  buffer_load_dwordx4 v[228:231], v5, s[12:15], s21 offen
  s_add_u32 s21, s44, 2042880
  buffer_load_dwordx4 v[232:235], v4, s[12:15], s21 offen
  s_add_u32 s21, s44, 2050560
  buffer_load_dwordx4 v[236:239], v5, s[12:15], s21 offen
  s_add_u32 s21, s44, 2058240
  buffer_load_dwordx4 v[240:243], v6, s[12:15], s21 offen
  s_add_u32 s21, s44, 2065920
  buffer_load_dwordx4 v[244:247], v7, s[12:15], s21 offen
  s_add_u32 s21, s44, 2073600
  buffer_load_dwordx4 v[248:251], v6, s[12:15], s21 offen
  s_add_u32 s21, s44, 2081280
  buffer_load_dwordx4 v[252:255], v7, s[12:15], s21 offen
  s_barrier
  ds_read_b64_tr_b16 a[64:65], v16 offset:0
  ds_read_b64_tr_b16 a[66:67], v16 offset:2048
  ds_read_b64_tr_b16 a[68:69], v17 offset:0
  ds_read_b64_tr_b16 a[70:71], v17 offset:2048
  ds_read_b64_tr_b16 a[72:73], v18 offset:0
  ds_read_b64_tr_b16 a[74:75], v18 offset:2048
  ds_read_b64_tr_b16 a[76:77], v19 offset:0
  ds_read_b64_tr_b16 a[78:79], v19 offset:2048
  ds_read_b64_tr_b16 a[80:81], v16 offset:16384
  ds_read_b64_tr_b16 a[82:83], v16 offset:18432
  ds_read_b64_tr_b16 a[84:85], v17 offset:16384
  ds_read_b64_tr_b16 a[86:87], v17 offset:18432
  ds_read_b64_tr_b16 a[88:89], v18 offset:16384
  ds_read_b64_tr_b16 a[90:91], v18 offset:18432
  ds_read_b64_tr_b16 a[92:93], v19 offset:16384
  ds_read_b64_tr_b16 a[94:95], v19 offset:18432
  ds_read_b64_tr_b16 a[96:97], v16 offset:32768
  ds_read_b64_tr_b16 a[98:99], v16 offset:34816
  ds_read_b64_tr_b16 a[100:101], v17 offset:32768
  ds_read_b64_tr_b16 a[102:103], v17 offset:34816
  ds_read_b64_tr_b16 a[104:105], v18 offset:32768
  ds_read_b64_tr_b16 a[106:107], v18 offset:34816
  ds_read_b64_tr_b16 a[108:109], v19 offset:32768
  ds_read_b64_tr_b16 a[110:111], v19 offset:34816
  ds_read_b64_tr_b16 a[112:113], v16 offset:49152
  ds_read_b64_tr_b16 a[114:115], v16 offset:51200
  ds_read_b64_tr_b16 a[116:117], v17 offset:49152
  ds_read_b64_tr_b16 a[118:119], v17 offset:51200
  ds_read_b64_tr_b16 a[120:121], v18 offset:49152
  ds_read_b64_tr_b16 a[122:123], v18 offset:51200
  ds_read_b64_tr_b16 a[124:125], v19 offset:49152
  ds_read_b64_tr_b16 a[126:127], v19 offset:51200
  s_waitcnt lgkmcnt(0)
  s_barrier
  s_waitcnt vmcnt(32)
  ds_write_b128 v23, v[64:67] offset:0
  ds_write_b128 v23, v[68:71] offset:1024
  ds_write_b128 v23, v[72:75] offset:2048
  ds_write_b128 v23, v[76:79] offset:3072
  ds_write_b128 v23, v[80:83] offset:4096
  ds_write_b128 v23, v[84:87] offset:5120
  ds_write_b128 v23, v[88:91] offset:6144
  ds_write_b128 v23, v[92:95] offset:7168
  ds_write_b128 v23, v[96:99] offset:8192
  ds_write_b128 v23, v[100:103] offset:9216
  ds_write_b128 v23, v[104:107] offset:10240
  ds_write_b128 v23, v[108:111] offset:11264
  ds_write_b128 v23, v[112:115] offset:12288
  ds_write_b128 v23, v[116:119] offset:13312
  ds_write_b128 v23, v[120:123] offset:14336
  ds_write_b128 v23, v[124:127] offset:15360
  s_waitcnt lgkmcnt(0)
  s_barrier
  ds_read_b64_tr_b16 a[128:129], v12 offset:0
  ds_read_b64_tr_b16 a[130:131], v12 offset:2048
  ds_read_b64_tr_b16 a[132:133], v13 offset:0
  ds_read_b64_tr_b16 a[134:135], v13 offset:2048
  ds_read_b64_tr_b16 a[136:137], v14 offset:0
  ds_read_b64_tr_b16 a[138:139], v14 offset:2048
  ds_read_b64_tr_b16 a[140:141], v15 offset:0
  ds_read_b64_tr_b16 a[142:143], v15 offset:2048
  ds_read_b64_tr_b16 a[144:145], v12 offset:16384
  ds_read_b64_tr_b16 a[146:147], v12 offset:18432
  ds_read_b64_tr_b16 a[148:149], v13 offset:16384
  ds_read_b64_tr_b16 a[150:151], v13 offset:18432
  ds_read_b64_tr_b16 a[152:153], v14 offset:16384
  ds_read_b64_tr_b16 a[154:155], v14 offset:18432
  ds_read_b64_tr_b16 a[156:157], v15 offset:16384
  ds_read_b64_tr_b16 a[158:159], v15 offset:18432
  ds_read_b64_tr_b16 a[160:161], v12 offset:32768
  ds_read_b64_tr_b16 a[162:163], v12 offset:34816
  ds_read_b64_tr_b16 a[164:165], v13 offset:32768
  ds_read_b64_tr_b16 a[166:167], v13 offset:34816
  ds_read_b64_tr_b16 a[168:169], v14 offset:32768
  ds_read_b64_tr_b16 a[170:171], v14 offset:34816
  ds_read_b64_tr_b16 a[172:173], v15 offset:32768
  ds_read_b64_tr_b16 a[174:175], v15 offset:34816
  ds_read_b64_tr_b16 a[176:177], v12 offset:49152
  ds_read_b64_tr_b16 a[178:179], v12 offset:51200
  ds_read_b64_tr_b16 a[180:181], v13 offset:49152
  ds_read_b64_tr_b16 a[182:183], v13 offset:51200
  ds_read_b64_tr_b16 a[184:185], v14 offset:49152
  ds_read_b64_tr_b16 a[186:187], v14 offset:51200
  ds_read_b64_tr_b16 a[188:189], v15 offset:49152
  ds_read_b64_tr_b16 a[190:191], v15 offset:51200
  s_waitcnt lgkmcnt(0)
  s_barrier
  s_waitcnt vmcnt(16)
  s_load_dwordx2 s[24:25], s[0:1], 0
  v_lshlrev_b32 v32, 7, v1
  s_lshl_b32 s23, s2, 2
  s_add_u32 s23, s23, s20
  s_mul_i32 s23, s23, 20480
  s_add_u32 s23, s23, 0
  s_waitcnt lgkmcnt(0)
  s_mov_b32 s24, s24
  s_mov_b32 s25, s25
  s_mov_b32 s26, 2621440
  s_mov_b32 s27, 0x00020000
  buffer_load_dword v33, v32, s[24:27], s23 offen
  s_add_u32 s23, s23, 8192
  buffer_load_dword v33, v32, s[24:27], s23 offen
  s_add_u32 s23, s23, 8192
  buffer_load_dword v33, v32, s[24:27], s23 offen
  s_add_u32 s23, s23, 8192
  s_load_dwordx2 s[24:25], s[0:1], 72
  v_lshlrev_b32 v32, 7, v1
  s_lshl_b32 s23, s2, 2
  s_add_u32 s23, s23, s20
  s_mul_i32 s23, s23, 6400
  s_add_u32 s23, s23, 0
  s_waitcnt lgkmcnt(0)
  s_mov_b32 s24, s24
  s_mov_b32 s25, s25
  s_mov_b32 s26, 819200
  s_mov_b32 s27, 0x00020000
  buffer_load_dword v33, v32, s[24:27], s23 offen
  s_add_u32 s23, s23, 8192
  ds_write_b128 v29, v[128:131] offset:0
  ds_write_b128 v29, v[132:135] offset:1024
  ds_write_b128 v29, v[136:139] offset:2048
  ds_write_b128 v29, v[140:143] offset:3072
  ds_write_b128 v29, v[144:147] offset:4096
  ds_write_b128 v29, v[148:151] offset:5120
  ds_write_b128 v29, v[152:155] offset:6144
  ds_write_b128 v29, v[156:159] offset:7168
  ds_write_b128 v29, v[160:163] offset:8192
  ds_write_b128 v29, v[164:167] offset:9216
  ds_write_b128 v29, v[168:171] offset:10240
  ds_write_b128 v29, v[172:175] offset:11264
  ds_write_b128 v29, v[176:179] offset:12288
  ds_write_b128 v29, v[180:183] offset:13312
  ds_write_b128 v29, v[184:187] offset:14336
  ds_write_b128 v29, v[188:191] offset:15360
  s_waitcnt lgkmcnt(0)
  s_barrier
  ds_read_b64_tr_b16 a[192:193], v16 offset:0
  ds_read_b64_tr_b16 a[194:195], v16 offset:2048
  ds_read_b64_tr_b16 a[196:197], v17 offset:0
  ds_read_b64_tr_b16 a[198:199], v17 offset:2048
  ds_read_b64_tr_b16 a[200:201], v18 offset:0
  ds_read_b64_tr_b16 a[202:203], v18 offset:2048
  ds_read_b64_tr_b16 a[204:205], v19 offset:0
  ds_read_b64_tr_b16 a[206:207], v19 offset:2048
  ds_read_b64_tr_b16 a[208:209], v16 offset:16384
  ds_read_b64_tr_b16 a[210:211], v16 offset:18432
  ds_read_b64_tr_b16 a[212:213], v17 offset:16384
  ds_read_b64_tr_b16 a[214:215], v17 offset:18432
  ds_read_b64_tr_b16 a[216:217], v18 offset:16384
  ds_read_b64_tr_b16 a[218:219], v18 offset:18432
  ds_read_b64_tr_b16 a[220:221], v19 offset:16384
  ds_read_b64_tr_b16 a[222:223], v19 offset:18432
  ds_read_b64_tr_b16 a[224:225], v16 offset:32768
  ds_read_b64_tr_b16 a[226:227], v16 offset:34816
  ds_read_b64_tr_b16 a[228:229], v17 offset:32768
  ds_read_b64_tr_b16 a[230:231], v17 offset:34816
  ds_read_b64_tr_b16 a[232:233], v18 offset:32768
  ds_read_b64_tr_b16 a[234:235], v18 offset:34816
  ds_read_b64_tr_b16 a[236:237], v19 offset:32768
  ds_read_b64_tr_b16 a[238:239], v19 offset:34816
  ds_read_b64_tr_b16 a[240:241], v16 offset:49152
  ds_read_b64_tr_b16 a[242:243], v16 offset:51200
  ds_read_b64_tr_b16 a[244:245], v17 offset:49152
  ds_read_b64_tr_b16 a[246:247], v17 offset:51200
  ds_read_b64_tr_b16 a[248:249], v18 offset:49152
  ds_read_b64_tr_b16 a[250:251], v18 offset:51200
  ds_read_b64_tr_b16 a[252:253], v19 offset:49152
  ds_read_b64_tr_b16 a[254:255], v19 offset:51200
  s_waitcnt lgkmcnt(0)
  s_barrier
  s_waitcnt vmcnt(4)
  ds_write_b128 v23, v[192:195] offset:0
  ds_write_b128 v23, v[196:199] offset:1024
  ds_write_b128 v23, v[200:203] offset:2048
  ds_write_b128 v23, v[204:207] offset:3072
  ds_write_b128 v23, v[208:211] offset:4096
  ds_write_b128 v23, v[212:215] offset:5120
  ds_write_b128 v23, v[216:219] offset:6144
  ds_write_b128 v23, v[220:223] offset:7168
  ds_write_b128 v23, v[224:227] offset:8192
  ds_write_b128 v23, v[228:231] offset:9216
  ds_write_b128 v23, v[232:235] offset:10240
  ds_write_b128 v23, v[236:239] offset:11264
  ds_write_b128 v23, v[240:243] offset:12288
  ds_write_b128 v23, v[244:247] offset:13312
  ds_write_b128 v23, v[248:251] offset:14336
  ds_write_b128 v23, v[252:255] offset:15360
  s_waitcnt lgkmcnt(0)
  s_barrier
  ds_read_b64_tr_b16 v[192:193], v12 offset:0
  ds_read_b64_tr_b16 v[194:195], v12 offset:2048
  ds_read_b64_tr_b16 v[196:197], v13 offset:0
  ds_read_b64_tr_b16 v[198:199], v13 offset:2048
  ds_read_b64_tr_b16 v[200:201], v14 offset:0
  ds_read_b64_tr_b16 v[202:203], v14 offset:2048
  ds_read_b64_tr_b16 v[204:205], v15 offset:0
  ds_read_b64_tr_b16 v[206:207], v15 offset:2048
  ds_read_b64_tr_b16 v[208:209], v12 offset:16384
  ds_read_b64_tr_b16 v[210:211], v12 offset:18432
  ds_read_b64_tr_b16 v[212:213], v13 offset:16384
  ds_read_b64_tr_b16 v[214:215], v13 offset:18432
  ds_read_b64_tr_b16 v[216:217], v14 offset:16384
  ds_read_b64_tr_b16 v[218:219], v14 offset:18432
  ds_read_b64_tr_b16 v[220:221], v15 offset:16384
  ds_read_b64_tr_b16 v[222:223], v15 offset:18432
  ds_read_b64_tr_b16 v[224:225], v12 offset:32768
  ds_read_b64_tr_b16 v[226:227], v12 offset:34816
  ds_read_b64_tr_b16 v[228:229], v13 offset:32768
  ds_read_b64_tr_b16 v[230:231], v13 offset:34816
  ds_read_b64_tr_b16 v[232:233], v14 offset:32768
  ds_read_b64_tr_b16 v[234:235], v14 offset:34816
  ds_read_b64_tr_b16 v[236:237], v15 offset:32768
  ds_read_b64_tr_b16 v[238:239], v15 offset:34816
  ds_read_b64_tr_b16 v[240:241], v12 offset:49152
  ds_read_b64_tr_b16 v[242:243], v12 offset:51200
  ds_read_b64_tr_b16 v[244:245], v13 offset:49152
  ds_read_b64_tr_b16 v[246:247], v13 offset:51200
  ds_read_b64_tr_b16 v[248:249], v14 offset:49152
  ds_read_b64_tr_b16 v[250:251], v14 offset:51200
  ds_read_b64_tr_b16 v[252:253], v15 offset:49152
  ds_read_b64_tr_b16 v[254:255], v15 offset:51200
  s_waitcnt lgkmcnt(0)
  s_barrier
  s_load_dwordx2 s[32:33], s[0:1], 96
  s_waitcnt lgkmcnt(0)
  s_mov_b32 s32, s32
  s_mov_b32 s33, s33
  s_mov_b32 s34, 256
  s_mov_b32 s35, 0x00020000
  s_mov_b32 s21, 76
  v_mov_b32 v4, 0
  s_mov_b32 s101, 0
wf_256:
  buffer_load_dword v5, v4, s[32:35], s21 offen sc1
  s_add_u32 s101, s101, 1
  s_cmp_gt_u32 s101, 131072
  s_cbranch_scc1 main_end
  s_waitcnt vmcnt(0)
  v_readfirstlane_b32 s100, v5
  s_cmp_ge_u32 s100, 1
  s_cbranch_scc1 wf_257
  s_sleep 8
  s_branch wf_256
wf_257:
  s_sub_u32 s80, s100, 1
  s_lshl_b32 s80, s80, 13
  v_lshrrev_b32 v8, 3, v1
  v_and_b32 v9, 7, v1
  v_xor_b32 v9, v9, v8
  s_and_b32 s21, s20, 1
  s_lshl_b32 s21, s21, 4
  s_lshr_b32 s22, s20, 1
  s_add_u32 s21, s21, s22
  v_lshl_add_u32 v8, v8, 1, s21
  v_mul_u32_u24 v8, 1280, v8
  v_lshl_add_u32 v4, v9, 4, v8
  s_lshl_b32 s31, s20, 10
  s_mul_i32 s30, s42, 655360
  s_sub_u32 s46, s30, 40960
  s_cmp_eq_u32 s42, 0
  s_cselect_b32 s46, 1073741824, s46
  s_add_u32 m0, s31, 0
  s_nop 0
  buffer_load_dwordx4 v4, s[8:11], s46 offen offset:0 lds
  s_add_u32 m0, s31, 3968
  s_nop 0
  buffer_load_dwordx4 v4, s[8:11], s46 offen offset:128 lds
  s_add_u32 m0, s31, 7936
  s_nop 0
  buffer_load_dwordx4 v4, s[8:11], s46 offen offset:256 lds
  s_add_u32 m0, s31, 11904
  s_nop 0
  buffer_load_dwordx4 v4, s[8:11], s46 offen offset:384 lds
  s_add_u32 m0, s31, 15872
  s_nop 0
  buffer_load_dwordx4 v4, s[8:11], s46 offen offset:512 lds
  s_add_u32 m0, s31, 19840
  s_nop 0
  buffer_load_dwordx4 v4, s[8:11], s46 offen offset:640 lds
  s_add_u32 m0, s31, 23808
  s_nop 0
  buffer_load_dwordx4 v4, s[8:11], s46 offen offset:768 lds
  s_add_u32 m0, s31, 27776
  s_nop 0
  buffer_load_dwordx4 v4, s[8:11], s46 offen offset:896 lds
  s_add_u32 m0, s31, 31744
  s_nop 0
  buffer_load_dwordx4 v4, s[8:11], s46 offen offset:1024 lds
  s_add_u32 m0, s31, 35712
  s_nop 0
  buffer_load_dwordx4 v4, s[8:11], s46 offen offset:1152 lds
  s_add_u32 s31, s31, 40960
  s_add_u32 m0, s31, 0
  s_nop 0
  buffer_load_dwordx4 v4, s[8:11], s30 offen offset:0 lds
  s_add_u32 m0, s31, 3968
  s_nop 0
  buffer_load_dwordx4 v4, s[8:11], s30 offen offset:128 lds
  s_add_u32 m0, s31, 7936
  s_nop 0
  buffer_load_dwordx4 v4, s[8:11], s30 offen offset:256 lds
  s_add_u32 m0, s31, 11904
  s_nop 0
  buffer_load_dwordx4 v4, s[8:11], s30 offen offset:384 lds
  s_add_u32 m0, s31, 15872
  s_nop 0
  buffer_load_dwordx4 v4, s[8:11], s30 offen offset:512 lds
  s_add_u32 m0, s31, 19840
  s_nop 0
  buffer_load_dwordx4 v4, s[8:11], s30 offen offset:640 lds
  s_add_u32 m0, s31, 23808
  s_nop 0
  buffer_load_dwordx4 v4, s[8:11], s30 offen offset:768 lds
  s_add_u32 m0, s31, 27776
  s_nop 0
  buffer_load_dwordx4 v4, s[8:11], s30 offen offset:896 lds
  s_add_u32 m0, s31, 31744
  s_nop 0
  buffer_load_dwordx4 v4, s[8:11], s30 offen offset:1024 lds
  s_add_u32 m0, s31, 35712
  s_nop 0
  buffer_load_dwordx4 v4, s[8:11], s30 offen offset:1152 lds
  s_add_u32 s31, s31, 40960
  s_add_u32 s30, s30, 40960
  v_and_b32 v10, 7, v2
  v_add_u32 v8, 0, v3
  v_xor_b32 v8, v8, v10
  v_lshlrev_b32 v8, 4, v8
  v_lshl_add_u32 v5, v2, 7, v8
  v_add_u32 v8, 4, v3
  v_xor_b32 v8, v8, v10
  v_lshlrev_b32 v8, 4, v8
  v_lshl_add_u32 v6, v2, 7, v8
  v_mov_b32 v7, v5
  v_mov_b32 v8, v6
  s_mov_b32 s33, 0
  v_lshlrev_b32 v15, 4, v1
  v_mov_b32 v16, 0xf149f2ca
  v_lshrrev_b32 v17, 3, v2
  v_mul_u32_u24 v17, 2560, v17
  v_lshlrev_b32 v18, 1, v10
  s_lshr_b32 s21, s20, 1
  s_lshl_b32 s21, s21, 10
  s_and_b32 s22, s20, 1
  s_lshl_b32 s22, s22, 3
  s_add_u32 s21, s21, s22
  s_add_u32 s21, s21, 131072
  v_lshl_add_u32 v9, v3, 4, v18
  v_lshl_add_u32 v9, v9, 4, v17
  v_add_u32 v9, s21, v9
  s_lshl_b32 s21, s20, 7
  s_add_u32 s21, s21, 133120
  v_lshl_add_u32 v10, v18, 3, v17
  v_add_u32 v10, s21, v10
  v_cmp_eq_u32 vcc, 2, v3
  v_lshlrev_b32 v19, 4, v1
  v_add_u32 v19, 136192, v19
  v_cndmask_b32 v10, v19, v10, vcc
  s_lshr_b32 s21, s20, 1
  s_and_b32 s22, s20, 1
  s_mul_i32 s23, s21, 2560
  s_lshl_b32 s47, s22, 10
  s_add_u32 s47, s47, s23
  s_add_u32 s47, s47, 131072
  v_add_u32 v11, s47, v15
  s_lshl_b32 s47, s22, 8
  s_add_u32 s47, s47, s23
  s_add_u32 s47, s47, 133120
  v_add_u32 v12, s47, v15
  s_mul_i32 s23, s22, 768
  s_sub_u32 s23, 2048, s23
  v_add_u32 v14, s23, v15
  v_mov_b32 v19, 1073741824
  v_cmp_gt_u32 vcc, 16, v1
  s_lshl_b32 s47, s42, 23
  s_lshl_b32 s21, s21, 14
  v_cndmask_b32 v14, v19, v14, vcc
  s_add_u32 s47, s47, s21
  s_lshr_b32 s21, s41, 1
  s_lshl_b32 s21, s21, 15
  s_add_u32 s47, s47, s21
  s_and_b32 s21, s41, 1
  s_mul_i32 s21, s21, 2560
  s_add_u32 s47, s47, s21
  s_xor_b32 s21, s80, 184819712
  s_add_u32 s47, s47, s21
  s_lshl_b32 s22, s22, 10
  s_add_u32 s47, s47, s22
  s_mov_b32 s48, 1073741824
  s_mov_b32 s49, 1073741824
  v_cmp_eq_u32 s[62:63], 0, v3
  v_lshlrev_b32 v17, 2, v3
  v_sub_u32 v17, v17, v2
  s_mov_b32 s82, 0x3e64f92e
  s_mov_b32 s83, 0x3fb8aa3b
  v_mov_b32 v20, 0
  v_mov_b32 v21, 0
  v_mov_b32 v22, 0
  v_mov_b32 v23, 0
  v_add_u32 v18, 7, v17
  v_cmp_gt_u32 s[84:85], 8, v18
  v_cmp_le_i32 s[64:65], 16, v18
  v_mov_b32 v18, 65535
  v_cndmask_b32 v19, 0, v18, s[84:85]
  v_or_b32 v20, v20, v19
  v_cndmask_b32 v19, 0, v18, s[64:65]
  v_or_b32 v22, v22, v19
  s_mov_b64 s[54:55], s[84:85]
  s_or_b64 s[84:85], s[84:85], s[64:65]
  v_add_u32 v18, 8, v17
  v_cmp_gt_u32 s[86:87], 8, v18
  v_cmp_le_i32 s[66:67], 16, v18
  v_mov_b32 v18, 4294901760
  v_cndmask_b32 v19, 0, v18, s[86:87]
  v_or_b32 v20, v20, v19
  v_cndmask_b32 v19, 0, v18, s[66:67]
  v_or_b32 v22, v22, v19
  s_mov_b64 s[56:57], s[86:87]
  s_or_b64 s[86:87], s[86:87], s[66:67]
  v_add_u32 v18, 9, v17
  v_cmp_gt_u32 s[88:89], 8, v18
  v_cmp_le_i32 s[68:69], 16, v18
  v_mov_b32 v18, 65535
  v_cndmask_b32 v19, 0, v18, s[88:89]
  v_or_b32 v21, v21, v19
  v_cndmask_b32 v19, 0, v18, s[68:69]
  v_or_b32 v23, v23, v19
  s_mov_b64 s[58:59], s[88:89]
  s_or_b64 s[88:89], s[88:89], s[68:69]
  v_add_u32 v18, 10, v17
  v_cmp_gt_u32 s[90:91], 8, v18
  v_cmp_le_i32 s[70:71], 16, v18
  v_mov_b32 v18, 4294901760
  v_cndmask_b32 v19, 0, v18, s[90:91]
  v_or_b32 v21, v21, v19
  v_cndmask_b32 v19, 0, v18, s[70:71]
  v_or_b32 v23, v23, v19
  s_mov_b64 s[60:61], s[90:91]
  s_or_b64 s[90:91], s[90:91], s[70:71]
  v_mov_b32 v18, 0x3f80
  v_mov_b32 v19, 0x3f800000
  v_cmp_eq_i32 vcc, 0, v17
  v_cmp_eq_i32 s[22:23], -1, v17
  s_nop 1
  v_cndmask_b32 v24, 0, v18, vcc
  v_cndmask_b32 v24, v24, v19, s[22:23]
  v_cmp_eq_i32 vcc, -2, v17
  v_cmp_eq_i32 s[22:23], -3, v17
  s_nop 1
  v_cndmask_b32 v25, 0, v18, vcc
  v_cndmask_b32 v25, v25, v19, s[22:23]
  v_mov_b32 v26, 0
  v_mov_b32 v27, 0
  v_mov_b32 v60, 0
  v_mov_b32 v61, 0
  v_mov_b32 v62, 0
  v_mov_b32 v63, 0
  v_mov_b32 v64, 0
  v_mov_b32 v65, 0
  v_mov_b32 v66, 0
  v_mov_b32 v67, 0
  v_mov_b32 v68, 0
  v_mov_b32 v69, 0
  v_mov_b32 v70, 0
  v_mov_b32 v71, 0
  v_mov_b32 v72, 0
  v_mov_b32 v73, 0
  v_mov_b32 v74, 0
  v_mov_b32 v75, 0
  v_mov_b32 v76, 0
  v_mov_b32 v77, 0
  v_mov_b32 v78, 0
  v_mov_b32 v79, 0
  v_mov_b32 v80, 0
  v_mov_b32 v81, 0
  v_mov_b32 v82, 0
  v_mov_b32 v83, 0
  v_mov_b32 v84, 0
  v_mov_b32 v85, 0
  v_mov_b32 v86, 0
  v_mov_b32 v87, 0
  v_mov_b32 v88, 0
  v_mov_b32 v89, 0
  v_mov_b32 v90, 0
  v_mov_b32 v91, 0
  v_mov_b32 v92, 0
  v_mov_b32 v93, 0
  v_mov_b32 v94, 0
  v_mov_b32 v95, 0
  v_mov_b32 v96, 0
  v_mov_b32 v97, 0
  v_mov_b32 v98, 0
  v_mov_b32 v99, 0
  v_mov_b32 v100, 0
  v_mov_b32 v101, 0
  v_mov_b32 v102, 0
  v_mov_b32 v103, 0
  v_mov_b32 v104, 0
  v_mov_b32 v105, 0
  v_mov_b32 v106, 0
  v_mov_b32 v107, 0
  v_mov_b32 v108, 0
  v_mov_b32 v109, 0
  v_mov_b32 v110, 0
  v_mov_b32 v111, 0
  v_mov_b32 v112, 0
  v_mov_b32 v113, 0
  v_mov_b32 v114, 0
  v_mov_b32 v115, 0
  v_mov_b32 v116, 0
  v_mov_b32 v117, 0
  v_mov_b32 v118, 0
  v_mov_b32 v119, 0
  v_mov_b32 v120, 0
  v_mov_b32 v121, 0
  v_mov_b32 v122, 0
  v_mov_b32 v123, 0
  v_mov_b32 v124, 0
  v_mov_b32 v125, 0
  v_mov_b32 v126, 0
  v_mov_b32 v127, 0
  v_mov_b32 v128, 0
  v_mov_b32 v129, 0
  v_mov_b32 v130, 0
  v_mov_b32 v131, 0
  s_load_dwordx2 s[36:37], s[0:1], 80
  s_lshl_b32 s50, s41, 2
  s_add_u32 s50, s50, s20
  s_and_b32 s21, s50, 7
  s_waitcnt lgkmcnt(0)
  s_mov_b32 s24, s36
  s_mov_b32 s25, s37
  s_mov_b32 s26, 1280
  s_mov_b32 s27, 0x00020000
  s_add_u32 s76, s38, 175112192
  s_addc_u32 s77, s39, 0
  s_mov_b32 s78, 8192
  s_mov_b32 s79, 0x00020000
  s_lshl_b32 s21, s21, 4
  v_lshlrev_b32 v186, 2, v1
  v_xor_b32 v186, s21, v186
  v_and_b32 v187, 31, v1
  v_lshrrev_b32 v189, 5, v1
  v_lshlrev_b32 v189, 12, v189
  v_lshl_add_u32 v189, v187, 2, v189
  s_lshl_b32 s21, s50, 7
  v_add_u32 v189, s21, v189
  v_mov_b32 v188, v189
  buffer_load_dword v174, v186, s[24:27], 0 offen offset:0
  buffer_load_dword v175, v186, s[24:27], 0 offen offset:256
  buffer_load_dword v176, v186, s[24:27], 0 offen offset:512
  buffer_load_dword v177, v186, s[24:27], 0 offen offset:768
  buffer_load_dword v178, v186, s[24:27], 0 offen offset:1024
  s_load_dwordx2 s[12:13], s[0:1], 16
  s_mul_i32 s51, s2, 384
  s_mul_i32 s21, s20, 1966080
  s_add_u32 s51, s51, s21
  v_mul_u32_u24 v187, 21846, v1
  v_lshrrev_b32 v187, 16, v187
  v_mul_u32_u24 v187, 11904, v187
  v_lshl_add_u32 v190, v1, 7, v187
  s_waitcnt lgkmcnt(0)
  s_mov_b32 s12, s12
  s_mov_b32 s13, s13
  s_mov_b32 s14, 7864320
  s_mov_b32 s15, 0x00020000
  s_waitcnt vmcnt(0)
  v_lshlrev_b32 v169, 16, v174
  v_and_b32 v174, 0xffff0000, v174
  v_lshlrev_b32 v170, 16, v175
  v_and_b32 v175, 0xffff0000, v175
  v_lshlrev_b32 v171, 16, v176
  v_and_b32 v176, 0xffff0000, v176
  v_lshlrev_b32 v172, 16, v177
  v_and_b32 v177, 0xffff0000, v177
  v_lshlrev_b32 v173, 16, v178
  v_and_b32 v178, 0xffff0000, v178
  s_cmp_eq_u32 s42, 0
  s_cselect_b32 s53, 15, 99
  s_mov_b32 s26, 17
  s_mov_b32 s52, -1
  s_waitcnt vmcnt(10)
  s_barrier
  ds_read_b128 v[28:31], v7 offset:0
  ds_read_b128 v[32:35], v8 offset:0
  ds_read_b128 v[36:39], v7 offset:4096
  ds_read_b128 v[40:43], v8 offset:4096
  s_waitcnt lgkmcnt(3)
  .p2align 3
bfl_258:
  v_mfma_f32_16x16x32_bf16 v[60:63], a[0:3], v[28:31], 0
  ds_read_b128 v[44:47], v7 offset:8192
  v_mfma_f32_16x16x32_bf16 v[64:67], a[4:7], v[28:31], 0
  ds_read_b32 v179, v188 offset:0
  ds_read_b32 v180, v188 offset:8192
  v_mfma_f32_16x16x32_bf16 v[68:71], a[8:11], v[28:31], 0
  v_cvt_pk_bf16_f32 v128, v84, v85
  v_cvt_pk_bf16_f32 v129, v86, v87
  v_mfma_f32_16x16x32_bf16 v[72:75], v[28:31], a[12:15], 0
  s_waitcnt lgkmcnt(5)
  v_cvt_pk_bf16_f32 v124, v76, v77
  v_cvt_pk_bf16_f32 v125, v78, v79
  v_mfma_f32_16x16x32_bf16 v[60:63], a[16:19], v[32:35], v[60:63]
  ds_read_b128 v[48:51], v8 offset:8192
  v_cvt_pk_bf16_f32 v100, v80, v81
  v_mfma_f32_16x16x32_bf16 v[64:67], a[20:23], v[32:35], v[64:67]
  v_cvt_pk_bf16_f32 v101, v82, v83
  v_cvt_pk_bf16_f32 v116, v88, v89
  v_mfma_f32_16x16x32_bf16 v[68:71], a[24:27], v[32:35], v[68:71]
  s_add_u32 m0, s31, 0
  v_cvt_pk_bf16_f32 v117, v90, v91
  v_cndmask_b32 v126, 0, v128, s[62:63]
  v_mfma_f32_16x16x32_bf16 v[72:75], v[32:35], a[28:31], v[72:75]
  s_waitcnt lgkmcnt(5)
  v_cndmask_b32 v127, 0, v129, s[62:63]
  buffer_load_dwordx4 v4, s[8:11], s30 offen offset:0 lds
  v_mfma_f32_16x16x32_bf16 v[60:63], a[32:35], v[36:39], v[60:63]
  ds_read_b128 v[52:55], v7 offset:12288
  ds_read_b32 v181, v188 offset:16384
  v_mfma_f32_16x16x32_bf16 v[64:67], a[36:39], v[36:39], v[64:67]
  ds_read_b32 v182, v188 offset:24576
  ds_read_b32 v183, v188 offset:32768
  v_mfma_f32_16x16x32_bf16 v[68:71], a[40:43], v[36:39], v[68:71]
  v_mfma_f32_16x16x32_bf16 v[72:75], v[36:39], a[44:47], v[72:75]
  v_mfma_f32_16x16x32_bf16 v[132:135], v[128:131], v[24:27], 0
  s_waitcnt lgkmcnt(8)
  v_permlane16_swap_b32 v128, v102
  v_permlane16_swap_b32 v129, v103
  v_mfma_f32_16x16x32_bf16 v[60:63], a[48:51], v[40:43], v[60:63]
  ds_read_b128 v[56:59], v8 offset:12288
  s_waitcnt lgkmcnt(1)
  v_mfma_f32_16x16x32_bf16 v[64:67], a[52:55], v[40:43], v[64:67]
  s_cmp_le_u32 s26, 4
  s_cbranch_scc1 wp_259
wp_259r:
  v_lshlrev_b32 v186, 16, v179
  v_mfma_f32_16x16x32_bf16 v[68:71], a[56:59], v[40:43], v[68:71]
  v_and_b32 v187, 0xffff0000, v179
  v_mul_f32 v186, v186, v169
  v_mfma_f32_16x16x32_bf16 v[72:75], v[40:43], a[60:63], v[72:75]
  v_mul_f32 v187, v187, v174
  v_cvt_pk_bf16_f32 v186, v186, v187
  v_mfma_f32_16x16x32_bf16 v[136:139], v[100:103], v[124:127], 0
  v_lshlrev_b32 v187, 16, v186
  v_and_b32 v186, 0xffff0000, v186
  v_mfma_f32_16x16x32_bf16 v[140:143], v[104:107], v[124:127], 0
  s_add_u32 m0, s31, 3968
  s_waitcnt lgkmcnt(8)
  v_add_f32 v184, v186, v187
  v_mfma_f32_16x16x32_bf16 v[60:63], a[64:67], v[44:47], v[60:63]
  ds_read_b128 v[28:31], v7 offset:16384
  buffer_load_dwordx4 v4, s[8:11], s30 offen offset:128 lds
  v_mfma_f32_16x16x32_bf16 v[64:67], a[68:71], v[44:47], v[64:67]
  v_lshlrev_b32 v186, 16, v180
  v_and_b32 v187, 0xffff0000, v180
  v_mfma_f32_16x16x32_bf16 v[68:71], a[72:75], v[44:47], v[68:71]
  v_cvt_pk_bf16_f32 v120, v132, v133
  v_cvt_pk_bf16_f32 v121, v134, v135
  v_mfma_f32_16x16x32_bf16 v[72:75], v[44:47], a[76:79], v[72:75]
  s_waitcnt lgkmcnt(6)
  v_cndmask_b32 v136, v136, v140, s[64:65]
  v_cndmask_b32 v137, v137, v141, s[66:67]
  v_mfma_f32_16x16x32_bf16 v[60:63], a[80:83], v[48:51], v[60:63]
  ds_read_b128 v[32:35], v8 offset:16384
  v_cndmask_b32 v138, v138, v142, s[68:69]
  v_mfma_f32_16x16x32_bf16 v[64:67], a[84:87], v[48:51], v[64:67]
  v_cndmask_b32 v139, v139, v143, s[70:71]
  v_cvt_pk_bf16_f32 v17, v136, v137
  v_mfma_f32_16x16x32_bf16 v[68:71], a[88:91], v[48:51], v[68:71]
  v_lshlrev_b32 v136, 16, v17
  v_and_b32 v137, 0xffff0000, v17
  v_mfma_f32_16x16x32_bf16 v[72:75], v[48:51], a[92:95], v[72:75]
  s_waitcnt lgkmcnt(6)
  v_cvt_pk_bf16_f32 v17, v138, v139
  v_lshlrev_b32 v138, 16, v17
  v_mfma_f32_16x16x32_bf16 v[60:63], a[96:99], v[52:55], v[60:63]
  ds_read_b128 v[36:39], v7 offset:20480
  v_and_b32 v139, 0xffff0000, v17
  v_mfma_f32_16x16x32_bf16 v[64:67], a[100:103], v[52:55], v[64:67]
  v_mul_f32 v136, s82, v136
  v_mul_f32 v137, s82, v137
  v_mfma_f32_16x16x32_bf16 v[68:71], a[104:107], v[52:55], v[68:71]
  v_mul_f32 v138, s82, v138
  v_mul_f32 v139, s82, v139
  v_mfma_f32_16x16x32_bf16 v[72:75], v[52:55], a[108:111], v[72:75]
  s_waitcnt lgkmcnt(3)
  v_cvt_pk_bf16_f32 v17, v136, v137
  v_lshlrev_b32 v136, 16, v17
  v_mfma_f32_16x16x32_bf16 v[60:63], a[112:115], v[56:59], v[60:63]
  s_add_u32 m0, s31, 7936
  ds_read_b128 v[40:43], v8 offset:20480
  v_and_b32 v137, 0xffff0000, v17
  v_mfma_f32_16x16x32_bf16 v[64:67], a[116:119], v[56:59], v[64:67]
  v_cvt_pk_bf16_f32 v17, v138, v139
  v_lshlrev_b32 v138, 16, v17
  v_mfma_f32_16x16x32_bf16 v[68:71], a[120:123], v[56:59], v[68:71]
  v_and_b32 v139, 0xffff0000, v17
  v_cndmask_b32 v136, v16, v136, s[54:55]
  v_mfma_f32_16x16x32_bf16 v[72:75], v[56:59], a[124:127], v[72:75]
  s_waitcnt lgkmcnt(3)
  v_cndmask_b32 v137, v16, v137, s[56:57]
  v_cndmask_b32 v138, v16, v138, s[58:59]
  v_mfma_f32_16x16x32_bf16 v[60:63], a[128:131], v[28:31], v[60:63]
  ds_read_b128 v[44:47], v7 offset:24576
  v_cndmask_b32 v139, v16, v139, s[60:61]
  v_mfma_f32_16x16x32_bf16 v[64:67], a[132:135], v[28:31], v[64:67]
  v_max3_f32 v17, v136, v137, v138
  v_max_f32 v17, v17, v139
  v_mfma_f32_16x16x32_bf16 v[68:71], a[136:139], v[28:31], v[68:71]
  v_mov_b32 v18, v17
  buffer_load_dwordx4 v4, s[8:11], s30 offen offset:256 lds
  v_mfma_f32_16x16x32_bf16 v[72:75], v[28:31], a[140:143], v[72:75]
  s_waitcnt lgkmcnt(3)
  v_permlane32_swap_b32 v17, v18
  v_max_f32 v17, v17, v18
  v_mfma_f32_16x16x32_bf16 v[60:63], a[144:147], v[32:35], v[60:63]
  ds_read_b128 v[48:51], v8 offset:24576
  v_mov_b32 v18, v17
  v_mfma_f32_16x16x32_bf16 v[64:67], a[148:151], v[32:35], v[64:67]
  v_permlane16_swap_b32 v17, v18
  v_max_f32 v17, v17, v18
  v_mfma_f32_16x16x32_bf16 v[68:71], a[152:155], v[32:35], v[68:71]
  v_mul_f32 v17, s83, v17
  v_fma_f32 v136, v136, s83, -v17
  v_mfma_f32_16x16x32_bf16 v[72:75], v[32:35], a[156:159], v[72:75]
  s_waitcnt lgkmcnt(3)
  v_fma_f32 v137, v137, s83, -v17
  v_fma_f32 v138, v138, s83, -v17
  v_mfma_f32_16x16x32_bf16 v[60:63], a[160:163], v[36:39], v[60:63]
  s_add_u32 m0, s31, 11904
  ds_read_b128 v[52:55], v7 offset:28672
  v_fma_f32 v139, v139, s83, -v17
  v_mfma_f32_16x16x32_bf16 v[64:67], a[164:167], v[36:39], v[64:67]
  v_exp_f32 v136, v136
  v_mfma_f32_16x16x32_bf16 v[68:71], a[168:171], v[36:39], v[68:71]
  v_exp_f32 v137, v137
  v_mfma_f32_16x16x32_bf16 v[72:75], v[36:39], a[172:175], v[72:75]
  s_waitcnt lgkmcnt(3)
  v_exp_f32 v138, v138
  v_mfma_f32_16x16x32_bf16 v[60:63], a[176:179], v[40:43], v[60:63]
  ds_read_b128 v[56:59], v8 offset:28672
  buffer_load_dwordx4 v4, s[8:11], s30 offen offset:384 lds
  v_mfma_f32_16x16x32_bf16 v[64:67], a[180:183], v[40:43], v[64:67]
  v_exp_f32 v139, v139
  v_mfma_f32_16x16x32_bf16 v[68:71], a[184:187], v[40:43], v[68:71]
  v_add_f32 v17, v136, v137
  v_add_f32 v18, v138, v139
  v_mfma_f32_16x16x32_bf16 v[72:75], v[40:43], a[188:191], v[72:75]
  s_waitcnt lgkmcnt(3)
  v_add_f32 v17, v17, v18
  v_mov_b32 v18, v17
  v_mfma_f32_16x16x32_bf16 v[60:63], a[192:195], v[44:47], v[60:63]
  ds_read_b128 v[28:31], v7 offset:32768
  v_permlane32_swap_b32 v17, v18
  v_mfma_f32_16x16x32_bf16 v[64:67], a[196:199], v[44:47], v[64:67]
  v_add_f32 v17, v17, v18
  v_mov_b32 v18, v17
  v_mfma_f32_16x16x32_bf16 v[68:71], a[200:203], v[44:47], v[68:71]
  v_permlane16_swap_b32 v17, v18
  v_add_f32 v17, v17, v18
  v_mfma_f32_16x16x32_bf16 v[72:75], v[44:47], a[204:207], v[72:75]
  s_waitcnt lgkmcnt(3)
  v_rcp_f32 v17, v17
  v_mfma_f32_16x16x32_bf16 v[60:63], a[208:211], v[48:51], v[60:63]
  s_add_u32 m0, s31, 15872
  ds_read_b128 v[32:35], v8 offset:32768
  v_mul_f32 v136, v136, v17
  v_mfma_f32_16x16x32_bf16 v[64:67], a[212:215], v[48:51], v[64:67]
  v_mul_f32 v137, v137, v17
  v_mul_f32 v138, v138, v17
  v_mfma_f32_16x16x32_bf16 v[68:71], a[216:219], v[48:51], v[68:71]
  v_mul_f32 v139, v139, v17
  v_cvt_pk_bf16_f32 v144, v136, v137
  v_mfma_f32_16x16x32_bf16 v[72:75], v[48:51], a[220:223], v[72:75]
  s_waitcnt lgkmcnt(3)
  v_cvt_pk_bf16_f32 v145, v138, v139
  v_and_b32 v146, v144, v22
  v_mfma_f32_16x16x32_bf16 v[60:63], a[224:227], v[52:55], v[60:63]
  ds_read_b128 v[36:39], v7 offset:36864
  v_and_b32 v147, v145, v23
  v_mfma_f32_16x16x32_bf16 v[64:67], a[228:231], v[52:55], v[64:67]
  v_and_b32 v144, v144, v20
  v_and_b32 v145, v145, v21
  v_mfma_f32_16x16x32_bf16 v[68:71], a[232:235], v[52:55], v[68:71]
  buffer_load_dwordx4 v4, s[8:11], s30 offen offset:512 lds
  v_mul_f32 v186, v186, v170
  v_mfma_f32_16x16x32_bf16 v[72:75], v[52:55], a[236:239], v[72:75]
  s_waitcnt lgkmcnt(3)
  v_mul_f32 v187, v187, v175
  v_cvt_pk_bf16_f32 v186, v186, v187
  v_mfma_f32_16x16x32_bf16 v[60:63], a[240:243], v[56:59], v[60:63]
  ds_read_b128 v[40:43], v8 offset:36864
  v_lshlrev_b32 v187, 16, v186
  v_mfma_f32_16x16x32_bf16 v[64:67], a[244:247], v[56:59], v[64:67]
  v_and_b32 v186, 0xffff0000, v186
  v_add_f32 v184, v184, v187
  v_mfma_f32_16x16x32_bf16 v[68:71], a[248:251], v[56:59], v[68:71]
  v_add_f32 v184, v184, v186
  v_lshlrev_b32 v186, 16, v181
  v_mfma_f32_16x16x32_bf16 v[72:75], v[56:59], a[252:255], v[72:75]
  s_add_u32 m0, s31, 19840
  s_waitcnt lgkmcnt(3)
  v_and_b32 v187, 0xffff0000, v181
  v_mfma_f32_16x16x32_bf16 v[60:63], v[192:195], v[28:31], v[60:63]
  ds_read_b128 v[44:47], v7 offset:2048
  buffer_load_dwordx4 v4, s[8:11], s30 offen offset:640 lds
  v_mfma_f32_16x16x32_bf16 v[64:67], v[196:199], v[28:31], v[64:67]
  v_mul_f32 v186, v186, v171
  v_mul_f32 v187, v187, v176
  v_mfma_f32_16x16x32_bf16 v[68:71], v[200:203], v[28:31], v[68:71]
  v_cvt_pk_bf16_f32 v186, v186, v187
  v_lshlrev_b32 v187, 16, v186
  v_mfma_f32_16x16x32_bf16 v[72:75], v[28:31], v[204:207], v[72:75]
  s_cmp_le_u32 s26, 4
  s_cbranch_scc1 wp_260
wp_260r:
  v_and_b32 v186, 0xffff0000, v186
  v_mfma_f32_16x16x32_bf16 v[148:151], v[116:119], v[144:147], 0
  s_cmp_le_u32 s26, s53
  s_cselect_b64 s[54:55], s[84:85], s[54:55]
  v_add_f32 v184, v184, v187
  v_mfma_f32_16x16x32_bf16 v[152:155], v[120:123], v[144:147], 0
  s_waitcnt lgkmcnt(3)
  v_mov_b32 v104, v100
  v_mov_b32 v105, v101
  v_mfma_f32_16x16x32_bf16 v[60:63], v[208:211], v[32:35], v[60:63]
  ds_read_b128 v[48:51], v8 offset:2048
  v_mov_b32 v106, v102
  v_mfma_f32_16x16x32_bf16 v[64:67], v[212:215], v[32:35], v[64:67]
  v_mov_b32 v107, v103
  v_mov_b32 v118, v116
  v_mfma_f32_16x16x32_bf16 v[68:71], v[216:219], v[32:35], v[68:71]
  v_cvt_pk_bf16_f32 v156, v148, v149
  v_cvt_pk_bf16_f32 v157, v150, v151
  v_mfma_f32_16x16x32_bf16 v[72:75], v[32:35], v[220:223], v[72:75]
  s_waitcnt lgkmcnt(3)
  ds_write_b64 v9, v[156:157] offset:16
  v_cvt_pk_bf16_f32 v158, v152, v153
  v_mfma_f32_16x16x32_bf16 v[60:63], v[224:227], v[36:39], v[60:63]
  ds_read_b128 v[52:55], v7 offset:6144
  v_cvt_pk_bf16_f32 v159, v154, v155
  v_mfma_f32_16x16x32_bf16 v[64:67], v[228:231], v[36:39], v[64:67]
  s_add_u32 m0, s31, 23808
  ds_write_b64 v10, v[158:159] offset:8
  v_mov_b32 v119, v117
  v_mfma_f32_16x16x32_bf16 v[68:71], v[232:235], v[36:39], v[68:71]
  v_mov_b32 v122, v120
  v_mov_b32 v123, v121
  v_mfma_f32_16x16x32_bf16 v[72:75], v[36:39], v[236:239], v[72:75]
  s_waitcnt lgkmcnt(5)
  buffer_load_dwordx4 v4, s[8:11], s30 offen offset:768 lds
  v_add_f32 v184, v184, v186
  v_mfma_f32_16x16x32_bf16 v[60:63], v[240:243], v[40:43], v[60:63]
  ds_read_b128 v[56:59], v8 offset:6144
  v_lshlrev_b32 v186, 16, v182
  v_mfma_f32_16x16x32_bf16 v[64:67], v[244:247], v[40:43], v[64:67]
  s_cmp_le_u32 s26, s53
  s_cselect_b64 s[56:57], s[86:87], s[56:57]
  v_and_b32 v187, 0xffff0000, v182
  v_mfma_f32_16x16x32_bf16 v[68:71], v[248:251], v[40:43], v[68:71]
  s_cmp_le_u32 s26, s53
  s_cselect_b64 s[58:59], s[88:89], s[58:59]
  v_mul_f32 v186, v186, v172
  v_mfma_f32_16x16x32_bf16 v[72:75], v[40:43], v[252:255], v[72:75]
  s_waitcnt lgkmcnt(5)
  s_cmp_le_u32 s26, s53
  s_cselect_b64 s[60:61], s[90:91], s[60:61]
  v_mfma_f32_16x16x32_bf16 v[76:79], a[0:3], v[44:47], 0
  ds_read_b128 v[28:31], v7 offset:10240
  v_mul_f32 v187, v187, v177
  v_mfma_f32_16x16x32_bf16 v[80:83], a[4:7], v[44:47], 0
  s_waitcnt lgkmcnt(2)
  s_barrier
  v_cvt_pk_bf16_f32 v186, v186, v187
  v_mfma_f32_16x16x32_bf16 v[84:87], a[8:11], v[44:47], 0
  v_cvt_pk_bf16_f32 v128, v68, v69
  v_cvt_pk_bf16_f32 v129, v70, v71
  v_mfma_f32_16x16x32_bf16 v[88:91], v[44:47], a[12:15], 0
  s_waitcnt lgkmcnt(5)
  v_cvt_pk_bf16_f32 v124, v60, v61
  v_cvt_pk_bf16_f32 v125, v62, v63
  v_mfma_f32_16x16x32_bf16 v[76:79], a[16:19], v[48:51], v[76:79]
  ds_read_b128 v[32:35], v8 offset:10240
  v_cvt_pk_bf16_f32 v92, v64, v65
  v_mfma_f32_16x16x32_bf16 v[80:83], a[20:23], v[48:51], v[80:83]
  s_add_u32 m0, s31, 27776
  v_cvt_pk_bf16_f32 v93, v66, v67
  v_cvt_pk_bf16_f32 v108, v72, v73
  v_mfma_f32_16x16x32_bf16 v[84:87], a[24:27], v[48:51], v[84:87]
  v_cvt_pk_bf16_f32 v109, v74, v75
  v_cndmask_b32 v126, 0, v128, s[62:63]
  v_mfma_f32_16x16x32_bf16 v[88:91], v[48:51], a[28:31], v[88:91]
  s_waitcnt lgkmcnt(4)
  v_cndmask_b32 v127, 0, v129, s[62:63]
  v_xor_b32 v9, 8192, v9
  v_mfma_f32_16x16x32_bf16 v[76:79], a[32:35], v[52:55], v[76:79]
  ds_read_b128 v[36:39], v7 offset:14336
  v_xor_b32 v10, 8192, v10
  v_mfma_f32_16x16x32_bf16 v[80:83], a[36:39], v[52:55], v[80:83]
  ds_read_b128 v[160:163], v11
  ds_read_b128 v[164:167], v12
  v_mfma_f32_16x16x32_bf16 v[84:87], a[40:43], v[52:55], v[84:87]
  buffer_load_dwordx4 v4, s[8:11], s30 offen offset:896 lds
  v_lshlrev_b32 v187, 16, v186
  v_mfma_f32_16x16x32_bf16 v[88:91], v[52:55], a[44:47], v[88:91]
  v_and_b32 v186, 0xffff0000, v186
  v_add_f32 v184, v184, v187
  v_mfma_f32_16x16x32_bf16 v[132:135], v[128:131], v[24:27], 0
  s_waitcnt lgkmcnt(5)
  v_permlane16_swap_b32 v128, v94
  v_permlane16_swap_b32 v129, v95
  v_mfma_f32_16x16x32_bf16 v[76:79], a[48:51], v[56:59], v[76:79]
  ds_read_b128 v[40:43], v8 offset:14336
  v_add_f32 v184, v184, v186
  v_mfma_f32_16x16x32_bf16 v[80:83], a[52:55], v[56:59], v[80:83]
  v_lshlrev_b32 v186, 16, v183
  v_and_b32 v187, 0xffff0000, v183
  v_mfma_f32_16x16x32_bf16 v[84:87], a[56:59], v[56:59], v[84:87]
  s_waitcnt lgkmcnt(1)
  buffer_store_dwordx4 v[160:163], v15, s[16:19], s49 offen sc1
  buffer_store_dwordx4 v[164:167], v14, s[16:19], s49 offen sc1
  v_mfma_f32_16x16x32_bf16 v[88:91], v[56:59], a[60:63], v[88:91]
  v_xor_b32 v11, 8192, v11
  v_xor_b32 v12, 8192, v12
  v_mfma_f32_16x16x32_bf16 v[136:139], v[92:95], v[124:127], 0
  s_add_u32 m0, s31, 31744
  s_mov_b32 s49, s48
  s_mov_b32 s48, s47
  v_mfma_f32_16x16x32_bf16 v[140:143], v[96:99], v[124:127], 0
  s_add_u32 s22, s47, 524288
  s_waitcnt lgkmcnt(5)
  buffer_load_dwordx4 v4, s[8:11], s30 offen offset:1024 lds
  v_mfma_f32_16x16x32_bf16 v[76:79], a[64:67], v[28:31], v[76:79]
  s_xor_b32 s47, s47, s22
  ds_read_b128 v[44:47], v7 offset:18432
  s_lshr_b32 s47, s47, 8
  v_mfma_f32_16x16x32_bf16 v[80:83], a[68:71], v[28:31], v[80:83]
  s_and_b32 s47, s47, 8192
  s_xor_b32 s47, s47, s22
  s_sub_u32 s26, s26, 1
  v_mfma_f32_16x16x32_bf16 v[84:87], a[72:75], v[28:31], v[84:87]
  v_cvt_pk_bf16_f32 v112, v132, v133
  v_cvt_pk_bf16_f32 v113, v134, v135
  v_mfma_f32_16x16x32_bf16 v[88:91], v[28:31], a[76:79], v[88:91]
  s_waitcnt lgkmcnt(5)
  v_cndmask_b32 v136, v136, v140, s[64:65]
  v_cndmask_b32 v137, v137, v141, s[66:67]
  v_mfma_f32_16x16x32_bf16 v[76:79], a[80:83], v[32:35], v[76:79]
  ds_read_b128 v[48:51], v8 offset:18432
  v_cndmask_b32 v138, v138, v142, s[68:69]
  v_mfma_f32_16x16x32_bf16 v[80:83], a[84:87], v[32:35], v[80:83]
  v_cndmask_b32 v139, v139, v143, s[70:71]
  v_cvt_pk_bf16_f32 v17, v136, v137
  v_mfma_f32_16x16x32_bf16 v[84:87], a[88:91], v[32:35], v[84:87]
  v_lshlrev_b32 v136, 16, v17
  v_and_b32 v137, 0xffff0000, v17
  v_mfma_f32_16x16x32_bf16 v[88:91], v[32:35], a[92:95], v[88:91]
  s_waitcnt lgkmcnt(5)
  v_cvt_pk_bf16_f32 v17, v138, v139
  v_lshlrev_b32 v138, 16, v17
  v_mfma_f32_16x16x32_bf16 v[76:79], a[96:99], v[36:39], v[76:79]
  ds_read_b128 v[52:55], v7 offset:22528
  v_and_b32 v139, 0xffff0000, v17
  v_mfma_f32_16x16x32_bf16 v[80:83], a[100:103], v[36:39], v[80:83]
  v_mul_f32 v136, s82, v136
  v_mul_f32 v137, s82, v137
  v_mfma_f32_16x16x32_bf16 v[84:87], a[104:107], v[36:39], v[84:87]
  s_add_u32 m0, s31, 35712
  v_mul_f32 v138, s82, v138
  v_mul_f32 v139, s82, v139
  v_mfma_f32_16x16x32_bf16 v[88:91], v[36:39], a[108:111], v[88:91]
  s_waitcnt lgkmcnt(3)
  v_cvt_pk_bf16_f32 v17, v136, v137
  v_lshlrev_b32 v136, 16, v17
  v_mfma_f32_16x16x32_bf16 v[76:79], a[112:115], v[40:43], v[76:79]
  ds_read_b128 v[56:59], v8 offset:22528
  v_and_b32 v137, 0xffff0000, v17
  v_mfma_f32_16x16x32_bf16 v[80:83], a[116:119], v[40:43], v[80:83]
  v_cvt_pk_bf16_f32 v17, v138, v139
  v_lshlrev_b32 v138, 16, v17
  v_mfma_f32_16x16x32_bf16 v[84:87], a[120:123], v[40:43], v[84:87]
  v_and_b32 v139, 0xffff0000, v17
  v_cndmask_b32 v136, v16, v136, s[54:55]
  v_mfma_f32_16x16x32_bf16 v[88:91], v[40:43], a[124:127], v[88:91]
  s_waitcnt lgkmcnt(3)
  v_cndmask_b32 v137, v16, v137, s[56:57]
  v_cndmask_b32 v138, v16, v138, s[58:59]
  v_mfma_f32_16x16x32_bf16 v[76:79], a[128:131], v[44:47], v[76:79]
  ds_read_b128 v[28:31], v7 offset:26624
  v_cndmask_b32 v139, v16, v139, s[60:61]
  v_mfma_f32_16x16x32_bf16 v[80:83], a[132:135], v[44:47], v[80:83]
  v_max3_f32 v17, v136, v137, v138
  v_max_f32 v17, v17, v139
  v_mfma_f32_16x16x32_bf16 v[84:87], a[136:139], v[44:47], v[84:87]
  v_mov_b32 v18, v17
  buffer_load_dwordx4 v4, s[8:11], s30 offen offset:1152 lds
  v_mfma_f32_16x16x32_bf16 v[88:91], v[44:47], a[140:143], v[88:91]
  s_waitcnt lgkmcnt(3)
  v_permlane32_swap_b32 v17, v18
  v_max_f32 v17, v17, v18
  v_mfma_f32_16x16x32_bf16 v[76:79], a[144:147], v[48:51], v[76:79]
  s_add_u32 s30, s30, 40960
  ds_read_b128 v[32:35], v8 offset:26624
  v_mov_b32 v18, v17
  v_mfma_f32_16x16x32_bf16 v[80:83], a[148:151], v[48:51], v[80:83]
  s_add_u32 s31, s31, 40960
  v_permlane16_swap_b32 v17, v18
  v_max_f32 v17, v17, v18
  v_mfma_f32_16x16x32_bf16 v[84:87], a[152:155], v[48:51], v[84:87]
  v_mul_f32 v17, s83, v17
  v_fma_f32 v136, v136, s83, -v17
  v_mfma_f32_16x16x32_bf16 v[88:91], v[48:51], a[156:159], v[88:91]
  s_waitcnt lgkmcnt(3)
  v_fma_f32 v137, v137, s83, -v17
  v_fma_f32 v138, v138, s83, -v17
  v_mfma_f32_16x16x32_bf16 v[76:79], a[160:163], v[52:55], v[76:79]
  ds_read_b128 v[36:39], v7 offset:30720
  v_fma_f32 v139, v139, s83, -v17
  v_mfma_f32_16x16x32_bf16 v[80:83], a[164:167], v[52:55], v[80:83]
  v_exp_f32 v136, v136
  v_mfma_f32_16x16x32_bf16 v[84:87], a[168:171], v[52:55], v[84:87]
  v_exp_f32 v137, v137
  v_mfma_f32_16x16x32_bf16 v[88:91], v[52:55], a[172:175], v[88:91]
  s_waitcnt lgkmcnt(3)
  v_exp_f32 v138, v138
  v_mfma_f32_16x16x32_bf16 v[76:79], a[176:179], v[56:59], v[76:79]
  ds_read_b128 v[40:43], v8 offset:30720
  v_mul_f32 v186, v186, v173
  v_mfma_f32_16x16x32_bf16 v[80:83], a[180:183], v[56:59], v[80:83]
  v_exp_f32 v139, v139
  v_mfma_f32_16x16x32_bf16 v[84:87], a[184:187], v[56:59], v[84:87]
  v_add_f32 v17, v136, v137
  v_add_f32 v18, v138, v139
  v_mfma_f32_16x16x32_bf16 v[88:91], v[56:59], a[188:191], v[88:91]
  s_waitcnt lgkmcnt(3)
  v_add_f32 v17, v17, v18
  v_mov_b32 v18, v17
  v_mfma_f32_16x16x32_bf16 v[76:79], a[192:195], v[28:31], v[76:79]
  ds_read_b128 v[44:47], v7 offset:34816
  v_permlane32_swap_b32 v17, v18
  v_mfma_f32_16x16x32_bf16 v[80:83], a[196:199], v[28:31], v[80:83]
  v_add_f32 v17, v17, v18
  v_mov_b32 v18, v17
  v_mfma_f32_16x16x32_bf16 v[84:87], a[200:203], v[28:31], v[84:87]
  v_permlane16_swap_b32 v17, v18
  v_add_f32 v17, v17, v18
  v_mfma_f32_16x16x32_bf16 v[88:91], v[28:31], a[204:207], v[88:91]
  s_waitcnt lgkmcnt(3)
  v_rcp_f32 v17, v17
  v_mfma_f32_16x16x32_bf16 v[76:79], a[208:211], v[32:35], v[76:79]
  ds_read_b128 v[48:51], v8 offset:34816
  v_mul_f32 v136, v136, v17
  v_mfma_f32_16x16x32_bf16 v[80:83], a[212:215], v[32:35], v[80:83]
  v_mul_f32 v137, v137, v17
  v_mul_f32 v138, v138, v17
  v_mfma_f32_16x16x32_bf16 v[84:87], a[216:219], v[32:35], v[84:87]
  v_mul_f32 v139, v139, v17
  v_cvt_pk_bf16_f32 v144, v136, v137
  v_mfma_f32_16x16x32_bf16 v[88:91], v[32:35], a[220:223], v[88:91]
  s_waitcnt lgkmcnt(3)
  v_cvt_pk_bf16_f32 v145, v138, v139
  v_and_b32 v146, v144, v22
  v_mfma_f32_16x16x32_bf16 v[76:79], a[224:227], v[36:39], v[76:79]
  ds_read_b128 v[52:55], v7 offset:38912
  v_and_b32 v147, v145, v23
  v_mfma_f32_16x16x32_bf16 v[80:83], a[228:231], v[36:39], v[80:83]
  v_and_b32 v144, v144, v20
  v_and_b32 v145, v145, v21
  v_mfma_f32_16x16x32_bf16 v[84:87], a[232:235], v[36:39], v[84:87]
  s_cmp_ge_u32 s31, 122880
  s_cselect_b32 s21, 122880, 0
  s_sub_u32 s31, s31, s21
  v_mfma_f32_16x16x32_bf16 v[88:91], v[36:39], a[236:239], v[88:91]
  s_add_u32 s33, s33, 40960
  s_waitcnt lgkmcnt(3)
  v_mul_f32 v187, v187, v178
  v_mfma_f32_16x16x32_bf16 v[76:79], a[240:243], v[40:43], v[76:79]
  ds_read_b128 v[56:59], v8 offset:38912
  v_cvt_pk_bf16_f32 v186, v186, v187
  v_mfma_f32_16x16x32_bf16 v[80:83], a[244:247], v[40:43], v[80:83]
  s_cmp_ge_u32 s33, 122880
  s_cselect_b32 s33, 0, s33
  v_lshlrev_b32 v187, 16, v186
  v_mfma_f32_16x16x32_bf16 v[84:87], a[248:251], v[40:43], v[84:87]
  v_add_u32 v7, s33, v5
  v_add_u32 v8, s33, v6
  v_mfma_f32_16x16x32_bf16 v[88:91], v[40:43], a[252:255], v[88:91]
  s_waitcnt lgkmcnt(3)
  v_and_b32 v186, 0xffff0000, v186
  v_add_f32 v184, v184, v187
  v_mfma_f32_16x16x32_bf16 v[76:79], v[192:195], v[44:47], v[76:79]
  s_waitcnt vmcnt(12)
  s_barrier
  ds_read_b128 v[28:31], v7 offset:0
  v_mfma_f32_16x16x32_bf16 v[80:83], v[196:199], v[44:47], v[80:83]
  v_add_u32 v188, s33, v189
  v_add_f32 v184, v184, v186
  v_mfma_f32_16x16x32_bf16 v[84:87], v[200:203], v[44:47], v[84:87]
  v_add_f32_dpp v184, v184, v184 row_ror:8 row_mask:0xf bank_mask:0xf
  v_mfma_f32_16x16x32_bf16 v[88:91], v[44:47], v[204:207], v[88:91]
  v_add_f32_dpp v184, v184, v184 row_ror:4 row_mask:0xf bank_mask:0xf
  v_mfma_f32_16x16x32_bf16 v[148:151], v[108:111], v[144:147], 0
  v_add_f32_dpp v184, v184, v184 row_ror:2 row_mask:0xf bank_mask:0xf
  v_mfma_f32_16x16x32_bf16 v[152:155], v[112:115], v[144:147], 0
  s_waitcnt lgkmcnt(3)
  v_mov_b32 v96, v92
  v_mov_b32 v97, v93
  v_mfma_f32_16x16x32_bf16 v[76:79], v[208:211], v[48:51], v[76:79]
  ds_read_b128 v[32:35], v8 offset:0
  v_mov_b32 v98, v94
  v_mfma_f32_16x16x32_bf16 v[80:83], v[212:215], v[48:51], v[80:83]
  v_mov_b32 v99, v95
  v_mov_b32 v110, v108
  v_mfma_f32_16x16x32_bf16 v[84:87], v[216:219], v[48:51], v[84:87]
  v_cvt_pk_bf16_f32 v156, v148, v149
  v_cvt_pk_bf16_f32 v157, v150, v151
  v_mfma_f32_16x16x32_bf16 v[88:91], v[48:51], v[220:223], v[88:91]
  s_waitcnt lgkmcnt(3)
  ds_write_b64 v9, v[156:157] offset:0
  v_cvt_pk_bf16_f32 v158, v152, v153
  v_mfma_f32_16x16x32_bf16 v[76:79], v[224:227], v[52:55], v[76:79]
  ds_read_b128 v[36:39], v7 offset:4096
  v_cvt_pk_bf16_f32 v159, v154, v155
  v_mfma_f32_16x16x32_bf16 v[80:83], v[228:231], v[52:55], v[80:83]
  ds_write_b64 v10, v[158:159] offset:0
  v_mov_b32 v111, v109
  v_mfma_f32_16x16x32_bf16 v[84:87], v[232:235], v[52:55], v[84:87]
  v_mov_b32 v114, v112
  v_mov_b32 v115, v113
  v_mfma_f32_16x16x32_bf16 v[88:91], v[52:55], v[236:239], v[88:91]
  s_waitcnt lgkmcnt(5)
  v_add_f32_dpp v184, v184, v184 row_ror:1 row_mask:0xf bank_mask:0xf
  v_cmp_eq_u32 vcc, s52, v2
  v_mfma_f32_16x16x32_bf16 v[76:79], v[240:243], v[56:59], v[76:79]
  ds_read_b128 v[40:43], v8 offset:4096
  v_cndmask_b32 v185, v185, v184, vcc
  v_mfma_f32_16x16x32_bf16 v[80:83], v[244:247], v[56:59], v[80:83]
  s_add_u32 s52, s52, 1
  v_mfma_f32_16x16x32_bf16 v[84:87], v[248:251], v[56:59], v[84:87]
  s_cmp_gt_u32 s26, 0
  v_mfma_f32_16x16x32_bf16 v[88:91], v[56:59], v[252:255], v[88:91]
  s_waitcnt lgkmcnt(5)
  s_cbranch_scc1 bfl_258
  s_branch wp_261
wp_259:
  buffer_load_dword v191, v190, s[12:15], s51 offen
  s_add_u32 s51, s51, 258048
  s_branch wp_259r
wp_260:
  buffer_load_dword v191, v190, s[12:15], s51 offen
  s_add_u32 s51, s51, 258048
  s_branch wp_260r
wp_261:
  v_mov_b32 v186, v185
  s_nop 1
  v_permlane32_swap_b32 v185, v186
  v_add_f32 v185, v185, v186
  v_mov_b32 v186, v185
  s_nop 1
  v_permlane16_swap_b32 v185, v186
  v_add_f32 v185, v185, v186
  v_cvt_pk_bf16_f32 v186, v185, v185
  v_lshlrev_b32 v185, 16, v186
  v_mul_f32 v185, 0xbfb8aa3b, v185
  v_exp_f32 v185, v185
  s_nop 0
  v_add_f32 v185, 1.0, v185
  v_rcp_f32 v185, v185
  s_nop 0
  v_cvt_pk_bf16_f32 v186, v185, v185
  v_lshlrev_b32 v185, 16, v186
  s_and_b32 s21, s50, 15
  s_lshl_b32 s21, s21, 1
  s_lshr_b32 s22, s50, 4
  s_add_u32 s21, s21, s22
  s_lshl_b32 s22, s42, 9
  s_add_u32 s21, s21, s22
  s_lshl_b32 s21, s21, 2
  v_lshlrev_b32 v187, 7, v2
  buffer_store_dword v185, v187, s[76:79], s21 offen sc1
  s_nop 7
  v_cvt_pk_bf16_f32 v128, v84, v85
  v_cvt_pk_bf16_f32 v129, v86, v87
  v_cvt_pk_bf16_f32 v124, v76, v77
  v_cvt_pk_bf16_f32 v125, v78, v79
  v_cvt_pk_bf16_f32 v100, v80, v81
  v_cvt_pk_bf16_f32 v101, v82, v83
  v_cvt_pk_bf16_f32 v116, v88, v89
  v_cvt_pk_bf16_f32 v117, v90, v91
  v_cndmask_b32 v126, 0, v128, s[62:63]
  v_cndmask_b32 v127, 0, v129, s[62:63]
  s_nop 1
  v_mfma_f32_16x16x32_bf16 v[132:135], v[128:131], v[24:27], 0
  s_nop 7
  v_permlane16_swap_b32 v128, v102
  v_permlane16_swap_b32 v129, v103
  s_nop 1
  v_mfma_f32_16x16x32_bf16 v[136:139], v[100:103], v[124:127], 0
  v_mfma_f32_16x16x32_bf16 v[140:143], v[104:107], v[124:127], 0
  s_nop 7
  v_cvt_pk_bf16_f32 v120, v132, v133
  v_cvt_pk_bf16_f32 v121, v134, v135
  v_cndmask_b32 v136, v136, v140, s[64:65]
  v_cndmask_b32 v137, v137, v141, s[66:67]
  v_cndmask_b32 v138, v138, v142, s[68:69]
  v_cndmask_b32 v139, v139, v143, s[70:71]
  v_cvt_pk_bf16_f32 v17, v136, v137
  v_lshlrev_b32 v136, 16, v17
  v_and_b32 v137, 0xffff0000, v17
  v_cvt_pk_bf16_f32 v17, v138, v139
  v_lshlrev_b32 v138, 16, v17
  v_and_b32 v139, 0xffff0000, v17
  v_mul_f32 v136, s82, v136
  v_mul_f32 v137, s82, v137
  v_mul_f32 v138, s82, v138
  v_mul_f32 v139, s82, v139
  v_cvt_pk_bf16_f32 v17, v136, v137
  v_lshlrev_b32 v136, 16, v17
  v_and_b32 v137, 0xffff0000, v17
  v_cvt_pk_bf16_f32 v17, v138, v139
  v_lshlrev_b32 v138, 16, v17
  v_and_b32 v139, 0xffff0000, v17
  v_cndmask_b32 v136, v16, v136, s[54:55]
  v_cndmask_b32 v137, v16, v137, s[56:57]
  v_cndmask_b32 v138, v16, v138, s[58:59]
  v_cndmask_b32 v139, v16, v139, s[60:61]
  v_max3_f32 v17, v136, v137, v138
  v_max_f32 v17, v17, v139
  v_mov_b32 v18, v17
  s_nop 1
  v_permlane32_swap_b32 v17, v18
  v_max_f32 v17, v17, v18
  v_mov_b32 v18, v17
  s_nop 1
  v_permlane16_swap_b32 v17, v18
  v_max_f32 v17, v17, v18
  v_mul_f32 v17, s83, v17
  v_fma_f32 v136, v136, s83, -v17
  v_fma_f32 v137, v137, s83, -v17
  v_fma_f32 v138, v138, s83, -v17
  v_fma_f32 v139, v139, s83, -v17
  v_exp_f32 v136, v136
  v_exp_f32 v137, v137
  v_exp_f32 v138, v138
  v_exp_f32 v139, v139
  s_nop 1
  v_add_f32 v17, v136, v137
  v_add_f32 v18, v138, v139
  v_add_f32 v17, v17, v18
  v_mov_b32 v18, v17
  s_nop 1
  v_permlane32_swap_b32 v17, v18
  v_add_f32 v17, v17, v18
  v_mov_b32 v18, v17
  s_nop 1
  v_permlane16_swap_b32 v17, v18
  v_add_f32 v17, v17, v18
  v_rcp_f32 v17, v17
  s_nop 1
  v_mul_f32 v136, v136, v17
  v_mul_f32 v137, v137, v17
  v_mul_f32 v138, v138, v17
  v_mul_f32 v139, v139, v17
  v_cvt_pk_bf16_f32 v144, v136, v137
  v_cvt_pk_bf16_f32 v145, v138, v139
  v_and_b32 v146, v144, v22
  v_and_b32 v147, v145, v23
  v_and_b32 v144, v144, v20
  v_and_b32 v145, v145, v21
  s_nop 1
  v_mfma_f32_16x16x32_bf16 v[148:151], v[116:119], v[144:147], 0
  v_mfma_f32_16x16x32_bf16 v[152:155], v[120:123], v[144:147], 0
  s_nop 7
  v_mov_b32 v104, v100
  v_mov_b32 v105, v101
  v_mov_b32 v106, v102
  v_mov_b32 v107, v103
  v_mov_b32 v118, v116
  v_mov_b32 v119, v117
  v_mov_b32 v122, v120
  v_mov_b32 v123, v121
  v_cvt_pk_bf16_f32 v156, v148, v149
  v_cvt_pk_bf16_f32 v157, v150, v151
  ds_write_b64 v9, v[156:157] offset:16
  v_cvt_pk_bf16_f32 v158, v152, v153
  v_cvt_pk_bf16_f32 v159, v154, v155
  ds_write_b64 v10, v[158:159] offset:8
  s_waitcnt lgkmcnt(0)
  s_barrier
  ds_read_b128 v[160:163], v11
  ds_read_b128 v[164:167], v12
  s_waitcnt lgkmcnt(0)
  buffer_store_dwordx4 v[160:163], v15, s[16:19], s49 offen sc1
  buffer_store_dwordx4 v[164:167], v14, s[16:19], s49 offen sc1
  s_waitcnt vmcnt(0)
  s_barrier
  s_lshl_b32 s21, s42, 7
  s_add_u32 s21, s21, 29696
  s_xor_b32 s21, s21, s80
  s_cmp_lg_u32 s20, 0
  s_cbranch_scc1 af_262
  v_mov_b32 v8, 0
  v_mov_b32 v9, 1
  s_mov_b64 exec, 1
  buffer_atomic_add v9, v8, s[72:75], s21 offen sc1
  s_mov_b64 exec, -1
  s_nop 1
af_262:
  s_barrier
  s_sub_u32 s2, s3, 96
  s_mov_b32 s40, 0
  s_mov_b32 s41, 10
q_entry:
  s_load_dwordx2 s[4:5], s[0:1], 0
  s_load_dwordx2 s[6:7], s[0:1], 16
  s_load_dwordx2 s[38:39], s[0:1], 104
  s_mov_b32 s42, s2
  s_waitcnt lgkmcnt(0)
  s_mov_b32 s8, s4
  s_mov_b32 s9, s5
  s_mov_b32 s10, 2621440
  s_mov_b32 s11, 0x00020000
  s_mov_b32 s12, s6
  s_mov_b32 s13, s7
  s_mov_b32 s14, 7864320
  s_mov_b32 s15, 0x00020000
  s_mov_b32 s16, s38
  s_mov_b32 s17, s39
  s_mov_b32 s18, 218103808
  s_mov_b32 s19, 0x00020000
  s_add_u32 s72, s38, 173080576
  s_addc_u32 s73, s39, 0
  s_mov_b32 s74, 49152
  s_mov_b32 s75, 0x00020000
  s_mul_i32 s44, s42, 384
  s_cmp_lg_u32 s40, 0
  s_cbranch_scc1 qg_263
  v_lshlrev_b32 v11, 4, v1
  s_load_dwordx2 s[36:37], s[0:1], 72
  s_lshr_b32 s21, s2, 3
  s_mul_i32 s21, s21, 204800
  s_and_b32 s22, s2, 7
  s_mul_i32 s22, s22, 160
  s_add_u32 s21, s21, s22
  s_waitcnt lgkmcnt(0)
  s_mov_b32 s28, s36
  s_mov_b32 s29, s37
  s_mov_b32 s30, 819200
  s_mov_b32 s31, 0x00020000
  s_mul_i32 s22, s20, 51200
  s_add_u32 s21, s21, s22
  s_mul_i32 s22, s20, 6400
  v_add_u32 v22, 0, v1
  v_mul_u32_u24 v23, 6554, v22
  v_lshrrev_b32 v23, 16, v23
  v_mul_u32_u24 v23, 1120, v23
  v_lshl_add_u32 v22, v22, 4, v23
  s_add_u32 m0, s22, 122880
  s_nop 0
  buffer_load_dwordx4 v22, s[28:31], s21 offen lds
  v_add_u32 v22, 64, v1
  v_mul_u32_u24 v23, 6554, v22
  v_lshrrev_b32 v23, 16, v23
  v_mul_u32_u24 v23, 1120, v23
  v_lshl_add_u32 v22, v22, 4, v23
  s_add_u32 m0, s22, 123904
  s_nop 0
  buffer_load_dwordx4 v22, s[28:31], s21 offen lds
  v_add_u32 v22, 128, v1
  v_mul_u32_u24 v23, 6554, v22
  v_lshrrev_b32 v23, 16, v23
  v_mul_u32_u24 v23, 1120, v23
  v_lshl_add_u32 v22, v22, 4, v23
  s_add_u32 m0, s22, 124928
  s_nop 0
  buffer_load_dwordx4 v22, s[28:31], s21 offen lds
  v_add_u32 v22, 192, v1
  v_mul_u32_u24 v23, 6554, v22
  v_lshrrev_b32 v23, 16, v23
  v_mul_u32_u24 v23, 1120, v23
  v_lshl_add_u32 v22, v22, 4, v23
  s_add_u32 m0, s22, 125952
  s_nop 0
  buffer_load_dwordx4 v22, s[28:31], s21 offen lds
  v_add_u32 v22, 256, v1
  v_mul_u32_u24 v23, 6554, v22
  v_lshrrev_b32 v23, 16, v23
  v_mul_u32_u24 v23, 1120, v23
  v_lshl_add_u32 v22, v22, 4, v23
  s_add_u32 m0, s22, 126976
  s_nop 0
  buffer_load_dwordx4 v22, s[28:31], s21 offen lds
  v_add_u32 v22, 320, v1
  v_mul_u32_u24 v23, 6554, v22
  v_lshrrev_b32 v23, 16, v23
  v_mul_u32_u24 v23, 1120, v23
  v_lshl_add_u32 v22, v22, 4, v23
  s_add_u32 m0, s22, 128000
  s_nop 0
  buffer_load_dwordx4 v22, s[28:31], s21 offen lds
  v_add_u32 v22, 384, v1
  v_mul_u32_u24 v23, 6554, v22
  v_lshrrev_b32 v23, 16, v23
  v_mul_u32_u24 v23, 1120, v23
  v_lshl_add_u32 v22, v22, 4, v23
  s_add_u32 m0, s22, 129024
  s_mov_b64 exec, 0xffff
  buffer_load_dwordx4 v22, s[28:31], s21 offen lds
  s_mov_b64 exec, -1
qg_263:
  s_mul_i32 s22, s20, 5
  s_and_b32 s22, s22, 1
  s_lshl_b32 s22, s22, 2
  s_mov_b32 s21, 12288
  v_add_u32 v30, 0, v1
  v_mul_u32_u24 v31, 2731, v30
  v_lshrrev_b32 v31, 16, v31
  v_mul_u32_u24 v4, 24, v31
  v_sub_u32 v30, v30, v4
  v_and_b32 v4, 2, v31
  v_xor_b32 v30, v30, v4
  v_xor_b32 v30, s22, v30
  v_mul_lo_u32 v31, v31, s21
  v_lshl_add_u32 v4, v30, 4, v31
  v_xor_b32 v7, 64, v4
  v_add_u32 v30, 64, v1
  v_mul_u32_u24 v31, 2731, v30
  v_lshrrev_b32 v31, 16, v31
  v_mul_u32_u24 v5, 24, v31
  v_sub_u32 v30, v30, v5
  v_and_b32 v5, 2, v31
  v_xor_b32 v30, v30, v5
  v_xor_b32 v30, s22, v30
  v_mul_lo_u32 v31, v31, s21
  v_lshl_add_u32 v5, v30, 4, v31
  v_xor_b32 v8, 64, v5
  v_add_u32 v30, 128, v1
  v_mul_u32_u24 v31, 2731, v30
  v_lshrrev_b32 v31, 16, v31
  v_mul_u32_u24 v6, 24, v31
  v_sub_u32 v30, v30, v6
  v_and_b32 v6, 2, v31
  v_xor_b32 v30, v30, v6
  v_xor_b32 v30, s22, v30
  v_mul_lo_u32 v31, v31, s21
  v_lshl_add_u32 v6, v30, 4, v31
  v_xor_b32 v9, 64, v6
  s_mul_i32 s21, s20, 491520
  s_add_u32 s21, s21, 0
  s_add_u32 s21, s21, s44
  s_mul_i32 s22, s20, 15360
  s_add_u32 s22, s22, 0
  s_add_u32 m0, s22, 0
  s_nop 0
  buffer_load_dwordx4 v4, s[12:15], s21 offen lds
  s_add_u32 m0, s22, 1024
  s_nop 0
  buffer_load_dwordx4 v5, s[12:15], s21 offen lds
  s_add_u32 m0, s22, 2048
  s_nop 0
  buffer_load_dwordx4 v6, s[12:15], s21 offen lds
  s_mul_i32 s21, s20, 491520
  s_add_u32 s21, s21, 98304
  s_add_u32 s21, s21, s44
  s_mul_i32 s22, s20, 15360
  s_add_u32 s22, s22, 3072
  s_add_u32 m0, s22, 0
  s_nop 0
  buffer_load_dwordx4 v7, s[12:15], s21 offen lds
  s_add_u32 m0, s22, 1024
  s_nop 0
  buffer_load_dwordx4 v8, s[12:15], s21 offen lds
  s_add_u32 m0, s22, 2048
  s_nop 0
  buffer_load_dwordx4 v9, s[12:15], s21 offen lds
  s_mul_i32 s21, s20, 491520
  s_add_u32 s21, s21, 196608
  s_add_u32 s21, s21, s44
  s_mul_i32 s22, s20, 15360
  s_add_u32 s22, s22, 6144
  s_add_u32 m0, s22, 0
  s_nop 0
  buffer_load_dwordx4 v4, s[12:15], s21 offen lds
  s_add_u32 m0, s22, 1024
  s_nop 0
  buffer_load_dwordx4 v5, s[12:15], s21 offen lds
  s_add_u32 m0, s22, 2048
  s_nop 0
  buffer_load_dwordx4 v6, s[12:15], s21 offen lds
  s_mul_i32 s21, s20, 491520
  s_add_u32 s21, s21, 294912
  s_add_u32 s21, s21, s44
  s_mul_i32 s22, s20, 15360
  s_add_u32 s22, s22, 9216
  s_add_u32 m0, s22, 0
  s_nop 0
  buffer_load_dwordx4 v7, s[12:15], s21 offen lds
  s_add_u32 m0, s22, 1024
  s_nop 0
  buffer_load_dwordx4 v8, s[12:15], s21 offen lds
  s_add_u32 m0, s22, 2048
  s_nop 0
  buffer_load_dwordx4 v9, s[12:15], s21 offen lds
  s_mul_i32 s21, s20, 491520
  s_add_u32 s21, s21, 393216
  s_add_u32 s21, s21, s44
  s_mul_i32 s22, s20, 15360
  s_add_u32 s22, s22, 12288
  s_add_u32 m0, s22, 0
  s_nop 0
  buffer_load_dwordx4 v4, s[12:15], s21 offen lds
  s_add_u32 m0, s22, 1024
  s_nop 0
  buffer_load_dwordx4 v5, s[12:15], s21 offen lds
  s_add_u32 m0, s22, 2048
  s_nop 0
  buffer_load_dwordx4 v6, s[12:15], s21 offen lds
  s_mul_i32 s21, s20, 491520
  s_add_u32 s21, s21, 1966080
  s_add_u32 s21, s21, s44
  s_mul_i32 s22, s20, 15360
  s_add_u32 s22, s22, 61440
  s_add_u32 m0, s22, 0
  s_nop 0
  buffer_load_dwordx4 v4, s[12:15], s21 offen lds
  s_add_u32 m0, s22, 1024
  s_nop 0
  buffer_load_dwordx4 v5, s[12:15], s21 offen lds
  s_add_u32 m0, s22, 2048
  s_nop 0
  buffer_load_dwordx4 v6, s[12:15], s21 offen lds
  s_mul_i32 s21, s20, 491520
  s_add_u32 s21, s21, 2064384
  s_add_u32 s21, s21, s44
  s_mul_i32 s22, s20, 15360
  s_add_u32 s22, s22, 64512
  s_add_u32 m0, s22, 0
  s_nop 0
  buffer_load_dwordx4 v7, s[12:15], s21 offen lds
  s_add_u32 m0, s22, 1024
  s_nop 0
  buffer_load_dwordx4 v8, s[12:15], s21 offen lds
  s_add_u32 m0, s22, 2048
  s_nop 0
  buffer_load_dwordx4 v9, s[12:15], s21 offen lds
  s_mul_i32 s21, s20, 491520
  s_add_u32 s21, s21, 2162688
  s_add_u32 s21, s21, s44
  s_mul_i32 s22, s20, 15360
  s_add_u32 s22, s22, 67584
  s_add_u32 m0, s22, 0
  s_nop 0
  buffer_load_dwordx4 v4, s[12:15], s21 offen lds
  s_add_u32 m0, s22, 1024
  s_nop 0
  buffer_load_dwordx4 v5, s[12:15], s21 offen lds
  s_add_u32 m0, s22, 2048
  s_nop 0
  buffer_load_dwordx4 v6, s[12:15], s21 offen lds
  s_mul_i32 s21, s20, 491520
  s_add_u32 s21, s21, 2260992
  s_add_u32 s21, s21, s44
  s_mul_i32 s22, s20, 15360
  s_add_u32 s22, s22, 70656
  s_add_u32 m0, s22, 0
  s_nop 0
  buffer_load_dwordx4 v7, s[12:15], s21 offen lds
  s_add_u32 m0, s22, 1024
  s_nop 0
  buffer_load_dwordx4 v8, s[12:15], s21 offen lds
  s_add_u32 m0, s22, 2048
  s_nop 0
  buffer_load_dwordx4 v9, s[12:15], s21 offen lds
  s_mul_i32 s21, s20, 491520
  s_add_u32 s21, s21, 2359296
  s_add_u32 s21, s21, s44
  s_mul_i32 s22, s20, 15360
  s_add_u32 s22, s22, 73728
  s_add_u32 m0, s22, 0
  s_nop 0
  buffer_load_dwordx4 v4, s[12:15], s21 offen lds
  s_add_u32 m0, s22, 1024
  s_nop 0
  buffer_load_dwordx4 v5, s[12:15], s21 offen lds
  s_add_u32 m0, s22, 2048
  s_nop 0
  buffer_load_dwordx4 v6, s[12:15], s21 offen lds
  s_waitcnt vmcnt(33)
  s_mul_i32 s21, s20, 491520
  s_add_u32 s21, s21, 3932160
  s_add_u32 s21, s21, s44
  buffer_load_dwordx4 v[64:67], v4, s[12:15], s21 offen
  buffer_load_dwordx4 v[68:71], v5, s[12:15], s21 offen
  buffer_load_dwordx4 v[72:75], v6, s[12:15], s21 offen
  s_mul_i32 s21, s20, 491520
  s_add_u32 s21, s21, 4030464
  s_add_u32 s21, s21, s44
  buffer_load_dwordx4 v[76:79], v7, s[12:15], s21 offen
  buffer_load_dwordx4 v[80:83], v8, s[12:15], s21 offen
  buffer_load_dwordx4 v[84:87], v9, s[12:15], s21 offen
  s_mul_i32 s21, s20, 491520
  s_add_u32 s21, s21, 4128768
  s_add_u32 s21, s21, s44
  buffer_load_dwordx4 v[88:91], v4, s[12:15], s21 offen
  buffer_load_dwordx4 v[92:95], v5, s[12:15], s21 offen
  buffer_load_dwordx4 v[96:99], v6, s[12:15], s21 offen
  s_mul_i32 s21, s20, 491520
  s_add_u32 s21, s21, 4227072
  s_add_u32 s21, s21, s44
  buffer_load_dwordx4 v[100:103], v7, s[12:15], s21 offen
  buffer_load_dwordx4 v[104:107], v8, s[12:15], s21 offen
  buffer_load_dwordx4 v[108:111], v9, s[12:15], s21 offen
  s_mul_i32 s21, s20, 491520
  s_add_u32 s21, s21, 4325376
  s_add_u32 s21, s21, s44
  buffer_load_dwordx4 v[112:115], v4, s[12:15], s21 offen
  buffer_load_dwordx4 v[116:119], v5, s[12:15], s21 offen
  buffer_load_dwordx4 v[120:123], v6, s[12:15], s21 offen
  s_mul_i32 s21, s20, 491520
  s_add_u32 s21, s21, 5898240
  s_add_u32 s21, s21, s44
  buffer_load_dwordx4 v[124:127], v4, s[12:15], s21 offen
  buffer_load_dwordx4 v[128:131], v5, s[12:15], s21 offen
  buffer_load_dwordx4 v[132:135], v6, s[12:15], s21 offen
  s_mul_i32 s21, s20, 491520
  s_add_u32 s21, s21, 5996544
  s_add_u32 s21, s21, s44
  buffer_load_dwordx4 v[136:139], v7, s[12:15], s21 offen
  buffer_load_dwordx4 v[140:143], v8, s[12:15], s21 offen
  buffer_load_dwordx4 v[144:147], v9, s[12:15], s21 offen
  s_mul_i32 s21, s20, 491520
  s_add_u32 s21, s21, 6094848
  s_add_u32 s21, s21, s44
  buffer_load_dwordx4 v[148:151], v4, s[12:15], s21 offen
  buffer_load_dwordx4 v[152:155], v5, s[12:15], s21 offen
  buffer_load_dwordx4 v[156:159], v6, s[12:15], s21 offen
  s_mul_i32 s21, s20, 491520
  s_add_u32 s21, s21, 6193152
  s_add_u32 s21, s21, s44
  buffer_load_dwordx4 v[160:163], v7, s[12:15], s21 offen
  buffer_load_dwordx4 v[164:167], v8, s[12:15], s21 offen
  buffer_load_dwordx4 v[168:171], v9, s[12:15], s21 offen
  s_mul_i32 s21, s20, 491520
  s_add_u32 s21, s21, 6291456
  s_add_u32 s21, s21, s44
  buffer_load_dwordx4 v[172:175], v4, s[12:15], s21 offen
  buffer_load_dwordx4 v[176:179], v5, s[12:15], s21 offen
  buffer_load_dwordx4 v[180:183], v6, s[12:15], s21 offen
  v_lshrrev_b32 v30, 2, v2
  v_lshl_add_u32 v30, v3, 3, v30
  v_mul_u32_u24 v30, 384, v30
  v_and_b32 v31, 3, v2
  v_lshl_add_u32 v30, v31, 3, v30
  v_lshrrev_b32 v31, 3, v1
  v_and_b32 v31, 3, v31
  v_lshlrev_b32 v31, 5, v31
  s_mul_i32 s21, s20, 96
  s_add_u32 s21, s21, 0
  v_xor_b32 v184, s21, v31
  v_add_u32 v184, v184, v30
  v_add_u32 v187, 61440, v184
  s_mul_i32 s21, s20, 96
  s_add_u32 s21, s21, 32
  v_xor_b32 v185, s21, v31
  v_add_u32 v185, v185, v30
  v_add_u32 v188, 61440, v185
  s_mul_i32 s21, s20, 96
  s_add_u32 s21, s21, 64
  v_xor_b32 v186, s21, v31
  v_add_u32 v186, v186, v30
  v_add_u32 v189, 61440, v186
  s_mul_i32 s22, s20, 15360
  v_lshl_add_u32 v30, v1, 4, s22
  v_add_u32 v31, 61440, v30
  s_waitcnt vmcnt(45)
  s_barrier
  ds_read_b64_tr_b16 a[0:1], v184 offset:0
  ds_read_b64_tr_b16 a[2:3], v184 offset:1536
  ds_read_b64_tr_b16 a[4:5], v185 offset:0
  ds_read_b64_tr_b16 a[6:7], v185 offset:1536
  ds_read_b64_tr_b16 a[8:9], v186 offset:0
  ds_read_b64_tr_b16 a[10:11], v186 offset:1536
  ds_read_b64_tr_b16 a[12:13], v184 offset:12288
  ds_read_b64_tr_b16 a[14:15], v184 offset:13824
  ds_read_b64_tr_b16 a[16:17], v185 offset:12288
  ds_read_b64_tr_b16 a[18:19], v185 offset:13824
  ds_read_b64_tr_b16 a[20:21], v186 offset:12288
  ds_read_b64_tr_b16 a[22:23], v186 offset:13824
  ds_read_b64_tr_b16 a[24:25], v184 offset:24576
  ds_read_b64_tr_b16 a[26:27], v184 offset:26112
  ds_read_b64_tr_b16 a[28:29], v185 offset:24576
  ds_read_b64_tr_b16 a[30:31], v185 offset:26112
  ds_read_b64_tr_b16 a[32:33], v186 offset:24576
  ds_read_b64_tr_b16 a[34:35], v186 offset:26112
  ds_read_b64_tr_b16 a[36:37], v184 offset:36864
  ds_read_b64_tr_b16 a[38:39], v184 offset:38400
  ds_read_b64_tr_b16 a[40:41], v185 offset:36864
  ds_read_b64_tr_b16 a[42:43], v185 offset:38400
  ds_read_b64_tr_b16 a[44:45], v186 offset:36864
  ds_read_b64_tr_b16 a[46:47], v186 offset:38400
  ds_read_b64_tr_b16 a[48:49], v184 offset:49152
  ds_read_b64_tr_b16 a[50:51], v184 offset:50688
  ds_read_b64_tr_b16 a[52:53], v185 offset:49152
  ds_read_b64_tr_b16 a[54:55], v185 offset:50688
  ds_read_b64_tr_b16 a[56:57], v186 offset:49152
  ds_read_b64_tr_b16 a[58:59], v186 offset:50688
  s_waitcnt lgkmcnt(0)
  s_barrier
  s_cmp_lg_u32 s40, 0
  s_cbranch_scc1 qg_264
  s_add_u32 s28, s38, 180355072
  s_addc_u32 s29, s39, 0
  s_mov_b32 s30, 4194304
  s_mov_b32 s31, 0x00020000
  v_lshrrev_b32 v22, 2, v2
  v_and_b32 v23, 3, v2
  v_lshlrev_b32 v23, 3, v23
  v_lshl_add_u32 v24, v3, 2, v22
  v_mul_u32_u24 v24, 160, v24
  s_mul_i32 s21, s20, 6400
  s_add_u32 s21, s21, 122880
  v_add3_u32 v24, v24, v23, s21
  v_add_u32 v25, v24, v23
  v_mul_u32_u24 v26, 20, v3
  v_add_u32 v26, v26, v22
  v_mul_u32_u24 v26, 160, v26
  s_mov_b32 s21, 122880
  v_add3_u32 v26, v26, v23, s21
  v_add_u32 v27, v26, v23
  s_and_b32 s22, s2, 7
  s_lshr_b32 s23, s2, 3
  ds_read_b64_tr_b16 v[192:193], v25 offset:0
  ds_read_b64_tr_b16 v[194:195], v25 offset:3200
  ds_read_b64_tr_b16 v[196:197], v25 offset:8
  ds_read_b64_tr_b16 v[198:199], v25 offset:3208
  ds_read_b64_tr_b16 v[200:201], v24 offset:64
  ds_read_b64_tr_b16 v[202:203], v24 offset:3264
  ds_read_b64_tr_b16 v[204:205], v25 offset:96
  ds_read_b64_tr_b16 v[206:207], v25 offset:3296
  ds_read_b64_tr_b16 v[208:209], v25 offset:104
  ds_read_b64_tr_b16 v[210:211], v25 offset:3304
  ds_read_b64_tr_b16 v[212:213], v27 offset:2560
  ds_read_b64_tr_b16 v[214:215], v27 offset:15360
  ds_read_b64_tr_b16 v[216:217], v27 offset:2568
  ds_read_b64_tr_b16 v[218:219], v27 offset:15368
  ds_read_b64_tr_b16 v[220:221], v26 offset:2624
  ds_read_b64_tr_b16 v[222:223], v26 offset:15424
  ds_read_b64_tr_b16 v[224:225], v27 offset:2656
  ds_read_b64_tr_b16 v[226:227], v27 offset:15456
  ds_read_b64_tr_b16 v[228:229], v27 offset:2664
  ds_read_b64_tr_b16 v[230:231], v27 offset:15464
  s_lshl_b32 s22, s22, 2
  s_add_u32 s22, s22, s23
  s_lshl_b32 s22, s22, 17
  s_lshr_b32 s21, s22, 8
  s_andn2_b32 s21, 8192, s21
  s_xor_b32 s21, s21, s80
  s_add_u32 s22, s22, s21
  s_add_u32 s23, s22, 65536
  s_cmp_eq_u32 s20, 0
  s_cselect_b32 s23, s23, 0x40000000
  s_lshl_b32 s21, s20, 14
  s_add_u32 s22, s22, s21
  v_add_u32 v22, 4096, v11
  s_waitcnt lgkmcnt(0)
  buffer_store_dwordx4 v[192:195], v11, s[28:31], s22 offen offset:0 sc1
  buffer_store_dwordx4 v[196:199], v11, s[28:31], s22 offen offset:1024 sc1
  buffer_store_dwordx4 v[200:203], v11, s[28:31], s22 offen offset:2048 sc1
  buffer_store_dwordx4 v[204:207], v11, s[28:31], s22 offen offset:3072 sc1
  buffer_store_dwordx4 v[208:211], v22, s[28:31], s22 offen offset:0 sc1
  buffer_store_dwordx4 v[212:215], v11, s[28:31], s23 offen offset:0 sc1
  buffer_store_dwordx4 v[216:219], v11, s[28:31], s23 offen offset:1024 sc1
  buffer_store_dwordx4 v[220:223], v11, s[28:31], s23 offen offset:2048 sc1
  buffer_store_dwordx4 v[224:227], v11, s[28:31], s23 offen offset:3072 sc1
  buffer_store_dwordx4 v[228:231], v22, s[28:31], s23 offen offset:0 sc1
qg_264:
  s_waitcnt vmcnt(30)
  s_barrier
  ds_read_b64_tr_b16 a[60:61], v187 offset:0
  ds_read_b64_tr_b16 a[62:63], v187 offset:1536
  ds_read_b64_tr_b16 a[64:65], v188 offset:0
  ds_read_b64_tr_b16 a[66:67], v188 offset:1536
  ds_read_b64_tr_b16 a[68:69], v189 offset:0
  ds_read_b64_tr_b16 a[70:71], v189 offset:1536
  ds_read_b64_tr_b16 a[72:73], v187 offset:12288
  ds_read_b64_tr_b16 a[74:75], v187 offset:13824
  ds_read_b64_tr_b16 a[76:77], v188 offset:12288
  ds_read_b64_tr_b16 a[78:79], v188 offset:13824
  ds_read_b64_tr_b16 a[80:81], v189 offset:12288
  ds_read_b64_tr_b16 a[82:83], v189 offset:13824
  ds_read_b64_tr_b16 a[84:85], v187 offset:24576
  ds_read_b64_tr_b16 a[86:87], v187 offset:26112
  ds_read_b64_tr_b16 a[88:89], v188 offset:24576
  ds_read_b64_tr_b16 a[90:91], v188 offset:26112
  ds_read_b64_tr_b16 a[92:93], v189 offset:24576
  ds_read_b64_tr_b16 a[94:95], v189 offset:26112
  ds_read_b64_tr_b16 a[96:97], v187 offset:36864
  ds_read_b64_tr_b16 a[98:99], v187 offset:38400
  ds_read_b64_tr_b16 a[100:101], v188 offset:36864
  ds_read_b64_tr_b16 a[102:103], v188 offset:38400
  ds_read_b64_tr_b16 a[104:105], v189 offset:36864
  ds_read_b64_tr_b16 a[106:107], v189 offset:38400
  ds_read_b64_tr_b16 a[108:109], v187 offset:49152
  ds_read_b64_tr_b16 a[110:111], v187 offset:50688
  ds_read_b64_tr_b16 a[112:113], v188 offset:49152
  ds_read_b64_tr_b16 a[114:115], v188 offset:50688
  ds_read_b64_tr_b16 a[116:117], v189 offset:49152
  ds_read_b64_tr_b16 a[118:119], v189 offset:50688
  s_waitcnt lgkmcnt(0)
  s_barrier
  s_waitcnt vmcnt(15)
  ds_write_b128 v30, v[64:67] offset:0
  ds_write_b128 v30, v[68:71] offset:1024
  ds_write_b128 v30, v[72:75] offset:2048
  ds_write_b128 v30, v[76:79] offset:3072
  ds_write_b128 v30, v[80:83] offset:4096
  ds_write_b128 v30, v[84:87] offset:5120
  ds_write_b128 v30, v[88:91] offset:6144
  ds_write_b128 v30, v[92:95] offset:7168
  ds_write_b128 v30, v[96:99] offset:8192
  ds_write_b128 v30, v[100:103] offset:9216
  ds_write_b128 v30, v[104:107] offset:10240
  ds_write_b128 v30, v[108:111] offset:11264
  ds_write_b128 v30, v[112:115] offset:12288
  ds_write_b128 v30, v[116:119] offset:13312
  ds_write_b128 v30, v[120:123] offset:14336
  s_waitcnt lgkmcnt(0)
  s_barrier
  ds_read_b64_tr_b16 a[120:121], v184 offset:0
  ds_read_b64_tr_b16 a[122:123], v184 offset:1536
  ds_read_b64_tr_b16 a[124:125], v185 offset:0
  ds_read_b64_tr_b16 a[126:127], v185 offset:1536
  ds_read_b64_tr_b16 a[128:129], v186 offset:0
  ds_read_b64_tr_b16 a[130:131], v186 offset:1536
  ds_read_b64_tr_b16 a[132:133], v184 offset:12288
  ds_read_b64_tr_b16 a[134:135], v184 offset:13824
  ds_read_b64_tr_b16 a[136:137], v185 offset:12288
  ds_read_b64_tr_b16 a[138:139], v185 offset:13824
  ds_read_b64_tr_b16 a[140:141], v186 offset:12288
  ds_read_b64_tr_b16 a[142:143], v186 offset:13824
  ds_read_b64_tr_b16 a[144:145], v184 offset:24576
  ds_read_b64_tr_b16 a[146:147], v184 offset:26112
  ds_read_b64_tr_b16 a[148:149], v185 offset:24576
  ds_read_b64_tr_b16 a[150:151], v185 offset:26112
  ds_read_b64_tr_b16 a[152:153], v186 offset:24576
  ds_read_b64_tr_b16 a[154:155], v186 offset:26112
  ds_read_b64_tr_b16 a[156:157], v184 offset:36864
  ds_read_b64_tr_b16 a[158:159], v184 offset:38400
  ds_read_b64_tr_b16 a[160:161], v185 offset:36864
  ds_read_b64_tr_b16 a[162:163], v185 offset:38400
  ds_read_b64_tr_b16 a[164:165], v186 offset:36864
  ds_read_b64_tr_b16 a[166:167], v186 offset:38400
  ds_read_b64_tr_b16 a[168:169], v184 offset:49152
  ds_read_b64_tr_b16 a[170:171], v184 offset:50688
  ds_read_b64_tr_b16 a[172:173], v185 offset:49152
  ds_read_b64_tr_b16 a[174:175], v185 offset:50688
  ds_read_b64_tr_b16 a[176:177], v186 offset:49152
  ds_read_b64_tr_b16 a[178:179], v186 offset:50688
  s_waitcnt lgkmcnt(0)
  s_barrier
  s_waitcnt vmcnt(0)
  s_cmp_eq_u32 s40, 0
  s_cselect_b32 s30, 0, 2457600
  v_lshrrev_b32 v4, 3, v1
  v_and_b32 v5, 7, v1
  v_xor_b32 v5, v5, v4
  s_mul_i32 s21, s20, 32
  v_add_u32 v4, s21, v4
  v_mul_u32_u24 v4, 1280, v4
  v_lshl_add_u32 v10, v5, 4, v4
  s_mul_i32 s31, s20, 4096
  v_add_u32 v11, 10240, v10
  v_add_u32 v12, 20480, v10
  v_add_u32 v13, 30720, v10
  s_add_u32 m0, s31, 0
  s_nop 0
  buffer_load_dwordx4 v10, s[8:11], s30 offen lds
  s_add_u32 m0, s31, 1024
  s_nop 0
  buffer_load_dwordx4 v11, s[8:11], s30 offen lds
  s_add_u32 m0, s31, 2048
  s_nop 0
  buffer_load_dwordx4 v12, s[8:11], s30 offen lds
  s_add_u32 m0, s31, 3072
  s_nop 0
  buffer_load_dwordx4 v13, s[8:11], s30 offen lds
  s_add_u32 s30, s30, 128
  s_add_u32 m0, s31, 16384
  s_nop 0
  buffer_load_dwordx4 v10, s[8:11], s30 offen lds
  s_add_u32 m0, s31, 17408
  s_nop 0
  buffer_load_dwordx4 v11, s[8:11], s30 offen lds
  s_add_u32 m0, s31, 18432
  s_nop 0
  buffer_load_dwordx4 v12, s[8:11], s30 offen lds
  s_add_u32 m0, s31, 19456
  s_nop 0
  buffer_load_dwordx4 v13, s[8:11], s30 offen lds
  s_add_u32 s30, s30, 128
  s_add_u32 m0, s31, 32768
  s_nop 0
  buffer_load_dwordx4 v10, s[8:11], s30 offen lds
  s_add_u32 m0, s31, 33792
  s_nop 0
  buffer_load_dwordx4 v11, s[8:11], s30 offen lds
  s_add_u32 m0, s31, 34816
  s_nop 0
  buffer_load_dwordx4 v12, s[8:11], s30 offen lds
  s_add_u32 m0, s31, 35840
  s_nop 0
  buffer_load_dwordx4 v13, s[8:11], s30 offen lds
  s_add_u32 s30, s30, 128
  ds_write_b128 v31, v[124:127] offset:0
  ds_write_b128 v31, v[128:131] offset:1024
  ds_write_b128 v31, v[132:135] offset:2048
  ds_write_b128 v31, v[136:139] offset:3072
  ds_write_b128 v31, v[140:143] offset:4096
  ds_write_b128 v31, v[144:147] offset:5120
  ds_write_b128 v31, v[148:151] offset:6144
  ds_write_b128 v31, v[152:155] offset:7168
  ds_write_b128 v31, v[156:159] offset:8192
  ds_write_b128 v31, v[160:163] offset:9216
  ds_write_b128 v31, v[164:167] offset:10240
  ds_write_b128 v31, v[168:171] offset:11264
  ds_write_b128 v31, v[172:175] offset:12288
  ds_write_b128 v31, v[176:179] offset:13312
  ds_write_b128 v31, v[180:183] offset:14336
  s_waitcnt lgkmcnt(0)
  s_barrier
  ds_read_b64_tr_b16 a[180:181], v187 offset:0
  ds_read_b64_tr_b16 a[182:183], v187 offset:1536
  ds_read_b64_tr_b16 a[184:185], v188 offset:0
  ds_read_b64_tr_b16 a[186:187], v188 offset:1536
  ds_read_b64_tr_b16 a[188:189], v189 offset:0
  ds_read_b64_tr_b16 a[190:191], v189 offset:1536
  ds_read_b64_tr_b16 a[192:193], v187 offset:12288
  ds_read_b64_tr_b16 a[194:195], v187 offset:13824
  ds_read_b64_tr_b16 a[196:197], v188 offset:12288
  ds_read_b64_tr_b16 a[198:199], v188 offset:13824
  ds_read_b64_tr_b16 a[200:201], v189 offset:12288
  ds_read_b64_tr_b16 a[202:203], v189 offset:13824
  ds_read_b64_tr_b16 a[204:205], v187 offset:24576
  ds_read_b64_tr_b16 a[206:207], v187 offset:26112
  ds_read_b64_tr_b16 a[208:209], v188 offset:24576
  ds_read_b64_tr_b16 a[210:211], v188 offset:26112
  ds_read_b64_tr_b16 a[212:213], v189 offset:24576
  ds_read_b64_tr_b16 a[214:215], v189 offset:26112
  ds_read_b64_tr_b16 a[216:217], v187 offset:36864
  ds_read_b64_tr_b16 a[218:219], v187 offset:38400
  ds_read_b64_tr_b16 a[220:221], v188 offset:36864
  ds_read_b64_tr_b16 a[222:223], v188 offset:38400
  ds_read_b64_tr_b16 a[224:225], v189 offset:36864
  ds_read_b64_tr_b16 a[226:227], v189 offset:38400
  ds_read_b64_tr_b16 a[228:229], v187 offset:49152
  ds_read_b64_tr_b16 a[230:231], v187 offset:50688
  ds_read_b64_tr_b16 a[232:233], v188 offset:49152
  ds_read_b64_tr_b16 a[234:235], v188 offset:50688
  ds_read_b64_tr_b16 a[236:237], v189 offset:49152
  ds_read_b64_tr_b16 a[238:239], v189 offset:50688
  s_waitcnt lgkmcnt(0)
  s_barrier
  s_and_b32 s21, s2, 3
  s_lshl_b32 s21, s21, 7
  s_add_u32 s21, s21, 29696
  s_xor_b32 s21, s21, s80
  s_cmp_lg_u32 s40, 0
  s_cbranch_scc1 qg_265
  s_cmp_lg_u32 s20, 0
  s_cbranch_scc1 af_266
  v_mov_b32 v8, 0
  v_mov_b32 v9, 1
  s_mov_b64 exec, 1
  buffer_atomic_add v9, v8, s[72:75], s21 offen sc1
  s_mov_b64 exec, -1
  s_nop 1
af_266:
qg_265:
  s_add_u32 s56, s38, 218103808
  s_addc_u32 s57, s39, 0
  s_mov_b32 s58, 12582912
  s_mov_b32 s59, 0x00020000
  s_cmp_eq_u32 s40, 0
  s_cselect_b32 s85, 1, 2
  s_cselect_b32 s91, 0, 1
  s_sub_u32 s87, s41, s91
  s_add_u32 s89, s87, 1
  s_mul_i32 s90, s41, 163840
  s_sub_u32 s90, 162688, s90
  s_mov_b32 s26, s41
  s_mul_i32 s86, s42, 393216
  s_lshl_b32 s46, s40, 2
  s_add_u32 s46, s46, s20
  v_and_b32 v6, 7, v2
  v_add_u32 v4, 0, v3
  v_xor_b32 v4, v4, v6
  v_lshlrev_b32 v4, 4, v4
  v_lshl_add_u32 v14, v2, 7, v4
  v_add_u32 v16, 65536, v14
  v_add_u32 v18, 131072, v14
  v_add_u32 v4, 4, v3
  v_xor_b32 v4, v4, v6
  v_lshlrev_b32 v4, 4, v4
  v_lshl_add_u32 v15, v2, 7, v4
  v_add_u32 v17, 65536, v15
  v_add_u32 v19, 131072, v15
  v_lshlrev_b32 v26, 4, v1
  v_mov_b32 v28, 1
  v_mov_b32 v4, 0x40000000
  v_cmp_eq_u32 vcc, 0, v0
  s_nop 1
  v_cndmask_b32 v27, v4, 0, vcc
  s_mul_i32 s21, s20, 3072
  s_add_u32 s21, s21, 81920
  v_add_u32 v20, s21, v26
  s_mul_i32 s21, s20, 12288
  s_add_u32 s21, s21, 81920
  v_add_u32 v21, s21, v26
  v_add_u32 v22, 2048, v21
  v_add_u32 v23, 2056, v21
  v_and_b32 v4, 7, v2
  v_lshlrev_b32 v4, 4, v4
  v_lshl_add_u32 v24, v3, 7, v4
  v_lshrrev_b32 v25, 1, v24
  v_lshlrev_b32 v29, 3, v1
  v_and_b32 v4, 3, v1
  v_lshlrev_b32 v30, 3, v4
  v_mov_b32 v31, 0xf149f2ca
  v_mov_b32 v32, 0
  v_mov_b32 v4, 1073741824
  v_cmp_eq_u32 vcc, 0, v1
  v_lshlrev_b32 v5, 2, v3
  v_sub_u32 v5, v2, v5
  v_cndmask_b32 v33, v4, 0, vcc
  v_cmp_gt_u32 s[62:63], 2, v3
  s_mov_b32 s83, 0x3dd53b95
  s_lshl_b32 s77, s42, 7
  s_add_u32 s77, s77, 0
  s_xor_b32 s77, s77, s80
  s_lshl_b32 s45, s46, 21
  s_lshl_b32 s21, s46, 13
  s_and_b32 s21, s21, 8192
  s_xor_b32 s21, s21, s80
  s_add_u32 s45, s45, s21
  s_lshl_b32 s21, s42, 16
  s_add_u32 s45, s45, s21
  s_lshr_b32 s47, s42, 1
  s_lshl_b32 s47, s47, 14
  s_and_b32 s22, s42, 1
  s_mul_i32 s22, s22, 2560
  s_add_u32 s47, s47, s22
  s_lshl_b32 s21, s46, 19
  s_lshl_b32 s22, s46, 11
  s_and_b32 s22, s22, 8192
  s_xor_b32 s22, s22, s80
  s_add_u32 s21, s21, s22
  s_add_u32 s21, s21, 136314880
  s_xor_b32 s21, s21, 8192
  s_add_u32 s47, s47, s21
  s_add_u32 s47, s47, 48234496
  s_lshl_b32 s48, s46, 7
  s_add_u32 s48, s48, 8192
  s_xor_b32 s48, s48, s80
  s_add_u32 s43, s46, 1
  s_mov_b32 s49, 0
  s_mov_b32 s50, 1073741824
  s_mov_b32 s81, 1073741824
  s_mov_b32 s82, 1073741824
  s_mov_b32 s84, 1073741824
  v_cmp_le_i32 s[64:65], 0, v5
  v_cmp_le_i32 s[66:67], 1, v5
  v_cmp_le_i32 s[68:69], 2, v5
  v_cmp_le_i32 s[70:71], 3, v5
  s_waitcnt vmcnt(8)
  s_barrier
  ds_read_b128 v[160:163], v14 offset:0
  ds_read_b128 v[164:167], v14 offset:2048
  ds_read_b128 v[168:171], v14 offset:4096
  ds_read_b128 v[172:175], v14 offset:6144
  s_waitcnt lgkmcnt(3)
  .p2align 3
qa_271:
  v_mfma_f32_16x16x32_bf16 v[64:67], a[0:3], v[160:163], 0
  ds_read_b128 v[176:179], v14 offset:8192
  v_cvt_pk_bf16_f32 v221, v126, v127
  v_mfma_f32_16x16x32_bf16 v[68:71], a[4:7], v[160:163], 0
  v_cvt_pk_bf16_f32 v222, v128, v129
  v_cvt_pk_bf16_f32 v223, v130, v131
  v_mfma_f32_16x16x32_bf16 v[72:75], a[8:11], v[160:163], 0
  s_waitcnt lgkmcnt(3)
  v_cvt_pk_bf16_f32 v226, v132, v133
  v_cvt_pk_bf16_f32 v227, v134, v135
  v_mfma_f32_16x16x32_bf16 v[76:79], a[0:3], v[164:167], 0
  ds_read_b128 v[180:183], v14 offset:10240
  v_cvt_pk_bf16_f32 v228, v136, v137
  v_mfma_f32_16x16x32_bf16 v[80:83], a[4:7], v[164:167], 0
  v_cvt_pk_bf16_f32 v229, v138, v139
  v_cvt_pk_bf16_f32 v230, v140, v141
  v_mfma_f32_16x16x32_bf16 v[84:87], a[8:11], v[164:167], 0
  s_waitcnt lgkmcnt(3)
  v_cvt_pk_bf16_f32 v231, v142, v143
  v_cvt_pk_bf16_f32 v236, v144, v145
  v_mfma_f32_16x16x32_bf16 v[88:91], a[0:3], v[168:171], 0
  ds_read_b128 v[184:187], v14 offset:12288
  v_cvt_pk_bf16_f32 v237, v146, v147
  v_mfma_f32_16x16x32_bf16 v[92:95], a[4:7], v[168:171], 0
  v_cvt_pk_bf16_f32 v232, v148, v149
  v_cvt_pk_bf16_f32 v233, v150, v151
  v_mfma_f32_16x16x32_bf16 v[96:99], a[8:11], v[168:171], 0
  s_waitcnt lgkmcnt(3)
  v_cvt_pk_bf16_f32 v234, v152, v153
  v_cvt_pk_bf16_f32 v235, v154, v155
  v_mfma_f32_16x16x32_bf16 v[100:103], a[0:3], v[172:175], 0
  ds_read_b128 v[188:191], v14 offset:14336
  v_cvt_pk_bf16_f32 v238, v156, v157
  v_mfma_f32_16x16x32_bf16 v[104:107], a[4:7], v[172:175], 0
  v_cvt_pk_bf16_f32 v239, v158, v159
  ds_write_b128 v20, v[192:195] offset:0
  v_mfma_f32_16x16x32_bf16 v[108:111], a[8:11], v[172:175], 0
  s_waitcnt lgkmcnt(4)
  v_mfma_f32_16x16x32_bf16 v[112:115], a[0:3], v[176:179], 0
  ds_read_b128 v[160:163], v15 offset:0
  s_waitcnt vmcnt(4)
  v_mfma_f32_16x16x32_bf16 v[116:119], a[4:7], v[176:179], 0
  s_add_u32 m0, s31, 49152
  v_cmp_gt_u32 vcc, s49, v32
  v_mfma_f32_16x16x32_bf16 v[120:123], a[8:11], v[176:179], 0
  s_waitcnt lgkmcnt(4)
  buffer_load_dwordx4 v10, s[8:11], s30 offen lds
  s_cbranch_vccnz qw_272
qj_273:
  v_mfma_f32_16x16x32_bf16 v[124:127], a[0:3], v[180:183], 0
  s_add_u32 s29, s50, 4096
  ds_read_b128 v[164:167], v15 offset:2048
  ds_write_b128 v20, v[196:199] offset:1024
  v_mfma_f32_16x16x32_bf16 v[128:131], a[4:7], v[180:183], 0
  v_mfma_f32_16x16x32_bf16 v[132:135], a[8:11], v[180:183], 0
  s_waitcnt lgkmcnt(5)
  buffer_load_dwordx4 a[240:243], v24, s[16:19], s29 offen offset:2560 sc1
  v_mfma_f32_16x16x32_bf16 v[136:139], a[0:3], v[184:187], 0
  ds_read_b128 v[168:171], v15 offset:4096
  v_mfma_f32_16x16x32_bf16 v[140:143], a[4:7], v[184:187], 0
  s_add_u32 m0, s31, 50176
  v_mfma_f32_16x16x32_bf16 v[144:147], a[8:11], v[184:187], 0
  s_waitcnt lgkmcnt(5)
  buffer_load_dwordx4 v11, s[8:11], s30 offen lds
  ds_write_b128 v20, v[200:203] offset:2048
  v_mfma_f32_16x16x32_bf16 v[148:151], a[0:3], v[188:191], 0
  ds_read_b128 v[172:175], v15 offset:6144
  v_mfma_f32_16x16x32_bf16 v[152:155], a[4:7], v[188:191], 0
  v_mfma_f32_16x16x32_bf16 v[156:159], a[8:11], v[188:191], 0
  s_waitcnt lgkmcnt(5)
  buffer_load_dwordx2 v[240:241], v25, s[16:19], s29 offen offset:3072 sc1
  s_add_u32 s29, s50, 20480
  v_mfma_f32_16x16x32_bf16 v[64:67], a[12:15], v[160:163], v[64:67]
  ds_read_b128 v[176:179], v15 offset:8192
  v_mfma_f32_16x16x32_bf16 v[68:71], a[16:19], v[160:163], v[68:71]
  s_add_u32 m0, s31, 51200
  ds_write_b128 v20, v[204:207] offset:12288
  v_mfma_f32_16x16x32_bf16 v[72:75], a[20:23], v[160:163], v[72:75]
  s_waitcnt lgkmcnt(6)
  buffer_load_dwordx4 v12, s[8:11], s30 offen lds
  v_mfma_f32_16x16x32_bf16 v[76:79], a[12:15], v[164:167], v[76:79]
  ds_read_b128 v[180:183], v15 offset:10240
  v_mfma_f32_16x16x32_bf16 v[80:83], a[16:19], v[164:167], v[80:83]
  v_mfma_f32_16x16x32_bf16 v[84:87], a[20:23], v[164:167], v[84:87]
  s_waitcnt lgkmcnt(5)
  buffer_load_dwordx4 a[244:247], v24, s[16:19], s29 offen offset:2560 sc1
  v_mfma_f32_16x16x32_bf16 v[88:91], a[12:15], v[168:171], v[88:91]
  ds_read_b128 v[184:187], v15 offset:12288
  ds_write_b128 v20, v[208:211] offset:13312
  v_mfma_f32_16x16x32_bf16 v[92:95], a[16:19], v[168:171], v[92:95]
  s_add_u32 m0, s31, 52224
  v_mfma_f32_16x16x32_bf16 v[96:99], a[20:23], v[168:171], v[96:99]
  s_waitcnt lgkmcnt(5)
  buffer_load_dwordx4 v13, s[8:11], s30 offen lds
  v_mfma_f32_16x16x32_bf16 v[100:103], a[12:15], v[172:175], v[100:103]
  s_add_u32 s30, s30, 128
  ds_read_b128 v[188:191], v15 offset:14336
  v_mfma_f32_16x16x32_bf16 v[104:107], a[16:19], v[172:175], v[104:107]
  v_mfma_f32_16x16x32_bf16 v[108:111], a[20:23], v[172:175], v[108:111]
  s_waitcnt lgkmcnt(5)
  ds_write_b128 v20, v[212:215] offset:14336
  v_mfma_f32_16x16x32_bf16 v[112:115], a[12:15], v[176:179], v[112:115]
  s_waitcnt vmcnt(11)
  s_barrier
  ds_read_b128 v[160:163], v14 offset:16384
  v_mfma_f32_16x16x32_bf16 v[116:119], a[16:19], v[176:179], v[116:119]
  s_waitcnt vmcnt(13)
  buffer_atomic_add v28, v33, s[72:75], s84 offen sc1
  v_mfma_f32_16x16x32_bf16 v[120:123], a[20:23], v[176:179], v[120:123]
  s_waitcnt lgkmcnt(5)
  v_mfma_f32_16x16x32_bf16 v[124:127], a[12:15], v[180:183], v[124:127]
  ds_read_b128 v[164:167], v14 offset:18432
  v_mfma_f32_16x16x32_bf16 v[128:131], a[16:19], v[180:183], v[128:131]
  ds_write_b128 v20, v[216:219] offset:24576
  buffer_load_dwordx2 v[242:243], v25, s[16:19], s29 offen offset:3072 sc1
  v_mfma_f32_16x16x32_bf16 v[132:135], a[20:23], v[180:183], v[132:135]
  s_add_u32 s29, s50, 36864
  s_waitcnt lgkmcnt(6)
  v_mfma_f32_16x16x32_bf16 v[136:139], a[12:15], v[184:187], v[136:139]
  ds_read_b128 v[168:171], v14 offset:20480
  v_mfma_f32_16x16x32_bf16 v[140:143], a[16:19], v[184:187], v[140:143]
  buffer_load_dwordx4 a[248:251], v24, s[16:19], s29 offen offset:2560 sc1
  v_mfma_f32_16x16x32_bf16 v[144:147], a[20:23], v[184:187], v[144:147]
  s_waitcnt lgkmcnt(5)
  v_mfma_f32_16x16x32_bf16 v[148:151], a[12:15], v[188:191], v[148:151]
  ds_read_b128 v[172:175], v14 offset:22528
  ds_write_b128 v20, v[220:223] offset:25600
  v_mfma_f32_16x16x32_bf16 v[152:155], a[16:19], v[188:191], v[152:155]
  buffer_load_dwordx2 v[244:245], v25, s[16:19], s29 offen offset:3072 sc1
  s_add_u32 s29, s50, 53248
  v_mfma_f32_16x16x32_bf16 v[156:159], a[20:23], v[188:191], v[156:159]
  s_waitcnt lgkmcnt(5)
  v_mfma_f32_16x16x32_bf16 v[64:67], a[24:27], v[160:163], v[64:67]
  ds_read_b128 v[176:179], v14 offset:24576
  v_mfma_f32_16x16x32_bf16 v[68:71], a[28:31], v[160:163], v[68:71]
  s_add_u32 m0, s31, 65536
  v_mfma_f32_16x16x32_bf16 v[72:75], a[32:35], v[160:163], v[72:75]
  s_waitcnt lgkmcnt(5)
  buffer_load_dwordx4 v10, s[8:11], s30 offen lds
  ds_write_b128 v20, v[224:227] offset:26624
  v_mfma_f32_16x16x32_bf16 v[76:79], a[24:27], v[164:167], v[76:79]
  ds_read_b128 v[180:183], v14 offset:26624
  v_mfma_f32_16x16x32_bf16 v[80:83], a[28:31], v[164:167], v[80:83]
  v_mfma_f32_16x16x32_bf16 v[84:87], a[32:35], v[164:167], v[84:87]
  s_waitcnt lgkmcnt(5)
  buffer_load_dwordx4 a[252:255], v24, s[16:19], s29 offen offset:2560 sc1
  v_mfma_f32_16x16x32_bf16 v[88:91], a[24:27], v[168:171], v[88:91]
  ds_read_b128 v[184:187], v14 offset:28672
  v_mfma_f32_16x16x32_bf16 v[92:95], a[28:31], v[168:171], v[92:95]
  ds_write_b128 v20, v[228:231] offset:36864
  v_mfma_f32_16x16x32_bf16 v[96:99], a[32:35], v[168:171], v[96:99]
  s_waitcnt lgkmcnt(6)
  buffer_load_dwordx2 v[246:247], v25, s[16:19], s29 offen offset:3072 sc1
  v_mfma_f32_16x16x32_bf16 v[100:103], a[24:27], v[172:175], v[100:103]
  ds_read_b128 v[188:191], v14 offset:30720
  v_mfma_f32_16x16x32_bf16 v[104:107], a[28:31], v[172:175], v[104:107]
  s_add_u32 m0, s31, 66560
  v_mfma_f32_16x16x32_bf16 v[108:111], a[32:35], v[172:175], v[108:111]
  s_waitcnt lgkmcnt(5)
  buffer_load_dwordx4 v11, s[8:11], s30 offen lds
  v_mfma_f32_16x16x32_bf16 v[112:115], a[24:27], v[176:179], v[112:115]
  ds_read_b128 v[160:163], v15 offset:16384
  ds_write_b128 v20, v[232:235] offset:37888
  v_mfma_f32_16x16x32_bf16 v[116:119], a[28:31], v[176:179], v[116:119]
  v_mfma_f32_16x16x32_bf16 v[120:123], a[32:35], v[176:179], v[120:123]
  s_waitcnt lgkmcnt(5)
  v_mfma_f32_16x16x32_bf16 v[124:127], a[24:27], v[180:183], v[124:127]
  ds_read_b128 v[164:167], v15 offset:18432
  v_mfma_f32_16x16x32_bf16 v[128:131], a[28:31], v[180:183], v[128:131]
  v_mfma_f32_16x16x32_bf16 v[132:135], a[32:35], v[180:183], v[132:135]
  s_waitcnt lgkmcnt(5)
  ds_write_b128 v20, v[236:239] offset:38912
  v_mfma_f32_16x16x32_bf16 v[136:139], a[24:27], v[184:187], v[136:139]
  ds_read_b128 v[168:171], v15 offset:20480
  v_mfma_f32_16x16x32_bf16 v[140:143], a[28:31], v[184:187], v[140:143]
  s_add_u32 m0, s31, 67584
  s_cmp_eq_u32 s26, s89
  s_cselect_b32 s25, s90, 162688
  v_mfma_f32_16x16x32_bf16 v[144:147], a[32:35], v[184:187], v[144:147]
  s_sub_u32 s21, s26, s87
  s_waitcnt lgkmcnt(5)
  buffer_load_dwordx4 v12, s[8:11], s30 offen lds
  v_mfma_f32_16x16x32_bf16 v[148:151], a[24:27], v[188:191], v[148:151]
  ds_read_b128 v[172:175], v15 offset:22528
  v_mfma_f32_16x16x32_bf16 v[152:155], a[28:31], v[188:191], v[152:155]
  s_cmp_lt_u32 s21, s91
  s_cbranch_scc1 qs_269
qs_270:
  s_waitcnt lgkmcnt(2)
  v_mfma_f32_16x16x32_bf16 v[156:159], a[32:35], v[188:191], v[156:159]
  s_add_u32 s29, s50, 0
  s_waitcnt lgkmcnt(5)
  buffer_load_dwordx4 v[192:195], v26, s[16:19], s29 offen offset:0 sc1
  v_mfma_f32_16x16x32_bf16 v[64:67], a[36:39], v[160:163], v[64:67]
  ds_read_b128 v[176:179], v15 offset:24576
  v_mfma_f32_16x16x32_bf16 v[68:71], a[40:43], v[160:163], v[68:71]
  v_mfma_f32_16x16x32_bf16 v[72:75], a[44:47], v[160:163], v[72:75]
  s_waitcnt lgkmcnt(4)
  buffer_load_dwordx4 v[196:199], v26, s[16:19], s29 offen offset:1024 sc1
  v_mfma_f32_16x16x32_bf16 v[76:79], a[36:39], v[164:167], v[76:79]
  ds_read_b128 v[180:183], v15 offset:26624
  v_mfma_f32_16x16x32_bf16 v[80:83], a[40:43], v[164:167], v[80:83]
  s_add_u32 m0, s31, 68608
  v_mfma_f32_16x16x32_bf16 v[84:87], a[44:47], v[164:167], v[84:87]
  s_waitcnt lgkmcnt(3)
  buffer_load_dwordx4 v13, s[8:11], s30 offen lds
  v_mfma_f32_16x16x32_bf16 v[88:91], a[36:39], v[168:171], v[88:91]
  s_add_u32 s30, s30, 128
  ds_read_b128 v[184:187], v15 offset:28672
  v_mfma_f32_16x16x32_bf16 v[92:95], a[40:43], v[168:171], v[92:95]
  v_mfma_f32_16x16x32_bf16 v[96:99], a[44:47], v[168:171], v[96:99]
  s_waitcnt lgkmcnt(3)
  buffer_load_dwordx4 v[224:227], v26, s[16:19], s29 offen offset:2048 sc1
  s_add_u32 s29, s50, 16384
  v_mfma_f32_16x16x32_bf16 v[100:103], a[36:39], v[172:175], v[100:103]
  ds_read_b128 v[188:191], v15 offset:30720
  v_mfma_f32_16x16x32_bf16 v[104:107], a[40:43], v[172:175], v[104:107]
  v_mfma_f32_16x16x32_bf16 v[108:111], a[44:47], v[172:175], v[108:111]
  s_waitcnt lgkmcnt(3)
  buffer_load_dwordx4 v[200:203], v26, s[16:19], s29 offen offset:0 sc1
  v_mfma_f32_16x16x32_bf16 v[112:115], a[36:39], v[176:179], v[112:115]
  s_waitcnt vmcnt(21)
  s_barrier
  ds_read_b128 v[160:163], v14 offset:32768
  v_mfma_f32_16x16x32_bf16 v[116:119], a[40:43], v[176:179], v[116:119]
  v_mfma_f32_16x16x32_bf16 v[120:123], a[44:47], v[176:179], v[120:123]
  s_waitcnt lgkmcnt(3)
  buffer_load_dwordx4 v[204:207], v26, s[16:19], s29 offen offset:1024 sc1
  v_mfma_f32_16x16x32_bf16 v[124:127], a[36:39], v[180:183], v[124:127]
  ds_read_b128 v[164:167], v14 offset:34816
  v_mfma_f32_16x16x32_bf16 v[128:131], a[40:43], v[180:183], v[128:131]
  v_mfma_f32_16x16x32_bf16 v[132:135], a[44:47], v[180:183], v[132:135]
  s_waitcnt lgkmcnt(3)
  buffer_load_dwordx4 v[228:231], v26, s[16:19], s29 offen offset:2048 sc1
  s_add_u32 s29, s50, 32768
  v_mfma_f32_16x16x32_bf16 v[136:139], a[36:39], v[184:187], v[136:139]
  ds_read_b128 v[168:171], v14 offset:36864
  v_mfma_f32_16x16x32_bf16 v[140:143], a[40:43], v[184:187], v[140:143]
  v_mfma_f32_16x16x32_bf16 v[144:147], a[44:47], v[184:187], v[144:147]
  s_waitcnt lgkmcnt(3)
  buffer_load_dwordx4 v[208:211], v26, s[16:19], s29 offen offset:0 sc1
  v_mfma_f32_16x16x32_bf16 v[148:151], a[36:39], v[188:191], v[148:151]
  ds_read_b128 v[172:175], v14 offset:38912
  v_mfma_f32_16x16x32_bf16 v[152:155], a[40:43], v[188:191], v[152:155]
  v_mfma_f32_16x16x32_bf16 v[156:159], a[44:47], v[188:191], v[156:159]
  s_waitcnt lgkmcnt(3)
  buffer_load_dwordx4 v[212:215], v26, s[16:19], s29 offen offset:1024 sc1
  v_mfma_f32_16x16x32_bf16 v[64:67], a[48:51], v[160:163], v[64:67]
  ds_read_b128 v[176:179], v14 offset:40960
  v_mfma_f32_16x16x32_bf16 v[68:71], a[52:55], v[160:163], v[68:71]
  s_add_u32 m0, s31, 0
  v_mfma_f32_16x16x32_bf16 v[72:75], a[56:59], v[160:163], v[72:75]
  s_waitcnt lgkmcnt(3)
  buffer_load_dwordx4 v10, s[8:11], s30 offen lds
  v_mfma_f32_16x16x32_bf16 v[76:79], a[48:51], v[164:167], v[76:79]
  ds_read_b128 v[180:183], v14 offset:43008
  v_mfma_f32_16x16x32_bf16 v[80:83], a[52:55], v[164:167], v[80:83]
  v_mfma_f32_16x16x32_bf16 v[84:87], a[56:59], v[164:167], v[84:87]
  s_waitcnt lgkmcnt(3)
  buffer_load_dwordx4 v[232:235], v26, s[16:19], s29 offen offset:2048 sc1
  s_add_u32 s29, s50, 49152
  v_mfma_f32_16x16x32_bf16 v[88:91], a[48:51], v[168:171], v[88:91]
  ds_read_b128 v[184:187], v14 offset:45056
  v_mfma_f32_16x16x32_bf16 v[92:95], a[52:55], v[168:171], v[92:95]
  v_mfma_f32_16x16x32_bf16 v[96:99], a[56:59], v[168:171], v[96:99]
  s_waitcnt lgkmcnt(3)
  buffer_load_dwordx4 v[216:219], v26, s[16:19], s29 offen offset:0 sc1
  v_mfma_f32_16x16x32_bf16 v[100:103], a[48:51], v[172:175], v[100:103]
  ds_read_b128 v[188:191], v14 offset:47104
  v_mfma_f32_16x16x32_bf16 v[104:107], a[52:55], v[172:175], v[104:107]
  s_add_u32 m0, s31, 1024
  v_mfma_f32_16x16x32_bf16 v[108:111], a[56:59], v[172:175], v[108:111]
  s_waitcnt lgkmcnt(3)
  buffer_load_dwordx4 v11, s[8:11], s30 offen lds
  v_mfma_f32_16x16x32_bf16 v[112:115], a[48:51], v[176:179], v[112:115]
  ds_read_b128 v[160:163], v15 offset:32768
  v_mfma_f32_16x16x32_bf16 v[116:119], a[52:55], v[176:179], v[116:119]
  v_mfma_f32_16x16x32_bf16 v[120:123], a[56:59], v[176:179], v[120:123]
  s_waitcnt lgkmcnt(3)
  buffer_load_dwordx4 v[220:223], v26, s[16:19], s29 offen offset:1024 sc1
  v_mfma_f32_16x16x32_bf16 v[124:127], a[48:51], v[180:183], v[124:127]
  ds_read_b128 v[164:167], v15 offset:34816
  v_mfma_f32_16x16x32_bf16 v[128:131], a[52:55], v[180:183], v[128:131]
  v_mfma_f32_16x16x32_bf16 v[132:135], a[56:59], v[180:183], v[132:135]
  s_waitcnt lgkmcnt(3)
  buffer_load_dwordx4 v[236:239], v26, s[16:19], s29 offen offset:2048 sc1
  v_mfma_f32_16x16x32_bf16 v[136:139], a[48:51], v[184:187], v[136:139]
  ds_read_b128 v[168:171], v15 offset:36864
  v_mfma_f32_16x16x32_bf16 v[140:143], a[52:55], v[184:187], v[140:143]
  s_add_u32 m0, s31, 2048
  v_mfma_f32_16x16x32_bf16 v[144:147], a[56:59], v[184:187], v[144:147]
  s_waitcnt lgkmcnt(3)
  buffer_load_dwordx4 v12, s[8:11], s30 offen lds
  v_mfma_f32_16x16x32_bf16 v[148:151], a[48:51], v[188:191], v[148:151]
  ds_read_b128 v[172:175], v15 offset:38912
  v_mfma_f32_16x16x32_bf16 v[152:155], a[52:55], v[188:191], v[152:155]
  v_mfma_f32_16x16x32_bf16 v[156:159], a[56:59], v[188:191], v[156:159]
  s_waitcnt lgkmcnt(3)
  v_mfma_f32_16x16x32_bf16 v[64:67], a[60:63], v[160:163], v[64:67]
  ds_read_b128 v[176:179], v15 offset:40960
  v_mfma_f32_16x16x32_bf16 v[68:71], a[64:67], v[160:163], v[68:71]
  v_mfma_f32_16x16x32_bf16 v[72:75], a[68:71], v[160:163], v[72:75]
  s_waitcnt lgkmcnt(3)
  v_mfma_f32_16x16x32_bf16 v[76:79], a[60:63], v[164:167], v[76:79]
  ds_read_b128 v[180:183], v15 offset:43008
  v_mfma_f32_16x16x32_bf16 v[80:83], a[64:67], v[164:167], v[80:83]
  s_add_u32 m0, s31, 3072
  v_mfma_f32_16x16x32_bf16 v[84:87], a[68:71], v[164:167], v[84:87]
  s_waitcnt lgkmcnt(3)
  buffer_load_dwordx4 v13, s[8:11], s30 offen lds
  v_mfma_f32_16x16x32_bf16 v[88:91], a[60:63], v[168:171], v[88:91]
  s_add_u32 s30, s30, 128
  ds_read_b128 v[184:187], v15 offset:45056
  v_mfma_f32_16x16x32_bf16 v[92:95], a[64:67], v[168:171], v[92:95]
  v_mfma_f32_16x16x32_bf16 v[96:99], a[68:71], v[168:171], v[96:99]
  s_waitcnt lgkmcnt(3)
  v_mfma_f32_16x16x32_bf16 v[100:103], a[60:63], v[172:175], v[100:103]
  ds_read_b128 v[188:191], v15 offset:47104
  v_mfma_f32_16x16x32_bf16 v[104:107], a[64:67], v[172:175], v[104:107]
  v_mfma_f32_16x16x32_bf16 v[108:111], a[68:71], v[172:175], v[108:111]
  s_waitcnt lgkmcnt(3)
  v_mfma_f32_16x16x32_bf16 v[112:115], a[60:63], v[176:179], v[112:115]
  s_waitcnt vmcnt(26)
  s_barrier
  ds_read_b128 v[160:163], v14 offset:49152
  v_mfma_f32_16x16x32_bf16 v[116:119], a[64:67], v[176:179], v[116:119]
  v_mfma_f32_16x16x32_bf16 v[120:123], a[68:71], v[176:179], v[120:123]
  s_waitcnt lgkmcnt(3)
  v_mfma_f32_16x16x32_bf16 v[124:127], a[60:63], v[180:183], v[124:127]
  ds_read_b128 v[164:167], v14 offset:51200
  v_mfma_f32_16x16x32_bf16 v[128:131], a[64:67], v[180:183], v[128:131]
  v_mfma_f32_16x16x32_bf16 v[132:135], a[68:71], v[180:183], v[132:135]
  s_waitcnt lgkmcnt(3)
  v_mfma_f32_16x16x32_bf16 v[136:139], a[60:63], v[184:187], v[136:139]
  ds_read_b128 v[168:171], v14 offset:53248
  v_mfma_f32_16x16x32_bf16 v[140:143], a[64:67], v[184:187], v[140:143]
  v_mfma_f32_16x16x32_bf16 v[144:147], a[68:71], v[184:187], v[144:147]
  s_waitcnt lgkmcnt(3)
  v_mfma_f32_16x16x32_bf16 v[148:151], a[60:63], v[188:191], v[148:151]
  ds_read_b128 v[172:175], v14 offset:55296
  v_mfma_f32_16x16x32_bf16 v[152:155], a[64:67], v[188:191], v[152:155]
  v_mfma_f32_16x16x32_bf16 v[156:159], a[68:71], v[188:191], v[156:159]
  s_waitcnt lgkmcnt(3)
  v_mfma_f32_16x16x32_bf16 v[64:67], a[72:75], v[160:163], v[64:67]
  ds_read_b128 v[176:179], v14 offset:57344
  v_mfma_f32_16x16x32_bf16 v[68:71], a[76:79], v[160:163], v[68:71]
  s_add_u32 m0, s31, 16384
  v_mfma_f32_16x16x32_bf16 v[72:75], a[80:83], v[160:163], v[72:75]
  s_waitcnt lgkmcnt(3)
  buffer_load_dwordx4 v10, s[8:11], s30 offen lds
  v_mfma_f32_16x16x32_bf16 v[76:79], a[72:75], v[164:167], v[76:79]
  ds_read_b128 v[180:183], v14 offset:59392
  v_mfma_f32_16x16x32_bf16 v[80:83], a[76:79], v[164:167], v[80:83]
  v_mfma_f32_16x16x32_bf16 v[84:87], a[80:83], v[164:167], v[84:87]
  s_waitcnt lgkmcnt(3)
  v_mfma_f32_16x16x32_bf16 v[88:91], a[72:75], v[168:171], v[88:91]
  ds_read_b128 v[184:187], v14 offset:61440
  v_mfma_f32_16x16x32_bf16 v[92:95], a[76:79], v[168:171], v[92:95]
  v_mfma_f32_16x16x32_bf16 v[96:99], a[80:83], v[168:171], v[96:99]
  s_waitcnt lgkmcnt(3)
  v_mfma_f32_16x16x32_bf16 v[100:103], a[72:75], v[172:175], v[100:103]
  ds_read_b128 v[188:191], v14 offset:63488
  v_mfma_f32_16x16x32_bf16 v[104:107], a[76:79], v[172:175], v[104:107]
  s_add_u32 m0, s31, 17408
  v_mfma_f32_16x16x32_bf16 v[108:111], a[80:83], v[172:175], v[108:111]
  s_waitcnt lgkmcnt(3)
  buffer_load_dwordx4 v11, s[8:11], s30 offen lds
  v_mfma_f32_16x16x32_bf16 v[112:115], a[72:75], v[176:179], v[112:115]
  ds_read_b128 v[160:163], v15 offset:49152
  v_mfma_f32_16x16x32_bf16 v[116:119], a[76:79], v[176:179], v[116:119]
  v_mfma_f32_16x16x32_bf16 v[120:123], a[80:83], v[176:179], v[120:123]
  s_waitcnt lgkmcnt(3)
  v_mfma_f32_16x16x32_bf16 v[124:127], a[72:75], v[180:183], v[124:127]
  ds_read_b128 v[164:167], v15 offset:51200
  v_mfma_f32_16x16x32_bf16 v[128:131], a[76:79], v[180:183], v[128:131]
  v_mfma_f32_16x16x32_bf16 v[132:135], a[80:83], v[180:183], v[132:135]
  s_waitcnt lgkmcnt(3)
  v_mfma_f32_16x16x32_bf16 v[136:139], a[72:75], v[184:187], v[136:139]
  ds_read_b128 v[168:171], v15 offset:53248
  v_mfma_f32_16x16x32_bf16 v[140:143], a[76:79], v[184:187], v[140:143]
  s_add_u32 m0, s31, 18432
  v_mfma_f32_16x16x32_bf16 v[144:147], a[80:83], v[184:187], v[144:147]
  s_waitcnt lgkmcnt(3)
  buffer_load_dwordx4 v12, s[8:11], s30 offen lds
  v_mfma_f32_16x16x32_bf16 v[148:151], a[72:75], v[188:191], v[148:151]
  ds_read_b128 v[172:175], v15 offset:55296
  v_mfma_f32_16x16x32_bf16 v[152:155], a[76:79], v[188:191], v[152:155]
  v_mfma_f32_16x16x32_bf16 v[156:159], a[80:83], v[188:191], v[156:159]
  s_waitcnt lgkmcnt(3)
  v_mfma_f32_16x16x32_bf16 v[64:67], a[84:87], v[160:163], v[64:67]
  ds_read_b128 v[176:179], v15 offset:57344
  v_mfma_f32_16x16x32_bf16 v[68:71], a[88:91], v[160:163], v[68:71]
  v_mfma_f32_16x16x32_bf16 v[72:75], a[92:95], v[160:163], v[72:75]
  s_waitcnt lgkmcnt(3)
  v_mfma_f32_16x16x32_bf16 v[76:79], a[84:87], v[164:167], v[76:79]
  ds_read_b128 v[180:183], v15 offset:59392
  v_mfma_f32_16x16x32_bf16 v[80:83], a[88:91], v[164:167], v[80:83]
  s_add_u32 m0, s31, 19456
  v_mfma_f32_16x16x32_bf16 v[84:87], a[92:95], v[164:167], v[84:87]
  s_waitcnt lgkmcnt(3)
  buffer_load_dwordx4 v13, s[8:11], s30 offen lds
  v_mfma_f32_16x16x32_bf16 v[88:91], a[84:87], v[168:171], v[88:91]
  s_add_u32 s30, s30, 128
  ds_read_b128 v[184:187], v15 offset:61440
  v_mfma_f32_16x16x32_bf16 v[92:95], a[88:91], v[168:171], v[92:95]
  v_mfma_f32_16x16x32_bf16 v[96:99], a[92:95], v[168:171], v[96:99]
  s_waitcnt lgkmcnt(3)
  v_mfma_f32_16x16x32_bf16 v[100:103], a[84:87], v[172:175], v[100:103]
  ds_read_b128 v[188:191], v15 offset:63488
  v_mfma_f32_16x16x32_bf16 v[104:107], a[88:91], v[172:175], v[104:107]
  v_mfma_f32_16x16x32_bf16 v[108:111], a[92:95], v[172:175], v[108:111]
  s_waitcnt lgkmcnt(3)
  v_mfma_f32_16x16x32_bf16 v[112:115], a[84:87], v[176:179], v[112:115]
  s_waitcnt vmcnt(18)
  s_barrier
  ds_read_b128 v[160:163], v16 offset:0
  v_mfma_f32_16x16x32_bf16 v[116:119], a[88:91], v[176:179], v[116:119]
  v_mfma_f32_16x16x32_bf16 v[120:123], a[92:95], v[176:179], v[120:123]
  s_waitcnt lgkmcnt(3)
  v_mfma_f32_16x16x32_bf16 v[124:127], a[84:87], v[180:183], v[124:127]
  ds_read_b128 v[164:167], v16 offset:2048
  v_mfma_f32_16x16x32_bf16 v[128:131], a[88:91], v[180:183], v[128:131]
  v_mfma_f32_16x16x32_bf16 v[132:135], a[92:95], v[180:183], v[132:135]
  s_waitcnt lgkmcnt(3)
  v_mfma_f32_16x16x32_bf16 v[136:139], a[84:87], v[184:187], v[136:139]
  ds_read_b128 v[168:171], v16 offset:4096
  v_mfma_f32_16x16x32_bf16 v[140:143], a[88:91], v[184:187], v[140:143]
  v_mfma_f32_16x16x32_bf16 v[144:147], a[92:95], v[184:187], v[144:147]
  s_waitcnt lgkmcnt(3)
  v_mfma_f32_16x16x32_bf16 v[148:151], a[84:87], v[188:191], v[148:151]
  ds_read_b128 v[172:175], v16 offset:6144
  v_mfma_f32_16x16x32_bf16 v[152:155], a[88:91], v[188:191], v[152:155]
  v_mfma_f32_16x16x32_bf16 v[156:159], a[92:95], v[188:191], v[156:159]
  s_waitcnt lgkmcnt(3)
  v_mfma_f32_16x16x32_bf16 v[64:67], a[96:99], v[160:163], v[64:67]
  ds_read_b128 v[176:179], v16 offset:8192
  v_mfma_f32_16x16x32_bf16 v[68:71], a[100:103], v[160:163], v[68:71]
  s_add_u32 m0, s31, 32768
  v_mfma_f32_16x16x32_bf16 v[72:75], a[104:107], v[160:163], v[72:75]
  s_waitcnt lgkmcnt(3)
  buffer_load_dwordx4 v10, s[8:11], s30 offen lds
  v_mfma_f32_16x16x32_bf16 v[76:79], a[96:99], v[164:167], v[76:79]
  ds_read_b128 v[180:183], v16 offset:10240
  v_mfma_f32_16x16x32_bf16 v[80:83], a[100:103], v[164:167], v[80:83]
  v_mfma_f32_16x16x32_bf16 v[84:87], a[104:107], v[164:167], v[84:87]
  s_waitcnt lgkmcnt(3)
  v_mfma_f32_16x16x32_bf16 v[88:91], a[96:99], v[168:171], v[88:91]
  ds_read_b128 v[184:187], v16 offset:12288
  v_mfma_f32_16x16x32_bf16 v[92:95], a[100:103], v[168:171], v[92:95]
  v_mfma_f32_16x16x32_bf16 v[96:99], a[104:107], v[168:171], v[96:99]
  s_waitcnt lgkmcnt(3)
  v_mfma_f32_16x16x32_bf16 v[100:103], a[96:99], v[172:175], v[100:103]
  ds_read_b128 v[188:191], v16 offset:14336
  v_mfma_f32_16x16x32_bf16 v[104:107], a[100:103], v[172:175], v[104:107]
  s_add_u32 m0, s31, 33792
  v_mfma_f32_16x16x32_bf16 v[108:111], a[104:107], v[172:175], v[108:111]
  s_waitcnt lgkmcnt(3)
  buffer_load_dwordx4 v11, s[8:11], s30 offen lds
  v_mfma_f32_16x16x32_bf16 v[112:115], a[96:99], v[176:179], v[112:115]
  ds_read_b128 v[160:163], v17 offset:0
  v_mfma_f32_16x16x32_bf16 v[116:119], a[100:103], v[176:179], v[116:119]
  v_mfma_f32_16x16x32_bf16 v[120:123], a[104:107], v[176:179], v[120:123]
  s_waitcnt lgkmcnt(3)
  v_mfma_f32_16x16x32_bf16 v[124:127], a[96:99], v[180:183], v[124:127]
  ds_read_b128 v[164:167], v17 offset:2048
  v_mfma_f32_16x16x32_bf16 v[128:131], a[100:103], v[180:183], v[128:131]
  v_mfma_f32_16x16x32_bf16 v[132:135], a[104:107], v[180:183], v[132:135]
  s_waitcnt lgkmcnt(3)
  v_mfma_f32_16x16x32_bf16 v[136:139], a[96:99], v[184:187], v[136:139]
  ds_read_b128 v[168:171], v17 offset:4096
  v_mfma_f32_16x16x32_bf16 v[140:143], a[100:103], v[184:187], v[140:143]
  s_add_u32 m0, s31, 34816
  v_mfma_f32_16x16x32_bf16 v[144:147], a[104:107], v[184:187], v[144:147]
  s_waitcnt lgkmcnt(3)
  buffer_load_dwordx4 v12, s[8:11], s30 offen lds
  v_mfma_f32_16x16x32_bf16 v[148:151], a[96:99], v[188:191], v[148:151]
  ds_read_b128 v[172:175], v17 offset:6144
  v_mfma_f32_16x16x32_bf16 v[152:155], a[100:103], v[188:191], v[152:155]
  v_mfma_f32_16x16x32_bf16 v[156:159], a[104:107], v[188:191], v[156:159]
  s_waitcnt lgkmcnt(3)
  v_mfma_f32_16x16x32_bf16 v[64:67], a[108:111], v[160:163], v[64:67]
  ds_read_b128 v[176:179], v17 offset:8192
  v_mfma_f32_16x16x32_bf16 v[68:71], a[112:115], v[160:163], v[68:71]
  v_mfma_f32_16x16x32_bf16 v[72:75], a[116:119], v[160:163], v[72:75]
  s_waitcnt lgkmcnt(3)
  v_mfma_f32_16x16x32_bf16 v[76:79], a[108:111], v[164:167], v[76:79]
  ds_read_b128 v[180:183], v17 offset:10240
  v_mfma_f32_16x16x32_bf16 v[80:83], a[112:115], v[164:167], v[80:83]
  s_add_u32 m0, s31, 35840
  v_mfma_f32_16x16x32_bf16 v[84:87], a[116:119], v[164:167], v[84:87]
  s_waitcnt lgkmcnt(3)
  buffer_load_dwordx4 v13, s[8:11], s30 offen lds
  v_mfma_f32_16x16x32_bf16 v[88:91], a[108:111], v[168:171], v[88:91]
  s_add_u32 s30, s30, 128
  ds_read_b128 v[184:187], v17 offset:12288
  v_mfma_f32_16x16x32_bf16 v[92:95], a[112:115], v[168:171], v[92:95]
  v_mfma_f32_16x16x32_bf16 v[96:99], a[116:119], v[168:171], v[96:99]
  s_waitcnt lgkmcnt(3)
  v_mfma_f32_16x16x32_bf16 v[100:103], a[108:111], v[172:175], v[100:103]
  ds_read_b128 v[188:191], v17 offset:14336
  v_mfma_f32_16x16x32_bf16 v[104:107], a[112:115], v[172:175], v[104:107]
  v_mfma_f32_16x16x32_bf16 v[108:111], a[116:119], v[172:175], v[108:111]
  s_waitcnt lgkmcnt(3)
  v_mfma_f32_16x16x32_bf16 v[112:115], a[108:111], v[176:179], v[112:115]
  s_waitcnt vmcnt(8)
  s_barrier
  ds_read_b128 v[160:163], v14 offset:0
  v_mfma_f32_16x16x32_bf16 v[116:119], a[112:115], v[176:179], v[116:119]
  v_mfma_f32_16x16x32_bf16 v[120:123], a[116:119], v[176:179], v[120:123]
  s_waitcnt lgkmcnt(3)
  v_mfma_f32_16x16x32_bf16 v[124:127], a[108:111], v[180:183], v[124:127]
  ds_read_b128 v[164:167], v14 offset:2048
  v_mfma_f32_16x16x32_bf16 v[128:131], a[112:115], v[180:183], v[128:131]
  v_mfma_f32_16x16x32_bf16 v[132:135], a[116:119], v[180:183], v[132:135]
  s_waitcnt lgkmcnt(3)
  v_mfma_f32_16x16x32_bf16 v[136:139], a[108:111], v[184:187], v[136:139]
  ds_read_b128 v[168:171], v14 offset:4096
  v_mfma_f32_16x16x32_bf16 v[140:143], a[112:115], v[184:187], v[140:143]
  v_mfma_f32_16x16x32_bf16 v[144:147], a[116:119], v[184:187], v[144:147]
  s_waitcnt lgkmcnt(3)
  v_mfma_f32_16x16x32_bf16 v[148:151], a[108:111], v[188:191], v[148:151]
  ds_read_b128 v[172:175], v14 offset:6144
  v_mfma_f32_16x16x32_bf16 v[152:155], a[112:115], v[188:191], v[152:155]
  v_mfma_f32_16x16x32_bf16 v[156:159], a[116:119], v[188:191], v[156:159]
  s_waitcnt lgkmcnt(3)
  v_mfma_f32_16x16x32_bf16 v[64:67], a[120:123], v[160:163], v[64:67]
  ds_read_b128 v[176:179], v14 offset:8192
  v_mfma_f32_16x16x32_bf16 v[68:71], a[124:127], v[160:163], v[68:71]
  s_add_u32 m0, s31, 49152
  v_mfma_f32_16x16x32_bf16 v[72:75], a[128:131], v[160:163], v[72:75]
  s_waitcnt lgkmcnt(3)
  buffer_load_dwordx4 v10, s[8:11], s30 offen lds
  v_mfma_f32_16x16x32_bf16 v[76:79], a[120:123], v[164:167], v[76:79]
  ds_read_b128 v[180:183], v14 offset:10240
  s_waitcnt vmcnt(11)
  v_mfma_f32_16x16x32_bf16 v[80:83], a[124:127], v[164:167], v[80:83]
  v_swap_b32 v226, v228
  v_swap_b32 v227, v229
  v_mfma_f32_16x16x32_bf16 v[84:87], a[128:131], v[164:167], v[84:87]
  s_waitcnt lgkmcnt(3)
  v_swap_b32 v234, v236
  v_swap_b32 v235, v237
  v_mfma_f32_16x16x32_bf16 v[88:91], a[120:123], v[168:171], v[88:91]
  ds_read_b128 v[184:187], v14 offset:12288
  v_mfma_f32_16x16x32_bf16 v[92:95], a[124:127], v[168:171], v[92:95]
  ds_read_b128 v[56:59], v21 offset:0
  ds_read_b128 v[60:63], v21 offset:1024
  v_mfma_f32_16x16x32_bf16 v[96:99], a[128:131], v[168:171], v[96:99]
  s_waitcnt lgkmcnt(5)
  v_mfma_f32_16x16x32_bf16 v[100:103], a[120:123], v[172:175], v[100:103]
  ds_read_b128 v[188:191], v14 offset:14336
  v_mfma_f32_16x16x32_bf16 v[104:107], a[124:127], v[172:175], v[104:107]
  s_add_u32 m0, s31, 50176
  v_mfma_f32_16x16x32_bf16 v[108:111], a[128:131], v[172:175], v[108:111]
  s_waitcnt lgkmcnt(5)
  buffer_load_dwordx4 v11, s[8:11], s30 offen lds
  v_mfma_f32_16x16x32_bf16 v[112:115], a[120:123], v[176:179], v[112:115]
  ds_read_b128 v[160:163], v15 offset:0
  v_mfma_f32_16x16x32_bf16 v[116:119], a[124:127], v[176:179], v[116:119]
  ds_read_b128 v[248:251], v21 offset:3072
  ds_read_b128 v[252:255], v21 offset:4096
  v_mfma_f32_16x16x32_bf16 v[120:123], a[128:131], v[176:179], v[120:123]
  s_waitcnt lgkmcnt(4)
  v_mfma_f32_16x16x32_bf16 v[36:39], v[192:195], v[56:59], 0
  v_mfma_f32_16x16x32_bf16 v[44:47], v[192:195], v[60:63], 0
  v_mfma_f32_16x16x32_bf16 v[48:51], v[196:199], v[60:63], 0
  v_mfma_f32_16x16x32_bf16 v[40:43], a[240:243], v[56:59], 0
  v_mfma_f32_16x16x32_bf16 v[52:55], a[240:243], v[60:63], 0
  s_waitcnt lgkmcnt(7)
  ds_read2st64_b64 v[56:59], v22 offset0:0 offset1:6
  ds_read2st64_b64 v[60:63], v23 offset0:0 offset1:6
  v_mfma_f32_16x16x32_bf16 v[124:127], a[120:123], v[180:183], v[124:127]
  ds_read_b128 v[164:167], v15 offset:2048
  v_mfma_f32_16x16x32_bf16 v[128:131], a[124:127], v[180:183], v[128:131]
  v_mfma_f32_16x16x32_bf16 v[132:135], a[128:131], v[180:183], v[132:135]
  s_waitcnt lgkmcnt(9)
  v_mfma_f32_16x16x32_bf16 v[136:139], a[120:123], v[184:187], v[136:139]
  ds_read_b128 v[168:171], v15 offset:4096
  v_mfma_f32_16x16x32_bf16 v[140:143], a[124:127], v[184:187], v[140:143]
  s_add_u32 m0, s31, 51200
  v_mfma_f32_16x16x32_bf16 v[144:147], a[128:131], v[184:187], v[144:147]
  s_waitcnt lgkmcnt(4)
  buffer_load_dwordx4 v12, s[8:11], s30 offen lds
  v_mfma_f32_16x16x32_bf16 v[36:39], v[200:203], v[248:251], v[36:39]
  v_mfma_f32_16x16x32_bf16 v[44:47], v[200:203], v[252:255], v[44:47]
  v_mfma_f32_16x16x32_bf16 v[48:51], v[204:207], v[252:255], v[48:51]
  v_mfma_f32_16x16x32_bf16 v[40:43], a[244:247], v[248:251], v[40:43]
  v_mfma_f32_16x16x32_bf16 v[52:55], a[244:247], v[252:255], v[52:55]
  s_waitcnt lgkmcnt(7)
  ds_read_b128 v[248:251], v21 offset:6144
  ds_read_b128 v[252:255], v21 offset:7168
  v_mfma_f32_16x16x32_bf16 v[148:151], a[120:123], v[188:191], v[148:151]
  ds_read_b128 v[172:175], v15 offset:6144
  v_mfma_f32_16x16x32_bf16 v[152:155], a[124:127], v[188:191], v[152:155]
  v_mfma_f32_16x16x32_bf16 v[156:159], a[128:131], v[188:191], v[156:159]
  s_waitcnt lgkmcnt(9)
  v_mfma_f32_16x16x32_bf16 v[64:67], a[132:135], v[160:163], v[64:67]
  ds_read_b128 v[176:179], v15 offset:8192
  v_mfma_f32_16x16x32_bf16 v[68:71], a[136:139], v[160:163], v[68:71]
  v_mfma_f32_16x16x32_bf16 v[72:75], a[140:143], v[160:163], v[72:75]
  s_waitcnt lgkmcnt(6)
  v_mfma_f32_16x16x32_bf16 v[36:39], v[224:227], v[56:59], v[36:39]
  v_mfma_f32_16x16x32_bf16 v[44:47], v[224:227], v[60:63], v[44:47]
  v_mfma_f32_16x16x32_bf16 v[48:51], v[228:231], v[60:63], v[48:51]
  v_mfma_f32_16x16x32_bf16 v[40:43], v[240:243], v[56:59], v[40:43]
  v_mfma_f32_16x16x32_bf16 v[52:55], v[240:243], v[60:63], v[52:55]
  s_waitcnt lgkmcnt(5)
  ds_read_b128 v[56:59], v21 offset:9216
  ds_read_b128 v[60:63], v21 offset:10240
  v_mfma_f32_16x16x32_bf16 v[76:79], a[132:135], v[164:167], v[76:79]
  ds_read_b128 v[180:183], v15 offset:10240
  v_mfma_f32_16x16x32_bf16 v[80:83], a[136:139], v[164:167], v[80:83]
  s_add_u32 m0, s31, 52224
  v_mfma_f32_16x16x32_bf16 v[84:87], a[140:143], v[164:167], v[84:87]
  s_waitcnt lgkmcnt(7)
  buffer_load_dwordx4 v13, s[8:11], s30 offen lds
  v_mfma_f32_16x16x32_bf16 v[88:91], a[132:135], v[168:171], v[88:91]
  s_add_u32 s30, s30, 128
  ds_read_b128 v[184:187], v15 offset:12288
  v_mfma_f32_16x16x32_bf16 v[92:95], a[136:139], v[168:171], v[92:95]
  v_mfma_f32_16x16x32_bf16 v[96:99], a[140:143], v[168:171], v[96:99]
  s_waitcnt lgkmcnt(6)
  v_mfma_f32_16x16x32_bf16 v[36:39], v[208:211], v[248:251], v[36:39]
  v_mfma_f32_16x16x32_bf16 v[44:47], v[208:211], v[252:255], v[44:47]
  v_mfma_f32_16x16x32_bf16 v[48:51], v[212:215], v[252:255], v[48:51]
  v_mfma_f32_16x16x32_bf16 v[40:43], a[248:251], v[248:251], v[40:43]
  v_mfma_f32_16x16x32_bf16 v[52:55], a[248:251], v[252:255], v[52:55]
  s_waitcnt lgkmcnt(5)
  ds_read2st64_b64 v[248:251], v22 offset0:12 offset1:18
  ds_read2st64_b64 v[252:255], v23 offset0:12 offset1:18
  v_mfma_f32_16x16x32_bf16 v[100:103], a[132:135], v[172:175], v[100:103]
  ds_read_b128 v[188:191], v15 offset:14336
  v_mfma_f32_16x16x32_bf16 v[104:107], a[136:139], v[172:175], v[104:107]
  v_mfma_f32_16x16x32_bf16 v[108:111], a[140:143], v[172:175], v[108:111]
  s_waitcnt lgkmcnt(7)
  v_mfma_f32_16x16x32_bf16 v[112:115], a[132:135], v[176:179], v[112:115]
  s_waitcnt vmcnt(8)
  s_barrier
  ds_read_b128 v[160:163], v14 offset:16384
  v_mfma_f32_16x16x32_bf16 v[116:119], a[136:139], v[176:179], v[116:119]
  v_mfma_f32_16x16x32_bf16 v[120:123], a[140:143], v[176:179], v[120:123]
  s_waitcnt lgkmcnt(6)
  v_mfma_f32_16x16x32_bf16 v[36:39], v[216:219], v[56:59], v[36:39]
  v_mfma_f32_16x16x32_bf16 v[44:47], v[216:219], v[60:63], v[44:47]
  v_mfma_f32_16x16x32_bf16 v[48:51], v[220:223], v[60:63], v[48:51]
  v_mfma_f32_16x16x32_bf16 v[40:43], a[252:255], v[56:59], v[40:43]
  v_mfma_f32_16x16x32_bf16 v[52:55], a[252:255], v[60:63], v[52:55]
  s_waitcnt lgkmcnt(5)
  v_mfma_f32_16x16x32_bf16 v[124:127], a[132:135], v[180:183], v[124:127]
  ds_read_b128 v[164:167], v14 offset:18432
  v_mfma_f32_16x16x32_bf16 v[128:131], a[136:139], v[180:183], v[128:131]
  v_mfma_f32_16x16x32_bf16 v[132:135], a[140:143], v[180:183], v[132:135]
  s_waitcnt lgkmcnt(5)
  v_mfma_f32_16x16x32_bf16 v[136:139], a[132:135], v[184:187], v[136:139]
  ds_read_b128 v[168:171], v14 offset:20480
  v_mfma_f32_16x16x32_bf16 v[140:143], a[136:139], v[184:187], v[140:143]
  v_mfma_f32_16x16x32_bf16 v[144:147], a[140:143], v[184:187], v[144:147]
  s_waitcnt lgkmcnt(4)
  v_mfma_f32_16x16x32_bf16 v[36:39], v[232:235], v[248:251], v[36:39]
  v_mfma_f32_16x16x32_bf16 v[44:47], v[232:235], v[252:255], v[44:47]
  v_mfma_f32_16x16x32_bf16 v[48:51], v[236:239], v[252:255], v[48:51]
  v_mfma_f32_16x16x32_bf16 v[40:43], v[244:247], v[248:251], v[40:43]
  v_mfma_f32_16x16x32_bf16 v[52:55], v[244:247], v[252:255], v[52:55]
  s_waitcnt lgkmcnt(3)
  v_mfma_f32_16x16x32_bf16 v[148:151], a[132:135], v[188:191], v[148:151]
  ds_read_b128 v[172:175], v14 offset:22528
  v_mfma_f32_16x16x32_bf16 v[152:155], a[136:139], v[188:191], v[152:155]
  v_mfma_f32_16x16x32_bf16 v[156:159], a[140:143], v[188:191], v[156:159]
  s_waitcnt lgkmcnt(3)
  v_cndmask_b32 v36, v31, v36, s[64:65]
  v_cndmask_b32 v48, v31, v48, s[64:65]
  v_mfma_f32_16x16x32_bf16 v[64:67], a[144:147], v[160:163], v[64:67]
  ds_read_b128 v[176:179], v14 offset:24576
  v_cndmask_b32 v37, v31, v37, s[66:67]
  v_mfma_f32_16x16x32_bf16 v[68:71], a[148:151], v[160:163], v[68:71]
  s_add_u32 m0, s31, 65536
  v_cndmask_b32 v49, v31, v49, s[66:67]
  v_cndmask_b32 v38, v31, v38, s[68:69]
  v_mfma_f32_16x16x32_bf16 v[72:75], a[152:155], v[160:163], v[72:75]
  s_waitcnt lgkmcnt(3)
  buffer_load_dwordx4 v10, s[8:11], s30 offen lds
  v_cndmask_b32 v50, v31, v50, s[68:69]
  v_mfma_f32_16x16x32_bf16 v[76:79], a[144:147], v[164:167], v[76:79]
  ds_read_b128 v[180:183], v14 offset:26624
  v_cndmask_b32 v39, v31, v39, s[70:71]
  v_mfma_f32_16x16x32_bf16 v[80:83], a[148:151], v[164:167], v[80:83]
  v_cndmask_b32 v51, v31, v51, s[70:71]
  v_max3_f32 v34, v36, v37, v38
  v_mfma_f32_16x16x32_bf16 v[84:87], a[152:155], v[164:167], v[84:87]
  s_waitcnt lgkmcnt(3)
  v_max3_f32 v34, v34, v39, v40
  v_max3_f32 v34, v34, v41, v42
  v_mfma_f32_16x16x32_bf16 v[88:91], a[144:147], v[168:171], v[88:91]
  ds_read_b128 v[184:187], v14 offset:28672
  v_max_f32 v34, v34, v43
  v_mfma_f32_16x16x32_bf16 v[92:95], a[148:151], v[168:171], v[92:95]
  v_mov_b32 v35, v34
  v_mfma_f32_16x16x32_bf16 v[96:99], a[152:155], v[168:171], v[96:99]
  s_waitcnt lgkmcnt(3)
  v_permlane32_swap_b32 v34, v35
  v_max_f32 v34, v34, v35
  v_mfma_f32_16x16x32_bf16 v[100:103], a[144:147], v[172:175], v[100:103]
  ds_read_b128 v[188:191], v14 offset:30720
  v_mov_b32 v35, v34
  v_mfma_f32_16x16x32_bf16 v[104:107], a[148:151], v[172:175], v[104:107]
  s_add_u32 m0, s31, 66560
  v_permlane16_swap_b32 v34, v35
  v_max_f32 v34, v34, v35
  v_mfma_f32_16x16x32_bf16 v[108:111], a[152:155], v[172:175], v[108:111]
  s_waitcnt lgkmcnt(3)
  buffer_load_dwordx4 v11, s[8:11], s30 offen lds
  v_mul_f32 v34, s83, v34
  v_mfma_f32_16x16x32_bf16 v[112:115], a[144:147], v[176:179], v[112:115]
  ds_read_b128 v[160:163], v15 offset:16384
  v_fma_f32 v36, v36, s83, -v34
  v_mfma_f32_16x16x32_bf16 v[116:119], a[148:151], v[176:179], v[116:119]
  v_fma_f32 v37, v37, s83, -v34
  v_fma_f32 v38, v38, s83, -v34
  v_mfma_f32_16x16x32_bf16 v[120:123], a[152:155], v[176:179], v[120:123]
  s_waitcnt lgkmcnt(3)
  v_fma_f32 v39, v39, s83, -v34
  v_fma_f32 v40, v40, s83, -v34
  v_mfma_f32_16x16x32_bf16 v[124:127], a[144:147], v[180:183], v[124:127]
  ds_read_b128 v[164:167], v15 offset:18432
  v_fma_f32 v41, v41, s83, -v34
  v_mfma_f32_16x16x32_bf16 v[128:131], a[148:151], v[180:183], v[128:131]
  v_fma_f32 v42, v42, s83, -v34
  v_fma_f32 v43, v43, s83, -v34
  v_mfma_f32_16x16x32_bf16 v[132:135], a[152:155], v[180:183], v[132:135]
  s_waitcnt lgkmcnt(3)
  v_exp_f32 v36, v36
  v_mfma_f32_16x16x32_bf16 v[136:139], a[144:147], v[184:187], v[136:139]
  ds_read_b128 v[168:171], v15 offset:20480
  v_mfma_f32_16x16x32_bf16 v[140:143], a[148:151], v[184:187], v[140:143]
  s_add_u32 m0, s31, 67584
  v_exp_f32 v37, v37
  v_mfma_f32_16x16x32_bf16 v[144:147], a[152:155], v[184:187], v[144:147]
  s_waitcnt lgkmcnt(3)
  buffer_load_dwordx4 v12, s[8:11], s30 offen lds
  v_mfma_f32_16x16x32_bf16 v[148:151], a[144:147], v[188:191], v[148:151]
  ds_read_b128 v[172:175], v15 offset:22528
  v_mfma_f32_16x16x32_bf16 v[152:155], a[148:151], v[188:191], v[152:155]
  v_exp_f32 v38, v38
  v_mfma_f32_16x16x32_bf16 v[156:159], a[152:155], v[188:191], v[156:159]
  s_waitcnt lgkmcnt(3)
  v_exp_f32 v39, v39
  v_mfma_f32_16x16x32_bf16 v[64:67], a[156:159], v[160:163], v[64:67]
  ds_read_b128 v[176:179], v15 offset:24576
  v_mfma_f32_16x16x32_bf16 v[68:71], a[160:163], v[160:163], v[68:71]
  v_exp_f32 v40, v40
  v_mfma_f32_16x16x32_bf16 v[72:75], a[164:167], v[160:163], v[72:75]
  s_waitcnt lgkmcnt(3)
  v_exp_f32 v41, v41
  v_mfma_f32_16x16x32_bf16 v[76:79], a[156:159], v[164:167], v[76:79]
  ds_read_b128 v[180:183], v15 offset:26624
  v_mfma_f32_16x16x32_bf16 v[80:83], a[160:163], v[164:167], v[80:83]
  s_add_u32 m0, s31, 68608
  v_exp_f32 v42, v42
  v_mfma_f32_16x16x32_bf16 v[84:87], a[164:167], v[164:167], v[84:87]
  s_waitcnt lgkmcnt(3)
  buffer_load_dwordx4 v13, s[8:11], s30 offen lds
  v_mfma_f32_16x16x32_bf16 v[88:91], a[156:159], v[168:171], v[88:91]
  s_add_u32 s30, s30, s25
  ds_read_b128 v[184:187], v15 offset:28672
  v_mfma_f32_16x16x32_bf16 v[92:95], a[160:163], v[168:171], v[92:95]
  v_exp_f32 v43, v43
  v_mfma_f32_16x16x32_bf16 v[96:99], a[164:167], v[168:171], v[96:99]
  s_waitcnt lgkmcnt(3)
  v_add_f32 v34, v40, v41
  v_add_f32 v34, v34, v42
  v_mfma_f32_16x16x32_bf16 v[100:103], a[156:159], v[172:175], v[100:103]
  ds_read_b128 v[188:191], v15 offset:30720
  v_add_f32 v34, v34, v43
  v_mfma_f32_16x16x32_bf16 v[104:107], a[160:163], v[172:175], v[104:107]
  v_cndmask_b32 v34, 0, v34, s[62:63]
  v_add_f32 v34, v34, v36
  v_mfma_f32_16x16x32_bf16 v[108:111], a[164:167], v[172:175], v[108:111]
  s_waitcnt lgkmcnt(3)
  v_add_f32 v34, v34, v37
  v_add_f32 v34, v34, v38
  v_mfma_f32_16x16x32_bf16 v[112:115], a[156:159], v[176:179], v[112:115]
  s_waitcnt vmcnt(8)
  s_barrier
  ds_read_b128 v[160:163], v14 offset:32768
  v_mfma_f32_16x16x32_bf16 v[116:119], a[160:163], v[176:179], v[116:119]
  v_add_f32 v34, v34, v39
  v_mov_b32 v35, v34
  v_mfma_f32_16x16x32_bf16 v[120:123], a[164:167], v[176:179], v[120:123]
  s_waitcnt lgkmcnt(3)
  v_permlane32_swap_b32 v34, v35
  v_add_f32 v34, v34, v35
  v_mfma_f32_16x16x32_bf16 v[124:127], a[156:159], v[180:183], v[124:127]
  ds_read_b128 v[164:167], v14 offset:34816
  v_mov_b32 v35, v34
  v_mfma_f32_16x16x32_bf16 v[128:131], a[160:163], v[180:183], v[128:131]
  v_permlane16_swap_b32 v34, v35
  v_add_f32 v34, v34, v35
  v_mfma_f32_16x16x32_bf16 v[132:135], a[164:167], v[180:183], v[132:135]
  s_waitcnt lgkmcnt(3)
  v_rcp_f32 v34, v34
  v_mfma_f32_16x16x32_bf16 v[136:139], a[156:159], v[184:187], v[136:139]
  ds_read_b128 v[168:171], v14 offset:36864
  v_mul_f32 v36, v36, v34
  v_mfma_f32_16x16x32_bf16 v[140:143], a[160:163], v[184:187], v[140:143]
  v_mul_f32 v37, v37, v34
  v_mul_f32 v38, v38, v34
  v_mfma_f32_16x16x32_bf16 v[144:147], a[164:167], v[184:187], v[144:147]
  s_waitcnt lgkmcnt(3)
  v_mul_f32 v39, v39, v34
  v_mul_f32 v40, v40, v34
  v_mfma_f32_16x16x32_bf16 v[148:151], a[156:159], v[188:191], v[148:151]
  ds_read_b128 v[172:175], v14 offset:38912
  v_mul_f32 v41, v41, v34
  v_mfma_f32_16x16x32_bf16 v[152:155], a[160:163], v[188:191], v[152:155]
  v_mul_f32 v42, v42, v34
  v_mul_f32 v43, v43, v34
  v_mfma_f32_16x16x32_bf16 v[156:159], a[164:167], v[188:191], v[156:159]
  s_waitcnt lgkmcnt(3)
  v_max3_f32 v34, v44, v45, v46
  v_max3_f32 v34, v34, v47, v48
  v_mfma_f32_16x16x32_bf16 v[64:67], a[168:171], v[160:163], v[64:67]
  ds_read_b128 v[176:179], v14 offset:40960
  v_max3_f32 v34, v34, v49, v50
  v_mfma_f32_16x16x32_bf16 v[68:71], a[172:175], v[160:163], v[68:71]
  s_add_u32 m0, s31, 0
  v_max3_f32 v34, v34, v51, v52
  v_max3_f32 v34, v34, v53, v54
  v_mfma_f32_16x16x32_bf16 v[72:75], a[176:179], v[160:163], v[72:75]
  s_waitcnt lgkmcnt(3)
  buffer_load_dwordx4 v10, s[8:11], s30 offen lds
  v_max_f32 v34, v34, v55
  v_mfma_f32_16x16x32_bf16 v[76:79], a[168:171], v[164:167], v[76:79]
  ds_read_b128 v[180:183], v14 offset:43008
  v_mov_b32 v35, v34
  v_mfma_f32_16x16x32_bf16 v[80:83], a[172:175], v[164:167], v[80:83]
  v_permlane32_swap_b32 v34, v35
  v_max_f32 v34, v34, v35
  v_mfma_f32_16x16x32_bf16 v[84:87], a[176:179], v[164:167], v[84:87]
  s_waitcnt lgkmcnt(3)
  v_mov_b32 v35, v34
  v_mfma_f32_16x16x32_bf16 v[88:91], a[168:171], v[168:171], v[88:91]
  ds_read_b128 v[184:187], v14 offset:45056
  v_permlane16_swap_b32 v34, v35
  v_mfma_f32_16x16x32_bf16 v[92:95], a[172:175], v[168:171], v[92:95]
  v_max_f32 v34, v34, v35
  v_mul_f32 v34, s83, v34
  v_mfma_f32_16x16x32_bf16 v[96:99], a[176:179], v[168:171], v[96:99]
  s_waitcnt lgkmcnt(3)
  v_fma_f32 v44, v44, s83, -v34
  v_fma_f32 v45, v45, s83, -v34
  v_mfma_f32_16x16x32_bf16 v[100:103], a[168:171], v[172:175], v[100:103]
  ds_read_b128 v[188:191], v14 offset:47104
  v_fma_f32 v46, v46, s83, -v34
  v_mfma_f32_16x16x32_bf16 v[104:107], a[172:175], v[172:175], v[104:107]
  s_add_u32 m0, s31, 1024
  v_fma_f32 v47, v47, s83, -v34
  v_fma_f32 v48, v48, s83, -v34
  v_mfma_f32_16x16x32_bf16 v[108:111], a[176:179], v[172:175], v[108:111]
  s_waitcnt lgkmcnt(3)
  buffer_load_dwordx4 v11, s[8:11], s30 offen lds
  v_fma_f32 v49, v49, s83, -v34
  v_mfma_f32_16x16x32_bf16 v[112:115], a[168:171], v[176:179], v[112:115]
  ds_read_b128 v[160:163], v15 offset:32768
  v_fma_f32 v50, v50, s83, -v34
  v_mfma_f32_16x16x32_bf16 v[116:119], a[172:175], v[176:179], v[116:119]
  v_fma_f32 v51, v51, s83, -v34
  v_fma_f32 v52, v52, s83, -v34
  v_mfma_f32_16x16x32_bf16 v[120:123], a[176:179], v[176:179], v[120:123]
  s_waitcnt lgkmcnt(3)
  v_fma_f32 v53, v53, s83, -v34
  v_fma_f32 v54, v54, s83, -v34
  v_mfma_f32_16x16x32_bf16 v[124:127], a[168:171], v[180:183], v[124:127]
  ds_read_b128 v[164:167], v15 offset:34816
  v_fma_f32 v55, v55, s83, -v34
  v_mfma_f32_16x16x32_bf16 v[128:131], a[172:175], v[180:183], v[128:131]
  v_exp_f32 v44, v44
  v_mfma_f32_16x16x32_bf16 v[132:135], a[176:179], v[180:183], v[132:135]
  s_waitcnt lgkmcnt(3)
  v_exp_f32 v45, v45
  v_mfma_f32_16x16x32_bf16 v[136:139], a[168:171], v[184:187], v[136:139]
  ds_read_b128 v[168:171], v15 offset:36864
  v_mfma_f32_16x16x32_bf16 v[140:143], a[172:175], v[184:187], v[140:143]
  s_add_u32 m0, s31, 2048
  v_exp_f32 v46, v46
  v_mfma_f32_16x16x32_bf16 v[144:147], a[176:179], v[184:187], v[144:147]
  s_waitcnt lgkmcnt(3)
  buffer_load_dwordx4 v12, s[8:11], s30 offen lds
  v_mfma_f32_16x16x32_bf16 v[148:151], a[168:171], v[188:191], v[148:151]
  ds_read_b128 v[172:175], v15 offset:38912
  v_mfma_f32_16x16x32_bf16 v[152:155], a[172:175], v[188:191], v[152:155]
  v_exp_f32 v47, v47
  v_mfma_f32_16x16x32_bf16 v[156:159], a[176:179], v[188:191], v[156:159]
  s_waitcnt lgkmcnt(3)
  v_exp_f32 v48, v48
  v_mfma_f32_16x16x32_bf16 v[64:67], a[180:183], v[160:163], v[64:67]
  ds_read_b128 v[176:179], v15 offset:40960
  v_mfma_f32_16x16x32_bf16 v[68:71], a[184:187], v[160:163], v[68:71]
  v_exp_f32 v49, v49
  v_mfma_f32_16x16x32_bf16 v[72:75], a[188:191], v[160:163], v[72:75]
  s_waitcnt lgkmcnt(3)
  v_exp_f32 v50, v50
  v_mfma_f32_16x16x32_bf16 v[76:79], a[180:183], v[164:167], v[76:79]
  ds_read_b128 v[180:183], v15 offset:43008
  v_mfma_f32_16x16x32_bf16 v[80:83], a[184:187], v[164:167], v[80:83]
  s_add_u32 m0, s31, 3072
  v_exp_f32 v51, v51
  v_mfma_f32_16x16x32_bf16 v[84:87], a[188:191], v[164:167], v[84:87]
  s_waitcnt lgkmcnt(3)
  buffer_load_dwordx4 v13, s[8:11], s30 offen lds
  v_mfma_f32_16x16x32_bf16 v[88:91], a[180:183], v[168:171], v[88:91]
  s_add_u32 s30, s30, 128
  ds_read_b128 v[184:187], v15 offset:45056
  v_mfma_f32_16x16x32_bf16 v[92:95], a[184:187], v[168:171], v[92:95]
  v_exp_f32 v52, v52
  v_mfma_f32_16x16x32_bf16 v[96:99], a[188:191], v[168:171], v[96:99]
  s_waitcnt lgkmcnt(3)
  v_exp_f32 v53, v53
  v_mfma_f32_16x16x32_bf16 v[100:103], a[180:183], v[172:175], v[100:103]
  ds_read_b128 v[188:191], v15 offset:47104
  v_mfma_f32_16x16x32_bf16 v[104:107], a[184:187], v[172:175], v[104:107]
  v_exp_f32 v54, v54
  v_mfma_f32_16x16x32_bf16 v[108:111], a[188:191], v[172:175], v[108:111]
  s_waitcnt lgkmcnt(3)
  v_exp_f32 v55, v55
  v_mfma_f32_16x16x32_bf16 v[112:115], a[180:183], v[176:179], v[112:115]
  s_waitcnt vmcnt(8)
  s_barrier
  ds_read_b128 v[160:163], v14 offset:49152
  v_mfma_f32_16x16x32_bf16 v[116:119], a[184:187], v[176:179], v[116:119]
  v_add_f32 v34, v52, v53
  v_add_f32 v34, v34, v54
  v_mfma_f32_16x16x32_bf16 v[120:123], a[188:191], v[176:179], v[120:123]
  s_waitcnt lgkmcnt(3)
  v_add_f32 v34, v34, v55
  v_cndmask_b32 v34, 0, v34, s[62:63]
  v_mfma_f32_16x16x32_bf16 v[124:127], a[180:183], v[180:183], v[124:127]
  ds_read_b128 v[164:167], v14 offset:51200
  v_add_f32 v34, v34, v44
  v_mfma_f32_16x16x32_bf16 v[128:131], a[184:187], v[180:183], v[128:131]
  v_add_f32 v34, v34, v45
  v_add_f32 v34, v34, v46
  v_mfma_f32_16x16x32_bf16 v[132:135], a[188:191], v[180:183], v[132:135]
  s_waitcnt lgkmcnt(3)
  v_add_f32 v34, v34, v47
  v_add_f32 v34, v34, v48
  v_mfma_f32_16x16x32_bf16 v[136:139], a[180:183], v[184:187], v[136:139]
  ds_read_b128 v[168:171], v14 offset:53248
  v_add_f32 v34, v34, v49
  v_mfma_f32_16x16x32_bf16 v[140:143], a[184:187], v[184:187], v[140:143]
  v_add_f32 v34, v34, v50
  v_add_f32 v34, v34, v51
  v_mfma_f32_16x16x32_bf16 v[144:147], a[188:191], v[184:187], v[144:147]
  s_waitcnt lgkmcnt(3)
  v_mov_b32 v35, v34
  v_mfma_f32_16x16x32_bf16 v[148:151], a[180:183], v[188:191], v[148:151]
  ds_read_b128 v[172:175], v14 offset:55296
  v_permlane32_swap_b32 v34, v35
  v_mfma_f32_16x16x32_bf16 v[152:155], a[184:187], v[188:191], v[152:155]
  v_add_f32 v34, v34, v35
  v_mov_b32 v35, v34
  v_mfma_f32_16x16x32_bf16 v[156:159], a[188:191], v[188:191], v[156:159]
  s_waitcnt lgkmcnt(3)
  v_permlane16_swap_b32 v34, v35
  v_add_f32 v34, v34, v35
  v_mfma_f32_16x16x32_bf16 v[64:67], a[192:195], v[160:163], v[64:67]
  ds_read_b128 v[176:179], v14 offset:57344
  v_mfma_f32_16x16x32_bf16 v[68:71], a[196:199], v[160:163], v[68:71]
  s_add_u32 m0, s31, 16384
  v_rcp_f32 v34, v34
  v_mfma_f32_16x16x32_bf16 v[72:75], a[200:203], v[160:163], v[72:75]
  s_waitcnt lgkmcnt(3)
  buffer_load_dwordx4 v10, s[8:11], s30 offen lds
  v_mul_f32 v44, v44, v34
  v_mfma_f32_16x16x32_bf16 v[76:79], a[192:195], v[164:167], v[76:79]
  ds_read_b128 v[180:183], v14 offset:59392
  v_mul_f32 v45, v45, v34
  v_mfma_f32_16x16x32_bf16 v[80:83], a[196:199], v[164:167], v[80:83]
  v_mul_f32 v46, v46, v34
  v_mul_f32 v47, v47, v34
  v_mfma_f32_16x16x32_bf16 v[84:87], a[200:203], v[164:167], v[84:87]
  s_waitcnt lgkmcnt(3)
  v_mul_f32 v48, v48, v34
  v_mul_f32 v49, v49, v34
  v_mfma_f32_16x16x32_bf16 v[88:91], a[192:195], v[168:171], v[88:91]
  ds_read_b128 v[184:187], v14 offset:61440
  v_mul_f32 v50, v50, v34
  v_mfma_f32_16x16x32_bf16 v[92:95], a[196:199], v[168:171], v[92:95]
  v_mul_f32 v51, v51, v34
  v_mul_f32 v52, v52, v34
  v_mfma_f32_16x16x32_bf16 v[96:99], a[200:203], v[168:171], v[96:99]
  s_waitcnt lgkmcnt(3)
  v_mul_f32 v53, v53, v34
  v_mul_f32 v54, v54, v34
  v_mfma_f32_16x16x32_bf16 v[100:103], a[192:195], v[172:175], v[100:103]
  ds_read_b128 v[188:191], v14 offset:63488
  v_mul_f32 v55, v55, v34
  v_mfma_f32_16x16x32_bf16 v[104:107], a[196:199], v[172:175], v[104:107]
  s_add_u32 m0, s31, 17408
  v_cvt_pk_bf16_f32 v56, v44, v45
  v_cvt_pk_bf16_f32 v57, v46, v47
  v_mfma_f32_16x16x32_bf16 v[108:111], a[200:203], v[172:175], v[108:111]
  s_waitcnt lgkmcnt(3)
  buffer_load_dwordx4 v11, s[8:11], s30 offen lds
  v_cvt_pk_bf16_f32 v58, v48, v49
  v_mfma_f32_16x16x32_bf16 v[112:115], a[192:195], v[176:179], v[112:115]
  ds_read_b128 v[160:163], v15 offset:49152
  v_cvt_pk_bf16_f32 v59, v50, v51
  v_mfma_f32_16x16x32_bf16 v[116:119], a[196:199], v[176:179], v[116:119]
  v_cvt_pk_bf16_f32 v60, v40, v41
  v_cvt_pk_bf16_f32 v61, v42, v43
  v_mfma_f32_16x16x32_bf16 v[120:123], a[200:203], v[176:179], v[120:123]
  s_waitcnt lgkmcnt(3)
  v_cvt_pk_bf16_f32 v62, v52, v53
  v_cvt_pk_bf16_f32 v63, v54, v55
  v_mfma_f32_16x16x32_bf16 v[124:127], a[192:195], v[180:183], v[124:127]
  ds_read_b128 v[164:167], v15 offset:51200
  v_cvt_pk_bf16_f32 v248, v36, v37
  v_mfma_f32_16x16x32_bf16 v[128:131], a[196:199], v[180:183], v[128:131]
  v_cvt_pk_bf16_f32 v249, v38, v39
  buffer_store_dwordx4 v[56:59], v26, s[16:19], s81 offen sc1
  v_mfma_f32_16x16x32_bf16 v[132:135], a[200:203], v[180:183], v[132:135]
  s_waitcnt lgkmcnt(3)
  v_mfma_f32_16x16x32_bf16 v[136:139], a[192:195], v[184:187], v[136:139]
  ds_read_b128 v[168:171], v15 offset:53248
  v_mfma_f32_16x16x32_bf16 v[140:143], a[196:199], v[184:187], v[140:143]
  s_add_u32 m0, s31, 18432
  v_mfma_f32_16x16x32_bf16 v[144:147], a[200:203], v[184:187], v[144:147]
  s_waitcnt lgkmcnt(3)
  buffer_load_dwordx4 v12, s[8:11], s30 offen lds
  v_mfma_f32_16x16x32_bf16 v[148:151], a[192:195], v[188:191], v[148:151]
  ds_read_b128 v[172:175], v15 offset:55296
  v_mfma_f32_16x16x32_bf16 v[152:155], a[196:199], v[188:191], v[152:155]
  v_mfma_f32_16x16x32_bf16 v[156:159], a[200:203], v[188:191], v[156:159]
  s_waitcnt lgkmcnt(3)
  buffer_store_dwordx4 v[60:63], v26, s[16:19], s81 offen offset:1024 sc1
  v_mfma_f32_16x16x32_bf16 v[64:67], a[204:207], v[160:163], v[64:67]
  ds_read_b128 v[176:179], v15 offset:57344
  v_mfma_f32_16x16x32_bf16 v[68:71], a[208:211], v[160:163], v[68:71]
  v_mfma_f32_16x16x32_bf16 v[72:75], a[212:215], v[160:163], v[72:75]
  s_waitcnt lgkmcnt(3)
  buffer_store_dwordx2 v[248:249], v29, s[16:19], s81 offen offset:2048 sc1
  v_mfma_f32_16x16x32_bf16 v[76:79], a[204:207], v[164:167], v[76:79]
  ds_read_b128 v[180:183], v15 offset:59392
  s_mov_b32 s84, s82
  v_mfma_f32_16x16x32_bf16 v[80:83], a[208:211], v[164:167], v[80:83]
  s_add_u32 m0, s31, 19456
  s_cmp_gt_u32 s26, s87
  s_cselect_b32 s21, 0, s26
  v_mfma_f32_16x16x32_bf16 v[84:87], a[212:215], v[164:167], v[84:87]
  s_waitcnt lgkmcnt(3)
  buffer_load_dwordx4 v13, s[8:11], s30 offen lds
  v_mfma_f32_16x16x32_bf16 v[88:91], a[204:207], v[168:171], v[88:91]
  s_add_u32 s30, s30, 128
  ds_read_b128 v[184:187], v15 offset:61440
  v_mfma_f32_16x16x32_bf16 v[92:95], a[208:211], v[168:171], v[92:95]
  s_cmp_le_u32 s21, s85
  s_cbranch_scc1 qa2_267
  s_mov_b32 s49, s43
  s_mov_b32 s50, s45
  s_mov_b32 s81, s47
  s_mov_b32 s82, s48
  s_add_u32 s43, s43, 4
  s_add_u32 s45, s45, 8388608
  s_add_u32 s47, s47, 2097152
  s_xor_b32 s47, s47, 8192
  s_add_u32 s48, s48, 512
qa3_268:
  v_mfma_f32_16x16x32_bf16 v[96:99], a[212:215], v[168:171], v[96:99]
  s_waitcnt lgkmcnt(3)
  v_mfma_f32_16x16x32_bf16 v[100:103], a[204:207], v[172:175], v[100:103]
  ds_read_b128 v[188:191], v15 offset:63488
  v_mfma_f32_16x16x32_bf16 v[104:107], a[208:211], v[172:175], v[104:107]
  v_mfma_f32_16x16x32_bf16 v[108:111], a[212:215], v[172:175], v[108:111]
  s_waitcnt lgkmcnt(3)
  v_mfma_f32_16x16x32_bf16 v[112:115], a[204:207], v[176:179], v[112:115]
  s_waitcnt vmcnt(11)
  s_barrier
  ds_read_b128 v[160:163], v16 offset:0
  v_mfma_f32_16x16x32_bf16 v[116:119], a[208:211], v[176:179], v[116:119]
  buffer_load_dword v32, v30, s[72:75], s77 offen sc1
  v_mfma_f32_16x16x32_bf16 v[120:123], a[212:215], v[176:179], v[120:123]
  s_waitcnt lgkmcnt(3)
  v_mfma_f32_16x16x32_bf16 v[124:127], a[204:207], v[180:183], v[124:127]
  ds_read_b128 v[164:167], v16 offset:2048
  v_mfma_f32_16x16x32_bf16 v[128:131], a[208:211], v[180:183], v[128:131]
  v_mfma_f32_16x16x32_bf16 v[132:135], a[212:215], v[180:183], v[132:135]
  s_waitcnt lgkmcnt(3)
  v_mfma_f32_16x16x32_bf16 v[136:139], a[204:207], v[184:187], v[136:139]
  ds_read_b128 v[168:171], v16 offset:4096
  v_mfma_f32_16x16x32_bf16 v[140:143], a[208:211], v[184:187], v[140:143]
  v_mfma_f32_16x16x32_bf16 v[144:147], a[212:215], v[184:187], v[144:147]
  s_waitcnt lgkmcnt(3)
  v_mfma_f32_16x16x32_bf16 v[148:151], a[204:207], v[188:191], v[148:151]
  ds_read_b128 v[172:175], v16 offset:6144
  v_mfma_f32_16x16x32_bf16 v[152:155], a[208:211], v[188:191], v[152:155]
  v_mfma_f32_16x16x32_bf16 v[156:159], a[212:215], v[188:191], v[156:159]
  s_waitcnt lgkmcnt(3)
  v_mfma_f32_16x16x32_bf16 v[64:67], a[216:219], v[160:163], v[64:67]
  ds_read_b128 v[176:179], v16 offset:8192
  v_mfma_f32_16x16x32_bf16 v[68:71], a[220:223], v[160:163], v[68:71]
  s_add_u32 m0, s31, 32768
  v_mfma_f32_16x16x32_bf16 v[72:75], a[224:227], v[160:163], v[72:75]
  s_waitcnt lgkmcnt(3)
  buffer_load_dwordx4 v10, s[8:11], s30 offen lds
  v_mfma_f32_16x16x32_bf16 v[76:79], a[216:219], v[164:167], v[76:79]
  ds_read_b128 v[180:183], v16 offset:10240
  v_mfma_f32_16x16x32_bf16 v[80:83], a[220:223], v[164:167], v[80:83]
  v_mfma_f32_16x16x32_bf16 v[84:87], a[224:227], v[164:167], v[84:87]
  s_waitcnt lgkmcnt(3)
  v_mfma_f32_16x16x32_bf16 v[88:91], a[216:219], v[168:171], v[88:91]
  ds_read_b128 v[184:187], v16 offset:12288
  v_mfma_f32_16x16x32_bf16 v[92:95], a[220:223], v[168:171], v[92:95]
  s_add_u32 m0, s31, 33792
  v_mfma_f32_16x16x32_bf16 v[96:99], a[224:227], v[168:171], v[96:99]
  s_waitcnt lgkmcnt(3)
  buffer_load_dwordx4 v11, s[8:11], s30 offen lds
  v_mfma_f32_16x16x32_bf16 v[100:103], a[216:219], v[172:175], v[100:103]
  ds_read_b128 v[188:191], v16 offset:14336
  v_mfma_f32_16x16x32_bf16 v[104:107], a[220:223], v[172:175], v[104:107]
  v_mfma_f32_16x16x32_bf16 v[108:111], a[224:227], v[172:175], v[108:111]
  s_waitcnt lgkmcnt(3)
  v_mfma_f32_16x16x32_bf16 v[112:115], a[216:219], v[176:179], v[112:115]
  ds_read_b128 v[160:163], v17 offset:0
  v_mfma_f32_16x16x32_bf16 v[116:119], a[220:223], v[176:179], v[116:119]
  s_add_u32 m0, s31, 34816
  v_mfma_f32_16x16x32_bf16 v[120:123], a[224:227], v[176:179], v[120:123]
  s_waitcnt lgkmcnt(3)
  buffer_load_dwordx4 v12, s[8:11], s30 offen lds
  v_mfma_f32_16x16x32_bf16 v[124:127], a[216:219], v[180:183], v[124:127]
  ds_read_b128 v[164:167], v17 offset:2048
  v_mfma_f32_16x16x32_bf16 v[128:131], a[220:223], v[180:183], v[128:131]
  v_mfma_f32_16x16x32_bf16 v[132:135], a[224:227], v[180:183], v[132:135]
  s_waitcnt lgkmcnt(3)
  v_mfma_f32_16x16x32_bf16 v[136:139], a[216:219], v[184:187], v[136:139]
  ds_read_b128 v[168:171], v17 offset:4096
  v_mfma_f32_16x16x32_bf16 v[140:143], a[220:223], v[184:187], v[140:143]
  s_add_u32 m0, s31, 35840
  v_mfma_f32_16x16x32_bf16 v[144:147], a[224:227], v[184:187], v[144:147]
  s_waitcnt lgkmcnt(3)
  buffer_load_dwordx4 v13, s[8:11], s30 offen lds
  v_mfma_f32_16x16x32_bf16 v[148:151], a[216:219], v[188:191], v[148:151]
  s_add_u32 s30, s30, 128
  ds_read_b128 v[172:175], v17 offset:6144
  v_mfma_f32_16x16x32_bf16 v[152:155], a[220:223], v[188:191], v[152:155]
  v_mfma_f32_16x16x32_bf16 v[156:159], a[224:227], v[188:191], v[156:159]
  s_waitcnt lgkmcnt(3)
  v_mfma_f32_16x16x32_bf16 v[64:67], a[228:231], v[160:163], v[64:67]
  ds_read_b128 v[176:179], v17 offset:8192
  v_mfma_f32_16x16x32_bf16 v[68:71], a[232:235], v[160:163], v[68:71]
  v_mfma_f32_16x16x32_bf16 v[72:75], a[236:239], v[160:163], v[72:75]
  s_waitcnt lgkmcnt(3)
  v_mfma_f32_16x16x32_bf16 v[76:79], a[228:231], v[164:167], v[76:79]
  ds_read_b128 v[180:183], v17 offset:10240
  v_cvt_pk_bf16_f32 v192, v64, v65
  v_mfma_f32_16x16x32_bf16 v[80:83], a[232:235], v[164:167], v[80:83]
  v_cvt_pk_bf16_f32 v193, v66, v67
  v_cvt_pk_bf16_f32 v194, v68, v69
  v_mfma_f32_16x16x32_bf16 v[84:87], a[236:239], v[164:167], v[84:87]
  s_waitcnt lgkmcnt(3)
  v_cvt_pk_bf16_f32 v195, v70, v71
  v_cvt_pk_bf16_f32 v200, v72, v73
  v_mfma_f32_16x16x32_bf16 v[88:91], a[228:231], v[168:171], v[88:91]
  ds_read_b128 v[184:187], v17 offset:12288
  v_cvt_pk_bf16_f32 v201, v74, v75
  v_mfma_f32_16x16x32_bf16 v[92:95], a[232:235], v[168:171], v[92:95]
  v_cvt_pk_bf16_f32 v196, v76, v77
  v_cvt_pk_bf16_f32 v197, v78, v79
  v_mfma_f32_16x16x32_bf16 v[96:99], a[236:239], v[168:171], v[96:99]
  s_waitcnt lgkmcnt(3)
  v_cvt_pk_bf16_f32 v198, v80, v81
  v_cvt_pk_bf16_f32 v199, v82, v83
  v_mfma_f32_16x16x32_bf16 v[100:103], a[228:231], v[172:175], v[100:103]
  ds_read_b128 v[188:191], v17 offset:14336
  v_cvt_pk_bf16_f32 v202, v84, v85
  v_mfma_f32_16x16x32_bf16 v[104:107], a[232:235], v[172:175], v[104:107]
  v_cvt_pk_bf16_f32 v203, v86, v87
  v_cvt_pk_bf16_f32 v204, v88, v89
  v_mfma_f32_16x16x32_bf16 v[108:111], a[236:239], v[172:175], v[108:111]
  s_waitcnt lgkmcnt(3)
  v_cvt_pk_bf16_f32 v205, v90, v91
  v_cvt_pk_bf16_f32 v206, v92, v93
  v_mfma_f32_16x16x32_bf16 v[112:115], a[228:231], v[176:179], v[112:115]
  s_waitcnt vmcnt(12)
  s_barrier
  ds_read_b128 v[160:163], v14 offset:0
  v_mfma_f32_16x16x32_bf16 v[116:119], a[232:235], v[176:179], v[116:119]
  v_cvt_pk_bf16_f32 v207, v94, v95
  v_cvt_pk_bf16_f32 v212, v96, v97
  v_mfma_f32_16x16x32_bf16 v[120:123], a[236:239], v[176:179], v[120:123]
  s_waitcnt lgkmcnt(3)
  v_cvt_pk_bf16_f32 v213, v98, v99
  v_cvt_pk_bf16_f32 v208, v100, v101
  v_mfma_f32_16x16x32_bf16 v[124:127], a[228:231], v[180:183], v[124:127]
  ds_read_b128 v[164:167], v14 offset:2048
  v_cvt_pk_bf16_f32 v209, v102, v103
  v_mfma_f32_16x16x32_bf16 v[128:131], a[232:235], v[180:183], v[128:131]
  v_cvt_pk_bf16_f32 v210, v104, v105
  v_cvt_pk_bf16_f32 v211, v106, v107
  v_mfma_f32_16x16x32_bf16 v[132:135], a[236:239], v[180:183], v[132:135]
  s_waitcnt lgkmcnt(3)
  v_cvt_pk_bf16_f32 v214, v108, v109
  v_cvt_pk_bf16_f32 v215, v110, v111
  v_mfma_f32_16x16x32_bf16 v[136:139], a[228:231], v[184:187], v[136:139]
  ds_read_b128 v[168:171], v14 offset:4096
  v_cvt_pk_bf16_f32 v216, v112, v113
  v_mfma_f32_16x16x32_bf16 v[140:143], a[232:235], v[184:187], v[140:143]
  v_cvt_pk_bf16_f32 v217, v114, v115
  v_cvt_pk_bf16_f32 v218, v116, v117
  v_mfma_f32_16x16x32_bf16 v[144:147], a[236:239], v[184:187], v[144:147]
  s_waitcnt lgkmcnt(3)
  v_cvt_pk_bf16_f32 v219, v118, v119
  v_cvt_pk_bf16_f32 v224, v120, v121
  v_mfma_f32_16x16x32_bf16 v[148:151], a[228:231], v[188:191], v[148:151]
  ds_read_b128 v[172:175], v14 offset:6144
  v_cvt_pk_bf16_f32 v225, v122, v123
  v_mfma_f32_16x16x32_bf16 v[152:155], a[232:235], v[188:191], v[152:155]
  s_sub_u32 s26, s26, 1
  s_cmp_gt_u32 s26, 0
  v_cvt_pk_bf16_f32 v220, v124, v125
  v_mfma_f32_16x16x32_bf16 v[156:159], a[236:239], v[188:191], v[156:159]
  s_waitcnt lgkmcnt(3)
  s_cbranch_scc1 qa_271
  s_nop 7
  v_cvt_pk_bf16_f32 v221, v126, v127
  v_cvt_pk_bf16_f32 v222, v128, v129
  v_cvt_pk_bf16_f32 v223, v130, v131
  v_cvt_pk_bf16_f32 v226, v132, v133
  v_cvt_pk_bf16_f32 v227, v134, v135
  v_cvt_pk_bf16_f32 v228, v136, v137
  v_cvt_pk_bf16_f32 v229, v138, v139
  v_cvt_pk_bf16_f32 v230, v140, v141
  v_cvt_pk_bf16_f32 v231, v142, v143
  v_cvt_pk_bf16_f32 v236, v144, v145
  v_cvt_pk_bf16_f32 v237, v146, v147
  v_cvt_pk_bf16_f32 v232, v148, v149
  v_cvt_pk_bf16_f32 v233, v150, v151
  v_cvt_pk_bf16_f32 v234, v152, v153
  v_cvt_pk_bf16_f32 v235, v154, v155
  v_cvt_pk_bf16_f32 v238, v156, v157
  v_cvt_pk_bf16_f32 v239, v158, v159
  s_waitcnt lgkmcnt(0)
  s_mul_i32 s86, s42, 393216
  ds_read_b128 v[64:67], v21 offset:0
  ds_read_b128 v[68:71], v21 offset:1024
  ds_read_b128 v[72:75], v21 offset:3072
  ds_read_b128 v[76:79], v21 offset:4096
  ds_read2st64_b64 v[80:83], v22 offset0:0 offset1:6
  ds_read2st64_b64 v[84:87], v23 offset0:0 offset1:6
  ds_read_b128 v[88:91], v21 offset:6144
  ds_read_b128 v[92:95], v21 offset:7168
  ds_read_b128 v[96:99], v21 offset:9216
  ds_read_b128 v[100:103], v21 offset:10240
  ds_read2st64_b64 v[104:107], v22 offset0:12 offset1:18
  ds_read2st64_b64 v[108:111], v23 offset0:12 offset1:18
  s_waitcnt lgkmcnt(0)
  s_barrier
  ds_write_b128 v20, v[192:195] offset:0
  ds_write_b128 v20, v[196:199] offset:1024
  ds_write_b128 v20, v[200:203] offset:2048
  ds_write_b128 v20, v[204:207] offset:12288
  ds_write_b128 v20, v[208:211] offset:13312
  ds_write_b128 v20, v[212:215] offset:14336
  ds_write_b128 v20, v[216:219] offset:24576
  ds_write_b128 v20, v[220:223] offset:25600
  ds_write_b128 v20, v[224:227] offset:26624
  ds_write_b128 v20, v[228:231] offset:36864
  ds_write_b128 v20, v[232:235] offset:37888
  ds_write_b128 v20, v[236:239] offset:38912
  s_waitcnt lgkmcnt(0)
  s_barrier
  s_cmp_eq_u32 s40, 0
  s_cbranch_scc1 qf_274
  s_mov_b32 s49, s43
  s_mov_b32 s50, s45
  s_mov_b32 s81, s47
  s_mov_b32 s82, s48
  s_add_u32 s43, s43, 4
  s_add_u32 s45, s45, 8388608
  s_add_u32 s47, s47, 2097152
  s_xor_b32 s47, s47, 8192
  s_add_u32 s48, s48, 512
  s_cmp_gt_u32 s49, 60
  s_cselect_b32 s23, 58, s49
  v_cmp_gt_u32 vcc, s23, v32
  s_nop 1
  s_cbranch_vccz qk_277
  s_waitcnt vmcnt(0)
  buffer_atomic_add v28, v33, s[72:75], s84 offen sc1
  s_mov_b32 s84, 1073741824
  s_mov_b32 s101, 0
wm_281:
  buffer_load_dword v32, v30, s[72:75], s77 offen sc1
  s_add_u32 s101, s101, 1
  s_cmp_gt_u32 s101, 131072
  s_cbranch_scc1 main_end
  s_waitcnt vmcnt(0)
  v_cmp_gt_u32 vcc, s23, v32
  v_readfirstlane_b32 s100, v32
  s_nop 0
  s_cbranch_vccz wm_282
  s_sleep 4
  s_add_u32 s100, s100, 2
  s_cmp_ge_u32 s100, s23
  s_cbranch_scc1 wm_281
  s_sleep 40
  s_branch wm_281
wm_282:
qk_277:
  s_add_u32 s29, s50, 0
  buffer_load_dwordx4 v[112:115], v26, s[16:19], s29 offen offset:0 sc1
  buffer_load_dwordx4 v[116:119], v26, s[16:19], s29 offen offset:1024 sc1
  buffer_load_dwordx4 v[144:147], v26, s[16:19], s29 offen offset:2048 sc1
  s_add_u32 s29, s50, 16384
  buffer_load_dwordx4 v[120:123], v26, s[16:19], s29 offen offset:0 sc1
  buffer_load_dwordx4 v[124:127], v26, s[16:19], s29 offen offset:1024 sc1
  buffer_load_dwordx4 v[148:151], v26, s[16:19], s29 offen offset:2048 sc1
  s_add_u32 s29, s50, 32768
  buffer_load_dwordx4 v[128:131], v26, s[16:19], s29 offen offset:0 sc1
  buffer_load_dwordx4 v[132:135], v26, s[16:19], s29 offen offset:1024 sc1
  buffer_load_dwordx4 v[152:155], v26, s[16:19], s29 offen offset:2048 sc1
  s_add_u32 s29, s50, 49152
  buffer_load_dwordx4 v[136:139], v26, s[16:19], s29 offen offset:0 sc1
  buffer_load_dwordx4 v[140:143], v26, s[16:19], s29 offen offset:1024 sc1
  buffer_load_dwordx4 v[156:159], v26, s[16:19], s29 offen offset:2048 sc1
  s_add_u32 s29, s50, 4096
  buffer_load_dwordx4 v[160:163], v24, s[16:19], s29 offen offset:2560 sc1
  buffer_load_dwordx2 v[240:241], v25, s[16:19], s29 offen offset:3072 sc1
  s_add_u32 s29, s50, 20480
  buffer_load_dwordx4 v[164:167], v24, s[16:19], s29 offen offset:2560 sc1
  buffer_load_dwordx2 v[242:243], v25, s[16:19], s29 offen offset:3072 sc1
  s_add_u32 s29, s50, 36864
  buffer_load_dwordx4 v[168:171], v24, s[16:19], s29 offen offset:2560 sc1
  buffer_load_dwordx2 v[244:245], v25, s[16:19], s29 offen offset:3072 sc1
  s_add_u32 s29, s50, 53248
  buffer_load_dwordx4 v[172:175], v24, s[16:19], s29 offen offset:2560 sc1
  buffer_load_dwordx2 v[246:247], v25, s[16:19], s29 offen offset:3072 sc1
  buffer_load_dword v32, v30, s[72:75], s77 offen sc1
  s_waitcnt vmcnt(9) lgkmcnt(0)
  buffer_atomic_add v28, v33, s[72:75], s84 offen sc1
  v_swap_b32 v146, v148
  v_swap_b32 v147, v149
  v_swap_b32 v154, v156
  v_swap_b32 v155, v157
  s_nop 1
  v_mfma_f32_16x16x32_bf16 v[36:39], v[112:115], v[64:67], 0
  v_mfma_f32_16x16x32_bf16 v[44:47], v[112:115], v[68:71], 0
  v_mfma_f32_16x16x32_bf16 v[48:51], v[116:119], v[68:71], 0
  v_mfma_f32_16x16x32_bf16 v[36:39], v[120:123], v[72:75], v[36:39]
  v_mfma_f32_16x16x32_bf16 v[44:47], v[120:123], v[76:79], v[44:47]
  v_mfma_f32_16x16x32_bf16 v[48:51], v[124:127], v[76:79], v[48:51]
  v_mfma_f32_16x16x32_bf16 v[36:39], v[144:147], v[80:83], v[36:39]
  v_mfma_f32_16x16x32_bf16 v[44:47], v[144:147], v[84:87], v[44:47]
  v_mfma_f32_16x16x32_bf16 v[48:51], v[148:151], v[84:87], v[48:51]
  v_mfma_f32_16x16x32_bf16 v[36:39], v[128:131], v[88:91], v[36:39]
  v_mfma_f32_16x16x32_bf16 v[44:47], v[128:131], v[92:95], v[44:47]
  v_mfma_f32_16x16x32_bf16 v[48:51], v[132:135], v[92:95], v[48:51]
  v_mfma_f32_16x16x32_bf16 v[36:39], v[136:139], v[96:99], v[36:39]
  v_mfma_f32_16x16x32_bf16 v[44:47], v[136:139], v[100:103], v[44:47]
  v_mfma_f32_16x16x32_bf16 v[48:51], v[140:143], v[100:103], v[48:51]
  v_mfma_f32_16x16x32_bf16 v[36:39], v[152:155], v[104:107], v[36:39]
  v_mfma_f32_16x16x32_bf16 v[44:47], v[152:155], v[108:111], v[44:47]
  v_mfma_f32_16x16x32_bf16 v[48:51], v[156:159], v[108:111], v[48:51]
  s_waitcnt vmcnt(1)
  v_max3_u32 v34, v160, v164, v168
  v_max3_u32 v34, v34, v172, v240
  v_max3_u32 v34, v34, v242, v244
  v_max_u32 v34, v34, v246
  v_cmp_eq_u32 vcc, -1, v34
  s_nop 1
  s_cbranch_vccz qtp_280
  s_sub_u32 s23, s49, 1
  s_min_u32 s23, s23, 62
  s_mov_b32 s101, 0
wm_283:
  buffer_load_dword v32, v30, s[72:75], s77 offen sc1
  s_add_u32 s101, s101, 1
  s_cmp_gt_u32 s101, 131072
  s_cbranch_scc1 main_end
  s_waitcnt vmcnt(0)
  v_cmp_gt_u32 vcc, s23, v32
  v_readfirstlane_b32 s100, v32
  s_nop 0
  s_cbranch_vccz wm_284
  s_sleep 4
  s_add_u32 s100, s100, 2
  s_cmp_ge_u32 s100, s23
  s_cbranch_scc1 wm_283
  s_sleep 40
  s_branch wm_283
wm_284:
  s_mov_b32 s101, 0
  s_branch qtp_279
qtp_278:
  s_sleep 2
qtp_279:
  s_add_u32 s29, s50, 4096
  buffer_load_dwordx4 v[160:163], v24, s[16:19], s29 offen offset:2560 sc1
  buffer_load_dwordx2 v[240:241], v25, s[16:19], s29 offen offset:3072 sc1
  s_add_u32 s29, s50, 20480
  buffer_load_dwordx4 v[164:167], v24, s[16:19], s29 offen offset:2560 sc1
  buffer_load_dwordx2 v[242:243], v25, s[16:19], s29 offen offset:3072 sc1
  s_add_u32 s29, s50, 36864
  buffer_load_dwordx4 v[168:171], v24, s[16:19], s29 offen offset:2560 sc1
  buffer_load_dwordx2 v[244:245], v25, s[16:19], s29 offen offset:3072 sc1
  s_add_u32 s29, s50, 53248
  buffer_load_dwordx4 v[172:175], v24, s[16:19], s29 offen offset:2560 sc1
  buffer_load_dwordx2 v[246:247], v25, s[16:19], s29 offen offset:3072 sc1
  s_add_u32 s101, s101, 1
  s_cmp_gt_u32 s101, 131072
  s_cbranch_scc1 main_end
  s_waitcnt vmcnt(0)
  v_max3_u32 v34, v160, v164, v168
  v_max3_u32 v34, v34, v172, v240
  v_max3_u32 v34, v34, v242, v244
  v_max_u32 v34, v34, v246
  v_cmp_eq_u32 vcc, -1, v34
  s_nop 1
  s_cbranch_vccnz qtp_278
qtp_280:
  v_mfma_f32_16x16x32_bf16 v[40:43], v[160:163], v[64:67], 0
  v_mfma_f32_16x16x32_bf16 v[52:55], v[160:163], v[68:71], 0
  v_mfma_f32_16x16x32_bf16 v[40:43], v[164:167], v[72:75], v[40:43]
  v_mfma_f32_16x16x32_bf16 v[52:55], v[164:167], v[76:79], v[52:55]
  v_mfma_f32_16x16x32_bf16 v[40:43], v[240:243], v[80:83], v[40:43]
  v_mfma_f32_16x16x32_bf16 v[52:55], v[240:243], v[84:87], v[52:55]
  v_mfma_f32_16x16x32_bf16 v[40:43], v[168:171], v[88:91], v[40:43]
  v_mfma_f32_16x16x32_bf16 v[52:55], v[168:171], v[92:95], v[52:55]
  v_mfma_f32_16x16x32_bf16 v[40:43], v[172:175], v[96:99], v[40:43]
  v_mfma_f32_16x16x32_bf16 v[52:55], v[172:175], v[100:103], v[52:55]
  v_mfma_f32_16x16x32_bf16 v[40:43], v[244:247], v[104:107], v[40:43]
  v_mfma_f32_16x16x32_bf16 v[52:55], v[244:247], v[108:111], v[52:55]
  s_nop 4
  v_cndmask_b32 v36, v31, v36, s[64:65]
  v_cndmask_b32 v48, v31, v48, s[64:65]
  v_cndmask_b32 v37, v31, v37, s[66:67]
  v_cndmask_b32 v49, v31, v49, s[66:67]
  v_cndmask_b32 v38, v31, v38, s[68:69]
  v_cndmask_b32 v50, v31, v50, s[68:69]
  v_cndmask_b32 v39, v31, v39, s[70:71]
  v_cndmask_b32 v51, v31, v51, s[70:71]
  v_max3_f32 v34, v36, v37, v38
  v_max3_f32 v34, v34, v39, v40
  v_max3_f32 v34, v34, v41, v42
  v_max_f32 v34, v34, v43
  v_mov_b32 v35, v34
  s_nop 1
  v_permlane32_swap_b32 v34, v35
  v_max_f32 v34, v34, v35
  v_mov_b32 v35, v34
  s_nop 1
  v_permlane16_swap_b32 v34, v35
  v_max_f32 v34, v34, v35
  v_mul_f32 v34, s83, v34
  v_fma_f32 v36, v36, s83, -v34
  v_fma_f32 v37, v37, s83, -v34
  v_fma_f32 v38, v38, s83, -v34
  v_fma_f32 v39, v39, s83, -v34
  v_fma_f32 v40, v40, s83, -v34
  v_fma_f32 v41, v41, s83, -v34
  v_fma_f32 v42, v42, s83, -v34
  v_fma_f32 v43, v43, s83, -v34
  v_exp_f32 v36, v36
  v_exp_f32 v37, v37
  v_exp_f32 v38, v38
  v_exp_f32 v39, v39
  v_exp_f32 v40, v40
  v_exp_f32 v41, v41
  v_exp_f32 v42, v42
  v_exp_f32 v43, v43
  s_nop 0
  v_add_f32 v34, v40, v41
  v_add_f32 v34, v34, v42
  v_add_f32 v34, v34, v43
  v_cndmask_b32 v34, 0, v34, s[62:63]
  v_add_f32 v34, v34, v36
  v_add_f32 v34, v34, v37
  v_add_f32 v34, v34, v38
  v_add_f32 v34, v34, v39
  v_mov_b32 v35, v34
  s_nop 1
  v_permlane32_swap_b32 v34, v35
  v_add_f32 v34, v34, v35
  v_mov_b32 v35, v34
  s_nop 1
  v_permlane16_swap_b32 v34, v35
  v_add_f32 v34, v34, v35
  v_rcp_f32 v34, v34
  s_nop 0
  v_mul_f32 v36, v36, v34
  v_mul_f32 v37, v37, v34
  v_mul_f32 v38, v38, v34
  v_mul_f32 v39, v39, v34
  v_mul_f32 v40, v40, v34
  v_mul_f32 v41, v41, v34
  v_mul_f32 v42, v42, v34
  v_mul_f32 v43, v43, v34
  v_max3_f32 v34, v44, v45, v46
  v_max3_f32 v34, v34, v47, v48
  v_max3_f32 v34, v34, v49, v50
  v_max3_f32 v34, v34, v51, v52
  v_max3_f32 v34, v34, v53, v54
  v_max_f32 v34, v34, v55
  v_mov_b32 v35, v34
  s_nop 1
  v_permlane32_swap_b32 v34, v35
  v_max_f32 v34, v34, v35
  v_mov_b32 v35, v34
  s_nop 1
  v_permlane16_swap_b32 v34, v35
  v_max_f32 v34, v34, v35
  v_mul_f32 v34, s83, v34
  v_fma_f32 v44, v44, s83, -v34
  v_fma_f32 v45, v45, s83, -v34
  v_fma_f32 v46, v46, s83, -v34
  v_fma_f32 v47, v47, s83, -v34
  v_fma_f32 v48, v48, s83, -v34
  v_fma_f32 v49, v49, s83, -v34
  v_fma_f32 v50, v50, s83, -v34
  v_fma_f32 v51, v51, s83, -v34
  v_fma_f32 v52, v52, s83, -v34
  v_fma_f32 v53, v53, s83, -v34
  v_fma_f32 v54, v54, s83, -v34
  v_fma_f32 v55, v55, s83, -v34
  v_exp_f32 v44, v44
  v_exp_f32 v45, v45
  v_exp_f32 v46, v46
  v_exp_f32 v47, v47
  v_exp_f32 v48, v48
  v_exp_f32 v49, v49
  v_exp_f32 v50, v50
  v_exp_f32 v51, v51
  v_exp_f32 v52, v52
  v_exp_f32 v53, v53
  v_exp_f32 v54, v54
  v_exp_f32 v55, v55
  s_nop 0
  v_add_f32 v34, v52, v53
  v_add_f32 v34, v34, v54
  v_add_f32 v34, v34, v55
  v_cndmask_b32 v34, 0, v34, s[62:63]
  v_add_f32 v34, v34, v44
  v_add_f32 v34, v34, v45
  v_add_f32 v34, v34, v46
  v_add_f32 v34, v34, v47
  v_add_f32 v34, v34, v48
  v_add_f32 v34, v34, v49
  v_add_f32 v34, v34, v50
  v_add_f32 v34, v34, v51
  v_mov_b32 v35, v34
  s_nop 1
  v_permlane32_swap_b32 v34, v35
  v_add_f32 v34, v34, v35
  v_mov_b32 v35, v34
  s_nop 1
  v_permlane16_swap_b32 v34, v35
  v_add_f32 v34, v34, v35
  v_rcp_f32 v34, v34
  s_nop 0
  v_mul_f32 v44, v44, v34
  v_mul_f32 v45, v45, v34
  v_mul_f32 v46, v46, v34
  v_mul_f32 v47, v47, v34
  v_mul_f32 v48, v48, v34
  v_mul_f32 v49, v49, v34
  v_mul_f32 v50, v50, v34
  v_mul_f32 v51, v51, v34
  v_mul_f32 v52, v52, v34
  v_mul_f32 v53, v53, v34
  v_mul_f32 v54, v54, v34
  v_mul_f32 v55, v55, v34
  v_cvt_pk_bf16_f32 v56, v44, v45
  v_cvt_pk_bf16_f32 v57, v46, v47
  v_cvt_pk_bf16_f32 v58, v48, v49
  v_cvt_pk_bf16_f32 v59, v50, v51
  v_cvt_pk_bf16_f32 v60, v40, v41
  v_cvt_pk_bf16_f32 v61, v42, v43
  v_cvt_pk_bf16_f32 v62, v52, v53
  v_cvt_pk_bf16_f32 v63, v54, v55
  v_cvt_pk_bf16_f32 v248, v36, v37
  v_cvt_pk_bf16_f32 v249, v38, v39
  buffer_store_dwordx4 v[56:59], v26, s[16:19], s81 offen sc1
  buffer_store_dwordx4 v[60:63], v26, s[16:19], s81 offen offset:1024 sc1
  buffer_store_dwordx2 v[248:249], v29, s[16:19], s81 offen offset:2048 sc1
  s_mov_b32 s84, s82
qf_274:
  ds_read_b128 v[64:67], v21 offset:0
  ds_read_b128 v[68:71], v21 offset:1024
  ds_read_b128 v[72:75], v21 offset:3072
  ds_read_b128 v[76:79], v21 offset:4096
  ds_read2st64_b64 v[80:83], v22 offset0:0 offset1:6
  ds_read2st64_b64 v[84:87], v23 offset0:0 offset1:6
  ds_read_b128 v[88:91], v21 offset:6144
  ds_read_b128 v[92:95], v21 offset:7168
  ds_read_b128 v[96:99], v21 offset:9216
  ds_read_b128 v[100:103], v21 offset:10240
  ds_read2st64_b64 v[104:107], v22 offset0:12 offset1:18
  ds_read2st64_b64 v[108:111], v23 offset0:12 offset1:18
  s_mov_b32 s49, s43
  s_mov_b32 s50, s45
  s_mov_b32 s81, s47
  s_mov_b32 s82, s48
  s_add_u32 s43, s43, 4
  s_add_u32 s45, s45, 8388608
  s_add_u32 s47, s47, 2097152
  s_xor_b32 s47, s47, 8192
  s_add_u32 s48, s48, 512
  s_cmp_gt_u32 s49, 60
  s_cselect_b32 s23, 58, s49
  v_cmp_gt_u32 vcc, s23, v32
  s_nop 1
  s_cbranch_vccz qk_285
  s_waitcnt vmcnt(0)
  buffer_atomic_add v28, v33, s[72:75], s84 offen sc1
  s_mov_b32 s84, 1073741824
  s_mov_b32 s101, 0
wm_289:
  buffer_load_dword v32, v30, s[72:75], s77 offen sc1
  s_add_u32 s101, s101, 1
  s_cmp_gt_u32 s101, 131072
  s_cbranch_scc1 main_end
  s_waitcnt vmcnt(0)
  v_cmp_gt_u32 vcc, s23, v32
  v_readfirstlane_b32 s100, v32
  s_nop 0
  s_cbranch_vccz wm_290
  s_sleep 4
  s_add_u32 s100, s100, 2
  s_cmp_ge_u32 s100, s23
  s_cbranch_scc1 wm_289
  s_sleep 40
  s_branch wm_289
wm_290:
qk_285:
  s_add_u32 s29, s50, 0
  buffer_load_dwordx4 v[112:115], v26, s[16:19], s29 offen offset:0 sc1
  buffer_load_dwordx4 v[116:119], v26, s[16:19], s29 offen offset:1024 sc1
  buffer_load_dwordx4 v[144:147], v26, s[16:19], s29 offen offset:2048 sc1
  s_add_u32 s29, s50, 16384
  buffer_load_dwordx4 v[120:123], v26, s[16:19], s29 offen offset:0 sc1
  buffer_load_dwordx4 v[124:127], v26, s[16:19], s29 offen offset:1024 sc1
  buffer_load_dwordx4 v[148:151], v26, s[16:19], s29 offen offset:2048 sc1
  s_add_u32 s29, s50, 32768
  buffer_load_dwordx4 v[128:131], v26, s[16:19], s29 offen offset:0 sc1
  buffer_load_dwordx4 v[132:135], v26, s[16:19], s29 offen offset:1024 sc1
  buffer_load_dwordx4 v[152:155], v26, s[16:19], s29 offen offset:2048 sc1
  s_add_u32 s29, s50, 49152
  buffer_load_dwordx4 v[136:139], v26, s[16:19], s29 offen offset:0 sc1
  buffer_load_dwordx4 v[140:143], v26, s[16:19], s29 offen offset:1024 sc1
  buffer_load_dwordx4 v[156:159], v26, s[16:19], s29 offen offset:2048 sc1
  s_add_u32 s29, s50, 4096
  buffer_load_dwordx4 v[160:163], v24, s[16:19], s29 offen offset:2560 sc1
  buffer_load_dwordx2 v[240:241], v25, s[16:19], s29 offen offset:3072 sc1
  s_add_u32 s29, s50, 20480
  buffer_load_dwordx4 v[164:167], v24, s[16:19], s29 offen offset:2560 sc1
  buffer_load_dwordx2 v[242:243], v25, s[16:19], s29 offen offset:3072 sc1
  s_add_u32 s29, s50, 36864
  buffer_load_dwordx4 v[168:171], v24, s[16:19], s29 offen offset:2560 sc1
  buffer_load_dwordx2 v[244:245], v25, s[16:19], s29 offen offset:3072 sc1
  s_add_u32 s29, s50, 53248
  buffer_load_dwordx4 v[172:175], v24, s[16:19], s29 offen offset:2560 sc1
  buffer_load_dwordx2 v[246:247], v25, s[16:19], s29 offen offset:3072 sc1
  buffer_load_dword v32, v30, s[72:75], s77 offen sc1
  s_waitcnt vmcnt(9) lgkmcnt(0)
  buffer_atomic_add v28, v33, s[72:75], s84 offen sc1
  v_swap_b32 v146, v148
  v_swap_b32 v147, v149
  v_swap_b32 v154, v156
  v_swap_b32 v155, v157
  s_nop 1
  v_mfma_f32_16x16x32_bf16 v[36:39], v[112:115], v[64:67], 0
  v_mfma_f32_16x16x32_bf16 v[44:47], v[112:115], v[68:71], 0
  v_mfma_f32_16x16x32_bf16 v[48:51], v[116:119], v[68:71], 0
  v_mfma_f32_16x16x32_bf16 v[36:39], v[120:123], v[72:75], v[36:39]
  v_mfma_f32_16x16x32_bf16 v[44:47], v[120:123], v[76:79], v[44:47]
  v_mfma_f32_16x16x32_bf16 v[48:51], v[124:127], v[76:79], v[48:51]
  v_mfma_f32_16x16x32_bf16 v[36:39], v[144:147], v[80:83], v[36:39]
  v_mfma_f32_16x16x32_bf16 v[44:47], v[144:147], v[84:87], v[44:47]
  v_mfma_f32_16x16x32_bf16 v[48:51], v[148:151], v[84:87], v[48:51]
  v_mfma_f32_16x16x32_bf16 v[36:39], v[128:131], v[88:91], v[36:39]
  v_mfma_f32_16x16x32_bf16 v[44:47], v[128:131], v[92:95], v[44:47]
  v_mfma_f32_16x16x32_bf16 v[48:51], v[132:135], v[92:95], v[48:51]
  v_mfma_f32_16x16x32_bf16 v[36:39], v[136:139], v[96:99], v[36:39]
  v_mfma_f32_16x16x32_bf16 v[44:47], v[136:139], v[100:103], v[44:47]
  v_mfma_f32_16x16x32_bf16 v[48:51], v[140:143], v[100:103], v[48:51]
  v_mfma_f32_16x16x32_bf16 v[36:39], v[152:155], v[104:107], v[36:39]
  v_mfma_f32_16x16x32_bf16 v[44:47], v[152:155], v[108:111], v[44:47]
  v_mfma_f32_16x16x32_bf16 v[48:51], v[156:159], v[108:111], v[48:51]
  s_waitcnt vmcnt(1)
  v_max3_u32 v34, v160, v164, v168
  v_max3_u32 v34, v34, v172, v240
  v_max3_u32 v34, v34, v242, v244
  v_max_u32 v34, v34, v246
  v_cmp_eq_u32 vcc, -1, v34
  s_nop 1
  s_cbranch_vccz qtp_288
  s_sub_u32 s23, s49, 1
  s_min_u32 s23, s23, 62
  s_mov_b32 s101, 0
wm_291:
  buffer_load_dword v32, v30, s[72:75], s77 offen sc1
  s_add_u32 s101, s101, 1
  s_cmp_gt_u32 s101, 131072
  s_cbranch_scc1 main_end
  s_waitcnt vmcnt(0)
  v_cmp_gt_u32 vcc, s23, v32
  v_readfirstlane_b32 s100, v32
  s_nop 0
  s_cbranch_vccz wm_292
  s_sleep 4
  s_add_u32 s100, s100, 2
  s_cmp_ge_u32 s100, s23
  s_cbranch_scc1 wm_291
  s_sleep 40
  s_branch wm_291
wm_292:
  s_mov_b32 s101, 0
  s_branch qtp_287
qtp_286:
  s_sleep 2
qtp_287:
  s_add_u32 s29, s50, 4096
  buffer_load_dwordx4 v[160:163], v24, s[16:19], s29 offen offset:2560 sc1
  buffer_load_dwordx2 v[240:241], v25, s[16:19], s29 offen offset:3072 sc1
  s_add_u32 s29, s50, 20480
  buffer_load_dwordx4 v[164:167], v24, s[16:19], s29 offen offset:2560 sc1
  buffer_load_dwordx2 v[242:243], v25, s[16:19], s29 offen offset:3072 sc1
  s_add_u32 s29, s50, 36864
  buffer_load_dwordx4 v[168:171], v24, s[16:19], s29 offen offset:2560 sc1
  buffer_load_dwordx2 v[244:245], v25, s[16:19], s29 offen offset:3072 sc1
  s_add_u32 s29, s50, 53248
  buffer_load_dwordx4 v[172:175], v24, s[16:19], s29 offen offset:2560 sc1
  buffer_load_dwordx2 v[246:247], v25, s[16:19], s29 offen offset:3072 sc1
  s_add_u32 s101, s101, 1
  s_cmp_gt_u32 s101, 131072
  s_cbranch_scc1 main_end
  s_waitcnt vmcnt(0)
  v_max3_u32 v34, v160, v164, v168
  v_max3_u32 v34, v34, v172, v240
  v_max3_u32 v34, v34, v242, v244
  v_max_u32 v34, v34, v246
  v_cmp_eq_u32 vcc, -1, v34
  s_nop 1
  s_cbranch_vccnz qtp_286
qtp_288:
  v_mfma_f32_16x16x32_bf16 v[40:43], v[160:163], v[64:67], 0
  v_mfma_f32_16x16x32_bf16 v[52:55], v[160:163], v[68:71], 0
  v_mfma_f32_16x16x32_bf16 v[40:43], v[164:167], v[72:75], v[40:43]
  v_mfma_f32_16x16x32_bf16 v[52:55], v[164:167], v[76:79], v[52:55]
  v_mfma_f32_16x16x32_bf16 v[40:43], v[240:243], v[80:83], v[40:43]
  v_mfma_f32_16x16x32_bf16 v[52:55], v[240:243], v[84:87], v[52:55]
  v_mfma_f32_16x16x32_bf16 v[40:43], v[168:171], v[88:91], v[40:43]
  v_mfma_f32_16x16x32_bf16 v[52:55], v[168:171], v[92:95], v[52:55]
  v_mfma_f32_16x16x32_bf16 v[40:43], v[172:175], v[96:99], v[40:43]
  v_mfma_f32_16x16x32_bf16 v[52:55], v[172:175], v[100:103], v[52:55]
  v_mfma_f32_16x16x32_bf16 v[40:43], v[244:247], v[104:107], v[40:43]
  v_mfma_f32_16x16x32_bf16 v[52:55], v[244:247], v[108:111], v[52:55]
  s_nop 4
  v_cndmask_b32 v36, v31, v36, s[64:65]
  v_cndmask_b32 v48, v31, v48, s[64:65]
  v_cndmask_b32 v37, v31, v37, s[66:67]
  v_cndmask_b32 v49, v31, v49, s[66:67]
  v_cndmask_b32 v38, v31, v38, s[68:69]
  v_cndmask_b32 v50, v31, v50, s[68:69]
  v_cndmask_b32 v39, v31, v39, s[70:71]
  v_cndmask_b32 v51, v31, v51, s[70:71]
  v_max3_f32 v34, v36, v37, v38
  v_max3_f32 v34, v34, v39, v40
  v_max3_f32 v34, v34, v41, v42
  v_max_f32 v34, v34, v43
  v_mov_b32 v35, v34
  s_nop 1
  v_permlane32_swap_b32 v34, v35
  v_max_f32 v34, v34, v35
  v_mov_b32 v35, v34
  s_nop 1
  v_permlane16_swap_b32 v34, v35
  v_max_f32 v34, v34, v35
  v_mul_f32 v34, s83, v34
  v_fma_f32 v36, v36, s83, -v34
  v_fma_f32 v37, v37, s83, -v34
  v_fma_f32 v38, v38, s83, -v34
  v_fma_f32 v39, v39, s83, -v34
  v_fma_f32 v40, v40, s83, -v34
  v_fma_f32 v41, v41, s83, -v34
  v_fma_f32 v42, v42, s83, -v34
  v_fma_f32 v43, v43, s83, -v34
  v_exp_f32 v36, v36
  v_exp_f32 v37, v37
  v_exp_f32 v38, v38
  v_exp_f32 v39, v39
  v_exp_f32 v40, v40
  v_exp_f32 v41, v41
  v_exp_f32 v42, v42
  v_exp_f32 v43, v43
  s_nop 0
  v_add_f32 v34, v40, v41
  v_add_f32 v34, v34, v42
  v_add_f32 v34, v34, v43
  v_cndmask_b32 v34, 0, v34, s[62:63]
  v_add_f32 v34, v34, v36
  v_add_f32 v34, v34, v37
  v_add_f32 v34, v34, v38
  v_add_f32 v34, v34, v39
  v_mov_b32 v35, v34
  s_nop 1
  v_permlane32_swap_b32 v34, v35
  v_add_f32 v34, v34, v35
  v_mov_b32 v35, v34
  s_nop 1
  v_permlane16_swap_b32 v34, v35
  v_add_f32 v34, v34, v35
  v_rcp_f32 v34, v34
  s_nop 0
  v_mul_f32 v36, v36, v34
  v_mul_f32 v37, v37, v34
  v_mul_f32 v38, v38, v34
  v_mul_f32 v39, v39, v34
  v_mul_f32 v40, v40, v34
  v_mul_f32 v41, v41, v34
  v_mul_f32 v42, v42, v34
  v_mul_f32 v43, v43, v34
  v_max3_f32 v34, v44, v45, v46
  v_max3_f32 v34, v34, v47, v48
  v_max3_f32 v34, v34, v49, v50
  v_max3_f32 v34, v34, v51, v52
  v_max3_f32 v34, v34, v53, v54
  v_max_f32 v34, v34, v55
  v_mov_b32 v35, v34
  s_nop 1
  v_permlane32_swap_b32 v34, v35
  v_max_f32 v34, v34, v35
  v_mov_b32 v35, v34
  s_nop 1
  v_permlane16_swap_b32 v34, v35
  v_max_f32 v34, v34, v35
  v_mul_f32 v34, s83, v34
  v_fma_f32 v44, v44, s83, -v34
  v_fma_f32 v45, v45, s83, -v34
  v_fma_f32 v46, v46, s83, -v34
  v_fma_f32 v47, v47, s83, -v34
  v_fma_f32 v48, v48, s83, -v34
  v_fma_f32 v49, v49, s83, -v34
  v_fma_f32 v50, v50, s83, -v34
  v_fma_f32 v51, v51, s83, -v34
  v_fma_f32 v52, v52, s83, -v34
  v_fma_f32 v53, v53, s83, -v34
  v_fma_f32 v54, v54, s83, -v34
  v_fma_f32 v55, v55, s83, -v34
  v_exp_f32 v44, v44
  v_exp_f32 v45, v45
  v_exp_f32 v46, v46
  v_exp_f32 v47, v47
  v_exp_f32 v48, v48
  v_exp_f32 v49, v49
  v_exp_f32 v50, v50
  v_exp_f32 v51, v51
  v_exp_f32 v52, v52
  v_exp_f32 v53, v53
  v_exp_f32 v54, v54
  v_exp_f32 v55, v55
  s_nop 0
  v_add_f32 v34, v52, v53
  v_add_f32 v34, v34, v54
  v_add_f32 v34, v34, v55
  v_cndmask_b32 v34, 0, v34, s[62:63]
  v_add_f32 v34, v34, v44
  v_add_f32 v34, v34, v45
  v_add_f32 v34, v34, v46
  v_add_f32 v34, v34, v47
  v_add_f32 v34, v34, v48
  v_add_f32 v34, v34, v49
  v_add_f32 v34, v34, v50
  v_add_f32 v34, v34, v51
  v_mov_b32 v35, v34
  s_nop 1
  v_permlane32_swap_b32 v34, v35
  v_add_f32 v34, v34, v35
  v_mov_b32 v35, v34
  s_nop 1
  v_permlane16_swap_b32 v34, v35
  v_add_f32 v34, v34, v35
  v_rcp_f32 v34, v34
  s_nop 0
  v_mul_f32 v44, v44, v34
  v_mul_f32 v45, v45, v34
  v_mul_f32 v46, v46, v34
  v_mul_f32 v47, v47, v34
  v_mul_f32 v48, v48, v34
  v_mul_f32 v49, v49, v34
  v_mul_f32 v50, v50, v34
  v_mul_f32 v51, v51, v34
  v_mul_f32 v52, v52, v34
  v_mul_f32 v53, v53, v34
  v_mul_f32 v54, v54, v34
  v_mul_f32 v55, v55, v34
  v_cvt_pk_bf16_f32 v56, v44, v45
  v_cvt_pk_bf16_f32 v57, v46, v47
  v_cvt_pk_bf16_f32 v58, v48, v49
  v_cvt_pk_bf16_f32 v59, v50, v51
  v_cvt_pk_bf16_f32 v60, v40, v41
  v_cvt_pk_bf16_f32 v61, v42, v43
  v_cvt_pk_bf16_f32 v62, v52, v53
  v_cvt_pk_bf16_f32 v63, v54, v55
  v_cvt_pk_bf16_f32 v248, v36, v37
  v_cvt_pk_bf16_f32 v249, v38, v39
  buffer_store_dwordx4 v[56:59], v26, s[16:19], s81 offen sc1
  buffer_store_dwordx4 v[60:63], v26, s[16:19], s81 offen offset:1024 sc1
  buffer_store_dwordx2 v[248:249], v29, s[16:19], s81 offen offset:2048 sc1
  s_mov_b32 s84, s82
qf_275:
  s_cmp_eq_u32 s91, 0
  s_cbranch_scc1 qf_276
  s_sub_u32 s91, s91, 1
  s_mul_i32 s21, s20, 12288
  s_add_u32 s21, s21, s86
  s_add_u32 s86, s86, 49152
  buffer_load_dwordx4 v[64:67], v26, s[56:59], s21 offen offset:0 sc1
  buffer_load_dwordx4 v[68:71], v26, s[56:59], s21 offen offset:1024 sc1
  buffer_load_dwordx4 v[96:99], v26, s[56:59], s21 offen offset:2048 sc1
  s_add_u32 s21, s21, 3072
  buffer_load_dwordx4 v[72:75], v26, s[56:59], s21 offen offset:0 sc1
  buffer_load_dwordx4 v[76:79], v26, s[56:59], s21 offen offset:1024 sc1
  buffer_load_dwordx4 v[100:103], v26, s[56:59], s21 offen offset:2048 sc1
  s_add_u32 s21, s21, 3072
  buffer_load_dwordx4 v[80:83], v26, s[56:59], s21 offen offset:0 sc1
  buffer_load_dwordx4 v[84:87], v26, s[56:59], s21 offen offset:1024 sc1
  buffer_load_dwordx4 v[104:107], v26, s[56:59], s21 offen offset:2048 sc1
  s_add_u32 s21, s21, 3072
  buffer_load_dwordx4 v[88:91], v26, s[56:59], s21 offen offset:0 sc1
  buffer_load_dwordx4 v[92:95], v26, s[56:59], s21 offen offset:1024 sc1
  buffer_load_dwordx4 v[108:111], v26, s[56:59], s21 offen offset:2048 sc1
  s_add_u32 s21, s21, 3072
  s_mov_b32 s49, s43
  s_mov_b32 s50, s45
  s_mov_b32 s81, s47
  s_mov_b32 s82, s48
  s_add_u32 s43, s43, 4
  s_add_u32 s45, s45, 8388608
  s_add_u32 s47, s47, 2097152
  s_xor_b32 s47, s47, 8192
  s_add_u32 s48, s48, 512
  s_cmp_gt_u32 s49, 60
  s_cselect_b32 s23, 58, s49
  v_cmp_gt_u32 vcc, s23, v32
  s_nop 1
  s_cbranch_vccz qk_293
  s_waitcnt vmcnt(0)
  buffer_atomic_add v28, v33, s[72:75], s84 offen sc1
  s_mov_b32 s84, 1073741824
  s_mov_b32 s101, 0
wm_297:
  buffer_load_dword v32, v30, s[72:75], s77 offen sc1
  s_add_u32 s101, s101, 1
  s_cmp_gt_u32 s101, 131072
  s_cbranch_scc1 main_end
  s_waitcnt vmcnt(0)
  v_cmp_gt_u32 vcc, s23, v32
  v_readfirstlane_b32 s100, v32
  s_nop 0
  s_cbranch_vccz wm_298
  s_sleep 4
  s_add_u32 s100, s100, 2
  s_cmp_ge_u32 s100, s23
  s_cbranch_scc1 wm_297
  s_sleep 40
  s_branch wm_297
wm_298:
qk_293:
  s_add_u32 s29, s50, 0
  buffer_load_dwordx4 v[112:115], v26, s[16:19], s29 offen offset:0 sc1
  buffer_load_dwordx4 v[116:119], v26, s[16:19], s29 offen offset:1024 sc1
  buffer_load_dwordx4 v[144:147], v26, s[16:19], s29 offen offset:2048 sc1
  s_add_u32 s29, s50, 16384
  buffer_load_dwordx4 v[120:123], v26, s[16:19], s29 offen offset:0 sc1
  buffer_load_dwordx4 v[124:127], v26, s[16:19], s29 offen offset:1024 sc1
  buffer_load_dwordx4 v[148:151], v26, s[16:19], s29 offen offset:2048 sc1
  s_add_u32 s29, s50, 32768
  buffer_load_dwordx4 v[128:131], v26, s[16:19], s29 offen offset:0 sc1
  buffer_load_dwordx4 v[132:135], v26, s[16:19], s29 offen offset:1024 sc1
  buffer_load_dwordx4 v[152:155], v26, s[16:19], s29 offen offset:2048 sc1
  s_add_u32 s29, s50, 49152
  buffer_load_dwordx4 v[136:139], v26, s[16:19], s29 offen offset:0 sc1
  buffer_load_dwordx4 v[140:143], v26, s[16:19], s29 offen offset:1024 sc1
  buffer_load_dwordx4 v[156:159], v26, s[16:19], s29 offen offset:2048 sc1
  s_add_u32 s29, s50, 4096
  buffer_load_dwordx4 v[160:163], v24, s[16:19], s29 offen offset:2560 sc1
  buffer_load_dwordx2 v[240:241], v25, s[16:19], s29 offen offset:3072 sc1
  s_add_u32 s29, s50, 20480
  buffer_load_dwordx4 v[164:167], v24, s[16:19], s29 offen offset:2560 sc1
  buffer_load_dwordx2 v[242:243], v25, s[16:19], s29 offen offset:3072 sc1
  s_add_u32 s29, s50, 36864
  buffer_load_dwordx4 v[168:171], v24, s[16:19], s29 offen offset:2560 sc1
  buffer_load_dwordx2 v[244:245], v25, s[16:19], s29 offen offset:3072 sc1
  s_add_u32 s29, s50, 53248
  buffer_load_dwordx4 v[172:175], v24, s[16:19], s29 offen offset:2560 sc1
  buffer_load_dwordx2 v[246:247], v25, s[16:19], s29 offen offset:3072 sc1
  buffer_load_dword v32, v30, s[72:75], s77 offen sc1
  s_waitcnt vmcnt(9) lgkmcnt(0)
  buffer_atomic_add v28, v33, s[72:75], s84 offen sc1
  v_swap_b32 v98, v100
  v_swap_b32 v99, v101
  v_swap_b32 v106, v108
  v_swap_b32 v107, v109
  v_swap_b32 v146, v148
  v_swap_b32 v147, v149
  v_swap_b32 v154, v156
  v_swap_b32 v155, v157
  s_nop 1
  v_mfma_f32_16x16x32_bf16 v[36:39], v[112:115], v[64:67], 0
  v_mfma_f32_16x16x32_bf16 v[44:47], v[112:115], v[68:71], 0
  v_mfma_f32_16x16x32_bf16 v[48:51], v[116:119], v[68:71], 0
  v_mfma_f32_16x16x32_bf16 v[36:39], v[120:123], v[72:75], v[36:39]
  v_mfma_f32_16x16x32_bf16 v[44:47], v[120:123], v[76:79], v[44:47]
  v_mfma_f32_16x16x32_bf16 v[48:51], v[124:127], v[76:79], v[48:51]
  v_mfma_f32_16x16x32_bf16 v[36:39], v[144:147], v[96:99], v[36:39]
  v_mfma_f32_16x16x32_bf16 v[44:47], v[144:147], v[100:103], v[44:47]
  v_mfma_f32_16x16x32_bf16 v[48:51], v[148:151], v[100:103], v[48:51]
  v_mfma_f32_16x16x32_bf16 v[36:39], v[128:131], v[80:83], v[36:39]
  v_mfma_f32_16x16x32_bf16 v[44:47], v[128:131], v[84:87], v[44:47]
  v_mfma_f32_16x16x32_bf16 v[48:51], v[132:135], v[84:87], v[48:51]
  v_mfma_f32_16x16x32_bf16 v[36:39], v[136:139], v[88:91], v[36:39]
  v_mfma_f32_16x16x32_bf16 v[44:47], v[136:139], v[92:95], v[44:47]
  v_mfma_f32_16x16x32_bf16 v[48:51], v[140:143], v[92:95], v[48:51]
  v_mfma_f32_16x16x32_bf16 v[36:39], v[152:155], v[104:107], v[36:39]
  v_mfma_f32_16x16x32_bf16 v[44:47], v[152:155], v[108:111], v[44:47]
  v_mfma_f32_16x16x32_bf16 v[48:51], v[156:159], v[108:111], v[48:51]
  s_waitcnt vmcnt(1)
  v_max3_u32 v34, v160, v164, v168
  v_max3_u32 v34, v34, v172, v240
  v_max3_u32 v34, v34, v242, v244
  v_max_u32 v34, v34, v246
  v_cmp_eq_u32 vcc, -1, v34
  s_nop 1
  s_cbranch_vccz qtp_296
  s_sub_u32 s23, s49, 1
  s_min_u32 s23, s23, 62
  s_mov_b32 s101, 0
wm_299:
  buffer_load_dword v32, v30, s[72:75], s77 offen sc1
  s_add_u32 s101, s101, 1
  s_cmp_gt_u32 s101, 131072
  s_cbranch_scc1 main_end
  s_waitcnt vmcnt(0)
  v_cmp_gt_u32 vcc, s23, v32
  v_readfirstlane_b32 s100, v32
  s_nop 0
  s_cbranch_vccz wm_300
  s_sleep 4
  s_add_u32 s100, s100, 2
  s_cmp_ge_u32 s100, s23
  s_cbranch_scc1 wm_299
  s_sleep 40
  s_branch wm_299
wm_300:
  s_mov_b32 s101, 0
  s_branch qtp_295
qtp_294:
  s_sleep 2
qtp_295:
  s_add_u32 s29, s50, 4096
  buffer_load_dwordx4 v[160:163], v24, s[16:19], s29 offen offset:2560 sc1
  buffer_load_dwordx2 v[240:241], v25, s[16:19], s29 offen offset:3072 sc1
  s_add_u32 s29, s50, 20480
  buffer_load_dwordx4 v[164:167], v24, s[16:19], s29 offen offset:2560 sc1
  buffer_load_dwordx2 v[242:243], v25, s[16:19], s29 offen offset:3072 sc1
  s_add_u32 s29, s50, 36864
  buffer_load_dwordx4 v[168:171], v24, s[16:19], s29 offen offset:2560 sc1
  buffer_load_dwordx2 v[244:245], v25, s[16:19], s29 offen offset:3072 sc1
  s_add_u32 s29, s50, 53248
  buffer_load_dwordx4 v[172:175], v24, s[16:19], s29 offen offset:2560 sc1
  buffer_load_dwordx2 v[246:247], v25, s[16:19], s29 offen offset:3072 sc1
  s_add_u32 s101, s101, 1
  s_cmp_gt_u32 s101, 131072
  s_cbranch_scc1 main_end
  s_waitcnt vmcnt(0)
  v_max3_u32 v34, v160, v164, v168
  v_max3_u32 v34, v34, v172, v240
  v_max3_u32 v34, v34, v242, v244
  v_max_u32 v34, v34, v246
  v_cmp_eq_u32 vcc, -1, v34
  s_nop 1
  s_cbranch_vccnz qtp_294
qtp_296:
  v_mfma_f32_16x16x32_bf16 v[40:43], v[160:163], v[64:67], 0
  v_mfma_f32_16x16x32_bf16 v[52:55], v[160:163], v[68:71], 0
  v_mfma_f32_16x16x32_bf16 v[40:43], v[164:167], v[72:75], v[40:43]
  v_mfma_f32_16x16x32_bf16 v[52:55], v[164:167], v[76:79], v[52:55]
  v_mfma_f32_16x16x32_bf16 v[40:43], v[240:243], v[96:99], v[40:43]
  v_mfma_f32_16x16x32_bf16 v[52:55], v[240:243], v[100:103], v[52:55]
  v_mfma_f32_16x16x32_bf16 v[40:43], v[168:171], v[80:83], v[40:43]
  v_mfma_f32_16x16x32_bf16 v[52:55], v[168:171], v[84:87], v[52:55]
  v_mfma_f32_16x16x32_bf16 v[40:43], v[172:175], v[88:91], v[40:43]
  v_mfma_f32_16x16x32_bf16 v[52:55], v[172:175], v[92:95], v[52:55]
  v_mfma_f32_16x16x32_bf16 v[40:43], v[244:247], v[104:107], v[40:43]
  v_mfma_f32_16x16x32_bf16 v[52:55], v[244:247], v[108:111], v[52:55]
  s_nop 4
  v_cndmask_b32 v36, v31, v36, s[64:65]
  v_cndmask_b32 v48, v31, v48, s[64:65]
  v_cndmask_b32 v37, v31, v37, s[66:67]
  v_cndmask_b32 v49, v31, v49, s[66:67]
  v_cndmask_b32 v38, v31, v38, s[68:69]
  v_cndmask_b32 v50, v31, v50, s[68:69]
  v_cndmask_b32 v39, v31, v39, s[70:71]
  v_cndmask_b32 v51, v31, v51, s[70:71]
  v_max3_f32 v34, v36, v37, v38
  v_max3_f32 v34, v34, v39, v40
  v_max3_f32 v34, v34, v41, v42
  v_max_f32 v34, v34, v43
  v_mov_b32 v35, v34
  s_nop 1
  v_permlane32_swap_b32 v34, v35
  v_max_f32 v34, v34, v35
  v_mov_b32 v35, v34
  s_nop 1
  v_permlane16_swap_b32 v34, v35
  v_max_f32 v34, v34, v35
  v_mul_f32 v34, s83, v34
  v_fma_f32 v36, v36, s83, -v34
  v_fma_f32 v37, v37, s83, -v34
  v_fma_f32 v38, v38, s83, -v34
  v_fma_f32 v39, v39, s83, -v34
  v_fma_f32 v40, v40, s83, -v34
  v_fma_f32 v41, v41, s83, -v34
  v_fma_f32 v42, v42, s83, -v34
  v_fma_f32 v43, v43, s83, -v34
  v_exp_f32 v36, v36
  v_exp_f32 v37, v37
  v_exp_f32 v38, v38
  v_exp_f32 v39, v39
  v_exp_f32 v40, v40
  v_exp_f32 v41, v41
  v_exp_f32 v42, v42
  v_exp_f32 v43, v43
  s_nop 0
  v_add_f32 v34, v40, v41
  v_add_f32 v34, v34, v42
  v_add_f32 v34, v34, v43
  v_cndmask_b32 v34, 0, v34, s[62:63]
  v_add_f32 v34, v34, v36
  v_add_f32 v34, v34, v37
  v_add_f32 v34, v34, v38
  v_add_f32 v34, v34, v39
  v_mov_b32 v35, v34
  s_nop 1
  v_permlane32_swap_b32 v34, v35
  v_add_f32 v34, v34, v35
  v_mov_b32 v35, v34
  s_nop 1
  v_permlane16_swap_b32 v34, v35
  v_add_f32 v34, v34, v35
  v_rcp_f32 v34, v34
  s_nop 0
  v_mul_f32 v36, v36, v34
  v_mul_f32 v37, v37, v34
  v_mul_f32 v38, v38, v34
  v_mul_f32 v39, v39, v34
  v_mul_f32 v40, v40, v34
  v_mul_f32 v41, v41, v34
  v_mul_f32 v42, v42, v34
  v_mul_f32 v43, v43, v34
  v_max3_f32 v34, v44, v45, v46
  v_max3_f32 v34, v34, v47, v48
  v_max3_f32 v34, v34, v49, v50
  v_max3_f32 v34, v34, v51, v52
  v_max3_f32 v34, v34, v53, v54
  v_max_f32 v34, v34, v55
  v_mov_b32 v35, v34
  s_nop 1
  v_permlane32_swap_b32 v34, v35
  v_max_f32 v34, v34, v35
  v_mov_b32 v35, v34
  s_nop 1
  v_permlane16_swap_b32 v34, v35
  v_max_f32 v34, v34, v35
  v_mul_f32 v34, s83, v34
  v_fma_f32 v44, v44, s83, -v34
  v_fma_f32 v45, v45, s83, -v34
  v_fma_f32 v46, v46, s83, -v34
  v_fma_f32 v47, v47, s83, -v34
  v_fma_f32 v48, v48, s83, -v34
  v_fma_f32 v49, v49, s83, -v34
  v_fma_f32 v50, v50, s83, -v34
  v_fma_f32 v51, v51, s83, -v34
  v_fma_f32 v52, v52, s83, -v34
  v_fma_f32 v53, v53, s83, -v34
  v_fma_f32 v54, v54, s83, -v34
  v_fma_f32 v55, v55, s83, -v34
  v_exp_f32 v44, v44
  v_exp_f32 v45, v45
  v_exp_f32 v46, v46
  v_exp_f32 v47, v47
  v_exp_f32 v48, v48
  v_exp_f32 v49, v49
  v_exp_f32 v50, v50
  v_exp_f32 v51, v51
  v_exp_f32 v52, v52
  v_exp_f32 v53, v53
  v_exp_f32 v54, v54
  v_exp_f32 v55, v55
  s_nop 0
  v_add_f32 v34, v52, v53
  v_add_f32 v34, v34, v54
  v_add_f32 v34, v34, v55
  v_cndmask_b32 v34, 0, v34, s[62:63]
  v_add_f32 v34, v34, v44
  v_add_f32 v34, v34, v45
  v_add_f32 v34, v34, v46
  v_add_f32 v34, v34, v47
  v_add_f32 v34, v34, v48
  v_add_f32 v34, v34, v49
  v_add_f32 v34, v34, v50
  v_add_f32 v34, v34, v51
  v_mov_b32 v35, v34
  s_nop 1
  v_permlane32_swap_b32 v34, v35
  v_add_f32 v34, v34, v35
  v_mov_b32 v35, v34
  s_nop 1
  v_permlane16_swap_b32 v34, v35
  v_add_f32 v34, v34, v35
  v_rcp_f32 v34, v34
  s_nop 0
  v_mul_f32 v44, v44, v34
  v_mul_f32 v45, v45, v34
  v_mul_f32 v46, v46, v34
  v_mul_f32 v47, v47, v34
  v_mul_f32 v48, v48, v34
  v_mul_f32 v49, v49, v34
  v_mul_f32 v50, v50, v34
  v_mul_f32 v51, v51, v34
  v_mul_f32 v52, v52, v34
  v_mul_f32 v53, v53, v34
  v_mul_f32 v54, v54, v34
  v_mul_f32 v55, v55, v34
  v_cvt_pk_bf16_f32 v56, v44, v45
  v_cvt_pk_bf16_f32 v57, v46, v47
  v_cvt_pk_bf16_f32 v58, v48, v49
  v_cvt_pk_bf16_f32 v59, v50, v51
  v_cvt_pk_bf16_f32 v60, v40, v41
  v_cvt_pk_bf16_f32 v61, v42, v43
  v_cvt_pk_bf16_f32 v62, v52, v53
  v_cvt_pk_bf16_f32 v63, v54, v55
  v_cvt_pk_bf16_f32 v248, v36, v37
  v_cvt_pk_bf16_f32 v249, v38, v39
  buffer_store_dwordx4 v[56:59], v26, s[16:19], s81 offen sc1
  buffer_store_dwordx4 v[60:63], v26, s[16:19], s81 offen offset:1024 sc1
  buffer_store_dwordx2 v[248:249], v29, s[16:19], s81 offen offset:2048 sc1
  s_mov_b32 s84, s82
  s_branch qf_275
qf_276:
  s_waitcnt vmcnt(0)
  buffer_atomic_add v28, v33, s[72:75], s82 offen sc1
  s_branch qe_301
qw_272:
  s_mov_b32 s101, 0
wm_302:
  buffer_load_dword v32, v30, s[72:75], s77 offen sc1
  s_add_u32 s101, s101, 1
  s_cmp_gt_u32 s101, 131072
  s_cbranch_scc1 main_end
  s_waitcnt vmcnt(0)
  v_cmp_gt_u32 vcc, s49, v32
  v_readfirstlane_b32 s100, v32
  s_nop 0
  s_cbranch_vccz wm_303
  s_sleep 4
  s_add_u32 s100, s100, 2
  s_cmp_ge_u32 s100, s49
  s_cbranch_scc1 wm_302
  s_sleep 60
  s_branch wm_302
wm_303:
  s_branch qj_273
qa2_267:
  s_mov_b32 s49, 0
  s_mov_b32 s50, 1073741824
  s_mov_b32 s81, 1073741824
  s_mov_b32 s82, 1073741824
  s_branch qa3_268
qs_269:
  s_mul_i32 s21, s20, 3072
  s_add_u32 s21, s21, s86
  buffer_store_dwordx4 v[192:195], v26, s[56:59], s21 offen offset:0 sc1
  buffer_store_dwordx4 v[196:199], v26, s[56:59], s21 offen offset:1024 sc1
  buffer_store_dwordx4 v[200:203], v26, s[56:59], s21 offen offset:2048 sc1
  s_add_u32 s21, s21, 12288
  buffer_store_dwordx4 v[204:207], v26, s[56:59], s21 offen offset:0 sc1
  buffer_store_dwordx4 v[208:211], v26, s[56:59], s21 offen offset:1024 sc1
  buffer_store_dwordx4 v[212:215], v26, s[56:59], s21 offen offset:2048 sc1
  s_add_u32 s21, s21, 12288
  buffer_store_dwordx4 v[216:219], v26, s[56:59], s21 offen offset:0 sc1
  buffer_store_dwordx4 v[220:223], v26, s[56:59], s21 offen offset:1024 sc1
  buffer_store_dwordx4 v[224:227], v26, s[56:59], s21 offen offset:2048 sc1
  s_add_u32 s21, s21, 12288
  buffer_store_dwordx4 v[228:231], v26, s[56:59], s21 offen offset:0 sc1
  buffer_store_dwordx4 v[232:235], v26, s[56:59], s21 offen offset:1024 sc1
  buffer_store_dwordx4 v[236:239], v26, s[56:59], s21 offen offset:2048 sc1
  s_add_u32 s21, s21, 12288
  s_add_u32 s86, s86, 49152
  s_branch qs_270
qe_301:
queue:
  s_mov_b32 s87, 16
  s_mov_b32 s88, 0
queue2:
  s_load_dwordx2 s[4:5], s[0:1], 88
  s_load_dwordx2 s[38:39], s[0:1], 104
  s_lshr_b32 s58, s3, 4
  s_bfe_u32 s21, s3, 0x20003
  s_cmp_lt_u32 s3, 64
  s_cselect_b32 s58, s58, s21
  s_cselect_b32 s21, 1, 0
  s_lshr_b32 s41, s3, s21
  s_and_b32 s41, s41, 7
  s_lshl_b32 s59, s58, 3
  s_add_u32 s59, s59, s41
  s_lshl_b32 s59, s59, 7
  s_add_u32 s59, s59, 40960
  s_xor_b32 s59, s59, s80
  s_waitcnt vmcnt(0) lgkmcnt(0)
  s_barrier
  s_mov_b32 s8, s4
  s_mov_b32 s9, s5
  s_mov_b32 s10, 2621440
  s_mov_b32 s11, 0x00020000
  s_add_u32 s12, s38, 180355072
  s_addc_u32 s13, s39, 0
  s_mov_b32 s14, 4194304
  s_mov_b32 s15, 0x00020000
  s_mov_b32 s16, s38
  s_mov_b32 s17, s39
  s_mov_b32 s18, 218103808
  s_mov_b32 s19, 0x00020000
  s_add_u32 s28, s38, 175112192
  s_addc_u32 s29, s39, 0
  s_mov_b32 s30, 8192
  s_mov_b32 s31, 0x00020000
  s_add_u32 s72, s38, 173080576
  s_addc_u32 s73, s39, 0
  s_mov_b32 s74, 49152
  s_mov_b32 s75, 0x00020000
  v_mov_b32 v30, 102400
  v_mov_b32 v233, 0x40000000
  v_cmp_eq_u32 vcc, 0, v0
  v_and_b32 v7, 7, v1
  v_lshlrev_b32 v7, 7, v7
  v_cndmask_b32 v233, v233, 0, vcc
  v_mov_b32 v29, 1
  buffer_atomic_add v29, v233, s[72:75], s59 offen sc0 sc1
  v_bfe_u32 v31, v1, 3, 2
  v_lshl_add_u32 v31, v31, 2, v7
  s_lshl_b32 s51, s20, 10
  s_add_u32 s51, s51, 4096
  s_xor_b32 s51, s51, s80
  buffer_load_dword v8, v31, s[72:75], s51 offen sc1
  v_and_b32 v25, 3, v1
  v_lshlrev_b32 v25, 7, v25
  s_xor_b32 s56, s80, 29696
  buffer_load_dword v26, v25, s[72:75], s56 offen sc1
  v_lshlrev_b32 v4, 4, v1
  v_lshlrev_b32 v5, 3, v1
  v_lshlrev_b32 v6, 2, v2
  v_mul_u32_u24 v9, 1280, v2
  v_lshl_add_u32 v13, v3, 3, v9
  v_lshl_add_u32 v9, v3, 4, v9
  s_mul_i32 s21, s20, 10240
  v_add_u32 v10, s21, v4
  s_and_b32 s43, s20, 1
  s_lshr_b32 s44, s20, 1
  s_mul_i32 s21, s44, 6
  s_add_u32 s21, s21, s43
  s_lshl_b32 s21, s21, 10
  v_add_u32 v11, s21, v4
  s_add_u32 s21, s43, 4
  s_lshl_b32 s21, s21, 10
  v_add_u32 v12, s21, v4
  v_lshrrev_b32 v20, 5, v1
  v_mul_u32_u24 v21, 2560, v20
  v_add_u32 v21, v21, v4
  v_and_b32 v22, 31, v1
  v_lshlrev_b32 v22, 4, v22
  v_mul_u32_u24 v14, 640, v20
  v_add_u32 v22, v22, v14
  v_add_u32 v28, 16384, v22
  v_and_b32 v15, 1, v3
  v_lshl_add_u32 v14, v15, 6, v14
  v_lshrrev_b32 v16, 3, v2
  v_mul_u32_u24 v16, 16320, v16
  v_lshl_add_u32 v16, v2, 3, v16
  v_add_u32 v14, v14, v16
  v_add_u32 v15, 40960, v11
  v_lshlrev_b32 v17, 2, v7
  v_bfe_u32 v16, v1, 3, 1
  v_lshl_add_u32 v17, v16, 3, v17
  v_add_u32 v16, 40960, v12
  v_cmp_gt_u32 s[66:67], 16, v1
  s_lshr_b32 s52, s41, 1
  s_lshl_b32 s52, s52, 7
  s_and_b32 s21, s41, 1
  s_lshl_b32 s21, s21, 4
  s_add_u32 s52, s52, s21
  s_add_u32 s52, s52, 0
  s_xor_b32 s52, s52, s80
  v_add_u32 v17, s52, v17
  s_lshl_b32 s21, s20, 17
  s_lshl_b32 s22, s41, 10
  s_add_u32 s42, s21, s22
  s_lshl_b32 s53, s20, 19
  s_lshl_b32 s60, s41, 15
  s_add_u32 s60, s60, s53
  s_add_u32 s60, s60, 4096
  s_lshr_b32 s22, s41, 1
  s_lshl_b32 s22, s22, 14
  s_add_u32 s53, s53, s22
  s_and_b32 s22, s41, 1
  s_lshl_b32 s22, s22, 12
  s_add_u32 s53, s53, s22
  v_mov_b32 v70, 0
  v_mov_b32 v71, 0
  v_mov_b32 v78, 0
  v_mov_b32 v79, 0
  v_mov_b32 v86, 0
  v_mov_b32 v87, 0
  v_mov_b32 v94, 0
  v_mov_b32 v95, 0
  v_mov_b32 v102, 0
  v_mov_b32 v103, 0
  v_mov_b32 v110, 0
  v_mov_b32 v111, 0
  v_mov_b32 v118, 0
  v_mov_b32 v119, 0
  v_mov_b32 v126, 0
  v_mov_b32 v127, 0
  s_waitcnt vmcnt(0)
  s_cmp_lg_u32 s20, 0
  s_cbranch_scc1 pvq_305
  s_mov_b64 exec, 1
  ds_write_b32 v30, v29
  s_mov_b64 exec, -1
pvq_305:
  v_readlane_b32 s50, v8, 0
  v_readlane_b32 s21, v8, 1
  s_min_u32 s50, s50, s21
  v_readlane_b32 s21, v8, 2
  s_min_u32 s50, s50, s21
  v_readlane_b32 s21, v8, 3
  s_min_u32 s50, s50, s21
  v_readlane_b32 s21, v8, 4
  s_min_u32 s50, s50, s21
  v_readlane_b32 s21, v8, 5
  s_min_u32 s50, s50, s21
  v_readlane_b32 s21, v8, 6
  s_min_u32 s50, s50, s21
  v_readlane_b32 s21, v8, 7
  s_min_u32 s50, s50, s21
  v_readlane_b32 s21, v8, 8
  s_min_u32 s50, s50, s21
  v_readlane_b32 s21, v8, 9
  s_min_u32 s50, s50, s21
  v_readlane_b32 s21, v8, 10
  s_min_u32 s50, s50, s21
  v_readlane_b32 s21, v8, 11
  s_min_u32 s50, s50, s21
  v_readlane_b32 s21, v8, 12
  s_min_u32 s50, s50, s21
  v_readlane_b32 s21, v8, 13
  s_min_u32 s50, s50, s21
  v_readlane_b32 s21, v8, 14
  s_min_u32 s50, s50, s21
  v_readlane_b32 s21, v8, 15
  s_min_u32 s50, s50, s21
  v_readlane_b32 s21, v8, 16
  s_min_u32 s50, s50, s21
  v_readlane_b32 s21, v8, 17
  s_min_u32 s50, s50, s21
  v_readlane_b32 s21, v8, 18
  s_min_u32 s50, s50, s21
  v_readlane_b32 s21, v8, 19
  s_min_u32 s50, s50, s21
  v_readlane_b32 s21, v8, 20
  s_min_u32 s50, s50, s21
  v_readlane_b32 s21, v8, 21
  s_min_u32 s50, s50, s21
  v_readlane_b32 s21, v8, 22
  s_min_u32 s50, s50, s21
  v_readlane_b32 s21, v8, 23
  s_min_u32 s50, s50, s21
  v_readlane_b32 s21, v8, 24
  s_min_u32 s50, s50, s21
  v_readlane_b32 s21, v8, 25
  s_min_u32 s50, s50, s21
  v_readlane_b32 s21, v8, 26
  s_min_u32 s50, s50, s21
  v_readlane_b32 s21, v8, 27
  s_min_u32 s50, s50, s21
  v_readlane_b32 s21, v8, 28
  s_min_u32 s50, s50, s21
  v_readlane_b32 s21, v8, 29
  s_min_u32 s50, s50, s21
  v_readlane_b32 s21, v8, 30
  s_min_u32 s50, s50, s21
  v_readlane_b32 s21, v8, 31
  s_min_u32 s50, s50, s21
  v_cmp_gt_u32 vcc, 16, v26
  s_waitcnt lgkmcnt(0)
  s_barrier
  ds_read_b32 v23, v30
  s_cbranch_vccz pv_304
  s_mov_b32 s101, 0
wm_306:
  buffer_load_dword v26, v25, s[72:75], s56 offen sc1
  s_add_u32 s101, s101, 1
  s_cmp_gt_u32 s101, 131072
  s_cbranch_scc1 main_end
  s_waitcnt vmcnt(0)
  v_cmp_gt_u32 vcc, 16, v26
  v_readfirstlane_b32 s100, v26
  s_nop 0
  s_cbranch_vccz wm_307
  s_sleep 16
  s_branch wm_306
wm_307:
pv_304:
  s_mov_b32 s71, 0
pv_late:
  s_waitcnt lgkmcnt(0)
  v_readfirstlane_b32 s2, v23
  s_cmp_ge_u32 s2, 16
  s_cbranch_scc1 pv_done
  s_lshl_b32 s40, s2, 2
  s_add_u32 s40, s40, s58
  s_lshl_b32 s21, s40, 7
  s_add_u32 s21, s21, 8192
  s_xor_b32 s21, s21, s80
  v_mov_b32 v18, s21
  v_cndmask_b32 v18, v17, v18, s[66:67]
  s_add_u32 s21, s40, 1
  v_mov_b32 v19, s21
  v_cndmask_b32 v19, v19, 32, s[66:67]
  buffer_load_dword v27, v18, s[72:75], 0 offen sc1
  s_cmp_eq_u32 s71, 1
  s_cbranch_scc1 pv_308
  v_add_u32 v25, 4096, v4
  s_lshl_b32 s22, s41, 2
  s_add_u32 s22, s22, s20
  s_lshl_b32 s22, s22, 17
  s_lshr_b32 s21, s22, 8
  s_andn2_b32 s21, 8192, s21
  s_xor_b32 s21, s21, s80
  s_add_u32 s22, s22, s21
  buffer_load_dwordx4 a[160:163], v4, s[12:15], s22 offen offset:0 sc1
  buffer_load_dwordx4 a[164:167], v4, s[12:15], s22 offen offset:1024 sc1
  buffer_load_dwordx4 a[168:171], v4, s[12:15], s22 offen offset:2048 sc1
  buffer_load_dwordx4 a[172:175], v4, s[12:15], s22 offen offset:3072 sc1
  buffer_load_dwordx4 a[176:179], v25, s[12:15], s22 offen offset:0 sc1
  s_add_u32 s22, s22, 16384
  buffer_load_dwordx4 a[180:183], v4, s[12:15], s22 offen offset:0 sc1
  buffer_load_dwordx4 a[184:187], v4, s[12:15], s22 offen offset:1024 sc1
  buffer_load_dwordx4 a[188:191], v4, s[12:15], s22 offen offset:2048 sc1
  buffer_load_dwordx4 a[192:195], v4, s[12:15], s22 offen offset:3072 sc1
  buffer_load_dwordx4 a[196:199], v25, s[12:15], s22 offen offset:0 sc1
  s_add_u32 s22, s22, 16384
  buffer_load_dwordx4 a[200:203], v4, s[12:15], s22 offen offset:0 sc1
  buffer_load_dwordx4 a[204:207], v4, s[12:15], s22 offen offset:1024 sc1
  buffer_load_dwordx4 a[208:211], v4, s[12:15], s22 offen offset:2048 sc1
  buffer_load_dwordx4 a[212:215], v4, s[12:15], s22 offen offset:3072 sc1
  buffer_load_dwordx4 a[216:219], v25, s[12:15], s22 offen offset:0 sc1
  s_add_u32 s22, s22, 16384
  buffer_load_dwordx4 a[220:223], v4, s[12:15], s22 offen offset:0 sc1
  buffer_load_dwordx4 a[224:227], v4, s[12:15], s22 offen offset:1024 sc1
  buffer_load_dwordx4 a[228:231], v4, s[12:15], s22 offen offset:2048 sc1
  buffer_load_dwordx4 a[232:235], v4, s[12:15], s22 offen offset:3072 sc1
  buffer_load_dwordx4 a[236:239], v25, s[12:15], s22 offen offset:0 sc1
  s_add_u32 s22, s22, 16384
  buffer_load_dwordx4 a[240:243], v4, s[12:15], s22 offen offset:0 sc1
  buffer_load_dwordx4 a[244:247], v4, s[12:15], s22 offen offset:1024 sc1
  buffer_load_dwordx4 a[248:251], v4, s[12:15], s22 offen offset:2048 sc1
  buffer_load_dwordx4 a[252:255], v4, s[12:15], s22 offen offset:3072 sc1
  buffer_load_dwordx4 v[252:255], v25, s[12:15], s22 offen offset:0 sc1
  s_add_u32 s22, s22, 16384
pv_308:
  s_lshl_b32 s55, s40, 19
  s_lshl_b32 s21, s40, 11
  s_and_b32 s21, s21, 8192
  s_xor_b32 s21, s21, s80
  s_add_u32 s55, s55, s21
  s_add_u32 s55, s55, 136314880
  s_lshl_b32 s21, s20, 15
  s_xor_b32 s54, s55, 8192
  s_add_u32 s54, s54, 48234496
  s_add_u32 s54, s54, s21
  s_lshl_b32 s57, s40, 1
  s_add_u32 s57, s57, s43
  s_lshl_b32 s45, s57, 6
  s_add_u32 s69, s54, 262144
  s_cmp_lt_u32 s2, 16
  s_cselect_b32 s69, s69, 0x40000000
  s_cmp_lt_u32 s2, 12
  s_cselect_b32 s65, s87, 0
  s_cmp_gt_u32 s65, 1
  s_cselect_b32 s64, s59, 0x40000000
  s_cselect_b32 s65, 1, 0
  v_mov_b32 v29, 1
  buffer_atomic_add v29, v233, s[72:75], s64 offen sc0 sc1
  buffer_load_dword v232, v6, s[28:31], s45 offen sc1
  buffer_load_dwordx4 v[192:195], v4, s[16:19], s69 offen offset:0 sc1
  buffer_load_dwordx4 v[196:199], v4, s[16:19], s69 offen offset:1024 sc1
  buffer_load_dwordx2 v[208:209], v5, s[16:19], s69 offen offset:2048 sc1
  s_add_u32 s69, s69, 2560
  buffer_load_dwordx4 v[200:203], v4, s[16:19], s69 offen offset:0 sc1
  buffer_load_dwordx4 v[204:207], v4, s[16:19], s69 offen offset:1024 sc1
  buffer_load_dwordx2 v[210:211], v5, s[16:19], s69 offen offset:2048 sc1
  s_add_u32 s69, s69, 13824
  buffer_load_dwordx4 v[212:215], v4, s[16:19], s69 offen offset:0 sc1
  buffer_load_dwordx4 v[216:219], v4, s[16:19], s69 offen offset:1024 sc1
  buffer_load_dwordx2 v[228:229], v5, s[16:19], s69 offen offset:2048 sc1
  s_add_u32 s69, s69, 2560
  buffer_load_dwordx4 v[220:223], v4, s[16:19], s69 offen offset:0 sc1
  buffer_load_dwordx4 v[224:227], v4, s[16:19], s69 offen offset:1024 sc1
  buffer_load_dwordx2 v[230:231], v5, s[16:19], s69 offen offset:2048 sc1
  s_add_u32 s69, s69, 13824
  s_waitcnt vmcnt(14)
  s_add_u32 s23, s40, 1
  s_cmp_ge_u32 s50, s23
  s_cbranch_scc1 pv_309
  s_mov_b32 s101, 0
wm_312:
  buffer_load_dword v8, v31, s[72:75], s51 offen sc1
  s_add_u32 s101, s101, 1
  s_cmp_gt_u32 s101, 131072
  s_cbranch_scc1 main_end
  s_waitcnt vmcnt(0)
  v_cmp_gt_u32 vcc, s23, v8
  v_readfirstlane_b32 s100, v8
  s_nop 0
  s_cbranch_vccz wm_313
  s_sleep 8
  s_add_u32 s100, s100, 2
  s_cmp_ge_u32 s100, s23
  s_cbranch_scc1 wm_312
  s_sleep 60
  s_branch wm_312
wm_313:
  v_readlane_b32 s50, v8, 0
  v_readlane_b32 s21, v8, 1
  s_min_u32 s50, s50, s21
  v_readlane_b32 s21, v8, 2
  s_min_u32 s50, s50, s21
  v_readlane_b32 s21, v8, 3
  s_min_u32 s50, s50, s21
  v_readlane_b32 s21, v8, 4
  s_min_u32 s50, s50, s21
  v_readlane_b32 s21, v8, 5
  s_min_u32 s50, s50, s21
  v_readlane_b32 s21, v8, 6
  s_min_u32 s50, s50, s21
  v_readlane_b32 s21, v8, 7
  s_min_u32 s50, s50, s21
  v_readlane_b32 s21, v8, 8
  s_min_u32 s50, s50, s21
  v_readlane_b32 s21, v8, 9
  s_min_u32 s50, s50, s21
  v_readlane_b32 s21, v8, 10
  s_min_u32 s50, s50, s21
  v_readlane_b32 s21, v8, 11
  s_min_u32 s50, s50, s21
  v_readlane_b32 s21, v8, 12
  s_min_u32 s50, s50, s21
  v_readlane_b32 s21, v8, 13
  s_min_u32 s50, s50, s21
  v_readlane_b32 s21, v8, 14
  s_min_u32 s50, s50, s21
  v_readlane_b32 s21, v8, 15
  s_min_u32 s50, s50, s21
  v_readlane_b32 s21, v8, 16
  s_min_u32 s50, s50, s21
  v_readlane_b32 s21, v8, 17
  s_min_u32 s50, s50, s21
  v_readlane_b32 s21, v8, 18
  s_min_u32 s50, s50, s21
  v_readlane_b32 s21, v8, 19
  s_min_u32 s50, s50, s21
  v_readlane_b32 s21, v8, 20
  s_min_u32 s50, s50, s21
  v_readlane_b32 s21, v8, 21
  s_min_u32 s50, s50, s21
  v_readlane_b32 s21, v8, 22
  s_min_u32 s50, s50, s21
  v_readlane_b32 s21, v8, 23
  s_min_u32 s50, s50, s21
  v_readlane_b32 s21, v8, 24
  s_min_u32 s50, s50, s21
  v_readlane_b32 s21, v8, 25
  s_min_u32 s50, s50, s21
  v_readlane_b32 s21, v8, 26
  s_min_u32 s50, s50, s21
  v_readlane_b32 s21, v8, 27
  s_min_u32 s50, s50, s21
  v_readlane_b32 s21, v8, 28
  s_min_u32 s50, s50, s21
  v_readlane_b32 s21, v8, 29
  s_min_u32 s50, s50, s21
  v_readlane_b32 s21, v8, 30
  s_min_u32 s50, s50, s21
  v_readlane_b32 s21, v8, 31
  s_min_u32 s50, s50, s21
pv_309:
  v_cmp_gt_u32 vcc, v19, v27
  s_lshl_b32 s61, s40, 21
  s_lshl_b32 s21, s40, 13
  s_and_b32 s21, s21, 8192
  s_xor_b32 s21, s21, s80
  s_add_u32 s61, s61, s21
  s_lshl_b32 s21, s20, 15
  s_add_u32 s47, s54, s21
  s_add_u32 s48, s61, s60
  s_xor_b32 s68, s61, 8192
  s_add_u32 s68, s68, s53
  s_add_u32 s70, s55, s42
  s_xor_b32 s70, s70, 0
  s_mov_b32 s62, 0
  s_cbranch_vccnz pv_310
  s_mov_b32 s62, 1
  buffer_load_dwordx4 a[0:3], v4, s[16:19], s68 offen offset:0 sc1
  buffer_load_dwordx4 a[4:7], v4, s[16:19], s68 offen offset:1024 sc1
  buffer_load_dwordx4 v[32:35], v22, s[16:19], s48 offen offset:0 sc1
  buffer_load_dwordx4 a[8:11], v4, s[16:19], s70 offen sc1
  s_add_u32 s70, s70, 16384
  buffer_load_dwordx4 a[12:15], v4, s[16:19], s68 offen offset:2048 sc1
  buffer_load_dwordx4 a[16:19], v4, s[16:19], s68 offen offset:3072 sc1
  s_add_u32 s68, s68, 65536
  buffer_load_dwordx4 v[64:67], v4, s[16:19], s47 offen sc1
  buffer_load_dwordx2 v[68:69], v5, s[16:19], s47 offen offset:2048 sc1
  buffer_load_dwordx4 v[128:131], v21, s[16:19], s47 offen offset:1024 sc1
  s_add_u32 s47, s47, 2560
  buffer_load_dwordx4 a[20:23], v4, s[16:19], s68 offen offset:0 sc1
  buffer_load_dwordx4 a[24:27], v4, s[16:19], s68 offen offset:1024 sc1
  buffer_load_dwordx4 v[40:43], v28, s[16:19], s48 offen offset:0 sc1
  buffer_load_dwordx4 a[28:31], v4, s[16:19], s70 offen sc1
  s_add_u32 s70, s70, 16384
  buffer_load_dwordx4 a[32:35], v4, s[16:19], s68 offen offset:2048 sc1
  buffer_load_dwordx4 a[36:39], v4, s[16:19], s68 offen offset:3072 sc1
  s_add_u32 s68, s68, 65536
  buffer_load_dwordx2 v[184:185], v14, s[16:19], s48 offen offset:512 sc1
  buffer_load_dwordx4 v[72:75], v4, s[16:19], s47 offen sc1
  buffer_load_dwordx2 v[76:77], v5, s[16:19], s47 offen offset:2048 sc1
  s_add_u32 s47, s47, 13824
  buffer_load_dwordx4 a[40:43], v4, s[16:19], s68 offen offset:0 sc1
  buffer_load_dwordx4 a[44:47], v4, s[16:19], s68 offen offset:1024 sc1
  buffer_load_dwordx4 v[36:39], v22, s[16:19], s48 offen offset:1280 sc1
  buffer_load_dwordx4 a[48:51], v4, s[16:19], s70 offen sc1
  s_add_u32 s70, s70, 16384
  buffer_load_dwordx4 a[52:55], v4, s[16:19], s68 offen offset:2048 sc1
  buffer_load_dwordx4 a[56:59], v4, s[16:19], s68 offen offset:3072 sc1
  s_add_u32 s68, s68, 65536
  buffer_load_dwordx4 v[80:83], v4, s[16:19], s47 offen sc1
  buffer_load_dwordx2 v[84:85], v5, s[16:19], s47 offen offset:2048 sc1
  buffer_load_dwordx4 v[132:135], v21, s[16:19], s47 offen offset:1024 sc1
  s_add_u32 s47, s47, 2560
  buffer_load_dwordx4 a[60:63], v4, s[16:19], s68 offen offset:0 sc1
  buffer_load_dwordx4 a[64:67], v4, s[16:19], s68 offen offset:1024 sc1
  buffer_load_dwordx4 v[44:47], v28, s[16:19], s48 offen offset:1280 sc1
  buffer_load_dwordx4 a[68:71], v4, s[16:19], s70 offen sc1
  s_add_u32 s70, s70, 16384
  buffer_load_dwordx4 a[72:75], v4, s[16:19], s68 offen offset:2048 sc1
  buffer_load_dwordx4 a[76:79], v4, s[16:19], s68 offen offset:3072 sc1
  s_add_u32 s68, s68, 65536
  buffer_load_dwordx2 v[186:187], v14, s[16:19], s48 offen offset:1792 sc1
  s_add_u32 s48, s48, 262144
  buffer_load_dwordx4 v[88:91], v4, s[16:19], s47 offen sc1
  buffer_load_dwordx2 v[92:93], v5, s[16:19], s47 offen offset:2048 sc1
  s_add_u32 s47, s47, 13824
  s_branch pv_311
pv_310:
  buffer_load_dwordx4 a[0:3], v4, s[16:19], s68 offen offset:0 sc1
  buffer_load_dwordx4 a[4:7], v4, s[16:19], s68 offen offset:1024 sc1
  buffer_load_dwordx4 a[8:11], v4, s[16:19], s70 offen sc1
  s_add_u32 s70, s70, 16384
  buffer_load_dwordx4 a[12:15], v4, s[16:19], s68 offen offset:2048 sc1
  buffer_load_dwordx4 a[16:19], v4, s[16:19], s68 offen offset:3072 sc1
  s_add_u32 s68, s68, 65536
  buffer_load_dwordx4 a[20:23], v4, s[16:19], s68 offen offset:0 sc1
  buffer_load_dwordx4 a[24:27], v4, s[16:19], s68 offen offset:1024 sc1
  buffer_load_dwordx4 a[28:31], v4, s[16:19], s70 offen sc1
  s_add_u32 s70, s70, 16384
  buffer_load_dwordx4 a[32:35], v4, s[16:19], s68 offen offset:2048 sc1
  buffer_load_dwordx4 a[36:39], v4, s[16:19], s68 offen offset:3072 sc1
  s_add_u32 s68, s68, 65536
  buffer_load_dwordx4 a[40:43], v4, s[16:19], s68 offen offset:0 sc1
  buffer_load_dwordx4 a[44:47], v4, s[16:19], s68 offen offset:1024 sc1
  buffer_load_dwordx4 a[48:51], v4, s[16:19], s70 offen sc1
  s_add_u32 s70, s70, 16384
  buffer_load_dwordx4 a[52:55], v4, s[16:19], s68 offen offset:2048 sc1
  buffer_load_dwordx4 a[56:59], v4, s[16:19], s68 offen offset:3072 sc1
  s_add_u32 s68, s68, 65536
  buffer_load_dwordx4 a[60:63], v4, s[16:19], s68 offen offset:0 sc1
  buffer_load_dwordx4 a[64:67], v4, s[16:19], s68 offen offset:1024 sc1
  buffer_load_dwordx4 a[68:71], v4, s[16:19], s70 offen sc1
  s_add_u32 s70, s70, 16384
  buffer_load_dwordx4 a[72:75], v4, s[16:19], s68 offen offset:2048 sc1
  buffer_load_dwordx4 a[76:79], v4, s[16:19], s68 offen offset:3072 sc1
  s_add_u32 s68, s68, 65536
  buffer_load_dwordx4 a[80:83], v4, s[16:19], s68 offen offset:0 sc1
  buffer_load_dwordx4 a[84:87], v4, s[16:19], s68 offen offset:1024 sc1
  buffer_load_dwordx4 a[88:91], v4, s[16:19], s70 offen sc1
  s_add_u32 s70, s70, 16384
  buffer_load_dwordx4 a[92:95], v4, s[16:19], s68 offen offset:2048 sc1
  buffer_load_dwordx4 a[96:99], v4, s[16:19], s68 offen offset:3072 sc1
  s_add_u32 s68, s68, 65536
  buffer_load_dwordx4 a[100:103], v4, s[16:19], s68 offen offset:0 sc1
  buffer_load_dwordx4 a[104:107], v4, s[16:19], s68 offen offset:1024 sc1
  buffer_load_dwordx4 a[108:111], v4, s[16:19], s70 offen sc1
  s_add_u32 s70, s70, 16384
  buffer_load_dwordx4 a[112:115], v4, s[16:19], s68 offen offset:2048 sc1
  buffer_load_dwordx4 a[116:119], v4, s[16:19], s68 offen offset:3072 sc1
  s_add_u32 s68, s68, 65536
  buffer_load_dwordx4 a[120:123], v4, s[16:19], s68 offen offset:0 sc1
  buffer_load_dwordx4 a[124:127], v4, s[16:19], s68 offen offset:1024 sc1
  buffer_load_dwordx4 a[128:131], v4, s[16:19], s70 offen sc1
  s_add_u32 s70, s70, 16384
  buffer_load_dwordx4 a[132:135], v4, s[16:19], s68 offen offset:2048 sc1
  buffer_load_dwordx4 a[136:139], v4, s[16:19], s68 offen offset:3072 sc1
  s_add_u32 s68, s68, 65536
  buffer_load_dwordx4 a[140:143], v4, s[16:19], s68 offen offset:0 sc1
  buffer_load_dwordx4 a[144:147], v4, s[16:19], s68 offen offset:1024 sc1
  buffer_load_dwordx4 a[148:151], v4, s[16:19], s70 offen sc1
  s_add_u32 s70, s70, 16384
  buffer_load_dwordx4 a[152:155], v4, s[16:19], s68 offen offset:2048 sc1
  buffer_load_dwordx4 a[156:159], v4, s[16:19], s68 offen offset:3072 sc1
  s_add_u32 s68, s68, 65536
pv_311:
pv_first:
  s_waitcnt lgkmcnt(0)
  s_barrier
pv_loop:
  s_mov_b32 s63, s40
  s_mul_i32 s46, s57, 20480
  s_mul_i32 s22, s41, 160
  s_add_u32 s49, s46, s22
  s_mul_i32 s21, s44, 96
  s_add_u32 s46, s49, s21
  s_sub_u32 s87, s87, 1
  s_waitcnt vmcnt(36)
  v_mov_b32 v24, v232
  s_cmp_lg_u32 s20, 0
  s_cbranch_scc1 pvq_319
  s_mov_b64 exec, 1
  ds_write_b32 v30, v29
  s_mov_b64 exec, -1
pvq_319:
  s_cmp_eq_u32 s62, 0
  s_cbranch_scc1 pvw_314
  v_mfma_f32_16x16x32_bf16 v[144:147], a[160:163], v[192:195], 0
  v_mfma_f32_16x16x32_bf16 v[148:151], a[160:163], v[212:215], 0
  buffer_load_dwordx4 a[80:83], v4, s[16:19], s68 offen offset:0 sc1
  v_mfma_f32_16x16x32_bf16 v[152:155], a[164:167], v[192:195], 0
  v_mfma_f32_16x16x32_bf16 v[156:159], a[164:167], v[212:215], 0
  v_mfma_f32_16x16x32_bf16 v[160:163], a[168:171], v[192:195], 0
  buffer_load_dwordx4 a[84:87], v4, s[16:19], s68 offen offset:1024 sc1
  v_mfma_f32_16x16x32_bf16 v[164:167], a[168:171], v[212:215], 0
  v_mfma_f32_16x16x32_bf16 v[168:171], a[172:175], v[192:195], 0
  v_mfma_f32_16x16x32_bf16 v[172:175], a[172:175], v[212:215], 0
  buffer_load_dwordx4 v[48:51], v22, s[16:19], s48 offen offset:0 sc1
  v_mfma_f32_16x16x32_bf16 v[176:179], a[176:179], v[192:195], 0
  v_mfma_f32_16x16x32_bf16 v[180:183], a[176:179], v[212:215], 0
  buffer_load_dwordx4 a[88:91], v4, s[16:19], s70 offen sc1
  s_add_u32 s70, s70, 16384
  v_mfma_f32_16x16x32_bf16 v[144:147], a[180:183], v[196:199], v[144:147]
  v_mfma_f32_16x16x32_bf16 v[148:151], a[180:183], v[216:219], v[148:151]
  v_mfma_f32_16x16x32_bf16 v[152:155], a[184:187], v[196:199], v[152:155]
  buffer_load_dwordx4 a[92:95], v4, s[16:19], s68 offen offset:2048 sc1
  v_mfma_f32_16x16x32_bf16 v[156:159], a[184:187], v[216:219], v[156:159]
  v_mfma_f32_16x16x32_bf16 v[160:163], a[188:191], v[196:199], v[160:163]
  v_mfma_f32_16x16x32_bf16 v[164:167], a[188:191], v[216:219], v[164:167]
  buffer_load_dwordx4 a[96:99], v4, s[16:19], s68 offen offset:3072 sc1
  s_add_u32 s68, s68, 65536
  v_mfma_f32_16x16x32_bf16 v[168:171], a[192:195], v[196:199], v[168:171]
  v_mfma_f32_16x16x32_bf16 v[172:175], a[192:195], v[216:219], v[172:175]
  v_mfma_f32_16x16x32_bf16 v[176:179], a[196:199], v[196:199], v[176:179]
  buffer_load_dwordx4 v[96:99], v4, s[16:19], s47 offen sc1
  v_mfma_f32_16x16x32_bf16 v[180:183], a[196:199], v[216:219], v[180:183]
  v_mfma_f32_16x16x32_bf16 v[144:147], a[200:203], v[200:203], v[144:147]
  v_mfma_f32_16x16x32_bf16 v[148:151], a[200:203], v[220:223], v[148:151]
  buffer_load_dwordx2 v[100:101], v5, s[16:19], s47 offen offset:2048 sc1
  v_mfma_f32_16x16x32_bf16 v[152:155], a[204:207], v[200:203], v[152:155]
  v_mfma_f32_16x16x32_bf16 v[156:159], a[204:207], v[220:223], v[156:159]
  buffer_load_dwordx4 v[136:139], v21, s[16:19], s47 offen offset:1024 sc1
  s_add_u32 s47, s47, 2560
  v_mfma_f32_16x16x32_bf16 v[160:163], a[208:211], v[200:203], v[160:163]
  v_mfma_f32_16x16x32_bf16 v[164:167], a[208:211], v[220:223], v[164:167]
  v_mfma_f32_16x16x32_bf16 v[168:171], a[212:215], v[200:203], v[168:171]
  buffer_load_dwordx4 a[100:103], v4, s[16:19], s68 offen offset:0 sc1
  v_mfma_f32_16x16x32_bf16 v[172:175], a[212:215], v[220:223], v[172:175]
  v_mfma_f32_16x16x32_bf16 v[176:179], a[216:219], v[200:203], v[176:179]
  v_mfma_f32_16x16x32_bf16 v[180:183], a[216:219], v[220:223], v[180:183]
  buffer_load_dwordx4 a[104:107], v4, s[16:19], s68 offen offset:1024 sc1
  v_mfma_f32_16x16x32_bf16 v[144:147], a[220:223], v[204:207], v[144:147]
  v_mfma_f32_16x16x32_bf16 v[148:151], a[220:223], v[224:227], v[148:151]
  v_mfma_f32_16x16x32_bf16 v[152:155], a[224:227], v[204:207], v[152:155]
  buffer_load_dwordx4 v[56:59], v28, s[16:19], s48 offen offset:0 sc1
  v_mfma_f32_16x16x32_bf16 v[156:159], a[224:227], v[224:227], v[156:159]
  v_mfma_f32_16x16x32_bf16 v[160:163], a[228:231], v[204:207], v[160:163]
  v_mfma_f32_16x16x32_bf16 v[164:167], a[228:231], v[224:227], v[164:167]
  buffer_load_dwordx4 a[108:111], v4, s[16:19], s70 offen sc1
  s_add_u32 s70, s70, 16384
  v_mfma_f32_16x16x32_bf16 v[168:171], a[232:235], v[204:207], v[168:171]
  v_mfma_f32_16x16x32_bf16 v[172:175], a[232:235], v[224:227], v[172:175]
  buffer_load_dwordx4 a[112:115], v4, s[16:19], s68 offen offset:2048 sc1
  v_mfma_f32_16x16x32_bf16 v[176:179], a[236:239], v[204:207], v[176:179]
  v_mfma_f32_16x16x32_bf16 v[180:183], a[236:239], v[224:227], v[180:183]
  v_mfma_f32_16x16x32_bf16 v[144:147], a[240:243], v[208:211], v[144:147]
  buffer_load_dwordx4 a[116:119], v4, s[16:19], s68 offen offset:3072 sc1
  s_add_u32 s68, s68, 65536
  v_mfma_f32_16x16x32_bf16 v[148:151], a[240:243], v[228:231], v[148:151]
  v_mfma_f32_16x16x32_bf16 v[152:155], a[244:247], v[208:211], v[152:155]
  v_mfma_f32_16x16x32_bf16 v[156:159], a[244:247], v[228:231], v[156:159]
  buffer_load_dwordx2 v[188:189], v14, s[16:19], s48 offen offset:512 sc1
  v_mfma_f32_16x16x32_bf16 v[160:163], a[248:251], v[208:211], v[160:163]
  v_mfma_f32_16x16x32_bf16 v[164:167], a[248:251], v[228:231], v[164:167]
  v_mfma_f32_16x16x32_bf16 v[168:171], a[252:255], v[208:211], v[168:171]
  buffer_load_dwordx4 v[104:107], v4, s[16:19], s47 offen sc1
  v_mfma_f32_16x16x32_bf16 v[172:175], a[252:255], v[228:231], v[172:175]
  v_mfma_f32_16x16x32_bf16 v[176:179], v[252:255], v[208:211], v[176:179]
  v_mfma_f32_16x16x32_bf16 v[180:183], v[252:255], v[228:231], v[180:183]
  buffer_load_dwordx2 v[108:109], v5, s[16:19], s47 offen offset:2048 sc1
  s_add_u32 s47, s47, 13824
  ds_write_b128 v10, v[144:147] offset:40960
  buffer_load_dwordx4 a[120:123], v4, s[16:19], s68 offen offset:0 sc1
  ds_write_b128 v10, v[148:151] offset:41984
  buffer_load_dwordx4 a[124:127], v4, s[16:19], s68 offen offset:1024 sc1
  ds_write_b128 v10, v[152:155] offset:43008
  ds_write_b128 v10, v[156:159] offset:44032
  s_waitcnt vmcnt(40)
  buffer_load_dwordx4 v[52:55], v22, s[16:19], s48 offen offset:1280 sc1
  ds_write_b128 v10, v[160:163] offset:45056
  buffer_load_dwordx4 a[128:131], v4, s[16:19], s70 offen sc1
  s_add_u32 s70, s70, 16384
  ds_write_b128 v10, v[164:167] offset:46080
  buffer_load_dwordx4 a[132:135], v4, s[16:19], s68 offen offset:2048 sc1
  ds_write_b128 v10, v[168:171] offset:47104
  buffer_load_dwordx4 a[136:139], v4, s[16:19], s68 offen offset:3072 sc1
  s_add_u32 s68, s68, 65536
  ds_write_b128 v10, v[172:175] offset:48128
  buffer_load_dwordx4 v[112:115], v4, s[16:19], s47 offen sc1
  s_nop 1
  ds_write_b128 v10, v[176:179] offset:49152
  buffer_load_dwordx2 v[116:117], v5, s[16:19], s47 offen offset:2048 sc1
  ds_write_b128 v10, v[180:183] offset:50176
  buffer_load_dwordx4 v[140:143], v21, s[16:19], s47 offen offset:1024 sc1
  s_add_u32 s47, s47, 2560
  s_waitcnt lgkmcnt(0)
  s_barrier
  ds_read_b32 v23, v30
  s_waitcnt lgkmcnt(0)
  v_readfirstlane_b32 s2, v23
  s_min_u32 s2, s2, 16
  s_cmp_eq_u32 s65, 0
  s_cselect_b32 s2, 17, s2
  buffer_load_dwordx4 a[140:143], v4, s[16:19], s68 offen offset:0 sc1
  s_lshl_b32 s40, s2, 2
  s_add_u32 s40, s40, s58
  s_lshl_b32 s21, s40, 7
  s_add_u32 s21, s21, 8192
  s_xor_b32 s21, s21, s80
  v_mov_b32 v18, s21
  v_cndmask_b32 v18, v17, v18, s[66:67]
  s_add_u32 s21, s40, 1
  v_mov_b32 v19, s21
  v_cndmask_b32 v19, v19, 32, s[66:67]
  buffer_load_dword v27, v18, s[72:75], 0 offen sc1
  buffer_load_dwordx4 a[144:147], v4, s[16:19], s68 offen offset:1024 sc1
  v_sub_f32 v25, 1.0, v24
  v_cvt_pk_bf16_f32 v26, v25, v25
  v_lshlrev_b32 v25, 16, v26
  ds_read_b128 v[144:147], v15 offset:0
  ds_read_b128 v[148:151], v15 offset:10240
  ds_read_b128 v[152:155], v15 offset:20480
  ds_read_b128 v[156:159], v15 offset:30720
  ds_read_b128 v[160:163], v15 offset:2048
  ds_read_b128 v[164:167], v15 offset:12288
  ds_read_b128 v[168:171], v15 offset:22528
  ds_read_b128 v[172:175], v15 offset:32768
  s_waitcnt lgkmcnt(4)
  buffer_load_dwordx4 v[60:63], v28, s[16:19], s48 offen offset:1280 sc1
  v_pk_add_f32 v[144:145], v[144:145], v[148:149]
  v_pk_add_f32 v[152:153], v[152:153], v[156:157]
  v_pk_add_f32 v[146:147], v[146:147], v[150:151]
  v_pk_add_f32 v[154:155], v[154:155], v[158:159]
  v_pk_add_f32 v[176:177], v[144:145], v[152:153]
  v_pk_add_f32 v[178:179], v[146:147], v[154:155]
  ds_read_b128 v[144:147], v16 offset:0
  ds_read_b128 v[148:151], v16 offset:10240
  ds_read_b128 v[152:155], v16 offset:20480
  ds_read_b128 v[156:159], v16 offset:30720
  v_cvt_pk_bf16_f32 v26, v176, v177
  buffer_load_dwordx4 a[148:151], v4, s[16:19], s70 offen sc1
  s_add_u32 s70, s70, 16384
  v_lshlrev_b32 v240, 16, v26
  v_and_b32 v241, 0xffff0000, v26
  v_mul_f32 v240, v240, v25
  v_mul_f32 v241, v241, v25
  v_cvt_pk_bf16_f32 v26, v240, v241
  v_lshlrev_b32 v240, 16, v26
  v_and_b32 v241, 0xffff0000, v26
  v_cvt_pk_bf16_f32 v26, v178, v179
  v_lshlrev_b32 v242, 16, v26
  v_and_b32 v243, 0xffff0000, v26
  v_mul_f32 v242, v242, v25
  buffer_load_dwordx4 a[152:155], v4, s[16:19], s68 offen offset:2048 sc1
  v_mul_f32 v243, v243, v25
  v_cvt_pk_bf16_f32 v26, v242, v243
  v_lshlrev_b32 v242, 16, v26
  v_and_b32 v243, 0xffff0000, v26
  s_waitcnt lgkmcnt(4)
  v_pk_add_f32 v[160:161], v[160:161], v[164:165]
  v_pk_add_f32 v[168:169], v[168:169], v[172:173]
  v_pk_add_f32 v[162:163], v[162:163], v[166:167]
  v_pk_add_f32 v[170:171], v[170:171], v[174:175]
  v_pk_add_f32 v[176:177], v[160:161], v[168:169]
  v_pk_add_f32 v[178:179], v[162:163], v[170:171]
  buffer_load_dwordx4 a[156:159], v4, s[16:19], s68 offen offset:3072 sc1
  s_add_u32 s68, s68, 65536
  v_cvt_pk_bf16_f32 v26, v176, v177
  v_lshlrev_b32 v244, 16, v26
  v_and_b32 v245, 0xffff0000, v26
  v_mul_f32 v244, v244, v25
  v_mul_f32 v245, v245, v25
  v_cvt_pk_bf16_f32 v26, v244, v245
  v_lshlrev_b32 v244, 16, v26
  v_and_b32 v245, 0xffff0000, v26
  v_cvt_pk_bf16_f32 v26, v178, v179
  v_lshlrev_b32 v246, 16, v26
  v_and_b32 v247, 0xffff0000, v26
  buffer_load_dwordx2 v[190:191], v14, s[16:19], s48 offen offset:1792 sc1
  s_add_u32 s48, s48, 262144
  v_mul_f32 v246, v246, v25
  v_mul_f32 v247, v247, v25
  v_cvt_pk_bf16_f32 v26, v246, v247
  v_lshlrev_b32 v246, 16, v26
  v_and_b32 v247, 0xffff0000, v26
  s_waitcnt lgkmcnt(0)
  v_pk_add_f32 v[144:145], v[144:145], v[148:149]
  v_pk_add_f32 v[152:153], v[152:153], v[156:157]
  v_pk_add_f32 v[146:147], v[146:147], v[150:151]
  v_pk_add_f32 v[154:155], v[154:155], v[158:159]
  v_pk_add_f32 v[176:177], v[144:145], v[152:153]
  v_pk_add_f32 v[178:179], v[146:147], v[154:155]
  buffer_load_dwordx4 v[120:123], v4, s[16:19], s47 offen sc1
  v_cvt_pk_bf16_f32 v26, v176, v177
  v_lshlrev_b32 v248, 16, v26
  v_and_b32 v249, 0xffff0000, v26
  v_mul_f32 v248, v248, v25
  v_mul_f32 v249, v249, v25
  v_cvt_pk_bf16_f32 v26, v248, v249
  v_lshlrev_b32 v248, 16, v26
  v_and_b32 v249, 0xffff0000, v26
  v_cvt_pk_bf16_f32 v26, v178, v179
  v_lshlrev_b32 v250, 16, v26
  v_and_b32 v251, 0xffff0000, v26
  buffer_load_dwordx2 v[124:125], v5, s[16:19], s47 offen offset:2048 sc1
  s_add_u32 s47, s47, 13824
  v_mul_f32 v250, v250, v25
  v_mul_f32 v251, v251, v25
  v_cvt_pk_bf16_f32 v26, v250, v251
  v_lshlrev_b32 v250, 16, v26
  v_and_b32 v251, 0xffff0000, v26
  s_barrier
  s_lshl_b32 s55, s40, 19
  s_lshl_b32 s21, s40, 11
  s_and_b32 s21, s21, 8192
  s_xor_b32 s21, s21, s80
  s_add_u32 s55, s55, s21
  s_add_u32 s55, s55, 136314880
  s_lshl_b32 s21, s20, 15
  s_xor_b32 s54, s55, 8192
  s_add_u32 s54, s54, 48234496
  s_add_u32 s54, s54, s21
  s_lshl_b32 s57, s40, 1
  s_add_u32 s57, s57, s43
  s_lshl_b32 s45, s57, 6
  s_add_u32 s69, s54, 262144
  s_cmp_lt_u32 s2, 16
  s_cselect_b32 s69, s69, 0x40000000
  s_cmp_lt_u32 s2, 12
  s_cselect_b32 s65, s87, 0
  s_cmp_gt_u32 s65, 1
  s_cselect_b32 s64, s59, 0x40000000
  s_cselect_b32 s65, 1, 0
  s_waitcnt vmcnt(37)
  v_mfma_f32_16x16x32_bf16 v[148:151], a[0:3], v[64:67], 0
  v_mfma_f32_16x16x32_bf16 v[144:147], a[0:3], v[68:71], 0
  v_mov_b32 v29, 1
  buffer_atomic_add v29, v233, s[72:75], s64 offen sc0 sc1
  v_mfma_f32_16x16x32_bf16 v[156:159], a[4:7], v[64:67], 0
  v_mfma_f32_16x16x32_bf16 v[152:155], a[4:7], v[68:71], 0
  v_mfma_f32_16x16x32_bf16 v[164:167], a[8:11], v[64:67], 0
  v_mfma_f32_16x16x32_bf16 v[160:163], a[8:11], v[68:71], 0
  buffer_load_dword v232, v6, s[28:31], s45 offen sc1
  v_mfma_f32_16x16x32_bf16 v[172:175], a[12:15], v[64:67], 0
  v_mfma_f32_16x16x32_bf16 v[168:171], a[12:15], v[68:71], 0
  v_mfma_f32_16x16x32_bf16 v[180:183], a[16:19], v[64:67], 0
  v_mfma_f32_16x16x32_bf16 v[176:179], a[16:19], v[68:71], 0
  buffer_load_dwordx4 v[192:195], v4, s[16:19], s69 offen offset:0 sc1
  v_mfma_f32_16x16x32_bf16 v[148:151], a[20:23], v[72:75], v[148:151]
  v_mfma_f32_16x16x32_bf16 v[144:147], a[20:23], v[76:79], v[144:147]
  v_mfma_f32_16x16x32_bf16 v[156:159], a[24:27], v[72:75], v[156:159]
  v_mfma_f32_16x16x32_bf16 v[152:155], a[24:27], v[76:79], v[152:155]
  buffer_load_dwordx4 v[196:199], v4, s[16:19], s69 offen offset:1024 sc1
  v_mfma_f32_16x16x32_bf16 v[164:167], a[28:31], v[72:75], v[164:167]
  v_mfma_f32_16x16x32_bf16 v[160:163], a[28:31], v[76:79], v[160:163]
  v_mfma_f32_16x16x32_bf16 v[172:175], a[32:35], v[72:75], v[172:175]
  buffer_load_dwordx2 v[208:209], v5, s[16:19], s69 offen offset:2048 sc1
  s_add_u32 s69, s69, 2560
  v_mfma_f32_16x16x32_bf16 v[168:171], a[32:35], v[76:79], v[168:171]
  v_mfma_f32_16x16x32_bf16 v[180:183], a[36:39], v[72:75], v[180:183]
  v_mfma_f32_16x16x32_bf16 v[176:179], a[36:39], v[76:79], v[176:179]
  v_mfma_f32_16x16x32_bf16 v[148:151], a[40:43], v[80:83], v[148:151]
  buffer_load_dwordx4 v[200:203], v4, s[16:19], s69 offen offset:0 sc1
  v_mfma_f32_16x16x32_bf16 v[144:147], a[40:43], v[84:87], v[144:147]
  v_mfma_f32_16x16x32_bf16 v[156:159], a[44:47], v[80:83], v[156:159]
  v_mfma_f32_16x16x32_bf16 v[152:155], a[44:47], v[84:87], v[152:155]
  v_mfma_f32_16x16x32_bf16 v[164:167], a[48:51], v[80:83], v[164:167]
  buffer_load_dwordx4 v[204:207], v4, s[16:19], s69 offen offset:1024 sc1
  v_mfma_f32_16x16x32_bf16 v[160:163], a[48:51], v[84:87], v[160:163]
  v_mfma_f32_16x16x32_bf16 v[172:175], a[52:55], v[80:83], v[172:175]
  v_mfma_f32_16x16x32_bf16 v[168:171], a[52:55], v[84:87], v[168:171]
  buffer_load_dwordx2 v[210:211], v5, s[16:19], s69 offen offset:2048 sc1
  s_add_u32 s69, s69, 13824
  v_mfma_f32_16x16x32_bf16 v[180:183], a[56:59], v[80:83], v[180:183]
  v_mfma_f32_16x16x32_bf16 v[176:179], a[56:59], v[84:87], v[176:179]
  v_mfma_f32_16x16x32_bf16 v[148:151], a[60:63], v[88:91], v[148:151]
  v_mfma_f32_16x16x32_bf16 v[144:147], a[60:63], v[92:95], v[144:147]
  buffer_load_dwordx4 v[212:215], v4, s[16:19], s69 offen offset:0 sc1
  v_mfma_f32_16x16x32_bf16 v[156:159], a[64:67], v[88:91], v[156:159]
  v_mfma_f32_16x16x32_bf16 v[152:155], a[64:67], v[92:95], v[152:155]
  v_mfma_f32_16x16x32_bf16 v[164:167], a[68:71], v[88:91], v[164:167]
  v_mfma_f32_16x16x32_bf16 v[160:163], a[68:71], v[92:95], v[160:163]
  buffer_load_dwordx4 v[216:219], v4, s[16:19], s69 offen offset:1024 sc1
  v_mfma_f32_16x16x32_bf16 v[172:175], a[72:75], v[88:91], v[172:175]
  v_mfma_f32_16x16x32_bf16 v[168:171], a[72:75], v[92:95], v[168:171]
  v_mfma_f32_16x16x32_bf16 v[180:183], a[76:79], v[88:91], v[180:183]
  v_mfma_f32_16x16x32_bf16 v[176:179], a[76:79], v[92:95], v[176:179]
  buffer_load_dwordx2 v[228:229], v5, s[16:19], s69 offen offset:2048 sc1
  s_add_u32 s69, s69, 2560
  v_swap_b32 v130, v132
  v_swap_b32 v131, v133
  v_swap_b32 v34, v36
  v_swap_b32 v35, v37
  v_swap_b32 v42, v44
  v_swap_b32 v43, v45
  s_nop 1
  v_mfma_f32_16x16x32_bf16 v[144:147], v[32:35], v[128:131], v[144:147]
  v_mfma_f32_16x16x32_bf16 v[148:151], v[32:35], v[132:135], v[148:151]
  buffer_load_dwordx4 v[220:223], v4, s[16:19], s69 offen offset:0 sc1
  v_mfma_f32_16x16x32_bf16 v[152:155], v[36:39], v[128:131], v[152:155]
  v_mfma_f32_16x16x32_bf16 v[156:159], v[36:39], v[132:135], v[156:159]
  v_mfma_f32_16x16x32_bf16 v[160:163], v[184:187], v[128:131], v[160:163]
  buffer_load_dwordx4 v[224:227], v4, s[16:19], s69 offen offset:1024 sc1
  v_mfma_f32_16x16x32_bf16 v[164:167], v[184:187], v[132:135], v[164:167]
  v_mfma_f32_16x16x32_bf16 v[168:171], v[40:43], v[128:131], v[168:171]
  v_mfma_f32_16x16x32_bf16 v[172:175], v[40:43], v[132:135], v[172:175]
  v_mfma_f32_16x16x32_bf16 v[176:179], v[44:47], v[128:131], v[176:179]
  buffer_load_dwordx2 v[230:231], v5, s[16:19], s69 offen offset:2048 sc1
  s_add_u32 s69, s69, 13824
  v_mfma_f32_16x16x32_bf16 v[180:183], v[44:47], v[132:135], v[180:183]
  s_waitcnt vmcnt(22)
  v_cmp_gt_u32 vcc, v19, v27
  s_cmp_le_u32 s50, s40
  s_cbranch_scc1 pv_320
  s_cbranch_vccnz pv_320
  s_lshl_b32 s61, s40, 21
  s_lshl_b32 s21, s40, 13
  s_and_b32 s21, s21, 8192
  s_xor_b32 s21, s21, s80
  s_add_u32 s61, s61, s21
  s_lshl_b32 s21, s20, 15
  s_add_u32 s47, s54, s21
  s_add_u32 s48, s61, s60
  s_xor_b32 s68, s61, 8192
  s_add_u32 s68, s68, s53
  s_add_u32 s70, s55, s42
  s_xor_b32 s70, s70, 0
  s_waitcnt vmcnt(42)
  v_mfma_f32_16x16x32_bf16 v[148:151], a[80:83], v[96:99], v[148:151]
  v_mfma_f32_16x16x32_bf16 v[144:147], a[80:83], v[100:103], v[144:147]
  buffer_load_dwordx4 a[0:3], v4, s[16:19], s68 offen offset:0 sc1
  v_mfma_f32_16x16x32_bf16 v[156:159], a[84:87], v[96:99], v[156:159]
  v_mfma_f32_16x16x32_bf16 v[152:155], a[84:87], v[100:103], v[152:155]
  v_mfma_f32_16x16x32_bf16 v[164:167], a[88:91], v[96:99], v[164:167]
  buffer_load_dwordx4 a[4:7], v4, s[16:19], s68 offen offset:1024 sc1
  v_mfma_f32_16x16x32_bf16 v[160:163], a[88:91], v[100:103], v[160:163]
  v_mfma_f32_16x16x32_bf16 v[172:175], a[92:95], v[96:99], v[172:175]
  v_mfma_f32_16x16x32_bf16 v[168:171], a[92:95], v[100:103], v[168:171]
  buffer_load_dwordx4 v[32:35], v22, s[16:19], s48 offen offset:0 sc1
  v_mfma_f32_16x16x32_bf16 v[180:183], a[96:99], v[96:99], v[180:183]
  v_mfma_f32_16x16x32_bf16 v[176:179], a[96:99], v[100:103], v[176:179]
  s_waitcnt vmcnt(36)
  v_mfma_f32_16x16x32_bf16 v[148:151], a[100:103], v[104:107], v[148:151]
  buffer_load_dwordx4 a[8:11], v4, s[16:19], s70 offen sc1
  s_add_u32 s70, s70, 16384
  v_mfma_f32_16x16x32_bf16 v[144:147], a[100:103], v[108:111], v[144:147]
  v_mfma_f32_16x16x32_bf16 v[156:159], a[104:107], v[104:107], v[156:159]
  v_mfma_f32_16x16x32_bf16 v[152:155], a[104:107], v[108:111], v[152:155]
  buffer_load_dwordx4 a[12:15], v4, s[16:19], s68 offen offset:2048 sc1
  v_mfma_f32_16x16x32_bf16 v[164:167], a[108:111], v[104:107], v[164:167]
  v_mfma_f32_16x16x32_bf16 v[160:163], a[108:111], v[108:111], v[160:163]
  buffer_load_dwordx4 a[16:19], v4, s[16:19], s68 offen offset:3072 sc1
  s_add_u32 s68, s68, 65536
  v_mfma_f32_16x16x32_bf16 v[172:175], a[112:115], v[104:107], v[172:175]
  v_mfma_f32_16x16x32_bf16 v[168:171], a[112:115], v[108:111], v[168:171]
  v_mfma_f32_16x16x32_bf16 v[180:183], a[116:119], v[104:107], v[180:183]
  buffer_load_dwordx4 v[64:67], v4, s[16:19], s47 offen sc1
  v_mfma_f32_16x16x32_bf16 v[176:179], a[116:119], v[108:111], v[176:179]
  s_waitcnt vmcnt(31)
  v_mfma_f32_16x16x32_bf16 v[148:151], a[120:123], v[112:115], v[148:151]
  v_mfma_f32_16x16x32_bf16 v[144:147], a[120:123], v[116:119], v[144:147]
  buffer_load_dwordx2 v[68:69], v5, s[16:19], s47 offen offset:2048 sc1
  v_mfma_f32_16x16x32_bf16 v[156:159], a[124:127], v[112:115], v[156:159]
  v_mfma_f32_16x16x32_bf16 v[152:155], a[124:127], v[116:119], v[152:155]
  v_mfma_f32_16x16x32_bf16 v[164:167], a[128:131], v[112:115], v[164:167]
  buffer_load_dwordx4 v[128:131], v21, s[16:19], s47 offen offset:1024 sc1
  s_add_u32 s47, s47, 2560
  v_mfma_f32_16x16x32_bf16 v[160:163], a[128:131], v[116:119], v[160:163]
  v_mfma_f32_16x16x32_bf16 v[172:175], a[132:135], v[112:115], v[172:175]
  v_mfma_f32_16x16x32_bf16 v[168:171], a[132:135], v[116:119], v[168:171]
  buffer_load_dwordx4 a[20:23], v4, s[16:19], s68 offen offset:0 sc1
  v_mfma_f32_16x16x32_bf16 v[180:183], a[136:139], v[112:115], v[180:183]
  v_mfma_f32_16x16x32_bf16 v[176:179], a[136:139], v[116:119], v[176:179]
  s_waitcnt vmcnt(24)
  v_mfma_f32_16x16x32_bf16 v[148:151], a[140:143], v[120:123], v[148:151]
  buffer_load_dwordx4 a[24:27], v4, s[16:19], s68 offen offset:1024 sc1
  v_mfma_f32_16x16x32_bf16 v[144:147], a[140:143], v[124:127], v[144:147]
  v_mfma_f32_16x16x32_bf16 v[156:159], a[144:147], v[120:123], v[156:159]
  v_mfma_f32_16x16x32_bf16 v[152:155], a[144:147], v[124:127], v[152:155]
  buffer_load_dwordx4 v[40:43], v28, s[16:19], s48 offen offset:0 sc1
  v_mfma_f32_16x16x32_bf16 v[164:167], a[148:151], v[120:123], v[164:167]
  v_mfma_f32_16x16x32_bf16 v[160:163], a[148:151], v[124:127], v[160:163]
  v_mfma_f32_16x16x32_bf16 v[172:175], a[152:155], v[120:123], v[172:175]
  buffer_load_dwordx4 a[28:31], v4, s[16:19], s70 offen sc1
  s_add_u32 s70, s70, 16384
  v_mfma_f32_16x16x32_bf16 v[168:171], a[152:155], v[124:127], v[168:171]
  v_mfma_f32_16x16x32_bf16 v[180:183], a[156:159], v[120:123], v[180:183]
  v_mfma_f32_16x16x32_bf16 v[176:179], a[156:159], v[124:127], v[176:179]
  buffer_load_dwordx4 a[32:35], v4, s[16:19], s68 offen offset:2048 sc1
  v_swap_b32 v138, v140
  v_swap_b32 v139, v141
  v_swap_b32 v50, v52
  v_swap_b32 v51, v53
  v_swap_b32 v58, v60
  v_swap_b32 v59, v61
  s_nop 1
  v_mfma_f32_16x16x32_bf16 v[144:147], v[48:51], v[136:139], v[144:147]
  buffer_load_dwordx4 a[36:39], v4, s[16:19], s68 offen offset:3072 sc1
  s_add_u32 s68, s68, 65536
  v_mfma_f32_16x16x32_bf16 v[148:151], v[48:51], v[140:143], v[148:151]
  v_mfma_f32_16x16x32_bf16 v[152:155], v[52:55], v[136:139], v[152:155]
  v_mfma_f32_16x16x32_bf16 v[156:159], v[52:55], v[140:143], v[156:159]
  buffer_load_dwordx2 v[184:185], v14, s[16:19], s48 offen offset:512 sc1
  v_mfma_f32_16x16x32_bf16 v[160:163], v[188:191], v[136:139], v[160:163]
  v_mfma_f32_16x16x32_bf16 v[164:167], v[188:191], v[140:143], v[164:167]
  v_mfma_f32_16x16x32_bf16 v[168:171], v[56:59], v[136:139], v[168:171]
  buffer_load_dwordx4 v[72:75], v4, s[16:19], s47 offen sc1
  v_mfma_f32_16x16x32_bf16 v[172:175], v[56:59], v[140:143], v[172:175]
  v_mfma_f32_16x16x32_bf16 v[176:179], v[60:63], v[136:139], v[176:179]
  v_mfma_f32_16x16x32_bf16 v[180:183], v[60:63], v[140:143], v[180:183]
  buffer_load_dwordx2 v[76:77], v5, s[16:19], s47 offen offset:2048 sc1
  s_add_u32 s47, s47, 13824
  s_nop 0
  ds_write_b128 v10, v[144:147] offset:0
  buffer_load_dwordx4 a[40:43], v4, s[16:19], s68 offen offset:0 sc1
  ds_write_b128 v10, v[148:151] offset:1024
  buffer_load_dwordx4 a[44:47], v4, s[16:19], s68 offen offset:1024 sc1
  ds_write_b128 v10, v[152:155] offset:2048
  ds_write_b128 v10, v[156:159] offset:3072
  buffer_load_dwordx4 v[36:39], v22, s[16:19], s48 offen offset:1280 sc1
  ds_write_b128 v10, v[160:163] offset:4096
  buffer_load_dwordx4 a[48:51], v4, s[16:19], s70 offen sc1
  s_add_u32 s70, s70, 16384
  ds_write_b128 v10, v[164:167] offset:5120
  buffer_load_dwordx4 a[52:55], v4, s[16:19], s68 offen offset:2048 sc1
  ds_write_b128 v10, v[168:171] offset:6144
  buffer_load_dwordx4 a[56:59], v4, s[16:19], s68 offen offset:3072 sc1
  s_add_u32 s68, s68, 65536
  ds_write_b128 v10, v[172:175] offset:7168
  buffer_load_dwordx4 v[80:83], v4, s[16:19], s47 offen sc1
  s_nop 1
  ds_write_b128 v10, v[176:179] offset:8192
  buffer_load_dwordx2 v[84:85], v5, s[16:19], s47 offen offset:2048 sc1
  ds_write_b128 v10, v[180:183] offset:9216
  buffer_load_dwordx4 v[132:135], v21, s[16:19], s47 offen offset:1024 sc1
  s_add_u32 s47, s47, 2560
  s_waitcnt lgkmcnt(0)
  s_barrier
  ds_read_b128 v[144:147], v11 offset:0
  ds_read_b128 v[148:151], v11 offset:10240
  ds_read_b128 v[152:155], v11 offset:20480
  ds_read_b128 v[156:159], v11 offset:30720
  ds_read_b128 v[160:163], v11 offset:2048
  ds_read_b128 v[164:167], v11 offset:12288
  ds_read_b128 v[168:171], v11 offset:22528
  ds_read_b128 v[172:175], v11 offset:32768
  s_waitcnt lgkmcnt(4)
  buffer_load_dwordx4 a[60:63], v4, s[16:19], s68 offen offset:0 sc1
  v_pk_add_f32 v[144:145], v[144:145], v[148:149]
  v_pk_add_f32 v[152:153], v[152:153], v[156:157]
  v_pk_add_f32 v[146:147], v[146:147], v[150:151]
  v_pk_add_f32 v[154:155], v[154:155], v[158:159]
  v_pk_add_f32 v[176:177], v[144:145], v[152:153]
  v_pk_add_f32 v[178:179], v[146:147], v[154:155]
  ds_read_b128 v[144:147], v12 offset:0
  ds_read_b128 v[148:151], v12 offset:10240
  ds_read_b128 v[152:155], v12 offset:20480
  ds_read_b128 v[156:159], v12 offset:30720
  v_cvt_pk_bf16_f32 v26, v176, v177
  buffer_load_dwordx4 a[64:67], v4, s[16:19], s68 offen offset:1024 sc1
  v_lshlrev_b32 v176, 16, v26
  v_and_b32 v177, 0xffff0000, v26
  v_mul_f32 v176, v176, v24
  v_mul_f32 v177, v177, v24
  v_cvt_pk_bf16_f32 v26, v176, v177
  v_lshlrev_b32 v176, 16, v26
  v_and_b32 v177, 0xffff0000, v26
  v_add_f32 v176, v176, v240
  v_add_f32 v177, v177, v241
  v_cvt_pk_bf16_f32 v236, v176, v177
  v_cvt_pk_bf16_f32 v26, v178, v179
  v_lshlrev_b32 v178, 16, v26
  buffer_load_dwordx4 v[44:47], v28, s[16:19], s48 offen offset:1280 sc1
  v_and_b32 v179, 0xffff0000, v26
  v_mul_f32 v178, v178, v24
  v_mul_f32 v179, v179, v24
  v_cvt_pk_bf16_f32 v26, v178, v179
  v_lshlrev_b32 v178, 16, v26
  v_and_b32 v179, 0xffff0000, v26
  v_add_f32 v178, v178, v242
  v_add_f32 v179, v179, v243
  v_cvt_pk_bf16_f32 v237, v178, v179
  s_waitcnt lgkmcnt(4)
  v_pk_add_f32 v[160:161], v[160:161], v[164:165]
  v_pk_add_f32 v[168:169], v[168:169], v[172:173]
  buffer_load_dwordx4 a[68:71], v4, s[16:19], s70 offen sc1
  s_add_u32 s70, s70, 16384
  v_pk_add_f32 v[162:163], v[162:163], v[166:167]
  v_pk_add_f32 v[170:171], v[170:171], v[174:175]
  v_pk_add_f32 v[176:177], v[160:161], v[168:169]
  v_pk_add_f32 v[178:179], v[162:163], v[170:171]
  v_cvt_pk_bf16_f32 v26, v176, v177
  v_lshlrev_b32 v176, 16, v26
  v_and_b32 v177, 0xffff0000, v26
  v_mul_f32 v176, v176, v24
  v_mul_f32 v177, v177, v24
  v_cvt_pk_bf16_f32 v26, v176, v177
  v_lshlrev_b32 v176, 16, v26
  buffer_load_dwordx4 a[72:75], v4, s[16:19], s68 offen offset:2048 sc1
  v_and_b32 v177, 0xffff0000, v26
  v_add_f32 v176, v176, v244
  v_add_f32 v177, v177, v245
  v_cvt_pk_bf16_f32 v238, v176, v177
  v_cvt_pk_bf16_f32 v26, v178, v179
  v_lshlrev_b32 v178, 16, v26
  v_and_b32 v179, 0xffff0000, v26
  v_mul_f32 v178, v178, v24
  v_mul_f32 v179, v179, v24
  v_cvt_pk_bf16_f32 v26, v178, v179
  v_lshlrev_b32 v178, 16, v26
  v_and_b32 v179, 0xffff0000, v26
  buffer_load_dwordx4 a[76:79], v4, s[16:19], s68 offen offset:3072 sc1
  s_add_u32 s68, s68, 65536
  v_add_f32 v178, v178, v246
  v_add_f32 v179, v179, v247
  v_cvt_pk_bf16_f32 v239, v178, v179
  buffer_store_dwordx4 v[236:239], v9, s[8:11], s46 offen
  s_cmp_lt_u32 s20, 2
  s_cselect_b32 s49, s49, 0x40000000
  s_waitcnt lgkmcnt(0)
  v_pk_add_f32 v[144:145], v[144:145], v[148:149]
  v_pk_add_f32 v[152:153], v[152:153], v[156:157]
  v_pk_add_f32 v[146:147], v[146:147], v[150:151]
  v_pk_add_f32 v[154:155], v[154:155], v[158:159]
  buffer_load_dwordx2 v[186:187], v14, s[16:19], s48 offen offset:1792 sc1
  s_add_u32 s48, s48, 262144
  v_pk_add_f32 v[176:177], v[144:145], v[152:153]
  v_pk_add_f32 v[178:179], v[146:147], v[154:155]
  v_cvt_pk_bf16_f32 v26, v176, v177
  v_lshlrev_b32 v176, 16, v26
  v_and_b32 v177, 0xffff0000, v26
  v_mul_f32 v176, v176, v24
  v_mul_f32 v177, v177, v24
  v_cvt_pk_bf16_f32 v26, v176, v177
  v_lshlrev_b32 v176, 16, v26
  v_and_b32 v177, 0xffff0000, v26
  v_add_f32 v176, v176, v248
  v_add_f32 v177, v177, v249
  buffer_load_dwordx4 v[88:91], v4, s[16:19], s47 offen sc1
  v_cvt_pk_bf16_f32 v234, v176, v177
  v_cvt_pk_bf16_f32 v26, v178, v179
  v_lshlrev_b32 v178, 16, v26
  v_and_b32 v179, 0xffff0000, v26
  v_mul_f32 v178, v178, v24
  v_mul_f32 v179, v179, v24
  v_cvt_pk_bf16_f32 v26, v178, v179
  v_lshlrev_b32 v178, 16, v26
  v_and_b32 v179, 0xffff0000, v26
  v_add_f32 v178, v178, v250
  v_add_f32 v179, v179, v251
  v_cvt_pk_bf16_f32 v235, v178, v179
  buffer_load_dwordx2 v[92:93], v5, s[16:19], s47 offen offset:2048 sc1
  s_add_u32 s47, s47, 13824
  buffer_store_dwordx2 v[234:235], v13, s[8:11], s49 offen offset:64
  s_branch pv_loop
pv_320:
  s_waitcnt vmcnt(42)
  v_mfma_f32_16x16x32_bf16 v[148:151], a[80:83], v[96:99], v[148:151]
  v_mfma_f32_16x16x32_bf16 v[144:147], a[80:83], v[100:103], v[144:147]
  v_mfma_f32_16x16x32_bf16 v[156:159], a[84:87], v[96:99], v[156:159]
  v_mfma_f32_16x16x32_bf16 v[152:155], a[84:87], v[100:103], v[152:155]
  v_mfma_f32_16x16x32_bf16 v[164:167], a[88:91], v[96:99], v[164:167]
  v_mfma_f32_16x16x32_bf16 v[160:163], a[88:91], v[100:103], v[160:163]
  v_mfma_f32_16x16x32_bf16 v[172:175], a[92:95], v[96:99], v[172:175]
  v_mfma_f32_16x16x32_bf16 v[168:171], a[92:95], v[100:103], v[168:171]
  v_mfma_f32_16x16x32_bf16 v[180:183], a[96:99], v[96:99], v[180:183]
  v_mfma_f32_16x16x32_bf16 v[176:179], a[96:99], v[100:103], v[176:179]
  s_waitcnt vmcnt(33)
  v_mfma_f32_16x16x32_bf16 v[148:151], a[100:103], v[104:107], v[148:151]
  v_mfma_f32_16x16x32_bf16 v[144:147], a[100:103], v[108:111], v[144:147]
  v_mfma_f32_16x16x32_bf16 v[156:159], a[104:107], v[104:107], v[156:159]
  v_mfma_f32_16x16x32_bf16 v[152:155], a[104:107], v[108:111], v[152:155]
  v_mfma_f32_16x16x32_bf16 v[164:167], a[108:111], v[104:107], v[164:167]
  v_mfma_f32_16x16x32_bf16 v[160:163], a[108:111], v[108:111], v[160:163]
  v_mfma_f32_16x16x32_bf16 v[172:175], a[112:115], v[104:107], v[172:175]
  v_mfma_f32_16x16x32_bf16 v[168:171], a[112:115], v[108:111], v[168:171]
  v_mfma_f32_16x16x32_bf16 v[180:183], a[116:119], v[104:107], v[180:183]
  v_mfma_f32_16x16x32_bf16 v[176:179], a[116:119], v[108:111], v[176:179]
  s_waitcnt vmcnt(24)
  v_mfma_f32_16x16x32_bf16 v[148:151], a[120:123], v[112:115], v[148:151]
  v_mfma_f32_16x16x32_bf16 v[144:147], a[120:123], v[116:119], v[144:147]
  v_mfma_f32_16x16x32_bf16 v[156:159], a[124:127], v[112:115], v[156:159]
  v_mfma_f32_16x16x32_bf16 v[152:155], a[124:127], v[116:119], v[152:155]
  v_mfma_f32_16x16x32_bf16 v[164:167], a[128:131], v[112:115], v[164:167]
  v_mfma_f32_16x16x32_bf16 v[160:163], a[128:131], v[116:119], v[160:163]
  v_mfma_f32_16x16x32_bf16 v[172:175], a[132:135], v[112:115], v[172:175]
  v_mfma_f32_16x16x32_bf16 v[168:171], a[132:135], v[116:119], v[168:171]
  v_mfma_f32_16x16x32_bf16 v[180:183], a[136:139], v[112:115], v[180:183]
  v_mfma_f32_16x16x32_bf16 v[176:179], a[136:139], v[116:119], v[176:179]
  s_waitcnt vmcnt(14)
  v_mfma_f32_16x16x32_bf16 v[148:151], a[140:143], v[120:123], v[148:151]
  v_mfma_f32_16x16x32_bf16 v[144:147], a[140:143], v[124:127], v[144:147]
  v_mfma_f32_16x16x32_bf16 v[156:159], a[144:147], v[120:123], v[156:159]
  v_mfma_f32_16x16x32_bf16 v[152:155], a[144:147], v[124:127], v[152:155]
  v_mfma_f32_16x16x32_bf16 v[164:167], a[148:151], v[120:123], v[164:167]
  v_mfma_f32_16x16x32_bf16 v[160:163], a[148:151], v[124:127], v[160:163]
  v_mfma_f32_16x16x32_bf16 v[172:175], a[152:155], v[120:123], v[172:175]
  v_mfma_f32_16x16x32_bf16 v[168:171], a[152:155], v[124:127], v[168:171]
  v_mfma_f32_16x16x32_bf16 v[180:183], a[156:159], v[120:123], v[180:183]
  v_mfma_f32_16x16x32_bf16 v[176:179], a[156:159], v[124:127], v[176:179]
  v_swap_b32 v138, v140
  v_swap_b32 v139, v141
  v_swap_b32 v50, v52
  v_swap_b32 v51, v53
  v_swap_b32 v58, v60
  v_swap_b32 v59, v61
  s_nop 1
  v_mfma_f32_16x16x32_bf16 v[144:147], v[48:51], v[136:139], v[144:147]
  v_mfma_f32_16x16x32_bf16 v[148:151], v[48:51], v[140:143], v[148:151]
  v_mfma_f32_16x16x32_bf16 v[152:155], v[52:55], v[136:139], v[152:155]
  v_mfma_f32_16x16x32_bf16 v[156:159], v[52:55], v[140:143], v[156:159]
  v_mfma_f32_16x16x32_bf16 v[160:163], v[188:191], v[136:139], v[160:163]
  v_mfma_f32_16x16x32_bf16 v[164:167], v[188:191], v[140:143], v[164:167]
  v_mfma_f32_16x16x32_bf16 v[168:171], v[56:59], v[136:139], v[168:171]
  v_mfma_f32_16x16x32_bf16 v[172:175], v[56:59], v[140:143], v[172:175]
  v_mfma_f32_16x16x32_bf16 v[176:179], v[60:63], v[136:139], v[176:179]
  v_mfma_f32_16x16x32_bf16 v[180:183], v[60:63], v[140:143], v[180:183]
  s_branch pve_315
pvw_314:
  v_mfma_f32_16x16x32_bf16 v[144:147], a[160:163], v[192:195], 0
  v_mfma_f32_16x16x32_bf16 v[148:151], a[160:163], v[212:215], 0
  v_mfma_f32_16x16x32_bf16 v[152:155], a[164:167], v[192:195], 0
  v_mfma_f32_16x16x32_bf16 v[156:159], a[164:167], v[212:215], 0
  v_mfma_f32_16x16x32_bf16 v[160:163], a[168:171], v[192:195], 0
  v_mfma_f32_16x16x32_bf16 v[164:167], a[168:171], v[212:215], 0
  v_mfma_f32_16x16x32_bf16 v[168:171], a[172:175], v[192:195], 0
  v_mfma_f32_16x16x32_bf16 v[172:175], a[172:175], v[212:215], 0
  v_mfma_f32_16x16x32_bf16 v[176:179], a[176:179], v[192:195], 0
  v_mfma_f32_16x16x32_bf16 v[180:183], a[176:179], v[212:215], 0
  v_mfma_f32_16x16x32_bf16 v[144:147], a[180:183], v[196:199], v[144:147]
  v_mfma_f32_16x16x32_bf16 v[148:151], a[180:183], v[216:219], v[148:151]
  v_mfma_f32_16x16x32_bf16 v[152:155], a[184:187], v[196:199], v[152:155]
  v_mfma_f32_16x16x32_bf16 v[156:159], a[184:187], v[216:219], v[156:159]
  v_mfma_f32_16x16x32_bf16 v[160:163], a[188:191], v[196:199], v[160:163]
  v_mfma_f32_16x16x32_bf16 v[164:167], a[188:191], v[216:219], v[164:167]
  v_mfma_f32_16x16x32_bf16 v[168:171], a[192:195], v[196:199], v[168:171]
  v_mfma_f32_16x16x32_bf16 v[172:175], a[192:195], v[216:219], v[172:175]
  v_mfma_f32_16x16x32_bf16 v[176:179], a[196:199], v[196:199], v[176:179]
  v_mfma_f32_16x16x32_bf16 v[180:183], a[196:199], v[216:219], v[180:183]
  v_mfma_f32_16x16x32_bf16 v[144:147], a[200:203], v[200:203], v[144:147]
  v_mfma_f32_16x16x32_bf16 v[148:151], a[200:203], v[220:223], v[148:151]
  v_mfma_f32_16x16x32_bf16 v[152:155], a[204:207], v[200:203], v[152:155]
  v_mfma_f32_16x16x32_bf16 v[156:159], a[204:207], v[220:223], v[156:159]
  v_mfma_f32_16x16x32_bf16 v[160:163], a[208:211], v[200:203], v[160:163]
  v_mfma_f32_16x16x32_bf16 v[164:167], a[208:211], v[220:223], v[164:167]
  v_mfma_f32_16x16x32_bf16 v[168:171], a[212:215], v[200:203], v[168:171]
  v_mfma_f32_16x16x32_bf16 v[172:175], a[212:215], v[220:223], v[172:175]
  v_mfma_f32_16x16x32_bf16 v[176:179], a[216:219], v[200:203], v[176:179]
  v_mfma_f32_16x16x32_bf16 v[180:183], a[216:219], v[220:223], v[180:183]
  v_mfma_f32_16x16x32_bf16 v[144:147], a[220:223], v[204:207], v[144:147]
  v_mfma_f32_16x16x32_bf16 v[148:151], a[220:223], v[224:227], v[148:151]
  v_mfma_f32_16x16x32_bf16 v[152:155], a[224:227], v[204:207], v[152:155]
  v_mfma_f32_16x16x32_bf16 v[156:159], a[224:227], v[224:227], v[156:159]
  v_mfma_f32_16x16x32_bf16 v[160:163], a[228:231], v[204:207], v[160:163]
  v_mfma_f32_16x16x32_bf16 v[164:167], a[228:231], v[224:227], v[164:167]
  v_mfma_f32_16x16x32_bf16 v[168:171], a[232:235], v[204:207], v[168:171]
  v_mfma_f32_16x16x32_bf16 v[172:175], a[232:235], v[224:227], v[172:175]
  v_mfma_f32_16x16x32_bf16 v[176:179], a[236:239], v[204:207], v[176:179]
  v_mfma_f32_16x16x32_bf16 v[180:183], a[236:239], v[224:227], v[180:183]
  v_mfma_f32_16x16x32_bf16 v[144:147], a[240:243], v[208:211], v[144:147]
  v_mfma_f32_16x16x32_bf16 v[148:151], a[240:243], v[228:231], v[148:151]
  v_mfma_f32_16x16x32_bf16 v[152:155], a[244:247], v[208:211], v[152:155]
  v_mfma_f32_16x16x32_bf16 v[156:159], a[244:247], v[228:231], v[156:159]
  v_mfma_f32_16x16x32_bf16 v[160:163], a[248:251], v[208:211], v[160:163]
  v_mfma_f32_16x16x32_bf16 v[164:167], a[248:251], v[228:231], v[164:167]
  v_mfma_f32_16x16x32_bf16 v[168:171], a[252:255], v[208:211], v[168:171]
  v_mfma_f32_16x16x32_bf16 v[172:175], a[252:255], v[228:231], v[172:175]
  v_mfma_f32_16x16x32_bf16 v[176:179], v[252:255], v[208:211], v[176:179]
  v_mfma_f32_16x16x32_bf16 v[180:183], v[252:255], v[228:231], v[180:183]
  ds_write_b128 v10, v[144:147] offset:40960
  ds_write_b128 v10, v[148:151] offset:41984
  ds_write_b128 v10, v[152:155] offset:43008
  ds_write_b128 v10, v[156:159] offset:44032
  ds_write_b128 v10, v[160:163] offset:45056
  ds_write_b128 v10, v[164:167] offset:46080
  ds_write_b128 v10, v[168:171] offset:47104
  ds_write_b128 v10, v[172:175] offset:48128
  s_nop 1
  ds_write_b128 v10, v[176:179] offset:49152
  ds_write_b128 v10, v[180:183] offset:50176
  s_waitcnt lgkmcnt(0)
  s_barrier
  ds_read_b32 v23, v30
  s_waitcnt lgkmcnt(0)
  v_readfirstlane_b32 s2, v23
  s_min_u32 s2, s2, 16
  s_cmp_eq_u32 s65, 0
  s_cselect_b32 s2, 17, s2
  v_sub_f32 v25, 1.0, v24
  v_cvt_pk_bf16_f32 v26, v25, v25
  v_lshlrev_b32 v25, 16, v26
  ds_read_b128 v[144:147], v15 offset:0
  ds_read_b128 v[148:151], v15 offset:10240
  ds_read_b128 v[152:155], v15 offset:20480
  ds_read_b128 v[156:159], v15 offset:30720
  ds_read_b128 v[160:163], v15 offset:2048
  ds_read_b128 v[164:167], v15 offset:12288
  ds_read_b128 v[168:171], v15 offset:22528
  ds_read_b128 v[172:175], v15 offset:32768
  s_waitcnt lgkmcnt(4)
  v_pk_add_f32 v[144:145], v[144:145], v[148:149]
  v_pk_add_f32 v[152:153], v[152:153], v[156:157]
  v_pk_add_f32 v[146:147], v[146:147], v[150:151]
  v_pk_add_f32 v[154:155], v[154:155], v[158:159]
  v_pk_add_f32 v[176:177], v[144:145], v[152:153]
  v_pk_add_f32 v[178:179], v[146:147], v[154:155]
  ds_read_b128 v[144:147], v16 offset:0
  ds_read_b128 v[148:151], v16 offset:10240
  ds_read_b128 v[152:155], v16 offset:20480
  ds_read_b128 v[156:159], v16 offset:30720
  v_cvt_pk_bf16_f32 v26, v176, v177
  v_lshlrev_b32 v240, 16, v26
  v_and_b32 v241, 0xffff0000, v26
  v_mul_f32 v240, v240, v25
  v_mul_f32 v241, v241, v25
  v_cvt_pk_bf16_f32 v26, v240, v241
  v_lshlrev_b32 v240, 16, v26
  v_and_b32 v241, 0xffff0000, v26
  v_cvt_pk_bf16_f32 v26, v178, v179
  v_lshlrev_b32 v242, 16, v26
  v_and_b32 v243, 0xffff0000, v26
  v_mul_f32 v242, v242, v25
  v_mul_f32 v243, v243, v25
  v_cvt_pk_bf16_f32 v26, v242, v243
  v_lshlrev_b32 v242, 16, v26
  v_and_b32 v243, 0xffff0000, v26
  s_waitcnt lgkmcnt(4)
  v_pk_add_f32 v[160:161], v[160:161], v[164:165]
  v_pk_add_f32 v[168:169], v[168:169], v[172:173]
  v_pk_add_f32 v[162:163], v[162:163], v[166:167]
  v_pk_add_f32 v[170:171], v[170:171], v[174:175]
  v_pk_add_f32 v[176:177], v[160:161], v[168:169]
  v_pk_add_f32 v[178:179], v[162:163], v[170:171]
  v_cvt_pk_bf16_f32 v26, v176, v177
  v_lshlrev_b32 v244, 16, v26
  v_and_b32 v245, 0xffff0000, v26
  v_mul_f32 v244, v244, v25
  v_mul_f32 v245, v245, v25
  v_cvt_pk_bf16_f32 v26, v244, v245
  v_lshlrev_b32 v244, 16, v26
  v_and_b32 v245, 0xffff0000, v26
  v_cvt_pk_bf16_f32 v26, v178, v179
  v_lshlrev_b32 v246, 16, v26
  v_and_b32 v247, 0xffff0000, v26
  v_mul_f32 v246, v246, v25
  v_mul_f32 v247, v247, v25
  v_cvt_pk_bf16_f32 v26, v246, v247
  v_lshlrev_b32 v246, 16, v26
  v_and_b32 v247, 0xffff0000, v26
  s_waitcnt lgkmcnt(0)
  v_pk_add_f32 v[144:145], v[144:145], v[148:149]
  v_pk_add_f32 v[152:153], v[152:153], v[156:157]
  v_pk_add_f32 v[146:147], v[146:147], v[150:151]
  v_pk_add_f32 v[154:155], v[154:155], v[158:159]
  v_pk_add_f32 v[176:177], v[144:145], v[152:153]
  v_pk_add_f32 v[178:179], v[146:147], v[154:155]
  v_cvt_pk_bf16_f32 v26, v176, v177
  v_lshlrev_b32 v248, 16, v26
  v_and_b32 v249, 0xffff0000, v26
  v_mul_f32 v248, v248, v25
  v_mul_f32 v249, v249, v25
  v_cvt_pk_bf16_f32 v26, v248, v249
  v_lshlrev_b32 v248, 16, v26
  v_and_b32 v249, 0xffff0000, v26
  v_cvt_pk_bf16_f32 v26, v178, v179
  v_lshlrev_b32 v250, 16, v26
  v_and_b32 v251, 0xffff0000, v26
  v_mul_f32 v250, v250, v25
  v_mul_f32 v251, v251, v25
  v_cvt_pk_bf16_f32 v26, v250, v251
  v_lshlrev_b32 v250, 16, v26
  v_and_b32 v251, 0xffff0000, v26
  s_cmp_ge_u32 s40, 60
  s_cbranch_scc1 pvt_321
  s_cmp_lg_u32 s20, 0
  s_cbranch_scc1 wr_323
  s_mov_b32 s101, 0
wr_322:
  buffer_load_dword v26, v18, s[72:75], 0 offen sc1
  s_add_u32 s101, s101, 1
  s_cmp_gt_u32 s101, 131072
  s_cbranch_scc1 main_end
  s_waitcnt vmcnt(0)
  v_cmp_gt_u32 vcc, v19, v26
  v_readfirstlane_b32 s100, v26
  s_nop 0
  s_cbranch_vccz wr_323
  s_sleep 2
  s_cmp_lg_u32 s100, 0
  s_cbranch_scc1 wr_322
  s_sleep 24
  s_branch wr_322
wr_323:
  s_barrier
  s_waitcnt vmcnt(10)
  buffer_load_dwordx4 v[64:67], v4, s[16:19], s47 offen sc1
  buffer_load_dwordx2 v[68:69], v5, s[16:19], s47 offen offset:2048 sc1
  buffer_load_dwordx4 v[128:131], v21, s[16:19], s47 offen offset:1024 sc1
  s_add_u32 s47, s47, 2560
  buffer_load_dwordx4 v[72:75], v4, s[16:19], s47 offen sc1
  buffer_load_dwordx2 v[76:77], v5, s[16:19], s47 offen offset:2048 sc1
  s_add_u32 s47, s47, 13824
  buffer_load_dwordx4 v[80:83], v4, s[16:19], s47 offen sc1
  buffer_load_dwordx2 v[84:85], v5, s[16:19], s47 offen offset:2048 sc1
  buffer_load_dwordx4 v[132:135], v21, s[16:19], s47 offen offset:1024 sc1
  s_add_u32 s47, s47, 2560
  buffer_load_dwordx4 v[88:91], v4, s[16:19], s47 offen sc1
  buffer_load_dwordx2 v[92:93], v5, s[16:19], s47 offen offset:2048 sc1
  s_add_u32 s47, s47, 13824
  buffer_load_dwordx4 v[32:35], v22, s[16:19], s48 offen offset:0 sc1
  buffer_load_dwordx4 v[40:43], v28, s[16:19], s48 offen offset:0 sc1
  buffer_load_dwordx2 v[184:185], v14, s[16:19], s48 offen offset:512 sc1
  buffer_load_dwordx4 v[36:39], v22, s[16:19], s48 offen offset:1280 sc1
  buffer_load_dwordx4 v[44:47], v28, s[16:19], s48 offen offset:1280 sc1
  buffer_load_dwordx2 v[186:187], v14, s[16:19], s48 offen offset:1792 sc1
  s_add_u32 s48, s48, 262144
  buffer_load_dwordx4 v[96:99], v4, s[16:19], s47 offen sc1
  buffer_load_dwordx2 v[100:101], v5, s[16:19], s47 offen offset:2048 sc1
  buffer_load_dwordx4 v[136:139], v21, s[16:19], s47 offen offset:1024 sc1
  s_add_u32 s47, s47, 2560
  buffer_load_dwordx4 v[104:107], v4, s[16:19], s47 offen sc1
  buffer_load_dwordx2 v[108:109], v5, s[16:19], s47 offen offset:2048 sc1
  s_add_u32 s47, s47, 13824
  buffer_load_dwordx4 v[112:115], v4, s[16:19], s47 offen sc1
  buffer_load_dwordx2 v[116:117], v5, s[16:19], s47 offen offset:2048 sc1
  buffer_load_dwordx4 v[140:143], v21, s[16:19], s47 offen offset:1024 sc1
  s_add_u32 s47, s47, 2560
  buffer_load_dwordx4 v[120:123], v4, s[16:19], s47 offen sc1
  buffer_load_dwordx2 v[124:125], v5, s[16:19], s47 offen offset:2048 sc1
  s_add_u32 s47, s47, 13824
  buffer_load_dwordx4 v[48:51], v22, s[16:19], s48 offen offset:0 sc1
  buffer_load_dwordx4 v[56:59], v28, s[16:19], s48 offen offset:0 sc1
  buffer_load_dwordx2 v[188:189], v14, s[16:19], s48 offen offset:512 sc1
  buffer_load_dwordx4 v[52:55], v22, s[16:19], s48 offen offset:1280 sc1
  buffer_load_dwordx4 v[60:63], v28, s[16:19], s48 offen offset:1280 sc1
  buffer_load_dwordx2 v[190:191], v14, s[16:19], s48 offen offset:1792 sc1
  s_add_u32 s48, s48, 262144
  s_lshl_b32 s40, s2, 2
  s_add_u32 s40, s40, s58
  s_lshl_b32 s21, s40, 7
  s_add_u32 s21, s21, 8192
  s_xor_b32 s21, s21, s80
  v_mov_b32 v18, s21
  v_cndmask_b32 v18, v17, v18, s[66:67]
  s_add_u32 s21, s40, 1
  v_mov_b32 v19, s21
  v_cndmask_b32 v19, v19, 32, s[66:67]
  buffer_load_dword v27, v18, s[72:75], 0 offen sc1
  s_lshl_b32 s55, s40, 19
  s_lshl_b32 s21, s40, 11
  s_and_b32 s21, s21, 8192
  s_xor_b32 s21, s21, s80
  s_add_u32 s55, s55, s21
  s_add_u32 s55, s55, 136314880
  s_lshl_b32 s21, s20, 15
  s_xor_b32 s54, s55, 8192
  s_add_u32 s54, s54, 48234496
  s_add_u32 s54, s54, s21
  s_lshl_b32 s57, s40, 1
  s_add_u32 s57, s57, s43
  s_lshl_b32 s45, s57, 6
  s_add_u32 s69, s54, 262144
  s_cmp_lt_u32 s2, 16
  s_cselect_b32 s69, s69, 0x40000000
  s_cmp_lt_u32 s2, 12
  s_cselect_b32 s65, s87, 0
  s_cmp_gt_u32 s65, 1
  s_cselect_b32 s64, s59, 0x40000000
  s_cselect_b32 s65, 1, 0
  v_mov_b32 v29, 1
  buffer_atomic_add v29, v233, s[72:75], s64 offen sc0 sc1
  buffer_load_dword v232, v6, s[28:31], s45 offen sc1
  buffer_load_dwordx4 v[192:195], v4, s[16:19], s69 offen offset:0 sc1
  buffer_load_dwordx4 v[196:199], v4, s[16:19], s69 offen offset:1024 sc1
  buffer_load_dwordx2 v[208:209], v5, s[16:19], s69 offen offset:2048 sc1
  s_add_u32 s69, s69, 2560
  buffer_load_dwordx4 v[200:203], v4, s[16:19], s69 offen offset:0 sc1
  buffer_load_dwordx4 v[204:207], v4, s[16:19], s69 offen offset:1024 sc1
  buffer_load_dwordx2 v[210:211], v5, s[16:19], s69 offen offset:2048 sc1
  s_add_u32 s69, s69, 13824
  buffer_load_dwordx4 v[212:215], v4, s[16:19], s69 offen offset:0 sc1
  buffer_load_dwordx4 v[216:219], v4, s[16:19], s69 offen offset:1024 sc1
  buffer_load_dwordx2 v[228:229], v5, s[16:19], s69 offen offset:2048 sc1
  s_add_u32 s69, s69, 2560
  buffer_load_dwordx4 v[220:223], v4, s[16:19], s69 offen offset:0 sc1
  buffer_load_dwordx4 v[224:227], v4, s[16:19], s69 offen offset:1024 sc1
  buffer_load_dwordx2 v[230:231], v5, s[16:19], s69 offen offset:2048 sc1
  s_add_u32 s69, s69, 13824
  s_waitcnt vmcnt(45)
  v_mfma_f32_16x16x32_bf16 v[148:151], a[0:3], v[64:67], 0
  v_mfma_f32_16x16x32_bf16 v[144:147], a[0:3], v[68:71], 0
  v_mfma_f32_16x16x32_bf16 v[156:159], a[4:7], v[64:67], 0
  v_mfma_f32_16x16x32_bf16 v[152:155], a[4:7], v[68:71], 0
  v_mfma_f32_16x16x32_bf16 v[164:167], a[8:11], v[64:67], 0
  v_mfma_f32_16x16x32_bf16 v[160:163], a[8:11], v[68:71], 0
  v_mfma_f32_16x16x32_bf16 v[172:175], a[12:15], v[64:67], 0
  v_mfma_f32_16x16x32_bf16 v[168:171], a[12:15], v[68:71], 0
  v_mfma_f32_16x16x32_bf16 v[180:183], a[16:19], v[64:67], 0
  v_mfma_f32_16x16x32_bf16 v[176:179], a[16:19], v[68:71], 0
  s_waitcnt vmcnt(42)
  v_mfma_f32_16x16x32_bf16 v[148:151], a[20:23], v[72:75], v[148:151]
  v_mfma_f32_16x16x32_bf16 v[144:147], a[20:23], v[76:79], v[144:147]
  v_mfma_f32_16x16x32_bf16 v[156:159], a[24:27], v[72:75], v[156:159]
  v_mfma_f32_16x16x32_bf16 v[152:155], a[24:27], v[76:79], v[152:155]
  v_mfma_f32_16x16x32_bf16 v[164:167], a[28:31], v[72:75], v[164:167]
  v_mfma_f32_16x16x32_bf16 v[160:163], a[28:31], v[76:79], v[160:163]
  v_mfma_f32_16x16x32_bf16 v[172:175], a[32:35], v[72:75], v[172:175]
  v_mfma_f32_16x16x32_bf16 v[168:171], a[32:35], v[76:79], v[168:171]
  v_mfma_f32_16x16x32_bf16 v[180:183], a[36:39], v[72:75], v[180:183]
  v_mfma_f32_16x16x32_bf16 v[176:179], a[36:39], v[76:79], v[176:179]
  s_waitcnt vmcnt(40)
  v_mfma_f32_16x16x32_bf16 v[148:151], a[40:43], v[80:83], v[148:151]
  v_mfma_f32_16x16x32_bf16 v[144:147], a[40:43], v[84:87], v[144:147]
  v_mfma_f32_16x16x32_bf16 v[156:159], a[44:47], v[80:83], v[156:159]
  v_mfma_f32_16x16x32_bf16 v[152:155], a[44:47], v[84:87], v[152:155]
  v_mfma_f32_16x16x32_bf16 v[164:167], a[48:51], v[80:83], v[164:167]
  v_mfma_f32_16x16x32_bf16 v[160:163], a[48:51], v[84:87], v[160:163]
  v_mfma_f32_16x16x32_bf16 v[172:175], a[52:55], v[80:83], v[172:175]
  v_mfma_f32_16x16x32_bf16 v[168:171], a[52:55], v[84:87], v[168:171]
  v_mfma_f32_16x16x32_bf16 v[180:183], a[56:59], v[80:83], v[180:183]
  v_mfma_f32_16x16x32_bf16 v[176:179], a[56:59], v[84:87], v[176:179]
  s_waitcnt vmcnt(37)
  v_mfma_f32_16x16x32_bf16 v[148:151], a[60:63], v[88:91], v[148:151]
  v_mfma_f32_16x16x32_bf16 v[144:147], a[60:63], v[92:95], v[144:147]
  v_mfma_f32_16x16x32_bf16 v[156:159], a[64:67], v[88:91], v[156:159]
  v_mfma_f32_16x16x32_bf16 v[152:155], a[64:67], v[92:95], v[152:155]
  v_mfma_f32_16x16x32_bf16 v[164:167], a[68:71], v[88:91], v[164:167]
  v_mfma_f32_16x16x32_bf16 v[160:163], a[68:71], v[92:95], v[160:163]
  v_mfma_f32_16x16x32_bf16 v[172:175], a[72:75], v[88:91], v[172:175]
  v_mfma_f32_16x16x32_bf16 v[168:171], a[72:75], v[92:95], v[168:171]
  v_mfma_f32_16x16x32_bf16 v[180:183], a[76:79], v[88:91], v[180:183]
  v_mfma_f32_16x16x32_bf16 v[176:179], a[76:79], v[92:95], v[176:179]
  s_waitcnt vmcnt(31)
  v_swap_b32 v130, v132
  v_swap_b32 v131, v133
  v_swap_b32 v34, v36
  v_swap_b32 v35, v37
  v_swap_b32 v42, v44
  v_swap_b32 v43, v45
  s_nop 1
  v_mfma_f32_16x16x32_bf16 v[144:147], v[32:35], v[128:131], v[144:147]
  v_mfma_f32_16x16x32_bf16 v[148:151], v[32:35], v[132:135], v[148:151]
  v_mfma_f32_16x16x32_bf16 v[152:155], v[36:39], v[128:131], v[152:155]
  v_mfma_f32_16x16x32_bf16 v[156:159], v[36:39], v[132:135], v[156:159]
  v_mfma_f32_16x16x32_bf16 v[160:163], v[184:187], v[128:131], v[160:163]
  v_mfma_f32_16x16x32_bf16 v[164:167], v[184:187], v[132:135], v[164:167]
  v_mfma_f32_16x16x32_bf16 v[168:171], v[40:43], v[128:131], v[168:171]
  v_mfma_f32_16x16x32_bf16 v[172:175], v[40:43], v[132:135], v[172:175]
  v_mfma_f32_16x16x32_bf16 v[176:179], v[44:47], v[128:131], v[176:179]
  v_mfma_f32_16x16x32_bf16 v[180:183], v[44:47], v[132:135], v[180:183]
  s_waitcnt vmcnt(29)
  v_mfma_f32_16x16x32_bf16 v[148:151], a[80:83], v[96:99], v[148:151]
  v_mfma_f32_16x16x32_bf16 v[144:147], a[80:83], v[100:103], v[144:147]
  v_mfma_f32_16x16x32_bf16 v[156:159], a[84:87], v[96:99], v[156:159]
  v_mfma_f32_16x16x32_bf16 v[152:155], a[84:87], v[100:103], v[152:155]
  v_mfma_f32_16x16x32_bf16 v[164:167], a[88:91], v[96:99], v[164:167]
  v_mfma_f32_16x16x32_bf16 v[160:163], a[88:91], v[100:103], v[160:163]
  v_mfma_f32_16x16x32_bf16 v[172:175], a[92:95], v[96:99], v[172:175]
  v_mfma_f32_16x16x32_bf16 v[168:171], a[92:95], v[100:103], v[168:171]
  v_mfma_f32_16x16x32_bf16 v[180:183], a[96:99], v[96:99], v[180:183]
  v_mfma_f32_16x16x32_bf16 v[176:179], a[96:99], v[100:103], v[176:179]
  s_waitcnt vmcnt(26)
  v_mfma_f32_16x16x32_bf16 v[148:151], a[100:103], v[104:107], v[148:151]
  v_mfma_f32_16x16x32_bf16 v[144:147], a[100:103], v[108:111], v[144:147]
  v_mfma_f32_16x16x32_bf16 v[156:159], a[104:107], v[104:107], v[156:159]
  v_mfma_f32_16x16x32_bf16 v[152:155], a[104:107], v[108:111], v[152:155]
  v_mfma_f32_16x16x32_bf16 v[164:167], a[108:111], v[104:107], v[164:167]
  v_mfma_f32_16x16x32_bf16 v[160:163], a[108:111], v[108:111], v[160:163]
  v_mfma_f32_16x16x32_bf16 v[172:175], a[112:115], v[104:107], v[172:175]
  v_mfma_f32_16x16x32_bf16 v[168:171], a[112:115], v[108:111], v[168:171]
  v_mfma_f32_16x16x32_bf16 v[180:183], a[116:119], v[104:107], v[180:183]
  v_mfma_f32_16x16x32_bf16 v[176:179], a[116:119], v[108:111], v[176:179]
  s_waitcnt vmcnt(24)
  v_mfma_f32_16x16x32_bf16 v[148:151], a[120:123], v[112:115], v[148:151]
  v_mfma_f32_16x16x32_bf16 v[144:147], a[120:123], v[116:119], v[144:147]
  v_mfma_f32_16x16x32_bf16 v[156:159], a[124:127], v[112:115], v[156:159]
  v_mfma_f32_16x16x32_bf16 v[152:155], a[124:127], v[116:119], v[152:155]
  v_mfma_f32_16x16x32_bf16 v[164:167], a[128:131], v[112:115], v[164:167]
  v_mfma_f32_16x16x32_bf16 v[160:163], a[128:131], v[116:119], v[160:163]
  v_mfma_f32_16x16x32_bf16 v[172:175], a[132:135], v[112:115], v[172:175]
  v_mfma_f32_16x16x32_bf16 v[168:171], a[132:135], v[116:119], v[168:171]
  v_mfma_f32_16x16x32_bf16 v[180:183], a[136:139], v[112:115], v[180:183]
  v_mfma_f32_16x16x32_bf16 v[176:179], a[136:139], v[116:119], v[176:179]
  s_waitcnt vmcnt(21)
  v_mfma_f32_16x16x32_bf16 v[148:151], a[140:143], v[120:123], v[148:151]
  v_mfma_f32_16x16x32_bf16 v[144:147], a[140:143], v[124:127], v[144:147]
  v_mfma_f32_16x16x32_bf16 v[156:159], a[144:147], v[120:123], v[156:159]
  v_mfma_f32_16x16x32_bf16 v[152:155], a[144:147], v[124:127], v[152:155]
  v_mfma_f32_16x16x32_bf16 v[164:167], a[148:151], v[120:123], v[164:167]
  v_mfma_f32_16x16x32_bf16 v[160:163], a[148:151], v[124:127], v[160:163]
  v_mfma_f32_16x16x32_bf16 v[172:175], a[152:155], v[120:123], v[172:175]
  v_mfma_f32_16x16x32_bf16 v[168:171], a[152:155], v[124:127], v[168:171]
  v_mfma_f32_16x16x32_bf16 v[180:183], a[156:159], v[120:123], v[180:183]
  v_mfma_f32_16x16x32_bf16 v[176:179], a[156:159], v[124:127], v[176:179]
  s_waitcnt vmcnt(15)
  v_swap_b32 v138, v140
  v_swap_b32 v139, v141
  v_swap_b32 v50, v52
  v_swap_b32 v51, v53
  v_swap_b32 v58, v60
  v_swap_b32 v59, v61
  s_nop 1
  v_mfma_f32_16x16x32_bf16 v[144:147], v[48:51], v[136:139], v[144:147]
  v_mfma_f32_16x16x32_bf16 v[148:151], v[48:51], v[140:143], v[148:151]
  v_mfma_f32_16x16x32_bf16 v[152:155], v[52:55], v[136:139], v[152:155]
  v_mfma_f32_16x16x32_bf16 v[156:159], v[52:55], v[140:143], v[156:159]
  v_mfma_f32_16x16x32_bf16 v[160:163], v[188:191], v[136:139], v[160:163]
  v_mfma_f32_16x16x32_bf16 v[164:167], v[188:191], v[140:143], v[164:167]
  v_mfma_f32_16x16x32_bf16 v[168:171], v[56:59], v[136:139], v[168:171]
  v_mfma_f32_16x16x32_bf16 v[172:175], v[56:59], v[140:143], v[172:175]
  v_mfma_f32_16x16x32_bf16 v[176:179], v[60:63], v[136:139], v[176:179]
  v_mfma_f32_16x16x32_bf16 v[180:183], v[60:63], v[140:143], v[180:183]
  s_branch pve_315
pvt_321:
  s_min_u32 s21, s40, 62
  v_mov_b32 v19, s21
  v_mov_b32 v18, v17
  s_cmp_lg_u32 s20, 0
  s_cbranch_scc1 wr_325
  s_mov_b32 s101, 0
wr_324:
  buffer_load_dword v26, v18, s[72:75], 0 offen sc1
  s_add_u32 s101, s101, 1
  s_cmp_gt_u32 s101, 131072
  s_cbranch_scc1 main_end
  s_waitcnt vmcnt(0)
  v_cmp_gt_u32 vcc, v19, v26
  v_readfirstlane_b32 s100, v26
  s_nop 0
  s_cbranch_vccz wr_325
  s_sleep 6
  s_cmp_lg_u32 s100, 0
  s_cbranch_scc1 wr_324
  s_sleep 0
  s_branch wr_324
wr_325:
  s_barrier
  s_lshl_b32 s40, s2, 2
  s_add_u32 s40, s40, s58
  s_lshl_b32 s21, s40, 7
  s_add_u32 s21, s21, 8192
  s_xor_b32 s21, s21, s80
  v_mov_b32 v18, s21
  v_cndmask_b32 v18, v17, v18, s[66:67]
  s_add_u32 s21, s40, 1
  v_mov_b32 v19, s21
  v_cndmask_b32 v19, v19, 32, s[66:67]
  buffer_load_dword v27, v18, s[72:75], 0 offen sc1
  s_lshl_b32 s55, s40, 19
  s_lshl_b32 s21, s40, 11
  s_and_b32 s21, s21, 8192
  s_xor_b32 s21, s21, s80
  s_add_u32 s55, s55, s21
  s_add_u32 s55, s55, 136314880
  s_lshl_b32 s21, s20, 15
  s_xor_b32 s54, s55, 8192
  s_add_u32 s54, s54, 48234496
  s_add_u32 s54, s54, s21
  s_lshl_b32 s57, s40, 1
  s_add_u32 s57, s57, s43
  s_lshl_b32 s45, s57, 6
  s_add_u32 s69, s54, 262144
  s_cmp_lt_u32 s2, 16
  s_cselect_b32 s69, s69, 0x40000000
  s_cmp_lt_u32 s2, 12
  s_cselect_b32 s65, s87, 0
  s_cmp_gt_u32 s65, 1
  s_cselect_b32 s64, s59, 0x40000000
  s_cselect_b32 s65, 1, 0
  v_mov_b32 v29, 1
  buffer_atomic_add v29, v233, s[72:75], s64 offen sc0 sc1
  buffer_load_dword v232, v6, s[28:31], s45 offen sc1
  buffer_load_dwordx4 v[192:195], v4, s[16:19], s69 offen offset:0 sc1
  buffer_load_dwordx4 v[196:199], v4, s[16:19], s69 offen offset:1024 sc1
  buffer_load_dwordx2 v[208:209], v5, s[16:19], s69 offen offset:2048 sc1
  s_add_u32 s69, s69, 2560
  buffer_load_dwordx4 v[200:203], v4, s[16:19], s69 offen offset:0 sc1
  buffer_load_dwordx4 v[204:207], v4, s[16:19], s69 offen offset:1024 sc1
  buffer_load_dwordx2 v[210:211], v5, s[16:19], s69 offen offset:2048 sc1
  s_add_u32 s69, s69, 13824
  buffer_load_dwordx4 v[212:215], v4, s[16:19], s69 offen offset:0 sc1
  buffer_load_dwordx4 v[216:219], v4, s[16:19], s69 offen offset:1024 sc1
  buffer_load_dwordx2 v[228:229], v5, s[16:19], s69 offen offset:2048 sc1
  s_add_u32 s69, s69, 2560
  buffer_load_dwordx4 v[220:223], v4, s[16:19], s69 offen offset:0 sc1
  buffer_load_dwordx4 v[224:227], v4, s[16:19], s69 offen offset:1024 sc1
  buffer_load_dwordx2 v[230:231], v5, s[16:19], s69 offen offset:2048 sc1
  s_add_u32 s69, s69, 13824
  s_mov_b32 s56, s48
  buffer_load_dwordx4 v[32:35], v22, s[16:19], s56 offen offset:0 sc1
  buffer_load_dwordx4 v[40:43], v28, s[16:19], s56 offen offset:0 sc1
  buffer_load_dwordx2 v[184:185], v14, s[16:19], s56 offen offset:512 sc1
  buffer_load_dwordx4 v[36:39], v22, s[16:19], s56 offen offset:1280 sc1
  buffer_load_dwordx4 v[44:47], v28, s[16:19], s56 offen offset:1280 sc1
  buffer_load_dwordx2 v[186:187], v14, s[16:19], s56 offen offset:1792 sc1
  s_add_u32 s56, s56, 262144
  buffer_load_dwordx4 v[48:51], v22, s[16:19], s56 offen offset:0 sc1
  buffer_load_dwordx4 v[56:59], v28, s[16:19], s56 offen offset:0 sc1
  buffer_load_dwordx2 v[188:189], v14, s[16:19], s56 offen offset:512 sc1
  buffer_load_dwordx4 v[52:55], v22, s[16:19], s56 offen offset:1280 sc1
  buffer_load_dwordx4 v[60:63], v28, s[16:19], s56 offen offset:1280 sc1
  buffer_load_dwordx2 v[190:191], v14, s[16:19], s56 offen offset:1792 sc1
  s_add_u32 s56, s56, 262144
  s_mov_b32 s101, 0
  s_branch pvr_327
pvr_326:
  s_sleep 6
  s_mov_b32 s56, s48
  buffer_load_dwordx4 v[32:35], v22, s[16:19], s56 offen offset:0 sc1
  buffer_load_dwordx4 v[40:43], v28, s[16:19], s56 offen offset:0 sc1
  buffer_load_dwordx2 v[184:185], v14, s[16:19], s56 offen offset:512 sc1
  buffer_load_dwordx4 v[36:39], v22, s[16:19], s56 offen offset:1280 sc1
  buffer_load_dwordx4 v[44:47], v28, s[16:19], s56 offen offset:1280 sc1
  buffer_load_dwordx2 v[186:187], v14, s[16:19], s56 offen offset:1792 sc1
  s_add_u32 s56, s56, 262144
  buffer_load_dwordx4 v[48:51], v22, s[16:19], s56 offen offset:0 sc1
  buffer_load_dwordx4 v[56:59], v28, s[16:19], s56 offen offset:0 sc1
  buffer_load_dwordx2 v[188:189], v14, s[16:19], s56 offen offset:512 sc1
  buffer_load_dwordx4 v[52:55], v22, s[16:19], s56 offen offset:1280 sc1
  buffer_load_dwordx4 v[60:63], v28, s[16:19], s56 offen offset:1280 sc1
  buffer_load_dwordx2 v[190:191], v14, s[16:19], s56 offen offset:1792 sc1
  s_add_u32 s56, s56, 262144
  s_add_u32 s101, s101, 1
  s_cmp_gt_u32 s101, 131072
  s_cbranch_scc1 main_end
pvr_327:
  s_waitcnt vmcnt(0)
  v_max3_u32 v26, v32, v36, v40
  v_max3_u32 v26, v26, v44, v184
  v_max3_u32 v26, v26, v186, v48
  v_max3_u32 v26, v26, v52, v56
  v_max3_u32 v26, v26, v60, v188
  v_max3_u32 v26, v26, v190, v190
  v_cmp_eq_u32 vcc, -1, v26
  s_nop 1
  s_cbranch_vccnz pvr_326
  s_add_u32 s56, s47, 0
  buffer_load_dwordx4 v[64:67], v4, s[16:19], s56 offen sc1
  buffer_load_dwordx2 v[68:69], v5, s[16:19], s56 offen offset:2048 sc1
  buffer_load_dwordx4 v[128:131], v21, s[16:19], s56 offen offset:1024 sc1
  s_add_u32 s56, s56, 2560
  buffer_load_dwordx4 v[72:75], v4, s[16:19], s56 offen sc1
  buffer_load_dwordx2 v[76:77], v5, s[16:19], s56 offen offset:2048 sc1
  s_add_u32 s56, s56, 13824
  buffer_load_dwordx4 v[80:83], v4, s[16:19], s56 offen sc1
  buffer_load_dwordx2 v[84:85], v5, s[16:19], s56 offen offset:2048 sc1
  buffer_load_dwordx4 v[132:135], v21, s[16:19], s56 offen offset:1024 sc1
  s_add_u32 s56, s56, 2560
  buffer_load_dwordx4 v[88:91], v4, s[16:19], s56 offen sc1
  buffer_load_dwordx2 v[92:93], v5, s[16:19], s56 offen offset:2048 sc1
  s_add_u32 s56, s56, 13824
  s_mov_b32 s101, 0
  s_branch pvr_329
pvr_328:
  s_sleep 2
  s_add_u32 s56, s47, 0
  buffer_load_dwordx4 v[64:67], v4, s[16:19], s56 offen sc1
  buffer_load_dwordx2 v[68:69], v5, s[16:19], s56 offen offset:2048 sc1
  buffer_load_dwordx4 v[128:131], v21, s[16:19], s56 offen offset:1024 sc1
  s_add_u32 s56, s56, 2560
  buffer_load_dwordx4 v[72:75], v4, s[16:19], s56 offen sc1
  buffer_load_dwordx2 v[76:77], v5, s[16:19], s56 offen offset:2048 sc1
  s_add_u32 s56, s56, 13824
  buffer_load_dwordx4 v[80:83], v4, s[16:19], s56 offen sc1
  buffer_load_dwordx2 v[84:85], v5, s[16:19], s56 offen offset:2048 sc1
  buffer_load_dwordx4 v[132:135], v21, s[16:19], s56 offen offset:1024 sc1
  s_add_u32 s56, s56, 2560
  buffer_load_dwordx4 v[88:91], v4, s[16:19], s56 offen sc1
  buffer_load_dwordx2 v[92:93], v5, s[16:19], s56 offen offset:2048 sc1
  s_add_u32 s56, s56, 13824
  s_add_u32 s101, s101, 1
  s_cmp_gt_u32 s101, 131072
  s_cbranch_scc1 main_end
pvr_329:
  s_waitcnt vmcnt(0)
  v_max3_u32 v26, v64, v68, v72
  v_max3_u32 v26, v26, v76, v80
  v_max3_u32 v26, v26, v84, v88
  v_max3_u32 v26, v26, v92, v128
  v_max3_u32 v26, v26, v132, v132
  v_cmp_eq_u32 vcc, -1, v26
  s_nop 1
  s_cbranch_vccnz pvr_328
  s_add_u32 s56, s47, 32768
  buffer_load_dwordx4 v[96:99], v4, s[16:19], s56 offen sc1
  buffer_load_dwordx2 v[100:101], v5, s[16:19], s56 offen offset:2048 sc1
  buffer_load_dwordx4 v[136:139], v21, s[16:19], s56 offen offset:1024 sc1
  s_add_u32 s56, s56, 2560
  buffer_load_dwordx4 v[104:107], v4, s[16:19], s56 offen sc1
  buffer_load_dwordx2 v[108:109], v5, s[16:19], s56 offen offset:2048 sc1
  s_add_u32 s56, s56, 13824
  buffer_load_dwordx4 v[112:115], v4, s[16:19], s56 offen sc1
  buffer_load_dwordx2 v[116:117], v5, s[16:19], s56 offen offset:2048 sc1
  buffer_load_dwordx4 v[140:143], v21, s[16:19], s56 offen offset:1024 sc1
  s_add_u32 s56, s56, 2560
  buffer_load_dwordx4 v[120:123], v4, s[16:19], s56 offen sc1
  buffer_load_dwordx2 v[124:125], v5, s[16:19], s56 offen offset:2048 sc1
  s_add_u32 s56, s56, 13824
  v_mfma_f32_16x16x32_bf16 v[148:151], a[0:3], v[64:67], 0
  v_mfma_f32_16x16x32_bf16 v[144:147], a[0:3], v[68:71], 0
  v_mfma_f32_16x16x32_bf16 v[156:159], a[4:7], v[64:67], 0
  v_mfma_f32_16x16x32_bf16 v[152:155], a[4:7], v[68:71], 0
  v_mfma_f32_16x16x32_bf16 v[164:167], a[8:11], v[64:67], 0
  v_mfma_f32_16x16x32_bf16 v[160:163], a[8:11], v[68:71], 0
  v_mfma_f32_16x16x32_bf16 v[172:175], a[12:15], v[64:67], 0
  v_mfma_f32_16x16x32_bf16 v[168:171], a[12:15], v[68:71], 0
  v_mfma_f32_16x16x32_bf16 v[180:183], a[16:19], v[64:67], 0
  v_mfma_f32_16x16x32_bf16 v[176:179], a[16:19], v[68:71], 0
  v_mfma_f32_16x16x32_bf16 v[148:151], a[20:23], v[72:75], v[148:151]
  v_mfma_f32_16x16x32_bf16 v[144:147], a[20:23], v[76:79], v[144:147]
  v_mfma_f32_16x16x32_bf16 v[156:159], a[24:27], v[72:75], v[156:159]
  v_mfma_f32_16x16x32_bf16 v[152:155], a[24:27], v[76:79], v[152:155]
  v_mfma_f32_16x16x32_bf16 v[164:167], a[28:31], v[72:75], v[164:167]
  v_mfma_f32_16x16x32_bf16 v[160:163], a[28:31], v[76:79], v[160:163]
  v_mfma_f32_16x16x32_bf16 v[172:175], a[32:35], v[72:75], v[172:175]
  v_mfma_f32_16x16x32_bf16 v[168:171], a[32:35], v[76:79], v[168:171]
  v_mfma_f32_16x16x32_bf16 v[180:183], a[36:39], v[72:75], v[180:183]
  v_mfma_f32_16x16x32_bf16 v[176:179], a[36:39], v[76:79], v[176:179]
  v_mfma_f32_16x16x32_bf16 v[148:151], a[40:43], v[80:83], v[148:151]
  v_mfma_f32_16x16x32_bf16 v[144:147], a[40:43], v[84:87], v[144:147]
  v_mfma_f32_16x16x32_bf16 v[156:159], a[44:47], v[80:83], v[156:159]
  v_mfma_f32_16x16x32_bf16 v[152:155], a[44:47], v[84:87], v[152:155]
  v_mfma_f32_16x16x32_bf16 v[164:167], a[48:51], v[80:83], v[164:167]
  v_mfma_f32_16x16x32_bf16 v[160:163], a[48:51], v[84:87], v[160:163]
  v_mfma_f32_16x16x32_bf16 v[172:175], a[52:55], v[80:83], v[172:175]
  v_mfma_f32_16x16x32_bf16 v[168:171], a[52:55], v[84:87], v[168:171]
  v_mfma_f32_16x16x32_bf16 v[180:183], a[56:59], v[80:83], v[180:183]
  v_mfma_f32_16x16x32_bf16 v[176:179], a[56:59], v[84:87], v[176:179]
  v_mfma_f32_16x16x32_bf16 v[148:151], a[60:63], v[88:91], v[148:151]
  v_mfma_f32_16x16x32_bf16 v[144:147], a[60:63], v[92:95], v[144:147]
  v_mfma_f32_16x16x32_bf16 v[156:159], a[64:67], v[88:91], v[156:159]
  v_mfma_f32_16x16x32_bf16 v[152:155], a[64:67], v[92:95], v[152:155]
  v_mfma_f32_16x16x32_bf16 v[164:167], a[68:71], v[88:91], v[164:167]
  v_mfma_f32_16x16x32_bf16 v[160:163], a[68:71], v[92:95], v[160:163]
  v_mfma_f32_16x16x32_bf16 v[172:175], a[72:75], v[88:91], v[172:175]
  v_mfma_f32_16x16x32_bf16 v[168:171], a[72:75], v[92:95], v[168:171]
  v_mfma_f32_16x16x32_bf16 v[180:183], a[76:79], v[88:91], v[180:183]
  v_mfma_f32_16x16x32_bf16 v[176:179], a[76:79], v[92:95], v[176:179]
  v_swap_b32 v130, v132
  v_swap_b32 v131, v133
  v_swap_b32 v34, v36
  v_swap_b32 v35, v37
  v_swap_b32 v42, v44
  v_swap_b32 v43, v45
  s_nop 1
  v_mfma_f32_16x16x32_bf16 v[144:147], v[32:35], v[128:131], v[144:147]
  v_mfma_f32_16x16x32_bf16 v[148:151], v[32:35], v[132:135], v[148:151]
  v_mfma_f32_16x16x32_bf16 v[152:155], v[36:39], v[128:131], v[152:155]
  v_mfma_f32_16x16x32_bf16 v[156:159], v[36:39], v[132:135], v[156:159]
  v_mfma_f32_16x16x32_bf16 v[160:163], v[184:187], v[128:131], v[160:163]
  v_mfma_f32_16x16x32_bf16 v[164:167], v[184:187], v[132:135], v[164:167]
  v_mfma_f32_16x16x32_bf16 v[168:171], v[40:43], v[128:131], v[168:171]
  v_mfma_f32_16x16x32_bf16 v[172:175], v[40:43], v[132:135], v[172:175]
  v_mfma_f32_16x16x32_bf16 v[176:179], v[44:47], v[128:131], v[176:179]
  v_mfma_f32_16x16x32_bf16 v[180:183], v[44:47], v[132:135], v[180:183]
  s_mov_b32 s101, 0
  s_branch pvr_331
pvr_330:
  s_sleep 1
  s_add_u32 s56, s47, 32768
  buffer_load_dwordx4 v[96:99], v4, s[16:19], s56 offen sc1
  buffer_load_dwordx2 v[100:101], v5, s[16:19], s56 offen offset:2048 sc1
  buffer_load_dwordx4 v[136:139], v21, s[16:19], s56 offen offset:1024 sc1
  s_add_u32 s56, s56, 2560
  buffer_load_dwordx4 v[104:107], v4, s[16:19], s56 offen sc1
  buffer_load_dwordx2 v[108:109], v5, s[16:19], s56 offen offset:2048 sc1
  s_add_u32 s56, s56, 13824
  buffer_load_dwordx4 v[112:115], v4, s[16:19], s56 offen sc1
  buffer_load_dwordx2 v[116:117], v5, s[16:19], s56 offen offset:2048 sc1
  buffer_load_dwordx4 v[140:143], v21, s[16:19], s56 offen offset:1024 sc1
  s_add_u32 s56, s56, 2560
  buffer_load_dwordx4 v[120:123], v4, s[16:19], s56 offen sc1
  buffer_load_dwordx2 v[124:125], v5, s[16:19], s56 offen offset:2048 sc1
  s_add_u32 s56, s56, 13824
  s_add_u32 s101, s101, 1
  s_cmp_gt_u32 s101, 131072
  s_cbranch_scc1 main_end
pvr_331:
  s_waitcnt vmcnt(0)
  v_max3_u32 v26, v96, v100, v104
  v_max3_u32 v26, v26, v108, v112
  v_max3_u32 v26, v26, v116, v120
  v_max3_u32 v26, v26, v124, v136
  v_max3_u32 v26, v26, v140, v140
  v_cmp_eq_u32 vcc, -1, v26
  s_nop 1
  s_cbranch_vccnz pvr_330
  v_mfma_f32_16x16x32_bf16 v[148:151], a[80:83], v[96:99], v[148:151]
  v_mfma_f32_16x16x32_bf16 v[144:147], a[80:83], v[100:103], v[144:147]
  v_mfma_f32_16x16x32_bf16 v[156:159], a[84:87], v[96:99], v[156:159]
  v_mfma_f32_16x16x32_bf16 v[152:155], a[84:87], v[100:103], v[152:155]
  v_mfma_f32_16x16x32_bf16 v[164:167], a[88:91], v[96:99], v[164:167]
  v_mfma_f32_16x16x32_bf16 v[160:163], a[88:91], v[100:103], v[160:163]
  v_mfma_f32_16x16x32_bf16 v[172:175], a[92:95], v[96:99], v[172:175]
  v_mfma_f32_16x16x32_bf16 v[168:171], a[92:95], v[100:103], v[168:171]
  v_mfma_f32_16x16x32_bf16 v[180:183], a[96:99], v[96:99], v[180:183]
  v_mfma_f32_16x16x32_bf16 v[176:179], a[96:99], v[100:103], v[176:179]
  v_mfma_f32_16x16x32_bf16 v[148:151], a[100:103], v[104:107], v[148:151]
  v_mfma_f32_16x16x32_bf16 v[144:147], a[100:103], v[108:111], v[144:147]
  v_mfma_f32_16x16x32_bf16 v[156:159], a[104:107], v[104:107], v[156:159]
  v_mfma_f32_16x16x32_bf16 v[152:155], a[104:107], v[108:111], v[152:155]
  v_mfma_f32_16x16x32_bf16 v[164:167], a[108:111], v[104:107], v[164:167]
  v_mfma_f32_16x16x32_bf16 v[160:163], a[108:111], v[108:111], v[160:163]
  v_mfma_f32_16x16x32_bf16 v[172:175], a[112:115], v[104:107], v[172:175]
  v_mfma_f32_16x16x32_bf16 v[168:171], a[112:115], v[108:111], v[168:171]
  v_mfma_f32_16x16x32_bf16 v[180:183], a[116:119], v[104:107], v[180:183]
  v_mfma_f32_16x16x32_bf16 v[176:179], a[116:119], v[108:111], v[176:179]
  v_mfma_f32_16x16x32_bf16 v[148:151], a[120:123], v[112:115], v[148:151]
  v_mfma_f32_16x16x32_bf16 v[144:147], a[120:123], v[116:119], v[144:147]
  v_mfma_f32_16x16x32_bf16 v[156:159], a[124:127], v[112:115], v[156:159]
  v_mfma_f32_16x16x32_bf16 v[152:155], a[124:127], v[116:119], v[152:155]
  v_mfma_f32_16x16x32_bf16 v[164:167], a[128:131], v[112:115], v[164:167]
  v_mfma_f32_16x16x32_bf16 v[160:163], a[128:131], v[116:119], v[160:163]
  v_mfma_f32_16x16x32_bf16 v[172:175], a[132:135], v[112:115], v[172:175]
  v_mfma_f32_16x16x32_bf16 v[168:171], a[132:135], v[116:119], v[168:171]
  v_mfma_f32_16x16x32_bf16 v[180:183], a[136:139], v[112:115], v[180:183]
  v_mfma_f32_16x16x32_bf16 v[176:179], a[136:139], v[116:119], v[176:179]
  v_mfma_f32_16x16x32_bf16 v[148:151], a[140:143], v[120:123], v[148:151]
  v_mfma_f32_16x16x32_bf16 v[144:147], a[140:143], v[124:127], v[144:147]
  v_mfma_f32_16x16x32_bf16 v[156:159], a[144:147], v[120:123], v[156:159]
  v_mfma_f32_16x16x32_bf16 v[152:155], a[144:147], v[124:127], v[152:155]
  v_mfma_f32_16x16x32_bf16 v[164:167], a[148:151], v[120:123], v[164:167]
  v_mfma_f32_16x16x32_bf16 v[160:163], a[148:151], v[124:127], v[160:163]
  v_mfma_f32_16x16x32_bf16 v[172:175], a[152:155], v[120:123], v[172:175]
  v_mfma_f32_16x16x32_bf16 v[168:171], a[152:155], v[124:127], v[168:171]
  v_mfma_f32_16x16x32_bf16 v[180:183], a[156:159], v[120:123], v[180:183]
  v_mfma_f32_16x16x32_bf16 v[176:179], a[156:159], v[124:127], v[176:179]
  v_swap_b32 v138, v140
  v_swap_b32 v139, v141
  v_swap_b32 v50, v52
  v_swap_b32 v51, v53
  v_swap_b32 v58, v60
  v_swap_b32 v59, v61
  s_nop 1
  v_mfma_f32_16x16x32_bf16 v[144:147], v[48:51], v[136:139], v[144:147]
  v_mfma_f32_16x16x32_bf16 v[148:151], v[48:51], v[140:143], v[148:151]
  v_mfma_f32_16x16x32_bf16 v[152:155], v[52:55], v[136:139], v[152:155]
  v_mfma_f32_16x16x32_bf16 v[156:159], v[52:55], v[140:143], v[156:159]
  v_mfma_f32_16x16x32_bf16 v[160:163], v[188:191], v[136:139], v[160:163]
  v_mfma_f32_16x16x32_bf16 v[164:167], v[188:191], v[140:143], v[164:167]
  v_mfma_f32_16x16x32_bf16 v[168:171], v[56:59], v[136:139], v[168:171]
  v_mfma_f32_16x16x32_bf16 v[172:175], v[56:59], v[140:143], v[172:175]
  v_mfma_f32_16x16x32_bf16 v[176:179], v[60:63], v[136:139], v[176:179]
  v_mfma_f32_16x16x32_bf16 v[180:183], v[60:63], v[140:143], v[180:183]
pve_315:
  s_nop 0
  ds_write_b128 v10, v[144:147] offset:0
  ds_write_b128 v10, v[148:151] offset:1024
  ds_write_b128 v10, v[152:155] offset:2048
  ds_write_b128 v10, v[156:159] offset:3072
  ds_write_b128 v10, v[160:163] offset:4096
  ds_write_b128 v10, v[164:167] offset:5120
  ds_write_b128 v10, v[168:171] offset:6144
  ds_write_b128 v10, v[172:175] offset:7168
  s_nop 1
  ds_write_b128 v10, v[176:179] offset:8192
  ds_write_b128 v10, v[180:183] offset:9216
  s_cmp_ge_u32 s2, 16
  s_cbranch_scc1 pv_318
  s_waitcnt vmcnt(14)
  s_add_u32 s23, s40, 1
  s_cmp_ge_u32 s50, s23
  s_cbranch_scc1 pv_332
  s_mov_b32 s101, 0
wm_335:
  buffer_load_dword v8, v31, s[72:75], s51 offen sc1
  s_add_u32 s101, s101, 1
  s_cmp_gt_u32 s101, 131072
  s_cbranch_scc1 main_end
  s_waitcnt vmcnt(0)
  v_cmp_gt_u32 vcc, s23, v8
  v_readfirstlane_b32 s100, v8
  s_nop 0
  s_cbranch_vccz wm_336
  s_sleep 8
  s_add_u32 s100, s100, 2
  s_cmp_ge_u32 s100, s23
  s_cbranch_scc1 wm_335
  s_sleep 60
  s_branch wm_335
wm_336:
  v_readlane_b32 s50, v8, 0
  v_readlane_b32 s21, v8, 1
  s_min_u32 s50, s50, s21
  v_readlane_b32 s21, v8, 2
  s_min_u32 s50, s50, s21
  v_readlane_b32 s21, v8, 3
  s_min_u32 s50, s50, s21
  v_readlane_b32 s21, v8, 4
  s_min_u32 s50, s50, s21
  v_readlane_b32 s21, v8, 5
  s_min_u32 s50, s50, s21
  v_readlane_b32 s21, v8, 6
  s_min_u32 s50, s50, s21
  v_readlane_b32 s21, v8, 7
  s_min_u32 s50, s50, s21
  v_readlane_b32 s21, v8, 8
  s_min_u32 s50, s50, s21
  v_readlane_b32 s21, v8, 9
  s_min_u32 s50, s50, s21
  v_readlane_b32 s21, v8, 10
  s_min_u32 s50, s50, s21
  v_readlane_b32 s21, v8, 11
  s_min_u32 s50, s50, s21
  v_readlane_b32 s21, v8, 12
  s_min_u32 s50, s50, s21
  v_readlane_b32 s21, v8, 13
  s_min_u32 s50, s50, s21
  v_readlane_b32 s21, v8, 14
  s_min_u32 s50, s50, s21
  v_readlane_b32 s21, v8, 15
  s_min_u32 s50, s50, s21
  v_readlane_b32 s21, v8, 16
  s_min_u32 s50, s50, s21
  v_readlane_b32 s21, v8, 17
  s_min_u32 s50, s50, s21
  v_readlane_b32 s21, v8, 18
  s_min_u32 s50, s50, s21
  v_readlane_b32 s21, v8, 19
  s_min_u32 s50, s50, s21
  v_readlane_b32 s21, v8, 20
  s_min_u32 s50, s50, s21
  v_readlane_b32 s21, v8, 21
  s_min_u32 s50, s50, s21
  v_readlane_b32 s21, v8, 22
  s_min_u32 s50, s50, s21
  v_readlane_b32 s21, v8, 23
  s_min_u32 s50, s50, s21
  v_readlane_b32 s21, v8, 24
  s_min_u32 s50, s50, s21
  v_readlane_b32 s21, v8, 25
  s_min_u32 s50, s50, s21
  v_readlane_b32 s21, v8, 26
  s_min_u32 s50, s50, s21
  v_readlane_b32 s21, v8, 27
  s_min_u32 s50, s50, s21
  v_readlane_b32 s21, v8, 28
  s_min_u32 s50, s50, s21
  v_readlane_b32 s21, v8, 29
  s_min_u32 s50, s50, s21
  v_readlane_b32 s21, v8, 30
  s_min_u32 s50, s50, s21
  v_readlane_b32 s21, v8, 31
  s_min_u32 s50, s50, s21
pv_332:
  v_cmp_gt_u32 vcc, v19, v27
  s_lshl_b32 s61, s40, 21
  s_lshl_b32 s21, s40, 13
  s_and_b32 s21, s21, 8192
  s_xor_b32 s21, s21, s80
  s_add_u32 s61, s61, s21
  s_lshl_b32 s21, s20, 15
  s_add_u32 s47, s54, s21
  s_add_u32 s48, s61, s60
  s_xor_b32 s68, s61, 8192
  s_add_u32 s68, s68, s53
  s_add_u32 s70, s55, s42
  s_xor_b32 s70, s70, 0
  s_mov_b32 s62, 0
  s_cbranch_vccnz pv_333
  s_mov_b32 s62, 1
  buffer_load_dwordx4 a[0:3], v4, s[16:19], s68 offen offset:0 sc1
  buffer_load_dwordx4 a[4:7], v4, s[16:19], s68 offen offset:1024 sc1
  buffer_load_dwordx4 v[32:35], v22, s[16:19], s48 offen offset:0 sc1
  buffer_load_dwordx4 a[8:11], v4, s[16:19], s70 offen sc1
  s_add_u32 s70, s70, 16384
  buffer_load_dwordx4 a[12:15], v4, s[16:19], s68 offen offset:2048 sc1
  buffer_load_dwordx4 a[16:19], v4, s[16:19], s68 offen offset:3072 sc1
  s_add_u32 s68, s68, 65536
  buffer_load_dwordx4 v[64:67], v4, s[16:19], s47 offen sc1
  buffer_load_dwordx2 v[68:69], v5, s[16:19], s47 offen offset:2048 sc1
  buffer_load_dwordx4 v[128:131], v21, s[16:19], s47 offen offset:1024 sc1
  s_add_u32 s47, s47, 2560
  buffer_load_dwordx4 a[20:23], v4, s[16:19], s68 offen offset:0 sc1
  buffer_load_dwordx4 a[24:27], v4, s[16:19], s68 offen offset:1024 sc1
  buffer_load_dwordx4 v[40:43], v28, s[16:19], s48 offen offset:0 sc1
  buffer_load_dwordx4 a[28:31], v4, s[16:19], s70 offen sc1
  s_add_u32 s70, s70, 16384
  buffer_load_dwordx4 a[32:35], v4, s[16:19], s68 offen offset:2048 sc1
  buffer_load_dwordx4 a[36:39], v4, s[16:19], s68 offen offset:3072 sc1
  s_add_u32 s68, s68, 65536
  buffer_load_dwordx2 v[184:185], v14, s[16:19], s48 offen offset:512 sc1
  buffer_load_dwordx4 v[72:75], v4, s[16:19], s47 offen sc1
  buffer_load_dwordx2 v[76:77], v5, s[16:19], s47 offen offset:2048 sc1
  s_add_u32 s47, s47, 13824
  buffer_load_dwordx4 a[40:43], v4, s[16:19], s68 offen offset:0 sc1
  buffer_load_dwordx4 a[44:47], v4, s[16:19], s68 offen offset:1024 sc1
  buffer_load_dwordx4 v[36:39], v22, s[16:19], s48 offen offset:1280 sc1
  buffer_load_dwordx4 a[48:51], v4, s[16:19], s70 offen sc1
  s_add_u32 s70, s70, 16384
  buffer_load_dwordx4 a[52:55], v4, s[16:19], s68 offen offset:2048 sc1
  buffer_load_dwordx4 a[56:59], v4, s[16:19], s68 offen offset:3072 sc1
  s_add_u32 s68, s68, 65536
  buffer_load_dwordx4 v[80:83], v4, s[16:19], s47 offen sc1
  buffer_load_dwordx2 v[84:85], v5, s[16:19], s47 offen offset:2048 sc1
  buffer_load_dwordx4 v[132:135], v21, s[16:19], s47 offen offset:1024 sc1
  s_add_u32 s47, s47, 2560
  buffer_load_dwordx4 a[60:63], v4, s[16:19], s68 offen offset:0 sc1
  buffer_load_dwordx4 a[64:67], v4, s[16:19], s68 offen offset:1024 sc1
  buffer_load_dwordx4 v[44:47], v28, s[16:19], s48 offen offset:1280 sc1
  buffer_load_dwordx4 a[68:71], v4, s[16:19], s70 offen sc1
  s_add_u32 s70, s70, 16384
  buffer_load_dwordx4 a[72:75], v4, s[16:19], s68 offen offset:2048 sc1
  buffer_load_dwordx4 a[76:79], v4, s[16:19], s68 offen offset:3072 sc1
  s_add_u32 s68, s68, 65536
  buffer_load_dwordx2 v[186:187], v14, s[16:19], s48 offen offset:1792 sc1
  s_add_u32 s48, s48, 262144
  buffer_load_dwordx4 v[88:91], v4, s[16:19], s47 offen sc1
  buffer_load_dwordx2 v[92:93], v5, s[16:19], s47 offen offset:2048 sc1
  s_add_u32 s47, s47, 13824
  s_branch pv_334
pv_333:
  buffer_load_dwordx4 a[0:3], v4, s[16:19], s68 offen offset:0 sc1
  buffer_load_dwordx4 a[4:7], v4, s[16:19], s68 offen offset:1024 sc1
  buffer_load_dwordx4 a[8:11], v4, s[16:19], s70 offen sc1
  s_add_u32 s70, s70, 16384
  buffer_load_dwordx4 a[12:15], v4, s[16:19], s68 offen offset:2048 sc1
  buffer_load_dwordx4 a[16:19], v4, s[16:19], s68 offen offset:3072 sc1
  s_add_u32 s68, s68, 65536
  buffer_load_dwordx4 a[20:23], v4, s[16:19], s68 offen offset:0 sc1
  buffer_load_dwordx4 a[24:27], v4, s[16:19], s68 offen offset:1024 sc1
  buffer_load_dwordx4 a[28:31], v4, s[16:19], s70 offen sc1
  s_add_u32 s70, s70, 16384
  buffer_load_dwordx4 a[32:35], v4, s[16:19], s68 offen offset:2048 sc1
  buffer_load_dwordx4 a[36:39], v4, s[16:19], s68 offen offset:3072 sc1
  s_add_u32 s68, s68, 65536
  buffer_load_dwordx4 a[40:43], v4, s[16:19], s68 offen offset:0 sc1
  buffer_load_dwordx4 a[44:47], v4, s[16:19], s68 offen offset:1024 sc1
  buffer_load_dwordx4 a[48:51], v4, s[16:19], s70 offen sc1
  s_add_u32 s70, s70, 16384
  buffer_load_dwordx4 a[52:55], v4, s[16:19], s68 offen offset:2048 sc1
  buffer_load_dwordx4 a[56:59], v4, s[16:19], s68 offen offset:3072 sc1
  s_add_u32 s68, s68, 65536
  buffer_load_dwordx4 a[60:63], v4, s[16:19], s68 offen offset:0 sc1
  buffer_load_dwordx4 a[64:67], v4, s[16:19], s68 offen offset:1024 sc1
  buffer_load_dwordx4 a[68:71], v4, s[16:19], s70 offen sc1
  s_add_u32 s70, s70, 16384
  buffer_load_dwordx4 a[72:75], v4, s[16:19], s68 offen offset:2048 sc1
  buffer_load_dwordx4 a[76:79], v4, s[16:19], s68 offen offset:3072 sc1
  s_add_u32 s68, s68, 65536
  buffer_load_dwordx4 a[80:83], v4, s[16:19], s68 offen offset:0 sc1
  buffer_load_dwordx4 a[84:87], v4, s[16:19], s68 offen offset:1024 sc1
  buffer_load_dwordx4 a[88:91], v4, s[16:19], s70 offen sc1
  s_add_u32 s70, s70, 16384
  buffer_load_dwordx4 a[92:95], v4, s[16:19], s68 offen offset:2048 sc1
  buffer_load_dwordx4 a[96:99], v4, s[16:19], s68 offen offset:3072 sc1
  s_add_u32 s68, s68, 65536
  buffer_load_dwordx4 a[100:103], v4, s[16:19], s68 offen offset:0 sc1
  buffer_load_dwordx4 a[104:107], v4, s[16:19], s68 offen offset:1024 sc1
  buffer_load_dwordx4 a[108:111], v4, s[16:19], s70 offen sc1
  s_add_u32 s70, s70, 16384
  buffer_load_dwordx4 a[112:115], v4, s[16:19], s68 offen offset:2048 sc1
  buffer_load_dwordx4 a[116:119], v4, s[16:19], s68 offen offset:3072 sc1
  s_add_u32 s68, s68, 65536
  buffer_load_dwordx4 a[120:123], v4, s[16:19], s68 offen offset:0 sc1
  buffer_load_dwordx4 a[124:127], v4, s[16:19], s68 offen offset:1024 sc1
  buffer_load_dwordx4 a[128:131], v4, s[16:19], s70 offen sc1
  s_add_u32 s70, s70, 16384
  buffer_load_dwordx4 a[132:135], v4, s[16:19], s68 offen offset:2048 sc1
  buffer_load_dwordx4 a[136:139], v4, s[16:19], s68 offen offset:3072 sc1
  s_add_u32 s68, s68, 65536
  buffer_load_dwordx4 a[140:143], v4, s[16:19], s68 offen offset:0 sc1
  buffer_load_dwordx4 a[144:147], v4, s[16:19], s68 offen offset:1024 sc1
  buffer_load_dwordx4 a[148:151], v4, s[16:19], s70 offen sc1
  s_add_u32 s70, s70, 16384
  buffer_load_dwordx4 a[152:155], v4, s[16:19], s68 offen offset:2048 sc1
  buffer_load_dwordx4 a[156:159], v4, s[16:19], s68 offen offset:3072 sc1
  s_add_u32 s68, s68, 65536
pv_334:
pv_318:
  s_waitcnt lgkmcnt(0)
  s_barrier
  ds_read_b128 v[144:147], v11 offset:0
  ds_read_b128 v[148:151], v11 offset:10240
  ds_read_b128 v[152:155], v11 offset:20480
  ds_read_b128 v[156:159], v11 offset:30720
  ds_read_b128 v[160:163], v11 offset:2048
  ds_read_b128 v[164:167], v11 offset:12288
  ds_read_b128 v[168:171], v11 offset:22528
  ds_read_b128 v[172:175], v11 offset:32768
  s_waitcnt lgkmcnt(4)
  v_pk_add_f32 v[144:145], v[144:145], v[148:149]
  v_pk_add_f32 v[152:153], v[152:153], v[156:157]
  v_pk_add_f32 v[146:147], v[146:147], v[150:151]
  v_pk_add_f32 v[154:155], v[154:155], v[158:159]
  v_pk_add_f32 v[176:177], v[144:145], v[152:153]
  v_pk_add_f32 v[178:179], v[146:147], v[154:155]
  ds_read_b128 v[144:147], v12 offset:0
  ds_read_b128 v[148:151], v12 offset:10240
  ds_read_b128 v[152:155], v12 offset:20480
  ds_read_b128 v[156:159], v12 offset:30720
  v_cvt_pk_bf16_f32 v26, v176, v177
  v_lshlrev_b32 v176, 16, v26
  v_and_b32 v177, 0xffff0000, v26
  v_mul_f32 v176, v176, v24
  v_mul_f32 v177, v177, v24
  v_cvt_pk_bf16_f32 v26, v176, v177
  v_lshlrev_b32 v176, 16, v26
  v_and_b32 v177, 0xffff0000, v26
  v_add_f32 v176, v176, v240
  v_add_f32 v177, v177, v241
  v_cvt_pk_bf16_f32 v236, v176, v177
  v_cvt_pk_bf16_f32 v26, v178, v179
  v_lshlrev_b32 v178, 16, v26
  v_and_b32 v179, 0xffff0000, v26
  v_mul_f32 v178, v178, v24
  v_mul_f32 v179, v179, v24
  v_cvt_pk_bf16_f32 v26, v178, v179
  v_lshlrev_b32 v178, 16, v26
  v_and_b32 v179, 0xffff0000, v26
  v_add_f32 v178, v178, v242
  v_add_f32 v179, v179, v243
  v_cvt_pk_bf16_f32 v237, v178, v179
  s_waitcnt lgkmcnt(4)
  v_pk_add_f32 v[160:161], v[160:161], v[164:165]
  v_pk_add_f32 v[168:169], v[168:169], v[172:173]
  v_pk_add_f32 v[162:163], v[162:163], v[166:167]
  v_pk_add_f32 v[170:171], v[170:171], v[174:175]
  v_pk_add_f32 v[176:177], v[160:161], v[168:169]
  v_pk_add_f32 v[178:179], v[162:163], v[170:171]
  v_cvt_pk_bf16_f32 v26, v176, v177
  v_lshlrev_b32 v176, 16, v26
  v_and_b32 v177, 0xffff0000, v26
  v_mul_f32 v176, v176, v24
  v_mul_f32 v177, v177, v24
  v_cvt_pk_bf16_f32 v26, v176, v177
  v_lshlrev_b32 v176, 16, v26
  v_and_b32 v177, 0xffff0000, v26
  v_add_f32 v176, v176, v244
  v_add_f32 v177, v177, v245
  v_cvt_pk_bf16_f32 v238, v176, v177
  v_cvt_pk_bf16_f32 v26, v178, v179
  v_lshlrev_b32 v178, 16, v26
  v_and_b32 v179, 0xffff0000, v26
  v_mul_f32 v178, v178, v24
  v_mul_f32 v179, v179, v24
  v_cvt_pk_bf16_f32 v26, v178, v179
  v_lshlrev_b32 v178, 16, v26
  v_and_b32 v179, 0xffff0000, v26
  v_add_f32 v178, v178, v246
  v_add_f32 v179, v179, v247
  v_cvt_pk_bf16_f32 v239, v178, v179
  buffer_store_dwordx4 v[236:239], v9, s[8:11], s46 offen
  s_cmp_lt_u32 s20, 2
  s_cselect_b32 s49, s49, 0x40000000
  s_waitcnt lgkmcnt(0)
  v_pk_add_f32 v[144:145], v[144:145], v[148:149]
  v_pk_add_f32 v[152:153], v[152:153], v[156:157]
  v_pk_add_f32 v[146:147], v[146:147], v[150:151]
  v_pk_add_f32 v[154:155], v[154:155], v[158:159]
  v_pk_add_f32 v[176:177], v[144:145], v[152:153]
  v_pk_add_f32 v[178:179], v[146:147], v[154:155]
  v_cvt_pk_bf16_f32 v26, v176, v177
  v_lshlrev_b32 v176, 16, v26
  v_and_b32 v177, 0xffff0000, v26
  v_mul_f32 v176, v176, v24
  v_mul_f32 v177, v177, v24
  v_cvt_pk_bf16_f32 v26, v176, v177
  v_lshlrev_b32 v176, 16, v26
  v_and_b32 v177, 0xffff0000, v26
  v_add_f32 v176, v176, v248
  v_add_f32 v177, v177, v249
  v_cvt_pk_bf16_f32 v234, v176, v177
  v_cvt_pk_bf16_f32 v26, v178, v179
  v_lshlrev_b32 v178, 16, v26
  v_and_b32 v179, 0xffff0000, v26
  v_mul_f32 v178, v178, v24
  v_mul_f32 v179, v179, v24
  v_cvt_pk_bf16_f32 v26, v178, v179
  v_lshlrev_b32 v178, 16, v26
  v_and_b32 v179, 0xffff0000, v26
  v_add_f32 v178, v178, v250
  v_add_f32 v179, v179, v251
  v_cvt_pk_bf16_f32 v235, v178, v179
  buffer_store_dwordx2 v[234:235], v13, s[8:11], s49 offen offset:64
  s_cmp_lt_u32 s2, 16
  s_cbranch_scc1 pv_loop
  s_cmp_eq_u32 s2, 16
  s_cselect_b32 s87, 0, s87
  s_cmp_eq_u32 s87, 0
  s_cbranch_scc1 pv_done
  s_waitcnt vmcnt(2)
  v_mov_b32 v29, 1
  buffer_atomic_add v29, v233, s[72:75], s59 offen sc0 sc1
  s_waitcnt vmcnt(0)
  s_cmp_lg_u32 s20, 0
  s_cbranch_scc1 pvq_337
  s_mov_b64 exec, 1
  ds_write_b32 v30, v29
  s_mov_b64 exec, -1
pvq_337:
  s_mov_b32 s71, 1
  s_waitcnt lgkmcnt(0)
  s_barrier
  ds_read_b32 v23, v30
  s_branch pv_late
pv_done:
main_fin:
  s_waitcnt vmcnt(0)
main_end:
  s_endpgm
.section .rodata,"a"
.p2align 6
.amdhsa_kernel gated_mix__memory_aug_recurrent_mem_tr__sliding_local_dilated__prompt_kernel
  .amdhsa_next_free_vgpr 512
  .amdhsa_next_free_sgpr 102
  .amdhsa_accum_offset 256
  .amdhsa_group_segment_fixed_size 0
  .amdhsa_kernarg_size 112
  .amdhsa_user_sgpr_count 2
  .amdhsa_user_sgpr_kernarg_segment_ptr 1
  .amdhsa_system_sgpr_workgroup_id_x 1
.end_amdhsa_kernel
.text
```
